```python
import torch

def _softmax(x, axis=-1):
    return torch.softmax(x, dim=axis)

def _gelu(x):
    return torch.nn.functional.gelu(x, approximate='tanh')

def _silu(x):
    return torch.nn.functional.silu(x)

def _sigmoid(x):
    return torch.sigmoid(x)

def _layernorm(x, axis=-1, eps=1e-05):
    m = x.mean(dim=axis, keepdim=True)
    v = x.var(dim=axis, keepdim=True, unbiased=False)
    return (x - m) / torch.sqrt(v + eps)

def _scatter_add(tgt, idx, src, axis=0):
    return tgt.clone().index_add_(axis, idx, src)

def _segment_sum(src, seg, n):
    out = torch.zeros((n,) + src.shape[1:], dtype=src.dtype)
    return out.index_add_(0, seg, src)

def _pad(x, pw):
    flat = tuple((v for pair in reversed(pw) for v in pair))
    return torch.nn.functional.pad(x, flat)
kernel_name = 'interleave_layers__memory_aug_recurrent_mem_tr__moe_arch_mod__prompt'

def setup_inputs():

    _w = lambda a: (lambda t: t.to(torch.bfloat16) if t.is_floating_point() else t)(torch.as_tensor(a))

    def _A_setup():
        B, S, Dm = (1, 2048, 512)
        H, Dh = (32, 128)
        M, seg = (8, 32)
        seg = min(seg, S)
        S = S // seg * seg
        return {'x': _w((lambda *s: torch.randn(*s, dtype=torch.bfloat16) * 0.05)(B, S, Dm)), 'mem0': _w((lambda *s: torch.randn(*s, dtype=torch.bfloat16) * 0.8)(B, M, Dm)), 'Wq': _w((lambda *s: torch.randn(*s, dtype=torch.bfloat16) * 0.8)(Dm, H, Dh) * Dm ** (-0.5)), 'Wk': _w((lambda *s: torch.randn(*s, dtype=torch.bfloat16) * 0.8)(Dm, H, Dh) * Dm ** (-0.5)), 'Wv': _w((lambda *s: torch.randn(*s, dtype=torch.bfloat16) * 0.8)(Dm, H, Dh) * Dm ** (-0.5)), 'Wo': _w((lambda *s: torch.randn(*s, dtype=torch.bfloat16) * 0.8)(H, Dh, Dm) * (H * Dh) ** (-0.5)), 'seg_len': seg}
    _A_in = _A_setup()

    def _B_setup():
        B, S, D, F, C = (1, 2048, 512, 1792, 1)
        return {'x': _w((lambda *s: torch.randn(*s, dtype=torch.bfloat16) * 0.05)(B, S, D)), 'w_r': _w((lambda *s: torch.randn(*s, dtype=torch.bfloat16) * 0.05)(D)), 'w_gate': _w((lambda *s: torch.randn(*s, dtype=torch.bfloat16) * 0.05)(D, F)), 'w_up': _w((lambda *s: torch.randn(*s, dtype=torch.bfloat16) * 0.05)(D, F)), 'w_down': _w((lambda *s: torch.randn(*s, dtype=torch.bfloat16) * 0.05)(F, D))}
    _B_in = _B_setup()
    return {'A_x': _A_in['x'], 'A_mem0': _A_in['mem0'], 'A_Wq': _A_in['Wq'], 'A_Wk': _A_in['Wk'], 'A_Wv': _A_in['Wv'], 'A_Wo': _A_in['Wo'], 'A_seg_len': _A_in['seg_len'], 'B_x': _B_in['x'], 'B_w_r': _B_in['w_r'], 'B_w_gate': _B_in['w_gate'], 'B_w_up': _B_in['w_up'], 'B_w_down': _B_in['w_down']}

def reference(A_x, A_mem0, A_Wq, A_Wk, A_Wv, A_Wo, A_seg_len, B_x, B_w_r, B_w_gate, B_w_up, B_w_down):

    def _A_ref(x, mem0, Wq, Wk, Wv, Wo, seg_len):
        B, S, Dm = x.shape
        H, Dh = (Wq.shape[1], Wq.shape[2])
        M = mem0.shape[1]
        scale = Dh ** (-0.5)
        n_seg = S // seg_len
        L = M + seg_len
        idx = torch.arange(L)
        mask = (idx[:, None] < M) | (idx[:, None] >= idx[None, :])
        mem = mem0
        outs = []
        for s in range(n_seg):
            xs = x[:, s * seg_len:(s + 1) * seg_len, :].clone()
            h = torch.concatenate([mem, xs], axis=1)
            q = torch.einsum('btd,dhe->bhte', h, Wq)
            k = torch.einsum('btd,dhe->bhte', h, Wk)
            v = torch.einsum('btd,dhe->bhte', h, Wv)
            scores = torch.einsum('bhqe,bhke->bhqk', q, k) * scale
            scores = torch.where(mask[None, None], scores, -1000000000.0)
            p = _softmax(scores, axis=-1)
            o = torch.einsum('bhqk,bhke->bhqe', p, v)
            o = torch.einsum('bhte,hed->btd', o, Wo)
            mem = o[:, :M, :].clone()
            outs.append(o[:, M:, :])
        return torch.concatenate(outs, axis=1)

    def _B_ref(x, w_r, w_gate, w_up, w_down):
        B, S, D = x.shape
        C = 1
        r = x @ w_r
        idx = torch.argsort(-r, axis=-1)[:, :C]
        idx_e = (lambda x, n, axis: torch.repeat_interleave(x, n, dim=axis))(idx.reshape(B, C, 1), D, axis=2)
        x_sel = (lambda x, i, axis: torch.take_along_dim(x, i, dim=axis))(x, idx_e, axis=1)
        g = _silu(x_sel @ w_gate)
        u = x_sel @ w_up
        y = g * u @ w_down
        r_sel = _sigmoid((lambda x, i, axis: torch.take_along_dim(x, i, dim=axis))(r, idx, axis=1))
        y = y * r_sel.reshape(B, C, 1)
        b_off = (torch.arange(B) * S).reshape(B, 1)
        flat_idx = (idx + b_off).reshape(B * C)
        zero = (x * 0.0).reshape(B * S, D)
        upd = _scatter_add(zero, flat_idx, y.reshape(B * C, D), axis=0)
        return x + upd.reshape(B, S, D)
    x = A_x
    x = x + _A_ref(_layernorm(x, axis=-1), A_mem0, A_Wq, A_Wk, A_Wv, A_Wo, A_seg_len)
    x = x + _B_ref(_layernorm(x, axis=-1), B_w_r, B_w_gate, B_w_up, B_w_down)
    x = x + _A_ref(_layernorm(x, axis=-1), A_mem0, A_Wq, A_Wk, A_Wv, A_Wo, A_seg_len)
    x = x + _B_ref(_layernorm(x, axis=-1), B_w_r, B_w_gate, B_w_up, B_w_down)
    return x
```

```asm
; @launch grid=(256,1,1) block=(256,1,1) lds=163840
.amdgcn_target "amdgcn-amd-amdhsa--gfx950"
.text
.globl interleave_layers__memory_aug_recurrent_mem_tr__moe_arch_mod__prompt_kernel
.p2align 8
.type interleave_layers__memory_aug_recurrent_mem_tr__moe_arch_mod__prompt_kernel,@function
interleave_layers__memory_aug_recurrent_mem_tr__moe_arch_mod__prompt_kernel:
    s_cmp_ge_u32 s2, 256
    s_cbranch_scc1 L_abort
    s_load_dwordx16 s[16:31], s[0:1], 0
    s_load_dwordx8 s[32:39], s[0:1], 64
    s_load_dwordx4 s[40:43], s[0:1], 96
    s_load_dwordx2 s[44:45], s[0:1], 112
    v_lshrrev_b32 v2, 6, v0
    v_and_b32 v1, 63, v0
    v_readfirstlane_b32 s46, v2
    v_lshlrev_b32 v0, 4, v1
    s_getreg_b32 s48, hwreg(HW_REG_XCC_ID)
    s_and_b32 s48, s48, 7
    s_mov_b32 s49, 100000
    s_mov_b32 s50, 0
    s_mov_b32 s80, 0x3e0293ee
    s_waitcnt lgkmcnt(0)
    s_mov_b32 s8, s44
    s_mov_b32 s9, s45
    s_mov_b32 s10, 268435456
    s_mov_b32 s11, 0x20000
    s_mov_b32 s12, s42
    s_mov_b32 s13, s43
    s_mov_b32 s14, 256
    s_mov_b32 s15, 0x20000
    s_cmp_lg_u32 s46, 0
    s_cbranch_scc1 L_tk_1
    s_lshl_b32 s56, s48, 2
    v_mov_b32 v2, s56
    v_mov_b32 v3, 1
    s_mov_b64 exec, 1
    buffer_atomic_add v3, v2, s[12:15], 0 offen sc0
    s_waitcnt vmcnt(0)
    v_mov_b32 v4, 159744
    ds_write_b32 v4, v3
    s_mov_b64 exec, -1
    s_waitcnt lgkmcnt(0)
L_tk_1:
    s_barrier
    v_mov_b32 v4, 159744
    ds_read_b32 v3, v4
    s_waitcnt lgkmcnt(0)
    v_readfirstlane_b32 s47, v3
    s_and_b32 s47, s47, 31
    s_lshl_b32 s56, s2, 12
    s_lshl_b32 s57, s46, 10
    s_add_u32 s56, s56, s57
    v_add_u32 v2, s56, v0
    v_mov_b32 v4, -1
    v_mov_b32 v5, -1
    v_mov_b32 v6, -1
    v_mov_b32 v7, -1
    v_mov_b32 v8, 0
    v_mov_b32 v9, 0
    v_mov_b32 v10, 0
    v_mov_b32 v11, 0
    v_cmp_gt_u32 vcc, 524288, v2
    v_mov_b32 v3, 14155776
    v_mov_b32 v12, 11542528
    v_cndmask_b32 v3, v3, v12, vcc
    v_add_u32 v3, v3, v2
    s_mov_b32 s56, 0
    buffer_store_dwordx4 v[4:7], v3, s[8:11], s56 offen sc1
    s_mov_b32 s56, 1048576
    buffer_store_dwordx4 v[4:7], v3, s[8:11], s56 offen sc1
    s_mov_b32 s56, 2097152
    buffer_store_dwordx4 v[4:7], v3, s[8:11], s56 offen sc1
    v_cmp_gt_u32 vcc, 196608, v2
    v_add_u32 v3, 10551296, v2
    v_mov_b32 v12, 0x80000000
    v_cndmask_b32 v3, v12, v3, vcc
    buffer_store_dwordx4 v[8:11], v3, s[8:11], 0 offen sc1
    s_mov_b32 s4, s16
    s_mov_b32 s5, s17
    s_mov_b32 s6, 2097152
    s_mov_b32 s7, 0x20000
    s_lshl_b32 s56, s2, 3
    s_lshl_b32 s57, s46, 1
    s_add_u32 s56, s56, s57
    s_lshl_b32 s57, s56, 10
    buffer_load_dwordx4 v[24:27], v0, s[4:7], s57 offen
    buffer_load_dwordx4 v[28:31], v0, s[4:7], s57 offen offset:1024
    v_lshrrev_b32 v2, 2, v1
    v_lshlrev_b32 v2, 11, v2
    v_and_b32 v3, 3, v1
    v_lshl_add_u32 v2, v3, 8, v2
    s_lshr_b32 s57, s56, 5
    s_lshl_b32 s57, s57, 15
    s_bfe_u32 s58, s56, 0x10004
    s_lshl_b32 s58, s58, 10
    s_add_u32 s57, s57, s58
    s_and_b32 s58, s56, 15
    s_lshl_b32 s58, s58, 4
    s_add_u32 s57, s57, s58
    s_add_u32 s57, s57, 0
    s_waitcnt vmcnt(0)
    v_lshlrev_b32 v32, 16, v24
    v_and_b32 v33, 0xffff0000, v24
    v_lshlrev_b32 v34, 16, v25
    v_and_b32 v35, 0xffff0000, v25
    v_lshlrev_b32 v36, 16, v26
    v_and_b32 v37, 0xffff0000, v26
    v_lshlrev_b32 v38, 16, v27
    v_and_b32 v39, 0xffff0000, v27
    v_add_f32 v56, v32, v33
    v_add_f32 v57, v34, v35
    v_add_f32 v58, v36, v37
    v_add_f32 v59, v38, v39
    v_add_f32 v56, v56, v57
    v_add_f32 v58, v58, v59
    v_add_f32 v56, v56, v58
    s_nop 1
    v_add_f32_dpp v56, v56, v56 row_ror:8 row_mask:0xf bank_mask:0xf
    s_nop 1
    v_add_f32_dpp v56, v56, v56 row_ror:4 row_mask:0xf bank_mask:0xf
    s_nop 1
    v_add_f32_dpp v56, v56, v56 row_ror:2 row_mask:0xf bank_mask:0xf
    s_nop 1
    v_add_f32_dpp v56, v56, v56 row_ror:1 row_mask:0xf bank_mask:0xf
    v_mov_b32 v57, v56
    s_nop 1
    v_permlane16_swap_b32 v56, v57
    v_add_f32 v56, v56, v57
    v_mov_b32 v57, v56
    s_nop 1
    v_permlane32_swap_b32 v56, v57
    v_add_f32 v56, v56, v57
    v_mul_f32 v58, 0x3b000000, v56
    v_sub_f32 v48, v32, v58
    v_sub_f32 v49, v33, v58
    v_sub_f32 v50, v34, v58
    v_sub_f32 v51, v35, v58
    v_sub_f32 v52, v36, v58
    v_sub_f32 v53, v37, v58
    v_sub_f32 v54, v38, v58
    v_sub_f32 v55, v39, v58
    v_mul_f32 v56, v48, v48
    v_mul_f32 v59, v49, v49
    v_fmac_f32 v56, v50, v50
    v_fmac_f32 v59, v51, v51
    v_fmac_f32 v56, v52, v52
    v_fmac_f32 v59, v53, v53
    v_fmac_f32 v56, v54, v54
    v_fmac_f32 v59, v55, v55
    v_add_f32 v56, v56, v59
    v_cvt_pk_bf16_f32 v58, v58, v58
    v_and_b32 v58, 0xffff0000, v58
    v_add_f32_dpp v56, v56, v56 row_ror:8 row_mask:0xf bank_mask:0xf
    s_nop 1
    v_add_f32_dpp v56, v56, v56 row_ror:4 row_mask:0xf bank_mask:0xf
    s_nop 1
    v_add_f32_dpp v56, v56, v56 row_ror:2 row_mask:0xf bank_mask:0xf
    s_nop 1
    v_add_f32_dpp v56, v56, v56 row_ror:1 row_mask:0xf bank_mask:0xf
    v_mov_b32 v57, v56
    s_nop 1
    v_permlane16_swap_b32 v56, v57
    v_add_f32 v56, v56, v57
    v_mov_b32 v57, v56
    s_nop 1
    v_permlane32_swap_b32 v56, v57
    v_add_f32 v56, v56, v57
    v_mul_f32 v56, 0x3b000000, v56
    v_cvt_pk_bf16_f32 v56, v56, v56
    v_and_b32 v56, 0xffff0000, v56
    v_add_f32 v56, 0x3727c5ac, v56
    v_cvt_pk_bf16_f32 v56, v56, v56
    v_and_b32 v56, 0xffff0000, v56
    v_sqrt_f32 v56, v56
    v_sub_f32 v48, v32, v58
    v_sub_f32 v49, v33, v58
    v_sub_f32 v50, v34, v58
    v_sub_f32 v51, v35, v58
    v_sub_f32 v52, v36, v58
    v_sub_f32 v53, v37, v58
    v_sub_f32 v54, v38, v58
    v_sub_f32 v55, v39, v58
    v_cvt_pk_bf16_f32 v56, v56, v56
    v_and_b32 v56, 0xffff0000, v56
    v_rcp_f32 v56, v56
    v_cvt_pk_bf16_f32 v40, v48, v49
    v_cvt_pk_bf16_f32 v41, v50, v51
    v_cvt_pk_bf16_f32 v42, v52, v53
    v_cvt_pk_bf16_f32 v43, v54, v55
    v_lshlrev_b32 v48, 16, v40
    v_and_b32 v49, 0xffff0000, v40
    v_lshlrev_b32 v50, 16, v41
    v_and_b32 v51, 0xffff0000, v41
    v_lshlrev_b32 v52, 16, v42
    v_and_b32 v53, 0xffff0000, v42
    v_lshlrev_b32 v54, 16, v43
    v_and_b32 v55, 0xffff0000, v43
    v_mul_f32 v48, v48, v56
    v_mul_f32 v49, v49, v56
    v_mul_f32 v50, v50, v56
    v_mul_f32 v51, v51, v56
    v_mul_f32 v52, v52, v56
    v_mul_f32 v53, v53, v56
    v_mul_f32 v54, v54, v56
    v_mul_f32 v55, v55, v56
    v_cvt_pk_bf16_f32 v40, v48, v49
    v_cvt_pk_bf16_f32 v41, v50, v51
    v_cvt_pk_bf16_f32 v42, v52, v53
    v_cvt_pk_bf16_f32 v43, v54, v55
    buffer_store_dwordx4 v[40:43], v2, s[8:11], s57 offen offset:0 sc1
    v_lshlrev_b32 v32, 16, v28
    v_and_b32 v33, 0xffff0000, v28
    v_lshlrev_b32 v34, 16, v29
    v_and_b32 v35, 0xffff0000, v29
    v_lshlrev_b32 v36, 16, v30
    v_and_b32 v37, 0xffff0000, v30
    v_lshlrev_b32 v38, 16, v31
    v_and_b32 v39, 0xffff0000, v31
    v_add_f32 v56, v32, v33
    v_add_f32 v57, v34, v35
    v_add_f32 v58, v36, v37
    v_add_f32 v59, v38, v39
    v_add_f32 v56, v56, v57
    v_add_f32 v58, v58, v59
    v_add_f32 v56, v56, v58
    s_nop 1
    v_add_f32_dpp v56, v56, v56 row_ror:8 row_mask:0xf bank_mask:0xf
    s_nop 1
    v_add_f32_dpp v56, v56, v56 row_ror:4 row_mask:0xf bank_mask:0xf
    s_nop 1
    v_add_f32_dpp v56, v56, v56 row_ror:2 row_mask:0xf bank_mask:0xf
    s_nop 1
    v_add_f32_dpp v56, v56, v56 row_ror:1 row_mask:0xf bank_mask:0xf
    v_mov_b32 v57, v56
    s_nop 1
    v_permlane16_swap_b32 v56, v57
    v_add_f32 v56, v56, v57
    v_mov_b32 v57, v56
    s_nop 1
    v_permlane32_swap_b32 v56, v57
    v_add_f32 v56, v56, v57
    v_mul_f32 v58, 0x3b000000, v56
    v_sub_f32 v48, v32, v58
    v_sub_f32 v49, v33, v58
    v_sub_f32 v50, v34, v58
    v_sub_f32 v51, v35, v58
    v_sub_f32 v52, v36, v58
    v_sub_f32 v53, v37, v58
    v_sub_f32 v54, v38, v58
    v_sub_f32 v55, v39, v58
    v_mul_f32 v56, v48, v48
    v_mul_f32 v59, v49, v49
    v_fmac_f32 v56, v50, v50
    v_fmac_f32 v59, v51, v51
    v_fmac_f32 v56, v52, v52
    v_fmac_f32 v59, v53, v53
    v_fmac_f32 v56, v54, v54
    v_fmac_f32 v59, v55, v55
    v_add_f32 v56, v56, v59
    v_cvt_pk_bf16_f32 v58, v58, v58
    v_and_b32 v58, 0xffff0000, v58
    v_add_f32_dpp v56, v56, v56 row_ror:8 row_mask:0xf bank_mask:0xf
    s_nop 1
    v_add_f32_dpp v56, v56, v56 row_ror:4 row_mask:0xf bank_mask:0xf
    s_nop 1
    v_add_f32_dpp v56, v56, v56 row_ror:2 row_mask:0xf bank_mask:0xf
    s_nop 1
    v_add_f32_dpp v56, v56, v56 row_ror:1 row_mask:0xf bank_mask:0xf
    v_mov_b32 v57, v56
    s_nop 1
    v_permlane16_swap_b32 v56, v57
    v_add_f32 v56, v56, v57
    v_mov_b32 v57, v56
    s_nop 1
    v_permlane32_swap_b32 v56, v57
    v_add_f32 v56, v56, v57
    v_mul_f32 v56, 0x3b000000, v56
    v_cvt_pk_bf16_f32 v56, v56, v56
    v_and_b32 v56, 0xffff0000, v56
    v_add_f32 v56, 0x3727c5ac, v56
    v_cvt_pk_bf16_f32 v56, v56, v56
    v_and_b32 v56, 0xffff0000, v56
    v_sqrt_f32 v56, v56
    v_sub_f32 v48, v32, v58
    v_sub_f32 v49, v33, v58
    v_sub_f32 v50, v34, v58
    v_sub_f32 v51, v35, v58
    v_sub_f32 v52, v36, v58
    v_sub_f32 v53, v37, v58
    v_sub_f32 v54, v38, v58
    v_sub_f32 v55, v39, v58
    v_cvt_pk_bf16_f32 v56, v56, v56
    v_and_b32 v56, 0xffff0000, v56
    v_rcp_f32 v56, v56
    v_cvt_pk_bf16_f32 v44, v48, v49
    v_cvt_pk_bf16_f32 v45, v50, v51
    v_cvt_pk_bf16_f32 v46, v52, v53
    v_cvt_pk_bf16_f32 v47, v54, v55
    v_lshlrev_b32 v48, 16, v44
    v_and_b32 v49, 0xffff0000, v44
    v_lshlrev_b32 v50, 16, v45
    v_and_b32 v51, 0xffff0000, v45
    v_lshlrev_b32 v52, 16, v46
    v_and_b32 v53, 0xffff0000, v46
    v_lshlrev_b32 v54, 16, v47
    v_and_b32 v55, 0xffff0000, v47
    v_mul_f32 v48, v48, v56
    v_mul_f32 v49, v49, v56
    v_mul_f32 v50, v50, v56
    v_mul_f32 v51, v51, v56
    v_mul_f32 v52, v52, v56
    v_mul_f32 v53, v53, v56
    v_mul_f32 v54, v54, v56
    v_mul_f32 v55, v55, v56
    v_cvt_pk_bf16_f32 v44, v48, v49
    v_cvt_pk_bf16_f32 v45, v50, v51
    v_cvt_pk_bf16_f32 v46, v52, v53
    v_cvt_pk_bf16_f32 v47, v54, v55
    buffer_store_dwordx4 v[44:47], v2, s[8:11], s57 offen offset:16 sc1
    s_mov_b32 s4, s18
    s_mov_b32 s5, s19
    s_mov_b32 s6, 8192
    s_mov_b32 s7, 0x20000
    s_cmp_ge_u32 s2, 2
    s_cbranch_scc1 L_m0_2
    s_lshl_b32 s56, s2, 2
    s_add_u32 s56, s56, s46
    v_and_b32 v2, 7, v1
    v_lshlrev_b32 v2, 10, v2
    v_lshrrev_b32 v3, 4, v1
    v_lshl_add_u32 v2, v3, 5, v2
    s_lshl_b32 s57, s56, 7
    buffer_load_dwordx4 v[24:27], v2, s[4:7], s57 offen
    buffer_load_dwordx4 v[28:31], v2, s[4:7], s57 offen offset:16
    v_and_b32 v3, 8, v1
    v_cmp_eq_u32 vcc, 0, v3
    v_mov_b32 v4, 0x07060302
    v_mov_b32 v5, 0x05040100
    v_cndmask_b32 v4, v4, v5, vcc
    s_lshl_b32 s57, s56, 10
    s_waitcnt vmcnt(0)
    v_perm_b32 v32, v25, v24, v4
    v_perm_b32 v33, v27, v26, v4
    v_perm_b32 v34, v29, v28, v4
    v_perm_b32 v35, v31, v30, v4
    s_add_u32 s58, s57, 11534336
    buffer_store_dwordx4 v[32:35], v0, s[8:11], s58 offen sc1
    s_add_u32 s58, s57, 12582912
    buffer_store_dwordx4 v[32:35], v0, s[8:11], s58 offen sc1
    s_add_u32 s58, s57, 13631488
    buffer_store_dwordx4 v[32:35], v0, s[8:11], s58 offen sc1
L_m0_2:
    v_and_b32 v2, 15, v1
    v_lshlrev_b32 v2, 2, v2
    v_lshrrev_b32 v3, 4, v1
    v_lshl_add_u32 v4, v3, 16, v2
    v_lshl_add_u32 v5, v3, 13, v2
    s_lshl_b32 s58, s47, 8
    s_lshl_b32 s57, s46, 6
    s_add_u32 s58, s58, s57
    s_lshl_b32 s59, s47, 17
    s_add_u32 s59, s59, s57
    s_lshl_b32 s60, s46, 15
    v_add_u32 v6, s60, v0
    s_mov_b32 s61, 0x05040100
    s_mov_b32 s62, 0x07060302
    s_mov_b32 s4, s22
    s_mov_b32 s5, s23
    s_mov_b32 s6, 4194304
    s_mov_b32 s7, 0x20000
    s_add_u32 s56, s58, 0
    buffer_load_dword v24, v4, s[4:7], s56 offen
    s_add_u32 s56, s58, 8192
    buffer_load_dword v25, v4, s[4:7], s56 offen
    s_add_u32 s56, s58, 16384
    buffer_load_dword v26, v4, s[4:7], s56 offen
    s_add_u32 s56, s58, 24576
    buffer_load_dword v27, v4, s[4:7], s56 offen
    s_add_u32 s56, s58, 32768
    buffer_load_dword v28, v4, s[4:7], s56 offen
    s_add_u32 s56, s58, 40960
    buffer_load_dword v29, v4, s[4:7], s56 offen
    s_add_u32 s56, s58, 49152
    buffer_load_dword v30, v4, s[4:7], s56 offen
    s_add_u32 s56, s58, 57344
    buffer_load_dword v31, v4, s[4:7], s56 offen
    s_add_u32 s56, s58, 262144
    buffer_load_dword v32, v4, s[4:7], s56 offen
    s_add_u32 s56, s58, 270336
    buffer_load_dword v33, v4, s[4:7], s56 offen
    s_add_u32 s56, s58, 278528
    buffer_load_dword v34, v4, s[4:7], s56 offen
    s_add_u32 s56, s58, 286720
    buffer_load_dword v35, v4, s[4:7], s56 offen
    s_add_u32 s56, s58, 294912
    buffer_load_dword v36, v4, s[4:7], s56 offen
    s_add_u32 s56, s58, 303104
    buffer_load_dword v37, v4, s[4:7], s56 offen
    s_add_u32 s56, s58, 311296
    buffer_load_dword v38, v4, s[4:7], s56 offen
    s_add_u32 s56, s58, 319488
    buffer_load_dword v39, v4, s[4:7], s56 offen
    s_add_u32 s56, s58, 524288
    buffer_load_dword v40, v4, s[4:7], s56 offen
    s_add_u32 s56, s58, 532480
    buffer_load_dword v41, v4, s[4:7], s56 offen
    s_add_u32 s56, s58, 540672
    buffer_load_dword v42, v4, s[4:7], s56 offen
    s_add_u32 s56, s58, 548864
    buffer_load_dword v43, v4, s[4:7], s56 offen
    s_add_u32 s56, s58, 557056
    buffer_load_dword v44, v4, s[4:7], s56 offen
    s_add_u32 s56, s58, 565248
    buffer_load_dword v45, v4, s[4:7], s56 offen
    s_add_u32 s56, s58, 573440
    buffer_load_dword v46, v4, s[4:7], s56 offen
    s_add_u32 s56, s58, 581632
    buffer_load_dword v47, v4, s[4:7], s56 offen
    s_add_u32 s56, s58, 786432
    buffer_load_dword v48, v4, s[4:7], s56 offen
    s_add_u32 s56, s58, 794624
    buffer_load_dword v49, v4, s[4:7], s56 offen
    s_add_u32 s56, s58, 802816
    buffer_load_dword v50, v4, s[4:7], s56 offen
    s_add_u32 s56, s58, 811008
    buffer_load_dword v51, v4, s[4:7], s56 offen
    s_add_u32 s56, s58, 819200
    buffer_load_dword v52, v4, s[4:7], s56 offen
    s_add_u32 s56, s58, 827392
    buffer_load_dword v53, v4, s[4:7], s56 offen
    s_add_u32 s56, s58, 835584
    buffer_load_dword v54, v4, s[4:7], s56 offen
    s_add_u32 s56, s58, 843776
    buffer_load_dword v55, v4, s[4:7], s56 offen
    s_add_u32 s56, s58, 1048576
    buffer_load_dword v56, v4, s[4:7], s56 offen
    s_add_u32 s56, s58, 1056768
    buffer_load_dword v57, v4, s[4:7], s56 offen
    s_add_u32 s56, s58, 1064960
    buffer_load_dword v58, v4, s[4:7], s56 offen
    s_add_u32 s56, s58, 1073152
    buffer_load_dword v59, v4, s[4:7], s56 offen
    s_add_u32 s56, s58, 1081344
    buffer_load_dword v60, v4, s[4:7], s56 offen
    s_add_u32 s56, s58, 1089536
    buffer_load_dword v61, v4, s[4:7], s56 offen
    s_add_u32 s56, s58, 1097728
    buffer_load_dword v62, v4, s[4:7], s56 offen
    s_add_u32 s56, s58, 1105920
    buffer_load_dword v63, v4, s[4:7], s56 offen
    s_add_u32 s56, s58, 1310720
    buffer_load_dword v64, v4, s[4:7], s56 offen
    s_add_u32 s56, s58, 1318912
    buffer_load_dword v65, v4, s[4:7], s56 offen
    s_add_u32 s56, s58, 1327104
    buffer_load_dword v66, v4, s[4:7], s56 offen
    s_add_u32 s56, s58, 1335296
    buffer_load_dword v67, v4, s[4:7], s56 offen
    s_add_u32 s56, s58, 1343488
    buffer_load_dword v68, v4, s[4:7], s56 offen
    s_add_u32 s56, s58, 1351680
    buffer_load_dword v69, v4, s[4:7], s56 offen
    s_add_u32 s56, s58, 1359872
    buffer_load_dword v70, v4, s[4:7], s56 offen
    s_add_u32 s56, s58, 1368064
    buffer_load_dword v71, v4, s[4:7], s56 offen
    s_add_u32 s56, s58, 1572864
    buffer_load_dword v72, v4, s[4:7], s56 offen
    s_add_u32 s56, s58, 1581056
    buffer_load_dword v73, v4, s[4:7], s56 offen
    s_add_u32 s56, s58, 1589248
    buffer_load_dword v74, v4, s[4:7], s56 offen
    s_add_u32 s56, s58, 1597440
    buffer_load_dword v75, v4, s[4:7], s56 offen
    s_add_u32 s56, s58, 1605632
    buffer_load_dword v76, v4, s[4:7], s56 offen
    s_add_u32 s56, s58, 1613824
    buffer_load_dword v77, v4, s[4:7], s56 offen
    s_add_u32 s56, s58, 1622016
    buffer_load_dword v78, v4, s[4:7], s56 offen
    s_add_u32 s56, s58, 1630208
    buffer_load_dword v79, v4, s[4:7], s56 offen
    s_waitcnt vmcnt(48)
    v_perm_b32 v80, v25, v24, s61
    v_perm_b32 v81, v27, v26, s61
    v_perm_b32 v82, v29, v28, s61
    v_perm_b32 v83, v31, v30, s61
    v_perm_b32 v84, v25, v24, s62
    v_perm_b32 v85, v27, v26, s62
    v_perm_b32 v86, v29, v28, s62
    v_perm_b32 v87, v31, v30, s62
    v_accvgpr_write_b32 a128, v80
    v_accvgpr_write_b32 a129, v81
    v_accvgpr_write_b32 a130, v82
    v_accvgpr_write_b32 a131, v83
    v_accvgpr_write_b32 a136, v84
    v_accvgpr_write_b32 a137, v85
    v_accvgpr_write_b32 a138, v86
    v_accvgpr_write_b32 a139, v87
    s_add_u32 s56, s58, 1835008
    buffer_load_dword v24, v4, s[4:7], s56 offen
    s_add_u32 s56, s58, 1843200
    buffer_load_dword v25, v4, s[4:7], s56 offen
    s_add_u32 s56, s58, 1851392
    buffer_load_dword v26, v4, s[4:7], s56 offen
    s_add_u32 s56, s58, 1859584
    buffer_load_dword v27, v4, s[4:7], s56 offen
    s_add_u32 s56, s58, 1867776
    buffer_load_dword v28, v4, s[4:7], s56 offen
    s_add_u32 s56, s58, 1875968
    buffer_load_dword v29, v4, s[4:7], s56 offen
    s_add_u32 s56, s58, 1884160
    buffer_load_dword v30, v4, s[4:7], s56 offen
    s_add_u32 s56, s58, 1892352
    buffer_load_dword v31, v4, s[4:7], s56 offen
    s_waitcnt vmcnt(48)
    v_perm_b32 v80, v33, v32, s61
    v_perm_b32 v81, v35, v34, s61
    v_perm_b32 v82, v37, v36, s61
    v_perm_b32 v83, v39, v38, s61
    v_perm_b32 v84, v33, v32, s62
    v_perm_b32 v85, v35, v34, s62
    v_perm_b32 v86, v37, v36, s62
    v_perm_b32 v87, v39, v38, s62
    v_accvgpr_write_b32 a132, v80
    v_accvgpr_write_b32 a133, v81
    v_accvgpr_write_b32 a134, v82
    v_accvgpr_write_b32 a135, v83
    v_accvgpr_write_b32 a140, v84
    v_accvgpr_write_b32 a141, v85
    v_accvgpr_write_b32 a142, v86
    v_accvgpr_write_b32 a143, v87
    s_add_u32 s56, s58, 2097152
    buffer_load_dword v32, v4, s[4:7], s56 offen
    s_add_u32 s56, s58, 2105344
    buffer_load_dword v33, v4, s[4:7], s56 offen
    s_add_u32 s56, s58, 2113536
    buffer_load_dword v34, v4, s[4:7], s56 offen
    s_add_u32 s56, s58, 2121728
    buffer_load_dword v35, v4, s[4:7], s56 offen
    s_add_u32 s56, s58, 2129920
    buffer_load_dword v36, v4, s[4:7], s56 offen
    s_add_u32 s56, s58, 2138112
    buffer_load_dword v37, v4, s[4:7], s56 offen
    s_add_u32 s56, s58, 2146304
    buffer_load_dword v38, v4, s[4:7], s56 offen
    s_add_u32 s56, s58, 2154496
    buffer_load_dword v39, v4, s[4:7], s56 offen
    s_waitcnt vmcnt(48)
    v_perm_b32 v80, v41, v40, s61
    v_perm_b32 v81, v43, v42, s61
    v_perm_b32 v82, v45, v44, s61
    v_perm_b32 v83, v47, v46, s61
    v_perm_b32 v84, v41, v40, s62
    v_perm_b32 v85, v43, v42, s62
    v_perm_b32 v86, v45, v44, s62
    v_perm_b32 v87, v47, v46, s62
    v_accvgpr_write_b32 a144, v80
    v_accvgpr_write_b32 a145, v81
    v_accvgpr_write_b32 a146, v82
    v_accvgpr_write_b32 a147, v83
    v_accvgpr_write_b32 a152, v84
    v_accvgpr_write_b32 a153, v85
    v_accvgpr_write_b32 a154, v86
    v_accvgpr_write_b32 a155, v87
    s_add_u32 s56, s58, 2359296
    buffer_load_dword v40, v4, s[4:7], s56 offen
    s_add_u32 s56, s58, 2367488
    buffer_load_dword v41, v4, s[4:7], s56 offen
    s_add_u32 s56, s58, 2375680
    buffer_load_dword v42, v4, s[4:7], s56 offen
    s_add_u32 s56, s58, 2383872
    buffer_load_dword v43, v4, s[4:7], s56 offen
    s_add_u32 s56, s58, 2392064
    buffer_load_dword v44, v4, s[4:7], s56 offen
    s_add_u32 s56, s58, 2400256
    buffer_load_dword v45, v4, s[4:7], s56 offen
    s_add_u32 s56, s58, 2408448
    buffer_load_dword v46, v4, s[4:7], s56 offen
    s_add_u32 s56, s58, 2416640
    buffer_load_dword v47, v4, s[4:7], s56 offen
    s_waitcnt vmcnt(48)
    v_perm_b32 v80, v49, v48, s61
    v_perm_b32 v81, v51, v50, s61
    v_perm_b32 v82, v53, v52, s61
    v_perm_b32 v83, v55, v54, s61
    v_perm_b32 v84, v49, v48, s62
    v_perm_b32 v85, v51, v50, s62
    v_perm_b32 v86, v53, v52, s62
    v_perm_b32 v87, v55, v54, s62
    v_accvgpr_write_b32 a148, v80
    v_accvgpr_write_b32 a149, v81
    v_accvgpr_write_b32 a150, v82
    v_accvgpr_write_b32 a151, v83
    v_accvgpr_write_b32 a156, v84
    v_accvgpr_write_b32 a157, v85
    v_accvgpr_write_b32 a158, v86
    v_accvgpr_write_b32 a159, v87
    s_add_u32 s56, s58, 2621440
    buffer_load_dword v48, v4, s[4:7], s56 offen
    s_add_u32 s56, s58, 2629632
    buffer_load_dword v49, v4, s[4:7], s56 offen
    s_add_u32 s56, s58, 2637824
    buffer_load_dword v50, v4, s[4:7], s56 offen
    s_add_u32 s56, s58, 2646016
    buffer_load_dword v51, v4, s[4:7], s56 offen
    s_add_u32 s56, s58, 2654208
    buffer_load_dword v52, v4, s[4:7], s56 offen
    s_add_u32 s56, s58, 2662400
    buffer_load_dword v53, v4, s[4:7], s56 offen
    s_add_u32 s56, s58, 2670592
    buffer_load_dword v54, v4, s[4:7], s56 offen
    s_add_u32 s56, s58, 2678784
    buffer_load_dword v55, v4, s[4:7], s56 offen
    s_waitcnt vmcnt(48)
    v_perm_b32 v80, v57, v56, s61
    v_perm_b32 v81, v59, v58, s61
    v_perm_b32 v82, v61, v60, s61
    v_perm_b32 v83, v63, v62, s61
    v_perm_b32 v84, v57, v56, s62
    v_perm_b32 v85, v59, v58, s62
    v_perm_b32 v86, v61, v60, s62
    v_perm_b32 v87, v63, v62, s62
    v_accvgpr_write_b32 a160, v80
    v_accvgpr_write_b32 a161, v81
    v_accvgpr_write_b32 a162, v82
    v_accvgpr_write_b32 a163, v83
    v_accvgpr_write_b32 a168, v84
    v_accvgpr_write_b32 a169, v85
    v_accvgpr_write_b32 a170, v86
    v_accvgpr_write_b32 a171, v87
    s_add_u32 s56, s58, 2883584
    buffer_load_dword v56, v4, s[4:7], s56 offen
    s_add_u32 s56, s58, 2891776
    buffer_load_dword v57, v4, s[4:7], s56 offen
    s_add_u32 s56, s58, 2899968
    buffer_load_dword v58, v4, s[4:7], s56 offen
    s_add_u32 s56, s58, 2908160
    buffer_load_dword v59, v4, s[4:7], s56 offen
    s_add_u32 s56, s58, 2916352
    buffer_load_dword v60, v4, s[4:7], s56 offen
    s_add_u32 s56, s58, 2924544
    buffer_load_dword v61, v4, s[4:7], s56 offen
    s_add_u32 s56, s58, 2932736
    buffer_load_dword v62, v4, s[4:7], s56 offen
    s_add_u32 s56, s58, 2940928
    buffer_load_dword v63, v4, s[4:7], s56 offen
    s_waitcnt vmcnt(48)
    v_perm_b32 v80, v65, v64, s61
    v_perm_b32 v81, v67, v66, s61
    v_perm_b32 v82, v69, v68, s61
    v_perm_b32 v83, v71, v70, s61
    v_perm_b32 v84, v65, v64, s62
    v_perm_b32 v85, v67, v66, s62
    v_perm_b32 v86, v69, v68, s62
    v_perm_b32 v87, v71, v70, s62
    v_accvgpr_write_b32 a164, v80
    v_accvgpr_write_b32 a165, v81
    v_accvgpr_write_b32 a166, v82
    v_accvgpr_write_b32 a167, v83
    v_accvgpr_write_b32 a172, v84
    v_accvgpr_write_b32 a173, v85
    v_accvgpr_write_b32 a174, v86
    v_accvgpr_write_b32 a175, v87
    s_add_u32 s56, s58, 3145728
    buffer_load_dword v64, v4, s[4:7], s56 offen
    s_add_u32 s56, s58, 3153920
    buffer_load_dword v65, v4, s[4:7], s56 offen
    s_add_u32 s56, s58, 3162112
    buffer_load_dword v66, v4, s[4:7], s56 offen
    s_add_u32 s56, s58, 3170304
    buffer_load_dword v67, v4, s[4:7], s56 offen
    s_add_u32 s56, s58, 3178496
    buffer_load_dword v68, v4, s[4:7], s56 offen
    s_add_u32 s56, s58, 3186688
    buffer_load_dword v69, v4, s[4:7], s56 offen
    s_add_u32 s56, s58, 3194880
    buffer_load_dword v70, v4, s[4:7], s56 offen
    s_add_u32 s56, s58, 3203072
    buffer_load_dword v71, v4, s[4:7], s56 offen
    s_waitcnt vmcnt(48)
    v_perm_b32 v80, v73, v72, s61
    v_perm_b32 v81, v75, v74, s61
    v_perm_b32 v82, v77, v76, s61
    v_perm_b32 v83, v79, v78, s61
    v_perm_b32 v84, v73, v72, s62
    v_perm_b32 v85, v75, v74, s62
    v_perm_b32 v86, v77, v76, s62
    v_perm_b32 v87, v79, v78, s62
    v_accvgpr_write_b32 a176, v80
    v_accvgpr_write_b32 a177, v81
    v_accvgpr_write_b32 a178, v82
    v_accvgpr_write_b32 a179, v83
    v_accvgpr_write_b32 a184, v84
    v_accvgpr_write_b32 a185, v85
    v_accvgpr_write_b32 a186, v86
    v_accvgpr_write_b32 a187, v87
    s_add_u32 s56, s58, 3407872
    buffer_load_dword v72, v4, s[4:7], s56 offen
    s_add_u32 s56, s58, 3416064
    buffer_load_dword v73, v4, s[4:7], s56 offen
    s_add_u32 s56, s58, 3424256
    buffer_load_dword v74, v4, s[4:7], s56 offen
    s_add_u32 s56, s58, 3432448
    buffer_load_dword v75, v4, s[4:7], s56 offen
    s_add_u32 s56, s58, 3440640
    buffer_load_dword v76, v4, s[4:7], s56 offen
    s_add_u32 s56, s58, 3448832
    buffer_load_dword v77, v4, s[4:7], s56 offen
    s_add_u32 s56, s58, 3457024
    buffer_load_dword v78, v4, s[4:7], s56 offen
    s_add_u32 s56, s58, 3465216
    buffer_load_dword v79, v4, s[4:7], s56 offen
    s_waitcnt vmcnt(48)
    v_perm_b32 v80, v25, v24, s61
    v_perm_b32 v81, v27, v26, s61
    v_perm_b32 v82, v29, v28, s61
    v_perm_b32 v83, v31, v30, s61
    v_perm_b32 v84, v25, v24, s62
    v_perm_b32 v85, v27, v26, s62
    v_perm_b32 v86, v29, v28, s62
    v_perm_b32 v87, v31, v30, s62
    v_accvgpr_write_b32 a180, v80
    v_accvgpr_write_b32 a181, v81
    v_accvgpr_write_b32 a182, v82
    v_accvgpr_write_b32 a183, v83
    v_accvgpr_write_b32 a188, v84
    v_accvgpr_write_b32 a189, v85
    v_accvgpr_write_b32 a190, v86
    v_accvgpr_write_b32 a191, v87
    s_add_u32 s56, s58, 3670016
    buffer_load_dword v24, v4, s[4:7], s56 offen
    s_add_u32 s56, s58, 3678208
    buffer_load_dword v25, v4, s[4:7], s56 offen
    s_add_u32 s56, s58, 3686400
    buffer_load_dword v26, v4, s[4:7], s56 offen
    s_add_u32 s56, s58, 3694592
    buffer_load_dword v27, v4, s[4:7], s56 offen
    s_add_u32 s56, s58, 3702784
    buffer_load_dword v28, v4, s[4:7], s56 offen
    s_add_u32 s56, s58, 3710976
    buffer_load_dword v29, v4, s[4:7], s56 offen
    s_add_u32 s56, s58, 3719168
    buffer_load_dword v30, v4, s[4:7], s56 offen
    s_add_u32 s56, s58, 3727360
    buffer_load_dword v31, v4, s[4:7], s56 offen
    s_waitcnt vmcnt(48)
    v_perm_b32 v80, v33, v32, s61
    v_perm_b32 v81, v35, v34, s61
    v_perm_b32 v82, v37, v36, s61
    v_perm_b32 v83, v39, v38, s61
    v_perm_b32 v84, v33, v32, s62
    v_perm_b32 v85, v35, v34, s62
    v_perm_b32 v86, v37, v36, s62
    v_perm_b32 v87, v39, v38, s62
    v_accvgpr_write_b32 a192, v80
    v_accvgpr_write_b32 a193, v81
    v_accvgpr_write_b32 a194, v82
    v_accvgpr_write_b32 a195, v83
    v_accvgpr_write_b32 a200, v84
    v_accvgpr_write_b32 a201, v85
    v_accvgpr_write_b32 a202, v86
    v_accvgpr_write_b32 a203, v87
    s_add_u32 s56, s58, 3932160
    buffer_load_dword v32, v4, s[4:7], s56 offen
    s_add_u32 s56, s58, 3940352
    buffer_load_dword v33, v4, s[4:7], s56 offen
    s_add_u32 s56, s58, 3948544
    buffer_load_dword v34, v4, s[4:7], s56 offen
    s_add_u32 s56, s58, 3956736
    buffer_load_dword v35, v4, s[4:7], s56 offen
    s_add_u32 s56, s58, 3964928
    buffer_load_dword v36, v4, s[4:7], s56 offen
    s_add_u32 s56, s58, 3973120
    buffer_load_dword v37, v4, s[4:7], s56 offen
    s_add_u32 s56, s58, 3981312
    buffer_load_dword v38, v4, s[4:7], s56 offen
    s_add_u32 s56, s58, 3989504
    buffer_load_dword v39, v4, s[4:7], s56 offen
    s_waitcnt vmcnt(48)
    v_perm_b32 v80, v41, v40, s61
    v_perm_b32 v81, v43, v42, s61
    v_perm_b32 v82, v45, v44, s61
    v_perm_b32 v83, v47, v46, s61
    v_perm_b32 v84, v41, v40, s62
    v_perm_b32 v85, v43, v42, s62
    v_perm_b32 v86, v45, v44, s62
    v_perm_b32 v87, v47, v46, s62
    v_accvgpr_write_b32 a196, v80
    v_accvgpr_write_b32 a197, v81
    v_accvgpr_write_b32 a198, v82
    v_accvgpr_write_b32 a199, v83
    v_accvgpr_write_b32 a204, v84
    v_accvgpr_write_b32 a205, v85
    v_accvgpr_write_b32 a206, v86
    v_accvgpr_write_b32 a207, v87
    s_mov_b32 s4, s24
    s_mov_b32 s5, s25
    s_mov_b32 s6, 4194304
    s_mov_b32 s7, 0x20000
    s_add_u32 s56, s58, 0
    buffer_load_dword v40, v4, s[4:7], s56 offen
    s_add_u32 s56, s58, 8192
    buffer_load_dword v41, v4, s[4:7], s56 offen
    s_add_u32 s56, s58, 16384
    buffer_load_dword v42, v4, s[4:7], s56 offen
    s_add_u32 s56, s58, 24576
    buffer_load_dword v43, v4, s[4:7], s56 offen
    s_add_u32 s56, s58, 32768
    buffer_load_dword v44, v4, s[4:7], s56 offen
    s_add_u32 s56, s58, 40960
    buffer_load_dword v45, v4, s[4:7], s56 offen
    s_add_u32 s56, s58, 49152
    buffer_load_dword v46, v4, s[4:7], s56 offen
    s_add_u32 s56, s58, 57344
    buffer_load_dword v47, v4, s[4:7], s56 offen
    s_waitcnt vmcnt(48)
    v_perm_b32 v80, v49, v48, s61
    v_perm_b32 v81, v51, v50, s61
    v_perm_b32 v82, v53, v52, s61
    v_perm_b32 v83, v55, v54, s61
    v_perm_b32 v84, v49, v48, s62
    v_perm_b32 v85, v51, v50, s62
    v_perm_b32 v86, v53, v52, s62
    v_perm_b32 v87, v55, v54, s62
    v_accvgpr_write_b32 a208, v80
    v_accvgpr_write_b32 a209, v81
    v_accvgpr_write_b32 a210, v82
    v_accvgpr_write_b32 a211, v83
    v_accvgpr_write_b32 a216, v84
    v_accvgpr_write_b32 a217, v85
    v_accvgpr_write_b32 a218, v86
    v_accvgpr_write_b32 a219, v87
    s_add_u32 s56, s58, 262144
    buffer_load_dword v48, v4, s[4:7], s56 offen
    s_add_u32 s56, s58, 270336
    buffer_load_dword v49, v4, s[4:7], s56 offen
    s_add_u32 s56, s58, 278528
    buffer_load_dword v50, v4, s[4:7], s56 offen
    s_add_u32 s56, s58, 286720
    buffer_load_dword v51, v4, s[4:7], s56 offen
    s_add_u32 s56, s58, 294912
    buffer_load_dword v52, v4, s[4:7], s56 offen
    s_add_u32 s56, s58, 303104
    buffer_load_dword v53, v4, s[4:7], s56 offen
    s_add_u32 s56, s58, 311296
    buffer_load_dword v54, v4, s[4:7], s56 offen
    s_add_u32 s56, s58, 319488
    buffer_load_dword v55, v4, s[4:7], s56 offen
    s_waitcnt vmcnt(48)
    v_perm_b32 v80, v57, v56, s61
    v_perm_b32 v81, v59, v58, s61
    v_perm_b32 v82, v61, v60, s61
    v_perm_b32 v83, v63, v62, s61
    v_perm_b32 v84, v57, v56, s62
    v_perm_b32 v85, v59, v58, s62
    v_perm_b32 v86, v61, v60, s62
    v_perm_b32 v87, v63, v62, s62
    v_accvgpr_write_b32 a212, v80
    v_accvgpr_write_b32 a213, v81
    v_accvgpr_write_b32 a214, v82
    v_accvgpr_write_b32 a215, v83
    v_accvgpr_write_b32 a220, v84
    v_accvgpr_write_b32 a221, v85
    v_accvgpr_write_b32 a222, v86
    v_accvgpr_write_b32 a223, v87
    s_add_u32 s56, s58, 524288
    buffer_load_dword v56, v4, s[4:7], s56 offen
    s_add_u32 s56, s58, 532480
    buffer_load_dword v57, v4, s[4:7], s56 offen
    s_add_u32 s56, s58, 540672
    buffer_load_dword v58, v4, s[4:7], s56 offen
    s_add_u32 s56, s58, 548864
    buffer_load_dword v59, v4, s[4:7], s56 offen
    s_add_u32 s56, s58, 557056
    buffer_load_dword v60, v4, s[4:7], s56 offen
    s_add_u32 s56, s58, 565248
    buffer_load_dword v61, v4, s[4:7], s56 offen
    s_add_u32 s56, s58, 573440
    buffer_load_dword v62, v4, s[4:7], s56 offen
    s_add_u32 s56, s58, 581632
    buffer_load_dword v63, v4, s[4:7], s56 offen
    s_waitcnt vmcnt(48)
    v_perm_b32 v80, v65, v64, s61
    v_perm_b32 v81, v67, v66, s61
    v_perm_b32 v82, v69, v68, s61
    v_perm_b32 v83, v71, v70, s61
    v_perm_b32 v84, v65, v64, s62
    v_perm_b32 v85, v67, v66, s62
    v_perm_b32 v86, v69, v68, s62
    v_perm_b32 v87, v71, v70, s62
    v_accvgpr_write_b32 a224, v80
    v_accvgpr_write_b32 a225, v81
    v_accvgpr_write_b32 a226, v82
    v_accvgpr_write_b32 a227, v83
    v_accvgpr_write_b32 a232, v84
    v_accvgpr_write_b32 a233, v85
    v_accvgpr_write_b32 a234, v86
    v_accvgpr_write_b32 a235, v87
    s_add_u32 s56, s58, 786432
    buffer_load_dword v64, v4, s[4:7], s56 offen
    s_add_u32 s56, s58, 794624
    buffer_load_dword v65, v4, s[4:7], s56 offen
    s_add_u32 s56, s58, 802816
    buffer_load_dword v66, v4, s[4:7], s56 offen
    s_add_u32 s56, s58, 811008
    buffer_load_dword v67, v4, s[4:7], s56 offen
    s_add_u32 s56, s58, 819200
    buffer_load_dword v68, v4, s[4:7], s56 offen
    s_add_u32 s56, s58, 827392
    buffer_load_dword v69, v4, s[4:7], s56 offen
    s_add_u32 s56, s58, 835584
    buffer_load_dword v70, v4, s[4:7], s56 offen
    s_add_u32 s56, s58, 843776
    buffer_load_dword v71, v4, s[4:7], s56 offen
    s_waitcnt vmcnt(48)
    v_perm_b32 v80, v73, v72, s61
    v_perm_b32 v81, v75, v74, s61
    v_perm_b32 v82, v77, v76, s61
    v_perm_b32 v83, v79, v78, s61
    v_perm_b32 v84, v73, v72, s62
    v_perm_b32 v85, v75, v74, s62
    v_perm_b32 v86, v77, v76, s62
    v_perm_b32 v87, v79, v78, s62
    v_accvgpr_write_b32 a228, v80
    v_accvgpr_write_b32 a229, v81
    v_accvgpr_write_b32 a230, v82
    v_accvgpr_write_b32 a231, v83
    v_accvgpr_write_b32 a236, v84
    v_accvgpr_write_b32 a237, v85
    v_accvgpr_write_b32 a238, v86
    v_accvgpr_write_b32 a239, v87
    s_add_u32 s56, s58, 1048576
    buffer_load_dword v72, v4, s[4:7], s56 offen
    s_add_u32 s56, s58, 1056768
    buffer_load_dword v73, v4, s[4:7], s56 offen
    s_add_u32 s56, s58, 1064960
    buffer_load_dword v74, v4, s[4:7], s56 offen
    s_add_u32 s56, s58, 1073152
    buffer_load_dword v75, v4, s[4:7], s56 offen
    s_add_u32 s56, s58, 1081344
    buffer_load_dword v76, v4, s[4:7], s56 offen
    s_add_u32 s56, s58, 1089536
    buffer_load_dword v77, v4, s[4:7], s56 offen
    s_add_u32 s56, s58, 1097728
    buffer_load_dword v78, v4, s[4:7], s56 offen
    s_add_u32 s56, s58, 1105920
    buffer_load_dword v79, v4, s[4:7], s56 offen
    s_waitcnt vmcnt(48)
    v_perm_b32 v80, v25, v24, s61
    v_perm_b32 v81, v27, v26, s61
    v_perm_b32 v82, v29, v28, s61
    v_perm_b32 v83, v31, v30, s61
    v_perm_b32 v84, v25, v24, s62
    v_perm_b32 v85, v27, v26, s62
    v_perm_b32 v86, v29, v28, s62
    v_perm_b32 v87, v31, v30, s62
    v_accvgpr_write_b32 a240, v80
    v_accvgpr_write_b32 a241, v81
    v_accvgpr_write_b32 a242, v82
    v_accvgpr_write_b32 a243, v83
    v_accvgpr_write_b32 a248, v84
    v_accvgpr_write_b32 a249, v85
    v_accvgpr_write_b32 a250, v86
    v_accvgpr_write_b32 a251, v87
    s_add_u32 s56, s58, 1310720
    buffer_load_dword v24, v4, s[4:7], s56 offen
    s_add_u32 s56, s58, 1318912
    buffer_load_dword v25, v4, s[4:7], s56 offen
    s_add_u32 s56, s58, 1327104
    buffer_load_dword v26, v4, s[4:7], s56 offen
    s_add_u32 s56, s58, 1335296
    buffer_load_dword v27, v4, s[4:7], s56 offen
    s_add_u32 s56, s58, 1343488
    buffer_load_dword v28, v4, s[4:7], s56 offen
    s_add_u32 s56, s58, 1351680
    buffer_load_dword v29, v4, s[4:7], s56 offen
    s_add_u32 s56, s58, 1359872
    buffer_load_dword v30, v4, s[4:7], s56 offen
    s_add_u32 s56, s58, 1368064
    buffer_load_dword v31, v4, s[4:7], s56 offen
    s_waitcnt vmcnt(48)
    v_perm_b32 v80, v33, v32, s61
    v_perm_b32 v81, v35, v34, s61
    v_perm_b32 v82, v37, v36, s61
    v_perm_b32 v83, v39, v38, s61
    v_perm_b32 v84, v33, v32, s62
    v_perm_b32 v85, v35, v34, s62
    v_perm_b32 v86, v37, v36, s62
    v_perm_b32 v87, v39, v38, s62
    v_accvgpr_write_b32 a244, v80
    v_accvgpr_write_b32 a245, v81
    v_accvgpr_write_b32 a246, v82
    v_accvgpr_write_b32 a247, v83
    v_accvgpr_write_b32 a252, v84
    v_accvgpr_write_b32 a253, v85
    v_accvgpr_write_b32 a254, v86
    v_accvgpr_write_b32 a255, v87
    s_add_u32 s56, s58, 1572864
    buffer_load_dword v32, v4, s[4:7], s56 offen
    s_add_u32 s56, s58, 1581056
    buffer_load_dword v33, v4, s[4:7], s56 offen
    s_add_u32 s56, s58, 1589248
    buffer_load_dword v34, v4, s[4:7], s56 offen
    s_add_u32 s56, s58, 1597440
    buffer_load_dword v35, v4, s[4:7], s56 offen
    s_add_u32 s56, s58, 1605632
    buffer_load_dword v36, v4, s[4:7], s56 offen
    s_add_u32 s56, s58, 1613824
    buffer_load_dword v37, v4, s[4:7], s56 offen
    s_add_u32 s56, s58, 1622016
    buffer_load_dword v38, v4, s[4:7], s56 offen
    s_add_u32 s56, s58, 1630208
    buffer_load_dword v39, v4, s[4:7], s56 offen
    s_waitcnt vmcnt(48)
    v_perm_b32 v128, v41, v40, s61
    v_perm_b32 v129, v43, v42, s61
    v_perm_b32 v130, v45, v44, s61
    v_perm_b32 v131, v47, v46, s61
    v_perm_b32 v136, v41, v40, s62
    v_perm_b32 v137, v43, v42, s62
    v_perm_b32 v138, v45, v44, s62
    v_perm_b32 v139, v47, v46, s62
    s_add_u32 s56, s58, 1835008
    buffer_load_dword v40, v4, s[4:7], s56 offen
    s_add_u32 s56, s58, 1843200
    buffer_load_dword v41, v4, s[4:7], s56 offen
    s_add_u32 s56, s58, 1851392
    buffer_load_dword v42, v4, s[4:7], s56 offen
    s_add_u32 s56, s58, 1859584
    buffer_load_dword v43, v4, s[4:7], s56 offen
    s_add_u32 s56, s58, 1867776
    buffer_load_dword v44, v4, s[4:7], s56 offen
    s_add_u32 s56, s58, 1875968
    buffer_load_dword v45, v4, s[4:7], s56 offen
    s_add_u32 s56, s58, 1884160
    buffer_load_dword v46, v4, s[4:7], s56 offen
    s_add_u32 s56, s58, 1892352
    buffer_load_dword v47, v4, s[4:7], s56 offen
    s_waitcnt vmcnt(48)
    v_perm_b32 v132, v49, v48, s61
    v_perm_b32 v133, v51, v50, s61
    v_perm_b32 v134, v53, v52, s61
    v_perm_b32 v135, v55, v54, s61
    v_perm_b32 v140, v49, v48, s62
    v_perm_b32 v141, v51, v50, s62
    v_perm_b32 v142, v53, v52, s62
    v_perm_b32 v143, v55, v54, s62
    s_add_u32 s56, s58, 2097152
    buffer_load_dword v48, v4, s[4:7], s56 offen
    s_add_u32 s56, s58, 2105344
    buffer_load_dword v49, v4, s[4:7], s56 offen
    s_add_u32 s56, s58, 2113536
    buffer_load_dword v50, v4, s[4:7], s56 offen
    s_add_u32 s56, s58, 2121728
    buffer_load_dword v51, v4, s[4:7], s56 offen
    s_add_u32 s56, s58, 2129920
    buffer_load_dword v52, v4, s[4:7], s56 offen
    s_add_u32 s56, s58, 2138112
    buffer_load_dword v53, v4, s[4:7], s56 offen
    s_add_u32 s56, s58, 2146304
    buffer_load_dword v54, v4, s[4:7], s56 offen
    s_add_u32 s56, s58, 2154496
    buffer_load_dword v55, v4, s[4:7], s56 offen
    s_waitcnt vmcnt(48)
    v_perm_b32 v144, v57, v56, s61
    v_perm_b32 v145, v59, v58, s61
    v_perm_b32 v146, v61, v60, s61
    v_perm_b32 v147, v63, v62, s61
    v_perm_b32 v152, v57, v56, s62
    v_perm_b32 v153, v59, v58, s62
    v_perm_b32 v154, v61, v60, s62
    v_perm_b32 v155, v63, v62, s62
    s_add_u32 s56, s58, 2359296
    buffer_load_dword v56, v4, s[4:7], s56 offen
    s_add_u32 s56, s58, 2367488
    buffer_load_dword v57, v4, s[4:7], s56 offen
    s_add_u32 s56, s58, 2375680
    buffer_load_dword v58, v4, s[4:7], s56 offen
    s_add_u32 s56, s58, 2383872
    buffer_load_dword v59, v4, s[4:7], s56 offen
    s_add_u32 s56, s58, 2392064
    buffer_load_dword v60, v4, s[4:7], s56 offen
    s_add_u32 s56, s58, 2400256
    buffer_load_dword v61, v4, s[4:7], s56 offen
    s_add_u32 s56, s58, 2408448
    buffer_load_dword v62, v4, s[4:7], s56 offen
    s_add_u32 s56, s58, 2416640
    buffer_load_dword v63, v4, s[4:7], s56 offen
    s_waitcnt vmcnt(48)
    v_perm_b32 v148, v65, v64, s61
    v_perm_b32 v149, v67, v66, s61
    v_perm_b32 v150, v69, v68, s61
    v_perm_b32 v151, v71, v70, s61
    v_perm_b32 v156, v65, v64, s62
    v_perm_b32 v157, v67, v66, s62
    v_perm_b32 v158, v69, v68, s62
    v_perm_b32 v159, v71, v70, s62
    s_add_u32 s56, s58, 2621440
    buffer_load_dword v64, v4, s[4:7], s56 offen
    s_add_u32 s56, s58, 2629632
    buffer_load_dword v65, v4, s[4:7], s56 offen
    s_add_u32 s56, s58, 2637824
    buffer_load_dword v66, v4, s[4:7], s56 offen
    s_add_u32 s56, s58, 2646016
    buffer_load_dword v67, v4, s[4:7], s56 offen
    s_add_u32 s56, s58, 2654208
    buffer_load_dword v68, v4, s[4:7], s56 offen
    s_add_u32 s56, s58, 2662400
    buffer_load_dword v69, v4, s[4:7], s56 offen
    s_add_u32 s56, s58, 2670592
    buffer_load_dword v70, v4, s[4:7], s56 offen
    s_add_u32 s56, s58, 2678784
    buffer_load_dword v71, v4, s[4:7], s56 offen
    s_waitcnt vmcnt(48)
    v_perm_b32 v160, v73, v72, s61
    v_perm_b32 v161, v75, v74, s61
    v_perm_b32 v162, v77, v76, s61
    v_perm_b32 v163, v79, v78, s61
    v_perm_b32 v168, v73, v72, s62
    v_perm_b32 v169, v75, v74, s62
    v_perm_b32 v170, v77, v76, s62
    v_perm_b32 v171, v79, v78, s62
    s_add_u32 s56, s58, 2883584
    buffer_load_dword v72, v4, s[4:7], s56 offen
    s_add_u32 s56, s58, 2891776
    buffer_load_dword v73, v4, s[4:7], s56 offen
    s_add_u32 s56, s58, 2899968
    buffer_load_dword v74, v4, s[4:7], s56 offen
    s_add_u32 s56, s58, 2908160
    buffer_load_dword v75, v4, s[4:7], s56 offen
    s_add_u32 s56, s58, 2916352
    buffer_load_dword v76, v4, s[4:7], s56 offen
    s_add_u32 s56, s58, 2924544
    buffer_load_dword v77, v4, s[4:7], s56 offen
    s_add_u32 s56, s58, 2932736
    buffer_load_dword v78, v4, s[4:7], s56 offen
    s_add_u32 s56, s58, 2940928
    buffer_load_dword v79, v4, s[4:7], s56 offen
    s_waitcnt vmcnt(48)
    v_perm_b32 v164, v25, v24, s61
    v_perm_b32 v165, v27, v26, s61
    v_perm_b32 v166, v29, v28, s61
    v_perm_b32 v167, v31, v30, s61
    v_perm_b32 v172, v25, v24, s62
    v_perm_b32 v173, v27, v26, s62
    v_perm_b32 v174, v29, v28, s62
    v_perm_b32 v175, v31, v30, s62
    s_add_u32 s56, s58, 3145728
    buffer_load_dword v24, v4, s[4:7], s56 offen
    s_add_u32 s56, s58, 3153920
    buffer_load_dword v25, v4, s[4:7], s56 offen
    s_add_u32 s56, s58, 3162112
    buffer_load_dword v26, v4, s[4:7], s56 offen
    s_add_u32 s56, s58, 3170304
    buffer_load_dword v27, v4, s[4:7], s56 offen
    s_add_u32 s56, s58, 3178496
    buffer_load_dword v28, v4, s[4:7], s56 offen
    s_add_u32 s56, s58, 3186688
    buffer_load_dword v29, v4, s[4:7], s56 offen
    s_add_u32 s56, s58, 3194880
    buffer_load_dword v30, v4, s[4:7], s56 offen
    s_add_u32 s56, s58, 3203072
    buffer_load_dword v31, v4, s[4:7], s56 offen
    s_waitcnt vmcnt(48)
    v_perm_b32 v176, v33, v32, s61
    v_perm_b32 v177, v35, v34, s61
    v_perm_b32 v178, v37, v36, s61
    v_perm_b32 v179, v39, v38, s61
    v_perm_b32 v184, v33, v32, s62
    v_perm_b32 v185, v35, v34, s62
    v_perm_b32 v186, v37, v36, s62
    v_perm_b32 v187, v39, v38, s62
    s_add_u32 s56, s58, 3407872
    buffer_load_dword v32, v4, s[4:7], s56 offen
    s_add_u32 s56, s58, 3416064
    buffer_load_dword v33, v4, s[4:7], s56 offen
    s_add_u32 s56, s58, 3424256
    buffer_load_dword v34, v4, s[4:7], s56 offen
    s_add_u32 s56, s58, 3432448
    buffer_load_dword v35, v4, s[4:7], s56 offen
    s_add_u32 s56, s58, 3440640
    buffer_load_dword v36, v4, s[4:7], s56 offen
    s_add_u32 s56, s58, 3448832
    buffer_load_dword v37, v4, s[4:7], s56 offen
    s_add_u32 s56, s58, 3457024
    buffer_load_dword v38, v4, s[4:7], s56 offen
    s_add_u32 s56, s58, 3465216
    buffer_load_dword v39, v4, s[4:7], s56 offen
    s_waitcnt vmcnt(48)
    v_perm_b32 v180, v41, v40, s61
    v_perm_b32 v181, v43, v42, s61
    v_perm_b32 v182, v45, v44, s61
    v_perm_b32 v183, v47, v46, s61
    v_perm_b32 v188, v41, v40, s62
    v_perm_b32 v189, v43, v42, s62
    v_perm_b32 v190, v45, v44, s62
    v_perm_b32 v191, v47, v46, s62
    s_add_u32 s56, s58, 3670016
    buffer_load_dword v40, v4, s[4:7], s56 offen
    s_add_u32 s56, s58, 3678208
    buffer_load_dword v41, v4, s[4:7], s56 offen
    s_add_u32 s56, s58, 3686400
    buffer_load_dword v42, v4, s[4:7], s56 offen
    s_add_u32 s56, s58, 3694592
    buffer_load_dword v43, v4, s[4:7], s56 offen
    s_add_u32 s56, s58, 3702784
    buffer_load_dword v44, v4, s[4:7], s56 offen
    s_add_u32 s56, s58, 3710976
    buffer_load_dword v45, v4, s[4:7], s56 offen
    s_add_u32 s56, s58, 3719168
    buffer_load_dword v46, v4, s[4:7], s56 offen
    s_add_u32 s56, s58, 3727360
    buffer_load_dword v47, v4, s[4:7], s56 offen
    s_waitcnt vmcnt(48)
    v_perm_b32 v192, v49, v48, s61
    v_perm_b32 v193, v51, v50, s61
    v_perm_b32 v194, v53, v52, s61
    v_perm_b32 v195, v55, v54, s61
    v_perm_b32 v200, v49, v48, s62
    v_perm_b32 v201, v51, v50, s62
    v_perm_b32 v202, v53, v52, s62
    v_perm_b32 v203, v55, v54, s62
    s_add_u32 s56, s58, 3932160
    buffer_load_dword v48, v4, s[4:7], s56 offen
    s_add_u32 s56, s58, 3940352
    buffer_load_dword v49, v4, s[4:7], s56 offen
    s_add_u32 s56, s58, 3948544
    buffer_load_dword v50, v4, s[4:7], s56 offen
    s_add_u32 s56, s58, 3956736
    buffer_load_dword v51, v4, s[4:7], s56 offen
    s_add_u32 s56, s58, 3964928
    buffer_load_dword v52, v4, s[4:7], s56 offen
    s_add_u32 s56, s58, 3973120
    buffer_load_dword v53, v4, s[4:7], s56 offen
    s_add_u32 s56, s58, 3981312
    buffer_load_dword v54, v4, s[4:7], s56 offen
    s_add_u32 s56, s58, 3989504
    buffer_load_dword v55, v4, s[4:7], s56 offen
    s_waitcnt vmcnt(48)
    v_perm_b32 v196, v57, v56, s61
    v_perm_b32 v197, v59, v58, s61
    v_perm_b32 v198, v61, v60, s61
    v_perm_b32 v199, v63, v62, s61
    v_perm_b32 v204, v57, v56, s62
    v_perm_b32 v205, v59, v58, s62
    v_perm_b32 v206, v61, v60, s62
    v_perm_b32 v207, v63, v62, s62
    s_mov_b32 s4, s20
    s_mov_b32 s5, s21
    s_mov_b32 s6, 4194304
    s_mov_b32 s7, 0x20000
    s_add_u32 s56, s58, 0
    buffer_load_dword v56, v4, s[4:7], s56 offen
    s_add_u32 s56, s58, 8192
    buffer_load_dword v57, v4, s[4:7], s56 offen
    s_add_u32 s56, s58, 16384
    buffer_load_dword v58, v4, s[4:7], s56 offen
    s_add_u32 s56, s58, 24576
    buffer_load_dword v59, v4, s[4:7], s56 offen
    s_add_u32 s56, s58, 32768
    buffer_load_dword v60, v4, s[4:7], s56 offen
    s_add_u32 s56, s58, 40960
    buffer_load_dword v61, v4, s[4:7], s56 offen
    s_add_u32 s56, s58, 49152
    buffer_load_dword v62, v4, s[4:7], s56 offen
    s_add_u32 s56, s58, 57344
    buffer_load_dword v63, v4, s[4:7], s56 offen
    s_waitcnt vmcnt(48)
    v_perm_b32 v208, v65, v64, s61
    v_perm_b32 v209, v67, v66, s61
    v_perm_b32 v210, v69, v68, s61
    v_perm_b32 v211, v71, v70, s61
    v_perm_b32 v216, v65, v64, s62
    v_perm_b32 v217, v67, v66, s62
    v_perm_b32 v218, v69, v68, s62
    v_perm_b32 v219, v71, v70, s62
    s_add_u32 s56, s58, 262144
    buffer_load_dword v64, v4, s[4:7], s56 offen
    s_add_u32 s56, s58, 270336
    buffer_load_dword v65, v4, s[4:7], s56 offen
    s_add_u32 s56, s58, 278528
    buffer_load_dword v66, v4, s[4:7], s56 offen
    s_add_u32 s56, s58, 286720
    buffer_load_dword v67, v4, s[4:7], s56 offen
    s_add_u32 s56, s58, 294912
    buffer_load_dword v68, v4, s[4:7], s56 offen
    s_add_u32 s56, s58, 303104
    buffer_load_dword v69, v4, s[4:7], s56 offen
    s_add_u32 s56, s58, 311296
    buffer_load_dword v70, v4, s[4:7], s56 offen
    s_add_u32 s56, s58, 319488
    buffer_load_dword v71, v4, s[4:7], s56 offen
    s_waitcnt vmcnt(48)
    v_perm_b32 v212, v73, v72, s61
    v_perm_b32 v213, v75, v74, s61
    v_perm_b32 v214, v77, v76, s61
    v_perm_b32 v215, v79, v78, s61
    v_perm_b32 v220, v73, v72, s62
    v_perm_b32 v221, v75, v74, s62
    v_perm_b32 v222, v77, v76, s62
    v_perm_b32 v223, v79, v78, s62
    s_add_u32 s56, s58, 524288
    buffer_load_dword v72, v4, s[4:7], s56 offen
    s_add_u32 s56, s58, 532480
    buffer_load_dword v73, v4, s[4:7], s56 offen
    s_add_u32 s56, s58, 540672
    buffer_load_dword v74, v4, s[4:7], s56 offen
    s_add_u32 s56, s58, 548864
    buffer_load_dword v75, v4, s[4:7], s56 offen
    s_add_u32 s56, s58, 557056
    buffer_load_dword v76, v4, s[4:7], s56 offen
    s_add_u32 s56, s58, 565248
    buffer_load_dword v77, v4, s[4:7], s56 offen
    s_add_u32 s56, s58, 573440
    buffer_load_dword v78, v4, s[4:7], s56 offen
    s_add_u32 s56, s58, 581632
    buffer_load_dword v79, v4, s[4:7], s56 offen
    s_waitcnt vmcnt(48)
    v_perm_b32 v224, v25, v24, s61
    v_perm_b32 v225, v27, v26, s61
    v_perm_b32 v226, v29, v28, s61
    v_perm_b32 v227, v31, v30, s61
    v_perm_b32 v232, v25, v24, s62
    v_perm_b32 v233, v27, v26, s62
    v_perm_b32 v234, v29, v28, s62
    v_perm_b32 v235, v31, v30, s62
    s_add_u32 s56, s58, 786432
    buffer_load_dword v24, v4, s[4:7], s56 offen
    s_add_u32 s56, s58, 794624
    buffer_load_dword v25, v4, s[4:7], s56 offen
    s_add_u32 s56, s58, 802816
    buffer_load_dword v26, v4, s[4:7], s56 offen
    s_add_u32 s56, s58, 811008
    buffer_load_dword v27, v4, s[4:7], s56 offen
    s_add_u32 s56, s58, 819200
    buffer_load_dword v28, v4, s[4:7], s56 offen
    s_add_u32 s56, s58, 827392
    buffer_load_dword v29, v4, s[4:7], s56 offen
    s_add_u32 s56, s58, 835584
    buffer_load_dword v30, v4, s[4:7], s56 offen
    s_add_u32 s56, s58, 843776
    buffer_load_dword v31, v4, s[4:7], s56 offen
    s_waitcnt vmcnt(48)
    v_perm_b32 v228, v33, v32, s61
    v_perm_b32 v229, v35, v34, s61
    v_perm_b32 v230, v37, v36, s61
    v_perm_b32 v231, v39, v38, s61
    v_perm_b32 v236, v33, v32, s62
    v_perm_b32 v237, v35, v34, s62
    v_perm_b32 v238, v37, v36, s62
    v_perm_b32 v239, v39, v38, s62
    s_add_u32 s56, s58, 1048576
    buffer_load_dword v32, v4, s[4:7], s56 offen
    s_add_u32 s56, s58, 1056768
    buffer_load_dword v33, v4, s[4:7], s56 offen
    s_add_u32 s56, s58, 1064960
    buffer_load_dword v34, v4, s[4:7], s56 offen
    s_add_u32 s56, s58, 1073152
    buffer_load_dword v35, v4, s[4:7], s56 offen
    s_add_u32 s56, s58, 1081344
    buffer_load_dword v36, v4, s[4:7], s56 offen
    s_add_u32 s56, s58, 1089536
    buffer_load_dword v37, v4, s[4:7], s56 offen
    s_add_u32 s56, s58, 1097728
    buffer_load_dword v38, v4, s[4:7], s56 offen
    s_add_u32 s56, s58, 1105920
    buffer_load_dword v39, v4, s[4:7], s56 offen
    s_waitcnt vmcnt(48)
    v_perm_b32 v240, v41, v40, s61
    v_perm_b32 v241, v43, v42, s61
    v_perm_b32 v242, v45, v44, s61
    v_perm_b32 v243, v47, v46, s61
    v_perm_b32 v248, v41, v40, s62
    v_perm_b32 v249, v43, v42, s62
    v_perm_b32 v250, v45, v44, s62
    v_perm_b32 v251, v47, v46, s62
    s_add_u32 s56, s58, 1310720
    buffer_load_dword v40, v4, s[4:7], s56 offen
    s_add_u32 s56, s58, 1318912
    buffer_load_dword v41, v4, s[4:7], s56 offen
    s_add_u32 s56, s58, 1327104
    buffer_load_dword v42, v4, s[4:7], s56 offen
    s_add_u32 s56, s58, 1335296
    buffer_load_dword v43, v4, s[4:7], s56 offen
    s_add_u32 s56, s58, 1343488
    buffer_load_dword v44, v4, s[4:7], s56 offen
    s_add_u32 s56, s58, 1351680
    buffer_load_dword v45, v4, s[4:7], s56 offen
    s_add_u32 s56, s58, 1359872
    buffer_load_dword v46, v4, s[4:7], s56 offen
    s_add_u32 s56, s58, 1368064
    buffer_load_dword v47, v4, s[4:7], s56 offen
    s_waitcnt vmcnt(48)
    v_perm_b32 v244, v49, v48, s61
    v_perm_b32 v245, v51, v50, s61
    v_perm_b32 v246, v53, v52, s61
    v_perm_b32 v247, v55, v54, s61
    v_perm_b32 v252, v49, v48, s62
    v_perm_b32 v253, v51, v50, s62
    v_perm_b32 v254, v53, v52, s62
    v_perm_b32 v255, v55, v54, s62
    s_add_u32 s56, s58, 1572864
    buffer_load_dword v48, v4, s[4:7], s56 offen
    s_add_u32 s56, s58, 1581056
    buffer_load_dword v49, v4, s[4:7], s56 offen
    s_add_u32 s56, s58, 1589248
    buffer_load_dword v50, v4, s[4:7], s56 offen
    s_add_u32 s56, s58, 1597440
    buffer_load_dword v51, v4, s[4:7], s56 offen
    s_add_u32 s56, s58, 1605632
    buffer_load_dword v52, v4, s[4:7], s56 offen
    s_add_u32 s56, s58, 1613824
    buffer_load_dword v53, v4, s[4:7], s56 offen
    s_add_u32 s56, s58, 1622016
    buffer_load_dword v54, v4, s[4:7], s56 offen
    s_add_u32 s56, s58, 1630208
    buffer_load_dword v55, v4, s[4:7], s56 offen
    s_waitcnt vmcnt(48)
    v_perm_b32 v80, v57, v56, s61
    v_perm_b32 v81, v59, v58, s61
    v_perm_b32 v82, v61, v60, s61
    v_perm_b32 v83, v63, v62, s61
    v_perm_b32 v84, v57, v56, s62
    v_perm_b32 v85, v59, v58, s62
    v_perm_b32 v86, v61, v60, s62
    v_perm_b32 v87, v63, v62, s62
    v_accvgpr_write_b32 a0, v80
    v_accvgpr_write_b32 a1, v81
    v_accvgpr_write_b32 a2, v82
    v_accvgpr_write_b32 a3, v83
    v_accvgpr_write_b32 a8, v84
    v_accvgpr_write_b32 a9, v85
    v_accvgpr_write_b32 a10, v86
    v_accvgpr_write_b32 a11, v87
    s_add_u32 s56, s58, 1835008
    buffer_load_dword v56, v4, s[4:7], s56 offen
    s_add_u32 s56, s58, 1843200
    buffer_load_dword v57, v4, s[4:7], s56 offen
    s_add_u32 s56, s58, 1851392
    buffer_load_dword v58, v4, s[4:7], s56 offen
    s_add_u32 s56, s58, 1859584
    buffer_load_dword v59, v4, s[4:7], s56 offen
    s_add_u32 s56, s58, 1867776
    buffer_load_dword v60, v4, s[4:7], s56 offen
    s_add_u32 s56, s58, 1875968
    buffer_load_dword v61, v4, s[4:7], s56 offen
    s_add_u32 s56, s58, 1884160
    buffer_load_dword v62, v4, s[4:7], s56 offen
    s_add_u32 s56, s58, 1892352
    buffer_load_dword v63, v4, s[4:7], s56 offen
    s_waitcnt vmcnt(48)
    v_perm_b32 v80, v65, v64, s61
    v_perm_b32 v81, v67, v66, s61
    v_perm_b32 v82, v69, v68, s61
    v_perm_b32 v83, v71, v70, s61
    v_perm_b32 v84, v65, v64, s62
    v_perm_b32 v85, v67, v66, s62
    v_perm_b32 v86, v69, v68, s62
    v_perm_b32 v87, v71, v70, s62
    v_accvgpr_write_b32 a4, v80
    v_accvgpr_write_b32 a5, v81
    v_accvgpr_write_b32 a6, v82
    v_accvgpr_write_b32 a7, v83
    v_accvgpr_write_b32 a12, v84
    v_accvgpr_write_b32 a13, v85
    v_accvgpr_write_b32 a14, v86
    v_accvgpr_write_b32 a15, v87
    s_add_u32 s56, s58, 2097152
    buffer_load_dword v64, v4, s[4:7], s56 offen
    s_add_u32 s56, s58, 2105344
    buffer_load_dword v65, v4, s[4:7], s56 offen
    s_add_u32 s56, s58, 2113536
    buffer_load_dword v66, v4, s[4:7], s56 offen
    s_add_u32 s56, s58, 2121728
    buffer_load_dword v67, v4, s[4:7], s56 offen
    s_add_u32 s56, s58, 2129920
    buffer_load_dword v68, v4, s[4:7], s56 offen
    s_add_u32 s56, s58, 2138112
    buffer_load_dword v69, v4, s[4:7], s56 offen
    s_add_u32 s56, s58, 2146304
    buffer_load_dword v70, v4, s[4:7], s56 offen
    s_add_u32 s56, s58, 2154496
    buffer_load_dword v71, v4, s[4:7], s56 offen
    s_waitcnt vmcnt(48)
    v_perm_b32 v80, v73, v72, s61
    v_perm_b32 v81, v75, v74, s61
    v_perm_b32 v82, v77, v76, s61
    v_perm_b32 v83, v79, v78, s61
    v_perm_b32 v84, v73, v72, s62
    v_perm_b32 v85, v75, v74, s62
    v_perm_b32 v86, v77, v76, s62
    v_perm_b32 v87, v79, v78, s62
    v_accvgpr_write_b32 a16, v80
    v_accvgpr_write_b32 a17, v81
    v_accvgpr_write_b32 a18, v82
    v_accvgpr_write_b32 a19, v83
    v_accvgpr_write_b32 a24, v84
    v_accvgpr_write_b32 a25, v85
    v_accvgpr_write_b32 a26, v86
    v_accvgpr_write_b32 a27, v87
    s_add_u32 s56, s58, 2359296
    buffer_load_dword v72, v4, s[4:7], s56 offen
    s_add_u32 s56, s58, 2367488
    buffer_load_dword v73, v4, s[4:7], s56 offen
    s_add_u32 s56, s58, 2375680
    buffer_load_dword v74, v4, s[4:7], s56 offen
    s_add_u32 s56, s58, 2383872
    buffer_load_dword v75, v4, s[4:7], s56 offen
    s_add_u32 s56, s58, 2392064
    buffer_load_dword v76, v4, s[4:7], s56 offen
    s_add_u32 s56, s58, 2400256
    buffer_load_dword v77, v4, s[4:7], s56 offen
    s_add_u32 s56, s58, 2408448
    buffer_load_dword v78, v4, s[4:7], s56 offen
    s_add_u32 s56, s58, 2416640
    buffer_load_dword v79, v4, s[4:7], s56 offen
    s_waitcnt vmcnt(48)
    v_perm_b32 v80, v25, v24, s61
    v_perm_b32 v81, v27, v26, s61
    v_perm_b32 v82, v29, v28, s61
    v_perm_b32 v83, v31, v30, s61
    v_perm_b32 v84, v25, v24, s62
    v_perm_b32 v85, v27, v26, s62
    v_perm_b32 v86, v29, v28, s62
    v_perm_b32 v87, v31, v30, s62
    v_accvgpr_write_b32 a20, v80
    v_accvgpr_write_b32 a21, v81
    v_accvgpr_write_b32 a22, v82
    v_accvgpr_write_b32 a23, v83
    v_accvgpr_write_b32 a28, v84
    v_accvgpr_write_b32 a29, v85
    v_accvgpr_write_b32 a30, v86
    v_accvgpr_write_b32 a31, v87
    s_add_u32 s56, s58, 2621440
    buffer_load_dword v24, v4, s[4:7], s56 offen
    s_add_u32 s56, s58, 2629632
    buffer_load_dword v25, v4, s[4:7], s56 offen
    s_add_u32 s56, s58, 2637824
    buffer_load_dword v26, v4, s[4:7], s56 offen
    s_add_u32 s56, s58, 2646016
    buffer_load_dword v27, v4, s[4:7], s56 offen
    s_add_u32 s56, s58, 2654208
    buffer_load_dword v28, v4, s[4:7], s56 offen
    s_add_u32 s56, s58, 2662400
    buffer_load_dword v29, v4, s[4:7], s56 offen
    s_add_u32 s56, s58, 2670592
    buffer_load_dword v30, v4, s[4:7], s56 offen
    s_add_u32 s56, s58, 2678784
    buffer_load_dword v31, v4, s[4:7], s56 offen
    s_waitcnt vmcnt(48)
    v_perm_b32 v80, v33, v32, s61
    v_perm_b32 v81, v35, v34, s61
    v_perm_b32 v82, v37, v36, s61
    v_perm_b32 v83, v39, v38, s61
    v_perm_b32 v84, v33, v32, s62
    v_perm_b32 v85, v35, v34, s62
    v_perm_b32 v86, v37, v36, s62
    v_perm_b32 v87, v39, v38, s62
    v_accvgpr_write_b32 a32, v80
    v_accvgpr_write_b32 a33, v81
    v_accvgpr_write_b32 a34, v82
    v_accvgpr_write_b32 a35, v83
    v_accvgpr_write_b32 a40, v84
    v_accvgpr_write_b32 a41, v85
    v_accvgpr_write_b32 a42, v86
    v_accvgpr_write_b32 a43, v87
    s_add_u32 s56, s58, 2883584
    buffer_load_dword v32, v4, s[4:7], s56 offen
    s_add_u32 s56, s58, 2891776
    buffer_load_dword v33, v4, s[4:7], s56 offen
    s_add_u32 s56, s58, 2899968
    buffer_load_dword v34, v4, s[4:7], s56 offen
    s_add_u32 s56, s58, 2908160
    buffer_load_dword v35, v4, s[4:7], s56 offen
    s_add_u32 s56, s58, 2916352
    buffer_load_dword v36, v4, s[4:7], s56 offen
    s_add_u32 s56, s58, 2924544
    buffer_load_dword v37, v4, s[4:7], s56 offen
    s_add_u32 s56, s58, 2932736
    buffer_load_dword v38, v4, s[4:7], s56 offen
    s_add_u32 s56, s58, 2940928
    buffer_load_dword v39, v4, s[4:7], s56 offen
    s_waitcnt vmcnt(48)
    v_perm_b32 v80, v41, v40, s61
    v_perm_b32 v81, v43, v42, s61
    v_perm_b32 v82, v45, v44, s61
    v_perm_b32 v83, v47, v46, s61
    v_perm_b32 v84, v41, v40, s62
    v_perm_b32 v85, v43, v42, s62
    v_perm_b32 v86, v45, v44, s62
    v_perm_b32 v87, v47, v46, s62
    v_accvgpr_write_b32 a36, v80
    v_accvgpr_write_b32 a37, v81
    v_accvgpr_write_b32 a38, v82
    v_accvgpr_write_b32 a39, v83
    v_accvgpr_write_b32 a44, v84
    v_accvgpr_write_b32 a45, v85
    v_accvgpr_write_b32 a46, v86
    v_accvgpr_write_b32 a47, v87
    s_add_u32 s56, s58, 3145728
    buffer_load_dword v40, v4, s[4:7], s56 offen
    s_add_u32 s56, s58, 3153920
    buffer_load_dword v41, v4, s[4:7], s56 offen
    s_add_u32 s56, s58, 3162112
    buffer_load_dword v42, v4, s[4:7], s56 offen
    s_add_u32 s56, s58, 3170304
    buffer_load_dword v43, v4, s[4:7], s56 offen
    s_add_u32 s56, s58, 3178496
    buffer_load_dword v44, v4, s[4:7], s56 offen
    s_add_u32 s56, s58, 3186688
    buffer_load_dword v45, v4, s[4:7], s56 offen
    s_add_u32 s56, s58, 3194880
    buffer_load_dword v46, v4, s[4:7], s56 offen
    s_add_u32 s56, s58, 3203072
    buffer_load_dword v47, v4, s[4:7], s56 offen
    s_waitcnt vmcnt(48)
    v_perm_b32 v80, v49, v48, s61
    v_perm_b32 v81, v51, v50, s61
    v_perm_b32 v82, v53, v52, s61
    v_perm_b32 v83, v55, v54, s61
    v_perm_b32 v84, v49, v48, s62
    v_perm_b32 v85, v51, v50, s62
    v_perm_b32 v86, v53, v52, s62
    v_perm_b32 v87, v55, v54, s62
    v_accvgpr_write_b32 a48, v80
    v_accvgpr_write_b32 a49, v81
    v_accvgpr_write_b32 a50, v82
    v_accvgpr_write_b32 a51, v83
    v_accvgpr_write_b32 a56, v84
    v_accvgpr_write_b32 a57, v85
    v_accvgpr_write_b32 a58, v86
    v_accvgpr_write_b32 a59, v87
    s_add_u32 s56, s58, 3407872
    buffer_load_dword v48, v4, s[4:7], s56 offen
    s_add_u32 s56, s58, 3416064
    buffer_load_dword v49, v4, s[4:7], s56 offen
    s_add_u32 s56, s58, 3424256
    buffer_load_dword v50, v4, s[4:7], s56 offen
    s_add_u32 s56, s58, 3432448
    buffer_load_dword v51, v4, s[4:7], s56 offen
    s_add_u32 s56, s58, 3440640
    buffer_load_dword v52, v4, s[4:7], s56 offen
    s_add_u32 s56, s58, 3448832
    buffer_load_dword v53, v4, s[4:7], s56 offen
    s_add_u32 s56, s58, 3457024
    buffer_load_dword v54, v4, s[4:7], s56 offen
    s_add_u32 s56, s58, 3465216
    buffer_load_dword v55, v4, s[4:7], s56 offen
    s_waitcnt vmcnt(48)
    v_perm_b32 v80, v57, v56, s61
    v_perm_b32 v81, v59, v58, s61
    v_perm_b32 v82, v61, v60, s61
    v_perm_b32 v83, v63, v62, s61
    v_perm_b32 v84, v57, v56, s62
    v_perm_b32 v85, v59, v58, s62
    v_perm_b32 v86, v61, v60, s62
    v_perm_b32 v87, v63, v62, s62
    v_accvgpr_write_b32 a52, v80
    v_accvgpr_write_b32 a53, v81
    v_accvgpr_write_b32 a54, v82
    v_accvgpr_write_b32 a55, v83
    v_accvgpr_write_b32 a60, v84
    v_accvgpr_write_b32 a61, v85
    v_accvgpr_write_b32 a62, v86
    v_accvgpr_write_b32 a63, v87
    s_add_u32 s56, s58, 3670016
    buffer_load_dword v56, v4, s[4:7], s56 offen
    s_add_u32 s56, s58, 3678208
    buffer_load_dword v57, v4, s[4:7], s56 offen
    s_add_u32 s56, s58, 3686400
    buffer_load_dword v58, v4, s[4:7], s56 offen
    s_add_u32 s56, s58, 3694592
    buffer_load_dword v59, v4, s[4:7], s56 offen
    s_add_u32 s56, s58, 3702784
    buffer_load_dword v60, v4, s[4:7], s56 offen
    s_add_u32 s56, s58, 3710976
    buffer_load_dword v61, v4, s[4:7], s56 offen
    s_add_u32 s56, s58, 3719168
    buffer_load_dword v62, v4, s[4:7], s56 offen
    s_add_u32 s56, s58, 3727360
    buffer_load_dword v63, v4, s[4:7], s56 offen
    s_waitcnt vmcnt(48)
    v_perm_b32 v80, v65, v64, s61
    v_perm_b32 v81, v67, v66, s61
    v_perm_b32 v82, v69, v68, s61
    v_perm_b32 v83, v71, v70, s61
    v_perm_b32 v84, v65, v64, s62
    v_perm_b32 v85, v67, v66, s62
    v_perm_b32 v86, v69, v68, s62
    v_perm_b32 v87, v71, v70, s62
    v_accvgpr_write_b32 a64, v80
    v_accvgpr_write_b32 a65, v81
    v_accvgpr_write_b32 a66, v82
    v_accvgpr_write_b32 a67, v83
    v_accvgpr_write_b32 a72, v84
    v_accvgpr_write_b32 a73, v85
    v_accvgpr_write_b32 a74, v86
    v_accvgpr_write_b32 a75, v87
    s_add_u32 s56, s58, 3932160
    buffer_load_dword v64, v4, s[4:7], s56 offen
    s_add_u32 s56, s58, 3940352
    buffer_load_dword v65, v4, s[4:7], s56 offen
    s_add_u32 s56, s58, 3948544
    buffer_load_dword v66, v4, s[4:7], s56 offen
    s_add_u32 s56, s58, 3956736
    buffer_load_dword v67, v4, s[4:7], s56 offen
    s_add_u32 s56, s58, 3964928
    buffer_load_dword v68, v4, s[4:7], s56 offen
    s_add_u32 s56, s58, 3973120
    buffer_load_dword v69, v4, s[4:7], s56 offen
    s_add_u32 s56, s58, 3981312
    buffer_load_dword v70, v4, s[4:7], s56 offen
    s_add_u32 s56, s58, 3989504
    buffer_load_dword v71, v4, s[4:7], s56 offen
    s_waitcnt vmcnt(48)
    v_perm_b32 v80, v73, v72, s61
    v_perm_b32 v81, v75, v74, s61
    v_perm_b32 v82, v77, v76, s61
    v_perm_b32 v83, v79, v78, s61
    v_perm_b32 v84, v73, v72, s62
    v_perm_b32 v85, v75, v74, s62
    v_perm_b32 v86, v77, v76, s62
    v_perm_b32 v87, v79, v78, s62
    v_accvgpr_write_b32 a68, v80
    v_accvgpr_write_b32 a69, v81
    v_accvgpr_write_b32 a70, v82
    v_accvgpr_write_b32 a71, v83
    v_accvgpr_write_b32 a76, v84
    v_accvgpr_write_b32 a77, v85
    v_accvgpr_write_b32 a78, v86
    v_accvgpr_write_b32 a79, v87
    s_mov_b32 s4, s26
    s_mov_b32 s5, s27
    s_mov_b32 s6, 4194304
    s_mov_b32 s7, 0x20000
    s_add_u32 s56, s59, 0
    buffer_load_dword v72, v5, s[4:7], s56 offen offset:0
    buffer_load_dword v73, v5, s[4:7], s56 offen offset:1024
    buffer_load_dword v74, v5, s[4:7], s56 offen offset:2048
    buffer_load_dword v75, v5, s[4:7], s56 offen offset:3072
    s_add_u32 s56, s59, 4096
    buffer_load_dword v76, v5, s[4:7], s56 offen offset:0
    buffer_load_dword v77, v5, s[4:7], s56 offen offset:1024
    buffer_load_dword v78, v5, s[4:7], s56 offen offset:2048
    buffer_load_dword v79, v5, s[4:7], s56 offen offset:3072
    s_waitcnt vmcnt(48)
    v_perm_b32 v80, v25, v24, s61
    v_perm_b32 v81, v27, v26, s61
    v_perm_b32 v82, v29, v28, s61
    v_perm_b32 v83, v31, v30, s61
    v_perm_b32 v84, v25, v24, s62
    v_perm_b32 v85, v27, v26, s62
    v_perm_b32 v86, v29, v28, s62
    v_perm_b32 v87, v31, v30, s62
    v_accvgpr_write_b32 a80, v80
    v_accvgpr_write_b32 a81, v81
    v_accvgpr_write_b32 a82, v82
    v_accvgpr_write_b32 a83, v83
    v_accvgpr_write_b32 a88, v84
    v_accvgpr_write_b32 a89, v85
    v_accvgpr_write_b32 a90, v86
    v_accvgpr_write_b32 a91, v87
    s_add_u32 s56, s59, 32768
    buffer_load_dword v24, v5, s[4:7], s56 offen offset:0
    buffer_load_dword v25, v5, s[4:7], s56 offen offset:1024
    buffer_load_dword v26, v5, s[4:7], s56 offen offset:2048
    buffer_load_dword v27, v5, s[4:7], s56 offen offset:3072
    s_add_u32 s56, s59, 36864
    buffer_load_dword v28, v5, s[4:7], s56 offen offset:0
    buffer_load_dword v29, v5, s[4:7], s56 offen offset:1024
    buffer_load_dword v30, v5, s[4:7], s56 offen offset:2048
    buffer_load_dword v31, v5, s[4:7], s56 offen offset:3072
    s_waitcnt vmcnt(48)
    v_perm_b32 v80, v33, v32, s61
    v_perm_b32 v81, v35, v34, s61
    v_perm_b32 v82, v37, v36, s61
    v_perm_b32 v83, v39, v38, s61
    v_perm_b32 v84, v33, v32, s62
    v_perm_b32 v85, v35, v34, s62
    v_perm_b32 v86, v37, v36, s62
    v_perm_b32 v87, v39, v38, s62
    v_accvgpr_write_b32 a84, v80
    v_accvgpr_write_b32 a85, v81
    v_accvgpr_write_b32 a86, v82
    v_accvgpr_write_b32 a87, v83
    v_accvgpr_write_b32 a92, v84
    v_accvgpr_write_b32 a93, v85
    v_accvgpr_write_b32 a94, v86
    v_accvgpr_write_b32 a95, v87
    s_add_u32 s56, s59, 65536
    buffer_load_dword v32, v5, s[4:7], s56 offen offset:0
    buffer_load_dword v33, v5, s[4:7], s56 offen offset:1024
    buffer_load_dword v34, v5, s[4:7], s56 offen offset:2048
    buffer_load_dword v35, v5, s[4:7], s56 offen offset:3072
    s_add_u32 s56, s59, 69632
    buffer_load_dword v36, v5, s[4:7], s56 offen offset:0
    buffer_load_dword v37, v5, s[4:7], s56 offen offset:1024
    buffer_load_dword v38, v5, s[4:7], s56 offen offset:2048
    buffer_load_dword v39, v5, s[4:7], s56 offen offset:3072
    s_waitcnt vmcnt(48)
    v_perm_b32 v80, v41, v40, s61
    v_perm_b32 v81, v43, v42, s61
    v_perm_b32 v82, v45, v44, s61
    v_perm_b32 v83, v47, v46, s61
    v_perm_b32 v84, v41, v40, s62
    v_perm_b32 v85, v43, v42, s62
    v_perm_b32 v86, v45, v44, s62
    v_perm_b32 v87, v47, v46, s62
    v_accvgpr_write_b32 a96, v80
    v_accvgpr_write_b32 a97, v81
    v_accvgpr_write_b32 a98, v82
    v_accvgpr_write_b32 a99, v83
    v_accvgpr_write_b32 a104, v84
    v_accvgpr_write_b32 a105, v85
    v_accvgpr_write_b32 a106, v86
    v_accvgpr_write_b32 a107, v87
    s_add_u32 s56, s59, 98304
    buffer_load_dword v40, v5, s[4:7], s56 offen offset:0
    buffer_load_dword v41, v5, s[4:7], s56 offen offset:1024
    buffer_load_dword v42, v5, s[4:7], s56 offen offset:2048
    buffer_load_dword v43, v5, s[4:7], s56 offen offset:3072
    s_add_u32 s56, s59, 102400
    buffer_load_dword v44, v5, s[4:7], s56 offen offset:0
    buffer_load_dword v45, v5, s[4:7], s56 offen offset:1024
    buffer_load_dword v46, v5, s[4:7], s56 offen offset:2048
    buffer_load_dword v47, v5, s[4:7], s56 offen offset:3072
    s_waitcnt vmcnt(48)
    v_perm_b32 v80, v49, v48, s61
    v_perm_b32 v81, v51, v50, s61
    v_perm_b32 v82, v53, v52, s61
    v_perm_b32 v83, v55, v54, s61
    v_perm_b32 v84, v49, v48, s62
    v_perm_b32 v85, v51, v50, s62
    v_perm_b32 v86, v53, v52, s62
    v_perm_b32 v87, v55, v54, s62
    v_accvgpr_write_b32 a100, v80
    v_accvgpr_write_b32 a101, v81
    v_accvgpr_write_b32 a102, v82
    v_accvgpr_write_b32 a103, v83
    v_accvgpr_write_b32 a108, v84
    v_accvgpr_write_b32 a109, v85
    v_accvgpr_write_b32 a110, v86
    v_accvgpr_write_b32 a111, v87
    s_add_u32 s56, s59, 256
    buffer_load_dword v48, v5, s[4:7], s56 offen offset:0
    buffer_load_dword v49, v5, s[4:7], s56 offen offset:1024
    buffer_load_dword v50, v5, s[4:7], s56 offen offset:2048
    buffer_load_dword v51, v5, s[4:7], s56 offen offset:3072
    s_add_u32 s56, s59, 4352
    buffer_load_dword v52, v5, s[4:7], s56 offen offset:0
    buffer_load_dword v53, v5, s[4:7], s56 offen offset:1024
    buffer_load_dword v54, v5, s[4:7], s56 offen offset:2048
    buffer_load_dword v55, v5, s[4:7], s56 offen offset:3072
    s_waitcnt vmcnt(48)
    v_perm_b32 v80, v57, v56, s61
    v_perm_b32 v81, v59, v58, s61
    v_perm_b32 v82, v61, v60, s61
    v_perm_b32 v83, v63, v62, s61
    v_perm_b32 v84, v57, v56, s62
    v_perm_b32 v85, v59, v58, s62
    v_perm_b32 v86, v61, v60, s62
    v_perm_b32 v87, v63, v62, s62
    v_accvgpr_write_b32 a112, v80
    v_accvgpr_write_b32 a113, v81
    v_accvgpr_write_b32 a114, v82
    v_accvgpr_write_b32 a115, v83
    v_accvgpr_write_b32 a120, v84
    v_accvgpr_write_b32 a121, v85
    v_accvgpr_write_b32 a122, v86
    v_accvgpr_write_b32 a123, v87
    s_add_u32 s56, s59, 33024
    buffer_load_dword v56, v5, s[4:7], s56 offen offset:0
    buffer_load_dword v57, v5, s[4:7], s56 offen offset:1024
    buffer_load_dword v58, v5, s[4:7], s56 offen offset:2048
    buffer_load_dword v59, v5, s[4:7], s56 offen offset:3072
    s_add_u32 s56, s59, 37120
    buffer_load_dword v60, v5, s[4:7], s56 offen offset:0
    buffer_load_dword v61, v5, s[4:7], s56 offen offset:1024
    buffer_load_dword v62, v5, s[4:7], s56 offen offset:2048
    buffer_load_dword v63, v5, s[4:7], s56 offen offset:3072
    s_waitcnt vmcnt(48)
    v_perm_b32 v80, v65, v64, s61
    v_perm_b32 v81, v67, v66, s61
    v_perm_b32 v82, v69, v68, s61
    v_perm_b32 v83, v71, v70, s61
    v_perm_b32 v84, v65, v64, s62
    v_perm_b32 v85, v67, v66, s62
    v_perm_b32 v86, v69, v68, s62
    v_perm_b32 v87, v71, v70, s62
    v_accvgpr_write_b32 a116, v80
    v_accvgpr_write_b32 a117, v81
    v_accvgpr_write_b32 a118, v82
    v_accvgpr_write_b32 a119, v83
    v_accvgpr_write_b32 a124, v84
    v_accvgpr_write_b32 a125, v85
    v_accvgpr_write_b32 a126, v86
    v_accvgpr_write_b32 a127, v87
    s_add_u32 s56, s59, 65792
    buffer_load_dword v64, v5, s[4:7], s56 offen offset:0
    buffer_load_dword v65, v5, s[4:7], s56 offen offset:1024
    buffer_load_dword v66, v5, s[4:7], s56 offen offset:2048
    buffer_load_dword v67, v5, s[4:7], s56 offen offset:3072
    s_add_u32 s56, s59, 69888
    buffer_load_dword v68, v5, s[4:7], s56 offen offset:0
    buffer_load_dword v69, v5, s[4:7], s56 offen offset:1024
    buffer_load_dword v70, v5, s[4:7], s56 offen offset:2048
    buffer_load_dword v71, v5, s[4:7], s56 offen offset:3072
    s_waitcnt vmcnt(48)
    v_perm_b32 v80, v73, v72, s61
    v_perm_b32 v81, v75, v74, s61
    v_perm_b32 v82, v77, v76, s61
    v_perm_b32 v83, v79, v78, s61
    v_perm_b32 v84, v73, v72, s62
    v_perm_b32 v85, v75, v74, s62
    v_perm_b32 v86, v77, v76, s62
    v_perm_b32 v87, v79, v78, s62
    ds_write_b128 v6, v[80:83] offset:0
    ds_write_b128 v6, v[84:87] offset:4096
    s_waitcnt lgkmcnt(0)
    s_add_u32 s56, s59, 98560
    buffer_load_dword v72, v5, s[4:7], s56 offen offset:0
    buffer_load_dword v73, v5, s[4:7], s56 offen offset:1024
    buffer_load_dword v74, v5, s[4:7], s56 offen offset:2048
    buffer_load_dword v75, v5, s[4:7], s56 offen offset:3072
    s_add_u32 s56, s59, 102656
    buffer_load_dword v76, v5, s[4:7], s56 offen offset:0
    buffer_load_dword v77, v5, s[4:7], s56 offen offset:1024
    buffer_load_dword v78, v5, s[4:7], s56 offen offset:2048
    buffer_load_dword v79, v5, s[4:7], s56 offen offset:3072
    s_waitcnt vmcnt(48)
    v_perm_b32 v80, v25, v24, s61
    v_perm_b32 v81, v27, v26, s61
    v_perm_b32 v82, v29, v28, s61
    v_perm_b32 v83, v31, v30, s61
    v_perm_b32 v84, v25, v24, s62
    v_perm_b32 v85, v27, v26, s62
    v_perm_b32 v86, v29, v28, s62
    v_perm_b32 v87, v31, v30, s62
    ds_write_b128 v6, v[80:83] offset:1024
    ds_write_b128 v6, v[84:87] offset:5120
    s_waitcnt lgkmcnt(0)
    s_add_u32 s56, s59, 512
    buffer_load_dword v24, v5, s[4:7], s56 offen offset:0
    buffer_load_dword v25, v5, s[4:7], s56 offen offset:1024
    buffer_load_dword v26, v5, s[4:7], s56 offen offset:2048
    buffer_load_dword v27, v5, s[4:7], s56 offen offset:3072
    s_add_u32 s56, s59, 4608
    buffer_load_dword v28, v5, s[4:7], s56 offen offset:0
    buffer_load_dword v29, v5, s[4:7], s56 offen offset:1024
    buffer_load_dword v30, v5, s[4:7], s56 offen offset:2048
    buffer_load_dword v31, v5, s[4:7], s56 offen offset:3072
    s_waitcnt vmcnt(48)
    v_perm_b32 v80, v33, v32, s61
    v_perm_b32 v81, v35, v34, s61
    v_perm_b32 v82, v37, v36, s61
    v_perm_b32 v83, v39, v38, s61
    v_perm_b32 v84, v33, v32, s62
    v_perm_b32 v85, v35, v34, s62
    v_perm_b32 v86, v37, v36, s62
    v_perm_b32 v87, v39, v38, s62
    ds_write_b128 v6, v[80:83] offset:2048
    ds_write_b128 v6, v[84:87] offset:6144
    s_waitcnt lgkmcnt(0)
    s_add_u32 s56, s59, 33280
    buffer_load_dword v32, v5, s[4:7], s56 offen offset:0
    buffer_load_dword v33, v5, s[4:7], s56 offen offset:1024
    buffer_load_dword v34, v5, s[4:7], s56 offen offset:2048
    buffer_load_dword v35, v5, s[4:7], s56 offen offset:3072
    s_add_u32 s56, s59, 37376
    buffer_load_dword v36, v5, s[4:7], s56 offen offset:0
    buffer_load_dword v37, v5, s[4:7], s56 offen offset:1024
    buffer_load_dword v38, v5, s[4:7], s56 offen offset:2048
    buffer_load_dword v39, v5, s[4:7], s56 offen offset:3072
    s_waitcnt vmcnt(48)
    v_perm_b32 v80, v41, v40, s61
    v_perm_b32 v81, v43, v42, s61
    v_perm_b32 v82, v45, v44, s61
    v_perm_b32 v83, v47, v46, s61
    v_perm_b32 v84, v41, v40, s62
    v_perm_b32 v85, v43, v42, s62
    v_perm_b32 v86, v45, v44, s62
    v_perm_b32 v87, v47, v46, s62
    ds_write_b128 v6, v[80:83] offset:3072
    ds_write_b128 v6, v[84:87] offset:7168
    s_waitcnt lgkmcnt(0)
    s_add_u32 s56, s59, 66048
    buffer_load_dword v40, v5, s[4:7], s56 offen offset:0
    buffer_load_dword v41, v5, s[4:7], s56 offen offset:1024
    buffer_load_dword v42, v5, s[4:7], s56 offen offset:2048
    buffer_load_dword v43, v5, s[4:7], s56 offen offset:3072
    s_add_u32 s56, s59, 70144
    buffer_load_dword v44, v5, s[4:7], s56 offen offset:0
    buffer_load_dword v45, v5, s[4:7], s56 offen offset:1024
    buffer_load_dword v46, v5, s[4:7], s56 offen offset:2048
    buffer_load_dword v47, v5, s[4:7], s56 offen offset:3072
    s_waitcnt vmcnt(48)
    v_perm_b32 v80, v49, v48, s61
    v_perm_b32 v81, v51, v50, s61
    v_perm_b32 v82, v53, v52, s61
    v_perm_b32 v83, v55, v54, s61
    v_perm_b32 v84, v49, v48, s62
    v_perm_b32 v85, v51, v50, s62
    v_perm_b32 v86, v53, v52, s62
    v_perm_b32 v87, v55, v54, s62
    ds_write_b128 v6, v[80:83] offset:8192
    ds_write_b128 v6, v[84:87] offset:12288
    s_waitcnt lgkmcnt(0)
    s_add_u32 s56, s59, 98816
    buffer_load_dword v48, v5, s[4:7], s56 offen offset:0
    buffer_load_dword v49, v5, s[4:7], s56 offen offset:1024
    buffer_load_dword v50, v5, s[4:7], s56 offen offset:2048
    buffer_load_dword v51, v5, s[4:7], s56 offen offset:3072
    s_add_u32 s56, s59, 102912
    buffer_load_dword v52, v5, s[4:7], s56 offen offset:0
    buffer_load_dword v53, v5, s[4:7], s56 offen offset:1024
    buffer_load_dword v54, v5, s[4:7], s56 offen offset:2048
    buffer_load_dword v55, v5, s[4:7], s56 offen offset:3072
    s_waitcnt vmcnt(48)
    v_perm_b32 v80, v57, v56, s61
    v_perm_b32 v81, v59, v58, s61
    v_perm_b32 v82, v61, v60, s61
    v_perm_b32 v83, v63, v62, s61
    v_perm_b32 v84, v57, v56, s62
    v_perm_b32 v85, v59, v58, s62
    v_perm_b32 v86, v61, v60, s62
    v_perm_b32 v87, v63, v62, s62
    ds_write_b128 v6, v[80:83] offset:9216
    ds_write_b128 v6, v[84:87] offset:13312
    s_waitcnt lgkmcnt(0)
    s_add_u32 s56, s59, 768
    buffer_load_dword v56, v5, s[4:7], s56 offen offset:0
    buffer_load_dword v57, v5, s[4:7], s56 offen offset:1024
    buffer_load_dword v58, v5, s[4:7], s56 offen offset:2048
    buffer_load_dword v59, v5, s[4:7], s56 offen offset:3072
    s_add_u32 s56, s59, 4864
    buffer_load_dword v60, v5, s[4:7], s56 offen offset:0
    buffer_load_dword v61, v5, s[4:7], s56 offen offset:1024
    buffer_load_dword v62, v5, s[4:7], s56 offen offset:2048
    buffer_load_dword v63, v5, s[4:7], s56 offen offset:3072
    s_waitcnt vmcnt(48)
    v_perm_b32 v80, v65, v64, s61
    v_perm_b32 v81, v67, v66, s61
    v_perm_b32 v82, v69, v68, s61
    v_perm_b32 v83, v71, v70, s61
    v_perm_b32 v84, v65, v64, s62
    v_perm_b32 v85, v67, v66, s62
    v_perm_b32 v86, v69, v68, s62
    v_perm_b32 v87, v71, v70, s62
    ds_write_b128 v6, v[80:83] offset:10240
    ds_write_b128 v6, v[84:87] offset:14336
    s_waitcnt lgkmcnt(0)
    s_add_u32 s56, s59, 33536
    buffer_load_dword v64, v5, s[4:7], s56 offen offset:0
    buffer_load_dword v65, v5, s[4:7], s56 offen offset:1024
    buffer_load_dword v66, v5, s[4:7], s56 offen offset:2048
    buffer_load_dword v67, v5, s[4:7], s56 offen offset:3072
    s_add_u32 s56, s59, 37632
    buffer_load_dword v68, v5, s[4:7], s56 offen offset:0
    buffer_load_dword v69, v5, s[4:7], s56 offen offset:1024
    buffer_load_dword v70, v5, s[4:7], s56 offen offset:2048
    buffer_load_dword v71, v5, s[4:7], s56 offen offset:3072
    s_waitcnt vmcnt(48)
    v_perm_b32 v80, v73, v72, s61
    v_perm_b32 v81, v75, v74, s61
    v_perm_b32 v82, v77, v76, s61
    v_perm_b32 v83, v79, v78, s61
    v_perm_b32 v84, v73, v72, s62
    v_perm_b32 v85, v75, v74, s62
    v_perm_b32 v86, v77, v76, s62
    v_perm_b32 v87, v79, v78, s62
    ds_write_b128 v6, v[80:83] offset:11264
    ds_write_b128 v6, v[84:87] offset:15360
    s_waitcnt lgkmcnt(0)
    s_add_u32 s56, s59, 66304
    buffer_load_dword v72, v5, s[4:7], s56 offen offset:0
    buffer_load_dword v73, v5, s[4:7], s56 offen offset:1024
    buffer_load_dword v74, v5, s[4:7], s56 offen offset:2048
    buffer_load_dword v75, v5, s[4:7], s56 offen offset:3072
    s_add_u32 s56, s59, 70400
    buffer_load_dword v76, v5, s[4:7], s56 offen offset:0
    buffer_load_dword v77, v5, s[4:7], s56 offen offset:1024
    buffer_load_dword v78, v5, s[4:7], s56 offen offset:2048
    buffer_load_dword v79, v5, s[4:7], s56 offen offset:3072
    s_waitcnt vmcnt(48)
    v_perm_b32 v80, v25, v24, s61
    v_perm_b32 v81, v27, v26, s61
    v_perm_b32 v82, v29, v28, s61
    v_perm_b32 v83, v31, v30, s61
    v_perm_b32 v84, v25, v24, s62
    v_perm_b32 v85, v27, v26, s62
    v_perm_b32 v86, v29, v28, s62
    v_perm_b32 v87, v31, v30, s62
    ds_write_b128 v6, v[80:83] offset:16384
    ds_write_b128 v6, v[84:87] offset:20480
    s_waitcnt lgkmcnt(0)
    s_add_u32 s56, s59, 99072
    buffer_load_dword v24, v5, s[4:7], s56 offen offset:0
    buffer_load_dword v25, v5, s[4:7], s56 offen offset:1024
    buffer_load_dword v26, v5, s[4:7], s56 offen offset:2048
    buffer_load_dword v27, v5, s[4:7], s56 offen offset:3072
    s_add_u32 s56, s59, 103168
    buffer_load_dword v28, v5, s[4:7], s56 offen offset:0
    buffer_load_dword v29, v5, s[4:7], s56 offen offset:1024
    buffer_load_dword v30, v5, s[4:7], s56 offen offset:2048
    buffer_load_dword v31, v5, s[4:7], s56 offen offset:3072
    s_waitcnt vmcnt(48)
    v_perm_b32 v80, v33, v32, s61
    v_perm_b32 v81, v35, v34, s61
    v_perm_b32 v82, v37, v36, s61
    v_perm_b32 v83, v39, v38, s61
    v_perm_b32 v84, v33, v32, s62
    v_perm_b32 v85, v35, v34, s62
    v_perm_b32 v86, v37, v36, s62
    v_perm_b32 v87, v39, v38, s62
    ds_write_b128 v6, v[80:83] offset:17408
    ds_write_b128 v6, v[84:87] offset:21504
    s_waitcnt lgkmcnt(0)
    s_waitcnt vmcnt(40)
    v_perm_b32 v80, v41, v40, s61
    v_perm_b32 v81, v43, v42, s61
    v_perm_b32 v82, v45, v44, s61
    v_perm_b32 v83, v47, v46, s61
    v_perm_b32 v84, v41, v40, s62
    v_perm_b32 v85, v43, v42, s62
    v_perm_b32 v86, v45, v44, s62
    v_perm_b32 v87, v47, v46, s62
    ds_write_b128 v6, v[80:83] offset:18432
    ds_write_b128 v6, v[84:87] offset:22528
    s_waitcnt lgkmcnt(0)
    s_waitcnt vmcnt(32)
    v_perm_b32 v80, v49, v48, s61
    v_perm_b32 v81, v51, v50, s61
    v_perm_b32 v82, v53, v52, s61
    v_perm_b32 v83, v55, v54, s61
    v_perm_b32 v84, v49, v48, s62
    v_perm_b32 v85, v51, v50, s62
    v_perm_b32 v86, v53, v52, s62
    v_perm_b32 v87, v55, v54, s62
    ds_write_b128 v6, v[80:83] offset:19456
    ds_write_b128 v6, v[84:87] offset:23552
    s_waitcnt lgkmcnt(0)
    s_waitcnt vmcnt(24)
    v_perm_b32 v80, v57, v56, s61
    v_perm_b32 v81, v59, v58, s61
    v_perm_b32 v82, v61, v60, s61
    v_perm_b32 v83, v63, v62, s61
    v_perm_b32 v84, v57, v56, s62
    v_perm_b32 v85, v59, v58, s62
    v_perm_b32 v86, v61, v60, s62
    v_perm_b32 v87, v63, v62, s62
    ds_write_b128 v6, v[80:83] offset:24576
    ds_write_b128 v6, v[84:87] offset:28672
    s_waitcnt lgkmcnt(0)
    s_waitcnt vmcnt(16)
    v_perm_b32 v80, v65, v64, s61
    v_perm_b32 v81, v67, v66, s61
    v_perm_b32 v82, v69, v68, s61
    v_perm_b32 v83, v71, v70, s61
    v_perm_b32 v84, v65, v64, s62
    v_perm_b32 v85, v67, v66, s62
    v_perm_b32 v86, v69, v68, s62
    v_perm_b32 v87, v71, v70, s62
    ds_write_b128 v6, v[80:83] offset:25600
    ds_write_b128 v6, v[84:87] offset:29696
    s_waitcnt lgkmcnt(0)
    s_waitcnt vmcnt(8)
    v_perm_b32 v80, v73, v72, s61
    v_perm_b32 v81, v75, v74, s61
    v_perm_b32 v82, v77, v76, s61
    v_perm_b32 v83, v79, v78, s61
    v_perm_b32 v84, v73, v72, s62
    v_perm_b32 v85, v75, v74, s62
    v_perm_b32 v86, v77, v76, s62
    v_perm_b32 v87, v79, v78, s62
    ds_write_b128 v6, v[80:83] offset:26624
    ds_write_b128 v6, v[84:87] offset:30720
    s_waitcnt lgkmcnt(0)
    s_waitcnt vmcnt(0)
    v_perm_b32 v80, v25, v24, s61
    v_perm_b32 v81, v27, v26, s61
    v_perm_b32 v82, v29, v28, s61
    v_perm_b32 v83, v31, v30, s61
    v_perm_b32 v84, v25, v24, s62
    v_perm_b32 v85, v27, v26, s62
    v_perm_b32 v86, v29, v28, s62
    v_perm_b32 v87, v31, v30, s62
    ds_write_b128 v6, v[80:83] offset:27648
    ds_write_b128 v6, v[84:87] offset:31744
    s_waitcnt lgkmcnt(0)
    s_waitcnt vmcnt(0) lgkmcnt(0)
    s_barrier
    s_add_u32 s50, s50, 256
    s_cmp_lg_u32 s46, 0
    s_cbranch_scc1 L_gbd_4
    v_mov_b32 v124, 128
    v_mov_b32 v125, 1
    s_mov_b64 exec, 1
    buffer_atomic_add v125, v124, s[12:15], 0 offen
    s_mov_b64 exec, -1
L_gb_3:
    buffer_load_dword v125, v124, s[12:15], 0 offen sc1
    s_waitcnt vmcnt(0)
    v_readfirstlane_b32 s56, v125
    s_cmp_ge_u32 s56, s50
    s_cbranch_scc1 L_gbd_4
    s_sleep 4
    s_sub_u32 s49, s49, 1
    s_cmp_gt_i32 s49, 0
    s_cbranch_scc1 L_gb_3
    s_branch L_abort
L_gbd_4:
    s_barrier
    s_mov_b32 s52, 0
    s_mov_b32 s51, s48
L_t1_5:
    s_lshl_b32 s56, s51, 15
    s_lshl_b32 s57, s52, 21
    s_add_u32 s56, s56, s57
    buffer_load_dwordx4 v[72:75], v0, s[8:11], s56 offen offset:0 sc1
    buffer_load_dwordx4 v[76:79], v0, s[8:11], s56 offen offset:1024 sc1
    buffer_load_dwordx4 v[80:83], v0, s[8:11], s56 offen offset:2048 sc1
    buffer_load_dwordx4 v[84:87], v0, s[8:11], s56 offen offset:3072 sc1
    s_add_u32 s56, s56, 4096
    buffer_load_dwordx4 v[88:91], v0, s[8:11], s56 offen offset:0 sc1
    buffer_load_dwordx4 v[92:95], v0, s[8:11], s56 offen offset:1024 sc1
    buffer_load_dwordx4 v[96:99], v0, s[8:11], s56 offen offset:2048 sc1
    buffer_load_dwordx4 v[100:103], v0, s[8:11], s56 offen offset:3072 sc1
    s_add_u32 s56, s56, 4096
    buffer_load_dwordx4 v[104:107], v0, s[8:11], s56 offen offset:0 sc1
    buffer_load_dwordx4 v[108:111], v0, s[8:11], s56 offen offset:1024 sc1
    buffer_load_dwordx4 v[112:115], v0, s[8:11], s56 offen offset:2048 sc1
    buffer_load_dwordx4 v[116:119], v0, s[8:11], s56 offen offset:3072 sc1
    s_add_u32 s56, s56, 4096
    buffer_load_dwordx4 v[120:123], v0, s[8:11], s56 offen offset:0 sc1
    buffer_load_dwordx4 v[124:127], v0, s[8:11], s56 offen offset:1024 sc1
    s_lshl_b32 s58, s51, 5
    s_add_u32 s58, s58, s47
    s_mul_i32 s58, s58, 24576
    s_mul_i32 s59, s52, 50331648
    s_add_u32 s58, s58, s59
    s_add_u32 s58, s58, 100663296
    s_lshl_b32 s60, s46, 10
    s_add_u32 s61, s58, s60
    s_add_u32 s62, s61, 4096
    s_add_u32 s63, s61, 16384
    s_add_u32 s64, s61, 20480
    s_add_u32 s65, s61, s60
    s_add_u32 s65, s65, 8192
    s_waitcnt vmcnt(12)
    v_mfma_f32_16x16x32_bf16 v[40:43], a[128:131], v[72:75], 0
    v_mfma_f32_16x16x32_bf16 v[56:59], v[72:75], v[128:131], 0
    v_mfma_f32_16x16x32_bf16 v[24:27], a[0:3], v[72:75], 0
    v_mfma_f32_16x16x32_bf16 v[44:47], a[128:131], v[76:79], 0
    v_mfma_f32_16x16x32_bf16 v[60:63], v[76:79], v[128:131], 0
    v_mfma_f32_16x16x32_bf16 v[28:31], a[0:3], v[76:79], 0
    v_mfma_f32_16x16x32_bf16 v[48:51], a[136:139], v[72:75], 0
    v_mfma_f32_16x16x32_bf16 v[64:67], v[72:75], v[136:139], 0
    v_mfma_f32_16x16x32_bf16 v[32:35], a[8:11], v[72:75], 0
    v_mfma_f32_16x16x32_bf16 v[52:55], a[136:139], v[76:79], 0
    v_mfma_f32_16x16x32_bf16 v[68:71], v[76:79], v[136:139], 0
    v_mfma_f32_16x16x32_bf16 v[36:39], a[8:11], v[76:79], 0
    buffer_load_dwordx4 v[72:75], v0, s[8:11], s56 offen offset:2048 sc1
    buffer_load_dwordx4 v[76:79], v0, s[8:11], s56 offen offset:3072 sc1
    s_waitcnt vmcnt(12)
    v_mfma_f32_16x16x32_bf16 v[40:43], a[132:135], v[80:83], v[40:43]
    v_mfma_f32_16x16x32_bf16 v[56:59], v[80:83], v[132:135], v[56:59]
    v_mfma_f32_16x16x32_bf16 v[24:27], a[4:7], v[80:83], v[24:27]
    v_mfma_f32_16x16x32_bf16 v[44:47], a[132:135], v[84:87], v[44:47]
    v_mfma_f32_16x16x32_bf16 v[60:63], v[84:87], v[132:135], v[60:63]
    v_mfma_f32_16x16x32_bf16 v[28:31], a[4:7], v[84:87], v[28:31]
    v_mfma_f32_16x16x32_bf16 v[48:51], a[140:143], v[80:83], v[48:51]
    v_mfma_f32_16x16x32_bf16 v[64:67], v[80:83], v[140:143], v[64:67]
    v_mfma_f32_16x16x32_bf16 v[32:35], a[12:15], v[80:83], v[32:35]
    v_mfma_f32_16x16x32_bf16 v[52:55], a[140:143], v[84:87], v[52:55]
    v_mfma_f32_16x16x32_bf16 v[68:71], v[84:87], v[140:143], v[68:71]
    v_mfma_f32_16x16x32_bf16 v[36:39], a[12:15], v[84:87], v[36:39]
    s_add_u32 s56, s56, 4096
    buffer_load_dwordx4 v[80:83], v0, s[8:11], s56 offen offset:0 sc1
    buffer_load_dwordx4 v[84:87], v0, s[8:11], s56 offen offset:1024 sc1
    s_waitcnt vmcnt(12)
    v_mfma_f32_16x16x32_bf16 v[40:43], a[144:147], v[88:91], v[40:43]
    v_mfma_f32_16x16x32_bf16 v[56:59], v[88:91], v[144:147], v[56:59]
    v_mfma_f32_16x16x32_bf16 v[24:27], a[16:19], v[88:91], v[24:27]
    v_mfma_f32_16x16x32_bf16 v[44:47], a[144:147], v[92:95], v[44:47]
    v_mfma_f32_16x16x32_bf16 v[60:63], v[92:95], v[144:147], v[60:63]
    v_mfma_f32_16x16x32_bf16 v[28:31], a[16:19], v[92:95], v[28:31]
    v_mfma_f32_16x16x32_bf16 v[48:51], a[152:155], v[88:91], v[48:51]
    v_mfma_f32_16x16x32_bf16 v[64:67], v[88:91], v[152:155], v[64:67]
    v_mfma_f32_16x16x32_bf16 v[32:35], a[24:27], v[88:91], v[32:35]
    v_mfma_f32_16x16x32_bf16 v[52:55], a[152:155], v[92:95], v[52:55]
    v_mfma_f32_16x16x32_bf16 v[68:71], v[92:95], v[152:155], v[68:71]
    v_mfma_f32_16x16x32_bf16 v[36:39], a[24:27], v[92:95], v[36:39]
    buffer_load_dwordx4 v[88:91], v0, s[8:11], s56 offen offset:2048 sc1
    buffer_load_dwordx4 v[92:95], v0, s[8:11], s56 offen offset:3072 sc1
    s_waitcnt vmcnt(12)
    v_mfma_f32_16x16x32_bf16 v[40:43], a[148:151], v[96:99], v[40:43]
    v_mfma_f32_16x16x32_bf16 v[56:59], v[96:99], v[148:151], v[56:59]
    v_mfma_f32_16x16x32_bf16 v[24:27], a[20:23], v[96:99], v[24:27]
    v_mfma_f32_16x16x32_bf16 v[44:47], a[148:151], v[100:103], v[44:47]
    v_mfma_f32_16x16x32_bf16 v[60:63], v[100:103], v[148:151], v[60:63]
    v_mfma_f32_16x16x32_bf16 v[28:31], a[20:23], v[100:103], v[28:31]
    v_mfma_f32_16x16x32_bf16 v[48:51], a[156:159], v[96:99], v[48:51]
    v_mfma_f32_16x16x32_bf16 v[64:67], v[96:99], v[156:159], v[64:67]
    v_mfma_f32_16x16x32_bf16 v[32:35], a[28:31], v[96:99], v[32:35]
    v_mfma_f32_16x16x32_bf16 v[52:55], a[156:159], v[100:103], v[52:55]
    v_mfma_f32_16x16x32_bf16 v[68:71], v[100:103], v[156:159], v[68:71]
    v_mfma_f32_16x16x32_bf16 v[36:39], a[28:31], v[100:103], v[36:39]
    s_add_u32 s56, s56, 4096
    buffer_load_dwordx4 v[96:99], v0, s[8:11], s56 offen offset:0 sc1
    buffer_load_dwordx4 v[100:103], v0, s[8:11], s56 offen offset:1024 sc1
    s_waitcnt vmcnt(12)
    v_mfma_f32_16x16x32_bf16 v[40:43], a[160:163], v[104:107], v[40:43]
    v_mfma_f32_16x16x32_bf16 v[56:59], v[104:107], v[160:163], v[56:59]
    v_mfma_f32_16x16x32_bf16 v[24:27], a[32:35], v[104:107], v[24:27]
    v_mfma_f32_16x16x32_bf16 v[44:47], a[160:163], v[108:111], v[44:47]
    v_mfma_f32_16x16x32_bf16 v[60:63], v[108:111], v[160:163], v[60:63]
    v_mfma_f32_16x16x32_bf16 v[28:31], a[32:35], v[108:111], v[28:31]
    v_mfma_f32_16x16x32_bf16 v[48:51], a[168:171], v[104:107], v[48:51]
    v_mfma_f32_16x16x32_bf16 v[64:67], v[104:107], v[168:171], v[64:67]
    v_mfma_f32_16x16x32_bf16 v[32:35], a[40:43], v[104:107], v[32:35]
    v_mfma_f32_16x16x32_bf16 v[52:55], a[168:171], v[108:111], v[52:55]
    v_mfma_f32_16x16x32_bf16 v[68:71], v[108:111], v[168:171], v[68:71]
    v_mfma_f32_16x16x32_bf16 v[36:39], a[40:43], v[108:111], v[36:39]
    buffer_load_dwordx4 v[104:107], v0, s[8:11], s56 offen offset:2048 sc1
    buffer_load_dwordx4 v[108:111], v0, s[8:11], s56 offen offset:3072 sc1
    s_waitcnt vmcnt(12)
    v_mfma_f32_16x16x32_bf16 v[40:43], a[164:167], v[112:115], v[40:43]
    v_mfma_f32_16x16x32_bf16 v[56:59], v[112:115], v[164:167], v[56:59]
    v_mfma_f32_16x16x32_bf16 v[24:27], a[36:39], v[112:115], v[24:27]
    v_mfma_f32_16x16x32_bf16 v[44:47], a[164:167], v[116:119], v[44:47]
    v_mfma_f32_16x16x32_bf16 v[60:63], v[116:119], v[164:167], v[60:63]
    v_mfma_f32_16x16x32_bf16 v[28:31], a[36:39], v[116:119], v[28:31]
    v_mfma_f32_16x16x32_bf16 v[48:51], a[172:175], v[112:115], v[48:51]
    v_mfma_f32_16x16x32_bf16 v[64:67], v[112:115], v[172:175], v[64:67]
    v_mfma_f32_16x16x32_bf16 v[32:35], a[44:47], v[112:115], v[32:35]
    v_mfma_f32_16x16x32_bf16 v[52:55], a[172:175], v[116:119], v[52:55]
    v_mfma_f32_16x16x32_bf16 v[68:71], v[116:119], v[172:175], v[68:71]
    v_mfma_f32_16x16x32_bf16 v[36:39], a[44:47], v[116:119], v[36:39]
    s_add_u32 s56, s56, 4096
    buffer_load_dwordx4 v[112:115], v0, s[8:11], s56 offen offset:0 sc1
    buffer_load_dwordx4 v[116:119], v0, s[8:11], s56 offen offset:1024 sc1
    s_waitcnt vmcnt(12)
    v_mfma_f32_16x16x32_bf16 v[40:43], a[176:179], v[120:123], v[40:43]
    v_mfma_f32_16x16x32_bf16 v[56:59], v[120:123], v[176:179], v[56:59]
    v_mfma_f32_16x16x32_bf16 v[24:27], a[48:51], v[120:123], v[24:27]
    v_mfma_f32_16x16x32_bf16 v[44:47], a[176:179], v[124:127], v[44:47]
    v_mfma_f32_16x16x32_bf16 v[60:63], v[124:127], v[176:179], v[60:63]
    v_mfma_f32_16x16x32_bf16 v[28:31], a[48:51], v[124:127], v[28:31]
    v_mfma_f32_16x16x32_bf16 v[48:51], a[184:187], v[120:123], v[48:51]
    v_mfma_f32_16x16x32_bf16 v[64:67], v[120:123], v[184:187], v[64:67]
    v_mfma_f32_16x16x32_bf16 v[32:35], a[56:59], v[120:123], v[32:35]
    v_mfma_f32_16x16x32_bf16 v[52:55], a[184:187], v[124:127], v[52:55]
    v_mfma_f32_16x16x32_bf16 v[68:71], v[124:127], v[184:187], v[68:71]
    v_mfma_f32_16x16x32_bf16 v[36:39], a[56:59], v[124:127], v[36:39]
    buffer_load_dwordx4 v[120:123], v0, s[8:11], s56 offen offset:2048 sc1
    buffer_load_dwordx4 v[124:127], v0, s[8:11], s56 offen offset:3072 sc1
    s_waitcnt vmcnt(12)
    v_mfma_f32_16x16x32_bf16 v[40:43], a[180:183], v[72:75], v[40:43]
    v_mfma_f32_16x16x32_bf16 v[56:59], v[72:75], v[180:183], v[56:59]
    v_mfma_f32_16x16x32_bf16 v[24:27], a[52:55], v[72:75], v[24:27]
    v_mfma_f32_16x16x32_bf16 v[44:47], a[180:183], v[76:79], v[44:47]
    v_mfma_f32_16x16x32_bf16 v[60:63], v[76:79], v[180:183], v[60:63]
    v_mfma_f32_16x16x32_bf16 v[28:31], a[52:55], v[76:79], v[28:31]
    v_mfma_f32_16x16x32_bf16 v[48:51], a[188:191], v[72:75], v[48:51]
    v_mfma_f32_16x16x32_bf16 v[64:67], v[72:75], v[188:191], v[64:67]
    v_mfma_f32_16x16x32_bf16 v[32:35], a[60:63], v[72:75], v[32:35]
    v_mfma_f32_16x16x32_bf16 v[52:55], a[188:191], v[76:79], v[52:55]
    v_mfma_f32_16x16x32_bf16 v[68:71], v[76:79], v[188:191], v[68:71]
    v_mfma_f32_16x16x32_bf16 v[36:39], a[60:63], v[76:79], v[36:39]
    s_add_u32 s56, s56, 4096
    buffer_load_dwordx4 v[72:75], v0, s[8:11], s56 offen offset:0 sc1
    buffer_load_dwordx4 v[76:79], v0, s[8:11], s56 offen offset:1024 sc1
    s_waitcnt vmcnt(12)
    v_mfma_f32_16x16x32_bf16 v[40:43], a[192:195], v[80:83], v[40:43]
    v_mfma_f32_16x16x32_bf16 v[56:59], v[80:83], v[192:195], v[56:59]
    v_mfma_f32_16x16x32_bf16 v[24:27], a[64:67], v[80:83], v[24:27]
    v_mfma_f32_16x16x32_bf16 v[44:47], a[192:195], v[84:87], v[44:47]
    v_mfma_f32_16x16x32_bf16 v[60:63], v[84:87], v[192:195], v[60:63]
    v_mfma_f32_16x16x32_bf16 v[28:31], a[64:67], v[84:87], v[28:31]
    v_mfma_f32_16x16x32_bf16 v[48:51], a[200:203], v[80:83], v[48:51]
    v_mfma_f32_16x16x32_bf16 v[64:67], v[80:83], v[200:203], v[64:67]
    v_mfma_f32_16x16x32_bf16 v[32:35], a[72:75], v[80:83], v[32:35]
    v_mfma_f32_16x16x32_bf16 v[52:55], a[200:203], v[84:87], v[52:55]
    v_mfma_f32_16x16x32_bf16 v[68:71], v[84:87], v[200:203], v[68:71]
    v_mfma_f32_16x16x32_bf16 v[36:39], a[72:75], v[84:87], v[36:39]
    buffer_load_dwordx4 v[80:83], v0, s[8:11], s56 offen offset:2048 sc1
    buffer_load_dwordx4 v[84:87], v0, s[8:11], s56 offen offset:3072 sc1
    s_waitcnt vmcnt(12)
    v_mfma_f32_16x16x32_bf16 v[40:43], a[196:199], v[88:91], v[40:43]
    v_mfma_f32_16x16x32_bf16 v[56:59], v[88:91], v[196:199], v[56:59]
    v_mfma_f32_16x16x32_bf16 v[24:27], a[68:71], v[88:91], v[24:27]
    v_mfma_f32_16x16x32_bf16 v[44:47], a[196:199], v[92:95], v[44:47]
    v_mfma_f32_16x16x32_bf16 v[60:63], v[92:95], v[196:199], v[60:63]
    v_mfma_f32_16x16x32_bf16 v[28:31], a[68:71], v[92:95], v[28:31]
    v_mfma_f32_16x16x32_bf16 v[48:51], a[204:207], v[88:91], v[48:51]
    v_mfma_f32_16x16x32_bf16 v[64:67], v[88:91], v[204:207], v[64:67]
    v_mfma_f32_16x16x32_bf16 v[32:35], a[76:79], v[88:91], v[32:35]
    v_mfma_f32_16x16x32_bf16 v[52:55], a[204:207], v[92:95], v[52:55]
    v_mfma_f32_16x16x32_bf16 v[68:71], v[92:95], v[204:207], v[68:71]
    v_mfma_f32_16x16x32_bf16 v[36:39], a[76:79], v[92:95], v[36:39]
    s_waitcnt vmcnt(10)
    v_mfma_f32_16x16x32_bf16 v[40:43], a[208:211], v[96:99], v[40:43]
    v_mfma_f32_16x16x32_bf16 v[56:59], v[96:99], v[208:211], v[56:59]
    v_mfma_f32_16x16x32_bf16 v[24:27], a[80:83], v[96:99], v[24:27]
    v_mfma_f32_16x16x32_bf16 v[44:47], a[208:211], v[100:103], v[44:47]
    v_mfma_f32_16x16x32_bf16 v[60:63], v[100:103], v[208:211], v[60:63]
    v_mfma_f32_16x16x32_bf16 v[28:31], a[80:83], v[100:103], v[28:31]
    v_mfma_f32_16x16x32_bf16 v[48:51], a[216:219], v[96:99], v[48:51]
    v_mfma_f32_16x16x32_bf16 v[64:67], v[96:99], v[216:219], v[64:67]
    v_mfma_f32_16x16x32_bf16 v[32:35], a[88:91], v[96:99], v[32:35]
    v_mfma_f32_16x16x32_bf16 v[52:55], a[216:219], v[100:103], v[52:55]
    v_mfma_f32_16x16x32_bf16 v[68:71], v[100:103], v[216:219], v[68:71]
    v_mfma_f32_16x16x32_bf16 v[36:39], a[88:91], v[100:103], v[36:39]
    s_waitcnt vmcnt(8)
    v_mfma_f32_16x16x32_bf16 v[40:43], a[212:215], v[104:107], v[40:43]
    v_mfma_f32_16x16x32_bf16 v[56:59], v[104:107], v[212:215], v[56:59]
    v_mfma_f32_16x16x32_bf16 v[24:27], a[84:87], v[104:107], v[24:27]
    v_mfma_f32_16x16x32_bf16 v[44:47], a[212:215], v[108:111], v[44:47]
    v_mfma_f32_16x16x32_bf16 v[60:63], v[108:111], v[212:215], v[60:63]
    v_mfma_f32_16x16x32_bf16 v[28:31], a[84:87], v[108:111], v[28:31]
    v_mfma_f32_16x16x32_bf16 v[48:51], a[220:223], v[104:107], v[48:51]
    v_mfma_f32_16x16x32_bf16 v[64:67], v[104:107], v[220:223], v[64:67]
    v_mfma_f32_16x16x32_bf16 v[32:35], a[92:95], v[104:107], v[32:35]
    v_mfma_f32_16x16x32_bf16 v[52:55], a[220:223], v[108:111], v[52:55]
    v_mfma_f32_16x16x32_bf16 v[68:71], v[108:111], v[220:223], v[68:71]
    v_mfma_f32_16x16x32_bf16 v[36:39], a[92:95], v[108:111], v[36:39]
    s_waitcnt vmcnt(6)
    v_mfma_f32_16x16x32_bf16 v[40:43], a[224:227], v[112:115], v[40:43]
    v_mfma_f32_16x16x32_bf16 v[56:59], v[112:115], v[224:227], v[56:59]
    v_mfma_f32_16x16x32_bf16 v[24:27], a[96:99], v[112:115], v[24:27]
    v_mfma_f32_16x16x32_bf16 v[44:47], a[224:227], v[116:119], v[44:47]
    v_mfma_f32_16x16x32_bf16 v[60:63], v[116:119], v[224:227], v[60:63]
    v_mfma_f32_16x16x32_bf16 v[28:31], a[96:99], v[116:119], v[28:31]
    v_mfma_f32_16x16x32_bf16 v[48:51], a[232:235], v[112:115], v[48:51]
    v_mfma_f32_16x16x32_bf16 v[64:67], v[112:115], v[232:235], v[64:67]
    v_mfma_f32_16x16x32_bf16 v[32:35], a[104:107], v[112:115], v[32:35]
    v_mfma_f32_16x16x32_bf16 v[52:55], a[232:235], v[116:119], v[52:55]
    v_mfma_f32_16x16x32_bf16 v[68:71], v[116:119], v[232:235], v[68:71]
    v_mfma_f32_16x16x32_bf16 v[36:39], a[104:107], v[116:119], v[36:39]
    s_waitcnt vmcnt(4)
    v_mfma_f32_16x16x32_bf16 v[40:43], a[228:231], v[120:123], v[40:43]
    v_mfma_f32_16x16x32_bf16 v[56:59], v[120:123], v[228:231], v[56:59]
    v_mfma_f32_16x16x32_bf16 v[24:27], a[100:103], v[120:123], v[24:27]
    v_mfma_f32_16x16x32_bf16 v[44:47], a[228:231], v[124:127], v[44:47]
    v_mfma_f32_16x16x32_bf16 v[60:63], v[124:127], v[228:231], v[60:63]
    v_mfma_f32_16x16x32_bf16 v[28:31], a[100:103], v[124:127], v[28:31]
    v_mfma_f32_16x16x32_bf16 v[48:51], a[236:239], v[120:123], v[48:51]
    v_mfma_f32_16x16x32_bf16 v[64:67], v[120:123], v[236:239], v[64:67]
    v_mfma_f32_16x16x32_bf16 v[32:35], a[108:111], v[120:123], v[32:35]
    v_mfma_f32_16x16x32_bf16 v[52:55], a[236:239], v[124:127], v[52:55]
    v_mfma_f32_16x16x32_bf16 v[68:71], v[124:127], v[236:239], v[68:71]
    v_mfma_f32_16x16x32_bf16 v[36:39], a[108:111], v[124:127], v[36:39]
    s_waitcnt vmcnt(2)
    v_mfma_f32_16x16x32_bf16 v[40:43], a[240:243], v[72:75], v[40:43]
    v_mfma_f32_16x16x32_bf16 v[56:59], v[72:75], v[240:243], v[56:59]
    v_mfma_f32_16x16x32_bf16 v[24:27], a[112:115], v[72:75], v[24:27]
    v_mfma_f32_16x16x32_bf16 v[44:47], a[240:243], v[76:79], v[44:47]
    v_mfma_f32_16x16x32_bf16 v[60:63], v[76:79], v[240:243], v[60:63]
    v_mfma_f32_16x16x32_bf16 v[28:31], a[112:115], v[76:79], v[28:31]
    v_mfma_f32_16x16x32_bf16 v[48:51], a[248:251], v[72:75], v[48:51]
    v_mfma_f32_16x16x32_bf16 v[64:67], v[72:75], v[248:251], v[64:67]
    v_mfma_f32_16x16x32_bf16 v[32:35], a[120:123], v[72:75], v[32:35]
    v_mfma_f32_16x16x32_bf16 v[52:55], a[248:251], v[76:79], v[52:55]
    v_mfma_f32_16x16x32_bf16 v[68:71], v[76:79], v[248:251], v[68:71]
    v_mfma_f32_16x16x32_bf16 v[36:39], a[120:123], v[76:79], v[36:39]
    s_waitcnt vmcnt(0)
    v_mfma_f32_16x16x32_bf16 v[40:43], a[244:247], v[80:83], v[40:43]
    v_mfma_f32_16x16x32_bf16 v[56:59], v[80:83], v[244:247], v[56:59]
    v_mfma_f32_16x16x32_bf16 v[24:27], a[116:119], v[80:83], v[24:27]
    v_mfma_f32_16x16x32_bf16 v[44:47], a[244:247], v[84:87], v[44:47]
    v_mfma_f32_16x16x32_bf16 v[60:63], v[84:87], v[244:247], v[60:63]
    v_mfma_f32_16x16x32_bf16 v[28:31], a[116:119], v[84:87], v[28:31]
    v_mfma_f32_16x16x32_bf16 v[48:51], a[252:255], v[80:83], v[48:51]
    v_mfma_f32_16x16x32_bf16 v[64:67], v[80:83], v[252:255], v[64:67]
    v_mfma_f32_16x16x32_bf16 v[32:35], a[124:127], v[80:83], v[32:35]
    v_mfma_f32_16x16x32_bf16 v[52:55], a[252:255], v[84:87], v[52:55]
    v_mfma_f32_16x16x32_bf16 v[68:71], v[84:87], v[252:255], v[68:71]
    v_mfma_f32_16x16x32_bf16 v[36:39], a[124:127], v[84:87], v[36:39]
    v_cvt_pk_bf16_f32 v72, v40, v48
    v_cvt_pk_bf16_f32 v73, v41, v49
    v_cvt_pk_bf16_f32 v74, v42, v50
    v_cvt_pk_bf16_f32 v75, v43, v51
    buffer_store_dwordx4 v[72:75], v0, s[8:11], s61 offen sc1
    v_cvt_pk_bf16_f32 v76, v44, v52
    v_cvt_pk_bf16_f32 v77, v45, v53
    v_cvt_pk_bf16_f32 v78, v46, v54
    v_cvt_pk_bf16_f32 v79, v47, v55
    buffer_store_dwordx4 v[76:79], v0, s[8:11], s62 offen sc1
    v_cvt_pk_bf16_f32 v88, v56, v57
    v_cvt_pk_bf16_f32 v89, v58, v59
    v_cvt_pk_bf16_f32 v90, v60, v61
    v_cvt_pk_bf16_f32 v91, v62, v63
    buffer_store_dwordx4 v[88:91], v0, s[8:11], s65 offen offset:0 sc1
    v_cvt_pk_bf16_f32 v92, v64, v65
    v_cvt_pk_bf16_f32 v93, v66, v67
    v_cvt_pk_bf16_f32 v94, v68, v69
    v_cvt_pk_bf16_f32 v95, v70, v71
    buffer_store_dwordx4 v[92:95], v0, s[8:11], s65 offen offset:1024 sc1
    v_cvt_pk_bf16_f32 v80, v24, v32
    v_cvt_pk_bf16_f32 v81, v25, v33
    v_cvt_pk_bf16_f32 v82, v26, v34
    v_cvt_pk_bf16_f32 v83, v27, v35
    buffer_store_dwordx4 v[80:83], v0, s[8:11], s63 offen sc1
    v_cvt_pk_bf16_f32 v84, v28, v36
    v_cvt_pk_bf16_f32 v85, v29, v37
    v_cvt_pk_bf16_f32 v86, v30, v38
    v_cvt_pk_bf16_f32 v87, v31, v39
    buffer_store_dwordx4 v[84:87], v0, s[8:11], s64 offen sc1
    s_add_u32 s51, s51, 8
    s_cmp_lt_u32 s51, 64
    s_cbranch_scc1 L_t1_5
    s_waitcnt vmcnt(0) lgkmcnt(0)
    s_barrier
    s_add_u32 s50, s50, 256
    s_cmp_lg_u32 s46, 0
    s_cbranch_scc1 L_gbd_7
    v_mov_b32 v124, 128
    v_mov_b32 v125, 1
    s_mov_b64 exec, 1
    buffer_atomic_add v125, v124, s[12:15], 0 offen
    s_mov_b64 exec, -1
L_gb_6:
    buffer_load_dword v125, v124, s[12:15], 0 offen sc1
    s_waitcnt vmcnt(0)
    v_readfirstlane_b32 s56, v125
    s_cmp_ge_u32 s56, s50
    s_cbranch_scc1 L_gbd_7
    s_sleep 4
    s_sub_u32 s49, s49, 1
    s_cmp_gt_i32 s49, 0
    s_cbranch_scc1 L_gb_6
    s_branch L_abort
L_gbd_7:
    s_barrier
    s_cmp_lg_u32 s48, 0
    s_cbranch_scc1 L_nc_8
    v_and_b32 v120, 15, v1
    v_lshrrev_b32 v121, 4, v1
    v_and_b32 v122, 8, v1
    v_cmp_eq_u32 vcc, 0, v122
    v_mov_b32 v2, 0xdddd
    v_mov_b32 v123, 0x8888
    v_cndmask_b32 v2, v2, v123, vcc
    v_lshrrev_b32 v122, 1, v120
    v_bfe_u32 v123, v120, 2, 1
    v_xor_b32 v123, v123, v122
    v_lshlrev_b32 v3, 7, v123
    v_and_b32 v123, 1, v120
    v_lshl_add_u32 v3, v123, 6, v3
    v_xor_b32 v123, v121, v122
    v_and_b32 v123, 3, v123
    v_lshl_add_u32 v3, v123, 4, v3
    s_lshl_b32 s56, s46, 10
    s_add_u32 s56, s56, 147456
    v_add_u32 v3, s56, v3
    v_lshlrev_b32 v122, 1, v121
    v_add_u32 v122, 0, v122
    v_and_b32 v123, 1, v121
    v_xor_b32 v123, v123, v122
    v_lshlrev_b32 v4, 7, v123
    v_bfe_u32 v123, v120, 3, 1
    v_lshl_add_u32 v4, v123, 6, v4
    v_xor_b32 v123, v120, v122
    v_and_b32 v123, 3, v123
    v_lshl_add_u32 v4, v123, 4, v4
    v_bfe_u32 v123, v120, 2, 1
    v_lshl_add_u32 v4, v123, 3, v4
    v_add_u32 v4, 147456, v4
    v_lshlrev_b32 v122, 1, v121
    v_add_u32 v122, 1, v122
    v_and_b32 v123, 1, v121
    v_xor_b32 v123, v123, v122
    v_lshlrev_b32 v5, 7, v123
    v_bfe_u32 v123, v120, 3, 1
    v_lshl_add_u32 v5, v123, 6, v5
    v_xor_b32 v123, v120, v122
    v_and_b32 v123, 3, v123
    v_lshl_add_u32 v5, v123, 4, v5
    v_bfe_u32 v123, v120, 2, 1
    v_lshl_add_u32 v5, v123, 3, v5
    v_add_u32 v5, 147456, v5
    v_lshrrev_b32 v122, 1, v121
    v_lshlrev_b32 v6, 8, v122
    v_and_b32 v122, 7, v120
    v_lshl_add_u32 v6, v122, 4, v6
    v_and_b32 v122, 1, v121
    v_lshl_add_u32 v6, v122, 3, v6
    v_and_b32 v122, 8, v120
    v_lshl_add_u32 v6, v122, 8, v6
    s_lshl_b32 s56, s46, 9
    s_add_u32 s56, s56, 151552
    v_add_u32 v6, s56, v6
    v_lshrrev_b32 v122, 1, v121
    v_lshlrev_b32 v7, 13, v122
    v_and_b32 v122, 1, v121
    v_lshl_add_u32 v7, v122, 7, v7
    v_bfe_u32 v122, v120, 3, 1
    v_lshl_add_u32 v7, v122, 6, v7
    v_and_b32 v122, 3, v120
    v_lshl_add_u32 v7, v122, 4, v7
    v_bfe_u32 v122, v120, 2, 1
    v_lshl_add_u32 v7, v122, 3, v7
    s_lshl_b32 s56, s46, 14
    s_lshl_b32 s57, s47, 8
    s_add_u32 s56, s56, s57
    v_add_u32 v7, s56, v7
    v_and_b32 v122, 1, v121
    v_lshlrev_b32 v8, 8, v122
    v_lshrrev_b32 v122, 1, v121
    v_lshl_add_u32 v8, v122, 6, v8
    v_and_b32 v122, 3, v120
    v_lshl_add_u32 v8, v122, 4, v8
    v_bfe_u32 v122, v120, 2, 1
    v_lshl_add_u32 v8, v122, 3, v8
    v_and_b32 v122, 8, v120
    v_lshl_add_u32 v8, v122, 28, v8
    s_lshr_b32 s56, s47, 1
    s_lshl_b32 s56, s56, 9
    s_and_b32 s57, s47, 1
    s_lshl_b32 s57, s57, 7
    s_add_u32 s56, s56, s57
    v_add_u32 v8, s56, v8
    s_lshl_b32 s56, s46, 15
    v_add_u32 v9, s56, v0
    v_add_u32 v10, 131072, v0
    v_and_b32 v120, 15, v1
    v_and_b32 v121, 1, v1
    v_lshlrev_b32 v121, 4, v121
    v_mov_b32 v122, 0x3f80
    v_lshlrev_b32 v122, v121, v122
    v_lshrrev_b32 v120, 1, v120
    v_cmp_eq_u32 vcc, 0, v120
    s_nop 1
    v_cndmask_b32 v12, 0, v122, vcc
    v_cmp_eq_u32 vcc, 1, v120
    s_nop 1
    v_cndmask_b32 v13, 0, v122, vcc
    v_cmp_eq_u32 vcc, 2, v120
    s_nop 1
    v_cndmask_b32 v14, 0, v122, vcc
    v_cmp_eq_u32 vcc, 3, v120
    s_nop 1
    v_cndmask_b32 v15, 0, v122, vcc
    v_cmp_gt_u32 vcc, 32, v1
    v_mov_b32 v17, 0xf149f2ca
    s_nop 0
    v_cndmask_b32 v16, 0, v17, vcc
    v_mov_b32 v17, v16
    v_mov_b32 v18, v16
    v_mov_b32 v19, v16
    v_mov_b32 v20, 0x3f803f80
    v_mov_b32 v21, 0x3f803f80
    v_mov_b32 v22, 0x3f803f80
    v_mov_b32 v23, 0x3f803f80
    s_mov_b32 s51, 0
    s_mov_b32 s64, 11534336
    s_mov_b32 s65, 14680064
    s_lshl_b32 s68, s47, 13
    s_lshl_b32 s56, s46, 10
    s_add_u32 s68, s68, s56
    s_add_u32 s68, s68, 41943040
    s_lshl_b32 s56, s51, 5
    s_add_u32 s56, s56, s47
    s_mul_i32 s56, s56, 24576
    s_mul_i32 s57, s52, 50331648
    s_add_u32 s56, s56, s57
    s_add_u32 s56, s56, 100663296
    s_lshl_b32 s57, s46, 11
    s_add_u32 s67, s56, s57
    s_lshl_b32 s56, s46, 11
    s_add_u32 m0, s56, 131072
    s_add_u32 s57, s67, 8192
    buffer_load_dwordx4 v0, s[8:11], s67 offen sc1 lds
    buffer_load_dwordx4 v0, s[8:11], s67 offen offset:1024 sc1 lds
    s_add_u32 m0, s56, 139264
    s_add_u32 s67, s67, 786432
    buffer_load_dwordx4 v0, s[8:11], s57 offen sc1 lds
    buffer_load_dwordx4 v0, s[8:11], s57 offen offset:1024 sc1 lds
L_chain_9:
    s_waitcnt vmcnt(0)
    s_barrier
    ds_read_b128 v[56:59], v10 offset:0
    ds_read_b128 v[60:63], v10 offset:1024
    ds_read_b128 v[64:67], v10 offset:2048
    ds_read_b128 v[68:71], v10 offset:3072
    ds_read_b128 v[72:75], v10 offset:4096
    ds_read_b128 v[76:79], v10 offset:5120
    ds_read_b128 v[80:83], v10 offset:6144
    ds_read_b128 v[84:87], v10 offset:7168
    s_lshl_b32 s56, s46, 11
    v_add_u32 v120, s56, v10
    ds_read_b128 v[88:91], v120 offset:8192
    ds_read_b128 v[92:95], v120 offset:9216
    v_mov_b32 v96, 0
    v_mov_b32 v97, 0
    v_mov_b32 v98, 0
    v_mov_b32 v99, 0
    v_mov_b32 v100, 0
    v_mov_b32 v101, 0
    v_mov_b32 v102, 0
    v_mov_b32 v103, 0
    v_mov_b32 v104, 0
    v_mov_b32 v105, 0
    v_mov_b32 v106, 0
    v_mov_b32 v107, 0
    v_mov_b32 v108, 0
    v_mov_b32 v109, 0
    v_mov_b32 v110, 0
    v_mov_b32 v111, 0
    v_mov_b32 v112, 0
    v_mov_b32 v113, 0
    v_mov_b32 v114, 0
    v_mov_b32 v115, 0
    v_mov_b32 v116, 0
    v_mov_b32 v117, 0
    v_mov_b32 v118, 0
    v_mov_b32 v119, 0
    s_add_u32 s56, s64, 4096
L_cpoll_10:
    buffer_load_dwordx4 v[24:27], v0, s[8:11], s64 offen offset:0 sc1
    buffer_load_dwordx4 v[28:31], v0, s[8:11], s64 offen offset:1024 sc1
    buffer_load_dwordx4 v[32:35], v0, s[8:11], s64 offen offset:2048 sc1
    buffer_load_dwordx4 v[36:39], v0, s[8:11], s64 offen offset:3072 sc1
    buffer_load_dwordx4 v[40:43], v0, s[8:11], s56 offen offset:0 sc1
    buffer_load_dwordx4 v[44:47], v0, s[8:11], s56 offen offset:1024 sc1
    buffer_load_dwordx4 v[48:51], v0, s[8:11], s56 offen offset:2048 sc1
    buffer_load_dwordx4 v[52:55], v0, s[8:11], s56 offen offset:3072 sc1
    s_waitcnt vmcnt(0)
    v_max_u32 v120, v24, v26
    v_max3_u32 v120, v28, v30, v120
    v_max3_u32 v120, v32, v34, v120
    v_max3_u32 v120, v36, v38, v120
    v_max3_u32 v120, v40, v42, v120
    v_max3_u32 v120, v44, v46, v120
    v_max3_u32 v120, v48, v50, v120
    v_max3_u32 v120, v52, v54, v120
    v_cmp_eq_u32 vcc, -1, v120
    s_cbranch_vccnz L_cpb_14
    v_smfmac_f32_16x16x64_bf16 v[96:99], v[24:27], a[0:7], v2
    v_smfmac_f32_16x16x64_bf16 v[100:103], v[24:27], a[128:135], v2
    v_smfmac_f32_16x16x64_bf16 v[104:107], v[24:27], a[8:15], v2
    v_smfmac_f32_16x16x64_bf16 v[108:111], v[24:27], a[136:143], v2
    v_smfmac_f32_16x16x64_bf16 v[96:99], v[28:31], a[16:23], v2
    v_smfmac_f32_16x16x64_bf16 v[100:103], v[28:31], a[144:151], v2
    v_smfmac_f32_16x16x64_bf16 v[104:107], v[28:31], a[24:31], v2
    v_smfmac_f32_16x16x64_bf16 v[108:111], v[28:31], a[152:159], v2
    v_smfmac_f32_16x16x64_bf16 v[96:99], v[32:35], a[32:39], v2
    v_smfmac_f32_16x16x64_bf16 v[100:103], v[32:35], a[160:167], v2
    v_smfmac_f32_16x16x64_bf16 v[104:107], v[32:35], a[40:47], v2
    v_smfmac_f32_16x16x64_bf16 v[108:111], v[32:35], a[168:175], v2
    v_smfmac_f32_16x16x64_bf16 v[96:99], v[36:39], a[48:55], v2
    v_smfmac_f32_16x16x64_bf16 v[100:103], v[36:39], a[176:183], v2
    v_smfmac_f32_16x16x64_bf16 v[104:107], v[36:39], a[56:63], v2
    v_smfmac_f32_16x16x64_bf16 v[108:111], v[36:39], a[184:191], v2
    v_smfmac_f32_16x16x64_bf16 v[96:99], v[40:43], a[64:71], v2
    v_smfmac_f32_16x16x64_bf16 v[100:103], v[40:43], a[192:199], v2
    v_smfmac_f32_16x16x64_bf16 v[104:107], v[40:43], a[72:79], v2
    v_smfmac_f32_16x16x64_bf16 v[108:111], v[40:43], a[200:207], v2
    v_smfmac_f32_16x16x64_bf16 v[96:99], v[44:47], a[80:87], v2
    v_smfmac_f32_16x16x64_bf16 v[100:103], v[44:47], a[208:215], v2
    v_smfmac_f32_16x16x64_bf16 v[104:107], v[44:47], a[88:95], v2
    v_smfmac_f32_16x16x64_bf16 v[108:111], v[44:47], a[216:223], v2
    v_smfmac_f32_16x16x64_bf16 v[96:99], v[48:51], a[96:103], v2
    v_smfmac_f32_16x16x64_bf16 v[100:103], v[48:51], a[224:231], v2
    v_smfmac_f32_16x16x64_bf16 v[104:107], v[48:51], a[104:111], v2
    v_smfmac_f32_16x16x64_bf16 v[108:111], v[48:51], a[232:239], v2
    v_smfmac_f32_16x16x64_bf16 v[96:99], v[52:55], a[112:119], v2
    v_smfmac_f32_16x16x64_bf16 v[100:103], v[52:55], a[240:247], v2
    v_smfmac_f32_16x16x64_bf16 v[104:107], v[52:55], a[120:127], v2
    v_smfmac_f32_16x16x64_bf16 v[108:111], v[52:55], a[248:255], v2
    v_smfmac_f32_16x16x64_bf16 v[112:115], v[24:27], v[128:135], v2
    v_smfmac_f32_16x16x64_bf16 v[116:119], v[24:27], v[136:143], v2
    v_permlane32_swap_b32 v96, v100
    v_permlane32_swap_b32 v97, v101
    v_permlane32_swap_b32 v98, v102
    v_permlane32_swap_b32 v99, v103
    v_pk_add_f32 v[96:97], v[96:97], v[100:101]
    v_pk_add_f32 v[98:99], v[98:99], v[102:103]
    v_cvt_pk_bf16_f32 v120, v96, v97
    v_cvt_pk_bf16_f32 v121, v98, v99
    v_permlane32_swap_b32 v104, v108
    v_permlane32_swap_b32 v105, v109
    v_permlane32_swap_b32 v106, v110
    v_permlane32_swap_b32 v107, v111
    v_pk_add_f32 v[104:105], v[104:105], v[108:109]
    v_pk_add_f32 v[106:107], v[106:107], v[110:111]
    v_cvt_pk_bf16_f32 v122, v104, v105
    v_cvt_pk_bf16_f32 v123, v106, v107
    ds_write_b128 v3, v[120:123]
    v_smfmac_f32_16x16x64_bf16 v[112:115], v[28:31], v[144:151], v2
    v_smfmac_f32_16x16x64_bf16 v[116:119], v[28:31], v[152:159], v2
    v_smfmac_f32_16x16x64_bf16 v[112:115], v[32:35], v[160:167], v2
    v_smfmac_f32_16x16x64_bf16 v[116:119], v[32:35], v[168:175], v2
    s_waitcnt lgkmcnt(0)
    s_barrier
    ds_read_b64_tr_b16 v[96:97], v4 offset:0
    ds_read_b64_tr_b16 v[98:99], v5 offset:0
    ds_read_b64_tr_b16 v[100:101], v4 offset:1024
    ds_read_b64_tr_b16 v[102:103], v5 offset:1024
    ds_read_b64_tr_b16 v[104:105], v4 offset:2048
    ds_read_b64_tr_b16 v[106:107], v5 offset:2048
    ds_read_b64_tr_b16 v[108:109], v4 offset:3072
    ds_read_b64_tr_b16 v[110:111], v5 offset:3072
    v_smfmac_f32_16x16x64_bf16 v[112:115], v[36:39], v[176:183], v2
    v_smfmac_f32_16x16x64_bf16 v[116:119], v[36:39], v[184:191], v2
    v_smfmac_f32_16x16x64_bf16 v[112:115], v[40:43], v[192:199], v2
    v_smfmac_f32_16x16x64_bf16 v[116:119], v[40:43], v[200:207], v2
    s_waitcnt lgkmcnt(6)
    v_mfma_f32_16x16x32_bf16 v[24:27], v[56:59], v[96:99], 0
    v_mfma_f32_16x16x32_bf16 v[28:31], v[72:75], v[96:99], 0
    v_mfma_f32_16x16x32_bf16 v[32:35], v[96:99], v[96:99], v[16:19]
    s_waitcnt lgkmcnt(4)
    v_mfma_f32_16x16x32_bf16 v[24:27], v[60:63], v[100:103], v[24:27]
    v_mfma_f32_16x16x32_bf16 v[28:31], v[76:79], v[100:103], v[28:31]
    v_mfma_f32_16x16x32_bf16 v[32:35], v[100:103], v[100:103], v[32:35]
    s_waitcnt lgkmcnt(2)
    v_mfma_f32_16x16x32_bf16 v[24:27], v[64:67], v[104:107], v[24:27]
    v_mfma_f32_16x16x32_bf16 v[28:31], v[80:83], v[104:107], v[28:31]
    v_mfma_f32_16x16x32_bf16 v[32:35], v[104:107], v[104:107], v[32:35]
    s_waitcnt lgkmcnt(0)
    v_mfma_f32_16x16x32_bf16 v[24:27], v[68:71], v[108:111], v[24:27]
    v_mfma_f32_16x16x32_bf16 v[28:31], v[84:87], v[108:111], v[28:31]
    v_mfma_f32_16x16x32_bf16 v[32:35], v[108:111], v[108:111], v[32:35]
    v_smfmac_f32_16x16x64_bf16 v[112:115], v[44:47], v[208:215], v2
    v_smfmac_f32_16x16x64_bf16 v[116:119], v[44:47], v[216:223], v2
    v_smfmac_f32_16x16x64_bf16 v[112:115], v[48:51], v[224:231], v2
    v_smfmac_f32_16x16x64_bf16 v[116:119], v[48:51], v[232:239], v2
    v_smfmac_f32_16x16x64_bf16 v[112:115], v[52:55], v[240:247], v2
    v_smfmac_f32_16x16x64_bf16 v[116:119], v[52:55], v[248:255], v2
    s_xor_b32 s69, s65, 262144
    s_lshl_b32 s56, s47, 13
    s_add_u32 s69, s69, s56
    s_add_u32 s66, s65, s56
    s_lshl_b32 s56, s46, 11
    s_add_u32 s69, s69, s56
    v_mov_b32 v120, -1
    v_mov_b32 v121, -1
    v_mov_b32 v122, -1
    v_mov_b32 v123, -1
    buffer_store_dwordx4 v[120:123], v0, s[8:11], s69 offen
    buffer_store_dwordx4 v[120:123], v0, s[8:11], s69 offen offset:1024
    s_lshl_b32 s56, s46, 11
    s_add_u32 m0, s56, 131072
    s_add_u32 s57, s67, 8192
    buffer_load_dwordx4 v0, s[8:11], s67 offen sc1 lds
    buffer_load_dwordx4 v0, s[8:11], s67 offen offset:1024 sc1 lds
    s_add_u32 m0, s56, 139264
    s_add_u32 s67, s67, 786432
    buffer_load_dwordx4 v0, s[8:11], s57 offen sc1 lds
    buffer_load_dwordx4 v0, s[8:11], s57 offen offset:1024 sc1 lds
    ds_read_b128 v[56:59], v9 offset:0
    ds_read_b128 v[60:63], v9 offset:1024
    ds_read_b128 v[64:67], v9 offset:2048
    ds_read_b128 v[68:71], v9 offset:3072
    ds_read_b128 v[72:75], v9 offset:4096
    ds_read_b128 v[76:79], v9 offset:5120
    ds_read_b128 v[80:83], v9 offset:6144
    ds_read_b128 v[84:87], v9 offset:7168
    v_max3_f32 v36, v24, v25, v26
    v_max3_f32 v37, v27, v28, v29
    v_max3_f32 v36, v30, v31, v36
    v_max3_f32 v37, v32, v33, v37
    v_max3_f32 v36, v34, v35, v36
    v_max_f32 v36, v36, v37
    v_mov_b32 v37, v36
    s_nop 1
    v_permlane16_swap_b32 v36, v37
    v_max_f32 v36, v36, v37
    v_mov_b32 v37, v36
    s_nop 1
    v_permlane32_swap_b32 v36, v37
    v_max_f32 v36, v36, v37
    v_mul_f32 v36, s80, v36
    v_fma_f32 v32, v32, s80, -v36
    v_fma_f32 v33, v33, s80, -v36
    v_exp_f32 v32, v32
    v_fma_f32 v34, v34, s80, -v36
    v_exp_f32 v33, v33
    v_fma_f32 v35, v35, s80, -v36
    v_exp_f32 v34, v34
    v_fma_f32 v24, v24, s80, -v36
    v_exp_f32 v35, v35
    v_fma_f32 v25, v25, s80, -v36
    v_exp_f32 v24, v24
    v_cvt_pk_bf16_f32 v124, v32, v33
    v_cvt_pk_bf16_f32 v125, v34, v35
    v_cvt_pk_bf16_f32 v126, v32, v33
    v_cvt_pk_bf16_f32 v127, v34, v35
    v_fma_f32 v26, v26, s80, -v36
    v_exp_f32 v25, v25
    v_fma_f32 v27, v27, s80, -v36
    v_exp_f32 v26, v26
    v_permlane32_swap_b32 v126, v124
    v_permlane32_swap_b32 v127, v125
    v_fma_f32 v28, v28, s80, -v36
    v_exp_f32 v27, v27
    v_fma_f32 v29, v29, s80, -v36
    v_exp_f32 v28, v28
    v_fma_f32 v30, v30, s80, -v36
    v_exp_f32 v29, v29
    v_fma_f32 v31, v31, s80, -v36
    v_exp_f32 v30, v30
    v_exp_f32 v31, v31
    v_cvt_pk_bf16_f32 v120, v24, v25
    v_cvt_pk_bf16_f32 v121, v26, v27
    v_cvt_pk_bf16_f32 v122, v28, v29
    v_cvt_pk_bf16_f32 v123, v30, v31
    v_cvt_pk_bf16_f32 v36, v112, v113
    v_cvt_pk_bf16_f32 v37, v114, v115
    v_cvt_pk_bf16_f32 v38, v116, v117
    v_cvt_pk_bf16_f32 v39, v118, v119
    v_mov_b32 v126, 0x3f003f00
    v_mov_b32 v127, 0x3f003f00
    v_mfma_f32_16x16x32_bf16 v[32:35], v[20:23], v[120:123], 0
    v_mfma_f32_16x16x32_bf16 v[24:27], v[88:91], v[120:123], 0
    v_mfma_f32_16x16x32_bf16 v[28:31], v[92:95], v[120:123], 0
    v_mfma_f32_16x16x16_bf16 v[32:35], v[126:127], v[124:125], v[32:35]
    v_mfma_f32_16x16x16_bf16 v[24:27], v[36:37], v[124:125], v[24:27]
    v_mfma_f32_16x16x16_bf16 v[28:31], v[38:39], v[124:125], v[28:31]
    s_add_u32 s56, s68, 4096
    buffer_store_dwordx4 v[36:39], v0, s[8:11], s56 offen sc1
    v_rcp_f32 v32, v32
    s_nop 0
    v_mov_b32 v33, v32
    v_pk_mul_f32 v[24:25], v[24:25], v[32:33]
    v_pk_mul_f32 v[26:27], v[26:27], v[32:33]
    v_cvt_pk_bf16_f32 v120, v24, v25
    v_cvt_pk_bf16_f32 v121, v26, v27
    v_pk_mul_f32 v[28:29], v[28:29], v[32:33]
    v_pk_mul_f32 v[30:31], v[30:31], v[32:33]
    v_cvt_pk_bf16_f32 v122, v28, v29
    v_cvt_pk_bf16_f32 v123, v30, v31
    ds_write2_b64 v6, v[120:121], v[122:123] offset0:0 offset1:16
    s_lshl_b32 s56, s46, 10
    v_add_u32 v124, s56, v4
    v_add_u32 v125, s56, v5
    ds_read_b64_tr_b16 v[88:89], v124
    ds_read_b64_tr_b16 v[90:91], v125
    v_mov_b32 v112, 0
    v_mov_b32 v113, 0
    v_mov_b32 v114, 0
    v_mov_b32 v115, 0
    v_mov_b32 v116, 0
    v_mov_b32 v117, 0
    v_mov_b32 v118, 0
    v_mov_b32 v119, 0
    v_mov_b32 v24, 0
    v_mov_b32 v25, 0
    v_mov_b32 v26, 0
    v_mov_b32 v27, 0
    v_mov_b32 v28, 0
    v_mov_b32 v29, 0
    v_mov_b32 v30, 0
    v_mov_b32 v31, 0
    s_waitcnt lgkmcnt(0) vmcnt(5)
    s_barrier
    ds_read_b128 v[120:123], v10 offset:20480
    ds_read_b128 v[124:127], v10 offset:21504
    buffer_store_dwordx4 v[88:91], v0, s[8:11], s68 offen sc1
    s_cmp_eq_u32 s51, 63
    s_cbranch_scc1 L_cend_11
    ds_read_b128 v[96:99], v9 offset:8192
    ds_read_b128 v[100:103], v9 offset:9216
    ds_read_b128 v[104:107], v9 offset:10240
    ds_read_b128 v[108:111], v9 offset:11264
    ds_read_b128 v[40:43], v9 offset:12288
    ds_read_b128 v[44:47], v9 offset:13312
    ds_read_b128 v[48:51], v9 offset:14336
    ds_read_b128 v[52:55], v9 offset:15360
    v_mov_b32 v32, 0
    v_mov_b32 v33, 0
    v_mov_b32 v34, 0
    v_mov_b32 v35, 0
    v_mov_b32 v36, 0
    v_mov_b32 v37, 0
    v_mov_b32 v38, 0
    v_mov_b32 v39, 0
    v_mov_b32 v88, 0
    v_mov_b32 v89, 0
    v_mov_b32 v90, 0
    v_mov_b32 v91, 0
    v_mov_b32 v92, 0
    v_mov_b32 v93, 0
    v_mov_b32 v94, 0
    v_mov_b32 v95, 0
    s_waitcnt lgkmcnt(8)
    v_smfmac_f32_16x16x64_bf16 v[112:115], v[120:123], v[56:63], v2
    v_smfmac_f32_16x16x64_bf16 v[116:119], v[120:123], v[72:79], v2
    v_smfmac_f32_16x16x64_bf16 v[112:115], v[124:127], v[64:71], v2
    v_smfmac_f32_16x16x64_bf16 v[116:119], v[124:127], v[80:87], v2
    ds_read_b128 v[56:59], v9 offset:16384
    ds_read_b128 v[60:63], v9 offset:17408
    ds_read_b128 v[64:67], v9 offset:18432
    ds_read_b128 v[68:71], v9 offset:19456
    ds_read_b128 v[72:75], v9 offset:20480
    ds_read_b128 v[76:79], v9 offset:21504
    ds_read_b128 v[80:83], v9 offset:22528
    ds_read_b128 v[84:87], v9 offset:23552
    s_waitcnt lgkmcnt(8)
    v_smfmac_f32_16x16x64_bf16 v[24:27], v[120:123], v[96:103], v2
    v_smfmac_f32_16x16x64_bf16 v[28:31], v[120:123], v[40:47], v2
    v_smfmac_f32_16x16x64_bf16 v[24:27], v[124:127], v[104:111], v2
    v_smfmac_f32_16x16x64_bf16 v[28:31], v[124:127], v[48:55], v2
    v_permlane32_swap_b32 v112, v116
    v_permlane32_swap_b32 v113, v117
    v_permlane32_swap_b32 v114, v118
    v_permlane32_swap_b32 v115, v119
    v_pk_add_f32 v[112:113], v[112:113], v[116:117]
    v_pk_add_f32 v[114:115], v[114:115], v[118:119]
    v_cvt_pk_bf16_f32 v112, v112, v113
    v_cvt_pk_bf16_f32 v113, v114, v115
    s_add_u32 s56, s65, 0
    buffer_store_dwordx2 v[112:113], v7, s[8:11], s56 offen
    ds_read_b128 v[96:99], v9 offset:24576
    ds_read_b128 v[100:103], v9 offset:25600
    ds_read_b128 v[104:107], v9 offset:26624
    ds_read_b128 v[108:111], v9 offset:27648
    ds_read_b128 v[40:43], v9 offset:28672
    ds_read_b128 v[44:47], v9 offset:29696
    ds_read_b128 v[48:51], v9 offset:30720
    ds_read_b128 v[52:55], v9 offset:31744
    s_waitcnt lgkmcnt(8)
    v_smfmac_f32_16x16x64_bf16 v[32:35], v[120:123], v[56:63], v2
    v_smfmac_f32_16x16x64_bf16 v[36:39], v[120:123], v[72:79], v2
    v_smfmac_f32_16x16x64_bf16 v[32:35], v[124:127], v[64:71], v2
    v_smfmac_f32_16x16x64_bf16 v[36:39], v[124:127], v[80:87], v2
    v_permlane32_swap_b32 v24, v28
    v_permlane32_swap_b32 v25, v29
    v_permlane32_swap_b32 v26, v30
    v_permlane32_swap_b32 v27, v31
    v_pk_add_f32 v[24:25], v[24:25], v[28:29]
    v_pk_add_f32 v[26:27], v[26:27], v[30:31]
    v_cvt_pk_bf16_f32 v24, v24, v25
    v_cvt_pk_bf16_f32 v25, v26, v27
    s_add_u32 s56, s65, 65536
    buffer_store_dwordx2 v[24:25], v7, s[8:11], s56 offen
    s_waitcnt lgkmcnt(0)
    v_smfmac_f32_16x16x64_bf16 v[88:91], v[120:123], v[96:103], v2
    v_smfmac_f32_16x16x64_bf16 v[92:95], v[120:123], v[40:47], v2
    v_smfmac_f32_16x16x64_bf16 v[88:91], v[124:127], v[104:111], v2
    v_smfmac_f32_16x16x64_bf16 v[92:95], v[124:127], v[48:55], v2
    v_permlane32_swap_b32 v32, v36
    v_permlane32_swap_b32 v33, v37
    v_permlane32_swap_b32 v34, v38
    v_permlane32_swap_b32 v35, v39
    v_pk_add_f32 v[32:33], v[32:33], v[36:37]
    v_pk_add_f32 v[34:35], v[34:35], v[38:39]
    v_cvt_pk_bf16_f32 v32, v32, v33
    v_cvt_pk_bf16_f32 v33, v34, v35
    s_add_u32 s56, s65, 131072
    buffer_store_dwordx2 v[32:33], v7, s[8:11], s56 offen
    v_permlane32_swap_b32 v88, v92
    v_permlane32_swap_b32 v89, v93
    v_permlane32_swap_b32 v90, v94
    v_permlane32_swap_b32 v91, v95
    v_pk_add_f32 v[88:89], v[88:89], v[92:93]
    v_pk_add_f32 v[90:91], v[90:91], v[94:95]
    v_cvt_pk_bf16_f32 v88, v88, v89
    v_cvt_pk_bf16_f32 v89, v90, v91
    s_add_u32 s56, s65, 196608
    buffer_store_dwordx2 v[88:89], v7, s[8:11], s56 offen
    s_add_u32 s64, s64, 8192
    s_add_u32 s68, s68, 262144
    s_add_u32 s51, s51, 1
    s_xor_b32 s65, s65, 262144
    s_cmp_lg_u32 s46, 0
    s_cbranch_scc1 L_cnr_13
    s_add_u32 s56, s66, 4096
L_crp_12:
    buffer_load_dwordx4 v[56:59], v0, s[8:11], s66 offen offset:0 sc1
    buffer_load_dwordx4 v[60:63], v0, s[8:11], s66 offen offset:1024 sc1
    buffer_load_dwordx4 v[64:67], v0, s[8:11], s66 offen offset:2048 sc1
    buffer_load_dwordx4 v[68:71], v0, s[8:11], s66 offen offset:3072 sc1
    buffer_load_dwordx4 v[72:75], v0, s[8:11], s56 offen offset:0 sc1
    buffer_load_dwordx4 v[76:79], v0, s[8:11], s56 offen offset:1024 sc1
    buffer_load_dwordx4 v[80:83], v0, s[8:11], s56 offen offset:2048 sc1
    buffer_load_dwordx4 v[84:87], v0, s[8:11], s56 offen offset:3072 sc1
    s_waitcnt vmcnt(7)
    v_mfma_f32_16x16x32_bf16 v[120:123], v[56:59], v[12:15], 0
    s_waitcnt vmcnt(6)
    v_mfma_f32_16x16x32_bf16 v[120:123], v[60:63], v[12:15], v[120:123]
    s_waitcnt vmcnt(5)
    v_mfma_f32_16x16x32_bf16 v[120:123], v[64:67], v[12:15], v[120:123]
    s_waitcnt vmcnt(4)
    v_mfma_f32_16x16x32_bf16 v[120:123], v[68:71], v[12:15], v[120:123]
    s_waitcnt vmcnt(3)
    v_mfma_f32_16x16x32_bf16 v[120:123], v[72:75], v[12:15], v[120:123]
    s_waitcnt vmcnt(2)
    v_mfma_f32_16x16x32_bf16 v[120:123], v[76:79], v[12:15], v[120:123]
    s_waitcnt vmcnt(1)
    v_mfma_f32_16x16x32_bf16 v[120:123], v[80:83], v[12:15], v[120:123]
    s_waitcnt vmcnt(0)
    v_mfma_f32_16x16x32_bf16 v[120:123], v[84:87], v[12:15], v[120:123]
    s_nop 7
    v_cvt_pk_bf16_f32 v124, v120, v121
    v_cvt_pk_bf16_f32 v125, v122, v123
    v_add_f32 v120, v120, v121
    v_add_f32 v122, v122, v123
    v_cmp_u_f32 vcc, v120, v122
    s_cbranch_vccnz L_crb_15
    buffer_store_dwordx2 v[124:125], v8, s[8:11], s64 offen
L_cnr_13:
    s_branch L_chain_9
L_cpb_14:
    s_sub_u32 s49, s49, 1
    s_cmp_gt_i32 s49, 0
    s_cbranch_scc1 L_cpoll_10
    s_branch L_abort
L_crb_15:
    s_sub_u32 s49, s49, 1
    s_cmp_gt_i32 s49, 0
    s_cbranch_scc1 L_crp_12
    s_branch L_abort
L_cend_11:
    s_nop 11
L_nc_8:
    s_waitcnt vmcnt(0) lgkmcnt(0)
    s_barrier
    s_add_u32 s50, s50, 256
    s_cmp_lg_u32 s46, 0
    s_cbranch_scc1 L_gbd_17
    v_mov_b32 v124, 128
    v_mov_b32 v125, 1
    s_mov_b64 exec, 1
    buffer_atomic_add v125, v124, s[12:15], 0 offen
    s_mov_b64 exec, -1
L_gb_16:
    buffer_load_dword v125, v124, s[12:15], 0 offen sc1
    s_waitcnt vmcnt(0)
    v_readfirstlane_b32 s56, v125
    s_cmp_ge_u32 s56, s50
    s_cbranch_scc1 L_gbd_17
    s_sleep 4
    s_sub_u32 s49, s49, 1
    s_cmp_gt_i32 s49, 0
    s_cbranch_scc1 L_gb_16
    s_branch L_abort
L_gbd_17:
    s_barrier
    v_cmp_gt_u32 vcc, 32, v1
    v_mov_b32 v5, 0xf149f2ca
    s_nop 0
    v_cndmask_b32 v4, 0, v5, vcc
    v_mov_b32 v5, v4
    v_mov_b32 v6, v4
    v_mov_b32 v7, v4
    v_and_b32 v120, 15, v1
    v_lshrrev_b32 v121, 4, v1
    v_lshlrev_b32 v122, 2, v121
    v_mov_b32 v123, 0xf149f2ca
    s_and_b32 s56, s46, 1
    s_lshl_b32 s56, s56, 4
    v_add_u32 v124, s56, v120
    v_add_u32 v125, 0, v122
    v_cmp_gt_u32 vcc, v125, v124
    s_nop 1
    v_cndmask_b32 v8, 0, v123, vcc
    v_add_u32 v125, 1, v122
    v_cmp_gt_u32 vcc, v125, v124
    s_nop 1
    v_cndmask_b32 v9, 0, v123, vcc
    v_add_u32 v125, 2, v122
    v_cmp_gt_u32 vcc, v125, v124
    s_nop 1
    v_cndmask_b32 v10, 0, v123, vcc
    v_add_u32 v125, 3, v122
    v_cmp_gt_u32 vcc, v125, v124
    s_nop 1
    v_cndmask_b32 v11, 0, v123, vcc
    v_add_u32 v125, 16, v122
    v_cmp_gt_u32 vcc, v125, v124
    s_nop 1
    v_cndmask_b32 v12, 0, v123, vcc
    v_add_u32 v125, 17, v122
    v_cmp_gt_u32 vcc, v125, v124
    s_nop 1
    v_cndmask_b32 v13, 0, v123, vcc
    v_add_u32 v125, 18, v122
    v_cmp_gt_u32 vcc, v125, v124
    s_nop 1
    v_cndmask_b32 v14, 0, v123, vcc
    v_add_u32 v125, 19, v122
    v_cmp_gt_u32 vcc, v125, v124
    s_nop 1
    v_cndmask_b32 v15, 0, v123, vcc
    s_and_b32 s56, s46, 1
    s_lshl_b32 s56, s56, 12
    s_lshr_b32 s57, s46, 1
    s_lshl_b32 s57, s57, 11
    s_add_u32 s56, s56, s57
    s_add_u32 s56, s56, 131072
    v_add_u32 v16, s56, v0
    v_add_u32 v17, 131072, v0
    s_lshl_b32 s56, s46, 15
    v_add_u32 v18, s56, v0
    v_lshlrev_b32 v19, 15, v120
    v_lshl_add_u32 v19, v121, 4, v19
    s_lshl_b32 s56, s46, 6
    v_add_u32 v19, s56, v19
    v_lshrrev_b32 v20, 2, v1
    v_lshlrev_b32 v20, 11, v20
    v_and_b32 v125, 3, v1
    v_lshl_add_u32 v20, v125, 8, v20
    v_lshlrev_b32 v21, 5, v120
    v_and_b32 v125, 1, v121
    v_lshl_add_u32 v21, v125, 4, v21
    v_lshrrev_b32 v125, 1, v121
    v_lshl_add_u32 v21, v125, 11, v21
    s_lshl_b32 s56, s46, 9
    s_add_u32 s56, s56, 139264
    v_add_u32 v21, s56, v21
    v_lshlrev_b32 v22, 4, v120
    v_lshl_add_u32 v22, v121, 10, v22
    s_lshl_b32 s56, s46, 8
    v_add_u32 v22, s56, v22
    s_mov_b32 s51, s48
    s_lshl_b32 s54, s48, 21
    s_add_u32 s54, s54, 20971520
    s_mov_b32 s55, 41943040
L_t2_18:
    s_lshl_b32 s56, s51, 5
    s_add_u32 s56, s56, s47
    s_mul_i32 s56, s56, 24576
    s_mul_i32 s57, s52, 50331648
    s_add_u32 s56, s56, s57
    s_add_u32 s56, s56, 100663296
    s_and_b32 s57, s46, 1
    s_lshl_b32 s57, s57, 12
    s_add_u32 s58, s56, s57
    s_add_u32 s58, s58, 16384
    s_add_u32 s59, s56, 4096
    s_lshr_b32 s57, s46, 1
    s_lshl_b32 s60, s57, 12
    s_add_u32 s60, s60, s56
    s_add_u32 s60, s60, 8192
    s_lshl_b32 s61, s51, 5
    s_add_u32 s61, s61, s47
    s_lshl_b32 s61, s61, 13
    s_add_u32 s61, s61, s55
    s_lshl_b32 s62, s57, 11
    s_add_u32 s62, s62, s61
    s_add_u32 s62, s62, 4096
    buffer_load_dwordx4 v[24:27], v0, s[8:11], s58 offen offset:0 sc1
    buffer_load_dwordx4 v[40:43], v0, s[8:11], s56 offen offset:0 sc1
    buffer_load_dwordx4 v[56:59], v0, s[8:11], s59 offen offset:0 sc1
    buffer_load_dwordx4 v[72:75], v0, s[8:11], s61 offen offset:0 sc1
    buffer_load_dwordx4 v[28:31], v0, s[8:11], s58 offen offset:1024 sc1
    buffer_load_dwordx4 v[44:47], v0, s[8:11], s56 offen offset:1024 sc1
    buffer_load_dwordx4 v[60:63], v0, s[8:11], s59 offen offset:1024 sc1
    buffer_load_dwordx4 v[76:79], v0, s[8:11], s61 offen offset:1024 sc1
    buffer_load_dwordx4 v[32:35], v0, s[8:11], s58 offen offset:2048 sc1
    buffer_load_dwordx4 v[48:51], v0, s[8:11], s56 offen offset:2048 sc1
    buffer_load_dwordx4 v[64:67], v0, s[8:11], s59 offen offset:2048 sc1
    buffer_load_dwordx4 v[80:83], v0, s[8:11], s61 offen offset:2048 sc1
    buffer_load_dwordx4 v[36:39], v0, s[8:11], s58 offen offset:3072 sc1
    buffer_load_dwordx4 v[52:55], v0, s[8:11], s56 offen offset:3072 sc1
    buffer_load_dwordx4 v[68:71], v0, s[8:11], s59 offen offset:3072 sc1
    buffer_load_dwordx4 v[84:87], v0, s[8:11], s61 offen offset:3072 sc1
    buffer_load_dwordx4 v[88:91], v0, s[8:11], s60 offen offset:0 sc1
    buffer_load_dwordx4 v[92:95], v0, s[8:11], s60 offen offset:1024 sc1
    buffer_load_dwordx4 v[96:99], v0, s[8:11], s60 offen offset:2048 sc1
    buffer_load_dwordx4 v[100:103], v0, s[8:11], s60 offen offset:3072 sc1
    buffer_load_dwordx4 v[104:107], v0, s[8:11], s62 offen offset:0 sc1
    buffer_load_dwordx4 v[108:111], v0, s[8:11], s62 offen offset:1024 sc1
    s_waitcnt vmcnt(18)
    v_mfma_f32_16x16x32_bf16 v[112:115], v[40:43], v[24:27], v[8:11]
    v_mfma_f32_16x16x32_bf16 v[116:119], v[56:59], v[24:27], v[12:15]
    v_mfma_f32_16x16x32_bf16 v[120:123], v[72:75], v[24:27], v[4:7]
    s_waitcnt vmcnt(14)
    v_mfma_f32_16x16x32_bf16 v[112:115], v[44:47], v[28:31], v[112:115]
    v_mfma_f32_16x16x32_bf16 v[116:119], v[60:63], v[28:31], v[116:119]
    v_mfma_f32_16x16x32_bf16 v[120:123], v[76:79], v[28:31], v[120:123]
    s_waitcnt vmcnt(10)
    v_mfma_f32_16x16x32_bf16 v[112:115], v[48:51], v[32:35], v[112:115]
    v_mfma_f32_16x16x32_bf16 v[116:119], v[64:67], v[32:35], v[116:119]
    v_mfma_f32_16x16x32_bf16 v[120:123], v[80:83], v[32:35], v[120:123]
    s_waitcnt vmcnt(6)
    v_mfma_f32_16x16x32_bf16 v[112:115], v[52:55], v[36:39], v[112:115]
    v_mfma_f32_16x16x32_bf16 v[116:119], v[68:71], v[36:39], v[116:119]
    v_mfma_f32_16x16x32_bf16 v[120:123], v[84:87], v[36:39], v[120:123]
    ds_read_b128 v[56:59], v18 offset:0
    ds_read_b128 v[60:63], v18 offset:4096
    ds_read_b128 v[64:67], v18 offset:1024
    ds_read_b128 v[68:71], v18 offset:5120
    ds_read_b128 v[72:75], v18 offset:2048
    ds_read_b128 v[76:79], v18 offset:6144
    ds_read_b128 v[80:83], v18 offset:3072
    ds_read_b128 v[84:87], v18 offset:7168
    v_max3_f32 v124, v112, v113, v114
    v_max3_f32 v125, v115, v116, v117
    v_max3_f32 v124, v118, v119, v124
    v_max3_f32 v125, v120, v121, v125
    v_max3_f32 v124, v122, v123, v124
    v_max_f32 v124, v124, v125
    v_mov_b32 v125, v124
    s_nop 1
    v_permlane16_swap_b32 v124, v125
    v_max_f32 v124, v124, v125
    v_mov_b32 v125, v124
    s_nop 1
    v_permlane32_swap_b32 v124, v125
    v_max_f32 v124, v124, v125
    v_mul_f32 v124, s80, v124
    v_fma_f32 v120, v120, s80, -v124
    v_fma_f32 v121, v121, s80, -v124
    v_exp_f32 v120, v120
    v_fma_f32 v122, v122, s80, -v124
    v_exp_f32 v121, v121
    v_fma_f32 v123, v123, s80, -v124
    v_exp_f32 v122, v122
    v_fma_f32 v112, v112, s80, -v124
    v_exp_f32 v123, v123
    v_fma_f32 v113, v113, s80, -v124
    v_exp_f32 v112, v112
    v_cvt_pk_bf16_f32 v48, v120, v121
    v_cvt_pk_bf16_f32 v49, v122, v123
    v_cvt_pk_bf16_f32 v50, v120, v121
    v_cvt_pk_bf16_f32 v51, v122, v123
    v_fma_f32 v114, v114, s80, -v124
    v_exp_f32 v113, v113
    v_fma_f32 v115, v115, s80, -v124
    v_exp_f32 v114, v114
    v_permlane32_swap_b32 v50, v48
    v_permlane32_swap_b32 v51, v49
    v_fma_f32 v116, v116, s80, -v124
    v_exp_f32 v115, v115
    v_fma_f32 v117, v117, s80, -v124
    v_exp_f32 v116, v116
    v_fma_f32 v118, v118, s80, -v124
    v_exp_f32 v117, v117
    v_fma_f32 v119, v119, s80, -v124
    v_exp_f32 v118, v118
    v_exp_f32 v119, v119
    v_cvt_pk_bf16_f32 v44, v112, v113
    v_cvt_pk_bf16_f32 v45, v114, v115
    v_cvt_pk_bf16_f32 v46, v116, v117
    v_cvt_pk_bf16_f32 v47, v118, v119
    v_mov_b32 v52, 0x3f803f80
    v_mov_b32 v53, 0x3f803f80
    v_mov_b32 v54, 0x3f803f80
    v_mov_b32 v55, 0x3f803f80
    v_mov_b32 v50, 0x3f003f00
    v_mov_b32 v51, 0x3f003f00
    s_waitcnt vmcnt(0)
    v_mfma_f32_16x16x32_bf16 v[40:43], v[52:55], v[44:47], 0
    v_mfma_f32_16x16x32_bf16 v[24:27], v[88:91], v[44:47], 0
    v_mfma_f32_16x16x32_bf16 v[28:31], v[92:95], v[44:47], 0
    v_mfma_f32_16x16x32_bf16 v[32:35], v[96:99], v[44:47], 0
    v_mfma_f32_16x16x32_bf16 v[36:39], v[100:103], v[44:47], 0
    v_mfma_f32_16x16x16_bf16 v[40:43], v[50:51], v[48:49], v[40:43]
    v_mfma_f32_16x16x16_bf16 v[24:27], v[104:105], v[48:49], v[24:27]
    v_mfma_f32_16x16x16_bf16 v[28:31], v[106:107], v[48:49], v[28:31]
    v_mfma_f32_16x16x16_bf16 v[32:35], v[108:109], v[48:49], v[32:35]
    v_mfma_f32_16x16x16_bf16 v[36:39], v[110:111], v[48:49], v[36:39]
    v_rcp_f32 v40, v40
    s_nop 0
    v_mov_b32 v41, v40
    v_pk_mul_f32 v[24:25], v[24:25], v[40:41]
    v_pk_mul_f32 v[26:27], v[26:27], v[40:41]
    v_pk_mul_f32 v[28:29], v[28:29], v[40:41]
    v_pk_mul_f32 v[30:31], v[30:31], v[40:41]
    v_cvt_pk_bf16_f32 v112, v24, v28
    v_cvt_pk_bf16_f32 v113, v25, v29
    v_cvt_pk_bf16_f32 v114, v26, v30
    v_cvt_pk_bf16_f32 v115, v27, v31
    ds_write_b128 v16, v[112:115] offset:0
    v_pk_mul_f32 v[32:33], v[32:33], v[40:41]
    v_pk_mul_f32 v[34:35], v[34:35], v[40:41]
    v_pk_mul_f32 v[36:37], v[36:37], v[40:41]
    v_pk_mul_f32 v[38:39], v[38:39], v[40:41]
    v_cvt_pk_bf16_f32 v116, v32, v36
    v_cvt_pk_bf16_f32 v117, v33, v37
    v_cvt_pk_bf16_f32 v118, v34, v38
    v_cvt_pk_bf16_f32 v119, v35, v39
    ds_write_b128 v16, v[116:119] offset:1024
    s_lshl_b32 s56, s47, 10
    s_add_u32 s56, s56, s54
    s_add_u32 s57, s56, 524288
    s_waitcnt lgkmcnt(0)
    s_barrier
    ds_read_b128 v[24:27], v17 offset:0
    ds_read_b128 v[28:31], v17 offset:4096
    ds_read_b128 v[32:35], v17 offset:1024
    ds_read_b128 v[36:39], v17 offset:5120
    ds_read_b128 v[40:43], v17 offset:2048
    ds_read_b128 v[44:47], v17 offset:6144
    ds_read_b128 v[48:51], v17 offset:3072
    ds_read_b128 v[52:55], v17 offset:7168
    s_waitcnt lgkmcnt(6)
    v_mfma_f32_16x16x32_bf16 v[88:91], v[56:59], v[24:27], 0
    v_mfma_f32_16x16x32_bf16 v[92:95], v[56:59], v[28:31], 0
    ds_read_b128 v[56:59], v18 offset:8192
    v_mfma_f32_16x16x32_bf16 v[96:99], v[60:63], v[24:27], 0
    v_mfma_f32_16x16x32_bf16 v[100:103], v[60:63], v[28:31], 0
    ds_read_b128 v[60:63], v18 offset:12288
    s_waitcnt lgkmcnt(6)
    v_mfma_f32_16x16x32_bf16 v[88:91], v[64:67], v[32:35], v[88:91]
    v_mfma_f32_16x16x32_bf16 v[92:95], v[64:67], v[36:39], v[92:95]
    ds_read_b128 v[64:67], v18 offset:9216
    v_mfma_f32_16x16x32_bf16 v[96:99], v[68:71], v[32:35], v[96:99]
    v_mfma_f32_16x16x32_bf16 v[100:103], v[68:71], v[36:39], v[100:103]
    ds_read_b128 v[68:71], v18 offset:13312
    s_waitcnt lgkmcnt(6)
    v_mfma_f32_16x16x32_bf16 v[88:91], v[72:75], v[40:43], v[88:91]
    v_mfma_f32_16x16x32_bf16 v[92:95], v[72:75], v[44:47], v[92:95]
    ds_read_b128 v[72:75], v18 offset:10240
    v_mfma_f32_16x16x32_bf16 v[96:99], v[76:79], v[40:43], v[96:99]
    v_mfma_f32_16x16x32_bf16 v[100:103], v[76:79], v[44:47], v[100:103]
    ds_read_b128 v[76:79], v18 offset:14336
    s_waitcnt lgkmcnt(6)
    v_mfma_f32_16x16x32_bf16 v[88:91], v[80:83], v[48:51], v[88:91]
    v_mfma_f32_16x16x32_bf16 v[92:95], v[80:83], v[52:55], v[92:95]
    ds_read_b128 v[80:83], v18 offset:11264
    v_mfma_f32_16x16x32_bf16 v[96:99], v[84:87], v[48:51], v[96:99]
    v_mfma_f32_16x16x32_bf16 v[100:103], v[84:87], v[52:55], v[100:103]
    ds_read_b128 v[84:87], v18 offset:15360
    s_waitcnt lgkmcnt(7)
    v_mfma_f32_16x16x32_bf16 v[104:107], v[56:59], v[24:27], 0
    v_mfma_f32_16x16x32_bf16 v[108:111], v[56:59], v[28:31], 0
    ds_read_b128 v[56:59], v18 offset:16384
    s_waitcnt lgkmcnt(7)
    v_mfma_f32_16x16x32_bf16 v[112:115], v[60:63], v[24:27], 0
    v_mfma_f32_16x16x32_bf16 v[116:119], v[60:63], v[28:31], 0
    ds_read_b128 v[60:63], v18 offset:20480
    s_waitcnt lgkmcnt(7)
    v_mfma_f32_16x16x32_bf16 v[104:107], v[64:67], v[32:35], v[104:107]
    v_mfma_f32_16x16x32_bf16 v[108:111], v[64:67], v[36:39], v[108:111]
    ds_read_b128 v[64:67], v18 offset:17408
    s_waitcnt lgkmcnt(7)
    v_mfma_f32_16x16x32_bf16 v[112:115], v[68:71], v[32:35], v[112:115]
    v_mfma_f32_16x16x32_bf16 v[116:119], v[68:71], v[36:39], v[116:119]
    ds_read_b128 v[68:71], v18 offset:21504
    v_cvt_pk_bf16_f32 v120, v88, v96
    v_cvt_pk_bf16_f32 v121, v89, v97
    v_cvt_pk_bf16_f32 v122, v90, v98
    v_cvt_pk_bf16_f32 v123, v91, v99
    buffer_store_dwordx4 v[120:123], v19, s[8:11], s56 offen offset:0
    v_cvt_pk_bf16_f32 v124, v92, v100
    v_cvt_pk_bf16_f32 v125, v93, v101
    v_cvt_pk_bf16_f32 v126, v94, v102
    v_cvt_pk_bf16_f32 v127, v95, v103
    buffer_store_dwordx4 v[124:127], v19, s[8:11], s57 offen offset:0
    s_waitcnt lgkmcnt(7)
    v_mfma_f32_16x16x32_bf16 v[104:107], v[72:75], v[40:43], v[104:107]
    v_mfma_f32_16x16x32_bf16 v[108:111], v[72:75], v[44:47], v[108:111]
    ds_read_b128 v[72:75], v18 offset:18432
    s_waitcnt lgkmcnt(7)
    v_mfma_f32_16x16x32_bf16 v[112:115], v[76:79], v[40:43], v[112:115]
    v_mfma_f32_16x16x32_bf16 v[116:119], v[76:79], v[44:47], v[116:119]
    ds_read_b128 v[76:79], v18 offset:22528
    s_waitcnt lgkmcnt(7)
    v_mfma_f32_16x16x32_bf16 v[104:107], v[80:83], v[48:51], v[104:107]
    v_mfma_f32_16x16x32_bf16 v[108:111], v[80:83], v[52:55], v[108:111]
    ds_read_b128 v[80:83], v18 offset:19456
    s_waitcnt lgkmcnt(7)
    v_mfma_f32_16x16x32_bf16 v[112:115], v[84:87], v[48:51], v[112:115]
    v_mfma_f32_16x16x32_bf16 v[116:119], v[84:87], v[52:55], v[116:119]
    ds_read_b128 v[84:87], v18 offset:23552
    s_waitcnt lgkmcnt(7)
    v_mfma_f32_16x16x32_bf16 v[88:91], v[56:59], v[24:27], 0
    v_mfma_f32_16x16x32_bf16 v[92:95], v[56:59], v[28:31], 0
    ds_read_b128 v[56:59], v18 offset:24576
    s_waitcnt lgkmcnt(7)
    v_mfma_f32_16x16x32_bf16 v[96:99], v[60:63], v[24:27], 0
    v_mfma_f32_16x16x32_bf16 v[100:103], v[60:63], v[28:31], 0
    ds_read_b128 v[60:63], v18 offset:28672
    s_waitcnt lgkmcnt(7)
    v_mfma_f32_16x16x32_bf16 v[88:91], v[64:67], v[32:35], v[88:91]
    v_mfma_f32_16x16x32_bf16 v[92:95], v[64:67], v[36:39], v[92:95]
    ds_read_b128 v[64:67], v18 offset:25600
    s_waitcnt lgkmcnt(7)
    v_mfma_f32_16x16x32_bf16 v[96:99], v[68:71], v[32:35], v[96:99]
    v_mfma_f32_16x16x32_bf16 v[100:103], v[68:71], v[36:39], v[100:103]
    ds_read_b128 v[68:71], v18 offset:29696
    v_cvt_pk_bf16_f32 v120, v104, v112
    v_cvt_pk_bf16_f32 v121, v105, v113
    v_cvt_pk_bf16_f32 v122, v106, v114
    v_cvt_pk_bf16_f32 v123, v107, v115
    buffer_store_dwordx4 v[120:123], v19, s[8:11], s56 offen offset:256
    v_cvt_pk_bf16_f32 v124, v108, v116
    v_cvt_pk_bf16_f32 v125, v109, v117
    v_cvt_pk_bf16_f32 v126, v110, v118
    v_cvt_pk_bf16_f32 v127, v111, v119
    buffer_store_dwordx4 v[124:127], v19, s[8:11], s57 offen offset:256
    s_waitcnt lgkmcnt(7)
    v_mfma_f32_16x16x32_bf16 v[88:91], v[72:75], v[40:43], v[88:91]
    v_mfma_f32_16x16x32_bf16 v[92:95], v[72:75], v[44:47], v[92:95]
    ds_read_b128 v[72:75], v18 offset:26624
    s_waitcnt lgkmcnt(7)
    v_mfma_f32_16x16x32_bf16 v[96:99], v[76:79], v[40:43], v[96:99]
    v_mfma_f32_16x16x32_bf16 v[100:103], v[76:79], v[44:47], v[100:103]
    ds_read_b128 v[76:79], v18 offset:30720
    s_waitcnt lgkmcnt(7)
    v_mfma_f32_16x16x32_bf16 v[88:91], v[80:83], v[48:51], v[88:91]
    v_mfma_f32_16x16x32_bf16 v[92:95], v[80:83], v[52:55], v[92:95]
    ds_read_b128 v[80:83], v18 offset:27648
    s_waitcnt lgkmcnt(7)
    v_mfma_f32_16x16x32_bf16 v[96:99], v[84:87], v[48:51], v[96:99]
    v_mfma_f32_16x16x32_bf16 v[100:103], v[84:87], v[52:55], v[100:103]
    ds_read_b128 v[84:87], v18 offset:31744
    s_waitcnt lgkmcnt(7)
    v_mfma_f32_16x16x32_bf16 v[104:107], v[56:59], v[24:27], 0
    v_mfma_f32_16x16x32_bf16 v[108:111], v[56:59], v[28:31], 0
    s_waitcnt lgkmcnt(6)
    v_mfma_f32_16x16x32_bf16 v[112:115], v[60:63], v[24:27], 0
    v_mfma_f32_16x16x32_bf16 v[116:119], v[60:63], v[28:31], 0
    s_waitcnt lgkmcnt(5)
    v_mfma_f32_16x16x32_bf16 v[104:107], v[64:67], v[32:35], v[104:107]
    v_mfma_f32_16x16x32_bf16 v[108:111], v[64:67], v[36:39], v[108:111]
    s_waitcnt lgkmcnt(4)
    v_mfma_f32_16x16x32_bf16 v[112:115], v[68:71], v[32:35], v[112:115]
    v_mfma_f32_16x16x32_bf16 v[116:119], v[68:71], v[36:39], v[116:119]
    v_cvt_pk_bf16_f32 v120, v88, v96
    v_cvt_pk_bf16_f32 v121, v89, v97
    v_cvt_pk_bf16_f32 v122, v90, v98
    v_cvt_pk_bf16_f32 v123, v91, v99
    buffer_store_dwordx4 v[120:123], v19, s[8:11], s56 offen offset:512
    v_cvt_pk_bf16_f32 v124, v92, v100
    v_cvt_pk_bf16_f32 v125, v93, v101
    v_cvt_pk_bf16_f32 v126, v94, v102
    v_cvt_pk_bf16_f32 v127, v95, v103
    buffer_store_dwordx4 v[124:127], v19, s[8:11], s57 offen offset:512
    s_waitcnt lgkmcnt(3)
    v_mfma_f32_16x16x32_bf16 v[104:107], v[72:75], v[40:43], v[104:107]
    v_mfma_f32_16x16x32_bf16 v[108:111], v[72:75], v[44:47], v[108:111]
    s_waitcnt lgkmcnt(2)
    v_mfma_f32_16x16x32_bf16 v[112:115], v[76:79], v[40:43], v[112:115]
    v_mfma_f32_16x16x32_bf16 v[116:119], v[76:79], v[44:47], v[116:119]
    s_waitcnt lgkmcnt(1)
    v_mfma_f32_16x16x32_bf16 v[104:107], v[80:83], v[48:51], v[104:107]
    v_mfma_f32_16x16x32_bf16 v[108:111], v[80:83], v[52:55], v[108:111]
    s_waitcnt lgkmcnt(0)
    v_mfma_f32_16x16x32_bf16 v[112:115], v[84:87], v[48:51], v[112:115]
    v_mfma_f32_16x16x32_bf16 v[116:119], v[84:87], v[52:55], v[116:119]
    s_nop 3
    v_cvt_pk_bf16_f32 v120, v104, v112
    v_cvt_pk_bf16_f32 v121, v105, v113
    v_cvt_pk_bf16_f32 v122, v106, v114
    v_cvt_pk_bf16_f32 v123, v107, v115
    buffer_store_dwordx4 v[120:123], v19, s[8:11], s56 offen offset:768
    v_cvt_pk_bf16_f32 v124, v108, v116
    v_cvt_pk_bf16_f32 v125, v109, v117
    v_cvt_pk_bf16_f32 v126, v110, v118
    v_cvt_pk_bf16_f32 v127, v111, v119
    buffer_store_dwordx4 v[124:127], v19, s[8:11], s57 offen offset:768
    s_lshl_b32 s59, s51, 5
    s_add_u32 s59, s59, s47
    s_lshl_b32 s59, s59, 2
    s_add_u32 s59, s59, 10551296
    s_waitcnt vmcnt(0)
    s_barrier
    s_cmp_lg_u32 s46, 0
    s_cbranch_scc1 L_fs_19
    v_mov_b32 v124, 0
    v_mov_b32 v125, 1
    s_mov_b64 exec, 1
    buffer_store_dword v125, v124, s[8:11], s59 offen
    s_mov_b64 exec, -1
L_fs_19:
    s_lshl_b32 s64, s51, 5
    s_add_u32 s64, s64, s47
    s_lshl_b32 s56, s64, 10
    s_lshr_b32 s57, s64, 5
    s_lshl_b32 s57, s57, 15
    s_bfe_u32 s58, s64, 0x10004
    s_lshl_b32 s58, s58, 10
    s_add_u32 s57, s57, s58
    s_and_b32 s58, s64, 15
    s_lshl_b32 s58, s58, 4
    s_add_u32 s57, s57, s58
    s_add_u32 s57, s57, 2097152
    s_mov_b32 s4, s16
    s_mov_b32 s5, s17
    s_mov_b32 s6, 2097152
    s_mov_b32 s7, 0x20000
    buffer_load_dwordx4 v[72:75], v0, s[4:7], s56 offen
    s_mov_b32 s4, s32
    s_mov_b32 s5, s33
    s_mov_b32 s6, 1024
    s_mov_b32 s7, 0x20000
    buffer_load_dwordx4 v[76:79], v0, s[4:7], 0 offen
    s_lshl_b32 s59, s51, 7
    s_add_u32 s59, s59, 10551296
    v_and_b32 v124, 31, v1
    v_lshlrev_b32 v124, 2, v124
L_fw_20:
    buffer_load_dword v125, v124, s[8:11], s59 offen sc1
    s_waitcnt vmcnt(0)
    v_cmp_eq_u32 vcc, 0, v125
    s_cbranch_vccz L_fwd_21
    s_sub_u32 s49, s49, 1
    s_cmp_gt_i32 s49, 0
    s_cbranch_scc1 L_fw_20
    s_branch L_abort
L_fwd_21:
    s_lshl_b32 s60, s47, 15
    s_add_u32 s60, s60, s54
    s_add_u32 s63, s60, 0
    buffer_load_dwordx4 v[24:27], v22, s[8:11], s63 offen sc1
    s_add_u32 s63, s60, 4096
    buffer_load_dwordx4 v[28:31], v22, s[8:11], s63 offen sc1
    s_add_u32 s63, s60, 8192
    buffer_load_dwordx4 v[32:35], v22, s[8:11], s63 offen sc1
    s_add_u32 s63, s60, 12288
    buffer_load_dwordx4 v[36:39], v22, s[8:11], s63 offen sc1
    s_add_u32 s63, s60, 16384
    buffer_load_dwordx4 v[40:43], v22, s[8:11], s63 offen sc1
    s_add_u32 s63, s60, 20480
    buffer_load_dwordx4 v[44:47], v22, s[8:11], s63 offen sc1
    s_add_u32 s63, s60, 24576
    buffer_load_dwordx4 v[48:51], v22, s[8:11], s63 offen sc1
    s_add_u32 s63, s60, 28672
    buffer_load_dwordx4 v[52:55], v22, s[8:11], s63 offen sc1
    v_and_b32 v64, 15, v1
    v_and_b32 v65, 1, v1
    v_lshlrev_b32 v65, 4, v65
    v_mov_b32 v66, 0x3f80
    v_lshlrev_b32 v66, v65, v66
    v_lshrrev_b32 v64, 1, v64
    v_cmp_eq_u32 vcc, 0, v64
    s_nop 1
    v_cndmask_b32 v56, 0, v66, vcc
    v_cmp_eq_u32 vcc, 1, v64
    s_nop 1
    v_cndmask_b32 v57, 0, v66, vcc
    v_cmp_eq_u32 vcc, 2, v64
    s_nop 1
    v_cndmask_b32 v58, 0, v66, vcc
    v_cmp_eq_u32 vcc, 3, v64
    s_nop 1
    v_cndmask_b32 v59, 0, v66, vcc
    s_waitcnt vmcnt(7)
    s_nop 0
    v_mfma_f32_16x16x32_bf16 v[60:63], v[56:59], v[24:27], 0
    s_waitcnt vmcnt(6)
    v_mfma_f32_16x16x32_bf16 v[60:63], v[56:59], v[28:31], v[60:63]
    s_waitcnt vmcnt(5)
    v_mfma_f32_16x16x32_bf16 v[60:63], v[56:59], v[32:35], v[60:63]
    s_waitcnt vmcnt(4)
    v_mfma_f32_16x16x32_bf16 v[60:63], v[56:59], v[36:39], v[60:63]
    s_waitcnt vmcnt(3)
    v_mfma_f32_16x16x32_bf16 v[60:63], v[56:59], v[40:43], v[60:63]
    s_waitcnt vmcnt(2)
    v_mfma_f32_16x16x32_bf16 v[60:63], v[56:59], v[44:47], v[60:63]
    s_waitcnt vmcnt(1)
    v_mfma_f32_16x16x32_bf16 v[60:63], v[56:59], v[48:51], v[60:63]
    s_waitcnt vmcnt(0)
    v_mfma_f32_16x16x32_bf16 v[60:63], v[56:59], v[52:55], v[60:63]
    s_nop 7
    ds_write_b128 v21, v[60:63]
    s_waitcnt lgkmcnt(0)
    s_barrier
    s_cmp_lg_u32 s46, 0
    s_cbranch_scc1 L_t4d_22
    v_lshlrev_b32 v56, 5, v1
    v_add_u32 v56, 139264, v56
    ds_read_b128 v[24:27], v56
    ds_read_b128 v[28:31], v56 offset:16
    v_lshlrev_b32 v32, 16, v72
    v_and_b32 v33, 0xffff0000, v72
    v_lshlrev_b32 v34, 16, v73
    v_and_b32 v35, 0xffff0000, v73
    v_lshlrev_b32 v36, 16, v74
    v_and_b32 v37, 0xffff0000, v74
    v_lshlrev_b32 v38, 16, v75
    v_and_b32 v39, 0xffff0000, v75
    s_waitcnt lgkmcnt(0)
    v_cvt_pk_bf16_f32 v40, v24, v25
    v_cvt_pk_bf16_f32 v41, v26, v27
    v_cvt_pk_bf16_f32 v42, v28, v29
    v_cvt_pk_bf16_f32 v43, v30, v31
    v_lshlrev_b32 v24, 16, v40
    v_and_b32 v25, 0xffff0000, v40
    v_lshlrev_b32 v26, 16, v41
    v_and_b32 v27, 0xffff0000, v41
    v_lshlrev_b32 v28, 16, v42
    v_and_b32 v29, 0xffff0000, v42
    v_lshlrev_b32 v30, 16, v43
    v_and_b32 v31, 0xffff0000, v43
    v_add_f32 v32, v32, v24
    v_add_f32 v33, v33, v25
    v_add_f32 v34, v34, v26
    v_add_f32 v35, v35, v27
    v_add_f32 v36, v36, v28
    v_add_f32 v37, v37, v29
    v_add_f32 v38, v38, v30
    v_add_f32 v39, v39, v31
    v_cvt_pk_bf16_f32 v40, v32, v33
    v_cvt_pk_bf16_f32 v41, v34, v35
    v_cvt_pk_bf16_f32 v42, v36, v37
    v_cvt_pk_bf16_f32 v43, v38, v39
    s_add_u32 s58, s56, 4194304
    buffer_store_dwordx4 v[40:43], v0, s[8:11], s58 offen sc1
    v_lshlrev_b32 v32, 16, v40
    v_and_b32 v33, 0xffff0000, v40
    v_lshlrev_b32 v34, 16, v41
    v_and_b32 v35, 0xffff0000, v41
    v_lshlrev_b32 v36, 16, v42
    v_and_b32 v37, 0xffff0000, v42
    v_lshlrev_b32 v38, 16, v43
    v_and_b32 v39, 0xffff0000, v43
    v_add_f32 v64, v32, v33
    v_add_f32 v65, v34, v35
    v_add_f32 v66, v36, v37
    v_add_f32 v67, v38, v39
    v_add_f32 v64, v64, v65
    v_add_f32 v66, v66, v67
    v_add_f32 v64, v64, v66
    s_nop 1
    v_add_f32_dpp v64, v64, v64 row_ror:8 row_mask:0xf bank_mask:0xf
    s_nop 1
    v_add_f32_dpp v64, v64, v64 row_ror:4 row_mask:0xf bank_mask:0xf
    s_nop 1
    v_add_f32_dpp v64, v64, v64 row_ror:2 row_mask:0xf bank_mask:0xf
    s_nop 1
    v_add_f32_dpp v64, v64, v64 row_ror:1 row_mask:0xf bank_mask:0xf
    v_mov_b32 v65, v64
    s_nop 1
    v_permlane16_swap_b32 v64, v65
    v_add_f32 v64, v64, v65
    v_mov_b32 v65, v64
    s_nop 1
    v_permlane32_swap_b32 v64, v65
    v_add_f32 v64, v64, v65
    v_mul_f32 v66, 0x3b000000, v64
    v_sub_f32 v56, v32, v66
    v_sub_f32 v57, v33, v66
    v_sub_f32 v58, v34, v66
    v_sub_f32 v59, v35, v66
    v_sub_f32 v60, v36, v66
    v_sub_f32 v61, v37, v66
    v_sub_f32 v62, v38, v66
    v_sub_f32 v63, v39, v66
    v_mul_f32 v64, v56, v56
    v_mul_f32 v67, v57, v57
    v_fmac_f32 v64, v58, v58
    v_fmac_f32 v67, v59, v59
    v_fmac_f32 v64, v60, v60
    v_fmac_f32 v67, v61, v61
    v_fmac_f32 v64, v62, v62
    v_fmac_f32 v67, v63, v63
    v_add_f32 v64, v64, v67
    v_cvt_pk_bf16_f32 v66, v66, v66
    v_and_b32 v66, 0xffff0000, v66
    v_add_f32_dpp v64, v64, v64 row_ror:8 row_mask:0xf bank_mask:0xf
    s_nop 1
    v_add_f32_dpp v64, v64, v64 row_ror:4 row_mask:0xf bank_mask:0xf
    s_nop 1
    v_add_f32_dpp v64, v64, v64 row_ror:2 row_mask:0xf bank_mask:0xf
    s_nop 1
    v_add_f32_dpp v64, v64, v64 row_ror:1 row_mask:0xf bank_mask:0xf
    v_mov_b32 v65, v64
    s_nop 1
    v_permlane16_swap_b32 v64, v65
    v_add_f32 v64, v64, v65
    v_mov_b32 v65, v64
    s_nop 1
    v_permlane32_swap_b32 v64, v65
    v_add_f32 v64, v64, v65
    v_mul_f32 v64, 0x3b000000, v64
    v_cvt_pk_bf16_f32 v64, v64, v64
    v_and_b32 v64, 0xffff0000, v64
    v_add_f32 v64, 0x3727c5ac, v64
    v_cvt_pk_bf16_f32 v64, v64, v64
    v_and_b32 v64, 0xffff0000, v64
    v_sqrt_f32 v64, v64
    v_sub_f32 v56, v32, v66
    v_sub_f32 v57, v33, v66
    v_sub_f32 v58, v34, v66
    v_sub_f32 v59, v35, v66
    v_sub_f32 v60, v36, v66
    v_sub_f32 v61, v37, v66
    v_sub_f32 v62, v38, v66
    v_sub_f32 v63, v39, v66
    v_cvt_pk_bf16_f32 v64, v64, v64
    v_and_b32 v64, 0xffff0000, v64
    v_rcp_f32 v64, v64
    v_cvt_pk_bf16_f32 v44, v56, v57
    v_cvt_pk_bf16_f32 v45, v58, v59
    v_cvt_pk_bf16_f32 v46, v60, v61
    v_cvt_pk_bf16_f32 v47, v62, v63
    v_lshlrev_b32 v56, 16, v44
    v_and_b32 v57, 0xffff0000, v44
    v_lshlrev_b32 v58, 16, v45
    v_and_b32 v59, 0xffff0000, v45
    v_lshlrev_b32 v60, 16, v46
    v_and_b32 v61, 0xffff0000, v46
    v_lshlrev_b32 v62, 16, v47
    v_and_b32 v63, 0xffff0000, v47
    v_mul_f32 v56, v56, v64
    v_mul_f32 v57, v57, v64
    v_mul_f32 v58, v58, v64
    v_mul_f32 v59, v59, v64
    v_mul_f32 v60, v60, v64
    v_mul_f32 v61, v61, v64
    v_mul_f32 v62, v62, v64
    v_mul_f32 v63, v63, v64
    v_cvt_pk_bf16_f32 v44, v56, v57
    v_cvt_pk_bf16_f32 v45, v58, v59
    v_cvt_pk_bf16_f32 v46, v60, v61
    v_cvt_pk_bf16_f32 v47, v62, v63
    v_lshlrev_b32 v48, 16, v44
    v_and_b32 v49, 0xffff0000, v44
    v_lshlrev_b32 v50, 16, v45
    v_and_b32 v51, 0xffff0000, v45
    v_lshlrev_b32 v52, 16, v46
    v_and_b32 v53, 0xffff0000, v46
    v_lshlrev_b32 v54, 16, v47
    v_and_b32 v55, 0xffff0000, v47
    v_lshlrev_b32 v24, 16, v76
    v_and_b32 v25, 0xffff0000, v76
    v_lshlrev_b32 v26, 16, v77
    v_and_b32 v27, 0xffff0000, v77
    v_lshlrev_b32 v28, 16, v78
    v_and_b32 v29, 0xffff0000, v78
    v_lshlrev_b32 v30, 16, v79
    v_and_b32 v31, 0xffff0000, v79
    v_mul_f32 v56, v48, v24
    v_fmac_f32 v56, v49, v25
    v_fmac_f32 v56, v50, v26
    v_fmac_f32 v56, v51, v27
    v_fmac_f32 v56, v52, v28
    v_fmac_f32 v56, v53, v29
    v_fmac_f32 v56, v54, v30
    v_fmac_f32 v56, v55, v31
    v_add_f32 v32, v32, v48
    v_add_f32 v33, v33, v49
    v_add_f32 v34, v34, v50
    v_add_f32 v35, v35, v51
    v_add_f32 v36, v36, v52
    v_add_f32 v37, v37, v53
    v_add_f32 v38, v38, v54
    v_add_f32 v39, v39, v55
    v_add_f32_dpp v56, v56, v56 row_ror:8 row_mask:0xf bank_mask:0xf
    s_nop 1
    v_add_f32_dpp v56, v56, v56 row_ror:4 row_mask:0xf bank_mask:0xf
    s_nop 1
    v_add_f32_dpp v56, v56, v56 row_ror:2 row_mask:0xf bank_mask:0xf
    s_nop 1
    v_add_f32_dpp v56, v56, v56 row_ror:1 row_mask:0xf bank_mask:0xf
    v_mov_b32 v57, v56
    s_nop 1
    v_permlane16_swap_b32 v56, v57
    v_add_f32 v56, v56, v57
    v_mov_b32 v57, v56
    s_nop 1
    v_permlane32_swap_b32 v56, v57
    v_add_f32 v56, v56, v57
    v_cvt_pk_bf16_f32 v56, v56, v56
    v_and_b32 v56, 0xffff0000, v56
    v_ashrrev_i32 v57, 31, v56
    v_or_b32 v57, 0x80000000, v57
    v_xor_b32 v56, v56, v57
    v_and_b32 v56, 0xffff0000, v56
    s_sub_u32 s58, 2047, s64
    v_or_b32 v56, s58, v56
    s_lshl_b32 s58, s64, 2
    s_add_u32 s58, s58, 10485760
    v_mov_b32 v57, 0
    s_mov_b64 exec, 1
    buffer_store_dword v56, v57, s[8:11], s58 offen sc1
    s_mov_b64 exec, -1
    v_cvt_pk_bf16_f32 v80, v32, v33
    v_cvt_pk_bf16_f32 v81, v34, v35
    v_cvt_pk_bf16_f32 v82, v36, v37
    v_cvt_pk_bf16_f32 v83, v38, v39
    v_lshlrev_b32 v32, 16, v80
    v_and_b32 v33, 0xffff0000, v80
    v_lshlrev_b32 v34, 16, v81
    v_and_b32 v35, 0xffff0000, v81
    v_lshlrev_b32 v36, 16, v82
    v_and_b32 v37, 0xffff0000, v82
    v_lshlrev_b32 v38, 16, v83
    v_and_b32 v39, 0xffff0000, v83
    s_add_u32 s58, s56, 8388608
    buffer_store_dwordx4 v[80:83], v0, s[8:11], s58 offen sc1
    v_add_f32 v66, v32, v33
    v_add_f32 v67, v34, v35
    v_add_f32 v68, v36, v37
    v_add_f32 v69, v38, v39
    v_add_f32 v66, v66, v67
    v_add_f32 v68, v68, v69
    v_add_f32 v66, v66, v68
    s_nop 1
    v_add_f32_dpp v66, v66, v66 row_ror:8 row_mask:0xf bank_mask:0xf
    s_nop 1
    v_add_f32_dpp v66, v66, v66 row_ror:4 row_mask:0xf bank_mask:0xf
    s_nop 1
    v_add_f32_dpp v66, v66, v66 row_ror:2 row_mask:0xf bank_mask:0xf
    s_nop 1
    v_add_f32_dpp v66, v66, v66 row_ror:1 row_mask:0xf bank_mask:0xf
    v_mov_b32 v67, v66
    s_nop 1
    v_permlane16_swap_b32 v66, v67
    v_add_f32 v66, v66, v67
    v_mov_b32 v67, v66
    s_nop 1
    v_permlane32_swap_b32 v66, v67
    v_add_f32 v66, v66, v67
    v_mul_f32 v68, 0x3b000000, v66
    v_sub_f32 v58, v32, v68
    v_sub_f32 v59, v33, v68
    v_sub_f32 v60, v34, v68
    v_sub_f32 v61, v35, v68
    v_sub_f32 v62, v36, v68
    v_sub_f32 v63, v37, v68
    v_sub_f32 v64, v38, v68
    v_sub_f32 v65, v39, v68
    v_mul_f32 v66, v58, v58
    v_mul_f32 v69, v59, v59
    v_fmac_f32 v66, v60, v60
    v_fmac_f32 v69, v61, v61
    v_fmac_f32 v66, v62, v62
    v_fmac_f32 v69, v63, v63
    v_fmac_f32 v66, v64, v64
    v_fmac_f32 v69, v65, v65
    v_add_f32 v66, v66, v69
    v_cvt_pk_bf16_f32 v68, v68, v68
    v_and_b32 v68, 0xffff0000, v68
    v_add_f32_dpp v66, v66, v66 row_ror:8 row_mask:0xf bank_mask:0xf
    s_nop 1
    v_add_f32_dpp v66, v66, v66 row_ror:4 row_mask:0xf bank_mask:0xf
    s_nop 1
    v_add_f32_dpp v66, v66, v66 row_ror:2 row_mask:0xf bank_mask:0xf
    s_nop 1
    v_add_f32_dpp v66, v66, v66 row_ror:1 row_mask:0xf bank_mask:0xf
    v_mov_b32 v67, v66
    s_nop 1
    v_permlane16_swap_b32 v66, v67
    v_add_f32 v66, v66, v67
    v_mov_b32 v67, v66
    s_nop 1
    v_permlane32_swap_b32 v66, v67
    v_add_f32 v66, v66, v67
    v_mul_f32 v66, 0x3b000000, v66
    v_cvt_pk_bf16_f32 v66, v66, v66
    v_and_b32 v66, 0xffff0000, v66
    v_add_f32 v66, 0x3727c5ac, v66
    v_cvt_pk_bf16_f32 v66, v66, v66
    v_and_b32 v66, 0xffff0000, v66
    v_sqrt_f32 v66, v66
    v_sub_f32 v58, v32, v68
    v_sub_f32 v59, v33, v68
    v_sub_f32 v60, v34, v68
    v_sub_f32 v61, v35, v68
    v_sub_f32 v62, v36, v68
    v_sub_f32 v63, v37, v68
    v_sub_f32 v64, v38, v68
    v_sub_f32 v65, v39, v68
    v_cvt_pk_bf16_f32 v66, v66, v66
    v_and_b32 v66, 0xffff0000, v66
    v_rcp_f32 v66, v66
    v_cvt_pk_bf16_f32 v84, v58, v59
    v_cvt_pk_bf16_f32 v85, v60, v61
    v_cvt_pk_bf16_f32 v86, v62, v63
    v_cvt_pk_bf16_f32 v87, v64, v65
    v_lshlrev_b32 v58, 16, v84
    v_and_b32 v59, 0xffff0000, v84
    v_lshlrev_b32 v60, 16, v85
    v_and_b32 v61, 0xffff0000, v85
    v_lshlrev_b32 v62, 16, v86
    v_and_b32 v63, 0xffff0000, v86
    v_lshlrev_b32 v64, 16, v87
    v_and_b32 v65, 0xffff0000, v87
    v_mul_f32 v58, v58, v66
    v_mul_f32 v59, v59, v66
    v_mul_f32 v60, v60, v66
    v_mul_f32 v61, v61, v66
    v_mul_f32 v62, v62, v66
    v_mul_f32 v63, v63, v66
    v_mul_f32 v64, v64, v66
    v_mul_f32 v65, v65, v66
    v_cvt_pk_bf16_f32 v84, v58, v59
    v_cvt_pk_bf16_f32 v85, v60, v61
    v_cvt_pk_bf16_f32 v86, v62, v63
    v_cvt_pk_bf16_f32 v87, v64, v65
    buffer_store_dwordx4 v[84:87], v20, s[8:11], s57 offen sc1
L_t4d_22:
    s_xor_b32 s54, s54, 1048576
    s_add_u32 s51, s51, 8
    s_cmp_lt_u32 s51, 64
    s_cbranch_scc1 L_t2_18
    s_waitcnt vmcnt(0) lgkmcnt(0)
    s_barrier
    s_add_u32 s50, s50, 256
    s_cmp_lg_u32 s46, 0
    s_cbranch_scc1 L_gbd_24
    v_mov_b32 v124, 128
    v_mov_b32 v125, 1
    s_mov_b64 exec, 1
    buffer_atomic_add v125, v124, s[12:15], 0 offen
    s_mov_b64 exec, -1
L_gb_23:
    buffer_load_dword v125, v124, s[12:15], 0 offen sc1
    s_waitcnt vmcnt(0)
    v_readfirstlane_b32 s56, v125
    s_cmp_ge_u32 s56, s50
    s_cbranch_scc1 L_gbd_24
    s_sleep 4
    s_sub_u32 s49, s49, 1
    s_cmp_gt_i32 s49, 0
    s_cbranch_scc1 L_gb_23
    s_branch L_abort
L_gbd_24:
    s_barrier
    s_cmp_lg_u32 s48, 0
    s_cbranch_scc1 L_nm_25
    s_mov_b32 s56, 10485760
    s_mov_b32 s57, 10489856
    buffer_load_dwordx4 v[24:27], v0, s[8:11], s56 offen offset:0 sc1
    buffer_load_dwordx4 v[28:31], v0, s[8:11], s56 offen offset:1024 sc1
    buffer_load_dwordx4 v[32:35], v0, s[8:11], s56 offen offset:2048 sc1
    buffer_load_dwordx4 v[36:39], v0, s[8:11], s56 offen offset:3072 sc1
    buffer_load_dwordx4 v[40:43], v0, s[8:11], s57 offen offset:0 sc1
    buffer_load_dwordx4 v[44:47], v0, s[8:11], s57 offen offset:1024 sc1
    buffer_load_dwordx4 v[48:51], v0, s[8:11], s57 offen offset:2048 sc1
    buffer_load_dwordx4 v[52:55], v0, s[8:11], s57 offen offset:3072 sc1
    s_waitcnt vmcnt(0)
    v_max_u32 v24, v24, v25
    v_max3_u32 v24, v26, v27, v24
    v_max3_u32 v24, v28, v29, v24
    v_max3_u32 v24, v30, v31, v24
    v_max3_u32 v24, v32, v33, v24
    v_max3_u32 v24, v34, v35, v24
    v_max3_u32 v24, v36, v37, v24
    v_max3_u32 v24, v38, v39, v24
    v_max3_u32 v24, v40, v41, v24
    v_max3_u32 v24, v42, v43, v24
    v_max3_u32 v24, v44, v45, v24
    v_max3_u32 v24, v46, v47, v24
    v_max3_u32 v24, v48, v49, v24
    v_max3_u32 v24, v50, v51, v24
    v_max3_u32 v24, v52, v53, v24
    v_max3_u32 v24, v54, v55, v24
    s_nop 1
    v_max_u32_dpp v24, v24, v24 row_ror:8 row_mask:0xf bank_mask:0xf
    s_nop 1
    v_max_u32_dpp v24, v24, v24 row_ror:4 row_mask:0xf bank_mask:0xf
    s_nop 1
    v_max_u32_dpp v24, v24, v24 row_ror:2 row_mask:0xf bank_mask:0xf
    s_nop 1
    v_max_u32_dpp v24, v24, v24 row_ror:1 row_mask:0xf bank_mask:0xf
    v_mov_b32 v25, v24
    s_nop 1
    v_permlane16_swap_b32 v24, v25
    v_max_u32 v24, v24, v25
    v_mov_b32 v25, v24
    s_nop 1
    v_permlane32_swap_b32 v24, v25
    v_max_u32 v24, v24, v25
    s_nop 0
    v_readfirstlane_b32 s66, v24
    s_and_b32 s64, s66, 0x7ff
    s_sub_u32 s64, 2047, s64
    s_lshl_b32 s56, s64, 10
    s_lshr_b32 s57, s64, 5
    s_lshl_b32 s57, s57, 15
    s_bfe_u32 s58, s64, 0x10004
    s_lshl_b32 s58, s58, 10
    s_add_u32 s57, s57, s58
    s_and_b32 s58, s64, 15
    s_lshl_b32 s58, s58, 4
    s_add_u32 s57, s57, s58
    s_add_u32 s57, s57, 2097152
    s_add_u32 s58, s56, 4194304
    buffer_load_dwordx4 v[24:27], v0, s[8:11], s58 offen sc1
    s_waitcnt vmcnt(0)
    v_lshlrev_b32 v96, 16, v24
    v_and_b32 v97, 0xffff0000, v24
    v_lshlrev_b32 v98, 16, v25
    v_and_b32 v99, 0xffff0000, v25
    v_lshlrev_b32 v100, 16, v26
    v_and_b32 v101, 0xffff0000, v26
    v_lshlrev_b32 v102, 16, v27
    v_and_b32 v103, 0xffff0000, v27
    v_add_f32 v116, v96, v97
    v_add_f32 v117, v98, v99
    v_add_f32 v118, v100, v101
    v_add_f32 v119, v102, v103
    v_add_f32 v116, v116, v117
    v_add_f32 v118, v118, v119
    v_add_f32 v116, v116, v118
    s_nop 1
    v_add_f32_dpp v116, v116, v116 row_ror:8 row_mask:0xf bank_mask:0xf
    s_nop 1
    v_add_f32_dpp v116, v116, v116 row_ror:4 row_mask:0xf bank_mask:0xf
    s_nop 1
    v_add_f32_dpp v116, v116, v116 row_ror:2 row_mask:0xf bank_mask:0xf
    s_nop 1
    v_add_f32_dpp v116, v116, v116 row_ror:1 row_mask:0xf bank_mask:0xf
    v_mov_b32 v117, v116
    s_nop 1
    v_permlane16_swap_b32 v116, v117
    v_add_f32 v116, v116, v117
    v_mov_b32 v117, v116
    s_nop 1
    v_permlane32_swap_b32 v116, v117
    v_add_f32 v116, v116, v117
    v_mul_f32 v118, 0x3b000000, v116
    v_sub_f32 v108, v96, v118
    v_sub_f32 v109, v97, v118
    v_sub_f32 v110, v98, v118
    v_sub_f32 v111, v99, v118
    v_sub_f32 v112, v100, v118
    v_sub_f32 v113, v101, v118
    v_sub_f32 v114, v102, v118
    v_sub_f32 v115, v103, v118
    v_mul_f32 v116, v108, v108
    v_mul_f32 v119, v109, v109
    v_fmac_f32 v116, v110, v110
    v_fmac_f32 v119, v111, v111
    v_fmac_f32 v116, v112, v112
    v_fmac_f32 v119, v113, v113
    v_fmac_f32 v116, v114, v114
    v_fmac_f32 v119, v115, v115
    v_add_f32 v116, v116, v119
    v_cvt_pk_bf16_f32 v118, v118, v118
    v_and_b32 v118, 0xffff0000, v118
    v_add_f32_dpp v116, v116, v116 row_ror:8 row_mask:0xf bank_mask:0xf
    s_nop 1
    v_add_f32_dpp v116, v116, v116 row_ror:4 row_mask:0xf bank_mask:0xf
    s_nop 1
    v_add_f32_dpp v116, v116, v116 row_ror:2 row_mask:0xf bank_mask:0xf
    s_nop 1
    v_add_f32_dpp v116, v116, v116 row_ror:1 row_mask:0xf bank_mask:0xf
    v_mov_b32 v117, v116
    s_nop 1
    v_permlane16_swap_b32 v116, v117
    v_add_f32 v116, v116, v117
    v_mov_b32 v117, v116
    s_nop 1
    v_permlane32_swap_b32 v116, v117
    v_add_f32 v116, v116, v117
    v_mul_f32 v116, 0x3b000000, v116
    v_cvt_pk_bf16_f32 v116, v116, v116
    v_and_b32 v116, 0xffff0000, v116
    v_add_f32 v116, 0x3727c5ac, v116
    v_cvt_pk_bf16_f32 v116, v116, v116
    v_and_b32 v116, 0xffff0000, v116
    v_sqrt_f32 v116, v116
    v_sub_f32 v108, v96, v118
    v_sub_f32 v109, v97, v118
    v_sub_f32 v110, v98, v118
    v_sub_f32 v111, v99, v118
    v_sub_f32 v112, v100, v118
    v_sub_f32 v113, v101, v118
    v_sub_f32 v114, v102, v118
    v_sub_f32 v115, v103, v118
    v_cvt_pk_bf16_f32 v116, v116, v116
    v_and_b32 v116, 0xffff0000, v116
    v_rcp_f32 v116, v116
    v_cvt_pk_bf16_f32 v104, v108, v109
    v_cvt_pk_bf16_f32 v105, v110, v111
    v_cvt_pk_bf16_f32 v106, v112, v113
    v_cvt_pk_bf16_f32 v107, v114, v115
    v_lshlrev_b32 v108, 16, v104
    v_and_b32 v109, 0xffff0000, v104
    v_lshlrev_b32 v110, 16, v105
    v_and_b32 v111, 0xffff0000, v105
    v_lshlrev_b32 v112, 16, v106
    v_and_b32 v113, 0xffff0000, v106
    v_lshlrev_b32 v114, 16, v107
    v_and_b32 v115, 0xffff0000, v107
    v_mul_f32 v108, v108, v116
    v_mul_f32 v109, v109, v116
    v_mul_f32 v110, v110, v116
    v_mul_f32 v111, v111, v116
    v_mul_f32 v112, v112, v116
    v_mul_f32 v113, v113, v116
    v_mul_f32 v114, v114, v116
    v_mul_f32 v115, v115, v116
    v_cvt_pk_bf16_f32 v104, v108, v109
    v_cvt_pk_bf16_f32 v105, v110, v111
    v_cvt_pk_bf16_f32 v106, v112, v113
    v_cvt_pk_bf16_f32 v107, v114, v115
    s_mov_b32 s58, 0x01000100
    s_mov_b32 s59, 0x03020302
    v_perm_b32 v24, v104, v104, s58
    v_perm_b32 v25, v104, v104, s59
    v_perm_b32 v26, v105, v105, s58
    v_perm_b32 v27, v105, v105, s59
    v_perm_b32 v28, v106, v106, s58
    v_perm_b32 v29, v106, v106, s59
    v_perm_b32 v30, v107, v107, s58
    v_perm_b32 v31, v107, v107, s59
    v_lshlrev_b32 v32, 5, v1
    s_lshl_b32 s58, s46, 11
    s_add_u32 s58, s58, 147456
    v_add_u32 v32, s58, v32
    ds_write_b128 v32, v[24:27]
    ds_write_b128 v32, v[28:31] offset:16
    v_and_b32 v33, 15, v1
    v_lshrrev_b32 v34, 4, v1
    v_and_b32 v35, 1, v1
    v_lshlrev_b32 v35, 4, v35
    v_mov_b32 v36, 0xffff
    v_lshlrev_b32 v36, v35, v36
    v_lshrrev_b32 v35, 1, v33
    v_cmp_eq_u32 vcc, 0, v35
    s_nop 1
    v_cndmask_b32 v120, 0, v36, vcc
    v_cmp_eq_u32 vcc, 1, v35
    s_nop 1
    v_cndmask_b32 v121, 0, v36, vcc
    v_cmp_eq_u32 vcc, 2, v35
    s_nop 1
    v_cndmask_b32 v122, 0, v36, vcc
    v_cmp_eq_u32 vcc, 3, v35
    s_nop 1
    v_cndmask_b32 v123, 0, v36, vcc
    s_lshl_b32 s59, s46, 9
    s_add_u32 s58, s58, s59
    v_lshlrev_b32 v32, 7, v34
    v_add_u32 v32, s58, v32
    s_min_u32 s60, s47, 27
    s_lshl_b32 s60, s60, 7
    s_mul_i32 s59, s46, 458752
    s_add_u32 s60, s60, s59
    v_mul_u32_u24 v36, 114688, v34
    v_and_b32 v35, 7, v33
    v_lshl_add_u32 v36, v35, 4, v36
    v_add_u32 v36, s60, v36
    v_cmp_gt_u32 vcc, 8, v33
    v_mov_b32 v38, s36
    v_mov_b32 v39, s37
    v_mov_b32 v40, s34
    v_mov_b32 v41, s35
    v_cndmask_b32 v38, v38, v40, vcc
    v_cndmask_b32 v39, v39, v41, vcc
    v_add_co_u32 v38, vcc, v38, v36
    s_nop 1
    v_addc_co_u32 v39, vcc, 0, v39, vcc
    global_load_dwordx4 v[44:47], v[38:39], off
    v_add_co_u32 v38, vcc, 3584, v38
    s_nop 1
    v_addc_co_u32 v39, vcc, 0, v39, vcc
    global_load_dwordx4 v[48:51], v[38:39], off
    v_add_co_u32 v38, vcc, 3584, v38
    s_nop 1
    v_addc_co_u32 v39, vcc, 0, v39, vcc
    global_load_dwordx4 v[52:55], v[38:39], off
    v_add_co_u32 v38, vcc, 3584, v38
    s_nop 1
    v_addc_co_u32 v39, vcc, 0, v39, vcc
    global_load_dwordx4 v[56:59], v[38:39], off
    v_add_co_u32 v38, vcc, 3584, v38
    s_nop 1
    v_addc_co_u32 v39, vcc, 0, v39, vcc
    global_load_dwordx4 v[60:63], v[38:39], off
    v_add_co_u32 v38, vcc, 3584, v38
    s_nop 1
    v_addc_co_u32 v39, vcc, 0, v39, vcc
    global_load_dwordx4 v[64:67], v[38:39], off
    v_add_co_u32 v38, vcc, 3584, v38
    s_nop 1
    v_addc_co_u32 v39, vcc, 0, v39, vcc
    global_load_dwordx4 v[68:71], v[38:39], off
    v_add_co_u32 v38, vcc, 3584, v38
    s_nop 1
    v_addc_co_u32 v39, vcc, 0, v39, vcc
    global_load_dwordx4 v[72:75], v[38:39], off
    v_add_co_u32 v38, vcc, 3584, v38
    s_nop 1
    v_addc_co_u32 v39, vcc, 0, v39, vcc
    global_load_dwordx4 v[76:79], v[38:39], off
    v_add_co_u32 v38, vcc, 3584, v38
    s_nop 1
    v_addc_co_u32 v39, vcc, 0, v39, vcc
    global_load_dwordx4 v[80:83], v[38:39], off
    v_add_co_u32 v38, vcc, 3584, v38
    s_nop 1
    v_addc_co_u32 v39, vcc, 0, v39, vcc
    global_load_dwordx4 v[84:87], v[38:39], off
    v_add_co_u32 v38, vcc, 3584, v38
    s_nop 1
    v_addc_co_u32 v39, vcc, 0, v39, vcc
    global_load_dwordx4 v[88:91], v[38:39], off
    v_add_co_u32 v38, vcc, 3584, v38
    s_nop 1
    v_addc_co_u32 v39, vcc, 0, v39, vcc
    ds_read_b128 v[24:27], v32 offset:0
    ds_read_b128 v[28:31], v32 offset:16
    s_waitcnt lgkmcnt(0)
    v_and_b32 v124, v120, v24
    v_and_b32 v125, v121, v24
    v_and_b32 v126, v122, v24
    v_and_b32 v127, v123, v24
    s_waitcnt vmcnt(11)
    s_nop 0
    v_mfma_f32_16x16x32_bf16 v[116:119], v[124:127], v[44:47], 0
    global_load_dwordx4 v[44:47], v[38:39], off
    v_add_co_u32 v38, vcc, 3584, v38
    s_nop 1
    v_addc_co_u32 v39, vcc, 0, v39, vcc
    v_and_b32 v124, v120, v25
    v_and_b32 v125, v121, v25
    v_and_b32 v126, v122, v25
    v_and_b32 v127, v123, v25
    s_waitcnt vmcnt(11)
    s_nop 0
    v_mfma_f32_16x16x32_bf16 v[116:119], v[124:127], v[48:51], v[116:119]
    global_load_dwordx4 v[48:51], v[38:39], off
    v_add_co_u32 v38, vcc, 3584, v38
    s_nop 1
    v_addc_co_u32 v39, vcc, 0, v39, vcc
    v_and_b32 v124, v120, v26
    v_and_b32 v125, v121, v26
    v_and_b32 v126, v122, v26
    v_and_b32 v127, v123, v26
    s_waitcnt vmcnt(11)
    s_nop 0
    v_mfma_f32_16x16x32_bf16 v[116:119], v[124:127], v[52:55], v[116:119]
    global_load_dwordx4 v[52:55], v[38:39], off
    v_add_co_u32 v38, vcc, 3584, v38
    s_nop 1
    v_addc_co_u32 v39, vcc, 0, v39, vcc
    v_and_b32 v124, v120, v27
    v_and_b32 v125, v121, v27
    v_and_b32 v126, v122, v27
    v_and_b32 v127, v123, v27
    s_waitcnt vmcnt(11)
    s_nop 0
    v_mfma_f32_16x16x32_bf16 v[116:119], v[124:127], v[56:59], v[116:119]
    global_load_dwordx4 v[56:59], v[38:39], off
    v_add_co_u32 v38, vcc, 3584, v38
    s_nop 1
    v_addc_co_u32 v39, vcc, 0, v39, vcc
    v_and_b32 v124, v120, v28
    v_and_b32 v125, v121, v28
    v_and_b32 v126, v122, v28
    v_and_b32 v127, v123, v28
    s_waitcnt vmcnt(11)
    s_nop 0
    v_mfma_f32_16x16x32_bf16 v[116:119], v[124:127], v[60:63], v[116:119]
    global_load_dwordx4 v[60:63], v[38:39], off
    v_add_co_u32 v38, vcc, 3584, v38
    s_nop 1
    v_addc_co_u32 v39, vcc, 0, v39, vcc
    v_and_b32 v124, v120, v29
    v_and_b32 v125, v121, v29
    v_and_b32 v126, v122, v29
    v_and_b32 v127, v123, v29
    s_waitcnt vmcnt(11)
    s_nop 0
    v_mfma_f32_16x16x32_bf16 v[116:119], v[124:127], v[64:67], v[116:119]
    global_load_dwordx4 v[64:67], v[38:39], off
    v_add_co_u32 v38, vcc, 3584, v38
    s_nop 1
    v_addc_co_u32 v39, vcc, 0, v39, vcc
    v_and_b32 v124, v120, v30
    v_and_b32 v125, v121, v30
    v_and_b32 v126, v122, v30
    v_and_b32 v127, v123, v30
    s_waitcnt vmcnt(11)
    s_nop 0
    v_mfma_f32_16x16x32_bf16 v[116:119], v[124:127], v[68:71], v[116:119]
    global_load_dwordx4 v[68:71], v[38:39], off
    v_add_co_u32 v38, vcc, 3584, v38
    s_nop 1
    v_addc_co_u32 v39, vcc, 0, v39, vcc
    v_and_b32 v124, v120, v31
    v_and_b32 v125, v121, v31
    v_and_b32 v126, v122, v31
    v_and_b32 v127, v123, v31
    s_waitcnt vmcnt(11)
    s_nop 0
    v_mfma_f32_16x16x32_bf16 v[116:119], v[124:127], v[72:75], v[116:119]
    global_load_dwordx4 v[72:75], v[38:39], off
    v_add_co_u32 v38, vcc, 3584, v38
    s_nop 1
    v_addc_co_u32 v39, vcc, 0, v39, vcc
    ds_read_b128 v[24:27], v32 offset:32
    ds_read_b128 v[28:31], v32 offset:48
    s_waitcnt lgkmcnt(0)
    v_and_b32 v124, v120, v24
    v_and_b32 v125, v121, v24
    v_and_b32 v126, v122, v24
    v_and_b32 v127, v123, v24
    s_waitcnt vmcnt(11)
    s_nop 0
    v_mfma_f32_16x16x32_bf16 v[116:119], v[124:127], v[76:79], v[116:119]
    global_load_dwordx4 v[76:79], v[38:39], off
    v_add_co_u32 v38, vcc, 3584, v38
    s_nop 1
    v_addc_co_u32 v39, vcc, 0, v39, vcc
    v_and_b32 v124, v120, v25
    v_and_b32 v125, v121, v25
    v_and_b32 v126, v122, v25
    v_and_b32 v127, v123, v25
    s_waitcnt vmcnt(11)
    s_nop 0
    v_mfma_f32_16x16x32_bf16 v[116:119], v[124:127], v[80:83], v[116:119]
    global_load_dwordx4 v[80:83], v[38:39], off
    v_add_co_u32 v38, vcc, 3584, v38
    s_nop 1
    v_addc_co_u32 v39, vcc, 0, v39, vcc
    v_and_b32 v124, v120, v26
    v_and_b32 v125, v121, v26
    v_and_b32 v126, v122, v26
    v_and_b32 v127, v123, v26
    s_waitcnt vmcnt(11)
    s_nop 0
    v_mfma_f32_16x16x32_bf16 v[116:119], v[124:127], v[84:87], v[116:119]
    global_load_dwordx4 v[84:87], v[38:39], off
    v_add_co_u32 v38, vcc, 3584, v38
    s_nop 1
    v_addc_co_u32 v39, vcc, 0, v39, vcc
    v_and_b32 v124, v120, v27
    v_and_b32 v125, v121, v27
    v_and_b32 v126, v122, v27
    v_and_b32 v127, v123, v27
    s_waitcnt vmcnt(11)
    s_nop 0
    v_mfma_f32_16x16x32_bf16 v[116:119], v[124:127], v[88:91], v[116:119]
    global_load_dwordx4 v[88:91], v[38:39], off
    v_add_co_u32 v38, vcc, 3584, v38
    s_nop 1
    v_addc_co_u32 v39, vcc, 0, v39, vcc
    v_and_b32 v124, v120, v28
    v_and_b32 v125, v121, v28
    v_and_b32 v126, v122, v28
    v_and_b32 v127, v123, v28
    s_waitcnt vmcnt(11)
    s_nop 0
    v_mfma_f32_16x16x32_bf16 v[116:119], v[124:127], v[44:47], v[116:119]
    global_load_dwordx4 v[44:47], v[38:39], off
    v_add_co_u32 v38, vcc, 3584, v38
    s_nop 1
    v_addc_co_u32 v39, vcc, 0, v39, vcc
    v_and_b32 v124, v120, v29
    v_and_b32 v125, v121, v29
    v_and_b32 v126, v122, v29
    v_and_b32 v127, v123, v29
    s_waitcnt vmcnt(11)
    s_nop 0
    v_mfma_f32_16x16x32_bf16 v[116:119], v[124:127], v[48:51], v[116:119]
    global_load_dwordx4 v[48:51], v[38:39], off
    v_add_co_u32 v38, vcc, 3584, v38
    s_nop 1
    v_addc_co_u32 v39, vcc, 0, v39, vcc
    v_and_b32 v124, v120, v30
    v_and_b32 v125, v121, v30
    v_and_b32 v126, v122, v30
    v_and_b32 v127, v123, v30
    s_waitcnt vmcnt(11)
    s_nop 0
    v_mfma_f32_16x16x32_bf16 v[116:119], v[124:127], v[52:55], v[116:119]
    global_load_dwordx4 v[52:55], v[38:39], off
    v_add_co_u32 v38, vcc, 3584, v38
    s_nop 1
    v_addc_co_u32 v39, vcc, 0, v39, vcc
    v_and_b32 v124, v120, v31
    v_and_b32 v125, v121, v31
    v_and_b32 v126, v122, v31
    v_and_b32 v127, v123, v31
    s_waitcnt vmcnt(11)
    s_nop 0
    v_mfma_f32_16x16x32_bf16 v[116:119], v[124:127], v[56:59], v[116:119]
    global_load_dwordx4 v[56:59], v[38:39], off
    v_add_co_u32 v38, vcc, 3584, v38
    s_nop 1
    v_addc_co_u32 v39, vcc, 0, v39, vcc
    ds_read_b128 v[24:27], v32 offset:64
    ds_read_b128 v[28:31], v32 offset:80
    s_waitcnt lgkmcnt(0)
    v_and_b32 v124, v120, v24
    v_and_b32 v125, v121, v24
    v_and_b32 v126, v122, v24
    v_and_b32 v127, v123, v24
    s_waitcnt vmcnt(11)
    s_nop 0
    v_mfma_f32_16x16x32_bf16 v[116:119], v[124:127], v[60:63], v[116:119]
    global_load_dwordx4 v[60:63], v[38:39], off
    v_add_co_u32 v38, vcc, 3584, v38
    s_nop 1
    v_addc_co_u32 v39, vcc, 0, v39, vcc
    v_and_b32 v124, v120, v25
    v_and_b32 v125, v121, v25
    v_and_b32 v126, v122, v25
    v_and_b32 v127, v123, v25
    s_waitcnt vmcnt(11)
    s_nop 0
    v_mfma_f32_16x16x32_bf16 v[116:119], v[124:127], v[64:67], v[116:119]
    global_load_dwordx4 v[64:67], v[38:39], off
    v_add_co_u32 v38, vcc, 3584, v38
    s_nop 1
    v_addc_co_u32 v39, vcc, 0, v39, vcc
    v_and_b32 v124, v120, v26
    v_and_b32 v125, v121, v26
    v_and_b32 v126, v122, v26
    v_and_b32 v127, v123, v26
    s_waitcnt vmcnt(11)
    s_nop 0
    v_mfma_f32_16x16x32_bf16 v[116:119], v[124:127], v[68:71], v[116:119]
    global_load_dwordx4 v[68:71], v[38:39], off
    v_add_co_u32 v38, vcc, 3584, v38
    s_nop 1
    v_addc_co_u32 v39, vcc, 0, v39, vcc
    v_and_b32 v124, v120, v27
    v_and_b32 v125, v121, v27
    v_and_b32 v126, v122, v27
    v_and_b32 v127, v123, v27
    s_waitcnt vmcnt(11)
    s_nop 0
    v_mfma_f32_16x16x32_bf16 v[116:119], v[124:127], v[72:75], v[116:119]
    global_load_dwordx4 v[72:75], v[38:39], off
    v_add_co_u32 v38, vcc, 3584, v38
    s_nop 1
    v_addc_co_u32 v39, vcc, 0, v39, vcc
    v_and_b32 v124, v120, v28
    v_and_b32 v125, v121, v28
    v_and_b32 v126, v122, v28
    v_and_b32 v127, v123, v28
    s_waitcnt vmcnt(11)
    s_nop 0
    v_mfma_f32_16x16x32_bf16 v[116:119], v[124:127], v[76:79], v[116:119]
    v_and_b32 v124, v120, v29
    v_and_b32 v125, v121, v29
    v_and_b32 v126, v122, v29
    v_and_b32 v127, v123, v29
    s_waitcnt vmcnt(10)
    s_nop 0
    v_mfma_f32_16x16x32_bf16 v[116:119], v[124:127], v[80:83], v[116:119]
    v_and_b32 v124, v120, v30
    v_and_b32 v125, v121, v30
    v_and_b32 v126, v122, v30
    v_and_b32 v127, v123, v30
    s_waitcnt vmcnt(9)
    s_nop 0
    v_mfma_f32_16x16x32_bf16 v[116:119], v[124:127], v[84:87], v[116:119]
    v_and_b32 v124, v120, v31
    v_and_b32 v125, v121, v31
    v_and_b32 v126, v122, v31
    v_and_b32 v127, v123, v31
    s_waitcnt vmcnt(8)
    s_nop 0
    v_mfma_f32_16x16x32_bf16 v[116:119], v[124:127], v[88:91], v[116:119]
    ds_read_b128 v[24:27], v32 offset:96
    ds_read_b128 v[28:31], v32 offset:112
    s_waitcnt lgkmcnt(0)
    v_and_b32 v124, v120, v24
    v_and_b32 v125, v121, v24
    v_and_b32 v126, v122, v24
    v_and_b32 v127, v123, v24
    s_waitcnt vmcnt(7)
    s_nop 0
    v_mfma_f32_16x16x32_bf16 v[116:119], v[124:127], v[44:47], v[116:119]
    v_and_b32 v124, v120, v25
    v_and_b32 v125, v121, v25
    v_and_b32 v126, v122, v25
    v_and_b32 v127, v123, v25
    s_waitcnt vmcnt(6)
    s_nop 0
    v_mfma_f32_16x16x32_bf16 v[116:119], v[124:127], v[48:51], v[116:119]
    v_and_b32 v124, v120, v26
    v_and_b32 v125, v121, v26
    v_and_b32 v126, v122, v26
    v_and_b32 v127, v123, v26
    s_waitcnt vmcnt(5)
    s_nop 0
    v_mfma_f32_16x16x32_bf16 v[116:119], v[124:127], v[52:55], v[116:119]
    v_and_b32 v124, v120, v27
    v_and_b32 v125, v121, v27
    v_and_b32 v126, v122, v27
    v_and_b32 v127, v123, v27
    s_waitcnt vmcnt(4)
    s_nop 0
    v_mfma_f32_16x16x32_bf16 v[116:119], v[124:127], v[56:59], v[116:119]
    v_and_b32 v124, v120, v28
    v_and_b32 v125, v121, v28
    v_and_b32 v126, v122, v28
    v_and_b32 v127, v123, v28
    s_waitcnt vmcnt(3)
    s_nop 0
    v_mfma_f32_16x16x32_bf16 v[116:119], v[124:127], v[60:63], v[116:119]
    v_and_b32 v124, v120, v29
    v_and_b32 v125, v121, v29
    v_and_b32 v126, v122, v29
    v_and_b32 v127, v123, v29
    s_waitcnt vmcnt(2)
    s_nop 0
    v_mfma_f32_16x16x32_bf16 v[116:119], v[124:127], v[64:67], v[116:119]
    v_and_b32 v124, v120, v30
    v_and_b32 v125, v121, v30
    v_and_b32 v126, v122, v30
    v_and_b32 v127, v123, v30
    s_waitcnt vmcnt(1)
    s_nop 0
    v_mfma_f32_16x16x32_bf16 v[116:119], v[124:127], v[68:71], v[116:119]
    v_and_b32 v124, v120, v31
    v_and_b32 v125, v121, v31
    v_and_b32 v126, v122, v31
    v_and_b32 v127, v123, v31
    s_waitcnt vmcnt(0)
    s_nop 0
    v_mfma_f32_16x16x32_bf16 v[116:119], v[124:127], v[72:75], v[116:119]
    s_mov_b32 s4, s38
    s_mov_b32 s5, s39
    s_mov_b32 s6, 1835008
    s_mov_b32 s7, 0x20000
    v_lshlrev_b32 v36, 14, v34
    v_lshl_add_u32 v36, v33, 4, v36
    s_lshl_b32 s59, s47, 16
    s_lshl_b32 s60, s46, 8
    s_add_u32 s59, s59, s60
    buffer_load_dwordx4 v[44:47], v36, s[4:7], s59 offen offset:0
    buffer_load_dwordx4 v[48:51], v36, s[4:7], s59 offen offset:1024
    buffer_load_dwordx4 v[52:55], v36, s[4:7], s59 offen offset:2048
    buffer_load_dwordx4 v[56:59], v36, s[4:7], s59 offen offset:3072
    s_add_u32 s59, s59, 4096
    buffer_load_dwordx4 v[60:63], v36, s[4:7], s59 offen offset:0
    buffer_load_dwordx4 v[64:67], v36, s[4:7], s59 offen offset:1024
    buffer_load_dwordx4 v[68:71], v36, s[4:7], s59 offen offset:2048
    buffer_load_dwordx4 v[72:75], v36, s[4:7], s59 offen offset:3072
    s_add_u32 s59, s59, 4096
    buffer_load_dwordx4 v[76:79], v36, s[4:7], s59 offen offset:0
    buffer_load_dwordx4 v[80:83], v36, s[4:7], s59 offen offset:1024
    buffer_load_dwordx4 v[84:87], v36, s[4:7], s59 offen offset:2048
    buffer_load_dwordx4 v[88:91], v36, s[4:7], s59 offen offset:3072
    v_lshlrev_b32 v37, 5, v33
    v_and_b32 v35, 1, v34
    v_lshl_add_u32 v37, v35, 4, v37
    v_lshrrev_b32 v35, 1, v34
    v_lshl_add_u32 v37, v35, 11, v37
    s_lshl_b32 s60, s46, 9
    s_add_u32 s60, s60, 155648
    v_add_u32 v37, s60, v37
    ds_write_b128 v37, v[116:119]
    v_lshlrev_b32 v37, 2, v1
    v_add_u32 v37, 155648, v37
    s_waitcnt lgkmcnt(0)
    s_barrier
    ds_read2st64_b32 v[24:25], v37 offset0:0 offset1:1
    ds_read2st64_b32 v[26:27], v37 offset0:2 offset1:3
    ds_read2st64_b32 v[28:29], v37 offset0:4 offset1:5
    ds_read2st64_b32 v[30:31], v37 offset0:6 offset1:7
    s_waitcnt lgkmcnt(0)
    v_pk_add_f32 v[24:25], v[24:25], v[26:27]
    v_pk_add_f32 v[28:29], v[28:29], v[30:31]
    v_pk_add_f32 v[24:25], v[24:25], v[28:29]
    v_cvt_pk_bf16_f32 v24, v24, v24
    v_and_b32 v24, 0xffff0000, v24
    v_cvt_pk_bf16_f32 v25, v25, v25
    v_and_b32 v25, 0xffff0000, v25
    v_mul_f32 v26, 0xbfb8aa3b, v24
    v_exp_f32 v26, v26
    s_nop 0
    v_add_f32 v26, 1.0, v26
    v_rcp_f32 v26, v26
    s_nop 0
    v_mul_f32 v24, v24, v26
    v_cvt_pk_bf16_f32 v24, v24, v24
    v_and_b32 v24, 0xffff0000, v24
    v_mul_f32 v24, v24, v25
    v_cvt_pk_bf16_f32 v24, v24, v24
    v_lshlrev_b32 v37, 2, v1
    s_lshl_b32 s60, s46, 11
    s_add_u32 s60, s60, 147456
    v_add_u32 v37, s60, v37
    ds_write_b32 v37, v24
    v_lshlrev_b32 v32, 6, v34
    v_add_u32 v32, s60, v32
    ds_read_b128 v[24:27], v32 offset:0
    ds_read_b128 v[28:31], v32 offset:16
    s_waitcnt lgkmcnt(0)
    v_and_b32 v124, v120, v24
    v_and_b32 v125, v121, v24
    v_and_b32 v126, v122, v24
    v_and_b32 v127, v123, v24
    s_waitcnt vmcnt(11)
    s_nop 0
    v_mfma_f32_16x16x32_bf16 v[116:119], v[124:127], v[44:47], 0
    s_add_u32 s59, s59, 4096
    buffer_load_dwordx4 v[44:47], v36, s[4:7], s59 offen offset:0
    v_and_b32 v124, v120, v25
    v_and_b32 v125, v121, v25
    v_and_b32 v126, v122, v25
    v_and_b32 v127, v123, v25
    s_waitcnt vmcnt(11)
    s_nop 0
    v_mfma_f32_16x16x32_bf16 v[116:119], v[124:127], v[48:51], v[116:119]
    buffer_load_dwordx4 v[48:51], v36, s[4:7], s59 offen offset:1024
    v_and_b32 v124, v120, v26
    v_and_b32 v125, v121, v26
    v_and_b32 v126, v122, v26
    v_and_b32 v127, v123, v26
    s_waitcnt vmcnt(11)
    s_nop 0
    v_mfma_f32_16x16x32_bf16 v[116:119], v[124:127], v[52:55], v[116:119]
    buffer_load_dwordx4 v[52:55], v36, s[4:7], s59 offen offset:2048
    v_and_b32 v124, v120, v27
    v_and_b32 v125, v121, v27
    v_and_b32 v126, v122, v27
    v_and_b32 v127, v123, v27
    s_waitcnt vmcnt(11)
    s_nop 0
    v_mfma_f32_16x16x32_bf16 v[116:119], v[124:127], v[56:59], v[116:119]
    buffer_load_dwordx4 v[56:59], v36, s[4:7], s59 offen offset:3072
    v_and_b32 v124, v120, v28
    v_and_b32 v125, v121, v28
    v_and_b32 v126, v122, v28
    v_and_b32 v127, v123, v28
    s_waitcnt vmcnt(11)
    s_nop 0
    v_mfma_f32_16x16x32_bf16 v[116:119], v[124:127], v[60:63], v[116:119]
    v_and_b32 v124, v120, v29
    v_and_b32 v125, v121, v29
    v_and_b32 v126, v122, v29
    v_and_b32 v127, v123, v29
    s_waitcnt vmcnt(10)
    s_nop 0
    v_mfma_f32_16x16x32_bf16 v[116:119], v[124:127], v[64:67], v[116:119]
    v_and_b32 v124, v120, v30
    v_and_b32 v125, v121, v30
    v_and_b32 v126, v122, v30
    v_and_b32 v127, v123, v30
    s_waitcnt vmcnt(9)
    s_nop 0
    v_mfma_f32_16x16x32_bf16 v[116:119], v[124:127], v[68:71], v[116:119]
    v_and_b32 v124, v120, v31
    v_and_b32 v125, v121, v31
    v_and_b32 v126, v122, v31
    v_and_b32 v127, v123, v31
    s_waitcnt vmcnt(8)
    s_nop 0
    v_mfma_f32_16x16x32_bf16 v[116:119], v[124:127], v[72:75], v[116:119]
    ds_read_b128 v[24:27], v32 offset:32
    ds_read_b128 v[28:31], v32 offset:48
    s_waitcnt lgkmcnt(0)
    v_and_b32 v124, v120, v24
    v_and_b32 v125, v121, v24
    v_and_b32 v126, v122, v24
    v_and_b32 v127, v123, v24
    s_waitcnt vmcnt(7)
    s_nop 0
    v_mfma_f32_16x16x32_bf16 v[116:119], v[124:127], v[76:79], v[116:119]
    v_and_b32 v124, v120, v25
    v_and_b32 v125, v121, v25
    v_and_b32 v126, v122, v25
    v_and_b32 v127, v123, v25
    s_waitcnt vmcnt(6)
    s_nop 0
    v_mfma_f32_16x16x32_bf16 v[116:119], v[124:127], v[80:83], v[116:119]
    v_and_b32 v124, v120, v26
    v_and_b32 v125, v121, v26
    v_and_b32 v126, v122, v26
    v_and_b32 v127, v123, v26
    s_waitcnt vmcnt(5)
    s_nop 0
    v_mfma_f32_16x16x32_bf16 v[116:119], v[124:127], v[84:87], v[116:119]
    v_and_b32 v124, v120, v27
    v_and_b32 v125, v121, v27
    v_and_b32 v126, v122, v27
    v_and_b32 v127, v123, v27
    s_waitcnt vmcnt(4)
    s_nop 0
    v_mfma_f32_16x16x32_bf16 v[116:119], v[124:127], v[88:91], v[116:119]
    v_and_b32 v124, v120, v28
    v_and_b32 v125, v121, v28
    v_and_b32 v126, v122, v28
    v_and_b32 v127, v123, v28
    s_waitcnt vmcnt(3)
    s_nop 0
    v_mfma_f32_16x16x32_bf16 v[116:119], v[124:127], v[44:47], v[116:119]
    v_and_b32 v124, v120, v29
    v_and_b32 v125, v121, v29
    v_and_b32 v126, v122, v29
    v_and_b32 v127, v123, v29
    s_waitcnt vmcnt(2)
    s_nop 0
    v_mfma_f32_16x16x32_bf16 v[116:119], v[124:127], v[48:51], v[116:119]
    v_and_b32 v124, v120, v30
    v_and_b32 v125, v121, v30
    v_and_b32 v126, v122, v30
    v_and_b32 v127, v123, v30
    s_waitcnt vmcnt(1)
    s_nop 0
    v_mfma_f32_16x16x32_bf16 v[116:119], v[124:127], v[52:55], v[116:119]
    v_and_b32 v124, v120, v31
    v_and_b32 v125, v121, v31
    v_and_b32 v126, v122, v31
    v_and_b32 v127, v123, v31
    s_waitcnt vmcnt(0)
    s_nop 0
    v_mfma_f32_16x16x32_bf16 v[116:119], v[124:127], v[56:59], v[116:119]
    v_lshlrev_b32 v37, 4, v33
    v_and_b32 v35, 1, v34
    v_lshl_add_u32 v37, v35, 3, v37
    v_and_b32 v35, 2, v34
    v_lshl_add_u32 v37, v35, 30, v37
    s_lshl_b32 s59, s47, 10
    s_lshl_b32 s60, s46, 8
    s_add_u32 s59, s59, s60
    s_add_u32 s59, s59, 17825792
    v_cvt_pk_bf16_f32 v24, v116, v117
    v_cvt_pk_bf16_f32 v25, v118, v119
    buffer_store_dwordx2 v[24:25], v37, s[8:11], s59 offen
    s_lshl_b32 s59, s47, 2
    s_add_u32 s59, s59, 10567680
    s_waitcnt vmcnt(0)
    s_barrier
    s_cmp_lg_u32 s46, 0
    s_cbranch_scc1 L_fs_26
    v_mov_b32 v124, 0
    v_mov_b32 v125, 1
    s_mov_b64 exec, 1
    buffer_store_dword v125, v124, s[8:11], s59 offen
    s_mov_b64 exec, -1
L_fs_26:
    s_cmp_lg_u32 s47, 0
    s_cbranch_scc1 L_moed_27
    s_mov_b32 s59, 10567680
    v_and_b32 v124, 31, v1
    v_lshlrev_b32 v124, 2, v124
L_fw_28:
    buffer_load_dword v125, v124, s[8:11], s59 offen sc1
    s_waitcnt vmcnt(0)
    v_cmp_eq_u32 vcc, 0, v125
    s_cbranch_vccz L_fwd_29
    s_sub_u32 s49, s49, 1
    s_cmp_gt_i32 s49, 0
    s_cbranch_scc1 L_fw_28
    s_branch L_abort
L_fwd_29:
    s_mov_b32 s60, 17825792
    s_add_u32 s63, s60, 0
    buffer_load_dwordx4 v[24:27], v22, s[8:11], s63 offen sc1
    s_add_u32 s63, s60, 4096
    buffer_load_dwordx4 v[28:31], v22, s[8:11], s63 offen sc1
    s_add_u32 s63, s60, 8192
    buffer_load_dwordx4 v[32:35], v22, s[8:11], s63 offen sc1
    s_add_u32 s63, s60, 12288
    buffer_load_dwordx4 v[36:39], v22, s[8:11], s63 offen sc1
    s_add_u32 s63, s60, 16384
    buffer_load_dwordx4 v[40:43], v22, s[8:11], s63 offen sc1
    s_add_u32 s63, s60, 20480
    buffer_load_dwordx4 v[44:47], v22, s[8:11], s63 offen sc1
    s_add_u32 s63, s60, 24576
    buffer_load_dwordx4 v[48:51], v22, s[8:11], s63 offen sc1
    s_add_u32 s63, s60, 28672
    buffer_load_dwordx4 v[52:55], v22, s[8:11], s63 offen sc1
    v_and_b32 v64, 15, v1
    v_and_b32 v65, 1, v1
    v_lshlrev_b32 v65, 4, v65
    v_mov_b32 v66, 0x3f80
    v_lshlrev_b32 v66, v65, v66
    v_lshrrev_b32 v64, 1, v64
    v_cmp_eq_u32 vcc, 0, v64
    s_nop 1
    v_cndmask_b32 v56, 0, v66, vcc
    v_cmp_eq_u32 vcc, 1, v64
    s_nop 1
    v_cndmask_b32 v57, 0, v66, vcc
    v_cmp_eq_u32 vcc, 2, v64
    s_nop 1
    v_cndmask_b32 v58, 0, v66, vcc
    v_cmp_eq_u32 vcc, 3, v64
    s_nop 1
    v_cndmask_b32 v59, 0, v66, vcc
    s_waitcnt vmcnt(7)
    s_nop 0
    v_mfma_f32_16x16x32_bf16 v[60:63], v[56:59], v[24:27], 0
    s_waitcnt vmcnt(6)
    v_mfma_f32_16x16x32_bf16 v[60:63], v[56:59], v[28:31], v[60:63]
    s_waitcnt vmcnt(5)
    v_mfma_f32_16x16x32_bf16 v[60:63], v[56:59], v[32:35], v[60:63]
    s_waitcnt vmcnt(4)
    v_mfma_f32_16x16x32_bf16 v[60:63], v[56:59], v[36:39], v[60:63]
    s_waitcnt vmcnt(3)
    v_mfma_f32_16x16x32_bf16 v[60:63], v[56:59], v[40:43], v[60:63]
    s_waitcnt vmcnt(2)
    v_mfma_f32_16x16x32_bf16 v[60:63], v[56:59], v[44:47], v[60:63]
    s_waitcnt vmcnt(1)
    v_mfma_f32_16x16x32_bf16 v[60:63], v[56:59], v[48:51], v[60:63]
    s_waitcnt vmcnt(0)
    v_mfma_f32_16x16x32_bf16 v[60:63], v[56:59], v[52:55], v[60:63]
    s_nop 7
    ds_write_b128 v21, v[60:63]
    s_waitcnt lgkmcnt(0)
    s_barrier
    s_cmp_lg_u32 s46, 0
    s_cbranch_scc1 L_moed_27
    v_lshlrev_b32 v56, 5, v1
    v_add_u32 v56, 139264, v56
    ds_read_b128 v[24:27], v56
    ds_read_b128 v[28:31], v56 offset:16
    s_and_b32 s59, s66, 0xffff0000
    s_xor_b32 s60, s59, 0x80000000
    s_xor_b32 s61, s59, 0xffff0000
    s_cmp_lt_i32 s59, 0
    s_cselect_b32 s59, s60, s61
    v_mov_b32 v56, s59
    v_mul_f32 v56, 0xbfb8aa3b, v56
    v_exp_f32 v56, v56
    s_nop 0
    v_add_f32 v56, 1.0, v56
    v_rcp_f32 v56, v56
    s_nop 0
    v_cvt_pk_bf16_f32 v56, v56, v56
    v_and_b32 v56, 0xffff0000, v56
    v_lshlrev_b32 v48, 16, v104
    v_and_b32 v49, 0xffff0000, v104
    v_lshlrev_b32 v50, 16, v105
    v_and_b32 v51, 0xffff0000, v105
    v_lshlrev_b32 v52, 16, v106
    v_and_b32 v53, 0xffff0000, v106
    v_lshlrev_b32 v54, 16, v107
    v_and_b32 v55, 0xffff0000, v107
    s_waitcnt lgkmcnt(0)
    v_cvt_pk_bf16_f32 v40, v24, v25
    v_cvt_pk_bf16_f32 v41, v26, v27
    v_cvt_pk_bf16_f32 v42, v28, v29
    v_cvt_pk_bf16_f32 v43, v30, v31
    v_lshlrev_b32 v24, 16, v40
    v_and_b32 v25, 0xffff0000, v40
    v_lshlrev_b32 v26, 16, v41
    v_and_b32 v27, 0xffff0000, v41
    v_lshlrev_b32 v28, 16, v42
    v_and_b32 v29, 0xffff0000, v42
    v_lshlrev_b32 v30, 16, v43
    v_and_b32 v31, 0xffff0000, v43
    v_mul_f32 v24, v24, v56
    v_mul_f32 v25, v25, v56
    v_mul_f32 v26, v26, v56
    v_mul_f32 v27, v27, v56
    v_mul_f32 v28, v28, v56
    v_mul_f32 v29, v29, v56
    v_mul_f32 v30, v30, v56
    v_mul_f32 v31, v31, v56
    v_cvt_pk_bf16_f32 v40, v24, v25
    v_cvt_pk_bf16_f32 v41, v26, v27
    v_cvt_pk_bf16_f32 v42, v28, v29
    v_cvt_pk_bf16_f32 v43, v30, v31
    v_lshlrev_b32 v24, 16, v40
    v_and_b32 v25, 0xffff0000, v40
    v_lshlrev_b32 v26, 16, v41
    v_and_b32 v27, 0xffff0000, v41
    v_lshlrev_b32 v28, 16, v42
    v_and_b32 v29, 0xffff0000, v42
    v_lshlrev_b32 v30, 16, v43
    v_and_b32 v31, 0xffff0000, v43
    v_add_f32 v24, v24, v48
    v_add_f32 v25, v25, v49
    v_add_f32 v26, v26, v50
    v_add_f32 v27, v27, v51
    v_add_f32 v28, v28, v52
    v_add_f32 v29, v29, v53
    v_add_f32 v30, v30, v54
    v_add_f32 v31, v31, v55
    v_cvt_pk_bf16_f32 v40, v24, v25
    v_cvt_pk_bf16_f32 v41, v26, v27
    v_cvt_pk_bf16_f32 v42, v28, v29
    v_cvt_pk_bf16_f32 v43, v30, v31
    v_lshlrev_b32 v24, 16, v40
    v_and_b32 v25, 0xffff0000, v40
    v_lshlrev_b32 v26, 16, v41
    v_and_b32 v27, 0xffff0000, v41
    v_lshlrev_b32 v28, 16, v42
    v_and_b32 v29, 0xffff0000, v42
    v_lshlrev_b32 v30, 16, v43
    v_and_b32 v31, 0xffff0000, v43
    v_add_f32 v96, v96, v24
    v_add_f32 v97, v97, v25
    v_add_f32 v98, v98, v26
    v_add_f32 v99, v99, v27
    v_add_f32 v100, v100, v28
    v_add_f32 v101, v101, v29
    v_add_f32 v102, v102, v30
    v_add_f32 v103, v103, v31
    v_cvt_pk_bf16_f32 v80, v96, v97
    v_cvt_pk_bf16_f32 v81, v98, v99
    v_cvt_pk_bf16_f32 v82, v100, v101
    v_cvt_pk_bf16_f32 v83, v102, v103
    v_lshlrev_b32 v96, 16, v80
    v_and_b32 v97, 0xffff0000, v80
    v_lshlrev_b32 v98, 16, v81
    v_and_b32 v99, 0xffff0000, v81
    v_lshlrev_b32 v100, 16, v82
    v_and_b32 v101, 0xffff0000, v82
    v_lshlrev_b32 v102, 16, v83
    v_and_b32 v103, 0xffff0000, v83
    s_add_u32 s58, s56, 8388608
    buffer_store_dwordx4 v[80:83], v0, s[8:11], s58 offen sc1
    v_add_f32 v66, v96, v97
    v_add_f32 v67, v98, v99
    v_add_f32 v68, v100, v101
    v_add_f32 v69, v102, v103
    v_add_f32 v66, v66, v67
    v_add_f32 v68, v68, v69
    v_add_f32 v66, v66, v68
    s_nop 1
    v_add_f32_dpp v66, v66, v66 row_ror:8 row_mask:0xf bank_mask:0xf
    s_nop 1
    v_add_f32_dpp v66, v66, v66 row_ror:4 row_mask:0xf bank_mask:0xf
    s_nop 1
    v_add_f32_dpp v66, v66, v66 row_ror:2 row_mask:0xf bank_mask:0xf
    s_nop 1
    v_add_f32_dpp v66, v66, v66 row_ror:1 row_mask:0xf bank_mask:0xf
    v_mov_b32 v67, v66
    s_nop 1
    v_permlane16_swap_b32 v66, v67
    v_add_f32 v66, v66, v67
    v_mov_b32 v67, v66
    s_nop 1
    v_permlane32_swap_b32 v66, v67
    v_add_f32 v66, v66, v67
    v_mul_f32 v68, 0x3b000000, v66
    v_sub_f32 v58, v96, v68
    v_sub_f32 v59, v97, v68
    v_sub_f32 v60, v98, v68
    v_sub_f32 v61, v99, v68
    v_sub_f32 v62, v100, v68
    v_sub_f32 v63, v101, v68
    v_sub_f32 v64, v102, v68
    v_sub_f32 v65, v103, v68
    v_mul_f32 v66, v58, v58
    v_mul_f32 v69, v59, v59
    v_fmac_f32 v66, v60, v60
    v_fmac_f32 v69, v61, v61
    v_fmac_f32 v66, v62, v62
    v_fmac_f32 v69, v63, v63
    v_fmac_f32 v66, v64, v64
    v_fmac_f32 v69, v65, v65
    v_add_f32 v66, v66, v69
    v_cvt_pk_bf16_f32 v68, v68, v68
    v_and_b32 v68, 0xffff0000, v68
    v_add_f32_dpp v66, v66, v66 row_ror:8 row_mask:0xf bank_mask:0xf
    s_nop 1
    v_add_f32_dpp v66, v66, v66 row_ror:4 row_mask:0xf bank_mask:0xf
    s_nop 1
    v_add_f32_dpp v66, v66, v66 row_ror:2 row_mask:0xf bank_mask:0xf
    s_nop 1
    v_add_f32_dpp v66, v66, v66 row_ror:1 row_mask:0xf bank_mask:0xf
    v_mov_b32 v67, v66
    s_nop 1
    v_permlane16_swap_b32 v66, v67
    v_add_f32 v66, v66, v67
    v_mov_b32 v67, v66
    s_nop 1
    v_permlane32_swap_b32 v66, v67
    v_add_f32 v66, v66, v67
    v_mul_f32 v66, 0x3b000000, v66
    v_cvt_pk_bf16_f32 v66, v66, v66
    v_and_b32 v66, 0xffff0000, v66
    v_add_f32 v66, 0x3727c5ac, v66
    v_cvt_pk_bf16_f32 v66, v66, v66
    v_and_b32 v66, 0xffff0000, v66
    v_sqrt_f32 v66, v66
    v_sub_f32 v58, v96, v68
    v_sub_f32 v59, v97, v68
    v_sub_f32 v60, v98, v68
    v_sub_f32 v61, v99, v68
    v_sub_f32 v62, v100, v68
    v_sub_f32 v63, v101, v68
    v_sub_f32 v64, v102, v68
    v_sub_f32 v65, v103, v68
    v_cvt_pk_bf16_f32 v66, v66, v66
    v_and_b32 v66, 0xffff0000, v66
    v_rcp_f32 v66, v66
    v_cvt_pk_bf16_f32 v84, v58, v59
    v_cvt_pk_bf16_f32 v85, v60, v61
    v_cvt_pk_bf16_f32 v86, v62, v63
    v_cvt_pk_bf16_f32 v87, v64, v65
    v_lshlrev_b32 v58, 16, v84
    v_and_b32 v59, 0xffff0000, v84
    v_lshlrev_b32 v60, 16, v85
    v_and_b32 v61, 0xffff0000, v85
    v_lshlrev_b32 v62, 16, v86
    v_and_b32 v63, 0xffff0000, v86
    v_lshlrev_b32 v64, 16, v87
    v_and_b32 v65, 0xffff0000, v87
    v_mul_f32 v58, v58, v66
    v_mul_f32 v59, v59, v66
    v_mul_f32 v60, v60, v66
    v_mul_f32 v61, v61, v66
    v_mul_f32 v62, v62, v66
    v_mul_f32 v63, v63, v66
    v_mul_f32 v64, v64, v66
    v_mul_f32 v65, v65, v66
    v_cvt_pk_bf16_f32 v84, v58, v59
    v_cvt_pk_bf16_f32 v85, v60, v61
    v_cvt_pk_bf16_f32 v86, v62, v63
    v_cvt_pk_bf16_f32 v87, v64, v65
    buffer_store_dwordx4 v[84:87], v20, s[8:11], s57 offen sc1
L_moed_27:
L_nm_25:
    s_waitcnt vmcnt(0) lgkmcnt(0)
    s_barrier
    s_add_u32 s50, s50, 256
    s_cmp_lg_u32 s46, 0
    s_cbranch_scc1 L_gbd_31
    v_mov_b32 v124, 128
    v_mov_b32 v125, 1
    s_mov_b64 exec, 1
    buffer_atomic_add v125, v124, s[12:15], 0 offen
    s_mov_b64 exec, -1
L_gb_30:
    buffer_load_dword v125, v124, s[12:15], 0 offen sc1
    s_waitcnt vmcnt(0)
    v_readfirstlane_b32 s56, v125
    s_cmp_ge_u32 s56, s50
    s_cbranch_scc1 L_gbd_31
    s_sleep 4
    s_sub_u32 s49, s49, 1
    s_cmp_gt_i32 s49, 0
    s_cbranch_scc1 L_gb_30
    s_branch L_abort
L_gbd_31:
    s_barrier
    s_mov_b32 s52, 1
    s_mov_b32 s51, s48
L_t1_32:
    s_lshl_b32 s56, s51, 15
    s_lshl_b32 s57, s52, 21
    s_add_u32 s56, s56, s57
    buffer_load_dwordx4 v[72:75], v0, s[8:11], s56 offen offset:0 sc1
    buffer_load_dwordx4 v[76:79], v0, s[8:11], s56 offen offset:1024 sc1
    buffer_load_dwordx4 v[80:83], v0, s[8:11], s56 offen offset:2048 sc1
    buffer_load_dwordx4 v[84:87], v0, s[8:11], s56 offen offset:3072 sc1
    s_add_u32 s56, s56, 4096
    buffer_load_dwordx4 v[88:91], v0, s[8:11], s56 offen offset:0 sc1
    buffer_load_dwordx4 v[92:95], v0, s[8:11], s56 offen offset:1024 sc1
    buffer_load_dwordx4 v[96:99], v0, s[8:11], s56 offen offset:2048 sc1
    buffer_load_dwordx4 v[100:103], v0, s[8:11], s56 offen offset:3072 sc1
    s_add_u32 s56, s56, 4096
    buffer_load_dwordx4 v[104:107], v0, s[8:11], s56 offen offset:0 sc1
    buffer_load_dwordx4 v[108:111], v0, s[8:11], s56 offen offset:1024 sc1
    buffer_load_dwordx4 v[112:115], v0, s[8:11], s56 offen offset:2048 sc1
    buffer_load_dwordx4 v[116:119], v0, s[8:11], s56 offen offset:3072 sc1
    s_add_u32 s56, s56, 4096
    buffer_load_dwordx4 v[120:123], v0, s[8:11], s56 offen offset:0 sc1
    buffer_load_dwordx4 v[124:127], v0, s[8:11], s56 offen offset:1024 sc1
    s_lshl_b32 s58, s51, 5
    s_add_u32 s58, s58, s47
    s_mul_i32 s58, s58, 24576
    s_mul_i32 s59, s52, 50331648
    s_add_u32 s58, s58, s59
    s_add_u32 s58, s58, 100663296
    s_lshl_b32 s60, s46, 10
    s_add_u32 s61, s58, s60
    s_add_u32 s62, s61, 4096
    s_add_u32 s63, s61, 16384
    s_add_u32 s64, s61, 20480
    s_add_u32 s65, s61, s60
    s_add_u32 s65, s65, 8192
    s_waitcnt vmcnt(12)
    v_mfma_f32_16x16x32_bf16 v[40:43], a[128:131], v[72:75], 0
    v_mfma_f32_16x16x32_bf16 v[56:59], v[72:75], v[128:131], 0
    v_mfma_f32_16x16x32_bf16 v[24:27], a[0:3], v[72:75], 0
    v_mfma_f32_16x16x32_bf16 v[44:47], a[128:131], v[76:79], 0
    v_mfma_f32_16x16x32_bf16 v[60:63], v[76:79], v[128:131], 0
    v_mfma_f32_16x16x32_bf16 v[28:31], a[0:3], v[76:79], 0
    v_mfma_f32_16x16x32_bf16 v[48:51], a[136:139], v[72:75], 0
    v_mfma_f32_16x16x32_bf16 v[64:67], v[72:75], v[136:139], 0
    v_mfma_f32_16x16x32_bf16 v[32:35], a[8:11], v[72:75], 0
    v_mfma_f32_16x16x32_bf16 v[52:55], a[136:139], v[76:79], 0
    v_mfma_f32_16x16x32_bf16 v[68:71], v[76:79], v[136:139], 0
    v_mfma_f32_16x16x32_bf16 v[36:39], a[8:11], v[76:79], 0
    buffer_load_dwordx4 v[72:75], v0, s[8:11], s56 offen offset:2048 sc1
    buffer_load_dwordx4 v[76:79], v0, s[8:11], s56 offen offset:3072 sc1
    s_waitcnt vmcnt(12)
    v_mfma_f32_16x16x32_bf16 v[40:43], a[132:135], v[80:83], v[40:43]
    v_mfma_f32_16x16x32_bf16 v[56:59], v[80:83], v[132:135], v[56:59]
    v_mfma_f32_16x16x32_bf16 v[24:27], a[4:7], v[80:83], v[24:27]
    v_mfma_f32_16x16x32_bf16 v[44:47], a[132:135], v[84:87], v[44:47]
    v_mfma_f32_16x16x32_bf16 v[60:63], v[84:87], v[132:135], v[60:63]
    v_mfma_f32_16x16x32_bf16 v[28:31], a[4:7], v[84:87], v[28:31]
    v_mfma_f32_16x16x32_bf16 v[48:51], a[140:143], v[80:83], v[48:51]
    v_mfma_f32_16x16x32_bf16 v[64:67], v[80:83], v[140:143], v[64:67]
    v_mfma_f32_16x16x32_bf16 v[32:35], a[12:15], v[80:83], v[32:35]
    v_mfma_f32_16x16x32_bf16 v[52:55], a[140:143], v[84:87], v[52:55]
    v_mfma_f32_16x16x32_bf16 v[68:71], v[84:87], v[140:143], v[68:71]
    v_mfma_f32_16x16x32_bf16 v[36:39], a[12:15], v[84:87], v[36:39]
    s_add_u32 s56, s56, 4096
    buffer_load_dwordx4 v[80:83], v0, s[8:11], s56 offen offset:0 sc1
    buffer_load_dwordx4 v[84:87], v0, s[8:11], s56 offen offset:1024 sc1
    s_waitcnt vmcnt(12)
    v_mfma_f32_16x16x32_bf16 v[40:43], a[144:147], v[88:91], v[40:43]
    v_mfma_f32_16x16x32_bf16 v[56:59], v[88:91], v[144:147], v[56:59]
    v_mfma_f32_16x16x32_bf16 v[24:27], a[16:19], v[88:91], v[24:27]
    v_mfma_f32_16x16x32_bf16 v[44:47], a[144:147], v[92:95], v[44:47]
    v_mfma_f32_16x16x32_bf16 v[60:63], v[92:95], v[144:147], v[60:63]
    v_mfma_f32_16x16x32_bf16 v[28:31], a[16:19], v[92:95], v[28:31]
    v_mfma_f32_16x16x32_bf16 v[48:51], a[152:155], v[88:91], v[48:51]
    v_mfma_f32_16x16x32_bf16 v[64:67], v[88:91], v[152:155], v[64:67]
    v_mfma_f32_16x16x32_bf16 v[32:35], a[24:27], v[88:91], v[32:35]
    v_mfma_f32_16x16x32_bf16 v[52:55], a[152:155], v[92:95], v[52:55]
    v_mfma_f32_16x16x32_bf16 v[68:71], v[92:95], v[152:155], v[68:71]
    v_mfma_f32_16x16x32_bf16 v[36:39], a[24:27], v[92:95], v[36:39]
    buffer_load_dwordx4 v[88:91], v0, s[8:11], s56 offen offset:2048 sc1
    buffer_load_dwordx4 v[92:95], v0, s[8:11], s56 offen offset:3072 sc1
    s_waitcnt vmcnt(12)
    v_mfma_f32_16x16x32_bf16 v[40:43], a[148:151], v[96:99], v[40:43]
    v_mfma_f32_16x16x32_bf16 v[56:59], v[96:99], v[148:151], v[56:59]
    v_mfma_f32_16x16x32_bf16 v[24:27], a[20:23], v[96:99], v[24:27]
    v_mfma_f32_16x16x32_bf16 v[44:47], a[148:151], v[100:103], v[44:47]
    v_mfma_f32_16x16x32_bf16 v[60:63], v[100:103], v[148:151], v[60:63]
    v_mfma_f32_16x16x32_bf16 v[28:31], a[20:23], v[100:103], v[28:31]
    v_mfma_f32_16x16x32_bf16 v[48:51], a[156:159], v[96:99], v[48:51]
    v_mfma_f32_16x16x32_bf16 v[64:67], v[96:99], v[156:159], v[64:67]
    v_mfma_f32_16x16x32_bf16 v[32:35], a[28:31], v[96:99], v[32:35]
    v_mfma_f32_16x16x32_bf16 v[52:55], a[156:159], v[100:103], v[52:55]
    v_mfma_f32_16x16x32_bf16 v[68:71], v[100:103], v[156:159], v[68:71]
    v_mfma_f32_16x16x32_bf16 v[36:39], a[28:31], v[100:103], v[36:39]
    s_add_u32 s56, s56, 4096
    buffer_load_dwordx4 v[96:99], v0, s[8:11], s56 offen offset:0 sc1
    buffer_load_dwordx4 v[100:103], v0, s[8:11], s56 offen offset:1024 sc1
    s_waitcnt vmcnt(12)
    v_mfma_f32_16x16x32_bf16 v[40:43], a[160:163], v[104:107], v[40:43]
    v_mfma_f32_16x16x32_bf16 v[56:59], v[104:107], v[160:163], v[56:59]
    v_mfma_f32_16x16x32_bf16 v[24:27], a[32:35], v[104:107], v[24:27]
    v_mfma_f32_16x16x32_bf16 v[44:47], a[160:163], v[108:111], v[44:47]
    v_mfma_f32_16x16x32_bf16 v[60:63], v[108:111], v[160:163], v[60:63]
    v_mfma_f32_16x16x32_bf16 v[28:31], a[32:35], v[108:111], v[28:31]
    v_mfma_f32_16x16x32_bf16 v[48:51], a[168:171], v[104:107], v[48:51]
    v_mfma_f32_16x16x32_bf16 v[64:67], v[104:107], v[168:171], v[64:67]
    v_mfma_f32_16x16x32_bf16 v[32:35], a[40:43], v[104:107], v[32:35]
    v_mfma_f32_16x16x32_bf16 v[52:55], a[168:171], v[108:111], v[52:55]
    v_mfma_f32_16x16x32_bf16 v[68:71], v[108:111], v[168:171], v[68:71]
    v_mfma_f32_16x16x32_bf16 v[36:39], a[40:43], v[108:111], v[36:39]
    buffer_load_dwordx4 v[104:107], v0, s[8:11], s56 offen offset:2048 sc1
    buffer_load_dwordx4 v[108:111], v0, s[8:11], s56 offen offset:3072 sc1
    s_waitcnt vmcnt(12)
    v_mfma_f32_16x16x32_bf16 v[40:43], a[164:167], v[112:115], v[40:43]
    v_mfma_f32_16x16x32_bf16 v[56:59], v[112:115], v[164:167], v[56:59]
    v_mfma_f32_16x16x32_bf16 v[24:27], a[36:39], v[112:115], v[24:27]
    v_mfma_f32_16x16x32_bf16 v[44:47], a[164:167], v[116:119], v[44:47]
    v_mfma_f32_16x16x32_bf16 v[60:63], v[116:119], v[164:167], v[60:63]
    v_mfma_f32_16x16x32_bf16 v[28:31], a[36:39], v[116:119], v[28:31]
    v_mfma_f32_16x16x32_bf16 v[48:51], a[172:175], v[112:115], v[48:51]
    v_mfma_f32_16x16x32_bf16 v[64:67], v[112:115], v[172:175], v[64:67]
    v_mfma_f32_16x16x32_bf16 v[32:35], a[44:47], v[112:115], v[32:35]
    v_mfma_f32_16x16x32_bf16 v[52:55], a[172:175], v[116:119], v[52:55]
    v_mfma_f32_16x16x32_bf16 v[68:71], v[116:119], v[172:175], v[68:71]
    v_mfma_f32_16x16x32_bf16 v[36:39], a[44:47], v[116:119], v[36:39]
    s_add_u32 s56, s56, 4096
    buffer_load_dwordx4 v[112:115], v0, s[8:11], s56 offen offset:0 sc1
    buffer_load_dwordx4 v[116:119], v0, s[8:11], s56 offen offset:1024 sc1
    s_waitcnt vmcnt(12)
    v_mfma_f32_16x16x32_bf16 v[40:43], a[176:179], v[120:123], v[40:43]
    v_mfma_f32_16x16x32_bf16 v[56:59], v[120:123], v[176:179], v[56:59]
    v_mfma_f32_16x16x32_bf16 v[24:27], a[48:51], v[120:123], v[24:27]
    v_mfma_f32_16x16x32_bf16 v[44:47], a[176:179], v[124:127], v[44:47]
    v_mfma_f32_16x16x32_bf16 v[60:63], v[124:127], v[176:179], v[60:63]
    v_mfma_f32_16x16x32_bf16 v[28:31], a[48:51], v[124:127], v[28:31]
    v_mfma_f32_16x16x32_bf16 v[48:51], a[184:187], v[120:123], v[48:51]
    v_mfma_f32_16x16x32_bf16 v[64:67], v[120:123], v[184:187], v[64:67]
    v_mfma_f32_16x16x32_bf16 v[32:35], a[56:59], v[120:123], v[32:35]
    v_mfma_f32_16x16x32_bf16 v[52:55], a[184:187], v[124:127], v[52:55]
    v_mfma_f32_16x16x32_bf16 v[68:71], v[124:127], v[184:187], v[68:71]
    v_mfma_f32_16x16x32_bf16 v[36:39], a[56:59], v[124:127], v[36:39]
    buffer_load_dwordx4 v[120:123], v0, s[8:11], s56 offen offset:2048 sc1
    buffer_load_dwordx4 v[124:127], v0, s[8:11], s56 offen offset:3072 sc1
    s_waitcnt vmcnt(12)
    v_mfma_f32_16x16x32_bf16 v[40:43], a[180:183], v[72:75], v[40:43]
    v_mfma_f32_16x16x32_bf16 v[56:59], v[72:75], v[180:183], v[56:59]
    v_mfma_f32_16x16x32_bf16 v[24:27], a[52:55], v[72:75], v[24:27]
    v_mfma_f32_16x16x32_bf16 v[44:47], a[180:183], v[76:79], v[44:47]
    v_mfma_f32_16x16x32_bf16 v[60:63], v[76:79], v[180:183], v[60:63]
    v_mfma_f32_16x16x32_bf16 v[28:31], a[52:55], v[76:79], v[28:31]
    v_mfma_f32_16x16x32_bf16 v[48:51], a[188:191], v[72:75], v[48:51]
    v_mfma_f32_16x16x32_bf16 v[64:67], v[72:75], v[188:191], v[64:67]
    v_mfma_f32_16x16x32_bf16 v[32:35], a[60:63], v[72:75], v[32:35]
    v_mfma_f32_16x16x32_bf16 v[52:55], a[188:191], v[76:79], v[52:55]
    v_mfma_f32_16x16x32_bf16 v[68:71], v[76:79], v[188:191], v[68:71]
    v_mfma_f32_16x16x32_bf16 v[36:39], a[60:63], v[76:79], v[36:39]
    s_add_u32 s56, s56, 4096
    buffer_load_dwordx4 v[72:75], v0, s[8:11], s56 offen offset:0 sc1
    buffer_load_dwordx4 v[76:79], v0, s[8:11], s56 offen offset:1024 sc1
    s_waitcnt vmcnt(12)
    v_mfma_f32_16x16x32_bf16 v[40:43], a[192:195], v[80:83], v[40:43]
    v_mfma_f32_16x16x32_bf16 v[56:59], v[80:83], v[192:195], v[56:59]
    v_mfma_f32_16x16x32_bf16 v[24:27], a[64:67], v[80:83], v[24:27]
    v_mfma_f32_16x16x32_bf16 v[44:47], a[192:195], v[84:87], v[44:47]
    v_mfma_f32_16x16x32_bf16 v[60:63], v[84:87], v[192:195], v[60:63]
    v_mfma_f32_16x16x32_bf16 v[28:31], a[64:67], v[84:87], v[28:31]
    v_mfma_f32_16x16x32_bf16 v[48:51], a[200:203], v[80:83], v[48:51]
    v_mfma_f32_16x16x32_bf16 v[64:67], v[80:83], v[200:203], v[64:67]
    v_mfma_f32_16x16x32_bf16 v[32:35], a[72:75], v[80:83], v[32:35]
    v_mfma_f32_16x16x32_bf16 v[52:55], a[200:203], v[84:87], v[52:55]
    v_mfma_f32_16x16x32_bf16 v[68:71], v[84:87], v[200:203], v[68:71]
    v_mfma_f32_16x16x32_bf16 v[36:39], a[72:75], v[84:87], v[36:39]
    buffer_load_dwordx4 v[80:83], v0, s[8:11], s56 offen offset:2048 sc1
    buffer_load_dwordx4 v[84:87], v0, s[8:11], s56 offen offset:3072 sc1
    s_waitcnt vmcnt(12)
    v_mfma_f32_16x16x32_bf16 v[40:43], a[196:199], v[88:91], v[40:43]
    v_mfma_f32_16x16x32_bf16 v[56:59], v[88:91], v[196:199], v[56:59]
    v_mfma_f32_16x16x32_bf16 v[24:27], a[68:71], v[88:91], v[24:27]
    v_mfma_f32_16x16x32_bf16 v[44:47], a[196:199], v[92:95], v[44:47]
    v_mfma_f32_16x16x32_bf16 v[60:63], v[92:95], v[196:199], v[60:63]
    v_mfma_f32_16x16x32_bf16 v[28:31], a[68:71], v[92:95], v[28:31]
    v_mfma_f32_16x16x32_bf16 v[48:51], a[204:207], v[88:91], v[48:51]
    v_mfma_f32_16x16x32_bf16 v[64:67], v[88:91], v[204:207], v[64:67]
    v_mfma_f32_16x16x32_bf16 v[32:35], a[76:79], v[88:91], v[32:35]
    v_mfma_f32_16x16x32_bf16 v[52:55], a[204:207], v[92:95], v[52:55]
    v_mfma_f32_16x16x32_bf16 v[68:71], v[92:95], v[204:207], v[68:71]
    v_mfma_f32_16x16x32_bf16 v[36:39], a[76:79], v[92:95], v[36:39]
    s_waitcnt vmcnt(10)
    v_mfma_f32_16x16x32_bf16 v[40:43], a[208:211], v[96:99], v[40:43]
    v_mfma_f32_16x16x32_bf16 v[56:59], v[96:99], v[208:211], v[56:59]
    v_mfma_f32_16x16x32_bf16 v[24:27], a[80:83], v[96:99], v[24:27]
    v_mfma_f32_16x16x32_bf16 v[44:47], a[208:211], v[100:103], v[44:47]
    v_mfma_f32_16x16x32_bf16 v[60:63], v[100:103], v[208:211], v[60:63]
    v_mfma_f32_16x16x32_bf16 v[28:31], a[80:83], v[100:103], v[28:31]
    v_mfma_f32_16x16x32_bf16 v[48:51], a[216:219], v[96:99], v[48:51]
    v_mfma_f32_16x16x32_bf16 v[64:67], v[96:99], v[216:219], v[64:67]
    v_mfma_f32_16x16x32_bf16 v[32:35], a[88:91], v[96:99], v[32:35]
    v_mfma_f32_16x16x32_bf16 v[52:55], a[216:219], v[100:103], v[52:55]
    v_mfma_f32_16x16x32_bf16 v[68:71], v[100:103], v[216:219], v[68:71]
    v_mfma_f32_16x16x32_bf16 v[36:39], a[88:91], v[100:103], v[36:39]
    s_waitcnt vmcnt(8)
    v_mfma_f32_16x16x32_bf16 v[40:43], a[212:215], v[104:107], v[40:43]
    v_mfma_f32_16x16x32_bf16 v[56:59], v[104:107], v[212:215], v[56:59]
    v_mfma_f32_16x16x32_bf16 v[24:27], a[84:87], v[104:107], v[24:27]
    v_mfma_f32_16x16x32_bf16 v[44:47], a[212:215], v[108:111], v[44:47]
    v_mfma_f32_16x16x32_bf16 v[60:63], v[108:111], v[212:215], v[60:63]
    v_mfma_f32_16x16x32_bf16 v[28:31], a[84:87], v[108:111], v[28:31]
    v_mfma_f32_16x16x32_bf16 v[48:51], a[220:223], v[104:107], v[48:51]
    v_mfma_f32_16x16x32_bf16 v[64:67], v[104:107], v[220:223], v[64:67]
    v_mfma_f32_16x16x32_bf16 v[32:35], a[92:95], v[104:107], v[32:35]
    v_mfma_f32_16x16x32_bf16 v[52:55], a[220:223], v[108:111], v[52:55]
    v_mfma_f32_16x16x32_bf16 v[68:71], v[108:111], v[220:223], v[68:71]
    v_mfma_f32_16x16x32_bf16 v[36:39], a[92:95], v[108:111], v[36:39]
    s_waitcnt vmcnt(6)
    v_mfma_f32_16x16x32_bf16 v[40:43], a[224:227], v[112:115], v[40:43]
    v_mfma_f32_16x16x32_bf16 v[56:59], v[112:115], v[224:227], v[56:59]
    v_mfma_f32_16x16x32_bf16 v[24:27], a[96:99], v[112:115], v[24:27]
    v_mfma_f32_16x16x32_bf16 v[44:47], a[224:227], v[116:119], v[44:47]
    v_mfma_f32_16x16x32_bf16 v[60:63], v[116:119], v[224:227], v[60:63]
    v_mfma_f32_16x16x32_bf16 v[28:31], a[96:99], v[116:119], v[28:31]
    v_mfma_f32_16x16x32_bf16 v[48:51], a[232:235], v[112:115], v[48:51]
    v_mfma_f32_16x16x32_bf16 v[64:67], v[112:115], v[232:235], v[64:67]
    v_mfma_f32_16x16x32_bf16 v[32:35], a[104:107], v[112:115], v[32:35]
    v_mfma_f32_16x16x32_bf16 v[52:55], a[232:235], v[116:119], v[52:55]
    v_mfma_f32_16x16x32_bf16 v[68:71], v[116:119], v[232:235], v[68:71]
    v_mfma_f32_16x16x32_bf16 v[36:39], a[104:107], v[116:119], v[36:39]
    s_waitcnt vmcnt(4)
    v_mfma_f32_16x16x32_bf16 v[40:43], a[228:231], v[120:123], v[40:43]
    v_mfma_f32_16x16x32_bf16 v[56:59], v[120:123], v[228:231], v[56:59]
    v_mfma_f32_16x16x32_bf16 v[24:27], a[100:103], v[120:123], v[24:27]
    v_mfma_f32_16x16x32_bf16 v[44:47], a[228:231], v[124:127], v[44:47]
    v_mfma_f32_16x16x32_bf16 v[60:63], v[124:127], v[228:231], v[60:63]
    v_mfma_f32_16x16x32_bf16 v[28:31], a[100:103], v[124:127], v[28:31]
    v_mfma_f32_16x16x32_bf16 v[48:51], a[236:239], v[120:123], v[48:51]
    v_mfma_f32_16x16x32_bf16 v[64:67], v[120:123], v[236:239], v[64:67]
    v_mfma_f32_16x16x32_bf16 v[32:35], a[108:111], v[120:123], v[32:35]
    v_mfma_f32_16x16x32_bf16 v[52:55], a[236:239], v[124:127], v[52:55]
    v_mfma_f32_16x16x32_bf16 v[68:71], v[124:127], v[236:239], v[68:71]
    v_mfma_f32_16x16x32_bf16 v[36:39], a[108:111], v[124:127], v[36:39]
    s_waitcnt vmcnt(2)
    v_mfma_f32_16x16x32_bf16 v[40:43], a[240:243], v[72:75], v[40:43]
    v_mfma_f32_16x16x32_bf16 v[56:59], v[72:75], v[240:243], v[56:59]
    v_mfma_f32_16x16x32_bf16 v[24:27], a[112:115], v[72:75], v[24:27]
    v_mfma_f32_16x16x32_bf16 v[44:47], a[240:243], v[76:79], v[44:47]
    v_mfma_f32_16x16x32_bf16 v[60:63], v[76:79], v[240:243], v[60:63]
    v_mfma_f32_16x16x32_bf16 v[28:31], a[112:115], v[76:79], v[28:31]
    v_mfma_f32_16x16x32_bf16 v[48:51], a[248:251], v[72:75], v[48:51]
    v_mfma_f32_16x16x32_bf16 v[64:67], v[72:75], v[248:251], v[64:67]
    v_mfma_f32_16x16x32_bf16 v[32:35], a[120:123], v[72:75], v[32:35]
    v_mfma_f32_16x16x32_bf16 v[52:55], a[248:251], v[76:79], v[52:55]
    v_mfma_f32_16x16x32_bf16 v[68:71], v[76:79], v[248:251], v[68:71]
    v_mfma_f32_16x16x32_bf16 v[36:39], a[120:123], v[76:79], v[36:39]
    s_waitcnt vmcnt(0)
    v_mfma_f32_16x16x32_bf16 v[40:43], a[244:247], v[80:83], v[40:43]
    v_mfma_f32_16x16x32_bf16 v[56:59], v[80:83], v[244:247], v[56:59]
    v_mfma_f32_16x16x32_bf16 v[24:27], a[116:119], v[80:83], v[24:27]
    v_mfma_f32_16x16x32_bf16 v[44:47], a[244:247], v[84:87], v[44:47]
    v_mfma_f32_16x16x32_bf16 v[60:63], v[84:87], v[244:247], v[60:63]
    v_mfma_f32_16x16x32_bf16 v[28:31], a[116:119], v[84:87], v[28:31]
    v_mfma_f32_16x16x32_bf16 v[48:51], a[252:255], v[80:83], v[48:51]
    v_mfma_f32_16x16x32_bf16 v[64:67], v[80:83], v[252:255], v[64:67]
    v_mfma_f32_16x16x32_bf16 v[32:35], a[124:127], v[80:83], v[32:35]
    v_mfma_f32_16x16x32_bf16 v[52:55], a[252:255], v[84:87], v[52:55]
    v_mfma_f32_16x16x32_bf16 v[68:71], v[84:87], v[252:255], v[68:71]
    v_mfma_f32_16x16x32_bf16 v[36:39], a[124:127], v[84:87], v[36:39]
    v_cvt_pk_bf16_f32 v72, v40, v48
    v_cvt_pk_bf16_f32 v73, v41, v49
    v_cvt_pk_bf16_f32 v74, v42, v50
    v_cvt_pk_bf16_f32 v75, v43, v51
    buffer_store_dwordx4 v[72:75], v0, s[8:11], s61 offen sc1
    v_cvt_pk_bf16_f32 v76, v44, v52
    v_cvt_pk_bf16_f32 v77, v45, v53
    v_cvt_pk_bf16_f32 v78, v46, v54
    v_cvt_pk_bf16_f32 v79, v47, v55
    buffer_store_dwordx4 v[76:79], v0, s[8:11], s62 offen sc1
    v_cvt_pk_bf16_f32 v88, v56, v57
    v_cvt_pk_bf16_f32 v89, v58, v59
    v_cvt_pk_bf16_f32 v90, v60, v61
    v_cvt_pk_bf16_f32 v91, v62, v63
    buffer_store_dwordx4 v[88:91], v0, s[8:11], s65 offen offset:0 sc1
    v_cvt_pk_bf16_f32 v92, v64, v65
    v_cvt_pk_bf16_f32 v93, v66, v67
    v_cvt_pk_bf16_f32 v94, v68, v69
    v_cvt_pk_bf16_f32 v95, v70, v71
    buffer_store_dwordx4 v[92:95], v0, s[8:11], s65 offen offset:1024 sc1
    v_cvt_pk_bf16_f32 v80, v24, v32
    v_cvt_pk_bf16_f32 v81, v25, v33
    v_cvt_pk_bf16_f32 v82, v26, v34
    v_cvt_pk_bf16_f32 v83, v27, v35
    buffer_store_dwordx4 v[80:83], v0, s[8:11], s63 offen sc1
    v_cvt_pk_bf16_f32 v84, v28, v36
    v_cvt_pk_bf16_f32 v85, v29, v37
    v_cvt_pk_bf16_f32 v86, v30, v38
    v_cvt_pk_bf16_f32 v87, v31, v39
    buffer_store_dwordx4 v[84:87], v0, s[8:11], s64 offen sc1
    s_add_u32 s51, s51, 8
    s_cmp_lt_u32 s51, 64
    s_cbranch_scc1 L_t1_32
    s_waitcnt vmcnt(0) lgkmcnt(0)
    s_barrier
    s_add_u32 s50, s50, 256
    s_cmp_lg_u32 s46, 0
    s_cbranch_scc1 L_gbd_34
    v_mov_b32 v124, 128
    v_mov_b32 v125, 1
    s_mov_b64 exec, 1
    buffer_atomic_add v125, v124, s[12:15], 0 offen
    s_mov_b64 exec, -1
L_gb_33:
    buffer_load_dword v125, v124, s[12:15], 0 offen sc1
    s_waitcnt vmcnt(0)
    v_readfirstlane_b32 s56, v125
    s_cmp_ge_u32 s56, s50
    s_cbranch_scc1 L_gbd_34
    s_sleep 4
    s_sub_u32 s49, s49, 1
    s_cmp_gt_i32 s49, 0
    s_cbranch_scc1 L_gb_33
    s_branch L_abort
L_gbd_34:
    s_barrier
    s_cmp_lg_u32 s48, 0
    s_cbranch_scc1 L_nc_35
    v_and_b32 v120, 15, v1
    v_lshrrev_b32 v121, 4, v1
    v_and_b32 v122, 8, v1
    v_cmp_eq_u32 vcc, 0, v122
    v_mov_b32 v2, 0xdddd
    v_mov_b32 v123, 0x8888
    v_cndmask_b32 v2, v2, v123, vcc
    v_lshrrev_b32 v122, 1, v120
    v_bfe_u32 v123, v120, 2, 1
    v_xor_b32 v123, v123, v122
    v_lshlrev_b32 v3, 7, v123
    v_and_b32 v123, 1, v120
    v_lshl_add_u32 v3, v123, 6, v3
    v_xor_b32 v123, v121, v122
    v_and_b32 v123, 3, v123
    v_lshl_add_u32 v3, v123, 4, v3
    s_lshl_b32 s56, s46, 10
    s_add_u32 s56, s56, 147456
    v_add_u32 v3, s56, v3
    v_lshlrev_b32 v122, 1, v121
    v_add_u32 v122, 0, v122
    v_and_b32 v123, 1, v121
    v_xor_b32 v123, v123, v122
    v_lshlrev_b32 v4, 7, v123
    v_bfe_u32 v123, v120, 3, 1
    v_lshl_add_u32 v4, v123, 6, v4
    v_xor_b32 v123, v120, v122
    v_and_b32 v123, 3, v123
    v_lshl_add_u32 v4, v123, 4, v4
    v_bfe_u32 v123, v120, 2, 1
    v_lshl_add_u32 v4, v123, 3, v4
    v_add_u32 v4, 147456, v4
    v_lshlrev_b32 v122, 1, v121
    v_add_u32 v122, 1, v122
    v_and_b32 v123, 1, v121
    v_xor_b32 v123, v123, v122
    v_lshlrev_b32 v5, 7, v123
    v_bfe_u32 v123, v120, 3, 1
    v_lshl_add_u32 v5, v123, 6, v5
    v_xor_b32 v123, v120, v122
    v_and_b32 v123, 3, v123
    v_lshl_add_u32 v5, v123, 4, v5
    v_bfe_u32 v123, v120, 2, 1
    v_lshl_add_u32 v5, v123, 3, v5
    v_add_u32 v5, 147456, v5
    v_lshrrev_b32 v122, 1, v121
    v_lshlrev_b32 v6, 8, v122
    v_and_b32 v122, 7, v120
    v_lshl_add_u32 v6, v122, 4, v6
    v_and_b32 v122, 1, v121
    v_lshl_add_u32 v6, v122, 3, v6
    v_and_b32 v122, 8, v120
    v_lshl_add_u32 v6, v122, 8, v6
    s_lshl_b32 s56, s46, 9
    s_add_u32 s56, s56, 151552
    v_add_u32 v6, s56, v6
    v_lshrrev_b32 v122, 1, v121
    v_lshlrev_b32 v7, 13, v122
    v_and_b32 v122, 1, v121
    v_lshl_add_u32 v7, v122, 7, v7
    v_bfe_u32 v122, v120, 3, 1
    v_lshl_add_u32 v7, v122, 6, v7
    v_and_b32 v122, 3, v120
    v_lshl_add_u32 v7, v122, 4, v7
    v_bfe_u32 v122, v120, 2, 1
    v_lshl_add_u32 v7, v122, 3, v7
    s_lshl_b32 s56, s46, 14
    s_lshl_b32 s57, s47, 8
    s_add_u32 s56, s56, s57
    v_add_u32 v7, s56, v7
    v_and_b32 v122, 1, v121
    v_lshlrev_b32 v8, 8, v122
    v_lshrrev_b32 v122, 1, v121
    v_lshl_add_u32 v8, v122, 6, v8
    v_and_b32 v122, 3, v120
    v_lshl_add_u32 v8, v122, 4, v8
    v_bfe_u32 v122, v120, 2, 1
    v_lshl_add_u32 v8, v122, 3, v8
    v_and_b32 v122, 8, v120
    v_lshl_add_u32 v8, v122, 28, v8
    s_lshr_b32 s56, s47, 1
    s_lshl_b32 s56, s56, 9
    s_and_b32 s57, s47, 1
    s_lshl_b32 s57, s57, 7
    s_add_u32 s56, s56, s57
    v_add_u32 v8, s56, v8
    s_lshl_b32 s56, s46, 15
    v_add_u32 v9, s56, v0
    v_add_u32 v10, 131072, v0
    v_and_b32 v120, 15, v1
    v_and_b32 v121, 1, v1
    v_lshlrev_b32 v121, 4, v121
    v_mov_b32 v122, 0x3f80
    v_lshlrev_b32 v122, v121, v122
    v_lshrrev_b32 v120, 1, v120
    v_cmp_eq_u32 vcc, 0, v120
    s_nop 1
    v_cndmask_b32 v12, 0, v122, vcc
    v_cmp_eq_u32 vcc, 1, v120
    s_nop 1
    v_cndmask_b32 v13, 0, v122, vcc
    v_cmp_eq_u32 vcc, 2, v120
    s_nop 1
    v_cndmask_b32 v14, 0, v122, vcc
    v_cmp_eq_u32 vcc, 3, v120
    s_nop 1
    v_cndmask_b32 v15, 0, v122, vcc
    v_cmp_gt_u32 vcc, 32, v1
    v_mov_b32 v17, 0xf149f2ca
    s_nop 0
    v_cndmask_b32 v16, 0, v17, vcc
    v_mov_b32 v17, v16
    v_mov_b32 v18, v16
    v_mov_b32 v19, v16
    v_mov_b32 v20, 0x3f803f80
    v_mov_b32 v21, 0x3f803f80
    v_mov_b32 v22, 0x3f803f80
    v_mov_b32 v23, 0x3f803f80
    s_mov_b32 s51, 0
    s_mov_b32 s64, 12582912
    s_mov_b32 s65, 15728640
    s_lshl_b32 s68, s47, 13
    s_lshl_b32 s56, s46, 10
    s_add_u32 s68, s68, s56
    s_add_u32 s68, s68, 58720256
    s_lshl_b32 s56, s51, 5
    s_add_u32 s56, s56, s47
    s_mul_i32 s56, s56, 24576
    s_mul_i32 s57, s52, 50331648
    s_add_u32 s56, s56, s57
    s_add_u32 s56, s56, 100663296
    s_lshl_b32 s57, s46, 11
    s_add_u32 s67, s56, s57
    s_lshl_b32 s56, s46, 11
    s_add_u32 m0, s56, 131072
    s_add_u32 s57, s67, 8192
    buffer_load_dwordx4 v0, s[8:11], s67 offen sc1 lds
    buffer_load_dwordx4 v0, s[8:11], s67 offen offset:1024 sc1 lds
    s_add_u32 m0, s56, 139264
    s_add_u32 s67, s67, 786432
    buffer_load_dwordx4 v0, s[8:11], s57 offen sc1 lds
    buffer_load_dwordx4 v0, s[8:11], s57 offen offset:1024 sc1 lds
L_chain_36:
    s_waitcnt vmcnt(0)
    s_barrier
    ds_read_b128 v[56:59], v10 offset:0
    ds_read_b128 v[60:63], v10 offset:1024
    ds_read_b128 v[64:67], v10 offset:2048
    ds_read_b128 v[68:71], v10 offset:3072
    ds_read_b128 v[72:75], v10 offset:4096
    ds_read_b128 v[76:79], v10 offset:5120
    ds_read_b128 v[80:83], v10 offset:6144
    ds_read_b128 v[84:87], v10 offset:7168
    s_lshl_b32 s56, s46, 11
    v_add_u32 v120, s56, v10
    ds_read_b128 v[88:91], v120 offset:8192
    ds_read_b128 v[92:95], v120 offset:9216
    v_mov_b32 v96, 0
    v_mov_b32 v97, 0
    v_mov_b32 v98, 0
    v_mov_b32 v99, 0
    v_mov_b32 v100, 0
    v_mov_b32 v101, 0
    v_mov_b32 v102, 0
    v_mov_b32 v103, 0
    v_mov_b32 v104, 0
    v_mov_b32 v105, 0
    v_mov_b32 v106, 0
    v_mov_b32 v107, 0
    v_mov_b32 v108, 0
    v_mov_b32 v109, 0
    v_mov_b32 v110, 0
    v_mov_b32 v111, 0
    v_mov_b32 v112, 0
    v_mov_b32 v113, 0
    v_mov_b32 v114, 0
    v_mov_b32 v115, 0
    v_mov_b32 v116, 0
    v_mov_b32 v117, 0
    v_mov_b32 v118, 0
    v_mov_b32 v119, 0
    s_add_u32 s56, s64, 4096
L_cpoll_37:
    buffer_load_dwordx4 v[24:27], v0, s[8:11], s64 offen offset:0 sc1
    buffer_load_dwordx4 v[28:31], v0, s[8:11], s64 offen offset:1024 sc1
    buffer_load_dwordx4 v[32:35], v0, s[8:11], s64 offen offset:2048 sc1
    buffer_load_dwordx4 v[36:39], v0, s[8:11], s64 offen offset:3072 sc1
    buffer_load_dwordx4 v[40:43], v0, s[8:11], s56 offen offset:0 sc1
    buffer_load_dwordx4 v[44:47], v0, s[8:11], s56 offen offset:1024 sc1
    buffer_load_dwordx4 v[48:51], v0, s[8:11], s56 offen offset:2048 sc1
    buffer_load_dwordx4 v[52:55], v0, s[8:11], s56 offen offset:3072 sc1
    s_waitcnt vmcnt(0)
    v_max_u32 v120, v24, v26
    v_max3_u32 v120, v28, v30, v120
    v_max3_u32 v120, v32, v34, v120
    v_max3_u32 v120, v36, v38, v120
    v_max3_u32 v120, v40, v42, v120
    v_max3_u32 v120, v44, v46, v120
    v_max3_u32 v120, v48, v50, v120
    v_max3_u32 v120, v52, v54, v120
    v_cmp_eq_u32 vcc, -1, v120
    s_cbranch_vccnz L_cpb_41
    v_smfmac_f32_16x16x64_bf16 v[96:99], v[24:27], a[0:7], v2
    v_smfmac_f32_16x16x64_bf16 v[100:103], v[24:27], a[128:135], v2
    v_smfmac_f32_16x16x64_bf16 v[104:107], v[24:27], a[8:15], v2
    v_smfmac_f32_16x16x64_bf16 v[108:111], v[24:27], a[136:143], v2
    v_smfmac_f32_16x16x64_bf16 v[96:99], v[28:31], a[16:23], v2
    v_smfmac_f32_16x16x64_bf16 v[100:103], v[28:31], a[144:151], v2
    v_smfmac_f32_16x16x64_bf16 v[104:107], v[28:31], a[24:31], v2
    v_smfmac_f32_16x16x64_bf16 v[108:111], v[28:31], a[152:159], v2
    v_smfmac_f32_16x16x64_bf16 v[96:99], v[32:35], a[32:39], v2
    v_smfmac_f32_16x16x64_bf16 v[100:103], v[32:35], a[160:167], v2
    v_smfmac_f32_16x16x64_bf16 v[104:107], v[32:35], a[40:47], v2
    v_smfmac_f32_16x16x64_bf16 v[108:111], v[32:35], a[168:175], v2
    v_smfmac_f32_16x16x64_bf16 v[96:99], v[36:39], a[48:55], v2
    v_smfmac_f32_16x16x64_bf16 v[100:103], v[36:39], a[176:183], v2
    v_smfmac_f32_16x16x64_bf16 v[104:107], v[36:39], a[56:63], v2
    v_smfmac_f32_16x16x64_bf16 v[108:111], v[36:39], a[184:191], v2
    v_smfmac_f32_16x16x64_bf16 v[96:99], v[40:43], a[64:71], v2
    v_smfmac_f32_16x16x64_bf16 v[100:103], v[40:43], a[192:199], v2
    v_smfmac_f32_16x16x64_bf16 v[104:107], v[40:43], a[72:79], v2
    v_smfmac_f32_16x16x64_bf16 v[108:111], v[40:43], a[200:207], v2
    v_smfmac_f32_16x16x64_bf16 v[96:99], v[44:47], a[80:87], v2
    v_smfmac_f32_16x16x64_bf16 v[100:103], v[44:47], a[208:215], v2
    v_smfmac_f32_16x16x64_bf16 v[104:107], v[44:47], a[88:95], v2
    v_smfmac_f32_16x16x64_bf16 v[108:111], v[44:47], a[216:223], v2
    v_smfmac_f32_16x16x64_bf16 v[96:99], v[48:51], a[96:103], v2
    v_smfmac_f32_16x16x64_bf16 v[100:103], v[48:51], a[224:231], v2
    v_smfmac_f32_16x16x64_bf16 v[104:107], v[48:51], a[104:111], v2
    v_smfmac_f32_16x16x64_bf16 v[108:111], v[48:51], a[232:239], v2
    v_smfmac_f32_16x16x64_bf16 v[96:99], v[52:55], a[112:119], v2
    v_smfmac_f32_16x16x64_bf16 v[100:103], v[52:55], a[240:247], v2
    v_smfmac_f32_16x16x64_bf16 v[104:107], v[52:55], a[120:127], v2
    v_smfmac_f32_16x16x64_bf16 v[108:111], v[52:55], a[248:255], v2
    v_smfmac_f32_16x16x64_bf16 v[112:115], v[24:27], v[128:135], v2
    v_smfmac_f32_16x16x64_bf16 v[116:119], v[24:27], v[136:143], v2
    v_permlane32_swap_b32 v96, v100
    v_permlane32_swap_b32 v97, v101
    v_permlane32_swap_b32 v98, v102
    v_permlane32_swap_b32 v99, v103
    v_pk_add_f32 v[96:97], v[96:97], v[100:101]
    v_pk_add_f32 v[98:99], v[98:99], v[102:103]
    v_cvt_pk_bf16_f32 v120, v96, v97
    v_cvt_pk_bf16_f32 v121, v98, v99
    v_permlane32_swap_b32 v104, v108
    v_permlane32_swap_b32 v105, v109
    v_permlane32_swap_b32 v106, v110
    v_permlane32_swap_b32 v107, v111
    v_pk_add_f32 v[104:105], v[104:105], v[108:109]
    v_pk_add_f32 v[106:107], v[106:107], v[110:111]
    v_cvt_pk_bf16_f32 v122, v104, v105
    v_cvt_pk_bf16_f32 v123, v106, v107
    ds_write_b128 v3, v[120:123]
    v_smfmac_f32_16x16x64_bf16 v[112:115], v[28:31], v[144:151], v2
    v_smfmac_f32_16x16x64_bf16 v[116:119], v[28:31], v[152:159], v2
    v_smfmac_f32_16x16x64_bf16 v[112:115], v[32:35], v[160:167], v2
    v_smfmac_f32_16x16x64_bf16 v[116:119], v[32:35], v[168:175], v2
    s_waitcnt lgkmcnt(0)
    s_barrier
    ds_read_b64_tr_b16 v[96:97], v4 offset:0
    ds_read_b64_tr_b16 v[98:99], v5 offset:0
    ds_read_b64_tr_b16 v[100:101], v4 offset:1024
    ds_read_b64_tr_b16 v[102:103], v5 offset:1024
    ds_read_b64_tr_b16 v[104:105], v4 offset:2048
    ds_read_b64_tr_b16 v[106:107], v5 offset:2048
    ds_read_b64_tr_b16 v[108:109], v4 offset:3072
    ds_read_b64_tr_b16 v[110:111], v5 offset:3072
    v_smfmac_f32_16x16x64_bf16 v[112:115], v[36:39], v[176:183], v2
    v_smfmac_f32_16x16x64_bf16 v[116:119], v[36:39], v[184:191], v2
    v_smfmac_f32_16x16x64_bf16 v[112:115], v[40:43], v[192:199], v2
    v_smfmac_f32_16x16x64_bf16 v[116:119], v[40:43], v[200:207], v2
    s_waitcnt lgkmcnt(6)
    v_mfma_f32_16x16x32_bf16 v[24:27], v[56:59], v[96:99], 0
    v_mfma_f32_16x16x32_bf16 v[28:31], v[72:75], v[96:99], 0
    v_mfma_f32_16x16x32_bf16 v[32:35], v[96:99], v[96:99], v[16:19]
    s_waitcnt lgkmcnt(4)
    v_mfma_f32_16x16x32_bf16 v[24:27], v[60:63], v[100:103], v[24:27]
    v_mfma_f32_16x16x32_bf16 v[28:31], v[76:79], v[100:103], v[28:31]
    v_mfma_f32_16x16x32_bf16 v[32:35], v[100:103], v[100:103], v[32:35]
    s_waitcnt lgkmcnt(2)
    v_mfma_f32_16x16x32_bf16 v[24:27], v[64:67], v[104:107], v[24:27]
    v_mfma_f32_16x16x32_bf16 v[28:31], v[80:83], v[104:107], v[28:31]
    v_mfma_f32_16x16x32_bf16 v[32:35], v[104:107], v[104:107], v[32:35]
    s_waitcnt lgkmcnt(0)
    v_mfma_f32_16x16x32_bf16 v[24:27], v[68:71], v[108:111], v[24:27]
    v_mfma_f32_16x16x32_bf16 v[28:31], v[84:87], v[108:111], v[28:31]
    v_mfma_f32_16x16x32_bf16 v[32:35], v[108:111], v[108:111], v[32:35]
    v_smfmac_f32_16x16x64_bf16 v[112:115], v[44:47], v[208:215], v2
    v_smfmac_f32_16x16x64_bf16 v[116:119], v[44:47], v[216:223], v2
    v_smfmac_f32_16x16x64_bf16 v[112:115], v[48:51], v[224:231], v2
    v_smfmac_f32_16x16x64_bf16 v[116:119], v[48:51], v[232:239], v2
    v_smfmac_f32_16x16x64_bf16 v[112:115], v[52:55], v[240:247], v2
    v_smfmac_f32_16x16x64_bf16 v[116:119], v[52:55], v[248:255], v2
    s_xor_b32 s69, s65, 262144
    s_lshl_b32 s56, s47, 13
    s_add_u32 s69, s69, s56
    s_add_u32 s66, s65, s56
    s_lshl_b32 s56, s46, 11
    s_add_u32 s69, s69, s56
    v_mov_b32 v120, -1
    v_mov_b32 v121, -1
    v_mov_b32 v122, -1
    v_mov_b32 v123, -1
    buffer_store_dwordx4 v[120:123], v0, s[8:11], s69 offen
    buffer_store_dwordx4 v[120:123], v0, s[8:11], s69 offen offset:1024
    s_lshl_b32 s56, s46, 11
    s_add_u32 m0, s56, 131072
    s_add_u32 s57, s67, 8192
    buffer_load_dwordx4 v0, s[8:11], s67 offen sc1 lds
    buffer_load_dwordx4 v0, s[8:11], s67 offen offset:1024 sc1 lds
    s_add_u32 m0, s56, 139264
    s_add_u32 s67, s67, 786432
    buffer_load_dwordx4 v0, s[8:11], s57 offen sc1 lds
    buffer_load_dwordx4 v0, s[8:11], s57 offen offset:1024 sc1 lds
    ds_read_b128 v[56:59], v9 offset:0
    ds_read_b128 v[60:63], v9 offset:1024
    ds_read_b128 v[64:67], v9 offset:2048
    ds_read_b128 v[68:71], v9 offset:3072
    ds_read_b128 v[72:75], v9 offset:4096
    ds_read_b128 v[76:79], v9 offset:5120
    ds_read_b128 v[80:83], v9 offset:6144
    ds_read_b128 v[84:87], v9 offset:7168
    v_max3_f32 v36, v24, v25, v26
    v_max3_f32 v37, v27, v28, v29
    v_max3_f32 v36, v30, v31, v36
    v_max3_f32 v37, v32, v33, v37
    v_max3_f32 v36, v34, v35, v36
    v_max_f32 v36, v36, v37
    v_mov_b32 v37, v36
    s_nop 1
    v_permlane16_swap_b32 v36, v37
    v_max_f32 v36, v36, v37
    v_mov_b32 v37, v36
    s_nop 1
    v_permlane32_swap_b32 v36, v37
    v_max_f32 v36, v36, v37
    v_mul_f32 v36, s80, v36
    v_fma_f32 v32, v32, s80, -v36
    v_fma_f32 v33, v33, s80, -v36
    v_exp_f32 v32, v32
    v_fma_f32 v34, v34, s80, -v36
    v_exp_f32 v33, v33
    v_fma_f32 v35, v35, s80, -v36
    v_exp_f32 v34, v34
    v_fma_f32 v24, v24, s80, -v36
    v_exp_f32 v35, v35
    v_fma_f32 v25, v25, s80, -v36
    v_exp_f32 v24, v24
    v_cvt_pk_bf16_f32 v124, v32, v33
    v_cvt_pk_bf16_f32 v125, v34, v35
    v_cvt_pk_bf16_f32 v126, v32, v33
    v_cvt_pk_bf16_f32 v127, v34, v35
    v_fma_f32 v26, v26, s80, -v36
    v_exp_f32 v25, v25
    v_fma_f32 v27, v27, s80, -v36
    v_exp_f32 v26, v26
    v_permlane32_swap_b32 v126, v124
    v_permlane32_swap_b32 v127, v125
    v_fma_f32 v28, v28, s80, -v36
    v_exp_f32 v27, v27
    v_fma_f32 v29, v29, s80, -v36
    v_exp_f32 v28, v28
    v_fma_f32 v30, v30, s80, -v36
    v_exp_f32 v29, v29
    v_fma_f32 v31, v31, s80, -v36
    v_exp_f32 v30, v30
    v_exp_f32 v31, v31
    v_cvt_pk_bf16_f32 v120, v24, v25
    v_cvt_pk_bf16_f32 v121, v26, v27
    v_cvt_pk_bf16_f32 v122, v28, v29
    v_cvt_pk_bf16_f32 v123, v30, v31
    v_cvt_pk_bf16_f32 v36, v112, v113
    v_cvt_pk_bf16_f32 v37, v114, v115
    v_cvt_pk_bf16_f32 v38, v116, v117
    v_cvt_pk_bf16_f32 v39, v118, v119
    v_mov_b32 v126, 0x3f003f00
    v_mov_b32 v127, 0x3f003f00
    v_mfma_f32_16x16x32_bf16 v[32:35], v[20:23], v[120:123], 0
    v_mfma_f32_16x16x32_bf16 v[24:27], v[88:91], v[120:123], 0
    v_mfma_f32_16x16x32_bf16 v[28:31], v[92:95], v[120:123], 0
    v_mfma_f32_16x16x16_bf16 v[32:35], v[126:127], v[124:125], v[32:35]
    v_mfma_f32_16x16x16_bf16 v[24:27], v[36:37], v[124:125], v[24:27]
    v_mfma_f32_16x16x16_bf16 v[28:31], v[38:39], v[124:125], v[28:31]
    s_add_u32 s56, s68, 4096
    buffer_store_dwordx4 v[36:39], v0, s[8:11], s56 offen sc1
    v_rcp_f32 v32, v32
    s_nop 0
    v_mov_b32 v33, v32
    v_pk_mul_f32 v[24:25], v[24:25], v[32:33]
    v_pk_mul_f32 v[26:27], v[26:27], v[32:33]
    v_cvt_pk_bf16_f32 v120, v24, v25
    v_cvt_pk_bf16_f32 v121, v26, v27
    v_pk_mul_f32 v[28:29], v[28:29], v[32:33]
    v_pk_mul_f32 v[30:31], v[30:31], v[32:33]
    v_cvt_pk_bf16_f32 v122, v28, v29
    v_cvt_pk_bf16_f32 v123, v30, v31
    ds_write2_b64 v6, v[120:121], v[122:123] offset0:0 offset1:16
    s_lshl_b32 s56, s46, 10
    v_add_u32 v124, s56, v4
    v_add_u32 v125, s56, v5
    ds_read_b64_tr_b16 v[88:89], v124
    ds_read_b64_tr_b16 v[90:91], v125
    v_mov_b32 v112, 0
    v_mov_b32 v113, 0
    v_mov_b32 v114, 0
    v_mov_b32 v115, 0
    v_mov_b32 v116, 0
    v_mov_b32 v117, 0
    v_mov_b32 v118, 0
    v_mov_b32 v119, 0
    v_mov_b32 v24, 0
    v_mov_b32 v25, 0
    v_mov_b32 v26, 0
    v_mov_b32 v27, 0
    v_mov_b32 v28, 0
    v_mov_b32 v29, 0
    v_mov_b32 v30, 0
    v_mov_b32 v31, 0
    s_waitcnt lgkmcnt(0) vmcnt(5)
    s_barrier
    ds_read_b128 v[120:123], v10 offset:20480
    ds_read_b128 v[124:127], v10 offset:21504
    buffer_store_dwordx4 v[88:91], v0, s[8:11], s68 offen sc1
    s_cmp_eq_u32 s51, 63
    s_cbranch_scc1 L_cend_38
    ds_read_b128 v[96:99], v9 offset:8192
    ds_read_b128 v[100:103], v9 offset:9216
    ds_read_b128 v[104:107], v9 offset:10240
    ds_read_b128 v[108:111], v9 offset:11264
    ds_read_b128 v[40:43], v9 offset:12288
    ds_read_b128 v[44:47], v9 offset:13312
    ds_read_b128 v[48:51], v9 offset:14336
    ds_read_b128 v[52:55], v9 offset:15360
    v_mov_b32 v32, 0
    v_mov_b32 v33, 0
    v_mov_b32 v34, 0
    v_mov_b32 v35, 0
    v_mov_b32 v36, 0
    v_mov_b32 v37, 0
    v_mov_b32 v38, 0
    v_mov_b32 v39, 0
    v_mov_b32 v88, 0
    v_mov_b32 v89, 0
    v_mov_b32 v90, 0
    v_mov_b32 v91, 0
    v_mov_b32 v92, 0
    v_mov_b32 v93, 0
    v_mov_b32 v94, 0
    v_mov_b32 v95, 0
    s_waitcnt lgkmcnt(8)
    v_smfmac_f32_16x16x64_bf16 v[112:115], v[120:123], v[56:63], v2
    v_smfmac_f32_16x16x64_bf16 v[116:119], v[120:123], v[72:79], v2
    v_smfmac_f32_16x16x64_bf16 v[112:115], v[124:127], v[64:71], v2
    v_smfmac_f32_16x16x64_bf16 v[116:119], v[124:127], v[80:87], v2
    ds_read_b128 v[56:59], v9 offset:16384
    ds_read_b128 v[60:63], v9 offset:17408
    ds_read_b128 v[64:67], v9 offset:18432
    ds_read_b128 v[68:71], v9 offset:19456
    ds_read_b128 v[72:75], v9 offset:20480
    ds_read_b128 v[76:79], v9 offset:21504
    ds_read_b128 v[80:83], v9 offset:22528
    ds_read_b128 v[84:87], v9 offset:23552
    s_waitcnt lgkmcnt(8)
    v_smfmac_f32_16x16x64_bf16 v[24:27], v[120:123], v[96:103], v2
    v_smfmac_f32_16x16x64_bf16 v[28:31], v[120:123], v[40:47], v2
    v_smfmac_f32_16x16x64_bf16 v[24:27], v[124:127], v[104:111], v2
    v_smfmac_f32_16x16x64_bf16 v[28:31], v[124:127], v[48:55], v2
    v_permlane32_swap_b32 v112, v116
    v_permlane32_swap_b32 v113, v117
    v_permlane32_swap_b32 v114, v118
    v_permlane32_swap_b32 v115, v119
    v_pk_add_f32 v[112:113], v[112:113], v[116:117]
    v_pk_add_f32 v[114:115], v[114:115], v[118:119]
    v_cvt_pk_bf16_f32 v112, v112, v113
    v_cvt_pk_bf16_f32 v113, v114, v115
    s_add_u32 s56, s65, 0
    buffer_store_dwordx2 v[112:113], v7, s[8:11], s56 offen
    ds_read_b128 v[96:99], v9 offset:24576
    ds_read_b128 v[100:103], v9 offset:25600
    ds_read_b128 v[104:107], v9 offset:26624
    ds_read_b128 v[108:111], v9 offset:27648
    ds_read_b128 v[40:43], v9 offset:28672
    ds_read_b128 v[44:47], v9 offset:29696
    ds_read_b128 v[48:51], v9 offset:30720
    ds_read_b128 v[52:55], v9 offset:31744
    s_waitcnt lgkmcnt(8)
    v_smfmac_f32_16x16x64_bf16 v[32:35], v[120:123], v[56:63], v2
    v_smfmac_f32_16x16x64_bf16 v[36:39], v[120:123], v[72:79], v2
    v_smfmac_f32_16x16x64_bf16 v[32:35], v[124:127], v[64:71], v2
    v_smfmac_f32_16x16x64_bf16 v[36:39], v[124:127], v[80:87], v2
    v_permlane32_swap_b32 v24, v28
    v_permlane32_swap_b32 v25, v29
    v_permlane32_swap_b32 v26, v30
    v_permlane32_swap_b32 v27, v31
    v_pk_add_f32 v[24:25], v[24:25], v[28:29]
    v_pk_add_f32 v[26:27], v[26:27], v[30:31]
    v_cvt_pk_bf16_f32 v24, v24, v25
    v_cvt_pk_bf16_f32 v25, v26, v27
    s_add_u32 s56, s65, 65536
    buffer_store_dwordx2 v[24:25], v7, s[8:11], s56 offen
    s_waitcnt lgkmcnt(0)
    v_smfmac_f32_16x16x64_bf16 v[88:91], v[120:123], v[96:103], v2
    v_smfmac_f32_16x16x64_bf16 v[92:95], v[120:123], v[40:47], v2
    v_smfmac_f32_16x16x64_bf16 v[88:91], v[124:127], v[104:111], v2
    v_smfmac_f32_16x16x64_bf16 v[92:95], v[124:127], v[48:55], v2
    v_permlane32_swap_b32 v32, v36
    v_permlane32_swap_b32 v33, v37
    v_permlane32_swap_b32 v34, v38
    v_permlane32_swap_b32 v35, v39
    v_pk_add_f32 v[32:33], v[32:33], v[36:37]
    v_pk_add_f32 v[34:35], v[34:35], v[38:39]
    v_cvt_pk_bf16_f32 v32, v32, v33
    v_cvt_pk_bf16_f32 v33, v34, v35
    s_add_u32 s56, s65, 131072
    buffer_store_dwordx2 v[32:33], v7, s[8:11], s56 offen
    v_permlane32_swap_b32 v88, v92
    v_permlane32_swap_b32 v89, v93
    v_permlane32_swap_b32 v90, v94
    v_permlane32_swap_b32 v91, v95
    v_pk_add_f32 v[88:89], v[88:89], v[92:93]
    v_pk_add_f32 v[90:91], v[90:91], v[94:95]
    v_cvt_pk_bf16_f32 v88, v88, v89
    v_cvt_pk_bf16_f32 v89, v90, v91
    s_add_u32 s56, s65, 196608
    buffer_store_dwordx2 v[88:89], v7, s[8:11], s56 offen
    s_add_u32 s64, s64, 8192
    s_add_u32 s68, s68, 262144
    s_add_u32 s51, s51, 1
    s_xor_b32 s65, s65, 262144
    s_cmp_lg_u32 s46, 0
    s_cbranch_scc1 L_cnr_40
    s_add_u32 s56, s66, 4096
L_crp_39:
    buffer_load_dwordx4 v[56:59], v0, s[8:11], s66 offen offset:0 sc1
    buffer_load_dwordx4 v[60:63], v0, s[8:11], s66 offen offset:1024 sc1
    buffer_load_dwordx4 v[64:67], v0, s[8:11], s66 offen offset:2048 sc1
    buffer_load_dwordx4 v[68:71], v0, s[8:11], s66 offen offset:3072 sc1
    buffer_load_dwordx4 v[72:75], v0, s[8:11], s56 offen offset:0 sc1
    buffer_load_dwordx4 v[76:79], v0, s[8:11], s56 offen offset:1024 sc1
    buffer_load_dwordx4 v[80:83], v0, s[8:11], s56 offen offset:2048 sc1
    buffer_load_dwordx4 v[84:87], v0, s[8:11], s56 offen offset:3072 sc1
    s_waitcnt vmcnt(7)
    v_mfma_f32_16x16x32_bf16 v[120:123], v[56:59], v[12:15], 0
    s_waitcnt vmcnt(6)
    v_mfma_f32_16x16x32_bf16 v[120:123], v[60:63], v[12:15], v[120:123]
    s_waitcnt vmcnt(5)
    v_mfma_f32_16x16x32_bf16 v[120:123], v[64:67], v[12:15], v[120:123]
    s_waitcnt vmcnt(4)
    v_mfma_f32_16x16x32_bf16 v[120:123], v[68:71], v[12:15], v[120:123]
    s_waitcnt vmcnt(3)
    v_mfma_f32_16x16x32_bf16 v[120:123], v[72:75], v[12:15], v[120:123]
    s_waitcnt vmcnt(2)
    v_mfma_f32_16x16x32_bf16 v[120:123], v[76:79], v[12:15], v[120:123]
    s_waitcnt vmcnt(1)
    v_mfma_f32_16x16x32_bf16 v[120:123], v[80:83], v[12:15], v[120:123]
    s_waitcnt vmcnt(0)
    v_mfma_f32_16x16x32_bf16 v[120:123], v[84:87], v[12:15], v[120:123]
    s_nop 7
    v_cvt_pk_bf16_f32 v124, v120, v121
    v_cvt_pk_bf16_f32 v125, v122, v123
    v_add_f32 v120, v120, v121
    v_add_f32 v122, v122, v123
    v_cmp_u_f32 vcc, v120, v122
    s_cbranch_vccnz L_crb_42
    buffer_store_dwordx2 v[124:125], v8, s[8:11], s64 offen
L_cnr_40:
    s_branch L_chain_36
L_cpb_41:
    s_sub_u32 s49, s49, 1
    s_cmp_gt_i32 s49, 0
    s_cbranch_scc1 L_cpoll_37
    s_branch L_abort
L_crb_42:
    s_sub_u32 s49, s49, 1
    s_cmp_gt_i32 s49, 0
    s_cbranch_scc1 L_crp_39
    s_branch L_abort
L_cend_38:
    s_nop 11
L_nc_35:
    s_waitcnt vmcnt(0) lgkmcnt(0)
    s_barrier
    s_add_u32 s50, s50, 256
    s_cmp_lg_u32 s46, 0
    s_cbranch_scc1 L_gbd_44
    v_mov_b32 v124, 128
    v_mov_b32 v125, 1
    s_mov_b64 exec, 1
    buffer_atomic_add v125, v124, s[12:15], 0 offen
    s_mov_b64 exec, -1
L_gb_43:
    buffer_load_dword v125, v124, s[12:15], 0 offen sc1
    s_waitcnt vmcnt(0)
    v_readfirstlane_b32 s56, v125
    s_cmp_ge_u32 s56, s50
    s_cbranch_scc1 L_gbd_44
    s_sleep 4
    s_sub_u32 s49, s49, 1
    s_cmp_gt_i32 s49, 0
    s_cbranch_scc1 L_gb_43
    s_branch L_abort
L_gbd_44:
    s_barrier
    v_cmp_gt_u32 vcc, 32, v1
    v_mov_b32 v5, 0xf149f2ca
    s_nop 0
    v_cndmask_b32 v4, 0, v5, vcc
    v_mov_b32 v5, v4
    v_mov_b32 v6, v4
    v_mov_b32 v7, v4
    v_and_b32 v120, 15, v1
    v_lshrrev_b32 v121, 4, v1
    v_lshlrev_b32 v122, 2, v121
    v_mov_b32 v123, 0xf149f2ca
    s_and_b32 s56, s46, 1
    s_lshl_b32 s56, s56, 4
    v_add_u32 v124, s56, v120
    v_add_u32 v125, 0, v122
    v_cmp_gt_u32 vcc, v125, v124
    s_nop 1
    v_cndmask_b32 v8, 0, v123, vcc
    v_add_u32 v125, 1, v122
    v_cmp_gt_u32 vcc, v125, v124
    s_nop 1
    v_cndmask_b32 v9, 0, v123, vcc
    v_add_u32 v125, 2, v122
    v_cmp_gt_u32 vcc, v125, v124
    s_nop 1
    v_cndmask_b32 v10, 0, v123, vcc
    v_add_u32 v125, 3, v122
    v_cmp_gt_u32 vcc, v125, v124
    s_nop 1
    v_cndmask_b32 v11, 0, v123, vcc
    v_add_u32 v125, 16, v122
    v_cmp_gt_u32 vcc, v125, v124
    s_nop 1
    v_cndmask_b32 v12, 0, v123, vcc
    v_add_u32 v125, 17, v122
    v_cmp_gt_u32 vcc, v125, v124
    s_nop 1
    v_cndmask_b32 v13, 0, v123, vcc
    v_add_u32 v125, 18, v122
    v_cmp_gt_u32 vcc, v125, v124
    s_nop 1
    v_cndmask_b32 v14, 0, v123, vcc
    v_add_u32 v125, 19, v122
    v_cmp_gt_u32 vcc, v125, v124
    s_nop 1
    v_cndmask_b32 v15, 0, v123, vcc
    s_and_b32 s56, s46, 1
    s_lshl_b32 s56, s56, 12
    s_lshr_b32 s57, s46, 1
    s_lshl_b32 s57, s57, 11
    s_add_u32 s56, s56, s57
    s_add_u32 s56, s56, 131072
    v_add_u32 v16, s56, v0
    v_add_u32 v17, 131072, v0
    s_lshl_b32 s56, s46, 15
    v_add_u32 v18, s56, v0
    v_lshlrev_b32 v19, 15, v120
    v_lshl_add_u32 v19, v121, 4, v19
    s_lshl_b32 s56, s46, 6
    v_add_u32 v19, s56, v19
    v_lshrrev_b32 v20, 2, v1
    v_lshlrev_b32 v20, 11, v20
    v_and_b32 v125, 3, v1
    v_lshl_add_u32 v20, v125, 8, v20
    v_lshlrev_b32 v21, 5, v120
    v_and_b32 v125, 1, v121
    v_lshl_add_u32 v21, v125, 4, v21
    v_lshrrev_b32 v125, 1, v121
    v_lshl_add_u32 v21, v125, 11, v21
    s_lshl_b32 s56, s46, 9
    s_add_u32 s56, s56, 139264
    v_add_u32 v21, s56, v21
    v_lshlrev_b32 v22, 4, v120
    v_lshl_add_u32 v22, v121, 10, v22
    s_lshl_b32 s56, s46, 8
    v_add_u32 v22, s56, v22
    s_mov_b32 s51, s48
    s_lshl_b32 s54, s48, 21
    s_add_u32 s54, s54, 20971520
    s_mov_b32 s55, 58720256
L_t2_45:
    s_lshl_b32 s56, s51, 5
    s_add_u32 s56, s56, s47
    s_mul_i32 s56, s56, 24576
    s_mul_i32 s57, s52, 50331648
    s_add_u32 s56, s56, s57
    s_add_u32 s56, s56, 100663296
    s_and_b32 s57, s46, 1
    s_lshl_b32 s57, s57, 12
    s_add_u32 s58, s56, s57
    s_add_u32 s58, s58, 16384
    s_add_u32 s59, s56, 4096
    s_lshr_b32 s57, s46, 1
    s_lshl_b32 s60, s57, 12
    s_add_u32 s60, s60, s56
    s_add_u32 s60, s60, 8192
    s_lshl_b32 s61, s51, 5
    s_add_u32 s61, s61, s47
    s_lshl_b32 s61, s61, 13
    s_add_u32 s61, s61, s55
    s_lshl_b32 s62, s57, 11
    s_add_u32 s62, s62, s61
    s_add_u32 s62, s62, 4096
    buffer_load_dwordx4 v[24:27], v0, s[8:11], s58 offen offset:0 sc1
    buffer_load_dwordx4 v[40:43], v0, s[8:11], s56 offen offset:0 sc1
    buffer_load_dwordx4 v[56:59], v0, s[8:11], s59 offen offset:0 sc1
    buffer_load_dwordx4 v[72:75], v0, s[8:11], s61 offen offset:0 sc1
    buffer_load_dwordx4 v[28:31], v0, s[8:11], s58 offen offset:1024 sc1
    buffer_load_dwordx4 v[44:47], v0, s[8:11], s56 offen offset:1024 sc1
    buffer_load_dwordx4 v[60:63], v0, s[8:11], s59 offen offset:1024 sc1
    buffer_load_dwordx4 v[76:79], v0, s[8:11], s61 offen offset:1024 sc1
    buffer_load_dwordx4 v[32:35], v0, s[8:11], s58 offen offset:2048 sc1
    buffer_load_dwordx4 v[48:51], v0, s[8:11], s56 offen offset:2048 sc1
    buffer_load_dwordx4 v[64:67], v0, s[8:11], s59 offen offset:2048 sc1
    buffer_load_dwordx4 v[80:83], v0, s[8:11], s61 offen offset:2048 sc1
    buffer_load_dwordx4 v[36:39], v0, s[8:11], s58 offen offset:3072 sc1
    buffer_load_dwordx4 v[52:55], v0, s[8:11], s56 offen offset:3072 sc1
    buffer_load_dwordx4 v[68:71], v0, s[8:11], s59 offen offset:3072 sc1
    buffer_load_dwordx4 v[84:87], v0, s[8:11], s61 offen offset:3072 sc1
    buffer_load_dwordx4 v[88:91], v0, s[8:11], s60 offen offset:0 sc1
    buffer_load_dwordx4 v[92:95], v0, s[8:11], s60 offen offset:1024 sc1
    buffer_load_dwordx4 v[96:99], v0, s[8:11], s60 offen offset:2048 sc1
    buffer_load_dwordx4 v[100:103], v0, s[8:11], s60 offen offset:3072 sc1
    buffer_load_dwordx4 v[104:107], v0, s[8:11], s62 offen offset:0 sc1
    buffer_load_dwordx4 v[108:111], v0, s[8:11], s62 offen offset:1024 sc1
    s_waitcnt vmcnt(18)
    v_mfma_f32_16x16x32_bf16 v[112:115], v[40:43], v[24:27], v[8:11]
    v_mfma_f32_16x16x32_bf16 v[116:119], v[56:59], v[24:27], v[12:15]
    v_mfma_f32_16x16x32_bf16 v[120:123], v[72:75], v[24:27], v[4:7]
    s_waitcnt vmcnt(14)
    v_mfma_f32_16x16x32_bf16 v[112:115], v[44:47], v[28:31], v[112:115]
    v_mfma_f32_16x16x32_bf16 v[116:119], v[60:63], v[28:31], v[116:119]
    v_mfma_f32_16x16x32_bf16 v[120:123], v[76:79], v[28:31], v[120:123]
    s_waitcnt vmcnt(10)
    v_mfma_f32_16x16x32_bf16 v[112:115], v[48:51], v[32:35], v[112:115]
    v_mfma_f32_16x16x32_bf16 v[116:119], v[64:67], v[32:35], v[116:119]
    v_mfma_f32_16x16x32_bf16 v[120:123], v[80:83], v[32:35], v[120:123]
    s_waitcnt vmcnt(6)
    v_mfma_f32_16x16x32_bf16 v[112:115], v[52:55], v[36:39], v[112:115]
    v_mfma_f32_16x16x32_bf16 v[116:119], v[68:71], v[36:39], v[116:119]
    v_mfma_f32_16x16x32_bf16 v[120:123], v[84:87], v[36:39], v[120:123]
    ds_read_b128 v[56:59], v18 offset:0
    ds_read_b128 v[60:63], v18 offset:4096
    ds_read_b128 v[64:67], v18 offset:1024
    ds_read_b128 v[68:71], v18 offset:5120
    ds_read_b128 v[72:75], v18 offset:2048
    ds_read_b128 v[76:79], v18 offset:6144
    ds_read_b128 v[80:83], v18 offset:3072
    ds_read_b128 v[84:87], v18 offset:7168
    v_max3_f32 v124, v112, v113, v114
    v_max3_f32 v125, v115, v116, v117
    v_max3_f32 v124, v118, v119, v124
    v_max3_f32 v125, v120, v121, v125
    v_max3_f32 v124, v122, v123, v124
    v_max_f32 v124, v124, v125
    v_mov_b32 v125, v124
    s_nop 1
    v_permlane16_swap_b32 v124, v125
    v_max_f32 v124, v124, v125
    v_mov_b32 v125, v124
    s_nop 1
    v_permlane32_swap_b32 v124, v125
    v_max_f32 v124, v124, v125
    v_mul_f32 v124, s80, v124
    v_fma_f32 v120, v120, s80, -v124
    v_fma_f32 v121, v121, s80, -v124
    v_exp_f32 v120, v120
    v_fma_f32 v122, v122, s80, -v124
    v_exp_f32 v121, v121
    v_fma_f32 v123, v123, s80, -v124
    v_exp_f32 v122, v122
    v_fma_f32 v112, v112, s80, -v124
    v_exp_f32 v123, v123
    v_fma_f32 v113, v113, s80, -v124
    v_exp_f32 v112, v112
    v_cvt_pk_bf16_f32 v48, v120, v121
    v_cvt_pk_bf16_f32 v49, v122, v123
    v_cvt_pk_bf16_f32 v50, v120, v121
    v_cvt_pk_bf16_f32 v51, v122, v123
    v_fma_f32 v114, v114, s80, -v124
    v_exp_f32 v113, v113
    v_fma_f32 v115, v115, s80, -v124
    v_exp_f32 v114, v114
    v_permlane32_swap_b32 v50, v48
    v_permlane32_swap_b32 v51, v49
    v_fma_f32 v116, v116, s80, -v124
    v_exp_f32 v115, v115
    v_fma_f32 v117, v117, s80, -v124
    v_exp_f32 v116, v116
    v_fma_f32 v118, v118, s80, -v124
    v_exp_f32 v117, v117
    v_fma_f32 v119, v119, s80, -v124
    v_exp_f32 v118, v118
    v_exp_f32 v119, v119
    v_cvt_pk_bf16_f32 v44, v112, v113
    v_cvt_pk_bf16_f32 v45, v114, v115
    v_cvt_pk_bf16_f32 v46, v116, v117
    v_cvt_pk_bf16_f32 v47, v118, v119
    v_mov_b32 v52, 0x3f803f80
    v_mov_b32 v53, 0x3f803f80
    v_mov_b32 v54, 0x3f803f80
    v_mov_b32 v55, 0x3f803f80
    v_mov_b32 v50, 0x3f003f00
    v_mov_b32 v51, 0x3f003f00
    s_waitcnt vmcnt(0)
    v_mfma_f32_16x16x32_bf16 v[40:43], v[52:55], v[44:47], 0
    v_mfma_f32_16x16x32_bf16 v[24:27], v[88:91], v[44:47], 0
    v_mfma_f32_16x16x32_bf16 v[28:31], v[92:95], v[44:47], 0
    v_mfma_f32_16x16x32_bf16 v[32:35], v[96:99], v[44:47], 0
    v_mfma_f32_16x16x32_bf16 v[36:39], v[100:103], v[44:47], 0
    v_mfma_f32_16x16x16_bf16 v[40:43], v[50:51], v[48:49], v[40:43]
    v_mfma_f32_16x16x16_bf16 v[24:27], v[104:105], v[48:49], v[24:27]
    v_mfma_f32_16x16x16_bf16 v[28:31], v[106:107], v[48:49], v[28:31]
    v_mfma_f32_16x16x16_bf16 v[32:35], v[108:109], v[48:49], v[32:35]
    v_mfma_f32_16x16x16_bf16 v[36:39], v[110:111], v[48:49], v[36:39]
    v_rcp_f32 v40, v40
    s_nop 0
    v_mov_b32 v41, v40
    v_pk_mul_f32 v[24:25], v[24:25], v[40:41]
    v_pk_mul_f32 v[26:27], v[26:27], v[40:41]
    v_pk_mul_f32 v[28:29], v[28:29], v[40:41]
    v_pk_mul_f32 v[30:31], v[30:31], v[40:41]
    v_cvt_pk_bf16_f32 v112, v24, v28
    v_cvt_pk_bf16_f32 v113, v25, v29
    v_cvt_pk_bf16_f32 v114, v26, v30
    v_cvt_pk_bf16_f32 v115, v27, v31
    ds_write_b128 v16, v[112:115] offset:0
    v_pk_mul_f32 v[32:33], v[32:33], v[40:41]
    v_pk_mul_f32 v[34:35], v[34:35], v[40:41]
    v_pk_mul_f32 v[36:37], v[36:37], v[40:41]
    v_pk_mul_f32 v[38:39], v[38:39], v[40:41]
    v_cvt_pk_bf16_f32 v116, v32, v36
    v_cvt_pk_bf16_f32 v117, v33, v37
    v_cvt_pk_bf16_f32 v118, v34, v38
    v_cvt_pk_bf16_f32 v119, v35, v39
    ds_write_b128 v16, v[116:119] offset:1024
    s_lshl_b32 s56, s47, 10
    s_add_u32 s56, s56, s54
    s_add_u32 s57, s56, 524288
    s_waitcnt lgkmcnt(0)
    s_barrier
    ds_read_b128 v[24:27], v17 offset:0
    ds_read_b128 v[28:31], v17 offset:4096
    ds_read_b128 v[32:35], v17 offset:1024
    ds_read_b128 v[36:39], v17 offset:5120
    ds_read_b128 v[40:43], v17 offset:2048
    ds_read_b128 v[44:47], v17 offset:6144
    ds_read_b128 v[48:51], v17 offset:3072
    ds_read_b128 v[52:55], v17 offset:7168
    s_waitcnt lgkmcnt(6)
    v_mfma_f32_16x16x32_bf16 v[88:91], v[56:59], v[24:27], 0
    v_mfma_f32_16x16x32_bf16 v[92:95], v[56:59], v[28:31], 0
    ds_read_b128 v[56:59], v18 offset:8192
    v_mfma_f32_16x16x32_bf16 v[96:99], v[60:63], v[24:27], 0
    v_mfma_f32_16x16x32_bf16 v[100:103], v[60:63], v[28:31], 0
    ds_read_b128 v[60:63], v18 offset:12288
    s_waitcnt lgkmcnt(6)
    v_mfma_f32_16x16x32_bf16 v[88:91], v[64:67], v[32:35], v[88:91]
    v_mfma_f32_16x16x32_bf16 v[92:95], v[64:67], v[36:39], v[92:95]
    ds_read_b128 v[64:67], v18 offset:9216
    v_mfma_f32_16x16x32_bf16 v[96:99], v[68:71], v[32:35], v[96:99]
    v_mfma_f32_16x16x32_bf16 v[100:103], v[68:71], v[36:39], v[100:103]
    ds_read_b128 v[68:71], v18 offset:13312
    s_waitcnt lgkmcnt(6)
    v_mfma_f32_16x16x32_bf16 v[88:91], v[72:75], v[40:43], v[88:91]
    v_mfma_f32_16x16x32_bf16 v[92:95], v[72:75], v[44:47], v[92:95]
    ds_read_b128 v[72:75], v18 offset:10240
    v_mfma_f32_16x16x32_bf16 v[96:99], v[76:79], v[40:43], v[96:99]
    v_mfma_f32_16x16x32_bf16 v[100:103], v[76:79], v[44:47], v[100:103]
    ds_read_b128 v[76:79], v18 offset:14336
    s_waitcnt lgkmcnt(6)
    v_mfma_f32_16x16x32_bf16 v[88:91], v[80:83], v[48:51], v[88:91]
    v_mfma_f32_16x16x32_bf16 v[92:95], v[80:83], v[52:55], v[92:95]
    ds_read_b128 v[80:83], v18 offset:11264
    v_mfma_f32_16x16x32_bf16 v[96:99], v[84:87], v[48:51], v[96:99]
    v_mfma_f32_16x16x32_bf16 v[100:103], v[84:87], v[52:55], v[100:103]
    ds_read_b128 v[84:87], v18 offset:15360
    s_waitcnt lgkmcnt(7)
    v_mfma_f32_16x16x32_bf16 v[104:107], v[56:59], v[24:27], 0
    v_mfma_f32_16x16x32_bf16 v[108:111], v[56:59], v[28:31], 0
    ds_read_b128 v[56:59], v18 offset:16384
    s_waitcnt lgkmcnt(7)
    v_mfma_f32_16x16x32_bf16 v[112:115], v[60:63], v[24:27], 0
    v_mfma_f32_16x16x32_bf16 v[116:119], v[60:63], v[28:31], 0
    ds_read_b128 v[60:63], v18 offset:20480
    s_waitcnt lgkmcnt(7)
    v_mfma_f32_16x16x32_bf16 v[104:107], v[64:67], v[32:35], v[104:107]
    v_mfma_f32_16x16x32_bf16 v[108:111], v[64:67], v[36:39], v[108:111]
    ds_read_b128 v[64:67], v18 offset:17408
    s_waitcnt lgkmcnt(7)
    v_mfma_f32_16x16x32_bf16 v[112:115], v[68:71], v[32:35], v[112:115]
    v_mfma_f32_16x16x32_bf16 v[116:119], v[68:71], v[36:39], v[116:119]
    ds_read_b128 v[68:71], v18 offset:21504
    v_cvt_pk_bf16_f32 v120, v88, v96
    v_cvt_pk_bf16_f32 v121, v89, v97
    v_cvt_pk_bf16_f32 v122, v90, v98
    v_cvt_pk_bf16_f32 v123, v91, v99
    buffer_store_dwordx4 v[120:123], v19, s[8:11], s56 offen offset:0
    v_cvt_pk_bf16_f32 v124, v92, v100
    v_cvt_pk_bf16_f32 v125, v93, v101
    v_cvt_pk_bf16_f32 v126, v94, v102
    v_cvt_pk_bf16_f32 v127, v95, v103
    buffer_store_dwordx4 v[124:127], v19, s[8:11], s57 offen offset:0
    s_waitcnt lgkmcnt(7)
    v_mfma_f32_16x16x32_bf16 v[104:107], v[72:75], v[40:43], v[104:107]
    v_mfma_f32_16x16x32_bf16 v[108:111], v[72:75], v[44:47], v[108:111]
    ds_read_b128 v[72:75], v18 offset:18432
    s_waitcnt lgkmcnt(7)
    v_mfma_f32_16x16x32_bf16 v[112:115], v[76:79], v[40:43], v[112:115]
    v_mfma_f32_16x16x32_bf16 v[116:119], v[76:79], v[44:47], v[116:119]
    ds_read_b128 v[76:79], v18 offset:22528
    s_waitcnt lgkmcnt(7)
    v_mfma_f32_16x16x32_bf16 v[104:107], v[80:83], v[48:51], v[104:107]
    v_mfma_f32_16x16x32_bf16 v[108:111], v[80:83], v[52:55], v[108:111]
    ds_read_b128 v[80:83], v18 offset:19456
    s_waitcnt lgkmcnt(7)
    v_mfma_f32_16x16x32_bf16 v[112:115], v[84:87], v[48:51], v[112:115]
    v_mfma_f32_16x16x32_bf16 v[116:119], v[84:87], v[52:55], v[116:119]
    ds_read_b128 v[84:87], v18 offset:23552
    s_waitcnt lgkmcnt(7)
    v_mfma_f32_16x16x32_bf16 v[88:91], v[56:59], v[24:27], 0
    v_mfma_f32_16x16x32_bf16 v[92:95], v[56:59], v[28:31], 0
    ds_read_b128 v[56:59], v18 offset:24576
    s_waitcnt lgkmcnt(7)
    v_mfma_f32_16x16x32_bf16 v[96:99], v[60:63], v[24:27], 0
    v_mfma_f32_16x16x32_bf16 v[100:103], v[60:63], v[28:31], 0
    ds_read_b128 v[60:63], v18 offset:28672
    s_waitcnt lgkmcnt(7)
    v_mfma_f32_16x16x32_bf16 v[88:91], v[64:67], v[32:35], v[88:91]
    v_mfma_f32_16x16x32_bf16 v[92:95], v[64:67], v[36:39], v[92:95]
    ds_read_b128 v[64:67], v18 offset:25600
    s_waitcnt lgkmcnt(7)
    v_mfma_f32_16x16x32_bf16 v[96:99], v[68:71], v[32:35], v[96:99]
    v_mfma_f32_16x16x32_bf16 v[100:103], v[68:71], v[36:39], v[100:103]
    ds_read_b128 v[68:71], v18 offset:29696
    v_cvt_pk_bf16_f32 v120, v104, v112
    v_cvt_pk_bf16_f32 v121, v105, v113
    v_cvt_pk_bf16_f32 v122, v106, v114
    v_cvt_pk_bf16_f32 v123, v107, v115
    buffer_store_dwordx4 v[120:123], v19, s[8:11], s56 offen offset:256
    v_cvt_pk_bf16_f32 v124, v108, v116
    v_cvt_pk_bf16_f32 v125, v109, v117
    v_cvt_pk_bf16_f32 v126, v110, v118
    v_cvt_pk_bf16_f32 v127, v111, v119
    buffer_store_dwordx4 v[124:127], v19, s[8:11], s57 offen offset:256
    s_waitcnt lgkmcnt(7)
    v_mfma_f32_16x16x32_bf16 v[88:91], v[72:75], v[40:43], v[88:91]
    v_mfma_f32_16x16x32_bf16 v[92:95], v[72:75], v[44:47], v[92:95]
    ds_read_b128 v[72:75], v18 offset:26624
    s_waitcnt lgkmcnt(7)
    v_mfma_f32_16x16x32_bf16 v[96:99], v[76:79], v[40:43], v[96:99]
    v_mfma_f32_16x16x32_bf16 v[100:103], v[76:79], v[44:47], v[100:103]
    ds_read_b128 v[76:79], v18 offset:30720
    s_waitcnt lgkmcnt(7)
    v_mfma_f32_16x16x32_bf16 v[88:91], v[80:83], v[48:51], v[88:91]
    v_mfma_f32_16x16x32_bf16 v[92:95], v[80:83], v[52:55], v[92:95]
    ds_read_b128 v[80:83], v18 offset:27648
    s_waitcnt lgkmcnt(7)
    v_mfma_f32_16x16x32_bf16 v[96:99], v[84:87], v[48:51], v[96:99]
    v_mfma_f32_16x16x32_bf16 v[100:103], v[84:87], v[52:55], v[100:103]
    ds_read_b128 v[84:87], v18 offset:31744
    s_waitcnt lgkmcnt(7)
    v_mfma_f32_16x16x32_bf16 v[104:107], v[56:59], v[24:27], 0
    v_mfma_f32_16x16x32_bf16 v[108:111], v[56:59], v[28:31], 0
    s_waitcnt lgkmcnt(6)
    v_mfma_f32_16x16x32_bf16 v[112:115], v[60:63], v[24:27], 0
    v_mfma_f32_16x16x32_bf16 v[116:119], v[60:63], v[28:31], 0
    s_waitcnt lgkmcnt(5)
    v_mfma_f32_16x16x32_bf16 v[104:107], v[64:67], v[32:35], v[104:107]
    v_mfma_f32_16x16x32_bf16 v[108:111], v[64:67], v[36:39], v[108:111]
    s_waitcnt lgkmcnt(4)
    v_mfma_f32_16x16x32_bf16 v[112:115], v[68:71], v[32:35], v[112:115]
    v_mfma_f32_16x16x32_bf16 v[116:119], v[68:71], v[36:39], v[116:119]
    v_cvt_pk_bf16_f32 v120, v88, v96
    v_cvt_pk_bf16_f32 v121, v89, v97
    v_cvt_pk_bf16_f32 v122, v90, v98
    v_cvt_pk_bf16_f32 v123, v91, v99
    buffer_store_dwordx4 v[120:123], v19, s[8:11], s56 offen offset:512
    v_cvt_pk_bf16_f32 v124, v92, v100
    v_cvt_pk_bf16_f32 v125, v93, v101
    v_cvt_pk_bf16_f32 v126, v94, v102
    v_cvt_pk_bf16_f32 v127, v95, v103
    buffer_store_dwordx4 v[124:127], v19, s[8:11], s57 offen offset:512
    s_waitcnt lgkmcnt(3)
    v_mfma_f32_16x16x32_bf16 v[104:107], v[72:75], v[40:43], v[104:107]
    v_mfma_f32_16x16x32_bf16 v[108:111], v[72:75], v[44:47], v[108:111]
    s_waitcnt lgkmcnt(2)
    v_mfma_f32_16x16x32_bf16 v[112:115], v[76:79], v[40:43], v[112:115]
    v_mfma_f32_16x16x32_bf16 v[116:119], v[76:79], v[44:47], v[116:119]
    s_waitcnt lgkmcnt(1)
    v_mfma_f32_16x16x32_bf16 v[104:107], v[80:83], v[48:51], v[104:107]
    v_mfma_f32_16x16x32_bf16 v[108:111], v[80:83], v[52:55], v[108:111]
    s_waitcnt lgkmcnt(0)
    v_mfma_f32_16x16x32_bf16 v[112:115], v[84:87], v[48:51], v[112:115]
    v_mfma_f32_16x16x32_bf16 v[116:119], v[84:87], v[52:55], v[116:119]
    s_nop 3
    v_cvt_pk_bf16_f32 v120, v104, v112
    v_cvt_pk_bf16_f32 v121, v105, v113
    v_cvt_pk_bf16_f32 v122, v106, v114
    v_cvt_pk_bf16_f32 v123, v107, v115
    buffer_store_dwordx4 v[120:123], v19, s[8:11], s56 offen offset:768
    v_cvt_pk_bf16_f32 v124, v108, v116
    v_cvt_pk_bf16_f32 v125, v109, v117
    v_cvt_pk_bf16_f32 v126, v110, v118
    v_cvt_pk_bf16_f32 v127, v111, v119
    buffer_store_dwordx4 v[124:127], v19, s[8:11], s57 offen offset:768
    s_lshl_b32 s59, s51, 5
    s_add_u32 s59, s59, s47
    s_lshl_b32 s59, s59, 2
    s_add_u32 s59, s59, 10559488
    s_waitcnt vmcnt(0)
    s_barrier
    s_cmp_lg_u32 s46, 0
    s_cbranch_scc1 L_fs_46
    v_mov_b32 v124, 0
    v_mov_b32 v125, 1
    s_mov_b64 exec, 1
    buffer_store_dword v125, v124, s[8:11], s59 offen
    s_mov_b64 exec, -1
L_fs_46:
    s_lshl_b32 s64, s51, 5
    s_add_u32 s64, s64, s47
    s_lshl_b32 s56, s64, 10
    s_lshr_b32 s57, s64, 5
    s_lshl_b32 s57, s57, 15
    s_bfe_u32 s58, s64, 0x10004
    s_lshl_b32 s58, s58, 10
    s_add_u32 s57, s57, s58
    s_and_b32 s58, s64, 15
    s_lshl_b32 s58, s58, 4
    s_add_u32 s57, s57, s58
    s_add_u32 s57, s57, 2097152
    s_add_u32 s58, s56, 8388608
    buffer_load_dwordx4 v[72:75], v0, s[8:11], s58 offen sc1
    s_mov_b32 s4, s32
    s_mov_b32 s5, s33
    s_mov_b32 s6, 1024
    s_mov_b32 s7, 0x20000
    buffer_load_dwordx4 v[76:79], v0, s[4:7], 0 offen
    s_lshl_b32 s59, s51, 7
    s_add_u32 s59, s59, 10559488
    v_and_b32 v124, 31, v1
    v_lshlrev_b32 v124, 2, v124
L_fw_47:
    buffer_load_dword v125, v124, s[8:11], s59 offen sc1
    s_waitcnt vmcnt(0)
    v_cmp_eq_u32 vcc, 0, v125
    s_cbranch_vccz L_fwd_48
    s_sub_u32 s49, s49, 1
    s_cmp_gt_i32 s49, 0
    s_cbranch_scc1 L_fw_47
    s_branch L_abort
L_fwd_48:
    s_lshl_b32 s60, s47, 15
    s_add_u32 s60, s60, s54
    s_add_u32 s63, s60, 0
    buffer_load_dwordx4 v[24:27], v22, s[8:11], s63 offen sc1
    s_add_u32 s63, s60, 4096
    buffer_load_dwordx4 v[28:31], v22, s[8:11], s63 offen sc1
    s_add_u32 s63, s60, 8192
    buffer_load_dwordx4 v[32:35], v22, s[8:11], s63 offen sc1
    s_add_u32 s63, s60, 12288
    buffer_load_dwordx4 v[36:39], v22, s[8:11], s63 offen sc1
    s_add_u32 s63, s60, 16384
    buffer_load_dwordx4 v[40:43], v22, s[8:11], s63 offen sc1
    s_add_u32 s63, s60, 20480
    buffer_load_dwordx4 v[44:47], v22, s[8:11], s63 offen sc1
    s_add_u32 s63, s60, 24576
    buffer_load_dwordx4 v[48:51], v22, s[8:11], s63 offen sc1
    s_add_u32 s63, s60, 28672
    buffer_load_dwordx4 v[52:55], v22, s[8:11], s63 offen sc1
    v_and_b32 v64, 15, v1
    v_and_b32 v65, 1, v1
    v_lshlrev_b32 v65, 4, v65
    v_mov_b32 v66, 0x3f80
    v_lshlrev_b32 v66, v65, v66
    v_lshrrev_b32 v64, 1, v64
    v_cmp_eq_u32 vcc, 0, v64
    s_nop 1
    v_cndmask_b32 v56, 0, v66, vcc
    v_cmp_eq_u32 vcc, 1, v64
    s_nop 1
    v_cndmask_b32 v57, 0, v66, vcc
    v_cmp_eq_u32 vcc, 2, v64
    s_nop 1
    v_cndmask_b32 v58, 0, v66, vcc
    v_cmp_eq_u32 vcc, 3, v64
    s_nop 1
    v_cndmask_b32 v59, 0, v66, vcc
    s_waitcnt vmcnt(7)
    s_nop 0
    v_mfma_f32_16x16x32_bf16 v[60:63], v[56:59], v[24:27], 0
    s_waitcnt vmcnt(6)
    v_mfma_f32_16x16x32_bf16 v[60:63], v[56:59], v[28:31], v[60:63]
    s_waitcnt vmcnt(5)
    v_mfma_f32_16x16x32_bf16 v[60:63], v[56:59], v[32:35], v[60:63]
    s_waitcnt vmcnt(4)
    v_mfma_f32_16x16x32_bf16 v[60:63], v[56:59], v[36:39], v[60:63]
    s_waitcnt vmcnt(3)
    v_mfma_f32_16x16x32_bf16 v[60:63], v[56:59], v[40:43], v[60:63]
    s_waitcnt vmcnt(2)
    v_mfma_f32_16x16x32_bf16 v[60:63], v[56:59], v[44:47], v[60:63]
    s_waitcnt vmcnt(1)
    v_mfma_f32_16x16x32_bf16 v[60:63], v[56:59], v[48:51], v[60:63]
    s_waitcnt vmcnt(0)
    v_mfma_f32_16x16x32_bf16 v[60:63], v[56:59], v[52:55], v[60:63]
    s_nop 7
    ds_write_b128 v21, v[60:63]
    s_waitcnt lgkmcnt(0)
    s_barrier
    s_cmp_lg_u32 s46, 0
    s_cbranch_scc1 L_t4d_49
    v_lshlrev_b32 v56, 5, v1
    v_add_u32 v56, 139264, v56
    ds_read_b128 v[24:27], v56
    ds_read_b128 v[28:31], v56 offset:16
    v_lshlrev_b32 v32, 16, v72
    v_and_b32 v33, 0xffff0000, v72
    v_lshlrev_b32 v34, 16, v73
    v_and_b32 v35, 0xffff0000, v73
    v_lshlrev_b32 v36, 16, v74
    v_and_b32 v37, 0xffff0000, v74
    v_lshlrev_b32 v38, 16, v75
    v_and_b32 v39, 0xffff0000, v75
    s_waitcnt lgkmcnt(0)
    v_cvt_pk_bf16_f32 v40, v24, v25
    v_cvt_pk_bf16_f32 v41, v26, v27
    v_cvt_pk_bf16_f32 v42, v28, v29
    v_cvt_pk_bf16_f32 v43, v30, v31
    v_lshlrev_b32 v24, 16, v40
    v_and_b32 v25, 0xffff0000, v40
    v_lshlrev_b32 v26, 16, v41
    v_and_b32 v27, 0xffff0000, v41
    v_lshlrev_b32 v28, 16, v42
    v_and_b32 v29, 0xffff0000, v42
    v_lshlrev_b32 v30, 16, v43
    v_and_b32 v31, 0xffff0000, v43
    v_add_f32 v32, v32, v24
    v_add_f32 v33, v33, v25
    v_add_f32 v34, v34, v26
    v_add_f32 v35, v35, v27
    v_add_f32 v36, v36, v28
    v_add_f32 v37, v37, v29
    v_add_f32 v38, v38, v30
    v_add_f32 v39, v39, v31
    v_cvt_pk_bf16_f32 v40, v32, v33
    v_cvt_pk_bf16_f32 v41, v34, v35
    v_cvt_pk_bf16_f32 v42, v36, v37
    v_cvt_pk_bf16_f32 v43, v38, v39
    s_add_u32 s58, s56, 6291456
    buffer_store_dwordx4 v[40:43], v0, s[8:11], s58 offen sc1
    v_lshlrev_b32 v32, 16, v40
    v_and_b32 v33, 0xffff0000, v40
    v_lshlrev_b32 v34, 16, v41
    v_and_b32 v35, 0xffff0000, v41
    v_lshlrev_b32 v36, 16, v42
    v_and_b32 v37, 0xffff0000, v42
    v_lshlrev_b32 v38, 16, v43
    v_and_b32 v39, 0xffff0000, v43
    v_add_f32 v64, v32, v33
    v_add_f32 v65, v34, v35
    v_add_f32 v66, v36, v37
    v_add_f32 v67, v38, v39
    v_add_f32 v64, v64, v65
    v_add_f32 v66, v66, v67
    v_add_f32 v64, v64, v66
    s_nop 1
    v_add_f32_dpp v64, v64, v64 row_ror:8 row_mask:0xf bank_mask:0xf
    s_nop 1
    v_add_f32_dpp v64, v64, v64 row_ror:4 row_mask:0xf bank_mask:0xf
    s_nop 1
    v_add_f32_dpp v64, v64, v64 row_ror:2 row_mask:0xf bank_mask:0xf
    s_nop 1
    v_add_f32_dpp v64, v64, v64 row_ror:1 row_mask:0xf bank_mask:0xf
    v_mov_b32 v65, v64
    s_nop 1
    v_permlane16_swap_b32 v64, v65
    v_add_f32 v64, v64, v65
    v_mov_b32 v65, v64
    s_nop 1
    v_permlane32_swap_b32 v64, v65
    v_add_f32 v64, v64, v65
    v_mul_f32 v66, 0x3b000000, v64
    v_sub_f32 v56, v32, v66
    v_sub_f32 v57, v33, v66
    v_sub_f32 v58, v34, v66
    v_sub_f32 v59, v35, v66
    v_sub_f32 v60, v36, v66
    v_sub_f32 v61, v37, v66
    v_sub_f32 v62, v38, v66
    v_sub_f32 v63, v39, v66
    v_mul_f32 v64, v56, v56
    v_mul_f32 v67, v57, v57
    v_fmac_f32 v64, v58, v58
    v_fmac_f32 v67, v59, v59
    v_fmac_f32 v64, v60, v60
    v_fmac_f32 v67, v61, v61
    v_fmac_f32 v64, v62, v62
    v_fmac_f32 v67, v63, v63
    v_add_f32 v64, v64, v67
    v_cvt_pk_bf16_f32 v66, v66, v66
    v_and_b32 v66, 0xffff0000, v66
    v_add_f32_dpp v64, v64, v64 row_ror:8 row_mask:0xf bank_mask:0xf
    s_nop 1
    v_add_f32_dpp v64, v64, v64 row_ror:4 row_mask:0xf bank_mask:0xf
    s_nop 1
    v_add_f32_dpp v64, v64, v64 row_ror:2 row_mask:0xf bank_mask:0xf
    s_nop 1
    v_add_f32_dpp v64, v64, v64 row_ror:1 row_mask:0xf bank_mask:0xf
    v_mov_b32 v65, v64
    s_nop 1
    v_permlane16_swap_b32 v64, v65
    v_add_f32 v64, v64, v65
    v_mov_b32 v65, v64
    s_nop 1
    v_permlane32_swap_b32 v64, v65
    v_add_f32 v64, v64, v65
    v_mul_f32 v64, 0x3b000000, v64
    v_cvt_pk_bf16_f32 v64, v64, v64
    v_and_b32 v64, 0xffff0000, v64
    v_add_f32 v64, 0x3727c5ac, v64
    v_cvt_pk_bf16_f32 v64, v64, v64
    v_and_b32 v64, 0xffff0000, v64
    v_sqrt_f32 v64, v64
    v_sub_f32 v56, v32, v66
    v_sub_f32 v57, v33, v66
    v_sub_f32 v58, v34, v66
    v_sub_f32 v59, v35, v66
    v_sub_f32 v60, v36, v66
    v_sub_f32 v61, v37, v66
    v_sub_f32 v62, v38, v66
    v_sub_f32 v63, v39, v66
    v_cvt_pk_bf16_f32 v64, v64, v64
    v_and_b32 v64, 0xffff0000, v64
    v_rcp_f32 v64, v64
    v_cvt_pk_bf16_f32 v44, v56, v57
    v_cvt_pk_bf16_f32 v45, v58, v59
    v_cvt_pk_bf16_f32 v46, v60, v61
    v_cvt_pk_bf16_f32 v47, v62, v63
    v_lshlrev_b32 v56, 16, v44
    v_and_b32 v57, 0xffff0000, v44
    v_lshlrev_b32 v58, 16, v45
    v_and_b32 v59, 0xffff0000, v45
    v_lshlrev_b32 v60, 16, v46
    v_and_b32 v61, 0xffff0000, v46
    v_lshlrev_b32 v62, 16, v47
    v_and_b32 v63, 0xffff0000, v47
    v_mul_f32 v56, v56, v64
    v_mul_f32 v57, v57, v64
    v_mul_f32 v58, v58, v64
    v_mul_f32 v59, v59, v64
    v_mul_f32 v60, v60, v64
    v_mul_f32 v61, v61, v64
    v_mul_f32 v62, v62, v64
    v_mul_f32 v63, v63, v64
    v_cvt_pk_bf16_f32 v44, v56, v57
    v_cvt_pk_bf16_f32 v45, v58, v59
    v_cvt_pk_bf16_f32 v46, v60, v61
    v_cvt_pk_bf16_f32 v47, v62, v63
    v_lshlrev_b32 v48, 16, v44
    v_and_b32 v49, 0xffff0000, v44
    v_lshlrev_b32 v50, 16, v45
    v_and_b32 v51, 0xffff0000, v45
    v_lshlrev_b32 v52, 16, v46
    v_and_b32 v53, 0xffff0000, v46
    v_lshlrev_b32 v54, 16, v47
    v_and_b32 v55, 0xffff0000, v47
    v_lshlrev_b32 v24, 16, v76
    v_and_b32 v25, 0xffff0000, v76
    v_lshlrev_b32 v26, 16, v77
    v_and_b32 v27, 0xffff0000, v77
    v_lshlrev_b32 v28, 16, v78
    v_and_b32 v29, 0xffff0000, v78
    v_lshlrev_b32 v30, 16, v79
    v_and_b32 v31, 0xffff0000, v79
    v_mul_f32 v56, v48, v24
    v_fmac_f32 v56, v49, v25
    v_fmac_f32 v56, v50, v26
    v_fmac_f32 v56, v51, v27
    v_fmac_f32 v56, v52, v28
    v_fmac_f32 v56, v53, v29
    v_fmac_f32 v56, v54, v30
    v_fmac_f32 v56, v55, v31
    v_add_f32 v32, v32, v48
    v_add_f32 v33, v33, v49
    v_add_f32 v34, v34, v50
    v_add_f32 v35, v35, v51
    v_add_f32 v36, v36, v52
    v_add_f32 v37, v37, v53
    v_add_f32 v38, v38, v54
    v_add_f32 v39, v39, v55
    v_add_f32_dpp v56, v56, v56 row_ror:8 row_mask:0xf bank_mask:0xf
    s_nop 1
    v_add_f32_dpp v56, v56, v56 row_ror:4 row_mask:0xf bank_mask:0xf
    s_nop 1
    v_add_f32_dpp v56, v56, v56 row_ror:2 row_mask:0xf bank_mask:0xf
    s_nop 1
    v_add_f32_dpp v56, v56, v56 row_ror:1 row_mask:0xf bank_mask:0xf
    v_mov_b32 v57, v56
    s_nop 1
    v_permlane16_swap_b32 v56, v57
    v_add_f32 v56, v56, v57
    v_mov_b32 v57, v56
    s_nop 1
    v_permlane32_swap_b32 v56, v57
    v_add_f32 v56, v56, v57
    v_cvt_pk_bf16_f32 v56, v56, v56
    v_and_b32 v56, 0xffff0000, v56
    v_ashrrev_i32 v57, 31, v56
    v_or_b32 v57, 0x80000000, v57
    v_xor_b32 v56, v56, v57
    v_and_b32 v56, 0xffff0000, v56
    s_sub_u32 s58, 2047, s64
    v_or_b32 v56, s58, v56
    s_lshl_b32 s58, s64, 2
    s_add_u32 s58, s58, 10493952
    v_mov_b32 v57, 0
    s_mov_b64 exec, 1
    buffer_store_dword v56, v57, s[8:11], s58 offen sc1
    s_mov_b64 exec, -1
    v_cvt_pk_bf16_f32 v80, v32, v33
    v_cvt_pk_bf16_f32 v81, v34, v35
    v_cvt_pk_bf16_f32 v82, v36, v37
    v_cvt_pk_bf16_f32 v83, v38, v39
    v_lshlrev_b32 v32, 16, v80
    v_and_b32 v33, 0xffff0000, v80
    v_lshlrev_b32 v34, 16, v81
    v_and_b32 v35, 0xffff0000, v81
    v_lshlrev_b32 v36, 16, v82
    v_and_b32 v37, 0xffff0000, v82
    v_lshlrev_b32 v38, 16, v83
    v_and_b32 v39, 0xffff0000, v83
    s_mov_b32 s4, s40
    s_mov_b32 s5, s41
    s_mov_b32 s6, 2097152
    s_mov_b32 s7, 0x20000
    buffer_store_dwordx4 v[80:83], v0, s[4:7], s56 offen sc1
L_t4d_49:
    s_xor_b32 s54, s54, 1048576
    s_add_u32 s51, s51, 8
    s_cmp_lt_u32 s51, 64
    s_cbranch_scc1 L_t2_45
    s_waitcnt vmcnt(0) lgkmcnt(0)
    s_barrier
    s_add_u32 s50, s50, 256
    s_cmp_lg_u32 s46, 0
    s_cbranch_scc1 L_gbd_51
    v_mov_b32 v124, 128
    v_mov_b32 v125, 1
    s_mov_b64 exec, 1
    buffer_atomic_add v125, v124, s[12:15], 0 offen
    s_mov_b64 exec, -1
L_gb_50:
    buffer_load_dword v125, v124, s[12:15], 0 offen sc1
    s_waitcnt vmcnt(0)
    v_readfirstlane_b32 s56, v125
    s_cmp_ge_u32 s56, s50
    s_cbranch_scc1 L_gbd_51
    s_sleep 4
    s_sub_u32 s49, s49, 1
    s_cmp_gt_i32 s49, 0
    s_cbranch_scc1 L_gb_50
    s_branch L_abort
L_gbd_51:
    s_barrier
    s_cmp_lg_u32 s48, 0
    s_cbranch_scc1 L_nm_52
    s_mov_b32 s56, 10493952
    s_mov_b32 s57, 10498048
    buffer_load_dwordx4 v[24:27], v0, s[8:11], s56 offen offset:0 sc1
    buffer_load_dwordx4 v[28:31], v0, s[8:11], s56 offen offset:1024 sc1
    buffer_load_dwordx4 v[32:35], v0, s[8:11], s56 offen offset:2048 sc1
    buffer_load_dwordx4 v[36:39], v0, s[8:11], s56 offen offset:3072 sc1
    buffer_load_dwordx4 v[40:43], v0, s[8:11], s57 offen offset:0 sc1
    buffer_load_dwordx4 v[44:47], v0, s[8:11], s57 offen offset:1024 sc1
    buffer_load_dwordx4 v[48:51], v0, s[8:11], s57 offen offset:2048 sc1
    buffer_load_dwordx4 v[52:55], v0, s[8:11], s57 offen offset:3072 sc1
    s_waitcnt vmcnt(0)
    v_max_u32 v24, v24, v25
    v_max3_u32 v24, v26, v27, v24
    v_max3_u32 v24, v28, v29, v24
    v_max3_u32 v24, v30, v31, v24
    v_max3_u32 v24, v32, v33, v24
    v_max3_u32 v24, v34, v35, v24
    v_max3_u32 v24, v36, v37, v24
    v_max3_u32 v24, v38, v39, v24
    v_max3_u32 v24, v40, v41, v24
    v_max3_u32 v24, v42, v43, v24
    v_max3_u32 v24, v44, v45, v24
    v_max3_u32 v24, v46, v47, v24
    v_max3_u32 v24, v48, v49, v24
    v_max3_u32 v24, v50, v51, v24
    v_max3_u32 v24, v52, v53, v24
    v_max3_u32 v24, v54, v55, v24
    s_nop 1
    v_max_u32_dpp v24, v24, v24 row_ror:8 row_mask:0xf bank_mask:0xf
    s_nop 1
    v_max_u32_dpp v24, v24, v24 row_ror:4 row_mask:0xf bank_mask:0xf
    s_nop 1
    v_max_u32_dpp v24, v24, v24 row_ror:2 row_mask:0xf bank_mask:0xf
    s_nop 1
    v_max_u32_dpp v24, v24, v24 row_ror:1 row_mask:0xf bank_mask:0xf
    v_mov_b32 v25, v24
    s_nop 1
    v_permlane16_swap_b32 v24, v25
    v_max_u32 v24, v24, v25
    v_mov_b32 v25, v24
    s_nop 1
    v_permlane32_swap_b32 v24, v25
    v_max_u32 v24, v24, v25
    s_nop 0
    v_readfirstlane_b32 s66, v24
    s_and_b32 s64, s66, 0x7ff
    s_sub_u32 s64, 2047, s64
    s_lshl_b32 s56, s64, 10
    s_lshr_b32 s57, s64, 5
    s_lshl_b32 s57, s57, 15
    s_bfe_u32 s58, s64, 0x10004
    s_lshl_b32 s58, s58, 10
    s_add_u32 s57, s57, s58
    s_and_b32 s58, s64, 15
    s_lshl_b32 s58, s58, 4
    s_add_u32 s57, s57, s58
    s_add_u32 s57, s57, 2097152
    s_add_u32 s58, s56, 6291456
    buffer_load_dwordx4 v[24:27], v0, s[8:11], s58 offen sc1
    s_waitcnt vmcnt(0)
    v_lshlrev_b32 v96, 16, v24
    v_and_b32 v97, 0xffff0000, v24
    v_lshlrev_b32 v98, 16, v25
    v_and_b32 v99, 0xffff0000, v25
    v_lshlrev_b32 v100, 16, v26
    v_and_b32 v101, 0xffff0000, v26
    v_lshlrev_b32 v102, 16, v27
    v_and_b32 v103, 0xffff0000, v27
    v_add_f32 v116, v96, v97
    v_add_f32 v117, v98, v99
    v_add_f32 v118, v100, v101
    v_add_f32 v119, v102, v103
    v_add_f32 v116, v116, v117
    v_add_f32 v118, v118, v119
    v_add_f32 v116, v116, v118
    s_nop 1
    v_add_f32_dpp v116, v116, v116 row_ror:8 row_mask:0xf bank_mask:0xf
    s_nop 1
    v_add_f32_dpp v116, v116, v116 row_ror:4 row_mask:0xf bank_mask:0xf
    s_nop 1
    v_add_f32_dpp v116, v116, v116 row_ror:2 row_mask:0xf bank_mask:0xf
    s_nop 1
    v_add_f32_dpp v116, v116, v116 row_ror:1 row_mask:0xf bank_mask:0xf
    v_mov_b32 v117, v116
    s_nop 1
    v_permlane16_swap_b32 v116, v117
    v_add_f32 v116, v116, v117
    v_mov_b32 v117, v116
    s_nop 1
    v_permlane32_swap_b32 v116, v117
    v_add_f32 v116, v116, v117
    v_mul_f32 v118, 0x3b000000, v116
    v_sub_f32 v108, v96, v118
    v_sub_f32 v109, v97, v118
    v_sub_f32 v110, v98, v118
    v_sub_f32 v111, v99, v118
    v_sub_f32 v112, v100, v118
    v_sub_f32 v113, v101, v118
    v_sub_f32 v114, v102, v118
    v_sub_f32 v115, v103, v118
    v_mul_f32 v116, v108, v108
    v_mul_f32 v119, v109, v109
    v_fmac_f32 v116, v110, v110
    v_fmac_f32 v119, v111, v111
    v_fmac_f32 v116, v112, v112
    v_fmac_f32 v119, v113, v113
    v_fmac_f32 v116, v114, v114
    v_fmac_f32 v119, v115, v115
    v_add_f32 v116, v116, v119
    v_cvt_pk_bf16_f32 v118, v118, v118
    v_and_b32 v118, 0xffff0000, v118
    v_add_f32_dpp v116, v116, v116 row_ror:8 row_mask:0xf bank_mask:0xf
    s_nop 1
    v_add_f32_dpp v116, v116, v116 row_ror:4 row_mask:0xf bank_mask:0xf
    s_nop 1
    v_add_f32_dpp v116, v116, v116 row_ror:2 row_mask:0xf bank_mask:0xf
    s_nop 1
    v_add_f32_dpp v116, v116, v116 row_ror:1 row_mask:0xf bank_mask:0xf
    v_mov_b32 v117, v116
    s_nop 1
    v_permlane16_swap_b32 v116, v117
    v_add_f32 v116, v116, v117
    v_mov_b32 v117, v116
    s_nop 1
    v_permlane32_swap_b32 v116, v117
    v_add_f32 v116, v116, v117
    v_mul_f32 v116, 0x3b000000, v116
    v_cvt_pk_bf16_f32 v116, v116, v116
    v_and_b32 v116, 0xffff0000, v116
    v_add_f32 v116, 0x3727c5ac, v116
    v_cvt_pk_bf16_f32 v116, v116, v116
    v_and_b32 v116, 0xffff0000, v116
    v_sqrt_f32 v116, v116
    v_sub_f32 v108, v96, v118
    v_sub_f32 v109, v97, v118
    v_sub_f32 v110, v98, v118
    v_sub_f32 v111, v99, v118
    v_sub_f32 v112, v100, v118
    v_sub_f32 v113, v101, v118
    v_sub_f32 v114, v102, v118
    v_sub_f32 v115, v103, v118
    v_cvt_pk_bf16_f32 v116, v116, v116
    v_and_b32 v116, 0xffff0000, v116
    v_rcp_f32 v116, v116
    v_cvt_pk_bf16_f32 v104, v108, v109
    v_cvt_pk_bf16_f32 v105, v110, v111
    v_cvt_pk_bf16_f32 v106, v112, v113
    v_cvt_pk_bf16_f32 v107, v114, v115
    v_lshlrev_b32 v108, 16, v104
    v_and_b32 v109, 0xffff0000, v104
    v_lshlrev_b32 v110, 16, v105
    v_and_b32 v111, 0xffff0000, v105
    v_lshlrev_b32 v112, 16, v106
    v_and_b32 v113, 0xffff0000, v106
    v_lshlrev_b32 v114, 16, v107
    v_and_b32 v115, 0xffff0000, v107
    v_mul_f32 v108, v108, v116
    v_mul_f32 v109, v109, v116
    v_mul_f32 v110, v110, v116
    v_mul_f32 v111, v111, v116
    v_mul_f32 v112, v112, v116
    v_mul_f32 v113, v113, v116
    v_mul_f32 v114, v114, v116
    v_mul_f32 v115, v115, v116
    v_cvt_pk_bf16_f32 v104, v108, v109
    v_cvt_pk_bf16_f32 v105, v110, v111
    v_cvt_pk_bf16_f32 v106, v112, v113
    v_cvt_pk_bf16_f32 v107, v114, v115
    s_mov_b32 s58, 0x01000100
    s_mov_b32 s59, 0x03020302
    v_perm_b32 v24, v104, v104, s58
    v_perm_b32 v25, v104, v104, s59
    v_perm_b32 v26, v105, v105, s58
    v_perm_b32 v27, v105, v105, s59
    v_perm_b32 v28, v106, v106, s58
    v_perm_b32 v29, v106, v106, s59
    v_perm_b32 v30, v107, v107, s58
    v_perm_b32 v31, v107, v107, s59
    v_lshlrev_b32 v32, 5, v1
    s_lshl_b32 s58, s46, 11
    s_add_u32 s58, s58, 147456
    v_add_u32 v32, s58, v32
    ds_write_b128 v32, v[24:27]
    ds_write_b128 v32, v[28:31] offset:16
    v_and_b32 v33, 15, v1
    v_lshrrev_b32 v34, 4, v1
    v_and_b32 v35, 1, v1
    v_lshlrev_b32 v35, 4, v35
    v_mov_b32 v36, 0xffff
    v_lshlrev_b32 v36, v35, v36
    v_lshrrev_b32 v35, 1, v33
    v_cmp_eq_u32 vcc, 0, v35
    s_nop 1
    v_cndmask_b32 v120, 0, v36, vcc
    v_cmp_eq_u32 vcc, 1, v35
    s_nop 1
    v_cndmask_b32 v121, 0, v36, vcc
    v_cmp_eq_u32 vcc, 2, v35
    s_nop 1
    v_cndmask_b32 v122, 0, v36, vcc
    v_cmp_eq_u32 vcc, 3, v35
    s_nop 1
    v_cndmask_b32 v123, 0, v36, vcc
    s_lshl_b32 s59, s46, 9
    s_add_u32 s58, s58, s59
    v_lshlrev_b32 v32, 7, v34
    v_add_u32 v32, s58, v32
    s_min_u32 s60, s47, 27
    s_lshl_b32 s60, s60, 7
    s_mul_i32 s59, s46, 458752
    s_add_u32 s60, s60, s59
    v_mul_u32_u24 v36, 114688, v34
    v_and_b32 v35, 7, v33
    v_lshl_add_u32 v36, v35, 4, v36
    v_add_u32 v36, s60, v36
    v_cmp_gt_u32 vcc, 8, v33
    v_mov_b32 v38, s36
    v_mov_b32 v39, s37
    v_mov_b32 v40, s34
    v_mov_b32 v41, s35
    v_cndmask_b32 v38, v38, v40, vcc
    v_cndmask_b32 v39, v39, v41, vcc
    v_add_co_u32 v38, vcc, v38, v36
    s_nop 1
    v_addc_co_u32 v39, vcc, 0, v39, vcc
    global_load_dwordx4 v[44:47], v[38:39], off
    v_add_co_u32 v38, vcc, 3584, v38
    s_nop 1
    v_addc_co_u32 v39, vcc, 0, v39, vcc
    global_load_dwordx4 v[48:51], v[38:39], off
    v_add_co_u32 v38, vcc, 3584, v38
    s_nop 1
    v_addc_co_u32 v39, vcc, 0, v39, vcc
    global_load_dwordx4 v[52:55], v[38:39], off
    v_add_co_u32 v38, vcc, 3584, v38
    s_nop 1
    v_addc_co_u32 v39, vcc, 0, v39, vcc
    global_load_dwordx4 v[56:59], v[38:39], off
    v_add_co_u32 v38, vcc, 3584, v38
    s_nop 1
    v_addc_co_u32 v39, vcc, 0, v39, vcc
    global_load_dwordx4 v[60:63], v[38:39], off
    v_add_co_u32 v38, vcc, 3584, v38
    s_nop 1
    v_addc_co_u32 v39, vcc, 0, v39, vcc
    global_load_dwordx4 v[64:67], v[38:39], off
    v_add_co_u32 v38, vcc, 3584, v38
    s_nop 1
    v_addc_co_u32 v39, vcc, 0, v39, vcc
    global_load_dwordx4 v[68:71], v[38:39], off
    v_add_co_u32 v38, vcc, 3584, v38
    s_nop 1
    v_addc_co_u32 v39, vcc, 0, v39, vcc
    global_load_dwordx4 v[72:75], v[38:39], off
    v_add_co_u32 v38, vcc, 3584, v38
    s_nop 1
    v_addc_co_u32 v39, vcc, 0, v39, vcc
    global_load_dwordx4 v[76:79], v[38:39], off
    v_add_co_u32 v38, vcc, 3584, v38
    s_nop 1
    v_addc_co_u32 v39, vcc, 0, v39, vcc
    global_load_dwordx4 v[80:83], v[38:39], off
    v_add_co_u32 v38, vcc, 3584, v38
    s_nop 1
    v_addc_co_u32 v39, vcc, 0, v39, vcc
    global_load_dwordx4 v[84:87], v[38:39], off
    v_add_co_u32 v38, vcc, 3584, v38
    s_nop 1
    v_addc_co_u32 v39, vcc, 0, v39, vcc
    global_load_dwordx4 v[88:91], v[38:39], off
    v_add_co_u32 v38, vcc, 3584, v38
    s_nop 1
    v_addc_co_u32 v39, vcc, 0, v39, vcc
    ds_read_b128 v[24:27], v32 offset:0
    ds_read_b128 v[28:31], v32 offset:16
    s_waitcnt lgkmcnt(0)
    v_and_b32 v124, v120, v24
    v_and_b32 v125, v121, v24
    v_and_b32 v126, v122, v24
    v_and_b32 v127, v123, v24
    s_waitcnt vmcnt(11)
    s_nop 0
    v_mfma_f32_16x16x32_bf16 v[116:119], v[124:127], v[44:47], 0
    global_load_dwordx4 v[44:47], v[38:39], off
    v_add_co_u32 v38, vcc, 3584, v38
    s_nop 1
    v_addc_co_u32 v39, vcc, 0, v39, vcc
    v_and_b32 v124, v120, v25
    v_and_b32 v125, v121, v25
    v_and_b32 v126, v122, v25
    v_and_b32 v127, v123, v25
    s_waitcnt vmcnt(11)
    s_nop 0
    v_mfma_f32_16x16x32_bf16 v[116:119], v[124:127], v[48:51], v[116:119]
    global_load_dwordx4 v[48:51], v[38:39], off
    v_add_co_u32 v38, vcc, 3584, v38
    s_nop 1
    v_addc_co_u32 v39, vcc, 0, v39, vcc
    v_and_b32 v124, v120, v26
    v_and_b32 v125, v121, v26
    v_and_b32 v126, v122, v26
    v_and_b32 v127, v123, v26
    s_waitcnt vmcnt(11)
    s_nop 0
    v_mfma_f32_16x16x32_bf16 v[116:119], v[124:127], v[52:55], v[116:119]
    global_load_dwordx4 v[52:55], v[38:39], off
    v_add_co_u32 v38, vcc, 3584, v38
    s_nop 1
    v_addc_co_u32 v39, vcc, 0, v39, vcc
    v_and_b32 v124, v120, v27
    v_and_b32 v125, v121, v27
    v_and_b32 v126, v122, v27
    v_and_b32 v127, v123, v27
    s_waitcnt vmcnt(11)
    s_nop 0
    v_mfma_f32_16x16x32_bf16 v[116:119], v[124:127], v[56:59], v[116:119]
    global_load_dwordx4 v[56:59], v[38:39], off
    v_add_co_u32 v38, vcc, 3584, v38
    s_nop 1
    v_addc_co_u32 v39, vcc, 0, v39, vcc
    v_and_b32 v124, v120, v28
    v_and_b32 v125, v121, v28
    v_and_b32 v126, v122, v28
    v_and_b32 v127, v123, v28
    s_waitcnt vmcnt(11)
    s_nop 0
    v_mfma_f32_16x16x32_bf16 v[116:119], v[124:127], v[60:63], v[116:119]
    global_load_dwordx4 v[60:63], v[38:39], off
    v_add_co_u32 v38, vcc, 3584, v38
    s_nop 1
    v_addc_co_u32 v39, vcc, 0, v39, vcc
    v_and_b32 v124, v120, v29
    v_and_b32 v125, v121, v29
    v_and_b32 v126, v122, v29
    v_and_b32 v127, v123, v29
    s_waitcnt vmcnt(11)
    s_nop 0
    v_mfma_f32_16x16x32_bf16 v[116:119], v[124:127], v[64:67], v[116:119]
    global_load_dwordx4 v[64:67], v[38:39], off
    v_add_co_u32 v38, vcc, 3584, v38
    s_nop 1
    v_addc_co_u32 v39, vcc, 0, v39, vcc
    v_and_b32 v124, v120, v30
    v_and_b32 v125, v121, v30
    v_and_b32 v126, v122, v30
    v_and_b32 v127, v123, v30
    s_waitcnt vmcnt(11)
    s_nop 0
    v_mfma_f32_16x16x32_bf16 v[116:119], v[124:127], v[68:71], v[116:119]
    global_load_dwordx4 v[68:71], v[38:39], off
    v_add_co_u32 v38, vcc, 3584, v38
    s_nop 1
    v_addc_co_u32 v39, vcc, 0, v39, vcc
    v_and_b32 v124, v120, v31
    v_and_b32 v125, v121, v31
    v_and_b32 v126, v122, v31
    v_and_b32 v127, v123, v31
    s_waitcnt vmcnt(11)
    s_nop 0
    v_mfma_f32_16x16x32_bf16 v[116:119], v[124:127], v[72:75], v[116:119]
    global_load_dwordx4 v[72:75], v[38:39], off
    v_add_co_u32 v38, vcc, 3584, v38
    s_nop 1
    v_addc_co_u32 v39, vcc, 0, v39, vcc
    ds_read_b128 v[24:27], v32 offset:32
    ds_read_b128 v[28:31], v32 offset:48
    s_waitcnt lgkmcnt(0)
    v_and_b32 v124, v120, v24
    v_and_b32 v125, v121, v24
    v_and_b32 v126, v122, v24
    v_and_b32 v127, v123, v24
    s_waitcnt vmcnt(11)
    s_nop 0
    v_mfma_f32_16x16x32_bf16 v[116:119], v[124:127], v[76:79], v[116:119]
    global_load_dwordx4 v[76:79], v[38:39], off
    v_add_co_u32 v38, vcc, 3584, v38
    s_nop 1
    v_addc_co_u32 v39, vcc, 0, v39, vcc
    v_and_b32 v124, v120, v25
    v_and_b32 v125, v121, v25
    v_and_b32 v126, v122, v25
    v_and_b32 v127, v123, v25
    s_waitcnt vmcnt(11)
    s_nop 0
    v_mfma_f32_16x16x32_bf16 v[116:119], v[124:127], v[80:83], v[116:119]
    global_load_dwordx4 v[80:83], v[38:39], off
    v_add_co_u32 v38, vcc, 3584, v38
    s_nop 1
    v_addc_co_u32 v39, vcc, 0, v39, vcc
    v_and_b32 v124, v120, v26
    v_and_b32 v125, v121, v26
    v_and_b32 v126, v122, v26
    v_and_b32 v127, v123, v26
    s_waitcnt vmcnt(11)
    s_nop 0
    v_mfma_f32_16x16x32_bf16 v[116:119], v[124:127], v[84:87], v[116:119]
    global_load_dwordx4 v[84:87], v[38:39], off
    v_add_co_u32 v38, vcc, 3584, v38
    s_nop 1
    v_addc_co_u32 v39, vcc, 0, v39, vcc
    v_and_b32 v124, v120, v27
    v_and_b32 v125, v121, v27
    v_and_b32 v126, v122, v27
    v_and_b32 v127, v123, v27
    s_waitcnt vmcnt(11)
    s_nop 0
    v_mfma_f32_16x16x32_bf16 v[116:119], v[124:127], v[88:91], v[116:119]
    global_load_dwordx4 v[88:91], v[38:39], off
    v_add_co_u32 v38, vcc, 3584, v38
    s_nop 1
    v_addc_co_u32 v39, vcc, 0, v39, vcc
    v_and_b32 v124, v120, v28
    v_and_b32 v125, v121, v28
    v_and_b32 v126, v122, v28
    v_and_b32 v127, v123, v28
    s_waitcnt vmcnt(11)
    s_nop 0
    v_mfma_f32_16x16x32_bf16 v[116:119], v[124:127], v[44:47], v[116:119]
    global_load_dwordx4 v[44:47], v[38:39], off
    v_add_co_u32 v38, vcc, 3584, v38
    s_nop 1
    v_addc_co_u32 v39, vcc, 0, v39, vcc
    v_and_b32 v124, v120, v29
    v_and_b32 v125, v121, v29
    v_and_b32 v126, v122, v29
    v_and_b32 v127, v123, v29
    s_waitcnt vmcnt(11)
    s_nop 0
    v_mfma_f32_16x16x32_bf16 v[116:119], v[124:127], v[48:51], v[116:119]
    global_load_dwordx4 v[48:51], v[38:39], off
    v_add_co_u32 v38, vcc, 3584, v38
    s_nop 1
    v_addc_co_u32 v39, vcc, 0, v39, vcc
    v_and_b32 v124, v120, v30
    v_and_b32 v125, v121, v30
    v_and_b32 v126, v122, v30
    v_and_b32 v127, v123, v30
    s_waitcnt vmcnt(11)
    s_nop 0
    v_mfma_f32_16x16x32_bf16 v[116:119], v[124:127], v[52:55], v[116:119]
    global_load_dwordx4 v[52:55], v[38:39], off
    v_add_co_u32 v38, vcc, 3584, v38
    s_nop 1
    v_addc_co_u32 v39, vcc, 0, v39, vcc
    v_and_b32 v124, v120, v31
    v_and_b32 v125, v121, v31
    v_and_b32 v126, v122, v31
    v_and_b32 v127, v123, v31
    s_waitcnt vmcnt(11)
    s_nop 0
    v_mfma_f32_16x16x32_bf16 v[116:119], v[124:127], v[56:59], v[116:119]
    global_load_dwordx4 v[56:59], v[38:39], off
    v_add_co_u32 v38, vcc, 3584, v38
    s_nop 1
    v_addc_co_u32 v39, vcc, 0, v39, vcc
    ds_read_b128 v[24:27], v32 offset:64
    ds_read_b128 v[28:31], v32 offset:80
    s_waitcnt lgkmcnt(0)
    v_and_b32 v124, v120, v24
    v_and_b32 v125, v121, v24
    v_and_b32 v126, v122, v24
    v_and_b32 v127, v123, v24
    s_waitcnt vmcnt(11)
    s_nop 0
    v_mfma_f32_16x16x32_bf16 v[116:119], v[124:127], v[60:63], v[116:119]
    global_load_dwordx4 v[60:63], v[38:39], off
    v_add_co_u32 v38, vcc, 3584, v38
    s_nop 1
    v_addc_co_u32 v39, vcc, 0, v39, vcc
    v_and_b32 v124, v120, v25
    v_and_b32 v125, v121, v25
    v_and_b32 v126, v122, v25
    v_and_b32 v127, v123, v25
    s_waitcnt vmcnt(11)
    s_nop 0
    v_mfma_f32_16x16x32_bf16 v[116:119], v[124:127], v[64:67], v[116:119]
    global_load_dwordx4 v[64:67], v[38:39], off
    v_add_co_u32 v38, vcc, 3584, v38
    s_nop 1
    v_addc_co_u32 v39, vcc, 0, v39, vcc
    v_and_b32 v124, v120, v26
    v_and_b32 v125, v121, v26
    v_and_b32 v126, v122, v26
    v_and_b32 v127, v123, v26
    s_waitcnt vmcnt(11)
    s_nop 0
    v_mfma_f32_16x16x32_bf16 v[116:119], v[124:127], v[68:71], v[116:119]
    global_load_dwordx4 v[68:71], v[38:39], off
    v_add_co_u32 v38, vcc, 3584, v38
    s_nop 1
    v_addc_co_u32 v39, vcc, 0, v39, vcc
    v_and_b32 v124, v120, v27
    v_and_b32 v125, v121, v27
    v_and_b32 v126, v122, v27
    v_and_b32 v127, v123, v27
    s_waitcnt vmcnt(11)
    s_nop 0
    v_mfma_f32_16x16x32_bf16 v[116:119], v[124:127], v[72:75], v[116:119]
    global_load_dwordx4 v[72:75], v[38:39], off
    v_add_co_u32 v38, vcc, 3584, v38
    s_nop 1
    v_addc_co_u32 v39, vcc, 0, v39, vcc
    v_and_b32 v124, v120, v28
    v_and_b32 v125, v121, v28
    v_and_b32 v126, v122, v28
    v_and_b32 v127, v123, v28
    s_waitcnt vmcnt(11)
    s_nop 0
    v_mfma_f32_16x16x32_bf16 v[116:119], v[124:127], v[76:79], v[116:119]
    v_and_b32 v124, v120, v29
    v_and_b32 v125, v121, v29
    v_and_b32 v126, v122, v29
    v_and_b32 v127, v123, v29
    s_waitcnt vmcnt(10)
    s_nop 0
    v_mfma_f32_16x16x32_bf16 v[116:119], v[124:127], v[80:83], v[116:119]
    v_and_b32 v124, v120, v30
    v_and_b32 v125, v121, v30
    v_and_b32 v126, v122, v30
    v_and_b32 v127, v123, v30
    s_waitcnt vmcnt(9)
    s_nop 0
    v_mfma_f32_16x16x32_bf16 v[116:119], v[124:127], v[84:87], v[116:119]
    v_and_b32 v124, v120, v31
    v_and_b32 v125, v121, v31
    v_and_b32 v126, v122, v31
    v_and_b32 v127, v123, v31
    s_waitcnt vmcnt(8)
    s_nop 0
    v_mfma_f32_16x16x32_bf16 v[116:119], v[124:127], v[88:91], v[116:119]
    ds_read_b128 v[24:27], v32 offset:96
    ds_read_b128 v[28:31], v32 offset:112
    s_waitcnt lgkmcnt(0)
    v_and_b32 v124, v120, v24
    v_and_b32 v125, v121, v24
    v_and_b32 v126, v122, v24
    v_and_b32 v127, v123, v24
    s_waitcnt vmcnt(7)
    s_nop 0
    v_mfma_f32_16x16x32_bf16 v[116:119], v[124:127], v[44:47], v[116:119]
    v_and_b32 v124, v120, v25
    v_and_b32 v125, v121, v25
    v_and_b32 v126, v122, v25
    v_and_b32 v127, v123, v25
    s_waitcnt vmcnt(6)
    s_nop 0
    v_mfma_f32_16x16x32_bf16 v[116:119], v[124:127], v[48:51], v[116:119]
    v_and_b32 v124, v120, v26
    v_and_b32 v125, v121, v26
    v_and_b32 v126, v122, v26
    v_and_b32 v127, v123, v26
    s_waitcnt vmcnt(5)
    s_nop 0
    v_mfma_f32_16x16x32_bf16 v[116:119], v[124:127], v[52:55], v[116:119]
    v_and_b32 v124, v120, v27
    v_and_b32 v125, v121, v27
    v_and_b32 v126, v122, v27
    v_and_b32 v127, v123, v27
    s_waitcnt vmcnt(4)
    s_nop 0
    v_mfma_f32_16x16x32_bf16 v[116:119], v[124:127], v[56:59], v[116:119]
    v_and_b32 v124, v120, v28
    v_and_b32 v125, v121, v28
    v_and_b32 v126, v122, v28
    v_and_b32 v127, v123, v28
    s_waitcnt vmcnt(3)
    s_nop 0
    v_mfma_f32_16x16x32_bf16 v[116:119], v[124:127], v[60:63], v[116:119]
    v_and_b32 v124, v120, v29
    v_and_b32 v125, v121, v29
    v_and_b32 v126, v122, v29
    v_and_b32 v127, v123, v29
    s_waitcnt vmcnt(2)
    s_nop 0
    v_mfma_f32_16x16x32_bf16 v[116:119], v[124:127], v[64:67], v[116:119]
    v_and_b32 v124, v120, v30
    v_and_b32 v125, v121, v30
    v_and_b32 v126, v122, v30
    v_and_b32 v127, v123, v30
    s_waitcnt vmcnt(1)
    s_nop 0
    v_mfma_f32_16x16x32_bf16 v[116:119], v[124:127], v[68:71], v[116:119]
    v_and_b32 v124, v120, v31
    v_and_b32 v125, v121, v31
    v_and_b32 v126, v122, v31
    v_and_b32 v127, v123, v31
    s_waitcnt vmcnt(0)
    s_nop 0
    v_mfma_f32_16x16x32_bf16 v[116:119], v[124:127], v[72:75], v[116:119]
    s_mov_b32 s4, s38
    s_mov_b32 s5, s39
    s_mov_b32 s6, 1835008
    s_mov_b32 s7, 0x20000
    v_lshlrev_b32 v36, 14, v34
    v_lshl_add_u32 v36, v33, 4, v36
    s_lshl_b32 s59, s47, 16
    s_lshl_b32 s60, s46, 8
    s_add_u32 s59, s59, s60
    buffer_load_dwordx4 v[44:47], v36, s[4:7], s59 offen offset:0
    buffer_load_dwordx4 v[48:51], v36, s[4:7], s59 offen offset:1024
    buffer_load_dwordx4 v[52:55], v36, s[4:7], s59 offen offset:2048
    buffer_load_dwordx4 v[56:59], v36, s[4:7], s59 offen offset:3072
    s_add_u32 s59, s59, 4096
    buffer_load_dwordx4 v[60:63], v36, s[4:7], s59 offen offset:0
    buffer_load_dwordx4 v[64:67], v36, s[4:7], s59 offen offset:1024
    buffer_load_dwordx4 v[68:71], v36, s[4:7], s59 offen offset:2048
    buffer_load_dwordx4 v[72:75], v36, s[4:7], s59 offen offset:3072
    s_add_u32 s59, s59, 4096
    buffer_load_dwordx4 v[76:79], v36, s[4:7], s59 offen offset:0
    buffer_load_dwordx4 v[80:83], v36, s[4:7], s59 offen offset:1024
    buffer_load_dwordx4 v[84:87], v36, s[4:7], s59 offen offset:2048
    buffer_load_dwordx4 v[88:91], v36, s[4:7], s59 offen offset:3072
    v_lshlrev_b32 v37, 5, v33
    v_and_b32 v35, 1, v34
    v_lshl_add_u32 v37, v35, 4, v37
    v_lshrrev_b32 v35, 1, v34
    v_lshl_add_u32 v37, v35, 11, v37
    s_lshl_b32 s60, s46, 9
    s_add_u32 s60, s60, 155648
    v_add_u32 v37, s60, v37
    ds_write_b128 v37, v[116:119]
    v_lshlrev_b32 v37, 2, v1
    v_add_u32 v37, 155648, v37
    s_waitcnt lgkmcnt(0)
    s_barrier
    ds_read2st64_b32 v[24:25], v37 offset0:0 offset1:1
    ds_read2st64_b32 v[26:27], v37 offset0:2 offset1:3
    ds_read2st64_b32 v[28:29], v37 offset0:4 offset1:5
    ds_read2st64_b32 v[30:31], v37 offset0:6 offset1:7
    s_waitcnt lgkmcnt(0)
    v_pk_add_f32 v[24:25], v[24:25], v[26:27]
    v_pk_add_f32 v[28:29], v[28:29], v[30:31]
    v_pk_add_f32 v[24:25], v[24:25], v[28:29]
    v_cvt_pk_bf16_f32 v24, v24, v24
    v_and_b32 v24, 0xffff0000, v24
    v_cvt_pk_bf16_f32 v25, v25, v25
    v_and_b32 v25, 0xffff0000, v25
    v_mul_f32 v26, 0xbfb8aa3b, v24
    v_exp_f32 v26, v26
    s_nop 0
    v_add_f32 v26, 1.0, v26
    v_rcp_f32 v26, v26
    s_nop 0
    v_mul_f32 v24, v24, v26
    v_cvt_pk_bf16_f32 v24, v24, v24
    v_and_b32 v24, 0xffff0000, v24
    v_mul_f32 v24, v24, v25
    v_cvt_pk_bf16_f32 v24, v24, v24
    v_lshlrev_b32 v37, 2, v1
    s_lshl_b32 s60, s46, 11
    s_add_u32 s60, s60, 147456
    v_add_u32 v37, s60, v37
    ds_write_b32 v37, v24
    v_lshlrev_b32 v32, 6, v34
    v_add_u32 v32, s60, v32
    ds_read_b128 v[24:27], v32 offset:0
    ds_read_b128 v[28:31], v32 offset:16
    s_waitcnt lgkmcnt(0)
    v_and_b32 v124, v120, v24
    v_and_b32 v125, v121, v24
    v_and_b32 v126, v122, v24
    v_and_b32 v127, v123, v24
    s_waitcnt vmcnt(11)
    s_nop 0
    v_mfma_f32_16x16x32_bf16 v[116:119], v[124:127], v[44:47], 0
    s_add_u32 s59, s59, 4096
    buffer_load_dwordx4 v[44:47], v36, s[4:7], s59 offen offset:0
    v_and_b32 v124, v120, v25
    v_and_b32 v125, v121, v25
    v_and_b32 v126, v122, v25
    v_and_b32 v127, v123, v25
    s_waitcnt vmcnt(11)
    s_nop 0
    v_mfma_f32_16x16x32_bf16 v[116:119], v[124:127], v[48:51], v[116:119]
    buffer_load_dwordx4 v[48:51], v36, s[4:7], s59 offen offset:1024
    v_and_b32 v124, v120, v26
    v_and_b32 v125, v121, v26
    v_and_b32 v126, v122, v26
    v_and_b32 v127, v123, v26
    s_waitcnt vmcnt(11)
    s_nop 0
    v_mfma_f32_16x16x32_bf16 v[116:119], v[124:127], v[52:55], v[116:119]
    buffer_load_dwordx4 v[52:55], v36, s[4:7], s59 offen offset:2048
    v_and_b32 v124, v120, v27
    v_and_b32 v125, v121, v27
    v_and_b32 v126, v122, v27
    v_and_b32 v127, v123, v27
    s_waitcnt vmcnt(11)
    s_nop 0
    v_mfma_f32_16x16x32_bf16 v[116:119], v[124:127], v[56:59], v[116:119]
    buffer_load_dwordx4 v[56:59], v36, s[4:7], s59 offen offset:3072
    v_and_b32 v124, v120, v28
    v_and_b32 v125, v121, v28
    v_and_b32 v126, v122, v28
    v_and_b32 v127, v123, v28
    s_waitcnt vmcnt(11)
    s_nop 0
    v_mfma_f32_16x16x32_bf16 v[116:119], v[124:127], v[60:63], v[116:119]
    v_and_b32 v124, v120, v29
    v_and_b32 v125, v121, v29
    v_and_b32 v126, v122, v29
    v_and_b32 v127, v123, v29
    s_waitcnt vmcnt(10)
    s_nop 0
    v_mfma_f32_16x16x32_bf16 v[116:119], v[124:127], v[64:67], v[116:119]
    v_and_b32 v124, v120, v30
    v_and_b32 v125, v121, v30
    v_and_b32 v126, v122, v30
    v_and_b32 v127, v123, v30
    s_waitcnt vmcnt(9)
    s_nop 0
    v_mfma_f32_16x16x32_bf16 v[116:119], v[124:127], v[68:71], v[116:119]
    v_and_b32 v124, v120, v31
    v_and_b32 v125, v121, v31
    v_and_b32 v126, v122, v31
    v_and_b32 v127, v123, v31
    s_waitcnt vmcnt(8)
    s_nop 0
    v_mfma_f32_16x16x32_bf16 v[116:119], v[124:127], v[72:75], v[116:119]
    ds_read_b128 v[24:27], v32 offset:32
    ds_read_b128 v[28:31], v32 offset:48
    s_waitcnt lgkmcnt(0)
    v_and_b32 v124, v120, v24
    v_and_b32 v125, v121, v24
    v_and_b32 v126, v122, v24
    v_and_b32 v127, v123, v24
    s_waitcnt vmcnt(7)
    s_nop 0
    v_mfma_f32_16x16x32_bf16 v[116:119], v[124:127], v[76:79], v[116:119]
    v_and_b32 v124, v120, v25
    v_and_b32 v125, v121, v25
    v_and_b32 v126, v122, v25
    v_and_b32 v127, v123, v25
    s_waitcnt vmcnt(6)
    s_nop 0
    v_mfma_f32_16x16x32_bf16 v[116:119], v[124:127], v[80:83], v[116:119]
    v_and_b32 v124, v120, v26
    v_and_b32 v125, v121, v26
    v_and_b32 v126, v122, v26
    v_and_b32 v127, v123, v26
    s_waitcnt vmcnt(5)
    s_nop 0
    v_mfma_f32_16x16x32_bf16 v[116:119], v[124:127], v[84:87], v[116:119]
    v_and_b32 v124, v120, v27
    v_and_b32 v125, v121, v27
    v_and_b32 v126, v122, v27
    v_and_b32 v127, v123, v27
    s_waitcnt vmcnt(4)
    s_nop 0
    v_mfma_f32_16x16x32_bf16 v[116:119], v[124:127], v[88:91], v[116:119]
    v_and_b32 v124, v120, v28
    v_and_b32 v125, v121, v28
    v_and_b32 v126, v122, v28
    v_and_b32 v127, v123, v28
    s_waitcnt vmcnt(3)
    s_nop 0
    v_mfma_f32_16x16x32_bf16 v[116:119], v[124:127], v[44:47], v[116:119]
    v_and_b32 v124, v120, v29
    v_and_b32 v125, v121, v29
    v_and_b32 v126, v122, v29
    v_and_b32 v127, v123, v29
    s_waitcnt vmcnt(2)
    s_nop 0
    v_mfma_f32_16x16x32_bf16 v[116:119], v[124:127], v[48:51], v[116:119]
    v_and_b32 v124, v120, v30
    v_and_b32 v125, v121, v30
    v_and_b32 v126, v122, v30
    v_and_b32 v127, v123, v30
    s_waitcnt vmcnt(1)
    s_nop 0
    v_mfma_f32_16x16x32_bf16 v[116:119], v[124:127], v[52:55], v[116:119]
    v_and_b32 v124, v120, v31
    v_and_b32 v125, v121, v31
    v_and_b32 v126, v122, v31
    v_and_b32 v127, v123, v31
    s_waitcnt vmcnt(0)
    s_nop 0
    v_mfma_f32_16x16x32_bf16 v[116:119], v[124:127], v[56:59], v[116:119]
    v_lshlrev_b32 v37, 4, v33
    v_and_b32 v35, 1, v34
    v_lshl_add_u32 v37, v35, 3, v37
    v_and_b32 v35, 2, v34
    v_lshl_add_u32 v37, v35, 30, v37
    s_lshl_b32 s59, s47, 10
    s_lshl_b32 s60, s46, 8
    s_add_u32 s59, s59, s60
    s_add_u32 s59, s59, 17858560
    v_cvt_pk_bf16_f32 v24, v116, v117
    v_cvt_pk_bf16_f32 v25, v118, v119
    buffer_store_dwordx2 v[24:25], v37, s[8:11], s59 offen
    s_lshl_b32 s59, s47, 2
    s_add_u32 s59, s59, 10567808
    s_waitcnt vmcnt(0)
    s_barrier
    s_cmp_lg_u32 s46, 0
    s_cbranch_scc1 L_fs_53
    v_mov_b32 v124, 0
    v_mov_b32 v125, 1
    s_mov_b64 exec, 1
    buffer_store_dword v125, v124, s[8:11], s59 offen
    s_mov_b64 exec, -1
L_fs_53:
    s_cmp_lg_u32 s47, 0
    s_cbranch_scc1 L_moed_54
    s_mov_b32 s59, 10567808
    v_and_b32 v124, 31, v1
    v_lshlrev_b32 v124, 2, v124
L_fw_55:
    buffer_load_dword v125, v124, s[8:11], s59 offen sc1
    s_waitcnt vmcnt(0)
    v_cmp_eq_u32 vcc, 0, v125
    s_cbranch_vccz L_fwd_56
    s_sub_u32 s49, s49, 1
    s_cmp_gt_i32 s49, 0
    s_cbranch_scc1 L_fw_55
    s_branch L_abort
L_fwd_56:
    s_mov_b32 s60, 17858560
    s_add_u32 s63, s60, 0
    buffer_load_dwordx4 v[24:27], v22, s[8:11], s63 offen sc1
    s_add_u32 s63, s60, 4096
    buffer_load_dwordx4 v[28:31], v22, s[8:11], s63 offen sc1
    s_add_u32 s63, s60, 8192
    buffer_load_dwordx4 v[32:35], v22, s[8:11], s63 offen sc1
    s_add_u32 s63, s60, 12288
    buffer_load_dwordx4 v[36:39], v22, s[8:11], s63 offen sc1
    s_add_u32 s63, s60, 16384
    buffer_load_dwordx4 v[40:43], v22, s[8:11], s63 offen sc1
    s_add_u32 s63, s60, 20480
    buffer_load_dwordx4 v[44:47], v22, s[8:11], s63 offen sc1
    s_add_u32 s63, s60, 24576
    buffer_load_dwordx4 v[48:51], v22, s[8:11], s63 offen sc1
    s_add_u32 s63, s60, 28672
    buffer_load_dwordx4 v[52:55], v22, s[8:11], s63 offen sc1
    v_and_b32 v64, 15, v1
    v_and_b32 v65, 1, v1
    v_lshlrev_b32 v65, 4, v65
    v_mov_b32 v66, 0x3f80
    v_lshlrev_b32 v66, v65, v66
    v_lshrrev_b32 v64, 1, v64
    v_cmp_eq_u32 vcc, 0, v64
    s_nop 1
    v_cndmask_b32 v56, 0, v66, vcc
    v_cmp_eq_u32 vcc, 1, v64
    s_nop 1
    v_cndmask_b32 v57, 0, v66, vcc
    v_cmp_eq_u32 vcc, 2, v64
    s_nop 1
    v_cndmask_b32 v58, 0, v66, vcc
    v_cmp_eq_u32 vcc, 3, v64
    s_nop 1
    v_cndmask_b32 v59, 0, v66, vcc
    s_waitcnt vmcnt(7)
    s_nop 0
    v_mfma_f32_16x16x32_bf16 v[60:63], v[56:59], v[24:27], 0
    s_waitcnt vmcnt(6)
    v_mfma_f32_16x16x32_bf16 v[60:63], v[56:59], v[28:31], v[60:63]
    s_waitcnt vmcnt(5)
    v_mfma_f32_16x16x32_bf16 v[60:63], v[56:59], v[32:35], v[60:63]
    s_waitcnt vmcnt(4)
    v_mfma_f32_16x16x32_bf16 v[60:63], v[56:59], v[36:39], v[60:63]
    s_waitcnt vmcnt(3)
    v_mfma_f32_16x16x32_bf16 v[60:63], v[56:59], v[40:43], v[60:63]
    s_waitcnt vmcnt(2)
    v_mfma_f32_16x16x32_bf16 v[60:63], v[56:59], v[44:47], v[60:63]
    s_waitcnt vmcnt(1)
    v_mfma_f32_16x16x32_bf16 v[60:63], v[56:59], v[48:51], v[60:63]
    s_waitcnt vmcnt(0)
    v_mfma_f32_16x16x32_bf16 v[60:63], v[56:59], v[52:55], v[60:63]
    s_nop 7
    ds_write_b128 v21, v[60:63]
    s_waitcnt lgkmcnt(0)
    s_barrier
    s_cmp_lg_u32 s46, 0
    s_cbranch_scc1 L_moed_54
    v_lshlrev_b32 v56, 5, v1
    v_add_u32 v56, 139264, v56
    ds_read_b128 v[24:27], v56
    ds_read_b128 v[28:31], v56 offset:16
    s_and_b32 s59, s66, 0xffff0000
    s_xor_b32 s60, s59, 0x80000000
    s_xor_b32 s61, s59, 0xffff0000
    s_cmp_lt_i32 s59, 0
    s_cselect_b32 s59, s60, s61
    v_mov_b32 v56, s59
    v_mul_f32 v56, 0xbfb8aa3b, v56
    v_exp_f32 v56, v56
    s_nop 0
    v_add_f32 v56, 1.0, v56
    v_rcp_f32 v56, v56
    s_nop 0
    v_cvt_pk_bf16_f32 v56, v56, v56
    v_and_b32 v56, 0xffff0000, v56
    v_lshlrev_b32 v48, 16, v104
    v_and_b32 v49, 0xffff0000, v104
    v_lshlrev_b32 v50, 16, v105
    v_and_b32 v51, 0xffff0000, v105
    v_lshlrev_b32 v52, 16, v106
    v_and_b32 v53, 0xffff0000, v106
    v_lshlrev_b32 v54, 16, v107
    v_and_b32 v55, 0xffff0000, v107
    s_waitcnt lgkmcnt(0)
    v_cvt_pk_bf16_f32 v40, v24, v25
    v_cvt_pk_bf16_f32 v41, v26, v27
    v_cvt_pk_bf16_f32 v42, v28, v29
    v_cvt_pk_bf16_f32 v43, v30, v31
    v_lshlrev_b32 v24, 16, v40
    v_and_b32 v25, 0xffff0000, v40
    v_lshlrev_b32 v26, 16, v41
    v_and_b32 v27, 0xffff0000, v41
    v_lshlrev_b32 v28, 16, v42
    v_and_b32 v29, 0xffff0000, v42
    v_lshlrev_b32 v30, 16, v43
    v_and_b32 v31, 0xffff0000, v43
    v_mul_f32 v24, v24, v56
    v_mul_f32 v25, v25, v56
    v_mul_f32 v26, v26, v56
    v_mul_f32 v27, v27, v56
    v_mul_f32 v28, v28, v56
    v_mul_f32 v29, v29, v56
    v_mul_f32 v30, v30, v56
    v_mul_f32 v31, v31, v56
    v_cvt_pk_bf16_f32 v40, v24, v25
    v_cvt_pk_bf16_f32 v41, v26, v27
    v_cvt_pk_bf16_f32 v42, v28, v29
    v_cvt_pk_bf16_f32 v43, v30, v31
    v_lshlrev_b32 v24, 16, v40
    v_and_b32 v25, 0xffff0000, v40
    v_lshlrev_b32 v26, 16, v41
    v_and_b32 v27, 0xffff0000, v41
    v_lshlrev_b32 v28, 16, v42
    v_and_b32 v29, 0xffff0000, v42
    v_lshlrev_b32 v30, 16, v43
    v_and_b32 v31, 0xffff0000, v43
    v_add_f32 v24, v24, v48
    v_add_f32 v25, v25, v49
    v_add_f32 v26, v26, v50
    v_add_f32 v27, v27, v51
    v_add_f32 v28, v28, v52
    v_add_f32 v29, v29, v53
    v_add_f32 v30, v30, v54
    v_add_f32 v31, v31, v55
    v_cvt_pk_bf16_f32 v40, v24, v25
    v_cvt_pk_bf16_f32 v41, v26, v27
    v_cvt_pk_bf16_f32 v42, v28, v29
    v_cvt_pk_bf16_f32 v43, v30, v31
    v_lshlrev_b32 v24, 16, v40
    v_and_b32 v25, 0xffff0000, v40
    v_lshlrev_b32 v26, 16, v41
    v_and_b32 v27, 0xffff0000, v41
    v_lshlrev_b32 v28, 16, v42
    v_and_b32 v29, 0xffff0000, v42
    v_lshlrev_b32 v30, 16, v43
    v_and_b32 v31, 0xffff0000, v43
    v_add_f32 v96, v96, v24
    v_add_f32 v97, v97, v25
    v_add_f32 v98, v98, v26
    v_add_f32 v99, v99, v27
    v_add_f32 v100, v100, v28
    v_add_f32 v101, v101, v29
    v_add_f32 v102, v102, v30
    v_add_f32 v103, v103, v31
    v_cvt_pk_bf16_f32 v80, v96, v97
    v_cvt_pk_bf16_f32 v81, v98, v99
    v_cvt_pk_bf16_f32 v82, v100, v101
    v_cvt_pk_bf16_f32 v83, v102, v103
    v_lshlrev_b32 v96, 16, v80
    v_and_b32 v97, 0xffff0000, v80
    v_lshlrev_b32 v98, 16, v81
    v_and_b32 v99, 0xffff0000, v81
    v_lshlrev_b32 v100, 16, v82
    v_and_b32 v101, 0xffff0000, v82
    v_lshlrev_b32 v102, 16, v83
    v_and_b32 v103, 0xffff0000, v83
    s_mov_b32 s4, s40
    s_mov_b32 s5, s41
    s_mov_b32 s6, 2097152
    s_mov_b32 s7, 0x20000
    buffer_store_dwordx4 v[80:83], v0, s[4:7], s56 offen sc1
L_moed_54:
L_nm_52:
L_abort:
    s_endpgm
.section .rodata,"a"
.p2align 6
.amdhsa_kernel interleave_layers__memory_aug_recurrent_mem_tr__moe_arch_mod__prompt_kernel
  .amdhsa_next_free_vgpr 512
  .amdhsa_next_free_sgpr 102
  .amdhsa_accum_offset 256
  .amdhsa_group_segment_fixed_size 0
  .amdhsa_kernarg_size 120
  .amdhsa_user_sgpr_count 2
  .amdhsa_user_sgpr_kernarg_segment_ptr 1
  .amdhsa_system_sgpr_workgroup_id_x 1
  .amdhsa_float_denorm_mode_32 3
.end_amdhsa_kernel
```

```asm
; @launch grid=(256,1,1) block=(256,1,1) lds=163840
.amdgcn_target "amdgcn-amd-amdhsa--gfx950"
.text
.globl interleave_layers__memory_aug_recurrent_mem_tr__moe_arch_mod__prompt_kernel
.p2align 8
.type interleave_layers__memory_aug_recurrent_mem_tr__moe_arch_mod__prompt_kernel,@function
interleave_layers__memory_aug_recurrent_mem_tr__moe_arch_mod__prompt_kernel:
    s_cmp_ge_u32 s2, 256
    s_cbranch_scc1 L_abort
    s_load_dwordx16 s[16:31], s[0:1], 0
    s_load_dwordx8 s[32:39], s[0:1], 64
    s_load_dwordx4 s[40:43], s[0:1], 96
    s_load_dwordx2 s[44:45], s[0:1], 112
    v_lshrrev_b32 v2, 6, v0
    v_and_b32 v1, 63, v0
    v_readfirstlane_b32 s46, v2
    v_lshlrev_b32 v0, 4, v1
    s_getreg_b32 s48, hwreg(HW_REG_XCC_ID)
    s_and_b32 s48, s48, 7
    s_mov_b32 s49, 100000
    s_mov_b32 s80, 0x3e0293ee
    s_waitcnt lgkmcnt(0)
    s_mov_b32 s8, s44
    s_mov_b32 s9, s45
    s_mov_b32 s10, 268435456
    s_mov_b32 s11, 0x20000
    s_mov_b32 s12, s42
    s_mov_b32 s13, s43
    s_mov_b32 s14, 256
    s_mov_b32 s15, 0x20000
    s_cmp_lg_u32 s46, 0
    s_cbranch_scc1 L_tk_1
    s_lshl_b32 s56, s48, 2
    v_mov_b32 v2, s56
    v_mov_b32 v3, 1
    s_mov_b64 exec, 1
    buffer_atomic_add v3, v2, s[12:15], 0 offen sc0
    s_waitcnt vmcnt(0)
    v_mov_b32 v4, 159744
    ds_write_b32 v4, v3
    s_mov_b64 exec, -1
    s_waitcnt lgkmcnt(0)
L_tk_1:
    s_barrier
    v_mov_b32 v4, 159744
    ds_read_b32 v3, v4
    s_waitcnt lgkmcnt(0)
    v_readfirstlane_b32 s47, v3
    s_and_b32 s47, s47, 31
    s_mov_b32 s28, 0x3f803f80
    s_mov_b32 s29, 0x3f803f80
    s_mov_b32 s51, 0
    s_lshl_b32 s56, s2, 12
    s_lshl_b32 s57, s46, 10
    s_add_u32 s56, s56, s57
    v_add_u32 v2, s56, v0
    v_mov_b32 v4, -1
    v_mov_b32 v5, -1
    v_mov_b32 v6, -1
    v_mov_b32 v7, -1
    v_mov_b32 v8, 0
    v_mov_b32 v9, 0
    v_mov_b32 v10, 0
    v_mov_b32 v11, 0
    v_cmp_gt_u32 vcc, 524288, v2
    v_mov_b32 v3, 14155776
    v_mov_b32 v12, 11542528
    v_cndmask_b32 v3, v3, v12, vcc
    v_add_u32 v3, v3, v2
    s_mov_b32 s56, 0
    buffer_store_dwordx4 v[4:7], v3, s[8:11], s56 offen sc1
    s_mov_b32 s56, 1048576
    buffer_store_dwordx4 v[4:7], v3, s[8:11], s56 offen sc1
    s_mov_b32 s56, 2097152
    buffer_store_dwordx4 v[4:7], v3, s[8:11], s56 offen sc1
    v_add_u32 v3, 17309696, v2
    v_mov_b32 v12, 0x80000000
    v_cndmask_b32 v3, v3, v12, vcc
    buffer_store_dwordx4 v[4:7], v3, s[8:11], 0 offen sc1
    v_cmp_gt_u32 vcc, 147456, v2
    v_lshrrev_b32 v3, 11, v2
    v_lshlrev_b32 v3, 13, v3
    v_and_b32 v13, 0x7ff, v2
    v_add_u32 v3, v3, v13
    v_add_u32 v3, 10485760, v3
    v_cndmask_b32 v3, v12, v3, vcc
    buffer_store_dwordx4 v[8:11], v3, s[8:11], 0 offen sc1
    s_mov_b32 s4, s16
    s_mov_b32 s5, s17
    s_mov_b32 s6, 2097152
    s_mov_b32 s7, 0x20000
    s_lshl_b32 s56, s2, 3
    s_lshl_b32 s57, s46, 1
    s_add_u32 s56, s56, s57
    s_lshl_b32 s57, s56, 10
    buffer_load_dwordx4 v[24:27], v0, s[4:7], s57 offen
    buffer_load_dwordx4 v[28:31], v0, s[4:7], s57 offen offset:1024
    v_lshrrev_b32 v2, 2, v1
    v_lshlrev_b32 v2, 11, v2
    v_and_b32 v3, 3, v1
    v_lshl_add_u32 v2, v3, 8, v2
    s_lshr_b32 s57, s56, 5
    s_lshl_b32 s57, s57, 15
    s_bfe_u32 s58, s56, 0x10004
    s_lshl_b32 s58, s58, 10
    s_add_u32 s57, s57, s58
    s_and_b32 s58, s56, 15
    s_lshl_b32 s58, s58, 4
    s_add_u32 s57, s57, s58
    s_add_u32 s57, s57, 0
    s_waitcnt vmcnt(0)
    v_lshlrev_b32 v32, 16, v24
    v_and_b32 v33, 0xffff0000, v24
    v_lshlrev_b32 v34, 16, v25
    v_and_b32 v35, 0xffff0000, v25
    v_lshlrev_b32 v36, 16, v26
    v_and_b32 v37, 0xffff0000, v26
    v_lshlrev_b32 v38, 16, v27
    v_and_b32 v39, 0xffff0000, v27
    v_add_f32 v56, v32, v33
    v_add_f32 v57, v34, v35
    v_add_f32 v58, v36, v37
    v_add_f32 v59, v38, v39
    v_add_f32 v56, v56, v57
    v_add_f32 v58, v58, v59
    v_add_f32 v56, v56, v58
    s_nop 1
    v_add_f32_dpp v56, v56, v56 row_ror:8 row_mask:0xf bank_mask:0xf
    s_nop 1
    v_add_f32_dpp v56, v56, v56 row_ror:4 row_mask:0xf bank_mask:0xf
    s_nop 1
    v_add_f32_dpp v56, v56, v56 row_ror:2 row_mask:0xf bank_mask:0xf
    s_nop 1
    v_add_f32_dpp v56, v56, v56 row_ror:1 row_mask:0xf bank_mask:0xf
    v_mov_b32 v57, v56
    s_nop 1
    v_permlane16_swap_b32 v56, v57
    v_add_f32 v56, v56, v57
    v_mov_b32 v57, v56
    s_nop 1
    v_permlane32_swap_b32 v56, v57
    v_add_f32 v56, v56, v57
    v_mul_f32 v58, 0x3b000000, v56
    v_sub_f32 v48, v32, v58
    v_sub_f32 v49, v33, v58
    v_sub_f32 v50, v34, v58
    v_sub_f32 v51, v35, v58
    v_sub_f32 v52, v36, v58
    v_sub_f32 v53, v37, v58
    v_sub_f32 v54, v38, v58
    v_sub_f32 v55, v39, v58
    v_mul_f32 v56, v48, v48
    v_mul_f32 v59, v49, v49
    v_fmac_f32 v56, v50, v50
    v_fmac_f32 v59, v51, v51
    v_fmac_f32 v56, v52, v52
    v_fmac_f32 v59, v53, v53
    v_fmac_f32 v56, v54, v54
    v_fmac_f32 v59, v55, v55
    v_add_f32 v56, v56, v59
    v_cvt_pk_bf16_f32 v58, v58, v58
    v_and_b32 v58, 0xffff0000, v58
    v_add_f32_dpp v56, v56, v56 row_ror:8 row_mask:0xf bank_mask:0xf
    s_nop 1
    v_add_f32_dpp v56, v56, v56 row_ror:4 row_mask:0xf bank_mask:0xf
    s_nop 1
    v_add_f32_dpp v56, v56, v56 row_ror:2 row_mask:0xf bank_mask:0xf
    s_nop 1
    v_add_f32_dpp v56, v56, v56 row_ror:1 row_mask:0xf bank_mask:0xf
    v_mov_b32 v57, v56
    s_nop 1
    v_permlane16_swap_b32 v56, v57
    v_add_f32 v56, v56, v57
    v_mov_b32 v57, v56
    s_nop 1
    v_permlane32_swap_b32 v56, v57
    v_add_f32 v56, v56, v57
    v_mul_f32 v56, 0x3b000000, v56
    v_cvt_pk_bf16_f32 v56, v56, v56
    v_and_b32 v56, 0xffff0000, v56
    v_add_f32 v56, 0x3727c5ac, v56
    v_cvt_pk_bf16_f32 v56, v56, v56
    v_and_b32 v56, 0xffff0000, v56
    v_sqrt_f32 v56, v56
    v_sub_f32 v48, v32, v58
    v_sub_f32 v49, v33, v58
    v_sub_f32 v50, v34, v58
    v_sub_f32 v51, v35, v58
    v_sub_f32 v52, v36, v58
    v_sub_f32 v53, v37, v58
    v_sub_f32 v54, v38, v58
    v_sub_f32 v55, v39, v58
    v_cvt_pk_bf16_f32 v56, v56, v56
    v_and_b32 v56, 0xffff0000, v56
    v_rcp_f32 v56, v56
    v_cvt_pk_bf16_f32 v40, v48, v49
    v_cvt_pk_bf16_f32 v41, v50, v51
    v_cvt_pk_bf16_f32 v42, v52, v53
    v_cvt_pk_bf16_f32 v43, v54, v55
    v_lshlrev_b32 v48, 16, v40
    v_and_b32 v49, 0xffff0000, v40
    v_lshlrev_b32 v50, 16, v41
    v_and_b32 v51, 0xffff0000, v41
    v_lshlrev_b32 v52, 16, v42
    v_and_b32 v53, 0xffff0000, v42
    v_lshlrev_b32 v54, 16, v43
    v_and_b32 v55, 0xffff0000, v43
    v_mul_f32 v48, v48, v56
    v_mul_f32 v49, v49, v56
    v_mul_f32 v50, v50, v56
    v_mul_f32 v51, v51, v56
    v_mul_f32 v52, v52, v56
    v_mul_f32 v53, v53, v56
    v_mul_f32 v54, v54, v56
    v_mul_f32 v55, v55, v56
    v_cvt_pk_bf16_f32 v40, v48, v49
    v_cvt_pk_bf16_f32 v41, v50, v51
    v_cvt_pk_bf16_f32 v42, v52, v53
    v_cvt_pk_bf16_f32 v43, v54, v55
    buffer_store_dwordx4 v[40:43], v2, s[8:11], s57 offen offset:0 sc1
    v_lshlrev_b32 v32, 16, v28
    v_and_b32 v33, 0xffff0000, v28
    v_lshlrev_b32 v34, 16, v29
    v_and_b32 v35, 0xffff0000, v29
    v_lshlrev_b32 v36, 16, v30
    v_and_b32 v37, 0xffff0000, v30
    v_lshlrev_b32 v38, 16, v31
    v_and_b32 v39, 0xffff0000, v31
    v_add_f32 v56, v32, v33
    v_add_f32 v57, v34, v35
    v_add_f32 v58, v36, v37
    v_add_f32 v59, v38, v39
    v_add_f32 v56, v56, v57
    v_add_f32 v58, v58, v59
    v_add_f32 v56, v56, v58
    s_nop 1
    v_add_f32_dpp v56, v56, v56 row_ror:8 row_mask:0xf bank_mask:0xf
    s_nop 1
    v_add_f32_dpp v56, v56, v56 row_ror:4 row_mask:0xf bank_mask:0xf
    s_nop 1
    v_add_f32_dpp v56, v56, v56 row_ror:2 row_mask:0xf bank_mask:0xf
    s_nop 1
    v_add_f32_dpp v56, v56, v56 row_ror:1 row_mask:0xf bank_mask:0xf
    v_mov_b32 v57, v56
    s_nop 1
    v_permlane16_swap_b32 v56, v57
    v_add_f32 v56, v56, v57
    v_mov_b32 v57, v56
    s_nop 1
    v_permlane32_swap_b32 v56, v57
    v_add_f32 v56, v56, v57
    v_mul_f32 v58, 0x3b000000, v56
    v_sub_f32 v48, v32, v58
    v_sub_f32 v49, v33, v58
    v_sub_f32 v50, v34, v58
    v_sub_f32 v51, v35, v58
    v_sub_f32 v52, v36, v58
    v_sub_f32 v53, v37, v58
    v_sub_f32 v54, v38, v58
    v_sub_f32 v55, v39, v58
    v_mul_f32 v56, v48, v48
    v_mul_f32 v59, v49, v49
    v_fmac_f32 v56, v50, v50
    v_fmac_f32 v59, v51, v51
    v_fmac_f32 v56, v52, v52
    v_fmac_f32 v59, v53, v53
    v_fmac_f32 v56, v54, v54
    v_fmac_f32 v59, v55, v55
    v_add_f32 v56, v56, v59
    v_cvt_pk_bf16_f32 v58, v58, v58
    v_and_b32 v58, 0xffff0000, v58
    v_add_f32_dpp v56, v56, v56 row_ror:8 row_mask:0xf bank_mask:0xf
    s_nop 1
    v_add_f32_dpp v56, v56, v56 row_ror:4 row_mask:0xf bank_mask:0xf
    s_nop 1
    v_add_f32_dpp v56, v56, v56 row_ror:2 row_mask:0xf bank_mask:0xf
    s_nop 1
    v_add_f32_dpp v56, v56, v56 row_ror:1 row_mask:0xf bank_mask:0xf
    v_mov_b32 v57, v56
    s_nop 1
    v_permlane16_swap_b32 v56, v57
    v_add_f32 v56, v56, v57
    v_mov_b32 v57, v56
    s_nop 1
    v_permlane32_swap_b32 v56, v57
    v_add_f32 v56, v56, v57
    v_mul_f32 v56, 0x3b000000, v56
    v_cvt_pk_bf16_f32 v56, v56, v56
    v_and_b32 v56, 0xffff0000, v56
    v_add_f32 v56, 0x3727c5ac, v56
    v_cvt_pk_bf16_f32 v56, v56, v56
    v_and_b32 v56, 0xffff0000, v56
    v_sqrt_f32 v56, v56
    v_sub_f32 v48, v32, v58
    v_sub_f32 v49, v33, v58
    v_sub_f32 v50, v34, v58
    v_sub_f32 v51, v35, v58
    v_sub_f32 v52, v36, v58
    v_sub_f32 v53, v37, v58
    v_sub_f32 v54, v38, v58
    v_sub_f32 v55, v39, v58
    v_cvt_pk_bf16_f32 v56, v56, v56
    v_and_b32 v56, 0xffff0000, v56
    v_rcp_f32 v56, v56
    v_cvt_pk_bf16_f32 v44, v48, v49
    v_cvt_pk_bf16_f32 v45, v50, v51
    v_cvt_pk_bf16_f32 v46, v52, v53
    v_cvt_pk_bf16_f32 v47, v54, v55
    v_lshlrev_b32 v48, 16, v44
    v_and_b32 v49, 0xffff0000, v44
    v_lshlrev_b32 v50, 16, v45
    v_and_b32 v51, 0xffff0000, v45
    v_lshlrev_b32 v52, 16, v46
    v_and_b32 v53, 0xffff0000, v46
    v_lshlrev_b32 v54, 16, v47
    v_and_b32 v55, 0xffff0000, v47
    v_mul_f32 v48, v48, v56
    v_mul_f32 v49, v49, v56
    v_mul_f32 v50, v50, v56
    v_mul_f32 v51, v51, v56
    v_mul_f32 v52, v52, v56
    v_mul_f32 v53, v53, v56
    v_mul_f32 v54, v54, v56
    v_mul_f32 v55, v55, v56
    v_cvt_pk_bf16_f32 v44, v48, v49
    v_cvt_pk_bf16_f32 v45, v50, v51
    v_cvt_pk_bf16_f32 v46, v52, v53
    v_cvt_pk_bf16_f32 v47, v54, v55
    buffer_store_dwordx4 v[44:47], v2, s[8:11], s57 offen offset:16 sc1
    s_mov_b32 s4, s18
    s_mov_b32 s5, s19
    s_mov_b32 s6, 8192
    s_mov_b32 s7, 0x20000
    s_cmp_ge_u32 s2, 2
    s_cbranch_scc1 L_m0_2
    s_lshl_b32 s56, s2, 2
    s_add_u32 s56, s56, s46
    v_bfe_u32 v2, v1, 2, 2
    v_and_b32 v3, 1, v1
    v_lshl_add_u32 v2, v2, 1, v3
    v_lshlrev_b32 v2, 10, v2
    v_lshrrev_b32 v3, 4, v1
    v_lshl_add_u32 v2, v3, 5, v2
    v_and_b32 v3, 2, v1
    v_lshl_add_u32 v2, v3, 1, v2
    s_lshl_b32 s57, s56, 7
    buffer_load_dword v32, v2, s[4:7], s57 offen offset:0
    buffer_load_dword v33, v2, s[4:7], s57 offen offset:8
    buffer_load_dword v34, v2, s[4:7], s57 offen offset:16
    buffer_load_dword v35, v2, s[4:7], s57 offen offset:24
    v_lshrrev_b32 v2, 3, v1
    v_lshlrev_b32 v2, 9, v2
    v_and_b32 v3, 7, v1
    v_lshl_add_u32 v2, v3, 4, v2
    s_and_b32 s57, s56, 1
    s_lshl_b32 s57, s57, 8
    s_and_b32 s58, s56, 2
    s_lshl_b32 s58, s58, 6
    s_add_u32 s57, s57, s58
    s_and_b32 s58, s56, 4
    s_lshl_b32 s58, s58, 10
    s_add_u32 s57, s57, s58
    s_waitcnt vmcnt(0)
    s_add_u32 s58, s57, 11534336
    buffer_store_dwordx4 v[32:35], v2, s[8:11], s58 offen sc1
    s_add_u32 s58, s57, 12582912
    buffer_store_dwordx4 v[32:35], v2, s[8:11], s58 offen sc1
    s_add_u32 s58, s57, 17825792
    buffer_store_dwordx4 v[32:35], v2, s[8:11], s58 offen sc1
L_m0_2:
    s_waitcnt vmcnt(0) lgkmcnt(0)
    s_barrier
    s_cmp_lg_u32 s46, 0
    s_cbranch_scc1 L_ar_3
    v_mov_b32 v124, 128
    v_mov_b32 v125, 1
    s_mov_b64 exec, 1
    buffer_atomic_add v125, v124, s[12:15], 0 offen
    s_mov_b64 exec, -1
L_ar_3:
    v_and_b32 v2, 15, v1
    v_lshlrev_b32 v2, 2, v2
    v_lshrrev_b32 v3, 4, v1
    v_lshl_add_u32 v4, v3, 16, v2
    v_lshl_add_u32 v5, v3, 13, v2
    s_lshl_b32 s58, s47, 8
    s_lshl_b32 s57, s46, 6
    s_add_u32 s58, s58, s57
    s_lshl_b32 s59, s47, 17
    s_add_u32 s59, s59, s57
    s_lshl_b32 s60, s46, 15
    v_add_u32 v6, s60, v0
    s_mov_b32 s61, 0x05040100
    s_mov_b32 s62, 0x07060302
    s_lshl_b32 s63, s46, 19
    s_mov_b32 s4, s22
    s_mov_b32 s5, s23
    s_mov_b32 s6, 4194304
    s_mov_b32 s7, 0x20000
    s_xor_b32 s56, s63, 0
    s_add_u32 s56, s56, s58
    buffer_load_dword v24, v4, s[4:7], s56 offen
    s_add_u32 s56, s56, 8192
    buffer_load_dword v25, v4, s[4:7], s56 offen
    s_add_u32 s56, s56, 8192
    buffer_load_dword v26, v4, s[4:7], s56 offen
    s_add_u32 s56, s56, 8192
    buffer_load_dword v27, v4, s[4:7], s56 offen
    s_add_u32 s56, s56, 8192
    buffer_load_dword v28, v4, s[4:7], s56 offen
    s_add_u32 s56, s56, 8192
    buffer_load_dword v29, v4, s[4:7], s56 offen
    s_add_u32 s56, s56, 8192
    buffer_load_dword v30, v4, s[4:7], s56 offen
    s_add_u32 s56, s56, 8192
    buffer_load_dword v31, v4, s[4:7], s56 offen
    s_xor_b32 s56, s63, 262144
    s_add_u32 s56, s56, s58
    buffer_load_dword v32, v4, s[4:7], s56 offen
    s_add_u32 s56, s56, 8192
    buffer_load_dword v33, v4, s[4:7], s56 offen
    s_add_u32 s56, s56, 8192
    buffer_load_dword v34, v4, s[4:7], s56 offen
    s_add_u32 s56, s56, 8192
    buffer_load_dword v35, v4, s[4:7], s56 offen
    s_add_u32 s56, s56, 8192
    buffer_load_dword v36, v4, s[4:7], s56 offen
    s_add_u32 s56, s56, 8192
    buffer_load_dword v37, v4, s[4:7], s56 offen
    s_add_u32 s56, s56, 8192
    buffer_load_dword v38, v4, s[4:7], s56 offen
    s_add_u32 s56, s56, 8192
    buffer_load_dword v39, v4, s[4:7], s56 offen
    s_xor_b32 s56, s63, 524288
    s_add_u32 s56, s56, s58
    buffer_load_dword v40, v4, s[4:7], s56 offen
    s_add_u32 s56, s56, 8192
    buffer_load_dword v41, v4, s[4:7], s56 offen
    s_add_u32 s56, s56, 8192
    buffer_load_dword v42, v4, s[4:7], s56 offen
    s_add_u32 s56, s56, 8192
    buffer_load_dword v43, v4, s[4:7], s56 offen
    s_add_u32 s56, s56, 8192
    buffer_load_dword v44, v4, s[4:7], s56 offen
    s_add_u32 s56, s56, 8192
    buffer_load_dword v45, v4, s[4:7], s56 offen
    s_add_u32 s56, s56, 8192
    buffer_load_dword v46, v4, s[4:7], s56 offen
    s_add_u32 s56, s56, 8192
    buffer_load_dword v47, v4, s[4:7], s56 offen
    s_xor_b32 s56, s63, 786432
    s_add_u32 s56, s56, s58
    buffer_load_dword v48, v4, s[4:7], s56 offen
    s_add_u32 s56, s56, 8192
    buffer_load_dword v49, v4, s[4:7], s56 offen
    s_add_u32 s56, s56, 8192
    buffer_load_dword v50, v4, s[4:7], s56 offen
    s_add_u32 s56, s56, 8192
    buffer_load_dword v51, v4, s[4:7], s56 offen
    s_add_u32 s56, s56, 8192
    buffer_load_dword v52, v4, s[4:7], s56 offen
    s_add_u32 s56, s56, 8192
    buffer_load_dword v53, v4, s[4:7], s56 offen
    s_add_u32 s56, s56, 8192
    buffer_load_dword v54, v4, s[4:7], s56 offen
    s_add_u32 s56, s56, 8192
    buffer_load_dword v55, v4, s[4:7], s56 offen
    s_xor_b32 s56, s63, 1048576
    s_add_u32 s56, s56, s58
    buffer_load_dword v56, v4, s[4:7], s56 offen
    s_add_u32 s56, s56, 8192
    buffer_load_dword v57, v4, s[4:7], s56 offen
    s_add_u32 s56, s56, 8192
    buffer_load_dword v58, v4, s[4:7], s56 offen
    s_add_u32 s56, s56, 8192
    buffer_load_dword v59, v4, s[4:7], s56 offen
    s_add_u32 s56, s56, 8192
    buffer_load_dword v60, v4, s[4:7], s56 offen
    s_add_u32 s56, s56, 8192
    buffer_load_dword v61, v4, s[4:7], s56 offen
    s_add_u32 s56, s56, 8192
    buffer_load_dword v62, v4, s[4:7], s56 offen
    s_add_u32 s56, s56, 8192
    buffer_load_dword v63, v4, s[4:7], s56 offen
    s_xor_b32 s56, s63, 1310720
    s_add_u32 s56, s56, s58
    buffer_load_dword v64, v4, s[4:7], s56 offen
    s_add_u32 s56, s56, 8192
    buffer_load_dword v65, v4, s[4:7], s56 offen
    s_add_u32 s56, s56, 8192
    buffer_load_dword v66, v4, s[4:7], s56 offen
    s_add_u32 s56, s56, 8192
    buffer_load_dword v67, v4, s[4:7], s56 offen
    s_add_u32 s56, s56, 8192
    buffer_load_dword v68, v4, s[4:7], s56 offen
    s_add_u32 s56, s56, 8192
    buffer_load_dword v69, v4, s[4:7], s56 offen
    s_add_u32 s56, s56, 8192
    buffer_load_dword v70, v4, s[4:7], s56 offen
    s_add_u32 s56, s56, 8192
    buffer_load_dword v71, v4, s[4:7], s56 offen
    s_xor_b32 s56, s63, 1572864
    s_add_u32 s56, s56, s58
    buffer_load_dword v72, v4, s[4:7], s56 offen
    s_add_u32 s56, s56, 8192
    buffer_load_dword v73, v4, s[4:7], s56 offen
    s_add_u32 s56, s56, 8192
    buffer_load_dword v74, v4, s[4:7], s56 offen
    s_add_u32 s56, s56, 8192
    buffer_load_dword v75, v4, s[4:7], s56 offen
    s_add_u32 s56, s56, 8192
    buffer_load_dword v76, v4, s[4:7], s56 offen
    s_add_u32 s56, s56, 8192
    buffer_load_dword v77, v4, s[4:7], s56 offen
    s_add_u32 s56, s56, 8192
    buffer_load_dword v78, v4, s[4:7], s56 offen
    s_add_u32 s56, s56, 8192
    buffer_load_dword v79, v4, s[4:7], s56 offen
    s_waitcnt vmcnt(48)
    v_perm_b32 v80, v25, v24, s61
    v_perm_b32 v81, v27, v26, s61
    v_perm_b32 v82, v29, v28, s61
    v_perm_b32 v83, v31, v30, s61
    v_perm_b32 v84, v25, v24, s62
    v_perm_b32 v85, v27, v26, s62
    v_perm_b32 v86, v29, v28, s62
    v_perm_b32 v87, v31, v30, s62
    v_accvgpr_write_b32 a128, v80
    v_accvgpr_write_b32 a129, v81
    v_accvgpr_write_b32 a130, v82
    v_accvgpr_write_b32 a131, v83
    v_accvgpr_write_b32 a136, v84
    v_accvgpr_write_b32 a137, v85
    v_accvgpr_write_b32 a138, v86
    v_accvgpr_write_b32 a139, v87
    s_xor_b32 s56, s63, 1835008
    s_add_u32 s56, s56, s58
    buffer_load_dword v24, v4, s[4:7], s56 offen
    s_add_u32 s56, s56, 8192
    buffer_load_dword v25, v4, s[4:7], s56 offen
    s_add_u32 s56, s56, 8192
    buffer_load_dword v26, v4, s[4:7], s56 offen
    s_add_u32 s56, s56, 8192
    buffer_load_dword v27, v4, s[4:7], s56 offen
    s_add_u32 s56, s56, 8192
    buffer_load_dword v28, v4, s[4:7], s56 offen
    s_add_u32 s56, s56, 8192
    buffer_load_dword v29, v4, s[4:7], s56 offen
    s_add_u32 s56, s56, 8192
    buffer_load_dword v30, v4, s[4:7], s56 offen
    s_add_u32 s56, s56, 8192
    buffer_load_dword v31, v4, s[4:7], s56 offen
    s_waitcnt vmcnt(48)
    v_perm_b32 v80, v33, v32, s61
    v_perm_b32 v81, v35, v34, s61
    v_perm_b32 v82, v37, v36, s61
    v_perm_b32 v83, v39, v38, s61
    v_perm_b32 v84, v33, v32, s62
    v_perm_b32 v85, v35, v34, s62
    v_perm_b32 v86, v37, v36, s62
    v_perm_b32 v87, v39, v38, s62
    v_accvgpr_write_b32 a132, v80
    v_accvgpr_write_b32 a133, v81
    v_accvgpr_write_b32 a134, v82
    v_accvgpr_write_b32 a135, v83
    v_accvgpr_write_b32 a140, v84
    v_accvgpr_write_b32 a141, v85
    v_accvgpr_write_b32 a142, v86
    v_accvgpr_write_b32 a143, v87
    s_xor_b32 s56, s63, 2097152
    s_add_u32 s56, s56, s58
    buffer_load_dword v32, v4, s[4:7], s56 offen
    s_add_u32 s56, s56, 8192
    buffer_load_dword v33, v4, s[4:7], s56 offen
    s_add_u32 s56, s56, 8192
    buffer_load_dword v34, v4, s[4:7], s56 offen
    s_add_u32 s56, s56, 8192
    buffer_load_dword v35, v4, s[4:7], s56 offen
    s_add_u32 s56, s56, 8192
    buffer_load_dword v36, v4, s[4:7], s56 offen
    s_add_u32 s56, s56, 8192
    buffer_load_dword v37, v4, s[4:7], s56 offen
    s_add_u32 s56, s56, 8192
    buffer_load_dword v38, v4, s[4:7], s56 offen
    s_add_u32 s56, s56, 8192
    buffer_load_dword v39, v4, s[4:7], s56 offen
    s_waitcnt vmcnt(48)
    v_perm_b32 v80, v41, v40, s61
    v_perm_b32 v81, v43, v42, s61
    v_perm_b32 v82, v45, v44, s61
    v_perm_b32 v83, v47, v46, s61
    v_perm_b32 v84, v41, v40, s62
    v_perm_b32 v85, v43, v42, s62
    v_perm_b32 v86, v45, v44, s62
    v_perm_b32 v87, v47, v46, s62
    v_accvgpr_write_b32 a144, v80
    v_accvgpr_write_b32 a145, v81
    v_accvgpr_write_b32 a146, v82
    v_accvgpr_write_b32 a147, v83
    v_accvgpr_write_b32 a152, v84
    v_accvgpr_write_b32 a153, v85
    v_accvgpr_write_b32 a154, v86
    v_accvgpr_write_b32 a155, v87
    s_xor_b32 s56, s63, 2359296
    s_add_u32 s56, s56, s58
    buffer_load_dword v40, v4, s[4:7], s56 offen
    s_add_u32 s56, s56, 8192
    buffer_load_dword v41, v4, s[4:7], s56 offen
    s_add_u32 s56, s56, 8192
    buffer_load_dword v42, v4, s[4:7], s56 offen
    s_add_u32 s56, s56, 8192
    buffer_load_dword v43, v4, s[4:7], s56 offen
    s_add_u32 s56, s56, 8192
    buffer_load_dword v44, v4, s[4:7], s56 offen
    s_add_u32 s56, s56, 8192
    buffer_load_dword v45, v4, s[4:7], s56 offen
    s_add_u32 s56, s56, 8192
    buffer_load_dword v46, v4, s[4:7], s56 offen
    s_add_u32 s56, s56, 8192
    buffer_load_dword v47, v4, s[4:7], s56 offen
    s_waitcnt vmcnt(48)
    v_perm_b32 v80, v49, v48, s61
    v_perm_b32 v81, v51, v50, s61
    v_perm_b32 v82, v53, v52, s61
    v_perm_b32 v83, v55, v54, s61
    v_perm_b32 v84, v49, v48, s62
    v_perm_b32 v85, v51, v50, s62
    v_perm_b32 v86, v53, v52, s62
    v_perm_b32 v87, v55, v54, s62
    v_accvgpr_write_b32 a148, v80
    v_accvgpr_write_b32 a149, v81
    v_accvgpr_write_b32 a150, v82
    v_accvgpr_write_b32 a151, v83
    v_accvgpr_write_b32 a156, v84
    v_accvgpr_write_b32 a157, v85
    v_accvgpr_write_b32 a158, v86
    v_accvgpr_write_b32 a159, v87
    s_xor_b32 s56, s63, 2621440
    s_add_u32 s56, s56, s58
    buffer_load_dword v48, v4, s[4:7], s56 offen
    s_add_u32 s56, s56, 8192
    buffer_load_dword v49, v4, s[4:7], s56 offen
    s_add_u32 s56, s56, 8192
    buffer_load_dword v50, v4, s[4:7], s56 offen
    s_add_u32 s56, s56, 8192
    buffer_load_dword v51, v4, s[4:7], s56 offen
    s_add_u32 s56, s56, 8192
    buffer_load_dword v52, v4, s[4:7], s56 offen
    s_add_u32 s56, s56, 8192
    buffer_load_dword v53, v4, s[4:7], s56 offen
    s_add_u32 s56, s56, 8192
    buffer_load_dword v54, v4, s[4:7], s56 offen
    s_add_u32 s56, s56, 8192
    buffer_load_dword v55, v4, s[4:7], s56 offen
    s_waitcnt vmcnt(48)
    v_perm_b32 v80, v57, v56, s61
    v_perm_b32 v81, v59, v58, s61
    v_perm_b32 v82, v61, v60, s61
    v_perm_b32 v83, v63, v62, s61
    v_perm_b32 v84, v57, v56, s62
    v_perm_b32 v85, v59, v58, s62
    v_perm_b32 v86, v61, v60, s62
    v_perm_b32 v87, v63, v62, s62
    v_accvgpr_write_b32 a160, v80
    v_accvgpr_write_b32 a161, v81
    v_accvgpr_write_b32 a162, v82
    v_accvgpr_write_b32 a163, v83
    v_accvgpr_write_b32 a168, v84
    v_accvgpr_write_b32 a169, v85
    v_accvgpr_write_b32 a170, v86
    v_accvgpr_write_b32 a171, v87
    s_xor_b32 s56, s63, 2883584
    s_add_u32 s56, s56, s58
    buffer_load_dword v56, v4, s[4:7], s56 offen
    s_add_u32 s56, s56, 8192
    buffer_load_dword v57, v4, s[4:7], s56 offen
    s_add_u32 s56, s56, 8192
    buffer_load_dword v58, v4, s[4:7], s56 offen
    s_add_u32 s56, s56, 8192
    buffer_load_dword v59, v4, s[4:7], s56 offen
    s_add_u32 s56, s56, 8192
    buffer_load_dword v60, v4, s[4:7], s56 offen
    s_add_u32 s56, s56, 8192
    buffer_load_dword v61, v4, s[4:7], s56 offen
    s_add_u32 s56, s56, 8192
    buffer_load_dword v62, v4, s[4:7], s56 offen
    s_add_u32 s56, s56, 8192
    buffer_load_dword v63, v4, s[4:7], s56 offen
    s_waitcnt vmcnt(48)
    v_perm_b32 v80, v65, v64, s61
    v_perm_b32 v81, v67, v66, s61
    v_perm_b32 v82, v69, v68, s61
    v_perm_b32 v83, v71, v70, s61
    v_perm_b32 v84, v65, v64, s62
    v_perm_b32 v85, v67, v66, s62
    v_perm_b32 v86, v69, v68, s62
    v_perm_b32 v87, v71, v70, s62
    v_accvgpr_write_b32 a164, v80
    v_accvgpr_write_b32 a165, v81
    v_accvgpr_write_b32 a166, v82
    v_accvgpr_write_b32 a167, v83
    v_accvgpr_write_b32 a172, v84
    v_accvgpr_write_b32 a173, v85
    v_accvgpr_write_b32 a174, v86
    v_accvgpr_write_b32 a175, v87
    s_xor_b32 s56, s63, 3145728
    s_add_u32 s56, s56, s58
    buffer_load_dword v64, v4, s[4:7], s56 offen
    s_add_u32 s56, s56, 8192
    buffer_load_dword v65, v4, s[4:7], s56 offen
    s_add_u32 s56, s56, 8192
    buffer_load_dword v66, v4, s[4:7], s56 offen
    s_add_u32 s56, s56, 8192
    buffer_load_dword v67, v4, s[4:7], s56 offen
    s_add_u32 s56, s56, 8192
    buffer_load_dword v68, v4, s[4:7], s56 offen
    s_add_u32 s56, s56, 8192
    buffer_load_dword v69, v4, s[4:7], s56 offen
    s_add_u32 s56, s56, 8192
    buffer_load_dword v70, v4, s[4:7], s56 offen
    s_add_u32 s56, s56, 8192
    buffer_load_dword v71, v4, s[4:7], s56 offen
    s_waitcnt vmcnt(48)
    v_perm_b32 v80, v73, v72, s61
    v_perm_b32 v81, v75, v74, s61
    v_perm_b32 v82, v77, v76, s61
    v_perm_b32 v83, v79, v78, s61
    v_perm_b32 v84, v73, v72, s62
    v_perm_b32 v85, v75, v74, s62
    v_perm_b32 v86, v77, v76, s62
    v_perm_b32 v87, v79, v78, s62
    v_accvgpr_write_b32 a176, v80
    v_accvgpr_write_b32 a177, v81
    v_accvgpr_write_b32 a178, v82
    v_accvgpr_write_b32 a179, v83
    v_accvgpr_write_b32 a184, v84
    v_accvgpr_write_b32 a185, v85
    v_accvgpr_write_b32 a186, v86
    v_accvgpr_write_b32 a187, v87
    s_xor_b32 s56, s63, 3407872
    s_add_u32 s56, s56, s58
    buffer_load_dword v72, v4, s[4:7], s56 offen
    s_add_u32 s56, s56, 8192
    buffer_load_dword v73, v4, s[4:7], s56 offen
    s_add_u32 s56, s56, 8192
    buffer_load_dword v74, v4, s[4:7], s56 offen
    s_add_u32 s56, s56, 8192
    buffer_load_dword v75, v4, s[4:7], s56 offen
    s_add_u32 s56, s56, 8192
    buffer_load_dword v76, v4, s[4:7], s56 offen
    s_add_u32 s56, s56, 8192
    buffer_load_dword v77, v4, s[4:7], s56 offen
    s_add_u32 s56, s56, 8192
    buffer_load_dword v78, v4, s[4:7], s56 offen
    s_add_u32 s56, s56, 8192
    buffer_load_dword v79, v4, s[4:7], s56 offen
    s_waitcnt vmcnt(48)
    v_perm_b32 v80, v25, v24, s61
    v_perm_b32 v81, v27, v26, s61
    v_perm_b32 v82, v29, v28, s61
    v_perm_b32 v83, v31, v30, s61
    v_perm_b32 v84, v25, v24, s62
    v_perm_b32 v85, v27, v26, s62
    v_perm_b32 v86, v29, v28, s62
    v_perm_b32 v87, v31, v30, s62
    v_accvgpr_write_b32 a180, v80
    v_accvgpr_write_b32 a181, v81
    v_accvgpr_write_b32 a182, v82
    v_accvgpr_write_b32 a183, v83
    v_accvgpr_write_b32 a188, v84
    v_accvgpr_write_b32 a189, v85
    v_accvgpr_write_b32 a190, v86
    v_accvgpr_write_b32 a191, v87
    s_xor_b32 s56, s63, 3670016
    s_add_u32 s56, s56, s58
    buffer_load_dword v24, v4, s[4:7], s56 offen
    s_add_u32 s56, s56, 8192
    buffer_load_dword v25, v4, s[4:7], s56 offen
    s_add_u32 s56, s56, 8192
    buffer_load_dword v26, v4, s[4:7], s56 offen
    s_add_u32 s56, s56, 8192
    buffer_load_dword v27, v4, s[4:7], s56 offen
    s_add_u32 s56, s56, 8192
    buffer_load_dword v28, v4, s[4:7], s56 offen
    s_add_u32 s56, s56, 8192
    buffer_load_dword v29, v4, s[4:7], s56 offen
    s_add_u32 s56, s56, 8192
    buffer_load_dword v30, v4, s[4:7], s56 offen
    s_add_u32 s56, s56, 8192
    buffer_load_dword v31, v4, s[4:7], s56 offen
    s_waitcnt vmcnt(48)
    v_perm_b32 v80, v33, v32, s61
    v_perm_b32 v81, v35, v34, s61
    v_perm_b32 v82, v37, v36, s61
    v_perm_b32 v83, v39, v38, s61
    v_perm_b32 v84, v33, v32, s62
    v_perm_b32 v85, v35, v34, s62
    v_perm_b32 v86, v37, v36, s62
    v_perm_b32 v87, v39, v38, s62
    v_accvgpr_write_b32 a192, v80
    v_accvgpr_write_b32 a193, v81
    v_accvgpr_write_b32 a194, v82
    v_accvgpr_write_b32 a195, v83
    v_accvgpr_write_b32 a200, v84
    v_accvgpr_write_b32 a201, v85
    v_accvgpr_write_b32 a202, v86
    v_accvgpr_write_b32 a203, v87
    s_xor_b32 s56, s63, 3932160
    s_add_u32 s56, s56, s58
    buffer_load_dword v32, v4, s[4:7], s56 offen
    s_add_u32 s56, s56, 8192
    buffer_load_dword v33, v4, s[4:7], s56 offen
    s_add_u32 s56, s56, 8192
    buffer_load_dword v34, v4, s[4:7], s56 offen
    s_add_u32 s56, s56, 8192
    buffer_load_dword v35, v4, s[4:7], s56 offen
    s_add_u32 s56, s56, 8192
    buffer_load_dword v36, v4, s[4:7], s56 offen
    s_add_u32 s56, s56, 8192
    buffer_load_dword v37, v4, s[4:7], s56 offen
    s_add_u32 s56, s56, 8192
    buffer_load_dword v38, v4, s[4:7], s56 offen
    s_add_u32 s56, s56, 8192
    buffer_load_dword v39, v4, s[4:7], s56 offen
    s_waitcnt vmcnt(48)
    v_perm_b32 v80, v41, v40, s61
    v_perm_b32 v81, v43, v42, s61
    v_perm_b32 v82, v45, v44, s61
    v_perm_b32 v83, v47, v46, s61
    v_perm_b32 v84, v41, v40, s62
    v_perm_b32 v85, v43, v42, s62
    v_perm_b32 v86, v45, v44, s62
    v_perm_b32 v87, v47, v46, s62
    v_accvgpr_write_b32 a196, v80
    v_accvgpr_write_b32 a197, v81
    v_accvgpr_write_b32 a198, v82
    v_accvgpr_write_b32 a199, v83
    v_accvgpr_write_b32 a204, v84
    v_accvgpr_write_b32 a205, v85
    v_accvgpr_write_b32 a206, v86
    v_accvgpr_write_b32 a207, v87
    s_mov_b32 s4, s24
    s_mov_b32 s5, s25
    s_mov_b32 s6, 4194304
    s_mov_b32 s7, 0x20000
    s_xor_b32 s56, s63, 0
    s_add_u32 s56, s56, s58
    buffer_load_dword v40, v4, s[4:7], s56 offen
    s_add_u32 s56, s56, 8192
    buffer_load_dword v41, v4, s[4:7], s56 offen
    s_add_u32 s56, s56, 8192
    buffer_load_dword v42, v4, s[4:7], s56 offen
    s_add_u32 s56, s56, 8192
    buffer_load_dword v43, v4, s[4:7], s56 offen
    s_add_u32 s56, s56, 8192
    buffer_load_dword v44, v4, s[4:7], s56 offen
    s_add_u32 s56, s56, 8192
    buffer_load_dword v45, v4, s[4:7], s56 offen
    s_add_u32 s56, s56, 8192
    buffer_load_dword v46, v4, s[4:7], s56 offen
    s_add_u32 s56, s56, 8192
    buffer_load_dword v47, v4, s[4:7], s56 offen
    s_waitcnt vmcnt(48)
    v_perm_b32 v80, v49, v48, s61
    v_perm_b32 v81, v51, v50, s61
    v_perm_b32 v82, v53, v52, s61
    v_perm_b32 v83, v55, v54, s61
    v_perm_b32 v84, v49, v48, s62
    v_perm_b32 v85, v51, v50, s62
    v_perm_b32 v86, v53, v52, s62
    v_perm_b32 v87, v55, v54, s62
    v_accvgpr_write_b32 a208, v80
    v_accvgpr_write_b32 a209, v81
    v_accvgpr_write_b32 a210, v82
    v_accvgpr_write_b32 a211, v83
    v_accvgpr_write_b32 a216, v84
    v_accvgpr_write_b32 a217, v85
    v_accvgpr_write_b32 a218, v86
    v_accvgpr_write_b32 a219, v87
    s_xor_b32 s56, s63, 262144
    s_add_u32 s56, s56, s58
    buffer_load_dword v48, v4, s[4:7], s56 offen
    s_add_u32 s56, s56, 8192
    buffer_load_dword v49, v4, s[4:7], s56 offen
    s_add_u32 s56, s56, 8192
    buffer_load_dword v50, v4, s[4:7], s56 offen
    s_add_u32 s56, s56, 8192
    buffer_load_dword v51, v4, s[4:7], s56 offen
    s_add_u32 s56, s56, 8192
    buffer_load_dword v52, v4, s[4:7], s56 offen
    s_add_u32 s56, s56, 8192
    buffer_load_dword v53, v4, s[4:7], s56 offen
    s_add_u32 s56, s56, 8192
    buffer_load_dword v54, v4, s[4:7], s56 offen
    s_add_u32 s56, s56, 8192
    buffer_load_dword v55, v4, s[4:7], s56 offen
    s_waitcnt vmcnt(48)
    v_perm_b32 v80, v57, v56, s61
    v_perm_b32 v81, v59, v58, s61
    v_perm_b32 v82, v61, v60, s61
    v_perm_b32 v83, v63, v62, s61
    v_perm_b32 v84, v57, v56, s62
    v_perm_b32 v85, v59, v58, s62
    v_perm_b32 v86, v61, v60, s62
    v_perm_b32 v87, v63, v62, s62
    v_accvgpr_write_b32 a212, v80
    v_accvgpr_write_b32 a213, v81
    v_accvgpr_write_b32 a214, v82
    v_accvgpr_write_b32 a215, v83
    v_accvgpr_write_b32 a220, v84
    v_accvgpr_write_b32 a221, v85
    v_accvgpr_write_b32 a222, v86
    v_accvgpr_write_b32 a223, v87
    s_xor_b32 s56, s63, 524288
    s_add_u32 s56, s56, s58
    buffer_load_dword v56, v4, s[4:7], s56 offen
    s_add_u32 s56, s56, 8192
    buffer_load_dword v57, v4, s[4:7], s56 offen
    s_add_u32 s56, s56, 8192
    buffer_load_dword v58, v4, s[4:7], s56 offen
    s_add_u32 s56, s56, 8192
    buffer_load_dword v59, v4, s[4:7], s56 offen
    s_add_u32 s56, s56, 8192
    buffer_load_dword v60, v4, s[4:7], s56 offen
    s_add_u32 s56, s56, 8192
    buffer_load_dword v61, v4, s[4:7], s56 offen
    s_add_u32 s56, s56, 8192
    buffer_load_dword v62, v4, s[4:7], s56 offen
    s_add_u32 s56, s56, 8192
    buffer_load_dword v63, v4, s[4:7], s56 offen
    s_waitcnt vmcnt(48)
    v_perm_b32 v80, v65, v64, s61
    v_perm_b32 v81, v67, v66, s61
    v_perm_b32 v82, v69, v68, s61
    v_perm_b32 v83, v71, v70, s61
    v_perm_b32 v84, v65, v64, s62
    v_perm_b32 v85, v67, v66, s62
    v_perm_b32 v86, v69, v68, s62
    v_perm_b32 v87, v71, v70, s62
    v_accvgpr_write_b32 a224, v80
    v_accvgpr_write_b32 a225, v81
    v_accvgpr_write_b32 a226, v82
    v_accvgpr_write_b32 a227, v83
    v_accvgpr_write_b32 a232, v84
    v_accvgpr_write_b32 a233, v85
    v_accvgpr_write_b32 a234, v86
    v_accvgpr_write_b32 a235, v87
    s_xor_b32 s56, s63, 786432
    s_add_u32 s56, s56, s58
    buffer_load_dword v64, v4, s[4:7], s56 offen
    s_add_u32 s56, s56, 8192
    buffer_load_dword v65, v4, s[4:7], s56 offen
    s_add_u32 s56, s56, 8192
    buffer_load_dword v66, v4, s[4:7], s56 offen
    s_add_u32 s56, s56, 8192
    buffer_load_dword v67, v4, s[4:7], s56 offen
    s_add_u32 s56, s56, 8192
    buffer_load_dword v68, v4, s[4:7], s56 offen
    s_add_u32 s56, s56, 8192
    buffer_load_dword v69, v4, s[4:7], s56 offen
    s_add_u32 s56, s56, 8192
    buffer_load_dword v70, v4, s[4:7], s56 offen
    s_add_u32 s56, s56, 8192
    buffer_load_dword v71, v4, s[4:7], s56 offen
    s_waitcnt vmcnt(48)
    v_perm_b32 v80, v73, v72, s61
    v_perm_b32 v81, v75, v74, s61
    v_perm_b32 v82, v77, v76, s61
    v_perm_b32 v83, v79, v78, s61
    v_perm_b32 v84, v73, v72, s62
    v_perm_b32 v85, v75, v74, s62
    v_perm_b32 v86, v77, v76, s62
    v_perm_b32 v87, v79, v78, s62
    v_accvgpr_write_b32 a228, v80
    v_accvgpr_write_b32 a229, v81
    v_accvgpr_write_b32 a230, v82
    v_accvgpr_write_b32 a231, v83
    v_accvgpr_write_b32 a236, v84
    v_accvgpr_write_b32 a237, v85
    v_accvgpr_write_b32 a238, v86
    v_accvgpr_write_b32 a239, v87
    s_xor_b32 s56, s63, 1048576
    s_add_u32 s56, s56, s58
    buffer_load_dword v72, v4, s[4:7], s56 offen
    s_add_u32 s56, s56, 8192
    buffer_load_dword v73, v4, s[4:7], s56 offen
    s_add_u32 s56, s56, 8192
    buffer_load_dword v74, v4, s[4:7], s56 offen
    s_add_u32 s56, s56, 8192
    buffer_load_dword v75, v4, s[4:7], s56 offen
    s_add_u32 s56, s56, 8192
    buffer_load_dword v76, v4, s[4:7], s56 offen
    s_add_u32 s56, s56, 8192
    buffer_load_dword v77, v4, s[4:7], s56 offen
    s_add_u32 s56, s56, 8192
    buffer_load_dword v78, v4, s[4:7], s56 offen
    s_add_u32 s56, s56, 8192
    buffer_load_dword v79, v4, s[4:7], s56 offen
    s_waitcnt vmcnt(48)
    v_perm_b32 v80, v25, v24, s61
    v_perm_b32 v81, v27, v26, s61
    v_perm_b32 v82, v29, v28, s61
    v_perm_b32 v83, v31, v30, s61
    v_perm_b32 v84, v25, v24, s62
    v_perm_b32 v85, v27, v26, s62
    v_perm_b32 v86, v29, v28, s62
    v_perm_b32 v87, v31, v30, s62
    v_accvgpr_write_b32 a240, v80
    v_accvgpr_write_b32 a241, v81
    v_accvgpr_write_b32 a242, v82
    v_accvgpr_write_b32 a243, v83
    v_accvgpr_write_b32 a248, v84
    v_accvgpr_write_b32 a249, v85
    v_accvgpr_write_b32 a250, v86
    v_accvgpr_write_b32 a251, v87
    s_xor_b32 s56, s63, 1310720
    s_add_u32 s56, s56, s58
    buffer_load_dword v24, v4, s[4:7], s56 offen
    s_add_u32 s56, s56, 8192
    buffer_load_dword v25, v4, s[4:7], s56 offen
    s_add_u32 s56, s56, 8192
    buffer_load_dword v26, v4, s[4:7], s56 offen
    s_add_u32 s56, s56, 8192
    buffer_load_dword v27, v4, s[4:7], s56 offen
    s_add_u32 s56, s56, 8192
    buffer_load_dword v28, v4, s[4:7], s56 offen
    s_add_u32 s56, s56, 8192
    buffer_load_dword v29, v4, s[4:7], s56 offen
    s_add_u32 s56, s56, 8192
    buffer_load_dword v30, v4, s[4:7], s56 offen
    s_add_u32 s56, s56, 8192
    buffer_load_dword v31, v4, s[4:7], s56 offen
    s_waitcnt vmcnt(48)
    v_perm_b32 v80, v33, v32, s61
    v_perm_b32 v81, v35, v34, s61
    v_perm_b32 v82, v37, v36, s61
    v_perm_b32 v83, v39, v38, s61
    v_perm_b32 v84, v33, v32, s62
    v_perm_b32 v85, v35, v34, s62
    v_perm_b32 v86, v37, v36, s62
    v_perm_b32 v87, v39, v38, s62
    v_accvgpr_write_b32 a244, v80
    v_accvgpr_write_b32 a245, v81
    v_accvgpr_write_b32 a246, v82
    v_accvgpr_write_b32 a247, v83
    v_accvgpr_write_b32 a252, v84
    v_accvgpr_write_b32 a253, v85
    v_accvgpr_write_b32 a254, v86
    v_accvgpr_write_b32 a255, v87
    s_xor_b32 s56, s63, 1572864
    s_add_u32 s56, s56, s58
    buffer_load_dword v32, v4, s[4:7], s56 offen
    s_add_u32 s56, s56, 8192
    buffer_load_dword v33, v4, s[4:7], s56 offen
    s_add_u32 s56, s56, 8192
    buffer_load_dword v34, v4, s[4:7], s56 offen
    s_add_u32 s56, s56, 8192
    buffer_load_dword v35, v4, s[4:7], s56 offen
    s_add_u32 s56, s56, 8192
    buffer_load_dword v36, v4, s[4:7], s56 offen
    s_add_u32 s56, s56, 8192
    buffer_load_dword v37, v4, s[4:7], s56 offen
    s_add_u32 s56, s56, 8192
    buffer_load_dword v38, v4, s[4:7], s56 offen
    s_add_u32 s56, s56, 8192
    buffer_load_dword v39, v4, s[4:7], s56 offen
    s_waitcnt vmcnt(48)
    v_perm_b32 v128, v41, v40, s61
    v_perm_b32 v129, v43, v42, s61
    v_perm_b32 v130, v45, v44, s61
    v_perm_b32 v131, v47, v46, s61
    v_perm_b32 v136, v41, v40, s62
    v_perm_b32 v137, v43, v42, s62
    v_perm_b32 v138, v45, v44, s62
    v_perm_b32 v139, v47, v46, s62
    s_xor_b32 s56, s63, 1835008
    s_add_u32 s56, s56, s58
    buffer_load_dword v40, v4, s[4:7], s56 offen
    s_add_u32 s56, s56, 8192
    buffer_load_dword v41, v4, s[4:7], s56 offen
    s_add_u32 s56, s56, 8192
    buffer_load_dword v42, v4, s[4:7], s56 offen
    s_add_u32 s56, s56, 8192
    buffer_load_dword v43, v4, s[4:7], s56 offen
    s_add_u32 s56, s56, 8192
    buffer_load_dword v44, v4, s[4:7], s56 offen
    s_add_u32 s56, s56, 8192
    buffer_load_dword v45, v4, s[4:7], s56 offen
    s_add_u32 s56, s56, 8192
    buffer_load_dword v46, v4, s[4:7], s56 offen
    s_add_u32 s56, s56, 8192
    buffer_load_dword v47, v4, s[4:7], s56 offen
    s_waitcnt vmcnt(48)
    v_perm_b32 v132, v49, v48, s61
    v_perm_b32 v133, v51, v50, s61
    v_perm_b32 v134, v53, v52, s61
    v_perm_b32 v135, v55, v54, s61
    v_perm_b32 v140, v49, v48, s62
    v_perm_b32 v141, v51, v50, s62
    v_perm_b32 v142, v53, v52, s62
    v_perm_b32 v143, v55, v54, s62
    s_xor_b32 s56, s63, 2097152
    s_add_u32 s56, s56, s58
    buffer_load_dword v48, v4, s[4:7], s56 offen
    s_add_u32 s56, s56, 8192
    buffer_load_dword v49, v4, s[4:7], s56 offen
    s_add_u32 s56, s56, 8192
    buffer_load_dword v50, v4, s[4:7], s56 offen
    s_add_u32 s56, s56, 8192
    buffer_load_dword v51, v4, s[4:7], s56 offen
    s_add_u32 s56, s56, 8192
    buffer_load_dword v52, v4, s[4:7], s56 offen
    s_add_u32 s56, s56, 8192
    buffer_load_dword v53, v4, s[4:7], s56 offen
    s_add_u32 s56, s56, 8192
    buffer_load_dword v54, v4, s[4:7], s56 offen
    s_add_u32 s56, s56, 8192
    buffer_load_dword v55, v4, s[4:7], s56 offen
    s_waitcnt vmcnt(48)
    v_perm_b32 v144, v57, v56, s61
    v_perm_b32 v145, v59, v58, s61
    v_perm_b32 v146, v61, v60, s61
    v_perm_b32 v147, v63, v62, s61
    v_perm_b32 v152, v57, v56, s62
    v_perm_b32 v153, v59, v58, s62
    v_perm_b32 v154, v61, v60, s62
    v_perm_b32 v155, v63, v62, s62
    s_xor_b32 s56, s63, 2359296
    s_add_u32 s56, s56, s58
    buffer_load_dword v56, v4, s[4:7], s56 offen
    s_add_u32 s56, s56, 8192
    buffer_load_dword v57, v4, s[4:7], s56 offen
    s_add_u32 s56, s56, 8192
    buffer_load_dword v58, v4, s[4:7], s56 offen
    s_add_u32 s56, s56, 8192
    buffer_load_dword v59, v4, s[4:7], s56 offen
    s_add_u32 s56, s56, 8192
    buffer_load_dword v60, v4, s[4:7], s56 offen
    s_add_u32 s56, s56, 8192
    buffer_load_dword v61, v4, s[4:7], s56 offen
    s_add_u32 s56, s56, 8192
    buffer_load_dword v62, v4, s[4:7], s56 offen
    s_add_u32 s56, s56, 8192
    buffer_load_dword v63, v4, s[4:7], s56 offen
    s_waitcnt vmcnt(48)
    v_perm_b32 v148, v65, v64, s61
    v_perm_b32 v149, v67, v66, s61
    v_perm_b32 v150, v69, v68, s61
    v_perm_b32 v151, v71, v70, s61
    v_perm_b32 v156, v65, v64, s62
    v_perm_b32 v157, v67, v66, s62
    v_perm_b32 v158, v69, v68, s62
    v_perm_b32 v159, v71, v70, s62
    s_xor_b32 s56, s63, 2621440
    s_add_u32 s56, s56, s58
    buffer_load_dword v64, v4, s[4:7], s56 offen
    s_add_u32 s56, s56, 8192
    buffer_load_dword v65, v4, s[4:7], s56 offen
    s_add_u32 s56, s56, 8192
    buffer_load_dword v66, v4, s[4:7], s56 offen
    s_add_u32 s56, s56, 8192
    buffer_load_dword v67, v4, s[4:7], s56 offen
    s_add_u32 s56, s56, 8192
    buffer_load_dword v68, v4, s[4:7], s56 offen
    s_add_u32 s56, s56, 8192
    buffer_load_dword v69, v4, s[4:7], s56 offen
    s_add_u32 s56, s56, 8192
    buffer_load_dword v70, v4, s[4:7], s56 offen
    s_add_u32 s56, s56, 8192
    buffer_load_dword v71, v4, s[4:7], s56 offen
    s_waitcnt vmcnt(48)
    v_perm_b32 v160, v73, v72, s61
    v_perm_b32 v161, v75, v74, s61
    v_perm_b32 v162, v77, v76, s61
    v_perm_b32 v163, v79, v78, s61
    v_perm_b32 v168, v73, v72, s62
    v_perm_b32 v169, v75, v74, s62
    v_perm_b32 v170, v77, v76, s62
    v_perm_b32 v171, v79, v78, s62
    s_xor_b32 s56, s63, 2883584
    s_add_u32 s56, s56, s58
    buffer_load_dword v72, v4, s[4:7], s56 offen
    s_add_u32 s56, s56, 8192
    buffer_load_dword v73, v4, s[4:7], s56 offen
    s_add_u32 s56, s56, 8192
    buffer_load_dword v74, v4, s[4:7], s56 offen
    s_add_u32 s56, s56, 8192
    buffer_load_dword v75, v4, s[4:7], s56 offen
    s_add_u32 s56, s56, 8192
    buffer_load_dword v76, v4, s[4:7], s56 offen
    s_add_u32 s56, s56, 8192
    buffer_load_dword v77, v4, s[4:7], s56 offen
    s_add_u32 s56, s56, 8192
    buffer_load_dword v78, v4, s[4:7], s56 offen
    s_add_u32 s56, s56, 8192
    buffer_load_dword v79, v4, s[4:7], s56 offen
    s_waitcnt vmcnt(48)
    v_perm_b32 v164, v25, v24, s61
    v_perm_b32 v165, v27, v26, s61
    v_perm_b32 v166, v29, v28, s61
    v_perm_b32 v167, v31, v30, s61
    v_perm_b32 v172, v25, v24, s62
    v_perm_b32 v173, v27, v26, s62
    v_perm_b32 v174, v29, v28, s62
    v_perm_b32 v175, v31, v30, s62
    s_xor_b32 s56, s63, 3145728
    s_add_u32 s56, s56, s58
    buffer_load_dword v24, v4, s[4:7], s56 offen
    s_add_u32 s56, s56, 8192
    buffer_load_dword v25, v4, s[4:7], s56 offen
    s_add_u32 s56, s56, 8192
    buffer_load_dword v26, v4, s[4:7], s56 offen
    s_add_u32 s56, s56, 8192
    buffer_load_dword v27, v4, s[4:7], s56 offen
    s_add_u32 s56, s56, 8192
    buffer_load_dword v28, v4, s[4:7], s56 offen
    s_add_u32 s56, s56, 8192
    buffer_load_dword v29, v4, s[4:7], s56 offen
    s_add_u32 s56, s56, 8192
    buffer_load_dword v30, v4, s[4:7], s56 offen
    s_add_u32 s56, s56, 8192
    buffer_load_dword v31, v4, s[4:7], s56 offen
    s_waitcnt vmcnt(48)
    v_perm_b32 v176, v33, v32, s61
    v_perm_b32 v177, v35, v34, s61
    v_perm_b32 v178, v37, v36, s61
    v_perm_b32 v179, v39, v38, s61
    v_perm_b32 v184, v33, v32, s62
    v_perm_b32 v185, v35, v34, s62
    v_perm_b32 v186, v37, v36, s62
    v_perm_b32 v187, v39, v38, s62
    s_xor_b32 s56, s63, 3407872
    s_add_u32 s56, s56, s58
    buffer_load_dword v32, v4, s[4:7], s56 offen
    s_add_u32 s56, s56, 8192
    buffer_load_dword v33, v4, s[4:7], s56 offen
    s_add_u32 s56, s56, 8192
    buffer_load_dword v34, v4, s[4:7], s56 offen
    s_add_u32 s56, s56, 8192
    buffer_load_dword v35, v4, s[4:7], s56 offen
    s_add_u32 s56, s56, 8192
    buffer_load_dword v36, v4, s[4:7], s56 offen
    s_add_u32 s56, s56, 8192
    buffer_load_dword v37, v4, s[4:7], s56 offen
    s_add_u32 s56, s56, 8192
    buffer_load_dword v38, v4, s[4:7], s56 offen
    s_add_u32 s56, s56, 8192
    buffer_load_dword v39, v4, s[4:7], s56 offen
    s_waitcnt vmcnt(48)
    v_perm_b32 v180, v41, v40, s61
    v_perm_b32 v181, v43, v42, s61
    v_perm_b32 v182, v45, v44, s61
    v_perm_b32 v183, v47, v46, s61
    v_perm_b32 v188, v41, v40, s62
    v_perm_b32 v189, v43, v42, s62
    v_perm_b32 v190, v45, v44, s62
    v_perm_b32 v191, v47, v46, s62
    s_xor_b32 s56, s63, 3670016
    s_add_u32 s56, s56, s58
    buffer_load_dword v40, v4, s[4:7], s56 offen
    s_add_u32 s56, s56, 8192
    buffer_load_dword v41, v4, s[4:7], s56 offen
    s_add_u32 s56, s56, 8192
    buffer_load_dword v42, v4, s[4:7], s56 offen
    s_add_u32 s56, s56, 8192
    buffer_load_dword v43, v4, s[4:7], s56 offen
    s_add_u32 s56, s56, 8192
    buffer_load_dword v44, v4, s[4:7], s56 offen
    s_add_u32 s56, s56, 8192
    buffer_load_dword v45, v4, s[4:7], s56 offen
    s_add_u32 s56, s56, 8192
    buffer_load_dword v46, v4, s[4:7], s56 offen
    s_add_u32 s56, s56, 8192
    buffer_load_dword v47, v4, s[4:7], s56 offen
    s_waitcnt vmcnt(48)
    v_perm_b32 v192, v49, v48, s61
    v_perm_b32 v193, v51, v50, s61
    v_perm_b32 v194, v53, v52, s61
    v_perm_b32 v195, v55, v54, s61
    v_perm_b32 v200, v49, v48, s62
    v_perm_b32 v201, v51, v50, s62
    v_perm_b32 v202, v53, v52, s62
    v_perm_b32 v203, v55, v54, s62
    s_xor_b32 s56, s63, 3932160
    s_add_u32 s56, s56, s58
    buffer_load_dword v48, v4, s[4:7], s56 offen
    s_add_u32 s56, s56, 8192
    buffer_load_dword v49, v4, s[4:7], s56 offen
    s_add_u32 s56, s56, 8192
    buffer_load_dword v50, v4, s[4:7], s56 offen
    s_add_u32 s56, s56, 8192
    buffer_load_dword v51, v4, s[4:7], s56 offen
    s_add_u32 s56, s56, 8192
    buffer_load_dword v52, v4, s[4:7], s56 offen
    s_add_u32 s56, s56, 8192
    buffer_load_dword v53, v4, s[4:7], s56 offen
    s_add_u32 s56, s56, 8192
    buffer_load_dword v54, v4, s[4:7], s56 offen
    s_add_u32 s56, s56, 8192
    buffer_load_dword v55, v4, s[4:7], s56 offen
    s_waitcnt vmcnt(48)
    v_perm_b32 v196, v57, v56, s61
    v_perm_b32 v197, v59, v58, s61
    v_perm_b32 v198, v61, v60, s61
    v_perm_b32 v199, v63, v62, s61
    v_perm_b32 v204, v57, v56, s62
    v_perm_b32 v205, v59, v58, s62
    v_perm_b32 v206, v61, v60, s62
    v_perm_b32 v207, v63, v62, s62
    s_mov_b32 s4, s20
    s_mov_b32 s5, s21
    s_mov_b32 s6, 4194304
    s_mov_b32 s7, 0x20000
    s_xor_b32 s56, s63, 0
    s_add_u32 s56, s56, s58
    buffer_load_dword v56, v4, s[4:7], s56 offen
    s_add_u32 s56, s56, 8192
    buffer_load_dword v57, v4, s[4:7], s56 offen
    s_add_u32 s56, s56, 8192
    buffer_load_dword v58, v4, s[4:7], s56 offen
    s_add_u32 s56, s56, 8192
    buffer_load_dword v59, v4, s[4:7], s56 offen
    s_add_u32 s56, s56, 8192
    buffer_load_dword v60, v4, s[4:7], s56 offen
    s_add_u32 s56, s56, 8192
    buffer_load_dword v61, v4, s[4:7], s56 offen
    s_add_u32 s56, s56, 8192
    buffer_load_dword v62, v4, s[4:7], s56 offen
    s_add_u32 s56, s56, 8192
    buffer_load_dword v63, v4, s[4:7], s56 offen
    s_waitcnt vmcnt(48)
    v_perm_b32 v208, v65, v64, s61
    v_perm_b32 v209, v67, v66, s61
    v_perm_b32 v210, v69, v68, s61
    v_perm_b32 v211, v71, v70, s61
    v_perm_b32 v216, v65, v64, s62
    v_perm_b32 v217, v67, v66, s62
    v_perm_b32 v218, v69, v68, s62
    v_perm_b32 v219, v71, v70, s62
    s_xor_b32 s56, s63, 262144
    s_add_u32 s56, s56, s58
    buffer_load_dword v64, v4, s[4:7], s56 offen
    s_add_u32 s56, s56, 8192
    buffer_load_dword v65, v4, s[4:7], s56 offen
    s_add_u32 s56, s56, 8192
    buffer_load_dword v66, v4, s[4:7], s56 offen
    s_add_u32 s56, s56, 8192
    buffer_load_dword v67, v4, s[4:7], s56 offen
    s_add_u32 s56, s56, 8192
    buffer_load_dword v68, v4, s[4:7], s56 offen
    s_add_u32 s56, s56, 8192
    buffer_load_dword v69, v4, s[4:7], s56 offen
    s_add_u32 s56, s56, 8192
    buffer_load_dword v70, v4, s[4:7], s56 offen
    s_add_u32 s56, s56, 8192
    buffer_load_dword v71, v4, s[4:7], s56 offen
    s_waitcnt vmcnt(48)
    v_perm_b32 v212, v73, v72, s61
    v_perm_b32 v213, v75, v74, s61
    v_perm_b32 v214, v77, v76, s61
    v_perm_b32 v215, v79, v78, s61
    v_perm_b32 v220, v73, v72, s62
    v_perm_b32 v221, v75, v74, s62
    v_perm_b32 v222, v77, v76, s62
    v_perm_b32 v223, v79, v78, s62
    s_xor_b32 s56, s63, 524288
    s_add_u32 s56, s56, s58
    buffer_load_dword v72, v4, s[4:7], s56 offen
    s_add_u32 s56, s56, 8192
    buffer_load_dword v73, v4, s[4:7], s56 offen
    s_add_u32 s56, s56, 8192
    buffer_load_dword v74, v4, s[4:7], s56 offen
    s_add_u32 s56, s56, 8192
    buffer_load_dword v75, v4, s[4:7], s56 offen
    s_add_u32 s56, s56, 8192
    buffer_load_dword v76, v4, s[4:7], s56 offen
    s_add_u32 s56, s56, 8192
    buffer_load_dword v77, v4, s[4:7], s56 offen
    s_add_u32 s56, s56, 8192
    buffer_load_dword v78, v4, s[4:7], s56 offen
    s_add_u32 s56, s56, 8192
    buffer_load_dword v79, v4, s[4:7], s56 offen
    s_waitcnt vmcnt(48)
    v_perm_b32 v224, v25, v24, s61
    v_perm_b32 v225, v27, v26, s61
    v_perm_b32 v226, v29, v28, s61
    v_perm_b32 v227, v31, v30, s61
    v_perm_b32 v232, v25, v24, s62
    v_perm_b32 v233, v27, v26, s62
    v_perm_b32 v234, v29, v28, s62
    v_perm_b32 v235, v31, v30, s62
    s_xor_b32 s56, s63, 786432
    s_add_u32 s56, s56, s58
    buffer_load_dword v24, v4, s[4:7], s56 offen
    s_add_u32 s56, s56, 8192
    buffer_load_dword v25, v4, s[4:7], s56 offen
    s_add_u32 s56, s56, 8192
    buffer_load_dword v26, v4, s[4:7], s56 offen
    s_add_u32 s56, s56, 8192
    buffer_load_dword v27, v4, s[4:7], s56 offen
    s_add_u32 s56, s56, 8192
    buffer_load_dword v28, v4, s[4:7], s56 offen
    s_add_u32 s56, s56, 8192
    buffer_load_dword v29, v4, s[4:7], s56 offen
    s_add_u32 s56, s56, 8192
    buffer_load_dword v30, v4, s[4:7], s56 offen
    s_add_u32 s56, s56, 8192
    buffer_load_dword v31, v4, s[4:7], s56 offen
    s_waitcnt vmcnt(48)
    v_perm_b32 v228, v33, v32, s61
    v_perm_b32 v229, v35, v34, s61
    v_perm_b32 v230, v37, v36, s61
    v_perm_b32 v231, v39, v38, s61
    v_perm_b32 v236, v33, v32, s62
    v_perm_b32 v237, v35, v34, s62
    v_perm_b32 v238, v37, v36, s62
    v_perm_b32 v239, v39, v38, s62
    s_xor_b32 s56, s63, 1048576
    s_add_u32 s56, s56, s58
    buffer_load_dword v32, v4, s[4:7], s56 offen
    s_add_u32 s56, s56, 8192
    buffer_load_dword v33, v4, s[4:7], s56 offen
    s_add_u32 s56, s56, 8192
    buffer_load_dword v34, v4, s[4:7], s56 offen
    s_add_u32 s56, s56, 8192
    buffer_load_dword v35, v4, s[4:7], s56 offen
    s_add_u32 s56, s56, 8192
    buffer_load_dword v36, v4, s[4:7], s56 offen
    s_add_u32 s56, s56, 8192
    buffer_load_dword v37, v4, s[4:7], s56 offen
    s_add_u32 s56, s56, 8192
    buffer_load_dword v38, v4, s[4:7], s56 offen
    s_add_u32 s56, s56, 8192
    buffer_load_dword v39, v4, s[4:7], s56 offen
    s_waitcnt vmcnt(48)
    v_perm_b32 v240, v41, v40, s61
    v_perm_b32 v241, v43, v42, s61
    v_perm_b32 v242, v45, v44, s61
    v_perm_b32 v243, v47, v46, s61
    v_perm_b32 v248, v41, v40, s62
    v_perm_b32 v249, v43, v42, s62
    v_perm_b32 v250, v45, v44, s62
    v_perm_b32 v251, v47, v46, s62
    s_xor_b32 s56, s63, 1310720
    s_add_u32 s56, s56, s58
    buffer_load_dword v40, v4, s[4:7], s56 offen
    s_add_u32 s56, s56, 8192
    buffer_load_dword v41, v4, s[4:7], s56 offen
    s_add_u32 s56, s56, 8192
    buffer_load_dword v42, v4, s[4:7], s56 offen
    s_add_u32 s56, s56, 8192
    buffer_load_dword v43, v4, s[4:7], s56 offen
    s_add_u32 s56, s56, 8192
    buffer_load_dword v44, v4, s[4:7], s56 offen
    s_add_u32 s56, s56, 8192
    buffer_load_dword v45, v4, s[4:7], s56 offen
    s_add_u32 s56, s56, 8192
    buffer_load_dword v46, v4, s[4:7], s56 offen
    s_add_u32 s56, s56, 8192
    buffer_load_dword v47, v4, s[4:7], s56 offen
    s_waitcnt vmcnt(48)
    v_perm_b32 v244, v49, v48, s61
    v_perm_b32 v245, v51, v50, s61
    v_perm_b32 v246, v53, v52, s61
    v_perm_b32 v247, v55, v54, s61
    v_perm_b32 v252, v49, v48, s62
    v_perm_b32 v253, v51, v50, s62
    v_perm_b32 v254, v53, v52, s62
    v_perm_b32 v255, v55, v54, s62
    s_xor_b32 s56, s63, 1572864
    s_add_u32 s56, s56, s58
    buffer_load_dword v48, v4, s[4:7], s56 offen
    s_add_u32 s56, s56, 8192
    buffer_load_dword v49, v4, s[4:7], s56 offen
    s_add_u32 s56, s56, 8192
    buffer_load_dword v50, v4, s[4:7], s56 offen
    s_add_u32 s56, s56, 8192
    buffer_load_dword v51, v4, s[4:7], s56 offen
    s_add_u32 s56, s56, 8192
    buffer_load_dword v52, v4, s[4:7], s56 offen
    s_add_u32 s56, s56, 8192
    buffer_load_dword v53, v4, s[4:7], s56 offen
    s_add_u32 s56, s56, 8192
    buffer_load_dword v54, v4, s[4:7], s56 offen
    s_add_u32 s56, s56, 8192
    buffer_load_dword v55, v4, s[4:7], s56 offen
    s_waitcnt vmcnt(48)
    v_perm_b32 v80, v57, v56, s61
    v_perm_b32 v81, v59, v58, s61
    v_perm_b32 v82, v61, v60, s61
    v_perm_b32 v83, v63, v62, s61
    v_perm_b32 v84, v57, v56, s62
    v_perm_b32 v85, v59, v58, s62
    v_perm_b32 v86, v61, v60, s62
    v_perm_b32 v87, v63, v62, s62
    v_accvgpr_write_b32 a0, v80
    v_accvgpr_write_b32 a1, v81
    v_accvgpr_write_b32 a2, v82
    v_accvgpr_write_b32 a3, v83
    v_accvgpr_write_b32 a8, v84
    v_accvgpr_write_b32 a9, v85
    v_accvgpr_write_b32 a10, v86
    v_accvgpr_write_b32 a11, v87
    s_xor_b32 s56, s63, 1835008
    s_add_u32 s56, s56, s58
    buffer_load_dword v56, v4, s[4:7], s56 offen
    s_add_u32 s56, s56, 8192
    buffer_load_dword v57, v4, s[4:7], s56 offen
    s_add_u32 s56, s56, 8192
    buffer_load_dword v58, v4, s[4:7], s56 offen
    s_add_u32 s56, s56, 8192
    buffer_load_dword v59, v4, s[4:7], s56 offen
    s_add_u32 s56, s56, 8192
    buffer_load_dword v60, v4, s[4:7], s56 offen
    s_add_u32 s56, s56, 8192
    buffer_load_dword v61, v4, s[4:7], s56 offen
    s_add_u32 s56, s56, 8192
    buffer_load_dword v62, v4, s[4:7], s56 offen
    s_add_u32 s56, s56, 8192
    buffer_load_dword v63, v4, s[4:7], s56 offen
    s_waitcnt vmcnt(48)
    v_perm_b32 v80, v65, v64, s61
    v_perm_b32 v81, v67, v66, s61
    v_perm_b32 v82, v69, v68, s61
    v_perm_b32 v83, v71, v70, s61
    v_perm_b32 v84, v65, v64, s62
    v_perm_b32 v85, v67, v66, s62
    v_perm_b32 v86, v69, v68, s62
    v_perm_b32 v87, v71, v70, s62
    v_accvgpr_write_b32 a4, v80
    v_accvgpr_write_b32 a5, v81
    v_accvgpr_write_b32 a6, v82
    v_accvgpr_write_b32 a7, v83
    v_accvgpr_write_b32 a12, v84
    v_accvgpr_write_b32 a13, v85
    v_accvgpr_write_b32 a14, v86
    v_accvgpr_write_b32 a15, v87
    s_xor_b32 s56, s63, 2097152
    s_add_u32 s56, s56, s58
    buffer_load_dword v64, v4, s[4:7], s56 offen
    s_add_u32 s56, s56, 8192
    buffer_load_dword v65, v4, s[4:7], s56 offen
    s_add_u32 s56, s56, 8192
    buffer_load_dword v66, v4, s[4:7], s56 offen
    s_add_u32 s56, s56, 8192
    buffer_load_dword v67, v4, s[4:7], s56 offen
    s_add_u32 s56, s56, 8192
    buffer_load_dword v68, v4, s[4:7], s56 offen
    s_add_u32 s56, s56, 8192
    buffer_load_dword v69, v4, s[4:7], s56 offen
    s_add_u32 s56, s56, 8192
    buffer_load_dword v70, v4, s[4:7], s56 offen
    s_add_u32 s56, s56, 8192
    buffer_load_dword v71, v4, s[4:7], s56 offen
    s_waitcnt vmcnt(48)
    v_perm_b32 v80, v73, v72, s61
    v_perm_b32 v81, v75, v74, s61
    v_perm_b32 v82, v77, v76, s61
    v_perm_b32 v83, v79, v78, s61
    v_perm_b32 v84, v73, v72, s62
    v_perm_b32 v85, v75, v74, s62
    v_perm_b32 v86, v77, v76, s62
    v_perm_b32 v87, v79, v78, s62
    v_accvgpr_write_b32 a16, v80
    v_accvgpr_write_b32 a17, v81
    v_accvgpr_write_b32 a18, v82
    v_accvgpr_write_b32 a19, v83
    v_accvgpr_write_b32 a24, v84
    v_accvgpr_write_b32 a25, v85
    v_accvgpr_write_b32 a26, v86
    v_accvgpr_write_b32 a27, v87
    s_xor_b32 s56, s63, 2359296
    s_add_u32 s56, s56, s58
    buffer_load_dword v72, v4, s[4:7], s56 offen
    s_add_u32 s56, s56, 8192
    buffer_load_dword v73, v4, s[4:7], s56 offen
    s_add_u32 s56, s56, 8192
    buffer_load_dword v74, v4, s[4:7], s56 offen
    s_add_u32 s56, s56, 8192
    buffer_load_dword v75, v4, s[4:7], s56 offen
    s_add_u32 s56, s56, 8192
    buffer_load_dword v76, v4, s[4:7], s56 offen
    s_add_u32 s56, s56, 8192
    buffer_load_dword v77, v4, s[4:7], s56 offen
    s_add_u32 s56, s56, 8192
    buffer_load_dword v78, v4, s[4:7], s56 offen
    s_add_u32 s56, s56, 8192
    buffer_load_dword v79, v4, s[4:7], s56 offen
    s_waitcnt vmcnt(48)
    v_perm_b32 v80, v25, v24, s61
    v_perm_b32 v81, v27, v26, s61
    v_perm_b32 v82, v29, v28, s61
    v_perm_b32 v83, v31, v30, s61
    v_perm_b32 v84, v25, v24, s62
    v_perm_b32 v85, v27, v26, s62
    v_perm_b32 v86, v29, v28, s62
    v_perm_b32 v87, v31, v30, s62
    v_accvgpr_write_b32 a20, v80
    v_accvgpr_write_b32 a21, v81
    v_accvgpr_write_b32 a22, v82
    v_accvgpr_write_b32 a23, v83
    v_accvgpr_write_b32 a28, v84
    v_accvgpr_write_b32 a29, v85
    v_accvgpr_write_b32 a30, v86
    v_accvgpr_write_b32 a31, v87
    s_xor_b32 s56, s63, 2621440
    s_add_u32 s56, s56, s58
    buffer_load_dword v24, v4, s[4:7], s56 offen
    s_add_u32 s56, s56, 8192
    buffer_load_dword v25, v4, s[4:7], s56 offen
    s_add_u32 s56, s56, 8192
    buffer_load_dword v26, v4, s[4:7], s56 offen
    s_add_u32 s56, s56, 8192
    buffer_load_dword v27, v4, s[4:7], s56 offen
    s_add_u32 s56, s56, 8192
    buffer_load_dword v28, v4, s[4:7], s56 offen
    s_add_u32 s56, s56, 8192
    buffer_load_dword v29, v4, s[4:7], s56 offen
    s_add_u32 s56, s56, 8192
    buffer_load_dword v30, v4, s[4:7], s56 offen
    s_add_u32 s56, s56, 8192
    buffer_load_dword v31, v4, s[4:7], s56 offen
    s_waitcnt vmcnt(48)
    v_perm_b32 v80, v33, v32, s61
    v_perm_b32 v81, v35, v34, s61
    v_perm_b32 v82, v37, v36, s61
    v_perm_b32 v83, v39, v38, s61
    v_perm_b32 v84, v33, v32, s62
    v_perm_b32 v85, v35, v34, s62
    v_perm_b32 v86, v37, v36, s62
    v_perm_b32 v87, v39, v38, s62
    v_accvgpr_write_b32 a32, v80
    v_accvgpr_write_b32 a33, v81
    v_accvgpr_write_b32 a34, v82
    v_accvgpr_write_b32 a35, v83
    v_accvgpr_write_b32 a40, v84
    v_accvgpr_write_b32 a41, v85
    v_accvgpr_write_b32 a42, v86
    v_accvgpr_write_b32 a43, v87
    s_xor_b32 s56, s63, 2883584
    s_add_u32 s56, s56, s58
    buffer_load_dword v32, v4, s[4:7], s56 offen
    s_add_u32 s56, s56, 8192
    buffer_load_dword v33, v4, s[4:7], s56 offen
    s_add_u32 s56, s56, 8192
    buffer_load_dword v34, v4, s[4:7], s56 offen
    s_add_u32 s56, s56, 8192
    buffer_load_dword v35, v4, s[4:7], s56 offen
    s_add_u32 s56, s56, 8192
    buffer_load_dword v36, v4, s[4:7], s56 offen
    s_add_u32 s56, s56, 8192
    buffer_load_dword v37, v4, s[4:7], s56 offen
    s_add_u32 s56, s56, 8192
    buffer_load_dword v38, v4, s[4:7], s56 offen
    s_add_u32 s56, s56, 8192
    buffer_load_dword v39, v4, s[4:7], s56 offen
    s_waitcnt vmcnt(48)
    v_perm_b32 v80, v41, v40, s61
    v_perm_b32 v81, v43, v42, s61
    v_perm_b32 v82, v45, v44, s61
    v_perm_b32 v83, v47, v46, s61
    v_perm_b32 v84, v41, v40, s62
    v_perm_b32 v85, v43, v42, s62
    v_perm_b32 v86, v45, v44, s62
    v_perm_b32 v87, v47, v46, s62
    v_accvgpr_write_b32 a36, v80
    v_accvgpr_write_b32 a37, v81
    v_accvgpr_write_b32 a38, v82
    v_accvgpr_write_b32 a39, v83
    v_accvgpr_write_b32 a44, v84
    v_accvgpr_write_b32 a45, v85
    v_accvgpr_write_b32 a46, v86
    v_accvgpr_write_b32 a47, v87
    s_xor_b32 s56, s63, 3145728
    s_add_u32 s56, s56, s58
    buffer_load_dword v40, v4, s[4:7], s56 offen
    s_add_u32 s56, s56, 8192
    buffer_load_dword v41, v4, s[4:7], s56 offen
    s_add_u32 s56, s56, 8192
    buffer_load_dword v42, v4, s[4:7], s56 offen
    s_add_u32 s56, s56, 8192
    buffer_load_dword v43, v4, s[4:7], s56 offen
    s_add_u32 s56, s56, 8192
    buffer_load_dword v44, v4, s[4:7], s56 offen
    s_add_u32 s56, s56, 8192
    buffer_load_dword v45, v4, s[4:7], s56 offen
    s_add_u32 s56, s56, 8192
    buffer_load_dword v46, v4, s[4:7], s56 offen
    s_add_u32 s56, s56, 8192
    buffer_load_dword v47, v4, s[4:7], s56 offen
    s_waitcnt vmcnt(48)
    v_perm_b32 v80, v49, v48, s61
    v_perm_b32 v81, v51, v50, s61
    v_perm_b32 v82, v53, v52, s61
    v_perm_b32 v83, v55, v54, s61
    v_perm_b32 v84, v49, v48, s62
    v_perm_b32 v85, v51, v50, s62
    v_perm_b32 v86, v53, v52, s62
    v_perm_b32 v87, v55, v54, s62
    v_accvgpr_write_b32 a48, v80
    v_accvgpr_write_b32 a49, v81
    v_accvgpr_write_b32 a50, v82
    v_accvgpr_write_b32 a51, v83
    v_accvgpr_write_b32 a56, v84
    v_accvgpr_write_b32 a57, v85
    v_accvgpr_write_b32 a58, v86
    v_accvgpr_write_b32 a59, v87
    s_xor_b32 s56, s63, 3407872
    s_add_u32 s56, s56, s58
    buffer_load_dword v48, v4, s[4:7], s56 offen
    s_add_u32 s56, s56, 8192
    buffer_load_dword v49, v4, s[4:7], s56 offen
    s_add_u32 s56, s56, 8192
    buffer_load_dword v50, v4, s[4:7], s56 offen
    s_add_u32 s56, s56, 8192
    buffer_load_dword v51, v4, s[4:7], s56 offen
    s_add_u32 s56, s56, 8192
    buffer_load_dword v52, v4, s[4:7], s56 offen
    s_add_u32 s56, s56, 8192
    buffer_load_dword v53, v4, s[4:7], s56 offen
    s_add_u32 s56, s56, 8192
    buffer_load_dword v54, v4, s[4:7], s56 offen
    s_add_u32 s56, s56, 8192
    buffer_load_dword v55, v4, s[4:7], s56 offen
    s_waitcnt vmcnt(48)
    v_perm_b32 v80, v57, v56, s61
    v_perm_b32 v81, v59, v58, s61
    v_perm_b32 v82, v61, v60, s61
    v_perm_b32 v83, v63, v62, s61
    v_perm_b32 v84, v57, v56, s62
    v_perm_b32 v85, v59, v58, s62
    v_perm_b32 v86, v61, v60, s62
    v_perm_b32 v87, v63, v62, s62
    v_accvgpr_write_b32 a52, v80
    v_accvgpr_write_b32 a53, v81
    v_accvgpr_write_b32 a54, v82
    v_accvgpr_write_b32 a55, v83
    v_accvgpr_write_b32 a60, v84
    v_accvgpr_write_b32 a61, v85
    v_accvgpr_write_b32 a62, v86
    v_accvgpr_write_b32 a63, v87
    s_xor_b32 s56, s63, 3670016
    s_add_u32 s56, s56, s58
    buffer_load_dword v56, v4, s[4:7], s56 offen
    s_add_u32 s56, s56, 8192
    buffer_load_dword v57, v4, s[4:7], s56 offen
    s_add_u32 s56, s56, 8192
    buffer_load_dword v58, v4, s[4:7], s56 offen
    s_add_u32 s56, s56, 8192
    buffer_load_dword v59, v4, s[4:7], s56 offen
    s_add_u32 s56, s56, 8192
    buffer_load_dword v60, v4, s[4:7], s56 offen
    s_add_u32 s56, s56, 8192
    buffer_load_dword v61, v4, s[4:7], s56 offen
    s_add_u32 s56, s56, 8192
    buffer_load_dword v62, v4, s[4:7], s56 offen
    s_add_u32 s56, s56, 8192
    buffer_load_dword v63, v4, s[4:7], s56 offen
    s_waitcnt vmcnt(48)
    v_perm_b32 v80, v65, v64, s61
    v_perm_b32 v81, v67, v66, s61
    v_perm_b32 v82, v69, v68, s61
    v_perm_b32 v83, v71, v70, s61
    v_perm_b32 v84, v65, v64, s62
    v_perm_b32 v85, v67, v66, s62
    v_perm_b32 v86, v69, v68, s62
    v_perm_b32 v87, v71, v70, s62
    v_accvgpr_write_b32 a64, v80
    v_accvgpr_write_b32 a65, v81
    v_accvgpr_write_b32 a66, v82
    v_accvgpr_write_b32 a67, v83
    v_accvgpr_write_b32 a72, v84
    v_accvgpr_write_b32 a73, v85
    v_accvgpr_write_b32 a74, v86
    v_accvgpr_write_b32 a75, v87
    s_xor_b32 s56, s63, 3932160
    s_add_u32 s56, s56, s58
    buffer_load_dword v64, v4, s[4:7], s56 offen
    s_add_u32 s56, s56, 8192
    buffer_load_dword v65, v4, s[4:7], s56 offen
    s_add_u32 s56, s56, 8192
    buffer_load_dword v66, v4, s[4:7], s56 offen
    s_add_u32 s56, s56, 8192
    buffer_load_dword v67, v4, s[4:7], s56 offen
    s_add_u32 s56, s56, 8192
    buffer_load_dword v68, v4, s[4:7], s56 offen
    s_add_u32 s56, s56, 8192
    buffer_load_dword v69, v4, s[4:7], s56 offen
    s_add_u32 s56, s56, 8192
    buffer_load_dword v70, v4, s[4:7], s56 offen
    s_add_u32 s56, s56, 8192
    buffer_load_dword v71, v4, s[4:7], s56 offen
    s_waitcnt vmcnt(48)
    v_perm_b32 v80, v73, v72, s61
    v_perm_b32 v81, v75, v74, s61
    v_perm_b32 v82, v77, v76, s61
    v_perm_b32 v83, v79, v78, s61
    v_perm_b32 v84, v73, v72, s62
    v_perm_b32 v85, v75, v74, s62
    v_perm_b32 v86, v77, v76, s62
    v_perm_b32 v87, v79, v78, s62
    v_accvgpr_write_b32 a68, v80
    v_accvgpr_write_b32 a69, v81
    v_accvgpr_write_b32 a70, v82
    v_accvgpr_write_b32 a71, v83
    v_accvgpr_write_b32 a76, v84
    v_accvgpr_write_b32 a77, v85
    v_accvgpr_write_b32 a78, v86
    v_accvgpr_write_b32 a79, v87
    s_waitcnt vmcnt(40)
    v_perm_b32 v80, v25, v24, s61
    v_perm_b32 v81, v27, v26, s61
    v_perm_b32 v82, v29, v28, s61
    v_perm_b32 v83, v31, v30, s61
    v_perm_b32 v84, v25, v24, s62
    v_perm_b32 v85, v27, v26, s62
    v_perm_b32 v86, v29, v28, s62
    v_perm_b32 v87, v31, v30, s62
    v_accvgpr_write_b32 a80, v80
    v_accvgpr_write_b32 a81, v81
    v_accvgpr_write_b32 a82, v82
    v_accvgpr_write_b32 a83, v83
    v_accvgpr_write_b32 a88, v84
    v_accvgpr_write_b32 a89, v85
    v_accvgpr_write_b32 a90, v86
    v_accvgpr_write_b32 a91, v87
    s_waitcnt vmcnt(32)
    v_perm_b32 v80, v33, v32, s61
    v_perm_b32 v81, v35, v34, s61
    v_perm_b32 v82, v37, v36, s61
    v_perm_b32 v83, v39, v38, s61
    v_perm_b32 v84, v33, v32, s62
    v_perm_b32 v85, v35, v34, s62
    v_perm_b32 v86, v37, v36, s62
    v_perm_b32 v87, v39, v38, s62
    v_accvgpr_write_b32 a84, v80
    v_accvgpr_write_b32 a85, v81
    v_accvgpr_write_b32 a86, v82
    v_accvgpr_write_b32 a87, v83
    v_accvgpr_write_b32 a92, v84
    v_accvgpr_write_b32 a93, v85
    v_accvgpr_write_b32 a94, v86
    v_accvgpr_write_b32 a95, v87
    s_waitcnt vmcnt(24)
    v_perm_b32 v80, v41, v40, s61
    v_perm_b32 v81, v43, v42, s61
    v_perm_b32 v82, v45, v44, s61
    v_perm_b32 v83, v47, v46, s61
    v_perm_b32 v84, v41, v40, s62
    v_perm_b32 v85, v43, v42, s62
    v_perm_b32 v86, v45, v44, s62
    v_perm_b32 v87, v47, v46, s62
    v_accvgpr_write_b32 a96, v80
    v_accvgpr_write_b32 a97, v81
    v_accvgpr_write_b32 a98, v82
    v_accvgpr_write_b32 a99, v83
    v_accvgpr_write_b32 a104, v84
    v_accvgpr_write_b32 a105, v85
    v_accvgpr_write_b32 a106, v86
    v_accvgpr_write_b32 a107, v87
    s_waitcnt vmcnt(16)
    v_perm_b32 v80, v49, v48, s61
    v_perm_b32 v81, v51, v50, s61
    v_perm_b32 v82, v53, v52, s61
    v_perm_b32 v83, v55, v54, s61
    v_perm_b32 v84, v49, v48, s62
    v_perm_b32 v85, v51, v50, s62
    v_perm_b32 v86, v53, v52, s62
    v_perm_b32 v87, v55, v54, s62
    v_accvgpr_write_b32 a100, v80
    v_accvgpr_write_b32 a101, v81
    v_accvgpr_write_b32 a102, v82
    v_accvgpr_write_b32 a103, v83
    v_accvgpr_write_b32 a108, v84
    v_accvgpr_write_b32 a109, v85
    v_accvgpr_write_b32 a110, v86
    v_accvgpr_write_b32 a111, v87
    s_waitcnt vmcnt(8)
    v_perm_b32 v80, v57, v56, s61
    v_perm_b32 v81, v59, v58, s61
    v_perm_b32 v82, v61, v60, s61
    v_perm_b32 v83, v63, v62, s61
    v_perm_b32 v84, v57, v56, s62
    v_perm_b32 v85, v59, v58, s62
    v_perm_b32 v86, v61, v60, s62
    v_perm_b32 v87, v63, v62, s62
    v_accvgpr_write_b32 a112, v80
    v_accvgpr_write_b32 a113, v81
    v_accvgpr_write_b32 a114, v82
    v_accvgpr_write_b32 a115, v83
    v_accvgpr_write_b32 a120, v84
    v_accvgpr_write_b32 a121, v85
    v_accvgpr_write_b32 a122, v86
    v_accvgpr_write_b32 a123, v87
    s_waitcnt vmcnt(0)
    v_perm_b32 v80, v65, v64, s61
    v_perm_b32 v81, v67, v66, s61
    v_perm_b32 v82, v69, v68, s61
    v_perm_b32 v83, v71, v70, s61
    v_perm_b32 v84, v65, v64, s62
    v_perm_b32 v85, v67, v66, s62
    v_perm_b32 v86, v69, v68, s62
    v_perm_b32 v87, v71, v70, s62
    v_accvgpr_write_b32 a116, v80
    v_accvgpr_write_b32 a117, v81
    v_accvgpr_write_b32 a118, v82
    v_accvgpr_write_b32 a119, v83
    v_accvgpr_write_b32 a124, v84
    v_accvgpr_write_b32 a125, v85
    v_accvgpr_write_b32 a126, v86
    v_accvgpr_write_b32 a127, v87
    s_mov_b32 s53, 0
    s_cmp_lt_u32 s48, 3
    s_cbranch_scc1 L_rch_4
    s_cmp_eq_u32 s48, 3
    s_cbranch_scc1 L_rm_5
L_rw_9:
    v_and_b32 v2, 15, v1
    v_lshlrev_b32 v2, 2, v2
    v_lshrrev_b32 v3, 4, v1
    v_lshl_add_u32 v4, v3, 16, v2
    v_lshl_add_u32 v5, v3, 13, v2
    s_lshl_b32 s58, s47, 8
    s_lshl_b32 s57, s46, 6
    s_add_u32 s58, s58, s57
    s_lshl_b32 s59, s47, 17
    s_add_u32 s59, s59, s57
    s_lshl_b32 s60, s46, 15
    v_add_u32 v6, s60, v0
    s_mov_b32 s61, 0x05040100
    s_mov_b32 s62, 0x07060302
    s_lshl_b32 s63, s46, 19
    s_mov_b32 s4, s26
    s_mov_b32 s5, s27
    s_mov_b32 s6, 4194304
    s_mov_b32 s7, 0x20000
    s_add_u32 s56, s59, 0
    buffer_load_dword v24, v5, s[4:7], s56 offen offset:0
    buffer_load_dword v25, v5, s[4:7], s56 offen offset:1024
    buffer_load_dword v26, v5, s[4:7], s56 offen offset:2048
    buffer_load_dword v27, v5, s[4:7], s56 offen offset:3072
    s_add_u32 s56, s59, 4096
    buffer_load_dword v28, v5, s[4:7], s56 offen offset:0
    buffer_load_dword v29, v5, s[4:7], s56 offen offset:1024
    buffer_load_dword v30, v5, s[4:7], s56 offen offset:2048
    buffer_load_dword v31, v5, s[4:7], s56 offen offset:3072
    s_add_u32 s56, s59, 32768
    buffer_load_dword v32, v5, s[4:7], s56 offen offset:0
    buffer_load_dword v33, v5, s[4:7], s56 offen offset:1024
    buffer_load_dword v34, v5, s[4:7], s56 offen offset:2048
    buffer_load_dword v35, v5, s[4:7], s56 offen offset:3072
    s_add_u32 s56, s59, 36864
    buffer_load_dword v36, v5, s[4:7], s56 offen offset:0
    buffer_load_dword v37, v5, s[4:7], s56 offen offset:1024
    buffer_load_dword v38, v5, s[4:7], s56 offen offset:2048
    buffer_load_dword v39, v5, s[4:7], s56 offen offset:3072
    s_add_u32 s56, s59, 65536
    buffer_load_dword v40, v5, s[4:7], s56 offen offset:0
    buffer_load_dword v41, v5, s[4:7], s56 offen offset:1024
    buffer_load_dword v42, v5, s[4:7], s56 offen offset:2048
    buffer_load_dword v43, v5, s[4:7], s56 offen offset:3072
    s_add_u32 s56, s59, 69632
    buffer_load_dword v44, v5, s[4:7], s56 offen offset:0
    buffer_load_dword v45, v5, s[4:7], s56 offen offset:1024
    buffer_load_dword v46, v5, s[4:7], s56 offen offset:2048
    buffer_load_dword v47, v5, s[4:7], s56 offen offset:3072
    s_add_u32 s56, s59, 98304
    buffer_load_dword v48, v5, s[4:7], s56 offen offset:0
    buffer_load_dword v49, v5, s[4:7], s56 offen offset:1024
    buffer_load_dword v50, v5, s[4:7], s56 offen offset:2048
    buffer_load_dword v51, v5, s[4:7], s56 offen offset:3072
    s_add_u32 s56, s59, 102400
    buffer_load_dword v52, v5, s[4:7], s56 offen offset:0
    buffer_load_dword v53, v5, s[4:7], s56 offen offset:1024
    buffer_load_dword v54, v5, s[4:7], s56 offen offset:2048
    buffer_load_dword v55, v5, s[4:7], s56 offen offset:3072
    s_add_u32 s56, s59, 256
    buffer_load_dword v56, v5, s[4:7], s56 offen offset:0
    buffer_load_dword v57, v5, s[4:7], s56 offen offset:1024
    buffer_load_dword v58, v5, s[4:7], s56 offen offset:2048
    buffer_load_dword v59, v5, s[4:7], s56 offen offset:3072
    s_add_u32 s56, s59, 4352
    buffer_load_dword v60, v5, s[4:7], s56 offen offset:0
    buffer_load_dword v61, v5, s[4:7], s56 offen offset:1024
    buffer_load_dword v62, v5, s[4:7], s56 offen offset:2048
    buffer_load_dword v63, v5, s[4:7], s56 offen offset:3072
    s_add_u32 s56, s59, 33024
    buffer_load_dword v64, v5, s[4:7], s56 offen offset:0
    buffer_load_dword v65, v5, s[4:7], s56 offen offset:1024
    buffer_load_dword v66, v5, s[4:7], s56 offen offset:2048
    buffer_load_dword v67, v5, s[4:7], s56 offen offset:3072
    s_add_u32 s56, s59, 37120
    buffer_load_dword v68, v5, s[4:7], s56 offen offset:0
    buffer_load_dword v69, v5, s[4:7], s56 offen offset:1024
    buffer_load_dword v70, v5, s[4:7], s56 offen offset:2048
    buffer_load_dword v71, v5, s[4:7], s56 offen offset:3072
    s_add_u32 s56, s59, 65792
    buffer_load_dword v72, v5, s[4:7], s56 offen offset:0
    buffer_load_dword v73, v5, s[4:7], s56 offen offset:1024
    buffer_load_dword v74, v5, s[4:7], s56 offen offset:2048
    buffer_load_dword v75, v5, s[4:7], s56 offen offset:3072
    s_add_u32 s56, s59, 69888
    buffer_load_dword v76, v5, s[4:7], s56 offen offset:0
    buffer_load_dword v77, v5, s[4:7], s56 offen offset:1024
    buffer_load_dword v78, v5, s[4:7], s56 offen offset:2048
    buffer_load_dword v79, v5, s[4:7], s56 offen offset:3072
    s_waitcnt vmcnt(48)
    v_perm_b32 v80, v25, v24, s61
    v_perm_b32 v81, v27, v26, s61
    v_perm_b32 v82, v29, v28, s61
    v_perm_b32 v83, v31, v30, s61
    v_perm_b32 v84, v25, v24, s62
    v_perm_b32 v85, v27, v26, s62
    v_perm_b32 v86, v29, v28, s62
    v_perm_b32 v87, v31, v30, s62
    ds_write_b128 v6, v[80:83] offset:0
    ds_write_b128 v6, v[84:87] offset:4096
    s_waitcnt lgkmcnt(0)
    s_add_u32 s56, s59, 98560
    buffer_load_dword v24, v5, s[4:7], s56 offen offset:0
    buffer_load_dword v25, v5, s[4:7], s56 offen offset:1024
    buffer_load_dword v26, v5, s[4:7], s56 offen offset:2048
    buffer_load_dword v27, v5, s[4:7], s56 offen offset:3072
    s_add_u32 s56, s59, 102656
    buffer_load_dword v28, v5, s[4:7], s56 offen offset:0
    buffer_load_dword v29, v5, s[4:7], s56 offen offset:1024
    buffer_load_dword v30, v5, s[4:7], s56 offen offset:2048
    buffer_load_dword v31, v5, s[4:7], s56 offen offset:3072
    s_waitcnt vmcnt(48)
    v_perm_b32 v80, v33, v32, s61
    v_perm_b32 v81, v35, v34, s61
    v_perm_b32 v82, v37, v36, s61
    v_perm_b32 v83, v39, v38, s61
    v_perm_b32 v84, v33, v32, s62
    v_perm_b32 v85, v35, v34, s62
    v_perm_b32 v86, v37, v36, s62
    v_perm_b32 v87, v39, v38, s62
    ds_write_b128 v6, v[80:83] offset:1024
    ds_write_b128 v6, v[84:87] offset:5120
    s_waitcnt lgkmcnt(0)
    s_add_u32 s56, s59, 512
    buffer_load_dword v32, v5, s[4:7], s56 offen offset:0
    buffer_load_dword v33, v5, s[4:7], s56 offen offset:1024
    buffer_load_dword v34, v5, s[4:7], s56 offen offset:2048
    buffer_load_dword v35, v5, s[4:7], s56 offen offset:3072
    s_add_u32 s56, s59, 4608
    buffer_load_dword v36, v5, s[4:7], s56 offen offset:0
    buffer_load_dword v37, v5, s[4:7], s56 offen offset:1024
    buffer_load_dword v38, v5, s[4:7], s56 offen offset:2048
    buffer_load_dword v39, v5, s[4:7], s56 offen offset:3072
    s_waitcnt vmcnt(48)
    v_perm_b32 v80, v41, v40, s61
    v_perm_b32 v81, v43, v42, s61
    v_perm_b32 v82, v45, v44, s61
    v_perm_b32 v83, v47, v46, s61
    v_perm_b32 v84, v41, v40, s62
    v_perm_b32 v85, v43, v42, s62
    v_perm_b32 v86, v45, v44, s62
    v_perm_b32 v87, v47, v46, s62
    ds_write_b128 v6, v[80:83] offset:2048
    ds_write_b128 v6, v[84:87] offset:6144
    s_waitcnt lgkmcnt(0)
    s_add_u32 s56, s59, 33280
    buffer_load_dword v40, v5, s[4:7], s56 offen offset:0
    buffer_load_dword v41, v5, s[4:7], s56 offen offset:1024
    buffer_load_dword v42, v5, s[4:7], s56 offen offset:2048
    buffer_load_dword v43, v5, s[4:7], s56 offen offset:3072
    s_add_u32 s56, s59, 37376
    buffer_load_dword v44, v5, s[4:7], s56 offen offset:0
    buffer_load_dword v45, v5, s[4:7], s56 offen offset:1024
    buffer_load_dword v46, v5, s[4:7], s56 offen offset:2048
    buffer_load_dword v47, v5, s[4:7], s56 offen offset:3072
    s_waitcnt vmcnt(48)
    v_perm_b32 v80, v49, v48, s61
    v_perm_b32 v81, v51, v50, s61
    v_perm_b32 v82, v53, v52, s61
    v_perm_b32 v83, v55, v54, s61
    v_perm_b32 v84, v49, v48, s62
    v_perm_b32 v85, v51, v50, s62
    v_perm_b32 v86, v53, v52, s62
    v_perm_b32 v87, v55, v54, s62
    ds_write_b128 v6, v[80:83] offset:3072
    ds_write_b128 v6, v[84:87] offset:7168
    s_waitcnt lgkmcnt(0)
    s_add_u32 s56, s59, 66048
    buffer_load_dword v48, v5, s[4:7], s56 offen offset:0
    buffer_load_dword v49, v5, s[4:7], s56 offen offset:1024
    buffer_load_dword v50, v5, s[4:7], s56 offen offset:2048
    buffer_load_dword v51, v5, s[4:7], s56 offen offset:3072
    s_add_u32 s56, s59, 70144
    buffer_load_dword v52, v5, s[4:7], s56 offen offset:0
    buffer_load_dword v53, v5, s[4:7], s56 offen offset:1024
    buffer_load_dword v54, v5, s[4:7], s56 offen offset:2048
    buffer_load_dword v55, v5, s[4:7], s56 offen offset:3072
    s_waitcnt vmcnt(48)
    v_perm_b32 v80, v57, v56, s61
    v_perm_b32 v81, v59, v58, s61
    v_perm_b32 v82, v61, v60, s61
    v_perm_b32 v83, v63, v62, s61
    v_perm_b32 v84, v57, v56, s62
    v_perm_b32 v85, v59, v58, s62
    v_perm_b32 v86, v61, v60, s62
    v_perm_b32 v87, v63, v62, s62
    ds_write_b128 v6, v[80:83] offset:8192
    ds_write_b128 v6, v[84:87] offset:12288
    s_waitcnt lgkmcnt(0)
    s_add_u32 s56, s59, 98816
    buffer_load_dword v56, v5, s[4:7], s56 offen offset:0
    buffer_load_dword v57, v5, s[4:7], s56 offen offset:1024
    buffer_load_dword v58, v5, s[4:7], s56 offen offset:2048
    buffer_load_dword v59, v5, s[4:7], s56 offen offset:3072
    s_add_u32 s56, s59, 102912
    buffer_load_dword v60, v5, s[4:7], s56 offen offset:0
    buffer_load_dword v61, v5, s[4:7], s56 offen offset:1024
    buffer_load_dword v62, v5, s[4:7], s56 offen offset:2048
    buffer_load_dword v63, v5, s[4:7], s56 offen offset:3072
    s_waitcnt vmcnt(48)
    v_perm_b32 v80, v65, v64, s61
    v_perm_b32 v81, v67, v66, s61
    v_perm_b32 v82, v69, v68, s61
    v_perm_b32 v83, v71, v70, s61
    v_perm_b32 v84, v65, v64, s62
    v_perm_b32 v85, v67, v66, s62
    v_perm_b32 v86, v69, v68, s62
    v_perm_b32 v87, v71, v70, s62
    ds_write_b128 v6, v[80:83] offset:9216
    ds_write_b128 v6, v[84:87] offset:13312
    s_waitcnt lgkmcnt(0)
    s_add_u32 s56, s59, 768
    buffer_load_dword v64, v5, s[4:7], s56 offen offset:0
    buffer_load_dword v65, v5, s[4:7], s56 offen offset:1024
    buffer_load_dword v66, v5, s[4:7], s56 offen offset:2048
    buffer_load_dword v67, v5, s[4:7], s56 offen offset:3072
    s_add_u32 s56, s59, 4864
    buffer_load_dword v68, v5, s[4:7], s56 offen offset:0
    buffer_load_dword v69, v5, s[4:7], s56 offen offset:1024
    buffer_load_dword v70, v5, s[4:7], s56 offen offset:2048
    buffer_load_dword v71, v5, s[4:7], s56 offen offset:3072
    s_waitcnt vmcnt(48)
    v_perm_b32 v80, v73, v72, s61
    v_perm_b32 v81, v75, v74, s61
    v_perm_b32 v82, v77, v76, s61
    v_perm_b32 v83, v79, v78, s61
    v_perm_b32 v84, v73, v72, s62
    v_perm_b32 v85, v75, v74, s62
    v_perm_b32 v86, v77, v76, s62
    v_perm_b32 v87, v79, v78, s62
    ds_write_b128 v6, v[80:83] offset:10240
    ds_write_b128 v6, v[84:87] offset:14336
    s_waitcnt lgkmcnt(0)
    s_add_u32 s56, s59, 33536
    buffer_load_dword v72, v5, s[4:7], s56 offen offset:0
    buffer_load_dword v73, v5, s[4:7], s56 offen offset:1024
    buffer_load_dword v74, v5, s[4:7], s56 offen offset:2048
    buffer_load_dword v75, v5, s[4:7], s56 offen offset:3072
    s_add_u32 s56, s59, 37632
    buffer_load_dword v76, v5, s[4:7], s56 offen offset:0
    buffer_load_dword v77, v5, s[4:7], s56 offen offset:1024
    buffer_load_dword v78, v5, s[4:7], s56 offen offset:2048
    buffer_load_dword v79, v5, s[4:7], s56 offen offset:3072
    s_waitcnt vmcnt(48)
    v_perm_b32 v80, v25, v24, s61
    v_perm_b32 v81, v27, v26, s61
    v_perm_b32 v82, v29, v28, s61
    v_perm_b32 v83, v31, v30, s61
    v_perm_b32 v84, v25, v24, s62
    v_perm_b32 v85, v27, v26, s62
    v_perm_b32 v86, v29, v28, s62
    v_perm_b32 v87, v31, v30, s62
    ds_write_b128 v6, v[80:83] offset:11264
    ds_write_b128 v6, v[84:87] offset:15360
    s_waitcnt lgkmcnt(0)
    s_add_u32 s56, s59, 66304
    buffer_load_dword v24, v5, s[4:7], s56 offen offset:0
    buffer_load_dword v25, v5, s[4:7], s56 offen offset:1024
    buffer_load_dword v26, v5, s[4:7], s56 offen offset:2048
    buffer_load_dword v27, v5, s[4:7], s56 offen offset:3072
    s_add_u32 s56, s59, 70400
    buffer_load_dword v28, v5, s[4:7], s56 offen offset:0
    buffer_load_dword v29, v5, s[4:7], s56 offen offset:1024
    buffer_load_dword v30, v5, s[4:7], s56 offen offset:2048
    buffer_load_dword v31, v5, s[4:7], s56 offen offset:3072
    s_waitcnt vmcnt(48)
    v_perm_b32 v80, v33, v32, s61
    v_perm_b32 v81, v35, v34, s61
    v_perm_b32 v82, v37, v36, s61
    v_perm_b32 v83, v39, v38, s61
    v_perm_b32 v84, v33, v32, s62
    v_perm_b32 v85, v35, v34, s62
    v_perm_b32 v86, v37, v36, s62
    v_perm_b32 v87, v39, v38, s62
    ds_write_b128 v6, v[80:83] offset:16384
    ds_write_b128 v6, v[84:87] offset:20480
    s_waitcnt lgkmcnt(0)
    s_add_u32 s56, s59, 99072
    buffer_load_dword v32, v5, s[4:7], s56 offen offset:0
    buffer_load_dword v33, v5, s[4:7], s56 offen offset:1024
    buffer_load_dword v34, v5, s[4:7], s56 offen offset:2048
    buffer_load_dword v35, v5, s[4:7], s56 offen offset:3072
    s_add_u32 s56, s59, 103168
    buffer_load_dword v36, v5, s[4:7], s56 offen offset:0
    buffer_load_dword v37, v5, s[4:7], s56 offen offset:1024
    buffer_load_dword v38, v5, s[4:7], s56 offen offset:2048
    buffer_load_dword v39, v5, s[4:7], s56 offen offset:3072
    s_waitcnt vmcnt(48)
    v_perm_b32 v80, v41, v40, s61
    v_perm_b32 v81, v43, v42, s61
    v_perm_b32 v82, v45, v44, s61
    v_perm_b32 v83, v47, v46, s61
    v_perm_b32 v84, v41, v40, s62
    v_perm_b32 v85, v43, v42, s62
    v_perm_b32 v86, v45, v44, s62
    v_perm_b32 v87, v47, v46, s62
    ds_write_b128 v6, v[80:83] offset:17408
    ds_write_b128 v6, v[84:87] offset:21504
    s_waitcnt lgkmcnt(0)
    s_waitcnt vmcnt(40)
    v_perm_b32 v80, v49, v48, s61
    v_perm_b32 v81, v51, v50, s61
    v_perm_b32 v82, v53, v52, s61
    v_perm_b32 v83, v55, v54, s61
    v_perm_b32 v84, v49, v48, s62
    v_perm_b32 v85, v51, v50, s62
    v_perm_b32 v86, v53, v52, s62
    v_perm_b32 v87, v55, v54, s62
    ds_write_b128 v6, v[80:83] offset:18432
    ds_write_b128 v6, v[84:87] offset:22528
    s_waitcnt lgkmcnt(0)
    s_waitcnt vmcnt(32)
    v_perm_b32 v80, v57, v56, s61
    v_perm_b32 v81, v59, v58, s61
    v_perm_b32 v82, v61, v60, s61
    v_perm_b32 v83, v63, v62, s61
    v_perm_b32 v84, v57, v56, s62
    v_perm_b32 v85, v59, v58, s62
    v_perm_b32 v86, v61, v60, s62
    v_perm_b32 v87, v63, v62, s62
    ds_write_b128 v6, v[80:83] offset:19456
    ds_write_b128 v6, v[84:87] offset:23552
    s_waitcnt lgkmcnt(0)
    s_waitcnt vmcnt(24)
    v_perm_b32 v80, v65, v64, s61
    v_perm_b32 v81, v67, v66, s61
    v_perm_b32 v82, v69, v68, s61
    v_perm_b32 v83, v71, v70, s61
    v_perm_b32 v84, v65, v64, s62
    v_perm_b32 v85, v67, v66, s62
    v_perm_b32 v86, v69, v68, s62
    v_perm_b32 v87, v71, v70, s62
    ds_write_b128 v6, v[80:83] offset:24576
    ds_write_b128 v6, v[84:87] offset:28672
    s_waitcnt lgkmcnt(0)
    s_waitcnt vmcnt(16)
    v_perm_b32 v80, v73, v72, s61
    v_perm_b32 v81, v75, v74, s61
    v_perm_b32 v82, v77, v76, s61
    v_perm_b32 v83, v79, v78, s61
    v_perm_b32 v84, v73, v72, s62
    v_perm_b32 v85, v75, v74, s62
    v_perm_b32 v86, v77, v76, s62
    v_perm_b32 v87, v79, v78, s62
    ds_write_b128 v6, v[80:83] offset:25600
    ds_write_b128 v6, v[84:87] offset:29696
    s_waitcnt lgkmcnt(0)
    s_waitcnt vmcnt(8)
    v_perm_b32 v80, v25, v24, s61
    v_perm_b32 v81, v27, v26, s61
    v_perm_b32 v82, v29, v28, s61
    v_perm_b32 v83, v31, v30, s61
    v_perm_b32 v84, v25, v24, s62
    v_perm_b32 v85, v27, v26, s62
    v_perm_b32 v86, v29, v28, s62
    v_perm_b32 v87, v31, v30, s62
    ds_write_b128 v6, v[80:83] offset:26624
    ds_write_b128 v6, v[84:87] offset:30720
    s_waitcnt lgkmcnt(0)
    s_waitcnt vmcnt(0)
    v_perm_b32 v80, v33, v32, s61
    v_perm_b32 v81, v35, v34, s61
    v_perm_b32 v82, v37, v36, s61
    v_perm_b32 v83, v39, v38, s61
    v_perm_b32 v84, v33, v32, s62
    v_perm_b32 v85, v35, v34, s62
    v_perm_b32 v86, v37, v36, s62
    v_perm_b32 v87, v39, v38, s62
    ds_write_b128 v6, v[80:83] offset:27648
    ds_write_b128 v6, v[84:87] offset:31744
    s_waitcnt lgkmcnt(0)
    s_cmp_lg_u32 s46, 0
    s_cbranch_scc1 L_gbd_12
    v_mov_b32 v124, 128
L_gb_11:
    buffer_load_dword v125, v124, s[12:15], 0 offen sc1
    s_waitcnt vmcnt(0)
    v_readfirstlane_b32 s56, v125
    s_cmp_ge_u32 s56, 256
    s_cbranch_scc1 L_gbd_12
    s_sleep 4
    s_sub_u32 s49, s49, 1
    s_cmp_gt_i32 s49, 0
    s_cbranch_scc1 L_gb_11
    s_branch L_abort
L_gbd_12:
    s_waitcnt lgkmcnt(0)
    s_barrier
    v_and_b32 v120, 15, v1
    v_lshrrev_b32 v121, 4, v1
    v_lshlrev_b32 v122, 2, v121
    v_mov_b32 v123, 0xf149f2ca
    s_and_b32 s56, s46, 1
    s_lshl_b32 s56, s56, 4
    v_add_u32 v124, s56, v120
    v_add_u32 v125, 0, v122
    v_cmp_gt_u32 vcc, v125, v124
    s_nop 1
    v_cndmask_b32 v8, 0, v123, vcc
    v_add_u32 v125, 1, v122
    v_cmp_gt_u32 vcc, v125, v124
    s_nop 1
    v_cndmask_b32 v9, 0, v123, vcc
    v_add_u32 v125, 2, v122
    v_cmp_gt_u32 vcc, v125, v124
    s_nop 1
    v_cndmask_b32 v10, 0, v123, vcc
    v_add_u32 v125, 3, v122
    v_cmp_gt_u32 vcc, v125, v124
    s_nop 1
    v_cndmask_b32 v11, 0, v123, vcc
    v_add_u32 v125, 16, v122
    v_cmp_gt_u32 vcc, v125, v124
    s_nop 1
    v_cndmask_b32 v12, 0, v123, vcc
    v_add_u32 v125, 17, v122
    v_cmp_gt_u32 vcc, v125, v124
    s_nop 1
    v_cndmask_b32 v13, 0, v123, vcc
    v_add_u32 v125, 18, v122
    v_cmp_gt_u32 vcc, v125, v124
    s_nop 1
    v_cndmask_b32 v14, 0, v123, vcc
    v_add_u32 v125, 19, v122
    v_cmp_gt_u32 vcc, v125, v124
    s_nop 1
    v_cndmask_b32 v15, 0, v123, vcc
    s_and_b32 s56, s46, 1
    s_lshl_b32 s56, s56, 12
    s_lshr_b32 s57, s46, 1
    s_lshl_b32 s57, s57, 11
    s_add_u32 s56, s56, s57
    s_add_u32 s56, s56, 131072
    v_add_u32 v16, s56, v0
    v_add_u32 v17, 131072, v0
    s_lshl_b32 s56, s46, 15
    v_add_u32 v18, s56, v0
    v_lshlrev_b32 v19, 15, v120
    v_lshl_add_u32 v19, v121, 4, v19
    s_lshl_b32 s56, s46, 6
    v_add_u32 v19, s56, v19
    v_lshrrev_b32 v20, 2, v1
    v_lshlrev_b32 v20, 11, v20
    v_and_b32 v125, 3, v1
    v_lshl_add_u32 v20, v125, 8, v20
    v_lshlrev_b32 v21, 5, v120
    v_and_b32 v125, 1, v121
    v_lshl_add_u32 v21, v125, 4, v21
    v_lshrrev_b32 v125, 1, v121
    v_lshl_add_u32 v21, v125, 11, v21
    s_lshl_b32 s56, s46, 9
    s_add_u32 s56, s56, 139264
    v_add_u32 v21, s56, v21
    v_lshlrev_b32 v22, 4, v120
    v_lshl_add_u32 v22, v121, 10, v22
    s_lshl_b32 s56, s46, 8
    v_add_u32 v22, s56, v22
    s_lshl_b32 s54, s48, 21
    s_add_u32 s54, s54, 20971520
    s_mov_b32 s51, 0
    s_cmp_eq_u32 s48, 0
    s_cbranch_scc1 L_rb_6
    s_sub_u32 s55, s48, 12
L_tk_13:
    s_cmp_lt_i32 s55, 0
    s_cbranch_scc1 L_tks_14
    s_mov_b32 s51, s55
    s_lshl_b32 s59, s51, 13
    s_lshl2_add_u32 s59, s47, s59
    s_add_u32 s59, s59, 10486144
    v_mov_b32 v124, 0
L_ww_16:
    buffer_load_dword v125, v124, s[8:11], s59 offen sc1
    s_waitcnt vmcnt(0)
    v_readfirstlane_b32 s61, v125
    s_cmp_lg_u32 s61, 0
    s_cbranch_scc1 L_wwd_17
    s_sleep 1
    s_sub_u32 s49, s49, 1
    s_cmp_gt_i32 s49, 0
    s_cbranch_scc1 L_ww_16
    s_branch L_abort
L_wwd_17:
    s_lshl_b32 s56, s51, 5
    s_add_u32 s56, s56, s47
    s_mul_i32 s56, s56, 24576
    s_add_u32 s56, s56, 100663296
    s_and_b32 s57, s46, 1
    s_lshl_b32 s57, s57, 12
    s_add_u32 s58, s56, s57
    s_add_u32 s58, s58, 16384
    s_add_u32 s59, s56, 4096
    s_lshr_b32 s57, s46, 1
    s_lshl_b32 s60, s57, 12
    s_add_u32 s60, s60, s56
    s_add_u32 s60, s60, 8192
    s_lshl_b32 s61, s51, 5
    s_add_u32 s61, s61, s47
    s_lshl_b32 s61, s61, 13
    s_add_u32 s61, s61, 41943040
    s_lshl_b32 s62, s57, 11
    s_add_u32 s62, s62, s61
    s_add_u32 s62, s62, 4096
    buffer_load_dwordx4 v[24:27], v0, s[8:11], s58 offen offset:0 sc1
    buffer_load_dwordx4 v[40:43], v0, s[8:11], s56 offen offset:0 sc1
    buffer_load_dwordx4 v[56:59], v0, s[8:11], s59 offen offset:0 sc1
    buffer_load_dwordx4 v[72:75], v0, s[8:11], s61 offen offset:0 sc1
    buffer_load_dwordx4 v[28:31], v0, s[8:11], s58 offen offset:1024 sc1
    buffer_load_dwordx4 v[44:47], v0, s[8:11], s56 offen offset:1024 sc1
    buffer_load_dwordx4 v[60:63], v0, s[8:11], s59 offen offset:1024 sc1
    buffer_load_dwordx4 v[76:79], v0, s[8:11], s61 offen offset:1024 sc1
    buffer_load_dwordx4 v[32:35], v0, s[8:11], s58 offen offset:2048 sc1
    buffer_load_dwordx4 v[48:51], v0, s[8:11], s56 offen offset:2048 sc1
    buffer_load_dwordx4 v[64:67], v0, s[8:11], s59 offen offset:2048 sc1
    buffer_load_dwordx4 v[80:83], v0, s[8:11], s61 offen offset:2048 sc1
    buffer_load_dwordx4 v[36:39], v0, s[8:11], s58 offen offset:3072 sc1
    buffer_load_dwordx4 v[52:55], v0, s[8:11], s56 offen offset:3072 sc1
    buffer_load_dwordx4 v[68:71], v0, s[8:11], s59 offen offset:3072 sc1
    buffer_load_dwordx4 v[84:87], v0, s[8:11], s61 offen offset:3072 sc1
    buffer_load_dwordx4 v[88:91], v0, s[8:11], s60 offen offset:0 sc1
    buffer_load_dwordx4 v[92:95], v0, s[8:11], s60 offen offset:1024 sc1
    buffer_load_dwordx4 v[96:99], v0, s[8:11], s60 offen offset:2048 sc1
    buffer_load_dwordx4 v[100:103], v0, s[8:11], s60 offen offset:3072 sc1
    buffer_load_dword v104, v0, s[8:11], s62 offen offset:0 sc1
    v_mov_b32 v105, 0
    buffer_load_dword v106, v0, s[8:11], s62 offen offset:4 sc1
    v_mov_b32 v107, 0
    buffer_load_dword v108, v0, s[8:11], s62 offen offset:1024 sc1
    v_mov_b32 v109, 0
    buffer_load_dword v110, v0, s[8:11], s62 offen offset:1028 sc1
    v_mov_b32 v111, 0
    s_waitcnt vmcnt(20)
    v_mfma_f32_16x16x32_bf16 v[112:115], v[40:43], v[24:27], v[8:11]
    v_mfma_f32_16x16x32_bf16 v[116:119], v[56:59], v[24:27], v[12:15]
    v_mfma_f32_16x16x32_bf16 v[120:123], v[72:75], v[24:27], 0
    s_waitcnt vmcnt(16)
    v_mfma_f32_16x16x32_bf16 v[112:115], v[44:47], v[28:31], v[112:115]
    v_mfma_f32_16x16x32_bf16 v[116:119], v[60:63], v[28:31], v[116:119]
    v_mfma_f32_16x16x32_bf16 v[120:123], v[76:79], v[28:31], v[120:123]
    s_waitcnt vmcnt(12)
    v_mfma_f32_16x16x32_bf16 v[112:115], v[48:51], v[32:35], v[112:115]
    v_mfma_f32_16x16x32_bf16 v[116:119], v[64:67], v[32:35], v[116:119]
    v_mfma_f32_16x16x32_bf16 v[120:123], v[80:83], v[32:35], v[120:123]
    s_waitcnt vmcnt(8)
    v_mfma_f32_16x16x32_bf16 v[112:115], v[52:55], v[36:39], v[112:115]
    v_mfma_f32_16x16x32_bf16 v[116:119], v[68:71], v[36:39], v[116:119]
    v_mfma_f32_16x16x32_bf16 v[120:123], v[84:87], v[36:39], v[120:123]
    ds_read_b128 v[56:59], v18 offset:0
    ds_read_b128 v[60:63], v18 offset:4096
    ds_read_b128 v[64:67], v18 offset:1024
    ds_read_b128 v[68:71], v18 offset:5120
    ds_read_b128 v[72:75], v18 offset:2048
    ds_read_b128 v[76:79], v18 offset:6144
    ds_read_b128 v[80:83], v18 offset:3072
    ds_read_b128 v[84:87], v18 offset:7168
    v_max3_f32 v124, v112, v113, v114
    v_max3_f32 v125, v115, v116, v117
    v_max3_f32 v124, v118, v119, v124
    v_max3_f32 v125, v122, v123, v125
    v_max_f32 v124, v124, v125
    v_max_f32 v125, v124, v125
    s_nop 1
    v_permlane16_swap_b32 v124, v125
    v_max_f32 v124, v124, v125
    v_max_f32 v125, v124, v125
    s_nop 1
    v_permlane32_swap_b32 v124, v125
    v_max_f32 v124, v124, v125
    v_mul_f32 v124, s80, v124
    v_fma_f32 v112, v112, s80, -v124
    v_fma_f32 v113, v113, s80, -v124
    v_exp_f32 v112, v112
    v_fma_f32 v114, v114, s80, -v124
    v_exp_f32 v113, v113
    v_fma_f32 v115, v115, s80, -v124
    v_exp_f32 v114, v114
    v_fma_f32 v116, v116, s80, -v124
    v_exp_f32 v115, v115
    v_fma_f32 v117, v117, s80, -v124
    v_exp_f32 v116, v116
    v_fma_f32 v118, v118, s80, -v124
    v_exp_f32 v117, v117
    v_fma_f32 v119, v119, s80, -v124
    v_exp_f32 v118, v118
    v_fma_f32 v122, v122, s80, -v124
    v_exp_f32 v119, v119
    v_fma_f32 v123, v123, s80, -v124
    v_exp_f32 v122, v122
    v_exp_f32 v123, v123
    v_cvt_pk_bf16_f32 v44, v112, v113
    v_cvt_pk_bf16_f32 v45, v114, v115
    v_cvt_pk_bf16_f32 v46, v116, v117
    v_cvt_pk_bf16_f32 v47, v118, v119
    v_cvt_pk_bf16_f32 v48, v122, v123
    v_mov_b32 v52, 0x3f803f80
    v_mov_b32 v53, 0x3f803f80
    v_mov_b32 v54, 0x3f803f80
    v_mov_b32 v55, 0x3f803f80
    v_mov_b32 v49, 0
    s_waitcnt vmcnt(0)
    v_mfma_f32_16x16x32_bf16 v[40:43], v[52:55], v[44:47], 0
    v_mfma_f32_16x16x32_bf16 v[24:27], v[88:91], v[44:47], 0
    v_mfma_f32_16x16x32_bf16 v[28:31], v[92:95], v[44:47], 0
    v_mfma_f32_16x16x32_bf16 v[32:35], v[96:99], v[44:47], 0
    v_mfma_f32_16x16x32_bf16 v[36:39], v[100:103], v[44:47], 0
    v_mfma_f32_16x16x16_bf16 v[40:43], v[52:53], v[48:49], v[40:43]
    v_mfma_f32_16x16x16_bf16 v[24:27], v[104:105], v[48:49], v[24:27]
    v_mfma_f32_16x16x16_bf16 v[28:31], v[106:107], v[48:49], v[28:31]
    v_mfma_f32_16x16x16_bf16 v[32:35], v[108:109], v[48:49], v[32:35]
    v_mfma_f32_16x16x16_bf16 v[36:39], v[110:111], v[48:49], v[36:39]
    v_rcp_f32 v40, v40
    s_nop 0
    v_mov_b32 v41, v40
    v_pk_mul_f32 v[24:25], v[24:25], v[40:41]
    v_pk_mul_f32 v[26:27], v[26:27], v[40:41]
    v_pk_mul_f32 v[28:29], v[28:29], v[40:41]
    v_pk_mul_f32 v[30:31], v[30:31], v[40:41]
    v_cvt_pk_bf16_f32 v112, v24, v28
    v_cvt_pk_bf16_f32 v113, v25, v29
    v_cvt_pk_bf16_f32 v114, v26, v30
    v_cvt_pk_bf16_f32 v115, v27, v31
    ds_write_b128 v16, v[112:115] offset:0
    v_pk_mul_f32 v[32:33], v[32:33], v[40:41]
    v_pk_mul_f32 v[34:35], v[34:35], v[40:41]
    v_pk_mul_f32 v[36:37], v[36:37], v[40:41]
    v_pk_mul_f32 v[38:39], v[38:39], v[40:41]
    v_cvt_pk_bf16_f32 v116, v32, v36
    v_cvt_pk_bf16_f32 v117, v33, v37
    v_cvt_pk_bf16_f32 v118, v34, v38
    v_cvt_pk_bf16_f32 v119, v35, v39
    ds_write_b128 v16, v[116:119] offset:1024
    s_lshl_b32 s56, s47, 10
    s_add_u32 s56, s56, s54
    s_add_u32 s57, s56, 524288
    s_waitcnt lgkmcnt(0)
    s_barrier
    ds_read_b128 v[24:27], v17 offset:0
    ds_read_b128 v[28:31], v17 offset:4096
    ds_read_b128 v[32:35], v17 offset:1024
    ds_read_b128 v[36:39], v17 offset:5120
    ds_read_b128 v[40:43], v17 offset:2048
    ds_read_b128 v[44:47], v17 offset:6144
    ds_read_b128 v[48:51], v17 offset:3072
    ds_read_b128 v[52:55], v17 offset:7168
    s_waitcnt lgkmcnt(6)
    v_mfma_f32_16x16x32_bf16 v[88:91], v[56:59], v[24:27], 0
    v_mfma_f32_16x16x32_bf16 v[92:95], v[56:59], v[28:31], 0
    ds_read_b128 v[56:59], v18 offset:8192
    v_mfma_f32_16x16x32_bf16 v[96:99], v[60:63], v[24:27], 0
    v_mfma_f32_16x16x32_bf16 v[100:103], v[60:63], v[28:31], 0
    ds_read_b128 v[60:63], v18 offset:12288
    s_waitcnt lgkmcnt(6)
    v_mfma_f32_16x16x32_bf16 v[88:91], v[64:67], v[32:35], v[88:91]
    v_mfma_f32_16x16x32_bf16 v[92:95], v[64:67], v[36:39], v[92:95]
    ds_read_b128 v[64:67], v18 offset:9216
    v_mfma_f32_16x16x32_bf16 v[96:99], v[68:71], v[32:35], v[96:99]
    v_mfma_f32_16x16x32_bf16 v[100:103], v[68:71], v[36:39], v[100:103]
    ds_read_b128 v[68:71], v18 offset:13312
    s_waitcnt lgkmcnt(6)
    v_mfma_f32_16x16x32_bf16 v[88:91], v[72:75], v[40:43], v[88:91]
    v_mfma_f32_16x16x32_bf16 v[92:95], v[72:75], v[44:47], v[92:95]
    ds_read_b128 v[72:75], v18 offset:10240
    v_mfma_f32_16x16x32_bf16 v[96:99], v[76:79], v[40:43], v[96:99]
    v_mfma_f32_16x16x32_bf16 v[100:103], v[76:79], v[44:47], v[100:103]
    ds_read_b128 v[76:79], v18 offset:14336
    s_waitcnt lgkmcnt(6)
    v_mfma_f32_16x16x32_bf16 v[88:91], v[80:83], v[48:51], v[88:91]
    v_mfma_f32_16x16x32_bf16 v[92:95], v[80:83], v[52:55], v[92:95]
    ds_read_b128 v[80:83], v18 offset:11264
    v_mfma_f32_16x16x32_bf16 v[96:99], v[84:87], v[48:51], v[96:99]
    v_mfma_f32_16x16x32_bf16 v[100:103], v[84:87], v[52:55], v[100:103]
    ds_read_b128 v[84:87], v18 offset:15360
    s_waitcnt lgkmcnt(7)
    v_mfma_f32_16x16x32_bf16 v[104:107], v[56:59], v[24:27], 0
    v_mfma_f32_16x16x32_bf16 v[108:111], v[56:59], v[28:31], 0
    ds_read_b128 v[56:59], v18 offset:16384
    s_waitcnt lgkmcnt(7)
    v_mfma_f32_16x16x32_bf16 v[112:115], v[60:63], v[24:27], 0
    v_mfma_f32_16x16x32_bf16 v[116:119], v[60:63], v[28:31], 0
    ds_read_b128 v[60:63], v18 offset:20480
    s_waitcnt lgkmcnt(7)
    v_mfma_f32_16x16x32_bf16 v[104:107], v[64:67], v[32:35], v[104:107]
    v_mfma_f32_16x16x32_bf16 v[108:111], v[64:67], v[36:39], v[108:111]
    ds_read_b128 v[64:67], v18 offset:17408
    s_waitcnt lgkmcnt(7)
    v_mfma_f32_16x16x32_bf16 v[112:115], v[68:71], v[32:35], v[112:115]
    v_mfma_f32_16x16x32_bf16 v[116:119], v[68:71], v[36:39], v[116:119]
    ds_read_b128 v[68:71], v18 offset:21504
    v_cvt_pk_bf16_f32 v120, v88, v96
    v_cvt_pk_bf16_f32 v121, v89, v97
    v_cvt_pk_bf16_f32 v122, v90, v98
    v_cvt_pk_bf16_f32 v123, v91, v99
    buffer_store_dwordx4 v[120:123], v19, s[8:11], s56 offen offset:0
    v_cvt_pk_bf16_f32 v124, v92, v100
    v_cvt_pk_bf16_f32 v125, v93, v101
    v_cvt_pk_bf16_f32 v126, v94, v102
    v_cvt_pk_bf16_f32 v127, v95, v103
    buffer_store_dwordx4 v[124:127], v19, s[8:11], s57 offen offset:0
    s_waitcnt lgkmcnt(7)
    v_mfma_f32_16x16x32_bf16 v[104:107], v[72:75], v[40:43], v[104:107]
    v_mfma_f32_16x16x32_bf16 v[108:111], v[72:75], v[44:47], v[108:111]
    ds_read_b128 v[72:75], v18 offset:18432
    s_waitcnt lgkmcnt(7)
    v_mfma_f32_16x16x32_bf16 v[112:115], v[76:79], v[40:43], v[112:115]
    v_mfma_f32_16x16x32_bf16 v[116:119], v[76:79], v[44:47], v[116:119]
    ds_read_b128 v[76:79], v18 offset:22528
    s_waitcnt lgkmcnt(7)
    v_mfma_f32_16x16x32_bf16 v[104:107], v[80:83], v[48:51], v[104:107]
    v_mfma_f32_16x16x32_bf16 v[108:111], v[80:83], v[52:55], v[108:111]
    ds_read_b128 v[80:83], v18 offset:19456
    s_waitcnt lgkmcnt(7)
    v_mfma_f32_16x16x32_bf16 v[112:115], v[84:87], v[48:51], v[112:115]
    v_mfma_f32_16x16x32_bf16 v[116:119], v[84:87], v[52:55], v[116:119]
    ds_read_b128 v[84:87], v18 offset:23552
    s_waitcnt lgkmcnt(7)
    v_mfma_f32_16x16x32_bf16 v[88:91], v[56:59], v[24:27], 0
    v_mfma_f32_16x16x32_bf16 v[92:95], v[56:59], v[28:31], 0
    ds_read_b128 v[56:59], v18 offset:24576
    s_waitcnt lgkmcnt(7)
    v_mfma_f32_16x16x32_bf16 v[96:99], v[60:63], v[24:27], 0
    v_mfma_f32_16x16x32_bf16 v[100:103], v[60:63], v[28:31], 0
    ds_read_b128 v[60:63], v18 offset:28672
    s_waitcnt lgkmcnt(7)
    v_mfma_f32_16x16x32_bf16 v[88:91], v[64:67], v[32:35], v[88:91]
    v_mfma_f32_16x16x32_bf16 v[92:95], v[64:67], v[36:39], v[92:95]
    ds_read_b128 v[64:67], v18 offset:25600
    s_waitcnt lgkmcnt(7)
    v_mfma_f32_16x16x32_bf16 v[96:99], v[68:71], v[32:35], v[96:99]
    v_mfma_f32_16x16x32_bf16 v[100:103], v[68:71], v[36:39], v[100:103]
    ds_read_b128 v[68:71], v18 offset:29696
    v_cvt_pk_bf16_f32 v120, v104, v112
    v_cvt_pk_bf16_f32 v121, v105, v113
    v_cvt_pk_bf16_f32 v122, v106, v114
    v_cvt_pk_bf16_f32 v123, v107, v115
    buffer_store_dwordx4 v[120:123], v19, s[8:11], s56 offen offset:256
    v_cvt_pk_bf16_f32 v124, v108, v116
    v_cvt_pk_bf16_f32 v125, v109, v117
    v_cvt_pk_bf16_f32 v126, v110, v118
    v_cvt_pk_bf16_f32 v127, v111, v119
    buffer_store_dwordx4 v[124:127], v19, s[8:11], s57 offen offset:256
    s_waitcnt lgkmcnt(7)
    v_mfma_f32_16x16x32_bf16 v[88:91], v[72:75], v[40:43], v[88:91]
    v_mfma_f32_16x16x32_bf16 v[92:95], v[72:75], v[44:47], v[92:95]
    ds_read_b128 v[72:75], v18 offset:26624
    s_waitcnt lgkmcnt(7)
    v_mfma_f32_16x16x32_bf16 v[96:99], v[76:79], v[40:43], v[96:99]
    v_mfma_f32_16x16x32_bf16 v[100:103], v[76:79], v[44:47], v[100:103]
    ds_read_b128 v[76:79], v18 offset:30720
    s_waitcnt lgkmcnt(7)
    v_mfma_f32_16x16x32_bf16 v[88:91], v[80:83], v[48:51], v[88:91]
    v_mfma_f32_16x16x32_bf16 v[92:95], v[80:83], v[52:55], v[92:95]
    ds_read_b128 v[80:83], v18 offset:27648
    s_waitcnt lgkmcnt(7)
    v_mfma_f32_16x16x32_bf16 v[96:99], v[84:87], v[48:51], v[96:99]
    v_mfma_f32_16x16x32_bf16 v[100:103], v[84:87], v[52:55], v[100:103]
    ds_read_b128 v[84:87], v18 offset:31744
    s_waitcnt lgkmcnt(7)
    v_mfma_f32_16x16x32_bf16 v[104:107], v[56:59], v[24:27], 0
    v_mfma_f32_16x16x32_bf16 v[108:111], v[56:59], v[28:31], 0
    s_waitcnt lgkmcnt(6)
    v_mfma_f32_16x16x32_bf16 v[112:115], v[60:63], v[24:27], 0
    v_mfma_f32_16x16x32_bf16 v[116:119], v[60:63], v[28:31], 0
    s_waitcnt lgkmcnt(5)
    v_mfma_f32_16x16x32_bf16 v[104:107], v[64:67], v[32:35], v[104:107]
    v_mfma_f32_16x16x32_bf16 v[108:111], v[64:67], v[36:39], v[108:111]
    s_waitcnt lgkmcnt(4)
    v_mfma_f32_16x16x32_bf16 v[112:115], v[68:71], v[32:35], v[112:115]
    v_mfma_f32_16x16x32_bf16 v[116:119], v[68:71], v[36:39], v[116:119]
    v_cvt_pk_bf16_f32 v120, v88, v96
    v_cvt_pk_bf16_f32 v121, v89, v97
    v_cvt_pk_bf16_f32 v122, v90, v98
    v_cvt_pk_bf16_f32 v123, v91, v99
    buffer_store_dwordx4 v[120:123], v19, s[8:11], s56 offen offset:512
    v_cvt_pk_bf16_f32 v124, v92, v100
    v_cvt_pk_bf16_f32 v125, v93, v101
    v_cvt_pk_bf16_f32 v126, v94, v102
    v_cvt_pk_bf16_f32 v127, v95, v103
    buffer_store_dwordx4 v[124:127], v19, s[8:11], s57 offen offset:512
    s_waitcnt lgkmcnt(3)
    v_mfma_f32_16x16x32_bf16 v[104:107], v[72:75], v[40:43], v[104:107]
    v_mfma_f32_16x16x32_bf16 v[108:111], v[72:75], v[44:47], v[108:111]
    s_waitcnt lgkmcnt(2)
    v_mfma_f32_16x16x32_bf16 v[112:115], v[76:79], v[40:43], v[112:115]
    v_mfma_f32_16x16x32_bf16 v[116:119], v[76:79], v[44:47], v[116:119]
    s_waitcnt lgkmcnt(1)
    v_mfma_f32_16x16x32_bf16 v[104:107], v[80:83], v[48:51], v[104:107]
    v_mfma_f32_16x16x32_bf16 v[108:111], v[80:83], v[52:55], v[108:111]
    s_waitcnt lgkmcnt(0)
    v_mfma_f32_16x16x32_bf16 v[112:115], v[84:87], v[48:51], v[112:115]
    v_mfma_f32_16x16x32_bf16 v[116:119], v[84:87], v[52:55], v[116:119]
    s_nop 3
    v_cvt_pk_bf16_f32 v120, v104, v112
    v_cvt_pk_bf16_f32 v121, v105, v113
    v_cvt_pk_bf16_f32 v122, v106, v114
    v_cvt_pk_bf16_f32 v123, v107, v115
    buffer_store_dwordx4 v[120:123], v19, s[8:11], s56 offen offset:768
    v_cvt_pk_bf16_f32 v124, v108, v116
    v_cvt_pk_bf16_f32 v125, v109, v117
    v_cvt_pk_bf16_f32 v126, v110, v118
    v_cvt_pk_bf16_f32 v127, v111, v119
    buffer_store_dwordx4 v[124:127], v19, s[8:11], s57 offen offset:768
    s_lshl_b32 s59, s51, 13
    s_lshl2_add_u32 s59, s47, s59
    s_add_u32 s59, s59, 10486528
    s_waitcnt vmcnt(0)
    s_barrier
    s_cmp_lg_u32 s46, 0
    s_cbranch_scc1 L_fs_18
    v_mov_b32 v124, 0
    v_mov_b32 v125, 1
    s_mov_b64 exec, 1
    buffer_store_dword v125, v124, s[8:11], s59 offen
    s_mov_b64 exec, -1
L_fs_18:
    s_lshl_b32 s64, s51, 5
    s_add_u32 s64, s64, s47
    s_lshl_b32 s56, s64, 10
    s_lshr_b32 s57, s64, 5
    s_lshl_b32 s57, s57, 15
    s_bfe_u32 s58, s64, 0x10004
    s_lshl_b32 s58, s58, 10
    s_add_u32 s57, s57, s58
    s_and_b32 s58, s64, 15
    s_lshl_b32 s58, s58, 4
    s_add_u32 s57, s57, s58
    s_add_u32 s57, s57, 2097152
    s_mov_b32 s4, s16
    s_mov_b32 s5, s17
    s_mov_b32 s6, 2097152
    s_mov_b32 s7, 0x20000
    buffer_load_dwordx4 v[72:75], v0, s[4:7], s56 offen
    s_mov_b32 s4, s32
    s_mov_b32 s5, s33
    s_mov_b32 s6, 1024
    s_mov_b32 s7, 0x20000
    buffer_load_dwordx4 v[76:79], v0, s[4:7], 0 offen
    s_lshl_b32 s59, s51, 13
    s_add_u32 s59, s59, 10486528
    v_and_b32 v124, 31, v1
    v_lshlrev_b32 v124, 2, v124
L_fw_19:
    buffer_load_dword v125, v124, s[8:11], s59 offen sc1
    s_waitcnt vmcnt(0)
    v_cmp_eq_u32 vcc, 0, v125
    s_cbranch_vccz L_fwd_20
    s_sub_u32 s49, s49, 1
    s_cmp_gt_i32 s49, 0
    s_cbranch_scc1 L_fw_19
    s_branch L_abort
L_fwd_20:
    s_lshl_b32 s60, s47, 15
    s_add_u32 s60, s60, s54
    s_add_u32 s63, s60, 0
    buffer_load_dwordx4 v[24:27], v22, s[8:11], s63 offen sc1
    s_add_u32 s63, s60, 4096
    buffer_load_dwordx4 v[28:31], v22, s[8:11], s63 offen sc1
    s_add_u32 s63, s60, 8192
    buffer_load_dwordx4 v[32:35], v22, s[8:11], s63 offen sc1
    s_add_u32 s63, s60, 12288
    buffer_load_dwordx4 v[36:39], v22, s[8:11], s63 offen sc1
    s_add_u32 s63, s60, 16384
    buffer_load_dwordx4 v[40:43], v22, s[8:11], s63 offen sc1
    s_add_u32 s63, s60, 20480
    buffer_load_dwordx4 v[44:47], v22, s[8:11], s63 offen sc1
    s_add_u32 s63, s60, 24576
    buffer_load_dwordx4 v[48:51], v22, s[8:11], s63 offen sc1
    s_add_u32 s63, s60, 28672
    buffer_load_dwordx4 v[52:55], v22, s[8:11], s63 offen sc1
    v_and_b32 v64, 15, v1
    v_and_b32 v65, 1, v1
    v_lshlrev_b32 v65, 4, v65
    v_mov_b32 v66, 0x3f80
    v_lshlrev_b32 v66, v65, v66
    v_lshrrev_b32 v64, 1, v64
    v_cmp_eq_u32 vcc, 0, v64
    s_nop 1
    v_cndmask_b32 v56, 0, v66, vcc
    v_cmp_eq_u32 vcc, 1, v64
    s_nop 1
    v_cndmask_b32 v57, 0, v66, vcc
    v_cmp_eq_u32 vcc, 2, v64
    s_nop 1
    v_cndmask_b32 v58, 0, v66, vcc
    v_cmp_eq_u32 vcc, 3, v64
    s_nop 1
    v_cndmask_b32 v59, 0, v66, vcc
    s_waitcnt vmcnt(7)
    s_nop 0
    v_mfma_f32_16x16x32_bf16 v[60:63], v[56:59], v[24:27], 0
    s_waitcnt vmcnt(6)
    v_mfma_f32_16x16x32_bf16 v[60:63], v[56:59], v[28:31], v[60:63]
    s_waitcnt vmcnt(5)
    v_mfma_f32_16x16x32_bf16 v[60:63], v[56:59], v[32:35], v[60:63]
    s_waitcnt vmcnt(4)
    v_mfma_f32_16x16x32_bf16 v[60:63], v[56:59], v[36:39], v[60:63]
    s_waitcnt vmcnt(3)
    v_mfma_f32_16x16x32_bf16 v[60:63], v[56:59], v[40:43], v[60:63]
    s_waitcnt vmcnt(2)
    v_mfma_f32_16x16x32_bf16 v[60:63], v[56:59], v[44:47], v[60:63]
    s_waitcnt vmcnt(1)
    v_mfma_f32_16x16x32_bf16 v[60:63], v[56:59], v[48:51], v[60:63]
    s_waitcnt vmcnt(0)
    v_mfma_f32_16x16x32_bf16 v[60:63], v[56:59], v[52:55], v[60:63]
    s_nop 7
    ds_write_b128 v21, v[60:63]
    s_waitcnt lgkmcnt(0)
    s_barrier
    s_cmp_lg_u32 s46, 0
    s_cbranch_scc1 L_t4d_21
    v_lshlrev_b32 v56, 5, v1
    v_add_u32 v56, 139264, v56
    ds_read_b128 v[24:27], v56
    ds_read_b128 v[28:31], v56 offset:16
    v_lshlrev_b32 v32, 16, v72
    v_and_b32 v33, 0xffff0000, v72
    v_lshlrev_b32 v34, 16, v73
    v_and_b32 v35, 0xffff0000, v73
    v_lshlrev_b32 v36, 16, v74
    v_and_b32 v37, 0xffff0000, v74
    v_lshlrev_b32 v38, 16, v75
    v_and_b32 v39, 0xffff0000, v75
    s_waitcnt lgkmcnt(0)
    v_cvt_pk_bf16_f32 v40, v24, v25
    v_cvt_pk_bf16_f32 v41, v26, v27
    v_cvt_pk_bf16_f32 v42, v28, v29
    v_cvt_pk_bf16_f32 v43, v30, v31
    v_lshlrev_b32 v24, 16, v40
    v_and_b32 v25, 0xffff0000, v40
    v_lshlrev_b32 v26, 16, v41
    v_and_b32 v27, 0xffff0000, v41
    v_lshlrev_b32 v28, 16, v42
    v_and_b32 v29, 0xffff0000, v42
    v_lshlrev_b32 v30, 16, v43
    v_and_b32 v31, 0xffff0000, v43
    v_add_f32 v32, v32, v24
    v_add_f32 v33, v33, v25
    v_add_f32 v34, v34, v26
    v_add_f32 v35, v35, v27
    v_add_f32 v36, v36, v28
    v_add_f32 v37, v37, v29
    v_add_f32 v38, v38, v30
    v_add_f32 v39, v39, v31
    v_cvt_pk_bf16_f32 v40, v32, v33
    v_cvt_pk_bf16_f32 v41, v34, v35
    v_cvt_pk_bf16_f32 v42, v36, v37
    v_cvt_pk_bf16_f32 v43, v38, v39
    s_add_u32 s58, s56, 4194304
    buffer_store_dwordx4 v[40:43], v0, s[8:11], s58 offen sc1
    v_lshlrev_b32 v32, 16, v40
    v_and_b32 v33, 0xffff0000, v40
    v_lshlrev_b32 v34, 16, v41
    v_and_b32 v35, 0xffff0000, v41
    v_lshlrev_b32 v36, 16, v42
    v_and_b32 v37, 0xffff0000, v42
    v_lshlrev_b32 v38, 16, v43
    v_and_b32 v39, 0xffff0000, v43
    v_add_f32 v64, v32, v33
    v_add_f32 v65, v34, v35
    v_add_f32 v66, v36, v37
    v_add_f32 v67, v38, v39
    v_add_f32 v64, v64, v65
    v_add_f32 v66, v66, v67
    v_add_f32 v64, v64, v66
    s_nop 1
    v_add_f32_dpp v64, v64, v64 row_ror:8 row_mask:0xf bank_mask:0xf
    s_nop 1
    v_add_f32_dpp v64, v64, v64 row_ror:4 row_mask:0xf bank_mask:0xf
    s_nop 1
    v_add_f32_dpp v64, v64, v64 row_ror:2 row_mask:0xf bank_mask:0xf
    s_nop 1
    v_add_f32_dpp v64, v64, v64 row_ror:1 row_mask:0xf bank_mask:0xf
    v_mov_b32 v65, v64
    s_nop 1
    v_permlane16_swap_b32 v64, v65
    v_add_f32 v64, v64, v65
    v_mov_b32 v65, v64
    s_nop 1
    v_permlane32_swap_b32 v64, v65
    v_add_f32 v64, v64, v65
    v_mul_f32 v66, 0x3b000000, v64
    v_sub_f32 v56, v32, v66
    v_sub_f32 v57, v33, v66
    v_sub_f32 v58, v34, v66
    v_sub_f32 v59, v35, v66
    v_sub_f32 v60, v36, v66
    v_sub_f32 v61, v37, v66
    v_sub_f32 v62, v38, v66
    v_sub_f32 v63, v39, v66
    v_mul_f32 v64, v56, v56
    v_mul_f32 v67, v57, v57
    v_fmac_f32 v64, v58, v58
    v_fmac_f32 v67, v59, v59
    v_fmac_f32 v64, v60, v60
    v_fmac_f32 v67, v61, v61
    v_fmac_f32 v64, v62, v62
    v_fmac_f32 v67, v63, v63
    v_add_f32 v64, v64, v67
    v_cvt_pk_bf16_f32 v66, v66, v66
    v_and_b32 v66, 0xffff0000, v66
    v_add_f32_dpp v64, v64, v64 row_ror:8 row_mask:0xf bank_mask:0xf
    s_nop 1
    v_add_f32_dpp v64, v64, v64 row_ror:4 row_mask:0xf bank_mask:0xf
    s_nop 1
    v_add_f32_dpp v64, v64, v64 row_ror:2 row_mask:0xf bank_mask:0xf
    s_nop 1
    v_add_f32_dpp v64, v64, v64 row_ror:1 row_mask:0xf bank_mask:0xf
    v_mov_b32 v65, v64
    s_nop 1
    v_permlane16_swap_b32 v64, v65
    v_add_f32 v64, v64, v65
    v_mov_b32 v65, v64
    s_nop 1
    v_permlane32_swap_b32 v64, v65
    v_add_f32 v64, v64, v65
    v_mul_f32 v64, 0x3b000000, v64
    v_cvt_pk_bf16_f32 v64, v64, v64
    v_and_b32 v64, 0xffff0000, v64
    v_add_f32 v64, 0x3727c5ac, v64
    v_cvt_pk_bf16_f32 v64, v64, v64
    v_and_b32 v64, 0xffff0000, v64
    v_sqrt_f32 v64, v64
    v_sub_f32 v56, v32, v66
    v_sub_f32 v57, v33, v66
    v_sub_f32 v58, v34, v66
    v_sub_f32 v59, v35, v66
    v_sub_f32 v60, v36, v66
    v_sub_f32 v61, v37, v66
    v_sub_f32 v62, v38, v66
    v_sub_f32 v63, v39, v66
    v_cvt_pk_bf16_f32 v64, v64, v64
    v_and_b32 v64, 0xffff0000, v64
    v_rcp_f32 v64, v64
    v_cvt_pk_bf16_f32 v44, v56, v57
    v_cvt_pk_bf16_f32 v45, v58, v59
    v_cvt_pk_bf16_f32 v46, v60, v61
    v_cvt_pk_bf16_f32 v47, v62, v63
    v_lshlrev_b32 v56, 16, v44
    v_and_b32 v57, 0xffff0000, v44
    v_lshlrev_b32 v58, 16, v45
    v_and_b32 v59, 0xffff0000, v45
    v_lshlrev_b32 v60, 16, v46
    v_and_b32 v61, 0xffff0000, v46
    v_lshlrev_b32 v62, 16, v47
    v_and_b32 v63, 0xffff0000, v47
    v_mul_f32 v56, v56, v64
    v_mul_f32 v57, v57, v64
    v_mul_f32 v58, v58, v64
    v_mul_f32 v59, v59, v64
    v_mul_f32 v60, v60, v64
    v_mul_f32 v61, v61, v64
    v_mul_f32 v62, v62, v64
    v_mul_f32 v63, v63, v64
    v_cvt_pk_bf16_f32 v44, v56, v57
    v_cvt_pk_bf16_f32 v45, v58, v59
    v_cvt_pk_bf16_f32 v46, v60, v61
    v_cvt_pk_bf16_f32 v47, v62, v63
    v_lshlrev_b32 v48, 16, v44
    v_and_b32 v49, 0xffff0000, v44
    v_lshlrev_b32 v50, 16, v45
    v_and_b32 v51, 0xffff0000, v45
    v_lshlrev_b32 v52, 16, v46
    v_and_b32 v53, 0xffff0000, v46
    v_lshlrev_b32 v54, 16, v47
    v_and_b32 v55, 0xffff0000, v47
    v_add_f32 v32, v32, v48
    v_add_f32 v33, v33, v49
    v_add_f32 v34, v34, v50
    v_add_f32 v35, v35, v51
    v_add_f32 v36, v36, v52
    v_add_f32 v37, v37, v53
    v_add_f32 v38, v38, v54
    v_add_f32 v39, v39, v55
    v_cvt_pk_bf16_f32 v80, v32, v33
    v_cvt_pk_bf16_f32 v81, v34, v35
    v_cvt_pk_bf16_f32 v82, v36, v37
    v_cvt_pk_bf16_f32 v83, v38, v39
    s_add_u32 s58, s56, 8388608
    buffer_store_dwordx4 v[80:83], v0, s[8:11], s58 offen sc1
    v_lshlrev_b32 v32, 16, v80
    v_and_b32 v33, 0xffff0000, v80
    v_lshlrev_b32 v34, 16, v81
    v_and_b32 v35, 0xffff0000, v81
    v_lshlrev_b32 v36, 16, v82
    v_and_b32 v37, 0xffff0000, v82
    v_lshlrev_b32 v38, 16, v83
    v_and_b32 v39, 0xffff0000, v83
    v_add_f32 v64, v32, v33
    v_add_f32 v65, v34, v35
    v_add_f32 v66, v36, v37
    v_add_f32 v67, v38, v39
    v_add_f32 v64, v64, v65
    v_add_f32 v66, v66, v67
    v_add_f32 v64, v64, v66
    s_nop 1
    v_add_f32_dpp v64, v64, v64 row_ror:8 row_mask:0xf bank_mask:0xf
    s_nop 1
    v_add_f32_dpp v64, v64, v64 row_ror:4 row_mask:0xf bank_mask:0xf
    s_nop 1
    v_add_f32_dpp v64, v64, v64 row_ror:2 row_mask:0xf bank_mask:0xf
    s_nop 1
    v_add_f32_dpp v64, v64, v64 row_ror:1 row_mask:0xf bank_mask:0xf
    v_mov_b32 v65, v64
    s_nop 1
    v_permlane16_swap_b32 v64, v65
    v_add_f32 v64, v64, v65
    v_mov_b32 v65, v64
    s_nop 1
    v_permlane32_swap_b32 v64, v65
    v_add_f32 v64, v64, v65
    v_mul_f32 v66, 0x3b000000, v64
    v_sub_f32 v56, v32, v66
    v_sub_f32 v57, v33, v66
    v_sub_f32 v58, v34, v66
    v_sub_f32 v59, v35, v66
    v_sub_f32 v60, v36, v66
    v_sub_f32 v61, v37, v66
    v_sub_f32 v62, v38, v66
    v_sub_f32 v63, v39, v66
    v_mul_f32 v64, v56, v56
    v_mul_f32 v67, v57, v57
    v_fmac_f32 v64, v58, v58
    v_fmac_f32 v67, v59, v59
    v_fmac_f32 v64, v60, v60
    v_fmac_f32 v67, v61, v61
    v_fmac_f32 v64, v62, v62
    v_fmac_f32 v67, v63, v63
    v_add_f32 v64, v64, v67
    v_cvt_pk_bf16_f32 v66, v66, v66
    v_and_b32 v66, 0xffff0000, v66
    v_add_f32_dpp v64, v64, v64 row_ror:8 row_mask:0xf bank_mask:0xf
    s_nop 1
    v_add_f32_dpp v64, v64, v64 row_ror:4 row_mask:0xf bank_mask:0xf
    s_nop 1
    v_add_f32_dpp v64, v64, v64 row_ror:2 row_mask:0xf bank_mask:0xf
    s_nop 1
    v_add_f32_dpp v64, v64, v64 row_ror:1 row_mask:0xf bank_mask:0xf
    v_mov_b32 v65, v64
    s_nop 1
    v_permlane16_swap_b32 v64, v65
    v_add_f32 v64, v64, v65
    v_mov_b32 v65, v64
    s_nop 1
    v_permlane32_swap_b32 v64, v65
    v_add_f32 v64, v64, v65
    v_mul_f32 v64, 0x3b000000, v64
    v_cvt_pk_bf16_f32 v64, v64, v64
    v_and_b32 v64, 0xffff0000, v64
    v_add_f32 v64, 0x3727c5ac, v64
    v_cvt_pk_bf16_f32 v64, v64, v64
    v_and_b32 v64, 0xffff0000, v64
    v_sqrt_f32 v64, v64
    v_sub_f32 v56, v32, v66
    v_sub_f32 v57, v33, v66
    v_sub_f32 v58, v34, v66
    v_sub_f32 v59, v35, v66
    v_sub_f32 v60, v36, v66
    v_sub_f32 v61, v37, v66
    v_sub_f32 v62, v38, v66
    v_sub_f32 v63, v39, v66
    v_cvt_pk_bf16_f32 v64, v64, v64
    v_and_b32 v64, 0xffff0000, v64
    v_rcp_f32 v64, v64
    v_cvt_pk_bf16_f32 v84, v56, v57
    v_cvt_pk_bf16_f32 v85, v58, v59
    v_cvt_pk_bf16_f32 v86, v60, v61
    v_cvt_pk_bf16_f32 v87, v62, v63
    v_lshlrev_b32 v56, 16, v84
    v_and_b32 v57, 0xffff0000, v84
    v_lshlrev_b32 v58, 16, v85
    v_and_b32 v59, 0xffff0000, v85
    v_lshlrev_b32 v60, 16, v86
    v_and_b32 v61, 0xffff0000, v86
    v_lshlrev_b32 v62, 16, v87
    v_and_b32 v63, 0xffff0000, v87
    v_mul_f32 v56, v56, v64
    v_mul_f32 v57, v57, v64
    v_mul_f32 v58, v58, v64
    v_mul_f32 v59, v59, v64
    v_mul_f32 v60, v60, v64
    v_mul_f32 v61, v61, v64
    v_mul_f32 v62, v62, v64
    v_mul_f32 v63, v63, v64
    v_cvt_pk_bf16_f32 v84, v56, v57
    v_cvt_pk_bf16_f32 v85, v58, v59
    v_cvt_pk_bf16_f32 v86, v60, v61
    v_cvt_pk_bf16_f32 v87, v62, v63
    buffer_store_dwordx4 v[84:87], v20, s[8:11], s57 offen sc1
    v_lshlrev_b32 v24, 16, v76
    v_and_b32 v25, 0xffff0000, v76
    v_lshlrev_b32 v26, 16, v77
    v_and_b32 v27, 0xffff0000, v77
    v_lshlrev_b32 v28, 16, v78
    v_and_b32 v29, 0xffff0000, v78
    v_lshlrev_b32 v30, 16, v79
    v_and_b32 v31, 0xffff0000, v79
    v_mul_f32 v90, v48, v24
    v_fmac_f32 v90, v49, v25
    v_fmac_f32 v90, v50, v26
    v_fmac_f32 v90, v51, v27
    v_fmac_f32 v90, v52, v28
    v_fmac_f32 v90, v53, v29
    v_fmac_f32 v90, v54, v30
    v_fmac_f32 v90, v55, v31
    s_nop 1
    v_add_f32_dpp v90, v90, v90 row_ror:8 row_mask:0xf bank_mask:0xf
    s_nop 1
    v_add_f32_dpp v90, v90, v90 row_ror:4 row_mask:0xf bank_mask:0xf
    s_nop 1
    v_add_f32_dpp v90, v90, v90 row_ror:2 row_mask:0xf bank_mask:0xf
    s_nop 1
    v_add_f32_dpp v90, v90, v90 row_ror:1 row_mask:0xf bank_mask:0xf
    v_mov_b32 v91, v90
    s_nop 1
    v_permlane16_swap_b32 v90, v91
    v_add_f32 v90, v90, v91
    v_mov_b32 v91, v90
    s_nop 1
    v_permlane32_swap_b32 v90, v91
    v_add_f32 v90, v90, v91
    v_cvt_pk_bf16_f32 v90, v90, v90
    v_and_b32 v90, 0xffff0000, v90
    v_ashrrev_i32 v91, 31, v90
    v_or_b32 v91, 0x80000000, v91
    v_xor_b32 v90, v90, v91
    v_and_b32 v90, 0xffff0000, v90
    s_sub_u32 s58, 4095, s64
    v_or_b32 v90, s58, v90
    s_lshl_b32 s58, s51, 13
    s_lshl2_add_u32 s58, s47, s58
    s_add_u32 s58, s58, 10487168
    s_waitcnt vmcnt(0)
    s_mov_b64 exec, 1
    buffer_store_dword v90, off, s[8:11], s58 sc1
    s_mov_b64 exec, -1
L_t4d_21:
    s_xor_b32 s54, s54, 1048576
    s_lshl_b32 s59, s51, 13
    s_add_u32 s59, s59, 10487168
    v_and_b32 v124, 31, v1
    v_lshlrev_b32 v124, 2, v124
L_fw_22:
    buffer_load_dword v125, v124, s[8:11], s59 offen sc1
    s_waitcnt vmcnt(0)
    v_cmp_eq_u32 vcc, 0, v125
    s_cbranch_vccz L_fwd_23
    s_sub_u32 s49, s49, 1
    s_cmp_gt_i32 s49, 0
    s_cbranch_scc1 L_fw_22
    s_branch L_abort
L_fwd_23:
    s_lshl_b32 s56, s51, 15
    s_lshl_b32 s57, s46, 12
    s_add_u32 s66, s56, s57
    s_add_u32 s66, s66, 2097152
    s_xor_b32 s56, s66, 0
    buffer_load_dwordx4 v[72:75], v0, s[8:11], s56 offen offset:0 sc1
    buffer_load_dwordx4 v[76:79], v0, s[8:11], s56 offen offset:1024 sc1
    buffer_load_dwordx4 v[80:83], v0, s[8:11], s56 offen offset:2048 sc1
    buffer_load_dwordx4 v[84:87], v0, s[8:11], s56 offen offset:3072 sc1
    s_xor_b32 s56, s66, 4096
    buffer_load_dwordx4 v[88:91], v0, s[8:11], s56 offen offset:0 sc1
    buffer_load_dwordx4 v[92:95], v0, s[8:11], s56 offen offset:1024 sc1
    buffer_load_dwordx4 v[96:99], v0, s[8:11], s56 offen offset:2048 sc1
    buffer_load_dwordx4 v[100:103], v0, s[8:11], s56 offen offset:3072 sc1
    s_xor_b32 s56, s66, 8192
    buffer_load_dwordx4 v[104:107], v0, s[8:11], s56 offen offset:0 sc1
    buffer_load_dwordx4 v[108:111], v0, s[8:11], s56 offen offset:1024 sc1
    buffer_load_dwordx4 v[112:115], v0, s[8:11], s56 offen offset:2048 sc1
    buffer_load_dwordx4 v[116:119], v0, s[8:11], s56 offen offset:3072 sc1
    s_xor_b32 s56, s66, 12288
    buffer_load_dwordx4 v[120:123], v0, s[8:11], s56 offen offset:0 sc1
    buffer_load_dwordx4 v[124:127], v0, s[8:11], s56 offen offset:1024 sc1
    s_lshl_b32 s58, s51, 5
    s_add_u32 s58, s58, s47
    s_mul_i32 s58, s58, 24576
    s_add_u32 s58, s58, 150994944
    s_lshl_b32 s60, s46, 10
    s_add_u32 s61, s58, s60
    s_add_u32 s62, s61, 4096
    s_add_u32 s63, s61, 16384
    s_add_u32 s64, s61, 20480
    s_add_u32 s65, s61, s60
    s_add_u32 s65, s65, 8192
    s_waitcnt vmcnt(12)
    v_mfma_f32_16x16x32_bf16 v[40:43], a[128:131], v[72:75], 0
    v_mfma_f32_16x16x32_bf16 v[56:59], v[72:75], v[128:131], 0
    v_mfma_f32_16x16x32_bf16 v[24:27], a[0:3], v[72:75], 0
    v_mfma_f32_16x16x32_bf16 v[44:47], a[128:131], v[76:79], 0
    v_mfma_f32_16x16x32_bf16 v[60:63], v[76:79], v[128:131], 0
    v_mfma_f32_16x16x32_bf16 v[28:31], a[0:3], v[76:79], 0
    v_mfma_f32_16x16x32_bf16 v[48:51], a[136:139], v[72:75], 0
    v_mfma_f32_16x16x32_bf16 v[64:67], v[72:75], v[136:139], 0
    v_mfma_f32_16x16x32_bf16 v[32:35], a[8:11], v[72:75], 0
    v_mfma_f32_16x16x32_bf16 v[52:55], a[136:139], v[76:79], 0
    v_mfma_f32_16x16x32_bf16 v[68:71], v[76:79], v[136:139], 0
    v_mfma_f32_16x16x32_bf16 v[36:39], a[8:11], v[76:79], 0
    buffer_load_dwordx4 v[72:75], v0, s[8:11], s56 offen offset:2048 sc1
    buffer_load_dwordx4 v[76:79], v0, s[8:11], s56 offen offset:3072 sc1
    s_waitcnt vmcnt(12)
    v_mfma_f32_16x16x32_bf16 v[40:43], a[132:135], v[80:83], v[40:43]
    v_mfma_f32_16x16x32_bf16 v[56:59], v[80:83], v[132:135], v[56:59]
    v_mfma_f32_16x16x32_bf16 v[24:27], a[4:7], v[80:83], v[24:27]
    v_mfma_f32_16x16x32_bf16 v[44:47], a[132:135], v[84:87], v[44:47]
    v_mfma_f32_16x16x32_bf16 v[60:63], v[84:87], v[132:135], v[60:63]
    v_mfma_f32_16x16x32_bf16 v[28:31], a[4:7], v[84:87], v[28:31]
    v_mfma_f32_16x16x32_bf16 v[48:51], a[140:143], v[80:83], v[48:51]
    v_mfma_f32_16x16x32_bf16 v[64:67], v[80:83], v[140:143], v[64:67]
    v_mfma_f32_16x16x32_bf16 v[32:35], a[12:15], v[80:83], v[32:35]
    v_mfma_f32_16x16x32_bf16 v[52:55], a[140:143], v[84:87], v[52:55]
    v_mfma_f32_16x16x32_bf16 v[68:71], v[84:87], v[140:143], v[68:71]
    v_mfma_f32_16x16x32_bf16 v[36:39], a[12:15], v[84:87], v[36:39]
    s_xor_b32 s56, s66, 16384
    buffer_load_dwordx4 v[80:83], v0, s[8:11], s56 offen offset:0 sc1
    buffer_load_dwordx4 v[84:87], v0, s[8:11], s56 offen offset:1024 sc1
    s_waitcnt vmcnt(12)
    v_mfma_f32_16x16x32_bf16 v[40:43], a[144:147], v[88:91], v[40:43]
    v_mfma_f32_16x16x32_bf16 v[56:59], v[88:91], v[144:147], v[56:59]
    v_mfma_f32_16x16x32_bf16 v[24:27], a[16:19], v[88:91], v[24:27]
    v_mfma_f32_16x16x32_bf16 v[44:47], a[144:147], v[92:95], v[44:47]
    v_mfma_f32_16x16x32_bf16 v[60:63], v[92:95], v[144:147], v[60:63]
    v_mfma_f32_16x16x32_bf16 v[28:31], a[16:19], v[92:95], v[28:31]
    v_mfma_f32_16x16x32_bf16 v[48:51], a[152:155], v[88:91], v[48:51]
    v_mfma_f32_16x16x32_bf16 v[64:67], v[88:91], v[152:155], v[64:67]
    v_mfma_f32_16x16x32_bf16 v[32:35], a[24:27], v[88:91], v[32:35]
    v_mfma_f32_16x16x32_bf16 v[52:55], a[152:155], v[92:95], v[52:55]
    v_mfma_f32_16x16x32_bf16 v[68:71], v[92:95], v[152:155], v[68:71]
    v_mfma_f32_16x16x32_bf16 v[36:39], a[24:27], v[92:95], v[36:39]
    buffer_load_dwordx4 v[88:91], v0, s[8:11], s56 offen offset:2048 sc1
    buffer_load_dwordx4 v[92:95], v0, s[8:11], s56 offen offset:3072 sc1
    s_waitcnt vmcnt(12)
    v_mfma_f32_16x16x32_bf16 v[40:43], a[148:151], v[96:99], v[40:43]
    v_mfma_f32_16x16x32_bf16 v[56:59], v[96:99], v[148:151], v[56:59]
    v_mfma_f32_16x16x32_bf16 v[24:27], a[20:23], v[96:99], v[24:27]
    v_mfma_f32_16x16x32_bf16 v[44:47], a[148:151], v[100:103], v[44:47]
    v_mfma_f32_16x16x32_bf16 v[60:63], v[100:103], v[148:151], v[60:63]
    v_mfma_f32_16x16x32_bf16 v[28:31], a[20:23], v[100:103], v[28:31]
    v_mfma_f32_16x16x32_bf16 v[48:51], a[156:159], v[96:99], v[48:51]
    v_mfma_f32_16x16x32_bf16 v[64:67], v[96:99], v[156:159], v[64:67]
    v_mfma_f32_16x16x32_bf16 v[32:35], a[28:31], v[96:99], v[32:35]
    v_mfma_f32_16x16x32_bf16 v[52:55], a[156:159], v[100:103], v[52:55]
    v_mfma_f32_16x16x32_bf16 v[68:71], v[100:103], v[156:159], v[68:71]
    v_mfma_f32_16x16x32_bf16 v[36:39], a[28:31], v[100:103], v[36:39]
    s_xor_b32 s56, s66, 20480
    buffer_load_dwordx4 v[96:99], v0, s[8:11], s56 offen offset:0 sc1
    buffer_load_dwordx4 v[100:103], v0, s[8:11], s56 offen offset:1024 sc1
    s_waitcnt vmcnt(12)
    v_mfma_f32_16x16x32_bf16 v[40:43], a[160:163], v[104:107], v[40:43]
    v_mfma_f32_16x16x32_bf16 v[56:59], v[104:107], v[160:163], v[56:59]
    v_mfma_f32_16x16x32_bf16 v[24:27], a[32:35], v[104:107], v[24:27]
    v_mfma_f32_16x16x32_bf16 v[44:47], a[160:163], v[108:111], v[44:47]
    v_mfma_f32_16x16x32_bf16 v[60:63], v[108:111], v[160:163], v[60:63]
    v_mfma_f32_16x16x32_bf16 v[28:31], a[32:35], v[108:111], v[28:31]
    v_mfma_f32_16x16x32_bf16 v[48:51], a[168:171], v[104:107], v[48:51]
    v_mfma_f32_16x16x32_bf16 v[64:67], v[104:107], v[168:171], v[64:67]
    v_mfma_f32_16x16x32_bf16 v[32:35], a[40:43], v[104:107], v[32:35]
    v_mfma_f32_16x16x32_bf16 v[52:55], a[168:171], v[108:111], v[52:55]
    v_mfma_f32_16x16x32_bf16 v[68:71], v[108:111], v[168:171], v[68:71]
    v_mfma_f32_16x16x32_bf16 v[36:39], a[40:43], v[108:111], v[36:39]
    buffer_load_dwordx4 v[104:107], v0, s[8:11], s56 offen offset:2048 sc1
    buffer_load_dwordx4 v[108:111], v0, s[8:11], s56 offen offset:3072 sc1
    s_waitcnt vmcnt(12)
    v_mfma_f32_16x16x32_bf16 v[40:43], a[164:167], v[112:115], v[40:43]
    v_mfma_f32_16x16x32_bf16 v[56:59], v[112:115], v[164:167], v[56:59]
    v_mfma_f32_16x16x32_bf16 v[24:27], a[36:39], v[112:115], v[24:27]
    v_mfma_f32_16x16x32_bf16 v[44:47], a[164:167], v[116:119], v[44:47]
    v_mfma_f32_16x16x32_bf16 v[60:63], v[116:119], v[164:167], v[60:63]
    v_mfma_f32_16x16x32_bf16 v[28:31], a[36:39], v[116:119], v[28:31]
    v_mfma_f32_16x16x32_bf16 v[48:51], a[172:175], v[112:115], v[48:51]
    v_mfma_f32_16x16x32_bf16 v[64:67], v[112:115], v[172:175], v[64:67]
    v_mfma_f32_16x16x32_bf16 v[32:35], a[44:47], v[112:115], v[32:35]
    v_mfma_f32_16x16x32_bf16 v[52:55], a[172:175], v[116:119], v[52:55]
    v_mfma_f32_16x16x32_bf16 v[68:71], v[116:119], v[172:175], v[68:71]
    v_mfma_f32_16x16x32_bf16 v[36:39], a[44:47], v[116:119], v[36:39]
    s_xor_b32 s56, s66, 24576
    buffer_load_dwordx4 v[112:115], v0, s[8:11], s56 offen offset:0 sc1
    buffer_load_dwordx4 v[116:119], v0, s[8:11], s56 offen offset:1024 sc1
    s_waitcnt vmcnt(12)
    v_mfma_f32_16x16x32_bf16 v[40:43], a[176:179], v[120:123], v[40:43]
    v_mfma_f32_16x16x32_bf16 v[56:59], v[120:123], v[176:179], v[56:59]
    v_mfma_f32_16x16x32_bf16 v[24:27], a[48:51], v[120:123], v[24:27]
    v_mfma_f32_16x16x32_bf16 v[44:47], a[176:179], v[124:127], v[44:47]
    v_mfma_f32_16x16x32_bf16 v[60:63], v[124:127], v[176:179], v[60:63]
    v_mfma_f32_16x16x32_bf16 v[28:31], a[48:51], v[124:127], v[28:31]
    v_mfma_f32_16x16x32_bf16 v[48:51], a[184:187], v[120:123], v[48:51]
    v_mfma_f32_16x16x32_bf16 v[64:67], v[120:123], v[184:187], v[64:67]
    v_mfma_f32_16x16x32_bf16 v[32:35], a[56:59], v[120:123], v[32:35]
    v_mfma_f32_16x16x32_bf16 v[52:55], a[184:187], v[124:127], v[52:55]
    v_mfma_f32_16x16x32_bf16 v[68:71], v[124:127], v[184:187], v[68:71]
    v_mfma_f32_16x16x32_bf16 v[36:39], a[56:59], v[124:127], v[36:39]
    buffer_load_dwordx4 v[120:123], v0, s[8:11], s56 offen offset:2048 sc1
    buffer_load_dwordx4 v[124:127], v0, s[8:11], s56 offen offset:3072 sc1
    s_waitcnt vmcnt(12)
    v_mfma_f32_16x16x32_bf16 v[40:43], a[180:183], v[72:75], v[40:43]
    v_mfma_f32_16x16x32_bf16 v[56:59], v[72:75], v[180:183], v[56:59]
    v_mfma_f32_16x16x32_bf16 v[24:27], a[52:55], v[72:75], v[24:27]
    v_mfma_f32_16x16x32_bf16 v[44:47], a[180:183], v[76:79], v[44:47]
    v_mfma_f32_16x16x32_bf16 v[60:63], v[76:79], v[180:183], v[60:63]
    v_mfma_f32_16x16x32_bf16 v[28:31], a[52:55], v[76:79], v[28:31]
    v_mfma_f32_16x16x32_bf16 v[48:51], a[188:191], v[72:75], v[48:51]
    v_mfma_f32_16x16x32_bf16 v[64:67], v[72:75], v[188:191], v[64:67]
    v_mfma_f32_16x16x32_bf16 v[32:35], a[60:63], v[72:75], v[32:35]
    v_mfma_f32_16x16x32_bf16 v[52:55], a[188:191], v[76:79], v[52:55]
    v_mfma_f32_16x16x32_bf16 v[68:71], v[76:79], v[188:191], v[68:71]
    v_mfma_f32_16x16x32_bf16 v[36:39], a[60:63], v[76:79], v[36:39]
    s_xor_b32 s56, s66, 28672
    buffer_load_dwordx4 v[72:75], v0, s[8:11], s56 offen offset:0 sc1
    buffer_load_dwordx4 v[76:79], v0, s[8:11], s56 offen offset:1024 sc1
    s_waitcnt vmcnt(12)
    v_mfma_f32_16x16x32_bf16 v[40:43], a[192:195], v[80:83], v[40:43]
    v_mfma_f32_16x16x32_bf16 v[56:59], v[80:83], v[192:195], v[56:59]
    v_mfma_f32_16x16x32_bf16 v[24:27], a[64:67], v[80:83], v[24:27]
    v_mfma_f32_16x16x32_bf16 v[44:47], a[192:195], v[84:87], v[44:47]
    v_mfma_f32_16x16x32_bf16 v[60:63], v[84:87], v[192:195], v[60:63]
    v_mfma_f32_16x16x32_bf16 v[28:31], a[64:67], v[84:87], v[28:31]
    v_mfma_f32_16x16x32_bf16 v[48:51], a[200:203], v[80:83], v[48:51]
    v_mfma_f32_16x16x32_bf16 v[64:67], v[80:83], v[200:203], v[64:67]
    v_mfma_f32_16x16x32_bf16 v[32:35], a[72:75], v[80:83], v[32:35]
    v_mfma_f32_16x16x32_bf16 v[52:55], a[200:203], v[84:87], v[52:55]
    v_mfma_f32_16x16x32_bf16 v[68:71], v[84:87], v[200:203], v[68:71]
    v_mfma_f32_16x16x32_bf16 v[36:39], a[72:75], v[84:87], v[36:39]
    buffer_load_dwordx4 v[80:83], v0, s[8:11], s56 offen offset:2048 sc1
    buffer_load_dwordx4 v[84:87], v0, s[8:11], s56 offen offset:3072 sc1
    s_waitcnt vmcnt(12)
    v_mfma_f32_16x16x32_bf16 v[40:43], a[196:199], v[88:91], v[40:43]
    v_mfma_f32_16x16x32_bf16 v[56:59], v[88:91], v[196:199], v[56:59]
    v_mfma_f32_16x16x32_bf16 v[24:27], a[68:71], v[88:91], v[24:27]
    v_mfma_f32_16x16x32_bf16 v[44:47], a[196:199], v[92:95], v[44:47]
    v_mfma_f32_16x16x32_bf16 v[60:63], v[92:95], v[196:199], v[60:63]
    v_mfma_f32_16x16x32_bf16 v[28:31], a[68:71], v[92:95], v[28:31]
    v_mfma_f32_16x16x32_bf16 v[48:51], a[204:207], v[88:91], v[48:51]
    v_mfma_f32_16x16x32_bf16 v[64:67], v[88:91], v[204:207], v[64:67]
    v_mfma_f32_16x16x32_bf16 v[32:35], a[76:79], v[88:91], v[32:35]
    v_mfma_f32_16x16x32_bf16 v[52:55], a[204:207], v[92:95], v[52:55]
    v_mfma_f32_16x16x32_bf16 v[68:71], v[92:95], v[204:207], v[68:71]
    v_mfma_f32_16x16x32_bf16 v[36:39], a[76:79], v[92:95], v[36:39]
    s_waitcnt vmcnt(10)
    v_mfma_f32_16x16x32_bf16 v[40:43], a[208:211], v[96:99], v[40:43]
    v_mfma_f32_16x16x32_bf16 v[56:59], v[96:99], v[208:211], v[56:59]
    v_mfma_f32_16x16x32_bf16 v[24:27], a[80:83], v[96:99], v[24:27]
    v_mfma_f32_16x16x32_bf16 v[44:47], a[208:211], v[100:103], v[44:47]
    v_mfma_f32_16x16x32_bf16 v[60:63], v[100:103], v[208:211], v[60:63]
    v_mfma_f32_16x16x32_bf16 v[28:31], a[80:83], v[100:103], v[28:31]
    v_mfma_f32_16x16x32_bf16 v[48:51], a[216:219], v[96:99], v[48:51]
    v_mfma_f32_16x16x32_bf16 v[64:67], v[96:99], v[216:219], v[64:67]
    v_mfma_f32_16x16x32_bf16 v[32:35], a[88:91], v[96:99], v[32:35]
    v_mfma_f32_16x16x32_bf16 v[52:55], a[216:219], v[100:103], v[52:55]
    v_mfma_f32_16x16x32_bf16 v[68:71], v[100:103], v[216:219], v[68:71]
    v_mfma_f32_16x16x32_bf16 v[36:39], a[88:91], v[100:103], v[36:39]
    s_waitcnt vmcnt(8)
    v_mfma_f32_16x16x32_bf16 v[40:43], a[212:215], v[104:107], v[40:43]
    v_mfma_f32_16x16x32_bf16 v[56:59], v[104:107], v[212:215], v[56:59]
    v_mfma_f32_16x16x32_bf16 v[24:27], a[84:87], v[104:107], v[24:27]
    v_mfma_f32_16x16x32_bf16 v[44:47], a[212:215], v[108:111], v[44:47]
    v_mfma_f32_16x16x32_bf16 v[60:63], v[108:111], v[212:215], v[60:63]
    v_mfma_f32_16x16x32_bf16 v[28:31], a[84:87], v[108:111], v[28:31]
    v_mfma_f32_16x16x32_bf16 v[48:51], a[220:223], v[104:107], v[48:51]
    v_mfma_f32_16x16x32_bf16 v[64:67], v[104:107], v[220:223], v[64:67]
    v_mfma_f32_16x16x32_bf16 v[32:35], a[92:95], v[104:107], v[32:35]
    v_mfma_f32_16x16x32_bf16 v[52:55], a[220:223], v[108:111], v[52:55]
    v_mfma_f32_16x16x32_bf16 v[68:71], v[108:111], v[220:223], v[68:71]
    v_mfma_f32_16x16x32_bf16 v[36:39], a[92:95], v[108:111], v[36:39]
    s_waitcnt vmcnt(6)
    v_mfma_f32_16x16x32_bf16 v[40:43], a[224:227], v[112:115], v[40:43]
    v_mfma_f32_16x16x32_bf16 v[56:59], v[112:115], v[224:227], v[56:59]
    v_mfma_f32_16x16x32_bf16 v[24:27], a[96:99], v[112:115], v[24:27]
    v_mfma_f32_16x16x32_bf16 v[44:47], a[224:227], v[116:119], v[44:47]
    v_mfma_f32_16x16x32_bf16 v[60:63], v[116:119], v[224:227], v[60:63]
    v_mfma_f32_16x16x32_bf16 v[28:31], a[96:99], v[116:119], v[28:31]
    v_mfma_f32_16x16x32_bf16 v[48:51], a[232:235], v[112:115], v[48:51]
    v_mfma_f32_16x16x32_bf16 v[64:67], v[112:115], v[232:235], v[64:67]
    v_mfma_f32_16x16x32_bf16 v[32:35], a[104:107], v[112:115], v[32:35]
    v_mfma_f32_16x16x32_bf16 v[52:55], a[232:235], v[116:119], v[52:55]
    v_mfma_f32_16x16x32_bf16 v[68:71], v[116:119], v[232:235], v[68:71]
    v_mfma_f32_16x16x32_bf16 v[36:39], a[104:107], v[116:119], v[36:39]
    s_waitcnt vmcnt(4)
    v_mfma_f32_16x16x32_bf16 v[40:43], a[228:231], v[120:123], v[40:43]
    v_mfma_f32_16x16x32_bf16 v[56:59], v[120:123], v[228:231], v[56:59]
    v_mfma_f32_16x16x32_bf16 v[24:27], a[100:103], v[120:123], v[24:27]
    v_mfma_f32_16x16x32_bf16 v[44:47], a[228:231], v[124:127], v[44:47]
    v_mfma_f32_16x16x32_bf16 v[60:63], v[124:127], v[228:231], v[60:63]
    v_mfma_f32_16x16x32_bf16 v[28:31], a[100:103], v[124:127], v[28:31]
    v_mfma_f32_16x16x32_bf16 v[48:51], a[236:239], v[120:123], v[48:51]
    v_mfma_f32_16x16x32_bf16 v[64:67], v[120:123], v[236:239], v[64:67]
    v_mfma_f32_16x16x32_bf16 v[32:35], a[108:111], v[120:123], v[32:35]
    v_mfma_f32_16x16x32_bf16 v[52:55], a[236:239], v[124:127], v[52:55]
    v_mfma_f32_16x16x32_bf16 v[68:71], v[124:127], v[236:239], v[68:71]
    v_mfma_f32_16x16x32_bf16 v[36:39], a[108:111], v[124:127], v[36:39]
    s_waitcnt vmcnt(2)
    v_mfma_f32_16x16x32_bf16 v[40:43], a[240:243], v[72:75], v[40:43]
    v_mfma_f32_16x16x32_bf16 v[56:59], v[72:75], v[240:243], v[56:59]
    v_mfma_f32_16x16x32_bf16 v[24:27], a[112:115], v[72:75], v[24:27]
    v_mfma_f32_16x16x32_bf16 v[44:47], a[240:243], v[76:79], v[44:47]
    v_mfma_f32_16x16x32_bf16 v[60:63], v[76:79], v[240:243], v[60:63]
    v_mfma_f32_16x16x32_bf16 v[28:31], a[112:115], v[76:79], v[28:31]
    v_mfma_f32_16x16x32_bf16 v[48:51], a[248:251], v[72:75], v[48:51]
    v_mfma_f32_16x16x32_bf16 v[64:67], v[72:75], v[248:251], v[64:67]
    v_mfma_f32_16x16x32_bf16 v[32:35], a[120:123], v[72:75], v[32:35]
    v_mfma_f32_16x16x32_bf16 v[52:55], a[248:251], v[76:79], v[52:55]
    v_mfma_f32_16x16x32_bf16 v[68:71], v[76:79], v[248:251], v[68:71]
    v_mfma_f32_16x16x32_bf16 v[36:39], a[120:123], v[76:79], v[36:39]
    s_waitcnt vmcnt(0)
    v_mfma_f32_16x16x32_bf16 v[40:43], a[244:247], v[80:83], v[40:43]
    v_mfma_f32_16x16x32_bf16 v[56:59], v[80:83], v[244:247], v[56:59]
    v_mfma_f32_16x16x32_bf16 v[24:27], a[116:119], v[80:83], v[24:27]
    v_mfma_f32_16x16x32_bf16 v[44:47], a[244:247], v[84:87], v[44:47]
    v_mfma_f32_16x16x32_bf16 v[60:63], v[84:87], v[244:247], v[60:63]
    v_mfma_f32_16x16x32_bf16 v[28:31], a[116:119], v[84:87], v[28:31]
    v_mfma_f32_16x16x32_bf16 v[48:51], a[252:255], v[80:83], v[48:51]
    v_mfma_f32_16x16x32_bf16 v[64:67], v[80:83], v[252:255], v[64:67]
    v_mfma_f32_16x16x32_bf16 v[32:35], a[124:127], v[80:83], v[32:35]
    v_mfma_f32_16x16x32_bf16 v[52:55], a[252:255], v[84:87], v[52:55]
    v_mfma_f32_16x16x32_bf16 v[68:71], v[84:87], v[252:255], v[68:71]
    v_mfma_f32_16x16x32_bf16 v[36:39], a[124:127], v[84:87], v[36:39]
    v_cvt_pk_bf16_f32 v72, v40, v48
    v_cvt_pk_bf16_f32 v73, v41, v49
    v_cvt_pk_bf16_f32 v74, v42, v50
    v_cvt_pk_bf16_f32 v75, v43, v51
    buffer_store_dwordx4 v[72:75], v0, s[8:11], s61 offen sc1
    v_cvt_pk_bf16_f32 v76, v44, v52
    v_cvt_pk_bf16_f32 v77, v45, v53
    v_cvt_pk_bf16_f32 v78, v46, v54
    v_cvt_pk_bf16_f32 v79, v47, v55
    buffer_store_dwordx4 v[76:79], v0, s[8:11], s62 offen sc1
    v_cvt_pk_bf16_f32 v88, v56, v57
    v_cvt_pk_bf16_f32 v89, v58, v59
    v_cvt_pk_bf16_f32 v90, v60, v61
    v_cvt_pk_bf16_f32 v91, v62, v63
    buffer_store_dwordx4 v[88:91], v0, s[8:11], s65 offen offset:0 sc1
    v_cvt_pk_bf16_f32 v92, v64, v65
    v_cvt_pk_bf16_f32 v93, v66, v67
    v_cvt_pk_bf16_f32 v94, v68, v69
    v_cvt_pk_bf16_f32 v95, v70, v71
    buffer_store_dwordx4 v[92:95], v0, s[8:11], s65 offen offset:1024 sc1
    v_cvt_pk_bf16_f32 v80, v24, v32
    v_cvt_pk_bf16_f32 v81, v25, v33
    v_cvt_pk_bf16_f32 v82, v26, v34
    v_cvt_pk_bf16_f32 v83, v27, v35
    buffer_store_dwordx4 v[80:83], v0, s[8:11], s63 offen sc1
    v_cvt_pk_bf16_f32 v84, v28, v36
    v_cvt_pk_bf16_f32 v85, v29, v37
    v_cvt_pk_bf16_f32 v86, v30, v38
    v_cvt_pk_bf16_f32 v87, v31, v39
    buffer_store_dwordx4 v[84:87], v0, s[8:11], s64 offen sc1
    s_lshl_b32 s59, s51, 13
    s_lshl2_add_u32 s59, s47, s59
    s_add_u32 s59, s59, 10485888
    s_waitcnt vmcnt(0)
    s_barrier
    s_cmp_lg_u32 s46, 0
    s_cbranch_scc1 L_fs_24
    v_mov_b32 v124, 0
    v_mov_b32 v125, 1
    s_mov_b64 exec, 1
    buffer_store_dword v125, v124, s[8:11], s59 offen sc1
    s_mov_b64 exec, -1
L_fs_24:
L_tks_14:
    s_add_u32 s51, s55, 8
    s_cmp_ge_u32 s51, 64
    s_cbranch_scc1 L_tkt_15
    s_lshl_b32 s56, s51, 15
    s_lshl_b32 s57, s46, 12
    s_add_u32 s66, s56, s57
    s_add_u32 s66, s66, 0
    s_xor_b32 s56, s66, 0
    buffer_load_dwordx4 v[72:75], v0, s[8:11], s56 offen offset:0 sc1
    buffer_load_dwordx4 v[76:79], v0, s[8:11], s56 offen offset:1024 sc1
    buffer_load_dwordx4 v[80:83], v0, s[8:11], s56 offen offset:2048 sc1
    buffer_load_dwordx4 v[84:87], v0, s[8:11], s56 offen offset:3072 sc1
    s_xor_b32 s56, s66, 4096
    buffer_load_dwordx4 v[88:91], v0, s[8:11], s56 offen offset:0 sc1
    buffer_load_dwordx4 v[92:95], v0, s[8:11], s56 offen offset:1024 sc1
    buffer_load_dwordx4 v[96:99], v0, s[8:11], s56 offen offset:2048 sc1
    buffer_load_dwordx4 v[100:103], v0, s[8:11], s56 offen offset:3072 sc1
    s_xor_b32 s56, s66, 8192
    buffer_load_dwordx4 v[104:107], v0, s[8:11], s56 offen offset:0 sc1
    buffer_load_dwordx4 v[108:111], v0, s[8:11], s56 offen offset:1024 sc1
    buffer_load_dwordx4 v[112:115], v0, s[8:11], s56 offen offset:2048 sc1
    buffer_load_dwordx4 v[116:119], v0, s[8:11], s56 offen offset:3072 sc1
    s_xor_b32 s56, s66, 12288
    buffer_load_dwordx4 v[120:123], v0, s[8:11], s56 offen offset:0 sc1
    buffer_load_dwordx4 v[124:127], v0, s[8:11], s56 offen offset:1024 sc1
    s_lshl_b32 s58, s51, 5
    s_add_u32 s58, s58, s47
    s_mul_i32 s58, s58, 24576
    s_add_u32 s58, s58, 100663296
    s_lshl_b32 s60, s46, 10
    s_add_u32 s61, s58, s60
    s_add_u32 s62, s61, 4096
    s_add_u32 s63, s61, 16384
    s_add_u32 s64, s61, 20480
    s_add_u32 s65, s61, s60
    s_add_u32 s65, s65, 8192
    s_waitcnt vmcnt(12)
    v_mfma_f32_16x16x32_bf16 v[40:43], a[128:131], v[72:75], 0
    v_mfma_f32_16x16x32_bf16 v[56:59], v[72:75], v[128:131], 0
    v_mfma_f32_16x16x32_bf16 v[24:27], a[0:3], v[72:75], 0
    v_mfma_f32_16x16x32_bf16 v[44:47], a[128:131], v[76:79], 0
    v_mfma_f32_16x16x32_bf16 v[60:63], v[76:79], v[128:131], 0
    v_mfma_f32_16x16x32_bf16 v[28:31], a[0:3], v[76:79], 0
    v_mfma_f32_16x16x32_bf16 v[48:51], a[136:139], v[72:75], 0
    v_mfma_f32_16x16x32_bf16 v[64:67], v[72:75], v[136:139], 0
    v_mfma_f32_16x16x32_bf16 v[32:35], a[8:11], v[72:75], 0
    v_mfma_f32_16x16x32_bf16 v[52:55], a[136:139], v[76:79], 0
    v_mfma_f32_16x16x32_bf16 v[68:71], v[76:79], v[136:139], 0
    v_mfma_f32_16x16x32_bf16 v[36:39], a[8:11], v[76:79], 0
    buffer_load_dwordx4 v[72:75], v0, s[8:11], s56 offen offset:2048 sc1
    buffer_load_dwordx4 v[76:79], v0, s[8:11], s56 offen offset:3072 sc1
    s_waitcnt vmcnt(12)
    v_mfma_f32_16x16x32_bf16 v[40:43], a[132:135], v[80:83], v[40:43]
    v_mfma_f32_16x16x32_bf16 v[56:59], v[80:83], v[132:135], v[56:59]
    v_mfma_f32_16x16x32_bf16 v[24:27], a[4:7], v[80:83], v[24:27]
    v_mfma_f32_16x16x32_bf16 v[44:47], a[132:135], v[84:87], v[44:47]
    v_mfma_f32_16x16x32_bf16 v[60:63], v[84:87], v[132:135], v[60:63]
    v_mfma_f32_16x16x32_bf16 v[28:31], a[4:7], v[84:87], v[28:31]
    v_mfma_f32_16x16x32_bf16 v[48:51], a[140:143], v[80:83], v[48:51]
    v_mfma_f32_16x16x32_bf16 v[64:67], v[80:83], v[140:143], v[64:67]
    v_mfma_f32_16x16x32_bf16 v[32:35], a[12:15], v[80:83], v[32:35]
    v_mfma_f32_16x16x32_bf16 v[52:55], a[140:143], v[84:87], v[52:55]
    v_mfma_f32_16x16x32_bf16 v[68:71], v[84:87], v[140:143], v[68:71]
    v_mfma_f32_16x16x32_bf16 v[36:39], a[12:15], v[84:87], v[36:39]
    s_xor_b32 s56, s66, 16384
    buffer_load_dwordx4 v[80:83], v0, s[8:11], s56 offen offset:0 sc1
    buffer_load_dwordx4 v[84:87], v0, s[8:11], s56 offen offset:1024 sc1
    s_waitcnt vmcnt(12)
    v_mfma_f32_16x16x32_bf16 v[40:43], a[144:147], v[88:91], v[40:43]
    v_mfma_f32_16x16x32_bf16 v[56:59], v[88:91], v[144:147], v[56:59]
    v_mfma_f32_16x16x32_bf16 v[24:27], a[16:19], v[88:91], v[24:27]
    v_mfma_f32_16x16x32_bf16 v[44:47], a[144:147], v[92:95], v[44:47]
    v_mfma_f32_16x16x32_bf16 v[60:63], v[92:95], v[144:147], v[60:63]
    v_mfma_f32_16x16x32_bf16 v[28:31], a[16:19], v[92:95], v[28:31]
    v_mfma_f32_16x16x32_bf16 v[48:51], a[152:155], v[88:91], v[48:51]
    v_mfma_f32_16x16x32_bf16 v[64:67], v[88:91], v[152:155], v[64:67]
    v_mfma_f32_16x16x32_bf16 v[32:35], a[24:27], v[88:91], v[32:35]
    v_mfma_f32_16x16x32_bf16 v[52:55], a[152:155], v[92:95], v[52:55]
    v_mfma_f32_16x16x32_bf16 v[68:71], v[92:95], v[152:155], v[68:71]
    v_mfma_f32_16x16x32_bf16 v[36:39], a[24:27], v[92:95], v[36:39]
    buffer_load_dwordx4 v[88:91], v0, s[8:11], s56 offen offset:2048 sc1
    buffer_load_dwordx4 v[92:95], v0, s[8:11], s56 offen offset:3072 sc1
    s_waitcnt vmcnt(12)
    v_mfma_f32_16x16x32_bf16 v[40:43], a[148:151], v[96:99], v[40:43]
    v_mfma_f32_16x16x32_bf16 v[56:59], v[96:99], v[148:151], v[56:59]
    v_mfma_f32_16x16x32_bf16 v[24:27], a[20:23], v[96:99], v[24:27]
    v_mfma_f32_16x16x32_bf16 v[44:47], a[148:151], v[100:103], v[44:47]
    v_mfma_f32_16x16x32_bf16 v[60:63], v[100:103], v[148:151], v[60:63]
    v_mfma_f32_16x16x32_bf16 v[28:31], a[20:23], v[100:103], v[28:31]
    v_mfma_f32_16x16x32_bf16 v[48:51], a[156:159], v[96:99], v[48:51]
    v_mfma_f32_16x16x32_bf16 v[64:67], v[96:99], v[156:159], v[64:67]
    v_mfma_f32_16x16x32_bf16 v[32:35], a[28:31], v[96:99], v[32:35]
    v_mfma_f32_16x16x32_bf16 v[52:55], a[156:159], v[100:103], v[52:55]
    v_mfma_f32_16x16x32_bf16 v[68:71], v[100:103], v[156:159], v[68:71]
    v_mfma_f32_16x16x32_bf16 v[36:39], a[28:31], v[100:103], v[36:39]
    s_xor_b32 s56, s66, 20480
    buffer_load_dwordx4 v[96:99], v0, s[8:11], s56 offen offset:0 sc1
    buffer_load_dwordx4 v[100:103], v0, s[8:11], s56 offen offset:1024 sc1
    s_waitcnt vmcnt(12)
    v_mfma_f32_16x16x32_bf16 v[40:43], a[160:163], v[104:107], v[40:43]
    v_mfma_f32_16x16x32_bf16 v[56:59], v[104:107], v[160:163], v[56:59]
    v_mfma_f32_16x16x32_bf16 v[24:27], a[32:35], v[104:107], v[24:27]
    v_mfma_f32_16x16x32_bf16 v[44:47], a[160:163], v[108:111], v[44:47]
    v_mfma_f32_16x16x32_bf16 v[60:63], v[108:111], v[160:163], v[60:63]
    v_mfma_f32_16x16x32_bf16 v[28:31], a[32:35], v[108:111], v[28:31]
    v_mfma_f32_16x16x32_bf16 v[48:51], a[168:171], v[104:107], v[48:51]
    v_mfma_f32_16x16x32_bf16 v[64:67], v[104:107], v[168:171], v[64:67]
    v_mfma_f32_16x16x32_bf16 v[32:35], a[40:43], v[104:107], v[32:35]
    v_mfma_f32_16x16x32_bf16 v[52:55], a[168:171], v[108:111], v[52:55]
    v_mfma_f32_16x16x32_bf16 v[68:71], v[108:111], v[168:171], v[68:71]
    v_mfma_f32_16x16x32_bf16 v[36:39], a[40:43], v[108:111], v[36:39]
    buffer_load_dwordx4 v[104:107], v0, s[8:11], s56 offen offset:2048 sc1
    buffer_load_dwordx4 v[108:111], v0, s[8:11], s56 offen offset:3072 sc1
    s_waitcnt vmcnt(12)
    v_mfma_f32_16x16x32_bf16 v[40:43], a[164:167], v[112:115], v[40:43]
    v_mfma_f32_16x16x32_bf16 v[56:59], v[112:115], v[164:167], v[56:59]
    v_mfma_f32_16x16x32_bf16 v[24:27], a[36:39], v[112:115], v[24:27]
    v_mfma_f32_16x16x32_bf16 v[44:47], a[164:167], v[116:119], v[44:47]
    v_mfma_f32_16x16x32_bf16 v[60:63], v[116:119], v[164:167], v[60:63]
    v_mfma_f32_16x16x32_bf16 v[28:31], a[36:39], v[116:119], v[28:31]
    v_mfma_f32_16x16x32_bf16 v[48:51], a[172:175], v[112:115], v[48:51]
    v_mfma_f32_16x16x32_bf16 v[64:67], v[112:115], v[172:175], v[64:67]
    v_mfma_f32_16x16x32_bf16 v[32:35], a[44:47], v[112:115], v[32:35]
    v_mfma_f32_16x16x32_bf16 v[52:55], a[172:175], v[116:119], v[52:55]
    v_mfma_f32_16x16x32_bf16 v[68:71], v[116:119], v[172:175], v[68:71]
    v_mfma_f32_16x16x32_bf16 v[36:39], a[44:47], v[116:119], v[36:39]
    s_xor_b32 s56, s66, 24576
    buffer_load_dwordx4 v[112:115], v0, s[8:11], s56 offen offset:0 sc1
    buffer_load_dwordx4 v[116:119], v0, s[8:11], s56 offen offset:1024 sc1
    s_waitcnt vmcnt(12)
    v_mfma_f32_16x16x32_bf16 v[40:43], a[176:179], v[120:123], v[40:43]
    v_mfma_f32_16x16x32_bf16 v[56:59], v[120:123], v[176:179], v[56:59]
    v_mfma_f32_16x16x32_bf16 v[24:27], a[48:51], v[120:123], v[24:27]
    v_mfma_f32_16x16x32_bf16 v[44:47], a[176:179], v[124:127], v[44:47]
    v_mfma_f32_16x16x32_bf16 v[60:63], v[124:127], v[176:179], v[60:63]
    v_mfma_f32_16x16x32_bf16 v[28:31], a[48:51], v[124:127], v[28:31]
    v_mfma_f32_16x16x32_bf16 v[48:51], a[184:187], v[120:123], v[48:51]
    v_mfma_f32_16x16x32_bf16 v[64:67], v[120:123], v[184:187], v[64:67]
    v_mfma_f32_16x16x32_bf16 v[32:35], a[56:59], v[120:123], v[32:35]
    v_mfma_f32_16x16x32_bf16 v[52:55], a[184:187], v[124:127], v[52:55]
    v_mfma_f32_16x16x32_bf16 v[68:71], v[124:127], v[184:187], v[68:71]
    v_mfma_f32_16x16x32_bf16 v[36:39], a[56:59], v[124:127], v[36:39]
    buffer_load_dwordx4 v[120:123], v0, s[8:11], s56 offen offset:2048 sc1
    buffer_load_dwordx4 v[124:127], v0, s[8:11], s56 offen offset:3072 sc1
    s_waitcnt vmcnt(12)
    v_mfma_f32_16x16x32_bf16 v[40:43], a[180:183], v[72:75], v[40:43]
    v_mfma_f32_16x16x32_bf16 v[56:59], v[72:75], v[180:183], v[56:59]
    v_mfma_f32_16x16x32_bf16 v[24:27], a[52:55], v[72:75], v[24:27]
    v_mfma_f32_16x16x32_bf16 v[44:47], a[180:183], v[76:79], v[44:47]
    v_mfma_f32_16x16x32_bf16 v[60:63], v[76:79], v[180:183], v[60:63]
    v_mfma_f32_16x16x32_bf16 v[28:31], a[52:55], v[76:79], v[28:31]
    v_mfma_f32_16x16x32_bf16 v[48:51], a[188:191], v[72:75], v[48:51]
    v_mfma_f32_16x16x32_bf16 v[64:67], v[72:75], v[188:191], v[64:67]
    v_mfma_f32_16x16x32_bf16 v[32:35], a[60:63], v[72:75], v[32:35]
    v_mfma_f32_16x16x32_bf16 v[52:55], a[188:191], v[76:79], v[52:55]
    v_mfma_f32_16x16x32_bf16 v[68:71], v[76:79], v[188:191], v[68:71]
    v_mfma_f32_16x16x32_bf16 v[36:39], a[60:63], v[76:79], v[36:39]
    s_xor_b32 s56, s66, 28672
    buffer_load_dwordx4 v[72:75], v0, s[8:11], s56 offen offset:0 sc1
    buffer_load_dwordx4 v[76:79], v0, s[8:11], s56 offen offset:1024 sc1
    s_waitcnt vmcnt(12)
    v_mfma_f32_16x16x32_bf16 v[40:43], a[192:195], v[80:83], v[40:43]
    v_mfma_f32_16x16x32_bf16 v[56:59], v[80:83], v[192:195], v[56:59]
    v_mfma_f32_16x16x32_bf16 v[24:27], a[64:67], v[80:83], v[24:27]
    v_mfma_f32_16x16x32_bf16 v[44:47], a[192:195], v[84:87], v[44:47]
    v_mfma_f32_16x16x32_bf16 v[60:63], v[84:87], v[192:195], v[60:63]
    v_mfma_f32_16x16x32_bf16 v[28:31], a[64:67], v[84:87], v[28:31]
    v_mfma_f32_16x16x32_bf16 v[48:51], a[200:203], v[80:83], v[48:51]
    v_mfma_f32_16x16x32_bf16 v[64:67], v[80:83], v[200:203], v[64:67]
    v_mfma_f32_16x16x32_bf16 v[32:35], a[72:75], v[80:83], v[32:35]
    v_mfma_f32_16x16x32_bf16 v[52:55], a[200:203], v[84:87], v[52:55]
    v_mfma_f32_16x16x32_bf16 v[68:71], v[84:87], v[200:203], v[68:71]
    v_mfma_f32_16x16x32_bf16 v[36:39], a[72:75], v[84:87], v[36:39]
    buffer_load_dwordx4 v[80:83], v0, s[8:11], s56 offen offset:2048 sc1
    buffer_load_dwordx4 v[84:87], v0, s[8:11], s56 offen offset:3072 sc1
    s_waitcnt vmcnt(12)
    v_mfma_f32_16x16x32_bf16 v[40:43], a[196:199], v[88:91], v[40:43]
    v_mfma_f32_16x16x32_bf16 v[56:59], v[88:91], v[196:199], v[56:59]
    v_mfma_f32_16x16x32_bf16 v[24:27], a[68:71], v[88:91], v[24:27]
    v_mfma_f32_16x16x32_bf16 v[44:47], a[196:199], v[92:95], v[44:47]
    v_mfma_f32_16x16x32_bf16 v[60:63], v[92:95], v[196:199], v[60:63]
    v_mfma_f32_16x16x32_bf16 v[28:31], a[68:71], v[92:95], v[28:31]
    v_mfma_f32_16x16x32_bf16 v[48:51], a[204:207], v[88:91], v[48:51]
    v_mfma_f32_16x16x32_bf16 v[64:67], v[88:91], v[204:207], v[64:67]
    v_mfma_f32_16x16x32_bf16 v[32:35], a[76:79], v[88:91], v[32:35]
    v_mfma_f32_16x16x32_bf16 v[52:55], a[204:207], v[92:95], v[52:55]
    v_mfma_f32_16x16x32_bf16 v[68:71], v[92:95], v[204:207], v[68:71]
    v_mfma_f32_16x16x32_bf16 v[36:39], a[76:79], v[92:95], v[36:39]
    s_waitcnt vmcnt(10)
    v_mfma_f32_16x16x32_bf16 v[40:43], a[208:211], v[96:99], v[40:43]
    v_mfma_f32_16x16x32_bf16 v[56:59], v[96:99], v[208:211], v[56:59]
    v_mfma_f32_16x16x32_bf16 v[24:27], a[80:83], v[96:99], v[24:27]
    v_mfma_f32_16x16x32_bf16 v[44:47], a[208:211], v[100:103], v[44:47]
    v_mfma_f32_16x16x32_bf16 v[60:63], v[100:103], v[208:211], v[60:63]
    v_mfma_f32_16x16x32_bf16 v[28:31], a[80:83], v[100:103], v[28:31]
    v_mfma_f32_16x16x32_bf16 v[48:51], a[216:219], v[96:99], v[48:51]
    v_mfma_f32_16x16x32_bf16 v[64:67], v[96:99], v[216:219], v[64:67]
    v_mfma_f32_16x16x32_bf16 v[32:35], a[88:91], v[96:99], v[32:35]
    v_mfma_f32_16x16x32_bf16 v[52:55], a[216:219], v[100:103], v[52:55]
    v_mfma_f32_16x16x32_bf16 v[68:71], v[100:103], v[216:219], v[68:71]
    v_mfma_f32_16x16x32_bf16 v[36:39], a[88:91], v[100:103], v[36:39]
    s_waitcnt vmcnt(8)
    v_mfma_f32_16x16x32_bf16 v[40:43], a[212:215], v[104:107], v[40:43]
    v_mfma_f32_16x16x32_bf16 v[56:59], v[104:107], v[212:215], v[56:59]
    v_mfma_f32_16x16x32_bf16 v[24:27], a[84:87], v[104:107], v[24:27]
    v_mfma_f32_16x16x32_bf16 v[44:47], a[212:215], v[108:111], v[44:47]
    v_mfma_f32_16x16x32_bf16 v[60:63], v[108:111], v[212:215], v[60:63]
    v_mfma_f32_16x16x32_bf16 v[28:31], a[84:87], v[108:111], v[28:31]
    v_mfma_f32_16x16x32_bf16 v[48:51], a[220:223], v[104:107], v[48:51]
    v_mfma_f32_16x16x32_bf16 v[64:67], v[104:107], v[220:223], v[64:67]
    v_mfma_f32_16x16x32_bf16 v[32:35], a[92:95], v[104:107], v[32:35]
    v_mfma_f32_16x16x32_bf16 v[52:55], a[220:223], v[108:111], v[52:55]
    v_mfma_f32_16x16x32_bf16 v[68:71], v[108:111], v[220:223], v[68:71]
    v_mfma_f32_16x16x32_bf16 v[36:39], a[92:95], v[108:111], v[36:39]
    s_waitcnt vmcnt(6)
    v_mfma_f32_16x16x32_bf16 v[40:43], a[224:227], v[112:115], v[40:43]
    v_mfma_f32_16x16x32_bf16 v[56:59], v[112:115], v[224:227], v[56:59]
    v_mfma_f32_16x16x32_bf16 v[24:27], a[96:99], v[112:115], v[24:27]
    v_mfma_f32_16x16x32_bf16 v[44:47], a[224:227], v[116:119], v[44:47]
    v_mfma_f32_16x16x32_bf16 v[60:63], v[116:119], v[224:227], v[60:63]
    v_mfma_f32_16x16x32_bf16 v[28:31], a[96:99], v[116:119], v[28:31]
    v_mfma_f32_16x16x32_bf16 v[48:51], a[232:235], v[112:115], v[48:51]
    v_mfma_f32_16x16x32_bf16 v[64:67], v[112:115], v[232:235], v[64:67]
    v_mfma_f32_16x16x32_bf16 v[32:35], a[104:107], v[112:115], v[32:35]
    v_mfma_f32_16x16x32_bf16 v[52:55], a[232:235], v[116:119], v[52:55]
    v_mfma_f32_16x16x32_bf16 v[68:71], v[116:119], v[232:235], v[68:71]
    v_mfma_f32_16x16x32_bf16 v[36:39], a[104:107], v[116:119], v[36:39]
    s_waitcnt vmcnt(4)
    v_mfma_f32_16x16x32_bf16 v[40:43], a[228:231], v[120:123], v[40:43]
    v_mfma_f32_16x16x32_bf16 v[56:59], v[120:123], v[228:231], v[56:59]
    v_mfma_f32_16x16x32_bf16 v[24:27], a[100:103], v[120:123], v[24:27]
    v_mfma_f32_16x16x32_bf16 v[44:47], a[228:231], v[124:127], v[44:47]
    v_mfma_f32_16x16x32_bf16 v[60:63], v[124:127], v[228:231], v[60:63]
    v_mfma_f32_16x16x32_bf16 v[28:31], a[100:103], v[124:127], v[28:31]
    v_mfma_f32_16x16x32_bf16 v[48:51], a[236:239], v[120:123], v[48:51]
    v_mfma_f32_16x16x32_bf16 v[64:67], v[120:123], v[236:239], v[64:67]
    v_mfma_f32_16x16x32_bf16 v[32:35], a[108:111], v[120:123], v[32:35]
    v_mfma_f32_16x16x32_bf16 v[52:55], a[236:239], v[124:127], v[52:55]
    v_mfma_f32_16x16x32_bf16 v[68:71], v[124:127], v[236:239], v[68:71]
    v_mfma_f32_16x16x32_bf16 v[36:39], a[108:111], v[124:127], v[36:39]
    s_waitcnt vmcnt(2)
    v_mfma_f32_16x16x32_bf16 v[40:43], a[240:243], v[72:75], v[40:43]
    v_mfma_f32_16x16x32_bf16 v[56:59], v[72:75], v[240:243], v[56:59]
    v_mfma_f32_16x16x32_bf16 v[24:27], a[112:115], v[72:75], v[24:27]
    v_mfma_f32_16x16x32_bf16 v[44:47], a[240:243], v[76:79], v[44:47]
    v_mfma_f32_16x16x32_bf16 v[60:63], v[76:79], v[240:243], v[60:63]
    v_mfma_f32_16x16x32_bf16 v[28:31], a[112:115], v[76:79], v[28:31]
    v_mfma_f32_16x16x32_bf16 v[48:51], a[248:251], v[72:75], v[48:51]
    v_mfma_f32_16x16x32_bf16 v[64:67], v[72:75], v[248:251], v[64:67]
    v_mfma_f32_16x16x32_bf16 v[32:35], a[120:123], v[72:75], v[32:35]
    v_mfma_f32_16x16x32_bf16 v[52:55], a[248:251], v[76:79], v[52:55]
    v_mfma_f32_16x16x32_bf16 v[68:71], v[76:79], v[248:251], v[68:71]
    v_mfma_f32_16x16x32_bf16 v[36:39], a[120:123], v[76:79], v[36:39]
    s_waitcnt vmcnt(0)
    v_mfma_f32_16x16x32_bf16 v[40:43], a[244:247], v[80:83], v[40:43]
    v_mfma_f32_16x16x32_bf16 v[56:59], v[80:83], v[244:247], v[56:59]
    v_mfma_f32_16x16x32_bf16 v[24:27], a[116:119], v[80:83], v[24:27]
    v_mfma_f32_16x16x32_bf16 v[44:47], a[244:247], v[84:87], v[44:47]
    v_mfma_f32_16x16x32_bf16 v[60:63], v[84:87], v[244:247], v[60:63]
    v_mfma_f32_16x16x32_bf16 v[28:31], a[116:119], v[84:87], v[28:31]
    v_mfma_f32_16x16x32_bf16 v[48:51], a[252:255], v[80:83], v[48:51]
    v_mfma_f32_16x16x32_bf16 v[64:67], v[80:83], v[252:255], v[64:67]
    v_mfma_f32_16x16x32_bf16 v[32:35], a[124:127], v[80:83], v[32:35]
    v_mfma_f32_16x16x32_bf16 v[52:55], a[252:255], v[84:87], v[52:55]
    v_mfma_f32_16x16x32_bf16 v[68:71], v[84:87], v[252:255], v[68:71]
    v_mfma_f32_16x16x32_bf16 v[36:39], a[124:127], v[84:87], v[36:39]
    v_cvt_pk_bf16_f32 v72, v40, v48
    v_cvt_pk_bf16_f32 v73, v41, v49
    v_cvt_pk_bf16_f32 v74, v42, v50
    v_cvt_pk_bf16_f32 v75, v43, v51
    buffer_store_dwordx4 v[72:75], v0, s[8:11], s61 offen sc1
    v_cvt_pk_bf16_f32 v76, v44, v52
    v_cvt_pk_bf16_f32 v77, v45, v53
    v_cvt_pk_bf16_f32 v78, v46, v54
    v_cvt_pk_bf16_f32 v79, v47, v55
    buffer_store_dwordx4 v[76:79], v0, s[8:11], s62 offen sc1
    v_cvt_pk_bf16_f32 v88, v56, v57
    v_cvt_pk_bf16_f32 v89, v58, v59
    v_cvt_pk_bf16_f32 v90, v60, v61
    v_cvt_pk_bf16_f32 v91, v62, v63
    buffer_store_dwordx4 v[88:91], v0, s[8:11], s65 offen offset:0 sc1
    v_cvt_pk_bf16_f32 v92, v64, v65
    v_cvt_pk_bf16_f32 v93, v66, v67
    v_cvt_pk_bf16_f32 v94, v68, v69
    v_cvt_pk_bf16_f32 v95, v70, v71
    buffer_store_dwordx4 v[92:95], v0, s[8:11], s65 offen offset:1024 sc1
    v_cvt_pk_bf16_f32 v80, v24, v32
    v_cvt_pk_bf16_f32 v81, v25, v33
    v_cvt_pk_bf16_f32 v82, v26, v34
    v_cvt_pk_bf16_f32 v83, v27, v35
    buffer_store_dwordx4 v[80:83], v0, s[8:11], s63 offen sc1
    v_cvt_pk_bf16_f32 v84, v28, v36
    v_cvt_pk_bf16_f32 v85, v29, v37
    v_cvt_pk_bf16_f32 v86, v30, v38
    v_cvt_pk_bf16_f32 v87, v31, v39
    buffer_store_dwordx4 v[84:87], v0, s[8:11], s64 offen sc1
    s_lshl_b32 s59, s51, 13
    s_lshl2_add_u32 s59, s47, s59
    s_add_u32 s59, s59, 10485760
    s_waitcnt vmcnt(0)
    s_barrier
    s_cmp_lg_u32 s46, 0
    s_cbranch_scc1 L_fs_25
    v_mov_b32 v124, 0
    v_mov_b32 v125, 1
    s_mov_b64 exec, 1
    buffer_store_dword v125, v124, s[8:11], s59 offen sc1
    s_mov_b64 exec, -1
L_fs_25:
L_tkt_15:
    s_add_u32 s55, s55, 4
    s_cmp_lt_i32 s55, 64
    s_cbranch_scc1 L_tk_13
    s_sub_u32 s51, s48, 3
L_rb_6:
    s_mov_b32 s59, 11011712
    v_mov_b32 v124, 0
L_ww_26:
    buffer_load_dword v125, v124, s[8:11], s59 offen sc1
    s_waitcnt vmcnt(0)
    v_readfirstlane_b32 s55, v125
    s_cmp_lg_u32 s55, 0
    s_cbranch_scc1 L_wwd_27
    s_sleep 2
    s_sub_u32 s49, s49, 1
    s_cmp_gt_i32 s49, 0
    s_cbranch_scc1 L_ww_26
    s_branch L_abort
L_wwd_27:
    s_sub_u32 s55, s55, 1
L_bu_28:
    s_lshr_b32 s56, s55, 5
    s_cmp_lt_u32 s51, s56
    s_cselect_b32 s31, 0, 16777216
    s_cselect_b32 s60, 0, 128
    s_add_u32 s31, s31, 58720256
    s_cmp_eq_u32 s51, s56
    s_cselect_b32 s30, 50331648, 0
    s_add_u32 s30, s30, 150994944
    s_lshl_b32 s59, s51, 13
    s_lshl2_add_u32 s59, s47, s59
    s_add_u32 s59, s59, 10486272
    s_add_u32 s59, s59, s60
    v_mov_b32 v124, 0
L_ww_29:
    buffer_load_dword v125, v124, s[8:11], s59 offen sc1
    s_waitcnt vmcnt(0)
    v_readfirstlane_b32 s61, v125
    s_cmp_lg_u32 s61, 0
    s_cbranch_scc1 L_wwd_30
    s_sleep 1
    s_sub_u32 s49, s49, 1
    s_cmp_gt_i32 s49, 0
    s_cbranch_scc1 L_ww_29
    s_branch L_abort
L_wwd_30:
    s_lshl_b32 s56, s51, 5
    s_add_u32 s56, s56, s47
    s_mul_i32 s56, s56, 24576
    s_add_u32 s56, s56, s30
    s_and_b32 s57, s46, 1
    s_lshl_b32 s57, s57, 12
    s_add_u32 s58, s56, s57
    s_add_u32 s58, s58, 16384
    s_add_u32 s59, s56, 4096
    s_lshr_b32 s57, s46, 1
    s_lshl_b32 s60, s57, 12
    s_add_u32 s60, s60, s56
    s_add_u32 s60, s60, 8192
    s_lshl_b32 s61, s51, 5
    s_add_u32 s61, s61, s47
    s_lshl_b32 s61, s61, 13
    s_add_u32 s61, s61, s31
    s_lshl_b32 s62, s57, 11
    s_add_u32 s62, s62, s61
    s_add_u32 s62, s62, 4096
    buffer_load_dwordx4 v[24:27], v0, s[8:11], s58 offen offset:0 sc1
    buffer_load_dwordx4 v[40:43], v0, s[8:11], s56 offen offset:0 sc1
    buffer_load_dwordx4 v[56:59], v0, s[8:11], s59 offen offset:0 sc1
    buffer_load_dwordx4 v[72:75], v0, s[8:11], s61 offen offset:0 sc1
    buffer_load_dwordx4 v[28:31], v0, s[8:11], s58 offen offset:1024 sc1
    buffer_load_dwordx4 v[44:47], v0, s[8:11], s56 offen offset:1024 sc1
    buffer_load_dwordx4 v[60:63], v0, s[8:11], s59 offen offset:1024 sc1
    buffer_load_dwordx4 v[76:79], v0, s[8:11], s61 offen offset:1024 sc1
    buffer_load_dwordx4 v[32:35], v0, s[8:11], s58 offen offset:2048 sc1
    buffer_load_dwordx4 v[48:51], v0, s[8:11], s56 offen offset:2048 sc1
    buffer_load_dwordx4 v[64:67], v0, s[8:11], s59 offen offset:2048 sc1
    buffer_load_dwordx4 v[80:83], v0, s[8:11], s61 offen offset:2048 sc1
    buffer_load_dwordx4 v[36:39], v0, s[8:11], s58 offen offset:3072 sc1
    buffer_load_dwordx4 v[52:55], v0, s[8:11], s56 offen offset:3072 sc1
    buffer_load_dwordx4 v[68:71], v0, s[8:11], s59 offen offset:3072 sc1
    buffer_load_dwordx4 v[84:87], v0, s[8:11], s61 offen offset:3072 sc1
    buffer_load_dwordx4 v[88:91], v0, s[8:11], s60 offen offset:0 sc1
    buffer_load_dwordx4 v[92:95], v0, s[8:11], s60 offen offset:1024 sc1
    buffer_load_dwordx4 v[96:99], v0, s[8:11], s60 offen offset:2048 sc1
    buffer_load_dwordx4 v[100:103], v0, s[8:11], s60 offen offset:3072 sc1
    buffer_load_dword v104, v0, s[8:11], s62 offen offset:0 sc1
    v_mov_b32 v105, 0
    buffer_load_dword v106, v0, s[8:11], s62 offen offset:4 sc1
    v_mov_b32 v107, 0
    buffer_load_dword v108, v0, s[8:11], s62 offen offset:1024 sc1
    v_mov_b32 v109, 0
    buffer_load_dword v110, v0, s[8:11], s62 offen offset:1028 sc1
    v_mov_b32 v111, 0
    s_waitcnt vmcnt(20)
    v_mfma_f32_16x16x32_bf16 v[112:115], v[40:43], v[24:27], v[8:11]
    v_mfma_f32_16x16x32_bf16 v[116:119], v[56:59], v[24:27], v[12:15]
    v_mfma_f32_16x16x32_bf16 v[120:123], v[72:75], v[24:27], 0
    s_waitcnt vmcnt(16)
    v_mfma_f32_16x16x32_bf16 v[112:115], v[44:47], v[28:31], v[112:115]
    v_mfma_f32_16x16x32_bf16 v[116:119], v[60:63], v[28:31], v[116:119]
    v_mfma_f32_16x16x32_bf16 v[120:123], v[76:79], v[28:31], v[120:123]
    s_waitcnt vmcnt(12)
    v_mfma_f32_16x16x32_bf16 v[112:115], v[48:51], v[32:35], v[112:115]
    v_mfma_f32_16x16x32_bf16 v[116:119], v[64:67], v[32:35], v[116:119]
    v_mfma_f32_16x16x32_bf16 v[120:123], v[80:83], v[32:35], v[120:123]
    s_waitcnt vmcnt(8)
    v_mfma_f32_16x16x32_bf16 v[112:115], v[52:55], v[36:39], v[112:115]
    v_mfma_f32_16x16x32_bf16 v[116:119], v[68:71], v[36:39], v[116:119]
    v_mfma_f32_16x16x32_bf16 v[120:123], v[84:87], v[36:39], v[120:123]
    ds_read_b128 v[56:59], v18 offset:0
    ds_read_b128 v[60:63], v18 offset:4096
    ds_read_b128 v[64:67], v18 offset:1024
    ds_read_b128 v[68:71], v18 offset:5120
    ds_read_b128 v[72:75], v18 offset:2048
    ds_read_b128 v[76:79], v18 offset:6144
    ds_read_b128 v[80:83], v18 offset:3072
    ds_read_b128 v[84:87], v18 offset:7168
    v_max3_f32 v124, v112, v113, v114
    v_max3_f32 v125, v115, v116, v117
    v_max3_f32 v124, v118, v119, v124
    v_max3_f32 v125, v122, v123, v125
    v_max_f32 v124, v124, v125
    v_max_f32 v125, v124, v125
    s_nop 1
    v_permlane16_swap_b32 v124, v125
    v_max_f32 v124, v124, v125
    v_max_f32 v125, v124, v125
    s_nop 1
    v_permlane32_swap_b32 v124, v125
    v_max_f32 v124, v124, v125
    v_mul_f32 v124, s80, v124
    v_fma_f32 v112, v112, s80, -v124
    v_fma_f32 v113, v113, s80, -v124
    v_exp_f32 v112, v112
    v_fma_f32 v114, v114, s80, -v124
    v_exp_f32 v113, v113
    v_fma_f32 v115, v115, s80, -v124
    v_exp_f32 v114, v114
    v_fma_f32 v116, v116, s80, -v124
    v_exp_f32 v115, v115
    v_fma_f32 v117, v117, s80, -v124
    v_exp_f32 v116, v116
    v_fma_f32 v118, v118, s80, -v124
    v_exp_f32 v117, v117
    v_fma_f32 v119, v119, s80, -v124
    v_exp_f32 v118, v118
    v_fma_f32 v122, v122, s80, -v124
    v_exp_f32 v119, v119
    v_fma_f32 v123, v123, s80, -v124
    v_exp_f32 v122, v122
    v_exp_f32 v123, v123
    v_cvt_pk_bf16_f32 v44, v112, v113
    v_cvt_pk_bf16_f32 v45, v114, v115
    v_cvt_pk_bf16_f32 v46, v116, v117
    v_cvt_pk_bf16_f32 v47, v118, v119
    v_cvt_pk_bf16_f32 v48, v122, v123
    v_mov_b32 v52, 0x3f803f80
    v_mov_b32 v53, 0x3f803f80
    v_mov_b32 v54, 0x3f803f80
    v_mov_b32 v55, 0x3f803f80
    v_mov_b32 v49, 0
    s_waitcnt vmcnt(0)
    v_mfma_f32_16x16x32_bf16 v[40:43], v[52:55], v[44:47], 0
    v_mfma_f32_16x16x32_bf16 v[24:27], v[88:91], v[44:47], 0
    v_mfma_f32_16x16x32_bf16 v[28:31], v[92:95], v[44:47], 0
    v_mfma_f32_16x16x32_bf16 v[32:35], v[96:99], v[44:47], 0
    v_mfma_f32_16x16x32_bf16 v[36:39], v[100:103], v[44:47], 0
    v_mfma_f32_16x16x16_bf16 v[40:43], v[52:53], v[48:49], v[40:43]
    v_mfma_f32_16x16x16_bf16 v[24:27], v[104:105], v[48:49], v[24:27]
    v_mfma_f32_16x16x16_bf16 v[28:31], v[106:107], v[48:49], v[28:31]
    v_mfma_f32_16x16x16_bf16 v[32:35], v[108:109], v[48:49], v[32:35]
    v_mfma_f32_16x16x16_bf16 v[36:39], v[110:111], v[48:49], v[36:39]
    v_rcp_f32 v40, v40
    s_nop 0
    v_mov_b32 v41, v40
    v_pk_mul_f32 v[24:25], v[24:25], v[40:41]
    v_pk_mul_f32 v[26:27], v[26:27], v[40:41]
    v_pk_mul_f32 v[28:29], v[28:29], v[40:41]
    v_pk_mul_f32 v[30:31], v[30:31], v[40:41]
    v_cvt_pk_bf16_f32 v112, v24, v28
    v_cvt_pk_bf16_f32 v113, v25, v29
    v_cvt_pk_bf16_f32 v114, v26, v30
    v_cvt_pk_bf16_f32 v115, v27, v31
    ds_write_b128 v16, v[112:115] offset:0
    v_pk_mul_f32 v[32:33], v[32:33], v[40:41]
    v_pk_mul_f32 v[34:35], v[34:35], v[40:41]
    v_pk_mul_f32 v[36:37], v[36:37], v[40:41]
    v_pk_mul_f32 v[38:39], v[38:39], v[40:41]
    v_cvt_pk_bf16_f32 v116, v32, v36
    v_cvt_pk_bf16_f32 v117, v33, v37
    v_cvt_pk_bf16_f32 v118, v34, v38
    v_cvt_pk_bf16_f32 v119, v35, v39
    ds_write_b128 v16, v[116:119] offset:1024
    s_lshl_b32 s56, s47, 10
    s_add_u32 s56, s56, s54
    s_add_u32 s57, s56, 524288
    s_waitcnt lgkmcnt(0)
    s_barrier
    ds_read_b128 v[24:27], v17 offset:0
    ds_read_b128 v[28:31], v17 offset:4096
    ds_read_b128 v[32:35], v17 offset:1024
    ds_read_b128 v[36:39], v17 offset:5120
    ds_read_b128 v[40:43], v17 offset:2048
    ds_read_b128 v[44:47], v17 offset:6144
    ds_read_b128 v[48:51], v17 offset:3072
    ds_read_b128 v[52:55], v17 offset:7168
    s_waitcnt lgkmcnt(6)
    v_mfma_f32_16x16x32_bf16 v[88:91], v[56:59], v[24:27], 0
    v_mfma_f32_16x16x32_bf16 v[92:95], v[56:59], v[28:31], 0
    ds_read_b128 v[56:59], v18 offset:8192
    v_mfma_f32_16x16x32_bf16 v[96:99], v[60:63], v[24:27], 0
    v_mfma_f32_16x16x32_bf16 v[100:103], v[60:63], v[28:31], 0
    ds_read_b128 v[60:63], v18 offset:12288
    s_waitcnt lgkmcnt(6)
    v_mfma_f32_16x16x32_bf16 v[88:91], v[64:67], v[32:35], v[88:91]
    v_mfma_f32_16x16x32_bf16 v[92:95], v[64:67], v[36:39], v[92:95]
    ds_read_b128 v[64:67], v18 offset:9216
    v_mfma_f32_16x16x32_bf16 v[96:99], v[68:71], v[32:35], v[96:99]
    v_mfma_f32_16x16x32_bf16 v[100:103], v[68:71], v[36:39], v[100:103]
    ds_read_b128 v[68:71], v18 offset:13312
    s_waitcnt lgkmcnt(6)
    v_mfma_f32_16x16x32_bf16 v[88:91], v[72:75], v[40:43], v[88:91]
    v_mfma_f32_16x16x32_bf16 v[92:95], v[72:75], v[44:47], v[92:95]
    ds_read_b128 v[72:75], v18 offset:10240
    v_mfma_f32_16x16x32_bf16 v[96:99], v[76:79], v[40:43], v[96:99]
    v_mfma_f32_16x16x32_bf16 v[100:103], v[76:79], v[44:47], v[100:103]
    ds_read_b128 v[76:79], v18 offset:14336
    s_waitcnt lgkmcnt(6)
    v_mfma_f32_16x16x32_bf16 v[88:91], v[80:83], v[48:51], v[88:91]
    v_mfma_f32_16x16x32_bf16 v[92:95], v[80:83], v[52:55], v[92:95]
    ds_read_b128 v[80:83], v18 offset:11264
    v_mfma_f32_16x16x32_bf16 v[96:99], v[84:87], v[48:51], v[96:99]
    v_mfma_f32_16x16x32_bf16 v[100:103], v[84:87], v[52:55], v[100:103]
    ds_read_b128 v[84:87], v18 offset:15360
    s_waitcnt lgkmcnt(7)
    v_mfma_f32_16x16x32_bf16 v[104:107], v[56:59], v[24:27], 0
    v_mfma_f32_16x16x32_bf16 v[108:111], v[56:59], v[28:31], 0
    ds_read_b128 v[56:59], v18 offset:16384
    s_waitcnt lgkmcnt(7)
    v_mfma_f32_16x16x32_bf16 v[112:115], v[60:63], v[24:27], 0
    v_mfma_f32_16x16x32_bf16 v[116:119], v[60:63], v[28:31], 0
    ds_read_b128 v[60:63], v18 offset:20480
    s_waitcnt lgkmcnt(7)
    v_mfma_f32_16x16x32_bf16 v[104:107], v[64:67], v[32:35], v[104:107]
    v_mfma_f32_16x16x32_bf16 v[108:111], v[64:67], v[36:39], v[108:111]
    ds_read_b128 v[64:67], v18 offset:17408
    s_waitcnt lgkmcnt(7)
    v_mfma_f32_16x16x32_bf16 v[112:115], v[68:71], v[32:35], v[112:115]
    v_mfma_f32_16x16x32_bf16 v[116:119], v[68:71], v[36:39], v[116:119]
    ds_read_b128 v[68:71], v18 offset:21504
    v_cvt_pk_bf16_f32 v120, v88, v96
    v_cvt_pk_bf16_f32 v121, v89, v97
    v_cvt_pk_bf16_f32 v122, v90, v98
    v_cvt_pk_bf16_f32 v123, v91, v99
    buffer_store_dwordx4 v[120:123], v19, s[8:11], s56 offen offset:0
    v_cvt_pk_bf16_f32 v124, v92, v100
    v_cvt_pk_bf16_f32 v125, v93, v101
    v_cvt_pk_bf16_f32 v126, v94, v102
    v_cvt_pk_bf16_f32 v127, v95, v103
    buffer_store_dwordx4 v[124:127], v19, s[8:11], s57 offen offset:0
    s_waitcnt lgkmcnt(7)
    v_mfma_f32_16x16x32_bf16 v[104:107], v[72:75], v[40:43], v[104:107]
    v_mfma_f32_16x16x32_bf16 v[108:111], v[72:75], v[44:47], v[108:111]
    ds_read_b128 v[72:75], v18 offset:18432
    s_waitcnt lgkmcnt(7)
    v_mfma_f32_16x16x32_bf16 v[112:115], v[76:79], v[40:43], v[112:115]
    v_mfma_f32_16x16x32_bf16 v[116:119], v[76:79], v[44:47], v[116:119]
    ds_read_b128 v[76:79], v18 offset:22528
    s_waitcnt lgkmcnt(7)
    v_mfma_f32_16x16x32_bf16 v[104:107], v[80:83], v[48:51], v[104:107]
    v_mfma_f32_16x16x32_bf16 v[108:111], v[80:83], v[52:55], v[108:111]
    ds_read_b128 v[80:83], v18 offset:19456
    s_waitcnt lgkmcnt(7)
    v_mfma_f32_16x16x32_bf16 v[112:115], v[84:87], v[48:51], v[112:115]
    v_mfma_f32_16x16x32_bf16 v[116:119], v[84:87], v[52:55], v[116:119]
    ds_read_b128 v[84:87], v18 offset:23552
    s_waitcnt lgkmcnt(7)
    v_mfma_f32_16x16x32_bf16 v[88:91], v[56:59], v[24:27], 0
    v_mfma_f32_16x16x32_bf16 v[92:95], v[56:59], v[28:31], 0
    ds_read_b128 v[56:59], v18 offset:24576
    s_waitcnt lgkmcnt(7)
    v_mfma_f32_16x16x32_bf16 v[96:99], v[60:63], v[24:27], 0
    v_mfma_f32_16x16x32_bf16 v[100:103], v[60:63], v[28:31], 0
    ds_read_b128 v[60:63], v18 offset:28672
    s_waitcnt lgkmcnt(7)
    v_mfma_f32_16x16x32_bf16 v[88:91], v[64:67], v[32:35], v[88:91]
    v_mfma_f32_16x16x32_bf16 v[92:95], v[64:67], v[36:39], v[92:95]
    ds_read_b128 v[64:67], v18 offset:25600
    s_waitcnt lgkmcnt(7)
    v_mfma_f32_16x16x32_bf16 v[96:99], v[68:71], v[32:35], v[96:99]
    v_mfma_f32_16x16x32_bf16 v[100:103], v[68:71], v[36:39], v[100:103]
    ds_read_b128 v[68:71], v18 offset:29696
    v_cvt_pk_bf16_f32 v120, v104, v112
    v_cvt_pk_bf16_f32 v121, v105, v113
    v_cvt_pk_bf16_f32 v122, v106, v114
    v_cvt_pk_bf16_f32 v123, v107, v115
    buffer_store_dwordx4 v[120:123], v19, s[8:11], s56 offen offset:256
    v_cvt_pk_bf16_f32 v124, v108, v116
    v_cvt_pk_bf16_f32 v125, v109, v117
    v_cvt_pk_bf16_f32 v126, v110, v118
    v_cvt_pk_bf16_f32 v127, v111, v119
    buffer_store_dwordx4 v[124:127], v19, s[8:11], s57 offen offset:256
    s_waitcnt lgkmcnt(7)
    v_mfma_f32_16x16x32_bf16 v[88:91], v[72:75], v[40:43], v[88:91]
    v_mfma_f32_16x16x32_bf16 v[92:95], v[72:75], v[44:47], v[92:95]
    ds_read_b128 v[72:75], v18 offset:26624
    s_waitcnt lgkmcnt(7)
    v_mfma_f32_16x16x32_bf16 v[96:99], v[76:79], v[40:43], v[96:99]
    v_mfma_f32_16x16x32_bf16 v[100:103], v[76:79], v[44:47], v[100:103]
    ds_read_b128 v[76:79], v18 offset:30720
    s_waitcnt lgkmcnt(7)
    v_mfma_f32_16x16x32_bf16 v[88:91], v[80:83], v[48:51], v[88:91]
    v_mfma_f32_16x16x32_bf16 v[92:95], v[80:83], v[52:55], v[92:95]
    ds_read_b128 v[80:83], v18 offset:27648
    s_waitcnt lgkmcnt(7)
    v_mfma_f32_16x16x32_bf16 v[96:99], v[84:87], v[48:51], v[96:99]
    v_mfma_f32_16x16x32_bf16 v[100:103], v[84:87], v[52:55], v[100:103]
    ds_read_b128 v[84:87], v18 offset:31744
    s_waitcnt lgkmcnt(7)
    v_mfma_f32_16x16x32_bf16 v[104:107], v[56:59], v[24:27], 0
    v_mfma_f32_16x16x32_bf16 v[108:111], v[56:59], v[28:31], 0
    s_waitcnt lgkmcnt(6)
    v_mfma_f32_16x16x32_bf16 v[112:115], v[60:63], v[24:27], 0
    v_mfma_f32_16x16x32_bf16 v[116:119], v[60:63], v[28:31], 0
    s_waitcnt lgkmcnt(5)
    v_mfma_f32_16x16x32_bf16 v[104:107], v[64:67], v[32:35], v[104:107]
    v_mfma_f32_16x16x32_bf16 v[108:111], v[64:67], v[36:39], v[108:111]
    s_waitcnt lgkmcnt(4)
    v_mfma_f32_16x16x32_bf16 v[112:115], v[68:71], v[32:35], v[112:115]
    v_mfma_f32_16x16x32_bf16 v[116:119], v[68:71], v[36:39], v[116:119]
    v_cvt_pk_bf16_f32 v120, v88, v96
    v_cvt_pk_bf16_f32 v121, v89, v97
    v_cvt_pk_bf16_f32 v122, v90, v98
    v_cvt_pk_bf16_f32 v123, v91, v99
    buffer_store_dwordx4 v[120:123], v19, s[8:11], s56 offen offset:512
    v_cvt_pk_bf16_f32 v124, v92, v100
    v_cvt_pk_bf16_f32 v125, v93, v101
    v_cvt_pk_bf16_f32 v126, v94, v102
    v_cvt_pk_bf16_f32 v127, v95, v103
    buffer_store_dwordx4 v[124:127], v19, s[8:11], s57 offen offset:512
    s_waitcnt lgkmcnt(3)
    v_mfma_f32_16x16x32_bf16 v[104:107], v[72:75], v[40:43], v[104:107]
    v_mfma_f32_16x16x32_bf16 v[108:111], v[72:75], v[44:47], v[108:111]
    s_waitcnt lgkmcnt(2)
    v_mfma_f32_16x16x32_bf16 v[112:115], v[76:79], v[40:43], v[112:115]
    v_mfma_f32_16x16x32_bf16 v[116:119], v[76:79], v[44:47], v[116:119]
    s_waitcnt lgkmcnt(1)
    v_mfma_f32_16x16x32_bf16 v[104:107], v[80:83], v[48:51], v[104:107]
    v_mfma_f32_16x16x32_bf16 v[108:111], v[80:83], v[52:55], v[108:111]
    s_waitcnt lgkmcnt(0)
    v_mfma_f32_16x16x32_bf16 v[112:115], v[84:87], v[48:51], v[112:115]
    v_mfma_f32_16x16x32_bf16 v[116:119], v[84:87], v[52:55], v[116:119]
    s_nop 3
    v_cvt_pk_bf16_f32 v120, v104, v112
    v_cvt_pk_bf16_f32 v121, v105, v113
    v_cvt_pk_bf16_f32 v122, v106, v114
    v_cvt_pk_bf16_f32 v123, v107, v115
    buffer_store_dwordx4 v[120:123], v19, s[8:11], s56 offen offset:768
    v_cvt_pk_bf16_f32 v124, v108, v116
    v_cvt_pk_bf16_f32 v125, v109, v117
    v_cvt_pk_bf16_f32 v126, v110, v118
    v_cvt_pk_bf16_f32 v127, v111, v119
    buffer_store_dwordx4 v[124:127], v19, s[8:11], s57 offen offset:768
    s_lshl_b32 s59, s51, 13
    s_lshl2_add_u32 s59, s47, s59
    s_add_u32 s59, s59, 10486656
    s_waitcnt vmcnt(0)
    s_barrier
    s_cmp_lg_u32 s46, 0
    s_cbranch_scc1 L_fs_31
    v_mov_b32 v124, 0
    v_mov_b32 v125, 1
    s_mov_b64 exec, 1
    buffer_store_dword v125, v124, s[8:11], s59 offen
    s_mov_b64 exec, -1
L_fs_31:
    s_lshl_b32 s64, s51, 5
    s_add_u32 s64, s64, s47
    s_lshl_b32 s56, s64, 10
    s_lshr_b32 s57, s64, 5
    s_lshl_b32 s57, s57, 15
    s_bfe_u32 s58, s64, 0x10004
    s_lshl_b32 s58, s58, 10
    s_add_u32 s57, s57, s58
    s_and_b32 s58, s64, 15
    s_lshl_b32 s58, s58, 4
    s_add_u32 s57, s57, s58
    s_add_u32 s57, s57, 2097152
    s_add_u32 s58, s56, 8388608
    s_lshl_b32 s59, s51, 10
    s_add_u32 s59, s59, 39845888
    s_cmp_eq_u32 s64, s55
    s_cselect_b32 s58, s59, s58
    buffer_load_dwordx4 v[72:75], v0, s[8:11], s58 offen sc1
    s_mov_b32 s4, s32
    s_mov_b32 s5, s33
    s_mov_b32 s6, 1024
    s_mov_b32 s7, 0x20000
    buffer_load_dwordx4 v[76:79], v0, s[4:7], 0 offen
    s_lshl_b32 s59, s51, 13
    s_add_u32 s59, s59, 10486656
    v_and_b32 v124, 31, v1
    v_lshlrev_b32 v124, 2, v124
L_fw_32:
    buffer_load_dword v125, v124, s[8:11], s59 offen sc1
    s_waitcnt vmcnt(0)
    v_cmp_eq_u32 vcc, 0, v125
    s_cbranch_vccz L_fwd_33
    s_sub_u32 s49, s49, 1
    s_cmp_gt_i32 s49, 0
    s_cbranch_scc1 L_fw_32
    s_branch L_abort
L_fwd_33:
    s_lshl_b32 s60, s47, 15
    s_add_u32 s60, s60, s54
    s_add_u32 s63, s60, 0
    buffer_load_dwordx4 v[24:27], v22, s[8:11], s63 offen sc1
    s_add_u32 s63, s60, 4096
    buffer_load_dwordx4 v[28:31], v22, s[8:11], s63 offen sc1
    s_add_u32 s63, s60, 8192
    buffer_load_dwordx4 v[32:35], v22, s[8:11], s63 offen sc1
    s_add_u32 s63, s60, 12288
    buffer_load_dwordx4 v[36:39], v22, s[8:11], s63 offen sc1
    s_add_u32 s63, s60, 16384
    buffer_load_dwordx4 v[40:43], v22, s[8:11], s63 offen sc1
    s_add_u32 s63, s60, 20480
    buffer_load_dwordx4 v[44:47], v22, s[8:11], s63 offen sc1
    s_add_u32 s63, s60, 24576
    buffer_load_dwordx4 v[48:51], v22, s[8:11], s63 offen sc1
    s_add_u32 s63, s60, 28672
    buffer_load_dwordx4 v[52:55], v22, s[8:11], s63 offen sc1
    v_and_b32 v64, 15, v1
    v_and_b32 v65, 1, v1
    v_lshlrev_b32 v65, 4, v65
    v_mov_b32 v66, 0x3f80
    v_lshlrev_b32 v66, v65, v66
    v_lshrrev_b32 v64, 1, v64
    v_cmp_eq_u32 vcc, 0, v64
    s_nop 1
    v_cndmask_b32 v56, 0, v66, vcc
    v_cmp_eq_u32 vcc, 1, v64
    s_nop 1
    v_cndmask_b32 v57, 0, v66, vcc
    v_cmp_eq_u32 vcc, 2, v64
    s_nop 1
    v_cndmask_b32 v58, 0, v66, vcc
    v_cmp_eq_u32 vcc, 3, v64
    s_nop 1
    v_cndmask_b32 v59, 0, v66, vcc
    s_waitcnt vmcnt(7)
    s_nop 0
    v_mfma_f32_16x16x32_bf16 v[60:63], v[56:59], v[24:27], 0
    s_waitcnt vmcnt(6)
    v_mfma_f32_16x16x32_bf16 v[60:63], v[56:59], v[28:31], v[60:63]
    s_waitcnt vmcnt(5)
    v_mfma_f32_16x16x32_bf16 v[60:63], v[56:59], v[32:35], v[60:63]
    s_waitcnt vmcnt(4)
    v_mfma_f32_16x16x32_bf16 v[60:63], v[56:59], v[36:39], v[60:63]
    s_waitcnt vmcnt(3)
    v_mfma_f32_16x16x32_bf16 v[60:63], v[56:59], v[40:43], v[60:63]
    s_waitcnt vmcnt(2)
    v_mfma_f32_16x16x32_bf16 v[60:63], v[56:59], v[44:47], v[60:63]
    s_waitcnt vmcnt(1)
    v_mfma_f32_16x16x32_bf16 v[60:63], v[56:59], v[48:51], v[60:63]
    s_waitcnt vmcnt(0)
    v_mfma_f32_16x16x32_bf16 v[60:63], v[56:59], v[52:55], v[60:63]
    s_nop 7
    ds_write_b128 v21, v[60:63]
    s_waitcnt lgkmcnt(0)
    s_barrier
    s_cmp_lg_u32 s46, 0
    s_cbranch_scc1 L_t4d_34
    v_lshlrev_b32 v56, 5, v1
    v_add_u32 v56, 139264, v56
    ds_read_b128 v[24:27], v56
    ds_read_b128 v[28:31], v56 offset:16
    v_lshlrev_b32 v32, 16, v72
    v_and_b32 v33, 0xffff0000, v72
    v_lshlrev_b32 v34, 16, v73
    v_and_b32 v35, 0xffff0000, v73
    v_lshlrev_b32 v36, 16, v74
    v_and_b32 v37, 0xffff0000, v74
    v_lshlrev_b32 v38, 16, v75
    v_and_b32 v39, 0xffff0000, v75
    s_waitcnt lgkmcnt(0)
    v_cvt_pk_bf16_f32 v40, v24, v25
    v_cvt_pk_bf16_f32 v41, v26, v27
    v_cvt_pk_bf16_f32 v42, v28, v29
    v_cvt_pk_bf16_f32 v43, v30, v31
    v_lshlrev_b32 v24, 16, v40
    v_and_b32 v25, 0xffff0000, v40
    v_lshlrev_b32 v26, 16, v41
    v_and_b32 v27, 0xffff0000, v41
    v_lshlrev_b32 v28, 16, v42
    v_and_b32 v29, 0xffff0000, v42
    v_lshlrev_b32 v30, 16, v43
    v_and_b32 v31, 0xffff0000, v43
    v_add_f32 v32, v32, v24
    v_add_f32 v33, v33, v25
    v_add_f32 v34, v34, v26
    v_add_f32 v35, v35, v27
    v_add_f32 v36, v36, v28
    v_add_f32 v37, v37, v29
    v_add_f32 v38, v38, v30
    v_add_f32 v39, v39, v31
    v_cvt_pk_bf16_f32 v40, v32, v33
    v_cvt_pk_bf16_f32 v41, v34, v35
    v_cvt_pk_bf16_f32 v42, v36, v37
    v_cvt_pk_bf16_f32 v43, v38, v39
    s_add_u32 s58, s56, 6291456
    buffer_store_dwordx4 v[40:43], v0, s[8:11], s58 offen sc1
    v_lshlrev_b32 v32, 16, v40
    v_and_b32 v33, 0xffff0000, v40
    v_lshlrev_b32 v34, 16, v41
    v_and_b32 v35, 0xffff0000, v41
    v_lshlrev_b32 v36, 16, v42
    v_and_b32 v37, 0xffff0000, v42
    v_lshlrev_b32 v38, 16, v43
    v_and_b32 v39, 0xffff0000, v43
    v_add_f32 v64, v32, v33
    v_add_f32 v65, v34, v35
    v_add_f32 v66, v36, v37
    v_add_f32 v67, v38, v39
    v_add_f32 v64, v64, v65
    v_add_f32 v66, v66, v67
    v_add_f32 v64, v64, v66
    s_nop 1
    v_add_f32_dpp v64, v64, v64 row_ror:8 row_mask:0xf bank_mask:0xf
    s_nop 1
    v_add_f32_dpp v64, v64, v64 row_ror:4 row_mask:0xf bank_mask:0xf
    s_nop 1
    v_add_f32_dpp v64, v64, v64 row_ror:2 row_mask:0xf bank_mask:0xf
    s_nop 1
    v_add_f32_dpp v64, v64, v64 row_ror:1 row_mask:0xf bank_mask:0xf
    v_mov_b32 v65, v64
    s_nop 1
    v_permlane16_swap_b32 v64, v65
    v_add_f32 v64, v64, v65
    v_mov_b32 v65, v64
    s_nop 1
    v_permlane32_swap_b32 v64, v65
    v_add_f32 v64, v64, v65
    v_mul_f32 v66, 0x3b000000, v64
    v_sub_f32 v56, v32, v66
    v_sub_f32 v57, v33, v66
    v_sub_f32 v58, v34, v66
    v_sub_f32 v59, v35, v66
    v_sub_f32 v60, v36, v66
    v_sub_f32 v61, v37, v66
    v_sub_f32 v62, v38, v66
    v_sub_f32 v63, v39, v66
    v_mul_f32 v64, v56, v56
    v_mul_f32 v67, v57, v57
    v_fmac_f32 v64, v58, v58
    v_fmac_f32 v67, v59, v59
    v_fmac_f32 v64, v60, v60
    v_fmac_f32 v67, v61, v61
    v_fmac_f32 v64, v62, v62
    v_fmac_f32 v67, v63, v63
    v_add_f32 v64, v64, v67
    v_cvt_pk_bf16_f32 v66, v66, v66
    v_and_b32 v66, 0xffff0000, v66
    v_add_f32_dpp v64, v64, v64 row_ror:8 row_mask:0xf bank_mask:0xf
    s_nop 1
    v_add_f32_dpp v64, v64, v64 row_ror:4 row_mask:0xf bank_mask:0xf
    s_nop 1
    v_add_f32_dpp v64, v64, v64 row_ror:2 row_mask:0xf bank_mask:0xf
    s_nop 1
    v_add_f32_dpp v64, v64, v64 row_ror:1 row_mask:0xf bank_mask:0xf
    v_mov_b32 v65, v64
    s_nop 1
    v_permlane16_swap_b32 v64, v65
    v_add_f32 v64, v64, v65
    v_mov_b32 v65, v64
    s_nop 1
    v_permlane32_swap_b32 v64, v65
    v_add_f32 v64, v64, v65
    v_mul_f32 v64, 0x3b000000, v64
    v_cvt_pk_bf16_f32 v64, v64, v64
    v_and_b32 v64, 0xffff0000, v64
    v_add_f32 v64, 0x3727c5ac, v64
    v_cvt_pk_bf16_f32 v64, v64, v64
    v_and_b32 v64, 0xffff0000, v64
    v_sqrt_f32 v64, v64
    v_sub_f32 v56, v32, v66
    v_sub_f32 v57, v33, v66
    v_sub_f32 v58, v34, v66
    v_sub_f32 v59, v35, v66
    v_sub_f32 v60, v36, v66
    v_sub_f32 v61, v37, v66
    v_sub_f32 v62, v38, v66
    v_sub_f32 v63, v39, v66
    v_cvt_pk_bf16_f32 v64, v64, v64
    v_and_b32 v64, 0xffff0000, v64
    v_rcp_f32 v64, v64
    v_cvt_pk_bf16_f32 v44, v56, v57
    v_cvt_pk_bf16_f32 v45, v58, v59
    v_cvt_pk_bf16_f32 v46, v60, v61
    v_cvt_pk_bf16_f32 v47, v62, v63
    v_lshlrev_b32 v56, 16, v44
    v_and_b32 v57, 0xffff0000, v44
    v_lshlrev_b32 v58, 16, v45
    v_and_b32 v59, 0xffff0000, v45
    v_lshlrev_b32 v60, 16, v46
    v_and_b32 v61, 0xffff0000, v46
    v_lshlrev_b32 v62, 16, v47
    v_and_b32 v63, 0xffff0000, v47
    v_mul_f32 v56, v56, v64
    v_mul_f32 v57, v57, v64
    v_mul_f32 v58, v58, v64
    v_mul_f32 v59, v59, v64
    v_mul_f32 v60, v60, v64
    v_mul_f32 v61, v61, v64
    v_mul_f32 v62, v62, v64
    v_mul_f32 v63, v63, v64
    v_cvt_pk_bf16_f32 v44, v56, v57
    v_cvt_pk_bf16_f32 v45, v58, v59
    v_cvt_pk_bf16_f32 v46, v60, v61
    v_cvt_pk_bf16_f32 v47, v62, v63
    v_lshlrev_b32 v48, 16, v44
    v_and_b32 v49, 0xffff0000, v44
    v_lshlrev_b32 v50, 16, v45
    v_and_b32 v51, 0xffff0000, v45
    v_lshlrev_b32 v52, 16, v46
    v_and_b32 v53, 0xffff0000, v46
    v_lshlrev_b32 v54, 16, v47
    v_and_b32 v55, 0xffff0000, v47
    v_add_f32 v32, v32, v48
    v_add_f32 v33, v33, v49
    v_add_f32 v34, v34, v50
    v_add_f32 v35, v35, v51
    v_add_f32 v36, v36, v52
    v_add_f32 v37, v37, v53
    v_add_f32 v38, v38, v54
    v_add_f32 v39, v39, v55
    v_cvt_pk_bf16_f32 v80, v32, v33
    v_cvt_pk_bf16_f32 v81, v34, v35
    v_cvt_pk_bf16_f32 v82, v36, v37
    v_cvt_pk_bf16_f32 v83, v38, v39
    s_mov_b32 s4, s40
    s_mov_b32 s5, s41
    s_mov_b32 s6, 2097152
    s_mov_b32 s7, 0x20000
    buffer_store_dwordx4 v[80:83], v0, s[4:7], s56 offen sc1
    v_lshlrev_b32 v24, 16, v76
    v_and_b32 v25, 0xffff0000, v76
    v_lshlrev_b32 v26, 16, v77
    v_and_b32 v27, 0xffff0000, v77
    v_lshlrev_b32 v28, 16, v78
    v_and_b32 v29, 0xffff0000, v78
    v_lshlrev_b32 v30, 16, v79
    v_and_b32 v31, 0xffff0000, v79
    v_mul_f32 v90, v48, v24
    v_fmac_f32 v90, v49, v25
    v_fmac_f32 v90, v50, v26
    v_fmac_f32 v90, v51, v27
    v_fmac_f32 v90, v52, v28
    v_fmac_f32 v90, v53, v29
    v_fmac_f32 v90, v54, v30
    v_fmac_f32 v90, v55, v31
    s_nop 1
    v_add_f32_dpp v90, v90, v90 row_ror:8 row_mask:0xf bank_mask:0xf
    s_nop 1
    v_add_f32_dpp v90, v90, v90 row_ror:4 row_mask:0xf bank_mask:0xf
    s_nop 1
    v_add_f32_dpp v90, v90, v90 row_ror:2 row_mask:0xf bank_mask:0xf
    s_nop 1
    v_add_f32_dpp v90, v90, v90 row_ror:1 row_mask:0xf bank_mask:0xf
    v_mov_b32 v91, v90
    s_nop 1
    v_permlane16_swap_b32 v90, v91
    v_add_f32 v90, v90, v91
    v_mov_b32 v91, v90
    s_nop 1
    v_permlane32_swap_b32 v90, v91
    v_add_f32 v90, v90, v91
    v_cvt_pk_bf16_f32 v90, v90, v90
    v_and_b32 v90, 0xffff0000, v90
    v_ashrrev_i32 v91, 31, v90
    v_or_b32 v91, 0x80000000, v91
    v_xor_b32 v90, v90, v91
    v_and_b32 v90, 0xffff0000, v90
    s_sub_u32 s58, 4095, s64
    v_or_b32 v90, s58, v90
    s_lshl_b32 s58, s51, 13
    s_lshl2_add_u32 s58, s47, s58
    s_add_u32 s58, s58, 10487296
    s_waitcnt vmcnt(0)
    s_mov_b64 exec, 1
    buffer_store_dword v90, off, s[8:11], s58 sc1
    s_mov_b64 exec, -1
L_t4d_34:
    s_xor_b32 s54, s54, 1048576
    s_add_u32 s51, s51, 5
    s_cmp_lt_u32 s51, 64
    s_cbranch_scc1 L_bu_28
    s_endpgm
L_rm_5:
    v_and_b32 v33, 15, v1
    v_lshrrev_b32 v34, 4, v1
    s_min_u32 s60, s47, 27
    s_lshl_b32 s60, s60, 7
    s_mul_i32 s59, s46, 458752
    s_add_u32 s60, s60, s59
    v_mul_u32_u24 v36, 114688, v34
    v_and_b32 v35, 7, v33
    v_lshl_add_u32 v36, v35, 4, v36
    v_add_u32 v36, s60, v36
    v_cmp_gt_u32 vcc, 8, v33
    v_mov_b32 v38, s36
    v_mov_b32 v39, s37
    v_mov_b32 v40, s34
    v_mov_b32 v41, s35
    v_cndmask_b32 v38, v38, v40, vcc
    v_cndmask_b32 v39, v39, v41, vcc
    v_add_co_u32 v38, vcc, v38, v36
    s_nop 1
    v_addc_co_u32 v39, vcc, 0, v39, vcc
    s_lshl_b32 s56, s46, 15
    v_add_u32 v37, s56, v0
    global_load_dwordx4 v[44:47], v[38:39], off
    v_add_co_u32 v38, vcc, 3584, v38
    s_nop 1
    v_addc_co_u32 v39, vcc, 0, v39, vcc
    global_load_dwordx4 v[48:51], v[38:39], off
    v_add_co_u32 v38, vcc, 3584, v38
    s_nop 1
    v_addc_co_u32 v39, vcc, 0, v39, vcc
    global_load_dwordx4 v[52:55], v[38:39], off
    v_add_co_u32 v38, vcc, 3584, v38
    s_nop 1
    v_addc_co_u32 v39, vcc, 0, v39, vcc
    global_load_dwordx4 v[56:59], v[38:39], off
    v_add_co_u32 v38, vcc, 3584, v38
    s_nop 1
    v_addc_co_u32 v39, vcc, 0, v39, vcc
    global_load_dwordx4 v[60:63], v[38:39], off
    v_add_co_u32 v38, vcc, 3584, v38
    s_nop 1
    v_addc_co_u32 v39, vcc, 0, v39, vcc
    global_load_dwordx4 v[64:67], v[38:39], off
    v_add_co_u32 v38, vcc, 3584, v38
    s_nop 1
    v_addc_co_u32 v39, vcc, 0, v39, vcc
    global_load_dwordx4 v[68:71], v[38:39], off
    v_add_co_u32 v38, vcc, 3584, v38
    s_nop 1
    v_addc_co_u32 v39, vcc, 0, v39, vcc
    global_load_dwordx4 v[72:75], v[38:39], off
    v_add_co_u32 v38, vcc, 3584, v38
    s_nop 1
    v_addc_co_u32 v39, vcc, 0, v39, vcc
    global_load_dwordx4 v[76:79], v[38:39], off
    v_add_co_u32 v38, vcc, 3584, v38
    s_nop 1
    v_addc_co_u32 v39, vcc, 0, v39, vcc
    global_load_dwordx4 v[80:83], v[38:39], off
    v_add_co_u32 v38, vcc, 3584, v38
    s_nop 1
    v_addc_co_u32 v39, vcc, 0, v39, vcc
    global_load_dwordx4 v[84:87], v[38:39], off
    v_add_co_u32 v38, vcc, 3584, v38
    s_nop 1
    v_addc_co_u32 v39, vcc, 0, v39, vcc
    global_load_dwordx4 v[88:91], v[38:39], off
    v_add_co_u32 v38, vcc, 3584, v38
    s_nop 1
    v_addc_co_u32 v39, vcc, 0, v39, vcc
    global_load_dwordx4 v[92:95], v[38:39], off
    v_add_co_u32 v38, vcc, 3584, v38
    s_nop 1
    v_addc_co_u32 v39, vcc, 0, v39, vcc
    global_load_dwordx4 v[96:99], v[38:39], off
    v_add_co_u32 v38, vcc, 3584, v38
    s_nop 1
    v_addc_co_u32 v39, vcc, 0, v39, vcc
    global_load_dwordx4 v[100:103], v[38:39], off
    v_add_co_u32 v38, vcc, 3584, v38
    s_nop 1
    v_addc_co_u32 v39, vcc, 0, v39, vcc
    global_load_dwordx4 v[104:107], v[38:39], off
    v_add_co_u32 v38, vcc, 3584, v38
    s_nop 1
    v_addc_co_u32 v39, vcc, 0, v39, vcc
    s_waitcnt vmcnt(15)
    ds_write_b128 v37, v[44:47] offset:0
    s_waitcnt vmcnt(14)
    ds_write_b128 v37, v[48:51] offset:1024
    s_waitcnt vmcnt(13)
    ds_write_b128 v37, v[52:55] offset:2048
    s_waitcnt vmcnt(12)
    ds_write_b128 v37, v[56:59] offset:3072
    s_waitcnt vmcnt(11)
    ds_write_b128 v37, v[60:63] offset:4096
    s_waitcnt vmcnt(10)
    ds_write_b128 v37, v[64:67] offset:5120
    s_waitcnt vmcnt(9)
    ds_write_b128 v37, v[68:71] offset:6144
    s_waitcnt vmcnt(8)
    ds_write_b128 v37, v[72:75] offset:7168
    s_waitcnt lgkmcnt(0)
    s_waitcnt vmcnt(7)
    ds_write_b128 v37, v[76:79] offset:8192
    s_waitcnt vmcnt(6)
    ds_write_b128 v37, v[80:83] offset:9216
    s_waitcnt vmcnt(5)
    ds_write_b128 v37, v[84:87] offset:10240
    s_waitcnt vmcnt(4)
    ds_write_b128 v37, v[88:91] offset:11264
    s_waitcnt vmcnt(3)
    ds_write_b128 v37, v[92:95] offset:12288
    s_waitcnt vmcnt(2)
    ds_write_b128 v37, v[96:99] offset:13312
    s_waitcnt vmcnt(1)
    ds_write_b128 v37, v[100:103] offset:14336
    s_waitcnt vmcnt(0)
    ds_write_b128 v37, v[104:107] offset:15360
    s_waitcnt lgkmcnt(0)
    global_load_dwordx4 v[44:47], v[38:39], off
    v_add_co_u32 v38, vcc, 3584, v38
    s_nop 1
    v_addc_co_u32 v39, vcc, 0, v39, vcc
    global_load_dwordx4 v[48:51], v[38:39], off
    v_add_co_u32 v38, vcc, 3584, v38
    s_nop 1
    v_addc_co_u32 v39, vcc, 0, v39, vcc
    global_load_dwordx4 v[52:55], v[38:39], off
    v_add_co_u32 v38, vcc, 3584, v38
    s_nop 1
    v_addc_co_u32 v39, vcc, 0, v39, vcc
    global_load_dwordx4 v[56:59], v[38:39], off
    v_add_co_u32 v38, vcc, 3584, v38
    s_nop 1
    v_addc_co_u32 v39, vcc, 0, v39, vcc
    global_load_dwordx4 v[60:63], v[38:39], off
    v_add_co_u32 v38, vcc, 3584, v38
    s_nop 1
    v_addc_co_u32 v39, vcc, 0, v39, vcc
    global_load_dwordx4 v[64:67], v[38:39], off
    v_add_co_u32 v38, vcc, 3584, v38
    s_nop 1
    v_addc_co_u32 v39, vcc, 0, v39, vcc
    global_load_dwordx4 v[68:71], v[38:39], off
    v_add_co_u32 v38, vcc, 3584, v38
    s_nop 1
    v_addc_co_u32 v39, vcc, 0, v39, vcc
    global_load_dwordx4 v[72:75], v[38:39], off
    v_add_co_u32 v38, vcc, 3584, v38
    s_nop 1
    v_addc_co_u32 v39, vcc, 0, v39, vcc
    global_load_dwordx4 v[76:79], v[38:39], off
    v_add_co_u32 v38, vcc, 3584, v38
    s_nop 1
    v_addc_co_u32 v39, vcc, 0, v39, vcc
    global_load_dwordx4 v[80:83], v[38:39], off
    v_add_co_u32 v38, vcc, 3584, v38
    s_nop 1
    v_addc_co_u32 v39, vcc, 0, v39, vcc
    global_load_dwordx4 v[84:87], v[38:39], off
    v_add_co_u32 v38, vcc, 3584, v38
    s_nop 1
    v_addc_co_u32 v39, vcc, 0, v39, vcc
    global_load_dwordx4 v[88:91], v[38:39], off
    v_add_co_u32 v38, vcc, 3584, v38
    s_nop 1
    v_addc_co_u32 v39, vcc, 0, v39, vcc
    global_load_dwordx4 v[92:95], v[38:39], off
    v_add_co_u32 v38, vcc, 3584, v38
    s_nop 1
    v_addc_co_u32 v39, vcc, 0, v39, vcc
    global_load_dwordx4 v[96:99], v[38:39], off
    v_add_co_u32 v38, vcc, 3584, v38
    s_nop 1
    v_addc_co_u32 v39, vcc, 0, v39, vcc
    global_load_dwordx4 v[100:103], v[38:39], off
    v_add_co_u32 v38, vcc, 3584, v38
    s_nop 1
    v_addc_co_u32 v39, vcc, 0, v39, vcc
    global_load_dwordx4 v[104:107], v[38:39], off
    v_add_co_u32 v38, vcc, 3584, v38
    s_nop 1
    v_addc_co_u32 v39, vcc, 0, v39, vcc
    s_waitcnt vmcnt(15)
    ds_write_b128 v37, v[44:47] offset:16384
    s_waitcnt vmcnt(14)
    ds_write_b128 v37, v[48:51] offset:17408
    s_waitcnt vmcnt(13)
    ds_write_b128 v37, v[52:55] offset:18432
    s_waitcnt vmcnt(12)
    ds_write_b128 v37, v[56:59] offset:19456
    s_waitcnt vmcnt(11)
    ds_write_b128 v37, v[60:63] offset:20480
    s_waitcnt vmcnt(10)
    ds_write_b128 v37, v[64:67] offset:21504
    s_waitcnt vmcnt(9)
    ds_write_b128 v37, v[68:71] offset:22528
    s_waitcnt vmcnt(8)
    ds_write_b128 v37, v[72:75] offset:23552
    s_waitcnt lgkmcnt(0)
    s_waitcnt vmcnt(7)
    ds_write_b128 v37, v[76:79] offset:24576
    s_waitcnt vmcnt(6)
    ds_write_b128 v37, v[80:83] offset:25600
    s_waitcnt vmcnt(5)
    ds_write_b128 v37, v[84:87] offset:26624
    s_waitcnt vmcnt(4)
    ds_write_b128 v37, v[88:91] offset:27648
    s_waitcnt vmcnt(3)
    ds_write_b128 v37, v[92:95] offset:28672
    s_waitcnt vmcnt(2)
    ds_write_b128 v37, v[96:99] offset:29696
    s_waitcnt vmcnt(1)
    ds_write_b128 v37, v[100:103] offset:30720
    s_waitcnt vmcnt(0)
    ds_write_b128 v37, v[104:107] offset:31744
    s_waitcnt lgkmcnt(0)
    s_cmp_lg_u32 s46, 0
    s_cbranch_scc1 L_gbd_36
    v_mov_b32 v124, 128
L_gb_35:
    buffer_load_dword v125, v124, s[12:15], 0 offen sc1
    s_waitcnt vmcnt(0)
    v_readfirstlane_b32 s56, v125
    s_cmp_ge_u32 s56, 256
    s_cbranch_scc1 L_gbd_36
    s_sleep 4
    s_sub_u32 s49, s49, 1
    s_cmp_gt_i32 s49, 0
    s_cbranch_scc1 L_gb_35
    s_branch L_abort
L_gbd_36:
    s_waitcnt lgkmcnt(0)
    s_barrier
    v_and_b32 v120, 15, v1
    v_lshrrev_b32 v121, 4, v1
    v_lshlrev_b32 v122, 2, v121
    v_mov_b32 v123, 0xf149f2ca
    s_and_b32 s56, s46, 1
    s_lshl_b32 s56, s56, 4
    v_add_u32 v124, s56, v120
    v_add_u32 v125, 0, v122
    v_cmp_gt_u32 vcc, v125, v124
    s_nop 1
    v_cndmask_b32 v8, 0, v123, vcc
    v_add_u32 v125, 1, v122
    v_cmp_gt_u32 vcc, v125, v124
    s_nop 1
    v_cndmask_b32 v9, 0, v123, vcc
    v_add_u32 v125, 2, v122
    v_cmp_gt_u32 vcc, v125, v124
    s_nop 1
    v_cndmask_b32 v10, 0, v123, vcc
    v_add_u32 v125, 3, v122
    v_cmp_gt_u32 vcc, v125, v124
    s_nop 1
    v_cndmask_b32 v11, 0, v123, vcc
    v_add_u32 v125, 16, v122
    v_cmp_gt_u32 vcc, v125, v124
    s_nop 1
    v_cndmask_b32 v12, 0, v123, vcc
    v_add_u32 v125, 17, v122
    v_cmp_gt_u32 vcc, v125, v124
    s_nop 1
    v_cndmask_b32 v13, 0, v123, vcc
    v_add_u32 v125, 18, v122
    v_cmp_gt_u32 vcc, v125, v124
    s_nop 1
    v_cndmask_b32 v14, 0, v123, vcc
    v_add_u32 v125, 19, v122
    v_cmp_gt_u32 vcc, v125, v124
    s_nop 1
    v_cndmask_b32 v15, 0, v123, vcc
    s_and_b32 s56, s46, 1
    s_lshl_b32 s56, s56, 12
    s_lshr_b32 s57, s46, 1
    s_lshl_b32 s57, s57, 11
    s_add_u32 s56, s56, s57
    s_add_u32 s56, s56, 131072
    v_add_u32 v16, s56, v0
    v_add_u32 v17, 131072, v0
    s_lshl_b32 s56, s46, 15
    v_add_u32 v18, s56, v0
    v_lshlrev_b32 v19, 15, v120
    v_lshl_add_u32 v19, v121, 4, v19
    s_lshl_b32 s56, s46, 6
    v_add_u32 v19, s56, v19
    v_lshrrev_b32 v20, 2, v1
    v_lshlrev_b32 v20, 11, v20
    v_and_b32 v125, 3, v1
    v_lshl_add_u32 v20, v125, 8, v20
    v_lshlrev_b32 v21, 5, v120
    v_and_b32 v125, 1, v121
    v_lshl_add_u32 v21, v125, 4, v21
    v_lshrrev_b32 v125, 1, v121
    v_lshl_add_u32 v21, v125, 11, v21
    s_lshl_b32 s56, s46, 9
    s_add_u32 s56, s56, 139264
    v_add_u32 v21, s56, v21
    v_lshlrev_b32 v22, 4, v120
    v_lshl_add_u32 v22, v121, 10, v22
    s_lshl_b32 s56, s46, 8
    v_add_u32 v22, s56, v22
    s_mov_b32 s54, 0
    s_mov_b32 s51, 0
L_mo_37:
    s_lshl_b32 s59, s51, 13
    s_add_u32 s59, s59, 10487168
    v_and_b32 v124, 31, v1
    v_lshlrev_b32 v124, 2, v124
L_fw_39:
    buffer_load_dword v125, v124, s[8:11], s59 offen sc1
    s_waitcnt vmcnt(0)
    v_cmp_eq_u32 vcc, 0, v125
    s_cbranch_vccz L_fwd_40
    s_sub_u32 s49, s49, 1
    s_cmp_gt_i32 s49, 0
    s_cbranch_scc1 L_fw_39
    s_branch L_abort
L_fwd_40:
    v_max_u32_dpp v125, v125, v125 row_ror:8 row_mask:0xf bank_mask:0xf
    s_nop 1
    v_max_u32_dpp v125, v125, v125 row_ror:4 row_mask:0xf bank_mask:0xf
    s_nop 1
    v_max_u32_dpp v125, v125, v125 row_ror:2 row_mask:0xf bank_mask:0xf
    s_nop 1
    v_max_u32_dpp v125, v125, v125 row_ror:1 row_mask:0xf bank_mask:0xf
    v_mov_b32 v124, v125
    s_nop 1
    v_permlane16_swap_b32 v125, v124
    v_max_u32 v125, v125, v124
    v_mov_b32 v124, v125
    s_nop 1
    v_permlane32_swap_b32 v125, v124
    v_max_u32 v125, v125, v124
    s_nop 0
    v_readfirstlane_b32 s55, v125
    s_cmp_gt_u32 s55, s54
    s_cselect_b32 s60, 2, 1
    s_max_u32 s54, s54, s55
    v_mov_b32 v125, s60
    s_lshl_b32 s59, s51, 13
    s_add_u32 s59, s59, 10487040
    s_or_b32 s61, s47, s46
    s_cmp_eq_u32 s61, 0
    s_cselect_b32 s59, s59, 0x80000000
    s_mov_b64 exec, 1
    buffer_store_dword v125, off, s[8:11], s59 sc1
    s_mov_b64 exec, -1
    s_and_b32 s62, s54, 0x7ff
    s_sub_u32 s62, 2048, s62
    v_mov_b32 v124, s62
    s_add_u32 s59, s59, 8576
    s_cmp_eq_u32 s51, 63
    s_cselect_b32 s59, s59, 0x80000000
    s_mov_b64 exec, 1
    buffer_store_dword v124, off, s[8:11], s59 sc1
    s_mov_b64 exec, -1
    s_cmp_eq_u32 s60, 1
    s_cbranch_scc1 L_mon_38
    s_and_b32 s64, s55, 0x7ff
    s_sub_u32 s64, 2047, s64
    s_lshl_b32 s56, s64, 10
    s_lshr_b32 s57, s64, 5
    s_lshl_b32 s57, s57, 15
    s_bfe_u32 s58, s64, 0x10004
    s_lshl_b32 s58, s58, 10
    s_add_u32 s57, s57, s58
    s_and_b32 s58, s64, 15
    s_lshl_b32 s58, s58, 4
    s_add_u32 s57, s57, s58
    s_add_u32 s57, s57, 37748736
    s_add_u32 s58, s56, 4194304
    buffer_load_dwordx4 v[88:91], v0, s[8:11], s58 offen sc1
    s_mov_b32 s4, s38
    s_mov_b32 s5, s39
    s_mov_b32 s6, 1835008
    s_mov_b32 s7, 0x20000
    v_and_b32 v5, 15, v1
    v_lshrrev_b32 v6, 4, v1
    v_lshlrev_b32 v4, 14, v6
    v_lshl_add_u32 v4, v5, 4, v4
    s_lshl_b32 s59, s47, 16
    s_lshl_b32 s60, s46, 8
    s_add_u32 s59, s59, s60
    buffer_load_dwordx4 v[24:27], v4, s[4:7], s59 offen offset:0
    buffer_load_dwordx4 v[28:31], v4, s[4:7], s59 offen offset:1024
    buffer_load_dwordx4 v[32:35], v4, s[4:7], s59 offen offset:2048
    buffer_load_dwordx4 v[36:39], v4, s[4:7], s59 offen offset:3072
    s_add_u32 s59, s59, 4096
    buffer_load_dwordx4 v[40:43], v4, s[4:7], s59 offen offset:0
    buffer_load_dwordx4 v[44:47], v4, s[4:7], s59 offen offset:1024
    buffer_load_dwordx4 v[48:51], v4, s[4:7], s59 offen offset:2048
    buffer_load_dwordx4 v[52:55], v4, s[4:7], s59 offen offset:3072
    s_add_u32 s59, s59, 4096
    buffer_load_dwordx4 v[56:59], v4, s[4:7], s59 offen offset:0
    buffer_load_dwordx4 v[60:63], v4, s[4:7], s59 offen offset:1024
    buffer_load_dwordx4 v[64:67], v4, s[4:7], s59 offen offset:2048
    buffer_load_dwordx4 v[68:71], v4, s[4:7], s59 offen offset:3072
    s_add_u32 s59, s59, 4096
    buffer_load_dwordx4 v[72:75], v4, s[4:7], s59 offen offset:0
    buffer_load_dwordx4 v[76:79], v4, s[4:7], s59 offen offset:1024
    buffer_load_dwordx4 v[80:83], v4, s[4:7], s59 offen offset:2048
    buffer_load_dwordx4 v[84:87], v4, s[4:7], s59 offen offset:3072
    v_and_b32 v124, 1, v1
    v_lshlrev_b32 v124, 4, v124
    v_mov_b32 v125, 0xffff
    v_lshlrev_b32 v125, v124, v125
    v_lshrrev_b32 v124, 1, v5
    v_cmp_eq_u32 vcc, 0, v124
    s_nop 1
    v_cndmask_b32 v120, 0, v125, vcc
    v_cmp_eq_u32 vcc, 1, v124
    s_nop 1
    v_cndmask_b32 v121, 0, v125, vcc
    v_cmp_eq_u32 vcc, 2, v124
    s_nop 1
    v_cndmask_b32 v122, 0, v125, vcc
    v_cmp_eq_u32 vcc, 3, v124
    s_nop 1
    v_cndmask_b32 v123, 0, v125, vcc
    s_waitcnt vmcnt(16)
    v_lshlrev_b32 v96, 16, v88
    v_and_b32 v97, 0xffff0000, v88
    v_lshlrev_b32 v98, 16, v89
    v_and_b32 v99, 0xffff0000, v89
    v_lshlrev_b32 v100, 16, v90
    v_and_b32 v101, 0xffff0000, v90
    v_lshlrev_b32 v102, 16, v91
    v_and_b32 v103, 0xffff0000, v91
    v_add_f32 v116, v96, v97
    v_add_f32 v117, v98, v99
    v_add_f32 v118, v100, v101
    v_add_f32 v119, v102, v103
    v_add_f32 v116, v116, v117
    v_add_f32 v118, v118, v119
    v_add_f32 v116, v116, v118
    s_nop 1
    v_add_f32_dpp v116, v116, v116 row_ror:8 row_mask:0xf bank_mask:0xf
    s_nop 1
    v_add_f32_dpp v116, v116, v116 row_ror:4 row_mask:0xf bank_mask:0xf
    s_nop 1
    v_add_f32_dpp v116, v116, v116 row_ror:2 row_mask:0xf bank_mask:0xf
    s_nop 1
    v_add_f32_dpp v116, v116, v116 row_ror:1 row_mask:0xf bank_mask:0xf
    v_mov_b32 v117, v116
    s_nop 1
    v_permlane16_swap_b32 v116, v117
    v_add_f32 v116, v116, v117
    v_mov_b32 v117, v116
    s_nop 1
    v_permlane32_swap_b32 v116, v117
    v_add_f32 v116, v116, v117
    v_mul_f32 v118, 0x3b000000, v116
    v_sub_f32 v108, v96, v118
    v_sub_f32 v109, v97, v118
    v_sub_f32 v110, v98, v118
    v_sub_f32 v111, v99, v118
    v_sub_f32 v112, v100, v118
    v_sub_f32 v113, v101, v118
    v_sub_f32 v114, v102, v118
    v_sub_f32 v115, v103, v118
    v_mul_f32 v116, v108, v108
    v_mul_f32 v119, v109, v109
    v_fmac_f32 v116, v110, v110
    v_fmac_f32 v119, v111, v111
    v_fmac_f32 v116, v112, v112
    v_fmac_f32 v119, v113, v113
    v_fmac_f32 v116, v114, v114
    v_fmac_f32 v119, v115, v115
    v_add_f32 v116, v116, v119
    v_cvt_pk_bf16_f32 v118, v118, v118
    v_and_b32 v118, 0xffff0000, v118
    v_add_f32_dpp v116, v116, v116 row_ror:8 row_mask:0xf bank_mask:0xf
    s_nop 1
    v_add_f32_dpp v116, v116, v116 row_ror:4 row_mask:0xf bank_mask:0xf
    s_nop 1
    v_add_f32_dpp v116, v116, v116 row_ror:2 row_mask:0xf bank_mask:0xf
    s_nop 1
    v_add_f32_dpp v116, v116, v116 row_ror:1 row_mask:0xf bank_mask:0xf
    v_mov_b32 v117, v116
    s_nop 1
    v_permlane16_swap_b32 v116, v117
    v_add_f32 v116, v116, v117
    v_mov_b32 v117, v116
    s_nop 1
    v_permlane32_swap_b32 v116, v117
    v_add_f32 v116, v116, v117
    v_mul_f32 v116, 0x3b000000, v116
    v_cvt_pk_bf16_f32 v116, v116, v116
    v_and_b32 v116, 0xffff0000, v116
    v_add_f32 v116, 0x3727c5ac, v116
    v_cvt_pk_bf16_f32 v116, v116, v116
    v_and_b32 v116, 0xffff0000, v116
    v_sqrt_f32 v116, v116
    v_sub_f32 v108, v96, v118
    v_sub_f32 v109, v97, v118
    v_sub_f32 v110, v98, v118
    v_sub_f32 v111, v99, v118
    v_sub_f32 v112, v100, v118
    v_sub_f32 v113, v101, v118
    v_sub_f32 v114, v102, v118
    v_sub_f32 v115, v103, v118
    v_cvt_pk_bf16_f32 v116, v116, v116
    v_and_b32 v116, 0xffff0000, v116
    v_rcp_f32 v116, v116
    v_cvt_pk_bf16_f32 v104, v108, v109
    v_cvt_pk_bf16_f32 v105, v110, v111
    v_cvt_pk_bf16_f32 v106, v112, v113
    v_cvt_pk_bf16_f32 v107, v114, v115
    v_lshlrev_b32 v108, 16, v104
    v_and_b32 v109, 0xffff0000, v104
    v_lshlrev_b32 v110, 16, v105
    v_and_b32 v111, 0xffff0000, v105
    v_lshlrev_b32 v112, 16, v106
    v_and_b32 v113, 0xffff0000, v106
    v_lshlrev_b32 v114, 16, v107
    v_and_b32 v115, 0xffff0000, v107
    v_mul_f32 v108, v108, v116
    v_mul_f32 v109, v109, v116
    v_mul_f32 v110, v110, v116
    v_mul_f32 v111, v111, v116
    v_mul_f32 v112, v112, v116
    v_mul_f32 v113, v113, v116
    v_mul_f32 v114, v114, v116
    v_mul_f32 v115, v115, v116
    v_cvt_pk_bf16_f32 v104, v108, v109
    v_cvt_pk_bf16_f32 v105, v110, v111
    v_cvt_pk_bf16_f32 v106, v112, v113
    v_cvt_pk_bf16_f32 v107, v114, v115
    s_mov_b32 s58, 0x01000100
    s_mov_b32 s59, 0x03020302
    v_perm_b32 v88, v104, v104, s58
    v_perm_b32 v89, v104, v104, s59
    v_perm_b32 v90, v105, v105, s58
    v_perm_b32 v91, v105, v105, s59
    v_perm_b32 v92, v106, v106, s58
    v_perm_b32 v93, v106, v106, s59
    v_perm_b32 v94, v107, v107, s58
    v_perm_b32 v95, v107, v107, s59
    v_lshlrev_b32 v4, 5, v1
    s_lshl_b32 s58, s46, 11
    s_add_u32 s58, s58, 147456
    v_add_u32 v4, s58, v4
    ds_write_b128 v4, v[88:91]
    ds_write_b128 v4, v[92:95] offset:16
    s_lshl_b32 s59, s46, 9
    s_add_u32 s59, s58, s59
    v_lshlrev_b32 v4, 7, v6
    v_add_u32 v4, s59, v4
    s_waitcnt lgkmcnt(0)
    ds_read_b128 v[108:111], v18 offset:0
    ds_read_b128 v[88:91], v4 offset:0
    ds_read_b128 v[92:95], v4 offset:16
    ds_read_b128 v[112:115], v18 offset:1024
    s_waitcnt lgkmcnt(1)
    v_and_b32 v124, v120, v88
    v_and_b32 v125, v121, v88
    v_and_b32 v126, v122, v88
    v_and_b32 v127, v123, v88
    s_nop 1
    v_mfma_f32_16x16x32_bf16 v[116:119], v[124:127], v[108:111], 0
    ds_read_b128 v[108:111], v18 offset:2048
    s_waitcnt lgkmcnt(1)
    v_and_b32 v124, v120, v89
    v_and_b32 v125, v121, v89
    v_and_b32 v126, v122, v89
    v_and_b32 v127, v123, v89
    s_nop 1
    v_mfma_f32_16x16x32_bf16 v[116:119], v[124:127], v[112:115], v[116:119]
    ds_read_b128 v[112:115], v18 offset:3072
    s_waitcnt lgkmcnt(1)
    v_and_b32 v124, v120, v90
    v_and_b32 v125, v121, v90
    v_and_b32 v126, v122, v90
    v_and_b32 v127, v123, v90
    s_nop 1
    v_mfma_f32_16x16x32_bf16 v[116:119], v[124:127], v[108:111], v[116:119]
    ds_read_b128 v[108:111], v18 offset:4096
    s_waitcnt lgkmcnt(1)
    v_and_b32 v124, v120, v91
    v_and_b32 v125, v121, v91
    v_and_b32 v126, v122, v91
    v_and_b32 v127, v123, v91
    s_nop 1
    v_mfma_f32_16x16x32_bf16 v[116:119], v[124:127], v[112:115], v[116:119]
    ds_read_b128 v[112:115], v18 offset:5120
    s_waitcnt lgkmcnt(1)
    v_and_b32 v124, v120, v92
    v_and_b32 v125, v121, v92
    v_and_b32 v126, v122, v92
    v_and_b32 v127, v123, v92
    s_nop 1
    v_mfma_f32_16x16x32_bf16 v[116:119], v[124:127], v[108:111], v[116:119]
    ds_read_b128 v[108:111], v18 offset:6144
    s_waitcnt lgkmcnt(1)
    v_and_b32 v124, v120, v93
    v_and_b32 v125, v121, v93
    v_and_b32 v126, v122, v93
    v_and_b32 v127, v123, v93
    s_nop 1
    v_mfma_f32_16x16x32_bf16 v[116:119], v[124:127], v[112:115], v[116:119]
    ds_read_b128 v[112:115], v18 offset:7168
    s_waitcnt lgkmcnt(1)
    v_and_b32 v124, v120, v94
    v_and_b32 v125, v121, v94
    v_and_b32 v126, v122, v94
    v_and_b32 v127, v123, v94
    s_nop 1
    v_mfma_f32_16x16x32_bf16 v[116:119], v[124:127], v[108:111], v[116:119]
    ds_read_b128 v[108:111], v18 offset:8192
    s_waitcnt lgkmcnt(1)
    v_and_b32 v124, v120, v95
    v_and_b32 v125, v121, v95
    v_and_b32 v126, v122, v95
    v_and_b32 v127, v123, v95
    s_nop 1
    v_mfma_f32_16x16x32_bf16 v[116:119], v[124:127], v[112:115], v[116:119]
    ds_read_b128 v[88:91], v4 offset:32
    ds_read_b128 v[92:95], v4 offset:48
    ds_read_b128 v[112:115], v18 offset:9216
    s_waitcnt lgkmcnt(1)
    v_and_b32 v124, v120, v88
    v_and_b32 v125, v121, v88
    v_and_b32 v126, v122, v88
    v_and_b32 v127, v123, v88
    s_nop 1
    v_mfma_f32_16x16x32_bf16 v[116:119], v[124:127], v[108:111], v[116:119]
    ds_read_b128 v[108:111], v18 offset:10240
    s_waitcnt lgkmcnt(1)
    v_and_b32 v124, v120, v89
    v_and_b32 v125, v121, v89
    v_and_b32 v126, v122, v89
    v_and_b32 v127, v123, v89
    s_nop 1
    v_mfma_f32_16x16x32_bf16 v[116:119], v[124:127], v[112:115], v[116:119]
    ds_read_b128 v[112:115], v18 offset:11264
    s_waitcnt lgkmcnt(1)
    v_and_b32 v124, v120, v90
    v_and_b32 v125, v121, v90
    v_and_b32 v126, v122, v90
    v_and_b32 v127, v123, v90
    s_nop 1
    v_mfma_f32_16x16x32_bf16 v[116:119], v[124:127], v[108:111], v[116:119]
    ds_read_b128 v[108:111], v18 offset:12288
    s_waitcnt lgkmcnt(1)
    v_and_b32 v124, v120, v91
    v_and_b32 v125, v121, v91
    v_and_b32 v126, v122, v91
    v_and_b32 v127, v123, v91
    s_nop 1
    v_mfma_f32_16x16x32_bf16 v[116:119], v[124:127], v[112:115], v[116:119]
    ds_read_b128 v[112:115], v18 offset:13312
    s_waitcnt lgkmcnt(1)
    v_and_b32 v124, v120, v92
    v_and_b32 v125, v121, v92
    v_and_b32 v126, v122, v92
    v_and_b32 v127, v123, v92
    s_nop 1
    v_mfma_f32_16x16x32_bf16 v[116:119], v[124:127], v[108:111], v[116:119]
    ds_read_b128 v[108:111], v18 offset:14336
    s_waitcnt lgkmcnt(1)
    v_and_b32 v124, v120, v93
    v_and_b32 v125, v121, v93
    v_and_b32 v126, v122, v93
    v_and_b32 v127, v123, v93
    s_nop 1
    v_mfma_f32_16x16x32_bf16 v[116:119], v[124:127], v[112:115], v[116:119]
    ds_read_b128 v[112:115], v18 offset:15360
    s_waitcnt lgkmcnt(1)
    v_and_b32 v124, v120, v94
    v_and_b32 v125, v121, v94
    v_and_b32 v126, v122, v94
    v_and_b32 v127, v123, v94
    s_nop 1
    v_mfma_f32_16x16x32_bf16 v[116:119], v[124:127], v[108:111], v[116:119]
    ds_read_b128 v[108:111], v18 offset:16384
    s_waitcnt lgkmcnt(1)
    v_and_b32 v124, v120, v95
    v_and_b32 v125, v121, v95
    v_and_b32 v126, v122, v95
    v_and_b32 v127, v123, v95
    s_nop 1
    v_mfma_f32_16x16x32_bf16 v[116:119], v[124:127], v[112:115], v[116:119]
    ds_read_b128 v[88:91], v4 offset:64
    ds_read_b128 v[92:95], v4 offset:80
    ds_read_b128 v[112:115], v18 offset:17408
    s_waitcnt lgkmcnt(1)
    v_and_b32 v124, v120, v88
    v_and_b32 v125, v121, v88
    v_and_b32 v126, v122, v88
    v_and_b32 v127, v123, v88
    s_nop 1
    v_mfma_f32_16x16x32_bf16 v[116:119], v[124:127], v[108:111], v[116:119]
    ds_read_b128 v[108:111], v18 offset:18432
    s_waitcnt lgkmcnt(1)
    v_and_b32 v124, v120, v89
    v_and_b32 v125, v121, v89
    v_and_b32 v126, v122, v89
    v_and_b32 v127, v123, v89
    s_nop 1
    v_mfma_f32_16x16x32_bf16 v[116:119], v[124:127], v[112:115], v[116:119]
    ds_read_b128 v[112:115], v18 offset:19456
    s_waitcnt lgkmcnt(1)
    v_and_b32 v124, v120, v90
    v_and_b32 v125, v121, v90
    v_and_b32 v126, v122, v90
    v_and_b32 v127, v123, v90
    s_nop 1
    v_mfma_f32_16x16x32_bf16 v[116:119], v[124:127], v[108:111], v[116:119]
    ds_read_b128 v[108:111], v18 offset:20480
    s_waitcnt lgkmcnt(1)
    v_and_b32 v124, v120, v91
    v_and_b32 v125, v121, v91
    v_and_b32 v126, v122, v91
    v_and_b32 v127, v123, v91
    s_nop 1
    v_mfma_f32_16x16x32_bf16 v[116:119], v[124:127], v[112:115], v[116:119]
    ds_read_b128 v[112:115], v18 offset:21504
    s_waitcnt lgkmcnt(1)
    v_and_b32 v124, v120, v92
    v_and_b32 v125, v121, v92
    v_and_b32 v126, v122, v92
    v_and_b32 v127, v123, v92
    s_nop 1
    v_mfma_f32_16x16x32_bf16 v[116:119], v[124:127], v[108:111], v[116:119]
    ds_read_b128 v[108:111], v18 offset:22528
    s_waitcnt lgkmcnt(1)
    v_and_b32 v124, v120, v93
    v_and_b32 v125, v121, v93
    v_and_b32 v126, v122, v93
    v_and_b32 v127, v123, v93
    s_nop 1
    v_mfma_f32_16x16x32_bf16 v[116:119], v[124:127], v[112:115], v[116:119]
    ds_read_b128 v[112:115], v18 offset:23552
    s_waitcnt lgkmcnt(1)
    v_and_b32 v124, v120, v94
    v_and_b32 v125, v121, v94
    v_and_b32 v126, v122, v94
    v_and_b32 v127, v123, v94
    s_nop 1
    v_mfma_f32_16x16x32_bf16 v[116:119], v[124:127], v[108:111], v[116:119]
    ds_read_b128 v[108:111], v18 offset:24576
    s_waitcnt lgkmcnt(1)
    v_and_b32 v124, v120, v95
    v_and_b32 v125, v121, v95
    v_and_b32 v126, v122, v95
    v_and_b32 v127, v123, v95
    s_nop 1
    v_mfma_f32_16x16x32_bf16 v[116:119], v[124:127], v[112:115], v[116:119]
    ds_read_b128 v[88:91], v4 offset:96
    ds_read_b128 v[92:95], v4 offset:112
    ds_read_b128 v[112:115], v18 offset:25600
    s_waitcnt lgkmcnt(1)
    v_and_b32 v124, v120, v88
    v_and_b32 v125, v121, v88
    v_and_b32 v126, v122, v88
    v_and_b32 v127, v123, v88
    s_nop 1
    v_mfma_f32_16x16x32_bf16 v[116:119], v[124:127], v[108:111], v[116:119]
    ds_read_b128 v[108:111], v18 offset:26624
    s_waitcnt lgkmcnt(1)
    v_and_b32 v124, v120, v89
    v_and_b32 v125, v121, v89
    v_and_b32 v126, v122, v89
    v_and_b32 v127, v123, v89
    s_nop 1
    v_mfma_f32_16x16x32_bf16 v[116:119], v[124:127], v[112:115], v[116:119]
    ds_read_b128 v[112:115], v18 offset:27648
    s_waitcnt lgkmcnt(1)
    v_and_b32 v124, v120, v90
    v_and_b32 v125, v121, v90
    v_and_b32 v126, v122, v90
    v_and_b32 v127, v123, v90
    s_nop 1
    v_mfma_f32_16x16x32_bf16 v[116:119], v[124:127], v[108:111], v[116:119]
    ds_read_b128 v[108:111], v18 offset:28672
    s_waitcnt lgkmcnt(1)
    v_and_b32 v124, v120, v91
    v_and_b32 v125, v121, v91
    v_and_b32 v126, v122, v91
    v_and_b32 v127, v123, v91
    s_nop 1
    v_mfma_f32_16x16x32_bf16 v[116:119], v[124:127], v[112:115], v[116:119]
    ds_read_b128 v[112:115], v18 offset:29696
    s_waitcnt lgkmcnt(1)
    v_and_b32 v124, v120, v92
    v_and_b32 v125, v121, v92
    v_and_b32 v126, v122, v92
    v_and_b32 v127, v123, v92
    s_nop 1
    v_mfma_f32_16x16x32_bf16 v[116:119], v[124:127], v[108:111], v[116:119]
    ds_read_b128 v[108:111], v18 offset:30720
    s_waitcnt lgkmcnt(1)
    v_and_b32 v124, v120, v93
    v_and_b32 v125, v121, v93
    v_and_b32 v126, v122, v93
    v_and_b32 v127, v123, v93
    s_nop 1
    v_mfma_f32_16x16x32_bf16 v[116:119], v[124:127], v[112:115], v[116:119]
    ds_read_b128 v[112:115], v18 offset:31744
    s_waitcnt lgkmcnt(1)
    v_and_b32 v124, v120, v94
    v_and_b32 v125, v121, v94
    v_and_b32 v126, v122, v94
    v_and_b32 v127, v123, v94
    s_nop 1
    v_mfma_f32_16x16x32_bf16 v[116:119], v[124:127], v[108:111], v[116:119]
    s_waitcnt lgkmcnt(0)
    v_and_b32 v124, v120, v95
    v_and_b32 v125, v121, v95
    v_and_b32 v126, v122, v95
    v_and_b32 v127, v123, v95
    s_nop 1
    v_mfma_f32_16x16x32_bf16 v[116:119], v[124:127], v[112:115], v[116:119]
    v_lshlrev_b32 v4, 5, v5
    v_and_b32 v124, 1, v6
    v_lshl_add_u32 v4, v124, 4, v4
    v_lshrrev_b32 v124, 1, v6
    v_lshl_add_u32 v4, v124, 11, v4
    s_lshl_b32 s60, s46, 9
    s_add_u32 s60, s60, 155648
    v_add_u32 v4, s60, v4
    ds_write_b128 v4, v[116:119]
    v_lshlrev_b32 v4, 2, v1
    v_add_u32 v4, 155648, v4
    s_waitcnt lgkmcnt(0)
    s_barrier
    ds_read2st64_b32 v[88:89], v4 offset0:0 offset1:1
    ds_read2st64_b32 v[90:91], v4 offset0:2 offset1:3
    ds_read2st64_b32 v[92:93], v4 offset0:4 offset1:5
    ds_read2st64_b32 v[94:95], v4 offset0:6 offset1:7
    s_waitcnt lgkmcnt(0)
    v_pk_add_f32 v[88:89], v[88:89], v[90:91]
    v_pk_add_f32 v[92:93], v[92:93], v[94:95]
    v_pk_add_f32 v[88:89], v[88:89], v[92:93]
    v_cvt_pk_bf16_f32 v88, v88, v88
    v_and_b32 v88, 0xffff0000, v88
    v_cvt_pk_bf16_f32 v89, v89, v89
    v_and_b32 v89, 0xffff0000, v89
    v_mul_f32 v90, 0xbfb8aa3b, v88
    v_exp_f32 v90, v90
    s_nop 0
    v_add_f32 v90, 1.0, v90
    v_rcp_f32 v90, v90
    s_nop 0
    v_mul_f32 v88, v88, v90
    v_cvt_pk_bf16_f32 v88, v88, v88
    v_and_b32 v88, 0xffff0000, v88
    v_mul_f32 v88, v88, v89
    v_cvt_pk_bf16_f32 v88, v88, v88
    v_lshlrev_b32 v4, 2, v1
    v_add_u32 v4, s58, v4
    ds_write_b32 v4, v88
    v_lshlrev_b32 v4, 6, v6
    v_add_u32 v4, s58, v4
    s_waitcnt lgkmcnt(0)
    ds_read_b128 v[88:91], v4
    ds_read_b128 v[92:95], v4 offset:16
    ds_read_b128 v[108:111], v4 offset:32
    ds_read_b128 v[112:115], v4 offset:48
    s_waitcnt vmcnt(0) lgkmcnt(0)
    v_and_b32 v124, v120, v88
    v_and_b32 v125, v121, v88
    v_and_b32 v126, v122, v88
    v_and_b32 v127, v123, v88
    s_nop 1
    v_mfma_f32_16x16x32_bf16 v[116:119], v[124:127], v[24:27], 0
    v_and_b32 v124, v120, v89
    v_and_b32 v125, v121, v89
    v_and_b32 v126, v122, v89
    v_and_b32 v127, v123, v89
    s_nop 1
    v_mfma_f32_16x16x32_bf16 v[116:119], v[124:127], v[28:31], v[116:119]
    v_and_b32 v124, v120, v90
    v_and_b32 v125, v121, v90
    v_and_b32 v126, v122, v90
    v_and_b32 v127, v123, v90
    s_nop 1
    v_mfma_f32_16x16x32_bf16 v[116:119], v[124:127], v[32:35], v[116:119]
    v_and_b32 v124, v120, v91
    v_and_b32 v125, v121, v91
    v_and_b32 v126, v122, v91
    v_and_b32 v127, v123, v91
    s_nop 1
    v_mfma_f32_16x16x32_bf16 v[116:119], v[124:127], v[36:39], v[116:119]
    v_and_b32 v124, v120, v92
    v_and_b32 v125, v121, v92
    v_and_b32 v126, v122, v92
    v_and_b32 v127, v123, v92
    s_nop 1
    v_mfma_f32_16x16x32_bf16 v[116:119], v[124:127], v[40:43], v[116:119]
    v_and_b32 v124, v120, v93
    v_and_b32 v125, v121, v93
    v_and_b32 v126, v122, v93
    v_and_b32 v127, v123, v93
    s_nop 1
    v_mfma_f32_16x16x32_bf16 v[116:119], v[124:127], v[44:47], v[116:119]
    v_and_b32 v124, v120, v94
    v_and_b32 v125, v121, v94
    v_and_b32 v126, v122, v94
    v_and_b32 v127, v123, v94
    s_nop 1
    v_mfma_f32_16x16x32_bf16 v[116:119], v[124:127], v[48:51], v[116:119]
    v_and_b32 v124, v120, v95
    v_and_b32 v125, v121, v95
    v_and_b32 v126, v122, v95
    v_and_b32 v127, v123, v95
    s_nop 1
    v_mfma_f32_16x16x32_bf16 v[116:119], v[124:127], v[52:55], v[116:119]
    v_and_b32 v124, v120, v108
    v_and_b32 v125, v121, v108
    v_and_b32 v126, v122, v108
    v_and_b32 v127, v123, v108
    s_nop 1
    v_mfma_f32_16x16x32_bf16 v[116:119], v[124:127], v[56:59], v[116:119]
    v_and_b32 v124, v120, v109
    v_and_b32 v125, v121, v109
    v_and_b32 v126, v122, v109
    v_and_b32 v127, v123, v109
    s_nop 1
    v_mfma_f32_16x16x32_bf16 v[116:119], v[124:127], v[60:63], v[116:119]
    v_and_b32 v124, v120, v110
    v_and_b32 v125, v121, v110
    v_and_b32 v126, v122, v110
    v_and_b32 v127, v123, v110
    s_nop 1
    v_mfma_f32_16x16x32_bf16 v[116:119], v[124:127], v[64:67], v[116:119]
    v_and_b32 v124, v120, v111
    v_and_b32 v125, v121, v111
    v_and_b32 v126, v122, v111
    v_and_b32 v127, v123, v111
    s_nop 1
    v_mfma_f32_16x16x32_bf16 v[116:119], v[124:127], v[68:71], v[116:119]
    v_and_b32 v124, v120, v112
    v_and_b32 v125, v121, v112
    v_and_b32 v126, v122, v112
    v_and_b32 v127, v123, v112
    s_nop 1
    v_mfma_f32_16x16x32_bf16 v[116:119], v[124:127], v[72:75], v[116:119]
    v_and_b32 v124, v120, v113
    v_and_b32 v125, v121, v113
    v_and_b32 v126, v122, v113
    v_and_b32 v127, v123, v113
    s_nop 1
    v_mfma_f32_16x16x32_bf16 v[116:119], v[124:127], v[76:79], v[116:119]
    v_and_b32 v124, v120, v114
    v_and_b32 v125, v121, v114
    v_and_b32 v126, v122, v114
    v_and_b32 v127, v123, v114
    s_nop 1
    v_mfma_f32_16x16x32_bf16 v[116:119], v[124:127], v[80:83], v[116:119]
    v_and_b32 v124, v120, v115
    v_and_b32 v125, v121, v115
    v_and_b32 v126, v122, v115
    v_and_b32 v127, v123, v115
    s_nop 1
    v_mfma_f32_16x16x32_bf16 v[116:119], v[124:127], v[84:87], v[116:119]
    v_lshlrev_b32 v4, 4, v5
    v_and_b32 v124, 1, v6
    v_lshl_add_u32 v4, v124, 3, v4
    v_and_b32 v124, 2, v6
    v_lshl_add_u32 v4, v124, 30, v4
    s_lshl_b32 s65, s51, 15
    s_add_u32 s65, s65, 92274688
    s_lshl_b32 s59, s47, 10
    s_lshl_b32 s60, s46, 8
    s_add_u32 s59, s59, s60
    s_add_u32 s59, s59, s65
    v_cvt_pk_bf16_f32 v24, v116, v117
    v_cvt_pk_bf16_f32 v25, v118, v119
    buffer_store_dwordx2 v[24:25], v4, s[8:11], s59 offen
    s_lshl_b32 s59, s51, 13
    s_lshl2_add_u32 s59, s47, s59
    s_add_u32 s59, s59, 10486912
    s_waitcnt vmcnt(0)
    s_barrier
    s_cmp_lg_u32 s46, 0
    s_cbranch_scc1 L_fs_41
    v_mov_b32 v124, 0
    v_mov_b32 v125, 1
    s_mov_b64 exec, 1
    buffer_store_dword v125, v124, s[8:11], s59 offen
    s_mov_b64 exec, -1
L_fs_41:
    s_lshl_b32 s59, s51, 13
    s_add_u32 s59, s59, 10486912
    v_and_b32 v124, 31, v1
    v_lshlrev_b32 v124, 2, v124
L_fw_43:
    buffer_load_dword v125, v124, s[8:11], s59 offen sc1
    s_waitcnt vmcnt(0)
    v_cmp_eq_u32 vcc, 0, v125
    s_cbranch_vccz L_fwd_44
    s_sub_u32 s49, s49, 1
    s_cmp_gt_i32 s49, 0
    s_cbranch_scc1 L_fw_43
    s_branch L_abort
L_fwd_44:
    s_add_u32 s63, s65, 0
    buffer_load_dwordx4 v[24:27], v22, s[8:11], s63 offen sc1
    s_add_u32 s63, s65, 4096
    buffer_load_dwordx4 v[28:31], v22, s[8:11], s63 offen sc1
    s_add_u32 s63, s65, 8192
    buffer_load_dwordx4 v[32:35], v22, s[8:11], s63 offen sc1
    s_add_u32 s63, s65, 12288
    buffer_load_dwordx4 v[36:39], v22, s[8:11], s63 offen sc1
    s_add_u32 s63, s65, 16384
    buffer_load_dwordx4 v[40:43], v22, s[8:11], s63 offen sc1
    s_add_u32 s63, s65, 20480
    buffer_load_dwordx4 v[44:47], v22, s[8:11], s63 offen sc1
    s_add_u32 s63, s65, 24576
    buffer_load_dwordx4 v[48:51], v22, s[8:11], s63 offen sc1
    s_add_u32 s63, s65, 28672
    buffer_load_dwordx4 v[52:55], v22, s[8:11], s63 offen sc1
    v_and_b32 v64, 15, v1
    v_and_b32 v65, 1, v1
    v_lshlrev_b32 v65, 4, v65
    v_mov_b32 v66, 0x3f80
    v_lshlrev_b32 v66, v65, v66
    v_lshrrev_b32 v64, 1, v64
    v_cmp_eq_u32 vcc, 0, v64
    s_nop 1
    v_cndmask_b32 v56, 0, v66, vcc
    v_cmp_eq_u32 vcc, 1, v64
    s_nop 1
    v_cndmask_b32 v57, 0, v66, vcc
    v_cmp_eq_u32 vcc, 2, v64
    s_nop 1
    v_cndmask_b32 v58, 0, v66, vcc
    v_cmp_eq_u32 vcc, 3, v64
    s_nop 1
    v_cndmask_b32 v59, 0, v66, vcc
    s_waitcnt vmcnt(7)
    s_nop 0
    v_mfma_f32_16x16x32_bf16 v[60:63], v[56:59], v[24:27], 0
    s_waitcnt vmcnt(6)
    v_mfma_f32_16x16x32_bf16 v[60:63], v[56:59], v[28:31], v[60:63]
    s_waitcnt vmcnt(5)
    v_mfma_f32_16x16x32_bf16 v[60:63], v[56:59], v[32:35], v[60:63]
    s_waitcnt vmcnt(4)
    v_mfma_f32_16x16x32_bf16 v[60:63], v[56:59], v[36:39], v[60:63]
    s_waitcnt vmcnt(3)
    v_mfma_f32_16x16x32_bf16 v[60:63], v[56:59], v[40:43], v[60:63]
    s_waitcnt vmcnt(2)
    v_mfma_f32_16x16x32_bf16 v[60:63], v[56:59], v[44:47], v[60:63]
    s_waitcnt vmcnt(1)
    v_mfma_f32_16x16x32_bf16 v[60:63], v[56:59], v[48:51], v[60:63]
    s_waitcnt vmcnt(0)
    v_mfma_f32_16x16x32_bf16 v[60:63], v[56:59], v[52:55], v[60:63]
    s_nop 7
    ds_write_b128 v21, v[60:63]
    s_waitcnt lgkmcnt(0)
    s_barrier
    s_cmp_lg_u32 s46, 0
    s_cbranch_scc1 L_moed_42
    v_lshlrev_b32 v56, 5, v1
    v_add_u32 v56, 139264, v56
    ds_read_b128 v[24:27], v56
    ds_read_b128 v[28:31], v56 offset:16
    s_and_b32 s59, s55, 0xffff0000
    s_xor_b32 s60, s59, 0x80000000
    s_xor_b32 s61, s59, 0xffff0000
    s_cmp_lt_i32 s59, 0
    s_cselect_b32 s59, s60, s61
    v_mov_b32 v56, s59
    v_mul_f32 v56, 0xbfb8aa3b, v56
    v_exp_f32 v56, v56
    s_nop 0
    v_add_f32 v56, 1.0, v56
    v_rcp_f32 v56, v56
    s_nop 0
    v_cvt_pk_bf16_f32 v56, v56, v56
    v_and_b32 v56, 0xffff0000, v56
    v_lshlrev_b32 v48, 16, v104
    v_and_b32 v49, 0xffff0000, v104
    v_lshlrev_b32 v50, 16, v105
    v_and_b32 v51, 0xffff0000, v105
    v_lshlrev_b32 v52, 16, v106
    v_and_b32 v53, 0xffff0000, v106
    v_lshlrev_b32 v54, 16, v107
    v_and_b32 v55, 0xffff0000, v107
    s_waitcnt lgkmcnt(0)
    v_cvt_pk_bf16_f32 v40, v24, v25
    v_cvt_pk_bf16_f32 v41, v26, v27
    v_cvt_pk_bf16_f32 v42, v28, v29
    v_cvt_pk_bf16_f32 v43, v30, v31
    v_lshlrev_b32 v24, 16, v40
    v_and_b32 v25, 0xffff0000, v40
    v_lshlrev_b32 v26, 16, v41
    v_and_b32 v27, 0xffff0000, v41
    v_lshlrev_b32 v28, 16, v42
    v_and_b32 v29, 0xffff0000, v42
    v_lshlrev_b32 v30, 16, v43
    v_and_b32 v31, 0xffff0000, v43
    v_mul_f32 v24, v24, v56
    v_mul_f32 v25, v25, v56
    v_mul_f32 v26, v26, v56
    v_mul_f32 v27, v27, v56
    v_mul_f32 v28, v28, v56
    v_mul_f32 v29, v29, v56
    v_mul_f32 v30, v30, v56
    v_mul_f32 v31, v31, v56
    v_cvt_pk_bf16_f32 v40, v24, v25
    v_cvt_pk_bf16_f32 v41, v26, v27
    v_cvt_pk_bf16_f32 v42, v28, v29
    v_cvt_pk_bf16_f32 v43, v30, v31
    v_lshlrev_b32 v24, 16, v40
    v_and_b32 v25, 0xffff0000, v40
    v_lshlrev_b32 v26, 16, v41
    v_and_b32 v27, 0xffff0000, v41
    v_lshlrev_b32 v28, 16, v42
    v_and_b32 v29, 0xffff0000, v42
    v_lshlrev_b32 v30, 16, v43
    v_and_b32 v31, 0xffff0000, v43
    v_add_f32 v24, v24, v48
    v_add_f32 v25, v25, v49
    v_add_f32 v26, v26, v50
    v_add_f32 v27, v27, v51
    v_add_f32 v28, v28, v52
    v_add_f32 v29, v29, v53
    v_add_f32 v30, v30, v54
    v_add_f32 v31, v31, v55
    v_cvt_pk_bf16_f32 v40, v24, v25
    v_cvt_pk_bf16_f32 v41, v26, v27
    v_cvt_pk_bf16_f32 v42, v28, v29
    v_cvt_pk_bf16_f32 v43, v30, v31
    v_lshlrev_b32 v24, 16, v40
    v_and_b32 v25, 0xffff0000, v40
    v_lshlrev_b32 v26, 16, v41
    v_and_b32 v27, 0xffff0000, v41
    v_lshlrev_b32 v28, 16, v42
    v_and_b32 v29, 0xffff0000, v42
    v_lshlrev_b32 v30, 16, v43
    v_and_b32 v31, 0xffff0000, v43
    v_add_f32 v96, v96, v24
    v_add_f32 v97, v97, v25
    v_add_f32 v98, v98, v26
    v_add_f32 v99, v99, v27
    v_add_f32 v100, v100, v28
    v_add_f32 v101, v101, v29
    v_add_f32 v102, v102, v30
    v_add_f32 v103, v103, v31
    v_cvt_pk_bf16_f32 v80, v96, v97
    v_cvt_pk_bf16_f32 v81, v98, v99
    v_cvt_pk_bf16_f32 v82, v100, v101
    v_cvt_pk_bf16_f32 v83, v102, v103
    s_lshl_b32 s58, s51, 10
    s_add_u32 s58, s58, 39845888
    buffer_store_dwordx4 v[80:83], v0, s[8:11], s58 offen sc1
    v_lshlrev_b32 v96, 16, v80
    v_and_b32 v97, 0xffff0000, v80
    v_lshlrev_b32 v98, 16, v81
    v_and_b32 v99, 0xffff0000, v81
    v_lshlrev_b32 v100, 16, v82
    v_and_b32 v101, 0xffff0000, v82
    v_lshlrev_b32 v102, 16, v83
    v_and_b32 v103, 0xffff0000, v83
    v_add_f32 v66, v96, v97
    v_add_f32 v67, v98, v99
    v_add_f32 v68, v100, v101
    v_add_f32 v69, v102, v103
    v_add_f32 v66, v66, v67
    v_add_f32 v68, v68, v69
    v_add_f32 v66, v66, v68
    s_nop 1
    v_add_f32_dpp v66, v66, v66 row_ror:8 row_mask:0xf bank_mask:0xf
    s_nop 1
    v_add_f32_dpp v66, v66, v66 row_ror:4 row_mask:0xf bank_mask:0xf
    s_nop 1
    v_add_f32_dpp v66, v66, v66 row_ror:2 row_mask:0xf bank_mask:0xf
    s_nop 1
    v_add_f32_dpp v66, v66, v66 row_ror:1 row_mask:0xf bank_mask:0xf
    v_mov_b32 v67, v66
    s_nop 1
    v_permlane16_swap_b32 v66, v67
    v_add_f32 v66, v66, v67
    v_mov_b32 v67, v66
    s_nop 1
    v_permlane32_swap_b32 v66, v67
    v_add_f32 v66, v66, v67
    v_mul_f32 v68, 0x3b000000, v66
    v_sub_f32 v58, v96, v68
    v_sub_f32 v59, v97, v68
    v_sub_f32 v60, v98, v68
    v_sub_f32 v61, v99, v68
    v_sub_f32 v62, v100, v68
    v_sub_f32 v63, v101, v68
    v_sub_f32 v64, v102, v68
    v_sub_f32 v65, v103, v68
    v_mul_f32 v66, v58, v58
    v_mul_f32 v69, v59, v59
    v_fmac_f32 v66, v60, v60
    v_fmac_f32 v69, v61, v61
    v_fmac_f32 v66, v62, v62
    v_fmac_f32 v69, v63, v63
    v_fmac_f32 v66, v64, v64
    v_fmac_f32 v69, v65, v65
    v_add_f32 v66, v66, v69
    v_cvt_pk_bf16_f32 v68, v68, v68
    v_and_b32 v68, 0xffff0000, v68
    v_add_f32_dpp v66, v66, v66 row_ror:8 row_mask:0xf bank_mask:0xf
    s_nop 1
    v_add_f32_dpp v66, v66, v66 row_ror:4 row_mask:0xf bank_mask:0xf
    s_nop 1
    v_add_f32_dpp v66, v66, v66 row_ror:2 row_mask:0xf bank_mask:0xf
    s_nop 1
    v_add_f32_dpp v66, v66, v66 row_ror:1 row_mask:0xf bank_mask:0xf
    v_mov_b32 v67, v66
    s_nop 1
    v_permlane16_swap_b32 v66, v67
    v_add_f32 v66, v66, v67
    v_mov_b32 v67, v66
    s_nop 1
    v_permlane32_swap_b32 v66, v67
    v_add_f32 v66, v66, v67
    v_mul_f32 v66, 0x3b000000, v66
    v_cvt_pk_bf16_f32 v66, v66, v66
    v_and_b32 v66, 0xffff0000, v66
    v_add_f32 v66, 0x3727c5ac, v66
    v_cvt_pk_bf16_f32 v66, v66, v66
    v_and_b32 v66, 0xffff0000, v66
    v_sqrt_f32 v66, v66
    v_sub_f32 v58, v96, v68
    v_sub_f32 v59, v97, v68
    v_sub_f32 v60, v98, v68
    v_sub_f32 v61, v99, v68
    v_sub_f32 v62, v100, v68
    v_sub_f32 v63, v101, v68
    v_sub_f32 v64, v102, v68
    v_sub_f32 v65, v103, v68
    v_cvt_pk_bf16_f32 v66, v66, v66
    v_and_b32 v66, 0xffff0000, v66
    v_rcp_f32 v66, v66
    v_cvt_pk_bf16_f32 v84, v58, v59
    v_cvt_pk_bf16_f32 v85, v60, v61
    v_cvt_pk_bf16_f32 v86, v62, v63
    v_cvt_pk_bf16_f32 v87, v64, v65
    v_lshlrev_b32 v58, 16, v84
    v_and_b32 v59, 0xffff0000, v84
    v_lshlrev_b32 v60, 16, v85
    v_and_b32 v61, 0xffff0000, v85
    v_lshlrev_b32 v62, 16, v86
    v_and_b32 v63, 0xffff0000, v86
    v_lshlrev_b32 v64, 16, v87
    v_and_b32 v65, 0xffff0000, v87
    v_mul_f32 v58, v58, v66
    v_mul_f32 v59, v59, v66
    v_mul_f32 v60, v60, v66
    v_mul_f32 v61, v61, v66
    v_mul_f32 v62, v62, v66
    v_mul_f32 v63, v63, v66
    v_mul_f32 v64, v64, v66
    v_mul_f32 v65, v65, v66
    v_cvt_pk_bf16_f32 v84, v58, v59
    v_cvt_pk_bf16_f32 v85, v60, v61
    v_cvt_pk_bf16_f32 v86, v62, v63
    v_cvt_pk_bf16_f32 v87, v64, v65
    buffer_store_dwordx4 v[84:87], v20, s[8:11], s57 offen sc1
L_moed_42:
    s_and_b32 s56, s55, 31
    s_sub_u32 s56, 31, s56
    v_and_b32 v2, 15, v1
    v_add_u32 v3, 16, v2
    v_add_u32 v4, 35651584, v0
    v_cmp_eq_u32 vcc, s56, v2
    s_nop 1
    v_cndmask_b32 v2, v0, v4, vcc
    v_cmp_eq_u32 vcc, s56, v3
    s_nop 1
    v_cndmask_b32 v3, v0, v4, vcc
    s_waitcnt vmcnt(0)
    s_barrier
    s_lshl_b32 s56, s51, 15
    s_lshl_b32 s57, s46, 12
    s_add_u32 s66, s56, s57
    s_add_u32 s66, s66, 2097152
    s_xor_b32 s56, s66, 0
    buffer_load_dwordx4 v[72:75], v2, s[8:11], s56 offen offset:0 sc1
    buffer_load_dwordx4 v[76:79], v3, s[8:11], s56 offen offset:1024 sc1
    buffer_load_dwordx4 v[80:83], v2, s[8:11], s56 offen offset:2048 sc1
    buffer_load_dwordx4 v[84:87], v3, s[8:11], s56 offen offset:3072 sc1
    s_xor_b32 s56, s66, 4096
    buffer_load_dwordx4 v[88:91], v2, s[8:11], s56 offen offset:0 sc1
    buffer_load_dwordx4 v[92:95], v3, s[8:11], s56 offen offset:1024 sc1
    buffer_load_dwordx4 v[96:99], v2, s[8:11], s56 offen offset:2048 sc1
    buffer_load_dwordx4 v[100:103], v3, s[8:11], s56 offen offset:3072 sc1
    s_xor_b32 s56, s66, 8192
    buffer_load_dwordx4 v[104:107], v2, s[8:11], s56 offen offset:0 sc1
    buffer_load_dwordx4 v[108:111], v3, s[8:11], s56 offen offset:1024 sc1
    buffer_load_dwordx4 v[112:115], v2, s[8:11], s56 offen offset:2048 sc1
    buffer_load_dwordx4 v[116:119], v3, s[8:11], s56 offen offset:3072 sc1
    s_xor_b32 s56, s66, 12288
    buffer_load_dwordx4 v[120:123], v2, s[8:11], s56 offen offset:0 sc1
    buffer_load_dwordx4 v[124:127], v3, s[8:11], s56 offen offset:1024 sc1
    s_lshl_b32 s58, s51, 5
    s_add_u32 s58, s58, s47
    s_mul_i32 s58, s58, 24576
    s_add_u32 s58, s58, 201326592
    s_lshl_b32 s60, s46, 10
    s_add_u32 s61, s58, s60
    s_add_u32 s62, s61, 4096
    s_add_u32 s63, s61, 16384
    s_add_u32 s64, s61, 20480
    s_add_u32 s65, s61, s60
    s_add_u32 s65, s65, 8192
    s_waitcnt vmcnt(12)
    v_mfma_f32_16x16x32_bf16 v[40:43], a[128:131], v[72:75], 0
    v_mfma_f32_16x16x32_bf16 v[56:59], v[72:75], v[128:131], 0
    v_mfma_f32_16x16x32_bf16 v[24:27], a[0:3], v[72:75], 0
    v_mfma_f32_16x16x32_bf16 v[44:47], a[128:131], v[76:79], 0
    v_mfma_f32_16x16x32_bf16 v[60:63], v[76:79], v[128:131], 0
    v_mfma_f32_16x16x32_bf16 v[28:31], a[0:3], v[76:79], 0
    v_mfma_f32_16x16x32_bf16 v[48:51], a[136:139], v[72:75], 0
    v_mfma_f32_16x16x32_bf16 v[64:67], v[72:75], v[136:139], 0
    v_mfma_f32_16x16x32_bf16 v[32:35], a[8:11], v[72:75], 0
    v_mfma_f32_16x16x32_bf16 v[52:55], a[136:139], v[76:79], 0
    v_mfma_f32_16x16x32_bf16 v[68:71], v[76:79], v[136:139], 0
    v_mfma_f32_16x16x32_bf16 v[36:39], a[8:11], v[76:79], 0
    buffer_load_dwordx4 v[72:75], v2, s[8:11], s56 offen offset:2048 sc1
    buffer_load_dwordx4 v[76:79], v3, s[8:11], s56 offen offset:3072 sc1
    s_waitcnt vmcnt(12)
    v_mfma_f32_16x16x32_bf16 v[40:43], a[132:135], v[80:83], v[40:43]
    v_mfma_f32_16x16x32_bf16 v[56:59], v[80:83], v[132:135], v[56:59]
    v_mfma_f32_16x16x32_bf16 v[24:27], a[4:7], v[80:83], v[24:27]
    v_mfma_f32_16x16x32_bf16 v[44:47], a[132:135], v[84:87], v[44:47]
    v_mfma_f32_16x16x32_bf16 v[60:63], v[84:87], v[132:135], v[60:63]
    v_mfma_f32_16x16x32_bf16 v[28:31], a[4:7], v[84:87], v[28:31]
    v_mfma_f32_16x16x32_bf16 v[48:51], a[140:143], v[80:83], v[48:51]
    v_mfma_f32_16x16x32_bf16 v[64:67], v[80:83], v[140:143], v[64:67]
    v_mfma_f32_16x16x32_bf16 v[32:35], a[12:15], v[80:83], v[32:35]
    v_mfma_f32_16x16x32_bf16 v[52:55], a[140:143], v[84:87], v[52:55]
    v_mfma_f32_16x16x32_bf16 v[68:71], v[84:87], v[140:143], v[68:71]
    v_mfma_f32_16x16x32_bf16 v[36:39], a[12:15], v[84:87], v[36:39]
    s_xor_b32 s56, s66, 16384
    buffer_load_dwordx4 v[80:83], v2, s[8:11], s56 offen offset:0 sc1
    buffer_load_dwordx4 v[84:87], v3, s[8:11], s56 offen offset:1024 sc1
    s_waitcnt vmcnt(12)
    v_mfma_f32_16x16x32_bf16 v[40:43], a[144:147], v[88:91], v[40:43]
    v_mfma_f32_16x16x32_bf16 v[56:59], v[88:91], v[144:147], v[56:59]
    v_mfma_f32_16x16x32_bf16 v[24:27], a[16:19], v[88:91], v[24:27]
    v_mfma_f32_16x16x32_bf16 v[44:47], a[144:147], v[92:95], v[44:47]
    v_mfma_f32_16x16x32_bf16 v[60:63], v[92:95], v[144:147], v[60:63]
    v_mfma_f32_16x16x32_bf16 v[28:31], a[16:19], v[92:95], v[28:31]
    v_mfma_f32_16x16x32_bf16 v[48:51], a[152:155], v[88:91], v[48:51]
    v_mfma_f32_16x16x32_bf16 v[64:67], v[88:91], v[152:155], v[64:67]
    v_mfma_f32_16x16x32_bf16 v[32:35], a[24:27], v[88:91], v[32:35]
    v_mfma_f32_16x16x32_bf16 v[52:55], a[152:155], v[92:95], v[52:55]
    v_mfma_f32_16x16x32_bf16 v[68:71], v[92:95], v[152:155], v[68:71]
    v_mfma_f32_16x16x32_bf16 v[36:39], a[24:27], v[92:95], v[36:39]
    buffer_load_dwordx4 v[88:91], v2, s[8:11], s56 offen offset:2048 sc1
    buffer_load_dwordx4 v[92:95], v3, s[8:11], s56 offen offset:3072 sc1
    s_waitcnt vmcnt(12)
    v_mfma_f32_16x16x32_bf16 v[40:43], a[148:151], v[96:99], v[40:43]
    v_mfma_f32_16x16x32_bf16 v[56:59], v[96:99], v[148:151], v[56:59]
    v_mfma_f32_16x16x32_bf16 v[24:27], a[20:23], v[96:99], v[24:27]
    v_mfma_f32_16x16x32_bf16 v[44:47], a[148:151], v[100:103], v[44:47]
    v_mfma_f32_16x16x32_bf16 v[60:63], v[100:103], v[148:151], v[60:63]
    v_mfma_f32_16x16x32_bf16 v[28:31], a[20:23], v[100:103], v[28:31]
    v_mfma_f32_16x16x32_bf16 v[48:51], a[156:159], v[96:99], v[48:51]
    v_mfma_f32_16x16x32_bf16 v[64:67], v[96:99], v[156:159], v[64:67]
    v_mfma_f32_16x16x32_bf16 v[32:35], a[28:31], v[96:99], v[32:35]
    v_mfma_f32_16x16x32_bf16 v[52:55], a[156:159], v[100:103], v[52:55]
    v_mfma_f32_16x16x32_bf16 v[68:71], v[100:103], v[156:159], v[68:71]
    v_mfma_f32_16x16x32_bf16 v[36:39], a[28:31], v[100:103], v[36:39]
    s_xor_b32 s56, s66, 20480
    buffer_load_dwordx4 v[96:99], v2, s[8:11], s56 offen offset:0 sc1
    buffer_load_dwordx4 v[100:103], v3, s[8:11], s56 offen offset:1024 sc1
    s_waitcnt vmcnt(12)
    v_mfma_f32_16x16x32_bf16 v[40:43], a[160:163], v[104:107], v[40:43]
    v_mfma_f32_16x16x32_bf16 v[56:59], v[104:107], v[160:163], v[56:59]
    v_mfma_f32_16x16x32_bf16 v[24:27], a[32:35], v[104:107], v[24:27]
    v_mfma_f32_16x16x32_bf16 v[44:47], a[160:163], v[108:111], v[44:47]
    v_mfma_f32_16x16x32_bf16 v[60:63], v[108:111], v[160:163], v[60:63]
    v_mfma_f32_16x16x32_bf16 v[28:31], a[32:35], v[108:111], v[28:31]
    v_mfma_f32_16x16x32_bf16 v[48:51], a[168:171], v[104:107], v[48:51]
    v_mfma_f32_16x16x32_bf16 v[64:67], v[104:107], v[168:171], v[64:67]
    v_mfma_f32_16x16x32_bf16 v[32:35], a[40:43], v[104:107], v[32:35]
    v_mfma_f32_16x16x32_bf16 v[52:55], a[168:171], v[108:111], v[52:55]
    v_mfma_f32_16x16x32_bf16 v[68:71], v[108:111], v[168:171], v[68:71]
    v_mfma_f32_16x16x32_bf16 v[36:39], a[40:43], v[108:111], v[36:39]
    buffer_load_dwordx4 v[104:107], v2, s[8:11], s56 offen offset:2048 sc1
    buffer_load_dwordx4 v[108:111], v3, s[8:11], s56 offen offset:3072 sc1
    s_waitcnt vmcnt(12)
    v_mfma_f32_16x16x32_bf16 v[40:43], a[164:167], v[112:115], v[40:43]
    v_mfma_f32_16x16x32_bf16 v[56:59], v[112:115], v[164:167], v[56:59]
    v_mfma_f32_16x16x32_bf16 v[24:27], a[36:39], v[112:115], v[24:27]
    v_mfma_f32_16x16x32_bf16 v[44:47], a[164:167], v[116:119], v[44:47]
    v_mfma_f32_16x16x32_bf16 v[60:63], v[116:119], v[164:167], v[60:63]
    v_mfma_f32_16x16x32_bf16 v[28:31], a[36:39], v[116:119], v[28:31]
    v_mfma_f32_16x16x32_bf16 v[48:51], a[172:175], v[112:115], v[48:51]
    v_mfma_f32_16x16x32_bf16 v[64:67], v[112:115], v[172:175], v[64:67]
    v_mfma_f32_16x16x32_bf16 v[32:35], a[44:47], v[112:115], v[32:35]
    v_mfma_f32_16x16x32_bf16 v[52:55], a[172:175], v[116:119], v[52:55]
    v_mfma_f32_16x16x32_bf16 v[68:71], v[116:119], v[172:175], v[68:71]
    v_mfma_f32_16x16x32_bf16 v[36:39], a[44:47], v[116:119], v[36:39]
    s_xor_b32 s56, s66, 24576
    buffer_load_dwordx4 v[112:115], v2, s[8:11], s56 offen offset:0 sc1
    buffer_load_dwordx4 v[116:119], v3, s[8:11], s56 offen offset:1024 sc1
    s_waitcnt vmcnt(12)
    v_mfma_f32_16x16x32_bf16 v[40:43], a[176:179], v[120:123], v[40:43]
    v_mfma_f32_16x16x32_bf16 v[56:59], v[120:123], v[176:179], v[56:59]
    v_mfma_f32_16x16x32_bf16 v[24:27], a[48:51], v[120:123], v[24:27]
    v_mfma_f32_16x16x32_bf16 v[44:47], a[176:179], v[124:127], v[44:47]
    v_mfma_f32_16x16x32_bf16 v[60:63], v[124:127], v[176:179], v[60:63]
    v_mfma_f32_16x16x32_bf16 v[28:31], a[48:51], v[124:127], v[28:31]
    v_mfma_f32_16x16x32_bf16 v[48:51], a[184:187], v[120:123], v[48:51]
    v_mfma_f32_16x16x32_bf16 v[64:67], v[120:123], v[184:187], v[64:67]
    v_mfma_f32_16x16x32_bf16 v[32:35], a[56:59], v[120:123], v[32:35]
    v_mfma_f32_16x16x32_bf16 v[52:55], a[184:187], v[124:127], v[52:55]
    v_mfma_f32_16x16x32_bf16 v[68:71], v[124:127], v[184:187], v[68:71]
    v_mfma_f32_16x16x32_bf16 v[36:39], a[56:59], v[124:127], v[36:39]
    buffer_load_dwordx4 v[120:123], v2, s[8:11], s56 offen offset:2048 sc1
    buffer_load_dwordx4 v[124:127], v3, s[8:11], s56 offen offset:3072 sc1
    s_waitcnt vmcnt(12)
    v_mfma_f32_16x16x32_bf16 v[40:43], a[180:183], v[72:75], v[40:43]
    v_mfma_f32_16x16x32_bf16 v[56:59], v[72:75], v[180:183], v[56:59]
    v_mfma_f32_16x16x32_bf16 v[24:27], a[52:55], v[72:75], v[24:27]
    v_mfma_f32_16x16x32_bf16 v[44:47], a[180:183], v[76:79], v[44:47]
    v_mfma_f32_16x16x32_bf16 v[60:63], v[76:79], v[180:183], v[60:63]
    v_mfma_f32_16x16x32_bf16 v[28:31], a[52:55], v[76:79], v[28:31]
    v_mfma_f32_16x16x32_bf16 v[48:51], a[188:191], v[72:75], v[48:51]
    v_mfma_f32_16x16x32_bf16 v[64:67], v[72:75], v[188:191], v[64:67]
    v_mfma_f32_16x16x32_bf16 v[32:35], a[60:63], v[72:75], v[32:35]
    v_mfma_f32_16x16x32_bf16 v[52:55], a[188:191], v[76:79], v[52:55]
    v_mfma_f32_16x16x32_bf16 v[68:71], v[76:79], v[188:191], v[68:71]
    v_mfma_f32_16x16x32_bf16 v[36:39], a[60:63], v[76:79], v[36:39]
    s_xor_b32 s56, s66, 28672
    buffer_load_dwordx4 v[72:75], v2, s[8:11], s56 offen offset:0 sc1
    buffer_load_dwordx4 v[76:79], v3, s[8:11], s56 offen offset:1024 sc1
    s_waitcnt vmcnt(12)
    v_mfma_f32_16x16x32_bf16 v[40:43], a[192:195], v[80:83], v[40:43]
    v_mfma_f32_16x16x32_bf16 v[56:59], v[80:83], v[192:195], v[56:59]
    v_mfma_f32_16x16x32_bf16 v[24:27], a[64:67], v[80:83], v[24:27]
    v_mfma_f32_16x16x32_bf16 v[44:47], a[192:195], v[84:87], v[44:47]
    v_mfma_f32_16x16x32_bf16 v[60:63], v[84:87], v[192:195], v[60:63]
    v_mfma_f32_16x16x32_bf16 v[28:31], a[64:67], v[84:87], v[28:31]
    v_mfma_f32_16x16x32_bf16 v[48:51], a[200:203], v[80:83], v[48:51]
    v_mfma_f32_16x16x32_bf16 v[64:67], v[80:83], v[200:203], v[64:67]
    v_mfma_f32_16x16x32_bf16 v[32:35], a[72:75], v[80:83], v[32:35]
    v_mfma_f32_16x16x32_bf16 v[52:55], a[200:203], v[84:87], v[52:55]
    v_mfma_f32_16x16x32_bf16 v[68:71], v[84:87], v[200:203], v[68:71]
    v_mfma_f32_16x16x32_bf16 v[36:39], a[72:75], v[84:87], v[36:39]
    buffer_load_dwordx4 v[80:83], v2, s[8:11], s56 offen offset:2048 sc1
    buffer_load_dwordx4 v[84:87], v3, s[8:11], s56 offen offset:3072 sc1
    s_waitcnt vmcnt(12)
    v_mfma_f32_16x16x32_bf16 v[40:43], a[196:199], v[88:91], v[40:43]
    v_mfma_f32_16x16x32_bf16 v[56:59], v[88:91], v[196:199], v[56:59]
    v_mfma_f32_16x16x32_bf16 v[24:27], a[68:71], v[88:91], v[24:27]
    v_mfma_f32_16x16x32_bf16 v[44:47], a[196:199], v[92:95], v[44:47]
    v_mfma_f32_16x16x32_bf16 v[60:63], v[92:95], v[196:199], v[60:63]
    v_mfma_f32_16x16x32_bf16 v[28:31], a[68:71], v[92:95], v[28:31]
    v_mfma_f32_16x16x32_bf16 v[48:51], a[204:207], v[88:91], v[48:51]
    v_mfma_f32_16x16x32_bf16 v[64:67], v[88:91], v[204:207], v[64:67]
    v_mfma_f32_16x16x32_bf16 v[32:35], a[76:79], v[88:91], v[32:35]
    v_mfma_f32_16x16x32_bf16 v[52:55], a[204:207], v[92:95], v[52:55]
    v_mfma_f32_16x16x32_bf16 v[68:71], v[92:95], v[204:207], v[68:71]
    v_mfma_f32_16x16x32_bf16 v[36:39], a[76:79], v[92:95], v[36:39]
    s_waitcnt vmcnt(10)
    v_mfma_f32_16x16x32_bf16 v[40:43], a[208:211], v[96:99], v[40:43]
    v_mfma_f32_16x16x32_bf16 v[56:59], v[96:99], v[208:211], v[56:59]
    v_mfma_f32_16x16x32_bf16 v[24:27], a[80:83], v[96:99], v[24:27]
    v_mfma_f32_16x16x32_bf16 v[44:47], a[208:211], v[100:103], v[44:47]
    v_mfma_f32_16x16x32_bf16 v[60:63], v[100:103], v[208:211], v[60:63]
    v_mfma_f32_16x16x32_bf16 v[28:31], a[80:83], v[100:103], v[28:31]
    v_mfma_f32_16x16x32_bf16 v[48:51], a[216:219], v[96:99], v[48:51]
    v_mfma_f32_16x16x32_bf16 v[64:67], v[96:99], v[216:219], v[64:67]
    v_mfma_f32_16x16x32_bf16 v[32:35], a[88:91], v[96:99], v[32:35]
    v_mfma_f32_16x16x32_bf16 v[52:55], a[216:219], v[100:103], v[52:55]
    v_mfma_f32_16x16x32_bf16 v[68:71], v[100:103], v[216:219], v[68:71]
    v_mfma_f32_16x16x32_bf16 v[36:39], a[88:91], v[100:103], v[36:39]
    s_waitcnt vmcnt(8)
    v_mfma_f32_16x16x32_bf16 v[40:43], a[212:215], v[104:107], v[40:43]
    v_mfma_f32_16x16x32_bf16 v[56:59], v[104:107], v[212:215], v[56:59]
    v_mfma_f32_16x16x32_bf16 v[24:27], a[84:87], v[104:107], v[24:27]
    v_mfma_f32_16x16x32_bf16 v[44:47], a[212:215], v[108:111], v[44:47]
    v_mfma_f32_16x16x32_bf16 v[60:63], v[108:111], v[212:215], v[60:63]
    v_mfma_f32_16x16x32_bf16 v[28:31], a[84:87], v[108:111], v[28:31]
    v_mfma_f32_16x16x32_bf16 v[48:51], a[220:223], v[104:107], v[48:51]
    v_mfma_f32_16x16x32_bf16 v[64:67], v[104:107], v[220:223], v[64:67]
    v_mfma_f32_16x16x32_bf16 v[32:35], a[92:95], v[104:107], v[32:35]
    v_mfma_f32_16x16x32_bf16 v[52:55], a[220:223], v[108:111], v[52:55]
    v_mfma_f32_16x16x32_bf16 v[68:71], v[108:111], v[220:223], v[68:71]
    v_mfma_f32_16x16x32_bf16 v[36:39], a[92:95], v[108:111], v[36:39]
    s_waitcnt vmcnt(6)
    v_mfma_f32_16x16x32_bf16 v[40:43], a[224:227], v[112:115], v[40:43]
    v_mfma_f32_16x16x32_bf16 v[56:59], v[112:115], v[224:227], v[56:59]
    v_mfma_f32_16x16x32_bf16 v[24:27], a[96:99], v[112:115], v[24:27]
    v_mfma_f32_16x16x32_bf16 v[44:47], a[224:227], v[116:119], v[44:47]
    v_mfma_f32_16x16x32_bf16 v[60:63], v[116:119], v[224:227], v[60:63]
    v_mfma_f32_16x16x32_bf16 v[28:31], a[96:99], v[116:119], v[28:31]
    v_mfma_f32_16x16x32_bf16 v[48:51], a[232:235], v[112:115], v[48:51]
    v_mfma_f32_16x16x32_bf16 v[64:67], v[112:115], v[232:235], v[64:67]
    v_mfma_f32_16x16x32_bf16 v[32:35], a[104:107], v[112:115], v[32:35]
    v_mfma_f32_16x16x32_bf16 v[52:55], a[232:235], v[116:119], v[52:55]
    v_mfma_f32_16x16x32_bf16 v[68:71], v[116:119], v[232:235], v[68:71]
    v_mfma_f32_16x16x32_bf16 v[36:39], a[104:107], v[116:119], v[36:39]
    s_waitcnt vmcnt(4)
    v_mfma_f32_16x16x32_bf16 v[40:43], a[228:231], v[120:123], v[40:43]
    v_mfma_f32_16x16x32_bf16 v[56:59], v[120:123], v[228:231], v[56:59]
    v_mfma_f32_16x16x32_bf16 v[24:27], a[100:103], v[120:123], v[24:27]
    v_mfma_f32_16x16x32_bf16 v[44:47], a[228:231], v[124:127], v[44:47]
    v_mfma_f32_16x16x32_bf16 v[60:63], v[124:127], v[228:231], v[60:63]
    v_mfma_f32_16x16x32_bf16 v[28:31], a[100:103], v[124:127], v[28:31]
    v_mfma_f32_16x16x32_bf16 v[48:51], a[236:239], v[120:123], v[48:51]
    v_mfma_f32_16x16x32_bf16 v[64:67], v[120:123], v[236:239], v[64:67]
    v_mfma_f32_16x16x32_bf16 v[32:35], a[108:111], v[120:123], v[32:35]
    v_mfma_f32_16x16x32_bf16 v[52:55], a[236:239], v[124:127], v[52:55]
    v_mfma_f32_16x16x32_bf16 v[68:71], v[124:127], v[236:239], v[68:71]
    v_mfma_f32_16x16x32_bf16 v[36:39], a[108:111], v[124:127], v[36:39]
    s_waitcnt vmcnt(2)
    v_mfma_f32_16x16x32_bf16 v[40:43], a[240:243], v[72:75], v[40:43]
    v_mfma_f32_16x16x32_bf16 v[56:59], v[72:75], v[240:243], v[56:59]
    v_mfma_f32_16x16x32_bf16 v[24:27], a[112:115], v[72:75], v[24:27]
    v_mfma_f32_16x16x32_bf16 v[44:47], a[240:243], v[76:79], v[44:47]
    v_mfma_f32_16x16x32_bf16 v[60:63], v[76:79], v[240:243], v[60:63]
    v_mfma_f32_16x16x32_bf16 v[28:31], a[112:115], v[76:79], v[28:31]
    v_mfma_f32_16x16x32_bf16 v[48:51], a[248:251], v[72:75], v[48:51]
    v_mfma_f32_16x16x32_bf16 v[64:67], v[72:75], v[248:251], v[64:67]
    v_mfma_f32_16x16x32_bf16 v[32:35], a[120:123], v[72:75], v[32:35]
    v_mfma_f32_16x16x32_bf16 v[52:55], a[248:251], v[76:79], v[52:55]
    v_mfma_f32_16x16x32_bf16 v[68:71], v[76:79], v[248:251], v[68:71]
    v_mfma_f32_16x16x32_bf16 v[36:39], a[120:123], v[76:79], v[36:39]
    s_waitcnt vmcnt(0)
    v_mfma_f32_16x16x32_bf16 v[40:43], a[244:247], v[80:83], v[40:43]
    v_mfma_f32_16x16x32_bf16 v[56:59], v[80:83], v[244:247], v[56:59]
    v_mfma_f32_16x16x32_bf16 v[24:27], a[116:119], v[80:83], v[24:27]
    v_mfma_f32_16x16x32_bf16 v[44:47], a[244:247], v[84:87], v[44:47]
    v_mfma_f32_16x16x32_bf16 v[60:63], v[84:87], v[244:247], v[60:63]
    v_mfma_f32_16x16x32_bf16 v[28:31], a[116:119], v[84:87], v[28:31]
    v_mfma_f32_16x16x32_bf16 v[48:51], a[252:255], v[80:83], v[48:51]
    v_mfma_f32_16x16x32_bf16 v[64:67], v[80:83], v[252:255], v[64:67]
    v_mfma_f32_16x16x32_bf16 v[32:35], a[124:127], v[80:83], v[32:35]
    v_mfma_f32_16x16x32_bf16 v[52:55], a[252:255], v[84:87], v[52:55]
    v_mfma_f32_16x16x32_bf16 v[68:71], v[84:87], v[252:255], v[68:71]
    v_mfma_f32_16x16x32_bf16 v[36:39], a[124:127], v[84:87], v[36:39]
    v_cvt_pk_bf16_f32 v72, v40, v48
    v_cvt_pk_bf16_f32 v73, v41, v49
    v_cvt_pk_bf16_f32 v74, v42, v50
    v_cvt_pk_bf16_f32 v75, v43, v51
    buffer_store_dwordx4 v[72:75], v0, s[8:11], s61 offen sc1
    v_cvt_pk_bf16_f32 v76, v44, v52
    v_cvt_pk_bf16_f32 v77, v45, v53
    v_cvt_pk_bf16_f32 v78, v46, v54
    v_cvt_pk_bf16_f32 v79, v47, v55
    buffer_store_dwordx4 v[76:79], v0, s[8:11], s62 offen sc1
    v_cvt_pk_bf16_f32 v88, v56, v57
    v_cvt_pk_bf16_f32 v89, v58, v59
    v_cvt_pk_bf16_f32 v90, v60, v61
    v_cvt_pk_bf16_f32 v91, v62, v63
    buffer_store_dwordx4 v[88:91], v0, s[8:11], s65 offen offset:0 sc1
    v_cvt_pk_bf16_f32 v92, v64, v65
    v_cvt_pk_bf16_f32 v93, v66, v67
    v_cvt_pk_bf16_f32 v94, v68, v69
    v_cvt_pk_bf16_f32 v95, v70, v71
    buffer_store_dwordx4 v[92:95], v0, s[8:11], s65 offen offset:1024 sc1
    v_cvt_pk_bf16_f32 v80, v24, v32
    v_cvt_pk_bf16_f32 v81, v25, v33
    v_cvt_pk_bf16_f32 v82, v26, v34
    v_cvt_pk_bf16_f32 v83, v27, v35
    buffer_store_dwordx4 v[80:83], v0, s[8:11], s63 offen sc1
    v_cvt_pk_bf16_f32 v84, v28, v36
    v_cvt_pk_bf16_f32 v85, v29, v37
    v_cvt_pk_bf16_f32 v86, v30, v38
    v_cvt_pk_bf16_f32 v87, v31, v39
    buffer_store_dwordx4 v[84:87], v0, s[8:11], s64 offen sc1
    s_lshl_b32 s59, s51, 13
    s_lshl2_add_u32 s59, s47, s59
    s_add_u32 s59, s59, 10486016
    s_waitcnt vmcnt(0)
    s_barrier
    s_cmp_lg_u32 s46, 0
    s_cbranch_scc1 L_fs_45
    v_mov_b32 v124, 0
    v_mov_b32 v125, 1
    s_mov_b64 exec, 1
    buffer_store_dword v125, v124, s[8:11], s59 offen sc1
    s_mov_b64 exec, -1
L_fs_45:
L_mon_38:
    s_add_u32 s51, s51, 1
    s_cmp_lt_u32 s51, 64
    s_cbranch_scc1 L_mo_37
    v_lshrrev_b32 v2, 3, v1
    v_lshlrev_b32 v2, 13, v2
    v_and_b32 v3, 7, v1
    v_lshl_add_u32 v2, v3, 4, v2
L_mw_46:
    s_sleep 2
    s_mov_b32 s56, 10487296
    buffer_load_dwordx4 v[24:27], v2, s[8:11], s56 offen sc1
    s_mov_b32 s56, 10552832
    buffer_load_dwordx4 v[28:31], v2, s[8:11], s56 offen sc1
    s_mov_b32 s56, 10618368
    buffer_load_dwordx4 v[32:35], v2, s[8:11], s56 offen sc1
    s_mov_b32 s56, 10683904
    buffer_load_dwordx4 v[36:39], v2, s[8:11], s56 offen sc1
    s_mov_b32 s56, 10749440
    buffer_load_dwordx4 v[40:43], v2, s[8:11], s56 offen sc1
    s_mov_b32 s56, 10814976
    buffer_load_dwordx4 v[44:47], v2, s[8:11], s56 offen sc1
    s_mov_b32 s56, 10880512
    buffer_load_dwordx4 v[48:51], v2, s[8:11], s56 offen sc1
    s_mov_b32 s56, 10946048
    buffer_load_dwordx4 v[52:55], v2, s[8:11], s56 offen sc1
    s_sub_u32 s49, s49, 1
    s_cbranch_scc1 L_abort
    s_waitcnt vmcnt(0)
    v_min_u32 v56, v24, v25
    v_min3_u32 v56, v26, v27, v56
    v_min3_u32 v56, v28, v29, v56
    v_min3_u32 v56, v30, v31, v56
    v_min3_u32 v56, v32, v33, v56
    v_min3_u32 v56, v34, v35, v56
    v_min3_u32 v56, v36, v37, v56
    v_min3_u32 v56, v38, v39, v56
    v_min3_u32 v56, v40, v41, v56
    v_min3_u32 v56, v42, v43, v56
    v_min3_u32 v56, v44, v45, v56
    v_min3_u32 v56, v46, v47, v56
    v_min3_u32 v56, v48, v49, v56
    v_min3_u32 v56, v50, v51, v56
    v_min3_u32 v56, v52, v53, v56
    v_min3_u32 v56, v54, v55, v56
    v_cmp_eq_u32 vcc, 0, v56
    s_cbranch_vccnz L_mw_46
    v_max_u32 v24, v24, v25
    v_max3_u32 v24, v26, v27, v24
    v_max3_u32 v24, v28, v29, v24
    v_max3_u32 v24, v30, v31, v24
    v_max3_u32 v24, v32, v33, v24
    v_max3_u32 v24, v34, v35, v24
    v_max3_u32 v24, v36, v37, v24
    v_max3_u32 v24, v38, v39, v24
    v_max3_u32 v24, v40, v41, v24
    v_max3_u32 v24, v42, v43, v24
    v_max3_u32 v24, v44, v45, v24
    v_max3_u32 v24, v46, v47, v24
    v_max3_u32 v24, v48, v49, v24
    v_max3_u32 v24, v50, v51, v24
    v_max3_u32 v24, v52, v53, v24
    v_max3_u32 v24, v54, v55, v24
    s_nop 1
    v_max_u32_dpp v24, v24, v24 row_ror:8 row_mask:0xf bank_mask:0xf
    s_nop 1
    v_max_u32_dpp v24, v24, v24 row_ror:4 row_mask:0xf bank_mask:0xf
    s_nop 1
    v_max_u32_dpp v24, v24, v24 row_ror:2 row_mask:0xf bank_mask:0xf
    s_nop 1
    v_max_u32_dpp v24, v24, v24 row_ror:1 row_mask:0xf bank_mask:0xf
    v_mov_b32 v25, v24
    s_nop 1
    v_permlane16_swap_b32 v24, v25
    v_max_u32 v24, v24, v25
    v_mov_b32 v25, v24
    s_nop 1
    v_permlane32_swap_b32 v24, v25
    v_max_u32 v24, v24, v25
    s_nop 0
    v_readfirstlane_b32 s55, v24
    s_and_b32 s64, s55, 0x7ff
    s_sub_u32 s64, 2047, s64
    s_lshl_b32 s56, s64, 10
    s_lshr_b32 s57, s64, 5
    s_lshl_b32 s57, s57, 15
    s_bfe_u32 s58, s64, 0x10004
    s_lshl_b32 s58, s58, 10
    s_add_u32 s57, s57, s58
    s_and_b32 s58, s64, 15
    s_lshl_b32 s58, s58, 4
    s_add_u32 s57, s57, s58
    s_add_u32 s57, s57, 37748736
    s_add_u32 s58, s56, 6291456
    buffer_load_dwordx4 v[88:91], v0, s[8:11], s58 offen sc1
    s_mov_b32 s4, s38
    s_mov_b32 s5, s39
    s_mov_b32 s6, 1835008
    s_mov_b32 s7, 0x20000
    v_and_b32 v5, 15, v1
    v_lshrrev_b32 v6, 4, v1
    v_lshlrev_b32 v4, 14, v6
    v_lshl_add_u32 v4, v5, 4, v4
    s_lshl_b32 s59, s47, 16
    s_lshl_b32 s60, s46, 8
    s_add_u32 s59, s59, s60
    buffer_load_dwordx4 v[24:27], v4, s[4:7], s59 offen offset:0
    buffer_load_dwordx4 v[28:31], v4, s[4:7], s59 offen offset:1024
    buffer_load_dwordx4 v[32:35], v4, s[4:7], s59 offen offset:2048
    buffer_load_dwordx4 v[36:39], v4, s[4:7], s59 offen offset:3072
    s_add_u32 s59, s59, 4096
    buffer_load_dwordx4 v[40:43], v4, s[4:7], s59 offen offset:0
    buffer_load_dwordx4 v[44:47], v4, s[4:7], s59 offen offset:1024
    buffer_load_dwordx4 v[48:51], v4, s[4:7], s59 offen offset:2048
    buffer_load_dwordx4 v[52:55], v4, s[4:7], s59 offen offset:3072
    s_add_u32 s59, s59, 4096
    buffer_load_dwordx4 v[56:59], v4, s[4:7], s59 offen offset:0
    buffer_load_dwordx4 v[60:63], v4, s[4:7], s59 offen offset:1024
    buffer_load_dwordx4 v[64:67], v4, s[4:7], s59 offen offset:2048
    buffer_load_dwordx4 v[68:71], v4, s[4:7], s59 offen offset:3072
    s_add_u32 s59, s59, 4096
    buffer_load_dwordx4 v[72:75], v4, s[4:7], s59 offen offset:0
    buffer_load_dwordx4 v[76:79], v4, s[4:7], s59 offen offset:1024
    buffer_load_dwordx4 v[80:83], v4, s[4:7], s59 offen offset:2048
    buffer_load_dwordx4 v[84:87], v4, s[4:7], s59 offen offset:3072
    v_and_b32 v124, 1, v1
    v_lshlrev_b32 v124, 4, v124
    v_mov_b32 v125, 0xffff
    v_lshlrev_b32 v125, v124, v125
    v_lshrrev_b32 v124, 1, v5
    v_cmp_eq_u32 vcc, 0, v124
    s_nop 1
    v_cndmask_b32 v120, 0, v125, vcc
    v_cmp_eq_u32 vcc, 1, v124
    s_nop 1
    v_cndmask_b32 v121, 0, v125, vcc
    v_cmp_eq_u32 vcc, 2, v124
    s_nop 1
    v_cndmask_b32 v122, 0, v125, vcc
    v_cmp_eq_u32 vcc, 3, v124
    s_nop 1
    v_cndmask_b32 v123, 0, v125, vcc
    s_waitcnt vmcnt(16)
    v_lshlrev_b32 v96, 16, v88
    v_and_b32 v97, 0xffff0000, v88
    v_lshlrev_b32 v98, 16, v89
    v_and_b32 v99, 0xffff0000, v89
    v_lshlrev_b32 v100, 16, v90
    v_and_b32 v101, 0xffff0000, v90
    v_lshlrev_b32 v102, 16, v91
    v_and_b32 v103, 0xffff0000, v91
    v_add_f32 v116, v96, v97
    v_add_f32 v117, v98, v99
    v_add_f32 v118, v100, v101
    v_add_f32 v119, v102, v103
    v_add_f32 v116, v116, v117
    v_add_f32 v118, v118, v119
    v_add_f32 v116, v116, v118
    s_nop 1
    v_add_f32_dpp v116, v116, v116 row_ror:8 row_mask:0xf bank_mask:0xf
    s_nop 1
    v_add_f32_dpp v116, v116, v116 row_ror:4 row_mask:0xf bank_mask:0xf
    s_nop 1
    v_add_f32_dpp v116, v116, v116 row_ror:2 row_mask:0xf bank_mask:0xf
    s_nop 1
    v_add_f32_dpp v116, v116, v116 row_ror:1 row_mask:0xf bank_mask:0xf
    v_mov_b32 v117, v116
    s_nop 1
    v_permlane16_swap_b32 v116, v117
    v_add_f32 v116, v116, v117
    v_mov_b32 v117, v116
    s_nop 1
    v_permlane32_swap_b32 v116, v117
    v_add_f32 v116, v116, v117
    v_mul_f32 v118, 0x3b000000, v116
    v_sub_f32 v108, v96, v118
    v_sub_f32 v109, v97, v118
    v_sub_f32 v110, v98, v118
    v_sub_f32 v111, v99, v118
    v_sub_f32 v112, v100, v118
    v_sub_f32 v113, v101, v118
    v_sub_f32 v114, v102, v118
    v_sub_f32 v115, v103, v118
    v_mul_f32 v116, v108, v108
    v_mul_f32 v119, v109, v109
    v_fmac_f32 v116, v110, v110
    v_fmac_f32 v119, v111, v111
    v_fmac_f32 v116, v112, v112
    v_fmac_f32 v119, v113, v113
    v_fmac_f32 v116, v114, v114
    v_fmac_f32 v119, v115, v115
    v_add_f32 v116, v116, v119
    v_cvt_pk_bf16_f32 v118, v118, v118
    v_and_b32 v118, 0xffff0000, v118
    v_add_f32_dpp v116, v116, v116 row_ror:8 row_mask:0xf bank_mask:0xf
    s_nop 1
    v_add_f32_dpp v116, v116, v116 row_ror:4 row_mask:0xf bank_mask:0xf
    s_nop 1
    v_add_f32_dpp v116, v116, v116 row_ror:2 row_mask:0xf bank_mask:0xf
    s_nop 1
    v_add_f32_dpp v116, v116, v116 row_ror:1 row_mask:0xf bank_mask:0xf
    v_mov_b32 v117, v116
    s_nop 1
    v_permlane16_swap_b32 v116, v117
    v_add_f32 v116, v116, v117
    v_mov_b32 v117, v116
    s_nop 1
    v_permlane32_swap_b32 v116, v117
    v_add_f32 v116, v116, v117
    v_mul_f32 v116, 0x3b000000, v116
    v_cvt_pk_bf16_f32 v116, v116, v116
    v_and_b32 v116, 0xffff0000, v116
    v_add_f32 v116, 0x3727c5ac, v116
    v_cvt_pk_bf16_f32 v116, v116, v116
    v_and_b32 v116, 0xffff0000, v116
    v_sqrt_f32 v116, v116
    v_sub_f32 v108, v96, v118
    v_sub_f32 v109, v97, v118
    v_sub_f32 v110, v98, v118
    v_sub_f32 v111, v99, v118
    v_sub_f32 v112, v100, v118
    v_sub_f32 v113, v101, v118
    v_sub_f32 v114, v102, v118
    v_sub_f32 v115, v103, v118
    v_cvt_pk_bf16_f32 v116, v116, v116
    v_and_b32 v116, 0xffff0000, v116
    v_rcp_f32 v116, v116
    v_cvt_pk_bf16_f32 v104, v108, v109
    v_cvt_pk_bf16_f32 v105, v110, v111
    v_cvt_pk_bf16_f32 v106, v112, v113
    v_cvt_pk_bf16_f32 v107, v114, v115
    v_lshlrev_b32 v108, 16, v104
    v_and_b32 v109, 0xffff0000, v104
    v_lshlrev_b32 v110, 16, v105
    v_and_b32 v111, 0xffff0000, v105
    v_lshlrev_b32 v112, 16, v106
    v_and_b32 v113, 0xffff0000, v106
    v_lshlrev_b32 v114, 16, v107
    v_and_b32 v115, 0xffff0000, v107
    v_mul_f32 v108, v108, v116
    v_mul_f32 v109, v109, v116
    v_mul_f32 v110, v110, v116
    v_mul_f32 v111, v111, v116
    v_mul_f32 v112, v112, v116
    v_mul_f32 v113, v113, v116
    v_mul_f32 v114, v114, v116
    v_mul_f32 v115, v115, v116
    v_cvt_pk_bf16_f32 v104, v108, v109
    v_cvt_pk_bf16_f32 v105, v110, v111
    v_cvt_pk_bf16_f32 v106, v112, v113
    v_cvt_pk_bf16_f32 v107, v114, v115
    s_mov_b32 s58, 0x01000100
    s_mov_b32 s59, 0x03020302
    v_perm_b32 v88, v104, v104, s58
    v_perm_b32 v89, v104, v104, s59
    v_perm_b32 v90, v105, v105, s58
    v_perm_b32 v91, v105, v105, s59
    v_perm_b32 v92, v106, v106, s58
    v_perm_b32 v93, v106, v106, s59
    v_perm_b32 v94, v107, v107, s58
    v_perm_b32 v95, v107, v107, s59
    v_lshlrev_b32 v4, 5, v1
    s_lshl_b32 s58, s46, 11
    s_add_u32 s58, s58, 147456
    v_add_u32 v4, s58, v4
    ds_write_b128 v4, v[88:91]
    ds_write_b128 v4, v[92:95] offset:16
    s_lshl_b32 s59, s46, 9
    s_add_u32 s59, s58, s59
    v_lshlrev_b32 v4, 7, v6
    v_add_u32 v4, s59, v4
    s_waitcnt lgkmcnt(0)
    ds_read_b128 v[108:111], v18 offset:0
    ds_read_b128 v[88:91], v4 offset:0
    ds_read_b128 v[92:95], v4 offset:16
    ds_read_b128 v[112:115], v18 offset:1024
    s_waitcnt lgkmcnt(1)
    v_and_b32 v124, v120, v88
    v_and_b32 v125, v121, v88
    v_and_b32 v126, v122, v88
    v_and_b32 v127, v123, v88
    s_nop 1
    v_mfma_f32_16x16x32_bf16 v[116:119], v[124:127], v[108:111], 0
    ds_read_b128 v[108:111], v18 offset:2048
    s_waitcnt lgkmcnt(1)
    v_and_b32 v124, v120, v89
    v_and_b32 v125, v121, v89
    v_and_b32 v126, v122, v89
    v_and_b32 v127, v123, v89
    s_nop 1
    v_mfma_f32_16x16x32_bf16 v[116:119], v[124:127], v[112:115], v[116:119]
    ds_read_b128 v[112:115], v18 offset:3072
    s_waitcnt lgkmcnt(1)
    v_and_b32 v124, v120, v90
    v_and_b32 v125, v121, v90
    v_and_b32 v126, v122, v90
    v_and_b32 v127, v123, v90
    s_nop 1
    v_mfma_f32_16x16x32_bf16 v[116:119], v[124:127], v[108:111], v[116:119]
    ds_read_b128 v[108:111], v18 offset:4096
    s_waitcnt lgkmcnt(1)
    v_and_b32 v124, v120, v91
    v_and_b32 v125, v121, v91
    v_and_b32 v126, v122, v91
    v_and_b32 v127, v123, v91
    s_nop 1
    v_mfma_f32_16x16x32_bf16 v[116:119], v[124:127], v[112:115], v[116:119]
    ds_read_b128 v[112:115], v18 offset:5120
    s_waitcnt lgkmcnt(1)
    v_and_b32 v124, v120, v92
    v_and_b32 v125, v121, v92
    v_and_b32 v126, v122, v92
    v_and_b32 v127, v123, v92
    s_nop 1
    v_mfma_f32_16x16x32_bf16 v[116:119], v[124:127], v[108:111], v[116:119]
    ds_read_b128 v[108:111], v18 offset:6144
    s_waitcnt lgkmcnt(1)
    v_and_b32 v124, v120, v93
    v_and_b32 v125, v121, v93
    v_and_b32 v126, v122, v93
    v_and_b32 v127, v123, v93
    s_nop 1
    v_mfma_f32_16x16x32_bf16 v[116:119], v[124:127], v[112:115], v[116:119]
    ds_read_b128 v[112:115], v18 offset:7168
    s_waitcnt lgkmcnt(1)
    v_and_b32 v124, v120, v94
    v_and_b32 v125, v121, v94
    v_and_b32 v126, v122, v94
    v_and_b32 v127, v123, v94
    s_nop 1
    v_mfma_f32_16x16x32_bf16 v[116:119], v[124:127], v[108:111], v[116:119]
    ds_read_b128 v[108:111], v18 offset:8192
    s_waitcnt lgkmcnt(1)
    v_and_b32 v124, v120, v95
    v_and_b32 v125, v121, v95
    v_and_b32 v126, v122, v95
    v_and_b32 v127, v123, v95
    s_nop 1
    v_mfma_f32_16x16x32_bf16 v[116:119], v[124:127], v[112:115], v[116:119]
    ds_read_b128 v[88:91], v4 offset:32
    ds_read_b128 v[92:95], v4 offset:48
    ds_read_b128 v[112:115], v18 offset:9216
    s_waitcnt lgkmcnt(1)
    v_and_b32 v124, v120, v88
    v_and_b32 v125, v121, v88
    v_and_b32 v126, v122, v88
    v_and_b32 v127, v123, v88
    s_nop 1
    v_mfma_f32_16x16x32_bf16 v[116:119], v[124:127], v[108:111], v[116:119]
    ds_read_b128 v[108:111], v18 offset:10240
    s_waitcnt lgkmcnt(1)
    v_and_b32 v124, v120, v89
    v_and_b32 v125, v121, v89
    v_and_b32 v126, v122, v89
    v_and_b32 v127, v123, v89
    s_nop 1
    v_mfma_f32_16x16x32_bf16 v[116:119], v[124:127], v[112:115], v[116:119]
    ds_read_b128 v[112:115], v18 offset:11264
    s_waitcnt lgkmcnt(1)
    v_and_b32 v124, v120, v90
    v_and_b32 v125, v121, v90
    v_and_b32 v126, v122, v90
    v_and_b32 v127, v123, v90
    s_nop 1
    v_mfma_f32_16x16x32_bf16 v[116:119], v[124:127], v[108:111], v[116:119]
    ds_read_b128 v[108:111], v18 offset:12288
    s_waitcnt lgkmcnt(1)
    v_and_b32 v124, v120, v91
    v_and_b32 v125, v121, v91
    v_and_b32 v126, v122, v91
    v_and_b32 v127, v123, v91
    s_nop 1
    v_mfma_f32_16x16x32_bf16 v[116:119], v[124:127], v[112:115], v[116:119]
    ds_read_b128 v[112:115], v18 offset:13312
    s_waitcnt lgkmcnt(1)
    v_and_b32 v124, v120, v92
    v_and_b32 v125, v121, v92
    v_and_b32 v126, v122, v92
    v_and_b32 v127, v123, v92
    s_nop 1
    v_mfma_f32_16x16x32_bf16 v[116:119], v[124:127], v[108:111], v[116:119]
    ds_read_b128 v[108:111], v18 offset:14336
    s_waitcnt lgkmcnt(1)
    v_and_b32 v124, v120, v93
    v_and_b32 v125, v121, v93
    v_and_b32 v126, v122, v93
    v_and_b32 v127, v123, v93
    s_nop 1
    v_mfma_f32_16x16x32_bf16 v[116:119], v[124:127], v[112:115], v[116:119]
    ds_read_b128 v[112:115], v18 offset:15360
    s_waitcnt lgkmcnt(1)
    v_and_b32 v124, v120, v94
    v_and_b32 v125, v121, v94
    v_and_b32 v126, v122, v94
    v_and_b32 v127, v123, v94
    s_nop 1
    v_mfma_f32_16x16x32_bf16 v[116:119], v[124:127], v[108:111], v[116:119]
    ds_read_b128 v[108:111], v18 offset:16384
    s_waitcnt lgkmcnt(1)
    v_and_b32 v124, v120, v95
    v_and_b32 v125, v121, v95
    v_and_b32 v126, v122, v95
    v_and_b32 v127, v123, v95
    s_nop 1
    v_mfma_f32_16x16x32_bf16 v[116:119], v[124:127], v[112:115], v[116:119]
    ds_read_b128 v[88:91], v4 offset:64
    ds_read_b128 v[92:95], v4 offset:80
    ds_read_b128 v[112:115], v18 offset:17408
    s_waitcnt lgkmcnt(1)
    v_and_b32 v124, v120, v88
    v_and_b32 v125, v121, v88
    v_and_b32 v126, v122, v88
    v_and_b32 v127, v123, v88
    s_nop 1
    v_mfma_f32_16x16x32_bf16 v[116:119], v[124:127], v[108:111], v[116:119]
    ds_read_b128 v[108:111], v18 offset:18432
    s_waitcnt lgkmcnt(1)
    v_and_b32 v124, v120, v89
    v_and_b32 v125, v121, v89
    v_and_b32 v126, v122, v89
    v_and_b32 v127, v123, v89
    s_nop 1
    v_mfma_f32_16x16x32_bf16 v[116:119], v[124:127], v[112:115], v[116:119]
    ds_read_b128 v[112:115], v18 offset:19456
    s_waitcnt lgkmcnt(1)
    v_and_b32 v124, v120, v90
    v_and_b32 v125, v121, v90
    v_and_b32 v126, v122, v90
    v_and_b32 v127, v123, v90
    s_nop 1
    v_mfma_f32_16x16x32_bf16 v[116:119], v[124:127], v[108:111], v[116:119]
    ds_read_b128 v[108:111], v18 offset:20480
    s_waitcnt lgkmcnt(1)
    v_and_b32 v124, v120, v91
    v_and_b32 v125, v121, v91
    v_and_b32 v126, v122, v91
    v_and_b32 v127, v123, v91
    s_nop 1
    v_mfma_f32_16x16x32_bf16 v[116:119], v[124:127], v[112:115], v[116:119]
    ds_read_b128 v[112:115], v18 offset:21504
    s_waitcnt lgkmcnt(1)
    v_and_b32 v124, v120, v92
    v_and_b32 v125, v121, v92
    v_and_b32 v126, v122, v92
    v_and_b32 v127, v123, v92
    s_nop 1
    v_mfma_f32_16x16x32_bf16 v[116:119], v[124:127], v[108:111], v[116:119]
    ds_read_b128 v[108:111], v18 offset:22528
    s_waitcnt lgkmcnt(1)
    v_and_b32 v124, v120, v93
    v_and_b32 v125, v121, v93
    v_and_b32 v126, v122, v93
    v_and_b32 v127, v123, v93
    s_nop 1
    v_mfma_f32_16x16x32_bf16 v[116:119], v[124:127], v[112:115], v[116:119]
    ds_read_b128 v[112:115], v18 offset:23552
    s_waitcnt lgkmcnt(1)
    v_and_b32 v124, v120, v94
    v_and_b32 v125, v121, v94
    v_and_b32 v126, v122, v94
    v_and_b32 v127, v123, v94
    s_nop 1
    v_mfma_f32_16x16x32_bf16 v[116:119], v[124:127], v[108:111], v[116:119]
    ds_read_b128 v[108:111], v18 offset:24576
    s_waitcnt lgkmcnt(1)
    v_and_b32 v124, v120, v95
    v_and_b32 v125, v121, v95
    v_and_b32 v126, v122, v95
    v_and_b32 v127, v123, v95
    s_nop 1
    v_mfma_f32_16x16x32_bf16 v[116:119], v[124:127], v[112:115], v[116:119]
    ds_read_b128 v[88:91], v4 offset:96
    ds_read_b128 v[92:95], v4 offset:112
    ds_read_b128 v[112:115], v18 offset:25600
    s_waitcnt lgkmcnt(1)
    v_and_b32 v124, v120, v88
    v_and_b32 v125, v121, v88
    v_and_b32 v126, v122, v88
    v_and_b32 v127, v123, v88
    s_nop 1
    v_mfma_f32_16x16x32_bf16 v[116:119], v[124:127], v[108:111], v[116:119]
    ds_read_b128 v[108:111], v18 offset:26624
    s_waitcnt lgkmcnt(1)
    v_and_b32 v124, v120, v89
    v_and_b32 v125, v121, v89
    v_and_b32 v126, v122, v89
    v_and_b32 v127, v123, v89
    s_nop 1
    v_mfma_f32_16x16x32_bf16 v[116:119], v[124:127], v[112:115], v[116:119]
    ds_read_b128 v[112:115], v18 offset:27648
    s_waitcnt lgkmcnt(1)
    v_and_b32 v124, v120, v90
    v_and_b32 v125, v121, v90
    v_and_b32 v126, v122, v90
    v_and_b32 v127, v123, v90
    s_nop 1
    v_mfma_f32_16x16x32_bf16 v[116:119], v[124:127], v[108:111], v[116:119]
    ds_read_b128 v[108:111], v18 offset:28672
    s_waitcnt lgkmcnt(1)
    v_and_b32 v124, v120, v91
    v_and_b32 v125, v121, v91
    v_and_b32 v126, v122, v91
    v_and_b32 v127, v123, v91
    s_nop 1
    v_mfma_f32_16x16x32_bf16 v[116:119], v[124:127], v[112:115], v[116:119]
    ds_read_b128 v[112:115], v18 offset:29696
    s_waitcnt lgkmcnt(1)
    v_and_b32 v124, v120, v92
    v_and_b32 v125, v121, v92
    v_and_b32 v126, v122, v92
    v_and_b32 v127, v123, v92
    s_nop 1
    v_mfma_f32_16x16x32_bf16 v[116:119], v[124:127], v[108:111], v[116:119]
    ds_read_b128 v[108:111], v18 offset:30720
    s_waitcnt lgkmcnt(1)
    v_and_b32 v124, v120, v93
    v_and_b32 v125, v121, v93
    v_and_b32 v126, v122, v93
    v_and_b32 v127, v123, v93
    s_nop 1
    v_mfma_f32_16x16x32_bf16 v[116:119], v[124:127], v[112:115], v[116:119]
    ds_read_b128 v[112:115], v18 offset:31744
    s_waitcnt lgkmcnt(1)
    v_and_b32 v124, v120, v94
    v_and_b32 v125, v121, v94
    v_and_b32 v126, v122, v94
    v_and_b32 v127, v123, v94
    s_nop 1
    v_mfma_f32_16x16x32_bf16 v[116:119], v[124:127], v[108:111], v[116:119]
    s_waitcnt lgkmcnt(0)
    v_and_b32 v124, v120, v95
    v_and_b32 v125, v121, v95
    v_and_b32 v126, v122, v95
    v_and_b32 v127, v123, v95
    s_nop 1
    v_mfma_f32_16x16x32_bf16 v[116:119], v[124:127], v[112:115], v[116:119]
    v_lshlrev_b32 v4, 5, v5
    v_and_b32 v124, 1, v6
    v_lshl_add_u32 v4, v124, 4, v4
    v_lshrrev_b32 v124, 1, v6
    v_lshl_add_u32 v4, v124, 11, v4
    s_lshl_b32 s60, s46, 9
    s_add_u32 s60, s60, 155648
    v_add_u32 v4, s60, v4
    ds_write_b128 v4, v[116:119]
    v_lshlrev_b32 v4, 2, v1
    v_add_u32 v4, 155648, v4
    s_waitcnt lgkmcnt(0)
    s_barrier
    ds_read2st64_b32 v[88:89], v4 offset0:0 offset1:1
    ds_read2st64_b32 v[90:91], v4 offset0:2 offset1:3
    ds_read2st64_b32 v[92:93], v4 offset0:4 offset1:5
    ds_read2st64_b32 v[94:95], v4 offset0:6 offset1:7
    s_waitcnt lgkmcnt(0)
    v_pk_add_f32 v[88:89], v[88:89], v[90:91]
    v_pk_add_f32 v[92:93], v[92:93], v[94:95]
    v_pk_add_f32 v[88:89], v[88:89], v[92:93]
    v_cvt_pk_bf16_f32 v88, v88, v88
    v_and_b32 v88, 0xffff0000, v88
    v_cvt_pk_bf16_f32 v89, v89, v89
    v_and_b32 v89, 0xffff0000, v89
    v_mul_f32 v90, 0xbfb8aa3b, v88
    v_exp_f32 v90, v90
    s_nop 0
    v_add_f32 v90, 1.0, v90
    v_rcp_f32 v90, v90
    s_nop 0
    v_mul_f32 v88, v88, v90
    v_cvt_pk_bf16_f32 v88, v88, v88
    v_and_b32 v88, 0xffff0000, v88
    v_mul_f32 v88, v88, v89
    v_cvt_pk_bf16_f32 v88, v88, v88
    v_lshlrev_b32 v4, 2, v1
    v_add_u32 v4, s58, v4
    ds_write_b32 v4, v88
    v_lshlrev_b32 v4, 6, v6
    v_add_u32 v4, s58, v4
    s_waitcnt lgkmcnt(0)
    ds_read_b128 v[88:91], v4
    ds_read_b128 v[92:95], v4 offset:16
    ds_read_b128 v[108:111], v4 offset:32
    ds_read_b128 v[112:115], v4 offset:48
    s_waitcnt vmcnt(0) lgkmcnt(0)
    v_and_b32 v124, v120, v88
    v_and_b32 v125, v121, v88
    v_and_b32 v126, v122, v88
    v_and_b32 v127, v123, v88
    s_nop 1
    v_mfma_f32_16x16x32_bf16 v[116:119], v[124:127], v[24:27], 0
    v_and_b32 v124, v120, v89
    v_and_b32 v125, v121, v89
    v_and_b32 v126, v122, v89
    v_and_b32 v127, v123, v89
    s_nop 1
    v_mfma_f32_16x16x32_bf16 v[116:119], v[124:127], v[28:31], v[116:119]
    v_and_b32 v124, v120, v90
    v_and_b32 v125, v121, v90
    v_and_b32 v126, v122, v90
    v_and_b32 v127, v123, v90
    s_nop 1
    v_mfma_f32_16x16x32_bf16 v[116:119], v[124:127], v[32:35], v[116:119]
    v_and_b32 v124, v120, v91
    v_and_b32 v125, v121, v91
    v_and_b32 v126, v122, v91
    v_and_b32 v127, v123, v91
    s_nop 1
    v_mfma_f32_16x16x32_bf16 v[116:119], v[124:127], v[36:39], v[116:119]
    v_and_b32 v124, v120, v92
    v_and_b32 v125, v121, v92
    v_and_b32 v126, v122, v92
    v_and_b32 v127, v123, v92
    s_nop 1
    v_mfma_f32_16x16x32_bf16 v[116:119], v[124:127], v[40:43], v[116:119]
    v_and_b32 v124, v120, v93
    v_and_b32 v125, v121, v93
    v_and_b32 v126, v122, v93
    v_and_b32 v127, v123, v93
    s_nop 1
    v_mfma_f32_16x16x32_bf16 v[116:119], v[124:127], v[44:47], v[116:119]
    v_and_b32 v124, v120, v94
    v_and_b32 v125, v121, v94
    v_and_b32 v126, v122, v94
    v_and_b32 v127, v123, v94
    s_nop 1
    v_mfma_f32_16x16x32_bf16 v[116:119], v[124:127], v[48:51], v[116:119]
    v_and_b32 v124, v120, v95
    v_and_b32 v125, v121, v95
    v_and_b32 v126, v122, v95
    v_and_b32 v127, v123, v95
    s_nop 1
    v_mfma_f32_16x16x32_bf16 v[116:119], v[124:127], v[52:55], v[116:119]
    v_and_b32 v124, v120, v108
    v_and_b32 v125, v121, v108
    v_and_b32 v126, v122, v108
    v_and_b32 v127, v123, v108
    s_nop 1
    v_mfma_f32_16x16x32_bf16 v[116:119], v[124:127], v[56:59], v[116:119]
    v_and_b32 v124, v120, v109
    v_and_b32 v125, v121, v109
    v_and_b32 v126, v122, v109
    v_and_b32 v127, v123, v109
    s_nop 1
    v_mfma_f32_16x16x32_bf16 v[116:119], v[124:127], v[60:63], v[116:119]
    v_and_b32 v124, v120, v110
    v_and_b32 v125, v121, v110
    v_and_b32 v126, v122, v110
    v_and_b32 v127, v123, v110
    s_nop 1
    v_mfma_f32_16x16x32_bf16 v[116:119], v[124:127], v[64:67], v[116:119]
    v_and_b32 v124, v120, v111
    v_and_b32 v125, v121, v111
    v_and_b32 v126, v122, v111
    v_and_b32 v127, v123, v111
    s_nop 1
    v_mfma_f32_16x16x32_bf16 v[116:119], v[124:127], v[68:71], v[116:119]
    v_and_b32 v124, v120, v112
    v_and_b32 v125, v121, v112
    v_and_b32 v126, v122, v112
    v_and_b32 v127, v123, v112
    s_nop 1
    v_mfma_f32_16x16x32_bf16 v[116:119], v[124:127], v[72:75], v[116:119]
    v_and_b32 v124, v120, v113
    v_and_b32 v125, v121, v113
    v_and_b32 v126, v122, v113
    v_and_b32 v127, v123, v113
    s_nop 1
    v_mfma_f32_16x16x32_bf16 v[116:119], v[124:127], v[76:79], v[116:119]
    v_and_b32 v124, v120, v114
    v_and_b32 v125, v121, v114
    v_and_b32 v126, v122, v114
    v_and_b32 v127, v123, v114
    s_nop 1
    v_mfma_f32_16x16x32_bf16 v[116:119], v[124:127], v[80:83], v[116:119]
    v_and_b32 v124, v120, v115
    v_and_b32 v125, v121, v115
    v_and_b32 v126, v122, v115
    v_and_b32 v127, v123, v115
    s_nop 1
    v_mfma_f32_16x16x32_bf16 v[116:119], v[124:127], v[84:87], v[116:119]
    v_lshlrev_b32 v4, 4, v5
    v_and_b32 v124, 1, v6
    v_lshl_add_u32 v4, v124, 3, v4
    v_and_b32 v124, 2, v6
    v_lshl_add_u32 v4, v124, 30, v4
    s_lshl_b32 s65, s51, 15
    s_add_u32 s65, s65, 92274688
    s_lshl_b32 s59, s47, 10
    s_lshl_b32 s60, s46, 8
    s_add_u32 s59, s59, s60
    s_add_u32 s59, s59, s65
    v_cvt_pk_bf16_f32 v24, v116, v117
    v_cvt_pk_bf16_f32 v25, v118, v119
    buffer_store_dwordx2 v[24:25], v4, s[8:11], s59 offen
    s_lshl_b32 s59, s51, 13
    s_lshl2_add_u32 s59, s47, s59
    s_add_u32 s59, s59, 10486912
    s_waitcnt vmcnt(0)
    s_barrier
    s_cmp_lg_u32 s46, 0
    s_cbranch_scc1 L_fs_47
    v_mov_b32 v124, 0
    v_mov_b32 v125, 1
    s_mov_b64 exec, 1
    buffer_store_dword v125, v124, s[8:11], s59 offen
    s_mov_b64 exec, -1
L_fs_47:
    s_cmp_lg_u32 s47, 0
    s_cbranch_scc1 L_moed_48
    s_lshl_b32 s59, s51, 13
    s_add_u32 s59, s59, 10486912
    v_and_b32 v124, 31, v1
    v_lshlrev_b32 v124, 2, v124
L_fw_49:
    buffer_load_dword v125, v124, s[8:11], s59 offen sc1
    s_waitcnt vmcnt(0)
    v_cmp_eq_u32 vcc, 0, v125
    s_cbranch_vccz L_fwd_50
    s_sub_u32 s49, s49, 1
    s_cmp_gt_i32 s49, 0
    s_cbranch_scc1 L_fw_49
    s_branch L_abort
L_fwd_50:
    s_add_u32 s63, s65, 0
    buffer_load_dwordx4 v[24:27], v22, s[8:11], s63 offen sc1
    s_add_u32 s63, s65, 4096
    buffer_load_dwordx4 v[28:31], v22, s[8:11], s63 offen sc1
    s_add_u32 s63, s65, 8192
    buffer_load_dwordx4 v[32:35], v22, s[8:11], s63 offen sc1
    s_add_u32 s63, s65, 12288
    buffer_load_dwordx4 v[36:39], v22, s[8:11], s63 offen sc1
    s_add_u32 s63, s65, 16384
    buffer_load_dwordx4 v[40:43], v22, s[8:11], s63 offen sc1
    s_add_u32 s63, s65, 20480
    buffer_load_dwordx4 v[44:47], v22, s[8:11], s63 offen sc1
    s_add_u32 s63, s65, 24576
    buffer_load_dwordx4 v[48:51], v22, s[8:11], s63 offen sc1
    s_add_u32 s63, s65, 28672
    buffer_load_dwordx4 v[52:55], v22, s[8:11], s63 offen sc1
    v_and_b32 v64, 15, v1
    v_and_b32 v65, 1, v1
    v_lshlrev_b32 v65, 4, v65
    v_mov_b32 v66, 0x3f80
    v_lshlrev_b32 v66, v65, v66
    v_lshrrev_b32 v64, 1, v64
    v_cmp_eq_u32 vcc, 0, v64
    s_nop 1
    v_cndmask_b32 v56, 0, v66, vcc
    v_cmp_eq_u32 vcc, 1, v64
    s_nop 1
    v_cndmask_b32 v57, 0, v66, vcc
    v_cmp_eq_u32 vcc, 2, v64
    s_nop 1
    v_cndmask_b32 v58, 0, v66, vcc
    v_cmp_eq_u32 vcc, 3, v64
    s_nop 1
    v_cndmask_b32 v59, 0, v66, vcc
    s_waitcnt vmcnt(7)
    s_nop 0
    v_mfma_f32_16x16x32_bf16 v[60:63], v[56:59], v[24:27], 0
    s_waitcnt vmcnt(6)
    v_mfma_f32_16x16x32_bf16 v[60:63], v[56:59], v[28:31], v[60:63]
    s_waitcnt vmcnt(5)
    v_mfma_f32_16x16x32_bf16 v[60:63], v[56:59], v[32:35], v[60:63]
    s_waitcnt vmcnt(4)
    v_mfma_f32_16x16x32_bf16 v[60:63], v[56:59], v[36:39], v[60:63]
    s_waitcnt vmcnt(3)
    v_mfma_f32_16x16x32_bf16 v[60:63], v[56:59], v[40:43], v[60:63]
    s_waitcnt vmcnt(2)
    v_mfma_f32_16x16x32_bf16 v[60:63], v[56:59], v[44:47], v[60:63]
    s_waitcnt vmcnt(1)
    v_mfma_f32_16x16x32_bf16 v[60:63], v[56:59], v[48:51], v[60:63]
    s_waitcnt vmcnt(0)
    v_mfma_f32_16x16x32_bf16 v[60:63], v[56:59], v[52:55], v[60:63]
    s_nop 7
    ds_write_b128 v21, v[60:63]
    s_waitcnt lgkmcnt(0)
    s_barrier
    s_cmp_lg_u32 s46, 0
    s_cbranch_scc1 L_moed_48
    v_lshlrev_b32 v56, 5, v1
    v_add_u32 v56, 139264, v56
    ds_read_b128 v[24:27], v56
    ds_read_b128 v[28:31], v56 offset:16
    s_and_b32 s59, s55, 0xffff0000
    s_xor_b32 s60, s59, 0x80000000
    s_xor_b32 s61, s59, 0xffff0000
    s_cmp_lt_i32 s59, 0
    s_cselect_b32 s59, s60, s61
    v_mov_b32 v56, s59
    v_mul_f32 v56, 0xbfb8aa3b, v56
    v_exp_f32 v56, v56
    s_nop 0
    v_add_f32 v56, 1.0, v56
    v_rcp_f32 v56, v56
    s_nop 0
    v_cvt_pk_bf16_f32 v56, v56, v56
    v_and_b32 v56, 0xffff0000, v56
    v_lshlrev_b32 v48, 16, v104
    v_and_b32 v49, 0xffff0000, v104
    v_lshlrev_b32 v50, 16, v105
    v_and_b32 v51, 0xffff0000, v105
    v_lshlrev_b32 v52, 16, v106
    v_and_b32 v53, 0xffff0000, v106
    v_lshlrev_b32 v54, 16, v107
    v_and_b32 v55, 0xffff0000, v107
    s_waitcnt lgkmcnt(0)
    v_cvt_pk_bf16_f32 v40, v24, v25
    v_cvt_pk_bf16_f32 v41, v26, v27
    v_cvt_pk_bf16_f32 v42, v28, v29
    v_cvt_pk_bf16_f32 v43, v30, v31
    v_lshlrev_b32 v24, 16, v40
    v_and_b32 v25, 0xffff0000, v40
    v_lshlrev_b32 v26, 16, v41
    v_and_b32 v27, 0xffff0000, v41
    v_lshlrev_b32 v28, 16, v42
    v_and_b32 v29, 0xffff0000, v42
    v_lshlrev_b32 v30, 16, v43
    v_and_b32 v31, 0xffff0000, v43
    v_mul_f32 v24, v24, v56
    v_mul_f32 v25, v25, v56
    v_mul_f32 v26, v26, v56
    v_mul_f32 v27, v27, v56
    v_mul_f32 v28, v28, v56
    v_mul_f32 v29, v29, v56
    v_mul_f32 v30, v30, v56
    v_mul_f32 v31, v31, v56
    v_cvt_pk_bf16_f32 v40, v24, v25
    v_cvt_pk_bf16_f32 v41, v26, v27
    v_cvt_pk_bf16_f32 v42, v28, v29
    v_cvt_pk_bf16_f32 v43, v30, v31
    v_lshlrev_b32 v24, 16, v40
    v_and_b32 v25, 0xffff0000, v40
    v_lshlrev_b32 v26, 16, v41
    v_and_b32 v27, 0xffff0000, v41
    v_lshlrev_b32 v28, 16, v42
    v_and_b32 v29, 0xffff0000, v42
    v_lshlrev_b32 v30, 16, v43
    v_and_b32 v31, 0xffff0000, v43
    v_add_f32 v24, v24, v48
    v_add_f32 v25, v25, v49
    v_add_f32 v26, v26, v50
    v_add_f32 v27, v27, v51
    v_add_f32 v28, v28, v52
    v_add_f32 v29, v29, v53
    v_add_f32 v30, v30, v54
    v_add_f32 v31, v31, v55
    v_cvt_pk_bf16_f32 v40, v24, v25
    v_cvt_pk_bf16_f32 v41, v26, v27
    v_cvt_pk_bf16_f32 v42, v28, v29
    v_cvt_pk_bf16_f32 v43, v30, v31
    v_lshlrev_b32 v24, 16, v40
    v_and_b32 v25, 0xffff0000, v40
    v_lshlrev_b32 v26, 16, v41
    v_and_b32 v27, 0xffff0000, v41
    v_lshlrev_b32 v28, 16, v42
    v_and_b32 v29, 0xffff0000, v42
    v_lshlrev_b32 v30, 16, v43
    v_and_b32 v31, 0xffff0000, v43
    v_add_f32 v96, v96, v24
    v_add_f32 v97, v97, v25
    v_add_f32 v98, v98, v26
    v_add_f32 v99, v99, v27
    v_add_f32 v100, v100, v28
    v_add_f32 v101, v101, v29
    v_add_f32 v102, v102, v30
    v_add_f32 v103, v103, v31
    v_cvt_pk_bf16_f32 v80, v96, v97
    v_cvt_pk_bf16_f32 v81, v98, v99
    v_cvt_pk_bf16_f32 v82, v100, v101
    v_cvt_pk_bf16_f32 v83, v102, v103
    s_mov_b32 s4, s40
    s_mov_b32 s5, s41
    s_mov_b32 s6, 2097152
    s_mov_b32 s7, 0x20000
    buffer_store_dwordx4 v[80:83], v0, s[4:7], s56 offen sc1
L_moed_48:
    s_endpgm
L_abort:
    s_endpgm
L_rch_4:
    v_and_b32 v2, 15, v1
    v_lshlrev_b32 v2, 2, v2
    v_lshrrev_b32 v3, 4, v1
    v_lshl_add_u32 v4, v3, 16, v2
    v_lshl_add_u32 v5, v3, 12, v2
    s_lshl_b32 s58, s47, 8
    s_lshl_b32 s57, s46, 6
    s_add_u32 s58, s58, s57
    s_lshl_b32 s59, s47, 17
    s_add_u32 s59, s59, s57
    s_lshl_b32 s60, s46, 15
    v_add_u32 v6, s60, v0
    s_mov_b32 s61, 0x05040100
    s_mov_b32 s62, 0x07060302
    s_lshl_b32 s63, s46, 19
    s_mov_b32 s4, s26
    s_mov_b32 s5, s27
    s_mov_b32 s6, 4194304
    s_mov_b32 s7, 0x20000
    s_add_u32 s56, s59, 0
    buffer_load_dword v24, v5, s[4:7], s56 offen offset:0
    buffer_load_dword v25, v5, s[4:7], s56 offen offset:1024
    buffer_load_dword v26, v5, s[4:7], s56 offen offset:2048
    buffer_load_dword v27, v5, s[4:7], s56 offen offset:3072
    s_add_u32 s56, s59, 16384
    buffer_load_dword v28, v5, s[4:7], s56 offen offset:0
    buffer_load_dword v29, v5, s[4:7], s56 offen offset:1024
    buffer_load_dword v30, v5, s[4:7], s56 offen offset:2048
    buffer_load_dword v31, v5, s[4:7], s56 offen offset:3072
    s_add_u32 s56, s59, 32768
    buffer_load_dword v32, v5, s[4:7], s56 offen offset:0
    buffer_load_dword v33, v5, s[4:7], s56 offen offset:1024
    buffer_load_dword v34, v5, s[4:7], s56 offen offset:2048
    buffer_load_dword v35, v5, s[4:7], s56 offen offset:3072
    s_add_u32 s56, s59, 49152
    buffer_load_dword v36, v5, s[4:7], s56 offen offset:0
    buffer_load_dword v37, v5, s[4:7], s56 offen offset:1024
    buffer_load_dword v38, v5, s[4:7], s56 offen offset:2048
    buffer_load_dword v39, v5, s[4:7], s56 offen offset:3072
    s_add_u32 s56, s59, 65536
    buffer_load_dword v40, v5, s[4:7], s56 offen offset:0
    buffer_load_dword v41, v5, s[4:7], s56 offen offset:1024
    buffer_load_dword v42, v5, s[4:7], s56 offen offset:2048
    buffer_load_dword v43, v5, s[4:7], s56 offen offset:3072
    s_add_u32 s56, s59, 81920
    buffer_load_dword v44, v5, s[4:7], s56 offen offset:0
    buffer_load_dword v45, v5, s[4:7], s56 offen offset:1024
    buffer_load_dword v46, v5, s[4:7], s56 offen offset:2048
    buffer_load_dword v47, v5, s[4:7], s56 offen offset:3072
    s_add_u32 s56, s59, 98304
    buffer_load_dword v48, v5, s[4:7], s56 offen offset:0
    buffer_load_dword v49, v5, s[4:7], s56 offen offset:1024
    buffer_load_dword v50, v5, s[4:7], s56 offen offset:2048
    buffer_load_dword v51, v5, s[4:7], s56 offen offset:3072
    s_add_u32 s56, s59, 114688
    buffer_load_dword v52, v5, s[4:7], s56 offen offset:0
    buffer_load_dword v53, v5, s[4:7], s56 offen offset:1024
    buffer_load_dword v54, v5, s[4:7], s56 offen offset:2048
    buffer_load_dword v55, v5, s[4:7], s56 offen offset:3072
    s_add_u32 s56, s59, 256
    buffer_load_dword v56, v5, s[4:7], s56 offen offset:0
    buffer_load_dword v57, v5, s[4:7], s56 offen offset:1024
    buffer_load_dword v58, v5, s[4:7], s56 offen offset:2048
    buffer_load_dword v59, v5, s[4:7], s56 offen offset:3072
    s_add_u32 s56, s59, 16640
    buffer_load_dword v60, v5, s[4:7], s56 offen offset:0
    buffer_load_dword v61, v5, s[4:7], s56 offen offset:1024
    buffer_load_dword v62, v5, s[4:7], s56 offen offset:2048
    buffer_load_dword v63, v5, s[4:7], s56 offen offset:3072
    s_add_u32 s56, s59, 33024
    buffer_load_dword v64, v5, s[4:7], s56 offen offset:0
    buffer_load_dword v65, v5, s[4:7], s56 offen offset:1024
    buffer_load_dword v66, v5, s[4:7], s56 offen offset:2048
    buffer_load_dword v67, v5, s[4:7], s56 offen offset:3072
    s_add_u32 s56, s59, 49408
    buffer_load_dword v68, v5, s[4:7], s56 offen offset:0
    buffer_load_dword v69, v5, s[4:7], s56 offen offset:1024
    buffer_load_dword v70, v5, s[4:7], s56 offen offset:2048
    buffer_load_dword v71, v5, s[4:7], s56 offen offset:3072
    s_add_u32 s56, s59, 65792
    buffer_load_dword v72, v5, s[4:7], s56 offen offset:0
    buffer_load_dword v73, v5, s[4:7], s56 offen offset:1024
    buffer_load_dword v74, v5, s[4:7], s56 offen offset:2048
    buffer_load_dword v75, v5, s[4:7], s56 offen offset:3072
    s_add_u32 s56, s59, 82176
    buffer_load_dword v76, v5, s[4:7], s56 offen offset:0
    buffer_load_dword v77, v5, s[4:7], s56 offen offset:1024
    buffer_load_dword v78, v5, s[4:7], s56 offen offset:2048
    buffer_load_dword v79, v5, s[4:7], s56 offen offset:3072
    s_waitcnt vmcnt(48)
    ds_write_b128 v6, v[24:27] offset:0
    ds_write_b128 v6, v[28:31] offset:1024
    s_waitcnt lgkmcnt(0)
    s_add_u32 s56, s59, 98560
    buffer_load_dword v24, v5, s[4:7], s56 offen offset:0
    buffer_load_dword v25, v5, s[4:7], s56 offen offset:1024
    buffer_load_dword v26, v5, s[4:7], s56 offen offset:2048
    buffer_load_dword v27, v5, s[4:7], s56 offen offset:3072
    s_add_u32 s56, s59, 114944
    buffer_load_dword v28, v5, s[4:7], s56 offen offset:0
    buffer_load_dword v29, v5, s[4:7], s56 offen offset:1024
    buffer_load_dword v30, v5, s[4:7], s56 offen offset:2048
    buffer_load_dword v31, v5, s[4:7], s56 offen offset:3072
    s_waitcnt vmcnt(48)
    ds_write_b128 v6, v[32:35] offset:2048
    ds_write_b128 v6, v[36:39] offset:3072
    s_waitcnt lgkmcnt(0)
    s_add_u32 s56, s59, 512
    buffer_load_dword v32, v5, s[4:7], s56 offen offset:0
    buffer_load_dword v33, v5, s[4:7], s56 offen offset:1024
    buffer_load_dword v34, v5, s[4:7], s56 offen offset:2048
    buffer_load_dword v35, v5, s[4:7], s56 offen offset:3072
    s_add_u32 s56, s59, 16896
    buffer_load_dword v36, v5, s[4:7], s56 offen offset:0
    buffer_load_dword v37, v5, s[4:7], s56 offen offset:1024
    buffer_load_dword v38, v5, s[4:7], s56 offen offset:2048
    buffer_load_dword v39, v5, s[4:7], s56 offen offset:3072
    s_waitcnt vmcnt(48)
    ds_write_b128 v6, v[40:43] offset:4096
    ds_write_b128 v6, v[44:47] offset:5120
    s_waitcnt lgkmcnt(0)
    s_add_u32 s56, s59, 33280
    buffer_load_dword v40, v5, s[4:7], s56 offen offset:0
    buffer_load_dword v41, v5, s[4:7], s56 offen offset:1024
    buffer_load_dword v42, v5, s[4:7], s56 offen offset:2048
    buffer_load_dword v43, v5, s[4:7], s56 offen offset:3072
    s_add_u32 s56, s59, 49664
    buffer_load_dword v44, v5, s[4:7], s56 offen offset:0
    buffer_load_dword v45, v5, s[4:7], s56 offen offset:1024
    buffer_load_dword v46, v5, s[4:7], s56 offen offset:2048
    buffer_load_dword v47, v5, s[4:7], s56 offen offset:3072
    s_waitcnt vmcnt(48)
    ds_write_b128 v6, v[48:51] offset:6144
    ds_write_b128 v6, v[52:55] offset:7168
    s_waitcnt lgkmcnt(0)
    s_add_u32 s56, s59, 66048
    buffer_load_dword v48, v5, s[4:7], s56 offen offset:0
    buffer_load_dword v49, v5, s[4:7], s56 offen offset:1024
    buffer_load_dword v50, v5, s[4:7], s56 offen offset:2048
    buffer_load_dword v51, v5, s[4:7], s56 offen offset:3072
    s_add_u32 s56, s59, 82432
    buffer_load_dword v52, v5, s[4:7], s56 offen offset:0
    buffer_load_dword v53, v5, s[4:7], s56 offen offset:1024
    buffer_load_dword v54, v5, s[4:7], s56 offen offset:2048
    buffer_load_dword v55, v5, s[4:7], s56 offen offset:3072
    s_waitcnt vmcnt(48)
    ds_write_b128 v6, v[56:59] offset:8192
    ds_write_b128 v6, v[60:63] offset:9216
    s_waitcnt lgkmcnt(0)
    s_add_u32 s56, s59, 98816
    buffer_load_dword v56, v5, s[4:7], s56 offen offset:0
    buffer_load_dword v57, v5, s[4:7], s56 offen offset:1024
    buffer_load_dword v58, v5, s[4:7], s56 offen offset:2048
    buffer_load_dword v59, v5, s[4:7], s56 offen offset:3072
    s_add_u32 s56, s59, 115200
    buffer_load_dword v60, v5, s[4:7], s56 offen offset:0
    buffer_load_dword v61, v5, s[4:7], s56 offen offset:1024
    buffer_load_dword v62, v5, s[4:7], s56 offen offset:2048
    buffer_load_dword v63, v5, s[4:7], s56 offen offset:3072
    s_waitcnt vmcnt(48)
    ds_write_b128 v6, v[64:67] offset:10240
    ds_write_b128 v6, v[68:71] offset:11264
    s_waitcnt lgkmcnt(0)
    s_add_u32 s56, s59, 768
    buffer_load_dword v64, v5, s[4:7], s56 offen offset:0
    buffer_load_dword v65, v5, s[4:7], s56 offen offset:1024
    buffer_load_dword v66, v5, s[4:7], s56 offen offset:2048
    buffer_load_dword v67, v5, s[4:7], s56 offen offset:3072
    s_add_u32 s56, s59, 17152
    buffer_load_dword v68, v5, s[4:7], s56 offen offset:0
    buffer_load_dword v69, v5, s[4:7], s56 offen offset:1024
    buffer_load_dword v70, v5, s[4:7], s56 offen offset:2048
    buffer_load_dword v71, v5, s[4:7], s56 offen offset:3072
    s_waitcnt vmcnt(48)
    ds_write_b128 v6, v[72:75] offset:12288
    ds_write_b128 v6, v[76:79] offset:13312
    s_waitcnt lgkmcnt(0)
    s_add_u32 s56, s59, 33536
    buffer_load_dword v72, v5, s[4:7], s56 offen offset:0
    buffer_load_dword v73, v5, s[4:7], s56 offen offset:1024
    buffer_load_dword v74, v5, s[4:7], s56 offen offset:2048
    buffer_load_dword v75, v5, s[4:7], s56 offen offset:3072
    s_add_u32 s56, s59, 49920
    buffer_load_dword v76, v5, s[4:7], s56 offen offset:0
    buffer_load_dword v77, v5, s[4:7], s56 offen offset:1024
    buffer_load_dword v78, v5, s[4:7], s56 offen offset:2048
    buffer_load_dword v79, v5, s[4:7], s56 offen offset:3072
    s_waitcnt vmcnt(48)
    ds_write_b128 v6, v[24:27] offset:14336
    ds_write_b128 v6, v[28:31] offset:15360
    s_waitcnt lgkmcnt(0)
    s_add_u32 s56, s59, 66304
    buffer_load_dword v24, v5, s[4:7], s56 offen offset:0
    buffer_load_dword v25, v5, s[4:7], s56 offen offset:1024
    buffer_load_dword v26, v5, s[4:7], s56 offen offset:2048
    buffer_load_dword v27, v5, s[4:7], s56 offen offset:3072
    s_add_u32 s56, s59, 82688
    buffer_load_dword v28, v5, s[4:7], s56 offen offset:0
    buffer_load_dword v29, v5, s[4:7], s56 offen offset:1024
    buffer_load_dword v30, v5, s[4:7], s56 offen offset:2048
    buffer_load_dword v31, v5, s[4:7], s56 offen offset:3072
    s_waitcnt vmcnt(48)
    ds_write_b128 v6, v[32:35] offset:16384
    ds_write_b128 v6, v[36:39] offset:17408
    s_waitcnt lgkmcnt(0)
    s_add_u32 s56, s59, 99072
    buffer_load_dword v32, v5, s[4:7], s56 offen offset:0
    buffer_load_dword v33, v5, s[4:7], s56 offen offset:1024
    buffer_load_dword v34, v5, s[4:7], s56 offen offset:2048
    buffer_load_dword v35, v5, s[4:7], s56 offen offset:3072
    s_add_u32 s56, s59, 115456
    buffer_load_dword v36, v5, s[4:7], s56 offen offset:0
    buffer_load_dword v37, v5, s[4:7], s56 offen offset:1024
    buffer_load_dword v38, v5, s[4:7], s56 offen offset:2048
    buffer_load_dword v39, v5, s[4:7], s56 offen offset:3072
    s_waitcnt vmcnt(48)
    ds_write_b128 v6, v[40:43] offset:18432
    ds_write_b128 v6, v[44:47] offset:19456
    s_waitcnt lgkmcnt(0)
    s_waitcnt vmcnt(40)
    ds_write_b128 v6, v[48:51] offset:20480
    ds_write_b128 v6, v[52:55] offset:21504
    s_waitcnt lgkmcnt(0)
    s_waitcnt vmcnt(32)
    ds_write_b128 v6, v[56:59] offset:22528
    ds_write_b128 v6, v[60:63] offset:23552
    s_waitcnt lgkmcnt(0)
    s_waitcnt vmcnt(24)
    ds_write_b128 v6, v[64:67] offset:24576
    ds_write_b128 v6, v[68:71] offset:25600
    s_waitcnt lgkmcnt(0)
    s_waitcnt vmcnt(16)
    ds_write_b128 v6, v[72:75] offset:26624
    ds_write_b128 v6, v[76:79] offset:27648
    s_waitcnt lgkmcnt(0)
    s_waitcnt vmcnt(8)
    ds_write_b128 v6, v[24:27] offset:28672
    ds_write_b128 v6, v[28:31] offset:29696
    s_waitcnt lgkmcnt(0)
    s_waitcnt vmcnt(0)
    ds_write_b128 v6, v[32:35] offset:30720
    ds_write_b128 v6, v[36:39] offset:31744
    s_waitcnt lgkmcnt(0)
    s_cmp_lg_u32 s46, 0
    s_cbranch_scc1 L_gbd_52
    v_mov_b32 v124, 128
L_gb_51:
    buffer_load_dword v125, v124, s[12:15], 0 offen sc1
    s_waitcnt vmcnt(0)
    v_readfirstlane_b32 s56, v125
    s_cmp_ge_u32 s56, 256
    s_cbranch_scc1 L_gbd_52
    s_sleep 4
    s_sub_u32 s49, s49, 1
    s_cmp_gt_i32 s49, 0
    s_cbranch_scc1 L_gb_51
    s_branch L_abort
L_gbd_52:
    s_waitcnt lgkmcnt(0)
    s_barrier
    s_cmp_eq_u32 s48, 1
    s_cbranch_scc1 L_rc1_7
    s_cmp_eq_u32 s48, 2
    s_cbranch_scc1 L_rc2_8
    v_and_b32 v120, 15, v1
    v_lshrrev_b32 v121, 4, v1
    v_and_b32 v122, 2, v1
    v_cmp_eq_u32 vcc, 0, v122
    v_mov_b32 v2, 0xeeee
    v_mov_b32 v123, 0x4444
    v_cndmask_b32 v2, v2, v123, vcc
    v_and_b32 v122, 1, v1
    v_cmp_eq_u32 vcc, 0, v122
    v_mov_b32 v3, 0xdddd
    v_mov_b32 v123, 0x8888
    v_cndmask_b32 v3, v3, v123, vcc
    v_lshrrev_b32 v122, 1, v120
    v_bfe_u32 v123, v120, 2, 1
    v_xor_b32 v123, v123, v122
    v_lshlrev_b32 v4, 7, v123
    v_and_b32 v123, 1, v120
    v_lshl_add_u32 v4, v123, 6, v4
    v_xor_b32 v123, v121, v122
    v_and_b32 v123, 3, v123
    v_lshl_add_u32 v4, v123, 4, v4
    s_lshl_b32 s56, s46, 10
    s_add_u32 s56, s56, 147456
    v_add_u32 v4, s56, v4
    v_lshlrev_b32 v122, 1, v121
    v_add_u32 v122, 0, v122
    v_and_b32 v123, 1, v121
    v_xor_b32 v123, v123, v122
    v_lshlrev_b32 v5, 7, v123
    v_bfe_u32 v123, v120, 3, 1
    v_lshl_add_u32 v5, v123, 6, v5
    v_xor_b32 v123, v120, v122
    v_and_b32 v123, 3, v123
    v_lshl_add_u32 v5, v123, 4, v5
    v_bfe_u32 v123, v120, 2, 1
    v_lshl_add_u32 v5, v123, 3, v5
    v_add_u32 v5, 147456, v5
    v_lshlrev_b32 v122, 1, v121
    v_add_u32 v122, 1, v122
    v_and_b32 v123, 1, v121
    v_xor_b32 v123, v123, v122
    v_lshlrev_b32 v6, 7, v123
    v_bfe_u32 v123, v120, 3, 1
    v_lshl_add_u32 v6, v123, 6, v6
    v_xor_b32 v123, v120, v122
    v_and_b32 v123, 3, v123
    v_lshl_add_u32 v6, v123, 4, v6
    v_bfe_u32 v123, v120, 2, 1
    v_lshl_add_u32 v6, v123, 3, v6
    v_add_u32 v6, 147456, v6
    v_lshlrev_b32 v7, 7, v121
    v_lshrrev_b32 v122, 1, v120
    v_lshl_add_u32 v8, v122, 4, v7
    v_add_u32 v8, 151552, v8
    v_lshrrev_b32 v122, 2, v120
    v_lshl_add_u32 v7, v122, 5, v7
    v_and_b32 v122, 1, v120
    v_lshl_add_u32 v7, v122, 4, v7
    v_and_b32 v122, 2, v120
    v_lshl_add_u32 v7, v122, 10, v7
    s_lshl_b32 s56, s46, 9
    s_add_u32 s56, s56, 151552
    v_add_u32 v7, s56, v7
    v_lshrrev_b32 v122, 3, v1
    v_lshlrev_b32 v9, 11, v122
    v_and_b32 v122, 7, v1
    v_lshl_add_u32 v9, v122, 3, v9
    s_lshl_b32 s56, s46, 14
    s_lshl_b32 s57, s47, 6
    s_add_u32 s56, s56, s57
    v_add_u32 v9, s56, v9
    s_lshl_b32 s71, s47, 2
    s_add_u32 s71, s71, s46
    s_bfe_u32 s56, s71, 0x10003
    s_lshl_b32 s56, s56, 11
    s_and_b32 s57, s71, 1
    s_lshl_b32 s57, s57, 10
    s_add_u32 s56, s56, s57
    s_bfe_u32 s57, s71, 0x10002
    s_lshl_b32 s57, s57, 9
    s_add_u32 s56, s56, s57
    s_bfe_u32 s57, s71, 0x10001
    s_lshl_b32 s57, s57, 6
    s_add_u32 s56, s56, s57
    s_bfe_u32 s57, s71, 0x10004
    s_lshl_b32 s57, s57, 8
    s_add_u32 s56, s56, s57
    s_bfe_u32 s57, s71, 0x10005
    s_lshl_b32 s57, s57, 7
    s_add_u32 s56, s56, s57
    s_bfe_u32 s57, s71, 0x10006
    s_lshl_b32 s57, s57, 12
    s_add_u32 s56, s56, s57
    v_and_b32 v122, 3, v120
    v_lshlrev_b32 v10, 2, v122
    v_bfe_u32 v122, v120, 3, 1
    v_lshl_add_u32 v10, v122, 4, v10
    v_and_b32 v122, 1, v121
    v_lshl_add_u32 v10, v122, 5, v10
    v_add_u32 v10, s56, v10
    v_and_b32 v123, 36, v1
    v_mov_b32 v122, 0x80000000
    v_cmp_eq_u32 vcc, 0, v123
    s_nop 1
    v_cndmask_b32 v10, v122, v10, vcc
    s_lshl_b32 s56, s46, 15
    v_add_u32 v11, s56, v0
    s_lshl_b32 s71, s71, 11
    s_lshl_b32 s73, s46, 11
    s_mov_b32 s72, 0xffc00000
    s_mov_b32 s74, 0
    v_lshrrev_b32 v13, 3, v1
    v_lshlrev_b32 v13, 9, v13
    v_and_b32 v122, 7, v1
    v_lshl_add_u32 v13, v122, 4, v13
    v_and_b32 v122, 15, v1
    v_and_b32 v123, 1, v1
    v_lshlrev_b32 v123, 4, v123
    v_mov_b32 v124, 0x3f80
    v_lshlrev_b32 v124, v123, v124
    v_lshrrev_b32 v122, 1, v122
    v_cmp_eq_u32 vcc, 0, v122
    s_nop 1
    v_cndmask_b32 v18, 0, v124, vcc
    v_cmp_eq_u32 vcc, 1, v122
    s_nop 1
    v_cndmask_b32 v19, 0, v124, vcc
    v_cmp_eq_u32 vcc, 2, v122
    s_nop 1
    v_cndmask_b32 v20, 0, v124, vcc
    v_cmp_eq_u32 vcc, 3, v122
    s_nop 1
    v_cndmask_b32 v21, 0, v124, vcc
    s_and_b32 s56, s46, 1
    s_lshl_b32 s56, s56, 8
    s_and_b32 s57, s46, 2
    s_lshl_b32 s57, s57, 6
    s_add_u32 s56, s56, s57
    v_add_u32 v13, s56, v13
    s_xor_b32 s56, s46, 0
    s_lshl_b32 s56, s56, 10
    s_add_u32 s56, s56, 147456
    v_add_u32 v14, s56, v0
    s_xor_b32 s56, s46, 1
    s_lshl_b32 s56, s56, 10
    s_add_u32 s56, s56, 147456
    v_add_u32 v15, s56, v0
    s_xor_b32 s56, s46, 2
    s_lshl_b32 s56, s56, 10
    s_add_u32 s56, s56, 147456
    v_add_u32 v16, s56, v0
    s_xor_b32 s56, s46, 3
    s_lshl_b32 s56, s56, 10
    s_add_u32 s56, s56, 147456
    v_add_u32 v17, s56, v0
    v_add_u32 v22, 11550720, v10
    s_lshl_b32 s56, s47, 2
    s_add_u32 s56, s56, 10502144
    v_writelane_b32 v22, s56, 4
    s_mov_b32 s56, 10519808
    v_writelane_b32 v22, s56, 5
    v_add_u32 v1, 131072, v0
    s_mov_b32 s65, 14680064
    s_add_u32 s66, s71, 14680064
    s_add_u32 s69, s71, 14942208
    s_lshl_b32 s79, s47, 2
    s_add_u32 s79, s79, 10486144
    s_cmp_eq_u32 s46, 0
    s_cselect_b32 s79, s79, 0x80000000
    s_cmp_eq_u32 s47, 0
    s_cselect_b32 s31, 17825792, -1
    s_and_b32 s31, s31, 0x8fffffff
    s_mov_b32 s51, 0
L_cst_53:
    s_lshl_b32 s59, s51, 13
    s_lshl2_add_u32 s59, s47, s59
    s_add_u32 s59, s59, 10485760
    v_mov_b32 v120, 0
L_ww_58:
    buffer_load_dword v121, v120, s[8:11], s59 offen sc1
    s_waitcnt vmcnt(0)
    v_readfirstlane_b32 s61, v121
    s_cmp_lg_u32 s61, 0
    s_cbranch_scc1 L_wwd_59
    s_sleep 1
    s_sub_u32 s49, s49, 1
    s_cmp_gt_i32 s49, 0
    s_cbranch_scc1 L_ww_58
    s_branch L_abort
L_wwd_59:
    s_lshl_b32 s56, s51, 5
    s_add_u32 s56, s56, s47
    s_mul_i32 s56, s56, 24576
    s_add_u32 s56, s56, 100663296
    s_add_u32 s67, s56, s73
    s_add_u32 m0, s73, 131072
    s_add_u32 s57, s67, 8192
    buffer_load_dwordx4 v0, s[8:11], s67 offen sc1 lds
    buffer_load_dwordx4 v0, s[8:11], s67 offen offset:1024 sc1 lds
    s_add_u32 m0, s73, 139264
    s_add_u32 s67, s67, 786432
    buffer_load_dwordx4 v0, s[8:11], s57 offen sc1 lds
    buffer_load_dwordx4 v0, s[8:11], s57 offen offset:1024 sc1 lds
    s_lshl_b32 s75, s51, 13
    s_add_u32 s64, s75, 11534336
    s_add_u32 s70, s64, 4096
    s_lshl_b32 s68, s51, 5
    s_add_u32 s68, s68, s47
    s_lshl_b32 s68, s68, 13
    s_lshl_b32 s56, s46, 10
    s_add_u32 s68, s68, s56
    s_add_u32 s68, s68, 41943040
    s_sub_u32 s67, s67, 0
    s_mov_b32 s78, 0x80000000
    s_cmp_eq_u32 s51, 63
    s_cselect_b32 s76, 1, 0
    s_waitcnt vmcnt(0)
    s_barrier
    ds_read_b128 v[56:59], v1 offset:0
    ds_read_b128 v[60:63], v1 offset:4096
    ds_read_b128 v[64:67], v1 offset:1024
    ds_read_b128 v[68:71], v1 offset:5120
    ds_read_b128 v[72:75], v1 offset:2048
    ds_read_b128 v[76:79], v1 offset:6144
    ds_read_b128 v[80:83], v1 offset:3072
    ds_read_b128 v[84:87], v1 offset:7168
    v_add_u32 v12, s73, v1
    ds_read_b128 v[88:91], v12 offset:8192
    ds_read_b128 v[92:95], v12 offset:9216
    v_mov_b64 v[96:97], 0
    v_mov_b64 v[98:99], 0
    v_mov_b64 v[100:101], 0
    v_mov_b64 v[102:103], 0
    v_mov_b64 v[104:105], 0
    v_mov_b64 v[106:107], 0
    v_mov_b64 v[108:109], 0
    v_mov_b64 v[110:111], 0
    v_mov_b64 v[112:113], 0
    v_mov_b64 v[114:115], 0
    v_mov_b64 v[116:117], 0
    v_mov_b64 v[118:119], 0
    buffer_load_dwordx4 v[24:27], v13, s[8:11], s64 offen sc1
L_chain_60:
L_cpa_61:
    buffer_load_dwordx4 v[24:27], v13, s[8:11], s64 offen sc1
    s_sub_u32 s49, s49, 1
    s_cbranch_scc1 L_abort
    s_waitcnt vmcnt(1)
    v_max3_u32 v12, v24, v25, v26
    v_max_u32 v12, v27, v12
    v_cmp_le_u32 vcc, s72, v12
    s_cbranch_vccnz L_cpa_61
L_cgo_64:
    ds_write_b128 v14, v[24:27] offset:0
    buffer_load_dwordx4 v[40:43], v13, s[8:11], s70 offen sc1
    v_smfmac_f32_16x16x64_bf16 v[96:99], v[24:27], a[0:7], v2
    s_add_u32 m0, s73, 131072
    v_smfmac_f32_16x16x64_bf16 v[100:103], v[24:27], a[128:135], v2
    s_add_u32 s57, s67, 8192
    v_smfmac_f32_16x16x64_bf16 v[104:107], v[24:27], a[8:15], v2
    v_smfmac_f32_16x16x64_bf16 v[108:111], v[24:27], a[136:143], v2
    s_waitcnt lgkmcnt(0)
    s_barrier
    ds_read_b128 v[28:31], v15 offset:0
    ds_read_b128 v[32:35], v16 offset:0
    ds_read_b128 v[36:39], v17 offset:0
    v_smfmac_f32_16x16x64_bf16 v[112:115], v[24:27], v[128:135], v2
    v_smfmac_f32_16x16x64_bf16 v[116:119], v[24:27], v[136:143], v2
    s_waitcnt lgkmcnt(2)
    v_smfmac_f32_16x16x64_bf16 v[96:99], v[28:31], a[16:23], v2
    s_lshl_b32 s56, s46, 10
    v_smfmac_f32_16x16x64_bf16 v[100:103], v[28:31], a[144:151], v2
    v_smfmac_f32_16x16x64_bf16 v[104:107], v[28:31], a[24:31], v2
    v_smfmac_f32_16x16x64_bf16 v[108:111], v[28:31], a[152:159], v2
    s_waitcnt lgkmcnt(1) vmcnt(0)
    v_smfmac_f32_16x16x64_bf16 v[96:99], v[32:35], a[32:39], v2
    v_max3_u32 v12, v40, v41, v42
    v_smfmac_f32_16x16x64_bf16 v[100:103], v[32:35], a[160:167], v2
    v_max_u32 v12, v43, v12
    v_smfmac_f32_16x16x64_bf16 v[104:107], v[32:35], a[40:47], v2
    v_cmp_le_u32 vcc, s72, v12
    v_smfmac_f32_16x16x64_bf16 v[108:111], v[32:35], a[168:175], v2
    s_cbranch_vccnz L_cpb_67
L_cback_69:
    s_waitcnt lgkmcnt(0)
    ds_write_b128 v14, v[40:43] offset:4096
    v_smfmac_f32_16x16x64_bf16 v[96:99], v[36:39], a[48:55], v2
    v_mov_b64 v[120:121], -1
    v_smfmac_f32_16x16x64_bf16 v[100:103], v[36:39], a[176:183], v2
    v_mov_b64 v[122:123], -1
    v_smfmac_f32_16x16x64_bf16 v[104:107], v[36:39], a[56:63], v2
    v_add_u32 v124, s56, v5
    v_smfmac_f32_16x16x64_bf16 v[108:111], v[36:39], a[184:191], v2
    v_add_u32 v126, s56, v6
    s_waitcnt lgkmcnt(0)
    s_barrier
    v_smfmac_f32_16x16x64_bf16 v[96:99], v[40:43], a[64:71], v2
    ds_read_b128 v[44:47], v15 offset:4096
    v_smfmac_f32_16x16x64_bf16 v[100:103], v[40:43], a[192:199], v2
    ds_read_b128 v[48:51], v16 offset:4096
    v_smfmac_f32_16x16x64_bf16 v[104:107], v[40:43], a[72:79], v2
    ds_read_b128 v[52:55], v17 offset:4096
    v_smfmac_f32_16x16x64_bf16 v[108:111], v[40:43], a[200:207], v2
    s_cmp_eq_u32 s76, 0
    s_cbranch_scc1 L_ckw_54
L_ckb_55:
    s_waitcnt lgkmcnt(2)
    v_smfmac_f32_16x16x64_bf16 v[96:99], v[44:47], a[80:87], v2
    buffer_load_dwordx4 v0, s[8:11], s67 offen sc1 lds
    v_smfmac_f32_16x16x64_bf16 v[100:103], v[44:47], a[208:215], v2
    buffer_load_dwordx4 v0, s[8:11], s67 offen offset:1024 sc1 lds
    v_smfmac_f32_16x16x64_bf16 v[104:107], v[44:47], a[88:95], v2
    s_add_u32 m0, s73, 139264
    v_smfmac_f32_16x16x64_bf16 v[108:111], v[44:47], a[216:223], v2
    s_waitcnt lgkmcnt(1)
    v_smfmac_f32_16x16x64_bf16 v[96:99], v[48:51], a[96:103], v2
    s_add_u32 s67, s67, 786432
    v_smfmac_f32_16x16x64_bf16 v[100:103], v[48:51], a[224:231], v2
    buffer_load_dwordx4 v0, s[8:11], s57 offen sc1 lds
    v_smfmac_f32_16x16x64_bf16 v[104:107], v[48:51], a[104:111], v2
    buffer_load_dwordx4 v0, s[8:11], s57 offen offset:1024 sc1 lds
    v_smfmac_f32_16x16x64_bf16 v[108:111], v[48:51], a[232:239], v2
    s_waitcnt lgkmcnt(0)
    v_smfmac_f32_16x16x64_bf16 v[96:99], v[52:55], a[112:119], v2
    buffer_load_dword v23, v22, s[8:11], s75 offen sc1
    v_smfmac_f32_16x16x64_bf16 v[100:103], v[52:55], a[240:247], v2
    buffer_store_dword v2, off, s[8:11], s78 sc1
    v_smfmac_f32_16x16x64_bf16 v[104:107], v[52:55], a[120:127], v2
    buffer_store_dwordx4 v[120:123], v0, s[8:11], s69 offen
    v_smfmac_f32_16x16x64_bf16 v[108:111], v[52:55], a[248:255], v2
    buffer_store_dwordx4 v[120:123], v0, s[8:11], s69 offen offset:1024
    v_smfmac_f32_16x16x64_bf16 v[112:115], v[28:31], v[144:151], v2
    v_smfmac_f32_16x16x64_bf16 v[116:119], v[28:31], v[152:159], v2
    v_pk_add_f32 v[96:97], v[96:97], v[98:99]
    v_pk_add_f32 v[100:101], v[100:101], v[102:103]
    v_cvt_pk_bf16_f32 v120, v96, v97
    v_cvt_pk_bf16_f32 v121, v100, v101
    v_pk_add_f32 v[104:105], v[104:105], v[106:107]
    v_pk_add_f32 v[108:109], v[108:109], v[110:111]
    v_cvt_pk_bf16_f32 v122, v104, v105
    v_cvt_pk_bf16_f32 v123, v108, v109
    ds_write_b128 v4, v[120:123]
    v_smfmac_f32_16x16x64_bf16 v[112:115], v[32:35], v[160:167], v2
    v_smfmac_f32_16x16x64_bf16 v[116:119], v[32:35], v[168:175], v2
    v_smfmac_f32_16x16x64_bf16 v[112:115], v[36:39], v[176:183], v2
    v_smfmac_f32_16x16x64_bf16 v[116:119], v[36:39], v[184:191], v2
    s_waitcnt lgkmcnt(0)
    s_barrier
    ds_read_b64_tr_b16 v[96:97], v5 offset:0
    ds_read_b64_tr_b16 v[98:99], v6 offset:0
    ds_read_b64_tr_b16 v[100:101], v5 offset:1024
    ds_read_b64_tr_b16 v[102:103], v6 offset:1024
    ds_read_b64_tr_b16 v[104:105], v5 offset:2048
    ds_read_b64_tr_b16 v[106:107], v6 offset:2048
    ds_read_b64_tr_b16 v[108:109], v5 offset:3072
    ds_read_b64_tr_b16 v[110:111], v6 offset:3072
    ds_read_b64_tr_b16 v[124:125], v124
    ds_read_b64_tr_b16 v[126:127], v126
    v_smfmac_f32_16x16x64_bf16 v[112:115], v[40:43], v[192:199], v2
    v_smfmac_f32_16x16x64_bf16 v[116:119], v[40:43], v[200:207], v2
    s_waitcnt lgkmcnt(8)
    v_mfma_f32_16x16x32_bf16 v[24:27], v[56:59], v[96:99], 0
    v_mfma_f32_16x16x32_bf16 v[28:31], v[60:63], v[96:99], 0
    v_mfma_f32_16x16x32_bf16 v[32:35], v[96:99], v[96:99], 0
    s_waitcnt lgkmcnt(6)
    v_mfma_f32_16x16x32_bf16 v[24:27], v[64:67], v[100:103], v[24:27]
    ds_read_b128 v[56:59], v11 offset:0
    v_mfma_f32_16x16x32_bf16 v[28:31], v[68:71], v[100:103], v[28:31]
    ds_read_b128 v[60:63], v11 offset:1024
    v_mfma_f32_16x16x32_bf16 v[32:35], v[100:103], v[100:103], v[32:35]
    s_waitcnt lgkmcnt(6)
    v_mfma_f32_16x16x32_bf16 v[24:27], v[72:75], v[104:107], v[24:27]
    ds_read_b128 v[64:67], v11 offset:2048
    v_mfma_f32_16x16x32_bf16 v[28:31], v[76:79], v[104:107], v[28:31]
    ds_read_b128 v[68:71], v11 offset:3072
    v_mfma_f32_16x16x32_bf16 v[32:35], v[104:107], v[104:107], v[32:35]
    s_waitcnt lgkmcnt(6)
    v_mfma_f32_16x16x32_bf16 v[24:27], v[80:83], v[108:111], v[24:27]
    ds_read_b128 v[72:75], v11 offset:4096
    v_mfma_f32_16x16x32_bf16 v[28:31], v[84:87], v[108:111], v[28:31]
    ds_read_b128 v[76:79], v11 offset:5120
    v_mfma_f32_16x16x32_bf16 v[32:35], v[108:111], v[108:111], v[32:35]
    s_waitcnt lgkmcnt(6)
    v_smfmac_f32_16x16x64_bf16 v[112:115], v[44:47], v[208:215], v2
    buffer_store_dwordx4 v[124:127], v0, s[8:11], s68 offen sc1
    v_smfmac_f32_16x16x64_bf16 v[116:119], v[44:47], v[216:223], v2
    v_smfmac_f32_16x16x64_bf16 v[112:115], v[48:51], v[224:231], v2
    v_smfmac_f32_16x16x64_bf16 v[116:119], v[48:51], v[232:239], v2
    v_smfmac_f32_16x16x64_bf16 v[112:115], v[52:55], v[240:247], v2
    v_smfmac_f32_16x16x64_bf16 v[116:119], v[52:55], v[248:255], v2
    v_mov_b32 v125, 0
    v_mov_b64 v[52:53], s[28:29]
    v_mov_b64 v[54:55], s[28:29]
    v_max3_f32 v36, v24, v25, v26
    v_max3_f32 v37, v27, v28, v29
    v_max3_f32 v36, v30, v31, v36
    v_max3_f32 v37, v34, v35, v37
    v_max_f32 v36, v36, v37
    v_max_f32 v37, v36, v37
    ds_read_b128 v[80:83], v11 offset:6144
    s_nop 0
    v_permlane16_swap_b32 v36, v37
    v_max_f32 v36, v36, v37
    v_max_f32 v37, v36, v37
    ds_read_b128 v[84:87], v11 offset:7168
    s_nop 0
    v_permlane32_swap_b32 v36, v37
    v_max_f32 v36, v36, v37
    v_mul_f32 v36, s80, v36
    v_fma_f32 v24, v24, s80, -v36
    v_fma_f32 v25, v25, s80, -v36
    v_exp_f32 v24, v24
    v_fma_f32 v26, v26, s80, -v36
    v_exp_f32 v25, v25
    v_fma_f32 v27, v27, s80, -v36
    v_exp_f32 v26, v26
    v_fma_f32 v28, v28, s80, -v36
    v_exp_f32 v27, v27
    v_fma_f32 v29, v29, s80, -v36
    v_exp_f32 v28, v28
    v_fma_f32 v30, v30, s80, -v36
    v_exp_f32 v29, v29
    v_fma_f32 v31, v31, s80, -v36
    v_exp_f32 v30, v30
    v_fma_f32 v34, v34, s80, -v36
    v_exp_f32 v31, v31
    v_fma_f32 v35, v35, s80, -v36
    v_exp_f32 v34, v34
    v_exp_f32 v35, v35
    v_cvt_pk_bf16_f32 v120, v24, v25
    v_cvt_pk_bf16_f32 v121, v26, v27
    v_cvt_pk_bf16_f32 v122, v28, v29
    v_cvt_pk_bf16_f32 v123, v30, v31
    v_cvt_pk_bf16_f32 v124, v34, v35
    s_nop 0
    v_mfma_f32_16x16x32_bf16 v[32:35], v[52:55], v[120:123], 0
    v_pk_add_f32 v[112:113], v[112:113], v[114:115]
    v_pk_add_f32 v[116:117], v[116:117], v[118:119]
    v_mfma_f32_16x16x32_bf16 v[24:27], v[88:91], v[120:123], 0
    v_cvt_pk_bf16_f32 v36, v112, v113
    v_cvt_pk_bf16_f32 v37, v116, v117
    v_mfma_f32_16x16x32_bf16 v[28:31], v[92:95], v[120:123], 0
    v_cvt_pk_bf16_f32 v38, v116, v117
    v_mov_b32 v39, 0
    v_mfma_f32_16x16x16_bf16 v[32:35], v[52:53], v[124:125], v[32:35]
    s_add_u32 s56, s68, 4096
    buffer_store_dwordx2 v[36:37], v0, s[8:11], s56 offen sc1
    v_mfma_f32_16x16x16_bf16 v[24:27], v[36:37], v[124:125], v[24:27]
    ds_read_b128 v[96:99], v11 offset:8192
    v_mfma_f32_16x16x16_bf16 v[28:31], v[38:39], v[124:125], v[28:31]
    ds_read_b128 v[100:103], v11 offset:9216
    v_rcp_f32 v32, v32
    v_mov_b64 v[112:113], 0
    v_mov_b64 v[114:115], 0
    v_pk_mul_f32 v[24:25], v[24:25], v[32:33] op_sel_hi:[1,0]
    v_pk_mul_f32 v[26:27], v[26:27], v[32:33] op_sel_hi:[1,0]
    v_mov_b64 v[116:117], 0
    v_mov_b64 v[118:119], 0
    v_pk_mul_f32 v[28:29], v[28:29], v[32:33] op_sel_hi:[1,0]
    v_pk_mul_f32 v[30:31], v[30:31], v[32:33] op_sel_hi:[1,0]
    v_cvt_pk_bf16_f32 v120, v24, v28
    v_cvt_pk_bf16_f32 v121, v25, v29
    v_cvt_pk_bf16_f32 v122, v26, v30
    v_cvt_pk_bf16_f32 v123, v27, v31
    ds_write_b128 v7, v[120:123]
    ds_read_b128 v[104:107], v11 offset:10240
    ds_read_b128 v[108:111], v11 offset:11264
    ds_read_b128 v[40:43], v11 offset:12288
    ds_read_b128 v[44:47], v11 offset:13312
    s_waitcnt lgkmcnt(4)
    s_barrier
    ds_read_b128 v[24:27], v8 offset:0
    ds_read_b128 v[28:31], v8 offset:512
    ds_read_b128 v[32:35], v8 offset:1024
    ds_read_b128 v[36:39], v8 offset:1536
    ds_read_b128 v[48:51], v11 offset:14336
    ds_read_b128 v[52:55], v11 offset:15360
    v_mov_b64 v[88:89], 0
    v_mov_b64 v[90:91], 0
    v_mov_b64 v[92:93], 0
    v_mov_b64 v[94:95], 0
    s_waitcnt lgkmcnt(5)
    v_smfmac_f32_16x16x64_bf16 v[112:115], v[24:27], v[56:63], v3
    ds_read_b128 v[56:59], v11 offset:16384
    ds_read_b128 v[60:63], v11 offset:17408
    s_waitcnt lgkmcnt(6)
    v_smfmac_f32_16x16x64_bf16 v[112:115], v[28:31], v[64:71], v3
    ds_read_b128 v[64:67], v11 offset:18432
    ds_read_b128 v[68:71], v11 offset:19456
    s_waitcnt lgkmcnt(7)
    v_smfmac_f32_16x16x64_bf16 v[112:115], v[32:35], v[72:79], v3
    ds_read_b128 v[72:75], v11 offset:20480
    ds_read_b128 v[76:79], v11 offset:21504
    s_waitcnt lgkmcnt(8)
    v_smfmac_f32_16x16x64_bf16 v[112:115], v[36:39], v[80:87], v3
    ds_read_b128 v[80:83], v11 offset:22528
    ds_read_b128 v[84:87], v11 offset:23552
    s_waitcnt lgkmcnt(8)
    v_smfmac_f32_16x16x64_bf16 v[116:119], v[24:27], v[96:103], v3
    ds_read_b128 v[96:99], v11 offset:24576
    ds_read_b128 v[100:103], v11 offset:25600
    v_smfmac_f32_16x16x64_bf16 v[116:119], v[28:31], v[104:111], v3
    v_cvt_pk_bf16_f32 v112, v112, v113
    v_cvt_pk_bf16_f32 v113, v114, v115
    buffer_store_dwordx2 v[112:113], v9, s[8:11], s65 offen
    ds_read_b128 v[104:107], v11 offset:26624
    ds_read_b128 v[108:111], v11 offset:27648
    v_smfmac_f32_16x16x64_bf16 v[116:119], v[32:35], v[40:47], v3
    ds_read_b128 v[40:43], v11 offset:28672
    ds_read_b128 v[44:47], v11 offset:29696
    v_smfmac_f32_16x16x64_bf16 v[116:119], v[36:39], v[48:55], v3
    s_waitcnt lgkmcnt(12)
    ds_read_b128 v[48:51], v11 offset:30720
    ds_read_b128 v[52:55], v11 offset:31744
    s_waitcnt lgkmcnt(14)
    v_smfmac_f32_16x16x64_bf16 v[88:91], v[24:27], v[56:63], v3
    s_nop 2
    v_cvt_pk_bf16_f32 v116, v116, v117
    v_cvt_pk_bf16_f32 v117, v118, v119
    s_add_u32 s56, s65, 65536
    buffer_store_dwordx2 v[116:117], v9, s[8:11], s56 offen
    s_waitcnt lgkmcnt(12)
    v_smfmac_f32_16x16x64_bf16 v[88:91], v[28:31], v[64:71], v3
    s_waitcnt lgkmcnt(10)
    v_smfmac_f32_16x16x64_bf16 v[88:91], v[32:35], v[72:79], v3
    s_waitcnt lgkmcnt(8)
    v_smfmac_f32_16x16x64_bf16 v[88:91], v[36:39], v[80:87], v3
    s_waitcnt lgkmcnt(6)
    v_smfmac_f32_16x16x64_bf16 v[92:95], v[24:27], v[96:103], v3
    s_waitcnt lgkmcnt(4)
    v_smfmac_f32_16x16x64_bf16 v[92:95], v[28:31], v[104:111], v3
    v_cvt_pk_bf16_f32 v88, v88, v89
    v_cvt_pk_bf16_f32 v89, v90, v91
    s_add_u32 s56, s65, 131072
    buffer_store_dwordx2 v[88:89], v9, s[8:11], s56 offen
    s_waitcnt lgkmcnt(2)
    v_smfmac_f32_16x16x64_bf16 v[92:95], v[32:35], v[40:47], v3
    s_waitcnt lgkmcnt(0)
    v_smfmac_f32_16x16x64_bf16 v[92:95], v[36:39], v[48:55], v3
    s_add_u32 s78, s79, s75
    s_add_u32 s75, s75, 8192
    s_add_u32 s64, s75, 11534336
    s_add_u32 s70, s64, 4096
    s_add_u32 s68, s68, 262144
    s_add_u32 s51, s51, 1
    s_nop 1
    v_cvt_pk_bf16_f32 v92, v92, v93
    v_cvt_pk_bf16_f32 v93, v94, v95
    s_add_u32 s56, s65, 196608
    buffer_store_dwordx2 v[92:93], v9, s[8:11], s56 offen
    s_xor_b32 s65, s65, 262144
    s_cmp_eq_u32 s51, 64
    s_cbranch_scc1 L_cend_63
    s_cmp_lt_u32 s47, 16
    s_waitcnt vmcnt(2)
    s_cbranch_scc1 L_cea_70
    s_barrier
    ds_read_b128 v[56:59], v1 offset:0
    ds_read_b128 v[60:63], v1 offset:4096
    ds_read_b128 v[64:67], v1 offset:1024
    ds_read_b128 v[68:71], v1 offset:5120
    ds_read_b128 v[72:75], v1 offset:2048
    ds_read_b128 v[76:79], v1 offset:6144
    ds_read_b128 v[80:83], v1 offset:3072
    ds_read_b128 v[84:87], v1 offset:7168
    v_add_u32 v12, s73, v1
    ds_read_b128 v[88:91], v12 offset:8192
    ds_read_b128 v[92:95], v12 offset:9216
    v_mov_b64 v[96:97], 0
    v_mov_b64 v[98:99], 0
    v_mov_b64 v[100:101], 0
    v_mov_b64 v[102:103], 0
    v_mov_b64 v[104:105], 0
    v_mov_b64 v[106:107], 0
    v_mov_b64 v[108:109], 0
    v_mov_b64 v[110:111], 0
    v_mov_b64 v[112:113], 0
    v_mov_b64 v[114:115], 0
    v_mov_b64 v[116:117], 0
    v_mov_b64 v[118:119], 0
    v_readlane_b32 s76, v23, 4
    s_cmp_ge_u32 s51, 63
    s_cselect_b32 s76, 1, s76
    s_waitcnt vmcnt(0)
L_crp_65:
    buffer_load_dwordx4 v[120:123], v0, s[8:11], s66 offen offset:0 sc1
    buffer_load_dwordx4 v[124:127], v0, s[8:11], s66 offen offset:1024 sc1
    s_sub_u32 s49, s49, 1
    s_cbranch_scc1 L_abort
    s_waitcnt vmcnt(1)
    v_mfma_f32_16x16x32_bf16 v[28:31], v[18:21], v[120:123], 0
    s_waitcnt vmcnt(0)
    v_mfma_f32_16x16x32_bf16 v[28:31], v[18:21], v[124:127], v[28:31]
    s_nop 7
    v_cmp_u_f32 vcc, v28, v28
    v_add_f32_dpp v32, v28, v28 row_ror:8 row_mask:0xf bank_mask:0x3
    v_add_f32_dpp v33, v29, v29 row_ror:8 row_mask:0xf bank_mask:0x3
    v_add_f32_dpp v32, v30, v30 row_ror:8 row_mask:0xf bank_mask:0xc
    v_add_f32_dpp v33, v31, v31 row_ror:8 row_mask:0xf bank_mask:0xc
    s_nop 0
    v_add_f32_dpp v32, v32, v32 row_shl:4 row_mask:0xf bank_mask:0x5
    v_add_f32_dpp v33, v33, v33 row_shl:4 row_mask:0xf bank_mask:0x5
    s_cbranch_vccnz L_crp_65
    v_cvt_pk_bf16_f32 v34, v32, v33
    buffer_store_dword v34, v10, s[8:11], s64 offen
    s_mov_b32 s69, s66
    s_xor_b32 s66, s66, 262144
    buffer_load_dwordx4 v[24:27], v13, s[8:11], s64 offen sc1
    s_branch L_chain_60
L_cea_70:
    buffer_load_dwordx4 v[120:123], v0, s[8:11], s66 offen offset:0 sc1
    buffer_load_dwordx4 v[124:127], v0, s[8:11], s66 offen offset:1024 sc1
    v_mov_b64 v[96:97], 0
    v_mov_b64 v[98:99], 0
    v_mov_b64 v[100:101], 0
    v_mov_b64 v[102:103], 0
    v_mov_b64 v[104:105], 0
    v_mov_b64 v[106:107], 0
    v_mov_b64 v[108:109], 0
    v_mov_b64 v[110:111], 0
    v_mov_b64 v[112:113], 0
    v_mov_b64 v[114:115], 0
    v_mov_b64 v[116:117], 0
    v_mov_b64 v[118:119], 0
    v_readlane_b32 s76, v23, 4
    s_cmp_ge_u32 s51, 63
    s_cselect_b32 s76, 1, s76
    s_branch L_cr1_71
L_crb_66:
    buffer_load_dwordx4 v[120:123], v0, s[8:11], s66 offen offset:0 sc1
    buffer_load_dwordx4 v[124:127], v0, s[8:11], s66 offen offset:1024 sc1
L_cr1_71:
    s_sub_u32 s49, s49, 1
    s_cbranch_scc1 L_abort
    s_waitcnt vmcnt(1)
    v_mfma_f32_16x16x32_bf16 v[28:31], v[18:21], v[120:123], 0
    s_waitcnt vmcnt(0)
    v_mfma_f32_16x16x32_bf16 v[28:31], v[18:21], v[124:127], v[28:31]
    s_nop 7
    v_cmp_u_f32 vcc, v28, v28
    v_add_f32_dpp v32, v28, v28 row_ror:8 row_mask:0xf bank_mask:0x3
    v_add_f32_dpp v33, v29, v29 row_ror:8 row_mask:0xf bank_mask:0x3
    v_add_f32_dpp v32, v30, v30 row_ror:8 row_mask:0xf bank_mask:0xc
    v_add_f32_dpp v33, v31, v31 row_ror:8 row_mask:0xf bank_mask:0xc
    s_nop 0
    v_add_f32_dpp v32, v32, v32 row_shl:4 row_mask:0xf bank_mask:0x5
    v_add_f32_dpp v33, v33, v33 row_shl:4 row_mask:0xf bank_mask:0x5
    s_cbranch_vccnz L_crb_66
    v_cvt_pk_bf16_f32 v34, v32, v33
    buffer_store_dword v34, v10, s[8:11], s64 offen
    s_mov_b32 s69, s66
    s_xor_b32 s66, s66, 262144
    s_barrier
    ds_read_b128 v[56:59], v1 offset:0
    ds_read_b128 v[60:63], v1 offset:4096
    ds_read_b128 v[64:67], v1 offset:1024
    ds_read_b128 v[68:71], v1 offset:5120
    buffer_load_dwordx4 v[24:27], v13, s[8:11], s64 offen sc1
    ds_read_b128 v[72:75], v1 offset:2048
    ds_read_b128 v[76:79], v1 offset:6144
    ds_read_b128 v[80:83], v1 offset:3072
    ds_read_b128 v[84:87], v1 offset:7168
    v_add_u32 v12, s73, v1
    ds_read_b128 v[88:91], v12 offset:8192
    ds_read_b128 v[92:95], v12 offset:9216
    s_branch L_chain_60
L_ckw_54:
    s_lshl2_add_u32 s59, s47, s75
    s_add_u32 s59, s59, 10493952
L_ckl_72:
    buffer_load_dword v23, off, s[8:11], s59 sc1
    s_waitcnt vmcnt(0)
    v_readfirstlane_b32 s76, v23
    s_cmp_lg_u32 s76, 0
    s_cbranch_scc1 L_ckb_55
    s_sub_u32 s49, s49, 1
    s_cmp_gt_i32 s49, 0
    s_cbranch_scc1 L_ckl_72
    s_branch L_abort
L_cpb_67:
    buffer_load_dwordx4 v[40:43], v13, s[8:11], s70 offen sc1
    s_waitcnt vmcnt(0)
    v_max3_u32 v12, v40, v41, v42
    v_max_u32 v12, v43, v12
    v_cmp_le_u32 vcc, s72, v12
    s_cbranch_vccz L_cback_69
    s_sub_u32 s49, s49, 1
    s_cmp_gt_i32 s49, 0
    s_cbranch_scc1 L_cpb_67
    s_branch L_abort
L_cend_63:
    s_waitcnt vmcnt(0)
    s_barrier
    buffer_store_dword v2, off, s[8:11], s78 sc1
    s_nop 11
    v_lshrrev_b32 v1, 4, v0
    s_branch L_rw_9
L_rc1_7:
    v_and_b32 v120, 15, v1
    v_lshrrev_b32 v121, 4, v1
    v_and_b32 v122, 2, v1
    v_cmp_eq_u32 vcc, 0, v122
    v_mov_b32 v2, 0xeeee
    v_mov_b32 v123, 0x4444
    v_cndmask_b32 v2, v2, v123, vcc
    v_and_b32 v122, 1, v1
    v_cmp_eq_u32 vcc, 0, v122
    v_mov_b32 v3, 0xdddd
    v_mov_b32 v123, 0x8888
    v_cndmask_b32 v3, v3, v123, vcc
    v_lshrrev_b32 v122, 1, v120
    v_bfe_u32 v123, v120, 2, 1
    v_xor_b32 v123, v123, v122
    v_lshlrev_b32 v4, 7, v123
    v_and_b32 v123, 1, v120
    v_lshl_add_u32 v4, v123, 6, v4
    v_xor_b32 v123, v121, v122
    v_and_b32 v123, 3, v123
    v_lshl_add_u32 v4, v123, 4, v4
    s_lshl_b32 s56, s46, 10
    s_add_u32 s56, s56, 147456
    v_add_u32 v4, s56, v4
    v_lshlrev_b32 v122, 1, v121
    v_add_u32 v122, 0, v122
    v_and_b32 v123, 1, v121
    v_xor_b32 v123, v123, v122
    v_lshlrev_b32 v5, 7, v123
    v_bfe_u32 v123, v120, 3, 1
    v_lshl_add_u32 v5, v123, 6, v5
    v_xor_b32 v123, v120, v122
    v_and_b32 v123, 3, v123
    v_lshl_add_u32 v5, v123, 4, v5
    v_bfe_u32 v123, v120, 2, 1
    v_lshl_add_u32 v5, v123, 3, v5
    v_add_u32 v5, 147456, v5
    v_lshlrev_b32 v122, 1, v121
    v_add_u32 v122, 1, v122
    v_and_b32 v123, 1, v121
    v_xor_b32 v123, v123, v122
    v_lshlrev_b32 v6, 7, v123
    v_bfe_u32 v123, v120, 3, 1
    v_lshl_add_u32 v6, v123, 6, v6
    v_xor_b32 v123, v120, v122
    v_and_b32 v123, 3, v123
    v_lshl_add_u32 v6, v123, 4, v6
    v_bfe_u32 v123, v120, 2, 1
    v_lshl_add_u32 v6, v123, 3, v6
    v_add_u32 v6, 147456, v6
    v_lshlrev_b32 v7, 7, v121
    v_lshrrev_b32 v122, 1, v120
    v_lshl_add_u32 v8, v122, 4, v7
    v_add_u32 v8, 151552, v8
    v_lshrrev_b32 v122, 2, v120
    v_lshl_add_u32 v7, v122, 5, v7
    v_and_b32 v122, 1, v120
    v_lshl_add_u32 v7, v122, 4, v7
    v_and_b32 v122, 2, v120
    v_lshl_add_u32 v7, v122, 10, v7
    s_lshl_b32 s56, s46, 9
    s_add_u32 s56, s56, 151552
    v_add_u32 v7, s56, v7
    v_lshrrev_b32 v122, 3, v1
    v_lshlrev_b32 v9, 11, v122
    v_and_b32 v122, 7, v1
    v_lshl_add_u32 v9, v122, 3, v9
    s_lshl_b32 s56, s46, 14
    s_lshl_b32 s57, s47, 6
    s_add_u32 s56, s56, s57
    v_add_u32 v9, s56, v9
    s_lshl_b32 s71, s47, 2
    s_add_u32 s71, s71, s46
    s_bfe_u32 s56, s71, 0x10003
    s_lshl_b32 s56, s56, 11
    s_and_b32 s57, s71, 1
    s_lshl_b32 s57, s57, 10
    s_add_u32 s56, s56, s57
    s_bfe_u32 s57, s71, 0x10002
    s_lshl_b32 s57, s57, 9
    s_add_u32 s56, s56, s57
    s_bfe_u32 s57, s71, 0x10001
    s_lshl_b32 s57, s57, 6
    s_add_u32 s56, s56, s57
    s_bfe_u32 s57, s71, 0x10004
    s_lshl_b32 s57, s57, 8
    s_add_u32 s56, s56, s57
    s_bfe_u32 s57, s71, 0x10005
    s_lshl_b32 s57, s57, 7
    s_add_u32 s56, s56, s57
    s_bfe_u32 s57, s71, 0x10006
    s_lshl_b32 s57, s57, 12
    s_add_u32 s56, s56, s57
    v_and_b32 v122, 3, v120
    v_lshlrev_b32 v10, 2, v122
    v_bfe_u32 v122, v120, 3, 1
    v_lshl_add_u32 v10, v122, 4, v10
    v_and_b32 v122, 1, v121
    v_lshl_add_u32 v10, v122, 5, v10
    v_add_u32 v10, s56, v10
    v_and_b32 v123, 36, v1
    v_mov_b32 v122, 0x80000000
    v_cmp_eq_u32 vcc, 0, v123
    s_nop 1
    v_cndmask_b32 v10, v122, v10, vcc
    s_lshl_b32 s56, s46, 15
    v_add_u32 v11, s56, v0
    s_lshl_b32 s71, s71, 11
    s_lshl_b32 s73, s46, 11
    s_mov_b32 s72, 0xffc00000
    s_mov_b32 s74, 0
    v_lshrrev_b32 v13, 3, v1
    v_lshlrev_b32 v13, 9, v13
    v_and_b32 v122, 7, v1
    v_lshl_add_u32 v13, v122, 4, v13
    v_and_b32 v122, 15, v1
    v_and_b32 v123, 1, v1
    v_lshlrev_b32 v123, 4, v123
    v_mov_b32 v124, 0x3f80
    v_lshlrev_b32 v124, v123, v124
    v_lshrrev_b32 v122, 1, v122
    v_cmp_eq_u32 vcc, 0, v122
    s_nop 1
    v_cndmask_b32 v18, 0, v124, vcc
    v_cmp_eq_u32 vcc, 1, v122
    s_nop 1
    v_cndmask_b32 v19, 0, v124, vcc
    v_cmp_eq_u32 vcc, 2, v122
    s_nop 1
    v_cndmask_b32 v20, 0, v124, vcc
    v_cmp_eq_u32 vcc, 3, v122
    s_nop 1
    v_cndmask_b32 v21, 0, v124, vcc
    s_and_b32 s56, s46, 1
    s_lshl_b32 s56, s56, 8
    s_and_b32 s57, s46, 2
    s_lshl_b32 s57, s57, 6
    s_add_u32 s56, s56, s57
    v_add_u32 v13, s56, v13
    s_xor_b32 s56, s46, 0
    s_lshl_b32 s56, s56, 10
    s_add_u32 s56, s56, 147456
    v_add_u32 v14, s56, v0
    s_xor_b32 s56, s46, 1
    s_lshl_b32 s56, s56, 10
    s_add_u32 s56, s56, 147456
    v_add_u32 v15, s56, v0
    s_xor_b32 s56, s46, 2
    s_lshl_b32 s56, s56, 10
    s_add_u32 s56, s56, 147456
    v_add_u32 v16, s56, v0
    s_xor_b32 s56, s46, 3
    s_lshl_b32 s56, s56, 10
    s_add_u32 s56, s56, 147456
    v_add_u32 v17, s56, v0
    v_add_u32 v22, 12599296, v10
    s_lshl_b32 s56, s47, 2
    s_add_u32 s56, s56, 10502272
    v_writelane_b32 v22, s56, 4
    s_mov_b32 s56, 10519808
    v_writelane_b32 v22, s56, 5
    v_add_u32 v1, 131072, v0
    s_mov_b32 s65, 15728640
    s_add_u32 s66, s71, 15728640
    s_add_u32 s69, s71, 15990784
    s_lshl_b32 s79, s47, 2
    s_add_u32 s79, s79, 10486272
    s_cmp_eq_u32 s46, 0
    s_cselect_b32 s79, s79, 0x80000000
    s_cmp_eq_u32 s47, 0
    s_cselect_b32 s31, 17825792, -1
    s_and_b32 s31, s31, 0x8fffffff
    s_mov_b32 s51, 0
L_cst_73:
    s_lshl_b32 s59, s51, 13
    s_lshl2_add_u32 s59, s47, s59
    s_add_u32 s59, s59, 10485888
    v_mov_b32 v120, 0
L_ww_78:
    buffer_load_dword v121, v120, s[8:11], s59 offen sc1
    s_waitcnt vmcnt(0)
    v_readfirstlane_b32 s61, v121
    s_cmp_lg_u32 s61, 0
    s_cbranch_scc1 L_wwd_79
    s_sleep 1
    s_sub_u32 s49, s49, 1
    s_cmp_gt_i32 s49, 0
    s_cbranch_scc1 L_ww_78
    s_branch L_abort
L_wwd_79:
    s_lshl_b32 s56, s51, 5
    s_add_u32 s56, s56, s47
    s_mul_i32 s56, s56, 24576
    s_add_u32 s56, s56, 150994944
    s_add_u32 s67, s56, s73
    s_add_u32 m0, s73, 131072
    s_add_u32 s57, s67, 8192
    buffer_load_dwordx4 v0, s[8:11], s67 offen sc1 lds
    buffer_load_dwordx4 v0, s[8:11], s67 offen offset:1024 sc1 lds
    s_add_u32 m0, s73, 139264
    s_add_u32 s67, s67, 786432
    buffer_load_dwordx4 v0, s[8:11], s57 offen sc1 lds
    buffer_load_dwordx4 v0, s[8:11], s57 offen offset:1024 sc1 lds
    s_lshl_b32 s75, s51, 13
    s_add_u32 s64, s75, 12582912
    s_add_u32 s70, s64, 4096
    s_lshl_b32 s68, s51, 5
    s_add_u32 s68, s68, s47
    s_lshl_b32 s68, s68, 13
    s_lshl_b32 s56, s46, 10
    s_add_u32 s68, s68, s56
    s_add_u32 s68, s68, 58720256
    s_sub_u32 s67, s67, 0
    s_mov_b32 s78, 0x80000000
    s_cmp_eq_u32 s51, 63
    s_cselect_b32 s76, 1, 0
    s_waitcnt vmcnt(0)
    s_barrier
    ds_read_b128 v[56:59], v1 offset:0
    ds_read_b128 v[60:63], v1 offset:4096
    ds_read_b128 v[64:67], v1 offset:1024
    ds_read_b128 v[68:71], v1 offset:5120
    ds_read_b128 v[72:75], v1 offset:2048
    ds_read_b128 v[76:79], v1 offset:6144
    ds_read_b128 v[80:83], v1 offset:3072
    ds_read_b128 v[84:87], v1 offset:7168
    v_add_u32 v12, s73, v1
    ds_read_b128 v[88:91], v12 offset:8192
    ds_read_b128 v[92:95], v12 offset:9216
    v_mov_b64 v[96:97], 0
    v_mov_b64 v[98:99], 0
    v_mov_b64 v[100:101], 0
    v_mov_b64 v[102:103], 0
    v_mov_b64 v[104:105], 0
    v_mov_b64 v[106:107], 0
    v_mov_b64 v[108:109], 0
    v_mov_b64 v[110:111], 0
    v_mov_b64 v[112:113], 0
    v_mov_b64 v[114:115], 0
    v_mov_b64 v[116:117], 0
    v_mov_b64 v[118:119], 0
    buffer_load_dwordx4 v[24:27], v13, s[8:11], s64 offen sc1
L_chain_80:
L_cpa_81:
    buffer_load_dwordx4 v[24:27], v13, s[8:11], s64 offen sc1
    s_sub_u32 s49, s49, 1
    s_cbranch_scc1 L_abort
    s_waitcnt vmcnt(1)
    v_max3_u32 v12, v24, v25, v26
    v_max_u32 v12, v27, v12
    v_cmp_le_u32 vcc, s72, v12
    s_cbranch_vccnz L_cpa_81
L_cgo_84:
    ds_write_b128 v14, v[24:27] offset:0
    buffer_load_dwordx4 v[40:43], v13, s[8:11], s70 offen sc1
    v_smfmac_f32_16x16x64_bf16 v[96:99], v[24:27], a[0:7], v2
    s_add_u32 m0, s73, 131072
    v_smfmac_f32_16x16x64_bf16 v[100:103], v[24:27], a[128:135], v2
    s_add_u32 s57, s67, 8192
    v_smfmac_f32_16x16x64_bf16 v[104:107], v[24:27], a[8:15], v2
    s_add_u32 s30, s31, s75
    v_smfmac_f32_16x16x64_bf16 v[108:111], v[24:27], a[136:143], v2
    s_add_u32 s58, s30, 4096
    s_waitcnt lgkmcnt(0)
    s_barrier
    ds_read_b128 v[28:31], v15 offset:0
    ds_read_b128 v[32:35], v16 offset:0
    ds_read_b128 v[36:39], v17 offset:0
    v_smfmac_f32_16x16x64_bf16 v[112:115], v[24:27], v[128:135], v2
    v_smfmac_f32_16x16x64_bf16 v[116:119], v[24:27], v[136:143], v2
    s_waitcnt lgkmcnt(2)
    v_smfmac_f32_16x16x64_bf16 v[96:99], v[28:31], a[16:23], v2
    s_lshl_b32 s56, s46, 10
    v_smfmac_f32_16x16x64_bf16 v[100:103], v[28:31], a[144:151], v2
    v_smfmac_f32_16x16x64_bf16 v[104:107], v[28:31], a[24:31], v2
    v_smfmac_f32_16x16x64_bf16 v[108:111], v[28:31], a[152:159], v2
    s_waitcnt lgkmcnt(1) vmcnt(0)
    v_smfmac_f32_16x16x64_bf16 v[96:99], v[32:35], a[32:39], v2
    v_max3_u32 v12, v40, v41, v42
    v_smfmac_f32_16x16x64_bf16 v[100:103], v[32:35], a[160:167], v2
    v_max_u32 v12, v43, v12
    v_smfmac_f32_16x16x64_bf16 v[104:107], v[32:35], a[40:47], v2
    v_cmp_le_u32 vcc, s72, v12
    v_smfmac_f32_16x16x64_bf16 v[108:111], v[32:35], a[168:175], v2
    s_cbranch_vccnz L_cpb_87
L_cback_89:
    s_waitcnt lgkmcnt(0)
    ds_write_b128 v14, v[40:43] offset:4096
    v_smfmac_f32_16x16x64_bf16 v[96:99], v[36:39], a[48:55], v2
    v_mov_b64 v[120:121], -1
    v_smfmac_f32_16x16x64_bf16 v[100:103], v[36:39], a[176:183], v2
    v_mov_b64 v[122:123], -1
    v_smfmac_f32_16x16x64_bf16 v[104:107], v[36:39], a[56:63], v2
    v_add_u32 v124, s56, v5
    v_smfmac_f32_16x16x64_bf16 v[108:111], v[36:39], a[184:191], v2
    v_add_u32 v126, s56, v6
    s_waitcnt lgkmcnt(0)
    s_barrier
    v_smfmac_f32_16x16x64_bf16 v[96:99], v[40:43], a[64:71], v2
    ds_read_b128 v[44:47], v15 offset:4096
    v_smfmac_f32_16x16x64_bf16 v[100:103], v[40:43], a[192:199], v2
    ds_read_b128 v[48:51], v16 offset:4096
    v_smfmac_f32_16x16x64_bf16 v[104:107], v[40:43], a[72:79], v2
    ds_read_b128 v[52:55], v17 offset:4096
    v_smfmac_f32_16x16x64_bf16 v[108:111], v[40:43], a[200:207], v2
    s_cmp_eq_u32 s76, 0
    s_cbranch_scc1 L_ckw_74
L_ckb_75:
    s_waitcnt lgkmcnt(2)
    v_smfmac_f32_16x16x64_bf16 v[96:99], v[44:47], a[80:87], v2
    buffer_load_dwordx4 v0, s[8:11], s67 offen sc1 lds
    v_smfmac_f32_16x16x64_bf16 v[100:103], v[44:47], a[208:215], v2
    buffer_load_dwordx4 v0, s[8:11], s67 offen offset:1024 sc1 lds
    v_smfmac_f32_16x16x64_bf16 v[104:107], v[44:47], a[88:95], v2
    s_add_u32 m0, s73, 139264
    v_smfmac_f32_16x16x64_bf16 v[108:111], v[44:47], a[216:223], v2
    s_waitcnt lgkmcnt(1)
    v_smfmac_f32_16x16x64_bf16 v[96:99], v[48:51], a[96:103], v2
    s_add_u32 s67, s67, 786432
    v_smfmac_f32_16x16x64_bf16 v[100:103], v[48:51], a[224:231], v2
    buffer_load_dwordx4 v0, s[8:11], s57 offen sc1 lds
    v_smfmac_f32_16x16x64_bf16 v[104:107], v[48:51], a[104:111], v2
    buffer_load_dwordx4 v0, s[8:11], s57 offen offset:1024 sc1 lds
    v_smfmac_f32_16x16x64_bf16 v[108:111], v[48:51], a[232:239], v2
    s_waitcnt lgkmcnt(0)
    v_smfmac_f32_16x16x64_bf16 v[96:99], v[52:55], a[112:119], v2
    buffer_load_dword v23, v22, s[8:11], s75 offen sc1
    v_smfmac_f32_16x16x64_bf16 v[100:103], v[52:55], a[240:247], v2
    buffer_store_dword v2, off, s[8:11], s78 sc1
    v_smfmac_f32_16x16x64_bf16 v[104:107], v[52:55], a[120:127], v2
    buffer_store_dwordx4 v[120:123], v0, s[8:11], s69 offen
    v_smfmac_f32_16x16x64_bf16 v[108:111], v[52:55], a[248:255], v2
    buffer_store_dwordx4 v[120:123], v0, s[8:11], s69 offen offset:1024
    buffer_store_dwordx4 v[24:27], v13, s[8:11], s30 offen sc1
    buffer_store_dwordx4 v[40:43], v13, s[8:11], s58 offen sc1
    v_smfmac_f32_16x16x64_bf16 v[112:115], v[28:31], v[144:151], v2
    v_smfmac_f32_16x16x64_bf16 v[116:119], v[28:31], v[152:159], v2
    v_pk_add_f32 v[96:97], v[96:97], v[98:99]
    v_pk_add_f32 v[100:101], v[100:101], v[102:103]
    v_cvt_pk_bf16_f32 v120, v96, v97
    v_cvt_pk_bf16_f32 v121, v100, v101
    v_pk_add_f32 v[104:105], v[104:105], v[106:107]
    v_pk_add_f32 v[108:109], v[108:109], v[110:111]
    v_cvt_pk_bf16_f32 v122, v104, v105
    v_cvt_pk_bf16_f32 v123, v108, v109
    ds_write_b128 v4, v[120:123]
    v_smfmac_f32_16x16x64_bf16 v[112:115], v[32:35], v[160:167], v2
    v_smfmac_f32_16x16x64_bf16 v[116:119], v[32:35], v[168:175], v2
    v_smfmac_f32_16x16x64_bf16 v[112:115], v[36:39], v[176:183], v2
    v_smfmac_f32_16x16x64_bf16 v[116:119], v[36:39], v[184:191], v2
    s_waitcnt lgkmcnt(0)
    s_barrier
    ds_read_b64_tr_b16 v[96:97], v5 offset:0
    ds_read_b64_tr_b16 v[98:99], v6 offset:0
    ds_read_b64_tr_b16 v[100:101], v5 offset:1024
    ds_read_b64_tr_b16 v[102:103], v6 offset:1024
    ds_read_b64_tr_b16 v[104:105], v5 offset:2048
    ds_read_b64_tr_b16 v[106:107], v6 offset:2048
    ds_read_b64_tr_b16 v[108:109], v5 offset:3072
    ds_read_b64_tr_b16 v[110:111], v6 offset:3072
    ds_read_b64_tr_b16 v[124:125], v124
    ds_read_b64_tr_b16 v[126:127], v126
    v_smfmac_f32_16x16x64_bf16 v[112:115], v[40:43], v[192:199], v2
    v_smfmac_f32_16x16x64_bf16 v[116:119], v[40:43], v[200:207], v2
    s_waitcnt lgkmcnt(8)
    v_mfma_f32_16x16x32_bf16 v[24:27], v[56:59], v[96:99], 0
    v_mfma_f32_16x16x32_bf16 v[28:31], v[60:63], v[96:99], 0
    v_mfma_f32_16x16x32_bf16 v[32:35], v[96:99], v[96:99], 0
    s_waitcnt lgkmcnt(6)
    v_mfma_f32_16x16x32_bf16 v[24:27], v[64:67], v[100:103], v[24:27]
    ds_read_b128 v[56:59], v11 offset:0
    v_mfma_f32_16x16x32_bf16 v[28:31], v[68:71], v[100:103], v[28:31]
    ds_read_b128 v[60:63], v11 offset:1024
    v_mfma_f32_16x16x32_bf16 v[32:35], v[100:103], v[100:103], v[32:35]
    s_waitcnt lgkmcnt(6)
    v_mfma_f32_16x16x32_bf16 v[24:27], v[72:75], v[104:107], v[24:27]
    ds_read_b128 v[64:67], v11 offset:2048
    v_mfma_f32_16x16x32_bf16 v[28:31], v[76:79], v[104:107], v[28:31]
    ds_read_b128 v[68:71], v11 offset:3072
    v_mfma_f32_16x16x32_bf16 v[32:35], v[104:107], v[104:107], v[32:35]
    s_waitcnt lgkmcnt(6)
    v_mfma_f32_16x16x32_bf16 v[24:27], v[80:83], v[108:111], v[24:27]
    ds_read_b128 v[72:75], v11 offset:4096
    v_mfma_f32_16x16x32_bf16 v[28:31], v[84:87], v[108:111], v[28:31]
    ds_read_b128 v[76:79], v11 offset:5120
    v_mfma_f32_16x16x32_bf16 v[32:35], v[108:111], v[108:111], v[32:35]
    s_waitcnt lgkmcnt(6)
    v_smfmac_f32_16x16x64_bf16 v[112:115], v[44:47], v[208:215], v2
    buffer_store_dwordx4 v[124:127], v0, s[8:11], s68 offen sc1
    v_smfmac_f32_16x16x64_bf16 v[116:119], v[44:47], v[216:223], v2
    v_smfmac_f32_16x16x64_bf16 v[112:115], v[48:51], v[224:231], v2
    v_smfmac_f32_16x16x64_bf16 v[116:119], v[48:51], v[232:239], v2
    v_smfmac_f32_16x16x64_bf16 v[112:115], v[52:55], v[240:247], v2
    v_smfmac_f32_16x16x64_bf16 v[116:119], v[52:55], v[248:255], v2
    v_mov_b32 v125, 0
    v_mov_b64 v[52:53], s[28:29]
    v_mov_b64 v[54:55], s[28:29]
    v_max3_f32 v36, v24, v25, v26
    v_max3_f32 v37, v27, v28, v29
    v_max3_f32 v36, v30, v31, v36
    v_max3_f32 v37, v34, v35, v37
    v_max_f32 v36, v36, v37
    v_max_f32 v37, v36, v37
    ds_read_b128 v[80:83], v11 offset:6144
    s_nop 0
    v_permlane16_swap_b32 v36, v37
    v_max_f32 v36, v36, v37
    v_max_f32 v37, v36, v37
    ds_read_b128 v[84:87], v11 offset:7168
    s_nop 0
    v_permlane32_swap_b32 v36, v37
    v_max_f32 v36, v36, v37
    v_mul_f32 v36, s80, v36
    v_fma_f32 v24, v24, s80, -v36
    v_fma_f32 v25, v25, s80, -v36
    v_exp_f32 v24, v24
    v_fma_f32 v26, v26, s80, -v36
    v_exp_f32 v25, v25
    v_fma_f32 v27, v27, s80, -v36
    v_exp_f32 v26, v26
    v_fma_f32 v28, v28, s80, -v36
    v_exp_f32 v27, v27
    v_fma_f32 v29, v29, s80, -v36
    v_exp_f32 v28, v28
    v_fma_f32 v30, v30, s80, -v36
    v_exp_f32 v29, v29
    v_fma_f32 v31, v31, s80, -v36
    v_exp_f32 v30, v30
    v_fma_f32 v34, v34, s80, -v36
    v_exp_f32 v31, v31
    v_fma_f32 v35, v35, s80, -v36
    v_exp_f32 v34, v34
    v_exp_f32 v35, v35
    v_cvt_pk_bf16_f32 v120, v24, v25
    v_cvt_pk_bf16_f32 v121, v26, v27
    v_cvt_pk_bf16_f32 v122, v28, v29
    v_cvt_pk_bf16_f32 v123, v30, v31
    v_cvt_pk_bf16_f32 v124, v34, v35
    s_nop 0
    v_mfma_f32_16x16x32_bf16 v[32:35], v[52:55], v[120:123], 0
    v_pk_add_f32 v[112:113], v[112:113], v[114:115]
    v_pk_add_f32 v[116:117], v[116:117], v[118:119]
    v_mfma_f32_16x16x32_bf16 v[24:27], v[88:91], v[120:123], 0
    v_cvt_pk_bf16_f32 v36, v112, v113
    v_cvt_pk_bf16_f32 v37, v116, v117
    v_mfma_f32_16x16x32_bf16 v[28:31], v[92:95], v[120:123], 0
    v_cvt_pk_bf16_f32 v38, v116, v117
    v_mov_b32 v39, 0
    v_mfma_f32_16x16x16_bf16 v[32:35], v[52:53], v[124:125], v[32:35]
    s_add_u32 s56, s68, 4096
    buffer_store_dwordx2 v[36:37], v0, s[8:11], s56 offen sc1
    v_mfma_f32_16x16x16_bf16 v[24:27], v[36:37], v[124:125], v[24:27]
    ds_read_b128 v[96:99], v11 offset:8192
    v_mfma_f32_16x16x16_bf16 v[28:31], v[38:39], v[124:125], v[28:31]
    ds_read_b128 v[100:103], v11 offset:9216
    v_rcp_f32 v32, v32
    v_mov_b64 v[112:113], 0
    v_mov_b64 v[114:115], 0
    v_pk_mul_f32 v[24:25], v[24:25], v[32:33] op_sel_hi:[1,0]
    v_pk_mul_f32 v[26:27], v[26:27], v[32:33] op_sel_hi:[1,0]
    v_mov_b64 v[116:117], 0
    v_mov_b64 v[118:119], 0
    v_pk_mul_f32 v[28:29], v[28:29], v[32:33] op_sel_hi:[1,0]
    v_pk_mul_f32 v[30:31], v[30:31], v[32:33] op_sel_hi:[1,0]
    v_cvt_pk_bf16_f32 v120, v24, v28
    v_cvt_pk_bf16_f32 v121, v25, v29
    v_cvt_pk_bf16_f32 v122, v26, v30
    v_cvt_pk_bf16_f32 v123, v27, v31
    ds_write_b128 v7, v[120:123]
    ds_read_b128 v[104:107], v11 offset:10240
    ds_read_b128 v[108:111], v11 offset:11264
    ds_read_b128 v[40:43], v11 offset:12288
    ds_read_b128 v[44:47], v11 offset:13312
    s_waitcnt lgkmcnt(4)
    s_barrier
    ds_read_b128 v[24:27], v8 offset:0
    ds_read_b128 v[28:31], v8 offset:512
    ds_read_b128 v[32:35], v8 offset:1024
    ds_read_b128 v[36:39], v8 offset:1536
    ds_read_b128 v[48:51], v11 offset:14336
    ds_read_b128 v[52:55], v11 offset:15360
    v_mov_b64 v[88:89], 0
    v_mov_b64 v[90:91], 0
    v_mov_b64 v[92:93], 0
    v_mov_b64 v[94:95], 0
    s_waitcnt lgkmcnt(5)
    v_smfmac_f32_16x16x64_bf16 v[112:115], v[24:27], v[56:63], v3
    ds_read_b128 v[56:59], v11 offset:16384
    ds_read_b128 v[60:63], v11 offset:17408
    s_waitcnt lgkmcnt(6)
    v_smfmac_f32_16x16x64_bf16 v[112:115], v[28:31], v[64:71], v3
    ds_read_b128 v[64:67], v11 offset:18432
    ds_read_b128 v[68:71], v11 offset:19456
    s_waitcnt lgkmcnt(7)
    v_smfmac_f32_16x16x64_bf16 v[112:115], v[32:35], v[72:79], v3
    ds_read_b128 v[72:75], v11 offset:20480
    ds_read_b128 v[76:79], v11 offset:21504
    s_waitcnt lgkmcnt(8)
    v_smfmac_f32_16x16x64_bf16 v[112:115], v[36:39], v[80:87], v3
    ds_read_b128 v[80:83], v11 offset:22528
    ds_read_b128 v[84:87], v11 offset:23552
    s_waitcnt lgkmcnt(8)
    v_smfmac_f32_16x16x64_bf16 v[116:119], v[24:27], v[96:103], v3
    ds_read_b128 v[96:99], v11 offset:24576
    ds_read_b128 v[100:103], v11 offset:25600
    v_smfmac_f32_16x16x64_bf16 v[116:119], v[28:31], v[104:111], v3
    v_cvt_pk_bf16_f32 v112, v112, v113
    v_cvt_pk_bf16_f32 v113, v114, v115
    buffer_store_dwordx2 v[112:113], v9, s[8:11], s65 offen
    ds_read_b128 v[104:107], v11 offset:26624
    ds_read_b128 v[108:111], v11 offset:27648
    v_smfmac_f32_16x16x64_bf16 v[116:119], v[32:35], v[40:47], v3
    ds_read_b128 v[40:43], v11 offset:28672
    ds_read_b128 v[44:47], v11 offset:29696
    v_smfmac_f32_16x16x64_bf16 v[116:119], v[36:39], v[48:55], v3
    s_waitcnt lgkmcnt(12)
    ds_read_b128 v[48:51], v11 offset:30720
    ds_read_b128 v[52:55], v11 offset:31744
    s_waitcnt lgkmcnt(14)
    v_smfmac_f32_16x16x64_bf16 v[88:91], v[24:27], v[56:63], v3
    s_nop 2
    v_cvt_pk_bf16_f32 v116, v116, v117
    v_cvt_pk_bf16_f32 v117, v118, v119
    s_add_u32 s56, s65, 65536
    buffer_store_dwordx2 v[116:117], v9, s[8:11], s56 offen
    s_waitcnt lgkmcnt(12)
    v_smfmac_f32_16x16x64_bf16 v[88:91], v[28:31], v[64:71], v3
    s_waitcnt lgkmcnt(10)
    v_smfmac_f32_16x16x64_bf16 v[88:91], v[32:35], v[72:79], v3
    s_waitcnt lgkmcnt(8)
    v_smfmac_f32_16x16x64_bf16 v[88:91], v[36:39], v[80:87], v3
    s_waitcnt lgkmcnt(6)
    v_smfmac_f32_16x16x64_bf16 v[92:95], v[24:27], v[96:103], v3
    s_waitcnt lgkmcnt(4)
    v_smfmac_f32_16x16x64_bf16 v[92:95], v[28:31], v[104:111], v3
    v_cvt_pk_bf16_f32 v88, v88, v89
    v_cvt_pk_bf16_f32 v89, v90, v91
    s_add_u32 s56, s65, 131072
    buffer_store_dwordx2 v[88:89], v9, s[8:11], s56 offen
    s_waitcnt lgkmcnt(2)
    v_smfmac_f32_16x16x64_bf16 v[92:95], v[32:35], v[40:47], v3
    s_waitcnt lgkmcnt(0)
    v_smfmac_f32_16x16x64_bf16 v[92:95], v[36:39], v[48:55], v3
    s_add_u32 s78, s79, s75
    s_add_u32 s75, s75, 8192
    s_add_u32 s64, s75, 12582912
    s_add_u32 s70, s64, 4096
    s_add_u32 s68, s68, 262144
    s_add_u32 s51, s51, 1
    s_nop 1
    v_cvt_pk_bf16_f32 v92, v92, v93
    v_cvt_pk_bf16_f32 v93, v94, v95
    s_add_u32 s56, s65, 196608
    buffer_store_dwordx2 v[92:93], v9, s[8:11], s56 offen
    s_xor_b32 s65, s65, 262144
    s_cmp_eq_u32 s51, 64
    s_cbranch_scc1 L_cend_83
    s_cmp_lt_u32 s47, 16
    s_waitcnt vmcnt(2)
    s_cbranch_scc1 L_cea_90
    s_barrier
    ds_read_b128 v[56:59], v1 offset:0
    ds_read_b128 v[60:63], v1 offset:4096
    ds_read_b128 v[64:67], v1 offset:1024
    ds_read_b128 v[68:71], v1 offset:5120
    ds_read_b128 v[72:75], v1 offset:2048
    ds_read_b128 v[76:79], v1 offset:6144
    ds_read_b128 v[80:83], v1 offset:3072
    ds_read_b128 v[84:87], v1 offset:7168
    v_add_u32 v12, s73, v1
    ds_read_b128 v[88:91], v12 offset:8192
    ds_read_b128 v[92:95], v12 offset:9216
    v_mov_b64 v[96:97], 0
    v_mov_b64 v[98:99], 0
    v_mov_b64 v[100:101], 0
    v_mov_b64 v[102:103], 0
    v_mov_b64 v[104:105], 0
    v_mov_b64 v[106:107], 0
    v_mov_b64 v[108:109], 0
    v_mov_b64 v[110:111], 0
    v_mov_b64 v[112:113], 0
    v_mov_b64 v[114:115], 0
    v_mov_b64 v[116:117], 0
    v_mov_b64 v[118:119], 0
    v_readlane_b32 s76, v23, 4
    s_cmp_ge_u32 s51, 63
    s_cselect_b32 s76, 1, s76
    s_waitcnt vmcnt(0)
L_crp_85:
    buffer_load_dwordx4 v[120:123], v0, s[8:11], s66 offen offset:0 sc1
    buffer_load_dwordx4 v[124:127], v0, s[8:11], s66 offen offset:1024 sc1
    s_sub_u32 s49, s49, 1
    s_cbranch_scc1 L_abort
    s_waitcnt vmcnt(1)
    v_mfma_f32_16x16x32_bf16 v[28:31], v[18:21], v[120:123], 0
    s_waitcnt vmcnt(0)
    v_mfma_f32_16x16x32_bf16 v[28:31], v[18:21], v[124:127], v[28:31]
    s_nop 7
    v_cmp_u_f32 vcc, v28, v28
    v_add_f32_dpp v32, v28, v28 row_ror:8 row_mask:0xf bank_mask:0x3
    v_add_f32_dpp v33, v29, v29 row_ror:8 row_mask:0xf bank_mask:0x3
    v_add_f32_dpp v32, v30, v30 row_ror:8 row_mask:0xf bank_mask:0xc
    v_add_f32_dpp v33, v31, v31 row_ror:8 row_mask:0xf bank_mask:0xc
    s_nop 0
    v_add_f32_dpp v32, v32, v32 row_shl:4 row_mask:0xf bank_mask:0x5
    v_add_f32_dpp v33, v33, v33 row_shl:4 row_mask:0xf bank_mask:0x5
    s_cbranch_vccnz L_crp_85
    v_cvt_pk_bf16_f32 v34, v32, v33
    buffer_store_dword v34, v10, s[8:11], s64 offen
    s_mov_b32 s69, s66
    s_xor_b32 s66, s66, 262144
    buffer_load_dwordx4 v[24:27], v13, s[8:11], s64 offen sc1
    s_branch L_chain_80
L_cea_90:
    buffer_load_dwordx4 v[120:123], v0, s[8:11], s66 offen offset:0 sc1
    buffer_load_dwordx4 v[124:127], v0, s[8:11], s66 offen offset:1024 sc1
    v_mov_b64 v[96:97], 0
    v_mov_b64 v[98:99], 0
    v_mov_b64 v[100:101], 0
    v_mov_b64 v[102:103], 0
    v_mov_b64 v[104:105], 0
    v_mov_b64 v[106:107], 0
    v_mov_b64 v[108:109], 0
    v_mov_b64 v[110:111], 0
    v_mov_b64 v[112:113], 0
    v_mov_b64 v[114:115], 0
    v_mov_b64 v[116:117], 0
    v_mov_b64 v[118:119], 0
    v_readlane_b32 s76, v23, 4
    s_cmp_ge_u32 s51, 63
    s_cselect_b32 s76, 1, s76
    s_branch L_cr1_91
L_crb_86:
    buffer_load_dwordx4 v[120:123], v0, s[8:11], s66 offen offset:0 sc1
    buffer_load_dwordx4 v[124:127], v0, s[8:11], s66 offen offset:1024 sc1
L_cr1_91:
    s_sub_u32 s49, s49, 1
    s_cbranch_scc1 L_abort
    s_waitcnt vmcnt(1)
    v_mfma_f32_16x16x32_bf16 v[28:31], v[18:21], v[120:123], 0
    s_waitcnt vmcnt(0)
    v_mfma_f32_16x16x32_bf16 v[28:31], v[18:21], v[124:127], v[28:31]
    s_nop 7
    v_cmp_u_f32 vcc, v28, v28
    v_add_f32_dpp v32, v28, v28 row_ror:8 row_mask:0xf bank_mask:0x3
    v_add_f32_dpp v33, v29, v29 row_ror:8 row_mask:0xf bank_mask:0x3
    v_add_f32_dpp v32, v30, v30 row_ror:8 row_mask:0xf bank_mask:0xc
    v_add_f32_dpp v33, v31, v31 row_ror:8 row_mask:0xf bank_mask:0xc
    s_nop 0
    v_add_f32_dpp v32, v32, v32 row_shl:4 row_mask:0xf bank_mask:0x5
    v_add_f32_dpp v33, v33, v33 row_shl:4 row_mask:0xf bank_mask:0x5
    s_cbranch_vccnz L_crb_86
    v_cvt_pk_bf16_f32 v34, v32, v33
    buffer_store_dword v34, v10, s[8:11], s64 offen
    s_mov_b32 s69, s66
    s_xor_b32 s66, s66, 262144
    s_barrier
    ds_read_b128 v[56:59], v1 offset:0
    ds_read_b128 v[60:63], v1 offset:4096
    ds_read_b128 v[64:67], v1 offset:1024
    ds_read_b128 v[68:71], v1 offset:5120
    buffer_load_dwordx4 v[24:27], v13, s[8:11], s64 offen sc1
    ds_read_b128 v[72:75], v1 offset:2048
    ds_read_b128 v[76:79], v1 offset:6144
    ds_read_b128 v[80:83], v1 offset:3072
    ds_read_b128 v[84:87], v1 offset:7168
    v_add_u32 v12, s73, v1
    ds_read_b128 v[88:91], v12 offset:8192
    ds_read_b128 v[92:95], v12 offset:9216
    s_branch L_chain_80
L_ckw_74:
    s_lshl2_add_u32 s59, s47, s75
    s_add_u32 s59, s59, 10494080
L_ckl_92:
    buffer_load_dword v23, off, s[8:11], s59 sc1
    s_waitcnt vmcnt(0)
    v_readfirstlane_b32 s76, v23
    s_cmp_lg_u32 s76, 0
    s_cbranch_scc1 L_ckb_75
    s_sub_u32 s49, s49, 1
    s_cmp_gt_i32 s49, 0
    s_cbranch_scc1 L_ckl_92
    s_branch L_abort
L_cpb_87:
    buffer_load_dwordx4 v[40:43], v13, s[8:11], s70 offen sc1
    s_waitcnt vmcnt(0)
    v_max3_u32 v12, v40, v41, v42
    v_max_u32 v12, v43, v12
    v_cmp_le_u32 vcc, s72, v12
    s_cbranch_vccz L_cback_89
    s_sub_u32 s49, s49, 1
    s_cmp_gt_i32 s49, 0
    s_cbranch_scc1 L_cpb_87
    s_branch L_abort
L_cend_83:
    s_waitcnt vmcnt(0)
    s_barrier
    buffer_store_dword v2, off, s[8:11], s78 sc1
    s_nop 11
    v_lshrrev_b32 v1, 4, v0
    s_endpgm
L_rc2_8:
    v_and_b32 v120, 15, v1
    v_lshrrev_b32 v121, 4, v1
    v_and_b32 v122, 2, v1
    v_cmp_eq_u32 vcc, 0, v122
    v_mov_b32 v2, 0xeeee
    v_mov_b32 v123, 0x4444
    v_cndmask_b32 v2, v2, v123, vcc
    v_and_b32 v122, 1, v1
    v_cmp_eq_u32 vcc, 0, v122
    v_mov_b32 v3, 0xdddd
    v_mov_b32 v123, 0x8888
    v_cndmask_b32 v3, v3, v123, vcc
    v_lshrrev_b32 v122, 1, v120
    v_bfe_u32 v123, v120, 2, 1
    v_xor_b32 v123, v123, v122
    v_lshlrev_b32 v4, 7, v123
    v_and_b32 v123, 1, v120
    v_lshl_add_u32 v4, v123, 6, v4
    v_xor_b32 v123, v121, v122
    v_and_b32 v123, 3, v123
    v_lshl_add_u32 v4, v123, 4, v4
    s_lshl_b32 s56, s46, 10
    s_add_u32 s56, s56, 147456
    v_add_u32 v4, s56, v4
    v_lshlrev_b32 v122, 1, v121
    v_add_u32 v122, 0, v122
    v_and_b32 v123, 1, v121
    v_xor_b32 v123, v123, v122
    v_lshlrev_b32 v5, 7, v123
    v_bfe_u32 v123, v120, 3, 1
    v_lshl_add_u32 v5, v123, 6, v5
    v_xor_b32 v123, v120, v122
    v_and_b32 v123, 3, v123
    v_lshl_add_u32 v5, v123, 4, v5
    v_bfe_u32 v123, v120, 2, 1
    v_lshl_add_u32 v5, v123, 3, v5
    v_add_u32 v5, 147456, v5
    v_lshlrev_b32 v122, 1, v121
    v_add_u32 v122, 1, v122
    v_and_b32 v123, 1, v121
    v_xor_b32 v123, v123, v122
    v_lshlrev_b32 v6, 7, v123
    v_bfe_u32 v123, v120, 3, 1
    v_lshl_add_u32 v6, v123, 6, v6
    v_xor_b32 v123, v120, v122
    v_and_b32 v123, 3, v123
    v_lshl_add_u32 v6, v123, 4, v6
    v_bfe_u32 v123, v120, 2, 1
    v_lshl_add_u32 v6, v123, 3, v6
    v_add_u32 v6, 147456, v6
    v_lshlrev_b32 v7, 7, v121
    v_lshrrev_b32 v122, 1, v120
    v_lshl_add_u32 v8, v122, 4, v7
    v_add_u32 v8, 151552, v8
    v_lshrrev_b32 v122, 2, v120
    v_lshl_add_u32 v7, v122, 5, v7
    v_and_b32 v122, 1, v120
    v_lshl_add_u32 v7, v122, 4, v7
    v_and_b32 v122, 2, v120
    v_lshl_add_u32 v7, v122, 10, v7
    s_lshl_b32 s56, s46, 9
    s_add_u32 s56, s56, 151552
    v_add_u32 v7, s56, v7
    v_lshrrev_b32 v122, 3, v1
    v_lshlrev_b32 v9, 11, v122
    v_and_b32 v122, 7, v1
    v_lshl_add_u32 v9, v122, 3, v9
    s_lshl_b32 s56, s46, 14
    s_lshl_b32 s57, s47, 6
    s_add_u32 s56, s56, s57
    v_add_u32 v9, s56, v9
    s_lshl_b32 s71, s47, 2
    s_add_u32 s71, s71, s46
    s_bfe_u32 s56, s71, 0x10003
    s_lshl_b32 s56, s56, 11
    s_and_b32 s57, s71, 1
    s_lshl_b32 s57, s57, 10
    s_add_u32 s56, s56, s57
    s_bfe_u32 s57, s71, 0x10002
    s_lshl_b32 s57, s57, 9
    s_add_u32 s56, s56, s57
    s_bfe_u32 s57, s71, 0x10001
    s_lshl_b32 s57, s57, 6
    s_add_u32 s56, s56, s57
    s_bfe_u32 s57, s71, 0x10004
    s_lshl_b32 s57, s57, 8
    s_add_u32 s56, s56, s57
    s_bfe_u32 s57, s71, 0x10005
    s_lshl_b32 s57, s57, 7
    s_add_u32 s56, s56, s57
    s_bfe_u32 s57, s71, 0x10006
    s_lshl_b32 s57, s57, 12
    s_add_u32 s56, s56, s57
    v_and_b32 v122, 3, v120
    v_lshlrev_b32 v10, 2, v122
    v_bfe_u32 v122, v120, 3, 1
    v_lshl_add_u32 v10, v122, 4, v10
    v_and_b32 v122, 1, v121
    v_lshl_add_u32 v10, v122, 5, v10
    v_add_u32 v10, s56, v10
    v_and_b32 v123, 36, v1
    v_mov_b32 v122, 0x80000000
    v_cmp_eq_u32 vcc, 0, v123
    s_nop 1
    v_cndmask_b32 v10, v122, v10, vcc
    s_lshl_b32 s56, s46, 15
    v_add_u32 v11, s56, v0
    s_lshl_b32 s71, s71, 11
    s_lshl_b32 s73, s46, 11
    s_mov_b32 s72, 0xffc00000
    s_mov_b32 s74, 0
    v_lshrrev_b32 v13, 3, v1
    v_lshlrev_b32 v13, 9, v13
    v_and_b32 v122, 7, v1
    v_lshl_add_u32 v13, v122, 4, v13
    v_and_b32 v122, 15, v1
    v_and_b32 v123, 1, v1
    v_lshlrev_b32 v123, 4, v123
    v_mov_b32 v124, 0x3f80
    v_lshlrev_b32 v124, v123, v124
    v_lshrrev_b32 v122, 1, v122
    v_cmp_eq_u32 vcc, 0, v122
    s_nop 1
    v_cndmask_b32 v18, 0, v124, vcc
    v_cmp_eq_u32 vcc, 1, v122
    s_nop 1
    v_cndmask_b32 v19, 0, v124, vcc
    v_cmp_eq_u32 vcc, 2, v122
    s_nop 1
    v_cndmask_b32 v20, 0, v124, vcc
    v_cmp_eq_u32 vcc, 3, v122
    s_nop 1
    v_cndmask_b32 v21, 0, v124, vcc
    s_and_b32 s56, s46, 1
    s_lshl_b32 s56, s56, 8
    s_and_b32 s57, s46, 2
    s_lshl_b32 s57, s57, 6
    s_add_u32 s56, s56, s57
    v_add_u32 v13, s56, v13
    s_xor_b32 s56, s46, 0
    s_lshl_b32 s56, s56, 10
    s_add_u32 s56, s56, 147456
    v_add_u32 v14, s56, v0
    s_xor_b32 s56, s46, 1
    s_lshl_b32 s56, s56, 10
    s_add_u32 s56, s56, 147456
    v_add_u32 v15, s56, v0
    s_xor_b32 s56, s46, 2
    s_lshl_b32 s56, s56, 10
    s_add_u32 s56, s56, 147456
    v_add_u32 v16, s56, v0
    s_xor_b32 s56, s46, 3
    s_lshl_b32 s56, s56, 10
    s_add_u32 s56, s56, 147456
    v_add_u32 v17, s56, v0
    v_add_u32 v22, 13647872, v10
    s_lshl_b32 s56, s47, 2
    s_add_u32 s56, s56, 10502272
    v_writelane_b32 v22, s56, 4
    s_mov_b32 s56, 10519808
    v_writelane_b32 v22, s56, 5
    v_add_u32 v1, 131072, v0
    s_mov_b32 s65, 16777216
    s_add_u32 s66, s71, 16777216
    s_add_u32 s69, s71, 17039360
    s_lshl_b32 s79, s47, 2
    s_add_u32 s79, s79, 10486400
    s_cmp_eq_u32 s46, 0
    s_cselect_b32 s79, s79, 0x80000000
    s_cmp_eq_u32 s47, 0
    s_cselect_b32 s31, 17825792, -1
    s_and_b32 s31, s31, 0x8fffffff
    s_mov_b32 s51, 0
L_cst_93:
    s_mov_b32 s60, s51
L_csc_98:
    s_add_u32 s60, s60, 1
    s_add_u32 s61, s51, 3
    s_min_u32 s61, s61, 63
    s_cmp_gt_u32 s60, s61
    s_cbranch_scc1 L_csd_99
    s_lshl_b32 s59, s60, 13
    s_add_u32 s59, s59, 10487040
    v_mov_b32 v120, 0
L_ww_100:
    buffer_load_dword v121, v120, s[8:11], s59 offen sc1
    s_waitcnt vmcnt(0)
    v_readfirstlane_b32 s61, v121
    s_cmp_lg_u32 s61, 0
    s_cbranch_scc1 L_wwd_101
    s_sleep 1
    s_sub_u32 s49, s49, 1
    s_cmp_gt_i32 s49, 0
    s_cbranch_scc1 L_ww_100
    s_branch L_abort
L_wwd_101:
    s_cmp_eq_u32 s61, 2
    s_cselect_b32 s51, s60, s51
    s_branch L_csc_98
L_csd_99:
    s_lshl_b32 s59, s51, 13
    s_lshl2_add_u32 s59, s47, s59
    s_add_u32 s59, s59, 10486016
    v_mov_b32 v120, 0
L_ww_102:
    buffer_load_dword v121, v120, s[8:11], s59 offen sc1
    s_waitcnt vmcnt(0)
    v_readfirstlane_b32 s61, v121
    s_cmp_lg_u32 s61, 0
    s_cbranch_scc1 L_wwd_103
    s_sleep 1
    s_sub_u32 s49, s49, 1
    s_cmp_gt_i32 s49, 0
    s_cbranch_scc1 L_ww_102
    s_branch L_abort
L_wwd_103:
    s_lshl_b32 s56, s51, 5
    s_add_u32 s56, s56, s47
    s_mul_i32 s56, s56, 24576
    s_add_u32 s56, s56, 201326592
    s_add_u32 s67, s56, s73
    s_add_u32 m0, s73, 131072
    s_add_u32 s57, s67, 8192
    buffer_load_dwordx4 v0, s[8:11], s67 offen sc1 lds
    buffer_load_dwordx4 v0, s[8:11], s67 offen offset:1024 sc1 lds
    s_add_u32 m0, s73, 139264
    s_add_u32 s67, s67, 786432
    buffer_load_dwordx4 v0, s[8:11], s57 offen sc1 lds
    buffer_load_dwordx4 v0, s[8:11], s57 offen offset:1024 sc1 lds
    s_lshl_b32 s75, s51, 13
    s_add_u32 s64, s75, 17825792
    s_add_u32 s70, s64, 4096
    s_lshl_b32 s68, s51, 5
    s_add_u32 s68, s68, s47
    s_lshl_b32 s68, s68, 13
    s_lshl_b32 s56, s46, 10
    s_add_u32 s68, s68, s56
    s_add_u32 s68, s68, 75497472
    s_sub_u32 s67, s67, 50331648
    s_mov_b32 s78, 0x80000000
    s_cmp_eq_u32 s51, 63
    s_cselect_b32 s76, 1, 0
    s_waitcnt vmcnt(0)
    s_barrier
    ds_read_b128 v[56:59], v1 offset:0
    ds_read_b128 v[60:63], v1 offset:4096
    ds_read_b128 v[64:67], v1 offset:1024
    ds_read_b128 v[68:71], v1 offset:5120
    ds_read_b128 v[72:75], v1 offset:2048
    ds_read_b128 v[76:79], v1 offset:6144
    ds_read_b128 v[80:83], v1 offset:3072
    ds_read_b128 v[84:87], v1 offset:7168
    v_add_u32 v12, s73, v1
    ds_read_b128 v[88:91], v12 offset:8192
    ds_read_b128 v[92:95], v12 offset:9216
    v_mov_b64 v[96:97], 0
    v_mov_b64 v[98:99], 0
    v_mov_b64 v[100:101], 0
    v_mov_b64 v[102:103], 0
    v_mov_b64 v[104:105], 0
    v_mov_b64 v[106:107], 0
    v_mov_b64 v[108:109], 0
    v_mov_b64 v[110:111], 0
    v_mov_b64 v[112:113], 0
    v_mov_b64 v[114:115], 0
    v_mov_b64 v[116:117], 0
    v_mov_b64 v[118:119], 0
    buffer_load_dwordx4 v[24:27], v13, s[8:11], s64 offen sc1
L_chain_104:
L_cpa_105:
    buffer_load_dwordx4 v[24:27], v13, s[8:11], s64 offen sc1
    s_sub_u32 s49, s49, 1
    s_cbranch_scc1 L_abort
    s_waitcnt vmcnt(1)
    v_max3_u32 v12, v24, v25, v26
    v_max_u32 v12, v27, v12
    v_cmp_le_u32 vcc, s72, v12
    s_cbranch_vccnz L_cpa_105
L_cgo_108:
    ds_write_b128 v14, v[24:27] offset:0
    buffer_load_dwordx4 v[40:43], v13, s[8:11], s70 offen sc1
    v_smfmac_f32_16x16x64_bf16 v[96:99], v[24:27], a[0:7], v2
    s_add_u32 m0, s73, 131072
    v_smfmac_f32_16x16x64_bf16 v[100:103], v[24:27], a[128:135], v2
    s_add_u32 s57, s67, 8192
    v_smfmac_f32_16x16x64_bf16 v[104:107], v[24:27], a[8:15], v2
    v_smfmac_f32_16x16x64_bf16 v[108:111], v[24:27], a[136:143], v2
    s_waitcnt lgkmcnt(0)
    s_barrier
    ds_read_b128 v[28:31], v15 offset:0
    ds_read_b128 v[32:35], v16 offset:0
    ds_read_b128 v[36:39], v17 offset:0
    v_smfmac_f32_16x16x64_bf16 v[112:115], v[24:27], v[128:135], v2
    v_smfmac_f32_16x16x64_bf16 v[116:119], v[24:27], v[136:143], v2
    s_waitcnt lgkmcnt(2)
    v_smfmac_f32_16x16x64_bf16 v[96:99], v[28:31], a[16:23], v2
    s_lshl_b32 s56, s46, 10
    v_smfmac_f32_16x16x64_bf16 v[100:103], v[28:31], a[144:151], v2
    v_smfmac_f32_16x16x64_bf16 v[104:107], v[28:31], a[24:31], v2
    v_smfmac_f32_16x16x64_bf16 v[108:111], v[28:31], a[152:159], v2
    s_waitcnt lgkmcnt(1) vmcnt(0)
    v_smfmac_f32_16x16x64_bf16 v[96:99], v[32:35], a[32:39], v2
    v_max3_u32 v12, v40, v41, v42
    v_smfmac_f32_16x16x64_bf16 v[100:103], v[32:35], a[160:167], v2
    v_max_u32 v12, v43, v12
    v_smfmac_f32_16x16x64_bf16 v[104:107], v[32:35], a[40:47], v2
    v_cmp_le_u32 vcc, s72, v12
    v_smfmac_f32_16x16x64_bf16 v[108:111], v[32:35], a[168:175], v2
    s_cbranch_vccnz L_cpb_111
L_cback_113:
    s_waitcnt lgkmcnt(0)
    ds_write_b128 v14, v[40:43] offset:4096
    v_smfmac_f32_16x16x64_bf16 v[96:99], v[36:39], a[48:55], v2
    v_mov_b64 v[120:121], -1
    v_smfmac_f32_16x16x64_bf16 v[100:103], v[36:39], a[176:183], v2
    v_mov_b64 v[122:123], -1
    v_smfmac_f32_16x16x64_bf16 v[104:107], v[36:39], a[56:63], v2
    v_add_u32 v124, s56, v5
    v_smfmac_f32_16x16x64_bf16 v[108:111], v[36:39], a[184:191], v2
    v_add_u32 v126, s56, v6
    s_waitcnt lgkmcnt(0)
    s_barrier
    v_smfmac_f32_16x16x64_bf16 v[96:99], v[40:43], a[64:71], v2
    ds_read_b128 v[44:47], v15 offset:4096
    v_smfmac_f32_16x16x64_bf16 v[100:103], v[40:43], a[192:199], v2
    ds_read_b128 v[48:51], v16 offset:4096
    v_smfmac_f32_16x16x64_bf16 v[104:107], v[40:43], a[72:79], v2
    ds_read_b128 v[52:55], v17 offset:4096
    v_smfmac_f32_16x16x64_bf16 v[108:111], v[40:43], a[200:207], v2
    s_cmp_eq_u32 s76, 0
    s_cbranch_scc1 L_ckw_94
L_ckb_95:
    s_waitcnt lgkmcnt(2)
    v_smfmac_f32_16x16x64_bf16 v[96:99], v[44:47], a[80:87], v2
    buffer_load_dwordx4 v0, s[8:11], s67 offen sc1 lds
    v_smfmac_f32_16x16x64_bf16 v[100:103], v[44:47], a[208:215], v2
    buffer_load_dwordx4 v0, s[8:11], s67 offen offset:1024 sc1 lds
    v_smfmac_f32_16x16x64_bf16 v[104:107], v[44:47], a[88:95], v2
    s_add_u32 m0, s73, 139264
    v_smfmac_f32_16x16x64_bf16 v[108:111], v[44:47], a[216:223], v2
    s_waitcnt lgkmcnt(1)
    v_smfmac_f32_16x16x64_bf16 v[96:99], v[48:51], a[96:103], v2
    s_add_u32 s67, s67, 786432
    v_smfmac_f32_16x16x64_bf16 v[100:103], v[48:51], a[224:231], v2
    buffer_load_dwordx4 v0, s[8:11], s57 offen sc1 lds
    v_smfmac_f32_16x16x64_bf16 v[104:107], v[48:51], a[104:111], v2
    buffer_load_dwordx4 v0, s[8:11], s57 offen offset:1024 sc1 lds
    v_smfmac_f32_16x16x64_bf16 v[108:111], v[48:51], a[232:239], v2
    s_waitcnt lgkmcnt(0)
    v_smfmac_f32_16x16x64_bf16 v[96:99], v[52:55], a[112:119], v2
    buffer_load_dword v23, v22, s[8:11], s75 offen sc1
    v_smfmac_f32_16x16x64_bf16 v[100:103], v[52:55], a[240:247], v2
    buffer_store_dword v2, off, s[8:11], s78 sc1
    v_smfmac_f32_16x16x64_bf16 v[104:107], v[52:55], a[120:127], v2
    buffer_store_dwordx4 v[120:123], v0, s[8:11], s69 offen
    v_smfmac_f32_16x16x64_bf16 v[108:111], v[52:55], a[248:255], v2
    buffer_store_dwordx4 v[120:123], v0, s[8:11], s69 offen offset:1024
    v_smfmac_f32_16x16x64_bf16 v[112:115], v[28:31], v[144:151], v2
    v_smfmac_f32_16x16x64_bf16 v[116:119], v[28:31], v[152:159], v2
    v_pk_add_f32 v[96:97], v[96:97], v[98:99]
    v_pk_add_f32 v[100:101], v[100:101], v[102:103]
    v_cvt_pk_bf16_f32 v120, v96, v97
    v_cvt_pk_bf16_f32 v121, v100, v101
    v_pk_add_f32 v[104:105], v[104:105], v[106:107]
    v_pk_add_f32 v[108:109], v[108:109], v[110:111]
    v_cvt_pk_bf16_f32 v122, v104, v105
    v_cvt_pk_bf16_f32 v123, v108, v109
    ds_write_b128 v4, v[120:123]
    v_smfmac_f32_16x16x64_bf16 v[112:115], v[32:35], v[160:167], v2
    v_smfmac_f32_16x16x64_bf16 v[116:119], v[32:35], v[168:175], v2
    v_smfmac_f32_16x16x64_bf16 v[112:115], v[36:39], v[176:183], v2
    v_smfmac_f32_16x16x64_bf16 v[116:119], v[36:39], v[184:191], v2
    s_waitcnt lgkmcnt(0)
    s_barrier
    ds_read_b64_tr_b16 v[96:97], v5 offset:0
    ds_read_b64_tr_b16 v[98:99], v6 offset:0
    ds_read_b64_tr_b16 v[100:101], v5 offset:1024
    ds_read_b64_tr_b16 v[102:103], v6 offset:1024
    ds_read_b64_tr_b16 v[104:105], v5 offset:2048
    ds_read_b64_tr_b16 v[106:107], v6 offset:2048
    ds_read_b64_tr_b16 v[108:109], v5 offset:3072
    ds_read_b64_tr_b16 v[110:111], v6 offset:3072
    ds_read_b64_tr_b16 v[124:125], v124
    ds_read_b64_tr_b16 v[126:127], v126
    v_smfmac_f32_16x16x64_bf16 v[112:115], v[40:43], v[192:199], v2
    v_smfmac_f32_16x16x64_bf16 v[116:119], v[40:43], v[200:207], v2
    s_waitcnt lgkmcnt(8)
    v_mfma_f32_16x16x32_bf16 v[24:27], v[56:59], v[96:99], 0
    v_mfma_f32_16x16x32_bf16 v[28:31], v[60:63], v[96:99], 0
    v_mfma_f32_16x16x32_bf16 v[32:35], v[96:99], v[96:99], 0
    s_waitcnt lgkmcnt(6)
    v_mfma_f32_16x16x32_bf16 v[24:27], v[64:67], v[100:103], v[24:27]
    ds_read_b128 v[56:59], v11 offset:0
    v_mfma_f32_16x16x32_bf16 v[28:31], v[68:71], v[100:103], v[28:31]
    ds_read_b128 v[60:63], v11 offset:1024
    v_mfma_f32_16x16x32_bf16 v[32:35], v[100:103], v[100:103], v[32:35]
    s_waitcnt lgkmcnt(6)
    v_mfma_f32_16x16x32_bf16 v[24:27], v[72:75], v[104:107], v[24:27]
    ds_read_b128 v[64:67], v11 offset:2048
    v_mfma_f32_16x16x32_bf16 v[28:31], v[76:79], v[104:107], v[28:31]
    ds_read_b128 v[68:71], v11 offset:3072
    v_mfma_f32_16x16x32_bf16 v[32:35], v[104:107], v[104:107], v[32:35]
    s_waitcnt lgkmcnt(6)
    v_mfma_f32_16x16x32_bf16 v[24:27], v[80:83], v[108:111], v[24:27]
    ds_read_b128 v[72:75], v11 offset:4096
    v_mfma_f32_16x16x32_bf16 v[28:31], v[84:87], v[108:111], v[28:31]
    ds_read_b128 v[76:79], v11 offset:5120
    v_mfma_f32_16x16x32_bf16 v[32:35], v[108:111], v[108:111], v[32:35]
    s_waitcnt lgkmcnt(6)
    v_smfmac_f32_16x16x64_bf16 v[112:115], v[44:47], v[208:215], v2
    buffer_store_dwordx4 v[124:127], v0, s[8:11], s68 offen sc1
    v_smfmac_f32_16x16x64_bf16 v[116:119], v[44:47], v[216:223], v2
    v_smfmac_f32_16x16x64_bf16 v[112:115], v[48:51], v[224:231], v2
    v_smfmac_f32_16x16x64_bf16 v[116:119], v[48:51], v[232:239], v2
    v_smfmac_f32_16x16x64_bf16 v[112:115], v[52:55], v[240:247], v2
    v_smfmac_f32_16x16x64_bf16 v[116:119], v[52:55], v[248:255], v2
    v_mov_b32 v125, 0
    v_mov_b64 v[52:53], s[28:29]
    v_mov_b64 v[54:55], s[28:29]
    v_max3_f32 v36, v24, v25, v26
    v_max3_f32 v37, v27, v28, v29
    v_max3_f32 v36, v30, v31, v36
    v_max3_f32 v37, v34, v35, v37
    v_max_f32 v36, v36, v37
    v_max_f32 v37, v36, v37
    ds_read_b128 v[80:83], v11 offset:6144
    s_nop 0
    v_permlane16_swap_b32 v36, v37
    v_max_f32 v36, v36, v37
    v_max_f32 v37, v36, v37
    ds_read_b128 v[84:87], v11 offset:7168
    s_nop 0
    v_permlane32_swap_b32 v36, v37
    v_max_f32 v36, v36, v37
    v_mul_f32 v36, s80, v36
    v_fma_f32 v24, v24, s80, -v36
    v_fma_f32 v25, v25, s80, -v36
    v_exp_f32 v24, v24
    v_fma_f32 v26, v26, s80, -v36
    v_exp_f32 v25, v25
    v_fma_f32 v27, v27, s80, -v36
    v_exp_f32 v26, v26
    v_fma_f32 v28, v28, s80, -v36
    v_exp_f32 v27, v27
    v_fma_f32 v29, v29, s80, -v36
    v_exp_f32 v28, v28
    v_fma_f32 v30, v30, s80, -v36
    v_exp_f32 v29, v29
    v_fma_f32 v31, v31, s80, -v36
    v_exp_f32 v30, v30
    v_fma_f32 v34, v34, s80, -v36
    v_exp_f32 v31, v31
    v_fma_f32 v35, v35, s80, -v36
    v_exp_f32 v34, v34
    v_exp_f32 v35, v35
    v_cvt_pk_bf16_f32 v120, v24, v25
    v_cvt_pk_bf16_f32 v121, v26, v27
    v_cvt_pk_bf16_f32 v122, v28, v29
    v_cvt_pk_bf16_f32 v123, v30, v31
    v_cvt_pk_bf16_f32 v124, v34, v35
    s_nop 0
    v_mfma_f32_16x16x32_bf16 v[32:35], v[52:55], v[120:123], 0
    v_pk_add_f32 v[112:113], v[112:113], v[114:115]
    v_pk_add_f32 v[116:117], v[116:117], v[118:119]
    v_mfma_f32_16x16x32_bf16 v[24:27], v[88:91], v[120:123], 0
    v_cvt_pk_bf16_f32 v36, v112, v113
    v_cvt_pk_bf16_f32 v37, v116, v117
    v_mfma_f32_16x16x32_bf16 v[28:31], v[92:95], v[120:123], 0
    v_cvt_pk_bf16_f32 v38, v116, v117
    v_mov_b32 v39, 0
    v_mfma_f32_16x16x16_bf16 v[32:35], v[52:53], v[124:125], v[32:35]
    s_add_u32 s56, s68, 4096
    buffer_store_dwordx2 v[36:37], v0, s[8:11], s56 offen sc1
    v_mfma_f32_16x16x16_bf16 v[24:27], v[36:37], v[124:125], v[24:27]
    ds_read_b128 v[96:99], v11 offset:8192
    v_mfma_f32_16x16x16_bf16 v[28:31], v[38:39], v[124:125], v[28:31]
    ds_read_b128 v[100:103], v11 offset:9216
    v_rcp_f32 v32, v32
    v_mov_b64 v[112:113], 0
    v_mov_b64 v[114:115], 0
    v_pk_mul_f32 v[24:25], v[24:25], v[32:33] op_sel_hi:[1,0]
    v_pk_mul_f32 v[26:27], v[26:27], v[32:33] op_sel_hi:[1,0]
    v_mov_b64 v[116:117], 0
    v_mov_b64 v[118:119], 0
    v_pk_mul_f32 v[28:29], v[28:29], v[32:33] op_sel_hi:[1,0]
    v_pk_mul_f32 v[30:31], v[30:31], v[32:33] op_sel_hi:[1,0]
    v_cvt_pk_bf16_f32 v120, v24, v28
    v_cvt_pk_bf16_f32 v121, v25, v29
    v_cvt_pk_bf16_f32 v122, v26, v30
    v_cvt_pk_bf16_f32 v123, v27, v31
    ds_write_b128 v7, v[120:123]
    ds_read_b128 v[104:107], v11 offset:10240
    ds_read_b128 v[108:111], v11 offset:11264
    ds_read_b128 v[40:43], v11 offset:12288
    ds_read_b128 v[44:47], v11 offset:13312
    s_waitcnt lgkmcnt(4)
    s_barrier
    ds_read_b128 v[24:27], v8 offset:0
    ds_read_b128 v[28:31], v8 offset:512
    ds_read_b128 v[32:35], v8 offset:1024
    ds_read_b128 v[36:39], v8 offset:1536
    ds_read_b128 v[48:51], v11 offset:14336
    ds_read_b128 v[52:55], v11 offset:15360
    v_mov_b64 v[88:89], 0
    v_mov_b64 v[90:91], 0
    v_mov_b64 v[92:93], 0
    v_mov_b64 v[94:95], 0
    s_waitcnt lgkmcnt(5)
    v_smfmac_f32_16x16x64_bf16 v[112:115], v[24:27], v[56:63], v3
    ds_read_b128 v[56:59], v11 offset:16384
    ds_read_b128 v[60:63], v11 offset:17408
    s_waitcnt lgkmcnt(6)
    v_smfmac_f32_16x16x64_bf16 v[112:115], v[28:31], v[64:71], v3
    ds_read_b128 v[64:67], v11 offset:18432
    ds_read_b128 v[68:71], v11 offset:19456
    s_waitcnt lgkmcnt(7)
    v_smfmac_f32_16x16x64_bf16 v[112:115], v[32:35], v[72:79], v3
    ds_read_b128 v[72:75], v11 offset:20480
    ds_read_b128 v[76:79], v11 offset:21504
    s_waitcnt lgkmcnt(8)
    v_smfmac_f32_16x16x64_bf16 v[112:115], v[36:39], v[80:87], v3
    ds_read_b128 v[80:83], v11 offset:22528
    ds_read_b128 v[84:87], v11 offset:23552
    s_waitcnt lgkmcnt(8)
    v_smfmac_f32_16x16x64_bf16 v[116:119], v[24:27], v[96:103], v3
    ds_read_b128 v[96:99], v11 offset:24576
    ds_read_b128 v[100:103], v11 offset:25600
    v_smfmac_f32_16x16x64_bf16 v[116:119], v[28:31], v[104:111], v3
    v_cvt_pk_bf16_f32 v112, v112, v113
    v_cvt_pk_bf16_f32 v113, v114, v115
    buffer_store_dwordx2 v[112:113], v9, s[8:11], s65 offen
    ds_read_b128 v[104:107], v11 offset:26624
    ds_read_b128 v[108:111], v11 offset:27648
    v_smfmac_f32_16x16x64_bf16 v[116:119], v[32:35], v[40:47], v3
    ds_read_b128 v[40:43], v11 offset:28672
    ds_read_b128 v[44:47], v11 offset:29696
    v_smfmac_f32_16x16x64_bf16 v[116:119], v[36:39], v[48:55], v3
    s_waitcnt lgkmcnt(12)
    ds_read_b128 v[48:51], v11 offset:30720
    ds_read_b128 v[52:55], v11 offset:31744
    s_waitcnt lgkmcnt(14)
    v_smfmac_f32_16x16x64_bf16 v[88:91], v[24:27], v[56:63], v3
    s_nop 2
    v_cvt_pk_bf16_f32 v116, v116, v117
    v_cvt_pk_bf16_f32 v117, v118, v119
    s_add_u32 s56, s65, 65536
    buffer_store_dwordx2 v[116:117], v9, s[8:11], s56 offen
    s_waitcnt lgkmcnt(12)
    v_smfmac_f32_16x16x64_bf16 v[88:91], v[28:31], v[64:71], v3
    s_waitcnt lgkmcnt(10)
    v_smfmac_f32_16x16x64_bf16 v[88:91], v[32:35], v[72:79], v3
    s_waitcnt lgkmcnt(8)
    v_smfmac_f32_16x16x64_bf16 v[88:91], v[36:39], v[80:87], v3
    s_waitcnt lgkmcnt(6)
    v_smfmac_f32_16x16x64_bf16 v[92:95], v[24:27], v[96:103], v3
    s_waitcnt lgkmcnt(4)
    v_smfmac_f32_16x16x64_bf16 v[92:95], v[28:31], v[104:111], v3
    v_cvt_pk_bf16_f32 v88, v88, v89
    v_cvt_pk_bf16_f32 v89, v90, v91
    s_add_u32 s56, s65, 131072
    buffer_store_dwordx2 v[88:89], v9, s[8:11], s56 offen
    s_waitcnt lgkmcnt(2)
    v_smfmac_f32_16x16x64_bf16 v[92:95], v[32:35], v[40:47], v3
    s_waitcnt lgkmcnt(0)
    v_smfmac_f32_16x16x64_bf16 v[92:95], v[36:39], v[48:55], v3
    s_add_u32 s78, s79, s75
    s_add_u32 s75, s75, 8192
    s_add_u32 s64, s75, 13631488
    s_add_u32 s70, s64, 4096
    s_add_u32 s68, s68, 262144
    s_add_u32 s51, s51, 1
    s_nop 1
    v_cvt_pk_bf16_f32 v92, v92, v93
    v_cvt_pk_bf16_f32 v93, v94, v95
    s_add_u32 s56, s65, 196608
    buffer_store_dwordx2 v[92:93], v9, s[8:11], s56 offen
    s_xor_b32 s65, s65, 262144
    s_cmp_eq_u32 s51, 64
    s_cbranch_scc1 L_cend_107
    s_cmp_lt_u32 s47, 16
    s_waitcnt vmcnt(2)
    s_cbranch_scc1 L_cea_114
    s_barrier
    ds_read_b128 v[56:59], v1 offset:0
    ds_read_b128 v[60:63], v1 offset:4096
    ds_read_b128 v[64:67], v1 offset:1024
    ds_read_b128 v[68:71], v1 offset:5120
    ds_read_b128 v[72:75], v1 offset:2048
    ds_read_b128 v[76:79], v1 offset:6144
    ds_read_b128 v[80:83], v1 offset:3072
    ds_read_b128 v[84:87], v1 offset:7168
    v_add_u32 v12, s73, v1
    ds_read_b128 v[88:91], v12 offset:8192
    ds_read_b128 v[92:95], v12 offset:9216
    v_mov_b64 v[96:97], 0
    v_mov_b64 v[98:99], 0
    v_mov_b64 v[100:101], 0
    v_mov_b64 v[102:103], 0
    v_mov_b64 v[104:105], 0
    v_mov_b64 v[106:107], 0
    v_mov_b64 v[108:109], 0
    v_mov_b64 v[110:111], 0
    v_mov_b64 v[112:113], 0
    v_mov_b64 v[114:115], 0
    v_mov_b64 v[116:117], 0
    v_mov_b64 v[118:119], 0
    v_readlane_b32 s76, v23, 4
    s_cmp_ge_u32 s51, 63
    s_cselect_b32 s76, 1, s76
    v_readlane_b32 s77, v23, 5
    s_cmp_gt_u32 s51, 60
    s_cselect_b32 s77, 1, s77
    s_waitcnt vmcnt(0)
L_crp_109:
    buffer_load_dwordx4 v[120:123], v0, s[8:11], s66 offen offset:0 sc1
    buffer_load_dwordx4 v[124:127], v0, s[8:11], s66 offen offset:1024 sc1
    s_sub_u32 s49, s49, 1
    s_cbranch_scc1 L_abort
    s_waitcnt vmcnt(1)
    v_mfma_f32_16x16x32_bf16 v[28:31], v[18:21], v[120:123], 0
    s_waitcnt vmcnt(0)
    v_mfma_f32_16x16x32_bf16 v[28:31], v[18:21], v[124:127], v[28:31]
    s_nop 7
    v_cmp_u_f32 vcc, v28, v28
    v_add_f32_dpp v32, v28, v28 row_ror:8 row_mask:0xf bank_mask:0x3
    v_add_f32_dpp v33, v29, v29 row_ror:8 row_mask:0xf bank_mask:0x3
    v_add_f32_dpp v32, v30, v30 row_ror:8 row_mask:0xf bank_mask:0xc
    v_add_f32_dpp v33, v31, v31 row_ror:8 row_mask:0xf bank_mask:0xc
    s_nop 0
    v_add_f32_dpp v32, v32, v32 row_shl:4 row_mask:0xf bank_mask:0x5
    v_add_f32_dpp v33, v33, v33 row_shl:4 row_mask:0xf bank_mask:0x5
    s_cbranch_vccnz L_crp_109
    v_cvt_pk_bf16_f32 v34, v32, v33
    buffer_store_dword v34, v10, s[8:11], s64 offen
    s_mov_b32 s69, s66
    s_xor_b32 s66, s66, 262144
    buffer_load_dwordx4 v[24:27], v13, s[8:11], s64 offen sc1
    s_cmp_lg_u32 s77, 1
    s_cbranch_scc1 L_cjw_96
    s_branch L_chain_104
L_cea_114:
    buffer_load_dwordx4 v[120:123], v0, s[8:11], s66 offen offset:0 sc1
    buffer_load_dwordx4 v[124:127], v0, s[8:11], s66 offen offset:1024 sc1
    v_mov_b64 v[96:97], 0
    v_mov_b64 v[98:99], 0
    v_mov_b64 v[100:101], 0
    v_mov_b64 v[102:103], 0
    v_mov_b64 v[104:105], 0
    v_mov_b64 v[106:107], 0
    v_mov_b64 v[108:109], 0
    v_mov_b64 v[110:111], 0
    v_mov_b64 v[112:113], 0
    v_mov_b64 v[114:115], 0
    v_mov_b64 v[116:117], 0
    v_mov_b64 v[118:119], 0
    v_readlane_b32 s76, v23, 4
    s_cmp_ge_u32 s51, 63
    s_cselect_b32 s76, 1, s76
    v_readlane_b32 s77, v23, 5
    s_cmp_gt_u32 s51, 60
    s_cselect_b32 s77, 1, s77
    s_branch L_cr1_115
L_crb_110:
    buffer_load_dwordx4 v[120:123], v0, s[8:11], s66 offen offset:0 sc1
    buffer_load_dwordx4 v[124:127], v0, s[8:11], s66 offen offset:1024 sc1
L_cr1_115:
    s_sub_u32 s49, s49, 1
    s_cbranch_scc1 L_abort
    s_waitcnt vmcnt(1)
    v_mfma_f32_16x16x32_bf16 v[28:31], v[18:21], v[120:123], 0
    s_waitcnt vmcnt(0)
    v_mfma_f32_16x16x32_bf16 v[28:31], v[18:21], v[124:127], v[28:31]
    s_nop 7
    v_cmp_u_f32 vcc, v28, v28
    v_add_f32_dpp v32, v28, v28 row_ror:8 row_mask:0xf bank_mask:0x3
    v_add_f32_dpp v33, v29, v29 row_ror:8 row_mask:0xf bank_mask:0x3
    v_add_f32_dpp v32, v30, v30 row_ror:8 row_mask:0xf bank_mask:0xc
    v_add_f32_dpp v33, v31, v31 row_ror:8 row_mask:0xf bank_mask:0xc
    s_nop 0
    v_add_f32_dpp v32, v32, v32 row_shl:4 row_mask:0xf bank_mask:0x5
    v_add_f32_dpp v33, v33, v33 row_shl:4 row_mask:0xf bank_mask:0x5
    s_cbranch_vccnz L_crb_110
    v_cvt_pk_bf16_f32 v34, v32, v33
    buffer_store_dword v34, v10, s[8:11], s64 offen
    s_mov_b32 s69, s66
    s_xor_b32 s66, s66, 262144
    s_barrier
    ds_read_b128 v[56:59], v1 offset:0
    ds_read_b128 v[60:63], v1 offset:4096
    ds_read_b128 v[64:67], v1 offset:1024
    ds_read_b128 v[68:71], v1 offset:5120
    buffer_load_dwordx4 v[24:27], v13, s[8:11], s64 offen sc1
    ds_read_b128 v[72:75], v1 offset:2048
    ds_read_b128 v[76:79], v1 offset:6144
    ds_read_b128 v[80:83], v1 offset:3072
    ds_read_b128 v[84:87], v1 offset:7168
    v_add_u32 v12, s73, v1
    ds_read_b128 v[88:91], v12 offset:8192
    ds_read_b128 v[92:95], v12 offset:9216
    s_cmp_lg_u32 s77, 1
    s_cbranch_scc1 L_cjw_96
    s_branch L_chain_104
L_ckw_94:
    s_lshl2_add_u32 s59, s47, s75
    s_add_u32 s59, s59, 10494080
L_ckl_116:
    buffer_load_dword v23, off, s[8:11], s59 sc1
    s_waitcnt vmcnt(0)
    v_readfirstlane_b32 s76, v23
    s_cmp_lg_u32 s76, 0
    s_cbranch_scc1 L_ckb_95
    s_sub_u32 s49, s49, 1
    s_cmp_gt_i32 s49, 0
    s_cbranch_scc1 L_ckl_116
    s_branch L_abort
L_cjw_96:
    s_add_u32 s59, s75, 10511616
    v_mov_b32 v120, 0
L_ww_117:
    buffer_load_dword v121, v120, s[8:11], s59 offen sc1
    s_waitcnt vmcnt(0)
    v_readfirstlane_b32 s77, v121
    s_cmp_lg_u32 s77, 0
    s_cbranch_scc1 L_wwd_118
    s_sleep 1
    s_sub_u32 s49, s49, 1
    s_cmp_gt_i32 s49, 0
    s_cbranch_scc1 L_ww_117
    s_branch L_abort
L_wwd_118:
    s_cmp_eq_u32 s77, 1
    s_cbranch_scc1 L_chain_104
L_cjump_97:
    buffer_load_dwordx4 v[24:27], v13, s[8:11], s64 offen sc1
    buffer_load_dwordx4 v[40:43], v13, s[8:11], s70 offen sc1
    s_sub_u32 s49, s49, 1
    s_cbranch_scc1 L_abort
    s_waitcnt vmcnt(0)
    v_max3_u32 v12, v24, v25, v26
    v_max_u32 v12, v27, v12
    v_max3_u32 v12, v40, v41, v12
    v_max3_u32 v12, v42, v43, v12
    v_cmp_le_u32 vcc, s72, v12
    s_cbranch_vccnz L_cjump_97
    s_waitcnt lgkmcnt(0)
    s_barrier
    s_add_u32 s51, s51, 3
    s_branch L_cst_93
L_cpb_111:
    buffer_load_dwordx4 v[40:43], v13, s[8:11], s70 offen sc1
    s_waitcnt vmcnt(0)
    v_max3_u32 v12, v40, v41, v42
    v_max_u32 v12, v43, v12
    v_cmp_le_u32 vcc, s72, v12
    s_cbranch_vccz L_cback_113
    s_sub_u32 s49, s49, 1
    s_cmp_gt_i32 s49, 0
    s_cbranch_scc1 L_cpb_111
    s_branch L_abort
L_cend_107:
    s_waitcnt vmcnt(0)
    s_barrier
    buffer_store_dword v2, off, s[8:11], s78 sc1
    s_nop 11
    v_lshrrev_b32 v1, 4, v0
    s_endpgm
.section .rodata,"a"
.p2align 6
.amdhsa_kernel interleave_layers__memory_aug_recurrent_mem_tr__moe_arch_mod__prompt_kernel
  .amdhsa_next_free_vgpr 512
  .amdhsa_next_free_sgpr 102
  .amdhsa_accum_offset 256
  .amdhsa_group_segment_fixed_size 0
  .amdhsa_kernarg_size 120
  .amdhsa_user_sgpr_count 2
  .amdhsa_user_sgpr_kernarg_segment_ptr 1
  .amdhsa_system_sgpr_workgroup_id_x 1
  .amdhsa_float_denorm_mode_32 3
.end_amdhsa_kernel
```

```asm
; @launch grid=(256,1,1) block=(256,1,1) lds=163840
.amdgcn_target "amdgcn-amd-amdhsa--gfx950"
.text
.globl interleave_layers__memory_aug_recurrent_mem_tr__moe_arch_mod__prompt_kernel
.p2align 8
.type interleave_layers__memory_aug_recurrent_mem_tr__moe_arch_mod__prompt_kernel,@function
interleave_layers__memory_aug_recurrent_mem_tr__moe_arch_mod__prompt_kernel:
s_cmp_ge_u32 s2,256
s_cbranch_scc1 L_abort
s_load_dwordx16 s[16:31],s[0:1],0
s_load_dwordx8 s[32:39],s[0:1],64
s_load_dwordx4 s[40:43],s[0:1],96
s_load_dwordx2 s[44:45],s[0:1],112
v_lshrrev_b32 v2,6,v0
v_and_b32 v1,63,v0
v_readfirstlane_b32 s46,v2
v_lshlrev_b32 v0,4,v1
s_getreg_b32 s48,hwreg(HW_REG_XCC_ID)
s_and_b32 s48,s48,7
s_lshl_b32 s48,s48,2
s_lshr_b32 s48,1399931488,s48
s_and_b32 s48,s48,7
s_mov_b32 s49,100000
s_mov_b32 s80,0x3e0293ee
s_waitcnt lgkmcnt(0)
s_mov_b32 s8,s44
s_mov_b32 s9,s45
s_mov_b32 s10,268435456
s_mov_b32 s11,0x20000
s_mov_b32 s12,s42
s_mov_b32 s13,s43
s_mov_b32 s14,256
s_mov_b32 s15,0x20000
s_cmp_lg_u32 s46,0
s_cbranch_scc1 L_tk_1
s_lshl_b32 s56,s48,2
v_mov_b32 v2,s56
v_mov_b32 v3,1
s_mov_b64 exec,1
buffer_atomic_add v3,v2,s[12:15],0 offen sc0
s_waitcnt vmcnt(0)
v_mov_b32 v4,159744
ds_write_b32 v4,v3
s_mov_b64 exec,-1
s_waitcnt lgkmcnt(0)
L_tk_1:
s_barrier
v_mov_b32 v4,159744
ds_read_b32 v3,v4
s_waitcnt lgkmcnt(0)
v_readfirstlane_b32 s47,v3
s_mov_b32 s3,0
s_cmp_ge_u32 s47,32
s_cselect_b32 s53,0x10001,1
s_and_b32 s47,s47,31
s_lshl_b32 s50,s46,10
s_cmp_eq_u32 s46,0
s_cselect_b32 s52,0,0x80000000
s_mov_b32 s28,0x3f803f80
s_mov_b32 s29,0x3f803f80
s_mov_b32 s51,0
s_lshl_b32 s56,s2,12
s_lshl_b32 s57,s46,10
s_add_u32 s56,s56,s57
v_add_u32 v2,s56,v0
v_mov_b32 v4,-1
v_mov_b32 v5,-1
v_mov_b32 v6,-1
v_mov_b32 v7,-1
v_mov_b32 v8,0
v_mov_b32 v9,0
v_mov_b32 v10,0
v_mov_b32 v11,0
v_cmp_gt_u32 vcc,524288,v2
v_mov_b32 v3,14155776
v_mov_b32 v12,11542528
v_cndmask_b32 v3,v3,v12,vcc
v_add_u32 v3,v3,v2
s_mov_b32 s56,0
buffer_store_dwordx4 v[4:7],v3,s[8:11],s56 offen sc1
s_mov_b32 s56,1048576
buffer_store_dwordx4 v[4:7],v3,s[8:11],s56 offen sc1
s_mov_b32 s56,2097152
buffer_store_dwordx4 v[4:7],v3,s[8:11],s56 offen sc1
s_mov_b32 s56,4194304
buffer_store_dwordx4 v[4:7],v2,s[8:11],s56 offen sc1
s_mov_b32 s56,5242880
buffer_store_dwordx4 v[4:7],v2,s[8:11],s56 offen sc1
v_add_u32 v3,17309696,v2
v_mov_b32 v12,0x80000000
v_cndmask_b32 v3,v3,v12,vcc
buffer_store_dwordx4 v[4:7],v3,s[8:11],0 offen sc1
v_cmp_gt_u32 vcc,147456,v2
v_lshrrev_b32 v3,11,v2
v_lshlrev_b32 v3,13,v3
v_and_b32 v13,0x7ff,v2
v_add_u32 v3,v3,v13
v_add_u32 v3,10485760,v3
v_cndmask_b32 v3,v12,v3,vcc
buffer_store_dwordx4 v[8:11],v3,s[8:11],0 offen sc1
s_mov_b32 s4,s16
s_mov_b32 s5,s17
s_mov_b32 s6,2097152
s_mov_b32 s7,0x20000
s_lshl_b32 s56,s2,3
s_lshl_b32 s57,s46,1
s_add_u32 s56,s56,s57
s_lshl_b32 s57,s56,10
buffer_load_dwordx4 v[24:27],v0,s[4:7],s57 offen
buffer_load_dwordx4 v[28:31],v0,s[4:7],s57 offen offset:1024
s_waitcnt vmcnt(0)
v_lshlrev_b32 v32,16,v24
v_and_b32 v33,0xffff0000,v24
v_lshlrev_b32 v34,16,v25
v_and_b32 v35,0xffff0000,v25
v_lshlrev_b32 v36,16,v26
v_and_b32 v37,0xffff0000,v26
v_lshlrev_b32 v38,16,v27
v_and_b32 v39,0xffff0000,v27
v_readfirstlane_b32 s78,v32
s_nop 1
v_pk_add_f32 v[48:49],v[32:33],s[78:79] op_sel_hi:[1,0] neg_lo:[0,1] neg_hi:[0,1]
v_pk_add_f32 v[50:51],v[34:35],s[78:79] op_sel_hi:[1,0] neg_lo:[0,1] neg_hi:[0,1]
v_pk_add_f32 v[52:53],v[36:37],s[78:79] op_sel_hi:[1,0] neg_lo:[0,1] neg_hi:[0,1]
v_pk_add_f32 v[54:55],v[38:39],s[78:79] op_sel_hi:[1,0] neg_lo:[0,1] neg_hi:[0,1]
v_pk_add_f32 v[56:57],v[48:49],v[50:51]
v_pk_mul_f32 v[58:59],v[48:49],v[48:49]
v_pk_add_f32 v[60:61],v[52:53],v[54:55]
v_pk_fma_f32 v[58:59],v[50:51],v[50:51],v[58:59]
v_pk_add_f32 v[56:57],v[56:57],v[60:61]
v_pk_fma_f32 v[58:59],v[52:53],v[52:53],v[58:59]
v_add_f32 v56,v56,v57
v_pk_fma_f32 v[58:59],v[54:55],v[54:55],v[58:59]
v_add_f32 v58,v58,v59
s_nop 1
v_permlane32_swap_b32 v56,v58
v_add_f32 v56,v56,v58
s_nop 1
v_add_f32_dpp v56,v56,v56 row_ror:8 row_mask:0xf bank_mask:0xf
s_nop 1
v_add_f32_dpp v56,v56,v56 row_ror:4 row_mask:0xf bank_mask:0xf
s_nop 1
v_add_f32_dpp v56,v56,v56 row_ror:2 row_mask:0xf bank_mask:0xf
s_nop 1
v_add_f32_dpp v56,v56,v56 row_ror:1 row_mask:0xf bank_mask:0xf
v_mov_b32 v58,v56
s_nop 1
v_permlane16_swap_b32 v56,v58
v_add_f32 v56,v56,v58
v_mul_f32 v56,0x3b000000,v56
v_mov_b32 v58,v56
s_nop 1
v_permlane32_swap_b32 v56,v58
v_fma_f32 v58,-v56,v56,v58
v_add_f32 v56,s78,v56
v_max_f32 v58,0,v58
v_cvt_pk_bf16_f32 v58,v56,v58
v_lshlrev_b32 v56,16,v58
v_and_b32 v58,0xffff0000,v58
v_add_f32 v58,0x3727c5ac,v58
v_cvt_pk_bf16_f32 v58,v58,v58
v_and_b32 v58,0xffff0000,v58
v_sqrt_f32 v58,v58
v_pk_add_f32 v[48:49],v[32:33],v[56:57] op_sel_hi:[1,0] neg_lo:[0,1] neg_hi:[0,1]
v_pk_add_f32 v[50:51],v[34:35],v[56:57] op_sel_hi:[1,0] neg_lo:[0,1] neg_hi:[0,1]
v_pk_add_f32 v[52:53],v[36:37],v[56:57] op_sel_hi:[1,0] neg_lo:[0,1] neg_hi:[0,1]
v_pk_add_f32 v[54:55],v[38:39],v[56:57] op_sel_hi:[1,0] neg_lo:[0,1] neg_hi:[0,1]
v_cvt_pk_bf16_f32 v58,v58,v58
v_and_b32 v58,0xffff0000,v58
v_rcp_f32 v58,v58
v_cvt_pk_bf16_f32 v40,v48,v49
v_cvt_pk_bf16_f32 v41,v50,v51
v_cvt_pk_bf16_f32 v42,v52,v53
v_cvt_pk_bf16_f32 v43,v54,v55
v_lshlrev_b32 v48,16,v40
v_and_b32 v49,0xffff0000,v40
v_lshlrev_b32 v50,16,v41
v_and_b32 v51,0xffff0000,v41
v_lshlrev_b32 v52,16,v42
v_and_b32 v53,0xffff0000,v42
v_lshlrev_b32 v54,16,v43
v_and_b32 v55,0xffff0000,v43
v_pk_mul_f32 v[48:49],v[48:49],v[58:59] op_sel_hi:[1,0]
v_pk_mul_f32 v[50:51],v[50:51],v[58:59] op_sel_hi:[1,0]
v_pk_mul_f32 v[52:53],v[52:53],v[58:59] op_sel_hi:[1,0]
v_pk_mul_f32 v[54:55],v[54:55],v[58:59] op_sel_hi:[1,0]
v_cvt_pk_bf16_f32 v40,v48,v49
v_cvt_pk_bf16_f32 v41,v50,v51
v_cvt_pk_bf16_f32 v42,v52,v53
v_cvt_pk_bf16_f32 v43,v54,v55
buffer_store_dwordx4 v[40:43],v0,s[8:11],s57 offen offset:0 sc1
v_lshlrev_b32 v32,16,v28
v_and_b32 v33,0xffff0000,v28
v_lshlrev_b32 v34,16,v29
v_and_b32 v35,0xffff0000,v29
v_lshlrev_b32 v36,16,v30
v_and_b32 v37,0xffff0000,v30
v_lshlrev_b32 v38,16,v31
v_and_b32 v39,0xffff0000,v31
v_readfirstlane_b32 s78,v32
s_nop 1
v_pk_add_f32 v[48:49],v[32:33],s[78:79] op_sel_hi:[1,0] neg_lo:[0,1] neg_hi:[0,1]
v_pk_add_f32 v[50:51],v[34:35],s[78:79] op_sel_hi:[1,0] neg_lo:[0,1] neg_hi:[0,1]
v_pk_add_f32 v[52:53],v[36:37],s[78:79] op_sel_hi:[1,0] neg_lo:[0,1] neg_hi:[0,1]
v_pk_add_f32 v[54:55],v[38:39],s[78:79] op_sel_hi:[1,0] neg_lo:[0,1] neg_hi:[0,1]
v_pk_add_f32 v[56:57],v[48:49],v[50:51]
v_pk_mul_f32 v[58:59],v[48:49],v[48:49]
v_pk_add_f32 v[60:61],v[52:53],v[54:55]
v_pk_fma_f32 v[58:59],v[50:51],v[50:51],v[58:59]
v_pk_add_f32 v[56:57],v[56:57],v[60:61]
v_pk_fma_f32 v[58:59],v[52:53],v[52:53],v[58:59]
v_add_f32 v56,v56,v57
v_pk_fma_f32 v[58:59],v[54:55],v[54:55],v[58:59]
v_add_f32 v58,v58,v59
s_nop 1
v_permlane32_swap_b32 v56,v58
v_add_f32 v56,v56,v58
s_nop 1
v_add_f32_dpp v56,v56,v56 row_ror:8 row_mask:0xf bank_mask:0xf
s_nop 1
v_add_f32_dpp v56,v56,v56 row_ror:4 row_mask:0xf bank_mask:0xf
s_nop 1
v_add_f32_dpp v56,v56,v56 row_ror:2 row_mask:0xf bank_mask:0xf
s_nop 1
v_add_f32_dpp v56,v56,v56 row_ror:1 row_mask:0xf bank_mask:0xf
v_mov_b32 v58,v56
s_nop 1
v_permlane16_swap_b32 v56,v58
v_add_f32 v56,v56,v58
v_mul_f32 v56,0x3b000000,v56
v_mov_b32 v58,v56
s_nop 1
v_permlane32_swap_b32 v56,v58
v_fma_f32 v58,-v56,v56,v58
v_add_f32 v56,s78,v56
v_max_f32 v58,0,v58
v_cvt_pk_bf16_f32 v58,v56,v58
v_lshlrev_b32 v56,16,v58
v_and_b32 v58,0xffff0000,v58
v_add_f32 v58,0x3727c5ac,v58
v_cvt_pk_bf16_f32 v58,v58,v58
v_and_b32 v58,0xffff0000,v58
v_sqrt_f32 v58,v58
v_pk_add_f32 v[48:49],v[32:33],v[56:57] op_sel_hi:[1,0] neg_lo:[0,1] neg_hi:[0,1]
v_pk_add_f32 v[50:51],v[34:35],v[56:57] op_sel_hi:[1,0] neg_lo:[0,1] neg_hi:[0,1]
v_pk_add_f32 v[52:53],v[36:37],v[56:57] op_sel_hi:[1,0] neg_lo:[0,1] neg_hi:[0,1]
v_pk_add_f32 v[54:55],v[38:39],v[56:57] op_sel_hi:[1,0] neg_lo:[0,1] neg_hi:[0,1]
v_cvt_pk_bf16_f32 v58,v58,v58
v_and_b32 v58,0xffff0000,v58
v_rcp_f32 v58,v58
v_cvt_pk_bf16_f32 v44,v48,v49
v_cvt_pk_bf16_f32 v45,v50,v51
v_cvt_pk_bf16_f32 v46,v52,v53
v_cvt_pk_bf16_f32 v47,v54,v55
v_lshlrev_b32 v48,16,v44
v_and_b32 v49,0xffff0000,v44
v_lshlrev_b32 v50,16,v45
v_and_b32 v51,0xffff0000,v45
v_lshlrev_b32 v52,16,v46
v_and_b32 v53,0xffff0000,v46
v_lshlrev_b32 v54,16,v47
v_and_b32 v55,0xffff0000,v47
v_pk_mul_f32 v[48:49],v[48:49],v[58:59] op_sel_hi:[1,0]
v_pk_mul_f32 v[50:51],v[50:51],v[58:59] op_sel_hi:[1,0]
v_pk_mul_f32 v[52:53],v[52:53],v[58:59] op_sel_hi:[1,0]
v_pk_mul_f32 v[54:55],v[54:55],v[58:59] op_sel_hi:[1,0]
v_cvt_pk_bf16_f32 v44,v48,v49
v_cvt_pk_bf16_f32 v45,v50,v51
v_cvt_pk_bf16_f32 v46,v52,v53
v_cvt_pk_bf16_f32 v47,v54,v55
buffer_store_dwordx4 v[44:47],v0,s[8:11],s57 offen offset:1024 sc1
s_mov_b32 s4,s18
s_mov_b32 s5,s19
s_mov_b32 s6,8192
s_mov_b32 s7,0x20000
s_cmp_ge_u32 s2,2
s_cbranch_scc1 L_m0_2
s_lshl_b32 s56,s2,2
s_add_u32 s56,s56,s46
v_bfe_u32 v2,v1,2,2
v_and_b32 v3,1,v1
v_lshl_add_u32 v2,v2,1,v3
v_lshlrev_b32 v2,10,v2
v_lshrrev_b32 v3,4,v1
v_lshl_add_u32 v2,v3,5,v2
v_and_b32 v3,2,v1
v_lshl_add_u32 v2,v3,1,v2
s_lshl_b32 s57,s56,7
buffer_load_dword v32,v2,s[4:7],s57 offen offset:0
buffer_load_dword v33,v2,s[4:7],s57 offen offset:8
buffer_load_dword v34,v2,s[4:7],s57 offen offset:16
buffer_load_dword v35,v2,s[4:7],s57 offen offset:24
v_lshrrev_b32 v2,3,v1
v_lshlrev_b32 v2,9,v2
v_and_b32 v3,7,v1
v_lshl_add_u32 v2,v3,4,v2
s_and_b32 s57,s56,1
s_lshl_b32 s57,s57,8
s_and_b32 s58,s56,2
s_lshl_b32 s58,s58,6
s_add_u32 s57,s57,s58
s_and_b32 s58,s56,4
s_lshl_b32 s58,s58,10
s_add_u32 s57,s57,s58
s_waitcnt vmcnt(0)
s_add_u32 s58,s57,11534336
buffer_store_dwordx4 v[32:35],v2,s[8:11],s58 offen sc1
s_add_u32 s58,s57,12582912
buffer_store_dwordx4 v[32:35],v2,s[8:11],s58 offen sc1
s_add_u32 s58,s57,17825792
buffer_store_dwordx4 v[32:35],v2,s[8:11],s58 offen sc1
L_m0_2:
s_waitcnt vmcnt(0) lgkmcnt(0)
s_barrier
s_cmp_lg_u32 s46,0
s_cbranch_scc1 L_ar_3
v_mov_b32 v124,128
v_mov_b32 v125,s53
s_mov_b64 exec,1
buffer_atomic_add v125,v124,s[12:15],0 offen
s_mov_b64 exec,-1
L_ar_3:
L_roles:
s_cmp_ge_u32 s48,6
s_cbranch_scc1 L_ra_6
v_and_b32 v2,15,v1
v_lshlrev_b32 v2,2,v2
v_lshrrev_b32 v3,4,v1
v_lshl_add_u32 v4,v3,16,v2
v_lshl_add_u32 v5,v3,13,v2
s_lshl_b32 s58,s47,8
s_lshl_b32 s57,s46,6
s_add_u32 s58,s58,s57
s_lshl_b32 s59,s47,17
s_add_u32 s59,s59,s57
s_lshl_b32 s60,s46,15
v_add_u32 v6,s60,v0
s_mov_b32 s61,0x05040100
s_mov_b32 s62,0x07060302
s_lshl_b32 s63,s46,19
s_cmp_lt_u32 s48,3
s_cselect_b32 s63,s63,0
s_mov_b32 s4,s22
s_mov_b32 s5,s23
s_mov_b32 s6,4194304
s_mov_b32 s7,0x20000
s_xor_b32 s56,s63,0
s_add_u32 s56,s56,s58
buffer_load_dword v24,v4,s[4:7],s56 offen
s_add_u32 s56,s56,8192
buffer_load_dword v25,v4,s[4:7],s56 offen
s_add_u32 s56,s56,8192
buffer_load_dword v26,v4,s[4:7],s56 offen
s_add_u32 s56,s56,8192
buffer_load_dword v27,v4,s[4:7],s56 offen
s_add_u32 s56,s56,8192
buffer_load_dword v28,v4,s[4:7],s56 offen
s_add_u32 s56,s56,8192
buffer_load_dword v29,v4,s[4:7],s56 offen
s_add_u32 s56,s56,8192
buffer_load_dword v30,v4,s[4:7],s56 offen
s_add_u32 s56,s56,8192
buffer_load_dword v31,v4,s[4:7],s56 offen
s_xor_b32 s56,s63,262144
s_add_u32 s56,s56,s58
buffer_load_dword v32,v4,s[4:7],s56 offen
s_add_u32 s56,s56,8192
buffer_load_dword v33,v4,s[4:7],s56 offen
s_add_u32 s56,s56,8192
buffer_load_dword v34,v4,s[4:7],s56 offen
s_add_u32 s56,s56,8192
buffer_load_dword v35,v4,s[4:7],s56 offen
s_add_u32 s56,s56,8192
buffer_load_dword v36,v4,s[4:7],s56 offen
s_add_u32 s56,s56,8192
buffer_load_dword v37,v4,s[4:7],s56 offen
s_add_u32 s56,s56,8192
buffer_load_dword v38,v4,s[4:7],s56 offen
s_add_u32 s56,s56,8192
buffer_load_dword v39,v4,s[4:7],s56 offen
s_xor_b32 s56,s63,524288
s_add_u32 s56,s56,s58
buffer_load_dword v40,v4,s[4:7],s56 offen
s_add_u32 s56,s56,8192
buffer_load_dword v41,v4,s[4:7],s56 offen
s_add_u32 s56,s56,8192
buffer_load_dword v42,v4,s[4:7],s56 offen
s_add_u32 s56,s56,8192
buffer_load_dword v43,v4,s[4:7],s56 offen
s_add_u32 s56,s56,8192
buffer_load_dword v44,v4,s[4:7],s56 offen
s_add_u32 s56,s56,8192
buffer_load_dword v45,v4,s[4:7],s56 offen
s_add_u32 s56,s56,8192
buffer_load_dword v46,v4,s[4:7],s56 offen
s_add_u32 s56,s56,8192
buffer_load_dword v47,v4,s[4:7],s56 offen
s_xor_b32 s56,s63,786432
s_add_u32 s56,s56,s58
buffer_load_dword v48,v4,s[4:7],s56 offen
s_add_u32 s56,s56,8192
buffer_load_dword v49,v4,s[4:7],s56 offen
s_add_u32 s56,s56,8192
buffer_load_dword v50,v4,s[4:7],s56 offen
s_add_u32 s56,s56,8192
buffer_load_dword v51,v4,s[4:7],s56 offen
s_add_u32 s56,s56,8192
buffer_load_dword v52,v4,s[4:7],s56 offen
s_add_u32 s56,s56,8192
buffer_load_dword v53,v4,s[4:7],s56 offen
s_add_u32 s56,s56,8192
buffer_load_dword v54,v4,s[4:7],s56 offen
s_add_u32 s56,s56,8192
buffer_load_dword v55,v4,s[4:7],s56 offen
s_xor_b32 s56,s63,1048576
s_add_u32 s56,s56,s58
buffer_load_dword v56,v4,s[4:7],s56 offen
s_add_u32 s56,s56,8192
buffer_load_dword v57,v4,s[4:7],s56 offen
s_add_u32 s56,s56,8192
buffer_load_dword v58,v4,s[4:7],s56 offen
s_add_u32 s56,s56,8192
buffer_load_dword v59,v4,s[4:7],s56 offen
s_add_u32 s56,s56,8192
buffer_load_dword v60,v4,s[4:7],s56 offen
s_add_u32 s56,s56,8192
buffer_load_dword v61,v4,s[4:7],s56 offen
s_add_u32 s56,s56,8192
buffer_load_dword v62,v4,s[4:7],s56 offen
s_add_u32 s56,s56,8192
buffer_load_dword v63,v4,s[4:7],s56 offen
s_xor_b32 s56,s63,1310720
s_add_u32 s56,s56,s58
buffer_load_dword v64,v4,s[4:7],s56 offen
s_add_u32 s56,s56,8192
buffer_load_dword v65,v4,s[4:7],s56 offen
s_add_u32 s56,s56,8192
buffer_load_dword v66,v4,s[4:7],s56 offen
s_add_u32 s56,s56,8192
buffer_load_dword v67,v4,s[4:7],s56 offen
s_add_u32 s56,s56,8192
buffer_load_dword v68,v4,s[4:7],s56 offen
s_add_u32 s56,s56,8192
buffer_load_dword v69,v4,s[4:7],s56 offen
s_add_u32 s56,s56,8192
buffer_load_dword v70,v4,s[4:7],s56 offen
s_add_u32 s56,s56,8192
buffer_load_dword v71,v4,s[4:7],s56 offen
s_xor_b32 s56,s63,1572864
s_add_u32 s56,s56,s58
buffer_load_dword v72,v4,s[4:7],s56 offen
s_add_u32 s56,s56,8192
buffer_load_dword v73,v4,s[4:7],s56 offen
s_add_u32 s56,s56,8192
buffer_load_dword v74,v4,s[4:7],s56 offen
s_add_u32 s56,s56,8192
buffer_load_dword v75,v4,s[4:7],s56 offen
s_add_u32 s56,s56,8192
buffer_load_dword v76,v4,s[4:7],s56 offen
s_add_u32 s56,s56,8192
buffer_load_dword v77,v4,s[4:7],s56 offen
s_add_u32 s56,s56,8192
buffer_load_dword v78,v4,s[4:7],s56 offen
s_add_u32 s56,s56,8192
buffer_load_dword v79,v4,s[4:7],s56 offen
s_waitcnt vmcnt(48)
v_perm_b32 v80,v25,v24,s61
v_perm_b32 v81,v27,v26,s61
v_perm_b32 v82,v29,v28,s61
v_perm_b32 v83,v31,v30,s61
v_perm_b32 v84,v25,v24,s62
v_perm_b32 v85,v27,v26,s62
v_perm_b32 v86,v29,v28,s62
v_perm_b32 v87,v31,v30,s62
v_accvgpr_write_b32 a128,v80
v_accvgpr_write_b32 a129,v81
v_accvgpr_write_b32 a130,v82
v_accvgpr_write_b32 a131,v83
v_accvgpr_write_b32 a136,v84
v_accvgpr_write_b32 a137,v85
v_accvgpr_write_b32 a138,v86
v_accvgpr_write_b32 a139,v87
s_xor_b32 s56,s63,1835008
s_add_u32 s56,s56,s58
buffer_load_dword v24,v4,s[4:7],s56 offen
s_add_u32 s56,s56,8192
buffer_load_dword v25,v4,s[4:7],s56 offen
s_add_u32 s56,s56,8192
buffer_load_dword v26,v4,s[4:7],s56 offen
s_add_u32 s56,s56,8192
buffer_load_dword v27,v4,s[4:7],s56 offen
s_add_u32 s56,s56,8192
buffer_load_dword v28,v4,s[4:7],s56 offen
s_add_u32 s56,s56,8192
buffer_load_dword v29,v4,s[4:7],s56 offen
s_add_u32 s56,s56,8192
buffer_load_dword v30,v4,s[4:7],s56 offen
s_add_u32 s56,s56,8192
buffer_load_dword v31,v4,s[4:7],s56 offen
s_waitcnt vmcnt(48)
v_perm_b32 v80,v33,v32,s61
v_perm_b32 v81,v35,v34,s61
v_perm_b32 v82,v37,v36,s61
v_perm_b32 v83,v39,v38,s61
v_perm_b32 v84,v33,v32,s62
v_perm_b32 v85,v35,v34,s62
v_perm_b32 v86,v37,v36,s62
v_perm_b32 v87,v39,v38,s62
v_accvgpr_write_b32 a132,v80
v_accvgpr_write_b32 a133,v81
v_accvgpr_write_b32 a134,v82
v_accvgpr_write_b32 a135,v83
v_accvgpr_write_b32 a140,v84
v_accvgpr_write_b32 a141,v85
v_accvgpr_write_b32 a142,v86
v_accvgpr_write_b32 a143,v87
s_xor_b32 s56,s63,2097152
s_add_u32 s56,s56,s58
buffer_load_dword v32,v4,s[4:7],s56 offen
s_add_u32 s56,s56,8192
buffer_load_dword v33,v4,s[4:7],s56 offen
s_add_u32 s56,s56,8192
buffer_load_dword v34,v4,s[4:7],s56 offen
s_add_u32 s56,s56,8192
buffer_load_dword v35,v4,s[4:7],s56 offen
s_add_u32 s56,s56,8192
buffer_load_dword v36,v4,s[4:7],s56 offen
s_add_u32 s56,s56,8192
buffer_load_dword v37,v4,s[4:7],s56 offen
s_add_u32 s56,s56,8192
buffer_load_dword v38,v4,s[4:7],s56 offen
s_add_u32 s56,s56,8192
buffer_load_dword v39,v4,s[4:7],s56 offen
s_waitcnt vmcnt(48)
v_perm_b32 v80,v41,v40,s61
v_perm_b32 v81,v43,v42,s61
v_perm_b32 v82,v45,v44,s61
v_perm_b32 v83,v47,v46,s61
v_perm_b32 v84,v41,v40,s62
v_perm_b32 v85,v43,v42,s62
v_perm_b32 v86,v45,v44,s62
v_perm_b32 v87,v47,v46,s62
v_accvgpr_write_b32 a144,v80
v_accvgpr_write_b32 a145,v81
v_accvgpr_write_b32 a146,v82
v_accvgpr_write_b32 a147,v83
v_accvgpr_write_b32 a152,v84
v_accvgpr_write_b32 a153,v85
v_accvgpr_write_b32 a154,v86
v_accvgpr_write_b32 a155,v87
s_xor_b32 s56,s63,2359296
s_add_u32 s56,s56,s58
buffer_load_dword v40,v4,s[4:7],s56 offen
s_add_u32 s56,s56,8192
buffer_load_dword v41,v4,s[4:7],s56 offen
s_add_u32 s56,s56,8192
buffer_load_dword v42,v4,s[4:7],s56 offen
s_add_u32 s56,s56,8192
buffer_load_dword v43,v4,s[4:7],s56 offen
s_add_u32 s56,s56,8192
buffer_load_dword v44,v4,s[4:7],s56 offen
s_add_u32 s56,s56,8192
buffer_load_dword v45,v4,s[4:7],s56 offen
s_add_u32 s56,s56,8192
buffer_load_dword v46,v4,s[4:7],s56 offen
s_add_u32 s56,s56,8192
buffer_load_dword v47,v4,s[4:7],s56 offen
s_waitcnt vmcnt(48)
v_perm_b32 v80,v49,v48,s61
v_perm_b32 v81,v51,v50,s61
v_perm_b32 v82,v53,v52,s61
v_perm_b32 v83,v55,v54,s61
v_perm_b32 v84,v49,v48,s62
v_perm_b32 v85,v51,v50,s62
v_perm_b32 v86,v53,v52,s62
v_perm_b32 v87,v55,v54,s62
v_accvgpr_write_b32 a148,v80
v_accvgpr_write_b32 a149,v81
v_accvgpr_write_b32 a150,v82
v_accvgpr_write_b32 a151,v83
v_accvgpr_write_b32 a156,v84
v_accvgpr_write_b32 a157,v85
v_accvgpr_write_b32 a158,v86
v_accvgpr_write_b32 a159,v87
s_xor_b32 s56,s63,2621440
s_add_u32 s56,s56,s58
buffer_load_dword v48,v4,s[4:7],s56 offen
s_add_u32 s56,s56,8192
buffer_load_dword v49,v4,s[4:7],s56 offen
s_add_u32 s56,s56,8192
buffer_load_dword v50,v4,s[4:7],s56 offen
s_add_u32 s56,s56,8192
buffer_load_dword v51,v4,s[4:7],s56 offen
s_add_u32 s56,s56,8192
buffer_load_dword v52,v4,s[4:7],s56 offen
s_add_u32 s56,s56,8192
buffer_load_dword v53,v4,s[4:7],s56 offen
s_add_u32 s56,s56,8192
buffer_load_dword v54,v4,s[4:7],s56 offen
s_add_u32 s56,s56,8192
buffer_load_dword v55,v4,s[4:7],s56 offen
s_waitcnt vmcnt(48)
v_perm_b32 v80,v57,v56,s61
v_perm_b32 v81,v59,v58,s61
v_perm_b32 v82,v61,v60,s61
v_perm_b32 v83,v63,v62,s61
v_perm_b32 v84,v57,v56,s62
v_perm_b32 v85,v59,v58,s62
v_perm_b32 v86,v61,v60,s62
v_perm_b32 v87,v63,v62,s62
v_accvgpr_write_b32 a160,v80
v_accvgpr_write_b32 a161,v81
v_accvgpr_write_b32 a162,v82
v_accvgpr_write_b32 a163,v83
v_accvgpr_write_b32 a168,v84
v_accvgpr_write_b32 a169,v85
v_accvgpr_write_b32 a170,v86
v_accvgpr_write_b32 a171,v87
s_xor_b32 s56,s63,2883584
s_add_u32 s56,s56,s58
buffer_load_dword v56,v4,s[4:7],s56 offen
s_add_u32 s56,s56,8192
buffer_load_dword v57,v4,s[4:7],s56 offen
s_add_u32 s56,s56,8192
buffer_load_dword v58,v4,s[4:7],s56 offen
s_add_u32 s56,s56,8192
buffer_load_dword v59,v4,s[4:7],s56 offen
s_add_u32 s56,s56,8192
buffer_load_dword v60,v4,s[4:7],s56 offen
s_add_u32 s56,s56,8192
buffer_load_dword v61,v4,s[4:7],s56 offen
s_add_u32 s56,s56,8192
buffer_load_dword v62,v4,s[4:7],s56 offen
s_add_u32 s56,s56,8192
buffer_load_dword v63,v4,s[4:7],s56 offen
s_waitcnt vmcnt(48)
v_perm_b32 v80,v65,v64,s61
v_perm_b32 v81,v67,v66,s61
v_perm_b32 v82,v69,v68,s61
v_perm_b32 v83,v71,v70,s61
v_perm_b32 v84,v65,v64,s62
v_perm_b32 v85,v67,v66,s62
v_perm_b32 v86,v69,v68,s62
v_perm_b32 v87,v71,v70,s62
v_accvgpr_write_b32 a164,v80
v_accvgpr_write_b32 a165,v81
v_accvgpr_write_b32 a166,v82
v_accvgpr_write_b32 a167,v83
v_accvgpr_write_b32 a172,v84
v_accvgpr_write_b32 a173,v85
v_accvgpr_write_b32 a174,v86
v_accvgpr_write_b32 a175,v87
s_xor_b32 s56,s63,3145728
s_add_u32 s56,s56,s58
buffer_load_dword v64,v4,s[4:7],s56 offen
s_add_u32 s56,s56,8192
buffer_load_dword v65,v4,s[4:7],s56 offen
s_add_u32 s56,s56,8192
buffer_load_dword v66,v4,s[4:7],s56 offen
s_add_u32 s56,s56,8192
buffer_load_dword v67,v4,s[4:7],s56 offen
s_add_u32 s56,s56,8192
buffer_load_dword v68,v4,s[4:7],s56 offen
s_add_u32 s56,s56,8192
buffer_load_dword v69,v4,s[4:7],s56 offen
s_add_u32 s56,s56,8192
buffer_load_dword v70,v4,s[4:7],s56 offen
s_add_u32 s56,s56,8192
buffer_load_dword v71,v4,s[4:7],s56 offen
s_waitcnt vmcnt(48)
v_perm_b32 v80,v73,v72,s61
v_perm_b32 v81,v75,v74,s61
v_perm_b32 v82,v77,v76,s61
v_perm_b32 v83,v79,v78,s61
v_perm_b32 v84,v73,v72,s62
v_perm_b32 v85,v75,v74,s62
v_perm_b32 v86,v77,v76,s62
v_perm_b32 v87,v79,v78,s62
v_accvgpr_write_b32 a176,v80
v_accvgpr_write_b32 a177,v81
v_accvgpr_write_b32 a178,v82
v_accvgpr_write_b32 a179,v83
v_accvgpr_write_b32 a184,v84
v_accvgpr_write_b32 a185,v85
v_accvgpr_write_b32 a186,v86
v_accvgpr_write_b32 a187,v87
s_xor_b32 s56,s63,3407872
s_add_u32 s56,s56,s58
buffer_load_dword v72,v4,s[4:7],s56 offen
s_add_u32 s56,s56,8192
buffer_load_dword v73,v4,s[4:7],s56 offen
s_add_u32 s56,s56,8192
buffer_load_dword v74,v4,s[4:7],s56 offen
s_add_u32 s56,s56,8192
buffer_load_dword v75,v4,s[4:7],s56 offen
s_add_u32 s56,s56,8192
buffer_load_dword v76,v4,s[4:7],s56 offen
s_add_u32 s56,s56,8192
buffer_load_dword v77,v4,s[4:7],s56 offen
s_add_u32 s56,s56,8192
buffer_load_dword v78,v4,s[4:7],s56 offen
s_add_u32 s56,s56,8192
buffer_load_dword v79,v4,s[4:7],s56 offen
s_waitcnt vmcnt(48)
v_perm_b32 v80,v25,v24,s61
v_perm_b32 v81,v27,v26,s61
v_perm_b32 v82,v29,v28,s61
v_perm_b32 v83,v31,v30,s61
v_perm_b32 v84,v25,v24,s62
v_perm_b32 v85,v27,v26,s62
v_perm_b32 v86,v29,v28,s62
v_perm_b32 v87,v31,v30,s62
v_accvgpr_write_b32 a180,v80
v_accvgpr_write_b32 a181,v81
v_accvgpr_write_b32 a182,v82
v_accvgpr_write_b32 a183,v83
v_accvgpr_write_b32 a188,v84
v_accvgpr_write_b32 a189,v85
v_accvgpr_write_b32 a190,v86
v_accvgpr_write_b32 a191,v87
s_xor_b32 s56,s63,3670016
s_add_u32 s56,s56,s58
buffer_load_dword v24,v4,s[4:7],s56 offen
s_add_u32 s56,s56,8192
buffer_load_dword v25,v4,s[4:7],s56 offen
s_add_u32 s56,s56,8192
buffer_load_dword v26,v4,s[4:7],s56 offen
s_add_u32 s56,s56,8192
buffer_load_dword v27,v4,s[4:7],s56 offen
s_add_u32 s56,s56,8192
buffer_load_dword v28,v4,s[4:7],s56 offen
s_add_u32 s56,s56,8192
buffer_load_dword v29,v4,s[4:7],s56 offen
s_add_u32 s56,s56,8192
buffer_load_dword v30,v4,s[4:7],s56 offen
s_add_u32 s56,s56,8192
buffer_load_dword v31,v4,s[4:7],s56 offen
s_waitcnt vmcnt(48)
v_perm_b32 v80,v33,v32,s61
v_perm_b32 v81,v35,v34,s61
v_perm_b32 v82,v37,v36,s61
v_perm_b32 v83,v39,v38,s61
v_perm_b32 v84,v33,v32,s62
v_perm_b32 v85,v35,v34,s62
v_perm_b32 v86,v37,v36,s62
v_perm_b32 v87,v39,v38,s62
v_accvgpr_write_b32 a192,v80
v_accvgpr_write_b32 a193,v81
v_accvgpr_write_b32 a194,v82
v_accvgpr_write_b32 a195,v83
v_accvgpr_write_b32 a200,v84
v_accvgpr_write_b32 a201,v85
v_accvgpr_write_b32 a202,v86
v_accvgpr_write_b32 a203,v87
s_xor_b32 s56,s63,3932160
s_add_u32 s56,s56,s58
buffer_load_dword v32,v4,s[4:7],s56 offen
s_add_u32 s56,s56,8192
buffer_load_dword v33,v4,s[4:7],s56 offen
s_add_u32 s56,s56,8192
buffer_load_dword v34,v4,s[4:7],s56 offen
s_add_u32 s56,s56,8192
buffer_load_dword v35,v4,s[4:7],s56 offen
s_add_u32 s56,s56,8192
buffer_load_dword v36,v4,s[4:7],s56 offen
s_add_u32 s56,s56,8192
buffer_load_dword v37,v4,s[4:7],s56 offen
s_add_u32 s56,s56,8192
buffer_load_dword v38,v4,s[4:7],s56 offen
s_add_u32 s56,s56,8192
buffer_load_dword v39,v4,s[4:7],s56 offen
s_waitcnt vmcnt(48)
v_perm_b32 v80,v41,v40,s61
v_perm_b32 v81,v43,v42,s61
v_perm_b32 v82,v45,v44,s61
v_perm_b32 v83,v47,v46,s61
v_perm_b32 v84,v41,v40,s62
v_perm_b32 v85,v43,v42,s62
v_perm_b32 v86,v45,v44,s62
v_perm_b32 v87,v47,v46,s62
v_accvgpr_write_b32 a196,v80
v_accvgpr_write_b32 a197,v81
v_accvgpr_write_b32 a198,v82
v_accvgpr_write_b32 a199,v83
v_accvgpr_write_b32 a204,v84
v_accvgpr_write_b32 a205,v85
v_accvgpr_write_b32 a206,v86
v_accvgpr_write_b32 a207,v87
s_mov_b32 s4,s24
s_mov_b32 s5,s25
s_mov_b32 s6,4194304
s_mov_b32 s7,0x20000
s_xor_b32 s56,s63,0
s_add_u32 s56,s56,s58
buffer_load_dword v40,v4,s[4:7],s56 offen
s_add_u32 s56,s56,8192
buffer_load_dword v41,v4,s[4:7],s56 offen
s_add_u32 s56,s56,8192
buffer_load_dword v42,v4,s[4:7],s56 offen
s_add_u32 s56,s56,8192
buffer_load_dword v43,v4,s[4:7],s56 offen
s_add_u32 s56,s56,8192
buffer_load_dword v44,v4,s[4:7],s56 offen
s_add_u32 s56,s56,8192
buffer_load_dword v45,v4,s[4:7],s56 offen
s_add_u32 s56,s56,8192
buffer_load_dword v46,v4,s[4:7],s56 offen
s_add_u32 s56,s56,8192
buffer_load_dword v47,v4,s[4:7],s56 offen
s_waitcnt vmcnt(48)
v_perm_b32 v80,v49,v48,s61
v_perm_b32 v81,v51,v50,s61
v_perm_b32 v82,v53,v52,s61
v_perm_b32 v83,v55,v54,s61
v_perm_b32 v84,v49,v48,s62
v_perm_b32 v85,v51,v50,s62
v_perm_b32 v86,v53,v52,s62
v_perm_b32 v87,v55,v54,s62
v_accvgpr_write_b32 a208,v80
v_accvgpr_write_b32 a209,v81
v_accvgpr_write_b32 a210,v82
v_accvgpr_write_b32 a211,v83
v_accvgpr_write_b32 a216,v84
v_accvgpr_write_b32 a217,v85
v_accvgpr_write_b32 a218,v86
v_accvgpr_write_b32 a219,v87
s_xor_b32 s56,s63,262144
s_add_u32 s56,s56,s58
buffer_load_dword v48,v4,s[4:7],s56 offen
s_add_u32 s56,s56,8192
buffer_load_dword v49,v4,s[4:7],s56 offen
s_add_u32 s56,s56,8192
buffer_load_dword v50,v4,s[4:7],s56 offen
s_add_u32 s56,s56,8192
buffer_load_dword v51,v4,s[4:7],s56 offen
s_add_u32 s56,s56,8192
buffer_load_dword v52,v4,s[4:7],s56 offen
s_add_u32 s56,s56,8192
buffer_load_dword v53,v4,s[4:7],s56 offen
s_add_u32 s56,s56,8192
buffer_load_dword v54,v4,s[4:7],s56 offen
s_add_u32 s56,s56,8192
buffer_load_dword v55,v4,s[4:7],s56 offen
s_waitcnt vmcnt(48)
v_perm_b32 v80,v57,v56,s61
v_perm_b32 v81,v59,v58,s61
v_perm_b32 v82,v61,v60,s61
v_perm_b32 v83,v63,v62,s61
v_perm_b32 v84,v57,v56,s62
v_perm_b32 v85,v59,v58,s62
v_perm_b32 v86,v61,v60,s62
v_perm_b32 v87,v63,v62,s62
v_accvgpr_write_b32 a212,v80
v_accvgpr_write_b32 a213,v81
v_accvgpr_write_b32 a214,v82
v_accvgpr_write_b32 a215,v83
v_accvgpr_write_b32 a220,v84
v_accvgpr_write_b32 a221,v85
v_accvgpr_write_b32 a222,v86
v_accvgpr_write_b32 a223,v87
s_xor_b32 s56,s63,524288
s_add_u32 s56,s56,s58
buffer_load_dword v56,v4,s[4:7],s56 offen
s_add_u32 s56,s56,8192
buffer_load_dword v57,v4,s[4:7],s56 offen
s_add_u32 s56,s56,8192
buffer_load_dword v58,v4,s[4:7],s56 offen
s_add_u32 s56,s56,8192
buffer_load_dword v59,v4,s[4:7],s56 offen
s_add_u32 s56,s56,8192
buffer_load_dword v60,v4,s[4:7],s56 offen
s_add_u32 s56,s56,8192
buffer_load_dword v61,v4,s[4:7],s56 offen
s_add_u32 s56,s56,8192
buffer_load_dword v62,v4,s[4:7],s56 offen
s_add_u32 s56,s56,8192
buffer_load_dword v63,v4,s[4:7],s56 offen
s_waitcnt vmcnt(48)
v_perm_b32 v80,v65,v64,s61
v_perm_b32 v81,v67,v66,s61
v_perm_b32 v82,v69,v68,s61
v_perm_b32 v83,v71,v70,s61
v_perm_b32 v84,v65,v64,s62
v_perm_b32 v85,v67,v66,s62
v_perm_b32 v86,v69,v68,s62
v_perm_b32 v87,v71,v70,s62
v_accvgpr_write_b32 a224,v80
v_accvgpr_write_b32 a225,v81
v_accvgpr_write_b32 a226,v82
v_accvgpr_write_b32 a227,v83
v_accvgpr_write_b32 a232,v84
v_accvgpr_write_b32 a233,v85
v_accvgpr_write_b32 a234,v86
v_accvgpr_write_b32 a235,v87
s_xor_b32 s56,s63,786432
s_add_u32 s56,s56,s58
buffer_load_dword v64,v4,s[4:7],s56 offen
s_add_u32 s56,s56,8192
buffer_load_dword v65,v4,s[4:7],s56 offen
s_add_u32 s56,s56,8192
buffer_load_dword v66,v4,s[4:7],s56 offen
s_add_u32 s56,s56,8192
buffer_load_dword v67,v4,s[4:7],s56 offen
s_add_u32 s56,s56,8192
buffer_load_dword v68,v4,s[4:7],s56 offen
s_add_u32 s56,s56,8192
buffer_load_dword v69,v4,s[4:7],s56 offen
s_add_u32 s56,s56,8192
buffer_load_dword v70,v4,s[4:7],s56 offen
s_add_u32 s56,s56,8192
buffer_load_dword v71,v4,s[4:7],s56 offen
s_waitcnt vmcnt(48)
v_perm_b32 v80,v73,v72,s61
v_perm_b32 v81,v75,v74,s61
v_perm_b32 v82,v77,v76,s61
v_perm_b32 v83,v79,v78,s61
v_perm_b32 v84,v73,v72,s62
v_perm_b32 v85,v75,v74,s62
v_perm_b32 v86,v77,v76,s62
v_perm_b32 v87,v79,v78,s62
v_accvgpr_write_b32 a228,v80
v_accvgpr_write_b32 a229,v81
v_accvgpr_write_b32 a230,v82
v_accvgpr_write_b32 a231,v83
v_accvgpr_write_b32 a236,v84
v_accvgpr_write_b32 a237,v85
v_accvgpr_write_b32 a238,v86
v_accvgpr_write_b32 a239,v87
s_xor_b32 s56,s63,1048576
s_add_u32 s56,s56,s58
buffer_load_dword v72,v4,s[4:7],s56 offen
s_add_u32 s56,s56,8192
buffer_load_dword v73,v4,s[4:7],s56 offen
s_add_u32 s56,s56,8192
buffer_load_dword v74,v4,s[4:7],s56 offen
s_add_u32 s56,s56,8192
buffer_load_dword v75,v4,s[4:7],s56 offen
s_add_u32 s56,s56,8192
buffer_load_dword v76,v4,s[4:7],s56 offen
s_add_u32 s56,s56,8192
buffer_load_dword v77,v4,s[4:7],s56 offen
s_add_u32 s56,s56,8192
buffer_load_dword v78,v4,s[4:7],s56 offen
s_add_u32 s56,s56,8192
buffer_load_dword v79,v4,s[4:7],s56 offen
s_waitcnt vmcnt(48)
v_perm_b32 v80,v25,v24,s61
v_perm_b32 v81,v27,v26,s61
v_perm_b32 v82,v29,v28,s61
v_perm_b32 v83,v31,v30,s61
v_perm_b32 v84,v25,v24,s62
v_perm_b32 v85,v27,v26,s62
v_perm_b32 v86,v29,v28,s62
v_perm_b32 v87,v31,v30,s62
v_accvgpr_write_b32 a240,v80
v_accvgpr_write_b32 a241,v81
v_accvgpr_write_b32 a242,v82
v_accvgpr_write_b32 a243,v83
v_accvgpr_write_b32 a248,v84
v_accvgpr_write_b32 a249,v85
v_accvgpr_write_b32 a250,v86
v_accvgpr_write_b32 a251,v87
s_xor_b32 s56,s63,1310720
s_add_u32 s56,s56,s58
buffer_load_dword v24,v4,s[4:7],s56 offen
s_add_u32 s56,s56,8192
buffer_load_dword v25,v4,s[4:7],s56 offen
s_add_u32 s56,s56,8192
buffer_load_dword v26,v4,s[4:7],s56 offen
s_add_u32 s56,s56,8192
buffer_load_dword v27,v4,s[4:7],s56 offen
s_add_u32 s56,s56,8192
buffer_load_dword v28,v4,s[4:7],s56 offen
s_add_u32 s56,s56,8192
buffer_load_dword v29,v4,s[4:7],s56 offen
s_add_u32 s56,s56,8192
buffer_load_dword v30,v4,s[4:7],s56 offen
s_add_u32 s56,s56,8192
buffer_load_dword v31,v4,s[4:7],s56 offen
s_waitcnt vmcnt(48)
v_perm_b32 v80,v33,v32,s61
v_perm_b32 v81,v35,v34,s61
v_perm_b32 v82,v37,v36,s61
v_perm_b32 v83,v39,v38,s61
v_perm_b32 v84,v33,v32,s62
v_perm_b32 v85,v35,v34,s62
v_perm_b32 v86,v37,v36,s62
v_perm_b32 v87,v39,v38,s62
v_accvgpr_write_b32 a244,v80
v_accvgpr_write_b32 a245,v81
v_accvgpr_write_b32 a246,v82
v_accvgpr_write_b32 a247,v83
v_accvgpr_write_b32 a252,v84
v_accvgpr_write_b32 a253,v85
v_accvgpr_write_b32 a254,v86
v_accvgpr_write_b32 a255,v87
s_xor_b32 s56,s63,1572864
s_add_u32 s56,s56,s58
buffer_load_dword v32,v4,s[4:7],s56 offen
s_add_u32 s56,s56,8192
buffer_load_dword v33,v4,s[4:7],s56 offen
s_add_u32 s56,s56,8192
buffer_load_dword v34,v4,s[4:7],s56 offen
s_add_u32 s56,s56,8192
buffer_load_dword v35,v4,s[4:7],s56 offen
s_add_u32 s56,s56,8192
buffer_load_dword v36,v4,s[4:7],s56 offen
s_add_u32 s56,s56,8192
buffer_load_dword v37,v4,s[4:7],s56 offen
s_add_u32 s56,s56,8192
buffer_load_dword v38,v4,s[4:7],s56 offen
s_add_u32 s56,s56,8192
buffer_load_dword v39,v4,s[4:7],s56 offen
s_waitcnt vmcnt(48)
v_perm_b32 v128,v41,v40,s61
v_perm_b32 v129,v43,v42,s61
v_perm_b32 v130,v45,v44,s61
v_perm_b32 v131,v47,v46,s61
v_perm_b32 v136,v41,v40,s62
v_perm_b32 v137,v43,v42,s62
v_perm_b32 v138,v45,v44,s62
v_perm_b32 v139,v47,v46,s62
s_xor_b32 s56,s63,1835008
s_add_u32 s56,s56,s58
buffer_load_dword v40,v4,s[4:7],s56 offen
s_add_u32 s56,s56,8192
buffer_load_dword v41,v4,s[4:7],s56 offen
s_add_u32 s56,s56,8192
buffer_load_dword v42,v4,s[4:7],s56 offen
s_add_u32 s56,s56,8192
buffer_load_dword v43,v4,s[4:7],s56 offen
s_add_u32 s56,s56,8192
buffer_load_dword v44,v4,s[4:7],s56 offen
s_add_u32 s56,s56,8192
buffer_load_dword v45,v4,s[4:7],s56 offen
s_add_u32 s56,s56,8192
buffer_load_dword v46,v4,s[4:7],s56 offen
s_add_u32 s56,s56,8192
buffer_load_dword v47,v4,s[4:7],s56 offen
s_waitcnt vmcnt(48)
v_perm_b32 v132,v49,v48,s61
v_perm_b32 v133,v51,v50,s61
v_perm_b32 v134,v53,v52,s61
v_perm_b32 v135,v55,v54,s61
v_perm_b32 v140,v49,v48,s62
v_perm_b32 v141,v51,v50,s62
v_perm_b32 v142,v53,v52,s62
v_perm_b32 v143,v55,v54,s62
s_xor_b32 s56,s63,2097152
s_add_u32 s56,s56,s58
buffer_load_dword v48,v4,s[4:7],s56 offen
s_add_u32 s56,s56,8192
buffer_load_dword v49,v4,s[4:7],s56 offen
s_add_u32 s56,s56,8192
buffer_load_dword v50,v4,s[4:7],s56 offen
s_add_u32 s56,s56,8192
buffer_load_dword v51,v4,s[4:7],s56 offen
s_add_u32 s56,s56,8192
buffer_load_dword v52,v4,s[4:7],s56 offen
s_add_u32 s56,s56,8192
buffer_load_dword v53,v4,s[4:7],s56 offen
s_add_u32 s56,s56,8192
buffer_load_dword v54,v4,s[4:7],s56 offen
s_add_u32 s56,s56,8192
buffer_load_dword v55,v4,s[4:7],s56 offen
s_waitcnt vmcnt(48)
v_perm_b32 v144,v57,v56,s61
v_perm_b32 v145,v59,v58,s61
v_perm_b32 v146,v61,v60,s61
v_perm_b32 v147,v63,v62,s61
v_perm_b32 v152,v57,v56,s62
v_perm_b32 v153,v59,v58,s62
v_perm_b32 v154,v61,v60,s62
v_perm_b32 v155,v63,v62,s62
s_xor_b32 s56,s63,2359296
s_add_u32 s56,s56,s58
buffer_load_dword v56,v4,s[4:7],s56 offen
s_add_u32 s56,s56,8192
buffer_load_dword v57,v4,s[4:7],s56 offen
s_add_u32 s56,s56,8192
buffer_load_dword v58,v4,s[4:7],s56 offen
s_add_u32 s56,s56,8192
buffer_load_dword v59,v4,s[4:7],s56 offen
s_add_u32 s56,s56,8192
buffer_load_dword v60,v4,s[4:7],s56 offen
s_add_u32 s56,s56,8192
buffer_load_dword v61,v4,s[4:7],s56 offen
s_add_u32 s56,s56,8192
buffer_load_dword v62,v4,s[4:7],s56 offen
s_add_u32 s56,s56,8192
buffer_load_dword v63,v4,s[4:7],s56 offen
s_waitcnt vmcnt(48)
v_perm_b32 v148,v65,v64,s61
v_perm_b32 v149,v67,v66,s61
v_perm_b32 v150,v69,v68,s61
v_perm_b32 v151,v71,v70,s61
v_perm_b32 v156,v65,v64,s62
v_perm_b32 v157,v67,v66,s62
v_perm_b32 v158,v69,v68,s62
v_perm_b32 v159,v71,v70,s62
s_xor_b32 s56,s63,2621440
s_add_u32 s56,s56,s58
buffer_load_dword v64,v4,s[4:7],s56 offen
s_add_u32 s56,s56,8192
buffer_load_dword v65,v4,s[4:7],s56 offen
s_add_u32 s56,s56,8192
buffer_load_dword v66,v4,s[4:7],s56 offen
s_add_u32 s56,s56,8192
buffer_load_dword v67,v4,s[4:7],s56 offen
s_add_u32 s56,s56,8192
buffer_load_dword v68,v4,s[4:7],s56 offen
s_add_u32 s56,s56,8192
buffer_load_dword v69,v4,s[4:7],s56 offen
s_add_u32 s56,s56,8192
buffer_load_dword v70,v4,s[4:7],s56 offen
s_add_u32 s56,s56,8192
buffer_load_dword v71,v4,s[4:7],s56 offen
s_waitcnt vmcnt(48)
v_perm_b32 v160,v73,v72,s61
v_perm_b32 v161,v75,v74,s61
v_perm_b32 v162,v77,v76,s61
v_perm_b32 v163,v79,v78,s61
v_perm_b32 v168,v73,v72,s62
v_perm_b32 v169,v75,v74,s62
v_perm_b32 v170,v77,v76,s62
v_perm_b32 v171,v79,v78,s62
s_xor_b32 s56,s63,2883584
s_add_u32 s56,s56,s58
buffer_load_dword v72,v4,s[4:7],s56 offen
s_add_u32 s56,s56,8192
buffer_load_dword v73,v4,s[4:7],s56 offen
s_add_u32 s56,s56,8192
buffer_load_dword v74,v4,s[4:7],s56 offen
s_add_u32 s56,s56,8192
buffer_load_dword v75,v4,s[4:7],s56 offen
s_add_u32 s56,s56,8192
buffer_load_dword v76,v4,s[4:7],s56 offen
s_add_u32 s56,s56,8192
buffer_load_dword v77,v4,s[4:7],s56 offen
s_add_u32 s56,s56,8192
buffer_load_dword v78,v4,s[4:7],s56 offen
s_add_u32 s56,s56,8192
buffer_load_dword v79,v4,s[4:7],s56 offen
s_waitcnt vmcnt(48)
v_perm_b32 v164,v25,v24,s61
v_perm_b32 v165,v27,v26,s61
v_perm_b32 v166,v29,v28,s61
v_perm_b32 v167,v31,v30,s61
v_perm_b32 v172,v25,v24,s62
v_perm_b32 v173,v27,v26,s62
v_perm_b32 v174,v29,v28,s62
v_perm_b32 v175,v31,v30,s62
s_xor_b32 s56,s63,3145728
s_add_u32 s56,s56,s58
buffer_load_dword v24,v4,s[4:7],s56 offen
s_add_u32 s56,s56,8192
buffer_load_dword v25,v4,s[4:7],s56 offen
s_add_u32 s56,s56,8192
buffer_load_dword v26,v4,s[4:7],s56 offen
s_add_u32 s56,s56,8192
buffer_load_dword v27,v4,s[4:7],s56 offen
s_add_u32 s56,s56,8192
buffer_load_dword v28,v4,s[4:7],s56 offen
s_add_u32 s56,s56,8192
buffer_load_dword v29,v4,s[4:7],s56 offen
s_add_u32 s56,s56,8192
buffer_load_dword v30,v4,s[4:7],s56 offen
s_add_u32 s56,s56,8192
buffer_load_dword v31,v4,s[4:7],s56 offen
s_waitcnt vmcnt(48)
v_perm_b32 v176,v33,v32,s61
v_perm_b32 v177,v35,v34,s61
v_perm_b32 v178,v37,v36,s61
v_perm_b32 v179,v39,v38,s61
v_perm_b32 v184,v33,v32,s62
v_perm_b32 v185,v35,v34,s62
v_perm_b32 v186,v37,v36,s62
v_perm_b32 v187,v39,v38,s62
s_xor_b32 s56,s63,3407872
s_add_u32 s56,s56,s58
buffer_load_dword v32,v4,s[4:7],s56 offen
s_add_u32 s56,s56,8192
buffer_load_dword v33,v4,s[4:7],s56 offen
s_add_u32 s56,s56,8192
buffer_load_dword v34,v4,s[4:7],s56 offen
s_add_u32 s56,s56,8192
buffer_load_dword v35,v4,s[4:7],s56 offen
s_add_u32 s56,s56,8192
buffer_load_dword v36,v4,s[4:7],s56 offen
s_add_u32 s56,s56,8192
buffer_load_dword v37,v4,s[4:7],s56 offen
s_add_u32 s56,s56,8192
buffer_load_dword v38,v4,s[4:7],s56 offen
s_add_u32 s56,s56,8192
buffer_load_dword v39,v4,s[4:7],s56 offen
s_waitcnt vmcnt(48)
v_perm_b32 v180,v41,v40,s61
v_perm_b32 v181,v43,v42,s61
v_perm_b32 v182,v45,v44,s61
v_perm_b32 v183,v47,v46,s61
v_perm_b32 v188,v41,v40,s62
v_perm_b32 v189,v43,v42,s62
v_perm_b32 v190,v45,v44,s62
v_perm_b32 v191,v47,v46,s62
s_xor_b32 s56,s63,3670016
s_add_u32 s56,s56,s58
buffer_load_dword v40,v4,s[4:7],s56 offen
s_add_u32 s56,s56,8192
buffer_load_dword v41,v4,s[4:7],s56 offen
s_add_u32 s56,s56,8192
buffer_load_dword v42,v4,s[4:7],s56 offen
s_add_u32 s56,s56,8192
buffer_load_dword v43,v4,s[4:7],s56 offen
s_add_u32 s56,s56,8192
buffer_load_dword v44,v4,s[4:7],s56 offen
s_add_u32 s56,s56,8192
buffer_load_dword v45,v4,s[4:7],s56 offen
s_add_u32 s56,s56,8192
buffer_load_dword v46,v4,s[4:7],s56 offen
s_add_u32 s56,s56,8192
buffer_load_dword v47,v4,s[4:7],s56 offen
s_waitcnt vmcnt(48)
v_perm_b32 v192,v49,v48,s61
v_perm_b32 v193,v51,v50,s61
v_perm_b32 v194,v53,v52,s61
v_perm_b32 v195,v55,v54,s61
v_perm_b32 v200,v49,v48,s62
v_perm_b32 v201,v51,v50,s62
v_perm_b32 v202,v53,v52,s62
v_perm_b32 v203,v55,v54,s62
s_xor_b32 s56,s63,3932160
s_add_u32 s56,s56,s58
buffer_load_dword v48,v4,s[4:7],s56 offen
s_add_u32 s56,s56,8192
buffer_load_dword v49,v4,s[4:7],s56 offen
s_add_u32 s56,s56,8192
buffer_load_dword v50,v4,s[4:7],s56 offen
s_add_u32 s56,s56,8192
buffer_load_dword v51,v4,s[4:7],s56 offen
s_add_u32 s56,s56,8192
buffer_load_dword v52,v4,s[4:7],s56 offen
s_add_u32 s56,s56,8192
buffer_load_dword v53,v4,s[4:7],s56 offen
s_add_u32 s56,s56,8192
buffer_load_dword v54,v4,s[4:7],s56 offen
s_add_u32 s56,s56,8192
buffer_load_dword v55,v4,s[4:7],s56 offen
s_waitcnt vmcnt(48)
v_perm_b32 v196,v57,v56,s61
v_perm_b32 v197,v59,v58,s61
v_perm_b32 v198,v61,v60,s61
v_perm_b32 v199,v63,v62,s61
v_perm_b32 v204,v57,v56,s62
v_perm_b32 v205,v59,v58,s62
v_perm_b32 v206,v61,v60,s62
v_perm_b32 v207,v63,v62,s62
s_mov_b32 s4,s20
s_mov_b32 s5,s21
s_mov_b32 s6,4194304
s_mov_b32 s7,0x20000
s_xor_b32 s56,s63,0
s_add_u32 s56,s56,s58
buffer_load_dword v56,v4,s[4:7],s56 offen
s_add_u32 s56,s56,8192
buffer_load_dword v57,v4,s[4:7],s56 offen
s_add_u32 s56,s56,8192
buffer_load_dword v58,v4,s[4:7],s56 offen
s_add_u32 s56,s56,8192
buffer_load_dword v59,v4,s[4:7],s56 offen
s_add_u32 s56,s56,8192
buffer_load_dword v60,v4,s[4:7],s56 offen
s_add_u32 s56,s56,8192
buffer_load_dword v61,v4,s[4:7],s56 offen
s_add_u32 s56,s56,8192
buffer_load_dword v62,v4,s[4:7],s56 offen
s_add_u32 s56,s56,8192
buffer_load_dword v63,v4,s[4:7],s56 offen
s_waitcnt vmcnt(48)
v_perm_b32 v208,v65,v64,s61
v_perm_b32 v209,v67,v66,s61
v_perm_b32 v210,v69,v68,s61
v_perm_b32 v211,v71,v70,s61
v_perm_b32 v216,v65,v64,s62
v_perm_b32 v217,v67,v66,s62
v_perm_b32 v218,v69,v68,s62
v_perm_b32 v219,v71,v70,s62
s_xor_b32 s56,s63,262144
s_add_u32 s56,s56,s58
buffer_load_dword v64,v4,s[4:7],s56 offen
s_add_u32 s56,s56,8192
buffer_load_dword v65,v4,s[4:7],s56 offen
s_add_u32 s56,s56,8192
buffer_load_dword v66,v4,s[4:7],s56 offen
s_add_u32 s56,s56,8192
buffer_load_dword v67,v4,s[4:7],s56 offen
s_add_u32 s56,s56,8192
buffer_load_dword v68,v4,s[4:7],s56 offen
s_add_u32 s56,s56,8192
buffer_load_dword v69,v4,s[4:7],s56 offen
s_add_u32 s56,s56,8192
buffer_load_dword v70,v4,s[4:7],s56 offen
s_add_u32 s56,s56,8192
buffer_load_dword v71,v4,s[4:7],s56 offen
s_waitcnt vmcnt(48)
v_perm_b32 v212,v73,v72,s61
v_perm_b32 v213,v75,v74,s61
v_perm_b32 v214,v77,v76,s61
v_perm_b32 v215,v79,v78,s61
v_perm_b32 v220,v73,v72,s62
v_perm_b32 v221,v75,v74,s62
v_perm_b32 v222,v77,v76,s62
v_perm_b32 v223,v79,v78,s62
s_xor_b32 s56,s63,524288
s_add_u32 s56,s56,s58
buffer_load_dword v72,v4,s[4:7],s56 offen
s_add_u32 s56,s56,8192
buffer_load_dword v73,v4,s[4:7],s56 offen
s_add_u32 s56,s56,8192
buffer_load_dword v74,v4,s[4:7],s56 offen
s_add_u32 s56,s56,8192
buffer_load_dword v75,v4,s[4:7],s56 offen
s_add_u32 s56,s56,8192
buffer_load_dword v76,v4,s[4:7],s56 offen
s_add_u32 s56,s56,8192
buffer_load_dword v77,v4,s[4:7],s56 offen
s_add_u32 s56,s56,8192
buffer_load_dword v78,v4,s[4:7],s56 offen
s_add_u32 s56,s56,8192
buffer_load_dword v79,v4,s[4:7],s56 offen
s_waitcnt vmcnt(48)
v_perm_b32 v224,v25,v24,s61
v_perm_b32 v225,v27,v26,s61
v_perm_b32 v226,v29,v28,s61
v_perm_b32 v227,v31,v30,s61
v_perm_b32 v232,v25,v24,s62
v_perm_b32 v233,v27,v26,s62
v_perm_b32 v234,v29,v28,s62
v_perm_b32 v235,v31,v30,s62
s_xor_b32 s56,s63,786432
s_add_u32 s56,s56,s58
buffer_load_dword v24,v4,s[4:7],s56 offen
s_add_u32 s56,s56,8192
buffer_load_dword v25,v4,s[4:7],s56 offen
s_add_u32 s56,s56,8192
buffer_load_dword v26,v4,s[4:7],s56 offen
s_add_u32 s56,s56,8192
buffer_load_dword v27,v4,s[4:7],s56 offen
s_add_u32 s56,s56,8192
buffer_load_dword v28,v4,s[4:7],s56 offen
s_add_u32 s56,s56,8192
buffer_load_dword v29,v4,s[4:7],s56 offen
s_add_u32 s56,s56,8192
buffer_load_dword v30,v4,s[4:7],s56 offen
s_add_u32 s56,s56,8192
buffer_load_dword v31,v4,s[4:7],s56 offen
s_waitcnt vmcnt(48)
v_perm_b32 v228,v33,v32,s61
v_perm_b32 v229,v35,v34,s61
v_perm_b32 v230,v37,v36,s61
v_perm_b32 v231,v39,v38,s61
v_perm_b32 v236,v33,v32,s62
v_perm_b32 v237,v35,v34,s62
v_perm_b32 v238,v37,v36,s62
v_perm_b32 v239,v39,v38,s62
s_xor_b32 s56,s63,1048576
s_add_u32 s56,s56,s58
buffer_load_dword v32,v4,s[4:7],s56 offen
s_add_u32 s56,s56,8192
buffer_load_dword v33,v4,s[4:7],s56 offen
s_add_u32 s56,s56,8192
buffer_load_dword v34,v4,s[4:7],s56 offen
s_add_u32 s56,s56,8192
buffer_load_dword v35,v4,s[4:7],s56 offen
s_add_u32 s56,s56,8192
buffer_load_dword v36,v4,s[4:7],s56 offen
s_add_u32 s56,s56,8192
buffer_load_dword v37,v4,s[4:7],s56 offen
s_add_u32 s56,s56,8192
buffer_load_dword v38,v4,s[4:7],s56 offen
s_add_u32 s56,s56,8192
buffer_load_dword v39,v4,s[4:7],s56 offen
s_waitcnt vmcnt(48)
v_perm_b32 v240,v41,v40,s61
v_perm_b32 v241,v43,v42,s61
v_perm_b32 v242,v45,v44,s61
v_perm_b32 v243,v47,v46,s61
v_perm_b32 v248,v41,v40,s62
v_perm_b32 v249,v43,v42,s62
v_perm_b32 v250,v45,v44,s62
v_perm_b32 v251,v47,v46,s62
s_xor_b32 s56,s63,1310720
s_add_u32 s56,s56,s58
buffer_load_dword v40,v4,s[4:7],s56 offen
s_add_u32 s56,s56,8192
buffer_load_dword v41,v4,s[4:7],s56 offen
s_add_u32 s56,s56,8192
buffer_load_dword v42,v4,s[4:7],s56 offen
s_add_u32 s56,s56,8192
buffer_load_dword v43,v4,s[4:7],s56 offen
s_add_u32 s56,s56,8192
buffer_load_dword v44,v4,s[4:7],s56 offen
s_add_u32 s56,s56,8192
buffer_load_dword v45,v4,s[4:7],s56 offen
s_add_u32 s56,s56,8192
buffer_load_dword v46,v4,s[4:7],s56 offen
s_add_u32 s56,s56,8192
buffer_load_dword v47,v4,s[4:7],s56 offen
s_waitcnt vmcnt(48)
v_perm_b32 v244,v49,v48,s61
v_perm_b32 v245,v51,v50,s61
v_perm_b32 v246,v53,v52,s61
v_perm_b32 v247,v55,v54,s61
v_perm_b32 v252,v49,v48,s62
v_perm_b32 v253,v51,v50,s62
v_perm_b32 v254,v53,v52,s62
v_perm_b32 v255,v55,v54,s62
s_xor_b32 s56,s63,1572864
s_add_u32 s56,s56,s58
buffer_load_dword v48,v4,s[4:7],s56 offen
s_add_u32 s56,s56,8192
buffer_load_dword v49,v4,s[4:7],s56 offen
s_add_u32 s56,s56,8192
buffer_load_dword v50,v4,s[4:7],s56 offen
s_add_u32 s56,s56,8192
buffer_load_dword v51,v4,s[4:7],s56 offen
s_add_u32 s56,s56,8192
buffer_load_dword v52,v4,s[4:7],s56 offen
s_add_u32 s56,s56,8192
buffer_load_dword v53,v4,s[4:7],s56 offen
s_add_u32 s56,s56,8192
buffer_load_dword v54,v4,s[4:7],s56 offen
s_add_u32 s56,s56,8192
buffer_load_dword v55,v4,s[4:7],s56 offen
s_waitcnt vmcnt(48)
v_perm_b32 v80,v57,v56,s61
v_perm_b32 v81,v59,v58,s61
v_perm_b32 v82,v61,v60,s61
v_perm_b32 v83,v63,v62,s61
v_perm_b32 v84,v57,v56,s62
v_perm_b32 v85,v59,v58,s62
v_perm_b32 v86,v61,v60,s62
v_perm_b32 v87,v63,v62,s62
v_accvgpr_write_b32 a0,v80
v_accvgpr_write_b32 a1,v81
v_accvgpr_write_b32 a2,v82
v_accvgpr_write_b32 a3,v83
v_accvgpr_write_b32 a8,v84
v_accvgpr_write_b32 a9,v85
v_accvgpr_write_b32 a10,v86
v_accvgpr_write_b32 a11,v87
s_xor_b32 s56,s63,1835008
s_add_u32 s56,s56,s58
buffer_load_dword v56,v4,s[4:7],s56 offen
s_add_u32 s56,s56,8192
buffer_load_dword v57,v4,s[4:7],s56 offen
s_add_u32 s56,s56,8192
buffer_load_dword v58,v4,s[4:7],s56 offen
s_add_u32 s56,s56,8192
buffer_load_dword v59,v4,s[4:7],s56 offen
s_add_u32 s56,s56,8192
buffer_load_dword v60,v4,s[4:7],s56 offen
s_add_u32 s56,s56,8192
buffer_load_dword v61,v4,s[4:7],s56 offen
s_add_u32 s56,s56,8192
buffer_load_dword v62,v4,s[4:7],s56 offen
s_add_u32 s56,s56,8192
buffer_load_dword v63,v4,s[4:7],s56 offen
s_waitcnt vmcnt(48)
v_perm_b32 v80,v65,v64,s61
v_perm_b32 v81,v67,v66,s61
v_perm_b32 v82,v69,v68,s61
v_perm_b32 v83,v71,v70,s61
v_perm_b32 v84,v65,v64,s62
v_perm_b32 v85,v67,v66,s62
v_perm_b32 v86,v69,v68,s62
v_perm_b32 v87,v71,v70,s62
v_accvgpr_write_b32 a4,v80
v_accvgpr_write_b32 a5,v81
v_accvgpr_write_b32 a6,v82
v_accvgpr_write_b32 a7,v83
v_accvgpr_write_b32 a12,v84
v_accvgpr_write_b32 a13,v85
v_accvgpr_write_b32 a14,v86
v_accvgpr_write_b32 a15,v87
s_xor_b32 s56,s63,2097152
s_add_u32 s56,s56,s58
buffer_load_dword v64,v4,s[4:7],s56 offen
s_add_u32 s56,s56,8192
buffer_load_dword v65,v4,s[4:7],s56 offen
s_add_u32 s56,s56,8192
buffer_load_dword v66,v4,s[4:7],s56 offen
s_add_u32 s56,s56,8192
buffer_load_dword v67,v4,s[4:7],s56 offen
s_add_u32 s56,s56,8192
buffer_load_dword v68,v4,s[4:7],s56 offen
s_add_u32 s56,s56,8192
buffer_load_dword v69,v4,s[4:7],s56 offen
s_add_u32 s56,s56,8192
buffer_load_dword v70,v4,s[4:7],s56 offen
s_add_u32 s56,s56,8192
buffer_load_dword v71,v4,s[4:7],s56 offen
s_waitcnt vmcnt(48)
v_perm_b32 v80,v73,v72,s61
v_perm_b32 v81,v75,v74,s61
v_perm_b32 v82,v77,v76,s61
v_perm_b32 v83,v79,v78,s61
v_perm_b32 v84,v73,v72,s62
v_perm_b32 v85,v75,v74,s62
v_perm_b32 v86,v77,v76,s62
v_perm_b32 v87,v79,v78,s62
v_accvgpr_write_b32 a16,v80
v_accvgpr_write_b32 a17,v81
v_accvgpr_write_b32 a18,v82
v_accvgpr_write_b32 a19,v83
v_accvgpr_write_b32 a24,v84
v_accvgpr_write_b32 a25,v85
v_accvgpr_write_b32 a26,v86
v_accvgpr_write_b32 a27,v87
s_xor_b32 s56,s63,2359296
s_add_u32 s56,s56,s58
buffer_load_dword v72,v4,s[4:7],s56 offen
s_add_u32 s56,s56,8192
buffer_load_dword v73,v4,s[4:7],s56 offen
s_add_u32 s56,s56,8192
buffer_load_dword v74,v4,s[4:7],s56 offen
s_add_u32 s56,s56,8192
buffer_load_dword v75,v4,s[4:7],s56 offen
s_add_u32 s56,s56,8192
buffer_load_dword v76,v4,s[4:7],s56 offen
s_add_u32 s56,s56,8192
buffer_load_dword v77,v4,s[4:7],s56 offen
s_add_u32 s56,s56,8192
buffer_load_dword v78,v4,s[4:7],s56 offen
s_add_u32 s56,s56,8192
buffer_load_dword v79,v4,s[4:7],s56 offen
s_waitcnt vmcnt(48)
v_perm_b32 v80,v25,v24,s61
v_perm_b32 v81,v27,v26,s61
v_perm_b32 v82,v29,v28,s61
v_perm_b32 v83,v31,v30,s61
v_perm_b32 v84,v25,v24,s62
v_perm_b32 v85,v27,v26,s62
v_perm_b32 v86,v29,v28,s62
v_perm_b32 v87,v31,v30,s62
v_accvgpr_write_b32 a20,v80
v_accvgpr_write_b32 a21,v81
v_accvgpr_write_b32 a22,v82
v_accvgpr_write_b32 a23,v83
v_accvgpr_write_b32 a28,v84
v_accvgpr_write_b32 a29,v85
v_accvgpr_write_b32 a30,v86
v_accvgpr_write_b32 a31,v87
s_xor_b32 s56,s63,2621440
s_add_u32 s56,s56,s58
buffer_load_dword v24,v4,s[4:7],s56 offen
s_add_u32 s56,s56,8192
buffer_load_dword v25,v4,s[4:7],s56 offen
s_add_u32 s56,s56,8192
buffer_load_dword v26,v4,s[4:7],s56 offen
s_add_u32 s56,s56,8192
buffer_load_dword v27,v4,s[4:7],s56 offen
s_add_u32 s56,s56,8192
buffer_load_dword v28,v4,s[4:7],s56 offen
s_add_u32 s56,s56,8192
buffer_load_dword v29,v4,s[4:7],s56 offen
s_add_u32 s56,s56,8192
buffer_load_dword v30,v4,s[4:7],s56 offen
s_add_u32 s56,s56,8192
buffer_load_dword v31,v4,s[4:7],s56 offen
s_waitcnt vmcnt(48)
v_perm_b32 v80,v33,v32,s61
v_perm_b32 v81,v35,v34,s61
v_perm_b32 v82,v37,v36,s61
v_perm_b32 v83,v39,v38,s61
v_perm_b32 v84,v33,v32,s62
v_perm_b32 v85,v35,v34,s62
v_perm_b32 v86,v37,v36,s62
v_perm_b32 v87,v39,v38,s62
v_accvgpr_write_b32 a32,v80
v_accvgpr_write_b32 a33,v81
v_accvgpr_write_b32 a34,v82
v_accvgpr_write_b32 a35,v83
v_accvgpr_write_b32 a40,v84
v_accvgpr_write_b32 a41,v85
v_accvgpr_write_b32 a42,v86
v_accvgpr_write_b32 a43,v87
s_xor_b32 s56,s63,2883584
s_add_u32 s56,s56,s58
buffer_load_dword v32,v4,s[4:7],s56 offen
s_add_u32 s56,s56,8192
buffer_load_dword v33,v4,s[4:7],s56 offen
s_add_u32 s56,s56,8192
buffer_load_dword v34,v4,s[4:7],s56 offen
s_add_u32 s56,s56,8192
buffer_load_dword v35,v4,s[4:7],s56 offen
s_add_u32 s56,s56,8192
buffer_load_dword v36,v4,s[4:7],s56 offen
s_add_u32 s56,s56,8192
buffer_load_dword v37,v4,s[4:7],s56 offen
s_add_u32 s56,s56,8192
buffer_load_dword v38,v4,s[4:7],s56 offen
s_add_u32 s56,s56,8192
buffer_load_dword v39,v4,s[4:7],s56 offen
s_waitcnt vmcnt(48)
v_perm_b32 v80,v41,v40,s61
v_perm_b32 v81,v43,v42,s61
v_perm_b32 v82,v45,v44,s61
v_perm_b32 v83,v47,v46,s61
v_perm_b32 v84,v41,v40,s62
v_perm_b32 v85,v43,v42,s62
v_perm_b32 v86,v45,v44,s62
v_perm_b32 v87,v47,v46,s62
v_accvgpr_write_b32 a36,v80
v_accvgpr_write_b32 a37,v81
v_accvgpr_write_b32 a38,v82
v_accvgpr_write_b32 a39,v83
v_accvgpr_write_b32 a44,v84
v_accvgpr_write_b32 a45,v85
v_accvgpr_write_b32 a46,v86
v_accvgpr_write_b32 a47,v87
s_xor_b32 s56,s63,3145728
s_add_u32 s56,s56,s58
buffer_load_dword v40,v4,s[4:7],s56 offen
s_add_u32 s56,s56,8192
buffer_load_dword v41,v4,s[4:7],s56 offen
s_add_u32 s56,s56,8192
buffer_load_dword v42,v4,s[4:7],s56 offen
s_add_u32 s56,s56,8192
buffer_load_dword v43,v4,s[4:7],s56 offen
s_add_u32 s56,s56,8192
buffer_load_dword v44,v4,s[4:7],s56 offen
s_add_u32 s56,s56,8192
buffer_load_dword v45,v4,s[4:7],s56 offen
s_add_u32 s56,s56,8192
buffer_load_dword v46,v4,s[4:7],s56 offen
s_add_u32 s56,s56,8192
buffer_load_dword v47,v4,s[4:7],s56 offen
s_waitcnt vmcnt(48)
v_perm_b32 v80,v49,v48,s61
v_perm_b32 v81,v51,v50,s61
v_perm_b32 v82,v53,v52,s61
v_perm_b32 v83,v55,v54,s61
v_perm_b32 v84,v49,v48,s62
v_perm_b32 v85,v51,v50,s62
v_perm_b32 v86,v53,v52,s62
v_perm_b32 v87,v55,v54,s62
v_accvgpr_write_b32 a48,v80
v_accvgpr_write_b32 a49,v81
v_accvgpr_write_b32 a50,v82
v_accvgpr_write_b32 a51,v83
v_accvgpr_write_b32 a56,v84
v_accvgpr_write_b32 a57,v85
v_accvgpr_write_b32 a58,v86
v_accvgpr_write_b32 a59,v87
s_xor_b32 s56,s63,3407872
s_add_u32 s56,s56,s58
buffer_load_dword v48,v4,s[4:7],s56 offen
s_add_u32 s56,s56,8192
buffer_load_dword v49,v4,s[4:7],s56 offen
s_add_u32 s56,s56,8192
buffer_load_dword v50,v4,s[4:7],s56 offen
s_add_u32 s56,s56,8192
buffer_load_dword v51,v4,s[4:7],s56 offen
s_add_u32 s56,s56,8192
buffer_load_dword v52,v4,s[4:7],s56 offen
s_add_u32 s56,s56,8192
buffer_load_dword v53,v4,s[4:7],s56 offen
s_add_u32 s56,s56,8192
buffer_load_dword v54,v4,s[4:7],s56 offen
s_add_u32 s56,s56,8192
buffer_load_dword v55,v4,s[4:7],s56 offen
s_waitcnt vmcnt(48)
v_perm_b32 v80,v57,v56,s61
v_perm_b32 v81,v59,v58,s61
v_perm_b32 v82,v61,v60,s61
v_perm_b32 v83,v63,v62,s61
v_perm_b32 v84,v57,v56,s62
v_perm_b32 v85,v59,v58,s62
v_perm_b32 v86,v61,v60,s62
v_perm_b32 v87,v63,v62,s62
v_accvgpr_write_b32 a52,v80
v_accvgpr_write_b32 a53,v81
v_accvgpr_write_b32 a54,v82
v_accvgpr_write_b32 a55,v83
v_accvgpr_write_b32 a60,v84
v_accvgpr_write_b32 a61,v85
v_accvgpr_write_b32 a62,v86
v_accvgpr_write_b32 a63,v87
s_xor_b32 s56,s63,3670016
s_add_u32 s56,s56,s58
buffer_load_dword v56,v4,s[4:7],s56 offen
s_add_u32 s56,s56,8192
buffer_load_dword v57,v4,s[4:7],s56 offen
s_add_u32 s56,s56,8192
buffer_load_dword v58,v4,s[4:7],s56 offen
s_add_u32 s56,s56,8192
buffer_load_dword v59,v4,s[4:7],s56 offen
s_add_u32 s56,s56,8192
buffer_load_dword v60,v4,s[4:7],s56 offen
s_add_u32 s56,s56,8192
buffer_load_dword v61,v4,s[4:7],s56 offen
s_add_u32 s56,s56,8192
buffer_load_dword v62,v4,s[4:7],s56 offen
s_add_u32 s56,s56,8192
buffer_load_dword v63,v4,s[4:7],s56 offen
s_waitcnt vmcnt(48)
v_perm_b32 v80,v65,v64,s61
v_perm_b32 v81,v67,v66,s61
v_perm_b32 v82,v69,v68,s61
v_perm_b32 v83,v71,v70,s61
v_perm_b32 v84,v65,v64,s62
v_perm_b32 v85,v67,v66,s62
v_perm_b32 v86,v69,v68,s62
v_perm_b32 v87,v71,v70,s62
v_accvgpr_write_b32 a64,v80
v_accvgpr_write_b32 a65,v81
v_accvgpr_write_b32 a66,v82
v_accvgpr_write_b32 a67,v83
v_accvgpr_write_b32 a72,v84
v_accvgpr_write_b32 a73,v85
v_accvgpr_write_b32 a74,v86
v_accvgpr_write_b32 a75,v87
s_xor_b32 s56,s63,3932160
s_add_u32 s56,s56,s58
buffer_load_dword v64,v4,s[4:7],s56 offen
s_add_u32 s56,s56,8192
buffer_load_dword v65,v4,s[4:7],s56 offen
s_add_u32 s56,s56,8192
buffer_load_dword v66,v4,s[4:7],s56 offen
s_add_u32 s56,s56,8192
buffer_load_dword v67,v4,s[4:7],s56 offen
s_add_u32 s56,s56,8192
buffer_load_dword v68,v4,s[4:7],s56 offen
s_add_u32 s56,s56,8192
buffer_load_dword v69,v4,s[4:7],s56 offen
s_add_u32 s56,s56,8192
buffer_load_dword v70,v4,s[4:7],s56 offen
s_add_u32 s56,s56,8192
buffer_load_dword v71,v4,s[4:7],s56 offen
s_waitcnt vmcnt(48)
v_perm_b32 v80,v73,v72,s61
v_perm_b32 v81,v75,v74,s61
v_perm_b32 v82,v77,v76,s61
v_perm_b32 v83,v79,v78,s61
v_perm_b32 v84,v73,v72,s62
v_perm_b32 v85,v75,v74,s62
v_perm_b32 v86,v77,v76,s62
v_perm_b32 v87,v79,v78,s62
v_accvgpr_write_b32 a68,v80
v_accvgpr_write_b32 a69,v81
v_accvgpr_write_b32 a70,v82
v_accvgpr_write_b32 a71,v83
v_accvgpr_write_b32 a76,v84
v_accvgpr_write_b32 a77,v85
v_accvgpr_write_b32 a78,v86
v_accvgpr_write_b32 a79,v87
s_waitcnt vmcnt(40)
v_perm_b32 v80,v25,v24,s61
v_perm_b32 v81,v27,v26,s61
v_perm_b32 v82,v29,v28,s61
v_perm_b32 v83,v31,v30,s61
v_perm_b32 v84,v25,v24,s62
v_perm_b32 v85,v27,v26,s62
v_perm_b32 v86,v29,v28,s62
v_perm_b32 v87,v31,v30,s62
v_accvgpr_write_b32 a80,v80
v_accvgpr_write_b32 a81,v81
v_accvgpr_write_b32 a82,v82
v_accvgpr_write_b32 a83,v83
v_accvgpr_write_b32 a88,v84
v_accvgpr_write_b32 a89,v85
v_accvgpr_write_b32 a90,v86
v_accvgpr_write_b32 a91,v87
s_waitcnt vmcnt(32)
v_perm_b32 v80,v33,v32,s61
v_perm_b32 v81,v35,v34,s61
v_perm_b32 v82,v37,v36,s61
v_perm_b32 v83,v39,v38,s61
v_perm_b32 v84,v33,v32,s62
v_perm_b32 v85,v35,v34,s62
v_perm_b32 v86,v37,v36,s62
v_perm_b32 v87,v39,v38,s62
v_accvgpr_write_b32 a84,v80
v_accvgpr_write_b32 a85,v81
v_accvgpr_write_b32 a86,v82
v_accvgpr_write_b32 a87,v83
v_accvgpr_write_b32 a92,v84
v_accvgpr_write_b32 a93,v85
v_accvgpr_write_b32 a94,v86
v_accvgpr_write_b32 a95,v87
s_waitcnt vmcnt(24)
v_perm_b32 v80,v41,v40,s61
v_perm_b32 v81,v43,v42,s61
v_perm_b32 v82,v45,v44,s61
v_perm_b32 v83,v47,v46,s61
v_perm_b32 v84,v41,v40,s62
v_perm_b32 v85,v43,v42,s62
v_perm_b32 v86,v45,v44,s62
v_perm_b32 v87,v47,v46,s62
v_accvgpr_write_b32 a96,v80
v_accvgpr_write_b32 a97,v81
v_accvgpr_write_b32 a98,v82
v_accvgpr_write_b32 a99,v83
v_accvgpr_write_b32 a104,v84
v_accvgpr_write_b32 a105,v85
v_accvgpr_write_b32 a106,v86
v_accvgpr_write_b32 a107,v87
s_waitcnt vmcnt(16)
v_perm_b32 v80,v49,v48,s61
v_perm_b32 v81,v51,v50,s61
v_perm_b32 v82,v53,v52,s61
v_perm_b32 v83,v55,v54,s61
v_perm_b32 v84,v49,v48,s62
v_perm_b32 v85,v51,v50,s62
v_perm_b32 v86,v53,v52,s62
v_perm_b32 v87,v55,v54,s62
v_accvgpr_write_b32 a100,v80
v_accvgpr_write_b32 a101,v81
v_accvgpr_write_b32 a102,v82
v_accvgpr_write_b32 a103,v83
v_accvgpr_write_b32 a108,v84
v_accvgpr_write_b32 a109,v85
v_accvgpr_write_b32 a110,v86
v_accvgpr_write_b32 a111,v87
s_waitcnt vmcnt(8)
v_perm_b32 v80,v57,v56,s61
v_perm_b32 v81,v59,v58,s61
v_perm_b32 v82,v61,v60,s61
v_perm_b32 v83,v63,v62,s61
v_perm_b32 v84,v57,v56,s62
v_perm_b32 v85,v59,v58,s62
v_perm_b32 v86,v61,v60,s62
v_perm_b32 v87,v63,v62,s62
v_accvgpr_write_b32 a112,v80
v_accvgpr_write_b32 a113,v81
v_accvgpr_write_b32 a114,v82
v_accvgpr_write_b32 a115,v83
v_accvgpr_write_b32 a120,v84
v_accvgpr_write_b32 a121,v85
v_accvgpr_write_b32 a122,v86
v_accvgpr_write_b32 a123,v87
s_waitcnt vmcnt(0)
v_perm_b32 v80,v65,v64,s61
v_perm_b32 v81,v67,v66,s61
v_perm_b32 v82,v69,v68,s61
v_perm_b32 v83,v71,v70,s61
v_perm_b32 v84,v65,v64,s62
v_perm_b32 v85,v67,v66,s62
v_perm_b32 v86,v69,v68,s62
v_perm_b32 v87,v71,v70,s62
v_accvgpr_write_b32 a116,v80
v_accvgpr_write_b32 a117,v81
v_accvgpr_write_b32 a118,v82
v_accvgpr_write_b32 a119,v83
v_accvgpr_write_b32 a124,v84
v_accvgpr_write_b32 a125,v85
v_accvgpr_write_b32 a126,v86
v_accvgpr_write_b32 a127,v87
s_cmp_lt_u32 s48,3
s_cbranch_scc1 L_rch_4
s_cmp_eq_u32 s48,3
s_cbranch_scc1 L_rm_5
v_mov_b32 v123,159744
s_cmp_lg_u32 s46,0
s_cbranch_scc1 L_gbd_11
v_mov_b32 v124,128
L_gb_10:
buffer_load_dword v125,v124,s[12:15],0 offen sc1
s_waitcnt vmcnt(0)
v_readfirstlane_b32 s56,v125
ds_write_b32 v123,v125
s_bitcmp1_b32 s56,8
s_cbranch_scc1 L_gbd_11
s_sleep 4
s_sub_u32 s49,s49,1
s_cmp_gt_i32 s49,0
s_cbranch_scc1 L_gb_10
s_branch L_abort
L_gbd_11:
s_waitcnt lgkmcnt(0)
s_barrier
ds_read_b32 v125,v123
s_waitcnt lgkmcnt(0)
v_readfirstlane_b32 s56,v125
s_barrier
s_lshr_b32 s56,s56,16
s_andn2_b32 s56,s56,s3
s_cbranch_scc1 L_spread
v_and_b32 v120,15,v1
v_lshrrev_b32 v121,4,v1
v_mov_b32 v17,1
s_lshl_b32 s56,s46,15
v_add_u32 v18,s56,v0
s_lshl_b32 s56,s46,2
v_add_u32 v125,s56,v121
v_xor_b32 v126,v125,v120
v_lshlrev_b32 v126,4,v126
v_lshl_add_u32 v20,v125,10,v126
v_add_u32 v125,0,v121
v_xor_b32 v125,v125,v120
v_lshlrev_b32 v125,4,v125
v_lshl_add_u32 v125,v120,8,v125
v_add_u32 v4,65536,v125
v_add_u32 v125,4,v121
v_xor_b32 v125,v125,v120
v_lshlrev_b32 v125,4,v125
v_lshl_add_u32 v125,v120,8,v125
v_add_u32 v5,65536,v125
v_add_u32 v125,8,v121
v_xor_b32 v125,v125,v120
v_lshlrev_b32 v125,4,v125
v_lshl_add_u32 v125,v120,8,v125
v_add_u32 v6,65536,v125
v_add_u32 v125,12,v121
v_xor_b32 v125,v125,v120
v_lshlrev_b32 v125,4,v125
v_lshl_add_u32 v125,v120,8,v125
v_add_u32 v7,65536,v125
v_lshlrev_b32 v21,5,v120
v_and_b32 v125,1,v121
v_lshl_add_u32 v21,v125,4,v21
s_lshl_b32 s56,s46,9
v_lshrrev_b32 v125,1,v121
v_lshl_add_u32 v21,v125,11,v21
s_add_u32 s56,s56,155648
v_add_u32 v21,s56,v21
v_lshlrev_b32 v22,4,v120
v_lshl_add_u32 v22,v121,10,v22
s_lshl_b32 s56,s46,8
v_add_u32 v22,s56,v22
s_sub_u32 s54,s48,4
s_cmp_eq_u32 s54,0
s_mov_b32 s72,2453668010
s_mov_b32 s73,613566756
s_cmov_b32 s72,1226834005
s_cmov_b32 s73,2454267026
s_mov_b32 s70,0x80000000
s_mov_b32 s53,2
s_ff1_i32_b64 s55,s[72:73]
s_bitset0_b64 s[72:73],s55
s_min_u32 s55,s55,127
s_lshl_b32 s68,s55,15
s_add_u32 s68,s68,0
s_add_u32 s69,s68,16384
s_add_u32 m0,s50,98304
s_nop 0
buffer_load_dwordx4 v20,s[8:11],s68 offen offset:0 sc1 lds
s_add_u32 m0,s50,102400
s_nop 0
buffer_load_dwordx4 v20,s[8:11],s69 offen offset:0 sc1 lds
s_add_u32 m0,s50,106240
s_nop 0
buffer_load_dwordx4 v20,s[8:11],s68 offen offset:256 sc1 lds
s_add_u32 m0,s50,110336
s_nop 0
buffer_load_dwordx4 v20,s[8:11],s69 offen offset:256 sc1 lds
s_add_u32 m0,s50,114176
s_nop 0
buffer_load_dwordx4 v20,s[8:11],s68 offen offset:512 sc1 lds
s_add_u32 m0,s50,118272
s_nop 0
buffer_load_dwordx4 v20,s[8:11],s69 offen offset:512 sc1 lds
s_add_u32 m0,s50,122112
s_nop 0
buffer_load_dwordx4 v20,s[8:11],s68 offen offset:768 sc1 lds
s_add_u32 m0,s50,126208
s_nop 0
buffer_load_dwordx4 v20,s[8:11],s69 offen offset:768 sc1 lds
s_waitcnt vmcnt(0)
s_barrier
L_pu_12:
s_mov_b32 s51,s55
s_ff1_i32_b64 s55,s[72:73]
s_bitset0_b64 s[72:73],s55
s_min_u32 s55,s55,127
s_lshl_b32 s68,s55,15
s_add_u32 s68,s68,0
s_add_u32 s69,s68,16384
s_lshl_b32 s58,s51,5
s_add_u32 s58,s58,s47
s_mul_i32 s58,s58,24576
s_add_u32 s58,s58,100663296
s_add_u32 s61,s58,s50
s_add_u32 s62,s61,4096
s_add_u32 s63,s61,16384
s_add_u32 s64,s61,20480
s_add_u32 s65,s61,s50
s_add_u32 s65,s65,8192
ds_read_b128 v[104:107],v4 offset:32768
ds_read_b128 v[108:111],v4 offset:36864
ds_read_b128 v[112:115],v5 offset:32768
ds_read_b128 v[116:119],v5 offset:36864
s_waitcnt lgkmcnt(2)
v_mfma_f32_16x16x32_bf16 v[24:27],a[128:131],v[104:107],0
ds_read_b128 v[120:123],v6 offset:32768
v_mfma_f32_16x16x32_bf16 v[40:43],v[104:107],v[128:131],0
v_mfma_f32_16x16x32_bf16 v[28:31],a[128:131],v[108:111],0
ds_read_b128 v[124:127],v6 offset:36864
v_mfma_f32_16x16x32_bf16 v[44:47],v[108:111],v[128:131],0
v_mfma_f32_16x16x32_bf16 v[32:35],a[136:139],v[104:107],0
v_mfma_f32_16x16x32_bf16 v[48:51],v[104:107],v[136:139],0
v_mfma_f32_16x16x32_bf16 v[36:39],a[136:139],v[108:111],0
v_mfma_f32_16x16x32_bf16 v[52:55],v[108:111],v[136:139],0
s_waitcnt lgkmcnt(2)
v_mfma_f32_16x16x32_bf16 v[24:27],a[132:135],v[112:115],v[24:27]
ds_read_b128 v[104:107],v7 offset:32768
v_mfma_f32_16x16x32_bf16 v[40:43],v[112:115],v[132:135],v[40:43]
v_mfma_f32_16x16x32_bf16 v[28:31],a[132:135],v[116:119],v[28:31]
ds_read_b128 v[108:111],v7 offset:36864
v_mfma_f32_16x16x32_bf16 v[44:47],v[116:119],v[132:135],v[44:47]
v_mfma_f32_16x16x32_bf16 v[32:35],a[140:143],v[112:115],v[32:35]
v_mfma_f32_16x16x32_bf16 v[48:51],v[112:115],v[140:143],v[48:51]
v_mfma_f32_16x16x32_bf16 v[36:39],a[140:143],v[116:119],v[36:39]
v_mfma_f32_16x16x32_bf16 v[52:55],v[116:119],v[140:143],v[52:55]
s_waitcnt lgkmcnt(2)
v_mfma_f32_16x16x32_bf16 v[24:27],a[144:147],v[120:123],v[24:27]
ds_read_b128 v[112:115],v4 offset:40960
v_mfma_f32_16x16x32_bf16 v[40:43],v[120:123],v[144:147],v[40:43]
v_mfma_f32_16x16x32_bf16 v[28:31],a[144:147],v[124:127],v[28:31]
ds_read_b128 v[116:119],v4 offset:45056
v_mfma_f32_16x16x32_bf16 v[44:47],v[124:127],v[144:147],v[44:47]
v_mfma_f32_16x16x32_bf16 v[32:35],a[152:155],v[120:123],v[32:35]
v_mfma_f32_16x16x32_bf16 v[48:51],v[120:123],v[152:155],v[48:51]
v_mfma_f32_16x16x32_bf16 v[36:39],a[152:155],v[124:127],v[36:39]
v_mfma_f32_16x16x32_bf16 v[52:55],v[124:127],v[152:155],v[52:55]
s_waitcnt lgkmcnt(2)
v_mfma_f32_16x16x32_bf16 v[24:27],a[148:151],v[104:107],v[24:27]
ds_read_b128 v[120:123],v5 offset:40960
v_mfma_f32_16x16x32_bf16 v[40:43],v[104:107],v[148:151],v[40:43]
v_mfma_f32_16x16x32_bf16 v[28:31],a[148:151],v[108:111],v[28:31]
ds_read_b128 v[124:127],v5 offset:45056
v_mfma_f32_16x16x32_bf16 v[44:47],v[108:111],v[148:151],v[44:47]
v_mfma_f32_16x16x32_bf16 v[32:35],a[156:159],v[104:107],v[32:35]
v_mfma_f32_16x16x32_bf16 v[48:51],v[104:107],v[156:159],v[48:51]
v_mfma_f32_16x16x32_bf16 v[36:39],a[156:159],v[108:111],v[36:39]
v_mfma_f32_16x16x32_bf16 v[52:55],v[108:111],v[156:159],v[52:55]
s_waitcnt lgkmcnt(2)
v_mfma_f32_16x16x32_bf16 v[24:27],a[160:163],v[112:115],v[24:27]
ds_read_b128 v[104:107],v6 offset:40960
v_mfma_f32_16x16x32_bf16 v[40:43],v[112:115],v[160:163],v[40:43]
v_mfma_f32_16x16x32_bf16 v[28:31],a[160:163],v[116:119],v[28:31]
ds_read_b128 v[108:111],v6 offset:45056
v_mfma_f32_16x16x32_bf16 v[44:47],v[116:119],v[160:163],v[44:47]
v_mfma_f32_16x16x32_bf16 v[32:35],a[168:171],v[112:115],v[32:35]
v_mfma_f32_16x16x32_bf16 v[48:51],v[112:115],v[168:171],v[48:51]
v_mfma_f32_16x16x32_bf16 v[36:39],a[168:171],v[116:119],v[36:39]
v_mfma_f32_16x16x32_bf16 v[52:55],v[116:119],v[168:171],v[52:55]
s_waitcnt lgkmcnt(2)
v_mfma_f32_16x16x32_bf16 v[24:27],a[164:167],v[120:123],v[24:27]
ds_read_b128 v[112:115],v7 offset:40960
v_mfma_f32_16x16x32_bf16 v[40:43],v[120:123],v[164:167],v[40:43]
v_mfma_f32_16x16x32_bf16 v[28:31],a[164:167],v[124:127],v[28:31]
ds_read_b128 v[116:119],v7 offset:45056
v_mfma_f32_16x16x32_bf16 v[44:47],v[124:127],v[164:167],v[44:47]
v_mfma_f32_16x16x32_bf16 v[32:35],a[172:175],v[120:123],v[32:35]
v_mfma_f32_16x16x32_bf16 v[48:51],v[120:123],v[172:175],v[48:51]
v_mfma_f32_16x16x32_bf16 v[36:39],a[172:175],v[124:127],v[36:39]
v_mfma_f32_16x16x32_bf16 v[52:55],v[124:127],v[172:175],v[52:55]
s_waitcnt lgkmcnt(2)
v_mfma_f32_16x16x32_bf16 v[24:27],a[176:179],v[104:107],v[24:27]
ds_read_b128 v[120:123],v4 offset:49152
v_mfma_f32_16x16x32_bf16 v[40:43],v[104:107],v[176:179],v[40:43]
v_mfma_f32_16x16x32_bf16 v[28:31],a[176:179],v[108:111],v[28:31]
ds_read_b128 v[124:127],v4 offset:53248
v_mfma_f32_16x16x32_bf16 v[44:47],v[108:111],v[176:179],v[44:47]
v_mfma_f32_16x16x32_bf16 v[32:35],a[184:187],v[104:107],v[32:35]
v_mfma_f32_16x16x32_bf16 v[48:51],v[104:107],v[184:187],v[48:51]
v_mfma_f32_16x16x32_bf16 v[36:39],a[184:187],v[108:111],v[36:39]
v_mfma_f32_16x16x32_bf16 v[52:55],v[108:111],v[184:187],v[52:55]
s_waitcnt lgkmcnt(2)
v_mfma_f32_16x16x32_bf16 v[24:27],a[180:183],v[112:115],v[24:27]
ds_read_b128 v[104:107],v5 offset:49152
v_mfma_f32_16x16x32_bf16 v[40:43],v[112:115],v[180:183],v[40:43]
v_mfma_f32_16x16x32_bf16 v[28:31],a[180:183],v[116:119],v[28:31]
ds_read_b128 v[108:111],v5 offset:53248
v_mfma_f32_16x16x32_bf16 v[44:47],v[116:119],v[180:183],v[44:47]
v_mfma_f32_16x16x32_bf16 v[32:35],a[188:191],v[112:115],v[32:35]
v_mfma_f32_16x16x32_bf16 v[48:51],v[112:115],v[188:191],v[48:51]
v_mfma_f32_16x16x32_bf16 v[36:39],a[188:191],v[116:119],v[36:39]
v_mfma_f32_16x16x32_bf16 v[52:55],v[116:119],v[188:191],v[52:55]
s_waitcnt lgkmcnt(2)
v_mfma_f32_16x16x32_bf16 v[24:27],a[192:195],v[120:123],v[24:27]
ds_read_b128 v[112:115],v6 offset:49152
v_mfma_f32_16x16x32_bf16 v[40:43],v[120:123],v[192:195],v[40:43]
v_mfma_f32_16x16x32_bf16 v[28:31],a[192:195],v[124:127],v[28:31]
ds_read_b128 v[116:119],v6 offset:53248
v_mfma_f32_16x16x32_bf16 v[44:47],v[124:127],v[192:195],v[44:47]
v_mfma_f32_16x16x32_bf16 v[32:35],a[200:203],v[120:123],v[32:35]
v_mfma_f32_16x16x32_bf16 v[48:51],v[120:123],v[200:203],v[48:51]
v_mfma_f32_16x16x32_bf16 v[36:39],a[200:203],v[124:127],v[36:39]
v_mfma_f32_16x16x32_bf16 v[52:55],v[124:127],v[200:203],v[52:55]
s_waitcnt lgkmcnt(2)
v_mfma_f32_16x16x32_bf16 v[24:27],a[196:199],v[104:107],v[24:27]
ds_read_b128 v[120:123],v7 offset:49152
v_mfma_f32_16x16x32_bf16 v[40:43],v[104:107],v[196:199],v[40:43]
v_mfma_f32_16x16x32_bf16 v[28:31],a[196:199],v[108:111],v[28:31]
ds_read_b128 v[124:127],v7 offset:53248
v_mfma_f32_16x16x32_bf16 v[44:47],v[108:111],v[196:199],v[44:47]
v_mfma_f32_16x16x32_bf16 v[32:35],a[204:207],v[104:107],v[32:35]
v_mfma_f32_16x16x32_bf16 v[48:51],v[104:107],v[204:207],v[48:51]
v_mfma_f32_16x16x32_bf16 v[36:39],a[204:207],v[108:111],v[36:39]
v_mfma_f32_16x16x32_bf16 v[52:55],v[108:111],v[204:207],v[52:55]
s_waitcnt vmcnt(0)
s_barrier
s_or_b32 s70,s70,s52
buffer_store_dword v17,off,s[8:11],s70 sc1
s_waitcnt lgkmcnt(2)
v_mfma_f32_16x16x32_bf16 v[24:27],a[208:211],v[112:115],v[24:27]
ds_read_b128 v[104:107],v4 offset:57344
v_mfma_f32_16x16x32_bf16 v[40:43],v[112:115],v[208:211],v[40:43]
s_add_u32 m0,s50,65536
v_mfma_f32_16x16x32_bf16 v[28:31],a[208:211],v[116:119],v[28:31]
ds_read_b128 v[108:111],v4 offset:61440
v_mfma_f32_16x16x32_bf16 v[44:47],v[116:119],v[208:211],v[44:47]
buffer_load_dwordx4 v20,s[8:11],s68 offen offset:0 sc1 lds
v_mfma_f32_16x16x32_bf16 v[32:35],a[216:219],v[112:115],v[32:35]
s_add_u32 m0,s50,69632
v_mfma_f32_16x16x32_bf16 v[48:51],v[112:115],v[216:219],v[48:51]
buffer_load_dwordx4 v20,s[8:11],s69 offen offset:0 sc1 lds
v_mfma_f32_16x16x32_bf16 v[36:39],a[216:219],v[116:119],v[36:39]
s_add_u32 m0,s50,73472
v_mfma_f32_16x16x32_bf16 v[52:55],v[116:119],v[216:219],v[52:55]
buffer_load_dwordx4 v20,s[8:11],s68 offen offset:256 sc1 lds
s_waitcnt lgkmcnt(2)
v_mfma_f32_16x16x32_bf16 v[24:27],a[212:215],v[120:123],v[24:27]
ds_read_b128 v[112:115],v5 offset:57344
v_mfma_f32_16x16x32_bf16 v[40:43],v[120:123],v[212:215],v[40:43]
s_add_u32 m0,s50,77568
v_mfma_f32_16x16x32_bf16 v[28:31],a[212:215],v[124:127],v[28:31]
ds_read_b128 v[116:119],v5 offset:61440
v_mfma_f32_16x16x32_bf16 v[44:47],v[124:127],v[212:215],v[44:47]
buffer_load_dwordx4 v20,s[8:11],s69 offen offset:256 sc1 lds
v_mfma_f32_16x16x32_bf16 v[32:35],a[220:223],v[120:123],v[32:35]
s_add_u32 m0,s50,81408
v_mfma_f32_16x16x32_bf16 v[48:51],v[120:123],v[220:223],v[48:51]
buffer_load_dwordx4 v20,s[8:11],s68 offen offset:512 sc1 lds
v_mfma_f32_16x16x32_bf16 v[36:39],a[220:223],v[124:127],v[36:39]
s_add_u32 m0,s50,85504
v_mfma_f32_16x16x32_bf16 v[52:55],v[124:127],v[220:223],v[52:55]
buffer_load_dwordx4 v20,s[8:11],s69 offen offset:512 sc1 lds
s_waitcnt lgkmcnt(2)
v_mfma_f32_16x16x32_bf16 v[24:27],a[224:227],v[104:107],v[24:27]
ds_read_b128 v[120:123],v6 offset:57344
v_mfma_f32_16x16x32_bf16 v[40:43],v[104:107],v[224:227],v[40:43]
s_add_u32 m0,s50,89344
v_mfma_f32_16x16x32_bf16 v[28:31],a[224:227],v[108:111],v[28:31]
ds_read_b128 v[124:127],v6 offset:61440
v_mfma_f32_16x16x32_bf16 v[44:47],v[108:111],v[224:227],v[44:47]
buffer_load_dwordx4 v20,s[8:11],s68 offen offset:768 sc1 lds
v_mfma_f32_16x16x32_bf16 v[32:35],a[232:235],v[104:107],v[32:35]
s_add_u32 m0,s50,93440
v_mfma_f32_16x16x32_bf16 v[48:51],v[104:107],v[232:235],v[48:51]
buffer_load_dwordx4 v20,s[8:11],s69 offen offset:768 sc1 lds
v_mfma_f32_16x16x32_bf16 v[36:39],a[232:235],v[108:111],v[36:39]
s_lshl_b32 s56,s51,5
v_mfma_f32_16x16x32_bf16 v[52:55],v[108:111],v[232:235],v[52:55]
s_add_u32 s56,s56,s47
s_waitcnt lgkmcnt(2)
v_mfma_f32_16x16x32_bf16 v[24:27],a[228:231],v[112:115],v[24:27]
ds_read_b128 v[104:107],v7 offset:57344
v_mfma_f32_16x16x32_bf16 v[40:43],v[112:115],v[228:231],v[40:43]
s_lshl_b32 s56,s56,13
v_mfma_f32_16x16x32_bf16 v[28:31],a[228:231],v[116:119],v[28:31]
ds_read_b128 v[108:111],v7 offset:61440
v_mfma_f32_16x16x32_bf16 v[44:47],v[116:119],v[228:231],v[44:47]
s_add_u32 s56,s56,s50
v_mfma_f32_16x16x32_bf16 v[32:35],a[236:239],v[112:115],v[32:35]
s_add_u32 s56,s56,41943040
v_mfma_f32_16x16x32_bf16 v[48:51],v[112:115],v[236:239],v[48:51]
s_add_u32 s57,s56,4096
v_mfma_f32_16x16x32_bf16 v[36:39],a[236:239],v[116:119],v[36:39]
v_mov_b64 v[72:73],-1
v_mfma_f32_16x16x32_bf16 v[52:55],v[116:119],v[236:239],v[52:55]
v_mov_b64 v[74:75],-1
s_waitcnt lgkmcnt(2)
v_mfma_f32_16x16x32_bf16 v[24:27],a[240:243],v[120:123],v[24:27]
ds_read_b128 v[112:115],v4 offset:32768
v_mfma_f32_16x16x32_bf16 v[40:43],v[120:123],v[240:243],v[40:43]
buffer_store_dwordx4 v[72:75],v0,s[8:11],s56 offen sc1
v_mfma_f32_16x16x32_bf16 v[28:31],a[240:243],v[124:127],v[28:31]
ds_read_b128 v[116:119],v4 offset:36864
v_mfma_f32_16x16x32_bf16 v[44:47],v[124:127],v[240:243],v[44:47]
buffer_store_dwordx4 v[72:75],v0,s[8:11],s57 offen sc1
v_mfma_f32_16x16x32_bf16 v[32:35],a[248:251],v[120:123],v[32:35]
v_mfma_f32_16x16x32_bf16 v[48:51],v[120:123],v[248:251],v[48:51]
v_mfma_f32_16x16x32_bf16 v[36:39],a[248:251],v[124:127],v[36:39]
v_mfma_f32_16x16x32_bf16 v[52:55],v[124:127],v[248:251],v[52:55]
s_waitcnt lgkmcnt(2)
v_mfma_f32_16x16x32_bf16 v[24:27],a[244:247],v[104:107],v[24:27]
ds_read_b128 v[120:123],v5 offset:32768
v_mfma_f32_16x16x32_bf16 v[40:43],v[104:107],v[244:247],v[40:43]
v_mfma_f32_16x16x32_bf16 v[28:31],a[244:247],v[108:111],v[28:31]
ds_read_b128 v[124:127],v5 offset:36864
v_mfma_f32_16x16x32_bf16 v[44:47],v[108:111],v[244:247],v[44:47]
v_mfma_f32_16x16x32_bf16 v[32:35],a[252:255],v[104:107],v[32:35]
v_mfma_f32_16x16x32_bf16 v[48:51],v[104:107],v[252:255],v[48:51]
v_mfma_f32_16x16x32_bf16 v[36:39],a[252:255],v[108:111],v[36:39]
v_mfma_f32_16x16x32_bf16 v[52:55],v[108:111],v[252:255],v[52:55]
s_waitcnt lgkmcnt(2)
v_mfma_f32_16x16x32_bf16 v[88:91],a[0:3],v[112:115],0
ds_read_b128 v[104:107],v6 offset:32768
v_mfma_f32_16x16x32_bf16 v[92:95],a[0:3],v[116:119],0
v_mfma_f32_16x16x32_bf16 v[96:99],a[8:11],v[112:115],0
ds_read_b128 v[108:111],v6 offset:36864
v_mfma_f32_16x16x32_bf16 v[100:103],a[8:11],v[116:119],0
s_waitcnt lgkmcnt(2)
v_mfma_f32_16x16x32_bf16 v[88:91],a[4:7],v[120:123],v[88:91]
ds_read_b128 v[112:115],v7 offset:32768
v_mfma_f32_16x16x32_bf16 v[92:95],a[4:7],v[124:127],v[92:95]
v_cvt_pk_bf16_f32 v56,v24,v32
v_cvt_pk_bf16_f32 v57,v25,v33
v_mfma_f32_16x16x32_bf16 v[96:99],a[12:15],v[120:123],v[96:99]
ds_read_b128 v[116:119],v7 offset:36864
v_mfma_f32_16x16x32_bf16 v[100:103],a[12:15],v[124:127],v[100:103]
v_cvt_pk_bf16_f32 v58,v26,v34
v_cvt_pk_bf16_f32 v59,v27,v35
s_waitcnt lgkmcnt(2)
v_mfma_f32_16x16x32_bf16 v[88:91],a[16:19],v[104:107],v[88:91]
ds_read_b128 v[120:123],v4 offset:40960
v_mfma_f32_16x16x32_bf16 v[92:95],a[16:19],v[108:111],v[92:95]
buffer_store_dwordx4 v[56:59],v0,s[8:11],s61 offen sc1
v_cvt_pk_bf16_f32 v60,v28,v36
v_mfma_f32_16x16x32_bf16 v[96:99],a[24:27],v[104:107],v[96:99]
ds_read_b128 v[124:127],v4 offset:45056
v_mfma_f32_16x16x32_bf16 v[100:103],a[24:27],v[108:111],v[100:103]
v_cvt_pk_bf16_f32 v61,v29,v37
v_cvt_pk_bf16_f32 v62,v30,v38
s_waitcnt lgkmcnt(2)
v_mfma_f32_16x16x32_bf16 v[88:91],a[20:23],v[112:115],v[88:91]
ds_read_b128 v[104:107],v5 offset:40960
v_mfma_f32_16x16x32_bf16 v[92:95],a[20:23],v[116:119],v[92:95]
v_cvt_pk_bf16_f32 v63,v31,v39
buffer_store_dwordx4 v[60:63],v0,s[8:11],s62 offen sc1
v_mfma_f32_16x16x32_bf16 v[96:99],a[28:31],v[112:115],v[96:99]
ds_read_b128 v[108:111],v5 offset:45056
v_mfma_f32_16x16x32_bf16 v[100:103],a[28:31],v[116:119],v[100:103]
v_cvt_pk_bf16_f32 v64,v40,v41
v_cvt_pk_bf16_f32 v65,v42,v43
s_waitcnt lgkmcnt(2)
v_mfma_f32_16x16x32_bf16 v[88:91],a[32:35],v[120:123],v[88:91]
ds_read_b128 v[112:115],v6 offset:40960
v_mfma_f32_16x16x32_bf16 v[92:95],a[32:35],v[124:127],v[92:95]
v_cvt_pk_bf16_f32 v66,v44,v45
v_cvt_pk_bf16_f32 v67,v46,v47
v_mfma_f32_16x16x32_bf16 v[96:99],a[40:43],v[120:123],v[96:99]
ds_read_b128 v[116:119],v6 offset:45056
v_mfma_f32_16x16x32_bf16 v[100:103],a[40:43],v[124:127],v[100:103]
buffer_store_dwordx4 v[64:67],v0,s[8:11],s65 offen offset:0 sc1
v_cvt_pk_bf16_f32 v68,v48,v49
s_waitcnt lgkmcnt(2)
v_mfma_f32_16x16x32_bf16 v[88:91],a[36:39],v[104:107],v[88:91]
ds_read_b128 v[120:123],v7 offset:40960
v_mfma_f32_16x16x32_bf16 v[92:95],a[36:39],v[108:111],v[92:95]
v_cvt_pk_bf16_f32 v69,v50,v51
v_cvt_pk_bf16_f32 v70,v52,v53
v_mfma_f32_16x16x32_bf16 v[96:99],a[44:47],v[104:107],v[96:99]
ds_read_b128 v[124:127],v7 offset:45056
v_mfma_f32_16x16x32_bf16 v[100:103],a[44:47],v[108:111],v[100:103]
v_cvt_pk_bf16_f32 v71,v54,v55
buffer_store_dwordx4 v[68:71],v0,s[8:11],s65 offen offset:1024 sc1
s_waitcnt lgkmcnt(2)
v_mfma_f32_16x16x32_bf16 v[88:91],a[48:51],v[112:115],v[88:91]
ds_read_b128 v[104:107],v4 offset:49152
v_mfma_f32_16x16x32_bf16 v[92:95],a[48:51],v[116:119],v[92:95]
v_mfma_f32_16x16x32_bf16 v[96:99],a[56:59],v[112:115],v[96:99]
ds_read_b128 v[108:111],v4 offset:53248
v_mfma_f32_16x16x32_bf16 v[100:103],a[56:59],v[116:119],v[100:103]
s_waitcnt lgkmcnt(2)
v_mfma_f32_16x16x32_bf16 v[88:91],a[52:55],v[120:123],v[88:91]
ds_read_b128 v[112:115],v5 offset:49152
v_mfma_f32_16x16x32_bf16 v[92:95],a[52:55],v[124:127],v[92:95]
v_mfma_f32_16x16x32_bf16 v[96:99],a[60:63],v[120:123],v[96:99]
ds_read_b128 v[116:119],v5 offset:53248
v_mfma_f32_16x16x32_bf16 v[100:103],a[60:63],v[124:127],v[100:103]
s_waitcnt lgkmcnt(2)
v_mfma_f32_16x16x32_bf16 v[88:91],a[64:67],v[104:107],v[88:91]
ds_read_b128 v[120:123],v6 offset:49152
v_mfma_f32_16x16x32_bf16 v[92:95],a[64:67],v[108:111],v[92:95]
v_mfma_f32_16x16x32_bf16 v[96:99],a[72:75],v[104:107],v[96:99]
ds_read_b128 v[124:127],v6 offset:53248
v_mfma_f32_16x16x32_bf16 v[100:103],a[72:75],v[108:111],v[100:103]
s_waitcnt lgkmcnt(2)
v_mfma_f32_16x16x32_bf16 v[88:91],a[68:71],v[112:115],v[88:91]
ds_read_b128 v[104:107],v7 offset:49152
v_mfma_f32_16x16x32_bf16 v[92:95],a[68:71],v[116:119],v[92:95]
v_mfma_f32_16x16x32_bf16 v[96:99],a[76:79],v[112:115],v[96:99]
ds_read_b128 v[108:111],v7 offset:53248
v_mfma_f32_16x16x32_bf16 v[100:103],a[76:79],v[116:119],v[100:103]
s_waitcnt lgkmcnt(2)
v_mfma_f32_16x16x32_bf16 v[88:91],a[80:83],v[120:123],v[88:91]
ds_read_b128 v[112:115],v4 offset:57344
v_mfma_f32_16x16x32_bf16 v[92:95],a[80:83],v[124:127],v[92:95]
v_mfma_f32_16x16x32_bf16 v[96:99],a[88:91],v[120:123],v[96:99]
ds_read_b128 v[116:119],v4 offset:61440
v_mfma_f32_16x16x32_bf16 v[100:103],a[88:91],v[124:127],v[100:103]
s_waitcnt lgkmcnt(2)
v_mfma_f32_16x16x32_bf16 v[88:91],a[84:87],v[104:107],v[88:91]
ds_read_b128 v[120:123],v5 offset:57344
v_mfma_f32_16x16x32_bf16 v[92:95],a[84:87],v[108:111],v[92:95]
v_mfma_f32_16x16x32_bf16 v[96:99],a[92:95],v[104:107],v[96:99]
ds_read_b128 v[124:127],v5 offset:61440
v_mfma_f32_16x16x32_bf16 v[100:103],a[92:95],v[108:111],v[100:103]
s_waitcnt lgkmcnt(2)
v_mfma_f32_16x16x32_bf16 v[88:91],a[96:99],v[112:115],v[88:91]
ds_read_b128 v[104:107],v6 offset:57344
v_mfma_f32_16x16x32_bf16 v[92:95],a[96:99],v[116:119],v[92:95]
v_mfma_f32_16x16x32_bf16 v[96:99],a[104:107],v[112:115],v[96:99]
ds_read_b128 v[108:111],v6 offset:61440
v_mfma_f32_16x16x32_bf16 v[100:103],a[104:107],v[116:119],v[100:103]
s_waitcnt lgkmcnt(2)
v_mfma_f32_16x16x32_bf16 v[88:91],a[100:103],v[120:123],v[88:91]
ds_read_b128 v[112:115],v7 offset:57344
v_mfma_f32_16x16x32_bf16 v[92:95],a[100:103],v[124:127],v[92:95]
v_mfma_f32_16x16x32_bf16 v[96:99],a[108:111],v[120:123],v[96:99]
ds_read_b128 v[116:119],v7 offset:61440
v_mfma_f32_16x16x32_bf16 v[100:103],a[108:111],v[124:127],v[100:103]
s_waitcnt lgkmcnt(2)
v_mfma_f32_16x16x32_bf16 v[88:91],a[112:115],v[104:107],v[88:91]
v_mfma_f32_16x16x32_bf16 v[92:95],a[112:115],v[108:111],v[92:95]
v_mfma_f32_16x16x32_bf16 v[96:99],a[120:123],v[104:107],v[96:99]
v_mfma_f32_16x16x32_bf16 v[100:103],a[120:123],v[108:111],v[100:103]
s_waitcnt lgkmcnt(0)
v_mfma_f32_16x16x32_bf16 v[88:91],a[116:119],v[112:115],v[88:91]
v_mfma_f32_16x16x32_bf16 v[92:95],a[116:119],v[116:119],v[92:95]
v_mfma_f32_16x16x32_bf16 v[96:99],a[124:127],v[112:115],v[96:99]
v_mfma_f32_16x16x32_bf16 v[100:103],a[124:127],v[116:119],v[100:103]
s_nop 3
v_cvt_pk_bf16_f32 v104,v88,v96
v_cvt_pk_bf16_f32 v105,v89,v97
v_cvt_pk_bf16_f32 v106,v90,v98
v_cvt_pk_bf16_f32 v107,v91,v99
v_cvt_pk_bf16_f32 v108,v92,v100
v_cvt_pk_bf16_f32 v109,v93,v101
v_cvt_pk_bf16_f32 v110,v94,v102
v_cvt_pk_bf16_f32 v111,v95,v103
buffer_store_dwordx4 v[104:107],v0,s[8:11],s63 offen sc1
buffer_store_dwordx4 v[108:111],v0,s[8:11],s64 offen sc1
s_waitcnt vmcnt(6)
s_barrier
s_lshl_b32 s70,s51,13
s_lshl2_add_u32 s70,s47,s70
s_add_u32 s70,s70,10485760
s_mov_b32 s51,s55
s_ff1_i32_b64 s55,s[72:73]
s_bitset0_b64 s[72:73],s55
s_min_u32 s55,s55,127
s_lshl_b32 s68,s55,15
s_add_u32 s68,s68,0
s_add_u32 s69,s68,16384
s_lshl_b32 s58,s51,5
s_add_u32 s58,s58,s47
s_mul_i32 s58,s58,24576
s_add_u32 s58,s58,100663296
s_add_u32 s61,s58,s50
s_add_u32 s62,s61,4096
s_add_u32 s63,s61,16384
s_add_u32 s64,s61,20480
s_add_u32 s65,s61,s50
s_add_u32 s65,s65,8192
ds_read_b128 v[104:107],v4 offset:0
ds_read_b128 v[108:111],v4 offset:4096
ds_read_b128 v[112:115],v5 offset:0
ds_read_b128 v[116:119],v5 offset:4096
s_waitcnt lgkmcnt(2)
v_mfma_f32_16x16x32_bf16 v[24:27],a[128:131],v[104:107],0
ds_read_b128 v[120:123],v6 offset:0
v_mfma_f32_16x16x32_bf16 v[40:43],v[104:107],v[128:131],0
v_mfma_f32_16x16x32_bf16 v[28:31],a[128:131],v[108:111],0
ds_read_b128 v[124:127],v6 offset:4096
v_mfma_f32_16x16x32_bf16 v[44:47],v[108:111],v[128:131],0
v_mfma_f32_16x16x32_bf16 v[32:35],a[136:139],v[104:107],0
v_mfma_f32_16x16x32_bf16 v[48:51],v[104:107],v[136:139],0
v_mfma_f32_16x16x32_bf16 v[36:39],a[136:139],v[108:111],0
v_mfma_f32_16x16x32_bf16 v[52:55],v[108:111],v[136:139],0
s_waitcnt lgkmcnt(2)
v_mfma_f32_16x16x32_bf16 v[24:27],a[132:135],v[112:115],v[24:27]
ds_read_b128 v[104:107],v7 offset:0
v_mfma_f32_16x16x32_bf16 v[40:43],v[112:115],v[132:135],v[40:43]
v_mfma_f32_16x16x32_bf16 v[28:31],a[132:135],v[116:119],v[28:31]
ds_read_b128 v[108:111],v7 offset:4096
v_mfma_f32_16x16x32_bf16 v[44:47],v[116:119],v[132:135],v[44:47]
v_mfma_f32_16x16x32_bf16 v[32:35],a[140:143],v[112:115],v[32:35]
v_mfma_f32_16x16x32_bf16 v[48:51],v[112:115],v[140:143],v[48:51]
v_mfma_f32_16x16x32_bf16 v[36:39],a[140:143],v[116:119],v[36:39]
v_mfma_f32_16x16x32_bf16 v[52:55],v[116:119],v[140:143],v[52:55]
s_waitcnt lgkmcnt(2)
v_mfma_f32_16x16x32_bf16 v[24:27],a[144:147],v[120:123],v[24:27]
ds_read_b128 v[112:115],v4 offset:8192
v_mfma_f32_16x16x32_bf16 v[40:43],v[120:123],v[144:147],v[40:43]
v_mfma_f32_16x16x32_bf16 v[28:31],a[144:147],v[124:127],v[28:31]
ds_read_b128 v[116:119],v4 offset:12288
v_mfma_f32_16x16x32_bf16 v[44:47],v[124:127],v[144:147],v[44:47]
v_mfma_f32_16x16x32_bf16 v[32:35],a[152:155],v[120:123],v[32:35]
v_mfma_f32_16x16x32_bf16 v[48:51],v[120:123],v[152:155],v[48:51]
v_mfma_f32_16x16x32_bf16 v[36:39],a[152:155],v[124:127],v[36:39]
v_mfma_f32_16x16x32_bf16 v[52:55],v[124:127],v[152:155],v[52:55]
s_waitcnt lgkmcnt(2)
v_mfma_f32_16x16x32_bf16 v[24:27],a[148:151],v[104:107],v[24:27]
ds_read_b128 v[120:123],v5 offset:8192
v_mfma_f32_16x16x32_bf16 v[40:43],v[104:107],v[148:151],v[40:43]
v_mfma_f32_16x16x32_bf16 v[28:31],a[148:151],v[108:111],v[28:31]
ds_read_b128 v[124:127],v5 offset:12288
v_mfma_f32_16x16x32_bf16 v[44:47],v[108:111],v[148:151],v[44:47]
v_mfma_f32_16x16x32_bf16 v[32:35],a[156:159],v[104:107],v[32:35]
v_mfma_f32_16x16x32_bf16 v[48:51],v[104:107],v[156:159],v[48:51]
v_mfma_f32_16x16x32_bf16 v[36:39],a[156:159],v[108:111],v[36:39]
v_mfma_f32_16x16x32_bf16 v[52:55],v[108:111],v[156:159],v[52:55]
s_waitcnt lgkmcnt(2)
v_mfma_f32_16x16x32_bf16 v[24:27],a[160:163],v[112:115],v[24:27]
ds_read_b128 v[104:107],v6 offset:8192
v_mfma_f32_16x16x32_bf16 v[40:43],v[112:115],v[160:163],v[40:43]
v_mfma_f32_16x16x32_bf16 v[28:31],a[160:163],v[116:119],v[28:31]
ds_read_b128 v[108:111],v6 offset:12288
v_mfma_f32_16x16x32_bf16 v[44:47],v[116:119],v[160:163],v[44:47]
v_mfma_f32_16x16x32_bf16 v[32:35],a[168:171],v[112:115],v[32:35]
v_mfma_f32_16x16x32_bf16 v[48:51],v[112:115],v[168:171],v[48:51]
v_mfma_f32_16x16x32_bf16 v[36:39],a[168:171],v[116:119],v[36:39]
v_mfma_f32_16x16x32_bf16 v[52:55],v[116:119],v[168:171],v[52:55]
s_waitcnt lgkmcnt(2)
v_mfma_f32_16x16x32_bf16 v[24:27],a[164:167],v[120:123],v[24:27]
ds_read_b128 v[112:115],v7 offset:8192
v_mfma_f32_16x16x32_bf16 v[40:43],v[120:123],v[164:167],v[40:43]
v_mfma_f32_16x16x32_bf16 v[28:31],a[164:167],v[124:127],v[28:31]
ds_read_b128 v[116:119],v7 offset:12288
v_mfma_f32_16x16x32_bf16 v[44:47],v[124:127],v[164:167],v[44:47]
v_mfma_f32_16x16x32_bf16 v[32:35],a[172:175],v[120:123],v[32:35]
v_mfma_f32_16x16x32_bf16 v[48:51],v[120:123],v[172:175],v[48:51]
v_mfma_f32_16x16x32_bf16 v[36:39],a[172:175],v[124:127],v[36:39]
v_mfma_f32_16x16x32_bf16 v[52:55],v[124:127],v[172:175],v[52:55]
s_waitcnt lgkmcnt(2)
v_mfma_f32_16x16x32_bf16 v[24:27],a[176:179],v[104:107],v[24:27]
ds_read_b128 v[120:123],v4 offset:16384
v_mfma_f32_16x16x32_bf16 v[40:43],v[104:107],v[176:179],v[40:43]
v_mfma_f32_16x16x32_bf16 v[28:31],a[176:179],v[108:111],v[28:31]
ds_read_b128 v[124:127],v4 offset:20480
v_mfma_f32_16x16x32_bf16 v[44:47],v[108:111],v[176:179],v[44:47]
v_mfma_f32_16x16x32_bf16 v[32:35],a[184:187],v[104:107],v[32:35]
v_mfma_f32_16x16x32_bf16 v[48:51],v[104:107],v[184:187],v[48:51]
v_mfma_f32_16x16x32_bf16 v[36:39],a[184:187],v[108:111],v[36:39]
v_mfma_f32_16x16x32_bf16 v[52:55],v[108:111],v[184:187],v[52:55]
s_waitcnt lgkmcnt(2)
v_mfma_f32_16x16x32_bf16 v[24:27],a[180:183],v[112:115],v[24:27]
ds_read_b128 v[104:107],v5 offset:16384
v_mfma_f32_16x16x32_bf16 v[40:43],v[112:115],v[180:183],v[40:43]
v_mfma_f32_16x16x32_bf16 v[28:31],a[180:183],v[116:119],v[28:31]
ds_read_b128 v[108:111],v5 offset:20480
v_mfma_f32_16x16x32_bf16 v[44:47],v[116:119],v[180:183],v[44:47]
v_mfma_f32_16x16x32_bf16 v[32:35],a[188:191],v[112:115],v[32:35]
v_mfma_f32_16x16x32_bf16 v[48:51],v[112:115],v[188:191],v[48:51]
v_mfma_f32_16x16x32_bf16 v[36:39],a[188:191],v[116:119],v[36:39]
v_mfma_f32_16x16x32_bf16 v[52:55],v[116:119],v[188:191],v[52:55]
s_waitcnt lgkmcnt(2)
v_mfma_f32_16x16x32_bf16 v[24:27],a[192:195],v[120:123],v[24:27]
ds_read_b128 v[112:115],v6 offset:16384
v_mfma_f32_16x16x32_bf16 v[40:43],v[120:123],v[192:195],v[40:43]
v_mfma_f32_16x16x32_bf16 v[28:31],a[192:195],v[124:127],v[28:31]
ds_read_b128 v[116:119],v6 offset:20480
v_mfma_f32_16x16x32_bf16 v[44:47],v[124:127],v[192:195],v[44:47]
v_mfma_f32_16x16x32_bf16 v[32:35],a[200:203],v[120:123],v[32:35]
v_mfma_f32_16x16x32_bf16 v[48:51],v[120:123],v[200:203],v[48:51]
v_mfma_f32_16x16x32_bf16 v[36:39],a[200:203],v[124:127],v[36:39]
v_mfma_f32_16x16x32_bf16 v[52:55],v[124:127],v[200:203],v[52:55]
s_waitcnt lgkmcnt(2)
v_mfma_f32_16x16x32_bf16 v[24:27],a[196:199],v[104:107],v[24:27]
ds_read_b128 v[120:123],v7 offset:16384
v_mfma_f32_16x16x32_bf16 v[40:43],v[104:107],v[196:199],v[40:43]
v_mfma_f32_16x16x32_bf16 v[28:31],a[196:199],v[108:111],v[28:31]
ds_read_b128 v[124:127],v7 offset:20480
v_mfma_f32_16x16x32_bf16 v[44:47],v[108:111],v[196:199],v[44:47]
v_mfma_f32_16x16x32_bf16 v[32:35],a[204:207],v[104:107],v[32:35]
v_mfma_f32_16x16x32_bf16 v[48:51],v[104:107],v[204:207],v[48:51]
v_mfma_f32_16x16x32_bf16 v[36:39],a[204:207],v[108:111],v[36:39]
v_mfma_f32_16x16x32_bf16 v[52:55],v[108:111],v[204:207],v[52:55]
s_waitcnt vmcnt(0)
s_barrier
s_or_b32 s70,s70,s52
buffer_store_dword v17,off,s[8:11],s70 sc1
s_waitcnt lgkmcnt(2)
v_mfma_f32_16x16x32_bf16 v[24:27],a[208:211],v[112:115],v[24:27]
ds_read_b128 v[104:107],v4 offset:24576
v_mfma_f32_16x16x32_bf16 v[40:43],v[112:115],v[208:211],v[40:43]
s_add_u32 m0,s50,98304
v_mfma_f32_16x16x32_bf16 v[28:31],a[208:211],v[116:119],v[28:31]
ds_read_b128 v[108:111],v4 offset:28672
v_mfma_f32_16x16x32_bf16 v[44:47],v[116:119],v[208:211],v[44:47]
buffer_load_dwordx4 v20,s[8:11],s68 offen offset:0 sc1 lds
v_mfma_f32_16x16x32_bf16 v[32:35],a[216:219],v[112:115],v[32:35]
s_add_u32 m0,s50,102400
v_mfma_f32_16x16x32_bf16 v[48:51],v[112:115],v[216:219],v[48:51]
buffer_load_dwordx4 v20,s[8:11],s69 offen offset:0 sc1 lds
v_mfma_f32_16x16x32_bf16 v[36:39],a[216:219],v[116:119],v[36:39]
s_add_u32 m0,s50,106240
v_mfma_f32_16x16x32_bf16 v[52:55],v[116:119],v[216:219],v[52:55]
buffer_load_dwordx4 v20,s[8:11],s68 offen offset:256 sc1 lds
s_waitcnt lgkmcnt(2)
v_mfma_f32_16x16x32_bf16 v[24:27],a[212:215],v[120:123],v[24:27]
ds_read_b128 v[112:115],v5 offset:24576
v_mfma_f32_16x16x32_bf16 v[40:43],v[120:123],v[212:215],v[40:43]
s_add_u32 m0,s50,110336
v_mfma_f32_16x16x32_bf16 v[28:31],a[212:215],v[124:127],v[28:31]
ds_read_b128 v[116:119],v5 offset:28672
v_mfma_f32_16x16x32_bf16 v[44:47],v[124:127],v[212:215],v[44:47]
buffer_load_dwordx4 v20,s[8:11],s69 offen offset:256 sc1 lds
v_mfma_f32_16x16x32_bf16 v[32:35],a[220:223],v[120:123],v[32:35]
s_add_u32 m0,s50,114176
v_mfma_f32_16x16x32_bf16 v[48:51],v[120:123],v[220:223],v[48:51]
buffer_load_dwordx4 v20,s[8:11],s68 offen offset:512 sc1 lds
v_mfma_f32_16x16x32_bf16 v[36:39],a[220:223],v[124:127],v[36:39]
s_add_u32 m0,s50,118272
v_mfma_f32_16x16x32_bf16 v[52:55],v[124:127],v[220:223],v[52:55]
buffer_load_dwordx4 v20,s[8:11],s69 offen offset:512 sc1 lds
s_waitcnt lgkmcnt(2)
v_mfma_f32_16x16x32_bf16 v[24:27],a[224:227],v[104:107],v[24:27]
ds_read_b128 v[120:123],v6 offset:24576
v_mfma_f32_16x16x32_bf16 v[40:43],v[104:107],v[224:227],v[40:43]
s_add_u32 m0,s50,122112
v_mfma_f32_16x16x32_bf16 v[28:31],a[224:227],v[108:111],v[28:31]
ds_read_b128 v[124:127],v6 offset:28672
v_mfma_f32_16x16x32_bf16 v[44:47],v[108:111],v[224:227],v[44:47]
buffer_load_dwordx4 v20,s[8:11],s68 offen offset:768 sc1 lds
v_mfma_f32_16x16x32_bf16 v[32:35],a[232:235],v[104:107],v[32:35]
s_add_u32 m0,s50,126208
v_mfma_f32_16x16x32_bf16 v[48:51],v[104:107],v[232:235],v[48:51]
buffer_load_dwordx4 v20,s[8:11],s69 offen offset:768 sc1 lds
v_mfma_f32_16x16x32_bf16 v[36:39],a[232:235],v[108:111],v[36:39]
s_lshl_b32 s56,s51,5
v_mfma_f32_16x16x32_bf16 v[52:55],v[108:111],v[232:235],v[52:55]
s_add_u32 s56,s56,s47
s_waitcnt lgkmcnt(2)
v_mfma_f32_16x16x32_bf16 v[24:27],a[228:231],v[112:115],v[24:27]
ds_read_b128 v[104:107],v7 offset:24576
v_mfma_f32_16x16x32_bf16 v[40:43],v[112:115],v[228:231],v[40:43]
s_lshl_b32 s56,s56,13
v_mfma_f32_16x16x32_bf16 v[28:31],a[228:231],v[116:119],v[28:31]
ds_read_b128 v[108:111],v7 offset:28672
v_mfma_f32_16x16x32_bf16 v[44:47],v[116:119],v[228:231],v[44:47]
s_add_u32 s56,s56,s50
v_mfma_f32_16x16x32_bf16 v[32:35],a[236:239],v[112:115],v[32:35]
s_add_u32 s56,s56,41943040
v_mfma_f32_16x16x32_bf16 v[48:51],v[112:115],v[236:239],v[48:51]
s_add_u32 s57,s56,4096
v_mfma_f32_16x16x32_bf16 v[36:39],a[236:239],v[116:119],v[36:39]
v_mov_b64 v[72:73],-1
v_mfma_f32_16x16x32_bf16 v[52:55],v[116:119],v[236:239],v[52:55]
v_mov_b64 v[74:75],-1
s_waitcnt lgkmcnt(2)
v_mfma_f32_16x16x32_bf16 v[24:27],a[240:243],v[120:123],v[24:27]
ds_read_b128 v[112:115],v4 offset:0
v_mfma_f32_16x16x32_bf16 v[40:43],v[120:123],v[240:243],v[40:43]
buffer_store_dwordx4 v[72:75],v0,s[8:11],s56 offen sc1
v_mfma_f32_16x16x32_bf16 v[28:31],a[240:243],v[124:127],v[28:31]
ds_read_b128 v[116:119],v4 offset:4096
v_mfma_f32_16x16x32_bf16 v[44:47],v[124:127],v[240:243],v[44:47]
buffer_store_dwordx4 v[72:75],v0,s[8:11],s57 offen sc1
v_mfma_f32_16x16x32_bf16 v[32:35],a[248:251],v[120:123],v[32:35]
v_mfma_f32_16x16x32_bf16 v[48:51],v[120:123],v[248:251],v[48:51]
v_mfma_f32_16x16x32_bf16 v[36:39],a[248:251],v[124:127],v[36:39]
v_mfma_f32_16x16x32_bf16 v[52:55],v[124:127],v[248:251],v[52:55]
s_waitcnt lgkmcnt(2)
v_mfma_f32_16x16x32_bf16 v[24:27],a[244:247],v[104:107],v[24:27]
ds_read_b128 v[120:123],v5 offset:0
v_mfma_f32_16x16x32_bf16 v[40:43],v[104:107],v[244:247],v[40:43]
v_mfma_f32_16x16x32_bf16 v[28:31],a[244:247],v[108:111],v[28:31]
ds_read_b128 v[124:127],v5 offset:4096
v_mfma_f32_16x16x32_bf16 v[44:47],v[108:111],v[244:247],v[44:47]
v_mfma_f32_16x16x32_bf16 v[32:35],a[252:255],v[104:107],v[32:35]
v_mfma_f32_16x16x32_bf16 v[48:51],v[104:107],v[252:255],v[48:51]
v_mfma_f32_16x16x32_bf16 v[36:39],a[252:255],v[108:111],v[36:39]
v_mfma_f32_16x16x32_bf16 v[52:55],v[108:111],v[252:255],v[52:55]
s_waitcnt lgkmcnt(2)
v_mfma_f32_16x16x32_bf16 v[88:91],a[0:3],v[112:115],0
ds_read_b128 v[104:107],v6 offset:0
v_mfma_f32_16x16x32_bf16 v[92:95],a[0:3],v[116:119],0
v_mfma_f32_16x16x32_bf16 v[96:99],a[8:11],v[112:115],0
ds_read_b128 v[108:111],v6 offset:4096
v_mfma_f32_16x16x32_bf16 v[100:103],a[8:11],v[116:119],0
s_waitcnt lgkmcnt(2)
v_mfma_f32_16x16x32_bf16 v[88:91],a[4:7],v[120:123],v[88:91]
ds_read_b128 v[112:115],v7 offset:0
v_mfma_f32_16x16x32_bf16 v[92:95],a[4:7],v[124:127],v[92:95]
v_cvt_pk_bf16_f32 v56,v24,v32
v_cvt_pk_bf16_f32 v57,v25,v33
v_mfma_f32_16x16x32_bf16 v[96:99],a[12:15],v[120:123],v[96:99]
ds_read_b128 v[116:119],v7 offset:4096
v_mfma_f32_16x16x32_bf16 v[100:103],a[12:15],v[124:127],v[100:103]
v_cvt_pk_bf16_f32 v58,v26,v34
v_cvt_pk_bf16_f32 v59,v27,v35
s_waitcnt lgkmcnt(2)
v_mfma_f32_16x16x32_bf16 v[88:91],a[16:19],v[104:107],v[88:91]
ds_read_b128 v[120:123],v4 offset:8192
v_mfma_f32_16x16x32_bf16 v[92:95],a[16:19],v[108:111],v[92:95]
buffer_store_dwordx4 v[56:59],v0,s[8:11],s61 offen sc1
v_cvt_pk_bf16_f32 v60,v28,v36
v_mfma_f32_16x16x32_bf16 v[96:99],a[24:27],v[104:107],v[96:99]
ds_read_b128 v[124:127],v4 offset:12288
v_mfma_f32_16x16x32_bf16 v[100:103],a[24:27],v[108:111],v[100:103]
v_cvt_pk_bf16_f32 v61,v29,v37
v_cvt_pk_bf16_f32 v62,v30,v38
s_waitcnt lgkmcnt(2)
v_mfma_f32_16x16x32_bf16 v[88:91],a[20:23],v[112:115],v[88:91]
ds_read_b128 v[104:107],v5 offset:8192
v_mfma_f32_16x16x32_bf16 v[92:95],a[20:23],v[116:119],v[92:95]
v_cvt_pk_bf16_f32 v63,v31,v39
buffer_store_dwordx4 v[60:63],v0,s[8:11],s62 offen sc1
v_mfma_f32_16x16x32_bf16 v[96:99],a[28:31],v[112:115],v[96:99]
ds_read_b128 v[108:111],v5 offset:12288
v_mfma_f32_16x16x32_bf16 v[100:103],a[28:31],v[116:119],v[100:103]
v_cvt_pk_bf16_f32 v64,v40,v41
v_cvt_pk_bf16_f32 v65,v42,v43
s_waitcnt lgkmcnt(2)
v_mfma_f32_16x16x32_bf16 v[88:91],a[32:35],v[120:123],v[88:91]
ds_read_b128 v[112:115],v6 offset:8192
v_mfma_f32_16x16x32_bf16 v[92:95],a[32:35],v[124:127],v[92:95]
v_cvt_pk_bf16_f32 v66,v44,v45
v_cvt_pk_bf16_f32 v67,v46,v47
v_mfma_f32_16x16x32_bf16 v[96:99],a[40:43],v[120:123],v[96:99]
ds_read_b128 v[116:119],v6 offset:12288
v_mfma_f32_16x16x32_bf16 v[100:103],a[40:43],v[124:127],v[100:103]
buffer_store_dwordx4 v[64:67],v0,s[8:11],s65 offen offset:0 sc1
v_cvt_pk_bf16_f32 v68,v48,v49
s_waitcnt lgkmcnt(2)
v_mfma_f32_16x16x32_bf16 v[88:91],a[36:39],v[104:107],v[88:91]
ds_read_b128 v[120:123],v7 offset:8192
v_mfma_f32_16x16x32_bf16 v[92:95],a[36:39],v[108:111],v[92:95]
v_cvt_pk_bf16_f32 v69,v50,v51
v_cvt_pk_bf16_f32 v70,v52,v53
v_mfma_f32_16x16x32_bf16 v[96:99],a[44:47],v[104:107],v[96:99]
ds_read_b128 v[124:127],v7 offset:12288
v_mfma_f32_16x16x32_bf16 v[100:103],a[44:47],v[108:111],v[100:103]
v_cvt_pk_bf16_f32 v71,v54,v55
buffer_store_dwordx4 v[68:71],v0,s[8:11],s65 offen offset:1024 sc1
s_waitcnt lgkmcnt(2)
v_mfma_f32_16x16x32_bf16 v[88:91],a[48:51],v[112:115],v[88:91]
ds_read_b128 v[104:107],v4 offset:16384
v_mfma_f32_16x16x32_bf16 v[92:95],a[48:51],v[116:119],v[92:95]
v_mfma_f32_16x16x32_bf16 v[96:99],a[56:59],v[112:115],v[96:99]
ds_read_b128 v[108:111],v4 offset:20480
v_mfma_f32_16x16x32_bf16 v[100:103],a[56:59],v[116:119],v[100:103]
s_waitcnt lgkmcnt(2)
v_mfma_f32_16x16x32_bf16 v[88:91],a[52:55],v[120:123],v[88:91]
ds_read_b128 v[112:115],v5 offset:16384
v_mfma_f32_16x16x32_bf16 v[92:95],a[52:55],v[124:127],v[92:95]
v_mfma_f32_16x16x32_bf16 v[96:99],a[60:63],v[120:123],v[96:99]
ds_read_b128 v[116:119],v5 offset:20480
v_mfma_f32_16x16x32_bf16 v[100:103],a[60:63],v[124:127],v[100:103]
s_waitcnt lgkmcnt(2)
v_mfma_f32_16x16x32_bf16 v[88:91],a[64:67],v[104:107],v[88:91]
ds_read_b128 v[120:123],v6 offset:16384
v_mfma_f32_16x16x32_bf16 v[92:95],a[64:67],v[108:111],v[92:95]
v_mfma_f32_16x16x32_bf16 v[96:99],a[72:75],v[104:107],v[96:99]
ds_read_b128 v[124:127],v6 offset:20480
v_mfma_f32_16x16x32_bf16 v[100:103],a[72:75],v[108:111],v[100:103]
s_waitcnt lgkmcnt(2)
v_mfma_f32_16x16x32_bf16 v[88:91],a[68:71],v[112:115],v[88:91]
ds_read_b128 v[104:107],v7 offset:16384
v_mfma_f32_16x16x32_bf16 v[92:95],a[68:71],v[116:119],v[92:95]
v_mfma_f32_16x16x32_bf16 v[96:99],a[76:79],v[112:115],v[96:99]
ds_read_b128 v[108:111],v7 offset:20480
v_mfma_f32_16x16x32_bf16 v[100:103],a[76:79],v[116:119],v[100:103]
s_waitcnt lgkmcnt(2)
v_mfma_f32_16x16x32_bf16 v[88:91],a[80:83],v[120:123],v[88:91]
ds_read_b128 v[112:115],v4 offset:24576
v_mfma_f32_16x16x32_bf16 v[92:95],a[80:83],v[124:127],v[92:95]
v_mfma_f32_16x16x32_bf16 v[96:99],a[88:91],v[120:123],v[96:99]
ds_read_b128 v[116:119],v4 offset:28672
v_mfma_f32_16x16x32_bf16 v[100:103],a[88:91],v[124:127],v[100:103]
s_waitcnt lgkmcnt(2)
v_mfma_f32_16x16x32_bf16 v[88:91],a[84:87],v[104:107],v[88:91]
ds_read_b128 v[120:123],v5 offset:24576
v_mfma_f32_16x16x32_bf16 v[92:95],a[84:87],v[108:111],v[92:95]
v_mfma_f32_16x16x32_bf16 v[96:99],a[92:95],v[104:107],v[96:99]
ds_read_b128 v[124:127],v5 offset:28672
v_mfma_f32_16x16x32_bf16 v[100:103],a[92:95],v[108:111],v[100:103]
s_waitcnt lgkmcnt(2)
v_mfma_f32_16x16x32_bf16 v[88:91],a[96:99],v[112:115],v[88:91]
ds_read_b128 v[104:107],v6 offset:24576
v_mfma_f32_16x16x32_bf16 v[92:95],a[96:99],v[116:119],v[92:95]
v_mfma_f32_16x16x32_bf16 v[96:99],a[104:107],v[112:115],v[96:99]
ds_read_b128 v[108:111],v6 offset:28672
v_mfma_f32_16x16x32_bf16 v[100:103],a[104:107],v[116:119],v[100:103]
s_waitcnt lgkmcnt(2)
v_mfma_f32_16x16x32_bf16 v[88:91],a[100:103],v[120:123],v[88:91]
ds_read_b128 v[112:115],v7 offset:24576
v_mfma_f32_16x16x32_bf16 v[92:95],a[100:103],v[124:127],v[92:95]
v_mfma_f32_16x16x32_bf16 v[96:99],a[108:111],v[120:123],v[96:99]
ds_read_b128 v[116:119],v7 offset:28672
v_mfma_f32_16x16x32_bf16 v[100:103],a[108:111],v[124:127],v[100:103]
s_waitcnt lgkmcnt(2)
v_mfma_f32_16x16x32_bf16 v[88:91],a[112:115],v[104:107],v[88:91]
v_mfma_f32_16x16x32_bf16 v[92:95],a[112:115],v[108:111],v[92:95]
v_mfma_f32_16x16x32_bf16 v[96:99],a[120:123],v[104:107],v[96:99]
v_mfma_f32_16x16x32_bf16 v[100:103],a[120:123],v[108:111],v[100:103]
s_waitcnt lgkmcnt(0)
v_mfma_f32_16x16x32_bf16 v[88:91],a[116:119],v[112:115],v[88:91]
v_mfma_f32_16x16x32_bf16 v[92:95],a[116:119],v[116:119],v[92:95]
v_mfma_f32_16x16x32_bf16 v[96:99],a[124:127],v[112:115],v[96:99]
v_mfma_f32_16x16x32_bf16 v[100:103],a[124:127],v[116:119],v[100:103]
s_nop 3
v_cvt_pk_bf16_f32 v104,v88,v96
v_cvt_pk_bf16_f32 v105,v89,v97
v_cvt_pk_bf16_f32 v106,v90,v98
v_cvt_pk_bf16_f32 v107,v91,v99
v_cvt_pk_bf16_f32 v108,v92,v100
v_cvt_pk_bf16_f32 v109,v93,v101
v_cvt_pk_bf16_f32 v110,v94,v102
v_cvt_pk_bf16_f32 v111,v95,v103
buffer_store_dwordx4 v[104:107],v0,s[8:11],s63 offen sc1
buffer_store_dwordx4 v[108:111],v0,s[8:11],s64 offen sc1
s_waitcnt vmcnt(6)
s_barrier
s_lshl_b32 s70,s51,13
s_lshl2_add_u32 s70,s47,s70
s_add_u32 s70,s70,10485760
s_sub_u32 s53,s53,1
s_cmp_gt_u32 s53,0
s_cbranch_scc1 L_pu_12
s_waitcnt vmcnt(0)
s_barrier
s_or_b32 s70,s70,s52
buffer_store_dword v17,off,s[8:11],s70 sc1
s_mov_b32 s70,0x80000000
L_pl_13:
s_mov_b32 s51,s54
s_lshl_b32 s66,s54,15
s_add_u32 s66,s66,2097152
s_add_u32 s67,s66,16384
s_lshl_b32 s59,s51,13
s_add_u32 s59,s59,10487552
v_and_b32 v124,31,v1
v_lshlrev_b32 v124,2,v124
L_fw_15:
buffer_load_dword v125,v124,s[8:11],s59 offen sc1
s_sub_u32 s49,s49,1
s_cbranch_scc1 L_abort
s_waitcnt vmcnt(0)
v_cmp_eq_u32 vcc,0,v125
s_cbranch_vccnz L_fw_15
s_add_u32 m0,s50,65536
s_nop 0
buffer_load_dwordx4 v20,s[8:11],s66 offen offset:0 sc1 lds
s_add_u32 m0,s50,69632
s_nop 0
buffer_load_dwordx4 v20,s[8:11],s67 offen offset:0 sc1 lds
s_add_u32 m0,s50,73472
s_nop 0
buffer_load_dwordx4 v20,s[8:11],s66 offen offset:256 sc1 lds
s_add_u32 m0,s50,77568
s_nop 0
buffer_load_dwordx4 v20,s[8:11],s67 offen offset:256 sc1 lds
s_add_u32 m0,s50,81408
s_nop 0
buffer_load_dwordx4 v20,s[8:11],s66 offen offset:512 sc1 lds
s_add_u32 m0,s50,85504
s_nop 0
buffer_load_dwordx4 v20,s[8:11],s67 offen offset:512 sc1 lds
s_add_u32 m0,s50,89344
s_nop 0
buffer_load_dwordx4 v20,s[8:11],s66 offen offset:768 sc1 lds
s_add_u32 m0,s50,93440
s_nop 0
buffer_load_dwordx4 v20,s[8:11],s67 offen offset:768 sc1 lds
s_lshl_b32 s58,s51,5
s_add_u32 s58,s58,s47
s_mul_i32 s58,s58,24576
s_add_u32 s58,s58,150994944
s_add_u32 s61,s58,s50
s_add_u32 s62,s61,4096
s_add_u32 s63,s61,16384
s_add_u32 s64,s61,20480
s_add_u32 s65,s61,s50
s_add_u32 s65,s65,8192
s_waitcnt vmcnt(6)
s_barrier
ds_read_b128 v[104:107],v4 offset:0
ds_read_b128 v[108:111],v4 offset:4096
ds_read_b128 v[112:115],v5 offset:0
ds_read_b128 v[116:119],v5 offset:4096
s_waitcnt lgkmcnt(2)
v_mfma_f32_16x16x32_bf16 v[24:27],a[128:131],v[104:107],0
ds_read_b128 v[120:123],v6 offset:0
v_mfma_f32_16x16x32_bf16 v[40:43],v[104:107],v[128:131],0
v_mfma_f32_16x16x32_bf16 v[28:31],a[128:131],v[108:111],0
ds_read_b128 v[124:127],v6 offset:4096
v_mfma_f32_16x16x32_bf16 v[44:47],v[108:111],v[128:131],0
v_mfma_f32_16x16x32_bf16 v[32:35],a[136:139],v[104:107],0
v_mfma_f32_16x16x32_bf16 v[48:51],v[104:107],v[136:139],0
v_mfma_f32_16x16x32_bf16 v[36:39],a[136:139],v[108:111],0
v_mfma_f32_16x16x32_bf16 v[52:55],v[108:111],v[136:139],0
s_waitcnt lgkmcnt(2)
v_mfma_f32_16x16x32_bf16 v[24:27],a[132:135],v[112:115],v[24:27]
ds_read_b128 v[104:107],v7 offset:0
v_mfma_f32_16x16x32_bf16 v[40:43],v[112:115],v[132:135],v[40:43]
v_mfma_f32_16x16x32_bf16 v[28:31],a[132:135],v[116:119],v[28:31]
ds_read_b128 v[108:111],v7 offset:4096
v_mfma_f32_16x16x32_bf16 v[44:47],v[116:119],v[132:135],v[44:47]
v_mfma_f32_16x16x32_bf16 v[32:35],a[140:143],v[112:115],v[32:35]
v_mfma_f32_16x16x32_bf16 v[48:51],v[112:115],v[140:143],v[48:51]
v_mfma_f32_16x16x32_bf16 v[36:39],a[140:143],v[116:119],v[36:39]
v_mfma_f32_16x16x32_bf16 v[52:55],v[116:119],v[140:143],v[52:55]
s_waitcnt vmcnt(4)
s_barrier
s_waitcnt lgkmcnt(2)
v_mfma_f32_16x16x32_bf16 v[24:27],a[144:147],v[120:123],v[24:27]
ds_read_b128 v[112:115],v4 offset:8192
v_mfma_f32_16x16x32_bf16 v[40:43],v[120:123],v[144:147],v[40:43]
v_mfma_f32_16x16x32_bf16 v[28:31],a[144:147],v[124:127],v[28:31]
ds_read_b128 v[116:119],v4 offset:12288
v_mfma_f32_16x16x32_bf16 v[44:47],v[124:127],v[144:147],v[44:47]
v_mfma_f32_16x16x32_bf16 v[32:35],a[152:155],v[120:123],v[32:35]
v_mfma_f32_16x16x32_bf16 v[48:51],v[120:123],v[152:155],v[48:51]
v_mfma_f32_16x16x32_bf16 v[36:39],a[152:155],v[124:127],v[36:39]
v_mfma_f32_16x16x32_bf16 v[52:55],v[124:127],v[152:155],v[52:55]
s_waitcnt lgkmcnt(2)
v_mfma_f32_16x16x32_bf16 v[24:27],a[148:151],v[104:107],v[24:27]
ds_read_b128 v[120:123],v5 offset:8192
v_mfma_f32_16x16x32_bf16 v[40:43],v[104:107],v[148:151],v[40:43]
v_mfma_f32_16x16x32_bf16 v[28:31],a[148:151],v[108:111],v[28:31]
ds_read_b128 v[124:127],v5 offset:12288
v_mfma_f32_16x16x32_bf16 v[44:47],v[108:111],v[148:151],v[44:47]
v_mfma_f32_16x16x32_bf16 v[32:35],a[156:159],v[104:107],v[32:35]
v_mfma_f32_16x16x32_bf16 v[48:51],v[104:107],v[156:159],v[48:51]
v_mfma_f32_16x16x32_bf16 v[36:39],a[156:159],v[108:111],v[36:39]
v_mfma_f32_16x16x32_bf16 v[52:55],v[108:111],v[156:159],v[52:55]
s_waitcnt lgkmcnt(2)
v_mfma_f32_16x16x32_bf16 v[24:27],a[160:163],v[112:115],v[24:27]
ds_read_b128 v[104:107],v6 offset:8192
v_mfma_f32_16x16x32_bf16 v[40:43],v[112:115],v[160:163],v[40:43]
v_mfma_f32_16x16x32_bf16 v[28:31],a[160:163],v[116:119],v[28:31]
ds_read_b128 v[108:111],v6 offset:12288
v_mfma_f32_16x16x32_bf16 v[44:47],v[116:119],v[160:163],v[44:47]
v_mfma_f32_16x16x32_bf16 v[32:35],a[168:171],v[112:115],v[32:35]
v_mfma_f32_16x16x32_bf16 v[48:51],v[112:115],v[168:171],v[48:51]
v_mfma_f32_16x16x32_bf16 v[36:39],a[168:171],v[116:119],v[36:39]
v_mfma_f32_16x16x32_bf16 v[52:55],v[116:119],v[168:171],v[52:55]
s_waitcnt lgkmcnt(2)
v_mfma_f32_16x16x32_bf16 v[24:27],a[164:167],v[120:123],v[24:27]
ds_read_b128 v[112:115],v7 offset:8192
v_mfma_f32_16x16x32_bf16 v[40:43],v[120:123],v[164:167],v[40:43]
v_mfma_f32_16x16x32_bf16 v[28:31],a[164:167],v[124:127],v[28:31]
ds_read_b128 v[116:119],v7 offset:12288
v_mfma_f32_16x16x32_bf16 v[44:47],v[124:127],v[164:167],v[44:47]
v_mfma_f32_16x16x32_bf16 v[32:35],a[172:175],v[120:123],v[32:35]
v_mfma_f32_16x16x32_bf16 v[48:51],v[120:123],v[172:175],v[48:51]
v_mfma_f32_16x16x32_bf16 v[36:39],a[172:175],v[124:127],v[36:39]
v_mfma_f32_16x16x32_bf16 v[52:55],v[124:127],v[172:175],v[52:55]
s_waitcnt vmcnt(2)
s_barrier
s_waitcnt lgkmcnt(2)
v_mfma_f32_16x16x32_bf16 v[24:27],a[176:179],v[104:107],v[24:27]
ds_read_b128 v[120:123],v4 offset:16384
v_mfma_f32_16x16x32_bf16 v[40:43],v[104:107],v[176:179],v[40:43]
v_mfma_f32_16x16x32_bf16 v[28:31],a[176:179],v[108:111],v[28:31]
ds_read_b128 v[124:127],v4 offset:20480
v_mfma_f32_16x16x32_bf16 v[44:47],v[108:111],v[176:179],v[44:47]
v_mfma_f32_16x16x32_bf16 v[32:35],a[184:187],v[104:107],v[32:35]
v_mfma_f32_16x16x32_bf16 v[48:51],v[104:107],v[184:187],v[48:51]
v_mfma_f32_16x16x32_bf16 v[36:39],a[184:187],v[108:111],v[36:39]
v_mfma_f32_16x16x32_bf16 v[52:55],v[108:111],v[184:187],v[52:55]
s_waitcnt lgkmcnt(2)
v_mfma_f32_16x16x32_bf16 v[24:27],a[180:183],v[112:115],v[24:27]
ds_read_b128 v[104:107],v5 offset:16384
v_mfma_f32_16x16x32_bf16 v[40:43],v[112:115],v[180:183],v[40:43]
v_mfma_f32_16x16x32_bf16 v[28:31],a[180:183],v[116:119],v[28:31]
ds_read_b128 v[108:111],v5 offset:20480
v_mfma_f32_16x16x32_bf16 v[44:47],v[116:119],v[180:183],v[44:47]
v_mfma_f32_16x16x32_bf16 v[32:35],a[188:191],v[112:115],v[32:35]
v_mfma_f32_16x16x32_bf16 v[48:51],v[112:115],v[188:191],v[48:51]
v_mfma_f32_16x16x32_bf16 v[36:39],a[188:191],v[116:119],v[36:39]
v_mfma_f32_16x16x32_bf16 v[52:55],v[116:119],v[188:191],v[52:55]
s_waitcnt lgkmcnt(2)
v_mfma_f32_16x16x32_bf16 v[24:27],a[192:195],v[120:123],v[24:27]
ds_read_b128 v[112:115],v6 offset:16384
v_mfma_f32_16x16x32_bf16 v[40:43],v[120:123],v[192:195],v[40:43]
v_mfma_f32_16x16x32_bf16 v[28:31],a[192:195],v[124:127],v[28:31]
ds_read_b128 v[116:119],v6 offset:20480
v_mfma_f32_16x16x32_bf16 v[44:47],v[124:127],v[192:195],v[44:47]
v_mfma_f32_16x16x32_bf16 v[32:35],a[200:203],v[120:123],v[32:35]
v_mfma_f32_16x16x32_bf16 v[48:51],v[120:123],v[200:203],v[48:51]
v_mfma_f32_16x16x32_bf16 v[36:39],a[200:203],v[124:127],v[36:39]
v_mfma_f32_16x16x32_bf16 v[52:55],v[124:127],v[200:203],v[52:55]
s_waitcnt lgkmcnt(2)
v_mfma_f32_16x16x32_bf16 v[24:27],a[196:199],v[104:107],v[24:27]
ds_read_b128 v[120:123],v7 offset:16384
v_mfma_f32_16x16x32_bf16 v[40:43],v[104:107],v[196:199],v[40:43]
v_mfma_f32_16x16x32_bf16 v[28:31],a[196:199],v[108:111],v[28:31]
ds_read_b128 v[124:127],v7 offset:20480
v_mfma_f32_16x16x32_bf16 v[44:47],v[108:111],v[196:199],v[44:47]
v_mfma_f32_16x16x32_bf16 v[32:35],a[204:207],v[104:107],v[32:35]
v_mfma_f32_16x16x32_bf16 v[48:51],v[104:107],v[204:207],v[48:51]
v_mfma_f32_16x16x32_bf16 v[36:39],a[204:207],v[108:111],v[36:39]
v_mfma_f32_16x16x32_bf16 v[52:55],v[108:111],v[204:207],v[52:55]
s_waitcnt vmcnt(0)
s_barrier
s_or_b32 s70,s70,s52
buffer_store_dword v17,off,s[8:11],s70 sc1
s_waitcnt lgkmcnt(2)
v_mfma_f32_16x16x32_bf16 v[24:27],a[208:211],v[112:115],v[24:27]
ds_read_b128 v[104:107],v4 offset:24576
v_mfma_f32_16x16x32_bf16 v[40:43],v[112:115],v[208:211],v[40:43]
s_add_u32 m0,s50,98304
v_mfma_f32_16x16x32_bf16 v[28:31],a[208:211],v[116:119],v[28:31]
ds_read_b128 v[108:111],v4 offset:28672
v_mfma_f32_16x16x32_bf16 v[44:47],v[116:119],v[208:211],v[44:47]
buffer_load_dwordx4 v20,s[8:11],s68 offen offset:0 sc1 lds
v_mfma_f32_16x16x32_bf16 v[32:35],a[216:219],v[112:115],v[32:35]
s_add_u32 m0,s50,102400
v_mfma_f32_16x16x32_bf16 v[48:51],v[112:115],v[216:219],v[48:51]
buffer_load_dwordx4 v20,s[8:11],s69 offen offset:0 sc1 lds
v_mfma_f32_16x16x32_bf16 v[36:39],a[216:219],v[116:119],v[36:39]
s_add_u32 m0,s50,106240
v_mfma_f32_16x16x32_bf16 v[52:55],v[116:119],v[216:219],v[52:55]
buffer_load_dwordx4 v20,s[8:11],s68 offen offset:256 sc1 lds
s_waitcnt lgkmcnt(2)
v_mfma_f32_16x16x32_bf16 v[24:27],a[212:215],v[120:123],v[24:27]
ds_read_b128 v[112:115],v5 offset:24576
v_mfma_f32_16x16x32_bf16 v[40:43],v[120:123],v[212:215],v[40:43]
s_add_u32 m0,s50,110336
v_mfma_f32_16x16x32_bf16 v[28:31],a[212:215],v[124:127],v[28:31]
ds_read_b128 v[116:119],v5 offset:28672
v_mfma_f32_16x16x32_bf16 v[44:47],v[124:127],v[212:215],v[44:47]
buffer_load_dwordx4 v20,s[8:11],s69 offen offset:256 sc1 lds
v_mfma_f32_16x16x32_bf16 v[32:35],a[220:223],v[120:123],v[32:35]
s_add_u32 m0,s50,114176
v_mfma_f32_16x16x32_bf16 v[48:51],v[120:123],v[220:223],v[48:51]
buffer_load_dwordx4 v20,s[8:11],s68 offen offset:512 sc1 lds
v_mfma_f32_16x16x32_bf16 v[36:39],a[220:223],v[124:127],v[36:39]
s_add_u32 m0,s50,118272
v_mfma_f32_16x16x32_bf16 v[52:55],v[124:127],v[220:223],v[52:55]
buffer_load_dwordx4 v20,s[8:11],s69 offen offset:512 sc1 lds
s_waitcnt lgkmcnt(2)
v_mfma_f32_16x16x32_bf16 v[24:27],a[224:227],v[104:107],v[24:27]
ds_read_b128 v[120:123],v6 offset:24576
v_mfma_f32_16x16x32_bf16 v[40:43],v[104:107],v[224:227],v[40:43]
s_add_u32 m0,s50,122112
v_mfma_f32_16x16x32_bf16 v[28:31],a[224:227],v[108:111],v[28:31]
ds_read_b128 v[124:127],v6 offset:28672
v_mfma_f32_16x16x32_bf16 v[44:47],v[108:111],v[224:227],v[44:47]
buffer_load_dwordx4 v20,s[8:11],s68 offen offset:768 sc1 lds
v_mfma_f32_16x16x32_bf16 v[32:35],a[232:235],v[104:107],v[32:35]
s_add_u32 m0,s50,126208
v_mfma_f32_16x16x32_bf16 v[48:51],v[104:107],v[232:235],v[48:51]
buffer_load_dwordx4 v20,s[8:11],s69 offen offset:768 sc1 lds
v_mfma_f32_16x16x32_bf16 v[36:39],a[232:235],v[108:111],v[36:39]
v_mfma_f32_16x16x32_bf16 v[52:55],v[108:111],v[232:235],v[52:55]
s_waitcnt lgkmcnt(2)
v_mfma_f32_16x16x32_bf16 v[24:27],a[228:231],v[112:115],v[24:27]
ds_read_b128 v[104:107],v7 offset:24576
v_mfma_f32_16x16x32_bf16 v[40:43],v[112:115],v[228:231],v[40:43]
v_mfma_f32_16x16x32_bf16 v[28:31],a[228:231],v[116:119],v[28:31]
ds_read_b128 v[108:111],v7 offset:28672
v_mfma_f32_16x16x32_bf16 v[44:47],v[116:119],v[228:231],v[44:47]
v_mfma_f32_16x16x32_bf16 v[32:35],a[236:239],v[112:115],v[32:35]
v_mfma_f32_16x16x32_bf16 v[48:51],v[112:115],v[236:239],v[48:51]
v_mfma_f32_16x16x32_bf16 v[36:39],a[236:239],v[116:119],v[36:39]
v_mfma_f32_16x16x32_bf16 v[52:55],v[116:119],v[236:239],v[52:55]
s_waitcnt lgkmcnt(2)
v_mfma_f32_16x16x32_bf16 v[24:27],a[240:243],v[120:123],v[24:27]
ds_read_b128 v[112:115],v4 offset:0
v_mfma_f32_16x16x32_bf16 v[40:43],v[120:123],v[240:243],v[40:43]
v_mfma_f32_16x16x32_bf16 v[28:31],a[240:243],v[124:127],v[28:31]
ds_read_b128 v[116:119],v4 offset:4096
v_mfma_f32_16x16x32_bf16 v[44:47],v[124:127],v[240:243],v[44:47]
v_mfma_f32_16x16x32_bf16 v[32:35],a[248:251],v[120:123],v[32:35]
v_mfma_f32_16x16x32_bf16 v[48:51],v[120:123],v[248:251],v[48:51]
v_mfma_f32_16x16x32_bf16 v[36:39],a[248:251],v[124:127],v[36:39]
v_mfma_f32_16x16x32_bf16 v[52:55],v[124:127],v[248:251],v[52:55]
s_waitcnt lgkmcnt(2)
v_mfma_f32_16x16x32_bf16 v[24:27],a[244:247],v[104:107],v[24:27]
ds_read_b128 v[120:123],v5 offset:0
v_mfma_f32_16x16x32_bf16 v[40:43],v[104:107],v[244:247],v[40:43]
v_mfma_f32_16x16x32_bf16 v[28:31],a[244:247],v[108:111],v[28:31]
ds_read_b128 v[124:127],v5 offset:4096
v_mfma_f32_16x16x32_bf16 v[44:47],v[108:111],v[244:247],v[44:47]
v_mfma_f32_16x16x32_bf16 v[32:35],a[252:255],v[104:107],v[32:35]
v_mfma_f32_16x16x32_bf16 v[48:51],v[104:107],v[252:255],v[48:51]
v_mfma_f32_16x16x32_bf16 v[36:39],a[252:255],v[108:111],v[36:39]
v_mfma_f32_16x16x32_bf16 v[52:55],v[108:111],v[252:255],v[52:55]
s_waitcnt lgkmcnt(2)
v_mfma_f32_16x16x32_bf16 v[88:91],a[0:3],v[112:115],0
ds_read_b128 v[104:107],v6 offset:0
v_mfma_f32_16x16x32_bf16 v[92:95],a[0:3],v[116:119],0
v_mfma_f32_16x16x32_bf16 v[96:99],a[8:11],v[112:115],0
ds_read_b128 v[108:111],v6 offset:4096
v_mfma_f32_16x16x32_bf16 v[100:103],a[8:11],v[116:119],0
s_waitcnt lgkmcnt(2)
v_mfma_f32_16x16x32_bf16 v[88:91],a[4:7],v[120:123],v[88:91]
ds_read_b128 v[112:115],v7 offset:0
v_mfma_f32_16x16x32_bf16 v[92:95],a[4:7],v[124:127],v[92:95]
v_cvt_pk_bf16_f32 v56,v24,v32
v_cvt_pk_bf16_f32 v57,v25,v33
v_mfma_f32_16x16x32_bf16 v[96:99],a[12:15],v[120:123],v[96:99]
ds_read_b128 v[116:119],v7 offset:4096
v_mfma_f32_16x16x32_bf16 v[100:103],a[12:15],v[124:127],v[100:103]
v_cvt_pk_bf16_f32 v58,v26,v34
v_cvt_pk_bf16_f32 v59,v27,v35
s_waitcnt lgkmcnt(2)
v_mfma_f32_16x16x32_bf16 v[88:91],a[16:19],v[104:107],v[88:91]
ds_read_b128 v[120:123],v4 offset:8192
v_mfma_f32_16x16x32_bf16 v[92:95],a[16:19],v[108:111],v[92:95]
buffer_store_dwordx4 v[56:59],v0,s[8:11],s61 offen sc1
v_cvt_pk_bf16_f32 v60,v28,v36
v_mfma_f32_16x16x32_bf16 v[96:99],a[24:27],v[104:107],v[96:99]
ds_read_b128 v[124:127],v4 offset:12288
v_mfma_f32_16x16x32_bf16 v[100:103],a[24:27],v[108:111],v[100:103]
v_cvt_pk_bf16_f32 v61,v29,v37
v_cvt_pk_bf16_f32 v62,v30,v38
s_waitcnt lgkmcnt(2)
v_mfma_f32_16x16x32_bf16 v[88:91],a[20:23],v[112:115],v[88:91]
ds_read_b128 v[104:107],v5 offset:8192
v_mfma_f32_16x16x32_bf16 v[92:95],a[20:23],v[116:119],v[92:95]
v_cvt_pk_bf16_f32 v63,v31,v39
buffer_store_dwordx4 v[60:63],v0,s[8:11],s62 offen sc1
v_mfma_f32_16x16x32_bf16 v[96:99],a[28:31],v[112:115],v[96:99]
ds_read_b128 v[108:111],v5 offset:12288
v_mfma_f32_16x16x32_bf16 v[100:103],a[28:31],v[116:119],v[100:103]
v_cvt_pk_bf16_f32 v64,v40,v41
v_cvt_pk_bf16_f32 v65,v42,v43
s_waitcnt lgkmcnt(2)
v_mfma_f32_16x16x32_bf16 v[88:91],a[32:35],v[120:123],v[88:91]
ds_read_b128 v[112:115],v6 offset:8192
v_mfma_f32_16x16x32_bf16 v[92:95],a[32:35],v[124:127],v[92:95]
v_cvt_pk_bf16_f32 v66,v44,v45
v_cvt_pk_bf16_f32 v67,v46,v47
v_mfma_f32_16x16x32_bf16 v[96:99],a[40:43],v[120:123],v[96:99]
ds_read_b128 v[116:119],v6 offset:12288
v_mfma_f32_16x16x32_bf16 v[100:103],a[40:43],v[124:127],v[100:103]
buffer_store_dwordx4 v[64:67],v0,s[8:11],s65 offen offset:0 sc1
v_cvt_pk_bf16_f32 v68,v48,v49
s_waitcnt lgkmcnt(2)
v_mfma_f32_16x16x32_bf16 v[88:91],a[36:39],v[104:107],v[88:91]
ds_read_b128 v[120:123],v7 offset:8192
v_mfma_f32_16x16x32_bf16 v[92:95],a[36:39],v[108:111],v[92:95]
v_cvt_pk_bf16_f32 v69,v50,v51
v_cvt_pk_bf16_f32 v70,v52,v53
v_mfma_f32_16x16x32_bf16 v[96:99],a[44:47],v[104:107],v[96:99]
ds_read_b128 v[124:127],v7 offset:12288
v_mfma_f32_16x16x32_bf16 v[100:103],a[44:47],v[108:111],v[100:103]
v_cvt_pk_bf16_f32 v71,v54,v55
buffer_store_dwordx4 v[68:71],v0,s[8:11],s65 offen offset:1024 sc1
s_waitcnt lgkmcnt(2)
v_mfma_f32_16x16x32_bf16 v[88:91],a[48:51],v[112:115],v[88:91]
ds_read_b128 v[104:107],v4 offset:16384
v_mfma_f32_16x16x32_bf16 v[92:95],a[48:51],v[116:119],v[92:95]
v_mfma_f32_16x16x32_bf16 v[96:99],a[56:59],v[112:115],v[96:99]
ds_read_b128 v[108:111],v4 offset:20480
v_mfma_f32_16x16x32_bf16 v[100:103],a[56:59],v[116:119],v[100:103]
s_waitcnt lgkmcnt(2)
v_mfma_f32_16x16x32_bf16 v[88:91],a[52:55],v[120:123],v[88:91]
ds_read_b128 v[112:115],v5 offset:16384
v_mfma_f32_16x16x32_bf16 v[92:95],a[52:55],v[124:127],v[92:95]
v_mfma_f32_16x16x32_bf16 v[96:99],a[60:63],v[120:123],v[96:99]
ds_read_b128 v[116:119],v5 offset:20480
v_mfma_f32_16x16x32_bf16 v[100:103],a[60:63],v[124:127],v[100:103]
s_waitcnt lgkmcnt(2)
v_mfma_f32_16x16x32_bf16 v[88:91],a[64:67],v[104:107],v[88:91]
ds_read_b128 v[120:123],v6 offset:16384
v_mfma_f32_16x16x32_bf16 v[92:95],a[64:67],v[108:111],v[92:95]
v_mfma_f32_16x16x32_bf16 v[96:99],a[72:75],v[104:107],v[96:99]
ds_read_b128 v[124:127],v6 offset:20480
v_mfma_f32_16x16x32_bf16 v[100:103],a[72:75],v[108:111],v[100:103]
s_waitcnt lgkmcnt(2)
v_mfma_f32_16x16x32_bf16 v[88:91],a[68:71],v[112:115],v[88:91]
ds_read_b128 v[104:107],v7 offset:16384
v_mfma_f32_16x16x32_bf16 v[92:95],a[68:71],v[116:119],v[92:95]
v_mfma_f32_16x16x32_bf16 v[96:99],a[76:79],v[112:115],v[96:99]
ds_read_b128 v[108:111],v7 offset:20480
v_mfma_f32_16x16x32_bf16 v[100:103],a[76:79],v[116:119],v[100:103]
s_waitcnt lgkmcnt(2)
v_mfma_f32_16x16x32_bf16 v[88:91],a[80:83],v[120:123],v[88:91]
ds_read_b128 v[112:115],v4 offset:24576
v_mfma_f32_16x16x32_bf16 v[92:95],a[80:83],v[124:127],v[92:95]
v_mfma_f32_16x16x32_bf16 v[96:99],a[88:91],v[120:123],v[96:99]
ds_read_b128 v[116:119],v4 offset:28672
v_mfma_f32_16x16x32_bf16 v[100:103],a[88:91],v[124:127],v[100:103]
s_waitcnt lgkmcnt(2)
v_mfma_f32_16x16x32_bf16 v[88:91],a[84:87],v[104:107],v[88:91]
ds_read_b128 v[120:123],v5 offset:24576
v_mfma_f32_16x16x32_bf16 v[92:95],a[84:87],v[108:111],v[92:95]
v_mfma_f32_16x16x32_bf16 v[96:99],a[92:95],v[104:107],v[96:99]
ds_read_b128 v[124:127],v5 offset:28672
v_mfma_f32_16x16x32_bf16 v[100:103],a[92:95],v[108:111],v[100:103]
s_waitcnt lgkmcnt(2)
v_mfma_f32_16x16x32_bf16 v[88:91],a[96:99],v[112:115],v[88:91]
ds_read_b128 v[104:107],v6 offset:24576
v_mfma_f32_16x16x32_bf16 v[92:95],a[96:99],v[116:119],v[92:95]
v_mfma_f32_16x16x32_bf16 v[96:99],a[104:107],v[112:115],v[96:99]
ds_read_b128 v[108:111],v6 offset:28672
v_mfma_f32_16x16x32_bf16 v[100:103],a[104:107],v[116:119],v[100:103]
s_waitcnt lgkmcnt(2)
v_mfma_f32_16x16x32_bf16 v[88:91],a[100:103],v[120:123],v[88:91]
ds_read_b128 v[112:115],v7 offset:24576
v_mfma_f32_16x16x32_bf16 v[92:95],a[100:103],v[124:127],v[92:95]
v_mfma_f32_16x16x32_bf16 v[96:99],a[108:111],v[120:123],v[96:99]
ds_read_b128 v[116:119],v7 offset:28672
v_mfma_f32_16x16x32_bf16 v[100:103],a[108:111],v[124:127],v[100:103]
s_waitcnt lgkmcnt(2)
v_mfma_f32_16x16x32_bf16 v[88:91],a[112:115],v[104:107],v[88:91]
v_mfma_f32_16x16x32_bf16 v[92:95],a[112:115],v[108:111],v[92:95]
v_mfma_f32_16x16x32_bf16 v[96:99],a[120:123],v[104:107],v[96:99]
v_mfma_f32_16x16x32_bf16 v[100:103],a[120:123],v[108:111],v[100:103]
s_waitcnt lgkmcnt(0)
v_mfma_f32_16x16x32_bf16 v[88:91],a[116:119],v[112:115],v[88:91]
v_mfma_f32_16x16x32_bf16 v[92:95],a[116:119],v[116:119],v[92:95]
v_mfma_f32_16x16x32_bf16 v[96:99],a[124:127],v[112:115],v[96:99]
v_mfma_f32_16x16x32_bf16 v[100:103],a[124:127],v[116:119],v[100:103]
s_nop 3
v_cvt_pk_bf16_f32 v104,v88,v96
v_cvt_pk_bf16_f32 v105,v89,v97
v_cvt_pk_bf16_f32 v106,v90,v98
v_cvt_pk_bf16_f32 v107,v91,v99
v_cvt_pk_bf16_f32 v108,v92,v100
v_cvt_pk_bf16_f32 v109,v93,v101
v_cvt_pk_bf16_f32 v110,v94,v102
v_cvt_pk_bf16_f32 v111,v95,v103
buffer_store_dwordx4 v[104:107],v0,s[8:11],s63 offen sc1
buffer_store_dwordx4 v[108:111],v0,s[8:11],s64 offen sc1
s_lshl_b32 s59,s51,13
s_lshl2_add_u32 s59,s47,s59
s_add_u32 s59,s59,10485888
s_waitcnt vmcnt(2)
s_barrier
s_or_b32 s59,s59,s52
buffer_store_dword v17,off,s[8:11],s59 sc1
s_lshl_b32 s70,s51,13
s_lshl2_add_u32 s70,s47,s70
s_add_u32 s70,s70,10486144
s_sub_u32 s56,s55,s54
s_cmp_ge_i32 s56,20
s_cbranch_scc1 L_pn_14
s_mov_b32 s51,s55
s_ff1_i32_b64 s55,s[72:73]
s_bitset0_b64 s[72:73],s55
s_min_u32 s55,s55,127
s_lshl_b32 s68,s55,15
s_add_u32 s68,s68,0
s_add_u32 s69,s68,16384
s_lshl_b32 s58,s51,5
s_add_u32 s58,s58,s47
s_mul_i32 s58,s58,24576
s_add_u32 s58,s58,100663296
s_add_u32 s61,s58,s50
s_add_u32 s62,s61,4096
s_add_u32 s63,s61,16384
s_add_u32 s64,s61,20480
s_add_u32 s65,s61,s50
s_add_u32 s65,s65,8192
ds_read_b128 v[104:107],v4 offset:32768
ds_read_b128 v[108:111],v4 offset:36864
ds_read_b128 v[112:115],v5 offset:32768
ds_read_b128 v[116:119],v5 offset:36864
s_waitcnt lgkmcnt(2)
v_mfma_f32_16x16x32_bf16 v[24:27],a[128:131],v[104:107],0
ds_read_b128 v[120:123],v6 offset:32768
v_mfma_f32_16x16x32_bf16 v[40:43],v[104:107],v[128:131],0
v_mfma_f32_16x16x32_bf16 v[28:31],a[128:131],v[108:111],0
ds_read_b128 v[124:127],v6 offset:36864
v_mfma_f32_16x16x32_bf16 v[44:47],v[108:111],v[128:131],0
v_mfma_f32_16x16x32_bf16 v[32:35],a[136:139],v[104:107],0
v_mfma_f32_16x16x32_bf16 v[48:51],v[104:107],v[136:139],0
v_mfma_f32_16x16x32_bf16 v[36:39],a[136:139],v[108:111],0
v_mfma_f32_16x16x32_bf16 v[52:55],v[108:111],v[136:139],0
s_waitcnt lgkmcnt(2)
v_mfma_f32_16x16x32_bf16 v[24:27],a[132:135],v[112:115],v[24:27]
ds_read_b128 v[104:107],v7 offset:32768
v_mfma_f32_16x16x32_bf16 v[40:43],v[112:115],v[132:135],v[40:43]
v_mfma_f32_16x16x32_bf16 v[28:31],a[132:135],v[116:119],v[28:31]
ds_read_b128 v[108:111],v7 offset:36864
v_mfma_f32_16x16x32_bf16 v[44:47],v[116:119],v[132:135],v[44:47]
v_mfma_f32_16x16x32_bf16 v[32:35],a[140:143],v[112:115],v[32:35]
v_mfma_f32_16x16x32_bf16 v[48:51],v[112:115],v[140:143],v[48:51]
v_mfma_f32_16x16x32_bf16 v[36:39],a[140:143],v[116:119],v[36:39]
v_mfma_f32_16x16x32_bf16 v[52:55],v[116:119],v[140:143],v[52:55]
s_waitcnt lgkmcnt(2)
v_mfma_f32_16x16x32_bf16 v[24:27],a[144:147],v[120:123],v[24:27]
ds_read_b128 v[112:115],v4 offset:40960
v_mfma_f32_16x16x32_bf16 v[40:43],v[120:123],v[144:147],v[40:43]
v_mfma_f32_16x16x32_bf16 v[28:31],a[144:147],v[124:127],v[28:31]
ds_read_b128 v[116:119],v4 offset:45056
v_mfma_f32_16x16x32_bf16 v[44:47],v[124:127],v[144:147],v[44:47]
v_mfma_f32_16x16x32_bf16 v[32:35],a[152:155],v[120:123],v[32:35]
v_mfma_f32_16x16x32_bf16 v[48:51],v[120:123],v[152:155],v[48:51]
v_mfma_f32_16x16x32_bf16 v[36:39],a[152:155],v[124:127],v[36:39]
v_mfma_f32_16x16x32_bf16 v[52:55],v[124:127],v[152:155],v[52:55]
s_waitcnt lgkmcnt(2)
v_mfma_f32_16x16x32_bf16 v[24:27],a[148:151],v[104:107],v[24:27]
ds_read_b128 v[120:123],v5 offset:40960
v_mfma_f32_16x16x32_bf16 v[40:43],v[104:107],v[148:151],v[40:43]
v_mfma_f32_16x16x32_bf16 v[28:31],a[148:151],v[108:111],v[28:31]
ds_read_b128 v[124:127],v5 offset:45056
v_mfma_f32_16x16x32_bf16 v[44:47],v[108:111],v[148:151],v[44:47]
v_mfma_f32_16x16x32_bf16 v[32:35],a[156:159],v[104:107],v[32:35]
v_mfma_f32_16x16x32_bf16 v[48:51],v[104:107],v[156:159],v[48:51]
v_mfma_f32_16x16x32_bf16 v[36:39],a[156:159],v[108:111],v[36:39]
v_mfma_f32_16x16x32_bf16 v[52:55],v[108:111],v[156:159],v[52:55]
s_waitcnt lgkmcnt(2)
v_mfma_f32_16x16x32_bf16 v[24:27],a[160:163],v[112:115],v[24:27]
ds_read_b128 v[104:107],v6 offset:40960
v_mfma_f32_16x16x32_bf16 v[40:43],v[112:115],v[160:163],v[40:43]
v_mfma_f32_16x16x32_bf16 v[28:31],a[160:163],v[116:119],v[28:31]
ds_read_b128 v[108:111],v6 offset:45056
v_mfma_f32_16x16x32_bf16 v[44:47],v[116:119],v[160:163],v[44:47]
v_mfma_f32_16x16x32_bf16 v[32:35],a[168:171],v[112:115],v[32:35]
v_mfma_f32_16x16x32_bf16 v[48:51],v[112:115],v[168:171],v[48:51]
v_mfma_f32_16x16x32_bf16 v[36:39],a[168:171],v[116:119],v[36:39]
v_mfma_f32_16x16x32_bf16 v[52:55],v[116:119],v[168:171],v[52:55]
s_waitcnt lgkmcnt(2)
v_mfma_f32_16x16x32_bf16 v[24:27],a[164:167],v[120:123],v[24:27]
ds_read_b128 v[112:115],v7 offset:40960
v_mfma_f32_16x16x32_bf16 v[40:43],v[120:123],v[164:167],v[40:43]
v_mfma_f32_16x16x32_bf16 v[28:31],a[164:167],v[124:127],v[28:31]
ds_read_b128 v[116:119],v7 offset:45056
v_mfma_f32_16x16x32_bf16 v[44:47],v[124:127],v[164:167],v[44:47]
v_mfma_f32_16x16x32_bf16 v[32:35],a[172:175],v[120:123],v[32:35]
v_mfma_f32_16x16x32_bf16 v[48:51],v[120:123],v[172:175],v[48:51]
v_mfma_f32_16x16x32_bf16 v[36:39],a[172:175],v[124:127],v[36:39]
v_mfma_f32_16x16x32_bf16 v[52:55],v[124:127],v[172:175],v[52:55]
s_waitcnt lgkmcnt(2)
v_mfma_f32_16x16x32_bf16 v[24:27],a[176:179],v[104:107],v[24:27]
ds_read_b128 v[120:123],v4 offset:49152
v_mfma_f32_16x16x32_bf16 v[40:43],v[104:107],v[176:179],v[40:43]
v_mfma_f32_16x16x32_bf16 v[28:31],a[176:179],v[108:111],v[28:31]
ds_read_b128 v[124:127],v4 offset:53248
v_mfma_f32_16x16x32_bf16 v[44:47],v[108:111],v[176:179],v[44:47]
v_mfma_f32_16x16x32_bf16 v[32:35],a[184:187],v[104:107],v[32:35]
v_mfma_f32_16x16x32_bf16 v[48:51],v[104:107],v[184:187],v[48:51]
v_mfma_f32_16x16x32_bf16 v[36:39],a[184:187],v[108:111],v[36:39]
v_mfma_f32_16x16x32_bf16 v[52:55],v[108:111],v[184:187],v[52:55]
s_waitcnt lgkmcnt(2)
v_mfma_f32_16x16x32_bf16 v[24:27],a[180:183],v[112:115],v[24:27]
ds_read_b128 v[104:107],v5 offset:49152
v_mfma_f32_16x16x32_bf16 v[40:43],v[112:115],v[180:183],v[40:43]
v_mfma_f32_16x16x32_bf16 v[28:31],a[180:183],v[116:119],v[28:31]
ds_read_b128 v[108:111],v5 offset:53248
v_mfma_f32_16x16x32_bf16 v[44:47],v[116:119],v[180:183],v[44:47]
v_mfma_f32_16x16x32_bf16 v[32:35],a[188:191],v[112:115],v[32:35]
v_mfma_f32_16x16x32_bf16 v[48:51],v[112:115],v[188:191],v[48:51]
v_mfma_f32_16x16x32_bf16 v[36:39],a[188:191],v[116:119],v[36:39]
v_mfma_f32_16x16x32_bf16 v[52:55],v[116:119],v[188:191],v[52:55]
s_waitcnt lgkmcnt(2)
v_mfma_f32_16x16x32_bf16 v[24:27],a[192:195],v[120:123],v[24:27]
ds_read_b128 v[112:115],v6 offset:49152
v_mfma_f32_16x16x32_bf16 v[40:43],v[120:123],v[192:195],v[40:43]
v_mfma_f32_16x16x32_bf16 v[28:31],a[192:195],v[124:127],v[28:31]
ds_read_b128 v[116:119],v6 offset:53248
v_mfma_f32_16x16x32_bf16 v[44:47],v[124:127],v[192:195],v[44:47]
v_mfma_f32_16x16x32_bf16 v[32:35],a[200:203],v[120:123],v[32:35]
v_mfma_f32_16x16x32_bf16 v[48:51],v[120:123],v[200:203],v[48:51]
v_mfma_f32_16x16x32_bf16 v[36:39],a[200:203],v[124:127],v[36:39]
v_mfma_f32_16x16x32_bf16 v[52:55],v[124:127],v[200:203],v[52:55]
s_waitcnt lgkmcnt(2)
v_mfma_f32_16x16x32_bf16 v[24:27],a[196:199],v[104:107],v[24:27]
ds_read_b128 v[120:123],v7 offset:49152
v_mfma_f32_16x16x32_bf16 v[40:43],v[104:107],v[196:199],v[40:43]
v_mfma_f32_16x16x32_bf16 v[28:31],a[196:199],v[108:111],v[28:31]
ds_read_b128 v[124:127],v7 offset:53248
v_mfma_f32_16x16x32_bf16 v[44:47],v[108:111],v[196:199],v[44:47]
v_mfma_f32_16x16x32_bf16 v[32:35],a[204:207],v[104:107],v[32:35]
v_mfma_f32_16x16x32_bf16 v[48:51],v[104:107],v[204:207],v[48:51]
v_mfma_f32_16x16x32_bf16 v[36:39],a[204:207],v[108:111],v[36:39]
v_mfma_f32_16x16x32_bf16 v[52:55],v[108:111],v[204:207],v[52:55]
s_waitcnt vmcnt(0)
s_barrier
s_or_b32 s70,s70,s52
buffer_store_dword v17,off,s[8:11],s70 sc1
s_waitcnt lgkmcnt(2)
v_mfma_f32_16x16x32_bf16 v[24:27],a[208:211],v[112:115],v[24:27]
ds_read_b128 v[104:107],v4 offset:57344
v_mfma_f32_16x16x32_bf16 v[40:43],v[112:115],v[208:211],v[40:43]
s_lshl_b32 s56,s51,5
v_mfma_f32_16x16x32_bf16 v[28:31],a[208:211],v[116:119],v[28:31]
ds_read_b128 v[108:111],v4 offset:61440
v_mfma_f32_16x16x32_bf16 v[44:47],v[116:119],v[208:211],v[44:47]
s_add_u32 s56,s56,s47
v_mfma_f32_16x16x32_bf16 v[32:35],a[216:219],v[112:115],v[32:35]
s_lshl_b32 s56,s56,13
v_mfma_f32_16x16x32_bf16 v[48:51],v[112:115],v[216:219],v[48:51]
s_add_u32 s56,s56,s50
v_mfma_f32_16x16x32_bf16 v[36:39],a[216:219],v[116:119],v[36:39]
s_add_u32 s56,s56,41943040
v_mfma_f32_16x16x32_bf16 v[52:55],v[116:119],v[216:219],v[52:55]
s_add_u32 s57,s56,4096
s_waitcnt lgkmcnt(2)
v_mfma_f32_16x16x32_bf16 v[24:27],a[212:215],v[120:123],v[24:27]
ds_read_b128 v[112:115],v5 offset:57344
v_mfma_f32_16x16x32_bf16 v[40:43],v[120:123],v[212:215],v[40:43]
v_mov_b64 v[72:73],-1
v_mfma_f32_16x16x32_bf16 v[28:31],a[212:215],v[124:127],v[28:31]
ds_read_b128 v[116:119],v5 offset:61440
v_mfma_f32_16x16x32_bf16 v[44:47],v[124:127],v[212:215],v[44:47]
v_mov_b64 v[74:75],-1
v_mfma_f32_16x16x32_bf16 v[32:35],a[220:223],v[120:123],v[32:35]
buffer_store_dwordx4 v[72:75],v0,s[8:11],s56 offen sc1
v_mfma_f32_16x16x32_bf16 v[48:51],v[120:123],v[220:223],v[48:51]
buffer_store_dwordx4 v[72:75],v0,s[8:11],s57 offen sc1
v_mfma_f32_16x16x32_bf16 v[36:39],a[220:223],v[124:127],v[36:39]
v_mfma_f32_16x16x32_bf16 v[52:55],v[124:127],v[220:223],v[52:55]
s_waitcnt lgkmcnt(2)
v_mfma_f32_16x16x32_bf16 v[24:27],a[224:227],v[104:107],v[24:27]
ds_read_b128 v[120:123],v6 offset:57344
v_mfma_f32_16x16x32_bf16 v[40:43],v[104:107],v[224:227],v[40:43]
v_mfma_f32_16x16x32_bf16 v[28:31],a[224:227],v[108:111],v[28:31]
ds_read_b128 v[124:127],v6 offset:61440
v_mfma_f32_16x16x32_bf16 v[44:47],v[108:111],v[224:227],v[44:47]
v_mfma_f32_16x16x32_bf16 v[32:35],a[232:235],v[104:107],v[32:35]
v_mfma_f32_16x16x32_bf16 v[48:51],v[104:107],v[232:235],v[48:51]
v_mfma_f32_16x16x32_bf16 v[36:39],a[232:235],v[108:111],v[36:39]
v_mfma_f32_16x16x32_bf16 v[52:55],v[108:111],v[232:235],v[52:55]
s_waitcnt lgkmcnt(2)
v_mfma_f32_16x16x32_bf16 v[24:27],a[228:231],v[112:115],v[24:27]
ds_read_b128 v[104:107],v7 offset:57344
v_mfma_f32_16x16x32_bf16 v[40:43],v[112:115],v[228:231],v[40:43]
v_mfma_f32_16x16x32_bf16 v[28:31],a[228:231],v[116:119],v[28:31]
ds_read_b128 v[108:111],v7 offset:61440
v_mfma_f32_16x16x32_bf16 v[44:47],v[116:119],v[228:231],v[44:47]
v_mfma_f32_16x16x32_bf16 v[32:35],a[236:239],v[112:115],v[32:35]
v_mfma_f32_16x16x32_bf16 v[48:51],v[112:115],v[236:239],v[48:51]
v_mfma_f32_16x16x32_bf16 v[36:39],a[236:239],v[116:119],v[36:39]
v_mfma_f32_16x16x32_bf16 v[52:55],v[116:119],v[236:239],v[52:55]
s_waitcnt lgkmcnt(2)
v_mfma_f32_16x16x32_bf16 v[24:27],a[240:243],v[120:123],v[24:27]
ds_read_b128 v[112:115],v4 offset:32768
v_mfma_f32_16x16x32_bf16 v[40:43],v[120:123],v[240:243],v[40:43]
v_mfma_f32_16x16x32_bf16 v[28:31],a[240:243],v[124:127],v[28:31]
ds_read_b128 v[116:119],v4 offset:36864
v_mfma_f32_16x16x32_bf16 v[44:47],v[124:127],v[240:243],v[44:47]
v_mfma_f32_16x16x32_bf16 v[32:35],a[248:251],v[120:123],v[32:35]
v_mfma_f32_16x16x32_bf16 v[48:51],v[120:123],v[248:251],v[48:51]
v_mfma_f32_16x16x32_bf16 v[36:39],a[248:251],v[124:127],v[36:39]
v_mfma_f32_16x16x32_bf16 v[52:55],v[124:127],v[248:251],v[52:55]
s_waitcnt lgkmcnt(2)
v_mfma_f32_16x16x32_bf16 v[24:27],a[244:247],v[104:107],v[24:27]
ds_read_b128 v[120:123],v5 offset:32768
v_mfma_f32_16x16x32_bf16 v[40:43],v[104:107],v[244:247],v[40:43]
v_mfma_f32_16x16x32_bf16 v[28:31],a[244:247],v[108:111],v[28:31]
ds_read_b128 v[124:127],v5 offset:36864
v_mfma_f32_16x16x32_bf16 v[44:47],v[108:111],v[244:247],v[44:47]
v_mfma_f32_16x16x32_bf16 v[32:35],a[252:255],v[104:107],v[32:35]
v_mfma_f32_16x16x32_bf16 v[48:51],v[104:107],v[252:255],v[48:51]
v_mfma_f32_16x16x32_bf16 v[36:39],a[252:255],v[108:111],v[36:39]
v_mfma_f32_16x16x32_bf16 v[52:55],v[108:111],v[252:255],v[52:55]
s_waitcnt lgkmcnt(2)
v_mfma_f32_16x16x32_bf16 v[88:91],a[0:3],v[112:115],0
ds_read_b128 v[104:107],v6 offset:32768
v_mfma_f32_16x16x32_bf16 v[92:95],a[0:3],v[116:119],0
v_mfma_f32_16x16x32_bf16 v[96:99],a[8:11],v[112:115],0
ds_read_b128 v[108:111],v6 offset:36864
v_mfma_f32_16x16x32_bf16 v[100:103],a[8:11],v[116:119],0
s_waitcnt lgkmcnt(2)
v_mfma_f32_16x16x32_bf16 v[88:91],a[4:7],v[120:123],v[88:91]
ds_read_b128 v[112:115],v7 offset:32768
v_mfma_f32_16x16x32_bf16 v[92:95],a[4:7],v[124:127],v[92:95]
v_cvt_pk_bf16_f32 v56,v24,v32
v_cvt_pk_bf16_f32 v57,v25,v33
v_mfma_f32_16x16x32_bf16 v[96:99],a[12:15],v[120:123],v[96:99]
ds_read_b128 v[116:119],v7 offset:36864
v_mfma_f32_16x16x32_bf16 v[100:103],a[12:15],v[124:127],v[100:103]
v_cvt_pk_bf16_f32 v58,v26,v34
v_cvt_pk_bf16_f32 v59,v27,v35
s_waitcnt lgkmcnt(2)
v_mfma_f32_16x16x32_bf16 v[88:91],a[16:19],v[104:107],v[88:91]
ds_read_b128 v[120:123],v4 offset:40960
v_mfma_f32_16x16x32_bf16 v[92:95],a[16:19],v[108:111],v[92:95]
buffer_store_dwordx4 v[56:59],v0,s[8:11],s61 offen sc1
v_cvt_pk_bf16_f32 v60,v28,v36
v_mfma_f32_16x16x32_bf16 v[96:99],a[24:27],v[104:107],v[96:99]
ds_read_b128 v[124:127],v4 offset:45056
v_mfma_f32_16x16x32_bf16 v[100:103],a[24:27],v[108:111],v[100:103]
v_cvt_pk_bf16_f32 v61,v29,v37
v_cvt_pk_bf16_f32 v62,v30,v38
s_waitcnt lgkmcnt(2)
v_mfma_f32_16x16x32_bf16 v[88:91],a[20:23],v[112:115],v[88:91]
ds_read_b128 v[104:107],v5 offset:40960
v_mfma_f32_16x16x32_bf16 v[92:95],a[20:23],v[116:119],v[92:95]
v_cvt_pk_bf16_f32 v63,v31,v39
buffer_store_dwordx4 v[60:63],v0,s[8:11],s62 offen sc1
v_mfma_f32_16x16x32_bf16 v[96:99],a[28:31],v[112:115],v[96:99]
ds_read_b128 v[108:111],v5 offset:45056
v_mfma_f32_16x16x32_bf16 v[100:103],a[28:31],v[116:119],v[100:103]
v_cvt_pk_bf16_f32 v64,v40,v41
v_cvt_pk_bf16_f32 v65,v42,v43
s_waitcnt lgkmcnt(2)
v_mfma_f32_16x16x32_bf16 v[88:91],a[32:35],v[120:123],v[88:91]
ds_read_b128 v[112:115],v6 offset:40960
v_mfma_f32_16x16x32_bf16 v[92:95],a[32:35],v[124:127],v[92:95]
v_cvt_pk_bf16_f32 v66,v44,v45
v_cvt_pk_bf16_f32 v67,v46,v47
v_mfma_f32_16x16x32_bf16 v[96:99],a[40:43],v[120:123],v[96:99]
ds_read_b128 v[116:119],v6 offset:45056
v_mfma_f32_16x16x32_bf16 v[100:103],a[40:43],v[124:127],v[100:103]
buffer_store_dwordx4 v[64:67],v0,s[8:11],s65 offen offset:0 sc1
v_cvt_pk_bf16_f32 v68,v48,v49
s_waitcnt lgkmcnt(2)
v_mfma_f32_16x16x32_bf16 v[88:91],a[36:39],v[104:107],v[88:91]
ds_read_b128 v[120:123],v7 offset:40960
v_mfma_f32_16x16x32_bf16 v[92:95],a[36:39],v[108:111],v[92:95]
v_cvt_pk_bf16_f32 v69,v50,v51
v_cvt_pk_bf16_f32 v70,v52,v53
v_mfma_f32_16x16x32_bf16 v[96:99],a[44:47],v[104:107],v[96:99]
ds_read_b128 v[124:127],v7 offset:45056
v_mfma_f32_16x16x32_bf16 v[100:103],a[44:47],v[108:111],v[100:103]
v_cvt_pk_bf16_f32 v71,v54,v55
buffer_store_dwordx4 v[68:71],v0,s[8:11],s65 offen offset:1024 sc1
s_waitcnt lgkmcnt(2)
v_mfma_f32_16x16x32_bf16 v[88:91],a[48:51],v[112:115],v[88:91]
ds_read_b128 v[104:107],v4 offset:49152
v_mfma_f32_16x16x32_bf16 v[92:95],a[48:51],v[116:119],v[92:95]
v_mfma_f32_16x16x32_bf16 v[96:99],a[56:59],v[112:115],v[96:99]
ds_read_b128 v[108:111],v4 offset:53248
v_mfma_f32_16x16x32_bf16 v[100:103],a[56:59],v[116:119],v[100:103]
s_waitcnt lgkmcnt(2)
v_mfma_f32_16x16x32_bf16 v[88:91],a[52:55],v[120:123],v[88:91]
ds_read_b128 v[112:115],v5 offset:49152
v_mfma_f32_16x16x32_bf16 v[92:95],a[52:55],v[124:127],v[92:95]
v_mfma_f32_16x16x32_bf16 v[96:99],a[60:63],v[120:123],v[96:99]
ds_read_b128 v[116:119],v5 offset:53248
v_mfma_f32_16x16x32_bf16 v[100:103],a[60:63],v[124:127],v[100:103]
s_waitcnt lgkmcnt(2)
v_mfma_f32_16x16x32_bf16 v[88:91],a[64:67],v[104:107],v[88:91]
ds_read_b128 v[120:123],v6 offset:49152
v_mfma_f32_16x16x32_bf16 v[92:95],a[64:67],v[108:111],v[92:95]
v_mfma_f32_16x16x32_bf16 v[96:99],a[72:75],v[104:107],v[96:99]
ds_read_b128 v[124:127],v6 offset:53248
v_mfma_f32_16x16x32_bf16 v[100:103],a[72:75],v[108:111],v[100:103]
s_waitcnt lgkmcnt(2)
v_mfma_f32_16x16x32_bf16 v[88:91],a[68:71],v[112:115],v[88:91]
ds_read_b128 v[104:107],v7 offset:49152
v_mfma_f32_16x16x32_bf16 v[92:95],a[68:71],v[116:119],v[92:95]
v_mfma_f32_16x16x32_bf16 v[96:99],a[76:79],v[112:115],v[96:99]
ds_read_b128 v[108:111],v7 offset:53248
v_mfma_f32_16x16x32_bf16 v[100:103],a[76:79],v[116:119],v[100:103]
s_waitcnt lgkmcnt(2)
v_mfma_f32_16x16x32_bf16 v[88:91],a[80:83],v[120:123],v[88:91]
ds_read_b128 v[112:115],v4 offset:57344
v_mfma_f32_16x16x32_bf16 v[92:95],a[80:83],v[124:127],v[92:95]
v_mfma_f32_16x16x32_bf16 v[96:99],a[88:91],v[120:123],v[96:99]
ds_read_b128 v[116:119],v4 offset:61440
v_mfma_f32_16x16x32_bf16 v[100:103],a[88:91],v[124:127],v[100:103]
s_waitcnt lgkmcnt(2)
v_mfma_f32_16x16x32_bf16 v[88:91],a[84:87],v[104:107],v[88:91]
ds_read_b128 v[120:123],v5 offset:57344
v_mfma_f32_16x16x32_bf16 v[92:95],a[84:87],v[108:111],v[92:95]
v_mfma_f32_16x16x32_bf16 v[96:99],a[92:95],v[104:107],v[96:99]
ds_read_b128 v[124:127],v5 offset:61440
v_mfma_f32_16x16x32_bf16 v[100:103],a[92:95],v[108:111],v[100:103]
s_waitcnt lgkmcnt(2)
v_mfma_f32_16x16x32_bf16 v[88:91],a[96:99],v[112:115],v[88:91]
ds_read_b128 v[104:107],v6 offset:57344
v_mfma_f32_16x16x32_bf16 v[92:95],a[96:99],v[116:119],v[92:95]
v_mfma_f32_16x16x32_bf16 v[96:99],a[104:107],v[112:115],v[96:99]
ds_read_b128 v[108:111],v6 offset:61440
v_mfma_f32_16x16x32_bf16 v[100:103],a[104:107],v[116:119],v[100:103]
s_waitcnt lgkmcnt(2)
v_mfma_f32_16x16x32_bf16 v[88:91],a[100:103],v[120:123],v[88:91]
ds_read_b128 v[112:115],v7 offset:57344
v_mfma_f32_16x16x32_bf16 v[92:95],a[100:103],v[124:127],v[92:95]
v_mfma_f32_16x16x32_bf16 v[96:99],a[108:111],v[120:123],v[96:99]
ds_read_b128 v[116:119],v7 offset:61440
v_mfma_f32_16x16x32_bf16 v[100:103],a[108:111],v[124:127],v[100:103]
s_waitcnt lgkmcnt(2)
v_mfma_f32_16x16x32_bf16 v[88:91],a[112:115],v[104:107],v[88:91]
v_mfma_f32_16x16x32_bf16 v[92:95],a[112:115],v[108:111],v[92:95]
v_mfma_f32_16x16x32_bf16 v[96:99],a[120:123],v[104:107],v[96:99]
v_mfma_f32_16x16x32_bf16 v[100:103],a[120:123],v[108:111],v[100:103]
s_waitcnt lgkmcnt(0)
v_mfma_f32_16x16x32_bf16 v[88:91],a[116:119],v[112:115],v[88:91]
v_mfma_f32_16x16x32_bf16 v[92:95],a[116:119],v[116:119],v[92:95]
v_mfma_f32_16x16x32_bf16 v[96:99],a[124:127],v[112:115],v[96:99]
v_mfma_f32_16x16x32_bf16 v[100:103],a[124:127],v[116:119],v[100:103]
s_nop 3
v_cvt_pk_bf16_f32 v104,v88,v96
v_cvt_pk_bf16_f32 v105,v89,v97
v_cvt_pk_bf16_f32 v106,v90,v98
v_cvt_pk_bf16_f32 v107,v91,v99
v_cvt_pk_bf16_f32 v108,v92,v100
v_cvt_pk_bf16_f32 v109,v93,v101
v_cvt_pk_bf16_f32 v110,v94,v102
v_cvt_pk_bf16_f32 v111,v95,v103
buffer_store_dwordx4 v[104:107],v0,s[8:11],s63 offen sc1
buffer_store_dwordx4 v[108:111],v0,s[8:11],s64 offen sc1
s_waitcnt vmcnt(6)
s_barrier
s_lshl_b32 s70,s51,13
s_lshl2_add_u32 s70,s47,s70
s_add_u32 s70,s70,10485760
L_pn_14:
s_add_u32 s54,s54,2
s_cmp_lt_u32 s54,64
s_cbranch_scc1 L_pl_13
s_waitcnt vmcnt(0)
s_barrier
s_or_b32 s70,s70,s52
buffer_store_dword v17,off,s[8:11],s70 sc1
s_endpgm
L_rm_5:
v_and_b32 v33,15,v1
v_lshrrev_b32 v34,4,v1
s_min_u32 s60,s47,27
s_lshl_b32 s60,s60,7
s_mul_i32 s59,s46,458752
s_add_u32 s60,s60,s59
v_mul_u32_u24 v36,114688,v34
v_and_b32 v35,7,v33
v_lshl_add_u32 v36,v35,4,v36
v_add_u32 v36,s60,v36
v_cmp_gt_u32 vcc,8,v33
v_mov_b32 v38,s36
v_mov_b32 v39,s37
v_mov_b32 v40,s34
v_mov_b32 v41,s35
v_cndmask_b32 v38,v38,v40,vcc
v_cndmask_b32 v39,v39,v41,vcc
v_add_co_u32 v38,vcc,v38,v36
s_nop 1
v_addc_co_u32 v39,vcc,0,v39,vcc
s_lshl_b32 s56,s46,15
v_add_u32 v37,s56,v0
global_load_dwordx4 v[44:47],v[38:39],off
v_add_co_u32 v38,vcc,3584,v38
s_nop 1
v_addc_co_u32 v39,vcc,0,v39,vcc
global_load_dwordx4 v[48:51],v[38:39],off
v_add_co_u32 v38,vcc,3584,v38
s_nop 1
v_addc_co_u32 v39,vcc,0,v39,vcc
global_load_dwordx4 v[52:55],v[38:39],off
v_add_co_u32 v38,vcc,3584,v38
s_nop 1
v_addc_co_u32 v39,vcc,0,v39,vcc
global_load_dwordx4 v[56:59],v[38:39],off
v_add_co_u32 v38,vcc,3584,v38
s_nop 1
v_addc_co_u32 v39,vcc,0,v39,vcc
global_load_dwordx4 v[60:63],v[38:39],off
v_add_co_u32 v38,vcc,3584,v38
s_nop 1
v_addc_co_u32 v39,vcc,0,v39,vcc
global_load_dwordx4 v[64:67],v[38:39],off
v_add_co_u32 v38,vcc,3584,v38
s_nop 1
v_addc_co_u32 v39,vcc,0,v39,vcc
global_load_dwordx4 v[68:71],v[38:39],off
v_add_co_u32 v38,vcc,3584,v38
s_nop 1
v_addc_co_u32 v39,vcc,0,v39,vcc
global_load_dwordx4 v[72:75],v[38:39],off
v_add_co_u32 v38,vcc,3584,v38
s_nop 1
v_addc_co_u32 v39,vcc,0,v39,vcc
global_load_dwordx4 v[76:79],v[38:39],off
v_add_co_u32 v38,vcc,3584,v38
s_nop 1
v_addc_co_u32 v39,vcc,0,v39,vcc
global_load_dwordx4 v[80:83],v[38:39],off
v_add_co_u32 v38,vcc,3584,v38
s_nop 1
v_addc_co_u32 v39,vcc,0,v39,vcc
global_load_dwordx4 v[84:87],v[38:39],off
v_add_co_u32 v38,vcc,3584,v38
s_nop 1
v_addc_co_u32 v39,vcc,0,v39,vcc
global_load_dwordx4 v[88:91],v[38:39],off
v_add_co_u32 v38,vcc,3584,v38
s_nop 1
v_addc_co_u32 v39,vcc,0,v39,vcc
global_load_dwordx4 v[92:95],v[38:39],off
v_add_co_u32 v38,vcc,3584,v38
s_nop 1
v_addc_co_u32 v39,vcc,0,v39,vcc
global_load_dwordx4 v[96:99],v[38:39],off
v_add_co_u32 v38,vcc,3584,v38
s_nop 1
v_addc_co_u32 v39,vcc,0,v39,vcc
global_load_dwordx4 v[100:103],v[38:39],off
v_add_co_u32 v38,vcc,3584,v38
s_nop 1
v_addc_co_u32 v39,vcc,0,v39,vcc
global_load_dwordx4 v[104:107],v[38:39],off
v_add_co_u32 v38,vcc,3584,v38
s_nop 1
v_addc_co_u32 v39,vcc,0,v39,vcc
s_waitcnt vmcnt(15)
ds_write_b128 v37,v[44:47] offset:0
s_waitcnt vmcnt(14)
ds_write_b128 v37,v[48:51] offset:1024
s_waitcnt vmcnt(13)
ds_write_b128 v37,v[52:55] offset:2048
s_waitcnt vmcnt(12)
ds_write_b128 v37,v[56:59] offset:3072
s_waitcnt vmcnt(11)
ds_write_b128 v37,v[60:63] offset:4096
s_waitcnt vmcnt(10)
ds_write_b128 v37,v[64:67] offset:5120
s_waitcnt vmcnt(9)
ds_write_b128 v37,v[68:71] offset:6144
s_waitcnt vmcnt(8)
ds_write_b128 v37,v[72:75] offset:7168
s_waitcnt lgkmcnt(0)
s_waitcnt vmcnt(7)
ds_write_b128 v37,v[76:79] offset:8192
s_waitcnt vmcnt(6)
ds_write_b128 v37,v[80:83] offset:9216
s_waitcnt vmcnt(5)
ds_write_b128 v37,v[84:87] offset:10240
s_waitcnt vmcnt(4)
ds_write_b128 v37,v[88:91] offset:11264
s_waitcnt vmcnt(3)
ds_write_b128 v37,v[92:95] offset:12288
s_waitcnt vmcnt(2)
ds_write_b128 v37,v[96:99] offset:13312
s_waitcnt vmcnt(1)
ds_write_b128 v37,v[100:103] offset:14336
s_waitcnt vmcnt(0)
ds_write_b128 v37,v[104:107] offset:15360
s_waitcnt lgkmcnt(0)
global_load_dwordx4 v[44:47],v[38:39],off
v_add_co_u32 v38,vcc,3584,v38
s_nop 1
v_addc_co_u32 v39,vcc,0,v39,vcc
global_load_dwordx4 v[48:51],v[38:39],off
v_add_co_u32 v38,vcc,3584,v38
s_nop 1
v_addc_co_u32 v39,vcc,0,v39,vcc
global_load_dwordx4 v[52:55],v[38:39],off
v_add_co_u32 v38,vcc,3584,v38
s_nop 1
v_addc_co_u32 v39,vcc,0,v39,vcc
global_load_dwordx4 v[56:59],v[38:39],off
v_add_co_u32 v38,vcc,3584,v38
s_nop 1
v_addc_co_u32 v39,vcc,0,v39,vcc
global_load_dwordx4 v[60:63],v[38:39],off
v_add_co_u32 v38,vcc,3584,v38
s_nop 1
v_addc_co_u32 v39,vcc,0,v39,vcc
global_load_dwordx4 v[64:67],v[38:39],off
v_add_co_u32 v38,vcc,3584,v38
s_nop 1
v_addc_co_u32 v39,vcc,0,v39,vcc
global_load_dwordx4 v[68:71],v[38:39],off
v_add_co_u32 v38,vcc,3584,v38
s_nop 1
v_addc_co_u32 v39,vcc,0,v39,vcc
global_load_dwordx4 v[72:75],v[38:39],off
v_add_co_u32 v38,vcc,3584,v38
s_nop 1
v_addc_co_u32 v39,vcc,0,v39,vcc
global_load_dwordx4 v[76:79],v[38:39],off
v_add_co_u32 v38,vcc,3584,v38
s_nop 1
v_addc_co_u32 v39,vcc,0,v39,vcc
global_load_dwordx4 v[80:83],v[38:39],off
v_add_co_u32 v38,vcc,3584,v38
s_nop 1
v_addc_co_u32 v39,vcc,0,v39,vcc
global_load_dwordx4 v[84:87],v[38:39],off
v_add_co_u32 v38,vcc,3584,v38
s_nop 1
v_addc_co_u32 v39,vcc,0,v39,vcc
global_load_dwordx4 v[88:91],v[38:39],off
v_add_co_u32 v38,vcc,3584,v38
s_nop 1
v_addc_co_u32 v39,vcc,0,v39,vcc
global_load_dwordx4 v[92:95],v[38:39],off
v_add_co_u32 v38,vcc,3584,v38
s_nop 1
v_addc_co_u32 v39,vcc,0,v39,vcc
global_load_dwordx4 v[96:99],v[38:39],off
v_add_co_u32 v38,vcc,3584,v38
s_nop 1
v_addc_co_u32 v39,vcc,0,v39,vcc
global_load_dwordx4 v[100:103],v[38:39],off
v_add_co_u32 v38,vcc,3584,v38
s_nop 1
v_addc_co_u32 v39,vcc,0,v39,vcc
global_load_dwordx4 v[104:107],v[38:39],off
v_add_co_u32 v38,vcc,3584,v38
s_nop 1
v_addc_co_u32 v39,vcc,0,v39,vcc
s_waitcnt vmcnt(15)
ds_write_b128 v37,v[44:47] offset:16384
s_waitcnt vmcnt(14)
ds_write_b128 v37,v[48:51] offset:17408
s_waitcnt vmcnt(13)
ds_write_b128 v37,v[52:55] offset:18432
s_waitcnt vmcnt(12)
ds_write_b128 v37,v[56:59] offset:19456
s_waitcnt vmcnt(11)
ds_write_b128 v37,v[60:63] offset:20480
s_waitcnt vmcnt(10)
ds_write_b128 v37,v[64:67] offset:21504
s_waitcnt vmcnt(9)
ds_write_b128 v37,v[68:71] offset:22528
s_waitcnt vmcnt(8)
ds_write_b128 v37,v[72:75] offset:23552
s_waitcnt lgkmcnt(0)
s_waitcnt vmcnt(7)
ds_write_b128 v37,v[76:79] offset:24576
s_waitcnt vmcnt(6)
ds_write_b128 v37,v[80:83] offset:25600
s_waitcnt vmcnt(5)
ds_write_b128 v37,v[84:87] offset:26624
s_waitcnt vmcnt(4)
ds_write_b128 v37,v[88:91] offset:27648
s_waitcnt vmcnt(3)
ds_write_b128 v37,v[92:95] offset:28672
s_waitcnt vmcnt(2)
ds_write_b128 v37,v[96:99] offset:29696
s_waitcnt vmcnt(1)
ds_write_b128 v37,v[100:103] offset:30720
s_waitcnt vmcnt(0)
ds_write_b128 v37,v[104:107] offset:31744
s_waitcnt lgkmcnt(0)
v_mov_b32 v123,159744
s_cmp_lg_u32 s46,0
s_cbranch_scc1 L_gbd_17
v_mov_b32 v124,128
L_gb_16:
buffer_load_dword v125,v124,s[12:15],0 offen sc1
s_waitcnt vmcnt(0)
v_readfirstlane_b32 s56,v125
ds_write_b32 v123,v125
s_bitcmp1_b32 s56,8
s_cbranch_scc1 L_gbd_17
s_sleep 4
s_sub_u32 s49,s49,1
s_cmp_gt_i32 s49,0
s_cbranch_scc1 L_gb_16
s_branch L_abort
L_gbd_17:
s_waitcnt lgkmcnt(0)
s_barrier
ds_read_b32 v125,v123
s_waitcnt lgkmcnt(0)
v_readfirstlane_b32 s56,v125
s_barrier
s_lshr_b32 s56,s56,16
s_andn2_b32 s56,s56,s3
s_cbranch_scc1 L_spread
s_cmp_lg_u32 s3,0
s_cbranch_scc1 L_wm
v_and_b32 v120,15,v1
v_lshrrev_b32 v121,4,v1
v_mov_b32 v17,1
s_lshl_b32 s56,s46,15
v_add_u32 v18,s56,v0
s_lshl_b32 s56,s46,2
v_add_u32 v125,s56,v121
v_xor_b32 v126,v125,v120
v_lshlrev_b32 v126,4,v126
v_lshl_add_u32 v20,v125,10,v126
v_add_u32 v125,0,v121
v_xor_b32 v125,v125,v120
v_lshlrev_b32 v125,4,v125
v_lshl_add_u32 v125,v120,8,v125
v_add_u32 v4,131072,v125
v_add_u32 v125,4,v121
v_xor_b32 v125,v125,v120
v_lshlrev_b32 v125,4,v125
v_lshl_add_u32 v125,v120,8,v125
v_add_u32 v5,131072,v125
v_add_u32 v125,8,v121
v_xor_b32 v125,v125,v120
v_lshlrev_b32 v125,4,v125
v_lshl_add_u32 v125,v120,8,v125
v_add_u32 v6,131072,v125
v_add_u32 v125,12,v121
v_xor_b32 v125,v125,v120
v_lshlrev_b32 v125,4,v125
v_lshl_add_u32 v125,v120,8,v125
v_add_u32 v7,131072,v125
v_lshlrev_b32 v21,5,v120
v_and_b32 v125,1,v121
v_lshl_add_u32 v21,v125,4,v21
s_lshl_b32 s56,s46,9
v_lshrrev_b32 v125,1,v121
v_lshl_add_u32 v21,v125,11,v21
s_add_u32 s56,s56,155648
v_add_u32 v21,s56,v21
v_lshlrev_b32 v22,4,v120
v_lshl_add_u32 v22,v121,10,v22
s_lshl_b32 s56,s46,8
v_add_u32 v22,s56,v22
s_mov_b32 s54,0
s_mov_b32 s31,0
s_mov_b32 s53,3
s_mov_b32 s72,0x80000000
s_mov_b32 s73,0
s_mov_b32 s77,-1
s_mov_b64 s[84:85],0
s_mov_b32 s74,614203392
s_mov_b32 s75,1227133513
s_ff1_i32_b64 s30,s[74:75]
s_bitset0_b64 s[74:75],s30
s_min_u32 s30,s30,127
s_lshl_b32 s70,s30,15
s_add_u32 s70,s70,0
s_add_u32 s71,s70,16384
s_add_u32 m0,s50,131072
s_nop 0
buffer_load_dwordx4 v20,s[8:11],s70 offen offset:0 sc1 lds
s_add_u32 m0,s50,135168
s_nop 0
buffer_load_dwordx4 v20,s[8:11],s71 offen offset:0 sc1 lds
s_add_u32 m0,s50,139008
s_nop 0
buffer_load_dwordx4 v20,s[8:11],s70 offen offset:256 sc1 lds
s_add_u32 m0,s50,143104
s_nop 0
buffer_load_dwordx4 v20,s[8:11],s71 offen offset:256 sc1 lds
s_add_u32 m0,s50,146944
s_nop 0
buffer_load_dwordx4 v20,s[8:11],s70 offen offset:512 sc1 lds
s_add_u32 m0,s50,151040
s_nop 0
buffer_load_dwordx4 v20,s[8:11],s71 offen offset:512 sc1 lds
v_and_b32 v23,31,v1
v_lshlrev_b32 v23,2,v23
s_waitcnt vmcnt(0)
L_mo_19:
s_mov_b32 s51,s30
s_mov_b64 s[68:69],s[70:71]
s_ff1_i32_b64 s30,s[74:75]
s_bitset0_b64 s[74:75],s30
s_min_u32 s30,s30,127
s_lshl_b32 s70,s30,15
s_add_u32 s70,s70,0
s_add_u32 s71,s70,16384
s_lshl_b32 s76,s31,13
s_add_u32 s76,s76,10487168
s_lshl_b32 s58,s51,5
s_add_u32 s58,s58,s47
s_mul_i32 s58,s58,24576
s_add_u32 s58,s58,100663296
s_add_u32 s61,s58,s50
s_add_u32 s62,s61,4096
s_add_u32 s63,s61,16384
s_add_u32 s64,s61,20480
s_add_u32 s65,s61,s50
s_add_u32 s65,s65,8192
s_waitcnt vmcnt(13)
s_barrier
ds_read_b128 v[72:75],v4 offset:0
ds_read_b128 v[76:79],v4 offset:4096
ds_read_b128 v[80:83],v5 offset:0
ds_read_b128 v[84:87],v5 offset:4096
s_add_u32 m0,s50,154880
s_nop 0
buffer_load_dwordx4 v20,s[8:11],s68 offen offset:768 sc1 lds
s_add_u32 m0,s50,158976
s_nop 0
buffer_load_dwordx4 v20,s[8:11],s69 offen offset:768 sc1 lds
s_waitcnt lgkmcnt(2)
v_mfma_f32_16x16x32_bf16 v[40:43],a[128:131],v[72:75],0
ds_read_b128 v[108:111],v6 offset:0
v_mfma_f32_16x16x32_bf16 v[56:59],v[72:75],v[128:131],0
v_mfma_f32_16x16x32_bf16 v[24:27],a[0:3],v[72:75],0
ds_read_b128 v[112:115],v6 offset:4096
v_mfma_f32_16x16x32_bf16 v[44:47],a[128:131],v[76:79],0
v_mfma_f32_16x16x32_bf16 v[60:63],v[76:79],v[128:131],0
v_mfma_f32_16x16x32_bf16 v[28:31],a[0:3],v[76:79],0
v_mfma_f32_16x16x32_bf16 v[48:51],a[136:139],v[72:75],0
v_mfma_f32_16x16x32_bf16 v[64:67],v[72:75],v[136:139],0
v_mfma_f32_16x16x32_bf16 v[32:35],a[8:11],v[72:75],0
v_mfma_f32_16x16x32_bf16 v[52:55],a[136:139],v[76:79],0
v_mfma_f32_16x16x32_bf16 v[68:71],v[76:79],v[136:139],0
v_mfma_f32_16x16x32_bf16 v[36:39],a[8:11],v[76:79],0
s_waitcnt lgkmcnt(2)
v_mfma_f32_16x16x32_bf16 v[40:43],a[132:135],v[80:83],v[40:43]
ds_read_b128 v[72:75],v7 offset:0
v_mfma_f32_16x16x32_bf16 v[56:59],v[80:83],v[132:135],v[56:59]
v_mfma_f32_16x16x32_bf16 v[24:27],a[4:7],v[80:83],v[24:27]
ds_read_b128 v[76:79],v7 offset:4096
v_mfma_f32_16x16x32_bf16 v[44:47],a[132:135],v[84:87],v[44:47]
v_mfma_f32_16x16x32_bf16 v[60:63],v[84:87],v[132:135],v[60:63]
v_mfma_f32_16x16x32_bf16 v[28:31],a[4:7],v[84:87],v[28:31]
v_mfma_f32_16x16x32_bf16 v[48:51],a[140:143],v[80:83],v[48:51]
v_mfma_f32_16x16x32_bf16 v[64:67],v[80:83],v[140:143],v[64:67]
v_mfma_f32_16x16x32_bf16 v[32:35],a[12:15],v[80:83],v[32:35]
v_mfma_f32_16x16x32_bf16 v[52:55],a[140:143],v[84:87],v[52:55]
v_mfma_f32_16x16x32_bf16 v[68:71],v[84:87],v[140:143],v[68:71]
v_mfma_f32_16x16x32_bf16 v[36:39],a[12:15],v[84:87],v[36:39]
s_waitcnt vmcnt(13)
s_barrier
s_waitcnt lgkmcnt(2)
v_mfma_f32_16x16x32_bf16 v[40:43],a[144:147],v[108:111],v[40:43]
ds_read_b128 v[80:83],v4 offset:8192
v_mfma_f32_16x16x32_bf16 v[56:59],v[108:111],v[144:147],v[56:59]
v_mfma_f32_16x16x32_bf16 v[24:27],a[16:19],v[108:111],v[24:27]
ds_read_b128 v[84:87],v4 offset:12288
v_mfma_f32_16x16x32_bf16 v[44:47],a[144:147],v[112:115],v[44:47]
v_mfma_f32_16x16x32_bf16 v[60:63],v[112:115],v[144:147],v[60:63]
v_mfma_f32_16x16x32_bf16 v[28:31],a[16:19],v[112:115],v[28:31]
v_mfma_f32_16x16x32_bf16 v[48:51],a[152:155],v[108:111],v[48:51]
v_mfma_f32_16x16x32_bf16 v[64:67],v[108:111],v[152:155],v[64:67]
v_mfma_f32_16x16x32_bf16 v[32:35],a[24:27],v[108:111],v[32:35]
v_mfma_f32_16x16x32_bf16 v[52:55],a[152:155],v[112:115],v[52:55]
v_mfma_f32_16x16x32_bf16 v[68:71],v[112:115],v[152:155],v[68:71]
v_mfma_f32_16x16x32_bf16 v[36:39],a[24:27],v[112:115],v[36:39]
s_waitcnt lgkmcnt(2)
v_mfma_f32_16x16x32_bf16 v[40:43],a[148:151],v[72:75],v[40:43]
ds_read_b128 v[108:111],v5 offset:8192
v_mfma_f32_16x16x32_bf16 v[56:59],v[72:75],v[148:151],v[56:59]
v_mfma_f32_16x16x32_bf16 v[24:27],a[20:23],v[72:75],v[24:27]
ds_read_b128 v[112:115],v5 offset:12288
v_mfma_f32_16x16x32_bf16 v[44:47],a[148:151],v[76:79],v[44:47]
v_mfma_f32_16x16x32_bf16 v[60:63],v[76:79],v[148:151],v[60:63]
v_mfma_f32_16x16x32_bf16 v[28:31],a[20:23],v[76:79],v[28:31]
v_mfma_f32_16x16x32_bf16 v[48:51],a[156:159],v[72:75],v[48:51]
v_mfma_f32_16x16x32_bf16 v[64:67],v[72:75],v[156:159],v[64:67]
v_mfma_f32_16x16x32_bf16 v[32:35],a[28:31],v[72:75],v[32:35]
v_mfma_f32_16x16x32_bf16 v[52:55],a[156:159],v[76:79],v[52:55]
v_mfma_f32_16x16x32_bf16 v[68:71],v[76:79],v[156:159],v[68:71]
v_mfma_f32_16x16x32_bf16 v[36:39],a[28:31],v[76:79],v[36:39]
s_waitcnt lgkmcnt(2)
v_mfma_f32_16x16x32_bf16 v[40:43],a[160:163],v[80:83],v[40:43]
ds_read_b128 v[72:75],v6 offset:8192
v_mfma_f32_16x16x32_bf16 v[56:59],v[80:83],v[160:163],v[56:59]
v_mfma_f32_16x16x32_bf16 v[24:27],a[32:35],v[80:83],v[24:27]
ds_read_b128 v[76:79],v6 offset:12288
v_mfma_f32_16x16x32_bf16 v[44:47],a[160:163],v[84:87],v[44:47]
v_mfma_f32_16x16x32_bf16 v[60:63],v[84:87],v[160:163],v[60:63]
v_mfma_f32_16x16x32_bf16 v[28:31],a[32:35],v[84:87],v[28:31]
v_mfma_f32_16x16x32_bf16 v[48:51],a[168:171],v[80:83],v[48:51]
v_mfma_f32_16x16x32_bf16 v[64:67],v[80:83],v[168:171],v[64:67]
v_mfma_f32_16x16x32_bf16 v[32:35],a[40:43],v[80:83],v[32:35]
v_mfma_f32_16x16x32_bf16 v[52:55],a[168:171],v[84:87],v[52:55]
v_mfma_f32_16x16x32_bf16 v[68:71],v[84:87],v[168:171],v[68:71]
v_mfma_f32_16x16x32_bf16 v[36:39],a[40:43],v[84:87],v[36:39]
s_waitcnt lgkmcnt(2)
v_mfma_f32_16x16x32_bf16 v[40:43],a[164:167],v[108:111],v[40:43]
ds_read_b128 v[80:83],v7 offset:8192
v_mfma_f32_16x16x32_bf16 v[56:59],v[108:111],v[164:167],v[56:59]
v_mfma_f32_16x16x32_bf16 v[24:27],a[36:39],v[108:111],v[24:27]
ds_read_b128 v[84:87],v7 offset:12288
v_mfma_f32_16x16x32_bf16 v[44:47],a[164:167],v[112:115],v[44:47]
v_mfma_f32_16x16x32_bf16 v[60:63],v[112:115],v[164:167],v[60:63]
v_mfma_f32_16x16x32_bf16 v[28:31],a[36:39],v[112:115],v[28:31]
v_mfma_f32_16x16x32_bf16 v[48:51],a[172:175],v[108:111],v[48:51]
v_mfma_f32_16x16x32_bf16 v[64:67],v[108:111],v[172:175],v[64:67]
v_mfma_f32_16x16x32_bf16 v[32:35],a[44:47],v[108:111],v[32:35]
v_mfma_f32_16x16x32_bf16 v[52:55],a[172:175],v[112:115],v[52:55]
v_mfma_f32_16x16x32_bf16 v[68:71],v[112:115],v[172:175],v[68:71]
v_mfma_f32_16x16x32_bf16 v[36:39],a[44:47],v[112:115],v[36:39]
s_waitcnt vmcnt(11)
s_barrier
s_waitcnt lgkmcnt(2)
v_mfma_f32_16x16x32_bf16 v[40:43],a[176:179],v[72:75],v[40:43]
ds_read_b128 v[108:111],v4 offset:16384
v_mfma_f32_16x16x32_bf16 v[56:59],v[72:75],v[176:179],v[56:59]
v_mfma_f32_16x16x32_bf16 v[24:27],a[48:51],v[72:75],v[24:27]
ds_read_b128 v[112:115],v4 offset:20480
v_mfma_f32_16x16x32_bf16 v[44:47],a[176:179],v[76:79],v[44:47]
v_mfma_f32_16x16x32_bf16 v[60:63],v[76:79],v[176:179],v[60:63]
v_mfma_f32_16x16x32_bf16 v[28:31],a[48:51],v[76:79],v[28:31]
v_mfma_f32_16x16x32_bf16 v[48:51],a[184:187],v[72:75],v[48:51]
v_mfma_f32_16x16x32_bf16 v[64:67],v[72:75],v[184:187],v[64:67]
v_mfma_f32_16x16x32_bf16 v[32:35],a[56:59],v[72:75],v[32:35]
v_mfma_f32_16x16x32_bf16 v[52:55],a[184:187],v[76:79],v[52:55]
v_mfma_f32_16x16x32_bf16 v[68:71],v[76:79],v[184:187],v[68:71]
v_mfma_f32_16x16x32_bf16 v[36:39],a[56:59],v[76:79],v[36:39]
s_waitcnt vmcnt(2)
s_barrier
s_or_b32 s72,s72,s52
buffer_store_dword v17,off,s[8:11],s72 sc1
s_waitcnt lgkmcnt(2)
v_mfma_f32_16x16x32_bf16 v[40:43],a[180:183],v[80:83],v[40:43]
ds_read_b128 v[72:75],v5 offset:16384
v_mfma_f32_16x16x32_bf16 v[56:59],v[80:83],v[180:183],v[56:59]
v_mfma_f32_16x16x32_bf16 v[24:27],a[52:55],v[80:83],v[24:27]
ds_read_b128 v[76:79],v5 offset:20480
v_mfma_f32_16x16x32_bf16 v[44:47],a[180:183],v[84:87],v[44:47]
v_mfma_f32_16x16x32_bf16 v[60:63],v[84:87],v[180:183],v[60:63]
v_mfma_f32_16x16x32_bf16 v[28:31],a[52:55],v[84:87],v[28:31]
v_mfma_f32_16x16x32_bf16 v[48:51],a[188:191],v[80:83],v[48:51]
v_mfma_f32_16x16x32_bf16 v[64:67],v[80:83],v[188:191],v[64:67]
v_mfma_f32_16x16x32_bf16 v[32:35],a[60:63],v[80:83],v[32:35]
v_mfma_f32_16x16x32_bf16 v[52:55],a[188:191],v[84:87],v[52:55]
v_mfma_f32_16x16x32_bf16 v[68:71],v[84:87],v[188:191],v[68:71]
v_mfma_f32_16x16x32_bf16 v[36:39],a[60:63],v[84:87],v[36:39]
s_waitcnt lgkmcnt(2)
v_mfma_f32_16x16x32_bf16 v[40:43],a[192:195],v[108:111],v[40:43]
ds_read_b128 v[80:83],v6 offset:16384
v_mfma_f32_16x16x32_bf16 v[56:59],v[108:111],v[192:195],v[56:59]
v_mfma_f32_16x16x32_bf16 v[24:27],a[64:67],v[108:111],v[24:27]
ds_read_b128 v[84:87],v6 offset:20480
v_mfma_f32_16x16x32_bf16 v[44:47],a[192:195],v[112:115],v[44:47]
v_mfma_f32_16x16x32_bf16 v[60:63],v[112:115],v[192:195],v[60:63]
v_mfma_f32_16x16x32_bf16 v[28:31],a[64:67],v[112:115],v[28:31]
v_mfma_f32_16x16x32_bf16 v[48:51],a[200:203],v[108:111],v[48:51]
v_mfma_f32_16x16x32_bf16 v[64:67],v[108:111],v[200:203],v[64:67]
v_mfma_f32_16x16x32_bf16 v[32:35],a[72:75],v[108:111],v[32:35]
v_mfma_f32_16x16x32_bf16 v[52:55],a[200:203],v[112:115],v[52:55]
v_mfma_f32_16x16x32_bf16 v[68:71],v[112:115],v[200:203],v[68:71]
v_mfma_f32_16x16x32_bf16 v[36:39],a[72:75],v[112:115],v[36:39]
s_waitcnt lgkmcnt(2)
v_mfma_f32_16x16x32_bf16 v[40:43],a[196:199],v[72:75],v[40:43]
ds_read_b128 v[108:111],v7 offset:16384
v_mfma_f32_16x16x32_bf16 v[56:59],v[72:75],v[196:199],v[56:59]
v_mfma_f32_16x16x32_bf16 v[24:27],a[68:71],v[72:75],v[24:27]
ds_read_b128 v[112:115],v7 offset:20480
v_mfma_f32_16x16x32_bf16 v[44:47],a[196:199],v[76:79],v[44:47]
v_mfma_f32_16x16x32_bf16 v[60:63],v[76:79],v[196:199],v[60:63]
v_mfma_f32_16x16x32_bf16 v[28:31],a[68:71],v[76:79],v[28:31]
v_mfma_f32_16x16x32_bf16 v[48:51],a[204:207],v[72:75],v[48:51]
v_mfma_f32_16x16x32_bf16 v[64:67],v[72:75],v[204:207],v[64:67]
v_mfma_f32_16x16x32_bf16 v[32:35],a[76:79],v[72:75],v[32:35]
v_mfma_f32_16x16x32_bf16 v[52:55],a[204:207],v[76:79],v[52:55]
v_mfma_f32_16x16x32_bf16 v[68:71],v[76:79],v[204:207],v[68:71]
v_mfma_f32_16x16x32_bf16 v[36:39],a[76:79],v[76:79],v[36:39]
s_waitcnt vmcnt(1)
s_barrier
s_waitcnt lgkmcnt(2)
v_mfma_f32_16x16x32_bf16 v[40:43],a[208:211],v[80:83],v[40:43]
ds_read_b128 v[72:75],v4 offset:24576
v_mfma_f32_16x16x32_bf16 v[56:59],v[80:83],v[208:211],v[56:59]
v_mfma_f32_16x16x32_bf16 v[24:27],a[80:83],v[80:83],v[24:27]
ds_read_b128 v[76:79],v4 offset:28672
v_mfma_f32_16x16x32_bf16 v[44:47],a[208:211],v[84:87],v[44:47]
v_mfma_f32_16x16x32_bf16 v[60:63],v[84:87],v[208:211],v[60:63]
v_mfma_f32_16x16x32_bf16 v[28:31],a[80:83],v[84:87],v[28:31]
v_mfma_f32_16x16x32_bf16 v[48:51],a[216:219],v[80:83],v[48:51]
v_mfma_f32_16x16x32_bf16 v[64:67],v[80:83],v[216:219],v[64:67]
v_mfma_f32_16x16x32_bf16 v[32:35],a[88:91],v[80:83],v[32:35]
v_mfma_f32_16x16x32_bf16 v[52:55],a[216:219],v[84:87],v[52:55]
v_mfma_f32_16x16x32_bf16 v[68:71],v[84:87],v[216:219],v[68:71]
v_mfma_f32_16x16x32_bf16 v[36:39],a[88:91],v[84:87],v[36:39]
s_waitcnt lgkmcnt(2)
v_mfma_f32_16x16x32_bf16 v[40:43],a[212:215],v[108:111],v[40:43]
ds_read_b128 v[80:83],v5 offset:24576
v_mfma_f32_16x16x32_bf16 v[56:59],v[108:111],v[212:215],v[56:59]
v_mfma_f32_16x16x32_bf16 v[24:27],a[84:87],v[108:111],v[24:27]
ds_read_b128 v[84:87],v5 offset:28672
v_mfma_f32_16x16x32_bf16 v[44:47],a[212:215],v[112:115],v[44:47]
v_mfma_f32_16x16x32_bf16 v[60:63],v[112:115],v[212:215],v[60:63]
v_mfma_f32_16x16x32_bf16 v[28:31],a[84:87],v[112:115],v[28:31]
v_mfma_f32_16x16x32_bf16 v[48:51],a[220:223],v[108:111],v[48:51]
v_mfma_f32_16x16x32_bf16 v[64:67],v[108:111],v[220:223],v[64:67]
v_mfma_f32_16x16x32_bf16 v[32:35],a[92:95],v[108:111],v[32:35]
v_mfma_f32_16x16x32_bf16 v[52:55],a[220:223],v[112:115],v[52:55]
v_mfma_f32_16x16x32_bf16 v[68:71],v[112:115],v[220:223],v[68:71]
v_mfma_f32_16x16x32_bf16 v[36:39],a[92:95],v[112:115],v[36:39]
s_barrier
s_waitcnt lgkmcnt(2)
v_mfma_f32_16x16x32_bf16 v[40:43],a[224:227],v[72:75],v[40:43]
ds_read_b128 v[108:111],v6 offset:24576
v_mfma_f32_16x16x32_bf16 v[56:59],v[72:75],v[224:227],v[56:59]
s_add_u32 m0,s50,131072
v_mfma_f32_16x16x32_bf16 v[24:27],a[96:99],v[72:75],v[24:27]
ds_read_b128 v[112:115],v6 offset:28672
v_mfma_f32_16x16x32_bf16 v[44:47],a[224:227],v[76:79],v[44:47]
buffer_load_dwordx4 v20,s[8:11],s70 offen offset:0 sc1 lds
v_mfma_f32_16x16x32_bf16 v[60:63],v[76:79],v[224:227],v[60:63]
s_add_u32 m0,s50,135168
v_mfma_f32_16x16x32_bf16 v[28:31],a[96:99],v[76:79],v[28:31]
buffer_load_dwordx4 v20,s[8:11],s71 offen offset:0 sc1 lds
v_mfma_f32_16x16x32_bf16 v[48:51],a[232:235],v[72:75],v[48:51]
s_add_u32 m0,s50,139008
v_mfma_f32_16x16x32_bf16 v[64:67],v[72:75],v[232:235],v[64:67]
buffer_load_dwordx4 v20,s[8:11],s70 offen offset:256 sc1 lds
v_mfma_f32_16x16x32_bf16 v[32:35],a[104:107],v[72:75],v[32:35]
s_add_u32 m0,s50,143104
v_mfma_f32_16x16x32_bf16 v[52:55],a[232:235],v[76:79],v[52:55]
buffer_load_dwordx4 v20,s[8:11],s71 offen offset:256 sc1 lds
v_mfma_f32_16x16x32_bf16 v[68:71],v[76:79],v[232:235],v[68:71]
s_add_u32 m0,s50,146944
v_mfma_f32_16x16x32_bf16 v[36:39],a[104:107],v[76:79],v[36:39]
buffer_load_dwordx4 v20,s[8:11],s70 offen offset:512 sc1 lds
s_waitcnt lgkmcnt(2)
v_mfma_f32_16x16x32_bf16 v[40:43],a[228:231],v[80:83],v[40:43]
ds_read_b128 v[72:75],v7 offset:24576
v_mfma_f32_16x16x32_bf16 v[56:59],v[80:83],v[228:231],v[56:59]
s_add_u32 m0,s50,151040
v_mfma_f32_16x16x32_bf16 v[24:27],a[100:103],v[80:83],v[24:27]
ds_read_b128 v[76:79],v7 offset:28672
v_mfma_f32_16x16x32_bf16 v[44:47],a[228:231],v[84:87],v[44:47]
buffer_load_dwordx4 v20,s[8:11],s71 offen offset:512 sc1 lds
v_mfma_f32_16x16x32_bf16 v[60:63],v[84:87],v[228:231],v[60:63]
buffer_load_dword v125,v23,s[8:11],s76 offen sc1
v_mfma_f32_16x16x32_bf16 v[28:31],a[100:103],v[84:87],v[28:31]
v_mfma_f32_16x16x32_bf16 v[48:51],a[236:239],v[80:83],v[48:51]
v_mfma_f32_16x16x32_bf16 v[64:67],v[80:83],v[236:239],v[64:67]
v_mfma_f32_16x16x32_bf16 v[32:35],a[108:111],v[80:83],v[32:35]
v_mfma_f32_16x16x32_bf16 v[52:55],a[236:239],v[84:87],v[52:55]
v_mfma_f32_16x16x32_bf16 v[68:71],v[84:87],v[236:239],v[68:71]
v_mfma_f32_16x16x32_bf16 v[36:39],a[108:111],v[84:87],v[36:39]
s_waitcnt lgkmcnt(2)
v_mfma_f32_16x16x32_bf16 v[40:43],a[240:243],v[108:111],v[40:43]
v_mfma_f32_16x16x32_bf16 v[56:59],v[108:111],v[240:243],v[56:59]
v_mfma_f32_16x16x32_bf16 v[24:27],a[112:115],v[108:111],v[24:27]
v_mfma_f32_16x16x32_bf16 v[44:47],a[240:243],v[112:115],v[44:47]
v_mfma_f32_16x16x32_bf16 v[60:63],v[112:115],v[240:243],v[60:63]
v_mfma_f32_16x16x32_bf16 v[28:31],a[112:115],v[112:115],v[28:31]
v_mfma_f32_16x16x32_bf16 v[48:51],a[248:251],v[108:111],v[48:51]
v_mfma_f32_16x16x32_bf16 v[64:67],v[108:111],v[248:251],v[64:67]
v_mfma_f32_16x16x32_bf16 v[32:35],a[120:123],v[108:111],v[32:35]
v_mfma_f32_16x16x32_bf16 v[52:55],a[248:251],v[112:115],v[52:55]
v_mfma_f32_16x16x32_bf16 v[68:71],v[112:115],v[248:251],v[68:71]
v_mfma_f32_16x16x32_bf16 v[36:39],a[120:123],v[112:115],v[36:39]
s_waitcnt lgkmcnt(0)
v_mfma_f32_16x16x32_bf16 v[40:43],a[244:247],v[72:75],v[40:43]
v_mfma_f32_16x16x32_bf16 v[56:59],v[72:75],v[244:247],v[56:59]
v_mfma_f32_16x16x32_bf16 v[24:27],a[116:119],v[72:75],v[24:27]
v_mfma_f32_16x16x32_bf16 v[44:47],a[244:247],v[76:79],v[44:47]
v_mfma_f32_16x16x32_bf16 v[60:63],v[76:79],v[244:247],v[60:63]
v_mfma_f32_16x16x32_bf16 v[28:31],a[116:119],v[76:79],v[28:31]
v_mfma_f32_16x16x32_bf16 v[48:51],a[252:255],v[72:75],v[48:51]
v_mfma_f32_16x16x32_bf16 v[64:67],v[72:75],v[252:255],v[64:67]
v_mfma_f32_16x16x32_bf16 v[32:35],a[124:127],v[72:75],v[32:35]
v_mfma_f32_16x16x32_bf16 v[52:55],a[252:255],v[76:79],v[52:55]
v_mfma_f32_16x16x32_bf16 v[68:71],v[76:79],v[252:255],v[68:71]
v_mfma_f32_16x16x32_bf16 v[36:39],a[124:127],v[76:79],v[36:39]
s_lshl_b32 s56,s51,5
s_add_u32 s56,s56,s47
s_lshl_b32 s56,s56,13
s_add_u32 s56,s56,s50
s_add_u32 s56,s56,41943040
s_add_u32 s57,s56,4096
v_mov_b64 v[120:121],-1
v_mov_b64 v[122:123],-1
buffer_store_dwordx4 v[120:123],v0,s[8:11],s56 offen sc1
buffer_store_dwordx4 v[120:123],v0,s[8:11],s57 offen sc1
v_cvt_pk_bf16_f32 v72,v40,v48
v_cvt_pk_bf16_f32 v73,v41,v49
v_cvt_pk_bf16_f32 v74,v42,v50
v_cvt_pk_bf16_f32 v75,v43,v51
buffer_store_dwordx4 v[72:75],v0,s[8:11],s61 offen sc1
v_cvt_pk_bf16_f32 v76,v44,v52
v_cvt_pk_bf16_f32 v77,v45,v53
v_cvt_pk_bf16_f32 v78,v46,v54
v_cvt_pk_bf16_f32 v79,v47,v55
buffer_store_dwordx4 v[76:79],v0,s[8:11],s62 offen sc1
v_cvt_pk_bf16_f32 v80,v56,v57
v_cvt_pk_bf16_f32 v81,v58,v59
v_cvt_pk_bf16_f32 v82,v60,v61
v_cvt_pk_bf16_f32 v83,v62,v63
buffer_store_dwordx4 v[80:83],v0,s[8:11],s65 offen offset:0 sc1
v_cvt_pk_bf16_f32 v84,v64,v65
v_cvt_pk_bf16_f32 v85,v66,v67
v_cvt_pk_bf16_f32 v86,v68,v69
v_cvt_pk_bf16_f32 v87,v70,v71
buffer_store_dwordx4 v[84:87],v0,s[8:11],s65 offen offset:1024 sc1
v_cvt_pk_bf16_f32 v108,v24,v32
v_cvt_pk_bf16_f32 v109,v25,v33
v_cvt_pk_bf16_f32 v110,v26,v34
v_cvt_pk_bf16_f32 v111,v27,v35
buffer_store_dwordx4 v[108:111],v0,s[8:11],s63 offen sc1
v_cvt_pk_bf16_f32 v112,v28,v36
v_cvt_pk_bf16_f32 v113,v29,v37
v_cvt_pk_bf16_f32 v114,v30,v38
v_cvt_pk_bf16_f32 v115,v31,v39
buffer_store_dwordx4 v[112:115],v0,s[8:11],s64 offen sc1
s_lshl_b32 s72,s51,13
s_lshl2_add_u32 s72,s47,s72
s_add_u32 s72,s72,10485760
s_sub_u32 s53,s53,1
s_cmp_gt_i32 s53,0
s_cbranch_scc1 L_mo_19
s_add_u32 s73,s73,1
s_waitcnt vmcnt(8)
v_cmp_eq_u32 vcc,0,v125
s_cbranch_vccz L_mo_21
L_mo_18:
s_lshl_b32 s59,s31,13
s_add_u32 s59,s59,10487168
v_and_b32 v124,31,v1
v_lshlrev_b32 v124,2,v124
L_fw_26:
buffer_load_dword v125,v124,s[8:11],s59 offen sc1
s_sub_u32 s49,s49,1
s_cbranch_scc1 L_abort
s_waitcnt vmcnt(0)
v_cmp_eq_u32 vcc,0,v125
s_cbranch_vccnz L_fw_26
L_mo_21:
v_max_u32_dpp v125,v125,v125 row_ror:8 row_mask:0xf bank_mask:0xf
s_nop 1
v_max_u32_dpp v125,v125,v125 row_ror:4 row_mask:0xf bank_mask:0xf
s_nop 1
v_max_u32_dpp v125,v125,v125 row_ror:2 row_mask:0xf bank_mask:0xf
s_nop 1
v_max_u32_dpp v125,v125,v125 row_ror:1 row_mask:0xf bank_mask:0xf
v_mov_b32 v124,v125
s_nop 1
v_permlane16_swap_b32 v125,v124
v_max_u32 v125,v125,v124
v_mov_b32 v124,v125
s_nop 1
v_permlane32_swap_b32 v125,v124
v_max_u32 v125,v125,v124
s_nop 0
v_readfirstlane_b32 s55,v125
s_sub_u32 s73,s73,1
s_max_i32 s73,s73,0
s_sub_u32 s77,s77,1
s_min_u32 s61,s73,3
s_cmp_gt_u32 s55,s54
s_cselect_b32 s60,2,1
s_cselect_b32 s77,s61,s77
s_cselect_b32 s54,s55,s54
s_cbranch_scc0 L_mo_24
s_bitset1_b64 s[84:85],s31
L_mo_24:
s_cmp_lg_u32 s31,63
s_cbranch_scc1 L_mo_25
s_min_i32 s77,s77,0
s_lshr_b64 s[88:89],s[84:85],1
s_lshr_b64 s[90:91],s[84:85],2
s_or_b64 s[88:89],s[88:89],s[90:91]
s_lshr_b64 s[90:91],s[84:85],3
s_or_b64 s[88:89],s[88:89],s[90:91]
s_lshr_b64 s[90:91],s[84:85],4
s_or_b64 s[88:89],s[88:89],s[90:91]
s_or_b32 s88,s88,268435455
s_or_b32 s89,s89,0
s_flbit_i32_b64 s61,s[84:85]
s_sub_u32 s61,63,s61
s_bfm_b64 s[90:91],s61,0
s_xor_b64 s[84:85],s[88:89],s[90:91]
s_or_b32 s84,s84,0
s_or_b32 s85,s85,4278190080
L_mo_25:
s_or_b32 s61,s47,s46
s_cmp_lg_u32 s61,0
s_cbranch_scc1 L_mo_20
v_mov_b32 v125,s60
s_lshl_b32 s59,s31,13
s_add_u32 s59,s59,10487040
buffer_store_dword v125,off,s[8:11],s59 sc1
s_cmp_lg_u32 s31,63
s_cbranch_scc1 L_mo_20
s_and_b32 s62,s54,0x7ff
s_sub_u32 s62,2048,s62
v_mov_b32 v120,s62
s_lshr_b64 s[88:89],s[84:85],0
s_and_b32 s88,s88,0x3fffff
s_bitset1_b32 s88,31
v_mov_b32 v121,s88
s_lshr_b64 s[88:89],s[84:85],22
s_and_b32 s88,s88,0x3fffff
s_bitset1_b32 s88,31
v_mov_b32 v122,s88
s_lshr_b64 s[88:89],s[84:85],44
s_and_b32 s88,s88,0x3fffff
s_bitset1_b32 s88,31
v_mov_b32 v123,s88
s_mov_b32 s59,11011712
buffer_store_dwordx4 v[120:123],off,s[8:11],s59 sc1
L_mo_20:
s_add_u32 s31,s31,1
s_cmp_gt_i32 s77,0
s_cbranch_scc1 L_mo_18
s_cmp_lg_u32 s77,0
s_cbranch_scc1 L_mo_22
s_waitcnt vmcnt(0)
s_barrier
s_or_b32 s72,s72,s52
buffer_store_dword v17,off,s[8:11],s72 sc1
s_mov_b32 s72,0x80000000
s_and_b32 s51,s54,0x7ff
s_sub_u32 s51,2047,s51
s_lshr_b32 s51,s51,5
s_add_u32 s73,s73,3
s_and_b32 s64,s54,0x7ff
s_sub_u32 s64,2047,s64
s_lshl_b32 s56,s64,10
s_add_u32 s58,s56,4194304
buffer_load_dwordx4 v[88:91],v0,s[8:11],s58 offen sc1
s_mov_b32 s4,s38
s_mov_b32 s5,s39
s_mov_b32 s6,1835008
s_mov_b32 s7,0x20000
v_and_b32 v9,15,v1
v_lshrrev_b32 v10,4,v1
v_lshlrev_b32 v8,14,v10
v_lshl_add_u32 v8,v9,4,v8
s_lshl_b32 s59,s47,16
s_lshl_b32 s60,s46,8
s_add_u32 s59,s59,s60
buffer_load_dwordx4 v[24:27],v8,s[4:7],s59 offen offset:0
buffer_load_dwordx4 v[28:31],v8,s[4:7],s59 offen offset:1024
buffer_load_dwordx4 v[32:35],v8,s[4:7],s59 offen offset:2048
buffer_load_dwordx4 v[36:39],v8,s[4:7],s59 offen offset:3072
s_add_u32 s59,s59,4096
buffer_load_dwordx4 v[40:43],v8,s[4:7],s59 offen offset:0
buffer_load_dwordx4 v[44:47],v8,s[4:7],s59 offen offset:1024
buffer_load_dwordx4 v[48:51],v8,s[4:7],s59 offen offset:2048
buffer_load_dwordx4 v[52:55],v8,s[4:7],s59 offen offset:3072
s_add_u32 s59,s59,4096
buffer_load_dwordx4 v[56:59],v8,s[4:7],s59 offen offset:0
buffer_load_dwordx4 v[60:63],v8,s[4:7],s59 offen offset:1024
buffer_load_dwordx4 v[64:67],v8,s[4:7],s59 offen offset:2048
buffer_load_dwordx4 v[68:71],v8,s[4:7],s59 offen offset:3072
s_add_u32 s59,s59,4096
buffer_load_dwordx4 v[72:75],v8,s[4:7],s59 offen offset:0
buffer_load_dwordx4 v[76:79],v8,s[4:7],s59 offen offset:1024
buffer_load_dwordx4 v[80:83],v8,s[4:7],s59 offen offset:2048
buffer_load_dwordx4 v[84:87],v8,s[4:7],s59 offen offset:3072
v_and_b32 v124,1,v1
v_lshlrev_b32 v124,4,v124
v_mov_b32 v125,0xffff
v_lshlrev_b32 v125,v124,v125
v_lshrrev_b32 v124,1,v9
v_cmp_eq_u32 vcc,0,v124
s_nop 1
v_cndmask_b32 v12,0,v125,vcc
v_cmp_eq_u32 vcc,1,v124
s_nop 1
v_cndmask_b32 v13,0,v125,vcc
v_cmp_eq_u32 vcc,2,v124
s_nop 1
v_cndmask_b32 v14,0,v125,vcc
v_cmp_eq_u32 vcc,3,v124
s_nop 1
v_cndmask_b32 v15,0,v125,vcc
s_waitcnt vmcnt(16)
L_mx_27:
v_max3_u32 v124,v88,v89,v90
v_max_u32 v124,v91,v124
v_cmp_eq_u32 vcc,-1,v124
s_cbranch_vccz L_mxd_28
buffer_load_dwordx4 v[88:91],v0,s[8:11],s58 offen sc1
s_sub_u32 s49,s49,1
s_cbranch_scc1 L_abort
s_waitcnt vmcnt(0)
s_branch L_mx_27
L_mxd_28:
v_lshlrev_b32 v96,16,v88
v_and_b32 v97,0xffff0000,v88
v_lshlrev_b32 v98,16,v89
v_and_b32 v99,0xffff0000,v89
v_lshlrev_b32 v100,16,v90
v_and_b32 v101,0xffff0000,v90
v_lshlrev_b32 v102,16,v91
v_and_b32 v103,0xffff0000,v91
v_readfirstlane_b32 s78,v96
s_nop 1
v_pk_add_f32 v[108:109],v[96:97],s[78:79] op_sel_hi:[1,0] neg_lo:[0,1] neg_hi:[0,1]
v_pk_add_f32 v[110:111],v[98:99],s[78:79] op_sel_hi:[1,0] neg_lo:[0,1] neg_hi:[0,1]
v_pk_add_f32 v[112:113],v[100:101],s[78:79] op_sel_hi:[1,0] neg_lo:[0,1] neg_hi:[0,1]
v_pk_add_f32 v[114:115],v[102:103],s[78:79] op_sel_hi:[1,0] neg_lo:[0,1] neg_hi:[0,1]
v_pk_add_f32 v[116:117],v[108:109],v[110:111]
v_pk_mul_f32 v[118:119],v[108:109],v[108:109]
v_pk_add_f32 v[120:121],v[112:113],v[114:115]
v_pk_fma_f32 v[118:119],v[110:111],v[110:111],v[118:119]
v_pk_add_f32 v[116:117],v[116:117],v[120:121]
v_pk_fma_f32 v[118:119],v[112:113],v[112:113],v[118:119]
v_add_f32 v116,v116,v117
v_pk_fma_f32 v[118:119],v[114:115],v[114:115],v[118:119]
v_add_f32 v118,v118,v119
s_nop 1
v_permlane32_swap_b32 v116,v118
v_add_f32 v116,v116,v118
s_nop 1
v_add_f32_dpp v116,v116,v116 row_ror:8 row_mask:0xf bank_mask:0xf
s_nop 1
v_add_f32_dpp v116,v116,v116 row_ror:4 row_mask:0xf bank_mask:0xf
s_nop 1
v_add_f32_dpp v116,v116,v116 row_ror:2 row_mask:0xf bank_mask:0xf
s_nop 1
v_add_f32_dpp v116,v116,v116 row_ror:1 row_mask:0xf bank_mask:0xf
v_mov_b32 v118,v116
s_nop 1
v_permlane16_swap_b32 v116,v118
v_add_f32 v116,v116,v118
v_mul_f32 v116,0x3b000000,v116
v_mov_b32 v118,v116
s_nop 1
v_permlane32_swap_b32 v116,v118
v_fma_f32 v118,-v116,v116,v118
v_add_f32 v116,s78,v116
v_max_f32 v118,0,v118
v_cvt_pk_bf16_f32 v118,v116,v118
v_lshlrev_b32 v116,16,v118
v_and_b32 v118,0xffff0000,v118
v_add_f32 v118,0x3727c5ac,v118
v_cvt_pk_bf16_f32 v118,v118,v118
v_and_b32 v118,0xffff0000,v118
v_sqrt_f32 v118,v118
v_pk_add_f32 v[108:109],v[96:97],v[116:117] op_sel_hi:[1,0] neg_lo:[0,1] neg_hi:[0,1]
v_pk_add_f32 v[110:111],v[98:99],v[116:117] op_sel_hi:[1,0] neg_lo:[0,1] neg_hi:[0,1]
v_pk_add_f32 v[112:113],v[100:101],v[116:117] op_sel_hi:[1,0] neg_lo:[0,1] neg_hi:[0,1]
v_pk_add_f32 v[114:115],v[102:103],v[116:117] op_sel_hi:[1,0] neg_lo:[0,1] neg_hi:[0,1]
v_cvt_pk_bf16_f32 v118,v118,v118
v_and_b32 v118,0xffff0000,v118
v_rcp_f32 v118,v118
v_cvt_pk_bf16_f32 v104,v108,v109
v_cvt_pk_bf16_f32 v105,v110,v111
v_cvt_pk_bf16_f32 v106,v112,v113
v_cvt_pk_bf16_f32 v107,v114,v115
v_lshlrev_b32 v108,16,v104
v_and_b32 v109,0xffff0000,v104
v_lshlrev_b32 v110,16,v105
v_and_b32 v111,0xffff0000,v105
v_lshlrev_b32 v112,16,v106
v_and_b32 v113,0xffff0000,v106
v_lshlrev_b32 v114,16,v107
v_and_b32 v115,0xffff0000,v107
v_pk_mul_f32 v[108:109],v[108:109],v[118:119] op_sel_hi:[1,0]
v_pk_mul_f32 v[110:111],v[110:111],v[118:119] op_sel_hi:[1,0]
v_pk_mul_f32 v[112:113],v[112:113],v[118:119] op_sel_hi:[1,0]
v_pk_mul_f32 v[114:115],v[114:115],v[118:119] op_sel_hi:[1,0]
v_cvt_pk_bf16_f32 v104,v108,v109
v_cvt_pk_bf16_f32 v105,v110,v111
v_cvt_pk_bf16_f32 v106,v112,v113
v_cvt_pk_bf16_f32 v107,v114,v115
s_mov_b32 s58,0x01000100
s_mov_b32 s59,0x03020302
v_perm_b32 v88,v104,v104,s58
v_perm_b32 v89,v104,v104,s59
v_perm_b32 v90,v105,v105,s58
v_perm_b32 v91,v105,v105,s59
v_perm_b32 v92,v106,v106,s58
v_perm_b32 v93,v106,v106,s59
v_perm_b32 v94,v107,v107,s58
v_perm_b32 v95,v107,v107,s59
v_lshlrev_b32 v8,5,v1
s_lshl_b32 s58,s46,11
s_add_u32 s58,s58,139264
v_add_u32 v8,s58,v8
ds_write_b128 v8,v[88:91]
ds_write_b128 v8,v[92:95] offset:16
s_lshl_b32 s59,s46,9
s_add_u32 s59,s58,s59
v_lshlrev_b32 v8,7,v10
v_add_u32 v8,s59,v8
s_waitcnt lgkmcnt(0)
ds_read_b128 v[108:111],v18 offset:0
ds_read_b128 v[88:91],v8 offset:0
ds_read_b128 v[92:95],v8 offset:16
ds_read_b128 v[112:115],v18 offset:1024
s_waitcnt lgkmcnt(1)
v_and_b32 v124,v12,v88
v_and_b32 v125,v13,v88
v_and_b32 v126,v14,v88
v_and_b32 v127,v15,v88
s_nop 1
v_mfma_f32_16x16x32_bf16 v[116:119],v[124:127],v[108:111],0
ds_read_b128 v[108:111],v18 offset:2048
s_waitcnt lgkmcnt(1)
v_and_b32 v124,v12,v89
v_and_b32 v125,v13,v89
v_and_b32 v126,v14,v89
v_and_b32 v127,v15,v89
s_nop 1
v_mfma_f32_16x16x32_bf16 v[116:119],v[124:127],v[112:115],v[116:119]
ds_read_b128 v[112:115],v18 offset:3072
s_waitcnt lgkmcnt(1)
v_and_b32 v124,v12,v90
v_and_b32 v125,v13,v90
v_and_b32 v126,v14,v90
v_and_b32 v127,v15,v90
s_nop 1
v_mfma_f32_16x16x32_bf16 v[116:119],v[124:127],v[108:111],v[116:119]
ds_read_b128 v[108:111],v18 offset:4096
s_waitcnt lgkmcnt(1)
v_and_b32 v124,v12,v91
v_and_b32 v125,v13,v91
v_and_b32 v126,v14,v91
v_and_b32 v127,v15,v91
s_nop 1
v_mfma_f32_16x16x32_bf16 v[116:119],v[124:127],v[112:115],v[116:119]
ds_read_b128 v[112:115],v18 offset:5120
s_waitcnt lgkmcnt(1)
v_and_b32 v124,v12,v92
v_and_b32 v125,v13,v92
v_and_b32 v126,v14,v92
v_and_b32 v127,v15,v92
s_nop 1
v_mfma_f32_16x16x32_bf16 v[116:119],v[124:127],v[108:111],v[116:119]
ds_read_b128 v[108:111],v18 offset:6144
s_waitcnt lgkmcnt(1)
v_and_b32 v124,v12,v93
v_and_b32 v125,v13,v93
v_and_b32 v126,v14,v93
v_and_b32 v127,v15,v93
s_nop 1
v_mfma_f32_16x16x32_bf16 v[116:119],v[124:127],v[112:115],v[116:119]
ds_read_b128 v[112:115],v18 offset:7168
s_waitcnt lgkmcnt(1)
v_and_b32 v124,v12,v94
v_and_b32 v125,v13,v94
v_and_b32 v126,v14,v94
v_and_b32 v127,v15,v94
s_nop 1
v_mfma_f32_16x16x32_bf16 v[116:119],v[124:127],v[108:111],v[116:119]
ds_read_b128 v[108:111],v18 offset:8192
s_waitcnt lgkmcnt(1)
v_and_b32 v124,v12,v95
v_and_b32 v125,v13,v95
v_and_b32 v126,v14,v95
v_and_b32 v127,v15,v95
s_nop 1
v_mfma_f32_16x16x32_bf16 v[116:119],v[124:127],v[112:115],v[116:119]
ds_read_b128 v[88:91],v8 offset:32
ds_read_b128 v[92:95],v8 offset:48
ds_read_b128 v[112:115],v18 offset:9216
s_waitcnt lgkmcnt(1)
v_and_b32 v124,v12,v88
v_and_b32 v125,v13,v88
v_and_b32 v126,v14,v88
v_and_b32 v127,v15,v88
s_nop 1
v_mfma_f32_16x16x32_bf16 v[116:119],v[124:127],v[108:111],v[116:119]
ds_read_b128 v[108:111],v18 offset:10240
s_waitcnt lgkmcnt(1)
v_and_b32 v124,v12,v89
v_and_b32 v125,v13,v89
v_and_b32 v126,v14,v89
v_and_b32 v127,v15,v89
s_nop 1
v_mfma_f32_16x16x32_bf16 v[116:119],v[124:127],v[112:115],v[116:119]
ds_read_b128 v[112:115],v18 offset:11264
s_waitcnt lgkmcnt(1)
v_and_b32 v124,v12,v90
v_and_b32 v125,v13,v90
v_and_b32 v126,v14,v90
v_and_b32 v127,v15,v90
s_nop 1
v_mfma_f32_16x16x32_bf16 v[116:119],v[124:127],v[108:111],v[116:119]
ds_read_b128 v[108:111],v18 offset:12288
s_waitcnt lgkmcnt(1)
v_and_b32 v124,v12,v91
v_and_b32 v125,v13,v91
v_and_b32 v126,v14,v91
v_and_b32 v127,v15,v91
s_nop 1
v_mfma_f32_16x16x32_bf16 v[116:119],v[124:127],v[112:115],v[116:119]
ds_read_b128 v[112:115],v18 offset:13312
s_waitcnt lgkmcnt(1)
v_and_b32 v124,v12,v92
v_and_b32 v125,v13,v92
v_and_b32 v126,v14,v92
v_and_b32 v127,v15,v92
s_nop 1
v_mfma_f32_16x16x32_bf16 v[116:119],v[124:127],v[108:111],v[116:119]
ds_read_b128 v[108:111],v18 offset:14336
s_waitcnt lgkmcnt(1)
v_and_b32 v124,v12,v93
v_and_b32 v125,v13,v93
v_and_b32 v126,v14,v93
v_and_b32 v127,v15,v93
s_nop 1
v_mfma_f32_16x16x32_bf16 v[116:119],v[124:127],v[112:115],v[116:119]
ds_read_b128 v[112:115],v18 offset:15360
s_waitcnt lgkmcnt(1)
v_and_b32 v124,v12,v94
v_and_b32 v125,v13,v94
v_and_b32 v126,v14,v94
v_and_b32 v127,v15,v94
s_nop 1
v_mfma_f32_16x16x32_bf16 v[116:119],v[124:127],v[108:111],v[116:119]
ds_read_b128 v[108:111],v18 offset:16384
s_waitcnt lgkmcnt(1)
v_and_b32 v124,v12,v95
v_and_b32 v125,v13,v95
v_and_b32 v126,v14,v95
v_and_b32 v127,v15,v95
s_nop 1
v_mfma_f32_16x16x32_bf16 v[116:119],v[124:127],v[112:115],v[116:119]
ds_read_b128 v[88:91],v8 offset:64
ds_read_b128 v[92:95],v8 offset:80
ds_read_b128 v[112:115],v18 offset:17408
s_waitcnt lgkmcnt(1)
v_and_b32 v124,v12,v88
v_and_b32 v125,v13,v88
v_and_b32 v126,v14,v88
v_and_b32 v127,v15,v88
s_nop 1
v_mfma_f32_16x16x32_bf16 v[116:119],v[124:127],v[108:111],v[116:119]
ds_read_b128 v[108:111],v18 offset:18432
s_waitcnt lgkmcnt(1)
v_and_b32 v124,v12,v89
v_and_b32 v125,v13,v89
v_and_b32 v126,v14,v89
v_and_b32 v127,v15,v89
s_nop 1
v_mfma_f32_16x16x32_bf16 v[116:119],v[124:127],v[112:115],v[116:119]
ds_read_b128 v[112:115],v18 offset:19456
s_waitcnt lgkmcnt(1)
v_and_b32 v124,v12,v90
v_and_b32 v125,v13,v90
v_and_b32 v126,v14,v90
v_and_b32 v127,v15,v90
s_nop 1
v_mfma_f32_16x16x32_bf16 v[116:119],v[124:127],v[108:111],v[116:119]
ds_read_b128 v[108:111],v18 offset:20480
s_waitcnt lgkmcnt(1)
v_and_b32 v124,v12,v91
v_and_b32 v125,v13,v91
v_and_b32 v126,v14,v91
v_and_b32 v127,v15,v91
s_nop 1
v_mfma_f32_16x16x32_bf16 v[116:119],v[124:127],v[112:115],v[116:119]
ds_read_b128 v[112:115],v18 offset:21504
s_waitcnt lgkmcnt(1)
v_and_b32 v124,v12,v92
v_and_b32 v125,v13,v92
v_and_b32 v126,v14,v92
v_and_b32 v127,v15,v92
s_nop 1
v_mfma_f32_16x16x32_bf16 v[116:119],v[124:127],v[108:111],v[116:119]
ds_read_b128 v[108:111],v18 offset:22528
s_waitcnt lgkmcnt(1)
v_and_b32 v124,v12,v93
v_and_b32 v125,v13,v93
v_and_b32 v126,v14,v93
v_and_b32 v127,v15,v93
s_nop 1
v_mfma_f32_16x16x32_bf16 v[116:119],v[124:127],v[112:115],v[116:119]
ds_read_b128 v[112:115],v18 offset:23552
s_waitcnt lgkmcnt(1)
v_and_b32 v124,v12,v94
v_and_b32 v125,v13,v94
v_and_b32 v126,v14,v94
v_and_b32 v127,v15,v94
s_nop 1
v_mfma_f32_16x16x32_bf16 v[116:119],v[124:127],v[108:111],v[116:119]
ds_read_b128 v[108:111],v18 offset:24576
s_waitcnt lgkmcnt(1)
v_and_b32 v124,v12,v95
v_and_b32 v125,v13,v95
v_and_b32 v126,v14,v95
v_and_b32 v127,v15,v95
s_nop 1
v_mfma_f32_16x16x32_bf16 v[116:119],v[124:127],v[112:115],v[116:119]
ds_read_b128 v[88:91],v8 offset:96
ds_read_b128 v[92:95],v8 offset:112
ds_read_b128 v[112:115],v18 offset:25600
s_waitcnt lgkmcnt(1)
v_and_b32 v124,v12,v88
v_and_b32 v125,v13,v88
v_and_b32 v126,v14,v88
v_and_b32 v127,v15,v88
s_nop 1
v_mfma_f32_16x16x32_bf16 v[116:119],v[124:127],v[108:111],v[116:119]
ds_read_b128 v[108:111],v18 offset:26624
s_waitcnt lgkmcnt(1)
v_and_b32 v124,v12,v89
v_and_b32 v125,v13,v89
v_and_b32 v126,v14,v89
v_and_b32 v127,v15,v89
s_nop 1
v_mfma_f32_16x16x32_bf16 v[116:119],v[124:127],v[112:115],v[116:119]
ds_read_b128 v[112:115],v18 offset:27648
s_waitcnt lgkmcnt(1)
v_and_b32 v124,v12,v90
v_and_b32 v125,v13,v90
v_and_b32 v126,v14,v90
v_and_b32 v127,v15,v90
s_nop 1
v_mfma_f32_16x16x32_bf16 v[116:119],v[124:127],v[108:111],v[116:119]
ds_read_b128 v[108:111],v18 offset:28672
s_waitcnt lgkmcnt(1)
v_and_b32 v124,v12,v91
v_and_b32 v125,v13,v91
v_and_b32 v126,v14,v91
v_and_b32 v127,v15,v91
s_nop 1
v_mfma_f32_16x16x32_bf16 v[116:119],v[124:127],v[112:115],v[116:119]
ds_read_b128 v[112:115],v18 offset:29696
s_waitcnt lgkmcnt(1)
v_and_b32 v124,v12,v92
v_and_b32 v125,v13,v92
v_and_b32 v126,v14,v92
v_and_b32 v127,v15,v92
s_nop 1
v_mfma_f32_16x16x32_bf16 v[116:119],v[124:127],v[108:111],v[116:119]
ds_read_b128 v[108:111],v18 offset:30720
s_waitcnt lgkmcnt(1)
v_and_b32 v124,v12,v93
v_and_b32 v125,v13,v93
v_and_b32 v126,v14,v93
v_and_b32 v127,v15,v93
s_nop 1
v_mfma_f32_16x16x32_bf16 v[116:119],v[124:127],v[112:115],v[116:119]
ds_read_b128 v[112:115],v18 offset:31744
s_waitcnt lgkmcnt(1)
v_and_b32 v124,v12,v94
v_and_b32 v125,v13,v94
v_and_b32 v126,v14,v94
v_and_b32 v127,v15,v94
s_nop 1
v_mfma_f32_16x16x32_bf16 v[116:119],v[124:127],v[108:111],v[116:119]
s_waitcnt lgkmcnt(0)
v_and_b32 v124,v12,v95
v_and_b32 v125,v13,v95
v_and_b32 v126,v14,v95
v_and_b32 v127,v15,v95
s_nop 1
v_mfma_f32_16x16x32_bf16 v[116:119],v[124:127],v[112:115],v[116:119]
v_lshlrev_b32 v8,5,v9
v_and_b32 v124,1,v10
v_lshl_add_u32 v8,v124,4,v8
v_lshrrev_b32 v124,1,v10
v_lshl_add_u32 v8,v124,11,v8
s_lshl_b32 s60,s46,9
s_add_u32 s60,s60,147456
v_add_u32 v8,s60,v8
ds_write_b128 v8,v[116:119]
v_lshlrev_b32 v8,2,v1
v_add_u32 v8,147456,v8
s_waitcnt lgkmcnt(0)
s_barrier
ds_read2st64_b32 v[88:89],v8 offset0:0 offset1:1
ds_read2st64_b32 v[90:91],v8 offset0:2 offset1:3
ds_read2st64_b32 v[92:93],v8 offset0:4 offset1:5
ds_read2st64_b32 v[94:95],v8 offset0:6 offset1:7
s_waitcnt lgkmcnt(0)
v_pk_add_f32 v[88:89],v[88:89],v[90:91]
v_pk_add_f32 v[92:93],v[92:93],v[94:95]
v_pk_add_f32 v[88:89],v[88:89],v[92:93]
v_cvt_pk_bf16_f32 v88,v88,v88
v_and_b32 v88,0xffff0000,v88
v_cvt_pk_bf16_f32 v89,v89,v89
v_and_b32 v89,0xffff0000,v89
v_mul_f32 v90,0xbfb8aa3b,v88
v_exp_f32 v90,v90
s_nop 0
v_add_f32 v90,1.0,v90
v_rcp_f32 v90,v90
s_nop 0
v_mul_f32 v88,v88,v90
v_cvt_pk_bf16_f32 v88,v88,v88
v_and_b32 v88,0xffff0000,v88
v_mul_f32 v88,v88,v89
v_cvt_pk_bf16_f32 v88,v88,v88
v_lshlrev_b32 v8,2,v1
v_add_u32 v8,s58,v8
ds_write_b32 v8,v88
v_lshlrev_b32 v8,6,v10
v_add_u32 v8,s58,v8
s_waitcnt lgkmcnt(0)
ds_read_b128 v[88:91],v8
ds_read_b128 v[92:95],v8 offset:16
ds_read_b128 v[108:111],v8 offset:32
ds_read_b128 v[112:115],v8 offset:48
s_waitcnt vmcnt(0) lgkmcnt(0)
v_and_b32 v124,v12,v88
v_and_b32 v125,v13,v88
v_and_b32 v126,v14,v88
v_and_b32 v127,v15,v88
s_nop 1
v_mfma_f32_16x16x32_bf16 v[116:119],v[124:127],v[24:27],0
v_and_b32 v124,v12,v89
v_and_b32 v125,v13,v89
v_and_b32 v126,v14,v89
v_and_b32 v127,v15,v89
s_nop 1
v_mfma_f32_16x16x32_bf16 v[116:119],v[124:127],v[28:31],v[116:119]
v_and_b32 v124,v12,v90
v_and_b32 v125,v13,v90
v_and_b32 v126,v14,v90
v_and_b32 v127,v15,v90
s_nop 1
v_mfma_f32_16x16x32_bf16 v[116:119],v[124:127],v[32:35],v[116:119]
v_and_b32 v124,v12,v91
v_and_b32 v125,v13,v91
v_and_b32 v126,v14,v91
v_and_b32 v127,v15,v91
s_nop 1
v_mfma_f32_16x16x32_bf16 v[116:119],v[124:127],v[36:39],v[116:119]
v_and_b32 v124,v12,v92
v_and_b32 v125,v13,v92
v_and_b32 v126,v14,v92
v_and_b32 v127,v15,v92
s_nop 1
v_mfma_f32_16x16x32_bf16 v[116:119],v[124:127],v[40:43],v[116:119]
v_and_b32 v124,v12,v93
v_and_b32 v125,v13,v93
v_and_b32 v126,v14,v93
v_and_b32 v127,v15,v93
s_nop 1
v_mfma_f32_16x16x32_bf16 v[116:119],v[124:127],v[44:47],v[116:119]
v_and_b32 v124,v12,v94
v_and_b32 v125,v13,v94
v_and_b32 v126,v14,v94
v_and_b32 v127,v15,v94
s_nop 1
v_mfma_f32_16x16x32_bf16 v[116:119],v[124:127],v[48:51],v[116:119]
v_and_b32 v124,v12,v95
v_and_b32 v125,v13,v95
v_and_b32 v126,v14,v95
v_and_b32 v127,v15,v95
s_nop 1
v_mfma_f32_16x16x32_bf16 v[116:119],v[124:127],v[52:55],v[116:119]
v_and_b32 v124,v12,v108
v_and_b32 v125,v13,v108
v_and_b32 v126,v14,v108
v_and_b32 v127,v15,v108
s_nop 1
v_mfma_f32_16x16x32_bf16 v[116:119],v[124:127],v[56:59],v[116:119]
v_and_b32 v124,v12,v109
v_and_b32 v125,v13,v109
v_and_b32 v126,v14,v109
v_and_b32 v127,v15,v109
s_nop 1
v_mfma_f32_16x16x32_bf16 v[116:119],v[124:127],v[60:63],v[116:119]
v_and_b32 v124,v12,v110
v_and_b32 v125,v13,v110
v_and_b32 v126,v14,v110
v_and_b32 v127,v15,v110
s_nop 1
v_mfma_f32_16x16x32_bf16 v[116:119],v[124:127],v[64:67],v[116:119]
v_and_b32 v124,v12,v111
v_and_b32 v125,v13,v111
v_and_b32 v126,v14,v111
v_and_b32 v127,v15,v111
s_nop 1
v_mfma_f32_16x16x32_bf16 v[116:119],v[124:127],v[68:71],v[116:119]
v_and_b32 v124,v12,v112
v_and_b32 v125,v13,v112
v_and_b32 v126,v14,v112
v_and_b32 v127,v15,v112
s_nop 1
v_mfma_f32_16x16x32_bf16 v[116:119],v[124:127],v[72:75],v[116:119]
v_and_b32 v124,v12,v113
v_and_b32 v125,v13,v113
v_and_b32 v126,v14,v113
v_and_b32 v127,v15,v113
s_nop 1
v_mfma_f32_16x16x32_bf16 v[116:119],v[124:127],v[76:79],v[116:119]
v_and_b32 v124,v12,v114
v_and_b32 v125,v13,v114
v_and_b32 v126,v14,v114
v_and_b32 v127,v15,v114
s_nop 1
v_mfma_f32_16x16x32_bf16 v[116:119],v[124:127],v[80:83],v[116:119]
v_and_b32 v124,v12,v115
v_and_b32 v125,v13,v115
v_and_b32 v126,v14,v115
v_and_b32 v127,v15,v115
s_nop 1
v_mfma_f32_16x16x32_bf16 v[116:119],v[124:127],v[84:87],v[116:119]
v_lshlrev_b32 v8,4,v9
v_and_b32 v124,1,v10
v_lshl_add_u32 v8,v124,3,v8
v_and_b32 v124,2,v10
v_lshl_add_u32 v8,v124,30,v8
s_lshl_b32 s65,s51,15
s_add_u32 s65,s65,92274688
s_lshl_b32 s59,s47,10
s_lshl_b32 s60,s46,8
s_add_u32 s59,s59,s60
s_add_u32 s59,s59,s65
v_cvt_pk_bf16_f32 v24,v116,v117
v_cvt_pk_bf16_f32 v25,v118,v119
buffer_store_dwordx2 v[24:25],v8,s[8:11],s59 offen
s_lshl_b32 s59,s51,13
s_lshl2_add_u32 s59,s47,s59
s_add_u32 s59,s59,10486912
s_waitcnt vmcnt(0)
s_barrier
s_or_b32 s59,s59,s52
buffer_store_dword v17,off,s[8:11],s59
s_lshl_b32 s59,s51,13
s_add_u32 s59,s59,10486912
v_and_b32 v124,31,v1
v_lshlrev_b32 v124,2,v124
L_fw_30:
buffer_load_dword v125,v124,s[8:11],s59 offen sc1
s_sub_u32 s49,s49,1
s_cbranch_scc1 L_abort
s_waitcnt vmcnt(0)
v_cmp_eq_u32 vcc,0,v125
s_cbranch_vccnz L_fw_30
s_add_u32 s63,s65,0
buffer_load_dwordx4 v[24:27],v22,s[8:11],s63 offen sc1
s_add_u32 s63,s65,4096
buffer_load_dwordx4 v[28:31],v22,s[8:11],s63 offen sc1
s_add_u32 s63,s65,8192
buffer_load_dwordx4 v[32:35],v22,s[8:11],s63 offen sc1
s_add_u32 s63,s65,12288
buffer_load_dwordx4 v[36:39],v22,s[8:11],s63 offen sc1
s_add_u32 s63,s65,16384
buffer_load_dwordx4 v[40:43],v22,s[8:11],s63 offen sc1
s_add_u32 s63,s65,20480
buffer_load_dwordx4 v[44:47],v22,s[8:11],s63 offen sc1
s_add_u32 s63,s65,24576
buffer_load_dwordx4 v[48:51],v22,s[8:11],s63 offen sc1
s_add_u32 s63,s65,28672
buffer_load_dwordx4 v[52:55],v22,s[8:11],s63 offen sc1
v_and_b32 v64,15,v1
v_and_b32 v65,1,v1
v_lshlrev_b32 v65,4,v65
v_mov_b32 v66,0x3f80
v_lshlrev_b32 v66,v65,v66
v_lshrrev_b32 v64,1,v64
v_cmp_eq_u32 vcc,0,v64
s_nop 1
v_cndmask_b32 v56,0,v66,vcc
v_cmp_eq_u32 vcc,1,v64
s_nop 1
v_cndmask_b32 v57,0,v66,vcc
v_cmp_eq_u32 vcc,2,v64
s_nop 1
v_cndmask_b32 v58,0,v66,vcc
v_cmp_eq_u32 vcc,3,v64
s_nop 1
v_cndmask_b32 v59,0,v66,vcc
s_waitcnt vmcnt(7)
s_nop 0
v_mfma_f32_16x16x32_bf16 v[60:63],v[56:59],v[24:27],0
s_waitcnt vmcnt(6)
v_mfma_f32_16x16x32_bf16 v[60:63],v[56:59],v[28:31],v[60:63]
s_waitcnt vmcnt(5)
v_mfma_f32_16x16x32_bf16 v[60:63],v[56:59],v[32:35],v[60:63]
s_waitcnt vmcnt(4)
v_mfma_f32_16x16x32_bf16 v[60:63],v[56:59],v[36:39],v[60:63]
s_waitcnt vmcnt(3)
v_mfma_f32_16x16x32_bf16 v[60:63],v[56:59],v[40:43],v[60:63]
s_waitcnt vmcnt(2)
v_mfma_f32_16x16x32_bf16 v[60:63],v[56:59],v[44:47],v[60:63]
s_waitcnt vmcnt(1)
v_mfma_f32_16x16x32_bf16 v[60:63],v[56:59],v[48:51],v[60:63]
s_waitcnt vmcnt(0)
v_mfma_f32_16x16x32_bf16 v[60:63],v[56:59],v[52:55],v[60:63]
s_nop 7
ds_write_b128 v21,v[60:63]
s_waitcnt lgkmcnt(0)
s_barrier
s_cmp_lg_u32 s46,0
s_cbranch_scc1 L_moed_29
v_lshlrev_b32 v56,5,v1
v_add_u32 v56,155648,v56
ds_read_b128 v[24:27],v56
ds_read_b128 v[28:31],v56 offset:16
s_and_b32 s59,s54,0xffff0000
s_xor_b32 s60,s59,0x80000000
s_xor_b32 s61,s59,0xffff0000
s_cmp_lt_i32 s59,0
s_cselect_b32 s59,s60,s61
v_mov_b32 v56,s59
v_mul_f32 v56,0xbfb8aa3b,v56
v_exp_f32 v56,v56
s_nop 0
v_add_f32 v56,1.0,v56
v_rcp_f32 v56,v56
s_nop 0
v_cvt_pk_bf16_f32 v56,v56,v56
v_and_b32 v56,0xffff0000,v56
v_lshlrev_b32 v48,16,v104
v_and_b32 v49,0xffff0000,v104
v_lshlrev_b32 v50,16,v105
v_and_b32 v51,0xffff0000,v105
v_lshlrev_b32 v52,16,v106
v_and_b32 v53,0xffff0000,v106
v_lshlrev_b32 v54,16,v107
v_and_b32 v55,0xffff0000,v107
s_waitcnt lgkmcnt(0)
v_cvt_pk_bf16_f32 v40,v24,v25
v_cvt_pk_bf16_f32 v41,v26,v27
v_cvt_pk_bf16_f32 v42,v28,v29
v_cvt_pk_bf16_f32 v43,v30,v31
v_lshlrev_b32 v24,16,v40
v_and_b32 v25,0xffff0000,v40
v_lshlrev_b32 v26,16,v41
v_and_b32 v27,0xffff0000,v41
v_lshlrev_b32 v28,16,v42
v_and_b32 v29,0xffff0000,v42
v_lshlrev_b32 v30,16,v43
v_and_b32 v31,0xffff0000,v43
v_mul_f32 v24,v24,v56
v_mul_f32 v25,v25,v56
v_mul_f32 v26,v26,v56
v_mul_f32 v27,v27,v56
v_mul_f32 v28,v28,v56
v_mul_f32 v29,v29,v56
v_mul_f32 v30,v30,v56
v_mul_f32 v31,v31,v56
v_cvt_pk_bf16_f32 v40,v24,v25
v_cvt_pk_bf16_f32 v41,v26,v27
v_cvt_pk_bf16_f32 v42,v28,v29
v_cvt_pk_bf16_f32 v43,v30,v31
v_lshlrev_b32 v24,16,v40
v_and_b32 v25,0xffff0000,v40
v_lshlrev_b32 v26,16,v41
v_and_b32 v27,0xffff0000,v41
v_lshlrev_b32 v28,16,v42
v_and_b32 v29,0xffff0000,v42
v_lshlrev_b32 v30,16,v43
v_and_b32 v31,0xffff0000,v43
v_add_f32 v24,v24,v48
v_add_f32 v25,v25,v49
v_add_f32 v26,v26,v50
v_add_f32 v27,v27,v51
v_add_f32 v28,v28,v52
v_add_f32 v29,v29,v53
v_add_f32 v30,v30,v54
v_add_f32 v31,v31,v55
v_cvt_pk_bf16_f32 v40,v24,v25
v_cvt_pk_bf16_f32 v41,v26,v27
v_cvt_pk_bf16_f32 v42,v28,v29
v_cvt_pk_bf16_f32 v43,v30,v31
v_lshlrev_b32 v24,16,v40
v_and_b32 v25,0xffff0000,v40
v_lshlrev_b32 v26,16,v41
v_and_b32 v27,0xffff0000,v41
v_lshlrev_b32 v28,16,v42
v_and_b32 v29,0xffff0000,v42
v_lshlrev_b32 v30,16,v43
v_and_b32 v31,0xffff0000,v43
v_add_f32 v96,v96,v24
v_add_f32 v97,v97,v25
v_add_f32 v98,v98,v26
v_add_f32 v99,v99,v27
v_add_f32 v100,v100,v28
v_add_f32 v101,v101,v29
v_add_f32 v102,v102,v30
v_add_f32 v103,v103,v31
v_cvt_pk_bf16_f32 v80,v96,v97
v_cvt_pk_bf16_f32 v81,v98,v99
v_cvt_pk_bf16_f32 v82,v100,v101
v_cvt_pk_bf16_f32 v83,v102,v103
s_lshl_b32 s58,s51,10
s_add_u32 s58,s58,11272192
buffer_store_dwordx4 v[80:83],v0,s[8:11],s58 offen sc1
v_lshlrev_b32 v96,16,v80
v_and_b32 v97,0xffff0000,v80
v_lshlrev_b32 v98,16,v81
v_and_b32 v99,0xffff0000,v81
v_lshlrev_b32 v100,16,v82
v_and_b32 v101,0xffff0000,v82
v_lshlrev_b32 v102,16,v83
v_and_b32 v103,0xffff0000,v83
v_readfirstlane_b32 s78,v96
s_nop 1
v_pk_add_f32 v[58:59],v[96:97],s[78:79] op_sel_hi:[1,0] neg_lo:[0,1] neg_hi:[0,1]
v_pk_add_f32 v[60:61],v[98:99],s[78:79] op_sel_hi:[1,0] neg_lo:[0,1] neg_hi:[0,1]
v_pk_add_f32 v[62:63],v[100:101],s[78:79] op_sel_hi:[1,0] neg_lo:[0,1] neg_hi:[0,1]
v_pk_add_f32 v[64:65],v[102:103],s[78:79] op_sel_hi:[1,0] neg_lo:[0,1] neg_hi:[0,1]
v_pk_add_f32 v[66:67],v[58:59],v[60:61]
v_pk_mul_f32 v[68:69],v[58:59],v[58:59]
v_pk_add_f32 v[70:71],v[62:63],v[64:65]
v_pk_fma_f32 v[68:69],v[60:61],v[60:61],v[68:69]
v_pk_add_f32 v[66:67],v[66:67],v[70:71]
v_pk_fma_f32 v[68:69],v[62:63],v[62:63],v[68:69]
v_add_f32 v66,v66,v67
v_pk_fma_f32 v[68:69],v[64:65],v[64:65],v[68:69]
v_add_f32 v68,v68,v69
s_nop 1
v_permlane32_swap_b32 v66,v68
v_add_f32 v66,v66,v68
s_nop 1
v_add_f32_dpp v66,v66,v66 row_ror:8 row_mask:0xf bank_mask:0xf
s_nop 1
v_add_f32_dpp v66,v66,v66 row_ror:4 row_mask:0xf bank_mask:0xf
s_nop 1
v_add_f32_dpp v66,v66,v66 row_ror:2 row_mask:0xf bank_mask:0xf
s_nop 1
v_add_f32_dpp v66,v66,v66 row_ror:1 row_mask:0xf bank_mask:0xf
v_mov_b32 v68,v66
s_nop 1
v_permlane16_swap_b32 v66,v68
v_add_f32 v66,v66,v68
v_mul_f32 v66,0x3b000000,v66
v_mov_b32 v68,v66
s_nop 1
v_permlane32_swap_b32 v66,v68
v_fma_f32 v68,-v66,v66,v68
v_add_f32 v66,s78,v66
v_max_f32 v68,0,v68
v_cvt_pk_bf16_f32 v68,v66,v68
v_lshlrev_b32 v66,16,v68
v_and_b32 v68,0xffff0000,v68
v_add_f32 v68,0x3727c5ac,v68
v_cvt_pk_bf16_f32 v68,v68,v68
v_and_b32 v68,0xffff0000,v68
v_sqrt_f32 v68,v68
v_pk_add_f32 v[58:59],v[96:97],v[66:67] op_sel_hi:[1,0] neg_lo:[0,1] neg_hi:[0,1]
v_pk_add_f32 v[60:61],v[98:99],v[66:67] op_sel_hi:[1,0] neg_lo:[0,1] neg_hi:[0,1]
v_pk_add_f32 v[62:63],v[100:101],v[66:67] op_sel_hi:[1,0] neg_lo:[0,1] neg_hi:[0,1]
v_pk_add_f32 v[64:65],v[102:103],v[66:67] op_sel_hi:[1,0] neg_lo:[0,1] neg_hi:[0,1]
v_cvt_pk_bf16_f32 v68,v68,v68
v_and_b32 v68,0xffff0000,v68
v_rcp_f32 v68,v68
v_cvt_pk_bf16_f32 v84,v58,v59
v_cvt_pk_bf16_f32 v85,v60,v61
v_cvt_pk_bf16_f32 v86,v62,v63
v_cvt_pk_bf16_f32 v87,v64,v65
v_lshlrev_b32 v58,16,v84
v_and_b32 v59,0xffff0000,v84
v_lshlrev_b32 v60,16,v85
v_and_b32 v61,0xffff0000,v85
v_lshlrev_b32 v62,16,v86
v_and_b32 v63,0xffff0000,v86
v_lshlrev_b32 v64,16,v87
v_and_b32 v65,0xffff0000,v87
v_pk_mul_f32 v[58:59],v[58:59],v[68:69] op_sel_hi:[1,0]
v_pk_mul_f32 v[60:61],v[60:61],v[68:69] op_sel_hi:[1,0]
v_pk_mul_f32 v[62:63],v[62:63],v[68:69] op_sel_hi:[1,0]
v_pk_mul_f32 v[64:65],v[64:65],v[68:69] op_sel_hi:[1,0]
v_cvt_pk_bf16_f32 v84,v58,v59
v_cvt_pk_bf16_f32 v85,v60,v61
v_cvt_pk_bf16_f32 v86,v62,v63
v_cvt_pk_bf16_f32 v87,v64,v65
s_add_u32 s57,s56,98566144
buffer_store_dwordx4 v[84:87],v0,s[8:11],s57 offen sc1
L_moed_29:
s_and_b32 s56,s54,31
s_sub_u32 s56,31,s56
v_lshrrev_b32 v2,10,v20
v_add_u32 v3,16,v2
v_add_u32 v8,96468992,v20
v_cmp_eq_u32 vcc,s56,v2
s_nop 1
v_cndmask_b32 v2,v20,v8,vcc
v_cmp_eq_u32 vcc,s56,v3
s_nop 1
v_cndmask_b32 v3,v20,v8,vcc
s_lshl_b32 s59,s51,13
s_add_u32 s59,s59,10487552
v_and_b32 v124,31,v1
v_lshlrev_b32 v124,2,v124
L_fw_31:
buffer_load_dword v125,v124,s[8:11],s59 offen sc1
s_sub_u32 s49,s49,1
s_cbranch_scc1 L_abort
s_waitcnt vmcnt(0)
v_cmp_eq_u32 vcc,0,v125
s_cbranch_vccnz L_fw_31
s_barrier
s_lshl_b32 s66,s51,15
s_add_u32 s66,s66,2097152
s_add_u32 s67,s66,16384
s_add_u32 m0,s50,131072
s_nop 0
buffer_load_dwordx4 v2,s[8:11],s66 offen offset:0 sc1 lds
s_add_u32 m0,s50,135168
s_nop 0
buffer_load_dwordx4 v3,s[8:11],s67 offen offset:0 sc1 lds
s_add_u32 m0,s50,139008
s_nop 0
buffer_load_dwordx4 v2,s[8:11],s66 offen offset:256 sc1 lds
s_add_u32 m0,s50,143104
s_nop 0
buffer_load_dwordx4 v3,s[8:11],s67 offen offset:256 sc1 lds
s_add_u32 m0,s50,146944
s_nop 0
buffer_load_dwordx4 v2,s[8:11],s66 offen offset:512 sc1 lds
s_add_u32 m0,s50,151040
s_nop 0
buffer_load_dwordx4 v3,s[8:11],s67 offen offset:512 sc1 lds
s_lshl_b32 s58,s51,5
s_add_u32 s58,s58,s47
s_mul_i32 s58,s58,24576
s_add_u32 s58,s58,201326592
s_add_u32 s61,s58,s50
s_add_u32 s62,s61,4096
s_add_u32 s63,s61,16384
s_add_u32 s64,s61,20480
s_add_u32 s65,s61,s50
s_add_u32 s65,s65,8192
s_waitcnt vmcnt(4)
s_barrier
ds_read_b128 v[104:107],v4 offset:0
ds_read_b128 v[108:111],v4 offset:4096
ds_read_b128 v[112:115],v5 offset:0
ds_read_b128 v[116:119],v5 offset:4096
s_add_u32 m0,s50,154880
s_nop 0
buffer_load_dwordx4 v2,s[8:11],s66 offen offset:768 sc1 lds
s_add_u32 m0,s50,158976
s_nop 0
buffer_load_dwordx4 v3,s[8:11],s67 offen offset:768 sc1 lds
s_waitcnt lgkmcnt(2)
v_mfma_f32_16x16x32_bf16 v[24:27],a[128:131],v[104:107],0
ds_read_b128 v[120:123],v6 offset:0
v_mfma_f32_16x16x32_bf16 v[40:43],v[104:107],v[128:131],0
v_mfma_f32_16x16x32_bf16 v[28:31],a[128:131],v[108:111],0
ds_read_b128 v[124:127],v6 offset:4096
v_mfma_f32_16x16x32_bf16 v[44:47],v[108:111],v[128:131],0
v_mfma_f32_16x16x32_bf16 v[32:35],a[136:139],v[104:107],0
v_mfma_f32_16x16x32_bf16 v[48:51],v[104:107],v[136:139],0
v_mfma_f32_16x16x32_bf16 v[36:39],a[136:139],v[108:111],0
v_mfma_f32_16x16x32_bf16 v[52:55],v[108:111],v[136:139],0
s_waitcnt lgkmcnt(2)
v_mfma_f32_16x16x32_bf16 v[24:27],a[132:135],v[112:115],v[24:27]
ds_read_b128 v[104:107],v7 offset:0
v_mfma_f32_16x16x32_bf16 v[40:43],v[112:115],v[132:135],v[40:43]
v_mfma_f32_16x16x32_bf16 v[28:31],a[132:135],v[116:119],v[28:31]
ds_read_b128 v[108:111],v7 offset:4096
v_mfma_f32_16x16x32_bf16 v[44:47],v[116:119],v[132:135],v[44:47]
v_mfma_f32_16x16x32_bf16 v[32:35],a[140:143],v[112:115],v[32:35]
v_mfma_f32_16x16x32_bf16 v[48:51],v[112:115],v[140:143],v[48:51]
v_mfma_f32_16x16x32_bf16 v[36:39],a[140:143],v[116:119],v[36:39]
v_mfma_f32_16x16x32_bf16 v[52:55],v[116:119],v[140:143],v[52:55]
s_waitcnt vmcnt(4)
s_barrier
s_waitcnt lgkmcnt(2)
v_mfma_f32_16x16x32_bf16 v[24:27],a[144:147],v[120:123],v[24:27]
ds_read_b128 v[112:115],v4 offset:8192
v_mfma_f32_16x16x32_bf16 v[40:43],v[120:123],v[144:147],v[40:43]
v_mfma_f32_16x16x32_bf16 v[28:31],a[144:147],v[124:127],v[28:31]
ds_read_b128 v[116:119],v4 offset:12288
v_mfma_f32_16x16x32_bf16 v[44:47],v[124:127],v[144:147],v[44:47]
v_mfma_f32_16x16x32_bf16 v[32:35],a[152:155],v[120:123],v[32:35]
v_mfma_f32_16x16x32_bf16 v[48:51],v[120:123],v[152:155],v[48:51]
v_mfma_f32_16x16x32_bf16 v[36:39],a[152:155],v[124:127],v[36:39]
v_mfma_f32_16x16x32_bf16 v[52:55],v[124:127],v[152:155],v[52:55]
s_waitcnt lgkmcnt(2)
v_mfma_f32_16x16x32_bf16 v[24:27],a[148:151],v[104:107],v[24:27]
ds_read_b128 v[120:123],v5 offset:8192
v_mfma_f32_16x16x32_bf16 v[40:43],v[104:107],v[148:151],v[40:43]
v_mfma_f32_16x16x32_bf16 v[28:31],a[148:151],v[108:111],v[28:31]
ds_read_b128 v[124:127],v5 offset:12288
v_mfma_f32_16x16x32_bf16 v[44:47],v[108:111],v[148:151],v[44:47]
v_mfma_f32_16x16x32_bf16 v[32:35],a[156:159],v[104:107],v[32:35]
v_mfma_f32_16x16x32_bf16 v[48:51],v[104:107],v[156:159],v[48:51]
v_mfma_f32_16x16x32_bf16 v[36:39],a[156:159],v[108:111],v[36:39]
v_mfma_f32_16x16x32_bf16 v[52:55],v[108:111],v[156:159],v[52:55]
s_waitcnt lgkmcnt(2)
v_mfma_f32_16x16x32_bf16 v[24:27],a[160:163],v[112:115],v[24:27]
ds_read_b128 v[104:107],v6 offset:8192
v_mfma_f32_16x16x32_bf16 v[40:43],v[112:115],v[160:163],v[40:43]
v_mfma_f32_16x16x32_bf16 v[28:31],a[160:163],v[116:119],v[28:31]
ds_read_b128 v[108:111],v6 offset:12288
v_mfma_f32_16x16x32_bf16 v[44:47],v[116:119],v[160:163],v[44:47]
v_mfma_f32_16x16x32_bf16 v[32:35],a[168:171],v[112:115],v[32:35]
v_mfma_f32_16x16x32_bf16 v[48:51],v[112:115],v[168:171],v[48:51]
v_mfma_f32_16x16x32_bf16 v[36:39],a[168:171],v[116:119],v[36:39]
v_mfma_f32_16x16x32_bf16 v[52:55],v[116:119],v[168:171],v[52:55]
s_waitcnt lgkmcnt(2)
v_mfma_f32_16x16x32_bf16 v[24:27],a[164:167],v[120:123],v[24:27]
ds_read_b128 v[112:115],v7 offset:8192
v_mfma_f32_16x16x32_bf16 v[40:43],v[120:123],v[164:167],v[40:43]
v_mfma_f32_16x16x32_bf16 v[28:31],a[164:167],v[124:127],v[28:31]
ds_read_b128 v[116:119],v7 offset:12288
v_mfma_f32_16x16x32_bf16 v[44:47],v[124:127],v[164:167],v[44:47]
v_mfma_f32_16x16x32_bf16 v[32:35],a[172:175],v[120:123],v[32:35]
v_mfma_f32_16x16x32_bf16 v[48:51],v[120:123],v[172:175],v[48:51]
v_mfma_f32_16x16x32_bf16 v[36:39],a[172:175],v[124:127],v[36:39]
v_mfma_f32_16x16x32_bf16 v[52:55],v[124:127],v[172:175],v[52:55]
s_waitcnt vmcnt(2)
s_barrier
s_waitcnt lgkmcnt(2)
v_mfma_f32_16x16x32_bf16 v[24:27],a[176:179],v[104:107],v[24:27]
ds_read_b128 v[120:123],v4 offset:16384
v_mfma_f32_16x16x32_bf16 v[40:43],v[104:107],v[176:179],v[40:43]
v_mfma_f32_16x16x32_bf16 v[28:31],a[176:179],v[108:111],v[28:31]
ds_read_b128 v[124:127],v4 offset:20480
v_mfma_f32_16x16x32_bf16 v[44:47],v[108:111],v[176:179],v[44:47]
v_mfma_f32_16x16x32_bf16 v[32:35],a[184:187],v[104:107],v[32:35]
v_mfma_f32_16x16x32_bf16 v[48:51],v[104:107],v[184:187],v[48:51]
v_mfma_f32_16x16x32_bf16 v[36:39],a[184:187],v[108:111],v[36:39]
v_mfma_f32_16x16x32_bf16 v[52:55],v[108:111],v[184:187],v[52:55]
s_waitcnt lgkmcnt(2)
v_mfma_f32_16x16x32_bf16 v[24:27],a[180:183],v[112:115],v[24:27]
ds_read_b128 v[104:107],v5 offset:16384
v_mfma_f32_16x16x32_bf16 v[40:43],v[112:115],v[180:183],v[40:43]
v_mfma_f32_16x16x32_bf16 v[28:31],a[180:183],v[116:119],v[28:31]
ds_read_b128 v[108:111],v5 offset:20480
v_mfma_f32_16x16x32_bf16 v[44:47],v[116:119],v[180:183],v[44:47]
v_mfma_f32_16x16x32_bf16 v[32:35],a[188:191],v[112:115],v[32:35]
v_mfma_f32_16x16x32_bf16 v[48:51],v[112:115],v[188:191],v[48:51]
v_mfma_f32_16x16x32_bf16 v[36:39],a[188:191],v[116:119],v[36:39]
v_mfma_f32_16x16x32_bf16 v[52:55],v[116:119],v[188:191],v[52:55]
s_waitcnt lgkmcnt(2)
v_mfma_f32_16x16x32_bf16 v[24:27],a[192:195],v[120:123],v[24:27]
ds_read_b128 v[112:115],v6 offset:16384
v_mfma_f32_16x16x32_bf16 v[40:43],v[120:123],v[192:195],v[40:43]
v_mfma_f32_16x16x32_bf16 v[28:31],a[192:195],v[124:127],v[28:31]
ds_read_b128 v[116:119],v6 offset:20480
v_mfma_f32_16x16x32_bf16 v[44:47],v[124:127],v[192:195],v[44:47]
v_mfma_f32_16x16x32_bf16 v[32:35],a[200:203],v[120:123],v[32:35]
v_mfma_f32_16x16x32_bf16 v[48:51],v[120:123],v[200:203],v[48:51]
v_mfma_f32_16x16x32_bf16 v[36:39],a[200:203],v[124:127],v[36:39]
v_mfma_f32_16x16x32_bf16 v[52:55],v[124:127],v[200:203],v[52:55]
s_waitcnt lgkmcnt(2)
v_mfma_f32_16x16x32_bf16 v[24:27],a[196:199],v[104:107],v[24:27]
ds_read_b128 v[120:123],v7 offset:16384
v_mfma_f32_16x16x32_bf16 v[40:43],v[104:107],v[196:199],v[40:43]
v_mfma_f32_16x16x32_bf16 v[28:31],a[196:199],v[108:111],v[28:31]
ds_read_b128 v[124:127],v7 offset:20480
v_mfma_f32_16x16x32_bf16 v[44:47],v[108:111],v[196:199],v[44:47]
v_mfma_f32_16x16x32_bf16 v[32:35],a[204:207],v[104:107],v[32:35]
v_mfma_f32_16x16x32_bf16 v[48:51],v[104:107],v[204:207],v[48:51]
v_mfma_f32_16x16x32_bf16 v[36:39],a[204:207],v[108:111],v[36:39]
v_mfma_f32_16x16x32_bf16 v[52:55],v[108:111],v[204:207],v[52:55]
s_waitcnt vmcnt(0)
s_barrier
s_waitcnt lgkmcnt(2)
v_mfma_f32_16x16x32_bf16 v[24:27],a[208:211],v[112:115],v[24:27]
ds_read_b128 v[104:107],v4 offset:24576
v_mfma_f32_16x16x32_bf16 v[40:43],v[112:115],v[208:211],v[40:43]
v_mfma_f32_16x16x32_bf16 v[28:31],a[208:211],v[116:119],v[28:31]
ds_read_b128 v[108:111],v4 offset:28672
v_mfma_f32_16x16x32_bf16 v[44:47],v[116:119],v[208:211],v[44:47]
v_mfma_f32_16x16x32_bf16 v[32:35],a[216:219],v[112:115],v[32:35]
v_mfma_f32_16x16x32_bf16 v[48:51],v[112:115],v[216:219],v[48:51]
v_mfma_f32_16x16x32_bf16 v[36:39],a[216:219],v[116:119],v[36:39]
v_mfma_f32_16x16x32_bf16 v[52:55],v[116:119],v[216:219],v[52:55]
s_waitcnt lgkmcnt(2)
v_mfma_f32_16x16x32_bf16 v[24:27],a[212:215],v[120:123],v[24:27]
ds_read_b128 v[112:115],v5 offset:24576
v_mfma_f32_16x16x32_bf16 v[40:43],v[120:123],v[212:215],v[40:43]
v_mfma_f32_16x16x32_bf16 v[28:31],a[212:215],v[124:127],v[28:31]
ds_read_b128 v[116:119],v5 offset:28672
v_mfma_f32_16x16x32_bf16 v[44:47],v[124:127],v[212:215],v[44:47]
v_mfma_f32_16x16x32_bf16 v[32:35],a[220:223],v[120:123],v[32:35]
v_mfma_f32_16x16x32_bf16 v[48:51],v[120:123],v[220:223],v[48:51]
v_mfma_f32_16x16x32_bf16 v[36:39],a[220:223],v[124:127],v[36:39]
v_mfma_f32_16x16x32_bf16 v[52:55],v[124:127],v[220:223],v[52:55]
s_waitcnt lgkmcnt(2)
v_mfma_f32_16x16x32_bf16 v[24:27],a[224:227],v[104:107],v[24:27]
ds_read_b128 v[120:123],v6 offset:24576
v_mfma_f32_16x16x32_bf16 v[40:43],v[104:107],v[224:227],v[40:43]
v_mfma_f32_16x16x32_bf16 v[28:31],a[224:227],v[108:111],v[28:31]
ds_read_b128 v[124:127],v6 offset:28672
v_mfma_f32_16x16x32_bf16 v[44:47],v[108:111],v[224:227],v[44:47]
v_mfma_f32_16x16x32_bf16 v[32:35],a[232:235],v[104:107],v[32:35]
v_mfma_f32_16x16x32_bf16 v[48:51],v[104:107],v[232:235],v[48:51]
v_mfma_f32_16x16x32_bf16 v[36:39],a[232:235],v[108:111],v[36:39]
v_mfma_f32_16x16x32_bf16 v[52:55],v[108:111],v[232:235],v[52:55]
s_waitcnt lgkmcnt(2)
v_mfma_f32_16x16x32_bf16 v[24:27],a[228:231],v[112:115],v[24:27]
ds_read_b128 v[104:107],v7 offset:24576
v_mfma_f32_16x16x32_bf16 v[40:43],v[112:115],v[228:231],v[40:43]
v_mfma_f32_16x16x32_bf16 v[28:31],a[228:231],v[116:119],v[28:31]
ds_read_b128 v[108:111],v7 offset:28672
v_mfma_f32_16x16x32_bf16 v[44:47],v[116:119],v[228:231],v[44:47]
v_mfma_f32_16x16x32_bf16 v[32:35],a[236:239],v[112:115],v[32:35]
v_mfma_f32_16x16x32_bf16 v[48:51],v[112:115],v[236:239],v[48:51]
v_mfma_f32_16x16x32_bf16 v[36:39],a[236:239],v[116:119],v[36:39]
v_mfma_f32_16x16x32_bf16 v[52:55],v[116:119],v[236:239],v[52:55]
s_waitcnt lgkmcnt(2)
v_mfma_f32_16x16x32_bf16 v[24:27],a[240:243],v[120:123],v[24:27]
ds_read_b128 v[112:115],v4 offset:0
v_mfma_f32_16x16x32_bf16 v[40:43],v[120:123],v[240:243],v[40:43]
v_mfma_f32_16x16x32_bf16 v[28:31],a[240:243],v[124:127],v[28:31]
ds_read_b128 v[116:119],v4 offset:4096
v_mfma_f32_16x16x32_bf16 v[44:47],v[124:127],v[240:243],v[44:47]
v_mfma_f32_16x16x32_bf16 v[32:35],a[248:251],v[120:123],v[32:35]
v_mfma_f32_16x16x32_bf16 v[48:51],v[120:123],v[248:251],v[48:51]
v_mfma_f32_16x16x32_bf16 v[36:39],a[248:251],v[124:127],v[36:39]
v_mfma_f32_16x16x32_bf16 v[52:55],v[124:127],v[248:251],v[52:55]
s_waitcnt lgkmcnt(2)
v_mfma_f32_16x16x32_bf16 v[24:27],a[244:247],v[104:107],v[24:27]
ds_read_b128 v[120:123],v5 offset:0
v_mfma_f32_16x16x32_bf16 v[40:43],v[104:107],v[244:247],v[40:43]
v_mfma_f32_16x16x32_bf16 v[28:31],a[244:247],v[108:111],v[28:31]
ds_read_b128 v[124:127],v5 offset:4096
v_mfma_f32_16x16x32_bf16 v[44:47],v[108:111],v[244:247],v[44:47]
v_mfma_f32_16x16x32_bf16 v[32:35],a[252:255],v[104:107],v[32:35]
v_mfma_f32_16x16x32_bf16 v[48:51],v[104:107],v[252:255],v[48:51]
v_mfma_f32_16x16x32_bf16 v[36:39],a[252:255],v[108:111],v[36:39]
v_mfma_f32_16x16x32_bf16 v[52:55],v[108:111],v[252:255],v[52:55]
s_waitcnt lgkmcnt(2)
v_mfma_f32_16x16x32_bf16 v[88:91],a[0:3],v[112:115],0
ds_read_b128 v[104:107],v6 offset:0
v_mfma_f32_16x16x32_bf16 v[92:95],a[0:3],v[116:119],0
v_mfma_f32_16x16x32_bf16 v[96:99],a[8:11],v[112:115],0
ds_read_b128 v[108:111],v6 offset:4096
v_mfma_f32_16x16x32_bf16 v[100:103],a[8:11],v[116:119],0
s_waitcnt lgkmcnt(2)
v_mfma_f32_16x16x32_bf16 v[88:91],a[4:7],v[120:123],v[88:91]
ds_read_b128 v[112:115],v7 offset:0
v_mfma_f32_16x16x32_bf16 v[92:95],a[4:7],v[124:127],v[92:95]
v_cvt_pk_bf16_f32 v56,v24,v32
v_cvt_pk_bf16_f32 v57,v25,v33
v_mfma_f32_16x16x32_bf16 v[96:99],a[12:15],v[120:123],v[96:99]
ds_read_b128 v[116:119],v7 offset:4096
v_mfma_f32_16x16x32_bf16 v[100:103],a[12:15],v[124:127],v[100:103]
v_cvt_pk_bf16_f32 v58,v26,v34
v_cvt_pk_bf16_f32 v59,v27,v35
s_waitcnt lgkmcnt(2)
v_mfma_f32_16x16x32_bf16 v[88:91],a[16:19],v[104:107],v[88:91]
ds_read_b128 v[120:123],v4 offset:8192
v_mfma_f32_16x16x32_bf16 v[92:95],a[16:19],v[108:111],v[92:95]
buffer_store_dwordx4 v[56:59],v0,s[8:11],s61 offen sc1
v_cvt_pk_bf16_f32 v60,v28,v36
v_mfma_f32_16x16x32_bf16 v[96:99],a[24:27],v[104:107],v[96:99]
ds_read_b128 v[124:127],v4 offset:12288
v_mfma_f32_16x16x32_bf16 v[100:103],a[24:27],v[108:111],v[100:103]
v_cvt_pk_bf16_f32 v61,v29,v37
v_cvt_pk_bf16_f32 v62,v30,v38
s_waitcnt lgkmcnt(2)
v_mfma_f32_16x16x32_bf16 v[88:91],a[20:23],v[112:115],v[88:91]
ds_read_b128 v[104:107],v5 offset:8192
v_mfma_f32_16x16x32_bf16 v[92:95],a[20:23],v[116:119],v[92:95]
v_cvt_pk_bf16_f32 v63,v31,v39
buffer_store_dwordx4 v[60:63],v0,s[8:11],s62 offen sc1
v_mfma_f32_16x16x32_bf16 v[96:99],a[28:31],v[112:115],v[96:99]
ds_read_b128 v[108:111],v5 offset:12288
v_mfma_f32_16x16x32_bf16 v[100:103],a[28:31],v[116:119],v[100:103]
v_cvt_pk_bf16_f32 v64,v40,v41
v_cvt_pk_bf16_f32 v65,v42,v43
s_waitcnt lgkmcnt(2)
v_mfma_f32_16x16x32_bf16 v[88:91],a[32:35],v[120:123],v[88:91]
ds_read_b128 v[112:115],v6 offset:8192
v_mfma_f32_16x16x32_bf16 v[92:95],a[32:35],v[124:127],v[92:95]
v_cvt_pk_bf16_f32 v66,v44,v45
v_cvt_pk_bf16_f32 v67,v46,v47
v_mfma_f32_16x16x32_bf16 v[96:99],a[40:43],v[120:123],v[96:99]
ds_read_b128 v[116:119],v6 offset:12288
v_mfma_f32_16x16x32_bf16 v[100:103],a[40:43],v[124:127],v[100:103]
buffer_store_dwordx4 v[64:67],v0,s[8:11],s65 offen offset:0 sc1
v_cvt_pk_bf16_f32 v68,v48,v49
s_waitcnt lgkmcnt(2)
v_mfma_f32_16x16x32_bf16 v[88:91],a[36:39],v[104:107],v[88:91]
ds_read_b128 v[120:123],v7 offset:8192
v_mfma_f32_16x16x32_bf16 v[92:95],a[36:39],v[108:111],v[92:95]
v_cvt_pk_bf16_f32 v69,v50,v51
v_cvt_pk_bf16_f32 v70,v52,v53
v_mfma_f32_16x16x32_bf16 v[96:99],a[44:47],v[104:107],v[96:99]
ds_read_b128 v[124:127],v7 offset:12288
v_mfma_f32_16x16x32_bf16 v[100:103],a[44:47],v[108:111],v[100:103]
v_cvt_pk_bf16_f32 v71,v54,v55
buffer_store_dwordx4 v[68:71],v0,s[8:11],s65 offen offset:1024 sc1
s_waitcnt lgkmcnt(2)
v_mfma_f32_16x16x32_bf16 v[88:91],a[48:51],v[112:115],v[88:91]
ds_read_b128 v[104:107],v4 offset:16384
v_mfma_f32_16x16x32_bf16 v[92:95],a[48:51],v[116:119],v[92:95]
v_mfma_f32_16x16x32_bf16 v[96:99],a[56:59],v[112:115],v[96:99]
ds_read_b128 v[108:111],v4 offset:20480
v_mfma_f32_16x16x32_bf16 v[100:103],a[56:59],v[116:119],v[100:103]
s_waitcnt lgkmcnt(2)
v_mfma_f32_16x16x32_bf16 v[88:91],a[52:55],v[120:123],v[88:91]
ds_read_b128 v[112:115],v5 offset:16384
v_mfma_f32_16x16x32_bf16 v[92:95],a[52:55],v[124:127],v[92:95]
v_mfma_f32_16x16x32_bf16 v[96:99],a[60:63],v[120:123],v[96:99]
ds_read_b128 v[116:119],v5 offset:20480
v_mfma_f32_16x16x32_bf16 v[100:103],a[60:63],v[124:127],v[100:103]
s_waitcnt lgkmcnt(2)
v_mfma_f32_16x16x32_bf16 v[88:91],a[64:67],v[104:107],v[88:91]
ds_read_b128 v[120:123],v6 offset:16384
v_mfma_f32_16x16x32_bf16 v[92:95],a[64:67],v[108:111],v[92:95]
v_mfma_f32_16x16x32_bf16 v[96:99],a[72:75],v[104:107],v[96:99]
ds_read_b128 v[124:127],v6 offset:20480
v_mfma_f32_16x16x32_bf16 v[100:103],a[72:75],v[108:111],v[100:103]
s_waitcnt lgkmcnt(2)
v_mfma_f32_16x16x32_bf16 v[88:91],a[68:71],v[112:115],v[88:91]
ds_read_b128 v[104:107],v7 offset:16384
v_mfma_f32_16x16x32_bf16 v[92:95],a[68:71],v[116:119],v[92:95]
v_mfma_f32_16x16x32_bf16 v[96:99],a[76:79],v[112:115],v[96:99]
ds_read_b128 v[108:111],v7 offset:20480
v_mfma_f32_16x16x32_bf16 v[100:103],a[76:79],v[116:119],v[100:103]
s_waitcnt lgkmcnt(2)
v_mfma_f32_16x16x32_bf16 v[88:91],a[80:83],v[120:123],v[88:91]
ds_read_b128 v[112:115],v4 offset:24576
v_mfma_f32_16x16x32_bf16 v[92:95],a[80:83],v[124:127],v[92:95]
v_mfma_f32_16x16x32_bf16 v[96:99],a[88:91],v[120:123],v[96:99]
ds_read_b128 v[116:119],v4 offset:28672
v_mfma_f32_16x16x32_bf16 v[100:103],a[88:91],v[124:127],v[100:103]
s_waitcnt lgkmcnt(2)
v_mfma_f32_16x16x32_bf16 v[88:91],a[84:87],v[104:107],v[88:91]
ds_read_b128 v[120:123],v5 offset:24576
v_mfma_f32_16x16x32_bf16 v[92:95],a[84:87],v[108:111],v[92:95]
v_mfma_f32_16x16x32_bf16 v[96:99],a[92:95],v[104:107],v[96:99]
ds_read_b128 v[124:127],v5 offset:28672
v_mfma_f32_16x16x32_bf16 v[100:103],a[92:95],v[108:111],v[100:103]
s_waitcnt lgkmcnt(2)
v_mfma_f32_16x16x32_bf16 v[88:91],a[96:99],v[112:115],v[88:91]
ds_read_b128 v[104:107],v6 offset:24576
v_mfma_f32_16x16x32_bf16 v[92:95],a[96:99],v[116:119],v[92:95]
v_mfma_f32_16x16x32_bf16 v[96:99],a[104:107],v[112:115],v[96:99]
ds_read_b128 v[108:111],v6 offset:28672
v_mfma_f32_16x16x32_bf16 v[100:103],a[104:107],v[116:119],v[100:103]
s_waitcnt lgkmcnt(2)
v_mfma_f32_16x16x32_bf16 v[88:91],a[100:103],v[120:123],v[88:91]
ds_read_b128 v[112:115],v7 offset:24576
v_mfma_f32_16x16x32_bf16 v[92:95],a[100:103],v[124:127],v[92:95]
v_mfma_f32_16x16x32_bf16 v[96:99],a[108:111],v[120:123],v[96:99]
ds_read_b128 v[116:119],v7 offset:28672
v_mfma_f32_16x16x32_bf16 v[100:103],a[108:111],v[124:127],v[100:103]
s_waitcnt lgkmcnt(2)
v_mfma_f32_16x16x32_bf16 v[88:91],a[112:115],v[104:107],v[88:91]
v_mfma_f32_16x16x32_bf16 v[92:95],a[112:115],v[108:111],v[92:95]
v_mfma_f32_16x16x32_bf16 v[96:99],a[120:123],v[104:107],v[96:99]
v_mfma_f32_16x16x32_bf16 v[100:103],a[120:123],v[108:111],v[100:103]
s_waitcnt lgkmcnt(0)
v_mfma_f32_16x16x32_bf16 v[88:91],a[116:119],v[112:115],v[88:91]
v_mfma_f32_16x16x32_bf16 v[92:95],a[116:119],v[116:119],v[92:95]
v_mfma_f32_16x16x32_bf16 v[96:99],a[124:127],v[112:115],v[96:99]
v_mfma_f32_16x16x32_bf16 v[100:103],a[124:127],v[116:119],v[100:103]
s_nop 3
v_cvt_pk_bf16_f32 v104,v88,v96
v_cvt_pk_bf16_f32 v105,v89,v97
v_cvt_pk_bf16_f32 v106,v90,v98
v_cvt_pk_bf16_f32 v107,v91,v99
v_cvt_pk_bf16_f32 v108,v92,v100
v_cvt_pk_bf16_f32 v109,v93,v101
v_cvt_pk_bf16_f32 v110,v94,v102
v_cvt_pk_bf16_f32 v111,v95,v103
buffer_store_dwordx4 v[104:107],v0,s[8:11],s63 offen sc1
buffer_store_dwordx4 v[108:111],v0,s[8:11],s64 offen sc1
s_lshl_b32 s59,s51,13
s_lshl2_add_u32 s59,s47,s59
s_add_u32 s59,s59,10486016
s_waitcnt vmcnt(2)
s_barrier
s_or_b32 s59,s59,s52
buffer_store_dword v17,off,s[8:11],s59 sc1
s_add_u32 m0,s50,131072
s_nop 0
buffer_load_dwordx4 v20,s[8:11],s70 offen offset:0 sc1 lds
s_add_u32 m0,s50,135168
s_nop 0
buffer_load_dwordx4 v20,s[8:11],s71 offen offset:0 sc1 lds
s_add_u32 m0,s50,139008
s_nop 0
buffer_load_dwordx4 v20,s[8:11],s70 offen offset:256 sc1 lds
s_add_u32 m0,s50,143104
s_nop 0
buffer_load_dwordx4 v20,s[8:11],s71 offen offset:256 sc1 lds
s_add_u32 m0,s50,146944
s_nop 0
buffer_load_dwordx4 v20,s[8:11],s70 offen offset:512 sc1 lds
s_add_u32 m0,s50,151040
s_nop 0
buffer_load_dwordx4 v20,s[8:11],s71 offen offset:512 sc1 lds
s_lshl_b32 s59,s51,13
s_lshl2_add_u32 s59,s47,s59
s_add_u32 s59,s59,10487680
s_waitcnt vmcnt(0)
s_barrier
s_or_b32 s59,s59,s52
buffer_store_dword v17,off,s[8:11],s59 sc1
L_mo_22:
s_mov_b32 s77,-1
s_sub_u32 s56,s30,s31
s_cmp_eq_u32 s73,0
s_cselect_b32 s57,22,8
s_add_u32 s57,s57,s73
s_min_u32 s57,s57,60
s_cmp_lt_i32 s56,s57
s_cbranch_scc1 L_mo_19
s_waitcnt vmcnt(0)
s_barrier
s_or_b32 s72,s72,s52
buffer_store_dword v17,off,s[8:11],s72 sc1
s_mov_b32 s72,0x80000000
s_cmp_lt_u32 s31,64
s_cbranch_scc1 L_mo_18
s_mov_b32 s51,64
v_lshrrev_b32 v2,3,v1
v_and_b32 v3,7,v1
v_lshlrev_b32 v3,4,v3
v_lshl_add_u32 v3,v2,13,v3
s_lshr_b64 s[88:89],s[84:85],0
v_lshrrev_b32 v60,v2,s88
v_and_b32 v60,1,v60
v_mul_u32_u24 v60,768,v60
v_sub_u32 v60,v3,v60
v_add_u32 v60,10487296,v60
s_lshr_b64 s[88:89],s[84:85],8
v_lshrrev_b32 v61,v2,s88
v_and_b32 v61,1,v61
v_mul_u32_u24 v61,768,v61
v_sub_u32 v61,v3,v61
v_add_u32 v61,10552832,v61
s_lshr_b64 s[88:89],s[84:85],16
v_lshrrev_b32 v62,v2,s88
v_and_b32 v62,1,v62
v_mul_u32_u24 v62,768,v62
v_sub_u32 v62,v3,v62
v_add_u32 v62,10618368,v62
s_lshr_b64 s[88:89],s[84:85],24
v_lshrrev_b32 v63,v2,s88
v_and_b32 v63,1,v63
v_mul_u32_u24 v63,768,v63
v_sub_u32 v63,v3,v63
v_add_u32 v63,10683904,v63
s_lshr_b64 s[88:89],s[84:85],32
v_lshrrev_b32 v64,v2,s88
v_and_b32 v64,1,v64
v_mul_u32_u24 v64,768,v64
v_sub_u32 v64,v3,v64
v_add_u32 v64,10749440,v64
s_lshr_b64 s[88:89],s[84:85],40
v_lshrrev_b32 v65,v2,s88
v_and_b32 v65,1,v65
v_mul_u32_u24 v65,768,v65
v_sub_u32 v65,v3,v65
v_add_u32 v65,10814976,v65
s_lshr_b64 s[88:89],s[84:85],48
v_lshrrev_b32 v66,v2,s88
v_and_b32 v66,1,v66
v_mul_u32_u24 v66,768,v66
v_sub_u32 v66,v3,v66
v_add_u32 v66,10880512,v66
s_lshr_b64 s[88:89],s[84:85],56
v_lshrrev_b32 v67,v2,s88
v_and_b32 v67,1,v67
v_mul_u32_u24 v67,768,v67
v_sub_u32 v67,v3,v67
v_add_u32 v67,10946048,v67
L_mw_32:
s_sleep 2
buffer_load_dwordx4 v[24:27],v60,s[8:11],0 offen sc1
buffer_load_dwordx4 v[28:31],v61,s[8:11],0 offen sc1
buffer_load_dwordx4 v[32:35],v62,s[8:11],0 offen sc1
buffer_load_dwordx4 v[36:39],v63,s[8:11],0 offen sc1
buffer_load_dwordx4 v[40:43],v64,s[8:11],0 offen sc1
buffer_load_dwordx4 v[44:47],v65,s[8:11],0 offen sc1
buffer_load_dwordx4 v[48:51],v66,s[8:11],0 offen sc1
buffer_load_dwordx4 v[52:55],v67,s[8:11],0 offen sc1
s_sub_u32 s49,s49,1
s_cbranch_scc1 L_abort
s_waitcnt vmcnt(0)
v_min_u32 v56,v24,v25
v_min3_u32 v56,v26,v27,v56
v_min3_u32 v56,v28,v29,v56
v_min3_u32 v56,v30,v31,v56
v_min3_u32 v56,v32,v33,v56
v_min3_u32 v56,v34,v35,v56
v_min3_u32 v56,v36,v37,v56
v_min3_u32 v56,v38,v39,v56
v_min3_u32 v56,v40,v41,v56
v_min3_u32 v56,v42,v43,v56
v_min3_u32 v56,v44,v45,v56
v_min3_u32 v56,v46,v47,v56
v_min3_u32 v56,v48,v49,v56
v_min3_u32 v56,v50,v51,v56
v_min3_u32 v56,v52,v53,v56
v_min3_u32 v56,v54,v55,v56
v_cmp_eq_u32 vcc,0,v56
s_cbranch_vccnz L_mw_32
v_max_u32 v24,v24,v25
v_max3_u32 v24,v26,v27,v24
v_max3_u32 v24,v28,v29,v24
v_max3_u32 v24,v30,v31,v24
v_max3_u32 v24,v32,v33,v24
v_max3_u32 v24,v34,v35,v24
v_max3_u32 v24,v36,v37,v24
v_max3_u32 v24,v38,v39,v24
v_max3_u32 v24,v40,v41,v24
v_max3_u32 v24,v42,v43,v24
v_max3_u32 v24,v44,v45,v24
v_max3_u32 v24,v46,v47,v24
v_max3_u32 v24,v48,v49,v24
v_max3_u32 v24,v50,v51,v24
v_max3_u32 v24,v52,v53,v24
v_max3_u32 v24,v54,v55,v24
s_nop 1
v_max_u32_dpp v24,v24,v24 row_ror:8 row_mask:0xf bank_mask:0xf
s_nop 1
v_max_u32_dpp v24,v24,v24 row_ror:4 row_mask:0xf bank_mask:0xf
s_nop 1
v_max_u32_dpp v24,v24,v24 row_ror:2 row_mask:0xf bank_mask:0xf
s_nop 1
v_max_u32_dpp v24,v24,v24 row_ror:1 row_mask:0xf bank_mask:0xf
v_mov_b32 v25,v24
s_nop 1
v_permlane16_swap_b32 v24,v25
v_max_u32 v24,v24,v25
v_mov_b32 v25,v24
s_nop 1
v_permlane32_swap_b32 v24,v25
v_max_u32 v24,v24,v25
s_nop 0
v_readfirstlane_b32 s55,v24
s_and_b32 s64,s55,0x7ff
s_sub_u32 s64,2047,s64
s_lshl_b32 s56,s64,10
s_add_u32 s58,s56,6291456
buffer_load_dwordx4 v[88:91],v0,s[8:11],s58 offen sc1
s_mov_b32 s4,s38
s_mov_b32 s5,s39
s_mov_b32 s6,1835008
s_mov_b32 s7,0x20000
v_and_b32 v9,15,v1
v_lshrrev_b32 v10,4,v1
v_lshlrev_b32 v8,14,v10
v_lshl_add_u32 v8,v9,4,v8
s_lshl_b32 s59,s47,16
s_lshl_b32 s60,s46,8
s_add_u32 s59,s59,s60
buffer_load_dwordx4 v[24:27],v8,s[4:7],s59 offen offset:0
buffer_load_dwordx4 v[28:31],v8,s[4:7],s59 offen offset:1024
buffer_load_dwordx4 v[32:35],v8,s[4:7],s59 offen offset:2048
buffer_load_dwordx4 v[36:39],v8,s[4:7],s59 offen offset:3072
s_add_u32 s59,s59,4096
buffer_load_dwordx4 v[40:43],v8,s[4:7],s59 offen offset:0
buffer_load_dwordx4 v[44:47],v8,s[4:7],s59 offen offset:1024
buffer_load_dwordx4 v[48:51],v8,s[4:7],s59 offen offset:2048
buffer_load_dwordx4 v[52:55],v8,s[4:7],s59 offen offset:3072
s_add_u32 s59,s59,4096
buffer_load_dwordx4 v[56:59],v8,s[4:7],s59 offen offset:0
buffer_load_dwordx4 v[60:63],v8,s[4:7],s59 offen offset:1024
buffer_load_dwordx4 v[64:67],v8,s[4:7],s59 offen offset:2048
buffer_load_dwordx4 v[68:71],v8,s[4:7],s59 offen offset:3072
s_add_u32 s59,s59,4096
buffer_load_dwordx4 v[72:75],v8,s[4:7],s59 offen offset:0
buffer_load_dwordx4 v[76:79],v8,s[4:7],s59 offen offset:1024
buffer_load_dwordx4 v[80:83],v8,s[4:7],s59 offen offset:2048
buffer_load_dwordx4 v[84:87],v8,s[4:7],s59 offen offset:3072
v_and_b32 v124,1,v1
v_lshlrev_b32 v124,4,v124
v_mov_b32 v125,0xffff
v_lshlrev_b32 v125,v124,v125
v_lshrrev_b32 v124,1,v9
v_cmp_eq_u32 vcc,0,v124
s_nop 1
v_cndmask_b32 v12,0,v125,vcc
v_cmp_eq_u32 vcc,1,v124
s_nop 1
v_cndmask_b32 v13,0,v125,vcc
v_cmp_eq_u32 vcc,2,v124
s_nop 1
v_cndmask_b32 v14,0,v125,vcc
v_cmp_eq_u32 vcc,3,v124
s_nop 1
v_cndmask_b32 v15,0,v125,vcc
s_waitcnt vmcnt(16)
v_lshlrev_b32 v96,16,v88
v_and_b32 v97,0xffff0000,v88
v_lshlrev_b32 v98,16,v89
v_and_b32 v99,0xffff0000,v89
v_lshlrev_b32 v100,16,v90
v_and_b32 v101,0xffff0000,v90
v_lshlrev_b32 v102,16,v91
v_and_b32 v103,0xffff0000,v91
v_readfirstlane_b32 s78,v96
s_nop 1
v_pk_add_f32 v[108:109],v[96:97],s[78:79] op_sel_hi:[1,0] neg_lo:[0,1] neg_hi:[0,1]
v_pk_add_f32 v[110:111],v[98:99],s[78:79] op_sel_hi:[1,0] neg_lo:[0,1] neg_hi:[0,1]
v_pk_add_f32 v[112:113],v[100:101],s[78:79] op_sel_hi:[1,0] neg_lo:[0,1] neg_hi:[0,1]
v_pk_add_f32 v[114:115],v[102:103],s[78:79] op_sel_hi:[1,0] neg_lo:[0,1] neg_hi:[0,1]
v_pk_add_f32 v[116:117],v[108:109],v[110:111]
v_pk_mul_f32 v[118:119],v[108:109],v[108:109]
v_pk_add_f32 v[120:121],v[112:113],v[114:115]
v_pk_fma_f32 v[118:119],v[110:111],v[110:111],v[118:119]
v_pk_add_f32 v[116:117],v[116:117],v[120:121]
v_pk_fma_f32 v[118:119],v[112:113],v[112:113],v[118:119]
v_add_f32 v116,v116,v117
v_pk_fma_f32 v[118:119],v[114:115],v[114:115],v[118:119]
v_add_f32 v118,v118,v119
s_nop 1
v_permlane32_swap_b32 v116,v118
v_add_f32 v116,v116,v118
s_nop 1
v_add_f32_dpp v116,v116,v116 row_ror:8 row_mask:0xf bank_mask:0xf
s_nop 1
v_add_f32_dpp v116,v116,v116 row_ror:4 row_mask:0xf bank_mask:0xf
s_nop 1
v_add_f32_dpp v116,v116,v116 row_ror:2 row_mask:0xf bank_mask:0xf
s_nop 1
v_add_f32_dpp v116,v116,v116 row_ror:1 row_mask:0xf bank_mask:0xf
v_mov_b32 v118,v116
s_nop 1
v_permlane16_swap_b32 v116,v118
v_add_f32 v116,v116,v118
v_mul_f32 v116,0x3b000000,v116
v_mov_b32 v118,v116
s_nop 1
v_permlane32_swap_b32 v116,v118
v_fma_f32 v118,-v116,v116,v118
v_add_f32 v116,s78,v116
v_max_f32 v118,0,v118
v_cvt_pk_bf16_f32 v118,v116,v118
v_lshlrev_b32 v116,16,v118
v_and_b32 v118,0xffff0000,v118
v_add_f32 v118,0x3727c5ac,v118
v_cvt_pk_bf16_f32 v118,v118,v118
v_and_b32 v118,0xffff0000,v118
v_sqrt_f32 v118,v118
v_pk_add_f32 v[108:109],v[96:97],v[116:117] op_sel_hi:[1,0] neg_lo:[0,1] neg_hi:[0,1]
v_pk_add_f32 v[110:111],v[98:99],v[116:117] op_sel_hi:[1,0] neg_lo:[0,1] neg_hi:[0,1]
v_pk_add_f32 v[112:113],v[100:101],v[116:117] op_sel_hi:[1,0] neg_lo:[0,1] neg_hi:[0,1]
v_pk_add_f32 v[114:115],v[102:103],v[116:117] op_sel_hi:[1,0] neg_lo:[0,1] neg_hi:[0,1]
v_cvt_pk_bf16_f32 v118,v118,v118
v_and_b32 v118,0xffff0000,v118
v_rcp_f32 v118,v118
v_cvt_pk_bf16_f32 v104,v108,v109
v_cvt_pk_bf16_f32 v105,v110,v111
v_cvt_pk_bf16_f32 v106,v112,v113
v_cvt_pk_bf16_f32 v107,v114,v115
v_lshlrev_b32 v108,16,v104
v_and_b32 v109,0xffff0000,v104
v_lshlrev_b32 v110,16,v105
v_and_b32 v111,0xffff0000,v105
v_lshlrev_b32 v112,16,v106
v_and_b32 v113,0xffff0000,v106
v_lshlrev_b32 v114,16,v107
v_and_b32 v115,0xffff0000,v107
v_pk_mul_f32 v[108:109],v[108:109],v[118:119] op_sel_hi:[1,0]
v_pk_mul_f32 v[110:111],v[110:111],v[118:119] op_sel_hi:[1,0]
v_pk_mul_f32 v[112:113],v[112:113],v[118:119] op_sel_hi:[1,0]
v_pk_mul_f32 v[114:115],v[114:115],v[118:119] op_sel_hi:[1,0]
v_cvt_pk_bf16_f32 v104,v108,v109
v_cvt_pk_bf16_f32 v105,v110,v111
v_cvt_pk_bf16_f32 v106,v112,v113
v_cvt_pk_bf16_f32 v107,v114,v115
s_mov_b32 s58,0x01000100
s_mov_b32 s59,0x03020302
v_perm_b32 v88,v104,v104,s58
v_perm_b32 v89,v104,v104,s59
v_perm_b32 v90,v105,v105,s58
v_perm_b32 v91,v105,v105,s59
v_perm_b32 v92,v106,v106,s58
v_perm_b32 v93,v106,v106,s59
v_perm_b32 v94,v107,v107,s58
v_perm_b32 v95,v107,v107,s59
v_lshlrev_b32 v8,5,v1
s_lshl_b32 s58,s46,11
s_add_u32 s58,s58,139264
v_add_u32 v8,s58,v8
ds_write_b128 v8,v[88:91]
ds_write_b128 v8,v[92:95] offset:16
s_lshl_b32 s59,s46,9
s_add_u32 s59,s58,s59
v_lshlrev_b32 v8,7,v10
v_add_u32 v8,s59,v8
s_waitcnt lgkmcnt(0)
ds_read_b128 v[108:111],v18 offset:0
ds_read_b128 v[88:91],v8 offset:0
ds_read_b128 v[92:95],v8 offset:16
ds_read_b128 v[112:115],v18 offset:1024
s_waitcnt lgkmcnt(1)
v_and_b32 v124,v12,v88
v_and_b32 v125,v13,v88
v_and_b32 v126,v14,v88
v_and_b32 v127,v15,v88
s_nop 1
v_mfma_f32_16x16x32_bf16 v[116:119],v[124:127],v[108:111],0
ds_read_b128 v[108:111],v18 offset:2048
s_waitcnt lgkmcnt(1)
v_and_b32 v124,v12,v89
v_and_b32 v125,v13,v89
v_and_b32 v126,v14,v89
v_and_b32 v127,v15,v89
s_nop 1
v_mfma_f32_16x16x32_bf16 v[116:119],v[124:127],v[112:115],v[116:119]
ds_read_b128 v[112:115],v18 offset:3072
s_waitcnt lgkmcnt(1)
v_and_b32 v124,v12,v90
v_and_b32 v125,v13,v90
v_and_b32 v126,v14,v90
v_and_b32 v127,v15,v90
s_nop 1
v_mfma_f32_16x16x32_bf16 v[116:119],v[124:127],v[108:111],v[116:119]
ds_read_b128 v[108:111],v18 offset:4096
s_waitcnt lgkmcnt(1)
v_and_b32 v124,v12,v91
v_and_b32 v125,v13,v91
v_and_b32 v126,v14,v91
v_and_b32 v127,v15,v91
s_nop 1
v_mfma_f32_16x16x32_bf16 v[116:119],v[124:127],v[112:115],v[116:119]
ds_read_b128 v[112:115],v18 offset:5120
s_waitcnt lgkmcnt(1)
v_and_b32 v124,v12,v92
v_and_b32 v125,v13,v92
v_and_b32 v126,v14,v92
v_and_b32 v127,v15,v92
s_nop 1
v_mfma_f32_16x16x32_bf16 v[116:119],v[124:127],v[108:111],v[116:119]
ds_read_b128 v[108:111],v18 offset:6144
s_waitcnt lgkmcnt(1)
v_and_b32 v124,v12,v93
v_and_b32 v125,v13,v93
v_and_b32 v126,v14,v93
v_and_b32 v127,v15,v93
s_nop 1
v_mfma_f32_16x16x32_bf16 v[116:119],v[124:127],v[112:115],v[116:119]
ds_read_b128 v[112:115],v18 offset:7168
s_waitcnt lgkmcnt(1)
v_and_b32 v124,v12,v94
v_and_b32 v125,v13,v94
v_and_b32 v126,v14,v94
v_and_b32 v127,v15,v94
s_nop 1
v_mfma_f32_16x16x32_bf16 v[116:119],v[124:127],v[108:111],v[116:119]
ds_read_b128 v[108:111],v18 offset:8192
s_waitcnt lgkmcnt(1)
v_and_b32 v124,v12,v95
v_and_b32 v125,v13,v95
v_and_b32 v126,v14,v95
v_and_b32 v127,v15,v95
s_nop 1
v_mfma_f32_16x16x32_bf16 v[116:119],v[124:127],v[112:115],v[116:119]
ds_read_b128 v[88:91],v8 offset:32
ds_read_b128 v[92:95],v8 offset:48
ds_read_b128 v[112:115],v18 offset:9216
s_waitcnt lgkmcnt(1)
v_and_b32 v124,v12,v88
v_and_b32 v125,v13,v88
v_and_b32 v126,v14,v88
v_and_b32 v127,v15,v88
s_nop 1
v_mfma_f32_16x16x32_bf16 v[116:119],v[124:127],v[108:111],v[116:119]
ds_read_b128 v[108:111],v18 offset:10240
s_waitcnt lgkmcnt(1)
v_and_b32 v124,v12,v89
v_and_b32 v125,v13,v89
v_and_b32 v126,v14,v89
v_and_b32 v127,v15,v89
s_nop 1
v_mfma_f32_16x16x32_bf16 v[116:119],v[124:127],v[112:115],v[116:119]
ds_read_b128 v[112:115],v18 offset:11264
s_waitcnt lgkmcnt(1)
v_and_b32 v124,v12,v90
v_and_b32 v125,v13,v90
v_and_b32 v126,v14,v90
v_and_b32 v127,v15,v90
s_nop 1
v_mfma_f32_16x16x32_bf16 v[116:119],v[124:127],v[108:111],v[116:119]
ds_read_b128 v[108:111],v18 offset:12288
s_waitcnt lgkmcnt(1)
v_and_b32 v124,v12,v91
v_and_b32 v125,v13,v91
v_and_b32 v126,v14,v91
v_and_b32 v127,v15,v91
s_nop 1
v_mfma_f32_16x16x32_bf16 v[116:119],v[124:127],v[112:115],v[116:119]
ds_read_b128 v[112:115],v18 offset:13312
s_waitcnt lgkmcnt(1)
v_and_b32 v124,v12,v92
v_and_b32 v125,v13,v92
v_and_b32 v126,v14,v92
v_and_b32 v127,v15,v92
s_nop 1
v_mfma_f32_16x16x32_bf16 v[116:119],v[124:127],v[108:111],v[116:119]
ds_read_b128 v[108:111],v18 offset:14336
s_waitcnt lgkmcnt(1)
v_and_b32 v124,v12,v93
v_and_b32 v125,v13,v93
v_and_b32 v126,v14,v93
v_and_b32 v127,v15,v93
s_nop 1
v_mfma_f32_16x16x32_bf16 v[116:119],v[124:127],v[112:115],v[116:119]
ds_read_b128 v[112:115],v18 offset:15360
s_waitcnt lgkmcnt(1)
v_and_b32 v124,v12,v94
v_and_b32 v125,v13,v94
v_and_b32 v126,v14,v94
v_and_b32 v127,v15,v94
s_nop 1
v_mfma_f32_16x16x32_bf16 v[116:119],v[124:127],v[108:111],v[116:119]
ds_read_b128 v[108:111],v18 offset:16384
s_waitcnt lgkmcnt(1)
v_and_b32 v124,v12,v95
v_and_b32 v125,v13,v95
v_and_b32 v126,v14,v95
v_and_b32 v127,v15,v95
s_nop 1
v_mfma_f32_16x16x32_bf16 v[116:119],v[124:127],v[112:115],v[116:119]
ds_read_b128 v[88:91],v8 offset:64
ds_read_b128 v[92:95],v8 offset:80
ds_read_b128 v[112:115],v18 offset:17408
s_waitcnt lgkmcnt(1)
v_and_b32 v124,v12,v88
v_and_b32 v125,v13,v88
v_and_b32 v126,v14,v88
v_and_b32 v127,v15,v88
s_nop 1
v_mfma_f32_16x16x32_bf16 v[116:119],v[124:127],v[108:111],v[116:119]
ds_read_b128 v[108:111],v18 offset:18432
s_waitcnt lgkmcnt(1)
v_and_b32 v124,v12,v89
v_and_b32 v125,v13,v89
v_and_b32 v126,v14,v89
v_and_b32 v127,v15,v89
s_nop 1
v_mfma_f32_16x16x32_bf16 v[116:119],v[124:127],v[112:115],v[116:119]
ds_read_b128 v[112:115],v18 offset:19456
s_waitcnt lgkmcnt(1)
v_and_b32 v124,v12,v90
v_and_b32 v125,v13,v90
v_and_b32 v126,v14,v90
v_and_b32 v127,v15,v90
s_nop 1
v_mfma_f32_16x16x32_bf16 v[116:119],v[124:127],v[108:111],v[116:119]
ds_read_b128 v[108:111],v18 offset:20480
s_waitcnt lgkmcnt(1)
v_and_b32 v124,v12,v91
v_and_b32 v125,v13,v91
v_and_b32 v126,v14,v91
v_and_b32 v127,v15,v91
s_nop 1
v_mfma_f32_16x16x32_bf16 v[116:119],v[124:127],v[112:115],v[116:119]
ds_read_b128 v[112:115],v18 offset:21504
s_waitcnt lgkmcnt(1)
v_and_b32 v124,v12,v92
v_and_b32 v125,v13,v92
v_and_b32 v126,v14,v92
v_and_b32 v127,v15,v92
s_nop 1
v_mfma_f32_16x16x32_bf16 v[116:119],v[124:127],v[108:111],v[116:119]
ds_read_b128 v[108:111],v18 offset:22528
s_waitcnt lgkmcnt(1)
v_and_b32 v124,v12,v93
v_and_b32 v125,v13,v93
v_and_b32 v126,v14,v93
v_and_b32 v127,v15,v93
s_nop 1
v_mfma_f32_16x16x32_bf16 v[116:119],v[124:127],v[112:115],v[116:119]
ds_read_b128 v[112:115],v18 offset:23552
s_waitcnt lgkmcnt(1)
v_and_b32 v124,v12,v94
v_and_b32 v125,v13,v94
v_and_b32 v126,v14,v94
v_and_b32 v127,v15,v94
s_nop 1
v_mfma_f32_16x16x32_bf16 v[116:119],v[124:127],v[108:111],v[116:119]
ds_read_b128 v[108:111],v18 offset:24576
s_waitcnt lgkmcnt(1)
v_and_b32 v124,v12,v95
v_and_b32 v125,v13,v95
v_and_b32 v126,v14,v95
v_and_b32 v127,v15,v95
s_nop 1
v_mfma_f32_16x16x32_bf16 v[116:119],v[124:127],v[112:115],v[116:119]
ds_read_b128 v[88:91],v8 offset:96
ds_read_b128 v[92:95],v8 offset:112
ds_read_b128 v[112:115],v18 offset:25600
s_waitcnt lgkmcnt(1)
v_and_b32 v124,v12,v88
v_and_b32 v125,v13,v88
v_and_b32 v126,v14,v88
v_and_b32 v127,v15,v88
s_nop 1
v_mfma_f32_16x16x32_bf16 v[116:119],v[124:127],v[108:111],v[116:119]
ds_read_b128 v[108:111],v18 offset:26624
s_waitcnt lgkmcnt(1)
v_and_b32 v124,v12,v89
v_and_b32 v125,v13,v89
v_and_b32 v126,v14,v89
v_and_b32 v127,v15,v89
s_nop 1
v_mfma_f32_16x16x32_bf16 v[116:119],v[124:127],v[112:115],v[116:119]
ds_read_b128 v[112:115],v18 offset:27648
s_waitcnt lgkmcnt(1)
v_and_b32 v124,v12,v90
v_and_b32 v125,v13,v90
v_and_b32 v126,v14,v90
v_and_b32 v127,v15,v90
s_nop 1
v_mfma_f32_16x16x32_bf16 v[116:119],v[124:127],v[108:111],v[116:119]
ds_read_b128 v[108:111],v18 offset:28672
s_waitcnt lgkmcnt(1)
v_and_b32 v124,v12,v91
v_and_b32 v125,v13,v91
v_and_b32 v126,v14,v91
v_and_b32 v127,v15,v91
s_nop 1
v_mfma_f32_16x16x32_bf16 v[116:119],v[124:127],v[112:115],v[116:119]
ds_read_b128 v[112:115],v18 offset:29696
s_waitcnt lgkmcnt(1)
v_and_b32 v124,v12,v92
v_and_b32 v125,v13,v92
v_and_b32 v126,v14,v92
v_and_b32 v127,v15,v92
s_nop 1
v_mfma_f32_16x16x32_bf16 v[116:119],v[124:127],v[108:111],v[116:119]
ds_read_b128 v[108:111],v18 offset:30720
s_waitcnt lgkmcnt(1)
v_and_b32 v124,v12,v93
v_and_b32 v125,v13,v93
v_and_b32 v126,v14,v93
v_and_b32 v127,v15,v93
s_nop 1
v_mfma_f32_16x16x32_bf16 v[116:119],v[124:127],v[112:115],v[116:119]
ds_read_b128 v[112:115],v18 offset:31744
s_waitcnt lgkmcnt(1)
v_and_b32 v124,v12,v94
v_and_b32 v125,v13,v94
v_and_b32 v126,v14,v94
v_and_b32 v127,v15,v94
s_nop 1
v_mfma_f32_16x16x32_bf16 v[116:119],v[124:127],v[108:111],v[116:119]
s_waitcnt lgkmcnt(0)
v_and_b32 v124,v12,v95
v_and_b32 v125,v13,v95
v_and_b32 v126,v14,v95
v_and_b32 v127,v15,v95
s_nop 1
v_mfma_f32_16x16x32_bf16 v[116:119],v[124:127],v[112:115],v[116:119]
v_lshlrev_b32 v8,5,v9
v_and_b32 v124,1,v10
v_lshl_add_u32 v8,v124,4,v8
v_lshrrev_b32 v124,1,v10
v_lshl_add_u32 v8,v124,11,v8
s_lshl_b32 s60,s46,9
s_add_u32 s60,s60,147456
v_add_u32 v8,s60,v8
ds_write_b128 v8,v[116:119]
v_lshlrev_b32 v8,2,v1
v_add_u32 v8,147456,v8
s_waitcnt lgkmcnt(0)
s_barrier
ds_read2st64_b32 v[88:89],v8 offset0:0 offset1:1
ds_read2st64_b32 v[90:91],v8 offset0:2 offset1:3
ds_read2st64_b32 v[92:93],v8 offset0:4 offset1:5
ds_read2st64_b32 v[94:95],v8 offset0:6 offset1:7
s_waitcnt lgkmcnt(0)
v_pk_add_f32 v[88:89],v[88:89],v[90:91]
v_pk_add_f32 v[92:93],v[92:93],v[94:95]
v_pk_add_f32 v[88:89],v[88:89],v[92:93]
v_cvt_pk_bf16_f32 v88,v88,v88
v_and_b32 v88,0xffff0000,v88
v_cvt_pk_bf16_f32 v89,v89,v89
v_and_b32 v89,0xffff0000,v89
v_mul_f32 v90,0xbfb8aa3b,v88
v_exp_f32 v90,v90
s_nop 0
v_add_f32 v90,1.0,v90
v_rcp_f32 v90,v90
s_nop 0
v_mul_f32 v88,v88,v90
v_cvt_pk_bf16_f32 v88,v88,v88
v_and_b32 v88,0xffff0000,v88
v_mul_f32 v88,v88,v89
v_cvt_pk_bf16_f32 v88,v88,v88
v_lshlrev_b32 v8,2,v1
v_add_u32 v8,s58,v8
ds_write_b32 v8,v88
v_lshlrev_b32 v8,6,v10
v_add_u32 v8,s58,v8
s_waitcnt lgkmcnt(0)
ds_read_b128 v[88:91],v8
ds_read_b128 v[92:95],v8 offset:16
ds_read_b128 v[108:111],v8 offset:32
ds_read_b128 v[112:115],v8 offset:48
s_waitcnt vmcnt(0) lgkmcnt(0)
v_and_b32 v124,v12,v88
v_and_b32 v125,v13,v88
v_and_b32 v126,v14,v88
v_and_b32 v127,v15,v88
s_nop 1
v_mfma_f32_16x16x32_bf16 v[116:119],v[124:127],v[24:27],0
v_and_b32 v124,v12,v89
v_and_b32 v125,v13,v89
v_and_b32 v126,v14,v89
v_and_b32 v127,v15,v89
s_nop 1
v_mfma_f32_16x16x32_bf16 v[116:119],v[124:127],v[28:31],v[116:119]
v_and_b32 v124,v12,v90
v_and_b32 v125,v13,v90
v_and_b32 v126,v14,v90
v_and_b32 v127,v15,v90
s_nop 1
v_mfma_f32_16x16x32_bf16 v[116:119],v[124:127],v[32:35],v[116:119]
v_and_b32 v124,v12,v91
v_and_b32 v125,v13,v91
v_and_b32 v126,v14,v91
v_and_b32 v127,v15,v91
s_nop 1
v_mfma_f32_16x16x32_bf16 v[116:119],v[124:127],v[36:39],v[116:119]
v_and_b32 v124,v12,v92
v_and_b32 v125,v13,v92
v_and_b32 v126,v14,v92
v_and_b32 v127,v15,v92
s_nop 1
v_mfma_f32_16x16x32_bf16 v[116:119],v[124:127],v[40:43],v[116:119]
v_and_b32 v124,v12,v93
v_and_b32 v125,v13,v93
v_and_b32 v126,v14,v93
v_and_b32 v127,v15,v93
s_nop 1
v_mfma_f32_16x16x32_bf16 v[116:119],v[124:127],v[44:47],v[116:119]
v_and_b32 v124,v12,v94
v_and_b32 v125,v13,v94
v_and_b32 v126,v14,v94
v_and_b32 v127,v15,v94
s_nop 1
v_mfma_f32_16x16x32_bf16 v[116:119],v[124:127],v[48:51],v[116:119]
v_and_b32 v124,v12,v95
v_and_b32 v125,v13,v95
v_and_b32 v126,v14,v95
v_and_b32 v127,v15,v95
s_nop 1
v_mfma_f32_16x16x32_bf16 v[116:119],v[124:127],v[52:55],v[116:119]
v_and_b32 v124,v12,v108
v_and_b32 v125,v13,v108
v_and_b32 v126,v14,v108
v_and_b32 v127,v15,v108
s_nop 1
v_mfma_f32_16x16x32_bf16 v[116:119],v[124:127],v[56:59],v[116:119]
v_and_b32 v124,v12,v109
v_and_b32 v125,v13,v109
v_and_b32 v126,v14,v109
v_and_b32 v127,v15,v109
s_nop 1
v_mfma_f32_16x16x32_bf16 v[116:119],v[124:127],v[60:63],v[116:119]
v_and_b32 v124,v12,v110
v_and_b32 v125,v13,v110
v_and_b32 v126,v14,v110
v_and_b32 v127,v15,v110
s_nop 1
v_mfma_f32_16x16x32_bf16 v[116:119],v[124:127],v[64:67],v[116:119]
v_and_b32 v124,v12,v111
v_and_b32 v125,v13,v111
v_and_b32 v126,v14,v111
v_and_b32 v127,v15,v111
s_nop 1
v_mfma_f32_16x16x32_bf16 v[116:119],v[124:127],v[68:71],v[116:119]
v_and_b32 v124,v12,v112
v_and_b32 v125,v13,v112
v_and_b32 v126,v14,v112
v_and_b32 v127,v15,v112
s_nop 1
v_mfma_f32_16x16x32_bf16 v[116:119],v[124:127],v[72:75],v[116:119]
v_and_b32 v124,v12,v113
v_and_b32 v125,v13,v113
v_and_b32 v126,v14,v113
v_and_b32 v127,v15,v113
s_nop 1
v_mfma_f32_16x16x32_bf16 v[116:119],v[124:127],v[76:79],v[116:119]
v_and_b32 v124,v12,v114
v_and_b32 v125,v13,v114
v_and_b32 v126,v14,v114
v_and_b32 v127,v15,v114
s_nop 1
v_mfma_f32_16x16x32_bf16 v[116:119],v[124:127],v[80:83],v[116:119]
v_and_b32 v124,v12,v115
v_and_b32 v125,v13,v115
v_and_b32 v126,v14,v115
v_and_b32 v127,v15,v115
s_nop 1
v_mfma_f32_16x16x32_bf16 v[116:119],v[124:127],v[84:87],v[116:119]
v_lshlrev_b32 v8,4,v9
v_and_b32 v124,1,v10
v_lshl_add_u32 v8,v124,3,v8
v_and_b32 v124,2,v10
v_lshl_add_u32 v8,v124,30,v8
s_lshl_b32 s65,s51,15
s_add_u32 s65,s65,92274688
s_lshl_b32 s59,s47,10
s_lshl_b32 s60,s46,8
s_add_u32 s59,s59,s60
s_add_u32 s59,s59,s65
v_cvt_pk_bf16_f32 v24,v116,v117
v_cvt_pk_bf16_f32 v25,v118,v119
buffer_store_dwordx2 v[24:25],v8,s[8:11],s59 offen
s_lshl_b32 s59,s51,13
s_lshl2_add_u32 s59,s47,s59
s_add_u32 s59,s59,10486912
s_waitcnt vmcnt(0)
s_barrier
s_or_b32 s59,s59,s52
buffer_store_dword v17,off,s[8:11],s59
s_cmp_lg_u32 s47,0
s_cbranch_scc1 L_moed_33
s_lshl_b32 s59,s51,13
s_add_u32 s59,s59,10486912
v_and_b32 v124,31,v1
v_lshlrev_b32 v124,2,v124
L_fw_34:
buffer_load_dword v125,v124,s[8:11],s59 offen sc1
s_sub_u32 s49,s49,1
s_cbranch_scc1 L_abort
s_waitcnt vmcnt(0)
v_cmp_eq_u32 vcc,0,v125
s_cbranch_vccnz L_fw_34
s_add_u32 s63,s65,0
buffer_load_dwordx4 v[24:27],v22,s[8:11],s63 offen sc1
s_add_u32 s63,s65,4096
buffer_load_dwordx4 v[28:31],v22,s[8:11],s63 offen sc1
s_add_u32 s63,s65,8192
buffer_load_dwordx4 v[32:35],v22,s[8:11],s63 offen sc1
s_add_u32 s63,s65,12288
buffer_load_dwordx4 v[36:39],v22,s[8:11],s63 offen sc1
s_add_u32 s63,s65,16384
buffer_load_dwordx4 v[40:43],v22,s[8:11],s63 offen sc1
s_add_u32 s63,s65,20480
buffer_load_dwordx4 v[44:47],v22,s[8:11],s63 offen sc1
s_add_u32 s63,s65,24576
buffer_load_dwordx4 v[48:51],v22,s[8:11],s63 offen sc1
s_add_u32 s63,s65,28672
buffer_load_dwordx4 v[52:55],v22,s[8:11],s63 offen sc1
v_and_b32 v64,15,v1
v_and_b32 v65,1,v1
v_lshlrev_b32 v65,4,v65
v_mov_b32 v66,0x3f80
v_lshlrev_b32 v66,v65,v66
v_lshrrev_b32 v64,1,v64
v_cmp_eq_u32 vcc,0,v64
s_nop 1
v_cndmask_b32 v56,0,v66,vcc
v_cmp_eq_u32 vcc,1,v64
s_nop 1
v_cndmask_b32 v57,0,v66,vcc
v_cmp_eq_u32 vcc,2,v64
s_nop 1
v_cndmask_b32 v58,0,v66,vcc
v_cmp_eq_u32 vcc,3,v64
s_nop 1
v_cndmask_b32 v59,0,v66,vcc
s_waitcnt vmcnt(7)
s_nop 0
v_mfma_f32_16x16x32_bf16 v[60:63],v[56:59],v[24:27],0
s_waitcnt vmcnt(6)
v_mfma_f32_16x16x32_bf16 v[60:63],v[56:59],v[28:31],v[60:63]
s_waitcnt vmcnt(5)
v_mfma_f32_16x16x32_bf16 v[60:63],v[56:59],v[32:35],v[60:63]
s_waitcnt vmcnt(4)
v_mfma_f32_16x16x32_bf16 v[60:63],v[56:59],v[36:39],v[60:63]
s_waitcnt vmcnt(3)
v_mfma_f32_16x16x32_bf16 v[60:63],v[56:59],v[40:43],v[60:63]
s_waitcnt vmcnt(2)
v_mfma_f32_16x16x32_bf16 v[60:63],v[56:59],v[44:47],v[60:63]
s_waitcnt vmcnt(1)
v_mfma_f32_16x16x32_bf16 v[60:63],v[56:59],v[48:51],v[60:63]
s_waitcnt vmcnt(0)
v_mfma_f32_16x16x32_bf16 v[60:63],v[56:59],v[52:55],v[60:63]
s_nop 7
ds_write_b128 v21,v[60:63]
s_waitcnt lgkmcnt(0)
s_barrier
s_cmp_lg_u32 s46,0
s_cbranch_scc1 L_moed_33
v_lshlrev_b32 v56,5,v1
v_add_u32 v56,155648,v56
ds_read_b128 v[24:27],v56
ds_read_b128 v[28:31],v56 offset:16
s_and_b32 s59,s55,0xffff0000
s_xor_b32 s60,s59,0x80000000
s_xor_b32 s61,s59,0xffff0000
s_cmp_lt_i32 s59,0
s_cselect_b32 s59,s60,s61
v_mov_b32 v56,s59
v_mul_f32 v56,0xbfb8aa3b,v56
v_exp_f32 v56,v56
s_nop 0
v_add_f32 v56,1.0,v56
v_rcp_f32 v56,v56
s_nop 0
v_cvt_pk_bf16_f32 v56,v56,v56
v_and_b32 v56,0xffff0000,v56
v_lshlrev_b32 v48,16,v104
v_and_b32 v49,0xffff0000,v104
v_lshlrev_b32 v50,16,v105
v_and_b32 v51,0xffff0000,v105
v_lshlrev_b32 v52,16,v106
v_and_b32 v53,0xffff0000,v106
v_lshlrev_b32 v54,16,v107
v_and_b32 v55,0xffff0000,v107
s_waitcnt lgkmcnt(0)
v_cvt_pk_bf16_f32 v40,v24,v25
v_cvt_pk_bf16_f32 v41,v26,v27
v_cvt_pk_bf16_f32 v42,v28,v29
v_cvt_pk_bf16_f32 v43,v30,v31
v_lshlrev_b32 v24,16,v40
v_and_b32 v25,0xffff0000,v40
v_lshlrev_b32 v26,16,v41
v_and_b32 v27,0xffff0000,v41
v_lshlrev_b32 v28,16,v42
v_and_b32 v29,0xffff0000,v42
v_lshlrev_b32 v30,16,v43
v_and_b32 v31,0xffff0000,v43
v_mul_f32 v24,v24,v56
v_mul_f32 v25,v25,v56
v_mul_f32 v26,v26,v56
v_mul_f32 v27,v27,v56
v_mul_f32 v28,v28,v56
v_mul_f32 v29,v29,v56
v_mul_f32 v30,v30,v56
v_mul_f32 v31,v31,v56
v_cvt_pk_bf16_f32 v40,v24,v25
v_cvt_pk_bf16_f32 v41,v26,v27
v_cvt_pk_bf16_f32 v42,v28,v29
v_cvt_pk_bf16_f32 v43,v30,v31
v_lshlrev_b32 v24,16,v40
v_and_b32 v25,0xffff0000,v40
v_lshlrev_b32 v26,16,v41
v_and_b32 v27,0xffff0000,v41
v_lshlrev_b32 v28,16,v42
v_and_b32 v29,0xffff0000,v42
v_lshlrev_b32 v30,16,v43
v_and_b32 v31,0xffff0000,v43
v_add_f32 v24,v24,v48
v_add_f32 v25,v25,v49
v_add_f32 v26,v26,v50
v_add_f32 v27,v27,v51
v_add_f32 v28,v28,v52
v_add_f32 v29,v29,v53
v_add_f32 v30,v30,v54
v_add_f32 v31,v31,v55
v_cvt_pk_bf16_f32 v40,v24,v25
v_cvt_pk_bf16_f32 v41,v26,v27
v_cvt_pk_bf16_f32 v42,v28,v29
v_cvt_pk_bf16_f32 v43,v30,v31
v_lshlrev_b32 v24,16,v40
v_and_b32 v25,0xffff0000,v40
v_lshlrev_b32 v26,16,v41
v_and_b32 v27,0xffff0000,v41
v_lshlrev_b32 v28,16,v42
v_and_b32 v29,0xffff0000,v42
v_lshlrev_b32 v30,16,v43
v_and_b32 v31,0xffff0000,v43
v_add_f32 v96,v96,v24
v_add_f32 v97,v97,v25
v_add_f32 v98,v98,v26
v_add_f32 v99,v99,v27
v_add_f32 v100,v100,v28
v_add_f32 v101,v101,v29
v_add_f32 v102,v102,v30
v_add_f32 v103,v103,v31
v_cvt_pk_bf16_f32 v80,v96,v97
v_cvt_pk_bf16_f32 v81,v98,v99
v_cvt_pk_bf16_f32 v82,v100,v101
v_cvt_pk_bf16_f32 v83,v102,v103
s_mov_b32 s4,s40
s_mov_b32 s5,s41
s_mov_b32 s6,2097152
s_mov_b32 s7,0x20000
buffer_store_dwordx4 v[80:83],v0,s[4:7],s56 offen sc1
L_moed_33:
s_endpgm
L_abort:
s_endpgm
L_spread:
s_mov_b32 s3,-1
s_lshr_b32 s48,s2,5
s_and_b32 s47,s2,31
s_branch L_roles
L_ra_6:
s_mov_b32 s4,s26
s_mov_b32 s5,s27
s_mov_b32 s6,4194304
s_mov_b32 s7,0x20000
v_and_b32 v2,15,v1
v_lshlrev_b32 v2,4,v2
v_lshrrev_b32 v3,4,v1
v_lshl_add_u32 v2,v3,13,v2
s_and_b32 s56,s47,15
s_lshl_b32 s56,s56,18
s_lshl_b32 s57,s46,8
s_add_u32 s56,s56,s57
s_mov_b32 s61,0x05040100
s_mov_b32 s62,0x07060302
s_add_u32 s57,s56,0
buffer_load_dwordx4 v[24:27],v2,s[4:7],s57 offen offset:0
buffer_load_dwordx4 v[28:31],v2,s[4:7],s57 offen offset:1024
buffer_load_dwordx4 v[32:35],v2,s[4:7],s57 offen offset:2048
buffer_load_dwordx4 v[36:39],v2,s[4:7],s57 offen offset:3072
s_add_u32 s57,s56,4096
buffer_load_dwordx4 v[40:43],v2,s[4:7],s57 offen offset:0
buffer_load_dwordx4 v[44:47],v2,s[4:7],s57 offen offset:1024
buffer_load_dwordx4 v[48:51],v2,s[4:7],s57 offen offset:2048
buffer_load_dwordx4 v[52:55],v2,s[4:7],s57 offen offset:3072
s_add_u32 s57,s56,32768
buffer_load_dwordx4 v[56:59],v2,s[4:7],s57 offen offset:0
buffer_load_dwordx4 v[60:63],v2,s[4:7],s57 offen offset:1024
buffer_load_dwordx4 v[64:67],v2,s[4:7],s57 offen offset:2048
buffer_load_dwordx4 v[68:71],v2,s[4:7],s57 offen offset:3072
s_add_u32 s57,s56,36864
buffer_load_dwordx4 v[72:75],v2,s[4:7],s57 offen offset:0
buffer_load_dwordx4 v[76:79],v2,s[4:7],s57 offen offset:1024
buffer_load_dwordx4 v[80:83],v2,s[4:7],s57 offen offset:2048
buffer_load_dwordx4 v[84:87],v2,s[4:7],s57 offen offset:3072
s_add_u32 s57,s56,65536
buffer_load_dwordx4 v[88:91],v2,s[4:7],s57 offen offset:0
buffer_load_dwordx4 v[92:95],v2,s[4:7],s57 offen offset:1024
buffer_load_dwordx4 v[96:99],v2,s[4:7],s57 offen offset:2048
buffer_load_dwordx4 v[100:103],v2,s[4:7],s57 offen offset:3072
s_add_u32 s57,s56,69632
buffer_load_dwordx4 v[104:107],v2,s[4:7],s57 offen offset:0
buffer_load_dwordx4 v[108:111],v2,s[4:7],s57 offen offset:1024
buffer_load_dwordx4 v[112:115],v2,s[4:7],s57 offen offset:2048
buffer_load_dwordx4 v[116:119],v2,s[4:7],s57 offen offset:3072
s_add_u32 s57,s56,98304
buffer_load_dwordx4 v[120:123],v2,s[4:7],s57 offen offset:0
buffer_load_dwordx4 v[124:127],v2,s[4:7],s57 offen offset:1024
buffer_load_dwordx4 v[128:131],v2,s[4:7],s57 offen offset:2048
buffer_load_dwordx4 v[132:135],v2,s[4:7],s57 offen offset:3072
s_add_u32 s57,s56,102400
buffer_load_dwordx4 v[136:139],v2,s[4:7],s57 offen offset:0
buffer_load_dwordx4 v[140:143],v2,s[4:7],s57 offen offset:1024
buffer_load_dwordx4 v[144:147],v2,s[4:7],s57 offen offset:2048
buffer_load_dwordx4 v[148:151],v2,s[4:7],s57 offen offset:3072
s_add_u32 s57,s56,131072
buffer_load_dwordx4 v[152:155],v2,s[4:7],s57 offen offset:0
buffer_load_dwordx4 v[156:159],v2,s[4:7],s57 offen offset:1024
buffer_load_dwordx4 v[160:163],v2,s[4:7],s57 offen offset:2048
buffer_load_dwordx4 v[164:167],v2,s[4:7],s57 offen offset:3072
s_add_u32 s57,s56,135168
buffer_load_dwordx4 v[168:171],v2,s[4:7],s57 offen offset:0
buffer_load_dwordx4 v[172:175],v2,s[4:7],s57 offen offset:1024
buffer_load_dwordx4 v[176:179],v2,s[4:7],s57 offen offset:2048
buffer_load_dwordx4 v[180:183],v2,s[4:7],s57 offen offset:3072
s_add_u32 s57,s56,163840
buffer_load_dwordx4 v[184:187],v2,s[4:7],s57 offen offset:0
buffer_load_dwordx4 v[188:191],v2,s[4:7],s57 offen offset:1024
buffer_load_dwordx4 v[192:195],v2,s[4:7],s57 offen offset:2048
buffer_load_dwordx4 v[196:199],v2,s[4:7],s57 offen offset:3072
s_add_u32 s57,s56,167936
buffer_load_dwordx4 v[200:203],v2,s[4:7],s57 offen offset:0
buffer_load_dwordx4 v[204:207],v2,s[4:7],s57 offen offset:1024
buffer_load_dwordx4 v[208:211],v2,s[4:7],s57 offen offset:2048
buffer_load_dwordx4 v[212:215],v2,s[4:7],s57 offen offset:3072
s_waitcnt vmcnt(40)
v_perm_b32 v216,v28,v24,s61
v_perm_b32 v217,v36,v32,s61
v_perm_b32 v218,v44,v40,s61
v_perm_b32 v219,v52,v48,s61
v_accvgpr_write_b32 a0,v216
v_accvgpr_write_b32 a1,v217
v_accvgpr_write_b32 a2,v218
v_accvgpr_write_b32 a3,v219
v_perm_b32 v216,v28,v24,s62
v_perm_b32 v217,v36,v32,s62
v_perm_b32 v218,v44,v40,s62
v_perm_b32 v219,v52,v48,s62
v_accvgpr_write_b32 a4,v216
v_accvgpr_write_b32 a5,v217
v_accvgpr_write_b32 a6,v218
v_accvgpr_write_b32 a7,v219
v_perm_b32 v216,v29,v25,s61
v_perm_b32 v217,v37,v33,s61
v_perm_b32 v218,v45,v41,s61
v_perm_b32 v219,v53,v49,s61
v_accvgpr_write_b32 a8,v216
v_accvgpr_write_b32 a9,v217
v_accvgpr_write_b32 a10,v218
v_accvgpr_write_b32 a11,v219
v_perm_b32 v216,v29,v25,s62
v_perm_b32 v217,v37,v33,s62
v_perm_b32 v218,v45,v41,s62
v_perm_b32 v219,v53,v49,s62
v_accvgpr_write_b32 a12,v216
v_accvgpr_write_b32 a13,v217
v_accvgpr_write_b32 a14,v218
v_accvgpr_write_b32 a15,v219
v_perm_b32 v216,v30,v26,s61
v_perm_b32 v217,v38,v34,s61
v_perm_b32 v218,v46,v42,s61
v_perm_b32 v219,v54,v50,s61
v_accvgpr_write_b32 a16,v216
v_accvgpr_write_b32 a17,v217
v_accvgpr_write_b32 a18,v218
v_accvgpr_write_b32 a19,v219
v_perm_b32 v216,v30,v26,s62
v_perm_b32 v217,v38,v34,s62
v_perm_b32 v218,v46,v42,s62
v_perm_b32 v219,v54,v50,s62
v_accvgpr_write_b32 a20,v216
v_accvgpr_write_b32 a21,v217
v_accvgpr_write_b32 a22,v218
v_accvgpr_write_b32 a23,v219
v_perm_b32 v216,v31,v27,s61
v_perm_b32 v217,v39,v35,s61
v_perm_b32 v218,v47,v43,s61
v_perm_b32 v219,v55,v51,s61
v_accvgpr_write_b32 a24,v216
v_accvgpr_write_b32 a25,v217
v_accvgpr_write_b32 a26,v218
v_accvgpr_write_b32 a27,v219
v_perm_b32 v216,v31,v27,s62
v_perm_b32 v217,v39,v35,s62
v_perm_b32 v218,v47,v43,s62
v_perm_b32 v219,v55,v51,s62
v_accvgpr_write_b32 a28,v216
v_accvgpr_write_b32 a29,v217
v_accvgpr_write_b32 a30,v218
v_accvgpr_write_b32 a31,v219
s_add_u32 s57,s56,196608
buffer_load_dwordx4 v[24:27],v2,s[4:7],s57 offen offset:0
buffer_load_dwordx4 v[28:31],v2,s[4:7],s57 offen offset:1024
buffer_load_dwordx4 v[32:35],v2,s[4:7],s57 offen offset:2048
buffer_load_dwordx4 v[36:39],v2,s[4:7],s57 offen offset:3072
s_add_u32 s57,s56,200704
buffer_load_dwordx4 v[40:43],v2,s[4:7],s57 offen offset:0
buffer_load_dwordx4 v[44:47],v2,s[4:7],s57 offen offset:1024
buffer_load_dwordx4 v[48:51],v2,s[4:7],s57 offen offset:2048
buffer_load_dwordx4 v[52:55],v2,s[4:7],s57 offen offset:3072
s_waitcnt vmcnt(40)
v_perm_b32 v216,v60,v56,s61
v_perm_b32 v217,v68,v64,s61
v_perm_b32 v218,v76,v72,s61
v_perm_b32 v219,v84,v80,s61
v_accvgpr_write_b32 a32,v216
v_accvgpr_write_b32 a33,v217
v_accvgpr_write_b32 a34,v218
v_accvgpr_write_b32 a35,v219
v_perm_b32 v216,v60,v56,s62
v_perm_b32 v217,v68,v64,s62
v_perm_b32 v218,v76,v72,s62
v_perm_b32 v219,v84,v80,s62
v_accvgpr_write_b32 a36,v216
v_accvgpr_write_b32 a37,v217
v_accvgpr_write_b32 a38,v218
v_accvgpr_write_b32 a39,v219
v_perm_b32 v216,v61,v57,s61
v_perm_b32 v217,v69,v65,s61
v_perm_b32 v218,v77,v73,s61
v_perm_b32 v219,v85,v81,s61
v_accvgpr_write_b32 a40,v216
v_accvgpr_write_b32 a41,v217
v_accvgpr_write_b32 a42,v218
v_accvgpr_write_b32 a43,v219
v_perm_b32 v216,v61,v57,s62
v_perm_b32 v217,v69,v65,s62
v_perm_b32 v218,v77,v73,s62
v_perm_b32 v219,v85,v81,s62
v_accvgpr_write_b32 a44,v216
v_accvgpr_write_b32 a45,v217
v_accvgpr_write_b32 a46,v218
v_accvgpr_write_b32 a47,v219
v_perm_b32 v216,v62,v58,s61
v_perm_b32 v217,v70,v66,s61
v_perm_b32 v218,v78,v74,s61
v_perm_b32 v219,v86,v82,s61
v_accvgpr_write_b32 a48,v216
v_accvgpr_write_b32 a49,v217
v_accvgpr_write_b32 a50,v218
v_accvgpr_write_b32 a51,v219
v_perm_b32 v216,v62,v58,s62
v_perm_b32 v217,v70,v66,s62
v_perm_b32 v218,v78,v74,s62
v_perm_b32 v219,v86,v82,s62
v_accvgpr_write_b32 a52,v216
v_accvgpr_write_b32 a53,v217
v_accvgpr_write_b32 a54,v218
v_accvgpr_write_b32 a55,v219
v_perm_b32 v216,v63,v59,s61
v_perm_b32 v217,v71,v67,s61
v_perm_b32 v218,v79,v75,s61
v_perm_b32 v219,v87,v83,s61
v_accvgpr_write_b32 a56,v216
v_accvgpr_write_b32 a57,v217
v_accvgpr_write_b32 a58,v218
v_accvgpr_write_b32 a59,v219
v_perm_b32 v216,v63,v59,s62
v_perm_b32 v217,v71,v67,s62
v_perm_b32 v218,v79,v75,s62
v_perm_b32 v219,v87,v83,s62
v_accvgpr_write_b32 a60,v216
v_accvgpr_write_b32 a61,v217
v_accvgpr_write_b32 a62,v218
v_accvgpr_write_b32 a63,v219
s_add_u32 s57,s56,229376
buffer_load_dwordx4 v[56:59],v2,s[4:7],s57 offen offset:0
buffer_load_dwordx4 v[60:63],v2,s[4:7],s57 offen offset:1024
buffer_load_dwordx4 v[64:67],v2,s[4:7],s57 offen offset:2048
buffer_load_dwordx4 v[68:71],v2,s[4:7],s57 offen offset:3072
s_add_u32 s57,s56,233472
buffer_load_dwordx4 v[72:75],v2,s[4:7],s57 offen offset:0
buffer_load_dwordx4 v[76:79],v2,s[4:7],s57 offen offset:1024
buffer_load_dwordx4 v[80:83],v2,s[4:7],s57 offen offset:2048
buffer_load_dwordx4 v[84:87],v2,s[4:7],s57 offen offset:3072
s_waitcnt vmcnt(40)
v_perm_b32 v216,v92,v88,s61
v_perm_b32 v217,v100,v96,s61
v_perm_b32 v218,v108,v104,s61
v_perm_b32 v219,v116,v112,s61
v_accvgpr_write_b32 a64,v216
v_accvgpr_write_b32 a65,v217
v_accvgpr_write_b32 a66,v218
v_accvgpr_write_b32 a67,v219
v_perm_b32 v216,v92,v88,s62
v_perm_b32 v217,v100,v96,s62
v_perm_b32 v218,v108,v104,s62
v_perm_b32 v219,v116,v112,s62
v_accvgpr_write_b32 a68,v216
v_accvgpr_write_b32 a69,v217
v_accvgpr_write_b32 a70,v218
v_accvgpr_write_b32 a71,v219
v_perm_b32 v216,v93,v89,s61
v_perm_b32 v217,v101,v97,s61
v_perm_b32 v218,v109,v105,s61
v_perm_b32 v219,v117,v113,s61
v_accvgpr_write_b32 a72,v216
v_accvgpr_write_b32 a73,v217
v_accvgpr_write_b32 a74,v218
v_accvgpr_write_b32 a75,v219
v_perm_b32 v216,v93,v89,s62
v_perm_b32 v217,v101,v97,s62
v_perm_b32 v218,v109,v105,s62
v_perm_b32 v219,v117,v113,s62
v_accvgpr_write_b32 a76,v216
v_accvgpr_write_b32 a77,v217
v_accvgpr_write_b32 a78,v218
v_accvgpr_write_b32 a79,v219
v_perm_b32 v216,v94,v90,s61
v_perm_b32 v217,v102,v98,s61
v_perm_b32 v218,v110,v106,s61
v_perm_b32 v219,v118,v114,s61
v_accvgpr_write_b32 a80,v216
v_accvgpr_write_b32 a81,v217
v_accvgpr_write_b32 a82,v218
v_accvgpr_write_b32 a83,v219
v_perm_b32 v216,v94,v90,s62
v_perm_b32 v217,v102,v98,s62
v_perm_b32 v218,v110,v106,s62
v_perm_b32 v219,v118,v114,s62
v_accvgpr_write_b32 a84,v216
v_accvgpr_write_b32 a85,v217
v_accvgpr_write_b32 a86,v218
v_accvgpr_write_b32 a87,v219
v_perm_b32 v216,v95,v91,s61
v_perm_b32 v217,v103,v99,s61
v_perm_b32 v218,v111,v107,s61
v_perm_b32 v219,v119,v115,s61
v_accvgpr_write_b32 a88,v216
v_accvgpr_write_b32 a89,v217
v_accvgpr_write_b32 a90,v218
v_accvgpr_write_b32 a91,v219
v_perm_b32 v216,v95,v91,s62
v_perm_b32 v217,v103,v99,s62
v_perm_b32 v218,v111,v107,s62
v_perm_b32 v219,v119,v115,s62
v_accvgpr_write_b32 a92,v216
v_accvgpr_write_b32 a93,v217
v_accvgpr_write_b32 a94,v218
v_accvgpr_write_b32 a95,v219
s_waitcnt vmcnt(32)
v_perm_b32 v216,v124,v120,s61
v_perm_b32 v217,v132,v128,s61
v_perm_b32 v218,v140,v136,s61
v_perm_b32 v219,v148,v144,s61
v_accvgpr_write_b32 a96,v216
v_accvgpr_write_b32 a97,v217
v_accvgpr_write_b32 a98,v218
v_accvgpr_write_b32 a99,v219
v_perm_b32 v216,v124,v120,s62
v_perm_b32 v217,v132,v128,s62
v_perm_b32 v218,v140,v136,s62
v_perm_b32 v219,v148,v144,s62
v_accvgpr_write_b32 a100,v216
v_accvgpr_write_b32 a101,v217
v_accvgpr_write_b32 a102,v218
v_accvgpr_write_b32 a103,v219
v_perm_b32 v216,v125,v121,s61
v_perm_b32 v217,v133,v129,s61
v_perm_b32 v218,v141,v137,s61
v_perm_b32 v219,v149,v145,s61
v_accvgpr_write_b32 a104,v216
v_accvgpr_write_b32 a105,v217
v_accvgpr_write_b32 a106,v218
v_accvgpr_write_b32 a107,v219
v_perm_b32 v216,v125,v121,s62
v_perm_b32 v217,v133,v129,s62
v_perm_b32 v218,v141,v137,s62
v_perm_b32 v219,v149,v145,s62
v_accvgpr_write_b32 a108,v216
v_accvgpr_write_b32 a109,v217
v_accvgpr_write_b32 a110,v218
v_accvgpr_write_b32 a111,v219
v_perm_b32 v216,v126,v122,s61
v_perm_b32 v217,v134,v130,s61
v_perm_b32 v218,v142,v138,s61
v_perm_b32 v219,v150,v146,s61
v_accvgpr_write_b32 a112,v216
v_accvgpr_write_b32 a113,v217
v_accvgpr_write_b32 a114,v218
v_accvgpr_write_b32 a115,v219
v_perm_b32 v216,v126,v122,s62
v_perm_b32 v217,v134,v130,s62
v_perm_b32 v218,v142,v138,s62
v_perm_b32 v219,v150,v146,s62
v_accvgpr_write_b32 a116,v216
v_accvgpr_write_b32 a117,v217
v_accvgpr_write_b32 a118,v218
v_accvgpr_write_b32 a119,v219
v_perm_b32 v216,v127,v123,s61
v_perm_b32 v217,v135,v131,s61
v_perm_b32 v218,v143,v139,s61
v_perm_b32 v219,v151,v147,s61
v_accvgpr_write_b32 a120,v216
v_accvgpr_write_b32 a121,v217
v_accvgpr_write_b32 a122,v218
v_accvgpr_write_b32 a123,v219
v_perm_b32 v216,v127,v123,s62
v_perm_b32 v217,v135,v131,s62
v_perm_b32 v218,v143,v139,s62
v_perm_b32 v219,v151,v147,s62
v_accvgpr_write_b32 a124,v216
v_accvgpr_write_b32 a125,v217
v_accvgpr_write_b32 a126,v218
v_accvgpr_write_b32 a127,v219
s_waitcnt vmcnt(24)
v_perm_b32 v216,v156,v152,s61
v_perm_b32 v217,v164,v160,s61
v_perm_b32 v218,v172,v168,s61
v_perm_b32 v219,v180,v176,s61
v_accvgpr_write_b32 a128,v216
v_accvgpr_write_b32 a129,v217
v_accvgpr_write_b32 a130,v218
v_accvgpr_write_b32 a131,v219
v_perm_b32 v216,v156,v152,s62
v_perm_b32 v217,v164,v160,s62
v_perm_b32 v218,v172,v168,s62
v_perm_b32 v219,v180,v176,s62
v_accvgpr_write_b32 a132,v216
v_accvgpr_write_b32 a133,v217
v_accvgpr_write_b32 a134,v218
v_accvgpr_write_b32 a135,v219
v_perm_b32 v216,v157,v153,s61
v_perm_b32 v217,v165,v161,s61
v_perm_b32 v218,v173,v169,s61
v_perm_b32 v219,v181,v177,s61
v_accvgpr_write_b32 a136,v216
v_accvgpr_write_b32 a137,v217
v_accvgpr_write_b32 a138,v218
v_accvgpr_write_b32 a139,v219
v_perm_b32 v216,v157,v153,s62
v_perm_b32 v217,v165,v161,s62
v_perm_b32 v218,v173,v169,s62
v_perm_b32 v219,v181,v177,s62
v_accvgpr_write_b32 a140,v216
v_accvgpr_write_b32 a141,v217
v_accvgpr_write_b32 a142,v218
v_accvgpr_write_b32 a143,v219
v_perm_b32 v216,v158,v154,s61
v_perm_b32 v217,v166,v162,s61
v_perm_b32 v218,v174,v170,s61
v_perm_b32 v219,v182,v178,s61
v_accvgpr_write_b32 a144,v216
v_accvgpr_write_b32 a145,v217
v_accvgpr_write_b32 a146,v218
v_accvgpr_write_b32 a147,v219
v_perm_b32 v216,v158,v154,s62
v_perm_b32 v217,v166,v162,s62
v_perm_b32 v218,v174,v170,s62
v_perm_b32 v219,v182,v178,s62
v_accvgpr_write_b32 a148,v216
v_accvgpr_write_b32 a149,v217
v_accvgpr_write_b32 a150,v218
v_accvgpr_write_b32 a151,v219
v_perm_b32 v216,v159,v155,s61
v_perm_b32 v217,v167,v163,s61
v_perm_b32 v218,v175,v171,s61
v_perm_b32 v219,v183,v179,s61
v_accvgpr_write_b32 a152,v216
v_accvgpr_write_b32 a153,v217
v_accvgpr_write_b32 a154,v218
v_accvgpr_write_b32 a155,v219
v_perm_b32 v216,v159,v155,s62
v_perm_b32 v217,v167,v163,s62
v_perm_b32 v218,v175,v171,s62
v_perm_b32 v219,v183,v179,s62
v_accvgpr_write_b32 a156,v216
v_accvgpr_write_b32 a157,v217
v_accvgpr_write_b32 a158,v218
v_accvgpr_write_b32 a159,v219
s_waitcnt vmcnt(16)
v_perm_b32 v216,v188,v184,s61
v_perm_b32 v217,v196,v192,s61
v_perm_b32 v218,v204,v200,s61
v_perm_b32 v219,v212,v208,s61
v_accvgpr_write_b32 a160,v216
v_accvgpr_write_b32 a161,v217
v_accvgpr_write_b32 a162,v218
v_accvgpr_write_b32 a163,v219
v_perm_b32 v216,v188,v184,s62
v_perm_b32 v217,v196,v192,s62
v_perm_b32 v218,v204,v200,s62
v_perm_b32 v219,v212,v208,s62
v_accvgpr_write_b32 a164,v216
v_accvgpr_write_b32 a165,v217
v_accvgpr_write_b32 a166,v218
v_accvgpr_write_b32 a167,v219
v_perm_b32 v216,v189,v185,s61
v_perm_b32 v217,v197,v193,s61
v_perm_b32 v218,v205,v201,s61
v_perm_b32 v219,v213,v209,s61
v_accvgpr_write_b32 a168,v216
v_accvgpr_write_b32 a169,v217
v_accvgpr_write_b32 a170,v218
v_accvgpr_write_b32 a171,v219
v_perm_b32 v216,v189,v185,s62
v_perm_b32 v217,v197,v193,s62
v_perm_b32 v218,v205,v201,s62
v_perm_b32 v219,v213,v209,s62
v_accvgpr_write_b32 a172,v216
v_accvgpr_write_b32 a173,v217
v_accvgpr_write_b32 a174,v218
v_accvgpr_write_b32 a175,v219
v_perm_b32 v216,v190,v186,s61
v_perm_b32 v217,v198,v194,s61
v_perm_b32 v218,v206,v202,s61
v_perm_b32 v219,v214,v210,s61
v_accvgpr_write_b32 a176,v216
v_accvgpr_write_b32 a177,v217
v_accvgpr_write_b32 a178,v218
v_accvgpr_write_b32 a179,v219
v_perm_b32 v216,v190,v186,s62
v_perm_b32 v217,v198,v194,s62
v_perm_b32 v218,v206,v202,s62
v_perm_b32 v219,v214,v210,s62
v_accvgpr_write_b32 a180,v216
v_accvgpr_write_b32 a181,v217
v_accvgpr_write_b32 a182,v218
v_accvgpr_write_b32 a183,v219
v_perm_b32 v216,v191,v187,s61
v_perm_b32 v217,v199,v195,s61
v_perm_b32 v218,v207,v203,s61
v_perm_b32 v219,v215,v211,s61
v_accvgpr_write_b32 a184,v216
v_accvgpr_write_b32 a185,v217
v_accvgpr_write_b32 a186,v218
v_accvgpr_write_b32 a187,v219
v_perm_b32 v216,v191,v187,s62
v_perm_b32 v217,v199,v195,s62
v_perm_b32 v218,v207,v203,s62
v_perm_b32 v219,v215,v211,s62
v_accvgpr_write_b32 a188,v216
v_accvgpr_write_b32 a189,v217
v_accvgpr_write_b32 a190,v218
v_accvgpr_write_b32 a191,v219
s_waitcnt vmcnt(8)
v_perm_b32 v216,v28,v24,s61
v_perm_b32 v217,v36,v32,s61
v_perm_b32 v218,v44,v40,s61
v_perm_b32 v219,v52,v48,s61
v_accvgpr_write_b32 a192,v216
v_accvgpr_write_b32 a193,v217
v_accvgpr_write_b32 a194,v218
v_accvgpr_write_b32 a195,v219
v_perm_b32 v216,v28,v24,s62
v_perm_b32 v217,v36,v32,s62
v_perm_b32 v218,v44,v40,s62
v_perm_b32 v219,v52,v48,s62
v_accvgpr_write_b32 a196,v216
v_accvgpr_write_b32 a197,v217
v_accvgpr_write_b32 a198,v218
v_accvgpr_write_b32 a199,v219
v_perm_b32 v216,v29,v25,s61
v_perm_b32 v217,v37,v33,s61
v_perm_b32 v218,v45,v41,s61
v_perm_b32 v219,v53,v49,s61
v_accvgpr_write_b32 a200,v216
v_accvgpr_write_b32 a201,v217
v_accvgpr_write_b32 a202,v218
v_accvgpr_write_b32 a203,v219
v_perm_b32 v216,v29,v25,s62
v_perm_b32 v217,v37,v33,s62
v_perm_b32 v218,v45,v41,s62
v_perm_b32 v219,v53,v49,s62
v_accvgpr_write_b32 a204,v216
v_accvgpr_write_b32 a205,v217
v_accvgpr_write_b32 a206,v218
v_accvgpr_write_b32 a207,v219
v_perm_b32 v216,v30,v26,s61
v_perm_b32 v217,v38,v34,s61
v_perm_b32 v218,v46,v42,s61
v_perm_b32 v219,v54,v50,s61
v_accvgpr_write_b32 a208,v216
v_accvgpr_write_b32 a209,v217
v_accvgpr_write_b32 a210,v218
v_accvgpr_write_b32 a211,v219
v_perm_b32 v216,v30,v26,s62
v_perm_b32 v217,v38,v34,s62
v_perm_b32 v218,v46,v42,s62
v_perm_b32 v219,v54,v50,s62
v_accvgpr_write_b32 a212,v216
v_accvgpr_write_b32 a213,v217
v_accvgpr_write_b32 a214,v218
v_accvgpr_write_b32 a215,v219
v_perm_b32 v216,v31,v27,s61
v_perm_b32 v217,v39,v35,s61
v_perm_b32 v218,v47,v43,s61
v_perm_b32 v219,v55,v51,s61
v_accvgpr_write_b32 a216,v216
v_accvgpr_write_b32 a217,v217
v_accvgpr_write_b32 a218,v218
v_accvgpr_write_b32 a219,v219
v_perm_b32 v216,v31,v27,s62
v_perm_b32 v217,v39,v35,s62
v_perm_b32 v218,v47,v43,s62
v_perm_b32 v219,v55,v51,s62
v_accvgpr_write_b32 a220,v216
v_accvgpr_write_b32 a221,v217
v_accvgpr_write_b32 a222,v218
v_accvgpr_write_b32 a223,v219
s_waitcnt vmcnt(0)
v_perm_b32 v216,v60,v56,s61
v_perm_b32 v217,v68,v64,s61
v_perm_b32 v218,v76,v72,s61
v_perm_b32 v219,v84,v80,s61
v_accvgpr_write_b32 a224,v216
v_accvgpr_write_b32 a225,v217
v_accvgpr_write_b32 a226,v218
v_accvgpr_write_b32 a227,v219
v_perm_b32 v216,v60,v56,s62
v_perm_b32 v217,v68,v64,s62
v_perm_b32 v218,v76,v72,s62
v_perm_b32 v219,v84,v80,s62
v_accvgpr_write_b32 a228,v216
v_accvgpr_write_b32 a229,v217
v_accvgpr_write_b32 a230,v218
v_accvgpr_write_b32 a231,v219
v_perm_b32 v216,v61,v57,s61
v_perm_b32 v217,v69,v65,s61
v_perm_b32 v218,v77,v73,s61
v_perm_b32 v219,v85,v81,s61
v_accvgpr_write_b32 a232,v216
v_accvgpr_write_b32 a233,v217
v_accvgpr_write_b32 a234,v218
v_accvgpr_write_b32 a235,v219
v_perm_b32 v216,v61,v57,s62
v_perm_b32 v217,v69,v65,s62
v_perm_b32 v218,v77,v73,s62
v_perm_b32 v219,v85,v81,s62
v_accvgpr_write_b32 a236,v216
v_accvgpr_write_b32 a237,v217
v_accvgpr_write_b32 a238,v218
v_accvgpr_write_b32 a239,v219
v_perm_b32 v216,v62,v58,s61
v_perm_b32 v217,v70,v66,s61
v_perm_b32 v218,v78,v74,s61
v_perm_b32 v219,v86,v82,s61
v_accvgpr_write_b32 a240,v216
v_accvgpr_write_b32 a241,v217
v_accvgpr_write_b32 a242,v218
v_accvgpr_write_b32 a243,v219
v_perm_b32 v216,v62,v58,s62
v_perm_b32 v217,v70,v66,s62
v_perm_b32 v218,v78,v74,s62
v_perm_b32 v219,v86,v82,s62
v_accvgpr_write_b32 a244,v216
v_accvgpr_write_b32 a245,v217
v_accvgpr_write_b32 a246,v218
v_accvgpr_write_b32 a247,v219
v_perm_b32 v216,v63,v59,s61
v_perm_b32 v217,v71,v67,s61
v_perm_b32 v218,v79,v75,s61
v_perm_b32 v219,v87,v83,s61
v_accvgpr_write_b32 a248,v216
v_accvgpr_write_b32 a249,v217
v_accvgpr_write_b32 a250,v218
v_accvgpr_write_b32 a251,v219
v_perm_b32 v216,v63,v59,s62
v_perm_b32 v217,v71,v67,s62
v_perm_b32 v218,v79,v75,s62
v_perm_b32 v219,v87,v83,s62
v_accvgpr_write_b32 a252,v216
v_accvgpr_write_b32 a253,v217
v_accvgpr_write_b32 a254,v218
v_accvgpr_write_b32 a255,v219
v_mov_b32 v123,159744
s_cmp_lg_u32 s46,0
s_cbranch_scc1 L_gbd_36
v_mov_b32 v124,128
L_gb_35:
buffer_load_dword v125,v124,s[12:15],0 offen sc1
s_waitcnt vmcnt(0)
v_readfirstlane_b32 s56,v125
ds_write_b32 v123,v125
s_bitcmp1_b32 s56,8
s_cbranch_scc1 L_gbd_36
s_sleep 4
s_sub_u32 s49,s49,1
s_cmp_gt_i32 s49,0
s_cbranch_scc1 L_gb_35
s_branch L_abort
L_gbd_36:
s_waitcnt lgkmcnt(0)
s_barrier
ds_read_b32 v125,v123
s_waitcnt lgkmcnt(0)
v_readfirstlane_b32 s56,v125
s_barrier
s_lshr_b32 s56,s56,16
s_andn2_b32 s56,s56,s3
s_cbranch_scc1 L_spread
s_max_u32 s54,s48,5
s_sub_u32 s54,s54,5
s_lshl_b32 s54,s54,1
s_lshr_b32 s56,s47,4
s_add_u32 s54,s54,s56
s_cmp_lg_u32 s3,0
s_cbranch_scc1 L_wa
v_and_b32 v238,15,v1
v_and_b32 v239,1,v1
v_lshlrev_b32 v239,4,v239
v_mov_b32 v240,0x3f80
v_lshlrev_b32 v240,v239,v240
v_lshrrev_b32 v238,1,v238
v_cmp_eq_u32 vcc,0,v238
s_nop 1
v_cndmask_b32 v156,0,v240,vcc
v_cmp_eq_u32 vcc,1,v238
s_nop 1
v_cndmask_b32 v157,0,v240,vcc
v_cmp_eq_u32 vcc,2,v238
s_nop 1
v_cndmask_b32 v158,0,v240,vcc
v_cmp_eq_u32 vcc,3,v238
s_nop 1
v_cndmask_b32 v159,0,v240,vcc
s_mov_b32 s4,s32
s_mov_b32 s5,s33
s_mov_b32 s6,1024
s_mov_b32 s7,0x20000
buffer_load_dwordx4 v[224:227],v0,s[4:7],0 offen
v_and_b32 v238,15,v1
v_lshrrev_b32 v239,4,v1
v_lshlrev_b32 v240,2,v239
v_mov_b32 v241,0xf149f2ca
s_and_b32 s56,s46,1
s_lshl_b32 s56,s56,4
v_add_u32 v242,s56,v238
v_add_u32 v243,0,v240
v_cmp_gt_u32 vcc,v243,v242
s_nop 1
v_cndmask_b32 v8,0,v241,vcc
v_add_u32 v243,1,v240
v_cmp_gt_u32 vcc,v243,v242
s_nop 1
v_cndmask_b32 v9,0,v241,vcc
v_add_u32 v243,2,v240
v_cmp_gt_u32 vcc,v243,v242
s_nop 1
v_cndmask_b32 v10,0,v241,vcc
v_add_u32 v243,3,v240
v_cmp_gt_u32 vcc,v243,v242
s_nop 1
v_cndmask_b32 v11,0,v241,vcc
v_add_u32 v243,16,v240
v_cmp_gt_u32 vcc,v243,v242
s_nop 1
v_cndmask_b32 v12,0,v241,vcc
v_add_u32 v243,17,v240
v_cmp_gt_u32 vcc,v243,v242
s_nop 1
v_cndmask_b32 v13,0,v241,vcc
v_add_u32 v243,18,v240
v_cmp_gt_u32 vcc,v243,v242
s_nop 1
v_cndmask_b32 v14,0,v241,vcc
v_add_u32 v243,19,v240
v_cmp_gt_u32 vcc,v243,v242
s_nop 1
v_cndmask_b32 v15,0,v241,vcc
v_mov_b64 v[152:153],s[28:29]
v_mov_b64 v[154:155],s[28:29]
v_mov_b32 v145,0
v_mov_b32 v146,0
s_lshl_b32 s56,s46,12
s_add_u32 s56,s56,131072
v_add_u32 v3,s56,v0
v_add_u32 v4,131072,v0
s_lshl_b32 s56,s46,8
v_lshlrev_b32 v7,4,v238
v_add_u32 v7,s56,v7
v_lshl_add_u32 v5,v239,16,v7
v_lshlrev_b32 v6,1,v7
v_lshl_add_u32 v7,v239,10,v7
v_and_b32 v243,1,v239
v_lshl_add_u32 v6,v243,4,v6
v_lshrrev_b32 v243,1,v239
v_lshl_add_u32 v6,v243,12,v6
v_add_u32 v6,147456,v6
v_lshlrev_b32 v16,2,v238
v_lshlrev_b32 v21,3,v238
s_and_b32 s68,s47,15
s_lshl_b32 s69,s54,19
s_add_u32 s69,s69,20971520
s_lshl_b32 s87,s54,13
s_add_u32 s87,s87,10486656
s_lshl_b32 s68,s68,1
s_lshr_b32 s56,s46,1
s_add_u32 s68,s68,s56
s_mov_b32 s66,0
s_mov_b32 s67,0
s_mov_b32 s73,0x80000000
s_mov_b32 s75,0
s_waitcnt vmcnt(0)
v_lshlrev_b32 v228,16,v224
v_and_b32 v229,0xffff0000,v224
v_lshlrev_b32 v230,16,v225
v_and_b32 v231,0xffff0000,v225
v_lshlrev_b32 v232,16,v226
v_and_b32 v233,0xffff0000,v226
v_lshlrev_b32 v234,16,v227
v_and_b32 v235,0xffff0000,v227
v_add_u32 v21,10487168,v21
v_mov_b32 v244,v21
s_and_b32 s56,s50,2048
s_add_u32 s56,s56,147456
v_lshlrev_b32 v23,5,v1
v_add_u32 v23,s56,v23
s_lshr_b32 s56,s68,1
s_lshl2_add_u32 s74,s56,s87
s_or_b32 s74,s74,s52
s_cmp_lt_u32 s54,2
s_cbranch_scc1 L_aa_37
s_sub_u32 s77,s54,2
s_mov_b32 s30,0
s_mov_b32 s86,1536
s_lshl_b32 s56,s77,5
s_add_u32 s56,s56,s68
s_mul_i32 s70,s56,24576
s_lshl_b32 s71,s56,13
s_add_u32 s70,s70,100663296
s_add_u32 s71,s71,41943040
s_lshl_b32 s59,s77,13
s_lshl2_add_u32 s59,s68,s59
s_add_u32 s59,s59,10485760
v_mov_b32 v19,s59
buffer_load_dword v18,v19,s[8:11],0 offen sc1
s_branch L_aa_46
L_aa_38:
ds_read_b128 v[24:27],v4 offset:0
ds_read_b128 v[28:31],v4 offset:1024
ds_read_b128 v[32:35],v4 offset:2048
ds_read_b128 v[36:39],v4 offset:3072
ds_read_b128 v[40:43],v4 offset:8192
ds_read_b128 v[44:47],v4 offset:9216
ds_read_b128 v[48:51],v4 offset:10240
ds_read_b128 v[52:55],v4 offset:11264
s_waitcnt lgkmcnt(7)
v_mfma_f32_16x16x32_bf16 v[160:163],v[24:27],a[0:3],0
s_add_u32 s63,s87,128
buffer_load_dword v17,v16,s[8:11],s63 offen sc1
v_mfma_f32_16x16x32_bf16 v[164:167],v[24:27],a[4:7],0
s_lshl_b32 s61,s51,5
s_add_u32 s61,s61,s68
v_mfma_f32_16x16x32_bf16 v[168:171],v[24:27],a[8:11],0
s_lshl_b32 s58,s61,10
s_add_u32 s60,s58,8388608
v_mfma_f32_16x16x32_bf16 v[172:175],v[24:27],a[12:15],0
s_lshl_b32 s59,s51,10
s_add_u32 s59,s59,11272192
v_mfma_f32_16x16x32_bf16 v[176:179],v[24:27],a[16:19],0
s_cmp_eq_u32 s61,s55
s_cselect_b32 s60,s59,s60
v_mfma_f32_16x16x32_bf16 v[180:183],v[24:27],a[20:23],0
s_cmp_eq_u32 s31,0
s_cselect_b32 s60,s58,s60
v_mfma_f32_16x16x32_bf16 v[184:187],v[24:27],a[24:27],0
s_cselect_b64 s[4:5],s[16:17],s[44:45]
s_mov_b32 s6,268435456
v_mfma_f32_16x16x32_bf16 v[188:191],v[24:27],a[28:31],0
s_cmov_b32 s6,2097152
s_mov_b32 s7,0x20000
s_waitcnt lgkmcnt(6)
v_mfma_f32_16x16x32_bf16 v[160:163],v[28:31],a[32:35],v[160:163]
buffer_load_dwordx4 v[224:227],v0,s[4:7],s60 offen sc1
v_mfma_f32_16x16x32_bf16 v[164:167],v[28:31],a[36:39],v[164:167]
s_lshl_b32 s60,s51,13
s_lshl2_add_u32 s60,s68,s60
v_mfma_f32_16x16x32_bf16 v[168:171],v[28:31],a[40:43],v[168:171]
s_add_u32 s60,s60,10487296
buffer_load_dword v246,off,s[8:11],s60 sc1
v_mfma_f32_16x16x32_bf16 v[172:175],v[28:31],a[44:47],v[172:175]
s_cmp_eq_u32 s30,0
s_cselect_b32 s65,0x80000000,s71
v_mfma_f32_16x16x32_bf16 v[176:179],v[28:31],a[48:51],v[176:179]
s_lshl_b32 s56,s72,31
s_or_b32 s64,s70,s56
v_mfma_f32_16x16x32_bf16 v[180:183],v[28:31],a[52:55],v[180:183]
s_or_b32 s65,s65,s56
s_lshr_b32 s62,s68,1
v_mfma_f32_16x16x32_bf16 v[184:187],v[28:31],a[56:59],v[184:187]
s_lshl_b32 s61,s62,10
s_add_u32 s61,s61,s69
v_mfma_f32_16x16x32_bf16 v[188:191],v[28:31],a[60:63],v[188:191]
v_mov_b32 v238,155648
s_and_b32 s57,s46,1
s_waitcnt lgkmcnt(5)
v_mfma_f32_16x16x32_bf16 v[160:163],v[32:35],a[64:67],v[160:163]
s_mul_i32 s58,s57,12288
s_add_u32 s64,s64,s58
v_mfma_f32_16x16x32_bf16 v[164:167],v[32:35],a[68:71],v[164:167]
s_lshl_b32 s57,s57,12
s_add_u32 s65,s65,s57
v_mfma_f32_16x16x32_bf16 v[168:171],v[32:35],a[72:75],v[168:171]
s_and_b32 s59,s50,2048
s_lshl_b32 s59,s59,4
v_mfma_f32_16x16x32_bf16 v[172:175],v[32:35],a[76:79],v[172:175]
s_xor_b32 s60,s67,65536
s_add_u32 s59,s59,s60
v_mfma_f32_16x16x32_bf16 v[176:179],v[32:35],a[80:83],v[176:179]
s_add_u32 s58,s58,s59
s_add_u32 s57,s57,s59
v_mfma_f32_16x16x32_bf16 v[180:183],v[32:35],a[84:87],v[180:183]
s_add_u32 m0,s58,0
s_nop 0
buffer_load_dwordx4 v0,s[8:11],s64 offen offset:0 sc1 lds
v_mfma_f32_16x16x32_bf16 v[184:187],v[32:35],a[88:91],v[184:187]
v_mfma_f32_16x16x32_bf16 v[188:191],v[32:35],a[92:95],v[188:191]
s_waitcnt lgkmcnt(0)
v_mfma_f32_16x16x32_bf16 v[160:163],v[36:39],a[96:99],v[160:163]
ds_read_b128 v[56:59],v4 offset:4096
v_mfma_f32_16x16x32_bf16 v[164:167],v[36:39],a[100:103],v[164:167]
buffer_load_dwordx4 v0,s[8:11],s64 offen offset:1024 sc1 lds
v_mfma_f32_16x16x32_bf16 v[168:171],v[36:39],a[104:107],v[168:171]
ds_read_b128 v[60:63],v4 offset:5120
v_mfma_f32_16x16x32_bf16 v[172:175],v[36:39],a[108:111],v[172:175]
ds_read_b128 v[64:67],v4 offset:6144
v_mfma_f32_16x16x32_bf16 v[176:179],v[36:39],a[112:115],v[176:179]
ds_read_b128 v[68:71],v4 offset:7168
v_mfma_f32_16x16x32_bf16 v[180:183],v[36:39],a[116:119],v[180:183]
buffer_load_dwordx4 v0,s[8:11],s64 offen offset:2048 sc1 lds
v_mfma_f32_16x16x32_bf16 v[184:187],v[36:39],a[120:123],v[184:187]
ds_read_b128 v[72:75],v4 offset:12288
v_mfma_f32_16x16x32_bf16 v[188:191],v[36:39],a[124:127],v[188:191]
ds_read_b128 v[76:79],v4 offset:13312
v_mfma_f32_16x16x32_bf16 v[160:163],v[40:43],a[128:131],v[160:163]
ds_read_b128 v[80:83],v4 offset:14336
v_mfma_f32_16x16x32_bf16 v[164:167],v[40:43],a[132:135],v[164:167]
buffer_load_dwordx4 v0,s[8:11],s64 offen offset:3072 sc1 lds
v_mfma_f32_16x16x32_bf16 v[168:171],v[40:43],a[136:139],v[168:171]
s_add_u32 m0,s58,4096
s_add_u32 s64,s64,4096
v_mfma_f32_16x16x32_bf16 v[172:175],v[40:43],a[140:143],v[172:175]
ds_read_b128 v[84:87],v4 offset:15360
v_mfma_f32_16x16x32_bf16 v[176:179],v[40:43],a[144:147],v[176:179]
ds_read_b128 v[128:131],v238
v_mfma_f32_16x16x32_bf16 v[180:183],v[40:43],a[148:151],v[180:183]
buffer_load_dwordx4 v0,s[8:11],s64 offen offset:0 sc1 lds
v_mfma_f32_16x16x32_bf16 v[184:187],v[40:43],a[152:155],v[184:187]
v_mfma_f32_16x16x32_bf16 v[188:191],v[40:43],a[156:159],v[188:191]
s_waitcnt vmcnt(8)
buffer_store_dword v20,off,s[8:11],s73 sc1
s_mov_b32 s73,0x80000000
v_mfma_f32_16x16x32_bf16 v[160:163],v[44:47],a[160:163],v[160:163]
v_mfma_f32_16x16x32_bf16 v[164:167],v[44:47],a[164:167],v[164:167]
buffer_load_dwordx4 v0,s[8:11],s64 offen offset:1024 sc1 lds
v_mfma_f32_16x16x32_bf16 v[168:171],v[44:47],a[168:171],v[168:171]
v_mfma_f32_16x16x32_bf16 v[172:175],v[44:47],a[172:175],v[172:175]
v_mfma_f32_16x16x32_bf16 v[176:179],v[44:47],a[176:179],v[176:179]
v_mfma_f32_16x16x32_bf16 v[180:183],v[44:47],a[180:183],v[180:183]
buffer_load_dwordx4 v0,s[8:11],s64 offen offset:2048 sc1 lds
v_mfma_f32_16x16x32_bf16 v[184:187],v[44:47],a[184:187],v[184:187]
v_mfma_f32_16x16x32_bf16 v[188:191],v[44:47],a[188:191],v[188:191]
v_mfma_f32_16x16x32_bf16 v[160:163],v[48:51],a[192:195],v[160:163]
v_mfma_f32_16x16x32_bf16 v[164:167],v[48:51],a[196:199],v[164:167]
buffer_load_dwordx4 v0,s[8:11],s64 offen offset:3072 sc1 lds
v_mfma_f32_16x16x32_bf16 v[168:171],v[48:51],a[200:203],v[168:171]
s_add_u32 m0,s58,8192
s_add_u32 s64,s64,4096
v_mfma_f32_16x16x32_bf16 v[172:175],v[48:51],a[204:207],v[172:175]
v_mfma_f32_16x16x32_bf16 v[176:179],v[48:51],a[208:211],v[176:179]
v_mfma_f32_16x16x32_bf16 v[180:183],v[48:51],a[212:215],v[180:183]
buffer_load_dwordx4 v0,s[8:11],s64 offen offset:0 sc1 lds
v_mfma_f32_16x16x32_bf16 v[184:187],v[48:51],a[216:219],v[184:187]
v_mfma_f32_16x16x32_bf16 v[188:191],v[48:51],a[220:223],v[188:191]
v_mfma_f32_16x16x32_bf16 v[160:163],v[52:55],a[224:227],v[160:163]
v_mfma_f32_16x16x32_bf16 v[164:167],v[52:55],a[228:231],v[164:167]
buffer_load_dwordx4 v0,s[8:11],s64 offen offset:1024 sc1 lds
v_mfma_f32_16x16x32_bf16 v[168:171],v[52:55],a[232:235],v[168:171]
v_mfma_f32_16x16x32_bf16 v[172:175],v[52:55],a[236:239],v[172:175]
v_mfma_f32_16x16x32_bf16 v[176:179],v[52:55],a[240:243],v[176:179]
v_mfma_f32_16x16x32_bf16 v[180:183],v[52:55],a[244:247],v[180:183]
buffer_load_dwordx4 v0,s[8:11],s64 offen offset:2048 sc1 lds
v_mfma_f32_16x16x32_bf16 v[184:187],v[52:55],a[248:251],v[184:187]
v_mfma_f32_16x16x32_bf16 v[188:191],v[52:55],a[252:255],v[188:191]
s_waitcnt vmcnt(14) lgkmcnt(0)
L_aw_51:
v_cmp_gt_u32 vcc,s66,v17
s_cbranch_vccz L_awd_52
buffer_load_dword v17,v16,s[8:11],s63 offen sc1
s_sub_u32 s49,s49,1
s_cbranch_scc1 L_abort
s_waitcnt vmcnt(0)
s_branch L_aw_51
L_awd_52:
v_mfma_f32_16x16x32_bf16 v[192:195],v[56:59],a[0:3],0
v_or3_b32 v128,v128,v129,v130
v_or_b32 v128,v128,v131
v_mfma_f32_16x16x32_bf16 v[196:199],v[56:59],a[4:7],0
buffer_load_dwordx4 v0,s[8:11],s64 offen offset:3072 sc1 lds
v_mfma_f32_16x16x32_bf16 v[200:203],v[56:59],a[8:11],0
s_add_u32 m0,s57,24576
s_nop 0
v_mfma_f32_16x16x32_bf16 v[204:207],v[56:59],a[12:15],0
v_readfirstlane_b32 s72,v128
v_cvt_pk_bf16_f32 v88,v160,v164
v_mfma_f32_16x16x32_bf16 v[208:211],v[56:59],a[16:19],0
v_cvt_pk_bf16_f32 v89,v168,v172
v_cvt_pk_bf16_f32 v90,v176,v180
v_mfma_f32_16x16x32_bf16 v[212:215],v[56:59],a[20:23],0
buffer_load_dwordx4 v0,s[8:11],s65 offen offset:0 sc1 lds
v_mfma_f32_16x16x32_bf16 v[216:219],v[56:59],a[24:27],0
v_cvt_pk_bf16_f32 v91,v184,v188
s_add_u32 s62,s61,0
v_mfma_f32_16x16x32_bf16 v[220:223],v[56:59],a[28:31],0
buffer_store_dwordx4 v[88:91],v5,s[8:11],s62 offen
v_mfma_f32_16x16x32_bf16 v[192:195],v[60:63],a[32:35],v[192:195]
v_cvt_pk_bf16_f32 v92,v161,v165
v_cvt_pk_bf16_f32 v93,v169,v173
v_mfma_f32_16x16x32_bf16 v[196:199],v[60:63],a[36:39],v[196:199]
buffer_load_dwordx4 v0,s[8:11],s65 offen offset:1024 sc1 lds
v_mfma_f32_16x16x32_bf16 v[200:203],v[60:63],a[40:43],v[200:203]
v_cvt_pk_bf16_f32 v94,v177,v181
v_cvt_pk_bf16_f32 v95,v185,v189
v_mfma_f32_16x16x32_bf16 v[204:207],v[60:63],a[44:47],v[204:207]
s_add_u32 s62,s61,16384
buffer_store_dwordx4 v[92:95],v5,s[8:11],s62 offen
v_mfma_f32_16x16x32_bf16 v[208:211],v[60:63],a[48:51],v[208:211]
v_cvt_pk_bf16_f32 v96,v162,v166
v_cvt_pk_bf16_f32 v97,v170,v174
v_mfma_f32_16x16x32_bf16 v[212:215],v[60:63],a[52:55],v[212:215]
buffer_load_dwordx4 v0,s[8:11],s65 offen offset:2048 sc1 lds
v_mfma_f32_16x16x32_bf16 v[216:219],v[60:63],a[56:59],v[216:219]
v_cvt_pk_bf16_f32 v98,v178,v182
v_cvt_pk_bf16_f32 v99,v186,v190
v_mfma_f32_16x16x32_bf16 v[220:223],v[60:63],a[60:63],v[220:223]
s_add_u32 s62,s61,32768
buffer_store_dwordx4 v[96:99],v5,s[8:11],s62 offen
v_mfma_f32_16x16x32_bf16 v[192:195],v[64:67],a[64:67],v[192:195]
v_cvt_pk_bf16_f32 v100,v163,v167
v_cvt_pk_bf16_f32 v101,v171,v175
v_mfma_f32_16x16x32_bf16 v[196:199],v[64:67],a[68:71],v[196:199]
buffer_load_dwordx4 v0,s[8:11],s65 offen offset:3072 sc1 lds
v_mfma_f32_16x16x32_bf16 v[200:203],v[64:67],a[72:75],v[200:203]
v_cvt_pk_bf16_f32 v102,v179,v183
v_cvt_pk_bf16_f32 v103,v187,v191
v_mfma_f32_16x16x32_bf16 v[204:207],v[64:67],a[76:79],v[204:207]
s_add_u32 s62,s61,49152
buffer_store_dwordx4 v[100:103],v5,s[8:11],s62 offen
v_mfma_f32_16x16x32_bf16 v[208:211],v[64:67],a[80:83],v[208:211]
v_mfma_f32_16x16x32_bf16 v[212:215],v[64:67],a[84:87],v[212:215]
v_mfma_f32_16x16x32_bf16 v[216:219],v[64:67],a[88:91],v[216:219]
v_mfma_f32_16x16x32_bf16 v[220:223],v[64:67],a[92:95],v[220:223]
v_mfma_f32_16x16x32_bf16 v[192:195],v[68:71],a[96:99],v[192:195]
v_mfma_f32_16x16x32_bf16 v[196:199],v[68:71],a[100:103],v[196:199]
v_mfma_f32_16x16x32_bf16 v[200:203],v[68:71],a[104:107],v[200:203]
v_mfma_f32_16x16x32_bf16 v[204:207],v[68:71],a[108:111],v[204:207]
v_mfma_f32_16x16x32_bf16 v[208:211],v[68:71],a[112:115],v[208:211]
v_mfma_f32_16x16x32_bf16 v[212:215],v[68:71],a[116:119],v[212:215]
v_mfma_f32_16x16x32_bf16 v[216:219],v[68:71],a[120:123],v[216:219]
v_mfma_f32_16x16x32_bf16 v[220:223],v[68:71],a[124:127],v[220:223]
v_mfma_f32_16x16x32_bf16 v[192:195],v[72:75],a[128:131],v[192:195]
v_mfma_f32_16x16x32_bf16 v[196:199],v[72:75],a[132:135],v[196:199]
v_mfma_f32_16x16x32_bf16 v[200:203],v[72:75],a[136:139],v[200:203]
v_mfma_f32_16x16x32_bf16 v[204:207],v[72:75],a[140:143],v[204:207]
v_mfma_f32_16x16x32_bf16 v[208:211],v[72:75],a[144:147],v[208:211]
v_mfma_f32_16x16x32_bf16 v[212:215],v[72:75],a[148:151],v[212:215]
v_mfma_f32_16x16x32_bf16 v[216:219],v[72:75],a[152:155],v[216:219]
v_mfma_f32_16x16x32_bf16 v[220:223],v[72:75],a[156:159],v[220:223]
v_mfma_f32_16x16x32_bf16 v[192:195],v[76:79],a[160:163],v[192:195]
v_mfma_f32_16x16x32_bf16 v[196:199],v[76:79],a[164:167],v[196:199]
v_mfma_f32_16x16x32_bf16 v[200:203],v[76:79],a[168:171],v[200:203]
v_mfma_f32_16x16x32_bf16 v[204:207],v[76:79],a[172:175],v[204:207]
v_mfma_f32_16x16x32_bf16 v[208:211],v[76:79],a[176:179],v[208:211]
v_mfma_f32_16x16x32_bf16 v[212:215],v[76:79],a[180:183],v[212:215]
v_mfma_f32_16x16x32_bf16 v[216:219],v[76:79],a[184:187],v[216:219]
v_mfma_f32_16x16x32_bf16 v[220:223],v[76:79],a[188:191],v[220:223]
v_mfma_f32_16x16x32_bf16 v[192:195],v[80:83],a[192:195],v[192:195]
v_mfma_f32_16x16x32_bf16 v[196:199],v[80:83],a[196:199],v[196:199]
v_mfma_f32_16x16x32_bf16 v[200:203],v[80:83],a[200:203],v[200:203]
v_mfma_f32_16x16x32_bf16 v[204:207],v[80:83],a[204:207],v[204:207]
v_mfma_f32_16x16x32_bf16 v[208:211],v[80:83],a[208:211],v[208:211]
v_mfma_f32_16x16x32_bf16 v[212:215],v[80:83],a[212:215],v[212:215]
v_mfma_f32_16x16x32_bf16 v[216:219],v[80:83],a[216:219],v[216:219]
v_mfma_f32_16x16x32_bf16 v[220:223],v[80:83],a[220:223],v[220:223]
v_mfma_f32_16x16x32_bf16 v[192:195],v[84:87],a[224:227],v[192:195]
v_mfma_f32_16x16x32_bf16 v[196:199],v[84:87],a[228:231],v[196:199]
v_mfma_f32_16x16x32_bf16 v[200:203],v[84:87],a[232:235],v[200:203]
v_mfma_f32_16x16x32_bf16 v[204:207],v[84:87],a[236:239],v[204:207]
v_mfma_f32_16x16x32_bf16 v[208:211],v[84:87],a[240:243],v[208:211]
v_mfma_f32_16x16x32_bf16 v[212:215],v[84:87],a[244:247],v[212:215]
v_mfma_f32_16x16x32_bf16 v[216:219],v[84:87],a[248:251],v[216:219]
v_mfma_f32_16x16x32_bf16 v[220:223],v[84:87],a[252:255],v[220:223]
v_cvt_pk_bf16_f32 v104,v192,v196
v_cvt_pk_bf16_f32 v105,v200,v204
v_cvt_pk_bf16_f32 v106,v208,v212
s_nop 4
v_cvt_pk_bf16_f32 v107,v216,v220
s_add_u32 s62,s61,262144
buffer_store_dwordx4 v[104:107],v5,s[8:11],s62 offen
v_cvt_pk_bf16_f32 v108,v193,v197
v_cvt_pk_bf16_f32 v109,v201,v205
v_cvt_pk_bf16_f32 v110,v209,v213
v_cvt_pk_bf16_f32 v111,v217,v221
s_add_u32 s62,s61,278528
buffer_store_dwordx4 v[108:111],v5,s[8:11],s62 offen
v_cvt_pk_bf16_f32 v112,v194,v198
v_cvt_pk_bf16_f32 v113,v202,v206
v_cvt_pk_bf16_f32 v114,v210,v214
v_cvt_pk_bf16_f32 v115,v218,v222
s_add_u32 s62,s61,294912
buffer_store_dwordx4 v[112:115],v5,s[8:11],s62 offen
v_cvt_pk_bf16_f32 v116,v195,v199
v_cvt_pk_bf16_f32 v117,v203,v207
v_cvt_pk_bf16_f32 v118,v211,v215
v_cvt_pk_bf16_f32 v119,v219,v223
s_add_u32 s62,s61,311296
buffer_store_dwordx4 v[116:119],v5,s[8:11],s62 offen
s_cmp_lg_u32 s72,0
s_cbranch_scc1 L_aa_40
s_waitcnt vmcnt(5)
s_barrier
s_cmp_eq_u32 s30,0
s_cbranch_scc1 L_aa_39
s_xor_b32 s67,s67,65536
s_and_b32 s56,s50,2048
s_lshl_b32 s56,s56,4
s_add_u32 s56,s56,s67
v_add_u32 v2,s56,v0
s_and_b32 s56,s50,1024
s_lshl_b32 s56,s56,2
v_add_u32 v238,s56,v2
s_mov_b32 s76,s71
s_mov_b32 s53,s77
ds_read_b128 v[24:27],v238 offset:16384
ds_read_b128 v[40:43],v2 offset:0
ds_read_b128 v[56:59],v2 offset:4096
ds_read_b128 v[28:31],v238 offset:17408
ds_read_b128 v[44:47],v2 offset:1024
ds_read_b128 v[60:63],v2 offset:5120
ds_read_b128 v[32:35],v238 offset:18432
ds_read_b128 v[48:51],v2 offset:2048
ds_read_b128 v[64:67],v2 offset:6144
ds_read_b128 v[36:39],v238 offset:19456
ds_read_b128 v[52:55],v2 offset:3072
ds_read_b128 v[68:71],v2 offset:7168
s_waitcnt lgkmcnt(9)
v_mfma_f32_16x16x32_bf16 v[128:131],v[40:43],v[24:27],v[8:11]
ds_read_b128 v[72:75],v2 offset:24576
v_mfma_f32_16x16x32_bf16 v[132:135],v[56:59],v[24:27],v[12:15]
ds_read_b128 v[76:79],v2 offset:25600
s_waitcnt lgkmcnt(8)
v_mfma_f32_16x16x32_bf16 v[128:131],v[44:47],v[28:31],v[128:131]
ds_read_b128 v[80:83],v2 offset:26624
v_mfma_f32_16x16x32_bf16 v[132:135],v[60:63],v[28:31],v[132:135]
ds_read_b128 v[84:87],v2 offset:27648
s_waitcnt lgkmcnt(7)
v_mfma_f32_16x16x32_bf16 v[128:131],v[48:51],v[32:35],v[128:131]
ds_read_b128 v[88:91],v2 offset:8192
v_mfma_f32_16x16x32_bf16 v[132:135],v[64:67],v[32:35],v[132:135]
ds_read_b128 v[92:95],v2 offset:9216
s_waitcnt lgkmcnt(6)
v_mfma_f32_16x16x32_bf16 v[128:131],v[52:55],v[36:39],v[128:131]
ds_read_b128 v[96:99],v2 offset:10240
v_mfma_f32_16x16x32_bf16 v[132:135],v[68:71],v[36:39],v[132:135]
ds_read_b128 v[100:103],v2 offset:11264
s_waitcnt lgkmcnt(4)
v_mfma_f32_16x16x32_bf16 v[136:139],v[72:75],v[24:27],0
ds_read_b128 v[104:107],v2 offset:12288
ds_read_b128 v[108:111],v2 offset:13312
v_mfma_f32_16x16x32_bf16 v[136:139],v[76:79],v[28:31],v[136:139]
ds_read_b128 v[112:115],v2 offset:14336
ds_read_b128 v[116:119],v2 offset:15360
v_mfma_f32_16x16x32_bf16 v[136:139],v[80:83],v[32:35],v[136:139]
ds_read_b64 v[120:121],v2 offset:28672
ds_read_b64 v[122:123],v2 offset:29696
v_mfma_f32_16x16x32_bf16 v[136:139],v[84:87],v[36:39],v[136:139]
ds_read_b64 v[124:125],v2 offset:30720
ds_read_b64 v[126:127],v2 offset:31744
s_add_u32 s66,s66,1
v_mov_b32 v22,s66
s_waitcnt vmcnt(0)
s_barrier
buffer_store_dword v22,off,s[8:11],s74
s_cmp_lg_u32 s86,1536
s_cbranch_scc1 L_ae_53
s_add_u32 s77,s53,12
s_mov_b32 s30,0
s_lshl_b32 s56,s77,5
s_add_u32 s56,s56,s68
s_mul_i32 s70,s56,24576
s_lshl_b32 s71,s56,13
s_add_u32 s70,s70,100663296
s_add_u32 s71,s71,41943040
s_lshl_b32 s59,s77,13
s_lshl2_add_u32 s59,s68,s59
s_add_u32 s59,s59,10485760
v_mov_b32 v19,s59
buffer_load_dword v18,v19,s[8:11],0 offen sc1
s_branch L_af_54
L_ae_53:
s_ff1_i32_b64 s77,s[84:85]
s_bitset0_b64 s[84:85],s77
s_ff1_i32_b64 s77,s[84:85]
s_bitset0_b64 s[84:85],s77
s_ff1_i32_b64 s77,s[84:85]
s_bitset0_b64 s[84:85],s77
s_ff1_i32_b64 s77,s[84:85]
s_bitset0_b64 s[84:85],s77
s_ff1_i32_b64 s77,s[84:85]
s_bitset0_b64 s[84:85],s77
s_ff1_i32_b64 s77,s[84:85]
s_bitset0_b64 s[84:85],s77
s_min_u32 s77,s77,64
s_lshr_b32 s61,s55,5
s_lshl_b32 s56,s77,5
s_add_u32 s56,s56,s68
s_mul_i32 s70,s56,24576
s_lshl_b32 s71,s56,13
s_lshl_b32 s59,s77,13
s_lshl2_add_u32 s59,s68,s59
s_add_u32 s59,s59,10485760
s_cmp_lt_u32 s77,s61
s_cselect_b32 s57,0,16777216
s_cselect_b32 s60,0,128
s_add_u32 s71,s71,s57
s_add_u32 s71,s71,58720256
s_add_u32 s60,s60,s59
s_add_u32 s60,s60,512
s_cmp_eq_u32 s77,s61
s_cselect_b32 s57,50331648,0
s_cselect_b32 s58,1536,0
s_add_u32 s70,s70,s57
s_add_u32 s70,s70,150994944
s_add_u32 s59,s59,s58
s_add_u32 s59,s59,384
v_mov_b32 v19,s59
v_writelane_b32 v19,s60,1
buffer_load_dword v18,v19,s[8:11],0 offen sc1
L_af_54:
v_max3_f32 v238,v128,v129,v130
v_max3_f32 v239,v131,v132,v133
v_max3_f32 v238,v134,v135,v238
v_max3_f32 v239,v138,v139,v239
v_max_f32 v238,v238,v239
v_max_f32 v239,v238,v239
s_nop 1
v_permlane16_swap_b32 v238,v239
v_max_f32 v238,v238,v239
v_max_f32 v239,v238,v239
s_nop 1
v_permlane32_swap_b32 v238,v239
v_max_f32 v238,v238,v239
v_mul_f32 v238,s80,v238
v_fma_f32 v128,v128,s80,-v238
v_fma_f32 v129,v129,s80,-v238
v_exp_f32 v128,v128
v_fma_f32 v130,v130,s80,-v238
v_exp_f32 v129,v129
v_fma_f32 v131,v131,s80,-v238
v_exp_f32 v130,v130
v_fma_f32 v132,v132,s80,-v238
v_exp_f32 v131,v131
v_fma_f32 v133,v133,s80,-v238
v_exp_f32 v132,v132
v_fma_f32 v134,v134,s80,-v238
v_exp_f32 v133,v133
v_fma_f32 v135,v135,s80,-v238
v_exp_f32 v134,v134
v_fma_f32 v138,v138,s80,-v238
v_exp_f32 v135,v135
v_fma_f32 v139,v139,s80,-v238
v_exp_f32 v138,v138
v_exp_f32 v139,v139
v_cvt_pk_bf16_f32 v140,v128,v129
v_cvt_pk_bf16_f32 v141,v130,v131
v_cvt_pk_bf16_f32 v142,v132,v133
v_cvt_pk_bf16_f32 v143,v134,v135
v_cvt_pk_bf16_f32 v144,v138,v139
v_mov_b32 v147,v144
s_waitcnt lgkmcnt(0)
v_mfma_f32_16x16x32_bf16 v[148:151],v[152:155],v[140:143],0
v_mfma_f32_16x16x32_bf16 v[24:27],v[88:91],v[140:143],0
v_mfma_f32_16x16x32_bf16 v[28:31],v[92:95],v[140:143],0
v_mfma_f32_16x16x16_bf16 v[148:151],v[152:153],v[144:145],v[148:151]
v_mfma_f32_16x16x32_bf16 v[32:35],v[96:99],v[140:143],0
v_mfma_f32_16x16x32_bf16 v[36:39],v[100:103],v[140:143],0
v_mfma_f32_16x16x32_bf16 v[40:43],v[104:107],v[140:143],0
v_mfma_f32_16x16x32_bf16 v[44:47],v[108:111],v[140:143],0
v_mfma_f32_16x16x32_bf16 v[48:51],v[112:115],v[140:143],0
v_mfma_f32_16x16x32_bf16 v[52:55],v[116:119],v[140:143],0
v_rcp_f32 v148,v148
v_mfma_f32_16x16x16_bf16 v[24:27],v[120:121],v[144:145],v[24:27]
v_mfma_f32_16x16x16_bf16 v[28:31],v[120:121],v[146:147],v[28:31]
v_mfma_f32_16x16x16_bf16 v[32:35],v[122:123],v[144:145],v[32:35]
v_mfma_f32_16x16x16_bf16 v[36:39],v[122:123],v[146:147],v[36:39]
v_mfma_f32_16x16x16_bf16 v[40:43],v[124:125],v[144:145],v[40:43]
v_pk_mul_f32 v[24:25],v[24:25],v[148:149] op_sel_hi:[1,0]
v_pk_mul_f32 v[26:27],v[26:27],v[148:149] op_sel_hi:[1,0]
v_mfma_f32_16x16x16_bf16 v[44:47],v[124:125],v[146:147],v[44:47]
v_pk_mul_f32 v[28:29],v[28:29],v[148:149] op_sel_hi:[1,0]
v_pk_mul_f32 v[30:31],v[30:31],v[148:149] op_sel_hi:[1,0]
v_mfma_f32_16x16x16_bf16 v[48:51],v[126:127],v[144:145],v[48:51]
v_cvt_pk_bf16_f32 v72,v24,v28
v_cvt_pk_bf16_f32 v73,v25,v29
v_mfma_f32_16x16x16_bf16 v[52:55],v[126:127],v[146:147],v[52:55]
v_cvt_pk_bf16_f32 v74,v26,v30
v_cvt_pk_bf16_f32 v75,v27,v31
ds_write_b128 v3,v[72:75] offset:0
v_pk_mul_f32 v[32:33],v[32:33],v[148:149] op_sel_hi:[1,0]
v_pk_mul_f32 v[34:35],v[34:35],v[148:149] op_sel_hi:[1,0]
v_pk_mul_f32 v[36:37],v[36:37],v[148:149] op_sel_hi:[1,0]
v_pk_mul_f32 v[38:39],v[38:39],v[148:149] op_sel_hi:[1,0]
v_cvt_pk_bf16_f32 v76,v32,v36
v_cvt_pk_bf16_f32 v77,v33,v37
v_cvt_pk_bf16_f32 v78,v34,v38
v_cvt_pk_bf16_f32 v79,v35,v39
ds_write_b128 v3,v[76:79] offset:1024
v_pk_mul_f32 v[40:41],v[40:41],v[148:149] op_sel_hi:[1,0]
v_pk_mul_f32 v[42:43],v[42:43],v[148:149] op_sel_hi:[1,0]
v_pk_mul_f32 v[44:45],v[44:45],v[148:149] op_sel_hi:[1,0]
v_pk_mul_f32 v[46:47],v[46:47],v[148:149] op_sel_hi:[1,0]
v_cvt_pk_bf16_f32 v80,v40,v44
v_cvt_pk_bf16_f32 v81,v41,v45
v_cvt_pk_bf16_f32 v82,v42,v46
v_cvt_pk_bf16_f32 v83,v43,v47
ds_write_b128 v3,v[80:83] offset:2048
v_pk_mul_f32 v[48:49],v[48:49],v[148:149] op_sel_hi:[1,0]
v_pk_mul_f32 v[50:51],v[50:51],v[148:149] op_sel_hi:[1,0]
v_pk_mul_f32 v[52:53],v[52:53],v[148:149] op_sel_hi:[1,0]
v_pk_mul_f32 v[54:55],v[54:55],v[148:149] op_sel_hi:[1,0]
v_cvt_pk_bf16_f32 v84,v48,v52
v_cvt_pk_bf16_f32 v85,v49,v53
v_cvt_pk_bf16_f32 v86,v50,v54
v_cvt_pk_bf16_f32 v87,v51,v55
ds_write_b128 v3,v[84:87] offset:3072
s_lshr_b32 s60,s68,1
s_lshl_b32 s60,s60,15
s_add_u32 s60,s60,s69
L_aq_55:
buffer_load_dword v17,v16,s[8:11],s87 offen sc1
s_sub_u32 s49,s49,1
s_cbranch_scc1 L_abort
s_waitcnt vmcnt(0)
v_cmp_gt_u32 vcc,s66,v17
s_cbranch_vccnz L_aq_55
buffer_load_dwordx4 v[160:163],v7,s[8:11],s60 offen sc1
s_add_u32 s60,s60,4096
buffer_load_dwordx4 v[164:167],v7,s[8:11],s60 offen sc1
s_add_u32 s60,s60,4096
buffer_load_dwordx4 v[168:171],v7,s[8:11],s60 offen sc1
s_add_u32 s60,s60,4096
buffer_load_dwordx4 v[172:175],v7,s[8:11],s60 offen sc1
s_add_u32 s60,s60,4096
buffer_load_dwordx4 v[176:179],v7,s[8:11],s60 offen sc1
s_add_u32 s60,s60,4096
buffer_load_dwordx4 v[180:183],v7,s[8:11],s60 offen sc1
s_add_u32 s60,s60,4096
buffer_load_dwordx4 v[184:187],v7,s[8:11],s60 offen sc1
s_add_u32 s60,s60,4096
buffer_load_dwordx4 v[188:191],v7,s[8:11],s60 offen sc1
v_cmp_eq_u32 vcc,0,v18
s_lshl_b32 s56,s46,2
s_add_u32 s56,s56,155648
v_mov_b32 v238,s56
s_cmp_lg_u64 vcc,0
s_cselect_b32 s72,1,0
s_cmp_ge_u32 s77,64
s_cselect_b32 s72,1,s72
v_mov_b32 v239,s72
ds_write_b32 v238,v239
v_lshlrev_b32 v200,16,v224
v_and_b32 v201,0xffff0000,v224
v_lshlrev_b32 v202,16,v225
v_and_b32 v203,0xffff0000,v225
v_lshlrev_b32 v204,16,v226
v_and_b32 v205,0xffff0000,v226
v_lshlrev_b32 v206,16,v227
v_and_b32 v207,0xffff0000,v227
s_add_u32 s59,s74,128
s_waitcnt vmcnt(7)
v_mfma_f32_16x16x32_bf16 v[192:195],v[156:159],v[160:163],0
s_waitcnt vmcnt(6)
v_mfma_f32_16x16x32_bf16 v[192:195],v[156:159],v[164:167],v[192:195]
s_waitcnt vmcnt(5)
v_mfma_f32_16x16x32_bf16 v[192:195],v[156:159],v[168:171],v[192:195]
s_waitcnt vmcnt(4)
v_mfma_f32_16x16x32_bf16 v[192:195],v[156:159],v[172:175],v[192:195]
s_waitcnt vmcnt(3)
v_mfma_f32_16x16x32_bf16 v[196:199],v[156:159],v[176:179],0
s_waitcnt vmcnt(2)
v_mfma_f32_16x16x32_bf16 v[196:199],v[156:159],v[180:183],v[196:199]
s_waitcnt vmcnt(1)
v_mfma_f32_16x16x32_bf16 v[196:199],v[156:159],v[184:187],v[196:199]
ds_write_b128 v6,v[192:195]
s_waitcnt vmcnt(0)
v_mfma_f32_16x16x32_bf16 v[196:199],v[156:159],v[188:191],v[196:199]
s_nop 7
ds_write_b128 v6,v[196:199] offset:2048
s_waitcnt lgkmcnt(0)
s_barrier
buffer_store_dword v22,off,s[8:11],s59
s_mov_b32 s88,1
s_branch L_aa_41
L_aa_39:
s_xor_b32 s67,s67,65536
s_and_b32 s56,s50,2048
s_lshl_b32 s56,s56,4
s_add_u32 s56,s56,s67
v_add_u32 v2,s56,v0
s_and_b32 s56,s50,1024
s_lshl_b32 s56,s56,2
v_add_u32 v238,s56,v2
s_mov_b32 s76,s71
s_mov_b32 s53,s77
ds_read_b128 v[24:27],v238 offset:16384
ds_read_b128 v[40:43],v2 offset:0
ds_read_b128 v[56:59],v2 offset:4096
ds_read_b128 v[28:31],v238 offset:17408
ds_read_b128 v[44:47],v2 offset:1024
ds_read_b128 v[60:63],v2 offset:5120
ds_read_b128 v[32:35],v238 offset:18432
ds_read_b128 v[48:51],v2 offset:2048
ds_read_b128 v[64:67],v2 offset:6144
ds_read_b128 v[36:39],v238 offset:19456
ds_read_b128 v[52:55],v2 offset:3072
ds_read_b128 v[68:71],v2 offset:7168
s_waitcnt lgkmcnt(9)
v_mfma_f32_16x16x32_bf16 v[128:131],v[40:43],v[24:27],v[8:11]
ds_read_b128 v[88:91],v2 offset:8192
v_mfma_f32_16x16x32_bf16 v[132:135],v[56:59],v[24:27],v[12:15]
ds_read_b128 v[92:95],v2 offset:9216
s_waitcnt lgkmcnt(8)
v_mfma_f32_16x16x32_bf16 v[128:131],v[44:47],v[28:31],v[128:131]
ds_read_b128 v[96:99],v2 offset:10240
v_mfma_f32_16x16x32_bf16 v[132:135],v[60:63],v[28:31],v[132:135]
ds_read_b128 v[100:103],v2 offset:11264
s_waitcnt lgkmcnt(7)
v_mfma_f32_16x16x32_bf16 v[128:131],v[48:51],v[32:35],v[128:131]
ds_read_b128 v[104:107],v2 offset:12288
v_mfma_f32_16x16x32_bf16 v[132:135],v[64:67],v[32:35],v[132:135]
ds_read_b128 v[108:111],v2 offset:13312
s_waitcnt lgkmcnt(6)
v_mfma_f32_16x16x32_bf16 v[128:131],v[52:55],v[36:39],v[128:131]
ds_read_b128 v[112:115],v2 offset:14336
v_mfma_f32_16x16x32_bf16 v[132:135],v[68:71],v[36:39],v[132:135]
ds_read_b128 v[116:119],v2 offset:15360
s_add_u32 s66,s66,1
v_mov_b32 v22,s66
s_waitcnt vmcnt(0)
s_barrier
buffer_store_dword v22,off,s[8:11],s74
s_lshr_b32 s60,s68,1
s_lshl_b32 s60,s60,15
s_add_u32 s60,s60,s69
L_aq_56:
buffer_load_dword v17,v16,s[8:11],s87 offen sc1
s_sub_u32 s49,s49,1
s_cbranch_scc1 L_abort
s_waitcnt vmcnt(0)
v_cmp_gt_u32 vcc,s66,v17
s_cbranch_vccnz L_aq_56
buffer_load_dwordx4 v[160:163],v7,s[8:11],s60 offen sc1
s_add_u32 s60,s60,4096
buffer_load_dwordx4 v[164:167],v7,s[8:11],s60 offen sc1
s_add_u32 s60,s60,4096
buffer_load_dwordx4 v[168:171],v7,s[8:11],s60 offen sc1
s_add_u32 s60,s60,4096
buffer_load_dwordx4 v[172:175],v7,s[8:11],s60 offen sc1
s_add_u32 s60,s60,4096
buffer_load_dwordx4 v[176:179],v7,s[8:11],s60 offen sc1
s_add_u32 s60,s60,4096
buffer_load_dwordx4 v[180:183],v7,s[8:11],s60 offen sc1
s_add_u32 s60,s60,4096
buffer_load_dwordx4 v[184:187],v7,s[8:11],s60 offen sc1
s_add_u32 s60,s60,4096
buffer_load_dwordx4 v[188:191],v7,s[8:11],s60 offen sc1
s_add_u32 s62,s76,4096
buffer_load_dwordx4 v[72:75],v0,s[8:11],s76 offen offset:0 sc1
buffer_load_dwordx4 v[76:79],v0,s[8:11],s76 offen offset:1024 sc1
buffer_load_dwordx4 v[80:83],v0,s[8:11],s76 offen offset:2048 sc1
buffer_load_dwordx4 v[84:87],v0,s[8:11],s76 offen offset:3072 sc1
buffer_load_dwordx2 v[120:121],v0,s[8:11],s62 offen offset:0 sc1
buffer_load_dwordx2 v[122:123],v0,s[8:11],s62 offen offset:1024 sc1
buffer_load_dwordx2 v[124:125],v0,s[8:11],s62 offen offset:2048 sc1
buffer_load_dwordx2 v[126:127],v0,s[8:11],s62 offen offset:3072 sc1
v_lshrrev_b32 v244,4,v1
s_sub_u32 s56,s53,7
v_add_u32 v244,s56,v244
v_max_i32 v244,0,v244
v_lshl_add_u32 v244,v244,13,v21
buffer_load_dwordx2 v[242:243],v244,s[8:11],0 offen sc1
v_lshlrev_b32 v200,16,v224
v_and_b32 v201,0xffff0000,v224
v_lshlrev_b32 v202,16,v225
v_and_b32 v203,0xffff0000,v225
v_lshlrev_b32 v204,16,v226
v_and_b32 v205,0xffff0000,v226
v_lshlrev_b32 v206,16,v227
v_and_b32 v207,0xffff0000,v227
s_add_u32 s59,s74,128
s_waitcnt vmcnt(16)
v_mfma_f32_16x16x32_bf16 v[192:195],v[156:159],v[160:163],0
s_waitcnt vmcnt(15)
v_mfma_f32_16x16x32_bf16 v[192:195],v[156:159],v[164:167],v[192:195]
s_waitcnt vmcnt(14)
v_mfma_f32_16x16x32_bf16 v[192:195],v[156:159],v[168:171],v[192:195]
s_waitcnt vmcnt(13)
v_mfma_f32_16x16x32_bf16 v[192:195],v[156:159],v[172:175],v[192:195]
s_waitcnt vmcnt(12)
v_mfma_f32_16x16x32_bf16 v[196:199],v[156:159],v[176:179],0
s_waitcnt vmcnt(11)
v_mfma_f32_16x16x32_bf16 v[196:199],v[156:159],v[180:183],v[196:199]
s_waitcnt vmcnt(10)
v_mfma_f32_16x16x32_bf16 v[196:199],v[156:159],v[184:187],v[196:199]
ds_write_b128 v6,v[192:195]
s_waitcnt vmcnt(9)
v_mfma_f32_16x16x32_bf16 v[196:199],v[156:159],v[188:191],v[196:199]
s_nop 7
ds_write_b128 v6,v[196:199] offset:2048
s_waitcnt lgkmcnt(0)
s_barrier
buffer_store_dword v22,off,s[8:11],s59
s_mov_b32 s88,0
s_branch L_aa_41
L_aa_40:
s_add_u32 s66,s66,1
v_mov_b32 v22,s66
s_waitcnt vmcnt(0)
s_barrier
buffer_store_dword v22,off,s[8:11],s74
s_lshr_b32 s60,s68,1
s_lshl_b32 s60,s60,15
s_add_u32 s60,s60,s69
L_aq_57:
buffer_load_dword v17,v16,s[8:11],s87 offen sc1
s_sub_u32 s49,s49,1
s_cbranch_scc1 L_abort
s_waitcnt vmcnt(0)
v_cmp_gt_u32 vcc,s66,v17
s_cbranch_vccnz L_aq_57
buffer_load_dwordx4 v[160:163],v7,s[8:11],s60 offen sc1
s_add_u32 s60,s60,4096
buffer_load_dwordx4 v[164:167],v7,s[8:11],s60 offen sc1
s_add_u32 s60,s60,4096
buffer_load_dwordx4 v[168:171],v7,s[8:11],s60 offen sc1
s_add_u32 s60,s60,4096
buffer_load_dwordx4 v[172:175],v7,s[8:11],s60 offen sc1
s_add_u32 s60,s60,4096
buffer_load_dwordx4 v[176:179],v7,s[8:11],s60 offen sc1
s_add_u32 s60,s60,4096
buffer_load_dwordx4 v[180:183],v7,s[8:11],s60 offen sc1
s_add_u32 s60,s60,4096
buffer_load_dwordx4 v[184:187],v7,s[8:11],s60 offen sc1
s_add_u32 s60,s60,4096
buffer_load_dwordx4 v[188:191],v7,s[8:11],s60 offen sc1
v_lshlrev_b32 v200,16,v224
v_and_b32 v201,0xffff0000,v224
v_lshlrev_b32 v202,16,v225
v_and_b32 v203,0xffff0000,v225
v_lshlrev_b32 v204,16,v226
v_and_b32 v205,0xffff0000,v226
v_lshlrev_b32 v206,16,v227
v_and_b32 v207,0xffff0000,v227
s_add_u32 s59,s74,128
s_waitcnt vmcnt(7)
v_mfma_f32_16x16x32_bf16 v[192:195],v[156:159],v[160:163],0
s_waitcnt vmcnt(6)
v_mfma_f32_16x16x32_bf16 v[192:195],v[156:159],v[164:167],v[192:195]
s_waitcnt vmcnt(5)
v_mfma_f32_16x16x32_bf16 v[192:195],v[156:159],v[168:171],v[192:195]
s_waitcnt vmcnt(4)
v_mfma_f32_16x16x32_bf16 v[192:195],v[156:159],v[172:175],v[192:195]
s_waitcnt vmcnt(3)
v_mfma_f32_16x16x32_bf16 v[196:199],v[156:159],v[176:179],0
s_waitcnt vmcnt(2)
v_mfma_f32_16x16x32_bf16 v[196:199],v[156:159],v[180:183],v[196:199]
s_waitcnt vmcnt(1)
v_mfma_f32_16x16x32_bf16 v[196:199],v[156:159],v[184:187],v[196:199]
ds_write_b128 v6,v[192:195]
s_waitcnt vmcnt(0)
v_mfma_f32_16x16x32_bf16 v[196:199],v[156:159],v[188:191],v[196:199]
s_nop 7
ds_write_b128 v6,v[196:199] offset:2048
s_waitcnt lgkmcnt(0)
s_barrier
buffer_store_dword v22,off,s[8:11],s59
s_mov_b32 s88,2
L_aa_41:
s_cmp_lg_u32 s31,0
s_cbranch_scc1 L_aa_42
ds_read_b128 v[160:163],v23
ds_read_b128 v[164:167],v23 offset:16
s_lshl_b32 s64,s51,5
s_add_u32 s64,s64,s68
s_lshl_b32 s63,s64,10
s_add_u32 s58,s63,4194304
s_lshl_b32 s57,s46,31
s_xor_b32 s57,s57,0x80000000
s_or_b32 s58,s58,s57
s_waitcnt lgkmcnt(0)
v_cvt_pk_bf16_f32 v168,v160,v161
v_cvt_pk_bf16_f32 v169,v162,v163
v_cvt_pk_bf16_f32 v170,v164,v165
v_cvt_pk_bf16_f32 v171,v166,v167
v_lshlrev_b32 v160,16,v168
v_and_b32 v161,0xffff0000,v168
v_lshlrev_b32 v162,16,v169
v_and_b32 v163,0xffff0000,v169
v_lshlrev_b32 v164,16,v170
v_and_b32 v165,0xffff0000,v170
v_lshlrev_b32 v166,16,v171
v_and_b32 v167,0xffff0000,v171
v_pk_add_f32 v[200:201],v[200:201],v[160:161]
v_pk_add_f32 v[202:203],v[202:203],v[162:163]
v_pk_add_f32 v[204:205],v[204:205],v[164:165]
v_pk_add_f32 v[206:207],v[206:207],v[166:167]
v_cvt_pk_bf16_f32 v168,v200,v201
v_cvt_pk_bf16_f32 v169,v202,v203
v_cvt_pk_bf16_f32 v170,v204,v205
v_cvt_pk_bf16_f32 v171,v206,v207
buffer_store_dwordx4 v[168:171],v0,s[8:11],s58 offen sc1
v_lshlrev_b32 v200,16,v168
v_and_b32 v201,0xffff0000,v168
v_lshlrev_b32 v202,16,v169
v_and_b32 v203,0xffff0000,v169
v_lshlrev_b32 v204,16,v170
v_and_b32 v205,0xffff0000,v170
v_lshlrev_b32 v206,16,v171
v_and_b32 v207,0xffff0000,v171
v_readfirstlane_b32 s78,v200
s_nop 1
v_pk_add_f32 v[184:185],v[200:201],s[78:79] op_sel_hi:[1,0] neg_lo:[0,1] neg_hi:[0,1]
v_pk_add_f32 v[186:187],v[202:203],s[78:79] op_sel_hi:[1,0] neg_lo:[0,1] neg_hi:[0,1]
v_pk_add_f32 v[188:189],v[204:205],s[78:79] op_sel_hi:[1,0] neg_lo:[0,1] neg_hi:[0,1]
v_pk_add_f32 v[190:191],v[206:207],s[78:79] op_sel_hi:[1,0] neg_lo:[0,1] neg_hi:[0,1]
v_pk_add_f32 v[192:193],v[184:185],v[186:187]
v_pk_mul_f32 v[194:195],v[184:185],v[184:185]
v_pk_add_f32 v[196:197],v[188:189],v[190:191]
v_pk_fma_f32 v[194:195],v[186:187],v[186:187],v[194:195]
v_pk_add_f32 v[192:193],v[192:193],v[196:197]
v_pk_fma_f32 v[194:195],v[188:189],v[188:189],v[194:195]
v_add_f32 v192,v192,v193
v_pk_fma_f32 v[194:195],v[190:191],v[190:191],v[194:195]
v_add_f32 v194,v194,v195
s_nop 1
v_permlane32_swap_b32 v192,v194
v_add_f32 v192,v192,v194
s_nop 1
v_add_f32_dpp v192,v192,v192 row_ror:8 row_mask:0xf bank_mask:0xf
s_nop 1
v_add_f32_dpp v192,v192,v192 row_ror:4 row_mask:0xf bank_mask:0xf
s_nop 1
v_add_f32_dpp v192,v192,v192 row_ror:2 row_mask:0xf bank_mask:0xf
s_nop 1
v_add_f32_dpp v192,v192,v192 row_ror:1 row_mask:0xf bank_mask:0xf
v_mov_b32 v194,v192
s_nop 1
v_permlane16_swap_b32 v192,v194
v_add_f32 v192,v192,v194
v_mul_f32 v192,0x3b000000,v192
v_mov_b32 v194,v192
s_nop 1
v_permlane32_swap_b32 v192,v194
v_fma_f32 v194,-v192,v192,v194
v_add_f32 v192,s78,v192
v_max_f32 v194,0,v194
v_cvt_pk_bf16_f32 v194,v192,v194
v_lshlrev_b32 v192,16,v194
v_and_b32 v194,0xffff0000,v194
v_add_f32 v194,0x3727c5ac,v194
v_cvt_pk_bf16_f32 v194,v194,v194
v_and_b32 v194,0xffff0000,v194
v_sqrt_f32 v194,v194
v_pk_add_f32 v[184:185],v[200:201],v[192:193] op_sel_hi:[1,0] neg_lo:[0,1] neg_hi:[0,1]
v_pk_add_f32 v[186:187],v[202:203],v[192:193] op_sel_hi:[1,0] neg_lo:[0,1] neg_hi:[0,1]
v_pk_add_f32 v[188:189],v[204:205],v[192:193] op_sel_hi:[1,0] neg_lo:[0,1] neg_hi:[0,1]
v_pk_add_f32 v[190:191],v[206:207],v[192:193] op_sel_hi:[1,0] neg_lo:[0,1] neg_hi:[0,1]
v_cvt_pk_bf16_f32 v194,v194,v194
v_and_b32 v194,0xffff0000,v194
v_rcp_f32 v194,v194
v_cvt_pk_bf16_f32 v172,v184,v185
v_cvt_pk_bf16_f32 v173,v186,v187
v_cvt_pk_bf16_f32 v174,v188,v189
v_cvt_pk_bf16_f32 v175,v190,v191
v_lshlrev_b32 v184,16,v172
v_and_b32 v185,0xffff0000,v172
v_lshlrev_b32 v186,16,v173
v_and_b32 v187,0xffff0000,v173
v_lshlrev_b32 v188,16,v174
v_and_b32 v189,0xffff0000,v174
v_lshlrev_b32 v190,16,v175
v_and_b32 v191,0xffff0000,v175
v_pk_mul_f32 v[184:185],v[184:185],v[194:195] op_sel_hi:[1,0]
v_pk_mul_f32 v[186:187],v[186:187],v[194:195] op_sel_hi:[1,0]
v_pk_mul_f32 v[188:189],v[188:189],v[194:195] op_sel_hi:[1,0]
v_pk_mul_f32 v[190:191],v[190:191],v[194:195] op_sel_hi:[1,0]
v_cvt_pk_bf16_f32 v172,v184,v185
v_cvt_pk_bf16_f32 v173,v186,v187
v_cvt_pk_bf16_f32 v174,v188,v189
v_cvt_pk_bf16_f32 v175,v190,v191
v_lshlrev_b32 v176,16,v172
v_and_b32 v177,0xffff0000,v172
v_lshlrev_b32 v178,16,v173
v_and_b32 v179,0xffff0000,v173
v_lshlrev_b32 v180,16,v174
v_and_b32 v181,0xffff0000,v174
v_lshlrev_b32 v182,16,v175
v_and_b32 v183,0xffff0000,v175
s_bitcmp1_b32 s46,0
s_cbranch_scc1 L_ak_58
v_pk_add_f32 v[200:201],v[200:201],v[176:177]
v_pk_add_f32 v[202:203],v[202:203],v[178:179]
v_pk_add_f32 v[204:205],v[204:205],v[180:181]
v_pk_add_f32 v[206:207],v[206:207],v[182:183]
v_cvt_pk_bf16_f32 v160,v200,v201
v_cvt_pk_bf16_f32 v161,v202,v203
v_cvt_pk_bf16_f32 v162,v204,v205
v_cvt_pk_bf16_f32 v163,v206,v207
s_add_u32 s58,s63,8388608
buffer_store_dwordx4 v[160:163],v0,s[8:11],s58 offen sc1
v_lshlrev_b32 v200,16,v160
v_and_b32 v201,0xffff0000,v160
v_lshlrev_b32 v202,16,v161
v_and_b32 v203,0xffff0000,v161
v_lshlrev_b32 v204,16,v162
v_and_b32 v205,0xffff0000,v162
v_lshlrev_b32 v206,16,v163
v_and_b32 v207,0xffff0000,v163
v_readfirstlane_b32 s78,v200
s_nop 1
v_pk_add_f32 v[184:185],v[200:201],s[78:79] op_sel_hi:[1,0] neg_lo:[0,1] neg_hi:[0,1]
v_pk_add_f32 v[186:187],v[202:203],s[78:79] op_sel_hi:[1,0] neg_lo:[0,1] neg_hi:[0,1]
v_pk_add_f32 v[188:189],v[204:205],s[78:79] op_sel_hi:[1,0] neg_lo:[0,1] neg_hi:[0,1]
v_pk_add_f32 v[190:191],v[206:207],s[78:79] op_sel_hi:[1,0] neg_lo:[0,1] neg_hi:[0,1]
v_pk_add_f32 v[192:193],v[184:185],v[186:187]
v_pk_mul_f32 v[194:195],v[184:185],v[184:185]
v_pk_add_f32 v[196:197],v[188:189],v[190:191]
v_pk_fma_f32 v[194:195],v[186:187],v[186:187],v[194:195]
v_pk_add_f32 v[192:193],v[192:193],v[196:197]
v_pk_fma_f32 v[194:195],v[188:189],v[188:189],v[194:195]
v_add_f32 v192,v192,v193
v_pk_fma_f32 v[194:195],v[190:191],v[190:191],v[194:195]
v_add_f32 v194,v194,v195
s_nop 1
v_permlane32_swap_b32 v192,v194
v_add_f32 v192,v192,v194
s_nop 1
v_add_f32_dpp v192,v192,v192 row_ror:8 row_mask:0xf bank_mask:0xf
s_nop 1
v_add_f32_dpp v192,v192,v192 row_ror:4 row_mask:0xf bank_mask:0xf
s_nop 1
v_add_f32_dpp v192,v192,v192 row_ror:2 row_mask:0xf bank_mask:0xf
s_nop 1
v_add_f32_dpp v192,v192,v192 row_ror:1 row_mask:0xf bank_mask:0xf
v_mov_b32 v194,v192
s_nop 1
v_permlane16_swap_b32 v192,v194
v_add_f32 v192,v192,v194
v_mul_f32 v192,0x3b000000,v192
v_mov_b32 v194,v192
s_nop 1
v_permlane32_swap_b32 v192,v194
v_fma_f32 v194,-v192,v192,v194
v_add_f32 v192,s78,v192
v_max_f32 v194,0,v194
v_cvt_pk_bf16_f32 v194,v192,v194
v_lshlrev_b32 v192,16,v194
v_and_b32 v194,0xffff0000,v194
v_add_f32 v194,0x3727c5ac,v194
v_cvt_pk_bf16_f32 v194,v194,v194
v_and_b32 v194,0xffff0000,v194
v_sqrt_f32 v194,v194
v_pk_add_f32 v[184:185],v[200:201],v[192:193] op_sel_hi:[1,0] neg_lo:[0,1] neg_hi:[0,1]
v_pk_add_f32 v[186:187],v[202:203],v[192:193] op_sel_hi:[1,0] neg_lo:[0,1] neg_hi:[0,1]
v_pk_add_f32 v[188:189],v[204:205],v[192:193] op_sel_hi:[1,0] neg_lo:[0,1] neg_hi:[0,1]
v_pk_add_f32 v[190:191],v[206:207],v[192:193] op_sel_hi:[1,0] neg_lo:[0,1] neg_hi:[0,1]
v_cvt_pk_bf16_f32 v194,v194,v194
v_and_b32 v194,0xffff0000,v194
v_rcp_f32 v194,v194
v_cvt_pk_bf16_f32 v164,v184,v185
v_cvt_pk_bf16_f32 v165,v186,v187
v_cvt_pk_bf16_f32 v166,v188,v189
v_cvt_pk_bf16_f32 v167,v190,v191
v_lshlrev_b32 v184,16,v164
v_and_b32 v185,0xffff0000,v164
v_lshlrev_b32 v186,16,v165
v_and_b32 v187,0xffff0000,v165
v_lshlrev_b32 v188,16,v166
v_and_b32 v189,0xffff0000,v166
v_lshlrev_b32 v190,16,v167
v_and_b32 v191,0xffff0000,v167
v_pk_mul_f32 v[184:185],v[184:185],v[194:195] op_sel_hi:[1,0]
v_pk_mul_f32 v[186:187],v[186:187],v[194:195] op_sel_hi:[1,0]
v_pk_mul_f32 v[188:189],v[188:189],v[194:195] op_sel_hi:[1,0]
v_pk_mul_f32 v[190:191],v[190:191],v[194:195] op_sel_hi:[1,0]
v_cvt_pk_bf16_f32 v164,v184,v185
v_cvt_pk_bf16_f32 v165,v186,v187
v_cvt_pk_bf16_f32 v166,v188,v189
v_cvt_pk_bf16_f32 v167,v190,v191
s_add_u32 s58,s63,2097152
buffer_store_dwordx4 v[164:167],v0,s[8:11],s58 offen sc1
v_mov_b32 v20,1
s_lshl_b32 s73,s51,13
s_lshl2_add_u32 s73,s68,s73
s_add_u32 s73,s73,10487552
s_branch L_aa_43
L_ak_58:
v_pk_mul_f32 v[236:237],v[176:177],v[228:229]
v_pk_fma_f32 v[236:237],v[178:179],v[230:231],v[236:237]
v_pk_fma_f32 v[236:237],v[180:181],v[232:233],v[236:237]
v_pk_fma_f32 v[236:237],v[182:183],v[234:235],v[236:237]
v_add_f32 v236,v236,v237
s_nop 1
v_add_f32_dpp v236,v236,v236 row_ror:8 row_mask:0xf bank_mask:0xf
s_nop 1
v_add_f32_dpp v236,v236,v236 row_ror:4 row_mask:0xf bank_mask:0xf
s_nop 1
v_add_f32_dpp v236,v236,v236 row_ror:2 row_mask:0xf bank_mask:0xf
s_nop 1
v_add_f32_dpp v236,v236,v236 row_ror:1 row_mask:0xf bank_mask:0xf
v_mov_b32 v237,v236
s_nop 1
v_permlane16_swap_b32 v236,v237
v_add_f32 v236,v236,v237
v_mov_b32 v237,v236
s_nop 1
v_permlane32_swap_b32 v236,v237
v_add_f32 v236,v236,v237
v_cvt_pk_bf16_f32 v236,v236,v236
v_and_b32 v236,0xffff0000,v236
v_ashrrev_i32 v237,31,v236
v_or_b32 v237,0x80000000,v237
v_xor_b32 v236,v236,v237
v_and_b32 v236,0xffff0000,v236
s_sub_u32 s58,4095,s64
v_or_b32 v20,s58,v236
s_lshl_b32 s58,s51,13
s_lshl2_add_u32 s58,s68,s58
s_add_u32 s58,s58,10487168
buffer_store_dword v20,off,s[8:11],s58 sc1
s_branch L_aa_43
L_aa_42:
s_bitcmp1_b32 s46,0
s_cbranch_scc1 L_aa_43
ds_read_b128 v[160:163],v23
ds_read_b128 v[164:167],v23 offset:16
s_lshl_b32 s64,s51,5
s_add_u32 s64,s64,s68
s_lshl_b32 s63,s64,10
s_add_u32 s58,s63,6291456
v_readfirstlane_b32 s61,v246
s_cmp_lg_u32 s61,0
s_cbranch_scc1 L_ag_60
s_cmp_eq_u32 s86,1536
s_cbranch_scc1 L_ag_60
s_cmp_ge_i32 s51,56
s_cbranch_scc1 L_ag_60
s_lshl_b32 s60,s51,13
s_lshl2_add_u32 s60,s68,s60
s_add_u32 s60,s60,10487296
L_ww_61:
buffer_load_dword v246,off,s[8:11],s60 sc1
s_sub_u32 s49,s49,1
s_cbranch_scc1 L_abort
s_waitcnt vmcnt(0)
v_readfirstlane_b32 s61,v246
s_cmp_eq_u32 s61,0
s_cbranch_scc1 L_ww_61
L_wwd_62:
L_ag_60:
s_waitcnt lgkmcnt(0)
v_cvt_pk_bf16_f32 v168,v160,v161
v_cvt_pk_bf16_f32 v169,v162,v163
v_cvt_pk_bf16_f32 v170,v164,v165
v_cvt_pk_bf16_f32 v171,v166,v167
v_lshlrev_b32 v160,16,v168
v_and_b32 v161,0xffff0000,v168
v_lshlrev_b32 v162,16,v169
v_and_b32 v163,0xffff0000,v169
v_lshlrev_b32 v164,16,v170
v_and_b32 v165,0xffff0000,v170
v_lshlrev_b32 v166,16,v171
v_and_b32 v167,0xffff0000,v171
v_pk_add_f32 v[200:201],v[200:201],v[160:161]
v_pk_add_f32 v[202:203],v[202:203],v[162:163]
v_pk_add_f32 v[204:205],v[204:205],v[164:165]
v_pk_add_f32 v[206:207],v[206:207],v[166:167]
v_cvt_pk_bf16_f32 v168,v200,v201
v_cvt_pk_bf16_f32 v169,v202,v203
v_cvt_pk_bf16_f32 v170,v204,v205
v_cvt_pk_bf16_f32 v171,v206,v207
buffer_store_dwordx4 v[168:171],v0,s[8:11],s58 offen sc1
v_lshlrev_b32 v200,16,v168
v_and_b32 v201,0xffff0000,v168
v_lshlrev_b32 v202,16,v169
v_and_b32 v203,0xffff0000,v169
v_lshlrev_b32 v204,16,v170
v_and_b32 v205,0xffff0000,v170
v_lshlrev_b32 v206,16,v171
v_and_b32 v207,0xffff0000,v171
v_readfirstlane_b32 s78,v200
s_nop 1
v_pk_add_f32 v[184:185],v[200:201],s[78:79] op_sel_hi:[1,0] neg_lo:[0,1] neg_hi:[0,1]
v_pk_add_f32 v[186:187],v[202:203],s[78:79] op_sel_hi:[1,0] neg_lo:[0,1] neg_hi:[0,1]
v_pk_add_f32 v[188:189],v[204:205],s[78:79] op_sel_hi:[1,0] neg_lo:[0,1] neg_hi:[0,1]
v_pk_add_f32 v[190:191],v[206:207],s[78:79] op_sel_hi:[1,0] neg_lo:[0,1] neg_hi:[0,1]
v_pk_add_f32 v[192:193],v[184:185],v[186:187]
v_pk_mul_f32 v[194:195],v[184:185],v[184:185]
v_pk_add_f32 v[196:197],v[188:189],v[190:191]
v_pk_fma_f32 v[194:195],v[186:187],v[186:187],v[194:195]
v_pk_add_f32 v[192:193],v[192:193],v[196:197]
v_pk_fma_f32 v[194:195],v[188:189],v[188:189],v[194:195]
v_add_f32 v192,v192,v193
v_pk_fma_f32 v[194:195],v[190:191],v[190:191],v[194:195]
v_add_f32 v194,v194,v195
s_nop 1
v_permlane32_swap_b32 v192,v194
v_add_f32 v192,v192,v194
s_nop 1
v_add_f32_dpp v192,v192,v192 row_ror:8 row_mask:0xf bank_mask:0xf
s_nop 1
v_add_f32_dpp v192,v192,v192 row_ror:4 row_mask:0xf bank_mask:0xf
s_nop 1
v_add_f32_dpp v192,v192,v192 row_ror:2 row_mask:0xf bank_mask:0xf
s_nop 1
v_add_f32_dpp v192,v192,v192 row_ror:1 row_mask:0xf bank_mask:0xf
v_mov_b32 v194,v192
s_nop 1
v_permlane16_swap_b32 v192,v194
v_add_f32 v192,v192,v194
v_mul_f32 v192,0x3b000000,v192
v_mov_b32 v194,v192
s_nop 1
v_permlane32_swap_b32 v192,v194
v_fma_f32 v194,-v192,v192,v194
v_add_f32 v192,s78,v192
v_max_f32 v194,0,v194
v_cvt_pk_bf16_f32 v194,v192,v194
v_lshlrev_b32 v192,16,v194
v_and_b32 v194,0xffff0000,v194
v_add_f32 v194,0x3727c5ac,v194
v_cvt_pk_bf16_f32 v194,v194,v194
v_and_b32 v194,0xffff0000,v194
v_sqrt_f32 v194,v194
v_pk_add_f32 v[184:185],v[200:201],v[192:193] op_sel_hi:[1,0] neg_lo:[0,1] neg_hi:[0,1]
v_pk_add_f32 v[186:187],v[202:203],v[192:193] op_sel_hi:[1,0] neg_lo:[0,1] neg_hi:[0,1]
v_pk_add_f32 v[188:189],v[204:205],v[192:193] op_sel_hi:[1,0] neg_lo:[0,1] neg_hi:[0,1]
v_pk_add_f32 v[190:191],v[206:207],v[192:193] op_sel_hi:[1,0] neg_lo:[0,1] neg_hi:[0,1]
v_cvt_pk_bf16_f32 v194,v194,v194
v_and_b32 v194,0xffff0000,v194
v_rcp_f32 v194,v194
v_cvt_pk_bf16_f32 v172,v184,v185
v_cvt_pk_bf16_f32 v173,v186,v187
v_cvt_pk_bf16_f32 v174,v188,v189
v_cvt_pk_bf16_f32 v175,v190,v191
v_lshlrev_b32 v184,16,v172
v_and_b32 v185,0xffff0000,v172
v_lshlrev_b32 v186,16,v173
v_and_b32 v187,0xffff0000,v173
v_lshlrev_b32 v188,16,v174
v_and_b32 v189,0xffff0000,v174
v_lshlrev_b32 v190,16,v175
v_and_b32 v191,0xffff0000,v175
v_pk_mul_f32 v[184:185],v[184:185],v[194:195] op_sel_hi:[1,0]
v_pk_mul_f32 v[186:187],v[186:187],v[194:195] op_sel_hi:[1,0]
v_pk_mul_f32 v[188:189],v[188:189],v[194:195] op_sel_hi:[1,0]
v_pk_mul_f32 v[190:191],v[190:191],v[194:195] op_sel_hi:[1,0]
v_cvt_pk_bf16_f32 v172,v184,v185
v_cvt_pk_bf16_f32 v173,v186,v187
v_cvt_pk_bf16_f32 v174,v188,v189
v_cvt_pk_bf16_f32 v175,v190,v191
v_lshlrev_b32 v176,16,v172
v_and_b32 v177,0xffff0000,v172
v_lshlrev_b32 v178,16,v173
v_and_b32 v179,0xffff0000,v173
v_lshlrev_b32 v180,16,v174
v_and_b32 v181,0xffff0000,v174
v_lshlrev_b32 v182,16,v175
v_and_b32 v183,0xffff0000,v175
v_pk_add_f32 v[200:201],v[200:201],v[176:177]
v_pk_add_f32 v[202:203],v[202:203],v[178:179]
v_pk_add_f32 v[204:205],v[204:205],v[180:181]
v_pk_add_f32 v[206:207],v[206:207],v[182:183]
v_cvt_pk_bf16_f32 v160,v200,v201
v_cvt_pk_bf16_f32 v161,v202,v203
v_cvt_pk_bf16_f32 v162,v204,v205
v_cvt_pk_bf16_f32 v163,v206,v207
s_mov_b32 s4,s40
s_mov_b32 s5,s41
s_mov_b32 s6,2097152
s_mov_b32 s7,0x20000
buffer_store_dwordx4 v[160:163],v0,s[4:7],s63 offen sc1
v_pk_mul_f32 v[236:237],v[176:177],v[228:229]
v_pk_fma_f32 v[236:237],v[178:179],v[230:231],v[236:237]
v_pk_fma_f32 v[236:237],v[180:181],v[232:233],v[236:237]
v_pk_fma_f32 v[236:237],v[182:183],v[234:235],v[236:237]
v_add_f32 v236,v236,v237
s_nop 1
v_add_f32_dpp v236,v236,v236 row_ror:8 row_mask:0xf bank_mask:0xf
s_nop 1
v_add_f32_dpp v236,v236,v236 row_ror:4 row_mask:0xf bank_mask:0xf
s_nop 1
v_add_f32_dpp v236,v236,v236 row_ror:2 row_mask:0xf bank_mask:0xf
s_nop 1
v_add_f32_dpp v236,v236,v236 row_ror:1 row_mask:0xf bank_mask:0xf
v_mov_b32 v237,v236
s_nop 1
v_permlane16_swap_b32 v236,v237
v_add_f32 v236,v236,v237
v_mov_b32 v237,v236
s_nop 1
v_permlane32_swap_b32 v236,v237
v_add_f32 v236,v236,v237
v_cvt_pk_bf16_f32 v236,v236,v236
v_and_b32 v236,0xffff0000,v236
v_ashrrev_i32 v237,31,v236
v_or_b32 v237,0x80000000,v237
v_xor_b32 v236,v236,v237
v_and_b32 v236,0xffff0000,v236
s_sub_u32 s58,4095,s64
v_or_b32 v20,s58,v236
s_lshl_b32 s73,s51,13
s_lshl2_add_u32 s73,s68,s73
s_add_u32 s73,s73,10485760
s_add_u32 s73,s73,s86
L_aa_43:
s_cmp_eq_u32 s88,1
s_cbranch_scc1 L_aa_45
s_cmp_eq_u32 s88,0
s_cbranch_scc1 L_aa_44
s_cmp_ge_u32 s77,64
s_cbranch_scc1 L_aa_48
L_aa_46:
s_waitcnt vmcnt(0)
buffer_store_dword v20,off,s[8:11],s73 sc1
s_mov_b32 s73,0x80000000
L_aw_63:
v_cmp_eq_u32 vcc,0,v18
s_cbranch_vccz L_awd_64
buffer_load_dword v18,v19,s[8:11],0 offen sc1
s_sub_u32 s49,s49,1
s_cbranch_scc1 L_abort
s_waitcnt vmcnt(0)
s_branch L_aw_63
L_awd_64:
s_mov_b32 s64,s70
s_cmp_eq_u32 s30,0
s_cselect_b32 s65,0x80000000,s71
s_and_b32 s57,s46,1
s_mul_i32 s58,s57,12288
s_add_u32 s64,s64,s58
s_lshl_b32 s57,s57,12
s_add_u32 s65,s65,s57
s_and_b32 s59,s50,2048
s_lshl_b32 s59,s59,4
s_xor_b32 s60,s67,65536
s_add_u32 s59,s59,s60
s_add_u32 s58,s58,s59
s_add_u32 s57,s57,s59
s_add_u32 m0,s58,0
s_nop 0
buffer_load_dwordx4 v0,s[8:11],s64 offen offset:0 sc1 lds
buffer_load_dwordx4 v0,s[8:11],s64 offen offset:1024 sc1 lds
buffer_load_dwordx4 v0,s[8:11],s64 offen offset:2048 sc1 lds
buffer_load_dwordx4 v0,s[8:11],s64 offen offset:3072 sc1 lds
s_add_u32 m0,s58,4096
s_add_u32 s64,s64,4096
buffer_load_dwordx4 v0,s[8:11],s64 offen offset:0 sc1 lds
buffer_load_dwordx4 v0,s[8:11],s64 offen offset:1024 sc1 lds
buffer_load_dwordx4 v0,s[8:11],s64 offen offset:2048 sc1 lds
buffer_load_dwordx4 v0,s[8:11],s64 offen offset:3072 sc1 lds
s_add_u32 m0,s58,8192
s_add_u32 s64,s64,4096
buffer_load_dwordx4 v0,s[8:11],s64 offen offset:0 sc1 lds
buffer_load_dwordx4 v0,s[8:11],s64 offen offset:1024 sc1 lds
buffer_load_dwordx4 v0,s[8:11],s64 offen offset:2048 sc1 lds
buffer_load_dwordx4 v0,s[8:11],s64 offen offset:3072 sc1 lds
s_add_u32 m0,s57,24576
s_nop 0
buffer_load_dwordx4 v0,s[8:11],s65 offen offset:0 sc1 lds
buffer_load_dwordx4 v0,s[8:11],s65 offen offset:1024 sc1 lds
buffer_load_dwordx4 v0,s[8:11],s65 offen offset:2048 sc1 lds
buffer_load_dwordx4 v0,s[8:11],s65 offen offset:3072 sc1 lds
s_waitcnt vmcnt(0)
s_barrier
s_cmp_eq_u32 s30,0
s_cbranch_scc1 L_aa_47
s_xor_b32 s67,s67,65536
s_and_b32 s56,s50,2048
s_lshl_b32 s56,s56,4
s_add_u32 s56,s56,s67
v_add_u32 v2,s56,v0
s_and_b32 s56,s50,1024
s_lshl_b32 s56,s56,2
v_add_u32 v238,s56,v2
s_mov_b32 s76,s71
s_mov_b32 s53,s77
ds_read_b128 v[24:27],v238 offset:16384
ds_read_b128 v[40:43],v2 offset:0
ds_read_b128 v[56:59],v2 offset:4096
ds_read_b128 v[28:31],v238 offset:17408
ds_read_b128 v[44:47],v2 offset:1024
ds_read_b128 v[60:63],v2 offset:5120
ds_read_b128 v[32:35],v238 offset:18432
ds_read_b128 v[48:51],v2 offset:2048
ds_read_b128 v[64:67],v2 offset:6144
ds_read_b128 v[36:39],v238 offset:19456
ds_read_b128 v[52:55],v2 offset:3072
ds_read_b128 v[68:71],v2 offset:7168
s_waitcnt lgkmcnt(9)
v_mfma_f32_16x16x32_bf16 v[128:131],v[40:43],v[24:27],v[8:11]
ds_read_b128 v[72:75],v2 offset:24576
v_mfma_f32_16x16x32_bf16 v[132:135],v[56:59],v[24:27],v[12:15]
ds_read_b128 v[76:79],v2 offset:25600
s_waitcnt lgkmcnt(8)
v_mfma_f32_16x16x32_bf16 v[128:131],v[44:47],v[28:31],v[128:131]
ds_read_b128 v[80:83],v2 offset:26624
v_mfma_f32_16x16x32_bf16 v[132:135],v[60:63],v[28:31],v[132:135]
ds_read_b128 v[84:87],v2 offset:27648
s_waitcnt lgkmcnt(7)
v_mfma_f32_16x16x32_bf16 v[128:131],v[48:51],v[32:35],v[128:131]
ds_read_b128 v[88:91],v2 offset:8192
v_mfma_f32_16x16x32_bf16 v[132:135],v[64:67],v[32:35],v[132:135]
ds_read_b128 v[92:95],v2 offset:9216
s_waitcnt lgkmcnt(6)
v_mfma_f32_16x16x32_bf16 v[128:131],v[52:55],v[36:39],v[128:131]
ds_read_b128 v[96:99],v2 offset:10240
v_mfma_f32_16x16x32_bf16 v[132:135],v[68:71],v[36:39],v[132:135]
ds_read_b128 v[100:103],v2 offset:11264
s_waitcnt lgkmcnt(4)
v_mfma_f32_16x16x32_bf16 v[136:139],v[72:75],v[24:27],0
ds_read_b128 v[104:107],v2 offset:12288
ds_read_b128 v[108:111],v2 offset:13312
v_mfma_f32_16x16x32_bf16 v[136:139],v[76:79],v[28:31],v[136:139]
ds_read_b128 v[112:115],v2 offset:14336
ds_read_b128 v[116:119],v2 offset:15360
v_mfma_f32_16x16x32_bf16 v[136:139],v[80:83],v[32:35],v[136:139]
ds_read_b64 v[120:121],v2 offset:28672
ds_read_b64 v[122:123],v2 offset:29696
v_mfma_f32_16x16x32_bf16 v[136:139],v[84:87],v[36:39],v[136:139]
ds_read_b64 v[124:125],v2 offset:30720
ds_read_b64 v[126:127],v2 offset:31744
s_cmp_lg_u32 s86,1536
s_cbranch_scc1 L_ae_65
s_add_u32 s77,s53,12
s_mov_b32 s30,0
s_lshl_b32 s56,s77,5
s_add_u32 s56,s56,s68
s_mul_i32 s70,s56,24576
s_lshl_b32 s71,s56,13
s_add_u32 s70,s70,100663296
s_add_u32 s71,s71,41943040
s_lshl_b32 s59,s77,13
s_lshl2_add_u32 s59,s68,s59
s_add_u32 s59,s59,10485760
v_mov_b32 v19,s59
buffer_load_dword v18,v19,s[8:11],0 offen sc1
s_branch L_af_66
L_ae_65:
s_ff1_i32_b64 s77,s[84:85]
s_bitset0_b64 s[84:85],s77
s_ff1_i32_b64 s77,s[84:85]
s_bitset0_b64 s[84:85],s77
s_ff1_i32_b64 s77,s[84:85]
s_bitset0_b64 s[84:85],s77
s_ff1_i32_b64 s77,s[84:85]
s_bitset0_b64 s[84:85],s77
s_ff1_i32_b64 s77,s[84:85]
s_bitset0_b64 s[84:85],s77
s_ff1_i32_b64 s77,s[84:85]
s_bitset0_b64 s[84:85],s77
s_min_u32 s77,s77,64
s_lshr_b32 s61,s55,5
s_lshl_b32 s56,s77,5
s_add_u32 s56,s56,s68
s_mul_i32 s70,s56,24576
s_lshl_b32 s71,s56,13
s_lshl_b32 s59,s77,13
s_lshl2_add_u32 s59,s68,s59
s_add_u32 s59,s59,10485760
s_cmp_lt_u32 s77,s61
s_cselect_b32 s57,0,16777216
s_cselect_b32 s60,0,128
s_add_u32 s71,s71,s57
s_add_u32 s71,s71,58720256
s_add_u32 s60,s60,s59
s_add_u32 s60,s60,512
s_cmp_eq_u32 s77,s61
s_cselect_b32 s57,50331648,0
s_cselect_b32 s58,1536,0
s_add_u32 s70,s70,s57
s_add_u32 s70,s70,150994944
s_add_u32 s59,s59,s58
s_add_u32 s59,s59,384
v_mov_b32 v19,s59
v_writelane_b32 v19,s60,1
buffer_load_dword v18,v19,s[8:11],0 offen sc1
L_af_66:
v_max3_f32 v238,v128,v129,v130
v_max3_f32 v239,v131,v132,v133
v_max3_f32 v238,v134,v135,v238
v_max3_f32 v239,v138,v139,v239
v_max_f32 v238,v238,v239
v_max_f32 v239,v238,v239
s_nop 1
v_permlane16_swap_b32 v238,v239
v_max_f32 v238,v238,v239
v_max_f32 v239,v238,v239
s_nop 1
v_permlane32_swap_b32 v238,v239
v_max_f32 v238,v238,v239
v_mul_f32 v238,s80,v238
v_fma_f32 v128,v128,s80,-v238
v_fma_f32 v129,v129,s80,-v238
v_exp_f32 v128,v128
v_fma_f32 v130,v130,s80,-v238
v_exp_f32 v129,v129
v_fma_f32 v131,v131,s80,-v238
v_exp_f32 v130,v130
v_fma_f32 v132,v132,s80,-v238
v_exp_f32 v131,v131
v_fma_f32 v133,v133,s80,-v238
v_exp_f32 v132,v132
v_fma_f32 v134,v134,s80,-v238
v_exp_f32 v133,v133
v_fma_f32 v135,v135,s80,-v238
v_exp_f32 v134,v134
v_fma_f32 v138,v138,s80,-v238
v_exp_f32 v135,v135
v_fma_f32 v139,v139,s80,-v238
v_exp_f32 v138,v138
v_exp_f32 v139,v139
v_cvt_pk_bf16_f32 v140,v128,v129
v_cvt_pk_bf16_f32 v141,v130,v131
v_cvt_pk_bf16_f32 v142,v132,v133
v_cvt_pk_bf16_f32 v143,v134,v135
v_cvt_pk_bf16_f32 v144,v138,v139
v_mov_b32 v147,v144
s_waitcnt lgkmcnt(0)
v_mfma_f32_16x16x32_bf16 v[148:151],v[152:155],v[140:143],0
v_mfma_f32_16x16x32_bf16 v[24:27],v[88:91],v[140:143],0
v_mfma_f32_16x16x32_bf16 v[28:31],v[92:95],v[140:143],0
v_mfma_f32_16x16x16_bf16 v[148:151],v[152:153],v[144:145],v[148:151]
v_mfma_f32_16x16x32_bf16 v[32:35],v[96:99],v[140:143],0
v_mfma_f32_16x16x32_bf16 v[36:39],v[100:103],v[140:143],0
v_mfma_f32_16x16x32_bf16 v[40:43],v[104:107],v[140:143],0
v_mfma_f32_16x16x32_bf16 v[44:47],v[108:111],v[140:143],0
v_mfma_f32_16x16x32_bf16 v[48:51],v[112:115],v[140:143],0
v_mfma_f32_16x16x32_bf16 v[52:55],v[116:119],v[140:143],0
v_rcp_f32 v148,v148
v_mfma_f32_16x16x16_bf16 v[24:27],v[120:121],v[144:145],v[24:27]
v_mfma_f32_16x16x16_bf16 v[28:31],v[120:121],v[146:147],v[28:31]
v_mfma_f32_16x16x16_bf16 v[32:35],v[122:123],v[144:145],v[32:35]
v_mfma_f32_16x16x16_bf16 v[36:39],v[122:123],v[146:147],v[36:39]
v_mfma_f32_16x16x16_bf16 v[40:43],v[124:125],v[144:145],v[40:43]
v_pk_mul_f32 v[24:25],v[24:25],v[148:149] op_sel_hi:[1,0]
v_pk_mul_f32 v[26:27],v[26:27],v[148:149] op_sel_hi:[1,0]
v_mfma_f32_16x16x16_bf16 v[44:47],v[124:125],v[146:147],v[44:47]
v_pk_mul_f32 v[28:29],v[28:29],v[148:149] op_sel_hi:[1,0]
v_pk_mul_f32 v[30:31],v[30:31],v[148:149] op_sel_hi:[1,0]
v_mfma_f32_16x16x16_bf16 v[48:51],v[126:127],v[144:145],v[48:51]
v_cvt_pk_bf16_f32 v72,v24,v28
v_cvt_pk_bf16_f32 v73,v25,v29
v_mfma_f32_16x16x16_bf16 v[52:55],v[126:127],v[146:147],v[52:55]
v_cvt_pk_bf16_f32 v74,v26,v30
v_cvt_pk_bf16_f32 v75,v27,v31
ds_write_b128 v3,v[72:75] offset:0
v_pk_mul_f32 v[32:33],v[32:33],v[148:149] op_sel_hi:[1,0]
v_pk_mul_f32 v[34:35],v[34:35],v[148:149] op_sel_hi:[1,0]
v_pk_mul_f32 v[36:37],v[36:37],v[148:149] op_sel_hi:[1,0]
v_pk_mul_f32 v[38:39],v[38:39],v[148:149] op_sel_hi:[1,0]
v_cvt_pk_bf16_f32 v76,v32,v36
v_cvt_pk_bf16_f32 v77,v33,v37
v_cvt_pk_bf16_f32 v78,v34,v38
v_cvt_pk_bf16_f32 v79,v35,v39
ds_write_b128 v3,v[76:79] offset:1024
v_pk_mul_f32 v[40:41],v[40:41],v[148:149] op_sel_hi:[1,0]
v_pk_mul_f32 v[42:43],v[42:43],v[148:149] op_sel_hi:[1,0]
v_pk_mul_f32 v[44:45],v[44:45],v[148:149] op_sel_hi:[1,0]
v_pk_mul_f32 v[46:47],v[46:47],v[148:149] op_sel_hi:[1,0]
v_cvt_pk_bf16_f32 v80,v40,v44
v_cvt_pk_bf16_f32 v81,v41,v45
v_cvt_pk_bf16_f32 v82,v42,v46
v_cvt_pk_bf16_f32 v83,v43,v47
ds_write_b128 v3,v[80:83] offset:2048
v_pk_mul_f32 v[48:49],v[48:49],v[148:149] op_sel_hi:[1,0]
v_pk_mul_f32 v[50:51],v[50:51],v[148:149] op_sel_hi:[1,0]
v_pk_mul_f32 v[52:53],v[52:53],v[148:149] op_sel_hi:[1,0]
v_pk_mul_f32 v[54:55],v[54:55],v[148:149] op_sel_hi:[1,0]
v_cvt_pk_bf16_f32 v84,v48,v52
v_cvt_pk_bf16_f32 v85,v49,v53
v_cvt_pk_bf16_f32 v86,v50,v54
v_cvt_pk_bf16_f32 v87,v51,v55
ds_write_b128 v3,v[84:87] offset:3072
s_waitcnt vmcnt(0)
v_cmp_eq_u32 vcc,0,v18
s_lshl_b32 s56,s46,2
s_add_u32 s56,s56,155648
v_mov_b32 v238,s56
s_cmp_lg_u64 vcc,0
s_cselect_b32 s72,1,0
s_cmp_ge_u32 s77,64
s_cselect_b32 s72,1,s72
v_mov_b32 v239,s72
ds_write_b32 v238,v239
s_waitcnt lgkmcnt(0)
s_barrier
L_aa_45:
s_mov_b32 s51,s53
s_mov_b32 s31,1
s_branch L_aa_38
L_aa_47:
s_xor_b32 s67,s67,65536
s_and_b32 s56,s50,2048
s_lshl_b32 s56,s56,4
s_add_u32 s56,s56,s67
v_add_u32 v2,s56,v0
s_and_b32 s56,s50,1024
s_lshl_b32 s56,s56,2
v_add_u32 v238,s56,v2
s_mov_b32 s76,s71
s_mov_b32 s53,s77
ds_read_b128 v[24:27],v238 offset:16384
ds_read_b128 v[40:43],v2 offset:0
ds_read_b128 v[56:59],v2 offset:4096
ds_read_b128 v[28:31],v238 offset:17408
ds_read_b128 v[44:47],v2 offset:1024
ds_read_b128 v[60:63],v2 offset:5120
ds_read_b128 v[32:35],v238 offset:18432
ds_read_b128 v[48:51],v2 offset:2048
ds_read_b128 v[64:67],v2 offset:6144
ds_read_b128 v[36:39],v238 offset:19456
ds_read_b128 v[52:55],v2 offset:3072
ds_read_b128 v[68:71],v2 offset:7168
s_waitcnt lgkmcnt(9)
v_mfma_f32_16x16x32_bf16 v[128:131],v[40:43],v[24:27],v[8:11]
ds_read_b128 v[88:91],v2 offset:8192
v_mfma_f32_16x16x32_bf16 v[132:135],v[56:59],v[24:27],v[12:15]
ds_read_b128 v[92:95],v2 offset:9216
s_waitcnt lgkmcnt(8)
v_mfma_f32_16x16x32_bf16 v[128:131],v[44:47],v[28:31],v[128:131]
ds_read_b128 v[96:99],v2 offset:10240
v_mfma_f32_16x16x32_bf16 v[132:135],v[60:63],v[28:31],v[132:135]
ds_read_b128 v[100:103],v2 offset:11264
s_waitcnt lgkmcnt(7)
v_mfma_f32_16x16x32_bf16 v[128:131],v[48:51],v[32:35],v[128:131]
ds_read_b128 v[104:107],v2 offset:12288
v_mfma_f32_16x16x32_bf16 v[132:135],v[64:67],v[32:35],v[132:135]
ds_read_b128 v[108:111],v2 offset:13312
s_waitcnt lgkmcnt(6)
v_mfma_f32_16x16x32_bf16 v[128:131],v[52:55],v[36:39],v[128:131]
ds_read_b128 v[112:115],v2 offset:14336
v_mfma_f32_16x16x32_bf16 v[132:135],v[68:71],v[36:39],v[132:135]
ds_read_b128 v[116:119],v2 offset:15360
s_add_u32 s62,s76,4096
buffer_load_dwordx4 v[72:75],v0,s[8:11],s76 offen offset:0 sc1
buffer_load_dwordx4 v[76:79],v0,s[8:11],s76 offen offset:1024 sc1
buffer_load_dwordx4 v[80:83],v0,s[8:11],s76 offen offset:2048 sc1
buffer_load_dwordx4 v[84:87],v0,s[8:11],s76 offen offset:3072 sc1
buffer_load_dwordx2 v[120:121],v0,s[8:11],s62 offen offset:0 sc1
buffer_load_dwordx2 v[122:123],v0,s[8:11],s62 offen offset:1024 sc1
buffer_load_dwordx2 v[124:125],v0,s[8:11],s62 offen offset:2048 sc1
buffer_load_dwordx2 v[126:127],v0,s[8:11],s62 offen offset:3072 sc1
v_lshrrev_b32 v244,4,v1
s_sub_u32 s56,s53,7
v_add_u32 v244,s56,v244
v_max_i32 v244,0,v244
v_lshl_add_u32 v244,v244,13,v21
buffer_load_dwordx2 v[242:243],v244,s[8:11],0 offen sc1
s_mov_b32 s31,0
L_aa_44:
s_mov_b32 s51,s53
s_waitcnt vmcnt(3)
s_bitcmp1_b32 s46,0
s_cselect_b32 s56,0,s31
s_cmp_lg_u32 s56,0
s_cbranch_scc1 L_an_67
s_waitcnt vmcnt(0)
buffer_store_dword v20,off,s[8:11],s73 sc1
s_mov_b32 s73,0x80000000
L_an_67:
s_mov_b32 s31,0
s_cmp_lt_u32 s53,4
s_cbranch_scc1 L_ab_68
L_aw_70:
v_min_u32 v238,v242,v243
v_cmp_eq_u32 vcc,0,v238
s_cbranch_vccz L_awd_71
buffer_load_dwordx2 v[242:243],v244,s[8:11],0 offen sc1
s_sub_u32 s49,s49,1
s_cbranch_scc1 L_abort
s_waitcnt vmcnt(0)
s_branch L_aw_70
L_awd_71:
v_max_u32 v242,v242,v243
s_nop 1
v_max_u32_dpp v242,v242,v242 row_ror:8 row_mask:0xf bank_mask:0xf
s_nop 1
v_max_u32_dpp v242,v242,v242 row_ror:4 row_mask:0xf bank_mask:0xf
s_nop 1
v_max_u32_dpp v242,v242,v242 row_ror:2 row_mask:0xf bank_mask:0xf
s_nop 1
v_max_u32_dpp v242,v242,v242 row_ror:1 row_mask:0xf bank_mask:0xf
v_mov_b32 v243,v242
s_nop 1
v_permlane16_swap_b32 v242,v243
v_max_u32 v242,v242,v243
v_mov_b32 v243,v242
s_nop 1
v_permlane32_swap_b32 v242,v243
v_max_u32 v242,v242,v243
s_nop 0
v_readfirstlane_b32 s56,v242
s_max_u32 s75,s75,s56
s_cmp_lt_u32 s53,8
s_cbranch_scc1 L_ab_68
s_sub_u32 s77,s53,8
s_and_b32 s55,s75,0x7ff
s_sub_u32 s55,2047,s55
s_cmp_lt_u32 s77,28
s_cselect_b32 s55,4095,s55
s_lshr_b32 s61,s55,5
s_mov_b32 s30,1
s_lshl_b32 s56,s77,5
s_add_u32 s56,s56,s68
s_mul_i32 s70,s56,24576
s_lshl_b32 s71,s56,13
s_lshl_b32 s59,s77,13
s_lshl2_add_u32 s59,s68,s59
s_add_u32 s59,s59,10485760
s_cmp_lt_u32 s77,s61
s_cselect_b32 s57,0,16777216
s_cselect_b32 s60,0,128
s_add_u32 s71,s71,s57
s_add_u32 s71,s71,58720256
s_add_u32 s60,s60,s59
s_add_u32 s60,s60,512
s_cmp_eq_u32 s77,s61
s_cselect_b32 s57,50331648,0
s_cselect_b32 s58,1536,0
s_add_u32 s70,s70,s57
s_add_u32 s70,s70,150994944
s_add_u32 s59,s59,s58
s_add_u32 s59,s59,384
v_mov_b32 v19,s59
v_writelane_b32 v19,s60,1
buffer_load_dword v18,v19,s[8:11],0 offen sc1
s_branch L_aj_69
L_ab_68:
s_add_u32 s77,s53,4
s_mov_b32 s30,0
s_lshl_b32 s56,s77,5
s_add_u32 s56,s56,s68
s_mul_i32 s70,s56,24576
s_lshl_b32 s71,s56,13
s_add_u32 s70,s70,100663296
s_add_u32 s71,s71,41943040
s_lshl_b32 s59,s77,13
s_lshl2_add_u32 s59,s68,s59
s_add_u32 s59,s59,10485760
v_mov_b32 v19,s59
buffer_load_dword v18,v19,s[8:11],0 offen sc1
L_aj_69:
v_mfma_f32_16x16x32_bf16 v[136:139],v[72:75],v[24:27],0
v_max3_u32 v238,v72,v73,v74
v_max3_u32 v238,v74,v75,v238
v_mfma_f32_16x16x32_bf16 v[136:139],v[76:79],v[28:31],v[136:139]
v_max3_u32 v238,v76,v77,v238
v_max3_u32 v238,v78,v79,v238
v_mfma_f32_16x16x32_bf16 v[136:139],v[80:83],v[32:35],v[136:139]
v_max3_u32 v238,v80,v81,v238
v_max3_u32 v238,v82,v83,v238
v_mfma_f32_16x16x32_bf16 v[136:139],v[84:87],v[36:39],v[136:139]
v_max3_u32 v238,v84,v85,v238
v_max3_u32 v238,v86,v87,v238
v_max3_u32 v238,v120,v121,v238
v_max3_u32 v238,v122,v123,v238
v_max3_u32 v238,v124,v125,v238
v_max3_u32 v238,v126,v127,v238
v_cmp_eq_u32 vcc,-1,v238
s_cbranch_vccz L_aa_50
L_aa_49:
s_add_u32 s62,s76,4096
buffer_load_dwordx4 v[72:75],v0,s[8:11],s76 offen offset:0 sc1
buffer_load_dwordx4 v[76:79],v0,s[8:11],s76 offen offset:1024 sc1
buffer_load_dwordx4 v[80:83],v0,s[8:11],s76 offen offset:2048 sc1
buffer_load_dwordx4 v[84:87],v0,s[8:11],s76 offen offset:3072 sc1
buffer_load_dwordx2 v[120:121],v0,s[8:11],s62 offen offset:0 sc1
buffer_load_dwordx2 v[122:123],v0,s[8:11],s62 offen offset:1024 sc1
buffer_load_dwordx2 v[124:125],v0,s[8:11],s62 offen offset:2048 sc1
buffer_load_dwordx2 v[126:127],v0,s[8:11],s62 offen offset:3072 sc1
s_sub_u32 s49,s49,1
s_cbranch_scc1 L_abort
s_waitcnt vmcnt(7)
v_mfma_f32_16x16x32_bf16 v[136:139],v[72:75],v[24:27],0
v_max3_u32 v238,v72,v73,v74
v_max3_u32 v238,v74,v75,v238
s_waitcnt vmcnt(6)
v_mfma_f32_16x16x32_bf16 v[136:139],v[76:79],v[28:31],v[136:139]
v_max3_u32 v238,v76,v77,v238
v_max3_u32 v238,v78,v79,v238
s_waitcnt vmcnt(5)
v_mfma_f32_16x16x32_bf16 v[136:139],v[80:83],v[32:35],v[136:139]
v_max3_u32 v238,v80,v81,v238
v_max3_u32 v238,v82,v83,v238
s_waitcnt vmcnt(4)
v_mfma_f32_16x16x32_bf16 v[136:139],v[84:87],v[36:39],v[136:139]
v_max3_u32 v238,v84,v85,v238
v_max3_u32 v238,v86,v87,v238
s_waitcnt vmcnt(0)
v_max3_u32 v238,v120,v121,v238
v_max3_u32 v238,v122,v123,v238
v_max3_u32 v238,v124,v125,v238
v_max3_u32 v238,v126,v127,v238
v_cmp_eq_u32 vcc,-1,v238
s_cbranch_vccnz L_aa_49
L_aa_50:
v_max3_f32 v238,v128,v129,v130
v_max3_f32 v239,v131,v132,v133
v_max3_f32 v238,v134,v135,v238
v_max3_f32 v239,v138,v139,v239
v_max_f32 v238,v238,v239
v_max_f32 v239,v238,v239
s_nop 1
v_permlane16_swap_b32 v238,v239
v_max_f32 v238,v238,v239
v_max_f32 v239,v238,v239
s_nop 1
v_permlane32_swap_b32 v238,v239
v_max_f32 v238,v238,v239
v_mul_f32 v238,s80,v238
v_fma_f32 v128,v128,s80,-v238
v_fma_f32 v129,v129,s80,-v238
v_exp_f32 v128,v128
v_fma_f32 v130,v130,s80,-v238
v_exp_f32 v129,v129
v_fma_f32 v131,v131,s80,-v238
v_exp_f32 v130,v130
v_fma_f32 v132,v132,s80,-v238
v_exp_f32 v131,v131
v_fma_f32 v133,v133,s80,-v238
v_exp_f32 v132,v132
v_fma_f32 v134,v134,s80,-v238
v_exp_f32 v133,v133
v_fma_f32 v135,v135,s80,-v238
v_exp_f32 v134,v134
v_fma_f32 v138,v138,s80,-v238
v_exp_f32 v135,v135
v_fma_f32 v139,v139,s80,-v238
v_exp_f32 v138,v138
v_exp_f32 v139,v139
v_cvt_pk_bf16_f32 v140,v128,v129
v_cvt_pk_bf16_f32 v141,v130,v131
v_cvt_pk_bf16_f32 v142,v132,v133
v_cvt_pk_bf16_f32 v143,v134,v135
v_cvt_pk_bf16_f32 v144,v138,v139
v_mov_b32 v147,v144
s_waitcnt lgkmcnt(0)
v_mfma_f32_16x16x32_bf16 v[148:151],v[152:155],v[140:143],0
v_mfma_f32_16x16x32_bf16 v[24:27],v[88:91],v[140:143],0
v_mfma_f32_16x16x32_bf16 v[28:31],v[92:95],v[140:143],0
v_mfma_f32_16x16x16_bf16 v[148:151],v[152:153],v[144:145],v[148:151]
v_mfma_f32_16x16x32_bf16 v[32:35],v[96:99],v[140:143],0
v_mfma_f32_16x16x32_bf16 v[36:39],v[100:103],v[140:143],0
v_mfma_f32_16x16x32_bf16 v[40:43],v[104:107],v[140:143],0
v_mfma_f32_16x16x32_bf16 v[44:47],v[108:111],v[140:143],0
v_mfma_f32_16x16x32_bf16 v[48:51],v[112:115],v[140:143],0
v_mfma_f32_16x16x32_bf16 v[52:55],v[116:119],v[140:143],0
v_rcp_f32 v148,v148
v_mfma_f32_16x16x16_bf16 v[24:27],v[120:121],v[144:145],v[24:27]
v_mfma_f32_16x16x16_bf16 v[28:31],v[120:121],v[146:147],v[28:31]
v_mfma_f32_16x16x16_bf16 v[32:35],v[122:123],v[144:145],v[32:35]
v_mfma_f32_16x16x16_bf16 v[36:39],v[122:123],v[146:147],v[36:39]
v_mfma_f32_16x16x16_bf16 v[40:43],v[124:125],v[144:145],v[40:43]
v_pk_mul_f32 v[24:25],v[24:25],v[148:149] op_sel_hi:[1,0]
v_pk_mul_f32 v[26:27],v[26:27],v[148:149] op_sel_hi:[1,0]
v_mfma_f32_16x16x16_bf16 v[44:47],v[124:125],v[146:147],v[44:47]
v_pk_mul_f32 v[28:29],v[28:29],v[148:149] op_sel_hi:[1,0]
v_pk_mul_f32 v[30:31],v[30:31],v[148:149] op_sel_hi:[1,0]
v_mfma_f32_16x16x16_bf16 v[48:51],v[126:127],v[144:145],v[48:51]
v_cvt_pk_bf16_f32 v72,v24,v28
v_cvt_pk_bf16_f32 v73,v25,v29
v_mfma_f32_16x16x16_bf16 v[52:55],v[126:127],v[146:147],v[52:55]
v_cvt_pk_bf16_f32 v74,v26,v30
v_cvt_pk_bf16_f32 v75,v27,v31
ds_write_b128 v3,v[72:75] offset:0
v_pk_mul_f32 v[32:33],v[32:33],v[148:149] op_sel_hi:[1,0]
v_pk_mul_f32 v[34:35],v[34:35],v[148:149] op_sel_hi:[1,0]
v_pk_mul_f32 v[36:37],v[36:37],v[148:149] op_sel_hi:[1,0]
v_pk_mul_f32 v[38:39],v[38:39],v[148:149] op_sel_hi:[1,0]
v_cvt_pk_bf16_f32 v76,v32,v36
v_cvt_pk_bf16_f32 v77,v33,v37
v_cvt_pk_bf16_f32 v78,v34,v38
v_cvt_pk_bf16_f32 v79,v35,v39
ds_write_b128 v3,v[76:79] offset:1024
v_pk_mul_f32 v[40:41],v[40:41],v[148:149] op_sel_hi:[1,0]
v_pk_mul_f32 v[42:43],v[42:43],v[148:149] op_sel_hi:[1,0]
v_pk_mul_f32 v[44:45],v[44:45],v[148:149] op_sel_hi:[1,0]
v_pk_mul_f32 v[46:47],v[46:47],v[148:149] op_sel_hi:[1,0]
v_cvt_pk_bf16_f32 v80,v40,v44
v_cvt_pk_bf16_f32 v81,v41,v45
v_cvt_pk_bf16_f32 v82,v42,v46
v_cvt_pk_bf16_f32 v83,v43,v47
ds_write_b128 v3,v[80:83] offset:2048
v_pk_mul_f32 v[48:49],v[48:49],v[148:149] op_sel_hi:[1,0]
v_pk_mul_f32 v[50:51],v[50:51],v[148:149] op_sel_hi:[1,0]
v_pk_mul_f32 v[52:53],v[52:53],v[148:149] op_sel_hi:[1,0]
v_pk_mul_f32 v[54:55],v[54:55],v[148:149] op_sel_hi:[1,0]
v_cvt_pk_bf16_f32 v84,v48,v52
v_cvt_pk_bf16_f32 v85,v49,v53
v_cvt_pk_bf16_f32 v86,v50,v54
v_cvt_pk_bf16_f32 v87,v51,v55
ds_write_b128 v3,v[84:87] offset:3072
s_waitcnt vmcnt(0)
v_cmp_eq_u32 vcc,0,v18
s_lshl_b32 s56,s46,2
s_add_u32 s56,s56,155648
v_mov_b32 v238,s56
s_cmp_lg_u64 vcc,0
s_cselect_b32 s72,1,0
s_cmp_ge_u32 s77,64
s_cselect_b32 s72,1,s72
v_mov_b32 v239,s72
ds_write_b32 v238,v239
s_waitcnt lgkmcnt(0)
s_barrier
s_branch L_aa_38
L_aa_48:
s_cmp_lg_u32 s86,1536
s_cbranch_scc1 L_az_72
L_aa_37:
s_waitcnt vmcnt(0)
buffer_store_dword v20,off,s[8:11],s73 sc1
s_mov_b32 s73,0x80000000
s_mov_b32 s59,11011712
v_and_b32 v238,12,v16
v_mov_b32 v239,0
L_aw_73:
v_cmp_eq_u32 vcc,0,v239
s_cbranch_vccz L_awd_74
s_sleep 2
buffer_load_dword v239,v238,s[8:11],s59 offen sc1
s_sub_u32 s49,s49,1
s_cbranch_scc1 L_abort
s_waitcnt vmcnt(0)
s_branch L_aw_73
L_awd_74:
v_readlane_b32 s55,v239,0
v_readlane_b32 s84,v239,1
v_readlane_b32 s56,v239,2
v_readlane_b32 s58,v239,3
s_sub_u32 s55,s55,1
s_bitset0_b32 s84,31
s_bitset0_b32 s56,31
s_mov_b32 s57,0
s_lshl_b64 s[56:57],s[56:57],22
s_or_b32 s84,s84,s56
s_lshl_b32 s58,s58,12
s_or_b32 s85,s57,s58
s_mov_b32 s86,768
s_mov_b32 s30,1
s_mov_b32 s65,s54
L_as_75:
s_ff1_i32_b64 s77,s[84:85]
s_bitset0_b64 s[84:85],s77
s_min_u32 s77,s77,64
s_sub_u32 s65,s65,1
s_cbranch_scc0 L_as_75
s_lshr_b32 s61,s55,5
s_lshl_b32 s56,s77,5
s_add_u32 s56,s56,s68
s_mul_i32 s70,s56,24576
s_lshl_b32 s71,s56,13
s_lshl_b32 s59,s77,13
s_lshl2_add_u32 s59,s68,s59
s_add_u32 s59,s59,10485760
s_cmp_lt_u32 s77,s61
s_cselect_b32 s57,0,16777216
s_cselect_b32 s60,0,128
s_add_u32 s71,s71,s57
s_add_u32 s71,s71,58720256
s_add_u32 s60,s60,s59
s_add_u32 s60,s60,512
s_cmp_eq_u32 s77,s61
s_cselect_b32 s57,50331648,0
s_cselect_b32 s58,1536,0
s_add_u32 s70,s70,s57
s_add_u32 s70,s70,150994944
s_add_u32 s59,s59,s58
s_add_u32 s59,s59,384
v_mov_b32 v19,s59
v_writelane_b32 v19,s60,1
buffer_load_dword v18,v19,s[8:11],0 offen sc1
s_cmp_lt_u32 s77,64
s_cbranch_scc1 L_aa_46
L_az_72:
s_waitcnt vmcnt(0)
buffer_store_dword v20,off,s[8:11],s73 sc1
s_mov_b32 s73,0x80000000
s_endpgm
L_rch_4:
v_and_b32 v2,15,v1
v_lshlrev_b32 v2,2,v2
v_lshrrev_b32 v3,4,v1
v_lshl_add_u32 v4,v3,16,v2
v_lshl_add_u32 v5,v3,12,v2
s_lshl_b32 s58,s47,8
s_lshl_b32 s57,s46,6
s_add_u32 s58,s58,s57
s_lshl_b32 s59,s47,17
s_add_u32 s59,s59,s57
s_lshl_b32 s60,s46,15
v_add_u32 v6,s60,v0
s_mov_b32 s61,0x05040100
s_mov_b32 s62,0x07060302
s_lshl_b32 s63,s46,19
s_cmp_lt_u32 s48,3
s_cselect_b32 s63,s63,0
s_mov_b32 s4,s26
s_mov_b32 s5,s27
s_mov_b32 s6,4194304
s_mov_b32 s7,0x20000
s_add_u32 s56,s59,0
buffer_load_dword v24,v5,s[4:7],s56 offen offset:0
buffer_load_dword v25,v5,s[4:7],s56 offen offset:1024
buffer_load_dword v26,v5,s[4:7],s56 offen offset:2048
buffer_load_dword v27,v5,s[4:7],s56 offen offset:3072
s_add_u32 s56,s59,16384
buffer_load_dword v28,v5,s[4:7],s56 offen offset:0
buffer_load_dword v29,v5,s[4:7],s56 offen offset:1024
buffer_load_dword v30,v5,s[4:7],s56 offen offset:2048
buffer_load_dword v31,v5,s[4:7],s56 offen offset:3072
s_add_u32 s56,s59,32768
buffer_load_dword v32,v5,s[4:7],s56 offen offset:0
buffer_load_dword v33,v5,s[4:7],s56 offen offset:1024
buffer_load_dword v34,v5,s[4:7],s56 offen offset:2048
buffer_load_dword v35,v5,s[4:7],s56 offen offset:3072
s_add_u32 s56,s59,49152
buffer_load_dword v36,v5,s[4:7],s56 offen offset:0
buffer_load_dword v37,v5,s[4:7],s56 offen offset:1024
buffer_load_dword v38,v5,s[4:7],s56 offen offset:2048
buffer_load_dword v39,v5,s[4:7],s56 offen offset:3072
s_add_u32 s56,s59,65536
buffer_load_dword v40,v5,s[4:7],s56 offen offset:0
buffer_load_dword v41,v5,s[4:7],s56 offen offset:1024
buffer_load_dword v42,v5,s[4:7],s56 offen offset:2048
buffer_load_dword v43,v5,s[4:7],s56 offen offset:3072
s_add_u32 s56,s59,81920
buffer_load_dword v44,v5,s[4:7],s56 offen offset:0
buffer_load_dword v45,v5,s[4:7],s56 offen offset:1024
buffer_load_dword v46,v5,s[4:7],s56 offen offset:2048
buffer_load_dword v47,v5,s[4:7],s56 offen offset:3072
s_add_u32 s56,s59,98304
buffer_load_dword v48,v5,s[4:7],s56 offen offset:0
buffer_load_dword v49,v5,s[4:7],s56 offen offset:1024
buffer_load_dword v50,v5,s[4:7],s56 offen offset:2048
buffer_load_dword v51,v5,s[4:7],s56 offen offset:3072
s_add_u32 s56,s59,114688
buffer_load_dword v52,v5,s[4:7],s56 offen offset:0
buffer_load_dword v53,v5,s[4:7],s56 offen offset:1024
buffer_load_dword v54,v5,s[4:7],s56 offen offset:2048
buffer_load_dword v55,v5,s[4:7],s56 offen offset:3072
s_add_u32 s56,s59,256
buffer_load_dword v56,v5,s[4:7],s56 offen offset:0
buffer_load_dword v57,v5,s[4:7],s56 offen offset:1024
buffer_load_dword v58,v5,s[4:7],s56 offen offset:2048
buffer_load_dword v59,v5,s[4:7],s56 offen offset:3072
s_add_u32 s56,s59,16640
buffer_load_dword v60,v5,s[4:7],s56 offen offset:0
buffer_load_dword v61,v5,s[4:7],s56 offen offset:1024
buffer_load_dword v62,v5,s[4:7],s56 offen offset:2048
buffer_load_dword v63,v5,s[4:7],s56 offen offset:3072
s_add_u32 s56,s59,33024
buffer_load_dword v64,v5,s[4:7],s56 offen offset:0
buffer_load_dword v65,v5,s[4:7],s56 offen offset:1024
buffer_load_dword v66,v5,s[4:7],s56 offen offset:2048
buffer_load_dword v67,v5,s[4:7],s56 offen offset:3072
s_add_u32 s56,s59,49408
buffer_load_dword v68,v5,s[4:7],s56 offen offset:0
buffer_load_dword v69,v5,s[4:7],s56 offen offset:1024
buffer_load_dword v70,v5,s[4:7],s56 offen offset:2048
buffer_load_dword v71,v5,s[4:7],s56 offen offset:3072
s_add_u32 s56,s59,65792
buffer_load_dword v72,v5,s[4:7],s56 offen offset:0
buffer_load_dword v73,v5,s[4:7],s56 offen offset:1024
buffer_load_dword v74,v5,s[4:7],s56 offen offset:2048
buffer_load_dword v75,v5,s[4:7],s56 offen offset:3072
s_add_u32 s56,s59,82176
buffer_load_dword v76,v5,s[4:7],s56 offen offset:0
buffer_load_dword v77,v5,s[4:7],s56 offen offset:1024
buffer_load_dword v78,v5,s[4:7],s56 offen offset:2048
buffer_load_dword v79,v5,s[4:7],s56 offen offset:3072
s_waitcnt vmcnt(48)
ds_write_b128 v6,v[24:27] offset:0
ds_write_b128 v6,v[28:31] offset:1024
s_waitcnt lgkmcnt(0)
s_add_u32 s56,s59,98560
buffer_load_dword v24,v5,s[4:7],s56 offen offset:0
buffer_load_dword v25,v5,s[4:7],s56 offen offset:1024
buffer_load_dword v26,v5,s[4:7],s56 offen offset:2048
buffer_load_dword v27,v5,s[4:7],s56 offen offset:3072
s_add_u32 s56,s59,114944
buffer_load_dword v28,v5,s[4:7],s56 offen offset:0
buffer_load_dword v29,v5,s[4:7],s56 offen offset:1024
buffer_load_dword v30,v5,s[4:7],s56 offen offset:2048
buffer_load_dword v31,v5,s[4:7],s56 offen offset:3072
s_waitcnt vmcnt(48)
ds_write_b128 v6,v[32:35] offset:2048
ds_write_b128 v6,v[36:39] offset:3072
s_waitcnt lgkmcnt(0)
s_add_u32 s56,s59,512
buffer_load_dword v32,v5,s[4:7],s56 offen offset:0
buffer_load_dword v33,v5,s[4:7],s56 offen offset:1024
buffer_load_dword v34,v5,s[4:7],s56 offen offset:2048
buffer_load_dword v35,v5,s[4:7],s56 offen offset:3072
s_add_u32 s56,s59,16896
buffer_load_dword v36,v5,s[4:7],s56 offen offset:0
buffer_load_dword v37,v5,s[4:7],s56 offen offset:1024
buffer_load_dword v38,v5,s[4:7],s56 offen offset:2048
buffer_load_dword v39,v5,s[4:7],s56 offen offset:3072
s_waitcnt vmcnt(48)
ds_write_b128 v6,v[40:43] offset:4096
ds_write_b128 v6,v[44:47] offset:5120
s_waitcnt lgkmcnt(0)
s_add_u32 s56,s59,33280
buffer_load_dword v40,v5,s[4:7],s56 offen offset:0
buffer_load_dword v41,v5,s[4:7],s56 offen offset:1024
buffer_load_dword v42,v5,s[4:7],s56 offen offset:2048
buffer_load_dword v43,v5,s[4:7],s56 offen offset:3072
s_add_u32 s56,s59,49664
buffer_load_dword v44,v5,s[4:7],s56 offen offset:0
buffer_load_dword v45,v5,s[4:7],s56 offen offset:1024
buffer_load_dword v46,v5,s[4:7],s56 offen offset:2048
buffer_load_dword v47,v5,s[4:7],s56 offen offset:3072
s_waitcnt vmcnt(48)
ds_write_b128 v6,v[48:51] offset:6144
ds_write_b128 v6,v[52:55] offset:7168
s_waitcnt lgkmcnt(0)
s_add_u32 s56,s59,66048
buffer_load_dword v48,v5,s[4:7],s56 offen offset:0
buffer_load_dword v49,v5,s[4:7],s56 offen offset:1024
buffer_load_dword v50,v5,s[4:7],s56 offen offset:2048
buffer_load_dword v51,v5,s[4:7],s56 offen offset:3072
s_add_u32 s56,s59,82432
buffer_load_dword v52,v5,s[4:7],s56 offen offset:0
buffer_load_dword v53,v5,s[4:7],s56 offen offset:1024
buffer_load_dword v54,v5,s[4:7],s56 offen offset:2048
buffer_load_dword v55,v5,s[4:7],s56 offen offset:3072
s_waitcnt vmcnt(48)
ds_write_b128 v6,v[56:59] offset:8192
ds_write_b128 v6,v[60:63] offset:9216
s_waitcnt lgkmcnt(0)
s_add_u32 s56,s59,98816
buffer_load_dword v56,v5,s[4:7],s56 offen offset:0
buffer_load_dword v57,v5,s[4:7],s56 offen offset:1024
buffer_load_dword v58,v5,s[4:7],s56 offen offset:2048
buffer_load_dword v59,v5,s[4:7],s56 offen offset:3072
s_add_u32 s56,s59,115200
buffer_load_dword v60,v5,s[4:7],s56 offen offset:0
buffer_load_dword v61,v5,s[4:7],s56 offen offset:1024
buffer_load_dword v62,v5,s[4:7],s56 offen offset:2048
buffer_load_dword v63,v5,s[4:7],s56 offen offset:3072
s_waitcnt vmcnt(48)
ds_write_b128 v6,v[64:67] offset:10240
ds_write_b128 v6,v[68:71] offset:11264
s_waitcnt lgkmcnt(0)
s_add_u32 s56,s59,768
buffer_load_dword v64,v5,s[4:7],s56 offen offset:0
buffer_load_dword v65,v5,s[4:7],s56 offen offset:1024
buffer_load_dword v66,v5,s[4:7],s56 offen offset:2048
buffer_load_dword v67,v5,s[4:7],s56 offen offset:3072
s_add_u32 s56,s59,17152
buffer_load_dword v68,v5,s[4:7],s56 offen offset:0
buffer_load_dword v69,v5,s[4:7],s56 offen offset:1024
buffer_load_dword v70,v5,s[4:7],s56 offen offset:2048
buffer_load_dword v71,v5,s[4:7],s56 offen offset:3072
s_waitcnt vmcnt(48)
ds_write_b128 v6,v[72:75] offset:12288
ds_write_b128 v6,v[76:79] offset:13312
s_waitcnt lgkmcnt(0)
s_add_u32 s56,s59,33536
buffer_load_dword v72,v5,s[4:7],s56 offen offset:0
buffer_load_dword v73,v5,s[4:7],s56 offen offset:1024
buffer_load_dword v74,v5,s[4:7],s56 offen offset:2048
buffer_load_dword v75,v5,s[4:7],s56 offen offset:3072
s_add_u32 s56,s59,49920
buffer_load_dword v76,v5,s[4:7],s56 offen offset:0
buffer_load_dword v77,v5,s[4:7],s56 offen offset:1024
buffer_load_dword v78,v5,s[4:7],s56 offen offset:2048
buffer_load_dword v79,v5,s[4:7],s56 offen offset:3072
s_waitcnt vmcnt(48)
ds_write_b128 v6,v[24:27] offset:14336
ds_write_b128 v6,v[28:31] offset:15360
s_waitcnt lgkmcnt(0)
s_add_u32 s56,s59,66304
buffer_load_dword v24,v5,s[4:7],s56 offen offset:0
buffer_load_dword v25,v5,s[4:7],s56 offen offset:1024
buffer_load_dword v26,v5,s[4:7],s56 offen offset:2048
buffer_load_dword v27,v5,s[4:7],s56 offen offset:3072
s_add_u32 s56,s59,82688
buffer_load_dword v28,v5,s[4:7],s56 offen offset:0
buffer_load_dword v29,v5,s[4:7],s56 offen offset:1024
buffer_load_dword v30,v5,s[4:7],s56 offen offset:2048
buffer_load_dword v31,v5,s[4:7],s56 offen offset:3072
s_waitcnt vmcnt(48)
ds_write_b128 v6,v[32:35] offset:16384
ds_write_b128 v6,v[36:39] offset:17408
s_waitcnt lgkmcnt(0)
s_add_u32 s56,s59,99072
buffer_load_dword v32,v5,s[4:7],s56 offen offset:0
buffer_load_dword v33,v5,s[4:7],s56 offen offset:1024
buffer_load_dword v34,v5,s[4:7],s56 offen offset:2048
buffer_load_dword v35,v5,s[4:7],s56 offen offset:3072
s_add_u32 s56,s59,115456
buffer_load_dword v36,v5,s[4:7],s56 offen offset:0
buffer_load_dword v37,v5,s[4:7],s56 offen offset:1024
buffer_load_dword v38,v5,s[4:7],s56 offen offset:2048
buffer_load_dword v39,v5,s[4:7],s56 offen offset:3072
s_waitcnt vmcnt(48)
ds_write_b128 v6,v[40:43] offset:18432
ds_write_b128 v6,v[44:47] offset:19456
s_waitcnt lgkmcnt(0)
s_waitcnt vmcnt(40)
ds_write_b128 v6,v[48:51] offset:20480
ds_write_b128 v6,v[52:55] offset:21504
s_waitcnt lgkmcnt(0)
s_waitcnt vmcnt(32)
ds_write_b128 v6,v[56:59] offset:22528
ds_write_b128 v6,v[60:63] offset:23552
s_waitcnt lgkmcnt(0)
s_waitcnt vmcnt(24)
ds_write_b128 v6,v[64:67] offset:24576
ds_write_b128 v6,v[68:71] offset:25600
s_waitcnt lgkmcnt(0)
s_waitcnt vmcnt(16)
ds_write_b128 v6,v[72:75] offset:26624
ds_write_b128 v6,v[76:79] offset:27648
s_waitcnt lgkmcnt(0)
s_waitcnt vmcnt(8)
ds_write_b128 v6,v[24:27] offset:28672
ds_write_b128 v6,v[28:31] offset:29696
s_waitcnt lgkmcnt(0)
s_waitcnt vmcnt(0)
ds_write_b128 v6,v[32:35] offset:30720
ds_write_b128 v6,v[36:39] offset:31744
s_waitcnt lgkmcnt(0)
v_mov_b32 v123,159744
s_cmp_lg_u32 s46,0
s_cbranch_scc1 L_gbd_77
v_mov_b32 v124,128
L_gb_76:
buffer_load_dword v125,v124,s[12:15],0 offen sc1
s_waitcnt vmcnt(0)
v_readfirstlane_b32 s56,v125
ds_write_b32 v123,v125
s_bitcmp1_b32 s56,8
s_cbranch_scc1 L_gbd_77
s_sleep 4
s_sub_u32 s49,s49,1
s_cmp_gt_i32 s49,0
s_cbranch_scc1 L_gb_76
s_branch L_abort
L_gbd_77:
s_waitcnt lgkmcnt(0)
s_barrier
ds_read_b32 v125,v123
s_waitcnt lgkmcnt(0)
v_readfirstlane_b32 s56,v125
s_barrier
s_lshr_b32 s56,s56,16
s_andn2_b32 s56,s56,s3
s_cbranch_scc1 L_spread
s_cmp_eq_u32 s48,0
s_cbranch_scc1 L_chd_78
v_and_b32 v120,15,v1
v_lshrrev_b32 v121,4,v1
v_mov_b32 v17,1
s_lshl_b32 s56,s46,2
v_add_u32 v125,s56,v121
v_xor_b32 v126,v125,v120
v_lshlrev_b32 v126,4,v126
v_lshl_add_u32 v20,v125,10,v126
s_lshl_b32 s56,s46,1
s_xor_b32 s56,s56,0
s_and_b32 s57,s56,3
s_lshl_b32 s57,s57,2
s_lshr_b32 s56,s56,2
s_lshl_b32 s56,s56,13
s_add_u32 s56,s56,131072
v_add_u32 v125,s57,v121
v_xor_b32 v125,v125,v120
v_lshlrev_b32 v125,4,v125
v_lshl_add_u32 v125,v120,8,v125
v_add_u32 v4,s56,v125
s_lshl_b32 s56,s46,1
s_xor_b32 s56,s56,1
s_and_b32 s57,s56,3
s_lshl_b32 s57,s57,2
s_lshr_b32 s56,s56,2
s_lshl_b32 s56,s56,13
s_add_u32 s56,s56,131072
v_add_u32 v125,s57,v121
v_xor_b32 v125,v125,v120
v_lshlrev_b32 v125,4,v125
v_lshl_add_u32 v125,v120,8,v125
v_add_u32 v5,s56,v125
s_lshl_b32 s56,s46,1
s_xor_b32 s56,s56,2
s_and_b32 s57,s56,3
s_lshl_b32 s57,s57,2
s_lshr_b32 s56,s56,2
s_lshl_b32 s56,s56,13
s_add_u32 s56,s56,131072
v_add_u32 v125,s57,v121
v_xor_b32 v125,v125,v120
v_lshlrev_b32 v125,4,v125
v_lshl_add_u32 v125,v120,8,v125
v_add_u32 v6,s56,v125
s_lshl_b32 s56,s46,1
s_xor_b32 s56,s56,3
s_and_b32 s57,s56,3
s_lshl_b32 s57,s57,2
s_lshr_b32 s56,s56,2
s_lshl_b32 s56,s56,13
s_add_u32 s56,s56,131072
v_add_u32 v125,s57,v121
v_xor_b32 v125,v125,v120
v_lshlrev_b32 v125,4,v125
v_lshl_add_u32 v125,v120,8,v125
v_add_u32 v7,s56,v125
s_lshl_b32 s56,s46,1
s_xor_b32 s56,s56,4
s_and_b32 s57,s56,3
s_lshl_b32 s57,s57,2
s_lshr_b32 s56,s56,2
s_lshl_b32 s56,s56,13
s_add_u32 s56,s56,131072
v_add_u32 v125,s57,v121
v_xor_b32 v125,v125,v120
v_lshlrev_b32 v125,4,v125
v_lshl_add_u32 v125,v120,8,v125
v_add_u32 v8,s56,v125
s_lshl_b32 s56,s46,1
s_xor_b32 s56,s56,5
s_and_b32 s57,s56,3
s_lshl_b32 s57,s57,2
s_lshr_b32 s56,s56,2
s_lshl_b32 s56,s56,13
s_add_u32 s56,s56,131072
v_add_u32 v125,s57,v121
v_xor_b32 v125,v125,v120
v_lshlrev_b32 v125,4,v125
v_lshl_add_u32 v125,v120,8,v125
v_add_u32 v9,s56,v125
s_lshl_b32 s56,s46,1
s_xor_b32 s56,s56,6
s_and_b32 s57,s56,3
s_lshl_b32 s57,s57,2
s_lshr_b32 s56,s56,2
s_lshl_b32 s56,s56,13
s_add_u32 s56,s56,131072
v_add_u32 v125,s57,v121
v_xor_b32 v125,v125,v120
v_lshlrev_b32 v125,4,v125
v_lshl_add_u32 v125,v120,8,v125
v_add_u32 v10,s56,v125
s_lshl_b32 s56,s46,1
s_xor_b32 s56,s56,7
s_and_b32 s57,s56,3
s_lshl_b32 s57,s57,2
s_lshr_b32 s56,s56,2
s_lshl_b32 s56,s56,13
s_add_u32 s56,s56,131072
v_add_u32 v125,s57,v121
v_xor_b32 v125,v125,v120
v_lshlrev_b32 v125,4,v125
v_lshl_add_u32 v125,v120,8,v125
v_add_u32 v11,s56,v125
s_cmp_eq_u32 s48,1
s_cselect_b32 s51,8,12
s_cselect_b32 s53,4,6
s_mov_b32 s72,0x80000000
s_lshl_b32 s70,s51,15
s_add_u32 s70,s70,0
s_add_u32 s71,s70,16384
s_add_u32 m0,s50,131072
s_nop 0
buffer_load_dwordx4 v20,s[8:11],s70 offen offset:0 sc1 lds
s_add_u32 m0,s50,135168
s_nop 0
buffer_load_dwordx4 v20,s[8:11],s71 offen offset:0 sc1 lds
s_add_u32 m0,s50,139008
s_nop 0
buffer_load_dwordx4 v20,s[8:11],s70 offen offset:256 sc1 lds
s_add_u32 m0,s50,143104
s_nop 0
buffer_load_dwordx4 v20,s[8:11],s71 offen offset:256 sc1 lds
s_waitcnt vmcnt(0)
L_chl_79:
s_mov_b64 s[68:69],s[70:71]
s_add_u32 s70,s70,32768
s_add_u32 s71,s71,32768
s_lshl_b32 s58,s51,5
s_add_u32 s58,s58,s47
s_mul_i32 s58,s58,24576
s_add_u32 s58,s58,100663296
s_add_u32 s61,s58,s50
s_add_u32 s62,s61,4096
s_add_u32 s63,s61,16384
s_add_u32 s64,s61,20480
s_add_u32 s65,s61,s50
s_add_u32 s65,s65,8192
s_waitcnt vmcnt(8)
s_barrier
ds_read_b128 v[72:75],v4 offset:0
ds_read_b128 v[76:79],v4 offset:4096
ds_read_b128 v[80:83],v5 offset:0
ds_read_b128 v[84:87],v5 offset:4096
s_add_u32 m0,s50,146944
s_nop 0
buffer_load_dwordx4 v20,s[8:11],s68 offen offset:512 sc1 lds
s_add_u32 m0,s50,151040
s_nop 0
buffer_load_dwordx4 v20,s[8:11],s69 offen offset:512 sc1 lds
s_add_u32 m0,s50,154880
s_nop 0
buffer_load_dwordx4 v20,s[8:11],s68 offen offset:768 sc1 lds
s_add_u32 m0,s50,158976
s_nop 0
buffer_load_dwordx4 v20,s[8:11],s69 offen offset:768 sc1 lds
s_waitcnt lgkmcnt(2)
v_mfma_f32_16x16x32_bf16 v[40:43],a[128:131],v[72:75],0
ds_read_b128 v[108:111],v6 offset:0
v_mfma_f32_16x16x32_bf16 v[56:59],v[72:75],v[128:131],0
v_mfma_f32_16x16x32_bf16 v[24:27],a[0:3],v[72:75],0
ds_read_b128 v[112:115],v6 offset:4096
v_mfma_f32_16x16x32_bf16 v[44:47],a[128:131],v[76:79],0
v_mfma_f32_16x16x32_bf16 v[60:63],v[76:79],v[128:131],0
v_mfma_f32_16x16x32_bf16 v[28:31],a[0:3],v[76:79],0
v_mfma_f32_16x16x32_bf16 v[48:51],a[136:139],v[72:75],0
v_mfma_f32_16x16x32_bf16 v[64:67],v[72:75],v[136:139],0
v_mfma_f32_16x16x32_bf16 v[32:35],a[8:11],v[72:75],0
v_mfma_f32_16x16x32_bf16 v[52:55],a[136:139],v[76:79],0
v_mfma_f32_16x16x32_bf16 v[68:71],v[76:79],v[136:139],0
v_mfma_f32_16x16x32_bf16 v[36:39],a[8:11],v[76:79],0
s_waitcnt lgkmcnt(2)
v_mfma_f32_16x16x32_bf16 v[40:43],a[132:135],v[80:83],v[40:43]
ds_read_b128 v[72:75],v7 offset:0
v_mfma_f32_16x16x32_bf16 v[56:59],v[80:83],v[132:135],v[56:59]
v_mfma_f32_16x16x32_bf16 v[24:27],a[4:7],v[80:83],v[24:27]
ds_read_b128 v[76:79],v7 offset:4096
v_mfma_f32_16x16x32_bf16 v[44:47],a[132:135],v[84:87],v[44:47]
v_mfma_f32_16x16x32_bf16 v[60:63],v[84:87],v[132:135],v[60:63]
v_mfma_f32_16x16x32_bf16 v[28:31],a[4:7],v[84:87],v[28:31]
v_mfma_f32_16x16x32_bf16 v[48:51],a[140:143],v[80:83],v[48:51]
v_mfma_f32_16x16x32_bf16 v[64:67],v[80:83],v[140:143],v[64:67]
v_mfma_f32_16x16x32_bf16 v[32:35],a[12:15],v[80:83],v[32:35]
v_mfma_f32_16x16x32_bf16 v[52:55],a[140:143],v[84:87],v[52:55]
v_mfma_f32_16x16x32_bf16 v[68:71],v[84:87],v[140:143],v[68:71]
v_mfma_f32_16x16x32_bf16 v[36:39],a[12:15],v[84:87],v[36:39]
s_waitcnt lgkmcnt(2)
v_mfma_f32_16x16x32_bf16 v[40:43],a[144:147],v[108:111],v[40:43]
ds_read_b128 v[80:83],v8 offset:0
v_mfma_f32_16x16x32_bf16 v[56:59],v[108:111],v[144:147],v[56:59]
v_mfma_f32_16x16x32_bf16 v[24:27],a[16:19],v[108:111],v[24:27]
ds_read_b128 v[84:87],v8 offset:4096
v_mfma_f32_16x16x32_bf16 v[44:47],a[144:147],v[112:115],v[44:47]
v_mfma_f32_16x16x32_bf16 v[60:63],v[112:115],v[144:147],v[60:63]
v_mfma_f32_16x16x32_bf16 v[28:31],a[16:19],v[112:115],v[28:31]
v_mfma_f32_16x16x32_bf16 v[48:51],a[152:155],v[108:111],v[48:51]
v_mfma_f32_16x16x32_bf16 v[64:67],v[108:111],v[152:155],v[64:67]
v_mfma_f32_16x16x32_bf16 v[32:35],a[24:27],v[108:111],v[32:35]
v_mfma_f32_16x16x32_bf16 v[52:55],a[152:155],v[112:115],v[52:55]
v_mfma_f32_16x16x32_bf16 v[68:71],v[112:115],v[152:155],v[68:71]
v_mfma_f32_16x16x32_bf16 v[36:39],a[24:27],v[112:115],v[36:39]
s_waitcnt lgkmcnt(2)
v_mfma_f32_16x16x32_bf16 v[40:43],a[148:151],v[72:75],v[40:43]
ds_read_b128 v[108:111],v9 offset:0
v_mfma_f32_16x16x32_bf16 v[56:59],v[72:75],v[148:151],v[56:59]
v_mfma_f32_16x16x32_bf16 v[24:27],a[20:23],v[72:75],v[24:27]
ds_read_b128 v[112:115],v9 offset:4096
v_mfma_f32_16x16x32_bf16 v[44:47],a[148:151],v[76:79],v[44:47]
v_mfma_f32_16x16x32_bf16 v[60:63],v[76:79],v[148:151],v[60:63]
v_mfma_f32_16x16x32_bf16 v[28:31],a[20:23],v[76:79],v[28:31]
v_mfma_f32_16x16x32_bf16 v[48:51],a[156:159],v[72:75],v[48:51]
v_mfma_f32_16x16x32_bf16 v[64:67],v[72:75],v[156:159],v[64:67]
v_mfma_f32_16x16x32_bf16 v[32:35],a[28:31],v[72:75],v[32:35]
v_mfma_f32_16x16x32_bf16 v[52:55],a[156:159],v[76:79],v[52:55]
v_mfma_f32_16x16x32_bf16 v[68:71],v[76:79],v[156:159],v[68:71]
v_mfma_f32_16x16x32_bf16 v[36:39],a[28:31],v[76:79],v[36:39]
s_waitcnt lgkmcnt(2)
v_mfma_f32_16x16x32_bf16 v[40:43],a[160:163],v[80:83],v[40:43]
ds_read_b128 v[72:75],v10 offset:0
v_mfma_f32_16x16x32_bf16 v[56:59],v[80:83],v[160:163],v[56:59]
v_mfma_f32_16x16x32_bf16 v[24:27],a[32:35],v[80:83],v[24:27]
ds_read_b128 v[76:79],v10 offset:4096
v_mfma_f32_16x16x32_bf16 v[44:47],a[160:163],v[84:87],v[44:47]
v_mfma_f32_16x16x32_bf16 v[60:63],v[84:87],v[160:163],v[60:63]
v_mfma_f32_16x16x32_bf16 v[28:31],a[32:35],v[84:87],v[28:31]
v_mfma_f32_16x16x32_bf16 v[48:51],a[168:171],v[80:83],v[48:51]
v_mfma_f32_16x16x32_bf16 v[64:67],v[80:83],v[168:171],v[64:67]
v_mfma_f32_16x16x32_bf16 v[32:35],a[40:43],v[80:83],v[32:35]
v_mfma_f32_16x16x32_bf16 v[52:55],a[168:171],v[84:87],v[52:55]
v_mfma_f32_16x16x32_bf16 v[68:71],v[84:87],v[168:171],v[68:71]
v_mfma_f32_16x16x32_bf16 v[36:39],a[40:43],v[84:87],v[36:39]
s_waitcnt lgkmcnt(2)
v_mfma_f32_16x16x32_bf16 v[40:43],a[164:167],v[108:111],v[40:43]
ds_read_b128 v[80:83],v11 offset:0
v_mfma_f32_16x16x32_bf16 v[56:59],v[108:111],v[164:167],v[56:59]
v_mfma_f32_16x16x32_bf16 v[24:27],a[36:39],v[108:111],v[24:27]
ds_read_b128 v[84:87],v11 offset:4096
v_mfma_f32_16x16x32_bf16 v[44:47],a[164:167],v[112:115],v[44:47]
v_mfma_f32_16x16x32_bf16 v[60:63],v[112:115],v[164:167],v[60:63]
v_mfma_f32_16x16x32_bf16 v[28:31],a[36:39],v[112:115],v[28:31]
v_mfma_f32_16x16x32_bf16 v[48:51],a[172:175],v[108:111],v[48:51]
v_mfma_f32_16x16x32_bf16 v[64:67],v[108:111],v[172:175],v[64:67]
v_mfma_f32_16x16x32_bf16 v[32:35],a[44:47],v[108:111],v[32:35]
v_mfma_f32_16x16x32_bf16 v[52:55],a[172:175],v[112:115],v[52:55]
v_mfma_f32_16x16x32_bf16 v[68:71],v[112:115],v[172:175],v[68:71]
v_mfma_f32_16x16x32_bf16 v[36:39],a[44:47],v[112:115],v[36:39]
s_waitcnt vmcnt(0)
s_barrier
s_or_b32 s72,s72,s52
buffer_store_dword v17,off,s[8:11],s72 sc1
s_waitcnt lgkmcnt(2)
v_mfma_f32_16x16x32_bf16 v[40:43],a[176:179],v[72:75],v[40:43]
ds_read_b128 v[108:111],v4 offset:16384
v_mfma_f32_16x16x32_bf16 v[56:59],v[72:75],v[176:179],v[56:59]
v_mfma_f32_16x16x32_bf16 v[24:27],a[48:51],v[72:75],v[24:27]
ds_read_b128 v[112:115],v4 offset:20480
v_mfma_f32_16x16x32_bf16 v[44:47],a[176:179],v[76:79],v[44:47]
v_mfma_f32_16x16x32_bf16 v[60:63],v[76:79],v[176:179],v[60:63]
v_mfma_f32_16x16x32_bf16 v[28:31],a[48:51],v[76:79],v[28:31]
v_mfma_f32_16x16x32_bf16 v[48:51],a[184:187],v[72:75],v[48:51]
v_mfma_f32_16x16x32_bf16 v[64:67],v[72:75],v[184:187],v[64:67]
v_mfma_f32_16x16x32_bf16 v[32:35],a[56:59],v[72:75],v[32:35]
v_mfma_f32_16x16x32_bf16 v[52:55],a[184:187],v[76:79],v[52:55]
v_mfma_f32_16x16x32_bf16 v[68:71],v[76:79],v[184:187],v[68:71]
v_mfma_f32_16x16x32_bf16 v[36:39],a[56:59],v[76:79],v[36:39]
s_waitcnt lgkmcnt(2)
v_mfma_f32_16x16x32_bf16 v[40:43],a[180:183],v[80:83],v[40:43]
ds_read_b128 v[72:75],v5 offset:16384
v_mfma_f32_16x16x32_bf16 v[56:59],v[80:83],v[180:183],v[56:59]
v_mfma_f32_16x16x32_bf16 v[24:27],a[52:55],v[80:83],v[24:27]
ds_read_b128 v[76:79],v5 offset:20480
v_mfma_f32_16x16x32_bf16 v[44:47],a[180:183],v[84:87],v[44:47]
v_mfma_f32_16x16x32_bf16 v[60:63],v[84:87],v[180:183],v[60:63]
v_mfma_f32_16x16x32_bf16 v[28:31],a[52:55],v[84:87],v[28:31]
v_mfma_f32_16x16x32_bf16 v[48:51],a[188:191],v[80:83],v[48:51]
v_mfma_f32_16x16x32_bf16 v[64:67],v[80:83],v[188:191],v[64:67]
v_mfma_f32_16x16x32_bf16 v[32:35],a[60:63],v[80:83],v[32:35]
v_mfma_f32_16x16x32_bf16 v[52:55],a[188:191],v[84:87],v[52:55]
v_mfma_f32_16x16x32_bf16 v[68:71],v[84:87],v[188:191],v[68:71]
v_mfma_f32_16x16x32_bf16 v[36:39],a[60:63],v[84:87],v[36:39]
s_waitcnt lgkmcnt(2)
v_mfma_f32_16x16x32_bf16 v[40:43],a[192:195],v[108:111],v[40:43]
ds_read_b128 v[80:83],v6 offset:16384
v_mfma_f32_16x16x32_bf16 v[56:59],v[108:111],v[192:195],v[56:59]
v_mfma_f32_16x16x32_bf16 v[24:27],a[64:67],v[108:111],v[24:27]
ds_read_b128 v[84:87],v6 offset:20480
v_mfma_f32_16x16x32_bf16 v[44:47],a[192:195],v[112:115],v[44:47]
v_mfma_f32_16x16x32_bf16 v[60:63],v[112:115],v[192:195],v[60:63]
v_mfma_f32_16x16x32_bf16 v[28:31],a[64:67],v[112:115],v[28:31]
v_mfma_f32_16x16x32_bf16 v[48:51],a[200:203],v[108:111],v[48:51]
v_mfma_f32_16x16x32_bf16 v[64:67],v[108:111],v[200:203],v[64:67]
v_mfma_f32_16x16x32_bf16 v[32:35],a[72:75],v[108:111],v[32:35]
v_mfma_f32_16x16x32_bf16 v[52:55],a[200:203],v[112:115],v[52:55]
v_mfma_f32_16x16x32_bf16 v[68:71],v[112:115],v[200:203],v[68:71]
v_mfma_f32_16x16x32_bf16 v[36:39],a[72:75],v[112:115],v[36:39]
s_waitcnt lgkmcnt(2)
v_mfma_f32_16x16x32_bf16 v[40:43],a[196:199],v[72:75],v[40:43]
ds_read_b128 v[108:111],v7 offset:16384
v_mfma_f32_16x16x32_bf16 v[56:59],v[72:75],v[196:199],v[56:59]
v_mfma_f32_16x16x32_bf16 v[24:27],a[68:71],v[72:75],v[24:27]
ds_read_b128 v[112:115],v7 offset:20480
v_mfma_f32_16x16x32_bf16 v[44:47],a[196:199],v[76:79],v[44:47]
v_mfma_f32_16x16x32_bf16 v[60:63],v[76:79],v[196:199],v[60:63]
v_mfma_f32_16x16x32_bf16 v[28:31],a[68:71],v[76:79],v[28:31]
v_mfma_f32_16x16x32_bf16 v[48:51],a[204:207],v[72:75],v[48:51]
v_mfma_f32_16x16x32_bf16 v[64:67],v[72:75],v[204:207],v[64:67]
v_mfma_f32_16x16x32_bf16 v[32:35],a[76:79],v[72:75],v[32:35]
v_mfma_f32_16x16x32_bf16 v[52:55],a[204:207],v[76:79],v[52:55]
v_mfma_f32_16x16x32_bf16 v[68:71],v[76:79],v[204:207],v[68:71]
v_mfma_f32_16x16x32_bf16 v[36:39],a[76:79],v[76:79],v[36:39]
s_waitcnt lgkmcnt(2)
v_mfma_f32_16x16x32_bf16 v[40:43],a[208:211],v[80:83],v[40:43]
ds_read_b128 v[72:75],v8 offset:16384
v_mfma_f32_16x16x32_bf16 v[56:59],v[80:83],v[208:211],v[56:59]
v_mfma_f32_16x16x32_bf16 v[24:27],a[80:83],v[80:83],v[24:27]
ds_read_b128 v[76:79],v8 offset:20480
v_mfma_f32_16x16x32_bf16 v[44:47],a[208:211],v[84:87],v[44:47]
v_mfma_f32_16x16x32_bf16 v[60:63],v[84:87],v[208:211],v[60:63]
v_mfma_f32_16x16x32_bf16 v[28:31],a[80:83],v[84:87],v[28:31]
v_mfma_f32_16x16x32_bf16 v[48:51],a[216:219],v[80:83],v[48:51]
v_mfma_f32_16x16x32_bf16 v[64:67],v[80:83],v[216:219],v[64:67]
v_mfma_f32_16x16x32_bf16 v[32:35],a[88:91],v[80:83],v[32:35]
v_mfma_f32_16x16x32_bf16 v[52:55],a[216:219],v[84:87],v[52:55]
v_mfma_f32_16x16x32_bf16 v[68:71],v[84:87],v[216:219],v[68:71]
v_mfma_f32_16x16x32_bf16 v[36:39],a[88:91],v[84:87],v[36:39]
s_waitcnt lgkmcnt(2)
v_mfma_f32_16x16x32_bf16 v[40:43],a[212:215],v[108:111],v[40:43]
ds_read_b128 v[80:83],v9 offset:16384
v_mfma_f32_16x16x32_bf16 v[56:59],v[108:111],v[212:215],v[56:59]
v_mfma_f32_16x16x32_bf16 v[24:27],a[84:87],v[108:111],v[24:27]
ds_read_b128 v[84:87],v9 offset:20480
v_mfma_f32_16x16x32_bf16 v[44:47],a[212:215],v[112:115],v[44:47]
v_mfma_f32_16x16x32_bf16 v[60:63],v[112:115],v[212:215],v[60:63]
v_mfma_f32_16x16x32_bf16 v[28:31],a[84:87],v[112:115],v[28:31]
v_mfma_f32_16x16x32_bf16 v[48:51],a[220:223],v[108:111],v[48:51]
v_mfma_f32_16x16x32_bf16 v[64:67],v[108:111],v[220:223],v[64:67]
v_mfma_f32_16x16x32_bf16 v[32:35],a[92:95],v[108:111],v[32:35]
v_mfma_f32_16x16x32_bf16 v[52:55],a[220:223],v[112:115],v[52:55]
v_mfma_f32_16x16x32_bf16 v[68:71],v[112:115],v[220:223],v[68:71]
v_mfma_f32_16x16x32_bf16 v[36:39],a[92:95],v[112:115],v[36:39]
s_barrier
s_waitcnt lgkmcnt(2)
v_mfma_f32_16x16x32_bf16 v[40:43],a[224:227],v[72:75],v[40:43]
ds_read_b128 v[108:111],v10 offset:16384
v_mfma_f32_16x16x32_bf16 v[56:59],v[72:75],v[224:227],v[56:59]
s_add_u32 m0,s50,131072
v_mfma_f32_16x16x32_bf16 v[24:27],a[96:99],v[72:75],v[24:27]
ds_read_b128 v[112:115],v10 offset:20480
v_mfma_f32_16x16x32_bf16 v[44:47],a[224:227],v[76:79],v[44:47]
buffer_load_dwordx4 v20,s[8:11],s70 offen offset:0 sc1 lds
v_mfma_f32_16x16x32_bf16 v[60:63],v[76:79],v[224:227],v[60:63]
s_add_u32 m0,s50,135168
v_mfma_f32_16x16x32_bf16 v[28:31],a[96:99],v[76:79],v[28:31]
buffer_load_dwordx4 v20,s[8:11],s71 offen offset:0 sc1 lds
v_mfma_f32_16x16x32_bf16 v[48:51],a[232:235],v[72:75],v[48:51]
s_add_u32 m0,s50,139008
v_mfma_f32_16x16x32_bf16 v[64:67],v[72:75],v[232:235],v[64:67]
buffer_load_dwordx4 v20,s[8:11],s70 offen offset:256 sc1 lds
v_mfma_f32_16x16x32_bf16 v[32:35],a[104:107],v[72:75],v[32:35]
s_add_u32 m0,s50,143104
v_mfma_f32_16x16x32_bf16 v[52:55],a[232:235],v[76:79],v[52:55]
buffer_load_dwordx4 v20,s[8:11],s71 offen offset:256 sc1 lds
v_mfma_f32_16x16x32_bf16 v[68:71],v[76:79],v[232:235],v[68:71]
v_mfma_f32_16x16x32_bf16 v[36:39],a[104:107],v[76:79],v[36:39]
s_waitcnt lgkmcnt(2)
v_mfma_f32_16x16x32_bf16 v[40:43],a[228:231],v[80:83],v[40:43]
ds_read_b128 v[72:75],v11 offset:16384
v_mfma_f32_16x16x32_bf16 v[56:59],v[80:83],v[228:231],v[56:59]
v_mfma_f32_16x16x32_bf16 v[24:27],a[100:103],v[80:83],v[24:27]
ds_read_b128 v[76:79],v11 offset:20480
v_mfma_f32_16x16x32_bf16 v[44:47],a[228:231],v[84:87],v[44:47]
v_mfma_f32_16x16x32_bf16 v[60:63],v[84:87],v[228:231],v[60:63]
v_mfma_f32_16x16x32_bf16 v[28:31],a[100:103],v[84:87],v[28:31]
v_mfma_f32_16x16x32_bf16 v[48:51],a[236:239],v[80:83],v[48:51]
v_mfma_f32_16x16x32_bf16 v[64:67],v[80:83],v[236:239],v[64:67]
v_mfma_f32_16x16x32_bf16 v[32:35],a[108:111],v[80:83],v[32:35]
v_mfma_f32_16x16x32_bf16 v[52:55],a[236:239],v[84:87],v[52:55]
v_mfma_f32_16x16x32_bf16 v[68:71],v[84:87],v[236:239],v[68:71]
v_mfma_f32_16x16x32_bf16 v[36:39],a[108:111],v[84:87],v[36:39]
s_waitcnt lgkmcnt(2)
v_mfma_f32_16x16x32_bf16 v[40:43],a[240:243],v[108:111],v[40:43]
v_mfma_f32_16x16x32_bf16 v[56:59],v[108:111],v[240:243],v[56:59]
v_mfma_f32_16x16x32_bf16 v[24:27],a[112:115],v[108:111],v[24:27]
v_mfma_f32_16x16x32_bf16 v[44:47],a[240:243],v[112:115],v[44:47]
v_mfma_f32_16x16x32_bf16 v[60:63],v[112:115],v[240:243],v[60:63]
v_mfma_f32_16x16x32_bf16 v[28:31],a[112:115],v[112:115],v[28:31]
v_mfma_f32_16x16x32_bf16 v[48:51],a[248:251],v[108:111],v[48:51]
v_mfma_f32_16x16x32_bf16 v[64:67],v[108:111],v[248:251],v[64:67]
v_mfma_f32_16x16x32_bf16 v[32:35],a[120:123],v[108:111],v[32:35]
v_mfma_f32_16x16x32_bf16 v[52:55],a[248:251],v[112:115],v[52:55]
v_mfma_f32_16x16x32_bf16 v[68:71],v[112:115],v[248:251],v[68:71]
v_mfma_f32_16x16x32_bf16 v[36:39],a[120:123],v[112:115],v[36:39]
s_waitcnt lgkmcnt(0)
v_mfma_f32_16x16x32_bf16 v[40:43],a[244:247],v[72:75],v[40:43]
v_mfma_f32_16x16x32_bf16 v[56:59],v[72:75],v[244:247],v[56:59]
v_mfma_f32_16x16x32_bf16 v[24:27],a[116:119],v[72:75],v[24:27]
v_mfma_f32_16x16x32_bf16 v[44:47],a[244:247],v[76:79],v[44:47]
v_mfma_f32_16x16x32_bf16 v[60:63],v[76:79],v[244:247],v[60:63]
v_mfma_f32_16x16x32_bf16 v[28:31],a[116:119],v[76:79],v[28:31]
v_mfma_f32_16x16x32_bf16 v[48:51],a[252:255],v[72:75],v[48:51]
v_mfma_f32_16x16x32_bf16 v[64:67],v[72:75],v[252:255],v[64:67]
v_mfma_f32_16x16x32_bf16 v[32:35],a[124:127],v[72:75],v[32:35]
v_mfma_f32_16x16x32_bf16 v[52:55],a[252:255],v[76:79],v[52:55]
v_mfma_f32_16x16x32_bf16 v[68:71],v[76:79],v[252:255],v[68:71]
v_mfma_f32_16x16x32_bf16 v[36:39],a[124:127],v[76:79],v[36:39]
s_lshl_b32 s56,s51,5
s_add_u32 s56,s56,s47
s_lshl_b32 s56,s56,13
s_add_u32 s56,s56,s50
s_add_u32 s56,s56,41943040
s_add_u32 s57,s56,4096
v_mov_b64 v[120:121],-1
v_mov_b64 v[122:123],-1
buffer_store_dwordx4 v[120:123],v0,s[8:11],s56 offen sc1
buffer_store_dwordx4 v[120:123],v0,s[8:11],s57 offen sc1
v_cvt_pk_bf16_f32 v72,v40,v48
v_cvt_pk_bf16_f32 v73,v41,v49
v_cvt_pk_bf16_f32 v74,v42,v50
v_cvt_pk_bf16_f32 v75,v43,v51
buffer_store_dwordx4 v[72:75],v0,s[8:11],s61 offen sc1
v_cvt_pk_bf16_f32 v76,v44,v52
v_cvt_pk_bf16_f32 v77,v45,v53
v_cvt_pk_bf16_f32 v78,v46,v54
v_cvt_pk_bf16_f32 v79,v47,v55
buffer_store_dwordx4 v[76:79],v0,s[8:11],s62 offen sc1
v_cvt_pk_bf16_f32 v80,v56,v57
v_cvt_pk_bf16_f32 v81,v58,v59
v_cvt_pk_bf16_f32 v82,v60,v61
v_cvt_pk_bf16_f32 v83,v62,v63
buffer_store_dwordx4 v[80:83],v0,s[8:11],s65 offen offset:0 sc1
v_cvt_pk_bf16_f32 v84,v64,v65
v_cvt_pk_bf16_f32 v85,v66,v67
v_cvt_pk_bf16_f32 v86,v68,v69
v_cvt_pk_bf16_f32 v87,v70,v71
buffer_store_dwordx4 v[84:87],v0,s[8:11],s65 offen offset:1024 sc1
v_cvt_pk_bf16_f32 v108,v24,v32
v_cvt_pk_bf16_f32 v109,v25,v33
v_cvt_pk_bf16_f32 v110,v26,v34
v_cvt_pk_bf16_f32 v111,v27,v35
buffer_store_dwordx4 v[108:111],v0,s[8:11],s63 offen sc1
v_cvt_pk_bf16_f32 v112,v28,v36
v_cvt_pk_bf16_f32 v113,v29,v37
v_cvt_pk_bf16_f32 v114,v30,v38
v_cvt_pk_bf16_f32 v115,v31,v39
buffer_store_dwordx4 v[112:115],v0,s[8:11],s64 offen sc1
s_lshl_b32 s72,s51,13
s_lshl2_add_u32 s72,s47,s72
s_add_u32 s72,s72,10485760
s_add_u32 s51,s51,1
s_sub_u32 s53,s53,1
s_cmp_gt_u32 s53,0
s_cbranch_scc1 L_chl_79
s_waitcnt vmcnt(0)
s_barrier
s_or_b32 s72,s72,s52
buffer_store_dword v17,off,s[8:11],s72 sc1
L_chd_78:
s_cmp_lg_u32 s3,0
s_cbranch_scc1 L_wc
s_cmp_eq_u32 s48,1
s_cbranch_scc1 L_rc1_80
s_cmp_eq_u32 s48,2
s_cbranch_scc1 L_rc2_81
v_and_b32 v120,15,v1
v_lshrrev_b32 v121,4,v1
v_and_b32 v122,2,v1
v_cmp_eq_u32 vcc,0,v122
v_mov_b32 v2,0xeeee
v_mov_b32 v123,0x4444
v_cndmask_b32 v2,v2,v123,vcc
v_and_b32 v122,1,v1
v_cmp_eq_u32 vcc,0,v122
v_mov_b32 v3,0xdddd
v_mov_b32 v123,0x8888
v_cndmask_b32 v3,v3,v123,vcc
v_lshrrev_b32 v122,1,v120
v_bfe_u32 v123,v120,2,1
v_xor_b32 v123,v123,v122
v_lshlrev_b32 v4,7,v123
v_and_b32 v123,1,v120
v_lshl_add_u32 v4,v123,6,v4
v_xor_b32 v123,v121,v122
v_and_b32 v123,3,v123
v_lshl_add_u32 v4,v123,4,v4
s_lshl_b32 s56,s46,10
s_add_u32 s56,s56,147456
v_add_u32 v4,s56,v4
v_lshlrev_b32 v122,1,v121
v_add_u32 v122,0,v122
v_and_b32 v123,1,v121
v_xor_b32 v123,v123,v122
v_lshlrev_b32 v5,7,v123
v_bfe_u32 v123,v120,3,1
v_lshl_add_u32 v5,v123,6,v5
v_xor_b32 v123,v120,v122
v_and_b32 v123,3,v123
v_lshl_add_u32 v5,v123,4,v5
v_bfe_u32 v123,v120,2,1
v_lshl_add_u32 v5,v123,3,v5
v_add_u32 v5,147456,v5
v_lshlrev_b32 v122,1,v121
v_add_u32 v122,1,v122
v_and_b32 v123,1,v121
v_xor_b32 v123,v123,v122
v_lshlrev_b32 v6,7,v123
v_bfe_u32 v123,v120,3,1
v_lshl_add_u32 v6,v123,6,v6
v_xor_b32 v123,v120,v122
v_and_b32 v123,3,v123
v_lshl_add_u32 v6,v123,4,v6
v_bfe_u32 v123,v120,2,1
v_lshl_add_u32 v6,v123,3,v6
v_add_u32 v6,147456,v6
v_lshlrev_b32 v7,7,v121
v_lshrrev_b32 v122,1,v120
v_lshl_add_u32 v8,v122,4,v7
v_add_u32 v8,151552,v8
v_lshrrev_b32 v122,2,v120
v_lshl_add_u32 v7,v122,5,v7
v_and_b32 v122,1,v120
v_lshl_add_u32 v7,v122,4,v7
v_and_b32 v122,2,v120
v_lshl_add_u32 v7,v122,10,v7
s_lshl_b32 s56,s46,9
s_add_u32 s56,s56,151552
v_add_u32 v7,s56,v7
v_lshrrev_b32 v122,3,v1
v_lshlrev_b32 v9,11,v122
v_and_b32 v122,7,v1
v_lshl_add_u32 v9,v122,3,v9
s_lshl_b32 s56,s46,14
s_lshl_b32 s57,s47,6
s_add_u32 s56,s56,s57
v_add_u32 v9,s56,v9
s_lshl_b32 s71,s47,2
s_add_u32 s71,s71,s46
s_bfe_u32 s56,s71,0x10003
s_lshl_b32 s56,s56,11
s_and_b32 s57,s71,1
s_lshl_b32 s57,s57,10
s_add_u32 s56,s56,s57
s_bfe_u32 s57,s71,0x10002
s_lshl_b32 s57,s57,9
s_add_u32 s56,s56,s57
s_bfe_u32 s57,s71,0x10001
s_lshl_b32 s57,s57,6
s_add_u32 s56,s56,s57
s_bfe_u32 s57,s71,0x10004
s_lshl_b32 s57,s57,8
s_add_u32 s56,s56,s57
s_bfe_u32 s57,s71,0x10005
s_lshl_b32 s57,s57,7
s_add_u32 s56,s56,s57
s_bfe_u32 s57,s71,0x10006
s_lshl_b32 s57,s57,12
s_add_u32 s56,s56,s57
v_and_b32 v122,3,v120
v_lshlrev_b32 v10,2,v122
v_bfe_u32 v122,v120,3,1
v_lshl_add_u32 v10,v122,4,v10
v_and_b32 v122,1,v121
v_lshl_add_u32 v10,v122,5,v10
v_add_u32 v10,s56,v10
v_and_b32 v123,36,v1
v_mov_b32 v122,0x80000000
v_cmp_eq_u32 vcc,0,v123
s_nop 1
v_cndmask_b32 v10,v122,v10,vcc
s_lshl_b32 s56,s46,15
v_add_u32 v11,s56,v0
s_lshl_b32 s71,s71,11
s_lshl_b32 s73,s46,11
s_mov_b32 s72,0xffc00000
s_mov_b32 s74,0
v_lshrrev_b32 v13,3,v1
v_lshlrev_b32 v13,9,v13
v_and_b32 v122,7,v1
v_lshl_add_u32 v13,v122,4,v13
v_and_b32 v122,15,v1
v_and_b32 v123,1,v1
v_lshlrev_b32 v123,4,v123
v_mov_b32 v124,0x3f80
v_lshlrev_b32 v124,v123,v124
v_lshrrev_b32 v122,1,v122
v_cmp_eq_u32 vcc,0,v122
s_nop 1
v_cndmask_b32 v18,0,v124,vcc
v_cmp_eq_u32 vcc,1,v122
s_nop 1
v_cndmask_b32 v19,0,v124,vcc
v_cmp_eq_u32 vcc,2,v122
s_nop 1
v_cndmask_b32 v20,0,v124,vcc
v_cmp_eq_u32 vcc,3,v122
s_nop 1
v_cndmask_b32 v21,0,v124,vcc
s_and_b32 s56,s46,1
s_lshl_b32 s56,s56,8
s_and_b32 s57,s46,2
s_lshl_b32 s57,s57,6
s_add_u32 s56,s56,s57
v_add_u32 v13,s56,v13
s_xor_b32 s56,s46,0
s_lshl_b32 s56,s56,10
s_add_u32 s56,s56,147456
v_add_u32 v14,s56,v0
s_xor_b32 s56,s46,1
s_lshl_b32 s56,s56,10
s_add_u32 s56,s56,147456
v_add_u32 v15,s56,v0
s_xor_b32 s56,s46,2
s_lshl_b32 s56,s56,10
s_add_u32 s56,s56,147456
v_add_u32 v16,s56,v0
s_xor_b32 s56,s46,3
s_lshl_b32 s56,s56,10
s_add_u32 s56,s56,147456
v_add_u32 v17,s56,v0
v_add_u32 v22,11550720,v10
s_lshl_b32 s56,s47,2
s_add_u32 s56,s56,10502144
v_writelane_b32 v22,s56,4
s_mov_b32 s56,10519808
v_writelane_b32 v22,s56,5
v_add_u32 v1,131072,v0
s_mov_b32 s65,14680064
s_add_u32 s66,s71,14680064
s_add_u32 s69,s71,14942208
s_lshl_b32 s79,s47,2
s_add_u32 s79,s79,10485760
s_cmp_eq_u32 s46,0
s_cselect_b32 s79,s79,0x80000000
s_cmp_eq_u32 s47,0
s_cselect_b32 s31,17825792,-1
s_and_b32 s31,s31,0x8fffffff
s_mov_b32 s51,0
L_cst_82:
s_lshl_b32 s59,s51,13
s_lshl2_add_u32 s59,s47,s59
s_add_u32 s59,s59,10485760
L_ww_87:
buffer_load_dword v120,off,s[8:11],s59 sc1
s_sub_u32 s49,s49,1
s_cbranch_scc1 L_abort
s_waitcnt vmcnt(0)
v_readfirstlane_b32 s61,v120
s_cmp_eq_u32 s61,0
s_cbranch_scc1 L_ww_87
L_wwd_88:
s_lshl_b32 s56,s51,5
s_add_u32 s56,s56,s47
s_mul_i32 s56,s56,24576
s_add_u32 s56,s56,100663296
s_add_u32 s67,s56,s73
s_add_u32 m0,s73,131072
s_add_u32 s57,s67,8192
buffer_load_dwordx4 v0,s[8:11],s67 offen sc1 lds
buffer_load_dwordx4 v0,s[8:11],s67 offen offset:1024 sc1 lds
s_add_u32 m0,s73,139264
s_add_u32 s67,s67,786432
buffer_load_dwordx4 v0,s[8:11],s57 offen sc1 lds
buffer_load_dwordx4 v0,s[8:11],s57 offen offset:1024 sc1 lds
s_lshl_b32 s75,s51,13
s_add_u32 s64,s75,11534336
s_add_u32 s70,s64,4096
s_lshl_b32 s68,s51,5
s_add_u32 s68,s68,s47
s_lshl_b32 s68,s68,13
s_lshl_b32 s56,s46,10
s_add_u32 s68,s68,s56
s_add_u32 s68,s68,41943040
s_sub_u32 s67,s67,0
s_mov_b32 s78,0x80000000
s_cmp_eq_u32 s51,63
s_cselect_b32 s76,1,0
s_waitcnt vmcnt(0)
s_barrier
ds_read_b128 v[56:59],v1 offset:0
ds_read_b128 v[60:63],v1 offset:4096
ds_read_b128 v[64:67],v1 offset:1024
ds_read_b128 v[68:71],v1 offset:5120
ds_read_b128 v[72:75],v1 offset:2048
ds_read_b128 v[76:79],v1 offset:6144
ds_read_b128 v[80:83],v1 offset:3072
ds_read_b128 v[84:87],v1 offset:7168
v_add_u32 v12,s73,v1
ds_read_b128 v[88:91],v12 offset:8192
ds_read_b128 v[92:95],v12 offset:9216
v_mov_b64 v[96:97],0
v_mov_b64 v[98:99],0
v_mov_b64 v[100:101],0
v_mov_b64 v[102:103],0
v_mov_b64 v[104:105],0
v_mov_b64 v[106:107],0
v_mov_b64 v[108:109],0
v_mov_b64 v[110:111],0
v_mov_b64 v[112:113],0
v_mov_b64 v[114:115],0
v_mov_b64 v[116:117],0
v_mov_b64 v[118:119],0
buffer_load_dwordx4 v[24:27],v13,s[8:11],s64 offen sc1
L_chain_89:
L_cpa_90:
buffer_load_dwordx4 v[24:27],v13,s[8:11],s64 offen sc1
s_sub_u32 s49,s49,1
s_cbranch_scc1 L_abort
s_waitcnt vmcnt(1)
v_max3_u32 v12,v24,v25,v26
v_max_u32 v12,v27,v12
v_cmp_le_u32 vcc,s72,v12
s_cbranch_vccnz L_cpa_90
L_cgo_93:
ds_write_b128 v14,v[24:27] offset:0
buffer_load_dwordx4 v[40:43],v13,s[8:11],s70 offen sc1
v_smfmac_f32_16x16x64_bf16 v[96:99],v[24:27],a[0:7],v2
s_add_u32 m0,s73,131072
v_smfmac_f32_16x16x64_bf16 v[100:103],v[24:27],a[128:135],v2
s_add_u32 s57,s67,8192
v_smfmac_f32_16x16x64_bf16 v[104:107],v[24:27],a[8:15],v2
v_smfmac_f32_16x16x64_bf16 v[108:111],v[24:27],a[136:143],v2
s_waitcnt lgkmcnt(0)
s_barrier
ds_read_b128 v[28:31],v15 offset:0
ds_read_b128 v[32:35],v16 offset:0
ds_read_b128 v[36:39],v17 offset:0
v_smfmac_f32_16x16x64_bf16 v[112:115],v[24:27],v[128:135],v2
v_smfmac_f32_16x16x64_bf16 v[116:119],v[24:27],v[136:143],v2
s_waitcnt lgkmcnt(2)
v_smfmac_f32_16x16x64_bf16 v[96:99],v[28:31],a[16:23],v2
s_lshl_b32 s56,s46,10
v_smfmac_f32_16x16x64_bf16 v[100:103],v[28:31],a[144:151],v2
v_smfmac_f32_16x16x64_bf16 v[104:107],v[28:31],a[24:31],v2
v_smfmac_f32_16x16x64_bf16 v[108:111],v[28:31],a[152:159],v2
s_waitcnt lgkmcnt(1) vmcnt(0)
v_smfmac_f32_16x16x64_bf16 v[96:99],v[32:35],a[32:39],v2
v_max3_u32 v12,v40,v41,v42
v_smfmac_f32_16x16x64_bf16 v[100:103],v[32:35],a[160:167],v2
v_max_u32 v12,v43,v12
v_smfmac_f32_16x16x64_bf16 v[104:107],v[32:35],a[40:47],v2
v_cmp_le_u32 vcc,s72,v12
v_smfmac_f32_16x16x64_bf16 v[108:111],v[32:35],a[168:175],v2
s_cbranch_vccnz L_cpb_96
L_cback_98:
s_waitcnt lgkmcnt(0)
ds_write_b128 v14,v[40:43] offset:4096
v_smfmac_f32_16x16x64_bf16 v[96:99],v[36:39],a[48:55],v2
v_mov_b64 v[120:121],-1
v_smfmac_f32_16x16x64_bf16 v[100:103],v[36:39],a[176:183],v2
v_mov_b64 v[122:123],-1
v_smfmac_f32_16x16x64_bf16 v[104:107],v[36:39],a[56:63],v2
v_add_u32 v124,s56,v5
v_smfmac_f32_16x16x64_bf16 v[108:111],v[36:39],a[184:191],v2
v_add_u32 v126,s56,v6
s_waitcnt lgkmcnt(0)
s_barrier
v_smfmac_f32_16x16x64_bf16 v[96:99],v[40:43],a[64:71],v2
ds_read_b128 v[44:47],v15 offset:4096
v_smfmac_f32_16x16x64_bf16 v[100:103],v[40:43],a[192:199],v2
ds_read_b128 v[48:51],v16 offset:4096
v_smfmac_f32_16x16x64_bf16 v[104:107],v[40:43],a[72:79],v2
ds_read_b128 v[52:55],v17 offset:4096
v_smfmac_f32_16x16x64_bf16 v[108:111],v[40:43],a[200:207],v2
s_cmp_eq_u32 s76,0
s_cbranch_scc1 L_ckw_83
L_ckb_84:
s_waitcnt lgkmcnt(2)
v_smfmac_f32_16x16x64_bf16 v[96:99],v[44:47],a[80:87],v2
buffer_load_dwordx4 v0,s[8:11],s67 offen sc1 lds
v_smfmac_f32_16x16x64_bf16 v[100:103],v[44:47],a[208:215],v2
buffer_load_dwordx4 v0,s[8:11],s67 offen offset:1024 sc1 lds
v_smfmac_f32_16x16x64_bf16 v[104:107],v[44:47],a[88:95],v2
s_add_u32 m0,s73,139264
v_smfmac_f32_16x16x64_bf16 v[108:111],v[44:47],a[216:223],v2
s_waitcnt lgkmcnt(1)
v_smfmac_f32_16x16x64_bf16 v[96:99],v[48:51],a[96:103],v2
s_add_u32 s67,s67,786432
v_smfmac_f32_16x16x64_bf16 v[100:103],v[48:51],a[224:231],v2
buffer_load_dwordx4 v0,s[8:11],s57 offen sc1 lds
v_smfmac_f32_16x16x64_bf16 v[104:107],v[48:51],a[104:111],v2
buffer_load_dwordx4 v0,s[8:11],s57 offen offset:1024 sc1 lds
v_smfmac_f32_16x16x64_bf16 v[108:111],v[48:51],a[232:239],v2
s_waitcnt lgkmcnt(0)
v_smfmac_f32_16x16x64_bf16 v[96:99],v[52:55],a[112:119],v2
buffer_load_dword v23,v22,s[8:11],s75 offen sc1
v_smfmac_f32_16x16x64_bf16 v[100:103],v[52:55],a[240:247],v2
buffer_store_dwordx4 v[120:123],v0,s[8:11],s69 offen
v_smfmac_f32_16x16x64_bf16 v[104:107],v[52:55],a[120:127],v2
buffer_store_dwordx4 v[120:123],v0,s[8:11],s69 offen offset:1024
v_smfmac_f32_16x16x64_bf16 v[108:111],v[52:55],a[248:255],v2
v_smfmac_f32_16x16x64_bf16 v[112:115],v[28:31],v[144:151],v2
v_smfmac_f32_16x16x64_bf16 v[116:119],v[28:31],v[152:159],v2
v_pk_add_f32 v[96:97],v[96:97],v[98:99]
v_pk_add_f32 v[100:101],v[100:101],v[102:103]
v_cvt_pk_bf16_f32 v120,v96,v97
v_cvt_pk_bf16_f32 v121,v100,v101
v_pk_add_f32 v[104:105],v[104:105],v[106:107]
v_pk_add_f32 v[108:109],v[108:109],v[110:111]
v_cvt_pk_bf16_f32 v122,v104,v105
v_cvt_pk_bf16_f32 v123,v108,v109
ds_write_b128 v4,v[120:123]
v_smfmac_f32_16x16x64_bf16 v[112:115],v[32:35],v[160:167],v2
v_smfmac_f32_16x16x64_bf16 v[116:119],v[32:35],v[168:175],v2
v_smfmac_f32_16x16x64_bf16 v[112:115],v[36:39],v[176:183],v2
v_smfmac_f32_16x16x64_bf16 v[116:119],v[36:39],v[184:191],v2
s_waitcnt lgkmcnt(0)
s_barrier
ds_read_b64_tr_b16 v[96:97],v5 offset:0
ds_read_b64_tr_b16 v[98:99],v6 offset:0
ds_read_b64_tr_b16 v[100:101],v5 offset:1024
ds_read_b64_tr_b16 v[102:103],v6 offset:1024
ds_read_b64_tr_b16 v[104:105],v5 offset:2048
ds_read_b64_tr_b16 v[106:107],v6 offset:2048
ds_read_b64_tr_b16 v[108:109],v5 offset:3072
ds_read_b64_tr_b16 v[110:111],v6 offset:3072
ds_read_b64_tr_b16 v[124:125],v124
ds_read_b64_tr_b16 v[126:127],v126
v_smfmac_f32_16x16x64_bf16 v[112:115],v[40:43],v[192:199],v2
v_smfmac_f32_16x16x64_bf16 v[116:119],v[40:43],v[200:207],v2
s_waitcnt lgkmcnt(8)
v_mfma_f32_16x16x32_bf16 v[24:27],v[56:59],v[96:99],0
v_mfma_f32_16x16x32_bf16 v[28:31],v[60:63],v[96:99],0
v_mfma_f32_16x16x32_bf16 v[32:35],v[96:99],v[96:99],0
s_waitcnt lgkmcnt(6)
v_mfma_f32_16x16x32_bf16 v[24:27],v[64:67],v[100:103],v[24:27]
ds_read_b128 v[56:59],v11 offset:0
v_mfma_f32_16x16x32_bf16 v[28:31],v[68:71],v[100:103],v[28:31]
ds_read_b128 v[60:63],v11 offset:1024
v_mfma_f32_16x16x32_bf16 v[32:35],v[100:103],v[100:103],v[32:35]
s_waitcnt lgkmcnt(6)
v_mfma_f32_16x16x32_bf16 v[24:27],v[72:75],v[104:107],v[24:27]
ds_read_b128 v[64:67],v11 offset:2048
v_mfma_f32_16x16x32_bf16 v[28:31],v[76:79],v[104:107],v[28:31]
ds_read_b128 v[68:71],v11 offset:3072
v_mfma_f32_16x16x32_bf16 v[32:35],v[104:107],v[104:107],v[32:35]
s_waitcnt lgkmcnt(6)
v_mfma_f32_16x16x32_bf16 v[24:27],v[80:83],v[108:111],v[24:27]
ds_read_b128 v[72:75],v11 offset:4096
v_mfma_f32_16x16x32_bf16 v[28:31],v[84:87],v[108:111],v[28:31]
ds_read_b128 v[76:79],v11 offset:5120
v_mfma_f32_16x16x32_bf16 v[32:35],v[108:111],v[108:111],v[32:35]
s_waitcnt lgkmcnt(6)
v_smfmac_f32_16x16x64_bf16 v[112:115],v[44:47],v[208:215],v2
buffer_store_dwordx4 v[124:127],v0,s[8:11],s68 offen sc1
v_smfmac_f32_16x16x64_bf16 v[116:119],v[44:47],v[216:223],v2
v_smfmac_f32_16x16x64_bf16 v[112:115],v[48:51],v[224:231],v2
v_smfmac_f32_16x16x64_bf16 v[116:119],v[48:51],v[232:239],v2
v_smfmac_f32_16x16x64_bf16 v[112:115],v[52:55],v[240:247],v2
v_smfmac_f32_16x16x64_bf16 v[116:119],v[52:55],v[248:255],v2
v_mov_b32 v125,0
v_mov_b64 v[52:53],s[28:29]
v_mov_b64 v[54:55],s[28:29]
v_max3_f32 v36,v24,v25,v26
v_max3_f32 v37,v27,v28,v29
v_max3_f32 v36,v30,v31,v36
v_max3_f32 v37,v34,v35,v37
v_max_f32 v36,v36,v37
v_max_f32 v37,v36,v37
ds_read_b128 v[80:83],v11 offset:6144
s_nop 0
v_permlane16_swap_b32 v36,v37
v_max_f32 v36,v36,v37
v_max_f32 v37,v36,v37
ds_read_b128 v[84:87],v11 offset:7168
s_nop 0
v_permlane32_swap_b32 v36,v37
v_max_f32 v36,v36,v37
v_mul_f32 v36,s80,v36
v_fma_f32 v24,v24,s80,-v36
v_fma_f32 v25,v25,s80,-v36
v_exp_f32 v24,v24
v_fma_f32 v26,v26,s80,-v36
v_exp_f32 v25,v25
v_fma_f32 v27,v27,s80,-v36
v_exp_f32 v26,v26
v_fma_f32 v28,v28,s80,-v36
v_exp_f32 v27,v27
v_fma_f32 v29,v29,s80,-v36
v_exp_f32 v28,v28
v_fma_f32 v30,v30,s80,-v36
v_exp_f32 v29,v29
v_fma_f32 v31,v31,s80,-v36
v_exp_f32 v30,v30
v_fma_f32 v34,v34,s80,-v36
v_exp_f32 v31,v31
v_fma_f32 v35,v35,s80,-v36
v_exp_f32 v34,v34
v_exp_f32 v35,v35
v_cvt_pk_bf16_f32 v120,v24,v25
v_cvt_pk_bf16_f32 v121,v26,v27
v_cvt_pk_bf16_f32 v122,v28,v29
v_cvt_pk_bf16_f32 v123,v30,v31
v_cvt_pk_bf16_f32 v124,v34,v35
s_nop 0
v_mfma_f32_16x16x32_bf16 v[32:35],v[52:55],v[120:123],0
v_pk_add_f32 v[112:113],v[112:113],v[114:115]
v_pk_add_f32 v[116:117],v[116:117],v[118:119]
v_mfma_f32_16x16x32_bf16 v[24:27],v[88:91],v[120:123],0
v_cvt_pk_bf16_f32 v36,v112,v113
v_cvt_pk_bf16_f32 v37,v116,v117
v_mfma_f32_16x16x32_bf16 v[28:31],v[92:95],v[120:123],0
v_cvt_pk_bf16_f32 v38,v116,v117
v_mov_b32 v39,0
v_mfma_f32_16x16x16_bf16 v[32:35],v[52:53],v[124:125],v[32:35]
s_add_u32 s56,s68,4096
buffer_store_dwordx4 v[36:39],v0,s[8:11],s56 offen sc1
v_mfma_f32_16x16x16_bf16 v[24:27],v[36:37],v[124:125],v[24:27]
ds_read_b128 v[96:99],v11 offset:8192
v_mfma_f32_16x16x16_bf16 v[28:31],v[38:39],v[124:125],v[28:31]
ds_read_b128 v[100:103],v11 offset:9216
v_rcp_f32 v32,v32
v_mov_b64 v[112:113],0
v_mov_b64 v[114:115],0
v_pk_mul_f32 v[24:25],v[24:25],v[32:33] op_sel_hi:[1,0]
v_pk_mul_f32 v[26:27],v[26:27],v[32:33] op_sel_hi:[1,0]
v_mov_b64 v[116:117],0
v_mov_b64 v[118:119],0
v_pk_mul_f32 v[28:29],v[28:29],v[32:33] op_sel_hi:[1,0]
v_pk_mul_f32 v[30:31],v[30:31],v[32:33] op_sel_hi:[1,0]
v_cvt_pk_bf16_f32 v120,v24,v28
v_cvt_pk_bf16_f32 v121,v25,v29
v_cvt_pk_bf16_f32 v122,v26,v30
v_cvt_pk_bf16_f32 v123,v27,v31
ds_write_b128 v7,v[120:123]
ds_read_b128 v[104:107],v11 offset:10240
ds_read_b128 v[108:111],v11 offset:11264
ds_read_b128 v[40:43],v11 offset:12288
ds_read_b128 v[44:47],v11 offset:13312
s_waitcnt lgkmcnt(4)
s_barrier
ds_read_b128 v[24:27],v8 offset:0
ds_read_b128 v[28:31],v8 offset:512
ds_read_b128 v[32:35],v8 offset:1024
ds_read_b128 v[36:39],v8 offset:1536
ds_read_b128 v[48:51],v11 offset:14336
ds_read_b128 v[52:55],v11 offset:15360
v_mov_b64 v[88:89],0
v_mov_b64 v[90:91],0
v_mov_b64 v[92:93],0
v_mov_b64 v[94:95],0
s_waitcnt lgkmcnt(5)
v_smfmac_f32_16x16x64_bf16 v[112:115],v[24:27],v[56:63],v3
ds_read_b128 v[56:59],v11 offset:16384
ds_read_b128 v[60:63],v11 offset:17408
s_waitcnt lgkmcnt(6)
v_smfmac_f32_16x16x64_bf16 v[112:115],v[28:31],v[64:71],v3
ds_read_b128 v[64:67],v11 offset:18432
ds_read_b128 v[68:71],v11 offset:19456
s_waitcnt lgkmcnt(7)
v_smfmac_f32_16x16x64_bf16 v[112:115],v[32:35],v[72:79],v3
ds_read_b128 v[72:75],v11 offset:20480
ds_read_b128 v[76:79],v11 offset:21504
s_waitcnt lgkmcnt(8)
v_smfmac_f32_16x16x64_bf16 v[112:115],v[36:39],v[80:87],v3
ds_read_b128 v[80:83],v11 offset:22528
ds_read_b128 v[84:87],v11 offset:23552
s_waitcnt lgkmcnt(8)
v_smfmac_f32_16x16x64_bf16 v[116:119],v[24:27],v[96:103],v3
ds_read_b128 v[96:99],v11 offset:24576
ds_read_b128 v[100:103],v11 offset:25600
v_smfmac_f32_16x16x64_bf16 v[116:119],v[28:31],v[104:111],v3
v_cvt_pk_bf16_f32 v112,v112,v113
v_cvt_pk_bf16_f32 v113,v114,v115
buffer_store_dwordx2 v[112:113],v9,s[8:11],s65 offen
ds_read_b128 v[104:107],v11 offset:26624
ds_read_b128 v[108:111],v11 offset:27648
v_smfmac_f32_16x16x64_bf16 v[116:119],v[32:35],v[40:47],v3
ds_read_b128 v[40:43],v11 offset:28672
ds_read_b128 v[44:47],v11 offset:29696
v_smfmac_f32_16x16x64_bf16 v[116:119],v[36:39],v[48:55],v3
s_waitcnt lgkmcnt(12)
ds_read_b128 v[48:51],v11 offset:30720
ds_read_b128 v[52:55],v11 offset:31744
s_waitcnt lgkmcnt(14)
v_smfmac_f32_16x16x64_bf16 v[88:91],v[24:27],v[56:63],v3
s_nop 2
v_cvt_pk_bf16_f32 v116,v116,v117
v_cvt_pk_bf16_f32 v117,v118,v119
s_add_u32 s56,s65,65536
buffer_store_dwordx2 v[116:117],v9,s[8:11],s56 offen
s_waitcnt lgkmcnt(12)
v_smfmac_f32_16x16x64_bf16 v[88:91],v[28:31],v[64:71],v3
s_waitcnt lgkmcnt(10)
v_smfmac_f32_16x16x64_bf16 v[88:91],v[32:35],v[72:79],v3
s_waitcnt lgkmcnt(8)
v_smfmac_f32_16x16x64_bf16 v[88:91],v[36:39],v[80:87],v3
s_waitcnt lgkmcnt(6)
v_smfmac_f32_16x16x64_bf16 v[92:95],v[24:27],v[96:103],v3
s_waitcnt lgkmcnt(4)
v_smfmac_f32_16x16x64_bf16 v[92:95],v[28:31],v[104:111],v3
v_cvt_pk_bf16_f32 v88,v88,v89
v_cvt_pk_bf16_f32 v89,v90,v91
s_add_u32 s56,s65,131072
buffer_store_dwordx2 v[88:89],v9,s[8:11],s56 offen
s_waitcnt lgkmcnt(2)
v_smfmac_f32_16x16x64_bf16 v[92:95],v[32:35],v[40:47],v3
s_waitcnt lgkmcnt(0)
v_smfmac_f32_16x16x64_bf16 v[92:95],v[36:39],v[48:55],v3
s_add_u32 s78,s79,s75
s_add_u32 s75,s75,8192
s_add_u32 s64,s75,11534336
s_add_u32 s70,s64,4096
s_add_u32 s68,s68,262144
s_add_u32 s51,s51,1
s_nop 1
v_cvt_pk_bf16_f32 v92,v92,v93
v_cvt_pk_bf16_f32 v93,v94,v95
s_add_u32 s56,s65,196608
buffer_store_dwordx2 v[92:93],v9,s[8:11],s56 offen
s_xor_b32 s65,s65,262144
s_cmp_eq_u32 s51,64
s_cbranch_scc1 L_cend_92
s_cmp_lt_u32 s47,16
s_waitcnt vmcnt(2)
s_cbranch_scc1 L_cea_99
s_barrier
ds_read_b128 v[56:59],v1 offset:0
ds_read_b128 v[60:63],v1 offset:4096
ds_read_b128 v[64:67],v1 offset:1024
ds_read_b128 v[68:71],v1 offset:5120
ds_read_b128 v[72:75],v1 offset:2048
ds_read_b128 v[76:79],v1 offset:6144
ds_read_b128 v[80:83],v1 offset:3072
ds_read_b128 v[84:87],v1 offset:7168
v_add_u32 v12,s73,v1
ds_read_b128 v[88:91],v12 offset:8192
ds_read_b128 v[92:95],v12 offset:9216
v_mov_b64 v[96:97],0
v_mov_b64 v[98:99],0
v_mov_b64 v[100:101],0
v_mov_b64 v[102:103],0
v_mov_b64 v[104:105],0
v_mov_b64 v[106:107],0
v_mov_b64 v[108:109],0
v_mov_b64 v[110:111],0
v_mov_b64 v[112:113],0
v_mov_b64 v[114:115],0
v_mov_b64 v[116:117],0
v_mov_b64 v[118:119],0
v_readlane_b32 s76,v23,4
s_cmp_ge_u32 s51,63
s_cselect_b32 s76,1,s76
s_waitcnt vmcnt(0)
L_crp_94:
buffer_load_dwordx4 v[120:123],v0,s[8:11],s66 offen offset:0 sc1
buffer_load_dwordx4 v[124:127],v0,s[8:11],s66 offen offset:1024 sc1
s_sub_u32 s49,s49,1
s_cbranch_scc1 L_abort
s_waitcnt vmcnt(1)
v_mfma_f32_16x16x32_bf16 v[28:31],v[18:21],v[120:123],0
s_waitcnt vmcnt(0)
v_mfma_f32_16x16x32_bf16 v[28:31],v[18:21],v[124:127],v[28:31]
s_nop 7
v_cmp_u_f32 vcc,v28,v28
v_add_f32_dpp v32,v28,v28 row_ror:8 row_mask:0xf bank_mask:0x3
v_add_f32_dpp v33,v29,v29 row_ror:8 row_mask:0xf bank_mask:0x3
v_add_f32_dpp v32,v30,v30 row_ror:8 row_mask:0xf bank_mask:0xc
v_add_f32_dpp v33,v31,v31 row_ror:8 row_mask:0xf bank_mask:0xc
s_nop 0
v_add_f32_dpp v32,v32,v32 row_shl:4 row_mask:0xf bank_mask:0x5
v_add_f32_dpp v33,v33,v33 row_shl:4 row_mask:0xf bank_mask:0x5
s_cbranch_vccnz L_crp_94
v_cvt_pk_bf16_f32 v34,v32,v33
buffer_store_dword v34,v10,s[8:11],s64 offen
s_mov_b32 s69,s66
s_xor_b32 s66,s66,262144
buffer_load_dwordx4 v[24:27],v13,s[8:11],s64 offen sc1
s_branch L_chain_89
L_cea_99:
buffer_load_dwordx4 v[120:123],v0,s[8:11],s66 offen offset:0 sc1
buffer_load_dwordx4 v[124:127],v0,s[8:11],s66 offen offset:1024 sc1
v_mov_b64 v[96:97],0
v_mov_b64 v[98:99],0
v_mov_b64 v[100:101],0
v_mov_b64 v[102:103],0
v_mov_b64 v[104:105],0
v_mov_b64 v[106:107],0
v_mov_b64 v[108:109],0
v_mov_b64 v[110:111],0
v_mov_b64 v[112:113],0
v_mov_b64 v[114:115],0
v_mov_b64 v[116:117],0
v_mov_b64 v[118:119],0
v_readlane_b32 s76,v23,4
s_cmp_ge_u32 s51,63
s_cselect_b32 s76,1,s76
s_branch L_cr1_100
L_crb_95:
buffer_load_dwordx4 v[120:123],v0,s[8:11],s66 offen offset:0 sc1
buffer_load_dwordx4 v[124:127],v0,s[8:11],s66 offen offset:1024 sc1
L_cr1_100:
s_sub_u32 s49,s49,1
s_cbranch_scc1 L_abort
s_waitcnt vmcnt(1)
v_mfma_f32_16x16x32_bf16 v[28:31],v[18:21],v[120:123],0
s_waitcnt vmcnt(0)
v_mfma_f32_16x16x32_bf16 v[28:31],v[18:21],v[124:127],v[28:31]
s_nop 7
v_cmp_u_f32 vcc,v28,v28
v_add_f32_dpp v32,v28,v28 row_ror:8 row_mask:0xf bank_mask:0x3
v_add_f32_dpp v33,v29,v29 row_ror:8 row_mask:0xf bank_mask:0x3
v_add_f32_dpp v32,v30,v30 row_ror:8 row_mask:0xf bank_mask:0xc
v_add_f32_dpp v33,v31,v31 row_ror:8 row_mask:0xf bank_mask:0xc
s_nop 0
v_add_f32_dpp v32,v32,v32 row_shl:4 row_mask:0xf bank_mask:0x5
v_add_f32_dpp v33,v33,v33 row_shl:4 row_mask:0xf bank_mask:0x5
s_cbranch_vccnz L_crb_95
v_cvt_pk_bf16_f32 v34,v32,v33
buffer_store_dword v34,v10,s[8:11],s64 offen
s_mov_b32 s69,s66
s_xor_b32 s66,s66,262144
s_barrier
ds_read_b128 v[56:59],v1 offset:0
ds_read_b128 v[60:63],v1 offset:4096
ds_read_b128 v[64:67],v1 offset:1024
ds_read_b128 v[68:71],v1 offset:5120
buffer_load_dwordx4 v[24:27],v13,s[8:11],s64 offen sc1
ds_read_b128 v[72:75],v1 offset:2048
ds_read_b128 v[76:79],v1 offset:6144
ds_read_b128 v[80:83],v1 offset:3072
ds_read_b128 v[84:87],v1 offset:7168
v_add_u32 v12,s73,v1
ds_read_b128 v[88:91],v12 offset:8192
ds_read_b128 v[92:95],v12 offset:9216
s_branch L_chain_89
L_ckw_83:
s_lshl2_add_u32 s59,s47,s75
s_add_u32 s59,s59,10493952
L_ww_101:
buffer_load_dword v23,off,s[8:11],s59 sc1
s_sub_u32 s49,s49,1
s_cbranch_scc1 L_abort
s_waitcnt vmcnt(0)
v_readfirstlane_b32 s76,v23
s_cmp_eq_u32 s76,0
s_cbranch_scc1 L_ww_101
L_wwd_102:
s_branch L_ckb_84
L_cpb_96:
buffer_load_dwordx4 v[40:43],v13,s[8:11],s70 offen sc1
s_waitcnt vmcnt(0)
v_max3_u32 v12,v40,v41,v42
v_max_u32 v12,v43,v12
v_cmp_le_u32 vcc,s72,v12
s_cbranch_vccz L_cback_98
s_sub_u32 s49,s49,1
s_cmp_gt_i32 s49,0
s_cbranch_scc1 L_cpb_96
s_branch L_abort
L_cend_92:
s_waitcnt vmcnt(0)
s_barrier
s_nop 11
v_lshrrev_b32 v1,4,v0
s_branch L_ra_6
L_rc1_80:
v_and_b32 v120,15,v1
v_lshrrev_b32 v121,4,v1
v_and_b32 v122,2,v1
v_cmp_eq_u32 vcc,0,v122
v_mov_b32 v2,0xeeee
v_mov_b32 v123,0x4444
v_cndmask_b32 v2,v2,v123,vcc
v_and_b32 v122,1,v1
v_cmp_eq_u32 vcc,0,v122
v_mov_b32 v3,0xdddd
v_mov_b32 v123,0x8888
v_cndmask_b32 v3,v3,v123,vcc
v_lshrrev_b32 v122,1,v120
v_bfe_u32 v123,v120,2,1
v_xor_b32 v123,v123,v122
v_lshlrev_b32 v4,7,v123
v_and_b32 v123,1,v120
v_lshl_add_u32 v4,v123,6,v4
v_xor_b32 v123,v121,v122
v_and_b32 v123,3,v123
v_lshl_add_u32 v4,v123,4,v4
s_lshl_b32 s56,s46,10
s_add_u32 s56,s56,147456
v_add_u32 v4,s56,v4
v_lshlrev_b32 v122,1,v121
v_add_u32 v122,0,v122
v_and_b32 v123,1,v121
v_xor_b32 v123,v123,v122
v_lshlrev_b32 v5,7,v123
v_bfe_u32 v123,v120,3,1
v_lshl_add_u32 v5,v123,6,v5
v_xor_b32 v123,v120,v122
v_and_b32 v123,3,v123
v_lshl_add_u32 v5,v123,4,v5
v_bfe_u32 v123,v120,2,1
v_lshl_add_u32 v5,v123,3,v5
v_add_u32 v5,147456,v5
v_lshlrev_b32 v122,1,v121
v_add_u32 v122,1,v122
v_and_b32 v123,1,v121
v_xor_b32 v123,v123,v122
v_lshlrev_b32 v6,7,v123
v_bfe_u32 v123,v120,3,1
v_lshl_add_u32 v6,v123,6,v6
v_xor_b32 v123,v120,v122
v_and_b32 v123,3,v123
v_lshl_add_u32 v6,v123,4,v6
v_bfe_u32 v123,v120,2,1
v_lshl_add_u32 v6,v123,3,v6
v_add_u32 v6,147456,v6
v_lshlrev_b32 v7,7,v121
v_lshrrev_b32 v122,1,v120
v_lshl_add_u32 v8,v122,4,v7
v_add_u32 v8,151552,v8
v_lshrrev_b32 v122,2,v120
v_lshl_add_u32 v7,v122,5,v7
v_and_b32 v122,1,v120
v_lshl_add_u32 v7,v122,4,v7
v_and_b32 v122,2,v120
v_lshl_add_u32 v7,v122,10,v7
s_lshl_b32 s56,s46,9
s_add_u32 s56,s56,151552
v_add_u32 v7,s56,v7
v_lshrrev_b32 v122,3,v1
v_lshlrev_b32 v9,11,v122
v_and_b32 v122,7,v1
v_lshl_add_u32 v9,v122,3,v9
s_lshl_b32 s56,s46,14
s_lshl_b32 s57,s47,6
s_add_u32 s56,s56,s57
v_add_u32 v9,s56,v9
s_lshl_b32 s71,s47,2
s_add_u32 s71,s71,s46
s_bfe_u32 s56,s71,0x10003
s_lshl_b32 s56,s56,11
s_and_b32 s57,s71,1
s_lshl_b32 s57,s57,10
s_add_u32 s56,s56,s57
s_bfe_u32 s57,s71,0x10002
s_lshl_b32 s57,s57,9
s_add_u32 s56,s56,s57
s_bfe_u32 s57,s71,0x10001
s_lshl_b32 s57,s57,6
s_add_u32 s56,s56,s57
s_bfe_u32 s57,s71,0x10004
s_lshl_b32 s57,s57,8
s_add_u32 s56,s56,s57
s_bfe_u32 s57,s71,0x10005
s_lshl_b32 s57,s57,7
s_add_u32 s56,s56,s57
s_bfe_u32 s57,s71,0x10006
s_lshl_b32 s57,s57,12
s_add_u32 s56,s56,s57
v_and_b32 v122,3,v120
v_lshlrev_b32 v10,2,v122
v_bfe_u32 v122,v120,3,1
v_lshl_add_u32 v10,v122,4,v10
v_and_b32 v122,1,v121
v_lshl_add_u32 v10,v122,5,v10
v_add_u32 v10,s56,v10
v_and_b32 v123,36,v1
v_mov_b32 v122,0x80000000
v_cmp_eq_u32 vcc,0,v123
s_nop 1
v_cndmask_b32 v10,v122,v10,vcc
s_lshl_b32 s56,s46,15
v_add_u32 v11,s56,v0
s_lshl_b32 s71,s71,11
s_lshl_b32 s73,s46,11
s_mov_b32 s72,0xffc00000
s_mov_b32 s74,0
v_lshrrev_b32 v13,3,v1
v_lshlrev_b32 v13,9,v13
v_and_b32 v122,7,v1
v_lshl_add_u32 v13,v122,4,v13
v_and_b32 v122,15,v1
v_and_b32 v123,1,v1
v_lshlrev_b32 v123,4,v123
v_mov_b32 v124,0x3f80
v_lshlrev_b32 v124,v123,v124
v_lshrrev_b32 v122,1,v122
v_cmp_eq_u32 vcc,0,v122
s_nop 1
v_cndmask_b32 v18,0,v124,vcc
v_cmp_eq_u32 vcc,1,v122
s_nop 1
v_cndmask_b32 v19,0,v124,vcc
v_cmp_eq_u32 vcc,2,v122
s_nop 1
v_cndmask_b32 v20,0,v124,vcc
v_cmp_eq_u32 vcc,3,v122
s_nop 1
v_cndmask_b32 v21,0,v124,vcc
s_and_b32 s56,s46,1
s_lshl_b32 s56,s56,8
s_and_b32 s57,s46,2
s_lshl_b32 s57,s57,6
s_add_u32 s56,s56,s57
v_add_u32 v13,s56,v13
s_xor_b32 s56,s46,0
s_lshl_b32 s56,s56,10
s_add_u32 s56,s56,147456
v_add_u32 v14,s56,v0
s_xor_b32 s56,s46,1
s_lshl_b32 s56,s56,10
s_add_u32 s56,s56,147456
v_add_u32 v15,s56,v0
s_xor_b32 s56,s46,2
s_lshl_b32 s56,s56,10
s_add_u32 s56,s56,147456
v_add_u32 v16,s56,v0
s_xor_b32 s56,s46,3
s_lshl_b32 s56,s56,10
s_add_u32 s56,s56,147456
v_add_u32 v17,s56,v0
v_add_u32 v22,12599296,v10
s_lshl_b32 s56,s47,2
s_add_u32 s56,s56,10502272
v_writelane_b32 v22,s56,4
s_mov_b32 s56,10519808
v_writelane_b32 v22,s56,5
v_add_u32 v1,131072,v0
s_mov_b32 s65,15728640
s_add_u32 s66,s71,15728640
s_add_u32 s69,s71,15990784
s_lshl_b32 s79,s47,2
s_add_u32 s79,s79,10486272
s_cmp_eq_u32 s46,0
s_cselect_b32 s79,s79,0x80000000
s_cmp_eq_u32 s47,0
s_cselect_b32 s31,17825792,-1
s_and_b32 s31,s31,0x8fffffff
s_mov_b32 s51,0
L_cst_103:
s_lshl_b32 s59,s51,13
s_lshl2_add_u32 s59,s47,s59
s_add_u32 s59,s59,10485888
L_ww_108:
buffer_load_dword v120,off,s[8:11],s59 sc1
s_sub_u32 s49,s49,1
s_cbranch_scc1 L_abort
s_waitcnt vmcnt(0)
v_readfirstlane_b32 s61,v120
s_cmp_eq_u32 s61,0
s_cbranch_scc1 L_ww_108
L_wwd_109:
s_lshl_b32 s56,s51,5
s_add_u32 s56,s56,s47
s_mul_i32 s56,s56,24576
s_add_u32 s56,s56,150994944
s_add_u32 s67,s56,s73
s_add_u32 m0,s73,131072
s_add_u32 s57,s67,8192
buffer_load_dwordx4 v0,s[8:11],s67 offen sc1 lds
buffer_load_dwordx4 v0,s[8:11],s67 offen offset:1024 sc1 lds
s_add_u32 m0,s73,139264
s_add_u32 s67,s67,786432
buffer_load_dwordx4 v0,s[8:11],s57 offen sc1 lds
buffer_load_dwordx4 v0,s[8:11],s57 offen offset:1024 sc1 lds
s_lshl_b32 s75,s51,13
s_add_u32 s64,s75,12582912
s_add_u32 s70,s64,4096
s_lshl_b32 s68,s51,5
s_add_u32 s68,s68,s47
s_lshl_b32 s68,s68,13
s_lshl_b32 s56,s46,10
s_add_u32 s68,s68,s56
s_add_u32 s68,s68,58720256
s_sub_u32 s67,s67,0
s_mov_b32 s78,0x80000000
s_cmp_eq_u32 s51,63
s_cselect_b32 s76,1,0
s_waitcnt vmcnt(0)
s_barrier
ds_read_b128 v[56:59],v1 offset:0
ds_read_b128 v[60:63],v1 offset:4096
ds_read_b128 v[64:67],v1 offset:1024
ds_read_b128 v[68:71],v1 offset:5120
ds_read_b128 v[72:75],v1 offset:2048
ds_read_b128 v[76:79],v1 offset:6144
ds_read_b128 v[80:83],v1 offset:3072
ds_read_b128 v[84:87],v1 offset:7168
v_add_u32 v12,s73,v1
ds_read_b128 v[88:91],v12 offset:8192
ds_read_b128 v[92:95],v12 offset:9216
v_mov_b64 v[96:97],0
v_mov_b64 v[98:99],0
v_mov_b64 v[100:101],0
v_mov_b64 v[102:103],0
v_mov_b64 v[104:105],0
v_mov_b64 v[106:107],0
v_mov_b64 v[108:109],0
v_mov_b64 v[110:111],0
v_mov_b64 v[112:113],0
v_mov_b64 v[114:115],0
v_mov_b64 v[116:117],0
v_mov_b64 v[118:119],0
buffer_load_dwordx4 v[24:27],v13,s[8:11],s64 offen sc1
L_chain_110:
L_cpa_111:
buffer_load_dwordx4 v[24:27],v13,s[8:11],s64 offen sc1
s_sub_u32 s49,s49,1
s_cbranch_scc1 L_abort
s_waitcnt vmcnt(1)
v_max3_u32 v12,v24,v25,v26
v_max_u32 v12,v27,v12
v_cmp_le_u32 vcc,s72,v12
s_cbranch_vccnz L_cpa_111
L_cgo_114:
ds_write_b128 v14,v[24:27] offset:0
buffer_load_dwordx4 v[40:43],v13,s[8:11],s70 offen sc1
v_smfmac_f32_16x16x64_bf16 v[96:99],v[24:27],a[0:7],v2
s_add_u32 m0,s73,131072
v_smfmac_f32_16x16x64_bf16 v[100:103],v[24:27],a[128:135],v2
s_add_u32 s57,s67,8192
v_smfmac_f32_16x16x64_bf16 v[104:107],v[24:27],a[8:15],v2
s_add_u32 s30,s31,s75
v_smfmac_f32_16x16x64_bf16 v[108:111],v[24:27],a[136:143],v2
s_add_u32 s58,s30,4096
s_waitcnt lgkmcnt(0)
s_barrier
ds_read_b128 v[28:31],v15 offset:0
ds_read_b128 v[32:35],v16 offset:0
ds_read_b128 v[36:39],v17 offset:0
v_smfmac_f32_16x16x64_bf16 v[112:115],v[24:27],v[128:135],v2
v_smfmac_f32_16x16x64_bf16 v[116:119],v[24:27],v[136:143],v2
s_waitcnt lgkmcnt(2)
v_smfmac_f32_16x16x64_bf16 v[96:99],v[28:31],a[16:23],v2
s_lshl_b32 s56,s46,10
v_smfmac_f32_16x16x64_bf16 v[100:103],v[28:31],a[144:151],v2
v_smfmac_f32_16x16x64_bf16 v[104:107],v[28:31],a[24:31],v2
v_smfmac_f32_16x16x64_bf16 v[108:111],v[28:31],a[152:159],v2
s_waitcnt lgkmcnt(1) vmcnt(0)
v_smfmac_f32_16x16x64_bf16 v[96:99],v[32:35],a[32:39],v2
v_max3_u32 v12,v40,v41,v42
v_smfmac_f32_16x16x64_bf16 v[100:103],v[32:35],a[160:167],v2
v_max_u32 v12,v43,v12
v_smfmac_f32_16x16x64_bf16 v[104:107],v[32:35],a[40:47],v2
v_cmp_le_u32 vcc,s72,v12
v_smfmac_f32_16x16x64_bf16 v[108:111],v[32:35],a[168:175],v2
s_cbranch_vccnz L_cpb_117
L_cback_119:
s_waitcnt lgkmcnt(0)
ds_write_b128 v14,v[40:43] offset:4096
v_smfmac_f32_16x16x64_bf16 v[96:99],v[36:39],a[48:55],v2
v_mov_b64 v[120:121],-1
v_smfmac_f32_16x16x64_bf16 v[100:103],v[36:39],a[176:183],v2
v_mov_b64 v[122:123],-1
v_smfmac_f32_16x16x64_bf16 v[104:107],v[36:39],a[56:63],v2
v_add_u32 v124,s56,v5
v_smfmac_f32_16x16x64_bf16 v[108:111],v[36:39],a[184:191],v2
v_add_u32 v126,s56,v6
s_waitcnt lgkmcnt(0)
s_barrier
v_smfmac_f32_16x16x64_bf16 v[96:99],v[40:43],a[64:71],v2
ds_read_b128 v[44:47],v15 offset:4096
v_smfmac_f32_16x16x64_bf16 v[100:103],v[40:43],a[192:199],v2
ds_read_b128 v[48:51],v16 offset:4096
v_smfmac_f32_16x16x64_bf16 v[104:107],v[40:43],a[72:79],v2
ds_read_b128 v[52:55],v17 offset:4096
v_smfmac_f32_16x16x64_bf16 v[108:111],v[40:43],a[200:207],v2
s_cmp_eq_u32 s76,0
s_cbranch_scc1 L_ckw_104
L_ckb_105:
s_waitcnt lgkmcnt(2)
v_smfmac_f32_16x16x64_bf16 v[96:99],v[44:47],a[80:87],v2
buffer_load_dwordx4 v0,s[8:11],s67 offen sc1 lds
v_smfmac_f32_16x16x64_bf16 v[100:103],v[44:47],a[208:215],v2
buffer_load_dwordx4 v0,s[8:11],s67 offen offset:1024 sc1 lds
v_smfmac_f32_16x16x64_bf16 v[104:107],v[44:47],a[88:95],v2
s_add_u32 m0,s73,139264
v_smfmac_f32_16x16x64_bf16 v[108:111],v[44:47],a[216:223],v2
s_waitcnt lgkmcnt(1)
v_smfmac_f32_16x16x64_bf16 v[96:99],v[48:51],a[96:103],v2
s_add_u32 s67,s67,786432
v_smfmac_f32_16x16x64_bf16 v[100:103],v[48:51],a[224:231],v2
buffer_load_dwordx4 v0,s[8:11],s57 offen sc1 lds
v_smfmac_f32_16x16x64_bf16 v[104:107],v[48:51],a[104:111],v2
buffer_load_dwordx4 v0,s[8:11],s57 offen offset:1024 sc1 lds
v_smfmac_f32_16x16x64_bf16 v[108:111],v[48:51],a[232:239],v2
s_waitcnt lgkmcnt(0)
v_smfmac_f32_16x16x64_bf16 v[96:99],v[52:55],a[112:119],v2
buffer_load_dword v23,v22,s[8:11],s75 offen sc1
v_smfmac_f32_16x16x64_bf16 v[100:103],v[52:55],a[240:247],v2
buffer_store_dword v2,off,s[8:11],s78 sc1
v_smfmac_f32_16x16x64_bf16 v[104:107],v[52:55],a[120:127],v2
buffer_store_dwordx4 v[120:123],v0,s[8:11],s69 offen
v_smfmac_f32_16x16x64_bf16 v[108:111],v[52:55],a[248:255],v2
buffer_store_dwordx4 v[120:123],v0,s[8:11],s69 offen offset:1024
buffer_store_dwordx4 v[24:27],v13,s[8:11],s30 offen sc1
buffer_store_dwordx4 v[40:43],v13,s[8:11],s58 offen sc1
v_smfmac_f32_16x16x64_bf16 v[112:115],v[28:31],v[144:151],v2
v_smfmac_f32_16x16x64_bf16 v[116:119],v[28:31],v[152:159],v2
v_pk_add_f32 v[96:97],v[96:97],v[98:99]
v_pk_add_f32 v[100:101],v[100:101],v[102:103]
v_cvt_pk_bf16_f32 v120,v96,v97
v_cvt_pk_bf16_f32 v121,v100,v101
v_pk_add_f32 v[104:105],v[104:105],v[106:107]
v_pk_add_f32 v[108:109],v[108:109],v[110:111]
v_cvt_pk_bf16_f32 v122,v104,v105
v_cvt_pk_bf16_f32 v123,v108,v109
ds_write_b128 v4,v[120:123]
v_smfmac_f32_16x16x64_bf16 v[112:115],v[32:35],v[160:167],v2
v_smfmac_f32_16x16x64_bf16 v[116:119],v[32:35],v[168:175],v2
v_smfmac_f32_16x16x64_bf16 v[112:115],v[36:39],v[176:183],v2
v_smfmac_f32_16x16x64_bf16 v[116:119],v[36:39],v[184:191],v2
s_waitcnt lgkmcnt(0)
s_barrier
ds_read_b64_tr_b16 v[96:97],v5 offset:0
ds_read_b64_tr_b16 v[98:99],v6 offset:0
ds_read_b64_tr_b16 v[100:101],v5 offset:1024
ds_read_b64_tr_b16 v[102:103],v6 offset:1024
ds_read_b64_tr_b16 v[104:105],v5 offset:2048
ds_read_b64_tr_b16 v[106:107],v6 offset:2048
ds_read_b64_tr_b16 v[108:109],v5 offset:3072
ds_read_b64_tr_b16 v[110:111],v6 offset:3072
ds_read_b64_tr_b16 v[124:125],v124
ds_read_b64_tr_b16 v[126:127],v126
v_smfmac_f32_16x16x64_bf16 v[112:115],v[40:43],v[192:199],v2
v_smfmac_f32_16x16x64_bf16 v[116:119],v[40:43],v[200:207],v2
s_waitcnt lgkmcnt(8)
v_mfma_f32_16x16x32_bf16 v[24:27],v[56:59],v[96:99],0
v_mfma_f32_16x16x32_bf16 v[28:31],v[60:63],v[96:99],0
v_mfma_f32_16x16x32_bf16 v[32:35],v[96:99],v[96:99],0
s_waitcnt lgkmcnt(6)
v_mfma_f32_16x16x32_bf16 v[24:27],v[64:67],v[100:103],v[24:27]
ds_read_b128 v[56:59],v11 offset:0
v_mfma_f32_16x16x32_bf16 v[28:31],v[68:71],v[100:103],v[28:31]
ds_read_b128 v[60:63],v11 offset:1024
v_mfma_f32_16x16x32_bf16 v[32:35],v[100:103],v[100:103],v[32:35]
s_waitcnt lgkmcnt(6)
v_mfma_f32_16x16x32_bf16 v[24:27],v[72:75],v[104:107],v[24:27]
ds_read_b128 v[64:67],v11 offset:2048
v_mfma_f32_16x16x32_bf16 v[28:31],v[76:79],v[104:107],v[28:31]
ds_read_b128 v[68:71],v11 offset:3072
v_mfma_f32_16x16x32_bf16 v[32:35],v[104:107],v[104:107],v[32:35]
s_waitcnt lgkmcnt(6)
v_mfma_f32_16x16x32_bf16 v[24:27],v[80:83],v[108:111],v[24:27]
ds_read_b128 v[72:75],v11 offset:4096
v_mfma_f32_16x16x32_bf16 v[28:31],v[84:87],v[108:111],v[28:31]
ds_read_b128 v[76:79],v11 offset:5120
v_mfma_f32_16x16x32_bf16 v[32:35],v[108:111],v[108:111],v[32:35]
s_waitcnt lgkmcnt(6)
v_smfmac_f32_16x16x64_bf16 v[112:115],v[44:47],v[208:215],v2
buffer_store_dwordx4 v[124:127],v0,s[8:11],s68 offen sc1
v_smfmac_f32_16x16x64_bf16 v[116:119],v[44:47],v[216:223],v2
v_smfmac_f32_16x16x64_bf16 v[112:115],v[48:51],v[224:231],v2
v_smfmac_f32_16x16x64_bf16 v[116:119],v[48:51],v[232:239],v2
v_smfmac_f32_16x16x64_bf16 v[112:115],v[52:55],v[240:247],v2
v_smfmac_f32_16x16x64_bf16 v[116:119],v[52:55],v[248:255],v2
v_mov_b32 v125,0
v_mov_b64 v[52:53],s[28:29]
v_mov_b64 v[54:55],s[28:29]
v_max3_f32 v36,v24,v25,v26
v_max3_f32 v37,v27,v28,v29
v_max3_f32 v36,v30,v31,v36
v_max3_f32 v37,v34,v35,v37
v_max_f32 v36,v36,v37
v_max_f32 v37,v36,v37
ds_read_b128 v[80:83],v11 offset:6144
s_nop 0
v_permlane16_swap_b32 v36,v37
v_max_f32 v36,v36,v37
v_max_f32 v37,v36,v37
ds_read_b128 v[84:87],v11 offset:7168
s_nop 0
v_permlane32_swap_b32 v36,v37
v_max_f32 v36,v36,v37
v_mul_f32 v36,s80,v36
v_fma_f32 v24,v24,s80,-v36
v_fma_f32 v25,v25,s80,-v36
v_exp_f32 v24,v24
v_fma_f32 v26,v26,s80,-v36
v_exp_f32 v25,v25
v_fma_f32 v27,v27,s80,-v36
v_exp_f32 v26,v26
v_fma_f32 v28,v28,s80,-v36
v_exp_f32 v27,v27
v_fma_f32 v29,v29,s80,-v36
v_exp_f32 v28,v28
v_fma_f32 v30,v30,s80,-v36
v_exp_f32 v29,v29
v_fma_f32 v31,v31,s80,-v36
v_exp_f32 v30,v30
v_fma_f32 v34,v34,s80,-v36
v_exp_f32 v31,v31
v_fma_f32 v35,v35,s80,-v36
v_exp_f32 v34,v34
v_exp_f32 v35,v35
v_cvt_pk_bf16_f32 v120,v24,v25
v_cvt_pk_bf16_f32 v121,v26,v27
v_cvt_pk_bf16_f32 v122,v28,v29
v_cvt_pk_bf16_f32 v123,v30,v31
v_cvt_pk_bf16_f32 v124,v34,v35
s_nop 0
v_mfma_f32_16x16x32_bf16 v[32:35],v[52:55],v[120:123],0
v_pk_add_f32 v[112:113],v[112:113],v[114:115]
v_pk_add_f32 v[116:117],v[116:117],v[118:119]
v_mfma_f32_16x16x32_bf16 v[24:27],v[88:91],v[120:123],0
v_cvt_pk_bf16_f32 v36,v112,v113
v_cvt_pk_bf16_f32 v37,v116,v117
v_mfma_f32_16x16x32_bf16 v[28:31],v[92:95],v[120:123],0
v_cvt_pk_bf16_f32 v38,v116,v117
v_mov_b32 v39,0
v_mfma_f32_16x16x16_bf16 v[32:35],v[52:53],v[124:125],v[32:35]
s_add_u32 s56,s68,4096
buffer_store_dwordx4 v[36:39],v0,s[8:11],s56 offen sc1
v_mfma_f32_16x16x16_bf16 v[24:27],v[36:37],v[124:125],v[24:27]
ds_read_b128 v[96:99],v11 offset:8192
v_mfma_f32_16x16x16_bf16 v[28:31],v[38:39],v[124:125],v[28:31]
ds_read_b128 v[100:103],v11 offset:9216
v_rcp_f32 v32,v32
v_mov_b64 v[112:113],0
v_mov_b64 v[114:115],0
v_pk_mul_f32 v[24:25],v[24:25],v[32:33] op_sel_hi:[1,0]
v_pk_mul_f32 v[26:27],v[26:27],v[32:33] op_sel_hi:[1,0]
v_mov_b64 v[116:117],0
v_mov_b64 v[118:119],0
v_pk_mul_f32 v[28:29],v[28:29],v[32:33] op_sel_hi:[1,0]
v_pk_mul_f32 v[30:31],v[30:31],v[32:33] op_sel_hi:[1,0]
v_cvt_pk_bf16_f32 v120,v24,v28
v_cvt_pk_bf16_f32 v121,v25,v29
v_cvt_pk_bf16_f32 v122,v26,v30
v_cvt_pk_bf16_f32 v123,v27,v31
ds_write_b128 v7,v[120:123]
ds_read_b128 v[104:107],v11 offset:10240
ds_read_b128 v[108:111],v11 offset:11264
ds_read_b128 v[40:43],v11 offset:12288
ds_read_b128 v[44:47],v11 offset:13312
s_waitcnt lgkmcnt(4)
s_barrier
ds_read_b128 v[24:27],v8 offset:0
ds_read_b128 v[28:31],v8 offset:512
ds_read_b128 v[32:35],v8 offset:1024
ds_read_b128 v[36:39],v8 offset:1536
ds_read_b128 v[48:51],v11 offset:14336
ds_read_b128 v[52:55],v11 offset:15360
v_mov_b64 v[88:89],0
v_mov_b64 v[90:91],0
v_mov_b64 v[92:93],0
v_mov_b64 v[94:95],0
s_waitcnt lgkmcnt(5)
v_smfmac_f32_16x16x64_bf16 v[112:115],v[24:27],v[56:63],v3
ds_read_b128 v[56:59],v11 offset:16384
ds_read_b128 v[60:63],v11 offset:17408
s_waitcnt lgkmcnt(6)
v_smfmac_f32_16x16x64_bf16 v[112:115],v[28:31],v[64:71],v3
ds_read_b128 v[64:67],v11 offset:18432
ds_read_b128 v[68:71],v11 offset:19456
s_waitcnt lgkmcnt(7)
v_smfmac_f32_16x16x64_bf16 v[112:115],v[32:35],v[72:79],v3
ds_read_b128 v[72:75],v11 offset:20480
ds_read_b128 v[76:79],v11 offset:21504
s_waitcnt lgkmcnt(8)
v_smfmac_f32_16x16x64_bf16 v[112:115],v[36:39],v[80:87],v3
ds_read_b128 v[80:83],v11 offset:22528
ds_read_b128 v[84:87],v11 offset:23552
s_waitcnt lgkmcnt(8)
v_smfmac_f32_16x16x64_bf16 v[116:119],v[24:27],v[96:103],v3
ds_read_b128 v[96:99],v11 offset:24576
ds_read_b128 v[100:103],v11 offset:25600
v_smfmac_f32_16x16x64_bf16 v[116:119],v[28:31],v[104:111],v3
v_cvt_pk_bf16_f32 v112,v112,v113
v_cvt_pk_bf16_f32 v113,v114,v115
buffer_store_dwordx2 v[112:113],v9,s[8:11],s65 offen
ds_read_b128 v[104:107],v11 offset:26624
ds_read_b128 v[108:111],v11 offset:27648
v_smfmac_f32_16x16x64_bf16 v[116:119],v[32:35],v[40:47],v3
ds_read_b128 v[40:43],v11 offset:28672
ds_read_b128 v[44:47],v11 offset:29696
v_smfmac_f32_16x16x64_bf16 v[116:119],v[36:39],v[48:55],v3
s_waitcnt lgkmcnt(12)
ds_read_b128 v[48:51],v11 offset:30720
ds_read_b128 v[52:55],v11 offset:31744
s_waitcnt lgkmcnt(14)
v_smfmac_f32_16x16x64_bf16 v[88:91],v[24:27],v[56:63],v3
s_nop 2
v_cvt_pk_bf16_f32 v116,v116,v117
v_cvt_pk_bf16_f32 v117,v118,v119
s_add_u32 s56,s65,65536
buffer_store_dwordx2 v[116:117],v9,s[8:11],s56 offen
s_waitcnt lgkmcnt(12)
v_smfmac_f32_16x16x64_bf16 v[88:91],v[28:31],v[64:71],v3
s_waitcnt lgkmcnt(10)
v_smfmac_f32_16x16x64_bf16 v[88:91],v[32:35],v[72:79],v3
s_waitcnt lgkmcnt(8)
v_smfmac_f32_16x16x64_bf16 v[88:91],v[36:39],v[80:87],v3
s_waitcnt lgkmcnt(6)
v_smfmac_f32_16x16x64_bf16 v[92:95],v[24:27],v[96:103],v3
s_waitcnt lgkmcnt(4)
v_smfmac_f32_16x16x64_bf16 v[92:95],v[28:31],v[104:111],v3
v_cvt_pk_bf16_f32 v88,v88,v89
v_cvt_pk_bf16_f32 v89,v90,v91
s_add_u32 s56,s65,131072
buffer_store_dwordx2 v[88:89],v9,s[8:11],s56 offen
s_waitcnt lgkmcnt(2)
v_smfmac_f32_16x16x64_bf16 v[92:95],v[32:35],v[40:47],v3
s_waitcnt lgkmcnt(0)
v_smfmac_f32_16x16x64_bf16 v[92:95],v[36:39],v[48:55],v3
s_add_u32 s78,s79,s75
s_add_u32 s75,s75,8192
s_add_u32 s64,s75,12582912
s_add_u32 s70,s64,4096
s_add_u32 s68,s68,262144
s_add_u32 s51,s51,1
s_nop 1
v_cvt_pk_bf16_f32 v92,v92,v93
v_cvt_pk_bf16_f32 v93,v94,v95
s_add_u32 s56,s65,196608
buffer_store_dwordx2 v[92:93],v9,s[8:11],s56 offen
s_xor_b32 s65,s65,262144
s_cmp_eq_u32 s51,64
s_cbranch_scc1 L_cend_113
s_cmp_lt_u32 s47,16
s_waitcnt vmcnt(2)
s_cbranch_scc1 L_cea_120
s_barrier
ds_read_b128 v[56:59],v1 offset:0
ds_read_b128 v[60:63],v1 offset:4096
ds_read_b128 v[64:67],v1 offset:1024
ds_read_b128 v[68:71],v1 offset:5120
ds_read_b128 v[72:75],v1 offset:2048
ds_read_b128 v[76:79],v1 offset:6144
ds_read_b128 v[80:83],v1 offset:3072
ds_read_b128 v[84:87],v1 offset:7168
v_add_u32 v12,s73,v1
ds_read_b128 v[88:91],v12 offset:8192
ds_read_b128 v[92:95],v12 offset:9216
v_mov_b64 v[96:97],0
v_mov_b64 v[98:99],0
v_mov_b64 v[100:101],0
v_mov_b64 v[102:103],0
v_mov_b64 v[104:105],0
v_mov_b64 v[106:107],0
v_mov_b64 v[108:109],0
v_mov_b64 v[110:111],0
v_mov_b64 v[112:113],0
v_mov_b64 v[114:115],0
v_mov_b64 v[116:117],0
v_mov_b64 v[118:119],0
v_readlane_b32 s76,v23,4
s_cmp_ge_u32 s51,63
s_cselect_b32 s76,1,s76
s_waitcnt vmcnt(0)
L_crp_115:
buffer_load_dwordx4 v[120:123],v0,s[8:11],s66 offen offset:0 sc1
buffer_load_dwordx4 v[124:127],v0,s[8:11],s66 offen offset:1024 sc1
s_sub_u32 s49,s49,1
s_cbranch_scc1 L_abort
s_waitcnt vmcnt(1)
v_mfma_f32_16x16x32_bf16 v[28:31],v[18:21],v[120:123],0
s_waitcnt vmcnt(0)
v_mfma_f32_16x16x32_bf16 v[28:31],v[18:21],v[124:127],v[28:31]
s_nop 7
v_cmp_u_f32 vcc,v28,v28
v_add_f32_dpp v32,v28,v28 row_ror:8 row_mask:0xf bank_mask:0x3
v_add_f32_dpp v33,v29,v29 row_ror:8 row_mask:0xf bank_mask:0x3
v_add_f32_dpp v32,v30,v30 row_ror:8 row_mask:0xf bank_mask:0xc
v_add_f32_dpp v33,v31,v31 row_ror:8 row_mask:0xf bank_mask:0xc
s_nop 0
v_add_f32_dpp v32,v32,v32 row_shl:4 row_mask:0xf bank_mask:0x5
v_add_f32_dpp v33,v33,v33 row_shl:4 row_mask:0xf bank_mask:0x5
s_cbranch_vccnz L_crp_115
v_cvt_pk_bf16_f32 v34,v32,v33
buffer_store_dword v34,v10,s[8:11],s64 offen
s_mov_b32 s69,s66
s_xor_b32 s66,s66,262144
buffer_load_dwordx4 v[24:27],v13,s[8:11],s64 offen sc1
s_branch L_chain_110
L_cea_120:
buffer_load_dwordx4 v[120:123],v0,s[8:11],s66 offen offset:0 sc1
buffer_load_dwordx4 v[124:127],v0,s[8:11],s66 offen offset:1024 sc1
v_mov_b64 v[96:97],0
v_mov_b64 v[98:99],0
v_mov_b64 v[100:101],0
v_mov_b64 v[102:103],0
v_mov_b64 v[104:105],0
v_mov_b64 v[106:107],0
v_mov_b64 v[108:109],0
v_mov_b64 v[110:111],0
v_mov_b64 v[112:113],0
v_mov_b64 v[114:115],0
v_mov_b64 v[116:117],0
v_mov_b64 v[118:119],0
v_readlane_b32 s76,v23,4
s_cmp_ge_u32 s51,63
s_cselect_b32 s76,1,s76
s_branch L_cr1_121
L_crb_116:
buffer_load_dwordx4 v[120:123],v0,s[8:11],s66 offen offset:0 sc1
buffer_load_dwordx4 v[124:127],v0,s[8:11],s66 offen offset:1024 sc1
L_cr1_121:
s_sub_u32 s49,s49,1
s_cbranch_scc1 L_abort
s_waitcnt vmcnt(1)
v_mfma_f32_16x16x32_bf16 v[28:31],v[18:21],v[120:123],0
s_waitcnt vmcnt(0)
v_mfma_f32_16x16x32_bf16 v[28:31],v[18:21],v[124:127],v[28:31]
s_nop 7
v_cmp_u_f32 vcc,v28,v28
v_add_f32_dpp v32,v28,v28 row_ror:8 row_mask:0xf bank_mask:0x3
v_add_f32_dpp v33,v29,v29 row_ror:8 row_mask:0xf bank_mask:0x3
v_add_f32_dpp v32,v30,v30 row_ror:8 row_mask:0xf bank_mask:0xc
v_add_f32_dpp v33,v31,v31 row_ror:8 row_mask:0xf bank_mask:0xc
s_nop 0
v_add_f32_dpp v32,v32,v32 row_shl:4 row_mask:0xf bank_mask:0x5
v_add_f32_dpp v33,v33,v33 row_shl:4 row_mask:0xf bank_mask:0x5
s_cbranch_vccnz L_crb_116
v_cvt_pk_bf16_f32 v34,v32,v33
buffer_store_dword v34,v10,s[8:11],s64 offen
s_mov_b32 s69,s66
s_xor_b32 s66,s66,262144
s_barrier
ds_read_b128 v[56:59],v1 offset:0
ds_read_b128 v[60:63],v1 offset:4096
ds_read_b128 v[64:67],v1 offset:1024
ds_read_b128 v[68:71],v1 offset:5120
buffer_load_dwordx4 v[24:27],v13,s[8:11],s64 offen sc1
ds_read_b128 v[72:75],v1 offset:2048
ds_read_b128 v[76:79],v1 offset:6144
ds_read_b128 v[80:83],v1 offset:3072
ds_read_b128 v[84:87],v1 offset:7168
v_add_u32 v12,s73,v1
ds_read_b128 v[88:91],v12 offset:8192
ds_read_b128 v[92:95],v12 offset:9216
s_branch L_chain_110
L_ckw_104:
s_lshl2_add_u32 s59,s47,s75
s_add_u32 s59,s59,10494080
L_ww_122:
buffer_load_dword v23,off,s[8:11],s59 sc1
s_sub_u32 s49,s49,1
s_cbranch_scc1 L_abort
s_waitcnt vmcnt(0)
v_readfirstlane_b32 s76,v23
s_cmp_eq_u32 s76,0
s_cbranch_scc1 L_ww_122
L_wwd_123:
s_branch L_ckb_105
L_cpb_117:
buffer_load_dwordx4 v[40:43],v13,s[8:11],s70 offen sc1
s_waitcnt vmcnt(0)
v_max3_u32 v12,v40,v41,v42
v_max_u32 v12,v43,v12
v_cmp_le_u32 vcc,s72,v12
s_cbranch_vccz L_cback_119
s_sub_u32 s49,s49,1
s_cmp_gt_i32 s49,0
s_cbranch_scc1 L_cpb_117
s_branch L_abort
L_cend_113:
s_waitcnt vmcnt(0)
s_barrier
buffer_store_dword v2,off,s[8:11],s78 sc1
s_nop 11
v_lshrrev_b32 v1,4,v0
s_endpgm
L_rc2_81:
v_and_b32 v120,15,v1
v_lshrrev_b32 v121,4,v1
v_and_b32 v122,2,v1
v_cmp_eq_u32 vcc,0,v122
v_mov_b32 v2,0xeeee
v_mov_b32 v123,0x4444
v_cndmask_b32 v2,v2,v123,vcc
v_and_b32 v122,1,v1
v_cmp_eq_u32 vcc,0,v122
v_mov_b32 v3,0xdddd
v_mov_b32 v123,0x8888
v_cndmask_b32 v3,v3,v123,vcc
v_lshrrev_b32 v122,1,v120
v_bfe_u32 v123,v120,2,1
v_xor_b32 v123,v123,v122
v_lshlrev_b32 v4,7,v123
v_and_b32 v123,1,v120
v_lshl_add_u32 v4,v123,6,v4
v_xor_b32 v123,v121,v122
v_and_b32 v123,3,v123
v_lshl_add_u32 v4,v123,4,v4
s_lshl_b32 s56,s46,10
s_add_u32 s56,s56,147456
v_add_u32 v4,s56,v4
v_lshlrev_b32 v122,1,v121
v_add_u32 v122,0,v122
v_and_b32 v123,1,v121
v_xor_b32 v123,v123,v122
v_lshlrev_b32 v5,7,v123
v_bfe_u32 v123,v120,3,1
v_lshl_add_u32 v5,v123,6,v5
v_xor_b32 v123,v120,v122
v_and_b32 v123,3,v123
v_lshl_add_u32 v5,v123,4,v5
v_bfe_u32 v123,v120,2,1
v_lshl_add_u32 v5,v123,3,v5
v_add_u32 v5,147456,v5
v_lshlrev_b32 v122,1,v121
v_add_u32 v122,1,v122
v_and_b32 v123,1,v121
v_xor_b32 v123,v123,v122
v_lshlrev_b32 v6,7,v123
v_bfe_u32 v123,v120,3,1
v_lshl_add_u32 v6,v123,6,v6
v_xor_b32 v123,v120,v122
v_and_b32 v123,3,v123
v_lshl_add_u32 v6,v123,4,v6
v_bfe_u32 v123,v120,2,1
v_lshl_add_u32 v6,v123,3,v6
v_add_u32 v6,147456,v6
v_lshlrev_b32 v7,7,v121
v_lshrrev_b32 v122,1,v120
v_lshl_add_u32 v8,v122,4,v7
v_add_u32 v8,151552,v8
v_lshrrev_b32 v122,2,v120
v_lshl_add_u32 v7,v122,5,v7
v_and_b32 v122,1,v120
v_lshl_add_u32 v7,v122,4,v7
v_and_b32 v122,2,v120
v_lshl_add_u32 v7,v122,10,v7
s_lshl_b32 s56,s46,9
s_add_u32 s56,s56,151552
v_add_u32 v7,s56,v7
v_lshrrev_b32 v122,3,v1
v_lshlrev_b32 v9,11,v122
v_and_b32 v122,7,v1
v_lshl_add_u32 v9,v122,3,v9
s_lshl_b32 s56,s46,14
s_lshl_b32 s57,s47,6
s_add_u32 s56,s56,s57
v_add_u32 v9,s56,v9
s_lshl_b32 s71,s47,2
s_add_u32 s71,s71,s46
s_bfe_u32 s56,s71,0x10003
s_lshl_b32 s56,s56,11
s_and_b32 s57,s71,1
s_lshl_b32 s57,s57,10
s_add_u32 s56,s56,s57
s_bfe_u32 s57,s71,0x10002
s_lshl_b32 s57,s57,9
s_add_u32 s56,s56,s57
s_bfe_u32 s57,s71,0x10001
s_lshl_b32 s57,s57,6
s_add_u32 s56,s56,s57
s_bfe_u32 s57,s71,0x10004
s_lshl_b32 s57,s57,8
s_add_u32 s56,s56,s57
s_bfe_u32 s57,s71,0x10005
s_lshl_b32 s57,s57,7
s_add_u32 s56,s56,s57
s_bfe_u32 s57,s71,0x10006
s_lshl_b32 s57,s57,12
s_add_u32 s56,s56,s57
v_and_b32 v122,3,v120
v_lshlrev_b32 v10,2,v122
v_bfe_u32 v122,v120,3,1
v_lshl_add_u32 v10,v122,4,v10
v_and_b32 v122,1,v121
v_lshl_add_u32 v10,v122,5,v10
v_add_u32 v10,s56,v10
v_and_b32 v123,36,v1
v_mov_b32 v122,0x80000000
v_cmp_eq_u32 vcc,0,v123
s_nop 1
v_cndmask_b32 v10,v122,v10,vcc
s_lshl_b32 s56,s46,15
v_add_u32 v11,s56,v0
s_lshl_b32 s71,s71,11
s_lshl_b32 s73,s46,11
s_mov_b32 s72,0xffc00000
s_mov_b32 s74,0
v_lshrrev_b32 v13,3,v1
v_lshlrev_b32 v13,9,v13
v_and_b32 v122,7,v1
v_lshl_add_u32 v13,v122,4,v13
v_and_b32 v122,15,v1
v_and_b32 v123,1,v1
v_lshlrev_b32 v123,4,v123
v_mov_b32 v124,0x3f80
v_lshlrev_b32 v124,v123,v124
v_lshrrev_b32 v122,1,v122
v_cmp_eq_u32 vcc,0,v122
s_nop 1
v_cndmask_b32 v18,0,v124,vcc
v_cmp_eq_u32 vcc,1,v122
s_nop 1
v_cndmask_b32 v19,0,v124,vcc
v_cmp_eq_u32 vcc,2,v122
s_nop 1
v_cndmask_b32 v20,0,v124,vcc
v_cmp_eq_u32 vcc,3,v122
s_nop 1
v_cndmask_b32 v21,0,v124,vcc
s_and_b32 s56,s46,1
s_lshl_b32 s56,s56,8
s_and_b32 s57,s46,2
s_lshl_b32 s57,s57,6
s_add_u32 s56,s56,s57
v_add_u32 v13,s56,v13
s_xor_b32 s56,s46,0
s_lshl_b32 s56,s56,10
s_add_u32 s56,s56,147456
v_add_u32 v14,s56,v0
s_xor_b32 s56,s46,1
s_lshl_b32 s56,s56,10
s_add_u32 s56,s56,147456
v_add_u32 v15,s56,v0
s_xor_b32 s56,s46,2
s_lshl_b32 s56,s56,10
s_add_u32 s56,s56,147456
v_add_u32 v16,s56,v0
s_xor_b32 s56,s46,3
s_lshl_b32 s56,s56,10
s_add_u32 s56,s56,147456
v_add_u32 v17,s56,v0
v_add_u32 v22,13647872,v10
s_lshl_b32 s56,s47,2
s_add_u32 s56,s56,10502272
v_writelane_b32 v22,s56,4
s_mov_b32 s56,10519808
v_writelane_b32 v22,s56,5
v_add_u32 v1,131072,v0
s_mov_b32 s65,16777216
s_add_u32 s66,s71,16777216
s_add_u32 s69,s71,17039360
s_lshl_b32 s79,s47,2
s_add_u32 s79,s79,10486400
s_cmp_eq_u32 s46,0
s_cselect_b32 s79,s79,0x80000000
s_cmp_eq_u32 s47,0
s_cselect_b32 s31,17825792,-1
s_and_b32 s31,s31,0x8fffffff
s_mov_b32 s51,0
L_cst_124:
s_mov_b32 s60,s51
L_csc_129:
s_add_u32 s60,s60,1
s_add_u32 s61,s51,3
s_min_u32 s61,s61,63
s_cmp_gt_u32 s60,s61
s_cbranch_scc1 L_csd_130
s_lshl_b32 s59,s60,13
s_add_u32 s59,s59,10487040
L_ww_131:
buffer_load_dword v120,off,s[8:11],s59 sc1
s_sub_u32 s49,s49,1
s_cbranch_scc1 L_abort
s_waitcnt vmcnt(0)
v_readfirstlane_b32 s61,v120
s_cmp_eq_u32 s61,0
s_cbranch_scc1 L_ww_131
L_wwd_132:
s_cmp_eq_u32 s61,2
s_cselect_b32 s51,s60,s51
s_branch L_csc_129
L_csd_130:
s_lshl_b32 s59,s51,13
s_lshl2_add_u32 s59,s47,s59
s_add_u32 s59,s59,10486016
L_ww_133:
buffer_load_dword v120,off,s[8:11],s59 sc1
s_sub_u32 s49,s49,1
s_cbranch_scc1 L_abort
s_waitcnt vmcnt(0)
v_readfirstlane_b32 s61,v120
s_cmp_eq_u32 s61,0
s_cbranch_scc1 L_ww_133
L_wwd_134:
s_lshl_b32 s56,s51,5
s_add_u32 s56,s56,s47
s_mul_i32 s56,s56,24576
s_add_u32 s56,s56,201326592
s_add_u32 s67,s56,s73
s_add_u32 m0,s73,131072
s_add_u32 s57,s67,8192
buffer_load_dwordx4 v0,s[8:11],s67 offen sc1 lds
buffer_load_dwordx4 v0,s[8:11],s67 offen offset:1024 sc1 lds
s_add_u32 m0,s73,139264
s_add_u32 s67,s67,786432
buffer_load_dwordx4 v0,s[8:11],s57 offen sc1 lds
buffer_load_dwordx4 v0,s[8:11],s57 offen offset:1024 sc1 lds
s_lshl_b32 s75,s51,13
s_add_u32 s64,s75,17825792
s_add_u32 s70,s64,4096
s_lshl_b32 s68,s51,5
s_add_u32 s68,s68,s47
s_lshl_b32 s68,s68,13
s_lshl_b32 s56,s46,10
s_add_u32 s68,s68,s56
s_add_u32 s68,s68,75497472
s_sub_u32 s67,s67,50331648
s_mov_b32 s78,0x80000000
s_cmp_eq_u32 s51,63
s_cselect_b32 s76,1,0
s_waitcnt vmcnt(0)
s_barrier
ds_read_b128 v[56:59],v1 offset:0
ds_read_b128 v[60:63],v1 offset:4096
ds_read_b128 v[64:67],v1 offset:1024
ds_read_b128 v[68:71],v1 offset:5120
ds_read_b128 v[72:75],v1 offset:2048
ds_read_b128 v[76:79],v1 offset:6144
ds_read_b128 v[80:83],v1 offset:3072
ds_read_b128 v[84:87],v1 offset:7168
v_add_u32 v12,s73,v1
ds_read_b128 v[88:91],v12 offset:8192
ds_read_b128 v[92:95],v12 offset:9216
v_mov_b64 v[96:97],0
v_mov_b64 v[98:99],0
v_mov_b64 v[100:101],0
v_mov_b64 v[102:103],0
v_mov_b64 v[104:105],0
v_mov_b64 v[106:107],0
v_mov_b64 v[108:109],0
v_mov_b64 v[110:111],0
v_mov_b64 v[112:113],0
v_mov_b64 v[114:115],0
v_mov_b64 v[116:117],0
v_mov_b64 v[118:119],0
buffer_load_dwordx4 v[24:27],v13,s[8:11],s64 offen sc1
L_chain_135:
L_cpa_136:
buffer_load_dwordx4 v[24:27],v13,s[8:11],s64 offen sc1
s_sub_u32 s49,s49,1
s_cbranch_scc1 L_abort
s_waitcnt vmcnt(1)
v_max3_u32 v12,v24,v25,v26
v_max_u32 v12,v27,v12
v_cmp_le_u32 vcc,s72,v12
s_cbranch_vccnz L_cpa_136
L_cgo_139:
ds_write_b128 v14,v[24:27] offset:0
buffer_load_dwordx4 v[40:43],v13,s[8:11],s70 offen sc1
v_smfmac_f32_16x16x64_bf16 v[96:99],v[24:27],a[0:7],v2
s_add_u32 m0,s73,131072
v_smfmac_f32_16x16x64_bf16 v[100:103],v[24:27],a[128:135],v2
s_add_u32 s57,s67,8192
v_smfmac_f32_16x16x64_bf16 v[104:107],v[24:27],a[8:15],v2
v_smfmac_f32_16x16x64_bf16 v[108:111],v[24:27],a[136:143],v2
s_waitcnt lgkmcnt(0)
s_barrier
ds_read_b128 v[28:31],v15 offset:0
ds_read_b128 v[32:35],v16 offset:0
ds_read_b128 v[36:39],v17 offset:0
v_smfmac_f32_16x16x64_bf16 v[112:115],v[24:27],v[128:135],v2
v_smfmac_f32_16x16x64_bf16 v[116:119],v[24:27],v[136:143],v2
s_waitcnt lgkmcnt(2)
v_smfmac_f32_16x16x64_bf16 v[96:99],v[28:31],a[16:23],v2
s_lshl_b32 s56,s46,10
v_smfmac_f32_16x16x64_bf16 v[100:103],v[28:31],a[144:151],v2
v_smfmac_f32_16x16x64_bf16 v[104:107],v[28:31],a[24:31],v2
v_smfmac_f32_16x16x64_bf16 v[108:111],v[28:31],a[152:159],v2
s_waitcnt lgkmcnt(1) vmcnt(0)
v_smfmac_f32_16x16x64_bf16 v[96:99],v[32:35],a[32:39],v2
v_max3_u32 v12,v40,v41,v42
v_smfmac_f32_16x16x64_bf16 v[100:103],v[32:35],a[160:167],v2
v_max_u32 v12,v43,v12
v_smfmac_f32_16x16x64_bf16 v[104:107],v[32:35],a[40:47],v2
v_cmp_le_u32 vcc,s72,v12
v_smfmac_f32_16x16x64_bf16 v[108:111],v[32:35],a[168:175],v2
s_cbranch_vccnz L_cpb_142
L_cback_144:
s_waitcnt lgkmcnt(0)
ds_write_b128 v14,v[40:43] offset:4096
v_smfmac_f32_16x16x64_bf16 v[96:99],v[36:39],a[48:55],v2
v_mov_b64 v[120:121],-1
v_smfmac_f32_16x16x64_bf16 v[100:103],v[36:39],a[176:183],v2
v_mov_b64 v[122:123],-1
v_smfmac_f32_16x16x64_bf16 v[104:107],v[36:39],a[56:63],v2
v_add_u32 v124,s56,v5
v_smfmac_f32_16x16x64_bf16 v[108:111],v[36:39],a[184:191],v2
v_add_u32 v126,s56,v6
s_waitcnt lgkmcnt(0)
s_barrier
v_smfmac_f32_16x16x64_bf16 v[96:99],v[40:43],a[64:71],v2
ds_read_b128 v[44:47],v15 offset:4096
v_smfmac_f32_16x16x64_bf16 v[100:103],v[40:43],a[192:199],v2
ds_read_b128 v[48:51],v16 offset:4096
v_smfmac_f32_16x16x64_bf16 v[104:107],v[40:43],a[72:79],v2
ds_read_b128 v[52:55],v17 offset:4096
v_smfmac_f32_16x16x64_bf16 v[108:111],v[40:43],a[200:207],v2
s_cmp_eq_u32 s76,0
s_cbranch_scc1 L_ckw_125
L_ckb_126:
s_waitcnt lgkmcnt(2)
v_smfmac_f32_16x16x64_bf16 v[96:99],v[44:47],a[80:87],v2
buffer_load_dwordx4 v0,s[8:11],s67 offen sc1 lds
v_smfmac_f32_16x16x64_bf16 v[100:103],v[44:47],a[208:215],v2
buffer_load_dwordx4 v0,s[8:11],s67 offen offset:1024 sc1 lds
v_smfmac_f32_16x16x64_bf16 v[104:107],v[44:47],a[88:95],v2
s_add_u32 m0,s73,139264
v_smfmac_f32_16x16x64_bf16 v[108:111],v[44:47],a[216:223],v2
s_waitcnt lgkmcnt(1)
v_smfmac_f32_16x16x64_bf16 v[96:99],v[48:51],a[96:103],v2
s_add_u32 s67,s67,786432
v_smfmac_f32_16x16x64_bf16 v[100:103],v[48:51],a[224:231],v2
buffer_load_dwordx4 v0,s[8:11],s57 offen sc1 lds
v_smfmac_f32_16x16x64_bf16 v[104:107],v[48:51],a[104:111],v2
buffer_load_dwordx4 v0,s[8:11],s57 offen offset:1024 sc1 lds
v_smfmac_f32_16x16x64_bf16 v[108:111],v[48:51],a[232:239],v2
s_waitcnt lgkmcnt(0)
v_smfmac_f32_16x16x64_bf16 v[96:99],v[52:55],a[112:119],v2
buffer_load_dword v23,v22,s[8:11],s75 offen sc1
v_smfmac_f32_16x16x64_bf16 v[100:103],v[52:55],a[240:247],v2
buffer_store_dword v2,off,s[8:11],s78 sc1
v_smfmac_f32_16x16x64_bf16 v[104:107],v[52:55],a[120:127],v2
buffer_store_dwordx4 v[120:123],v0,s[8:11],s69 offen
v_smfmac_f32_16x16x64_bf16 v[108:111],v[52:55],a[248:255],v2
buffer_store_dwordx4 v[120:123],v0,s[8:11],s69 offen offset:1024
v_smfmac_f32_16x16x64_bf16 v[112:115],v[28:31],v[144:151],v2
v_smfmac_f32_16x16x64_bf16 v[116:119],v[28:31],v[152:159],v2
v_pk_add_f32 v[96:97],v[96:97],v[98:99]
v_pk_add_f32 v[100:101],v[100:101],v[102:103]
v_cvt_pk_bf16_f32 v120,v96,v97
v_cvt_pk_bf16_f32 v121,v100,v101
v_pk_add_f32 v[104:105],v[104:105],v[106:107]
v_pk_add_f32 v[108:109],v[108:109],v[110:111]
v_cvt_pk_bf16_f32 v122,v104,v105
v_cvt_pk_bf16_f32 v123,v108,v109
ds_write_b128 v4,v[120:123]
v_smfmac_f32_16x16x64_bf16 v[112:115],v[32:35],v[160:167],v2
v_smfmac_f32_16x16x64_bf16 v[116:119],v[32:35],v[168:175],v2
v_smfmac_f32_16x16x64_bf16 v[112:115],v[36:39],v[176:183],v2
v_smfmac_f32_16x16x64_bf16 v[116:119],v[36:39],v[184:191],v2
s_waitcnt lgkmcnt(0)
s_barrier
ds_read_b64_tr_b16 v[96:97],v5 offset:0
ds_read_b64_tr_b16 v[98:99],v6 offset:0
ds_read_b64_tr_b16 v[100:101],v5 offset:1024
ds_read_b64_tr_b16 v[102:103],v6 offset:1024
ds_read_b64_tr_b16 v[104:105],v5 offset:2048
ds_read_b64_tr_b16 v[106:107],v6 offset:2048
ds_read_b64_tr_b16 v[108:109],v5 offset:3072
ds_read_b64_tr_b16 v[110:111],v6 offset:3072
ds_read_b64_tr_b16 v[124:125],v124
ds_read_b64_tr_b16 v[126:127],v126
v_smfmac_f32_16x16x64_bf16 v[112:115],v[40:43],v[192:199],v2
v_smfmac_f32_16x16x64_bf16 v[116:119],v[40:43],v[200:207],v2
s_waitcnt lgkmcnt(8)
v_mfma_f32_16x16x32_bf16 v[24:27],v[56:59],v[96:99],0
v_mfma_f32_16x16x32_bf16 v[28:31],v[60:63],v[96:99],0
v_mfma_f32_16x16x32_bf16 v[32:35],v[96:99],v[96:99],0
s_waitcnt lgkmcnt(6)
v_mfma_f32_16x16x32_bf16 v[24:27],v[64:67],v[100:103],v[24:27]
ds_read_b128 v[56:59],v11 offset:0
v_mfma_f32_16x16x32_bf16 v[28:31],v[68:71],v[100:103],v[28:31]
ds_read_b128 v[60:63],v11 offset:1024
v_mfma_f32_16x16x32_bf16 v[32:35],v[100:103],v[100:103],v[32:35]
s_waitcnt lgkmcnt(6)
v_mfma_f32_16x16x32_bf16 v[24:27],v[72:75],v[104:107],v[24:27]
ds_read_b128 v[64:67],v11 offset:2048
v_mfma_f32_16x16x32_bf16 v[28:31],v[76:79],v[104:107],v[28:31]
ds_read_b128 v[68:71],v11 offset:3072
v_mfma_f32_16x16x32_bf16 v[32:35],v[104:107],v[104:107],v[32:35]
s_waitcnt lgkmcnt(6)
v_mfma_f32_16x16x32_bf16 v[24:27],v[80:83],v[108:111],v[24:27]
ds_read_b128 v[72:75],v11 offset:4096
v_mfma_f32_16x16x32_bf16 v[28:31],v[84:87],v[108:111],v[28:31]
ds_read_b128 v[76:79],v11 offset:5120
v_mfma_f32_16x16x32_bf16 v[32:35],v[108:111],v[108:111],v[32:35]
s_waitcnt lgkmcnt(6)
v_smfmac_f32_16x16x64_bf16 v[112:115],v[44:47],v[208:215],v2
buffer_store_dwordx4 v[124:127],v0,s[8:11],s68 offen sc1
v_smfmac_f32_16x16x64_bf16 v[116:119],v[44:47],v[216:223],v2
v_smfmac_f32_16x16x64_bf16 v[112:115],v[48:51],v[224:231],v2
v_smfmac_f32_16x16x64_bf16 v[116:119],v[48:51],v[232:239],v2
v_smfmac_f32_16x16x64_bf16 v[112:115],v[52:55],v[240:247],v2
v_smfmac_f32_16x16x64_bf16 v[116:119],v[52:55],v[248:255],v2
v_mov_b32 v125,0
v_mov_b64 v[52:53],s[28:29]
v_mov_b64 v[54:55],s[28:29]
v_max3_f32 v36,v24,v25,v26
v_max3_f32 v37,v27,v28,v29
v_max3_f32 v36,v30,v31,v36
v_max3_f32 v37,v34,v35,v37
v_max_f32 v36,v36,v37
v_max_f32 v37,v36,v37
ds_read_b128 v[80:83],v11 offset:6144
s_nop 0
v_permlane16_swap_b32 v36,v37
v_max_f32 v36,v36,v37
v_max_f32 v37,v36,v37
ds_read_b128 v[84:87],v11 offset:7168
s_nop 0
v_permlane32_swap_b32 v36,v37
v_max_f32 v36,v36,v37
v_mul_f32 v36,s80,v36
v_fma_f32 v24,v24,s80,-v36
v_fma_f32 v25,v25,s80,-v36
v_exp_f32 v24,v24
v_fma_f32 v26,v26,s80,-v36
v_exp_f32 v25,v25
v_fma_f32 v27,v27,s80,-v36
v_exp_f32 v26,v26
v_fma_f32 v28,v28,s80,-v36
v_exp_f32 v27,v27
v_fma_f32 v29,v29,s80,-v36
v_exp_f32 v28,v28
v_fma_f32 v30,v30,s80,-v36
v_exp_f32 v29,v29
v_fma_f32 v31,v31,s80,-v36
v_exp_f32 v30,v30
v_fma_f32 v34,v34,s80,-v36
v_exp_f32 v31,v31
v_fma_f32 v35,v35,s80,-v36
v_exp_f32 v34,v34
v_exp_f32 v35,v35
v_cvt_pk_bf16_f32 v120,v24,v25
v_cvt_pk_bf16_f32 v121,v26,v27
v_cvt_pk_bf16_f32 v122,v28,v29
v_cvt_pk_bf16_f32 v123,v30,v31
v_cvt_pk_bf16_f32 v124,v34,v35
s_nop 0
v_mfma_f32_16x16x32_bf16 v[32:35],v[52:55],v[120:123],0
v_pk_add_f32 v[112:113],v[112:113],v[114:115]
v_pk_add_f32 v[116:117],v[116:117],v[118:119]
v_mfma_f32_16x16x32_bf16 v[24:27],v[88:91],v[120:123],0
v_cvt_pk_bf16_f32 v36,v112,v113
v_cvt_pk_bf16_f32 v37,v116,v117
v_mfma_f32_16x16x32_bf16 v[28:31],v[92:95],v[120:123],0
v_cvt_pk_bf16_f32 v38,v116,v117
v_mov_b32 v39,0
v_mfma_f32_16x16x16_bf16 v[32:35],v[52:53],v[124:125],v[32:35]
s_add_u32 s56,s68,4096
buffer_store_dwordx4 v[36:39],v0,s[8:11],s56 offen sc1
v_mfma_f32_16x16x16_bf16 v[24:27],v[36:37],v[124:125],v[24:27]
ds_read_b128 v[96:99],v11 offset:8192
v_mfma_f32_16x16x16_bf16 v[28:31],v[38:39],v[124:125],v[28:31]
ds_read_b128 v[100:103],v11 offset:9216
v_rcp_f32 v32,v32
v_mov_b64 v[112:113],0
v_mov_b64 v[114:115],0
v_pk_mul_f32 v[24:25],v[24:25],v[32:33] op_sel_hi:[1,0]
v_pk_mul_f32 v[26:27],v[26:27],v[32:33] op_sel_hi:[1,0]
v_mov_b64 v[116:117],0
v_mov_b64 v[118:119],0
v_pk_mul_f32 v[28:29],v[28:29],v[32:33] op_sel_hi:[1,0]
v_pk_mul_f32 v[30:31],v[30:31],v[32:33] op_sel_hi:[1,0]
v_cvt_pk_bf16_f32 v120,v24,v28
v_cvt_pk_bf16_f32 v121,v25,v29
v_cvt_pk_bf16_f32 v122,v26,v30
v_cvt_pk_bf16_f32 v123,v27,v31
ds_write_b128 v7,v[120:123]
ds_read_b128 v[104:107],v11 offset:10240
ds_read_b128 v[108:111],v11 offset:11264
ds_read_b128 v[40:43],v11 offset:12288
ds_read_b128 v[44:47],v11 offset:13312
s_waitcnt lgkmcnt(4)
s_barrier
ds_read_b128 v[24:27],v8 offset:0
ds_read_b128 v[28:31],v8 offset:512
ds_read_b128 v[32:35],v8 offset:1024
ds_read_b128 v[36:39],v8 offset:1536
ds_read_b128 v[48:51],v11 offset:14336
ds_read_b128 v[52:55],v11 offset:15360
v_mov_b64 v[88:89],0
v_mov_b64 v[90:91],0
v_mov_b64 v[92:93],0
v_mov_b64 v[94:95],0
s_waitcnt lgkmcnt(5)
v_smfmac_f32_16x16x64_bf16 v[112:115],v[24:27],v[56:63],v3
ds_read_b128 v[56:59],v11 offset:16384
ds_read_b128 v[60:63],v11 offset:17408
s_waitcnt lgkmcnt(6)
v_smfmac_f32_16x16x64_bf16 v[112:115],v[28:31],v[64:71],v3
ds_read_b128 v[64:67],v11 offset:18432
ds_read_b128 v[68:71],v11 offset:19456
s_waitcnt lgkmcnt(7)
v_smfmac_f32_16x16x64_bf16 v[112:115],v[32:35],v[72:79],v3
ds_read_b128 v[72:75],v11 offset:20480
ds_read_b128 v[76:79],v11 offset:21504
s_waitcnt lgkmcnt(8)
v_smfmac_f32_16x16x64_bf16 v[112:115],v[36:39],v[80:87],v3
ds_read_b128 v[80:83],v11 offset:22528
ds_read_b128 v[84:87],v11 offset:23552
s_waitcnt lgkmcnt(8)
v_smfmac_f32_16x16x64_bf16 v[116:119],v[24:27],v[96:103],v3
ds_read_b128 v[96:99],v11 offset:24576
ds_read_b128 v[100:103],v11 offset:25600
v_smfmac_f32_16x16x64_bf16 v[116:119],v[28:31],v[104:111],v3
v_cvt_pk_bf16_f32 v112,v112,v113
v_cvt_pk_bf16_f32 v113,v114,v115
buffer_store_dwordx2 v[112:113],v9,s[8:11],s65 offen
ds_read_b128 v[104:107],v11 offset:26624
ds_read_b128 v[108:111],v11 offset:27648
v_smfmac_f32_16x16x64_bf16 v[116:119],v[32:35],v[40:47],v3
ds_read_b128 v[40:43],v11 offset:28672
ds_read_b128 v[44:47],v11 offset:29696
v_smfmac_f32_16x16x64_bf16 v[116:119],v[36:39],v[48:55],v3
s_waitcnt lgkmcnt(12)
ds_read_b128 v[48:51],v11 offset:30720
ds_read_b128 v[52:55],v11 offset:31744
s_waitcnt lgkmcnt(14)
v_smfmac_f32_16x16x64_bf16 v[88:91],v[24:27],v[56:63],v3
s_nop 2
v_cvt_pk_bf16_f32 v116,v116,v117
v_cvt_pk_bf16_f32 v117,v118,v119
s_add_u32 s56,s65,65536
buffer_store_dwordx2 v[116:117],v9,s[8:11],s56 offen
s_waitcnt lgkmcnt(12)
v_smfmac_f32_16x16x64_bf16 v[88:91],v[28:31],v[64:71],v3
s_waitcnt lgkmcnt(10)
v_smfmac_f32_16x16x64_bf16 v[88:91],v[32:35],v[72:79],v3
s_waitcnt lgkmcnt(8)
v_smfmac_f32_16x16x64_bf16 v[88:91],v[36:39],v[80:87],v3
s_waitcnt lgkmcnt(6)
v_smfmac_f32_16x16x64_bf16 v[92:95],v[24:27],v[96:103],v3
s_waitcnt lgkmcnt(4)
v_smfmac_f32_16x16x64_bf16 v[92:95],v[28:31],v[104:111],v3
v_cvt_pk_bf16_f32 v88,v88,v89
v_cvt_pk_bf16_f32 v89,v90,v91
s_add_u32 s56,s65,131072
buffer_store_dwordx2 v[88:89],v9,s[8:11],s56 offen
s_waitcnt lgkmcnt(2)
v_smfmac_f32_16x16x64_bf16 v[92:95],v[32:35],v[40:47],v3
s_waitcnt lgkmcnt(0)
v_smfmac_f32_16x16x64_bf16 v[92:95],v[36:39],v[48:55],v3
s_add_u32 s78,s79,s75
s_add_u32 s75,s75,8192
s_add_u32 s64,s75,13631488
s_add_u32 s70,s64,4096
s_add_u32 s68,s68,262144
s_add_u32 s51,s51,1
s_nop 1
v_cvt_pk_bf16_f32 v92,v92,v93
v_cvt_pk_bf16_f32 v93,v94,v95
s_add_u32 s56,s65,196608
buffer_store_dwordx2 v[92:93],v9,s[8:11],s56 offen
s_xor_b32 s65,s65,262144
s_cmp_eq_u32 s51,64
s_cbranch_scc1 L_cend_138
s_cmp_lt_u32 s47,16
s_waitcnt vmcnt(2)
s_cbranch_scc1 L_cea_145
s_barrier
ds_read_b128 v[56:59],v1 offset:0
ds_read_b128 v[60:63],v1 offset:4096
ds_read_b128 v[64:67],v1 offset:1024
ds_read_b128 v[68:71],v1 offset:5120
ds_read_b128 v[72:75],v1 offset:2048
ds_read_b128 v[76:79],v1 offset:6144
ds_read_b128 v[80:83],v1 offset:3072
ds_read_b128 v[84:87],v1 offset:7168
v_add_u32 v12,s73,v1
ds_read_b128 v[88:91],v12 offset:8192
ds_read_b128 v[92:95],v12 offset:9216
v_mov_b64 v[96:97],0
v_mov_b64 v[98:99],0
v_mov_b64 v[100:101],0
v_mov_b64 v[102:103],0
v_mov_b64 v[104:105],0
v_mov_b64 v[106:107],0
v_mov_b64 v[108:109],0
v_mov_b64 v[110:111],0
v_mov_b64 v[112:113],0
v_mov_b64 v[114:115],0
v_mov_b64 v[116:117],0
v_mov_b64 v[118:119],0
v_readlane_b32 s76,v23,4
s_cmp_ge_u32 s51,63
s_cselect_b32 s76,1,s76
v_readlane_b32 s77,v23,5
s_cmp_gt_u32 s51,60
s_cselect_b32 s77,1,s77
s_waitcnt vmcnt(0)
L_crp_140:
buffer_load_dwordx4 v[120:123],v0,s[8:11],s66 offen offset:0 sc1
buffer_load_dwordx4 v[124:127],v0,s[8:11],s66 offen offset:1024 sc1
s_sub_u32 s49,s49,1
s_cbranch_scc1 L_abort
s_waitcnt vmcnt(1)
v_mfma_f32_16x16x32_bf16 v[28:31],v[18:21],v[120:123],0
s_waitcnt vmcnt(0)
v_mfma_f32_16x16x32_bf16 v[28:31],v[18:21],v[124:127],v[28:31]
s_nop 7
v_cmp_u_f32 vcc,v28,v28
v_add_f32_dpp v32,v28,v28 row_ror:8 row_mask:0xf bank_mask:0x3
v_add_f32_dpp v33,v29,v29 row_ror:8 row_mask:0xf bank_mask:0x3
v_add_f32_dpp v32,v30,v30 row_ror:8 row_mask:0xf bank_mask:0xc
v_add_f32_dpp v33,v31,v31 row_ror:8 row_mask:0xf bank_mask:0xc
s_nop 0
v_add_f32_dpp v32,v32,v32 row_shl:4 row_mask:0xf bank_mask:0x5
v_add_f32_dpp v33,v33,v33 row_shl:4 row_mask:0xf bank_mask:0x5
s_cbranch_vccnz L_crp_140
v_cvt_pk_bf16_f32 v34,v32,v33
buffer_store_dword v34,v10,s[8:11],s64 offen
s_mov_b32 s69,s66
s_xor_b32 s66,s66,262144
buffer_load_dwordx4 v[24:27],v13,s[8:11],s64 offen sc1
s_cmp_lg_u32 s77,1
s_cbranch_scc1 L_cjw_127
s_branch L_chain_135
L_cea_145:
buffer_load_dwordx4 v[120:123],v0,s[8:11],s66 offen offset:0 sc1
buffer_load_dwordx4 v[124:127],v0,s[8:11],s66 offen offset:1024 sc1
v_mov_b64 v[96:97],0
v_mov_b64 v[98:99],0
v_mov_b64 v[100:101],0
v_mov_b64 v[102:103],0
v_mov_b64 v[104:105],0
v_mov_b64 v[106:107],0
v_mov_b64 v[108:109],0
v_mov_b64 v[110:111],0
v_mov_b64 v[112:113],0
v_mov_b64 v[114:115],0
v_mov_b64 v[116:117],0
v_mov_b64 v[118:119],0
v_readlane_b32 s76,v23,4
s_cmp_ge_u32 s51,63
s_cselect_b32 s76,1,s76
v_readlane_b32 s77,v23,5
s_cmp_gt_u32 s51,60
s_cselect_b32 s77,1,s77
s_branch L_cr1_146
L_crb_141:
buffer_load_dwordx4 v[120:123],v0,s[8:11],s66 offen offset:0 sc1
buffer_load_dwordx4 v[124:127],v0,s[8:11],s66 offen offset:1024 sc1
L_cr1_146:
s_sub_u32 s49,s49,1
s_cbranch_scc1 L_abort
s_waitcnt vmcnt(1)
v_mfma_f32_16x16x32_bf16 v[28:31],v[18:21],v[120:123],0
s_waitcnt vmcnt(0)
v_mfma_f32_16x16x32_bf16 v[28:31],v[18:21],v[124:127],v[28:31]
s_nop 7
v_cmp_u_f32 vcc,v28,v28
v_add_f32_dpp v32,v28,v28 row_ror:8 row_mask:0xf bank_mask:0x3
v_add_f32_dpp v33,v29,v29 row_ror:8 row_mask:0xf bank_mask:0x3
v_add_f32_dpp v32,v30,v30 row_ror:8 row_mask:0xf bank_mask:0xc
v_add_f32_dpp v33,v31,v31 row_ror:8 row_mask:0xf bank_mask:0xc
s_nop 0
v_add_f32_dpp v32,v32,v32 row_shl:4 row_mask:0xf bank_mask:0x5
v_add_f32_dpp v33,v33,v33 row_shl:4 row_mask:0xf bank_mask:0x5
s_cbranch_vccnz L_crb_141
v_cvt_pk_bf16_f32 v34,v32,v33
buffer_store_dword v34,v10,s[8:11],s64 offen
s_mov_b32 s69,s66
s_xor_b32 s66,s66,262144
s_barrier
ds_read_b128 v[56:59],v1 offset:0
ds_read_b128 v[60:63],v1 offset:4096
ds_read_b128 v[64:67],v1 offset:1024
ds_read_b128 v[68:71],v1 offset:5120
buffer_load_dwordx4 v[24:27],v13,s[8:11],s64 offen sc1
ds_read_b128 v[72:75],v1 offset:2048
ds_read_b128 v[76:79],v1 offset:6144
ds_read_b128 v[80:83],v1 offset:3072
ds_read_b128 v[84:87],v1 offset:7168
v_add_u32 v12,s73,v1
ds_read_b128 v[88:91],v12 offset:8192
ds_read_b128 v[92:95],v12 offset:9216
s_cmp_lg_u32 s77,1
s_cbranch_scc1 L_cjw_127
s_branch L_chain_135
L_ckw_125:
s_lshl2_add_u32 s59,s47,s75
s_add_u32 s59,s59,10494080
L_ww_147:
buffer_load_dword v23,off,s[8:11],s59 sc1
s_sub_u32 s49,s49,1
s_cbranch_scc1 L_abort
s_waitcnt vmcnt(0)
v_readfirstlane_b32 s76,v23
s_cmp_eq_u32 s76,0
s_cbranch_scc1 L_ww_147
L_wwd_148:
s_branch L_ckb_126
L_cjw_127:
s_add_u32 s59,s75,10511616
L_ww_149:
buffer_load_dword v120,off,s[8:11],s59 sc1
s_sub_u32 s49,s49,1
s_cbranch_scc1 L_abort
s_waitcnt vmcnt(0)
v_readfirstlane_b32 s77,v120
s_cmp_eq_u32 s77,0
s_cbranch_scc1 L_ww_149
L_wwd_150:
s_cmp_eq_u32 s77,1
s_cbranch_scc1 L_chain_135
L_cjump_128:
buffer_load_dwordx4 v[24:27],v13,s[8:11],s64 offen sc1
buffer_load_dwordx4 v[40:43],v13,s[8:11],s70 offen sc1
s_sub_u32 s49,s49,1
s_cbranch_scc1 L_abort
s_waitcnt vmcnt(0)
v_max3_u32 v12,v24,v25,v26
v_max_u32 v12,v27,v12
v_max3_u32 v12,v40,v41,v12
v_max3_u32 v12,v42,v43,v12
v_cmp_le_u32 vcc,s72,v12
s_cbranch_vccnz L_cjump_128
s_waitcnt lgkmcnt(0)
s_barrier
s_add_u32 s51,s51,3
s_branch L_cst_124
L_cpb_142:
buffer_load_dwordx4 v[40:43],v13,s[8:11],s70 offen sc1
s_waitcnt vmcnt(0)
v_max3_u32 v12,v40,v41,v42
v_max_u32 v12,v43,v12
v_cmp_le_u32 vcc,s72,v12
s_cbranch_vccz L_cback_144
s_sub_u32 s49,s49,1
s_cmp_gt_i32 s49,0
s_cbranch_scc1 L_cpb_142
s_branch L_abort
L_cend_138:
s_waitcnt vmcnt(0)
s_barrier
buffer_store_dword v2,off,s[8:11],s78 sc1
s_nop 11
v_lshrrev_b32 v1,4,v0
s_endpgm
L_abort2:
s_endpgm
L_wc:
s_nop 11
s_cmp_eq_u32 s48,1
s_cbranch_scc1 L_rc1_151
s_cmp_eq_u32 s48,2
s_cbranch_scc1 L_rc2_152
v_and_b32 v120,15,v1
v_lshrrev_b32 v121,4,v1
v_and_b32 v122,2,v1
v_cmp_eq_u32 vcc,0,v122
v_mov_b32 v2,0xeeee
v_mov_b32 v123,0x4444
v_cndmask_b32 v2,v2,v123,vcc
v_and_b32 v122,1,v1
v_cmp_eq_u32 vcc,0,v122
v_mov_b32 v3,0xdddd
v_mov_b32 v123,0x8888
v_cndmask_b32 v3,v3,v123,vcc
v_lshrrev_b32 v122,1,v120
v_bfe_u32 v123,v120,2,1
v_xor_b32 v123,v123,v122
v_lshlrev_b32 v4,7,v123
v_and_b32 v123,1,v120
v_lshl_add_u32 v4,v123,6,v4
v_xor_b32 v123,v121,v122
v_and_b32 v123,3,v123
v_lshl_add_u32 v4,v123,4,v4
s_lshl_b32 s56,s46,10
s_add_u32 s56,s56,147456
v_add_u32 v4,s56,v4
v_lshlrev_b32 v122,1,v121
v_add_u32 v122,0,v122
v_and_b32 v123,1,v121
v_xor_b32 v123,v123,v122
v_lshlrev_b32 v5,7,v123
v_bfe_u32 v123,v120,3,1
v_lshl_add_u32 v5,v123,6,v5
v_xor_b32 v123,v120,v122
v_and_b32 v123,3,v123
v_lshl_add_u32 v5,v123,4,v5
v_bfe_u32 v123,v120,2,1
v_lshl_add_u32 v5,v123,3,v5
v_add_u32 v5,147456,v5
v_lshlrev_b32 v122,1,v121
v_add_u32 v122,1,v122
v_and_b32 v123,1,v121
v_xor_b32 v123,v123,v122
v_lshlrev_b32 v6,7,v123
v_bfe_u32 v123,v120,3,1
v_lshl_add_u32 v6,v123,6,v6
v_xor_b32 v123,v120,v122
v_and_b32 v123,3,v123
v_lshl_add_u32 v6,v123,4,v6
v_bfe_u32 v123,v120,2,1
v_lshl_add_u32 v6,v123,3,v6
v_add_u32 v6,147456,v6
v_lshlrev_b32 v7,7,v121
v_lshrrev_b32 v122,1,v120
v_lshl_add_u32 v8,v122,4,v7
v_add_u32 v8,151552,v8
v_lshrrev_b32 v122,2,v120
v_lshl_add_u32 v7,v122,5,v7
v_and_b32 v122,1,v120
v_lshl_add_u32 v7,v122,4,v7
v_and_b32 v122,2,v120
v_lshl_add_u32 v7,v122,10,v7
s_lshl_b32 s56,s46,9
s_add_u32 s56,s56,151552
v_add_u32 v7,s56,v7
v_lshrrev_b32 v122,3,v1
v_lshlrev_b32 v9,11,v122
v_and_b32 v122,7,v1
v_lshl_add_u32 v9,v122,3,v9
s_lshl_b32 s56,s46,14
s_lshl_b32 s57,s47,6
s_add_u32 s56,s56,s57
v_add_u32 v9,s56,v9
s_lshl_b32 s71,s47,2
s_add_u32 s71,s71,s46
s_bfe_u32 s56,s71,0x10003
s_lshl_b32 s56,s56,11
s_and_b32 s57,s71,1
s_lshl_b32 s57,s57,10
s_add_u32 s56,s56,s57
s_bfe_u32 s57,s71,0x10002
s_lshl_b32 s57,s57,9
s_add_u32 s56,s56,s57
s_bfe_u32 s57,s71,0x10001
s_lshl_b32 s57,s57,6
s_add_u32 s56,s56,s57
s_bfe_u32 s57,s71,0x10004
s_lshl_b32 s57,s57,8
s_add_u32 s56,s56,s57
s_bfe_u32 s57,s71,0x10005
s_lshl_b32 s57,s57,7
s_add_u32 s56,s56,s57
s_bfe_u32 s57,s71,0x10006
s_lshl_b32 s57,s57,12
s_add_u32 s56,s56,s57
v_and_b32 v122,3,v120
v_lshlrev_b32 v10,2,v122
v_bfe_u32 v122,v120,3,1
v_lshl_add_u32 v10,v122,4,v10
v_and_b32 v122,1,v121
v_lshl_add_u32 v10,v122,5,v10
v_add_u32 v10,s56,v10
v_and_b32 v123,36,v1
v_mov_b32 v122,0x80000000
v_cmp_eq_u32 vcc,0,v123
s_nop 1
v_cndmask_b32 v10,v122,v10,vcc
s_lshl_b32 s56,s46,15
v_add_u32 v11,s56,v0
s_lshl_b32 s71,s71,11
s_lshl_b32 s73,s46,11
s_mov_b32 s72,0xffc00000
s_mov_b32 s74,0
v_lshrrev_b32 v13,3,v1
v_lshlrev_b32 v13,9,v13
v_and_b32 v122,7,v1
v_lshl_add_u32 v13,v122,4,v13
v_and_b32 v122,15,v1
v_and_b32 v123,1,v1
v_lshlrev_b32 v123,4,v123
v_mov_b32 v124,0x3f80
v_lshlrev_b32 v124,v123,v124
v_lshrrev_b32 v122,1,v122
v_cmp_eq_u32 vcc,0,v122
s_nop 1
v_cndmask_b32 v18,0,v124,vcc
v_cmp_eq_u32 vcc,1,v122
s_nop 1
v_cndmask_b32 v19,0,v124,vcc
v_cmp_eq_u32 vcc,2,v122
s_nop 1
v_cndmask_b32 v20,0,v124,vcc
v_cmp_eq_u32 vcc,3,v122
s_nop 1
v_cndmask_b32 v21,0,v124,vcc
s_and_b32 s56,s46,1
s_lshl_b32 s56,s56,8
s_and_b32 s57,s46,2
s_lshl_b32 s57,s57,6
s_add_u32 s56,s56,s57
v_add_u32 v13,s56,v13
s_xor_b32 s56,s46,0
s_lshl_b32 s56,s56,10
s_add_u32 s56,s56,147456
v_add_u32 v14,s56,v0
s_xor_b32 s56,s46,1
s_lshl_b32 s56,s56,10
s_add_u32 s56,s56,147456
v_add_u32 v15,s56,v0
s_xor_b32 s56,s46,2
s_lshl_b32 s56,s56,10
s_add_u32 s56,s56,147456
v_add_u32 v16,s56,v0
s_xor_b32 s56,s46,3
s_lshl_b32 s56,s56,10
s_add_u32 s56,s56,147456
v_add_u32 v17,s56,v0
v_add_u32 v22,11550720,v10
s_lshl_b32 s56,s47,2
s_add_u32 s56,s56,10502144
v_writelane_b32 v22,s56,4
s_mov_b32 s56,10519808
v_writelane_b32 v22,s56,5
v_add_u32 v1,131072,v0
s_mov_b32 s65,14680064
s_add_u32 s66,s71,14680064
s_add_u32 s69,s71,14942208
s_lshl_b32 s79,s47,2
s_add_u32 s79,s79,10485760
s_cmp_eq_u32 s46,0
s_cselect_b32 s79,s79,0x80000000
s_cmp_eq_u32 s47,0
s_cselect_b32 s31,17825792,-1
s_and_b32 s31,s31,0x8fffffff
s_mov_b32 s51,0
L_cst_153:
s_lshl_b32 s59,s51,13
s_lshl2_add_u32 s59,s47,s59
s_add_u32 s59,s59,10485760
L_ww_158:
buffer_load_dword v120,off,s[8:11],s59 sc1
s_sub_u32 s49,s49,1
s_cbranch_scc1 L_abort2
s_waitcnt vmcnt(0)
v_readfirstlane_b32 s61,v120
s_cmp_eq_u32 s61,0
s_cbranch_scc1 L_ww_158
L_wwd_159:
s_lshl_b32 s56,s51,5
s_add_u32 s56,s56,s47
s_mul_i32 s56,s56,24576
s_add_u32 s56,s56,100663296
s_add_u32 s67,s56,s73
s_add_u32 m0,s73,131072
s_add_u32 s57,s67,8192
buffer_load_dwordx4 v0,s[8:11],s67 offen sc1 lds
buffer_load_dwordx4 v0,s[8:11],s67 offen offset:1024 sc1 lds
s_add_u32 m0,s73,139264
s_add_u32 s67,s67,786432
buffer_load_dwordx4 v0,s[8:11],s57 offen sc1 lds
buffer_load_dwordx4 v0,s[8:11],s57 offen offset:1024 sc1 lds
s_lshl_b32 s75,s51,13
s_add_u32 s64,s75,11534336
s_add_u32 s70,s64,4096
s_lshl_b32 s68,s51,5
s_add_u32 s68,s68,s47
s_lshl_b32 s68,s68,13
s_lshl_b32 s56,s46,10
s_add_u32 s68,s68,s56
s_add_u32 s68,s68,41943040
s_sub_u32 s67,s67,0
s_mov_b32 s78,0x80000000
s_cmp_eq_u32 s51,63
s_cselect_b32 s76,1,0
s_waitcnt vmcnt(0)
s_barrier
ds_read_b128 v[56:59],v1 offset:0
ds_read_b128 v[60:63],v1 offset:4096
ds_read_b128 v[64:67],v1 offset:1024
ds_read_b128 v[68:71],v1 offset:5120
ds_read_b128 v[72:75],v1 offset:2048
ds_read_b128 v[76:79],v1 offset:6144
ds_read_b128 v[80:83],v1 offset:3072
ds_read_b128 v[84:87],v1 offset:7168
v_add_u32 v12,s73,v1
ds_read_b128 v[88:91],v12 offset:8192
ds_read_b128 v[92:95],v12 offset:9216
v_mov_b64 v[96:97],0
v_mov_b64 v[98:99],0
v_mov_b64 v[100:101],0
v_mov_b64 v[102:103],0
v_mov_b64 v[104:105],0
v_mov_b64 v[106:107],0
v_mov_b64 v[108:109],0
v_mov_b64 v[110:111],0
v_mov_b64 v[112:113],0
v_mov_b64 v[114:115],0
v_mov_b64 v[116:117],0
v_mov_b64 v[118:119],0
buffer_load_dwordx4 v[24:27],v13,s[8:11],s64 offen sc1
L_chain_160:
L_cpa_161:
buffer_load_dwordx4 v[24:27],v13,s[8:11],s64 offen sc1
s_sub_u32 s49,s49,1
s_cbranch_scc1 L_abort2
s_waitcnt vmcnt(1)
v_max3_u32 v12,v24,v25,v26
v_max_u32 v12,v27,v12
v_cmp_le_u32 vcc,s72,v12
s_cbranch_vccnz L_cpa_161
L_cgo_164:
ds_write_b128 v14,v[24:27] offset:0
buffer_load_dwordx4 v[40:43],v13,s[8:11],s70 offen sc1
v_smfmac_f32_16x16x64_bf16 v[96:99],v[24:27],a[0:7],v2
s_add_u32 m0,s73,131072
v_smfmac_f32_16x16x64_bf16 v[100:103],v[24:27],a[128:135],v2
s_add_u32 s57,s67,8192
v_smfmac_f32_16x16x64_bf16 v[104:107],v[24:27],a[8:15],v2
v_smfmac_f32_16x16x64_bf16 v[108:111],v[24:27],a[136:143],v2
s_waitcnt lgkmcnt(0)
s_barrier
ds_read_b128 v[28:31],v15 offset:0
ds_read_b128 v[32:35],v16 offset:0
ds_read_b128 v[36:39],v17 offset:0
v_smfmac_f32_16x16x64_bf16 v[112:115],v[24:27],v[128:135],v2
v_smfmac_f32_16x16x64_bf16 v[116:119],v[24:27],v[136:143],v2
s_waitcnt lgkmcnt(2)
v_smfmac_f32_16x16x64_bf16 v[96:99],v[28:31],a[16:23],v2
s_lshl_b32 s56,s46,10
v_smfmac_f32_16x16x64_bf16 v[100:103],v[28:31],a[144:151],v2
v_smfmac_f32_16x16x64_bf16 v[104:107],v[28:31],a[24:31],v2
v_smfmac_f32_16x16x64_bf16 v[108:111],v[28:31],a[152:159],v2
s_waitcnt lgkmcnt(1) vmcnt(0)
v_smfmac_f32_16x16x64_bf16 v[96:99],v[32:35],a[32:39],v2
v_max3_u32 v12,v40,v41,v42
v_smfmac_f32_16x16x64_bf16 v[100:103],v[32:35],a[160:167],v2
v_max_u32 v12,v43,v12
v_smfmac_f32_16x16x64_bf16 v[104:107],v[32:35],a[40:47],v2
v_cmp_le_u32 vcc,s72,v12
v_smfmac_f32_16x16x64_bf16 v[108:111],v[32:35],a[168:175],v2
s_cbranch_vccnz L_cpb_167
L_cback_169:
s_waitcnt lgkmcnt(0)
ds_write_b128 v14,v[40:43] offset:4096
v_smfmac_f32_16x16x64_bf16 v[96:99],v[36:39],a[48:55],v2
v_mov_b64 v[120:121],-1
v_smfmac_f32_16x16x64_bf16 v[100:103],v[36:39],a[176:183],v2
v_mov_b64 v[122:123],-1
v_smfmac_f32_16x16x64_bf16 v[104:107],v[36:39],a[56:63],v2
v_add_u32 v124,s56,v5
v_smfmac_f32_16x16x64_bf16 v[108:111],v[36:39],a[184:191],v2
v_add_u32 v126,s56,v6
s_waitcnt lgkmcnt(0)
s_barrier
v_smfmac_f32_16x16x64_bf16 v[96:99],v[40:43],a[64:71],v2
ds_read_b128 v[44:47],v15 offset:4096
v_smfmac_f32_16x16x64_bf16 v[100:103],v[40:43],a[192:199],v2
ds_read_b128 v[48:51],v16 offset:4096
v_smfmac_f32_16x16x64_bf16 v[104:107],v[40:43],a[72:79],v2
ds_read_b128 v[52:55],v17 offset:4096
v_smfmac_f32_16x16x64_bf16 v[108:111],v[40:43],a[200:207],v2
s_cmp_eq_u32 s76,0
s_cbranch_scc1 L_ckw_154
L_ckb_155:
s_waitcnt lgkmcnt(2)
v_smfmac_f32_16x16x64_bf16 v[96:99],v[44:47],a[80:87],v2
buffer_load_dwordx4 v0,s[8:11],s67 offen sc1 lds
v_smfmac_f32_16x16x64_bf16 v[100:103],v[44:47],a[208:215],v2
buffer_load_dwordx4 v0,s[8:11],s67 offen offset:1024 sc1 lds
v_smfmac_f32_16x16x64_bf16 v[104:107],v[44:47],a[88:95],v2
s_add_u32 m0,s73,139264
v_smfmac_f32_16x16x64_bf16 v[108:111],v[44:47],a[216:223],v2
s_waitcnt lgkmcnt(1)
v_smfmac_f32_16x16x64_bf16 v[96:99],v[48:51],a[96:103],v2
s_add_u32 s67,s67,786432
v_smfmac_f32_16x16x64_bf16 v[100:103],v[48:51],a[224:231],v2
buffer_load_dwordx4 v0,s[8:11],s57 offen sc1 lds
v_smfmac_f32_16x16x64_bf16 v[104:107],v[48:51],a[104:111],v2
buffer_load_dwordx4 v0,s[8:11],s57 offen offset:1024 sc1 lds
v_smfmac_f32_16x16x64_bf16 v[108:111],v[48:51],a[232:239],v2
s_waitcnt lgkmcnt(0)
v_smfmac_f32_16x16x64_bf16 v[96:99],v[52:55],a[112:119],v2
buffer_load_dword v23,v22,s[8:11],s75 offen sc1
v_smfmac_f32_16x16x64_bf16 v[100:103],v[52:55],a[240:247],v2
buffer_store_dwordx4 v[120:123],v0,s[8:11],s69 offen sc1
v_smfmac_f32_16x16x64_bf16 v[104:107],v[52:55],a[120:127],v2
buffer_store_dwordx4 v[120:123],v0,s[8:11],s69 offen offset:1024 sc1
v_smfmac_f32_16x16x64_bf16 v[108:111],v[52:55],a[248:255],v2
v_smfmac_f32_16x16x64_bf16 v[112:115],v[28:31],v[144:151],v2
v_smfmac_f32_16x16x64_bf16 v[116:119],v[28:31],v[152:159],v2
v_pk_add_f32 v[96:97],v[96:97],v[98:99]
v_pk_add_f32 v[100:101],v[100:101],v[102:103]
v_cvt_pk_bf16_f32 v120,v96,v97
v_cvt_pk_bf16_f32 v121,v100,v101
v_pk_add_f32 v[104:105],v[104:105],v[106:107]
v_pk_add_f32 v[108:109],v[108:109],v[110:111]
v_cvt_pk_bf16_f32 v122,v104,v105
v_cvt_pk_bf16_f32 v123,v108,v109
ds_write_b128 v4,v[120:123]
v_smfmac_f32_16x16x64_bf16 v[112:115],v[32:35],v[160:167],v2
v_smfmac_f32_16x16x64_bf16 v[116:119],v[32:35],v[168:175],v2
v_smfmac_f32_16x16x64_bf16 v[112:115],v[36:39],v[176:183],v2
v_smfmac_f32_16x16x64_bf16 v[116:119],v[36:39],v[184:191],v2
s_waitcnt lgkmcnt(0)
s_barrier
ds_read_b64_tr_b16 v[96:97],v5 offset:0
ds_read_b64_tr_b16 v[98:99],v6 offset:0
ds_read_b64_tr_b16 v[100:101],v5 offset:1024
ds_read_b64_tr_b16 v[102:103],v6 offset:1024
ds_read_b64_tr_b16 v[104:105],v5 offset:2048
ds_read_b64_tr_b16 v[106:107],v6 offset:2048
ds_read_b64_tr_b16 v[108:109],v5 offset:3072
ds_read_b64_tr_b16 v[110:111],v6 offset:3072
ds_read_b64_tr_b16 v[124:125],v124
ds_read_b64_tr_b16 v[126:127],v126
v_smfmac_f32_16x16x64_bf16 v[112:115],v[40:43],v[192:199],v2
v_smfmac_f32_16x16x64_bf16 v[116:119],v[40:43],v[200:207],v2
s_waitcnt lgkmcnt(8)
v_mfma_f32_16x16x32_bf16 v[24:27],v[56:59],v[96:99],0
v_mfma_f32_16x16x32_bf16 v[28:31],v[60:63],v[96:99],0
v_mfma_f32_16x16x32_bf16 v[32:35],v[96:99],v[96:99],0
s_waitcnt lgkmcnt(6)
v_mfma_f32_16x16x32_bf16 v[24:27],v[64:67],v[100:103],v[24:27]
ds_read_b128 v[56:59],v11 offset:0
v_mfma_f32_16x16x32_bf16 v[28:31],v[68:71],v[100:103],v[28:31]
ds_read_b128 v[60:63],v11 offset:1024
v_mfma_f32_16x16x32_bf16 v[32:35],v[100:103],v[100:103],v[32:35]
s_waitcnt lgkmcnt(6)
v_mfma_f32_16x16x32_bf16 v[24:27],v[72:75],v[104:107],v[24:27]
ds_read_b128 v[64:67],v11 offset:2048
v_mfma_f32_16x16x32_bf16 v[28:31],v[76:79],v[104:107],v[28:31]
ds_read_b128 v[68:71],v11 offset:3072
v_mfma_f32_16x16x32_bf16 v[32:35],v[104:107],v[104:107],v[32:35]
s_waitcnt lgkmcnt(6)
v_mfma_f32_16x16x32_bf16 v[24:27],v[80:83],v[108:111],v[24:27]
ds_read_b128 v[72:75],v11 offset:4096
v_mfma_f32_16x16x32_bf16 v[28:31],v[84:87],v[108:111],v[28:31]
ds_read_b128 v[76:79],v11 offset:5120
v_mfma_f32_16x16x32_bf16 v[32:35],v[108:111],v[108:111],v[32:35]
s_waitcnt lgkmcnt(6)
v_smfmac_f32_16x16x64_bf16 v[112:115],v[44:47],v[208:215],v2
buffer_store_dwordx4 v[124:127],v0,s[8:11],s68 offen sc1
v_smfmac_f32_16x16x64_bf16 v[116:119],v[44:47],v[216:223],v2
v_smfmac_f32_16x16x64_bf16 v[112:115],v[48:51],v[224:231],v2
v_smfmac_f32_16x16x64_bf16 v[116:119],v[48:51],v[232:239],v2
v_smfmac_f32_16x16x64_bf16 v[112:115],v[52:55],v[240:247],v2
v_smfmac_f32_16x16x64_bf16 v[116:119],v[52:55],v[248:255],v2
v_mov_b32 v125,0
v_mov_b64 v[52:53],s[28:29]
v_mov_b64 v[54:55],s[28:29]
v_max3_f32 v36,v24,v25,v26
v_max3_f32 v37,v27,v28,v29
v_max3_f32 v36,v30,v31,v36
v_max3_f32 v37,v34,v35,v37
v_max_f32 v36,v36,v37
v_max_f32 v37,v36,v37
ds_read_b128 v[80:83],v11 offset:6144
s_nop 0
v_permlane16_swap_b32 v36,v37
v_max_f32 v36,v36,v37
v_max_f32 v37,v36,v37
ds_read_b128 v[84:87],v11 offset:7168
s_nop 0
v_permlane32_swap_b32 v36,v37
v_max_f32 v36,v36,v37
v_mul_f32 v36,s80,v36
v_fma_f32 v24,v24,s80,-v36
v_fma_f32 v25,v25,s80,-v36
v_exp_f32 v24,v24
v_fma_f32 v26,v26,s80,-v36
v_exp_f32 v25,v25
v_fma_f32 v27,v27,s80,-v36
v_exp_f32 v26,v26
v_fma_f32 v28,v28,s80,-v36
v_exp_f32 v27,v27
v_fma_f32 v29,v29,s80,-v36
v_exp_f32 v28,v28
v_fma_f32 v30,v30,s80,-v36
v_exp_f32 v29,v29
v_fma_f32 v31,v31,s80,-v36
v_exp_f32 v30,v30
v_fma_f32 v34,v34,s80,-v36
v_exp_f32 v31,v31
v_fma_f32 v35,v35,s80,-v36
v_exp_f32 v34,v34
v_exp_f32 v35,v35
v_cvt_pk_bf16_f32 v120,v24,v25
v_cvt_pk_bf16_f32 v121,v26,v27
v_cvt_pk_bf16_f32 v122,v28,v29
v_cvt_pk_bf16_f32 v123,v30,v31
v_cvt_pk_bf16_f32 v124,v34,v35
s_nop 0
v_mfma_f32_16x16x32_bf16 v[32:35],v[52:55],v[120:123],0
v_pk_add_f32 v[112:113],v[112:113],v[114:115]
v_pk_add_f32 v[116:117],v[116:117],v[118:119]
v_mfma_f32_16x16x32_bf16 v[24:27],v[88:91],v[120:123],0
v_cvt_pk_bf16_f32 v36,v112,v113
v_cvt_pk_bf16_f32 v37,v116,v117
v_mfma_f32_16x16x32_bf16 v[28:31],v[92:95],v[120:123],0
v_cvt_pk_bf16_f32 v38,v116,v117
v_mov_b32 v39,0
v_mfma_f32_16x16x16_bf16 v[32:35],v[52:53],v[124:125],v[32:35]
s_add_u32 s56,s68,4096
buffer_store_dwordx4 v[36:39],v0,s[8:11],s56 offen sc1
v_mfma_f32_16x16x16_bf16 v[24:27],v[36:37],v[124:125],v[24:27]
ds_read_b128 v[96:99],v11 offset:8192
v_mfma_f32_16x16x16_bf16 v[28:31],v[38:39],v[124:125],v[28:31]
ds_read_b128 v[100:103],v11 offset:9216
v_rcp_f32 v32,v32
v_mov_b64 v[112:113],0
v_mov_b64 v[114:115],0
v_pk_mul_f32 v[24:25],v[24:25],v[32:33] op_sel_hi:[1,0]
v_pk_mul_f32 v[26:27],v[26:27],v[32:33] op_sel_hi:[1,0]
v_mov_b64 v[116:117],0
v_mov_b64 v[118:119],0
v_pk_mul_f32 v[28:29],v[28:29],v[32:33] op_sel_hi:[1,0]
v_pk_mul_f32 v[30:31],v[30:31],v[32:33] op_sel_hi:[1,0]
v_cvt_pk_bf16_f32 v120,v24,v28
v_cvt_pk_bf16_f32 v121,v25,v29
v_cvt_pk_bf16_f32 v122,v26,v30
v_cvt_pk_bf16_f32 v123,v27,v31
ds_write_b128 v7,v[120:123]
ds_read_b128 v[104:107],v11 offset:10240
ds_read_b128 v[108:111],v11 offset:11264
ds_read_b128 v[40:43],v11 offset:12288
ds_read_b128 v[44:47],v11 offset:13312
s_waitcnt lgkmcnt(4)
s_barrier
ds_read_b128 v[24:27],v8 offset:0
ds_read_b128 v[28:31],v8 offset:512
ds_read_b128 v[32:35],v8 offset:1024
ds_read_b128 v[36:39],v8 offset:1536
ds_read_b128 v[48:51],v11 offset:14336
ds_read_b128 v[52:55],v11 offset:15360
v_mov_b64 v[88:89],0
v_mov_b64 v[90:91],0
v_mov_b64 v[92:93],0
v_mov_b64 v[94:95],0
s_waitcnt lgkmcnt(5)
v_smfmac_f32_16x16x64_bf16 v[112:115],v[24:27],v[56:63],v3
ds_read_b128 v[56:59],v11 offset:16384
ds_read_b128 v[60:63],v11 offset:17408
s_waitcnt lgkmcnt(6)
v_smfmac_f32_16x16x64_bf16 v[112:115],v[28:31],v[64:71],v3
ds_read_b128 v[64:67],v11 offset:18432
ds_read_b128 v[68:71],v11 offset:19456
s_waitcnt lgkmcnt(7)
v_smfmac_f32_16x16x64_bf16 v[112:115],v[32:35],v[72:79],v3
ds_read_b128 v[72:75],v11 offset:20480
ds_read_b128 v[76:79],v11 offset:21504
s_waitcnt lgkmcnt(8)
v_smfmac_f32_16x16x64_bf16 v[112:115],v[36:39],v[80:87],v3
ds_read_b128 v[80:83],v11 offset:22528
ds_read_b128 v[84:87],v11 offset:23552
s_waitcnt lgkmcnt(8)
v_smfmac_f32_16x16x64_bf16 v[116:119],v[24:27],v[96:103],v3
ds_read_b128 v[96:99],v11 offset:24576
ds_read_b128 v[100:103],v11 offset:25600
v_smfmac_f32_16x16x64_bf16 v[116:119],v[28:31],v[104:111],v3
v_cvt_pk_bf16_f32 v112,v112,v113
v_cvt_pk_bf16_f32 v113,v114,v115
buffer_store_dwordx2 v[112:113],v9,s[8:11],s65 offen sc1
ds_read_b128 v[104:107],v11 offset:26624
ds_read_b128 v[108:111],v11 offset:27648
v_smfmac_f32_16x16x64_bf16 v[116:119],v[32:35],v[40:47],v3
ds_read_b128 v[40:43],v11 offset:28672
ds_read_b128 v[44:47],v11 offset:29696
v_smfmac_f32_16x16x64_bf16 v[116:119],v[36:39],v[48:55],v3
s_waitcnt lgkmcnt(12)
ds_read_b128 v[48:51],v11 offset:30720
ds_read_b128 v[52:55],v11 offset:31744
s_waitcnt lgkmcnt(14)
v_smfmac_f32_16x16x64_bf16 v[88:91],v[24:27],v[56:63],v3
s_nop 2
v_cvt_pk_bf16_f32 v116,v116,v117
v_cvt_pk_bf16_f32 v117,v118,v119
s_add_u32 s56,s65,65536
buffer_store_dwordx2 v[116:117],v9,s[8:11],s56 offen sc1
s_waitcnt lgkmcnt(12)
v_smfmac_f32_16x16x64_bf16 v[88:91],v[28:31],v[64:71],v3
s_waitcnt lgkmcnt(10)
v_smfmac_f32_16x16x64_bf16 v[88:91],v[32:35],v[72:79],v3
s_waitcnt lgkmcnt(8)
v_smfmac_f32_16x16x64_bf16 v[88:91],v[36:39],v[80:87],v3
s_waitcnt lgkmcnt(6)
v_smfmac_f32_16x16x64_bf16 v[92:95],v[24:27],v[96:103],v3
s_waitcnt lgkmcnt(4)
v_smfmac_f32_16x16x64_bf16 v[92:95],v[28:31],v[104:111],v3
v_cvt_pk_bf16_f32 v88,v88,v89
v_cvt_pk_bf16_f32 v89,v90,v91
s_add_u32 s56,s65,131072
buffer_store_dwordx2 v[88:89],v9,s[8:11],s56 offen sc1
s_waitcnt lgkmcnt(2)
v_smfmac_f32_16x16x64_bf16 v[92:95],v[32:35],v[40:47],v3
s_waitcnt lgkmcnt(0)
v_smfmac_f32_16x16x64_bf16 v[92:95],v[36:39],v[48:55],v3
s_add_u32 s78,s79,s75
s_add_u32 s75,s75,8192
s_add_u32 s64,s75,11534336
s_add_u32 s70,s64,4096
s_add_u32 s68,s68,262144
s_add_u32 s51,s51,1
s_nop 1
v_cvt_pk_bf16_f32 v92,v92,v93
v_cvt_pk_bf16_f32 v93,v94,v95
s_add_u32 s56,s65,196608
buffer_store_dwordx2 v[92:93],v9,s[8:11],s56 offen sc1
s_xor_b32 s65,s65,262144
s_cmp_eq_u32 s51,64
s_cbranch_scc1 L_cend_163
s_cmp_lt_u32 s47,16
s_waitcnt vmcnt(2)
s_cbranch_scc1 L_cea_170
s_barrier
ds_read_b128 v[56:59],v1 offset:0
ds_read_b128 v[60:63],v1 offset:4096
ds_read_b128 v[64:67],v1 offset:1024
ds_read_b128 v[68:71],v1 offset:5120
ds_read_b128 v[72:75],v1 offset:2048
ds_read_b128 v[76:79],v1 offset:6144
ds_read_b128 v[80:83],v1 offset:3072
ds_read_b128 v[84:87],v1 offset:7168
v_add_u32 v12,s73,v1
ds_read_b128 v[88:91],v12 offset:8192
ds_read_b128 v[92:95],v12 offset:9216
v_mov_b64 v[96:97],0
v_mov_b64 v[98:99],0
v_mov_b64 v[100:101],0
v_mov_b64 v[102:103],0
v_mov_b64 v[104:105],0
v_mov_b64 v[106:107],0
v_mov_b64 v[108:109],0
v_mov_b64 v[110:111],0
v_mov_b64 v[112:113],0
v_mov_b64 v[114:115],0
v_mov_b64 v[116:117],0
v_mov_b64 v[118:119],0
v_readlane_b32 s76,v23,4
s_cmp_ge_u32 s51,63
s_cselect_b32 s76,1,s76
s_waitcnt vmcnt(0)
L_crp_165:
buffer_load_dwordx4 v[120:123],v0,s[8:11],s66 offen offset:0 sc1
buffer_load_dwordx4 v[124:127],v0,s[8:11],s66 offen offset:1024 sc1
s_sub_u32 s49,s49,1
s_cbranch_scc1 L_abort2
s_waitcnt vmcnt(1)
v_mfma_f32_16x16x32_bf16 v[28:31],v[18:21],v[120:123],0
s_waitcnt vmcnt(0)
v_mfma_f32_16x16x32_bf16 v[28:31],v[18:21],v[124:127],v[28:31]
s_nop 7
v_cmp_u_f32 vcc,v28,v28
v_add_f32_dpp v32,v28,v28 row_ror:8 row_mask:0xf bank_mask:0x3
v_add_f32_dpp v33,v29,v29 row_ror:8 row_mask:0xf bank_mask:0x3
v_add_f32_dpp v32,v30,v30 row_ror:8 row_mask:0xf bank_mask:0xc
v_add_f32_dpp v33,v31,v31 row_ror:8 row_mask:0xf bank_mask:0xc
s_nop 0
v_add_f32_dpp v32,v32,v32 row_shl:4 row_mask:0xf bank_mask:0x5
v_add_f32_dpp v33,v33,v33 row_shl:4 row_mask:0xf bank_mask:0x5
s_cbranch_vccnz L_crp_165
v_cvt_pk_bf16_f32 v34,v32,v33
buffer_store_dword v34,v10,s[8:11],s64 offen sc1
s_mov_b32 s69,s66
s_xor_b32 s66,s66,262144
buffer_load_dwordx4 v[24:27],v13,s[8:11],s64 offen sc1
s_branch L_chain_160
L_cea_170:
buffer_load_dwordx4 v[120:123],v0,s[8:11],s66 offen offset:0 sc1
buffer_load_dwordx4 v[124:127],v0,s[8:11],s66 offen offset:1024 sc1
v_mov_b64 v[96:97],0
v_mov_b64 v[98:99],0
v_mov_b64 v[100:101],0
v_mov_b64 v[102:103],0
v_mov_b64 v[104:105],0
v_mov_b64 v[106:107],0
v_mov_b64 v[108:109],0
v_mov_b64 v[110:111],0
v_mov_b64 v[112:113],0
v_mov_b64 v[114:115],0
v_mov_b64 v[116:117],0
v_mov_b64 v[118:119],0
v_readlane_b32 s76,v23,4
s_cmp_ge_u32 s51,63
s_cselect_b32 s76,1,s76
s_branch L_cr1_171
L_crb_166:
buffer_load_dwordx4 v[120:123],v0,s[8:11],s66 offen offset:0 sc1
buffer_load_dwordx4 v[124:127],v0,s[8:11],s66 offen offset:1024 sc1
L_cr1_171:
s_sub_u32 s49,s49,1
s_cbranch_scc1 L_abort2
s_waitcnt vmcnt(1)
v_mfma_f32_16x16x32_bf16 v[28:31],v[18:21],v[120:123],0
s_waitcnt vmcnt(0)
v_mfma_f32_16x16x32_bf16 v[28:31],v[18:21],v[124:127],v[28:31]
s_nop 7
v_cmp_u_f32 vcc,v28,v28
v_add_f32_dpp v32,v28,v28 row_ror:8 row_mask:0xf bank_mask:0x3
v_add_f32_dpp v33,v29,v29 row_ror:8 row_mask:0xf bank_mask:0x3
v_add_f32_dpp v32,v30,v30 row_ror:8 row_mask:0xf bank_mask:0xc
v_add_f32_dpp v33,v31,v31 row_ror:8 row_mask:0xf bank_mask:0xc
s_nop 0
v_add_f32_dpp v32,v32,v32 row_shl:4 row_mask:0xf bank_mask:0x5
v_add_f32_dpp v33,v33,v33 row_shl:4 row_mask:0xf bank_mask:0x5
s_cbranch_vccnz L_crb_166
v_cvt_pk_bf16_f32 v34,v32,v33
buffer_store_dword v34,v10,s[8:11],s64 offen sc1
s_mov_b32 s69,s66
s_xor_b32 s66,s66,262144
s_barrier
ds_read_b128 v[56:59],v1 offset:0
ds_read_b128 v[60:63],v1 offset:4096
ds_read_b128 v[64:67],v1 offset:1024
ds_read_b128 v[68:71],v1 offset:5120
buffer_load_dwordx4 v[24:27],v13,s[8:11],s64 offen sc1
ds_read_b128 v[72:75],v1 offset:2048
ds_read_b128 v[76:79],v1 offset:6144
ds_read_b128 v[80:83],v1 offset:3072
ds_read_b128 v[84:87],v1 offset:7168
v_add_u32 v12,s73,v1
ds_read_b128 v[88:91],v12 offset:8192
ds_read_b128 v[92:95],v12 offset:9216
s_branch L_chain_160
L_ckw_154:
s_lshl2_add_u32 s59,s47,s75
s_add_u32 s59,s59,10493952
L_ww_172:
buffer_load_dword v23,off,s[8:11],s59 sc1
s_sub_u32 s49,s49,1
s_cbranch_scc1 L_abort2
s_waitcnt vmcnt(0)
v_readfirstlane_b32 s76,v23
s_cmp_eq_u32 s76,0
s_cbranch_scc1 L_ww_172
L_wwd_173:
s_branch L_ckb_155
L_cpb_167:
buffer_load_dwordx4 v[40:43],v13,s[8:11],s70 offen sc1
s_waitcnt vmcnt(0)
v_max3_u32 v12,v40,v41,v42
v_max_u32 v12,v43,v12
v_cmp_le_u32 vcc,s72,v12
s_cbranch_vccz L_cback_169
s_sub_u32 s49,s49,1
s_cmp_gt_i32 s49,0
s_cbranch_scc1 L_cpb_167
s_branch L_abort2
L_cend_163:
s_waitcnt vmcnt(0)
s_barrier
s_nop 11
v_lshrrev_b32 v1,4,v0
s_branch L_ra_6
L_rc1_151:
v_and_b32 v120,15,v1
v_lshrrev_b32 v121,4,v1
v_and_b32 v122,2,v1
v_cmp_eq_u32 vcc,0,v122
v_mov_b32 v2,0xeeee
v_mov_b32 v123,0x4444
v_cndmask_b32 v2,v2,v123,vcc
v_and_b32 v122,1,v1
v_cmp_eq_u32 vcc,0,v122
v_mov_b32 v3,0xdddd
v_mov_b32 v123,0x8888
v_cndmask_b32 v3,v3,v123,vcc
v_lshrrev_b32 v122,1,v120
v_bfe_u32 v123,v120,2,1
v_xor_b32 v123,v123,v122
v_lshlrev_b32 v4,7,v123
v_and_b32 v123,1,v120
v_lshl_add_u32 v4,v123,6,v4
v_xor_b32 v123,v121,v122
v_and_b32 v123,3,v123
v_lshl_add_u32 v4,v123,4,v4
s_lshl_b32 s56,s46,10
s_add_u32 s56,s56,147456
v_add_u32 v4,s56,v4
v_lshlrev_b32 v122,1,v121
v_add_u32 v122,0,v122
v_and_b32 v123,1,v121
v_xor_b32 v123,v123,v122
v_lshlrev_b32 v5,7,v123
v_bfe_u32 v123,v120,3,1
v_lshl_add_u32 v5,v123,6,v5
v_xor_b32 v123,v120,v122
v_and_b32 v123,3,v123
v_lshl_add_u32 v5,v123,4,v5
v_bfe_u32 v123,v120,2,1
v_lshl_add_u32 v5,v123,3,v5
v_add_u32 v5,147456,v5
v_lshlrev_b32 v122,1,v121
v_add_u32 v122,1,v122
v_and_b32 v123,1,v121
v_xor_b32 v123,v123,v122
v_lshlrev_b32 v6,7,v123
v_bfe_u32 v123,v120,3,1
v_lshl_add_u32 v6,v123,6,v6
v_xor_b32 v123,v120,v122
v_and_b32 v123,3,v123
v_lshl_add_u32 v6,v123,4,v6
v_bfe_u32 v123,v120,2,1
v_lshl_add_u32 v6,v123,3,v6
v_add_u32 v6,147456,v6
v_lshlrev_b32 v7,7,v121
v_lshrrev_b32 v122,1,v120
v_lshl_add_u32 v8,v122,4,v7
v_add_u32 v8,151552,v8
v_lshrrev_b32 v122,2,v120
v_lshl_add_u32 v7,v122,5,v7
v_and_b32 v122,1,v120
v_lshl_add_u32 v7,v122,4,v7
v_and_b32 v122,2,v120
v_lshl_add_u32 v7,v122,10,v7
s_lshl_b32 s56,s46,9
s_add_u32 s56,s56,151552
v_add_u32 v7,s56,v7
v_lshrrev_b32 v122,3,v1
v_lshlrev_b32 v9,11,v122
v_and_b32 v122,7,v1
v_lshl_add_u32 v9,v122,3,v9
s_lshl_b32 s56,s46,14
s_lshl_b32 s57,s47,6
s_add_u32 s56,s56,s57
v_add_u32 v9,s56,v9
s_lshl_b32 s71,s47,2
s_add_u32 s71,s71,s46
s_bfe_u32 s56,s71,0x10003
s_lshl_b32 s56,s56,11
s_and_b32 s57,s71,1
s_lshl_b32 s57,s57,10
s_add_u32 s56,s56,s57
s_bfe_u32 s57,s71,0x10002
s_lshl_b32 s57,s57,9
s_add_u32 s56,s56,s57
s_bfe_u32 s57,s71,0x10001
s_lshl_b32 s57,s57,6
s_add_u32 s56,s56,s57
s_bfe_u32 s57,s71,0x10004
s_lshl_b32 s57,s57,8
s_add_u32 s56,s56,s57
s_bfe_u32 s57,s71,0x10005
s_lshl_b32 s57,s57,7
s_add_u32 s56,s56,s57
s_bfe_u32 s57,s71,0x10006
s_lshl_b32 s57,s57,12
s_add_u32 s56,s56,s57
v_and_b32 v122,3,v120
v_lshlrev_b32 v10,2,v122
v_bfe_u32 v122,v120,3,1
v_lshl_add_u32 v10,v122,4,v10
v_and_b32 v122,1,v121
v_lshl_add_u32 v10,v122,5,v10
v_add_u32 v10,s56,v10
v_and_b32 v123,36,v1
v_mov_b32 v122,0x80000000
v_cmp_eq_u32 vcc,0,v123
s_nop 1
v_cndmask_b32 v10,v122,v10,vcc
s_lshl_b32 s56,s46,15
v_add_u32 v11,s56,v0
s_lshl_b32 s71,s71,11
s_lshl_b32 s73,s46,11
s_mov_b32 s72,0xffc00000
s_mov_b32 s74,0
v_lshrrev_b32 v13,3,v1
v_lshlrev_b32 v13,9,v13
v_and_b32 v122,7,v1
v_lshl_add_u32 v13,v122,4,v13
v_and_b32 v122,15,v1
v_and_b32 v123,1,v1
v_lshlrev_b32 v123,4,v123
v_mov_b32 v124,0x3f80
v_lshlrev_b32 v124,v123,v124
v_lshrrev_b32 v122,1,v122
v_cmp_eq_u32 vcc,0,v122
s_nop 1
v_cndmask_b32 v18,0,v124,vcc
v_cmp_eq_u32 vcc,1,v122
s_nop 1
v_cndmask_b32 v19,0,v124,vcc
v_cmp_eq_u32 vcc,2,v122
s_nop 1
v_cndmask_b32 v20,0,v124,vcc
v_cmp_eq_u32 vcc,3,v122
s_nop 1
v_cndmask_b32 v21,0,v124,vcc
s_and_b32 s56,s46,1
s_lshl_b32 s56,s56,8
s_and_b32 s57,s46,2
s_lshl_b32 s57,s57,6
s_add_u32 s56,s56,s57
v_add_u32 v13,s56,v13
s_xor_b32 s56,s46,0
s_lshl_b32 s56,s56,10
s_add_u32 s56,s56,147456
v_add_u32 v14,s56,v0
s_xor_b32 s56,s46,1
s_lshl_b32 s56,s56,10
s_add_u32 s56,s56,147456
v_add_u32 v15,s56,v0
s_xor_b32 s56,s46,2
s_lshl_b32 s56,s56,10
s_add_u32 s56,s56,147456
v_add_u32 v16,s56,v0
s_xor_b32 s56,s46,3
s_lshl_b32 s56,s56,10
s_add_u32 s56,s56,147456
v_add_u32 v17,s56,v0
v_add_u32 v22,12599296,v10
s_lshl_b32 s56,s47,2
s_add_u32 s56,s56,10502272
v_writelane_b32 v22,s56,4
s_mov_b32 s56,10519808
v_writelane_b32 v22,s56,5
v_add_u32 v1,131072,v0
s_mov_b32 s65,15728640
s_add_u32 s66,s71,15728640
s_add_u32 s69,s71,15990784
s_lshl_b32 s79,s47,2
s_add_u32 s79,s79,10486272
s_cmp_eq_u32 s46,0
s_cselect_b32 s79,s79,0x80000000
s_cmp_eq_u32 s47,0
s_cselect_b32 s31,17825792,-1
s_and_b32 s31,s31,0x8fffffff
s_mov_b32 s51,0
L_cst_174:
s_lshl_b32 s59,s51,13
s_lshl2_add_u32 s59,s47,s59
s_add_u32 s59,s59,10485888
L_ww_179:
buffer_load_dword v120,off,s[8:11],s59 sc1
s_sub_u32 s49,s49,1
s_cbranch_scc1 L_abort2
s_waitcnt vmcnt(0)
v_readfirstlane_b32 s61,v120
s_cmp_eq_u32 s61,0
s_cbranch_scc1 L_ww_179
L_wwd_180:
s_lshl_b32 s56,s51,5
s_add_u32 s56,s56,s47
s_mul_i32 s56,s56,24576
s_add_u32 s56,s56,150994944
s_add_u32 s67,s56,s73
s_add_u32 m0,s73,131072
s_add_u32 s57,s67,8192
buffer_load_dwordx4 v0,s[8:11],s67 offen sc1 lds
buffer_load_dwordx4 v0,s[8:11],s67 offen offset:1024 sc1 lds
s_add_u32 m0,s73,139264
s_add_u32 s67,s67,786432
buffer_load_dwordx4 v0,s[8:11],s57 offen sc1 lds
buffer_load_dwordx4 v0,s[8:11],s57 offen offset:1024 sc1 lds
s_lshl_b32 s75,s51,13
s_add_u32 s64,s75,12582912
s_add_u32 s70,s64,4096
s_lshl_b32 s68,s51,5
s_add_u32 s68,s68,s47
s_lshl_b32 s68,s68,13
s_lshl_b32 s56,s46,10
s_add_u32 s68,s68,s56
s_add_u32 s68,s68,58720256
s_sub_u32 s67,s67,0
s_mov_b32 s78,0x80000000
s_cmp_eq_u32 s51,63
s_cselect_b32 s76,1,0
s_waitcnt vmcnt(0)
s_barrier
ds_read_b128 v[56:59],v1 offset:0
ds_read_b128 v[60:63],v1 offset:4096
ds_read_b128 v[64:67],v1 offset:1024
ds_read_b128 v[68:71],v1 offset:5120
ds_read_b128 v[72:75],v1 offset:2048
ds_read_b128 v[76:79],v1 offset:6144
ds_read_b128 v[80:83],v1 offset:3072
ds_read_b128 v[84:87],v1 offset:7168
v_add_u32 v12,s73,v1
ds_read_b128 v[88:91],v12 offset:8192
ds_read_b128 v[92:95],v12 offset:9216
v_mov_b64 v[96:97],0
v_mov_b64 v[98:99],0
v_mov_b64 v[100:101],0
v_mov_b64 v[102:103],0
v_mov_b64 v[104:105],0
v_mov_b64 v[106:107],0
v_mov_b64 v[108:109],0
v_mov_b64 v[110:111],0
v_mov_b64 v[112:113],0
v_mov_b64 v[114:115],0
v_mov_b64 v[116:117],0
v_mov_b64 v[118:119],0
buffer_load_dwordx4 v[24:27],v13,s[8:11],s64 offen sc1
L_chain_181:
L_cpa_182:
buffer_load_dwordx4 v[24:27],v13,s[8:11],s64 offen sc1
s_sub_u32 s49,s49,1
s_cbranch_scc1 L_abort2
s_waitcnt vmcnt(1)
v_max3_u32 v12,v24,v25,v26
v_max_u32 v12,v27,v12
v_cmp_le_u32 vcc,s72,v12
s_cbranch_vccnz L_cpa_182
L_cgo_185:
ds_write_b128 v14,v[24:27] offset:0
buffer_load_dwordx4 v[40:43],v13,s[8:11],s70 offen sc1
v_smfmac_f32_16x16x64_bf16 v[96:99],v[24:27],a[0:7],v2
s_add_u32 m0,s73,131072
v_smfmac_f32_16x16x64_bf16 v[100:103],v[24:27],a[128:135],v2
s_add_u32 s57,s67,8192
v_smfmac_f32_16x16x64_bf16 v[104:107],v[24:27],a[8:15],v2
s_add_u32 s30,s31,s75
v_smfmac_f32_16x16x64_bf16 v[108:111],v[24:27],a[136:143],v2
s_add_u32 s58,s30,4096
s_waitcnt lgkmcnt(0)
s_barrier
ds_read_b128 v[28:31],v15 offset:0
ds_read_b128 v[32:35],v16 offset:0
ds_read_b128 v[36:39],v17 offset:0
v_smfmac_f32_16x16x64_bf16 v[112:115],v[24:27],v[128:135],v2
v_smfmac_f32_16x16x64_bf16 v[116:119],v[24:27],v[136:143],v2
s_waitcnt lgkmcnt(2)
v_smfmac_f32_16x16x64_bf16 v[96:99],v[28:31],a[16:23],v2
s_lshl_b32 s56,s46,10
v_smfmac_f32_16x16x64_bf16 v[100:103],v[28:31],a[144:151],v2
v_smfmac_f32_16x16x64_bf16 v[104:107],v[28:31],a[24:31],v2
v_smfmac_f32_16x16x64_bf16 v[108:111],v[28:31],a[152:159],v2
s_waitcnt lgkmcnt(1) vmcnt(0)
v_smfmac_f32_16x16x64_bf16 v[96:99],v[32:35],a[32:39],v2
v_max3_u32 v12,v40,v41,v42
v_smfmac_f32_16x16x64_bf16 v[100:103],v[32:35],a[160:167],v2
v_max_u32 v12,v43,v12
v_smfmac_f32_16x16x64_bf16 v[104:107],v[32:35],a[40:47],v2
v_cmp_le_u32 vcc,s72,v12
v_smfmac_f32_16x16x64_bf16 v[108:111],v[32:35],a[168:175],v2
s_cbranch_vccnz L_cpb_188
L_cback_190:
s_waitcnt lgkmcnt(0)
ds_write_b128 v14,v[40:43] offset:4096
v_smfmac_f32_16x16x64_bf16 v[96:99],v[36:39],a[48:55],v2
v_mov_b64 v[120:121],-1
v_smfmac_f32_16x16x64_bf16 v[100:103],v[36:39],a[176:183],v2
v_mov_b64 v[122:123],-1
v_smfmac_f32_16x16x64_bf16 v[104:107],v[36:39],a[56:63],v2
v_add_u32 v124,s56,v5
v_smfmac_f32_16x16x64_bf16 v[108:111],v[36:39],a[184:191],v2
v_add_u32 v126,s56,v6
s_waitcnt lgkmcnt(0)
s_barrier
v_smfmac_f32_16x16x64_bf16 v[96:99],v[40:43],a[64:71],v2
ds_read_b128 v[44:47],v15 offset:4096
v_smfmac_f32_16x16x64_bf16 v[100:103],v[40:43],a[192:199],v2
ds_read_b128 v[48:51],v16 offset:4096
v_smfmac_f32_16x16x64_bf16 v[104:107],v[40:43],a[72:79],v2
ds_read_b128 v[52:55],v17 offset:4096
v_smfmac_f32_16x16x64_bf16 v[108:111],v[40:43],a[200:207],v2
s_cmp_eq_u32 s76,0
s_cbranch_scc1 L_ckw_175
L_ckb_176:
s_waitcnt lgkmcnt(2)
v_smfmac_f32_16x16x64_bf16 v[96:99],v[44:47],a[80:87],v2
buffer_load_dwordx4 v0,s[8:11],s67 offen sc1 lds
v_smfmac_f32_16x16x64_bf16 v[100:103],v[44:47],a[208:215],v2
buffer_load_dwordx4 v0,s[8:11],s67 offen offset:1024 sc1 lds
v_smfmac_f32_16x16x64_bf16 v[104:107],v[44:47],a[88:95],v2
s_add_u32 m0,s73,139264
v_smfmac_f32_16x16x64_bf16 v[108:111],v[44:47],a[216:223],v2
s_waitcnt lgkmcnt(1)
v_smfmac_f32_16x16x64_bf16 v[96:99],v[48:51],a[96:103],v2
s_add_u32 s67,s67,786432
v_smfmac_f32_16x16x64_bf16 v[100:103],v[48:51],a[224:231],v2
buffer_load_dwordx4 v0,s[8:11],s57 offen sc1 lds
v_smfmac_f32_16x16x64_bf16 v[104:107],v[48:51],a[104:111],v2
buffer_load_dwordx4 v0,s[8:11],s57 offen offset:1024 sc1 lds
v_smfmac_f32_16x16x64_bf16 v[108:111],v[48:51],a[232:239],v2
s_waitcnt lgkmcnt(0)
v_smfmac_f32_16x16x64_bf16 v[96:99],v[52:55],a[112:119],v2
buffer_load_dword v23,v22,s[8:11],s75 offen sc1
v_smfmac_f32_16x16x64_bf16 v[100:103],v[52:55],a[240:247],v2
buffer_store_dword v2,off,s[8:11],s78 sc1
v_smfmac_f32_16x16x64_bf16 v[104:107],v[52:55],a[120:127],v2
buffer_store_dwordx4 v[120:123],v0,s[8:11],s69 offen sc1
v_smfmac_f32_16x16x64_bf16 v[108:111],v[52:55],a[248:255],v2
buffer_store_dwordx4 v[120:123],v0,s[8:11],s69 offen offset:1024 sc1
buffer_store_dwordx4 v[24:27],v13,s[8:11],s30 offen sc1
buffer_store_dwordx4 v[40:43],v13,s[8:11],s58 offen sc1
v_smfmac_f32_16x16x64_bf16 v[112:115],v[28:31],v[144:151],v2
v_smfmac_f32_16x16x64_bf16 v[116:119],v[28:31],v[152:159],v2
v_pk_add_f32 v[96:97],v[96:97],v[98:99]
v_pk_add_f32 v[100:101],v[100:101],v[102:103]
v_cvt_pk_bf16_f32 v120,v96,v97
v_cvt_pk_bf16_f32 v121,v100,v101
v_pk_add_f32 v[104:105],v[104:105],v[106:107]
v_pk_add_f32 v[108:109],v[108:109],v[110:111]
v_cvt_pk_bf16_f32 v122,v104,v105
v_cvt_pk_bf16_f32 v123,v108,v109
ds_write_b128 v4,v[120:123]
v_smfmac_f32_16x16x64_bf16 v[112:115],v[32:35],v[160:167],v2
v_smfmac_f32_16x16x64_bf16 v[116:119],v[32:35],v[168:175],v2
v_smfmac_f32_16x16x64_bf16 v[112:115],v[36:39],v[176:183],v2
v_smfmac_f32_16x16x64_bf16 v[116:119],v[36:39],v[184:191],v2
s_waitcnt lgkmcnt(0)
s_barrier
ds_read_b64_tr_b16 v[96:97],v5 offset:0
ds_read_b64_tr_b16 v[98:99],v6 offset:0
ds_read_b64_tr_b16 v[100:101],v5 offset:1024
ds_read_b64_tr_b16 v[102:103],v6 offset:1024
ds_read_b64_tr_b16 v[104:105],v5 offset:2048
ds_read_b64_tr_b16 v[106:107],v6 offset:2048
ds_read_b64_tr_b16 v[108:109],v5 offset:3072
ds_read_b64_tr_b16 v[110:111],v6 offset:3072
ds_read_b64_tr_b16 v[124:125],v124
ds_read_b64_tr_b16 v[126:127],v126
v_smfmac_f32_16x16x64_bf16 v[112:115],v[40:43],v[192:199],v2
v_smfmac_f32_16x16x64_bf16 v[116:119],v[40:43],v[200:207],v2
s_waitcnt lgkmcnt(8)
v_mfma_f32_16x16x32_bf16 v[24:27],v[56:59],v[96:99],0
v_mfma_f32_16x16x32_bf16 v[28:31],v[60:63],v[96:99],0
v_mfma_f32_16x16x32_bf16 v[32:35],v[96:99],v[96:99],0
s_waitcnt lgkmcnt(6)
v_mfma_f32_16x16x32_bf16 v[24:27],v[64:67],v[100:103],v[24:27]
ds_read_b128 v[56:59],v11 offset:0
v_mfma_f32_16x16x32_bf16 v[28:31],v[68:71],v[100:103],v[28:31]
ds_read_b128 v[60:63],v11 offset:1024
v_mfma_f32_16x16x32_bf16 v[32:35],v[100:103],v[100:103],v[32:35]
s_waitcnt lgkmcnt(6)
v_mfma_f32_16x16x32_bf16 v[24:27],v[72:75],v[104:107],v[24:27]
ds_read_b128 v[64:67],v11 offset:2048
v_mfma_f32_16x16x32_bf16 v[28:31],v[76:79],v[104:107],v[28:31]
ds_read_b128 v[68:71],v11 offset:3072
v_mfma_f32_16x16x32_bf16 v[32:35],v[104:107],v[104:107],v[32:35]
s_waitcnt lgkmcnt(6)
v_mfma_f32_16x16x32_bf16 v[24:27],v[80:83],v[108:111],v[24:27]
ds_read_b128 v[72:75],v11 offset:4096
v_mfma_f32_16x16x32_bf16 v[28:31],v[84:87],v[108:111],v[28:31]
ds_read_b128 v[76:79],v11 offset:5120
v_mfma_f32_16x16x32_bf16 v[32:35],v[108:111],v[108:111],v[32:35]
s_waitcnt lgkmcnt(6)
v_smfmac_f32_16x16x64_bf16 v[112:115],v[44:47],v[208:215],v2
buffer_store_dwordx4 v[124:127],v0,s[8:11],s68 offen sc1
v_smfmac_f32_16x16x64_bf16 v[116:119],v[44:47],v[216:223],v2
v_smfmac_f32_16x16x64_bf16 v[112:115],v[48:51],v[224:231],v2
v_smfmac_f32_16x16x64_bf16 v[116:119],v[48:51],v[232:239],v2
v_smfmac_f32_16x16x64_bf16 v[112:115],v[52:55],v[240:247],v2
v_smfmac_f32_16x16x64_bf16 v[116:119],v[52:55],v[248:255],v2
v_mov_b32 v125,0
v_mov_b64 v[52:53],s[28:29]
v_mov_b64 v[54:55],s[28:29]
v_max3_f32 v36,v24,v25,v26
v_max3_f32 v37,v27,v28,v29
v_max3_f32 v36,v30,v31,v36
v_max3_f32 v37,v34,v35,v37
v_max_f32 v36,v36,v37
v_max_f32 v37,v36,v37
ds_read_b128 v[80:83],v11 offset:6144
s_nop 0
v_permlane16_swap_b32 v36,v37
v_max_f32 v36,v36,v37
v_max_f32 v37,v36,v37
ds_read_b128 v[84:87],v11 offset:7168
s_nop 0
v_permlane32_swap_b32 v36,v37
v_max_f32 v36,v36,v37
v_mul_f32 v36,s80,v36
v_fma_f32 v24,v24,s80,-v36
v_fma_f32 v25,v25,s80,-v36
v_exp_f32 v24,v24
v_fma_f32 v26,v26,s80,-v36
v_exp_f32 v25,v25
v_fma_f32 v27,v27,s80,-v36
v_exp_f32 v26,v26
v_fma_f32 v28,v28,s80,-v36
v_exp_f32 v27,v27
v_fma_f32 v29,v29,s80,-v36
v_exp_f32 v28,v28
v_fma_f32 v30,v30,s80,-v36
v_exp_f32 v29,v29
v_fma_f32 v31,v31,s80,-v36
v_exp_f32 v30,v30
v_fma_f32 v34,v34,s80,-v36
v_exp_f32 v31,v31
v_fma_f32 v35,v35,s80,-v36
v_exp_f32 v34,v34
v_exp_f32 v35,v35
v_cvt_pk_bf16_f32 v120,v24,v25
v_cvt_pk_bf16_f32 v121,v26,v27
v_cvt_pk_bf16_f32 v122,v28,v29
v_cvt_pk_bf16_f32 v123,v30,v31
v_cvt_pk_bf16_f32 v124,v34,v35
s_nop 0
v_mfma_f32_16x16x32_bf16 v[32:35],v[52:55],v[120:123],0
v_pk_add_f32 v[112:113],v[112:113],v[114:115]
v_pk_add_f32 v[116:117],v[116:117],v[118:119]
v_mfma_f32_16x16x32_bf16 v[24:27],v[88:91],v[120:123],0
v_cvt_pk_bf16_f32 v36,v112,v113
v_cvt_pk_bf16_f32 v37,v116,v117
v_mfma_f32_16x16x32_bf16 v[28:31],v[92:95],v[120:123],0
v_cvt_pk_bf16_f32 v38,v116,v117
v_mov_b32 v39,0
v_mfma_f32_16x16x16_bf16 v[32:35],v[52:53],v[124:125],v[32:35]
s_add_u32 s56,s68,4096
buffer_store_dwordx4 v[36:39],v0,s[8:11],s56 offen sc1
v_mfma_f32_16x16x16_bf16 v[24:27],v[36:37],v[124:125],v[24:27]
ds_read_b128 v[96:99],v11 offset:8192
v_mfma_f32_16x16x16_bf16 v[28:31],v[38:39],v[124:125],v[28:31]
ds_read_b128 v[100:103],v11 offset:9216
v_rcp_f32 v32,v32
v_mov_b64 v[112:113],0
v_mov_b64 v[114:115],0
v_pk_mul_f32 v[24:25],v[24:25],v[32:33] op_sel_hi:[1,0]
v_pk_mul_f32 v[26:27],v[26:27],v[32:33] op_sel_hi:[1,0]
v_mov_b64 v[116:117],0
v_mov_b64 v[118:119],0
v_pk_mul_f32 v[28:29],v[28:29],v[32:33] op_sel_hi:[1,0]
v_pk_mul_f32 v[30:31],v[30:31],v[32:33] op_sel_hi:[1,0]
v_cvt_pk_bf16_f32 v120,v24,v28
v_cvt_pk_bf16_f32 v121,v25,v29
v_cvt_pk_bf16_f32 v122,v26,v30
v_cvt_pk_bf16_f32 v123,v27,v31
ds_write_b128 v7,v[120:123]
ds_read_b128 v[104:107],v11 offset:10240
ds_read_b128 v[108:111],v11 offset:11264
ds_read_b128 v[40:43],v11 offset:12288
ds_read_b128 v[44:47],v11 offset:13312
s_waitcnt lgkmcnt(4)
s_barrier
ds_read_b128 v[24:27],v8 offset:0
ds_read_b128 v[28:31],v8 offset:512
ds_read_b128 v[32:35],v8 offset:1024
ds_read_b128 v[36:39],v8 offset:1536
ds_read_b128 v[48:51],v11 offset:14336
ds_read_b128 v[52:55],v11 offset:15360
v_mov_b64 v[88:89],0
v_mov_b64 v[90:91],0
v_mov_b64 v[92:93],0
v_mov_b64 v[94:95],0
s_waitcnt lgkmcnt(5)
v_smfmac_f32_16x16x64_bf16 v[112:115],v[24:27],v[56:63],v3
ds_read_b128 v[56:59],v11 offset:16384
ds_read_b128 v[60:63],v11 offset:17408
s_waitcnt lgkmcnt(6)
v_smfmac_f32_16x16x64_bf16 v[112:115],v[28:31],v[64:71],v3
ds_read_b128 v[64:67],v11 offset:18432
ds_read_b128 v[68:71],v11 offset:19456
s_waitcnt lgkmcnt(7)
v_smfmac_f32_16x16x64_bf16 v[112:115],v[32:35],v[72:79],v3
ds_read_b128 v[72:75],v11 offset:20480
ds_read_b128 v[76:79],v11 offset:21504
s_waitcnt lgkmcnt(8)
v_smfmac_f32_16x16x64_bf16 v[112:115],v[36:39],v[80:87],v3
ds_read_b128 v[80:83],v11 offset:22528
ds_read_b128 v[84:87],v11 offset:23552
s_waitcnt lgkmcnt(8)
v_smfmac_f32_16x16x64_bf16 v[116:119],v[24:27],v[96:103],v3
ds_read_b128 v[96:99],v11 offset:24576
ds_read_b128 v[100:103],v11 offset:25600
v_smfmac_f32_16x16x64_bf16 v[116:119],v[28:31],v[104:111],v3
v_cvt_pk_bf16_f32 v112,v112,v113
v_cvt_pk_bf16_f32 v113,v114,v115
buffer_store_dwordx2 v[112:113],v9,s[8:11],s65 offen sc1
ds_read_b128 v[104:107],v11 offset:26624
ds_read_b128 v[108:111],v11 offset:27648
v_smfmac_f32_16x16x64_bf16 v[116:119],v[32:35],v[40:47],v3
ds_read_b128 v[40:43],v11 offset:28672
ds_read_b128 v[44:47],v11 offset:29696
v_smfmac_f32_16x16x64_bf16 v[116:119],v[36:39],v[48:55],v3
s_waitcnt lgkmcnt(12)
ds_read_b128 v[48:51],v11 offset:30720
ds_read_b128 v[52:55],v11 offset:31744
s_waitcnt lgkmcnt(14)
v_smfmac_f32_16x16x64_bf16 v[88:91],v[24:27],v[56:63],v3
s_nop 2
v_cvt_pk_bf16_f32 v116,v116,v117
v_cvt_pk_bf16_f32 v117,v118,v119
s_add_u32 s56,s65,65536
buffer_store_dwordx2 v[116:117],v9,s[8:11],s56 offen sc1
s_waitcnt lgkmcnt(12)
v_smfmac_f32_16x16x64_bf16 v[88:91],v[28:31],v[64:71],v3
s_waitcnt lgkmcnt(10)
v_smfmac_f32_16x16x64_bf16 v[88:91],v[32:35],v[72:79],v3
s_waitcnt lgkmcnt(8)
v_smfmac_f32_16x16x64_bf16 v[88:91],v[36:39],v[80:87],v3
s_waitcnt lgkmcnt(6)
v_smfmac_f32_16x16x64_bf16 v[92:95],v[24:27],v[96:103],v3
s_waitcnt lgkmcnt(4)
v_smfmac_f32_16x16x64_bf16 v[92:95],v[28:31],v[104:111],v3
v_cvt_pk_bf16_f32 v88,v88,v89
v_cvt_pk_bf16_f32 v89,v90,v91
s_add_u32 s56,s65,131072
buffer_store_dwordx2 v[88:89],v9,s[8:11],s56 offen sc1
s_waitcnt lgkmcnt(2)
v_smfmac_f32_16x16x64_bf16 v[92:95],v[32:35],v[40:47],v3
s_waitcnt lgkmcnt(0)
v_smfmac_f32_16x16x64_bf16 v[92:95],v[36:39],v[48:55],v3
s_add_u32 s78,s79,s75
s_add_u32 s75,s75,8192
s_add_u32 s64,s75,12582912
s_add_u32 s70,s64,4096
s_add_u32 s68,s68,262144
s_add_u32 s51,s51,1
s_nop 1
v_cvt_pk_bf16_f32 v92,v92,v93
v_cvt_pk_bf16_f32 v93,v94,v95
s_add_u32 s56,s65,196608
buffer_store_dwordx2 v[92:93],v9,s[8:11],s56 offen sc1
s_xor_b32 s65,s65,262144
s_cmp_eq_u32 s51,64
s_cbranch_scc1 L_cend_184
s_cmp_lt_u32 s47,16
s_waitcnt vmcnt(2)
s_cbranch_scc1 L_cea_191
s_barrier
ds_read_b128 v[56:59],v1 offset:0
ds_read_b128 v[60:63],v1 offset:4096
ds_read_b128 v[64:67],v1 offset:1024
ds_read_b128 v[68:71],v1 offset:5120
ds_read_b128 v[72:75],v1 offset:2048
ds_read_b128 v[76:79],v1 offset:6144
ds_read_b128 v[80:83],v1 offset:3072
ds_read_b128 v[84:87],v1 offset:7168
v_add_u32 v12,s73,v1
ds_read_b128 v[88:91],v12 offset:8192
ds_read_b128 v[92:95],v12 offset:9216
v_mov_b64 v[96:97],0
v_mov_b64 v[98:99],0
v_mov_b64 v[100:101],0
v_mov_b64 v[102:103],0
v_mov_b64 v[104:105],0
v_mov_b64 v[106:107],0
v_mov_b64 v[108:109],0
v_mov_b64 v[110:111],0
v_mov_b64 v[112:113],0
v_mov_b64 v[114:115],0
v_mov_b64 v[116:117],0
v_mov_b64 v[118:119],0
v_readlane_b32 s76,v23,4
s_cmp_ge_u32 s51,63
s_cselect_b32 s76,1,s76
s_waitcnt vmcnt(0)
L_crp_186:
buffer_load_dwordx4 v[120:123],v0,s[8:11],s66 offen offset:0 sc1
buffer_load_dwordx4 v[124:127],v0,s[8:11],s66 offen offset:1024 sc1
s_sub_u32 s49,s49,1
s_cbranch_scc1 L_abort2
s_waitcnt vmcnt(1)
v_mfma_f32_16x16x32_bf16 v[28:31],v[18:21],v[120:123],0
s_waitcnt vmcnt(0)
v_mfma_f32_16x16x32_bf16 v[28:31],v[18:21],v[124:127],v[28:31]
s_nop 7
v_cmp_u_f32 vcc,v28,v28
v_add_f32_dpp v32,v28,v28 row_ror:8 row_mask:0xf bank_mask:0x3
v_add_f32_dpp v33,v29,v29 row_ror:8 row_mask:0xf bank_mask:0x3
v_add_f32_dpp v32,v30,v30 row_ror:8 row_mask:0xf bank_mask:0xc
v_add_f32_dpp v33,v31,v31 row_ror:8 row_mask:0xf bank_mask:0xc
s_nop 0
v_add_f32_dpp v32,v32,v32 row_shl:4 row_mask:0xf bank_mask:0x5
v_add_f32_dpp v33,v33,v33 row_shl:4 row_mask:0xf bank_mask:0x5
s_cbranch_vccnz L_crp_186
v_cvt_pk_bf16_f32 v34,v32,v33
buffer_store_dword v34,v10,s[8:11],s64 offen sc1
s_mov_b32 s69,s66
s_xor_b32 s66,s66,262144
buffer_load_dwordx4 v[24:27],v13,s[8:11],s64 offen sc1
s_branch L_chain_181
L_cea_191:
buffer_load_dwordx4 v[120:123],v0,s[8:11],s66 offen offset:0 sc1
buffer_load_dwordx4 v[124:127],v0,s[8:11],s66 offen offset:1024 sc1
v_mov_b64 v[96:97],0
v_mov_b64 v[98:99],0
v_mov_b64 v[100:101],0
v_mov_b64 v[102:103],0
v_mov_b64 v[104:105],0
v_mov_b64 v[106:107],0
v_mov_b64 v[108:109],0
v_mov_b64 v[110:111],0
v_mov_b64 v[112:113],0
v_mov_b64 v[114:115],0
v_mov_b64 v[116:117],0
v_mov_b64 v[118:119],0
v_readlane_b32 s76,v23,4
s_cmp_ge_u32 s51,63
s_cselect_b32 s76,1,s76
s_branch L_cr1_192
L_crb_187:
buffer_load_dwordx4 v[120:123],v0,s[8:11],s66 offen offset:0 sc1
buffer_load_dwordx4 v[124:127],v0,s[8:11],s66 offen offset:1024 sc1
L_cr1_192:
s_sub_u32 s49,s49,1
s_cbranch_scc1 L_abort2
s_waitcnt vmcnt(1)
v_mfma_f32_16x16x32_bf16 v[28:31],v[18:21],v[120:123],0
s_waitcnt vmcnt(0)
v_mfma_f32_16x16x32_bf16 v[28:31],v[18:21],v[124:127],v[28:31]
s_nop 7
v_cmp_u_f32 vcc,v28,v28
v_add_f32_dpp v32,v28,v28 row_ror:8 row_mask:0xf bank_mask:0x3
v_add_f32_dpp v33,v29,v29 row_ror:8 row_mask:0xf bank_mask:0x3
v_add_f32_dpp v32,v30,v30 row_ror:8 row_mask:0xf bank_mask:0xc
v_add_f32_dpp v33,v31,v31 row_ror:8 row_mask:0xf bank_mask:0xc
s_nop 0
v_add_f32_dpp v32,v32,v32 row_shl:4 row_mask:0xf bank_mask:0x5
v_add_f32_dpp v33,v33,v33 row_shl:4 row_mask:0xf bank_mask:0x5
s_cbranch_vccnz L_crb_187
v_cvt_pk_bf16_f32 v34,v32,v33
buffer_store_dword v34,v10,s[8:11],s64 offen sc1
s_mov_b32 s69,s66
s_xor_b32 s66,s66,262144
s_barrier
ds_read_b128 v[56:59],v1 offset:0
ds_read_b128 v[60:63],v1 offset:4096
ds_read_b128 v[64:67],v1 offset:1024
ds_read_b128 v[68:71],v1 offset:5120
buffer_load_dwordx4 v[24:27],v13,s[8:11],s64 offen sc1
ds_read_b128 v[72:75],v1 offset:2048
ds_read_b128 v[76:79],v1 offset:6144
ds_read_b128 v[80:83],v1 offset:3072
ds_read_b128 v[84:87],v1 offset:7168
v_add_u32 v12,s73,v1
ds_read_b128 v[88:91],v12 offset:8192
ds_read_b128 v[92:95],v12 offset:9216
s_branch L_chain_181
L_ckw_175:
s_lshl2_add_u32 s59,s47,s75
s_add_u32 s59,s59,10494080
L_ww_193:
buffer_load_dword v23,off,s[8:11],s59 sc1
s_sub_u32 s49,s49,1
s_cbranch_scc1 L_abort2
s_waitcnt vmcnt(0)
v_readfirstlane_b32 s76,v23
s_cmp_eq_u32 s76,0
s_cbranch_scc1 L_ww_193
L_wwd_194:
s_branch L_ckb_176
L_cpb_188:
buffer_load_dwordx4 v[40:43],v13,s[8:11],s70 offen sc1
s_waitcnt vmcnt(0)
v_max3_u32 v12,v40,v41,v42
v_max_u32 v12,v43,v12
v_cmp_le_u32 vcc,s72,v12
s_cbranch_vccz L_cback_190
s_sub_u32 s49,s49,1
s_cmp_gt_i32 s49,0
s_cbranch_scc1 L_cpb_188
s_branch L_abort2
L_cend_184:
s_waitcnt vmcnt(0)
s_barrier
buffer_store_dword v2,off,s[8:11],s78 sc1
s_nop 11
v_lshrrev_b32 v1,4,v0
s_endpgm
L_rc2_152:
v_and_b32 v120,15,v1
v_lshrrev_b32 v121,4,v1
v_and_b32 v122,2,v1
v_cmp_eq_u32 vcc,0,v122
v_mov_b32 v2,0xeeee
v_mov_b32 v123,0x4444
v_cndmask_b32 v2,v2,v123,vcc
v_and_b32 v122,1,v1
v_cmp_eq_u32 vcc,0,v122
v_mov_b32 v3,0xdddd
v_mov_b32 v123,0x8888
v_cndmask_b32 v3,v3,v123,vcc
v_lshrrev_b32 v122,1,v120
v_bfe_u32 v123,v120,2,1
v_xor_b32 v123,v123,v122
v_lshlrev_b32 v4,7,v123
v_and_b32 v123,1,v120
v_lshl_add_u32 v4,v123,6,v4
v_xor_b32 v123,v121,v122
v_and_b32 v123,3,v123
v_lshl_add_u32 v4,v123,4,v4
s_lshl_b32 s56,s46,10
s_add_u32 s56,s56,147456
v_add_u32 v4,s56,v4
v_lshlrev_b32 v122,1,v121
v_add_u32 v122,0,v122
v_and_b32 v123,1,v121
v_xor_b32 v123,v123,v122
v_lshlrev_b32 v5,7,v123
v_bfe_u32 v123,v120,3,1
v_lshl_add_u32 v5,v123,6,v5
v_xor_b32 v123,v120,v122
v_and_b32 v123,3,v123
v_lshl_add_u32 v5,v123,4,v5
v_bfe_u32 v123,v120,2,1
v_lshl_add_u32 v5,v123,3,v5
v_add_u32 v5,147456,v5
v_lshlrev_b32 v122,1,v121
v_add_u32 v122,1,v122
v_and_b32 v123,1,v121
v_xor_b32 v123,v123,v122
v_lshlrev_b32 v6,7,v123
v_bfe_u32 v123,v120,3,1
v_lshl_add_u32 v6,v123,6,v6
v_xor_b32 v123,v120,v122
v_and_b32 v123,3,v123
v_lshl_add_u32 v6,v123,4,v6
v_bfe_u32 v123,v120,2,1
v_lshl_add_u32 v6,v123,3,v6
v_add_u32 v6,147456,v6
v_lshlrev_b32 v7,7,v121
v_lshrrev_b32 v122,1,v120
v_lshl_add_u32 v8,v122,4,v7
v_add_u32 v8,151552,v8
v_lshrrev_b32 v122,2,v120
v_lshl_add_u32 v7,v122,5,v7
v_and_b32 v122,1,v120
v_lshl_add_u32 v7,v122,4,v7
v_and_b32 v122,2,v120
v_lshl_add_u32 v7,v122,10,v7
s_lshl_b32 s56,s46,9
s_add_u32 s56,s56,151552
v_add_u32 v7,s56,v7
v_lshrrev_b32 v122,3,v1
v_lshlrev_b32 v9,11,v122
v_and_b32 v122,7,v1
v_lshl_add_u32 v9,v122,3,v9
s_lshl_b32 s56,s46,14
s_lshl_b32 s57,s47,6
s_add_u32 s56,s56,s57
v_add_u32 v9,s56,v9
s_lshl_b32 s71,s47,2
s_add_u32 s71,s71,s46
s_bfe_u32 s56,s71,0x10003
s_lshl_b32 s56,s56,11
s_and_b32 s57,s71,1
s_lshl_b32 s57,s57,10
s_add_u32 s56,s56,s57
s_bfe_u32 s57,s71,0x10002
s_lshl_b32 s57,s57,9
s_add_u32 s56,s56,s57
s_bfe_u32 s57,s71,0x10001
s_lshl_b32 s57,s57,6
s_add_u32 s56,s56,s57
s_bfe_u32 s57,s71,0x10004
s_lshl_b32 s57,s57,8
s_add_u32 s56,s56,s57
s_bfe_u32 s57,s71,0x10005
s_lshl_b32 s57,s57,7
s_add_u32 s56,s56,s57
s_bfe_u32 s57,s71,0x10006
s_lshl_b32 s57,s57,12
s_add_u32 s56,s56,s57
v_and_b32 v122,3,v120
v_lshlrev_b32 v10,2,v122
v_bfe_u32 v122,v120,3,1
v_lshl_add_u32 v10,v122,4,v10
v_and_b32 v122,1,v121
v_lshl_add_u32 v10,v122,5,v10
v_add_u32 v10,s56,v10
v_and_b32 v123,36,v1
v_mov_b32 v122,0x80000000
v_cmp_eq_u32 vcc,0,v123
s_nop 1
v_cndmask_b32 v10,v122,v10,vcc
s_lshl_b32 s56,s46,15
v_add_u32 v11,s56,v0
s_lshl_b32 s71,s71,11
s_lshl_b32 s73,s46,11
s_mov_b32 s72,0xffc00000
s_mov_b32 s74,0
v_lshrrev_b32 v13,3,v1
v_lshlrev_b32 v13,9,v13
v_and_b32 v122,7,v1
v_lshl_add_u32 v13,v122,4,v13
v_and_b32 v122,15,v1
v_and_b32 v123,1,v1
v_lshlrev_b32 v123,4,v123
v_mov_b32 v124,0x3f80
v_lshlrev_b32 v124,v123,v124
v_lshrrev_b32 v122,1,v122
v_cmp_eq_u32 vcc,0,v122
s_nop 1
v_cndmask_b32 v18,0,v124,vcc
v_cmp_eq_u32 vcc,1,v122
s_nop 1
v_cndmask_b32 v19,0,v124,vcc
v_cmp_eq_u32 vcc,2,v122
s_nop 1
v_cndmask_b32 v20,0,v124,vcc
v_cmp_eq_u32 vcc,3,v122
s_nop 1
v_cndmask_b32 v21,0,v124,vcc
s_and_b32 s56,s46,1
s_lshl_b32 s56,s56,8
s_and_b32 s57,s46,2
s_lshl_b32 s57,s57,6
s_add_u32 s56,s56,s57
v_add_u32 v13,s56,v13
s_xor_b32 s56,s46,0
s_lshl_b32 s56,s56,10
s_add_u32 s56,s56,147456
v_add_u32 v14,s56,v0
s_xor_b32 s56,s46,1
s_lshl_b32 s56,s56,10
s_add_u32 s56,s56,147456
v_add_u32 v15,s56,v0
s_xor_b32 s56,s46,2
s_lshl_b32 s56,s56,10
s_add_u32 s56,s56,147456
v_add_u32 v16,s56,v0
s_xor_b32 s56,s46,3
s_lshl_b32 s56,s56,10
s_add_u32 s56,s56,147456
v_add_u32 v17,s56,v0
v_add_u32 v22,13647872,v10
s_lshl_b32 s56,s47,2
s_add_u32 s56,s56,10502272
v_writelane_b32 v22,s56,4
s_mov_b32 s56,10519808
v_writelane_b32 v22,s56,5
v_add_u32 v1,131072,v0
s_mov_b32 s65,16777216
s_add_u32 s66,s71,16777216
s_add_u32 s69,s71,17039360
s_lshl_b32 s79,s47,2
s_add_u32 s79,s79,10486400
s_cmp_eq_u32 s46,0
s_cselect_b32 s79,s79,0x80000000
s_cmp_eq_u32 s47,0
s_cselect_b32 s31,17825792,-1
s_and_b32 s31,s31,0x8fffffff
s_mov_b32 s51,0
L_cst_195:
s_mov_b32 s60,s51
L_csc_200:
s_add_u32 s60,s60,1
s_add_u32 s61,s51,3
s_min_u32 s61,s61,63
s_cmp_gt_u32 s60,s61
s_cbranch_scc1 L_csd_201
s_lshl_b32 s59,s60,13
s_add_u32 s59,s59,10487040
L_ww_202:
buffer_load_dword v120,off,s[8:11],s59 sc1
s_sub_u32 s49,s49,1
s_cbranch_scc1 L_abort2
s_waitcnt vmcnt(0)
v_readfirstlane_b32 s61,v120
s_cmp_eq_u32 s61,0
s_cbranch_scc1 L_ww_202
L_wwd_203:
s_cmp_eq_u32 s61,2
s_cselect_b32 s51,s60,s51
s_branch L_csc_200
L_csd_201:
s_lshl_b32 s59,s51,13
s_lshl2_add_u32 s59,s47,s59
s_add_u32 s59,s59,10486016
L_ww_204:
buffer_load_dword v120,off,s[8:11],s59 sc1
s_sub_u32 s49,s49,1
s_cbranch_scc1 L_abort2
s_waitcnt vmcnt(0)
v_readfirstlane_b32 s61,v120
s_cmp_eq_u32 s61,0
s_cbranch_scc1 L_ww_204
L_wwd_205:
s_lshl_b32 s56,s51,5
s_add_u32 s56,s56,s47
s_mul_i32 s56,s56,24576
s_add_u32 s56,s56,201326592
s_add_u32 s67,s56,s73
s_add_u32 m0,s73,131072
s_add_u32 s57,s67,8192
buffer_load_dwordx4 v0,s[8:11],s67 offen sc1 lds
buffer_load_dwordx4 v0,s[8:11],s67 offen offset:1024 sc1 lds
s_add_u32 m0,s73,139264
s_add_u32 s67,s67,786432
buffer_load_dwordx4 v0,s[8:11],s57 offen sc1 lds
buffer_load_dwordx4 v0,s[8:11],s57 offen offset:1024 sc1 lds
s_lshl_b32 s75,s51,13
s_add_u32 s64,s75,17825792
s_add_u32 s70,s64,4096
s_lshl_b32 s68,s51,5
s_add_u32 s68,s68,s47
s_lshl_b32 s68,s68,13
s_lshl_b32 s56,s46,10
s_add_u32 s68,s68,s56
s_add_u32 s68,s68,75497472
s_sub_u32 s67,s67,50331648
s_mov_b32 s78,0x80000000
s_cmp_eq_u32 s51,63
s_cselect_b32 s76,1,0
s_waitcnt vmcnt(0)
s_barrier
ds_read_b128 v[56:59],v1 offset:0
ds_read_b128 v[60:63],v1 offset:4096
ds_read_b128 v[64:67],v1 offset:1024
ds_read_b128 v[68:71],v1 offset:5120
ds_read_b128 v[72:75],v1 offset:2048
ds_read_b128 v[76:79],v1 offset:6144
ds_read_b128 v[80:83],v1 offset:3072
ds_read_b128 v[84:87],v1 offset:7168
v_add_u32 v12,s73,v1
ds_read_b128 v[88:91],v12 offset:8192
ds_read_b128 v[92:95],v12 offset:9216
v_mov_b64 v[96:97],0
v_mov_b64 v[98:99],0
v_mov_b64 v[100:101],0
v_mov_b64 v[102:103],0
v_mov_b64 v[104:105],0
v_mov_b64 v[106:107],0
v_mov_b64 v[108:109],0
v_mov_b64 v[110:111],0
v_mov_b64 v[112:113],0
v_mov_b64 v[114:115],0
v_mov_b64 v[116:117],0
v_mov_b64 v[118:119],0
buffer_load_dwordx4 v[24:27],v13,s[8:11],s64 offen sc1
L_chain_206:
L_cpa_207:
buffer_load_dwordx4 v[24:27],v13,s[8:11],s64 offen sc1
s_sub_u32 s49,s49,1
s_cbranch_scc1 L_abort2
s_waitcnt vmcnt(1)
v_max3_u32 v12,v24,v25,v26
v_max_u32 v12,v27,v12
v_cmp_le_u32 vcc,s72,v12
s_cbranch_vccnz L_cpa_207
L_cgo_210:
ds_write_b128 v14,v[24:27] offset:0
buffer_load_dwordx4 v[40:43],v13,s[8:11],s70 offen sc1
v_smfmac_f32_16x16x64_bf16 v[96:99],v[24:27],a[0:7],v2
s_add_u32 m0,s73,131072
v_smfmac_f32_16x16x64_bf16 v[100:103],v[24:27],a[128:135],v2
s_add_u32 s57,s67,8192
v_smfmac_f32_16x16x64_bf16 v[104:107],v[24:27],a[8:15],v2
v_smfmac_f32_16x16x64_bf16 v[108:111],v[24:27],a[136:143],v2
s_waitcnt lgkmcnt(0)
s_barrier
ds_read_b128 v[28:31],v15 offset:0
ds_read_b128 v[32:35],v16 offset:0
ds_read_b128 v[36:39],v17 offset:0
v_smfmac_f32_16x16x64_bf16 v[112:115],v[24:27],v[128:135],v2
v_smfmac_f32_16x16x64_bf16 v[116:119],v[24:27],v[136:143],v2
s_waitcnt lgkmcnt(2)
v_smfmac_f32_16x16x64_bf16 v[96:99],v[28:31],a[16:23],v2
s_lshl_b32 s56,s46,10
v_smfmac_f32_16x16x64_bf16 v[100:103],v[28:31],a[144:151],v2
v_smfmac_f32_16x16x64_bf16 v[104:107],v[28:31],a[24:31],v2
v_smfmac_f32_16x16x64_bf16 v[108:111],v[28:31],a[152:159],v2
s_waitcnt lgkmcnt(1) vmcnt(0)
v_smfmac_f32_16x16x64_bf16 v[96:99],v[32:35],a[32:39],v2
v_max3_u32 v12,v40,v41,v42
v_smfmac_f32_16x16x64_bf16 v[100:103],v[32:35],a[160:167],v2
v_max_u32 v12,v43,v12
v_smfmac_f32_16x16x64_bf16 v[104:107],v[32:35],a[40:47],v2
v_cmp_le_u32 vcc,s72,v12
v_smfmac_f32_16x16x64_bf16 v[108:111],v[32:35],a[168:175],v2
s_cbranch_vccnz L_cpb_213
L_cback_215:
s_waitcnt lgkmcnt(0)
ds_write_b128 v14,v[40:43] offset:4096
v_smfmac_f32_16x16x64_bf16 v[96:99],v[36:39],a[48:55],v2
v_mov_b64 v[120:121],-1
v_smfmac_f32_16x16x64_bf16 v[100:103],v[36:39],a[176:183],v2
v_mov_b64 v[122:123],-1
v_smfmac_f32_16x16x64_bf16 v[104:107],v[36:39],a[56:63],v2
v_add_u32 v124,s56,v5
v_smfmac_f32_16x16x64_bf16 v[108:111],v[36:39],a[184:191],v2
v_add_u32 v126,s56,v6
s_waitcnt lgkmcnt(0)
s_barrier
v_smfmac_f32_16x16x64_bf16 v[96:99],v[40:43],a[64:71],v2
ds_read_b128 v[44:47],v15 offset:4096
v_smfmac_f32_16x16x64_bf16 v[100:103],v[40:43],a[192:199],v2
ds_read_b128 v[48:51],v16 offset:4096
v_smfmac_f32_16x16x64_bf16 v[104:107],v[40:43],a[72:79],v2
ds_read_b128 v[52:55],v17 offset:4096
v_smfmac_f32_16x16x64_bf16 v[108:111],v[40:43],a[200:207],v2
s_cmp_eq_u32 s76,0
s_cbranch_scc1 L_ckw_196
L_ckb_197:
s_waitcnt lgkmcnt(2)
v_smfmac_f32_16x16x64_bf16 v[96:99],v[44:47],a[80:87],v2
buffer_load_dwordx4 v0,s[8:11],s67 offen sc1 lds
v_smfmac_f32_16x16x64_bf16 v[100:103],v[44:47],a[208:215],v2
buffer_load_dwordx4 v0,s[8:11],s67 offen offset:1024 sc1 lds
v_smfmac_f32_16x16x64_bf16 v[104:107],v[44:47],a[88:95],v2
s_add_u32 m0,s73,139264
v_smfmac_f32_16x16x64_bf16 v[108:111],v[44:47],a[216:223],v2
s_waitcnt lgkmcnt(1)
v_smfmac_f32_16x16x64_bf16 v[96:99],v[48:51],a[96:103],v2
s_add_u32 s67,s67,786432
v_smfmac_f32_16x16x64_bf16 v[100:103],v[48:51],a[224:231],v2
buffer_load_dwordx4 v0,s[8:11],s57 offen sc1 lds
v_smfmac_f32_16x16x64_bf16 v[104:107],v[48:51],a[104:111],v2
buffer_load_dwordx4 v0,s[8:11],s57 offen offset:1024 sc1 lds
v_smfmac_f32_16x16x64_bf16 v[108:111],v[48:51],a[232:239],v2
s_waitcnt lgkmcnt(0)
v_smfmac_f32_16x16x64_bf16 v[96:99],v[52:55],a[112:119],v2
buffer_load_dword v23,v22,s[8:11],s75 offen sc1
v_smfmac_f32_16x16x64_bf16 v[100:103],v[52:55],a[240:247],v2
buffer_store_dword v2,off,s[8:11],s78 sc1
v_smfmac_f32_16x16x64_bf16 v[104:107],v[52:55],a[120:127],v2
buffer_store_dwordx4 v[120:123],v0,s[8:11],s69 offen sc1
v_smfmac_f32_16x16x64_bf16 v[108:111],v[52:55],a[248:255],v2
buffer_store_dwordx4 v[120:123],v0,s[8:11],s69 offen offset:1024 sc1
v_smfmac_f32_16x16x64_bf16 v[112:115],v[28:31],v[144:151],v2
v_smfmac_f32_16x16x64_bf16 v[116:119],v[28:31],v[152:159],v2
v_pk_add_f32 v[96:97],v[96:97],v[98:99]
v_pk_add_f32 v[100:101],v[100:101],v[102:103]
v_cvt_pk_bf16_f32 v120,v96,v97
v_cvt_pk_bf16_f32 v121,v100,v101
v_pk_add_f32 v[104:105],v[104:105],v[106:107]
v_pk_add_f32 v[108:109],v[108:109],v[110:111]
v_cvt_pk_bf16_f32 v122,v104,v105
v_cvt_pk_bf16_f32 v123,v108,v109
ds_write_b128 v4,v[120:123]
v_smfmac_f32_16x16x64_bf16 v[112:115],v[32:35],v[160:167],v2
v_smfmac_f32_16x16x64_bf16 v[116:119],v[32:35],v[168:175],v2
v_smfmac_f32_16x16x64_bf16 v[112:115],v[36:39],v[176:183],v2
v_smfmac_f32_16x16x64_bf16 v[116:119],v[36:39],v[184:191],v2
s_waitcnt lgkmcnt(0)
s_barrier
ds_read_b64_tr_b16 v[96:97],v5 offset:0
ds_read_b64_tr_b16 v[98:99],v6 offset:0
ds_read_b64_tr_b16 v[100:101],v5 offset:1024
ds_read_b64_tr_b16 v[102:103],v6 offset:1024
ds_read_b64_tr_b16 v[104:105],v5 offset:2048
ds_read_b64_tr_b16 v[106:107],v6 offset:2048
ds_read_b64_tr_b16 v[108:109],v5 offset:3072
ds_read_b64_tr_b16 v[110:111],v6 offset:3072
ds_read_b64_tr_b16 v[124:125],v124
ds_read_b64_tr_b16 v[126:127],v126
v_smfmac_f32_16x16x64_bf16 v[112:115],v[40:43],v[192:199],v2
v_smfmac_f32_16x16x64_bf16 v[116:119],v[40:43],v[200:207],v2
s_waitcnt lgkmcnt(8)
v_mfma_f32_16x16x32_bf16 v[24:27],v[56:59],v[96:99],0
v_mfma_f32_16x16x32_bf16 v[28:31],v[60:63],v[96:99],0
v_mfma_f32_16x16x32_bf16 v[32:35],v[96:99],v[96:99],0
s_waitcnt lgkmcnt(6)
v_mfma_f32_16x16x32_bf16 v[24:27],v[64:67],v[100:103],v[24:27]
ds_read_b128 v[56:59],v11 offset:0
v_mfma_f32_16x16x32_bf16 v[28:31],v[68:71],v[100:103],v[28:31]
ds_read_b128 v[60:63],v11 offset:1024
v_mfma_f32_16x16x32_bf16 v[32:35],v[100:103],v[100:103],v[32:35]
s_waitcnt lgkmcnt(6)
v_mfma_f32_16x16x32_bf16 v[24:27],v[72:75],v[104:107],v[24:27]
ds_read_b128 v[64:67],v11 offset:2048
v_mfma_f32_16x16x32_bf16 v[28:31],v[76:79],v[104:107],v[28:31]
ds_read_b128 v[68:71],v11 offset:3072
v_mfma_f32_16x16x32_bf16 v[32:35],v[104:107],v[104:107],v[32:35]
s_waitcnt lgkmcnt(6)
v_mfma_f32_16x16x32_bf16 v[24:27],v[80:83],v[108:111],v[24:27]
ds_read_b128 v[72:75],v11 offset:4096
v_mfma_f32_16x16x32_bf16 v[28:31],v[84:87],v[108:111],v[28:31]
ds_read_b128 v[76:79],v11 offset:5120
v_mfma_f32_16x16x32_bf16 v[32:35],v[108:111],v[108:111],v[32:35]
s_waitcnt lgkmcnt(6)
v_smfmac_f32_16x16x64_bf16 v[112:115],v[44:47],v[208:215],v2
buffer_store_dwordx4 v[124:127],v0,s[8:11],s68 offen sc1
v_smfmac_f32_16x16x64_bf16 v[116:119],v[44:47],v[216:223],v2
v_smfmac_f32_16x16x64_bf16 v[112:115],v[48:51],v[224:231],v2
v_smfmac_f32_16x16x64_bf16 v[116:119],v[48:51],v[232:239],v2
v_smfmac_f32_16x16x64_bf16 v[112:115],v[52:55],v[240:247],v2
v_smfmac_f32_16x16x64_bf16 v[116:119],v[52:55],v[248:255],v2
v_mov_b32 v125,0
v_mov_b64 v[52:53],s[28:29]
v_mov_b64 v[54:55],s[28:29]
v_max3_f32 v36,v24,v25,v26
v_max3_f32 v37,v27,v28,v29
v_max3_f32 v36,v30,v31,v36
v_max3_f32 v37,v34,v35,v37
v_max_f32 v36,v36,v37
v_max_f32 v37,v36,v37
ds_read_b128 v[80:83],v11 offset:6144
s_nop 0
v_permlane16_swap_b32 v36,v37
v_max_f32 v36,v36,v37
v_max_f32 v37,v36,v37
ds_read_b128 v[84:87],v11 offset:7168
s_nop 0
v_permlane32_swap_b32 v36,v37
v_max_f32 v36,v36,v37
v_mul_f32 v36,s80,v36
v_fma_f32 v24,v24,s80,-v36
v_fma_f32 v25,v25,s80,-v36
v_exp_f32 v24,v24
v_fma_f32 v26,v26,s80,-v36
v_exp_f32 v25,v25
v_fma_f32 v27,v27,s80,-v36
v_exp_f32 v26,v26
v_fma_f32 v28,v28,s80,-v36
v_exp_f32 v27,v27
v_fma_f32 v29,v29,s80,-v36
v_exp_f32 v28,v28
v_fma_f32 v30,v30,s80,-v36
v_exp_f32 v29,v29
v_fma_f32 v31,v31,s80,-v36
v_exp_f32 v30,v30
v_fma_f32 v34,v34,s80,-v36
v_exp_f32 v31,v31
v_fma_f32 v35,v35,s80,-v36
v_exp_f32 v34,v34
v_exp_f32 v35,v35
v_cvt_pk_bf16_f32 v120,v24,v25
v_cvt_pk_bf16_f32 v121,v26,v27
v_cvt_pk_bf16_f32 v122,v28,v29
v_cvt_pk_bf16_f32 v123,v30,v31
v_cvt_pk_bf16_f32 v124,v34,v35
s_nop 0
v_mfma_f32_16x16x32_bf16 v[32:35],v[52:55],v[120:123],0
v_pk_add_f32 v[112:113],v[112:113],v[114:115]
v_pk_add_f32 v[116:117],v[116:117],v[118:119]
v_mfma_f32_16x16x32_bf16 v[24:27],v[88:91],v[120:123],0
v_cvt_pk_bf16_f32 v36,v112,v113
v_cvt_pk_bf16_f32 v37,v116,v117
v_mfma_f32_16x16x32_bf16 v[28:31],v[92:95],v[120:123],0
v_cvt_pk_bf16_f32 v38,v116,v117
v_mov_b32 v39,0
v_mfma_f32_16x16x16_bf16 v[32:35],v[52:53],v[124:125],v[32:35]
s_add_u32 s56,s68,4096
buffer_store_dwordx4 v[36:39],v0,s[8:11],s56 offen sc1
v_mfma_f32_16x16x16_bf16 v[24:27],v[36:37],v[124:125],v[24:27]
ds_read_b128 v[96:99],v11 offset:8192
v_mfma_f32_16x16x16_bf16 v[28:31],v[38:39],v[124:125],v[28:31]
ds_read_b128 v[100:103],v11 offset:9216
v_rcp_f32 v32,v32
v_mov_b64 v[112:113],0
v_mov_b64 v[114:115],0
v_pk_mul_f32 v[24:25],v[24:25],v[32:33] op_sel_hi:[1,0]
v_pk_mul_f32 v[26:27],v[26:27],v[32:33] op_sel_hi:[1,0]
v_mov_b64 v[116:117],0
v_mov_b64 v[118:119],0
v_pk_mul_f32 v[28:29],v[28:29],v[32:33] op_sel_hi:[1,0]
v_pk_mul_f32 v[30:31],v[30:31],v[32:33] op_sel_hi:[1,0]
v_cvt_pk_bf16_f32 v120,v24,v28
v_cvt_pk_bf16_f32 v121,v25,v29
v_cvt_pk_bf16_f32 v122,v26,v30
v_cvt_pk_bf16_f32 v123,v27,v31
ds_write_b128 v7,v[120:123]
ds_read_b128 v[104:107],v11 offset:10240
ds_read_b128 v[108:111],v11 offset:11264
ds_read_b128 v[40:43],v11 offset:12288
ds_read_b128 v[44:47],v11 offset:13312
s_waitcnt lgkmcnt(4)
s_barrier
ds_read_b128 v[24:27],v8 offset:0
ds_read_b128 v[28:31],v8 offset:512
ds_read_b128 v[32:35],v8 offset:1024
ds_read_b128 v[36:39],v8 offset:1536
ds_read_b128 v[48:51],v11 offset:14336
ds_read_b128 v[52:55],v11 offset:15360
v_mov_b64 v[88:89],0
v_mov_b64 v[90:91],0
v_mov_b64 v[92:93],0
v_mov_b64 v[94:95],0
s_waitcnt lgkmcnt(5)
v_smfmac_f32_16x16x64_bf16 v[112:115],v[24:27],v[56:63],v3
ds_read_b128 v[56:59],v11 offset:16384
ds_read_b128 v[60:63],v11 offset:17408
s_waitcnt lgkmcnt(6)
v_smfmac_f32_16x16x64_bf16 v[112:115],v[28:31],v[64:71],v3
ds_read_b128 v[64:67],v11 offset:18432
ds_read_b128 v[68:71],v11 offset:19456
s_waitcnt lgkmcnt(7)
v_smfmac_f32_16x16x64_bf16 v[112:115],v[32:35],v[72:79],v3
ds_read_b128 v[72:75],v11 offset:20480
ds_read_b128 v[76:79],v11 offset:21504
s_waitcnt lgkmcnt(8)
v_smfmac_f32_16x16x64_bf16 v[112:115],v[36:39],v[80:87],v3
ds_read_b128 v[80:83],v11 offset:22528
ds_read_b128 v[84:87],v11 offset:23552
s_waitcnt lgkmcnt(8)
v_smfmac_f32_16x16x64_bf16 v[116:119],v[24:27],v[96:103],v3
ds_read_b128 v[96:99],v11 offset:24576
ds_read_b128 v[100:103],v11 offset:25600
v_smfmac_f32_16x16x64_bf16 v[116:119],v[28:31],v[104:111],v3
v_cvt_pk_bf16_f32 v112,v112,v113
v_cvt_pk_bf16_f32 v113,v114,v115
buffer_store_dwordx2 v[112:113],v9,s[8:11],s65 offen sc1
ds_read_b128 v[104:107],v11 offset:26624
ds_read_b128 v[108:111],v11 offset:27648
v_smfmac_f32_16x16x64_bf16 v[116:119],v[32:35],v[40:47],v3
ds_read_b128 v[40:43],v11 offset:28672
ds_read_b128 v[44:47],v11 offset:29696
v_smfmac_f32_16x16x64_bf16 v[116:119],v[36:39],v[48:55],v3
s_waitcnt lgkmcnt(12)
ds_read_b128 v[48:51],v11 offset:30720
ds_read_b128 v[52:55],v11 offset:31744
s_waitcnt lgkmcnt(14)
v_smfmac_f32_16x16x64_bf16 v[88:91],v[24:27],v[56:63],v3
s_nop 2
v_cvt_pk_bf16_f32 v116,v116,v117
v_cvt_pk_bf16_f32 v117,v118,v119
s_add_u32 s56,s65,65536
buffer_store_dwordx2 v[116:117],v9,s[8:11],s56 offen sc1
s_waitcnt lgkmcnt(12)
v_smfmac_f32_16x16x64_bf16 v[88:91],v[28:31],v[64:71],v3
s_waitcnt lgkmcnt(10)
v_smfmac_f32_16x16x64_bf16 v[88:91],v[32:35],v[72:79],v3
s_waitcnt lgkmcnt(8)
v_smfmac_f32_16x16x64_bf16 v[88:91],v[36:39],v[80:87],v3
s_waitcnt lgkmcnt(6)
v_smfmac_f32_16x16x64_bf16 v[92:95],v[24:27],v[96:103],v3
s_waitcnt lgkmcnt(4)
v_smfmac_f32_16x16x64_bf16 v[92:95],v[28:31],v[104:111],v3
v_cvt_pk_bf16_f32 v88,v88,v89
v_cvt_pk_bf16_f32 v89,v90,v91
s_add_u32 s56,s65,131072
buffer_store_dwordx2 v[88:89],v9,s[8:11],s56 offen sc1
s_waitcnt lgkmcnt(2)
v_smfmac_f32_16x16x64_bf16 v[92:95],v[32:35],v[40:47],v3
s_waitcnt lgkmcnt(0)
v_smfmac_f32_16x16x64_bf16 v[92:95],v[36:39],v[48:55],v3
s_add_u32 s78,s79,s75
s_add_u32 s75,s75,8192
s_add_u32 s64,s75,13631488
s_add_u32 s70,s64,4096
s_add_u32 s68,s68,262144
s_add_u32 s51,s51,1
s_nop 1
v_cvt_pk_bf16_f32 v92,v92,v93
v_cvt_pk_bf16_f32 v93,v94,v95
s_add_u32 s56,s65,196608
buffer_store_dwordx2 v[92:93],v9,s[8:11],s56 offen sc1
s_xor_b32 s65,s65,262144
s_cmp_eq_u32 s51,64
s_cbranch_scc1 L_cend_209
s_cmp_lt_u32 s47,16
s_waitcnt vmcnt(2)
s_cbranch_scc1 L_cea_216
s_barrier
ds_read_b128 v[56:59],v1 offset:0
ds_read_b128 v[60:63],v1 offset:4096
ds_read_b128 v[64:67],v1 offset:1024
ds_read_b128 v[68:71],v1 offset:5120
ds_read_b128 v[72:75],v1 offset:2048
ds_read_b128 v[76:79],v1 offset:6144
ds_read_b128 v[80:83],v1 offset:3072
ds_read_b128 v[84:87],v1 offset:7168
v_add_u32 v12,s73,v1
ds_read_b128 v[88:91],v12 offset:8192
ds_read_b128 v[92:95],v12 offset:9216
v_mov_b64 v[96:97],0
v_mov_b64 v[98:99],0
v_mov_b64 v[100:101],0
v_mov_b64 v[102:103],0
v_mov_b64 v[104:105],0
v_mov_b64 v[106:107],0
v_mov_b64 v[108:109],0
v_mov_b64 v[110:111],0
v_mov_b64 v[112:113],0
v_mov_b64 v[114:115],0
v_mov_b64 v[116:117],0
v_mov_b64 v[118:119],0
v_readlane_b32 s76,v23,4
s_cmp_ge_u32 s51,63
s_cselect_b32 s76,1,s76
v_readlane_b32 s77,v23,5
s_cmp_gt_u32 s51,60
s_cselect_b32 s77,1,s77
s_waitcnt vmcnt(0)
L_crp_211:
buffer_load_dwordx4 v[120:123],v0,s[8:11],s66 offen offset:0 sc1
buffer_load_dwordx4 v[124:127],v0,s[8:11],s66 offen offset:1024 sc1
s_sub_u32 s49,s49,1
s_cbranch_scc1 L_abort2
s_waitcnt vmcnt(1)
v_mfma_f32_16x16x32_bf16 v[28:31],v[18:21],v[120:123],0
s_waitcnt vmcnt(0)
v_mfma_f32_16x16x32_bf16 v[28:31],v[18:21],v[124:127],v[28:31]
s_nop 7
v_cmp_u_f32 vcc,v28,v28
v_add_f32_dpp v32,v28,v28 row_ror:8 row_mask:0xf bank_mask:0x3
v_add_f32_dpp v33,v29,v29 row_ror:8 row_mask:0xf bank_mask:0x3
v_add_f32_dpp v32,v30,v30 row_ror:8 row_mask:0xf bank_mask:0xc
v_add_f32_dpp v33,v31,v31 row_ror:8 row_mask:0xf bank_mask:0xc
s_nop 0
v_add_f32_dpp v32,v32,v32 row_shl:4 row_mask:0xf bank_mask:0x5
v_add_f32_dpp v33,v33,v33 row_shl:4 row_mask:0xf bank_mask:0x5
s_cbranch_vccnz L_crp_211
v_cvt_pk_bf16_f32 v34,v32,v33
buffer_store_dword v34,v10,s[8:11],s64 offen sc1
s_mov_b32 s69,s66
s_xor_b32 s66,s66,262144
buffer_load_dwordx4 v[24:27],v13,s[8:11],s64 offen sc1
s_cmp_lg_u32 s77,1
s_cbranch_scc1 L_cjw_198
s_branch L_chain_206
L_cea_216:
buffer_load_dwordx4 v[120:123],v0,s[8:11],s66 offen offset:0 sc1
buffer_load_dwordx4 v[124:127],v0,s[8:11],s66 offen offset:1024 sc1
v_mov_b64 v[96:97],0
v_mov_b64 v[98:99],0
v_mov_b64 v[100:101],0
v_mov_b64 v[102:103],0
v_mov_b64 v[104:105],0
v_mov_b64 v[106:107],0
v_mov_b64 v[108:109],0
v_mov_b64 v[110:111],0
v_mov_b64 v[112:113],0
v_mov_b64 v[114:115],0
v_mov_b64 v[116:117],0
v_mov_b64 v[118:119],0
v_readlane_b32 s76,v23,4
s_cmp_ge_u32 s51,63
s_cselect_b32 s76,1,s76
v_readlane_b32 s77,v23,5
s_cmp_gt_u32 s51,60
s_cselect_b32 s77,1,s77
s_branch L_cr1_217
L_crb_212:
buffer_load_dwordx4 v[120:123],v0,s[8:11],s66 offen offset:0 sc1
buffer_load_dwordx4 v[124:127],v0,s[8:11],s66 offen offset:1024 sc1
L_cr1_217:
s_sub_u32 s49,s49,1
s_cbranch_scc1 L_abort2
s_waitcnt vmcnt(1)
v_mfma_f32_16x16x32_bf16 v[28:31],v[18:21],v[120:123],0
s_waitcnt vmcnt(0)
v_mfma_f32_16x16x32_bf16 v[28:31],v[18:21],v[124:127],v[28:31]
s_nop 7
v_cmp_u_f32 vcc,v28,v28
v_add_f32_dpp v32,v28,v28 row_ror:8 row_mask:0xf bank_mask:0x3
v_add_f32_dpp v33,v29,v29 row_ror:8 row_mask:0xf bank_mask:0x3
v_add_f32_dpp v32,v30,v30 row_ror:8 row_mask:0xf bank_mask:0xc
v_add_f32_dpp v33,v31,v31 row_ror:8 row_mask:0xf bank_mask:0xc
s_nop 0
v_add_f32_dpp v32,v32,v32 row_shl:4 row_mask:0xf bank_mask:0x5
v_add_f32_dpp v33,v33,v33 row_shl:4 row_mask:0xf bank_mask:0x5
s_cbranch_vccnz L_crb_212
v_cvt_pk_bf16_f32 v34,v32,v33
buffer_store_dword v34,v10,s[8:11],s64 offen sc1
s_mov_b32 s69,s66
s_xor_b32 s66,s66,262144
s_barrier
ds_read_b128 v[56:59],v1 offset:0
ds_read_b128 v[60:63],v1 offset:4096
ds_read_b128 v[64:67],v1 offset:1024
ds_read_b128 v[68:71],v1 offset:5120
buffer_load_dwordx4 v[24:27],v13,s[8:11],s64 offen sc1
ds_read_b128 v[72:75],v1 offset:2048
ds_read_b128 v[76:79],v1 offset:6144
ds_read_b128 v[80:83],v1 offset:3072
ds_read_b128 v[84:87],v1 offset:7168
v_add_u32 v12,s73,v1
ds_read_b128 v[88:91],v12 offset:8192
ds_read_b128 v[92:95],v12 offset:9216
s_cmp_lg_u32 s77,1
s_cbranch_scc1 L_cjw_198
s_branch L_chain_206
L_ckw_196:
s_lshl2_add_u32 s59,s47,s75
s_add_u32 s59,s59,10494080
L_ww_218:
buffer_load_dword v23,off,s[8:11],s59 sc1
s_sub_u32 s49,s49,1
s_cbranch_scc1 L_abort2
s_waitcnt vmcnt(0)
v_readfirstlane_b32 s76,v23
s_cmp_eq_u32 s76,0
s_cbranch_scc1 L_ww_218
L_wwd_219:
s_branch L_ckb_197
L_cjw_198:
s_add_u32 s59,s75,10511616
L_ww_220:
buffer_load_dword v120,off,s[8:11],s59 sc1
s_sub_u32 s49,s49,1
s_cbranch_scc1 L_abort2
s_waitcnt vmcnt(0)
v_readfirstlane_b32 s77,v120
s_cmp_eq_u32 s77,0
s_cbranch_scc1 L_ww_220
L_wwd_221:
s_cmp_eq_u32 s77,1
s_cbranch_scc1 L_chain_206
L_cjump_199:
buffer_load_dwordx4 v[24:27],v13,s[8:11],s64 offen sc1
buffer_load_dwordx4 v[40:43],v13,s[8:11],s70 offen sc1
s_sub_u32 s49,s49,1
s_cbranch_scc1 L_abort2
s_waitcnt vmcnt(0)
v_max3_u32 v12,v24,v25,v26
v_max_u32 v12,v27,v12
v_max3_u32 v12,v40,v41,v12
v_max3_u32 v12,v42,v43,v12
v_cmp_le_u32 vcc,s72,v12
s_cbranch_vccnz L_cjump_199
s_waitcnt lgkmcnt(0)
s_barrier
s_add_u32 s51,s51,3
s_branch L_cst_195
L_cpb_213:
buffer_load_dwordx4 v[40:43],v13,s[8:11],s70 offen sc1
s_waitcnt vmcnt(0)
v_max3_u32 v12,v40,v41,v42
v_max_u32 v12,v43,v12
v_cmp_le_u32 vcc,s72,v12
s_cbranch_vccz L_cback_215
s_sub_u32 s49,s49,1
s_cmp_gt_i32 s49,0
s_cbranch_scc1 L_cpb_213
s_branch L_abort2
L_cend_209:
s_waitcnt vmcnt(0)
s_barrier
buffer_store_dword v2,off,s[8:11],s78 sc1
s_nop 11
v_lshrrev_b32 v1,4,v0
s_endpgm
L_wa:
s_nop 11
v_and_b32 v238,15,v1
v_and_b32 v239,1,v1
v_lshlrev_b32 v239,4,v239
v_mov_b32 v240,0x3f80
v_lshlrev_b32 v240,v239,v240
v_lshrrev_b32 v238,1,v238
v_cmp_eq_u32 vcc,0,v238
s_nop 1
v_cndmask_b32 v156,0,v240,vcc
v_cmp_eq_u32 vcc,1,v238
s_nop 1
v_cndmask_b32 v157,0,v240,vcc
v_cmp_eq_u32 vcc,2,v238
s_nop 1
v_cndmask_b32 v158,0,v240,vcc
v_cmp_eq_u32 vcc,3,v238
s_nop 1
v_cndmask_b32 v159,0,v240,vcc
s_mov_b32 s4,s32
s_mov_b32 s5,s33
s_mov_b32 s6,1024
s_mov_b32 s7,0x20000
buffer_load_dwordx4 v[224:227],v0,s[4:7],0 offen
v_and_b32 v238,15,v1
v_lshrrev_b32 v239,4,v1
v_lshlrev_b32 v240,2,v239
v_mov_b32 v241,0xf149f2ca
s_and_b32 s56,s46,1
s_lshl_b32 s56,s56,4
v_add_u32 v242,s56,v238
v_add_u32 v243,0,v240
v_cmp_gt_u32 vcc,v243,v242
s_nop 1
v_cndmask_b32 v8,0,v241,vcc
v_add_u32 v243,1,v240
v_cmp_gt_u32 vcc,v243,v242
s_nop 1
v_cndmask_b32 v9,0,v241,vcc
v_add_u32 v243,2,v240
v_cmp_gt_u32 vcc,v243,v242
s_nop 1
v_cndmask_b32 v10,0,v241,vcc
v_add_u32 v243,3,v240
v_cmp_gt_u32 vcc,v243,v242
s_nop 1
v_cndmask_b32 v11,0,v241,vcc
v_add_u32 v243,16,v240
v_cmp_gt_u32 vcc,v243,v242
s_nop 1
v_cndmask_b32 v12,0,v241,vcc
v_add_u32 v243,17,v240
v_cmp_gt_u32 vcc,v243,v242
s_nop 1
v_cndmask_b32 v13,0,v241,vcc
v_add_u32 v243,18,v240
v_cmp_gt_u32 vcc,v243,v242
s_nop 1
v_cndmask_b32 v14,0,v241,vcc
v_add_u32 v243,19,v240
v_cmp_gt_u32 vcc,v243,v242
s_nop 1
v_cndmask_b32 v15,0,v241,vcc
v_mov_b64 v[152:153],s[28:29]
v_mov_b64 v[154:155],s[28:29]
v_mov_b32 v145,0
v_mov_b32 v146,0
s_lshl_b32 s56,s46,12
s_add_u32 s56,s56,131072
v_add_u32 v3,s56,v0
v_add_u32 v4,131072,v0
s_lshl_b32 s56,s46,8
v_lshlrev_b32 v7,4,v238
v_add_u32 v7,s56,v7
v_lshl_add_u32 v5,v239,16,v7
v_lshlrev_b32 v6,1,v7
v_lshl_add_u32 v7,v239,10,v7
v_and_b32 v243,1,v239
v_lshl_add_u32 v6,v243,4,v6
v_lshrrev_b32 v243,1,v239
v_lshl_add_u32 v6,v243,12,v6
v_add_u32 v6,147456,v6
v_lshlrev_b32 v16,2,v238
v_lshlrev_b32 v21,3,v238
s_and_b32 s68,s47,15
s_lshl_b32 s69,s54,19
s_add_u32 s69,s69,20971520
s_lshl_b32 s87,s54,13
s_add_u32 s87,s87,10486656
s_lshl_b32 s68,s68,1
s_lshr_b32 s56,s46,1
s_add_u32 s68,s68,s56
s_mov_b32 s66,0
s_mov_b32 s67,0
s_mov_b32 s73,0x80000000
s_mov_b32 s75,0
s_waitcnt vmcnt(0)
v_lshlrev_b32 v228,16,v224
v_and_b32 v229,0xffff0000,v224
v_lshlrev_b32 v230,16,v225
v_and_b32 v231,0xffff0000,v225
v_lshlrev_b32 v232,16,v226
v_and_b32 v233,0xffff0000,v226
v_lshlrev_b32 v234,16,v227
v_and_b32 v235,0xffff0000,v227
v_add_u32 v21,10487168,v21
v_mov_b32 v244,v21
s_and_b32 s56,s50,2048
s_add_u32 s56,s56,147456
v_lshlrev_b32 v23,5,v1
v_add_u32 v23,s56,v23
s_lshr_b32 s56,s68,1
s_lshl2_add_u32 s74,s56,s87
s_or_b32 s74,s74,s52
s_cmp_lt_u32 s54,2
s_cbranch_scc1 L_aa_222
s_sub_u32 s77,s54,2
s_mov_b32 s30,0
s_mov_b32 s86,1536
s_lshl_b32 s56,s77,5
s_add_u32 s56,s56,s68
s_mul_i32 s70,s56,24576
s_lshl_b32 s71,s56,13
s_add_u32 s70,s70,100663296
s_add_u32 s71,s71,41943040
s_lshl_b32 s59,s77,13
s_lshl2_add_u32 s59,s68,s59
s_add_u32 s59,s59,10485760
v_mov_b32 v19,s59
buffer_load_dword v18,v19,s[8:11],0 offen sc1
s_branch L_aa_231
L_aa_223:
ds_read_b128 v[24:27],v4 offset:0
ds_read_b128 v[28:31],v4 offset:1024
ds_read_b128 v[32:35],v4 offset:2048
ds_read_b128 v[36:39],v4 offset:3072
ds_read_b128 v[40:43],v4 offset:8192
ds_read_b128 v[44:47],v4 offset:9216
ds_read_b128 v[48:51],v4 offset:10240
ds_read_b128 v[52:55],v4 offset:11264
s_waitcnt lgkmcnt(7)
v_mfma_f32_16x16x32_bf16 v[160:163],v[24:27],a[0:3],0
s_add_u32 s63,s87,128
buffer_load_dword v17,v16,s[8:11],s63 offen sc1
v_mfma_f32_16x16x32_bf16 v[164:167],v[24:27],a[4:7],0
s_lshl_b32 s61,s51,5
s_add_u32 s61,s61,s68
v_mfma_f32_16x16x32_bf16 v[168:171],v[24:27],a[8:11],0
s_lshl_b32 s58,s61,10
s_add_u32 s60,s58,8388608
v_mfma_f32_16x16x32_bf16 v[172:175],v[24:27],a[12:15],0
s_lshl_b32 s59,s51,10
s_add_u32 s59,s59,11272192
v_mfma_f32_16x16x32_bf16 v[176:179],v[24:27],a[16:19],0
s_cmp_eq_u32 s61,s55
s_cselect_b32 s60,s59,s60
v_mfma_f32_16x16x32_bf16 v[180:183],v[24:27],a[20:23],0
s_cmp_eq_u32 s31,0
s_cselect_b32 s60,s58,s60
v_mfma_f32_16x16x32_bf16 v[184:187],v[24:27],a[24:27],0
s_cselect_b64 s[4:5],s[16:17],s[44:45]
s_mov_b32 s6,268435456
v_mfma_f32_16x16x32_bf16 v[188:191],v[24:27],a[28:31],0
s_cmov_b32 s6,2097152
s_mov_b32 s7,0x20000
s_waitcnt lgkmcnt(6)
v_mfma_f32_16x16x32_bf16 v[160:163],v[28:31],a[32:35],v[160:163]
buffer_load_dwordx4 v[224:227],v0,s[4:7],s60 offen sc1
v_mfma_f32_16x16x32_bf16 v[164:167],v[28:31],a[36:39],v[164:167]
s_lshl_b32 s60,s51,13
s_lshl2_add_u32 s60,s68,s60
v_mfma_f32_16x16x32_bf16 v[168:171],v[28:31],a[40:43],v[168:171]
s_add_u32 s60,s60,10487296
buffer_load_dword v246,off,s[8:11],s60 sc1
v_mfma_f32_16x16x32_bf16 v[172:175],v[28:31],a[44:47],v[172:175]
s_cmp_eq_u32 s30,0
s_cselect_b32 s65,0x80000000,s71
v_mfma_f32_16x16x32_bf16 v[176:179],v[28:31],a[48:51],v[176:179]
s_lshl_b32 s56,s72,31
s_or_b32 s64,s70,s56
v_mfma_f32_16x16x32_bf16 v[180:183],v[28:31],a[52:55],v[180:183]
s_or_b32 s65,s65,s56
s_lshr_b32 s62,s68,1
v_mfma_f32_16x16x32_bf16 v[184:187],v[28:31],a[56:59],v[184:187]
s_lshl_b32 s61,s62,10
s_add_u32 s61,s61,s69
v_mfma_f32_16x16x32_bf16 v[188:191],v[28:31],a[60:63],v[188:191]
v_mov_b32 v238,155648
s_and_b32 s57,s46,1
s_waitcnt lgkmcnt(5)
v_mfma_f32_16x16x32_bf16 v[160:163],v[32:35],a[64:67],v[160:163]
s_mul_i32 s58,s57,12288
s_add_u32 s64,s64,s58
v_mfma_f32_16x16x32_bf16 v[164:167],v[32:35],a[68:71],v[164:167]
s_lshl_b32 s57,s57,12
s_add_u32 s65,s65,s57
v_mfma_f32_16x16x32_bf16 v[168:171],v[32:35],a[72:75],v[168:171]
s_and_b32 s59,s50,2048
s_lshl_b32 s59,s59,4
v_mfma_f32_16x16x32_bf16 v[172:175],v[32:35],a[76:79],v[172:175]
s_xor_b32 s60,s67,65536
s_add_u32 s59,s59,s60
v_mfma_f32_16x16x32_bf16 v[176:179],v[32:35],a[80:83],v[176:179]
s_add_u32 s58,s58,s59
s_add_u32 s57,s57,s59
v_mfma_f32_16x16x32_bf16 v[180:183],v[32:35],a[84:87],v[180:183]
s_add_u32 m0,s58,0
s_nop 0
buffer_load_dwordx4 v0,s[8:11],s64 offen offset:0 sc1 lds
v_mfma_f32_16x16x32_bf16 v[184:187],v[32:35],a[88:91],v[184:187]
v_mfma_f32_16x16x32_bf16 v[188:191],v[32:35],a[92:95],v[188:191]
s_waitcnt lgkmcnt(0)
v_mfma_f32_16x16x32_bf16 v[160:163],v[36:39],a[96:99],v[160:163]
ds_read_b128 v[56:59],v4 offset:4096
v_mfma_f32_16x16x32_bf16 v[164:167],v[36:39],a[100:103],v[164:167]
buffer_load_dwordx4 v0,s[8:11],s64 offen offset:1024 sc1 lds
v_mfma_f32_16x16x32_bf16 v[168:171],v[36:39],a[104:107],v[168:171]
ds_read_b128 v[60:63],v4 offset:5120
v_mfma_f32_16x16x32_bf16 v[172:175],v[36:39],a[108:111],v[172:175]
ds_read_b128 v[64:67],v4 offset:6144
v_mfma_f32_16x16x32_bf16 v[176:179],v[36:39],a[112:115],v[176:179]
ds_read_b128 v[68:71],v4 offset:7168
v_mfma_f32_16x16x32_bf16 v[180:183],v[36:39],a[116:119],v[180:183]
buffer_load_dwordx4 v0,s[8:11],s64 offen offset:2048 sc1 lds
v_mfma_f32_16x16x32_bf16 v[184:187],v[36:39],a[120:123],v[184:187]
ds_read_b128 v[72:75],v4 offset:12288
v_mfma_f32_16x16x32_bf16 v[188:191],v[36:39],a[124:127],v[188:191]
ds_read_b128 v[76:79],v4 offset:13312
v_mfma_f32_16x16x32_bf16 v[160:163],v[40:43],a[128:131],v[160:163]
ds_read_b128 v[80:83],v4 offset:14336
v_mfma_f32_16x16x32_bf16 v[164:167],v[40:43],a[132:135],v[164:167]
buffer_load_dwordx4 v0,s[8:11],s64 offen offset:3072 sc1 lds
v_mfma_f32_16x16x32_bf16 v[168:171],v[40:43],a[136:139],v[168:171]
s_add_u32 m0,s58,4096
s_add_u32 s64,s64,4096
v_mfma_f32_16x16x32_bf16 v[172:175],v[40:43],a[140:143],v[172:175]
ds_read_b128 v[84:87],v4 offset:15360
v_mfma_f32_16x16x32_bf16 v[176:179],v[40:43],a[144:147],v[176:179]
ds_read_b128 v[128:131],v238
v_mfma_f32_16x16x32_bf16 v[180:183],v[40:43],a[148:151],v[180:183]
buffer_load_dwordx4 v0,s[8:11],s64 offen offset:0 sc1 lds
v_mfma_f32_16x16x32_bf16 v[184:187],v[40:43],a[152:155],v[184:187]
v_mfma_f32_16x16x32_bf16 v[188:191],v[40:43],a[156:159],v[188:191]
s_waitcnt vmcnt(8)
buffer_store_dword v20,off,s[8:11],s73 sc1
s_mov_b32 s73,0x80000000
v_mfma_f32_16x16x32_bf16 v[160:163],v[44:47],a[160:163],v[160:163]
v_mfma_f32_16x16x32_bf16 v[164:167],v[44:47],a[164:167],v[164:167]
buffer_load_dwordx4 v0,s[8:11],s64 offen offset:1024 sc1 lds
v_mfma_f32_16x16x32_bf16 v[168:171],v[44:47],a[168:171],v[168:171]
v_mfma_f32_16x16x32_bf16 v[172:175],v[44:47],a[172:175],v[172:175]
v_mfma_f32_16x16x32_bf16 v[176:179],v[44:47],a[176:179],v[176:179]
v_mfma_f32_16x16x32_bf16 v[180:183],v[44:47],a[180:183],v[180:183]
buffer_load_dwordx4 v0,s[8:11],s64 offen offset:2048 sc1 lds
v_mfma_f32_16x16x32_bf16 v[184:187],v[44:47],a[184:187],v[184:187]
v_mfma_f32_16x16x32_bf16 v[188:191],v[44:47],a[188:191],v[188:191]
v_mfma_f32_16x16x32_bf16 v[160:163],v[48:51],a[192:195],v[160:163]
v_mfma_f32_16x16x32_bf16 v[164:167],v[48:51],a[196:199],v[164:167]
buffer_load_dwordx4 v0,s[8:11],s64 offen offset:3072 sc1 lds
v_mfma_f32_16x16x32_bf16 v[168:171],v[48:51],a[200:203],v[168:171]
s_add_u32 m0,s58,8192
s_add_u32 s64,s64,4096
v_mfma_f32_16x16x32_bf16 v[172:175],v[48:51],a[204:207],v[172:175]
v_mfma_f32_16x16x32_bf16 v[176:179],v[48:51],a[208:211],v[176:179]
v_mfma_f32_16x16x32_bf16 v[180:183],v[48:51],a[212:215],v[180:183]
buffer_load_dwordx4 v0,s[8:11],s64 offen offset:0 sc1 lds
v_mfma_f32_16x16x32_bf16 v[184:187],v[48:51],a[216:219],v[184:187]
v_mfma_f32_16x16x32_bf16 v[188:191],v[48:51],a[220:223],v[188:191]
v_mfma_f32_16x16x32_bf16 v[160:163],v[52:55],a[224:227],v[160:163]
v_mfma_f32_16x16x32_bf16 v[164:167],v[52:55],a[228:231],v[164:167]
buffer_load_dwordx4 v0,s[8:11],s64 offen offset:1024 sc1 lds
v_mfma_f32_16x16x32_bf16 v[168:171],v[52:55],a[232:235],v[168:171]
v_mfma_f32_16x16x32_bf16 v[172:175],v[52:55],a[236:239],v[172:175]
v_mfma_f32_16x16x32_bf16 v[176:179],v[52:55],a[240:243],v[176:179]
v_mfma_f32_16x16x32_bf16 v[180:183],v[52:55],a[244:247],v[180:183]
buffer_load_dwordx4 v0,s[8:11],s64 offen offset:2048 sc1 lds
v_mfma_f32_16x16x32_bf16 v[184:187],v[52:55],a[248:251],v[184:187]
v_mfma_f32_16x16x32_bf16 v[188:191],v[52:55],a[252:255],v[188:191]
s_waitcnt vmcnt(14) lgkmcnt(0)
L_aw_236:
v_cmp_gt_u32 vcc,s66,v17
s_cbranch_vccz L_awd_237
buffer_load_dword v17,v16,s[8:11],s63 offen sc1
s_sub_u32 s49,s49,1
s_cbranch_scc1 L_abort2
s_waitcnt vmcnt(0)
s_branch L_aw_236
L_awd_237:
v_mfma_f32_16x16x32_bf16 v[192:195],v[56:59],a[0:3],0
v_or3_b32 v128,v128,v129,v130
v_or_b32 v128,v128,v131
v_mfma_f32_16x16x32_bf16 v[196:199],v[56:59],a[4:7],0
buffer_load_dwordx4 v0,s[8:11],s64 offen offset:3072 sc1 lds
v_mfma_f32_16x16x32_bf16 v[200:203],v[56:59],a[8:11],0
s_add_u32 m0,s57,24576
s_nop 0
v_mfma_f32_16x16x32_bf16 v[204:207],v[56:59],a[12:15],0
v_readfirstlane_b32 s72,v128
v_cvt_pk_bf16_f32 v88,v160,v164
v_mfma_f32_16x16x32_bf16 v[208:211],v[56:59],a[16:19],0
v_cvt_pk_bf16_f32 v89,v168,v172
v_cvt_pk_bf16_f32 v90,v176,v180
v_mfma_f32_16x16x32_bf16 v[212:215],v[56:59],a[20:23],0
buffer_load_dwordx4 v0,s[8:11],s65 offen offset:0 sc1 lds
v_mfma_f32_16x16x32_bf16 v[216:219],v[56:59],a[24:27],0
v_cvt_pk_bf16_f32 v91,v184,v188
s_add_u32 s62,s61,0
v_mfma_f32_16x16x32_bf16 v[220:223],v[56:59],a[28:31],0
buffer_store_dwordx4 v[88:91],v5,s[8:11],s62 offen sc1
v_mfma_f32_16x16x32_bf16 v[192:195],v[60:63],a[32:35],v[192:195]
v_cvt_pk_bf16_f32 v92,v161,v165
v_cvt_pk_bf16_f32 v93,v169,v173
v_mfma_f32_16x16x32_bf16 v[196:199],v[60:63],a[36:39],v[196:199]
buffer_load_dwordx4 v0,s[8:11],s65 offen offset:1024 sc1 lds
v_mfma_f32_16x16x32_bf16 v[200:203],v[60:63],a[40:43],v[200:203]
v_cvt_pk_bf16_f32 v94,v177,v181
v_cvt_pk_bf16_f32 v95,v185,v189
v_mfma_f32_16x16x32_bf16 v[204:207],v[60:63],a[44:47],v[204:207]
s_add_u32 s62,s61,16384
buffer_store_dwordx4 v[92:95],v5,s[8:11],s62 offen sc1
v_mfma_f32_16x16x32_bf16 v[208:211],v[60:63],a[48:51],v[208:211]
v_cvt_pk_bf16_f32 v96,v162,v166
v_cvt_pk_bf16_f32 v97,v170,v174
v_mfma_f32_16x16x32_bf16 v[212:215],v[60:63],a[52:55],v[212:215]
buffer_load_dwordx4 v0,s[8:11],s65 offen offset:2048 sc1 lds
v_mfma_f32_16x16x32_bf16 v[216:219],v[60:63],a[56:59],v[216:219]
v_cvt_pk_bf16_f32 v98,v178,v182
v_cvt_pk_bf16_f32 v99,v186,v190
v_mfma_f32_16x16x32_bf16 v[220:223],v[60:63],a[60:63],v[220:223]
s_add_u32 s62,s61,32768
buffer_store_dwordx4 v[96:99],v5,s[8:11],s62 offen sc1
v_mfma_f32_16x16x32_bf16 v[192:195],v[64:67],a[64:67],v[192:195]
v_cvt_pk_bf16_f32 v100,v163,v167
v_cvt_pk_bf16_f32 v101,v171,v175
v_mfma_f32_16x16x32_bf16 v[196:199],v[64:67],a[68:71],v[196:199]
buffer_load_dwordx4 v0,s[8:11],s65 offen offset:3072 sc1 lds
v_mfma_f32_16x16x32_bf16 v[200:203],v[64:67],a[72:75],v[200:203]
v_cvt_pk_bf16_f32 v102,v179,v183
v_cvt_pk_bf16_f32 v103,v187,v191
v_mfma_f32_16x16x32_bf16 v[204:207],v[64:67],a[76:79],v[204:207]
s_add_u32 s62,s61,49152
buffer_store_dwordx4 v[100:103],v5,s[8:11],s62 offen sc1
v_mfma_f32_16x16x32_bf16 v[208:211],v[64:67],a[80:83],v[208:211]
v_mfma_f32_16x16x32_bf16 v[212:215],v[64:67],a[84:87],v[212:215]
v_mfma_f32_16x16x32_bf16 v[216:219],v[64:67],a[88:91],v[216:219]
v_mfma_f32_16x16x32_bf16 v[220:223],v[64:67],a[92:95],v[220:223]
v_mfma_f32_16x16x32_bf16 v[192:195],v[68:71],a[96:99],v[192:195]
v_mfma_f32_16x16x32_bf16 v[196:199],v[68:71],a[100:103],v[196:199]
v_mfma_f32_16x16x32_bf16 v[200:203],v[68:71],a[104:107],v[200:203]
v_mfma_f32_16x16x32_bf16 v[204:207],v[68:71],a[108:111],v[204:207]
v_mfma_f32_16x16x32_bf16 v[208:211],v[68:71],a[112:115],v[208:211]
v_mfma_f32_16x16x32_bf16 v[212:215],v[68:71],a[116:119],v[212:215]
v_mfma_f32_16x16x32_bf16 v[216:219],v[68:71],a[120:123],v[216:219]
v_mfma_f32_16x16x32_bf16 v[220:223],v[68:71],a[124:127],v[220:223]
v_mfma_f32_16x16x32_bf16 v[192:195],v[72:75],a[128:131],v[192:195]
v_mfma_f32_16x16x32_bf16 v[196:199],v[72:75],a[132:135],v[196:199]
v_mfma_f32_16x16x32_bf16 v[200:203],v[72:75],a[136:139],v[200:203]
v_mfma_f32_16x16x32_bf16 v[204:207],v[72:75],a[140:143],v[204:207]
v_mfma_f32_16x16x32_bf16 v[208:211],v[72:75],a[144:147],v[208:211]
v_mfma_f32_16x16x32_bf16 v[212:215],v[72:75],a[148:151],v[212:215]
v_mfma_f32_16x16x32_bf16 v[216:219],v[72:75],a[152:155],v[216:219]
v_mfma_f32_16x16x32_bf16 v[220:223],v[72:75],a[156:159],v[220:223]
v_mfma_f32_16x16x32_bf16 v[192:195],v[76:79],a[160:163],v[192:195]
v_mfma_f32_16x16x32_bf16 v[196:199],v[76:79],a[164:167],v[196:199]
v_mfma_f32_16x16x32_bf16 v[200:203],v[76:79],a[168:171],v[200:203]
v_mfma_f32_16x16x32_bf16 v[204:207],v[76:79],a[172:175],v[204:207]
v_mfma_f32_16x16x32_bf16 v[208:211],v[76:79],a[176:179],v[208:211]
v_mfma_f32_16x16x32_bf16 v[212:215],v[76:79],a[180:183],v[212:215]
v_mfma_f32_16x16x32_bf16 v[216:219],v[76:79],a[184:187],v[216:219]
v_mfma_f32_16x16x32_bf16 v[220:223],v[76:79],a[188:191],v[220:223]
v_mfma_f32_16x16x32_bf16 v[192:195],v[80:83],a[192:195],v[192:195]
v_mfma_f32_16x16x32_bf16 v[196:199],v[80:83],a[196:199],v[196:199]
v_mfma_f32_16x16x32_bf16 v[200:203],v[80:83],a[200:203],v[200:203]
v_mfma_f32_16x16x32_bf16 v[204:207],v[80:83],a[204:207],v[204:207]
v_mfma_f32_16x16x32_bf16 v[208:211],v[80:83],a[208:211],v[208:211]
v_mfma_f32_16x16x32_bf16 v[212:215],v[80:83],a[212:215],v[212:215]
v_mfma_f32_16x16x32_bf16 v[216:219],v[80:83],a[216:219],v[216:219]
v_mfma_f32_16x16x32_bf16 v[220:223],v[80:83],a[220:223],v[220:223]
v_mfma_f32_16x16x32_bf16 v[192:195],v[84:87],a[224:227],v[192:195]
v_mfma_f32_16x16x32_bf16 v[196:199],v[84:87],a[228:231],v[196:199]
v_mfma_f32_16x16x32_bf16 v[200:203],v[84:87],a[232:235],v[200:203]
v_mfma_f32_16x16x32_bf16 v[204:207],v[84:87],a[236:239],v[204:207]
v_mfma_f32_16x16x32_bf16 v[208:211],v[84:87],a[240:243],v[208:211]
v_mfma_f32_16x16x32_bf16 v[212:215],v[84:87],a[244:247],v[212:215]
v_mfma_f32_16x16x32_bf16 v[216:219],v[84:87],a[248:251],v[216:219]
v_mfma_f32_16x16x32_bf16 v[220:223],v[84:87],a[252:255],v[220:223]
v_cvt_pk_bf16_f32 v104,v192,v196
v_cvt_pk_bf16_f32 v105,v200,v204
v_cvt_pk_bf16_f32 v106,v208,v212
s_nop 4
v_cvt_pk_bf16_f32 v107,v216,v220
s_add_u32 s62,s61,262144
buffer_store_dwordx4 v[104:107],v5,s[8:11],s62 offen sc1
v_cvt_pk_bf16_f32 v108,v193,v197
v_cvt_pk_bf16_f32 v109,v201,v205
v_cvt_pk_bf16_f32 v110,v209,v213
v_cvt_pk_bf16_f32 v111,v217,v221
s_add_u32 s62,s61,278528
buffer_store_dwordx4 v[108:111],v5,s[8:11],s62 offen sc1
v_cvt_pk_bf16_f32 v112,v194,v198
v_cvt_pk_bf16_f32 v113,v202,v206
v_cvt_pk_bf16_f32 v114,v210,v214
v_cvt_pk_bf16_f32 v115,v218,v222
s_add_u32 s62,s61,294912
buffer_store_dwordx4 v[112:115],v5,s[8:11],s62 offen sc1
v_cvt_pk_bf16_f32 v116,v195,v199
v_cvt_pk_bf16_f32 v117,v203,v207
v_cvt_pk_bf16_f32 v118,v211,v215
v_cvt_pk_bf16_f32 v119,v219,v223
s_add_u32 s62,s61,311296
buffer_store_dwordx4 v[116:119],v5,s[8:11],s62 offen sc1
s_cmp_lg_u32 s72,0
s_cbranch_scc1 L_aa_225
s_waitcnt vmcnt(5)
s_barrier
s_cmp_eq_u32 s30,0
s_cbranch_scc1 L_aa_224
s_xor_b32 s67,s67,65536
s_and_b32 s56,s50,2048
s_lshl_b32 s56,s56,4
s_add_u32 s56,s56,s67
v_add_u32 v2,s56,v0
s_and_b32 s56,s50,1024
s_lshl_b32 s56,s56,2
v_add_u32 v238,s56,v2
s_mov_b32 s76,s71
s_mov_b32 s53,s77
ds_read_b128 v[24:27],v238 offset:16384
ds_read_b128 v[40:43],v2 offset:0
ds_read_b128 v[56:59],v2 offset:4096
ds_read_b128 v[28:31],v238 offset:17408
ds_read_b128 v[44:47],v2 offset:1024
ds_read_b128 v[60:63],v2 offset:5120
ds_read_b128 v[32:35],v238 offset:18432
ds_read_b128 v[48:51],v2 offset:2048
ds_read_b128 v[64:67],v2 offset:6144
ds_read_b128 v[36:39],v238 offset:19456
ds_read_b128 v[52:55],v2 offset:3072
ds_read_b128 v[68:71],v2 offset:7168
s_waitcnt lgkmcnt(9)
v_mfma_f32_16x16x32_bf16 v[128:131],v[40:43],v[24:27],v[8:11]
ds_read_b128 v[72:75],v2 offset:24576
v_mfma_f32_16x16x32_bf16 v[132:135],v[56:59],v[24:27],v[12:15]
ds_read_b128 v[76:79],v2 offset:25600
s_waitcnt lgkmcnt(8)
v_mfma_f32_16x16x32_bf16 v[128:131],v[44:47],v[28:31],v[128:131]
ds_read_b128 v[80:83],v2 offset:26624
v_mfma_f32_16x16x32_bf16 v[132:135],v[60:63],v[28:31],v[132:135]
ds_read_b128 v[84:87],v2 offset:27648
s_waitcnt lgkmcnt(7)
v_mfma_f32_16x16x32_bf16 v[128:131],v[48:51],v[32:35],v[128:131]
ds_read_b128 v[88:91],v2 offset:8192
v_mfma_f32_16x16x32_bf16 v[132:135],v[64:67],v[32:35],v[132:135]
ds_read_b128 v[92:95],v2 offset:9216
s_waitcnt lgkmcnt(6)
v_mfma_f32_16x16x32_bf16 v[128:131],v[52:55],v[36:39],v[128:131]
ds_read_b128 v[96:99],v2 offset:10240
v_mfma_f32_16x16x32_bf16 v[132:135],v[68:71],v[36:39],v[132:135]
ds_read_b128 v[100:103],v2 offset:11264
s_waitcnt lgkmcnt(4)
v_mfma_f32_16x16x32_bf16 v[136:139],v[72:75],v[24:27],0
ds_read_b128 v[104:107],v2 offset:12288
ds_read_b128 v[108:111],v2 offset:13312
v_mfma_f32_16x16x32_bf16 v[136:139],v[76:79],v[28:31],v[136:139]
ds_read_b128 v[112:115],v2 offset:14336
ds_read_b128 v[116:119],v2 offset:15360
v_mfma_f32_16x16x32_bf16 v[136:139],v[80:83],v[32:35],v[136:139]
ds_read_b64 v[120:121],v2 offset:28672
ds_read_b64 v[122:123],v2 offset:29696
v_mfma_f32_16x16x32_bf16 v[136:139],v[84:87],v[36:39],v[136:139]
ds_read_b64 v[124:125],v2 offset:30720
ds_read_b64 v[126:127],v2 offset:31744
s_add_u32 s66,s66,1
v_mov_b32 v22,s66
s_waitcnt vmcnt(0)
s_barrier
buffer_store_dword v22,off,s[8:11],s74 sc1
s_cmp_lg_u32 s86,1536
s_cbranch_scc1 L_ae_238
s_add_u32 s77,s53,12
s_mov_b32 s30,0
s_lshl_b32 s56,s77,5
s_add_u32 s56,s56,s68
s_mul_i32 s70,s56,24576
s_lshl_b32 s71,s56,13
s_add_u32 s70,s70,100663296
s_add_u32 s71,s71,41943040
s_lshl_b32 s59,s77,13
s_lshl2_add_u32 s59,s68,s59
s_add_u32 s59,s59,10485760
v_mov_b32 v19,s59
buffer_load_dword v18,v19,s[8:11],0 offen sc1
s_branch L_af_239
L_ae_238:
s_ff1_i32_b64 s77,s[84:85]
s_bitset0_b64 s[84:85],s77
s_ff1_i32_b64 s77,s[84:85]
s_bitset0_b64 s[84:85],s77
s_ff1_i32_b64 s77,s[84:85]
s_bitset0_b64 s[84:85],s77
s_ff1_i32_b64 s77,s[84:85]
s_bitset0_b64 s[84:85],s77
s_ff1_i32_b64 s77,s[84:85]
s_bitset0_b64 s[84:85],s77
s_ff1_i32_b64 s77,s[84:85]
s_bitset0_b64 s[84:85],s77
s_min_u32 s77,s77,64
s_lshr_b32 s61,s55,5
s_lshl_b32 s56,s77,5
s_add_u32 s56,s56,s68
s_mul_i32 s70,s56,24576
s_lshl_b32 s71,s56,13
s_lshl_b32 s59,s77,13
s_lshl2_add_u32 s59,s68,s59
s_add_u32 s59,s59,10485760
s_cmp_lt_u32 s77,s61
s_cselect_b32 s57,0,16777216
s_cselect_b32 s60,0,128
s_add_u32 s71,s71,s57
s_add_u32 s71,s71,58720256
s_add_u32 s60,s60,s59
s_add_u32 s60,s60,512
s_cmp_eq_u32 s77,s61
s_cselect_b32 s57,50331648,0
s_cselect_b32 s58,1536,0
s_add_u32 s70,s70,s57
s_add_u32 s70,s70,150994944
s_add_u32 s59,s59,s58
s_add_u32 s59,s59,384
v_mov_b32 v19,s59
v_writelane_b32 v19,s60,1
buffer_load_dword v18,v19,s[8:11],0 offen sc1
L_af_239:
v_max3_f32 v238,v128,v129,v130
v_max3_f32 v239,v131,v132,v133
v_max3_f32 v238,v134,v135,v238
v_max3_f32 v239,v138,v139,v239
v_max_f32 v238,v238,v239
v_max_f32 v239,v238,v239
s_nop 1
v_permlane16_swap_b32 v238,v239
v_max_f32 v238,v238,v239
v_max_f32 v239,v238,v239
s_nop 1
v_permlane32_swap_b32 v238,v239
v_max_f32 v238,v238,v239
v_mul_f32 v238,s80,v238
v_fma_f32 v128,v128,s80,-v238
v_fma_f32 v129,v129,s80,-v238
v_exp_f32 v128,v128
v_fma_f32 v130,v130,s80,-v238
v_exp_f32 v129,v129
v_fma_f32 v131,v131,s80,-v238
v_exp_f32 v130,v130
v_fma_f32 v132,v132,s80,-v238
v_exp_f32 v131,v131
v_fma_f32 v133,v133,s80,-v238
v_exp_f32 v132,v132
v_fma_f32 v134,v134,s80,-v238
v_exp_f32 v133,v133
v_fma_f32 v135,v135,s80,-v238
v_exp_f32 v134,v134
v_fma_f32 v138,v138,s80,-v238
v_exp_f32 v135,v135
v_fma_f32 v139,v139,s80,-v238
v_exp_f32 v138,v138
v_exp_f32 v139,v139
v_cvt_pk_bf16_f32 v140,v128,v129
v_cvt_pk_bf16_f32 v141,v130,v131
v_cvt_pk_bf16_f32 v142,v132,v133
v_cvt_pk_bf16_f32 v143,v134,v135
v_cvt_pk_bf16_f32 v144,v138,v139
v_mov_b32 v147,v144
s_waitcnt lgkmcnt(0)
v_mfma_f32_16x16x32_bf16 v[148:151],v[152:155],v[140:143],0
v_mfma_f32_16x16x32_bf16 v[24:27],v[88:91],v[140:143],0
v_mfma_f32_16x16x32_bf16 v[28:31],v[92:95],v[140:143],0
v_mfma_f32_16x16x16_bf16 v[148:151],v[152:153],v[144:145],v[148:151]
v_mfma_f32_16x16x32_bf16 v[32:35],v[96:99],v[140:143],0
v_mfma_f32_16x16x32_bf16 v[36:39],v[100:103],v[140:143],0
v_mfma_f32_16x16x32_bf16 v[40:43],v[104:107],v[140:143],0
v_mfma_f32_16x16x32_bf16 v[44:47],v[108:111],v[140:143],0
v_mfma_f32_16x16x32_bf16 v[48:51],v[112:115],v[140:143],0
v_mfma_f32_16x16x32_bf16 v[52:55],v[116:119],v[140:143],0
v_rcp_f32 v148,v148
v_mfma_f32_16x16x16_bf16 v[24:27],v[120:121],v[144:145],v[24:27]
v_mfma_f32_16x16x16_bf16 v[28:31],v[120:121],v[146:147],v[28:31]
v_mfma_f32_16x16x16_bf16 v[32:35],v[122:123],v[144:145],v[32:35]
v_mfma_f32_16x16x16_bf16 v[36:39],v[122:123],v[146:147],v[36:39]
v_mfma_f32_16x16x16_bf16 v[40:43],v[124:125],v[144:145],v[40:43]
v_pk_mul_f32 v[24:25],v[24:25],v[148:149] op_sel_hi:[1,0]
v_pk_mul_f32 v[26:27],v[26:27],v[148:149] op_sel_hi:[1,0]
v_mfma_f32_16x16x16_bf16 v[44:47],v[124:125],v[146:147],v[44:47]
v_pk_mul_f32 v[28:29],v[28:29],v[148:149] op_sel_hi:[1,0]
v_pk_mul_f32 v[30:31],v[30:31],v[148:149] op_sel_hi:[1,0]
v_mfma_f32_16x16x16_bf16 v[48:51],v[126:127],v[144:145],v[48:51]
v_cvt_pk_bf16_f32 v72,v24,v28
v_cvt_pk_bf16_f32 v73,v25,v29
v_mfma_f32_16x16x16_bf16 v[52:55],v[126:127],v[146:147],v[52:55]
v_cvt_pk_bf16_f32 v74,v26,v30
v_cvt_pk_bf16_f32 v75,v27,v31
ds_write_b128 v3,v[72:75] offset:0
v_pk_mul_f32 v[32:33],v[32:33],v[148:149] op_sel_hi:[1,0]
v_pk_mul_f32 v[34:35],v[34:35],v[148:149] op_sel_hi:[1,0]
v_pk_mul_f32 v[36:37],v[36:37],v[148:149] op_sel_hi:[1,0]
v_pk_mul_f32 v[38:39],v[38:39],v[148:149] op_sel_hi:[1,0]
v_cvt_pk_bf16_f32 v76,v32,v36
v_cvt_pk_bf16_f32 v77,v33,v37
v_cvt_pk_bf16_f32 v78,v34,v38
v_cvt_pk_bf16_f32 v79,v35,v39
ds_write_b128 v3,v[76:79] offset:1024
v_pk_mul_f32 v[40:41],v[40:41],v[148:149] op_sel_hi:[1,0]
v_pk_mul_f32 v[42:43],v[42:43],v[148:149] op_sel_hi:[1,0]
v_pk_mul_f32 v[44:45],v[44:45],v[148:149] op_sel_hi:[1,0]
v_pk_mul_f32 v[46:47],v[46:47],v[148:149] op_sel_hi:[1,0]
v_cvt_pk_bf16_f32 v80,v40,v44
v_cvt_pk_bf16_f32 v81,v41,v45
v_cvt_pk_bf16_f32 v82,v42,v46
v_cvt_pk_bf16_f32 v83,v43,v47
ds_write_b128 v3,v[80:83] offset:2048
v_pk_mul_f32 v[48:49],v[48:49],v[148:149] op_sel_hi:[1,0]
v_pk_mul_f32 v[50:51],v[50:51],v[148:149] op_sel_hi:[1,0]
v_pk_mul_f32 v[52:53],v[52:53],v[148:149] op_sel_hi:[1,0]
v_pk_mul_f32 v[54:55],v[54:55],v[148:149] op_sel_hi:[1,0]
v_cvt_pk_bf16_f32 v84,v48,v52
v_cvt_pk_bf16_f32 v85,v49,v53
v_cvt_pk_bf16_f32 v86,v50,v54
v_cvt_pk_bf16_f32 v87,v51,v55
ds_write_b128 v3,v[84:87] offset:3072
s_lshr_b32 s60,s68,1
s_lshl_b32 s60,s60,15
s_add_u32 s60,s60,s69
L_aq_240:
buffer_load_dword v17,v16,s[8:11],s87 offen sc1
s_sub_u32 s49,s49,1
s_cbranch_scc1 L_abort2
s_waitcnt vmcnt(0)
v_cmp_gt_u32 vcc,s66,v17
s_cbranch_vccnz L_aq_240
buffer_load_dwordx4 v[160:163],v7,s[8:11],s60 offen sc1
s_add_u32 s60,s60,4096
buffer_load_dwordx4 v[164:167],v7,s[8:11],s60 offen sc1
s_add_u32 s60,s60,4096
buffer_load_dwordx4 v[168:171],v7,s[8:11],s60 offen sc1
s_add_u32 s60,s60,4096
buffer_load_dwordx4 v[172:175],v7,s[8:11],s60 offen sc1
s_add_u32 s60,s60,4096
buffer_load_dwordx4 v[176:179],v7,s[8:11],s60 offen sc1
s_add_u32 s60,s60,4096
buffer_load_dwordx4 v[180:183],v7,s[8:11],s60 offen sc1
s_add_u32 s60,s60,4096
buffer_load_dwordx4 v[184:187],v7,s[8:11],s60 offen sc1
s_add_u32 s60,s60,4096
buffer_load_dwordx4 v[188:191],v7,s[8:11],s60 offen sc1
v_cmp_eq_u32 vcc,0,v18
s_lshl_b32 s56,s46,2
s_add_u32 s56,s56,155648
v_mov_b32 v238,s56
s_cmp_lg_u64 vcc,0
s_cselect_b32 s72,1,0
s_cmp_ge_u32 s77,64
s_cselect_b32 s72,1,s72
v_mov_b32 v239,s72
ds_write_b32 v238,v239
v_lshlrev_b32 v200,16,v224
v_and_b32 v201,0xffff0000,v224
v_lshlrev_b32 v202,16,v225
v_and_b32 v203,0xffff0000,v225
v_lshlrev_b32 v204,16,v226
v_and_b32 v205,0xffff0000,v226
v_lshlrev_b32 v206,16,v227
v_and_b32 v207,0xffff0000,v227
s_add_u32 s59,s74,128
s_waitcnt vmcnt(7)
v_mfma_f32_16x16x32_bf16 v[192:195],v[156:159],v[160:163],0
s_waitcnt vmcnt(6)
v_mfma_f32_16x16x32_bf16 v[192:195],v[156:159],v[164:167],v[192:195]
s_waitcnt vmcnt(5)
v_mfma_f32_16x16x32_bf16 v[192:195],v[156:159],v[168:171],v[192:195]
s_waitcnt vmcnt(4)
v_mfma_f32_16x16x32_bf16 v[192:195],v[156:159],v[172:175],v[192:195]
s_waitcnt vmcnt(3)
v_mfma_f32_16x16x32_bf16 v[196:199],v[156:159],v[176:179],0
s_waitcnt vmcnt(2)
v_mfma_f32_16x16x32_bf16 v[196:199],v[156:159],v[180:183],v[196:199]
s_waitcnt vmcnt(1)
v_mfma_f32_16x16x32_bf16 v[196:199],v[156:159],v[184:187],v[196:199]
ds_write_b128 v6,v[192:195]
s_waitcnt vmcnt(0)
v_mfma_f32_16x16x32_bf16 v[196:199],v[156:159],v[188:191],v[196:199]
s_nop 7
ds_write_b128 v6,v[196:199] offset:2048
s_waitcnt lgkmcnt(0)
s_barrier
buffer_store_dword v22,off,s[8:11],s59 sc1
s_mov_b32 s88,1
s_branch L_aa_226
L_aa_224:
s_xor_b32 s67,s67,65536
s_and_b32 s56,s50,2048
s_lshl_b32 s56,s56,4
s_add_u32 s56,s56,s67
v_add_u32 v2,s56,v0
s_and_b32 s56,s50,1024
s_lshl_b32 s56,s56,2
v_add_u32 v238,s56,v2
s_mov_b32 s76,s71
s_mov_b32 s53,s77
ds_read_b128 v[24:27],v238 offset:16384
ds_read_b128 v[40:43],v2 offset:0
ds_read_b128 v[56:59],v2 offset:4096
ds_read_b128 v[28:31],v238 offset:17408
ds_read_b128 v[44:47],v2 offset:1024
ds_read_b128 v[60:63],v2 offset:5120
ds_read_b128 v[32:35],v238 offset:18432
ds_read_b128 v[48:51],v2 offset:2048
ds_read_b128 v[64:67],v2 offset:6144
ds_read_b128 v[36:39],v238 offset:19456
ds_read_b128 v[52:55],v2 offset:3072
ds_read_b128 v[68:71],v2 offset:7168
s_waitcnt lgkmcnt(9)
v_mfma_f32_16x16x32_bf16 v[128:131],v[40:43],v[24:27],v[8:11]
ds_read_b128 v[88:91],v2 offset:8192
v_mfma_f32_16x16x32_bf16 v[132:135],v[56:59],v[24:27],v[12:15]
ds_read_b128 v[92:95],v2 offset:9216
s_waitcnt lgkmcnt(8)
v_mfma_f32_16x16x32_bf16 v[128:131],v[44:47],v[28:31],v[128:131]
ds_read_b128 v[96:99],v2 offset:10240
v_mfma_f32_16x16x32_bf16 v[132:135],v[60:63],v[28:31],v[132:135]
ds_read_b128 v[100:103],v2 offset:11264
s_waitcnt lgkmcnt(7)
v_mfma_f32_16x16x32_bf16 v[128:131],v[48:51],v[32:35],v[128:131]
ds_read_b128 v[104:107],v2 offset:12288
v_mfma_f32_16x16x32_bf16 v[132:135],v[64:67],v[32:35],v[132:135]
ds_read_b128 v[108:111],v2 offset:13312
s_waitcnt lgkmcnt(6)
v_mfma_f32_16x16x32_bf16 v[128:131],v[52:55],v[36:39],v[128:131]
ds_read_b128 v[112:115],v2 offset:14336
v_mfma_f32_16x16x32_bf16 v[132:135],v[68:71],v[36:39],v[132:135]
ds_read_b128 v[116:119],v2 offset:15360
s_add_u32 s66,s66,1
v_mov_b32 v22,s66
s_waitcnt vmcnt(0)
s_barrier
buffer_store_dword v22,off,s[8:11],s74 sc1
s_lshr_b32 s60,s68,1
s_lshl_b32 s60,s60,15
s_add_u32 s60,s60,s69
L_aq_241:
buffer_load_dword v17,v16,s[8:11],s87 offen sc1
s_sub_u32 s49,s49,1
s_cbranch_scc1 L_abort2
s_waitcnt vmcnt(0)
v_cmp_gt_u32 vcc,s66,v17
s_cbranch_vccnz L_aq_241
buffer_load_dwordx4 v[160:163],v7,s[8:11],s60 offen sc1
s_add_u32 s60,s60,4096
buffer_load_dwordx4 v[164:167],v7,s[8:11],s60 offen sc1
s_add_u32 s60,s60,4096
buffer_load_dwordx4 v[168:171],v7,s[8:11],s60 offen sc1
s_add_u32 s60,s60,4096
buffer_load_dwordx4 v[172:175],v7,s[8:11],s60 offen sc1
s_add_u32 s60,s60,4096
buffer_load_dwordx4 v[176:179],v7,s[8:11],s60 offen sc1
s_add_u32 s60,s60,4096
buffer_load_dwordx4 v[180:183],v7,s[8:11],s60 offen sc1
s_add_u32 s60,s60,4096
buffer_load_dwordx4 v[184:187],v7,s[8:11],s60 offen sc1
s_add_u32 s60,s60,4096
buffer_load_dwordx4 v[188:191],v7,s[8:11],s60 offen sc1
s_add_u32 s62,s76,4096
buffer_load_dwordx4 v[72:75],v0,s[8:11],s76 offen offset:0 sc1
buffer_load_dwordx4 v[76:79],v0,s[8:11],s76 offen offset:1024 sc1
buffer_load_dwordx4 v[80:83],v0,s[8:11],s76 offen offset:2048 sc1
buffer_load_dwordx4 v[84:87],v0,s[8:11],s76 offen offset:3072 sc1
buffer_load_dwordx2 v[120:121],v0,s[8:11],s62 offen offset:0 sc1
buffer_load_dwordx2 v[122:123],v0,s[8:11],s62 offen offset:1024 sc1
buffer_load_dwordx2 v[124:125],v0,s[8:11],s62 offen offset:2048 sc1
buffer_load_dwordx2 v[126:127],v0,s[8:11],s62 offen offset:3072 sc1
v_lshrrev_b32 v244,4,v1
s_sub_u32 s56,s53,7
v_add_u32 v244,s56,v244
v_max_i32 v244,0,v244
v_lshl_add_u32 v244,v244,13,v21
buffer_load_dwordx2 v[242:243],v244,s[8:11],0 offen sc1
v_lshlrev_b32 v200,16,v224
v_and_b32 v201,0xffff0000,v224
v_lshlrev_b32 v202,16,v225
v_and_b32 v203,0xffff0000,v225
v_lshlrev_b32 v204,16,v226
v_and_b32 v205,0xffff0000,v226
v_lshlrev_b32 v206,16,v227
v_and_b32 v207,0xffff0000,v227
s_add_u32 s59,s74,128
s_waitcnt vmcnt(16)
v_mfma_f32_16x16x32_bf16 v[192:195],v[156:159],v[160:163],0
s_waitcnt vmcnt(15)
v_mfma_f32_16x16x32_bf16 v[192:195],v[156:159],v[164:167],v[192:195]
s_waitcnt vmcnt(14)
v_mfma_f32_16x16x32_bf16 v[192:195],v[156:159],v[168:171],v[192:195]
s_waitcnt vmcnt(13)
v_mfma_f32_16x16x32_bf16 v[192:195],v[156:159],v[172:175],v[192:195]
s_waitcnt vmcnt(12)
v_mfma_f32_16x16x32_bf16 v[196:199],v[156:159],v[176:179],0
s_waitcnt vmcnt(11)
v_mfma_f32_16x16x32_bf16 v[196:199],v[156:159],v[180:183],v[196:199]
s_waitcnt vmcnt(10)
v_mfma_f32_16x16x32_bf16 v[196:199],v[156:159],v[184:187],v[196:199]
ds_write_b128 v6,v[192:195]
s_waitcnt vmcnt(9)
v_mfma_f32_16x16x32_bf16 v[196:199],v[156:159],v[188:191],v[196:199]
s_nop 7
ds_write_b128 v6,v[196:199] offset:2048
s_waitcnt lgkmcnt(0)
s_barrier
buffer_store_dword v22,off,s[8:11],s59 sc1
s_mov_b32 s88,0
s_branch L_aa_226
L_aa_225:
s_add_u32 s66,s66,1
v_mov_b32 v22,s66
s_waitcnt vmcnt(0)
s_barrier
buffer_store_dword v22,off,s[8:11],s74 sc1
s_lshr_b32 s60,s68,1
s_lshl_b32 s60,s60,15
s_add_u32 s60,s60,s69
L_aq_242:
buffer_load_dword v17,v16,s[8:11],s87 offen sc1
s_sub_u32 s49,s49,1
s_cbranch_scc1 L_abort2
s_waitcnt vmcnt(0)
v_cmp_gt_u32 vcc,s66,v17
s_cbranch_vccnz L_aq_242
buffer_load_dwordx4 v[160:163],v7,s[8:11],s60 offen sc1
s_add_u32 s60,s60,4096
buffer_load_dwordx4 v[164:167],v7,s[8:11],s60 offen sc1
s_add_u32 s60,s60,4096
buffer_load_dwordx4 v[168:171],v7,s[8:11],s60 offen sc1
s_add_u32 s60,s60,4096
buffer_load_dwordx4 v[172:175],v7,s[8:11],s60 offen sc1
s_add_u32 s60,s60,4096
buffer_load_dwordx4 v[176:179],v7,s[8:11],s60 offen sc1
s_add_u32 s60,s60,4096
buffer_load_dwordx4 v[180:183],v7,s[8:11],s60 offen sc1
s_add_u32 s60,s60,4096
buffer_load_dwordx4 v[184:187],v7,s[8:11],s60 offen sc1
s_add_u32 s60,s60,4096
buffer_load_dwordx4 v[188:191],v7,s[8:11],s60 offen sc1
v_lshlrev_b32 v200,16,v224
v_and_b32 v201,0xffff0000,v224
v_lshlrev_b32 v202,16,v225
v_and_b32 v203,0xffff0000,v225
v_lshlrev_b32 v204,16,v226
v_and_b32 v205,0xffff0000,v226
v_lshlrev_b32 v206,16,v227
v_and_b32 v207,0xffff0000,v227
s_add_u32 s59,s74,128
s_waitcnt vmcnt(7)
v_mfma_f32_16x16x32_bf16 v[192:195],v[156:159],v[160:163],0
s_waitcnt vmcnt(6)
v_mfma_f32_16x16x32_bf16 v[192:195],v[156:159],v[164:167],v[192:195]
s_waitcnt vmcnt(5)
v_mfma_f32_16x16x32_bf16 v[192:195],v[156:159],v[168:171],v[192:195]
s_waitcnt vmcnt(4)
v_mfma_f32_16x16x32_bf16 v[192:195],v[156:159],v[172:175],v[192:195]
s_waitcnt vmcnt(3)
v_mfma_f32_16x16x32_bf16 v[196:199],v[156:159],v[176:179],0
s_waitcnt vmcnt(2)
v_mfma_f32_16x16x32_bf16 v[196:199],v[156:159],v[180:183],v[196:199]
s_waitcnt vmcnt(1)
v_mfma_f32_16x16x32_bf16 v[196:199],v[156:159],v[184:187],v[196:199]
ds_write_b128 v6,v[192:195]
s_waitcnt vmcnt(0)
v_mfma_f32_16x16x32_bf16 v[196:199],v[156:159],v[188:191],v[196:199]
s_nop 7
ds_write_b128 v6,v[196:199] offset:2048
s_waitcnt lgkmcnt(0)
s_barrier
buffer_store_dword v22,off,s[8:11],s59 sc1
s_mov_b32 s88,2
L_aa_226:
s_cmp_lg_u32 s31,0
s_cbranch_scc1 L_aa_227
ds_read_b128 v[160:163],v23
ds_read_b128 v[164:167],v23 offset:16
s_lshl_b32 s64,s51,5
s_add_u32 s64,s64,s68
s_lshl_b32 s63,s64,10
s_add_u32 s58,s63,4194304
s_lshl_b32 s57,s46,31
s_xor_b32 s57,s57,0x80000000
s_or_b32 s58,s58,s57
s_waitcnt lgkmcnt(0)
v_cvt_pk_bf16_f32 v168,v160,v161
v_cvt_pk_bf16_f32 v169,v162,v163
v_cvt_pk_bf16_f32 v170,v164,v165
v_cvt_pk_bf16_f32 v171,v166,v167
v_lshlrev_b32 v160,16,v168
v_and_b32 v161,0xffff0000,v168
v_lshlrev_b32 v162,16,v169
v_and_b32 v163,0xffff0000,v169
v_lshlrev_b32 v164,16,v170
v_and_b32 v165,0xffff0000,v170
v_lshlrev_b32 v166,16,v171
v_and_b32 v167,0xffff0000,v171
v_pk_add_f32 v[200:201],v[200:201],v[160:161]
v_pk_add_f32 v[202:203],v[202:203],v[162:163]
v_pk_add_f32 v[204:205],v[204:205],v[164:165]
v_pk_add_f32 v[206:207],v[206:207],v[166:167]
v_cvt_pk_bf16_f32 v168,v200,v201
v_cvt_pk_bf16_f32 v169,v202,v203
v_cvt_pk_bf16_f32 v170,v204,v205
v_cvt_pk_bf16_f32 v171,v206,v207
buffer_store_dwordx4 v[168:171],v0,s[8:11],s58 offen sc1
v_lshlrev_b32 v200,16,v168
v_and_b32 v201,0xffff0000,v168
v_lshlrev_b32 v202,16,v169
v_and_b32 v203,0xffff0000,v169
v_lshlrev_b32 v204,16,v170
v_and_b32 v205,0xffff0000,v170
v_lshlrev_b32 v206,16,v171
v_and_b32 v207,0xffff0000,v171
v_readfirstlane_b32 s78,v200
s_nop 1
v_pk_add_f32 v[184:185],v[200:201],s[78:79] op_sel_hi:[1,0] neg_lo:[0,1] neg_hi:[0,1]
v_pk_add_f32 v[186:187],v[202:203],s[78:79] op_sel_hi:[1,0] neg_lo:[0,1] neg_hi:[0,1]
v_pk_add_f32 v[188:189],v[204:205],s[78:79] op_sel_hi:[1,0] neg_lo:[0,1] neg_hi:[0,1]
v_pk_add_f32 v[190:191],v[206:207],s[78:79] op_sel_hi:[1,0] neg_lo:[0,1] neg_hi:[0,1]
v_pk_add_f32 v[192:193],v[184:185],v[186:187]
v_pk_mul_f32 v[194:195],v[184:185],v[184:185]
v_pk_add_f32 v[196:197],v[188:189],v[190:191]
v_pk_fma_f32 v[194:195],v[186:187],v[186:187],v[194:195]
v_pk_add_f32 v[192:193],v[192:193],v[196:197]
v_pk_fma_f32 v[194:195],v[188:189],v[188:189],v[194:195]
v_add_f32 v192,v192,v193
v_pk_fma_f32 v[194:195],v[190:191],v[190:191],v[194:195]
v_add_f32 v194,v194,v195
s_nop 1
v_permlane32_swap_b32 v192,v194
v_add_f32 v192,v192,v194
s_nop 1
v_add_f32_dpp v192,v192,v192 row_ror:8 row_mask:0xf bank_mask:0xf
s_nop 1
v_add_f32_dpp v192,v192,v192 row_ror:4 row_mask:0xf bank_mask:0xf
s_nop 1
v_add_f32_dpp v192,v192,v192 row_ror:2 row_mask:0xf bank_mask:0xf
s_nop 1
v_add_f32_dpp v192,v192,v192 row_ror:1 row_mask:0xf bank_mask:0xf
v_mov_b32 v194,v192
s_nop 1
v_permlane16_swap_b32 v192,v194
v_add_f32 v192,v192,v194
v_mul_f32 v192,0x3b000000,v192
v_mov_b32 v194,v192
s_nop 1
v_permlane32_swap_b32 v192,v194
v_fma_f32 v194,-v192,v192,v194
v_add_f32 v192,s78,v192
v_max_f32 v194,0,v194
v_cvt_pk_bf16_f32 v194,v192,v194
v_lshlrev_b32 v192,16,v194
v_and_b32 v194,0xffff0000,v194
v_add_f32 v194,0x3727c5ac,v194
v_cvt_pk_bf16_f32 v194,v194,v194
v_and_b32 v194,0xffff0000,v194
v_sqrt_f32 v194,v194
v_pk_add_f32 v[184:185],v[200:201],v[192:193] op_sel_hi:[1,0] neg_lo:[0,1] neg_hi:[0,1]
v_pk_add_f32 v[186:187],v[202:203],v[192:193] op_sel_hi:[1,0] neg_lo:[0,1] neg_hi:[0,1]
v_pk_add_f32 v[188:189],v[204:205],v[192:193] op_sel_hi:[1,0] neg_lo:[0,1] neg_hi:[0,1]
v_pk_add_f32 v[190:191],v[206:207],v[192:193] op_sel_hi:[1,0] neg_lo:[0,1] neg_hi:[0,1]
v_cvt_pk_bf16_f32 v194,v194,v194
v_and_b32 v194,0xffff0000,v194
v_rcp_f32 v194,v194
v_cvt_pk_bf16_f32 v172,v184,v185
v_cvt_pk_bf16_f32 v173,v186,v187
v_cvt_pk_bf16_f32 v174,v188,v189
v_cvt_pk_bf16_f32 v175,v190,v191
v_lshlrev_b32 v184,16,v172
v_and_b32 v185,0xffff0000,v172
v_lshlrev_b32 v186,16,v173
v_and_b32 v187,0xffff0000,v173
v_lshlrev_b32 v188,16,v174
v_and_b32 v189,0xffff0000,v174
v_lshlrev_b32 v190,16,v175
v_and_b32 v191,0xffff0000,v175
v_pk_mul_f32 v[184:185],v[184:185],v[194:195] op_sel_hi:[1,0]
v_pk_mul_f32 v[186:187],v[186:187],v[194:195] op_sel_hi:[1,0]
v_pk_mul_f32 v[188:189],v[188:189],v[194:195] op_sel_hi:[1,0]
v_pk_mul_f32 v[190:191],v[190:191],v[194:195] op_sel_hi:[1,0]
v_cvt_pk_bf16_f32 v172,v184,v185
v_cvt_pk_bf16_f32 v173,v186,v187
v_cvt_pk_bf16_f32 v174,v188,v189
v_cvt_pk_bf16_f32 v175,v190,v191
v_lshlrev_b32 v176,16,v172
v_and_b32 v177,0xffff0000,v172
v_lshlrev_b32 v178,16,v173
v_and_b32 v179,0xffff0000,v173
v_lshlrev_b32 v180,16,v174
v_and_b32 v181,0xffff0000,v174
v_lshlrev_b32 v182,16,v175
v_and_b32 v183,0xffff0000,v175
s_bitcmp1_b32 s46,0
s_cbranch_scc1 L_ak_243
v_pk_add_f32 v[200:201],v[200:201],v[176:177]
v_pk_add_f32 v[202:203],v[202:203],v[178:179]
v_pk_add_f32 v[204:205],v[204:205],v[180:181]
v_pk_add_f32 v[206:207],v[206:207],v[182:183]
v_cvt_pk_bf16_f32 v160,v200,v201
v_cvt_pk_bf16_f32 v161,v202,v203
v_cvt_pk_bf16_f32 v162,v204,v205
v_cvt_pk_bf16_f32 v163,v206,v207
s_add_u32 s58,s63,8388608
buffer_store_dwordx4 v[160:163],v0,s[8:11],s58 offen sc1
v_lshlrev_b32 v200,16,v160
v_and_b32 v201,0xffff0000,v160
v_lshlrev_b32 v202,16,v161
v_and_b32 v203,0xffff0000,v161
v_lshlrev_b32 v204,16,v162
v_and_b32 v205,0xffff0000,v162
v_lshlrev_b32 v206,16,v163
v_and_b32 v207,0xffff0000,v163
v_readfirstlane_b32 s78,v200
s_nop 1
v_pk_add_f32 v[184:185],v[200:201],s[78:79] op_sel_hi:[1,0] neg_lo:[0,1] neg_hi:[0,1]
v_pk_add_f32 v[186:187],v[202:203],s[78:79] op_sel_hi:[1,0] neg_lo:[0,1] neg_hi:[0,1]
v_pk_add_f32 v[188:189],v[204:205],s[78:79] op_sel_hi:[1,0] neg_lo:[0,1] neg_hi:[0,1]
v_pk_add_f32 v[190:191],v[206:207],s[78:79] op_sel_hi:[1,0] neg_lo:[0,1] neg_hi:[0,1]
v_pk_add_f32 v[192:193],v[184:185],v[186:187]
v_pk_mul_f32 v[194:195],v[184:185],v[184:185]
v_pk_add_f32 v[196:197],v[188:189],v[190:191]
v_pk_fma_f32 v[194:195],v[186:187],v[186:187],v[194:195]
v_pk_add_f32 v[192:193],v[192:193],v[196:197]
v_pk_fma_f32 v[194:195],v[188:189],v[188:189],v[194:195]
v_add_f32 v192,v192,v193
v_pk_fma_f32 v[194:195],v[190:191],v[190:191],v[194:195]
v_add_f32 v194,v194,v195
s_nop 1
v_permlane32_swap_b32 v192,v194
v_add_f32 v192,v192,v194
s_nop 1
v_add_f32_dpp v192,v192,v192 row_ror:8 row_mask:0xf bank_mask:0xf
s_nop 1
v_add_f32_dpp v192,v192,v192 row_ror:4 row_mask:0xf bank_mask:0xf
s_nop 1
v_add_f32_dpp v192,v192,v192 row_ror:2 row_mask:0xf bank_mask:0xf
s_nop 1
v_add_f32_dpp v192,v192,v192 row_ror:1 row_mask:0xf bank_mask:0xf
v_mov_b32 v194,v192
s_nop 1
v_permlane16_swap_b32 v192,v194
v_add_f32 v192,v192,v194
v_mul_f32 v192,0x3b000000,v192
v_mov_b32 v194,v192
s_nop 1
v_permlane32_swap_b32 v192,v194
v_fma_f32 v194,-v192,v192,v194
v_add_f32 v192,s78,v192
v_max_f32 v194,0,v194
v_cvt_pk_bf16_f32 v194,v192,v194
v_lshlrev_b32 v192,16,v194
v_and_b32 v194,0xffff0000,v194
v_add_f32 v194,0x3727c5ac,v194
v_cvt_pk_bf16_f32 v194,v194,v194
v_and_b32 v194,0xffff0000,v194
v_sqrt_f32 v194,v194
v_pk_add_f32 v[184:185],v[200:201],v[192:193] op_sel_hi:[1,0] neg_lo:[0,1] neg_hi:[0,1]
v_pk_add_f32 v[186:187],v[202:203],v[192:193] op_sel_hi:[1,0] neg_lo:[0,1] neg_hi:[0,1]
v_pk_add_f32 v[188:189],v[204:205],v[192:193] op_sel_hi:[1,0] neg_lo:[0,1] neg_hi:[0,1]
v_pk_add_f32 v[190:191],v[206:207],v[192:193] op_sel_hi:[1,0] neg_lo:[0,1] neg_hi:[0,1]
v_cvt_pk_bf16_f32 v194,v194,v194
v_and_b32 v194,0xffff0000,v194
v_rcp_f32 v194,v194
v_cvt_pk_bf16_f32 v164,v184,v185
v_cvt_pk_bf16_f32 v165,v186,v187
v_cvt_pk_bf16_f32 v166,v188,v189
v_cvt_pk_bf16_f32 v167,v190,v191
v_lshlrev_b32 v184,16,v164
v_and_b32 v185,0xffff0000,v164
v_lshlrev_b32 v186,16,v165
v_and_b32 v187,0xffff0000,v165
v_lshlrev_b32 v188,16,v166
v_and_b32 v189,0xffff0000,v166
v_lshlrev_b32 v190,16,v167
v_and_b32 v191,0xffff0000,v167
v_pk_mul_f32 v[184:185],v[184:185],v[194:195] op_sel_hi:[1,0]
v_pk_mul_f32 v[186:187],v[186:187],v[194:195] op_sel_hi:[1,0]
v_pk_mul_f32 v[188:189],v[188:189],v[194:195] op_sel_hi:[1,0]
v_pk_mul_f32 v[190:191],v[190:191],v[194:195] op_sel_hi:[1,0]
v_cvt_pk_bf16_f32 v164,v184,v185
v_cvt_pk_bf16_f32 v165,v186,v187
v_cvt_pk_bf16_f32 v166,v188,v189
v_cvt_pk_bf16_f32 v167,v190,v191
s_add_u32 s58,s63,2097152
buffer_store_dwordx4 v[164:167],v0,s[8:11],s58 offen sc1
v_mov_b32 v20,1
s_lshl_b32 s73,s51,13
s_lshl2_add_u32 s73,s68,s73
s_add_u32 s73,s73,10487552
s_branch L_aa_228
L_ak_243:
v_pk_mul_f32 v[236:237],v[176:177],v[228:229]
v_pk_fma_f32 v[236:237],v[178:179],v[230:231],v[236:237]
v_pk_fma_f32 v[236:237],v[180:181],v[232:233],v[236:237]
v_pk_fma_f32 v[236:237],v[182:183],v[234:235],v[236:237]
v_add_f32 v236,v236,v237
s_nop 1
v_add_f32_dpp v236,v236,v236 row_ror:8 row_mask:0xf bank_mask:0xf
s_nop 1
v_add_f32_dpp v236,v236,v236 row_ror:4 row_mask:0xf bank_mask:0xf
s_nop 1
v_add_f32_dpp v236,v236,v236 row_ror:2 row_mask:0xf bank_mask:0xf
s_nop 1
v_add_f32_dpp v236,v236,v236 row_ror:1 row_mask:0xf bank_mask:0xf
v_mov_b32 v237,v236
s_nop 1
v_permlane16_swap_b32 v236,v237
v_add_f32 v236,v236,v237
v_mov_b32 v237,v236
s_nop 1
v_permlane32_swap_b32 v236,v237
v_add_f32 v236,v236,v237
v_cvt_pk_bf16_f32 v236,v236,v236
v_and_b32 v236,0xffff0000,v236
v_ashrrev_i32 v237,31,v236
v_or_b32 v237,0x80000000,v237
v_xor_b32 v236,v236,v237
v_and_b32 v236,0xffff0000,v236
s_sub_u32 s58,4095,s64
v_or_b32 v20,s58,v236
s_lshl_b32 s58,s51,13
s_lshl2_add_u32 s58,s68,s58
s_add_u32 s58,s58,10487168
buffer_store_dword v20,off,s[8:11],s58 sc1
s_branch L_aa_228
L_aa_227:
s_bitcmp1_b32 s46,0
s_cbranch_scc1 L_aa_228
ds_read_b128 v[160:163],v23
ds_read_b128 v[164:167],v23 offset:16
s_lshl_b32 s64,s51,5
s_add_u32 s64,s64,s68
s_lshl_b32 s63,s64,10
s_add_u32 s58,s63,6291456
v_readfirstlane_b32 s61,v246
s_cmp_lg_u32 s61,0
s_cbranch_scc1 L_ag_245
s_cmp_eq_u32 s86,1536
s_cbranch_scc1 L_ag_245
s_cmp_ge_i32 s51,56
s_cbranch_scc1 L_ag_245
s_lshl_b32 s60,s51,13
s_lshl2_add_u32 s60,s68,s60
s_add_u32 s60,s60,10487296
L_ww_246:
buffer_load_dword v246,off,s[8:11],s60 sc1
s_sub_u32 s49,s49,1
s_cbranch_scc1 L_abort2
s_waitcnt vmcnt(0)
v_readfirstlane_b32 s61,v246
s_cmp_eq_u32 s61,0
s_cbranch_scc1 L_ww_246
L_wwd_247:
L_ag_245:
s_waitcnt lgkmcnt(0)
v_cvt_pk_bf16_f32 v168,v160,v161
v_cvt_pk_bf16_f32 v169,v162,v163
v_cvt_pk_bf16_f32 v170,v164,v165
v_cvt_pk_bf16_f32 v171,v166,v167
v_lshlrev_b32 v160,16,v168
v_and_b32 v161,0xffff0000,v168
v_lshlrev_b32 v162,16,v169
v_and_b32 v163,0xffff0000,v169
v_lshlrev_b32 v164,16,v170
v_and_b32 v165,0xffff0000,v170
v_lshlrev_b32 v166,16,v171
v_and_b32 v167,0xffff0000,v171
v_pk_add_f32 v[200:201],v[200:201],v[160:161]
v_pk_add_f32 v[202:203],v[202:203],v[162:163]
v_pk_add_f32 v[204:205],v[204:205],v[164:165]
v_pk_add_f32 v[206:207],v[206:207],v[166:167]
v_cvt_pk_bf16_f32 v168,v200,v201
v_cvt_pk_bf16_f32 v169,v202,v203
v_cvt_pk_bf16_f32 v170,v204,v205
v_cvt_pk_bf16_f32 v171,v206,v207
buffer_store_dwordx4 v[168:171],v0,s[8:11],s58 offen sc1
v_lshlrev_b32 v200,16,v168
v_and_b32 v201,0xffff0000,v168
v_lshlrev_b32 v202,16,v169
v_and_b32 v203,0xffff0000,v169
v_lshlrev_b32 v204,16,v170
v_and_b32 v205,0xffff0000,v170
v_lshlrev_b32 v206,16,v171
v_and_b32 v207,0xffff0000,v171
v_readfirstlane_b32 s78,v200
s_nop 1
v_pk_add_f32 v[184:185],v[200:201],s[78:79] op_sel_hi:[1,0] neg_lo:[0,1] neg_hi:[0,1]
v_pk_add_f32 v[186:187],v[202:203],s[78:79] op_sel_hi:[1,0] neg_lo:[0,1] neg_hi:[0,1]
v_pk_add_f32 v[188:189],v[204:205],s[78:79] op_sel_hi:[1,0] neg_lo:[0,1] neg_hi:[0,1]
v_pk_add_f32 v[190:191],v[206:207],s[78:79] op_sel_hi:[1,0] neg_lo:[0,1] neg_hi:[0,1]
v_pk_add_f32 v[192:193],v[184:185],v[186:187]
v_pk_mul_f32 v[194:195],v[184:185],v[184:185]
v_pk_add_f32 v[196:197],v[188:189],v[190:191]
v_pk_fma_f32 v[194:195],v[186:187],v[186:187],v[194:195]
v_pk_add_f32 v[192:193],v[192:193],v[196:197]
v_pk_fma_f32 v[194:195],v[188:189],v[188:189],v[194:195]
v_add_f32 v192,v192,v193
v_pk_fma_f32 v[194:195],v[190:191],v[190:191],v[194:195]
v_add_f32 v194,v194,v195
s_nop 1
v_permlane32_swap_b32 v192,v194
v_add_f32 v192,v192,v194
s_nop 1
v_add_f32_dpp v192,v192,v192 row_ror:8 row_mask:0xf bank_mask:0xf
s_nop 1
v_add_f32_dpp v192,v192,v192 row_ror:4 row_mask:0xf bank_mask:0xf
s_nop 1
v_add_f32_dpp v192,v192,v192 row_ror:2 row_mask:0xf bank_mask:0xf
s_nop 1
v_add_f32_dpp v192,v192,v192 row_ror:1 row_mask:0xf bank_mask:0xf
v_mov_b32 v194,v192
s_nop 1
v_permlane16_swap_b32 v192,v194
v_add_f32 v192,v192,v194
v_mul_f32 v192,0x3b000000,v192
v_mov_b32 v194,v192
s_nop 1
v_permlane32_swap_b32 v192,v194
v_fma_f32 v194,-v192,v192,v194
v_add_f32 v192,s78,v192
v_max_f32 v194,0,v194
v_cvt_pk_bf16_f32 v194,v192,v194
v_lshlrev_b32 v192,16,v194
v_and_b32 v194,0xffff0000,v194
v_add_f32 v194,0x3727c5ac,v194
v_cvt_pk_bf16_f32 v194,v194,v194
v_and_b32 v194,0xffff0000,v194
v_sqrt_f32 v194,v194
v_pk_add_f32 v[184:185],v[200:201],v[192:193] op_sel_hi:[1,0] neg_lo:[0,1] neg_hi:[0,1]
v_pk_add_f32 v[186:187],v[202:203],v[192:193] op_sel_hi:[1,0] neg_lo:[0,1] neg_hi:[0,1]
v_pk_add_f32 v[188:189],v[204:205],v[192:193] op_sel_hi:[1,0] neg_lo:[0,1] neg_hi:[0,1]
v_pk_add_f32 v[190:191],v[206:207],v[192:193] op_sel_hi:[1,0] neg_lo:[0,1] neg_hi:[0,1]
v_cvt_pk_bf16_f32 v194,v194,v194
v_and_b32 v194,0xffff0000,v194
v_rcp_f32 v194,v194
v_cvt_pk_bf16_f32 v172,v184,v185
v_cvt_pk_bf16_f32 v173,v186,v187
v_cvt_pk_bf16_f32 v174,v188,v189
v_cvt_pk_bf16_f32 v175,v190,v191
v_lshlrev_b32 v184,16,v172
v_and_b32 v185,0xffff0000,v172
v_lshlrev_b32 v186,16,v173
v_and_b32 v187,0xffff0000,v173
v_lshlrev_b32 v188,16,v174
v_and_b32 v189,0xffff0000,v174
v_lshlrev_b32 v190,16,v175
v_and_b32 v191,0xffff0000,v175
v_pk_mul_f32 v[184:185],v[184:185],v[194:195] op_sel_hi:[1,0]
v_pk_mul_f32 v[186:187],v[186:187],v[194:195] op_sel_hi:[1,0]
v_pk_mul_f32 v[188:189],v[188:189],v[194:195] op_sel_hi:[1,0]
v_pk_mul_f32 v[190:191],v[190:191],v[194:195] op_sel_hi:[1,0]
v_cvt_pk_bf16_f32 v172,v184,v185
v_cvt_pk_bf16_f32 v173,v186,v187
v_cvt_pk_bf16_f32 v174,v188,v189
v_cvt_pk_bf16_f32 v175,v190,v191
v_lshlrev_b32 v176,16,v172
v_and_b32 v177,0xffff0000,v172
v_lshlrev_b32 v178,16,v173
v_and_b32 v179,0xffff0000,v173
v_lshlrev_b32 v180,16,v174
v_and_b32 v181,0xffff0000,v174
v_lshlrev_b32 v182,16,v175
v_and_b32 v183,0xffff0000,v175
v_pk_add_f32 v[200:201],v[200:201],v[176:177]
v_pk_add_f32 v[202:203],v[202:203],v[178:179]
v_pk_add_f32 v[204:205],v[204:205],v[180:181]
v_pk_add_f32 v[206:207],v[206:207],v[182:183]
v_cvt_pk_bf16_f32 v160,v200,v201
v_cvt_pk_bf16_f32 v161,v202,v203
v_cvt_pk_bf16_f32 v162,v204,v205
v_cvt_pk_bf16_f32 v163,v206,v207
s_mov_b32 s4,s40
s_mov_b32 s5,s41
s_mov_b32 s6,2097152
s_mov_b32 s7,0x20000
buffer_store_dwordx4 v[160:163],v0,s[4:7],s63 offen sc1
v_pk_mul_f32 v[236:237],v[176:177],v[228:229]
v_pk_fma_f32 v[236:237],v[178:179],v[230:231],v[236:237]
v_pk_fma_f32 v[236:237],v[180:181],v[232:233],v[236:237]
v_pk_fma_f32 v[236:237],v[182:183],v[234:235],v[236:237]
v_add_f32 v236,v236,v237
s_nop 1
v_add_f32_dpp v236,v236,v236 row_ror:8 row_mask:0xf bank_mask:0xf
s_nop 1
v_add_f32_dpp v236,v236,v236 row_ror:4 row_mask:0xf bank_mask:0xf
s_nop 1
v_add_f32_dpp v236,v236,v236 row_ror:2 row_mask:0xf bank_mask:0xf
s_nop 1
v_add_f32_dpp v236,v236,v236 row_ror:1 row_mask:0xf bank_mask:0xf
v_mov_b32 v237,v236
s_nop 1
v_permlane16_swap_b32 v236,v237
v_add_f32 v236,v236,v237
v_mov_b32 v237,v236
s_nop 1
v_permlane32_swap_b32 v236,v237
v_add_f32 v236,v236,v237
v_cvt_pk_bf16_f32 v236,v236,v236
v_and_b32 v236,0xffff0000,v236
v_ashrrev_i32 v237,31,v236
v_or_b32 v237,0x80000000,v237
v_xor_b32 v236,v236,v237
v_and_b32 v236,0xffff0000,v236
s_sub_u32 s58,4095,s64
v_or_b32 v20,s58,v236
s_lshl_b32 s73,s51,13
s_lshl2_add_u32 s73,s68,s73
s_add_u32 s73,s73,10485760
s_add_u32 s73,s73,s86
L_aa_228:
s_cmp_eq_u32 s88,1
s_cbranch_scc1 L_aa_230
s_cmp_eq_u32 s88,0
s_cbranch_scc1 L_aa_229
s_cmp_ge_u32 s77,64
s_cbranch_scc1 L_aa_233
L_aa_231:
s_waitcnt vmcnt(0)
buffer_store_dword v20,off,s[8:11],s73 sc1
s_mov_b32 s73,0x80000000
L_aw_248:
v_cmp_eq_u32 vcc,0,v18
s_cbranch_vccz L_awd_249
buffer_load_dword v18,v19,s[8:11],0 offen sc1
s_sub_u32 s49,s49,1
s_cbranch_scc1 L_abort2
s_waitcnt vmcnt(0)
s_branch L_aw_248
L_awd_249:
s_mov_b32 s64,s70
s_cmp_eq_u32 s30,0
s_cselect_b32 s65,0x80000000,s71
s_and_b32 s57,s46,1
s_mul_i32 s58,s57,12288
s_add_u32 s64,s64,s58
s_lshl_b32 s57,s57,12
s_add_u32 s65,s65,s57
s_and_b32 s59,s50,2048
s_lshl_b32 s59,s59,4
s_xor_b32 s60,s67,65536
s_add_u32 s59,s59,s60
s_add_u32 s58,s58,s59
s_add_u32 s57,s57,s59
s_add_u32 m0,s58,0
s_nop 0
buffer_load_dwordx4 v0,s[8:11],s64 offen offset:0 sc1 lds
buffer_load_dwordx4 v0,s[8:11],s64 offen offset:1024 sc1 lds
buffer_load_dwordx4 v0,s[8:11],s64 offen offset:2048 sc1 lds
buffer_load_dwordx4 v0,s[8:11],s64 offen offset:3072 sc1 lds
s_add_u32 m0,s58,4096
s_add_u32 s64,s64,4096
buffer_load_dwordx4 v0,s[8:11],s64 offen offset:0 sc1 lds
buffer_load_dwordx4 v0,s[8:11],s64 offen offset:1024 sc1 lds
buffer_load_dwordx4 v0,s[8:11],s64 offen offset:2048 sc1 lds
buffer_load_dwordx4 v0,s[8:11],s64 offen offset:3072 sc1 lds
s_add_u32 m0,s58,8192
s_add_u32 s64,s64,4096
buffer_load_dwordx4 v0,s[8:11],s64 offen offset:0 sc1 lds
buffer_load_dwordx4 v0,s[8:11],s64 offen offset:1024 sc1 lds
buffer_load_dwordx4 v0,s[8:11],s64 offen offset:2048 sc1 lds
buffer_load_dwordx4 v0,s[8:11],s64 offen offset:3072 sc1 lds
s_add_u32 m0,s57,24576
s_nop 0
buffer_load_dwordx4 v0,s[8:11],s65 offen offset:0 sc1 lds
buffer_load_dwordx4 v0,s[8:11],s65 offen offset:1024 sc1 lds
buffer_load_dwordx4 v0,s[8:11],s65 offen offset:2048 sc1 lds
buffer_load_dwordx4 v0,s[8:11],s65 offen offset:3072 sc1 lds
s_waitcnt vmcnt(0)
s_barrier
s_cmp_eq_u32 s30,0
s_cbranch_scc1 L_aa_232
s_xor_b32 s67,s67,65536
s_and_b32 s56,s50,2048
s_lshl_b32 s56,s56,4
s_add_u32 s56,s56,s67
v_add_u32 v2,s56,v0
s_and_b32 s56,s50,1024
s_lshl_b32 s56,s56,2
v_add_u32 v238,s56,v2
s_mov_b32 s76,s71
s_mov_b32 s53,s77
ds_read_b128 v[24:27],v238 offset:16384
ds_read_b128 v[40:43],v2 offset:0
ds_read_b128 v[56:59],v2 offset:4096
ds_read_b128 v[28:31],v238 offset:17408
ds_read_b128 v[44:47],v2 offset:1024
ds_read_b128 v[60:63],v2 offset:5120
ds_read_b128 v[32:35],v238 offset:18432
ds_read_b128 v[48:51],v2 offset:2048
ds_read_b128 v[64:67],v2 offset:6144
ds_read_b128 v[36:39],v238 offset:19456
ds_read_b128 v[52:55],v2 offset:3072
ds_read_b128 v[68:71],v2 offset:7168
s_waitcnt lgkmcnt(9)
v_mfma_f32_16x16x32_bf16 v[128:131],v[40:43],v[24:27],v[8:11]
ds_read_b128 v[72:75],v2 offset:24576
v_mfma_f32_16x16x32_bf16 v[132:135],v[56:59],v[24:27],v[12:15]
ds_read_b128 v[76:79],v2 offset:25600
s_waitcnt lgkmcnt(8)
v_mfma_f32_16x16x32_bf16 v[128:131],v[44:47],v[28:31],v[128:131]
ds_read_b128 v[80:83],v2 offset:26624
v_mfma_f32_16x16x32_bf16 v[132:135],v[60:63],v[28:31],v[132:135]
ds_read_b128 v[84:87],v2 offset:27648
s_waitcnt lgkmcnt(7)
v_mfma_f32_16x16x32_bf16 v[128:131],v[48:51],v[32:35],v[128:131]
ds_read_b128 v[88:91],v2 offset:8192
v_mfma_f32_16x16x32_bf16 v[132:135],v[64:67],v[32:35],v[132:135]
ds_read_b128 v[92:95],v2 offset:9216
s_waitcnt lgkmcnt(6)
v_mfma_f32_16x16x32_bf16 v[128:131],v[52:55],v[36:39],v[128:131]
ds_read_b128 v[96:99],v2 offset:10240
v_mfma_f32_16x16x32_bf16 v[132:135],v[68:71],v[36:39],v[132:135]
ds_read_b128 v[100:103],v2 offset:11264
s_waitcnt lgkmcnt(4)
v_mfma_f32_16x16x32_bf16 v[136:139],v[72:75],v[24:27],0
ds_read_b128 v[104:107],v2 offset:12288
ds_read_b128 v[108:111],v2 offset:13312
v_mfma_f32_16x16x32_bf16 v[136:139],v[76:79],v[28:31],v[136:139]
ds_read_b128 v[112:115],v2 offset:14336
ds_read_b128 v[116:119],v2 offset:15360
v_mfma_f32_16x16x32_bf16 v[136:139],v[80:83],v[32:35],v[136:139]
ds_read_b64 v[120:121],v2 offset:28672
ds_read_b64 v[122:123],v2 offset:29696
v_mfma_f32_16x16x32_bf16 v[136:139],v[84:87],v[36:39],v[136:139]
ds_read_b64 v[124:125],v2 offset:30720
ds_read_b64 v[126:127],v2 offset:31744
s_cmp_lg_u32 s86,1536
s_cbranch_scc1 L_ae_250
s_add_u32 s77,s53,12
s_mov_b32 s30,0
s_lshl_b32 s56,s77,5
s_add_u32 s56,s56,s68
s_mul_i32 s70,s56,24576
s_lshl_b32 s71,s56,13
s_add_u32 s70,s70,100663296
s_add_u32 s71,s71,41943040
s_lshl_b32 s59,s77,13
s_lshl2_add_u32 s59,s68,s59
s_add_u32 s59,s59,10485760
v_mov_b32 v19,s59
buffer_load_dword v18,v19,s[8:11],0 offen sc1
s_branch L_af_251
L_ae_250:
s_ff1_i32_b64 s77,s[84:85]
s_bitset0_b64 s[84:85],s77
s_ff1_i32_b64 s77,s[84:85]
s_bitset0_b64 s[84:85],s77
s_ff1_i32_b64 s77,s[84:85]
s_bitset0_b64 s[84:85],s77
s_ff1_i32_b64 s77,s[84:85]
s_bitset0_b64 s[84:85],s77
s_ff1_i32_b64 s77,s[84:85]
s_bitset0_b64 s[84:85],s77
s_ff1_i32_b64 s77,s[84:85]
s_bitset0_b64 s[84:85],s77
s_min_u32 s77,s77,64
s_lshr_b32 s61,s55,5
s_lshl_b32 s56,s77,5
s_add_u32 s56,s56,s68
s_mul_i32 s70,s56,24576
s_lshl_b32 s71,s56,13
s_lshl_b32 s59,s77,13
s_lshl2_add_u32 s59,s68,s59
s_add_u32 s59,s59,10485760
s_cmp_lt_u32 s77,s61
s_cselect_b32 s57,0,16777216
s_cselect_b32 s60,0,128
s_add_u32 s71,s71,s57
s_add_u32 s71,s71,58720256
s_add_u32 s60,s60,s59
s_add_u32 s60,s60,512
s_cmp_eq_u32 s77,s61
s_cselect_b32 s57,50331648,0
s_cselect_b32 s58,1536,0
s_add_u32 s70,s70,s57
s_add_u32 s70,s70,150994944
s_add_u32 s59,s59,s58
s_add_u32 s59,s59,384
v_mov_b32 v19,s59
v_writelane_b32 v19,s60,1
buffer_load_dword v18,v19,s[8:11],0 offen sc1
L_af_251:
v_max3_f32 v238,v128,v129,v130
v_max3_f32 v239,v131,v132,v133
v_max3_f32 v238,v134,v135,v238
v_max3_f32 v239,v138,v139,v239
v_max_f32 v238,v238,v239
v_max_f32 v239,v238,v239
s_nop 1
v_permlane16_swap_b32 v238,v239
v_max_f32 v238,v238,v239
v_max_f32 v239,v238,v239
s_nop 1
v_permlane32_swap_b32 v238,v239
v_max_f32 v238,v238,v239
v_mul_f32 v238,s80,v238
v_fma_f32 v128,v128,s80,-v238
v_fma_f32 v129,v129,s80,-v238
v_exp_f32 v128,v128
v_fma_f32 v130,v130,s80,-v238
v_exp_f32 v129,v129
v_fma_f32 v131,v131,s80,-v238
v_exp_f32 v130,v130
v_fma_f32 v132,v132,s80,-v238
v_exp_f32 v131,v131
v_fma_f32 v133,v133,s80,-v238
v_exp_f32 v132,v132
v_fma_f32 v134,v134,s80,-v238
v_exp_f32 v133,v133
v_fma_f32 v135,v135,s80,-v238
v_exp_f32 v134,v134
v_fma_f32 v138,v138,s80,-v238
v_exp_f32 v135,v135
v_fma_f32 v139,v139,s80,-v238
v_exp_f32 v138,v138
v_exp_f32 v139,v139
v_cvt_pk_bf16_f32 v140,v128,v129
v_cvt_pk_bf16_f32 v141,v130,v131
v_cvt_pk_bf16_f32 v142,v132,v133
v_cvt_pk_bf16_f32 v143,v134,v135
v_cvt_pk_bf16_f32 v144,v138,v139
v_mov_b32 v147,v144
s_waitcnt lgkmcnt(0)
v_mfma_f32_16x16x32_bf16 v[148:151],v[152:155],v[140:143],0
v_mfma_f32_16x16x32_bf16 v[24:27],v[88:91],v[140:143],0
v_mfma_f32_16x16x32_bf16 v[28:31],v[92:95],v[140:143],0
v_mfma_f32_16x16x16_bf16 v[148:151],v[152:153],v[144:145],v[148:151]
v_mfma_f32_16x16x32_bf16 v[32:35],v[96:99],v[140:143],0
v_mfma_f32_16x16x32_bf16 v[36:39],v[100:103],v[140:143],0
v_mfma_f32_16x16x32_bf16 v[40:43],v[104:107],v[140:143],0
v_mfma_f32_16x16x32_bf16 v[44:47],v[108:111],v[140:143],0
v_mfma_f32_16x16x32_bf16 v[48:51],v[112:115],v[140:143],0
v_mfma_f32_16x16x32_bf16 v[52:55],v[116:119],v[140:143],0
v_rcp_f32 v148,v148
v_mfma_f32_16x16x16_bf16 v[24:27],v[120:121],v[144:145],v[24:27]
v_mfma_f32_16x16x16_bf16 v[28:31],v[120:121],v[146:147],v[28:31]
v_mfma_f32_16x16x16_bf16 v[32:35],v[122:123],v[144:145],v[32:35]
v_mfma_f32_16x16x16_bf16 v[36:39],v[122:123],v[146:147],v[36:39]
v_mfma_f32_16x16x16_bf16 v[40:43],v[124:125],v[144:145],v[40:43]
v_pk_mul_f32 v[24:25],v[24:25],v[148:149] op_sel_hi:[1,0]
v_pk_mul_f32 v[26:27],v[26:27],v[148:149] op_sel_hi:[1,0]
v_mfma_f32_16x16x16_bf16 v[44:47],v[124:125],v[146:147],v[44:47]
v_pk_mul_f32 v[28:29],v[28:29],v[148:149] op_sel_hi:[1,0]
v_pk_mul_f32 v[30:31],v[30:31],v[148:149] op_sel_hi:[1,0]
v_mfma_f32_16x16x16_bf16 v[48:51],v[126:127],v[144:145],v[48:51]
v_cvt_pk_bf16_f32 v72,v24,v28
v_cvt_pk_bf16_f32 v73,v25,v29
v_mfma_f32_16x16x16_bf16 v[52:55],v[126:127],v[146:147],v[52:55]
v_cvt_pk_bf16_f32 v74,v26,v30
v_cvt_pk_bf16_f32 v75,v27,v31
ds_write_b128 v3,v[72:75] offset:0
v_pk_mul_f32 v[32:33],v[32:33],v[148:149] op_sel_hi:[1,0]
v_pk_mul_f32 v[34:35],v[34:35],v[148:149] op_sel_hi:[1,0]
v_pk_mul_f32 v[36:37],v[36:37],v[148:149] op_sel_hi:[1,0]
v_pk_mul_f32 v[38:39],v[38:39],v[148:149] op_sel_hi:[1,0]
v_cvt_pk_bf16_f32 v76,v32,v36
v_cvt_pk_bf16_f32 v77,v33,v37
v_cvt_pk_bf16_f32 v78,v34,v38
v_cvt_pk_bf16_f32 v79,v35,v39
ds_write_b128 v3,v[76:79] offset:1024
v_pk_mul_f32 v[40:41],v[40:41],v[148:149] op_sel_hi:[1,0]
v_pk_mul_f32 v[42:43],v[42:43],v[148:149] op_sel_hi:[1,0]
v_pk_mul_f32 v[44:45],v[44:45],v[148:149] op_sel_hi:[1,0]
v_pk_mul_f32 v[46:47],v[46:47],v[148:149] op_sel_hi:[1,0]
v_cvt_pk_bf16_f32 v80,v40,v44
v_cvt_pk_bf16_f32 v81,v41,v45
v_cvt_pk_bf16_f32 v82,v42,v46
v_cvt_pk_bf16_f32 v83,v43,v47
ds_write_b128 v3,v[80:83] offset:2048
v_pk_mul_f32 v[48:49],v[48:49],v[148:149] op_sel_hi:[1,0]
v_pk_mul_f32 v[50:51],v[50:51],v[148:149] op_sel_hi:[1,0]
v_pk_mul_f32 v[52:53],v[52:53],v[148:149] op_sel_hi:[1,0]
v_pk_mul_f32 v[54:55],v[54:55],v[148:149] op_sel_hi:[1,0]
v_cvt_pk_bf16_f32 v84,v48,v52
v_cvt_pk_bf16_f32 v85,v49,v53
v_cvt_pk_bf16_f32 v86,v50,v54
v_cvt_pk_bf16_f32 v87,v51,v55
ds_write_b128 v3,v[84:87] offset:3072
s_waitcnt vmcnt(0)
v_cmp_eq_u32 vcc,0,v18
s_lshl_b32 s56,s46,2
s_add_u32 s56,s56,155648
v_mov_b32 v238,s56
s_cmp_lg_u64 vcc,0
s_cselect_b32 s72,1,0
s_cmp_ge_u32 s77,64
s_cselect_b32 s72,1,s72
v_mov_b32 v239,s72
ds_write_b32 v238,v239
s_waitcnt lgkmcnt(0)
s_barrier
L_aa_230:
s_mov_b32 s51,s53
s_mov_b32 s31,1
s_branch L_aa_223
L_aa_232:
s_xor_b32 s67,s67,65536
s_and_b32 s56,s50,2048
s_lshl_b32 s56,s56,4
s_add_u32 s56,s56,s67
v_add_u32 v2,s56,v0
s_and_b32 s56,s50,1024
s_lshl_b32 s56,s56,2
v_add_u32 v238,s56,v2
s_mov_b32 s76,s71
s_mov_b32 s53,s77
ds_read_b128 v[24:27],v238 offset:16384
ds_read_b128 v[40:43],v2 offset:0
ds_read_b128 v[56:59],v2 offset:4096
ds_read_b128 v[28:31],v238 offset:17408
ds_read_b128 v[44:47],v2 offset:1024
ds_read_b128 v[60:63],v2 offset:5120
ds_read_b128 v[32:35],v238 offset:18432
ds_read_b128 v[48:51],v2 offset:2048
ds_read_b128 v[64:67],v2 offset:6144
ds_read_b128 v[36:39],v238 offset:19456
ds_read_b128 v[52:55],v2 offset:3072
ds_read_b128 v[68:71],v2 offset:7168
s_waitcnt lgkmcnt(9)
v_mfma_f32_16x16x32_bf16 v[128:131],v[40:43],v[24:27],v[8:11]
ds_read_b128 v[88:91],v2 offset:8192
v_mfma_f32_16x16x32_bf16 v[132:135],v[56:59],v[24:27],v[12:15]
ds_read_b128 v[92:95],v2 offset:9216
s_waitcnt lgkmcnt(8)
v_mfma_f32_16x16x32_bf16 v[128:131],v[44:47],v[28:31],v[128:131]
ds_read_b128 v[96:99],v2 offset:10240
v_mfma_f32_16x16x32_bf16 v[132:135],v[60:63],v[28:31],v[132:135]
ds_read_b128 v[100:103],v2 offset:11264
s_waitcnt lgkmcnt(7)
v_mfma_f32_16x16x32_bf16 v[128:131],v[48:51],v[32:35],v[128:131]
ds_read_b128 v[104:107],v2 offset:12288
v_mfma_f32_16x16x32_bf16 v[132:135],v[64:67],v[32:35],v[132:135]
ds_read_b128 v[108:111],v2 offset:13312
s_waitcnt lgkmcnt(6)
v_mfma_f32_16x16x32_bf16 v[128:131],v[52:55],v[36:39],v[128:131]
ds_read_b128 v[112:115],v2 offset:14336
v_mfma_f32_16x16x32_bf16 v[132:135],v[68:71],v[36:39],v[132:135]
ds_read_b128 v[116:119],v2 offset:15360
s_add_u32 s62,s76,4096
buffer_load_dwordx4 v[72:75],v0,s[8:11],s76 offen offset:0 sc1
buffer_load_dwordx4 v[76:79],v0,s[8:11],s76 offen offset:1024 sc1
buffer_load_dwordx4 v[80:83],v0,s[8:11],s76 offen offset:2048 sc1
buffer_load_dwordx4 v[84:87],v0,s[8:11],s76 offen offset:3072 sc1
buffer_load_dwordx2 v[120:121],v0,s[8:11],s62 offen offset:0 sc1
buffer_load_dwordx2 v[122:123],v0,s[8:11],s62 offen offset:1024 sc1
buffer_load_dwordx2 v[124:125],v0,s[8:11],s62 offen offset:2048 sc1
buffer_load_dwordx2 v[126:127],v0,s[8:11],s62 offen offset:3072 sc1
v_lshrrev_b32 v244,4,v1
s_sub_u32 s56,s53,7
v_add_u32 v244,s56,v244
v_max_i32 v244,0,v244
v_lshl_add_u32 v244,v244,13,v21
buffer_load_dwordx2 v[242:243],v244,s[8:11],0 offen sc1
s_mov_b32 s31,0
L_aa_229:
s_mov_b32 s51,s53
s_waitcnt vmcnt(3)
s_bitcmp1_b32 s46,0
s_cselect_b32 s56,0,s31
s_cmp_lg_u32 s56,0
s_cbranch_scc1 L_an_252
s_waitcnt vmcnt(0)
buffer_store_dword v20,off,s[8:11],s73 sc1
s_mov_b32 s73,0x80000000
L_an_252:
s_mov_b32 s31,0
s_cmp_lt_u32 s53,4
s_cbranch_scc1 L_ab_253
L_aw_255:
v_min_u32 v238,v242,v243
v_cmp_eq_u32 vcc,0,v238
s_cbranch_vccz L_awd_256
buffer_load_dwordx2 v[242:243],v244,s[8:11],0 offen sc1
s_sub_u32 s49,s49,1
s_cbranch_scc1 L_abort2
s_waitcnt vmcnt(0)
s_branch L_aw_255
L_awd_256:
v_max_u32 v242,v242,v243
s_nop 1
v_max_u32_dpp v242,v242,v242 row_ror:8 row_mask:0xf bank_mask:0xf
s_nop 1
v_max_u32_dpp v242,v242,v242 row_ror:4 row_mask:0xf bank_mask:0xf
s_nop 1
v_max_u32_dpp v242,v242,v242 row_ror:2 row_mask:0xf bank_mask:0xf
s_nop 1
v_max_u32_dpp v242,v242,v242 row_ror:1 row_mask:0xf bank_mask:0xf
v_mov_b32 v243,v242
s_nop 1
v_permlane16_swap_b32 v242,v243
v_max_u32 v242,v242,v243
v_mov_b32 v243,v242
s_nop 1
v_permlane32_swap_b32 v242,v243
v_max_u32 v242,v242,v243
s_nop 0
v_readfirstlane_b32 s56,v242
s_max_u32 s75,s75,s56
s_cmp_lt_u32 s53,8
s_cbranch_scc1 L_ab_253
s_sub_u32 s77,s53,8
s_and_b32 s55,s75,0x7ff
s_sub_u32 s55,2047,s55
s_cmp_lt_u32 s77,28
s_cselect_b32 s55,4095,s55
s_lshr_b32 s61,s55,5
s_mov_b32 s30,1
s_lshl_b32 s56,s77,5
s_add_u32 s56,s56,s68
s_mul_i32 s70,s56,24576
s_lshl_b32 s71,s56,13
s_lshl_b32 s59,s77,13
s_lshl2_add_u32 s59,s68,s59
s_add_u32 s59,s59,10485760
s_cmp_lt_u32 s77,s61
s_cselect_b32 s57,0,16777216
s_cselect_b32 s60,0,128
s_add_u32 s71,s71,s57
s_add_u32 s71,s71,58720256
s_add_u32 s60,s60,s59
s_add_u32 s60,s60,512
s_cmp_eq_u32 s77,s61
s_cselect_b32 s57,50331648,0
s_cselect_b32 s58,1536,0
s_add_u32 s70,s70,s57
s_add_u32 s70,s70,150994944
s_add_u32 s59,s59,s58
s_add_u32 s59,s59,384
v_mov_b32 v19,s59
v_writelane_b32 v19,s60,1
buffer_load_dword v18,v19,s[8:11],0 offen sc1
s_branch L_aj_254
L_ab_253:
s_add_u32 s77,s53,4
s_mov_b32 s30,0
s_lshl_b32 s56,s77,5
s_add_u32 s56,s56,s68
s_mul_i32 s70,s56,24576
s_lshl_b32 s71,s56,13
s_add_u32 s70,s70,100663296
s_add_u32 s71,s71,41943040
s_lshl_b32 s59,s77,13
s_lshl2_add_u32 s59,s68,s59
s_add_u32 s59,s59,10485760
v_mov_b32 v19,s59
buffer_load_dword v18,v19,s[8:11],0 offen sc1
L_aj_254:
v_mfma_f32_16x16x32_bf16 v[136:139],v[72:75],v[24:27],0
v_max3_u32 v238,v72,v73,v74
v_max3_u32 v238,v74,v75,v238
v_mfma_f32_16x16x32_bf16 v[136:139],v[76:79],v[28:31],v[136:139]
v_max3_u32 v238,v76,v77,v238
v_max3_u32 v238,v78,v79,v238
v_mfma_f32_16x16x32_bf16 v[136:139],v[80:83],v[32:35],v[136:139]
v_max3_u32 v238,v80,v81,v238
v_max3_u32 v238,v82,v83,v238
v_mfma_f32_16x16x32_bf16 v[136:139],v[84:87],v[36:39],v[136:139]
v_max3_u32 v238,v84,v85,v238
v_max3_u32 v238,v86,v87,v238
v_max3_u32 v238,v120,v121,v238
v_max3_u32 v238,v122,v123,v238
v_max3_u32 v238,v124,v125,v238
v_max3_u32 v238,v126,v127,v238
v_cmp_eq_u32 vcc,-1,v238
s_cbranch_vccz L_aa_235
L_aa_234:
s_add_u32 s62,s76,4096
buffer_load_dwordx4 v[72:75],v0,s[8:11],s76 offen offset:0 sc1
buffer_load_dwordx4 v[76:79],v0,s[8:11],s76 offen offset:1024 sc1
buffer_load_dwordx4 v[80:83],v0,s[8:11],s76 offen offset:2048 sc1
buffer_load_dwordx4 v[84:87],v0,s[8:11],s76 offen offset:3072 sc1
buffer_load_dwordx2 v[120:121],v0,s[8:11],s62 offen offset:0 sc1
buffer_load_dwordx2 v[122:123],v0,s[8:11],s62 offen offset:1024 sc1
buffer_load_dwordx2 v[124:125],v0,s[8:11],s62 offen offset:2048 sc1
buffer_load_dwordx2 v[126:127],v0,s[8:11],s62 offen offset:3072 sc1
s_sub_u32 s49,s49,1
s_cbranch_scc1 L_abort2
s_waitcnt vmcnt(7)
v_mfma_f32_16x16x32_bf16 v[136:139],v[72:75],v[24:27],0
v_max3_u32 v238,v72,v73,v74
v_max3_u32 v238,v74,v75,v238
s_waitcnt vmcnt(6)
v_mfma_f32_16x16x32_bf16 v[136:139],v[76:79],v[28:31],v[136:139]
v_max3_u32 v238,v76,v77,v238
v_max3_u32 v238,v78,v79,v238
s_waitcnt vmcnt(5)
v_mfma_f32_16x16x32_bf16 v[136:139],v[80:83],v[32:35],v[136:139]
v_max3_u32 v238,v80,v81,v238
v_max3_u32 v238,v82,v83,v238
s_waitcnt vmcnt(4)
v_mfma_f32_16x16x32_bf16 v[136:139],v[84:87],v[36:39],v[136:139]
v_max3_u32 v238,v84,v85,v238
v_max3_u32 v238,v86,v87,v238
s_waitcnt vmcnt(0)
v_max3_u32 v238,v120,v121,v238
v_max3_u32 v238,v122,v123,v238
v_max3_u32 v238,v124,v125,v238
v_max3_u32 v238,v126,v127,v238
v_cmp_eq_u32 vcc,-1,v238
s_cbranch_vccnz L_aa_234
L_aa_235:
v_max3_f32 v238,v128,v129,v130
v_max3_f32 v239,v131,v132,v133
v_max3_f32 v238,v134,v135,v238
v_max3_f32 v239,v138,v139,v239
v_max_f32 v238,v238,v239
v_max_f32 v239,v238,v239
s_nop 1
v_permlane16_swap_b32 v238,v239
v_max_f32 v238,v238,v239
v_max_f32 v239,v238,v239
s_nop 1
v_permlane32_swap_b32 v238,v239
v_max_f32 v238,v238,v239
v_mul_f32 v238,s80,v238
v_fma_f32 v128,v128,s80,-v238
v_fma_f32 v129,v129,s80,-v238
v_exp_f32 v128,v128
v_fma_f32 v130,v130,s80,-v238
v_exp_f32 v129,v129
v_fma_f32 v131,v131,s80,-v238
v_exp_f32 v130,v130
v_fma_f32 v132,v132,s80,-v238
v_exp_f32 v131,v131
v_fma_f32 v133,v133,s80,-v238
v_exp_f32 v132,v132
v_fma_f32 v134,v134,s80,-v238
v_exp_f32 v133,v133
v_fma_f32 v135,v135,s80,-v238
v_exp_f32 v134,v134
v_fma_f32 v138,v138,s80,-v238
v_exp_f32 v135,v135
v_fma_f32 v139,v139,s80,-v238
v_exp_f32 v138,v138
v_exp_f32 v139,v139
v_cvt_pk_bf16_f32 v140,v128,v129
v_cvt_pk_bf16_f32 v141,v130,v131
v_cvt_pk_bf16_f32 v142,v132,v133
v_cvt_pk_bf16_f32 v143,v134,v135
v_cvt_pk_bf16_f32 v144,v138,v139
v_mov_b32 v147,v144
s_waitcnt lgkmcnt(0)
v_mfma_f32_16x16x32_bf16 v[148:151],v[152:155],v[140:143],0
v_mfma_f32_16x16x32_bf16 v[24:27],v[88:91],v[140:143],0
v_mfma_f32_16x16x32_bf16 v[28:31],v[92:95],v[140:143],0
v_mfma_f32_16x16x16_bf16 v[148:151],v[152:153],v[144:145],v[148:151]
v_mfma_f32_16x16x32_bf16 v[32:35],v[96:99],v[140:143],0
v_mfma_f32_16x16x32_bf16 v[36:39],v[100:103],v[140:143],0
v_mfma_f32_16x16x32_bf16 v[40:43],v[104:107],v[140:143],0
v_mfma_f32_16x16x32_bf16 v[44:47],v[108:111],v[140:143],0
v_mfma_f32_16x16x32_bf16 v[48:51],v[112:115],v[140:143],0
v_mfma_f32_16x16x32_bf16 v[52:55],v[116:119],v[140:143],0
v_rcp_f32 v148,v148
v_mfma_f32_16x16x16_bf16 v[24:27],v[120:121],v[144:145],v[24:27]
v_mfma_f32_16x16x16_bf16 v[28:31],v[120:121],v[146:147],v[28:31]
v_mfma_f32_16x16x16_bf16 v[32:35],v[122:123],v[144:145],v[32:35]
v_mfma_f32_16x16x16_bf16 v[36:39],v[122:123],v[146:147],v[36:39]
v_mfma_f32_16x16x16_bf16 v[40:43],v[124:125],v[144:145],v[40:43]
v_pk_mul_f32 v[24:25],v[24:25],v[148:149] op_sel_hi:[1,0]
v_pk_mul_f32 v[26:27],v[26:27],v[148:149] op_sel_hi:[1,0]
v_mfma_f32_16x16x16_bf16 v[44:47],v[124:125],v[146:147],v[44:47]
v_pk_mul_f32 v[28:29],v[28:29],v[148:149] op_sel_hi:[1,0]
v_pk_mul_f32 v[30:31],v[30:31],v[148:149] op_sel_hi:[1,0]
v_mfma_f32_16x16x16_bf16 v[48:51],v[126:127],v[144:145],v[48:51]
v_cvt_pk_bf16_f32 v72,v24,v28
v_cvt_pk_bf16_f32 v73,v25,v29
v_mfma_f32_16x16x16_bf16 v[52:55],v[126:127],v[146:147],v[52:55]
v_cvt_pk_bf16_f32 v74,v26,v30
v_cvt_pk_bf16_f32 v75,v27,v31
ds_write_b128 v3,v[72:75] offset:0
v_pk_mul_f32 v[32:33],v[32:33],v[148:149] op_sel_hi:[1,0]
v_pk_mul_f32 v[34:35],v[34:35],v[148:149] op_sel_hi:[1,0]
v_pk_mul_f32 v[36:37],v[36:37],v[148:149] op_sel_hi:[1,0]
v_pk_mul_f32 v[38:39],v[38:39],v[148:149] op_sel_hi:[1,0]
v_cvt_pk_bf16_f32 v76,v32,v36
v_cvt_pk_bf16_f32 v77,v33,v37
v_cvt_pk_bf16_f32 v78,v34,v38
v_cvt_pk_bf16_f32 v79,v35,v39
ds_write_b128 v3,v[76:79] offset:1024
v_pk_mul_f32 v[40:41],v[40:41],v[148:149] op_sel_hi:[1,0]
v_pk_mul_f32 v[42:43],v[42:43],v[148:149] op_sel_hi:[1,0]
v_pk_mul_f32 v[44:45],v[44:45],v[148:149] op_sel_hi:[1,0]
v_pk_mul_f32 v[46:47],v[46:47],v[148:149] op_sel_hi:[1,0]
v_cvt_pk_bf16_f32 v80,v40,v44
v_cvt_pk_bf16_f32 v81,v41,v45
v_cvt_pk_bf16_f32 v82,v42,v46
v_cvt_pk_bf16_f32 v83,v43,v47
ds_write_b128 v3,v[80:83] offset:2048
v_pk_mul_f32 v[48:49],v[48:49],v[148:149] op_sel_hi:[1,0]
v_pk_mul_f32 v[50:51],v[50:51],v[148:149] op_sel_hi:[1,0]
v_pk_mul_f32 v[52:53],v[52:53],v[148:149] op_sel_hi:[1,0]
v_pk_mul_f32 v[54:55],v[54:55],v[148:149] op_sel_hi:[1,0]
v_cvt_pk_bf16_f32 v84,v48,v52
v_cvt_pk_bf16_f32 v85,v49,v53
v_cvt_pk_bf16_f32 v86,v50,v54
v_cvt_pk_bf16_f32 v87,v51,v55
ds_write_b128 v3,v[84:87] offset:3072
s_waitcnt vmcnt(0)
v_cmp_eq_u32 vcc,0,v18
s_lshl_b32 s56,s46,2
s_add_u32 s56,s56,155648
v_mov_b32 v238,s56
s_cmp_lg_u64 vcc,0
s_cselect_b32 s72,1,0
s_cmp_ge_u32 s77,64
s_cselect_b32 s72,1,s72
v_mov_b32 v239,s72
ds_write_b32 v238,v239
s_waitcnt lgkmcnt(0)
s_barrier
s_branch L_aa_223
L_aa_233:
s_cmp_lg_u32 s86,1536
s_cbranch_scc1 L_az_257
L_aa_222:
s_waitcnt vmcnt(0)
buffer_store_dword v20,off,s[8:11],s73 sc1
s_mov_b32 s73,0x80000000
s_mov_b32 s59,11011712
v_and_b32 v238,12,v16
v_mov_b32 v239,0
L_aw_258:
v_cmp_eq_u32 vcc,0,v239
s_cbranch_vccz L_awd_259
s_sleep 2
buffer_load_dword v239,v238,s[8:11],s59 offen sc1
s_sub_u32 s49,s49,1
s_cbranch_scc1 L_abort2
s_waitcnt vmcnt(0)
s_branch L_aw_258
L_awd_259:
v_readlane_b32 s55,v239,0
v_readlane_b32 s84,v239,1
v_readlane_b32 s56,v239,2
v_readlane_b32 s58,v239,3
s_sub_u32 s55,s55,1
s_bitset0_b32 s84,31
s_bitset0_b32 s56,31
s_mov_b32 s57,0
s_lshl_b64 s[56:57],s[56:57],22
s_or_b32 s84,s84,s56
s_lshl_b32 s58,s58,12
s_or_b32 s85,s57,s58
s_mov_b32 s86,768
s_mov_b32 s30,1
s_mov_b32 s65,s54
L_as_260:
s_ff1_i32_b64 s77,s[84:85]
s_bitset0_b64 s[84:85],s77
s_min_u32 s77,s77,64
s_sub_u32 s65,s65,1
s_cbranch_scc0 L_as_260
s_lshr_b32 s61,s55,5
s_lshl_b32 s56,s77,5
s_add_u32 s56,s56,s68
s_mul_i32 s70,s56,24576
s_lshl_b32 s71,s56,13
s_lshl_b32 s59,s77,13
s_lshl2_add_u32 s59,s68,s59
s_add_u32 s59,s59,10485760
s_cmp_lt_u32 s77,s61
s_cselect_b32 s57,0,16777216
s_cselect_b32 s60,0,128
s_add_u32 s71,s71,s57
s_add_u32 s71,s71,58720256
s_add_u32 s60,s60,s59
s_add_u32 s60,s60,512
s_cmp_eq_u32 s77,s61
s_cselect_b32 s57,50331648,0
s_cselect_b32 s58,1536,0
s_add_u32 s70,s70,s57
s_add_u32 s70,s70,150994944
s_add_u32 s59,s59,s58
s_add_u32 s59,s59,384
v_mov_b32 v19,s59
v_writelane_b32 v19,s60,1
buffer_load_dword v18,v19,s[8:11],0 offen sc1
s_cmp_lt_u32 s77,64
s_cbranch_scc1 L_aa_231
L_az_257:
s_waitcnt vmcnt(0)
buffer_store_dword v20,off,s[8:11],s73 sc1
s_mov_b32 s73,0x80000000
s_endpgm
L_wm:
s_nop 11
v_and_b32 v120,15,v1
v_lshrrev_b32 v121,4,v1
v_mov_b32 v17,1
s_lshl_b32 s56,s46,15
v_add_u32 v18,s56,v0
s_lshl_b32 s56,s46,2
v_add_u32 v125,s56,v121
v_xor_b32 v126,v125,v120
v_lshlrev_b32 v126,4,v126
v_lshl_add_u32 v20,v125,10,v126
v_add_u32 v125,0,v121
v_xor_b32 v125,v125,v120
v_lshlrev_b32 v125,4,v125
v_lshl_add_u32 v125,v120,8,v125
v_add_u32 v4,131072,v125
v_add_u32 v125,4,v121
v_xor_b32 v125,v125,v120
v_lshlrev_b32 v125,4,v125
v_lshl_add_u32 v125,v120,8,v125
v_add_u32 v5,131072,v125
v_add_u32 v125,8,v121
v_xor_b32 v125,v125,v120
v_lshlrev_b32 v125,4,v125
v_lshl_add_u32 v125,v120,8,v125
v_add_u32 v6,131072,v125
v_add_u32 v125,12,v121
v_xor_b32 v125,v125,v120
v_lshlrev_b32 v125,4,v125
v_lshl_add_u32 v125,v120,8,v125
v_add_u32 v7,131072,v125
v_lshlrev_b32 v21,5,v120
v_and_b32 v125,1,v121
v_lshl_add_u32 v21,v125,4,v21
s_lshl_b32 s56,s46,9
v_lshrrev_b32 v125,1,v121
v_lshl_add_u32 v21,v125,11,v21
s_add_u32 s56,s56,155648
v_add_u32 v21,s56,v21
v_lshlrev_b32 v22,4,v120
v_lshl_add_u32 v22,v121,10,v22
s_lshl_b32 s56,s46,8
v_add_u32 v22,s56,v22
s_mov_b32 s54,0
s_mov_b32 s31,0
s_mov_b32 s53,3
s_mov_b32 s72,0x80000000
s_mov_b32 s73,0
s_mov_b32 s77,-1
s_mov_b64 s[84:85],0
s_mov_b32 s74,614203392
s_mov_b32 s75,1227133513
s_ff1_i32_b64 s30,s[74:75]
s_bitset0_b64 s[74:75],s30
s_min_u32 s30,s30,127
s_lshl_b32 s70,s30,15
s_add_u32 s70,s70,0
s_add_u32 s71,s70,16384
s_add_u32 m0,s50,131072
s_nop 0
buffer_load_dwordx4 v20,s[8:11],s70 offen offset:0 sc1 lds
s_add_u32 m0,s50,135168
s_nop 0
buffer_load_dwordx4 v20,s[8:11],s71 offen offset:0 sc1 lds
s_add_u32 m0,s50,139008
s_nop 0
buffer_load_dwordx4 v20,s[8:11],s70 offen offset:256 sc1 lds
s_add_u32 m0,s50,143104
s_nop 0
buffer_load_dwordx4 v20,s[8:11],s71 offen offset:256 sc1 lds
s_add_u32 m0,s50,146944
s_nop 0
buffer_load_dwordx4 v20,s[8:11],s70 offen offset:512 sc1 lds
s_add_u32 m0,s50,151040
s_nop 0
buffer_load_dwordx4 v20,s[8:11],s71 offen offset:512 sc1 lds
v_and_b32 v23,31,v1
v_lshlrev_b32 v23,2,v23
s_waitcnt vmcnt(0)
L_mo_262:
s_mov_b32 s51,s30
s_mov_b64 s[68:69],s[70:71]
s_ff1_i32_b64 s30,s[74:75]
s_bitset0_b64 s[74:75],s30
s_min_u32 s30,s30,127
s_lshl_b32 s70,s30,15
s_add_u32 s70,s70,0
s_add_u32 s71,s70,16384
s_lshl_b32 s76,s31,13
s_add_u32 s76,s76,10487168
s_lshl_b32 s58,s51,5
s_add_u32 s58,s58,s47
s_mul_i32 s58,s58,24576
s_add_u32 s58,s58,100663296
s_add_u32 s61,s58,s50
s_add_u32 s62,s61,4096
s_add_u32 s63,s61,16384
s_add_u32 s64,s61,20480
s_add_u32 s65,s61,s50
s_add_u32 s65,s65,8192
s_waitcnt vmcnt(13)
s_barrier
ds_read_b128 v[72:75],v4 offset:0
ds_read_b128 v[76:79],v4 offset:4096
ds_read_b128 v[80:83],v5 offset:0
ds_read_b128 v[84:87],v5 offset:4096
s_add_u32 m0,s50,154880
s_nop 0
buffer_load_dwordx4 v20,s[8:11],s68 offen offset:768 sc1 lds
s_add_u32 m0,s50,158976
s_nop 0
buffer_load_dwordx4 v20,s[8:11],s69 offen offset:768 sc1 lds
s_waitcnt lgkmcnt(2)
v_mfma_f32_16x16x32_bf16 v[40:43],a[128:131],v[72:75],0
ds_read_b128 v[108:111],v6 offset:0
v_mfma_f32_16x16x32_bf16 v[56:59],v[72:75],v[128:131],0
v_mfma_f32_16x16x32_bf16 v[24:27],a[0:3],v[72:75],0
ds_read_b128 v[112:115],v6 offset:4096
v_mfma_f32_16x16x32_bf16 v[44:47],a[128:131],v[76:79],0
v_mfma_f32_16x16x32_bf16 v[60:63],v[76:79],v[128:131],0
v_mfma_f32_16x16x32_bf16 v[28:31],a[0:3],v[76:79],0
v_mfma_f32_16x16x32_bf16 v[48:51],a[136:139],v[72:75],0
v_mfma_f32_16x16x32_bf16 v[64:67],v[72:75],v[136:139],0
v_mfma_f32_16x16x32_bf16 v[32:35],a[8:11],v[72:75],0
v_mfma_f32_16x16x32_bf16 v[52:55],a[136:139],v[76:79],0
v_mfma_f32_16x16x32_bf16 v[68:71],v[76:79],v[136:139],0
v_mfma_f32_16x16x32_bf16 v[36:39],a[8:11],v[76:79],0
s_waitcnt lgkmcnt(2)
v_mfma_f32_16x16x32_bf16 v[40:43],a[132:135],v[80:83],v[40:43]
ds_read_b128 v[72:75],v7 offset:0
v_mfma_f32_16x16x32_bf16 v[56:59],v[80:83],v[132:135],v[56:59]
v_mfma_f32_16x16x32_bf16 v[24:27],a[4:7],v[80:83],v[24:27]
ds_read_b128 v[76:79],v7 offset:4096
v_mfma_f32_16x16x32_bf16 v[44:47],a[132:135],v[84:87],v[44:47]
v_mfma_f32_16x16x32_bf16 v[60:63],v[84:87],v[132:135],v[60:63]
v_mfma_f32_16x16x32_bf16 v[28:31],a[4:7],v[84:87],v[28:31]
v_mfma_f32_16x16x32_bf16 v[48:51],a[140:143],v[80:83],v[48:51]
v_mfma_f32_16x16x32_bf16 v[64:67],v[80:83],v[140:143],v[64:67]
v_mfma_f32_16x16x32_bf16 v[32:35],a[12:15],v[80:83],v[32:35]
v_mfma_f32_16x16x32_bf16 v[52:55],a[140:143],v[84:87],v[52:55]
v_mfma_f32_16x16x32_bf16 v[68:71],v[84:87],v[140:143],v[68:71]
v_mfma_f32_16x16x32_bf16 v[36:39],a[12:15],v[84:87],v[36:39]
s_waitcnt vmcnt(13)
s_barrier
s_waitcnt lgkmcnt(2)
v_mfma_f32_16x16x32_bf16 v[40:43],a[144:147],v[108:111],v[40:43]
ds_read_b128 v[80:83],v4 offset:8192
v_mfma_f32_16x16x32_bf16 v[56:59],v[108:111],v[144:147],v[56:59]
v_mfma_f32_16x16x32_bf16 v[24:27],a[16:19],v[108:111],v[24:27]
ds_read_b128 v[84:87],v4 offset:12288
v_mfma_f32_16x16x32_bf16 v[44:47],a[144:147],v[112:115],v[44:47]
v_mfma_f32_16x16x32_bf16 v[60:63],v[112:115],v[144:147],v[60:63]
v_mfma_f32_16x16x32_bf16 v[28:31],a[16:19],v[112:115],v[28:31]
v_mfma_f32_16x16x32_bf16 v[48:51],a[152:155],v[108:111],v[48:51]
v_mfma_f32_16x16x32_bf16 v[64:67],v[108:111],v[152:155],v[64:67]
v_mfma_f32_16x16x32_bf16 v[32:35],a[24:27],v[108:111],v[32:35]
v_mfma_f32_16x16x32_bf16 v[52:55],a[152:155],v[112:115],v[52:55]
v_mfma_f32_16x16x32_bf16 v[68:71],v[112:115],v[152:155],v[68:71]
v_mfma_f32_16x16x32_bf16 v[36:39],a[24:27],v[112:115],v[36:39]
s_waitcnt lgkmcnt(2)
v_mfma_f32_16x16x32_bf16 v[40:43],a[148:151],v[72:75],v[40:43]
ds_read_b128 v[108:111],v5 offset:8192
v_mfma_f32_16x16x32_bf16 v[56:59],v[72:75],v[148:151],v[56:59]
v_mfma_f32_16x16x32_bf16 v[24:27],a[20:23],v[72:75],v[24:27]
ds_read_b128 v[112:115],v5 offset:12288
v_mfma_f32_16x16x32_bf16 v[44:47],a[148:151],v[76:79],v[44:47]
v_mfma_f32_16x16x32_bf16 v[60:63],v[76:79],v[148:151],v[60:63]
v_mfma_f32_16x16x32_bf16 v[28:31],a[20:23],v[76:79],v[28:31]
v_mfma_f32_16x16x32_bf16 v[48:51],a[156:159],v[72:75],v[48:51]
v_mfma_f32_16x16x32_bf16 v[64:67],v[72:75],v[156:159],v[64:67]
v_mfma_f32_16x16x32_bf16 v[32:35],a[28:31],v[72:75],v[32:35]
v_mfma_f32_16x16x32_bf16 v[52:55],a[156:159],v[76:79],v[52:55]
v_mfma_f32_16x16x32_bf16 v[68:71],v[76:79],v[156:159],v[68:71]
v_mfma_f32_16x16x32_bf16 v[36:39],a[28:31],v[76:79],v[36:39]
s_waitcnt lgkmcnt(2)
v_mfma_f32_16x16x32_bf16 v[40:43],a[160:163],v[80:83],v[40:43]
ds_read_b128 v[72:75],v6 offset:8192
v_mfma_f32_16x16x32_bf16 v[56:59],v[80:83],v[160:163],v[56:59]
v_mfma_f32_16x16x32_bf16 v[24:27],a[32:35],v[80:83],v[24:27]
ds_read_b128 v[76:79],v6 offset:12288
v_mfma_f32_16x16x32_bf16 v[44:47],a[160:163],v[84:87],v[44:47]
v_mfma_f32_16x16x32_bf16 v[60:63],v[84:87],v[160:163],v[60:63]
v_mfma_f32_16x16x32_bf16 v[28:31],a[32:35],v[84:87],v[28:31]
v_mfma_f32_16x16x32_bf16 v[48:51],a[168:171],v[80:83],v[48:51]
v_mfma_f32_16x16x32_bf16 v[64:67],v[80:83],v[168:171],v[64:67]
v_mfma_f32_16x16x32_bf16 v[32:35],a[40:43],v[80:83],v[32:35]
v_mfma_f32_16x16x32_bf16 v[52:55],a[168:171],v[84:87],v[52:55]
v_mfma_f32_16x16x32_bf16 v[68:71],v[84:87],v[168:171],v[68:71]
v_mfma_f32_16x16x32_bf16 v[36:39],a[40:43],v[84:87],v[36:39]
s_waitcnt lgkmcnt(2)
v_mfma_f32_16x16x32_bf16 v[40:43],a[164:167],v[108:111],v[40:43]
ds_read_b128 v[80:83],v7 offset:8192
v_mfma_f32_16x16x32_bf16 v[56:59],v[108:111],v[164:167],v[56:59]
v_mfma_f32_16x16x32_bf16 v[24:27],a[36:39],v[108:111],v[24:27]
ds_read_b128 v[84:87],v7 offset:12288
v_mfma_f32_16x16x32_bf16 v[44:47],a[164:167],v[112:115],v[44:47]
v_mfma_f32_16x16x32_bf16 v[60:63],v[112:115],v[164:167],v[60:63]
v_mfma_f32_16x16x32_bf16 v[28:31],a[36:39],v[112:115],v[28:31]
v_mfma_f32_16x16x32_bf16 v[48:51],a[172:175],v[108:111],v[48:51]
v_mfma_f32_16x16x32_bf16 v[64:67],v[108:111],v[172:175],v[64:67]
v_mfma_f32_16x16x32_bf16 v[32:35],a[44:47],v[108:111],v[32:35]
v_mfma_f32_16x16x32_bf16 v[52:55],a[172:175],v[112:115],v[52:55]
v_mfma_f32_16x16x32_bf16 v[68:71],v[112:115],v[172:175],v[68:71]
v_mfma_f32_16x16x32_bf16 v[36:39],a[44:47],v[112:115],v[36:39]
s_waitcnt vmcnt(11)
s_barrier
s_waitcnt lgkmcnt(2)
v_mfma_f32_16x16x32_bf16 v[40:43],a[176:179],v[72:75],v[40:43]
ds_read_b128 v[108:111],v4 offset:16384
v_mfma_f32_16x16x32_bf16 v[56:59],v[72:75],v[176:179],v[56:59]
v_mfma_f32_16x16x32_bf16 v[24:27],a[48:51],v[72:75],v[24:27]
ds_read_b128 v[112:115],v4 offset:20480
v_mfma_f32_16x16x32_bf16 v[44:47],a[176:179],v[76:79],v[44:47]
v_mfma_f32_16x16x32_bf16 v[60:63],v[76:79],v[176:179],v[60:63]
v_mfma_f32_16x16x32_bf16 v[28:31],a[48:51],v[76:79],v[28:31]
v_mfma_f32_16x16x32_bf16 v[48:51],a[184:187],v[72:75],v[48:51]
v_mfma_f32_16x16x32_bf16 v[64:67],v[72:75],v[184:187],v[64:67]
v_mfma_f32_16x16x32_bf16 v[32:35],a[56:59],v[72:75],v[32:35]
v_mfma_f32_16x16x32_bf16 v[52:55],a[184:187],v[76:79],v[52:55]
v_mfma_f32_16x16x32_bf16 v[68:71],v[76:79],v[184:187],v[68:71]
v_mfma_f32_16x16x32_bf16 v[36:39],a[56:59],v[76:79],v[36:39]
s_waitcnt vmcnt(2)
s_barrier
s_or_b32 s72,s72,s52
buffer_store_dword v17,off,s[8:11],s72 sc1
s_waitcnt lgkmcnt(2)
v_mfma_f32_16x16x32_bf16 v[40:43],a[180:183],v[80:83],v[40:43]
ds_read_b128 v[72:75],v5 offset:16384
v_mfma_f32_16x16x32_bf16 v[56:59],v[80:83],v[180:183],v[56:59]
v_mfma_f32_16x16x32_bf16 v[24:27],a[52:55],v[80:83],v[24:27]
ds_read_b128 v[76:79],v5 offset:20480
v_mfma_f32_16x16x32_bf16 v[44:47],a[180:183],v[84:87],v[44:47]
v_mfma_f32_16x16x32_bf16 v[60:63],v[84:87],v[180:183],v[60:63]
v_mfma_f32_16x16x32_bf16 v[28:31],a[52:55],v[84:87],v[28:31]
v_mfma_f32_16x16x32_bf16 v[48:51],a[188:191],v[80:83],v[48:51]
v_mfma_f32_16x16x32_bf16 v[64:67],v[80:83],v[188:191],v[64:67]
v_mfma_f32_16x16x32_bf16 v[32:35],a[60:63],v[80:83],v[32:35]
v_mfma_f32_16x16x32_bf16 v[52:55],a[188:191],v[84:87],v[52:55]
v_mfma_f32_16x16x32_bf16 v[68:71],v[84:87],v[188:191],v[68:71]
v_mfma_f32_16x16x32_bf16 v[36:39],a[60:63],v[84:87],v[36:39]
s_waitcnt lgkmcnt(2)
v_mfma_f32_16x16x32_bf16 v[40:43],a[192:195],v[108:111],v[40:43]
ds_read_b128 v[80:83],v6 offset:16384
v_mfma_f32_16x16x32_bf16 v[56:59],v[108:111],v[192:195],v[56:59]
v_mfma_f32_16x16x32_bf16 v[24:27],a[64:67],v[108:111],v[24:27]
ds_read_b128 v[84:87],v6 offset:20480
v_mfma_f32_16x16x32_bf16 v[44:47],a[192:195],v[112:115],v[44:47]
v_mfma_f32_16x16x32_bf16 v[60:63],v[112:115],v[192:195],v[60:63]
v_mfma_f32_16x16x32_bf16 v[28:31],a[64:67],v[112:115],v[28:31]
v_mfma_f32_16x16x32_bf16 v[48:51],a[200:203],v[108:111],v[48:51]
v_mfma_f32_16x16x32_bf16 v[64:67],v[108:111],v[200:203],v[64:67]
v_mfma_f32_16x16x32_bf16 v[32:35],a[72:75],v[108:111],v[32:35]
v_mfma_f32_16x16x32_bf16 v[52:55],a[200:203],v[112:115],v[52:55]
v_mfma_f32_16x16x32_bf16 v[68:71],v[112:115],v[200:203],v[68:71]
v_mfma_f32_16x16x32_bf16 v[36:39],a[72:75],v[112:115],v[36:39]
s_waitcnt lgkmcnt(2)
v_mfma_f32_16x16x32_bf16 v[40:43],a[196:199],v[72:75],v[40:43]
ds_read_b128 v[108:111],v7 offset:16384
v_mfma_f32_16x16x32_bf16 v[56:59],v[72:75],v[196:199],v[56:59]
v_mfma_f32_16x16x32_bf16 v[24:27],a[68:71],v[72:75],v[24:27]
ds_read_b128 v[112:115],v7 offset:20480
v_mfma_f32_16x16x32_bf16 v[44:47],a[196:199],v[76:79],v[44:47]
v_mfma_f32_16x16x32_bf16 v[60:63],v[76:79],v[196:199],v[60:63]
v_mfma_f32_16x16x32_bf16 v[28:31],a[68:71],v[76:79],v[28:31]
v_mfma_f32_16x16x32_bf16 v[48:51],a[204:207],v[72:75],v[48:51]
v_mfma_f32_16x16x32_bf16 v[64:67],v[72:75],v[204:207],v[64:67]
v_mfma_f32_16x16x32_bf16 v[32:35],a[76:79],v[72:75],v[32:35]
v_mfma_f32_16x16x32_bf16 v[52:55],a[204:207],v[76:79],v[52:55]
v_mfma_f32_16x16x32_bf16 v[68:71],v[76:79],v[204:207],v[68:71]
v_mfma_f32_16x16x32_bf16 v[36:39],a[76:79],v[76:79],v[36:39]
s_waitcnt vmcnt(1)
s_barrier
s_waitcnt lgkmcnt(2)
v_mfma_f32_16x16x32_bf16 v[40:43],a[208:211],v[80:83],v[40:43]
ds_read_b128 v[72:75],v4 offset:24576
v_mfma_f32_16x16x32_bf16 v[56:59],v[80:83],v[208:211],v[56:59]
v_mfma_f32_16x16x32_bf16 v[24:27],a[80:83],v[80:83],v[24:27]
ds_read_b128 v[76:79],v4 offset:28672
v_mfma_f32_16x16x32_bf16 v[44:47],a[208:211],v[84:87],v[44:47]
v_mfma_f32_16x16x32_bf16 v[60:63],v[84:87],v[208:211],v[60:63]
v_mfma_f32_16x16x32_bf16 v[28:31],a[80:83],v[84:87],v[28:31]
v_mfma_f32_16x16x32_bf16 v[48:51],a[216:219],v[80:83],v[48:51]
v_mfma_f32_16x16x32_bf16 v[64:67],v[80:83],v[216:219],v[64:67]
v_mfma_f32_16x16x32_bf16 v[32:35],a[88:91],v[80:83],v[32:35]
v_mfma_f32_16x16x32_bf16 v[52:55],a[216:219],v[84:87],v[52:55]
v_mfma_f32_16x16x32_bf16 v[68:71],v[84:87],v[216:219],v[68:71]
v_mfma_f32_16x16x32_bf16 v[36:39],a[88:91],v[84:87],v[36:39]
s_waitcnt lgkmcnt(2)
v_mfma_f32_16x16x32_bf16 v[40:43],a[212:215],v[108:111],v[40:43]
ds_read_b128 v[80:83],v5 offset:24576
v_mfma_f32_16x16x32_bf16 v[56:59],v[108:111],v[212:215],v[56:59]
v_mfma_f32_16x16x32_bf16 v[24:27],a[84:87],v[108:111],v[24:27]
ds_read_b128 v[84:87],v5 offset:28672
v_mfma_f32_16x16x32_bf16 v[44:47],a[212:215],v[112:115],v[44:47]
v_mfma_f32_16x16x32_bf16 v[60:63],v[112:115],v[212:215],v[60:63]
v_mfma_f32_16x16x32_bf16 v[28:31],a[84:87],v[112:115],v[28:31]
v_mfma_f32_16x16x32_bf16 v[48:51],a[220:223],v[108:111],v[48:51]
v_mfma_f32_16x16x32_bf16 v[64:67],v[108:111],v[220:223],v[64:67]
v_mfma_f32_16x16x32_bf16 v[32:35],a[92:95],v[108:111],v[32:35]
v_mfma_f32_16x16x32_bf16 v[52:55],a[220:223],v[112:115],v[52:55]
v_mfma_f32_16x16x32_bf16 v[68:71],v[112:115],v[220:223],v[68:71]
v_mfma_f32_16x16x32_bf16 v[36:39],a[92:95],v[112:115],v[36:39]
s_barrier
s_waitcnt lgkmcnt(2)
v_mfma_f32_16x16x32_bf16 v[40:43],a[224:227],v[72:75],v[40:43]
ds_read_b128 v[108:111],v6 offset:24576
v_mfma_f32_16x16x32_bf16 v[56:59],v[72:75],v[224:227],v[56:59]
s_add_u32 m0,s50,131072
v_mfma_f32_16x16x32_bf16 v[24:27],a[96:99],v[72:75],v[24:27]
ds_read_b128 v[112:115],v6 offset:28672
v_mfma_f32_16x16x32_bf16 v[44:47],a[224:227],v[76:79],v[44:47]
buffer_load_dwordx4 v20,s[8:11],s70 offen offset:0 sc1 lds
v_mfma_f32_16x16x32_bf16 v[60:63],v[76:79],v[224:227],v[60:63]
s_add_u32 m0,s50,135168
v_mfma_f32_16x16x32_bf16 v[28:31],a[96:99],v[76:79],v[28:31]
buffer_load_dwordx4 v20,s[8:11],s71 offen offset:0 sc1 lds
v_mfma_f32_16x16x32_bf16 v[48:51],a[232:235],v[72:75],v[48:51]
s_add_u32 m0,s50,139008
v_mfma_f32_16x16x32_bf16 v[64:67],v[72:75],v[232:235],v[64:67]
buffer_load_dwordx4 v20,s[8:11],s70 offen offset:256 sc1 lds
v_mfma_f32_16x16x32_bf16 v[32:35],a[104:107],v[72:75],v[32:35]
s_add_u32 m0,s50,143104
v_mfma_f32_16x16x32_bf16 v[52:55],a[232:235],v[76:79],v[52:55]
buffer_load_dwordx4 v20,s[8:11],s71 offen offset:256 sc1 lds
v_mfma_f32_16x16x32_bf16 v[68:71],v[76:79],v[232:235],v[68:71]
s_add_u32 m0,s50,146944
v_mfma_f32_16x16x32_bf16 v[36:39],a[104:107],v[76:79],v[36:39]
buffer_load_dwordx4 v20,s[8:11],s70 offen offset:512 sc1 lds
s_waitcnt lgkmcnt(2)
v_mfma_f32_16x16x32_bf16 v[40:43],a[228:231],v[80:83],v[40:43]
ds_read_b128 v[72:75],v7 offset:24576
v_mfma_f32_16x16x32_bf16 v[56:59],v[80:83],v[228:231],v[56:59]
s_add_u32 m0,s50,151040
v_mfma_f32_16x16x32_bf16 v[24:27],a[100:103],v[80:83],v[24:27]
ds_read_b128 v[76:79],v7 offset:28672
v_mfma_f32_16x16x32_bf16 v[44:47],a[228:231],v[84:87],v[44:47]
buffer_load_dwordx4 v20,s[8:11],s71 offen offset:512 sc1 lds
v_mfma_f32_16x16x32_bf16 v[60:63],v[84:87],v[228:231],v[60:63]
buffer_load_dword v125,v23,s[8:11],s76 offen sc1
v_mfma_f32_16x16x32_bf16 v[28:31],a[100:103],v[84:87],v[28:31]
v_mfma_f32_16x16x32_bf16 v[48:51],a[236:239],v[80:83],v[48:51]
v_mfma_f32_16x16x32_bf16 v[64:67],v[80:83],v[236:239],v[64:67]
v_mfma_f32_16x16x32_bf16 v[32:35],a[108:111],v[80:83],v[32:35]
v_mfma_f32_16x16x32_bf16 v[52:55],a[236:239],v[84:87],v[52:55]
v_mfma_f32_16x16x32_bf16 v[68:71],v[84:87],v[236:239],v[68:71]
v_mfma_f32_16x16x32_bf16 v[36:39],a[108:111],v[84:87],v[36:39]
s_waitcnt lgkmcnt(2)
v_mfma_f32_16x16x32_bf16 v[40:43],a[240:243],v[108:111],v[40:43]
v_mfma_f32_16x16x32_bf16 v[56:59],v[108:111],v[240:243],v[56:59]
v_mfma_f32_16x16x32_bf16 v[24:27],a[112:115],v[108:111],v[24:27]
v_mfma_f32_16x16x32_bf16 v[44:47],a[240:243],v[112:115],v[44:47]
v_mfma_f32_16x16x32_bf16 v[60:63],v[112:115],v[240:243],v[60:63]
v_mfma_f32_16x16x32_bf16 v[28:31],a[112:115],v[112:115],v[28:31]
v_mfma_f32_16x16x32_bf16 v[48:51],a[248:251],v[108:111],v[48:51]
v_mfma_f32_16x16x32_bf16 v[64:67],v[108:111],v[248:251],v[64:67]
v_mfma_f32_16x16x32_bf16 v[32:35],a[120:123],v[108:111],v[32:35]
v_mfma_f32_16x16x32_bf16 v[52:55],a[248:251],v[112:115],v[52:55]
v_mfma_f32_16x16x32_bf16 v[68:71],v[112:115],v[248:251],v[68:71]
v_mfma_f32_16x16x32_bf16 v[36:39],a[120:123],v[112:115],v[36:39]
s_waitcnt lgkmcnt(0)
v_mfma_f32_16x16x32_bf16 v[40:43],a[244:247],v[72:75],v[40:43]
v_mfma_f32_16x16x32_bf16 v[56:59],v[72:75],v[244:247],v[56:59]
v_mfma_f32_16x16x32_bf16 v[24:27],a[116:119],v[72:75],v[24:27]
v_mfma_f32_16x16x32_bf16 v[44:47],a[244:247],v[76:79],v[44:47]
v_mfma_f32_16x16x32_bf16 v[60:63],v[76:79],v[244:247],v[60:63]
v_mfma_f32_16x16x32_bf16 v[28:31],a[116:119],v[76:79],v[28:31]
v_mfma_f32_16x16x32_bf16 v[48:51],a[252:255],v[72:75],v[48:51]
v_mfma_f32_16x16x32_bf16 v[64:67],v[72:75],v[252:255],v[64:67]
v_mfma_f32_16x16x32_bf16 v[32:35],a[124:127],v[72:75],v[32:35]
v_mfma_f32_16x16x32_bf16 v[52:55],a[252:255],v[76:79],v[52:55]
v_mfma_f32_16x16x32_bf16 v[68:71],v[76:79],v[252:255],v[68:71]
v_mfma_f32_16x16x32_bf16 v[36:39],a[124:127],v[76:79],v[36:39]
s_lshl_b32 s56,s51,5
s_add_u32 s56,s56,s47
s_lshl_b32 s56,s56,13
s_add_u32 s56,s56,s50
s_add_u32 s56,s56,41943040
s_add_u32 s57,s56,4096
v_mov_b64 v[120:121],-1
v_mov_b64 v[122:123],-1
buffer_store_dwordx4 v[120:123],v0,s[8:11],s56 offen sc1
buffer_store_dwordx4 v[120:123],v0,s[8:11],s57 offen sc1
v_cvt_pk_bf16_f32 v72,v40,v48
v_cvt_pk_bf16_f32 v73,v41,v49
v_cvt_pk_bf16_f32 v74,v42,v50
v_cvt_pk_bf16_f32 v75,v43,v51
buffer_store_dwordx4 v[72:75],v0,s[8:11],s61 offen sc1
v_cvt_pk_bf16_f32 v76,v44,v52
v_cvt_pk_bf16_f32 v77,v45,v53
v_cvt_pk_bf16_f32 v78,v46,v54
v_cvt_pk_bf16_f32 v79,v47,v55
buffer_store_dwordx4 v[76:79],v0,s[8:11],s62 offen sc1
v_cvt_pk_bf16_f32 v80,v56,v57
v_cvt_pk_bf16_f32 v81,v58,v59
v_cvt_pk_bf16_f32 v82,v60,v61
v_cvt_pk_bf16_f32 v83,v62,v63
buffer_store_dwordx4 v[80:83],v0,s[8:11],s65 offen offset:0 sc1
v_cvt_pk_bf16_f32 v84,v64,v65
v_cvt_pk_bf16_f32 v85,v66,v67
v_cvt_pk_bf16_f32 v86,v68,v69
v_cvt_pk_bf16_f32 v87,v70,v71
buffer_store_dwordx4 v[84:87],v0,s[8:11],s65 offen offset:1024 sc1
v_cvt_pk_bf16_f32 v108,v24,v32
v_cvt_pk_bf16_f32 v109,v25,v33
v_cvt_pk_bf16_f32 v110,v26,v34
v_cvt_pk_bf16_f32 v111,v27,v35
buffer_store_dwordx4 v[108:111],v0,s[8:11],s63 offen sc1
v_cvt_pk_bf16_f32 v112,v28,v36
v_cvt_pk_bf16_f32 v113,v29,v37
v_cvt_pk_bf16_f32 v114,v30,v38
v_cvt_pk_bf16_f32 v115,v31,v39
buffer_store_dwordx4 v[112:115],v0,s[8:11],s64 offen sc1
s_lshl_b32 s72,s51,13
s_lshl2_add_u32 s72,s47,s72
s_add_u32 s72,s72,10485760
s_sub_u32 s53,s53,1
s_cmp_gt_i32 s53,0
s_cbranch_scc1 L_mo_262
s_add_u32 s73,s73,1
s_waitcnt vmcnt(8)
v_cmp_eq_u32 vcc,0,v125
s_cbranch_vccz L_mo_264
L_mo_261:
s_lshl_b32 s59,s31,13
s_add_u32 s59,s59,10487168
v_and_b32 v124,31,v1
v_lshlrev_b32 v124,2,v124
L_fw_269:
buffer_load_dword v125,v124,s[8:11],s59 offen sc1
s_sub_u32 s49,s49,1
s_cbranch_scc1 L_abort2
s_waitcnt vmcnt(0)
v_cmp_eq_u32 vcc,0,v125
s_cbranch_vccnz L_fw_269
L_mo_264:
v_max_u32_dpp v125,v125,v125 row_ror:8 row_mask:0xf bank_mask:0xf
s_nop 1
v_max_u32_dpp v125,v125,v125 row_ror:4 row_mask:0xf bank_mask:0xf
s_nop 1
v_max_u32_dpp v125,v125,v125 row_ror:2 row_mask:0xf bank_mask:0xf
s_nop 1
v_max_u32_dpp v125,v125,v125 row_ror:1 row_mask:0xf bank_mask:0xf
v_mov_b32 v124,v125
s_nop 1
v_permlane16_swap_b32 v125,v124
v_max_u32 v125,v125,v124
v_mov_b32 v124,v125
s_nop 1
v_permlane32_swap_b32 v125,v124
v_max_u32 v125,v125,v124
s_nop 0
v_readfirstlane_b32 s55,v125
s_sub_u32 s73,s73,1
s_max_i32 s73,s73,0
s_sub_u32 s77,s77,1
s_min_u32 s61,s73,3
s_cmp_gt_u32 s55,s54
s_cselect_b32 s60,2,1
s_cselect_b32 s77,s61,s77
s_cselect_b32 s54,s55,s54
s_cbranch_scc0 L_mo_267
s_bitset1_b64 s[84:85],s31
L_mo_267:
s_cmp_lg_u32 s31,63
s_cbranch_scc1 L_mo_268
s_min_i32 s77,s77,0
s_lshr_b64 s[88:89],s[84:85],1
s_lshr_b64 s[90:91],s[84:85],2
s_or_b64 s[88:89],s[88:89],s[90:91]
s_lshr_b64 s[90:91],s[84:85],3
s_or_b64 s[88:89],s[88:89],s[90:91]
s_lshr_b64 s[90:91],s[84:85],4
s_or_b64 s[88:89],s[88:89],s[90:91]
s_or_b32 s88,s88,268435455
s_or_b32 s89,s89,0
s_flbit_i32_b64 s61,s[84:85]
s_sub_u32 s61,63,s61
s_bfm_b64 s[90:91],s61,0
s_xor_b64 s[84:85],s[88:89],s[90:91]
s_or_b32 s84,s84,0
s_or_b32 s85,s85,4278190080
L_mo_268:
s_or_b32 s61,s47,s46
s_cmp_lg_u32 s61,0
s_cbranch_scc1 L_mo_263
v_mov_b32 v125,s60
s_lshl_b32 s59,s31,13
s_add_u32 s59,s59,10487040
buffer_store_dword v125,off,s[8:11],s59 sc1
s_cmp_lg_u32 s31,63
s_cbranch_scc1 L_mo_263
s_and_b32 s62,s54,0x7ff
s_sub_u32 s62,2048,s62
v_mov_b32 v120,s62
s_lshr_b64 s[88:89],s[84:85],0
s_and_b32 s88,s88,0x3fffff
s_bitset1_b32 s88,31
v_mov_b32 v121,s88
s_lshr_b64 s[88:89],s[84:85],22
s_and_b32 s88,s88,0x3fffff
s_bitset1_b32 s88,31
v_mov_b32 v122,s88
s_lshr_b64 s[88:89],s[84:85],44
s_and_b32 s88,s88,0x3fffff
s_bitset1_b32 s88,31
v_mov_b32 v123,s88
s_mov_b32 s59,11011712
buffer_store_dwordx4 v[120:123],off,s[8:11],s59 sc1
L_mo_263:
s_add_u32 s31,s31,1
s_cmp_gt_i32 s77,0
s_cbranch_scc1 L_mo_261
s_cmp_lg_u32 s77,0
s_cbranch_scc1 L_mo_265
s_waitcnt vmcnt(0)
s_barrier
s_or_b32 s72,s72,s52
buffer_store_dword v17,off,s[8:11],s72 sc1
s_mov_b32 s72,0x80000000
s_and_b32 s51,s54,0x7ff
s_sub_u32 s51,2047,s51
s_lshr_b32 s51,s51,5
s_add_u32 s73,s73,3
s_and_b32 s64,s54,0x7ff
s_sub_u32 s64,2047,s64
s_lshl_b32 s56,s64,10
s_add_u32 s58,s56,4194304
buffer_load_dwordx4 v[88:91],v0,s[8:11],s58 offen sc1
s_mov_b32 s4,s38
s_mov_b32 s5,s39
s_mov_b32 s6,1835008
s_mov_b32 s7,0x20000
v_and_b32 v9,15,v1
v_lshrrev_b32 v10,4,v1
v_lshlrev_b32 v8,14,v10
v_lshl_add_u32 v8,v9,4,v8
s_lshl_b32 s59,s47,16
s_lshl_b32 s60,s46,8
s_add_u32 s59,s59,s60
buffer_load_dwordx4 v[24:27],v8,s[4:7],s59 offen offset:0
buffer_load_dwordx4 v[28:31],v8,s[4:7],s59 offen offset:1024
buffer_load_dwordx4 v[32:35],v8,s[4:7],s59 offen offset:2048
buffer_load_dwordx4 v[36:39],v8,s[4:7],s59 offen offset:3072
s_add_u32 s59,s59,4096
buffer_load_dwordx4 v[40:43],v8,s[4:7],s59 offen offset:0
buffer_load_dwordx4 v[44:47],v8,s[4:7],s59 offen offset:1024
buffer_load_dwordx4 v[48:51],v8,s[4:7],s59 offen offset:2048
buffer_load_dwordx4 v[52:55],v8,s[4:7],s59 offen offset:3072
s_add_u32 s59,s59,4096
buffer_load_dwordx4 v[56:59],v8,s[4:7],s59 offen offset:0
buffer_load_dwordx4 v[60:63],v8,s[4:7],s59 offen offset:1024
buffer_load_dwordx4 v[64:67],v8,s[4:7],s59 offen offset:2048
buffer_load_dwordx4 v[68:71],v8,s[4:7],s59 offen offset:3072
s_add_u32 s59,s59,4096
buffer_load_dwordx4 v[72:75],v8,s[4:7],s59 offen offset:0
buffer_load_dwordx4 v[76:79],v8,s[4:7],s59 offen offset:1024
buffer_load_dwordx4 v[80:83],v8,s[4:7],s59 offen offset:2048
buffer_load_dwordx4 v[84:87],v8,s[4:7],s59 offen offset:3072
v_and_b32 v124,1,v1
v_lshlrev_b32 v124,4,v124
v_mov_b32 v125,0xffff
v_lshlrev_b32 v125,v124,v125
v_lshrrev_b32 v124,1,v9
v_cmp_eq_u32 vcc,0,v124
s_nop 1
v_cndmask_b32 v12,0,v125,vcc
v_cmp_eq_u32 vcc,1,v124
s_nop 1
v_cndmask_b32 v13,0,v125,vcc
v_cmp_eq_u32 vcc,2,v124
s_nop 1
v_cndmask_b32 v14,0,v125,vcc
v_cmp_eq_u32 vcc,3,v124
s_nop 1
v_cndmask_b32 v15,0,v125,vcc
s_waitcnt vmcnt(16)
L_mx_270:
v_max3_u32 v124,v88,v89,v90
v_max_u32 v124,v91,v124
v_cmp_eq_u32 vcc,-1,v124
s_cbranch_vccz L_mxd_271
buffer_load_dwordx4 v[88:91],v0,s[8:11],s58 offen sc1
s_sub_u32 s49,s49,1
s_cbranch_scc1 L_abort2
s_waitcnt vmcnt(0)
s_branch L_mx_270
L_mxd_271:
v_lshlrev_b32 v96,16,v88
v_and_b32 v97,0xffff0000,v88
v_lshlrev_b32 v98,16,v89
v_and_b32 v99,0xffff0000,v89
v_lshlrev_b32 v100,16,v90
v_and_b32 v101,0xffff0000,v90
v_lshlrev_b32 v102,16,v91
v_and_b32 v103,0xffff0000,v91
v_readfirstlane_b32 s78,v96
s_nop 1
v_pk_add_f32 v[108:109],v[96:97],s[78:79] op_sel_hi:[1,0] neg_lo:[0,1] neg_hi:[0,1]
v_pk_add_f32 v[110:111],v[98:99],s[78:79] op_sel_hi:[1,0] neg_lo:[0,1] neg_hi:[0,1]
v_pk_add_f32 v[112:113],v[100:101],s[78:79] op_sel_hi:[1,0] neg_lo:[0,1] neg_hi:[0,1]
v_pk_add_f32 v[114:115],v[102:103],s[78:79] op_sel_hi:[1,0] neg_lo:[0,1] neg_hi:[0,1]
v_pk_add_f32 v[116:117],v[108:109],v[110:111]
v_pk_mul_f32 v[118:119],v[108:109],v[108:109]
v_pk_add_f32 v[120:121],v[112:113],v[114:115]
v_pk_fma_f32 v[118:119],v[110:111],v[110:111],v[118:119]
v_pk_add_f32 v[116:117],v[116:117],v[120:121]
v_pk_fma_f32 v[118:119],v[112:113],v[112:113],v[118:119]
v_add_f32 v116,v116,v117
v_pk_fma_f32 v[118:119],v[114:115],v[114:115],v[118:119]
v_add_f32 v118,v118,v119
s_nop 1
v_permlane32_swap_b32 v116,v118
v_add_f32 v116,v116,v118
s_nop 1
v_add_f32_dpp v116,v116,v116 row_ror:8 row_mask:0xf bank_mask:0xf
s_nop 1
v_add_f32_dpp v116,v116,v116 row_ror:4 row_mask:0xf bank_mask:0xf
s_nop 1
v_add_f32_dpp v116,v116,v116 row_ror:2 row_mask:0xf bank_mask:0xf
s_nop 1
v_add_f32_dpp v116,v116,v116 row_ror:1 row_mask:0xf bank_mask:0xf
v_mov_b32 v118,v116
s_nop 1
v_permlane16_swap_b32 v116,v118
v_add_f32 v116,v116,v118
v_mul_f32 v116,0x3b000000,v116
v_mov_b32 v118,v116
s_nop 1
v_permlane32_swap_b32 v116,v118
v_fma_f32 v118,-v116,v116,v118
v_add_f32 v116,s78,v116
v_max_f32 v118,0,v118
v_cvt_pk_bf16_f32 v118,v116,v118
v_lshlrev_b32 v116,16,v118
v_and_b32 v118,0xffff0000,v118
v_add_f32 v118,0x3727c5ac,v118
v_cvt_pk_bf16_f32 v118,v118,v118
v_and_b32 v118,0xffff0000,v118
v_sqrt_f32 v118,v118
v_pk_add_f32 v[108:109],v[96:97],v[116:117] op_sel_hi:[1,0] neg_lo:[0,1] neg_hi:[0,1]
v_pk_add_f32 v[110:111],v[98:99],v[116:117] op_sel_hi:[1,0] neg_lo:[0,1] neg_hi:[0,1]
v_pk_add_f32 v[112:113],v[100:101],v[116:117] op_sel_hi:[1,0] neg_lo:[0,1] neg_hi:[0,1]
v_pk_add_f32 v[114:115],v[102:103],v[116:117] op_sel_hi:[1,0] neg_lo:[0,1] neg_hi:[0,1]
v_cvt_pk_bf16_f32 v118,v118,v118
v_and_b32 v118,0xffff0000,v118
v_rcp_f32 v118,v118
v_cvt_pk_bf16_f32 v104,v108,v109
v_cvt_pk_bf16_f32 v105,v110,v111
v_cvt_pk_bf16_f32 v106,v112,v113
v_cvt_pk_bf16_f32 v107,v114,v115
v_lshlrev_b32 v108,16,v104
v_and_b32 v109,0xffff0000,v104
v_lshlrev_b32 v110,16,v105
v_and_b32 v111,0xffff0000,v105
v_lshlrev_b32 v112,16,v106
v_and_b32 v113,0xffff0000,v106
v_lshlrev_b32 v114,16,v107
v_and_b32 v115,0xffff0000,v107
v_pk_mul_f32 v[108:109],v[108:109],v[118:119] op_sel_hi:[1,0]
v_pk_mul_f32 v[110:111],v[110:111],v[118:119] op_sel_hi:[1,0]
v_pk_mul_f32 v[112:113],v[112:113],v[118:119] op_sel_hi:[1,0]
v_pk_mul_f32 v[114:115],v[114:115],v[118:119] op_sel_hi:[1,0]
v_cvt_pk_bf16_f32 v104,v108,v109
v_cvt_pk_bf16_f32 v105,v110,v111
v_cvt_pk_bf16_f32 v106,v112,v113
v_cvt_pk_bf16_f32 v107,v114,v115
s_mov_b32 s58,0x01000100
s_mov_b32 s59,0x03020302
v_perm_b32 v88,v104,v104,s58
v_perm_b32 v89,v104,v104,s59
v_perm_b32 v90,v105,v105,s58
v_perm_b32 v91,v105,v105,s59
v_perm_b32 v92,v106,v106,s58
v_perm_b32 v93,v106,v106,s59
v_perm_b32 v94,v107,v107,s58
v_perm_b32 v95,v107,v107,s59
v_lshlrev_b32 v8,5,v1
s_lshl_b32 s58,s46,11
s_add_u32 s58,s58,139264
v_add_u32 v8,s58,v8
ds_write_b128 v8,v[88:91]
ds_write_b128 v8,v[92:95] offset:16
s_lshl_b32 s59,s46,9
s_add_u32 s59,s58,s59
v_lshlrev_b32 v8,7,v10
v_add_u32 v8,s59,v8
s_waitcnt lgkmcnt(0)
ds_read_b128 v[108:111],v18 offset:0
ds_read_b128 v[88:91],v8 offset:0
ds_read_b128 v[92:95],v8 offset:16
ds_read_b128 v[112:115],v18 offset:1024
s_waitcnt lgkmcnt(1)
v_and_b32 v124,v12,v88
v_and_b32 v125,v13,v88
v_and_b32 v126,v14,v88
v_and_b32 v127,v15,v88
s_nop 1
v_mfma_f32_16x16x32_bf16 v[116:119],v[124:127],v[108:111],0
ds_read_b128 v[108:111],v18 offset:2048
s_waitcnt lgkmcnt(1)
v_and_b32 v124,v12,v89
v_and_b32 v125,v13,v89
v_and_b32 v126,v14,v89
v_and_b32 v127,v15,v89
s_nop 1
v_mfma_f32_16x16x32_bf16 v[116:119],v[124:127],v[112:115],v[116:119]
ds_read_b128 v[112:115],v18 offset:3072
s_waitcnt lgkmcnt(1)
v_and_b32 v124,v12,v90
v_and_b32 v125,v13,v90
v_and_b32 v126,v14,v90
v_and_b32 v127,v15,v90
s_nop 1
v_mfma_f32_16x16x32_bf16 v[116:119],v[124:127],v[108:111],v[116:119]
ds_read_b128 v[108:111],v18 offset:4096
s_waitcnt lgkmcnt(1)
v_and_b32 v124,v12,v91
v_and_b32 v125,v13,v91
v_and_b32 v126,v14,v91
v_and_b32 v127,v15,v91
s_nop 1
v_mfma_f32_16x16x32_bf16 v[116:119],v[124:127],v[112:115],v[116:119]
ds_read_b128 v[112:115],v18 offset:5120
s_waitcnt lgkmcnt(1)
v_and_b32 v124,v12,v92
v_and_b32 v125,v13,v92
v_and_b32 v126,v14,v92
v_and_b32 v127,v15,v92
s_nop 1
v_mfma_f32_16x16x32_bf16 v[116:119],v[124:127],v[108:111],v[116:119]
ds_read_b128 v[108:111],v18 offset:6144
s_waitcnt lgkmcnt(1)
v_and_b32 v124,v12,v93
v_and_b32 v125,v13,v93
v_and_b32 v126,v14,v93
v_and_b32 v127,v15,v93
s_nop 1
v_mfma_f32_16x16x32_bf16 v[116:119],v[124:127],v[112:115],v[116:119]
ds_read_b128 v[112:115],v18 offset:7168
s_waitcnt lgkmcnt(1)
v_and_b32 v124,v12,v94
v_and_b32 v125,v13,v94
v_and_b32 v126,v14,v94
v_and_b32 v127,v15,v94
s_nop 1
v_mfma_f32_16x16x32_bf16 v[116:119],v[124:127],v[108:111],v[116:119]
ds_read_b128 v[108:111],v18 offset:8192
s_waitcnt lgkmcnt(1)
v_and_b32 v124,v12,v95
v_and_b32 v125,v13,v95
v_and_b32 v126,v14,v95
v_and_b32 v127,v15,v95
s_nop 1
v_mfma_f32_16x16x32_bf16 v[116:119],v[124:127],v[112:115],v[116:119]
ds_read_b128 v[88:91],v8 offset:32
ds_read_b128 v[92:95],v8 offset:48
ds_read_b128 v[112:115],v18 offset:9216
s_waitcnt lgkmcnt(1)
v_and_b32 v124,v12,v88
v_and_b32 v125,v13,v88
v_and_b32 v126,v14,v88
v_and_b32 v127,v15,v88
s_nop 1
v_mfma_f32_16x16x32_bf16 v[116:119],v[124:127],v[108:111],v[116:119]
ds_read_b128 v[108:111],v18 offset:10240
s_waitcnt lgkmcnt(1)
v_and_b32 v124,v12,v89
v_and_b32 v125,v13,v89
v_and_b32 v126,v14,v89
v_and_b32 v127,v15,v89
s_nop 1
v_mfma_f32_16x16x32_bf16 v[116:119],v[124:127],v[112:115],v[116:119]
ds_read_b128 v[112:115],v18 offset:11264
s_waitcnt lgkmcnt(1)
v_and_b32 v124,v12,v90
v_and_b32 v125,v13,v90
v_and_b32 v126,v14,v90
v_and_b32 v127,v15,v90
s_nop 1
v_mfma_f32_16x16x32_bf16 v[116:119],v[124:127],v[108:111],v[116:119]
ds_read_b128 v[108:111],v18 offset:12288
s_waitcnt lgkmcnt(1)
v_and_b32 v124,v12,v91
v_and_b32 v125,v13,v91
v_and_b32 v126,v14,v91
v_and_b32 v127,v15,v91
s_nop 1
v_mfma_f32_16x16x32_bf16 v[116:119],v[124:127],v[112:115],v[116:119]
ds_read_b128 v[112:115],v18 offset:13312
s_waitcnt lgkmcnt(1)
v_and_b32 v124,v12,v92
v_and_b32 v125,v13,v92
v_and_b32 v126,v14,v92
v_and_b32 v127,v15,v92
s_nop 1
v_mfma_f32_16x16x32_bf16 v[116:119],v[124:127],v[108:111],v[116:119]
ds_read_b128 v[108:111],v18 offset:14336
s_waitcnt lgkmcnt(1)
v_and_b32 v124,v12,v93
v_and_b32 v125,v13,v93
v_and_b32 v126,v14,v93
v_and_b32 v127,v15,v93
s_nop 1
v_mfma_f32_16x16x32_bf16 v[116:119],v[124:127],v[112:115],v[116:119]
ds_read_b128 v[112:115],v18 offset:15360
s_waitcnt lgkmcnt(1)
v_and_b32 v124,v12,v94
v_and_b32 v125,v13,v94
v_and_b32 v126,v14,v94
v_and_b32 v127,v15,v94
s_nop 1
v_mfma_f32_16x16x32_bf16 v[116:119],v[124:127],v[108:111],v[116:119]
ds_read_b128 v[108:111],v18 offset:16384
s_waitcnt lgkmcnt(1)
v_and_b32 v124,v12,v95
v_and_b32 v125,v13,v95
v_and_b32 v126,v14,v95
v_and_b32 v127,v15,v95
s_nop 1
v_mfma_f32_16x16x32_bf16 v[116:119],v[124:127],v[112:115],v[116:119]
ds_read_b128 v[88:91],v8 offset:64
ds_read_b128 v[92:95],v8 offset:80
ds_read_b128 v[112:115],v18 offset:17408
s_waitcnt lgkmcnt(1)
v_and_b32 v124,v12,v88
v_and_b32 v125,v13,v88
v_and_b32 v126,v14,v88
v_and_b32 v127,v15,v88
s_nop 1
v_mfma_f32_16x16x32_bf16 v[116:119],v[124:127],v[108:111],v[116:119]
ds_read_b128 v[108:111],v18 offset:18432
s_waitcnt lgkmcnt(1)
v_and_b32 v124,v12,v89
v_and_b32 v125,v13,v89
v_and_b32 v126,v14,v89
v_and_b32 v127,v15,v89
s_nop 1
v_mfma_f32_16x16x32_bf16 v[116:119],v[124:127],v[112:115],v[116:119]
ds_read_b128 v[112:115],v18 offset:19456
s_waitcnt lgkmcnt(1)
v_and_b32 v124,v12,v90
v_and_b32 v125,v13,v90
v_and_b32 v126,v14,v90
v_and_b32 v127,v15,v90
s_nop 1
v_mfma_f32_16x16x32_bf16 v[116:119],v[124:127],v[108:111],v[116:119]
ds_read_b128 v[108:111],v18 offset:20480
s_waitcnt lgkmcnt(1)
v_and_b32 v124,v12,v91
v_and_b32 v125,v13,v91
v_and_b32 v126,v14,v91
v_and_b32 v127,v15,v91
s_nop 1
v_mfma_f32_16x16x32_bf16 v[116:119],v[124:127],v[112:115],v[116:119]
ds_read_b128 v[112:115],v18 offset:21504
s_waitcnt lgkmcnt(1)
v_and_b32 v124,v12,v92
v_and_b32 v125,v13,v92
v_and_b32 v126,v14,v92
v_and_b32 v127,v15,v92
s_nop 1
v_mfma_f32_16x16x32_bf16 v[116:119],v[124:127],v[108:111],v[116:119]
ds_read_b128 v[108:111],v18 offset:22528
s_waitcnt lgkmcnt(1)
v_and_b32 v124,v12,v93
v_and_b32 v125,v13,v93
v_and_b32 v126,v14,v93
v_and_b32 v127,v15,v93
s_nop 1
v_mfma_f32_16x16x32_bf16 v[116:119],v[124:127],v[112:115],v[116:119]
ds_read_b128 v[112:115],v18 offset:23552
s_waitcnt lgkmcnt(1)
v_and_b32 v124,v12,v94
v_and_b32 v125,v13,v94
v_and_b32 v126,v14,v94
v_and_b32 v127,v15,v94
s_nop 1
v_mfma_f32_16x16x32_bf16 v[116:119],v[124:127],v[108:111],v[116:119]
ds_read_b128 v[108:111],v18 offset:24576
s_waitcnt lgkmcnt(1)
v_and_b32 v124,v12,v95
v_and_b32 v125,v13,v95
v_and_b32 v126,v14,v95
v_and_b32 v127,v15,v95
s_nop 1
v_mfma_f32_16x16x32_bf16 v[116:119],v[124:127],v[112:115],v[116:119]
ds_read_b128 v[88:91],v8 offset:96
ds_read_b128 v[92:95],v8 offset:112
ds_read_b128 v[112:115],v18 offset:25600
s_waitcnt lgkmcnt(1)
v_and_b32 v124,v12,v88
v_and_b32 v125,v13,v88
v_and_b32 v126,v14,v88
v_and_b32 v127,v15,v88
s_nop 1
v_mfma_f32_16x16x32_bf16 v[116:119],v[124:127],v[108:111],v[116:119]
ds_read_b128 v[108:111],v18 offset:26624
s_waitcnt lgkmcnt(1)
v_and_b32 v124,v12,v89
v_and_b32 v125,v13,v89
v_and_b32 v126,v14,v89
v_and_b32 v127,v15,v89
s_nop 1
v_mfma_f32_16x16x32_bf16 v[116:119],v[124:127],v[112:115],v[116:119]
ds_read_b128 v[112:115],v18 offset:27648
s_waitcnt lgkmcnt(1)
v_and_b32 v124,v12,v90
v_and_b32 v125,v13,v90
v_and_b32 v126,v14,v90
v_and_b32 v127,v15,v90
s_nop 1
v_mfma_f32_16x16x32_bf16 v[116:119],v[124:127],v[108:111],v[116:119]
ds_read_b128 v[108:111],v18 offset:28672
s_waitcnt lgkmcnt(1)
v_and_b32 v124,v12,v91
v_and_b32 v125,v13,v91
v_and_b32 v126,v14,v91
v_and_b32 v127,v15,v91
s_nop 1
v_mfma_f32_16x16x32_bf16 v[116:119],v[124:127],v[112:115],v[116:119]
ds_read_b128 v[112:115],v18 offset:29696
s_waitcnt lgkmcnt(1)
v_and_b32 v124,v12,v92
v_and_b32 v125,v13,v92
v_and_b32 v126,v14,v92
v_and_b32 v127,v15,v92
s_nop 1
v_mfma_f32_16x16x32_bf16 v[116:119],v[124:127],v[108:111],v[116:119]
ds_read_b128 v[108:111],v18 offset:30720
s_waitcnt lgkmcnt(1)
v_and_b32 v124,v12,v93
v_and_b32 v125,v13,v93
v_and_b32 v126,v14,v93
v_and_b32 v127,v15,v93
s_nop 1
v_mfma_f32_16x16x32_bf16 v[116:119],v[124:127],v[112:115],v[116:119]
ds_read_b128 v[112:115],v18 offset:31744
s_waitcnt lgkmcnt(1)
v_and_b32 v124,v12,v94
v_and_b32 v125,v13,v94
v_and_b32 v126,v14,v94
v_and_b32 v127,v15,v94
s_nop 1
v_mfma_f32_16x16x32_bf16 v[116:119],v[124:127],v[108:111],v[116:119]
s_waitcnt lgkmcnt(0)
v_and_b32 v124,v12,v95
v_and_b32 v125,v13,v95
v_and_b32 v126,v14,v95
v_and_b32 v127,v15,v95
s_nop 1
v_mfma_f32_16x16x32_bf16 v[116:119],v[124:127],v[112:115],v[116:119]
v_lshlrev_b32 v8,5,v9
v_and_b32 v124,1,v10
v_lshl_add_u32 v8,v124,4,v8
v_lshrrev_b32 v124,1,v10
v_lshl_add_u32 v8,v124,11,v8
s_lshl_b32 s60,s46,9
s_add_u32 s60,s60,147456
v_add_u32 v8,s60,v8
ds_write_b128 v8,v[116:119]
v_lshlrev_b32 v8,2,v1
v_add_u32 v8,147456,v8
s_waitcnt lgkmcnt(0)
s_barrier
ds_read2st64_b32 v[88:89],v8 offset0:0 offset1:1
ds_read2st64_b32 v[90:91],v8 offset0:2 offset1:3
ds_read2st64_b32 v[92:93],v8 offset0:4 offset1:5
ds_read2st64_b32 v[94:95],v8 offset0:6 offset1:7
s_waitcnt lgkmcnt(0)
v_pk_add_f32 v[88:89],v[88:89],v[90:91]
v_pk_add_f32 v[92:93],v[92:93],v[94:95]
v_pk_add_f32 v[88:89],v[88:89],v[92:93]
v_cvt_pk_bf16_f32 v88,v88,v88
v_and_b32 v88,0xffff0000,v88
v_cvt_pk_bf16_f32 v89,v89,v89
v_and_b32 v89,0xffff0000,v89
v_mul_f32 v90,0xbfb8aa3b,v88
v_exp_f32 v90,v90
s_nop 0
v_add_f32 v90,1.0,v90
v_rcp_f32 v90,v90
s_nop 0
v_mul_f32 v88,v88,v90
v_cvt_pk_bf16_f32 v88,v88,v88
v_and_b32 v88,0xffff0000,v88
v_mul_f32 v88,v88,v89
v_cvt_pk_bf16_f32 v88,v88,v88
v_lshlrev_b32 v8,2,v1
v_add_u32 v8,s58,v8
ds_write_b32 v8,v88
v_lshlrev_b32 v8,6,v10
v_add_u32 v8,s58,v8
s_waitcnt lgkmcnt(0)
ds_read_b128 v[88:91],v8
ds_read_b128 v[92:95],v8 offset:16
ds_read_b128 v[108:111],v8 offset:32
ds_read_b128 v[112:115],v8 offset:48
s_waitcnt vmcnt(0) lgkmcnt(0)
v_and_b32 v124,v12,v88
v_and_b32 v125,v13,v88
v_and_b32 v126,v14,v88
v_and_b32 v127,v15,v88
s_nop 1
v_mfma_f32_16x16x32_bf16 v[116:119],v[124:127],v[24:27],0
v_and_b32 v124,v12,v89
v_and_b32 v125,v13,v89
v_and_b32 v126,v14,v89
v_and_b32 v127,v15,v89
s_nop 1
v_mfma_f32_16x16x32_bf16 v[116:119],v[124:127],v[28:31],v[116:119]
v_and_b32 v124,v12,v90
v_and_b32 v125,v13,v90
v_and_b32 v126,v14,v90
v_and_b32 v127,v15,v90
s_nop 1
v_mfma_f32_16x16x32_bf16 v[116:119],v[124:127],v[32:35],v[116:119]
v_and_b32 v124,v12,v91
v_and_b32 v125,v13,v91
v_and_b32 v126,v14,v91
v_and_b32 v127,v15,v91
s_nop 1
v_mfma_f32_16x16x32_bf16 v[116:119],v[124:127],v[36:39],v[116:119]
v_and_b32 v124,v12,v92
v_and_b32 v125,v13,v92
v_and_b32 v126,v14,v92
v_and_b32 v127,v15,v92
s_nop 1
v_mfma_f32_16x16x32_bf16 v[116:119],v[124:127],v[40:43],v[116:119]
v_and_b32 v124,v12,v93
v_and_b32 v125,v13,v93
v_and_b32 v126,v14,v93
v_and_b32 v127,v15,v93
s_nop 1
v_mfma_f32_16x16x32_bf16 v[116:119],v[124:127],v[44:47],v[116:119]
v_and_b32 v124,v12,v94
v_and_b32 v125,v13,v94
v_and_b32 v126,v14,v94
v_and_b32 v127,v15,v94
s_nop 1
v_mfma_f32_16x16x32_bf16 v[116:119],v[124:127],v[48:51],v[116:119]
v_and_b32 v124,v12,v95
v_and_b32 v125,v13,v95
v_and_b32 v126,v14,v95
v_and_b32 v127,v15,v95
s_nop 1
v_mfma_f32_16x16x32_bf16 v[116:119],v[124:127],v[52:55],v[116:119]
v_and_b32 v124,v12,v108
v_and_b32 v125,v13,v108
v_and_b32 v126,v14,v108
v_and_b32 v127,v15,v108
s_nop 1
v_mfma_f32_16x16x32_bf16 v[116:119],v[124:127],v[56:59],v[116:119]
v_and_b32 v124,v12,v109
v_and_b32 v125,v13,v109
v_and_b32 v126,v14,v109
v_and_b32 v127,v15,v109
s_nop 1
v_mfma_f32_16x16x32_bf16 v[116:119],v[124:127],v[60:63],v[116:119]
v_and_b32 v124,v12,v110
v_and_b32 v125,v13,v110
v_and_b32 v126,v14,v110
v_and_b32 v127,v15,v110
s_nop 1
v_mfma_f32_16x16x32_bf16 v[116:119],v[124:127],v[64:67],v[116:119]
v_and_b32 v124,v12,v111
v_and_b32 v125,v13,v111
v_and_b32 v126,v14,v111
v_and_b32 v127,v15,v111
s_nop 1
v_mfma_f32_16x16x32_bf16 v[116:119],v[124:127],v[68:71],v[116:119]
v_and_b32 v124,v12,v112
v_and_b32 v125,v13,v112
v_and_b32 v126,v14,v112
v_and_b32 v127,v15,v112
s_nop 1
v_mfma_f32_16x16x32_bf16 v[116:119],v[124:127],v[72:75],v[116:119]
v_and_b32 v124,v12,v113
v_and_b32 v125,v13,v113
v_and_b32 v126,v14,v113
v_and_b32 v127,v15,v113
s_nop 1
v_mfma_f32_16x16x32_bf16 v[116:119],v[124:127],v[76:79],v[116:119]
v_and_b32 v124,v12,v114
v_and_b32 v125,v13,v114
v_and_b32 v126,v14,v114
v_and_b32 v127,v15,v114
s_nop 1
v_mfma_f32_16x16x32_bf16 v[116:119],v[124:127],v[80:83],v[116:119]
v_and_b32 v124,v12,v115
v_and_b32 v125,v13,v115
v_and_b32 v126,v14,v115
v_and_b32 v127,v15,v115
s_nop 1
v_mfma_f32_16x16x32_bf16 v[116:119],v[124:127],v[84:87],v[116:119]
v_lshlrev_b32 v8,4,v9
v_and_b32 v124,1,v10
v_lshl_add_u32 v8,v124,3,v8
v_and_b32 v124,2,v10
v_lshl_add_u32 v8,v124,30,v8
s_lshl_b32 s65,s51,15
s_add_u32 s65,s65,92274688
s_lshl_b32 s59,s47,10
s_lshl_b32 s60,s46,8
s_add_u32 s59,s59,s60
s_add_u32 s59,s59,s65
v_cvt_pk_bf16_f32 v24,v116,v117
v_cvt_pk_bf16_f32 v25,v118,v119
buffer_store_dwordx2 v[24:25],v8,s[8:11],s59 offen sc1
s_lshl_b32 s59,s51,13
s_lshl2_add_u32 s59,s47,s59
s_add_u32 s59,s59,10486912
s_waitcnt vmcnt(0)
s_barrier
s_or_b32 s59,s59,s52
buffer_store_dword v17,off,s[8:11],s59 sc1
s_lshl_b32 s59,s51,13
s_add_u32 s59,s59,10486912
v_and_b32 v124,31,v1
v_lshlrev_b32 v124,2,v124
L_fw_273:
buffer_load_dword v125,v124,s[8:11],s59 offen sc1
s_sub_u32 s49,s49,1
s_cbranch_scc1 L_abort2
s_waitcnt vmcnt(0)
v_cmp_eq_u32 vcc,0,v125
s_cbranch_vccnz L_fw_273
s_add_u32 s63,s65,0
buffer_load_dwordx4 v[24:27],v22,s[8:11],s63 offen sc1
s_add_u32 s63,s65,4096
buffer_load_dwordx4 v[28:31],v22,s[8:11],s63 offen sc1
s_add_u32 s63,s65,8192
buffer_load_dwordx4 v[32:35],v22,s[8:11],s63 offen sc1
s_add_u32 s63,s65,12288
buffer_load_dwordx4 v[36:39],v22,s[8:11],s63 offen sc1
s_add_u32 s63,s65,16384
buffer_load_dwordx4 v[40:43],v22,s[8:11],s63 offen sc1
s_add_u32 s63,s65,20480
buffer_load_dwordx4 v[44:47],v22,s[8:11],s63 offen sc1
s_add_u32 s63,s65,24576
buffer_load_dwordx4 v[48:51],v22,s[8:11],s63 offen sc1
s_add_u32 s63,s65,28672
buffer_load_dwordx4 v[52:55],v22,s[8:11],s63 offen sc1
v_and_b32 v64,15,v1
v_and_b32 v65,1,v1
v_lshlrev_b32 v65,4,v65
v_mov_b32 v66,0x3f80
v_lshlrev_b32 v66,v65,v66
v_lshrrev_b32 v64,1,v64
v_cmp_eq_u32 vcc,0,v64
s_nop 1
v_cndmask_b32 v56,0,v66,vcc
v_cmp_eq_u32 vcc,1,v64
s_nop 1
v_cndmask_b32 v57,0,v66,vcc
v_cmp_eq_u32 vcc,2,v64
s_nop 1
v_cndmask_b32 v58,0,v66,vcc
v_cmp_eq_u32 vcc,3,v64
s_nop 1
v_cndmask_b32 v59,0,v66,vcc
s_waitcnt vmcnt(7)
s_nop 0
v_mfma_f32_16x16x32_bf16 v[60:63],v[56:59],v[24:27],0
s_waitcnt vmcnt(6)
v_mfma_f32_16x16x32_bf16 v[60:63],v[56:59],v[28:31],v[60:63]
s_waitcnt vmcnt(5)
v_mfma_f32_16x16x32_bf16 v[60:63],v[56:59],v[32:35],v[60:63]
s_waitcnt vmcnt(4)
v_mfma_f32_16x16x32_bf16 v[60:63],v[56:59],v[36:39],v[60:63]
s_waitcnt vmcnt(3)
v_mfma_f32_16x16x32_bf16 v[60:63],v[56:59],v[40:43],v[60:63]
s_waitcnt vmcnt(2)
v_mfma_f32_16x16x32_bf16 v[60:63],v[56:59],v[44:47],v[60:63]
s_waitcnt vmcnt(1)
v_mfma_f32_16x16x32_bf16 v[60:63],v[56:59],v[48:51],v[60:63]
s_waitcnt vmcnt(0)
v_mfma_f32_16x16x32_bf16 v[60:63],v[56:59],v[52:55],v[60:63]
s_nop 7
ds_write_b128 v21,v[60:63]
s_waitcnt lgkmcnt(0)
s_barrier
s_cmp_lg_u32 s46,0
s_cbranch_scc1 L_moed_272
v_lshlrev_b32 v56,5,v1
v_add_u32 v56,155648,v56
ds_read_b128 v[24:27],v56
ds_read_b128 v[28:31],v56 offset:16
s_and_b32 s59,s54,0xffff0000
s_xor_b32 s60,s59,0x80000000
s_xor_b32 s61,s59,0xffff0000
s_cmp_lt_i32 s59,0
s_cselect_b32 s59,s60,s61
v_mov_b32 v56,s59
v_mul_f32 v56,0xbfb8aa3b,v56
v_exp_f32 v56,v56
s_nop 0
v_add_f32 v56,1.0,v56
v_rcp_f32 v56,v56
s_nop 0
v_cvt_pk_bf16_f32 v56,v56,v56
v_and_b32 v56,0xffff0000,v56
v_lshlrev_b32 v48,16,v104
v_and_b32 v49,0xffff0000,v104
v_lshlrev_b32 v50,16,v105
v_and_b32 v51,0xffff0000,v105
v_lshlrev_b32 v52,16,v106
v_and_b32 v53,0xffff0000,v106
v_lshlrev_b32 v54,16,v107
v_and_b32 v55,0xffff0000,v107
s_waitcnt lgkmcnt(0)
v_cvt_pk_bf16_f32 v40,v24,v25
v_cvt_pk_bf16_f32 v41,v26,v27
v_cvt_pk_bf16_f32 v42,v28,v29
v_cvt_pk_bf16_f32 v43,v30,v31
v_lshlrev_b32 v24,16,v40
v_and_b32 v25,0xffff0000,v40
v_lshlrev_b32 v26,16,v41
v_and_b32 v27,0xffff0000,v41
v_lshlrev_b32 v28,16,v42
v_and_b32 v29,0xffff0000,v42
v_lshlrev_b32 v30,16,v43
v_and_b32 v31,0xffff0000,v43
v_mul_f32 v24,v24,v56
v_mul_f32 v25,v25,v56
v_mul_f32 v26,v26,v56
v_mul_f32 v27,v27,v56
v_mul_f32 v28,v28,v56
v_mul_f32 v29,v29,v56
v_mul_f32 v30,v30,v56
v_mul_f32 v31,v31,v56
v_cvt_pk_bf16_f32 v40,v24,v25
v_cvt_pk_bf16_f32 v41,v26,v27
v_cvt_pk_bf16_f32 v42,v28,v29
v_cvt_pk_bf16_f32 v43,v30,v31
v_lshlrev_b32 v24,16,v40
v_and_b32 v25,0xffff0000,v40
v_lshlrev_b32 v26,16,v41
v_and_b32 v27,0xffff0000,v41
v_lshlrev_b32 v28,16,v42
v_and_b32 v29,0xffff0000,v42
v_lshlrev_b32 v30,16,v43
v_and_b32 v31,0xffff0000,v43
v_add_f32 v24,v24,v48
v_add_f32 v25,v25,v49
v_add_f32 v26,v26,v50
v_add_f32 v27,v27,v51
v_add_f32 v28,v28,v52
v_add_f32 v29,v29,v53
v_add_f32 v30,v30,v54
v_add_f32 v31,v31,v55
v_cvt_pk_bf16_f32 v40,v24,v25
v_cvt_pk_bf16_f32 v41,v26,v27
v_cvt_pk_bf16_f32 v42,v28,v29
v_cvt_pk_bf16_f32 v43,v30,v31
v_lshlrev_b32 v24,16,v40
v_and_b32 v25,0xffff0000,v40
v_lshlrev_b32 v26,16,v41
v_and_b32 v27,0xffff0000,v41
v_lshlrev_b32 v28,16,v42
v_and_b32 v29,0xffff0000,v42
v_lshlrev_b32 v30,16,v43
v_and_b32 v31,0xffff0000,v43
v_add_f32 v96,v96,v24
v_add_f32 v97,v97,v25
v_add_f32 v98,v98,v26
v_add_f32 v99,v99,v27
v_add_f32 v100,v100,v28
v_add_f32 v101,v101,v29
v_add_f32 v102,v102,v30
v_add_f32 v103,v103,v31
v_cvt_pk_bf16_f32 v80,v96,v97
v_cvt_pk_bf16_f32 v81,v98,v99
v_cvt_pk_bf16_f32 v82,v100,v101
v_cvt_pk_bf16_f32 v83,v102,v103
s_lshl_b32 s58,s51,10
s_add_u32 s58,s58,11272192
buffer_store_dwordx4 v[80:83],v0,s[8:11],s58 offen sc1
v_lshlrev_b32 v96,16,v80
v_and_b32 v97,0xffff0000,v80
v_lshlrev_b32 v98,16,v81
v_and_b32 v99,0xffff0000,v81
v_lshlrev_b32 v100,16,v82
v_and_b32 v101,0xffff0000,v82
v_lshlrev_b32 v102,16,v83
v_and_b32 v103,0xffff0000,v83
v_readfirstlane_b32 s78,v96
s_nop 1
v_pk_add_f32 v[58:59],v[96:97],s[78:79] op_sel_hi:[1,0] neg_lo:[0,1] neg_hi:[0,1]
v_pk_add_f32 v[60:61],v[98:99],s[78:79] op_sel_hi:[1,0] neg_lo:[0,1] neg_hi:[0,1]
v_pk_add_f32 v[62:63],v[100:101],s[78:79] op_sel_hi:[1,0] neg_lo:[0,1] neg_hi:[0,1]
v_pk_add_f32 v[64:65],v[102:103],s[78:79] op_sel_hi:[1,0] neg_lo:[0,1] neg_hi:[0,1]
v_pk_add_f32 v[66:67],v[58:59],v[60:61]
v_pk_mul_f32 v[68:69],v[58:59],v[58:59]
v_pk_add_f32 v[70:71],v[62:63],v[64:65]
v_pk_fma_f32 v[68:69],v[60:61],v[60:61],v[68:69]
v_pk_add_f32 v[66:67],v[66:67],v[70:71]
v_pk_fma_f32 v[68:69],v[62:63],v[62:63],v[68:69]
v_add_f32 v66,v66,v67
v_pk_fma_f32 v[68:69],v[64:65],v[64:65],v[68:69]
v_add_f32 v68,v68,v69
s_nop 1
v_permlane32_swap_b32 v66,v68
v_add_f32 v66,v66,v68
s_nop 1
v_add_f32_dpp v66,v66,v66 row_ror:8 row_mask:0xf bank_mask:0xf
s_nop 1
v_add_f32_dpp v66,v66,v66 row_ror:4 row_mask:0xf bank_mask:0xf
s_nop 1
v_add_f32_dpp v66,v66,v66 row_ror:2 row_mask:0xf bank_mask:0xf
s_nop 1
v_add_f32_dpp v66,v66,v66 row_ror:1 row_mask:0xf bank_mask:0xf
v_mov_b32 v68,v66
s_nop 1
v_permlane16_swap_b32 v66,v68
v_add_f32 v66,v66,v68
v_mul_f32 v66,0x3b000000,v66
v_mov_b32 v68,v66
s_nop 1
v_permlane32_swap_b32 v66,v68
v_fma_f32 v68,-v66,v66,v68
v_add_f32 v66,s78,v66
v_max_f32 v68,0,v68
v_cvt_pk_bf16_f32 v68,v66,v68
v_lshlrev_b32 v66,16,v68
v_and_b32 v68,0xffff0000,v68
v_add_f32 v68,0x3727c5ac,v68
v_cvt_pk_bf16_f32 v68,v68,v68
v_and_b32 v68,0xffff0000,v68
v_sqrt_f32 v68,v68
v_pk_add_f32 v[58:59],v[96:97],v[66:67] op_sel_hi:[1,0] neg_lo:[0,1] neg_hi:[0,1]
v_pk_add_f32 v[60:61],v[98:99],v[66:67] op_sel_hi:[1,0] neg_lo:[0,1] neg_hi:[0,1]
v_pk_add_f32 v[62:63],v[100:101],v[66:67] op_sel_hi:[1,0] neg_lo:[0,1] neg_hi:[0,1]
v_pk_add_f32 v[64:65],v[102:103],v[66:67] op_sel_hi:[1,0] neg_lo:[0,1] neg_hi:[0,1]
v_cvt_pk_bf16_f32 v68,v68,v68
v_and_b32 v68,0xffff0000,v68
v_rcp_f32 v68,v68
v_cvt_pk_bf16_f32 v84,v58,v59
v_cvt_pk_bf16_f32 v85,v60,v61
v_cvt_pk_bf16_f32 v86,v62,v63
v_cvt_pk_bf16_f32 v87,v64,v65
v_lshlrev_b32 v58,16,v84
v_and_b32 v59,0xffff0000,v84
v_lshlrev_b32 v60,16,v85
v_and_b32 v61,0xffff0000,v85
v_lshlrev_b32 v62,16,v86
v_and_b32 v63,0xffff0000,v86
v_lshlrev_b32 v64,16,v87
v_and_b32 v65,0xffff0000,v87
v_pk_mul_f32 v[58:59],v[58:59],v[68:69] op_sel_hi:[1,0]
v_pk_mul_f32 v[60:61],v[60:61],v[68:69] op_sel_hi:[1,0]
v_pk_mul_f32 v[62:63],v[62:63],v[68:69] op_sel_hi:[1,0]
v_pk_mul_f32 v[64:65],v[64:65],v[68:69] op_sel_hi:[1,0]
v_cvt_pk_bf16_f32 v84,v58,v59
v_cvt_pk_bf16_f32 v85,v60,v61
v_cvt_pk_bf16_f32 v86,v62,v63
v_cvt_pk_bf16_f32 v87,v64,v65
s_add_u32 s57,s56,98566144
buffer_store_dwordx4 v[84:87],v0,s[8:11],s57 offen sc1
L_moed_272:
s_and_b32 s56,s54,31
s_sub_u32 s56,31,s56
v_lshrrev_b32 v2,10,v20
v_add_u32 v3,16,v2
v_add_u32 v8,96468992,v20
v_cmp_eq_u32 vcc,s56,v2
s_nop 1
v_cndmask_b32 v2,v20,v8,vcc
v_cmp_eq_u32 vcc,s56,v3
s_nop 1
v_cndmask_b32 v3,v20,v8,vcc
s_lshl_b32 s59,s51,13
s_add_u32 s59,s59,10487552
v_and_b32 v124,31,v1
v_lshlrev_b32 v124,2,v124
L_fw_274:
buffer_load_dword v125,v124,s[8:11],s59 offen sc1
s_sub_u32 s49,s49,1
s_cbranch_scc1 L_abort2
s_waitcnt vmcnt(0)
v_cmp_eq_u32 vcc,0,v125
s_cbranch_vccnz L_fw_274
s_barrier
s_lshl_b32 s66,s51,15
s_add_u32 s66,s66,2097152
s_add_u32 s67,s66,16384
s_add_u32 m0,s50,131072
s_nop 0
buffer_load_dwordx4 v2,s[8:11],s66 offen offset:0 sc1 lds
s_add_u32 m0,s50,135168
s_nop 0
buffer_load_dwordx4 v3,s[8:11],s67 offen offset:0 sc1 lds
s_add_u32 m0,s50,139008
s_nop 0
buffer_load_dwordx4 v2,s[8:11],s66 offen offset:256 sc1 lds
s_add_u32 m0,s50,143104
s_nop 0
buffer_load_dwordx4 v3,s[8:11],s67 offen offset:256 sc1 lds
s_add_u32 m0,s50,146944
s_nop 0
buffer_load_dwordx4 v2,s[8:11],s66 offen offset:512 sc1 lds
s_add_u32 m0,s50,151040
s_nop 0
buffer_load_dwordx4 v3,s[8:11],s67 offen offset:512 sc1 lds
s_lshl_b32 s58,s51,5
s_add_u32 s58,s58,s47
s_mul_i32 s58,s58,24576
s_add_u32 s58,s58,201326592
s_add_u32 s61,s58,s50
s_add_u32 s62,s61,4096
s_add_u32 s63,s61,16384
s_add_u32 s64,s61,20480
s_add_u32 s65,s61,s50
s_add_u32 s65,s65,8192
s_waitcnt vmcnt(4)
s_barrier
ds_read_b128 v[104:107],v4 offset:0
ds_read_b128 v[108:111],v4 offset:4096
ds_read_b128 v[112:115],v5 offset:0
ds_read_b128 v[116:119],v5 offset:4096
s_add_u32 m0,s50,154880
s_nop 0
buffer_load_dwordx4 v2,s[8:11],s66 offen offset:768 sc1 lds
s_add_u32 m0,s50,158976
s_nop 0
buffer_load_dwordx4 v3,s[8:11],s67 offen offset:768 sc1 lds
s_waitcnt lgkmcnt(2)
v_mfma_f32_16x16x32_bf16 v[24:27],a[128:131],v[104:107],0
ds_read_b128 v[120:123],v6 offset:0
v_mfma_f32_16x16x32_bf16 v[40:43],v[104:107],v[128:131],0
v_mfma_f32_16x16x32_bf16 v[28:31],a[128:131],v[108:111],0
ds_read_b128 v[124:127],v6 offset:4096
v_mfma_f32_16x16x32_bf16 v[44:47],v[108:111],v[128:131],0
v_mfma_f32_16x16x32_bf16 v[32:35],a[136:139],v[104:107],0
v_mfma_f32_16x16x32_bf16 v[48:51],v[104:107],v[136:139],0
v_mfma_f32_16x16x32_bf16 v[36:39],a[136:139],v[108:111],0
v_mfma_f32_16x16x32_bf16 v[52:55],v[108:111],v[136:139],0
s_waitcnt lgkmcnt(2)
v_mfma_f32_16x16x32_bf16 v[24:27],a[132:135],v[112:115],v[24:27]
ds_read_b128 v[104:107],v7 offset:0
v_mfma_f32_16x16x32_bf16 v[40:43],v[112:115],v[132:135],v[40:43]
v_mfma_f32_16x16x32_bf16 v[28:31],a[132:135],v[116:119],v[28:31]
ds_read_b128 v[108:111],v7 offset:4096
v_mfma_f32_16x16x32_bf16 v[44:47],v[116:119],v[132:135],v[44:47]
v_mfma_f32_16x16x32_bf16 v[32:35],a[140:143],v[112:115],v[32:35]
v_mfma_f32_16x16x32_bf16 v[48:51],v[112:115],v[140:143],v[48:51]
v_mfma_f32_16x16x32_bf16 v[36:39],a[140:143],v[116:119],v[36:39]
v_mfma_f32_16x16x32_bf16 v[52:55],v[116:119],v[140:143],v[52:55]
s_waitcnt vmcnt(4)
s_barrier
s_waitcnt lgkmcnt(2)
v_mfma_f32_16x16x32_bf16 v[24:27],a[144:147],v[120:123],v[24:27]
ds_read_b128 v[112:115],v4 offset:8192
v_mfma_f32_16x16x32_bf16 v[40:43],v[120:123],v[144:147],v[40:43]
v_mfma_f32_16x16x32_bf16 v[28:31],a[144:147],v[124:127],v[28:31]
ds_read_b128 v[116:119],v4 offset:12288
v_mfma_f32_16x16x32_bf16 v[44:47],v[124:127],v[144:147],v[44:47]
v_mfma_f32_16x16x32_bf16 v[32:35],a[152:155],v[120:123],v[32:35]
v_mfma_f32_16x16x32_bf16 v[48:51],v[120:123],v[152:155],v[48:51]
v_mfma_f32_16x16x32_bf16 v[36:39],a[152:155],v[124:127],v[36:39]
v_mfma_f32_16x16x32_bf16 v[52:55],v[124:127],v[152:155],v[52:55]
s_waitcnt lgkmcnt(2)
v_mfma_f32_16x16x32_bf16 v[24:27],a[148:151],v[104:107],v[24:27]
ds_read_b128 v[120:123],v5 offset:8192
v_mfma_f32_16x16x32_bf16 v[40:43],v[104:107],v[148:151],v[40:43]
v_mfma_f32_16x16x32_bf16 v[28:31],a[148:151],v[108:111],v[28:31]
ds_read_b128 v[124:127],v5 offset:12288
v_mfma_f32_16x16x32_bf16 v[44:47],v[108:111],v[148:151],v[44:47]
v_mfma_f32_16x16x32_bf16 v[32:35],a[156:159],v[104:107],v[32:35]
v_mfma_f32_16x16x32_bf16 v[48:51],v[104:107],v[156:159],v[48:51]
v_mfma_f32_16x16x32_bf16 v[36:39],a[156:159],v[108:111],v[36:39]
v_mfma_f32_16x16x32_bf16 v[52:55],v[108:111],v[156:159],v[52:55]
s_waitcnt lgkmcnt(2)
v_mfma_f32_16x16x32_bf16 v[24:27],a[160:163],v[112:115],v[24:27]
ds_read_b128 v[104:107],v6 offset:8192
v_mfma_f32_16x16x32_bf16 v[40:43],v[112:115],v[160:163],v[40:43]
v_mfma_f32_16x16x32_bf16 v[28:31],a[160:163],v[116:119],v[28:31]
ds_read_b128 v[108:111],v6 offset:12288
v_mfma_f32_16x16x32_bf16 v[44:47],v[116:119],v[160:163],v[44:47]
v_mfma_f32_16x16x32_bf16 v[32:35],a[168:171],v[112:115],v[32:35]
v_mfma_f32_16x16x32_bf16 v[48:51],v[112:115],v[168:171],v[48:51]
v_mfma_f32_16x16x32_bf16 v[36:39],a[168:171],v[116:119],v[36:39]
v_mfma_f32_16x16x32_bf16 v[52:55],v[116:119],v[168:171],v[52:55]
s_waitcnt lgkmcnt(2)
v_mfma_f32_16x16x32_bf16 v[24:27],a[164:167],v[120:123],v[24:27]
ds_read_b128 v[112:115],v7 offset:8192
v_mfma_f32_16x16x32_bf16 v[40:43],v[120:123],v[164:167],v[40:43]
v_mfma_f32_16x16x32_bf16 v[28:31],a[164:167],v[124:127],v[28:31]
ds_read_b128 v[116:119],v7 offset:12288
v_mfma_f32_16x16x32_bf16 v[44:47],v[124:127],v[164:167],v[44:47]
v_mfma_f32_16x16x32_bf16 v[32:35],a[172:175],v[120:123],v[32:35]
v_mfma_f32_16x16x32_bf16 v[48:51],v[120:123],v[172:175],v[48:51]
v_mfma_f32_16x16x32_bf16 v[36:39],a[172:175],v[124:127],v[36:39]
v_mfma_f32_16x16x32_bf16 v[52:55],v[124:127],v[172:175],v[52:55]
s_waitcnt vmcnt(2)
s_barrier
s_waitcnt lgkmcnt(2)
v_mfma_f32_16x16x32_bf16 v[24:27],a[176:179],v[104:107],v[24:27]
ds_read_b128 v[120:123],v4 offset:16384
v_mfma_f32_16x16x32_bf16 v[40:43],v[104:107],v[176:179],v[40:43]
v_mfma_f32_16x16x32_bf16 v[28:31],a[176:179],v[108:111],v[28:31]
ds_read_b128 v[124:127],v4 offset:20480
v_mfma_f32_16x16x32_bf16 v[44:47],v[108:111],v[176:179],v[44:47]
v_mfma_f32_16x16x32_bf16 v[32:35],a[184:187],v[104:107],v[32:35]
v_mfma_f32_16x16x32_bf16 v[48:51],v[104:107],v[184:187],v[48:51]
v_mfma_f32_16x16x32_bf16 v[36:39],a[184:187],v[108:111],v[36:39]
v_mfma_f32_16x16x32_bf16 v[52:55],v[108:111],v[184:187],v[52:55]
s_waitcnt lgkmcnt(2)
v_mfma_f32_16x16x32_bf16 v[24:27],a[180:183],v[112:115],v[24:27]
ds_read_b128 v[104:107],v5 offset:16384
v_mfma_f32_16x16x32_bf16 v[40:43],v[112:115],v[180:183],v[40:43]
v_mfma_f32_16x16x32_bf16 v[28:31],a[180:183],v[116:119],v[28:31]
ds_read_b128 v[108:111],v5 offset:20480
v_mfma_f32_16x16x32_bf16 v[44:47],v[116:119],v[180:183],v[44:47]
v_mfma_f32_16x16x32_bf16 v[32:35],a[188:191],v[112:115],v[32:35]
v_mfma_f32_16x16x32_bf16 v[48:51],v[112:115],v[188:191],v[48:51]
v_mfma_f32_16x16x32_bf16 v[36:39],a[188:191],v[116:119],v[36:39]
v_mfma_f32_16x16x32_bf16 v[52:55],v[116:119],v[188:191],v[52:55]
s_waitcnt lgkmcnt(2)
v_mfma_f32_16x16x32_bf16 v[24:27],a[192:195],v[120:123],v[24:27]
ds_read_b128 v[112:115],v6 offset:16384
v_mfma_f32_16x16x32_bf16 v[40:43],v[120:123],v[192:195],v[40:43]
v_mfma_f32_16x16x32_bf16 v[28:31],a[192:195],v[124:127],v[28:31]
ds_read_b128 v[116:119],v6 offset:20480
v_mfma_f32_16x16x32_bf16 v[44:47],v[124:127],v[192:195],v[44:47]
v_mfma_f32_16x16x32_bf16 v[32:35],a[200:203],v[120:123],v[32:35]
v_mfma_f32_16x16x32_bf16 v[48:51],v[120:123],v[200:203],v[48:51]
v_mfma_f32_16x16x32_bf16 v[36:39],a[200:203],v[124:127],v[36:39]
v_mfma_f32_16x16x32_bf16 v[52:55],v[124:127],v[200:203],v[52:55]
s_waitcnt lgkmcnt(2)
v_mfma_f32_16x16x32_bf16 v[24:27],a[196:199],v[104:107],v[24:27]
ds_read_b128 v[120:123],v7 offset:16384
v_mfma_f32_16x16x32_bf16 v[40:43],v[104:107],v[196:199],v[40:43]
v_mfma_f32_16x16x32_bf16 v[28:31],a[196:199],v[108:111],v[28:31]
ds_read_b128 v[124:127],v7 offset:20480
v_mfma_f32_16x16x32_bf16 v[44:47],v[108:111],v[196:199],v[44:47]
v_mfma_f32_16x16x32_bf16 v[32:35],a[204:207],v[104:107],v[32:35]
v_mfma_f32_16x16x32_bf16 v[48:51],v[104:107],v[204:207],v[48:51]
v_mfma_f32_16x16x32_bf16 v[36:39],a[204:207],v[108:111],v[36:39]
v_mfma_f32_16x16x32_bf16 v[52:55],v[108:111],v[204:207],v[52:55]
s_waitcnt vmcnt(0)
s_barrier
s_waitcnt lgkmcnt(2)
v_mfma_f32_16x16x32_bf16 v[24:27],a[208:211],v[112:115],v[24:27]
ds_read_b128 v[104:107],v4 offset:24576
v_mfma_f32_16x16x32_bf16 v[40:43],v[112:115],v[208:211],v[40:43]
v_mfma_f32_16x16x32_bf16 v[28:31],a[208:211],v[116:119],v[28:31]
ds_read_b128 v[108:111],v4 offset:28672
v_mfma_f32_16x16x32_bf16 v[44:47],v[116:119],v[208:211],v[44:47]
v_mfma_f32_16x16x32_bf16 v[32:35],a[216:219],v[112:115],v[32:35]
v_mfma_f32_16x16x32_bf16 v[48:51],v[112:115],v[216:219],v[48:51]
v_mfma_f32_16x16x32_bf16 v[36:39],a[216:219],v[116:119],v[36:39]
v_mfma_f32_16x16x32_bf16 v[52:55],v[116:119],v[216:219],v[52:55]
s_waitcnt lgkmcnt(2)
v_mfma_f32_16x16x32_bf16 v[24:27],a[212:215],v[120:123],v[24:27]
ds_read_b128 v[112:115],v5 offset:24576
v_mfma_f32_16x16x32_bf16 v[40:43],v[120:123],v[212:215],v[40:43]
v_mfma_f32_16x16x32_bf16 v[28:31],a[212:215],v[124:127],v[28:31]
ds_read_b128 v[116:119],v5 offset:28672
v_mfma_f32_16x16x32_bf16 v[44:47],v[124:127],v[212:215],v[44:47]
v_mfma_f32_16x16x32_bf16 v[32:35],a[220:223],v[120:123],v[32:35]
v_mfma_f32_16x16x32_bf16 v[48:51],v[120:123],v[220:223],v[48:51]
v_mfma_f32_16x16x32_bf16 v[36:39],a[220:223],v[124:127],v[36:39]
v_mfma_f32_16x16x32_bf16 v[52:55],v[124:127],v[220:223],v[52:55]
s_waitcnt lgkmcnt(2)
v_mfma_f32_16x16x32_bf16 v[24:27],a[224:227],v[104:107],v[24:27]
ds_read_b128 v[120:123],v6 offset:24576
v_mfma_f32_16x16x32_bf16 v[40:43],v[104:107],v[224:227],v[40:43]
v_mfma_f32_16x16x32_bf16 v[28:31],a[224:227],v[108:111],v[28:31]
ds_read_b128 v[124:127],v6 offset:28672
v_mfma_f32_16x16x32_bf16 v[44:47],v[108:111],v[224:227],v[44:47]
v_mfma_f32_16x16x32_bf16 v[32:35],a[232:235],v[104:107],v[32:35]
v_mfma_f32_16x16x32_bf16 v[48:51],v[104:107],v[232:235],v[48:51]
v_mfma_f32_16x16x32_bf16 v[36:39],a[232:235],v[108:111],v[36:39]
v_mfma_f32_16x16x32_bf16 v[52:55],v[108:111],v[232:235],v[52:55]
s_waitcnt lgkmcnt(2)
v_mfma_f32_16x16x32_bf16 v[24:27],a[228:231],v[112:115],v[24:27]
ds_read_b128 v[104:107],v7 offset:24576
v_mfma_f32_16x16x32_bf16 v[40:43],v[112:115],v[228:231],v[40:43]
v_mfma_f32_16x16x32_bf16 v[28:31],a[228:231],v[116:119],v[28:31]
ds_read_b128 v[108:111],v7 offset:28672
v_mfma_f32_16x16x32_bf16 v[44:47],v[116:119],v[228:231],v[44:47]
v_mfma_f32_16x16x32_bf16 v[32:35],a[236:239],v[112:115],v[32:35]
v_mfma_f32_16x16x32_bf16 v[48:51],v[112:115],v[236:239],v[48:51]
v_mfma_f32_16x16x32_bf16 v[36:39],a[236:239],v[116:119],v[36:39]
v_mfma_f32_16x16x32_bf16 v[52:55],v[116:119],v[236:239],v[52:55]
s_waitcnt lgkmcnt(2)
v_mfma_f32_16x16x32_bf16 v[24:27],a[240:243],v[120:123],v[24:27]
ds_read_b128 v[112:115],v4 offset:0
v_mfma_f32_16x16x32_bf16 v[40:43],v[120:123],v[240:243],v[40:43]
v_mfma_f32_16x16x32_bf16 v[28:31],a[240:243],v[124:127],v[28:31]
ds_read_b128 v[116:119],v4 offset:4096
v_mfma_f32_16x16x32_bf16 v[44:47],v[124:127],v[240:243],v[44:47]
v_mfma_f32_16x16x32_bf16 v[32:35],a[248:251],v[120:123],v[32:35]
v_mfma_f32_16x16x32_bf16 v[48:51],v[120:123],v[248:251],v[48:51]
v_mfma_f32_16x16x32_bf16 v[36:39],a[248:251],v[124:127],v[36:39]
v_mfma_f32_16x16x32_bf16 v[52:55],v[124:127],v[248:251],v[52:55]
s_waitcnt lgkmcnt(2)
v_mfma_f32_16x16x32_bf16 v[24:27],a[244:247],v[104:107],v[24:27]
ds_read_b128 v[120:123],v5 offset:0
v_mfma_f32_16x16x32_bf16 v[40:43],v[104:107],v[244:247],v[40:43]
v_mfma_f32_16x16x32_bf16 v[28:31],a[244:247],v[108:111],v[28:31]
ds_read_b128 v[124:127],v5 offset:4096
v_mfma_f32_16x16x32_bf16 v[44:47],v[108:111],v[244:247],v[44:47]
v_mfma_f32_16x16x32_bf16 v[32:35],a[252:255],v[104:107],v[32:35]
v_mfma_f32_16x16x32_bf16 v[48:51],v[104:107],v[252:255],v[48:51]
v_mfma_f32_16x16x32_bf16 v[36:39],a[252:255],v[108:111],v[36:39]
v_mfma_f32_16x16x32_bf16 v[52:55],v[108:111],v[252:255],v[52:55]
s_waitcnt lgkmcnt(2)
v_mfma_f32_16x16x32_bf16 v[88:91],a[0:3],v[112:115],0
ds_read_b128 v[104:107],v6 offset:0
v_mfma_f32_16x16x32_bf16 v[92:95],a[0:3],v[116:119],0
v_mfma_f32_16x16x32_bf16 v[96:99],a[8:11],v[112:115],0
ds_read_b128 v[108:111],v6 offset:4096
v_mfma_f32_16x16x32_bf16 v[100:103],a[8:11],v[116:119],0
s_waitcnt lgkmcnt(2)
v_mfma_f32_16x16x32_bf16 v[88:91],a[4:7],v[120:123],v[88:91]
ds_read_b128 v[112:115],v7 offset:0
v_mfma_f32_16x16x32_bf16 v[92:95],a[4:7],v[124:127],v[92:95]
v_cvt_pk_bf16_f32 v56,v24,v32
v_cvt_pk_bf16_f32 v57,v25,v33
v_mfma_f32_16x16x32_bf16 v[96:99],a[12:15],v[120:123],v[96:99]
ds_read_b128 v[116:119],v7 offset:4096
v_mfma_f32_16x16x32_bf16 v[100:103],a[12:15],v[124:127],v[100:103]
v_cvt_pk_bf16_f32 v58,v26,v34
v_cvt_pk_bf16_f32 v59,v27,v35
s_waitcnt lgkmcnt(2)
v_mfma_f32_16x16x32_bf16 v[88:91],a[16:19],v[104:107],v[88:91]
ds_read_b128 v[120:123],v4 offset:8192
v_mfma_f32_16x16x32_bf16 v[92:95],a[16:19],v[108:111],v[92:95]
buffer_store_dwordx4 v[56:59],v0,s[8:11],s61 offen sc1
v_cvt_pk_bf16_f32 v60,v28,v36
v_mfma_f32_16x16x32_bf16 v[96:99],a[24:27],v[104:107],v[96:99]
ds_read_b128 v[124:127],v4 offset:12288
v_mfma_f32_16x16x32_bf16 v[100:103],a[24:27],v[108:111],v[100:103]
v_cvt_pk_bf16_f32 v61,v29,v37
v_cvt_pk_bf16_f32 v62,v30,v38
s_waitcnt lgkmcnt(2)
v_mfma_f32_16x16x32_bf16 v[88:91],a[20:23],v[112:115],v[88:91]
ds_read_b128 v[104:107],v5 offset:8192
v_mfma_f32_16x16x32_bf16 v[92:95],a[20:23],v[116:119],v[92:95]
v_cvt_pk_bf16_f32 v63,v31,v39
buffer_store_dwordx4 v[60:63],v0,s[8:11],s62 offen sc1
v_mfma_f32_16x16x32_bf16 v[96:99],a[28:31],v[112:115],v[96:99]
ds_read_b128 v[108:111],v5 offset:12288
v_mfma_f32_16x16x32_bf16 v[100:103],a[28:31],v[116:119],v[100:103]
v_cvt_pk_bf16_f32 v64,v40,v41
v_cvt_pk_bf16_f32 v65,v42,v43
s_waitcnt lgkmcnt(2)
v_mfma_f32_16x16x32_bf16 v[88:91],a[32:35],v[120:123],v[88:91]
ds_read_b128 v[112:115],v6 offset:8192
v_mfma_f32_16x16x32_bf16 v[92:95],a[32:35],v[124:127],v[92:95]
v_cvt_pk_bf16_f32 v66,v44,v45
v_cvt_pk_bf16_f32 v67,v46,v47
v_mfma_f32_16x16x32_bf16 v[96:99],a[40:43],v[120:123],v[96:99]
ds_read_b128 v[116:119],v6 offset:12288
v_mfma_f32_16x16x32_bf16 v[100:103],a[40:43],v[124:127],v[100:103]
buffer_store_dwordx4 v[64:67],v0,s[8:11],s65 offen offset:0 sc1
v_cvt_pk_bf16_f32 v68,v48,v49
s_waitcnt lgkmcnt(2)
v_mfma_f32_16x16x32_bf16 v[88:91],a[36:39],v[104:107],v[88:91]
ds_read_b128 v[120:123],v7 offset:8192
v_mfma_f32_16x16x32_bf16 v[92:95],a[36:39],v[108:111],v[92:95]
v_cvt_pk_bf16_f32 v69,v50,v51
v_cvt_pk_bf16_f32 v70,v52,v53
v_mfma_f32_16x16x32_bf16 v[96:99],a[44:47],v[104:107],v[96:99]
ds_read_b128 v[124:127],v7 offset:12288
v_mfma_f32_16x16x32_bf16 v[100:103],a[44:47],v[108:111],v[100:103]
v_cvt_pk_bf16_f32 v71,v54,v55
buffer_store_dwordx4 v[68:71],v0,s[8:11],s65 offen offset:1024 sc1
s_waitcnt lgkmcnt(2)
v_mfma_f32_16x16x32_bf16 v[88:91],a[48:51],v[112:115],v[88:91]
ds_read_b128 v[104:107],v4 offset:16384
v_mfma_f32_16x16x32_bf16 v[92:95],a[48:51],v[116:119],v[92:95]
v_mfma_f32_16x16x32_bf16 v[96:99],a[56:59],v[112:115],v[96:99]
ds_read_b128 v[108:111],v4 offset:20480
v_mfma_f32_16x16x32_bf16 v[100:103],a[56:59],v[116:119],v[100:103]
s_waitcnt lgkmcnt(2)
v_mfma_f32_16x16x32_bf16 v[88:91],a[52:55],v[120:123],v[88:91]
ds_read_b128 v[112:115],v5 offset:16384
v_mfma_f32_16x16x32_bf16 v[92:95],a[52:55],v[124:127],v[92:95]
v_mfma_f32_16x16x32_bf16 v[96:99],a[60:63],v[120:123],v[96:99]
ds_read_b128 v[116:119],v5 offset:20480
v_mfma_f32_16x16x32_bf16 v[100:103],a[60:63],v[124:127],v[100:103]
s_waitcnt lgkmcnt(2)
v_mfma_f32_16x16x32_bf16 v[88:91],a[64:67],v[104:107],v[88:91]
ds_read_b128 v[120:123],v6 offset:16384
v_mfma_f32_16x16x32_bf16 v[92:95],a[64:67],v[108:111],v[92:95]
v_mfma_f32_16x16x32_bf16 v[96:99],a[72:75],v[104:107],v[96:99]
ds_read_b128 v[124:127],v6 offset:20480
v_mfma_f32_16x16x32_bf16 v[100:103],a[72:75],v[108:111],v[100:103]
s_waitcnt lgkmcnt(2)
v_mfma_f32_16x16x32_bf16 v[88:91],a[68:71],v[112:115],v[88:91]
ds_read_b128 v[104:107],v7 offset:16384
v_mfma_f32_16x16x32_bf16 v[92:95],a[68:71],v[116:119],v[92:95]
v_mfma_f32_16x16x32_bf16 v[96:99],a[76:79],v[112:115],v[96:99]
ds_read_b128 v[108:111],v7 offset:20480
v_mfma_f32_16x16x32_bf16 v[100:103],a[76:79],v[116:119],v[100:103]
s_waitcnt lgkmcnt(2)
v_mfma_f32_16x16x32_bf16 v[88:91],a[80:83],v[120:123],v[88:91]
ds_read_b128 v[112:115],v4 offset:24576
v_mfma_f32_16x16x32_bf16 v[92:95],a[80:83],v[124:127],v[92:95]
v_mfma_f32_16x16x32_bf16 v[96:99],a[88:91],v[120:123],v[96:99]
ds_read_b128 v[116:119],v4 offset:28672
v_mfma_f32_16x16x32_bf16 v[100:103],a[88:91],v[124:127],v[100:103]
s_waitcnt lgkmcnt(2)
v_mfma_f32_16x16x32_bf16 v[88:91],a[84:87],v[104:107],v[88:91]
ds_read_b128 v[120:123],v5 offset:24576
v_mfma_f32_16x16x32_bf16 v[92:95],a[84:87],v[108:111],v[92:95]
v_mfma_f32_16x16x32_bf16 v[96:99],a[92:95],v[104:107],v[96:99]
ds_read_b128 v[124:127],v5 offset:28672
v_mfma_f32_16x16x32_bf16 v[100:103],a[92:95],v[108:111],v[100:103]
s_waitcnt lgkmcnt(2)
v_mfma_f32_16x16x32_bf16 v[88:91],a[96:99],v[112:115],v[88:91]
ds_read_b128 v[104:107],v6 offset:24576
v_mfma_f32_16x16x32_bf16 v[92:95],a[96:99],v[116:119],v[92:95]
v_mfma_f32_16x16x32_bf16 v[96:99],a[104:107],v[112:115],v[96:99]
ds_read_b128 v[108:111],v6 offset:28672
v_mfma_f32_16x16x32_bf16 v[100:103],a[104:107],v[116:119],v[100:103]
s_waitcnt lgkmcnt(2)
v_mfma_f32_16x16x32_bf16 v[88:91],a[100:103],v[120:123],v[88:91]
ds_read_b128 v[112:115],v7 offset:24576
v_mfma_f32_16x16x32_bf16 v[92:95],a[100:103],v[124:127],v[92:95]
v_mfma_f32_16x16x32_bf16 v[96:99],a[108:111],v[120:123],v[96:99]
ds_read_b128 v[116:119],v7 offset:28672
v_mfma_f32_16x16x32_bf16 v[100:103],a[108:111],v[124:127],v[100:103]
s_waitcnt lgkmcnt(2)
v_mfma_f32_16x16x32_bf16 v[88:91],a[112:115],v[104:107],v[88:91]
v_mfma_f32_16x16x32_bf16 v[92:95],a[112:115],v[108:111],v[92:95]
v_mfma_f32_16x16x32_bf16 v[96:99],a[120:123],v[104:107],v[96:99]
v_mfma_f32_16x16x32_bf16 v[100:103],a[120:123],v[108:111],v[100:103]
s_waitcnt lgkmcnt(0)
v_mfma_f32_16x16x32_bf16 v[88:91],a[116:119],v[112:115],v[88:91]
v_mfma_f32_16x16x32_bf16 v[92:95],a[116:119],v[116:119],v[92:95]
v_mfma_f32_16x16x32_bf16 v[96:99],a[124:127],v[112:115],v[96:99]
v_mfma_f32_16x16x32_bf16 v[100:103],a[124:127],v[116:119],v[100:103]
s_nop 3
v_cvt_pk_bf16_f32 v104,v88,v96
v_cvt_pk_bf16_f32 v105,v89,v97
v_cvt_pk_bf16_f32 v106,v90,v98
v_cvt_pk_bf16_f32 v107,v91,v99
v_cvt_pk_bf16_f32 v108,v92,v100
v_cvt_pk_bf16_f32 v109,v93,v101
v_cvt_pk_bf16_f32 v110,v94,v102
v_cvt_pk_bf16_f32 v111,v95,v103
buffer_store_dwordx4 v[104:107],v0,s[8:11],s63 offen sc1
buffer_store_dwordx4 v[108:111],v0,s[8:11],s64 offen sc1
s_lshl_b32 s59,s51,13
s_lshl2_add_u32 s59,s47,s59
s_add_u32 s59,s59,10486016
s_waitcnt vmcnt(2)
s_barrier
s_or_b32 s59,s59,s52
buffer_store_dword v17,off,s[8:11],s59 sc1
s_add_u32 m0,s50,131072
s_nop 0
buffer_load_dwordx4 v20,s[8:11],s70 offen offset:0 sc1 lds
s_add_u32 m0,s50,135168
s_nop 0
buffer_load_dwordx4 v20,s[8:11],s71 offen offset:0 sc1 lds
s_add_u32 m0,s50,139008
s_nop 0
buffer_load_dwordx4 v20,s[8:11],s70 offen offset:256 sc1 lds
s_add_u32 m0,s50,143104
s_nop 0
buffer_load_dwordx4 v20,s[8:11],s71 offen offset:256 sc1 lds
s_add_u32 m0,s50,146944
s_nop 0
buffer_load_dwordx4 v20,s[8:11],s70 offen offset:512 sc1 lds
s_add_u32 m0,s50,151040
s_nop 0
buffer_load_dwordx4 v20,s[8:11],s71 offen offset:512 sc1 lds
s_lshl_b32 s59,s51,13
s_lshl2_add_u32 s59,s47,s59
s_add_u32 s59,s59,10487680
s_waitcnt vmcnt(0)
s_barrier
s_or_b32 s59,s59,s52
buffer_store_dword v17,off,s[8:11],s59 sc1
L_mo_265:
s_mov_b32 s77,-1
s_sub_u32 s56,s30,s31
s_cmp_eq_u32 s73,0
s_cselect_b32 s57,22,8
s_add_u32 s57,s57,s73
s_min_u32 s57,s57,60
s_cmp_lt_i32 s56,s57
s_cbranch_scc1 L_mo_262
s_waitcnt vmcnt(0)
s_barrier
s_or_b32 s72,s72,s52
buffer_store_dword v17,off,s[8:11],s72 sc1
s_mov_b32 s72,0x80000000
s_cmp_lt_u32 s31,64
s_cbranch_scc1 L_mo_261
s_mov_b32 s51,64
v_lshrrev_b32 v2,3,v1
v_and_b32 v3,7,v1
v_lshlrev_b32 v3,4,v3
v_lshl_add_u32 v3,v2,13,v3
s_lshr_b64 s[88:89],s[84:85],0
v_lshrrev_b32 v60,v2,s88
v_and_b32 v60,1,v60
v_mul_u32_u24 v60,768,v60
v_sub_u32 v60,v3,v60
v_add_u32 v60,10487296,v60
s_lshr_b64 s[88:89],s[84:85],8
v_lshrrev_b32 v61,v2,s88
v_and_b32 v61,1,v61
v_mul_u32_u24 v61,768,v61
v_sub_u32 v61,v3,v61
v_add_u32 v61,10552832,v61
s_lshr_b64 s[88:89],s[84:85],16
v_lshrrev_b32 v62,v2,s88
v_and_b32 v62,1,v62
v_mul_u32_u24 v62,768,v62
v_sub_u32 v62,v3,v62
v_add_u32 v62,10618368,v62
s_lshr_b64 s[88:89],s[84:85],24
v_lshrrev_b32 v63,v2,s88
v_and_b32 v63,1,v63
v_mul_u32_u24 v63,768,v63
v_sub_u32 v63,v3,v63
v_add_u32 v63,10683904,v63
s_lshr_b64 s[88:89],s[84:85],32
v_lshrrev_b32 v64,v2,s88
v_and_b32 v64,1,v64
v_mul_u32_u24 v64,768,v64
v_sub_u32 v64,v3,v64
v_add_u32 v64,10749440,v64
s_lshr_b64 s[88:89],s[84:85],40
v_lshrrev_b32 v65,v2,s88
v_and_b32 v65,1,v65
v_mul_u32_u24 v65,768,v65
v_sub_u32 v65,v3,v65
v_add_u32 v65,10814976,v65
s_lshr_b64 s[88:89],s[84:85],48
v_lshrrev_b32 v66,v2,s88
v_and_b32 v66,1,v66
v_mul_u32_u24 v66,768,v66
v_sub_u32 v66,v3,v66
v_add_u32 v66,10880512,v66
s_lshr_b64 s[88:89],s[84:85],56
v_lshrrev_b32 v67,v2,s88
v_and_b32 v67,1,v67
v_mul_u32_u24 v67,768,v67
v_sub_u32 v67,v3,v67
v_add_u32 v67,10946048,v67
L_mw_275:
s_sleep 2
buffer_load_dwordx4 v[24:27],v60,s[8:11],0 offen sc1
buffer_load_dwordx4 v[28:31],v61,s[8:11],0 offen sc1
buffer_load_dwordx4 v[32:35],v62,s[8:11],0 offen sc1
buffer_load_dwordx4 v[36:39],v63,s[8:11],0 offen sc1
buffer_load_dwordx4 v[40:43],v64,s[8:11],0 offen sc1
buffer_load_dwordx4 v[44:47],v65,s[8:11],0 offen sc1
buffer_load_dwordx4 v[48:51],v66,s[8:11],0 offen sc1
buffer_load_dwordx4 v[52:55],v67,s[8:11],0 offen sc1
s_sub_u32 s49,s49,1
s_cbranch_scc1 L_abort2
s_waitcnt vmcnt(0)
v_min_u32 v56,v24,v25
v_min3_u32 v56,v26,v27,v56
v_min3_u32 v56,v28,v29,v56
v_min3_u32 v56,v30,v31,v56
v_min3_u32 v56,v32,v33,v56
v_min3_u32 v56,v34,v35,v56
v_min3_u32 v56,v36,v37,v56
v_min3_u32 v56,v38,v39,v56
v_min3_u32 v56,v40,v41,v56
v_min3_u32 v56,v42,v43,v56
v_min3_u32 v56,v44,v45,v56
v_min3_u32 v56,v46,v47,v56
v_min3_u32 v56,v48,v49,v56
v_min3_u32 v56,v50,v51,v56
v_min3_u32 v56,v52,v53,v56
v_min3_u32 v56,v54,v55,v56
v_cmp_eq_u32 vcc,0,v56
s_cbranch_vccnz L_mw_275
v_max_u32 v24,v24,v25
v_max3_u32 v24,v26,v27,v24
v_max3_u32 v24,v28,v29,v24
v_max3_u32 v24,v30,v31,v24
v_max3_u32 v24,v32,v33,v24
v_max3_u32 v24,v34,v35,v24
v_max3_u32 v24,v36,v37,v24
v_max3_u32 v24,v38,v39,v24
v_max3_u32 v24,v40,v41,v24
v_max3_u32 v24,v42,v43,v24
v_max3_u32 v24,v44,v45,v24
v_max3_u32 v24,v46,v47,v24
v_max3_u32 v24,v48,v49,v24
v_max3_u32 v24,v50,v51,v24
v_max3_u32 v24,v52,v53,v24
v_max3_u32 v24,v54,v55,v24
s_nop 1
v_max_u32_dpp v24,v24,v24 row_ror:8 row_mask:0xf bank_mask:0xf
s_nop 1
v_max_u32_dpp v24,v24,v24 row_ror:4 row_mask:0xf bank_mask:0xf
s_nop 1
v_max_u32_dpp v24,v24,v24 row_ror:2 row_mask:0xf bank_mask:0xf
s_nop 1
v_max_u32_dpp v24,v24,v24 row_ror:1 row_mask:0xf bank_mask:0xf
v_mov_b32 v25,v24
s_nop 1
v_permlane16_swap_b32 v24,v25
v_max_u32 v24,v24,v25
v_mov_b32 v25,v24
s_nop 1
v_permlane32_swap_b32 v24,v25
v_max_u32 v24,v24,v25
s_nop 0
v_readfirstlane_b32 s55,v24
s_and_b32 s64,s55,0x7ff
s_sub_u32 s64,2047,s64
s_lshl_b32 s56,s64,10
s_add_u32 s58,s56,6291456
buffer_load_dwordx4 v[88:91],v0,s[8:11],s58 offen sc1
s_mov_b32 s4,s38
s_mov_b32 s5,s39
s_mov_b32 s6,1835008
s_mov_b32 s7,0x20000
v_and_b32 v9,15,v1
v_lshrrev_b32 v10,4,v1
v_lshlrev_b32 v8,14,v10
v_lshl_add_u32 v8,v9,4,v8
s_lshl_b32 s59,s47,16
s_lshl_b32 s60,s46,8
s_add_u32 s59,s59,s60
buffer_load_dwordx4 v[24:27],v8,s[4:7],s59 offen offset:0
buffer_load_dwordx4 v[28:31],v8,s[4:7],s59 offen offset:1024
buffer_load_dwordx4 v[32:35],v8,s[4:7],s59 offen offset:2048
buffer_load_dwordx4 v[36:39],v8,s[4:7],s59 offen offset:3072
s_add_u32 s59,s59,4096
buffer_load_dwordx4 v[40:43],v8,s[4:7],s59 offen offset:0
buffer_load_dwordx4 v[44:47],v8,s[4:7],s59 offen offset:1024
buffer_load_dwordx4 v[48:51],v8,s[4:7],s59 offen offset:2048
buffer_load_dwordx4 v[52:55],v8,s[4:7],s59 offen offset:3072
s_add_u32 s59,s59,4096
buffer_load_dwordx4 v[56:59],v8,s[4:7],s59 offen offset:0
buffer_load_dwordx4 v[60:63],v8,s[4:7],s59 offen offset:1024
buffer_load_dwordx4 v[64:67],v8,s[4:7],s59 offen offset:2048
buffer_load_dwordx4 v[68:71],v8,s[4:7],s59 offen offset:3072
s_add_u32 s59,s59,4096
buffer_load_dwordx4 v[72:75],v8,s[4:7],s59 offen offset:0
buffer_load_dwordx4 v[76:79],v8,s[4:7],s59 offen offset:1024
buffer_load_dwordx4 v[80:83],v8,s[4:7],s59 offen offset:2048
buffer_load_dwordx4 v[84:87],v8,s[4:7],s59 offen offset:3072
v_and_b32 v124,1,v1
v_lshlrev_b32 v124,4,v124
v_mov_b32 v125,0xffff
v_lshlrev_b32 v125,v124,v125
v_lshrrev_b32 v124,1,v9
v_cmp_eq_u32 vcc,0,v124
s_nop 1
v_cndmask_b32 v12,0,v125,vcc
v_cmp_eq_u32 vcc,1,v124
s_nop 1
v_cndmask_b32 v13,0,v125,vcc
v_cmp_eq_u32 vcc,2,v124
s_nop 1
v_cndmask_b32 v14,0,v125,vcc
v_cmp_eq_u32 vcc,3,v124
s_nop 1
v_cndmask_b32 v15,0,v125,vcc
s_waitcnt vmcnt(16)
v_lshlrev_b32 v96,16,v88
v_and_b32 v97,0xffff0000,v88
v_lshlrev_b32 v98,16,v89
v_and_b32 v99,0xffff0000,v89
v_lshlrev_b32 v100,16,v90
v_and_b32 v101,0xffff0000,v90
v_lshlrev_b32 v102,16,v91
v_and_b32 v103,0xffff0000,v91
v_readfirstlane_b32 s78,v96
s_nop 1
v_pk_add_f32 v[108:109],v[96:97],s[78:79] op_sel_hi:[1,0] neg_lo:[0,1] neg_hi:[0,1]
v_pk_add_f32 v[110:111],v[98:99],s[78:79] op_sel_hi:[1,0] neg_lo:[0,1] neg_hi:[0,1]
v_pk_add_f32 v[112:113],v[100:101],s[78:79] op_sel_hi:[1,0] neg_lo:[0,1] neg_hi:[0,1]
v_pk_add_f32 v[114:115],v[102:103],s[78:79] op_sel_hi:[1,0] neg_lo:[0,1] neg_hi:[0,1]
v_pk_add_f32 v[116:117],v[108:109],v[110:111]
v_pk_mul_f32 v[118:119],v[108:109],v[108:109]
v_pk_add_f32 v[120:121],v[112:113],v[114:115]
v_pk_fma_f32 v[118:119],v[110:111],v[110:111],v[118:119]
v_pk_add_f32 v[116:117],v[116:117],v[120:121]
v_pk_fma_f32 v[118:119],v[112:113],v[112:113],v[118:119]
v_add_f32 v116,v116,v117
v_pk_fma_f32 v[118:119],v[114:115],v[114:115],v[118:119]
v_add_f32 v118,v118,v119
s_nop 1
v_permlane32_swap_b32 v116,v118
v_add_f32 v116,v116,v118
s_nop 1
v_add_f32_dpp v116,v116,v116 row_ror:8 row_mask:0xf bank_mask:0xf
s_nop 1
v_add_f32_dpp v116,v116,v116 row_ror:4 row_mask:0xf bank_mask:0xf
s_nop 1
v_add_f32_dpp v116,v116,v116 row_ror:2 row_mask:0xf bank_mask:0xf
s_nop 1
v_add_f32_dpp v116,v116,v116 row_ror:1 row_mask:0xf bank_mask:0xf
v_mov_b32 v118,v116
s_nop 1
v_permlane16_swap_b32 v116,v118
v_add_f32 v116,v116,v118
v_mul_f32 v116,0x3b000000,v116
v_mov_b32 v118,v116
s_nop 1
v_permlane32_swap_b32 v116,v118
v_fma_f32 v118,-v116,v116,v118
v_add_f32 v116,s78,v116
v_max_f32 v118,0,v118
v_cvt_pk_bf16_f32 v118,v116,v118
v_lshlrev_b32 v116,16,v118
v_and_b32 v118,0xffff0000,v118
v_add_f32 v118,0x3727c5ac,v118
v_cvt_pk_bf16_f32 v118,v118,v118
v_and_b32 v118,0xffff0000,v118
v_sqrt_f32 v118,v118
v_pk_add_f32 v[108:109],v[96:97],v[116:117] op_sel_hi:[1,0] neg_lo:[0,1] neg_hi:[0,1]
v_pk_add_f32 v[110:111],v[98:99],v[116:117] op_sel_hi:[1,0] neg_lo:[0,1] neg_hi:[0,1]
v_pk_add_f32 v[112:113],v[100:101],v[116:117] op_sel_hi:[1,0] neg_lo:[0,1] neg_hi:[0,1]
v_pk_add_f32 v[114:115],v[102:103],v[116:117] op_sel_hi:[1,0] neg_lo:[0,1] neg_hi:[0,1]
v_cvt_pk_bf16_f32 v118,v118,v118
v_and_b32 v118,0xffff0000,v118
v_rcp_f32 v118,v118
v_cvt_pk_bf16_f32 v104,v108,v109
v_cvt_pk_bf16_f32 v105,v110,v111
v_cvt_pk_bf16_f32 v106,v112,v113
v_cvt_pk_bf16_f32 v107,v114,v115
v_lshlrev_b32 v108,16,v104
v_and_b32 v109,0xffff0000,v104
v_lshlrev_b32 v110,16,v105
v_and_b32 v111,0xffff0000,v105
v_lshlrev_b32 v112,16,v106
v_and_b32 v113,0xffff0000,v106
v_lshlrev_b32 v114,16,v107
v_and_b32 v115,0xffff0000,v107
v_pk_mul_f32 v[108:109],v[108:109],v[118:119] op_sel_hi:[1,0]
v_pk_mul_f32 v[110:111],v[110:111],v[118:119] op_sel_hi:[1,0]
v_pk_mul_f32 v[112:113],v[112:113],v[118:119] op_sel_hi:[1,0]
v_pk_mul_f32 v[114:115],v[114:115],v[118:119] op_sel_hi:[1,0]
v_cvt_pk_bf16_f32 v104,v108,v109
v_cvt_pk_bf16_f32 v105,v110,v111
v_cvt_pk_bf16_f32 v106,v112,v113
v_cvt_pk_bf16_f32 v107,v114,v115
s_mov_b32 s58,0x01000100
s_mov_b32 s59,0x03020302
v_perm_b32 v88,v104,v104,s58
v_perm_b32 v89,v104,v104,s59
v_perm_b32 v90,v105,v105,s58
v_perm_b32 v91,v105,v105,s59
v_perm_b32 v92,v106,v106,s58
v_perm_b32 v93,v106,v106,s59
v_perm_b32 v94,v107,v107,s58
v_perm_b32 v95,v107,v107,s59
v_lshlrev_b32 v8,5,v1
s_lshl_b32 s58,s46,11
s_add_u32 s58,s58,139264
v_add_u32 v8,s58,v8
ds_write_b128 v8,v[88:91]
ds_write_b128 v8,v[92:95] offset:16
s_lshl_b32 s59,s46,9
s_add_u32 s59,s58,s59
v_lshlrev_b32 v8,7,v10
v_add_u32 v8,s59,v8
s_waitcnt lgkmcnt(0)
ds_read_b128 v[108:111],v18 offset:0
ds_read_b128 v[88:91],v8 offset:0
ds_read_b128 v[92:95],v8 offset:16
ds_read_b128 v[112:115],v18 offset:1024
s_waitcnt lgkmcnt(1)
v_and_b32 v124,v12,v88
v_and_b32 v125,v13,v88
v_and_b32 v126,v14,v88
v_and_b32 v127,v15,v88
s_nop 1
v_mfma_f32_16x16x32_bf16 v[116:119],v[124:127],v[108:111],0
ds_read_b128 v[108:111],v18 offset:2048
s_waitcnt lgkmcnt(1)
v_and_b32 v124,v12,v89
v_and_b32 v125,v13,v89
v_and_b32 v126,v14,v89
v_and_b32 v127,v15,v89
s_nop 1
v_mfma_f32_16x16x32_bf16 v[116:119],v[124:127],v[112:115],v[116:119]
ds_read_b128 v[112:115],v18 offset:3072
s_waitcnt lgkmcnt(1)
v_and_b32 v124,v12,v90
v_and_b32 v125,v13,v90
v_and_b32 v126,v14,v90
v_and_b32 v127,v15,v90
s_nop 1
v_mfma_f32_16x16x32_bf16 v[116:119],v[124:127],v[108:111],v[116:119]
ds_read_b128 v[108:111],v18 offset:4096
s_waitcnt lgkmcnt(1)
v_and_b32 v124,v12,v91
v_and_b32 v125,v13,v91
v_and_b32 v126,v14,v91
v_and_b32 v127,v15,v91
s_nop 1
v_mfma_f32_16x16x32_bf16 v[116:119],v[124:127],v[112:115],v[116:119]
ds_read_b128 v[112:115],v18 offset:5120
s_waitcnt lgkmcnt(1)
v_and_b32 v124,v12,v92
v_and_b32 v125,v13,v92
v_and_b32 v126,v14,v92
v_and_b32 v127,v15,v92
s_nop 1
v_mfma_f32_16x16x32_bf16 v[116:119],v[124:127],v[108:111],v[116:119]
ds_read_b128 v[108:111],v18 offset:6144
s_waitcnt lgkmcnt(1)
v_and_b32 v124,v12,v93
v_and_b32 v125,v13,v93
v_and_b32 v126,v14,v93
v_and_b32 v127,v15,v93
s_nop 1
v_mfma_f32_16x16x32_bf16 v[116:119],v[124:127],v[112:115],v[116:119]
ds_read_b128 v[112:115],v18 offset:7168
s_waitcnt lgkmcnt(1)
v_and_b32 v124,v12,v94
v_and_b32 v125,v13,v94
v_and_b32 v126,v14,v94
v_and_b32 v127,v15,v94
s_nop 1
v_mfma_f32_16x16x32_bf16 v[116:119],v[124:127],v[108:111],v[116:119]
ds_read_b128 v[108:111],v18 offset:8192
s_waitcnt lgkmcnt(1)
v_and_b32 v124,v12,v95
v_and_b32 v125,v13,v95
v_and_b32 v126,v14,v95
v_and_b32 v127,v15,v95
s_nop 1
v_mfma_f32_16x16x32_bf16 v[116:119],v[124:127],v[112:115],v[116:119]
ds_read_b128 v[88:91],v8 offset:32
ds_read_b128 v[92:95],v8 offset:48
ds_read_b128 v[112:115],v18 offset:9216
s_waitcnt lgkmcnt(1)
v_and_b32 v124,v12,v88
v_and_b32 v125,v13,v88
v_and_b32 v126,v14,v88
v_and_b32 v127,v15,v88
s_nop 1
v_mfma_f32_16x16x32_bf16 v[116:119],v[124:127],v[108:111],v[116:119]
ds_read_b128 v[108:111],v18 offset:10240
s_waitcnt lgkmcnt(1)
v_and_b32 v124,v12,v89
v_and_b32 v125,v13,v89
v_and_b32 v126,v14,v89
v_and_b32 v127,v15,v89
s_nop 1
v_mfma_f32_16x16x32_bf16 v[116:119],v[124:127],v[112:115],v[116:119]
ds_read_b128 v[112:115],v18 offset:11264
s_waitcnt lgkmcnt(1)
v_and_b32 v124,v12,v90
v_and_b32 v125,v13,v90
v_and_b32 v126,v14,v90
v_and_b32 v127,v15,v90
s_nop 1
v_mfma_f32_16x16x32_bf16 v[116:119],v[124:127],v[108:111],v[116:119]
ds_read_b128 v[108:111],v18 offset:12288
s_waitcnt lgkmcnt(1)
v_and_b32 v124,v12,v91
v_and_b32 v125,v13,v91
v_and_b32 v126,v14,v91
v_and_b32 v127,v15,v91
s_nop 1
v_mfma_f32_16x16x32_bf16 v[116:119],v[124:127],v[112:115],v[116:119]
ds_read_b128 v[112:115],v18 offset:13312
s_waitcnt lgkmcnt(1)
v_and_b32 v124,v12,v92
v_and_b32 v125,v13,v92
v_and_b32 v126,v14,v92
v_and_b32 v127,v15,v92
s_nop 1
v_mfma_f32_16x16x32_bf16 v[116:119],v[124:127],v[108:111],v[116:119]
ds_read_b128 v[108:111],v18 offset:14336
s_waitcnt lgkmcnt(1)
v_and_b32 v124,v12,v93
v_and_b32 v125,v13,v93
v_and_b32 v126,v14,v93
v_and_b32 v127,v15,v93
s_nop 1
v_mfma_f32_16x16x32_bf16 v[116:119],v[124:127],v[112:115],v[116:119]
ds_read_b128 v[112:115],v18 offset:15360
s_waitcnt lgkmcnt(1)
v_and_b32 v124,v12,v94
v_and_b32 v125,v13,v94
v_and_b32 v126,v14,v94
v_and_b32 v127,v15,v94
s_nop 1
v_mfma_f32_16x16x32_bf16 v[116:119],v[124:127],v[108:111],v[116:119]
ds_read_b128 v[108:111],v18 offset:16384
s_waitcnt lgkmcnt(1)
v_and_b32 v124,v12,v95
v_and_b32 v125,v13,v95
v_and_b32 v126,v14,v95
v_and_b32 v127,v15,v95
s_nop 1
v_mfma_f32_16x16x32_bf16 v[116:119],v[124:127],v[112:115],v[116:119]
ds_read_b128 v[88:91],v8 offset:64
ds_read_b128 v[92:95],v8 offset:80
ds_read_b128 v[112:115],v18 offset:17408
s_waitcnt lgkmcnt(1)
v_and_b32 v124,v12,v88
v_and_b32 v125,v13,v88
v_and_b32 v126,v14,v88
v_and_b32 v127,v15,v88
s_nop 1
v_mfma_f32_16x16x32_bf16 v[116:119],v[124:127],v[108:111],v[116:119]
ds_read_b128 v[108:111],v18 offset:18432
s_waitcnt lgkmcnt(1)
v_and_b32 v124,v12,v89
v_and_b32 v125,v13,v89
v_and_b32 v126,v14,v89
v_and_b32 v127,v15,v89
s_nop 1
v_mfma_f32_16x16x32_bf16 v[116:119],v[124:127],v[112:115],v[116:119]
ds_read_b128 v[112:115],v18 offset:19456
s_waitcnt lgkmcnt(1)
v_and_b32 v124,v12,v90
v_and_b32 v125,v13,v90
v_and_b32 v126,v14,v90
v_and_b32 v127,v15,v90
s_nop 1
v_mfma_f32_16x16x32_bf16 v[116:119],v[124:127],v[108:111],v[116:119]
ds_read_b128 v[108:111],v18 offset:20480
s_waitcnt lgkmcnt(1)
v_and_b32 v124,v12,v91
v_and_b32 v125,v13,v91
v_and_b32 v126,v14,v91
v_and_b32 v127,v15,v91
s_nop 1
v_mfma_f32_16x16x32_bf16 v[116:119],v[124:127],v[112:115],v[116:119]
ds_read_b128 v[112:115],v18 offset:21504
s_waitcnt lgkmcnt(1)
v_and_b32 v124,v12,v92
v_and_b32 v125,v13,v92
v_and_b32 v126,v14,v92
v_and_b32 v127,v15,v92
s_nop 1
v_mfma_f32_16x16x32_bf16 v[116:119],v[124:127],v[108:111],v[116:119]
ds_read_b128 v[108:111],v18 offset:22528
s_waitcnt lgkmcnt(1)
v_and_b32 v124,v12,v93
v_and_b32 v125,v13,v93
v_and_b32 v126,v14,v93
v_and_b32 v127,v15,v93
s_nop 1
v_mfma_f32_16x16x32_bf16 v[116:119],v[124:127],v[112:115],v[116:119]
ds_read_b128 v[112:115],v18 offset:23552
s_waitcnt lgkmcnt(1)
v_and_b32 v124,v12,v94
v_and_b32 v125,v13,v94
v_and_b32 v126,v14,v94
v_and_b32 v127,v15,v94
s_nop 1
v_mfma_f32_16x16x32_bf16 v[116:119],v[124:127],v[108:111],v[116:119]
ds_read_b128 v[108:111],v18 offset:24576
s_waitcnt lgkmcnt(1)
v_and_b32 v124,v12,v95
v_and_b32 v125,v13,v95
v_and_b32 v126,v14,v95
v_and_b32 v127,v15,v95
s_nop 1
v_mfma_f32_16x16x32_bf16 v[116:119],v[124:127],v[112:115],v[116:119]
ds_read_b128 v[88:91],v8 offset:96
ds_read_b128 v[92:95],v8 offset:112
ds_read_b128 v[112:115],v18 offset:25600
s_waitcnt lgkmcnt(1)
v_and_b32 v124,v12,v88
v_and_b32 v125,v13,v88
v_and_b32 v126,v14,v88
v_and_b32 v127,v15,v88
s_nop 1
v_mfma_f32_16x16x32_bf16 v[116:119],v[124:127],v[108:111],v[116:119]
ds_read_b128 v[108:111],v18 offset:26624
s_waitcnt lgkmcnt(1)
v_and_b32 v124,v12,v89
v_and_b32 v125,v13,v89
v_and_b32 v126,v14,v89
v_and_b32 v127,v15,v89
s_nop 1
v_mfma_f32_16x16x32_bf16 v[116:119],v[124:127],v[112:115],v[116:119]
ds_read_b128 v[112:115],v18 offset:27648
s_waitcnt lgkmcnt(1)
v_and_b32 v124,v12,v90
v_and_b32 v125,v13,v90
v_and_b32 v126,v14,v90
v_and_b32 v127,v15,v90
s_nop 1
v_mfma_f32_16x16x32_bf16 v[116:119],v[124:127],v[108:111],v[116:119]
ds_read_b128 v[108:111],v18 offset:28672
s_waitcnt lgkmcnt(1)
v_and_b32 v124,v12,v91
v_and_b32 v125,v13,v91
v_and_b32 v126,v14,v91
v_and_b32 v127,v15,v91
s_nop 1
v_mfma_f32_16x16x32_bf16 v[116:119],v[124:127],v[112:115],v[116:119]
ds_read_b128 v[112:115],v18 offset:29696
s_waitcnt lgkmcnt(1)
v_and_b32 v124,v12,v92
v_and_b32 v125,v13,v92
v_and_b32 v126,v14,v92
v_and_b32 v127,v15,v92
s_nop 1
v_mfma_f32_16x16x32_bf16 v[116:119],v[124:127],v[108:111],v[116:119]
ds_read_b128 v[108:111],v18 offset:30720
s_waitcnt lgkmcnt(1)
v_and_b32 v124,v12,v93
v_and_b32 v125,v13,v93
v_and_b32 v126,v14,v93
v_and_b32 v127,v15,v93
s_nop 1
v_mfma_f32_16x16x32_bf16 v[116:119],v[124:127],v[112:115],v[116:119]
ds_read_b128 v[112:115],v18 offset:31744
s_waitcnt lgkmcnt(1)
v_and_b32 v124,v12,v94
v_and_b32 v125,v13,v94
v_and_b32 v126,v14,v94
v_and_b32 v127,v15,v94
s_nop 1
v_mfma_f32_16x16x32_bf16 v[116:119],v[124:127],v[108:111],v[116:119]
s_waitcnt lgkmcnt(0)
v_and_b32 v124,v12,v95
v_and_b32 v125,v13,v95
v_and_b32 v126,v14,v95
v_and_b32 v127,v15,v95
s_nop 1
v_mfma_f32_16x16x32_bf16 v[116:119],v[124:127],v[112:115],v[116:119]
v_lshlrev_b32 v8,5,v9
v_and_b32 v124,1,v10
v_lshl_add_u32 v8,v124,4,v8
v_lshrrev_b32 v124,1,v10
v_lshl_add_u32 v8,v124,11,v8
s_lshl_b32 s60,s46,9
s_add_u32 s60,s60,147456
v_add_u32 v8,s60,v8
ds_write_b128 v8,v[116:119]
v_lshlrev_b32 v8,2,v1
v_add_u32 v8,147456,v8
s_waitcnt lgkmcnt(0)
s_barrier
ds_read2st64_b32 v[88:89],v8 offset0:0 offset1:1
ds_read2st64_b32 v[90:91],v8 offset0:2 offset1:3
ds_read2st64_b32 v[92:93],v8 offset0:4 offset1:5
ds_read2st64_b32 v[94:95],v8 offset0:6 offset1:7
s_waitcnt lgkmcnt(0)
v_pk_add_f32 v[88:89],v[88:89],v[90:91]
v_pk_add_f32 v[92:93],v[92:93],v[94:95]
v_pk_add_f32 v[88:89],v[88:89],v[92:93]
v_cvt_pk_bf16_f32 v88,v88,v88
v_and_b32 v88,0xffff0000,v88
v_cvt_pk_bf16_f32 v89,v89,v89
v_and_b32 v89,0xffff0000,v89
v_mul_f32 v90,0xbfb8aa3b,v88
v_exp_f32 v90,v90
s_nop 0
v_add_f32 v90,1.0,v90
v_rcp_f32 v90,v90
s_nop 0
v_mul_f32 v88,v88,v90
v_cvt_pk_bf16_f32 v88,v88,v88
v_and_b32 v88,0xffff0000,v88
v_mul_f32 v88,v88,v89
v_cvt_pk_bf16_f32 v88,v88,v88
v_lshlrev_b32 v8,2,v1
v_add_u32 v8,s58,v8
ds_write_b32 v8,v88
v_lshlrev_b32 v8,6,v10
v_add_u32 v8,s58,v8
s_waitcnt lgkmcnt(0)
ds_read_b128 v[88:91],v8
ds_read_b128 v[92:95],v8 offset:16
ds_read_b128 v[108:111],v8 offset:32
ds_read_b128 v[112:115],v8 offset:48
s_waitcnt vmcnt(0) lgkmcnt(0)
v_and_b32 v124,v12,v88
v_and_b32 v125,v13,v88
v_and_b32 v126,v14,v88
v_and_b32 v127,v15,v88
s_nop 1
v_mfma_f32_16x16x32_bf16 v[116:119],v[124:127],v[24:27],0
v_and_b32 v124,v12,v89
v_and_b32 v125,v13,v89
v_and_b32 v126,v14,v89
v_and_b32 v127,v15,v89
s_nop 1
v_mfma_f32_16x16x32_bf16 v[116:119],v[124:127],v[28:31],v[116:119]
v_and_b32 v124,v12,v90
v_and_b32 v125,v13,v90
v_and_b32 v126,v14,v90
v_and_b32 v127,v15,v90
s_nop 1
v_mfma_f32_16x16x32_bf16 v[116:119],v[124:127],v[32:35],v[116:119]
v_and_b32 v124,v12,v91
v_and_b32 v125,v13,v91
v_and_b32 v126,v14,v91
v_and_b32 v127,v15,v91
s_nop 1
v_mfma_f32_16x16x32_bf16 v[116:119],v[124:127],v[36:39],v[116:119]
v_and_b32 v124,v12,v92
v_and_b32 v125,v13,v92
v_and_b32 v126,v14,v92
v_and_b32 v127,v15,v92
s_nop 1
v_mfma_f32_16x16x32_bf16 v[116:119],v[124:127],v[40:43],v[116:119]
v_and_b32 v124,v12,v93
v_and_b32 v125,v13,v93
v_and_b32 v126,v14,v93
v_and_b32 v127,v15,v93
s_nop 1
v_mfma_f32_16x16x32_bf16 v[116:119],v[124:127],v[44:47],v[116:119]
v_and_b32 v124,v12,v94
v_and_b32 v125,v13,v94
v_and_b32 v126,v14,v94
v_and_b32 v127,v15,v94
s_nop 1
v_mfma_f32_16x16x32_bf16 v[116:119],v[124:127],v[48:51],v[116:119]
v_and_b32 v124,v12,v95
v_and_b32 v125,v13,v95
v_and_b32 v126,v14,v95
v_and_b32 v127,v15,v95
s_nop 1
v_mfma_f32_16x16x32_bf16 v[116:119],v[124:127],v[52:55],v[116:119]
v_and_b32 v124,v12,v108
v_and_b32 v125,v13,v108
v_and_b32 v126,v14,v108
v_and_b32 v127,v15,v108
s_nop 1
v_mfma_f32_16x16x32_bf16 v[116:119],v[124:127],v[56:59],v[116:119]
v_and_b32 v124,v12,v109
v_and_b32 v125,v13,v109
v_and_b32 v126,v14,v109
v_and_b32 v127,v15,v109
s_nop 1
v_mfma_f32_16x16x32_bf16 v[116:119],v[124:127],v[60:63],v[116:119]
v_and_b32 v124,v12,v110
v_and_b32 v125,v13,v110
v_and_b32 v126,v14,v110
v_and_b32 v127,v15,v110
s_nop 1
v_mfma_f32_16x16x32_bf16 v[116:119],v[124:127],v[64:67],v[116:119]
v_and_b32 v124,v12,v111
v_and_b32 v125,v13,v111
v_and_b32 v126,v14,v111
v_and_b32 v127,v15,v111
s_nop 1
v_mfma_f32_16x16x32_bf16 v[116:119],v[124:127],v[68:71],v[116:119]
v_and_b32 v124,v12,v112
v_and_b32 v125,v13,v112
v_and_b32 v126,v14,v112
v_and_b32 v127,v15,v112
s_nop 1
v_mfma_f32_16x16x32_bf16 v[116:119],v[124:127],v[72:75],v[116:119]
v_and_b32 v124,v12,v113
v_and_b32 v125,v13,v113
v_and_b32 v126,v14,v113
v_and_b32 v127,v15,v113
s_nop 1
v_mfma_f32_16x16x32_bf16 v[116:119],v[124:127],v[76:79],v[116:119]
v_and_b32 v124,v12,v114
v_and_b32 v125,v13,v114
v_and_b32 v126,v14,v114
v_and_b32 v127,v15,v114
s_nop 1
v_mfma_f32_16x16x32_bf16 v[116:119],v[124:127],v[80:83],v[116:119]
v_and_b32 v124,v12,v115
v_and_b32 v125,v13,v115
v_and_b32 v126,v14,v115
v_and_b32 v127,v15,v115
s_nop 1
v_mfma_f32_16x16x32_bf16 v[116:119],v[124:127],v[84:87],v[116:119]
v_lshlrev_b32 v8,4,v9
v_and_b32 v124,1,v10
v_lshl_add_u32 v8,v124,3,v8
v_and_b32 v124,2,v10
v_lshl_add_u32 v8,v124,30,v8
s_lshl_b32 s65,s51,15
s_add_u32 s65,s65,92274688
s_lshl_b32 s59,s47,10
s_lshl_b32 s60,s46,8
s_add_u32 s59,s59,s60
s_add_u32 s59,s59,s65
v_cvt_pk_bf16_f32 v24,v116,v117
v_cvt_pk_bf16_f32 v25,v118,v119
buffer_store_dwordx2 v[24:25],v8,s[8:11],s59 offen sc1
s_lshl_b32 s59,s51,13
s_lshl2_add_u32 s59,s47,s59
s_add_u32 s59,s59,10486912
s_waitcnt vmcnt(0)
s_barrier
s_or_b32 s59,s59,s52
buffer_store_dword v17,off,s[8:11],s59 sc1
s_cmp_lg_u32 s47,0
s_cbranch_scc1 L_moed_276
s_lshl_b32 s59,s51,13
s_add_u32 s59,s59,10486912
v_and_b32 v124,31,v1
v_lshlrev_b32 v124,2,v124
L_fw_277:
buffer_load_dword v125,v124,s[8:11],s59 offen sc1
s_sub_u32 s49,s49,1
s_cbranch_scc1 L_abort2
s_waitcnt vmcnt(0)
v_cmp_eq_u32 vcc,0,v125
s_cbranch_vccnz L_fw_277
s_add_u32 s63,s65,0
buffer_load_dwordx4 v[24:27],v22,s[8:11],s63 offen sc1
s_add_u32 s63,s65,4096
buffer_load_dwordx4 v[28:31],v22,s[8:11],s63 offen sc1
s_add_u32 s63,s65,8192
buffer_load_dwordx4 v[32:35],v22,s[8:11],s63 offen sc1
s_add_u32 s63,s65,12288
buffer_load_dwordx4 v[36:39],v22,s[8:11],s63 offen sc1
s_add_u32 s63,s65,16384
buffer_load_dwordx4 v[40:43],v22,s[8:11],s63 offen sc1
s_add_u32 s63,s65,20480
buffer_load_dwordx4 v[44:47],v22,s[8:11],s63 offen sc1
s_add_u32 s63,s65,24576
buffer_load_dwordx4 v[48:51],v22,s[8:11],s63 offen sc1
s_add_u32 s63,s65,28672
buffer_load_dwordx4 v[52:55],v22,s[8:11],s63 offen sc1
v_and_b32 v64,15,v1
v_and_b32 v65,1,v1
v_lshlrev_b32 v65,4,v65
v_mov_b32 v66,0x3f80
v_lshlrev_b32 v66,v65,v66
v_lshrrev_b32 v64,1,v64
v_cmp_eq_u32 vcc,0,v64
s_nop 1
v_cndmask_b32 v56,0,v66,vcc
v_cmp_eq_u32 vcc,1,v64
s_nop 1
v_cndmask_b32 v57,0,v66,vcc
v_cmp_eq_u32 vcc,2,v64
s_nop 1
v_cndmask_b32 v58,0,v66,vcc
v_cmp_eq_u32 vcc,3,v64
s_nop 1
v_cndmask_b32 v59,0,v66,vcc
s_waitcnt vmcnt(7)
s_nop 0
v_mfma_f32_16x16x32_bf16 v[60:63],v[56:59],v[24:27],0
s_waitcnt vmcnt(6)
v_mfma_f32_16x16x32_bf16 v[60:63],v[56:59],v[28:31],v[60:63]
s_waitcnt vmcnt(5)
v_mfma_f32_16x16x32_bf16 v[60:63],v[56:59],v[32:35],v[60:63]
s_waitcnt vmcnt(4)
v_mfma_f32_16x16x32_bf16 v[60:63],v[56:59],v[36:39],v[60:63]
s_waitcnt vmcnt(3)
v_mfma_f32_16x16x32_bf16 v[60:63],v[56:59],v[40:43],v[60:63]
s_waitcnt vmcnt(2)
v_mfma_f32_16x16x32_bf16 v[60:63],v[56:59],v[44:47],v[60:63]
s_waitcnt vmcnt(1)
v_mfma_f32_16x16x32_bf16 v[60:63],v[56:59],v[48:51],v[60:63]
s_waitcnt vmcnt(0)
v_mfma_f32_16x16x32_bf16 v[60:63],v[56:59],v[52:55],v[60:63]
s_nop 7
ds_write_b128 v21,v[60:63]
s_waitcnt lgkmcnt(0)
s_barrier
s_cmp_lg_u32 s46,0
s_cbranch_scc1 L_moed_276
v_lshlrev_b32 v56,5,v1
v_add_u32 v56,155648,v56
ds_read_b128 v[24:27],v56
ds_read_b128 v[28:31],v56 offset:16
s_and_b32 s59,s55,0xffff0000
s_xor_b32 s60,s59,0x80000000
s_xor_b32 s61,s59,0xffff0000
s_cmp_lt_i32 s59,0
s_cselect_b32 s59,s60,s61
v_mov_b32 v56,s59
v_mul_f32 v56,0xbfb8aa3b,v56
v_exp_f32 v56,v56
s_nop 0
v_add_f32 v56,1.0,v56
v_rcp_f32 v56,v56
s_nop 0
v_cvt_pk_bf16_f32 v56,v56,v56
v_and_b32 v56,0xffff0000,v56
v_lshlrev_b32 v48,16,v104
v_and_b32 v49,0xffff0000,v104
v_lshlrev_b32 v50,16,v105
v_and_b32 v51,0xffff0000,v105
v_lshlrev_b32 v52,16,v106
v_and_b32 v53,0xffff0000,v106
v_lshlrev_b32 v54,16,v107
v_and_b32 v55,0xffff0000,v107
s_waitcnt lgkmcnt(0)
v_cvt_pk_bf16_f32 v40,v24,v25
v_cvt_pk_bf16_f32 v41,v26,v27
v_cvt_pk_bf16_f32 v42,v28,v29
v_cvt_pk_bf16_f32 v43,v30,v31
v_lshlrev_b32 v24,16,v40
v_and_b32 v25,0xffff0000,v40
v_lshlrev_b32 v26,16,v41
v_and_b32 v27,0xffff0000,v41
v_lshlrev_b32 v28,16,v42
v_and_b32 v29,0xffff0000,v42
v_lshlrev_b32 v30,16,v43
v_and_b32 v31,0xffff0000,v43
v_mul_f32 v24,v24,v56
v_mul_f32 v25,v25,v56
v_mul_f32 v26,v26,v56
v_mul_f32 v27,v27,v56
v_mul_f32 v28,v28,v56
v_mul_f32 v29,v29,v56
v_mul_f32 v30,v30,v56
v_mul_f32 v31,v31,v56
v_cvt_pk_bf16_f32 v40,v24,v25
v_cvt_pk_bf16_f32 v41,v26,v27
v_cvt_pk_bf16_f32 v42,v28,v29
v_cvt_pk_bf16_f32 v43,v30,v31
v_lshlrev_b32 v24,16,v40
v_and_b32 v25,0xffff0000,v40
v_lshlrev_b32 v26,16,v41
v_and_b32 v27,0xffff0000,v41
v_lshlrev_b32 v28,16,v42
v_and_b32 v29,0xffff0000,v42
v_lshlrev_b32 v30,16,v43
v_and_b32 v31,0xffff0000,v43
v_add_f32 v24,v24,v48
v_add_f32 v25,v25,v49
v_add_f32 v26,v26,v50
v_add_f32 v27,v27,v51
v_add_f32 v28,v28,v52
v_add_f32 v29,v29,v53
v_add_f32 v30,v30,v54
v_add_f32 v31,v31,v55
v_cvt_pk_bf16_f32 v40,v24,v25
v_cvt_pk_bf16_f32 v41,v26,v27
v_cvt_pk_bf16_f32 v42,v28,v29
v_cvt_pk_bf16_f32 v43,v30,v31
v_lshlrev_b32 v24,16,v40
v_and_b32 v25,0xffff0000,v40
v_lshlrev_b32 v26,16,v41
v_and_b32 v27,0xffff0000,v41
v_lshlrev_b32 v28,16,v42
v_and_b32 v29,0xffff0000,v42
v_lshlrev_b32 v30,16,v43
v_and_b32 v31,0xffff0000,v43
v_add_f32 v96,v96,v24
v_add_f32 v97,v97,v25
v_add_f32 v98,v98,v26
v_add_f32 v99,v99,v27
v_add_f32 v100,v100,v28
v_add_f32 v101,v101,v29
v_add_f32 v102,v102,v30
v_add_f32 v103,v103,v31
v_cvt_pk_bf16_f32 v80,v96,v97
v_cvt_pk_bf16_f32 v81,v98,v99
v_cvt_pk_bf16_f32 v82,v100,v101
v_cvt_pk_bf16_f32 v83,v102,v103
s_mov_b32 s4,s40
s_mov_b32 s5,s41
s_mov_b32 s6,2097152
s_mov_b32 s7,0x20000
buffer_store_dwordx4 v[80:83],v0,s[4:7],s56 offen sc1
L_moed_276:
s_endpgm
.section .rodata,"a"
.p2align 6
.amdhsa_kernel interleave_layers__memory_aug_recurrent_mem_tr__moe_arch_mod__prompt_kernel
  .amdhsa_next_free_vgpr 512
  .amdhsa_next_free_sgpr 102
  .amdhsa_accum_offset 256
  .amdhsa_group_segment_fixed_size 0
  .amdhsa_kernarg_size 120
  .amdhsa_user_sgpr_count 2
  .amdhsa_user_sgpr_kernarg_segment_ptr 1
  .amdhsa_system_sgpr_workgroup_id_x 1
  .amdhsa_float_denorm_mode_32 3
.end_amdhsa_kernel
```

```asm
; @launch grid=(256,1,1) block=(256,1,1) lds=163840
.amdgcn_target "amdgcn-amd-amdhsa--gfx950"
.text
.globl interleave_layers__memory_aug_recurrent_mem_tr__moe_arch_mod__prompt_kernel
.p2align 8
.type interleave_layers__memory_aug_recurrent_mem_tr__moe_arch_mod__prompt_kernel,@function
interleave_layers__memory_aug_recurrent_mem_tr__moe_arch_mod__prompt_kernel:
s_cmp_ge_u32 s2,256
s_cbranch_scc1 L_abort
s_load_dwordx16 s[16:31],s[0:1],0
s_load_dwordx8 s[32:39],s[0:1],64
s_load_dwordx4 s[40:43],s[0:1],96
s_load_dwordx2 s[44:45],s[0:1],112
v_lshrrev_b32 v2,6,v0
v_and_b32 v1,63,v0
v_readfirstlane_b32 s46,v2
v_lshlrev_b32 v0,4,v1
s_getreg_b32 s48,hwreg(HW_REG_XCC_ID)
s_and_b32 s48,s48,7
s_lshl_b32 s48,s48,2
s_lshr_b32 s48,1399931488,s48
s_and_b32 s48,s48,7
s_mov_b32 s49,100000
s_mov_b32 s80,0x3e0293ee
s_waitcnt lgkmcnt(0)
s_mov_b32 s8,s44
s_mov_b32 s9,s45
s_mov_b32 s10,268435456
s_mov_b32 s11,0x20000
s_mov_b32 s12,s42
s_mov_b32 s13,s43
s_mov_b32 s14,256
s_mov_b32 s15,0x20000
s_cmp_lg_u32 s46,0
s_cbranch_scc1 L_tk_1
s_lshl_b32 s56,s48,2
v_mov_b32 v2,s56
v_mov_b32 v3,1
s_mov_b64 exec,1
buffer_atomic_add v3,v2,s[12:15],0 offen sc0
s_waitcnt vmcnt(0)
v_mov_b32 v4,159744
ds_write_b32 v4,v3
s_mov_b64 exec,-1
s_waitcnt lgkmcnt(0)
L_tk_1:
s_barrier
v_mov_b32 v4,159744
ds_read_b32 v3,v4
s_waitcnt lgkmcnt(0)
v_readfirstlane_b32 s47,v3
s_mov_b32 s3,0
s_cmp_ge_u32 s47,32
s_cselect_b32 s53,0x10001,1
s_and_b32 s47,s47,31
s_lshl_b32 s50,s46,10
s_cmp_eq_u32 s46,0
s_cselect_b32 s52,0,0x80000000
s_mov_b32 s28,0x3f803f80
s_mov_b32 s29,0x3f803f80
s_mov_b32 s51,0
s_lshl_b32 s56,s2,12
s_lshl_b32 s57,s46,10
s_add_u32 s56,s56,s57
v_add_u32 v2,s56,v0
v_mov_b32 v4,-1
v_mov_b32 v5,-1
v_mov_b32 v6,-1
v_mov_b32 v7,-1
v_mov_b32 v8,0
v_mov_b32 v9,0
v_mov_b32 v10,0
v_mov_b32 v11,0
v_cmp_gt_u32 vcc,524288,v2
v_mov_b32 v3,14155776
v_mov_b32 v12,11542528
v_cndmask_b32 v3,v3,v12,vcc
v_add_u32 v3,v3,v2
s_mov_b32 s56,0
buffer_store_dwordx4 v[4:7],v3,s[8:11],s56 offen sc1
s_mov_b32 s56,1048576
buffer_store_dwordx4 v[4:7],v3,s[8:11],s56 offen sc1
s_mov_b32 s56,2097152
buffer_store_dwordx4 v[4:7],v3,s[8:11],s56 offen sc1
s_mov_b32 s56,4194304
buffer_store_dwordx4 v[4:7],v2,s[8:11],s56 offen sc1
s_mov_b32 s56,5242880
buffer_store_dwordx4 v[4:7],v2,s[8:11],s56 offen sc1
v_add_u32 v3,17309696,v2
v_mov_b32 v12,0x80000000
v_cndmask_b32 v3,v3,v12,vcc
buffer_store_dwordx4 v[4:7],v3,s[8:11],0 offen sc1
v_cmp_gt_u32 vcc,147456,v2
v_lshrrev_b32 v3,11,v2
v_lshlrev_b32 v3,13,v3
v_and_b32 v13,0x7ff,v2
v_add_u32 v3,v3,v13
v_add_u32 v3,10485760,v3
v_cndmask_b32 v3,v12,v3,vcc
buffer_store_dwordx4 v[8:11],v3,s[8:11],0 offen sc1
s_mov_b32 s4,s16
s_mov_b32 s5,s17
s_mov_b32 s6,2097152
s_mov_b32 s7,0x20000
s_lshl_b32 s56,s2,3
s_lshl_b32 s57,s46,1
s_add_u32 s56,s56,s57
s_lshl_b32 s57,s56,10
buffer_load_dwordx4 v[24:27],v0,s[4:7],s57 offen
buffer_load_dwordx4 v[28:31],v0,s[4:7],s57 offen offset:1024
s_waitcnt vmcnt(0)
v_lshlrev_b32 v32,16,v24
v_and_b32 v33,0xffff0000,v24
v_lshlrev_b32 v34,16,v25
v_and_b32 v35,0xffff0000,v25
v_lshlrev_b32 v36,16,v26
v_and_b32 v37,0xffff0000,v26
v_lshlrev_b32 v38,16,v27
v_and_b32 v39,0xffff0000,v27
v_readfirstlane_b32 s78,v32
s_nop 1
v_pk_add_f32 v[48:49],v[32:33],s[78:79] op_sel_hi:[1,0] neg_lo:[0,1] neg_hi:[0,1]
v_pk_add_f32 v[50:51],v[34:35],s[78:79] op_sel_hi:[1,0] neg_lo:[0,1] neg_hi:[0,1]
v_pk_add_f32 v[52:53],v[36:37],s[78:79] op_sel_hi:[1,0] neg_lo:[0,1] neg_hi:[0,1]
v_pk_add_f32 v[54:55],v[38:39],s[78:79] op_sel_hi:[1,0] neg_lo:[0,1] neg_hi:[0,1]
v_pk_add_f32 v[56:57],v[48:49],v[50:51]
v_pk_mul_f32 v[58:59],v[48:49],v[48:49]
v_pk_add_f32 v[60:61],v[52:53],v[54:55]
v_pk_fma_f32 v[58:59],v[50:51],v[50:51],v[58:59]
v_pk_add_f32 v[56:57],v[56:57],v[60:61]
v_pk_fma_f32 v[58:59],v[52:53],v[52:53],v[58:59]
v_add_f32 v56,v56,v57
v_pk_fma_f32 v[58:59],v[54:55],v[54:55],v[58:59]
v_add_f32 v58,v58,v59
s_nop 1
v_permlane32_swap_b32 v56,v58
v_add_f32 v56,v56,v58
s_nop 1
v_add_f32_dpp v56,v56,v56 row_ror:8 row_mask:0xf bank_mask:0xf
s_nop 1
v_add_f32_dpp v56,v56,v56 row_ror:4 row_mask:0xf bank_mask:0xf
s_nop 1
v_add_f32_dpp v56,v56,v56 row_ror:2 row_mask:0xf bank_mask:0xf
s_nop 1
v_add_f32_dpp v56,v56,v56 row_ror:1 row_mask:0xf bank_mask:0xf
v_mov_b32 v58,v56
s_nop 1
v_permlane16_swap_b32 v56,v58
v_add_f32 v56,v56,v58
v_mul_f32 v56,0x3b000000,v56
v_mov_b32 v58,v56
s_nop 1
v_permlane32_swap_b32 v56,v58
v_fma_f32 v58,-v56,v56,v58
v_add_f32 v56,s78,v56
v_max_f32 v58,0,v58
v_cvt_pk_bf16_f32 v58,v56,v58
v_lshlrev_b32 v56,16,v58
v_and_b32 v58,0xffff0000,v58
v_add_f32 v58,0x3727c5ac,v58
v_cvt_pk_bf16_f32 v58,v58,v58
v_and_b32 v58,0xffff0000,v58
v_sqrt_f32 v58,v58
v_pk_add_f32 v[48:49],v[32:33],v[56:57] op_sel_hi:[1,0] neg_lo:[0,1] neg_hi:[0,1]
v_pk_add_f32 v[50:51],v[34:35],v[56:57] op_sel_hi:[1,0] neg_lo:[0,1] neg_hi:[0,1]
v_pk_add_f32 v[52:53],v[36:37],v[56:57] op_sel_hi:[1,0] neg_lo:[0,1] neg_hi:[0,1]
v_pk_add_f32 v[54:55],v[38:39],v[56:57] op_sel_hi:[1,0] neg_lo:[0,1] neg_hi:[0,1]
v_cvt_pk_bf16_f32 v58,v58,v58
v_and_b32 v58,0xffff0000,v58
v_rcp_f32 v58,v58
v_cvt_pk_bf16_f32 v40,v48,v49
v_cvt_pk_bf16_f32 v41,v50,v51
v_cvt_pk_bf16_f32 v42,v52,v53
v_cvt_pk_bf16_f32 v43,v54,v55
v_lshlrev_b32 v48,16,v40
v_and_b32 v49,0xffff0000,v40
v_lshlrev_b32 v50,16,v41
v_and_b32 v51,0xffff0000,v41
v_lshlrev_b32 v52,16,v42
v_and_b32 v53,0xffff0000,v42
v_lshlrev_b32 v54,16,v43
v_and_b32 v55,0xffff0000,v43
v_pk_mul_f32 v[48:49],v[48:49],v[58:59] op_sel_hi:[1,0]
v_pk_mul_f32 v[50:51],v[50:51],v[58:59] op_sel_hi:[1,0]
v_pk_mul_f32 v[52:53],v[52:53],v[58:59] op_sel_hi:[1,0]
v_pk_mul_f32 v[54:55],v[54:55],v[58:59] op_sel_hi:[1,0]
v_cvt_pk_bf16_f32 v40,v48,v49
v_cvt_pk_bf16_f32 v41,v50,v51
v_cvt_pk_bf16_f32 v42,v52,v53
v_cvt_pk_bf16_f32 v43,v54,v55
buffer_store_dwordx4 v[40:43],v0,s[8:11],s57 offen offset:0 sc1
v_lshlrev_b32 v32,16,v28
v_and_b32 v33,0xffff0000,v28
v_lshlrev_b32 v34,16,v29
v_and_b32 v35,0xffff0000,v29
v_lshlrev_b32 v36,16,v30
v_and_b32 v37,0xffff0000,v30
v_lshlrev_b32 v38,16,v31
v_and_b32 v39,0xffff0000,v31
v_readfirstlane_b32 s78,v32
s_nop 1
v_pk_add_f32 v[48:49],v[32:33],s[78:79] op_sel_hi:[1,0] neg_lo:[0,1] neg_hi:[0,1]
v_pk_add_f32 v[50:51],v[34:35],s[78:79] op_sel_hi:[1,0] neg_lo:[0,1] neg_hi:[0,1]
v_pk_add_f32 v[52:53],v[36:37],s[78:79] op_sel_hi:[1,0] neg_lo:[0,1] neg_hi:[0,1]
v_pk_add_f32 v[54:55],v[38:39],s[78:79] op_sel_hi:[1,0] neg_lo:[0,1] neg_hi:[0,1]
v_pk_add_f32 v[56:57],v[48:49],v[50:51]
v_pk_mul_f32 v[58:59],v[48:49],v[48:49]
v_pk_add_f32 v[60:61],v[52:53],v[54:55]
v_pk_fma_f32 v[58:59],v[50:51],v[50:51],v[58:59]
v_pk_add_f32 v[56:57],v[56:57],v[60:61]
v_pk_fma_f32 v[58:59],v[52:53],v[52:53],v[58:59]
v_add_f32 v56,v56,v57
v_pk_fma_f32 v[58:59],v[54:55],v[54:55],v[58:59]
v_add_f32 v58,v58,v59
s_nop 1
v_permlane32_swap_b32 v56,v58
v_add_f32 v56,v56,v58
s_nop 1
v_add_f32_dpp v56,v56,v56 row_ror:8 row_mask:0xf bank_mask:0xf
s_nop 1
v_add_f32_dpp v56,v56,v56 row_ror:4 row_mask:0xf bank_mask:0xf
s_nop 1
v_add_f32_dpp v56,v56,v56 row_ror:2 row_mask:0xf bank_mask:0xf
s_nop 1
v_add_f32_dpp v56,v56,v56 row_ror:1 row_mask:0xf bank_mask:0xf
v_mov_b32 v58,v56
s_nop 1
v_permlane16_swap_b32 v56,v58
v_add_f32 v56,v56,v58
v_mul_f32 v56,0x3b000000,v56
v_mov_b32 v58,v56
s_nop 1
v_permlane32_swap_b32 v56,v58
v_fma_f32 v58,-v56,v56,v58
v_add_f32 v56,s78,v56
v_max_f32 v58,0,v58
v_cvt_pk_bf16_f32 v58,v56,v58
v_lshlrev_b32 v56,16,v58
v_and_b32 v58,0xffff0000,v58
v_add_f32 v58,0x3727c5ac,v58
v_cvt_pk_bf16_f32 v58,v58,v58
v_and_b32 v58,0xffff0000,v58
v_sqrt_f32 v58,v58
v_pk_add_f32 v[48:49],v[32:33],v[56:57] op_sel_hi:[1,0] neg_lo:[0,1] neg_hi:[0,1]
v_pk_add_f32 v[50:51],v[34:35],v[56:57] op_sel_hi:[1,0] neg_lo:[0,1] neg_hi:[0,1]
v_pk_add_f32 v[52:53],v[36:37],v[56:57] op_sel_hi:[1,0] neg_lo:[0,1] neg_hi:[0,1]
v_pk_add_f32 v[54:55],v[38:39],v[56:57] op_sel_hi:[1,0] neg_lo:[0,1] neg_hi:[0,1]
v_cvt_pk_bf16_f32 v58,v58,v58
v_and_b32 v58,0xffff0000,v58
v_rcp_f32 v58,v58
v_cvt_pk_bf16_f32 v44,v48,v49
v_cvt_pk_bf16_f32 v45,v50,v51
v_cvt_pk_bf16_f32 v46,v52,v53
v_cvt_pk_bf16_f32 v47,v54,v55
v_lshlrev_b32 v48,16,v44
v_and_b32 v49,0xffff0000,v44
v_lshlrev_b32 v50,16,v45
v_and_b32 v51,0xffff0000,v45
v_lshlrev_b32 v52,16,v46
v_and_b32 v53,0xffff0000,v46
v_lshlrev_b32 v54,16,v47
v_and_b32 v55,0xffff0000,v47
v_pk_mul_f32 v[48:49],v[48:49],v[58:59] op_sel_hi:[1,0]
v_pk_mul_f32 v[50:51],v[50:51],v[58:59] op_sel_hi:[1,0]
v_pk_mul_f32 v[52:53],v[52:53],v[58:59] op_sel_hi:[1,0]
v_pk_mul_f32 v[54:55],v[54:55],v[58:59] op_sel_hi:[1,0]
v_cvt_pk_bf16_f32 v44,v48,v49
v_cvt_pk_bf16_f32 v45,v50,v51
v_cvt_pk_bf16_f32 v46,v52,v53
v_cvt_pk_bf16_f32 v47,v54,v55
buffer_store_dwordx4 v[44:47],v0,s[8:11],s57 offen offset:1024 sc1
s_mov_b32 s4,s18
s_mov_b32 s5,s19
s_mov_b32 s6,8192
s_mov_b32 s7,0x20000
s_cmp_ge_u32 s2,2
s_cbranch_scc1 L_m0_2
s_lshl_b32 s56,s2,2
s_add_u32 s56,s56,s46
v_bfe_u32 v2,v1,2,2
v_and_b32 v3,1,v1
v_lshl_add_u32 v2,v2,1,v3
v_lshlrev_b32 v2,10,v2
v_lshrrev_b32 v3,4,v1
v_lshl_add_u32 v2,v3,5,v2
v_and_b32 v3,2,v1
v_lshl_add_u32 v2,v3,1,v2
s_lshl_b32 s57,s56,7
buffer_load_dword v32,v2,s[4:7],s57 offen offset:0
buffer_load_dword v33,v2,s[4:7],s57 offen offset:8
buffer_load_dword v34,v2,s[4:7],s57 offen offset:16
buffer_load_dword v35,v2,s[4:7],s57 offen offset:24
v_lshrrev_b32 v2,3,v1
v_lshlrev_b32 v2,9,v2
v_and_b32 v3,7,v1
v_lshl_add_u32 v2,v3,4,v2
s_and_b32 s57,s56,1
s_lshl_b32 s57,s57,8
s_and_b32 s58,s56,2
s_lshl_b32 s58,s58,6
s_add_u32 s57,s57,s58
s_and_b32 s58,s56,4
s_lshl_b32 s58,s58,10
s_add_u32 s57,s57,s58
s_waitcnt vmcnt(0)
s_add_u32 s58,s57,11534336
buffer_store_dwordx4 v[32:35],v2,s[8:11],s58 offen sc1
s_add_u32 s58,s57,12582912
buffer_store_dwordx4 v[32:35],v2,s[8:11],s58 offen sc1
s_add_u32 s58,s57,17825792
buffer_store_dwordx4 v[32:35],v2,s[8:11],s58 offen sc1
L_m0_2:
s_waitcnt vmcnt(0) lgkmcnt(0)
s_barrier
s_cmp_lg_u32 s46,0
s_cbranch_scc1 L_ar_3
v_mov_b32 v124,128
v_mov_b32 v125,s53
s_mov_b64 exec,1
buffer_atomic_add v125,v124,s[12:15],0 offen
s_mov_b64 exec,-1
L_ar_3:
L_roles:
s_cmp_ge_u32 s48,6
s_cbranch_scc1 L_ra_6
v_and_b32 v2,15,v1
v_lshlrev_b32 v2,2,v2
v_lshrrev_b32 v3,4,v1
v_lshl_add_u32 v4,v3,16,v2
v_lshl_add_u32 v5,v3,13,v2
s_lshl_b32 s58,s47,8
s_lshl_b32 s57,s46,6
s_add_u32 s58,s58,s57
s_lshl_b32 s59,s47,17
s_add_u32 s59,s59,s57
s_lshl_b32 s60,s46,15
v_add_u32 v6,s60,v0
s_mov_b32 s61,0x05040100
s_mov_b32 s62,0x07060302
s_lshl_b32 s63,s46,19
s_cmp_lt_u32 s48,3
s_cselect_b32 s63,s63,0
s_mov_b32 s4,s22
s_mov_b32 s5,s23
s_mov_b32 s6,4194304
s_mov_b32 s7,0x20000
s_xor_b32 s56,s63,0
s_add_u32 s56,s56,s58
buffer_load_dword v24,v4,s[4:7],s56 offen
s_add_u32 s56,s56,8192
buffer_load_dword v25,v4,s[4:7],s56 offen
s_add_u32 s56,s56,8192
buffer_load_dword v26,v4,s[4:7],s56 offen
s_add_u32 s56,s56,8192
buffer_load_dword v27,v4,s[4:7],s56 offen
s_add_u32 s56,s56,8192
buffer_load_dword v28,v4,s[4:7],s56 offen
s_add_u32 s56,s56,8192
buffer_load_dword v29,v4,s[4:7],s56 offen
s_add_u32 s56,s56,8192
buffer_load_dword v30,v4,s[4:7],s56 offen
s_add_u32 s56,s56,8192
buffer_load_dword v31,v4,s[4:7],s56 offen
s_xor_b32 s56,s63,262144
s_add_u32 s56,s56,s58
buffer_load_dword v32,v4,s[4:7],s56 offen
s_add_u32 s56,s56,8192
buffer_load_dword v33,v4,s[4:7],s56 offen
s_add_u32 s56,s56,8192
buffer_load_dword v34,v4,s[4:7],s56 offen
s_add_u32 s56,s56,8192
buffer_load_dword v35,v4,s[4:7],s56 offen
s_add_u32 s56,s56,8192
buffer_load_dword v36,v4,s[4:7],s56 offen
s_add_u32 s56,s56,8192
buffer_load_dword v37,v4,s[4:7],s56 offen
s_add_u32 s56,s56,8192
buffer_load_dword v38,v4,s[4:7],s56 offen
s_add_u32 s56,s56,8192
buffer_load_dword v39,v4,s[4:7],s56 offen
s_xor_b32 s56,s63,524288
s_add_u32 s56,s56,s58
buffer_load_dword v40,v4,s[4:7],s56 offen
s_add_u32 s56,s56,8192
buffer_load_dword v41,v4,s[4:7],s56 offen
s_add_u32 s56,s56,8192
buffer_load_dword v42,v4,s[4:7],s56 offen
s_add_u32 s56,s56,8192
buffer_load_dword v43,v4,s[4:7],s56 offen
s_add_u32 s56,s56,8192
buffer_load_dword v44,v4,s[4:7],s56 offen
s_add_u32 s56,s56,8192
buffer_load_dword v45,v4,s[4:7],s56 offen
s_add_u32 s56,s56,8192
buffer_load_dword v46,v4,s[4:7],s56 offen
s_add_u32 s56,s56,8192
buffer_load_dword v47,v4,s[4:7],s56 offen
s_xor_b32 s56,s63,786432
s_add_u32 s56,s56,s58
buffer_load_dword v48,v4,s[4:7],s56 offen
s_add_u32 s56,s56,8192
buffer_load_dword v49,v4,s[4:7],s56 offen
s_add_u32 s56,s56,8192
buffer_load_dword v50,v4,s[4:7],s56 offen
s_add_u32 s56,s56,8192
buffer_load_dword v51,v4,s[4:7],s56 offen
s_add_u32 s56,s56,8192
buffer_load_dword v52,v4,s[4:7],s56 offen
s_add_u32 s56,s56,8192
buffer_load_dword v53,v4,s[4:7],s56 offen
s_add_u32 s56,s56,8192
buffer_load_dword v54,v4,s[4:7],s56 offen
s_add_u32 s56,s56,8192
buffer_load_dword v55,v4,s[4:7],s56 offen
s_xor_b32 s56,s63,1048576
s_add_u32 s56,s56,s58
buffer_load_dword v56,v4,s[4:7],s56 offen
s_add_u32 s56,s56,8192
buffer_load_dword v57,v4,s[4:7],s56 offen
s_add_u32 s56,s56,8192
buffer_load_dword v58,v4,s[4:7],s56 offen
s_add_u32 s56,s56,8192
buffer_load_dword v59,v4,s[4:7],s56 offen
s_add_u32 s56,s56,8192
buffer_load_dword v60,v4,s[4:7],s56 offen
s_add_u32 s56,s56,8192
buffer_load_dword v61,v4,s[4:7],s56 offen
s_add_u32 s56,s56,8192
buffer_load_dword v62,v4,s[4:7],s56 offen
s_add_u32 s56,s56,8192
buffer_load_dword v63,v4,s[4:7],s56 offen
s_xor_b32 s56,s63,1310720
s_add_u32 s56,s56,s58
buffer_load_dword v64,v4,s[4:7],s56 offen
s_add_u32 s56,s56,8192
buffer_load_dword v65,v4,s[4:7],s56 offen
s_add_u32 s56,s56,8192
buffer_load_dword v66,v4,s[4:7],s56 offen
s_add_u32 s56,s56,8192
buffer_load_dword v67,v4,s[4:7],s56 offen
s_add_u32 s56,s56,8192
buffer_load_dword v68,v4,s[4:7],s56 offen
s_add_u32 s56,s56,8192
buffer_load_dword v69,v4,s[4:7],s56 offen
s_add_u32 s56,s56,8192
buffer_load_dword v70,v4,s[4:7],s56 offen
s_add_u32 s56,s56,8192
buffer_load_dword v71,v4,s[4:7],s56 offen
s_xor_b32 s56,s63,1572864
s_add_u32 s56,s56,s58
buffer_load_dword v72,v4,s[4:7],s56 offen
s_add_u32 s56,s56,8192
buffer_load_dword v73,v4,s[4:7],s56 offen
s_add_u32 s56,s56,8192
buffer_load_dword v74,v4,s[4:7],s56 offen
s_add_u32 s56,s56,8192
buffer_load_dword v75,v4,s[4:7],s56 offen
s_add_u32 s56,s56,8192
buffer_load_dword v76,v4,s[4:7],s56 offen
s_add_u32 s56,s56,8192
buffer_load_dword v77,v4,s[4:7],s56 offen
s_add_u32 s56,s56,8192
buffer_load_dword v78,v4,s[4:7],s56 offen
s_add_u32 s56,s56,8192
buffer_load_dword v79,v4,s[4:7],s56 offen
s_waitcnt vmcnt(48)
v_perm_b32 v80,v25,v24,s61
v_perm_b32 v81,v27,v26,s61
v_perm_b32 v82,v29,v28,s61
v_perm_b32 v83,v31,v30,s61
v_perm_b32 v84,v25,v24,s62
v_perm_b32 v85,v27,v26,s62
v_perm_b32 v86,v29,v28,s62
v_perm_b32 v87,v31,v30,s62
v_accvgpr_write_b32 a128,v80
v_accvgpr_write_b32 a129,v81
v_accvgpr_write_b32 a130,v82
v_accvgpr_write_b32 a131,v83
v_accvgpr_write_b32 a136,v84
v_accvgpr_write_b32 a137,v85
v_accvgpr_write_b32 a138,v86
v_accvgpr_write_b32 a139,v87
s_xor_b32 s56,s63,1835008
s_add_u32 s56,s56,s58
buffer_load_dword v24,v4,s[4:7],s56 offen
s_add_u32 s56,s56,8192
buffer_load_dword v25,v4,s[4:7],s56 offen
s_add_u32 s56,s56,8192
buffer_load_dword v26,v4,s[4:7],s56 offen
s_add_u32 s56,s56,8192
buffer_load_dword v27,v4,s[4:7],s56 offen
s_add_u32 s56,s56,8192
buffer_load_dword v28,v4,s[4:7],s56 offen
s_add_u32 s56,s56,8192
buffer_load_dword v29,v4,s[4:7],s56 offen
s_add_u32 s56,s56,8192
buffer_load_dword v30,v4,s[4:7],s56 offen
s_add_u32 s56,s56,8192
buffer_load_dword v31,v4,s[4:7],s56 offen
s_waitcnt vmcnt(48)
v_perm_b32 v80,v33,v32,s61
v_perm_b32 v81,v35,v34,s61
v_perm_b32 v82,v37,v36,s61
v_perm_b32 v83,v39,v38,s61
v_perm_b32 v84,v33,v32,s62
v_perm_b32 v85,v35,v34,s62
v_perm_b32 v86,v37,v36,s62
v_perm_b32 v87,v39,v38,s62
v_accvgpr_write_b32 a132,v80
v_accvgpr_write_b32 a133,v81
v_accvgpr_write_b32 a134,v82
v_accvgpr_write_b32 a135,v83
v_accvgpr_write_b32 a140,v84
v_accvgpr_write_b32 a141,v85
v_accvgpr_write_b32 a142,v86
v_accvgpr_write_b32 a143,v87
s_xor_b32 s56,s63,2097152
s_add_u32 s56,s56,s58
buffer_load_dword v32,v4,s[4:7],s56 offen
s_add_u32 s56,s56,8192
buffer_load_dword v33,v4,s[4:7],s56 offen
s_add_u32 s56,s56,8192
buffer_load_dword v34,v4,s[4:7],s56 offen
s_add_u32 s56,s56,8192
buffer_load_dword v35,v4,s[4:7],s56 offen
s_add_u32 s56,s56,8192
buffer_load_dword v36,v4,s[4:7],s56 offen
s_add_u32 s56,s56,8192
buffer_load_dword v37,v4,s[4:7],s56 offen
s_add_u32 s56,s56,8192
buffer_load_dword v38,v4,s[4:7],s56 offen
s_add_u32 s56,s56,8192
buffer_load_dword v39,v4,s[4:7],s56 offen
s_waitcnt vmcnt(48)
v_perm_b32 v80,v41,v40,s61
v_perm_b32 v81,v43,v42,s61
v_perm_b32 v82,v45,v44,s61
v_perm_b32 v83,v47,v46,s61
v_perm_b32 v84,v41,v40,s62
v_perm_b32 v85,v43,v42,s62
v_perm_b32 v86,v45,v44,s62
v_perm_b32 v87,v47,v46,s62
v_accvgpr_write_b32 a144,v80
v_accvgpr_write_b32 a145,v81
v_accvgpr_write_b32 a146,v82
v_accvgpr_write_b32 a147,v83
v_accvgpr_write_b32 a152,v84
v_accvgpr_write_b32 a153,v85
v_accvgpr_write_b32 a154,v86
v_accvgpr_write_b32 a155,v87
s_xor_b32 s56,s63,2359296
s_add_u32 s56,s56,s58
buffer_load_dword v40,v4,s[4:7],s56 offen
s_add_u32 s56,s56,8192
buffer_load_dword v41,v4,s[4:7],s56 offen
s_add_u32 s56,s56,8192
buffer_load_dword v42,v4,s[4:7],s56 offen
s_add_u32 s56,s56,8192
buffer_load_dword v43,v4,s[4:7],s56 offen
s_add_u32 s56,s56,8192
buffer_load_dword v44,v4,s[4:7],s56 offen
s_add_u32 s56,s56,8192
buffer_load_dword v45,v4,s[4:7],s56 offen
s_add_u32 s56,s56,8192
buffer_load_dword v46,v4,s[4:7],s56 offen
s_add_u32 s56,s56,8192
buffer_load_dword v47,v4,s[4:7],s56 offen
s_waitcnt vmcnt(48)
v_perm_b32 v80,v49,v48,s61
v_perm_b32 v81,v51,v50,s61
v_perm_b32 v82,v53,v52,s61
v_perm_b32 v83,v55,v54,s61
v_perm_b32 v84,v49,v48,s62
v_perm_b32 v85,v51,v50,s62
v_perm_b32 v86,v53,v52,s62
v_perm_b32 v87,v55,v54,s62
v_accvgpr_write_b32 a148,v80
v_accvgpr_write_b32 a149,v81
v_accvgpr_write_b32 a150,v82
v_accvgpr_write_b32 a151,v83
v_accvgpr_write_b32 a156,v84
v_accvgpr_write_b32 a157,v85
v_accvgpr_write_b32 a158,v86
v_accvgpr_write_b32 a159,v87
s_xor_b32 s56,s63,2621440
s_add_u32 s56,s56,s58
buffer_load_dword v48,v4,s[4:7],s56 offen
s_add_u32 s56,s56,8192
buffer_load_dword v49,v4,s[4:7],s56 offen
s_add_u32 s56,s56,8192
buffer_load_dword v50,v4,s[4:7],s56 offen
s_add_u32 s56,s56,8192
buffer_load_dword v51,v4,s[4:7],s56 offen
s_add_u32 s56,s56,8192
buffer_load_dword v52,v4,s[4:7],s56 offen
s_add_u32 s56,s56,8192
buffer_load_dword v53,v4,s[4:7],s56 offen
s_add_u32 s56,s56,8192
buffer_load_dword v54,v4,s[4:7],s56 offen
s_add_u32 s56,s56,8192
buffer_load_dword v55,v4,s[4:7],s56 offen
s_waitcnt vmcnt(48)
v_perm_b32 v80,v57,v56,s61
v_perm_b32 v81,v59,v58,s61
v_perm_b32 v82,v61,v60,s61
v_perm_b32 v83,v63,v62,s61
v_perm_b32 v84,v57,v56,s62
v_perm_b32 v85,v59,v58,s62
v_perm_b32 v86,v61,v60,s62
v_perm_b32 v87,v63,v62,s62
v_accvgpr_write_b32 a160,v80
v_accvgpr_write_b32 a161,v81
v_accvgpr_write_b32 a162,v82
v_accvgpr_write_b32 a163,v83
v_accvgpr_write_b32 a168,v84
v_accvgpr_write_b32 a169,v85
v_accvgpr_write_b32 a170,v86
v_accvgpr_write_b32 a171,v87
s_xor_b32 s56,s63,2883584
s_add_u32 s56,s56,s58
buffer_load_dword v56,v4,s[4:7],s56 offen
s_add_u32 s56,s56,8192
buffer_load_dword v57,v4,s[4:7],s56 offen
s_add_u32 s56,s56,8192
buffer_load_dword v58,v4,s[4:7],s56 offen
s_add_u32 s56,s56,8192
buffer_load_dword v59,v4,s[4:7],s56 offen
s_add_u32 s56,s56,8192
buffer_load_dword v60,v4,s[4:7],s56 offen
s_add_u32 s56,s56,8192
buffer_load_dword v61,v4,s[4:7],s56 offen
s_add_u32 s56,s56,8192
buffer_load_dword v62,v4,s[4:7],s56 offen
s_add_u32 s56,s56,8192
buffer_load_dword v63,v4,s[4:7],s56 offen
s_waitcnt vmcnt(48)
v_perm_b32 v80,v65,v64,s61
v_perm_b32 v81,v67,v66,s61
v_perm_b32 v82,v69,v68,s61
v_perm_b32 v83,v71,v70,s61
v_perm_b32 v84,v65,v64,s62
v_perm_b32 v85,v67,v66,s62
v_perm_b32 v86,v69,v68,s62
v_perm_b32 v87,v71,v70,s62
v_accvgpr_write_b32 a164,v80
v_accvgpr_write_b32 a165,v81
v_accvgpr_write_b32 a166,v82
v_accvgpr_write_b32 a167,v83
v_accvgpr_write_b32 a172,v84
v_accvgpr_write_b32 a173,v85
v_accvgpr_write_b32 a174,v86
v_accvgpr_write_b32 a175,v87
s_xor_b32 s56,s63,3145728
s_add_u32 s56,s56,s58
buffer_load_dword v64,v4,s[4:7],s56 offen
s_add_u32 s56,s56,8192
buffer_load_dword v65,v4,s[4:7],s56 offen
s_add_u32 s56,s56,8192
buffer_load_dword v66,v4,s[4:7],s56 offen
s_add_u32 s56,s56,8192
buffer_load_dword v67,v4,s[4:7],s56 offen
s_add_u32 s56,s56,8192
buffer_load_dword v68,v4,s[4:7],s56 offen
s_add_u32 s56,s56,8192
buffer_load_dword v69,v4,s[4:7],s56 offen
s_add_u32 s56,s56,8192
buffer_load_dword v70,v4,s[4:7],s56 offen
s_add_u32 s56,s56,8192
buffer_load_dword v71,v4,s[4:7],s56 offen
s_waitcnt vmcnt(48)
v_perm_b32 v80,v73,v72,s61
v_perm_b32 v81,v75,v74,s61
v_perm_b32 v82,v77,v76,s61
v_perm_b32 v83,v79,v78,s61
v_perm_b32 v84,v73,v72,s62
v_perm_b32 v85,v75,v74,s62
v_perm_b32 v86,v77,v76,s62
v_perm_b32 v87,v79,v78,s62
v_accvgpr_write_b32 a176,v80
v_accvgpr_write_b32 a177,v81
v_accvgpr_write_b32 a178,v82
v_accvgpr_write_b32 a179,v83
v_accvgpr_write_b32 a184,v84
v_accvgpr_write_b32 a185,v85
v_accvgpr_write_b32 a186,v86
v_accvgpr_write_b32 a187,v87
s_xor_b32 s56,s63,3407872
s_add_u32 s56,s56,s58
buffer_load_dword v72,v4,s[4:7],s56 offen
s_add_u32 s56,s56,8192
buffer_load_dword v73,v4,s[4:7],s56 offen
s_add_u32 s56,s56,8192
buffer_load_dword v74,v4,s[4:7],s56 offen
s_add_u32 s56,s56,8192
buffer_load_dword v75,v4,s[4:7],s56 offen
s_add_u32 s56,s56,8192
buffer_load_dword v76,v4,s[4:7],s56 offen
s_add_u32 s56,s56,8192
buffer_load_dword v77,v4,s[4:7],s56 offen
s_add_u32 s56,s56,8192
buffer_load_dword v78,v4,s[4:7],s56 offen
s_add_u32 s56,s56,8192
buffer_load_dword v79,v4,s[4:7],s56 offen
s_waitcnt vmcnt(48)
v_perm_b32 v80,v25,v24,s61
v_perm_b32 v81,v27,v26,s61
v_perm_b32 v82,v29,v28,s61
v_perm_b32 v83,v31,v30,s61
v_perm_b32 v84,v25,v24,s62
v_perm_b32 v85,v27,v26,s62
v_perm_b32 v86,v29,v28,s62
v_perm_b32 v87,v31,v30,s62
v_accvgpr_write_b32 a180,v80
v_accvgpr_write_b32 a181,v81
v_accvgpr_write_b32 a182,v82
v_accvgpr_write_b32 a183,v83
v_accvgpr_write_b32 a188,v84
v_accvgpr_write_b32 a189,v85
v_accvgpr_write_b32 a190,v86
v_accvgpr_write_b32 a191,v87
s_xor_b32 s56,s63,3670016
s_add_u32 s56,s56,s58
buffer_load_dword v24,v4,s[4:7],s56 offen
s_add_u32 s56,s56,8192
buffer_load_dword v25,v4,s[4:7],s56 offen
s_add_u32 s56,s56,8192
buffer_load_dword v26,v4,s[4:7],s56 offen
s_add_u32 s56,s56,8192
buffer_load_dword v27,v4,s[4:7],s56 offen
s_add_u32 s56,s56,8192
buffer_load_dword v28,v4,s[4:7],s56 offen
s_add_u32 s56,s56,8192
buffer_load_dword v29,v4,s[4:7],s56 offen
s_add_u32 s56,s56,8192
buffer_load_dword v30,v4,s[4:7],s56 offen
s_add_u32 s56,s56,8192
buffer_load_dword v31,v4,s[4:7],s56 offen
s_waitcnt vmcnt(48)
v_perm_b32 v80,v33,v32,s61
v_perm_b32 v81,v35,v34,s61
v_perm_b32 v82,v37,v36,s61
v_perm_b32 v83,v39,v38,s61
v_perm_b32 v84,v33,v32,s62
v_perm_b32 v85,v35,v34,s62
v_perm_b32 v86,v37,v36,s62
v_perm_b32 v87,v39,v38,s62
v_accvgpr_write_b32 a192,v80
v_accvgpr_write_b32 a193,v81
v_accvgpr_write_b32 a194,v82
v_accvgpr_write_b32 a195,v83
v_accvgpr_write_b32 a200,v84
v_accvgpr_write_b32 a201,v85
v_accvgpr_write_b32 a202,v86
v_accvgpr_write_b32 a203,v87
s_xor_b32 s56,s63,3932160
s_add_u32 s56,s56,s58
buffer_load_dword v32,v4,s[4:7],s56 offen
s_add_u32 s56,s56,8192
buffer_load_dword v33,v4,s[4:7],s56 offen
s_add_u32 s56,s56,8192
buffer_load_dword v34,v4,s[4:7],s56 offen
s_add_u32 s56,s56,8192
buffer_load_dword v35,v4,s[4:7],s56 offen
s_add_u32 s56,s56,8192
buffer_load_dword v36,v4,s[4:7],s56 offen
s_add_u32 s56,s56,8192
buffer_load_dword v37,v4,s[4:7],s56 offen
s_add_u32 s56,s56,8192
buffer_load_dword v38,v4,s[4:7],s56 offen
s_add_u32 s56,s56,8192
buffer_load_dword v39,v4,s[4:7],s56 offen
s_waitcnt vmcnt(48)
v_perm_b32 v80,v41,v40,s61
v_perm_b32 v81,v43,v42,s61
v_perm_b32 v82,v45,v44,s61
v_perm_b32 v83,v47,v46,s61
v_perm_b32 v84,v41,v40,s62
v_perm_b32 v85,v43,v42,s62
v_perm_b32 v86,v45,v44,s62
v_perm_b32 v87,v47,v46,s62
v_accvgpr_write_b32 a196,v80
v_accvgpr_write_b32 a197,v81
v_accvgpr_write_b32 a198,v82
v_accvgpr_write_b32 a199,v83
v_accvgpr_write_b32 a204,v84
v_accvgpr_write_b32 a205,v85
v_accvgpr_write_b32 a206,v86
v_accvgpr_write_b32 a207,v87
s_mov_b32 s4,s24
s_mov_b32 s5,s25
s_mov_b32 s6,4194304
s_mov_b32 s7,0x20000
s_xor_b32 s56,s63,0
s_add_u32 s56,s56,s58
buffer_load_dword v40,v4,s[4:7],s56 offen
s_add_u32 s56,s56,8192
buffer_load_dword v41,v4,s[4:7],s56 offen
s_add_u32 s56,s56,8192
buffer_load_dword v42,v4,s[4:7],s56 offen
s_add_u32 s56,s56,8192
buffer_load_dword v43,v4,s[4:7],s56 offen
s_add_u32 s56,s56,8192
buffer_load_dword v44,v4,s[4:7],s56 offen
s_add_u32 s56,s56,8192
buffer_load_dword v45,v4,s[4:7],s56 offen
s_add_u32 s56,s56,8192
buffer_load_dword v46,v4,s[4:7],s56 offen
s_add_u32 s56,s56,8192
buffer_load_dword v47,v4,s[4:7],s56 offen
s_waitcnt vmcnt(48)
v_perm_b32 v80,v49,v48,s61
v_perm_b32 v81,v51,v50,s61
v_perm_b32 v82,v53,v52,s61
v_perm_b32 v83,v55,v54,s61
v_perm_b32 v84,v49,v48,s62
v_perm_b32 v85,v51,v50,s62
v_perm_b32 v86,v53,v52,s62
v_perm_b32 v87,v55,v54,s62
v_accvgpr_write_b32 a208,v80
v_accvgpr_write_b32 a209,v81
v_accvgpr_write_b32 a210,v82
v_accvgpr_write_b32 a211,v83
v_accvgpr_write_b32 a216,v84
v_accvgpr_write_b32 a217,v85
v_accvgpr_write_b32 a218,v86
v_accvgpr_write_b32 a219,v87
s_xor_b32 s56,s63,262144
s_add_u32 s56,s56,s58
buffer_load_dword v48,v4,s[4:7],s56 offen
s_add_u32 s56,s56,8192
buffer_load_dword v49,v4,s[4:7],s56 offen
s_add_u32 s56,s56,8192
buffer_load_dword v50,v4,s[4:7],s56 offen
s_add_u32 s56,s56,8192
buffer_load_dword v51,v4,s[4:7],s56 offen
s_add_u32 s56,s56,8192
buffer_load_dword v52,v4,s[4:7],s56 offen
s_add_u32 s56,s56,8192
buffer_load_dword v53,v4,s[4:7],s56 offen
s_add_u32 s56,s56,8192
buffer_load_dword v54,v4,s[4:7],s56 offen
s_add_u32 s56,s56,8192
buffer_load_dword v55,v4,s[4:7],s56 offen
s_waitcnt vmcnt(48)
v_perm_b32 v80,v57,v56,s61
v_perm_b32 v81,v59,v58,s61
v_perm_b32 v82,v61,v60,s61
v_perm_b32 v83,v63,v62,s61
v_perm_b32 v84,v57,v56,s62
v_perm_b32 v85,v59,v58,s62
v_perm_b32 v86,v61,v60,s62
v_perm_b32 v87,v63,v62,s62
v_accvgpr_write_b32 a212,v80
v_accvgpr_write_b32 a213,v81
v_accvgpr_write_b32 a214,v82
v_accvgpr_write_b32 a215,v83
v_accvgpr_write_b32 a220,v84
v_accvgpr_write_b32 a221,v85
v_accvgpr_write_b32 a222,v86
v_accvgpr_write_b32 a223,v87
s_xor_b32 s56,s63,524288
s_add_u32 s56,s56,s58
buffer_load_dword v56,v4,s[4:7],s56 offen
s_add_u32 s56,s56,8192
buffer_load_dword v57,v4,s[4:7],s56 offen
s_add_u32 s56,s56,8192
buffer_load_dword v58,v4,s[4:7],s56 offen
s_add_u32 s56,s56,8192
buffer_load_dword v59,v4,s[4:7],s56 offen
s_add_u32 s56,s56,8192
buffer_load_dword v60,v4,s[4:7],s56 offen
s_add_u32 s56,s56,8192
buffer_load_dword v61,v4,s[4:7],s56 offen
s_add_u32 s56,s56,8192
buffer_load_dword v62,v4,s[4:7],s56 offen
s_add_u32 s56,s56,8192
buffer_load_dword v63,v4,s[4:7],s56 offen
s_waitcnt vmcnt(48)
v_perm_b32 v80,v65,v64,s61
v_perm_b32 v81,v67,v66,s61
v_perm_b32 v82,v69,v68,s61
v_perm_b32 v83,v71,v70,s61
v_perm_b32 v84,v65,v64,s62
v_perm_b32 v85,v67,v66,s62
v_perm_b32 v86,v69,v68,s62
v_perm_b32 v87,v71,v70,s62
v_accvgpr_write_b32 a224,v80
v_accvgpr_write_b32 a225,v81
v_accvgpr_write_b32 a226,v82
v_accvgpr_write_b32 a227,v83
v_accvgpr_write_b32 a232,v84
v_accvgpr_write_b32 a233,v85
v_accvgpr_write_b32 a234,v86
v_accvgpr_write_b32 a235,v87
s_xor_b32 s56,s63,786432
s_add_u32 s56,s56,s58
buffer_load_dword v64,v4,s[4:7],s56 offen
s_add_u32 s56,s56,8192
buffer_load_dword v65,v4,s[4:7],s56 offen
s_add_u32 s56,s56,8192
buffer_load_dword v66,v4,s[4:7],s56 offen
s_add_u32 s56,s56,8192
buffer_load_dword v67,v4,s[4:7],s56 offen
s_add_u32 s56,s56,8192
buffer_load_dword v68,v4,s[4:7],s56 offen
s_add_u32 s56,s56,8192
buffer_load_dword v69,v4,s[4:7],s56 offen
s_add_u32 s56,s56,8192
buffer_load_dword v70,v4,s[4:7],s56 offen
s_add_u32 s56,s56,8192
buffer_load_dword v71,v4,s[4:7],s56 offen
s_waitcnt vmcnt(48)
v_perm_b32 v80,v73,v72,s61
v_perm_b32 v81,v75,v74,s61
v_perm_b32 v82,v77,v76,s61
v_perm_b32 v83,v79,v78,s61
v_perm_b32 v84,v73,v72,s62
v_perm_b32 v85,v75,v74,s62
v_perm_b32 v86,v77,v76,s62
v_perm_b32 v87,v79,v78,s62
v_accvgpr_write_b32 a228,v80
v_accvgpr_write_b32 a229,v81
v_accvgpr_write_b32 a230,v82
v_accvgpr_write_b32 a231,v83
v_accvgpr_write_b32 a236,v84
v_accvgpr_write_b32 a237,v85
v_accvgpr_write_b32 a238,v86
v_accvgpr_write_b32 a239,v87
s_xor_b32 s56,s63,1048576
s_add_u32 s56,s56,s58
buffer_load_dword v72,v4,s[4:7],s56 offen
s_add_u32 s56,s56,8192
buffer_load_dword v73,v4,s[4:7],s56 offen
s_add_u32 s56,s56,8192
buffer_load_dword v74,v4,s[4:7],s56 offen
s_add_u32 s56,s56,8192
buffer_load_dword v75,v4,s[4:7],s56 offen
s_add_u32 s56,s56,8192
buffer_load_dword v76,v4,s[4:7],s56 offen
s_add_u32 s56,s56,8192
buffer_load_dword v77,v4,s[4:7],s56 offen
s_add_u32 s56,s56,8192
buffer_load_dword v78,v4,s[4:7],s56 offen
s_add_u32 s56,s56,8192
buffer_load_dword v79,v4,s[4:7],s56 offen
s_waitcnt vmcnt(48)
v_perm_b32 v80,v25,v24,s61
v_perm_b32 v81,v27,v26,s61
v_perm_b32 v82,v29,v28,s61
v_perm_b32 v83,v31,v30,s61
v_perm_b32 v84,v25,v24,s62
v_perm_b32 v85,v27,v26,s62
v_perm_b32 v86,v29,v28,s62
v_perm_b32 v87,v31,v30,s62
v_accvgpr_write_b32 a240,v80
v_accvgpr_write_b32 a241,v81
v_accvgpr_write_b32 a242,v82
v_accvgpr_write_b32 a243,v83
v_accvgpr_write_b32 a248,v84
v_accvgpr_write_b32 a249,v85
v_accvgpr_write_b32 a250,v86
v_accvgpr_write_b32 a251,v87
s_xor_b32 s56,s63,1310720
s_add_u32 s56,s56,s58
buffer_load_dword v24,v4,s[4:7],s56 offen
s_add_u32 s56,s56,8192
buffer_load_dword v25,v4,s[4:7],s56 offen
s_add_u32 s56,s56,8192
buffer_load_dword v26,v4,s[4:7],s56 offen
s_add_u32 s56,s56,8192
buffer_load_dword v27,v4,s[4:7],s56 offen
s_add_u32 s56,s56,8192
buffer_load_dword v28,v4,s[4:7],s56 offen
s_add_u32 s56,s56,8192
buffer_load_dword v29,v4,s[4:7],s56 offen
s_add_u32 s56,s56,8192
buffer_load_dword v30,v4,s[4:7],s56 offen
s_add_u32 s56,s56,8192
buffer_load_dword v31,v4,s[4:7],s56 offen
s_waitcnt vmcnt(48)
v_perm_b32 v80,v33,v32,s61
v_perm_b32 v81,v35,v34,s61
v_perm_b32 v82,v37,v36,s61
v_perm_b32 v83,v39,v38,s61
v_perm_b32 v84,v33,v32,s62
v_perm_b32 v85,v35,v34,s62
v_perm_b32 v86,v37,v36,s62
v_perm_b32 v87,v39,v38,s62
v_accvgpr_write_b32 a244,v80
v_accvgpr_write_b32 a245,v81
v_accvgpr_write_b32 a246,v82
v_accvgpr_write_b32 a247,v83
v_accvgpr_write_b32 a252,v84
v_accvgpr_write_b32 a253,v85
v_accvgpr_write_b32 a254,v86
v_accvgpr_write_b32 a255,v87
s_xor_b32 s56,s63,1572864
s_add_u32 s56,s56,s58
buffer_load_dword v32,v4,s[4:7],s56 offen
s_add_u32 s56,s56,8192
buffer_load_dword v33,v4,s[4:7],s56 offen
s_add_u32 s56,s56,8192
buffer_load_dword v34,v4,s[4:7],s56 offen
s_add_u32 s56,s56,8192
buffer_load_dword v35,v4,s[4:7],s56 offen
s_add_u32 s56,s56,8192
buffer_load_dword v36,v4,s[4:7],s56 offen
s_add_u32 s56,s56,8192
buffer_load_dword v37,v4,s[4:7],s56 offen
s_add_u32 s56,s56,8192
buffer_load_dword v38,v4,s[4:7],s56 offen
s_add_u32 s56,s56,8192
buffer_load_dword v39,v4,s[4:7],s56 offen
s_waitcnt vmcnt(48)
v_perm_b32 v128,v41,v40,s61
v_perm_b32 v129,v43,v42,s61
v_perm_b32 v130,v45,v44,s61
v_perm_b32 v131,v47,v46,s61
v_perm_b32 v136,v41,v40,s62
v_perm_b32 v137,v43,v42,s62
v_perm_b32 v138,v45,v44,s62
v_perm_b32 v139,v47,v46,s62
s_xor_b32 s56,s63,1835008
s_add_u32 s56,s56,s58
buffer_load_dword v40,v4,s[4:7],s56 offen
s_add_u32 s56,s56,8192
buffer_load_dword v41,v4,s[4:7],s56 offen
s_add_u32 s56,s56,8192
buffer_load_dword v42,v4,s[4:7],s56 offen
s_add_u32 s56,s56,8192
buffer_load_dword v43,v4,s[4:7],s56 offen
s_add_u32 s56,s56,8192
buffer_load_dword v44,v4,s[4:7],s56 offen
s_add_u32 s56,s56,8192
buffer_load_dword v45,v4,s[4:7],s56 offen
s_add_u32 s56,s56,8192
buffer_load_dword v46,v4,s[4:7],s56 offen
s_add_u32 s56,s56,8192
buffer_load_dword v47,v4,s[4:7],s56 offen
s_waitcnt vmcnt(48)
v_perm_b32 v132,v49,v48,s61
v_perm_b32 v133,v51,v50,s61
v_perm_b32 v134,v53,v52,s61
v_perm_b32 v135,v55,v54,s61
v_perm_b32 v140,v49,v48,s62
v_perm_b32 v141,v51,v50,s62
v_perm_b32 v142,v53,v52,s62
v_perm_b32 v143,v55,v54,s62
s_xor_b32 s56,s63,2097152
s_add_u32 s56,s56,s58
buffer_load_dword v48,v4,s[4:7],s56 offen
s_add_u32 s56,s56,8192
buffer_load_dword v49,v4,s[4:7],s56 offen
s_add_u32 s56,s56,8192
buffer_load_dword v50,v4,s[4:7],s56 offen
s_add_u32 s56,s56,8192
buffer_load_dword v51,v4,s[4:7],s56 offen
s_add_u32 s56,s56,8192
buffer_load_dword v52,v4,s[4:7],s56 offen
s_add_u32 s56,s56,8192
buffer_load_dword v53,v4,s[4:7],s56 offen
s_add_u32 s56,s56,8192
buffer_load_dword v54,v4,s[4:7],s56 offen
s_add_u32 s56,s56,8192
buffer_load_dword v55,v4,s[4:7],s56 offen
s_waitcnt vmcnt(48)
v_perm_b32 v144,v57,v56,s61
v_perm_b32 v145,v59,v58,s61
v_perm_b32 v146,v61,v60,s61
v_perm_b32 v147,v63,v62,s61
v_perm_b32 v152,v57,v56,s62
v_perm_b32 v153,v59,v58,s62
v_perm_b32 v154,v61,v60,s62
v_perm_b32 v155,v63,v62,s62
s_xor_b32 s56,s63,2359296
s_add_u32 s56,s56,s58
buffer_load_dword v56,v4,s[4:7],s56 offen
s_add_u32 s56,s56,8192
buffer_load_dword v57,v4,s[4:7],s56 offen
s_add_u32 s56,s56,8192
buffer_load_dword v58,v4,s[4:7],s56 offen
s_add_u32 s56,s56,8192
buffer_load_dword v59,v4,s[4:7],s56 offen
s_add_u32 s56,s56,8192
buffer_load_dword v60,v4,s[4:7],s56 offen
s_add_u32 s56,s56,8192
buffer_load_dword v61,v4,s[4:7],s56 offen
s_add_u32 s56,s56,8192
buffer_load_dword v62,v4,s[4:7],s56 offen
s_add_u32 s56,s56,8192
buffer_load_dword v63,v4,s[4:7],s56 offen
s_waitcnt vmcnt(48)
v_perm_b32 v148,v65,v64,s61
v_perm_b32 v149,v67,v66,s61
v_perm_b32 v150,v69,v68,s61
v_perm_b32 v151,v71,v70,s61
v_perm_b32 v156,v65,v64,s62
v_perm_b32 v157,v67,v66,s62
v_perm_b32 v158,v69,v68,s62
v_perm_b32 v159,v71,v70,s62
s_xor_b32 s56,s63,2621440
s_add_u32 s56,s56,s58
buffer_load_dword v64,v4,s[4:7],s56 offen
s_add_u32 s56,s56,8192
buffer_load_dword v65,v4,s[4:7],s56 offen
s_add_u32 s56,s56,8192
buffer_load_dword v66,v4,s[4:7],s56 offen
s_add_u32 s56,s56,8192
buffer_load_dword v67,v4,s[4:7],s56 offen
s_add_u32 s56,s56,8192
buffer_load_dword v68,v4,s[4:7],s56 offen
s_add_u32 s56,s56,8192
buffer_load_dword v69,v4,s[4:7],s56 offen
s_add_u32 s56,s56,8192
buffer_load_dword v70,v4,s[4:7],s56 offen
s_add_u32 s56,s56,8192
buffer_load_dword v71,v4,s[4:7],s56 offen
s_waitcnt vmcnt(48)
v_perm_b32 v160,v73,v72,s61
v_perm_b32 v161,v75,v74,s61
v_perm_b32 v162,v77,v76,s61
v_perm_b32 v163,v79,v78,s61
v_perm_b32 v168,v73,v72,s62
v_perm_b32 v169,v75,v74,s62
v_perm_b32 v170,v77,v76,s62
v_perm_b32 v171,v79,v78,s62
s_xor_b32 s56,s63,2883584
s_add_u32 s56,s56,s58
buffer_load_dword v72,v4,s[4:7],s56 offen
s_add_u32 s56,s56,8192
buffer_load_dword v73,v4,s[4:7],s56 offen
s_add_u32 s56,s56,8192
buffer_load_dword v74,v4,s[4:7],s56 offen
s_add_u32 s56,s56,8192
buffer_load_dword v75,v4,s[4:7],s56 offen
s_add_u32 s56,s56,8192
buffer_load_dword v76,v4,s[4:7],s56 offen
s_add_u32 s56,s56,8192
buffer_load_dword v77,v4,s[4:7],s56 offen
s_add_u32 s56,s56,8192
buffer_load_dword v78,v4,s[4:7],s56 offen
s_add_u32 s56,s56,8192
buffer_load_dword v79,v4,s[4:7],s56 offen
s_waitcnt vmcnt(48)
v_perm_b32 v164,v25,v24,s61
v_perm_b32 v165,v27,v26,s61
v_perm_b32 v166,v29,v28,s61
v_perm_b32 v167,v31,v30,s61
v_perm_b32 v172,v25,v24,s62
v_perm_b32 v173,v27,v26,s62
v_perm_b32 v174,v29,v28,s62
v_perm_b32 v175,v31,v30,s62
s_xor_b32 s56,s63,3145728
s_add_u32 s56,s56,s58
buffer_load_dword v24,v4,s[4:7],s56 offen
s_add_u32 s56,s56,8192
buffer_load_dword v25,v4,s[4:7],s56 offen
s_add_u32 s56,s56,8192
buffer_load_dword v26,v4,s[4:7],s56 offen
s_add_u32 s56,s56,8192
buffer_load_dword v27,v4,s[4:7],s56 offen
s_add_u32 s56,s56,8192
buffer_load_dword v28,v4,s[4:7],s56 offen
s_add_u32 s56,s56,8192
buffer_load_dword v29,v4,s[4:7],s56 offen
s_add_u32 s56,s56,8192
buffer_load_dword v30,v4,s[4:7],s56 offen
s_add_u32 s56,s56,8192
buffer_load_dword v31,v4,s[4:7],s56 offen
s_waitcnt vmcnt(48)
v_perm_b32 v176,v33,v32,s61
v_perm_b32 v177,v35,v34,s61
v_perm_b32 v178,v37,v36,s61
v_perm_b32 v179,v39,v38,s61
v_perm_b32 v184,v33,v32,s62
v_perm_b32 v185,v35,v34,s62
v_perm_b32 v186,v37,v36,s62
v_perm_b32 v187,v39,v38,s62
s_xor_b32 s56,s63,3407872
s_add_u32 s56,s56,s58
buffer_load_dword v32,v4,s[4:7],s56 offen
s_add_u32 s56,s56,8192
buffer_load_dword v33,v4,s[4:7],s56 offen
s_add_u32 s56,s56,8192
buffer_load_dword v34,v4,s[4:7],s56 offen
s_add_u32 s56,s56,8192
buffer_load_dword v35,v4,s[4:7],s56 offen
s_add_u32 s56,s56,8192
buffer_load_dword v36,v4,s[4:7],s56 offen
s_add_u32 s56,s56,8192
buffer_load_dword v37,v4,s[4:7],s56 offen
s_add_u32 s56,s56,8192
buffer_load_dword v38,v4,s[4:7],s56 offen
s_add_u32 s56,s56,8192
buffer_load_dword v39,v4,s[4:7],s56 offen
s_waitcnt vmcnt(48)
v_perm_b32 v180,v41,v40,s61
v_perm_b32 v181,v43,v42,s61
v_perm_b32 v182,v45,v44,s61
v_perm_b32 v183,v47,v46,s61
v_perm_b32 v188,v41,v40,s62
v_perm_b32 v189,v43,v42,s62
v_perm_b32 v190,v45,v44,s62
v_perm_b32 v191,v47,v46,s62
s_xor_b32 s56,s63,3670016
s_add_u32 s56,s56,s58
buffer_load_dword v40,v4,s[4:7],s56 offen
s_add_u32 s56,s56,8192
buffer_load_dword v41,v4,s[4:7],s56 offen
s_add_u32 s56,s56,8192
buffer_load_dword v42,v4,s[4:7],s56 offen
s_add_u32 s56,s56,8192
buffer_load_dword v43,v4,s[4:7],s56 offen
s_add_u32 s56,s56,8192
buffer_load_dword v44,v4,s[4:7],s56 offen
s_add_u32 s56,s56,8192
buffer_load_dword v45,v4,s[4:7],s56 offen
s_add_u32 s56,s56,8192
buffer_load_dword v46,v4,s[4:7],s56 offen
s_add_u32 s56,s56,8192
buffer_load_dword v47,v4,s[4:7],s56 offen
s_waitcnt vmcnt(48)
v_perm_b32 v192,v49,v48,s61
v_perm_b32 v193,v51,v50,s61
v_perm_b32 v194,v53,v52,s61
v_perm_b32 v195,v55,v54,s61
v_perm_b32 v200,v49,v48,s62
v_perm_b32 v201,v51,v50,s62
v_perm_b32 v202,v53,v52,s62
v_perm_b32 v203,v55,v54,s62
s_xor_b32 s56,s63,3932160
s_add_u32 s56,s56,s58
buffer_load_dword v48,v4,s[4:7],s56 offen
s_add_u32 s56,s56,8192
buffer_load_dword v49,v4,s[4:7],s56 offen
s_add_u32 s56,s56,8192
buffer_load_dword v50,v4,s[4:7],s56 offen
s_add_u32 s56,s56,8192
buffer_load_dword v51,v4,s[4:7],s56 offen
s_add_u32 s56,s56,8192
buffer_load_dword v52,v4,s[4:7],s56 offen
s_add_u32 s56,s56,8192
buffer_load_dword v53,v4,s[4:7],s56 offen
s_add_u32 s56,s56,8192
buffer_load_dword v54,v4,s[4:7],s56 offen
s_add_u32 s56,s56,8192
buffer_load_dword v55,v4,s[4:7],s56 offen
s_waitcnt vmcnt(48)
v_perm_b32 v196,v57,v56,s61
v_perm_b32 v197,v59,v58,s61
v_perm_b32 v198,v61,v60,s61
v_perm_b32 v199,v63,v62,s61
v_perm_b32 v204,v57,v56,s62
v_perm_b32 v205,v59,v58,s62
v_perm_b32 v206,v61,v60,s62
v_perm_b32 v207,v63,v62,s62
s_mov_b32 s4,s20
s_mov_b32 s5,s21
s_mov_b32 s6,4194304
s_mov_b32 s7,0x20000
s_xor_b32 s56,s63,0
s_add_u32 s56,s56,s58
buffer_load_dword v56,v4,s[4:7],s56 offen
s_add_u32 s56,s56,8192
buffer_load_dword v57,v4,s[4:7],s56 offen
s_add_u32 s56,s56,8192
buffer_load_dword v58,v4,s[4:7],s56 offen
s_add_u32 s56,s56,8192
buffer_load_dword v59,v4,s[4:7],s56 offen
s_add_u32 s56,s56,8192
buffer_load_dword v60,v4,s[4:7],s56 offen
s_add_u32 s56,s56,8192
buffer_load_dword v61,v4,s[4:7],s56 offen
s_add_u32 s56,s56,8192
buffer_load_dword v62,v4,s[4:7],s56 offen
s_add_u32 s56,s56,8192
buffer_load_dword v63,v4,s[4:7],s56 offen
s_waitcnt vmcnt(48)
v_perm_b32 v208,v65,v64,s61
v_perm_b32 v209,v67,v66,s61
v_perm_b32 v210,v69,v68,s61
v_perm_b32 v211,v71,v70,s61
v_perm_b32 v216,v65,v64,s62
v_perm_b32 v217,v67,v66,s62
v_perm_b32 v218,v69,v68,s62
v_perm_b32 v219,v71,v70,s62
s_xor_b32 s56,s63,262144
s_add_u32 s56,s56,s58
buffer_load_dword v64,v4,s[4:7],s56 offen
s_add_u32 s56,s56,8192
buffer_load_dword v65,v4,s[4:7],s56 offen
s_add_u32 s56,s56,8192
buffer_load_dword v66,v4,s[4:7],s56 offen
s_add_u32 s56,s56,8192
buffer_load_dword v67,v4,s[4:7],s56 offen
s_add_u32 s56,s56,8192
buffer_load_dword v68,v4,s[4:7],s56 offen
s_add_u32 s56,s56,8192
buffer_load_dword v69,v4,s[4:7],s56 offen
s_add_u32 s56,s56,8192
buffer_load_dword v70,v4,s[4:7],s56 offen
s_add_u32 s56,s56,8192
buffer_load_dword v71,v4,s[4:7],s56 offen
s_waitcnt vmcnt(48)
v_perm_b32 v212,v73,v72,s61
v_perm_b32 v213,v75,v74,s61
v_perm_b32 v214,v77,v76,s61
v_perm_b32 v215,v79,v78,s61
v_perm_b32 v220,v73,v72,s62
v_perm_b32 v221,v75,v74,s62
v_perm_b32 v222,v77,v76,s62
v_perm_b32 v223,v79,v78,s62
s_xor_b32 s56,s63,524288
s_add_u32 s56,s56,s58
buffer_load_dword v72,v4,s[4:7],s56 offen
s_add_u32 s56,s56,8192
buffer_load_dword v73,v4,s[4:7],s56 offen
s_add_u32 s56,s56,8192
buffer_load_dword v74,v4,s[4:7],s56 offen
s_add_u32 s56,s56,8192
buffer_load_dword v75,v4,s[4:7],s56 offen
s_add_u32 s56,s56,8192
buffer_load_dword v76,v4,s[4:7],s56 offen
s_add_u32 s56,s56,8192
buffer_load_dword v77,v4,s[4:7],s56 offen
s_add_u32 s56,s56,8192
buffer_load_dword v78,v4,s[4:7],s56 offen
s_add_u32 s56,s56,8192
buffer_load_dword v79,v4,s[4:7],s56 offen
s_waitcnt vmcnt(48)
v_perm_b32 v224,v25,v24,s61
v_perm_b32 v225,v27,v26,s61
v_perm_b32 v226,v29,v28,s61
v_perm_b32 v227,v31,v30,s61
v_perm_b32 v232,v25,v24,s62
v_perm_b32 v233,v27,v26,s62
v_perm_b32 v234,v29,v28,s62
v_perm_b32 v235,v31,v30,s62
s_xor_b32 s56,s63,786432
s_add_u32 s56,s56,s58
buffer_load_dword v24,v4,s[4:7],s56 offen
s_add_u32 s56,s56,8192
buffer_load_dword v25,v4,s[4:7],s56 offen
s_add_u32 s56,s56,8192
buffer_load_dword v26,v4,s[4:7],s56 offen
s_add_u32 s56,s56,8192
buffer_load_dword v27,v4,s[4:7],s56 offen
s_add_u32 s56,s56,8192
buffer_load_dword v28,v4,s[4:7],s56 offen
s_add_u32 s56,s56,8192
buffer_load_dword v29,v4,s[4:7],s56 offen
s_add_u32 s56,s56,8192
buffer_load_dword v30,v4,s[4:7],s56 offen
s_add_u32 s56,s56,8192
buffer_load_dword v31,v4,s[4:7],s56 offen
s_waitcnt vmcnt(48)
v_perm_b32 v228,v33,v32,s61
v_perm_b32 v229,v35,v34,s61
v_perm_b32 v230,v37,v36,s61
v_perm_b32 v231,v39,v38,s61
v_perm_b32 v236,v33,v32,s62
v_perm_b32 v237,v35,v34,s62
v_perm_b32 v238,v37,v36,s62
v_perm_b32 v239,v39,v38,s62
s_xor_b32 s56,s63,1048576
s_add_u32 s56,s56,s58
buffer_load_dword v32,v4,s[4:7],s56 offen
s_add_u32 s56,s56,8192
buffer_load_dword v33,v4,s[4:7],s56 offen
s_add_u32 s56,s56,8192
buffer_load_dword v34,v4,s[4:7],s56 offen
s_add_u32 s56,s56,8192
buffer_load_dword v35,v4,s[4:7],s56 offen
s_add_u32 s56,s56,8192
buffer_load_dword v36,v4,s[4:7],s56 offen
s_add_u32 s56,s56,8192
buffer_load_dword v37,v4,s[4:7],s56 offen
s_add_u32 s56,s56,8192
buffer_load_dword v38,v4,s[4:7],s56 offen
s_add_u32 s56,s56,8192
buffer_load_dword v39,v4,s[4:7],s56 offen
s_waitcnt vmcnt(48)
v_perm_b32 v240,v41,v40,s61
v_perm_b32 v241,v43,v42,s61
v_perm_b32 v242,v45,v44,s61
v_perm_b32 v243,v47,v46,s61
v_perm_b32 v248,v41,v40,s62
v_perm_b32 v249,v43,v42,s62
v_perm_b32 v250,v45,v44,s62
v_perm_b32 v251,v47,v46,s62
s_xor_b32 s56,s63,1310720
s_add_u32 s56,s56,s58
buffer_load_dword v40,v4,s[4:7],s56 offen
s_add_u32 s56,s56,8192
buffer_load_dword v41,v4,s[4:7],s56 offen
s_add_u32 s56,s56,8192
buffer_load_dword v42,v4,s[4:7],s56 offen
s_add_u32 s56,s56,8192
buffer_load_dword v43,v4,s[4:7],s56 offen
s_add_u32 s56,s56,8192
buffer_load_dword v44,v4,s[4:7],s56 offen
s_add_u32 s56,s56,8192
buffer_load_dword v45,v4,s[4:7],s56 offen
s_add_u32 s56,s56,8192
buffer_load_dword v46,v4,s[4:7],s56 offen
s_add_u32 s56,s56,8192
buffer_load_dword v47,v4,s[4:7],s56 offen
s_waitcnt vmcnt(48)
v_perm_b32 v244,v49,v48,s61
v_perm_b32 v245,v51,v50,s61
v_perm_b32 v246,v53,v52,s61
v_perm_b32 v247,v55,v54,s61
v_perm_b32 v252,v49,v48,s62
v_perm_b32 v253,v51,v50,s62
v_perm_b32 v254,v53,v52,s62
v_perm_b32 v255,v55,v54,s62
s_xor_b32 s56,s63,1572864
s_add_u32 s56,s56,s58
buffer_load_dword v48,v4,s[4:7],s56 offen
s_add_u32 s56,s56,8192
buffer_load_dword v49,v4,s[4:7],s56 offen
s_add_u32 s56,s56,8192
buffer_load_dword v50,v4,s[4:7],s56 offen
s_add_u32 s56,s56,8192
buffer_load_dword v51,v4,s[4:7],s56 offen
s_add_u32 s56,s56,8192
buffer_load_dword v52,v4,s[4:7],s56 offen
s_add_u32 s56,s56,8192
buffer_load_dword v53,v4,s[4:7],s56 offen
s_add_u32 s56,s56,8192
buffer_load_dword v54,v4,s[4:7],s56 offen
s_add_u32 s56,s56,8192
buffer_load_dword v55,v4,s[4:7],s56 offen
s_waitcnt vmcnt(48)
v_perm_b32 v80,v57,v56,s61
v_perm_b32 v81,v59,v58,s61
v_perm_b32 v82,v61,v60,s61
v_perm_b32 v83,v63,v62,s61
v_perm_b32 v84,v57,v56,s62
v_perm_b32 v85,v59,v58,s62
v_perm_b32 v86,v61,v60,s62
v_perm_b32 v87,v63,v62,s62
v_accvgpr_write_b32 a0,v80
v_accvgpr_write_b32 a1,v81
v_accvgpr_write_b32 a2,v82
v_accvgpr_write_b32 a3,v83
v_accvgpr_write_b32 a8,v84
v_accvgpr_write_b32 a9,v85
v_accvgpr_write_b32 a10,v86
v_accvgpr_write_b32 a11,v87
s_xor_b32 s56,s63,1835008
s_add_u32 s56,s56,s58
buffer_load_dword v56,v4,s[4:7],s56 offen
s_add_u32 s56,s56,8192
buffer_load_dword v57,v4,s[4:7],s56 offen
s_add_u32 s56,s56,8192
buffer_load_dword v58,v4,s[4:7],s56 offen
s_add_u32 s56,s56,8192
buffer_load_dword v59,v4,s[4:7],s56 offen
s_add_u32 s56,s56,8192
buffer_load_dword v60,v4,s[4:7],s56 offen
s_add_u32 s56,s56,8192
buffer_load_dword v61,v4,s[4:7],s56 offen
s_add_u32 s56,s56,8192
buffer_load_dword v62,v4,s[4:7],s56 offen
s_add_u32 s56,s56,8192
buffer_load_dword v63,v4,s[4:7],s56 offen
s_waitcnt vmcnt(48)
v_perm_b32 v80,v65,v64,s61
v_perm_b32 v81,v67,v66,s61
v_perm_b32 v82,v69,v68,s61
v_perm_b32 v83,v71,v70,s61
v_perm_b32 v84,v65,v64,s62
v_perm_b32 v85,v67,v66,s62
v_perm_b32 v86,v69,v68,s62
v_perm_b32 v87,v71,v70,s62
v_accvgpr_write_b32 a4,v80
v_accvgpr_write_b32 a5,v81
v_accvgpr_write_b32 a6,v82
v_accvgpr_write_b32 a7,v83
v_accvgpr_write_b32 a12,v84
v_accvgpr_write_b32 a13,v85
v_accvgpr_write_b32 a14,v86
v_accvgpr_write_b32 a15,v87
s_xor_b32 s56,s63,2097152
s_add_u32 s56,s56,s58
buffer_load_dword v64,v4,s[4:7],s56 offen
s_add_u32 s56,s56,8192
buffer_load_dword v65,v4,s[4:7],s56 offen
s_add_u32 s56,s56,8192
buffer_load_dword v66,v4,s[4:7],s56 offen
s_add_u32 s56,s56,8192
buffer_load_dword v67,v4,s[4:7],s56 offen
s_add_u32 s56,s56,8192
buffer_load_dword v68,v4,s[4:7],s56 offen
s_add_u32 s56,s56,8192
buffer_load_dword v69,v4,s[4:7],s56 offen
s_add_u32 s56,s56,8192
buffer_load_dword v70,v4,s[4:7],s56 offen
s_add_u32 s56,s56,8192
buffer_load_dword v71,v4,s[4:7],s56 offen
s_waitcnt vmcnt(48)
v_perm_b32 v80,v73,v72,s61
v_perm_b32 v81,v75,v74,s61
v_perm_b32 v82,v77,v76,s61
v_perm_b32 v83,v79,v78,s61
v_perm_b32 v84,v73,v72,s62
v_perm_b32 v85,v75,v74,s62
v_perm_b32 v86,v77,v76,s62
v_perm_b32 v87,v79,v78,s62
v_accvgpr_write_b32 a16,v80
v_accvgpr_write_b32 a17,v81
v_accvgpr_write_b32 a18,v82
v_accvgpr_write_b32 a19,v83
v_accvgpr_write_b32 a24,v84
v_accvgpr_write_b32 a25,v85
v_accvgpr_write_b32 a26,v86
v_accvgpr_write_b32 a27,v87
s_xor_b32 s56,s63,2359296
s_add_u32 s56,s56,s58
buffer_load_dword v72,v4,s[4:7],s56 offen
s_add_u32 s56,s56,8192
buffer_load_dword v73,v4,s[4:7],s56 offen
s_add_u32 s56,s56,8192
buffer_load_dword v74,v4,s[4:7],s56 offen
s_add_u32 s56,s56,8192
buffer_load_dword v75,v4,s[4:7],s56 offen
s_add_u32 s56,s56,8192
buffer_load_dword v76,v4,s[4:7],s56 offen
s_add_u32 s56,s56,8192
buffer_load_dword v77,v4,s[4:7],s56 offen
s_add_u32 s56,s56,8192
buffer_load_dword v78,v4,s[4:7],s56 offen
s_add_u32 s56,s56,8192
buffer_load_dword v79,v4,s[4:7],s56 offen
s_waitcnt vmcnt(48)
v_perm_b32 v80,v25,v24,s61
v_perm_b32 v81,v27,v26,s61
v_perm_b32 v82,v29,v28,s61
v_perm_b32 v83,v31,v30,s61
v_perm_b32 v84,v25,v24,s62
v_perm_b32 v85,v27,v26,s62
v_perm_b32 v86,v29,v28,s62
v_perm_b32 v87,v31,v30,s62
v_accvgpr_write_b32 a20,v80
v_accvgpr_write_b32 a21,v81
v_accvgpr_write_b32 a22,v82
v_accvgpr_write_b32 a23,v83
v_accvgpr_write_b32 a28,v84
v_accvgpr_write_b32 a29,v85
v_accvgpr_write_b32 a30,v86
v_accvgpr_write_b32 a31,v87
s_xor_b32 s56,s63,2621440
s_add_u32 s56,s56,s58
buffer_load_dword v24,v4,s[4:7],s56 offen
s_add_u32 s56,s56,8192
buffer_load_dword v25,v4,s[4:7],s56 offen
s_add_u32 s56,s56,8192
buffer_load_dword v26,v4,s[4:7],s56 offen
s_add_u32 s56,s56,8192
buffer_load_dword v27,v4,s[4:7],s56 offen
s_add_u32 s56,s56,8192
buffer_load_dword v28,v4,s[4:7],s56 offen
s_add_u32 s56,s56,8192
buffer_load_dword v29,v4,s[4:7],s56 offen
s_add_u32 s56,s56,8192
buffer_load_dword v30,v4,s[4:7],s56 offen
s_add_u32 s56,s56,8192
buffer_load_dword v31,v4,s[4:7],s56 offen
s_waitcnt vmcnt(48)
v_perm_b32 v80,v33,v32,s61
v_perm_b32 v81,v35,v34,s61
v_perm_b32 v82,v37,v36,s61
v_perm_b32 v83,v39,v38,s61
v_perm_b32 v84,v33,v32,s62
v_perm_b32 v85,v35,v34,s62
v_perm_b32 v86,v37,v36,s62
v_perm_b32 v87,v39,v38,s62
v_accvgpr_write_b32 a32,v80
v_accvgpr_write_b32 a33,v81
v_accvgpr_write_b32 a34,v82
v_accvgpr_write_b32 a35,v83
v_accvgpr_write_b32 a40,v84
v_accvgpr_write_b32 a41,v85
v_accvgpr_write_b32 a42,v86
v_accvgpr_write_b32 a43,v87
s_xor_b32 s56,s63,2883584
s_add_u32 s56,s56,s58
buffer_load_dword v32,v4,s[4:7],s56 offen
s_add_u32 s56,s56,8192
buffer_load_dword v33,v4,s[4:7],s56 offen
s_add_u32 s56,s56,8192
buffer_load_dword v34,v4,s[4:7],s56 offen
s_add_u32 s56,s56,8192
buffer_load_dword v35,v4,s[4:7],s56 offen
s_add_u32 s56,s56,8192
buffer_load_dword v36,v4,s[4:7],s56 offen
s_add_u32 s56,s56,8192
buffer_load_dword v37,v4,s[4:7],s56 offen
s_add_u32 s56,s56,8192
buffer_load_dword v38,v4,s[4:7],s56 offen
s_add_u32 s56,s56,8192
buffer_load_dword v39,v4,s[4:7],s56 offen
s_waitcnt vmcnt(48)
v_perm_b32 v80,v41,v40,s61
v_perm_b32 v81,v43,v42,s61
v_perm_b32 v82,v45,v44,s61
v_perm_b32 v83,v47,v46,s61
v_perm_b32 v84,v41,v40,s62
v_perm_b32 v85,v43,v42,s62
v_perm_b32 v86,v45,v44,s62
v_perm_b32 v87,v47,v46,s62
v_accvgpr_write_b32 a36,v80
v_accvgpr_write_b32 a37,v81
v_accvgpr_write_b32 a38,v82
v_accvgpr_write_b32 a39,v83
v_accvgpr_write_b32 a44,v84
v_accvgpr_write_b32 a45,v85
v_accvgpr_write_b32 a46,v86
v_accvgpr_write_b32 a47,v87
s_xor_b32 s56,s63,3145728
s_add_u32 s56,s56,s58
buffer_load_dword v40,v4,s[4:7],s56 offen
s_add_u32 s56,s56,8192
buffer_load_dword v41,v4,s[4:7],s56 offen
s_add_u32 s56,s56,8192
buffer_load_dword v42,v4,s[4:7],s56 offen
s_add_u32 s56,s56,8192
buffer_load_dword v43,v4,s[4:7],s56 offen
s_add_u32 s56,s56,8192
buffer_load_dword v44,v4,s[4:7],s56 offen
s_add_u32 s56,s56,8192
buffer_load_dword v45,v4,s[4:7],s56 offen
s_add_u32 s56,s56,8192
buffer_load_dword v46,v4,s[4:7],s56 offen
s_add_u32 s56,s56,8192
buffer_load_dword v47,v4,s[4:7],s56 offen
s_waitcnt vmcnt(48)
v_perm_b32 v80,v49,v48,s61
v_perm_b32 v81,v51,v50,s61
v_perm_b32 v82,v53,v52,s61
v_perm_b32 v83,v55,v54,s61
v_perm_b32 v84,v49,v48,s62
v_perm_b32 v85,v51,v50,s62
v_perm_b32 v86,v53,v52,s62
v_perm_b32 v87,v55,v54,s62
v_accvgpr_write_b32 a48,v80
v_accvgpr_write_b32 a49,v81
v_accvgpr_write_b32 a50,v82
v_accvgpr_write_b32 a51,v83
v_accvgpr_write_b32 a56,v84
v_accvgpr_write_b32 a57,v85
v_accvgpr_write_b32 a58,v86
v_accvgpr_write_b32 a59,v87
s_xor_b32 s56,s63,3407872
s_add_u32 s56,s56,s58
buffer_load_dword v48,v4,s[4:7],s56 offen
s_add_u32 s56,s56,8192
buffer_load_dword v49,v4,s[4:7],s56 offen
s_add_u32 s56,s56,8192
buffer_load_dword v50,v4,s[4:7],s56 offen
s_add_u32 s56,s56,8192
buffer_load_dword v51,v4,s[4:7],s56 offen
s_add_u32 s56,s56,8192
buffer_load_dword v52,v4,s[4:7],s56 offen
s_add_u32 s56,s56,8192
buffer_load_dword v53,v4,s[4:7],s56 offen
s_add_u32 s56,s56,8192
buffer_load_dword v54,v4,s[4:7],s56 offen
s_add_u32 s56,s56,8192
buffer_load_dword v55,v4,s[4:7],s56 offen
s_waitcnt vmcnt(48)
v_perm_b32 v80,v57,v56,s61
v_perm_b32 v81,v59,v58,s61
v_perm_b32 v82,v61,v60,s61
v_perm_b32 v83,v63,v62,s61
v_perm_b32 v84,v57,v56,s62
v_perm_b32 v85,v59,v58,s62
v_perm_b32 v86,v61,v60,s62
v_perm_b32 v87,v63,v62,s62
v_accvgpr_write_b32 a52,v80
v_accvgpr_write_b32 a53,v81
v_accvgpr_write_b32 a54,v82
v_accvgpr_write_b32 a55,v83
v_accvgpr_write_b32 a60,v84
v_accvgpr_write_b32 a61,v85
v_accvgpr_write_b32 a62,v86
v_accvgpr_write_b32 a63,v87
s_xor_b32 s56,s63,3670016
s_add_u32 s56,s56,s58
buffer_load_dword v56,v4,s[4:7],s56 offen
s_add_u32 s56,s56,8192
buffer_load_dword v57,v4,s[4:7],s56 offen
s_add_u32 s56,s56,8192
buffer_load_dword v58,v4,s[4:7],s56 offen
s_add_u32 s56,s56,8192
buffer_load_dword v59,v4,s[4:7],s56 offen
s_add_u32 s56,s56,8192
buffer_load_dword v60,v4,s[4:7],s56 offen
s_add_u32 s56,s56,8192
buffer_load_dword v61,v4,s[4:7],s56 offen
s_add_u32 s56,s56,8192
buffer_load_dword v62,v4,s[4:7],s56 offen
s_add_u32 s56,s56,8192
buffer_load_dword v63,v4,s[4:7],s56 offen
s_waitcnt vmcnt(48)
v_perm_b32 v80,v65,v64,s61
v_perm_b32 v81,v67,v66,s61
v_perm_b32 v82,v69,v68,s61
v_perm_b32 v83,v71,v70,s61
v_perm_b32 v84,v65,v64,s62
v_perm_b32 v85,v67,v66,s62
v_perm_b32 v86,v69,v68,s62
v_perm_b32 v87,v71,v70,s62
v_accvgpr_write_b32 a64,v80
v_accvgpr_write_b32 a65,v81
v_accvgpr_write_b32 a66,v82
v_accvgpr_write_b32 a67,v83
v_accvgpr_write_b32 a72,v84
v_accvgpr_write_b32 a73,v85
v_accvgpr_write_b32 a74,v86
v_accvgpr_write_b32 a75,v87
s_xor_b32 s56,s63,3932160
s_add_u32 s56,s56,s58
buffer_load_dword v64,v4,s[4:7],s56 offen
s_add_u32 s56,s56,8192
buffer_load_dword v65,v4,s[4:7],s56 offen
s_add_u32 s56,s56,8192
buffer_load_dword v66,v4,s[4:7],s56 offen
s_add_u32 s56,s56,8192
buffer_load_dword v67,v4,s[4:7],s56 offen
s_add_u32 s56,s56,8192
buffer_load_dword v68,v4,s[4:7],s56 offen
s_add_u32 s56,s56,8192
buffer_load_dword v69,v4,s[4:7],s56 offen
s_add_u32 s56,s56,8192
buffer_load_dword v70,v4,s[4:7],s56 offen
s_add_u32 s56,s56,8192
buffer_load_dword v71,v4,s[4:7],s56 offen
s_waitcnt vmcnt(48)
v_perm_b32 v80,v73,v72,s61
v_perm_b32 v81,v75,v74,s61
v_perm_b32 v82,v77,v76,s61
v_perm_b32 v83,v79,v78,s61
v_perm_b32 v84,v73,v72,s62
v_perm_b32 v85,v75,v74,s62
v_perm_b32 v86,v77,v76,s62
v_perm_b32 v87,v79,v78,s62
v_accvgpr_write_b32 a68,v80
v_accvgpr_write_b32 a69,v81
v_accvgpr_write_b32 a70,v82
v_accvgpr_write_b32 a71,v83
v_accvgpr_write_b32 a76,v84
v_accvgpr_write_b32 a77,v85
v_accvgpr_write_b32 a78,v86
v_accvgpr_write_b32 a79,v87
s_waitcnt vmcnt(40)
v_perm_b32 v80,v25,v24,s61
v_perm_b32 v81,v27,v26,s61
v_perm_b32 v82,v29,v28,s61
v_perm_b32 v83,v31,v30,s61
v_perm_b32 v84,v25,v24,s62
v_perm_b32 v85,v27,v26,s62
v_perm_b32 v86,v29,v28,s62
v_perm_b32 v87,v31,v30,s62
v_accvgpr_write_b32 a80,v80
v_accvgpr_write_b32 a81,v81
v_accvgpr_write_b32 a82,v82
v_accvgpr_write_b32 a83,v83
v_accvgpr_write_b32 a88,v84
v_accvgpr_write_b32 a89,v85
v_accvgpr_write_b32 a90,v86
v_accvgpr_write_b32 a91,v87
s_waitcnt vmcnt(32)
v_perm_b32 v80,v33,v32,s61
v_perm_b32 v81,v35,v34,s61
v_perm_b32 v82,v37,v36,s61
v_perm_b32 v83,v39,v38,s61
v_perm_b32 v84,v33,v32,s62
v_perm_b32 v85,v35,v34,s62
v_perm_b32 v86,v37,v36,s62
v_perm_b32 v87,v39,v38,s62
v_accvgpr_write_b32 a84,v80
v_accvgpr_write_b32 a85,v81
v_accvgpr_write_b32 a86,v82
v_accvgpr_write_b32 a87,v83
v_accvgpr_write_b32 a92,v84
v_accvgpr_write_b32 a93,v85
v_accvgpr_write_b32 a94,v86
v_accvgpr_write_b32 a95,v87
s_waitcnt vmcnt(24)
v_perm_b32 v80,v41,v40,s61
v_perm_b32 v81,v43,v42,s61
v_perm_b32 v82,v45,v44,s61
v_perm_b32 v83,v47,v46,s61
v_perm_b32 v84,v41,v40,s62
v_perm_b32 v85,v43,v42,s62
v_perm_b32 v86,v45,v44,s62
v_perm_b32 v87,v47,v46,s62
v_accvgpr_write_b32 a96,v80
v_accvgpr_write_b32 a97,v81
v_accvgpr_write_b32 a98,v82
v_accvgpr_write_b32 a99,v83
v_accvgpr_write_b32 a104,v84
v_accvgpr_write_b32 a105,v85
v_accvgpr_write_b32 a106,v86
v_accvgpr_write_b32 a107,v87
s_waitcnt vmcnt(16)
v_perm_b32 v80,v49,v48,s61
v_perm_b32 v81,v51,v50,s61
v_perm_b32 v82,v53,v52,s61
v_perm_b32 v83,v55,v54,s61
v_perm_b32 v84,v49,v48,s62
v_perm_b32 v85,v51,v50,s62
v_perm_b32 v86,v53,v52,s62
v_perm_b32 v87,v55,v54,s62
v_accvgpr_write_b32 a100,v80
v_accvgpr_write_b32 a101,v81
v_accvgpr_write_b32 a102,v82
v_accvgpr_write_b32 a103,v83
v_accvgpr_write_b32 a108,v84
v_accvgpr_write_b32 a109,v85
v_accvgpr_write_b32 a110,v86
v_accvgpr_write_b32 a111,v87
s_waitcnt vmcnt(8)
v_perm_b32 v80,v57,v56,s61
v_perm_b32 v81,v59,v58,s61
v_perm_b32 v82,v61,v60,s61
v_perm_b32 v83,v63,v62,s61
v_perm_b32 v84,v57,v56,s62
v_perm_b32 v85,v59,v58,s62
v_perm_b32 v86,v61,v60,s62
v_perm_b32 v87,v63,v62,s62
v_accvgpr_write_b32 a112,v80
v_accvgpr_write_b32 a113,v81
v_accvgpr_write_b32 a114,v82
v_accvgpr_write_b32 a115,v83
v_accvgpr_write_b32 a120,v84
v_accvgpr_write_b32 a121,v85
v_accvgpr_write_b32 a122,v86
v_accvgpr_write_b32 a123,v87
s_waitcnt vmcnt(0)
v_perm_b32 v80,v65,v64,s61
v_perm_b32 v81,v67,v66,s61
v_perm_b32 v82,v69,v68,s61
v_perm_b32 v83,v71,v70,s61
v_perm_b32 v84,v65,v64,s62
v_perm_b32 v85,v67,v66,s62
v_perm_b32 v86,v69,v68,s62
v_perm_b32 v87,v71,v70,s62
v_accvgpr_write_b32 a116,v80
v_accvgpr_write_b32 a117,v81
v_accvgpr_write_b32 a118,v82
v_accvgpr_write_b32 a119,v83
v_accvgpr_write_b32 a124,v84
v_accvgpr_write_b32 a125,v85
v_accvgpr_write_b32 a126,v86
v_accvgpr_write_b32 a127,v87
s_cmp_lt_u32 s48,3
s_cbranch_scc1 L_rch_4
s_cmp_eq_u32 s48,3
s_cbranch_scc1 L_rm_5
v_mov_b32 v123,159744
s_cmp_lg_u32 s46,0
s_cbranch_scc1 L_gbd_11
v_mov_b32 v124,128
L_gb_10:
buffer_load_dword v125,v124,s[12:15],0 offen sc1
s_waitcnt vmcnt(0)
v_readfirstlane_b32 s56,v125
ds_write_b32 v123,v125
s_bitcmp1_b32 s56,8
s_cbranch_scc1 L_gbd_11
s_sleep 4
s_sub_u32 s49,s49,1
s_cmp_gt_i32 s49,0
s_cbranch_scc1 L_gb_10
s_branch L_abort
L_gbd_11:
s_waitcnt lgkmcnt(0)
s_barrier
ds_read_b32 v125,v123
s_waitcnt lgkmcnt(0)
v_readfirstlane_b32 s56,v125
s_barrier
s_lshr_b32 s56,s56,16
s_andn2_b32 s56,s56,s3
s_cbranch_scc1 L_spread
v_and_b32 v120,15,v1
v_lshrrev_b32 v121,4,v1
v_mov_b32 v17,1
s_lshl_b32 s56,s46,15
v_add_u32 v18,s56,v0
s_lshl_b32 s56,s46,2
v_add_u32 v125,s56,v121
v_xor_b32 v126,v125,v120
v_lshlrev_b32 v126,4,v126
v_lshl_add_u32 v20,v125,10,v126
v_add_u32 v125,0,v121
v_xor_b32 v125,v125,v120
v_lshlrev_b32 v125,4,v125
v_lshl_add_u32 v125,v120,8,v125
v_add_u32 v4,65536,v125
v_add_u32 v125,4,v121
v_xor_b32 v125,v125,v120
v_lshlrev_b32 v125,4,v125
v_lshl_add_u32 v125,v120,8,v125
v_add_u32 v5,65536,v125
v_add_u32 v125,8,v121
v_xor_b32 v125,v125,v120
v_lshlrev_b32 v125,4,v125
v_lshl_add_u32 v125,v120,8,v125
v_add_u32 v6,65536,v125
v_add_u32 v125,12,v121
v_xor_b32 v125,v125,v120
v_lshlrev_b32 v125,4,v125
v_lshl_add_u32 v125,v120,8,v125
v_add_u32 v7,65536,v125
v_lshlrev_b32 v21,5,v120
v_and_b32 v125,1,v121
v_lshl_add_u32 v21,v125,4,v21
s_lshl_b32 s56,s46,9
v_lshrrev_b32 v125,1,v121
v_lshl_add_u32 v21,v125,11,v21
s_add_u32 s56,s56,155648
v_add_u32 v21,s56,v21
v_lshlrev_b32 v22,4,v120
v_lshl_add_u32 v22,v121,10,v22
s_lshl_b32 s56,s46,8
v_add_u32 v22,s56,v22
s_sub_u32 s54,s48,4
s_cmp_eq_u32 s54,0
s_mov_b32 s72,2453668010
s_mov_b32 s73,613566756
s_cmov_b32 s72,1226834005
s_cmov_b32 s73,2454267026
s_mov_b32 s70,0x80000000
s_mov_b32 s53,2
s_ff1_i32_b64 s55,s[72:73]
s_bitset0_b64 s[72:73],s55
s_min_u32 s55,s55,127
s_lshl_b32 s68,s55,15
s_add_u32 s68,s68,0
s_add_u32 s69,s68,16384
s_add_u32 m0,s50,98304
s_nop 0
buffer_load_dwordx4 v20,s[8:11],s68 offen offset:0 sc1 lds
s_add_u32 m0,s50,102400
s_nop 0
buffer_load_dwordx4 v20,s[8:11],s69 offen offset:0 sc1 lds
s_add_u32 m0,s50,106240
s_nop 0
buffer_load_dwordx4 v20,s[8:11],s68 offen offset:256 sc1 lds
s_add_u32 m0,s50,110336
s_nop 0
buffer_load_dwordx4 v20,s[8:11],s69 offen offset:256 sc1 lds
s_add_u32 m0,s50,114176
s_nop 0
buffer_load_dwordx4 v20,s[8:11],s68 offen offset:512 sc1 lds
s_add_u32 m0,s50,118272
s_nop 0
buffer_load_dwordx4 v20,s[8:11],s69 offen offset:512 sc1 lds
s_add_u32 m0,s50,122112
s_nop 0
buffer_load_dwordx4 v20,s[8:11],s68 offen offset:768 sc1 lds
s_add_u32 m0,s50,126208
s_nop 0
buffer_load_dwordx4 v20,s[8:11],s69 offen offset:768 sc1 lds
s_waitcnt vmcnt(0)
s_barrier
L_pu_12:
s_mov_b32 s51,s55
s_ff1_i32_b64 s55,s[72:73]
s_bitset0_b64 s[72:73],s55
s_min_u32 s55,s55,127
s_lshl_b32 s68,s55,15
s_add_u32 s68,s68,0
s_add_u32 s69,s68,16384
s_lshl_b32 s58,s51,5
s_add_u32 s58,s58,s47
s_mul_i32 s58,s58,24576
s_add_u32 s58,s58,100663296
s_add_u32 s61,s58,s50
s_add_u32 s62,s61,4096
s_add_u32 s63,s61,16384
s_add_u32 s64,s61,20480
s_add_u32 s65,s61,s50
s_add_u32 s65,s65,8192
ds_read_b128 v[104:107],v4 offset:32768
ds_read_b128 v[108:111],v4 offset:36864
ds_read_b128 v[112:115],v5 offset:32768
ds_read_b128 v[116:119],v5 offset:36864
s_waitcnt lgkmcnt(2)
v_mfma_f32_16x16x32_bf16 v[24:27],a[128:131],v[104:107],0
ds_read_b128 v[120:123],v6 offset:32768
v_mfma_f32_16x16x32_bf16 v[40:43],v[104:107],v[128:131],0
v_mfma_f32_16x16x32_bf16 v[28:31],a[128:131],v[108:111],0
ds_read_b128 v[124:127],v6 offset:36864
v_mfma_f32_16x16x32_bf16 v[44:47],v[108:111],v[128:131],0
v_mfma_f32_16x16x32_bf16 v[32:35],a[136:139],v[104:107],0
v_mfma_f32_16x16x32_bf16 v[48:51],v[104:107],v[136:139],0
v_mfma_f32_16x16x32_bf16 v[36:39],a[136:139],v[108:111],0
v_mfma_f32_16x16x32_bf16 v[52:55],v[108:111],v[136:139],0
s_waitcnt lgkmcnt(2)
v_mfma_f32_16x16x32_bf16 v[24:27],a[132:135],v[112:115],v[24:27]
ds_read_b128 v[104:107],v7 offset:32768
v_mfma_f32_16x16x32_bf16 v[40:43],v[112:115],v[132:135],v[40:43]
v_mfma_f32_16x16x32_bf16 v[28:31],a[132:135],v[116:119],v[28:31]
ds_read_b128 v[108:111],v7 offset:36864
v_mfma_f32_16x16x32_bf16 v[44:47],v[116:119],v[132:135],v[44:47]
v_mfma_f32_16x16x32_bf16 v[32:35],a[140:143],v[112:115],v[32:35]
v_mfma_f32_16x16x32_bf16 v[48:51],v[112:115],v[140:143],v[48:51]
v_mfma_f32_16x16x32_bf16 v[36:39],a[140:143],v[116:119],v[36:39]
v_mfma_f32_16x16x32_bf16 v[52:55],v[116:119],v[140:143],v[52:55]
s_waitcnt lgkmcnt(2)
v_mfma_f32_16x16x32_bf16 v[24:27],a[144:147],v[120:123],v[24:27]
ds_read_b128 v[112:115],v4 offset:40960
v_mfma_f32_16x16x32_bf16 v[40:43],v[120:123],v[144:147],v[40:43]
v_mfma_f32_16x16x32_bf16 v[28:31],a[144:147],v[124:127],v[28:31]
ds_read_b128 v[116:119],v4 offset:45056
v_mfma_f32_16x16x32_bf16 v[44:47],v[124:127],v[144:147],v[44:47]
v_mfma_f32_16x16x32_bf16 v[32:35],a[152:155],v[120:123],v[32:35]
v_mfma_f32_16x16x32_bf16 v[48:51],v[120:123],v[152:155],v[48:51]
v_mfma_f32_16x16x32_bf16 v[36:39],a[152:155],v[124:127],v[36:39]
v_mfma_f32_16x16x32_bf16 v[52:55],v[124:127],v[152:155],v[52:55]
s_waitcnt lgkmcnt(2)
v_mfma_f32_16x16x32_bf16 v[24:27],a[148:151],v[104:107],v[24:27]
ds_read_b128 v[120:123],v5 offset:40960
v_mfma_f32_16x16x32_bf16 v[40:43],v[104:107],v[148:151],v[40:43]
v_mfma_f32_16x16x32_bf16 v[28:31],a[148:151],v[108:111],v[28:31]
ds_read_b128 v[124:127],v5 offset:45056
v_mfma_f32_16x16x32_bf16 v[44:47],v[108:111],v[148:151],v[44:47]
v_mfma_f32_16x16x32_bf16 v[32:35],a[156:159],v[104:107],v[32:35]
v_mfma_f32_16x16x32_bf16 v[48:51],v[104:107],v[156:159],v[48:51]
v_mfma_f32_16x16x32_bf16 v[36:39],a[156:159],v[108:111],v[36:39]
v_mfma_f32_16x16x32_bf16 v[52:55],v[108:111],v[156:159],v[52:55]
s_waitcnt lgkmcnt(2)
v_mfma_f32_16x16x32_bf16 v[24:27],a[160:163],v[112:115],v[24:27]
ds_read_b128 v[104:107],v6 offset:40960
v_mfma_f32_16x16x32_bf16 v[40:43],v[112:115],v[160:163],v[40:43]
v_mfma_f32_16x16x32_bf16 v[28:31],a[160:163],v[116:119],v[28:31]
ds_read_b128 v[108:111],v6 offset:45056
v_mfma_f32_16x16x32_bf16 v[44:47],v[116:119],v[160:163],v[44:47]
v_mfma_f32_16x16x32_bf16 v[32:35],a[168:171],v[112:115],v[32:35]
v_mfma_f32_16x16x32_bf16 v[48:51],v[112:115],v[168:171],v[48:51]
v_mfma_f32_16x16x32_bf16 v[36:39],a[168:171],v[116:119],v[36:39]
v_mfma_f32_16x16x32_bf16 v[52:55],v[116:119],v[168:171],v[52:55]
s_waitcnt lgkmcnt(2)
v_mfma_f32_16x16x32_bf16 v[24:27],a[164:167],v[120:123],v[24:27]
ds_read_b128 v[112:115],v7 offset:40960
v_mfma_f32_16x16x32_bf16 v[40:43],v[120:123],v[164:167],v[40:43]
v_mfma_f32_16x16x32_bf16 v[28:31],a[164:167],v[124:127],v[28:31]
ds_read_b128 v[116:119],v7 offset:45056
v_mfma_f32_16x16x32_bf16 v[44:47],v[124:127],v[164:167],v[44:47]
v_mfma_f32_16x16x32_bf16 v[32:35],a[172:175],v[120:123],v[32:35]
v_mfma_f32_16x16x32_bf16 v[48:51],v[120:123],v[172:175],v[48:51]
v_mfma_f32_16x16x32_bf16 v[36:39],a[172:175],v[124:127],v[36:39]
v_mfma_f32_16x16x32_bf16 v[52:55],v[124:127],v[172:175],v[52:55]
s_waitcnt lgkmcnt(2)
v_mfma_f32_16x16x32_bf16 v[24:27],a[176:179],v[104:107],v[24:27]
ds_read_b128 v[120:123],v4 offset:49152
v_mfma_f32_16x16x32_bf16 v[40:43],v[104:107],v[176:179],v[40:43]
v_mfma_f32_16x16x32_bf16 v[28:31],a[176:179],v[108:111],v[28:31]
ds_read_b128 v[124:127],v4 offset:53248
v_mfma_f32_16x16x32_bf16 v[44:47],v[108:111],v[176:179],v[44:47]
v_mfma_f32_16x16x32_bf16 v[32:35],a[184:187],v[104:107],v[32:35]
v_mfma_f32_16x16x32_bf16 v[48:51],v[104:107],v[184:187],v[48:51]
v_mfma_f32_16x16x32_bf16 v[36:39],a[184:187],v[108:111],v[36:39]
v_mfma_f32_16x16x32_bf16 v[52:55],v[108:111],v[184:187],v[52:55]
s_waitcnt lgkmcnt(2)
v_mfma_f32_16x16x32_bf16 v[24:27],a[180:183],v[112:115],v[24:27]
ds_read_b128 v[104:107],v5 offset:49152
v_mfma_f32_16x16x32_bf16 v[40:43],v[112:115],v[180:183],v[40:43]
v_mfma_f32_16x16x32_bf16 v[28:31],a[180:183],v[116:119],v[28:31]
ds_read_b128 v[108:111],v5 offset:53248
v_mfma_f32_16x16x32_bf16 v[44:47],v[116:119],v[180:183],v[44:47]
v_mfma_f32_16x16x32_bf16 v[32:35],a[188:191],v[112:115],v[32:35]
v_mfma_f32_16x16x32_bf16 v[48:51],v[112:115],v[188:191],v[48:51]
v_mfma_f32_16x16x32_bf16 v[36:39],a[188:191],v[116:119],v[36:39]
v_mfma_f32_16x16x32_bf16 v[52:55],v[116:119],v[188:191],v[52:55]
s_waitcnt lgkmcnt(2)
v_mfma_f32_16x16x32_bf16 v[24:27],a[192:195],v[120:123],v[24:27]
ds_read_b128 v[112:115],v6 offset:49152
v_mfma_f32_16x16x32_bf16 v[40:43],v[120:123],v[192:195],v[40:43]
v_mfma_f32_16x16x32_bf16 v[28:31],a[192:195],v[124:127],v[28:31]
ds_read_b128 v[116:119],v6 offset:53248
v_mfma_f32_16x16x32_bf16 v[44:47],v[124:127],v[192:195],v[44:47]
v_mfma_f32_16x16x32_bf16 v[32:35],a[200:203],v[120:123],v[32:35]
v_mfma_f32_16x16x32_bf16 v[48:51],v[120:123],v[200:203],v[48:51]
v_mfma_f32_16x16x32_bf16 v[36:39],a[200:203],v[124:127],v[36:39]
v_mfma_f32_16x16x32_bf16 v[52:55],v[124:127],v[200:203],v[52:55]
s_waitcnt lgkmcnt(2)
v_mfma_f32_16x16x32_bf16 v[24:27],a[196:199],v[104:107],v[24:27]
ds_read_b128 v[120:123],v7 offset:49152
v_mfma_f32_16x16x32_bf16 v[40:43],v[104:107],v[196:199],v[40:43]
v_mfma_f32_16x16x32_bf16 v[28:31],a[196:199],v[108:111],v[28:31]
ds_read_b128 v[124:127],v7 offset:53248
v_mfma_f32_16x16x32_bf16 v[44:47],v[108:111],v[196:199],v[44:47]
v_mfma_f32_16x16x32_bf16 v[32:35],a[204:207],v[104:107],v[32:35]
v_mfma_f32_16x16x32_bf16 v[48:51],v[104:107],v[204:207],v[48:51]
v_mfma_f32_16x16x32_bf16 v[36:39],a[204:207],v[108:111],v[36:39]
v_mfma_f32_16x16x32_bf16 v[52:55],v[108:111],v[204:207],v[52:55]
s_waitcnt vmcnt(0)
s_barrier
s_or_b32 s70,s70,s52
buffer_store_dword v17,off,s[8:11],s70 sc1
s_waitcnt lgkmcnt(2)
v_mfma_f32_16x16x32_bf16 v[24:27],a[208:211],v[112:115],v[24:27]
ds_read_b128 v[104:107],v4 offset:57344
v_mfma_f32_16x16x32_bf16 v[40:43],v[112:115],v[208:211],v[40:43]
s_add_u32 m0,s50,65536
v_mfma_f32_16x16x32_bf16 v[28:31],a[208:211],v[116:119],v[28:31]
ds_read_b128 v[108:111],v4 offset:61440
v_mfma_f32_16x16x32_bf16 v[44:47],v[116:119],v[208:211],v[44:47]
buffer_load_dwordx4 v20,s[8:11],s68 offen offset:0 sc1 lds
v_mfma_f32_16x16x32_bf16 v[32:35],a[216:219],v[112:115],v[32:35]
s_add_u32 m0,s50,69632
v_mfma_f32_16x16x32_bf16 v[48:51],v[112:115],v[216:219],v[48:51]
buffer_load_dwordx4 v20,s[8:11],s69 offen offset:0 sc1 lds
v_mfma_f32_16x16x32_bf16 v[36:39],a[216:219],v[116:119],v[36:39]
s_add_u32 m0,s50,73472
v_mfma_f32_16x16x32_bf16 v[52:55],v[116:119],v[216:219],v[52:55]
buffer_load_dwordx4 v20,s[8:11],s68 offen offset:256 sc1 lds
s_waitcnt lgkmcnt(2)
v_mfma_f32_16x16x32_bf16 v[24:27],a[212:215],v[120:123],v[24:27]
ds_read_b128 v[112:115],v5 offset:57344
v_mfma_f32_16x16x32_bf16 v[40:43],v[120:123],v[212:215],v[40:43]
s_add_u32 m0,s50,77568
v_mfma_f32_16x16x32_bf16 v[28:31],a[212:215],v[124:127],v[28:31]
ds_read_b128 v[116:119],v5 offset:61440
v_mfma_f32_16x16x32_bf16 v[44:47],v[124:127],v[212:215],v[44:47]
buffer_load_dwordx4 v20,s[8:11],s69 offen offset:256 sc1 lds
v_mfma_f32_16x16x32_bf16 v[32:35],a[220:223],v[120:123],v[32:35]
s_add_u32 m0,s50,81408
v_mfma_f32_16x16x32_bf16 v[48:51],v[120:123],v[220:223],v[48:51]
buffer_load_dwordx4 v20,s[8:11],s68 offen offset:512 sc1 lds
v_mfma_f32_16x16x32_bf16 v[36:39],a[220:223],v[124:127],v[36:39]
s_add_u32 m0,s50,85504
v_mfma_f32_16x16x32_bf16 v[52:55],v[124:127],v[220:223],v[52:55]
buffer_load_dwordx4 v20,s[8:11],s69 offen offset:512 sc1 lds
s_waitcnt lgkmcnt(2)
v_mfma_f32_16x16x32_bf16 v[24:27],a[224:227],v[104:107],v[24:27]
ds_read_b128 v[120:123],v6 offset:57344
v_mfma_f32_16x16x32_bf16 v[40:43],v[104:107],v[224:227],v[40:43]
s_add_u32 m0,s50,89344
v_mfma_f32_16x16x32_bf16 v[28:31],a[224:227],v[108:111],v[28:31]
ds_read_b128 v[124:127],v6 offset:61440
v_mfma_f32_16x16x32_bf16 v[44:47],v[108:111],v[224:227],v[44:47]
buffer_load_dwordx4 v20,s[8:11],s68 offen offset:768 sc1 lds
v_mfma_f32_16x16x32_bf16 v[32:35],a[232:235],v[104:107],v[32:35]
s_add_u32 m0,s50,93440
v_mfma_f32_16x16x32_bf16 v[48:51],v[104:107],v[232:235],v[48:51]
buffer_load_dwordx4 v20,s[8:11],s69 offen offset:768 sc1 lds
v_mfma_f32_16x16x32_bf16 v[36:39],a[232:235],v[108:111],v[36:39]
s_lshl_b32 s56,s51,5
v_mfma_f32_16x16x32_bf16 v[52:55],v[108:111],v[232:235],v[52:55]
s_add_u32 s56,s56,s47
s_waitcnt lgkmcnt(2)
v_mfma_f32_16x16x32_bf16 v[24:27],a[228:231],v[112:115],v[24:27]
ds_read_b128 v[104:107],v7 offset:57344
v_mfma_f32_16x16x32_bf16 v[40:43],v[112:115],v[228:231],v[40:43]
s_lshl_b32 s56,s56,13
v_mfma_f32_16x16x32_bf16 v[28:31],a[228:231],v[116:119],v[28:31]
ds_read_b128 v[108:111],v7 offset:61440
v_mfma_f32_16x16x32_bf16 v[44:47],v[116:119],v[228:231],v[44:47]
s_add_u32 s56,s56,s50
v_mfma_f32_16x16x32_bf16 v[32:35],a[236:239],v[112:115],v[32:35]
s_add_u32 s56,s56,41943040
v_mfma_f32_16x16x32_bf16 v[48:51],v[112:115],v[236:239],v[48:51]
s_add_u32 s57,s56,4096
v_mfma_f32_16x16x32_bf16 v[36:39],a[236:239],v[116:119],v[36:39]
v_mov_b64 v[72:73],-1
v_mfma_f32_16x16x32_bf16 v[52:55],v[116:119],v[236:239],v[52:55]
v_mov_b64 v[74:75],-1
s_waitcnt lgkmcnt(2)
v_mfma_f32_16x16x32_bf16 v[24:27],a[240:243],v[120:123],v[24:27]
ds_read_b128 v[112:115],v4 offset:32768
v_mfma_f32_16x16x32_bf16 v[40:43],v[120:123],v[240:243],v[40:43]
buffer_store_dwordx4 v[72:75],v0,s[8:11],s56 offen sc1
v_mfma_f32_16x16x32_bf16 v[28:31],a[240:243],v[124:127],v[28:31]
ds_read_b128 v[116:119],v4 offset:36864
v_mfma_f32_16x16x32_bf16 v[44:47],v[124:127],v[240:243],v[44:47]
buffer_store_dwordx4 v[72:75],v0,s[8:11],s57 offen sc1
v_mfma_f32_16x16x32_bf16 v[32:35],a[248:251],v[120:123],v[32:35]
v_mfma_f32_16x16x32_bf16 v[48:51],v[120:123],v[248:251],v[48:51]
v_mfma_f32_16x16x32_bf16 v[36:39],a[248:251],v[124:127],v[36:39]
v_mfma_f32_16x16x32_bf16 v[52:55],v[124:127],v[248:251],v[52:55]
s_waitcnt lgkmcnt(2)
v_mfma_f32_16x16x32_bf16 v[24:27],a[244:247],v[104:107],v[24:27]
ds_read_b128 v[120:123],v5 offset:32768
v_mfma_f32_16x16x32_bf16 v[40:43],v[104:107],v[244:247],v[40:43]
v_mfma_f32_16x16x32_bf16 v[28:31],a[244:247],v[108:111],v[28:31]
ds_read_b128 v[124:127],v5 offset:36864
v_mfma_f32_16x16x32_bf16 v[44:47],v[108:111],v[244:247],v[44:47]
v_mfma_f32_16x16x32_bf16 v[32:35],a[252:255],v[104:107],v[32:35]
v_mfma_f32_16x16x32_bf16 v[48:51],v[104:107],v[252:255],v[48:51]
v_mfma_f32_16x16x32_bf16 v[36:39],a[252:255],v[108:111],v[36:39]
v_mfma_f32_16x16x32_bf16 v[52:55],v[108:111],v[252:255],v[52:55]
s_waitcnt lgkmcnt(2)
v_mfma_f32_16x16x32_bf16 v[88:91],a[0:3],v[112:115],0
ds_read_b128 v[104:107],v6 offset:32768
v_mfma_f32_16x16x32_bf16 v[92:95],a[0:3],v[116:119],0
v_mfma_f32_16x16x32_bf16 v[96:99],a[8:11],v[112:115],0
ds_read_b128 v[108:111],v6 offset:36864
v_mfma_f32_16x16x32_bf16 v[100:103],a[8:11],v[116:119],0
s_waitcnt lgkmcnt(2)
v_mfma_f32_16x16x32_bf16 v[88:91],a[4:7],v[120:123],v[88:91]
ds_read_b128 v[112:115],v7 offset:32768
v_mfma_f32_16x16x32_bf16 v[92:95],a[4:7],v[124:127],v[92:95]
v_cvt_pk_bf16_f32 v56,v24,v32
v_cvt_pk_bf16_f32 v57,v25,v33
v_mfma_f32_16x16x32_bf16 v[96:99],a[12:15],v[120:123],v[96:99]
ds_read_b128 v[116:119],v7 offset:36864
v_mfma_f32_16x16x32_bf16 v[100:103],a[12:15],v[124:127],v[100:103]
v_cvt_pk_bf16_f32 v58,v26,v34
v_cvt_pk_bf16_f32 v59,v27,v35
s_waitcnt lgkmcnt(2)
v_mfma_f32_16x16x32_bf16 v[88:91],a[16:19],v[104:107],v[88:91]
ds_read_b128 v[120:123],v4 offset:40960
v_mfma_f32_16x16x32_bf16 v[92:95],a[16:19],v[108:111],v[92:95]
buffer_store_dwordx4 v[56:59],v0,s[8:11],s61 offen sc1
v_cvt_pk_bf16_f32 v60,v28,v36
v_mfma_f32_16x16x32_bf16 v[96:99],a[24:27],v[104:107],v[96:99]
ds_read_b128 v[124:127],v4 offset:45056
v_mfma_f32_16x16x32_bf16 v[100:103],a[24:27],v[108:111],v[100:103]
v_cvt_pk_bf16_f32 v61,v29,v37
v_cvt_pk_bf16_f32 v62,v30,v38
s_waitcnt lgkmcnt(2)
v_mfma_f32_16x16x32_bf16 v[88:91],a[20:23],v[112:115],v[88:91]
ds_read_b128 v[104:107],v5 offset:40960
v_mfma_f32_16x16x32_bf16 v[92:95],a[20:23],v[116:119],v[92:95]
v_cvt_pk_bf16_f32 v63,v31,v39
buffer_store_dwordx4 v[60:63],v0,s[8:11],s62 offen sc1
v_mfma_f32_16x16x32_bf16 v[96:99],a[28:31],v[112:115],v[96:99]
ds_read_b128 v[108:111],v5 offset:45056
v_mfma_f32_16x16x32_bf16 v[100:103],a[28:31],v[116:119],v[100:103]
v_cvt_pk_bf16_f32 v64,v40,v41
v_cvt_pk_bf16_f32 v65,v42,v43
s_waitcnt lgkmcnt(2)
v_mfma_f32_16x16x32_bf16 v[88:91],a[32:35],v[120:123],v[88:91]
ds_read_b128 v[112:115],v6 offset:40960
v_mfma_f32_16x16x32_bf16 v[92:95],a[32:35],v[124:127],v[92:95]
v_cvt_pk_bf16_f32 v66,v44,v45
v_cvt_pk_bf16_f32 v67,v46,v47
v_mfma_f32_16x16x32_bf16 v[96:99],a[40:43],v[120:123],v[96:99]
ds_read_b128 v[116:119],v6 offset:45056
v_mfma_f32_16x16x32_bf16 v[100:103],a[40:43],v[124:127],v[100:103]
buffer_store_dwordx4 v[64:67],v0,s[8:11],s65 offen offset:0 sc1
v_cvt_pk_bf16_f32 v68,v48,v49
s_waitcnt lgkmcnt(2)
v_mfma_f32_16x16x32_bf16 v[88:91],a[36:39],v[104:107],v[88:91]
ds_read_b128 v[120:123],v7 offset:40960
v_mfma_f32_16x16x32_bf16 v[92:95],a[36:39],v[108:111],v[92:95]
v_cvt_pk_bf16_f32 v69,v50,v51
v_cvt_pk_bf16_f32 v70,v52,v53
v_mfma_f32_16x16x32_bf16 v[96:99],a[44:47],v[104:107],v[96:99]
ds_read_b128 v[124:127],v7 offset:45056
v_mfma_f32_16x16x32_bf16 v[100:103],a[44:47],v[108:111],v[100:103]
v_cvt_pk_bf16_f32 v71,v54,v55
buffer_store_dwordx4 v[68:71],v0,s[8:11],s65 offen offset:1024 sc1
s_waitcnt lgkmcnt(2)
v_mfma_f32_16x16x32_bf16 v[88:91],a[48:51],v[112:115],v[88:91]
ds_read_b128 v[104:107],v4 offset:49152
v_mfma_f32_16x16x32_bf16 v[92:95],a[48:51],v[116:119],v[92:95]
v_mfma_f32_16x16x32_bf16 v[96:99],a[56:59],v[112:115],v[96:99]
ds_read_b128 v[108:111],v4 offset:53248
v_mfma_f32_16x16x32_bf16 v[100:103],a[56:59],v[116:119],v[100:103]
s_waitcnt lgkmcnt(2)
v_mfma_f32_16x16x32_bf16 v[88:91],a[52:55],v[120:123],v[88:91]
ds_read_b128 v[112:115],v5 offset:49152
v_mfma_f32_16x16x32_bf16 v[92:95],a[52:55],v[124:127],v[92:95]
v_mfma_f32_16x16x32_bf16 v[96:99],a[60:63],v[120:123],v[96:99]
ds_read_b128 v[116:119],v5 offset:53248
v_mfma_f32_16x16x32_bf16 v[100:103],a[60:63],v[124:127],v[100:103]
s_waitcnt lgkmcnt(2)
v_mfma_f32_16x16x32_bf16 v[88:91],a[64:67],v[104:107],v[88:91]
ds_read_b128 v[120:123],v6 offset:49152
v_mfma_f32_16x16x32_bf16 v[92:95],a[64:67],v[108:111],v[92:95]
v_mfma_f32_16x16x32_bf16 v[96:99],a[72:75],v[104:107],v[96:99]
ds_read_b128 v[124:127],v6 offset:53248
v_mfma_f32_16x16x32_bf16 v[100:103],a[72:75],v[108:111],v[100:103]
s_waitcnt lgkmcnt(2)
v_mfma_f32_16x16x32_bf16 v[88:91],a[68:71],v[112:115],v[88:91]
ds_read_b128 v[104:107],v7 offset:49152
v_mfma_f32_16x16x32_bf16 v[92:95],a[68:71],v[116:119],v[92:95]
v_mfma_f32_16x16x32_bf16 v[96:99],a[76:79],v[112:115],v[96:99]
ds_read_b128 v[108:111],v7 offset:53248
v_mfma_f32_16x16x32_bf16 v[100:103],a[76:79],v[116:119],v[100:103]
s_waitcnt lgkmcnt(2)
v_mfma_f32_16x16x32_bf16 v[88:91],a[80:83],v[120:123],v[88:91]
ds_read_b128 v[112:115],v4 offset:57344
v_mfma_f32_16x16x32_bf16 v[92:95],a[80:83],v[124:127],v[92:95]
v_mfma_f32_16x16x32_bf16 v[96:99],a[88:91],v[120:123],v[96:99]
ds_read_b128 v[116:119],v4 offset:61440
v_mfma_f32_16x16x32_bf16 v[100:103],a[88:91],v[124:127],v[100:103]
s_waitcnt lgkmcnt(2)
v_mfma_f32_16x16x32_bf16 v[88:91],a[84:87],v[104:107],v[88:91]
ds_read_b128 v[120:123],v5 offset:57344
v_mfma_f32_16x16x32_bf16 v[92:95],a[84:87],v[108:111],v[92:95]
v_mfma_f32_16x16x32_bf16 v[96:99],a[92:95],v[104:107],v[96:99]
ds_read_b128 v[124:127],v5 offset:61440
v_mfma_f32_16x16x32_bf16 v[100:103],a[92:95],v[108:111],v[100:103]
s_waitcnt lgkmcnt(2)
v_mfma_f32_16x16x32_bf16 v[88:91],a[96:99],v[112:115],v[88:91]
ds_read_b128 v[104:107],v6 offset:57344
v_mfma_f32_16x16x32_bf16 v[92:95],a[96:99],v[116:119],v[92:95]
v_mfma_f32_16x16x32_bf16 v[96:99],a[104:107],v[112:115],v[96:99]
ds_read_b128 v[108:111],v6 offset:61440
v_mfma_f32_16x16x32_bf16 v[100:103],a[104:107],v[116:119],v[100:103]
s_waitcnt lgkmcnt(2)
v_mfma_f32_16x16x32_bf16 v[88:91],a[100:103],v[120:123],v[88:91]
ds_read_b128 v[112:115],v7 offset:57344
v_mfma_f32_16x16x32_bf16 v[92:95],a[100:103],v[124:127],v[92:95]
v_mfma_f32_16x16x32_bf16 v[96:99],a[108:111],v[120:123],v[96:99]
ds_read_b128 v[116:119],v7 offset:61440
v_mfma_f32_16x16x32_bf16 v[100:103],a[108:111],v[124:127],v[100:103]
s_waitcnt lgkmcnt(2)
v_mfma_f32_16x16x32_bf16 v[88:91],a[112:115],v[104:107],v[88:91]
v_mfma_f32_16x16x32_bf16 v[92:95],a[112:115],v[108:111],v[92:95]
v_mfma_f32_16x16x32_bf16 v[96:99],a[120:123],v[104:107],v[96:99]
v_mfma_f32_16x16x32_bf16 v[100:103],a[120:123],v[108:111],v[100:103]
s_waitcnt lgkmcnt(0)
v_mfma_f32_16x16x32_bf16 v[88:91],a[116:119],v[112:115],v[88:91]
v_mfma_f32_16x16x32_bf16 v[92:95],a[116:119],v[116:119],v[92:95]
v_mfma_f32_16x16x32_bf16 v[96:99],a[124:127],v[112:115],v[96:99]
v_mfma_f32_16x16x32_bf16 v[100:103],a[124:127],v[116:119],v[100:103]
s_nop 3
v_cvt_pk_bf16_f32 v104,v88,v96
v_cvt_pk_bf16_f32 v105,v89,v97
v_cvt_pk_bf16_f32 v106,v90,v98
v_cvt_pk_bf16_f32 v107,v91,v99
v_cvt_pk_bf16_f32 v108,v92,v100
v_cvt_pk_bf16_f32 v109,v93,v101
v_cvt_pk_bf16_f32 v110,v94,v102
v_cvt_pk_bf16_f32 v111,v95,v103
buffer_store_dwordx4 v[104:107],v0,s[8:11],s63 offen sc1
buffer_store_dwordx4 v[108:111],v0,s[8:11],s64 offen sc1
s_waitcnt vmcnt(6)
s_barrier
s_lshl_b32 s70,s51,13
s_lshl2_add_u32 s70,s47,s70
s_add_u32 s70,s70,10485760
s_mov_b32 s51,s55
s_ff1_i32_b64 s55,s[72:73]
s_bitset0_b64 s[72:73],s55
s_min_u32 s55,s55,127
s_lshl_b32 s68,s55,15
s_add_u32 s68,s68,0
s_add_u32 s69,s68,16384
s_lshl_b32 s58,s51,5
s_add_u32 s58,s58,s47
s_mul_i32 s58,s58,24576
s_add_u32 s58,s58,100663296
s_add_u32 s61,s58,s50
s_add_u32 s62,s61,4096
s_add_u32 s63,s61,16384
s_add_u32 s64,s61,20480
s_add_u32 s65,s61,s50
s_add_u32 s65,s65,8192
ds_read_b128 v[104:107],v4 offset:0
ds_read_b128 v[108:111],v4 offset:4096
ds_read_b128 v[112:115],v5 offset:0
ds_read_b128 v[116:119],v5 offset:4096
s_waitcnt lgkmcnt(2)
v_mfma_f32_16x16x32_bf16 v[24:27],a[128:131],v[104:107],0
ds_read_b128 v[120:123],v6 offset:0
v_mfma_f32_16x16x32_bf16 v[40:43],v[104:107],v[128:131],0
v_mfma_f32_16x16x32_bf16 v[28:31],a[128:131],v[108:111],0
ds_read_b128 v[124:127],v6 offset:4096
v_mfma_f32_16x16x32_bf16 v[44:47],v[108:111],v[128:131],0
v_mfma_f32_16x16x32_bf16 v[32:35],a[136:139],v[104:107],0
v_mfma_f32_16x16x32_bf16 v[48:51],v[104:107],v[136:139],0
v_mfma_f32_16x16x32_bf16 v[36:39],a[136:139],v[108:111],0
v_mfma_f32_16x16x32_bf16 v[52:55],v[108:111],v[136:139],0
s_waitcnt lgkmcnt(2)
v_mfma_f32_16x16x32_bf16 v[24:27],a[132:135],v[112:115],v[24:27]
ds_read_b128 v[104:107],v7 offset:0
v_mfma_f32_16x16x32_bf16 v[40:43],v[112:115],v[132:135],v[40:43]
v_mfma_f32_16x16x32_bf16 v[28:31],a[132:135],v[116:119],v[28:31]
ds_read_b128 v[108:111],v7 offset:4096
v_mfma_f32_16x16x32_bf16 v[44:47],v[116:119],v[132:135],v[44:47]
v_mfma_f32_16x16x32_bf16 v[32:35],a[140:143],v[112:115],v[32:35]
v_mfma_f32_16x16x32_bf16 v[48:51],v[112:115],v[140:143],v[48:51]
v_mfma_f32_16x16x32_bf16 v[36:39],a[140:143],v[116:119],v[36:39]
v_mfma_f32_16x16x32_bf16 v[52:55],v[116:119],v[140:143],v[52:55]
s_waitcnt lgkmcnt(2)
v_mfma_f32_16x16x32_bf16 v[24:27],a[144:147],v[120:123],v[24:27]
ds_read_b128 v[112:115],v4 offset:8192
v_mfma_f32_16x16x32_bf16 v[40:43],v[120:123],v[144:147],v[40:43]
v_mfma_f32_16x16x32_bf16 v[28:31],a[144:147],v[124:127],v[28:31]
ds_read_b128 v[116:119],v4 offset:12288
v_mfma_f32_16x16x32_bf16 v[44:47],v[124:127],v[144:147],v[44:47]
v_mfma_f32_16x16x32_bf16 v[32:35],a[152:155],v[120:123],v[32:35]
v_mfma_f32_16x16x32_bf16 v[48:51],v[120:123],v[152:155],v[48:51]
v_mfma_f32_16x16x32_bf16 v[36:39],a[152:155],v[124:127],v[36:39]
v_mfma_f32_16x16x32_bf16 v[52:55],v[124:127],v[152:155],v[52:55]
s_waitcnt lgkmcnt(2)
v_mfma_f32_16x16x32_bf16 v[24:27],a[148:151],v[104:107],v[24:27]
ds_read_b128 v[120:123],v5 offset:8192
v_mfma_f32_16x16x32_bf16 v[40:43],v[104:107],v[148:151],v[40:43]
v_mfma_f32_16x16x32_bf16 v[28:31],a[148:151],v[108:111],v[28:31]
ds_read_b128 v[124:127],v5 offset:12288
v_mfma_f32_16x16x32_bf16 v[44:47],v[108:111],v[148:151],v[44:47]
v_mfma_f32_16x16x32_bf16 v[32:35],a[156:159],v[104:107],v[32:35]
v_mfma_f32_16x16x32_bf16 v[48:51],v[104:107],v[156:159],v[48:51]
v_mfma_f32_16x16x32_bf16 v[36:39],a[156:159],v[108:111],v[36:39]
v_mfma_f32_16x16x32_bf16 v[52:55],v[108:111],v[156:159],v[52:55]
s_waitcnt lgkmcnt(2)
v_mfma_f32_16x16x32_bf16 v[24:27],a[160:163],v[112:115],v[24:27]
ds_read_b128 v[104:107],v6 offset:8192
v_mfma_f32_16x16x32_bf16 v[40:43],v[112:115],v[160:163],v[40:43]
v_mfma_f32_16x16x32_bf16 v[28:31],a[160:163],v[116:119],v[28:31]
ds_read_b128 v[108:111],v6 offset:12288
v_mfma_f32_16x16x32_bf16 v[44:47],v[116:119],v[160:163],v[44:47]
v_mfma_f32_16x16x32_bf16 v[32:35],a[168:171],v[112:115],v[32:35]
v_mfma_f32_16x16x32_bf16 v[48:51],v[112:115],v[168:171],v[48:51]
v_mfma_f32_16x16x32_bf16 v[36:39],a[168:171],v[116:119],v[36:39]
v_mfma_f32_16x16x32_bf16 v[52:55],v[116:119],v[168:171],v[52:55]
s_waitcnt lgkmcnt(2)
v_mfma_f32_16x16x32_bf16 v[24:27],a[164:167],v[120:123],v[24:27]
ds_read_b128 v[112:115],v7 offset:8192
v_mfma_f32_16x16x32_bf16 v[40:43],v[120:123],v[164:167],v[40:43]
v_mfma_f32_16x16x32_bf16 v[28:31],a[164:167],v[124:127],v[28:31]
ds_read_b128 v[116:119],v7 offset:12288
v_mfma_f32_16x16x32_bf16 v[44:47],v[124:127],v[164:167],v[44:47]
v_mfma_f32_16x16x32_bf16 v[32:35],a[172:175],v[120:123],v[32:35]
v_mfma_f32_16x16x32_bf16 v[48:51],v[120:123],v[172:175],v[48:51]
v_mfma_f32_16x16x32_bf16 v[36:39],a[172:175],v[124:127],v[36:39]
v_mfma_f32_16x16x32_bf16 v[52:55],v[124:127],v[172:175],v[52:55]
s_waitcnt lgkmcnt(2)
v_mfma_f32_16x16x32_bf16 v[24:27],a[176:179],v[104:107],v[24:27]
ds_read_b128 v[120:123],v4 offset:16384
v_mfma_f32_16x16x32_bf16 v[40:43],v[104:107],v[176:179],v[40:43]
v_mfma_f32_16x16x32_bf16 v[28:31],a[176:179],v[108:111],v[28:31]
ds_read_b128 v[124:127],v4 offset:20480
v_mfma_f32_16x16x32_bf16 v[44:47],v[108:111],v[176:179],v[44:47]
v_mfma_f32_16x16x32_bf16 v[32:35],a[184:187],v[104:107],v[32:35]
v_mfma_f32_16x16x32_bf16 v[48:51],v[104:107],v[184:187],v[48:51]
v_mfma_f32_16x16x32_bf16 v[36:39],a[184:187],v[108:111],v[36:39]
v_mfma_f32_16x16x32_bf16 v[52:55],v[108:111],v[184:187],v[52:55]
s_waitcnt lgkmcnt(2)
v_mfma_f32_16x16x32_bf16 v[24:27],a[180:183],v[112:115],v[24:27]
ds_read_b128 v[104:107],v5 offset:16384
v_mfma_f32_16x16x32_bf16 v[40:43],v[112:115],v[180:183],v[40:43]
v_mfma_f32_16x16x32_bf16 v[28:31],a[180:183],v[116:119],v[28:31]
ds_read_b128 v[108:111],v5 offset:20480
v_mfma_f32_16x16x32_bf16 v[44:47],v[116:119],v[180:183],v[44:47]
v_mfma_f32_16x16x32_bf16 v[32:35],a[188:191],v[112:115],v[32:35]
v_mfma_f32_16x16x32_bf16 v[48:51],v[112:115],v[188:191],v[48:51]
v_mfma_f32_16x16x32_bf16 v[36:39],a[188:191],v[116:119],v[36:39]
v_mfma_f32_16x16x32_bf16 v[52:55],v[116:119],v[188:191],v[52:55]
s_waitcnt lgkmcnt(2)
v_mfma_f32_16x16x32_bf16 v[24:27],a[192:195],v[120:123],v[24:27]
ds_read_b128 v[112:115],v6 offset:16384
v_mfma_f32_16x16x32_bf16 v[40:43],v[120:123],v[192:195],v[40:43]
v_mfma_f32_16x16x32_bf16 v[28:31],a[192:195],v[124:127],v[28:31]
ds_read_b128 v[116:119],v6 offset:20480
v_mfma_f32_16x16x32_bf16 v[44:47],v[124:127],v[192:195],v[44:47]
v_mfma_f32_16x16x32_bf16 v[32:35],a[200:203],v[120:123],v[32:35]
v_mfma_f32_16x16x32_bf16 v[48:51],v[120:123],v[200:203],v[48:51]
v_mfma_f32_16x16x32_bf16 v[36:39],a[200:203],v[124:127],v[36:39]
v_mfma_f32_16x16x32_bf16 v[52:55],v[124:127],v[200:203],v[52:55]
s_waitcnt lgkmcnt(2)
v_mfma_f32_16x16x32_bf16 v[24:27],a[196:199],v[104:107],v[24:27]
ds_read_b128 v[120:123],v7 offset:16384
v_mfma_f32_16x16x32_bf16 v[40:43],v[104:107],v[196:199],v[40:43]
v_mfma_f32_16x16x32_bf16 v[28:31],a[196:199],v[108:111],v[28:31]
ds_read_b128 v[124:127],v7 offset:20480
v_mfma_f32_16x16x32_bf16 v[44:47],v[108:111],v[196:199],v[44:47]
v_mfma_f32_16x16x32_bf16 v[32:35],a[204:207],v[104:107],v[32:35]
v_mfma_f32_16x16x32_bf16 v[48:51],v[104:107],v[204:207],v[48:51]
v_mfma_f32_16x16x32_bf16 v[36:39],a[204:207],v[108:111],v[36:39]
v_mfma_f32_16x16x32_bf16 v[52:55],v[108:111],v[204:207],v[52:55]
s_waitcnt vmcnt(0)
s_barrier
s_or_b32 s70,s70,s52
buffer_store_dword v17,off,s[8:11],s70 sc1
s_waitcnt lgkmcnt(2)
v_mfma_f32_16x16x32_bf16 v[24:27],a[208:211],v[112:115],v[24:27]
ds_read_b128 v[104:107],v4 offset:24576
v_mfma_f32_16x16x32_bf16 v[40:43],v[112:115],v[208:211],v[40:43]
s_add_u32 m0,s50,98304
v_mfma_f32_16x16x32_bf16 v[28:31],a[208:211],v[116:119],v[28:31]
ds_read_b128 v[108:111],v4 offset:28672
v_mfma_f32_16x16x32_bf16 v[44:47],v[116:119],v[208:211],v[44:47]
buffer_load_dwordx4 v20,s[8:11],s68 offen offset:0 sc1 lds
v_mfma_f32_16x16x32_bf16 v[32:35],a[216:219],v[112:115],v[32:35]
s_add_u32 m0,s50,102400
v_mfma_f32_16x16x32_bf16 v[48:51],v[112:115],v[216:219],v[48:51]
buffer_load_dwordx4 v20,s[8:11],s69 offen offset:0 sc1 lds
v_mfma_f32_16x16x32_bf16 v[36:39],a[216:219],v[116:119],v[36:39]
s_add_u32 m0,s50,106240
v_mfma_f32_16x16x32_bf16 v[52:55],v[116:119],v[216:219],v[52:55]
buffer_load_dwordx4 v20,s[8:11],s68 offen offset:256 sc1 lds
s_waitcnt lgkmcnt(2)
v_mfma_f32_16x16x32_bf16 v[24:27],a[212:215],v[120:123],v[24:27]
ds_read_b128 v[112:115],v5 offset:24576
v_mfma_f32_16x16x32_bf16 v[40:43],v[120:123],v[212:215],v[40:43]
s_add_u32 m0,s50,110336
v_mfma_f32_16x16x32_bf16 v[28:31],a[212:215],v[124:127],v[28:31]
ds_read_b128 v[116:119],v5 offset:28672
v_mfma_f32_16x16x32_bf16 v[44:47],v[124:127],v[212:215],v[44:47]
buffer_load_dwordx4 v20,s[8:11],s69 offen offset:256 sc1 lds
v_mfma_f32_16x16x32_bf16 v[32:35],a[220:223],v[120:123],v[32:35]
s_add_u32 m0,s50,114176
v_mfma_f32_16x16x32_bf16 v[48:51],v[120:123],v[220:223],v[48:51]
buffer_load_dwordx4 v20,s[8:11],s68 offen offset:512 sc1 lds
v_mfma_f32_16x16x32_bf16 v[36:39],a[220:223],v[124:127],v[36:39]
s_add_u32 m0,s50,118272
v_mfma_f32_16x16x32_bf16 v[52:55],v[124:127],v[220:223],v[52:55]
buffer_load_dwordx4 v20,s[8:11],s69 offen offset:512 sc1 lds
s_waitcnt lgkmcnt(2)
v_mfma_f32_16x16x32_bf16 v[24:27],a[224:227],v[104:107],v[24:27]
ds_read_b128 v[120:123],v6 offset:24576
v_mfma_f32_16x16x32_bf16 v[40:43],v[104:107],v[224:227],v[40:43]
s_add_u32 m0,s50,122112
v_mfma_f32_16x16x32_bf16 v[28:31],a[224:227],v[108:111],v[28:31]
ds_read_b128 v[124:127],v6 offset:28672
v_mfma_f32_16x16x32_bf16 v[44:47],v[108:111],v[224:227],v[44:47]
buffer_load_dwordx4 v20,s[8:11],s68 offen offset:768 sc1 lds
v_mfma_f32_16x16x32_bf16 v[32:35],a[232:235],v[104:107],v[32:35]
s_add_u32 m0,s50,126208
v_mfma_f32_16x16x32_bf16 v[48:51],v[104:107],v[232:235],v[48:51]
buffer_load_dwordx4 v20,s[8:11],s69 offen offset:768 sc1 lds
v_mfma_f32_16x16x32_bf16 v[36:39],a[232:235],v[108:111],v[36:39]
s_lshl_b32 s56,s51,5
v_mfma_f32_16x16x32_bf16 v[52:55],v[108:111],v[232:235],v[52:55]
s_add_u32 s56,s56,s47
s_waitcnt lgkmcnt(2)
v_mfma_f32_16x16x32_bf16 v[24:27],a[228:231],v[112:115],v[24:27]
ds_read_b128 v[104:107],v7 offset:24576
v_mfma_f32_16x16x32_bf16 v[40:43],v[112:115],v[228:231],v[40:43]
s_lshl_b32 s56,s56,13
v_mfma_f32_16x16x32_bf16 v[28:31],a[228:231],v[116:119],v[28:31]
ds_read_b128 v[108:111],v7 offset:28672
v_mfma_f32_16x16x32_bf16 v[44:47],v[116:119],v[228:231],v[44:47]
s_add_u32 s56,s56,s50
v_mfma_f32_16x16x32_bf16 v[32:35],a[236:239],v[112:115],v[32:35]
s_add_u32 s56,s56,41943040
v_mfma_f32_16x16x32_bf16 v[48:51],v[112:115],v[236:239],v[48:51]
s_add_u32 s57,s56,4096
v_mfma_f32_16x16x32_bf16 v[36:39],a[236:239],v[116:119],v[36:39]
v_mov_b64 v[72:73],-1
v_mfma_f32_16x16x32_bf16 v[52:55],v[116:119],v[236:239],v[52:55]
v_mov_b64 v[74:75],-1
s_waitcnt lgkmcnt(2)
v_mfma_f32_16x16x32_bf16 v[24:27],a[240:243],v[120:123],v[24:27]
ds_read_b128 v[112:115],v4 offset:0
v_mfma_f32_16x16x32_bf16 v[40:43],v[120:123],v[240:243],v[40:43]
buffer_store_dwordx4 v[72:75],v0,s[8:11],s56 offen sc1
v_mfma_f32_16x16x32_bf16 v[28:31],a[240:243],v[124:127],v[28:31]
ds_read_b128 v[116:119],v4 offset:4096
v_mfma_f32_16x16x32_bf16 v[44:47],v[124:127],v[240:243],v[44:47]
buffer_store_dwordx4 v[72:75],v0,s[8:11],s57 offen sc1
v_mfma_f32_16x16x32_bf16 v[32:35],a[248:251],v[120:123],v[32:35]
v_mfma_f32_16x16x32_bf16 v[48:51],v[120:123],v[248:251],v[48:51]
v_mfma_f32_16x16x32_bf16 v[36:39],a[248:251],v[124:127],v[36:39]
v_mfma_f32_16x16x32_bf16 v[52:55],v[124:127],v[248:251],v[52:55]
s_waitcnt lgkmcnt(2)
v_mfma_f32_16x16x32_bf16 v[24:27],a[244:247],v[104:107],v[24:27]
ds_read_b128 v[120:123],v5 offset:0
v_mfma_f32_16x16x32_bf16 v[40:43],v[104:107],v[244:247],v[40:43]
v_mfma_f32_16x16x32_bf16 v[28:31],a[244:247],v[108:111],v[28:31]
ds_read_b128 v[124:127],v5 offset:4096
v_mfma_f32_16x16x32_bf16 v[44:47],v[108:111],v[244:247],v[44:47]
v_mfma_f32_16x16x32_bf16 v[32:35],a[252:255],v[104:107],v[32:35]
v_mfma_f32_16x16x32_bf16 v[48:51],v[104:107],v[252:255],v[48:51]
v_mfma_f32_16x16x32_bf16 v[36:39],a[252:255],v[108:111],v[36:39]
v_mfma_f32_16x16x32_bf16 v[52:55],v[108:111],v[252:255],v[52:55]
s_waitcnt lgkmcnt(2)
v_mfma_f32_16x16x32_bf16 v[88:91],a[0:3],v[112:115],0
ds_read_b128 v[104:107],v6 offset:0
v_mfma_f32_16x16x32_bf16 v[92:95],a[0:3],v[116:119],0
v_mfma_f32_16x16x32_bf16 v[96:99],a[8:11],v[112:115],0
ds_read_b128 v[108:111],v6 offset:4096
v_mfma_f32_16x16x32_bf16 v[100:103],a[8:11],v[116:119],0
s_waitcnt lgkmcnt(2)
v_mfma_f32_16x16x32_bf16 v[88:91],a[4:7],v[120:123],v[88:91]
ds_read_b128 v[112:115],v7 offset:0
v_mfma_f32_16x16x32_bf16 v[92:95],a[4:7],v[124:127],v[92:95]
v_cvt_pk_bf16_f32 v56,v24,v32
v_cvt_pk_bf16_f32 v57,v25,v33
v_mfma_f32_16x16x32_bf16 v[96:99],a[12:15],v[120:123],v[96:99]
ds_read_b128 v[116:119],v7 offset:4096
v_mfma_f32_16x16x32_bf16 v[100:103],a[12:15],v[124:127],v[100:103]
v_cvt_pk_bf16_f32 v58,v26,v34
v_cvt_pk_bf16_f32 v59,v27,v35
s_waitcnt lgkmcnt(2)
v_mfma_f32_16x16x32_bf16 v[88:91],a[16:19],v[104:107],v[88:91]
ds_read_b128 v[120:123],v4 offset:8192
v_mfma_f32_16x16x32_bf16 v[92:95],a[16:19],v[108:111],v[92:95]
buffer_store_dwordx4 v[56:59],v0,s[8:11],s61 offen sc1
v_cvt_pk_bf16_f32 v60,v28,v36
v_mfma_f32_16x16x32_bf16 v[96:99],a[24:27],v[104:107],v[96:99]
ds_read_b128 v[124:127],v4 offset:12288
v_mfma_f32_16x16x32_bf16 v[100:103],a[24:27],v[108:111],v[100:103]
v_cvt_pk_bf16_f32 v61,v29,v37
v_cvt_pk_bf16_f32 v62,v30,v38
s_waitcnt lgkmcnt(2)
v_mfma_f32_16x16x32_bf16 v[88:91],a[20:23],v[112:115],v[88:91]
ds_read_b128 v[104:107],v5 offset:8192
v_mfma_f32_16x16x32_bf16 v[92:95],a[20:23],v[116:119],v[92:95]
v_cvt_pk_bf16_f32 v63,v31,v39
buffer_store_dwordx4 v[60:63],v0,s[8:11],s62 offen sc1
v_mfma_f32_16x16x32_bf16 v[96:99],a[28:31],v[112:115],v[96:99]
ds_read_b128 v[108:111],v5 offset:12288
v_mfma_f32_16x16x32_bf16 v[100:103],a[28:31],v[116:119],v[100:103]
v_cvt_pk_bf16_f32 v64,v40,v41
v_cvt_pk_bf16_f32 v65,v42,v43
s_waitcnt lgkmcnt(2)
v_mfma_f32_16x16x32_bf16 v[88:91],a[32:35],v[120:123],v[88:91]
ds_read_b128 v[112:115],v6 offset:8192
v_mfma_f32_16x16x32_bf16 v[92:95],a[32:35],v[124:127],v[92:95]
v_cvt_pk_bf16_f32 v66,v44,v45
v_cvt_pk_bf16_f32 v67,v46,v47
v_mfma_f32_16x16x32_bf16 v[96:99],a[40:43],v[120:123],v[96:99]
ds_read_b128 v[116:119],v6 offset:12288
v_mfma_f32_16x16x32_bf16 v[100:103],a[40:43],v[124:127],v[100:103]
buffer_store_dwordx4 v[64:67],v0,s[8:11],s65 offen offset:0 sc1
v_cvt_pk_bf16_f32 v68,v48,v49
s_waitcnt lgkmcnt(2)
v_mfma_f32_16x16x32_bf16 v[88:91],a[36:39],v[104:107],v[88:91]
ds_read_b128 v[120:123],v7 offset:8192
v_mfma_f32_16x16x32_bf16 v[92:95],a[36:39],v[108:111],v[92:95]
v_cvt_pk_bf16_f32 v69,v50,v51
v_cvt_pk_bf16_f32 v70,v52,v53
v_mfma_f32_16x16x32_bf16 v[96:99],a[44:47],v[104:107],v[96:99]
ds_read_b128 v[124:127],v7 offset:12288
v_mfma_f32_16x16x32_bf16 v[100:103],a[44:47],v[108:111],v[100:103]
v_cvt_pk_bf16_f32 v71,v54,v55
buffer_store_dwordx4 v[68:71],v0,s[8:11],s65 offen offset:1024 sc1
s_waitcnt lgkmcnt(2)
v_mfma_f32_16x16x32_bf16 v[88:91],a[48:51],v[112:115],v[88:91]
ds_read_b128 v[104:107],v4 offset:16384
v_mfma_f32_16x16x32_bf16 v[92:95],a[48:51],v[116:119],v[92:95]
v_mfma_f32_16x16x32_bf16 v[96:99],a[56:59],v[112:115],v[96:99]
ds_read_b128 v[108:111],v4 offset:20480
v_mfma_f32_16x16x32_bf16 v[100:103],a[56:59],v[116:119],v[100:103]
s_waitcnt lgkmcnt(2)
v_mfma_f32_16x16x32_bf16 v[88:91],a[52:55],v[120:123],v[88:91]
ds_read_b128 v[112:115],v5 offset:16384
v_mfma_f32_16x16x32_bf16 v[92:95],a[52:55],v[124:127],v[92:95]
v_mfma_f32_16x16x32_bf16 v[96:99],a[60:63],v[120:123],v[96:99]
ds_read_b128 v[116:119],v5 offset:20480
v_mfma_f32_16x16x32_bf16 v[100:103],a[60:63],v[124:127],v[100:103]
s_waitcnt lgkmcnt(2)
v_mfma_f32_16x16x32_bf16 v[88:91],a[64:67],v[104:107],v[88:91]
ds_read_b128 v[120:123],v6 offset:16384
v_mfma_f32_16x16x32_bf16 v[92:95],a[64:67],v[108:111],v[92:95]
v_mfma_f32_16x16x32_bf16 v[96:99],a[72:75],v[104:107],v[96:99]
ds_read_b128 v[124:127],v6 offset:20480
v_mfma_f32_16x16x32_bf16 v[100:103],a[72:75],v[108:111],v[100:103]
s_waitcnt lgkmcnt(2)
v_mfma_f32_16x16x32_bf16 v[88:91],a[68:71],v[112:115],v[88:91]
ds_read_b128 v[104:107],v7 offset:16384
v_mfma_f32_16x16x32_bf16 v[92:95],a[68:71],v[116:119],v[92:95]
v_mfma_f32_16x16x32_bf16 v[96:99],a[76:79],v[112:115],v[96:99]
ds_read_b128 v[108:111],v7 offset:20480
v_mfma_f32_16x16x32_bf16 v[100:103],a[76:79],v[116:119],v[100:103]
s_waitcnt lgkmcnt(2)
v_mfma_f32_16x16x32_bf16 v[88:91],a[80:83],v[120:123],v[88:91]
ds_read_b128 v[112:115],v4 offset:24576
v_mfma_f32_16x16x32_bf16 v[92:95],a[80:83],v[124:127],v[92:95]
v_mfma_f32_16x16x32_bf16 v[96:99],a[88:91],v[120:123],v[96:99]
ds_read_b128 v[116:119],v4 offset:28672
v_mfma_f32_16x16x32_bf16 v[100:103],a[88:91],v[124:127],v[100:103]
s_waitcnt lgkmcnt(2)
v_mfma_f32_16x16x32_bf16 v[88:91],a[84:87],v[104:107],v[88:91]
ds_read_b128 v[120:123],v5 offset:24576
v_mfma_f32_16x16x32_bf16 v[92:95],a[84:87],v[108:111],v[92:95]
v_mfma_f32_16x16x32_bf16 v[96:99],a[92:95],v[104:107],v[96:99]
ds_read_b128 v[124:127],v5 offset:28672
v_mfma_f32_16x16x32_bf16 v[100:103],a[92:95],v[108:111],v[100:103]
s_waitcnt lgkmcnt(2)
v_mfma_f32_16x16x32_bf16 v[88:91],a[96:99],v[112:115],v[88:91]
ds_read_b128 v[104:107],v6 offset:24576
v_mfma_f32_16x16x32_bf16 v[92:95],a[96:99],v[116:119],v[92:95]
v_mfma_f32_16x16x32_bf16 v[96:99],a[104:107],v[112:115],v[96:99]
ds_read_b128 v[108:111],v6 offset:28672
v_mfma_f32_16x16x32_bf16 v[100:103],a[104:107],v[116:119],v[100:103]
s_waitcnt lgkmcnt(2)
v_mfma_f32_16x16x32_bf16 v[88:91],a[100:103],v[120:123],v[88:91]
ds_read_b128 v[112:115],v7 offset:24576
v_mfma_f32_16x16x32_bf16 v[92:95],a[100:103],v[124:127],v[92:95]
v_mfma_f32_16x16x32_bf16 v[96:99],a[108:111],v[120:123],v[96:99]
ds_read_b128 v[116:119],v7 offset:28672
v_mfma_f32_16x16x32_bf16 v[100:103],a[108:111],v[124:127],v[100:103]
s_waitcnt lgkmcnt(2)
v_mfma_f32_16x16x32_bf16 v[88:91],a[112:115],v[104:107],v[88:91]
v_mfma_f32_16x16x32_bf16 v[92:95],a[112:115],v[108:111],v[92:95]
v_mfma_f32_16x16x32_bf16 v[96:99],a[120:123],v[104:107],v[96:99]
v_mfma_f32_16x16x32_bf16 v[100:103],a[120:123],v[108:111],v[100:103]
s_waitcnt lgkmcnt(0)
v_mfma_f32_16x16x32_bf16 v[88:91],a[116:119],v[112:115],v[88:91]
v_mfma_f32_16x16x32_bf16 v[92:95],a[116:119],v[116:119],v[92:95]
v_mfma_f32_16x16x32_bf16 v[96:99],a[124:127],v[112:115],v[96:99]
v_mfma_f32_16x16x32_bf16 v[100:103],a[124:127],v[116:119],v[100:103]
s_nop 3
v_cvt_pk_bf16_f32 v104,v88,v96
v_cvt_pk_bf16_f32 v105,v89,v97
v_cvt_pk_bf16_f32 v106,v90,v98
v_cvt_pk_bf16_f32 v107,v91,v99
v_cvt_pk_bf16_f32 v108,v92,v100
v_cvt_pk_bf16_f32 v109,v93,v101
v_cvt_pk_bf16_f32 v110,v94,v102
v_cvt_pk_bf16_f32 v111,v95,v103
buffer_store_dwordx4 v[104:107],v0,s[8:11],s63 offen sc1
buffer_store_dwordx4 v[108:111],v0,s[8:11],s64 offen sc1
s_waitcnt vmcnt(6)
s_barrier
s_lshl_b32 s70,s51,13
s_lshl2_add_u32 s70,s47,s70
s_add_u32 s70,s70,10485760
s_sub_u32 s53,s53,1
s_cmp_gt_u32 s53,0
s_cbranch_scc1 L_pu_12
s_waitcnt vmcnt(0)
s_barrier
s_or_b32 s70,s70,s52
buffer_store_dword v17,off,s[8:11],s70 sc1
s_mov_b32 s70,0x80000000
L_pl_13:
s_mov_b32 s51,s54
s_lshl_b32 s66,s54,15
s_add_u32 s66,s66,2097152
s_add_u32 s67,s66,16384
s_lshl_b32 s59,s51,13
s_add_u32 s59,s59,10487552
v_and_b32 v124,31,v1
v_lshlrev_b32 v124,2,v124
L_fw_15:
buffer_load_dword v125,v124,s[8:11],s59 offen sc1
s_sub_u32 s49,s49,1
s_cbranch_scc1 L_abort
s_waitcnt vmcnt(0)
v_cmp_eq_u32 vcc,0,v125
s_cbranch_vccnz L_fw_15
s_add_u32 m0,s50,65536
s_nop 0
buffer_load_dwordx4 v20,s[8:11],s66 offen offset:0 sc1 lds
s_add_u32 m0,s50,69632
s_nop 0
buffer_load_dwordx4 v20,s[8:11],s67 offen offset:0 sc1 lds
s_add_u32 m0,s50,73472
s_nop 0
buffer_load_dwordx4 v20,s[8:11],s66 offen offset:256 sc1 lds
s_add_u32 m0,s50,77568
s_nop 0
buffer_load_dwordx4 v20,s[8:11],s67 offen offset:256 sc1 lds
s_add_u32 m0,s50,81408
s_nop 0
buffer_load_dwordx4 v20,s[8:11],s66 offen offset:512 sc1 lds
s_add_u32 m0,s50,85504
s_nop 0
buffer_load_dwordx4 v20,s[8:11],s67 offen offset:512 sc1 lds
s_add_u32 m0,s50,89344
s_nop 0
buffer_load_dwordx4 v20,s[8:11],s66 offen offset:768 sc1 lds
s_add_u32 m0,s50,93440
s_nop 0
buffer_load_dwordx4 v20,s[8:11],s67 offen offset:768 sc1 lds
s_lshl_b32 s58,s51,5
s_add_u32 s58,s58,s47
s_mul_i32 s58,s58,24576
s_add_u32 s58,s58,150994944
s_add_u32 s61,s58,s50
s_add_u32 s62,s61,4096
s_add_u32 s63,s61,16384
s_add_u32 s64,s61,20480
s_add_u32 s65,s61,s50
s_add_u32 s65,s65,8192
s_waitcnt vmcnt(6)
s_barrier
ds_read_b128 v[104:107],v4 offset:0
ds_read_b128 v[108:111],v4 offset:4096
ds_read_b128 v[112:115],v5 offset:0
ds_read_b128 v[116:119],v5 offset:4096
s_waitcnt lgkmcnt(2)
v_mfma_f32_16x16x32_bf16 v[24:27],a[128:131],v[104:107],0
ds_read_b128 v[120:123],v6 offset:0
v_mfma_f32_16x16x32_bf16 v[40:43],v[104:107],v[128:131],0
v_mfma_f32_16x16x32_bf16 v[28:31],a[128:131],v[108:111],0
ds_read_b128 v[124:127],v6 offset:4096
v_mfma_f32_16x16x32_bf16 v[44:47],v[108:111],v[128:131],0
v_mfma_f32_16x16x32_bf16 v[32:35],a[136:139],v[104:107],0
v_mfma_f32_16x16x32_bf16 v[48:51],v[104:107],v[136:139],0
v_mfma_f32_16x16x32_bf16 v[36:39],a[136:139],v[108:111],0
v_mfma_f32_16x16x32_bf16 v[52:55],v[108:111],v[136:139],0
s_waitcnt lgkmcnt(2)
v_mfma_f32_16x16x32_bf16 v[24:27],a[132:135],v[112:115],v[24:27]
ds_read_b128 v[104:107],v7 offset:0
v_mfma_f32_16x16x32_bf16 v[40:43],v[112:115],v[132:135],v[40:43]
v_mfma_f32_16x16x32_bf16 v[28:31],a[132:135],v[116:119],v[28:31]
ds_read_b128 v[108:111],v7 offset:4096
v_mfma_f32_16x16x32_bf16 v[44:47],v[116:119],v[132:135],v[44:47]
v_mfma_f32_16x16x32_bf16 v[32:35],a[140:143],v[112:115],v[32:35]
v_mfma_f32_16x16x32_bf16 v[48:51],v[112:115],v[140:143],v[48:51]
v_mfma_f32_16x16x32_bf16 v[36:39],a[140:143],v[116:119],v[36:39]
v_mfma_f32_16x16x32_bf16 v[52:55],v[116:119],v[140:143],v[52:55]
s_waitcnt vmcnt(4)
s_barrier
s_waitcnt lgkmcnt(2)
v_mfma_f32_16x16x32_bf16 v[24:27],a[144:147],v[120:123],v[24:27]
ds_read_b128 v[112:115],v4 offset:8192
v_mfma_f32_16x16x32_bf16 v[40:43],v[120:123],v[144:147],v[40:43]
v_mfma_f32_16x16x32_bf16 v[28:31],a[144:147],v[124:127],v[28:31]
ds_read_b128 v[116:119],v4 offset:12288
v_mfma_f32_16x16x32_bf16 v[44:47],v[124:127],v[144:147],v[44:47]
v_mfma_f32_16x16x32_bf16 v[32:35],a[152:155],v[120:123],v[32:35]
v_mfma_f32_16x16x32_bf16 v[48:51],v[120:123],v[152:155],v[48:51]
v_mfma_f32_16x16x32_bf16 v[36:39],a[152:155],v[124:127],v[36:39]
v_mfma_f32_16x16x32_bf16 v[52:55],v[124:127],v[152:155],v[52:55]
s_waitcnt lgkmcnt(2)
v_mfma_f32_16x16x32_bf16 v[24:27],a[148:151],v[104:107],v[24:27]
ds_read_b128 v[120:123],v5 offset:8192
v_mfma_f32_16x16x32_bf16 v[40:43],v[104:107],v[148:151],v[40:43]
v_mfma_f32_16x16x32_bf16 v[28:31],a[148:151],v[108:111],v[28:31]
ds_read_b128 v[124:127],v5 offset:12288
v_mfma_f32_16x16x32_bf16 v[44:47],v[108:111],v[148:151],v[44:47]
v_mfma_f32_16x16x32_bf16 v[32:35],a[156:159],v[104:107],v[32:35]
v_mfma_f32_16x16x32_bf16 v[48:51],v[104:107],v[156:159],v[48:51]
v_mfma_f32_16x16x32_bf16 v[36:39],a[156:159],v[108:111],v[36:39]
v_mfma_f32_16x16x32_bf16 v[52:55],v[108:111],v[156:159],v[52:55]
s_waitcnt lgkmcnt(2)
v_mfma_f32_16x16x32_bf16 v[24:27],a[160:163],v[112:115],v[24:27]
ds_read_b128 v[104:107],v6 offset:8192
v_mfma_f32_16x16x32_bf16 v[40:43],v[112:115],v[160:163],v[40:43]
v_mfma_f32_16x16x32_bf16 v[28:31],a[160:163],v[116:119],v[28:31]
ds_read_b128 v[108:111],v6 offset:12288
v_mfma_f32_16x16x32_bf16 v[44:47],v[116:119],v[160:163],v[44:47]
v_mfma_f32_16x16x32_bf16 v[32:35],a[168:171],v[112:115],v[32:35]
v_mfma_f32_16x16x32_bf16 v[48:51],v[112:115],v[168:171],v[48:51]
v_mfma_f32_16x16x32_bf16 v[36:39],a[168:171],v[116:119],v[36:39]
v_mfma_f32_16x16x32_bf16 v[52:55],v[116:119],v[168:171],v[52:55]
s_waitcnt lgkmcnt(2)
v_mfma_f32_16x16x32_bf16 v[24:27],a[164:167],v[120:123],v[24:27]
ds_read_b128 v[112:115],v7 offset:8192
v_mfma_f32_16x16x32_bf16 v[40:43],v[120:123],v[164:167],v[40:43]
v_mfma_f32_16x16x32_bf16 v[28:31],a[164:167],v[124:127],v[28:31]
ds_read_b128 v[116:119],v7 offset:12288
v_mfma_f32_16x16x32_bf16 v[44:47],v[124:127],v[164:167],v[44:47]
v_mfma_f32_16x16x32_bf16 v[32:35],a[172:175],v[120:123],v[32:35]
v_mfma_f32_16x16x32_bf16 v[48:51],v[120:123],v[172:175],v[48:51]
v_mfma_f32_16x16x32_bf16 v[36:39],a[172:175],v[124:127],v[36:39]
v_mfma_f32_16x16x32_bf16 v[52:55],v[124:127],v[172:175],v[52:55]
s_waitcnt vmcnt(2)
s_barrier
s_waitcnt lgkmcnt(2)
v_mfma_f32_16x16x32_bf16 v[24:27],a[176:179],v[104:107],v[24:27]
ds_read_b128 v[120:123],v4 offset:16384
v_mfma_f32_16x16x32_bf16 v[40:43],v[104:107],v[176:179],v[40:43]
v_mfma_f32_16x16x32_bf16 v[28:31],a[176:179],v[108:111],v[28:31]
ds_read_b128 v[124:127],v4 offset:20480
v_mfma_f32_16x16x32_bf16 v[44:47],v[108:111],v[176:179],v[44:47]
v_mfma_f32_16x16x32_bf16 v[32:35],a[184:187],v[104:107],v[32:35]
v_mfma_f32_16x16x32_bf16 v[48:51],v[104:107],v[184:187],v[48:51]
v_mfma_f32_16x16x32_bf16 v[36:39],a[184:187],v[108:111],v[36:39]
v_mfma_f32_16x16x32_bf16 v[52:55],v[108:111],v[184:187],v[52:55]
s_waitcnt lgkmcnt(2)
v_mfma_f32_16x16x32_bf16 v[24:27],a[180:183],v[112:115],v[24:27]
ds_read_b128 v[104:107],v5 offset:16384
v_mfma_f32_16x16x32_bf16 v[40:43],v[112:115],v[180:183],v[40:43]
v_mfma_f32_16x16x32_bf16 v[28:31],a[180:183],v[116:119],v[28:31]
ds_read_b128 v[108:111],v5 offset:20480
v_mfma_f32_16x16x32_bf16 v[44:47],v[116:119],v[180:183],v[44:47]
v_mfma_f32_16x16x32_bf16 v[32:35],a[188:191],v[112:115],v[32:35]
v_mfma_f32_16x16x32_bf16 v[48:51],v[112:115],v[188:191],v[48:51]
v_mfma_f32_16x16x32_bf16 v[36:39],a[188:191],v[116:119],v[36:39]
v_mfma_f32_16x16x32_bf16 v[52:55],v[116:119],v[188:191],v[52:55]
s_waitcnt lgkmcnt(2)
v_mfma_f32_16x16x32_bf16 v[24:27],a[192:195],v[120:123],v[24:27]
ds_read_b128 v[112:115],v6 offset:16384
v_mfma_f32_16x16x32_bf16 v[40:43],v[120:123],v[192:195],v[40:43]
v_mfma_f32_16x16x32_bf16 v[28:31],a[192:195],v[124:127],v[28:31]
ds_read_b128 v[116:119],v6 offset:20480
v_mfma_f32_16x16x32_bf16 v[44:47],v[124:127],v[192:195],v[44:47]
v_mfma_f32_16x16x32_bf16 v[32:35],a[200:203],v[120:123],v[32:35]
v_mfma_f32_16x16x32_bf16 v[48:51],v[120:123],v[200:203],v[48:51]
v_mfma_f32_16x16x32_bf16 v[36:39],a[200:203],v[124:127],v[36:39]
v_mfma_f32_16x16x32_bf16 v[52:55],v[124:127],v[200:203],v[52:55]
s_waitcnt lgkmcnt(2)
v_mfma_f32_16x16x32_bf16 v[24:27],a[196:199],v[104:107],v[24:27]
ds_read_b128 v[120:123],v7 offset:16384
v_mfma_f32_16x16x32_bf16 v[40:43],v[104:107],v[196:199],v[40:43]
v_mfma_f32_16x16x32_bf16 v[28:31],a[196:199],v[108:111],v[28:31]
ds_read_b128 v[124:127],v7 offset:20480
v_mfma_f32_16x16x32_bf16 v[44:47],v[108:111],v[196:199],v[44:47]
v_mfma_f32_16x16x32_bf16 v[32:35],a[204:207],v[104:107],v[32:35]
v_mfma_f32_16x16x32_bf16 v[48:51],v[104:107],v[204:207],v[48:51]
v_mfma_f32_16x16x32_bf16 v[36:39],a[204:207],v[108:111],v[36:39]
v_mfma_f32_16x16x32_bf16 v[52:55],v[108:111],v[204:207],v[52:55]
s_waitcnt vmcnt(0)
s_barrier
s_or_b32 s70,s70,s52
buffer_store_dword v17,off,s[8:11],s70 sc1
s_waitcnt lgkmcnt(2)
v_mfma_f32_16x16x32_bf16 v[24:27],a[208:211],v[112:115],v[24:27]
ds_read_b128 v[104:107],v4 offset:24576
v_mfma_f32_16x16x32_bf16 v[40:43],v[112:115],v[208:211],v[40:43]
s_add_u32 m0,s50,98304
v_mfma_f32_16x16x32_bf16 v[28:31],a[208:211],v[116:119],v[28:31]
ds_read_b128 v[108:111],v4 offset:28672
v_mfma_f32_16x16x32_bf16 v[44:47],v[116:119],v[208:211],v[44:47]
buffer_load_dwordx4 v20,s[8:11],s68 offen offset:0 sc1 lds
v_mfma_f32_16x16x32_bf16 v[32:35],a[216:219],v[112:115],v[32:35]
s_add_u32 m0,s50,102400
v_mfma_f32_16x16x32_bf16 v[48:51],v[112:115],v[216:219],v[48:51]
buffer_load_dwordx4 v20,s[8:11],s69 offen offset:0 sc1 lds
v_mfma_f32_16x16x32_bf16 v[36:39],a[216:219],v[116:119],v[36:39]
s_add_u32 m0,s50,106240
v_mfma_f32_16x16x32_bf16 v[52:55],v[116:119],v[216:219],v[52:55]
buffer_load_dwordx4 v20,s[8:11],s68 offen offset:256 sc1 lds
s_waitcnt lgkmcnt(2)
v_mfma_f32_16x16x32_bf16 v[24:27],a[212:215],v[120:123],v[24:27]
ds_read_b128 v[112:115],v5 offset:24576
v_mfma_f32_16x16x32_bf16 v[40:43],v[120:123],v[212:215],v[40:43]
s_add_u32 m0,s50,110336
v_mfma_f32_16x16x32_bf16 v[28:31],a[212:215],v[124:127],v[28:31]
ds_read_b128 v[116:119],v5 offset:28672
v_mfma_f32_16x16x32_bf16 v[44:47],v[124:127],v[212:215],v[44:47]
buffer_load_dwordx4 v20,s[8:11],s69 offen offset:256 sc1 lds
v_mfma_f32_16x16x32_bf16 v[32:35],a[220:223],v[120:123],v[32:35]
s_add_u32 m0,s50,114176
v_mfma_f32_16x16x32_bf16 v[48:51],v[120:123],v[220:223],v[48:51]
buffer_load_dwordx4 v20,s[8:11],s68 offen offset:512 sc1 lds
v_mfma_f32_16x16x32_bf16 v[36:39],a[220:223],v[124:127],v[36:39]
s_add_u32 m0,s50,118272
v_mfma_f32_16x16x32_bf16 v[52:55],v[124:127],v[220:223],v[52:55]
buffer_load_dwordx4 v20,s[8:11],s69 offen offset:512 sc1 lds
s_waitcnt lgkmcnt(2)
v_mfma_f32_16x16x32_bf16 v[24:27],a[224:227],v[104:107],v[24:27]
ds_read_b128 v[120:123],v6 offset:24576
v_mfma_f32_16x16x32_bf16 v[40:43],v[104:107],v[224:227],v[40:43]
s_add_u32 m0,s50,122112
v_mfma_f32_16x16x32_bf16 v[28:31],a[224:227],v[108:111],v[28:31]
ds_read_b128 v[124:127],v6 offset:28672
v_mfma_f32_16x16x32_bf16 v[44:47],v[108:111],v[224:227],v[44:47]
buffer_load_dwordx4 v20,s[8:11],s68 offen offset:768 sc1 lds
v_mfma_f32_16x16x32_bf16 v[32:35],a[232:235],v[104:107],v[32:35]
s_add_u32 m0,s50,126208
v_mfma_f32_16x16x32_bf16 v[48:51],v[104:107],v[232:235],v[48:51]
buffer_load_dwordx4 v20,s[8:11],s69 offen offset:768 sc1 lds
v_mfma_f32_16x16x32_bf16 v[36:39],a[232:235],v[108:111],v[36:39]
v_mfma_f32_16x16x32_bf16 v[52:55],v[108:111],v[232:235],v[52:55]
s_waitcnt lgkmcnt(2)
v_mfma_f32_16x16x32_bf16 v[24:27],a[228:231],v[112:115],v[24:27]
ds_read_b128 v[104:107],v7 offset:24576
v_mfma_f32_16x16x32_bf16 v[40:43],v[112:115],v[228:231],v[40:43]
v_mfma_f32_16x16x32_bf16 v[28:31],a[228:231],v[116:119],v[28:31]
ds_read_b128 v[108:111],v7 offset:28672
v_mfma_f32_16x16x32_bf16 v[44:47],v[116:119],v[228:231],v[44:47]
v_mfma_f32_16x16x32_bf16 v[32:35],a[236:239],v[112:115],v[32:35]
v_mfma_f32_16x16x32_bf16 v[48:51],v[112:115],v[236:239],v[48:51]
v_mfma_f32_16x16x32_bf16 v[36:39],a[236:239],v[116:119],v[36:39]
v_mfma_f32_16x16x32_bf16 v[52:55],v[116:119],v[236:239],v[52:55]
s_waitcnt lgkmcnt(2)
v_mfma_f32_16x16x32_bf16 v[24:27],a[240:243],v[120:123],v[24:27]
ds_read_b128 v[112:115],v4 offset:0
v_mfma_f32_16x16x32_bf16 v[40:43],v[120:123],v[240:243],v[40:43]
v_mfma_f32_16x16x32_bf16 v[28:31],a[240:243],v[124:127],v[28:31]
ds_read_b128 v[116:119],v4 offset:4096
v_mfma_f32_16x16x32_bf16 v[44:47],v[124:127],v[240:243],v[44:47]
v_mfma_f32_16x16x32_bf16 v[32:35],a[248:251],v[120:123],v[32:35]
v_mfma_f32_16x16x32_bf16 v[48:51],v[120:123],v[248:251],v[48:51]
v_mfma_f32_16x16x32_bf16 v[36:39],a[248:251],v[124:127],v[36:39]
v_mfma_f32_16x16x32_bf16 v[52:55],v[124:127],v[248:251],v[52:55]
s_waitcnt lgkmcnt(2)
v_mfma_f32_16x16x32_bf16 v[24:27],a[244:247],v[104:107],v[24:27]
ds_read_b128 v[120:123],v5 offset:0
v_mfma_f32_16x16x32_bf16 v[40:43],v[104:107],v[244:247],v[40:43]
v_mfma_f32_16x16x32_bf16 v[28:31],a[244:247],v[108:111],v[28:31]
ds_read_b128 v[124:127],v5 offset:4096
v_mfma_f32_16x16x32_bf16 v[44:47],v[108:111],v[244:247],v[44:47]
v_mfma_f32_16x16x32_bf16 v[32:35],a[252:255],v[104:107],v[32:35]
v_mfma_f32_16x16x32_bf16 v[48:51],v[104:107],v[252:255],v[48:51]
v_mfma_f32_16x16x32_bf16 v[36:39],a[252:255],v[108:111],v[36:39]
v_mfma_f32_16x16x32_bf16 v[52:55],v[108:111],v[252:255],v[52:55]
s_waitcnt lgkmcnt(2)
v_mfma_f32_16x16x32_bf16 v[88:91],a[0:3],v[112:115],0
ds_read_b128 v[104:107],v6 offset:0
v_mfma_f32_16x16x32_bf16 v[92:95],a[0:3],v[116:119],0
v_mfma_f32_16x16x32_bf16 v[96:99],a[8:11],v[112:115],0
ds_read_b128 v[108:111],v6 offset:4096
v_mfma_f32_16x16x32_bf16 v[100:103],a[8:11],v[116:119],0
s_waitcnt lgkmcnt(2)
v_mfma_f32_16x16x32_bf16 v[88:91],a[4:7],v[120:123],v[88:91]
ds_read_b128 v[112:115],v7 offset:0
v_mfma_f32_16x16x32_bf16 v[92:95],a[4:7],v[124:127],v[92:95]
v_cvt_pk_bf16_f32 v56,v24,v32
v_cvt_pk_bf16_f32 v57,v25,v33
v_mfma_f32_16x16x32_bf16 v[96:99],a[12:15],v[120:123],v[96:99]
ds_read_b128 v[116:119],v7 offset:4096
v_mfma_f32_16x16x32_bf16 v[100:103],a[12:15],v[124:127],v[100:103]
v_cvt_pk_bf16_f32 v58,v26,v34
v_cvt_pk_bf16_f32 v59,v27,v35
s_waitcnt lgkmcnt(2)
v_mfma_f32_16x16x32_bf16 v[88:91],a[16:19],v[104:107],v[88:91]
ds_read_b128 v[120:123],v4 offset:8192
v_mfma_f32_16x16x32_bf16 v[92:95],a[16:19],v[108:111],v[92:95]
buffer_store_dwordx4 v[56:59],v0,s[8:11],s61 offen sc1
v_cvt_pk_bf16_f32 v60,v28,v36
v_mfma_f32_16x16x32_bf16 v[96:99],a[24:27],v[104:107],v[96:99]
ds_read_b128 v[124:127],v4 offset:12288
v_mfma_f32_16x16x32_bf16 v[100:103],a[24:27],v[108:111],v[100:103]
v_cvt_pk_bf16_f32 v61,v29,v37
v_cvt_pk_bf16_f32 v62,v30,v38
s_waitcnt lgkmcnt(2)
v_mfma_f32_16x16x32_bf16 v[88:91],a[20:23],v[112:115],v[88:91]
ds_read_b128 v[104:107],v5 offset:8192
v_mfma_f32_16x16x32_bf16 v[92:95],a[20:23],v[116:119],v[92:95]
v_cvt_pk_bf16_f32 v63,v31,v39
buffer_store_dwordx4 v[60:63],v0,s[8:11],s62 offen sc1
v_mfma_f32_16x16x32_bf16 v[96:99],a[28:31],v[112:115],v[96:99]
ds_read_b128 v[108:111],v5 offset:12288
v_mfma_f32_16x16x32_bf16 v[100:103],a[28:31],v[116:119],v[100:103]
v_cvt_pk_bf16_f32 v64,v40,v41
v_cvt_pk_bf16_f32 v65,v42,v43
s_waitcnt lgkmcnt(2)
v_mfma_f32_16x16x32_bf16 v[88:91],a[32:35],v[120:123],v[88:91]
ds_read_b128 v[112:115],v6 offset:8192
v_mfma_f32_16x16x32_bf16 v[92:95],a[32:35],v[124:127],v[92:95]
v_cvt_pk_bf16_f32 v66,v44,v45
v_cvt_pk_bf16_f32 v67,v46,v47
v_mfma_f32_16x16x32_bf16 v[96:99],a[40:43],v[120:123],v[96:99]
ds_read_b128 v[116:119],v6 offset:12288
v_mfma_f32_16x16x32_bf16 v[100:103],a[40:43],v[124:127],v[100:103]
buffer_store_dwordx4 v[64:67],v0,s[8:11],s65 offen offset:0 sc1
v_cvt_pk_bf16_f32 v68,v48,v49
s_waitcnt lgkmcnt(2)
v_mfma_f32_16x16x32_bf16 v[88:91],a[36:39],v[104:107],v[88:91]
ds_read_b128 v[120:123],v7 offset:8192
v_mfma_f32_16x16x32_bf16 v[92:95],a[36:39],v[108:111],v[92:95]
v_cvt_pk_bf16_f32 v69,v50,v51
v_cvt_pk_bf16_f32 v70,v52,v53
v_mfma_f32_16x16x32_bf16 v[96:99],a[44:47],v[104:107],v[96:99]
ds_read_b128 v[124:127],v7 offset:12288
v_mfma_f32_16x16x32_bf16 v[100:103],a[44:47],v[108:111],v[100:103]
v_cvt_pk_bf16_f32 v71,v54,v55
buffer_store_dwordx4 v[68:71],v0,s[8:11],s65 offen offset:1024 sc1
s_waitcnt lgkmcnt(2)
v_mfma_f32_16x16x32_bf16 v[88:91],a[48:51],v[112:115],v[88:91]
ds_read_b128 v[104:107],v4 offset:16384
v_mfma_f32_16x16x32_bf16 v[92:95],a[48:51],v[116:119],v[92:95]
v_mfma_f32_16x16x32_bf16 v[96:99],a[56:59],v[112:115],v[96:99]
ds_read_b128 v[108:111],v4 offset:20480
v_mfma_f32_16x16x32_bf16 v[100:103],a[56:59],v[116:119],v[100:103]
s_waitcnt lgkmcnt(2)
v_mfma_f32_16x16x32_bf16 v[88:91],a[52:55],v[120:123],v[88:91]
ds_read_b128 v[112:115],v5 offset:16384
v_mfma_f32_16x16x32_bf16 v[92:95],a[52:55],v[124:127],v[92:95]
v_mfma_f32_16x16x32_bf16 v[96:99],a[60:63],v[120:123],v[96:99]
ds_read_b128 v[116:119],v5 offset:20480
v_mfma_f32_16x16x32_bf16 v[100:103],a[60:63],v[124:127],v[100:103]
s_waitcnt lgkmcnt(2)
v_mfma_f32_16x16x32_bf16 v[88:91],a[64:67],v[104:107],v[88:91]
ds_read_b128 v[120:123],v6 offset:16384
v_mfma_f32_16x16x32_bf16 v[92:95],a[64:67],v[108:111],v[92:95]
v_mfma_f32_16x16x32_bf16 v[96:99],a[72:75],v[104:107],v[96:99]
ds_read_b128 v[124:127],v6 offset:20480
v_mfma_f32_16x16x32_bf16 v[100:103],a[72:75],v[108:111],v[100:103]
s_waitcnt lgkmcnt(2)
v_mfma_f32_16x16x32_bf16 v[88:91],a[68:71],v[112:115],v[88:91]
ds_read_b128 v[104:107],v7 offset:16384
v_mfma_f32_16x16x32_bf16 v[92:95],a[68:71],v[116:119],v[92:95]
v_mfma_f32_16x16x32_bf16 v[96:99],a[76:79],v[112:115],v[96:99]
ds_read_b128 v[108:111],v7 offset:20480
v_mfma_f32_16x16x32_bf16 v[100:103],a[76:79],v[116:119],v[100:103]
s_waitcnt lgkmcnt(2)
v_mfma_f32_16x16x32_bf16 v[88:91],a[80:83],v[120:123],v[88:91]
ds_read_b128 v[112:115],v4 offset:24576
v_mfma_f32_16x16x32_bf16 v[92:95],a[80:83],v[124:127],v[92:95]
v_mfma_f32_16x16x32_bf16 v[96:99],a[88:91],v[120:123],v[96:99]
ds_read_b128 v[116:119],v4 offset:28672
v_mfma_f32_16x16x32_bf16 v[100:103],a[88:91],v[124:127],v[100:103]
s_waitcnt lgkmcnt(2)
v_mfma_f32_16x16x32_bf16 v[88:91],a[84:87],v[104:107],v[88:91]
ds_read_b128 v[120:123],v5 offset:24576
v_mfma_f32_16x16x32_bf16 v[92:95],a[84:87],v[108:111],v[92:95]
v_mfma_f32_16x16x32_bf16 v[96:99],a[92:95],v[104:107],v[96:99]
ds_read_b128 v[124:127],v5 offset:28672
v_mfma_f32_16x16x32_bf16 v[100:103],a[92:95],v[108:111],v[100:103]
s_waitcnt lgkmcnt(2)
v_mfma_f32_16x16x32_bf16 v[88:91],a[96:99],v[112:115],v[88:91]
ds_read_b128 v[104:107],v6 offset:24576
v_mfma_f32_16x16x32_bf16 v[92:95],a[96:99],v[116:119],v[92:95]
v_mfma_f32_16x16x32_bf16 v[96:99],a[104:107],v[112:115],v[96:99]
ds_read_b128 v[108:111],v6 offset:28672
v_mfma_f32_16x16x32_bf16 v[100:103],a[104:107],v[116:119],v[100:103]
s_waitcnt lgkmcnt(2)
v_mfma_f32_16x16x32_bf16 v[88:91],a[100:103],v[120:123],v[88:91]
ds_read_b128 v[112:115],v7 offset:24576
v_mfma_f32_16x16x32_bf16 v[92:95],a[100:103],v[124:127],v[92:95]
v_mfma_f32_16x16x32_bf16 v[96:99],a[108:111],v[120:123],v[96:99]
ds_read_b128 v[116:119],v7 offset:28672
v_mfma_f32_16x16x32_bf16 v[100:103],a[108:111],v[124:127],v[100:103]
s_waitcnt lgkmcnt(2)
v_mfma_f32_16x16x32_bf16 v[88:91],a[112:115],v[104:107],v[88:91]
v_mfma_f32_16x16x32_bf16 v[92:95],a[112:115],v[108:111],v[92:95]
v_mfma_f32_16x16x32_bf16 v[96:99],a[120:123],v[104:107],v[96:99]
v_mfma_f32_16x16x32_bf16 v[100:103],a[120:123],v[108:111],v[100:103]
s_waitcnt lgkmcnt(0)
v_mfma_f32_16x16x32_bf16 v[88:91],a[116:119],v[112:115],v[88:91]
v_mfma_f32_16x16x32_bf16 v[92:95],a[116:119],v[116:119],v[92:95]
v_mfma_f32_16x16x32_bf16 v[96:99],a[124:127],v[112:115],v[96:99]
v_mfma_f32_16x16x32_bf16 v[100:103],a[124:127],v[116:119],v[100:103]
s_nop 3
v_cvt_pk_bf16_f32 v104,v88,v96
v_cvt_pk_bf16_f32 v105,v89,v97
v_cvt_pk_bf16_f32 v106,v90,v98
v_cvt_pk_bf16_f32 v107,v91,v99
v_cvt_pk_bf16_f32 v108,v92,v100
v_cvt_pk_bf16_f32 v109,v93,v101
v_cvt_pk_bf16_f32 v110,v94,v102
v_cvt_pk_bf16_f32 v111,v95,v103
buffer_store_dwordx4 v[104:107],v0,s[8:11],s63 offen sc1
buffer_store_dwordx4 v[108:111],v0,s[8:11],s64 offen sc1
s_lshl_b32 s59,s51,13
s_lshl2_add_u32 s59,s47,s59
s_add_u32 s59,s59,10485888
s_waitcnt vmcnt(2)
s_barrier
s_or_b32 s59,s59,s52
buffer_store_dword v17,off,s[8:11],s59 sc1
s_lshl_b32 s70,s51,13
s_lshl2_add_u32 s70,s47,s70
s_add_u32 s70,s70,10486144
s_sub_u32 s56,s55,s54
s_cmp_ge_i32 s56,20
s_cbranch_scc1 L_pn_14
s_mov_b32 s51,s55
s_ff1_i32_b64 s55,s[72:73]
s_bitset0_b64 s[72:73],s55
s_min_u32 s55,s55,127
s_lshl_b32 s68,s55,15
s_add_u32 s68,s68,0
s_add_u32 s69,s68,16384
s_lshl_b32 s58,s51,5
s_add_u32 s58,s58,s47
s_mul_i32 s58,s58,24576
s_add_u32 s58,s58,100663296
s_add_u32 s61,s58,s50
s_add_u32 s62,s61,4096
s_add_u32 s63,s61,16384
s_add_u32 s64,s61,20480
s_add_u32 s65,s61,s50
s_add_u32 s65,s65,8192
ds_read_b128 v[104:107],v4 offset:32768
ds_read_b128 v[108:111],v4 offset:36864
ds_read_b128 v[112:115],v5 offset:32768
ds_read_b128 v[116:119],v5 offset:36864
s_waitcnt lgkmcnt(2)
v_mfma_f32_16x16x32_bf16 v[24:27],a[128:131],v[104:107],0
ds_read_b128 v[120:123],v6 offset:32768
v_mfma_f32_16x16x32_bf16 v[40:43],v[104:107],v[128:131],0
v_mfma_f32_16x16x32_bf16 v[28:31],a[128:131],v[108:111],0
ds_read_b128 v[124:127],v6 offset:36864
v_mfma_f32_16x16x32_bf16 v[44:47],v[108:111],v[128:131],0
v_mfma_f32_16x16x32_bf16 v[32:35],a[136:139],v[104:107],0
v_mfma_f32_16x16x32_bf16 v[48:51],v[104:107],v[136:139],0
v_mfma_f32_16x16x32_bf16 v[36:39],a[136:139],v[108:111],0
v_mfma_f32_16x16x32_bf16 v[52:55],v[108:111],v[136:139],0
s_waitcnt lgkmcnt(2)
v_mfma_f32_16x16x32_bf16 v[24:27],a[132:135],v[112:115],v[24:27]
ds_read_b128 v[104:107],v7 offset:32768
v_mfma_f32_16x16x32_bf16 v[40:43],v[112:115],v[132:135],v[40:43]
v_mfma_f32_16x16x32_bf16 v[28:31],a[132:135],v[116:119],v[28:31]
ds_read_b128 v[108:111],v7 offset:36864
v_mfma_f32_16x16x32_bf16 v[44:47],v[116:119],v[132:135],v[44:47]
v_mfma_f32_16x16x32_bf16 v[32:35],a[140:143],v[112:115],v[32:35]
v_mfma_f32_16x16x32_bf16 v[48:51],v[112:115],v[140:143],v[48:51]
v_mfma_f32_16x16x32_bf16 v[36:39],a[140:143],v[116:119],v[36:39]
v_mfma_f32_16x16x32_bf16 v[52:55],v[116:119],v[140:143],v[52:55]
s_waitcnt lgkmcnt(2)
v_mfma_f32_16x16x32_bf16 v[24:27],a[144:147],v[120:123],v[24:27]
ds_read_b128 v[112:115],v4 offset:40960
v_mfma_f32_16x16x32_bf16 v[40:43],v[120:123],v[144:147],v[40:43]
v_mfma_f32_16x16x32_bf16 v[28:31],a[144:147],v[124:127],v[28:31]
ds_read_b128 v[116:119],v4 offset:45056
v_mfma_f32_16x16x32_bf16 v[44:47],v[124:127],v[144:147],v[44:47]
v_mfma_f32_16x16x32_bf16 v[32:35],a[152:155],v[120:123],v[32:35]
v_mfma_f32_16x16x32_bf16 v[48:51],v[120:123],v[152:155],v[48:51]
v_mfma_f32_16x16x32_bf16 v[36:39],a[152:155],v[124:127],v[36:39]
v_mfma_f32_16x16x32_bf16 v[52:55],v[124:127],v[152:155],v[52:55]
s_waitcnt lgkmcnt(2)
v_mfma_f32_16x16x32_bf16 v[24:27],a[148:151],v[104:107],v[24:27]
ds_read_b128 v[120:123],v5 offset:40960
v_mfma_f32_16x16x32_bf16 v[40:43],v[104:107],v[148:151],v[40:43]
v_mfma_f32_16x16x32_bf16 v[28:31],a[148:151],v[108:111],v[28:31]
ds_read_b128 v[124:127],v5 offset:45056
v_mfma_f32_16x16x32_bf16 v[44:47],v[108:111],v[148:151],v[44:47]
v_mfma_f32_16x16x32_bf16 v[32:35],a[156:159],v[104:107],v[32:35]
v_mfma_f32_16x16x32_bf16 v[48:51],v[104:107],v[156:159],v[48:51]
v_mfma_f32_16x16x32_bf16 v[36:39],a[156:159],v[108:111],v[36:39]
v_mfma_f32_16x16x32_bf16 v[52:55],v[108:111],v[156:159],v[52:55]
s_waitcnt lgkmcnt(2)
v_mfma_f32_16x16x32_bf16 v[24:27],a[160:163],v[112:115],v[24:27]
ds_read_b128 v[104:107],v6 offset:40960
v_mfma_f32_16x16x32_bf16 v[40:43],v[112:115],v[160:163],v[40:43]
v_mfma_f32_16x16x32_bf16 v[28:31],a[160:163],v[116:119],v[28:31]
ds_read_b128 v[108:111],v6 offset:45056
v_mfma_f32_16x16x32_bf16 v[44:47],v[116:119],v[160:163],v[44:47]
v_mfma_f32_16x16x32_bf16 v[32:35],a[168:171],v[112:115],v[32:35]
v_mfma_f32_16x16x32_bf16 v[48:51],v[112:115],v[168:171],v[48:51]
v_mfma_f32_16x16x32_bf16 v[36:39],a[168:171],v[116:119],v[36:39]
v_mfma_f32_16x16x32_bf16 v[52:55],v[116:119],v[168:171],v[52:55]
s_waitcnt lgkmcnt(2)
v_mfma_f32_16x16x32_bf16 v[24:27],a[164:167],v[120:123],v[24:27]
ds_read_b128 v[112:115],v7 offset:40960
v_mfma_f32_16x16x32_bf16 v[40:43],v[120:123],v[164:167],v[40:43]
v_mfma_f32_16x16x32_bf16 v[28:31],a[164:167],v[124:127],v[28:31]
ds_read_b128 v[116:119],v7 offset:45056
v_mfma_f32_16x16x32_bf16 v[44:47],v[124:127],v[164:167],v[44:47]
v_mfma_f32_16x16x32_bf16 v[32:35],a[172:175],v[120:123],v[32:35]
v_mfma_f32_16x16x32_bf16 v[48:51],v[120:123],v[172:175],v[48:51]
v_mfma_f32_16x16x32_bf16 v[36:39],a[172:175],v[124:127],v[36:39]
v_mfma_f32_16x16x32_bf16 v[52:55],v[124:127],v[172:175],v[52:55]
s_waitcnt lgkmcnt(2)
v_mfma_f32_16x16x32_bf16 v[24:27],a[176:179],v[104:107],v[24:27]
ds_read_b128 v[120:123],v4 offset:49152
v_mfma_f32_16x16x32_bf16 v[40:43],v[104:107],v[176:179],v[40:43]
v_mfma_f32_16x16x32_bf16 v[28:31],a[176:179],v[108:111],v[28:31]
ds_read_b128 v[124:127],v4 offset:53248
v_mfma_f32_16x16x32_bf16 v[44:47],v[108:111],v[176:179],v[44:47]
v_mfma_f32_16x16x32_bf16 v[32:35],a[184:187],v[104:107],v[32:35]
v_mfma_f32_16x16x32_bf16 v[48:51],v[104:107],v[184:187],v[48:51]
v_mfma_f32_16x16x32_bf16 v[36:39],a[184:187],v[108:111],v[36:39]
v_mfma_f32_16x16x32_bf16 v[52:55],v[108:111],v[184:187],v[52:55]
s_waitcnt lgkmcnt(2)
v_mfma_f32_16x16x32_bf16 v[24:27],a[180:183],v[112:115],v[24:27]
ds_read_b128 v[104:107],v5 offset:49152
v_mfma_f32_16x16x32_bf16 v[40:43],v[112:115],v[180:183],v[40:43]
v_mfma_f32_16x16x32_bf16 v[28:31],a[180:183],v[116:119],v[28:31]
ds_read_b128 v[108:111],v5 offset:53248
v_mfma_f32_16x16x32_bf16 v[44:47],v[116:119],v[180:183],v[44:47]
v_mfma_f32_16x16x32_bf16 v[32:35],a[188:191],v[112:115],v[32:35]
v_mfma_f32_16x16x32_bf16 v[48:51],v[112:115],v[188:191],v[48:51]
v_mfma_f32_16x16x32_bf16 v[36:39],a[188:191],v[116:119],v[36:39]
v_mfma_f32_16x16x32_bf16 v[52:55],v[116:119],v[188:191],v[52:55]
s_waitcnt lgkmcnt(2)
v_mfma_f32_16x16x32_bf16 v[24:27],a[192:195],v[120:123],v[24:27]
ds_read_b128 v[112:115],v6 offset:49152
v_mfma_f32_16x16x32_bf16 v[40:43],v[120:123],v[192:195],v[40:43]
v_mfma_f32_16x16x32_bf16 v[28:31],a[192:195],v[124:127],v[28:31]
ds_read_b128 v[116:119],v6 offset:53248
v_mfma_f32_16x16x32_bf16 v[44:47],v[124:127],v[192:195],v[44:47]
v_mfma_f32_16x16x32_bf16 v[32:35],a[200:203],v[120:123],v[32:35]
v_mfma_f32_16x16x32_bf16 v[48:51],v[120:123],v[200:203],v[48:51]
v_mfma_f32_16x16x32_bf16 v[36:39],a[200:203],v[124:127],v[36:39]
v_mfma_f32_16x16x32_bf16 v[52:55],v[124:127],v[200:203],v[52:55]
s_waitcnt lgkmcnt(2)
v_mfma_f32_16x16x32_bf16 v[24:27],a[196:199],v[104:107],v[24:27]
ds_read_b128 v[120:123],v7 offset:49152
v_mfma_f32_16x16x32_bf16 v[40:43],v[104:107],v[196:199],v[40:43]
v_mfma_f32_16x16x32_bf16 v[28:31],a[196:199],v[108:111],v[28:31]
ds_read_b128 v[124:127],v7 offset:53248
v_mfma_f32_16x16x32_bf16 v[44:47],v[108:111],v[196:199],v[44:47]
v_mfma_f32_16x16x32_bf16 v[32:35],a[204:207],v[104:107],v[32:35]
v_mfma_f32_16x16x32_bf16 v[48:51],v[104:107],v[204:207],v[48:51]
v_mfma_f32_16x16x32_bf16 v[36:39],a[204:207],v[108:111],v[36:39]
v_mfma_f32_16x16x32_bf16 v[52:55],v[108:111],v[204:207],v[52:55]
s_waitcnt vmcnt(0)
s_barrier
s_or_b32 s70,s70,s52
buffer_store_dword v17,off,s[8:11],s70 sc1
s_waitcnt lgkmcnt(2)
v_mfma_f32_16x16x32_bf16 v[24:27],a[208:211],v[112:115],v[24:27]
ds_read_b128 v[104:107],v4 offset:57344
v_mfma_f32_16x16x32_bf16 v[40:43],v[112:115],v[208:211],v[40:43]
s_lshl_b32 s56,s51,5
v_mfma_f32_16x16x32_bf16 v[28:31],a[208:211],v[116:119],v[28:31]
ds_read_b128 v[108:111],v4 offset:61440
v_mfma_f32_16x16x32_bf16 v[44:47],v[116:119],v[208:211],v[44:47]
s_add_u32 s56,s56,s47
v_mfma_f32_16x16x32_bf16 v[32:35],a[216:219],v[112:115],v[32:35]
s_lshl_b32 s56,s56,13
v_mfma_f32_16x16x32_bf16 v[48:51],v[112:115],v[216:219],v[48:51]
s_add_u32 s56,s56,s50
v_mfma_f32_16x16x32_bf16 v[36:39],a[216:219],v[116:119],v[36:39]
s_add_u32 s56,s56,41943040
v_mfma_f32_16x16x32_bf16 v[52:55],v[116:119],v[216:219],v[52:55]
s_add_u32 s57,s56,4096
s_waitcnt lgkmcnt(2)
v_mfma_f32_16x16x32_bf16 v[24:27],a[212:215],v[120:123],v[24:27]
ds_read_b128 v[112:115],v5 offset:57344
v_mfma_f32_16x16x32_bf16 v[40:43],v[120:123],v[212:215],v[40:43]
v_mov_b64 v[72:73],-1
v_mfma_f32_16x16x32_bf16 v[28:31],a[212:215],v[124:127],v[28:31]
ds_read_b128 v[116:119],v5 offset:61440
v_mfma_f32_16x16x32_bf16 v[44:47],v[124:127],v[212:215],v[44:47]
v_mov_b64 v[74:75],-1
v_mfma_f32_16x16x32_bf16 v[32:35],a[220:223],v[120:123],v[32:35]
buffer_store_dwordx4 v[72:75],v0,s[8:11],s56 offen sc1
v_mfma_f32_16x16x32_bf16 v[48:51],v[120:123],v[220:223],v[48:51]
buffer_store_dwordx4 v[72:75],v0,s[8:11],s57 offen sc1
v_mfma_f32_16x16x32_bf16 v[36:39],a[220:223],v[124:127],v[36:39]
v_mfma_f32_16x16x32_bf16 v[52:55],v[124:127],v[220:223],v[52:55]
s_waitcnt lgkmcnt(2)
v_mfma_f32_16x16x32_bf16 v[24:27],a[224:227],v[104:107],v[24:27]
ds_read_b128 v[120:123],v6 offset:57344
v_mfma_f32_16x16x32_bf16 v[40:43],v[104:107],v[224:227],v[40:43]
v_mfma_f32_16x16x32_bf16 v[28:31],a[224:227],v[108:111],v[28:31]
ds_read_b128 v[124:127],v6 offset:61440
v_mfma_f32_16x16x32_bf16 v[44:47],v[108:111],v[224:227],v[44:47]
v_mfma_f32_16x16x32_bf16 v[32:35],a[232:235],v[104:107],v[32:35]
v_mfma_f32_16x16x32_bf16 v[48:51],v[104:107],v[232:235],v[48:51]
v_mfma_f32_16x16x32_bf16 v[36:39],a[232:235],v[108:111],v[36:39]
v_mfma_f32_16x16x32_bf16 v[52:55],v[108:111],v[232:235],v[52:55]
s_waitcnt lgkmcnt(2)
v_mfma_f32_16x16x32_bf16 v[24:27],a[228:231],v[112:115],v[24:27]
ds_read_b128 v[104:107],v7 offset:57344
v_mfma_f32_16x16x32_bf16 v[40:43],v[112:115],v[228:231],v[40:43]
v_mfma_f32_16x16x32_bf16 v[28:31],a[228:231],v[116:119],v[28:31]
ds_read_b128 v[108:111],v7 offset:61440
v_mfma_f32_16x16x32_bf16 v[44:47],v[116:119],v[228:231],v[44:47]
v_mfma_f32_16x16x32_bf16 v[32:35],a[236:239],v[112:115],v[32:35]
v_mfma_f32_16x16x32_bf16 v[48:51],v[112:115],v[236:239],v[48:51]
v_mfma_f32_16x16x32_bf16 v[36:39],a[236:239],v[116:119],v[36:39]
v_mfma_f32_16x16x32_bf16 v[52:55],v[116:119],v[236:239],v[52:55]
s_waitcnt lgkmcnt(2)
v_mfma_f32_16x16x32_bf16 v[24:27],a[240:243],v[120:123],v[24:27]
ds_read_b128 v[112:115],v4 offset:32768
v_mfma_f32_16x16x32_bf16 v[40:43],v[120:123],v[240:243],v[40:43]
v_mfma_f32_16x16x32_bf16 v[28:31],a[240:243],v[124:127],v[28:31]
ds_read_b128 v[116:119],v4 offset:36864
v_mfma_f32_16x16x32_bf16 v[44:47],v[124:127],v[240:243],v[44:47]
v_mfma_f32_16x16x32_bf16 v[32:35],a[248:251],v[120:123],v[32:35]
v_mfma_f32_16x16x32_bf16 v[48:51],v[120:123],v[248:251],v[48:51]
v_mfma_f32_16x16x32_bf16 v[36:39],a[248:251],v[124:127],v[36:39]
v_mfma_f32_16x16x32_bf16 v[52:55],v[124:127],v[248:251],v[52:55]
s_waitcnt lgkmcnt(2)
v_mfma_f32_16x16x32_bf16 v[24:27],a[244:247],v[104:107],v[24:27]
ds_read_b128 v[120:123],v5 offset:32768
v_mfma_f32_16x16x32_bf16 v[40:43],v[104:107],v[244:247],v[40:43]
v_mfma_f32_16x16x32_bf16 v[28:31],a[244:247],v[108:111],v[28:31]
ds_read_b128 v[124:127],v5 offset:36864
v_mfma_f32_16x16x32_bf16 v[44:47],v[108:111],v[244:247],v[44:47]
v_mfma_f32_16x16x32_bf16 v[32:35],a[252:255],v[104:107],v[32:35]
v_mfma_f32_16x16x32_bf16 v[48:51],v[104:107],v[252:255],v[48:51]
v_mfma_f32_16x16x32_bf16 v[36:39],a[252:255],v[108:111],v[36:39]
v_mfma_f32_16x16x32_bf16 v[52:55],v[108:111],v[252:255],v[52:55]
s_waitcnt lgkmcnt(2)
v_mfma_f32_16x16x32_bf16 v[88:91],a[0:3],v[112:115],0
ds_read_b128 v[104:107],v6 offset:32768
v_mfma_f32_16x16x32_bf16 v[92:95],a[0:3],v[116:119],0
v_mfma_f32_16x16x32_bf16 v[96:99],a[8:11],v[112:115],0
ds_read_b128 v[108:111],v6 offset:36864
v_mfma_f32_16x16x32_bf16 v[100:103],a[8:11],v[116:119],0
s_waitcnt lgkmcnt(2)
v_mfma_f32_16x16x32_bf16 v[88:91],a[4:7],v[120:123],v[88:91]
ds_read_b128 v[112:115],v7 offset:32768
v_mfma_f32_16x16x32_bf16 v[92:95],a[4:7],v[124:127],v[92:95]
v_cvt_pk_bf16_f32 v56,v24,v32
v_cvt_pk_bf16_f32 v57,v25,v33
v_mfma_f32_16x16x32_bf16 v[96:99],a[12:15],v[120:123],v[96:99]
ds_read_b128 v[116:119],v7 offset:36864
v_mfma_f32_16x16x32_bf16 v[100:103],a[12:15],v[124:127],v[100:103]
v_cvt_pk_bf16_f32 v58,v26,v34
v_cvt_pk_bf16_f32 v59,v27,v35
s_waitcnt lgkmcnt(2)
v_mfma_f32_16x16x32_bf16 v[88:91],a[16:19],v[104:107],v[88:91]
ds_read_b128 v[120:123],v4 offset:40960
v_mfma_f32_16x16x32_bf16 v[92:95],a[16:19],v[108:111],v[92:95]
buffer_store_dwordx4 v[56:59],v0,s[8:11],s61 offen sc1
v_cvt_pk_bf16_f32 v60,v28,v36
v_mfma_f32_16x16x32_bf16 v[96:99],a[24:27],v[104:107],v[96:99]
ds_read_b128 v[124:127],v4 offset:45056
v_mfma_f32_16x16x32_bf16 v[100:103],a[24:27],v[108:111],v[100:103]
v_cvt_pk_bf16_f32 v61,v29,v37
v_cvt_pk_bf16_f32 v62,v30,v38
s_waitcnt lgkmcnt(2)
v_mfma_f32_16x16x32_bf16 v[88:91],a[20:23],v[112:115],v[88:91]
ds_read_b128 v[104:107],v5 offset:40960
v_mfma_f32_16x16x32_bf16 v[92:95],a[20:23],v[116:119],v[92:95]
v_cvt_pk_bf16_f32 v63,v31,v39
buffer_store_dwordx4 v[60:63],v0,s[8:11],s62 offen sc1
v_mfma_f32_16x16x32_bf16 v[96:99],a[28:31],v[112:115],v[96:99]
ds_read_b128 v[108:111],v5 offset:45056
v_mfma_f32_16x16x32_bf16 v[100:103],a[28:31],v[116:119],v[100:103]
v_cvt_pk_bf16_f32 v64,v40,v41
v_cvt_pk_bf16_f32 v65,v42,v43
s_waitcnt lgkmcnt(2)
v_mfma_f32_16x16x32_bf16 v[88:91],a[32:35],v[120:123],v[88:91]
ds_read_b128 v[112:115],v6 offset:40960
v_mfma_f32_16x16x32_bf16 v[92:95],a[32:35],v[124:127],v[92:95]
v_cvt_pk_bf16_f32 v66,v44,v45
v_cvt_pk_bf16_f32 v67,v46,v47
v_mfma_f32_16x16x32_bf16 v[96:99],a[40:43],v[120:123],v[96:99]
ds_read_b128 v[116:119],v6 offset:45056
v_mfma_f32_16x16x32_bf16 v[100:103],a[40:43],v[124:127],v[100:103]
buffer_store_dwordx4 v[64:67],v0,s[8:11],s65 offen offset:0 sc1
v_cvt_pk_bf16_f32 v68,v48,v49
s_waitcnt lgkmcnt(2)
v_mfma_f32_16x16x32_bf16 v[88:91],a[36:39],v[104:107],v[88:91]
ds_read_b128 v[120:123],v7 offset:40960
v_mfma_f32_16x16x32_bf16 v[92:95],a[36:39],v[108:111],v[92:95]
v_cvt_pk_bf16_f32 v69,v50,v51
v_cvt_pk_bf16_f32 v70,v52,v53
v_mfma_f32_16x16x32_bf16 v[96:99],a[44:47],v[104:107],v[96:99]
ds_read_b128 v[124:127],v7 offset:45056
v_mfma_f32_16x16x32_bf16 v[100:103],a[44:47],v[108:111],v[100:103]
v_cvt_pk_bf16_f32 v71,v54,v55
buffer_store_dwordx4 v[68:71],v0,s[8:11],s65 offen offset:1024 sc1
s_waitcnt lgkmcnt(2)
v_mfma_f32_16x16x32_bf16 v[88:91],a[48:51],v[112:115],v[88:91]
ds_read_b128 v[104:107],v4 offset:49152
v_mfma_f32_16x16x32_bf16 v[92:95],a[48:51],v[116:119],v[92:95]
v_mfma_f32_16x16x32_bf16 v[96:99],a[56:59],v[112:115],v[96:99]
ds_read_b128 v[108:111],v4 offset:53248
v_mfma_f32_16x16x32_bf16 v[100:103],a[56:59],v[116:119],v[100:103]
s_waitcnt lgkmcnt(2)
v_mfma_f32_16x16x32_bf16 v[88:91],a[52:55],v[120:123],v[88:91]
ds_read_b128 v[112:115],v5 offset:49152
v_mfma_f32_16x16x32_bf16 v[92:95],a[52:55],v[124:127],v[92:95]
v_mfma_f32_16x16x32_bf16 v[96:99],a[60:63],v[120:123],v[96:99]
ds_read_b128 v[116:119],v5 offset:53248
v_mfma_f32_16x16x32_bf16 v[100:103],a[60:63],v[124:127],v[100:103]
s_waitcnt lgkmcnt(2)
v_mfma_f32_16x16x32_bf16 v[88:91],a[64:67],v[104:107],v[88:91]
ds_read_b128 v[120:123],v6 offset:49152
v_mfma_f32_16x16x32_bf16 v[92:95],a[64:67],v[108:111],v[92:95]
v_mfma_f32_16x16x32_bf16 v[96:99],a[72:75],v[104:107],v[96:99]
ds_read_b128 v[124:127],v6 offset:53248
v_mfma_f32_16x16x32_bf16 v[100:103],a[72:75],v[108:111],v[100:103]
s_waitcnt lgkmcnt(2)
v_mfma_f32_16x16x32_bf16 v[88:91],a[68:71],v[112:115],v[88:91]
ds_read_b128 v[104:107],v7 offset:49152
v_mfma_f32_16x16x32_bf16 v[92:95],a[68:71],v[116:119],v[92:95]
v_mfma_f32_16x16x32_bf16 v[96:99],a[76:79],v[112:115],v[96:99]
ds_read_b128 v[108:111],v7 offset:53248
v_mfma_f32_16x16x32_bf16 v[100:103],a[76:79],v[116:119],v[100:103]
s_waitcnt lgkmcnt(2)
v_mfma_f32_16x16x32_bf16 v[88:91],a[80:83],v[120:123],v[88:91]
ds_read_b128 v[112:115],v4 offset:57344
v_mfma_f32_16x16x32_bf16 v[92:95],a[80:83],v[124:127],v[92:95]
v_mfma_f32_16x16x32_bf16 v[96:99],a[88:91],v[120:123],v[96:99]
ds_read_b128 v[116:119],v4 offset:61440
v_mfma_f32_16x16x32_bf16 v[100:103],a[88:91],v[124:127],v[100:103]
s_waitcnt lgkmcnt(2)
v_mfma_f32_16x16x32_bf16 v[88:91],a[84:87],v[104:107],v[88:91]
ds_read_b128 v[120:123],v5 offset:57344
v_mfma_f32_16x16x32_bf16 v[92:95],a[84:87],v[108:111],v[92:95]
v_mfma_f32_16x16x32_bf16 v[96:99],a[92:95],v[104:107],v[96:99]
ds_read_b128 v[124:127],v5 offset:61440
v_mfma_f32_16x16x32_bf16 v[100:103],a[92:95],v[108:111],v[100:103]
s_waitcnt lgkmcnt(2)
v_mfma_f32_16x16x32_bf16 v[88:91],a[96:99],v[112:115],v[88:91]
ds_read_b128 v[104:107],v6 offset:57344
v_mfma_f32_16x16x32_bf16 v[92:95],a[96:99],v[116:119],v[92:95]
v_mfma_f32_16x16x32_bf16 v[96:99],a[104:107],v[112:115],v[96:99]
ds_read_b128 v[108:111],v6 offset:61440
v_mfma_f32_16x16x32_bf16 v[100:103],a[104:107],v[116:119],v[100:103]
s_waitcnt lgkmcnt(2)
v_mfma_f32_16x16x32_bf16 v[88:91],a[100:103],v[120:123],v[88:91]
ds_read_b128 v[112:115],v7 offset:57344
v_mfma_f32_16x16x32_bf16 v[92:95],a[100:103],v[124:127],v[92:95]
v_mfma_f32_16x16x32_bf16 v[96:99],a[108:111],v[120:123],v[96:99]
ds_read_b128 v[116:119],v7 offset:61440
v_mfma_f32_16x16x32_bf16 v[100:103],a[108:111],v[124:127],v[100:103]
s_waitcnt lgkmcnt(2)
v_mfma_f32_16x16x32_bf16 v[88:91],a[112:115],v[104:107],v[88:91]
v_mfma_f32_16x16x32_bf16 v[92:95],a[112:115],v[108:111],v[92:95]
v_mfma_f32_16x16x32_bf16 v[96:99],a[120:123],v[104:107],v[96:99]
v_mfma_f32_16x16x32_bf16 v[100:103],a[120:123],v[108:111],v[100:103]
s_waitcnt lgkmcnt(0)
v_mfma_f32_16x16x32_bf16 v[88:91],a[116:119],v[112:115],v[88:91]
v_mfma_f32_16x16x32_bf16 v[92:95],a[116:119],v[116:119],v[92:95]
v_mfma_f32_16x16x32_bf16 v[96:99],a[124:127],v[112:115],v[96:99]
v_mfma_f32_16x16x32_bf16 v[100:103],a[124:127],v[116:119],v[100:103]
s_nop 3
v_cvt_pk_bf16_f32 v104,v88,v96
v_cvt_pk_bf16_f32 v105,v89,v97
v_cvt_pk_bf16_f32 v106,v90,v98
v_cvt_pk_bf16_f32 v107,v91,v99
v_cvt_pk_bf16_f32 v108,v92,v100
v_cvt_pk_bf16_f32 v109,v93,v101
v_cvt_pk_bf16_f32 v110,v94,v102
v_cvt_pk_bf16_f32 v111,v95,v103
buffer_store_dwordx4 v[104:107],v0,s[8:11],s63 offen sc1
buffer_store_dwordx4 v[108:111],v0,s[8:11],s64 offen sc1
s_waitcnt vmcnt(6)
s_barrier
s_lshl_b32 s70,s51,13
s_lshl2_add_u32 s70,s47,s70
s_add_u32 s70,s70,10485760
L_pn_14:
s_add_u32 s54,s54,2
s_cmp_lt_u32 s54,64
s_cbranch_scc1 L_pl_13
s_waitcnt vmcnt(0)
s_barrier
s_or_b32 s70,s70,s52
buffer_store_dword v17,off,s[8:11],s70 sc1
s_endpgm
L_rm_5:
v_and_b32 v33,15,v1
v_lshrrev_b32 v34,4,v1
s_min_u32 s60,s47,27
s_lshl_b32 s60,s60,7
s_mul_i32 s59,s46,458752
s_add_u32 s60,s60,s59
v_mul_u32_u24 v36,114688,v34
v_and_b32 v35,7,v33
v_lshl_add_u32 v36,v35,4,v36
v_add_u32 v36,s60,v36
v_cmp_gt_u32 vcc,8,v33
v_mov_b32 v38,s36
v_mov_b32 v39,s37
v_mov_b32 v40,s34
v_mov_b32 v41,s35
v_cndmask_b32 v38,v38,v40,vcc
v_cndmask_b32 v39,v39,v41,vcc
v_add_co_u32 v38,vcc,v38,v36
s_nop 1
v_addc_co_u32 v39,vcc,0,v39,vcc
s_lshl_b32 s56,s46,15
v_add_u32 v37,s56,v0
global_load_dwordx4 v[44:47],v[38:39],off
v_add_co_u32 v38,vcc,3584,v38
s_nop 1
v_addc_co_u32 v39,vcc,0,v39,vcc
global_load_dwordx4 v[48:51],v[38:39],off
v_add_co_u32 v38,vcc,3584,v38
s_nop 1
v_addc_co_u32 v39,vcc,0,v39,vcc
global_load_dwordx4 v[52:55],v[38:39],off
v_add_co_u32 v38,vcc,3584,v38
s_nop 1
v_addc_co_u32 v39,vcc,0,v39,vcc
global_load_dwordx4 v[56:59],v[38:39],off
v_add_co_u32 v38,vcc,3584,v38
s_nop 1
v_addc_co_u32 v39,vcc,0,v39,vcc
global_load_dwordx4 v[60:63],v[38:39],off
v_add_co_u32 v38,vcc,3584,v38
s_nop 1
v_addc_co_u32 v39,vcc,0,v39,vcc
global_load_dwordx4 v[64:67],v[38:39],off
v_add_co_u32 v38,vcc,3584,v38
s_nop 1
v_addc_co_u32 v39,vcc,0,v39,vcc
global_load_dwordx4 v[68:71],v[38:39],off
v_add_co_u32 v38,vcc,3584,v38
s_nop 1
v_addc_co_u32 v39,vcc,0,v39,vcc
global_load_dwordx4 v[72:75],v[38:39],off
v_add_co_u32 v38,vcc,3584,v38
s_nop 1
v_addc_co_u32 v39,vcc,0,v39,vcc
global_load_dwordx4 v[76:79],v[38:39],off
v_add_co_u32 v38,vcc,3584,v38
s_nop 1
v_addc_co_u32 v39,vcc,0,v39,vcc
global_load_dwordx4 v[80:83],v[38:39],off
v_add_co_u32 v38,vcc,3584,v38
s_nop 1
v_addc_co_u32 v39,vcc,0,v39,vcc
global_load_dwordx4 v[84:87],v[38:39],off
v_add_co_u32 v38,vcc,3584,v38
s_nop 1
v_addc_co_u32 v39,vcc,0,v39,vcc
global_load_dwordx4 v[88:91],v[38:39],off
v_add_co_u32 v38,vcc,3584,v38
s_nop 1
v_addc_co_u32 v39,vcc,0,v39,vcc
global_load_dwordx4 v[92:95],v[38:39],off
v_add_co_u32 v38,vcc,3584,v38
s_nop 1
v_addc_co_u32 v39,vcc,0,v39,vcc
global_load_dwordx4 v[96:99],v[38:39],off
v_add_co_u32 v38,vcc,3584,v38
s_nop 1
v_addc_co_u32 v39,vcc,0,v39,vcc
global_load_dwordx4 v[100:103],v[38:39],off
v_add_co_u32 v38,vcc,3584,v38
s_nop 1
v_addc_co_u32 v39,vcc,0,v39,vcc
global_load_dwordx4 v[104:107],v[38:39],off
v_add_co_u32 v38,vcc,3584,v38
s_nop 1
v_addc_co_u32 v39,vcc,0,v39,vcc
s_waitcnt vmcnt(15)
ds_write_b128 v37,v[44:47] offset:0
s_waitcnt vmcnt(14)
ds_write_b128 v37,v[48:51] offset:1024
s_waitcnt vmcnt(13)
ds_write_b128 v37,v[52:55] offset:2048
s_waitcnt vmcnt(12)
ds_write_b128 v37,v[56:59] offset:3072
s_waitcnt vmcnt(11)
ds_write_b128 v37,v[60:63] offset:4096
s_waitcnt vmcnt(10)
ds_write_b128 v37,v[64:67] offset:5120
s_waitcnt vmcnt(9)
ds_write_b128 v37,v[68:71] offset:6144
s_waitcnt vmcnt(8)
ds_write_b128 v37,v[72:75] offset:7168
s_waitcnt lgkmcnt(0)
s_waitcnt vmcnt(7)
ds_write_b128 v37,v[76:79] offset:8192
s_waitcnt vmcnt(6)
ds_write_b128 v37,v[80:83] offset:9216
s_waitcnt vmcnt(5)
ds_write_b128 v37,v[84:87] offset:10240
s_waitcnt vmcnt(4)
ds_write_b128 v37,v[88:91] offset:11264
s_waitcnt vmcnt(3)
ds_write_b128 v37,v[92:95] offset:12288
s_waitcnt vmcnt(2)
ds_write_b128 v37,v[96:99] offset:13312
s_waitcnt vmcnt(1)
ds_write_b128 v37,v[100:103] offset:14336
s_waitcnt vmcnt(0)
ds_write_b128 v37,v[104:107] offset:15360
s_waitcnt lgkmcnt(0)
global_load_dwordx4 v[44:47],v[38:39],off
v_add_co_u32 v38,vcc,3584,v38
s_nop 1
v_addc_co_u32 v39,vcc,0,v39,vcc
global_load_dwordx4 v[48:51],v[38:39],off
v_add_co_u32 v38,vcc,3584,v38
s_nop 1
v_addc_co_u32 v39,vcc,0,v39,vcc
global_load_dwordx4 v[52:55],v[38:39],off
v_add_co_u32 v38,vcc,3584,v38
s_nop 1
v_addc_co_u32 v39,vcc,0,v39,vcc
global_load_dwordx4 v[56:59],v[38:39],off
v_add_co_u32 v38,vcc,3584,v38
s_nop 1
v_addc_co_u32 v39,vcc,0,v39,vcc
global_load_dwordx4 v[60:63],v[38:39],off
v_add_co_u32 v38,vcc,3584,v38
s_nop 1
v_addc_co_u32 v39,vcc,0,v39,vcc
global_load_dwordx4 v[64:67],v[38:39],off
v_add_co_u32 v38,vcc,3584,v38
s_nop 1
v_addc_co_u32 v39,vcc,0,v39,vcc
global_load_dwordx4 v[68:71],v[38:39],off
v_add_co_u32 v38,vcc,3584,v38
s_nop 1
v_addc_co_u32 v39,vcc,0,v39,vcc
global_load_dwordx4 v[72:75],v[38:39],off
v_add_co_u32 v38,vcc,3584,v38
s_nop 1
v_addc_co_u32 v39,vcc,0,v39,vcc
global_load_dwordx4 v[76:79],v[38:39],off
v_add_co_u32 v38,vcc,3584,v38
s_nop 1
v_addc_co_u32 v39,vcc,0,v39,vcc
global_load_dwordx4 v[80:83],v[38:39],off
v_add_co_u32 v38,vcc,3584,v38
s_nop 1
v_addc_co_u32 v39,vcc,0,v39,vcc
global_load_dwordx4 v[84:87],v[38:39],off
v_add_co_u32 v38,vcc,3584,v38
s_nop 1
v_addc_co_u32 v39,vcc,0,v39,vcc
global_load_dwordx4 v[88:91],v[38:39],off
v_add_co_u32 v38,vcc,3584,v38
s_nop 1
v_addc_co_u32 v39,vcc,0,v39,vcc
global_load_dwordx4 v[92:95],v[38:39],off
v_add_co_u32 v38,vcc,3584,v38
s_nop 1
v_addc_co_u32 v39,vcc,0,v39,vcc
global_load_dwordx4 v[96:99],v[38:39],off
v_add_co_u32 v38,vcc,3584,v38
s_nop 1
v_addc_co_u32 v39,vcc,0,v39,vcc
global_load_dwordx4 v[100:103],v[38:39],off
v_add_co_u32 v38,vcc,3584,v38
s_nop 1
v_addc_co_u32 v39,vcc,0,v39,vcc
global_load_dwordx4 v[104:107],v[38:39],off
v_add_co_u32 v38,vcc,3584,v38
s_nop 1
v_addc_co_u32 v39,vcc,0,v39,vcc
s_waitcnt vmcnt(15)
ds_write_b128 v37,v[44:47] offset:16384
s_waitcnt vmcnt(14)
ds_write_b128 v37,v[48:51] offset:17408
s_waitcnt vmcnt(13)
ds_write_b128 v37,v[52:55] offset:18432
s_waitcnt vmcnt(12)
ds_write_b128 v37,v[56:59] offset:19456
s_waitcnt vmcnt(11)
ds_write_b128 v37,v[60:63] offset:20480
s_waitcnt vmcnt(10)
ds_write_b128 v37,v[64:67] offset:21504
s_waitcnt vmcnt(9)
ds_write_b128 v37,v[68:71] offset:22528
s_waitcnt vmcnt(8)
ds_write_b128 v37,v[72:75] offset:23552
s_waitcnt lgkmcnt(0)
s_waitcnt vmcnt(7)
ds_write_b128 v37,v[76:79] offset:24576
s_waitcnt vmcnt(6)
ds_write_b128 v37,v[80:83] offset:25600
s_waitcnt vmcnt(5)
ds_write_b128 v37,v[84:87] offset:26624
s_waitcnt vmcnt(4)
ds_write_b128 v37,v[88:91] offset:27648
s_waitcnt vmcnt(3)
ds_write_b128 v37,v[92:95] offset:28672
s_waitcnt vmcnt(2)
ds_write_b128 v37,v[96:99] offset:29696
s_waitcnt vmcnt(1)
ds_write_b128 v37,v[100:103] offset:30720
s_waitcnt vmcnt(0)
ds_write_b128 v37,v[104:107] offset:31744
s_waitcnt lgkmcnt(0)
v_mov_b32 v123,159744
s_cmp_lg_u32 s46,0
s_cbranch_scc1 L_gbd_17
v_mov_b32 v124,128
L_gb_16:
buffer_load_dword v125,v124,s[12:15],0 offen sc1
s_waitcnt vmcnt(0)
v_readfirstlane_b32 s56,v125
ds_write_b32 v123,v125
s_bitcmp1_b32 s56,8
s_cbranch_scc1 L_gbd_17
s_sleep 4
s_sub_u32 s49,s49,1
s_cmp_gt_i32 s49,0
s_cbranch_scc1 L_gb_16
s_branch L_abort
L_gbd_17:
s_waitcnt lgkmcnt(0)
s_barrier
ds_read_b32 v125,v123
s_waitcnt lgkmcnt(0)
v_readfirstlane_b32 s56,v125
s_barrier
s_lshr_b32 s56,s56,16
s_andn2_b32 s56,s56,s3
s_cbranch_scc1 L_spread
s_cmp_lg_u32 s3,0
s_cbranch_scc1 L_wm
v_and_b32 v120,15,v1
v_lshrrev_b32 v121,4,v1
v_mov_b32 v17,1
s_lshl_b32 s56,s46,15
v_add_u32 v18,s56,v0
s_lshl_b32 s56,s46,2
v_add_u32 v125,s56,v121
v_xor_b32 v126,v125,v120
v_lshlrev_b32 v126,4,v126
v_lshl_add_u32 v20,v125,10,v126
v_add_u32 v125,0,v121
v_xor_b32 v125,v125,v120
v_lshlrev_b32 v125,4,v125
v_lshl_add_u32 v125,v120,8,v125
v_add_u32 v4,131072,v125
v_add_u32 v125,4,v121
v_xor_b32 v125,v125,v120
v_lshlrev_b32 v125,4,v125
v_lshl_add_u32 v125,v120,8,v125
v_add_u32 v5,131072,v125
v_add_u32 v125,8,v121
v_xor_b32 v125,v125,v120
v_lshlrev_b32 v125,4,v125
v_lshl_add_u32 v125,v120,8,v125
v_add_u32 v6,131072,v125
v_add_u32 v125,12,v121
v_xor_b32 v125,v125,v120
v_lshlrev_b32 v125,4,v125
v_lshl_add_u32 v125,v120,8,v125
v_add_u32 v7,131072,v125
v_lshlrev_b32 v21,5,v120
v_and_b32 v125,1,v121
v_lshl_add_u32 v21,v125,4,v21
s_lshl_b32 s56,s46,9
v_lshrrev_b32 v125,1,v121
v_lshl_add_u32 v21,v125,11,v21
s_add_u32 s56,s56,155648
v_add_u32 v21,s56,v21
v_lshlrev_b32 v22,4,v120
v_lshl_add_u32 v22,v121,10,v22
s_lshl_b32 s56,s46,8
v_add_u32 v22,s56,v22
s_mov_b32 s54,0
s_mov_b32 s31,0
s_mov_b32 s53,3
s_mov_b32 s72,0x80000000
s_mov_b32 s73,0
s_mov_b32 s77,-1
s_mov_b64 s[84:85],0
s_mov_b32 s74,614203392
s_mov_b32 s75,1227133513
s_ff1_i32_b64 s30,s[74:75]
s_bitset0_b64 s[74:75],s30
s_min_u32 s30,s30,127
s_lshl_b32 s70,s30,15
s_add_u32 s70,s70,0
s_add_u32 s71,s70,16384
s_add_u32 m0,s50,131072
s_nop 0
buffer_load_dwordx4 v20,s[8:11],s70 offen offset:0 sc1 lds
s_add_u32 m0,s50,135168
s_nop 0
buffer_load_dwordx4 v20,s[8:11],s71 offen offset:0 sc1 lds
s_add_u32 m0,s50,139008
s_nop 0
buffer_load_dwordx4 v20,s[8:11],s70 offen offset:256 sc1 lds
s_add_u32 m0,s50,143104
s_nop 0
buffer_load_dwordx4 v20,s[8:11],s71 offen offset:256 sc1 lds
s_add_u32 m0,s50,146944
s_nop 0
buffer_load_dwordx4 v20,s[8:11],s70 offen offset:512 sc1 lds
s_add_u32 m0,s50,151040
s_nop 0
buffer_load_dwordx4 v20,s[8:11],s71 offen offset:512 sc1 lds
v_and_b32 v23,31,v1
v_lshlrev_b32 v23,2,v23
s_waitcnt vmcnt(0)
L_mo_19:
s_mov_b32 s51,s30
s_mov_b64 s[68:69],s[70:71]
s_ff1_i32_b64 s30,s[74:75]
s_bitset0_b64 s[74:75],s30
s_min_u32 s30,s30,127
s_lshl_b32 s70,s30,15
s_add_u32 s70,s70,0
s_add_u32 s71,s70,16384
s_lshl_b32 s76,s31,13
s_add_u32 s76,s76,10487168
s_lshl_b32 s58,s51,5
s_add_u32 s58,s58,s47
s_mul_i32 s58,s58,24576
s_add_u32 s58,s58,100663296
s_add_u32 s61,s58,s50
s_add_u32 s62,s61,4096
s_add_u32 s63,s61,16384
s_add_u32 s64,s61,20480
s_add_u32 s65,s61,s50
s_add_u32 s65,s65,8192
s_waitcnt vmcnt(13)
s_barrier
ds_read_b128 v[72:75],v4 offset:0
ds_read_b128 v[76:79],v4 offset:4096
ds_read_b128 v[80:83],v5 offset:0
ds_read_b128 v[84:87],v5 offset:4096
s_add_u32 m0,s50,154880
s_nop 0
buffer_load_dwordx4 v20,s[8:11],s68 offen offset:768 sc1 lds
s_add_u32 m0,s50,158976
s_nop 0
buffer_load_dwordx4 v20,s[8:11],s69 offen offset:768 sc1 lds
s_waitcnt lgkmcnt(2)
v_mfma_f32_16x16x32_bf16 v[40:43],a[128:131],v[72:75],0
ds_read_b128 v[108:111],v6 offset:0
v_mfma_f32_16x16x32_bf16 v[56:59],v[72:75],v[128:131],0
v_mfma_f32_16x16x32_bf16 v[24:27],a[0:3],v[72:75],0
ds_read_b128 v[112:115],v6 offset:4096
v_mfma_f32_16x16x32_bf16 v[44:47],a[128:131],v[76:79],0
v_mfma_f32_16x16x32_bf16 v[60:63],v[76:79],v[128:131],0
v_mfma_f32_16x16x32_bf16 v[28:31],a[0:3],v[76:79],0
v_mfma_f32_16x16x32_bf16 v[48:51],a[136:139],v[72:75],0
v_mfma_f32_16x16x32_bf16 v[64:67],v[72:75],v[136:139],0
v_mfma_f32_16x16x32_bf16 v[32:35],a[8:11],v[72:75],0
v_mfma_f32_16x16x32_bf16 v[52:55],a[136:139],v[76:79],0
v_mfma_f32_16x16x32_bf16 v[68:71],v[76:79],v[136:139],0
v_mfma_f32_16x16x32_bf16 v[36:39],a[8:11],v[76:79],0
s_waitcnt lgkmcnt(2)
v_mfma_f32_16x16x32_bf16 v[40:43],a[132:135],v[80:83],v[40:43]
ds_read_b128 v[72:75],v7 offset:0
v_mfma_f32_16x16x32_bf16 v[56:59],v[80:83],v[132:135],v[56:59]
v_mfma_f32_16x16x32_bf16 v[24:27],a[4:7],v[80:83],v[24:27]
ds_read_b128 v[76:79],v7 offset:4096
v_mfma_f32_16x16x32_bf16 v[44:47],a[132:135],v[84:87],v[44:47]
v_mfma_f32_16x16x32_bf16 v[60:63],v[84:87],v[132:135],v[60:63]
v_mfma_f32_16x16x32_bf16 v[28:31],a[4:7],v[84:87],v[28:31]
v_mfma_f32_16x16x32_bf16 v[48:51],a[140:143],v[80:83],v[48:51]
v_mfma_f32_16x16x32_bf16 v[64:67],v[80:83],v[140:143],v[64:67]
v_mfma_f32_16x16x32_bf16 v[32:35],a[12:15],v[80:83],v[32:35]
v_mfma_f32_16x16x32_bf16 v[52:55],a[140:143],v[84:87],v[52:55]
v_mfma_f32_16x16x32_bf16 v[68:71],v[84:87],v[140:143],v[68:71]
v_mfma_f32_16x16x32_bf16 v[36:39],a[12:15],v[84:87],v[36:39]
s_waitcnt vmcnt(13)
s_barrier
s_waitcnt lgkmcnt(2)
v_mfma_f32_16x16x32_bf16 v[40:43],a[144:147],v[108:111],v[40:43]
ds_read_b128 v[80:83],v4 offset:8192
v_mfma_f32_16x16x32_bf16 v[56:59],v[108:111],v[144:147],v[56:59]
v_mfma_f32_16x16x32_bf16 v[24:27],a[16:19],v[108:111],v[24:27]
ds_read_b128 v[84:87],v4 offset:12288
v_mfma_f32_16x16x32_bf16 v[44:47],a[144:147],v[112:115],v[44:47]
v_mfma_f32_16x16x32_bf16 v[60:63],v[112:115],v[144:147],v[60:63]
v_mfma_f32_16x16x32_bf16 v[28:31],a[16:19],v[112:115],v[28:31]
v_mfma_f32_16x16x32_bf16 v[48:51],a[152:155],v[108:111],v[48:51]
v_mfma_f32_16x16x32_bf16 v[64:67],v[108:111],v[152:155],v[64:67]
v_mfma_f32_16x16x32_bf16 v[32:35],a[24:27],v[108:111],v[32:35]
v_mfma_f32_16x16x32_bf16 v[52:55],a[152:155],v[112:115],v[52:55]
v_mfma_f32_16x16x32_bf16 v[68:71],v[112:115],v[152:155],v[68:71]
v_mfma_f32_16x16x32_bf16 v[36:39],a[24:27],v[112:115],v[36:39]
s_waitcnt lgkmcnt(2)
v_mfma_f32_16x16x32_bf16 v[40:43],a[148:151],v[72:75],v[40:43]
ds_read_b128 v[108:111],v5 offset:8192
v_mfma_f32_16x16x32_bf16 v[56:59],v[72:75],v[148:151],v[56:59]
v_mfma_f32_16x16x32_bf16 v[24:27],a[20:23],v[72:75],v[24:27]
ds_read_b128 v[112:115],v5 offset:12288
v_mfma_f32_16x16x32_bf16 v[44:47],a[148:151],v[76:79],v[44:47]
v_mfma_f32_16x16x32_bf16 v[60:63],v[76:79],v[148:151],v[60:63]
v_mfma_f32_16x16x32_bf16 v[28:31],a[20:23],v[76:79],v[28:31]
v_mfma_f32_16x16x32_bf16 v[48:51],a[156:159],v[72:75],v[48:51]
v_mfma_f32_16x16x32_bf16 v[64:67],v[72:75],v[156:159],v[64:67]
v_mfma_f32_16x16x32_bf16 v[32:35],a[28:31],v[72:75],v[32:35]
v_mfma_f32_16x16x32_bf16 v[52:55],a[156:159],v[76:79],v[52:55]
v_mfma_f32_16x16x32_bf16 v[68:71],v[76:79],v[156:159],v[68:71]
v_mfma_f32_16x16x32_bf16 v[36:39],a[28:31],v[76:79],v[36:39]
s_waitcnt lgkmcnt(2)
v_mfma_f32_16x16x32_bf16 v[40:43],a[160:163],v[80:83],v[40:43]
ds_read_b128 v[72:75],v6 offset:8192
v_mfma_f32_16x16x32_bf16 v[56:59],v[80:83],v[160:163],v[56:59]
v_mfma_f32_16x16x32_bf16 v[24:27],a[32:35],v[80:83],v[24:27]
ds_read_b128 v[76:79],v6 offset:12288
v_mfma_f32_16x16x32_bf16 v[44:47],a[160:163],v[84:87],v[44:47]
v_mfma_f32_16x16x32_bf16 v[60:63],v[84:87],v[160:163],v[60:63]
v_mfma_f32_16x16x32_bf16 v[28:31],a[32:35],v[84:87],v[28:31]
v_mfma_f32_16x16x32_bf16 v[48:51],a[168:171],v[80:83],v[48:51]
v_mfma_f32_16x16x32_bf16 v[64:67],v[80:83],v[168:171],v[64:67]
v_mfma_f32_16x16x32_bf16 v[32:35],a[40:43],v[80:83],v[32:35]
v_mfma_f32_16x16x32_bf16 v[52:55],a[168:171],v[84:87],v[52:55]
v_mfma_f32_16x16x32_bf16 v[68:71],v[84:87],v[168:171],v[68:71]
v_mfma_f32_16x16x32_bf16 v[36:39],a[40:43],v[84:87],v[36:39]
s_waitcnt lgkmcnt(2)
v_mfma_f32_16x16x32_bf16 v[40:43],a[164:167],v[108:111],v[40:43]
ds_read_b128 v[80:83],v7 offset:8192
v_mfma_f32_16x16x32_bf16 v[56:59],v[108:111],v[164:167],v[56:59]
v_mfma_f32_16x16x32_bf16 v[24:27],a[36:39],v[108:111],v[24:27]
ds_read_b128 v[84:87],v7 offset:12288
v_mfma_f32_16x16x32_bf16 v[44:47],a[164:167],v[112:115],v[44:47]
v_mfma_f32_16x16x32_bf16 v[60:63],v[112:115],v[164:167],v[60:63]
v_mfma_f32_16x16x32_bf16 v[28:31],a[36:39],v[112:115],v[28:31]
v_mfma_f32_16x16x32_bf16 v[48:51],a[172:175],v[108:111],v[48:51]
v_mfma_f32_16x16x32_bf16 v[64:67],v[108:111],v[172:175],v[64:67]
v_mfma_f32_16x16x32_bf16 v[32:35],a[44:47],v[108:111],v[32:35]
v_mfma_f32_16x16x32_bf16 v[52:55],a[172:175],v[112:115],v[52:55]
v_mfma_f32_16x16x32_bf16 v[68:71],v[112:115],v[172:175],v[68:71]
v_mfma_f32_16x16x32_bf16 v[36:39],a[44:47],v[112:115],v[36:39]
s_waitcnt vmcnt(11)
s_barrier
s_waitcnt lgkmcnt(2)
v_mfma_f32_16x16x32_bf16 v[40:43],a[176:179],v[72:75],v[40:43]
ds_read_b128 v[108:111],v4 offset:16384
v_mfma_f32_16x16x32_bf16 v[56:59],v[72:75],v[176:179],v[56:59]
v_mfma_f32_16x16x32_bf16 v[24:27],a[48:51],v[72:75],v[24:27]
ds_read_b128 v[112:115],v4 offset:20480
v_mfma_f32_16x16x32_bf16 v[44:47],a[176:179],v[76:79],v[44:47]
v_mfma_f32_16x16x32_bf16 v[60:63],v[76:79],v[176:179],v[60:63]
v_mfma_f32_16x16x32_bf16 v[28:31],a[48:51],v[76:79],v[28:31]
v_mfma_f32_16x16x32_bf16 v[48:51],a[184:187],v[72:75],v[48:51]
v_mfma_f32_16x16x32_bf16 v[64:67],v[72:75],v[184:187],v[64:67]
v_mfma_f32_16x16x32_bf16 v[32:35],a[56:59],v[72:75],v[32:35]
v_mfma_f32_16x16x32_bf16 v[52:55],a[184:187],v[76:79],v[52:55]
v_mfma_f32_16x16x32_bf16 v[68:71],v[76:79],v[184:187],v[68:71]
v_mfma_f32_16x16x32_bf16 v[36:39],a[56:59],v[76:79],v[36:39]
s_waitcnt vmcnt(2)
s_barrier
s_or_b32 s72,s72,s52
buffer_store_dword v17,off,s[8:11],s72 sc1
s_waitcnt lgkmcnt(2)
v_mfma_f32_16x16x32_bf16 v[40:43],a[180:183],v[80:83],v[40:43]
ds_read_b128 v[72:75],v5 offset:16384
v_mfma_f32_16x16x32_bf16 v[56:59],v[80:83],v[180:183],v[56:59]
v_mfma_f32_16x16x32_bf16 v[24:27],a[52:55],v[80:83],v[24:27]
ds_read_b128 v[76:79],v5 offset:20480
v_mfma_f32_16x16x32_bf16 v[44:47],a[180:183],v[84:87],v[44:47]
v_mfma_f32_16x16x32_bf16 v[60:63],v[84:87],v[180:183],v[60:63]
v_mfma_f32_16x16x32_bf16 v[28:31],a[52:55],v[84:87],v[28:31]
v_mfma_f32_16x16x32_bf16 v[48:51],a[188:191],v[80:83],v[48:51]
v_mfma_f32_16x16x32_bf16 v[64:67],v[80:83],v[188:191],v[64:67]
v_mfma_f32_16x16x32_bf16 v[32:35],a[60:63],v[80:83],v[32:35]
v_mfma_f32_16x16x32_bf16 v[52:55],a[188:191],v[84:87],v[52:55]
v_mfma_f32_16x16x32_bf16 v[68:71],v[84:87],v[188:191],v[68:71]
v_mfma_f32_16x16x32_bf16 v[36:39],a[60:63],v[84:87],v[36:39]
s_waitcnt lgkmcnt(2)
v_mfma_f32_16x16x32_bf16 v[40:43],a[192:195],v[108:111],v[40:43]
ds_read_b128 v[80:83],v6 offset:16384
v_mfma_f32_16x16x32_bf16 v[56:59],v[108:111],v[192:195],v[56:59]
v_mfma_f32_16x16x32_bf16 v[24:27],a[64:67],v[108:111],v[24:27]
ds_read_b128 v[84:87],v6 offset:20480
v_mfma_f32_16x16x32_bf16 v[44:47],a[192:195],v[112:115],v[44:47]
v_mfma_f32_16x16x32_bf16 v[60:63],v[112:115],v[192:195],v[60:63]
v_mfma_f32_16x16x32_bf16 v[28:31],a[64:67],v[112:115],v[28:31]
v_mfma_f32_16x16x32_bf16 v[48:51],a[200:203],v[108:111],v[48:51]
v_mfma_f32_16x16x32_bf16 v[64:67],v[108:111],v[200:203],v[64:67]
v_mfma_f32_16x16x32_bf16 v[32:35],a[72:75],v[108:111],v[32:35]
v_mfma_f32_16x16x32_bf16 v[52:55],a[200:203],v[112:115],v[52:55]
v_mfma_f32_16x16x32_bf16 v[68:71],v[112:115],v[200:203],v[68:71]
v_mfma_f32_16x16x32_bf16 v[36:39],a[72:75],v[112:115],v[36:39]
s_waitcnt lgkmcnt(2)
v_mfma_f32_16x16x32_bf16 v[40:43],a[196:199],v[72:75],v[40:43]
ds_read_b128 v[108:111],v7 offset:16384
v_mfma_f32_16x16x32_bf16 v[56:59],v[72:75],v[196:199],v[56:59]
v_mfma_f32_16x16x32_bf16 v[24:27],a[68:71],v[72:75],v[24:27]
ds_read_b128 v[112:115],v7 offset:20480
v_mfma_f32_16x16x32_bf16 v[44:47],a[196:199],v[76:79],v[44:47]
v_mfma_f32_16x16x32_bf16 v[60:63],v[76:79],v[196:199],v[60:63]
v_mfma_f32_16x16x32_bf16 v[28:31],a[68:71],v[76:79],v[28:31]
v_mfma_f32_16x16x32_bf16 v[48:51],a[204:207],v[72:75],v[48:51]
v_mfma_f32_16x16x32_bf16 v[64:67],v[72:75],v[204:207],v[64:67]
v_mfma_f32_16x16x32_bf16 v[32:35],a[76:79],v[72:75],v[32:35]
v_mfma_f32_16x16x32_bf16 v[52:55],a[204:207],v[76:79],v[52:55]
v_mfma_f32_16x16x32_bf16 v[68:71],v[76:79],v[204:207],v[68:71]
v_mfma_f32_16x16x32_bf16 v[36:39],a[76:79],v[76:79],v[36:39]
s_waitcnt vmcnt(1)
s_barrier
s_waitcnt lgkmcnt(2)
v_mfma_f32_16x16x32_bf16 v[40:43],a[208:211],v[80:83],v[40:43]
ds_read_b128 v[72:75],v4 offset:24576
v_mfma_f32_16x16x32_bf16 v[56:59],v[80:83],v[208:211],v[56:59]
v_mfma_f32_16x16x32_bf16 v[24:27],a[80:83],v[80:83],v[24:27]
ds_read_b128 v[76:79],v4 offset:28672
v_mfma_f32_16x16x32_bf16 v[44:47],a[208:211],v[84:87],v[44:47]
v_mfma_f32_16x16x32_bf16 v[60:63],v[84:87],v[208:211],v[60:63]
v_mfma_f32_16x16x32_bf16 v[28:31],a[80:83],v[84:87],v[28:31]
v_mfma_f32_16x16x32_bf16 v[48:51],a[216:219],v[80:83],v[48:51]
v_mfma_f32_16x16x32_bf16 v[64:67],v[80:83],v[216:219],v[64:67]
v_mfma_f32_16x16x32_bf16 v[32:35],a[88:91],v[80:83],v[32:35]
v_mfma_f32_16x16x32_bf16 v[52:55],a[216:219],v[84:87],v[52:55]
v_mfma_f32_16x16x32_bf16 v[68:71],v[84:87],v[216:219],v[68:71]
v_mfma_f32_16x16x32_bf16 v[36:39],a[88:91],v[84:87],v[36:39]
s_waitcnt lgkmcnt(2)
v_mfma_f32_16x16x32_bf16 v[40:43],a[212:215],v[108:111],v[40:43]
ds_read_b128 v[80:83],v5 offset:24576
v_mfma_f32_16x16x32_bf16 v[56:59],v[108:111],v[212:215],v[56:59]
v_mfma_f32_16x16x32_bf16 v[24:27],a[84:87],v[108:111],v[24:27]
ds_read_b128 v[84:87],v5 offset:28672
v_mfma_f32_16x16x32_bf16 v[44:47],a[212:215],v[112:115],v[44:47]
v_mfma_f32_16x16x32_bf16 v[60:63],v[112:115],v[212:215],v[60:63]
v_mfma_f32_16x16x32_bf16 v[28:31],a[84:87],v[112:115],v[28:31]
v_mfma_f32_16x16x32_bf16 v[48:51],a[220:223],v[108:111],v[48:51]
v_mfma_f32_16x16x32_bf16 v[64:67],v[108:111],v[220:223],v[64:67]
v_mfma_f32_16x16x32_bf16 v[32:35],a[92:95],v[108:111],v[32:35]
v_mfma_f32_16x16x32_bf16 v[52:55],a[220:223],v[112:115],v[52:55]
v_mfma_f32_16x16x32_bf16 v[68:71],v[112:115],v[220:223],v[68:71]
v_mfma_f32_16x16x32_bf16 v[36:39],a[92:95],v[112:115],v[36:39]
s_barrier
s_waitcnt lgkmcnt(2)
v_mfma_f32_16x16x32_bf16 v[40:43],a[224:227],v[72:75],v[40:43]
ds_read_b128 v[108:111],v6 offset:24576
v_mfma_f32_16x16x32_bf16 v[56:59],v[72:75],v[224:227],v[56:59]
s_add_u32 m0,s50,131072
v_mfma_f32_16x16x32_bf16 v[24:27],a[96:99],v[72:75],v[24:27]
ds_read_b128 v[112:115],v6 offset:28672
v_mfma_f32_16x16x32_bf16 v[44:47],a[224:227],v[76:79],v[44:47]
buffer_load_dwordx4 v20,s[8:11],s70 offen offset:0 sc1 lds
v_mfma_f32_16x16x32_bf16 v[60:63],v[76:79],v[224:227],v[60:63]
s_add_u32 m0,s50,135168
v_mfma_f32_16x16x32_bf16 v[28:31],a[96:99],v[76:79],v[28:31]
buffer_load_dwordx4 v20,s[8:11],s71 offen offset:0 sc1 lds
v_mfma_f32_16x16x32_bf16 v[48:51],a[232:235],v[72:75],v[48:51]
s_add_u32 m0,s50,139008
v_mfma_f32_16x16x32_bf16 v[64:67],v[72:75],v[232:235],v[64:67]
buffer_load_dwordx4 v20,s[8:11],s70 offen offset:256 sc1 lds
v_mfma_f32_16x16x32_bf16 v[32:35],a[104:107],v[72:75],v[32:35]
s_add_u32 m0,s50,143104
v_mfma_f32_16x16x32_bf16 v[52:55],a[232:235],v[76:79],v[52:55]
buffer_load_dwordx4 v20,s[8:11],s71 offen offset:256 sc1 lds
v_mfma_f32_16x16x32_bf16 v[68:71],v[76:79],v[232:235],v[68:71]
s_add_u32 m0,s50,146944
v_mfma_f32_16x16x32_bf16 v[36:39],a[104:107],v[76:79],v[36:39]
buffer_load_dwordx4 v20,s[8:11],s70 offen offset:512 sc1 lds
s_waitcnt lgkmcnt(2)
v_mfma_f32_16x16x32_bf16 v[40:43],a[228:231],v[80:83],v[40:43]
ds_read_b128 v[72:75],v7 offset:24576
v_mfma_f32_16x16x32_bf16 v[56:59],v[80:83],v[228:231],v[56:59]
s_add_u32 m0,s50,151040
v_mfma_f32_16x16x32_bf16 v[24:27],a[100:103],v[80:83],v[24:27]
ds_read_b128 v[76:79],v7 offset:28672
v_mfma_f32_16x16x32_bf16 v[44:47],a[228:231],v[84:87],v[44:47]
buffer_load_dwordx4 v20,s[8:11],s71 offen offset:512 sc1 lds
v_mfma_f32_16x16x32_bf16 v[60:63],v[84:87],v[228:231],v[60:63]
buffer_load_dword v125,v23,s[8:11],s76 offen sc1
v_mfma_f32_16x16x32_bf16 v[28:31],a[100:103],v[84:87],v[28:31]
v_mfma_f32_16x16x32_bf16 v[48:51],a[236:239],v[80:83],v[48:51]
v_mfma_f32_16x16x32_bf16 v[64:67],v[80:83],v[236:239],v[64:67]
v_mfma_f32_16x16x32_bf16 v[32:35],a[108:111],v[80:83],v[32:35]
v_mfma_f32_16x16x32_bf16 v[52:55],a[236:239],v[84:87],v[52:55]
v_mfma_f32_16x16x32_bf16 v[68:71],v[84:87],v[236:239],v[68:71]
v_mfma_f32_16x16x32_bf16 v[36:39],a[108:111],v[84:87],v[36:39]
s_waitcnt lgkmcnt(2)
v_mfma_f32_16x16x32_bf16 v[40:43],a[240:243],v[108:111],v[40:43]
v_mfma_f32_16x16x32_bf16 v[56:59],v[108:111],v[240:243],v[56:59]
v_mfma_f32_16x16x32_bf16 v[24:27],a[112:115],v[108:111],v[24:27]
v_mfma_f32_16x16x32_bf16 v[44:47],a[240:243],v[112:115],v[44:47]
v_mfma_f32_16x16x32_bf16 v[60:63],v[112:115],v[240:243],v[60:63]
v_mfma_f32_16x16x32_bf16 v[28:31],a[112:115],v[112:115],v[28:31]
v_mfma_f32_16x16x32_bf16 v[48:51],a[248:251],v[108:111],v[48:51]
v_mfma_f32_16x16x32_bf16 v[64:67],v[108:111],v[248:251],v[64:67]
v_mfma_f32_16x16x32_bf16 v[32:35],a[120:123],v[108:111],v[32:35]
v_mfma_f32_16x16x32_bf16 v[52:55],a[248:251],v[112:115],v[52:55]
v_mfma_f32_16x16x32_bf16 v[68:71],v[112:115],v[248:251],v[68:71]
v_mfma_f32_16x16x32_bf16 v[36:39],a[120:123],v[112:115],v[36:39]
s_waitcnt lgkmcnt(0)
v_mfma_f32_16x16x32_bf16 v[40:43],a[244:247],v[72:75],v[40:43]
v_mfma_f32_16x16x32_bf16 v[56:59],v[72:75],v[244:247],v[56:59]
v_mfma_f32_16x16x32_bf16 v[24:27],a[116:119],v[72:75],v[24:27]
v_mfma_f32_16x16x32_bf16 v[44:47],a[244:247],v[76:79],v[44:47]
v_mfma_f32_16x16x32_bf16 v[60:63],v[76:79],v[244:247],v[60:63]
v_mfma_f32_16x16x32_bf16 v[28:31],a[116:119],v[76:79],v[28:31]
v_mfma_f32_16x16x32_bf16 v[48:51],a[252:255],v[72:75],v[48:51]
v_mfma_f32_16x16x32_bf16 v[64:67],v[72:75],v[252:255],v[64:67]
v_mfma_f32_16x16x32_bf16 v[32:35],a[124:127],v[72:75],v[32:35]
v_mfma_f32_16x16x32_bf16 v[52:55],a[252:255],v[76:79],v[52:55]
v_mfma_f32_16x16x32_bf16 v[68:71],v[76:79],v[252:255],v[68:71]
v_mfma_f32_16x16x32_bf16 v[36:39],a[124:127],v[76:79],v[36:39]
s_lshl_b32 s56,s51,5
s_add_u32 s56,s56,s47
s_lshl_b32 s56,s56,13
s_add_u32 s56,s56,s50
s_add_u32 s56,s56,41943040
s_add_u32 s57,s56,4096
v_mov_b64 v[120:121],-1
v_mov_b64 v[122:123],-1
buffer_store_dwordx4 v[120:123],v0,s[8:11],s56 offen sc1
buffer_store_dwordx4 v[120:123],v0,s[8:11],s57 offen sc1
v_cvt_pk_bf16_f32 v72,v40,v48
v_cvt_pk_bf16_f32 v73,v41,v49
v_cvt_pk_bf16_f32 v74,v42,v50
v_cvt_pk_bf16_f32 v75,v43,v51
buffer_store_dwordx4 v[72:75],v0,s[8:11],s61 offen sc1
v_cvt_pk_bf16_f32 v76,v44,v52
v_cvt_pk_bf16_f32 v77,v45,v53
v_cvt_pk_bf16_f32 v78,v46,v54
v_cvt_pk_bf16_f32 v79,v47,v55
buffer_store_dwordx4 v[76:79],v0,s[8:11],s62 offen sc1
v_cvt_pk_bf16_f32 v80,v56,v57
v_cvt_pk_bf16_f32 v81,v58,v59
v_cvt_pk_bf16_f32 v82,v60,v61
v_cvt_pk_bf16_f32 v83,v62,v63
buffer_store_dwordx4 v[80:83],v0,s[8:11],s65 offen offset:0 sc1
v_cvt_pk_bf16_f32 v84,v64,v65
v_cvt_pk_bf16_f32 v85,v66,v67
v_cvt_pk_bf16_f32 v86,v68,v69
v_cvt_pk_bf16_f32 v87,v70,v71
buffer_store_dwordx4 v[84:87],v0,s[8:11],s65 offen offset:1024 sc1
v_cvt_pk_bf16_f32 v108,v24,v32
v_cvt_pk_bf16_f32 v109,v25,v33
v_cvt_pk_bf16_f32 v110,v26,v34
v_cvt_pk_bf16_f32 v111,v27,v35
buffer_store_dwordx4 v[108:111],v0,s[8:11],s63 offen sc1
v_cvt_pk_bf16_f32 v112,v28,v36
v_cvt_pk_bf16_f32 v113,v29,v37
v_cvt_pk_bf16_f32 v114,v30,v38
v_cvt_pk_bf16_f32 v115,v31,v39
buffer_store_dwordx4 v[112:115],v0,s[8:11],s64 offen sc1
s_lshl_b32 s72,s51,13
s_lshl2_add_u32 s72,s47,s72
s_add_u32 s72,s72,10485760
s_sub_u32 s53,s53,1
s_cmp_gt_i32 s53,0
s_cbranch_scc1 L_mo_19
s_add_u32 s73,s73,1
s_waitcnt vmcnt(8)
v_cmp_eq_u32 vcc,0,v125
s_cbranch_vccz L_mo_21
L_mo_18:
s_lshl_b32 s59,s31,13
s_add_u32 s59,s59,10487168
v_and_b32 v124,31,v1
v_lshlrev_b32 v124,2,v124
L_fw_26:
buffer_load_dword v125,v124,s[8:11],s59 offen sc1
s_sub_u32 s49,s49,1
s_cbranch_scc1 L_abort
s_waitcnt vmcnt(0)
v_cmp_eq_u32 vcc,0,v125
s_cbranch_vccnz L_fw_26
L_mo_21:
v_max_u32_dpp v125,v125,v125 row_ror:8 row_mask:0xf bank_mask:0xf
s_nop 1
v_max_u32_dpp v125,v125,v125 row_ror:4 row_mask:0xf bank_mask:0xf
s_nop 1
v_max_u32_dpp v125,v125,v125 row_ror:2 row_mask:0xf bank_mask:0xf
s_nop 1
v_max_u32_dpp v125,v125,v125 row_ror:1 row_mask:0xf bank_mask:0xf
v_mov_b32 v124,v125
s_nop 1
v_permlane16_swap_b32 v125,v124
v_max_u32 v125,v125,v124
v_mov_b32 v124,v125
s_nop 1
v_permlane32_swap_b32 v125,v124
v_max_u32 v125,v125,v124
s_nop 0
v_readfirstlane_b32 s55,v125
s_sub_u32 s73,s73,1
s_max_i32 s73,s73,0
s_sub_u32 s77,s77,1
s_min_u32 s61,s73,3
s_cmp_gt_u32 s55,s54
s_cselect_b32 s60,2,1
s_cselect_b32 s77,s61,s77
s_cselect_b32 s54,s55,s54
s_cbranch_scc0 L_mo_24
s_bitset1_b64 s[84:85],s31
L_mo_24:
s_cmp_lg_u32 s31,63
s_cbranch_scc1 L_mo_25
s_min_i32 s77,s77,0
s_lshr_b64 s[88:89],s[84:85],1
s_lshr_b64 s[90:91],s[84:85],2
s_or_b64 s[88:89],s[88:89],s[90:91]
s_lshr_b64 s[90:91],s[84:85],3
s_or_b64 s[88:89],s[88:89],s[90:91]
s_lshr_b64 s[90:91],s[84:85],4
s_or_b64 s[88:89],s[88:89],s[90:91]
s_or_b32 s88,s88,268435455
s_or_b32 s89,s89,0
s_flbit_i32_b64 s61,s[84:85]
s_sub_u32 s61,63,s61
s_bfm_b64 s[90:91],s61,0
s_xor_b64 s[84:85],s[88:89],s[90:91]
s_or_b32 s84,s84,0
s_or_b32 s85,s85,4286578688
L_mo_25:
s_or_b32 s61,s47,s46
s_cmp_lg_u32 s61,0
s_cbranch_scc1 L_mo_20
v_mov_b32 v125,s60
s_lshl_b32 s59,s31,13
s_add_u32 s59,s59,10487040
buffer_store_dword v125,off,s[8:11],s59 sc1
s_cmp_lg_u32 s31,63
s_cbranch_scc1 L_mo_20
s_and_b32 s62,s54,0x7ff
s_sub_u32 s62,2048,s62
v_mov_b32 v120,s62
s_lshr_b64 s[88:89],s[84:85],0
s_and_b32 s88,s88,0x3fffff
s_bitset1_b32 s88,31
v_mov_b32 v121,s88
s_lshr_b64 s[88:89],s[84:85],22
s_and_b32 s88,s88,0x3fffff
s_bitset1_b32 s88,31
v_mov_b32 v122,s88
s_lshr_b64 s[88:89],s[84:85],44
s_and_b32 s88,s88,0x3fffff
s_bitset1_b32 s88,31
v_mov_b32 v123,s88
s_mov_b32 s59,11011712
buffer_store_dwordx4 v[120:123],off,s[8:11],s59 sc1
L_mo_20:
s_add_u32 s31,s31,1
s_cmp_gt_i32 s77,0
s_cbranch_scc1 L_mo_18
s_cmp_lg_u32 s77,0
s_cbranch_scc1 L_mo_22
s_waitcnt vmcnt(0)
s_barrier
s_or_b32 s72,s72,s52
buffer_store_dword v17,off,s[8:11],s72 sc1
s_mov_b32 s72,0x80000000
s_and_b32 s51,s54,0x7ff
s_sub_u32 s51,2047,s51
s_lshr_b32 s51,s51,5
s_add_u32 s73,s73,3
s_and_b32 s64,s54,0x7ff
s_sub_u32 s64,2047,s64
s_lshl_b32 s56,s64,10
s_add_u32 s58,s56,4194304
buffer_load_dwordx4 v[88:91],v0,s[8:11],s58 offen sc1
s_mov_b32 s4,s38
s_mov_b32 s5,s39
s_mov_b32 s6,1835008
s_mov_b32 s7,0x20000
v_and_b32 v9,15,v1
v_lshrrev_b32 v10,4,v1
v_lshlrev_b32 v8,14,v10
v_lshl_add_u32 v8,v9,4,v8
s_lshl_b32 s59,s47,16
s_lshl_b32 s60,s46,8
s_add_u32 s59,s59,s60
buffer_load_dwordx4 v[24:27],v8,s[4:7],s59 offen offset:0
buffer_load_dwordx4 v[28:31],v8,s[4:7],s59 offen offset:1024
buffer_load_dwordx4 v[32:35],v8,s[4:7],s59 offen offset:2048
buffer_load_dwordx4 v[36:39],v8,s[4:7],s59 offen offset:3072
s_add_u32 s59,s59,4096
buffer_load_dwordx4 v[40:43],v8,s[4:7],s59 offen offset:0
buffer_load_dwordx4 v[44:47],v8,s[4:7],s59 offen offset:1024
buffer_load_dwordx4 v[48:51],v8,s[4:7],s59 offen offset:2048
buffer_load_dwordx4 v[52:55],v8,s[4:7],s59 offen offset:3072
s_add_u32 s59,s59,4096
buffer_load_dwordx4 v[56:59],v8,s[4:7],s59 offen offset:0
buffer_load_dwordx4 v[60:63],v8,s[4:7],s59 offen offset:1024
buffer_load_dwordx4 v[64:67],v8,s[4:7],s59 offen offset:2048
buffer_load_dwordx4 v[68:71],v8,s[4:7],s59 offen offset:3072
s_add_u32 s59,s59,4096
buffer_load_dwordx4 v[72:75],v8,s[4:7],s59 offen offset:0
buffer_load_dwordx4 v[76:79],v8,s[4:7],s59 offen offset:1024
buffer_load_dwordx4 v[80:83],v8,s[4:7],s59 offen offset:2048
buffer_load_dwordx4 v[84:87],v8,s[4:7],s59 offen offset:3072
v_and_b32 v124,1,v1
v_lshlrev_b32 v124,4,v124
v_mov_b32 v125,0xffff
v_lshlrev_b32 v125,v124,v125
v_lshrrev_b32 v124,1,v9
v_cmp_eq_u32 vcc,0,v124
s_nop 1
v_cndmask_b32 v12,0,v125,vcc
v_cmp_eq_u32 vcc,1,v124
s_nop 1
v_cndmask_b32 v13,0,v125,vcc
v_cmp_eq_u32 vcc,2,v124
s_nop 1
v_cndmask_b32 v14,0,v125,vcc
v_cmp_eq_u32 vcc,3,v124
s_nop 1
v_cndmask_b32 v15,0,v125,vcc
s_waitcnt vmcnt(16)
L_mx_27:
v_max3_u32 v124,v88,v89,v90
v_max_u32 v124,v91,v124
v_cmp_eq_u32 vcc,-1,v124
s_cbranch_vccz L_mxd_28
buffer_load_dwordx4 v[88:91],v0,s[8:11],s58 offen sc1
s_sub_u32 s49,s49,1
s_cbranch_scc1 L_abort
s_waitcnt vmcnt(0)
s_branch L_mx_27
L_mxd_28:
v_lshlrev_b32 v96,16,v88
v_and_b32 v97,0xffff0000,v88
v_lshlrev_b32 v98,16,v89
v_and_b32 v99,0xffff0000,v89
v_lshlrev_b32 v100,16,v90
v_and_b32 v101,0xffff0000,v90
v_lshlrev_b32 v102,16,v91
v_and_b32 v103,0xffff0000,v91
v_readfirstlane_b32 s78,v96
s_nop 1
v_pk_add_f32 v[108:109],v[96:97],s[78:79] op_sel_hi:[1,0] neg_lo:[0,1] neg_hi:[0,1]
v_pk_add_f32 v[110:111],v[98:99],s[78:79] op_sel_hi:[1,0] neg_lo:[0,1] neg_hi:[0,1]
v_pk_add_f32 v[112:113],v[100:101],s[78:79] op_sel_hi:[1,0] neg_lo:[0,1] neg_hi:[0,1]
v_pk_add_f32 v[114:115],v[102:103],s[78:79] op_sel_hi:[1,0] neg_lo:[0,1] neg_hi:[0,1]
v_pk_add_f32 v[116:117],v[108:109],v[110:111]
v_pk_mul_f32 v[118:119],v[108:109],v[108:109]
v_pk_add_f32 v[120:121],v[112:113],v[114:115]
v_pk_fma_f32 v[118:119],v[110:111],v[110:111],v[118:119]
v_pk_add_f32 v[116:117],v[116:117],v[120:121]
v_pk_fma_f32 v[118:119],v[112:113],v[112:113],v[118:119]
v_add_f32 v116,v116,v117
v_pk_fma_f32 v[118:119],v[114:115],v[114:115],v[118:119]
v_add_f32 v118,v118,v119
s_nop 1
v_permlane32_swap_b32 v116,v118
v_add_f32 v116,v116,v118
s_nop 1
v_add_f32_dpp v116,v116,v116 row_ror:8 row_mask:0xf bank_mask:0xf
s_nop 1
v_add_f32_dpp v116,v116,v116 row_ror:4 row_mask:0xf bank_mask:0xf
s_nop 1
v_add_f32_dpp v116,v116,v116 row_ror:2 row_mask:0xf bank_mask:0xf
s_nop 1
v_add_f32_dpp v116,v116,v116 row_ror:1 row_mask:0xf bank_mask:0xf
v_mov_b32 v118,v116
s_nop 1
v_permlane16_swap_b32 v116,v118
v_add_f32 v116,v116,v118
v_mul_f32 v116,0x3b000000,v116
v_mov_b32 v118,v116
s_nop 1
v_permlane32_swap_b32 v116,v118
v_fma_f32 v118,-v116,v116,v118
v_add_f32 v116,s78,v116
v_max_f32 v118,0,v118
v_cvt_pk_bf16_f32 v118,v116,v118
v_lshlrev_b32 v116,16,v118
v_and_b32 v118,0xffff0000,v118
v_add_f32 v118,0x3727c5ac,v118
v_cvt_pk_bf16_f32 v118,v118,v118
v_and_b32 v118,0xffff0000,v118
v_sqrt_f32 v118,v118
v_pk_add_f32 v[108:109],v[96:97],v[116:117] op_sel_hi:[1,0] neg_lo:[0,1] neg_hi:[0,1]
v_pk_add_f32 v[110:111],v[98:99],v[116:117] op_sel_hi:[1,0] neg_lo:[0,1] neg_hi:[0,1]
v_pk_add_f32 v[112:113],v[100:101],v[116:117] op_sel_hi:[1,0] neg_lo:[0,1] neg_hi:[0,1]
v_pk_add_f32 v[114:115],v[102:103],v[116:117] op_sel_hi:[1,0] neg_lo:[0,1] neg_hi:[0,1]
v_cvt_pk_bf16_f32 v118,v118,v118
v_and_b32 v118,0xffff0000,v118
v_rcp_f32 v118,v118
v_cvt_pk_bf16_f32 v104,v108,v109
v_cvt_pk_bf16_f32 v105,v110,v111
v_cvt_pk_bf16_f32 v106,v112,v113
v_cvt_pk_bf16_f32 v107,v114,v115
v_lshlrev_b32 v108,16,v104
v_and_b32 v109,0xffff0000,v104
v_lshlrev_b32 v110,16,v105
v_and_b32 v111,0xffff0000,v105
v_lshlrev_b32 v112,16,v106
v_and_b32 v113,0xffff0000,v106
v_lshlrev_b32 v114,16,v107
v_and_b32 v115,0xffff0000,v107
v_pk_mul_f32 v[108:109],v[108:109],v[118:119] op_sel_hi:[1,0]
v_pk_mul_f32 v[110:111],v[110:111],v[118:119] op_sel_hi:[1,0]
v_pk_mul_f32 v[112:113],v[112:113],v[118:119] op_sel_hi:[1,0]
v_pk_mul_f32 v[114:115],v[114:115],v[118:119] op_sel_hi:[1,0]
v_cvt_pk_bf16_f32 v104,v108,v109
v_cvt_pk_bf16_f32 v105,v110,v111
v_cvt_pk_bf16_f32 v106,v112,v113
v_cvt_pk_bf16_f32 v107,v114,v115
s_mov_b32 s58,0x01000100
s_mov_b32 s59,0x03020302
v_perm_b32 v88,v104,v104,s58
v_perm_b32 v89,v104,v104,s59
v_perm_b32 v90,v105,v105,s58
v_perm_b32 v91,v105,v105,s59
v_perm_b32 v92,v106,v106,s58
v_perm_b32 v93,v106,v106,s59
v_perm_b32 v94,v107,v107,s58
v_perm_b32 v95,v107,v107,s59
v_lshlrev_b32 v8,5,v1
s_lshl_b32 s58,s46,11
s_add_u32 s58,s58,139264
v_add_u32 v8,s58,v8
ds_write_b128 v8,v[88:91]
ds_write_b128 v8,v[92:95] offset:16
s_lshl_b32 s59,s46,9
s_add_u32 s59,s58,s59
v_lshlrev_b32 v8,7,v10
v_add_u32 v8,s59,v8
s_waitcnt lgkmcnt(0)
ds_read_b128 v[108:111],v18 offset:0
ds_read_b128 v[88:91],v8 offset:0
ds_read_b128 v[92:95],v8 offset:16
ds_read_b128 v[112:115],v18 offset:1024
s_waitcnt lgkmcnt(1)
v_and_b32 v124,v12,v88
v_and_b32 v125,v13,v88
v_and_b32 v126,v14,v88
v_and_b32 v127,v15,v88
s_nop 1
v_mfma_f32_16x16x32_bf16 v[116:119],v[124:127],v[108:111],0
ds_read_b128 v[108:111],v18 offset:2048
s_waitcnt lgkmcnt(1)
v_and_b32 v124,v12,v89
v_and_b32 v125,v13,v89
v_and_b32 v126,v14,v89
v_and_b32 v127,v15,v89
s_nop 1
v_mfma_f32_16x16x32_bf16 v[116:119],v[124:127],v[112:115],v[116:119]
ds_read_b128 v[112:115],v18 offset:3072
s_waitcnt lgkmcnt(1)
v_and_b32 v124,v12,v90
v_and_b32 v125,v13,v90
v_and_b32 v126,v14,v90
v_and_b32 v127,v15,v90
s_nop 1
v_mfma_f32_16x16x32_bf16 v[116:119],v[124:127],v[108:111],v[116:119]
ds_read_b128 v[108:111],v18 offset:4096
s_waitcnt lgkmcnt(1)
v_and_b32 v124,v12,v91
v_and_b32 v125,v13,v91
v_and_b32 v126,v14,v91
v_and_b32 v127,v15,v91
s_nop 1
v_mfma_f32_16x16x32_bf16 v[116:119],v[124:127],v[112:115],v[116:119]
ds_read_b128 v[112:115],v18 offset:5120
s_waitcnt lgkmcnt(1)
v_and_b32 v124,v12,v92
v_and_b32 v125,v13,v92
v_and_b32 v126,v14,v92
v_and_b32 v127,v15,v92
s_nop 1
v_mfma_f32_16x16x32_bf16 v[116:119],v[124:127],v[108:111],v[116:119]
ds_read_b128 v[108:111],v18 offset:6144
s_waitcnt lgkmcnt(1)
v_and_b32 v124,v12,v93
v_and_b32 v125,v13,v93
v_and_b32 v126,v14,v93
v_and_b32 v127,v15,v93
s_nop 1
v_mfma_f32_16x16x32_bf16 v[116:119],v[124:127],v[112:115],v[116:119]
ds_read_b128 v[112:115],v18 offset:7168
s_waitcnt lgkmcnt(1)
v_and_b32 v124,v12,v94
v_and_b32 v125,v13,v94
v_and_b32 v126,v14,v94
v_and_b32 v127,v15,v94
s_nop 1
v_mfma_f32_16x16x32_bf16 v[116:119],v[124:127],v[108:111],v[116:119]
ds_read_b128 v[108:111],v18 offset:8192
s_waitcnt lgkmcnt(1)
v_and_b32 v124,v12,v95
v_and_b32 v125,v13,v95
v_and_b32 v126,v14,v95
v_and_b32 v127,v15,v95
s_nop 1
v_mfma_f32_16x16x32_bf16 v[116:119],v[124:127],v[112:115],v[116:119]
ds_read_b128 v[88:91],v8 offset:32
ds_read_b128 v[92:95],v8 offset:48
ds_read_b128 v[112:115],v18 offset:9216
s_waitcnt lgkmcnt(1)
v_and_b32 v124,v12,v88
v_and_b32 v125,v13,v88
v_and_b32 v126,v14,v88
v_and_b32 v127,v15,v88
s_nop 1
v_mfma_f32_16x16x32_bf16 v[116:119],v[124:127],v[108:111],v[116:119]
ds_read_b128 v[108:111],v18 offset:10240
s_waitcnt lgkmcnt(1)
v_and_b32 v124,v12,v89
v_and_b32 v125,v13,v89
v_and_b32 v126,v14,v89
v_and_b32 v127,v15,v89
s_nop 1
v_mfma_f32_16x16x32_bf16 v[116:119],v[124:127],v[112:115],v[116:119]
ds_read_b128 v[112:115],v18 offset:11264
s_waitcnt lgkmcnt(1)
v_and_b32 v124,v12,v90
v_and_b32 v125,v13,v90
v_and_b32 v126,v14,v90
v_and_b32 v127,v15,v90
s_nop 1
v_mfma_f32_16x16x32_bf16 v[116:119],v[124:127],v[108:111],v[116:119]
ds_read_b128 v[108:111],v18 offset:12288
s_waitcnt lgkmcnt(1)
v_and_b32 v124,v12,v91
v_and_b32 v125,v13,v91
v_and_b32 v126,v14,v91
v_and_b32 v127,v15,v91
s_nop 1
v_mfma_f32_16x16x32_bf16 v[116:119],v[124:127],v[112:115],v[116:119]
ds_read_b128 v[112:115],v18 offset:13312
s_waitcnt lgkmcnt(1)
v_and_b32 v124,v12,v92
v_and_b32 v125,v13,v92
v_and_b32 v126,v14,v92
v_and_b32 v127,v15,v92
s_nop 1
v_mfma_f32_16x16x32_bf16 v[116:119],v[124:127],v[108:111],v[116:119]
ds_read_b128 v[108:111],v18 offset:14336
s_waitcnt lgkmcnt(1)
v_and_b32 v124,v12,v93
v_and_b32 v125,v13,v93
v_and_b32 v126,v14,v93
v_and_b32 v127,v15,v93
s_nop 1
v_mfma_f32_16x16x32_bf16 v[116:119],v[124:127],v[112:115],v[116:119]
ds_read_b128 v[112:115],v18 offset:15360
s_waitcnt lgkmcnt(1)
v_and_b32 v124,v12,v94
v_and_b32 v125,v13,v94
v_and_b32 v126,v14,v94
v_and_b32 v127,v15,v94
s_nop 1
v_mfma_f32_16x16x32_bf16 v[116:119],v[124:127],v[108:111],v[116:119]
ds_read_b128 v[108:111],v18 offset:16384
s_waitcnt lgkmcnt(1)
v_and_b32 v124,v12,v95
v_and_b32 v125,v13,v95
v_and_b32 v126,v14,v95
v_and_b32 v127,v15,v95
s_nop 1
v_mfma_f32_16x16x32_bf16 v[116:119],v[124:127],v[112:115],v[116:119]
ds_read_b128 v[88:91],v8 offset:64
ds_read_b128 v[92:95],v8 offset:80
ds_read_b128 v[112:115],v18 offset:17408
s_waitcnt lgkmcnt(1)
v_and_b32 v124,v12,v88
v_and_b32 v125,v13,v88
v_and_b32 v126,v14,v88
v_and_b32 v127,v15,v88
s_nop 1
v_mfma_f32_16x16x32_bf16 v[116:119],v[124:127],v[108:111],v[116:119]
ds_read_b128 v[108:111],v18 offset:18432
s_waitcnt lgkmcnt(1)
v_and_b32 v124,v12,v89
v_and_b32 v125,v13,v89
v_and_b32 v126,v14,v89
v_and_b32 v127,v15,v89
s_nop 1
v_mfma_f32_16x16x32_bf16 v[116:119],v[124:127],v[112:115],v[116:119]
ds_read_b128 v[112:115],v18 offset:19456
s_waitcnt lgkmcnt(1)
v_and_b32 v124,v12,v90
v_and_b32 v125,v13,v90
v_and_b32 v126,v14,v90
v_and_b32 v127,v15,v90
s_nop 1
v_mfma_f32_16x16x32_bf16 v[116:119],v[124:127],v[108:111],v[116:119]
ds_read_b128 v[108:111],v18 offset:20480
s_waitcnt lgkmcnt(1)
v_and_b32 v124,v12,v91
v_and_b32 v125,v13,v91
v_and_b32 v126,v14,v91
v_and_b32 v127,v15,v91
s_nop 1
v_mfma_f32_16x16x32_bf16 v[116:119],v[124:127],v[112:115],v[116:119]
ds_read_b128 v[112:115],v18 offset:21504
s_waitcnt lgkmcnt(1)
v_and_b32 v124,v12,v92
v_and_b32 v125,v13,v92
v_and_b32 v126,v14,v92
v_and_b32 v127,v15,v92
s_nop 1
v_mfma_f32_16x16x32_bf16 v[116:119],v[124:127],v[108:111],v[116:119]
ds_read_b128 v[108:111],v18 offset:22528
s_waitcnt lgkmcnt(1)
v_and_b32 v124,v12,v93
v_and_b32 v125,v13,v93
v_and_b32 v126,v14,v93
v_and_b32 v127,v15,v93
s_nop 1
v_mfma_f32_16x16x32_bf16 v[116:119],v[124:127],v[112:115],v[116:119]
ds_read_b128 v[112:115],v18 offset:23552
s_waitcnt lgkmcnt(1)
v_and_b32 v124,v12,v94
v_and_b32 v125,v13,v94
v_and_b32 v126,v14,v94
v_and_b32 v127,v15,v94
s_nop 1
v_mfma_f32_16x16x32_bf16 v[116:119],v[124:127],v[108:111],v[116:119]
ds_read_b128 v[108:111],v18 offset:24576
s_waitcnt lgkmcnt(1)
v_and_b32 v124,v12,v95
v_and_b32 v125,v13,v95
v_and_b32 v126,v14,v95
v_and_b32 v127,v15,v95
s_nop 1
v_mfma_f32_16x16x32_bf16 v[116:119],v[124:127],v[112:115],v[116:119]
ds_read_b128 v[88:91],v8 offset:96
ds_read_b128 v[92:95],v8 offset:112
ds_read_b128 v[112:115],v18 offset:25600
s_waitcnt lgkmcnt(1)
v_and_b32 v124,v12,v88
v_and_b32 v125,v13,v88
v_and_b32 v126,v14,v88
v_and_b32 v127,v15,v88
s_nop 1
v_mfma_f32_16x16x32_bf16 v[116:119],v[124:127],v[108:111],v[116:119]
ds_read_b128 v[108:111],v18 offset:26624
s_waitcnt lgkmcnt(1)
v_and_b32 v124,v12,v89
v_and_b32 v125,v13,v89
v_and_b32 v126,v14,v89
v_and_b32 v127,v15,v89
s_nop 1
v_mfma_f32_16x16x32_bf16 v[116:119],v[124:127],v[112:115],v[116:119]
ds_read_b128 v[112:115],v18 offset:27648
s_waitcnt lgkmcnt(1)
v_and_b32 v124,v12,v90
v_and_b32 v125,v13,v90
v_and_b32 v126,v14,v90
v_and_b32 v127,v15,v90
s_nop 1
v_mfma_f32_16x16x32_bf16 v[116:119],v[124:127],v[108:111],v[116:119]
ds_read_b128 v[108:111],v18 offset:28672
s_waitcnt lgkmcnt(1)
v_and_b32 v124,v12,v91
v_and_b32 v125,v13,v91
v_and_b32 v126,v14,v91
v_and_b32 v127,v15,v91
s_nop 1
v_mfma_f32_16x16x32_bf16 v[116:119],v[124:127],v[112:115],v[116:119]
ds_read_b128 v[112:115],v18 offset:29696
s_waitcnt lgkmcnt(1)
v_and_b32 v124,v12,v92
v_and_b32 v125,v13,v92
v_and_b32 v126,v14,v92
v_and_b32 v127,v15,v92
s_nop 1
v_mfma_f32_16x16x32_bf16 v[116:119],v[124:127],v[108:111],v[116:119]
ds_read_b128 v[108:111],v18 offset:30720
s_waitcnt lgkmcnt(1)
v_and_b32 v124,v12,v93
v_and_b32 v125,v13,v93
v_and_b32 v126,v14,v93
v_and_b32 v127,v15,v93
s_nop 1
v_mfma_f32_16x16x32_bf16 v[116:119],v[124:127],v[112:115],v[116:119]
ds_read_b128 v[112:115],v18 offset:31744
s_waitcnt lgkmcnt(1)
v_and_b32 v124,v12,v94
v_and_b32 v125,v13,v94
v_and_b32 v126,v14,v94
v_and_b32 v127,v15,v94
s_nop 1
v_mfma_f32_16x16x32_bf16 v[116:119],v[124:127],v[108:111],v[116:119]
s_waitcnt lgkmcnt(0)
v_and_b32 v124,v12,v95
v_and_b32 v125,v13,v95
v_and_b32 v126,v14,v95
v_and_b32 v127,v15,v95
s_nop 1
v_mfma_f32_16x16x32_bf16 v[116:119],v[124:127],v[112:115],v[116:119]
v_lshlrev_b32 v8,5,v9
v_and_b32 v124,1,v10
v_lshl_add_u32 v8,v124,4,v8
v_lshrrev_b32 v124,1,v10
v_lshl_add_u32 v8,v124,11,v8
s_lshl_b32 s60,s46,9
s_add_u32 s60,s60,147456
v_add_u32 v8,s60,v8
ds_write_b128 v8,v[116:119]
v_lshlrev_b32 v8,2,v1
v_add_u32 v8,147456,v8
s_waitcnt lgkmcnt(0)
s_barrier
ds_read2st64_b32 v[88:89],v8 offset0:0 offset1:1
ds_read2st64_b32 v[90:91],v8 offset0:2 offset1:3
ds_read2st64_b32 v[92:93],v8 offset0:4 offset1:5
ds_read2st64_b32 v[94:95],v8 offset0:6 offset1:7
s_waitcnt lgkmcnt(0)
v_pk_add_f32 v[88:89],v[88:89],v[90:91]
v_pk_add_f32 v[92:93],v[92:93],v[94:95]
v_pk_add_f32 v[88:89],v[88:89],v[92:93]
v_cvt_pk_bf16_f32 v88,v88,v88
v_and_b32 v88,0xffff0000,v88
v_cvt_pk_bf16_f32 v89,v89,v89
v_and_b32 v89,0xffff0000,v89
v_mul_f32 v90,0xbfb8aa3b,v88
v_exp_f32 v90,v90
s_nop 0
v_add_f32 v90,1.0,v90
v_rcp_f32 v90,v90
s_nop 0
v_mul_f32 v88,v88,v90
v_cvt_pk_bf16_f32 v88,v88,v88
v_and_b32 v88,0xffff0000,v88
v_mul_f32 v88,v88,v89
v_cvt_pk_bf16_f32 v88,v88,v88
v_lshlrev_b32 v8,2,v1
v_add_u32 v8,s58,v8
ds_write_b32 v8,v88
v_lshlrev_b32 v8,6,v10
v_add_u32 v8,s58,v8
s_waitcnt lgkmcnt(0)
ds_read_b128 v[88:91],v8
ds_read_b128 v[92:95],v8 offset:16
ds_read_b128 v[108:111],v8 offset:32
ds_read_b128 v[112:115],v8 offset:48
s_waitcnt vmcnt(0) lgkmcnt(0)
v_and_b32 v124,v12,v88
v_and_b32 v125,v13,v88
v_and_b32 v126,v14,v88
v_and_b32 v127,v15,v88
s_nop 1
v_mfma_f32_16x16x32_bf16 v[116:119],v[124:127],v[24:27],0
v_and_b32 v124,v12,v89
v_and_b32 v125,v13,v89
v_and_b32 v126,v14,v89
v_and_b32 v127,v15,v89
s_nop 1
v_mfma_f32_16x16x32_bf16 v[116:119],v[124:127],v[28:31],v[116:119]
v_and_b32 v124,v12,v90
v_and_b32 v125,v13,v90
v_and_b32 v126,v14,v90
v_and_b32 v127,v15,v90
s_nop 1
v_mfma_f32_16x16x32_bf16 v[116:119],v[124:127],v[32:35],v[116:119]
v_and_b32 v124,v12,v91
v_and_b32 v125,v13,v91
v_and_b32 v126,v14,v91
v_and_b32 v127,v15,v91
s_nop 1
v_mfma_f32_16x16x32_bf16 v[116:119],v[124:127],v[36:39],v[116:119]
v_and_b32 v124,v12,v92
v_and_b32 v125,v13,v92
v_and_b32 v126,v14,v92
v_and_b32 v127,v15,v92
s_nop 1
v_mfma_f32_16x16x32_bf16 v[116:119],v[124:127],v[40:43],v[116:119]
v_and_b32 v124,v12,v93
v_and_b32 v125,v13,v93
v_and_b32 v126,v14,v93
v_and_b32 v127,v15,v93
s_nop 1
v_mfma_f32_16x16x32_bf16 v[116:119],v[124:127],v[44:47],v[116:119]
v_and_b32 v124,v12,v94
v_and_b32 v125,v13,v94
v_and_b32 v126,v14,v94
v_and_b32 v127,v15,v94
s_nop 1
v_mfma_f32_16x16x32_bf16 v[116:119],v[124:127],v[48:51],v[116:119]
v_and_b32 v124,v12,v95
v_and_b32 v125,v13,v95
v_and_b32 v126,v14,v95
v_and_b32 v127,v15,v95
s_nop 1
v_mfma_f32_16x16x32_bf16 v[116:119],v[124:127],v[52:55],v[116:119]
v_and_b32 v124,v12,v108
v_and_b32 v125,v13,v108
v_and_b32 v126,v14,v108
v_and_b32 v127,v15,v108
s_nop 1
v_mfma_f32_16x16x32_bf16 v[116:119],v[124:127],v[56:59],v[116:119]
v_and_b32 v124,v12,v109
v_and_b32 v125,v13,v109
v_and_b32 v126,v14,v109
v_and_b32 v127,v15,v109
s_nop 1
v_mfma_f32_16x16x32_bf16 v[116:119],v[124:127],v[60:63],v[116:119]
v_and_b32 v124,v12,v110
v_and_b32 v125,v13,v110
v_and_b32 v126,v14,v110
v_and_b32 v127,v15,v110
s_nop 1
v_mfma_f32_16x16x32_bf16 v[116:119],v[124:127],v[64:67],v[116:119]
v_and_b32 v124,v12,v111
v_and_b32 v125,v13,v111
v_and_b32 v126,v14,v111
v_and_b32 v127,v15,v111
s_nop 1
v_mfma_f32_16x16x32_bf16 v[116:119],v[124:127],v[68:71],v[116:119]
v_and_b32 v124,v12,v112
v_and_b32 v125,v13,v112
v_and_b32 v126,v14,v112
v_and_b32 v127,v15,v112
s_nop 1
v_mfma_f32_16x16x32_bf16 v[116:119],v[124:127],v[72:75],v[116:119]
v_and_b32 v124,v12,v113
v_and_b32 v125,v13,v113
v_and_b32 v126,v14,v113
v_and_b32 v127,v15,v113
s_nop 1
v_mfma_f32_16x16x32_bf16 v[116:119],v[124:127],v[76:79],v[116:119]
v_and_b32 v124,v12,v114
v_and_b32 v125,v13,v114
v_and_b32 v126,v14,v114
v_and_b32 v127,v15,v114
s_nop 1
v_mfma_f32_16x16x32_bf16 v[116:119],v[124:127],v[80:83],v[116:119]
v_and_b32 v124,v12,v115
v_and_b32 v125,v13,v115
v_and_b32 v126,v14,v115
v_and_b32 v127,v15,v115
s_nop 1
v_mfma_f32_16x16x32_bf16 v[116:119],v[124:127],v[84:87],v[116:119]
v_lshlrev_b32 v8,4,v9
v_and_b32 v124,1,v10
v_lshl_add_u32 v8,v124,3,v8
v_and_b32 v124,2,v10
v_lshl_add_u32 v8,v124,30,v8
s_lshl_b32 s65,s51,15
s_add_u32 s65,s65,92274688
s_lshl_b32 s59,s47,10
s_lshl_b32 s60,s46,8
s_add_u32 s59,s59,s60
s_add_u32 s59,s59,s65
v_cvt_pk_bf16_f32 v24,v116,v117
v_cvt_pk_bf16_f32 v25,v118,v119
buffer_store_dwordx2 v[24:25],v8,s[8:11],s59 offen
s_lshl_b32 s59,s51,13
s_lshl2_add_u32 s59,s47,s59
s_add_u32 s59,s59,10486912
s_waitcnt vmcnt(0)
s_barrier
s_or_b32 s59,s59,s52
buffer_store_dword v17,off,s[8:11],s59
s_lshl_b32 s59,s51,13
s_add_u32 s59,s59,10486912
v_and_b32 v124,31,v1
v_lshlrev_b32 v124,2,v124
L_fw_30:
buffer_load_dword v125,v124,s[8:11],s59 offen sc1
s_sub_u32 s49,s49,1
s_cbranch_scc1 L_abort
s_waitcnt vmcnt(0)
v_cmp_eq_u32 vcc,0,v125
s_cbranch_vccnz L_fw_30
s_add_u32 s63,s65,0
buffer_load_dwordx4 v[24:27],v22,s[8:11],s63 offen sc1
s_add_u32 s63,s65,4096
buffer_load_dwordx4 v[28:31],v22,s[8:11],s63 offen sc1
s_add_u32 s63,s65,8192
buffer_load_dwordx4 v[32:35],v22,s[8:11],s63 offen sc1
s_add_u32 s63,s65,12288
buffer_load_dwordx4 v[36:39],v22,s[8:11],s63 offen sc1
s_add_u32 s63,s65,16384
buffer_load_dwordx4 v[40:43],v22,s[8:11],s63 offen sc1
s_add_u32 s63,s65,20480
buffer_load_dwordx4 v[44:47],v22,s[8:11],s63 offen sc1
s_add_u32 s63,s65,24576
buffer_load_dwordx4 v[48:51],v22,s[8:11],s63 offen sc1
s_add_u32 s63,s65,28672
buffer_load_dwordx4 v[52:55],v22,s[8:11],s63 offen sc1
v_and_b32 v64,15,v1
v_and_b32 v65,1,v1
v_lshlrev_b32 v65,4,v65
v_mov_b32 v66,0x3f80
v_lshlrev_b32 v66,v65,v66
v_lshrrev_b32 v64,1,v64
v_cmp_eq_u32 vcc,0,v64
s_nop 1
v_cndmask_b32 v56,0,v66,vcc
v_cmp_eq_u32 vcc,1,v64
s_nop 1
v_cndmask_b32 v57,0,v66,vcc
v_cmp_eq_u32 vcc,2,v64
s_nop 1
v_cndmask_b32 v58,0,v66,vcc
v_cmp_eq_u32 vcc,3,v64
s_nop 1
v_cndmask_b32 v59,0,v66,vcc
s_waitcnt vmcnt(7)
s_nop 0
v_mfma_f32_16x16x32_bf16 v[60:63],v[56:59],v[24:27],0
s_waitcnt vmcnt(6)
v_mfma_f32_16x16x32_bf16 v[60:63],v[56:59],v[28:31],v[60:63]
s_waitcnt vmcnt(5)
v_mfma_f32_16x16x32_bf16 v[60:63],v[56:59],v[32:35],v[60:63]
s_waitcnt vmcnt(4)
v_mfma_f32_16x16x32_bf16 v[60:63],v[56:59],v[36:39],v[60:63]
s_waitcnt vmcnt(3)
v_mfma_f32_16x16x32_bf16 v[60:63],v[56:59],v[40:43],v[60:63]
s_waitcnt vmcnt(2)
v_mfma_f32_16x16x32_bf16 v[60:63],v[56:59],v[44:47],v[60:63]
s_waitcnt vmcnt(1)
v_mfma_f32_16x16x32_bf16 v[60:63],v[56:59],v[48:51],v[60:63]
s_waitcnt vmcnt(0)
v_mfma_f32_16x16x32_bf16 v[60:63],v[56:59],v[52:55],v[60:63]
s_nop 7
ds_write_b128 v21,v[60:63]
s_waitcnt lgkmcnt(0)
s_barrier
s_cmp_lg_u32 s46,0
s_cbranch_scc1 L_moed_29
v_lshlrev_b32 v56,5,v1
v_add_u32 v56,155648,v56
ds_read_b128 v[24:27],v56
ds_read_b128 v[28:31],v56 offset:16
s_and_b32 s59,s54,0xffff0000
s_xor_b32 s60,s59,0x80000000
s_xor_b32 s61,s59,0xffff0000
s_cmp_lt_i32 s59,0
s_cselect_b32 s59,s60,s61
v_mov_b32 v56,s59
v_mul_f32 v56,0xbfb8aa3b,v56
v_exp_f32 v56,v56
s_nop 0
v_add_f32 v56,1.0,v56
v_rcp_f32 v56,v56
s_nop 0
v_cvt_pk_bf16_f32 v56,v56,v56
v_and_b32 v56,0xffff0000,v56
v_lshlrev_b32 v48,16,v104
v_and_b32 v49,0xffff0000,v104
v_lshlrev_b32 v50,16,v105
v_and_b32 v51,0xffff0000,v105
v_lshlrev_b32 v52,16,v106
v_and_b32 v53,0xffff0000,v106
v_lshlrev_b32 v54,16,v107
v_and_b32 v55,0xffff0000,v107
s_waitcnt lgkmcnt(0)
v_cvt_pk_bf16_f32 v40,v24,v25
v_cvt_pk_bf16_f32 v41,v26,v27
v_cvt_pk_bf16_f32 v42,v28,v29
v_cvt_pk_bf16_f32 v43,v30,v31
v_lshlrev_b32 v24,16,v40
v_and_b32 v25,0xffff0000,v40
v_lshlrev_b32 v26,16,v41
v_and_b32 v27,0xffff0000,v41
v_lshlrev_b32 v28,16,v42
v_and_b32 v29,0xffff0000,v42
v_lshlrev_b32 v30,16,v43
v_and_b32 v31,0xffff0000,v43
v_mul_f32 v24,v24,v56
v_mul_f32 v25,v25,v56
v_mul_f32 v26,v26,v56
v_mul_f32 v27,v27,v56
v_mul_f32 v28,v28,v56
v_mul_f32 v29,v29,v56
v_mul_f32 v30,v30,v56
v_mul_f32 v31,v31,v56
v_cvt_pk_bf16_f32 v40,v24,v25
v_cvt_pk_bf16_f32 v41,v26,v27
v_cvt_pk_bf16_f32 v42,v28,v29
v_cvt_pk_bf16_f32 v43,v30,v31
v_lshlrev_b32 v24,16,v40
v_and_b32 v25,0xffff0000,v40
v_lshlrev_b32 v26,16,v41
v_and_b32 v27,0xffff0000,v41
v_lshlrev_b32 v28,16,v42
v_and_b32 v29,0xffff0000,v42
v_lshlrev_b32 v30,16,v43
v_and_b32 v31,0xffff0000,v43
v_add_f32 v24,v24,v48
v_add_f32 v25,v25,v49
v_add_f32 v26,v26,v50
v_add_f32 v27,v27,v51
v_add_f32 v28,v28,v52
v_add_f32 v29,v29,v53
v_add_f32 v30,v30,v54
v_add_f32 v31,v31,v55
v_cvt_pk_bf16_f32 v40,v24,v25
v_cvt_pk_bf16_f32 v41,v26,v27
v_cvt_pk_bf16_f32 v42,v28,v29
v_cvt_pk_bf16_f32 v43,v30,v31
v_lshlrev_b32 v24,16,v40
v_and_b32 v25,0xffff0000,v40
v_lshlrev_b32 v26,16,v41
v_and_b32 v27,0xffff0000,v41
v_lshlrev_b32 v28,16,v42
v_and_b32 v29,0xffff0000,v42
v_lshlrev_b32 v30,16,v43
v_and_b32 v31,0xffff0000,v43
v_add_f32 v96,v96,v24
v_add_f32 v97,v97,v25
v_add_f32 v98,v98,v26
v_add_f32 v99,v99,v27
v_add_f32 v100,v100,v28
v_add_f32 v101,v101,v29
v_add_f32 v102,v102,v30
v_add_f32 v103,v103,v31
v_cvt_pk_bf16_f32 v80,v96,v97
v_cvt_pk_bf16_f32 v81,v98,v99
v_cvt_pk_bf16_f32 v82,v100,v101
v_cvt_pk_bf16_f32 v83,v102,v103
s_lshl_b32 s58,s51,10
s_add_u32 s58,s58,11272192
buffer_store_dwordx4 v[80:83],v0,s[8:11],s58 offen sc1
v_lshlrev_b32 v96,16,v80
v_and_b32 v97,0xffff0000,v80
v_lshlrev_b32 v98,16,v81
v_and_b32 v99,0xffff0000,v81
v_lshlrev_b32 v100,16,v82
v_and_b32 v101,0xffff0000,v82
v_lshlrev_b32 v102,16,v83
v_and_b32 v103,0xffff0000,v83
v_readfirstlane_b32 s78,v96
s_nop 1
v_pk_add_f32 v[58:59],v[96:97],s[78:79] op_sel_hi:[1,0] neg_lo:[0,1] neg_hi:[0,1]
v_pk_add_f32 v[60:61],v[98:99],s[78:79] op_sel_hi:[1,0] neg_lo:[0,1] neg_hi:[0,1]
v_pk_add_f32 v[62:63],v[100:101],s[78:79] op_sel_hi:[1,0] neg_lo:[0,1] neg_hi:[0,1]
v_pk_add_f32 v[64:65],v[102:103],s[78:79] op_sel_hi:[1,0] neg_lo:[0,1] neg_hi:[0,1]
v_pk_add_f32 v[66:67],v[58:59],v[60:61]
v_pk_mul_f32 v[68:69],v[58:59],v[58:59]
v_pk_add_f32 v[70:71],v[62:63],v[64:65]
v_pk_fma_f32 v[68:69],v[60:61],v[60:61],v[68:69]
v_pk_add_f32 v[66:67],v[66:67],v[70:71]
v_pk_fma_f32 v[68:69],v[62:63],v[62:63],v[68:69]
v_add_f32 v66,v66,v67
v_pk_fma_f32 v[68:69],v[64:65],v[64:65],v[68:69]
v_add_f32 v68,v68,v69
s_nop 1
v_permlane32_swap_b32 v66,v68
v_add_f32 v66,v66,v68
s_nop 1
v_add_f32_dpp v66,v66,v66 row_ror:8 row_mask:0xf bank_mask:0xf
s_nop 1
v_add_f32_dpp v66,v66,v66 row_ror:4 row_mask:0xf bank_mask:0xf
s_nop 1
v_add_f32_dpp v66,v66,v66 row_ror:2 row_mask:0xf bank_mask:0xf
s_nop 1
v_add_f32_dpp v66,v66,v66 row_ror:1 row_mask:0xf bank_mask:0xf
v_mov_b32 v68,v66
s_nop 1
v_permlane16_swap_b32 v66,v68
v_add_f32 v66,v66,v68
v_mul_f32 v66,0x3b000000,v66
v_mov_b32 v68,v66
s_nop 1
v_permlane32_swap_b32 v66,v68
v_fma_f32 v68,-v66,v66,v68
v_add_f32 v66,s78,v66
v_max_f32 v68,0,v68
v_cvt_pk_bf16_f32 v68,v66,v68
v_lshlrev_b32 v66,16,v68
v_and_b32 v68,0xffff0000,v68
v_add_f32 v68,0x3727c5ac,v68
v_cvt_pk_bf16_f32 v68,v68,v68
v_and_b32 v68,0xffff0000,v68
v_sqrt_f32 v68,v68
v_pk_add_f32 v[58:59],v[96:97],v[66:67] op_sel_hi:[1,0] neg_lo:[0,1] neg_hi:[0,1]
v_pk_add_f32 v[60:61],v[98:99],v[66:67] op_sel_hi:[1,0] neg_lo:[0,1] neg_hi:[0,1]
v_pk_add_f32 v[62:63],v[100:101],v[66:67] op_sel_hi:[1,0] neg_lo:[0,1] neg_hi:[0,1]
v_pk_add_f32 v[64:65],v[102:103],v[66:67] op_sel_hi:[1,0] neg_lo:[0,1] neg_hi:[0,1]
v_cvt_pk_bf16_f32 v68,v68,v68
v_and_b32 v68,0xffff0000,v68
v_rcp_f32 v68,v68
v_cvt_pk_bf16_f32 v84,v58,v59
v_cvt_pk_bf16_f32 v85,v60,v61
v_cvt_pk_bf16_f32 v86,v62,v63
v_cvt_pk_bf16_f32 v87,v64,v65
v_lshlrev_b32 v58,16,v84
v_and_b32 v59,0xffff0000,v84
v_lshlrev_b32 v60,16,v85
v_and_b32 v61,0xffff0000,v85
v_lshlrev_b32 v62,16,v86
v_and_b32 v63,0xffff0000,v86
v_lshlrev_b32 v64,16,v87
v_and_b32 v65,0xffff0000,v87
v_pk_mul_f32 v[58:59],v[58:59],v[68:69] op_sel_hi:[1,0]
v_pk_mul_f32 v[60:61],v[60:61],v[68:69] op_sel_hi:[1,0]
v_pk_mul_f32 v[62:63],v[62:63],v[68:69] op_sel_hi:[1,0]
v_pk_mul_f32 v[64:65],v[64:65],v[68:69] op_sel_hi:[1,0]
v_cvt_pk_bf16_f32 v84,v58,v59
v_cvt_pk_bf16_f32 v85,v60,v61
v_cvt_pk_bf16_f32 v86,v62,v63
v_cvt_pk_bf16_f32 v87,v64,v65
s_add_u32 s57,s56,98566144
buffer_store_dwordx4 v[84:87],v0,s[8:11],s57 offen sc1
L_moed_29:
s_and_b32 s56,s54,31
s_sub_u32 s56,31,s56
v_lshrrev_b32 v2,10,v20
v_add_u32 v3,16,v2
v_add_u32 v8,96468992,v20
v_cmp_eq_u32 vcc,s56,v2
s_nop 1
v_cndmask_b32 v2,v20,v8,vcc
v_cmp_eq_u32 vcc,s56,v3
s_nop 1
v_cndmask_b32 v3,v20,v8,vcc
s_lshl_b32 s59,s51,13
s_add_u32 s59,s59,10487552
v_and_b32 v124,31,v1
v_lshlrev_b32 v124,2,v124
L_fw_31:
buffer_load_dword v125,v124,s[8:11],s59 offen sc1
s_sub_u32 s49,s49,1
s_cbranch_scc1 L_abort
s_waitcnt vmcnt(0)
v_cmp_eq_u32 vcc,0,v125
s_cbranch_vccnz L_fw_31
s_barrier
s_lshl_b32 s66,s51,15
s_add_u32 s66,s66,2097152
s_add_u32 s67,s66,16384
s_add_u32 m0,s50,131072
s_nop 0
buffer_load_dwordx4 v2,s[8:11],s66 offen offset:0 sc1 lds
s_add_u32 m0,s50,135168
s_nop 0
buffer_load_dwordx4 v3,s[8:11],s67 offen offset:0 sc1 lds
s_add_u32 m0,s50,139008
s_nop 0
buffer_load_dwordx4 v2,s[8:11],s66 offen offset:256 sc1 lds
s_add_u32 m0,s50,143104
s_nop 0
buffer_load_dwordx4 v3,s[8:11],s67 offen offset:256 sc1 lds
s_add_u32 m0,s50,146944
s_nop 0
buffer_load_dwordx4 v2,s[8:11],s66 offen offset:512 sc1 lds
s_add_u32 m0,s50,151040
s_nop 0
buffer_load_dwordx4 v3,s[8:11],s67 offen offset:512 sc1 lds
s_lshl_b32 s58,s51,5
s_add_u32 s58,s58,s47
s_mul_i32 s58,s58,24576
s_add_u32 s58,s58,201326592
s_add_u32 s61,s58,s50
s_add_u32 s62,s61,4096
s_add_u32 s63,s61,16384
s_add_u32 s64,s61,20480
s_add_u32 s65,s61,s50
s_add_u32 s65,s65,8192
s_waitcnt vmcnt(4)
s_barrier
ds_read_b128 v[104:107],v4 offset:0
ds_read_b128 v[108:111],v4 offset:4096
ds_read_b128 v[112:115],v5 offset:0
ds_read_b128 v[116:119],v5 offset:4096
s_add_u32 m0,s50,154880
s_nop 0
buffer_load_dwordx4 v2,s[8:11],s66 offen offset:768 sc1 lds
s_add_u32 m0,s50,158976
s_nop 0
buffer_load_dwordx4 v3,s[8:11],s67 offen offset:768 sc1 lds
s_waitcnt lgkmcnt(2)
v_mfma_f32_16x16x32_bf16 v[24:27],a[128:131],v[104:107],0
ds_read_b128 v[120:123],v6 offset:0
v_mfma_f32_16x16x32_bf16 v[40:43],v[104:107],v[128:131],0
v_mfma_f32_16x16x32_bf16 v[28:31],a[128:131],v[108:111],0
ds_read_b128 v[124:127],v6 offset:4096
v_mfma_f32_16x16x32_bf16 v[44:47],v[108:111],v[128:131],0
v_mfma_f32_16x16x32_bf16 v[32:35],a[136:139],v[104:107],0
v_mfma_f32_16x16x32_bf16 v[48:51],v[104:107],v[136:139],0
v_mfma_f32_16x16x32_bf16 v[36:39],a[136:139],v[108:111],0
v_mfma_f32_16x16x32_bf16 v[52:55],v[108:111],v[136:139],0
s_waitcnt lgkmcnt(2)
v_mfma_f32_16x16x32_bf16 v[24:27],a[132:135],v[112:115],v[24:27]
ds_read_b128 v[104:107],v7 offset:0
v_mfma_f32_16x16x32_bf16 v[40:43],v[112:115],v[132:135],v[40:43]
v_mfma_f32_16x16x32_bf16 v[28:31],a[132:135],v[116:119],v[28:31]
ds_read_b128 v[108:111],v7 offset:4096
v_mfma_f32_16x16x32_bf16 v[44:47],v[116:119],v[132:135],v[44:47]
v_mfma_f32_16x16x32_bf16 v[32:35],a[140:143],v[112:115],v[32:35]
v_mfma_f32_16x16x32_bf16 v[48:51],v[112:115],v[140:143],v[48:51]
v_mfma_f32_16x16x32_bf16 v[36:39],a[140:143],v[116:119],v[36:39]
v_mfma_f32_16x16x32_bf16 v[52:55],v[116:119],v[140:143],v[52:55]
s_waitcnt vmcnt(4)
s_barrier
s_waitcnt lgkmcnt(2)
v_mfma_f32_16x16x32_bf16 v[24:27],a[144:147],v[120:123],v[24:27]
ds_read_b128 v[112:115],v4 offset:8192
v_mfma_f32_16x16x32_bf16 v[40:43],v[120:123],v[144:147],v[40:43]
v_mfma_f32_16x16x32_bf16 v[28:31],a[144:147],v[124:127],v[28:31]
ds_read_b128 v[116:119],v4 offset:12288
v_mfma_f32_16x16x32_bf16 v[44:47],v[124:127],v[144:147],v[44:47]
v_mfma_f32_16x16x32_bf16 v[32:35],a[152:155],v[120:123],v[32:35]
v_mfma_f32_16x16x32_bf16 v[48:51],v[120:123],v[152:155],v[48:51]
v_mfma_f32_16x16x32_bf16 v[36:39],a[152:155],v[124:127],v[36:39]
v_mfma_f32_16x16x32_bf16 v[52:55],v[124:127],v[152:155],v[52:55]
s_waitcnt lgkmcnt(2)
v_mfma_f32_16x16x32_bf16 v[24:27],a[148:151],v[104:107],v[24:27]
ds_read_b128 v[120:123],v5 offset:8192
v_mfma_f32_16x16x32_bf16 v[40:43],v[104:107],v[148:151],v[40:43]
v_mfma_f32_16x16x32_bf16 v[28:31],a[148:151],v[108:111],v[28:31]
ds_read_b128 v[124:127],v5 offset:12288
v_mfma_f32_16x16x32_bf16 v[44:47],v[108:111],v[148:151],v[44:47]
v_mfma_f32_16x16x32_bf16 v[32:35],a[156:159],v[104:107],v[32:35]
v_mfma_f32_16x16x32_bf16 v[48:51],v[104:107],v[156:159],v[48:51]
v_mfma_f32_16x16x32_bf16 v[36:39],a[156:159],v[108:111],v[36:39]
v_mfma_f32_16x16x32_bf16 v[52:55],v[108:111],v[156:159],v[52:55]
s_waitcnt lgkmcnt(2)
v_mfma_f32_16x16x32_bf16 v[24:27],a[160:163],v[112:115],v[24:27]
ds_read_b128 v[104:107],v6 offset:8192
v_mfma_f32_16x16x32_bf16 v[40:43],v[112:115],v[160:163],v[40:43]
v_mfma_f32_16x16x32_bf16 v[28:31],a[160:163],v[116:119],v[28:31]
ds_read_b128 v[108:111],v6 offset:12288
v_mfma_f32_16x16x32_bf16 v[44:47],v[116:119],v[160:163],v[44:47]
v_mfma_f32_16x16x32_bf16 v[32:35],a[168:171],v[112:115],v[32:35]
v_mfma_f32_16x16x32_bf16 v[48:51],v[112:115],v[168:171],v[48:51]
v_mfma_f32_16x16x32_bf16 v[36:39],a[168:171],v[116:119],v[36:39]
v_mfma_f32_16x16x32_bf16 v[52:55],v[116:119],v[168:171],v[52:55]
s_waitcnt lgkmcnt(2)
v_mfma_f32_16x16x32_bf16 v[24:27],a[164:167],v[120:123],v[24:27]
ds_read_b128 v[112:115],v7 offset:8192
v_mfma_f32_16x16x32_bf16 v[40:43],v[120:123],v[164:167],v[40:43]
v_mfma_f32_16x16x32_bf16 v[28:31],a[164:167],v[124:127],v[28:31]
ds_read_b128 v[116:119],v7 offset:12288
v_mfma_f32_16x16x32_bf16 v[44:47],v[124:127],v[164:167],v[44:47]
v_mfma_f32_16x16x32_bf16 v[32:35],a[172:175],v[120:123],v[32:35]
v_mfma_f32_16x16x32_bf16 v[48:51],v[120:123],v[172:175],v[48:51]
v_mfma_f32_16x16x32_bf16 v[36:39],a[172:175],v[124:127],v[36:39]
v_mfma_f32_16x16x32_bf16 v[52:55],v[124:127],v[172:175],v[52:55]
s_waitcnt vmcnt(2)
s_barrier
s_waitcnt lgkmcnt(2)
v_mfma_f32_16x16x32_bf16 v[24:27],a[176:179],v[104:107],v[24:27]
ds_read_b128 v[120:123],v4 offset:16384
v_mfma_f32_16x16x32_bf16 v[40:43],v[104:107],v[176:179],v[40:43]
v_mfma_f32_16x16x32_bf16 v[28:31],a[176:179],v[108:111],v[28:31]
ds_read_b128 v[124:127],v4 offset:20480
v_mfma_f32_16x16x32_bf16 v[44:47],v[108:111],v[176:179],v[44:47]
v_mfma_f32_16x16x32_bf16 v[32:35],a[184:187],v[104:107],v[32:35]
v_mfma_f32_16x16x32_bf16 v[48:51],v[104:107],v[184:187],v[48:51]
v_mfma_f32_16x16x32_bf16 v[36:39],a[184:187],v[108:111],v[36:39]
v_mfma_f32_16x16x32_bf16 v[52:55],v[108:111],v[184:187],v[52:55]
s_waitcnt lgkmcnt(2)
v_mfma_f32_16x16x32_bf16 v[24:27],a[180:183],v[112:115],v[24:27]
ds_read_b128 v[104:107],v5 offset:16384
v_mfma_f32_16x16x32_bf16 v[40:43],v[112:115],v[180:183],v[40:43]
v_mfma_f32_16x16x32_bf16 v[28:31],a[180:183],v[116:119],v[28:31]
ds_read_b128 v[108:111],v5 offset:20480
v_mfma_f32_16x16x32_bf16 v[44:47],v[116:119],v[180:183],v[44:47]
v_mfma_f32_16x16x32_bf16 v[32:35],a[188:191],v[112:115],v[32:35]
v_mfma_f32_16x16x32_bf16 v[48:51],v[112:115],v[188:191],v[48:51]
v_mfma_f32_16x16x32_bf16 v[36:39],a[188:191],v[116:119],v[36:39]
v_mfma_f32_16x16x32_bf16 v[52:55],v[116:119],v[188:191],v[52:55]
s_waitcnt lgkmcnt(2)
v_mfma_f32_16x16x32_bf16 v[24:27],a[192:195],v[120:123],v[24:27]
ds_read_b128 v[112:115],v6 offset:16384
v_mfma_f32_16x16x32_bf16 v[40:43],v[120:123],v[192:195],v[40:43]
v_mfma_f32_16x16x32_bf16 v[28:31],a[192:195],v[124:127],v[28:31]
ds_read_b128 v[116:119],v6 offset:20480
v_mfma_f32_16x16x32_bf16 v[44:47],v[124:127],v[192:195],v[44:47]
v_mfma_f32_16x16x32_bf16 v[32:35],a[200:203],v[120:123],v[32:35]
v_mfma_f32_16x16x32_bf16 v[48:51],v[120:123],v[200:203],v[48:51]
v_mfma_f32_16x16x32_bf16 v[36:39],a[200:203],v[124:127],v[36:39]
v_mfma_f32_16x16x32_bf16 v[52:55],v[124:127],v[200:203],v[52:55]
s_waitcnt lgkmcnt(2)
v_mfma_f32_16x16x32_bf16 v[24:27],a[196:199],v[104:107],v[24:27]
ds_read_b128 v[120:123],v7 offset:16384
v_mfma_f32_16x16x32_bf16 v[40:43],v[104:107],v[196:199],v[40:43]
v_mfma_f32_16x16x32_bf16 v[28:31],a[196:199],v[108:111],v[28:31]
ds_read_b128 v[124:127],v7 offset:20480
v_mfma_f32_16x16x32_bf16 v[44:47],v[108:111],v[196:199],v[44:47]
v_mfma_f32_16x16x32_bf16 v[32:35],a[204:207],v[104:107],v[32:35]
v_mfma_f32_16x16x32_bf16 v[48:51],v[104:107],v[204:207],v[48:51]
v_mfma_f32_16x16x32_bf16 v[36:39],a[204:207],v[108:111],v[36:39]
v_mfma_f32_16x16x32_bf16 v[52:55],v[108:111],v[204:207],v[52:55]
s_waitcnt vmcnt(0)
s_barrier
s_waitcnt lgkmcnt(2)
v_mfma_f32_16x16x32_bf16 v[24:27],a[208:211],v[112:115],v[24:27]
ds_read_b128 v[104:107],v4 offset:24576
v_mfma_f32_16x16x32_bf16 v[40:43],v[112:115],v[208:211],v[40:43]
v_mfma_f32_16x16x32_bf16 v[28:31],a[208:211],v[116:119],v[28:31]
ds_read_b128 v[108:111],v4 offset:28672
v_mfma_f32_16x16x32_bf16 v[44:47],v[116:119],v[208:211],v[44:47]
v_mfma_f32_16x16x32_bf16 v[32:35],a[216:219],v[112:115],v[32:35]
v_mfma_f32_16x16x32_bf16 v[48:51],v[112:115],v[216:219],v[48:51]
v_mfma_f32_16x16x32_bf16 v[36:39],a[216:219],v[116:119],v[36:39]
v_mfma_f32_16x16x32_bf16 v[52:55],v[116:119],v[216:219],v[52:55]
s_waitcnt lgkmcnt(2)
v_mfma_f32_16x16x32_bf16 v[24:27],a[212:215],v[120:123],v[24:27]
ds_read_b128 v[112:115],v5 offset:24576
v_mfma_f32_16x16x32_bf16 v[40:43],v[120:123],v[212:215],v[40:43]
v_mfma_f32_16x16x32_bf16 v[28:31],a[212:215],v[124:127],v[28:31]
ds_read_b128 v[116:119],v5 offset:28672
v_mfma_f32_16x16x32_bf16 v[44:47],v[124:127],v[212:215],v[44:47]
v_mfma_f32_16x16x32_bf16 v[32:35],a[220:223],v[120:123],v[32:35]
v_mfma_f32_16x16x32_bf16 v[48:51],v[120:123],v[220:223],v[48:51]
v_mfma_f32_16x16x32_bf16 v[36:39],a[220:223],v[124:127],v[36:39]
v_mfma_f32_16x16x32_bf16 v[52:55],v[124:127],v[220:223],v[52:55]
s_waitcnt lgkmcnt(2)
v_mfma_f32_16x16x32_bf16 v[24:27],a[224:227],v[104:107],v[24:27]
ds_read_b128 v[120:123],v6 offset:24576
v_mfma_f32_16x16x32_bf16 v[40:43],v[104:107],v[224:227],v[40:43]
v_mfma_f32_16x16x32_bf16 v[28:31],a[224:227],v[108:111],v[28:31]
ds_read_b128 v[124:127],v6 offset:28672
v_mfma_f32_16x16x32_bf16 v[44:47],v[108:111],v[224:227],v[44:47]
v_mfma_f32_16x16x32_bf16 v[32:35],a[232:235],v[104:107],v[32:35]
v_mfma_f32_16x16x32_bf16 v[48:51],v[104:107],v[232:235],v[48:51]
v_mfma_f32_16x16x32_bf16 v[36:39],a[232:235],v[108:111],v[36:39]
v_mfma_f32_16x16x32_bf16 v[52:55],v[108:111],v[232:235],v[52:55]
s_waitcnt lgkmcnt(2)
v_mfma_f32_16x16x32_bf16 v[24:27],a[228:231],v[112:115],v[24:27]
ds_read_b128 v[104:107],v7 offset:24576
v_mfma_f32_16x16x32_bf16 v[40:43],v[112:115],v[228:231],v[40:43]
v_mfma_f32_16x16x32_bf16 v[28:31],a[228:231],v[116:119],v[28:31]
ds_read_b128 v[108:111],v7 offset:28672
v_mfma_f32_16x16x32_bf16 v[44:47],v[116:119],v[228:231],v[44:47]
v_mfma_f32_16x16x32_bf16 v[32:35],a[236:239],v[112:115],v[32:35]
v_mfma_f32_16x16x32_bf16 v[48:51],v[112:115],v[236:239],v[48:51]
v_mfma_f32_16x16x32_bf16 v[36:39],a[236:239],v[116:119],v[36:39]
v_mfma_f32_16x16x32_bf16 v[52:55],v[116:119],v[236:239],v[52:55]
s_waitcnt lgkmcnt(2)
v_mfma_f32_16x16x32_bf16 v[24:27],a[240:243],v[120:123],v[24:27]
ds_read_b128 v[112:115],v4 offset:0
v_mfma_f32_16x16x32_bf16 v[40:43],v[120:123],v[240:243],v[40:43]
v_mfma_f32_16x16x32_bf16 v[28:31],a[240:243],v[124:127],v[28:31]
ds_read_b128 v[116:119],v4 offset:4096
v_mfma_f32_16x16x32_bf16 v[44:47],v[124:127],v[240:243],v[44:47]
v_mfma_f32_16x16x32_bf16 v[32:35],a[248:251],v[120:123],v[32:35]
v_mfma_f32_16x16x32_bf16 v[48:51],v[120:123],v[248:251],v[48:51]
v_mfma_f32_16x16x32_bf16 v[36:39],a[248:251],v[124:127],v[36:39]
v_mfma_f32_16x16x32_bf16 v[52:55],v[124:127],v[248:251],v[52:55]
s_waitcnt lgkmcnt(2)
v_mfma_f32_16x16x32_bf16 v[24:27],a[244:247],v[104:107],v[24:27]
ds_read_b128 v[120:123],v5 offset:0
v_mfma_f32_16x16x32_bf16 v[40:43],v[104:107],v[244:247],v[40:43]
v_mfma_f32_16x16x32_bf16 v[28:31],a[244:247],v[108:111],v[28:31]
ds_read_b128 v[124:127],v5 offset:4096
v_mfma_f32_16x16x32_bf16 v[44:47],v[108:111],v[244:247],v[44:47]
v_mfma_f32_16x16x32_bf16 v[32:35],a[252:255],v[104:107],v[32:35]
v_mfma_f32_16x16x32_bf16 v[48:51],v[104:107],v[252:255],v[48:51]
v_mfma_f32_16x16x32_bf16 v[36:39],a[252:255],v[108:111],v[36:39]
v_mfma_f32_16x16x32_bf16 v[52:55],v[108:111],v[252:255],v[52:55]
s_waitcnt lgkmcnt(2)
v_mfma_f32_16x16x32_bf16 v[88:91],a[0:3],v[112:115],0
ds_read_b128 v[104:107],v6 offset:0
v_mfma_f32_16x16x32_bf16 v[92:95],a[0:3],v[116:119],0
v_mfma_f32_16x16x32_bf16 v[96:99],a[8:11],v[112:115],0
ds_read_b128 v[108:111],v6 offset:4096
v_mfma_f32_16x16x32_bf16 v[100:103],a[8:11],v[116:119],0
s_waitcnt lgkmcnt(2)
v_mfma_f32_16x16x32_bf16 v[88:91],a[4:7],v[120:123],v[88:91]
ds_read_b128 v[112:115],v7 offset:0
v_mfma_f32_16x16x32_bf16 v[92:95],a[4:7],v[124:127],v[92:95]
v_cvt_pk_bf16_f32 v56,v24,v32
v_cvt_pk_bf16_f32 v57,v25,v33
v_mfma_f32_16x16x32_bf16 v[96:99],a[12:15],v[120:123],v[96:99]
ds_read_b128 v[116:119],v7 offset:4096
v_mfma_f32_16x16x32_bf16 v[100:103],a[12:15],v[124:127],v[100:103]
v_cvt_pk_bf16_f32 v58,v26,v34
v_cvt_pk_bf16_f32 v59,v27,v35
s_waitcnt lgkmcnt(2)
v_mfma_f32_16x16x32_bf16 v[88:91],a[16:19],v[104:107],v[88:91]
ds_read_b128 v[120:123],v4 offset:8192
v_mfma_f32_16x16x32_bf16 v[92:95],a[16:19],v[108:111],v[92:95]
buffer_store_dwordx4 v[56:59],v0,s[8:11],s61 offen sc1
v_cvt_pk_bf16_f32 v60,v28,v36
v_mfma_f32_16x16x32_bf16 v[96:99],a[24:27],v[104:107],v[96:99]
ds_read_b128 v[124:127],v4 offset:12288
v_mfma_f32_16x16x32_bf16 v[100:103],a[24:27],v[108:111],v[100:103]
v_cvt_pk_bf16_f32 v61,v29,v37
v_cvt_pk_bf16_f32 v62,v30,v38
s_waitcnt lgkmcnt(2)
v_mfma_f32_16x16x32_bf16 v[88:91],a[20:23],v[112:115],v[88:91]
ds_read_b128 v[104:107],v5 offset:8192
v_mfma_f32_16x16x32_bf16 v[92:95],a[20:23],v[116:119],v[92:95]
v_cvt_pk_bf16_f32 v63,v31,v39
buffer_store_dwordx4 v[60:63],v0,s[8:11],s62 offen sc1
v_mfma_f32_16x16x32_bf16 v[96:99],a[28:31],v[112:115],v[96:99]
ds_read_b128 v[108:111],v5 offset:12288
v_mfma_f32_16x16x32_bf16 v[100:103],a[28:31],v[116:119],v[100:103]
v_cvt_pk_bf16_f32 v64,v40,v41
v_cvt_pk_bf16_f32 v65,v42,v43
s_waitcnt lgkmcnt(2)
v_mfma_f32_16x16x32_bf16 v[88:91],a[32:35],v[120:123],v[88:91]
ds_read_b128 v[112:115],v6 offset:8192
v_mfma_f32_16x16x32_bf16 v[92:95],a[32:35],v[124:127],v[92:95]
v_cvt_pk_bf16_f32 v66,v44,v45
v_cvt_pk_bf16_f32 v67,v46,v47
v_mfma_f32_16x16x32_bf16 v[96:99],a[40:43],v[120:123],v[96:99]
ds_read_b128 v[116:119],v6 offset:12288
v_mfma_f32_16x16x32_bf16 v[100:103],a[40:43],v[124:127],v[100:103]
buffer_store_dwordx4 v[64:67],v0,s[8:11],s65 offen offset:0 sc1
v_cvt_pk_bf16_f32 v68,v48,v49
s_waitcnt lgkmcnt(2)
v_mfma_f32_16x16x32_bf16 v[88:91],a[36:39],v[104:107],v[88:91]
ds_read_b128 v[120:123],v7 offset:8192
v_mfma_f32_16x16x32_bf16 v[92:95],a[36:39],v[108:111],v[92:95]
v_cvt_pk_bf16_f32 v69,v50,v51
v_cvt_pk_bf16_f32 v70,v52,v53
v_mfma_f32_16x16x32_bf16 v[96:99],a[44:47],v[104:107],v[96:99]
ds_read_b128 v[124:127],v7 offset:12288
v_mfma_f32_16x16x32_bf16 v[100:103],a[44:47],v[108:111],v[100:103]
v_cvt_pk_bf16_f32 v71,v54,v55
buffer_store_dwordx4 v[68:71],v0,s[8:11],s65 offen offset:1024 sc1
s_waitcnt lgkmcnt(2)
v_mfma_f32_16x16x32_bf16 v[88:91],a[48:51],v[112:115],v[88:91]
ds_read_b128 v[104:107],v4 offset:16384
v_mfma_f32_16x16x32_bf16 v[92:95],a[48:51],v[116:119],v[92:95]
v_mfma_f32_16x16x32_bf16 v[96:99],a[56:59],v[112:115],v[96:99]
ds_read_b128 v[108:111],v4 offset:20480
v_mfma_f32_16x16x32_bf16 v[100:103],a[56:59],v[116:119],v[100:103]
s_waitcnt lgkmcnt(2)
v_mfma_f32_16x16x32_bf16 v[88:91],a[52:55],v[120:123],v[88:91]
ds_read_b128 v[112:115],v5 offset:16384
v_mfma_f32_16x16x32_bf16 v[92:95],a[52:55],v[124:127],v[92:95]
v_mfma_f32_16x16x32_bf16 v[96:99],a[60:63],v[120:123],v[96:99]
ds_read_b128 v[116:119],v5 offset:20480
v_mfma_f32_16x16x32_bf16 v[100:103],a[60:63],v[124:127],v[100:103]
s_waitcnt lgkmcnt(2)
v_mfma_f32_16x16x32_bf16 v[88:91],a[64:67],v[104:107],v[88:91]
ds_read_b128 v[120:123],v6 offset:16384
v_mfma_f32_16x16x32_bf16 v[92:95],a[64:67],v[108:111],v[92:95]
v_mfma_f32_16x16x32_bf16 v[96:99],a[72:75],v[104:107],v[96:99]
ds_read_b128 v[124:127],v6 offset:20480
v_mfma_f32_16x16x32_bf16 v[100:103],a[72:75],v[108:111],v[100:103]
s_waitcnt lgkmcnt(2)
v_mfma_f32_16x16x32_bf16 v[88:91],a[68:71],v[112:115],v[88:91]
ds_read_b128 v[104:107],v7 offset:16384
v_mfma_f32_16x16x32_bf16 v[92:95],a[68:71],v[116:119],v[92:95]
v_mfma_f32_16x16x32_bf16 v[96:99],a[76:79],v[112:115],v[96:99]
ds_read_b128 v[108:111],v7 offset:20480
v_mfma_f32_16x16x32_bf16 v[100:103],a[76:79],v[116:119],v[100:103]
s_waitcnt lgkmcnt(2)
v_mfma_f32_16x16x32_bf16 v[88:91],a[80:83],v[120:123],v[88:91]
ds_read_b128 v[112:115],v4 offset:24576
v_mfma_f32_16x16x32_bf16 v[92:95],a[80:83],v[124:127],v[92:95]
v_mfma_f32_16x16x32_bf16 v[96:99],a[88:91],v[120:123],v[96:99]
ds_read_b128 v[116:119],v4 offset:28672
v_mfma_f32_16x16x32_bf16 v[100:103],a[88:91],v[124:127],v[100:103]
s_waitcnt lgkmcnt(2)
v_mfma_f32_16x16x32_bf16 v[88:91],a[84:87],v[104:107],v[88:91]
ds_read_b128 v[120:123],v5 offset:24576
v_mfma_f32_16x16x32_bf16 v[92:95],a[84:87],v[108:111],v[92:95]
v_mfma_f32_16x16x32_bf16 v[96:99],a[92:95],v[104:107],v[96:99]
ds_read_b128 v[124:127],v5 offset:28672
v_mfma_f32_16x16x32_bf16 v[100:103],a[92:95],v[108:111],v[100:103]
s_waitcnt lgkmcnt(2)
v_mfma_f32_16x16x32_bf16 v[88:91],a[96:99],v[112:115],v[88:91]
ds_read_b128 v[104:107],v6 offset:24576
v_mfma_f32_16x16x32_bf16 v[92:95],a[96:99],v[116:119],v[92:95]
v_mfma_f32_16x16x32_bf16 v[96:99],a[104:107],v[112:115],v[96:99]
ds_read_b128 v[108:111],v6 offset:28672
v_mfma_f32_16x16x32_bf16 v[100:103],a[104:107],v[116:119],v[100:103]
s_waitcnt lgkmcnt(2)
v_mfma_f32_16x16x32_bf16 v[88:91],a[100:103],v[120:123],v[88:91]
ds_read_b128 v[112:115],v7 offset:24576
v_mfma_f32_16x16x32_bf16 v[92:95],a[100:103],v[124:127],v[92:95]
v_mfma_f32_16x16x32_bf16 v[96:99],a[108:111],v[120:123],v[96:99]
ds_read_b128 v[116:119],v7 offset:28672
v_mfma_f32_16x16x32_bf16 v[100:103],a[108:111],v[124:127],v[100:103]
s_waitcnt lgkmcnt(2)
v_mfma_f32_16x16x32_bf16 v[88:91],a[112:115],v[104:107],v[88:91]
v_mfma_f32_16x16x32_bf16 v[92:95],a[112:115],v[108:111],v[92:95]
v_mfma_f32_16x16x32_bf16 v[96:99],a[120:123],v[104:107],v[96:99]
v_mfma_f32_16x16x32_bf16 v[100:103],a[120:123],v[108:111],v[100:103]
s_waitcnt lgkmcnt(0)
v_mfma_f32_16x16x32_bf16 v[88:91],a[116:119],v[112:115],v[88:91]
v_mfma_f32_16x16x32_bf16 v[92:95],a[116:119],v[116:119],v[92:95]
v_mfma_f32_16x16x32_bf16 v[96:99],a[124:127],v[112:115],v[96:99]
v_mfma_f32_16x16x32_bf16 v[100:103],a[124:127],v[116:119],v[100:103]
s_nop 3
v_cvt_pk_bf16_f32 v104,v88,v96
v_cvt_pk_bf16_f32 v105,v89,v97
v_cvt_pk_bf16_f32 v106,v90,v98
v_cvt_pk_bf16_f32 v107,v91,v99
v_cvt_pk_bf16_f32 v108,v92,v100
v_cvt_pk_bf16_f32 v109,v93,v101
v_cvt_pk_bf16_f32 v110,v94,v102
v_cvt_pk_bf16_f32 v111,v95,v103
buffer_store_dwordx4 v[104:107],v0,s[8:11],s63 offen sc1
buffer_store_dwordx4 v[108:111],v0,s[8:11],s64 offen sc1
s_lshl_b32 s59,s51,13
s_lshl2_add_u32 s59,s47,s59
s_add_u32 s59,s59,10486016
s_waitcnt vmcnt(2)
s_barrier
s_or_b32 s59,s59,s52
buffer_store_dword v17,off,s[8:11],s59 sc1
s_add_u32 m0,s50,131072
s_nop 0
buffer_load_dwordx4 v20,s[8:11],s70 offen offset:0 sc1 lds
s_add_u32 m0,s50,135168
s_nop 0
buffer_load_dwordx4 v20,s[8:11],s71 offen offset:0 sc1 lds
s_add_u32 m0,s50,139008
s_nop 0
buffer_load_dwordx4 v20,s[8:11],s70 offen offset:256 sc1 lds
s_add_u32 m0,s50,143104
s_nop 0
buffer_load_dwordx4 v20,s[8:11],s71 offen offset:256 sc1 lds
s_add_u32 m0,s50,146944
s_nop 0
buffer_load_dwordx4 v20,s[8:11],s70 offen offset:512 sc1 lds
s_add_u32 m0,s50,151040
s_nop 0
buffer_load_dwordx4 v20,s[8:11],s71 offen offset:512 sc1 lds
s_lshl_b32 s59,s51,13
s_lshl2_add_u32 s59,s47,s59
s_add_u32 s59,s59,10487680
s_waitcnt vmcnt(0)
s_barrier
s_or_b32 s59,s59,s52
buffer_store_dword v17,off,s[8:11],s59 sc1
L_mo_22:
s_mov_b32 s77,-1
s_sub_u32 s56,s30,s31
s_cmp_eq_u32 s73,0
s_cselect_b32 s57,22,8
s_add_u32 s57,s57,s73
s_min_u32 s57,s57,60
s_cmp_lt_i32 s56,s57
s_cbranch_scc1 L_mo_19
s_waitcnt vmcnt(0)
s_barrier
s_or_b32 s72,s72,s52
buffer_store_dword v17,off,s[8:11],s72 sc1
s_mov_b32 s72,0x80000000
s_cmp_lt_u32 s31,64
s_cbranch_scc1 L_mo_18
s_mov_b32 s51,64
v_lshrrev_b32 v2,3,v1
v_and_b32 v3,7,v1
v_lshlrev_b32 v3,4,v3
v_lshl_add_u32 v3,v2,13,v3
s_lshr_b64 s[88:89],s[84:85],0
v_lshrrev_b32 v60,v2,s88
v_and_b32 v60,1,v60
v_mul_u32_u24 v60,768,v60
v_sub_u32 v60,v3,v60
v_add_u32 v60,10487296,v60
s_lshr_b64 s[88:89],s[84:85],8
v_lshrrev_b32 v61,v2,s88
v_and_b32 v61,1,v61
v_mul_u32_u24 v61,768,v61
v_sub_u32 v61,v3,v61
v_add_u32 v61,10552832,v61
s_lshr_b64 s[88:89],s[84:85],16
v_lshrrev_b32 v62,v2,s88
v_and_b32 v62,1,v62
v_mul_u32_u24 v62,768,v62
v_sub_u32 v62,v3,v62
v_add_u32 v62,10618368,v62
s_lshr_b64 s[88:89],s[84:85],24
v_lshrrev_b32 v63,v2,s88
v_and_b32 v63,1,v63
v_mul_u32_u24 v63,768,v63
v_sub_u32 v63,v3,v63
v_add_u32 v63,10683904,v63
s_lshr_b64 s[88:89],s[84:85],32
v_lshrrev_b32 v64,v2,s88
v_and_b32 v64,1,v64
v_mul_u32_u24 v64,768,v64
v_sub_u32 v64,v3,v64
v_add_u32 v64,10749440,v64
s_lshr_b64 s[88:89],s[84:85],40
v_lshrrev_b32 v65,v2,s88
v_and_b32 v65,1,v65
v_mul_u32_u24 v65,768,v65
v_sub_u32 v65,v3,v65
v_add_u32 v65,10814976,v65
s_lshr_b64 s[88:89],s[84:85],48
v_lshrrev_b32 v66,v2,s88
v_and_b32 v66,1,v66
v_mul_u32_u24 v66,768,v66
v_sub_u32 v66,v3,v66
v_add_u32 v66,10880512,v66
s_lshr_b64 s[88:89],s[84:85],56
v_lshrrev_b32 v67,v2,s88
v_and_b32 v67,1,v67
v_mul_u32_u24 v67,768,v67
v_sub_u32 v67,v3,v67
v_add_u32 v67,10946048,v67
L_mw_32:
s_sleep 2
buffer_load_dwordx4 v[24:27],v60,s[8:11],0 offen sc1
buffer_load_dwordx4 v[28:31],v61,s[8:11],0 offen sc1
buffer_load_dwordx4 v[32:35],v62,s[8:11],0 offen sc1
buffer_load_dwordx4 v[36:39],v63,s[8:11],0 offen sc1
buffer_load_dwordx4 v[40:43],v64,s[8:11],0 offen sc1
buffer_load_dwordx4 v[44:47],v65,s[8:11],0 offen sc1
buffer_load_dwordx4 v[48:51],v66,s[8:11],0 offen sc1
buffer_load_dwordx4 v[52:55],v67,s[8:11],0 offen sc1
s_sub_u32 s49,s49,1
s_cbranch_scc1 L_abort
s_waitcnt vmcnt(0)
v_min_u32 v56,v24,v25
v_min3_u32 v56,v26,v27,v56
v_min3_u32 v56,v28,v29,v56
v_min3_u32 v56,v30,v31,v56
v_min3_u32 v56,v32,v33,v56
v_min3_u32 v56,v34,v35,v56
v_min3_u32 v56,v36,v37,v56
v_min3_u32 v56,v38,v39,v56
v_min3_u32 v56,v40,v41,v56
v_min3_u32 v56,v42,v43,v56
v_min3_u32 v56,v44,v45,v56
v_min3_u32 v56,v46,v47,v56
v_min3_u32 v56,v48,v49,v56
v_min3_u32 v56,v50,v51,v56
v_min3_u32 v56,v52,v53,v56
v_min3_u32 v56,v54,v55,v56
v_cmp_eq_u32 vcc,0,v56
s_cbranch_vccnz L_mw_32
v_max_u32 v24,v24,v25
v_max3_u32 v24,v26,v27,v24
v_max3_u32 v24,v28,v29,v24
v_max3_u32 v24,v30,v31,v24
v_max3_u32 v24,v32,v33,v24
v_max3_u32 v24,v34,v35,v24
v_max3_u32 v24,v36,v37,v24
v_max3_u32 v24,v38,v39,v24
v_max3_u32 v24,v40,v41,v24
v_max3_u32 v24,v42,v43,v24
v_max3_u32 v24,v44,v45,v24
v_max3_u32 v24,v46,v47,v24
v_max3_u32 v24,v48,v49,v24
v_max3_u32 v24,v50,v51,v24
v_max3_u32 v24,v52,v53,v24
v_max3_u32 v24,v54,v55,v24
s_nop 1
v_max_u32_dpp v24,v24,v24 row_ror:8 row_mask:0xf bank_mask:0xf
s_nop 1
v_max_u32_dpp v24,v24,v24 row_ror:4 row_mask:0xf bank_mask:0xf
s_nop 1
v_max_u32_dpp v24,v24,v24 row_ror:2 row_mask:0xf bank_mask:0xf
s_nop 1
v_max_u32_dpp v24,v24,v24 row_ror:1 row_mask:0xf bank_mask:0xf
v_mov_b32 v25,v24
s_nop 1
v_permlane16_swap_b32 v24,v25
v_max_u32 v24,v24,v25
v_mov_b32 v25,v24
s_nop 1
v_permlane32_swap_b32 v24,v25
v_max_u32 v24,v24,v25
s_nop 0
v_readfirstlane_b32 s55,v24
s_and_b32 s64,s55,0x7ff
s_sub_u32 s64,2047,s64
s_lshl_b32 s56,s64,10
s_add_u32 s58,s56,6291456
buffer_load_dwordx4 v[88:91],v0,s[8:11],s58 offen sc1
s_mov_b32 s4,s38
s_mov_b32 s5,s39
s_mov_b32 s6,1835008
s_mov_b32 s7,0x20000
v_and_b32 v9,15,v1
v_lshrrev_b32 v10,4,v1
v_lshlrev_b32 v8,14,v10
v_lshl_add_u32 v8,v9,4,v8
s_lshl_b32 s59,s47,16
s_lshl_b32 s60,s46,8
s_add_u32 s59,s59,s60
buffer_load_dwordx4 v[24:27],v8,s[4:7],s59 offen offset:0
buffer_load_dwordx4 v[28:31],v8,s[4:7],s59 offen offset:1024
buffer_load_dwordx4 v[32:35],v8,s[4:7],s59 offen offset:2048
buffer_load_dwordx4 v[36:39],v8,s[4:7],s59 offen offset:3072
s_add_u32 s59,s59,4096
buffer_load_dwordx4 v[40:43],v8,s[4:7],s59 offen offset:0
buffer_load_dwordx4 v[44:47],v8,s[4:7],s59 offen offset:1024
buffer_load_dwordx4 v[48:51],v8,s[4:7],s59 offen offset:2048
buffer_load_dwordx4 v[52:55],v8,s[4:7],s59 offen offset:3072
s_add_u32 s59,s59,4096
buffer_load_dwordx4 v[56:59],v8,s[4:7],s59 offen offset:0
buffer_load_dwordx4 v[60:63],v8,s[4:7],s59 offen offset:1024
buffer_load_dwordx4 v[64:67],v8,s[4:7],s59 offen offset:2048
buffer_load_dwordx4 v[68:71],v8,s[4:7],s59 offen offset:3072
s_add_u32 s59,s59,4096
buffer_load_dwordx4 v[72:75],v8,s[4:7],s59 offen offset:0
buffer_load_dwordx4 v[76:79],v8,s[4:7],s59 offen offset:1024
buffer_load_dwordx4 v[80:83],v8,s[4:7],s59 offen offset:2048
buffer_load_dwordx4 v[84:87],v8,s[4:7],s59 offen offset:3072
v_and_b32 v124,1,v1
v_lshlrev_b32 v124,4,v124
v_mov_b32 v125,0xffff
v_lshlrev_b32 v125,v124,v125
v_lshrrev_b32 v124,1,v9
v_cmp_eq_u32 vcc,0,v124
s_nop 1
v_cndmask_b32 v12,0,v125,vcc
v_cmp_eq_u32 vcc,1,v124
s_nop 1
v_cndmask_b32 v13,0,v125,vcc
v_cmp_eq_u32 vcc,2,v124
s_nop 1
v_cndmask_b32 v14,0,v125,vcc
v_cmp_eq_u32 vcc,3,v124
s_nop 1
v_cndmask_b32 v15,0,v125,vcc
s_waitcnt vmcnt(16)
v_lshlrev_b32 v96,16,v88
v_and_b32 v97,0xffff0000,v88
v_lshlrev_b32 v98,16,v89
v_and_b32 v99,0xffff0000,v89
v_lshlrev_b32 v100,16,v90
v_and_b32 v101,0xffff0000,v90
v_lshlrev_b32 v102,16,v91
v_and_b32 v103,0xffff0000,v91
v_readfirstlane_b32 s78,v96
s_nop 1
v_pk_add_f32 v[108:109],v[96:97],s[78:79] op_sel_hi:[1,0] neg_lo:[0,1] neg_hi:[0,1]
v_pk_add_f32 v[110:111],v[98:99],s[78:79] op_sel_hi:[1,0] neg_lo:[0,1] neg_hi:[0,1]
v_pk_add_f32 v[112:113],v[100:101],s[78:79] op_sel_hi:[1,0] neg_lo:[0,1] neg_hi:[0,1]
v_pk_add_f32 v[114:115],v[102:103],s[78:79] op_sel_hi:[1,0] neg_lo:[0,1] neg_hi:[0,1]
v_pk_add_f32 v[116:117],v[108:109],v[110:111]
v_pk_mul_f32 v[118:119],v[108:109],v[108:109]
v_pk_add_f32 v[120:121],v[112:113],v[114:115]
v_pk_fma_f32 v[118:119],v[110:111],v[110:111],v[118:119]
v_pk_add_f32 v[116:117],v[116:117],v[120:121]
v_pk_fma_f32 v[118:119],v[112:113],v[112:113],v[118:119]
v_add_f32 v116,v116,v117
v_pk_fma_f32 v[118:119],v[114:115],v[114:115],v[118:119]
v_add_f32 v118,v118,v119
s_nop 1
v_permlane32_swap_b32 v116,v118
v_add_f32 v116,v116,v118
s_nop 1
v_add_f32_dpp v116,v116,v116 row_ror:8 row_mask:0xf bank_mask:0xf
s_nop 1
v_add_f32_dpp v116,v116,v116 row_ror:4 row_mask:0xf bank_mask:0xf
s_nop 1
v_add_f32_dpp v116,v116,v116 row_ror:2 row_mask:0xf bank_mask:0xf
s_nop 1
v_add_f32_dpp v116,v116,v116 row_ror:1 row_mask:0xf bank_mask:0xf
v_mov_b32 v118,v116
s_nop 1
v_permlane16_swap_b32 v116,v118
v_add_f32 v116,v116,v118
v_mul_f32 v116,0x3b000000,v116
v_mov_b32 v118,v116
s_nop 1
v_permlane32_swap_b32 v116,v118
v_fma_f32 v118,-v116,v116,v118
v_add_f32 v116,s78,v116
v_max_f32 v118,0,v118
v_cvt_pk_bf16_f32 v118,v116,v118
v_lshlrev_b32 v116,16,v118
v_and_b32 v118,0xffff0000,v118
v_add_f32 v118,0x3727c5ac,v118
v_cvt_pk_bf16_f32 v118,v118,v118
v_and_b32 v118,0xffff0000,v118
v_sqrt_f32 v118,v118
v_pk_add_f32 v[108:109],v[96:97],v[116:117] op_sel_hi:[1,0] neg_lo:[0,1] neg_hi:[0,1]
v_pk_add_f32 v[110:111],v[98:99],v[116:117] op_sel_hi:[1,0] neg_lo:[0,1] neg_hi:[0,1]
v_pk_add_f32 v[112:113],v[100:101],v[116:117] op_sel_hi:[1,0] neg_lo:[0,1] neg_hi:[0,1]
v_pk_add_f32 v[114:115],v[102:103],v[116:117] op_sel_hi:[1,0] neg_lo:[0,1] neg_hi:[0,1]
v_cvt_pk_bf16_f32 v118,v118,v118
v_and_b32 v118,0xffff0000,v118
v_rcp_f32 v118,v118
v_cvt_pk_bf16_f32 v104,v108,v109
v_cvt_pk_bf16_f32 v105,v110,v111
v_cvt_pk_bf16_f32 v106,v112,v113
v_cvt_pk_bf16_f32 v107,v114,v115
v_lshlrev_b32 v108,16,v104
v_and_b32 v109,0xffff0000,v104
v_lshlrev_b32 v110,16,v105
v_and_b32 v111,0xffff0000,v105
v_lshlrev_b32 v112,16,v106
v_and_b32 v113,0xffff0000,v106
v_lshlrev_b32 v114,16,v107
v_and_b32 v115,0xffff0000,v107
v_pk_mul_f32 v[108:109],v[108:109],v[118:119] op_sel_hi:[1,0]
v_pk_mul_f32 v[110:111],v[110:111],v[118:119] op_sel_hi:[1,0]
v_pk_mul_f32 v[112:113],v[112:113],v[118:119] op_sel_hi:[1,0]
v_pk_mul_f32 v[114:115],v[114:115],v[118:119] op_sel_hi:[1,0]
v_cvt_pk_bf16_f32 v104,v108,v109
v_cvt_pk_bf16_f32 v105,v110,v111
v_cvt_pk_bf16_f32 v106,v112,v113
v_cvt_pk_bf16_f32 v107,v114,v115
s_mov_b32 s58,0x01000100
s_mov_b32 s59,0x03020302
v_perm_b32 v88,v104,v104,s58
v_perm_b32 v89,v104,v104,s59
v_perm_b32 v90,v105,v105,s58
v_perm_b32 v91,v105,v105,s59
v_perm_b32 v92,v106,v106,s58
v_perm_b32 v93,v106,v106,s59
v_perm_b32 v94,v107,v107,s58
v_perm_b32 v95,v107,v107,s59
v_lshlrev_b32 v8,5,v1
s_lshl_b32 s58,s46,11
s_add_u32 s58,s58,139264
v_add_u32 v8,s58,v8
ds_write_b128 v8,v[88:91]
ds_write_b128 v8,v[92:95] offset:16
s_lshl_b32 s59,s46,9
s_add_u32 s59,s58,s59
v_lshlrev_b32 v8,7,v10
v_add_u32 v8,s59,v8
s_waitcnt lgkmcnt(0)
ds_read_b128 v[108:111],v18 offset:0
ds_read_b128 v[88:91],v8 offset:0
ds_read_b128 v[92:95],v8 offset:16
ds_read_b128 v[112:115],v18 offset:1024
s_waitcnt lgkmcnt(1)
v_and_b32 v124,v12,v88
v_and_b32 v125,v13,v88
v_and_b32 v126,v14,v88
v_and_b32 v127,v15,v88
s_nop 1
v_mfma_f32_16x16x32_bf16 v[116:119],v[124:127],v[108:111],0
ds_read_b128 v[108:111],v18 offset:2048
s_waitcnt lgkmcnt(1)
v_and_b32 v124,v12,v89
v_and_b32 v125,v13,v89
v_and_b32 v126,v14,v89
v_and_b32 v127,v15,v89
s_nop 1
v_mfma_f32_16x16x32_bf16 v[116:119],v[124:127],v[112:115],v[116:119]
ds_read_b128 v[112:115],v18 offset:3072
s_waitcnt lgkmcnt(1)
v_and_b32 v124,v12,v90
v_and_b32 v125,v13,v90
v_and_b32 v126,v14,v90
v_and_b32 v127,v15,v90
s_nop 1
v_mfma_f32_16x16x32_bf16 v[116:119],v[124:127],v[108:111],v[116:119]
ds_read_b128 v[108:111],v18 offset:4096
s_waitcnt lgkmcnt(1)
v_and_b32 v124,v12,v91
v_and_b32 v125,v13,v91
v_and_b32 v126,v14,v91
v_and_b32 v127,v15,v91
s_nop 1
v_mfma_f32_16x16x32_bf16 v[116:119],v[124:127],v[112:115],v[116:119]
ds_read_b128 v[112:115],v18 offset:5120
s_waitcnt lgkmcnt(1)
v_and_b32 v124,v12,v92
v_and_b32 v125,v13,v92
v_and_b32 v126,v14,v92
v_and_b32 v127,v15,v92
s_nop 1
v_mfma_f32_16x16x32_bf16 v[116:119],v[124:127],v[108:111],v[116:119]
ds_read_b128 v[108:111],v18 offset:6144
s_waitcnt lgkmcnt(1)
v_and_b32 v124,v12,v93
v_and_b32 v125,v13,v93
v_and_b32 v126,v14,v93
v_and_b32 v127,v15,v93
s_nop 1
v_mfma_f32_16x16x32_bf16 v[116:119],v[124:127],v[112:115],v[116:119]
ds_read_b128 v[112:115],v18 offset:7168
s_waitcnt lgkmcnt(1)
v_and_b32 v124,v12,v94
v_and_b32 v125,v13,v94
v_and_b32 v126,v14,v94
v_and_b32 v127,v15,v94
s_nop 1
v_mfma_f32_16x16x32_bf16 v[116:119],v[124:127],v[108:111],v[116:119]
ds_read_b128 v[108:111],v18 offset:8192
s_waitcnt lgkmcnt(1)
v_and_b32 v124,v12,v95
v_and_b32 v125,v13,v95
v_and_b32 v126,v14,v95
v_and_b32 v127,v15,v95
s_nop 1
v_mfma_f32_16x16x32_bf16 v[116:119],v[124:127],v[112:115],v[116:119]
ds_read_b128 v[88:91],v8 offset:32
ds_read_b128 v[92:95],v8 offset:48
ds_read_b128 v[112:115],v18 offset:9216
s_waitcnt lgkmcnt(1)
v_and_b32 v124,v12,v88
v_and_b32 v125,v13,v88
v_and_b32 v126,v14,v88
v_and_b32 v127,v15,v88
s_nop 1
v_mfma_f32_16x16x32_bf16 v[116:119],v[124:127],v[108:111],v[116:119]
ds_read_b128 v[108:111],v18 offset:10240
s_waitcnt lgkmcnt(1)
v_and_b32 v124,v12,v89
v_and_b32 v125,v13,v89
v_and_b32 v126,v14,v89
v_and_b32 v127,v15,v89
s_nop 1
v_mfma_f32_16x16x32_bf16 v[116:119],v[124:127],v[112:115],v[116:119]
ds_read_b128 v[112:115],v18 offset:11264
s_waitcnt lgkmcnt(1)
v_and_b32 v124,v12,v90
v_and_b32 v125,v13,v90
v_and_b32 v126,v14,v90
v_and_b32 v127,v15,v90
s_nop 1
v_mfma_f32_16x16x32_bf16 v[116:119],v[124:127],v[108:111],v[116:119]
ds_read_b128 v[108:111],v18 offset:12288
s_waitcnt lgkmcnt(1)
v_and_b32 v124,v12,v91
v_and_b32 v125,v13,v91
v_and_b32 v126,v14,v91
v_and_b32 v127,v15,v91
s_nop 1
v_mfma_f32_16x16x32_bf16 v[116:119],v[124:127],v[112:115],v[116:119]
ds_read_b128 v[112:115],v18 offset:13312
s_waitcnt lgkmcnt(1)
v_and_b32 v124,v12,v92
v_and_b32 v125,v13,v92
v_and_b32 v126,v14,v92
v_and_b32 v127,v15,v92
s_nop 1
v_mfma_f32_16x16x32_bf16 v[116:119],v[124:127],v[108:111],v[116:119]
ds_read_b128 v[108:111],v18 offset:14336
s_waitcnt lgkmcnt(1)
v_and_b32 v124,v12,v93
v_and_b32 v125,v13,v93
v_and_b32 v126,v14,v93
v_and_b32 v127,v15,v93
s_nop 1
v_mfma_f32_16x16x32_bf16 v[116:119],v[124:127],v[112:115],v[116:119]
ds_read_b128 v[112:115],v18 offset:15360
s_waitcnt lgkmcnt(1)
v_and_b32 v124,v12,v94
v_and_b32 v125,v13,v94
v_and_b32 v126,v14,v94
v_and_b32 v127,v15,v94
s_nop 1
v_mfma_f32_16x16x32_bf16 v[116:119],v[124:127],v[108:111],v[116:119]
ds_read_b128 v[108:111],v18 offset:16384
s_waitcnt lgkmcnt(1)
v_and_b32 v124,v12,v95
v_and_b32 v125,v13,v95
v_and_b32 v126,v14,v95
v_and_b32 v127,v15,v95
s_nop 1
v_mfma_f32_16x16x32_bf16 v[116:119],v[124:127],v[112:115],v[116:119]
ds_read_b128 v[88:91],v8 offset:64
ds_read_b128 v[92:95],v8 offset:80
ds_read_b128 v[112:115],v18 offset:17408
s_waitcnt lgkmcnt(1)
v_and_b32 v124,v12,v88
v_and_b32 v125,v13,v88
v_and_b32 v126,v14,v88
v_and_b32 v127,v15,v88
s_nop 1
v_mfma_f32_16x16x32_bf16 v[116:119],v[124:127],v[108:111],v[116:119]
ds_read_b128 v[108:111],v18 offset:18432
s_waitcnt lgkmcnt(1)
v_and_b32 v124,v12,v89
v_and_b32 v125,v13,v89
v_and_b32 v126,v14,v89
v_and_b32 v127,v15,v89
s_nop 1
v_mfma_f32_16x16x32_bf16 v[116:119],v[124:127],v[112:115],v[116:119]
ds_read_b128 v[112:115],v18 offset:19456
s_waitcnt lgkmcnt(1)
v_and_b32 v124,v12,v90
v_and_b32 v125,v13,v90
v_and_b32 v126,v14,v90
v_and_b32 v127,v15,v90
s_nop 1
v_mfma_f32_16x16x32_bf16 v[116:119],v[124:127],v[108:111],v[116:119]
ds_read_b128 v[108:111],v18 offset:20480
s_waitcnt lgkmcnt(1)
v_and_b32 v124,v12,v91
v_and_b32 v125,v13,v91
v_and_b32 v126,v14,v91
v_and_b32 v127,v15,v91
s_nop 1
v_mfma_f32_16x16x32_bf16 v[116:119],v[124:127],v[112:115],v[116:119]
ds_read_b128 v[112:115],v18 offset:21504
s_waitcnt lgkmcnt(1)
v_and_b32 v124,v12,v92
v_and_b32 v125,v13,v92
v_and_b32 v126,v14,v92
v_and_b32 v127,v15,v92
s_nop 1
v_mfma_f32_16x16x32_bf16 v[116:119],v[124:127],v[108:111],v[116:119]
ds_read_b128 v[108:111],v18 offset:22528
s_waitcnt lgkmcnt(1)
v_and_b32 v124,v12,v93
v_and_b32 v125,v13,v93
v_and_b32 v126,v14,v93
v_and_b32 v127,v15,v93
s_nop 1
v_mfma_f32_16x16x32_bf16 v[116:119],v[124:127],v[112:115],v[116:119]
ds_read_b128 v[112:115],v18 offset:23552
s_waitcnt lgkmcnt(1)
v_and_b32 v124,v12,v94
v_and_b32 v125,v13,v94
v_and_b32 v126,v14,v94
v_and_b32 v127,v15,v94
s_nop 1
v_mfma_f32_16x16x32_bf16 v[116:119],v[124:127],v[108:111],v[116:119]
ds_read_b128 v[108:111],v18 offset:24576
s_waitcnt lgkmcnt(1)
v_and_b32 v124,v12,v95
v_and_b32 v125,v13,v95
v_and_b32 v126,v14,v95
v_and_b32 v127,v15,v95
s_nop 1
v_mfma_f32_16x16x32_bf16 v[116:119],v[124:127],v[112:115],v[116:119]
ds_read_b128 v[88:91],v8 offset:96
ds_read_b128 v[92:95],v8 offset:112
ds_read_b128 v[112:115],v18 offset:25600
s_waitcnt lgkmcnt(1)
v_and_b32 v124,v12,v88
v_and_b32 v125,v13,v88
v_and_b32 v126,v14,v88
v_and_b32 v127,v15,v88
s_nop 1
v_mfma_f32_16x16x32_bf16 v[116:119],v[124:127],v[108:111],v[116:119]
ds_read_b128 v[108:111],v18 offset:26624
s_waitcnt lgkmcnt(1)
v_and_b32 v124,v12,v89
v_and_b32 v125,v13,v89
v_and_b32 v126,v14,v89
v_and_b32 v127,v15,v89
s_nop 1
v_mfma_f32_16x16x32_bf16 v[116:119],v[124:127],v[112:115],v[116:119]
ds_read_b128 v[112:115],v18 offset:27648
s_waitcnt lgkmcnt(1)
v_and_b32 v124,v12,v90
v_and_b32 v125,v13,v90
v_and_b32 v126,v14,v90
v_and_b32 v127,v15,v90
s_nop 1
v_mfma_f32_16x16x32_bf16 v[116:119],v[124:127],v[108:111],v[116:119]
ds_read_b128 v[108:111],v18 offset:28672
s_waitcnt lgkmcnt(1)
v_and_b32 v124,v12,v91
v_and_b32 v125,v13,v91
v_and_b32 v126,v14,v91
v_and_b32 v127,v15,v91
s_nop 1
v_mfma_f32_16x16x32_bf16 v[116:119],v[124:127],v[112:115],v[116:119]
ds_read_b128 v[112:115],v18 offset:29696
s_waitcnt lgkmcnt(1)
v_and_b32 v124,v12,v92
v_and_b32 v125,v13,v92
v_and_b32 v126,v14,v92
v_and_b32 v127,v15,v92
s_nop 1
v_mfma_f32_16x16x32_bf16 v[116:119],v[124:127],v[108:111],v[116:119]
ds_read_b128 v[108:111],v18 offset:30720
s_waitcnt lgkmcnt(1)
v_and_b32 v124,v12,v93
v_and_b32 v125,v13,v93
v_and_b32 v126,v14,v93
v_and_b32 v127,v15,v93
s_nop 1
v_mfma_f32_16x16x32_bf16 v[116:119],v[124:127],v[112:115],v[116:119]
ds_read_b128 v[112:115],v18 offset:31744
s_waitcnt lgkmcnt(1)
v_and_b32 v124,v12,v94
v_and_b32 v125,v13,v94
v_and_b32 v126,v14,v94
v_and_b32 v127,v15,v94
s_nop 1
v_mfma_f32_16x16x32_bf16 v[116:119],v[124:127],v[108:111],v[116:119]
s_waitcnt lgkmcnt(0)
v_and_b32 v124,v12,v95
v_and_b32 v125,v13,v95
v_and_b32 v126,v14,v95
v_and_b32 v127,v15,v95
s_nop 1
v_mfma_f32_16x16x32_bf16 v[116:119],v[124:127],v[112:115],v[116:119]
v_lshlrev_b32 v8,5,v9
v_and_b32 v124,1,v10
v_lshl_add_u32 v8,v124,4,v8
v_lshrrev_b32 v124,1,v10
v_lshl_add_u32 v8,v124,11,v8
s_lshl_b32 s60,s46,9
s_add_u32 s60,s60,147456
v_add_u32 v8,s60,v8
ds_write_b128 v8,v[116:119]
v_lshlrev_b32 v8,2,v1
v_add_u32 v8,147456,v8
s_waitcnt lgkmcnt(0)
s_barrier
ds_read2st64_b32 v[88:89],v8 offset0:0 offset1:1
ds_read2st64_b32 v[90:91],v8 offset0:2 offset1:3
ds_read2st64_b32 v[92:93],v8 offset0:4 offset1:5
ds_read2st64_b32 v[94:95],v8 offset0:6 offset1:7
s_waitcnt lgkmcnt(0)
v_pk_add_f32 v[88:89],v[88:89],v[90:91]
v_pk_add_f32 v[92:93],v[92:93],v[94:95]
v_pk_add_f32 v[88:89],v[88:89],v[92:93]
v_cvt_pk_bf16_f32 v88,v88,v88
v_and_b32 v88,0xffff0000,v88
v_cvt_pk_bf16_f32 v89,v89,v89
v_and_b32 v89,0xffff0000,v89
v_mul_f32 v90,0xbfb8aa3b,v88
v_exp_f32 v90,v90
s_nop 0
v_add_f32 v90,1.0,v90
v_rcp_f32 v90,v90
s_nop 0
v_mul_f32 v88,v88,v90
v_cvt_pk_bf16_f32 v88,v88,v88
v_and_b32 v88,0xffff0000,v88
v_mul_f32 v88,v88,v89
v_cvt_pk_bf16_f32 v88,v88,v88
v_lshlrev_b32 v8,2,v1
v_add_u32 v8,s58,v8
ds_write_b32 v8,v88
v_lshlrev_b32 v8,6,v10
v_add_u32 v8,s58,v8
s_waitcnt lgkmcnt(0)
ds_read_b128 v[88:91],v8
ds_read_b128 v[92:95],v8 offset:16
ds_read_b128 v[108:111],v8 offset:32
ds_read_b128 v[112:115],v8 offset:48
s_waitcnt vmcnt(0) lgkmcnt(0)
v_and_b32 v124,v12,v88
v_and_b32 v125,v13,v88
v_and_b32 v126,v14,v88
v_and_b32 v127,v15,v88
s_nop 1
v_mfma_f32_16x16x32_bf16 v[116:119],v[124:127],v[24:27],0
v_and_b32 v124,v12,v89
v_and_b32 v125,v13,v89
v_and_b32 v126,v14,v89
v_and_b32 v127,v15,v89
s_nop 1
v_mfma_f32_16x16x32_bf16 v[116:119],v[124:127],v[28:31],v[116:119]
v_and_b32 v124,v12,v90
v_and_b32 v125,v13,v90
v_and_b32 v126,v14,v90
v_and_b32 v127,v15,v90
s_nop 1
v_mfma_f32_16x16x32_bf16 v[116:119],v[124:127],v[32:35],v[116:119]
v_and_b32 v124,v12,v91
v_and_b32 v125,v13,v91
v_and_b32 v126,v14,v91
v_and_b32 v127,v15,v91
s_nop 1
v_mfma_f32_16x16x32_bf16 v[116:119],v[124:127],v[36:39],v[116:119]
v_and_b32 v124,v12,v92
v_and_b32 v125,v13,v92
v_and_b32 v126,v14,v92
v_and_b32 v127,v15,v92
s_nop 1
v_mfma_f32_16x16x32_bf16 v[116:119],v[124:127],v[40:43],v[116:119]
v_and_b32 v124,v12,v93
v_and_b32 v125,v13,v93
v_and_b32 v126,v14,v93
v_and_b32 v127,v15,v93
s_nop 1
v_mfma_f32_16x16x32_bf16 v[116:119],v[124:127],v[44:47],v[116:119]
v_and_b32 v124,v12,v94
v_and_b32 v125,v13,v94
v_and_b32 v126,v14,v94
v_and_b32 v127,v15,v94
s_nop 1
v_mfma_f32_16x16x32_bf16 v[116:119],v[124:127],v[48:51],v[116:119]
v_and_b32 v124,v12,v95
v_and_b32 v125,v13,v95
v_and_b32 v126,v14,v95
v_and_b32 v127,v15,v95
s_nop 1
v_mfma_f32_16x16x32_bf16 v[116:119],v[124:127],v[52:55],v[116:119]
v_and_b32 v124,v12,v108
v_and_b32 v125,v13,v108
v_and_b32 v126,v14,v108
v_and_b32 v127,v15,v108
s_nop 1
v_mfma_f32_16x16x32_bf16 v[116:119],v[124:127],v[56:59],v[116:119]
v_and_b32 v124,v12,v109
v_and_b32 v125,v13,v109
v_and_b32 v126,v14,v109
v_and_b32 v127,v15,v109
s_nop 1
v_mfma_f32_16x16x32_bf16 v[116:119],v[124:127],v[60:63],v[116:119]
v_and_b32 v124,v12,v110
v_and_b32 v125,v13,v110
v_and_b32 v126,v14,v110
v_and_b32 v127,v15,v110
s_nop 1
v_mfma_f32_16x16x32_bf16 v[116:119],v[124:127],v[64:67],v[116:119]
v_and_b32 v124,v12,v111
v_and_b32 v125,v13,v111
v_and_b32 v126,v14,v111
v_and_b32 v127,v15,v111
s_nop 1
v_mfma_f32_16x16x32_bf16 v[116:119],v[124:127],v[68:71],v[116:119]
v_and_b32 v124,v12,v112
v_and_b32 v125,v13,v112
v_and_b32 v126,v14,v112
v_and_b32 v127,v15,v112
s_nop 1
v_mfma_f32_16x16x32_bf16 v[116:119],v[124:127],v[72:75],v[116:119]
v_and_b32 v124,v12,v113
v_and_b32 v125,v13,v113
v_and_b32 v126,v14,v113
v_and_b32 v127,v15,v113
s_nop 1
v_mfma_f32_16x16x32_bf16 v[116:119],v[124:127],v[76:79],v[116:119]
v_and_b32 v124,v12,v114
v_and_b32 v125,v13,v114
v_and_b32 v126,v14,v114
v_and_b32 v127,v15,v114
s_nop 1
v_mfma_f32_16x16x32_bf16 v[116:119],v[124:127],v[80:83],v[116:119]
v_and_b32 v124,v12,v115
v_and_b32 v125,v13,v115
v_and_b32 v126,v14,v115
v_and_b32 v127,v15,v115
s_nop 1
v_mfma_f32_16x16x32_bf16 v[116:119],v[124:127],v[84:87],v[116:119]
v_lshlrev_b32 v8,4,v9
v_and_b32 v124,1,v10
v_lshl_add_u32 v8,v124,3,v8
v_and_b32 v124,2,v10
v_lshl_add_u32 v8,v124,30,v8
s_lshl_b32 s65,s51,15
s_add_u32 s65,s65,92274688
s_lshl_b32 s59,s47,10
s_lshl_b32 s60,s46,8
s_add_u32 s59,s59,s60
s_add_u32 s59,s59,s65
v_cvt_pk_bf16_f32 v24,v116,v117
v_cvt_pk_bf16_f32 v25,v118,v119
buffer_store_dwordx2 v[24:25],v8,s[8:11],s59 offen
s_lshl_b32 s59,s51,13
s_lshl2_add_u32 s59,s47,s59
s_add_u32 s59,s59,10486912
s_waitcnt vmcnt(0)
s_barrier
s_or_b32 s59,s59,s52
buffer_store_dword v17,off,s[8:11],s59
s_cmp_lg_u32 s47,0
s_cbranch_scc1 L_moed_33
s_lshl_b32 s59,s51,13
s_add_u32 s59,s59,10486912
v_and_b32 v124,31,v1
v_lshlrev_b32 v124,2,v124
L_fw_34:
buffer_load_dword v125,v124,s[8:11],s59 offen sc1
s_sub_u32 s49,s49,1
s_cbranch_scc1 L_abort
s_waitcnt vmcnt(0)
v_cmp_eq_u32 vcc,0,v125
s_cbranch_vccnz L_fw_34
s_add_u32 s63,s65,0
buffer_load_dwordx4 v[24:27],v22,s[8:11],s63 offen sc1
s_add_u32 s63,s65,4096
buffer_load_dwordx4 v[28:31],v22,s[8:11],s63 offen sc1
s_add_u32 s63,s65,8192
buffer_load_dwordx4 v[32:35],v22,s[8:11],s63 offen sc1
s_add_u32 s63,s65,12288
buffer_load_dwordx4 v[36:39],v22,s[8:11],s63 offen sc1
s_add_u32 s63,s65,16384
buffer_load_dwordx4 v[40:43],v22,s[8:11],s63 offen sc1
s_add_u32 s63,s65,20480
buffer_load_dwordx4 v[44:47],v22,s[8:11],s63 offen sc1
s_add_u32 s63,s65,24576
buffer_load_dwordx4 v[48:51],v22,s[8:11],s63 offen sc1
s_add_u32 s63,s65,28672
buffer_load_dwordx4 v[52:55],v22,s[8:11],s63 offen sc1
v_and_b32 v64,15,v1
v_and_b32 v65,1,v1
v_lshlrev_b32 v65,4,v65
v_mov_b32 v66,0x3f80
v_lshlrev_b32 v66,v65,v66
v_lshrrev_b32 v64,1,v64
v_cmp_eq_u32 vcc,0,v64
s_nop 1
v_cndmask_b32 v56,0,v66,vcc
v_cmp_eq_u32 vcc,1,v64
s_nop 1
v_cndmask_b32 v57,0,v66,vcc
v_cmp_eq_u32 vcc,2,v64
s_nop 1
v_cndmask_b32 v58,0,v66,vcc
v_cmp_eq_u32 vcc,3,v64
s_nop 1
v_cndmask_b32 v59,0,v66,vcc
s_waitcnt vmcnt(7)
s_nop 0
v_mfma_f32_16x16x32_bf16 v[60:63],v[56:59],v[24:27],0
s_waitcnt vmcnt(6)
v_mfma_f32_16x16x32_bf16 v[60:63],v[56:59],v[28:31],v[60:63]
s_waitcnt vmcnt(5)
v_mfma_f32_16x16x32_bf16 v[60:63],v[56:59],v[32:35],v[60:63]
s_waitcnt vmcnt(4)
v_mfma_f32_16x16x32_bf16 v[60:63],v[56:59],v[36:39],v[60:63]
s_waitcnt vmcnt(3)
v_mfma_f32_16x16x32_bf16 v[60:63],v[56:59],v[40:43],v[60:63]
s_waitcnt vmcnt(2)
v_mfma_f32_16x16x32_bf16 v[60:63],v[56:59],v[44:47],v[60:63]
s_waitcnt vmcnt(1)
v_mfma_f32_16x16x32_bf16 v[60:63],v[56:59],v[48:51],v[60:63]
s_waitcnt vmcnt(0)
v_mfma_f32_16x16x32_bf16 v[60:63],v[56:59],v[52:55],v[60:63]
s_nop 7
ds_write_b128 v21,v[60:63]
s_waitcnt lgkmcnt(0)
s_barrier
s_cmp_lg_u32 s46,0
s_cbranch_scc1 L_moed_33
v_lshlrev_b32 v56,5,v1
v_add_u32 v56,155648,v56
ds_read_b128 v[24:27],v56
ds_read_b128 v[28:31],v56 offset:16
s_and_b32 s59,s55,0xffff0000
s_xor_b32 s60,s59,0x80000000
s_xor_b32 s61,s59,0xffff0000
s_cmp_lt_i32 s59,0
s_cselect_b32 s59,s60,s61
v_mov_b32 v56,s59
v_mul_f32 v56,0xbfb8aa3b,v56
v_exp_f32 v56,v56
s_nop 0
v_add_f32 v56,1.0,v56
v_rcp_f32 v56,v56
s_nop 0
v_cvt_pk_bf16_f32 v56,v56,v56
v_and_b32 v56,0xffff0000,v56
v_lshlrev_b32 v48,16,v104
v_and_b32 v49,0xffff0000,v104
v_lshlrev_b32 v50,16,v105
v_and_b32 v51,0xffff0000,v105
v_lshlrev_b32 v52,16,v106
v_and_b32 v53,0xffff0000,v106
v_lshlrev_b32 v54,16,v107
v_and_b32 v55,0xffff0000,v107
s_waitcnt lgkmcnt(0)
v_cvt_pk_bf16_f32 v40,v24,v25
v_cvt_pk_bf16_f32 v41,v26,v27
v_cvt_pk_bf16_f32 v42,v28,v29
v_cvt_pk_bf16_f32 v43,v30,v31
v_lshlrev_b32 v24,16,v40
v_and_b32 v25,0xffff0000,v40
v_lshlrev_b32 v26,16,v41
v_and_b32 v27,0xffff0000,v41
v_lshlrev_b32 v28,16,v42
v_and_b32 v29,0xffff0000,v42
v_lshlrev_b32 v30,16,v43
v_and_b32 v31,0xffff0000,v43
v_mul_f32 v24,v24,v56
v_mul_f32 v25,v25,v56
v_mul_f32 v26,v26,v56
v_mul_f32 v27,v27,v56
v_mul_f32 v28,v28,v56
v_mul_f32 v29,v29,v56
v_mul_f32 v30,v30,v56
v_mul_f32 v31,v31,v56
v_cvt_pk_bf16_f32 v40,v24,v25
v_cvt_pk_bf16_f32 v41,v26,v27
v_cvt_pk_bf16_f32 v42,v28,v29
v_cvt_pk_bf16_f32 v43,v30,v31
v_lshlrev_b32 v24,16,v40
v_and_b32 v25,0xffff0000,v40
v_lshlrev_b32 v26,16,v41
v_and_b32 v27,0xffff0000,v41
v_lshlrev_b32 v28,16,v42
v_and_b32 v29,0xffff0000,v42
v_lshlrev_b32 v30,16,v43
v_and_b32 v31,0xffff0000,v43
v_add_f32 v24,v24,v48
v_add_f32 v25,v25,v49
v_add_f32 v26,v26,v50
v_add_f32 v27,v27,v51
v_add_f32 v28,v28,v52
v_add_f32 v29,v29,v53
v_add_f32 v30,v30,v54
v_add_f32 v31,v31,v55
v_cvt_pk_bf16_f32 v40,v24,v25
v_cvt_pk_bf16_f32 v41,v26,v27
v_cvt_pk_bf16_f32 v42,v28,v29
v_cvt_pk_bf16_f32 v43,v30,v31
v_lshlrev_b32 v24,16,v40
v_and_b32 v25,0xffff0000,v40
v_lshlrev_b32 v26,16,v41
v_and_b32 v27,0xffff0000,v41
v_lshlrev_b32 v28,16,v42
v_and_b32 v29,0xffff0000,v42
v_lshlrev_b32 v30,16,v43
v_and_b32 v31,0xffff0000,v43
v_add_f32 v96,v96,v24
v_add_f32 v97,v97,v25
v_add_f32 v98,v98,v26
v_add_f32 v99,v99,v27
v_add_f32 v100,v100,v28
v_add_f32 v101,v101,v29
v_add_f32 v102,v102,v30
v_add_f32 v103,v103,v31
v_cvt_pk_bf16_f32 v80,v96,v97
v_cvt_pk_bf16_f32 v81,v98,v99
v_cvt_pk_bf16_f32 v82,v100,v101
v_cvt_pk_bf16_f32 v83,v102,v103
s_mov_b32 s4,s40
s_mov_b32 s5,s41
s_mov_b32 s6,2097152
s_mov_b32 s7,0x20000
buffer_store_dwordx4 v[80:83],v0,s[4:7],s56 offen sc1
L_moed_33:
s_endpgm
L_abort:
s_endpgm
L_spread:
s_mov_b32 s3,-1
s_lshr_b32 s48,s2,5
s_and_b32 s47,s2,31
s_branch L_roles
L_ra_6:
s_mov_b32 s4,s26
s_mov_b32 s5,s27
s_mov_b32 s6,4194304
s_mov_b32 s7,0x20000
v_and_b32 v2,15,v1
v_lshlrev_b32 v2,4,v2
v_lshrrev_b32 v3,4,v1
v_lshl_add_u32 v2,v3,13,v2
s_and_b32 s56,s47,15
s_lshl_b32 s56,s56,18
s_lshl_b32 s57,s46,8
s_add_u32 s56,s56,s57
s_mov_b32 s61,0x05040100
s_mov_b32 s62,0x07060302
s_add_u32 s57,s56,0
buffer_load_dwordx4 v[24:27],v2,s[4:7],s57 offen offset:0
buffer_load_dwordx4 v[28:31],v2,s[4:7],s57 offen offset:1024
buffer_load_dwordx4 v[32:35],v2,s[4:7],s57 offen offset:2048
buffer_load_dwordx4 v[36:39],v2,s[4:7],s57 offen offset:3072
s_add_u32 s57,s56,4096
buffer_load_dwordx4 v[40:43],v2,s[4:7],s57 offen offset:0
buffer_load_dwordx4 v[44:47],v2,s[4:7],s57 offen offset:1024
buffer_load_dwordx4 v[48:51],v2,s[4:7],s57 offen offset:2048
buffer_load_dwordx4 v[52:55],v2,s[4:7],s57 offen offset:3072
s_add_u32 s57,s56,32768
buffer_load_dwordx4 v[56:59],v2,s[4:7],s57 offen offset:0
buffer_load_dwordx4 v[60:63],v2,s[4:7],s57 offen offset:1024
buffer_load_dwordx4 v[64:67],v2,s[4:7],s57 offen offset:2048
buffer_load_dwordx4 v[68:71],v2,s[4:7],s57 offen offset:3072
s_add_u32 s57,s56,36864
buffer_load_dwordx4 v[72:75],v2,s[4:7],s57 offen offset:0
buffer_load_dwordx4 v[76:79],v2,s[4:7],s57 offen offset:1024
buffer_load_dwordx4 v[80:83],v2,s[4:7],s57 offen offset:2048
buffer_load_dwordx4 v[84:87],v2,s[4:7],s57 offen offset:3072
s_add_u32 s57,s56,65536
buffer_load_dwordx4 v[88:91],v2,s[4:7],s57 offen offset:0
buffer_load_dwordx4 v[92:95],v2,s[4:7],s57 offen offset:1024
buffer_load_dwordx4 v[96:99],v2,s[4:7],s57 offen offset:2048
buffer_load_dwordx4 v[100:103],v2,s[4:7],s57 offen offset:3072
s_add_u32 s57,s56,69632
buffer_load_dwordx4 v[104:107],v2,s[4:7],s57 offen offset:0
buffer_load_dwordx4 v[108:111],v2,s[4:7],s57 offen offset:1024
buffer_load_dwordx4 v[112:115],v2,s[4:7],s57 offen offset:2048
buffer_load_dwordx4 v[116:119],v2,s[4:7],s57 offen offset:3072
s_add_u32 s57,s56,98304
buffer_load_dwordx4 v[120:123],v2,s[4:7],s57 offen offset:0
buffer_load_dwordx4 v[124:127],v2,s[4:7],s57 offen offset:1024
buffer_load_dwordx4 v[128:131],v2,s[4:7],s57 offen offset:2048
buffer_load_dwordx4 v[132:135],v2,s[4:7],s57 offen offset:3072
s_add_u32 s57,s56,102400
buffer_load_dwordx4 v[136:139],v2,s[4:7],s57 offen offset:0
buffer_load_dwordx4 v[140:143],v2,s[4:7],s57 offen offset:1024
buffer_load_dwordx4 v[144:147],v2,s[4:7],s57 offen offset:2048
buffer_load_dwordx4 v[148:151],v2,s[4:7],s57 offen offset:3072
s_add_u32 s57,s56,131072
buffer_load_dwordx4 v[152:155],v2,s[4:7],s57 offen offset:0
buffer_load_dwordx4 v[156:159],v2,s[4:7],s57 offen offset:1024
buffer_load_dwordx4 v[160:163],v2,s[4:7],s57 offen offset:2048
buffer_load_dwordx4 v[164:167],v2,s[4:7],s57 offen offset:3072
s_add_u32 s57,s56,135168
buffer_load_dwordx4 v[168:171],v2,s[4:7],s57 offen offset:0
buffer_load_dwordx4 v[172:175],v2,s[4:7],s57 offen offset:1024
buffer_load_dwordx4 v[176:179],v2,s[4:7],s57 offen offset:2048
buffer_load_dwordx4 v[180:183],v2,s[4:7],s57 offen offset:3072
s_add_u32 s57,s56,163840
buffer_load_dwordx4 v[184:187],v2,s[4:7],s57 offen offset:0
buffer_load_dwordx4 v[188:191],v2,s[4:7],s57 offen offset:1024
buffer_load_dwordx4 v[192:195],v2,s[4:7],s57 offen offset:2048
buffer_load_dwordx4 v[196:199],v2,s[4:7],s57 offen offset:3072
s_add_u32 s57,s56,167936
buffer_load_dwordx4 v[200:203],v2,s[4:7],s57 offen offset:0
buffer_load_dwordx4 v[204:207],v2,s[4:7],s57 offen offset:1024
buffer_load_dwordx4 v[208:211],v2,s[4:7],s57 offen offset:2048
buffer_load_dwordx4 v[212:215],v2,s[4:7],s57 offen offset:3072
s_waitcnt vmcnt(40)
v_perm_b32 v216,v28,v24,s61
v_perm_b32 v217,v36,v32,s61
v_perm_b32 v218,v44,v40,s61
v_perm_b32 v219,v52,v48,s61
v_accvgpr_write_b32 a0,v216
v_accvgpr_write_b32 a1,v217
v_accvgpr_write_b32 a2,v218
v_accvgpr_write_b32 a3,v219
v_perm_b32 v216,v28,v24,s62
v_perm_b32 v217,v36,v32,s62
v_perm_b32 v218,v44,v40,s62
v_perm_b32 v219,v52,v48,s62
v_accvgpr_write_b32 a4,v216
v_accvgpr_write_b32 a5,v217
v_accvgpr_write_b32 a6,v218
v_accvgpr_write_b32 a7,v219
v_perm_b32 v216,v29,v25,s61
v_perm_b32 v217,v37,v33,s61
v_perm_b32 v218,v45,v41,s61
v_perm_b32 v219,v53,v49,s61
v_accvgpr_write_b32 a8,v216
v_accvgpr_write_b32 a9,v217
v_accvgpr_write_b32 a10,v218
v_accvgpr_write_b32 a11,v219
v_perm_b32 v216,v29,v25,s62
v_perm_b32 v217,v37,v33,s62
v_perm_b32 v218,v45,v41,s62
v_perm_b32 v219,v53,v49,s62
v_accvgpr_write_b32 a12,v216
v_accvgpr_write_b32 a13,v217
v_accvgpr_write_b32 a14,v218
v_accvgpr_write_b32 a15,v219
v_perm_b32 v216,v30,v26,s61
v_perm_b32 v217,v38,v34,s61
v_perm_b32 v218,v46,v42,s61
v_perm_b32 v219,v54,v50,s61
v_accvgpr_write_b32 a16,v216
v_accvgpr_write_b32 a17,v217
v_accvgpr_write_b32 a18,v218
v_accvgpr_write_b32 a19,v219
v_perm_b32 v216,v30,v26,s62
v_perm_b32 v217,v38,v34,s62
v_perm_b32 v218,v46,v42,s62
v_perm_b32 v219,v54,v50,s62
v_accvgpr_write_b32 a20,v216
v_accvgpr_write_b32 a21,v217
v_accvgpr_write_b32 a22,v218
v_accvgpr_write_b32 a23,v219
v_perm_b32 v216,v31,v27,s61
v_perm_b32 v217,v39,v35,s61
v_perm_b32 v218,v47,v43,s61
v_perm_b32 v219,v55,v51,s61
v_accvgpr_write_b32 a24,v216
v_accvgpr_write_b32 a25,v217
v_accvgpr_write_b32 a26,v218
v_accvgpr_write_b32 a27,v219
v_perm_b32 v216,v31,v27,s62
v_perm_b32 v217,v39,v35,s62
v_perm_b32 v218,v47,v43,s62
v_perm_b32 v219,v55,v51,s62
v_accvgpr_write_b32 a28,v216
v_accvgpr_write_b32 a29,v217
v_accvgpr_write_b32 a30,v218
v_accvgpr_write_b32 a31,v219
s_add_u32 s57,s56,196608
buffer_load_dwordx4 v[24:27],v2,s[4:7],s57 offen offset:0
buffer_load_dwordx4 v[28:31],v2,s[4:7],s57 offen offset:1024
buffer_load_dwordx4 v[32:35],v2,s[4:7],s57 offen offset:2048
buffer_load_dwordx4 v[36:39],v2,s[4:7],s57 offen offset:3072
s_add_u32 s57,s56,200704
buffer_load_dwordx4 v[40:43],v2,s[4:7],s57 offen offset:0
buffer_load_dwordx4 v[44:47],v2,s[4:7],s57 offen offset:1024
buffer_load_dwordx4 v[48:51],v2,s[4:7],s57 offen offset:2048
buffer_load_dwordx4 v[52:55],v2,s[4:7],s57 offen offset:3072
s_waitcnt vmcnt(40)
v_perm_b32 v216,v60,v56,s61
v_perm_b32 v217,v68,v64,s61
v_perm_b32 v218,v76,v72,s61
v_perm_b32 v219,v84,v80,s61
v_accvgpr_write_b32 a32,v216
v_accvgpr_write_b32 a33,v217
v_accvgpr_write_b32 a34,v218
v_accvgpr_write_b32 a35,v219
v_perm_b32 v216,v60,v56,s62
v_perm_b32 v217,v68,v64,s62
v_perm_b32 v218,v76,v72,s62
v_perm_b32 v219,v84,v80,s62
v_accvgpr_write_b32 a36,v216
v_accvgpr_write_b32 a37,v217
v_accvgpr_write_b32 a38,v218
v_accvgpr_write_b32 a39,v219
v_perm_b32 v216,v61,v57,s61
v_perm_b32 v217,v69,v65,s61
v_perm_b32 v218,v77,v73,s61
v_perm_b32 v219,v85,v81,s61
v_accvgpr_write_b32 a40,v216
v_accvgpr_write_b32 a41,v217
v_accvgpr_write_b32 a42,v218
v_accvgpr_write_b32 a43,v219
v_perm_b32 v216,v61,v57,s62
v_perm_b32 v217,v69,v65,s62
v_perm_b32 v218,v77,v73,s62
v_perm_b32 v219,v85,v81,s62
v_accvgpr_write_b32 a44,v216
v_accvgpr_write_b32 a45,v217
v_accvgpr_write_b32 a46,v218
v_accvgpr_write_b32 a47,v219
v_perm_b32 v216,v62,v58,s61
v_perm_b32 v217,v70,v66,s61
v_perm_b32 v218,v78,v74,s61
v_perm_b32 v219,v86,v82,s61
v_accvgpr_write_b32 a48,v216
v_accvgpr_write_b32 a49,v217
v_accvgpr_write_b32 a50,v218
v_accvgpr_write_b32 a51,v219
v_perm_b32 v216,v62,v58,s62
v_perm_b32 v217,v70,v66,s62
v_perm_b32 v218,v78,v74,s62
v_perm_b32 v219,v86,v82,s62
v_accvgpr_write_b32 a52,v216
v_accvgpr_write_b32 a53,v217
v_accvgpr_write_b32 a54,v218
v_accvgpr_write_b32 a55,v219
v_perm_b32 v216,v63,v59,s61
v_perm_b32 v217,v71,v67,s61
v_perm_b32 v218,v79,v75,s61
v_perm_b32 v219,v87,v83,s61
v_accvgpr_write_b32 a56,v216
v_accvgpr_write_b32 a57,v217
v_accvgpr_write_b32 a58,v218
v_accvgpr_write_b32 a59,v219
v_perm_b32 v216,v63,v59,s62
v_perm_b32 v217,v71,v67,s62
v_perm_b32 v218,v79,v75,s62
v_perm_b32 v219,v87,v83,s62
v_accvgpr_write_b32 a60,v216
v_accvgpr_write_b32 a61,v217
v_accvgpr_write_b32 a62,v218
v_accvgpr_write_b32 a63,v219
s_add_u32 s57,s56,229376
buffer_load_dwordx4 v[56:59],v2,s[4:7],s57 offen offset:0
buffer_load_dwordx4 v[60:63],v2,s[4:7],s57 offen offset:1024
buffer_load_dwordx4 v[64:67],v2,s[4:7],s57 offen offset:2048
buffer_load_dwordx4 v[68:71],v2,s[4:7],s57 offen offset:3072
s_add_u32 s57,s56,233472
buffer_load_dwordx4 v[72:75],v2,s[4:7],s57 offen offset:0
buffer_load_dwordx4 v[76:79],v2,s[4:7],s57 offen offset:1024
buffer_load_dwordx4 v[80:83],v2,s[4:7],s57 offen offset:2048
buffer_load_dwordx4 v[84:87],v2,s[4:7],s57 offen offset:3072
s_waitcnt vmcnt(40)
v_perm_b32 v216,v92,v88,s61
v_perm_b32 v217,v100,v96,s61
v_perm_b32 v218,v108,v104,s61
v_perm_b32 v219,v116,v112,s61
v_accvgpr_write_b32 a64,v216
v_accvgpr_write_b32 a65,v217
v_accvgpr_write_b32 a66,v218
v_accvgpr_write_b32 a67,v219
v_perm_b32 v216,v92,v88,s62
v_perm_b32 v217,v100,v96,s62
v_perm_b32 v218,v108,v104,s62
v_perm_b32 v219,v116,v112,s62
v_accvgpr_write_b32 a68,v216
v_accvgpr_write_b32 a69,v217
v_accvgpr_write_b32 a70,v218
v_accvgpr_write_b32 a71,v219
v_perm_b32 v216,v93,v89,s61
v_perm_b32 v217,v101,v97,s61
v_perm_b32 v218,v109,v105,s61
v_perm_b32 v219,v117,v113,s61
v_accvgpr_write_b32 a72,v216
v_accvgpr_write_b32 a73,v217
v_accvgpr_write_b32 a74,v218
v_accvgpr_write_b32 a75,v219
v_perm_b32 v216,v93,v89,s62
v_perm_b32 v217,v101,v97,s62
v_perm_b32 v218,v109,v105,s62
v_perm_b32 v219,v117,v113,s62
v_accvgpr_write_b32 a76,v216
v_accvgpr_write_b32 a77,v217
v_accvgpr_write_b32 a78,v218
v_accvgpr_write_b32 a79,v219
v_perm_b32 v216,v94,v90,s61
v_perm_b32 v217,v102,v98,s61
v_perm_b32 v218,v110,v106,s61
v_perm_b32 v219,v118,v114,s61
v_accvgpr_write_b32 a80,v216
v_accvgpr_write_b32 a81,v217
v_accvgpr_write_b32 a82,v218
v_accvgpr_write_b32 a83,v219
v_perm_b32 v216,v94,v90,s62
v_perm_b32 v217,v102,v98,s62
v_perm_b32 v218,v110,v106,s62
v_perm_b32 v219,v118,v114,s62
v_accvgpr_write_b32 a84,v216
v_accvgpr_write_b32 a85,v217
v_accvgpr_write_b32 a86,v218
v_accvgpr_write_b32 a87,v219
v_perm_b32 v216,v95,v91,s61
v_perm_b32 v217,v103,v99,s61
v_perm_b32 v218,v111,v107,s61
v_perm_b32 v219,v119,v115,s61
v_accvgpr_write_b32 a88,v216
v_accvgpr_write_b32 a89,v217
v_accvgpr_write_b32 a90,v218
v_accvgpr_write_b32 a91,v219
v_perm_b32 v216,v95,v91,s62
v_perm_b32 v217,v103,v99,s62
v_perm_b32 v218,v111,v107,s62
v_perm_b32 v219,v119,v115,s62
v_accvgpr_write_b32 a92,v216
v_accvgpr_write_b32 a93,v217
v_accvgpr_write_b32 a94,v218
v_accvgpr_write_b32 a95,v219
s_waitcnt vmcnt(32)
v_perm_b32 v216,v124,v120,s61
v_perm_b32 v217,v132,v128,s61
v_perm_b32 v218,v140,v136,s61
v_perm_b32 v219,v148,v144,s61
v_accvgpr_write_b32 a96,v216
v_accvgpr_write_b32 a97,v217
v_accvgpr_write_b32 a98,v218
v_accvgpr_write_b32 a99,v219
v_perm_b32 v216,v124,v120,s62
v_perm_b32 v217,v132,v128,s62
v_perm_b32 v218,v140,v136,s62
v_perm_b32 v219,v148,v144,s62
v_accvgpr_write_b32 a100,v216
v_accvgpr_write_b32 a101,v217
v_accvgpr_write_b32 a102,v218
v_accvgpr_write_b32 a103,v219
v_perm_b32 v216,v125,v121,s61
v_perm_b32 v217,v133,v129,s61
v_perm_b32 v218,v141,v137,s61
v_perm_b32 v219,v149,v145,s61
v_accvgpr_write_b32 a104,v216
v_accvgpr_write_b32 a105,v217
v_accvgpr_write_b32 a106,v218
v_accvgpr_write_b32 a107,v219
v_perm_b32 v216,v125,v121,s62
v_perm_b32 v217,v133,v129,s62
v_perm_b32 v218,v141,v137,s62
v_perm_b32 v219,v149,v145,s62
v_accvgpr_write_b32 a108,v216
v_accvgpr_write_b32 a109,v217
v_accvgpr_write_b32 a110,v218
v_accvgpr_write_b32 a111,v219
v_perm_b32 v216,v126,v122,s61
v_perm_b32 v217,v134,v130,s61
v_perm_b32 v218,v142,v138,s61
v_perm_b32 v219,v150,v146,s61
v_accvgpr_write_b32 a112,v216
v_accvgpr_write_b32 a113,v217
v_accvgpr_write_b32 a114,v218
v_accvgpr_write_b32 a115,v219
v_perm_b32 v216,v126,v122,s62
v_perm_b32 v217,v134,v130,s62
v_perm_b32 v218,v142,v138,s62
v_perm_b32 v219,v150,v146,s62
v_accvgpr_write_b32 a116,v216
v_accvgpr_write_b32 a117,v217
v_accvgpr_write_b32 a118,v218
v_accvgpr_write_b32 a119,v219
v_perm_b32 v216,v127,v123,s61
v_perm_b32 v217,v135,v131,s61
v_perm_b32 v218,v143,v139,s61
v_perm_b32 v219,v151,v147,s61
v_accvgpr_write_b32 a120,v216
v_accvgpr_write_b32 a121,v217
v_accvgpr_write_b32 a122,v218
v_accvgpr_write_b32 a123,v219
v_perm_b32 v216,v127,v123,s62
v_perm_b32 v217,v135,v131,s62
v_perm_b32 v218,v143,v139,s62
v_perm_b32 v219,v151,v147,s62
v_accvgpr_write_b32 a124,v216
v_accvgpr_write_b32 a125,v217
v_accvgpr_write_b32 a126,v218
v_accvgpr_write_b32 a127,v219
s_waitcnt vmcnt(24)
v_perm_b32 v216,v156,v152,s61
v_perm_b32 v217,v164,v160,s61
v_perm_b32 v218,v172,v168,s61
v_perm_b32 v219,v180,v176,s61
v_accvgpr_write_b32 a128,v216
v_accvgpr_write_b32 a129,v217
v_accvgpr_write_b32 a130,v218
v_accvgpr_write_b32 a131,v219
v_perm_b32 v216,v156,v152,s62
v_perm_b32 v217,v164,v160,s62
v_perm_b32 v218,v172,v168,s62
v_perm_b32 v219,v180,v176,s62
v_accvgpr_write_b32 a132,v216
v_accvgpr_write_b32 a133,v217
v_accvgpr_write_b32 a134,v218
v_accvgpr_write_b32 a135,v219
v_perm_b32 v216,v157,v153,s61
v_perm_b32 v217,v165,v161,s61
v_perm_b32 v218,v173,v169,s61
v_perm_b32 v219,v181,v177,s61
v_accvgpr_write_b32 a136,v216
v_accvgpr_write_b32 a137,v217
v_accvgpr_write_b32 a138,v218
v_accvgpr_write_b32 a139,v219
v_perm_b32 v216,v157,v153,s62
v_perm_b32 v217,v165,v161,s62
v_perm_b32 v218,v173,v169,s62
v_perm_b32 v219,v181,v177,s62
v_accvgpr_write_b32 a140,v216
v_accvgpr_write_b32 a141,v217
v_accvgpr_write_b32 a142,v218
v_accvgpr_write_b32 a143,v219
v_perm_b32 v216,v158,v154,s61
v_perm_b32 v217,v166,v162,s61
v_perm_b32 v218,v174,v170,s61
v_perm_b32 v219,v182,v178,s61
v_accvgpr_write_b32 a144,v216
v_accvgpr_write_b32 a145,v217
v_accvgpr_write_b32 a146,v218
v_accvgpr_write_b32 a147,v219
v_perm_b32 v216,v158,v154,s62
v_perm_b32 v217,v166,v162,s62
v_perm_b32 v218,v174,v170,s62
v_perm_b32 v219,v182,v178,s62
v_accvgpr_write_b32 a148,v216
v_accvgpr_write_b32 a149,v217
v_accvgpr_write_b32 a150,v218
v_accvgpr_write_b32 a151,v219
v_perm_b32 v216,v159,v155,s61
v_perm_b32 v217,v167,v163,s61
v_perm_b32 v218,v175,v171,s61
v_perm_b32 v219,v183,v179,s61
v_accvgpr_write_b32 a152,v216
v_accvgpr_write_b32 a153,v217
v_accvgpr_write_b32 a154,v218
v_accvgpr_write_b32 a155,v219
v_perm_b32 v216,v159,v155,s62
v_perm_b32 v217,v167,v163,s62
v_perm_b32 v218,v175,v171,s62
v_perm_b32 v219,v183,v179,s62
v_accvgpr_write_b32 a156,v216
v_accvgpr_write_b32 a157,v217
v_accvgpr_write_b32 a158,v218
v_accvgpr_write_b32 a159,v219
s_waitcnt vmcnt(16)
v_perm_b32 v216,v188,v184,s61
v_perm_b32 v217,v196,v192,s61
v_perm_b32 v218,v204,v200,s61
v_perm_b32 v219,v212,v208,s61
v_accvgpr_write_b32 a160,v216
v_accvgpr_write_b32 a161,v217
v_accvgpr_write_b32 a162,v218
v_accvgpr_write_b32 a163,v219
v_perm_b32 v216,v188,v184,s62
v_perm_b32 v217,v196,v192,s62
v_perm_b32 v218,v204,v200,s62
v_perm_b32 v219,v212,v208,s62
v_accvgpr_write_b32 a164,v216
v_accvgpr_write_b32 a165,v217
v_accvgpr_write_b32 a166,v218
v_accvgpr_write_b32 a167,v219
v_perm_b32 v216,v189,v185,s61
v_perm_b32 v217,v197,v193,s61
v_perm_b32 v218,v205,v201,s61
v_perm_b32 v219,v213,v209,s61
v_accvgpr_write_b32 a168,v216
v_accvgpr_write_b32 a169,v217
v_accvgpr_write_b32 a170,v218
v_accvgpr_write_b32 a171,v219
v_perm_b32 v216,v189,v185,s62
v_perm_b32 v217,v197,v193,s62
v_perm_b32 v218,v205,v201,s62
v_perm_b32 v219,v213,v209,s62
v_accvgpr_write_b32 a172,v216
v_accvgpr_write_b32 a173,v217
v_accvgpr_write_b32 a174,v218
v_accvgpr_write_b32 a175,v219
v_perm_b32 v216,v190,v186,s61
v_perm_b32 v217,v198,v194,s61
v_perm_b32 v218,v206,v202,s61
v_perm_b32 v219,v214,v210,s61
v_accvgpr_write_b32 a176,v216
v_accvgpr_write_b32 a177,v217
v_accvgpr_write_b32 a178,v218
v_accvgpr_write_b32 a179,v219
v_perm_b32 v216,v190,v186,s62
v_perm_b32 v217,v198,v194,s62
v_perm_b32 v218,v206,v202,s62
v_perm_b32 v219,v214,v210,s62
v_accvgpr_write_b32 a180,v216
v_accvgpr_write_b32 a181,v217
v_accvgpr_write_b32 a182,v218
v_accvgpr_write_b32 a183,v219
v_perm_b32 v216,v191,v187,s61
v_perm_b32 v217,v199,v195,s61
v_perm_b32 v218,v207,v203,s61
v_perm_b32 v219,v215,v211,s61
v_accvgpr_write_b32 a184,v216
v_accvgpr_write_b32 a185,v217
v_accvgpr_write_b32 a186,v218
v_accvgpr_write_b32 a187,v219
v_perm_b32 v216,v191,v187,s62
v_perm_b32 v217,v199,v195,s62
v_perm_b32 v218,v207,v203,s62
v_perm_b32 v219,v215,v211,s62
v_accvgpr_write_b32 a188,v216
v_accvgpr_write_b32 a189,v217
v_accvgpr_write_b32 a190,v218
v_accvgpr_write_b32 a191,v219
s_waitcnt vmcnt(8)
v_perm_b32 v216,v28,v24,s61
v_perm_b32 v217,v36,v32,s61
v_perm_b32 v218,v44,v40,s61
v_perm_b32 v219,v52,v48,s61
v_accvgpr_write_b32 a192,v216
v_accvgpr_write_b32 a193,v217
v_accvgpr_write_b32 a194,v218
v_accvgpr_write_b32 a195,v219
v_perm_b32 v216,v28,v24,s62
v_perm_b32 v217,v36,v32,s62
v_perm_b32 v218,v44,v40,s62
v_perm_b32 v219,v52,v48,s62
v_accvgpr_write_b32 a196,v216
v_accvgpr_write_b32 a197,v217
v_accvgpr_write_b32 a198,v218
v_accvgpr_write_b32 a199,v219
v_perm_b32 v216,v29,v25,s61
v_perm_b32 v217,v37,v33,s61
v_perm_b32 v218,v45,v41,s61
v_perm_b32 v219,v53,v49,s61
v_accvgpr_write_b32 a200,v216
v_accvgpr_write_b32 a201,v217
v_accvgpr_write_b32 a202,v218
v_accvgpr_write_b32 a203,v219
v_perm_b32 v216,v29,v25,s62
v_perm_b32 v217,v37,v33,s62
v_perm_b32 v218,v45,v41,s62
v_perm_b32 v219,v53,v49,s62
v_accvgpr_write_b32 a204,v216
v_accvgpr_write_b32 a205,v217
v_accvgpr_write_b32 a206,v218
v_accvgpr_write_b32 a207,v219
v_perm_b32 v216,v30,v26,s61
v_perm_b32 v217,v38,v34,s61
v_perm_b32 v218,v46,v42,s61
v_perm_b32 v219,v54,v50,s61
v_accvgpr_write_b32 a208,v216
v_accvgpr_write_b32 a209,v217
v_accvgpr_write_b32 a210,v218
v_accvgpr_write_b32 a211,v219
v_perm_b32 v216,v30,v26,s62
v_perm_b32 v217,v38,v34,s62
v_perm_b32 v218,v46,v42,s62
v_perm_b32 v219,v54,v50,s62
v_accvgpr_write_b32 a212,v216
v_accvgpr_write_b32 a213,v217
v_accvgpr_write_b32 a214,v218
v_accvgpr_write_b32 a215,v219
v_perm_b32 v216,v31,v27,s61
v_perm_b32 v217,v39,v35,s61
v_perm_b32 v218,v47,v43,s61
v_perm_b32 v219,v55,v51,s61
v_accvgpr_write_b32 a216,v216
v_accvgpr_write_b32 a217,v217
v_accvgpr_write_b32 a218,v218
v_accvgpr_write_b32 a219,v219
v_perm_b32 v216,v31,v27,s62
v_perm_b32 v217,v39,v35,s62
v_perm_b32 v218,v47,v43,s62
v_perm_b32 v219,v55,v51,s62
v_accvgpr_write_b32 a220,v216
v_accvgpr_write_b32 a221,v217
v_accvgpr_write_b32 a222,v218
v_accvgpr_write_b32 a223,v219
s_waitcnt vmcnt(0)
v_perm_b32 v216,v60,v56,s61
v_perm_b32 v217,v68,v64,s61
v_perm_b32 v218,v76,v72,s61
v_perm_b32 v219,v84,v80,s61
v_accvgpr_write_b32 a224,v216
v_accvgpr_write_b32 a225,v217
v_accvgpr_write_b32 a226,v218
v_accvgpr_write_b32 a227,v219
v_perm_b32 v216,v60,v56,s62
v_perm_b32 v217,v68,v64,s62
v_perm_b32 v218,v76,v72,s62
v_perm_b32 v219,v84,v80,s62
v_accvgpr_write_b32 a228,v216
v_accvgpr_write_b32 a229,v217
v_accvgpr_write_b32 a230,v218
v_accvgpr_write_b32 a231,v219
v_perm_b32 v216,v61,v57,s61
v_perm_b32 v217,v69,v65,s61
v_perm_b32 v218,v77,v73,s61
v_perm_b32 v219,v85,v81,s61
v_accvgpr_write_b32 a232,v216
v_accvgpr_write_b32 a233,v217
v_accvgpr_write_b32 a234,v218
v_accvgpr_write_b32 a235,v219
v_perm_b32 v216,v61,v57,s62
v_perm_b32 v217,v69,v65,s62
v_perm_b32 v218,v77,v73,s62
v_perm_b32 v219,v85,v81,s62
v_accvgpr_write_b32 a236,v216
v_accvgpr_write_b32 a237,v217
v_accvgpr_write_b32 a238,v218
v_accvgpr_write_b32 a239,v219
v_perm_b32 v216,v62,v58,s61
v_perm_b32 v217,v70,v66,s61
v_perm_b32 v218,v78,v74,s61
v_perm_b32 v219,v86,v82,s61
v_accvgpr_write_b32 a240,v216
v_accvgpr_write_b32 a241,v217
v_accvgpr_write_b32 a242,v218
v_accvgpr_write_b32 a243,v219
v_perm_b32 v216,v62,v58,s62
v_perm_b32 v217,v70,v66,s62
v_perm_b32 v218,v78,v74,s62
v_perm_b32 v219,v86,v82,s62
v_accvgpr_write_b32 a244,v216
v_accvgpr_write_b32 a245,v217
v_accvgpr_write_b32 a246,v218
v_accvgpr_write_b32 a247,v219
v_perm_b32 v216,v63,v59,s61
v_perm_b32 v217,v71,v67,s61
v_perm_b32 v218,v79,v75,s61
v_perm_b32 v219,v87,v83,s61
v_accvgpr_write_b32 a248,v216
v_accvgpr_write_b32 a249,v217
v_accvgpr_write_b32 a250,v218
v_accvgpr_write_b32 a251,v219
v_perm_b32 v216,v63,v59,s62
v_perm_b32 v217,v71,v67,s62
v_perm_b32 v218,v79,v75,s62
v_perm_b32 v219,v87,v83,s62
v_accvgpr_write_b32 a252,v216
v_accvgpr_write_b32 a253,v217
v_accvgpr_write_b32 a254,v218
v_accvgpr_write_b32 a255,v219
v_mov_b32 v123,159744
s_cmp_lg_u32 s46,0
s_cbranch_scc1 L_gbd_36
v_mov_b32 v124,128
L_gb_35:
buffer_load_dword v125,v124,s[12:15],0 offen sc1
s_waitcnt vmcnt(0)
v_readfirstlane_b32 s56,v125
ds_write_b32 v123,v125
s_bitcmp1_b32 s56,8
s_cbranch_scc1 L_gbd_36
s_sleep 4
s_sub_u32 s49,s49,1
s_cmp_gt_i32 s49,0
s_cbranch_scc1 L_gb_35
s_branch L_abort
L_gbd_36:
s_waitcnt lgkmcnt(0)
s_barrier
ds_read_b32 v125,v123
s_waitcnt lgkmcnt(0)
v_readfirstlane_b32 s56,v125
s_barrier
s_lshr_b32 s56,s56,16
s_andn2_b32 s56,s56,s3
s_cbranch_scc1 L_spread
s_max_u32 s54,s48,5
s_sub_u32 s54,s54,5
s_lshl_b32 s54,s54,1
s_lshr_b32 s56,s47,4
s_add_u32 s54,s54,s56
s_cmp_lg_u32 s3,0
s_cbranch_scc1 L_wa
v_and_b32 v238,15,v1
v_and_b32 v239,1,v1
v_lshlrev_b32 v239,4,v239
v_mov_b32 v240,0x3f80
v_lshlrev_b32 v240,v239,v240
v_lshrrev_b32 v238,1,v238
v_cmp_eq_u32 vcc,0,v238
s_nop 1
v_cndmask_b32 v156,0,v240,vcc
v_cmp_eq_u32 vcc,1,v238
s_nop 1
v_cndmask_b32 v157,0,v240,vcc
v_cmp_eq_u32 vcc,2,v238
s_nop 1
v_cndmask_b32 v158,0,v240,vcc
v_cmp_eq_u32 vcc,3,v238
s_nop 1
v_cndmask_b32 v159,0,v240,vcc
s_mov_b32 s4,s32
s_mov_b32 s5,s33
s_mov_b32 s6,1024
s_mov_b32 s7,0x20000
buffer_load_dwordx4 v[224:227],v0,s[4:7],0 offen
v_and_b32 v238,15,v1
v_lshrrev_b32 v239,4,v1
v_lshlrev_b32 v240,2,v239
v_mov_b32 v241,0xf149f2ca
s_and_b32 s56,s46,1
s_lshl_b32 s56,s56,4
v_add_u32 v242,s56,v238
v_add_u32 v243,0,v240
v_cmp_gt_u32 vcc,v243,v242
s_nop 1
v_cndmask_b32 v8,0,v241,vcc
v_add_u32 v243,1,v240
v_cmp_gt_u32 vcc,v243,v242
s_nop 1
v_cndmask_b32 v9,0,v241,vcc
v_add_u32 v243,2,v240
v_cmp_gt_u32 vcc,v243,v242
s_nop 1
v_cndmask_b32 v10,0,v241,vcc
v_add_u32 v243,3,v240
v_cmp_gt_u32 vcc,v243,v242
s_nop 1
v_cndmask_b32 v11,0,v241,vcc
v_add_u32 v243,16,v240
v_cmp_gt_u32 vcc,v243,v242
s_nop 1
v_cndmask_b32 v12,0,v241,vcc
v_add_u32 v243,17,v240
v_cmp_gt_u32 vcc,v243,v242
s_nop 1
v_cndmask_b32 v13,0,v241,vcc
v_add_u32 v243,18,v240
v_cmp_gt_u32 vcc,v243,v242
s_nop 1
v_cndmask_b32 v14,0,v241,vcc
v_add_u32 v243,19,v240
v_cmp_gt_u32 vcc,v243,v242
s_nop 1
v_cndmask_b32 v15,0,v241,vcc
v_mov_b64 v[152:153],s[28:29]
v_mov_b64 v[154:155],s[28:29]
v_mov_b32 v145,0
v_mov_b32 v146,0
s_lshl_b32 s56,s46,12
s_add_u32 s56,s56,131072
v_add_u32 v3,s56,v0
v_add_u32 v4,131072,v0
s_lshl_b32 s56,s46,8
v_lshlrev_b32 v7,4,v238
v_add_u32 v7,s56,v7
v_lshl_add_u32 v5,v239,16,v7
v_lshlrev_b32 v6,1,v7
v_lshl_add_u32 v7,v239,10,v7
v_and_b32 v243,1,v239
v_lshl_add_u32 v6,v243,4,v6
v_lshrrev_b32 v243,1,v239
v_lshl_add_u32 v6,v243,12,v6
v_add_u32 v6,147456,v6
v_lshlrev_b32 v16,2,v238
v_lshlrev_b32 v21,3,v238
s_and_b32 s68,s47,15
s_lshl_b32 s56,s68,10
v_add_u32 v5,s56,v5
s_lshl_b32 s56,s68,15
v_add_u32 v7,s56,v7
s_lshl_b32 s69,s54,20
s_add_u32 s69,s69,20971520
s_lshl_b32 s87,s54,13
s_add_u32 s87,s87,10486656
s_lshl2_add_u32 s74,s68,s87
s_or_b32 s74,s74,s52
s_lshl_b32 s68,s68,1
s_lshr_b32 s56,s46,1
s_add_u32 s68,s68,s56
s_mov_b32 s66,0
s_mov_b32 s67,0
s_mov_b32 s73,0x80000000
s_mov_b32 s75,0
s_mov_b32 s12,s40
s_mov_b32 s13,s41
s_mov_b32 s14,2097152
s_mov_b32 s15,0x20000
v_add_u32 v21,10487168,v21
v_mov_b32 v244,v21
s_and_b32 s56,s50,2048
s_add_u32 s56,s56,147456
v_lshlrev_b32 v23,5,v1
v_add_u32 v23,s56,v23
v_mov_b32 v245,155648
s_lshl_b32 s56,s46,2
v_add_u32 v247,s56,v245
s_waitcnt vmcnt(0)
v_lshlrev_b32 v228,16,v224
v_and_b32 v229,0xffff0000,v224
v_lshlrev_b32 v230,16,v225
v_and_b32 v231,0xffff0000,v225
v_lshlrev_b32 v232,16,v226
v_and_b32 v233,0xffff0000,v226
v_lshlrev_b32 v234,16,v227
v_and_b32 v235,0xffff0000,v227
s_cmp_lt_u32 s54,2
s_cbranch_scc1 L_aa_37
s_sub_u32 s77,s54,2
s_mov_b32 s30,0
s_mov_b32 s86,1536
s_lshl_b32 s56,s77,5
s_add_u32 s56,s56,s68
s_mul_i32 s70,s56,24576
s_lshl_b32 s71,s56,13
s_lshl_b32 s59,s77,13
s_lshl2_add_u32 s59,s68,s59
s_add_u32 s59,s59,10485760
s_buffer_load_dword s32,s[8:11],s59 glc
s_mov_b32 s33,1
s_add_u32 s70,s70,100663296
s_add_u32 s71,s71,41943040
v_mov_b32 v19,s59
s_branch L_aa_45
L_aa_51:
s_mov_b32 s26,s51
s_mov_b32 s51,s53
s_cmp_lg_u32 s27,0
s_cbranch_scc1 L_av_54
s_bitcmp1_b32 s46,0
s_cbranch_scc1 L_av_53
L_av_52:
ds_read_b128 v[24:27],v4 offset:0
ds_read_b128 v[28:31],v4 offset:1024
ds_read_b128 v[32:35],v4 offset:2048
ds_read_b128 v[36:39],v4 offset:3072
ds_read_b128 v[40:43],v4 offset:8192
ds_read_b128 v[44:47],v4 offset:9216
ds_read_b128 v[48:51],v4 offset:10240
ds_read_b128 v[52:55],v4 offset:11264
s_min_u32 s56,s32,s33
s_cmp_lt_u32 s77,64
s_cselect_b32 s56,s56,0
s_cmp_eq_u32 s56,0
s_cselect_b32 s72,0x80000000,0
v_mov_b32 v248,s72
s_or_b32 s64,s70,s72
s_or_b32 s65,s71,s72
ds_write_b32 v247,v248
s_and_b32 s57,s46,1
s_mul_i32 s58,s57,12288
s_add_u32 s64,s64,s58
s_lshl_b32 s57,s57,12
s_add_u32 s65,s65,s57
s_and_b32 s59,s50,2048
s_lshl_b32 s59,s59,4
s_xor_b32 s60,s67,65536
s_add_u32 s59,s59,s60
s_add_u32 s58,s58,s59
s_add_u32 s57,s57,s59
s_add_u32 m0,s58,0
s_waitcnt lgkmcnt(8)
v_mfma_f32_16x16x32_bf16 v[160:163],v[24:27],a[0:3],0
buffer_load_dwordx4 v0,s[8:11],s64 offen offset:0 sc1 lds
v_mfma_f32_16x16x32_bf16 v[164:167],v[24:27],a[4:7],0
v_mfma_f32_16x16x32_bf16 v[168:171],v[24:27],a[8:11],0
v_mfma_f32_16x16x32_bf16 v[172:175],v[24:27],a[12:15],0
v_mfma_f32_16x16x32_bf16 v[176:179],v[24:27],a[16:19],0
buffer_load_dwordx4 v0,s[8:11],s64 offen offset:1024 sc1 lds
v_mfma_f32_16x16x32_bf16 v[180:183],v[24:27],a[20:23],0
v_mfma_f32_16x16x32_bf16 v[184:187],v[24:27],a[24:27],0
s_waitcnt vmcnt(9)
v_mfma_f32_16x16x32_bf16 v[128:131],v[156:159],v[192:195],0
v_mfma_f32_16x16x32_bf16 v[188:191],v[24:27],a[28:31],0
s_waitcnt lgkmcnt(7)
v_mfma_f32_16x16x32_bf16 v[160:163],v[28:31],a[32:35],v[160:163]
buffer_load_dwordx4 v0,s[8:11],s64 offen offset:2048 sc1 lds
s_waitcnt vmcnt(9)
v_mfma_f32_16x16x32_bf16 v[164:167],v[28:31],a[36:39],v[164:167]
v_mfma_f32_16x16x32_bf16 v[128:131],v[156:159],v[196:199],v[128:131]
v_mfma_f32_16x16x32_bf16 v[168:171],v[28:31],a[40:43],v[168:171]
s_waitcnt vmcnt(8)
v_mfma_f32_16x16x32_bf16 v[128:131],v[156:159],v[200:203],v[128:131]
v_mfma_f32_16x16x32_bf16 v[172:175],v[28:31],a[44:47],v[172:175]
v_mfma_f32_16x16x32_bf16 v[176:179],v[28:31],a[48:51],v[176:179]
buffer_load_dwordx4 v0,s[8:11],s64 offen offset:3072 sc1 lds
s_waitcnt vmcnt(8)
v_mfma_f32_16x16x32_bf16 v[180:183],v[28:31],a[52:55],v[180:183]
v_mfma_f32_16x16x32_bf16 v[128:131],v[156:159],v[204:207],v[128:131]
v_mfma_f32_16x16x32_bf16 v[184:187],v[28:31],a[56:59],v[184:187]
s_waitcnt vmcnt(7)
v_mfma_f32_16x16x32_bf16 v[132:135],v[156:159],v[208:211],0
v_mfma_f32_16x16x32_bf16 v[188:191],v[28:31],a[60:63],v[188:191]
s_waitcnt lgkmcnt(6)
v_mfma_f32_16x16x32_bf16 v[160:163],v[32:35],a[64:67],v[160:163]
s_add_u32 m0,s58,4096
s_add_u32 s64,s64,4096
buffer_load_dwordx4 v0,s[8:11],s64 offen offset:0 sc1 lds
v_mfma_f32_16x16x32_bf16 v[164:167],v[32:35],a[68:71],v[164:167]
s_waitcnt vmcnt(7)
v_mfma_f32_16x16x32_bf16 v[132:135],v[156:159],v[212:215],v[132:135]
v_mfma_f32_16x16x32_bf16 v[168:171],v[32:35],a[72:75],v[168:171]
v_mfma_f32_16x16x32_bf16 v[172:175],v[32:35],a[76:79],v[172:175]
s_waitcnt vmcnt(6)
v_mfma_f32_16x16x32_bf16 v[132:135],v[156:159],v[216:219],v[132:135]
v_mfma_f32_16x16x32_bf16 v[176:179],v[32:35],a[80:83],v[176:179]
buffer_load_dwordx4 v0,s[8:11],s64 offen offset:1024 sc1 lds
v_mfma_f32_16x16x32_bf16 v[180:183],v[32:35],a[84:87],v[180:183]
ds_write_b128 v6,v[128:131]
s_waitcnt vmcnt(6)
v_mfma_f32_16x16x32_bf16 v[184:187],v[32:35],a[88:91],v[184:187]
v_mfma_f32_16x16x32_bf16 v[132:135],v[156:159],v[220:223],v[132:135]
v_mfma_f32_16x16x32_bf16 v[188:191],v[32:35],a[92:95],v[188:191]
s_waitcnt lgkmcnt(2)
v_mfma_f32_16x16x32_bf16 v[160:163],v[36:39],a[96:99],v[160:163]
buffer_load_dwordx4 v0,s[8:11],s64 offen offset:2048 sc1 lds
v_mfma_f32_16x16x32_bf16 v[164:167],v[36:39],a[100:103],v[164:167]
ds_write_b128 v6,v[132:135] offset:2048
v_mfma_f32_16x16x32_bf16 v[168:171],v[36:39],a[104:107],v[168:171]
v_mfma_f32_16x16x32_bf16 v[172:175],v[36:39],a[108:111],v[172:175]
v_mfma_f32_16x16x32_bf16 v[176:179],v[36:39],a[112:115],v[176:179]
buffer_load_dwordx4 v0,s[8:11],s64 offen offset:3072 sc1 lds
v_mfma_f32_16x16x32_bf16 v[180:183],v[36:39],a[116:119],v[180:183]
s_waitcnt lgkmcnt(0)
s_barrier
ds_read_b128 v[56:59],v4 offset:4096
v_mfma_f32_16x16x32_bf16 v[184:187],v[36:39],a[120:123],v[184:187]
ds_read_b128 v[60:63],v4 offset:5120
ds_read_b128 v[64:67],v4 offset:6144
v_mfma_f32_16x16x32_bf16 v[188:191],v[36:39],a[124:127],v[188:191]
ds_read_b128 v[68:71],v4 offset:7168
ds_read_b128 v[72:75],v4 offset:12288
v_mfma_f32_16x16x32_bf16 v[160:163],v[40:43],a[128:131],v[160:163]
s_add_u32 m0,s58,8192
s_add_u32 s64,s64,4096
buffer_load_dwordx4 v0,s[8:11],s64 offen offset:0 sc1 lds
v_mfma_f32_16x16x32_bf16 v[164:167],v[40:43],a[132:135],v[164:167]
ds_read_b128 v[76:79],v4 offset:13312
ds_read_b128 v[80:83],v4 offset:14336
v_mfma_f32_16x16x32_bf16 v[168:171],v[40:43],a[136:139],v[168:171]
ds_read_b128 v[84:87],v4 offset:15360
ds_read_b128 v[248:251],v245
v_mfma_f32_16x16x32_bf16 v[172:175],v[40:43],a[140:143],v[172:175]
ds_read_b128 v[96:99],v23
ds_read_b128 v[100:103],v23 offset:16
v_mfma_f32_16x16x32_bf16 v[176:179],v[40:43],a[144:147],v[176:179]
buffer_load_dwordx4 v0,s[8:11],s64 offen offset:1024 sc1 lds
v_lshlrev_b32 v88,16,v224
v_mfma_f32_16x16x32_bf16 v[180:183],v[40:43],a[148:151],v[180:183]
v_and_b32 v89,0xffff0000,v224
v_lshlrev_b32 v90,16,v225
v_and_b32 v91,0xffff0000,v225
v_mfma_f32_16x16x32_bf16 v[184:187],v[40:43],a[152:155],v[184:187]
v_lshlrev_b32 v92,16,v226
v_and_b32 v93,0xffff0000,v226
v_lshlrev_b32 v94,16,v227
v_mfma_f32_16x16x32_bf16 v[188:191],v[40:43],a[156:159],v[188:191]
v_and_b32 v95,0xffff0000,v227
s_lshl_b32 s23,s51,5
s_add_u32 s23,s23,s68
v_mfma_f32_16x16x32_bf16 v[160:163],v[44:47],a[160:163],v[160:163]
buffer_load_dwordx4 v0,s[8:11],s64 offen offset:2048 sc1 lds
s_lshl_b32 s24,s23,10
v_mfma_f32_16x16x32_bf16 v[164:167],v[44:47],a[164:167],v[164:167]
s_waitcnt lgkmcnt(0)
v_or3_b32 v248,v248,v249,v250
v_or_b32 v248,v248,v251
v_mfma_f32_16x16x32_bf16 v[168:171],v[44:47],a[168:171],v[168:171]
s_lshl_b32 s25,s51,10
s_add_u32 s25,s25,2883584
s_cmp_eq_u32 s23,s55
s_cselect_b32 s25,s25,s24
v_mfma_f32_16x16x32_bf16 v[172:175],v[44:47],a[172:175],v[172:175]
v_readfirstlane_b32 s72,v248
s_add_u32 s25,s25,8388608
s_mov_b32 s6,268435456
v_mfma_f32_16x16x32_bf16 v[176:179],v[44:47],a[176:179],v[176:179]
buffer_load_dwordx4 v0,s[8:11],s64 offen offset:3072 sc1 lds
s_cmp_eq_u32 s31,0
s_cselect_b32 s25,s24,s25
s_cselect_b64 s[4:5],s[16:17],s[44:45]
s_cmov_b32 s6,2097152
v_mfma_f32_16x16x32_bf16 v[180:183],v[44:47],a[180:183],v[180:183]
buffer_load_dwordx4 v[224:227],v0,s[4:7],s25 offen sc1
s_cmp_lt_u32 s51,55
s_cselect_b32 s24,s86,1536
v_mfma_f32_16x16x32_bf16 v[184:187],v[44:47],a[184:187],v[184:187]
s_cmp_eq_u32 s24,768
s_cselect_b32 s24,128,0
s_lshl_b32 s23,s51,13
v_mfma_f32_16x16x32_bf16 v[188:191],v[44:47],a[188:191],v[188:191]
s_lshl2_add_u32 s23,s68,s23
s_add_u32 s23,s23,10487168
s_add_u32 s23,s23,s24
v_mfma_f32_16x16x32_bf16 v[160:163],v[48:51],a[192:195],v[160:163]
s_add_u32 m0,s57,24576
s_nop 0
buffer_load_dwordx4 v0,s[8:11],s65 offen offset:0 sc1 lds
v_mfma_f32_16x16x32_bf16 v[164:167],v[48:51],a[196:199],v[164:167]
buffer_load_dword v246,off,s[8:11],s23 sc1
v_lshrrev_b32 v244,4,v1
v_mfma_f32_16x16x32_bf16 v[168:171],v[48:51],a[200:203],v[168:171]
s_sub_u32 s23,s77,8
v_add_u32 v244,s23,v244
v_max_i32 v244,0,v244
v_mfma_f32_16x16x32_bf16 v[172:175],v[48:51],a[204:207],v[172:175]
v_lshl_add_u32 v244,v244,13,v21
buffer_load_dwordx2 v[242:243],v244,s[8:11],0 offen sc1
v_mfma_f32_16x16x32_bf16 v[176:179],v[48:51],a[208:211],v[176:179]
buffer_load_dwordx4 v0,s[8:11],s65 offen offset:1024 sc1 lds
s_lshl_b32 s18,s26,5
v_mfma_f32_16x16x32_bf16 v[180:183],v[48:51],a[212:215],v[180:183]
s_add_u32 s18,s18,s68
s_lshl_b32 s19,s18,10
s_add_u32 s20,s19,8388608
v_mfma_f32_16x16x32_bf16 v[184:187],v[48:51],a[216:219],v[184:187]
s_waitcnt lgkmcnt(0)
v_cvt_pk_bf16_f32 v104,v96,v97
v_cvt_pk_bf16_f32 v105,v98,v99
v_mfma_f32_16x16x32_bf16 v[188:191],v[48:51],a[220:223],v[188:191]
v_cvt_pk_bf16_f32 v106,v100,v101
v_cvt_pk_bf16_f32 v107,v102,v103
v_lshlrev_b32 v96,16,v104
v_mfma_f32_16x16x32_bf16 v[160:163],v[52:55],a[224:227],v[160:163]
buffer_load_dwordx4 v0,s[8:11],s65 offen offset:2048 sc1 lds
v_and_b32 v97,0xffff0000,v104
v_mfma_f32_16x16x32_bf16 v[164:167],v[52:55],a[228:231],v[164:167]
v_lshlrev_b32 v98,16,v105
v_and_b32 v99,0xffff0000,v105
v_lshlrev_b32 v100,16,v106
v_mfma_f32_16x16x32_bf16 v[168:171],v[52:55],a[232:235],v[168:171]
v_and_b32 v101,0xffff0000,v106
v_lshlrev_b32 v102,16,v107
v_and_b32 v103,0xffff0000,v107
v_mfma_f32_16x16x32_bf16 v[172:175],v[52:55],a[236:239],v[172:175]
v_pk_add_f32 v[88:89],v[88:89],v[96:97]
v_pk_add_f32 v[90:91],v[90:91],v[98:99]
v_pk_add_f32 v[92:93],v[92:93],v[100:101]
v_mfma_f32_16x16x32_bf16 v[176:179],v[52:55],a[240:243],v[176:179]
buffer_load_dwordx4 v0,s[8:11],s65 offen offset:3072 sc1 lds
v_pk_add_f32 v[94:95],v[94:95],v[102:103]
v_mfma_f32_16x16x32_bf16 v[180:183],v[52:55],a[244:247],v[180:183]
v_cvt_pk_bf16_f32 v104,v88,v89
v_cvt_pk_bf16_f32 v105,v90,v91
v_cvt_pk_bf16_f32 v106,v92,v93
v_mfma_f32_16x16x32_bf16 v[184:187],v[52:55],a[248:251],v[184:187]
v_cvt_pk_bf16_f32 v107,v94,v95
v_lshlrev_b32 v88,16,v104
v_and_b32 v89,0xffff0000,v104
v_mfma_f32_16x16x32_bf16 v[188:191],v[52:55],a[252:255],v[188:191]
v_lshlrev_b32 v90,16,v105
v_and_b32 v91,0xffff0000,v105
v_lshlrev_b32 v92,16,v106
s_waitcnt lgkmcnt(10)
v_mfma_f32_16x16x32_bf16 v[192:195],v[56:59],a[0:3],0
v_and_b32 v93,0xffff0000,v106
v_lshlrev_b32 v94,16,v107
v_and_b32 v95,0xffff0000,v107
v_mfma_f32_16x16x32_bf16 v[196:199],v[56:59],a[4:7],0
v_readfirstlane_b32 s78,v88
s_nop 1
v_pk_add_f32 v[120:121],v[88:89],s[78:79] op_sel_hi:[1,0] neg_lo:[0,1] neg_hi:[0,1]
v_pk_add_f32 v[122:123],v[90:91],s[78:79] op_sel_hi:[1,0] neg_lo:[0,1] neg_hi:[0,1]
v_mfma_f32_16x16x32_bf16 v[200:203],v[56:59],a[8:11],0
v_cvt_pk_bf16_f32 v24,v160,v164
v_cvt_pk_bf16_f32 v25,v168,v172
v_cvt_pk_bf16_f32 v26,v176,v180
v_mfma_f32_16x16x32_bf16 v[204:207],v[56:59],a[12:15],0
v_cvt_pk_bf16_f32 v27,v184,v188
s_add_u32 s62,s69,0
buffer_store_dwordx4 v[24:27],v5,s[8:11],s62 offen
v_mfma_f32_16x16x32_bf16 v[208:211],v[56:59],a[16:19],0
v_cvt_pk_bf16_f32 v28,v161,v165
v_cvt_pk_bf16_f32 v29,v169,v173
v_cvt_pk_bf16_f32 v30,v177,v181
v_mfma_f32_16x16x32_bf16 v[212:215],v[56:59],a[20:23],0
v_cvt_pk_bf16_f32 v31,v185,v189
s_add_u32 s62,s69,16384
buffer_store_dwordx4 v[28:31],v5,s[8:11],s62 offen
v_mfma_f32_16x16x32_bf16 v[216:219],v[56:59],a[24:27],0
v_cvt_pk_bf16_f32 v32,v162,v166
v_cvt_pk_bf16_f32 v33,v170,v174
v_cvt_pk_bf16_f32 v34,v178,v182
v_mfma_f32_16x16x32_bf16 v[220:223],v[56:59],a[28:31],0
v_cvt_pk_bf16_f32 v35,v186,v190
s_add_u32 s62,s69,32768
buffer_store_dwordx4 v[32:35],v5,s[8:11],s62 offen
s_waitcnt lgkmcnt(9)
v_mfma_f32_16x16x32_bf16 v[192:195],v[60:63],a[32:35],v[192:195]
v_cvt_pk_bf16_f32 v36,v163,v167
v_cvt_pk_bf16_f32 v37,v171,v175
v_cvt_pk_bf16_f32 v38,v179,v183
v_mfma_f32_16x16x32_bf16 v[196:199],v[60:63],a[36:39],v[196:199]
v_cvt_pk_bf16_f32 v39,v187,v191
s_add_u32 s62,s69,49152
buffer_store_dwordx4 v[36:39],v5,s[8:11],s62 offen
v_mfma_f32_16x16x32_bf16 v[200:203],v[60:63],a[40:43],v[200:203]
v_pk_add_f32 v[124:125],v[92:93],s[78:79] op_sel_hi:[1,0] neg_lo:[0,1] neg_hi:[0,1]
v_pk_add_f32 v[126:127],v[94:95],s[78:79] op_sel_hi:[1,0] neg_lo:[0,1] neg_hi:[0,1]
v_pk_add_f32 v[128:129],v[120:121],v[122:123]
v_mfma_f32_16x16x32_bf16 v[204:207],v[60:63],a[44:47],v[204:207]
v_pk_mul_f32 v[130:131],v[120:121],v[120:121]
v_pk_add_f32 v[132:133],v[124:125],v[126:127]
v_pk_fma_f32 v[130:131],v[122:123],v[122:123],v[130:131]
v_mfma_f32_16x16x32_bf16 v[208:211],v[60:63],a[48:51],v[208:211]
v_pk_add_f32 v[128:129],v[128:129],v[132:133]
v_pk_fma_f32 v[130:131],v[124:125],v[124:125],v[130:131]
v_add_f32 v128,v128,v129
v_mfma_f32_16x16x32_bf16 v[212:215],v[60:63],a[52:55],v[212:215]
v_pk_fma_f32 v[130:131],v[126:127],v[126:127],v[130:131]
v_add_f32 v130,v130,v131
s_nop 1
v_permlane32_swap_b32 v128,v130
v_mfma_f32_16x16x32_bf16 v[216:219],v[60:63],a[56:59],v[216:219]
v_add_f32 v128,v128,v130
s_nop 1
v_add_f32_dpp v128,v128,v128 row_ror:8 row_mask:0xf bank_mask:0xf
s_nop 1
v_add_f32_dpp v128,v128,v128 row_ror:4 row_mask:0xf bank_mask:0xf
v_mfma_f32_16x16x32_bf16 v[220:223],v[60:63],a[60:63],v[220:223]
s_nop 0
v_add_f32_dpp v128,v128,v128 row_ror:2 row_mask:0xf bank_mask:0xf
s_nop 1
v_add_f32_dpp v128,v128,v128 row_ror:1 row_mask:0xf bank_mask:0xf
v_mov_b32 v130,v128
s_waitcnt lgkmcnt(8)
v_mfma_f32_16x16x32_bf16 v[192:195],v[64:67],a[64:67],v[192:195]
v_permlane16_swap_b32 v128,v130
v_add_f32 v128,v128,v130
v_mul_f32 v128,0x3b000000,v128
v_mfma_f32_16x16x32_bf16 v[196:199],v[64:67],a[68:71],v[196:199]
v_mov_b32 v130,v128
s_nop 1
v_permlane32_swap_b32 v128,v130
v_fma_f32 v130,-v128,v128,v130
v_mfma_f32_16x16x32_bf16 v[200:203],v[64:67],a[72:75],v[200:203]
v_add_f32 v128,s78,v128
v_max_f32 v130,0,v130
v_cvt_pk_bf16_f32 v130,v128,v130
v_mfma_f32_16x16x32_bf16 v[204:207],v[64:67],a[76:79],v[204:207]
v_lshlrev_b32 v128,16,v130
v_and_b32 v130,0xffff0000,v130
v_add_f32 v130,0x3727c5ac,v130
v_mfma_f32_16x16x32_bf16 v[208:211],v[64:67],a[80:83],v[208:211]
v_cvt_pk_bf16_f32 v130,v130,v130
v_and_b32 v130,0xffff0000,v130
v_sqrt_f32 v130,v130
v_mfma_f32_16x16x32_bf16 v[212:215],v[64:67],a[84:87],v[212:215]
v_pk_add_f32 v[120:121],v[88:89],v[128:129] op_sel_hi:[1,0] neg_lo:[0,1] neg_hi:[0,1]
v_pk_add_f32 v[122:123],v[90:91],v[128:129] op_sel_hi:[1,0] neg_lo:[0,1] neg_hi:[0,1]
v_pk_add_f32 v[124:125],v[92:93],v[128:129] op_sel_hi:[1,0] neg_lo:[0,1] neg_hi:[0,1]
v_mfma_f32_16x16x32_bf16 v[216:219],v[64:67],a[88:91],v[216:219]
v_pk_add_f32 v[126:127],v[94:95],v[128:129] op_sel_hi:[1,0] neg_lo:[0,1] neg_hi:[0,1]
v_cvt_pk_bf16_f32 v130,v130,v130
v_and_b32 v130,0xffff0000,v130
v_mfma_f32_16x16x32_bf16 v[220:223],v[64:67],a[92:95],v[220:223]
v_rcp_f32 v130,v130
v_cvt_pk_bf16_f32 v108,v120,v121
v_cvt_pk_bf16_f32 v109,v122,v123
s_waitcnt lgkmcnt(7)
v_mfma_f32_16x16x32_bf16 v[192:195],v[68:71],a[96:99],v[192:195]
v_cvt_pk_bf16_f32 v110,v124,v125
v_cvt_pk_bf16_f32 v111,v126,v127
v_lshlrev_b32 v120,16,v108
v_mfma_f32_16x16x32_bf16 v[196:199],v[68:71],a[100:103],v[196:199]
v_and_b32 v121,0xffff0000,v108
v_lshlrev_b32 v122,16,v109
v_and_b32 v123,0xffff0000,v109
v_mfma_f32_16x16x32_bf16 v[200:203],v[68:71],a[104:107],v[200:203]
v_lshlrev_b32 v124,16,v110
v_and_b32 v125,0xffff0000,v110
v_lshlrev_b32 v126,16,v111
v_mfma_f32_16x16x32_bf16 v[204:207],v[68:71],a[108:111],v[204:207]
v_and_b32 v127,0xffff0000,v111
v_pk_mul_f32 v[120:121],v[120:121],v[130:131] op_sel_hi:[1,0]
v_pk_mul_f32 v[122:123],v[122:123],v[130:131] op_sel_hi:[1,0]
v_mfma_f32_16x16x32_bf16 v[208:211],v[68:71],a[112:115],v[208:211]
v_pk_mul_f32 v[124:125],v[124:125],v[130:131] op_sel_hi:[1,0]
v_pk_mul_f32 v[126:127],v[126:127],v[130:131] op_sel_hi:[1,0]
v_cvt_pk_bf16_f32 v108,v120,v121
v_mfma_f32_16x16x32_bf16 v[212:215],v[68:71],a[116:119],v[212:215]
v_cvt_pk_bf16_f32 v109,v122,v123
v_cvt_pk_bf16_f32 v110,v124,v125
v_cvt_pk_bf16_f32 v111,v126,v127
v_mfma_f32_16x16x32_bf16 v[216:219],v[68:71],a[120:123],v[216:219]
v_lshlrev_b32 v112,16,v108
v_and_b32 v113,0xffff0000,v108
v_lshlrev_b32 v114,16,v109
v_mfma_f32_16x16x32_bf16 v[220:223],v[68:71],a[124:127],v[220:223]
v_and_b32 v115,0xffff0000,v109
v_lshlrev_b32 v116,16,v110
v_and_b32 v117,0xffff0000,v110
s_waitcnt lgkmcnt(6)
v_mfma_f32_16x16x32_bf16 v[192:195],v[72:75],a[128:131],v[192:195]
v_lshlrev_b32 v118,16,v111
v_and_b32 v119,0xffff0000,v111
v_pk_add_f32 v[88:89],v[88:89],v[112:113]
v_mfma_f32_16x16x32_bf16 v[196:199],v[72:75],a[132:135],v[196:199]
v_pk_add_f32 v[90:91],v[90:91],v[114:115]
v_pk_add_f32 v[92:93],v[92:93],v[116:117]
v_pk_add_f32 v[94:95],v[94:95],v[118:119]
v_mfma_f32_16x16x32_bf16 v[200:203],v[72:75],a[136:139],v[200:203]
v_cvt_pk_bf16_f32 v96,v88,v89
v_cvt_pk_bf16_f32 v97,v90,v91
v_cvt_pk_bf16_f32 v98,v92,v93
v_mfma_f32_16x16x32_bf16 v[204:207],v[72:75],a[140:143],v[204:207]
v_cvt_pk_bf16_f32 v99,v94,v95
buffer_store_dwordx4 v[96:99],v0,s[8:11],s20 offen sc1
v_mfma_f32_16x16x32_bf16 v[208:211],v[72:75],a[144:147],v[208:211]
v_lshlrev_b32 v88,16,v96
v_and_b32 v89,0xffff0000,v96
v_lshlrev_b32 v90,16,v97
v_mfma_f32_16x16x32_bf16 v[212:215],v[72:75],a[148:151],v[212:215]
v_and_b32 v91,0xffff0000,v97
v_lshlrev_b32 v92,16,v98
v_and_b32 v93,0xffff0000,v98
v_mfma_f32_16x16x32_bf16 v[216:219],v[72:75],a[152:155],v[216:219]
v_lshlrev_b32 v94,16,v99
v_and_b32 v95,0xffff0000,v99
v_readfirstlane_b32 s78,v88
v_mfma_f32_16x16x32_bf16 v[220:223],v[72:75],a[156:159],v[220:223]
s_nop 0
v_pk_add_f32 v[120:121],v[88:89],s[78:79] op_sel_hi:[1,0] neg_lo:[0,1] neg_hi:[0,1]
v_pk_add_f32 v[122:123],v[90:91],s[78:79] op_sel_hi:[1,0] neg_lo:[0,1] neg_hi:[0,1]
v_pk_add_f32 v[124:125],v[92:93],s[78:79] op_sel_hi:[1,0] neg_lo:[0,1] neg_hi:[0,1]
s_waitcnt lgkmcnt(5)
v_mfma_f32_16x16x32_bf16 v[192:195],v[76:79],a[160:163],v[192:195]
v_pk_add_f32 v[126:127],v[94:95],s[78:79] op_sel_hi:[1,0] neg_lo:[0,1] neg_hi:[0,1]
v_pk_add_f32 v[128:129],v[120:121],v[122:123]
v_pk_mul_f32 v[130:131],v[120:121],v[120:121]
v_mfma_f32_16x16x32_bf16 v[196:199],v[76:79],a[164:167],v[196:199]
v_pk_add_f32 v[132:133],v[124:125],v[126:127]
v_pk_fma_f32 v[130:131],v[122:123],v[122:123],v[130:131]
v_pk_add_f32 v[128:129],v[128:129],v[132:133]
v_mfma_f32_16x16x32_bf16 v[200:203],v[76:79],a[168:171],v[200:203]
v_pk_fma_f32 v[130:131],v[124:125],v[124:125],v[130:131]
v_add_f32 v128,v128,v129
v_pk_fma_f32 v[130:131],v[126:127],v[126:127],v[130:131]
v_mfma_f32_16x16x32_bf16 v[204:207],v[76:79],a[172:175],v[204:207]
v_add_f32 v130,v130,v131
s_nop 1
v_permlane32_swap_b32 v128,v130
v_add_f32 v128,v128,v130
v_mfma_f32_16x16x32_bf16 v[208:211],v[76:79],a[176:179],v[208:211]
s_nop 0
v_add_f32_dpp v128,v128,v128 row_ror:8 row_mask:0xf bank_mask:0xf
s_nop 1
v_add_f32_dpp v128,v128,v128 row_ror:4 row_mask:0xf bank_mask:0xf
s_nop 1
v_add_f32_dpp v128,v128,v128 row_ror:2 row_mask:0xf bank_mask:0xf
v_mfma_f32_16x16x32_bf16 v[212:215],v[76:79],a[180:183],v[212:215]
s_nop 0
v_add_f32_dpp v128,v128,v128 row_ror:1 row_mask:0xf bank_mask:0xf
v_mov_b32 v130,v128
s_nop 1
v_permlane16_swap_b32 v128,v130
v_mfma_f32_16x16x32_bf16 v[216:219],v[76:79],a[184:187],v[216:219]
v_add_f32 v128,v128,v130
v_mul_f32 v128,0x3b000000,v128
v_mov_b32 v130,v128
v_mfma_f32_16x16x32_bf16 v[220:223],v[76:79],a[188:191],v[220:223]
s_nop 0
v_permlane32_swap_b32 v128,v130
v_fma_f32 v130,-v128,v128,v130
v_add_f32 v128,s78,v128
s_waitcnt lgkmcnt(4)
v_mfma_f32_16x16x32_bf16 v[192:195],v[80:83],a[192:195],v[192:195]
v_max_f32 v130,0,v130
v_cvt_pk_bf16_f32 v130,v128,v130
v_lshlrev_b32 v128,16,v130
v_mfma_f32_16x16x32_bf16 v[196:199],v[80:83],a[196:199],v[196:199]
v_and_b32 v130,0xffff0000,v130
v_add_f32 v130,0x3727c5ac,v130
v_cvt_pk_bf16_f32 v130,v130,v130
v_mfma_f32_16x16x32_bf16 v[200:203],v[80:83],a[200:203],v[200:203]
v_and_b32 v130,0xffff0000,v130
v_sqrt_f32 v130,v130
v_pk_add_f32 v[120:121],v[88:89],v[128:129] op_sel_hi:[1,0] neg_lo:[0,1] neg_hi:[0,1]
v_mfma_f32_16x16x32_bf16 v[204:207],v[80:83],a[204:207],v[204:207]
v_pk_add_f32 v[122:123],v[90:91],v[128:129] op_sel_hi:[1,0] neg_lo:[0,1] neg_hi:[0,1]
v_pk_add_f32 v[124:125],v[92:93],v[128:129] op_sel_hi:[1,0] neg_lo:[0,1] neg_hi:[0,1]
v_pk_add_f32 v[126:127],v[94:95],v[128:129] op_sel_hi:[1,0] neg_lo:[0,1] neg_hi:[0,1]
v_mfma_f32_16x16x32_bf16 v[208:211],v[80:83],a[208:211],v[208:211]
v_cvt_pk_bf16_f32 v130,v130,v130
v_and_b32 v130,0xffff0000,v130
v_rcp_f32 v130,v130
v_mfma_f32_16x16x32_bf16 v[212:215],v[80:83],a[212:215],v[212:215]
v_cvt_pk_bf16_f32 v100,v120,v121
v_cvt_pk_bf16_f32 v101,v122,v123
v_cvt_pk_bf16_f32 v102,v124,v125
v_mfma_f32_16x16x32_bf16 v[216:219],v[80:83],a[216:219],v[216:219]
v_cvt_pk_bf16_f32 v103,v126,v127
v_lshlrev_b32 v120,16,v100
v_and_b32 v121,0xffff0000,v100
v_mfma_f32_16x16x32_bf16 v[220:223],v[80:83],a[220:223],v[220:223]
v_lshlrev_b32 v122,16,v101
v_and_b32 v123,0xffff0000,v101
v_lshlrev_b32 v124,16,v102
s_waitcnt lgkmcnt(3)
v_mfma_f32_16x16x32_bf16 v[192:195],v[84:87],a[224:227],v[192:195]
v_and_b32 v125,0xffff0000,v102
v_lshlrev_b32 v126,16,v103
v_and_b32 v127,0xffff0000,v103
v_mfma_f32_16x16x32_bf16 v[196:199],v[84:87],a[228:231],v[196:199]
v_pk_mul_f32 v[120:121],v[120:121],v[130:131] op_sel_hi:[1,0]
v_pk_mul_f32 v[122:123],v[122:123],v[130:131] op_sel_hi:[1,0]
v_pk_mul_f32 v[124:125],v[124:125],v[130:131] op_sel_hi:[1,0]
v_mfma_f32_16x16x32_bf16 v[200:203],v[84:87],a[232:235],v[200:203]
v_pk_mul_f32 v[126:127],v[126:127],v[130:131] op_sel_hi:[1,0]
v_cvt_pk_bf16_f32 v100,v120,v121
v_cvt_pk_bf16_f32 v101,v122,v123
v_mfma_f32_16x16x32_bf16 v[204:207],v[84:87],a[236:239],v[204:207]
v_cvt_pk_bf16_f32 v102,v124,v125
v_cvt_pk_bf16_f32 v103,v126,v127
s_add_u32 s20,s19,2097152
v_mfma_f32_16x16x32_bf16 v[208:211],v[84:87],a[240:243],v[208:211]
buffer_store_dwordx4 v[100:103],v0,s[8:11],s20 offen sc1
v_mfma_f32_16x16x32_bf16 v[212:215],v[84:87],a[244:247],v[212:215]
v_mov_b32 v20,1
s_lshl_b32 s73,s26,13
v_mfma_f32_16x16x32_bf16 v[216:219],v[84:87],a[248:251],v[216:219]
s_lshl2_add_u32 s73,s68,s73
s_add_u32 s73,s73,10487552
v_mfma_f32_16x16x32_bf16 v[220:223],v[84:87],a[252:255],v[220:223]
v_cvt_pk_bf16_f32 v40,v192,v196
v_cvt_pk_bf16_f32 v41,v200,v204
v_cvt_pk_bf16_f32 v42,v208,v212
s_nop 4
v_cvt_pk_bf16_f32 v43,v216,v220
s_add_u32 s62,s69,262144
buffer_store_dwordx4 v[40:43],v5,s[8:11],s62 offen
v_cvt_pk_bf16_f32 v44,v193,v197
v_cvt_pk_bf16_f32 v45,v201,v205
v_cvt_pk_bf16_f32 v46,v209,v213
v_cvt_pk_bf16_f32 v47,v217,v221
s_add_u32 s62,s69,278528
buffer_store_dwordx4 v[44:47],v5,s[8:11],s62 offen
v_cvt_pk_bf16_f32 v48,v194,v198
v_cvt_pk_bf16_f32 v49,v202,v206
v_cvt_pk_bf16_f32 v50,v210,v214
v_cvt_pk_bf16_f32 v51,v218,v222
s_add_u32 s62,s69,294912
buffer_store_dwordx4 v[48:51],v5,s[8:11],s62 offen
v_cvt_pk_bf16_f32 v52,v195,v199
v_cvt_pk_bf16_f32 v53,v203,v207
v_cvt_pk_bf16_f32 v54,v211,v215
v_cvt_pk_bf16_f32 v55,v219,v223
s_add_u32 s62,s69,311296
buffer_store_dwordx4 v[52:55],v5,s[8:11],s62 offen
s_cmp_lg_u32 s72,0
s_cbranch_scc1 L_aa_40
s_waitcnt vmcnt(10)
s_branch L_aa_50
L_av_53:
ds_read_b128 v[24:27],v4 offset:0
ds_read_b128 v[28:31],v4 offset:1024
ds_read_b128 v[32:35],v4 offset:2048
ds_read_b128 v[36:39],v4 offset:3072
ds_read_b128 v[40:43],v4 offset:8192
ds_read_b128 v[44:47],v4 offset:9216
ds_read_b128 v[48:51],v4 offset:10240
ds_read_b128 v[52:55],v4 offset:11264
s_min_u32 s56,s32,s33
s_cmp_lt_u32 s77,64
s_cselect_b32 s56,s56,0
s_cmp_eq_u32 s56,0
s_cselect_b32 s72,0x80000000,0
v_mov_b32 v248,s72
s_or_b32 s64,s70,s72
s_or_b32 s65,s71,s72
ds_write_b32 v247,v248
s_and_b32 s57,s46,1
s_mul_i32 s58,s57,12288
s_add_u32 s64,s64,s58
s_lshl_b32 s57,s57,12
s_add_u32 s65,s65,s57
s_and_b32 s59,s50,2048
s_lshl_b32 s59,s59,4
s_xor_b32 s60,s67,65536
s_add_u32 s59,s59,s60
s_add_u32 s58,s58,s59
s_add_u32 s57,s57,s59
s_add_u32 m0,s58,0
s_waitcnt lgkmcnt(8)
v_mfma_f32_16x16x32_bf16 v[160:163],v[24:27],a[0:3],0
buffer_load_dwordx4 v0,s[8:11],s64 offen offset:0 sc1 lds
v_mfma_f32_16x16x32_bf16 v[164:167],v[24:27],a[4:7],0
v_mfma_f32_16x16x32_bf16 v[168:171],v[24:27],a[8:11],0
v_mfma_f32_16x16x32_bf16 v[172:175],v[24:27],a[12:15],0
v_mfma_f32_16x16x32_bf16 v[176:179],v[24:27],a[16:19],0
buffer_load_dwordx4 v0,s[8:11],s64 offen offset:1024 sc1 lds
v_mfma_f32_16x16x32_bf16 v[180:183],v[24:27],a[20:23],0
v_mfma_f32_16x16x32_bf16 v[184:187],v[24:27],a[24:27],0
s_waitcnt vmcnt(9)
v_mfma_f32_16x16x32_bf16 v[128:131],v[156:159],v[192:195],0
v_mfma_f32_16x16x32_bf16 v[188:191],v[24:27],a[28:31],0
s_waitcnt lgkmcnt(7)
v_mfma_f32_16x16x32_bf16 v[160:163],v[28:31],a[32:35],v[160:163]
buffer_load_dwordx4 v0,s[8:11],s64 offen offset:2048 sc1 lds
s_waitcnt vmcnt(9)
v_mfma_f32_16x16x32_bf16 v[164:167],v[28:31],a[36:39],v[164:167]
v_mfma_f32_16x16x32_bf16 v[128:131],v[156:159],v[196:199],v[128:131]
v_mfma_f32_16x16x32_bf16 v[168:171],v[28:31],a[40:43],v[168:171]
s_waitcnt vmcnt(8)
v_mfma_f32_16x16x32_bf16 v[128:131],v[156:159],v[200:203],v[128:131]
v_mfma_f32_16x16x32_bf16 v[172:175],v[28:31],a[44:47],v[172:175]
v_mfma_f32_16x16x32_bf16 v[176:179],v[28:31],a[48:51],v[176:179]
buffer_load_dwordx4 v0,s[8:11],s64 offen offset:3072 sc1 lds
s_waitcnt vmcnt(8)
v_mfma_f32_16x16x32_bf16 v[180:183],v[28:31],a[52:55],v[180:183]
v_mfma_f32_16x16x32_bf16 v[128:131],v[156:159],v[204:207],v[128:131]
v_mfma_f32_16x16x32_bf16 v[184:187],v[28:31],a[56:59],v[184:187]
s_waitcnt vmcnt(7)
v_mfma_f32_16x16x32_bf16 v[132:135],v[156:159],v[208:211],0
v_mfma_f32_16x16x32_bf16 v[188:191],v[28:31],a[60:63],v[188:191]
s_waitcnt lgkmcnt(6)
v_mfma_f32_16x16x32_bf16 v[160:163],v[32:35],a[64:67],v[160:163]
s_add_u32 m0,s58,4096
s_add_u32 s64,s64,4096
buffer_load_dwordx4 v0,s[8:11],s64 offen offset:0 sc1 lds
v_mfma_f32_16x16x32_bf16 v[164:167],v[32:35],a[68:71],v[164:167]
s_waitcnt vmcnt(7)
v_mfma_f32_16x16x32_bf16 v[132:135],v[156:159],v[212:215],v[132:135]
v_mfma_f32_16x16x32_bf16 v[168:171],v[32:35],a[72:75],v[168:171]
v_mfma_f32_16x16x32_bf16 v[172:175],v[32:35],a[76:79],v[172:175]
s_waitcnt vmcnt(6)
v_mfma_f32_16x16x32_bf16 v[132:135],v[156:159],v[216:219],v[132:135]
v_mfma_f32_16x16x32_bf16 v[176:179],v[32:35],a[80:83],v[176:179]
buffer_load_dwordx4 v0,s[8:11],s64 offen offset:1024 sc1 lds
v_mfma_f32_16x16x32_bf16 v[180:183],v[32:35],a[84:87],v[180:183]
ds_write_b128 v6,v[128:131]
s_waitcnt vmcnt(6)
v_mfma_f32_16x16x32_bf16 v[184:187],v[32:35],a[88:91],v[184:187]
v_mfma_f32_16x16x32_bf16 v[132:135],v[156:159],v[220:223],v[132:135]
v_mfma_f32_16x16x32_bf16 v[188:191],v[32:35],a[92:95],v[188:191]
s_waitcnt lgkmcnt(2)
v_mfma_f32_16x16x32_bf16 v[160:163],v[36:39],a[96:99],v[160:163]
buffer_load_dwordx4 v0,s[8:11],s64 offen offset:2048 sc1 lds
v_mfma_f32_16x16x32_bf16 v[164:167],v[36:39],a[100:103],v[164:167]
ds_write_b128 v6,v[132:135] offset:2048
v_mfma_f32_16x16x32_bf16 v[168:171],v[36:39],a[104:107],v[168:171]
v_mfma_f32_16x16x32_bf16 v[172:175],v[36:39],a[108:111],v[172:175]
v_mfma_f32_16x16x32_bf16 v[176:179],v[36:39],a[112:115],v[176:179]
buffer_load_dwordx4 v0,s[8:11],s64 offen offset:3072 sc1 lds
v_mfma_f32_16x16x32_bf16 v[180:183],v[36:39],a[116:119],v[180:183]
s_waitcnt lgkmcnt(0)
s_barrier
ds_read_b128 v[56:59],v4 offset:4096
v_mfma_f32_16x16x32_bf16 v[184:187],v[36:39],a[120:123],v[184:187]
ds_read_b128 v[60:63],v4 offset:5120
ds_read_b128 v[64:67],v4 offset:6144
v_mfma_f32_16x16x32_bf16 v[188:191],v[36:39],a[124:127],v[188:191]
ds_read_b128 v[68:71],v4 offset:7168
ds_read_b128 v[72:75],v4 offset:12288
v_mfma_f32_16x16x32_bf16 v[160:163],v[40:43],a[128:131],v[160:163]
s_add_u32 m0,s58,8192
s_add_u32 s64,s64,4096
buffer_load_dwordx4 v0,s[8:11],s64 offen offset:0 sc1 lds
v_mfma_f32_16x16x32_bf16 v[164:167],v[40:43],a[132:135],v[164:167]
ds_read_b128 v[76:79],v4 offset:13312
ds_read_b128 v[80:83],v4 offset:14336
v_mfma_f32_16x16x32_bf16 v[168:171],v[40:43],a[136:139],v[168:171]
ds_read_b128 v[84:87],v4 offset:15360
ds_read_b128 v[248:251],v245
v_mfma_f32_16x16x32_bf16 v[172:175],v[40:43],a[140:143],v[172:175]
ds_read_b128 v[96:99],v23
ds_read_b128 v[100:103],v23 offset:16
v_mfma_f32_16x16x32_bf16 v[176:179],v[40:43],a[144:147],v[176:179]
buffer_load_dwordx4 v0,s[8:11],s64 offen offset:1024 sc1 lds
v_lshlrev_b32 v88,16,v224
v_mfma_f32_16x16x32_bf16 v[180:183],v[40:43],a[148:151],v[180:183]
v_and_b32 v89,0xffff0000,v224
v_lshlrev_b32 v90,16,v225
v_and_b32 v91,0xffff0000,v225
v_mfma_f32_16x16x32_bf16 v[184:187],v[40:43],a[152:155],v[184:187]
v_lshlrev_b32 v92,16,v226
v_and_b32 v93,0xffff0000,v226
v_lshlrev_b32 v94,16,v227
v_mfma_f32_16x16x32_bf16 v[188:191],v[40:43],a[156:159],v[188:191]
v_and_b32 v95,0xffff0000,v227
s_lshl_b32 s23,s51,5
s_add_u32 s23,s23,s68
v_mfma_f32_16x16x32_bf16 v[160:163],v[44:47],a[160:163],v[160:163]
buffer_load_dwordx4 v0,s[8:11],s64 offen offset:2048 sc1 lds
s_lshl_b32 s24,s23,10
v_mfma_f32_16x16x32_bf16 v[164:167],v[44:47],a[164:167],v[164:167]
s_waitcnt lgkmcnt(0)
v_or3_b32 v248,v248,v249,v250
v_or_b32 v248,v248,v251
v_mfma_f32_16x16x32_bf16 v[168:171],v[44:47],a[168:171],v[168:171]
s_lshl_b32 s25,s51,10
s_add_u32 s25,s25,2883584
s_cmp_eq_u32 s23,s55
s_cselect_b32 s25,s25,s24
v_mfma_f32_16x16x32_bf16 v[172:175],v[44:47],a[172:175],v[172:175]
v_readfirstlane_b32 s72,v248
s_add_u32 s25,s25,8388608
s_mov_b32 s6,268435456
v_mfma_f32_16x16x32_bf16 v[176:179],v[44:47],a[176:179],v[176:179]
buffer_load_dwordx4 v0,s[8:11],s64 offen offset:3072 sc1 lds
s_cmp_eq_u32 s31,0
s_cselect_b32 s25,s24,s25
s_cselect_b64 s[4:5],s[16:17],s[44:45]
s_cmov_b32 s6,2097152
v_mfma_f32_16x16x32_bf16 v[180:183],v[44:47],a[180:183],v[180:183]
buffer_load_dwordx4 v[224:227],v0,s[4:7],s25 offen sc1
s_cmp_lt_u32 s51,55
s_cselect_b32 s24,s86,1536
v_mfma_f32_16x16x32_bf16 v[184:187],v[44:47],a[184:187],v[184:187]
s_cmp_eq_u32 s24,768
s_cselect_b32 s24,128,0
s_lshl_b32 s23,s51,13
v_mfma_f32_16x16x32_bf16 v[188:191],v[44:47],a[188:191],v[188:191]
s_lshl2_add_u32 s23,s68,s23
s_add_u32 s23,s23,10487168
s_add_u32 s23,s23,s24
v_mfma_f32_16x16x32_bf16 v[160:163],v[48:51],a[192:195],v[160:163]
s_add_u32 m0,s57,24576
s_nop 0
buffer_load_dwordx4 v0,s[8:11],s65 offen offset:0 sc1 lds
v_mfma_f32_16x16x32_bf16 v[164:167],v[48:51],a[196:199],v[164:167]
buffer_load_dword v246,off,s[8:11],s23 sc1
v_lshrrev_b32 v244,4,v1
v_mfma_f32_16x16x32_bf16 v[168:171],v[48:51],a[200:203],v[168:171]
s_sub_u32 s23,s77,8
v_add_u32 v244,s23,v244
v_max_i32 v244,0,v244
v_mfma_f32_16x16x32_bf16 v[172:175],v[48:51],a[204:207],v[172:175]
v_lshl_add_u32 v244,v244,13,v21
buffer_load_dwordx2 v[242:243],v244,s[8:11],0 offen sc1
v_mfma_f32_16x16x32_bf16 v[176:179],v[48:51],a[208:211],v[176:179]
buffer_load_dwordx4 v0,s[8:11],s65 offen offset:1024 sc1 lds
s_lshl_b32 s18,s26,5
v_mfma_f32_16x16x32_bf16 v[180:183],v[48:51],a[212:215],v[180:183]
s_add_u32 s18,s18,s68
s_lshl_b32 s19,s18,10
s_add_u32 s20,s19,4194304
v_mfma_f32_16x16x32_bf16 v[184:187],v[48:51],a[216:219],v[184:187]
s_waitcnt lgkmcnt(0)
v_cvt_pk_bf16_f32 v104,v96,v97
v_cvt_pk_bf16_f32 v105,v98,v99
v_mfma_f32_16x16x32_bf16 v[188:191],v[48:51],a[220:223],v[188:191]
v_cvt_pk_bf16_f32 v106,v100,v101
v_cvt_pk_bf16_f32 v107,v102,v103
v_lshlrev_b32 v96,16,v104
v_mfma_f32_16x16x32_bf16 v[160:163],v[52:55],a[224:227],v[160:163]
buffer_load_dwordx4 v0,s[8:11],s65 offen offset:2048 sc1 lds
v_and_b32 v97,0xffff0000,v104
v_mfma_f32_16x16x32_bf16 v[164:167],v[52:55],a[228:231],v[164:167]
v_lshlrev_b32 v98,16,v105
v_and_b32 v99,0xffff0000,v105
v_lshlrev_b32 v100,16,v106
v_mfma_f32_16x16x32_bf16 v[168:171],v[52:55],a[232:235],v[168:171]
v_and_b32 v101,0xffff0000,v106
v_lshlrev_b32 v102,16,v107
v_and_b32 v103,0xffff0000,v107
v_mfma_f32_16x16x32_bf16 v[172:175],v[52:55],a[236:239],v[172:175]
v_pk_add_f32 v[88:89],v[88:89],v[96:97]
v_pk_add_f32 v[90:91],v[90:91],v[98:99]
v_pk_add_f32 v[92:93],v[92:93],v[100:101]
v_mfma_f32_16x16x32_bf16 v[176:179],v[52:55],a[240:243],v[176:179]
buffer_load_dwordx4 v0,s[8:11],s65 offen offset:3072 sc1 lds
v_pk_add_f32 v[94:95],v[94:95],v[102:103]
v_mfma_f32_16x16x32_bf16 v[180:183],v[52:55],a[244:247],v[180:183]
v_cvt_pk_bf16_f32 v104,v88,v89
v_cvt_pk_bf16_f32 v105,v90,v91
v_cvt_pk_bf16_f32 v106,v92,v93
v_mfma_f32_16x16x32_bf16 v[184:187],v[52:55],a[248:251],v[184:187]
v_cvt_pk_bf16_f32 v107,v94,v95
buffer_store_dwordx4 v[104:107],v0,s[8:11],s20 offen sc1
v_mfma_f32_16x16x32_bf16 v[188:191],v[52:55],a[252:255],v[188:191]
v_lshlrev_b32 v88,16,v104
v_and_b32 v89,0xffff0000,v104
v_lshlrev_b32 v90,16,v105
s_waitcnt lgkmcnt(10)
v_mfma_f32_16x16x32_bf16 v[192:195],v[56:59],a[0:3],0
v_and_b32 v91,0xffff0000,v105
v_lshlrev_b32 v92,16,v106
v_and_b32 v93,0xffff0000,v106
v_mfma_f32_16x16x32_bf16 v[196:199],v[56:59],a[4:7],0
v_lshlrev_b32 v94,16,v107
v_and_b32 v95,0xffff0000,v107
v_readfirstlane_b32 s78,v88
v_mfma_f32_16x16x32_bf16 v[200:203],v[56:59],a[8:11],0
v_cvt_pk_bf16_f32 v24,v160,v164
v_cvt_pk_bf16_f32 v25,v168,v172
v_cvt_pk_bf16_f32 v26,v176,v180
v_mfma_f32_16x16x32_bf16 v[204:207],v[56:59],a[12:15],0
v_cvt_pk_bf16_f32 v27,v184,v188
s_add_u32 s62,s69,0
buffer_store_dwordx4 v[24:27],v5,s[8:11],s62 offen
v_mfma_f32_16x16x32_bf16 v[208:211],v[56:59],a[16:19],0
v_cvt_pk_bf16_f32 v28,v161,v165
v_cvt_pk_bf16_f32 v29,v169,v173
v_cvt_pk_bf16_f32 v30,v177,v181
v_mfma_f32_16x16x32_bf16 v[212:215],v[56:59],a[20:23],0
v_cvt_pk_bf16_f32 v31,v185,v189
s_add_u32 s62,s69,16384
buffer_store_dwordx4 v[28:31],v5,s[8:11],s62 offen
v_mfma_f32_16x16x32_bf16 v[216:219],v[56:59],a[24:27],0
v_cvt_pk_bf16_f32 v32,v162,v166
v_cvt_pk_bf16_f32 v33,v170,v174
v_cvt_pk_bf16_f32 v34,v178,v182
v_mfma_f32_16x16x32_bf16 v[220:223],v[56:59],a[28:31],0
v_cvt_pk_bf16_f32 v35,v186,v190
s_add_u32 s62,s69,32768
buffer_store_dwordx4 v[32:35],v5,s[8:11],s62 offen
s_waitcnt lgkmcnt(9)
v_mfma_f32_16x16x32_bf16 v[192:195],v[60:63],a[32:35],v[192:195]
v_cvt_pk_bf16_f32 v36,v163,v167
v_cvt_pk_bf16_f32 v37,v171,v175
v_cvt_pk_bf16_f32 v38,v179,v183
v_mfma_f32_16x16x32_bf16 v[196:199],v[60:63],a[36:39],v[196:199]
v_cvt_pk_bf16_f32 v39,v187,v191
s_add_u32 s62,s69,49152
buffer_store_dwordx4 v[36:39],v5,s[8:11],s62 offen
v_mfma_f32_16x16x32_bf16 v[200:203],v[60:63],a[40:43],v[200:203]
v_pk_add_f32 v[120:121],v[88:89],s[78:79] op_sel_hi:[1,0] neg_lo:[0,1] neg_hi:[0,1]
v_pk_add_f32 v[122:123],v[90:91],s[78:79] op_sel_hi:[1,0] neg_lo:[0,1] neg_hi:[0,1]
v_pk_add_f32 v[124:125],v[92:93],s[78:79] op_sel_hi:[1,0] neg_lo:[0,1] neg_hi:[0,1]
v_mfma_f32_16x16x32_bf16 v[204:207],v[60:63],a[44:47],v[204:207]
v_pk_add_f32 v[126:127],v[94:95],s[78:79] op_sel_hi:[1,0] neg_lo:[0,1] neg_hi:[0,1]
v_pk_add_f32 v[128:129],v[120:121],v[122:123]
v_pk_mul_f32 v[130:131],v[120:121],v[120:121]
v_mfma_f32_16x16x32_bf16 v[208:211],v[60:63],a[48:51],v[208:211]
v_pk_add_f32 v[132:133],v[124:125],v[126:127]
v_pk_fma_f32 v[130:131],v[122:123],v[122:123],v[130:131]
v_pk_add_f32 v[128:129],v[128:129],v[132:133]
v_mfma_f32_16x16x32_bf16 v[212:215],v[60:63],a[52:55],v[212:215]
v_pk_fma_f32 v[130:131],v[124:125],v[124:125],v[130:131]
v_add_f32 v128,v128,v129
v_pk_fma_f32 v[130:131],v[126:127],v[126:127],v[130:131]
v_mfma_f32_16x16x32_bf16 v[216:219],v[60:63],a[56:59],v[216:219]
v_add_f32 v130,v130,v131
s_nop 1
v_permlane32_swap_b32 v128,v130
v_add_f32 v128,v128,v130
v_mfma_f32_16x16x32_bf16 v[220:223],v[60:63],a[60:63],v[220:223]
s_nop 0
v_add_f32_dpp v128,v128,v128 row_ror:8 row_mask:0xf bank_mask:0xf
s_nop 1
v_add_f32_dpp v128,v128,v128 row_ror:4 row_mask:0xf bank_mask:0xf
s_nop 1
v_add_f32_dpp v128,v128,v128 row_ror:2 row_mask:0xf bank_mask:0xf
s_waitcnt lgkmcnt(8)
v_mfma_f32_16x16x32_bf16 v[192:195],v[64:67],a[64:67],v[192:195]
v_add_f32_dpp v128,v128,v128 row_ror:1 row_mask:0xf bank_mask:0xf
v_mov_b32 v130,v128
s_nop 1
v_permlane16_swap_b32 v128,v130
v_mfma_f32_16x16x32_bf16 v[196:199],v[64:67],a[68:71],v[196:199]
v_add_f32 v128,v128,v130
v_mul_f32 v128,0x3b000000,v128
v_mov_b32 v130,v128
v_mfma_f32_16x16x32_bf16 v[200:203],v[64:67],a[72:75],v[200:203]
s_nop 0
v_permlane32_swap_b32 v128,v130
v_fma_f32 v130,-v128,v128,v130
v_add_f32 v128,s78,v128
v_mfma_f32_16x16x32_bf16 v[204:207],v[64:67],a[76:79],v[204:207]
v_max_f32 v130,0,v130
v_cvt_pk_bf16_f32 v130,v128,v130
v_lshlrev_b32 v128,16,v130
v_mfma_f32_16x16x32_bf16 v[208:211],v[64:67],a[80:83],v[208:211]
v_and_b32 v130,0xffff0000,v130
v_add_f32 v130,0x3727c5ac,v130
v_mfma_f32_16x16x32_bf16 v[212:215],v[64:67],a[84:87],v[212:215]
v_cvt_pk_bf16_f32 v130,v130,v130
v_and_b32 v130,0xffff0000,v130
v_mfma_f32_16x16x32_bf16 v[216:219],v[64:67],a[88:91],v[216:219]
v_sqrt_f32 v130,v130
v_pk_add_f32 v[120:121],v[88:89],v[128:129] op_sel_hi:[1,0] neg_lo:[0,1] neg_hi:[0,1]
v_mfma_f32_16x16x32_bf16 v[220:223],v[64:67],a[92:95],v[220:223]
v_pk_add_f32 v[122:123],v[90:91],v[128:129] op_sel_hi:[1,0] neg_lo:[0,1] neg_hi:[0,1]
v_pk_add_f32 v[124:125],v[92:93],v[128:129] op_sel_hi:[1,0] neg_lo:[0,1] neg_hi:[0,1]
s_waitcnt lgkmcnt(7)
v_mfma_f32_16x16x32_bf16 v[192:195],v[68:71],a[96:99],v[192:195]
v_pk_add_f32 v[126:127],v[94:95],v[128:129] op_sel_hi:[1,0] neg_lo:[0,1] neg_hi:[0,1]
v_cvt_pk_bf16_f32 v130,v130,v130
v_mfma_f32_16x16x32_bf16 v[196:199],v[68:71],a[100:103],v[196:199]
v_and_b32 v130,0xffff0000,v130
v_rcp_f32 v130,v130
v_mfma_f32_16x16x32_bf16 v[200:203],v[68:71],a[104:107],v[200:203]
v_cvt_pk_bf16_f32 v108,v120,v121
v_cvt_pk_bf16_f32 v109,v122,v123
v_mfma_f32_16x16x32_bf16 v[204:207],v[68:71],a[108:111],v[204:207]
v_cvt_pk_bf16_f32 v110,v124,v125
v_cvt_pk_bf16_f32 v111,v126,v127
v_mfma_f32_16x16x32_bf16 v[208:211],v[68:71],a[112:115],v[208:211]
v_lshlrev_b32 v120,16,v108
v_and_b32 v121,0xffff0000,v108
v_mfma_f32_16x16x32_bf16 v[212:215],v[68:71],a[116:119],v[212:215]
v_lshlrev_b32 v122,16,v109
v_and_b32 v123,0xffff0000,v109
v_mfma_f32_16x16x32_bf16 v[216:219],v[68:71],a[120:123],v[216:219]
v_lshlrev_b32 v124,16,v110
v_and_b32 v125,0xffff0000,v110
v_mfma_f32_16x16x32_bf16 v[220:223],v[68:71],a[124:127],v[220:223]
v_lshlrev_b32 v126,16,v111
v_and_b32 v127,0xffff0000,v111
s_waitcnt lgkmcnt(6)
v_mfma_f32_16x16x32_bf16 v[192:195],v[72:75],a[128:131],v[192:195]
v_pk_mul_f32 v[120:121],v[120:121],v[130:131] op_sel_hi:[1,0]
v_pk_mul_f32 v[122:123],v[122:123],v[130:131] op_sel_hi:[1,0]
v_mfma_f32_16x16x32_bf16 v[196:199],v[72:75],a[132:135],v[196:199]
v_pk_mul_f32 v[124:125],v[124:125],v[130:131] op_sel_hi:[1,0]
v_pk_mul_f32 v[126:127],v[126:127],v[130:131] op_sel_hi:[1,0]
v_mfma_f32_16x16x32_bf16 v[200:203],v[72:75],a[136:139],v[200:203]
v_cvt_pk_bf16_f32 v108,v120,v121
v_cvt_pk_bf16_f32 v109,v122,v123
v_mfma_f32_16x16x32_bf16 v[204:207],v[72:75],a[140:143],v[204:207]
v_cvt_pk_bf16_f32 v110,v124,v125
v_cvt_pk_bf16_f32 v111,v126,v127
v_mfma_f32_16x16x32_bf16 v[208:211],v[72:75],a[144:147],v[208:211]
v_lshlrev_b32 v112,16,v108
v_and_b32 v113,0xffff0000,v108
v_mfma_f32_16x16x32_bf16 v[212:215],v[72:75],a[148:151],v[212:215]
v_lshlrev_b32 v114,16,v109
v_and_b32 v115,0xffff0000,v109
v_mfma_f32_16x16x32_bf16 v[216:219],v[72:75],a[152:155],v[216:219]
v_lshlrev_b32 v116,16,v110
v_and_b32 v117,0xffff0000,v110
v_mfma_f32_16x16x32_bf16 v[220:223],v[72:75],a[156:159],v[220:223]
v_lshlrev_b32 v118,16,v111
v_and_b32 v119,0xffff0000,v111
s_waitcnt lgkmcnt(5)
v_mfma_f32_16x16x32_bf16 v[192:195],v[76:79],a[160:163],v[192:195]
v_pk_mul_f32 v[236:237],v[112:113],v[228:229]
v_pk_fma_f32 v[236:237],v[114:115],v[230:231],v[236:237]
v_mfma_f32_16x16x32_bf16 v[196:199],v[76:79],a[164:167],v[196:199]
v_pk_fma_f32 v[236:237],v[116:117],v[232:233],v[236:237]
v_pk_fma_f32 v[236:237],v[118:119],v[234:235],v[236:237]
v_mfma_f32_16x16x32_bf16 v[200:203],v[76:79],a[168:171],v[200:203]
v_add_f32 v236,v236,v237
s_nop 1
v_add_f32_dpp v236,v236,v236 row_ror:8 row_mask:0xf bank_mask:0xf
v_mfma_f32_16x16x32_bf16 v[204:207],v[76:79],a[172:175],v[204:207]
s_nop 0
v_add_f32_dpp v236,v236,v236 row_ror:4 row_mask:0xf bank_mask:0xf
s_nop 1
v_add_f32_dpp v236,v236,v236 row_ror:2 row_mask:0xf bank_mask:0xf
v_mfma_f32_16x16x32_bf16 v[208:211],v[76:79],a[176:179],v[208:211]
s_nop 0
v_add_f32_dpp v236,v236,v236 row_ror:1 row_mask:0xf bank_mask:0xf
v_mov_b32 v237,v236
v_mfma_f32_16x16x32_bf16 v[212:215],v[76:79],a[180:183],v[212:215]
s_nop 0
v_permlane16_swap_b32 v236,v237
v_add_f32 v236,v236,v237
v_mfma_f32_16x16x32_bf16 v[216:219],v[76:79],a[184:187],v[216:219]
v_mov_b32 v237,v236
s_nop 1
v_permlane32_swap_b32 v236,v237
v_mfma_f32_16x16x32_bf16 v[220:223],v[76:79],a[188:191],v[220:223]
v_add_f32 v236,v236,v237
v_cvt_pk_bf16_f32 v236,v236,v236
s_waitcnt lgkmcnt(4)
v_mfma_f32_16x16x32_bf16 v[192:195],v[80:83],a[192:195],v[192:195]
v_and_b32 v236,0xffff0000,v236
v_ashrrev_i32 v237,31,v236
v_mfma_f32_16x16x32_bf16 v[196:199],v[80:83],a[196:199],v[196:199]
v_or_b32 v237,0x80000000,v237
v_xor_b32 v236,v236,v237
v_mfma_f32_16x16x32_bf16 v[200:203],v[80:83],a[200:203],v[200:203]
v_and_b32 v236,0xffff0000,v236
s_sub_u32 s20,4095,s18
v_mfma_f32_16x16x32_bf16 v[204:207],v[80:83],a[204:207],v[204:207]
v_or_b32 v20,s20,v236
s_lshl_b32 s20,s26,13
v_mfma_f32_16x16x32_bf16 v[208:211],v[80:83],a[208:211],v[208:211]
s_lshl2_add_u32 s20,s68,s20
s_add_u32 s20,s20,10487168
v_mfma_f32_16x16x32_bf16 v[212:215],v[80:83],a[212:215],v[212:215]
buffer_store_dword v20,off,s[8:11],s20 sc1
v_mfma_f32_16x16x32_bf16 v[216:219],v[80:83],a[216:219],v[216:219]
v_mfma_f32_16x16x32_bf16 v[220:223],v[80:83],a[220:223],v[220:223]
s_waitcnt lgkmcnt(3)
v_mfma_f32_16x16x32_bf16 v[192:195],v[84:87],a[224:227],v[192:195]
v_mfma_f32_16x16x32_bf16 v[196:199],v[84:87],a[228:231],v[196:199]
v_mfma_f32_16x16x32_bf16 v[200:203],v[84:87],a[232:235],v[200:203]
v_mfma_f32_16x16x32_bf16 v[204:207],v[84:87],a[236:239],v[204:207]
v_mfma_f32_16x16x32_bf16 v[208:211],v[84:87],a[240:243],v[208:211]
v_mfma_f32_16x16x32_bf16 v[212:215],v[84:87],a[244:247],v[212:215]
v_mfma_f32_16x16x32_bf16 v[216:219],v[84:87],a[248:251],v[216:219]
v_mfma_f32_16x16x32_bf16 v[220:223],v[84:87],a[252:255],v[220:223]
v_cvt_pk_bf16_f32 v40,v192,v196
v_cvt_pk_bf16_f32 v41,v200,v204
v_cvt_pk_bf16_f32 v42,v208,v212
s_nop 4
v_cvt_pk_bf16_f32 v43,v216,v220
s_add_u32 s62,s69,262144
buffer_store_dwordx4 v[40:43],v5,s[8:11],s62 offen
v_cvt_pk_bf16_f32 v44,v193,v197
v_cvt_pk_bf16_f32 v45,v201,v205
v_cvt_pk_bf16_f32 v46,v209,v213
v_cvt_pk_bf16_f32 v47,v217,v221
s_add_u32 s62,s69,278528
buffer_store_dwordx4 v[44:47],v5,s[8:11],s62 offen
v_cvt_pk_bf16_f32 v48,v194,v198
v_cvt_pk_bf16_f32 v49,v202,v206
v_cvt_pk_bf16_f32 v50,v210,v214
v_cvt_pk_bf16_f32 v51,v218,v222
s_add_u32 s62,s69,294912
buffer_store_dwordx4 v[48:51],v5,s[8:11],s62 offen
v_cvt_pk_bf16_f32 v52,v195,v199
v_cvt_pk_bf16_f32 v53,v203,v207
v_cvt_pk_bf16_f32 v54,v211,v215
v_cvt_pk_bf16_f32 v55,v219,v223
s_add_u32 s62,s69,311296
buffer_store_dwordx4 v[52:55],v5,s[8:11],s62 offen
s_cmp_lg_u32 s72,0
s_cbranch_scc1 L_aa_40
s_waitcnt vmcnt(10)
s_branch L_aa_50
L_av_54:
s_bitcmp1_b32 s46,0
s_cbranch_scc1 L_av_55
ds_read_b128 v[24:27],v4 offset:0
ds_read_b128 v[28:31],v4 offset:1024
ds_read_b128 v[32:35],v4 offset:2048
ds_read_b128 v[36:39],v4 offset:3072
ds_read_b128 v[40:43],v4 offset:8192
ds_read_b128 v[44:47],v4 offset:9216
ds_read_b128 v[48:51],v4 offset:10240
ds_read_b128 v[52:55],v4 offset:11264
s_min_u32 s56,s32,s33
s_cmp_lt_u32 s77,64
s_cselect_b32 s56,s56,0
s_cmp_eq_u32 s56,0
s_cselect_b32 s72,0x80000000,0
v_mov_b32 v248,s72
s_or_b32 s64,s70,s72
s_or_b32 s65,s71,s72
ds_write_b32 v247,v248
s_and_b32 s57,s46,1
s_mul_i32 s58,s57,12288
s_add_u32 s64,s64,s58
s_lshl_b32 s57,s57,12
s_add_u32 s65,s65,s57
s_and_b32 s59,s50,2048
s_lshl_b32 s59,s59,4
s_xor_b32 s60,s67,65536
s_add_u32 s59,s59,s60
s_add_u32 s58,s58,s59
s_add_u32 s57,s57,s59
s_add_u32 m0,s58,0
s_waitcnt lgkmcnt(8)
v_mfma_f32_16x16x32_bf16 v[160:163],v[24:27],a[0:3],0
buffer_load_dwordx4 v0,s[8:11],s64 offen offset:0 sc1 lds
v_mfma_f32_16x16x32_bf16 v[164:167],v[24:27],a[4:7],0
v_mfma_f32_16x16x32_bf16 v[168:171],v[24:27],a[8:11],0
v_mfma_f32_16x16x32_bf16 v[172:175],v[24:27],a[12:15],0
v_mfma_f32_16x16x32_bf16 v[176:179],v[24:27],a[16:19],0
buffer_load_dwordx4 v0,s[8:11],s64 offen offset:1024 sc1 lds
v_mfma_f32_16x16x32_bf16 v[180:183],v[24:27],a[20:23],0
v_mfma_f32_16x16x32_bf16 v[184:187],v[24:27],a[24:27],0
s_waitcnt vmcnt(9)
v_mfma_f32_16x16x32_bf16 v[128:131],v[156:159],v[192:195],0
v_mfma_f32_16x16x32_bf16 v[188:191],v[24:27],a[28:31],0
s_waitcnt lgkmcnt(7)
v_mfma_f32_16x16x32_bf16 v[160:163],v[28:31],a[32:35],v[160:163]
buffer_load_dwordx4 v0,s[8:11],s64 offen offset:2048 sc1 lds
s_waitcnt vmcnt(9)
v_mfma_f32_16x16x32_bf16 v[164:167],v[28:31],a[36:39],v[164:167]
v_mfma_f32_16x16x32_bf16 v[128:131],v[156:159],v[196:199],v[128:131]
v_mfma_f32_16x16x32_bf16 v[168:171],v[28:31],a[40:43],v[168:171]
s_waitcnt vmcnt(8)
v_mfma_f32_16x16x32_bf16 v[128:131],v[156:159],v[200:203],v[128:131]
v_mfma_f32_16x16x32_bf16 v[172:175],v[28:31],a[44:47],v[172:175]
v_mfma_f32_16x16x32_bf16 v[176:179],v[28:31],a[48:51],v[176:179]
buffer_load_dwordx4 v0,s[8:11],s64 offen offset:3072 sc1 lds
s_waitcnt vmcnt(8)
v_mfma_f32_16x16x32_bf16 v[180:183],v[28:31],a[52:55],v[180:183]
v_mfma_f32_16x16x32_bf16 v[128:131],v[156:159],v[204:207],v[128:131]
v_mfma_f32_16x16x32_bf16 v[184:187],v[28:31],a[56:59],v[184:187]
s_waitcnt vmcnt(7)
v_mfma_f32_16x16x32_bf16 v[132:135],v[156:159],v[208:211],0
v_mfma_f32_16x16x32_bf16 v[188:191],v[28:31],a[60:63],v[188:191]
s_waitcnt lgkmcnt(6)
v_mfma_f32_16x16x32_bf16 v[160:163],v[32:35],a[64:67],v[160:163]
s_add_u32 m0,s58,4096
s_add_u32 s64,s64,4096
buffer_load_dwordx4 v0,s[8:11],s64 offen offset:0 sc1 lds
v_mfma_f32_16x16x32_bf16 v[164:167],v[32:35],a[68:71],v[164:167]
s_waitcnt vmcnt(7)
v_mfma_f32_16x16x32_bf16 v[132:135],v[156:159],v[212:215],v[132:135]
v_mfma_f32_16x16x32_bf16 v[168:171],v[32:35],a[72:75],v[168:171]
v_mfma_f32_16x16x32_bf16 v[172:175],v[32:35],a[76:79],v[172:175]
s_waitcnt vmcnt(6)
v_mfma_f32_16x16x32_bf16 v[132:135],v[156:159],v[216:219],v[132:135]
v_mfma_f32_16x16x32_bf16 v[176:179],v[32:35],a[80:83],v[176:179]
buffer_load_dwordx4 v0,s[8:11],s64 offen offset:1024 sc1 lds
v_mfma_f32_16x16x32_bf16 v[180:183],v[32:35],a[84:87],v[180:183]
ds_write_b128 v6,v[128:131]
s_waitcnt vmcnt(6)
v_mfma_f32_16x16x32_bf16 v[184:187],v[32:35],a[88:91],v[184:187]
v_mfma_f32_16x16x32_bf16 v[132:135],v[156:159],v[220:223],v[132:135]
v_mfma_f32_16x16x32_bf16 v[188:191],v[32:35],a[92:95],v[188:191]
s_waitcnt lgkmcnt(2)
v_mfma_f32_16x16x32_bf16 v[160:163],v[36:39],a[96:99],v[160:163]
buffer_load_dwordx4 v0,s[8:11],s64 offen offset:2048 sc1 lds
v_mfma_f32_16x16x32_bf16 v[164:167],v[36:39],a[100:103],v[164:167]
ds_write_b128 v6,v[132:135] offset:2048
v_mfma_f32_16x16x32_bf16 v[168:171],v[36:39],a[104:107],v[168:171]
v_mfma_f32_16x16x32_bf16 v[172:175],v[36:39],a[108:111],v[172:175]
v_mfma_f32_16x16x32_bf16 v[176:179],v[36:39],a[112:115],v[176:179]
buffer_load_dwordx4 v0,s[8:11],s64 offen offset:3072 sc1 lds
v_mfma_f32_16x16x32_bf16 v[180:183],v[36:39],a[116:119],v[180:183]
s_waitcnt lgkmcnt(0)
s_barrier
ds_read_b128 v[56:59],v4 offset:4096
v_mfma_f32_16x16x32_bf16 v[184:187],v[36:39],a[120:123],v[184:187]
ds_read_b128 v[60:63],v4 offset:5120
ds_read_b128 v[64:67],v4 offset:6144
v_mfma_f32_16x16x32_bf16 v[188:191],v[36:39],a[124:127],v[188:191]
ds_read_b128 v[68:71],v4 offset:7168
ds_read_b128 v[72:75],v4 offset:12288
v_mfma_f32_16x16x32_bf16 v[160:163],v[40:43],a[128:131],v[160:163]
s_add_u32 m0,s58,8192
s_add_u32 s64,s64,4096
buffer_load_dwordx4 v0,s[8:11],s64 offen offset:0 sc1 lds
v_mfma_f32_16x16x32_bf16 v[164:167],v[40:43],a[132:135],v[164:167]
ds_read_b128 v[76:79],v4 offset:13312
ds_read_b128 v[80:83],v4 offset:14336
v_mfma_f32_16x16x32_bf16 v[168:171],v[40:43],a[136:139],v[168:171]
ds_read_b128 v[84:87],v4 offset:15360
ds_read_b128 v[248:251],v245
v_mfma_f32_16x16x32_bf16 v[172:175],v[40:43],a[140:143],v[172:175]
ds_read_b128 v[96:99],v23
ds_read_b128 v[100:103],v23 offset:16
v_mfma_f32_16x16x32_bf16 v[176:179],v[40:43],a[144:147],v[176:179]
buffer_load_dwordx4 v0,s[8:11],s64 offen offset:1024 sc1 lds
v_lshlrev_b32 v88,16,v224
v_mfma_f32_16x16x32_bf16 v[180:183],v[40:43],a[148:151],v[180:183]
v_and_b32 v89,0xffff0000,v224
v_lshlrev_b32 v90,16,v225
v_and_b32 v91,0xffff0000,v225
v_mfma_f32_16x16x32_bf16 v[184:187],v[40:43],a[152:155],v[184:187]
v_lshlrev_b32 v92,16,v226
v_and_b32 v93,0xffff0000,v226
v_lshlrev_b32 v94,16,v227
v_mfma_f32_16x16x32_bf16 v[188:191],v[40:43],a[156:159],v[188:191]
v_and_b32 v95,0xffff0000,v227
v_readfirstlane_b32 s22,v246
s_cmp_eq_u32 s22,0
s_cbranch_scc1 L_ag_56
L_agb_57:
v_mfma_f32_16x16x32_bf16 v[160:163],v[44:47],a[160:163],v[160:163]
buffer_load_dwordx4 v0,s[8:11],s64 offen offset:2048 sc1 lds
s_lshl_b32 s23,s51,5
v_mfma_f32_16x16x32_bf16 v[164:167],v[44:47],a[164:167],v[164:167]
s_waitcnt lgkmcnt(0)
v_or3_b32 v248,v248,v249,v250
v_or_b32 v248,v248,v251
v_mfma_f32_16x16x32_bf16 v[168:171],v[44:47],a[168:171],v[168:171]
s_add_u32 s23,s23,s68
s_lshl_b32 s24,s23,10
s_lshl_b32 s25,s51,10
v_mfma_f32_16x16x32_bf16 v[172:175],v[44:47],a[172:175],v[172:175]
v_readfirstlane_b32 s72,v248
s_add_u32 s25,s25,2883584
s_cmp_eq_u32 s23,s55
s_cselect_b32 s25,s25,s24
v_mfma_f32_16x16x32_bf16 v[176:179],v[44:47],a[176:179],v[176:179]
buffer_load_dwordx4 v0,s[8:11],s64 offen offset:3072 sc1 lds
s_add_u32 s25,s25,8388608
v_mfma_f32_16x16x32_bf16 v[180:183],v[44:47],a[180:183],v[180:183]
s_mov_b32 s6,268435456
s_cmp_eq_u32 s31,0
s_cselect_b32 s25,s24,s25
s_cselect_b64 s[4:5],s[16:17],s[44:45]
s_cmov_b32 s6,2097152
v_mfma_f32_16x16x32_bf16 v[184:187],v[44:47],a[184:187],v[184:187]
buffer_load_dwordx4 v[224:227],v0,s[4:7],s25 offen sc1
s_cmp_lt_u32 s51,55
s_cselect_b32 s24,s86,1536
v_mfma_f32_16x16x32_bf16 v[188:191],v[44:47],a[188:191],v[188:191]
s_cmp_eq_u32 s24,768
s_cselect_b32 s24,128,0
s_lshl_b32 s23,s51,13
v_mfma_f32_16x16x32_bf16 v[160:163],v[48:51],a[192:195],v[160:163]
s_add_u32 m0,s57,24576
s_nop 0
buffer_load_dwordx4 v0,s[8:11],s65 offen offset:0 sc1 lds
v_mfma_f32_16x16x32_bf16 v[164:167],v[48:51],a[196:199],v[164:167]
s_lshl2_add_u32 s23,s68,s23
s_add_u32 s23,s23,10487168
s_add_u32 s23,s23,s24
v_mfma_f32_16x16x32_bf16 v[168:171],v[48:51],a[200:203],v[168:171]
buffer_load_dword v246,off,s[8:11],s23 sc1
v_lshrrev_b32 v244,4,v1
v_mfma_f32_16x16x32_bf16 v[172:175],v[48:51],a[204:207],v[172:175]
s_sub_u32 s23,s77,8
v_add_u32 v244,s23,v244
v_max_i32 v244,0,v244
v_mfma_f32_16x16x32_bf16 v[176:179],v[48:51],a[208:211],v[176:179]
buffer_load_dwordx4 v0,s[8:11],s65 offen offset:1024 sc1 lds
v_lshl_add_u32 v244,v244,13,v21
v_mfma_f32_16x16x32_bf16 v[180:183],v[48:51],a[212:215],v[180:183]
buffer_load_dwordx2 v[242:243],v244,s[8:11],0 offen sc1
s_lshl_b32 s18,s26,5
v_mfma_f32_16x16x32_bf16 v[184:187],v[48:51],a[216:219],v[184:187]
s_add_u32 s18,s18,s68
s_lshl_b32 s19,s18,10
s_add_u32 s20,s19,6291456
v_mfma_f32_16x16x32_bf16 v[188:191],v[48:51],a[220:223],v[188:191]
s_waitcnt lgkmcnt(0)
v_cvt_pk_bf16_f32 v104,v96,v97
v_cvt_pk_bf16_f32 v105,v98,v99
v_mfma_f32_16x16x32_bf16 v[160:163],v[52:55],a[224:227],v[160:163]
buffer_load_dwordx4 v0,s[8:11],s65 offen offset:2048 sc1 lds
v_cvt_pk_bf16_f32 v106,v100,v101
v_mfma_f32_16x16x32_bf16 v[164:167],v[52:55],a[228:231],v[164:167]
v_cvt_pk_bf16_f32 v107,v102,v103
v_lshlrev_b32 v96,16,v104
v_and_b32 v97,0xffff0000,v104
v_mfma_f32_16x16x32_bf16 v[168:171],v[52:55],a[232:235],v[168:171]
v_lshlrev_b32 v98,16,v105
v_and_b32 v99,0xffff0000,v105
v_lshlrev_b32 v100,16,v106
v_mfma_f32_16x16x32_bf16 v[172:175],v[52:55],a[236:239],v[172:175]
v_and_b32 v101,0xffff0000,v106
v_lshlrev_b32 v102,16,v107
v_and_b32 v103,0xffff0000,v107
v_mfma_f32_16x16x32_bf16 v[176:179],v[52:55],a[240:243],v[176:179]
buffer_load_dwordx4 v0,s[8:11],s65 offen offset:3072 sc1 lds
v_pk_add_f32 v[88:89],v[88:89],v[96:97]
v_mfma_f32_16x16x32_bf16 v[180:183],v[52:55],a[244:247],v[180:183]
v_pk_add_f32 v[90:91],v[90:91],v[98:99]
v_pk_add_f32 v[92:93],v[92:93],v[100:101]
v_pk_add_f32 v[94:95],v[94:95],v[102:103]
v_mfma_f32_16x16x32_bf16 v[184:187],v[52:55],a[248:251],v[184:187]
v_cvt_pk_bf16_f32 v104,v88,v89
v_cvt_pk_bf16_f32 v105,v90,v91
v_cvt_pk_bf16_f32 v106,v92,v93
v_mfma_f32_16x16x32_bf16 v[188:191],v[52:55],a[252:255],v[188:191]
v_cvt_pk_bf16_f32 v107,v94,v95
buffer_store_dwordx4 v[104:107],v0,s[8:11],s20 offen sc1
s_waitcnt lgkmcnt(10)
v_mfma_f32_16x16x32_bf16 v[192:195],v[56:59],a[0:3],0
v_lshlrev_b32 v88,16,v104
v_and_b32 v89,0xffff0000,v104
v_lshlrev_b32 v90,16,v105
v_mfma_f32_16x16x32_bf16 v[196:199],v[56:59],a[4:7],0
v_and_b32 v91,0xffff0000,v105
v_lshlrev_b32 v92,16,v106
v_and_b32 v93,0xffff0000,v106
v_mfma_f32_16x16x32_bf16 v[200:203],v[56:59],a[8:11],0
v_cvt_pk_bf16_f32 v24,v160,v164
v_cvt_pk_bf16_f32 v25,v168,v172
v_cvt_pk_bf16_f32 v26,v176,v180
v_mfma_f32_16x16x32_bf16 v[204:207],v[56:59],a[12:15],0
v_cvt_pk_bf16_f32 v27,v184,v188
s_add_u32 s62,s69,0
buffer_store_dwordx4 v[24:27],v5,s[8:11],s62 offen
v_mfma_f32_16x16x32_bf16 v[208:211],v[56:59],a[16:19],0
v_cvt_pk_bf16_f32 v28,v161,v165
v_cvt_pk_bf16_f32 v29,v169,v173
v_cvt_pk_bf16_f32 v30,v177,v181
v_mfma_f32_16x16x32_bf16 v[212:215],v[56:59],a[20:23],0
v_cvt_pk_bf16_f32 v31,v185,v189
s_add_u32 s62,s69,16384
buffer_store_dwordx4 v[28:31],v5,s[8:11],s62 offen
v_mfma_f32_16x16x32_bf16 v[216:219],v[56:59],a[24:27],0
v_cvt_pk_bf16_f32 v32,v162,v166
v_cvt_pk_bf16_f32 v33,v170,v174
v_cvt_pk_bf16_f32 v34,v178,v182
v_mfma_f32_16x16x32_bf16 v[220:223],v[56:59],a[28:31],0
v_cvt_pk_bf16_f32 v35,v186,v190
s_add_u32 s62,s69,32768
buffer_store_dwordx4 v[32:35],v5,s[8:11],s62 offen
s_waitcnt lgkmcnt(9)
v_mfma_f32_16x16x32_bf16 v[192:195],v[60:63],a[32:35],v[192:195]
v_cvt_pk_bf16_f32 v36,v163,v167
v_cvt_pk_bf16_f32 v37,v171,v175
v_cvt_pk_bf16_f32 v38,v179,v183
v_mfma_f32_16x16x32_bf16 v[196:199],v[60:63],a[36:39],v[196:199]
v_cvt_pk_bf16_f32 v39,v187,v191
s_add_u32 s62,s69,49152
buffer_store_dwordx4 v[36:39],v5,s[8:11],s62 offen
v_mfma_f32_16x16x32_bf16 v[200:203],v[60:63],a[40:43],v[200:203]
v_lshlrev_b32 v94,16,v107
v_and_b32 v95,0xffff0000,v107
v_readfirstlane_b32 s78,v88
v_mfma_f32_16x16x32_bf16 v[204:207],v[60:63],a[44:47],v[204:207]
s_nop 0
v_pk_add_f32 v[120:121],v[88:89],s[78:79] op_sel_hi:[1,0] neg_lo:[0,1] neg_hi:[0,1]
v_pk_add_f32 v[122:123],v[90:91],s[78:79] op_sel_hi:[1,0] neg_lo:[0,1] neg_hi:[0,1]
v_pk_add_f32 v[124:125],v[92:93],s[78:79] op_sel_hi:[1,0] neg_lo:[0,1] neg_hi:[0,1]
v_mfma_f32_16x16x32_bf16 v[208:211],v[60:63],a[48:51],v[208:211]
v_pk_add_f32 v[126:127],v[94:95],s[78:79] op_sel_hi:[1,0] neg_lo:[0,1] neg_hi:[0,1]
v_pk_add_f32 v[128:129],v[120:121],v[122:123]
v_pk_mul_f32 v[130:131],v[120:121],v[120:121]
v_mfma_f32_16x16x32_bf16 v[212:215],v[60:63],a[52:55],v[212:215]
v_pk_add_f32 v[132:133],v[124:125],v[126:127]
v_pk_fma_f32 v[130:131],v[122:123],v[122:123],v[130:131]
v_pk_add_f32 v[128:129],v[128:129],v[132:133]
v_mfma_f32_16x16x32_bf16 v[216:219],v[60:63],a[56:59],v[216:219]
v_pk_fma_f32 v[130:131],v[124:125],v[124:125],v[130:131]
v_add_f32 v128,v128,v129
v_pk_fma_f32 v[130:131],v[126:127],v[126:127],v[130:131]
v_mfma_f32_16x16x32_bf16 v[220:223],v[60:63],a[60:63],v[220:223]
v_add_f32 v130,v130,v131
s_nop 1
v_permlane32_swap_b32 v128,v130
v_add_f32 v128,v128,v130
s_waitcnt lgkmcnt(8)
v_mfma_f32_16x16x32_bf16 v[192:195],v[64:67],a[64:67],v[192:195]
v_add_f32_dpp v128,v128,v128 row_ror:8 row_mask:0xf bank_mask:0xf
s_nop 1
v_add_f32_dpp v128,v128,v128 row_ror:4 row_mask:0xf bank_mask:0xf
s_nop 1
v_add_f32_dpp v128,v128,v128 row_ror:2 row_mask:0xf bank_mask:0xf
v_mfma_f32_16x16x32_bf16 v[196:199],v[64:67],a[68:71],v[196:199]
s_nop 0
v_add_f32_dpp v128,v128,v128 row_ror:1 row_mask:0xf bank_mask:0xf
v_mov_b32 v130,v128
s_nop 1
v_permlane16_swap_b32 v128,v130
v_mfma_f32_16x16x32_bf16 v[200:203],v[64:67],a[72:75],v[200:203]
v_add_f32 v128,v128,v130
v_mul_f32 v128,0x3b000000,v128
v_mov_b32 v130,v128
v_mfma_f32_16x16x32_bf16 v[204:207],v[64:67],a[76:79],v[204:207]
s_nop 0
v_permlane32_swap_b32 v128,v130
v_fma_f32 v130,-v128,v128,v130
v_add_f32 v128,s78,v128
v_mfma_f32_16x16x32_bf16 v[208:211],v[64:67],a[80:83],v[208:211]
v_max_f32 v130,0,v130
v_cvt_pk_bf16_f32 v130,v128,v130
v_lshlrev_b32 v128,16,v130
v_mfma_f32_16x16x32_bf16 v[212:215],v[64:67],a[84:87],v[212:215]
v_and_b32 v130,0xffff0000,v130
v_add_f32 v130,0x3727c5ac,v130
v_cvt_pk_bf16_f32 v130,v130,v130
v_mfma_f32_16x16x32_bf16 v[216:219],v[64:67],a[88:91],v[216:219]
v_and_b32 v130,0xffff0000,v130
v_sqrt_f32 v130,v130
v_pk_add_f32 v[120:121],v[88:89],v[128:129] op_sel_hi:[1,0] neg_lo:[0,1] neg_hi:[0,1]
v_mfma_f32_16x16x32_bf16 v[220:223],v[64:67],a[92:95],v[220:223]
v_pk_add_f32 v[122:123],v[90:91],v[128:129] op_sel_hi:[1,0] neg_lo:[0,1] neg_hi:[0,1]
v_pk_add_f32 v[124:125],v[92:93],v[128:129] op_sel_hi:[1,0] neg_lo:[0,1] neg_hi:[0,1]
v_pk_add_f32 v[126:127],v[94:95],v[128:129] op_sel_hi:[1,0] neg_lo:[0,1] neg_hi:[0,1]
s_waitcnt lgkmcnt(7)
v_mfma_f32_16x16x32_bf16 v[192:195],v[68:71],a[96:99],v[192:195]
v_cvt_pk_bf16_f32 v130,v130,v130
v_and_b32 v130,0xffff0000,v130
v_rcp_f32 v130,v130
v_mfma_f32_16x16x32_bf16 v[196:199],v[68:71],a[100:103],v[196:199]
v_cvt_pk_bf16_f32 v108,v120,v121
v_cvt_pk_bf16_f32 v109,v122,v123
v_cvt_pk_bf16_f32 v110,v124,v125
v_mfma_f32_16x16x32_bf16 v[200:203],v[68:71],a[104:107],v[200:203]
v_cvt_pk_bf16_f32 v111,v126,v127
v_lshlrev_b32 v120,16,v108
v_and_b32 v121,0xffff0000,v108
v_mfma_f32_16x16x32_bf16 v[204:207],v[68:71],a[108:111],v[204:207]
v_lshlrev_b32 v122,16,v109
v_and_b32 v123,0xffff0000,v109
v_lshlrev_b32 v124,16,v110
v_mfma_f32_16x16x32_bf16 v[208:211],v[68:71],a[112:115],v[208:211]
v_and_b32 v125,0xffff0000,v110
v_lshlrev_b32 v126,16,v111
v_mfma_f32_16x16x32_bf16 v[212:215],v[68:71],a[116:119],v[212:215]
v_and_b32 v127,0xffff0000,v111
v_pk_mul_f32 v[120:121],v[120:121],v[130:131] op_sel_hi:[1,0]
v_mfma_f32_16x16x32_bf16 v[216:219],v[68:71],a[120:123],v[216:219]
v_pk_mul_f32 v[122:123],v[122:123],v[130:131] op_sel_hi:[1,0]
v_pk_mul_f32 v[124:125],v[124:125],v[130:131] op_sel_hi:[1,0]
v_mfma_f32_16x16x32_bf16 v[220:223],v[68:71],a[124:127],v[220:223]
v_pk_mul_f32 v[126:127],v[126:127],v[130:131] op_sel_hi:[1,0]
v_cvt_pk_bf16_f32 v108,v120,v121
s_waitcnt lgkmcnt(6)
v_mfma_f32_16x16x32_bf16 v[192:195],v[72:75],a[128:131],v[192:195]
v_cvt_pk_bf16_f32 v109,v122,v123
v_cvt_pk_bf16_f32 v110,v124,v125
v_mfma_f32_16x16x32_bf16 v[196:199],v[72:75],a[132:135],v[196:199]
v_cvt_pk_bf16_f32 v111,v126,v127
v_lshlrev_b32 v112,16,v108
v_mfma_f32_16x16x32_bf16 v[200:203],v[72:75],a[136:139],v[200:203]
v_and_b32 v113,0xffff0000,v108
v_lshlrev_b32 v114,16,v109
v_mfma_f32_16x16x32_bf16 v[204:207],v[72:75],a[140:143],v[204:207]
v_and_b32 v115,0xffff0000,v109
v_lshlrev_b32 v116,16,v110
v_mfma_f32_16x16x32_bf16 v[208:211],v[72:75],a[144:147],v[208:211]
v_and_b32 v117,0xffff0000,v110
v_lshlrev_b32 v118,16,v111
v_mfma_f32_16x16x32_bf16 v[212:215],v[72:75],a[148:151],v[212:215]
v_and_b32 v119,0xffff0000,v111
v_pk_add_f32 v[88:89],v[88:89],v[112:113]
v_mfma_f32_16x16x32_bf16 v[216:219],v[72:75],a[152:155],v[216:219]
v_pk_add_f32 v[90:91],v[90:91],v[114:115]
v_pk_add_f32 v[92:93],v[92:93],v[116:117]
v_mfma_f32_16x16x32_bf16 v[220:223],v[72:75],a[156:159],v[220:223]
v_pk_add_f32 v[94:95],v[94:95],v[118:119]
v_cvt_pk_bf16_f32 v96,v88,v89
s_waitcnt lgkmcnt(5)
v_mfma_f32_16x16x32_bf16 v[192:195],v[76:79],a[160:163],v[192:195]
v_cvt_pk_bf16_f32 v97,v90,v91
v_cvt_pk_bf16_f32 v98,v92,v93
v_mfma_f32_16x16x32_bf16 v[196:199],v[76:79],a[164:167],v[196:199]
v_cvt_pk_bf16_f32 v99,v94,v95
buffer_store_dwordx4 v[96:99],v0,s[12:15],s19 offen sc1
v_mfma_f32_16x16x32_bf16 v[200:203],v[76:79],a[168:171],v[200:203]
v_pk_mul_f32 v[236:237],v[112:113],v[228:229]
v_pk_fma_f32 v[236:237],v[114:115],v[230:231],v[236:237]
v_mfma_f32_16x16x32_bf16 v[204:207],v[76:79],a[172:175],v[204:207]
v_pk_fma_f32 v[236:237],v[116:117],v[232:233],v[236:237]
v_pk_fma_f32 v[236:237],v[118:119],v[234:235],v[236:237]
v_mfma_f32_16x16x32_bf16 v[208:211],v[76:79],a[176:179],v[208:211]
v_add_f32 v236,v236,v237
s_nop 1
v_add_f32_dpp v236,v236,v236 row_ror:8 row_mask:0xf bank_mask:0xf
v_mfma_f32_16x16x32_bf16 v[212:215],v[76:79],a[180:183],v[212:215]
s_nop 0
v_add_f32_dpp v236,v236,v236 row_ror:4 row_mask:0xf bank_mask:0xf
s_nop 1
v_add_f32_dpp v236,v236,v236 row_ror:2 row_mask:0xf bank_mask:0xf
v_mfma_f32_16x16x32_bf16 v[216:219],v[76:79],a[184:187],v[216:219]
s_nop 0
v_add_f32_dpp v236,v236,v236 row_ror:1 row_mask:0xf bank_mask:0xf
v_mov_b32 v237,v236
v_mfma_f32_16x16x32_bf16 v[220:223],v[76:79],a[188:191],v[220:223]
s_nop 0
v_permlane16_swap_b32 v236,v237
v_add_f32 v236,v236,v237
s_waitcnt lgkmcnt(4)
v_mfma_f32_16x16x32_bf16 v[192:195],v[80:83],a[192:195],v[192:195]
v_mov_b32 v237,v236
s_nop 1
v_permlane32_swap_b32 v236,v237
v_mfma_f32_16x16x32_bf16 v[196:199],v[80:83],a[196:199],v[196:199]
v_add_f32 v236,v236,v237
v_cvt_pk_bf16_f32 v236,v236,v236
v_mfma_f32_16x16x32_bf16 v[200:203],v[80:83],a[200:203],v[200:203]
v_and_b32 v236,0xffff0000,v236
v_ashrrev_i32 v237,31,v236
v_mfma_f32_16x16x32_bf16 v[204:207],v[80:83],a[204:207],v[204:207]
v_or_b32 v237,0x80000000,v237
v_xor_b32 v236,v236,v237
v_mfma_f32_16x16x32_bf16 v[208:211],v[80:83],a[208:211],v[208:211]
v_and_b32 v236,0xffff0000,v236
s_sub_u32 s20,4095,s18
v_mfma_f32_16x16x32_bf16 v[212:215],v[80:83],a[212:215],v[212:215]
v_or_b32 v20,s20,v236
s_lshl_b32 s73,s26,13
v_mfma_f32_16x16x32_bf16 v[216:219],v[80:83],a[216:219],v[216:219]
s_lshl2_add_u32 s73,s68,s73
s_add_u32 s73,s73,10485760
v_mfma_f32_16x16x32_bf16 v[220:223],v[80:83],a[220:223],v[220:223]
s_add_u32 s73,s73,s86
s_waitcnt lgkmcnt(3)
v_mfma_f32_16x16x32_bf16 v[192:195],v[84:87],a[224:227],v[192:195]
v_mfma_f32_16x16x32_bf16 v[196:199],v[84:87],a[228:231],v[196:199]
v_mfma_f32_16x16x32_bf16 v[200:203],v[84:87],a[232:235],v[200:203]
v_mfma_f32_16x16x32_bf16 v[204:207],v[84:87],a[236:239],v[204:207]
v_mfma_f32_16x16x32_bf16 v[208:211],v[84:87],a[240:243],v[208:211]
v_mfma_f32_16x16x32_bf16 v[212:215],v[84:87],a[244:247],v[212:215]
v_mfma_f32_16x16x32_bf16 v[216:219],v[84:87],a[248:251],v[216:219]
v_mfma_f32_16x16x32_bf16 v[220:223],v[84:87],a[252:255],v[220:223]
v_cvt_pk_bf16_f32 v40,v192,v196
v_cvt_pk_bf16_f32 v41,v200,v204
v_cvt_pk_bf16_f32 v42,v208,v212
s_nop 4
v_cvt_pk_bf16_f32 v43,v216,v220
s_add_u32 s62,s69,262144
buffer_store_dwordx4 v[40:43],v5,s[8:11],s62 offen
v_cvt_pk_bf16_f32 v44,v193,v197
v_cvt_pk_bf16_f32 v45,v201,v205
v_cvt_pk_bf16_f32 v46,v209,v213
v_cvt_pk_bf16_f32 v47,v217,v221
s_add_u32 s62,s69,278528
buffer_store_dwordx4 v[44:47],v5,s[8:11],s62 offen
v_cvt_pk_bf16_f32 v48,v194,v198
v_cvt_pk_bf16_f32 v49,v202,v206
v_cvt_pk_bf16_f32 v50,v210,v214
v_cvt_pk_bf16_f32 v51,v218,v222
s_add_u32 s62,s69,294912
buffer_store_dwordx4 v[48:51],v5,s[8:11],s62 offen
v_cvt_pk_bf16_f32 v52,v195,v199
v_cvt_pk_bf16_f32 v53,v203,v207
v_cvt_pk_bf16_f32 v54,v211,v215
v_cvt_pk_bf16_f32 v55,v219,v223
s_add_u32 s62,s69,311296
buffer_store_dwordx4 v[52:55],v5,s[8:11],s62 offen
s_cmp_lg_u32 s72,0
s_cbranch_scc1 L_aa_40
s_waitcnt vmcnt(10)
s_branch L_aa_50
L_av_55:
ds_read_b128 v[24:27],v4 offset:0
ds_read_b128 v[28:31],v4 offset:1024
ds_read_b128 v[32:35],v4 offset:2048
ds_read_b128 v[36:39],v4 offset:3072
ds_read_b128 v[40:43],v4 offset:8192
ds_read_b128 v[44:47],v4 offset:9216
ds_read_b128 v[48:51],v4 offset:10240
ds_read_b128 v[52:55],v4 offset:11264
s_min_u32 s56,s32,s33
s_cmp_lt_u32 s77,64
s_cselect_b32 s56,s56,0
s_cmp_eq_u32 s56,0
s_cselect_b32 s72,0x80000000,0
v_mov_b32 v248,s72
s_or_b32 s64,s70,s72
s_or_b32 s65,s71,s72
ds_write_b32 v247,v248
s_and_b32 s57,s46,1
s_mul_i32 s58,s57,12288
s_add_u32 s64,s64,s58
s_lshl_b32 s57,s57,12
s_add_u32 s65,s65,s57
s_and_b32 s59,s50,2048
s_lshl_b32 s59,s59,4
s_xor_b32 s60,s67,65536
s_add_u32 s59,s59,s60
s_add_u32 s58,s58,s59
s_add_u32 s57,s57,s59
s_add_u32 m0,s58,0
s_waitcnt lgkmcnt(8)
v_mfma_f32_16x16x32_bf16 v[160:163],v[24:27],a[0:3],0
buffer_load_dwordx4 v0,s[8:11],s64 offen offset:0 sc1 lds
v_mfma_f32_16x16x32_bf16 v[164:167],v[24:27],a[4:7],0
v_mfma_f32_16x16x32_bf16 v[168:171],v[24:27],a[8:11],0
v_mfma_f32_16x16x32_bf16 v[172:175],v[24:27],a[12:15],0
v_mfma_f32_16x16x32_bf16 v[176:179],v[24:27],a[16:19],0
buffer_load_dwordx4 v0,s[8:11],s64 offen offset:1024 sc1 lds
v_mfma_f32_16x16x32_bf16 v[180:183],v[24:27],a[20:23],0
v_mfma_f32_16x16x32_bf16 v[184:187],v[24:27],a[24:27],0
s_waitcnt vmcnt(9)
v_mfma_f32_16x16x32_bf16 v[128:131],v[156:159],v[192:195],0
v_mfma_f32_16x16x32_bf16 v[188:191],v[24:27],a[28:31],0
s_waitcnt lgkmcnt(7)
v_mfma_f32_16x16x32_bf16 v[160:163],v[28:31],a[32:35],v[160:163]
buffer_load_dwordx4 v0,s[8:11],s64 offen offset:2048 sc1 lds
v_mfma_f32_16x16x32_bf16 v[164:167],v[28:31],a[36:39],v[164:167]
s_waitcnt vmcnt(9)
v_mfma_f32_16x16x32_bf16 v[128:131],v[156:159],v[196:199],v[128:131]
v_mfma_f32_16x16x32_bf16 v[168:171],v[28:31],a[40:43],v[168:171]
v_mfma_f32_16x16x32_bf16 v[172:175],v[28:31],a[44:47],v[172:175]
s_waitcnt vmcnt(8)
v_mfma_f32_16x16x32_bf16 v[128:131],v[156:159],v[200:203],v[128:131]
v_mfma_f32_16x16x32_bf16 v[176:179],v[28:31],a[48:51],v[176:179]
buffer_load_dwordx4 v0,s[8:11],s64 offen offset:3072 sc1 lds
v_mfma_f32_16x16x32_bf16 v[180:183],v[28:31],a[52:55],v[180:183]
v_mfma_f32_16x16x32_bf16 v[184:187],v[28:31],a[56:59],v[184:187]
s_waitcnt vmcnt(8)
v_mfma_f32_16x16x32_bf16 v[128:131],v[156:159],v[204:207],v[128:131]
v_mfma_f32_16x16x32_bf16 v[188:191],v[28:31],a[60:63],v[188:191]
s_waitcnt lgkmcnt(6)
v_mfma_f32_16x16x32_bf16 v[160:163],v[32:35],a[64:67],v[160:163]
s_add_u32 m0,s58,4096
s_add_u32 s64,s64,4096
v_mfma_f32_16x16x32_bf16 v[164:167],v[32:35],a[68:71],v[164:167]
buffer_load_dwordx4 v0,s[8:11],s64 offen offset:0 sc1 lds
v_mfma_f32_16x16x32_bf16 v[168:171],v[32:35],a[72:75],v[168:171]
s_waitcnt vmcnt(8)
v_mfma_f32_16x16x32_bf16 v[132:135],v[156:159],v[208:211],0
v_mfma_f32_16x16x32_bf16 v[172:175],v[32:35],a[76:79],v[172:175]
v_mfma_f32_16x16x32_bf16 v[176:179],v[32:35],a[80:83],v[176:179]
s_waitcnt vmcnt(7)
v_mfma_f32_16x16x32_bf16 v[132:135],v[156:159],v[212:215],v[132:135]
v_mfma_f32_16x16x32_bf16 v[180:183],v[32:35],a[84:87],v[180:183]
buffer_load_dwordx4 v0,s[8:11],s64 offen offset:1024 sc1 lds
v_mfma_f32_16x16x32_bf16 v[184:187],v[32:35],a[88:91],v[184:187]
v_mfma_f32_16x16x32_bf16 v[188:191],v[32:35],a[92:95],v[188:191]
s_waitcnt vmcnt(7)
v_mfma_f32_16x16x32_bf16 v[132:135],v[156:159],v[216:219],v[132:135]
s_waitcnt lgkmcnt(1)
v_mfma_f32_16x16x32_bf16 v[160:163],v[36:39],a[96:99],v[160:163]
v_mfma_f32_16x16x32_bf16 v[164:167],v[36:39],a[100:103],v[164:167]
buffer_load_dwordx4 v0,s[8:11],s64 offen offset:2048 sc1 lds
v_mfma_f32_16x16x32_bf16 v[168:171],v[36:39],a[104:107],v[168:171]
ds_write_b128 v6,v[128:131]
v_mfma_f32_16x16x32_bf16 v[172:175],v[36:39],a[108:111],v[172:175]
s_waitcnt vmcnt(7)
v_mfma_f32_16x16x32_bf16 v[132:135],v[156:159],v[220:223],v[132:135]
v_mfma_f32_16x16x32_bf16 v[176:179],v[36:39],a[112:115],v[176:179]
v_mfma_f32_16x16x32_bf16 v[180:183],v[36:39],a[116:119],v[180:183]
buffer_load_dwordx4 v0,s[8:11],s64 offen offset:3072 sc1 lds
v_mfma_f32_16x16x32_bf16 v[184:187],v[36:39],a[120:123],v[184:187]
v_mfma_f32_16x16x32_bf16 v[188:191],v[36:39],a[124:127],v[188:191]
v_mfma_f32_16x16x32_bf16 v[160:163],v[40:43],a[128:131],v[160:163]
ds_write_b128 v6,v[132:135] offset:2048
v_mfma_f32_16x16x32_bf16 v[164:167],v[40:43],a[132:135],v[164:167]
s_add_u32 m0,s58,8192
s_add_u32 s64,s64,4096
v_mfma_f32_16x16x32_bf16 v[168:171],v[40:43],a[136:139],v[168:171]
buffer_load_dwordx4 v0,s[8:11],s64 offen offset:0 sc1 lds
v_mfma_f32_16x16x32_bf16 v[172:175],v[40:43],a[140:143],v[172:175]
v_mfma_f32_16x16x32_bf16 v[176:179],v[40:43],a[144:147],v[176:179]
v_mfma_f32_16x16x32_bf16 v[180:183],v[40:43],a[148:151],v[180:183]
v_mfma_f32_16x16x32_bf16 v[184:187],v[40:43],a[152:155],v[184:187]
buffer_load_dwordx4 v0,s[8:11],s64 offen offset:1024 sc1 lds
v_mfma_f32_16x16x32_bf16 v[188:191],v[40:43],a[156:159],v[188:191]
s_waitcnt lgkmcnt(0)
s_barrier
v_mfma_f32_16x16x32_bf16 v[160:163],v[44:47],a[160:163],v[160:163]
ds_read_b128 v[56:59],v4 offset:4096
v_mfma_f32_16x16x32_bf16 v[164:167],v[44:47],a[164:167],v[164:167]
ds_read_b128 v[60:63],v4 offset:5120
v_mfma_f32_16x16x32_bf16 v[168:171],v[44:47],a[168:171],v[168:171]
buffer_load_dwordx4 v0,s[8:11],s64 offen offset:2048 sc1 lds
v_mfma_f32_16x16x32_bf16 v[172:175],v[44:47],a[172:175],v[172:175]
ds_read_b128 v[64:67],v4 offset:6144
v_mfma_f32_16x16x32_bf16 v[176:179],v[44:47],a[176:179],v[176:179]
ds_read_b128 v[68:71],v4 offset:7168
v_mfma_f32_16x16x32_bf16 v[180:183],v[44:47],a[180:183],v[180:183]
ds_read_b128 v[72:75],v4 offset:12288
v_mfma_f32_16x16x32_bf16 v[184:187],v[44:47],a[184:187],v[184:187]
buffer_load_dwordx4 v0,s[8:11],s64 offen offset:3072 sc1 lds
v_mfma_f32_16x16x32_bf16 v[188:191],v[44:47],a[188:191],v[188:191]
ds_read_b128 v[76:79],v4 offset:13312
v_mfma_f32_16x16x32_bf16 v[160:163],v[48:51],a[192:195],v[160:163]
ds_read_b128 v[80:83],v4 offset:14336
v_mfma_f32_16x16x32_bf16 v[164:167],v[48:51],a[196:199],v[164:167]
ds_read_b128 v[84:87],v4 offset:15360
v_mfma_f32_16x16x32_bf16 v[168:171],v[48:51],a[200:203],v[168:171]
s_add_u32 m0,s57,24576
s_nop 0
buffer_load_dwordx4 v0,s[8:11],s65 offen offset:0 sc1 lds
v_mfma_f32_16x16x32_bf16 v[172:175],v[48:51],a[204:207],v[172:175]
ds_read_b128 v[248:251],v245
v_mfma_f32_16x16x32_bf16 v[176:179],v[48:51],a[208:211],v[176:179]
s_lshl_b32 s23,s51,5
s_add_u32 s23,s23,s68
v_mfma_f32_16x16x32_bf16 v[180:183],v[48:51],a[212:215],v[180:183]
s_lshl_b32 s24,s23,10
s_lshl_b32 s25,s51,10
v_mfma_f32_16x16x32_bf16 v[184:187],v[48:51],a[216:219],v[184:187]
buffer_load_dwordx4 v0,s[8:11],s65 offen offset:1024 sc1 lds
v_mfma_f32_16x16x32_bf16 v[188:191],v[48:51],a[220:223],v[188:191]
s_add_u32 s25,s25,2883584
s_cmp_eq_u32 s23,s55
s_cselect_b32 s25,s25,s24
v_mfma_f32_16x16x32_bf16 v[160:163],v[52:55],a[224:227],v[160:163]
s_add_u32 s25,s25,8388608
s_mov_b32 s6,268435456
v_mfma_f32_16x16x32_bf16 v[164:167],v[52:55],a[228:231],v[164:167]
s_cmp_eq_u32 s31,0
s_cselect_b32 s25,s24,s25
s_cselect_b64 s[4:5],s[16:17],s[44:45]
s_cmov_b32 s6,2097152
v_mfma_f32_16x16x32_bf16 v[168:171],v[52:55],a[232:235],v[168:171]
buffer_load_dwordx4 v0,s[8:11],s65 offen offset:2048 sc1 lds
v_mfma_f32_16x16x32_bf16 v[172:175],v[52:55],a[236:239],v[172:175]
s_waitcnt lgkmcnt(0)
v_or3_b32 v248,v248,v249,v250
v_mfma_f32_16x16x32_bf16 v[176:179],v[52:55],a[240:243],v[176:179]
v_or_b32 v248,v248,v251
buffer_load_dwordx4 v[224:227],v0,s[4:7],s25 offen sc1
v_mfma_f32_16x16x32_bf16 v[180:183],v[52:55],a[244:247],v[180:183]
v_readfirstlane_b32 s72,v248
s_cmp_lt_u32 s51,55
s_cselect_b32 s24,s86,1536
v_mfma_f32_16x16x32_bf16 v[184:187],v[52:55],a[248:251],v[184:187]
buffer_load_dwordx4 v0,s[8:11],s65 offen offset:3072 sc1 lds
v_mfma_f32_16x16x32_bf16 v[188:191],v[52:55],a[252:255],v[188:191]
s_cmp_eq_u32 s24,768
s_cselect_b32 s24,128,0
s_waitcnt lgkmcnt(8)
v_mfma_f32_16x16x32_bf16 v[192:195],v[56:59],a[0:3],0
s_lshl_b32 s23,s51,13
s_lshl2_add_u32 s23,s68,s23
v_mfma_f32_16x16x32_bf16 v[196:199],v[56:59],a[4:7],0
s_add_u32 s23,s23,10487168
s_add_u32 s23,s23,s24
v_mfma_f32_16x16x32_bf16 v[200:203],v[56:59],a[8:11],0
buffer_load_dword v246,off,s[8:11],s23 sc1
v_mfma_f32_16x16x32_bf16 v[204:207],v[56:59],a[12:15],0
v_lshrrev_b32 v244,4,v1
s_sub_u32 s23,s77,8
v_mfma_f32_16x16x32_bf16 v[208:211],v[56:59],a[16:19],0
v_add_u32 v244,s23,v244
v_max_i32 v244,0,v244
v_mfma_f32_16x16x32_bf16 v[212:215],v[56:59],a[20:23],0
v_lshl_add_u32 v244,v244,13,v21
buffer_load_dwordx2 v[242:243],v244,s[8:11],0 offen sc1
v_mfma_f32_16x16x32_bf16 v[216:219],v[56:59],a[24:27],0
v_cvt_pk_bf16_f32 v24,v160,v164
v_cvt_pk_bf16_f32 v25,v168,v172
v_mfma_f32_16x16x32_bf16 v[220:223],v[56:59],a[28:31],0
v_cvt_pk_bf16_f32 v26,v176,v180
v_cvt_pk_bf16_f32 v27,v184,v188
s_waitcnt lgkmcnt(7)
v_mfma_f32_16x16x32_bf16 v[192:195],v[60:63],a[32:35],v[192:195]
s_add_u32 s62,s69,0
buffer_store_dwordx4 v[24:27],v5,s[8:11],s62 offen
v_mfma_f32_16x16x32_bf16 v[196:199],v[60:63],a[36:39],v[196:199]
v_cvt_pk_bf16_f32 v28,v161,v165
v_cvt_pk_bf16_f32 v29,v169,v173
v_mfma_f32_16x16x32_bf16 v[200:203],v[60:63],a[40:43],v[200:203]
v_cvt_pk_bf16_f32 v30,v177,v181
v_cvt_pk_bf16_f32 v31,v185,v189
v_mfma_f32_16x16x32_bf16 v[204:207],v[60:63],a[44:47],v[204:207]
s_add_u32 s62,s69,16384
buffer_store_dwordx4 v[28:31],v5,s[8:11],s62 offen
v_mfma_f32_16x16x32_bf16 v[208:211],v[60:63],a[48:51],v[208:211]
v_cvt_pk_bf16_f32 v32,v162,v166
v_cvt_pk_bf16_f32 v33,v170,v174
v_mfma_f32_16x16x32_bf16 v[212:215],v[60:63],a[52:55],v[212:215]
v_cvt_pk_bf16_f32 v34,v178,v182
v_cvt_pk_bf16_f32 v35,v186,v190
v_mfma_f32_16x16x32_bf16 v[216:219],v[60:63],a[56:59],v[216:219]
s_add_u32 s62,s69,32768
buffer_store_dwordx4 v[32:35],v5,s[8:11],s62 offen
v_mfma_f32_16x16x32_bf16 v[220:223],v[60:63],a[60:63],v[220:223]
v_cvt_pk_bf16_f32 v36,v163,v167
v_cvt_pk_bf16_f32 v37,v171,v175
s_waitcnt lgkmcnt(6)
v_mfma_f32_16x16x32_bf16 v[192:195],v[64:67],a[64:67],v[192:195]
v_cvt_pk_bf16_f32 v38,v179,v183
v_cvt_pk_bf16_f32 v39,v187,v191
v_mfma_f32_16x16x32_bf16 v[196:199],v[64:67],a[68:71],v[196:199]
s_add_u32 s62,s69,49152
buffer_store_dwordx4 v[36:39],v5,s[8:11],s62 offen
v_mfma_f32_16x16x32_bf16 v[200:203],v[64:67],a[72:75],v[200:203]
v_mfma_f32_16x16x32_bf16 v[204:207],v[64:67],a[76:79],v[204:207]
v_mfma_f32_16x16x32_bf16 v[208:211],v[64:67],a[80:83],v[208:211]
v_mfma_f32_16x16x32_bf16 v[212:215],v[64:67],a[84:87],v[212:215]
v_mfma_f32_16x16x32_bf16 v[216:219],v[64:67],a[88:91],v[216:219]
v_mfma_f32_16x16x32_bf16 v[220:223],v[64:67],a[92:95],v[220:223]
s_waitcnt lgkmcnt(5)
v_mfma_f32_16x16x32_bf16 v[192:195],v[68:71],a[96:99],v[192:195]
v_mfma_f32_16x16x32_bf16 v[196:199],v[68:71],a[100:103],v[196:199]
v_mfma_f32_16x16x32_bf16 v[200:203],v[68:71],a[104:107],v[200:203]
v_mfma_f32_16x16x32_bf16 v[204:207],v[68:71],a[108:111],v[204:207]
v_mfma_f32_16x16x32_bf16 v[208:211],v[68:71],a[112:115],v[208:211]
v_mfma_f32_16x16x32_bf16 v[212:215],v[68:71],a[116:119],v[212:215]
v_mfma_f32_16x16x32_bf16 v[216:219],v[68:71],a[120:123],v[216:219]
v_mfma_f32_16x16x32_bf16 v[220:223],v[68:71],a[124:127],v[220:223]
s_waitcnt lgkmcnt(4)
v_mfma_f32_16x16x32_bf16 v[192:195],v[72:75],a[128:131],v[192:195]
v_mfma_f32_16x16x32_bf16 v[196:199],v[72:75],a[132:135],v[196:199]
v_mfma_f32_16x16x32_bf16 v[200:203],v[72:75],a[136:139],v[200:203]
v_mfma_f32_16x16x32_bf16 v[204:207],v[72:75],a[140:143],v[204:207]
v_mfma_f32_16x16x32_bf16 v[208:211],v[72:75],a[144:147],v[208:211]
v_mfma_f32_16x16x32_bf16 v[212:215],v[72:75],a[148:151],v[212:215]
v_mfma_f32_16x16x32_bf16 v[216:219],v[72:75],a[152:155],v[216:219]
v_mfma_f32_16x16x32_bf16 v[220:223],v[72:75],a[156:159],v[220:223]
s_waitcnt lgkmcnt(3)
v_mfma_f32_16x16x32_bf16 v[192:195],v[76:79],a[160:163],v[192:195]
v_mfma_f32_16x16x32_bf16 v[196:199],v[76:79],a[164:167],v[196:199]
v_mfma_f32_16x16x32_bf16 v[200:203],v[76:79],a[168:171],v[200:203]
v_mfma_f32_16x16x32_bf16 v[204:207],v[76:79],a[172:175],v[204:207]
v_mfma_f32_16x16x32_bf16 v[208:211],v[76:79],a[176:179],v[208:211]
v_mfma_f32_16x16x32_bf16 v[212:215],v[76:79],a[180:183],v[212:215]
v_mfma_f32_16x16x32_bf16 v[216:219],v[76:79],a[184:187],v[216:219]
v_mfma_f32_16x16x32_bf16 v[220:223],v[76:79],a[188:191],v[220:223]
s_waitcnt lgkmcnt(2)
v_mfma_f32_16x16x32_bf16 v[192:195],v[80:83],a[192:195],v[192:195]
v_mfma_f32_16x16x32_bf16 v[196:199],v[80:83],a[196:199],v[196:199]
v_mfma_f32_16x16x32_bf16 v[200:203],v[80:83],a[200:203],v[200:203]
v_mfma_f32_16x16x32_bf16 v[204:207],v[80:83],a[204:207],v[204:207]
v_mfma_f32_16x16x32_bf16 v[208:211],v[80:83],a[208:211],v[208:211]
v_mfma_f32_16x16x32_bf16 v[212:215],v[80:83],a[212:215],v[212:215]
v_mfma_f32_16x16x32_bf16 v[216:219],v[80:83],a[216:219],v[216:219]
v_mfma_f32_16x16x32_bf16 v[220:223],v[80:83],a[220:223],v[220:223]
s_waitcnt lgkmcnt(1)
v_mfma_f32_16x16x32_bf16 v[192:195],v[84:87],a[224:227],v[192:195]
v_mfma_f32_16x16x32_bf16 v[196:199],v[84:87],a[228:231],v[196:199]
v_mfma_f32_16x16x32_bf16 v[200:203],v[84:87],a[232:235],v[200:203]
v_mfma_f32_16x16x32_bf16 v[204:207],v[84:87],a[236:239],v[204:207]
v_mfma_f32_16x16x32_bf16 v[208:211],v[84:87],a[240:243],v[208:211]
v_mfma_f32_16x16x32_bf16 v[212:215],v[84:87],a[244:247],v[212:215]
v_mfma_f32_16x16x32_bf16 v[216:219],v[84:87],a[248:251],v[216:219]
v_mfma_f32_16x16x32_bf16 v[220:223],v[84:87],a[252:255],v[220:223]
v_cvt_pk_bf16_f32 v40,v192,v196
v_cvt_pk_bf16_f32 v41,v200,v204
v_cvt_pk_bf16_f32 v42,v208,v212
s_nop 4
v_cvt_pk_bf16_f32 v43,v216,v220
s_add_u32 s62,s69,262144
buffer_store_dwordx4 v[40:43],v5,s[8:11],s62 offen
v_cvt_pk_bf16_f32 v44,v193,v197
v_cvt_pk_bf16_f32 v45,v201,v205
v_cvt_pk_bf16_f32 v46,v209,v213
v_cvt_pk_bf16_f32 v47,v217,v221
s_add_u32 s62,s69,278528
buffer_store_dwordx4 v[44:47],v5,s[8:11],s62 offen
v_cvt_pk_bf16_f32 v48,v194,v198
v_cvt_pk_bf16_f32 v49,v202,v206
v_cvt_pk_bf16_f32 v50,v210,v214
v_cvt_pk_bf16_f32 v51,v218,v222
s_add_u32 s62,s69,294912
buffer_store_dwordx4 v[48:51],v5,s[8:11],s62 offen
v_cvt_pk_bf16_f32 v52,v195,v199
v_cvt_pk_bf16_f32 v53,v203,v207
v_cvt_pk_bf16_f32 v54,v211,v215
v_cvt_pk_bf16_f32 v55,v219,v223
s_add_u32 s62,s69,311296
buffer_store_dwordx4 v[52:55],v5,s[8:11],s62 offen
s_cmp_lg_u32 s72,0
s_cbranch_scc1 L_aa_40
s_waitcnt vmcnt(10)
s_branch L_aa_50
L_aa_38:
ds_read_b128 v[24:27],v4 offset:0
ds_read_b128 v[28:31],v4 offset:1024
ds_read_b128 v[32:35],v4 offset:2048
ds_read_b128 v[36:39],v4 offset:3072
ds_read_b128 v[40:43],v4 offset:8192
ds_read_b128 v[44:47],v4 offset:9216
ds_read_b128 v[48:51],v4 offset:10240
ds_read_b128 v[52:55],v4 offset:11264
s_min_u32 s56,s32,s33
s_cmp_lt_u32 s77,64
s_cselect_b32 s56,s56,0
s_cmp_eq_u32 s56,0
s_cselect_b32 s72,0x80000000,0
v_mov_b32 v248,s72
s_or_b32 s64,s70,s72
s_or_b32 s65,s71,s72
ds_write_b32 v247,v248
s_and_b32 s57,s46,1
s_mul_i32 s58,s57,12288
s_add_u32 s64,s64,s58
s_lshl_b32 s57,s57,12
s_add_u32 s65,s65,s57
s_and_b32 s59,s50,2048
s_lshl_b32 s59,s59,4
s_xor_b32 s60,s67,65536
s_add_u32 s59,s59,s60
s_add_u32 s58,s58,s59
s_add_u32 s57,s57,s59
s_add_u32 m0,s58,0
s_waitcnt lgkmcnt(8)
v_mfma_f32_16x16x32_bf16 v[160:163],v[24:27],a[0:3],0
buffer_load_dwordx4 v0,s[8:11],s64 offen offset:0 sc1 lds
v_mfma_f32_16x16x32_bf16 v[164:167],v[24:27],a[4:7],0
s_lshl_b32 s23,s51,5
s_add_u32 s23,s23,s68
v_mfma_f32_16x16x32_bf16 v[168:171],v[24:27],a[8:11],0
s_lshl_b32 s24,s23,10
s_lshl_b32 s25,s51,10
v_mfma_f32_16x16x32_bf16 v[172:175],v[24:27],a[12:15],0
s_add_u32 s25,s25,2883584
s_cmp_eq_u32 s23,s55
s_cselect_b32 s25,s25,s24
v_mfma_f32_16x16x32_bf16 v[176:179],v[24:27],a[16:19],0
buffer_load_dwordx4 v0,s[8:11],s64 offen offset:1024 sc1 lds
v_mfma_f32_16x16x32_bf16 v[180:183],v[24:27],a[20:23],0
s_add_u32 s25,s25,8388608
s_mov_b32 s6,268435456
v_mfma_f32_16x16x32_bf16 v[184:187],v[24:27],a[24:27],0
s_cmp_eq_u32 s31,0
s_cselect_b32 s25,s24,s25
s_cselect_b64 s[4:5],s[16:17],s[44:45]
s_cmov_b32 s6,2097152
v_mfma_f32_16x16x32_bf16 v[188:191],v[24:27],a[28:31],0
buffer_load_dwordx4 v[224:227],v0,s[4:7],s25 offen sc1
s_waitcnt lgkmcnt(7)
v_mfma_f32_16x16x32_bf16 v[160:163],v[28:31],a[32:35],v[160:163]
buffer_load_dwordx4 v0,s[8:11],s64 offen offset:2048 sc1 lds
v_mfma_f32_16x16x32_bf16 v[164:167],v[28:31],a[36:39],v[164:167]
s_cmp_lt_u32 s51,55
s_cselect_b32 s24,s86,1536
v_mfma_f32_16x16x32_bf16 v[168:171],v[28:31],a[40:43],v[168:171]
s_cmp_eq_u32 s24,768
s_cselect_b32 s24,128,0
v_mfma_f32_16x16x32_bf16 v[172:175],v[28:31],a[44:47],v[172:175]
s_lshl_b32 s23,s51,13
s_lshl2_add_u32 s23,s68,s23
v_mfma_f32_16x16x32_bf16 v[176:179],v[28:31],a[48:51],v[176:179]
buffer_load_dwordx4 v0,s[8:11],s64 offen offset:3072 sc1 lds
v_mfma_f32_16x16x32_bf16 v[180:183],v[28:31],a[52:55],v[180:183]
s_add_u32 s23,s23,10487168
s_add_u32 s23,s23,s24
v_mfma_f32_16x16x32_bf16 v[184:187],v[28:31],a[56:59],v[184:187]
buffer_load_dword v246,off,s[8:11],s23 sc1
v_mfma_f32_16x16x32_bf16 v[188:191],v[28:31],a[60:63],v[188:191]
v_lshrrev_b32 v244,4,v1
s_sub_u32 s23,s77,8
s_waitcnt lgkmcnt(6)
v_mfma_f32_16x16x32_bf16 v[160:163],v[32:35],a[64:67],v[160:163]
s_add_u32 m0,s58,4096
s_add_u32 s64,s64,4096
v_mfma_f32_16x16x32_bf16 v[164:167],v[32:35],a[68:71],v[164:167]
buffer_load_dwordx4 v0,s[8:11],s64 offen offset:0 sc1 lds
v_mfma_f32_16x16x32_bf16 v[168:171],v[32:35],a[72:75],v[168:171]
v_add_u32 v244,s23,v244
v_max_i32 v244,0,v244
v_mfma_f32_16x16x32_bf16 v[172:175],v[32:35],a[76:79],v[172:175]
v_lshl_add_u32 v244,v244,13,v21
buffer_load_dwordx2 v[242:243],v244,s[8:11],0 offen sc1
v_mfma_f32_16x16x32_bf16 v[176:179],v[32:35],a[80:83],v[176:179]
s_waitcnt lgkmcnt(0)
s_barrier
v_mfma_f32_16x16x32_bf16 v[180:183],v[32:35],a[84:87],v[180:183]
buffer_load_dwordx4 v0,s[8:11],s64 offen offset:1024 sc1 lds
v_mfma_f32_16x16x32_bf16 v[184:187],v[32:35],a[88:91],v[184:187]
v_mfma_f32_16x16x32_bf16 v[188:191],v[32:35],a[92:95],v[188:191]
s_waitcnt lgkmcnt(1)
v_mfma_f32_16x16x32_bf16 v[160:163],v[36:39],a[96:99],v[160:163]
ds_read_b128 v[56:59],v4 offset:4096
v_mfma_f32_16x16x32_bf16 v[164:167],v[36:39],a[100:103],v[164:167]
buffer_load_dwordx4 v0,s[8:11],s64 offen offset:2048 sc1 lds
v_mfma_f32_16x16x32_bf16 v[168:171],v[36:39],a[104:107],v[168:171]
ds_read_b128 v[60:63],v4 offset:5120
v_mfma_f32_16x16x32_bf16 v[172:175],v[36:39],a[108:111],v[172:175]
ds_read_b128 v[64:67],v4 offset:6144
v_mfma_f32_16x16x32_bf16 v[176:179],v[36:39],a[112:115],v[176:179]
ds_read_b128 v[68:71],v4 offset:7168
v_mfma_f32_16x16x32_bf16 v[180:183],v[36:39],a[116:119],v[180:183]
buffer_load_dwordx4 v0,s[8:11],s64 offen offset:3072 sc1 lds
v_mfma_f32_16x16x32_bf16 v[184:187],v[36:39],a[120:123],v[184:187]
ds_read_b128 v[72:75],v4 offset:12288
v_mfma_f32_16x16x32_bf16 v[188:191],v[36:39],a[124:127],v[188:191]
ds_read_b128 v[76:79],v4 offset:13312
v_mfma_f32_16x16x32_bf16 v[160:163],v[40:43],a[128:131],v[160:163]
ds_read_b128 v[80:83],v4 offset:14336
v_mfma_f32_16x16x32_bf16 v[164:167],v[40:43],a[132:135],v[164:167]
s_add_u32 m0,s58,8192
s_add_u32 s64,s64,4096
v_mfma_f32_16x16x32_bf16 v[168:171],v[40:43],a[136:139],v[168:171]
buffer_load_dwordx4 v0,s[8:11],s64 offen offset:0 sc1 lds
v_mfma_f32_16x16x32_bf16 v[172:175],v[40:43],a[140:143],v[172:175]
ds_read_b128 v[84:87],v4 offset:15360
v_mfma_f32_16x16x32_bf16 v[176:179],v[40:43],a[144:147],v[176:179]
ds_read_b128 v[248:251],v245
v_mfma_f32_16x16x32_bf16 v[180:183],v[40:43],a[148:151],v[180:183]
s_waitcnt vmcnt(12)
buffer_store_dword v20,off,s[8:11],s73 sc1
v_mfma_f32_16x16x32_bf16 v[184:187],v[40:43],a[152:155],v[184:187]
buffer_load_dwordx4 v0,s[8:11],s64 offen offset:1024 sc1 lds
v_mfma_f32_16x16x32_bf16 v[188:191],v[40:43],a[156:159],v[188:191]
s_mov_b32 s73,0x80000000
v_mfma_f32_16x16x32_bf16 v[160:163],v[44:47],a[160:163],v[160:163]
v_mfma_f32_16x16x32_bf16 v[164:167],v[44:47],a[164:167],v[164:167]
v_mfma_f32_16x16x32_bf16 v[168:171],v[44:47],a[168:171],v[168:171]
buffer_load_dwordx4 v0,s[8:11],s64 offen offset:2048 sc1 lds
v_mfma_f32_16x16x32_bf16 v[172:175],v[44:47],a[172:175],v[172:175]
s_waitcnt lgkmcnt(0)
v_or3_b32 v248,v248,v249,v250
v_mfma_f32_16x16x32_bf16 v[176:179],v[44:47],a[176:179],v[176:179]
v_or_b32 v248,v248,v251
v_mfma_f32_16x16x32_bf16 v[180:183],v[44:47],a[180:183],v[180:183]
v_readfirstlane_b32 s72,v248
v_mfma_f32_16x16x32_bf16 v[184:187],v[44:47],a[184:187],v[184:187]
buffer_load_dwordx4 v0,s[8:11],s64 offen offset:3072 sc1 lds
v_mfma_f32_16x16x32_bf16 v[188:191],v[44:47],a[188:191],v[188:191]
v_mfma_f32_16x16x32_bf16 v[160:163],v[48:51],a[192:195],v[160:163]
v_mfma_f32_16x16x32_bf16 v[164:167],v[48:51],a[196:199],v[164:167]
v_mfma_f32_16x16x32_bf16 v[168:171],v[48:51],a[200:203],v[168:171]
s_add_u32 m0,s57,24576
s_nop 0
buffer_load_dwordx4 v0,s[8:11],s65 offen offset:0 sc1 lds
v_mfma_f32_16x16x32_bf16 v[172:175],v[48:51],a[204:207],v[172:175]
v_mfma_f32_16x16x32_bf16 v[176:179],v[48:51],a[208:211],v[176:179]
v_mfma_f32_16x16x32_bf16 v[180:183],v[48:51],a[212:215],v[180:183]
v_mfma_f32_16x16x32_bf16 v[184:187],v[48:51],a[216:219],v[184:187]
buffer_load_dwordx4 v0,s[8:11],s65 offen offset:1024 sc1 lds
v_mfma_f32_16x16x32_bf16 v[188:191],v[48:51],a[220:223],v[188:191]
v_mfma_f32_16x16x32_bf16 v[160:163],v[52:55],a[224:227],v[160:163]
v_mfma_f32_16x16x32_bf16 v[164:167],v[52:55],a[228:231],v[164:167]
v_mfma_f32_16x16x32_bf16 v[168:171],v[52:55],a[232:235],v[168:171]
buffer_load_dwordx4 v0,s[8:11],s65 offen offset:2048 sc1 lds
v_mfma_f32_16x16x32_bf16 v[172:175],v[52:55],a[236:239],v[172:175]
v_mfma_f32_16x16x32_bf16 v[176:179],v[52:55],a[240:243],v[176:179]
v_mfma_f32_16x16x32_bf16 v[180:183],v[52:55],a[244:247],v[180:183]
v_mfma_f32_16x16x32_bf16 v[184:187],v[52:55],a[248:251],v[184:187]
buffer_load_dwordx4 v0,s[8:11],s65 offen offset:3072 sc1 lds
v_mfma_f32_16x16x32_bf16 v[188:191],v[52:55],a[252:255],v[188:191]
s_waitcnt lgkmcnt(8)
v_mfma_f32_16x16x32_bf16 v[192:195],v[56:59],a[0:3],0
v_mfma_f32_16x16x32_bf16 v[196:199],v[56:59],a[4:7],0
v_mfma_f32_16x16x32_bf16 v[200:203],v[56:59],a[8:11],0
v_cvt_pk_bf16_f32 v24,v160,v164
v_cvt_pk_bf16_f32 v25,v168,v172
v_mfma_f32_16x16x32_bf16 v[204:207],v[56:59],a[12:15],0
v_cvt_pk_bf16_f32 v26,v176,v180
v_cvt_pk_bf16_f32 v27,v184,v188
v_mfma_f32_16x16x32_bf16 v[208:211],v[56:59],a[16:19],0
s_add_u32 s62,s69,0
buffer_store_dwordx4 v[24:27],v5,s[8:11],s62 offen
v_mfma_f32_16x16x32_bf16 v[212:215],v[56:59],a[20:23],0
v_cvt_pk_bf16_f32 v28,v161,v165
v_cvt_pk_bf16_f32 v29,v169,v173
v_mfma_f32_16x16x32_bf16 v[216:219],v[56:59],a[24:27],0
v_cvt_pk_bf16_f32 v30,v177,v181
v_cvt_pk_bf16_f32 v31,v185,v189
v_mfma_f32_16x16x32_bf16 v[220:223],v[56:59],a[28:31],0
s_add_u32 s62,s69,16384
buffer_store_dwordx4 v[28:31],v5,s[8:11],s62 offen
s_waitcnt lgkmcnt(7)
v_mfma_f32_16x16x32_bf16 v[192:195],v[60:63],a[32:35],v[192:195]
v_cvt_pk_bf16_f32 v32,v162,v166
v_cvt_pk_bf16_f32 v33,v170,v174
v_mfma_f32_16x16x32_bf16 v[196:199],v[60:63],a[36:39],v[196:199]
v_cvt_pk_bf16_f32 v34,v178,v182
v_cvt_pk_bf16_f32 v35,v186,v190
v_mfma_f32_16x16x32_bf16 v[200:203],v[60:63],a[40:43],v[200:203]
s_add_u32 s62,s69,32768
buffer_store_dwordx4 v[32:35],v5,s[8:11],s62 offen
v_mfma_f32_16x16x32_bf16 v[204:207],v[60:63],a[44:47],v[204:207]
v_cvt_pk_bf16_f32 v36,v163,v167
v_cvt_pk_bf16_f32 v37,v171,v175
v_mfma_f32_16x16x32_bf16 v[208:211],v[60:63],a[48:51],v[208:211]
v_cvt_pk_bf16_f32 v38,v179,v183
v_cvt_pk_bf16_f32 v39,v187,v191
v_mfma_f32_16x16x32_bf16 v[212:215],v[60:63],a[52:55],v[212:215]
s_add_u32 s62,s69,49152
buffer_store_dwordx4 v[36:39],v5,s[8:11],s62 offen
v_mfma_f32_16x16x32_bf16 v[216:219],v[60:63],a[56:59],v[216:219]
v_mfma_f32_16x16x32_bf16 v[220:223],v[60:63],a[60:63],v[220:223]
s_waitcnt lgkmcnt(6)
v_mfma_f32_16x16x32_bf16 v[192:195],v[64:67],a[64:67],v[192:195]
v_mfma_f32_16x16x32_bf16 v[196:199],v[64:67],a[68:71],v[196:199]
v_mfma_f32_16x16x32_bf16 v[200:203],v[64:67],a[72:75],v[200:203]
v_mfma_f32_16x16x32_bf16 v[204:207],v[64:67],a[76:79],v[204:207]
v_mfma_f32_16x16x32_bf16 v[208:211],v[64:67],a[80:83],v[208:211]
v_mfma_f32_16x16x32_bf16 v[212:215],v[64:67],a[84:87],v[212:215]
v_mfma_f32_16x16x32_bf16 v[216:219],v[64:67],a[88:91],v[216:219]
v_mfma_f32_16x16x32_bf16 v[220:223],v[64:67],a[92:95],v[220:223]
s_waitcnt lgkmcnt(5)
v_mfma_f32_16x16x32_bf16 v[192:195],v[68:71],a[96:99],v[192:195]
v_mfma_f32_16x16x32_bf16 v[196:199],v[68:71],a[100:103],v[196:199]
v_mfma_f32_16x16x32_bf16 v[200:203],v[68:71],a[104:107],v[200:203]
v_mfma_f32_16x16x32_bf16 v[204:207],v[68:71],a[108:111],v[204:207]
v_mfma_f32_16x16x32_bf16 v[208:211],v[68:71],a[112:115],v[208:211]
v_mfma_f32_16x16x32_bf16 v[212:215],v[68:71],a[116:119],v[212:215]
v_mfma_f32_16x16x32_bf16 v[216:219],v[68:71],a[120:123],v[216:219]
v_mfma_f32_16x16x32_bf16 v[220:223],v[68:71],a[124:127],v[220:223]
s_waitcnt lgkmcnt(4)
v_mfma_f32_16x16x32_bf16 v[192:195],v[72:75],a[128:131],v[192:195]
v_mfma_f32_16x16x32_bf16 v[196:199],v[72:75],a[132:135],v[196:199]
v_mfma_f32_16x16x32_bf16 v[200:203],v[72:75],a[136:139],v[200:203]
v_mfma_f32_16x16x32_bf16 v[204:207],v[72:75],a[140:143],v[204:207]
v_mfma_f32_16x16x32_bf16 v[208:211],v[72:75],a[144:147],v[208:211]
v_mfma_f32_16x16x32_bf16 v[212:215],v[72:75],a[148:151],v[212:215]
v_mfma_f32_16x16x32_bf16 v[216:219],v[72:75],a[152:155],v[216:219]
v_mfma_f32_16x16x32_bf16 v[220:223],v[72:75],a[156:159],v[220:223]
s_waitcnt lgkmcnt(3)
v_mfma_f32_16x16x32_bf16 v[192:195],v[76:79],a[160:163],v[192:195]
v_mfma_f32_16x16x32_bf16 v[196:199],v[76:79],a[164:167],v[196:199]
v_mfma_f32_16x16x32_bf16 v[200:203],v[76:79],a[168:171],v[200:203]
v_mfma_f32_16x16x32_bf16 v[204:207],v[76:79],a[172:175],v[204:207]
v_mfma_f32_16x16x32_bf16 v[208:211],v[76:79],a[176:179],v[208:211]
v_mfma_f32_16x16x32_bf16 v[212:215],v[76:79],a[180:183],v[212:215]
v_mfma_f32_16x16x32_bf16 v[216:219],v[76:79],a[184:187],v[216:219]
v_mfma_f32_16x16x32_bf16 v[220:223],v[76:79],a[188:191],v[220:223]
s_waitcnt lgkmcnt(2)
v_mfma_f32_16x16x32_bf16 v[192:195],v[80:83],a[192:195],v[192:195]
v_mfma_f32_16x16x32_bf16 v[196:199],v[80:83],a[196:199],v[196:199]
v_mfma_f32_16x16x32_bf16 v[200:203],v[80:83],a[200:203],v[200:203]
v_mfma_f32_16x16x32_bf16 v[204:207],v[80:83],a[204:207],v[204:207]
v_mfma_f32_16x16x32_bf16 v[208:211],v[80:83],a[208:211],v[208:211]
v_mfma_f32_16x16x32_bf16 v[212:215],v[80:83],a[212:215],v[212:215]
v_mfma_f32_16x16x32_bf16 v[216:219],v[80:83],a[216:219],v[216:219]
v_mfma_f32_16x16x32_bf16 v[220:223],v[80:83],a[220:223],v[220:223]
s_waitcnt lgkmcnt(1)
v_mfma_f32_16x16x32_bf16 v[192:195],v[84:87],a[224:227],v[192:195]
v_mfma_f32_16x16x32_bf16 v[196:199],v[84:87],a[228:231],v[196:199]
v_mfma_f32_16x16x32_bf16 v[200:203],v[84:87],a[232:235],v[200:203]
v_mfma_f32_16x16x32_bf16 v[204:207],v[84:87],a[236:239],v[204:207]
v_mfma_f32_16x16x32_bf16 v[208:211],v[84:87],a[240:243],v[208:211]
v_mfma_f32_16x16x32_bf16 v[212:215],v[84:87],a[244:247],v[212:215]
v_mfma_f32_16x16x32_bf16 v[216:219],v[84:87],a[248:251],v[216:219]
v_mfma_f32_16x16x32_bf16 v[220:223],v[84:87],a[252:255],v[220:223]
v_cvt_pk_bf16_f32 v40,v192,v196
v_cvt_pk_bf16_f32 v41,v200,v204
v_cvt_pk_bf16_f32 v42,v208,v212
s_nop 4
v_cvt_pk_bf16_f32 v43,v216,v220
s_add_u32 s62,s69,262144
buffer_store_dwordx4 v[40:43],v5,s[8:11],s62 offen
v_cvt_pk_bf16_f32 v44,v193,v197
v_cvt_pk_bf16_f32 v45,v201,v205
v_cvt_pk_bf16_f32 v46,v209,v213
v_cvt_pk_bf16_f32 v47,v217,v221
s_add_u32 s62,s69,278528
buffer_store_dwordx4 v[44:47],v5,s[8:11],s62 offen
v_cvt_pk_bf16_f32 v48,v194,v198
v_cvt_pk_bf16_f32 v49,v202,v206
v_cvt_pk_bf16_f32 v50,v210,v214
v_cvt_pk_bf16_f32 v51,v218,v222
s_add_u32 s62,s69,294912
buffer_store_dwordx4 v[48:51],v5,s[8:11],s62 offen
v_cvt_pk_bf16_f32 v52,v195,v199
v_cvt_pk_bf16_f32 v53,v203,v207
v_cvt_pk_bf16_f32 v54,v211,v215
v_cvt_pk_bf16_f32 v55,v219,v223
s_add_u32 s62,s69,311296
buffer_store_dwordx4 v[52:55],v5,s[8:11],s62 offen
s_cmp_lg_u32 s72,0
s_cbranch_scc1 L_aa_40
s_waitcnt vmcnt(8)
L_aa_50:
s_barrier
s_xor_b32 s67,s67,65536
s_and_b32 s56,s50,2048
s_lshl_b32 s56,s56,4
s_add_u32 s56,s56,s67
v_add_u32 v2,s56,v0
s_and_b32 s56,s50,1024
s_lshl_b32 s56,s56,2
v_add_u32 v238,s56,v2
s_mov_b32 s76,s71
s_mov_b32 s53,s77
ds_read_b128 v[24:27],v238 offset:16384
ds_read_b128 v[40:43],v2 offset:0
ds_read_b128 v[56:59],v2 offset:4096
ds_read_b128 v[28:31],v238 offset:17408
ds_read_b128 v[44:47],v2 offset:1024
ds_read_b128 v[60:63],v2 offset:5120
ds_read_b128 v[32:35],v238 offset:18432
ds_read_b128 v[48:51],v2 offset:2048
ds_read_b128 v[64:67],v2 offset:6144
ds_read_b128 v[36:39],v238 offset:19456
ds_read_b128 v[52:55],v2 offset:3072
ds_read_b128 v[68:71],v2 offset:7168
s_waitcnt lgkmcnt(9)
v_mfma_f32_16x16x32_bf16 v[128:131],v[40:43],v[24:27],v[8:11]
ds_read_b128 v[72:75],v2 offset:24576
v_mfma_f32_16x16x32_bf16 v[132:135],v[56:59],v[24:27],v[12:15]
ds_read_b128 v[76:79],v2 offset:25600
s_waitcnt lgkmcnt(8)
v_mfma_f32_16x16x32_bf16 v[128:131],v[44:47],v[28:31],v[128:131]
ds_read_b128 v[80:83],v2 offset:26624
v_mfma_f32_16x16x32_bf16 v[132:135],v[60:63],v[28:31],v[132:135]
ds_read_b128 v[84:87],v2 offset:27648
s_waitcnt lgkmcnt(7)
v_mfma_f32_16x16x32_bf16 v[128:131],v[48:51],v[32:35],v[128:131]
ds_read_b64 v[120:121],v2 offset:28672
v_mfma_f32_16x16x32_bf16 v[132:135],v[64:67],v[32:35],v[132:135]
ds_read_b64 v[122:123],v2 offset:29696
s_waitcnt lgkmcnt(6)
v_mfma_f32_16x16x32_bf16 v[128:131],v[52:55],v[36:39],v[128:131]
ds_read_b64 v[124:125],v2 offset:30720
v_mfma_f32_16x16x32_bf16 v[132:135],v[68:71],v[36:39],v[132:135]
ds_read_b64 v[126:127],v2 offset:31744
s_waitcnt lgkmcnt(4)
v_mfma_f32_16x16x32_bf16 v[136:139],v[72:75],v[24:27],0
ds_read_b128 v[88:91],v2 offset:8192
ds_read_b128 v[92:95],v2 offset:9216
v_mfma_f32_16x16x32_bf16 v[136:139],v[76:79],v[28:31],v[136:139]
ds_read_b128 v[96:99],v2 offset:10240
ds_read_b128 v[100:103],v2 offset:11264
v_mfma_f32_16x16x32_bf16 v[136:139],v[80:83],v[32:35],v[136:139]
ds_read_b128 v[104:107],v2 offset:12288
ds_read_b128 v[108:111],v2 offset:13312
v_mfma_f32_16x16x32_bf16 v[136:139],v[84:87],v[36:39],v[136:139]
ds_read_b128 v[112:115],v2 offset:14336
ds_read_b128 v[116:119],v2 offset:15360
s_cmp_eq_u32 s30,0
s_cbranch_scc1 L_aa_39
s_add_u32 s66,s66,1
v_mov_b32 v22,s66
s_xor_b32 s69,s69,524288
s_waitcnt vmcnt(0) lgkmcnt(0)
s_barrier
buffer_store_dword v22,off,s[8:11],s74
buffer_store_dword v20,off,s[8:11],s73 sc1
s_mov_b32 s73,0x80000000
s_cmp_lg_u32 s86,1536
s_cbranch_scc1 L_ae_58
s_add_u32 s77,s53,13
s_mov_b32 s30,0
s_lshl_b32 s56,s77,5
s_add_u32 s56,s56,s68
s_mul_i32 s70,s56,24576
s_lshl_b32 s71,s56,13
s_lshl_b32 s59,s77,13
s_lshl2_add_u32 s59,s68,s59
s_add_u32 s59,s59,10485760
s_buffer_load_dword s32,s[8:11],s59 glc
s_mov_b32 s33,1
s_add_u32 s70,s70,100663296
s_add_u32 s71,s71,41943040
v_mov_b32 v19,s59
s_branch L_af_59
L_ae_58:
s_ff1_i32_b64 s77,s[84:85]
s_bitset0_b64 s[84:85],s77
s_ff1_i32_b64 s77,s[84:85]
s_bitset0_b64 s[84:85],s77
s_ff1_i32_b64 s77,s[84:85]
s_bitset0_b64 s[84:85],s77
s_ff1_i32_b64 s77,s[84:85]
s_bitset0_b64 s[84:85],s77
s_ff1_i32_b64 s77,s[84:85]
s_bitset0_b64 s[84:85],s77
s_ff1_i32_b64 s77,s[84:85]
s_bitset0_b64 s[84:85],s77
s_min_u32 s77,s77,64
s_lshr_b32 s61,s55,5
s_lshl_b32 s56,s77,5
s_add_u32 s56,s56,s68
s_mul_i32 s70,s56,24576
s_lshl_b32 s71,s56,13
s_lshl_b32 s59,s77,13
s_lshl2_add_u32 s59,s68,s59
s_add_u32 s59,s59,10486144
s_cmp_lt_u32 s77,s61
s_cselect_b32 s57,0,16777216
s_cselect_b32 s60,0,128
s_add_u32 s60,s60,s59
s_add_u32 s60,s60,128
s_buffer_load_dword s33,s[8:11],s60 glc
s_add_u32 s71,s71,s57
s_add_u32 s71,s71,58720256
s_cmp_eq_u32 s77,s61
s_cselect_b32 s57,50331648,0
s_cselect_b32 s58,1536,0
s_add_u32 s59,s59,s58
s_buffer_load_dword s32,s[8:11],s59 glc
s_add_u32 s70,s70,s57
s_add_u32 s70,s70,150994944
v_mov_b32 v19,s59
v_writelane_b32 v19,s60,1
L_af_59:
v_max3_f32 v238,v128,v129,v130
v_max3_f32 v239,v131,v132,v133
v_max3_f32 v238,v134,v135,v238
v_max3_f32 v239,v138,v139,v239
v_max_f32 v238,v238,v239
v_max_f32 v239,v238,v239
s_nop 1
v_permlane16_swap_b32 v238,v239
v_max_f32 v238,v238,v239
v_max_f32 v239,v238,v239
s_nop 1
v_permlane32_swap_b32 v238,v239
v_max_f32 v238,v238,v239
v_mul_f32 v238,s80,v238
v_fma_f32 v128,v128,s80,-v238
v_fma_f32 v129,v129,s80,-v238
v_exp_f32 v128,v128
v_fma_f32 v130,v130,s80,-v238
v_exp_f32 v129,v129
v_fma_f32 v131,v131,s80,-v238
v_exp_f32 v130,v130
v_fma_f32 v132,v132,s80,-v238
v_exp_f32 v131,v131
v_fma_f32 v133,v133,s80,-v238
v_exp_f32 v132,v132
v_fma_f32 v134,v134,s80,-v238
v_exp_f32 v133,v133
v_fma_f32 v135,v135,s80,-v238
v_exp_f32 v134,v134
v_fma_f32 v138,v138,s80,-v238
v_exp_f32 v135,v135
v_fma_f32 v139,v139,s80,-v238
v_exp_f32 v138,v138
v_exp_f32 v139,v139
v_cvt_pk_bf16_f32 v140,v128,v129
v_cvt_pk_bf16_f32 v141,v130,v131
v_cvt_pk_bf16_f32 v142,v132,v133
v_cvt_pk_bf16_f32 v143,v134,v135
v_cvt_pk_bf16_f32 v144,v138,v139
v_mov_b32 v147,v144
buffer_load_dword v17,v16,s[8:11],s87 offen sc1
v_mfma_f32_16x16x32_bf16 v[148:151],v[152:155],v[140:143],0
v_mfma_f32_16x16x32_bf16 v[24:27],v[88:91],v[140:143],0
v_mfma_f32_16x16x32_bf16 v[28:31],v[92:95],v[140:143],0
v_mfma_f32_16x16x16_bf16 v[148:151],v[152:153],v[144:145],v[148:151]
v_mfma_f32_16x16x32_bf16 v[32:35],v[96:99],v[140:143],0
v_mfma_f32_16x16x32_bf16 v[36:39],v[100:103],v[140:143],0
v_mfma_f32_16x16x32_bf16 v[40:43],v[104:107],v[140:143],0
v_mfma_f32_16x16x32_bf16 v[44:47],v[108:111],v[140:143],0
v_mfma_f32_16x16x32_bf16 v[48:51],v[112:115],v[140:143],0
v_mfma_f32_16x16x32_bf16 v[52:55],v[116:119],v[140:143],0
v_rcp_f32 v148,v148
v_mfma_f32_16x16x16_bf16 v[24:27],v[120:121],v[144:145],v[24:27]
v_mfma_f32_16x16x16_bf16 v[28:31],v[120:121],v[146:147],v[28:31]
v_mfma_f32_16x16x16_bf16 v[32:35],v[122:123],v[144:145],v[32:35]
v_mfma_f32_16x16x16_bf16 v[36:39],v[122:123],v[146:147],v[36:39]
v_mfma_f32_16x16x16_bf16 v[40:43],v[124:125],v[144:145],v[40:43]
v_pk_mul_f32 v[24:25],v[24:25],v[148:149] op_sel_hi:[1,0]
v_pk_mul_f32 v[26:27],v[26:27],v[148:149] op_sel_hi:[1,0]
v_mfma_f32_16x16x16_bf16 v[44:47],v[124:125],v[146:147],v[44:47]
v_pk_mul_f32 v[28:29],v[28:29],v[148:149] op_sel_hi:[1,0]
v_pk_mul_f32 v[30:31],v[30:31],v[148:149] op_sel_hi:[1,0]
v_mfma_f32_16x16x16_bf16 v[48:51],v[126:127],v[144:145],v[48:51]
v_cvt_pk_bf16_f32 v72,v24,v28
v_cvt_pk_bf16_f32 v73,v25,v29
v_mfma_f32_16x16x16_bf16 v[52:55],v[126:127],v[146:147],v[52:55]
v_cvt_pk_bf16_f32 v74,v26,v30
v_cvt_pk_bf16_f32 v75,v27,v31
ds_write_b128 v3,v[72:75] offset:0
v_pk_mul_f32 v[32:33],v[32:33],v[148:149] op_sel_hi:[1,0]
v_pk_mul_f32 v[34:35],v[34:35],v[148:149] op_sel_hi:[1,0]
v_pk_mul_f32 v[36:37],v[36:37],v[148:149] op_sel_hi:[1,0]
v_pk_mul_f32 v[38:39],v[38:39],v[148:149] op_sel_hi:[1,0]
v_cvt_pk_bf16_f32 v76,v32,v36
v_cvt_pk_bf16_f32 v77,v33,v37
v_cvt_pk_bf16_f32 v78,v34,v38
v_cvt_pk_bf16_f32 v79,v35,v39
ds_write_b128 v3,v[76:79] offset:1024
s_waitcnt vmcnt(0)
v_cmp_gt_u32 vcc,s66,v17
v_pk_mul_f32 v[40:41],v[40:41],v[148:149] op_sel_hi:[1,0]
v_pk_mul_f32 v[42:43],v[42:43],v[148:149] op_sel_hi:[1,0]
v_pk_mul_f32 v[44:45],v[44:45],v[148:149] op_sel_hi:[1,0]
v_pk_mul_f32 v[46:47],v[46:47],v[148:149] op_sel_hi:[1,0]
s_cbranch_vccnz L_ap_60
L_apb_61:
s_xor_b32 s34,s69,524288
buffer_load_dwordx4 v[192:195],v7,s[8:11],s34 offen sc1
v_cvt_pk_bf16_f32 v80,v40,v44
v_cvt_pk_bf16_f32 v81,v41,v45
s_add_u32 s34,s34,4096
buffer_load_dwordx4 v[196:199],v7,s[8:11],s34 offen sc1
v_cvt_pk_bf16_f32 v82,v42,v46
v_cvt_pk_bf16_f32 v83,v43,v47
s_add_u32 s34,s34,4096
buffer_load_dwordx4 v[200:203],v7,s[8:11],s34 offen sc1
ds_write_b128 v3,v[80:83] offset:2048
v_pk_mul_f32 v[48:49],v[48:49],v[148:149] op_sel_hi:[1,0]
s_add_u32 s34,s34,4096
buffer_load_dwordx4 v[204:207],v7,s[8:11],s34 offen sc1
v_pk_mul_f32 v[50:51],v[50:51],v[148:149] op_sel_hi:[1,0]
v_pk_mul_f32 v[52:53],v[52:53],v[148:149] op_sel_hi:[1,0]
s_add_u32 s34,s34,4096
buffer_load_dwordx4 v[208:211],v7,s[8:11],s34 offen sc1
v_pk_mul_f32 v[54:55],v[54:55],v[148:149] op_sel_hi:[1,0]
v_cvt_pk_bf16_f32 v84,v48,v52
s_add_u32 s34,s34,4096
buffer_load_dwordx4 v[212:215],v7,s[8:11],s34 offen sc1
v_cvt_pk_bf16_f32 v85,v49,v53
v_cvt_pk_bf16_f32 v86,v50,v54
s_add_u32 s34,s34,4096
buffer_load_dwordx4 v[216:219],v7,s[8:11],s34 offen sc1
v_cvt_pk_bf16_f32 v87,v51,v55
ds_write_b128 v3,v[84:87] offset:3072
s_add_u32 s34,s34,4096
buffer_load_dwordx4 v[220:223],v7,s[8:11],s34 offen sc1
s_waitcnt lgkmcnt(0)
s_barrier
s_mov_b32 s27,s31
s_mov_b32 s31,1
s_branch L_aa_51
L_aa_39:
v_max3_u32 v238,v72,v73,v74
v_max3_u32 v238,v74,v75,v238
v_max3_u32 v238,v76,v77,v238
v_max3_u32 v238,v78,v79,v238
v_max3_u32 v238,v80,v81,v238
v_max3_u32 v238,v82,v83,v238
v_max3_u32 v238,v84,v85,v238
v_max3_u32 v238,v86,v87,v238
s_waitcnt lgkmcnt(8)
v_max3_u32 v238,v120,v121,v238
v_max3_u32 v238,v122,v123,v238
v_max3_u32 v238,v124,v125,v238
v_max3_u32 v238,v126,v127,v238
v_cmp_eq_u32 vcc,-1,v238
s_cmp_lg_u64 vcc,0
s_cselect_b32 s56,1,0
v_mov_b32 v238,s56
ds_write_b32 v247,v238 offset:16
s_add_u32 s66,s66,1
v_mov_b32 v22,s66
s_xor_b32 s69,s69,524288
s_waitcnt vmcnt(0) lgkmcnt(0)
s_barrier
buffer_store_dword v22,off,s[8:11],s74
buffer_store_dword v20,off,s[8:11],s73 sc1
s_mov_b32 s73,0x80000000
ds_read_b128 v[248:251],v245 offset:16
s_waitcnt lgkmcnt(0)
v_or3_b32 v248,v248,v249,v250
v_or_b32 v248,v248,v251
v_cmp_ne_u32 vcc,0,v248
s_cbranch_vccnz L_aa_41
s_cmp_lt_u32 s53,5
s_cbranch_scc1 L_ab_62
L_aw_64:
v_min_u32 v239,v242,v243
v_cmp_eq_u32 vcc,0,v239
s_cbranch_vccz L_awd_65
buffer_load_dwordx2 v[242:243],v244,s[8:11],0 offen sc1
s_sub_u32 s49,s49,1
s_cbranch_scc1 L_abort
s_waitcnt vmcnt(0)
s_branch L_aw_64
L_awd_65:
v_max_u32 v242,v242,v243
s_nop 1
v_max_u32_dpp v242,v242,v242 row_ror:8 row_mask:0xf bank_mask:0xf
s_nop 1
v_max_u32_dpp v242,v242,v242 row_ror:4 row_mask:0xf bank_mask:0xf
s_nop 1
v_max_u32_dpp v242,v242,v242 row_ror:2 row_mask:0xf bank_mask:0xf
s_nop 1
v_max_u32_dpp v242,v242,v242 row_ror:1 row_mask:0xf bank_mask:0xf
v_mov_b32 v243,v242
s_nop 1
v_permlane16_swap_b32 v242,v243
v_max_u32 v242,v242,v243
v_mov_b32 v243,v242
s_nop 1
v_permlane32_swap_b32 v242,v243
v_max_u32 v242,v242,v243
s_nop 0
v_readfirstlane_b32 s56,v242
s_max_u32 s75,s75,s56
s_cmp_lt_u32 s53,9
s_cbranch_scc1 L_ab_62
s_sub_u32 s77,s53,9
s_and_b32 s55,s75,0x7ff
s_sub_u32 s55,2047,s55
s_cmp_lt_u32 s77,28
s_cselect_b32 s55,4095,s55
s_lshr_b32 s61,s55,5
s_mov_b32 s30,1
s_lshl_b32 s56,s77,5
s_add_u32 s56,s56,s68
s_mul_i32 s70,s56,24576
s_lshl_b32 s71,s56,13
s_lshl_b32 s59,s77,13
s_lshl2_add_u32 s59,s68,s59
s_add_u32 s59,s59,10486144
s_cmp_lt_u32 s77,s61
s_cselect_b32 s57,0,16777216
s_cselect_b32 s60,0,128
s_add_u32 s60,s60,s59
s_add_u32 s60,s60,128
s_buffer_load_dword s33,s[8:11],s60 glc
s_add_u32 s71,s71,s57
s_add_u32 s71,s71,58720256
s_cmp_eq_u32 s77,s61
s_cselect_b32 s57,50331648,0
s_cselect_b32 s58,1536,0
s_add_u32 s59,s59,s58
s_buffer_load_dword s32,s[8:11],s59 glc
s_add_u32 s70,s70,s57
s_add_u32 s70,s70,150994944
v_mov_b32 v19,s59
v_writelane_b32 v19,s60,1
s_branch L_aj_63
L_ab_62:
s_add_u32 s77,s53,4
s_mov_b32 s30,0
s_lshl_b32 s56,s77,5
s_add_u32 s56,s56,s68
s_mul_i32 s70,s56,24576
s_lshl_b32 s71,s56,13
s_lshl_b32 s59,s77,13
s_lshl2_add_u32 s59,s68,s59
s_add_u32 s59,s59,10485760
s_buffer_load_dword s32,s[8:11],s59 glc
s_mov_b32 s33,1
s_add_u32 s70,s70,100663296
s_add_u32 s71,s71,41943040
v_mov_b32 v19,s59
L_aj_63:
v_max3_f32 v238,v128,v129,v130
v_max3_f32 v239,v131,v132,v133
v_max3_f32 v238,v134,v135,v238
v_max3_f32 v239,v138,v139,v239
v_max_f32 v238,v238,v239
v_max_f32 v239,v238,v239
s_nop 1
v_permlane16_swap_b32 v238,v239
v_max_f32 v238,v238,v239
v_max_f32 v239,v238,v239
s_nop 1
v_permlane32_swap_b32 v238,v239
v_max_f32 v238,v238,v239
v_mul_f32 v238,s80,v238
v_fma_f32 v128,v128,s80,-v238
v_fma_f32 v129,v129,s80,-v238
v_exp_f32 v128,v128
v_fma_f32 v130,v130,s80,-v238
v_exp_f32 v129,v129
v_fma_f32 v131,v131,s80,-v238
v_exp_f32 v130,v130
v_fma_f32 v132,v132,s80,-v238
v_exp_f32 v131,v131
v_fma_f32 v133,v133,s80,-v238
v_exp_f32 v132,v132
v_fma_f32 v134,v134,s80,-v238
v_exp_f32 v133,v133
v_fma_f32 v135,v135,s80,-v238
v_exp_f32 v134,v134
v_fma_f32 v138,v138,s80,-v238
v_exp_f32 v135,v135
v_fma_f32 v139,v139,s80,-v238
v_exp_f32 v138,v138
v_exp_f32 v139,v139
v_cvt_pk_bf16_f32 v140,v128,v129
v_cvt_pk_bf16_f32 v141,v130,v131
v_cvt_pk_bf16_f32 v142,v132,v133
v_cvt_pk_bf16_f32 v143,v134,v135
v_cvt_pk_bf16_f32 v144,v138,v139
v_mov_b32 v147,v144
buffer_load_dword v17,v16,s[8:11],s87 offen sc1
v_mfma_f32_16x16x32_bf16 v[148:151],v[152:155],v[140:143],0
v_mfma_f32_16x16x32_bf16 v[24:27],v[88:91],v[140:143],0
v_mfma_f32_16x16x32_bf16 v[28:31],v[92:95],v[140:143],0
v_mfma_f32_16x16x16_bf16 v[148:151],v[152:153],v[144:145],v[148:151]
v_mfma_f32_16x16x32_bf16 v[32:35],v[96:99],v[140:143],0
v_mfma_f32_16x16x32_bf16 v[36:39],v[100:103],v[140:143],0
v_mfma_f32_16x16x32_bf16 v[40:43],v[104:107],v[140:143],0
v_mfma_f32_16x16x32_bf16 v[44:47],v[108:111],v[140:143],0
v_mfma_f32_16x16x32_bf16 v[48:51],v[112:115],v[140:143],0
v_mfma_f32_16x16x32_bf16 v[52:55],v[116:119],v[140:143],0
v_rcp_f32 v148,v148
v_mfma_f32_16x16x16_bf16 v[24:27],v[120:121],v[144:145],v[24:27]
v_mfma_f32_16x16x16_bf16 v[28:31],v[120:121],v[146:147],v[28:31]
v_mfma_f32_16x16x16_bf16 v[32:35],v[122:123],v[144:145],v[32:35]
v_mfma_f32_16x16x16_bf16 v[36:39],v[122:123],v[146:147],v[36:39]
v_mfma_f32_16x16x16_bf16 v[40:43],v[124:125],v[144:145],v[40:43]
v_pk_mul_f32 v[24:25],v[24:25],v[148:149] op_sel_hi:[1,0]
v_pk_mul_f32 v[26:27],v[26:27],v[148:149] op_sel_hi:[1,0]
v_mfma_f32_16x16x16_bf16 v[44:47],v[124:125],v[146:147],v[44:47]
v_pk_mul_f32 v[28:29],v[28:29],v[148:149] op_sel_hi:[1,0]
v_pk_mul_f32 v[30:31],v[30:31],v[148:149] op_sel_hi:[1,0]
v_mfma_f32_16x16x16_bf16 v[48:51],v[126:127],v[144:145],v[48:51]
v_cvt_pk_bf16_f32 v72,v24,v28
v_cvt_pk_bf16_f32 v73,v25,v29
v_mfma_f32_16x16x16_bf16 v[52:55],v[126:127],v[146:147],v[52:55]
v_cvt_pk_bf16_f32 v74,v26,v30
v_cvt_pk_bf16_f32 v75,v27,v31
ds_write_b128 v3,v[72:75] offset:0
v_pk_mul_f32 v[32:33],v[32:33],v[148:149] op_sel_hi:[1,0]
v_pk_mul_f32 v[34:35],v[34:35],v[148:149] op_sel_hi:[1,0]
v_pk_mul_f32 v[36:37],v[36:37],v[148:149] op_sel_hi:[1,0]
v_pk_mul_f32 v[38:39],v[38:39],v[148:149] op_sel_hi:[1,0]
v_cvt_pk_bf16_f32 v76,v32,v36
v_cvt_pk_bf16_f32 v77,v33,v37
v_cvt_pk_bf16_f32 v78,v34,v38
v_cvt_pk_bf16_f32 v79,v35,v39
ds_write_b128 v3,v[76:79] offset:1024
s_waitcnt vmcnt(0)
v_cmp_gt_u32 vcc,s66,v17
v_pk_mul_f32 v[40:41],v[40:41],v[148:149] op_sel_hi:[1,0]
v_pk_mul_f32 v[42:43],v[42:43],v[148:149] op_sel_hi:[1,0]
v_pk_mul_f32 v[44:45],v[44:45],v[148:149] op_sel_hi:[1,0]
v_pk_mul_f32 v[46:47],v[46:47],v[148:149] op_sel_hi:[1,0]
s_cbranch_vccnz L_ap_66
L_apb_67:
s_xor_b32 s34,s69,524288
buffer_load_dwordx4 v[192:195],v7,s[8:11],s34 offen sc1
v_cvt_pk_bf16_f32 v80,v40,v44
v_cvt_pk_bf16_f32 v81,v41,v45
s_add_u32 s34,s34,4096
buffer_load_dwordx4 v[196:199],v7,s[8:11],s34 offen sc1
v_cvt_pk_bf16_f32 v82,v42,v46
v_cvt_pk_bf16_f32 v83,v43,v47
s_add_u32 s34,s34,4096
buffer_load_dwordx4 v[200:203],v7,s[8:11],s34 offen sc1
ds_write_b128 v3,v[80:83] offset:2048
v_pk_mul_f32 v[48:49],v[48:49],v[148:149] op_sel_hi:[1,0]
s_add_u32 s34,s34,4096
buffer_load_dwordx4 v[204:207],v7,s[8:11],s34 offen sc1
v_pk_mul_f32 v[50:51],v[50:51],v[148:149] op_sel_hi:[1,0]
v_pk_mul_f32 v[52:53],v[52:53],v[148:149] op_sel_hi:[1,0]
s_add_u32 s34,s34,4096
buffer_load_dwordx4 v[208:211],v7,s[8:11],s34 offen sc1
v_pk_mul_f32 v[54:55],v[54:55],v[148:149] op_sel_hi:[1,0]
v_cvt_pk_bf16_f32 v84,v48,v52
s_add_u32 s34,s34,4096
buffer_load_dwordx4 v[212:215],v7,s[8:11],s34 offen sc1
v_cvt_pk_bf16_f32 v85,v49,v53
v_cvt_pk_bf16_f32 v86,v50,v54
s_add_u32 s34,s34,4096
buffer_load_dwordx4 v[216:219],v7,s[8:11],s34 offen sc1
v_cvt_pk_bf16_f32 v87,v51,v55
ds_write_b128 v3,v[84:87] offset:3072
s_add_u32 s34,s34,4096
buffer_load_dwordx4 v[220:223],v7,s[8:11],s34 offen sc1
s_waitcnt lgkmcnt(0)
s_barrier
s_mov_b32 s27,s31
s_mov_b32 s31,0
s_branch L_aa_51
L_aa_41:
L_aq_68:
buffer_load_dword v17,v16,s[8:11],s87 offen sc1
s_sub_u32 s49,s49,1
s_cbranch_scc1 L_abort
s_waitcnt vmcnt(0)
v_cmp_gt_u32 vcc,s66,v17
s_cbranch_vccnz L_aq_68
s_xor_b32 s34,s69,524288
buffer_load_dwordx4 v[160:163],v7,s[8:11],s34 offen sc1
s_add_u32 s34,s34,4096
buffer_load_dwordx4 v[164:167],v7,s[8:11],s34 offen sc1
s_add_u32 s34,s34,4096
buffer_load_dwordx4 v[168:171],v7,s[8:11],s34 offen sc1
s_add_u32 s34,s34,4096
buffer_load_dwordx4 v[172:175],v7,s[8:11],s34 offen sc1
s_add_u32 s34,s34,4096
buffer_load_dwordx4 v[176:179],v7,s[8:11],s34 offen sc1
s_add_u32 s34,s34,4096
buffer_load_dwordx4 v[180:183],v7,s[8:11],s34 offen sc1
s_add_u32 s34,s34,4096
buffer_load_dwordx4 v[184:187],v7,s[8:11],s34 offen sc1
s_add_u32 s34,s34,4096
buffer_load_dwordx4 v[188:191],v7,s[8:11],s34 offen sc1
s_add_u32 s62,s76,4096
buffer_load_dwordx4 v[72:75],v0,s[8:11],s76 offen offset:0 sc1
buffer_load_dwordx4 v[76:79],v0,s[8:11],s76 offen offset:1024 sc1
buffer_load_dwordx4 v[80:83],v0,s[8:11],s76 offen offset:2048 sc1
buffer_load_dwordx4 v[84:87],v0,s[8:11],s76 offen offset:3072 sc1
buffer_load_dwordx2 v[120:121],v0,s[8:11],s62 offen offset:0 sc1
buffer_load_dwordx2 v[122:123],v0,s[8:11],s62 offen offset:1024 sc1
buffer_load_dwordx2 v[124:125],v0,s[8:11],s62 offen offset:2048 sc1
buffer_load_dwordx2 v[126:127],v0,s[8:11],s62 offen offset:3072 sc1
s_waitcnt vmcnt(15)
v_mfma_f32_16x16x32_bf16 v[192:195],v[156:159],v[160:163],0
s_waitcnt vmcnt(14)
v_mfma_f32_16x16x32_bf16 v[192:195],v[156:159],v[164:167],v[192:195]
s_waitcnt vmcnt(13)
v_mfma_f32_16x16x32_bf16 v[192:195],v[156:159],v[168:171],v[192:195]
s_waitcnt vmcnt(12)
v_mfma_f32_16x16x32_bf16 v[192:195],v[156:159],v[172:175],v[192:195]
s_waitcnt vmcnt(11)
v_mfma_f32_16x16x32_bf16 v[196:199],v[156:159],v[176:179],0
s_waitcnt vmcnt(10)
v_mfma_f32_16x16x32_bf16 v[196:199],v[156:159],v[180:183],v[196:199]
s_waitcnt vmcnt(9)
v_mfma_f32_16x16x32_bf16 v[196:199],v[156:159],v[184:187],v[196:199]
ds_write_b128 v6,v[192:195]
s_waitcnt vmcnt(8)
v_mfma_f32_16x16x32_bf16 v[196:199],v[156:159],v[188:191],v[196:199]
s_nop 7
ds_write_b128 v6,v[196:199] offset:2048
s_waitcnt lgkmcnt(0)
s_barrier
s_mov_b32 s27,0
s_branch L_aa_42
L_aa_40:
s_add_u32 s66,s66,1
v_mov_b32 v22,s66
s_xor_b32 s69,s69,524288
s_waitcnt vmcnt(0) lgkmcnt(0)
s_barrier
buffer_store_dword v22,off,s[8:11],s74
buffer_store_dword v20,off,s[8:11],s73 sc1
s_mov_b32 s73,0x80000000
L_aq_69:
buffer_load_dword v17,v16,s[8:11],s87 offen sc1
s_sub_u32 s49,s49,1
s_cbranch_scc1 L_abort
s_waitcnt vmcnt(0)
v_cmp_gt_u32 vcc,s66,v17
s_cbranch_vccnz L_aq_69
s_xor_b32 s34,s69,524288
buffer_load_dwordx4 v[160:163],v7,s[8:11],s34 offen sc1
s_add_u32 s34,s34,4096
buffer_load_dwordx4 v[164:167],v7,s[8:11],s34 offen sc1
s_add_u32 s34,s34,4096
buffer_load_dwordx4 v[168:171],v7,s[8:11],s34 offen sc1
s_add_u32 s34,s34,4096
buffer_load_dwordx4 v[172:175],v7,s[8:11],s34 offen sc1
s_add_u32 s34,s34,4096
buffer_load_dwordx4 v[176:179],v7,s[8:11],s34 offen sc1
s_add_u32 s34,s34,4096
buffer_load_dwordx4 v[180:183],v7,s[8:11],s34 offen sc1
s_add_u32 s34,s34,4096
buffer_load_dwordx4 v[184:187],v7,s[8:11],s34 offen sc1
s_add_u32 s34,s34,4096
buffer_load_dwordx4 v[188:191],v7,s[8:11],s34 offen sc1
s_waitcnt vmcnt(7)
v_mfma_f32_16x16x32_bf16 v[192:195],v[156:159],v[160:163],0
s_waitcnt vmcnt(6)
v_mfma_f32_16x16x32_bf16 v[192:195],v[156:159],v[164:167],v[192:195]
s_waitcnt vmcnt(5)
v_mfma_f32_16x16x32_bf16 v[192:195],v[156:159],v[168:171],v[192:195]
s_waitcnt vmcnt(4)
v_mfma_f32_16x16x32_bf16 v[192:195],v[156:159],v[172:175],v[192:195]
s_waitcnt vmcnt(3)
v_mfma_f32_16x16x32_bf16 v[196:199],v[156:159],v[176:179],0
s_waitcnt vmcnt(2)
v_mfma_f32_16x16x32_bf16 v[196:199],v[156:159],v[180:183],v[196:199]
s_waitcnt vmcnt(1)
v_mfma_f32_16x16x32_bf16 v[196:199],v[156:159],v[184:187],v[196:199]
ds_write_b128 v6,v[192:195]
s_waitcnt vmcnt(0)
v_mfma_f32_16x16x32_bf16 v[196:199],v[156:159],v[188:191],v[196:199]
s_nop 7
ds_write_b128 v6,v[196:199] offset:2048
s_waitcnt lgkmcnt(0)
s_barrier
s_mov_b32 s27,2
L_aa_42:
s_cmp_lg_u32 s31,0
s_cbranch_scc1 L_ar_72
s_bitcmp1_b32 s46,0
s_cbranch_scc1 L_ar_71
L_ar_70:
ds_read_b128 v[160:163],v23
ds_read_b128 v[164:167],v23 offset:16
v_lshlrev_b32 v200,16,v224
v_and_b32 v201,0xffff0000,v224
v_lshlrev_b32 v202,16,v225
v_and_b32 v203,0xffff0000,v225
v_lshlrev_b32 v204,16,v226
v_and_b32 v205,0xffff0000,v226
v_lshlrev_b32 v206,16,v227
v_and_b32 v207,0xffff0000,v227
s_lshl_b32 s18,s51,5
s_add_u32 s18,s18,s68
s_lshl_b32 s19,s18,10
s_add_u32 s20,s19,8388608
s_waitcnt lgkmcnt(0)
v_cvt_pk_bf16_f32 v168,v160,v161
v_cvt_pk_bf16_f32 v169,v162,v163
v_cvt_pk_bf16_f32 v170,v164,v165
v_cvt_pk_bf16_f32 v171,v166,v167
v_lshlrev_b32 v160,16,v168
v_and_b32 v161,0xffff0000,v168
v_lshlrev_b32 v162,16,v169
v_and_b32 v163,0xffff0000,v169
v_lshlrev_b32 v164,16,v170
v_and_b32 v165,0xffff0000,v170
v_lshlrev_b32 v166,16,v171
v_and_b32 v167,0xffff0000,v171
v_pk_add_f32 v[200:201],v[200:201],v[160:161]
v_pk_add_f32 v[202:203],v[202:203],v[162:163]
v_pk_add_f32 v[204:205],v[204:205],v[164:165]
v_pk_add_f32 v[206:207],v[206:207],v[166:167]
v_cvt_pk_bf16_f32 v168,v200,v201
v_cvt_pk_bf16_f32 v169,v202,v203
v_cvt_pk_bf16_f32 v170,v204,v205
v_cvt_pk_bf16_f32 v171,v206,v207
v_lshlrev_b32 v200,16,v168
v_and_b32 v201,0xffff0000,v168
v_lshlrev_b32 v202,16,v169
v_and_b32 v203,0xffff0000,v169
v_lshlrev_b32 v204,16,v170
v_and_b32 v205,0xffff0000,v170
v_lshlrev_b32 v206,16,v171
v_and_b32 v207,0xffff0000,v171
v_readfirstlane_b32 s78,v200
s_nop 1
v_pk_add_f32 v[184:185],v[200:201],s[78:79] op_sel_hi:[1,0] neg_lo:[0,1] neg_hi:[0,1]
v_pk_add_f32 v[186:187],v[202:203],s[78:79] op_sel_hi:[1,0] neg_lo:[0,1] neg_hi:[0,1]
v_pk_add_f32 v[188:189],v[204:205],s[78:79] op_sel_hi:[1,0] neg_lo:[0,1] neg_hi:[0,1]
v_pk_add_f32 v[190:191],v[206:207],s[78:79] op_sel_hi:[1,0] neg_lo:[0,1] neg_hi:[0,1]
v_pk_add_f32 v[192:193],v[184:185],v[186:187]
v_pk_mul_f32 v[194:195],v[184:185],v[184:185]
v_pk_add_f32 v[196:197],v[188:189],v[190:191]
v_pk_fma_f32 v[194:195],v[186:187],v[186:187],v[194:195]
v_pk_add_f32 v[192:193],v[192:193],v[196:197]
v_pk_fma_f32 v[194:195],v[188:189],v[188:189],v[194:195]
v_add_f32 v192,v192,v193
v_pk_fma_f32 v[194:195],v[190:191],v[190:191],v[194:195]
v_add_f32 v194,v194,v195
s_nop 1
v_permlane32_swap_b32 v192,v194
v_add_f32 v192,v192,v194
s_nop 1
v_add_f32_dpp v192,v192,v192 row_ror:8 row_mask:0xf bank_mask:0xf
s_nop 1
v_add_f32_dpp v192,v192,v192 row_ror:4 row_mask:0xf bank_mask:0xf
s_nop 1
v_add_f32_dpp v192,v192,v192 row_ror:2 row_mask:0xf bank_mask:0xf
s_nop 1
v_add_f32_dpp v192,v192,v192 row_ror:1 row_mask:0xf bank_mask:0xf
v_mov_b32 v194,v192
s_nop 1
v_permlane16_swap_b32 v192,v194
v_add_f32 v192,v192,v194
v_mul_f32 v192,0x3b000000,v192
v_mov_b32 v194,v192
s_nop 1
v_permlane32_swap_b32 v192,v194
v_fma_f32 v194,-v192,v192,v194
v_add_f32 v192,s78,v192
v_max_f32 v194,0,v194
v_cvt_pk_bf16_f32 v194,v192,v194
v_lshlrev_b32 v192,16,v194
v_and_b32 v194,0xffff0000,v194
v_add_f32 v194,0x3727c5ac,v194
v_cvt_pk_bf16_f32 v194,v194,v194
v_and_b32 v194,0xffff0000,v194
v_sqrt_f32 v194,v194
v_pk_add_f32 v[184:185],v[200:201],v[192:193] op_sel_hi:[1,0] neg_lo:[0,1] neg_hi:[0,1]
v_pk_add_f32 v[186:187],v[202:203],v[192:193] op_sel_hi:[1,0] neg_lo:[0,1] neg_hi:[0,1]
v_pk_add_f32 v[188:189],v[204:205],v[192:193] op_sel_hi:[1,0] neg_lo:[0,1] neg_hi:[0,1]
v_pk_add_f32 v[190:191],v[206:207],v[192:193] op_sel_hi:[1,0] neg_lo:[0,1] neg_hi:[0,1]
v_cvt_pk_bf16_f32 v194,v194,v194
v_and_b32 v194,0xffff0000,v194
v_rcp_f32 v194,v194
v_cvt_pk_bf16_f32 v172,v184,v185
v_cvt_pk_bf16_f32 v173,v186,v187
v_cvt_pk_bf16_f32 v174,v188,v189
v_cvt_pk_bf16_f32 v175,v190,v191
v_lshlrev_b32 v184,16,v172
v_and_b32 v185,0xffff0000,v172
v_lshlrev_b32 v186,16,v173
v_and_b32 v187,0xffff0000,v173
v_lshlrev_b32 v188,16,v174
v_and_b32 v189,0xffff0000,v174
v_lshlrev_b32 v190,16,v175
v_and_b32 v191,0xffff0000,v175
v_pk_mul_f32 v[184:185],v[184:185],v[194:195] op_sel_hi:[1,0]
v_pk_mul_f32 v[186:187],v[186:187],v[194:195] op_sel_hi:[1,0]
v_pk_mul_f32 v[188:189],v[188:189],v[194:195] op_sel_hi:[1,0]
v_pk_mul_f32 v[190:191],v[190:191],v[194:195] op_sel_hi:[1,0]
v_cvt_pk_bf16_f32 v172,v184,v185
v_cvt_pk_bf16_f32 v173,v186,v187
v_cvt_pk_bf16_f32 v174,v188,v189
v_cvt_pk_bf16_f32 v175,v190,v191
v_lshlrev_b32 v176,16,v172
v_and_b32 v177,0xffff0000,v172
v_lshlrev_b32 v178,16,v173
v_and_b32 v179,0xffff0000,v173
v_lshlrev_b32 v180,16,v174
v_and_b32 v181,0xffff0000,v174
v_lshlrev_b32 v182,16,v175
v_and_b32 v183,0xffff0000,v175
v_pk_add_f32 v[200:201],v[200:201],v[176:177]
v_pk_add_f32 v[202:203],v[202:203],v[178:179]
v_pk_add_f32 v[204:205],v[204:205],v[180:181]
v_pk_add_f32 v[206:207],v[206:207],v[182:183]
v_cvt_pk_bf16_f32 v160,v200,v201
v_cvt_pk_bf16_f32 v161,v202,v203
v_cvt_pk_bf16_f32 v162,v204,v205
v_cvt_pk_bf16_f32 v163,v206,v207
buffer_store_dwordx4 v[160:163],v0,s[8:11],s20 offen sc1
v_lshlrev_b32 v200,16,v160
v_and_b32 v201,0xffff0000,v160
v_lshlrev_b32 v202,16,v161
v_and_b32 v203,0xffff0000,v161
v_lshlrev_b32 v204,16,v162
v_and_b32 v205,0xffff0000,v162
v_lshlrev_b32 v206,16,v163
v_and_b32 v207,0xffff0000,v163
v_readfirstlane_b32 s78,v200
s_nop 1
v_pk_add_f32 v[184:185],v[200:201],s[78:79] op_sel_hi:[1,0] neg_lo:[0,1] neg_hi:[0,1]
v_pk_add_f32 v[186:187],v[202:203],s[78:79] op_sel_hi:[1,0] neg_lo:[0,1] neg_hi:[0,1]
v_pk_add_f32 v[188:189],v[204:205],s[78:79] op_sel_hi:[1,0] neg_lo:[0,1] neg_hi:[0,1]
v_pk_add_f32 v[190:191],v[206:207],s[78:79] op_sel_hi:[1,0] neg_lo:[0,1] neg_hi:[0,1]
v_pk_add_f32 v[192:193],v[184:185],v[186:187]
v_pk_mul_f32 v[194:195],v[184:185],v[184:185]
v_pk_add_f32 v[196:197],v[188:189],v[190:191]
v_pk_fma_f32 v[194:195],v[186:187],v[186:187],v[194:195]
v_pk_add_f32 v[192:193],v[192:193],v[196:197]
v_pk_fma_f32 v[194:195],v[188:189],v[188:189],v[194:195]
v_add_f32 v192,v192,v193
v_pk_fma_f32 v[194:195],v[190:191],v[190:191],v[194:195]
v_add_f32 v194,v194,v195
s_nop 1
v_permlane32_swap_b32 v192,v194
v_add_f32 v192,v192,v194
s_nop 1
v_add_f32_dpp v192,v192,v192 row_ror:8 row_mask:0xf bank_mask:0xf
s_nop 1
v_add_f32_dpp v192,v192,v192 row_ror:4 row_mask:0xf bank_mask:0xf
s_nop 1
v_add_f32_dpp v192,v192,v192 row_ror:2 row_mask:0xf bank_mask:0xf
s_nop 1
v_add_f32_dpp v192,v192,v192 row_ror:1 row_mask:0xf bank_mask:0xf
v_mov_b32 v194,v192
s_nop 1
v_permlane16_swap_b32 v192,v194
v_add_f32 v192,v192,v194
v_mul_f32 v192,0x3b000000,v192
v_mov_b32 v194,v192
s_nop 1
v_permlane32_swap_b32 v192,v194
v_fma_f32 v194,-v192,v192,v194
v_add_f32 v192,s78,v192
v_max_f32 v194,0,v194
v_cvt_pk_bf16_f32 v194,v192,v194
v_lshlrev_b32 v192,16,v194
v_and_b32 v194,0xffff0000,v194
v_add_f32 v194,0x3727c5ac,v194
v_cvt_pk_bf16_f32 v194,v194,v194
v_and_b32 v194,0xffff0000,v194
v_sqrt_f32 v194,v194
v_pk_add_f32 v[184:185],v[200:201],v[192:193] op_sel_hi:[1,0] neg_lo:[0,1] neg_hi:[0,1]
v_pk_add_f32 v[186:187],v[202:203],v[192:193] op_sel_hi:[1,0] neg_lo:[0,1] neg_hi:[0,1]
v_pk_add_f32 v[188:189],v[204:205],v[192:193] op_sel_hi:[1,0] neg_lo:[0,1] neg_hi:[0,1]
v_pk_add_f32 v[190:191],v[206:207],v[192:193] op_sel_hi:[1,0] neg_lo:[0,1] neg_hi:[0,1]
v_cvt_pk_bf16_f32 v194,v194,v194
v_and_b32 v194,0xffff0000,v194
v_rcp_f32 v194,v194
v_cvt_pk_bf16_f32 v164,v184,v185
v_cvt_pk_bf16_f32 v165,v186,v187
v_cvt_pk_bf16_f32 v166,v188,v189
v_cvt_pk_bf16_f32 v167,v190,v191
v_lshlrev_b32 v184,16,v164
v_and_b32 v185,0xffff0000,v164
v_lshlrev_b32 v186,16,v165
v_and_b32 v187,0xffff0000,v165
v_lshlrev_b32 v188,16,v166
v_and_b32 v189,0xffff0000,v166
v_lshlrev_b32 v190,16,v167
v_and_b32 v191,0xffff0000,v167
v_pk_mul_f32 v[184:185],v[184:185],v[194:195] op_sel_hi:[1,0]
v_pk_mul_f32 v[186:187],v[186:187],v[194:195] op_sel_hi:[1,0]
v_pk_mul_f32 v[188:189],v[188:189],v[194:195] op_sel_hi:[1,0]
v_pk_mul_f32 v[190:191],v[190:191],v[194:195] op_sel_hi:[1,0]
v_cvt_pk_bf16_f32 v164,v184,v185
v_cvt_pk_bf16_f32 v165,v186,v187
v_cvt_pk_bf16_f32 v166,v188,v189
v_cvt_pk_bf16_f32 v167,v190,v191
s_add_u32 s20,s19,2097152
buffer_store_dwordx4 v[164:167],v0,s[8:11],s20 offen sc1
v_mov_b32 v20,1
s_lshl_b32 s73,s51,13
s_lshl2_add_u32 s73,s68,s73
s_add_u32 s73,s73,10487552
s_branch L_aa_43
L_ar_71:
ds_read_b128 v[160:163],v23
ds_read_b128 v[164:167],v23 offset:16
v_lshlrev_b32 v200,16,v224
v_and_b32 v201,0xffff0000,v224
v_lshlrev_b32 v202,16,v225
v_and_b32 v203,0xffff0000,v225
v_lshlrev_b32 v204,16,v226
v_and_b32 v205,0xffff0000,v226
v_lshlrev_b32 v206,16,v227
v_and_b32 v207,0xffff0000,v227
s_lshl_b32 s18,s51,5
s_add_u32 s18,s18,s68
s_lshl_b32 s19,s18,10
s_add_u32 s20,s19,4194304
s_waitcnt lgkmcnt(0)
v_cvt_pk_bf16_f32 v168,v160,v161
v_cvt_pk_bf16_f32 v169,v162,v163
v_cvt_pk_bf16_f32 v170,v164,v165
v_cvt_pk_bf16_f32 v171,v166,v167
v_lshlrev_b32 v160,16,v168
v_and_b32 v161,0xffff0000,v168
v_lshlrev_b32 v162,16,v169
v_and_b32 v163,0xffff0000,v169
v_lshlrev_b32 v164,16,v170
v_and_b32 v165,0xffff0000,v170
v_lshlrev_b32 v166,16,v171
v_and_b32 v167,0xffff0000,v171
v_pk_add_f32 v[200:201],v[200:201],v[160:161]
v_pk_add_f32 v[202:203],v[202:203],v[162:163]
v_pk_add_f32 v[204:205],v[204:205],v[164:165]
v_pk_add_f32 v[206:207],v[206:207],v[166:167]
v_cvt_pk_bf16_f32 v168,v200,v201
v_cvt_pk_bf16_f32 v169,v202,v203
v_cvt_pk_bf16_f32 v170,v204,v205
v_cvt_pk_bf16_f32 v171,v206,v207
buffer_store_dwordx4 v[168:171],v0,s[8:11],s20 offen sc1
v_lshlrev_b32 v200,16,v168
v_and_b32 v201,0xffff0000,v168
v_lshlrev_b32 v202,16,v169
v_and_b32 v203,0xffff0000,v169
v_lshlrev_b32 v204,16,v170
v_and_b32 v205,0xffff0000,v170
v_lshlrev_b32 v206,16,v171
v_and_b32 v207,0xffff0000,v171
v_readfirstlane_b32 s78,v200
s_nop 1
v_pk_add_f32 v[184:185],v[200:201],s[78:79] op_sel_hi:[1,0] neg_lo:[0,1] neg_hi:[0,1]
v_pk_add_f32 v[186:187],v[202:203],s[78:79] op_sel_hi:[1,0] neg_lo:[0,1] neg_hi:[0,1]
v_pk_add_f32 v[188:189],v[204:205],s[78:79] op_sel_hi:[1,0] neg_lo:[0,1] neg_hi:[0,1]
v_pk_add_f32 v[190:191],v[206:207],s[78:79] op_sel_hi:[1,0] neg_lo:[0,1] neg_hi:[0,1]
v_pk_add_f32 v[192:193],v[184:185],v[186:187]
v_pk_mul_f32 v[194:195],v[184:185],v[184:185]
v_pk_add_f32 v[196:197],v[188:189],v[190:191]
v_pk_fma_f32 v[194:195],v[186:187],v[186:187],v[194:195]
v_pk_add_f32 v[192:193],v[192:193],v[196:197]
v_pk_fma_f32 v[194:195],v[188:189],v[188:189],v[194:195]
v_add_f32 v192,v192,v193
v_pk_fma_f32 v[194:195],v[190:191],v[190:191],v[194:195]
v_add_f32 v194,v194,v195
s_nop 1
v_permlane32_swap_b32 v192,v194
v_add_f32 v192,v192,v194
s_nop 1
v_add_f32_dpp v192,v192,v192 row_ror:8 row_mask:0xf bank_mask:0xf
s_nop 1
v_add_f32_dpp v192,v192,v192 row_ror:4 row_mask:0xf bank_mask:0xf
s_nop 1
v_add_f32_dpp v192,v192,v192 row_ror:2 row_mask:0xf bank_mask:0xf
s_nop 1
v_add_f32_dpp v192,v192,v192 row_ror:1 row_mask:0xf bank_mask:0xf
v_mov_b32 v194,v192
s_nop 1
v_permlane16_swap_b32 v192,v194
v_add_f32 v192,v192,v194
v_mul_f32 v192,0x3b000000,v192
v_mov_b32 v194,v192
s_nop 1
v_permlane32_swap_b32 v192,v194
v_fma_f32 v194,-v192,v192,v194
v_add_f32 v192,s78,v192
v_max_f32 v194,0,v194
v_cvt_pk_bf16_f32 v194,v192,v194
v_lshlrev_b32 v192,16,v194
v_and_b32 v194,0xffff0000,v194
v_add_f32 v194,0x3727c5ac,v194
v_cvt_pk_bf16_f32 v194,v194,v194
v_and_b32 v194,0xffff0000,v194
v_sqrt_f32 v194,v194
v_pk_add_f32 v[184:185],v[200:201],v[192:193] op_sel_hi:[1,0] neg_lo:[0,1] neg_hi:[0,1]
v_pk_add_f32 v[186:187],v[202:203],v[192:193] op_sel_hi:[1,0] neg_lo:[0,1] neg_hi:[0,1]
v_pk_add_f32 v[188:189],v[204:205],v[192:193] op_sel_hi:[1,0] neg_lo:[0,1] neg_hi:[0,1]
v_pk_add_f32 v[190:191],v[206:207],v[192:193] op_sel_hi:[1,0] neg_lo:[0,1] neg_hi:[0,1]
v_cvt_pk_bf16_f32 v194,v194,v194
v_and_b32 v194,0xffff0000,v194
v_rcp_f32 v194,v194
v_cvt_pk_bf16_f32 v172,v184,v185
v_cvt_pk_bf16_f32 v173,v186,v187
v_cvt_pk_bf16_f32 v174,v188,v189
v_cvt_pk_bf16_f32 v175,v190,v191
v_lshlrev_b32 v184,16,v172
v_and_b32 v185,0xffff0000,v172
v_lshlrev_b32 v186,16,v173
v_and_b32 v187,0xffff0000,v173
v_lshlrev_b32 v188,16,v174
v_and_b32 v189,0xffff0000,v174
v_lshlrev_b32 v190,16,v175
v_and_b32 v191,0xffff0000,v175
v_pk_mul_f32 v[184:185],v[184:185],v[194:195] op_sel_hi:[1,0]
v_pk_mul_f32 v[186:187],v[186:187],v[194:195] op_sel_hi:[1,0]
v_pk_mul_f32 v[188:189],v[188:189],v[194:195] op_sel_hi:[1,0]
v_pk_mul_f32 v[190:191],v[190:191],v[194:195] op_sel_hi:[1,0]
v_cvt_pk_bf16_f32 v172,v184,v185
v_cvt_pk_bf16_f32 v173,v186,v187
v_cvt_pk_bf16_f32 v174,v188,v189
v_cvt_pk_bf16_f32 v175,v190,v191
v_lshlrev_b32 v176,16,v172
v_and_b32 v177,0xffff0000,v172
v_lshlrev_b32 v178,16,v173
v_and_b32 v179,0xffff0000,v173
v_lshlrev_b32 v180,16,v174
v_and_b32 v181,0xffff0000,v174
v_lshlrev_b32 v182,16,v175
v_and_b32 v183,0xffff0000,v175
v_pk_mul_f32 v[236:237],v[176:177],v[228:229]
v_pk_fma_f32 v[236:237],v[178:179],v[230:231],v[236:237]
v_pk_fma_f32 v[236:237],v[180:181],v[232:233],v[236:237]
v_pk_fma_f32 v[236:237],v[182:183],v[234:235],v[236:237]
v_add_f32 v236,v236,v237
s_nop 1
v_add_f32_dpp v236,v236,v236 row_ror:8 row_mask:0xf bank_mask:0xf
s_nop 1
v_add_f32_dpp v236,v236,v236 row_ror:4 row_mask:0xf bank_mask:0xf
s_nop 1
v_add_f32_dpp v236,v236,v236 row_ror:2 row_mask:0xf bank_mask:0xf
s_nop 1
v_add_f32_dpp v236,v236,v236 row_ror:1 row_mask:0xf bank_mask:0xf
v_mov_b32 v237,v236
s_nop 1
v_permlane16_swap_b32 v236,v237
v_add_f32 v236,v236,v237
v_mov_b32 v237,v236
s_nop 1
v_permlane32_swap_b32 v236,v237
v_add_f32 v236,v236,v237
v_cvt_pk_bf16_f32 v236,v236,v236
v_and_b32 v236,0xffff0000,v236
v_ashrrev_i32 v237,31,v236
v_or_b32 v237,0x80000000,v237
v_xor_b32 v236,v236,v237
v_and_b32 v236,0xffff0000,v236
s_sub_u32 s20,4095,s18
v_or_b32 v20,s20,v236
s_lshl_b32 s20,s51,13
s_lshl2_add_u32 s20,s68,s20
s_add_u32 s20,s20,10487168
buffer_store_dword v20,off,s[8:11],s20 sc1
s_branch L_aa_43
L_ar_72:
s_bitcmp1_b32 s46,0
s_cbranch_scc1 L_aa_43
ds_read_b128 v[160:163],v23
ds_read_b128 v[164:167],v23 offset:16
v_lshlrev_b32 v200,16,v224
v_and_b32 v201,0xffff0000,v224
v_lshlrev_b32 v202,16,v225
v_and_b32 v203,0xffff0000,v225
v_lshlrev_b32 v204,16,v226
v_and_b32 v205,0xffff0000,v226
v_lshlrev_b32 v206,16,v227
v_and_b32 v207,0xffff0000,v227
v_readfirstlane_b32 s22,v246
s_cmp_eq_u32 s22,0
s_cbranch_scc1 L_ag_73
L_agb_74:
s_lshl_b32 s18,s51,5
s_add_u32 s18,s18,s68
s_lshl_b32 s19,s18,10
s_add_u32 s20,s19,6291456
s_waitcnt lgkmcnt(0)
v_cvt_pk_bf16_f32 v168,v160,v161
v_cvt_pk_bf16_f32 v169,v162,v163
v_cvt_pk_bf16_f32 v170,v164,v165
v_cvt_pk_bf16_f32 v171,v166,v167
v_lshlrev_b32 v160,16,v168
v_and_b32 v161,0xffff0000,v168
v_lshlrev_b32 v162,16,v169
v_and_b32 v163,0xffff0000,v169
v_lshlrev_b32 v164,16,v170
v_and_b32 v165,0xffff0000,v170
v_lshlrev_b32 v166,16,v171
v_and_b32 v167,0xffff0000,v171
v_pk_add_f32 v[200:201],v[200:201],v[160:161]
v_pk_add_f32 v[202:203],v[202:203],v[162:163]
v_pk_add_f32 v[204:205],v[204:205],v[164:165]
v_pk_add_f32 v[206:207],v[206:207],v[166:167]
v_cvt_pk_bf16_f32 v168,v200,v201
v_cvt_pk_bf16_f32 v169,v202,v203
v_cvt_pk_bf16_f32 v170,v204,v205
v_cvt_pk_bf16_f32 v171,v206,v207
buffer_store_dwordx4 v[168:171],v0,s[8:11],s20 offen sc1
v_lshlrev_b32 v200,16,v168
v_and_b32 v201,0xffff0000,v168
v_lshlrev_b32 v202,16,v169
v_and_b32 v203,0xffff0000,v169
v_lshlrev_b32 v204,16,v170
v_and_b32 v205,0xffff0000,v170
v_lshlrev_b32 v206,16,v171
v_and_b32 v207,0xffff0000,v171
v_readfirstlane_b32 s78,v200
s_nop 1
v_pk_add_f32 v[184:185],v[200:201],s[78:79] op_sel_hi:[1,0] neg_lo:[0,1] neg_hi:[0,1]
v_pk_add_f32 v[186:187],v[202:203],s[78:79] op_sel_hi:[1,0] neg_lo:[0,1] neg_hi:[0,1]
v_pk_add_f32 v[188:189],v[204:205],s[78:79] op_sel_hi:[1,0] neg_lo:[0,1] neg_hi:[0,1]
v_pk_add_f32 v[190:191],v[206:207],s[78:79] op_sel_hi:[1,0] neg_lo:[0,1] neg_hi:[0,1]
v_pk_add_f32 v[192:193],v[184:185],v[186:187]
v_pk_mul_f32 v[194:195],v[184:185],v[184:185]
v_pk_add_f32 v[196:197],v[188:189],v[190:191]
v_pk_fma_f32 v[194:195],v[186:187],v[186:187],v[194:195]
v_pk_add_f32 v[192:193],v[192:193],v[196:197]
v_pk_fma_f32 v[194:195],v[188:189],v[188:189],v[194:195]
v_add_f32 v192,v192,v193
v_pk_fma_f32 v[194:195],v[190:191],v[190:191],v[194:195]
v_add_f32 v194,v194,v195
s_nop 1
v_permlane32_swap_b32 v192,v194
v_add_f32 v192,v192,v194
s_nop 1
v_add_f32_dpp v192,v192,v192 row_ror:8 row_mask:0xf bank_mask:0xf
s_nop 1
v_add_f32_dpp v192,v192,v192 row_ror:4 row_mask:0xf bank_mask:0xf
s_nop 1
v_add_f32_dpp v192,v192,v192 row_ror:2 row_mask:0xf bank_mask:0xf
s_nop 1
v_add_f32_dpp v192,v192,v192 row_ror:1 row_mask:0xf bank_mask:0xf
v_mov_b32 v194,v192
s_nop 1
v_permlane16_swap_b32 v192,v194
v_add_f32 v192,v192,v194
v_mul_f32 v192,0x3b000000,v192
v_mov_b32 v194,v192
s_nop 1
v_permlane32_swap_b32 v192,v194
v_fma_f32 v194,-v192,v192,v194
v_add_f32 v192,s78,v192
v_max_f32 v194,0,v194
v_cvt_pk_bf16_f32 v194,v192,v194
v_lshlrev_b32 v192,16,v194
v_and_b32 v194,0xffff0000,v194
v_add_f32 v194,0x3727c5ac,v194
v_cvt_pk_bf16_f32 v194,v194,v194
v_and_b32 v194,0xffff0000,v194
v_sqrt_f32 v194,v194
v_pk_add_f32 v[184:185],v[200:201],v[192:193] op_sel_hi:[1,0] neg_lo:[0,1] neg_hi:[0,1]
v_pk_add_f32 v[186:187],v[202:203],v[192:193] op_sel_hi:[1,0] neg_lo:[0,1] neg_hi:[0,1]
v_pk_add_f32 v[188:189],v[204:205],v[192:193] op_sel_hi:[1,0] neg_lo:[0,1] neg_hi:[0,1]
v_pk_add_f32 v[190:191],v[206:207],v[192:193] op_sel_hi:[1,0] neg_lo:[0,1] neg_hi:[0,1]
v_cvt_pk_bf16_f32 v194,v194,v194
v_and_b32 v194,0xffff0000,v194
v_rcp_f32 v194,v194
v_cvt_pk_bf16_f32 v172,v184,v185
v_cvt_pk_bf16_f32 v173,v186,v187
v_cvt_pk_bf16_f32 v174,v188,v189
v_cvt_pk_bf16_f32 v175,v190,v191
v_lshlrev_b32 v184,16,v172
v_and_b32 v185,0xffff0000,v172
v_lshlrev_b32 v186,16,v173
v_and_b32 v187,0xffff0000,v173
v_lshlrev_b32 v188,16,v174
v_and_b32 v189,0xffff0000,v174
v_lshlrev_b32 v190,16,v175
v_and_b32 v191,0xffff0000,v175
v_pk_mul_f32 v[184:185],v[184:185],v[194:195] op_sel_hi:[1,0]
v_pk_mul_f32 v[186:187],v[186:187],v[194:195] op_sel_hi:[1,0]
v_pk_mul_f32 v[188:189],v[188:189],v[194:195] op_sel_hi:[1,0]
v_pk_mul_f32 v[190:191],v[190:191],v[194:195] op_sel_hi:[1,0]
v_cvt_pk_bf16_f32 v172,v184,v185
v_cvt_pk_bf16_f32 v173,v186,v187
v_cvt_pk_bf16_f32 v174,v188,v189
v_cvt_pk_bf16_f32 v175,v190,v191
v_lshlrev_b32 v176,16,v172
v_and_b32 v177,0xffff0000,v172
v_lshlrev_b32 v178,16,v173
v_and_b32 v179,0xffff0000,v173
v_lshlrev_b32 v180,16,v174
v_and_b32 v181,0xffff0000,v174
v_lshlrev_b32 v182,16,v175
v_and_b32 v183,0xffff0000,v175
v_pk_add_f32 v[200:201],v[200:201],v[176:177]
v_pk_add_f32 v[202:203],v[202:203],v[178:179]
v_pk_add_f32 v[204:205],v[204:205],v[180:181]
v_pk_add_f32 v[206:207],v[206:207],v[182:183]
v_cvt_pk_bf16_f32 v160,v200,v201
v_cvt_pk_bf16_f32 v161,v202,v203
v_cvt_pk_bf16_f32 v162,v204,v205
v_cvt_pk_bf16_f32 v163,v206,v207
buffer_store_dwordx4 v[160:163],v0,s[12:15],s19 offen sc1
v_pk_mul_f32 v[236:237],v[176:177],v[228:229]
v_pk_fma_f32 v[236:237],v[178:179],v[230:231],v[236:237]
v_pk_fma_f32 v[236:237],v[180:181],v[232:233],v[236:237]
v_pk_fma_f32 v[236:237],v[182:183],v[234:235],v[236:237]
v_add_f32 v236,v236,v237
s_nop 1
v_add_f32_dpp v236,v236,v236 row_ror:8 row_mask:0xf bank_mask:0xf
s_nop 1
v_add_f32_dpp v236,v236,v236 row_ror:4 row_mask:0xf bank_mask:0xf
s_nop 1
v_add_f32_dpp v236,v236,v236 row_ror:2 row_mask:0xf bank_mask:0xf
s_nop 1
v_add_f32_dpp v236,v236,v236 row_ror:1 row_mask:0xf bank_mask:0xf
v_mov_b32 v237,v236
s_nop 1
v_permlane16_swap_b32 v236,v237
v_add_f32 v236,v236,v237
v_mov_b32 v237,v236
s_nop 1
v_permlane32_swap_b32 v236,v237
v_add_f32 v236,v236,v237
v_cvt_pk_bf16_f32 v236,v236,v236
v_and_b32 v236,0xffff0000,v236
v_ashrrev_i32 v237,31,v236
v_or_b32 v237,0x80000000,v237
v_xor_b32 v236,v236,v237
v_and_b32 v236,0xffff0000,v236
s_sub_u32 s20,4095,s18
v_or_b32 v20,s20,v236
s_lshl_b32 s73,s51,13
s_lshl2_add_u32 s73,s68,s73
s_add_u32 s73,s73,10485760
s_add_u32 s73,s73,s86
L_aa_43:
s_cmp_eq_u32 s27,0
s_cbranch_scc1 L_aa_44
s_cmp_ge_u32 s77,64
s_cbranch_scc1 L_aa_47
L_aa_45:
s_waitcnt vmcnt(0)
buffer_store_dword v20,off,s[8:11],s73 sc1
s_mov_b32 s73,0x80000000
v_mov_b32 v18,0
L_aw_76:
v_cmp_eq_u32 vcc,0,v18
s_cbranch_vccz L_awd_77
buffer_load_dword v18,v19,s[8:11],0 offen sc1
s_sub_u32 s49,s49,1
s_cbranch_scc1 L_abort
s_waitcnt vmcnt(0)
s_branch L_aw_76
L_awd_77:
s_mov_b32 s64,s70
s_mov_b32 s65,s71
s_and_b32 s57,s46,1
s_mul_i32 s58,s57,12288
s_add_u32 s64,s64,s58
s_lshl_b32 s57,s57,12
s_add_u32 s65,s65,s57
s_and_b32 s59,s50,2048
s_lshl_b32 s59,s59,4
s_xor_b32 s60,s67,65536
s_add_u32 s59,s59,s60
s_add_u32 s58,s58,s59
s_add_u32 s57,s57,s59
s_add_u32 m0,s58,0
s_nop 0
buffer_load_dwordx4 v0,s[8:11],s64 offen offset:0 sc1 lds
buffer_load_dwordx4 v0,s[8:11],s64 offen offset:1024 sc1 lds
buffer_load_dwordx4 v0,s[8:11],s64 offen offset:2048 sc1 lds
buffer_load_dwordx4 v0,s[8:11],s64 offen offset:3072 sc1 lds
s_add_u32 m0,s58,4096
s_add_u32 s64,s64,4096
buffer_load_dwordx4 v0,s[8:11],s64 offen offset:0 sc1 lds
buffer_load_dwordx4 v0,s[8:11],s64 offen offset:1024 sc1 lds
buffer_load_dwordx4 v0,s[8:11],s64 offen offset:2048 sc1 lds
buffer_load_dwordx4 v0,s[8:11],s64 offen offset:3072 sc1 lds
s_add_u32 m0,s58,8192
s_add_u32 s64,s64,4096
buffer_load_dwordx4 v0,s[8:11],s64 offen offset:0 sc1 lds
buffer_load_dwordx4 v0,s[8:11],s64 offen offset:1024 sc1 lds
buffer_load_dwordx4 v0,s[8:11],s64 offen offset:2048 sc1 lds
buffer_load_dwordx4 v0,s[8:11],s64 offen offset:3072 sc1 lds
s_add_u32 m0,s57,24576
s_nop 0
buffer_load_dwordx4 v0,s[8:11],s65 offen offset:0 sc1 lds
buffer_load_dwordx4 v0,s[8:11],s65 offen offset:1024 sc1 lds
buffer_load_dwordx4 v0,s[8:11],s65 offen offset:2048 sc1 lds
buffer_load_dwordx4 v0,s[8:11],s65 offen offset:3072 sc1 lds
v_lshrrev_b32 v244,4,v1
s_sub_u32 s56,s77,8
v_add_u32 v244,s56,v244
v_max_i32 v244,0,v244
v_lshl_add_u32 v244,v244,13,v21
buffer_load_dwordx2 v[242:243],v244,s[8:11],0 offen sc1
s_waitcnt vmcnt(0) lgkmcnt(0)
s_barrier
s_xor_b32 s67,s67,65536
s_and_b32 s56,s50,2048
s_lshl_b32 s56,s56,4
s_add_u32 s56,s56,s67
v_add_u32 v2,s56,v0
s_and_b32 s56,s50,1024
s_lshl_b32 s56,s56,2
v_add_u32 v238,s56,v2
s_mov_b32 s76,s71
s_mov_b32 s53,s77
ds_read_b128 v[24:27],v238 offset:16384
ds_read_b128 v[40:43],v2 offset:0
ds_read_b128 v[56:59],v2 offset:4096
ds_read_b128 v[28:31],v238 offset:17408
ds_read_b128 v[44:47],v2 offset:1024
ds_read_b128 v[60:63],v2 offset:5120
ds_read_b128 v[32:35],v238 offset:18432
ds_read_b128 v[48:51],v2 offset:2048
ds_read_b128 v[64:67],v2 offset:6144
ds_read_b128 v[36:39],v238 offset:19456
ds_read_b128 v[52:55],v2 offset:3072
ds_read_b128 v[68:71],v2 offset:7168
s_waitcnt lgkmcnt(9)
v_mfma_f32_16x16x32_bf16 v[128:131],v[40:43],v[24:27],v[8:11]
ds_read_b128 v[72:75],v2 offset:24576
v_mfma_f32_16x16x32_bf16 v[132:135],v[56:59],v[24:27],v[12:15]
ds_read_b128 v[76:79],v2 offset:25600
s_waitcnt lgkmcnt(8)
v_mfma_f32_16x16x32_bf16 v[128:131],v[44:47],v[28:31],v[128:131]
ds_read_b128 v[80:83],v2 offset:26624
v_mfma_f32_16x16x32_bf16 v[132:135],v[60:63],v[28:31],v[132:135]
ds_read_b128 v[84:87],v2 offset:27648
s_waitcnt lgkmcnt(7)
v_mfma_f32_16x16x32_bf16 v[128:131],v[48:51],v[32:35],v[128:131]
ds_read_b64 v[120:121],v2 offset:28672
v_mfma_f32_16x16x32_bf16 v[132:135],v[64:67],v[32:35],v[132:135]
ds_read_b64 v[122:123],v2 offset:29696
s_waitcnt lgkmcnt(6)
v_mfma_f32_16x16x32_bf16 v[128:131],v[52:55],v[36:39],v[128:131]
ds_read_b64 v[124:125],v2 offset:30720
v_mfma_f32_16x16x32_bf16 v[132:135],v[68:71],v[36:39],v[132:135]
ds_read_b64 v[126:127],v2 offset:31744
s_waitcnt lgkmcnt(4)
v_mfma_f32_16x16x32_bf16 v[136:139],v[72:75],v[24:27],0
ds_read_b128 v[88:91],v2 offset:8192
ds_read_b128 v[92:95],v2 offset:9216
v_mfma_f32_16x16x32_bf16 v[136:139],v[76:79],v[28:31],v[136:139]
ds_read_b128 v[96:99],v2 offset:10240
ds_read_b128 v[100:103],v2 offset:11264
v_mfma_f32_16x16x32_bf16 v[136:139],v[80:83],v[32:35],v[136:139]
ds_read_b128 v[104:107],v2 offset:12288
ds_read_b128 v[108:111],v2 offset:13312
v_mfma_f32_16x16x32_bf16 v[136:139],v[84:87],v[36:39],v[136:139]
ds_read_b128 v[112:115],v2 offset:14336
ds_read_b128 v[116:119],v2 offset:15360
s_waitcnt lgkmcnt(0)
s_cmp_eq_u32 s30,0
s_cbranch_scc1 L_aa_46
s_cmp_lg_u32 s86,1536
s_cbranch_scc1 L_ae_78
s_add_u32 s77,s53,13
s_mov_b32 s30,0
s_lshl_b32 s56,s77,5
s_add_u32 s56,s56,s68
s_mul_i32 s70,s56,24576
s_lshl_b32 s71,s56,13
s_lshl_b32 s59,s77,13
s_lshl2_add_u32 s59,s68,s59
s_add_u32 s59,s59,10485760
s_buffer_load_dword s32,s[8:11],s59 glc
s_mov_b32 s33,1
s_add_u32 s70,s70,100663296
s_add_u32 s71,s71,41943040
v_mov_b32 v19,s59
s_branch L_af_79
L_ae_78:
s_ff1_i32_b64 s77,s[84:85]
s_bitset0_b64 s[84:85],s77
s_ff1_i32_b64 s77,s[84:85]
s_bitset0_b64 s[84:85],s77
s_ff1_i32_b64 s77,s[84:85]
s_bitset0_b64 s[84:85],s77
s_ff1_i32_b64 s77,s[84:85]
s_bitset0_b64 s[84:85],s77
s_ff1_i32_b64 s77,s[84:85]
s_bitset0_b64 s[84:85],s77
s_ff1_i32_b64 s77,s[84:85]
s_bitset0_b64 s[84:85],s77
s_min_u32 s77,s77,64
s_lshr_b32 s61,s55,5
s_lshl_b32 s56,s77,5
s_add_u32 s56,s56,s68
s_mul_i32 s70,s56,24576
s_lshl_b32 s71,s56,13
s_lshl_b32 s59,s77,13
s_lshl2_add_u32 s59,s68,s59
s_add_u32 s59,s59,10486144
s_cmp_lt_u32 s77,s61
s_cselect_b32 s57,0,16777216
s_cselect_b32 s60,0,128
s_add_u32 s60,s60,s59
s_add_u32 s60,s60,128
s_buffer_load_dword s33,s[8:11],s60 glc
s_add_u32 s71,s71,s57
s_add_u32 s71,s71,58720256
s_cmp_eq_u32 s77,s61
s_cselect_b32 s57,50331648,0
s_cselect_b32 s58,1536,0
s_add_u32 s59,s59,s58
s_buffer_load_dword s32,s[8:11],s59 glc
s_add_u32 s70,s70,s57
s_add_u32 s70,s70,150994944
v_mov_b32 v19,s59
v_writelane_b32 v19,s60,1
L_af_79:
v_max3_f32 v238,v128,v129,v130
v_max3_f32 v239,v131,v132,v133
v_max3_f32 v238,v134,v135,v238
v_max3_f32 v239,v138,v139,v239
v_max_f32 v238,v238,v239
v_max_f32 v239,v238,v239
s_nop 1
v_permlane16_swap_b32 v238,v239
v_max_f32 v238,v238,v239
v_max_f32 v239,v238,v239
s_nop 1
v_permlane32_swap_b32 v238,v239
v_max_f32 v238,v238,v239
v_mul_f32 v238,s80,v238
v_fma_f32 v128,v128,s80,-v238
v_fma_f32 v129,v129,s80,-v238
v_exp_f32 v128,v128
v_fma_f32 v130,v130,s80,-v238
v_exp_f32 v129,v129
v_fma_f32 v131,v131,s80,-v238
v_exp_f32 v130,v130
v_fma_f32 v132,v132,s80,-v238
v_exp_f32 v131,v131
v_fma_f32 v133,v133,s80,-v238
v_exp_f32 v132,v132
v_fma_f32 v134,v134,s80,-v238
v_exp_f32 v133,v133
v_fma_f32 v135,v135,s80,-v238
v_exp_f32 v134,v134
v_fma_f32 v138,v138,s80,-v238
v_exp_f32 v135,v135
v_fma_f32 v139,v139,s80,-v238
v_exp_f32 v138,v138
v_exp_f32 v139,v139
v_cvt_pk_bf16_f32 v140,v128,v129
v_cvt_pk_bf16_f32 v141,v130,v131
v_cvt_pk_bf16_f32 v142,v132,v133
v_cvt_pk_bf16_f32 v143,v134,v135
v_cvt_pk_bf16_f32 v144,v138,v139
v_mov_b32 v147,v144
v_mfma_f32_16x16x32_bf16 v[148:151],v[152:155],v[140:143],0
v_mfma_f32_16x16x32_bf16 v[24:27],v[88:91],v[140:143],0
v_mfma_f32_16x16x32_bf16 v[28:31],v[92:95],v[140:143],0
v_mfma_f32_16x16x16_bf16 v[148:151],v[152:153],v[144:145],v[148:151]
v_mfma_f32_16x16x32_bf16 v[32:35],v[96:99],v[140:143],0
v_mfma_f32_16x16x32_bf16 v[36:39],v[100:103],v[140:143],0
v_mfma_f32_16x16x32_bf16 v[40:43],v[104:107],v[140:143],0
v_mfma_f32_16x16x32_bf16 v[44:47],v[108:111],v[140:143],0
v_mfma_f32_16x16x32_bf16 v[48:51],v[112:115],v[140:143],0
v_mfma_f32_16x16x32_bf16 v[52:55],v[116:119],v[140:143],0
v_rcp_f32 v148,v148
v_mfma_f32_16x16x16_bf16 v[24:27],v[120:121],v[144:145],v[24:27]
v_mfma_f32_16x16x16_bf16 v[28:31],v[120:121],v[146:147],v[28:31]
v_mfma_f32_16x16x16_bf16 v[32:35],v[122:123],v[144:145],v[32:35]
v_mfma_f32_16x16x16_bf16 v[36:39],v[122:123],v[146:147],v[36:39]
v_mfma_f32_16x16x16_bf16 v[40:43],v[124:125],v[144:145],v[40:43]
v_pk_mul_f32 v[24:25],v[24:25],v[148:149] op_sel_hi:[1,0]
v_pk_mul_f32 v[26:27],v[26:27],v[148:149] op_sel_hi:[1,0]
v_mfma_f32_16x16x16_bf16 v[44:47],v[124:125],v[146:147],v[44:47]
v_pk_mul_f32 v[28:29],v[28:29],v[148:149] op_sel_hi:[1,0]
v_pk_mul_f32 v[30:31],v[30:31],v[148:149] op_sel_hi:[1,0]
v_mfma_f32_16x16x16_bf16 v[48:51],v[126:127],v[144:145],v[48:51]
v_cvt_pk_bf16_f32 v72,v24,v28
v_cvt_pk_bf16_f32 v73,v25,v29
v_mfma_f32_16x16x16_bf16 v[52:55],v[126:127],v[146:147],v[52:55]
v_cvt_pk_bf16_f32 v74,v26,v30
v_cvt_pk_bf16_f32 v75,v27,v31
ds_write_b128 v3,v[72:75] offset:0
v_pk_mul_f32 v[32:33],v[32:33],v[148:149] op_sel_hi:[1,0]
v_pk_mul_f32 v[34:35],v[34:35],v[148:149] op_sel_hi:[1,0]
v_pk_mul_f32 v[36:37],v[36:37],v[148:149] op_sel_hi:[1,0]
v_pk_mul_f32 v[38:39],v[38:39],v[148:149] op_sel_hi:[1,0]
v_cvt_pk_bf16_f32 v76,v32,v36
v_cvt_pk_bf16_f32 v77,v33,v37
v_cvt_pk_bf16_f32 v78,v34,v38
v_cvt_pk_bf16_f32 v79,v35,v39
ds_write_b128 v3,v[76:79] offset:1024
v_pk_mul_f32 v[40:41],v[40:41],v[148:149] op_sel_hi:[1,0]
v_pk_mul_f32 v[42:43],v[42:43],v[148:149] op_sel_hi:[1,0]
v_pk_mul_f32 v[44:45],v[44:45],v[148:149] op_sel_hi:[1,0]
v_pk_mul_f32 v[46:47],v[46:47],v[148:149] op_sel_hi:[1,0]
v_cvt_pk_bf16_f32 v80,v40,v44
v_cvt_pk_bf16_f32 v81,v41,v45
v_cvt_pk_bf16_f32 v82,v42,v46
v_cvt_pk_bf16_f32 v83,v43,v47
ds_write_b128 v3,v[80:83] offset:2048
v_pk_mul_f32 v[48:49],v[48:49],v[148:149] op_sel_hi:[1,0]
v_pk_mul_f32 v[50:51],v[50:51],v[148:149] op_sel_hi:[1,0]
v_pk_mul_f32 v[52:53],v[52:53],v[148:149] op_sel_hi:[1,0]
v_pk_mul_f32 v[54:55],v[54:55],v[148:149] op_sel_hi:[1,0]
v_cvt_pk_bf16_f32 v84,v48,v52
v_cvt_pk_bf16_f32 v85,v49,v53
v_cvt_pk_bf16_f32 v86,v50,v54
v_cvt_pk_bf16_f32 v87,v51,v55
ds_write_b128 v3,v[84:87] offset:3072
s_waitcnt lgkmcnt(0)
s_barrier
L_ad_75:
s_mov_b32 s51,s53
s_mov_b32 s31,1
s_branch L_aa_38
L_aa_44:
s_waitcnt vmcnt(2)
s_bitcmp1_b32 s46,0
s_cselect_b32 s56,0,s31
s_cmp_lg_u32 s56,0
s_cbranch_scc1 L_aa_46
s_waitcnt vmcnt(0)
buffer_store_dword v20,off,s[8:11],s73 sc1
s_mov_b32 s73,0x80000000
L_aa_46:
s_mov_b32 s51,s53
s_mov_b32 s31,0
s_cmp_lt_u32 s53,5
s_cbranch_scc1 L_ab_80
L_aw_82:
v_min_u32 v239,v242,v243
v_cmp_eq_u32 vcc,0,v239
s_cbranch_vccz L_awd_83
buffer_load_dwordx2 v[242:243],v244,s[8:11],0 offen sc1
s_sub_u32 s49,s49,1
s_cbranch_scc1 L_abort
s_waitcnt vmcnt(0)
s_branch L_aw_82
L_awd_83:
v_max_u32 v242,v242,v243
s_nop 1
v_max_u32_dpp v242,v242,v242 row_ror:8 row_mask:0xf bank_mask:0xf
s_nop 1
v_max_u32_dpp v242,v242,v242 row_ror:4 row_mask:0xf bank_mask:0xf
s_nop 1
v_max_u32_dpp v242,v242,v242 row_ror:2 row_mask:0xf bank_mask:0xf
s_nop 1
v_max_u32_dpp v242,v242,v242 row_ror:1 row_mask:0xf bank_mask:0xf
v_mov_b32 v243,v242
s_nop 1
v_permlane16_swap_b32 v242,v243
v_max_u32 v242,v242,v243
v_mov_b32 v243,v242
s_nop 1
v_permlane32_swap_b32 v242,v243
v_max_u32 v242,v242,v243
s_nop 0
v_readfirstlane_b32 s56,v242
s_max_u32 s75,s75,s56
s_cmp_lt_u32 s53,9
s_cbranch_scc1 L_ab_80
s_sub_u32 s77,s53,9
s_and_b32 s55,s75,0x7ff
s_sub_u32 s55,2047,s55
s_cmp_lt_u32 s77,28
s_cselect_b32 s55,4095,s55
s_lshr_b32 s61,s55,5
s_mov_b32 s30,1
s_lshl_b32 s56,s77,5
s_add_u32 s56,s56,s68
s_mul_i32 s70,s56,24576
s_lshl_b32 s71,s56,13
s_lshl_b32 s59,s77,13
s_lshl2_add_u32 s59,s68,s59
s_add_u32 s59,s59,10486144
s_cmp_lt_u32 s77,s61
s_cselect_b32 s57,0,16777216
s_cselect_b32 s60,0,128
s_add_u32 s60,s60,s59
s_add_u32 s60,s60,128
s_add_u32 s71,s71,s57
s_add_u32 s71,s71,58720256
s_cmp_eq_u32 s77,s61
s_cselect_b32 s57,50331648,0
s_cselect_b32 s58,1536,0
s_add_u32 s59,s59,s58
s_add_u32 s70,s70,s57
s_add_u32 s70,s70,150994944
v_mov_b32 v19,s59
v_writelane_b32 v19,s60,1
s_branch L_aj_81
L_ab_80:
s_add_u32 s77,s53,4
s_mov_b32 s30,0
s_lshl_b32 s56,s77,5
s_add_u32 s56,s56,s68
s_mul_i32 s70,s56,24576
s_lshl_b32 s71,s56,13
s_lshl_b32 s59,s77,13
s_lshl2_add_u32 s59,s68,s59
s_add_u32 s59,s59,10485760
s_mov_b32 s33,1
s_add_u32 s70,s70,100663296
s_add_u32 s71,s71,41943040
v_mov_b32 v19,s59
L_aj_81:
buffer_load_dword v18,v19,s[8:11],0 offen sc1
v_mfma_f32_16x16x32_bf16 v[136:139],v[72:75],v[24:27],0
v_max3_u32 v238,v72,v73,v74
v_max3_u32 v238,v74,v75,v238
v_mfma_f32_16x16x32_bf16 v[136:139],v[76:79],v[28:31],v[136:139]
v_max3_u32 v238,v76,v77,v238
v_max3_u32 v238,v78,v79,v238
v_mfma_f32_16x16x32_bf16 v[136:139],v[80:83],v[32:35],v[136:139]
v_max3_u32 v238,v80,v81,v238
v_max3_u32 v238,v82,v83,v238
v_mfma_f32_16x16x32_bf16 v[136:139],v[84:87],v[36:39],v[136:139]
v_max3_u32 v238,v84,v85,v238
v_max3_u32 v238,v86,v87,v238
v_max3_u32 v238,v120,v121,v238
v_max3_u32 v238,v122,v123,v238
v_max3_u32 v238,v124,v125,v238
v_max3_u32 v238,v126,v127,v238
v_cmp_eq_u32 vcc,-1,v238
s_cbranch_vccz L_aa_49
L_aa_48:
s_add_u32 s62,s76,4096
buffer_load_dwordx4 v[72:75],v0,s[8:11],s76 offen offset:0 sc1
buffer_load_dwordx4 v[76:79],v0,s[8:11],s76 offen offset:1024 sc1
buffer_load_dwordx4 v[80:83],v0,s[8:11],s76 offen offset:2048 sc1
buffer_load_dwordx4 v[84:87],v0,s[8:11],s76 offen offset:3072 sc1
buffer_load_dwordx2 v[120:121],v0,s[8:11],s62 offen offset:0 sc1
buffer_load_dwordx2 v[122:123],v0,s[8:11],s62 offen offset:1024 sc1
buffer_load_dwordx2 v[124:125],v0,s[8:11],s62 offen offset:2048 sc1
buffer_load_dwordx2 v[126:127],v0,s[8:11],s62 offen offset:3072 sc1
buffer_load_dword v18,v19,s[8:11],0 offen sc1
s_sub_u32 s49,s49,1
s_cbranch_scc1 L_abort
s_waitcnt vmcnt(8)
v_mfma_f32_16x16x32_bf16 v[136:139],v[72:75],v[24:27],0
v_max3_u32 v238,v72,v73,v74
v_max3_u32 v238,v74,v75,v238
s_waitcnt vmcnt(7)
v_mfma_f32_16x16x32_bf16 v[136:139],v[76:79],v[28:31],v[136:139]
v_max3_u32 v238,v76,v77,v238
v_max3_u32 v238,v78,v79,v238
s_waitcnt vmcnt(6)
v_mfma_f32_16x16x32_bf16 v[136:139],v[80:83],v[32:35],v[136:139]
v_max3_u32 v238,v80,v81,v238
v_max3_u32 v238,v82,v83,v238
s_waitcnt vmcnt(5)
v_mfma_f32_16x16x32_bf16 v[136:139],v[84:87],v[36:39],v[136:139]
v_max3_u32 v238,v84,v85,v238
v_max3_u32 v238,v86,v87,v238
s_waitcnt vmcnt(1)
v_max3_u32 v238,v120,v121,v238
v_max3_u32 v238,v122,v123,v238
v_max3_u32 v238,v124,v125,v238
v_max3_u32 v238,v126,v127,v238
v_cmp_eq_u32 vcc,-1,v238
s_cbranch_vccnz L_aa_48
L_aa_49:
v_max3_f32 v238,v128,v129,v130
v_max3_f32 v239,v131,v132,v133
v_max3_f32 v238,v134,v135,v238
v_max3_f32 v239,v138,v139,v239
v_max_f32 v238,v238,v239
v_max_f32 v239,v238,v239
s_nop 1
v_permlane16_swap_b32 v238,v239
v_max_f32 v238,v238,v239
v_max_f32 v239,v238,v239
s_nop 1
v_permlane32_swap_b32 v238,v239
v_max_f32 v238,v238,v239
v_mul_f32 v238,s80,v238
v_fma_f32 v128,v128,s80,-v238
v_fma_f32 v129,v129,s80,-v238
v_exp_f32 v128,v128
v_fma_f32 v130,v130,s80,-v238
v_exp_f32 v129,v129
v_fma_f32 v131,v131,s80,-v238
v_exp_f32 v130,v130
v_fma_f32 v132,v132,s80,-v238
v_exp_f32 v131,v131
v_fma_f32 v133,v133,s80,-v238
v_exp_f32 v132,v132
v_fma_f32 v134,v134,s80,-v238
v_exp_f32 v133,v133
v_fma_f32 v135,v135,s80,-v238
v_exp_f32 v134,v134
v_fma_f32 v138,v138,s80,-v238
v_exp_f32 v135,v135
v_fma_f32 v139,v139,s80,-v238
v_exp_f32 v138,v138
v_exp_f32 v139,v139
v_cvt_pk_bf16_f32 v140,v128,v129
v_cvt_pk_bf16_f32 v141,v130,v131
v_cvt_pk_bf16_f32 v142,v132,v133
v_cvt_pk_bf16_f32 v143,v134,v135
v_cvt_pk_bf16_f32 v144,v138,v139
v_mov_b32 v147,v144
v_mfma_f32_16x16x32_bf16 v[148:151],v[152:155],v[140:143],0
v_mfma_f32_16x16x32_bf16 v[24:27],v[88:91],v[140:143],0
v_mfma_f32_16x16x32_bf16 v[28:31],v[92:95],v[140:143],0
v_mfma_f32_16x16x16_bf16 v[148:151],v[152:153],v[144:145],v[148:151]
v_mfma_f32_16x16x32_bf16 v[32:35],v[96:99],v[140:143],0
v_mfma_f32_16x16x32_bf16 v[36:39],v[100:103],v[140:143],0
v_mfma_f32_16x16x32_bf16 v[40:43],v[104:107],v[140:143],0
v_mfma_f32_16x16x32_bf16 v[44:47],v[108:111],v[140:143],0
v_mfma_f32_16x16x32_bf16 v[48:51],v[112:115],v[140:143],0
v_mfma_f32_16x16x32_bf16 v[52:55],v[116:119],v[140:143],0
v_rcp_f32 v148,v148
v_mfma_f32_16x16x16_bf16 v[24:27],v[120:121],v[144:145],v[24:27]
v_mfma_f32_16x16x16_bf16 v[28:31],v[120:121],v[146:147],v[28:31]
v_mfma_f32_16x16x16_bf16 v[32:35],v[122:123],v[144:145],v[32:35]
v_mfma_f32_16x16x16_bf16 v[36:39],v[122:123],v[146:147],v[36:39]
v_mfma_f32_16x16x16_bf16 v[40:43],v[124:125],v[144:145],v[40:43]
v_pk_mul_f32 v[24:25],v[24:25],v[148:149] op_sel_hi:[1,0]
v_pk_mul_f32 v[26:27],v[26:27],v[148:149] op_sel_hi:[1,0]
v_mfma_f32_16x16x16_bf16 v[44:47],v[124:125],v[146:147],v[44:47]
v_pk_mul_f32 v[28:29],v[28:29],v[148:149] op_sel_hi:[1,0]
v_pk_mul_f32 v[30:31],v[30:31],v[148:149] op_sel_hi:[1,0]
v_mfma_f32_16x16x16_bf16 v[48:51],v[126:127],v[144:145],v[48:51]
v_cvt_pk_bf16_f32 v72,v24,v28
v_cvt_pk_bf16_f32 v73,v25,v29
v_mfma_f32_16x16x16_bf16 v[52:55],v[126:127],v[146:147],v[52:55]
v_cvt_pk_bf16_f32 v74,v26,v30
v_cvt_pk_bf16_f32 v75,v27,v31
ds_write_b128 v3,v[72:75] offset:0
v_pk_mul_f32 v[32:33],v[32:33],v[148:149] op_sel_hi:[1,0]
v_pk_mul_f32 v[34:35],v[34:35],v[148:149] op_sel_hi:[1,0]
v_pk_mul_f32 v[36:37],v[36:37],v[148:149] op_sel_hi:[1,0]
v_pk_mul_f32 v[38:39],v[38:39],v[148:149] op_sel_hi:[1,0]
v_cvt_pk_bf16_f32 v76,v32,v36
v_cvt_pk_bf16_f32 v77,v33,v37
v_cvt_pk_bf16_f32 v78,v34,v38
v_cvt_pk_bf16_f32 v79,v35,v39
ds_write_b128 v3,v[76:79] offset:1024
v_pk_mul_f32 v[40:41],v[40:41],v[148:149] op_sel_hi:[1,0]
v_pk_mul_f32 v[42:43],v[42:43],v[148:149] op_sel_hi:[1,0]
v_pk_mul_f32 v[44:45],v[44:45],v[148:149] op_sel_hi:[1,0]
v_pk_mul_f32 v[46:47],v[46:47],v[148:149] op_sel_hi:[1,0]
v_cvt_pk_bf16_f32 v80,v40,v44
v_cvt_pk_bf16_f32 v81,v41,v45
v_cvt_pk_bf16_f32 v82,v42,v46
v_cvt_pk_bf16_f32 v83,v43,v47
ds_write_b128 v3,v[80:83] offset:2048
v_pk_mul_f32 v[48:49],v[48:49],v[148:149] op_sel_hi:[1,0]
v_pk_mul_f32 v[50:51],v[50:51],v[148:149] op_sel_hi:[1,0]
v_pk_mul_f32 v[52:53],v[52:53],v[148:149] op_sel_hi:[1,0]
v_pk_mul_f32 v[54:55],v[54:55],v[148:149] op_sel_hi:[1,0]
v_cvt_pk_bf16_f32 v84,v48,v52
v_cvt_pk_bf16_f32 v85,v49,v53
v_cvt_pk_bf16_f32 v86,v50,v54
v_cvt_pk_bf16_f32 v87,v51,v55
ds_write_b128 v3,v[84:87] offset:3072
s_waitcnt vmcnt(0)
v_readlane_b32 s32,v18,0
v_readlane_b32 s33,v18,1
s_waitcnt lgkmcnt(0)
s_barrier
s_branch L_aa_38
L_aa_47:
s_cmp_lg_u32 s86,1536
s_cbranch_scc1 L_az_84
L_aa_37:
s_waitcnt vmcnt(0)
buffer_store_dword v20,off,s[8:11],s73 sc1
s_mov_b32 s73,0x80000000
s_mov_b32 s59,11011712
v_and_b32 v238,12,v16
v_mov_b32 v239,0
L_aw_85:
v_cmp_eq_u32 vcc,0,v239
s_cbranch_vccz L_awd_86
s_sleep 2
buffer_load_dword v239,v238,s[8:11],s59 offen sc1
s_sub_u32 s49,s49,1
s_cbranch_scc1 L_abort
s_waitcnt vmcnt(0)
s_branch L_aw_85
L_awd_86:
v_readlane_b32 s55,v239,0
v_readlane_b32 s84,v239,1
v_readlane_b32 s56,v239,2
v_readlane_b32 s58,v239,3
s_sub_u32 s55,s55,1
s_bitset0_b32 s84,31
s_bitset0_b32 s56,31
s_mov_b32 s57,0
s_lshl_b64 s[56:57],s[56:57],22
s_or_b32 s84,s84,s56
s_lshl_b32 s58,s58,12
s_or_b32 s85,s57,s58
s_mov_b32 s86,768
s_mov_b32 s30,1
s_mov_b32 s65,s54
L_as_87:
s_ff1_i32_b64 s77,s[84:85]
s_bitset0_b64 s[84:85],s77
s_min_u32 s77,s77,64
s_sub_u32 s65,s65,1
s_cbranch_scc0 L_as_87
s_lshr_b32 s61,s55,5
s_lshl_b32 s56,s77,5
s_add_u32 s56,s56,s68
s_mul_i32 s70,s56,24576
s_lshl_b32 s71,s56,13
s_lshl_b32 s59,s77,13
s_lshl2_add_u32 s59,s68,s59
s_add_u32 s59,s59,10486144
s_cmp_lt_u32 s77,s61
s_cselect_b32 s57,0,16777216
s_cselect_b32 s60,0,128
s_add_u32 s60,s60,s59
s_add_u32 s60,s60,128
s_buffer_load_dword s33,s[8:11],s60 glc
s_add_u32 s71,s71,s57
s_add_u32 s71,s71,58720256
s_cmp_eq_u32 s77,s61
s_cselect_b32 s57,50331648,0
s_cselect_b32 s58,1536,0
s_add_u32 s59,s59,s58
s_buffer_load_dword s32,s[8:11],s59 glc
s_add_u32 s70,s70,s57
s_add_u32 s70,s70,150994944
v_mov_b32 v19,s59
v_writelane_b32 v19,s60,1
s_cmp_lt_u32 s77,64
s_cbranch_scc1 L_aa_45
L_az_84:
s_waitcnt vmcnt(0)
buffer_store_dword v20,off,s[8:11],s73 sc1
s_mov_b32 s73,0x80000000
s_endpgm
L_ag_56:
s_lshl_b32 s21,s26,13
s_lshl2_add_u32 s21,s68,s21
s_add_u32 s21,s21,10487296
L_ww_88:
buffer_load_dword v246,off,s[8:11],s21 sc1
s_sub_u32 s49,s49,1
s_cbranch_scc1 L_abort
s_waitcnt vmcnt(0)
v_readfirstlane_b32 s22,v246
s_cmp_eq_u32 s22,0
s_cbranch_scc1 L_ww_88
L_wwd_89:
s_branch L_agb_57
L_ap_60:
L_aw_90:
v_cmp_gt_u32 vcc,s66,v17
s_cbranch_vccz L_awd_91
buffer_load_dword v17,v16,s[8:11],s87 offen sc1
s_sub_u32 s49,s49,1
s_cbranch_scc1 L_abort
s_waitcnt vmcnt(0)
s_branch L_aw_90
L_awd_91:
s_branch L_apb_61
L_ap_66:
L_aw_92:
v_cmp_gt_u32 vcc,s66,v17
s_cbranch_vccz L_awd_93
buffer_load_dword v17,v16,s[8:11],s87 offen sc1
s_sub_u32 s49,s49,1
s_cbranch_scc1 L_abort
s_waitcnt vmcnt(0)
s_branch L_aw_92
L_awd_93:
s_branch L_apb_67
L_ag_73:
s_lshl_b32 s21,s51,13
s_lshl2_add_u32 s21,s68,s21
s_add_u32 s21,s21,10487296
L_ww_94:
buffer_load_dword v246,off,s[8:11],s21 sc1
s_sub_u32 s49,s49,1
s_cbranch_scc1 L_abort
s_waitcnt vmcnt(0)
v_readfirstlane_b32 s22,v246
s_cmp_eq_u32 s22,0
s_cbranch_scc1 L_ww_94
L_wwd_95:
s_branch L_agb_74
s_endpgm
L_rch_4:
v_and_b32 v2,15,v1
v_lshlrev_b32 v2,2,v2
v_lshrrev_b32 v3,4,v1
v_lshl_add_u32 v4,v3,16,v2
v_lshl_add_u32 v5,v3,12,v2
s_lshl_b32 s58,s47,8
s_lshl_b32 s57,s46,6
s_add_u32 s58,s58,s57
s_lshl_b32 s59,s47,17
s_add_u32 s59,s59,s57
s_lshl_b32 s60,s46,15
v_add_u32 v6,s60,v0
s_mov_b32 s61,0x05040100
s_mov_b32 s62,0x07060302
s_lshl_b32 s63,s46,19
s_cmp_lt_u32 s48,3
s_cselect_b32 s63,s63,0
s_mov_b32 s4,s26
s_mov_b32 s5,s27
s_mov_b32 s6,4194304
s_mov_b32 s7,0x20000
s_add_u32 s56,s59,0
buffer_load_dword v24,v5,s[4:7],s56 offen offset:0
buffer_load_dword v25,v5,s[4:7],s56 offen offset:1024
buffer_load_dword v26,v5,s[4:7],s56 offen offset:2048
buffer_load_dword v27,v5,s[4:7],s56 offen offset:3072
s_add_u32 s56,s59,16384
buffer_load_dword v28,v5,s[4:7],s56 offen offset:0
buffer_load_dword v29,v5,s[4:7],s56 offen offset:1024
buffer_load_dword v30,v5,s[4:7],s56 offen offset:2048
buffer_load_dword v31,v5,s[4:7],s56 offen offset:3072
s_add_u32 s56,s59,32768
buffer_load_dword v32,v5,s[4:7],s56 offen offset:0
buffer_load_dword v33,v5,s[4:7],s56 offen offset:1024
buffer_load_dword v34,v5,s[4:7],s56 offen offset:2048
buffer_load_dword v35,v5,s[4:7],s56 offen offset:3072
s_add_u32 s56,s59,49152
buffer_load_dword v36,v5,s[4:7],s56 offen offset:0
buffer_load_dword v37,v5,s[4:7],s56 offen offset:1024
buffer_load_dword v38,v5,s[4:7],s56 offen offset:2048
buffer_load_dword v39,v5,s[4:7],s56 offen offset:3072
s_add_u32 s56,s59,65536
buffer_load_dword v40,v5,s[4:7],s56 offen offset:0
buffer_load_dword v41,v5,s[4:7],s56 offen offset:1024
buffer_load_dword v42,v5,s[4:7],s56 offen offset:2048
buffer_load_dword v43,v5,s[4:7],s56 offen offset:3072
s_add_u32 s56,s59,81920
buffer_load_dword v44,v5,s[4:7],s56 offen offset:0
buffer_load_dword v45,v5,s[4:7],s56 offen offset:1024
buffer_load_dword v46,v5,s[4:7],s56 offen offset:2048
buffer_load_dword v47,v5,s[4:7],s56 offen offset:3072
s_add_u32 s56,s59,98304
buffer_load_dword v48,v5,s[4:7],s56 offen offset:0
buffer_load_dword v49,v5,s[4:7],s56 offen offset:1024
buffer_load_dword v50,v5,s[4:7],s56 offen offset:2048
buffer_load_dword v51,v5,s[4:7],s56 offen offset:3072
s_add_u32 s56,s59,114688
buffer_load_dword v52,v5,s[4:7],s56 offen offset:0
buffer_load_dword v53,v5,s[4:7],s56 offen offset:1024
buffer_load_dword v54,v5,s[4:7],s56 offen offset:2048
buffer_load_dword v55,v5,s[4:7],s56 offen offset:3072
s_add_u32 s56,s59,256
buffer_load_dword v56,v5,s[4:7],s56 offen offset:0
buffer_load_dword v57,v5,s[4:7],s56 offen offset:1024
buffer_load_dword v58,v5,s[4:7],s56 offen offset:2048
buffer_load_dword v59,v5,s[4:7],s56 offen offset:3072
s_add_u32 s56,s59,16640
buffer_load_dword v60,v5,s[4:7],s56 offen offset:0
buffer_load_dword v61,v5,s[4:7],s56 offen offset:1024
buffer_load_dword v62,v5,s[4:7],s56 offen offset:2048
buffer_load_dword v63,v5,s[4:7],s56 offen offset:3072
s_add_u32 s56,s59,33024
buffer_load_dword v64,v5,s[4:7],s56 offen offset:0
buffer_load_dword v65,v5,s[4:7],s56 offen offset:1024
buffer_load_dword v66,v5,s[4:7],s56 offen offset:2048
buffer_load_dword v67,v5,s[4:7],s56 offen offset:3072
s_add_u32 s56,s59,49408
buffer_load_dword v68,v5,s[4:7],s56 offen offset:0
buffer_load_dword v69,v5,s[4:7],s56 offen offset:1024
buffer_load_dword v70,v5,s[4:7],s56 offen offset:2048
buffer_load_dword v71,v5,s[4:7],s56 offen offset:3072
s_add_u32 s56,s59,65792
buffer_load_dword v72,v5,s[4:7],s56 offen offset:0
buffer_load_dword v73,v5,s[4:7],s56 offen offset:1024
buffer_load_dword v74,v5,s[4:7],s56 offen offset:2048
buffer_load_dword v75,v5,s[4:7],s56 offen offset:3072
s_add_u32 s56,s59,82176
buffer_load_dword v76,v5,s[4:7],s56 offen offset:0
buffer_load_dword v77,v5,s[4:7],s56 offen offset:1024
buffer_load_dword v78,v5,s[4:7],s56 offen offset:2048
buffer_load_dword v79,v5,s[4:7],s56 offen offset:3072
s_waitcnt vmcnt(48)
ds_write_b128 v6,v[24:27] offset:0
ds_write_b128 v6,v[28:31] offset:1024
s_waitcnt lgkmcnt(0)
s_add_u32 s56,s59,98560
buffer_load_dword v24,v5,s[4:7],s56 offen offset:0
buffer_load_dword v25,v5,s[4:7],s56 offen offset:1024
buffer_load_dword v26,v5,s[4:7],s56 offen offset:2048
buffer_load_dword v27,v5,s[4:7],s56 offen offset:3072
s_add_u32 s56,s59,114944
buffer_load_dword v28,v5,s[4:7],s56 offen offset:0
buffer_load_dword v29,v5,s[4:7],s56 offen offset:1024
buffer_load_dword v30,v5,s[4:7],s56 offen offset:2048
buffer_load_dword v31,v5,s[4:7],s56 offen offset:3072
s_waitcnt vmcnt(48)
ds_write_b128 v6,v[32:35] offset:2048
ds_write_b128 v6,v[36:39] offset:3072
s_waitcnt lgkmcnt(0)
s_add_u32 s56,s59,512
buffer_load_dword v32,v5,s[4:7],s56 offen offset:0
buffer_load_dword v33,v5,s[4:7],s56 offen offset:1024
buffer_load_dword v34,v5,s[4:7],s56 offen offset:2048
buffer_load_dword v35,v5,s[4:7],s56 offen offset:3072
s_add_u32 s56,s59,16896
buffer_load_dword v36,v5,s[4:7],s56 offen offset:0
buffer_load_dword v37,v5,s[4:7],s56 offen offset:1024
buffer_load_dword v38,v5,s[4:7],s56 offen offset:2048
buffer_load_dword v39,v5,s[4:7],s56 offen offset:3072
s_waitcnt vmcnt(48)
ds_write_b128 v6,v[40:43] offset:4096
ds_write_b128 v6,v[44:47] offset:5120
s_waitcnt lgkmcnt(0)
s_add_u32 s56,s59,33280
buffer_load_dword v40,v5,s[4:7],s56 offen offset:0
buffer_load_dword v41,v5,s[4:7],s56 offen offset:1024
buffer_load_dword v42,v5,s[4:7],s56 offen offset:2048
buffer_load_dword v43,v5,s[4:7],s56 offen offset:3072
s_add_u32 s56,s59,49664
buffer_load_dword v44,v5,s[4:7],s56 offen offset:0
buffer_load_dword v45,v5,s[4:7],s56 offen offset:1024
buffer_load_dword v46,v5,s[4:7],s56 offen offset:2048
buffer_load_dword v47,v5,s[4:7],s56 offen offset:3072
s_waitcnt vmcnt(48)
ds_write_b128 v6,v[48:51] offset:6144
ds_write_b128 v6,v[52:55] offset:7168
s_waitcnt lgkmcnt(0)
s_add_u32 s56,s59,66048
buffer_load_dword v48,v5,s[4:7],s56 offen offset:0
buffer_load_dword v49,v5,s[4:7],s56 offen offset:1024
buffer_load_dword v50,v5,s[4:7],s56 offen offset:2048
buffer_load_dword v51,v5,s[4:7],s56 offen offset:3072
s_add_u32 s56,s59,82432
buffer_load_dword v52,v5,s[4:7],s56 offen offset:0
buffer_load_dword v53,v5,s[4:7],s56 offen offset:1024
buffer_load_dword v54,v5,s[4:7],s56 offen offset:2048
buffer_load_dword v55,v5,s[4:7],s56 offen offset:3072
s_waitcnt vmcnt(48)
ds_write_b128 v6,v[56:59] offset:8192
ds_write_b128 v6,v[60:63] offset:9216
s_waitcnt lgkmcnt(0)
s_add_u32 s56,s59,98816
buffer_load_dword v56,v5,s[4:7],s56 offen offset:0
buffer_load_dword v57,v5,s[4:7],s56 offen offset:1024
buffer_load_dword v58,v5,s[4:7],s56 offen offset:2048
buffer_load_dword v59,v5,s[4:7],s56 offen offset:3072
s_add_u32 s56,s59,115200
buffer_load_dword v60,v5,s[4:7],s56 offen offset:0
buffer_load_dword v61,v5,s[4:7],s56 offen offset:1024
buffer_load_dword v62,v5,s[4:7],s56 offen offset:2048
buffer_load_dword v63,v5,s[4:7],s56 offen offset:3072
s_waitcnt vmcnt(48)
ds_write_b128 v6,v[64:67] offset:10240
ds_write_b128 v6,v[68:71] offset:11264
s_waitcnt lgkmcnt(0)
s_add_u32 s56,s59,768
buffer_load_dword v64,v5,s[4:7],s56 offen offset:0
buffer_load_dword v65,v5,s[4:7],s56 offen offset:1024
buffer_load_dword v66,v5,s[4:7],s56 offen offset:2048
buffer_load_dword v67,v5,s[4:7],s56 offen offset:3072
s_add_u32 s56,s59,17152
buffer_load_dword v68,v5,s[4:7],s56 offen offset:0
buffer_load_dword v69,v5,s[4:7],s56 offen offset:1024
buffer_load_dword v70,v5,s[4:7],s56 offen offset:2048
buffer_load_dword v71,v5,s[4:7],s56 offen offset:3072
s_waitcnt vmcnt(48)
ds_write_b128 v6,v[72:75] offset:12288
ds_write_b128 v6,v[76:79] offset:13312
s_waitcnt lgkmcnt(0)
s_add_u32 s56,s59,33536
buffer_load_dword v72,v5,s[4:7],s56 offen offset:0
buffer_load_dword v73,v5,s[4:7],s56 offen offset:1024
buffer_load_dword v74,v5,s[4:7],s56 offen offset:2048
buffer_load_dword v75,v5,s[4:7],s56 offen offset:3072
s_add_u32 s56,s59,49920
buffer_load_dword v76,v5,s[4:7],s56 offen offset:0
buffer_load_dword v77,v5,s[4:7],s56 offen offset:1024
buffer_load_dword v78,v5,s[4:7],s56 offen offset:2048
buffer_load_dword v79,v5,s[4:7],s56 offen offset:3072
s_waitcnt vmcnt(48)
ds_write_b128 v6,v[24:27] offset:14336
ds_write_b128 v6,v[28:31] offset:15360
s_waitcnt lgkmcnt(0)
s_add_u32 s56,s59,66304
buffer_load_dword v24,v5,s[4:7],s56 offen offset:0
buffer_load_dword v25,v5,s[4:7],s56 offen offset:1024
buffer_load_dword v26,v5,s[4:7],s56 offen offset:2048
buffer_load_dword v27,v5,s[4:7],s56 offen offset:3072
s_add_u32 s56,s59,82688
buffer_load_dword v28,v5,s[4:7],s56 offen offset:0
buffer_load_dword v29,v5,s[4:7],s56 offen offset:1024
buffer_load_dword v30,v5,s[4:7],s56 offen offset:2048
buffer_load_dword v31,v5,s[4:7],s56 offen offset:3072
s_waitcnt vmcnt(48)
ds_write_b128 v6,v[32:35] offset:16384
ds_write_b128 v6,v[36:39] offset:17408
s_waitcnt lgkmcnt(0)
s_add_u32 s56,s59,99072
buffer_load_dword v32,v5,s[4:7],s56 offen offset:0
buffer_load_dword v33,v5,s[4:7],s56 offen offset:1024
buffer_load_dword v34,v5,s[4:7],s56 offen offset:2048
buffer_load_dword v35,v5,s[4:7],s56 offen offset:3072
s_add_u32 s56,s59,115456
buffer_load_dword v36,v5,s[4:7],s56 offen offset:0
buffer_load_dword v37,v5,s[4:7],s56 offen offset:1024
buffer_load_dword v38,v5,s[4:7],s56 offen offset:2048
buffer_load_dword v39,v5,s[4:7],s56 offen offset:3072
s_waitcnt vmcnt(48)
ds_write_b128 v6,v[40:43] offset:18432
ds_write_b128 v6,v[44:47] offset:19456
s_waitcnt lgkmcnt(0)
s_waitcnt vmcnt(40)
ds_write_b128 v6,v[48:51] offset:20480
ds_write_b128 v6,v[52:55] offset:21504
s_waitcnt lgkmcnt(0)
s_waitcnt vmcnt(32)
ds_write_b128 v6,v[56:59] offset:22528
ds_write_b128 v6,v[60:63] offset:23552
s_waitcnt lgkmcnt(0)
s_waitcnt vmcnt(24)
ds_write_b128 v6,v[64:67] offset:24576
ds_write_b128 v6,v[68:71] offset:25600
s_waitcnt lgkmcnt(0)
s_waitcnt vmcnt(16)
ds_write_b128 v6,v[72:75] offset:26624
ds_write_b128 v6,v[76:79] offset:27648
s_waitcnt lgkmcnt(0)
s_waitcnt vmcnt(8)
ds_write_b128 v6,v[24:27] offset:28672
ds_write_b128 v6,v[28:31] offset:29696
s_waitcnt lgkmcnt(0)
s_waitcnt vmcnt(0)
ds_write_b128 v6,v[32:35] offset:30720
ds_write_b128 v6,v[36:39] offset:31744
s_waitcnt lgkmcnt(0)
v_mov_b32 v123,159744
s_cmp_lg_u32 s46,0
s_cbranch_scc1 L_gbd_97
v_mov_b32 v124,128
L_gb_96:
buffer_load_dword v125,v124,s[12:15],0 offen sc1
s_waitcnt vmcnt(0)
v_readfirstlane_b32 s56,v125
ds_write_b32 v123,v125
s_bitcmp1_b32 s56,8
s_cbranch_scc1 L_gbd_97
s_sleep 4
s_sub_u32 s49,s49,1
s_cmp_gt_i32 s49,0
s_cbranch_scc1 L_gb_96
s_branch L_abort
L_gbd_97:
s_waitcnt lgkmcnt(0)
s_barrier
ds_read_b32 v125,v123
s_waitcnt lgkmcnt(0)
v_readfirstlane_b32 s56,v125
s_barrier
s_lshr_b32 s56,s56,16
s_andn2_b32 s56,s56,s3
s_cbranch_scc1 L_spread
s_cmp_eq_u32 s48,0
s_cbranch_scc1 L_chd_98
v_and_b32 v120,15,v1
v_lshrrev_b32 v121,4,v1
v_mov_b32 v17,1
s_lshl_b32 s56,s46,2
v_add_u32 v125,s56,v121
v_xor_b32 v126,v125,v120
v_lshlrev_b32 v126,4,v126
v_lshl_add_u32 v20,v125,10,v126
s_lshl_b32 s56,s46,1
s_xor_b32 s56,s56,0
s_and_b32 s57,s56,3
s_lshl_b32 s57,s57,2
s_lshr_b32 s56,s56,2
s_lshl_b32 s56,s56,13
s_add_u32 s56,s56,131072
v_add_u32 v125,s57,v121
v_xor_b32 v125,v125,v120
v_lshlrev_b32 v125,4,v125
v_lshl_add_u32 v125,v120,8,v125
v_add_u32 v4,s56,v125
s_lshl_b32 s56,s46,1
s_xor_b32 s56,s56,1
s_and_b32 s57,s56,3
s_lshl_b32 s57,s57,2
s_lshr_b32 s56,s56,2
s_lshl_b32 s56,s56,13
s_add_u32 s56,s56,131072
v_add_u32 v125,s57,v121
v_xor_b32 v125,v125,v120
v_lshlrev_b32 v125,4,v125
v_lshl_add_u32 v125,v120,8,v125
v_add_u32 v5,s56,v125
s_lshl_b32 s56,s46,1
s_xor_b32 s56,s56,2
s_and_b32 s57,s56,3
s_lshl_b32 s57,s57,2
s_lshr_b32 s56,s56,2
s_lshl_b32 s56,s56,13
s_add_u32 s56,s56,131072
v_add_u32 v125,s57,v121
v_xor_b32 v125,v125,v120
v_lshlrev_b32 v125,4,v125
v_lshl_add_u32 v125,v120,8,v125
v_add_u32 v6,s56,v125
s_lshl_b32 s56,s46,1
s_xor_b32 s56,s56,3
s_and_b32 s57,s56,3
s_lshl_b32 s57,s57,2
s_lshr_b32 s56,s56,2
s_lshl_b32 s56,s56,13
s_add_u32 s56,s56,131072
v_add_u32 v125,s57,v121
v_xor_b32 v125,v125,v120
v_lshlrev_b32 v125,4,v125
v_lshl_add_u32 v125,v120,8,v125
v_add_u32 v7,s56,v125
s_lshl_b32 s56,s46,1
s_xor_b32 s56,s56,4
s_and_b32 s57,s56,3
s_lshl_b32 s57,s57,2
s_lshr_b32 s56,s56,2
s_lshl_b32 s56,s56,13
s_add_u32 s56,s56,131072
v_add_u32 v125,s57,v121
v_xor_b32 v125,v125,v120
v_lshlrev_b32 v125,4,v125
v_lshl_add_u32 v125,v120,8,v125
v_add_u32 v8,s56,v125
s_lshl_b32 s56,s46,1
s_xor_b32 s56,s56,5
s_and_b32 s57,s56,3
s_lshl_b32 s57,s57,2
s_lshr_b32 s56,s56,2
s_lshl_b32 s56,s56,13
s_add_u32 s56,s56,131072
v_add_u32 v125,s57,v121
v_xor_b32 v125,v125,v120
v_lshlrev_b32 v125,4,v125
v_lshl_add_u32 v125,v120,8,v125
v_add_u32 v9,s56,v125
s_lshl_b32 s56,s46,1
s_xor_b32 s56,s56,6
s_and_b32 s57,s56,3
s_lshl_b32 s57,s57,2
s_lshr_b32 s56,s56,2
s_lshl_b32 s56,s56,13
s_add_u32 s56,s56,131072
v_add_u32 v125,s57,v121
v_xor_b32 v125,v125,v120
v_lshlrev_b32 v125,4,v125
v_lshl_add_u32 v125,v120,8,v125
v_add_u32 v10,s56,v125
s_lshl_b32 s56,s46,1
s_xor_b32 s56,s56,7
s_and_b32 s57,s56,3
s_lshl_b32 s57,s57,2
s_lshr_b32 s56,s56,2
s_lshl_b32 s56,s56,13
s_add_u32 s56,s56,131072
v_add_u32 v125,s57,v121
v_xor_b32 v125,v125,v120
v_lshlrev_b32 v125,4,v125
v_lshl_add_u32 v125,v120,8,v125
v_add_u32 v11,s56,v125
s_cmp_eq_u32 s48,1
s_cselect_b32 s51,8,12
s_cselect_b32 s53,4,6
s_mov_b32 s72,0x80000000
s_lshl_b32 s70,s51,15
s_add_u32 s70,s70,0
s_add_u32 s71,s70,16384
s_add_u32 m0,s50,131072
s_nop 0
buffer_load_dwordx4 v20,s[8:11],s70 offen offset:0 sc1 lds
s_add_u32 m0,s50,135168
s_nop 0
buffer_load_dwordx4 v20,s[8:11],s71 offen offset:0 sc1 lds
s_add_u32 m0,s50,139008
s_nop 0
buffer_load_dwordx4 v20,s[8:11],s70 offen offset:256 sc1 lds
s_add_u32 m0,s50,143104
s_nop 0
buffer_load_dwordx4 v20,s[8:11],s71 offen offset:256 sc1 lds
s_waitcnt vmcnt(0)
L_chl_99:
s_mov_b64 s[68:69],s[70:71]
s_add_u32 s70,s70,32768
s_add_u32 s71,s71,32768
s_lshl_b32 s58,s51,5
s_add_u32 s58,s58,s47
s_mul_i32 s58,s58,24576
s_add_u32 s58,s58,100663296
s_add_u32 s61,s58,s50
s_add_u32 s62,s61,4096
s_add_u32 s63,s61,16384
s_add_u32 s64,s61,20480
s_add_u32 s65,s61,s50
s_add_u32 s65,s65,8192
s_waitcnt vmcnt(8)
s_barrier
ds_read_b128 v[72:75],v4 offset:0
ds_read_b128 v[76:79],v4 offset:4096
ds_read_b128 v[80:83],v5 offset:0
ds_read_b128 v[84:87],v5 offset:4096
s_add_u32 m0,s50,146944
s_nop 0
buffer_load_dwordx4 v20,s[8:11],s68 offen offset:512 sc1 lds
s_add_u32 m0,s50,151040
s_nop 0
buffer_load_dwordx4 v20,s[8:11],s69 offen offset:512 sc1 lds
s_add_u32 m0,s50,154880
s_nop 0
buffer_load_dwordx4 v20,s[8:11],s68 offen offset:768 sc1 lds
s_add_u32 m0,s50,158976
s_nop 0
buffer_load_dwordx4 v20,s[8:11],s69 offen offset:768 sc1 lds
s_waitcnt lgkmcnt(2)
v_mfma_f32_16x16x32_bf16 v[40:43],a[128:131],v[72:75],0
ds_read_b128 v[108:111],v6 offset:0
v_mfma_f32_16x16x32_bf16 v[56:59],v[72:75],v[128:131],0
v_mfma_f32_16x16x32_bf16 v[24:27],a[0:3],v[72:75],0
ds_read_b128 v[112:115],v6 offset:4096
v_mfma_f32_16x16x32_bf16 v[44:47],a[128:131],v[76:79],0
v_mfma_f32_16x16x32_bf16 v[60:63],v[76:79],v[128:131],0
v_mfma_f32_16x16x32_bf16 v[28:31],a[0:3],v[76:79],0
v_mfma_f32_16x16x32_bf16 v[48:51],a[136:139],v[72:75],0
v_mfma_f32_16x16x32_bf16 v[64:67],v[72:75],v[136:139],0
v_mfma_f32_16x16x32_bf16 v[32:35],a[8:11],v[72:75],0
v_mfma_f32_16x16x32_bf16 v[52:55],a[136:139],v[76:79],0
v_mfma_f32_16x16x32_bf16 v[68:71],v[76:79],v[136:139],0
v_mfma_f32_16x16x32_bf16 v[36:39],a[8:11],v[76:79],0
s_waitcnt lgkmcnt(2)
v_mfma_f32_16x16x32_bf16 v[40:43],a[132:135],v[80:83],v[40:43]
ds_read_b128 v[72:75],v7 offset:0
v_mfma_f32_16x16x32_bf16 v[56:59],v[80:83],v[132:135],v[56:59]
v_mfma_f32_16x16x32_bf16 v[24:27],a[4:7],v[80:83],v[24:27]
ds_read_b128 v[76:79],v7 offset:4096
v_mfma_f32_16x16x32_bf16 v[44:47],a[132:135],v[84:87],v[44:47]
v_mfma_f32_16x16x32_bf16 v[60:63],v[84:87],v[132:135],v[60:63]
v_mfma_f32_16x16x32_bf16 v[28:31],a[4:7],v[84:87],v[28:31]
v_mfma_f32_16x16x32_bf16 v[48:51],a[140:143],v[80:83],v[48:51]
v_mfma_f32_16x16x32_bf16 v[64:67],v[80:83],v[140:143],v[64:67]
v_mfma_f32_16x16x32_bf16 v[32:35],a[12:15],v[80:83],v[32:35]
v_mfma_f32_16x16x32_bf16 v[52:55],a[140:143],v[84:87],v[52:55]
v_mfma_f32_16x16x32_bf16 v[68:71],v[84:87],v[140:143],v[68:71]
v_mfma_f32_16x16x32_bf16 v[36:39],a[12:15],v[84:87],v[36:39]
s_waitcnt lgkmcnt(2)
v_mfma_f32_16x16x32_bf16 v[40:43],a[144:147],v[108:111],v[40:43]
ds_read_b128 v[80:83],v8 offset:0
v_mfma_f32_16x16x32_bf16 v[56:59],v[108:111],v[144:147],v[56:59]
v_mfma_f32_16x16x32_bf16 v[24:27],a[16:19],v[108:111],v[24:27]
ds_read_b128 v[84:87],v8 offset:4096
v_mfma_f32_16x16x32_bf16 v[44:47],a[144:147],v[112:115],v[44:47]
v_mfma_f32_16x16x32_bf16 v[60:63],v[112:115],v[144:147],v[60:63]
v_mfma_f32_16x16x32_bf16 v[28:31],a[16:19],v[112:115],v[28:31]
v_mfma_f32_16x16x32_bf16 v[48:51],a[152:155],v[108:111],v[48:51]
v_mfma_f32_16x16x32_bf16 v[64:67],v[108:111],v[152:155],v[64:67]
v_mfma_f32_16x16x32_bf16 v[32:35],a[24:27],v[108:111],v[32:35]
v_mfma_f32_16x16x32_bf16 v[52:55],a[152:155],v[112:115],v[52:55]
v_mfma_f32_16x16x32_bf16 v[68:71],v[112:115],v[152:155],v[68:71]
v_mfma_f32_16x16x32_bf16 v[36:39],a[24:27],v[112:115],v[36:39]
s_waitcnt lgkmcnt(2)
v_mfma_f32_16x16x32_bf16 v[40:43],a[148:151],v[72:75],v[40:43]
ds_read_b128 v[108:111],v9 offset:0
v_mfma_f32_16x16x32_bf16 v[56:59],v[72:75],v[148:151],v[56:59]
v_mfma_f32_16x16x32_bf16 v[24:27],a[20:23],v[72:75],v[24:27]
ds_read_b128 v[112:115],v9 offset:4096
v_mfma_f32_16x16x32_bf16 v[44:47],a[148:151],v[76:79],v[44:47]
v_mfma_f32_16x16x32_bf16 v[60:63],v[76:79],v[148:151],v[60:63]
v_mfma_f32_16x16x32_bf16 v[28:31],a[20:23],v[76:79],v[28:31]
v_mfma_f32_16x16x32_bf16 v[48:51],a[156:159],v[72:75],v[48:51]
v_mfma_f32_16x16x32_bf16 v[64:67],v[72:75],v[156:159],v[64:67]
v_mfma_f32_16x16x32_bf16 v[32:35],a[28:31],v[72:75],v[32:35]
v_mfma_f32_16x16x32_bf16 v[52:55],a[156:159],v[76:79],v[52:55]
v_mfma_f32_16x16x32_bf16 v[68:71],v[76:79],v[156:159],v[68:71]
v_mfma_f32_16x16x32_bf16 v[36:39],a[28:31],v[76:79],v[36:39]
s_waitcnt lgkmcnt(2)
v_mfma_f32_16x16x32_bf16 v[40:43],a[160:163],v[80:83],v[40:43]
ds_read_b128 v[72:75],v10 offset:0
v_mfma_f32_16x16x32_bf16 v[56:59],v[80:83],v[160:163],v[56:59]
v_mfma_f32_16x16x32_bf16 v[24:27],a[32:35],v[80:83],v[24:27]
ds_read_b128 v[76:79],v10 offset:4096
v_mfma_f32_16x16x32_bf16 v[44:47],a[160:163],v[84:87],v[44:47]
v_mfma_f32_16x16x32_bf16 v[60:63],v[84:87],v[160:163],v[60:63]
v_mfma_f32_16x16x32_bf16 v[28:31],a[32:35],v[84:87],v[28:31]
v_mfma_f32_16x16x32_bf16 v[48:51],a[168:171],v[80:83],v[48:51]
v_mfma_f32_16x16x32_bf16 v[64:67],v[80:83],v[168:171],v[64:67]
v_mfma_f32_16x16x32_bf16 v[32:35],a[40:43],v[80:83],v[32:35]
v_mfma_f32_16x16x32_bf16 v[52:55],a[168:171],v[84:87],v[52:55]
v_mfma_f32_16x16x32_bf16 v[68:71],v[84:87],v[168:171],v[68:71]
v_mfma_f32_16x16x32_bf16 v[36:39],a[40:43],v[84:87],v[36:39]
s_waitcnt lgkmcnt(2)
v_mfma_f32_16x16x32_bf16 v[40:43],a[164:167],v[108:111],v[40:43]
ds_read_b128 v[80:83],v11 offset:0
v_mfma_f32_16x16x32_bf16 v[56:59],v[108:111],v[164:167],v[56:59]
v_mfma_f32_16x16x32_bf16 v[24:27],a[36:39],v[108:111],v[24:27]
ds_read_b128 v[84:87],v11 offset:4096
v_mfma_f32_16x16x32_bf16 v[44:47],a[164:167],v[112:115],v[44:47]
v_mfma_f32_16x16x32_bf16 v[60:63],v[112:115],v[164:167],v[60:63]
v_mfma_f32_16x16x32_bf16 v[28:31],a[36:39],v[112:115],v[28:31]
v_mfma_f32_16x16x32_bf16 v[48:51],a[172:175],v[108:111],v[48:51]
v_mfma_f32_16x16x32_bf16 v[64:67],v[108:111],v[172:175],v[64:67]
v_mfma_f32_16x16x32_bf16 v[32:35],a[44:47],v[108:111],v[32:35]
v_mfma_f32_16x16x32_bf16 v[52:55],a[172:175],v[112:115],v[52:55]
v_mfma_f32_16x16x32_bf16 v[68:71],v[112:115],v[172:175],v[68:71]
v_mfma_f32_16x16x32_bf16 v[36:39],a[44:47],v[112:115],v[36:39]
s_waitcnt vmcnt(0)
s_barrier
s_or_b32 s72,s72,s52
buffer_store_dword v17,off,s[8:11],s72 sc1
s_waitcnt lgkmcnt(2)
v_mfma_f32_16x16x32_bf16 v[40:43],a[176:179],v[72:75],v[40:43]
ds_read_b128 v[108:111],v4 offset:16384
v_mfma_f32_16x16x32_bf16 v[56:59],v[72:75],v[176:179],v[56:59]
v_mfma_f32_16x16x32_bf16 v[24:27],a[48:51],v[72:75],v[24:27]
ds_read_b128 v[112:115],v4 offset:20480
v_mfma_f32_16x16x32_bf16 v[44:47],a[176:179],v[76:79],v[44:47]
v_mfma_f32_16x16x32_bf16 v[60:63],v[76:79],v[176:179],v[60:63]
v_mfma_f32_16x16x32_bf16 v[28:31],a[48:51],v[76:79],v[28:31]
v_mfma_f32_16x16x32_bf16 v[48:51],a[184:187],v[72:75],v[48:51]
v_mfma_f32_16x16x32_bf16 v[64:67],v[72:75],v[184:187],v[64:67]
v_mfma_f32_16x16x32_bf16 v[32:35],a[56:59],v[72:75],v[32:35]
v_mfma_f32_16x16x32_bf16 v[52:55],a[184:187],v[76:79],v[52:55]
v_mfma_f32_16x16x32_bf16 v[68:71],v[76:79],v[184:187],v[68:71]
v_mfma_f32_16x16x32_bf16 v[36:39],a[56:59],v[76:79],v[36:39]
s_waitcnt lgkmcnt(2)
v_mfma_f32_16x16x32_bf16 v[40:43],a[180:183],v[80:83],v[40:43]
ds_read_b128 v[72:75],v5 offset:16384
v_mfma_f32_16x16x32_bf16 v[56:59],v[80:83],v[180:183],v[56:59]
v_mfma_f32_16x16x32_bf16 v[24:27],a[52:55],v[80:83],v[24:27]
ds_read_b128 v[76:79],v5 offset:20480
v_mfma_f32_16x16x32_bf16 v[44:47],a[180:183],v[84:87],v[44:47]
v_mfma_f32_16x16x32_bf16 v[60:63],v[84:87],v[180:183],v[60:63]
v_mfma_f32_16x16x32_bf16 v[28:31],a[52:55],v[84:87],v[28:31]
v_mfma_f32_16x16x32_bf16 v[48:51],a[188:191],v[80:83],v[48:51]
v_mfma_f32_16x16x32_bf16 v[64:67],v[80:83],v[188:191],v[64:67]
v_mfma_f32_16x16x32_bf16 v[32:35],a[60:63],v[80:83],v[32:35]
v_mfma_f32_16x16x32_bf16 v[52:55],a[188:191],v[84:87],v[52:55]
v_mfma_f32_16x16x32_bf16 v[68:71],v[84:87],v[188:191],v[68:71]
v_mfma_f32_16x16x32_bf16 v[36:39],a[60:63],v[84:87],v[36:39]
s_waitcnt lgkmcnt(2)
v_mfma_f32_16x16x32_bf16 v[40:43],a[192:195],v[108:111],v[40:43]
ds_read_b128 v[80:83],v6 offset:16384
v_mfma_f32_16x16x32_bf16 v[56:59],v[108:111],v[192:195],v[56:59]
v_mfma_f32_16x16x32_bf16 v[24:27],a[64:67],v[108:111],v[24:27]
ds_read_b128 v[84:87],v6 offset:20480
v_mfma_f32_16x16x32_bf16 v[44:47],a[192:195],v[112:115],v[44:47]
v_mfma_f32_16x16x32_bf16 v[60:63],v[112:115],v[192:195],v[60:63]
v_mfma_f32_16x16x32_bf16 v[28:31],a[64:67],v[112:115],v[28:31]
v_mfma_f32_16x16x32_bf16 v[48:51],a[200:203],v[108:111],v[48:51]
v_mfma_f32_16x16x32_bf16 v[64:67],v[108:111],v[200:203],v[64:67]
v_mfma_f32_16x16x32_bf16 v[32:35],a[72:75],v[108:111],v[32:35]
v_mfma_f32_16x16x32_bf16 v[52:55],a[200:203],v[112:115],v[52:55]
v_mfma_f32_16x16x32_bf16 v[68:71],v[112:115],v[200:203],v[68:71]
v_mfma_f32_16x16x32_bf16 v[36:39],a[72:75],v[112:115],v[36:39]
s_waitcnt lgkmcnt(2)
v_mfma_f32_16x16x32_bf16 v[40:43],a[196:199],v[72:75],v[40:43]
ds_read_b128 v[108:111],v7 offset:16384
v_mfma_f32_16x16x32_bf16 v[56:59],v[72:75],v[196:199],v[56:59]
v_mfma_f32_16x16x32_bf16 v[24:27],a[68:71],v[72:75],v[24:27]
ds_read_b128 v[112:115],v7 offset:20480
v_mfma_f32_16x16x32_bf16 v[44:47],a[196:199],v[76:79],v[44:47]
v_mfma_f32_16x16x32_bf16 v[60:63],v[76:79],v[196:199],v[60:63]
v_mfma_f32_16x16x32_bf16 v[28:31],a[68:71],v[76:79],v[28:31]
v_mfma_f32_16x16x32_bf16 v[48:51],a[204:207],v[72:75],v[48:51]
v_mfma_f32_16x16x32_bf16 v[64:67],v[72:75],v[204:207],v[64:67]
v_mfma_f32_16x16x32_bf16 v[32:35],a[76:79],v[72:75],v[32:35]
v_mfma_f32_16x16x32_bf16 v[52:55],a[204:207],v[76:79],v[52:55]
v_mfma_f32_16x16x32_bf16 v[68:71],v[76:79],v[204:207],v[68:71]
v_mfma_f32_16x16x32_bf16 v[36:39],a[76:79],v[76:79],v[36:39]
s_waitcnt lgkmcnt(2)
v_mfma_f32_16x16x32_bf16 v[40:43],a[208:211],v[80:83],v[40:43]
ds_read_b128 v[72:75],v8 offset:16384
v_mfma_f32_16x16x32_bf16 v[56:59],v[80:83],v[208:211],v[56:59]
v_mfma_f32_16x16x32_bf16 v[24:27],a[80:83],v[80:83],v[24:27]
ds_read_b128 v[76:79],v8 offset:20480
v_mfma_f32_16x16x32_bf16 v[44:47],a[208:211],v[84:87],v[44:47]
v_mfma_f32_16x16x32_bf16 v[60:63],v[84:87],v[208:211],v[60:63]
v_mfma_f32_16x16x32_bf16 v[28:31],a[80:83],v[84:87],v[28:31]
v_mfma_f32_16x16x32_bf16 v[48:51],a[216:219],v[80:83],v[48:51]
v_mfma_f32_16x16x32_bf16 v[64:67],v[80:83],v[216:219],v[64:67]
v_mfma_f32_16x16x32_bf16 v[32:35],a[88:91],v[80:83],v[32:35]
v_mfma_f32_16x16x32_bf16 v[52:55],a[216:219],v[84:87],v[52:55]
v_mfma_f32_16x16x32_bf16 v[68:71],v[84:87],v[216:219],v[68:71]
v_mfma_f32_16x16x32_bf16 v[36:39],a[88:91],v[84:87],v[36:39]
s_waitcnt lgkmcnt(2)
v_mfma_f32_16x16x32_bf16 v[40:43],a[212:215],v[108:111],v[40:43]
ds_read_b128 v[80:83],v9 offset:16384
v_mfma_f32_16x16x32_bf16 v[56:59],v[108:111],v[212:215],v[56:59]
v_mfma_f32_16x16x32_bf16 v[24:27],a[84:87],v[108:111],v[24:27]
ds_read_b128 v[84:87],v9 offset:20480
v_mfma_f32_16x16x32_bf16 v[44:47],a[212:215],v[112:115],v[44:47]
v_mfma_f32_16x16x32_bf16 v[60:63],v[112:115],v[212:215],v[60:63]
v_mfma_f32_16x16x32_bf16 v[28:31],a[84:87],v[112:115],v[28:31]
v_mfma_f32_16x16x32_bf16 v[48:51],a[220:223],v[108:111],v[48:51]
v_mfma_f32_16x16x32_bf16 v[64:67],v[108:111],v[220:223],v[64:67]
v_mfma_f32_16x16x32_bf16 v[32:35],a[92:95],v[108:111],v[32:35]
v_mfma_f32_16x16x32_bf16 v[52:55],a[220:223],v[112:115],v[52:55]
v_mfma_f32_16x16x32_bf16 v[68:71],v[112:115],v[220:223],v[68:71]
v_mfma_f32_16x16x32_bf16 v[36:39],a[92:95],v[112:115],v[36:39]
s_barrier
s_waitcnt lgkmcnt(2)
v_mfma_f32_16x16x32_bf16 v[40:43],a[224:227],v[72:75],v[40:43]
ds_read_b128 v[108:111],v10 offset:16384
v_mfma_f32_16x16x32_bf16 v[56:59],v[72:75],v[224:227],v[56:59]
s_add_u32 m0,s50,131072
v_mfma_f32_16x16x32_bf16 v[24:27],a[96:99],v[72:75],v[24:27]
ds_read_b128 v[112:115],v10 offset:20480
v_mfma_f32_16x16x32_bf16 v[44:47],a[224:227],v[76:79],v[44:47]
buffer_load_dwordx4 v20,s[8:11],s70 offen offset:0 sc1 lds
v_mfma_f32_16x16x32_bf16 v[60:63],v[76:79],v[224:227],v[60:63]
s_add_u32 m0,s50,135168
v_mfma_f32_16x16x32_bf16 v[28:31],a[96:99],v[76:79],v[28:31]
buffer_load_dwordx4 v20,s[8:11],s71 offen offset:0 sc1 lds
v_mfma_f32_16x16x32_bf16 v[48:51],a[232:235],v[72:75],v[48:51]
s_add_u32 m0,s50,139008
v_mfma_f32_16x16x32_bf16 v[64:67],v[72:75],v[232:235],v[64:67]
buffer_load_dwordx4 v20,s[8:11],s70 offen offset:256 sc1 lds
v_mfma_f32_16x16x32_bf16 v[32:35],a[104:107],v[72:75],v[32:35]
s_add_u32 m0,s50,143104
v_mfma_f32_16x16x32_bf16 v[52:55],a[232:235],v[76:79],v[52:55]
buffer_load_dwordx4 v20,s[8:11],s71 offen offset:256 sc1 lds
v_mfma_f32_16x16x32_bf16 v[68:71],v[76:79],v[232:235],v[68:71]
v_mfma_f32_16x16x32_bf16 v[36:39],a[104:107],v[76:79],v[36:39]
s_waitcnt lgkmcnt(2)
v_mfma_f32_16x16x32_bf16 v[40:43],a[228:231],v[80:83],v[40:43]
ds_read_b128 v[72:75],v11 offset:16384
v_mfma_f32_16x16x32_bf16 v[56:59],v[80:83],v[228:231],v[56:59]
v_mfma_f32_16x16x32_bf16 v[24:27],a[100:103],v[80:83],v[24:27]
ds_read_b128 v[76:79],v11 offset:20480
v_mfma_f32_16x16x32_bf16 v[44:47],a[228:231],v[84:87],v[44:47]
v_mfma_f32_16x16x32_bf16 v[60:63],v[84:87],v[228:231],v[60:63]
v_mfma_f32_16x16x32_bf16 v[28:31],a[100:103],v[84:87],v[28:31]
v_mfma_f32_16x16x32_bf16 v[48:51],a[236:239],v[80:83],v[48:51]
v_mfma_f32_16x16x32_bf16 v[64:67],v[80:83],v[236:239],v[64:67]
v_mfma_f32_16x16x32_bf16 v[32:35],a[108:111],v[80:83],v[32:35]
v_mfma_f32_16x16x32_bf16 v[52:55],a[236:239],v[84:87],v[52:55]
v_mfma_f32_16x16x32_bf16 v[68:71],v[84:87],v[236:239],v[68:71]
v_mfma_f32_16x16x32_bf16 v[36:39],a[108:111],v[84:87],v[36:39]
s_waitcnt lgkmcnt(2)
v_mfma_f32_16x16x32_bf16 v[40:43],a[240:243],v[108:111],v[40:43]
v_mfma_f32_16x16x32_bf16 v[56:59],v[108:111],v[240:243],v[56:59]
v_mfma_f32_16x16x32_bf16 v[24:27],a[112:115],v[108:111],v[24:27]
v_mfma_f32_16x16x32_bf16 v[44:47],a[240:243],v[112:115],v[44:47]
v_mfma_f32_16x16x32_bf16 v[60:63],v[112:115],v[240:243],v[60:63]
v_mfma_f32_16x16x32_bf16 v[28:31],a[112:115],v[112:115],v[28:31]
v_mfma_f32_16x16x32_bf16 v[48:51],a[248:251],v[108:111],v[48:51]
v_mfma_f32_16x16x32_bf16 v[64:67],v[108:111],v[248:251],v[64:67]
v_mfma_f32_16x16x32_bf16 v[32:35],a[120:123],v[108:111],v[32:35]
v_mfma_f32_16x16x32_bf16 v[52:55],a[248:251],v[112:115],v[52:55]
v_mfma_f32_16x16x32_bf16 v[68:71],v[112:115],v[248:251],v[68:71]
v_mfma_f32_16x16x32_bf16 v[36:39],a[120:123],v[112:115],v[36:39]
s_waitcnt lgkmcnt(0)
v_mfma_f32_16x16x32_bf16 v[40:43],a[244:247],v[72:75],v[40:43]
v_mfma_f32_16x16x32_bf16 v[56:59],v[72:75],v[244:247],v[56:59]
v_mfma_f32_16x16x32_bf16 v[24:27],a[116:119],v[72:75],v[24:27]
v_mfma_f32_16x16x32_bf16 v[44:47],a[244:247],v[76:79],v[44:47]
v_mfma_f32_16x16x32_bf16 v[60:63],v[76:79],v[244:247],v[60:63]
v_mfma_f32_16x16x32_bf16 v[28:31],a[116:119],v[76:79],v[28:31]
v_mfma_f32_16x16x32_bf16 v[48:51],a[252:255],v[72:75],v[48:51]
v_mfma_f32_16x16x32_bf16 v[64:67],v[72:75],v[252:255],v[64:67]
v_mfma_f32_16x16x32_bf16 v[32:35],a[124:127],v[72:75],v[32:35]
v_mfma_f32_16x16x32_bf16 v[52:55],a[252:255],v[76:79],v[52:55]
v_mfma_f32_16x16x32_bf16 v[68:71],v[76:79],v[252:255],v[68:71]
v_mfma_f32_16x16x32_bf16 v[36:39],a[124:127],v[76:79],v[36:39]
s_lshl_b32 s56,s51,5
s_add_u32 s56,s56,s47
s_lshl_b32 s56,s56,13
s_add_u32 s56,s56,s50
s_add_u32 s56,s56,41943040
s_add_u32 s57,s56,4096
v_mov_b64 v[120:121],-1
v_mov_b64 v[122:123],-1
buffer_store_dwordx4 v[120:123],v0,s[8:11],s56 offen sc1
buffer_store_dwordx4 v[120:123],v0,s[8:11],s57 offen sc1
v_cvt_pk_bf16_f32 v72,v40,v48
v_cvt_pk_bf16_f32 v73,v41,v49
v_cvt_pk_bf16_f32 v74,v42,v50
v_cvt_pk_bf16_f32 v75,v43,v51
buffer_store_dwordx4 v[72:75],v0,s[8:11],s61 offen sc1
v_cvt_pk_bf16_f32 v76,v44,v52
v_cvt_pk_bf16_f32 v77,v45,v53
v_cvt_pk_bf16_f32 v78,v46,v54
v_cvt_pk_bf16_f32 v79,v47,v55
buffer_store_dwordx4 v[76:79],v0,s[8:11],s62 offen sc1
v_cvt_pk_bf16_f32 v80,v56,v57
v_cvt_pk_bf16_f32 v81,v58,v59
v_cvt_pk_bf16_f32 v82,v60,v61
v_cvt_pk_bf16_f32 v83,v62,v63
buffer_store_dwordx4 v[80:83],v0,s[8:11],s65 offen offset:0 sc1
v_cvt_pk_bf16_f32 v84,v64,v65
v_cvt_pk_bf16_f32 v85,v66,v67
v_cvt_pk_bf16_f32 v86,v68,v69
v_cvt_pk_bf16_f32 v87,v70,v71
buffer_store_dwordx4 v[84:87],v0,s[8:11],s65 offen offset:1024 sc1
v_cvt_pk_bf16_f32 v108,v24,v32
v_cvt_pk_bf16_f32 v109,v25,v33
v_cvt_pk_bf16_f32 v110,v26,v34
v_cvt_pk_bf16_f32 v111,v27,v35
buffer_store_dwordx4 v[108:111],v0,s[8:11],s63 offen sc1
v_cvt_pk_bf16_f32 v112,v28,v36
v_cvt_pk_bf16_f32 v113,v29,v37
v_cvt_pk_bf16_f32 v114,v30,v38
v_cvt_pk_bf16_f32 v115,v31,v39
buffer_store_dwordx4 v[112:115],v0,s[8:11],s64 offen sc1
s_lshl_b32 s72,s51,13
s_lshl2_add_u32 s72,s47,s72
s_add_u32 s72,s72,10485760
s_add_u32 s51,s51,1
s_sub_u32 s53,s53,1
s_cmp_gt_u32 s53,0
s_cbranch_scc1 L_chl_99
s_waitcnt vmcnt(0)
s_barrier
s_or_b32 s72,s72,s52
buffer_store_dword v17,off,s[8:11],s72 sc1
L_chd_98:
s_cmp_lg_u32 s3,0
s_cbranch_scc1 L_wc
s_cmp_eq_u32 s48,1
s_cbranch_scc1 L_rc1_100
s_cmp_eq_u32 s48,2
s_cbranch_scc1 L_rc2_101
v_and_b32 v120,15,v1
v_lshrrev_b32 v121,4,v1
v_and_b32 v122,2,v1
v_cmp_eq_u32 vcc,0,v122
v_mov_b32 v2,0xeeee
v_mov_b32 v123,0x4444
v_cndmask_b32 v2,v2,v123,vcc
v_and_b32 v122,1,v1
v_cmp_eq_u32 vcc,0,v122
v_mov_b32 v3,0xdddd
v_mov_b32 v123,0x8888
v_cndmask_b32 v3,v3,v123,vcc
v_lshrrev_b32 v122,1,v120
v_bfe_u32 v123,v120,2,1
v_xor_b32 v123,v123,v122
v_lshlrev_b32 v4,7,v123
v_and_b32 v123,1,v120
v_lshl_add_u32 v4,v123,6,v4
v_xor_b32 v123,v121,v122
v_and_b32 v123,3,v123
v_lshl_add_u32 v4,v123,4,v4
s_lshl_b32 s56,s46,10
s_add_u32 s56,s56,147456
v_add_u32 v4,s56,v4
v_lshlrev_b32 v122,1,v121
v_add_u32 v122,0,v122
v_and_b32 v123,1,v121
v_xor_b32 v123,v123,v122
v_lshlrev_b32 v5,7,v123
v_bfe_u32 v123,v120,3,1
v_lshl_add_u32 v5,v123,6,v5
v_xor_b32 v123,v120,v122
v_and_b32 v123,3,v123
v_lshl_add_u32 v5,v123,4,v5
v_bfe_u32 v123,v120,2,1
v_lshl_add_u32 v5,v123,3,v5
v_add_u32 v5,147456,v5
v_lshlrev_b32 v122,1,v121
v_add_u32 v122,1,v122
v_and_b32 v123,1,v121
v_xor_b32 v123,v123,v122
v_lshlrev_b32 v6,7,v123
v_bfe_u32 v123,v120,3,1
v_lshl_add_u32 v6,v123,6,v6
v_xor_b32 v123,v120,v122
v_and_b32 v123,3,v123
v_lshl_add_u32 v6,v123,4,v6
v_bfe_u32 v123,v120,2,1
v_lshl_add_u32 v6,v123,3,v6
v_add_u32 v6,147456,v6
v_lshlrev_b32 v7,7,v121
v_lshrrev_b32 v122,1,v120
v_lshl_add_u32 v8,v122,4,v7
v_add_u32 v8,151552,v8
v_lshrrev_b32 v122,2,v120
v_lshl_add_u32 v7,v122,5,v7
v_and_b32 v122,1,v120
v_lshl_add_u32 v7,v122,4,v7
v_and_b32 v122,2,v120
v_lshl_add_u32 v7,v122,10,v7
s_lshl_b32 s56,s46,9
s_add_u32 s56,s56,151552
v_add_u32 v7,s56,v7
v_lshrrev_b32 v122,3,v1
v_lshlrev_b32 v9,11,v122
v_and_b32 v122,7,v1
v_lshl_add_u32 v9,v122,3,v9
s_lshl_b32 s56,s46,14
s_lshl_b32 s57,s47,6
s_add_u32 s56,s56,s57
v_add_u32 v9,s56,v9
s_lshl_b32 s71,s47,2
s_add_u32 s71,s71,s46
s_bfe_u32 s56,s71,0x10003
s_lshl_b32 s56,s56,11
s_and_b32 s57,s71,1
s_lshl_b32 s57,s57,10
s_add_u32 s56,s56,s57
s_bfe_u32 s57,s71,0x10002
s_lshl_b32 s57,s57,9
s_add_u32 s56,s56,s57
s_bfe_u32 s57,s71,0x10001
s_lshl_b32 s57,s57,6
s_add_u32 s56,s56,s57
s_bfe_u32 s57,s71,0x10004
s_lshl_b32 s57,s57,8
s_add_u32 s56,s56,s57
s_bfe_u32 s57,s71,0x10005
s_lshl_b32 s57,s57,7
s_add_u32 s56,s56,s57
s_bfe_u32 s57,s71,0x10006
s_lshl_b32 s57,s57,12
s_add_u32 s56,s56,s57
v_and_b32 v122,3,v120
v_lshlrev_b32 v10,2,v122
v_bfe_u32 v122,v120,3,1
v_lshl_add_u32 v10,v122,4,v10
v_and_b32 v122,1,v121
v_lshl_add_u32 v10,v122,5,v10
v_add_u32 v10,s56,v10
v_and_b32 v123,36,v1
v_mov_b32 v122,0x80000000
v_cmp_eq_u32 vcc,0,v123
s_nop 1
v_cndmask_b32 v10,v122,v10,vcc
s_lshl_b32 s56,s46,15
v_add_u32 v11,s56,v0
s_lshl_b32 s71,s71,11
s_lshl_b32 s73,s46,11
s_mov_b32 s72,0xffc00000
s_mov_b32 s74,0
v_lshrrev_b32 v13,3,v1
v_lshlrev_b32 v13,9,v13
v_and_b32 v122,7,v1
v_lshl_add_u32 v13,v122,4,v13
v_and_b32 v122,15,v1
v_and_b32 v123,1,v1
v_lshlrev_b32 v123,4,v123
v_mov_b32 v124,0x3f80
v_lshlrev_b32 v124,v123,v124
v_lshrrev_b32 v122,1,v122
v_cmp_eq_u32 vcc,0,v122
s_nop 1
v_cndmask_b32 v18,0,v124,vcc
v_cmp_eq_u32 vcc,1,v122
s_nop 1
v_cndmask_b32 v19,0,v124,vcc
v_cmp_eq_u32 vcc,2,v122
s_nop 1
v_cndmask_b32 v20,0,v124,vcc
v_cmp_eq_u32 vcc,3,v122
s_nop 1
v_cndmask_b32 v21,0,v124,vcc
s_and_b32 s56,s46,1
s_lshl_b32 s56,s56,8
s_and_b32 s57,s46,2
s_lshl_b32 s57,s57,6
s_add_u32 s56,s56,s57
v_add_u32 v13,s56,v13
s_xor_b32 s56,s46,0
s_lshl_b32 s56,s56,10
s_add_u32 s56,s56,147456
v_add_u32 v14,s56,v0
s_xor_b32 s56,s46,1
s_lshl_b32 s56,s56,10
s_add_u32 s56,s56,147456
v_add_u32 v15,s56,v0
s_xor_b32 s56,s46,2
s_lshl_b32 s56,s56,10
s_add_u32 s56,s56,147456
v_add_u32 v16,s56,v0
s_xor_b32 s56,s46,3
s_lshl_b32 s56,s56,10
s_add_u32 s56,s56,147456
v_add_u32 v17,s56,v0
v_add_u32 v22,11550720,v10
s_lshl_b32 s56,s47,2
s_add_u32 s56,s56,10502144
v_writelane_b32 v22,s56,4
s_mov_b32 s56,10519808
v_writelane_b32 v22,s56,5
v_add_u32 v1,131072,v0
s_mov_b32 s65,14680064
s_add_u32 s66,s71,14680064
s_add_u32 s69,s71,14942208
s_lshl_b32 s79,s47,2
s_add_u32 s79,s79,10485760
s_cmp_eq_u32 s46,0
s_cselect_b32 s79,s79,0x80000000
s_cmp_eq_u32 s47,0
s_cselect_b32 s31,17825792,-1
s_and_b32 s31,s31,0x8fffffff
s_mov_b32 s51,0
L_cst_102:
s_lshl_b32 s59,s51,13
s_lshl2_add_u32 s59,s47,s59
s_add_u32 s59,s59,10485760
L_ww_107:
buffer_load_dword v120,off,s[8:11],s59 sc1
s_sub_u32 s49,s49,1
s_cbranch_scc1 L_abort
s_waitcnt vmcnt(0)
v_readfirstlane_b32 s61,v120
s_cmp_eq_u32 s61,0
s_cbranch_scc1 L_ww_107
L_wwd_108:
s_lshl_b32 s56,s51,5
s_add_u32 s56,s56,s47
s_mul_i32 s56,s56,24576
s_add_u32 s56,s56,100663296
s_add_u32 s67,s56,s73
s_add_u32 m0,s73,131072
s_add_u32 s57,s67,8192
buffer_load_dwordx4 v0,s[8:11],s67 offen sc1 lds
buffer_load_dwordx4 v0,s[8:11],s67 offen offset:1024 sc1 lds
s_add_u32 m0,s73,139264
s_add_u32 s67,s67,786432
buffer_load_dwordx4 v0,s[8:11],s57 offen sc1 lds
buffer_load_dwordx4 v0,s[8:11],s57 offen offset:1024 sc1 lds
s_lshl_b32 s75,s51,13
s_add_u32 s64,s75,11534336
s_add_u32 s70,s64,4096
s_lshl_b32 s68,s51,5
s_add_u32 s68,s68,s47
s_lshl_b32 s68,s68,13
s_lshl_b32 s56,s46,10
s_add_u32 s68,s68,s56
s_add_u32 s68,s68,41943040
s_sub_u32 s67,s67,0
s_mov_b32 s78,0x80000000
s_cmp_eq_u32 s51,63
s_cselect_b32 s76,1,0
s_waitcnt vmcnt(0)
s_barrier
ds_read_b128 v[56:59],v1 offset:0
ds_read_b128 v[60:63],v1 offset:4096
ds_read_b128 v[64:67],v1 offset:1024
ds_read_b128 v[68:71],v1 offset:5120
ds_read_b128 v[72:75],v1 offset:2048
ds_read_b128 v[76:79],v1 offset:6144
ds_read_b128 v[80:83],v1 offset:3072
ds_read_b128 v[84:87],v1 offset:7168
v_add_u32 v12,s73,v1
ds_read_b128 v[88:91],v12 offset:8192
ds_read_b128 v[92:95],v12 offset:9216
v_mov_b64 v[96:97],0
v_mov_b64 v[98:99],0
v_mov_b64 v[100:101],0
v_mov_b64 v[102:103],0
v_mov_b64 v[104:105],0
v_mov_b64 v[106:107],0
v_mov_b64 v[108:109],0
v_mov_b64 v[110:111],0
v_mov_b64 v[112:113],0
v_mov_b64 v[114:115],0
v_mov_b64 v[116:117],0
v_mov_b64 v[118:119],0
buffer_load_dwordx4 v[24:27],v13,s[8:11],s64 offen sc1
L_chain_109:
L_cpa_110:
buffer_load_dwordx4 v[24:27],v13,s[8:11],s64 offen sc1
s_sub_u32 s49,s49,1
s_cbranch_scc1 L_abort
s_waitcnt vmcnt(1)
v_max3_u32 v12,v24,v25,v26
v_max_u32 v12,v27,v12
v_cmp_le_u32 vcc,s72,v12
s_cbranch_vccnz L_cpa_110
L_cgo_113:
ds_write_b128 v14,v[24:27] offset:0
buffer_load_dwordx4 v[40:43],v13,s[8:11],s70 offen sc1
v_smfmac_f32_16x16x64_bf16 v[96:99],v[24:27],a[0:7],v2
s_add_u32 m0,s73,131072
v_smfmac_f32_16x16x64_bf16 v[100:103],v[24:27],a[128:135],v2
s_add_u32 s57,s67,8192
v_smfmac_f32_16x16x64_bf16 v[104:107],v[24:27],a[8:15],v2
v_smfmac_f32_16x16x64_bf16 v[108:111],v[24:27],a[136:143],v2
s_waitcnt lgkmcnt(0)
s_barrier
ds_read_b128 v[28:31],v15 offset:0
ds_read_b128 v[32:35],v16 offset:0
ds_read_b128 v[36:39],v17 offset:0
v_smfmac_f32_16x16x64_bf16 v[112:115],v[24:27],v[128:135],v2
v_smfmac_f32_16x16x64_bf16 v[116:119],v[24:27],v[136:143],v2
s_waitcnt lgkmcnt(2)
v_smfmac_f32_16x16x64_bf16 v[96:99],v[28:31],a[16:23],v2
s_lshl_b32 s56,s46,10
v_smfmac_f32_16x16x64_bf16 v[100:103],v[28:31],a[144:151],v2
v_smfmac_f32_16x16x64_bf16 v[104:107],v[28:31],a[24:31],v2
v_smfmac_f32_16x16x64_bf16 v[108:111],v[28:31],a[152:159],v2
s_waitcnt lgkmcnt(1) vmcnt(0)
v_smfmac_f32_16x16x64_bf16 v[96:99],v[32:35],a[32:39],v2
v_max3_u32 v12,v40,v41,v42
v_smfmac_f32_16x16x64_bf16 v[100:103],v[32:35],a[160:167],v2
v_max_u32 v12,v43,v12
v_smfmac_f32_16x16x64_bf16 v[104:107],v[32:35],a[40:47],v2
v_cmp_le_u32 vcc,s72,v12
v_smfmac_f32_16x16x64_bf16 v[108:111],v[32:35],a[168:175],v2
s_cbranch_vccnz L_cpb_116
L_cback_118:
s_waitcnt lgkmcnt(0)
ds_write_b128 v14,v[40:43] offset:4096
v_smfmac_f32_16x16x64_bf16 v[96:99],v[36:39],a[48:55],v2
v_mov_b64 v[120:121],-1
v_smfmac_f32_16x16x64_bf16 v[100:103],v[36:39],a[176:183],v2
v_mov_b64 v[122:123],-1
v_smfmac_f32_16x16x64_bf16 v[104:107],v[36:39],a[56:63],v2
v_add_u32 v124,s56,v5
v_smfmac_f32_16x16x64_bf16 v[108:111],v[36:39],a[184:191],v2
v_add_u32 v126,s56,v6
s_waitcnt lgkmcnt(0)
s_barrier
v_smfmac_f32_16x16x64_bf16 v[96:99],v[40:43],a[64:71],v2
ds_read_b128 v[44:47],v15 offset:4096
v_smfmac_f32_16x16x64_bf16 v[100:103],v[40:43],a[192:199],v2
ds_read_b128 v[48:51],v16 offset:4096
v_smfmac_f32_16x16x64_bf16 v[104:107],v[40:43],a[72:79],v2
ds_read_b128 v[52:55],v17 offset:4096
v_smfmac_f32_16x16x64_bf16 v[108:111],v[40:43],a[200:207],v2
s_cmp_eq_u32 s76,0
s_cbranch_scc1 L_ckw_103
L_ckb_104:
s_waitcnt lgkmcnt(2)
v_smfmac_f32_16x16x64_bf16 v[96:99],v[44:47],a[80:87],v2
buffer_load_dwordx4 v0,s[8:11],s67 offen sc1 lds
v_smfmac_f32_16x16x64_bf16 v[100:103],v[44:47],a[208:215],v2
buffer_load_dwordx4 v0,s[8:11],s67 offen offset:1024 sc1 lds
v_smfmac_f32_16x16x64_bf16 v[104:107],v[44:47],a[88:95],v2
s_add_u32 m0,s73,139264
v_smfmac_f32_16x16x64_bf16 v[108:111],v[44:47],a[216:223],v2
s_waitcnt lgkmcnt(1)
v_smfmac_f32_16x16x64_bf16 v[96:99],v[48:51],a[96:103],v2
s_add_u32 s67,s67,786432
v_smfmac_f32_16x16x64_bf16 v[100:103],v[48:51],a[224:231],v2
buffer_load_dwordx4 v0,s[8:11],s57 offen sc1 lds
v_smfmac_f32_16x16x64_bf16 v[104:107],v[48:51],a[104:111],v2
buffer_load_dwordx4 v0,s[8:11],s57 offen offset:1024 sc1 lds
v_smfmac_f32_16x16x64_bf16 v[108:111],v[48:51],a[232:239],v2
s_waitcnt lgkmcnt(0)
v_smfmac_f32_16x16x64_bf16 v[96:99],v[52:55],a[112:119],v2
buffer_load_dword v23,v22,s[8:11],s75 offen sc1
v_smfmac_f32_16x16x64_bf16 v[100:103],v[52:55],a[240:247],v2
buffer_store_dwordx4 v[120:123],v0,s[8:11],s69 offen
v_smfmac_f32_16x16x64_bf16 v[104:107],v[52:55],a[120:127],v2
buffer_store_dwordx4 v[120:123],v0,s[8:11],s69 offen offset:1024
v_smfmac_f32_16x16x64_bf16 v[108:111],v[52:55],a[248:255],v2
v_smfmac_f32_16x16x64_bf16 v[112:115],v[28:31],v[144:151],v2
v_smfmac_f32_16x16x64_bf16 v[116:119],v[28:31],v[152:159],v2
v_pk_add_f32 v[96:97],v[96:97],v[98:99]
v_pk_add_f32 v[100:101],v[100:101],v[102:103]
v_cvt_pk_bf16_f32 v120,v96,v97
v_cvt_pk_bf16_f32 v121,v100,v101
v_pk_add_f32 v[104:105],v[104:105],v[106:107]
v_pk_add_f32 v[108:109],v[108:109],v[110:111]
v_cvt_pk_bf16_f32 v122,v104,v105
v_cvt_pk_bf16_f32 v123,v108,v109
ds_write_b128 v4,v[120:123]
v_smfmac_f32_16x16x64_bf16 v[112:115],v[32:35],v[160:167],v2
v_smfmac_f32_16x16x64_bf16 v[116:119],v[32:35],v[168:175],v2
v_smfmac_f32_16x16x64_bf16 v[112:115],v[36:39],v[176:183],v2
v_smfmac_f32_16x16x64_bf16 v[116:119],v[36:39],v[184:191],v2
s_waitcnt lgkmcnt(0)
s_barrier
ds_read_b64_tr_b16 v[96:97],v5 offset:0
ds_read_b64_tr_b16 v[98:99],v6 offset:0
ds_read_b64_tr_b16 v[100:101],v5 offset:1024
ds_read_b64_tr_b16 v[102:103],v6 offset:1024
ds_read_b64_tr_b16 v[104:105],v5 offset:2048
ds_read_b64_tr_b16 v[106:107],v6 offset:2048
ds_read_b64_tr_b16 v[108:109],v5 offset:3072
ds_read_b64_tr_b16 v[110:111],v6 offset:3072
ds_read_b64_tr_b16 v[124:125],v124
ds_read_b64_tr_b16 v[126:127],v126
v_smfmac_f32_16x16x64_bf16 v[112:115],v[40:43],v[192:199],v2
v_smfmac_f32_16x16x64_bf16 v[116:119],v[40:43],v[200:207],v2
s_waitcnt lgkmcnt(8)
v_mfma_f32_16x16x32_bf16 v[24:27],v[56:59],v[96:99],0
v_mfma_f32_16x16x32_bf16 v[28:31],v[60:63],v[96:99],0
v_mfma_f32_16x16x32_bf16 v[32:35],v[96:99],v[96:99],0
s_waitcnt lgkmcnt(6)
v_mfma_f32_16x16x32_bf16 v[24:27],v[64:67],v[100:103],v[24:27]
ds_read_b128 v[56:59],v11 offset:0
v_mfma_f32_16x16x32_bf16 v[28:31],v[68:71],v[100:103],v[28:31]
ds_read_b128 v[60:63],v11 offset:1024
v_mfma_f32_16x16x32_bf16 v[32:35],v[100:103],v[100:103],v[32:35]
s_waitcnt lgkmcnt(6)
v_mfma_f32_16x16x32_bf16 v[24:27],v[72:75],v[104:107],v[24:27]
ds_read_b128 v[64:67],v11 offset:2048
v_mfma_f32_16x16x32_bf16 v[28:31],v[76:79],v[104:107],v[28:31]
ds_read_b128 v[68:71],v11 offset:3072
v_mfma_f32_16x16x32_bf16 v[32:35],v[104:107],v[104:107],v[32:35]
s_waitcnt lgkmcnt(6)
v_mfma_f32_16x16x32_bf16 v[24:27],v[80:83],v[108:111],v[24:27]
ds_read_b128 v[72:75],v11 offset:4096
v_mfma_f32_16x16x32_bf16 v[28:31],v[84:87],v[108:111],v[28:31]
ds_read_b128 v[76:79],v11 offset:5120
v_mfma_f32_16x16x32_bf16 v[32:35],v[108:111],v[108:111],v[32:35]
s_waitcnt lgkmcnt(6)
v_smfmac_f32_16x16x64_bf16 v[112:115],v[44:47],v[208:215],v2
buffer_store_dwordx4 v[124:127],v0,s[8:11],s68 offen sc1
v_smfmac_f32_16x16x64_bf16 v[116:119],v[44:47],v[216:223],v2
v_smfmac_f32_16x16x64_bf16 v[112:115],v[48:51],v[224:231],v2
v_smfmac_f32_16x16x64_bf16 v[116:119],v[48:51],v[232:239],v2
v_smfmac_f32_16x16x64_bf16 v[112:115],v[52:55],v[240:247],v2
v_smfmac_f32_16x16x64_bf16 v[116:119],v[52:55],v[248:255],v2
v_mov_b32 v125,0
v_mov_b64 v[52:53],s[28:29]
v_mov_b64 v[54:55],s[28:29]
v_max3_f32 v36,v24,v25,v26
v_max3_f32 v37,v27,v28,v29
v_max3_f32 v36,v30,v31,v36
v_max3_f32 v37,v34,v35,v37
v_max_f32 v36,v36,v37
v_max_f32 v37,v36,v37
ds_read_b128 v[80:83],v11 offset:6144
s_nop 0
v_permlane16_swap_b32 v36,v37
v_max_f32 v36,v36,v37
v_max_f32 v37,v36,v37
ds_read_b128 v[84:87],v11 offset:7168
s_nop 0
v_permlane32_swap_b32 v36,v37
v_max_f32 v36,v36,v37
v_mul_f32 v36,s80,v36
v_fma_f32 v24,v24,s80,-v36
v_fma_f32 v25,v25,s80,-v36
v_exp_f32 v24,v24
v_fma_f32 v26,v26,s80,-v36
v_exp_f32 v25,v25
v_fma_f32 v27,v27,s80,-v36
v_exp_f32 v26,v26
v_fma_f32 v28,v28,s80,-v36
v_exp_f32 v27,v27
v_fma_f32 v29,v29,s80,-v36
v_exp_f32 v28,v28
v_fma_f32 v30,v30,s80,-v36
v_exp_f32 v29,v29
v_fma_f32 v31,v31,s80,-v36
v_exp_f32 v30,v30
v_fma_f32 v34,v34,s80,-v36
v_exp_f32 v31,v31
v_fma_f32 v35,v35,s80,-v36
v_exp_f32 v34,v34
v_exp_f32 v35,v35
v_cvt_pk_bf16_f32 v120,v24,v25
v_cvt_pk_bf16_f32 v121,v26,v27
v_cvt_pk_bf16_f32 v122,v28,v29
v_cvt_pk_bf16_f32 v123,v30,v31
v_cvt_pk_bf16_f32 v124,v34,v35
s_nop 0
v_mfma_f32_16x16x32_bf16 v[32:35],v[52:55],v[120:123],0
v_pk_add_f32 v[112:113],v[112:113],v[114:115]
v_pk_add_f32 v[116:117],v[116:117],v[118:119]
v_mfma_f32_16x16x32_bf16 v[24:27],v[88:91],v[120:123],0
v_cvt_pk_bf16_f32 v36,v112,v113
v_cvt_pk_bf16_f32 v37,v116,v117
v_mfma_f32_16x16x32_bf16 v[28:31],v[92:95],v[120:123],0
v_cvt_pk_bf16_f32 v38,v116,v117
v_mov_b32 v39,0
v_mfma_f32_16x16x16_bf16 v[32:35],v[52:53],v[124:125],v[32:35]
s_add_u32 s56,s68,4096
buffer_store_dwordx4 v[36:39],v0,s[8:11],s56 offen sc1
v_mfma_f32_16x16x16_bf16 v[24:27],v[36:37],v[124:125],v[24:27]
ds_read_b128 v[96:99],v11 offset:8192
v_mfma_f32_16x16x16_bf16 v[28:31],v[38:39],v[124:125],v[28:31]
ds_read_b128 v[100:103],v11 offset:9216
v_rcp_f32 v32,v32
v_mov_b64 v[112:113],0
v_mov_b64 v[114:115],0
v_pk_mul_f32 v[24:25],v[24:25],v[32:33] op_sel_hi:[1,0]
v_pk_mul_f32 v[26:27],v[26:27],v[32:33] op_sel_hi:[1,0]
v_mov_b64 v[116:117],0
v_mov_b64 v[118:119],0
v_pk_mul_f32 v[28:29],v[28:29],v[32:33] op_sel_hi:[1,0]
v_pk_mul_f32 v[30:31],v[30:31],v[32:33] op_sel_hi:[1,0]
v_cvt_pk_bf16_f32 v120,v24,v28
v_cvt_pk_bf16_f32 v121,v25,v29
v_cvt_pk_bf16_f32 v122,v26,v30
v_cvt_pk_bf16_f32 v123,v27,v31
ds_write_b128 v7,v[120:123]
ds_read_b128 v[104:107],v11 offset:10240
ds_read_b128 v[108:111],v11 offset:11264
ds_read_b128 v[40:43],v11 offset:12288
ds_read_b128 v[44:47],v11 offset:13312
s_waitcnt lgkmcnt(4)
s_barrier
ds_read_b128 v[24:27],v8 offset:0
ds_read_b128 v[28:31],v8 offset:512
ds_read_b128 v[32:35],v8 offset:1024
ds_read_b128 v[36:39],v8 offset:1536
ds_read_b128 v[48:51],v11 offset:14336
ds_read_b128 v[52:55],v11 offset:15360
v_mov_b64 v[88:89],0
v_mov_b64 v[90:91],0
v_mov_b64 v[92:93],0
v_mov_b64 v[94:95],0
s_waitcnt lgkmcnt(5)
v_smfmac_f32_16x16x64_bf16 v[112:115],v[24:27],v[56:63],v3
ds_read_b128 v[56:59],v11 offset:16384
ds_read_b128 v[60:63],v11 offset:17408
s_waitcnt lgkmcnt(6)
v_smfmac_f32_16x16x64_bf16 v[112:115],v[28:31],v[64:71],v3
ds_read_b128 v[64:67],v11 offset:18432
ds_read_b128 v[68:71],v11 offset:19456
s_waitcnt lgkmcnt(7)
v_smfmac_f32_16x16x64_bf16 v[112:115],v[32:35],v[72:79],v3
ds_read_b128 v[72:75],v11 offset:20480
ds_read_b128 v[76:79],v11 offset:21504
s_waitcnt lgkmcnt(8)
v_smfmac_f32_16x16x64_bf16 v[112:115],v[36:39],v[80:87],v3
ds_read_b128 v[80:83],v11 offset:22528
ds_read_b128 v[84:87],v11 offset:23552
s_waitcnt lgkmcnt(8)
v_smfmac_f32_16x16x64_bf16 v[116:119],v[24:27],v[96:103],v3
ds_read_b128 v[96:99],v11 offset:24576
ds_read_b128 v[100:103],v11 offset:25600
v_smfmac_f32_16x16x64_bf16 v[116:119],v[28:31],v[104:111],v3
v_cvt_pk_bf16_f32 v112,v112,v113
v_cvt_pk_bf16_f32 v113,v114,v115
buffer_store_dwordx2 v[112:113],v9,s[8:11],s65 offen
ds_read_b128 v[104:107],v11 offset:26624
ds_read_b128 v[108:111],v11 offset:27648
v_smfmac_f32_16x16x64_bf16 v[116:119],v[32:35],v[40:47],v3
ds_read_b128 v[40:43],v11 offset:28672
ds_read_b128 v[44:47],v11 offset:29696
v_smfmac_f32_16x16x64_bf16 v[116:119],v[36:39],v[48:55],v3
s_waitcnt lgkmcnt(12)
ds_read_b128 v[48:51],v11 offset:30720
ds_read_b128 v[52:55],v11 offset:31744
s_waitcnt lgkmcnt(14)
v_smfmac_f32_16x16x64_bf16 v[88:91],v[24:27],v[56:63],v3
s_nop 2
v_cvt_pk_bf16_f32 v116,v116,v117
v_cvt_pk_bf16_f32 v117,v118,v119
s_add_u32 s56,s65,65536
buffer_store_dwordx2 v[116:117],v9,s[8:11],s56 offen
s_waitcnt lgkmcnt(12)
v_smfmac_f32_16x16x64_bf16 v[88:91],v[28:31],v[64:71],v3
s_waitcnt lgkmcnt(10)
v_smfmac_f32_16x16x64_bf16 v[88:91],v[32:35],v[72:79],v3
s_waitcnt lgkmcnt(8)
v_smfmac_f32_16x16x64_bf16 v[88:91],v[36:39],v[80:87],v3
s_waitcnt lgkmcnt(6)
v_smfmac_f32_16x16x64_bf16 v[92:95],v[24:27],v[96:103],v3
s_waitcnt lgkmcnt(4)
v_smfmac_f32_16x16x64_bf16 v[92:95],v[28:31],v[104:111],v3
v_cvt_pk_bf16_f32 v88,v88,v89
v_cvt_pk_bf16_f32 v89,v90,v91
s_add_u32 s56,s65,131072
buffer_store_dwordx2 v[88:89],v9,s[8:11],s56 offen
s_waitcnt lgkmcnt(2)
v_smfmac_f32_16x16x64_bf16 v[92:95],v[32:35],v[40:47],v3
s_waitcnt lgkmcnt(0)
v_smfmac_f32_16x16x64_bf16 v[92:95],v[36:39],v[48:55],v3
s_add_u32 s78,s79,s75
s_add_u32 s75,s75,8192
s_add_u32 s64,s75,11534336
s_add_u32 s70,s64,4096
s_add_u32 s68,s68,262144
s_add_u32 s51,s51,1
s_nop 1
v_cvt_pk_bf16_f32 v92,v92,v93
v_cvt_pk_bf16_f32 v93,v94,v95
s_add_u32 s56,s65,196608
buffer_store_dwordx2 v[92:93],v9,s[8:11],s56 offen
s_xor_b32 s65,s65,262144
s_cmp_eq_u32 s51,64
s_cbranch_scc1 L_cend_112
s_cmp_lt_u32 s47,16
s_waitcnt vmcnt(2)
s_cbranch_scc1 L_cea_119
s_barrier
ds_read_b128 v[56:59],v1 offset:0
ds_read_b128 v[60:63],v1 offset:4096
ds_read_b128 v[64:67],v1 offset:1024
ds_read_b128 v[68:71],v1 offset:5120
ds_read_b128 v[72:75],v1 offset:2048
ds_read_b128 v[76:79],v1 offset:6144
ds_read_b128 v[80:83],v1 offset:3072
ds_read_b128 v[84:87],v1 offset:7168
v_add_u32 v12,s73,v1
ds_read_b128 v[88:91],v12 offset:8192
ds_read_b128 v[92:95],v12 offset:9216
v_mov_b64 v[96:97],0
v_mov_b64 v[98:99],0
v_mov_b64 v[100:101],0
v_mov_b64 v[102:103],0
v_mov_b64 v[104:105],0
v_mov_b64 v[106:107],0
v_mov_b64 v[108:109],0
v_mov_b64 v[110:111],0
v_mov_b64 v[112:113],0
v_mov_b64 v[114:115],0
v_mov_b64 v[116:117],0
v_mov_b64 v[118:119],0
v_readlane_b32 s76,v23,4
s_cmp_ge_u32 s51,63
s_cselect_b32 s76,1,s76
s_waitcnt vmcnt(0)
L_crp_114:
buffer_load_dwordx4 v[120:123],v0,s[8:11],s66 offen offset:0 sc1
buffer_load_dwordx4 v[124:127],v0,s[8:11],s66 offen offset:1024 sc1
s_sub_u32 s49,s49,1
s_cbranch_scc1 L_abort
s_waitcnt vmcnt(1)
v_mfma_f32_16x16x32_bf16 v[28:31],v[18:21],v[120:123],0
s_waitcnt vmcnt(0)
v_mfma_f32_16x16x32_bf16 v[28:31],v[18:21],v[124:127],v[28:31]
s_nop 7
v_cmp_u_f32 vcc,v28,v28
v_add_f32_dpp v32,v28,v28 row_ror:8 row_mask:0xf bank_mask:0x3
v_add_f32_dpp v33,v29,v29 row_ror:8 row_mask:0xf bank_mask:0x3
v_add_f32_dpp v32,v30,v30 row_ror:8 row_mask:0xf bank_mask:0xc
v_add_f32_dpp v33,v31,v31 row_ror:8 row_mask:0xf bank_mask:0xc
s_nop 0
v_add_f32_dpp v32,v32,v32 row_shl:4 row_mask:0xf bank_mask:0x5
v_add_f32_dpp v33,v33,v33 row_shl:4 row_mask:0xf bank_mask:0x5
s_cbranch_vccnz L_crp_114
v_cvt_pk_bf16_f32 v34,v32,v33
buffer_store_dword v34,v10,s[8:11],s64 offen
s_mov_b32 s69,s66
s_xor_b32 s66,s66,262144
buffer_load_dwordx4 v[24:27],v13,s[8:11],s64 offen sc1
s_branch L_chain_109
L_cea_119:
buffer_load_dwordx4 v[120:123],v0,s[8:11],s66 offen offset:0 sc1
buffer_load_dwordx4 v[124:127],v0,s[8:11],s66 offen offset:1024 sc1
v_mov_b64 v[96:97],0
v_mov_b64 v[98:99],0
v_mov_b64 v[100:101],0
v_mov_b64 v[102:103],0
v_mov_b64 v[104:105],0
v_mov_b64 v[106:107],0
v_mov_b64 v[108:109],0
v_mov_b64 v[110:111],0
v_mov_b64 v[112:113],0
v_mov_b64 v[114:115],0
v_mov_b64 v[116:117],0
v_mov_b64 v[118:119],0
v_readlane_b32 s76,v23,4
s_cmp_ge_u32 s51,63
s_cselect_b32 s76,1,s76
s_branch L_cr1_120
L_crb_115:
buffer_load_dwordx4 v[120:123],v0,s[8:11],s66 offen offset:0 sc1
buffer_load_dwordx4 v[124:127],v0,s[8:11],s66 offen offset:1024 sc1
L_cr1_120:
s_sub_u32 s49,s49,1
s_cbranch_scc1 L_abort
s_waitcnt vmcnt(1)
v_mfma_f32_16x16x32_bf16 v[28:31],v[18:21],v[120:123],0
s_waitcnt vmcnt(0)
v_mfma_f32_16x16x32_bf16 v[28:31],v[18:21],v[124:127],v[28:31]
s_nop 7
v_cmp_u_f32 vcc,v28,v28
v_add_f32_dpp v32,v28,v28 row_ror:8 row_mask:0xf bank_mask:0x3
v_add_f32_dpp v33,v29,v29 row_ror:8 row_mask:0xf bank_mask:0x3
v_add_f32_dpp v32,v30,v30 row_ror:8 row_mask:0xf bank_mask:0xc
v_add_f32_dpp v33,v31,v31 row_ror:8 row_mask:0xf bank_mask:0xc
s_nop 0
v_add_f32_dpp v32,v32,v32 row_shl:4 row_mask:0xf bank_mask:0x5
v_add_f32_dpp v33,v33,v33 row_shl:4 row_mask:0xf bank_mask:0x5
s_cbranch_vccnz L_crb_115
v_cvt_pk_bf16_f32 v34,v32,v33
buffer_store_dword v34,v10,s[8:11],s64 offen
s_mov_b32 s69,s66
s_xor_b32 s66,s66,262144
s_barrier
ds_read_b128 v[56:59],v1 offset:0
ds_read_b128 v[60:63],v1 offset:4096
ds_read_b128 v[64:67],v1 offset:1024
ds_read_b128 v[68:71],v1 offset:5120
buffer_load_dwordx4 v[24:27],v13,s[8:11],s64 offen sc1
ds_read_b128 v[72:75],v1 offset:2048
ds_read_b128 v[76:79],v1 offset:6144
ds_read_b128 v[80:83],v1 offset:3072
ds_read_b128 v[84:87],v1 offset:7168
v_add_u32 v12,s73,v1
ds_read_b128 v[88:91],v12 offset:8192
ds_read_b128 v[92:95],v12 offset:9216
s_branch L_chain_109
L_ckw_103:
s_lshl2_add_u32 s59,s47,s75
s_add_u32 s59,s59,10493952
L_ww_121:
buffer_load_dword v23,off,s[8:11],s59 sc1
s_sub_u32 s49,s49,1
s_cbranch_scc1 L_abort
s_waitcnt vmcnt(0)
v_readfirstlane_b32 s76,v23
s_cmp_eq_u32 s76,0
s_cbranch_scc1 L_ww_121
L_wwd_122:
s_branch L_ckb_104
L_cpb_116:
buffer_load_dwordx4 v[40:43],v13,s[8:11],s70 offen sc1
s_waitcnt vmcnt(0)
v_max3_u32 v12,v40,v41,v42
v_max_u32 v12,v43,v12
v_cmp_le_u32 vcc,s72,v12
s_cbranch_vccz L_cback_118
s_sub_u32 s49,s49,1
s_cmp_gt_i32 s49,0
s_cbranch_scc1 L_cpb_116
s_branch L_abort
L_cend_112:
s_waitcnt vmcnt(0)
s_barrier
s_nop 11
v_lshrrev_b32 v1,4,v0
s_branch L_ra_6
L_rc1_100:
v_and_b32 v120,15,v1
v_lshrrev_b32 v121,4,v1
v_and_b32 v122,2,v1
v_cmp_eq_u32 vcc,0,v122
v_mov_b32 v2,0xeeee
v_mov_b32 v123,0x4444
v_cndmask_b32 v2,v2,v123,vcc
v_and_b32 v122,1,v1
v_cmp_eq_u32 vcc,0,v122
v_mov_b32 v3,0xdddd
v_mov_b32 v123,0x8888
v_cndmask_b32 v3,v3,v123,vcc
v_lshrrev_b32 v122,1,v120
v_bfe_u32 v123,v120,2,1
v_xor_b32 v123,v123,v122
v_lshlrev_b32 v4,7,v123
v_and_b32 v123,1,v120
v_lshl_add_u32 v4,v123,6,v4
v_xor_b32 v123,v121,v122
v_and_b32 v123,3,v123
v_lshl_add_u32 v4,v123,4,v4
s_lshl_b32 s56,s46,10
s_add_u32 s56,s56,147456
v_add_u32 v4,s56,v4
v_lshlrev_b32 v122,1,v121
v_add_u32 v122,0,v122
v_and_b32 v123,1,v121
v_xor_b32 v123,v123,v122
v_lshlrev_b32 v5,7,v123
v_bfe_u32 v123,v120,3,1
v_lshl_add_u32 v5,v123,6,v5
v_xor_b32 v123,v120,v122
v_and_b32 v123,3,v123
v_lshl_add_u32 v5,v123,4,v5
v_bfe_u32 v123,v120,2,1
v_lshl_add_u32 v5,v123,3,v5
v_add_u32 v5,147456,v5
v_lshlrev_b32 v122,1,v121
v_add_u32 v122,1,v122
v_and_b32 v123,1,v121
v_xor_b32 v123,v123,v122
v_lshlrev_b32 v6,7,v123
v_bfe_u32 v123,v120,3,1
v_lshl_add_u32 v6,v123,6,v6
v_xor_b32 v123,v120,v122
v_and_b32 v123,3,v123
v_lshl_add_u32 v6,v123,4,v6
v_bfe_u32 v123,v120,2,1
v_lshl_add_u32 v6,v123,3,v6
v_add_u32 v6,147456,v6
v_lshlrev_b32 v7,7,v121
v_lshrrev_b32 v122,1,v120
v_lshl_add_u32 v8,v122,4,v7
v_add_u32 v8,151552,v8
v_lshrrev_b32 v122,2,v120
v_lshl_add_u32 v7,v122,5,v7
v_and_b32 v122,1,v120
v_lshl_add_u32 v7,v122,4,v7
v_and_b32 v122,2,v120
v_lshl_add_u32 v7,v122,10,v7
s_lshl_b32 s56,s46,9
s_add_u32 s56,s56,151552
v_add_u32 v7,s56,v7
v_lshrrev_b32 v122,3,v1
v_lshlrev_b32 v9,11,v122
v_and_b32 v122,7,v1
v_lshl_add_u32 v9,v122,3,v9
s_lshl_b32 s56,s46,14
s_lshl_b32 s57,s47,6
s_add_u32 s56,s56,s57
v_add_u32 v9,s56,v9
s_lshl_b32 s71,s47,2
s_add_u32 s71,s71,s46
s_bfe_u32 s56,s71,0x10003
s_lshl_b32 s56,s56,11
s_and_b32 s57,s71,1
s_lshl_b32 s57,s57,10
s_add_u32 s56,s56,s57
s_bfe_u32 s57,s71,0x10002
s_lshl_b32 s57,s57,9
s_add_u32 s56,s56,s57
s_bfe_u32 s57,s71,0x10001
s_lshl_b32 s57,s57,6
s_add_u32 s56,s56,s57
s_bfe_u32 s57,s71,0x10004
s_lshl_b32 s57,s57,8
s_add_u32 s56,s56,s57
s_bfe_u32 s57,s71,0x10005
s_lshl_b32 s57,s57,7
s_add_u32 s56,s56,s57
s_bfe_u32 s57,s71,0x10006
s_lshl_b32 s57,s57,12
s_add_u32 s56,s56,s57
v_and_b32 v122,3,v120
v_lshlrev_b32 v10,2,v122
v_bfe_u32 v122,v120,3,1
v_lshl_add_u32 v10,v122,4,v10
v_and_b32 v122,1,v121
v_lshl_add_u32 v10,v122,5,v10
v_add_u32 v10,s56,v10
v_and_b32 v123,36,v1
v_mov_b32 v122,0x80000000
v_cmp_eq_u32 vcc,0,v123
s_nop 1
v_cndmask_b32 v10,v122,v10,vcc
s_lshl_b32 s56,s46,15
v_add_u32 v11,s56,v0
s_lshl_b32 s71,s71,11
s_lshl_b32 s73,s46,11
s_mov_b32 s72,0xffc00000
s_mov_b32 s74,0
v_lshrrev_b32 v13,3,v1
v_lshlrev_b32 v13,9,v13
v_and_b32 v122,7,v1
v_lshl_add_u32 v13,v122,4,v13
v_and_b32 v122,15,v1
v_and_b32 v123,1,v1
v_lshlrev_b32 v123,4,v123
v_mov_b32 v124,0x3f80
v_lshlrev_b32 v124,v123,v124
v_lshrrev_b32 v122,1,v122
v_cmp_eq_u32 vcc,0,v122
s_nop 1
v_cndmask_b32 v18,0,v124,vcc
v_cmp_eq_u32 vcc,1,v122
s_nop 1
v_cndmask_b32 v19,0,v124,vcc
v_cmp_eq_u32 vcc,2,v122
s_nop 1
v_cndmask_b32 v20,0,v124,vcc
v_cmp_eq_u32 vcc,3,v122
s_nop 1
v_cndmask_b32 v21,0,v124,vcc
s_and_b32 s56,s46,1
s_lshl_b32 s56,s56,8
s_and_b32 s57,s46,2
s_lshl_b32 s57,s57,6
s_add_u32 s56,s56,s57
v_add_u32 v13,s56,v13
s_xor_b32 s56,s46,0
s_lshl_b32 s56,s56,10
s_add_u32 s56,s56,147456
v_add_u32 v14,s56,v0
s_xor_b32 s56,s46,1
s_lshl_b32 s56,s56,10
s_add_u32 s56,s56,147456
v_add_u32 v15,s56,v0
s_xor_b32 s56,s46,2
s_lshl_b32 s56,s56,10
s_add_u32 s56,s56,147456
v_add_u32 v16,s56,v0
s_xor_b32 s56,s46,3
s_lshl_b32 s56,s56,10
s_add_u32 s56,s56,147456
v_add_u32 v17,s56,v0
v_add_u32 v22,12599296,v10
s_lshl_b32 s56,s47,2
s_add_u32 s56,s56,10502272
v_writelane_b32 v22,s56,4
s_mov_b32 s56,10519808
v_writelane_b32 v22,s56,5
v_add_u32 v1,131072,v0
s_mov_b32 s65,15728640
s_add_u32 s66,s71,15728640
s_add_u32 s69,s71,15990784
s_lshl_b32 s79,s47,2
s_add_u32 s79,s79,10486272
s_cmp_eq_u32 s46,0
s_cselect_b32 s79,s79,0x80000000
s_cmp_eq_u32 s47,0
s_cselect_b32 s31,17825792,-1
s_and_b32 s31,s31,0x8fffffff
s_mov_b32 s51,0
L_cst_123:
s_lshl_b32 s59,s51,13
s_lshl2_add_u32 s59,s47,s59
s_add_u32 s59,s59,10485888
L_ww_128:
buffer_load_dword v120,off,s[8:11],s59 sc1
s_sub_u32 s49,s49,1
s_cbranch_scc1 L_abort
s_waitcnt vmcnt(0)
v_readfirstlane_b32 s61,v120
s_cmp_eq_u32 s61,0
s_cbranch_scc1 L_ww_128
L_wwd_129:
s_lshl_b32 s56,s51,5
s_add_u32 s56,s56,s47
s_mul_i32 s56,s56,24576
s_add_u32 s56,s56,150994944
s_add_u32 s67,s56,s73
s_add_u32 m0,s73,131072
s_add_u32 s57,s67,8192
buffer_load_dwordx4 v0,s[8:11],s67 offen sc1 lds
buffer_load_dwordx4 v0,s[8:11],s67 offen offset:1024 sc1 lds
s_add_u32 m0,s73,139264
s_add_u32 s67,s67,786432
buffer_load_dwordx4 v0,s[8:11],s57 offen sc1 lds
buffer_load_dwordx4 v0,s[8:11],s57 offen offset:1024 sc1 lds
s_lshl_b32 s75,s51,13
s_add_u32 s64,s75,12582912
s_add_u32 s70,s64,4096
s_lshl_b32 s68,s51,5
s_add_u32 s68,s68,s47
s_lshl_b32 s68,s68,13
s_lshl_b32 s56,s46,10
s_add_u32 s68,s68,s56
s_add_u32 s68,s68,58720256
s_sub_u32 s67,s67,0
s_mov_b32 s78,0x80000000
s_cmp_eq_u32 s51,63
s_cselect_b32 s76,1,0
s_waitcnt vmcnt(0)
s_barrier
ds_read_b128 v[56:59],v1 offset:0
ds_read_b128 v[60:63],v1 offset:4096
ds_read_b128 v[64:67],v1 offset:1024
ds_read_b128 v[68:71],v1 offset:5120
ds_read_b128 v[72:75],v1 offset:2048
ds_read_b128 v[76:79],v1 offset:6144
ds_read_b128 v[80:83],v1 offset:3072
ds_read_b128 v[84:87],v1 offset:7168
v_add_u32 v12,s73,v1
ds_read_b128 v[88:91],v12 offset:8192
ds_read_b128 v[92:95],v12 offset:9216
v_mov_b64 v[96:97],0
v_mov_b64 v[98:99],0
v_mov_b64 v[100:101],0
v_mov_b64 v[102:103],0
v_mov_b64 v[104:105],0
v_mov_b64 v[106:107],0
v_mov_b64 v[108:109],0
v_mov_b64 v[110:111],0
v_mov_b64 v[112:113],0
v_mov_b64 v[114:115],0
v_mov_b64 v[116:117],0
v_mov_b64 v[118:119],0
buffer_load_dwordx4 v[24:27],v13,s[8:11],s64 offen sc1
L_chain_130:
L_cpa_131:
buffer_load_dwordx4 v[24:27],v13,s[8:11],s64 offen sc1
s_sub_u32 s49,s49,1
s_cbranch_scc1 L_abort
s_waitcnt vmcnt(1)
v_max3_u32 v12,v24,v25,v26
v_max_u32 v12,v27,v12
v_cmp_le_u32 vcc,s72,v12
s_cbranch_vccnz L_cpa_131
L_cgo_134:
ds_write_b128 v14,v[24:27] offset:0
buffer_load_dwordx4 v[40:43],v13,s[8:11],s70 offen sc1
v_smfmac_f32_16x16x64_bf16 v[96:99],v[24:27],a[0:7],v2
s_add_u32 m0,s73,131072
v_smfmac_f32_16x16x64_bf16 v[100:103],v[24:27],a[128:135],v2
s_add_u32 s57,s67,8192
v_smfmac_f32_16x16x64_bf16 v[104:107],v[24:27],a[8:15],v2
s_add_u32 s30,s31,s75
v_smfmac_f32_16x16x64_bf16 v[108:111],v[24:27],a[136:143],v2
s_add_u32 s58,s30,4096
s_waitcnt lgkmcnt(0)
s_barrier
ds_read_b128 v[28:31],v15 offset:0
ds_read_b128 v[32:35],v16 offset:0
ds_read_b128 v[36:39],v17 offset:0
v_smfmac_f32_16x16x64_bf16 v[112:115],v[24:27],v[128:135],v2
v_smfmac_f32_16x16x64_bf16 v[116:119],v[24:27],v[136:143],v2
s_waitcnt lgkmcnt(2)
v_smfmac_f32_16x16x64_bf16 v[96:99],v[28:31],a[16:23],v2
s_lshl_b32 s56,s46,10
v_smfmac_f32_16x16x64_bf16 v[100:103],v[28:31],a[144:151],v2
v_smfmac_f32_16x16x64_bf16 v[104:107],v[28:31],a[24:31],v2
v_smfmac_f32_16x16x64_bf16 v[108:111],v[28:31],a[152:159],v2
s_waitcnt lgkmcnt(1) vmcnt(0)
v_smfmac_f32_16x16x64_bf16 v[96:99],v[32:35],a[32:39],v2
v_max3_u32 v12,v40,v41,v42
v_smfmac_f32_16x16x64_bf16 v[100:103],v[32:35],a[160:167],v2
v_max_u32 v12,v43,v12
v_smfmac_f32_16x16x64_bf16 v[104:107],v[32:35],a[40:47],v2
v_cmp_le_u32 vcc,s72,v12
v_smfmac_f32_16x16x64_bf16 v[108:111],v[32:35],a[168:175],v2
s_cbranch_vccnz L_cpb_137
L_cback_139:
s_waitcnt lgkmcnt(0)
ds_write_b128 v14,v[40:43] offset:4096
v_smfmac_f32_16x16x64_bf16 v[96:99],v[36:39],a[48:55],v2
v_mov_b64 v[120:121],-1
v_smfmac_f32_16x16x64_bf16 v[100:103],v[36:39],a[176:183],v2
v_mov_b64 v[122:123],-1
v_smfmac_f32_16x16x64_bf16 v[104:107],v[36:39],a[56:63],v2
v_add_u32 v124,s56,v5
v_smfmac_f32_16x16x64_bf16 v[108:111],v[36:39],a[184:191],v2
v_add_u32 v126,s56,v6
s_waitcnt lgkmcnt(0)
s_barrier
v_smfmac_f32_16x16x64_bf16 v[96:99],v[40:43],a[64:71],v2
ds_read_b128 v[44:47],v15 offset:4096
v_smfmac_f32_16x16x64_bf16 v[100:103],v[40:43],a[192:199],v2
ds_read_b128 v[48:51],v16 offset:4096
v_smfmac_f32_16x16x64_bf16 v[104:107],v[40:43],a[72:79],v2
ds_read_b128 v[52:55],v17 offset:4096
v_smfmac_f32_16x16x64_bf16 v[108:111],v[40:43],a[200:207],v2
s_cmp_eq_u32 s76,0
s_cbranch_scc1 L_ckw_124
L_ckb_125:
s_waitcnt lgkmcnt(2)
v_smfmac_f32_16x16x64_bf16 v[96:99],v[44:47],a[80:87],v2
buffer_load_dwordx4 v0,s[8:11],s67 offen sc1 lds
v_smfmac_f32_16x16x64_bf16 v[100:103],v[44:47],a[208:215],v2
buffer_load_dwordx4 v0,s[8:11],s67 offen offset:1024 sc1 lds
v_smfmac_f32_16x16x64_bf16 v[104:107],v[44:47],a[88:95],v2
s_add_u32 m0,s73,139264
v_smfmac_f32_16x16x64_bf16 v[108:111],v[44:47],a[216:223],v2
s_waitcnt lgkmcnt(1)
v_smfmac_f32_16x16x64_bf16 v[96:99],v[48:51],a[96:103],v2
s_add_u32 s67,s67,786432
v_smfmac_f32_16x16x64_bf16 v[100:103],v[48:51],a[224:231],v2
buffer_load_dwordx4 v0,s[8:11],s57 offen sc1 lds
v_smfmac_f32_16x16x64_bf16 v[104:107],v[48:51],a[104:111],v2
buffer_load_dwordx4 v0,s[8:11],s57 offen offset:1024 sc1 lds
v_smfmac_f32_16x16x64_bf16 v[108:111],v[48:51],a[232:239],v2
s_waitcnt lgkmcnt(0)
v_smfmac_f32_16x16x64_bf16 v[96:99],v[52:55],a[112:119],v2
buffer_load_dword v23,v22,s[8:11],s75 offen sc1
v_smfmac_f32_16x16x64_bf16 v[100:103],v[52:55],a[240:247],v2
buffer_store_dword v2,off,s[8:11],s78 sc1
v_smfmac_f32_16x16x64_bf16 v[104:107],v[52:55],a[120:127],v2
buffer_store_dwordx4 v[120:123],v0,s[8:11],s69 offen
v_smfmac_f32_16x16x64_bf16 v[108:111],v[52:55],a[248:255],v2
buffer_store_dwordx4 v[120:123],v0,s[8:11],s69 offen offset:1024
buffer_store_dwordx4 v[24:27],v13,s[8:11],s30 offen sc1
buffer_store_dwordx4 v[40:43],v13,s[8:11],s58 offen sc1
v_smfmac_f32_16x16x64_bf16 v[112:115],v[28:31],v[144:151],v2
v_smfmac_f32_16x16x64_bf16 v[116:119],v[28:31],v[152:159],v2
v_pk_add_f32 v[96:97],v[96:97],v[98:99]
v_pk_add_f32 v[100:101],v[100:101],v[102:103]
v_cvt_pk_bf16_f32 v120,v96,v97
v_cvt_pk_bf16_f32 v121,v100,v101
v_pk_add_f32 v[104:105],v[104:105],v[106:107]
v_pk_add_f32 v[108:109],v[108:109],v[110:111]
v_cvt_pk_bf16_f32 v122,v104,v105
v_cvt_pk_bf16_f32 v123,v108,v109
ds_write_b128 v4,v[120:123]
v_smfmac_f32_16x16x64_bf16 v[112:115],v[32:35],v[160:167],v2
v_smfmac_f32_16x16x64_bf16 v[116:119],v[32:35],v[168:175],v2
v_smfmac_f32_16x16x64_bf16 v[112:115],v[36:39],v[176:183],v2
v_smfmac_f32_16x16x64_bf16 v[116:119],v[36:39],v[184:191],v2
s_waitcnt lgkmcnt(0)
s_barrier
ds_read_b64_tr_b16 v[96:97],v5 offset:0
ds_read_b64_tr_b16 v[98:99],v6 offset:0
ds_read_b64_tr_b16 v[100:101],v5 offset:1024
ds_read_b64_tr_b16 v[102:103],v6 offset:1024
ds_read_b64_tr_b16 v[104:105],v5 offset:2048
ds_read_b64_tr_b16 v[106:107],v6 offset:2048
ds_read_b64_tr_b16 v[108:109],v5 offset:3072
ds_read_b64_tr_b16 v[110:111],v6 offset:3072
ds_read_b64_tr_b16 v[124:125],v124
ds_read_b64_tr_b16 v[126:127],v126
v_smfmac_f32_16x16x64_bf16 v[112:115],v[40:43],v[192:199],v2
v_smfmac_f32_16x16x64_bf16 v[116:119],v[40:43],v[200:207],v2
s_waitcnt lgkmcnt(8)
v_mfma_f32_16x16x32_bf16 v[24:27],v[56:59],v[96:99],0
v_mfma_f32_16x16x32_bf16 v[28:31],v[60:63],v[96:99],0
v_mfma_f32_16x16x32_bf16 v[32:35],v[96:99],v[96:99],0
s_waitcnt lgkmcnt(6)
v_mfma_f32_16x16x32_bf16 v[24:27],v[64:67],v[100:103],v[24:27]
ds_read_b128 v[56:59],v11 offset:0
v_mfma_f32_16x16x32_bf16 v[28:31],v[68:71],v[100:103],v[28:31]
ds_read_b128 v[60:63],v11 offset:1024
v_mfma_f32_16x16x32_bf16 v[32:35],v[100:103],v[100:103],v[32:35]
s_waitcnt lgkmcnt(6)
v_mfma_f32_16x16x32_bf16 v[24:27],v[72:75],v[104:107],v[24:27]
ds_read_b128 v[64:67],v11 offset:2048
v_mfma_f32_16x16x32_bf16 v[28:31],v[76:79],v[104:107],v[28:31]
ds_read_b128 v[68:71],v11 offset:3072
v_mfma_f32_16x16x32_bf16 v[32:35],v[104:107],v[104:107],v[32:35]
s_waitcnt lgkmcnt(6)
v_mfma_f32_16x16x32_bf16 v[24:27],v[80:83],v[108:111],v[24:27]
ds_read_b128 v[72:75],v11 offset:4096
v_mfma_f32_16x16x32_bf16 v[28:31],v[84:87],v[108:111],v[28:31]
ds_read_b128 v[76:79],v11 offset:5120
v_mfma_f32_16x16x32_bf16 v[32:35],v[108:111],v[108:111],v[32:35]
s_waitcnt lgkmcnt(6)
v_smfmac_f32_16x16x64_bf16 v[112:115],v[44:47],v[208:215],v2
buffer_store_dwordx4 v[124:127],v0,s[8:11],s68 offen sc1
v_smfmac_f32_16x16x64_bf16 v[116:119],v[44:47],v[216:223],v2
v_smfmac_f32_16x16x64_bf16 v[112:115],v[48:51],v[224:231],v2
v_smfmac_f32_16x16x64_bf16 v[116:119],v[48:51],v[232:239],v2
v_smfmac_f32_16x16x64_bf16 v[112:115],v[52:55],v[240:247],v2
v_smfmac_f32_16x16x64_bf16 v[116:119],v[52:55],v[248:255],v2
v_mov_b32 v125,0
v_mov_b64 v[52:53],s[28:29]
v_mov_b64 v[54:55],s[28:29]
v_max3_f32 v36,v24,v25,v26
v_max3_f32 v37,v27,v28,v29
v_max3_f32 v36,v30,v31,v36
v_max3_f32 v37,v34,v35,v37
v_max_f32 v36,v36,v37
v_max_f32 v37,v36,v37
ds_read_b128 v[80:83],v11 offset:6144
s_nop 0
v_permlane16_swap_b32 v36,v37
v_max_f32 v36,v36,v37
v_max_f32 v37,v36,v37
ds_read_b128 v[84:87],v11 offset:7168
s_nop 0
v_permlane32_swap_b32 v36,v37
v_max_f32 v36,v36,v37
v_mul_f32 v36,s80,v36
v_fma_f32 v24,v24,s80,-v36
v_fma_f32 v25,v25,s80,-v36
v_exp_f32 v24,v24
v_fma_f32 v26,v26,s80,-v36
v_exp_f32 v25,v25
v_fma_f32 v27,v27,s80,-v36
v_exp_f32 v26,v26
v_fma_f32 v28,v28,s80,-v36
v_exp_f32 v27,v27
v_fma_f32 v29,v29,s80,-v36
v_exp_f32 v28,v28
v_fma_f32 v30,v30,s80,-v36
v_exp_f32 v29,v29
v_fma_f32 v31,v31,s80,-v36
v_exp_f32 v30,v30
v_fma_f32 v34,v34,s80,-v36
v_exp_f32 v31,v31
v_fma_f32 v35,v35,s80,-v36
v_exp_f32 v34,v34
v_exp_f32 v35,v35
v_cvt_pk_bf16_f32 v120,v24,v25
v_cvt_pk_bf16_f32 v121,v26,v27
v_cvt_pk_bf16_f32 v122,v28,v29
v_cvt_pk_bf16_f32 v123,v30,v31
v_cvt_pk_bf16_f32 v124,v34,v35
s_nop 0
v_mfma_f32_16x16x32_bf16 v[32:35],v[52:55],v[120:123],0
v_pk_add_f32 v[112:113],v[112:113],v[114:115]
v_pk_add_f32 v[116:117],v[116:117],v[118:119]
v_mfma_f32_16x16x32_bf16 v[24:27],v[88:91],v[120:123],0
v_cvt_pk_bf16_f32 v36,v112,v113
v_cvt_pk_bf16_f32 v37,v116,v117
v_mfma_f32_16x16x32_bf16 v[28:31],v[92:95],v[120:123],0
v_cvt_pk_bf16_f32 v38,v116,v117
v_mov_b32 v39,0
v_mfma_f32_16x16x16_bf16 v[32:35],v[52:53],v[124:125],v[32:35]
s_add_u32 s56,s68,4096
buffer_store_dwordx4 v[36:39],v0,s[8:11],s56 offen sc1
v_mfma_f32_16x16x16_bf16 v[24:27],v[36:37],v[124:125],v[24:27]
ds_read_b128 v[96:99],v11 offset:8192
v_mfma_f32_16x16x16_bf16 v[28:31],v[38:39],v[124:125],v[28:31]
ds_read_b128 v[100:103],v11 offset:9216
v_rcp_f32 v32,v32
v_mov_b64 v[112:113],0
v_mov_b64 v[114:115],0
v_pk_mul_f32 v[24:25],v[24:25],v[32:33] op_sel_hi:[1,0]
v_pk_mul_f32 v[26:27],v[26:27],v[32:33] op_sel_hi:[1,0]
v_mov_b64 v[116:117],0
v_mov_b64 v[118:119],0
v_pk_mul_f32 v[28:29],v[28:29],v[32:33] op_sel_hi:[1,0]
v_pk_mul_f32 v[30:31],v[30:31],v[32:33] op_sel_hi:[1,0]
v_cvt_pk_bf16_f32 v120,v24,v28
v_cvt_pk_bf16_f32 v121,v25,v29
v_cvt_pk_bf16_f32 v122,v26,v30
v_cvt_pk_bf16_f32 v123,v27,v31
ds_write_b128 v7,v[120:123]
ds_read_b128 v[104:107],v11 offset:10240
ds_read_b128 v[108:111],v11 offset:11264
ds_read_b128 v[40:43],v11 offset:12288
ds_read_b128 v[44:47],v11 offset:13312
s_waitcnt lgkmcnt(4)
s_barrier
ds_read_b128 v[24:27],v8 offset:0
ds_read_b128 v[28:31],v8 offset:512
ds_read_b128 v[32:35],v8 offset:1024
ds_read_b128 v[36:39],v8 offset:1536
ds_read_b128 v[48:51],v11 offset:14336
ds_read_b128 v[52:55],v11 offset:15360
v_mov_b64 v[88:89],0
v_mov_b64 v[90:91],0
v_mov_b64 v[92:93],0
v_mov_b64 v[94:95],0
s_waitcnt lgkmcnt(5)
v_smfmac_f32_16x16x64_bf16 v[112:115],v[24:27],v[56:63],v3
ds_read_b128 v[56:59],v11 offset:16384
ds_read_b128 v[60:63],v11 offset:17408
s_waitcnt lgkmcnt(6)
v_smfmac_f32_16x16x64_bf16 v[112:115],v[28:31],v[64:71],v3
ds_read_b128 v[64:67],v11 offset:18432
ds_read_b128 v[68:71],v11 offset:19456
s_waitcnt lgkmcnt(7)
v_smfmac_f32_16x16x64_bf16 v[112:115],v[32:35],v[72:79],v3
ds_read_b128 v[72:75],v11 offset:20480
ds_read_b128 v[76:79],v11 offset:21504
s_waitcnt lgkmcnt(8)
v_smfmac_f32_16x16x64_bf16 v[112:115],v[36:39],v[80:87],v3
ds_read_b128 v[80:83],v11 offset:22528
ds_read_b128 v[84:87],v11 offset:23552
s_waitcnt lgkmcnt(8)
v_smfmac_f32_16x16x64_bf16 v[116:119],v[24:27],v[96:103],v3
ds_read_b128 v[96:99],v11 offset:24576
ds_read_b128 v[100:103],v11 offset:25600
v_smfmac_f32_16x16x64_bf16 v[116:119],v[28:31],v[104:111],v3
v_cvt_pk_bf16_f32 v112,v112,v113
v_cvt_pk_bf16_f32 v113,v114,v115
buffer_store_dwordx2 v[112:113],v9,s[8:11],s65 offen
ds_read_b128 v[104:107],v11 offset:26624
ds_read_b128 v[108:111],v11 offset:27648
v_smfmac_f32_16x16x64_bf16 v[116:119],v[32:35],v[40:47],v3
ds_read_b128 v[40:43],v11 offset:28672
ds_read_b128 v[44:47],v11 offset:29696
v_smfmac_f32_16x16x64_bf16 v[116:119],v[36:39],v[48:55],v3
s_waitcnt lgkmcnt(12)
ds_read_b128 v[48:51],v11 offset:30720
ds_read_b128 v[52:55],v11 offset:31744
s_waitcnt lgkmcnt(14)
v_smfmac_f32_16x16x64_bf16 v[88:91],v[24:27],v[56:63],v3
s_nop 2
v_cvt_pk_bf16_f32 v116,v116,v117
v_cvt_pk_bf16_f32 v117,v118,v119
s_add_u32 s56,s65,65536
buffer_store_dwordx2 v[116:117],v9,s[8:11],s56 offen
s_waitcnt lgkmcnt(12)
v_smfmac_f32_16x16x64_bf16 v[88:91],v[28:31],v[64:71],v3
s_waitcnt lgkmcnt(10)
v_smfmac_f32_16x16x64_bf16 v[88:91],v[32:35],v[72:79],v3
s_waitcnt lgkmcnt(8)
v_smfmac_f32_16x16x64_bf16 v[88:91],v[36:39],v[80:87],v3
s_waitcnt lgkmcnt(6)
v_smfmac_f32_16x16x64_bf16 v[92:95],v[24:27],v[96:103],v3
s_waitcnt lgkmcnt(4)
v_smfmac_f32_16x16x64_bf16 v[92:95],v[28:31],v[104:111],v3
v_cvt_pk_bf16_f32 v88,v88,v89
v_cvt_pk_bf16_f32 v89,v90,v91
s_add_u32 s56,s65,131072
buffer_store_dwordx2 v[88:89],v9,s[8:11],s56 offen
s_waitcnt lgkmcnt(2)
v_smfmac_f32_16x16x64_bf16 v[92:95],v[32:35],v[40:47],v3
s_waitcnt lgkmcnt(0)
v_smfmac_f32_16x16x64_bf16 v[92:95],v[36:39],v[48:55],v3
s_add_u32 s78,s79,s75
s_add_u32 s75,s75,8192
s_add_u32 s64,s75,12582912
s_add_u32 s70,s64,4096
s_add_u32 s68,s68,262144
s_add_u32 s51,s51,1
s_nop 1
v_cvt_pk_bf16_f32 v92,v92,v93
v_cvt_pk_bf16_f32 v93,v94,v95
s_add_u32 s56,s65,196608
buffer_store_dwordx2 v[92:93],v9,s[8:11],s56 offen
s_xor_b32 s65,s65,262144
s_cmp_eq_u32 s51,64
s_cbranch_scc1 L_cend_133
s_cmp_lt_u32 s47,16
s_waitcnt vmcnt(2)
s_cbranch_scc1 L_cea_140
s_barrier
ds_read_b128 v[56:59],v1 offset:0
ds_read_b128 v[60:63],v1 offset:4096
ds_read_b128 v[64:67],v1 offset:1024
ds_read_b128 v[68:71],v1 offset:5120
ds_read_b128 v[72:75],v1 offset:2048
ds_read_b128 v[76:79],v1 offset:6144
ds_read_b128 v[80:83],v1 offset:3072
ds_read_b128 v[84:87],v1 offset:7168
v_add_u32 v12,s73,v1
ds_read_b128 v[88:91],v12 offset:8192
ds_read_b128 v[92:95],v12 offset:9216
v_mov_b64 v[96:97],0
v_mov_b64 v[98:99],0
v_mov_b64 v[100:101],0
v_mov_b64 v[102:103],0
v_mov_b64 v[104:105],0
v_mov_b64 v[106:107],0
v_mov_b64 v[108:109],0
v_mov_b64 v[110:111],0
v_mov_b64 v[112:113],0
v_mov_b64 v[114:115],0
v_mov_b64 v[116:117],0
v_mov_b64 v[118:119],0
v_readlane_b32 s76,v23,4
s_cmp_ge_u32 s51,63
s_cselect_b32 s76,1,s76
s_waitcnt vmcnt(0)
L_crp_135:
buffer_load_dwordx4 v[120:123],v0,s[8:11],s66 offen offset:0 sc1
buffer_load_dwordx4 v[124:127],v0,s[8:11],s66 offen offset:1024 sc1
s_sub_u32 s49,s49,1
s_cbranch_scc1 L_abort
s_waitcnt vmcnt(1)
v_mfma_f32_16x16x32_bf16 v[28:31],v[18:21],v[120:123],0
s_waitcnt vmcnt(0)
v_mfma_f32_16x16x32_bf16 v[28:31],v[18:21],v[124:127],v[28:31]
s_nop 7
v_cmp_u_f32 vcc,v28,v28
v_add_f32_dpp v32,v28,v28 row_ror:8 row_mask:0xf bank_mask:0x3
v_add_f32_dpp v33,v29,v29 row_ror:8 row_mask:0xf bank_mask:0x3
v_add_f32_dpp v32,v30,v30 row_ror:8 row_mask:0xf bank_mask:0xc
v_add_f32_dpp v33,v31,v31 row_ror:8 row_mask:0xf bank_mask:0xc
s_nop 0
v_add_f32_dpp v32,v32,v32 row_shl:4 row_mask:0xf bank_mask:0x5
v_add_f32_dpp v33,v33,v33 row_shl:4 row_mask:0xf bank_mask:0x5
s_cbranch_vccnz L_crp_135
v_cvt_pk_bf16_f32 v34,v32,v33
buffer_store_dword v34,v10,s[8:11],s64 offen
s_mov_b32 s69,s66
s_xor_b32 s66,s66,262144
buffer_load_dwordx4 v[24:27],v13,s[8:11],s64 offen sc1
s_branch L_chain_130
L_cea_140:
buffer_load_dwordx4 v[120:123],v0,s[8:11],s66 offen offset:0 sc1
buffer_load_dwordx4 v[124:127],v0,s[8:11],s66 offen offset:1024 sc1
v_mov_b64 v[96:97],0
v_mov_b64 v[98:99],0
v_mov_b64 v[100:101],0
v_mov_b64 v[102:103],0
v_mov_b64 v[104:105],0
v_mov_b64 v[106:107],0
v_mov_b64 v[108:109],0
v_mov_b64 v[110:111],0
v_mov_b64 v[112:113],0
v_mov_b64 v[114:115],0
v_mov_b64 v[116:117],0
v_mov_b64 v[118:119],0
v_readlane_b32 s76,v23,4
s_cmp_ge_u32 s51,63
s_cselect_b32 s76,1,s76
s_branch L_cr1_141
L_crb_136:
buffer_load_dwordx4 v[120:123],v0,s[8:11],s66 offen offset:0 sc1
buffer_load_dwordx4 v[124:127],v0,s[8:11],s66 offen offset:1024 sc1
L_cr1_141:
s_sub_u32 s49,s49,1
s_cbranch_scc1 L_abort
s_waitcnt vmcnt(1)
v_mfma_f32_16x16x32_bf16 v[28:31],v[18:21],v[120:123],0
s_waitcnt vmcnt(0)
v_mfma_f32_16x16x32_bf16 v[28:31],v[18:21],v[124:127],v[28:31]
s_nop 7
v_cmp_u_f32 vcc,v28,v28
v_add_f32_dpp v32,v28,v28 row_ror:8 row_mask:0xf bank_mask:0x3
v_add_f32_dpp v33,v29,v29 row_ror:8 row_mask:0xf bank_mask:0x3
v_add_f32_dpp v32,v30,v30 row_ror:8 row_mask:0xf bank_mask:0xc
v_add_f32_dpp v33,v31,v31 row_ror:8 row_mask:0xf bank_mask:0xc
s_nop 0
v_add_f32_dpp v32,v32,v32 row_shl:4 row_mask:0xf bank_mask:0x5
v_add_f32_dpp v33,v33,v33 row_shl:4 row_mask:0xf bank_mask:0x5
s_cbranch_vccnz L_crb_136
v_cvt_pk_bf16_f32 v34,v32,v33
buffer_store_dword v34,v10,s[8:11],s64 offen
s_mov_b32 s69,s66
s_xor_b32 s66,s66,262144
s_barrier
ds_read_b128 v[56:59],v1 offset:0
ds_read_b128 v[60:63],v1 offset:4096
ds_read_b128 v[64:67],v1 offset:1024
ds_read_b128 v[68:71],v1 offset:5120
buffer_load_dwordx4 v[24:27],v13,s[8:11],s64 offen sc1
ds_read_b128 v[72:75],v1 offset:2048
ds_read_b128 v[76:79],v1 offset:6144
ds_read_b128 v[80:83],v1 offset:3072
ds_read_b128 v[84:87],v1 offset:7168
v_add_u32 v12,s73,v1
ds_read_b128 v[88:91],v12 offset:8192
ds_read_b128 v[92:95],v12 offset:9216
s_branch L_chain_130
L_ckw_124:
s_lshl2_add_u32 s59,s47,s75
s_add_u32 s59,s59,10494080
L_ww_142:
buffer_load_dword v23,off,s[8:11],s59 sc1
s_sub_u32 s49,s49,1
s_cbranch_scc1 L_abort
s_waitcnt vmcnt(0)
v_readfirstlane_b32 s76,v23
s_cmp_eq_u32 s76,0
s_cbranch_scc1 L_ww_142
L_wwd_143:
s_branch L_ckb_125
L_cpb_137:
buffer_load_dwordx4 v[40:43],v13,s[8:11],s70 offen sc1
s_waitcnt vmcnt(0)
v_max3_u32 v12,v40,v41,v42
v_max_u32 v12,v43,v12
v_cmp_le_u32 vcc,s72,v12
s_cbranch_vccz L_cback_139
s_sub_u32 s49,s49,1
s_cmp_gt_i32 s49,0
s_cbranch_scc1 L_cpb_137
s_branch L_abort
L_cend_133:
s_waitcnt vmcnt(0)
s_barrier
buffer_store_dword v2,off,s[8:11],s78 sc1
s_nop 11
v_lshrrev_b32 v1,4,v0
s_endpgm
L_rc2_101:
v_and_b32 v120,15,v1
v_lshrrev_b32 v121,4,v1
v_and_b32 v122,2,v1
v_cmp_eq_u32 vcc,0,v122
v_mov_b32 v2,0xeeee
v_mov_b32 v123,0x4444
v_cndmask_b32 v2,v2,v123,vcc
v_and_b32 v122,1,v1
v_cmp_eq_u32 vcc,0,v122
v_mov_b32 v3,0xdddd
v_mov_b32 v123,0x8888
v_cndmask_b32 v3,v3,v123,vcc
v_lshrrev_b32 v122,1,v120
v_bfe_u32 v123,v120,2,1
v_xor_b32 v123,v123,v122
v_lshlrev_b32 v4,7,v123
v_and_b32 v123,1,v120
v_lshl_add_u32 v4,v123,6,v4
v_xor_b32 v123,v121,v122
v_and_b32 v123,3,v123
v_lshl_add_u32 v4,v123,4,v4
s_lshl_b32 s56,s46,10
s_add_u32 s56,s56,147456
v_add_u32 v4,s56,v4
v_lshlrev_b32 v122,1,v121
v_add_u32 v122,0,v122
v_and_b32 v123,1,v121
v_xor_b32 v123,v123,v122
v_lshlrev_b32 v5,7,v123
v_bfe_u32 v123,v120,3,1
v_lshl_add_u32 v5,v123,6,v5
v_xor_b32 v123,v120,v122
v_and_b32 v123,3,v123
v_lshl_add_u32 v5,v123,4,v5
v_bfe_u32 v123,v120,2,1
v_lshl_add_u32 v5,v123,3,v5
v_add_u32 v5,147456,v5
v_lshlrev_b32 v122,1,v121
v_add_u32 v122,1,v122
v_and_b32 v123,1,v121
v_xor_b32 v123,v123,v122
v_lshlrev_b32 v6,7,v123
v_bfe_u32 v123,v120,3,1
v_lshl_add_u32 v6,v123,6,v6
v_xor_b32 v123,v120,v122
v_and_b32 v123,3,v123
v_lshl_add_u32 v6,v123,4,v6
v_bfe_u32 v123,v120,2,1
v_lshl_add_u32 v6,v123,3,v6
v_add_u32 v6,147456,v6
v_lshlrev_b32 v7,7,v121
v_lshrrev_b32 v122,1,v120
v_lshl_add_u32 v8,v122,4,v7
v_add_u32 v8,151552,v8
v_lshrrev_b32 v122,2,v120
v_lshl_add_u32 v7,v122,5,v7
v_and_b32 v122,1,v120
v_lshl_add_u32 v7,v122,4,v7
v_and_b32 v122,2,v120
v_lshl_add_u32 v7,v122,10,v7
s_lshl_b32 s56,s46,9
s_add_u32 s56,s56,151552
v_add_u32 v7,s56,v7
v_lshrrev_b32 v122,3,v1
v_lshlrev_b32 v9,11,v122
v_and_b32 v122,7,v1
v_lshl_add_u32 v9,v122,3,v9
s_lshl_b32 s56,s46,14
s_lshl_b32 s57,s47,6
s_add_u32 s56,s56,s57
v_add_u32 v9,s56,v9
s_lshl_b32 s71,s47,2
s_add_u32 s71,s71,s46
s_bfe_u32 s56,s71,0x10003
s_lshl_b32 s56,s56,11
s_and_b32 s57,s71,1
s_lshl_b32 s57,s57,10
s_add_u32 s56,s56,s57
s_bfe_u32 s57,s71,0x10002
s_lshl_b32 s57,s57,9
s_add_u32 s56,s56,s57
s_bfe_u32 s57,s71,0x10001
s_lshl_b32 s57,s57,6
s_add_u32 s56,s56,s57
s_bfe_u32 s57,s71,0x10004
s_lshl_b32 s57,s57,8
s_add_u32 s56,s56,s57
s_bfe_u32 s57,s71,0x10005
s_lshl_b32 s57,s57,7
s_add_u32 s56,s56,s57
s_bfe_u32 s57,s71,0x10006
s_lshl_b32 s57,s57,12
s_add_u32 s56,s56,s57
v_and_b32 v122,3,v120
v_lshlrev_b32 v10,2,v122
v_bfe_u32 v122,v120,3,1
v_lshl_add_u32 v10,v122,4,v10
v_and_b32 v122,1,v121
v_lshl_add_u32 v10,v122,5,v10
v_add_u32 v10,s56,v10
v_and_b32 v123,36,v1
v_mov_b32 v122,0x80000000
v_cmp_eq_u32 vcc,0,v123
s_nop 1
v_cndmask_b32 v10,v122,v10,vcc
s_lshl_b32 s56,s46,15
v_add_u32 v11,s56,v0
s_lshl_b32 s71,s71,11
s_lshl_b32 s73,s46,11
s_mov_b32 s72,0xffc00000
s_mov_b32 s74,0
v_lshrrev_b32 v13,3,v1
v_lshlrev_b32 v13,9,v13
v_and_b32 v122,7,v1
v_lshl_add_u32 v13,v122,4,v13
v_and_b32 v122,15,v1
v_and_b32 v123,1,v1
v_lshlrev_b32 v123,4,v123
v_mov_b32 v124,0x3f80
v_lshlrev_b32 v124,v123,v124
v_lshrrev_b32 v122,1,v122
v_cmp_eq_u32 vcc,0,v122
s_nop 1
v_cndmask_b32 v18,0,v124,vcc
v_cmp_eq_u32 vcc,1,v122
s_nop 1
v_cndmask_b32 v19,0,v124,vcc
v_cmp_eq_u32 vcc,2,v122
s_nop 1
v_cndmask_b32 v20,0,v124,vcc
v_cmp_eq_u32 vcc,3,v122
s_nop 1
v_cndmask_b32 v21,0,v124,vcc
s_and_b32 s56,s46,1
s_lshl_b32 s56,s56,8
s_and_b32 s57,s46,2
s_lshl_b32 s57,s57,6
s_add_u32 s56,s56,s57
v_add_u32 v13,s56,v13
s_xor_b32 s56,s46,0
s_lshl_b32 s56,s56,10
s_add_u32 s56,s56,147456
v_add_u32 v14,s56,v0
s_xor_b32 s56,s46,1
s_lshl_b32 s56,s56,10
s_add_u32 s56,s56,147456
v_add_u32 v15,s56,v0
s_xor_b32 s56,s46,2
s_lshl_b32 s56,s56,10
s_add_u32 s56,s56,147456
v_add_u32 v16,s56,v0
s_xor_b32 s56,s46,3
s_lshl_b32 s56,s56,10
s_add_u32 s56,s56,147456
v_add_u32 v17,s56,v0
v_add_u32 v22,13647872,v10
s_lshl_b32 s56,s47,2
s_add_u32 s56,s56,10502272
v_writelane_b32 v22,s56,4
s_mov_b32 s56,10519808
v_writelane_b32 v22,s56,5
v_add_u32 v1,131072,v0
s_mov_b32 s65,16777216
s_add_u32 s66,s71,16777216
s_add_u32 s69,s71,17039360
s_lshl_b32 s79,s47,2
s_add_u32 s79,s79,10486400
s_cmp_eq_u32 s46,0
s_cselect_b32 s79,s79,0x80000000
s_cmp_eq_u32 s47,0
s_cselect_b32 s31,17825792,-1
s_and_b32 s31,s31,0x8fffffff
s_mov_b32 s51,0
L_cst_144:
s_mov_b32 s60,s51
L_csc_149:
s_add_u32 s60,s60,1
s_add_u32 s61,s51,3
s_min_u32 s61,s61,63
s_cmp_gt_u32 s60,s61
s_cbranch_scc1 L_csd_150
s_lshl_b32 s59,s60,13
s_add_u32 s59,s59,10487040
L_ww_151:
buffer_load_dword v120,off,s[8:11],s59 sc1
s_sub_u32 s49,s49,1
s_cbranch_scc1 L_abort
s_waitcnt vmcnt(0)
v_readfirstlane_b32 s61,v120
s_cmp_eq_u32 s61,0
s_cbranch_scc1 L_ww_151
L_wwd_152:
s_cmp_eq_u32 s61,2
s_cselect_b32 s51,s60,s51
s_branch L_csc_149
L_csd_150:
s_lshl_b32 s59,s51,13
s_lshl2_add_u32 s59,s47,s59
s_add_u32 s59,s59,10486016
L_ww_153:
buffer_load_dword v120,off,s[8:11],s59 sc1
s_sub_u32 s49,s49,1
s_cbranch_scc1 L_abort
s_waitcnt vmcnt(0)
v_readfirstlane_b32 s61,v120
s_cmp_eq_u32 s61,0
s_cbranch_scc1 L_ww_153
L_wwd_154:
s_lshl_b32 s56,s51,5
s_add_u32 s56,s56,s47
s_mul_i32 s56,s56,24576
s_add_u32 s56,s56,201326592
s_add_u32 s67,s56,s73
s_add_u32 m0,s73,131072
s_add_u32 s57,s67,8192
buffer_load_dwordx4 v0,s[8:11],s67 offen sc1 lds
buffer_load_dwordx4 v0,s[8:11],s67 offen offset:1024 sc1 lds
s_add_u32 m0,s73,139264
s_add_u32 s67,s67,786432
buffer_load_dwordx4 v0,s[8:11],s57 offen sc1 lds
buffer_load_dwordx4 v0,s[8:11],s57 offen offset:1024 sc1 lds
s_lshl_b32 s75,s51,13
s_add_u32 s64,s75,17825792
s_add_u32 s70,s64,4096
s_lshl_b32 s68,s51,5
s_add_u32 s68,s68,s47
s_lshl_b32 s68,s68,13
s_lshl_b32 s56,s46,10
s_add_u32 s68,s68,s56
s_add_u32 s68,s68,75497472
s_sub_u32 s67,s67,50331648
s_mov_b32 s78,0x80000000
s_cmp_eq_u32 s51,63
s_cselect_b32 s76,1,0
s_waitcnt vmcnt(0)
s_barrier
ds_read_b128 v[56:59],v1 offset:0
ds_read_b128 v[60:63],v1 offset:4096
ds_read_b128 v[64:67],v1 offset:1024
ds_read_b128 v[68:71],v1 offset:5120
ds_read_b128 v[72:75],v1 offset:2048
ds_read_b128 v[76:79],v1 offset:6144
ds_read_b128 v[80:83],v1 offset:3072
ds_read_b128 v[84:87],v1 offset:7168
v_add_u32 v12,s73,v1
ds_read_b128 v[88:91],v12 offset:8192
ds_read_b128 v[92:95],v12 offset:9216
v_mov_b64 v[96:97],0
v_mov_b64 v[98:99],0
v_mov_b64 v[100:101],0
v_mov_b64 v[102:103],0
v_mov_b64 v[104:105],0
v_mov_b64 v[106:107],0
v_mov_b64 v[108:109],0
v_mov_b64 v[110:111],0
v_mov_b64 v[112:113],0
v_mov_b64 v[114:115],0
v_mov_b64 v[116:117],0
v_mov_b64 v[118:119],0
buffer_load_dwordx4 v[24:27],v13,s[8:11],s64 offen sc1
L_chain_155:
L_cpa_156:
buffer_load_dwordx4 v[24:27],v13,s[8:11],s64 offen sc1
s_sub_u32 s49,s49,1
s_cbranch_scc1 L_abort
s_waitcnt vmcnt(1)
v_max3_u32 v12,v24,v25,v26
v_max_u32 v12,v27,v12
v_cmp_le_u32 vcc,s72,v12
s_cbranch_vccnz L_cpa_156
L_cgo_159:
ds_write_b128 v14,v[24:27] offset:0
buffer_load_dwordx4 v[40:43],v13,s[8:11],s70 offen sc1
v_smfmac_f32_16x16x64_bf16 v[96:99],v[24:27],a[0:7],v2
s_add_u32 m0,s73,131072
v_smfmac_f32_16x16x64_bf16 v[100:103],v[24:27],a[128:135],v2
s_add_u32 s57,s67,8192
v_smfmac_f32_16x16x64_bf16 v[104:107],v[24:27],a[8:15],v2
v_smfmac_f32_16x16x64_bf16 v[108:111],v[24:27],a[136:143],v2
s_waitcnt lgkmcnt(0)
s_barrier
ds_read_b128 v[28:31],v15 offset:0
ds_read_b128 v[32:35],v16 offset:0
ds_read_b128 v[36:39],v17 offset:0
v_smfmac_f32_16x16x64_bf16 v[112:115],v[24:27],v[128:135],v2
v_smfmac_f32_16x16x64_bf16 v[116:119],v[24:27],v[136:143],v2
s_waitcnt lgkmcnt(2)
v_smfmac_f32_16x16x64_bf16 v[96:99],v[28:31],a[16:23],v2
s_lshl_b32 s56,s46,10
v_smfmac_f32_16x16x64_bf16 v[100:103],v[28:31],a[144:151],v2
v_smfmac_f32_16x16x64_bf16 v[104:107],v[28:31],a[24:31],v2
v_smfmac_f32_16x16x64_bf16 v[108:111],v[28:31],a[152:159],v2
s_waitcnt lgkmcnt(1) vmcnt(0)
v_smfmac_f32_16x16x64_bf16 v[96:99],v[32:35],a[32:39],v2
v_max3_u32 v12,v40,v41,v42
v_smfmac_f32_16x16x64_bf16 v[100:103],v[32:35],a[160:167],v2
v_max_u32 v12,v43,v12
v_smfmac_f32_16x16x64_bf16 v[104:107],v[32:35],a[40:47],v2
v_cmp_le_u32 vcc,s72,v12
v_smfmac_f32_16x16x64_bf16 v[108:111],v[32:35],a[168:175],v2
s_cbranch_vccnz L_cpb_162
L_cback_164:
s_waitcnt lgkmcnt(0)
ds_write_b128 v14,v[40:43] offset:4096
v_smfmac_f32_16x16x64_bf16 v[96:99],v[36:39],a[48:55],v2
v_mov_b64 v[120:121],-1
v_smfmac_f32_16x16x64_bf16 v[100:103],v[36:39],a[176:183],v2
v_mov_b64 v[122:123],-1
v_smfmac_f32_16x16x64_bf16 v[104:107],v[36:39],a[56:63],v2
v_add_u32 v124,s56,v5
v_smfmac_f32_16x16x64_bf16 v[108:111],v[36:39],a[184:191],v2
v_add_u32 v126,s56,v6
s_waitcnt lgkmcnt(0)
s_barrier
v_smfmac_f32_16x16x64_bf16 v[96:99],v[40:43],a[64:71],v2
ds_read_b128 v[44:47],v15 offset:4096
v_smfmac_f32_16x16x64_bf16 v[100:103],v[40:43],a[192:199],v2
ds_read_b128 v[48:51],v16 offset:4096
v_smfmac_f32_16x16x64_bf16 v[104:107],v[40:43],a[72:79],v2
ds_read_b128 v[52:55],v17 offset:4096
v_smfmac_f32_16x16x64_bf16 v[108:111],v[40:43],a[200:207],v2
s_cmp_eq_u32 s76,0
s_cbranch_scc1 L_ckw_145
L_ckb_146:
s_waitcnt lgkmcnt(2)
v_smfmac_f32_16x16x64_bf16 v[96:99],v[44:47],a[80:87],v2
buffer_load_dwordx4 v0,s[8:11],s67 offen sc1 lds
v_smfmac_f32_16x16x64_bf16 v[100:103],v[44:47],a[208:215],v2
buffer_load_dwordx4 v0,s[8:11],s67 offen offset:1024 sc1 lds
v_smfmac_f32_16x16x64_bf16 v[104:107],v[44:47],a[88:95],v2
s_add_u32 m0,s73,139264
v_smfmac_f32_16x16x64_bf16 v[108:111],v[44:47],a[216:223],v2
s_waitcnt lgkmcnt(1)
v_smfmac_f32_16x16x64_bf16 v[96:99],v[48:51],a[96:103],v2
s_add_u32 s67,s67,786432
v_smfmac_f32_16x16x64_bf16 v[100:103],v[48:51],a[224:231],v2
buffer_load_dwordx4 v0,s[8:11],s57 offen sc1 lds
v_smfmac_f32_16x16x64_bf16 v[104:107],v[48:51],a[104:111],v2
buffer_load_dwordx4 v0,s[8:11],s57 offen offset:1024 sc1 lds
v_smfmac_f32_16x16x64_bf16 v[108:111],v[48:51],a[232:239],v2
s_waitcnt lgkmcnt(0)
v_smfmac_f32_16x16x64_bf16 v[96:99],v[52:55],a[112:119],v2
buffer_load_dword v23,v22,s[8:11],s75 offen sc1
v_smfmac_f32_16x16x64_bf16 v[100:103],v[52:55],a[240:247],v2
buffer_store_dword v2,off,s[8:11],s78 sc1
v_smfmac_f32_16x16x64_bf16 v[104:107],v[52:55],a[120:127],v2
buffer_store_dwordx4 v[120:123],v0,s[8:11],s69 offen
v_smfmac_f32_16x16x64_bf16 v[108:111],v[52:55],a[248:255],v2
buffer_store_dwordx4 v[120:123],v0,s[8:11],s69 offen offset:1024
v_smfmac_f32_16x16x64_bf16 v[112:115],v[28:31],v[144:151],v2
v_smfmac_f32_16x16x64_bf16 v[116:119],v[28:31],v[152:159],v2
v_pk_add_f32 v[96:97],v[96:97],v[98:99]
v_pk_add_f32 v[100:101],v[100:101],v[102:103]
v_cvt_pk_bf16_f32 v120,v96,v97
v_cvt_pk_bf16_f32 v121,v100,v101
v_pk_add_f32 v[104:105],v[104:105],v[106:107]
v_pk_add_f32 v[108:109],v[108:109],v[110:111]
v_cvt_pk_bf16_f32 v122,v104,v105
v_cvt_pk_bf16_f32 v123,v108,v109
ds_write_b128 v4,v[120:123]
v_smfmac_f32_16x16x64_bf16 v[112:115],v[32:35],v[160:167],v2
v_smfmac_f32_16x16x64_bf16 v[116:119],v[32:35],v[168:175],v2
v_smfmac_f32_16x16x64_bf16 v[112:115],v[36:39],v[176:183],v2
v_smfmac_f32_16x16x64_bf16 v[116:119],v[36:39],v[184:191],v2
s_waitcnt lgkmcnt(0)
s_barrier
ds_read_b64_tr_b16 v[96:97],v5 offset:0
ds_read_b64_tr_b16 v[98:99],v6 offset:0
ds_read_b64_tr_b16 v[100:101],v5 offset:1024
ds_read_b64_tr_b16 v[102:103],v6 offset:1024
ds_read_b64_tr_b16 v[104:105],v5 offset:2048
ds_read_b64_tr_b16 v[106:107],v6 offset:2048
ds_read_b64_tr_b16 v[108:109],v5 offset:3072
ds_read_b64_tr_b16 v[110:111],v6 offset:3072
ds_read_b64_tr_b16 v[124:125],v124
ds_read_b64_tr_b16 v[126:127],v126
v_smfmac_f32_16x16x64_bf16 v[112:115],v[40:43],v[192:199],v2
v_smfmac_f32_16x16x64_bf16 v[116:119],v[40:43],v[200:207],v2
s_waitcnt lgkmcnt(8)
v_mfma_f32_16x16x32_bf16 v[24:27],v[56:59],v[96:99],0
v_mfma_f32_16x16x32_bf16 v[28:31],v[60:63],v[96:99],0
v_mfma_f32_16x16x32_bf16 v[32:35],v[96:99],v[96:99],0
s_waitcnt lgkmcnt(6)
v_mfma_f32_16x16x32_bf16 v[24:27],v[64:67],v[100:103],v[24:27]
ds_read_b128 v[56:59],v11 offset:0
v_mfma_f32_16x16x32_bf16 v[28:31],v[68:71],v[100:103],v[28:31]
ds_read_b128 v[60:63],v11 offset:1024
v_mfma_f32_16x16x32_bf16 v[32:35],v[100:103],v[100:103],v[32:35]
s_waitcnt lgkmcnt(6)
v_mfma_f32_16x16x32_bf16 v[24:27],v[72:75],v[104:107],v[24:27]
ds_read_b128 v[64:67],v11 offset:2048
v_mfma_f32_16x16x32_bf16 v[28:31],v[76:79],v[104:107],v[28:31]
ds_read_b128 v[68:71],v11 offset:3072
v_mfma_f32_16x16x32_bf16 v[32:35],v[104:107],v[104:107],v[32:35]
s_waitcnt lgkmcnt(6)
v_mfma_f32_16x16x32_bf16 v[24:27],v[80:83],v[108:111],v[24:27]
ds_read_b128 v[72:75],v11 offset:4096
v_mfma_f32_16x16x32_bf16 v[28:31],v[84:87],v[108:111],v[28:31]
ds_read_b128 v[76:79],v11 offset:5120
v_mfma_f32_16x16x32_bf16 v[32:35],v[108:111],v[108:111],v[32:35]
s_waitcnt lgkmcnt(6)
v_smfmac_f32_16x16x64_bf16 v[112:115],v[44:47],v[208:215],v2
buffer_store_dwordx4 v[124:127],v0,s[8:11],s68 offen sc1
v_smfmac_f32_16x16x64_bf16 v[116:119],v[44:47],v[216:223],v2
v_smfmac_f32_16x16x64_bf16 v[112:115],v[48:51],v[224:231],v2
v_smfmac_f32_16x16x64_bf16 v[116:119],v[48:51],v[232:239],v2
v_smfmac_f32_16x16x64_bf16 v[112:115],v[52:55],v[240:247],v2
v_smfmac_f32_16x16x64_bf16 v[116:119],v[52:55],v[248:255],v2
v_mov_b32 v125,0
v_mov_b64 v[52:53],s[28:29]
v_mov_b64 v[54:55],s[28:29]
v_max3_f32 v36,v24,v25,v26
v_max3_f32 v37,v27,v28,v29
v_max3_f32 v36,v30,v31,v36
v_max3_f32 v37,v34,v35,v37
v_max_f32 v36,v36,v37
v_max_f32 v37,v36,v37
ds_read_b128 v[80:83],v11 offset:6144
s_nop 0
v_permlane16_swap_b32 v36,v37
v_max_f32 v36,v36,v37
v_max_f32 v37,v36,v37
ds_read_b128 v[84:87],v11 offset:7168
s_nop 0
v_permlane32_swap_b32 v36,v37
v_max_f32 v36,v36,v37
v_mul_f32 v36,s80,v36
v_fma_f32 v24,v24,s80,-v36
v_fma_f32 v25,v25,s80,-v36
v_exp_f32 v24,v24
v_fma_f32 v26,v26,s80,-v36
v_exp_f32 v25,v25
v_fma_f32 v27,v27,s80,-v36
v_exp_f32 v26,v26
v_fma_f32 v28,v28,s80,-v36
v_exp_f32 v27,v27
v_fma_f32 v29,v29,s80,-v36
v_exp_f32 v28,v28
v_fma_f32 v30,v30,s80,-v36
v_exp_f32 v29,v29
v_fma_f32 v31,v31,s80,-v36
v_exp_f32 v30,v30
v_fma_f32 v34,v34,s80,-v36
v_exp_f32 v31,v31
v_fma_f32 v35,v35,s80,-v36
v_exp_f32 v34,v34
v_exp_f32 v35,v35
v_cvt_pk_bf16_f32 v120,v24,v25
v_cvt_pk_bf16_f32 v121,v26,v27
v_cvt_pk_bf16_f32 v122,v28,v29
v_cvt_pk_bf16_f32 v123,v30,v31
v_cvt_pk_bf16_f32 v124,v34,v35
s_nop 0
v_mfma_f32_16x16x32_bf16 v[32:35],v[52:55],v[120:123],0
v_pk_add_f32 v[112:113],v[112:113],v[114:115]
v_pk_add_f32 v[116:117],v[116:117],v[118:119]
v_mfma_f32_16x16x32_bf16 v[24:27],v[88:91],v[120:123],0
v_cvt_pk_bf16_f32 v36,v112,v113
v_cvt_pk_bf16_f32 v37,v116,v117
v_mfma_f32_16x16x32_bf16 v[28:31],v[92:95],v[120:123],0
v_cvt_pk_bf16_f32 v38,v116,v117
v_mov_b32 v39,0
v_mfma_f32_16x16x16_bf16 v[32:35],v[52:53],v[124:125],v[32:35]
s_add_u32 s56,s68,4096
buffer_store_dwordx4 v[36:39],v0,s[8:11],s56 offen sc1
v_mfma_f32_16x16x16_bf16 v[24:27],v[36:37],v[124:125],v[24:27]
ds_read_b128 v[96:99],v11 offset:8192
v_mfma_f32_16x16x16_bf16 v[28:31],v[38:39],v[124:125],v[28:31]
ds_read_b128 v[100:103],v11 offset:9216
v_rcp_f32 v32,v32
v_mov_b64 v[112:113],0
v_mov_b64 v[114:115],0
v_pk_mul_f32 v[24:25],v[24:25],v[32:33] op_sel_hi:[1,0]
v_pk_mul_f32 v[26:27],v[26:27],v[32:33] op_sel_hi:[1,0]
v_mov_b64 v[116:117],0
v_mov_b64 v[118:119],0
v_pk_mul_f32 v[28:29],v[28:29],v[32:33] op_sel_hi:[1,0]
v_pk_mul_f32 v[30:31],v[30:31],v[32:33] op_sel_hi:[1,0]
v_cvt_pk_bf16_f32 v120,v24,v28
v_cvt_pk_bf16_f32 v121,v25,v29
v_cvt_pk_bf16_f32 v122,v26,v30
v_cvt_pk_bf16_f32 v123,v27,v31
ds_write_b128 v7,v[120:123]
ds_read_b128 v[104:107],v11 offset:10240
ds_read_b128 v[108:111],v11 offset:11264
ds_read_b128 v[40:43],v11 offset:12288
ds_read_b128 v[44:47],v11 offset:13312
s_waitcnt lgkmcnt(4)
s_barrier
ds_read_b128 v[24:27],v8 offset:0
ds_read_b128 v[28:31],v8 offset:512
ds_read_b128 v[32:35],v8 offset:1024
ds_read_b128 v[36:39],v8 offset:1536
ds_read_b128 v[48:51],v11 offset:14336
ds_read_b128 v[52:55],v11 offset:15360
v_mov_b64 v[88:89],0
v_mov_b64 v[90:91],0
v_mov_b64 v[92:93],0
v_mov_b64 v[94:95],0
s_waitcnt lgkmcnt(5)
v_smfmac_f32_16x16x64_bf16 v[112:115],v[24:27],v[56:63],v3
ds_read_b128 v[56:59],v11 offset:16384
ds_read_b128 v[60:63],v11 offset:17408
s_waitcnt lgkmcnt(6)
v_smfmac_f32_16x16x64_bf16 v[112:115],v[28:31],v[64:71],v3
ds_read_b128 v[64:67],v11 offset:18432
ds_read_b128 v[68:71],v11 offset:19456
s_waitcnt lgkmcnt(7)
v_smfmac_f32_16x16x64_bf16 v[112:115],v[32:35],v[72:79],v3
ds_read_b128 v[72:75],v11 offset:20480
ds_read_b128 v[76:79],v11 offset:21504
s_waitcnt lgkmcnt(8)
v_smfmac_f32_16x16x64_bf16 v[112:115],v[36:39],v[80:87],v3
ds_read_b128 v[80:83],v11 offset:22528
ds_read_b128 v[84:87],v11 offset:23552
s_waitcnt lgkmcnt(8)
v_smfmac_f32_16x16x64_bf16 v[116:119],v[24:27],v[96:103],v3
ds_read_b128 v[96:99],v11 offset:24576
ds_read_b128 v[100:103],v11 offset:25600
v_smfmac_f32_16x16x64_bf16 v[116:119],v[28:31],v[104:111],v3
v_cvt_pk_bf16_f32 v112,v112,v113
v_cvt_pk_bf16_f32 v113,v114,v115
buffer_store_dwordx2 v[112:113],v9,s[8:11],s65 offen
ds_read_b128 v[104:107],v11 offset:26624
ds_read_b128 v[108:111],v11 offset:27648
v_smfmac_f32_16x16x64_bf16 v[116:119],v[32:35],v[40:47],v3
ds_read_b128 v[40:43],v11 offset:28672
ds_read_b128 v[44:47],v11 offset:29696
v_smfmac_f32_16x16x64_bf16 v[116:119],v[36:39],v[48:55],v3
s_waitcnt lgkmcnt(12)
ds_read_b128 v[48:51],v11 offset:30720
ds_read_b128 v[52:55],v11 offset:31744
s_waitcnt lgkmcnt(14)
v_smfmac_f32_16x16x64_bf16 v[88:91],v[24:27],v[56:63],v3
s_nop 2
v_cvt_pk_bf16_f32 v116,v116,v117
v_cvt_pk_bf16_f32 v117,v118,v119
s_add_u32 s56,s65,65536
buffer_store_dwordx2 v[116:117],v9,s[8:11],s56 offen
s_waitcnt lgkmcnt(12)
v_smfmac_f32_16x16x64_bf16 v[88:91],v[28:31],v[64:71],v3
s_waitcnt lgkmcnt(10)
v_smfmac_f32_16x16x64_bf16 v[88:91],v[32:35],v[72:79],v3
s_waitcnt lgkmcnt(8)
v_smfmac_f32_16x16x64_bf16 v[88:91],v[36:39],v[80:87],v3
s_waitcnt lgkmcnt(6)
v_smfmac_f32_16x16x64_bf16 v[92:95],v[24:27],v[96:103],v3
s_waitcnt lgkmcnt(4)
v_smfmac_f32_16x16x64_bf16 v[92:95],v[28:31],v[104:111],v3
v_cvt_pk_bf16_f32 v88,v88,v89
v_cvt_pk_bf16_f32 v89,v90,v91
s_add_u32 s56,s65,131072
buffer_store_dwordx2 v[88:89],v9,s[8:11],s56 offen
s_waitcnt lgkmcnt(2)
v_smfmac_f32_16x16x64_bf16 v[92:95],v[32:35],v[40:47],v3
s_waitcnt lgkmcnt(0)
v_smfmac_f32_16x16x64_bf16 v[92:95],v[36:39],v[48:55],v3
s_add_u32 s78,s79,s75
s_add_u32 s75,s75,8192
s_add_u32 s64,s75,13631488
s_add_u32 s70,s64,4096
s_add_u32 s68,s68,262144
s_add_u32 s51,s51,1
s_nop 1
v_cvt_pk_bf16_f32 v92,v92,v93
v_cvt_pk_bf16_f32 v93,v94,v95
s_add_u32 s56,s65,196608
buffer_store_dwordx2 v[92:93],v9,s[8:11],s56 offen
s_xor_b32 s65,s65,262144
s_cmp_eq_u32 s51,64
s_cbranch_scc1 L_cend_158
s_cmp_lt_u32 s47,16
s_waitcnt vmcnt(2)
s_cbranch_scc1 L_cea_165
s_barrier
ds_read_b128 v[56:59],v1 offset:0
ds_read_b128 v[60:63],v1 offset:4096
ds_read_b128 v[64:67],v1 offset:1024
ds_read_b128 v[68:71],v1 offset:5120
ds_read_b128 v[72:75],v1 offset:2048
ds_read_b128 v[76:79],v1 offset:6144
ds_read_b128 v[80:83],v1 offset:3072
ds_read_b128 v[84:87],v1 offset:7168
v_add_u32 v12,s73,v1
ds_read_b128 v[88:91],v12 offset:8192
ds_read_b128 v[92:95],v12 offset:9216
v_mov_b64 v[96:97],0
v_mov_b64 v[98:99],0
v_mov_b64 v[100:101],0
v_mov_b64 v[102:103],0
v_mov_b64 v[104:105],0
v_mov_b64 v[106:107],0
v_mov_b64 v[108:109],0
v_mov_b64 v[110:111],0
v_mov_b64 v[112:113],0
v_mov_b64 v[114:115],0
v_mov_b64 v[116:117],0
v_mov_b64 v[118:119],0
v_readlane_b32 s76,v23,4
s_cmp_ge_u32 s51,63
s_cselect_b32 s76,1,s76
v_readlane_b32 s77,v23,5
s_cmp_gt_u32 s51,60
s_cselect_b32 s77,1,s77
s_waitcnt vmcnt(0)
L_crp_160:
buffer_load_dwordx4 v[120:123],v0,s[8:11],s66 offen offset:0 sc1
buffer_load_dwordx4 v[124:127],v0,s[8:11],s66 offen offset:1024 sc1
s_sub_u32 s49,s49,1
s_cbranch_scc1 L_abort
s_waitcnt vmcnt(1)
v_mfma_f32_16x16x32_bf16 v[28:31],v[18:21],v[120:123],0
s_waitcnt vmcnt(0)
v_mfma_f32_16x16x32_bf16 v[28:31],v[18:21],v[124:127],v[28:31]
s_nop 7
v_cmp_u_f32 vcc,v28,v28
v_add_f32_dpp v32,v28,v28 row_ror:8 row_mask:0xf bank_mask:0x3
v_add_f32_dpp v33,v29,v29 row_ror:8 row_mask:0xf bank_mask:0x3
v_add_f32_dpp v32,v30,v30 row_ror:8 row_mask:0xf bank_mask:0xc
v_add_f32_dpp v33,v31,v31 row_ror:8 row_mask:0xf bank_mask:0xc
s_nop 0
v_add_f32_dpp v32,v32,v32 row_shl:4 row_mask:0xf bank_mask:0x5
v_add_f32_dpp v33,v33,v33 row_shl:4 row_mask:0xf bank_mask:0x5
s_cbranch_vccnz L_crp_160
v_cvt_pk_bf16_f32 v34,v32,v33
buffer_store_dword v34,v10,s[8:11],s64 offen
s_mov_b32 s69,s66
s_xor_b32 s66,s66,262144
buffer_load_dwordx4 v[24:27],v13,s[8:11],s64 offen sc1
s_cmp_lg_u32 s77,1
s_cbranch_scc1 L_cjw_147
s_branch L_chain_155
L_cea_165:
buffer_load_dwordx4 v[120:123],v0,s[8:11],s66 offen offset:0 sc1
buffer_load_dwordx4 v[124:127],v0,s[8:11],s66 offen offset:1024 sc1
v_mov_b64 v[96:97],0
v_mov_b64 v[98:99],0
v_mov_b64 v[100:101],0
v_mov_b64 v[102:103],0
v_mov_b64 v[104:105],0
v_mov_b64 v[106:107],0
v_mov_b64 v[108:109],0
v_mov_b64 v[110:111],0
v_mov_b64 v[112:113],0
v_mov_b64 v[114:115],0
v_mov_b64 v[116:117],0
v_mov_b64 v[118:119],0
v_readlane_b32 s76,v23,4
s_cmp_ge_u32 s51,63
s_cselect_b32 s76,1,s76
v_readlane_b32 s77,v23,5
s_cmp_gt_u32 s51,60
s_cselect_b32 s77,1,s77
s_branch L_cr1_166
L_crb_161:
buffer_load_dwordx4 v[120:123],v0,s[8:11],s66 offen offset:0 sc1
buffer_load_dwordx4 v[124:127],v0,s[8:11],s66 offen offset:1024 sc1
L_cr1_166:
s_sub_u32 s49,s49,1
s_cbranch_scc1 L_abort
s_waitcnt vmcnt(1)
v_mfma_f32_16x16x32_bf16 v[28:31],v[18:21],v[120:123],0
s_waitcnt vmcnt(0)
v_mfma_f32_16x16x32_bf16 v[28:31],v[18:21],v[124:127],v[28:31]
s_nop 7
v_cmp_u_f32 vcc,v28,v28
v_add_f32_dpp v32,v28,v28 row_ror:8 row_mask:0xf bank_mask:0x3
v_add_f32_dpp v33,v29,v29 row_ror:8 row_mask:0xf bank_mask:0x3
v_add_f32_dpp v32,v30,v30 row_ror:8 row_mask:0xf bank_mask:0xc
v_add_f32_dpp v33,v31,v31 row_ror:8 row_mask:0xf bank_mask:0xc
s_nop 0
v_add_f32_dpp v32,v32,v32 row_shl:4 row_mask:0xf bank_mask:0x5
v_add_f32_dpp v33,v33,v33 row_shl:4 row_mask:0xf bank_mask:0x5
s_cbranch_vccnz L_crb_161
v_cvt_pk_bf16_f32 v34,v32,v33
buffer_store_dword v34,v10,s[8:11],s64 offen
s_mov_b32 s69,s66
s_xor_b32 s66,s66,262144
s_barrier
ds_read_b128 v[56:59],v1 offset:0
ds_read_b128 v[60:63],v1 offset:4096
ds_read_b128 v[64:67],v1 offset:1024
ds_read_b128 v[68:71],v1 offset:5120
buffer_load_dwordx4 v[24:27],v13,s[8:11],s64 offen sc1
ds_read_b128 v[72:75],v1 offset:2048
ds_read_b128 v[76:79],v1 offset:6144
ds_read_b128 v[80:83],v1 offset:3072
ds_read_b128 v[84:87],v1 offset:7168
v_add_u32 v12,s73,v1
ds_read_b128 v[88:91],v12 offset:8192
ds_read_b128 v[92:95],v12 offset:9216
s_cmp_lg_u32 s77,1
s_cbranch_scc1 L_cjw_147
s_branch L_chain_155
L_ckw_145:
s_lshl2_add_u32 s59,s47,s75
s_add_u32 s59,s59,10494080
L_ww_167:
buffer_load_dword v23,off,s[8:11],s59 sc1
s_sub_u32 s49,s49,1
s_cbranch_scc1 L_abort
s_waitcnt vmcnt(0)
v_readfirstlane_b32 s76,v23
s_cmp_eq_u32 s76,0
s_cbranch_scc1 L_ww_167
L_wwd_168:
s_branch L_ckb_146
L_cjw_147:
s_add_u32 s59,s75,10511616
L_ww_169:
buffer_load_dword v120,off,s[8:11],s59 sc1
s_sub_u32 s49,s49,1
s_cbranch_scc1 L_abort
s_waitcnt vmcnt(0)
v_readfirstlane_b32 s77,v120
s_cmp_eq_u32 s77,0
s_cbranch_scc1 L_ww_169
L_wwd_170:
s_cmp_eq_u32 s77,1
s_cbranch_scc1 L_chain_155
L_cjump_148:
buffer_load_dwordx4 v[24:27],v13,s[8:11],s64 offen sc1
buffer_load_dwordx4 v[40:43],v13,s[8:11],s70 offen sc1
s_sub_u32 s49,s49,1
s_cbranch_scc1 L_abort
s_waitcnt vmcnt(0)
v_max3_u32 v12,v24,v25,v26
v_max_u32 v12,v27,v12
v_max3_u32 v12,v40,v41,v12
v_max3_u32 v12,v42,v43,v12
v_cmp_le_u32 vcc,s72,v12
s_cbranch_vccnz L_cjump_148
s_waitcnt lgkmcnt(0)
s_barrier
s_add_u32 s51,s51,3
s_branch L_cst_144
L_cpb_162:
buffer_load_dwordx4 v[40:43],v13,s[8:11],s70 offen sc1
s_waitcnt vmcnt(0)
v_max3_u32 v12,v40,v41,v42
v_max_u32 v12,v43,v12
v_cmp_le_u32 vcc,s72,v12
s_cbranch_vccz L_cback_164
s_sub_u32 s49,s49,1
s_cmp_gt_i32 s49,0
s_cbranch_scc1 L_cpb_162
s_branch L_abort
L_cend_158:
s_waitcnt vmcnt(0)
s_barrier
buffer_store_dword v2,off,s[8:11],s78 sc1
s_nop 11
v_lshrrev_b32 v1,4,v0
s_endpgm
L_abort2:
s_endpgm
L_wc:
s_nop 11
s_cmp_eq_u32 s48,1
s_cbranch_scc1 L_rc1_171
s_cmp_eq_u32 s48,2
s_cbranch_scc1 L_rc2_172
v_and_b32 v120,15,v1
v_lshrrev_b32 v121,4,v1
v_and_b32 v122,2,v1
v_cmp_eq_u32 vcc,0,v122
v_mov_b32 v2,0xeeee
v_mov_b32 v123,0x4444
v_cndmask_b32 v2,v2,v123,vcc
v_and_b32 v122,1,v1
v_cmp_eq_u32 vcc,0,v122
v_mov_b32 v3,0xdddd
v_mov_b32 v123,0x8888
v_cndmask_b32 v3,v3,v123,vcc
v_lshrrev_b32 v122,1,v120
v_bfe_u32 v123,v120,2,1
v_xor_b32 v123,v123,v122
v_lshlrev_b32 v4,7,v123
v_and_b32 v123,1,v120
v_lshl_add_u32 v4,v123,6,v4
v_xor_b32 v123,v121,v122
v_and_b32 v123,3,v123
v_lshl_add_u32 v4,v123,4,v4
s_lshl_b32 s56,s46,10
s_add_u32 s56,s56,147456
v_add_u32 v4,s56,v4
v_lshlrev_b32 v122,1,v121
v_add_u32 v122,0,v122
v_and_b32 v123,1,v121
v_xor_b32 v123,v123,v122
v_lshlrev_b32 v5,7,v123
v_bfe_u32 v123,v120,3,1
v_lshl_add_u32 v5,v123,6,v5
v_xor_b32 v123,v120,v122
v_and_b32 v123,3,v123
v_lshl_add_u32 v5,v123,4,v5
v_bfe_u32 v123,v120,2,1
v_lshl_add_u32 v5,v123,3,v5
v_add_u32 v5,147456,v5
v_lshlrev_b32 v122,1,v121
v_add_u32 v122,1,v122
v_and_b32 v123,1,v121
v_xor_b32 v123,v123,v122
v_lshlrev_b32 v6,7,v123
v_bfe_u32 v123,v120,3,1
v_lshl_add_u32 v6,v123,6,v6
v_xor_b32 v123,v120,v122
v_and_b32 v123,3,v123
v_lshl_add_u32 v6,v123,4,v6
v_bfe_u32 v123,v120,2,1
v_lshl_add_u32 v6,v123,3,v6
v_add_u32 v6,147456,v6
v_lshlrev_b32 v7,7,v121
v_lshrrev_b32 v122,1,v120
v_lshl_add_u32 v8,v122,4,v7
v_add_u32 v8,151552,v8
v_lshrrev_b32 v122,2,v120
v_lshl_add_u32 v7,v122,5,v7
v_and_b32 v122,1,v120
v_lshl_add_u32 v7,v122,4,v7
v_and_b32 v122,2,v120
v_lshl_add_u32 v7,v122,10,v7
s_lshl_b32 s56,s46,9
s_add_u32 s56,s56,151552
v_add_u32 v7,s56,v7
v_lshrrev_b32 v122,3,v1
v_lshlrev_b32 v9,11,v122
v_and_b32 v122,7,v1
v_lshl_add_u32 v9,v122,3,v9
s_lshl_b32 s56,s46,14
s_lshl_b32 s57,s47,6
s_add_u32 s56,s56,s57
v_add_u32 v9,s56,v9
s_lshl_b32 s71,s47,2
s_add_u32 s71,s71,s46
s_bfe_u32 s56,s71,0x10003
s_lshl_b32 s56,s56,11
s_and_b32 s57,s71,1
s_lshl_b32 s57,s57,10
s_add_u32 s56,s56,s57
s_bfe_u32 s57,s71,0x10002
s_lshl_b32 s57,s57,9
s_add_u32 s56,s56,s57
s_bfe_u32 s57,s71,0x10001
s_lshl_b32 s57,s57,6
s_add_u32 s56,s56,s57
s_bfe_u32 s57,s71,0x10004
s_lshl_b32 s57,s57,8
s_add_u32 s56,s56,s57
s_bfe_u32 s57,s71,0x10005
s_lshl_b32 s57,s57,7
s_add_u32 s56,s56,s57
s_bfe_u32 s57,s71,0x10006
s_lshl_b32 s57,s57,12
s_add_u32 s56,s56,s57
v_and_b32 v122,3,v120
v_lshlrev_b32 v10,2,v122
v_bfe_u32 v122,v120,3,1
v_lshl_add_u32 v10,v122,4,v10
v_and_b32 v122,1,v121
v_lshl_add_u32 v10,v122,5,v10
v_add_u32 v10,s56,v10
v_and_b32 v123,36,v1
v_mov_b32 v122,0x80000000
v_cmp_eq_u32 vcc,0,v123
s_nop 1
v_cndmask_b32 v10,v122,v10,vcc
s_lshl_b32 s56,s46,15
v_add_u32 v11,s56,v0
s_lshl_b32 s71,s71,11
s_lshl_b32 s73,s46,11
s_mov_b32 s72,0xffc00000
s_mov_b32 s74,0
v_lshrrev_b32 v13,3,v1
v_lshlrev_b32 v13,9,v13
v_and_b32 v122,7,v1
v_lshl_add_u32 v13,v122,4,v13
v_and_b32 v122,15,v1
v_and_b32 v123,1,v1
v_lshlrev_b32 v123,4,v123
v_mov_b32 v124,0x3f80
v_lshlrev_b32 v124,v123,v124
v_lshrrev_b32 v122,1,v122
v_cmp_eq_u32 vcc,0,v122
s_nop 1
v_cndmask_b32 v18,0,v124,vcc
v_cmp_eq_u32 vcc,1,v122
s_nop 1
v_cndmask_b32 v19,0,v124,vcc
v_cmp_eq_u32 vcc,2,v122
s_nop 1
v_cndmask_b32 v20,0,v124,vcc
v_cmp_eq_u32 vcc,3,v122
s_nop 1
v_cndmask_b32 v21,0,v124,vcc
s_and_b32 s56,s46,1
s_lshl_b32 s56,s56,8
s_and_b32 s57,s46,2
s_lshl_b32 s57,s57,6
s_add_u32 s56,s56,s57
v_add_u32 v13,s56,v13
s_xor_b32 s56,s46,0
s_lshl_b32 s56,s56,10
s_add_u32 s56,s56,147456
v_add_u32 v14,s56,v0
s_xor_b32 s56,s46,1
s_lshl_b32 s56,s56,10
s_add_u32 s56,s56,147456
v_add_u32 v15,s56,v0
s_xor_b32 s56,s46,2
s_lshl_b32 s56,s56,10
s_add_u32 s56,s56,147456
v_add_u32 v16,s56,v0
s_xor_b32 s56,s46,3
s_lshl_b32 s56,s56,10
s_add_u32 s56,s56,147456
v_add_u32 v17,s56,v0
v_add_u32 v22,11550720,v10
s_lshl_b32 s56,s47,2
s_add_u32 s56,s56,10502144
v_writelane_b32 v22,s56,4
s_mov_b32 s56,10519808
v_writelane_b32 v22,s56,5
v_add_u32 v1,131072,v0
s_mov_b32 s65,14680064
s_add_u32 s66,s71,14680064
s_add_u32 s69,s71,14942208
s_lshl_b32 s79,s47,2
s_add_u32 s79,s79,10485760
s_cmp_eq_u32 s46,0
s_cselect_b32 s79,s79,0x80000000
s_cmp_eq_u32 s47,0
s_cselect_b32 s31,17825792,-1
s_and_b32 s31,s31,0x8fffffff
s_mov_b32 s51,0
L_cst_173:
s_lshl_b32 s59,s51,13
s_lshl2_add_u32 s59,s47,s59
s_add_u32 s59,s59,10485760
L_ww_178:
buffer_load_dword v120,off,s[8:11],s59 sc1
s_sub_u32 s49,s49,1
s_cbranch_scc1 L_abort2
s_waitcnt vmcnt(0)
v_readfirstlane_b32 s61,v120
s_cmp_eq_u32 s61,0
s_cbranch_scc1 L_ww_178
L_wwd_179:
s_lshl_b32 s56,s51,5
s_add_u32 s56,s56,s47
s_mul_i32 s56,s56,24576
s_add_u32 s56,s56,100663296
s_add_u32 s67,s56,s73
s_add_u32 m0,s73,131072
s_add_u32 s57,s67,8192
buffer_load_dwordx4 v0,s[8:11],s67 offen sc1 lds
buffer_load_dwordx4 v0,s[8:11],s67 offen offset:1024 sc1 lds
s_add_u32 m0,s73,139264
s_add_u32 s67,s67,786432
buffer_load_dwordx4 v0,s[8:11],s57 offen sc1 lds
buffer_load_dwordx4 v0,s[8:11],s57 offen offset:1024 sc1 lds
s_lshl_b32 s75,s51,13
s_add_u32 s64,s75,11534336
s_add_u32 s70,s64,4096
s_lshl_b32 s68,s51,5
s_add_u32 s68,s68,s47
s_lshl_b32 s68,s68,13
s_lshl_b32 s56,s46,10
s_add_u32 s68,s68,s56
s_add_u32 s68,s68,41943040
s_sub_u32 s67,s67,0
s_mov_b32 s78,0x80000000
s_cmp_eq_u32 s51,63
s_cselect_b32 s76,1,0
s_waitcnt vmcnt(0)
s_barrier
ds_read_b128 v[56:59],v1 offset:0
ds_read_b128 v[60:63],v1 offset:4096
ds_read_b128 v[64:67],v1 offset:1024
ds_read_b128 v[68:71],v1 offset:5120
ds_read_b128 v[72:75],v1 offset:2048
ds_read_b128 v[76:79],v1 offset:6144
ds_read_b128 v[80:83],v1 offset:3072
ds_read_b128 v[84:87],v1 offset:7168
v_add_u32 v12,s73,v1
ds_read_b128 v[88:91],v12 offset:8192
ds_read_b128 v[92:95],v12 offset:9216
v_mov_b64 v[96:97],0
v_mov_b64 v[98:99],0
v_mov_b64 v[100:101],0
v_mov_b64 v[102:103],0
v_mov_b64 v[104:105],0
v_mov_b64 v[106:107],0
v_mov_b64 v[108:109],0
v_mov_b64 v[110:111],0
v_mov_b64 v[112:113],0
v_mov_b64 v[114:115],0
v_mov_b64 v[116:117],0
v_mov_b64 v[118:119],0
buffer_load_dwordx4 v[24:27],v13,s[8:11],s64 offen sc1
L_chain_180:
L_cpa_181:
buffer_load_dwordx4 v[24:27],v13,s[8:11],s64 offen sc1
s_sub_u32 s49,s49,1
s_cbranch_scc1 L_abort2
s_waitcnt vmcnt(1)
v_max3_u32 v12,v24,v25,v26
v_max_u32 v12,v27,v12
v_cmp_le_u32 vcc,s72,v12
s_cbranch_vccnz L_cpa_181
L_cgo_184:
ds_write_b128 v14,v[24:27] offset:0
buffer_load_dwordx4 v[40:43],v13,s[8:11],s70 offen sc1
v_smfmac_f32_16x16x64_bf16 v[96:99],v[24:27],a[0:7],v2
s_add_u32 m0,s73,131072
v_smfmac_f32_16x16x64_bf16 v[100:103],v[24:27],a[128:135],v2
s_add_u32 s57,s67,8192
v_smfmac_f32_16x16x64_bf16 v[104:107],v[24:27],a[8:15],v2
v_smfmac_f32_16x16x64_bf16 v[108:111],v[24:27],a[136:143],v2
s_waitcnt lgkmcnt(0)
s_barrier
ds_read_b128 v[28:31],v15 offset:0
ds_read_b128 v[32:35],v16 offset:0
ds_read_b128 v[36:39],v17 offset:0
v_smfmac_f32_16x16x64_bf16 v[112:115],v[24:27],v[128:135],v2
v_smfmac_f32_16x16x64_bf16 v[116:119],v[24:27],v[136:143],v2
s_waitcnt lgkmcnt(2)
v_smfmac_f32_16x16x64_bf16 v[96:99],v[28:31],a[16:23],v2
s_lshl_b32 s56,s46,10
v_smfmac_f32_16x16x64_bf16 v[100:103],v[28:31],a[144:151],v2
v_smfmac_f32_16x16x64_bf16 v[104:107],v[28:31],a[24:31],v2
v_smfmac_f32_16x16x64_bf16 v[108:111],v[28:31],a[152:159],v2
s_waitcnt lgkmcnt(1) vmcnt(0)
v_smfmac_f32_16x16x64_bf16 v[96:99],v[32:35],a[32:39],v2
v_max3_u32 v12,v40,v41,v42
v_smfmac_f32_16x16x64_bf16 v[100:103],v[32:35],a[160:167],v2
v_max_u32 v12,v43,v12
v_smfmac_f32_16x16x64_bf16 v[104:107],v[32:35],a[40:47],v2
v_cmp_le_u32 vcc,s72,v12
v_smfmac_f32_16x16x64_bf16 v[108:111],v[32:35],a[168:175],v2
s_cbranch_vccnz L_cpb_187
L_cback_189:
s_waitcnt lgkmcnt(0)
ds_write_b128 v14,v[40:43] offset:4096
v_smfmac_f32_16x16x64_bf16 v[96:99],v[36:39],a[48:55],v2
v_mov_b64 v[120:121],-1
v_smfmac_f32_16x16x64_bf16 v[100:103],v[36:39],a[176:183],v2
v_mov_b64 v[122:123],-1
v_smfmac_f32_16x16x64_bf16 v[104:107],v[36:39],a[56:63],v2
v_add_u32 v124,s56,v5
v_smfmac_f32_16x16x64_bf16 v[108:111],v[36:39],a[184:191],v2
v_add_u32 v126,s56,v6
s_waitcnt lgkmcnt(0)
s_barrier
v_smfmac_f32_16x16x64_bf16 v[96:99],v[40:43],a[64:71],v2
ds_read_b128 v[44:47],v15 offset:4096
v_smfmac_f32_16x16x64_bf16 v[100:103],v[40:43],a[192:199],v2
ds_read_b128 v[48:51],v16 offset:4096
v_smfmac_f32_16x16x64_bf16 v[104:107],v[40:43],a[72:79],v2
ds_read_b128 v[52:55],v17 offset:4096
v_smfmac_f32_16x16x64_bf16 v[108:111],v[40:43],a[200:207],v2
s_cmp_eq_u32 s76,0
s_cbranch_scc1 L_ckw_174
L_ckb_175:
s_waitcnt lgkmcnt(2)
v_smfmac_f32_16x16x64_bf16 v[96:99],v[44:47],a[80:87],v2
buffer_load_dwordx4 v0,s[8:11],s67 offen sc1 lds
v_smfmac_f32_16x16x64_bf16 v[100:103],v[44:47],a[208:215],v2
buffer_load_dwordx4 v0,s[8:11],s67 offen offset:1024 sc1 lds
v_smfmac_f32_16x16x64_bf16 v[104:107],v[44:47],a[88:95],v2
s_add_u32 m0,s73,139264
v_smfmac_f32_16x16x64_bf16 v[108:111],v[44:47],a[216:223],v2
s_waitcnt lgkmcnt(1)
v_smfmac_f32_16x16x64_bf16 v[96:99],v[48:51],a[96:103],v2
s_add_u32 s67,s67,786432
v_smfmac_f32_16x16x64_bf16 v[100:103],v[48:51],a[224:231],v2
buffer_load_dwordx4 v0,s[8:11],s57 offen sc1 lds
v_smfmac_f32_16x16x64_bf16 v[104:107],v[48:51],a[104:111],v2
buffer_load_dwordx4 v0,s[8:11],s57 offen offset:1024 sc1 lds
v_smfmac_f32_16x16x64_bf16 v[108:111],v[48:51],a[232:239],v2
s_waitcnt lgkmcnt(0)
v_smfmac_f32_16x16x64_bf16 v[96:99],v[52:55],a[112:119],v2
buffer_load_dword v23,v22,s[8:11],s75 offen sc1
v_smfmac_f32_16x16x64_bf16 v[100:103],v[52:55],a[240:247],v2
buffer_store_dwordx4 v[120:123],v0,s[8:11],s69 offen sc1
v_smfmac_f32_16x16x64_bf16 v[104:107],v[52:55],a[120:127],v2
buffer_store_dwordx4 v[120:123],v0,s[8:11],s69 offen offset:1024 sc1
v_smfmac_f32_16x16x64_bf16 v[108:111],v[52:55],a[248:255],v2
v_smfmac_f32_16x16x64_bf16 v[112:115],v[28:31],v[144:151],v2
v_smfmac_f32_16x16x64_bf16 v[116:119],v[28:31],v[152:159],v2
v_pk_add_f32 v[96:97],v[96:97],v[98:99]
v_pk_add_f32 v[100:101],v[100:101],v[102:103]
v_cvt_pk_bf16_f32 v120,v96,v97
v_cvt_pk_bf16_f32 v121,v100,v101
v_pk_add_f32 v[104:105],v[104:105],v[106:107]
v_pk_add_f32 v[108:109],v[108:109],v[110:111]
v_cvt_pk_bf16_f32 v122,v104,v105
v_cvt_pk_bf16_f32 v123,v108,v109
ds_write_b128 v4,v[120:123]
v_smfmac_f32_16x16x64_bf16 v[112:115],v[32:35],v[160:167],v2
v_smfmac_f32_16x16x64_bf16 v[116:119],v[32:35],v[168:175],v2
v_smfmac_f32_16x16x64_bf16 v[112:115],v[36:39],v[176:183],v2
v_smfmac_f32_16x16x64_bf16 v[116:119],v[36:39],v[184:191],v2
s_waitcnt lgkmcnt(0)
s_barrier
ds_read_b64_tr_b16 v[96:97],v5 offset:0
ds_read_b64_tr_b16 v[98:99],v6 offset:0
ds_read_b64_tr_b16 v[100:101],v5 offset:1024
ds_read_b64_tr_b16 v[102:103],v6 offset:1024
ds_read_b64_tr_b16 v[104:105],v5 offset:2048
ds_read_b64_tr_b16 v[106:107],v6 offset:2048
ds_read_b64_tr_b16 v[108:109],v5 offset:3072
ds_read_b64_tr_b16 v[110:111],v6 offset:3072
ds_read_b64_tr_b16 v[124:125],v124
ds_read_b64_tr_b16 v[126:127],v126
v_smfmac_f32_16x16x64_bf16 v[112:115],v[40:43],v[192:199],v2
v_smfmac_f32_16x16x64_bf16 v[116:119],v[40:43],v[200:207],v2
s_waitcnt lgkmcnt(8)
v_mfma_f32_16x16x32_bf16 v[24:27],v[56:59],v[96:99],0
v_mfma_f32_16x16x32_bf16 v[28:31],v[60:63],v[96:99],0
v_mfma_f32_16x16x32_bf16 v[32:35],v[96:99],v[96:99],0
s_waitcnt lgkmcnt(6)
v_mfma_f32_16x16x32_bf16 v[24:27],v[64:67],v[100:103],v[24:27]
ds_read_b128 v[56:59],v11 offset:0
v_mfma_f32_16x16x32_bf16 v[28:31],v[68:71],v[100:103],v[28:31]
ds_read_b128 v[60:63],v11 offset:1024
v_mfma_f32_16x16x32_bf16 v[32:35],v[100:103],v[100:103],v[32:35]
s_waitcnt lgkmcnt(6)
v_mfma_f32_16x16x32_bf16 v[24:27],v[72:75],v[104:107],v[24:27]
ds_read_b128 v[64:67],v11 offset:2048
v_mfma_f32_16x16x32_bf16 v[28:31],v[76:79],v[104:107],v[28:31]
ds_read_b128 v[68:71],v11 offset:3072
v_mfma_f32_16x16x32_bf16 v[32:35],v[104:107],v[104:107],v[32:35]
s_waitcnt lgkmcnt(6)
v_mfma_f32_16x16x32_bf16 v[24:27],v[80:83],v[108:111],v[24:27]
ds_read_b128 v[72:75],v11 offset:4096
v_mfma_f32_16x16x32_bf16 v[28:31],v[84:87],v[108:111],v[28:31]
ds_read_b128 v[76:79],v11 offset:5120
v_mfma_f32_16x16x32_bf16 v[32:35],v[108:111],v[108:111],v[32:35]
s_waitcnt lgkmcnt(6)
v_smfmac_f32_16x16x64_bf16 v[112:115],v[44:47],v[208:215],v2
buffer_store_dwordx4 v[124:127],v0,s[8:11],s68 offen sc1
v_smfmac_f32_16x16x64_bf16 v[116:119],v[44:47],v[216:223],v2
v_smfmac_f32_16x16x64_bf16 v[112:115],v[48:51],v[224:231],v2
v_smfmac_f32_16x16x64_bf16 v[116:119],v[48:51],v[232:239],v2
v_smfmac_f32_16x16x64_bf16 v[112:115],v[52:55],v[240:247],v2
v_smfmac_f32_16x16x64_bf16 v[116:119],v[52:55],v[248:255],v2
v_mov_b32 v125,0
v_mov_b64 v[52:53],s[28:29]
v_mov_b64 v[54:55],s[28:29]
v_max3_f32 v36,v24,v25,v26
v_max3_f32 v37,v27,v28,v29
v_max3_f32 v36,v30,v31,v36
v_max3_f32 v37,v34,v35,v37
v_max_f32 v36,v36,v37
v_max_f32 v37,v36,v37
ds_read_b128 v[80:83],v11 offset:6144
s_nop 0
v_permlane16_swap_b32 v36,v37
v_max_f32 v36,v36,v37
v_max_f32 v37,v36,v37
ds_read_b128 v[84:87],v11 offset:7168
s_nop 0
v_permlane32_swap_b32 v36,v37
v_max_f32 v36,v36,v37
v_mul_f32 v36,s80,v36
v_fma_f32 v24,v24,s80,-v36
v_fma_f32 v25,v25,s80,-v36
v_exp_f32 v24,v24
v_fma_f32 v26,v26,s80,-v36
v_exp_f32 v25,v25
v_fma_f32 v27,v27,s80,-v36
v_exp_f32 v26,v26
v_fma_f32 v28,v28,s80,-v36
v_exp_f32 v27,v27
v_fma_f32 v29,v29,s80,-v36
v_exp_f32 v28,v28
v_fma_f32 v30,v30,s80,-v36
v_exp_f32 v29,v29
v_fma_f32 v31,v31,s80,-v36
v_exp_f32 v30,v30
v_fma_f32 v34,v34,s80,-v36
v_exp_f32 v31,v31
v_fma_f32 v35,v35,s80,-v36
v_exp_f32 v34,v34
v_exp_f32 v35,v35
v_cvt_pk_bf16_f32 v120,v24,v25
v_cvt_pk_bf16_f32 v121,v26,v27
v_cvt_pk_bf16_f32 v122,v28,v29
v_cvt_pk_bf16_f32 v123,v30,v31
v_cvt_pk_bf16_f32 v124,v34,v35
s_nop 0
v_mfma_f32_16x16x32_bf16 v[32:35],v[52:55],v[120:123],0
v_pk_add_f32 v[112:113],v[112:113],v[114:115]
v_pk_add_f32 v[116:117],v[116:117],v[118:119]
v_mfma_f32_16x16x32_bf16 v[24:27],v[88:91],v[120:123],0
v_cvt_pk_bf16_f32 v36,v112,v113
v_cvt_pk_bf16_f32 v37,v116,v117
v_mfma_f32_16x16x32_bf16 v[28:31],v[92:95],v[120:123],0
v_cvt_pk_bf16_f32 v38,v116,v117
v_mov_b32 v39,0
v_mfma_f32_16x16x16_bf16 v[32:35],v[52:53],v[124:125],v[32:35]
s_add_u32 s56,s68,4096
buffer_store_dwordx4 v[36:39],v0,s[8:11],s56 offen sc1
v_mfma_f32_16x16x16_bf16 v[24:27],v[36:37],v[124:125],v[24:27]
ds_read_b128 v[96:99],v11 offset:8192
v_mfma_f32_16x16x16_bf16 v[28:31],v[38:39],v[124:125],v[28:31]
ds_read_b128 v[100:103],v11 offset:9216
v_rcp_f32 v32,v32
v_mov_b64 v[112:113],0
v_mov_b64 v[114:115],0
v_pk_mul_f32 v[24:25],v[24:25],v[32:33] op_sel_hi:[1,0]
v_pk_mul_f32 v[26:27],v[26:27],v[32:33] op_sel_hi:[1,0]
v_mov_b64 v[116:117],0
v_mov_b64 v[118:119],0
v_pk_mul_f32 v[28:29],v[28:29],v[32:33] op_sel_hi:[1,0]
v_pk_mul_f32 v[30:31],v[30:31],v[32:33] op_sel_hi:[1,0]
v_cvt_pk_bf16_f32 v120,v24,v28
v_cvt_pk_bf16_f32 v121,v25,v29
v_cvt_pk_bf16_f32 v122,v26,v30
v_cvt_pk_bf16_f32 v123,v27,v31
ds_write_b128 v7,v[120:123]
ds_read_b128 v[104:107],v11 offset:10240
ds_read_b128 v[108:111],v11 offset:11264
ds_read_b128 v[40:43],v11 offset:12288
ds_read_b128 v[44:47],v11 offset:13312
s_waitcnt lgkmcnt(4)
s_barrier
ds_read_b128 v[24:27],v8 offset:0
ds_read_b128 v[28:31],v8 offset:512
ds_read_b128 v[32:35],v8 offset:1024
ds_read_b128 v[36:39],v8 offset:1536
ds_read_b128 v[48:51],v11 offset:14336
ds_read_b128 v[52:55],v11 offset:15360
v_mov_b64 v[88:89],0
v_mov_b64 v[90:91],0
v_mov_b64 v[92:93],0
v_mov_b64 v[94:95],0
s_waitcnt lgkmcnt(5)
v_smfmac_f32_16x16x64_bf16 v[112:115],v[24:27],v[56:63],v3
ds_read_b128 v[56:59],v11 offset:16384
ds_read_b128 v[60:63],v11 offset:17408
s_waitcnt lgkmcnt(6)
v_smfmac_f32_16x16x64_bf16 v[112:115],v[28:31],v[64:71],v3
ds_read_b128 v[64:67],v11 offset:18432
ds_read_b128 v[68:71],v11 offset:19456
s_waitcnt lgkmcnt(7)
v_smfmac_f32_16x16x64_bf16 v[112:115],v[32:35],v[72:79],v3
ds_read_b128 v[72:75],v11 offset:20480
ds_read_b128 v[76:79],v11 offset:21504
s_waitcnt lgkmcnt(8)
v_smfmac_f32_16x16x64_bf16 v[112:115],v[36:39],v[80:87],v3
ds_read_b128 v[80:83],v11 offset:22528
ds_read_b128 v[84:87],v11 offset:23552
s_waitcnt lgkmcnt(8)
v_smfmac_f32_16x16x64_bf16 v[116:119],v[24:27],v[96:103],v3
ds_read_b128 v[96:99],v11 offset:24576
ds_read_b128 v[100:103],v11 offset:25600
v_smfmac_f32_16x16x64_bf16 v[116:119],v[28:31],v[104:111],v3
v_cvt_pk_bf16_f32 v112,v112,v113
v_cvt_pk_bf16_f32 v113,v114,v115
buffer_store_dwordx2 v[112:113],v9,s[8:11],s65 offen sc1
ds_read_b128 v[104:107],v11 offset:26624
ds_read_b128 v[108:111],v11 offset:27648
v_smfmac_f32_16x16x64_bf16 v[116:119],v[32:35],v[40:47],v3
ds_read_b128 v[40:43],v11 offset:28672
ds_read_b128 v[44:47],v11 offset:29696
v_smfmac_f32_16x16x64_bf16 v[116:119],v[36:39],v[48:55],v3
s_waitcnt lgkmcnt(12)
ds_read_b128 v[48:51],v11 offset:30720
ds_read_b128 v[52:55],v11 offset:31744
s_waitcnt lgkmcnt(14)
v_smfmac_f32_16x16x64_bf16 v[88:91],v[24:27],v[56:63],v3
s_nop 2
v_cvt_pk_bf16_f32 v116,v116,v117
v_cvt_pk_bf16_f32 v117,v118,v119
s_add_u32 s56,s65,65536
buffer_store_dwordx2 v[116:117],v9,s[8:11],s56 offen sc1
s_waitcnt lgkmcnt(12)
v_smfmac_f32_16x16x64_bf16 v[88:91],v[28:31],v[64:71],v3
s_waitcnt lgkmcnt(10)
v_smfmac_f32_16x16x64_bf16 v[88:91],v[32:35],v[72:79],v3
s_waitcnt lgkmcnt(8)
v_smfmac_f32_16x16x64_bf16 v[88:91],v[36:39],v[80:87],v3
s_waitcnt lgkmcnt(6)
v_smfmac_f32_16x16x64_bf16 v[92:95],v[24:27],v[96:103],v3
s_waitcnt lgkmcnt(4)
v_smfmac_f32_16x16x64_bf16 v[92:95],v[28:31],v[104:111],v3
v_cvt_pk_bf16_f32 v88,v88,v89
v_cvt_pk_bf16_f32 v89,v90,v91
s_add_u32 s56,s65,131072
buffer_store_dwordx2 v[88:89],v9,s[8:11],s56 offen sc1
s_waitcnt lgkmcnt(2)
v_smfmac_f32_16x16x64_bf16 v[92:95],v[32:35],v[40:47],v3
s_waitcnt lgkmcnt(0)
v_smfmac_f32_16x16x64_bf16 v[92:95],v[36:39],v[48:55],v3
s_add_u32 s78,s79,s75
s_add_u32 s75,s75,8192
s_add_u32 s64,s75,11534336
s_add_u32 s70,s64,4096
s_add_u32 s68,s68,262144
s_add_u32 s51,s51,1
s_nop 1
v_cvt_pk_bf16_f32 v92,v92,v93
v_cvt_pk_bf16_f32 v93,v94,v95
s_add_u32 s56,s65,196608
buffer_store_dwordx2 v[92:93],v9,s[8:11],s56 offen sc1
s_xor_b32 s65,s65,262144
s_cmp_eq_u32 s51,64
s_cbranch_scc1 L_cend_183
s_cmp_lt_u32 s47,16
s_waitcnt vmcnt(2)
s_cbranch_scc1 L_cea_190
s_barrier
ds_read_b128 v[56:59],v1 offset:0
ds_read_b128 v[60:63],v1 offset:4096
ds_read_b128 v[64:67],v1 offset:1024
ds_read_b128 v[68:71],v1 offset:5120
ds_read_b128 v[72:75],v1 offset:2048
ds_read_b128 v[76:79],v1 offset:6144
ds_read_b128 v[80:83],v1 offset:3072
ds_read_b128 v[84:87],v1 offset:7168
v_add_u32 v12,s73,v1
ds_read_b128 v[88:91],v12 offset:8192
ds_read_b128 v[92:95],v12 offset:9216
v_mov_b64 v[96:97],0
v_mov_b64 v[98:99],0
v_mov_b64 v[100:101],0
v_mov_b64 v[102:103],0
v_mov_b64 v[104:105],0
v_mov_b64 v[106:107],0
v_mov_b64 v[108:109],0
v_mov_b64 v[110:111],0
v_mov_b64 v[112:113],0
v_mov_b64 v[114:115],0
v_mov_b64 v[116:117],0
v_mov_b64 v[118:119],0
v_readlane_b32 s76,v23,4
s_cmp_ge_u32 s51,63
s_cselect_b32 s76,1,s76
s_waitcnt vmcnt(0)
L_crp_185:
buffer_load_dwordx4 v[120:123],v0,s[8:11],s66 offen offset:0 sc1
buffer_load_dwordx4 v[124:127],v0,s[8:11],s66 offen offset:1024 sc1
s_sub_u32 s49,s49,1
s_cbranch_scc1 L_abort2
s_waitcnt vmcnt(1)
v_mfma_f32_16x16x32_bf16 v[28:31],v[18:21],v[120:123],0
s_waitcnt vmcnt(0)
v_mfma_f32_16x16x32_bf16 v[28:31],v[18:21],v[124:127],v[28:31]
s_nop 7
v_cmp_u_f32 vcc,v28,v28
v_add_f32_dpp v32,v28,v28 row_ror:8 row_mask:0xf bank_mask:0x3
v_add_f32_dpp v33,v29,v29 row_ror:8 row_mask:0xf bank_mask:0x3
v_add_f32_dpp v32,v30,v30 row_ror:8 row_mask:0xf bank_mask:0xc
v_add_f32_dpp v33,v31,v31 row_ror:8 row_mask:0xf bank_mask:0xc
s_nop 0
v_add_f32_dpp v32,v32,v32 row_shl:4 row_mask:0xf bank_mask:0x5
v_add_f32_dpp v33,v33,v33 row_shl:4 row_mask:0xf bank_mask:0x5
s_cbranch_vccnz L_crp_185
v_cvt_pk_bf16_f32 v34,v32,v33
buffer_store_dword v34,v10,s[8:11],s64 offen sc1
s_mov_b32 s69,s66
s_xor_b32 s66,s66,262144
buffer_load_dwordx4 v[24:27],v13,s[8:11],s64 offen sc1
s_branch L_chain_180
L_cea_190:
buffer_load_dwordx4 v[120:123],v0,s[8:11],s66 offen offset:0 sc1
buffer_load_dwordx4 v[124:127],v0,s[8:11],s66 offen offset:1024 sc1
v_mov_b64 v[96:97],0
v_mov_b64 v[98:99],0
v_mov_b64 v[100:101],0
v_mov_b64 v[102:103],0
v_mov_b64 v[104:105],0
v_mov_b64 v[106:107],0
v_mov_b64 v[108:109],0
v_mov_b64 v[110:111],0
v_mov_b64 v[112:113],0
v_mov_b64 v[114:115],0
v_mov_b64 v[116:117],0
v_mov_b64 v[118:119],0
v_readlane_b32 s76,v23,4
s_cmp_ge_u32 s51,63
s_cselect_b32 s76,1,s76
s_branch L_cr1_191
L_crb_186:
buffer_load_dwordx4 v[120:123],v0,s[8:11],s66 offen offset:0 sc1
buffer_load_dwordx4 v[124:127],v0,s[8:11],s66 offen offset:1024 sc1
L_cr1_191:
s_sub_u32 s49,s49,1
s_cbranch_scc1 L_abort2
s_waitcnt vmcnt(1)
v_mfma_f32_16x16x32_bf16 v[28:31],v[18:21],v[120:123],0
s_waitcnt vmcnt(0)
v_mfma_f32_16x16x32_bf16 v[28:31],v[18:21],v[124:127],v[28:31]
s_nop 7
v_cmp_u_f32 vcc,v28,v28
v_add_f32_dpp v32,v28,v28 row_ror:8 row_mask:0xf bank_mask:0x3
v_add_f32_dpp v33,v29,v29 row_ror:8 row_mask:0xf bank_mask:0x3
v_add_f32_dpp v32,v30,v30 row_ror:8 row_mask:0xf bank_mask:0xc
v_add_f32_dpp v33,v31,v31 row_ror:8 row_mask:0xf bank_mask:0xc
s_nop 0
v_add_f32_dpp v32,v32,v32 row_shl:4 row_mask:0xf bank_mask:0x5
v_add_f32_dpp v33,v33,v33 row_shl:4 row_mask:0xf bank_mask:0x5
s_cbranch_vccnz L_crb_186
v_cvt_pk_bf16_f32 v34,v32,v33
buffer_store_dword v34,v10,s[8:11],s64 offen sc1
s_mov_b32 s69,s66
s_xor_b32 s66,s66,262144
s_barrier
ds_read_b128 v[56:59],v1 offset:0
ds_read_b128 v[60:63],v1 offset:4096
ds_read_b128 v[64:67],v1 offset:1024
ds_read_b128 v[68:71],v1 offset:5120
buffer_load_dwordx4 v[24:27],v13,s[8:11],s64 offen sc1
ds_read_b128 v[72:75],v1 offset:2048
ds_read_b128 v[76:79],v1 offset:6144
ds_read_b128 v[80:83],v1 offset:3072
ds_read_b128 v[84:87],v1 offset:7168
v_add_u32 v12,s73,v1
ds_read_b128 v[88:91],v12 offset:8192
ds_read_b128 v[92:95],v12 offset:9216
s_branch L_chain_180
L_ckw_174:
s_lshl2_add_u32 s59,s47,s75
s_add_u32 s59,s59,10493952
L_ww_192:
buffer_load_dword v23,off,s[8:11],s59 sc1
s_sub_u32 s49,s49,1
s_cbranch_scc1 L_abort2
s_waitcnt vmcnt(0)
v_readfirstlane_b32 s76,v23
s_cmp_eq_u32 s76,0
s_cbranch_scc1 L_ww_192
L_wwd_193:
s_branch L_ckb_175
L_cpb_187:
buffer_load_dwordx4 v[40:43],v13,s[8:11],s70 offen sc1
s_waitcnt vmcnt(0)
v_max3_u32 v12,v40,v41,v42
v_max_u32 v12,v43,v12
v_cmp_le_u32 vcc,s72,v12
s_cbranch_vccz L_cback_189
s_sub_u32 s49,s49,1
s_cmp_gt_i32 s49,0
s_cbranch_scc1 L_cpb_187
s_branch L_abort2
L_cend_183:
s_waitcnt vmcnt(0)
s_barrier
s_nop 11
v_lshrrev_b32 v1,4,v0
s_branch L_ra_6
L_rc1_171:
v_and_b32 v120,15,v1
v_lshrrev_b32 v121,4,v1
v_and_b32 v122,2,v1
v_cmp_eq_u32 vcc,0,v122
v_mov_b32 v2,0xeeee
v_mov_b32 v123,0x4444
v_cndmask_b32 v2,v2,v123,vcc
v_and_b32 v122,1,v1
v_cmp_eq_u32 vcc,0,v122
v_mov_b32 v3,0xdddd
v_mov_b32 v123,0x8888
v_cndmask_b32 v3,v3,v123,vcc
v_lshrrev_b32 v122,1,v120
v_bfe_u32 v123,v120,2,1
v_xor_b32 v123,v123,v122
v_lshlrev_b32 v4,7,v123
v_and_b32 v123,1,v120
v_lshl_add_u32 v4,v123,6,v4
v_xor_b32 v123,v121,v122
v_and_b32 v123,3,v123
v_lshl_add_u32 v4,v123,4,v4
s_lshl_b32 s56,s46,10
s_add_u32 s56,s56,147456
v_add_u32 v4,s56,v4
v_lshlrev_b32 v122,1,v121
v_add_u32 v122,0,v122
v_and_b32 v123,1,v121
v_xor_b32 v123,v123,v122
v_lshlrev_b32 v5,7,v123
v_bfe_u32 v123,v120,3,1
v_lshl_add_u32 v5,v123,6,v5
v_xor_b32 v123,v120,v122
v_and_b32 v123,3,v123
v_lshl_add_u32 v5,v123,4,v5
v_bfe_u32 v123,v120,2,1
v_lshl_add_u32 v5,v123,3,v5
v_add_u32 v5,147456,v5
v_lshlrev_b32 v122,1,v121
v_add_u32 v122,1,v122
v_and_b32 v123,1,v121
v_xor_b32 v123,v123,v122
v_lshlrev_b32 v6,7,v123
v_bfe_u32 v123,v120,3,1
v_lshl_add_u32 v6,v123,6,v6
v_xor_b32 v123,v120,v122
v_and_b32 v123,3,v123
v_lshl_add_u32 v6,v123,4,v6
v_bfe_u32 v123,v120,2,1
v_lshl_add_u32 v6,v123,3,v6
v_add_u32 v6,147456,v6
v_lshlrev_b32 v7,7,v121
v_lshrrev_b32 v122,1,v120
v_lshl_add_u32 v8,v122,4,v7
v_add_u32 v8,151552,v8
v_lshrrev_b32 v122,2,v120
v_lshl_add_u32 v7,v122,5,v7
v_and_b32 v122,1,v120
v_lshl_add_u32 v7,v122,4,v7
v_and_b32 v122,2,v120
v_lshl_add_u32 v7,v122,10,v7
s_lshl_b32 s56,s46,9
s_add_u32 s56,s56,151552
v_add_u32 v7,s56,v7
v_lshrrev_b32 v122,3,v1
v_lshlrev_b32 v9,11,v122
v_and_b32 v122,7,v1
v_lshl_add_u32 v9,v122,3,v9
s_lshl_b32 s56,s46,14
s_lshl_b32 s57,s47,6
s_add_u32 s56,s56,s57
v_add_u32 v9,s56,v9
s_lshl_b32 s71,s47,2
s_add_u32 s71,s71,s46
s_bfe_u32 s56,s71,0x10003
s_lshl_b32 s56,s56,11
s_and_b32 s57,s71,1
s_lshl_b32 s57,s57,10
s_add_u32 s56,s56,s57
s_bfe_u32 s57,s71,0x10002
s_lshl_b32 s57,s57,9
s_add_u32 s56,s56,s57
s_bfe_u32 s57,s71,0x10001
s_lshl_b32 s57,s57,6
s_add_u32 s56,s56,s57
s_bfe_u32 s57,s71,0x10004
s_lshl_b32 s57,s57,8
s_add_u32 s56,s56,s57
s_bfe_u32 s57,s71,0x10005
s_lshl_b32 s57,s57,7
s_add_u32 s56,s56,s57
s_bfe_u32 s57,s71,0x10006
s_lshl_b32 s57,s57,12
s_add_u32 s56,s56,s57
v_and_b32 v122,3,v120
v_lshlrev_b32 v10,2,v122
v_bfe_u32 v122,v120,3,1
v_lshl_add_u32 v10,v122,4,v10
v_and_b32 v122,1,v121
v_lshl_add_u32 v10,v122,5,v10
v_add_u32 v10,s56,v10
v_and_b32 v123,36,v1
v_mov_b32 v122,0x80000000
v_cmp_eq_u32 vcc,0,v123
s_nop 1
v_cndmask_b32 v10,v122,v10,vcc
s_lshl_b32 s56,s46,15
v_add_u32 v11,s56,v0
s_lshl_b32 s71,s71,11
s_lshl_b32 s73,s46,11
s_mov_b32 s72,0xffc00000
s_mov_b32 s74,0
v_lshrrev_b32 v13,3,v1
v_lshlrev_b32 v13,9,v13
v_and_b32 v122,7,v1
v_lshl_add_u32 v13,v122,4,v13
v_and_b32 v122,15,v1
v_and_b32 v123,1,v1
v_lshlrev_b32 v123,4,v123
v_mov_b32 v124,0x3f80
v_lshlrev_b32 v124,v123,v124
v_lshrrev_b32 v122,1,v122
v_cmp_eq_u32 vcc,0,v122
s_nop 1
v_cndmask_b32 v18,0,v124,vcc
v_cmp_eq_u32 vcc,1,v122
s_nop 1
v_cndmask_b32 v19,0,v124,vcc
v_cmp_eq_u32 vcc,2,v122
s_nop 1
v_cndmask_b32 v20,0,v124,vcc
v_cmp_eq_u32 vcc,3,v122
s_nop 1
v_cndmask_b32 v21,0,v124,vcc
s_and_b32 s56,s46,1
s_lshl_b32 s56,s56,8
s_and_b32 s57,s46,2
s_lshl_b32 s57,s57,6
s_add_u32 s56,s56,s57
v_add_u32 v13,s56,v13
s_xor_b32 s56,s46,0
s_lshl_b32 s56,s56,10
s_add_u32 s56,s56,147456
v_add_u32 v14,s56,v0
s_xor_b32 s56,s46,1
s_lshl_b32 s56,s56,10
s_add_u32 s56,s56,147456
v_add_u32 v15,s56,v0
s_xor_b32 s56,s46,2
s_lshl_b32 s56,s56,10
s_add_u32 s56,s56,147456
v_add_u32 v16,s56,v0
s_xor_b32 s56,s46,3
s_lshl_b32 s56,s56,10
s_add_u32 s56,s56,147456
v_add_u32 v17,s56,v0
v_add_u32 v22,12599296,v10
s_lshl_b32 s56,s47,2
s_add_u32 s56,s56,10502272
v_writelane_b32 v22,s56,4
s_mov_b32 s56,10519808
v_writelane_b32 v22,s56,5
v_add_u32 v1,131072,v0
s_mov_b32 s65,15728640
s_add_u32 s66,s71,15728640
s_add_u32 s69,s71,15990784
s_lshl_b32 s79,s47,2
s_add_u32 s79,s79,10486272
s_cmp_eq_u32 s46,0
s_cselect_b32 s79,s79,0x80000000
s_cmp_eq_u32 s47,0
s_cselect_b32 s31,17825792,-1
s_and_b32 s31,s31,0x8fffffff
s_mov_b32 s51,0
L_cst_194:
s_lshl_b32 s59,s51,13
s_lshl2_add_u32 s59,s47,s59
s_add_u32 s59,s59,10485888
L_ww_199:
buffer_load_dword v120,off,s[8:11],s59 sc1
s_sub_u32 s49,s49,1
s_cbranch_scc1 L_abort2
s_waitcnt vmcnt(0)
v_readfirstlane_b32 s61,v120
s_cmp_eq_u32 s61,0
s_cbranch_scc1 L_ww_199
L_wwd_200:
s_lshl_b32 s56,s51,5
s_add_u32 s56,s56,s47
s_mul_i32 s56,s56,24576
s_add_u32 s56,s56,150994944
s_add_u32 s67,s56,s73
s_add_u32 m0,s73,131072
s_add_u32 s57,s67,8192
buffer_load_dwordx4 v0,s[8:11],s67 offen sc1 lds
buffer_load_dwordx4 v0,s[8:11],s67 offen offset:1024 sc1 lds
s_add_u32 m0,s73,139264
s_add_u32 s67,s67,786432
buffer_load_dwordx4 v0,s[8:11],s57 offen sc1 lds
buffer_load_dwordx4 v0,s[8:11],s57 offen offset:1024 sc1 lds
s_lshl_b32 s75,s51,13
s_add_u32 s64,s75,12582912
s_add_u32 s70,s64,4096
s_lshl_b32 s68,s51,5
s_add_u32 s68,s68,s47
s_lshl_b32 s68,s68,13
s_lshl_b32 s56,s46,10
s_add_u32 s68,s68,s56
s_add_u32 s68,s68,58720256
s_sub_u32 s67,s67,0
s_mov_b32 s78,0x80000000
s_cmp_eq_u32 s51,63
s_cselect_b32 s76,1,0
s_waitcnt vmcnt(0)
s_barrier
ds_read_b128 v[56:59],v1 offset:0
ds_read_b128 v[60:63],v1 offset:4096
ds_read_b128 v[64:67],v1 offset:1024
ds_read_b128 v[68:71],v1 offset:5120
ds_read_b128 v[72:75],v1 offset:2048
ds_read_b128 v[76:79],v1 offset:6144
ds_read_b128 v[80:83],v1 offset:3072
ds_read_b128 v[84:87],v1 offset:7168
v_add_u32 v12,s73,v1
ds_read_b128 v[88:91],v12 offset:8192
ds_read_b128 v[92:95],v12 offset:9216
v_mov_b64 v[96:97],0
v_mov_b64 v[98:99],0
v_mov_b64 v[100:101],0
v_mov_b64 v[102:103],0
v_mov_b64 v[104:105],0
v_mov_b64 v[106:107],0
v_mov_b64 v[108:109],0
v_mov_b64 v[110:111],0
v_mov_b64 v[112:113],0
v_mov_b64 v[114:115],0
v_mov_b64 v[116:117],0
v_mov_b64 v[118:119],0
buffer_load_dwordx4 v[24:27],v13,s[8:11],s64 offen sc1
L_chain_201:
L_cpa_202:
buffer_load_dwordx4 v[24:27],v13,s[8:11],s64 offen sc1
s_sub_u32 s49,s49,1
s_cbranch_scc1 L_abort2
s_waitcnt vmcnt(1)
v_max3_u32 v12,v24,v25,v26
v_max_u32 v12,v27,v12
v_cmp_le_u32 vcc,s72,v12
s_cbranch_vccnz L_cpa_202
L_cgo_205:
ds_write_b128 v14,v[24:27] offset:0
buffer_load_dwordx4 v[40:43],v13,s[8:11],s70 offen sc1
v_smfmac_f32_16x16x64_bf16 v[96:99],v[24:27],a[0:7],v2
s_add_u32 m0,s73,131072
v_smfmac_f32_16x16x64_bf16 v[100:103],v[24:27],a[128:135],v2
s_add_u32 s57,s67,8192
v_smfmac_f32_16x16x64_bf16 v[104:107],v[24:27],a[8:15],v2
s_add_u32 s30,s31,s75
v_smfmac_f32_16x16x64_bf16 v[108:111],v[24:27],a[136:143],v2
s_add_u32 s58,s30,4096
s_waitcnt lgkmcnt(0)
s_barrier
ds_read_b128 v[28:31],v15 offset:0
ds_read_b128 v[32:35],v16 offset:0
ds_read_b128 v[36:39],v17 offset:0
v_smfmac_f32_16x16x64_bf16 v[112:115],v[24:27],v[128:135],v2
v_smfmac_f32_16x16x64_bf16 v[116:119],v[24:27],v[136:143],v2
s_waitcnt lgkmcnt(2)
v_smfmac_f32_16x16x64_bf16 v[96:99],v[28:31],a[16:23],v2
s_lshl_b32 s56,s46,10
v_smfmac_f32_16x16x64_bf16 v[100:103],v[28:31],a[144:151],v2
v_smfmac_f32_16x16x64_bf16 v[104:107],v[28:31],a[24:31],v2
v_smfmac_f32_16x16x64_bf16 v[108:111],v[28:31],a[152:159],v2
s_waitcnt lgkmcnt(1) vmcnt(0)
v_smfmac_f32_16x16x64_bf16 v[96:99],v[32:35],a[32:39],v2
v_max3_u32 v12,v40,v41,v42
v_smfmac_f32_16x16x64_bf16 v[100:103],v[32:35],a[160:167],v2
v_max_u32 v12,v43,v12
v_smfmac_f32_16x16x64_bf16 v[104:107],v[32:35],a[40:47],v2
v_cmp_le_u32 vcc,s72,v12
v_smfmac_f32_16x16x64_bf16 v[108:111],v[32:35],a[168:175],v2
s_cbranch_vccnz L_cpb_208
L_cback_210:
s_waitcnt lgkmcnt(0)
ds_write_b128 v14,v[40:43] offset:4096
v_smfmac_f32_16x16x64_bf16 v[96:99],v[36:39],a[48:55],v2
v_mov_b64 v[120:121],-1
v_smfmac_f32_16x16x64_bf16 v[100:103],v[36:39],a[176:183],v2
v_mov_b64 v[122:123],-1
v_smfmac_f32_16x16x64_bf16 v[104:107],v[36:39],a[56:63],v2
v_add_u32 v124,s56,v5
v_smfmac_f32_16x16x64_bf16 v[108:111],v[36:39],a[184:191],v2
v_add_u32 v126,s56,v6
s_waitcnt lgkmcnt(0)
s_barrier
v_smfmac_f32_16x16x64_bf16 v[96:99],v[40:43],a[64:71],v2
ds_read_b128 v[44:47],v15 offset:4096
v_smfmac_f32_16x16x64_bf16 v[100:103],v[40:43],a[192:199],v2
ds_read_b128 v[48:51],v16 offset:4096
v_smfmac_f32_16x16x64_bf16 v[104:107],v[40:43],a[72:79],v2
ds_read_b128 v[52:55],v17 offset:4096
v_smfmac_f32_16x16x64_bf16 v[108:111],v[40:43],a[200:207],v2
s_cmp_eq_u32 s76,0
s_cbranch_scc1 L_ckw_195
L_ckb_196:
s_waitcnt lgkmcnt(2)
v_smfmac_f32_16x16x64_bf16 v[96:99],v[44:47],a[80:87],v2
buffer_load_dwordx4 v0,s[8:11],s67 offen sc1 lds
v_smfmac_f32_16x16x64_bf16 v[100:103],v[44:47],a[208:215],v2
buffer_load_dwordx4 v0,s[8:11],s67 offen offset:1024 sc1 lds
v_smfmac_f32_16x16x64_bf16 v[104:107],v[44:47],a[88:95],v2
s_add_u32 m0,s73,139264
v_smfmac_f32_16x16x64_bf16 v[108:111],v[44:47],a[216:223],v2
s_waitcnt lgkmcnt(1)
v_smfmac_f32_16x16x64_bf16 v[96:99],v[48:51],a[96:103],v2
s_add_u32 s67,s67,786432
v_smfmac_f32_16x16x64_bf16 v[100:103],v[48:51],a[224:231],v2
buffer_load_dwordx4 v0,s[8:11],s57 offen sc1 lds
v_smfmac_f32_16x16x64_bf16 v[104:107],v[48:51],a[104:111],v2
buffer_load_dwordx4 v0,s[8:11],s57 offen offset:1024 sc1 lds
v_smfmac_f32_16x16x64_bf16 v[108:111],v[48:51],a[232:239],v2
s_waitcnt lgkmcnt(0)
v_smfmac_f32_16x16x64_bf16 v[96:99],v[52:55],a[112:119],v2
buffer_load_dword v23,v22,s[8:11],s75 offen sc1
v_smfmac_f32_16x16x64_bf16 v[100:103],v[52:55],a[240:247],v2
buffer_store_dword v2,off,s[8:11],s78 sc1
v_smfmac_f32_16x16x64_bf16 v[104:107],v[52:55],a[120:127],v2
buffer_store_dwordx4 v[120:123],v0,s[8:11],s69 offen sc1
v_smfmac_f32_16x16x64_bf16 v[108:111],v[52:55],a[248:255],v2
buffer_store_dwordx4 v[120:123],v0,s[8:11],s69 offen offset:1024 sc1
buffer_store_dwordx4 v[24:27],v13,s[8:11],s30 offen sc1
buffer_store_dwordx4 v[40:43],v13,s[8:11],s58 offen sc1
v_smfmac_f32_16x16x64_bf16 v[112:115],v[28:31],v[144:151],v2
v_smfmac_f32_16x16x64_bf16 v[116:119],v[28:31],v[152:159],v2
v_pk_add_f32 v[96:97],v[96:97],v[98:99]
v_pk_add_f32 v[100:101],v[100:101],v[102:103]
v_cvt_pk_bf16_f32 v120,v96,v97
v_cvt_pk_bf16_f32 v121,v100,v101
v_pk_add_f32 v[104:105],v[104:105],v[106:107]
v_pk_add_f32 v[108:109],v[108:109],v[110:111]
v_cvt_pk_bf16_f32 v122,v104,v105
v_cvt_pk_bf16_f32 v123,v108,v109
ds_write_b128 v4,v[120:123]
v_smfmac_f32_16x16x64_bf16 v[112:115],v[32:35],v[160:167],v2
v_smfmac_f32_16x16x64_bf16 v[116:119],v[32:35],v[168:175],v2
v_smfmac_f32_16x16x64_bf16 v[112:115],v[36:39],v[176:183],v2
v_smfmac_f32_16x16x64_bf16 v[116:119],v[36:39],v[184:191],v2
s_waitcnt lgkmcnt(0)
s_barrier
ds_read_b64_tr_b16 v[96:97],v5 offset:0
ds_read_b64_tr_b16 v[98:99],v6 offset:0
ds_read_b64_tr_b16 v[100:101],v5 offset:1024
ds_read_b64_tr_b16 v[102:103],v6 offset:1024
ds_read_b64_tr_b16 v[104:105],v5 offset:2048
ds_read_b64_tr_b16 v[106:107],v6 offset:2048
ds_read_b64_tr_b16 v[108:109],v5 offset:3072
ds_read_b64_tr_b16 v[110:111],v6 offset:3072
ds_read_b64_tr_b16 v[124:125],v124
ds_read_b64_tr_b16 v[126:127],v126
v_smfmac_f32_16x16x64_bf16 v[112:115],v[40:43],v[192:199],v2
v_smfmac_f32_16x16x64_bf16 v[116:119],v[40:43],v[200:207],v2
s_waitcnt lgkmcnt(8)
v_mfma_f32_16x16x32_bf16 v[24:27],v[56:59],v[96:99],0
v_mfma_f32_16x16x32_bf16 v[28:31],v[60:63],v[96:99],0
v_mfma_f32_16x16x32_bf16 v[32:35],v[96:99],v[96:99],0
s_waitcnt lgkmcnt(6)
v_mfma_f32_16x16x32_bf16 v[24:27],v[64:67],v[100:103],v[24:27]
ds_read_b128 v[56:59],v11 offset:0
v_mfma_f32_16x16x32_bf16 v[28:31],v[68:71],v[100:103],v[28:31]
ds_read_b128 v[60:63],v11 offset:1024
v_mfma_f32_16x16x32_bf16 v[32:35],v[100:103],v[100:103],v[32:35]
s_waitcnt lgkmcnt(6)
v_mfma_f32_16x16x32_bf16 v[24:27],v[72:75],v[104:107],v[24:27]
ds_read_b128 v[64:67],v11 offset:2048
v_mfma_f32_16x16x32_bf16 v[28:31],v[76:79],v[104:107],v[28:31]
ds_read_b128 v[68:71],v11 offset:3072
v_mfma_f32_16x16x32_bf16 v[32:35],v[104:107],v[104:107],v[32:35]
s_waitcnt lgkmcnt(6)
v_mfma_f32_16x16x32_bf16 v[24:27],v[80:83],v[108:111],v[24:27]
ds_read_b128 v[72:75],v11 offset:4096
v_mfma_f32_16x16x32_bf16 v[28:31],v[84:87],v[108:111],v[28:31]
ds_read_b128 v[76:79],v11 offset:5120
v_mfma_f32_16x16x32_bf16 v[32:35],v[108:111],v[108:111],v[32:35]
s_waitcnt lgkmcnt(6)
v_smfmac_f32_16x16x64_bf16 v[112:115],v[44:47],v[208:215],v2
buffer_store_dwordx4 v[124:127],v0,s[8:11],s68 offen sc1
v_smfmac_f32_16x16x64_bf16 v[116:119],v[44:47],v[216:223],v2
v_smfmac_f32_16x16x64_bf16 v[112:115],v[48:51],v[224:231],v2
v_smfmac_f32_16x16x64_bf16 v[116:119],v[48:51],v[232:239],v2
v_smfmac_f32_16x16x64_bf16 v[112:115],v[52:55],v[240:247],v2
v_smfmac_f32_16x16x64_bf16 v[116:119],v[52:55],v[248:255],v2
v_mov_b32 v125,0
v_mov_b64 v[52:53],s[28:29]
v_mov_b64 v[54:55],s[28:29]
v_max3_f32 v36,v24,v25,v26
v_max3_f32 v37,v27,v28,v29
v_max3_f32 v36,v30,v31,v36
v_max3_f32 v37,v34,v35,v37
v_max_f32 v36,v36,v37
v_max_f32 v37,v36,v37
ds_read_b128 v[80:83],v11 offset:6144
s_nop 0
v_permlane16_swap_b32 v36,v37
v_max_f32 v36,v36,v37
v_max_f32 v37,v36,v37
ds_read_b128 v[84:87],v11 offset:7168
s_nop 0
v_permlane32_swap_b32 v36,v37
v_max_f32 v36,v36,v37
v_mul_f32 v36,s80,v36
v_fma_f32 v24,v24,s80,-v36
v_fma_f32 v25,v25,s80,-v36
v_exp_f32 v24,v24
v_fma_f32 v26,v26,s80,-v36
v_exp_f32 v25,v25
v_fma_f32 v27,v27,s80,-v36
v_exp_f32 v26,v26
v_fma_f32 v28,v28,s80,-v36
v_exp_f32 v27,v27
v_fma_f32 v29,v29,s80,-v36
v_exp_f32 v28,v28
v_fma_f32 v30,v30,s80,-v36
v_exp_f32 v29,v29
v_fma_f32 v31,v31,s80,-v36
v_exp_f32 v30,v30
v_fma_f32 v34,v34,s80,-v36
v_exp_f32 v31,v31
v_fma_f32 v35,v35,s80,-v36
v_exp_f32 v34,v34
v_exp_f32 v35,v35
v_cvt_pk_bf16_f32 v120,v24,v25
v_cvt_pk_bf16_f32 v121,v26,v27
v_cvt_pk_bf16_f32 v122,v28,v29
v_cvt_pk_bf16_f32 v123,v30,v31
v_cvt_pk_bf16_f32 v124,v34,v35
s_nop 0
v_mfma_f32_16x16x32_bf16 v[32:35],v[52:55],v[120:123],0
v_pk_add_f32 v[112:113],v[112:113],v[114:115]
v_pk_add_f32 v[116:117],v[116:117],v[118:119]
v_mfma_f32_16x16x32_bf16 v[24:27],v[88:91],v[120:123],0
v_cvt_pk_bf16_f32 v36,v112,v113
v_cvt_pk_bf16_f32 v37,v116,v117
v_mfma_f32_16x16x32_bf16 v[28:31],v[92:95],v[120:123],0
v_cvt_pk_bf16_f32 v38,v116,v117
v_mov_b32 v39,0
v_mfma_f32_16x16x16_bf16 v[32:35],v[52:53],v[124:125],v[32:35]
s_add_u32 s56,s68,4096
buffer_store_dwordx4 v[36:39],v0,s[8:11],s56 offen sc1
v_mfma_f32_16x16x16_bf16 v[24:27],v[36:37],v[124:125],v[24:27]
ds_read_b128 v[96:99],v11 offset:8192
v_mfma_f32_16x16x16_bf16 v[28:31],v[38:39],v[124:125],v[28:31]
ds_read_b128 v[100:103],v11 offset:9216
v_rcp_f32 v32,v32
v_mov_b64 v[112:113],0
v_mov_b64 v[114:115],0
v_pk_mul_f32 v[24:25],v[24:25],v[32:33] op_sel_hi:[1,0]
v_pk_mul_f32 v[26:27],v[26:27],v[32:33] op_sel_hi:[1,0]
v_mov_b64 v[116:117],0
v_mov_b64 v[118:119],0
v_pk_mul_f32 v[28:29],v[28:29],v[32:33] op_sel_hi:[1,0]
v_pk_mul_f32 v[30:31],v[30:31],v[32:33] op_sel_hi:[1,0]
v_cvt_pk_bf16_f32 v120,v24,v28
v_cvt_pk_bf16_f32 v121,v25,v29
v_cvt_pk_bf16_f32 v122,v26,v30
v_cvt_pk_bf16_f32 v123,v27,v31
ds_write_b128 v7,v[120:123]
ds_read_b128 v[104:107],v11 offset:10240
ds_read_b128 v[108:111],v11 offset:11264
ds_read_b128 v[40:43],v11 offset:12288
ds_read_b128 v[44:47],v11 offset:13312
s_waitcnt lgkmcnt(4)
s_barrier
ds_read_b128 v[24:27],v8 offset:0
ds_read_b128 v[28:31],v8 offset:512
ds_read_b128 v[32:35],v8 offset:1024
ds_read_b128 v[36:39],v8 offset:1536
ds_read_b128 v[48:51],v11 offset:14336
ds_read_b128 v[52:55],v11 offset:15360
v_mov_b64 v[88:89],0
v_mov_b64 v[90:91],0
v_mov_b64 v[92:93],0
v_mov_b64 v[94:95],0
s_waitcnt lgkmcnt(5)
v_smfmac_f32_16x16x64_bf16 v[112:115],v[24:27],v[56:63],v3
ds_read_b128 v[56:59],v11 offset:16384
ds_read_b128 v[60:63],v11 offset:17408
s_waitcnt lgkmcnt(6)
v_smfmac_f32_16x16x64_bf16 v[112:115],v[28:31],v[64:71],v3
ds_read_b128 v[64:67],v11 offset:18432
ds_read_b128 v[68:71],v11 offset:19456
s_waitcnt lgkmcnt(7)
v_smfmac_f32_16x16x64_bf16 v[112:115],v[32:35],v[72:79],v3
ds_read_b128 v[72:75],v11 offset:20480
ds_read_b128 v[76:79],v11 offset:21504
s_waitcnt lgkmcnt(8)
v_smfmac_f32_16x16x64_bf16 v[112:115],v[36:39],v[80:87],v3
ds_read_b128 v[80:83],v11 offset:22528
ds_read_b128 v[84:87],v11 offset:23552
s_waitcnt lgkmcnt(8)
v_smfmac_f32_16x16x64_bf16 v[116:119],v[24:27],v[96:103],v3
ds_read_b128 v[96:99],v11 offset:24576
ds_read_b128 v[100:103],v11 offset:25600
v_smfmac_f32_16x16x64_bf16 v[116:119],v[28:31],v[104:111],v3
v_cvt_pk_bf16_f32 v112,v112,v113
v_cvt_pk_bf16_f32 v113,v114,v115
buffer_store_dwordx2 v[112:113],v9,s[8:11],s65 offen sc1
ds_read_b128 v[104:107],v11 offset:26624
ds_read_b128 v[108:111],v11 offset:27648
v_smfmac_f32_16x16x64_bf16 v[116:119],v[32:35],v[40:47],v3
ds_read_b128 v[40:43],v11 offset:28672
ds_read_b128 v[44:47],v11 offset:29696
v_smfmac_f32_16x16x64_bf16 v[116:119],v[36:39],v[48:55],v3
s_waitcnt lgkmcnt(12)
ds_read_b128 v[48:51],v11 offset:30720
ds_read_b128 v[52:55],v11 offset:31744
s_waitcnt lgkmcnt(14)
v_smfmac_f32_16x16x64_bf16 v[88:91],v[24:27],v[56:63],v3
s_nop 2
v_cvt_pk_bf16_f32 v116,v116,v117
v_cvt_pk_bf16_f32 v117,v118,v119
s_add_u32 s56,s65,65536
buffer_store_dwordx2 v[116:117],v9,s[8:11],s56 offen sc1
s_waitcnt lgkmcnt(12)
v_smfmac_f32_16x16x64_bf16 v[88:91],v[28:31],v[64:71],v3
s_waitcnt lgkmcnt(10)
v_smfmac_f32_16x16x64_bf16 v[88:91],v[32:35],v[72:79],v3
s_waitcnt lgkmcnt(8)
v_smfmac_f32_16x16x64_bf16 v[88:91],v[36:39],v[80:87],v3
s_waitcnt lgkmcnt(6)
v_smfmac_f32_16x16x64_bf16 v[92:95],v[24:27],v[96:103],v3
s_waitcnt lgkmcnt(4)
v_smfmac_f32_16x16x64_bf16 v[92:95],v[28:31],v[104:111],v3
v_cvt_pk_bf16_f32 v88,v88,v89
v_cvt_pk_bf16_f32 v89,v90,v91
s_add_u32 s56,s65,131072
buffer_store_dwordx2 v[88:89],v9,s[8:11],s56 offen sc1
s_waitcnt lgkmcnt(2)
v_smfmac_f32_16x16x64_bf16 v[92:95],v[32:35],v[40:47],v3
s_waitcnt lgkmcnt(0)
v_smfmac_f32_16x16x64_bf16 v[92:95],v[36:39],v[48:55],v3
s_add_u32 s78,s79,s75
s_add_u32 s75,s75,8192
s_add_u32 s64,s75,12582912
s_add_u32 s70,s64,4096
s_add_u32 s68,s68,262144
s_add_u32 s51,s51,1
s_nop 1
v_cvt_pk_bf16_f32 v92,v92,v93
v_cvt_pk_bf16_f32 v93,v94,v95
s_add_u32 s56,s65,196608
buffer_store_dwordx2 v[92:93],v9,s[8:11],s56 offen sc1
s_xor_b32 s65,s65,262144
s_cmp_eq_u32 s51,64
s_cbranch_scc1 L_cend_204
s_cmp_lt_u32 s47,16
s_waitcnt vmcnt(2)
s_cbranch_scc1 L_cea_211
s_barrier
ds_read_b128 v[56:59],v1 offset:0
ds_read_b128 v[60:63],v1 offset:4096
ds_read_b128 v[64:67],v1 offset:1024
ds_read_b128 v[68:71],v1 offset:5120
ds_read_b128 v[72:75],v1 offset:2048
ds_read_b128 v[76:79],v1 offset:6144
ds_read_b128 v[80:83],v1 offset:3072
ds_read_b128 v[84:87],v1 offset:7168
v_add_u32 v12,s73,v1
ds_read_b128 v[88:91],v12 offset:8192
ds_read_b128 v[92:95],v12 offset:9216
v_mov_b64 v[96:97],0
v_mov_b64 v[98:99],0
v_mov_b64 v[100:101],0
v_mov_b64 v[102:103],0
v_mov_b64 v[104:105],0
v_mov_b64 v[106:107],0
v_mov_b64 v[108:109],0
v_mov_b64 v[110:111],0
v_mov_b64 v[112:113],0
v_mov_b64 v[114:115],0
v_mov_b64 v[116:117],0
v_mov_b64 v[118:119],0
v_readlane_b32 s76,v23,4
s_cmp_ge_u32 s51,63
s_cselect_b32 s76,1,s76
s_waitcnt vmcnt(0)
L_crp_206:
buffer_load_dwordx4 v[120:123],v0,s[8:11],s66 offen offset:0 sc1
buffer_load_dwordx4 v[124:127],v0,s[8:11],s66 offen offset:1024 sc1
s_sub_u32 s49,s49,1
s_cbranch_scc1 L_abort2
s_waitcnt vmcnt(1)
v_mfma_f32_16x16x32_bf16 v[28:31],v[18:21],v[120:123],0
s_waitcnt vmcnt(0)
v_mfma_f32_16x16x32_bf16 v[28:31],v[18:21],v[124:127],v[28:31]
s_nop 7
v_cmp_u_f32 vcc,v28,v28
v_add_f32_dpp v32,v28,v28 row_ror:8 row_mask:0xf bank_mask:0x3
v_add_f32_dpp v33,v29,v29 row_ror:8 row_mask:0xf bank_mask:0x3
v_add_f32_dpp v32,v30,v30 row_ror:8 row_mask:0xf bank_mask:0xc
v_add_f32_dpp v33,v31,v31 row_ror:8 row_mask:0xf bank_mask:0xc
s_nop 0
v_add_f32_dpp v32,v32,v32 row_shl:4 row_mask:0xf bank_mask:0x5
v_add_f32_dpp v33,v33,v33 row_shl:4 row_mask:0xf bank_mask:0x5
s_cbranch_vccnz L_crp_206
v_cvt_pk_bf16_f32 v34,v32,v33
buffer_store_dword v34,v10,s[8:11],s64 offen sc1
s_mov_b32 s69,s66
s_xor_b32 s66,s66,262144
buffer_load_dwordx4 v[24:27],v13,s[8:11],s64 offen sc1
s_branch L_chain_201
L_cea_211:
buffer_load_dwordx4 v[120:123],v0,s[8:11],s66 offen offset:0 sc1
buffer_load_dwordx4 v[124:127],v0,s[8:11],s66 offen offset:1024 sc1
v_mov_b64 v[96:97],0
v_mov_b64 v[98:99],0
v_mov_b64 v[100:101],0
v_mov_b64 v[102:103],0
v_mov_b64 v[104:105],0
v_mov_b64 v[106:107],0
v_mov_b64 v[108:109],0
v_mov_b64 v[110:111],0
v_mov_b64 v[112:113],0
v_mov_b64 v[114:115],0
v_mov_b64 v[116:117],0
v_mov_b64 v[118:119],0
v_readlane_b32 s76,v23,4
s_cmp_ge_u32 s51,63
s_cselect_b32 s76,1,s76
s_branch L_cr1_212
L_crb_207:
buffer_load_dwordx4 v[120:123],v0,s[8:11],s66 offen offset:0 sc1
buffer_load_dwordx4 v[124:127],v0,s[8:11],s66 offen offset:1024 sc1
L_cr1_212:
s_sub_u32 s49,s49,1
s_cbranch_scc1 L_abort2
s_waitcnt vmcnt(1)
v_mfma_f32_16x16x32_bf16 v[28:31],v[18:21],v[120:123],0
s_waitcnt vmcnt(0)
v_mfma_f32_16x16x32_bf16 v[28:31],v[18:21],v[124:127],v[28:31]
s_nop 7
v_cmp_u_f32 vcc,v28,v28
v_add_f32_dpp v32,v28,v28 row_ror:8 row_mask:0xf bank_mask:0x3
v_add_f32_dpp v33,v29,v29 row_ror:8 row_mask:0xf bank_mask:0x3
v_add_f32_dpp v32,v30,v30 row_ror:8 row_mask:0xf bank_mask:0xc
v_add_f32_dpp v33,v31,v31 row_ror:8 row_mask:0xf bank_mask:0xc
s_nop 0
v_add_f32_dpp v32,v32,v32 row_shl:4 row_mask:0xf bank_mask:0x5
v_add_f32_dpp v33,v33,v33 row_shl:4 row_mask:0xf bank_mask:0x5
s_cbranch_vccnz L_crb_207
v_cvt_pk_bf16_f32 v34,v32,v33
buffer_store_dword v34,v10,s[8:11],s64 offen sc1
s_mov_b32 s69,s66
s_xor_b32 s66,s66,262144
s_barrier
ds_read_b128 v[56:59],v1 offset:0
ds_read_b128 v[60:63],v1 offset:4096
ds_read_b128 v[64:67],v1 offset:1024
ds_read_b128 v[68:71],v1 offset:5120
buffer_load_dwordx4 v[24:27],v13,s[8:11],s64 offen sc1
ds_read_b128 v[72:75],v1 offset:2048
ds_read_b128 v[76:79],v1 offset:6144
ds_read_b128 v[80:83],v1 offset:3072
ds_read_b128 v[84:87],v1 offset:7168
v_add_u32 v12,s73,v1
ds_read_b128 v[88:91],v12 offset:8192
ds_read_b128 v[92:95],v12 offset:9216
s_branch L_chain_201
L_ckw_195:
s_lshl2_add_u32 s59,s47,s75
s_add_u32 s59,s59,10494080
L_ww_213:
buffer_load_dword v23,off,s[8:11],s59 sc1
s_sub_u32 s49,s49,1
s_cbranch_scc1 L_abort2
s_waitcnt vmcnt(0)
v_readfirstlane_b32 s76,v23
s_cmp_eq_u32 s76,0
s_cbranch_scc1 L_ww_213
L_wwd_214:
s_branch L_ckb_196
L_cpb_208:
buffer_load_dwordx4 v[40:43],v13,s[8:11],s70 offen sc1
s_waitcnt vmcnt(0)
v_max3_u32 v12,v40,v41,v42
v_max_u32 v12,v43,v12
v_cmp_le_u32 vcc,s72,v12
s_cbranch_vccz L_cback_210
s_sub_u32 s49,s49,1
s_cmp_gt_i32 s49,0
s_cbranch_scc1 L_cpb_208
s_branch L_abort2
L_cend_204:
s_waitcnt vmcnt(0)
s_barrier
buffer_store_dword v2,off,s[8:11],s78 sc1
s_nop 11
v_lshrrev_b32 v1,4,v0
s_endpgm
L_rc2_172:
v_and_b32 v120,15,v1
v_lshrrev_b32 v121,4,v1
v_and_b32 v122,2,v1
v_cmp_eq_u32 vcc,0,v122
v_mov_b32 v2,0xeeee
v_mov_b32 v123,0x4444
v_cndmask_b32 v2,v2,v123,vcc
v_and_b32 v122,1,v1
v_cmp_eq_u32 vcc,0,v122
v_mov_b32 v3,0xdddd
v_mov_b32 v123,0x8888
v_cndmask_b32 v3,v3,v123,vcc
v_lshrrev_b32 v122,1,v120
v_bfe_u32 v123,v120,2,1
v_xor_b32 v123,v123,v122
v_lshlrev_b32 v4,7,v123
v_and_b32 v123,1,v120
v_lshl_add_u32 v4,v123,6,v4
v_xor_b32 v123,v121,v122
v_and_b32 v123,3,v123
v_lshl_add_u32 v4,v123,4,v4
s_lshl_b32 s56,s46,10
s_add_u32 s56,s56,147456
v_add_u32 v4,s56,v4
v_lshlrev_b32 v122,1,v121
v_add_u32 v122,0,v122
v_and_b32 v123,1,v121
v_xor_b32 v123,v123,v122
v_lshlrev_b32 v5,7,v123
v_bfe_u32 v123,v120,3,1
v_lshl_add_u32 v5,v123,6,v5
v_xor_b32 v123,v120,v122
v_and_b32 v123,3,v123
v_lshl_add_u32 v5,v123,4,v5
v_bfe_u32 v123,v120,2,1
v_lshl_add_u32 v5,v123,3,v5
v_add_u32 v5,147456,v5
v_lshlrev_b32 v122,1,v121
v_add_u32 v122,1,v122
v_and_b32 v123,1,v121
v_xor_b32 v123,v123,v122
v_lshlrev_b32 v6,7,v123
v_bfe_u32 v123,v120,3,1
v_lshl_add_u32 v6,v123,6,v6
v_xor_b32 v123,v120,v122
v_and_b32 v123,3,v123
v_lshl_add_u32 v6,v123,4,v6
v_bfe_u32 v123,v120,2,1
v_lshl_add_u32 v6,v123,3,v6
v_add_u32 v6,147456,v6
v_lshlrev_b32 v7,7,v121
v_lshrrev_b32 v122,1,v120
v_lshl_add_u32 v8,v122,4,v7
v_add_u32 v8,151552,v8
v_lshrrev_b32 v122,2,v120
v_lshl_add_u32 v7,v122,5,v7
v_and_b32 v122,1,v120
v_lshl_add_u32 v7,v122,4,v7
v_and_b32 v122,2,v120
v_lshl_add_u32 v7,v122,10,v7
s_lshl_b32 s56,s46,9
s_add_u32 s56,s56,151552
v_add_u32 v7,s56,v7
v_lshrrev_b32 v122,3,v1
v_lshlrev_b32 v9,11,v122
v_and_b32 v122,7,v1
v_lshl_add_u32 v9,v122,3,v9
s_lshl_b32 s56,s46,14
s_lshl_b32 s57,s47,6
s_add_u32 s56,s56,s57
v_add_u32 v9,s56,v9
s_lshl_b32 s71,s47,2
s_add_u32 s71,s71,s46
s_bfe_u32 s56,s71,0x10003
s_lshl_b32 s56,s56,11
s_and_b32 s57,s71,1
s_lshl_b32 s57,s57,10
s_add_u32 s56,s56,s57
s_bfe_u32 s57,s71,0x10002
s_lshl_b32 s57,s57,9
s_add_u32 s56,s56,s57
s_bfe_u32 s57,s71,0x10001
s_lshl_b32 s57,s57,6
s_add_u32 s56,s56,s57
s_bfe_u32 s57,s71,0x10004
s_lshl_b32 s57,s57,8
s_add_u32 s56,s56,s57
s_bfe_u32 s57,s71,0x10005
s_lshl_b32 s57,s57,7
s_add_u32 s56,s56,s57
s_bfe_u32 s57,s71,0x10006
s_lshl_b32 s57,s57,12
s_add_u32 s56,s56,s57
v_and_b32 v122,3,v120
v_lshlrev_b32 v10,2,v122
v_bfe_u32 v122,v120,3,1
v_lshl_add_u32 v10,v122,4,v10
v_and_b32 v122,1,v121
v_lshl_add_u32 v10,v122,5,v10
v_add_u32 v10,s56,v10
v_and_b32 v123,36,v1
v_mov_b32 v122,0x80000000
v_cmp_eq_u32 vcc,0,v123
s_nop 1
v_cndmask_b32 v10,v122,v10,vcc
s_lshl_b32 s56,s46,15
v_add_u32 v11,s56,v0
s_lshl_b32 s71,s71,11
s_lshl_b32 s73,s46,11
s_mov_b32 s72,0xffc00000
s_mov_b32 s74,0
v_lshrrev_b32 v13,3,v1
v_lshlrev_b32 v13,9,v13
v_and_b32 v122,7,v1
v_lshl_add_u32 v13,v122,4,v13
v_and_b32 v122,15,v1
v_and_b32 v123,1,v1
v_lshlrev_b32 v123,4,v123
v_mov_b32 v124,0x3f80
v_lshlrev_b32 v124,v123,v124
v_lshrrev_b32 v122,1,v122
v_cmp_eq_u32 vcc,0,v122
s_nop 1
v_cndmask_b32 v18,0,v124,vcc
v_cmp_eq_u32 vcc,1,v122
s_nop 1
v_cndmask_b32 v19,0,v124,vcc
v_cmp_eq_u32 vcc,2,v122
s_nop 1
v_cndmask_b32 v20,0,v124,vcc
v_cmp_eq_u32 vcc,3,v122
s_nop 1
v_cndmask_b32 v21,0,v124,vcc
s_and_b32 s56,s46,1
s_lshl_b32 s56,s56,8
s_and_b32 s57,s46,2
s_lshl_b32 s57,s57,6
s_add_u32 s56,s56,s57
v_add_u32 v13,s56,v13
s_xor_b32 s56,s46,0
s_lshl_b32 s56,s56,10
s_add_u32 s56,s56,147456
v_add_u32 v14,s56,v0
s_xor_b32 s56,s46,1
s_lshl_b32 s56,s56,10
s_add_u32 s56,s56,147456
v_add_u32 v15,s56,v0
s_xor_b32 s56,s46,2
s_lshl_b32 s56,s56,10
s_add_u32 s56,s56,147456
v_add_u32 v16,s56,v0
s_xor_b32 s56,s46,3
s_lshl_b32 s56,s56,10
s_add_u32 s56,s56,147456
v_add_u32 v17,s56,v0
v_add_u32 v22,13647872,v10
s_lshl_b32 s56,s47,2
s_add_u32 s56,s56,10502272
v_writelane_b32 v22,s56,4
s_mov_b32 s56,10519808
v_writelane_b32 v22,s56,5
v_add_u32 v1,131072,v0
s_mov_b32 s65,16777216
s_add_u32 s66,s71,16777216
s_add_u32 s69,s71,17039360
s_lshl_b32 s79,s47,2
s_add_u32 s79,s79,10486400
s_cmp_eq_u32 s46,0
s_cselect_b32 s79,s79,0x80000000
s_cmp_eq_u32 s47,0
s_cselect_b32 s31,17825792,-1
s_and_b32 s31,s31,0x8fffffff
s_mov_b32 s51,0
L_cst_215:
s_mov_b32 s60,s51
L_csc_220:
s_add_u32 s60,s60,1
s_add_u32 s61,s51,3
s_min_u32 s61,s61,63
s_cmp_gt_u32 s60,s61
s_cbranch_scc1 L_csd_221
s_lshl_b32 s59,s60,13
s_add_u32 s59,s59,10487040
L_ww_222:
buffer_load_dword v120,off,s[8:11],s59 sc1
s_sub_u32 s49,s49,1
s_cbranch_scc1 L_abort2
s_waitcnt vmcnt(0)
v_readfirstlane_b32 s61,v120
s_cmp_eq_u32 s61,0
s_cbranch_scc1 L_ww_222
L_wwd_223:
s_cmp_eq_u32 s61,2
s_cselect_b32 s51,s60,s51
s_branch L_csc_220
L_csd_221:
s_lshl_b32 s59,s51,13
s_lshl2_add_u32 s59,s47,s59
s_add_u32 s59,s59,10486016
L_ww_224:
buffer_load_dword v120,off,s[8:11],s59 sc1
s_sub_u32 s49,s49,1
s_cbranch_scc1 L_abort2
s_waitcnt vmcnt(0)
v_readfirstlane_b32 s61,v120
s_cmp_eq_u32 s61,0
s_cbranch_scc1 L_ww_224
L_wwd_225:
s_lshl_b32 s56,s51,5
s_add_u32 s56,s56,s47
s_mul_i32 s56,s56,24576
s_add_u32 s56,s56,201326592
s_add_u32 s67,s56,s73
s_add_u32 m0,s73,131072
s_add_u32 s57,s67,8192
buffer_load_dwordx4 v0,s[8:11],s67 offen sc1 lds
buffer_load_dwordx4 v0,s[8:11],s67 offen offset:1024 sc1 lds
s_add_u32 m0,s73,139264
s_add_u32 s67,s67,786432
buffer_load_dwordx4 v0,s[8:11],s57 offen sc1 lds
buffer_load_dwordx4 v0,s[8:11],s57 offen offset:1024 sc1 lds
s_lshl_b32 s75,s51,13
s_add_u32 s64,s75,17825792
s_add_u32 s70,s64,4096
s_lshl_b32 s68,s51,5
s_add_u32 s68,s68,s47
s_lshl_b32 s68,s68,13
s_lshl_b32 s56,s46,10
s_add_u32 s68,s68,s56
s_add_u32 s68,s68,75497472
s_sub_u32 s67,s67,50331648
s_mov_b32 s78,0x80000000
s_cmp_eq_u32 s51,63
s_cselect_b32 s76,1,0
s_waitcnt vmcnt(0)
s_barrier
ds_read_b128 v[56:59],v1 offset:0
ds_read_b128 v[60:63],v1 offset:4096
ds_read_b128 v[64:67],v1 offset:1024
ds_read_b128 v[68:71],v1 offset:5120
ds_read_b128 v[72:75],v1 offset:2048
ds_read_b128 v[76:79],v1 offset:6144
ds_read_b128 v[80:83],v1 offset:3072
ds_read_b128 v[84:87],v1 offset:7168
v_add_u32 v12,s73,v1
ds_read_b128 v[88:91],v12 offset:8192
ds_read_b128 v[92:95],v12 offset:9216
v_mov_b64 v[96:97],0
v_mov_b64 v[98:99],0
v_mov_b64 v[100:101],0
v_mov_b64 v[102:103],0
v_mov_b64 v[104:105],0
v_mov_b64 v[106:107],0
v_mov_b64 v[108:109],0
v_mov_b64 v[110:111],0
v_mov_b64 v[112:113],0
v_mov_b64 v[114:115],0
v_mov_b64 v[116:117],0
v_mov_b64 v[118:119],0
buffer_load_dwordx4 v[24:27],v13,s[8:11],s64 offen sc1
L_chain_226:
L_cpa_227:
buffer_load_dwordx4 v[24:27],v13,s[8:11],s64 offen sc1
s_sub_u32 s49,s49,1
s_cbranch_scc1 L_abort2
s_waitcnt vmcnt(1)
v_max3_u32 v12,v24,v25,v26
v_max_u32 v12,v27,v12
v_cmp_le_u32 vcc,s72,v12
s_cbranch_vccnz L_cpa_227
L_cgo_230:
ds_write_b128 v14,v[24:27] offset:0
buffer_load_dwordx4 v[40:43],v13,s[8:11],s70 offen sc1
v_smfmac_f32_16x16x64_bf16 v[96:99],v[24:27],a[0:7],v2
s_add_u32 m0,s73,131072
v_smfmac_f32_16x16x64_bf16 v[100:103],v[24:27],a[128:135],v2
s_add_u32 s57,s67,8192
v_smfmac_f32_16x16x64_bf16 v[104:107],v[24:27],a[8:15],v2
v_smfmac_f32_16x16x64_bf16 v[108:111],v[24:27],a[136:143],v2
s_waitcnt lgkmcnt(0)
s_barrier
ds_read_b128 v[28:31],v15 offset:0
ds_read_b128 v[32:35],v16 offset:0
ds_read_b128 v[36:39],v17 offset:0
v_smfmac_f32_16x16x64_bf16 v[112:115],v[24:27],v[128:135],v2
v_smfmac_f32_16x16x64_bf16 v[116:119],v[24:27],v[136:143],v2
s_waitcnt lgkmcnt(2)
v_smfmac_f32_16x16x64_bf16 v[96:99],v[28:31],a[16:23],v2
s_lshl_b32 s56,s46,10
v_smfmac_f32_16x16x64_bf16 v[100:103],v[28:31],a[144:151],v2
v_smfmac_f32_16x16x64_bf16 v[104:107],v[28:31],a[24:31],v2
v_smfmac_f32_16x16x64_bf16 v[108:111],v[28:31],a[152:159],v2
s_waitcnt lgkmcnt(1) vmcnt(0)
v_smfmac_f32_16x16x64_bf16 v[96:99],v[32:35],a[32:39],v2
v_max3_u32 v12,v40,v41,v42
v_smfmac_f32_16x16x64_bf16 v[100:103],v[32:35],a[160:167],v2
v_max_u32 v12,v43,v12
v_smfmac_f32_16x16x64_bf16 v[104:107],v[32:35],a[40:47],v2
v_cmp_le_u32 vcc,s72,v12
v_smfmac_f32_16x16x64_bf16 v[108:111],v[32:35],a[168:175],v2
s_cbranch_vccnz L_cpb_233
L_cback_235:
s_waitcnt lgkmcnt(0)
ds_write_b128 v14,v[40:43] offset:4096
v_smfmac_f32_16x16x64_bf16 v[96:99],v[36:39],a[48:55],v2
v_mov_b64 v[120:121],-1
v_smfmac_f32_16x16x64_bf16 v[100:103],v[36:39],a[176:183],v2
v_mov_b64 v[122:123],-1
v_smfmac_f32_16x16x64_bf16 v[104:107],v[36:39],a[56:63],v2
v_add_u32 v124,s56,v5
v_smfmac_f32_16x16x64_bf16 v[108:111],v[36:39],a[184:191],v2
v_add_u32 v126,s56,v6
s_waitcnt lgkmcnt(0)
s_barrier
v_smfmac_f32_16x16x64_bf16 v[96:99],v[40:43],a[64:71],v2
ds_read_b128 v[44:47],v15 offset:4096
v_smfmac_f32_16x16x64_bf16 v[100:103],v[40:43],a[192:199],v2
ds_read_b128 v[48:51],v16 offset:4096
v_smfmac_f32_16x16x64_bf16 v[104:107],v[40:43],a[72:79],v2
ds_read_b128 v[52:55],v17 offset:4096
v_smfmac_f32_16x16x64_bf16 v[108:111],v[40:43],a[200:207],v2
s_cmp_eq_u32 s76,0
s_cbranch_scc1 L_ckw_216
L_ckb_217:
s_waitcnt lgkmcnt(2)
v_smfmac_f32_16x16x64_bf16 v[96:99],v[44:47],a[80:87],v2
buffer_load_dwordx4 v0,s[8:11],s67 offen sc1 lds
v_smfmac_f32_16x16x64_bf16 v[100:103],v[44:47],a[208:215],v2
buffer_load_dwordx4 v0,s[8:11],s67 offen offset:1024 sc1 lds
v_smfmac_f32_16x16x64_bf16 v[104:107],v[44:47],a[88:95],v2
s_add_u32 m0,s73,139264
v_smfmac_f32_16x16x64_bf16 v[108:111],v[44:47],a[216:223],v2
s_waitcnt lgkmcnt(1)
v_smfmac_f32_16x16x64_bf16 v[96:99],v[48:51],a[96:103],v2
s_add_u32 s67,s67,786432
v_smfmac_f32_16x16x64_bf16 v[100:103],v[48:51],a[224:231],v2
buffer_load_dwordx4 v0,s[8:11],s57 offen sc1 lds
v_smfmac_f32_16x16x64_bf16 v[104:107],v[48:51],a[104:111],v2
buffer_load_dwordx4 v0,s[8:11],s57 offen offset:1024 sc1 lds
v_smfmac_f32_16x16x64_bf16 v[108:111],v[48:51],a[232:239],v2
s_waitcnt lgkmcnt(0)
v_smfmac_f32_16x16x64_bf16 v[96:99],v[52:55],a[112:119],v2
buffer_load_dword v23,v22,s[8:11],s75 offen sc1
v_smfmac_f32_16x16x64_bf16 v[100:103],v[52:55],a[240:247],v2
buffer_store_dword v2,off,s[8:11],s78 sc1
v_smfmac_f32_16x16x64_bf16 v[104:107],v[52:55],a[120:127],v2
buffer_store_dwordx4 v[120:123],v0,s[8:11],s69 offen sc1
v_smfmac_f32_16x16x64_bf16 v[108:111],v[52:55],a[248:255],v2
buffer_store_dwordx4 v[120:123],v0,s[8:11],s69 offen offset:1024 sc1
v_smfmac_f32_16x16x64_bf16 v[112:115],v[28:31],v[144:151],v2
v_smfmac_f32_16x16x64_bf16 v[116:119],v[28:31],v[152:159],v2
v_pk_add_f32 v[96:97],v[96:97],v[98:99]
v_pk_add_f32 v[100:101],v[100:101],v[102:103]
v_cvt_pk_bf16_f32 v120,v96,v97
v_cvt_pk_bf16_f32 v121,v100,v101
v_pk_add_f32 v[104:105],v[104:105],v[106:107]
v_pk_add_f32 v[108:109],v[108:109],v[110:111]
v_cvt_pk_bf16_f32 v122,v104,v105
v_cvt_pk_bf16_f32 v123,v108,v109
ds_write_b128 v4,v[120:123]
v_smfmac_f32_16x16x64_bf16 v[112:115],v[32:35],v[160:167],v2
v_smfmac_f32_16x16x64_bf16 v[116:119],v[32:35],v[168:175],v2
v_smfmac_f32_16x16x64_bf16 v[112:115],v[36:39],v[176:183],v2
v_smfmac_f32_16x16x64_bf16 v[116:119],v[36:39],v[184:191],v2
s_waitcnt lgkmcnt(0)
s_barrier
ds_read_b64_tr_b16 v[96:97],v5 offset:0
ds_read_b64_tr_b16 v[98:99],v6 offset:0
ds_read_b64_tr_b16 v[100:101],v5 offset:1024
ds_read_b64_tr_b16 v[102:103],v6 offset:1024
ds_read_b64_tr_b16 v[104:105],v5 offset:2048
ds_read_b64_tr_b16 v[106:107],v6 offset:2048
ds_read_b64_tr_b16 v[108:109],v5 offset:3072
ds_read_b64_tr_b16 v[110:111],v6 offset:3072
ds_read_b64_tr_b16 v[124:125],v124
ds_read_b64_tr_b16 v[126:127],v126
v_smfmac_f32_16x16x64_bf16 v[112:115],v[40:43],v[192:199],v2
v_smfmac_f32_16x16x64_bf16 v[116:119],v[40:43],v[200:207],v2
s_waitcnt lgkmcnt(8)
v_mfma_f32_16x16x32_bf16 v[24:27],v[56:59],v[96:99],0
v_mfma_f32_16x16x32_bf16 v[28:31],v[60:63],v[96:99],0
v_mfma_f32_16x16x32_bf16 v[32:35],v[96:99],v[96:99],0
s_waitcnt lgkmcnt(6)
v_mfma_f32_16x16x32_bf16 v[24:27],v[64:67],v[100:103],v[24:27]
ds_read_b128 v[56:59],v11 offset:0
v_mfma_f32_16x16x32_bf16 v[28:31],v[68:71],v[100:103],v[28:31]
ds_read_b128 v[60:63],v11 offset:1024
v_mfma_f32_16x16x32_bf16 v[32:35],v[100:103],v[100:103],v[32:35]
s_waitcnt lgkmcnt(6)
v_mfma_f32_16x16x32_bf16 v[24:27],v[72:75],v[104:107],v[24:27]
ds_read_b128 v[64:67],v11 offset:2048
v_mfma_f32_16x16x32_bf16 v[28:31],v[76:79],v[104:107],v[28:31]
ds_read_b128 v[68:71],v11 offset:3072
v_mfma_f32_16x16x32_bf16 v[32:35],v[104:107],v[104:107],v[32:35]
s_waitcnt lgkmcnt(6)
v_mfma_f32_16x16x32_bf16 v[24:27],v[80:83],v[108:111],v[24:27]
ds_read_b128 v[72:75],v11 offset:4096
v_mfma_f32_16x16x32_bf16 v[28:31],v[84:87],v[108:111],v[28:31]
ds_read_b128 v[76:79],v11 offset:5120
v_mfma_f32_16x16x32_bf16 v[32:35],v[108:111],v[108:111],v[32:35]
s_waitcnt lgkmcnt(6)
v_smfmac_f32_16x16x64_bf16 v[112:115],v[44:47],v[208:215],v2
buffer_store_dwordx4 v[124:127],v0,s[8:11],s68 offen sc1
v_smfmac_f32_16x16x64_bf16 v[116:119],v[44:47],v[216:223],v2
v_smfmac_f32_16x16x64_bf16 v[112:115],v[48:51],v[224:231],v2
v_smfmac_f32_16x16x64_bf16 v[116:119],v[48:51],v[232:239],v2
v_smfmac_f32_16x16x64_bf16 v[112:115],v[52:55],v[240:247],v2
v_smfmac_f32_16x16x64_bf16 v[116:119],v[52:55],v[248:255],v2
v_mov_b32 v125,0
v_mov_b64 v[52:53],s[28:29]
v_mov_b64 v[54:55],s[28:29]
v_max3_f32 v36,v24,v25,v26
v_max3_f32 v37,v27,v28,v29
v_max3_f32 v36,v30,v31,v36
v_max3_f32 v37,v34,v35,v37
v_max_f32 v36,v36,v37
v_max_f32 v37,v36,v37
ds_read_b128 v[80:83],v11 offset:6144
s_nop 0
v_permlane16_swap_b32 v36,v37
v_max_f32 v36,v36,v37
v_max_f32 v37,v36,v37
ds_read_b128 v[84:87],v11 offset:7168
s_nop 0
v_permlane32_swap_b32 v36,v37
v_max_f32 v36,v36,v37
v_mul_f32 v36,s80,v36
v_fma_f32 v24,v24,s80,-v36
v_fma_f32 v25,v25,s80,-v36
v_exp_f32 v24,v24
v_fma_f32 v26,v26,s80,-v36
v_exp_f32 v25,v25
v_fma_f32 v27,v27,s80,-v36
v_exp_f32 v26,v26
v_fma_f32 v28,v28,s80,-v36
v_exp_f32 v27,v27
v_fma_f32 v29,v29,s80,-v36
v_exp_f32 v28,v28
v_fma_f32 v30,v30,s80,-v36
v_exp_f32 v29,v29
v_fma_f32 v31,v31,s80,-v36
v_exp_f32 v30,v30
v_fma_f32 v34,v34,s80,-v36
v_exp_f32 v31,v31
v_fma_f32 v35,v35,s80,-v36
v_exp_f32 v34,v34
v_exp_f32 v35,v35
v_cvt_pk_bf16_f32 v120,v24,v25
v_cvt_pk_bf16_f32 v121,v26,v27
v_cvt_pk_bf16_f32 v122,v28,v29
v_cvt_pk_bf16_f32 v123,v30,v31
v_cvt_pk_bf16_f32 v124,v34,v35
s_nop 0
v_mfma_f32_16x16x32_bf16 v[32:35],v[52:55],v[120:123],0
v_pk_add_f32 v[112:113],v[112:113],v[114:115]
v_pk_add_f32 v[116:117],v[116:117],v[118:119]
v_mfma_f32_16x16x32_bf16 v[24:27],v[88:91],v[120:123],0
v_cvt_pk_bf16_f32 v36,v112,v113
v_cvt_pk_bf16_f32 v37,v116,v117
v_mfma_f32_16x16x32_bf16 v[28:31],v[92:95],v[120:123],0
v_cvt_pk_bf16_f32 v38,v116,v117
v_mov_b32 v39,0
v_mfma_f32_16x16x16_bf16 v[32:35],v[52:53],v[124:125],v[32:35]
s_add_u32 s56,s68,4096
buffer_store_dwordx4 v[36:39],v0,s[8:11],s56 offen sc1
v_mfma_f32_16x16x16_bf16 v[24:27],v[36:37],v[124:125],v[24:27]
ds_read_b128 v[96:99],v11 offset:8192
v_mfma_f32_16x16x16_bf16 v[28:31],v[38:39],v[124:125],v[28:31]
ds_read_b128 v[100:103],v11 offset:9216
v_rcp_f32 v32,v32
v_mov_b64 v[112:113],0
v_mov_b64 v[114:115],0
v_pk_mul_f32 v[24:25],v[24:25],v[32:33] op_sel_hi:[1,0]
v_pk_mul_f32 v[26:27],v[26:27],v[32:33] op_sel_hi:[1,0]
v_mov_b64 v[116:117],0
v_mov_b64 v[118:119],0
v_pk_mul_f32 v[28:29],v[28:29],v[32:33] op_sel_hi:[1,0]
v_pk_mul_f32 v[30:31],v[30:31],v[32:33] op_sel_hi:[1,0]
v_cvt_pk_bf16_f32 v120,v24,v28
v_cvt_pk_bf16_f32 v121,v25,v29
v_cvt_pk_bf16_f32 v122,v26,v30
v_cvt_pk_bf16_f32 v123,v27,v31
ds_write_b128 v7,v[120:123]
ds_read_b128 v[104:107],v11 offset:10240
ds_read_b128 v[108:111],v11 offset:11264
ds_read_b128 v[40:43],v11 offset:12288
ds_read_b128 v[44:47],v11 offset:13312
s_waitcnt lgkmcnt(4)
s_barrier
ds_read_b128 v[24:27],v8 offset:0
ds_read_b128 v[28:31],v8 offset:512
ds_read_b128 v[32:35],v8 offset:1024
ds_read_b128 v[36:39],v8 offset:1536
ds_read_b128 v[48:51],v11 offset:14336
ds_read_b128 v[52:55],v11 offset:15360
v_mov_b64 v[88:89],0
v_mov_b64 v[90:91],0
v_mov_b64 v[92:93],0
v_mov_b64 v[94:95],0
s_waitcnt lgkmcnt(5)
v_smfmac_f32_16x16x64_bf16 v[112:115],v[24:27],v[56:63],v3
ds_read_b128 v[56:59],v11 offset:16384
ds_read_b128 v[60:63],v11 offset:17408
s_waitcnt lgkmcnt(6)
v_smfmac_f32_16x16x64_bf16 v[112:115],v[28:31],v[64:71],v3
ds_read_b128 v[64:67],v11 offset:18432
ds_read_b128 v[68:71],v11 offset:19456
s_waitcnt lgkmcnt(7)
v_smfmac_f32_16x16x64_bf16 v[112:115],v[32:35],v[72:79],v3
ds_read_b128 v[72:75],v11 offset:20480
ds_read_b128 v[76:79],v11 offset:21504
s_waitcnt lgkmcnt(8)
v_smfmac_f32_16x16x64_bf16 v[112:115],v[36:39],v[80:87],v3
ds_read_b128 v[80:83],v11 offset:22528
ds_read_b128 v[84:87],v11 offset:23552
s_waitcnt lgkmcnt(8)
v_smfmac_f32_16x16x64_bf16 v[116:119],v[24:27],v[96:103],v3
ds_read_b128 v[96:99],v11 offset:24576
ds_read_b128 v[100:103],v11 offset:25600
v_smfmac_f32_16x16x64_bf16 v[116:119],v[28:31],v[104:111],v3
v_cvt_pk_bf16_f32 v112,v112,v113
v_cvt_pk_bf16_f32 v113,v114,v115
buffer_store_dwordx2 v[112:113],v9,s[8:11],s65 offen sc1
ds_read_b128 v[104:107],v11 offset:26624
ds_read_b128 v[108:111],v11 offset:27648
v_smfmac_f32_16x16x64_bf16 v[116:119],v[32:35],v[40:47],v3
ds_read_b128 v[40:43],v11 offset:28672
ds_read_b128 v[44:47],v11 offset:29696
v_smfmac_f32_16x16x64_bf16 v[116:119],v[36:39],v[48:55],v3
s_waitcnt lgkmcnt(12)
ds_read_b128 v[48:51],v11 offset:30720
ds_read_b128 v[52:55],v11 offset:31744
s_waitcnt lgkmcnt(14)
v_smfmac_f32_16x16x64_bf16 v[88:91],v[24:27],v[56:63],v3
s_nop 2
v_cvt_pk_bf16_f32 v116,v116,v117
v_cvt_pk_bf16_f32 v117,v118,v119
s_add_u32 s56,s65,65536
buffer_store_dwordx2 v[116:117],v9,s[8:11],s56 offen sc1
s_waitcnt lgkmcnt(12)
v_smfmac_f32_16x16x64_bf16 v[88:91],v[28:31],v[64:71],v3
s_waitcnt lgkmcnt(10)
v_smfmac_f32_16x16x64_bf16 v[88:91],v[32:35],v[72:79],v3
s_waitcnt lgkmcnt(8)
v_smfmac_f32_16x16x64_bf16 v[88:91],v[36:39],v[80:87],v3
s_waitcnt lgkmcnt(6)
v_smfmac_f32_16x16x64_bf16 v[92:95],v[24:27],v[96:103],v3
s_waitcnt lgkmcnt(4)
v_smfmac_f32_16x16x64_bf16 v[92:95],v[28:31],v[104:111],v3
v_cvt_pk_bf16_f32 v88,v88,v89
v_cvt_pk_bf16_f32 v89,v90,v91
s_add_u32 s56,s65,131072
buffer_store_dwordx2 v[88:89],v9,s[8:11],s56 offen sc1
s_waitcnt lgkmcnt(2)
v_smfmac_f32_16x16x64_bf16 v[92:95],v[32:35],v[40:47],v3
s_waitcnt lgkmcnt(0)
v_smfmac_f32_16x16x64_bf16 v[92:95],v[36:39],v[48:55],v3
s_add_u32 s78,s79,s75
s_add_u32 s75,s75,8192
s_add_u32 s64,s75,13631488
s_add_u32 s70,s64,4096
s_add_u32 s68,s68,262144
s_add_u32 s51,s51,1
s_nop 1
v_cvt_pk_bf16_f32 v92,v92,v93
v_cvt_pk_bf16_f32 v93,v94,v95
s_add_u32 s56,s65,196608
buffer_store_dwordx2 v[92:93],v9,s[8:11],s56 offen sc1
s_xor_b32 s65,s65,262144
s_cmp_eq_u32 s51,64
s_cbranch_scc1 L_cend_229
s_cmp_lt_u32 s47,16
s_waitcnt vmcnt(2)
s_cbranch_scc1 L_cea_236
s_barrier
ds_read_b128 v[56:59],v1 offset:0
ds_read_b128 v[60:63],v1 offset:4096
ds_read_b128 v[64:67],v1 offset:1024
ds_read_b128 v[68:71],v1 offset:5120
ds_read_b128 v[72:75],v1 offset:2048
ds_read_b128 v[76:79],v1 offset:6144
ds_read_b128 v[80:83],v1 offset:3072
ds_read_b128 v[84:87],v1 offset:7168
v_add_u32 v12,s73,v1
ds_read_b128 v[88:91],v12 offset:8192
ds_read_b128 v[92:95],v12 offset:9216
v_mov_b64 v[96:97],0
v_mov_b64 v[98:99],0
v_mov_b64 v[100:101],0
v_mov_b64 v[102:103],0
v_mov_b64 v[104:105],0
v_mov_b64 v[106:107],0
v_mov_b64 v[108:109],0
v_mov_b64 v[110:111],0
v_mov_b64 v[112:113],0
v_mov_b64 v[114:115],0
v_mov_b64 v[116:117],0
v_mov_b64 v[118:119],0
v_readlane_b32 s76,v23,4
s_cmp_ge_u32 s51,63
s_cselect_b32 s76,1,s76
v_readlane_b32 s77,v23,5
s_cmp_gt_u32 s51,60
s_cselect_b32 s77,1,s77
s_waitcnt vmcnt(0)
L_crp_231:
buffer_load_dwordx4 v[120:123],v0,s[8:11],s66 offen offset:0 sc1
buffer_load_dwordx4 v[124:127],v0,s[8:11],s66 offen offset:1024 sc1
s_sub_u32 s49,s49,1
s_cbranch_scc1 L_abort2
s_waitcnt vmcnt(1)
v_mfma_f32_16x16x32_bf16 v[28:31],v[18:21],v[120:123],0
s_waitcnt vmcnt(0)
v_mfma_f32_16x16x32_bf16 v[28:31],v[18:21],v[124:127],v[28:31]
s_nop 7
v_cmp_u_f32 vcc,v28,v28
v_add_f32_dpp v32,v28,v28 row_ror:8 row_mask:0xf bank_mask:0x3
v_add_f32_dpp v33,v29,v29 row_ror:8 row_mask:0xf bank_mask:0x3
v_add_f32_dpp v32,v30,v30 row_ror:8 row_mask:0xf bank_mask:0xc
v_add_f32_dpp v33,v31,v31 row_ror:8 row_mask:0xf bank_mask:0xc
s_nop 0
v_add_f32_dpp v32,v32,v32 row_shl:4 row_mask:0xf bank_mask:0x5
v_add_f32_dpp v33,v33,v33 row_shl:4 row_mask:0xf bank_mask:0x5
s_cbranch_vccnz L_crp_231
v_cvt_pk_bf16_f32 v34,v32,v33
buffer_store_dword v34,v10,s[8:11],s64 offen sc1
s_mov_b32 s69,s66
s_xor_b32 s66,s66,262144
buffer_load_dwordx4 v[24:27],v13,s[8:11],s64 offen sc1
s_cmp_lg_u32 s77,1
s_cbranch_scc1 L_cjw_218
s_branch L_chain_226
L_cea_236:
buffer_load_dwordx4 v[120:123],v0,s[8:11],s66 offen offset:0 sc1
buffer_load_dwordx4 v[124:127],v0,s[8:11],s66 offen offset:1024 sc1
v_mov_b64 v[96:97],0
v_mov_b64 v[98:99],0
v_mov_b64 v[100:101],0
v_mov_b64 v[102:103],0
v_mov_b64 v[104:105],0
v_mov_b64 v[106:107],0
v_mov_b64 v[108:109],0
v_mov_b64 v[110:111],0
v_mov_b64 v[112:113],0
v_mov_b64 v[114:115],0
v_mov_b64 v[116:117],0
v_mov_b64 v[118:119],0
v_readlane_b32 s76,v23,4
s_cmp_ge_u32 s51,63
s_cselect_b32 s76,1,s76
v_readlane_b32 s77,v23,5
s_cmp_gt_u32 s51,60
s_cselect_b32 s77,1,s77
s_branch L_cr1_237
L_crb_232:
buffer_load_dwordx4 v[120:123],v0,s[8:11],s66 offen offset:0 sc1
buffer_load_dwordx4 v[124:127],v0,s[8:11],s66 offen offset:1024 sc1
L_cr1_237:
s_sub_u32 s49,s49,1
s_cbranch_scc1 L_abort2
s_waitcnt vmcnt(1)
v_mfma_f32_16x16x32_bf16 v[28:31],v[18:21],v[120:123],0
s_waitcnt vmcnt(0)
v_mfma_f32_16x16x32_bf16 v[28:31],v[18:21],v[124:127],v[28:31]
s_nop 7
v_cmp_u_f32 vcc,v28,v28
v_add_f32_dpp v32,v28,v28 row_ror:8 row_mask:0xf bank_mask:0x3
v_add_f32_dpp v33,v29,v29 row_ror:8 row_mask:0xf bank_mask:0x3
v_add_f32_dpp v32,v30,v30 row_ror:8 row_mask:0xf bank_mask:0xc
v_add_f32_dpp v33,v31,v31 row_ror:8 row_mask:0xf bank_mask:0xc
s_nop 0
v_add_f32_dpp v32,v32,v32 row_shl:4 row_mask:0xf bank_mask:0x5
v_add_f32_dpp v33,v33,v33 row_shl:4 row_mask:0xf bank_mask:0x5
s_cbranch_vccnz L_crb_232
v_cvt_pk_bf16_f32 v34,v32,v33
buffer_store_dword v34,v10,s[8:11],s64 offen sc1
s_mov_b32 s69,s66
s_xor_b32 s66,s66,262144
s_barrier
ds_read_b128 v[56:59],v1 offset:0
ds_read_b128 v[60:63],v1 offset:4096
ds_read_b128 v[64:67],v1 offset:1024
ds_read_b128 v[68:71],v1 offset:5120
buffer_load_dwordx4 v[24:27],v13,s[8:11],s64 offen sc1
ds_read_b128 v[72:75],v1 offset:2048
ds_read_b128 v[76:79],v1 offset:6144
ds_read_b128 v[80:83],v1 offset:3072
ds_read_b128 v[84:87],v1 offset:7168
v_add_u32 v12,s73,v1
ds_read_b128 v[88:91],v12 offset:8192
ds_read_b128 v[92:95],v12 offset:9216
s_cmp_lg_u32 s77,1
s_cbranch_scc1 L_cjw_218
s_branch L_chain_226
L_ckw_216:
s_lshl2_add_u32 s59,s47,s75
s_add_u32 s59,s59,10494080
L_ww_238:
buffer_load_dword v23,off,s[8:11],s59 sc1
s_sub_u32 s49,s49,1
s_cbranch_scc1 L_abort2
s_waitcnt vmcnt(0)
v_readfirstlane_b32 s76,v23
s_cmp_eq_u32 s76,0
s_cbranch_scc1 L_ww_238
L_wwd_239:
s_branch L_ckb_217
L_cjw_218:
s_add_u32 s59,s75,10511616
L_ww_240:
buffer_load_dword v120,off,s[8:11],s59 sc1
s_sub_u32 s49,s49,1
s_cbranch_scc1 L_abort2
s_waitcnt vmcnt(0)
v_readfirstlane_b32 s77,v120
s_cmp_eq_u32 s77,0
s_cbranch_scc1 L_ww_240
L_wwd_241:
s_cmp_eq_u32 s77,1
s_cbranch_scc1 L_chain_226
L_cjump_219:
buffer_load_dwordx4 v[24:27],v13,s[8:11],s64 offen sc1
buffer_load_dwordx4 v[40:43],v13,s[8:11],s70 offen sc1
s_sub_u32 s49,s49,1
s_cbranch_scc1 L_abort2
s_waitcnt vmcnt(0)
v_max3_u32 v12,v24,v25,v26
v_max_u32 v12,v27,v12
v_max3_u32 v12,v40,v41,v12
v_max3_u32 v12,v42,v43,v12
v_cmp_le_u32 vcc,s72,v12
s_cbranch_vccnz L_cjump_219
s_waitcnt lgkmcnt(0)
s_barrier
s_add_u32 s51,s51,3
s_branch L_cst_215
L_cpb_233:
buffer_load_dwordx4 v[40:43],v13,s[8:11],s70 offen sc1
s_waitcnt vmcnt(0)
v_max3_u32 v12,v40,v41,v42
v_max_u32 v12,v43,v12
v_cmp_le_u32 vcc,s72,v12
s_cbranch_vccz L_cback_235
s_sub_u32 s49,s49,1
s_cmp_gt_i32 s49,0
s_cbranch_scc1 L_cpb_233
s_branch L_abort2
L_cend_229:
s_waitcnt vmcnt(0)
s_barrier
buffer_store_dword v2,off,s[8:11],s78 sc1
s_nop 11
v_lshrrev_b32 v1,4,v0
s_endpgm
L_wa:
s_nop 11
v_and_b32 v238,15,v1
v_and_b32 v239,1,v1
v_lshlrev_b32 v239,4,v239
v_mov_b32 v240,0x3f80
v_lshlrev_b32 v240,v239,v240
v_lshrrev_b32 v238,1,v238
v_cmp_eq_u32 vcc,0,v238
s_nop 1
v_cndmask_b32 v156,0,v240,vcc
v_cmp_eq_u32 vcc,1,v238
s_nop 1
v_cndmask_b32 v157,0,v240,vcc
v_cmp_eq_u32 vcc,2,v238
s_nop 1
v_cndmask_b32 v158,0,v240,vcc
v_cmp_eq_u32 vcc,3,v238
s_nop 1
v_cndmask_b32 v159,0,v240,vcc
s_mov_b32 s4,s32
s_mov_b32 s5,s33
s_mov_b32 s6,1024
s_mov_b32 s7,0x20000
buffer_load_dwordx4 v[224:227],v0,s[4:7],0 offen
v_and_b32 v238,15,v1
v_lshrrev_b32 v239,4,v1
v_lshlrev_b32 v240,2,v239
v_mov_b32 v241,0xf149f2ca
s_and_b32 s56,s46,1
s_lshl_b32 s56,s56,4
v_add_u32 v242,s56,v238
v_add_u32 v243,0,v240
v_cmp_gt_u32 vcc,v243,v242
s_nop 1
v_cndmask_b32 v8,0,v241,vcc
v_add_u32 v243,1,v240
v_cmp_gt_u32 vcc,v243,v242
s_nop 1
v_cndmask_b32 v9,0,v241,vcc
v_add_u32 v243,2,v240
v_cmp_gt_u32 vcc,v243,v242
s_nop 1
v_cndmask_b32 v10,0,v241,vcc
v_add_u32 v243,3,v240
v_cmp_gt_u32 vcc,v243,v242
s_nop 1
v_cndmask_b32 v11,0,v241,vcc
v_add_u32 v243,16,v240
v_cmp_gt_u32 vcc,v243,v242
s_nop 1
v_cndmask_b32 v12,0,v241,vcc
v_add_u32 v243,17,v240
v_cmp_gt_u32 vcc,v243,v242
s_nop 1
v_cndmask_b32 v13,0,v241,vcc
v_add_u32 v243,18,v240
v_cmp_gt_u32 vcc,v243,v242
s_nop 1
v_cndmask_b32 v14,0,v241,vcc
v_add_u32 v243,19,v240
v_cmp_gt_u32 vcc,v243,v242
s_nop 1
v_cndmask_b32 v15,0,v241,vcc
v_mov_b64 v[152:153],s[28:29]
v_mov_b64 v[154:155],s[28:29]
v_mov_b32 v145,0
v_mov_b32 v146,0
s_lshl_b32 s56,s46,12
s_add_u32 s56,s56,131072
v_add_u32 v3,s56,v0
v_add_u32 v4,131072,v0
s_lshl_b32 s56,s46,8
v_lshlrev_b32 v7,4,v238
v_add_u32 v7,s56,v7
v_lshl_add_u32 v5,v239,16,v7
v_lshlrev_b32 v6,1,v7
v_lshl_add_u32 v7,v239,10,v7
v_and_b32 v243,1,v239
v_lshl_add_u32 v6,v243,4,v6
v_lshrrev_b32 v243,1,v239
v_lshl_add_u32 v6,v243,12,v6
v_add_u32 v6,147456,v6
v_lshlrev_b32 v16,2,v238
v_lshlrev_b32 v21,3,v238
s_and_b32 s68,s47,15
s_lshl_b32 s56,s68,10
v_add_u32 v5,s56,v5
s_lshl_b32 s56,s68,15
v_add_u32 v7,s56,v7
s_lshl_b32 s69,s54,20
s_add_u32 s69,s69,20971520
s_lshl_b32 s87,s54,13
s_add_u32 s87,s87,10486656
s_lshl2_add_u32 s74,s68,s87
s_or_b32 s74,s74,s52
s_lshl_b32 s68,s68,1
s_lshr_b32 s56,s46,1
s_add_u32 s68,s68,s56
s_mov_b32 s66,0
s_mov_b32 s67,0
s_mov_b32 s73,0x80000000
s_mov_b32 s75,0
s_mov_b32 s12,s40
s_mov_b32 s13,s41
s_mov_b32 s14,2097152
s_mov_b32 s15,0x20000
v_add_u32 v21,10487168,v21
v_mov_b32 v244,v21
s_and_b32 s56,s50,2048
s_add_u32 s56,s56,147456
v_lshlrev_b32 v23,5,v1
v_add_u32 v23,s56,v23
v_mov_b32 v245,155648
s_lshl_b32 s56,s46,2
v_add_u32 v247,s56,v245
s_waitcnt vmcnt(0)
v_lshlrev_b32 v228,16,v224
v_and_b32 v229,0xffff0000,v224
v_lshlrev_b32 v230,16,v225
v_and_b32 v231,0xffff0000,v225
v_lshlrev_b32 v232,16,v226
v_and_b32 v233,0xffff0000,v226
v_lshlrev_b32 v234,16,v227
v_and_b32 v235,0xffff0000,v227
s_cmp_lt_u32 s54,2
s_cbranch_scc1 L_aa_242
s_sub_u32 s77,s54,2
s_mov_b32 s30,0
s_mov_b32 s86,1536
s_lshl_b32 s56,s77,5
s_add_u32 s56,s56,s68
s_mul_i32 s70,s56,24576
s_lshl_b32 s71,s56,13
s_lshl_b32 s59,s77,13
s_lshl2_add_u32 s59,s68,s59
s_add_u32 s59,s59,10485760
s_buffer_load_dword s32,s[8:11],s59 glc
s_mov_b32 s33,1
s_add_u32 s70,s70,100663296
s_add_u32 s71,s71,41943040
v_mov_b32 v19,s59
s_branch L_aa_250
L_aa_243:
ds_read_b128 v[24:27],v4 offset:0
ds_read_b128 v[28:31],v4 offset:1024
ds_read_b128 v[32:35],v4 offset:2048
ds_read_b128 v[36:39],v4 offset:3072
ds_read_b128 v[40:43],v4 offset:8192
ds_read_b128 v[44:47],v4 offset:9216
ds_read_b128 v[48:51],v4 offset:10240
ds_read_b128 v[52:55],v4 offset:11264
s_min_u32 s56,s32,s33
s_cmp_lt_u32 s77,64
s_cselect_b32 s56,s56,0
s_cmp_eq_u32 s56,0
s_cselect_b32 s72,0x80000000,0
v_mov_b32 v248,s72
s_or_b32 s64,s70,s72
s_or_b32 s65,s71,s72
ds_write_b32 v247,v248
s_and_b32 s57,s46,1
s_mul_i32 s58,s57,12288
s_add_u32 s64,s64,s58
s_lshl_b32 s57,s57,12
s_add_u32 s65,s65,s57
s_and_b32 s59,s50,2048
s_lshl_b32 s59,s59,4
s_xor_b32 s60,s67,65536
s_add_u32 s59,s59,s60
s_add_u32 s58,s58,s59
s_add_u32 s57,s57,s59
s_add_u32 m0,s58,0
s_waitcnt lgkmcnt(8)
v_mfma_f32_16x16x32_bf16 v[160:163],v[24:27],a[0:3],0
buffer_load_dwordx4 v0,s[8:11],s64 offen offset:0 sc1 lds
v_mfma_f32_16x16x32_bf16 v[164:167],v[24:27],a[4:7],0
s_lshl_b32 s23,s51,5
s_add_u32 s23,s23,s68
v_mfma_f32_16x16x32_bf16 v[168:171],v[24:27],a[8:11],0
s_lshl_b32 s24,s23,10
s_lshl_b32 s25,s51,10
v_mfma_f32_16x16x32_bf16 v[172:175],v[24:27],a[12:15],0
s_add_u32 s25,s25,2883584
s_cmp_eq_u32 s23,s55
s_cselect_b32 s25,s25,s24
v_mfma_f32_16x16x32_bf16 v[176:179],v[24:27],a[16:19],0
buffer_load_dwordx4 v0,s[8:11],s64 offen offset:1024 sc1 lds
v_mfma_f32_16x16x32_bf16 v[180:183],v[24:27],a[20:23],0
s_add_u32 s25,s25,8388608
s_mov_b32 s6,268435456
v_mfma_f32_16x16x32_bf16 v[184:187],v[24:27],a[24:27],0
s_cmp_eq_u32 s31,0
s_cselect_b32 s25,s24,s25
s_cselect_b64 s[4:5],s[16:17],s[44:45]
s_cmov_b32 s6,2097152
v_mfma_f32_16x16x32_bf16 v[188:191],v[24:27],a[28:31],0
buffer_load_dwordx4 v[224:227],v0,s[4:7],s25 offen sc1
s_waitcnt lgkmcnt(7)
v_mfma_f32_16x16x32_bf16 v[160:163],v[28:31],a[32:35],v[160:163]
buffer_load_dwordx4 v0,s[8:11],s64 offen offset:2048 sc1 lds
v_mfma_f32_16x16x32_bf16 v[164:167],v[28:31],a[36:39],v[164:167]
s_cmp_lt_u32 s51,55
s_cselect_b32 s24,s86,1536
v_mfma_f32_16x16x32_bf16 v[168:171],v[28:31],a[40:43],v[168:171]
s_cmp_eq_u32 s24,768
s_cselect_b32 s24,128,0
v_mfma_f32_16x16x32_bf16 v[172:175],v[28:31],a[44:47],v[172:175]
s_lshl_b32 s23,s51,13
s_lshl2_add_u32 s23,s68,s23
v_mfma_f32_16x16x32_bf16 v[176:179],v[28:31],a[48:51],v[176:179]
buffer_load_dwordx4 v0,s[8:11],s64 offen offset:3072 sc1 lds
v_mfma_f32_16x16x32_bf16 v[180:183],v[28:31],a[52:55],v[180:183]
s_add_u32 s23,s23,10487168
s_add_u32 s23,s23,s24
v_mfma_f32_16x16x32_bf16 v[184:187],v[28:31],a[56:59],v[184:187]
buffer_load_dword v246,off,s[8:11],s23 sc1
v_mfma_f32_16x16x32_bf16 v[188:191],v[28:31],a[60:63],v[188:191]
v_lshrrev_b32 v244,4,v1
s_sub_u32 s23,s77,8
s_waitcnt lgkmcnt(6)
v_mfma_f32_16x16x32_bf16 v[160:163],v[32:35],a[64:67],v[160:163]
s_add_u32 m0,s58,4096
s_add_u32 s64,s64,4096
v_mfma_f32_16x16x32_bf16 v[164:167],v[32:35],a[68:71],v[164:167]
buffer_load_dwordx4 v0,s[8:11],s64 offen offset:0 sc1 lds
v_mfma_f32_16x16x32_bf16 v[168:171],v[32:35],a[72:75],v[168:171]
v_add_u32 v244,s23,v244
v_max_i32 v244,0,v244
v_mfma_f32_16x16x32_bf16 v[172:175],v[32:35],a[76:79],v[172:175]
v_lshl_add_u32 v244,v244,13,v21
buffer_load_dwordx2 v[242:243],v244,s[8:11],0 offen sc1
v_mfma_f32_16x16x32_bf16 v[176:179],v[32:35],a[80:83],v[176:179]
s_waitcnt lgkmcnt(0)
s_barrier
v_mfma_f32_16x16x32_bf16 v[180:183],v[32:35],a[84:87],v[180:183]
buffer_load_dwordx4 v0,s[8:11],s64 offen offset:1024 sc1 lds
v_mfma_f32_16x16x32_bf16 v[184:187],v[32:35],a[88:91],v[184:187]
v_mfma_f32_16x16x32_bf16 v[188:191],v[32:35],a[92:95],v[188:191]
s_waitcnt lgkmcnt(1)
v_mfma_f32_16x16x32_bf16 v[160:163],v[36:39],a[96:99],v[160:163]
ds_read_b128 v[56:59],v4 offset:4096
v_mfma_f32_16x16x32_bf16 v[164:167],v[36:39],a[100:103],v[164:167]
buffer_load_dwordx4 v0,s[8:11],s64 offen offset:2048 sc1 lds
v_mfma_f32_16x16x32_bf16 v[168:171],v[36:39],a[104:107],v[168:171]
ds_read_b128 v[60:63],v4 offset:5120
v_mfma_f32_16x16x32_bf16 v[172:175],v[36:39],a[108:111],v[172:175]
ds_read_b128 v[64:67],v4 offset:6144
v_mfma_f32_16x16x32_bf16 v[176:179],v[36:39],a[112:115],v[176:179]
ds_read_b128 v[68:71],v4 offset:7168
v_mfma_f32_16x16x32_bf16 v[180:183],v[36:39],a[116:119],v[180:183]
buffer_load_dwordx4 v0,s[8:11],s64 offen offset:3072 sc1 lds
v_mfma_f32_16x16x32_bf16 v[184:187],v[36:39],a[120:123],v[184:187]
ds_read_b128 v[72:75],v4 offset:12288
v_mfma_f32_16x16x32_bf16 v[188:191],v[36:39],a[124:127],v[188:191]
ds_read_b128 v[76:79],v4 offset:13312
v_mfma_f32_16x16x32_bf16 v[160:163],v[40:43],a[128:131],v[160:163]
ds_read_b128 v[80:83],v4 offset:14336
v_mfma_f32_16x16x32_bf16 v[164:167],v[40:43],a[132:135],v[164:167]
s_add_u32 m0,s58,8192
s_add_u32 s64,s64,4096
v_mfma_f32_16x16x32_bf16 v[168:171],v[40:43],a[136:139],v[168:171]
buffer_load_dwordx4 v0,s[8:11],s64 offen offset:0 sc1 lds
v_mfma_f32_16x16x32_bf16 v[172:175],v[40:43],a[140:143],v[172:175]
ds_read_b128 v[84:87],v4 offset:15360
v_mfma_f32_16x16x32_bf16 v[176:179],v[40:43],a[144:147],v[176:179]
ds_read_b128 v[248:251],v245
v_mfma_f32_16x16x32_bf16 v[180:183],v[40:43],a[148:151],v[180:183]
s_waitcnt vmcnt(12)
buffer_store_dword v20,off,s[8:11],s73 sc1
v_mfma_f32_16x16x32_bf16 v[184:187],v[40:43],a[152:155],v[184:187]
buffer_load_dwordx4 v0,s[8:11],s64 offen offset:1024 sc1 lds
v_mfma_f32_16x16x32_bf16 v[188:191],v[40:43],a[156:159],v[188:191]
s_mov_b32 s73,0x80000000
v_mfma_f32_16x16x32_bf16 v[160:163],v[44:47],a[160:163],v[160:163]
v_mfma_f32_16x16x32_bf16 v[164:167],v[44:47],a[164:167],v[164:167]
v_mfma_f32_16x16x32_bf16 v[168:171],v[44:47],a[168:171],v[168:171]
buffer_load_dwordx4 v0,s[8:11],s64 offen offset:2048 sc1 lds
v_mfma_f32_16x16x32_bf16 v[172:175],v[44:47],a[172:175],v[172:175]
s_waitcnt lgkmcnt(0)
v_or3_b32 v248,v248,v249,v250
v_mfma_f32_16x16x32_bf16 v[176:179],v[44:47],a[176:179],v[176:179]
v_or_b32 v248,v248,v251
v_mfma_f32_16x16x32_bf16 v[180:183],v[44:47],a[180:183],v[180:183]
v_readfirstlane_b32 s72,v248
v_mfma_f32_16x16x32_bf16 v[184:187],v[44:47],a[184:187],v[184:187]
buffer_load_dwordx4 v0,s[8:11],s64 offen offset:3072 sc1 lds
v_mfma_f32_16x16x32_bf16 v[188:191],v[44:47],a[188:191],v[188:191]
v_mfma_f32_16x16x32_bf16 v[160:163],v[48:51],a[192:195],v[160:163]
v_mfma_f32_16x16x32_bf16 v[164:167],v[48:51],a[196:199],v[164:167]
v_mfma_f32_16x16x32_bf16 v[168:171],v[48:51],a[200:203],v[168:171]
s_add_u32 m0,s57,24576
s_nop 0
buffer_load_dwordx4 v0,s[8:11],s65 offen offset:0 sc1 lds
v_mfma_f32_16x16x32_bf16 v[172:175],v[48:51],a[204:207],v[172:175]
v_mfma_f32_16x16x32_bf16 v[176:179],v[48:51],a[208:211],v[176:179]
v_mfma_f32_16x16x32_bf16 v[180:183],v[48:51],a[212:215],v[180:183]
v_mfma_f32_16x16x32_bf16 v[184:187],v[48:51],a[216:219],v[184:187]
buffer_load_dwordx4 v0,s[8:11],s65 offen offset:1024 sc1 lds
v_mfma_f32_16x16x32_bf16 v[188:191],v[48:51],a[220:223],v[188:191]
v_mfma_f32_16x16x32_bf16 v[160:163],v[52:55],a[224:227],v[160:163]
v_mfma_f32_16x16x32_bf16 v[164:167],v[52:55],a[228:231],v[164:167]
v_mfma_f32_16x16x32_bf16 v[168:171],v[52:55],a[232:235],v[168:171]
buffer_load_dwordx4 v0,s[8:11],s65 offen offset:2048 sc1 lds
v_mfma_f32_16x16x32_bf16 v[172:175],v[52:55],a[236:239],v[172:175]
v_mfma_f32_16x16x32_bf16 v[176:179],v[52:55],a[240:243],v[176:179]
v_mfma_f32_16x16x32_bf16 v[180:183],v[52:55],a[244:247],v[180:183]
v_mfma_f32_16x16x32_bf16 v[184:187],v[52:55],a[248:251],v[184:187]
buffer_load_dwordx4 v0,s[8:11],s65 offen offset:3072 sc1 lds
v_mfma_f32_16x16x32_bf16 v[188:191],v[52:55],a[252:255],v[188:191]
s_waitcnt lgkmcnt(8)
v_mfma_f32_16x16x32_bf16 v[192:195],v[56:59],a[0:3],0
v_mfma_f32_16x16x32_bf16 v[196:199],v[56:59],a[4:7],0
v_mfma_f32_16x16x32_bf16 v[200:203],v[56:59],a[8:11],0
v_cvt_pk_bf16_f32 v24,v160,v164
v_cvt_pk_bf16_f32 v25,v168,v172
v_mfma_f32_16x16x32_bf16 v[204:207],v[56:59],a[12:15],0
v_cvt_pk_bf16_f32 v26,v176,v180
v_cvt_pk_bf16_f32 v27,v184,v188
v_mfma_f32_16x16x32_bf16 v[208:211],v[56:59],a[16:19],0
s_add_u32 s62,s69,0
buffer_store_dwordx4 v[24:27],v5,s[8:11],s62 offen sc1
v_mfma_f32_16x16x32_bf16 v[212:215],v[56:59],a[20:23],0
v_cvt_pk_bf16_f32 v28,v161,v165
v_cvt_pk_bf16_f32 v29,v169,v173
v_mfma_f32_16x16x32_bf16 v[216:219],v[56:59],a[24:27],0
v_cvt_pk_bf16_f32 v30,v177,v181
v_cvt_pk_bf16_f32 v31,v185,v189
v_mfma_f32_16x16x32_bf16 v[220:223],v[56:59],a[28:31],0
s_add_u32 s62,s69,16384
buffer_store_dwordx4 v[28:31],v5,s[8:11],s62 offen sc1
s_waitcnt lgkmcnt(7)
v_mfma_f32_16x16x32_bf16 v[192:195],v[60:63],a[32:35],v[192:195]
v_cvt_pk_bf16_f32 v32,v162,v166
v_cvt_pk_bf16_f32 v33,v170,v174
v_mfma_f32_16x16x32_bf16 v[196:199],v[60:63],a[36:39],v[196:199]
v_cvt_pk_bf16_f32 v34,v178,v182
v_cvt_pk_bf16_f32 v35,v186,v190
v_mfma_f32_16x16x32_bf16 v[200:203],v[60:63],a[40:43],v[200:203]
s_add_u32 s62,s69,32768
buffer_store_dwordx4 v[32:35],v5,s[8:11],s62 offen sc1
v_mfma_f32_16x16x32_bf16 v[204:207],v[60:63],a[44:47],v[204:207]
v_cvt_pk_bf16_f32 v36,v163,v167
v_cvt_pk_bf16_f32 v37,v171,v175
v_mfma_f32_16x16x32_bf16 v[208:211],v[60:63],a[48:51],v[208:211]
v_cvt_pk_bf16_f32 v38,v179,v183
v_cvt_pk_bf16_f32 v39,v187,v191
v_mfma_f32_16x16x32_bf16 v[212:215],v[60:63],a[52:55],v[212:215]
s_add_u32 s62,s69,49152
buffer_store_dwordx4 v[36:39],v5,s[8:11],s62 offen sc1
v_mfma_f32_16x16x32_bf16 v[216:219],v[60:63],a[56:59],v[216:219]
v_mfma_f32_16x16x32_bf16 v[220:223],v[60:63],a[60:63],v[220:223]
s_waitcnt lgkmcnt(6)
v_mfma_f32_16x16x32_bf16 v[192:195],v[64:67],a[64:67],v[192:195]
v_mfma_f32_16x16x32_bf16 v[196:199],v[64:67],a[68:71],v[196:199]
v_mfma_f32_16x16x32_bf16 v[200:203],v[64:67],a[72:75],v[200:203]
v_mfma_f32_16x16x32_bf16 v[204:207],v[64:67],a[76:79],v[204:207]
v_mfma_f32_16x16x32_bf16 v[208:211],v[64:67],a[80:83],v[208:211]
v_mfma_f32_16x16x32_bf16 v[212:215],v[64:67],a[84:87],v[212:215]
v_mfma_f32_16x16x32_bf16 v[216:219],v[64:67],a[88:91],v[216:219]
v_mfma_f32_16x16x32_bf16 v[220:223],v[64:67],a[92:95],v[220:223]
s_waitcnt lgkmcnt(5)
v_mfma_f32_16x16x32_bf16 v[192:195],v[68:71],a[96:99],v[192:195]
v_mfma_f32_16x16x32_bf16 v[196:199],v[68:71],a[100:103],v[196:199]
v_mfma_f32_16x16x32_bf16 v[200:203],v[68:71],a[104:107],v[200:203]
v_mfma_f32_16x16x32_bf16 v[204:207],v[68:71],a[108:111],v[204:207]
v_mfma_f32_16x16x32_bf16 v[208:211],v[68:71],a[112:115],v[208:211]
v_mfma_f32_16x16x32_bf16 v[212:215],v[68:71],a[116:119],v[212:215]
v_mfma_f32_16x16x32_bf16 v[216:219],v[68:71],a[120:123],v[216:219]
v_mfma_f32_16x16x32_bf16 v[220:223],v[68:71],a[124:127],v[220:223]
s_waitcnt lgkmcnt(4)
v_mfma_f32_16x16x32_bf16 v[192:195],v[72:75],a[128:131],v[192:195]
v_mfma_f32_16x16x32_bf16 v[196:199],v[72:75],a[132:135],v[196:199]
v_mfma_f32_16x16x32_bf16 v[200:203],v[72:75],a[136:139],v[200:203]
v_mfma_f32_16x16x32_bf16 v[204:207],v[72:75],a[140:143],v[204:207]
v_mfma_f32_16x16x32_bf16 v[208:211],v[72:75],a[144:147],v[208:211]
v_mfma_f32_16x16x32_bf16 v[212:215],v[72:75],a[148:151],v[212:215]
v_mfma_f32_16x16x32_bf16 v[216:219],v[72:75],a[152:155],v[216:219]
v_mfma_f32_16x16x32_bf16 v[220:223],v[72:75],a[156:159],v[220:223]
s_waitcnt lgkmcnt(3)
v_mfma_f32_16x16x32_bf16 v[192:195],v[76:79],a[160:163],v[192:195]
v_mfma_f32_16x16x32_bf16 v[196:199],v[76:79],a[164:167],v[196:199]
v_mfma_f32_16x16x32_bf16 v[200:203],v[76:79],a[168:171],v[200:203]
v_mfma_f32_16x16x32_bf16 v[204:207],v[76:79],a[172:175],v[204:207]
v_mfma_f32_16x16x32_bf16 v[208:211],v[76:79],a[176:179],v[208:211]
v_mfma_f32_16x16x32_bf16 v[212:215],v[76:79],a[180:183],v[212:215]
v_mfma_f32_16x16x32_bf16 v[216:219],v[76:79],a[184:187],v[216:219]
v_mfma_f32_16x16x32_bf16 v[220:223],v[76:79],a[188:191],v[220:223]
s_waitcnt lgkmcnt(2)
v_mfma_f32_16x16x32_bf16 v[192:195],v[80:83],a[192:195],v[192:195]
v_mfma_f32_16x16x32_bf16 v[196:199],v[80:83],a[196:199],v[196:199]
v_mfma_f32_16x16x32_bf16 v[200:203],v[80:83],a[200:203],v[200:203]
v_mfma_f32_16x16x32_bf16 v[204:207],v[80:83],a[204:207],v[204:207]
v_mfma_f32_16x16x32_bf16 v[208:211],v[80:83],a[208:211],v[208:211]
v_mfma_f32_16x16x32_bf16 v[212:215],v[80:83],a[212:215],v[212:215]
v_mfma_f32_16x16x32_bf16 v[216:219],v[80:83],a[216:219],v[216:219]
v_mfma_f32_16x16x32_bf16 v[220:223],v[80:83],a[220:223],v[220:223]
s_waitcnt lgkmcnt(1)
v_mfma_f32_16x16x32_bf16 v[192:195],v[84:87],a[224:227],v[192:195]
v_mfma_f32_16x16x32_bf16 v[196:199],v[84:87],a[228:231],v[196:199]
v_mfma_f32_16x16x32_bf16 v[200:203],v[84:87],a[232:235],v[200:203]
v_mfma_f32_16x16x32_bf16 v[204:207],v[84:87],a[236:239],v[204:207]
v_mfma_f32_16x16x32_bf16 v[208:211],v[84:87],a[240:243],v[208:211]
v_mfma_f32_16x16x32_bf16 v[212:215],v[84:87],a[244:247],v[212:215]
v_mfma_f32_16x16x32_bf16 v[216:219],v[84:87],a[248:251],v[216:219]
v_mfma_f32_16x16x32_bf16 v[220:223],v[84:87],a[252:255],v[220:223]
v_cvt_pk_bf16_f32 v40,v192,v196
v_cvt_pk_bf16_f32 v41,v200,v204
v_cvt_pk_bf16_f32 v42,v208,v212
s_nop 4
v_cvt_pk_bf16_f32 v43,v216,v220
s_add_u32 s62,s69,262144
buffer_store_dwordx4 v[40:43],v5,s[8:11],s62 offen sc1
v_cvt_pk_bf16_f32 v44,v193,v197
v_cvt_pk_bf16_f32 v45,v201,v205
v_cvt_pk_bf16_f32 v46,v209,v213
v_cvt_pk_bf16_f32 v47,v217,v221
s_add_u32 s62,s69,278528
buffer_store_dwordx4 v[44:47],v5,s[8:11],s62 offen sc1
v_cvt_pk_bf16_f32 v48,v194,v198
v_cvt_pk_bf16_f32 v49,v202,v206
v_cvt_pk_bf16_f32 v50,v210,v214
v_cvt_pk_bf16_f32 v51,v218,v222
s_add_u32 s62,s69,294912
buffer_store_dwordx4 v[48:51],v5,s[8:11],s62 offen sc1
v_cvt_pk_bf16_f32 v52,v195,v199
v_cvt_pk_bf16_f32 v53,v203,v207
v_cvt_pk_bf16_f32 v54,v211,v215
v_cvt_pk_bf16_f32 v55,v219,v223
s_add_u32 s62,s69,311296
buffer_store_dwordx4 v[52:55],v5,s[8:11],s62 offen sc1
s_cmp_lg_u32 s72,0
s_cbranch_scc1 L_aa_245
s_waitcnt vmcnt(8)
L_aa_255:
s_barrier
s_xor_b32 s67,s67,65536
s_and_b32 s56,s50,2048
s_lshl_b32 s56,s56,4
s_add_u32 s56,s56,s67
v_add_u32 v2,s56,v0
s_and_b32 s56,s50,1024
s_lshl_b32 s56,s56,2
v_add_u32 v238,s56,v2
s_mov_b32 s76,s71
s_mov_b32 s53,s77
ds_read_b128 v[24:27],v238 offset:16384
ds_read_b128 v[40:43],v2 offset:0
ds_read_b128 v[56:59],v2 offset:4096
ds_read_b128 v[28:31],v238 offset:17408
ds_read_b128 v[44:47],v2 offset:1024
ds_read_b128 v[60:63],v2 offset:5120
ds_read_b128 v[32:35],v238 offset:18432
ds_read_b128 v[48:51],v2 offset:2048
ds_read_b128 v[64:67],v2 offset:6144
ds_read_b128 v[36:39],v238 offset:19456
ds_read_b128 v[52:55],v2 offset:3072
ds_read_b128 v[68:71],v2 offset:7168
s_waitcnt lgkmcnt(9)
v_mfma_f32_16x16x32_bf16 v[128:131],v[40:43],v[24:27],v[8:11]
ds_read_b128 v[72:75],v2 offset:24576
v_mfma_f32_16x16x32_bf16 v[132:135],v[56:59],v[24:27],v[12:15]
ds_read_b128 v[76:79],v2 offset:25600
s_waitcnt lgkmcnt(8)
v_mfma_f32_16x16x32_bf16 v[128:131],v[44:47],v[28:31],v[128:131]
ds_read_b128 v[80:83],v2 offset:26624
v_mfma_f32_16x16x32_bf16 v[132:135],v[60:63],v[28:31],v[132:135]
ds_read_b128 v[84:87],v2 offset:27648
s_waitcnt lgkmcnt(7)
v_mfma_f32_16x16x32_bf16 v[128:131],v[48:51],v[32:35],v[128:131]
ds_read_b64 v[120:121],v2 offset:28672
v_mfma_f32_16x16x32_bf16 v[132:135],v[64:67],v[32:35],v[132:135]
ds_read_b64 v[122:123],v2 offset:29696
s_waitcnt lgkmcnt(6)
v_mfma_f32_16x16x32_bf16 v[128:131],v[52:55],v[36:39],v[128:131]
ds_read_b64 v[124:125],v2 offset:30720
v_mfma_f32_16x16x32_bf16 v[132:135],v[68:71],v[36:39],v[132:135]
ds_read_b64 v[126:127],v2 offset:31744
s_waitcnt lgkmcnt(4)
v_mfma_f32_16x16x32_bf16 v[136:139],v[72:75],v[24:27],0
ds_read_b128 v[88:91],v2 offset:8192
ds_read_b128 v[92:95],v2 offset:9216
v_mfma_f32_16x16x32_bf16 v[136:139],v[76:79],v[28:31],v[136:139]
ds_read_b128 v[96:99],v2 offset:10240
ds_read_b128 v[100:103],v2 offset:11264
v_mfma_f32_16x16x32_bf16 v[136:139],v[80:83],v[32:35],v[136:139]
ds_read_b128 v[104:107],v2 offset:12288
ds_read_b128 v[108:111],v2 offset:13312
v_mfma_f32_16x16x32_bf16 v[136:139],v[84:87],v[36:39],v[136:139]
ds_read_b128 v[112:115],v2 offset:14336
ds_read_b128 v[116:119],v2 offset:15360
s_cmp_eq_u32 s30,0
s_cbranch_scc1 L_aa_244
s_add_u32 s66,s66,1
v_mov_b32 v22,s66
s_xor_b32 s69,s69,524288
s_waitcnt vmcnt(0) lgkmcnt(0)
s_barrier
buffer_store_dword v22,off,s[8:11],s74 sc1
buffer_store_dword v20,off,s[8:11],s73 sc1
s_mov_b32 s73,0x80000000
s_cmp_lg_u32 s86,1536
s_cbranch_scc1 L_ae_257
s_add_u32 s77,s53,13
s_mov_b32 s30,0
s_lshl_b32 s56,s77,5
s_add_u32 s56,s56,s68
s_mul_i32 s70,s56,24576
s_lshl_b32 s71,s56,13
s_lshl_b32 s59,s77,13
s_lshl2_add_u32 s59,s68,s59
s_add_u32 s59,s59,10485760
s_buffer_load_dword s32,s[8:11],s59 glc
s_mov_b32 s33,1
s_add_u32 s70,s70,100663296
s_add_u32 s71,s71,41943040
v_mov_b32 v19,s59
s_branch L_af_258
L_ae_257:
s_ff1_i32_b64 s77,s[84:85]
s_bitset0_b64 s[84:85],s77
s_ff1_i32_b64 s77,s[84:85]
s_bitset0_b64 s[84:85],s77
s_ff1_i32_b64 s77,s[84:85]
s_bitset0_b64 s[84:85],s77
s_ff1_i32_b64 s77,s[84:85]
s_bitset0_b64 s[84:85],s77
s_ff1_i32_b64 s77,s[84:85]
s_bitset0_b64 s[84:85],s77
s_ff1_i32_b64 s77,s[84:85]
s_bitset0_b64 s[84:85],s77
s_min_u32 s77,s77,64
s_lshr_b32 s61,s55,5
s_lshl_b32 s56,s77,5
s_add_u32 s56,s56,s68
s_mul_i32 s70,s56,24576
s_lshl_b32 s71,s56,13
s_lshl_b32 s59,s77,13
s_lshl2_add_u32 s59,s68,s59
s_add_u32 s59,s59,10486144
s_cmp_lt_u32 s77,s61
s_cselect_b32 s57,0,16777216
s_cselect_b32 s60,0,128
s_add_u32 s60,s60,s59
s_add_u32 s60,s60,128
s_buffer_load_dword s33,s[8:11],s60 glc
s_add_u32 s71,s71,s57
s_add_u32 s71,s71,58720256
s_cmp_eq_u32 s77,s61
s_cselect_b32 s57,50331648,0
s_cselect_b32 s58,1536,0
s_add_u32 s59,s59,s58
s_buffer_load_dword s32,s[8:11],s59 glc
s_add_u32 s70,s70,s57
s_add_u32 s70,s70,150994944
v_mov_b32 v19,s59
v_writelane_b32 v19,s60,1
L_af_258:
v_max3_f32 v238,v128,v129,v130
v_max3_f32 v239,v131,v132,v133
v_max3_f32 v238,v134,v135,v238
v_max3_f32 v239,v138,v139,v239
v_max_f32 v238,v238,v239
v_max_f32 v239,v238,v239
s_nop 1
v_permlane16_swap_b32 v238,v239
v_max_f32 v238,v238,v239
v_max_f32 v239,v238,v239
s_nop 1
v_permlane32_swap_b32 v238,v239
v_max_f32 v238,v238,v239
v_mul_f32 v238,s80,v238
v_fma_f32 v128,v128,s80,-v238
v_fma_f32 v129,v129,s80,-v238
v_exp_f32 v128,v128
v_fma_f32 v130,v130,s80,-v238
v_exp_f32 v129,v129
v_fma_f32 v131,v131,s80,-v238
v_exp_f32 v130,v130
v_fma_f32 v132,v132,s80,-v238
v_exp_f32 v131,v131
v_fma_f32 v133,v133,s80,-v238
v_exp_f32 v132,v132
v_fma_f32 v134,v134,s80,-v238
v_exp_f32 v133,v133
v_fma_f32 v135,v135,s80,-v238
v_exp_f32 v134,v134
v_fma_f32 v138,v138,s80,-v238
v_exp_f32 v135,v135
v_fma_f32 v139,v139,s80,-v238
v_exp_f32 v138,v138
v_exp_f32 v139,v139
v_cvt_pk_bf16_f32 v140,v128,v129
v_cvt_pk_bf16_f32 v141,v130,v131
v_cvt_pk_bf16_f32 v142,v132,v133
v_cvt_pk_bf16_f32 v143,v134,v135
v_cvt_pk_bf16_f32 v144,v138,v139
v_mov_b32 v147,v144
v_mfma_f32_16x16x32_bf16 v[148:151],v[152:155],v[140:143],0
v_mfma_f32_16x16x32_bf16 v[24:27],v[88:91],v[140:143],0
v_mfma_f32_16x16x32_bf16 v[28:31],v[92:95],v[140:143],0
v_mfma_f32_16x16x16_bf16 v[148:151],v[152:153],v[144:145],v[148:151]
v_mfma_f32_16x16x32_bf16 v[32:35],v[96:99],v[140:143],0
v_mfma_f32_16x16x32_bf16 v[36:39],v[100:103],v[140:143],0
v_mfma_f32_16x16x32_bf16 v[40:43],v[104:107],v[140:143],0
v_mfma_f32_16x16x32_bf16 v[44:47],v[108:111],v[140:143],0
v_mfma_f32_16x16x32_bf16 v[48:51],v[112:115],v[140:143],0
v_mfma_f32_16x16x32_bf16 v[52:55],v[116:119],v[140:143],0
v_rcp_f32 v148,v148
v_mfma_f32_16x16x16_bf16 v[24:27],v[120:121],v[144:145],v[24:27]
v_mfma_f32_16x16x16_bf16 v[28:31],v[120:121],v[146:147],v[28:31]
v_mfma_f32_16x16x16_bf16 v[32:35],v[122:123],v[144:145],v[32:35]
v_mfma_f32_16x16x16_bf16 v[36:39],v[122:123],v[146:147],v[36:39]
v_mfma_f32_16x16x16_bf16 v[40:43],v[124:125],v[144:145],v[40:43]
v_pk_mul_f32 v[24:25],v[24:25],v[148:149] op_sel_hi:[1,0]
v_pk_mul_f32 v[26:27],v[26:27],v[148:149] op_sel_hi:[1,0]
v_mfma_f32_16x16x16_bf16 v[44:47],v[124:125],v[146:147],v[44:47]
v_pk_mul_f32 v[28:29],v[28:29],v[148:149] op_sel_hi:[1,0]
v_pk_mul_f32 v[30:31],v[30:31],v[148:149] op_sel_hi:[1,0]
v_mfma_f32_16x16x16_bf16 v[48:51],v[126:127],v[144:145],v[48:51]
v_cvt_pk_bf16_f32 v72,v24,v28
v_cvt_pk_bf16_f32 v73,v25,v29
v_mfma_f32_16x16x16_bf16 v[52:55],v[126:127],v[146:147],v[52:55]
v_cvt_pk_bf16_f32 v74,v26,v30
v_cvt_pk_bf16_f32 v75,v27,v31
ds_write_b128 v3,v[72:75] offset:0
v_pk_mul_f32 v[32:33],v[32:33],v[148:149] op_sel_hi:[1,0]
v_pk_mul_f32 v[34:35],v[34:35],v[148:149] op_sel_hi:[1,0]
v_pk_mul_f32 v[36:37],v[36:37],v[148:149] op_sel_hi:[1,0]
v_pk_mul_f32 v[38:39],v[38:39],v[148:149] op_sel_hi:[1,0]
v_cvt_pk_bf16_f32 v76,v32,v36
v_cvt_pk_bf16_f32 v77,v33,v37
v_cvt_pk_bf16_f32 v78,v34,v38
v_cvt_pk_bf16_f32 v79,v35,v39
ds_write_b128 v3,v[76:79] offset:1024
v_pk_mul_f32 v[40:41],v[40:41],v[148:149] op_sel_hi:[1,0]
v_pk_mul_f32 v[42:43],v[42:43],v[148:149] op_sel_hi:[1,0]
v_pk_mul_f32 v[44:45],v[44:45],v[148:149] op_sel_hi:[1,0]
v_pk_mul_f32 v[46:47],v[46:47],v[148:149] op_sel_hi:[1,0]
v_cvt_pk_bf16_f32 v80,v40,v44
v_cvt_pk_bf16_f32 v81,v41,v45
v_cvt_pk_bf16_f32 v82,v42,v46
v_cvt_pk_bf16_f32 v83,v43,v47
ds_write_b128 v3,v[80:83] offset:2048
v_pk_mul_f32 v[48:49],v[48:49],v[148:149] op_sel_hi:[1,0]
v_pk_mul_f32 v[50:51],v[50:51],v[148:149] op_sel_hi:[1,0]
v_pk_mul_f32 v[52:53],v[52:53],v[148:149] op_sel_hi:[1,0]
v_pk_mul_f32 v[54:55],v[54:55],v[148:149] op_sel_hi:[1,0]
v_cvt_pk_bf16_f32 v84,v48,v52
v_cvt_pk_bf16_f32 v85,v49,v53
v_cvt_pk_bf16_f32 v86,v50,v54
v_cvt_pk_bf16_f32 v87,v51,v55
ds_write_b128 v3,v[84:87] offset:3072
s_waitcnt lgkmcnt(0)
s_barrier
L_aq_259:
buffer_load_dword v17,v16,s[8:11],s87 offen sc1
s_sub_u32 s49,s49,1
s_cbranch_scc1 L_abort2
s_waitcnt vmcnt(0)
v_cmp_gt_u32 vcc,s66,v17
s_cbranch_vccnz L_aq_259
s_xor_b32 s34,s69,524288
buffer_load_dwordx4 v[160:163],v7,s[8:11],s34 offen sc1
s_add_u32 s34,s34,4096
buffer_load_dwordx4 v[164:167],v7,s[8:11],s34 offen sc1
s_add_u32 s34,s34,4096
buffer_load_dwordx4 v[168:171],v7,s[8:11],s34 offen sc1
s_add_u32 s34,s34,4096
buffer_load_dwordx4 v[172:175],v7,s[8:11],s34 offen sc1
s_add_u32 s34,s34,4096
buffer_load_dwordx4 v[176:179],v7,s[8:11],s34 offen sc1
s_add_u32 s34,s34,4096
buffer_load_dwordx4 v[180:183],v7,s[8:11],s34 offen sc1
s_add_u32 s34,s34,4096
buffer_load_dwordx4 v[184:187],v7,s[8:11],s34 offen sc1
s_add_u32 s34,s34,4096
buffer_load_dwordx4 v[188:191],v7,s[8:11],s34 offen sc1
s_waitcnt vmcnt(7)
v_mfma_f32_16x16x32_bf16 v[192:195],v[156:159],v[160:163],0
s_waitcnt vmcnt(6)
v_mfma_f32_16x16x32_bf16 v[192:195],v[156:159],v[164:167],v[192:195]
s_waitcnt vmcnt(5)
v_mfma_f32_16x16x32_bf16 v[192:195],v[156:159],v[168:171],v[192:195]
s_waitcnt vmcnt(4)
v_mfma_f32_16x16x32_bf16 v[192:195],v[156:159],v[172:175],v[192:195]
s_waitcnt vmcnt(3)
v_mfma_f32_16x16x32_bf16 v[196:199],v[156:159],v[176:179],0
s_waitcnt vmcnt(2)
v_mfma_f32_16x16x32_bf16 v[196:199],v[156:159],v[180:183],v[196:199]
s_waitcnt vmcnt(1)
v_mfma_f32_16x16x32_bf16 v[196:199],v[156:159],v[184:187],v[196:199]
ds_write_b128 v6,v[192:195]
s_waitcnt vmcnt(0)
v_mfma_f32_16x16x32_bf16 v[196:199],v[156:159],v[188:191],v[196:199]
s_nop 7
ds_write_b128 v6,v[196:199] offset:2048
s_waitcnt lgkmcnt(0)
s_barrier
s_mov_b32 s27,1
s_branch L_aa_247
L_aa_244:
s_add_u32 s66,s66,1
v_mov_b32 v22,s66
s_xor_b32 s69,s69,524288
s_waitcnt vmcnt(0) lgkmcnt(0)
s_barrier
buffer_store_dword v22,off,s[8:11],s74 sc1
buffer_store_dword v20,off,s[8:11],s73 sc1
s_mov_b32 s73,0x80000000
L_aa_246:
L_aq_260:
buffer_load_dword v17,v16,s[8:11],s87 offen sc1
s_sub_u32 s49,s49,1
s_cbranch_scc1 L_abort2
s_waitcnt vmcnt(0)
v_cmp_gt_u32 vcc,s66,v17
s_cbranch_vccnz L_aq_260
s_xor_b32 s34,s69,524288
buffer_load_dwordx4 v[160:163],v7,s[8:11],s34 offen sc1
s_add_u32 s34,s34,4096
buffer_load_dwordx4 v[164:167],v7,s[8:11],s34 offen sc1
s_add_u32 s34,s34,4096
buffer_load_dwordx4 v[168:171],v7,s[8:11],s34 offen sc1
s_add_u32 s34,s34,4096
buffer_load_dwordx4 v[172:175],v7,s[8:11],s34 offen sc1
s_add_u32 s34,s34,4096
buffer_load_dwordx4 v[176:179],v7,s[8:11],s34 offen sc1
s_add_u32 s34,s34,4096
buffer_load_dwordx4 v[180:183],v7,s[8:11],s34 offen sc1
s_add_u32 s34,s34,4096
buffer_load_dwordx4 v[184:187],v7,s[8:11],s34 offen sc1
s_add_u32 s34,s34,4096
buffer_load_dwordx4 v[188:191],v7,s[8:11],s34 offen sc1
s_add_u32 s62,s76,4096
buffer_load_dwordx4 v[72:75],v0,s[8:11],s76 offen offset:0 sc1
buffer_load_dwordx4 v[76:79],v0,s[8:11],s76 offen offset:1024 sc1
buffer_load_dwordx4 v[80:83],v0,s[8:11],s76 offen offset:2048 sc1
buffer_load_dwordx4 v[84:87],v0,s[8:11],s76 offen offset:3072 sc1
buffer_load_dwordx2 v[120:121],v0,s[8:11],s62 offen offset:0 sc1
buffer_load_dwordx2 v[122:123],v0,s[8:11],s62 offen offset:1024 sc1
buffer_load_dwordx2 v[124:125],v0,s[8:11],s62 offen offset:2048 sc1
buffer_load_dwordx2 v[126:127],v0,s[8:11],s62 offen offset:3072 sc1
s_waitcnt vmcnt(15)
v_mfma_f32_16x16x32_bf16 v[192:195],v[156:159],v[160:163],0
s_waitcnt vmcnt(14)
v_mfma_f32_16x16x32_bf16 v[192:195],v[156:159],v[164:167],v[192:195]
s_waitcnt vmcnt(13)
v_mfma_f32_16x16x32_bf16 v[192:195],v[156:159],v[168:171],v[192:195]
s_waitcnt vmcnt(12)
v_mfma_f32_16x16x32_bf16 v[192:195],v[156:159],v[172:175],v[192:195]
s_waitcnt vmcnt(11)
v_mfma_f32_16x16x32_bf16 v[196:199],v[156:159],v[176:179],0
s_waitcnt vmcnt(10)
v_mfma_f32_16x16x32_bf16 v[196:199],v[156:159],v[180:183],v[196:199]
s_waitcnt vmcnt(9)
v_mfma_f32_16x16x32_bf16 v[196:199],v[156:159],v[184:187],v[196:199]
ds_write_b128 v6,v[192:195]
s_waitcnt vmcnt(8)
v_mfma_f32_16x16x32_bf16 v[196:199],v[156:159],v[188:191],v[196:199]
s_nop 7
ds_write_b128 v6,v[196:199] offset:2048
s_waitcnt lgkmcnt(0)
s_barrier
s_mov_b32 s27,0
s_branch L_aa_247
L_aa_245:
s_add_u32 s66,s66,1
v_mov_b32 v22,s66
s_xor_b32 s69,s69,524288
s_waitcnt vmcnt(0) lgkmcnt(0)
s_barrier
buffer_store_dword v22,off,s[8:11],s74 sc1
buffer_store_dword v20,off,s[8:11],s73 sc1
s_mov_b32 s73,0x80000000
L_aq_261:
buffer_load_dword v17,v16,s[8:11],s87 offen sc1
s_sub_u32 s49,s49,1
s_cbranch_scc1 L_abort2
s_waitcnt vmcnt(0)
v_cmp_gt_u32 vcc,s66,v17
s_cbranch_vccnz L_aq_261
s_xor_b32 s34,s69,524288
buffer_load_dwordx4 v[160:163],v7,s[8:11],s34 offen sc1
s_add_u32 s34,s34,4096
buffer_load_dwordx4 v[164:167],v7,s[8:11],s34 offen sc1
s_add_u32 s34,s34,4096
buffer_load_dwordx4 v[168:171],v7,s[8:11],s34 offen sc1
s_add_u32 s34,s34,4096
buffer_load_dwordx4 v[172:175],v7,s[8:11],s34 offen sc1
s_add_u32 s34,s34,4096
buffer_load_dwordx4 v[176:179],v7,s[8:11],s34 offen sc1
s_add_u32 s34,s34,4096
buffer_load_dwordx4 v[180:183],v7,s[8:11],s34 offen sc1
s_add_u32 s34,s34,4096
buffer_load_dwordx4 v[184:187],v7,s[8:11],s34 offen sc1
s_add_u32 s34,s34,4096
buffer_load_dwordx4 v[188:191],v7,s[8:11],s34 offen sc1
s_waitcnt vmcnt(7)
v_mfma_f32_16x16x32_bf16 v[192:195],v[156:159],v[160:163],0
s_waitcnt vmcnt(6)
v_mfma_f32_16x16x32_bf16 v[192:195],v[156:159],v[164:167],v[192:195]
s_waitcnt vmcnt(5)
v_mfma_f32_16x16x32_bf16 v[192:195],v[156:159],v[168:171],v[192:195]
s_waitcnt vmcnt(4)
v_mfma_f32_16x16x32_bf16 v[192:195],v[156:159],v[172:175],v[192:195]
s_waitcnt vmcnt(3)
v_mfma_f32_16x16x32_bf16 v[196:199],v[156:159],v[176:179],0
s_waitcnt vmcnt(2)
v_mfma_f32_16x16x32_bf16 v[196:199],v[156:159],v[180:183],v[196:199]
s_waitcnt vmcnt(1)
v_mfma_f32_16x16x32_bf16 v[196:199],v[156:159],v[184:187],v[196:199]
ds_write_b128 v6,v[192:195]
s_waitcnt vmcnt(0)
v_mfma_f32_16x16x32_bf16 v[196:199],v[156:159],v[188:191],v[196:199]
s_nop 7
ds_write_b128 v6,v[196:199] offset:2048
s_waitcnt lgkmcnt(0)
s_barrier
s_mov_b32 s27,2
L_aa_247:
s_cmp_lg_u32 s31,0
s_cbranch_scc1 L_ar_264
s_bitcmp1_b32 s46,0
s_cbranch_scc1 L_ar_263
L_ar_262:
ds_read_b128 v[160:163],v23
ds_read_b128 v[164:167],v23 offset:16
v_lshlrev_b32 v200,16,v224
v_and_b32 v201,0xffff0000,v224
v_lshlrev_b32 v202,16,v225
v_and_b32 v203,0xffff0000,v225
v_lshlrev_b32 v204,16,v226
v_and_b32 v205,0xffff0000,v226
v_lshlrev_b32 v206,16,v227
v_and_b32 v207,0xffff0000,v227
s_lshl_b32 s18,s51,5
s_add_u32 s18,s18,s68
s_lshl_b32 s19,s18,10
s_add_u32 s20,s19,8388608
s_waitcnt lgkmcnt(0)
v_cvt_pk_bf16_f32 v168,v160,v161
v_cvt_pk_bf16_f32 v169,v162,v163
v_cvt_pk_bf16_f32 v170,v164,v165
v_cvt_pk_bf16_f32 v171,v166,v167
v_lshlrev_b32 v160,16,v168
v_and_b32 v161,0xffff0000,v168
v_lshlrev_b32 v162,16,v169
v_and_b32 v163,0xffff0000,v169
v_lshlrev_b32 v164,16,v170
v_and_b32 v165,0xffff0000,v170
v_lshlrev_b32 v166,16,v171
v_and_b32 v167,0xffff0000,v171
v_pk_add_f32 v[200:201],v[200:201],v[160:161]
v_pk_add_f32 v[202:203],v[202:203],v[162:163]
v_pk_add_f32 v[204:205],v[204:205],v[164:165]
v_pk_add_f32 v[206:207],v[206:207],v[166:167]
v_cvt_pk_bf16_f32 v168,v200,v201
v_cvt_pk_bf16_f32 v169,v202,v203
v_cvt_pk_bf16_f32 v170,v204,v205
v_cvt_pk_bf16_f32 v171,v206,v207
v_lshlrev_b32 v200,16,v168
v_and_b32 v201,0xffff0000,v168
v_lshlrev_b32 v202,16,v169
v_and_b32 v203,0xffff0000,v169
v_lshlrev_b32 v204,16,v170
v_and_b32 v205,0xffff0000,v170
v_lshlrev_b32 v206,16,v171
v_and_b32 v207,0xffff0000,v171
v_readfirstlane_b32 s78,v200
s_nop 1
v_pk_add_f32 v[184:185],v[200:201],s[78:79] op_sel_hi:[1,0] neg_lo:[0,1] neg_hi:[0,1]
v_pk_add_f32 v[186:187],v[202:203],s[78:79] op_sel_hi:[1,0] neg_lo:[0,1] neg_hi:[0,1]
v_pk_add_f32 v[188:189],v[204:205],s[78:79] op_sel_hi:[1,0] neg_lo:[0,1] neg_hi:[0,1]
v_pk_add_f32 v[190:191],v[206:207],s[78:79] op_sel_hi:[1,0] neg_lo:[0,1] neg_hi:[0,1]
v_pk_add_f32 v[192:193],v[184:185],v[186:187]
v_pk_mul_f32 v[194:195],v[184:185],v[184:185]
v_pk_add_f32 v[196:197],v[188:189],v[190:191]
v_pk_fma_f32 v[194:195],v[186:187],v[186:187],v[194:195]
v_pk_add_f32 v[192:193],v[192:193],v[196:197]
v_pk_fma_f32 v[194:195],v[188:189],v[188:189],v[194:195]
v_add_f32 v192,v192,v193
v_pk_fma_f32 v[194:195],v[190:191],v[190:191],v[194:195]
v_add_f32 v194,v194,v195
s_nop 1
v_permlane32_swap_b32 v192,v194
v_add_f32 v192,v192,v194
s_nop 1
v_add_f32_dpp v192,v192,v192 row_ror:8 row_mask:0xf bank_mask:0xf
s_nop 1
v_add_f32_dpp v192,v192,v192 row_ror:4 row_mask:0xf bank_mask:0xf
s_nop 1
v_add_f32_dpp v192,v192,v192 row_ror:2 row_mask:0xf bank_mask:0xf
s_nop 1
v_add_f32_dpp v192,v192,v192 row_ror:1 row_mask:0xf bank_mask:0xf
v_mov_b32 v194,v192
s_nop 1
v_permlane16_swap_b32 v192,v194
v_add_f32 v192,v192,v194
v_mul_f32 v192,0x3b000000,v192
v_mov_b32 v194,v192
s_nop 1
v_permlane32_swap_b32 v192,v194
v_fma_f32 v194,-v192,v192,v194
v_add_f32 v192,s78,v192
v_max_f32 v194,0,v194
v_cvt_pk_bf16_f32 v194,v192,v194
v_lshlrev_b32 v192,16,v194
v_and_b32 v194,0xffff0000,v194
v_add_f32 v194,0x3727c5ac,v194
v_cvt_pk_bf16_f32 v194,v194,v194
v_and_b32 v194,0xffff0000,v194
v_sqrt_f32 v194,v194
v_pk_add_f32 v[184:185],v[200:201],v[192:193] op_sel_hi:[1,0] neg_lo:[0,1] neg_hi:[0,1]
v_pk_add_f32 v[186:187],v[202:203],v[192:193] op_sel_hi:[1,0] neg_lo:[0,1] neg_hi:[0,1]
v_pk_add_f32 v[188:189],v[204:205],v[192:193] op_sel_hi:[1,0] neg_lo:[0,1] neg_hi:[0,1]
v_pk_add_f32 v[190:191],v[206:207],v[192:193] op_sel_hi:[1,0] neg_lo:[0,1] neg_hi:[0,1]
v_cvt_pk_bf16_f32 v194,v194,v194
v_and_b32 v194,0xffff0000,v194
v_rcp_f32 v194,v194
v_cvt_pk_bf16_f32 v172,v184,v185
v_cvt_pk_bf16_f32 v173,v186,v187
v_cvt_pk_bf16_f32 v174,v188,v189
v_cvt_pk_bf16_f32 v175,v190,v191
v_lshlrev_b32 v184,16,v172
v_and_b32 v185,0xffff0000,v172
v_lshlrev_b32 v186,16,v173
v_and_b32 v187,0xffff0000,v173
v_lshlrev_b32 v188,16,v174
v_and_b32 v189,0xffff0000,v174
v_lshlrev_b32 v190,16,v175
v_and_b32 v191,0xffff0000,v175
v_pk_mul_f32 v[184:185],v[184:185],v[194:195] op_sel_hi:[1,0]
v_pk_mul_f32 v[186:187],v[186:187],v[194:195] op_sel_hi:[1,0]
v_pk_mul_f32 v[188:189],v[188:189],v[194:195] op_sel_hi:[1,0]
v_pk_mul_f32 v[190:191],v[190:191],v[194:195] op_sel_hi:[1,0]
v_cvt_pk_bf16_f32 v172,v184,v185
v_cvt_pk_bf16_f32 v173,v186,v187
v_cvt_pk_bf16_f32 v174,v188,v189
v_cvt_pk_bf16_f32 v175,v190,v191
v_lshlrev_b32 v176,16,v172
v_and_b32 v177,0xffff0000,v172
v_lshlrev_b32 v178,16,v173
v_and_b32 v179,0xffff0000,v173
v_lshlrev_b32 v180,16,v174
v_and_b32 v181,0xffff0000,v174
v_lshlrev_b32 v182,16,v175
v_and_b32 v183,0xffff0000,v175
v_pk_add_f32 v[200:201],v[200:201],v[176:177]
v_pk_add_f32 v[202:203],v[202:203],v[178:179]
v_pk_add_f32 v[204:205],v[204:205],v[180:181]
v_pk_add_f32 v[206:207],v[206:207],v[182:183]
v_cvt_pk_bf16_f32 v160,v200,v201
v_cvt_pk_bf16_f32 v161,v202,v203
v_cvt_pk_bf16_f32 v162,v204,v205
v_cvt_pk_bf16_f32 v163,v206,v207
buffer_store_dwordx4 v[160:163],v0,s[8:11],s20 offen sc1
v_lshlrev_b32 v200,16,v160
v_and_b32 v201,0xffff0000,v160
v_lshlrev_b32 v202,16,v161
v_and_b32 v203,0xffff0000,v161
v_lshlrev_b32 v204,16,v162
v_and_b32 v205,0xffff0000,v162
v_lshlrev_b32 v206,16,v163
v_and_b32 v207,0xffff0000,v163
v_readfirstlane_b32 s78,v200
s_nop 1
v_pk_add_f32 v[184:185],v[200:201],s[78:79] op_sel_hi:[1,0] neg_lo:[0,1] neg_hi:[0,1]
v_pk_add_f32 v[186:187],v[202:203],s[78:79] op_sel_hi:[1,0] neg_lo:[0,1] neg_hi:[0,1]
v_pk_add_f32 v[188:189],v[204:205],s[78:79] op_sel_hi:[1,0] neg_lo:[0,1] neg_hi:[0,1]
v_pk_add_f32 v[190:191],v[206:207],s[78:79] op_sel_hi:[1,0] neg_lo:[0,1] neg_hi:[0,1]
v_pk_add_f32 v[192:193],v[184:185],v[186:187]
v_pk_mul_f32 v[194:195],v[184:185],v[184:185]
v_pk_add_f32 v[196:197],v[188:189],v[190:191]
v_pk_fma_f32 v[194:195],v[186:187],v[186:187],v[194:195]
v_pk_add_f32 v[192:193],v[192:193],v[196:197]
v_pk_fma_f32 v[194:195],v[188:189],v[188:189],v[194:195]
v_add_f32 v192,v192,v193
v_pk_fma_f32 v[194:195],v[190:191],v[190:191],v[194:195]
v_add_f32 v194,v194,v195
s_nop 1
v_permlane32_swap_b32 v192,v194
v_add_f32 v192,v192,v194
s_nop 1
v_add_f32_dpp v192,v192,v192 row_ror:8 row_mask:0xf bank_mask:0xf
s_nop 1
v_add_f32_dpp v192,v192,v192 row_ror:4 row_mask:0xf bank_mask:0xf
s_nop 1
v_add_f32_dpp v192,v192,v192 row_ror:2 row_mask:0xf bank_mask:0xf
s_nop 1
v_add_f32_dpp v192,v192,v192 row_ror:1 row_mask:0xf bank_mask:0xf
v_mov_b32 v194,v192
s_nop 1
v_permlane16_swap_b32 v192,v194
v_add_f32 v192,v192,v194
v_mul_f32 v192,0x3b000000,v192
v_mov_b32 v194,v192
s_nop 1
v_permlane32_swap_b32 v192,v194
v_fma_f32 v194,-v192,v192,v194
v_add_f32 v192,s78,v192
v_max_f32 v194,0,v194
v_cvt_pk_bf16_f32 v194,v192,v194
v_lshlrev_b32 v192,16,v194
v_and_b32 v194,0xffff0000,v194
v_add_f32 v194,0x3727c5ac,v194
v_cvt_pk_bf16_f32 v194,v194,v194
v_and_b32 v194,0xffff0000,v194
v_sqrt_f32 v194,v194
v_pk_add_f32 v[184:185],v[200:201],v[192:193] op_sel_hi:[1,0] neg_lo:[0,1] neg_hi:[0,1]
v_pk_add_f32 v[186:187],v[202:203],v[192:193] op_sel_hi:[1,0] neg_lo:[0,1] neg_hi:[0,1]
v_pk_add_f32 v[188:189],v[204:205],v[192:193] op_sel_hi:[1,0] neg_lo:[0,1] neg_hi:[0,1]
v_pk_add_f32 v[190:191],v[206:207],v[192:193] op_sel_hi:[1,0] neg_lo:[0,1] neg_hi:[0,1]
v_cvt_pk_bf16_f32 v194,v194,v194
v_and_b32 v194,0xffff0000,v194
v_rcp_f32 v194,v194
v_cvt_pk_bf16_f32 v164,v184,v185
v_cvt_pk_bf16_f32 v165,v186,v187
v_cvt_pk_bf16_f32 v166,v188,v189
v_cvt_pk_bf16_f32 v167,v190,v191
v_lshlrev_b32 v184,16,v164
v_and_b32 v185,0xffff0000,v164
v_lshlrev_b32 v186,16,v165
v_and_b32 v187,0xffff0000,v165
v_lshlrev_b32 v188,16,v166
v_and_b32 v189,0xffff0000,v166
v_lshlrev_b32 v190,16,v167
v_and_b32 v191,0xffff0000,v167
v_pk_mul_f32 v[184:185],v[184:185],v[194:195] op_sel_hi:[1,0]
v_pk_mul_f32 v[186:187],v[186:187],v[194:195] op_sel_hi:[1,0]
v_pk_mul_f32 v[188:189],v[188:189],v[194:195] op_sel_hi:[1,0]
v_pk_mul_f32 v[190:191],v[190:191],v[194:195] op_sel_hi:[1,0]
v_cvt_pk_bf16_f32 v164,v184,v185
v_cvt_pk_bf16_f32 v165,v186,v187
v_cvt_pk_bf16_f32 v166,v188,v189
v_cvt_pk_bf16_f32 v167,v190,v191
s_add_u32 s20,s19,2097152
buffer_store_dwordx4 v[164:167],v0,s[8:11],s20 offen sc1
v_mov_b32 v20,1
s_lshl_b32 s73,s51,13
s_lshl2_add_u32 s73,s68,s73
s_add_u32 s73,s73,10487552
s_branch L_aa_248
L_ar_263:
ds_read_b128 v[160:163],v23
ds_read_b128 v[164:167],v23 offset:16
v_lshlrev_b32 v200,16,v224
v_and_b32 v201,0xffff0000,v224
v_lshlrev_b32 v202,16,v225
v_and_b32 v203,0xffff0000,v225
v_lshlrev_b32 v204,16,v226
v_and_b32 v205,0xffff0000,v226
v_lshlrev_b32 v206,16,v227
v_and_b32 v207,0xffff0000,v227
s_lshl_b32 s18,s51,5
s_add_u32 s18,s18,s68
s_lshl_b32 s19,s18,10
s_add_u32 s20,s19,4194304
s_waitcnt lgkmcnt(0)
v_cvt_pk_bf16_f32 v168,v160,v161
v_cvt_pk_bf16_f32 v169,v162,v163
v_cvt_pk_bf16_f32 v170,v164,v165
v_cvt_pk_bf16_f32 v171,v166,v167
v_lshlrev_b32 v160,16,v168
v_and_b32 v161,0xffff0000,v168
v_lshlrev_b32 v162,16,v169
v_and_b32 v163,0xffff0000,v169
v_lshlrev_b32 v164,16,v170
v_and_b32 v165,0xffff0000,v170
v_lshlrev_b32 v166,16,v171
v_and_b32 v167,0xffff0000,v171
v_pk_add_f32 v[200:201],v[200:201],v[160:161]
v_pk_add_f32 v[202:203],v[202:203],v[162:163]
v_pk_add_f32 v[204:205],v[204:205],v[164:165]
v_pk_add_f32 v[206:207],v[206:207],v[166:167]
v_cvt_pk_bf16_f32 v168,v200,v201
v_cvt_pk_bf16_f32 v169,v202,v203
v_cvt_pk_bf16_f32 v170,v204,v205
v_cvt_pk_bf16_f32 v171,v206,v207
buffer_store_dwordx4 v[168:171],v0,s[8:11],s20 offen sc1
v_lshlrev_b32 v200,16,v168
v_and_b32 v201,0xffff0000,v168
v_lshlrev_b32 v202,16,v169
v_and_b32 v203,0xffff0000,v169
v_lshlrev_b32 v204,16,v170
v_and_b32 v205,0xffff0000,v170
v_lshlrev_b32 v206,16,v171
v_and_b32 v207,0xffff0000,v171
v_readfirstlane_b32 s78,v200
s_nop 1
v_pk_add_f32 v[184:185],v[200:201],s[78:79] op_sel_hi:[1,0] neg_lo:[0,1] neg_hi:[0,1]
v_pk_add_f32 v[186:187],v[202:203],s[78:79] op_sel_hi:[1,0] neg_lo:[0,1] neg_hi:[0,1]
v_pk_add_f32 v[188:189],v[204:205],s[78:79] op_sel_hi:[1,0] neg_lo:[0,1] neg_hi:[0,1]
v_pk_add_f32 v[190:191],v[206:207],s[78:79] op_sel_hi:[1,0] neg_lo:[0,1] neg_hi:[0,1]
v_pk_add_f32 v[192:193],v[184:185],v[186:187]
v_pk_mul_f32 v[194:195],v[184:185],v[184:185]
v_pk_add_f32 v[196:197],v[188:189],v[190:191]
v_pk_fma_f32 v[194:195],v[186:187],v[186:187],v[194:195]
v_pk_add_f32 v[192:193],v[192:193],v[196:197]
v_pk_fma_f32 v[194:195],v[188:189],v[188:189],v[194:195]
v_add_f32 v192,v192,v193
v_pk_fma_f32 v[194:195],v[190:191],v[190:191],v[194:195]
v_add_f32 v194,v194,v195
s_nop 1
v_permlane32_swap_b32 v192,v194
v_add_f32 v192,v192,v194
s_nop 1
v_add_f32_dpp v192,v192,v192 row_ror:8 row_mask:0xf bank_mask:0xf
s_nop 1
v_add_f32_dpp v192,v192,v192 row_ror:4 row_mask:0xf bank_mask:0xf
s_nop 1
v_add_f32_dpp v192,v192,v192 row_ror:2 row_mask:0xf bank_mask:0xf
s_nop 1
v_add_f32_dpp v192,v192,v192 row_ror:1 row_mask:0xf bank_mask:0xf
v_mov_b32 v194,v192
s_nop 1
v_permlane16_swap_b32 v192,v194
v_add_f32 v192,v192,v194
v_mul_f32 v192,0x3b000000,v192
v_mov_b32 v194,v192
s_nop 1
v_permlane32_swap_b32 v192,v194
v_fma_f32 v194,-v192,v192,v194
v_add_f32 v192,s78,v192
v_max_f32 v194,0,v194
v_cvt_pk_bf16_f32 v194,v192,v194
v_lshlrev_b32 v192,16,v194
v_and_b32 v194,0xffff0000,v194
v_add_f32 v194,0x3727c5ac,v194
v_cvt_pk_bf16_f32 v194,v194,v194
v_and_b32 v194,0xffff0000,v194
v_sqrt_f32 v194,v194
v_pk_add_f32 v[184:185],v[200:201],v[192:193] op_sel_hi:[1,0] neg_lo:[0,1] neg_hi:[0,1]
v_pk_add_f32 v[186:187],v[202:203],v[192:193] op_sel_hi:[1,0] neg_lo:[0,1] neg_hi:[0,1]
v_pk_add_f32 v[188:189],v[204:205],v[192:193] op_sel_hi:[1,0] neg_lo:[0,1] neg_hi:[0,1]
v_pk_add_f32 v[190:191],v[206:207],v[192:193] op_sel_hi:[1,0] neg_lo:[0,1] neg_hi:[0,1]
v_cvt_pk_bf16_f32 v194,v194,v194
v_and_b32 v194,0xffff0000,v194
v_rcp_f32 v194,v194
v_cvt_pk_bf16_f32 v172,v184,v185
v_cvt_pk_bf16_f32 v173,v186,v187
v_cvt_pk_bf16_f32 v174,v188,v189
v_cvt_pk_bf16_f32 v175,v190,v191
v_lshlrev_b32 v184,16,v172
v_and_b32 v185,0xffff0000,v172
v_lshlrev_b32 v186,16,v173
v_and_b32 v187,0xffff0000,v173
v_lshlrev_b32 v188,16,v174
v_and_b32 v189,0xffff0000,v174
v_lshlrev_b32 v190,16,v175
v_and_b32 v191,0xffff0000,v175
v_pk_mul_f32 v[184:185],v[184:185],v[194:195] op_sel_hi:[1,0]
v_pk_mul_f32 v[186:187],v[186:187],v[194:195] op_sel_hi:[1,0]
v_pk_mul_f32 v[188:189],v[188:189],v[194:195] op_sel_hi:[1,0]
v_pk_mul_f32 v[190:191],v[190:191],v[194:195] op_sel_hi:[1,0]
v_cvt_pk_bf16_f32 v172,v184,v185
v_cvt_pk_bf16_f32 v173,v186,v187
v_cvt_pk_bf16_f32 v174,v188,v189
v_cvt_pk_bf16_f32 v175,v190,v191
v_lshlrev_b32 v176,16,v172
v_and_b32 v177,0xffff0000,v172
v_lshlrev_b32 v178,16,v173
v_and_b32 v179,0xffff0000,v173
v_lshlrev_b32 v180,16,v174
v_and_b32 v181,0xffff0000,v174
v_lshlrev_b32 v182,16,v175
v_and_b32 v183,0xffff0000,v175
v_pk_mul_f32 v[236:237],v[176:177],v[228:229]
v_pk_fma_f32 v[236:237],v[178:179],v[230:231],v[236:237]
v_pk_fma_f32 v[236:237],v[180:181],v[232:233],v[236:237]
v_pk_fma_f32 v[236:237],v[182:183],v[234:235],v[236:237]
v_add_f32 v236,v236,v237
s_nop 1
v_add_f32_dpp v236,v236,v236 row_ror:8 row_mask:0xf bank_mask:0xf
s_nop 1
v_add_f32_dpp v236,v236,v236 row_ror:4 row_mask:0xf bank_mask:0xf
s_nop 1
v_add_f32_dpp v236,v236,v236 row_ror:2 row_mask:0xf bank_mask:0xf
s_nop 1
v_add_f32_dpp v236,v236,v236 row_ror:1 row_mask:0xf bank_mask:0xf
v_mov_b32 v237,v236
s_nop 1
v_permlane16_swap_b32 v236,v237
v_add_f32 v236,v236,v237
v_mov_b32 v237,v236
s_nop 1
v_permlane32_swap_b32 v236,v237
v_add_f32 v236,v236,v237
v_cvt_pk_bf16_f32 v236,v236,v236
v_and_b32 v236,0xffff0000,v236
v_ashrrev_i32 v237,31,v236
v_or_b32 v237,0x80000000,v237
v_xor_b32 v236,v236,v237
v_and_b32 v236,0xffff0000,v236
s_sub_u32 s20,4095,s18
v_or_b32 v20,s20,v236
s_lshl_b32 s20,s51,13
s_lshl2_add_u32 s20,s68,s20
s_add_u32 s20,s20,10487168
buffer_store_dword v20,off,s[8:11],s20 sc1
s_branch L_aa_248
L_ar_264:
s_bitcmp1_b32 s46,0
s_cbranch_scc1 L_aa_248
ds_read_b128 v[160:163],v23
ds_read_b128 v[164:167],v23 offset:16
v_lshlrev_b32 v200,16,v224
v_and_b32 v201,0xffff0000,v224
v_lshlrev_b32 v202,16,v225
v_and_b32 v203,0xffff0000,v225
v_lshlrev_b32 v204,16,v226
v_and_b32 v205,0xffff0000,v226
v_lshlrev_b32 v206,16,v227
v_and_b32 v207,0xffff0000,v227
v_readfirstlane_b32 s22,v246
s_cmp_eq_u32 s22,0
s_cbranch_scc1 L_ag_265
L_agb_266:
s_lshl_b32 s18,s51,5
s_add_u32 s18,s18,s68
s_lshl_b32 s19,s18,10
s_add_u32 s20,s19,6291456
s_waitcnt lgkmcnt(0)
v_cvt_pk_bf16_f32 v168,v160,v161
v_cvt_pk_bf16_f32 v169,v162,v163
v_cvt_pk_bf16_f32 v170,v164,v165
v_cvt_pk_bf16_f32 v171,v166,v167
v_lshlrev_b32 v160,16,v168
v_and_b32 v161,0xffff0000,v168
v_lshlrev_b32 v162,16,v169
v_and_b32 v163,0xffff0000,v169
v_lshlrev_b32 v164,16,v170
v_and_b32 v165,0xffff0000,v170
v_lshlrev_b32 v166,16,v171
v_and_b32 v167,0xffff0000,v171
v_pk_add_f32 v[200:201],v[200:201],v[160:161]
v_pk_add_f32 v[202:203],v[202:203],v[162:163]
v_pk_add_f32 v[204:205],v[204:205],v[164:165]
v_pk_add_f32 v[206:207],v[206:207],v[166:167]
v_cvt_pk_bf16_f32 v168,v200,v201
v_cvt_pk_bf16_f32 v169,v202,v203
v_cvt_pk_bf16_f32 v170,v204,v205
v_cvt_pk_bf16_f32 v171,v206,v207
buffer_store_dwordx4 v[168:171],v0,s[8:11],s20 offen sc1
v_lshlrev_b32 v200,16,v168
v_and_b32 v201,0xffff0000,v168
v_lshlrev_b32 v202,16,v169
v_and_b32 v203,0xffff0000,v169
v_lshlrev_b32 v204,16,v170
v_and_b32 v205,0xffff0000,v170
v_lshlrev_b32 v206,16,v171
v_and_b32 v207,0xffff0000,v171
v_readfirstlane_b32 s78,v200
s_nop 1
v_pk_add_f32 v[184:185],v[200:201],s[78:79] op_sel_hi:[1,0] neg_lo:[0,1] neg_hi:[0,1]
v_pk_add_f32 v[186:187],v[202:203],s[78:79] op_sel_hi:[1,0] neg_lo:[0,1] neg_hi:[0,1]
v_pk_add_f32 v[188:189],v[204:205],s[78:79] op_sel_hi:[1,0] neg_lo:[0,1] neg_hi:[0,1]
v_pk_add_f32 v[190:191],v[206:207],s[78:79] op_sel_hi:[1,0] neg_lo:[0,1] neg_hi:[0,1]
v_pk_add_f32 v[192:193],v[184:185],v[186:187]
v_pk_mul_f32 v[194:195],v[184:185],v[184:185]
v_pk_add_f32 v[196:197],v[188:189],v[190:191]
v_pk_fma_f32 v[194:195],v[186:187],v[186:187],v[194:195]
v_pk_add_f32 v[192:193],v[192:193],v[196:197]
v_pk_fma_f32 v[194:195],v[188:189],v[188:189],v[194:195]
v_add_f32 v192,v192,v193
v_pk_fma_f32 v[194:195],v[190:191],v[190:191],v[194:195]
v_add_f32 v194,v194,v195
s_nop 1
v_permlane32_swap_b32 v192,v194
v_add_f32 v192,v192,v194
s_nop 1
v_add_f32_dpp v192,v192,v192 row_ror:8 row_mask:0xf bank_mask:0xf
s_nop 1
v_add_f32_dpp v192,v192,v192 row_ror:4 row_mask:0xf bank_mask:0xf
s_nop 1
v_add_f32_dpp v192,v192,v192 row_ror:2 row_mask:0xf bank_mask:0xf
s_nop 1
v_add_f32_dpp v192,v192,v192 row_ror:1 row_mask:0xf bank_mask:0xf
v_mov_b32 v194,v192
s_nop 1
v_permlane16_swap_b32 v192,v194
v_add_f32 v192,v192,v194
v_mul_f32 v192,0x3b000000,v192
v_mov_b32 v194,v192
s_nop 1
v_permlane32_swap_b32 v192,v194
v_fma_f32 v194,-v192,v192,v194
v_add_f32 v192,s78,v192
v_max_f32 v194,0,v194
v_cvt_pk_bf16_f32 v194,v192,v194
v_lshlrev_b32 v192,16,v194
v_and_b32 v194,0xffff0000,v194
v_add_f32 v194,0x3727c5ac,v194
v_cvt_pk_bf16_f32 v194,v194,v194
v_and_b32 v194,0xffff0000,v194
v_sqrt_f32 v194,v194
v_pk_add_f32 v[184:185],v[200:201],v[192:193] op_sel_hi:[1,0] neg_lo:[0,1] neg_hi:[0,1]
v_pk_add_f32 v[186:187],v[202:203],v[192:193] op_sel_hi:[1,0] neg_lo:[0,1] neg_hi:[0,1]
v_pk_add_f32 v[188:189],v[204:205],v[192:193] op_sel_hi:[1,0] neg_lo:[0,1] neg_hi:[0,1]
v_pk_add_f32 v[190:191],v[206:207],v[192:193] op_sel_hi:[1,0] neg_lo:[0,1] neg_hi:[0,1]
v_cvt_pk_bf16_f32 v194,v194,v194
v_and_b32 v194,0xffff0000,v194
v_rcp_f32 v194,v194
v_cvt_pk_bf16_f32 v172,v184,v185
v_cvt_pk_bf16_f32 v173,v186,v187
v_cvt_pk_bf16_f32 v174,v188,v189
v_cvt_pk_bf16_f32 v175,v190,v191
v_lshlrev_b32 v184,16,v172
v_and_b32 v185,0xffff0000,v172
v_lshlrev_b32 v186,16,v173
v_and_b32 v187,0xffff0000,v173
v_lshlrev_b32 v188,16,v174
v_and_b32 v189,0xffff0000,v174
v_lshlrev_b32 v190,16,v175
v_and_b32 v191,0xffff0000,v175
v_pk_mul_f32 v[184:185],v[184:185],v[194:195] op_sel_hi:[1,0]
v_pk_mul_f32 v[186:187],v[186:187],v[194:195] op_sel_hi:[1,0]
v_pk_mul_f32 v[188:189],v[188:189],v[194:195] op_sel_hi:[1,0]
v_pk_mul_f32 v[190:191],v[190:191],v[194:195] op_sel_hi:[1,0]
v_cvt_pk_bf16_f32 v172,v184,v185
v_cvt_pk_bf16_f32 v173,v186,v187
v_cvt_pk_bf16_f32 v174,v188,v189
v_cvt_pk_bf16_f32 v175,v190,v191
v_lshlrev_b32 v176,16,v172
v_and_b32 v177,0xffff0000,v172
v_lshlrev_b32 v178,16,v173
v_and_b32 v179,0xffff0000,v173
v_lshlrev_b32 v180,16,v174
v_and_b32 v181,0xffff0000,v174
v_lshlrev_b32 v182,16,v175
v_and_b32 v183,0xffff0000,v175
v_pk_add_f32 v[200:201],v[200:201],v[176:177]
v_pk_add_f32 v[202:203],v[202:203],v[178:179]
v_pk_add_f32 v[204:205],v[204:205],v[180:181]
v_pk_add_f32 v[206:207],v[206:207],v[182:183]
v_cvt_pk_bf16_f32 v160,v200,v201
v_cvt_pk_bf16_f32 v161,v202,v203
v_cvt_pk_bf16_f32 v162,v204,v205
v_cvt_pk_bf16_f32 v163,v206,v207
buffer_store_dwordx4 v[160:163],v0,s[12:15],s19 offen sc1
v_pk_mul_f32 v[236:237],v[176:177],v[228:229]
v_pk_fma_f32 v[236:237],v[178:179],v[230:231],v[236:237]
v_pk_fma_f32 v[236:237],v[180:181],v[232:233],v[236:237]
v_pk_fma_f32 v[236:237],v[182:183],v[234:235],v[236:237]
v_add_f32 v236,v236,v237
s_nop 1
v_add_f32_dpp v236,v236,v236 row_ror:8 row_mask:0xf bank_mask:0xf
s_nop 1
v_add_f32_dpp v236,v236,v236 row_ror:4 row_mask:0xf bank_mask:0xf
s_nop 1
v_add_f32_dpp v236,v236,v236 row_ror:2 row_mask:0xf bank_mask:0xf
s_nop 1
v_add_f32_dpp v236,v236,v236 row_ror:1 row_mask:0xf bank_mask:0xf
v_mov_b32 v237,v236
s_nop 1
v_permlane16_swap_b32 v236,v237
v_add_f32 v236,v236,v237
v_mov_b32 v237,v236
s_nop 1
v_permlane32_swap_b32 v236,v237
v_add_f32 v236,v236,v237
v_cvt_pk_bf16_f32 v236,v236,v236
v_and_b32 v236,0xffff0000,v236
v_ashrrev_i32 v237,31,v236
v_or_b32 v237,0x80000000,v237
v_xor_b32 v236,v236,v237
v_and_b32 v236,0xffff0000,v236
s_sub_u32 s20,4095,s18
v_or_b32 v20,s20,v236
s_lshl_b32 s73,s51,13
s_lshl2_add_u32 s73,s68,s73
s_add_u32 s73,s73,10485760
s_add_u32 s73,s73,s86
L_aa_248:
s_cmp_eq_u32 s27,1
s_cbranch_scc1 L_ad_267
s_cmp_eq_u32 s27,0
s_cbranch_scc1 L_aa_249
s_cmp_ge_u32 s77,64
s_cbranch_scc1 L_aa_252
L_aa_250:
s_waitcnt vmcnt(0)
buffer_store_dword v20,off,s[8:11],s73 sc1
s_mov_b32 s73,0x80000000
v_mov_b32 v18,0
L_aw_268:
v_cmp_eq_u32 vcc,0,v18
s_cbranch_vccz L_awd_269
buffer_load_dword v18,v19,s[8:11],0 offen sc1
s_sub_u32 s49,s49,1
s_cbranch_scc1 L_abort2
s_waitcnt vmcnt(0)
s_branch L_aw_268
L_awd_269:
s_mov_b32 s64,s70
s_mov_b32 s65,s71
s_and_b32 s57,s46,1
s_mul_i32 s58,s57,12288
s_add_u32 s64,s64,s58
s_lshl_b32 s57,s57,12
s_add_u32 s65,s65,s57
s_and_b32 s59,s50,2048
s_lshl_b32 s59,s59,4
s_xor_b32 s60,s67,65536
s_add_u32 s59,s59,s60
s_add_u32 s58,s58,s59
s_add_u32 s57,s57,s59
s_add_u32 m0,s58,0
s_nop 0
buffer_load_dwordx4 v0,s[8:11],s64 offen offset:0 sc1 lds
buffer_load_dwordx4 v0,s[8:11],s64 offen offset:1024 sc1 lds
buffer_load_dwordx4 v0,s[8:11],s64 offen offset:2048 sc1 lds
buffer_load_dwordx4 v0,s[8:11],s64 offen offset:3072 sc1 lds
s_add_u32 m0,s58,4096
s_add_u32 s64,s64,4096
buffer_load_dwordx4 v0,s[8:11],s64 offen offset:0 sc1 lds
buffer_load_dwordx4 v0,s[8:11],s64 offen offset:1024 sc1 lds
buffer_load_dwordx4 v0,s[8:11],s64 offen offset:2048 sc1 lds
buffer_load_dwordx4 v0,s[8:11],s64 offen offset:3072 sc1 lds
s_add_u32 m0,s58,8192
s_add_u32 s64,s64,4096
buffer_load_dwordx4 v0,s[8:11],s64 offen offset:0 sc1 lds
buffer_load_dwordx4 v0,s[8:11],s64 offen offset:1024 sc1 lds
buffer_load_dwordx4 v0,s[8:11],s64 offen offset:2048 sc1 lds
buffer_load_dwordx4 v0,s[8:11],s64 offen offset:3072 sc1 lds
s_add_u32 m0,s57,24576
s_nop 0
buffer_load_dwordx4 v0,s[8:11],s65 offen offset:0 sc1 lds
buffer_load_dwordx4 v0,s[8:11],s65 offen offset:1024 sc1 lds
buffer_load_dwordx4 v0,s[8:11],s65 offen offset:2048 sc1 lds
buffer_load_dwordx4 v0,s[8:11],s65 offen offset:3072 sc1 lds
v_lshrrev_b32 v244,4,v1
s_sub_u32 s56,s77,8
v_add_u32 v244,s56,v244
v_max_i32 v244,0,v244
v_lshl_add_u32 v244,v244,13,v21
buffer_load_dwordx2 v[242:243],v244,s[8:11],0 offen sc1
s_waitcnt vmcnt(0) lgkmcnt(0)
s_barrier
s_xor_b32 s67,s67,65536
s_and_b32 s56,s50,2048
s_lshl_b32 s56,s56,4
s_add_u32 s56,s56,s67
v_add_u32 v2,s56,v0
s_and_b32 s56,s50,1024
s_lshl_b32 s56,s56,2
v_add_u32 v238,s56,v2
s_mov_b32 s76,s71
s_mov_b32 s53,s77
ds_read_b128 v[24:27],v238 offset:16384
ds_read_b128 v[40:43],v2 offset:0
ds_read_b128 v[56:59],v2 offset:4096
ds_read_b128 v[28:31],v238 offset:17408
ds_read_b128 v[44:47],v2 offset:1024
ds_read_b128 v[60:63],v2 offset:5120
ds_read_b128 v[32:35],v238 offset:18432
ds_read_b128 v[48:51],v2 offset:2048
ds_read_b128 v[64:67],v2 offset:6144
ds_read_b128 v[36:39],v238 offset:19456
ds_read_b128 v[52:55],v2 offset:3072
ds_read_b128 v[68:71],v2 offset:7168
s_waitcnt lgkmcnt(9)
v_mfma_f32_16x16x32_bf16 v[128:131],v[40:43],v[24:27],v[8:11]
ds_read_b128 v[72:75],v2 offset:24576
v_mfma_f32_16x16x32_bf16 v[132:135],v[56:59],v[24:27],v[12:15]
ds_read_b128 v[76:79],v2 offset:25600
s_waitcnt lgkmcnt(8)
v_mfma_f32_16x16x32_bf16 v[128:131],v[44:47],v[28:31],v[128:131]
ds_read_b128 v[80:83],v2 offset:26624
v_mfma_f32_16x16x32_bf16 v[132:135],v[60:63],v[28:31],v[132:135]
ds_read_b128 v[84:87],v2 offset:27648
s_waitcnt lgkmcnt(7)
v_mfma_f32_16x16x32_bf16 v[128:131],v[48:51],v[32:35],v[128:131]
ds_read_b64 v[120:121],v2 offset:28672
v_mfma_f32_16x16x32_bf16 v[132:135],v[64:67],v[32:35],v[132:135]
ds_read_b64 v[122:123],v2 offset:29696
s_waitcnt lgkmcnt(6)
v_mfma_f32_16x16x32_bf16 v[128:131],v[52:55],v[36:39],v[128:131]
ds_read_b64 v[124:125],v2 offset:30720
v_mfma_f32_16x16x32_bf16 v[132:135],v[68:71],v[36:39],v[132:135]
ds_read_b64 v[126:127],v2 offset:31744
s_waitcnt lgkmcnt(4)
v_mfma_f32_16x16x32_bf16 v[136:139],v[72:75],v[24:27],0
ds_read_b128 v[88:91],v2 offset:8192
ds_read_b128 v[92:95],v2 offset:9216
v_mfma_f32_16x16x32_bf16 v[136:139],v[76:79],v[28:31],v[136:139]
ds_read_b128 v[96:99],v2 offset:10240
ds_read_b128 v[100:103],v2 offset:11264
v_mfma_f32_16x16x32_bf16 v[136:139],v[80:83],v[32:35],v[136:139]
ds_read_b128 v[104:107],v2 offset:12288
ds_read_b128 v[108:111],v2 offset:13312
v_mfma_f32_16x16x32_bf16 v[136:139],v[84:87],v[36:39],v[136:139]
ds_read_b128 v[112:115],v2 offset:14336
ds_read_b128 v[116:119],v2 offset:15360
s_waitcnt lgkmcnt(0)
s_cmp_eq_u32 s30,0
s_cbranch_scc1 L_aa_251
s_cmp_lg_u32 s86,1536
s_cbranch_scc1 L_ae_270
s_add_u32 s77,s53,13
s_mov_b32 s30,0
s_lshl_b32 s56,s77,5
s_add_u32 s56,s56,s68
s_mul_i32 s70,s56,24576
s_lshl_b32 s71,s56,13
s_lshl_b32 s59,s77,13
s_lshl2_add_u32 s59,s68,s59
s_add_u32 s59,s59,10485760
s_buffer_load_dword s32,s[8:11],s59 glc
s_mov_b32 s33,1
s_add_u32 s70,s70,100663296
s_add_u32 s71,s71,41943040
v_mov_b32 v19,s59
s_branch L_af_271
L_ae_270:
s_ff1_i32_b64 s77,s[84:85]
s_bitset0_b64 s[84:85],s77
s_ff1_i32_b64 s77,s[84:85]
s_bitset0_b64 s[84:85],s77
s_ff1_i32_b64 s77,s[84:85]
s_bitset0_b64 s[84:85],s77
s_ff1_i32_b64 s77,s[84:85]
s_bitset0_b64 s[84:85],s77
s_ff1_i32_b64 s77,s[84:85]
s_bitset0_b64 s[84:85],s77
s_ff1_i32_b64 s77,s[84:85]
s_bitset0_b64 s[84:85],s77
s_min_u32 s77,s77,64
s_lshr_b32 s61,s55,5
s_lshl_b32 s56,s77,5
s_add_u32 s56,s56,s68
s_mul_i32 s70,s56,24576
s_lshl_b32 s71,s56,13
s_lshl_b32 s59,s77,13
s_lshl2_add_u32 s59,s68,s59
s_add_u32 s59,s59,10486144
s_cmp_lt_u32 s77,s61
s_cselect_b32 s57,0,16777216
s_cselect_b32 s60,0,128
s_add_u32 s60,s60,s59
s_add_u32 s60,s60,128
s_buffer_load_dword s33,s[8:11],s60 glc
s_add_u32 s71,s71,s57
s_add_u32 s71,s71,58720256
s_cmp_eq_u32 s77,s61
s_cselect_b32 s57,50331648,0
s_cselect_b32 s58,1536,0
s_add_u32 s59,s59,s58
s_buffer_load_dword s32,s[8:11],s59 glc
s_add_u32 s70,s70,s57
s_add_u32 s70,s70,150994944
v_mov_b32 v19,s59
v_writelane_b32 v19,s60,1
L_af_271:
v_max3_f32 v238,v128,v129,v130
v_max3_f32 v239,v131,v132,v133
v_max3_f32 v238,v134,v135,v238
v_max3_f32 v239,v138,v139,v239
v_max_f32 v238,v238,v239
v_max_f32 v239,v238,v239
s_nop 1
v_permlane16_swap_b32 v238,v239
v_max_f32 v238,v238,v239
v_max_f32 v239,v238,v239
s_nop 1
v_permlane32_swap_b32 v238,v239
v_max_f32 v238,v238,v239
v_mul_f32 v238,s80,v238
v_fma_f32 v128,v128,s80,-v238
v_fma_f32 v129,v129,s80,-v238
v_exp_f32 v128,v128
v_fma_f32 v130,v130,s80,-v238
v_exp_f32 v129,v129
v_fma_f32 v131,v131,s80,-v238
v_exp_f32 v130,v130
v_fma_f32 v132,v132,s80,-v238
v_exp_f32 v131,v131
v_fma_f32 v133,v133,s80,-v238
v_exp_f32 v132,v132
v_fma_f32 v134,v134,s80,-v238
v_exp_f32 v133,v133
v_fma_f32 v135,v135,s80,-v238
v_exp_f32 v134,v134
v_fma_f32 v138,v138,s80,-v238
v_exp_f32 v135,v135
v_fma_f32 v139,v139,s80,-v238
v_exp_f32 v138,v138
v_exp_f32 v139,v139
v_cvt_pk_bf16_f32 v140,v128,v129
v_cvt_pk_bf16_f32 v141,v130,v131
v_cvt_pk_bf16_f32 v142,v132,v133
v_cvt_pk_bf16_f32 v143,v134,v135
v_cvt_pk_bf16_f32 v144,v138,v139
v_mov_b32 v147,v144
v_mfma_f32_16x16x32_bf16 v[148:151],v[152:155],v[140:143],0
v_mfma_f32_16x16x32_bf16 v[24:27],v[88:91],v[140:143],0
v_mfma_f32_16x16x32_bf16 v[28:31],v[92:95],v[140:143],0
v_mfma_f32_16x16x16_bf16 v[148:151],v[152:153],v[144:145],v[148:151]
v_mfma_f32_16x16x32_bf16 v[32:35],v[96:99],v[140:143],0
v_mfma_f32_16x16x32_bf16 v[36:39],v[100:103],v[140:143],0
v_mfma_f32_16x16x32_bf16 v[40:43],v[104:107],v[140:143],0
v_mfma_f32_16x16x32_bf16 v[44:47],v[108:111],v[140:143],0
v_mfma_f32_16x16x32_bf16 v[48:51],v[112:115],v[140:143],0
v_mfma_f32_16x16x32_bf16 v[52:55],v[116:119],v[140:143],0
v_rcp_f32 v148,v148
v_mfma_f32_16x16x16_bf16 v[24:27],v[120:121],v[144:145],v[24:27]
v_mfma_f32_16x16x16_bf16 v[28:31],v[120:121],v[146:147],v[28:31]
v_mfma_f32_16x16x16_bf16 v[32:35],v[122:123],v[144:145],v[32:35]
v_mfma_f32_16x16x16_bf16 v[36:39],v[122:123],v[146:147],v[36:39]
v_mfma_f32_16x16x16_bf16 v[40:43],v[124:125],v[144:145],v[40:43]
v_pk_mul_f32 v[24:25],v[24:25],v[148:149] op_sel_hi:[1,0]
v_pk_mul_f32 v[26:27],v[26:27],v[148:149] op_sel_hi:[1,0]
v_mfma_f32_16x16x16_bf16 v[44:47],v[124:125],v[146:147],v[44:47]
v_pk_mul_f32 v[28:29],v[28:29],v[148:149] op_sel_hi:[1,0]
v_pk_mul_f32 v[30:31],v[30:31],v[148:149] op_sel_hi:[1,0]
v_mfma_f32_16x16x16_bf16 v[48:51],v[126:127],v[144:145],v[48:51]
v_cvt_pk_bf16_f32 v72,v24,v28
v_cvt_pk_bf16_f32 v73,v25,v29
v_mfma_f32_16x16x16_bf16 v[52:55],v[126:127],v[146:147],v[52:55]
v_cvt_pk_bf16_f32 v74,v26,v30
v_cvt_pk_bf16_f32 v75,v27,v31
ds_write_b128 v3,v[72:75] offset:0
v_pk_mul_f32 v[32:33],v[32:33],v[148:149] op_sel_hi:[1,0]
v_pk_mul_f32 v[34:35],v[34:35],v[148:149] op_sel_hi:[1,0]
v_pk_mul_f32 v[36:37],v[36:37],v[148:149] op_sel_hi:[1,0]
v_pk_mul_f32 v[38:39],v[38:39],v[148:149] op_sel_hi:[1,0]
v_cvt_pk_bf16_f32 v76,v32,v36
v_cvt_pk_bf16_f32 v77,v33,v37
v_cvt_pk_bf16_f32 v78,v34,v38
v_cvt_pk_bf16_f32 v79,v35,v39
ds_write_b128 v3,v[76:79] offset:1024
v_pk_mul_f32 v[40:41],v[40:41],v[148:149] op_sel_hi:[1,0]
v_pk_mul_f32 v[42:43],v[42:43],v[148:149] op_sel_hi:[1,0]
v_pk_mul_f32 v[44:45],v[44:45],v[148:149] op_sel_hi:[1,0]
v_pk_mul_f32 v[46:47],v[46:47],v[148:149] op_sel_hi:[1,0]
v_cvt_pk_bf16_f32 v80,v40,v44
v_cvt_pk_bf16_f32 v81,v41,v45
v_cvt_pk_bf16_f32 v82,v42,v46
v_cvt_pk_bf16_f32 v83,v43,v47
ds_write_b128 v3,v[80:83] offset:2048
v_pk_mul_f32 v[48:49],v[48:49],v[148:149] op_sel_hi:[1,0]
v_pk_mul_f32 v[50:51],v[50:51],v[148:149] op_sel_hi:[1,0]
v_pk_mul_f32 v[52:53],v[52:53],v[148:149] op_sel_hi:[1,0]
v_pk_mul_f32 v[54:55],v[54:55],v[148:149] op_sel_hi:[1,0]
v_cvt_pk_bf16_f32 v84,v48,v52
v_cvt_pk_bf16_f32 v85,v49,v53
v_cvt_pk_bf16_f32 v86,v50,v54
v_cvt_pk_bf16_f32 v87,v51,v55
ds_write_b128 v3,v[84:87] offset:3072
s_waitcnt lgkmcnt(0)
s_barrier
L_ad_267:
s_mov_b32 s51,s53
s_mov_b32 s31,1
s_branch L_aa_243
L_aa_249:
s_waitcnt vmcnt(2)
s_bitcmp1_b32 s46,0
s_cselect_b32 s56,0,s31
s_cmp_lg_u32 s56,0
s_cbranch_scc1 L_aa_251
s_waitcnt vmcnt(0)
buffer_store_dword v20,off,s[8:11],s73 sc1
s_mov_b32 s73,0x80000000
L_aa_251:
s_mov_b32 s51,s53
s_mov_b32 s31,0
s_cmp_lt_u32 s53,5
s_cbranch_scc1 L_ab_272
L_aw_274:
v_min_u32 v239,v242,v243
v_cmp_eq_u32 vcc,0,v239
s_cbranch_vccz L_awd_275
buffer_load_dwordx2 v[242:243],v244,s[8:11],0 offen sc1
s_sub_u32 s49,s49,1
s_cbranch_scc1 L_abort2
s_waitcnt vmcnt(0)
s_branch L_aw_274
L_awd_275:
v_max_u32 v242,v242,v243
s_nop 1
v_max_u32_dpp v242,v242,v242 row_ror:8 row_mask:0xf bank_mask:0xf
s_nop 1
v_max_u32_dpp v242,v242,v242 row_ror:4 row_mask:0xf bank_mask:0xf
s_nop 1
v_max_u32_dpp v242,v242,v242 row_ror:2 row_mask:0xf bank_mask:0xf
s_nop 1
v_max_u32_dpp v242,v242,v242 row_ror:1 row_mask:0xf bank_mask:0xf
v_mov_b32 v243,v242
s_nop 1
v_permlane16_swap_b32 v242,v243
v_max_u32 v242,v242,v243
v_mov_b32 v243,v242
s_nop 1
v_permlane32_swap_b32 v242,v243
v_max_u32 v242,v242,v243
s_nop 0
v_readfirstlane_b32 s56,v242
s_max_u32 s75,s75,s56
s_cmp_lt_u32 s53,9
s_cbranch_scc1 L_ab_272
s_sub_u32 s77,s53,9
s_and_b32 s55,s75,0x7ff
s_sub_u32 s55,2047,s55
s_cmp_lt_u32 s77,28
s_cselect_b32 s55,4095,s55
s_lshr_b32 s61,s55,5
s_mov_b32 s30,1
s_lshl_b32 s56,s77,5
s_add_u32 s56,s56,s68
s_mul_i32 s70,s56,24576
s_lshl_b32 s71,s56,13
s_lshl_b32 s59,s77,13
s_lshl2_add_u32 s59,s68,s59
s_add_u32 s59,s59,10486144
s_cmp_lt_u32 s77,s61
s_cselect_b32 s57,0,16777216
s_cselect_b32 s60,0,128
s_add_u32 s60,s60,s59
s_add_u32 s60,s60,128
s_add_u32 s71,s71,s57
s_add_u32 s71,s71,58720256
s_cmp_eq_u32 s77,s61
s_cselect_b32 s57,50331648,0
s_cselect_b32 s58,1536,0
s_add_u32 s59,s59,s58
s_add_u32 s70,s70,s57
s_add_u32 s70,s70,150994944
v_mov_b32 v19,s59
v_writelane_b32 v19,s60,1
s_branch L_aj_273
L_ab_272:
s_add_u32 s77,s53,4
s_mov_b32 s30,0
s_lshl_b32 s56,s77,5
s_add_u32 s56,s56,s68
s_mul_i32 s70,s56,24576
s_lshl_b32 s71,s56,13
s_lshl_b32 s59,s77,13
s_lshl2_add_u32 s59,s68,s59
s_add_u32 s59,s59,10485760
s_mov_b32 s33,1
s_add_u32 s70,s70,100663296
s_add_u32 s71,s71,41943040
v_mov_b32 v19,s59
L_aj_273:
buffer_load_dword v18,v19,s[8:11],0 offen sc1
v_mfma_f32_16x16x32_bf16 v[136:139],v[72:75],v[24:27],0
v_max3_u32 v238,v72,v73,v74
v_max3_u32 v238,v74,v75,v238
v_mfma_f32_16x16x32_bf16 v[136:139],v[76:79],v[28:31],v[136:139]
v_max3_u32 v238,v76,v77,v238
v_max3_u32 v238,v78,v79,v238
v_mfma_f32_16x16x32_bf16 v[136:139],v[80:83],v[32:35],v[136:139]
v_max3_u32 v238,v80,v81,v238
v_max3_u32 v238,v82,v83,v238
v_mfma_f32_16x16x32_bf16 v[136:139],v[84:87],v[36:39],v[136:139]
v_max3_u32 v238,v84,v85,v238
v_max3_u32 v238,v86,v87,v238
v_max3_u32 v238,v120,v121,v238
v_max3_u32 v238,v122,v123,v238
v_max3_u32 v238,v124,v125,v238
v_max3_u32 v238,v126,v127,v238
v_cmp_eq_u32 vcc,-1,v238
s_cbranch_vccz L_aa_254
L_aa_253:
s_add_u32 s62,s76,4096
buffer_load_dwordx4 v[72:75],v0,s[8:11],s76 offen offset:0 sc1
buffer_load_dwordx4 v[76:79],v0,s[8:11],s76 offen offset:1024 sc1
buffer_load_dwordx4 v[80:83],v0,s[8:11],s76 offen offset:2048 sc1
buffer_load_dwordx4 v[84:87],v0,s[8:11],s76 offen offset:3072 sc1
buffer_load_dwordx2 v[120:121],v0,s[8:11],s62 offen offset:0 sc1
buffer_load_dwordx2 v[122:123],v0,s[8:11],s62 offen offset:1024 sc1
buffer_load_dwordx2 v[124:125],v0,s[8:11],s62 offen offset:2048 sc1
buffer_load_dwordx2 v[126:127],v0,s[8:11],s62 offen offset:3072 sc1
buffer_load_dword v18,v19,s[8:11],0 offen sc1
s_sub_u32 s49,s49,1
s_cbranch_scc1 L_abort2
s_waitcnt vmcnt(8)
v_mfma_f32_16x16x32_bf16 v[136:139],v[72:75],v[24:27],0
v_max3_u32 v238,v72,v73,v74
v_max3_u32 v238,v74,v75,v238
s_waitcnt vmcnt(7)
v_mfma_f32_16x16x32_bf16 v[136:139],v[76:79],v[28:31],v[136:139]
v_max3_u32 v238,v76,v77,v238
v_max3_u32 v238,v78,v79,v238
s_waitcnt vmcnt(6)
v_mfma_f32_16x16x32_bf16 v[136:139],v[80:83],v[32:35],v[136:139]
v_max3_u32 v238,v80,v81,v238
v_max3_u32 v238,v82,v83,v238
s_waitcnt vmcnt(5)
v_mfma_f32_16x16x32_bf16 v[136:139],v[84:87],v[36:39],v[136:139]
v_max3_u32 v238,v84,v85,v238
v_max3_u32 v238,v86,v87,v238
s_waitcnt vmcnt(1)
v_max3_u32 v238,v120,v121,v238
v_max3_u32 v238,v122,v123,v238
v_max3_u32 v238,v124,v125,v238
v_max3_u32 v238,v126,v127,v238
v_cmp_eq_u32 vcc,-1,v238
s_cbranch_vccnz L_aa_253
L_aa_254:
v_max3_f32 v238,v128,v129,v130
v_max3_f32 v239,v131,v132,v133
v_max3_f32 v238,v134,v135,v238
v_max3_f32 v239,v138,v139,v239
v_max_f32 v238,v238,v239
v_max_f32 v239,v238,v239
s_nop 1
v_permlane16_swap_b32 v238,v239
v_max_f32 v238,v238,v239
v_max_f32 v239,v238,v239
s_nop 1
v_permlane32_swap_b32 v238,v239
v_max_f32 v238,v238,v239
v_mul_f32 v238,s80,v238
v_fma_f32 v128,v128,s80,-v238
v_fma_f32 v129,v129,s80,-v238
v_exp_f32 v128,v128
v_fma_f32 v130,v130,s80,-v238
v_exp_f32 v129,v129
v_fma_f32 v131,v131,s80,-v238
v_exp_f32 v130,v130
v_fma_f32 v132,v132,s80,-v238
v_exp_f32 v131,v131
v_fma_f32 v133,v133,s80,-v238
v_exp_f32 v132,v132
v_fma_f32 v134,v134,s80,-v238
v_exp_f32 v133,v133
v_fma_f32 v135,v135,s80,-v238
v_exp_f32 v134,v134
v_fma_f32 v138,v138,s80,-v238
v_exp_f32 v135,v135
v_fma_f32 v139,v139,s80,-v238
v_exp_f32 v138,v138
v_exp_f32 v139,v139
v_cvt_pk_bf16_f32 v140,v128,v129
v_cvt_pk_bf16_f32 v141,v130,v131
v_cvt_pk_bf16_f32 v142,v132,v133
v_cvt_pk_bf16_f32 v143,v134,v135
v_cvt_pk_bf16_f32 v144,v138,v139
v_mov_b32 v147,v144
v_mfma_f32_16x16x32_bf16 v[148:151],v[152:155],v[140:143],0
v_mfma_f32_16x16x32_bf16 v[24:27],v[88:91],v[140:143],0
v_mfma_f32_16x16x32_bf16 v[28:31],v[92:95],v[140:143],0
v_mfma_f32_16x16x16_bf16 v[148:151],v[152:153],v[144:145],v[148:151]
v_mfma_f32_16x16x32_bf16 v[32:35],v[96:99],v[140:143],0
v_mfma_f32_16x16x32_bf16 v[36:39],v[100:103],v[140:143],0
v_mfma_f32_16x16x32_bf16 v[40:43],v[104:107],v[140:143],0
v_mfma_f32_16x16x32_bf16 v[44:47],v[108:111],v[140:143],0
v_mfma_f32_16x16x32_bf16 v[48:51],v[112:115],v[140:143],0
v_mfma_f32_16x16x32_bf16 v[52:55],v[116:119],v[140:143],0
v_rcp_f32 v148,v148
v_mfma_f32_16x16x16_bf16 v[24:27],v[120:121],v[144:145],v[24:27]
v_mfma_f32_16x16x16_bf16 v[28:31],v[120:121],v[146:147],v[28:31]
v_mfma_f32_16x16x16_bf16 v[32:35],v[122:123],v[144:145],v[32:35]
v_mfma_f32_16x16x16_bf16 v[36:39],v[122:123],v[146:147],v[36:39]
v_mfma_f32_16x16x16_bf16 v[40:43],v[124:125],v[144:145],v[40:43]
v_pk_mul_f32 v[24:25],v[24:25],v[148:149] op_sel_hi:[1,0]
v_pk_mul_f32 v[26:27],v[26:27],v[148:149] op_sel_hi:[1,0]
v_mfma_f32_16x16x16_bf16 v[44:47],v[124:125],v[146:147],v[44:47]
v_pk_mul_f32 v[28:29],v[28:29],v[148:149] op_sel_hi:[1,0]
v_pk_mul_f32 v[30:31],v[30:31],v[148:149] op_sel_hi:[1,0]
v_mfma_f32_16x16x16_bf16 v[48:51],v[126:127],v[144:145],v[48:51]
v_cvt_pk_bf16_f32 v72,v24,v28
v_cvt_pk_bf16_f32 v73,v25,v29
v_mfma_f32_16x16x16_bf16 v[52:55],v[126:127],v[146:147],v[52:55]
v_cvt_pk_bf16_f32 v74,v26,v30
v_cvt_pk_bf16_f32 v75,v27,v31
ds_write_b128 v3,v[72:75] offset:0
v_pk_mul_f32 v[32:33],v[32:33],v[148:149] op_sel_hi:[1,0]
v_pk_mul_f32 v[34:35],v[34:35],v[148:149] op_sel_hi:[1,0]
v_pk_mul_f32 v[36:37],v[36:37],v[148:149] op_sel_hi:[1,0]
v_pk_mul_f32 v[38:39],v[38:39],v[148:149] op_sel_hi:[1,0]
v_cvt_pk_bf16_f32 v76,v32,v36
v_cvt_pk_bf16_f32 v77,v33,v37
v_cvt_pk_bf16_f32 v78,v34,v38
v_cvt_pk_bf16_f32 v79,v35,v39
ds_write_b128 v3,v[76:79] offset:1024
v_pk_mul_f32 v[40:41],v[40:41],v[148:149] op_sel_hi:[1,0]
v_pk_mul_f32 v[42:43],v[42:43],v[148:149] op_sel_hi:[1,0]
v_pk_mul_f32 v[44:45],v[44:45],v[148:149] op_sel_hi:[1,0]
v_pk_mul_f32 v[46:47],v[46:47],v[148:149] op_sel_hi:[1,0]
v_cvt_pk_bf16_f32 v80,v40,v44
v_cvt_pk_bf16_f32 v81,v41,v45
v_cvt_pk_bf16_f32 v82,v42,v46
v_cvt_pk_bf16_f32 v83,v43,v47
ds_write_b128 v3,v[80:83] offset:2048
v_pk_mul_f32 v[48:49],v[48:49],v[148:149] op_sel_hi:[1,0]
v_pk_mul_f32 v[50:51],v[50:51],v[148:149] op_sel_hi:[1,0]
v_pk_mul_f32 v[52:53],v[52:53],v[148:149] op_sel_hi:[1,0]
v_pk_mul_f32 v[54:55],v[54:55],v[148:149] op_sel_hi:[1,0]
v_cvt_pk_bf16_f32 v84,v48,v52
v_cvt_pk_bf16_f32 v85,v49,v53
v_cvt_pk_bf16_f32 v86,v50,v54
v_cvt_pk_bf16_f32 v87,v51,v55
ds_write_b128 v3,v[84:87] offset:3072
s_waitcnt vmcnt(0)
v_readlane_b32 s32,v18,0
v_readlane_b32 s33,v18,1
s_waitcnt lgkmcnt(0)
s_barrier
s_branch L_aa_243
L_aa_252:
s_cmp_lg_u32 s86,1536
s_cbranch_scc1 L_az_276
L_aa_242:
s_waitcnt vmcnt(0)
buffer_store_dword v20,off,s[8:11],s73 sc1
s_mov_b32 s73,0x80000000
s_mov_b32 s59,11011712
v_and_b32 v238,12,v16
v_mov_b32 v239,0
L_aw_277:
v_cmp_eq_u32 vcc,0,v239
s_cbranch_vccz L_awd_278
s_sleep 2
buffer_load_dword v239,v238,s[8:11],s59 offen sc1
s_sub_u32 s49,s49,1
s_cbranch_scc1 L_abort2
s_waitcnt vmcnt(0)
s_branch L_aw_277
L_awd_278:
v_readlane_b32 s55,v239,0
v_readlane_b32 s84,v239,1
v_readlane_b32 s56,v239,2
v_readlane_b32 s58,v239,3
s_sub_u32 s55,s55,1
s_bitset0_b32 s84,31
s_bitset0_b32 s56,31
s_mov_b32 s57,0
s_lshl_b64 s[56:57],s[56:57],22
s_or_b32 s84,s84,s56
s_lshl_b32 s58,s58,12
s_or_b32 s85,s57,s58
s_mov_b32 s86,768
s_mov_b32 s30,1
s_mov_b32 s65,s54
L_as_279:
s_ff1_i32_b64 s77,s[84:85]
s_bitset0_b64 s[84:85],s77
s_min_u32 s77,s77,64
s_sub_u32 s65,s65,1
s_cbranch_scc0 L_as_279
s_lshr_b32 s61,s55,5
s_lshl_b32 s56,s77,5
s_add_u32 s56,s56,s68
s_mul_i32 s70,s56,24576
s_lshl_b32 s71,s56,13
s_lshl_b32 s59,s77,13
s_lshl2_add_u32 s59,s68,s59
s_add_u32 s59,s59,10486144
s_cmp_lt_u32 s77,s61
s_cselect_b32 s57,0,16777216
s_cselect_b32 s60,0,128
s_add_u32 s60,s60,s59
s_add_u32 s60,s60,128
s_buffer_load_dword s33,s[8:11],s60 glc
s_add_u32 s71,s71,s57
s_add_u32 s71,s71,58720256
s_cmp_eq_u32 s77,s61
s_cselect_b32 s57,50331648,0
s_cselect_b32 s58,1536,0
s_add_u32 s59,s59,s58
s_buffer_load_dword s32,s[8:11],s59 glc
s_add_u32 s70,s70,s57
s_add_u32 s70,s70,150994944
v_mov_b32 v19,s59
v_writelane_b32 v19,s60,1
s_cmp_lt_u32 s77,64
s_cbranch_scc1 L_aa_250
L_az_276:
s_waitcnt vmcnt(0)
buffer_store_dword v20,off,s[8:11],s73 sc1
s_mov_b32 s73,0x80000000
s_endpgm
L_ag_265:
s_lshl_b32 s21,s51,13
s_lshl2_add_u32 s21,s68,s21
s_add_u32 s21,s21,10487296
L_ww_280:
buffer_load_dword v246,off,s[8:11],s21 sc1
s_sub_u32 s49,s49,1
s_cbranch_scc1 L_abort2
s_waitcnt vmcnt(0)
v_readfirstlane_b32 s22,v246
s_cmp_eq_u32 s22,0
s_cbranch_scc1 L_ww_280
L_wwd_281:
s_branch L_agb_266
s_endpgm
L_wm:
s_nop 11
v_and_b32 v120,15,v1
v_lshrrev_b32 v121,4,v1
v_mov_b32 v17,1
s_lshl_b32 s56,s46,15
v_add_u32 v18,s56,v0
s_lshl_b32 s56,s46,2
v_add_u32 v125,s56,v121
v_xor_b32 v126,v125,v120
v_lshlrev_b32 v126,4,v126
v_lshl_add_u32 v20,v125,10,v126
v_add_u32 v125,0,v121
v_xor_b32 v125,v125,v120
v_lshlrev_b32 v125,4,v125
v_lshl_add_u32 v125,v120,8,v125
v_add_u32 v4,131072,v125
v_add_u32 v125,4,v121
v_xor_b32 v125,v125,v120
v_lshlrev_b32 v125,4,v125
v_lshl_add_u32 v125,v120,8,v125
v_add_u32 v5,131072,v125
v_add_u32 v125,8,v121
v_xor_b32 v125,v125,v120
v_lshlrev_b32 v125,4,v125
v_lshl_add_u32 v125,v120,8,v125
v_add_u32 v6,131072,v125
v_add_u32 v125,12,v121
v_xor_b32 v125,v125,v120
v_lshlrev_b32 v125,4,v125
v_lshl_add_u32 v125,v120,8,v125
v_add_u32 v7,131072,v125
v_lshlrev_b32 v21,5,v120
v_and_b32 v125,1,v121
v_lshl_add_u32 v21,v125,4,v21
s_lshl_b32 s56,s46,9
v_lshrrev_b32 v125,1,v121
v_lshl_add_u32 v21,v125,11,v21
s_add_u32 s56,s56,155648
v_add_u32 v21,s56,v21
v_lshlrev_b32 v22,4,v120
v_lshl_add_u32 v22,v121,10,v22
s_lshl_b32 s56,s46,8
v_add_u32 v22,s56,v22
s_mov_b32 s54,0
s_mov_b32 s31,0
s_mov_b32 s53,3
s_mov_b32 s72,0x80000000
s_mov_b32 s73,0
s_mov_b32 s77,-1
s_mov_b64 s[84:85],0
s_mov_b32 s74,614203392
s_mov_b32 s75,1227133513
s_ff1_i32_b64 s30,s[74:75]
s_bitset0_b64 s[74:75],s30
s_min_u32 s30,s30,127
s_lshl_b32 s70,s30,15
s_add_u32 s70,s70,0
s_add_u32 s71,s70,16384
s_add_u32 m0,s50,131072
s_nop 0
buffer_load_dwordx4 v20,s[8:11],s70 offen offset:0 sc1 lds
s_add_u32 m0,s50,135168
s_nop 0
buffer_load_dwordx4 v20,s[8:11],s71 offen offset:0 sc1 lds
s_add_u32 m0,s50,139008
s_nop 0
buffer_load_dwordx4 v20,s[8:11],s70 offen offset:256 sc1 lds
s_add_u32 m0,s50,143104
s_nop 0
buffer_load_dwordx4 v20,s[8:11],s71 offen offset:256 sc1 lds
s_add_u32 m0,s50,146944
s_nop 0
buffer_load_dwordx4 v20,s[8:11],s70 offen offset:512 sc1 lds
s_add_u32 m0,s50,151040
s_nop 0
buffer_load_dwordx4 v20,s[8:11],s71 offen offset:512 sc1 lds
v_and_b32 v23,31,v1
v_lshlrev_b32 v23,2,v23
s_waitcnt vmcnt(0)
L_mo_283:
s_mov_b32 s51,s30
s_mov_b64 s[68:69],s[70:71]
s_ff1_i32_b64 s30,s[74:75]
s_bitset0_b64 s[74:75],s30
s_min_u32 s30,s30,127
s_lshl_b32 s70,s30,15
s_add_u32 s70,s70,0
s_add_u32 s71,s70,16384
s_lshl_b32 s76,s31,13
s_add_u32 s76,s76,10487168
s_lshl_b32 s58,s51,5
s_add_u32 s58,s58,s47
s_mul_i32 s58,s58,24576
s_add_u32 s58,s58,100663296
s_add_u32 s61,s58,s50
s_add_u32 s62,s61,4096
s_add_u32 s63,s61,16384
s_add_u32 s64,s61,20480
s_add_u32 s65,s61,s50
s_add_u32 s65,s65,8192
s_waitcnt vmcnt(13)
s_barrier
ds_read_b128 v[72:75],v4 offset:0
ds_read_b128 v[76:79],v4 offset:4096
ds_read_b128 v[80:83],v5 offset:0
ds_read_b128 v[84:87],v5 offset:4096
s_add_u32 m0,s50,154880
s_nop 0
buffer_load_dwordx4 v20,s[8:11],s68 offen offset:768 sc1 lds
s_add_u32 m0,s50,158976
s_nop 0
buffer_load_dwordx4 v20,s[8:11],s69 offen offset:768 sc1 lds
s_waitcnt lgkmcnt(2)
v_mfma_f32_16x16x32_bf16 v[40:43],a[128:131],v[72:75],0
ds_read_b128 v[108:111],v6 offset:0
v_mfma_f32_16x16x32_bf16 v[56:59],v[72:75],v[128:131],0
v_mfma_f32_16x16x32_bf16 v[24:27],a[0:3],v[72:75],0
ds_read_b128 v[112:115],v6 offset:4096
v_mfma_f32_16x16x32_bf16 v[44:47],a[128:131],v[76:79],0
v_mfma_f32_16x16x32_bf16 v[60:63],v[76:79],v[128:131],0
v_mfma_f32_16x16x32_bf16 v[28:31],a[0:3],v[76:79],0
v_mfma_f32_16x16x32_bf16 v[48:51],a[136:139],v[72:75],0
v_mfma_f32_16x16x32_bf16 v[64:67],v[72:75],v[136:139],0
v_mfma_f32_16x16x32_bf16 v[32:35],a[8:11],v[72:75],0
v_mfma_f32_16x16x32_bf16 v[52:55],a[136:139],v[76:79],0
v_mfma_f32_16x16x32_bf16 v[68:71],v[76:79],v[136:139],0
v_mfma_f32_16x16x32_bf16 v[36:39],a[8:11],v[76:79],0
s_waitcnt lgkmcnt(2)
v_mfma_f32_16x16x32_bf16 v[40:43],a[132:135],v[80:83],v[40:43]
ds_read_b128 v[72:75],v7 offset:0
v_mfma_f32_16x16x32_bf16 v[56:59],v[80:83],v[132:135],v[56:59]
v_mfma_f32_16x16x32_bf16 v[24:27],a[4:7],v[80:83],v[24:27]
ds_read_b128 v[76:79],v7 offset:4096
v_mfma_f32_16x16x32_bf16 v[44:47],a[132:135],v[84:87],v[44:47]
v_mfma_f32_16x16x32_bf16 v[60:63],v[84:87],v[132:135],v[60:63]
v_mfma_f32_16x16x32_bf16 v[28:31],a[4:7],v[84:87],v[28:31]
v_mfma_f32_16x16x32_bf16 v[48:51],a[140:143],v[80:83],v[48:51]
v_mfma_f32_16x16x32_bf16 v[64:67],v[80:83],v[140:143],v[64:67]
v_mfma_f32_16x16x32_bf16 v[32:35],a[12:15],v[80:83],v[32:35]
v_mfma_f32_16x16x32_bf16 v[52:55],a[140:143],v[84:87],v[52:55]
v_mfma_f32_16x16x32_bf16 v[68:71],v[84:87],v[140:143],v[68:71]
v_mfma_f32_16x16x32_bf16 v[36:39],a[12:15],v[84:87],v[36:39]
s_waitcnt vmcnt(13)
s_barrier
s_waitcnt lgkmcnt(2)
v_mfma_f32_16x16x32_bf16 v[40:43],a[144:147],v[108:111],v[40:43]
ds_read_b128 v[80:83],v4 offset:8192
v_mfma_f32_16x16x32_bf16 v[56:59],v[108:111],v[144:147],v[56:59]
v_mfma_f32_16x16x32_bf16 v[24:27],a[16:19],v[108:111],v[24:27]
ds_read_b128 v[84:87],v4 offset:12288
v_mfma_f32_16x16x32_bf16 v[44:47],a[144:147],v[112:115],v[44:47]
v_mfma_f32_16x16x32_bf16 v[60:63],v[112:115],v[144:147],v[60:63]
v_mfma_f32_16x16x32_bf16 v[28:31],a[16:19],v[112:115],v[28:31]
v_mfma_f32_16x16x32_bf16 v[48:51],a[152:155],v[108:111],v[48:51]
v_mfma_f32_16x16x32_bf16 v[64:67],v[108:111],v[152:155],v[64:67]
v_mfma_f32_16x16x32_bf16 v[32:35],a[24:27],v[108:111],v[32:35]
v_mfma_f32_16x16x32_bf16 v[52:55],a[152:155],v[112:115],v[52:55]
v_mfma_f32_16x16x32_bf16 v[68:71],v[112:115],v[152:155],v[68:71]
v_mfma_f32_16x16x32_bf16 v[36:39],a[24:27],v[112:115],v[36:39]
s_waitcnt lgkmcnt(2)
v_mfma_f32_16x16x32_bf16 v[40:43],a[148:151],v[72:75],v[40:43]
ds_read_b128 v[108:111],v5 offset:8192
v_mfma_f32_16x16x32_bf16 v[56:59],v[72:75],v[148:151],v[56:59]
v_mfma_f32_16x16x32_bf16 v[24:27],a[20:23],v[72:75],v[24:27]
ds_read_b128 v[112:115],v5 offset:12288
v_mfma_f32_16x16x32_bf16 v[44:47],a[148:151],v[76:79],v[44:47]
v_mfma_f32_16x16x32_bf16 v[60:63],v[76:79],v[148:151],v[60:63]
v_mfma_f32_16x16x32_bf16 v[28:31],a[20:23],v[76:79],v[28:31]
v_mfma_f32_16x16x32_bf16 v[48:51],a[156:159],v[72:75],v[48:51]
v_mfma_f32_16x16x32_bf16 v[64:67],v[72:75],v[156:159],v[64:67]
v_mfma_f32_16x16x32_bf16 v[32:35],a[28:31],v[72:75],v[32:35]
v_mfma_f32_16x16x32_bf16 v[52:55],a[156:159],v[76:79],v[52:55]
v_mfma_f32_16x16x32_bf16 v[68:71],v[76:79],v[156:159],v[68:71]
v_mfma_f32_16x16x32_bf16 v[36:39],a[28:31],v[76:79],v[36:39]
s_waitcnt lgkmcnt(2)
v_mfma_f32_16x16x32_bf16 v[40:43],a[160:163],v[80:83],v[40:43]
ds_read_b128 v[72:75],v6 offset:8192
v_mfma_f32_16x16x32_bf16 v[56:59],v[80:83],v[160:163],v[56:59]
v_mfma_f32_16x16x32_bf16 v[24:27],a[32:35],v[80:83],v[24:27]
ds_read_b128 v[76:79],v6 offset:12288
v_mfma_f32_16x16x32_bf16 v[44:47],a[160:163],v[84:87],v[44:47]
v_mfma_f32_16x16x32_bf16 v[60:63],v[84:87],v[160:163],v[60:63]
v_mfma_f32_16x16x32_bf16 v[28:31],a[32:35],v[84:87],v[28:31]
v_mfma_f32_16x16x32_bf16 v[48:51],a[168:171],v[80:83],v[48:51]
v_mfma_f32_16x16x32_bf16 v[64:67],v[80:83],v[168:171],v[64:67]
v_mfma_f32_16x16x32_bf16 v[32:35],a[40:43],v[80:83],v[32:35]
v_mfma_f32_16x16x32_bf16 v[52:55],a[168:171],v[84:87],v[52:55]
v_mfma_f32_16x16x32_bf16 v[68:71],v[84:87],v[168:171],v[68:71]
v_mfma_f32_16x16x32_bf16 v[36:39],a[40:43],v[84:87],v[36:39]
s_waitcnt lgkmcnt(2)
v_mfma_f32_16x16x32_bf16 v[40:43],a[164:167],v[108:111],v[40:43]
ds_read_b128 v[80:83],v7 offset:8192
v_mfma_f32_16x16x32_bf16 v[56:59],v[108:111],v[164:167],v[56:59]
v_mfma_f32_16x16x32_bf16 v[24:27],a[36:39],v[108:111],v[24:27]
ds_read_b128 v[84:87],v7 offset:12288
v_mfma_f32_16x16x32_bf16 v[44:47],a[164:167],v[112:115],v[44:47]
v_mfma_f32_16x16x32_bf16 v[60:63],v[112:115],v[164:167],v[60:63]
v_mfma_f32_16x16x32_bf16 v[28:31],a[36:39],v[112:115],v[28:31]
v_mfma_f32_16x16x32_bf16 v[48:51],a[172:175],v[108:111],v[48:51]
v_mfma_f32_16x16x32_bf16 v[64:67],v[108:111],v[172:175],v[64:67]
v_mfma_f32_16x16x32_bf16 v[32:35],a[44:47],v[108:111],v[32:35]
v_mfma_f32_16x16x32_bf16 v[52:55],a[172:175],v[112:115],v[52:55]
v_mfma_f32_16x16x32_bf16 v[68:71],v[112:115],v[172:175],v[68:71]
v_mfma_f32_16x16x32_bf16 v[36:39],a[44:47],v[112:115],v[36:39]
s_waitcnt vmcnt(11)
s_barrier
s_waitcnt lgkmcnt(2)
v_mfma_f32_16x16x32_bf16 v[40:43],a[176:179],v[72:75],v[40:43]
ds_read_b128 v[108:111],v4 offset:16384
v_mfma_f32_16x16x32_bf16 v[56:59],v[72:75],v[176:179],v[56:59]
v_mfma_f32_16x16x32_bf16 v[24:27],a[48:51],v[72:75],v[24:27]
ds_read_b128 v[112:115],v4 offset:20480
v_mfma_f32_16x16x32_bf16 v[44:47],a[176:179],v[76:79],v[44:47]
v_mfma_f32_16x16x32_bf16 v[60:63],v[76:79],v[176:179],v[60:63]
v_mfma_f32_16x16x32_bf16 v[28:31],a[48:51],v[76:79],v[28:31]
v_mfma_f32_16x16x32_bf16 v[48:51],a[184:187],v[72:75],v[48:51]
v_mfma_f32_16x16x32_bf16 v[64:67],v[72:75],v[184:187],v[64:67]
v_mfma_f32_16x16x32_bf16 v[32:35],a[56:59],v[72:75],v[32:35]
v_mfma_f32_16x16x32_bf16 v[52:55],a[184:187],v[76:79],v[52:55]
v_mfma_f32_16x16x32_bf16 v[68:71],v[76:79],v[184:187],v[68:71]
v_mfma_f32_16x16x32_bf16 v[36:39],a[56:59],v[76:79],v[36:39]
s_waitcnt vmcnt(2)
s_barrier
s_or_b32 s72,s72,s52
buffer_store_dword v17,off,s[8:11],s72 sc1
s_waitcnt lgkmcnt(2)
v_mfma_f32_16x16x32_bf16 v[40:43],a[180:183],v[80:83],v[40:43]
ds_read_b128 v[72:75],v5 offset:16384
v_mfma_f32_16x16x32_bf16 v[56:59],v[80:83],v[180:183],v[56:59]
v_mfma_f32_16x16x32_bf16 v[24:27],a[52:55],v[80:83],v[24:27]
ds_read_b128 v[76:79],v5 offset:20480
v_mfma_f32_16x16x32_bf16 v[44:47],a[180:183],v[84:87],v[44:47]
v_mfma_f32_16x16x32_bf16 v[60:63],v[84:87],v[180:183],v[60:63]
v_mfma_f32_16x16x32_bf16 v[28:31],a[52:55],v[84:87],v[28:31]
v_mfma_f32_16x16x32_bf16 v[48:51],a[188:191],v[80:83],v[48:51]
v_mfma_f32_16x16x32_bf16 v[64:67],v[80:83],v[188:191],v[64:67]
v_mfma_f32_16x16x32_bf16 v[32:35],a[60:63],v[80:83],v[32:35]
v_mfma_f32_16x16x32_bf16 v[52:55],a[188:191],v[84:87],v[52:55]
v_mfma_f32_16x16x32_bf16 v[68:71],v[84:87],v[188:191],v[68:71]
v_mfma_f32_16x16x32_bf16 v[36:39],a[60:63],v[84:87],v[36:39]
s_waitcnt lgkmcnt(2)
v_mfma_f32_16x16x32_bf16 v[40:43],a[192:195],v[108:111],v[40:43]
ds_read_b128 v[80:83],v6 offset:16384
v_mfma_f32_16x16x32_bf16 v[56:59],v[108:111],v[192:195],v[56:59]
v_mfma_f32_16x16x32_bf16 v[24:27],a[64:67],v[108:111],v[24:27]
ds_read_b128 v[84:87],v6 offset:20480
v_mfma_f32_16x16x32_bf16 v[44:47],a[192:195],v[112:115],v[44:47]
v_mfma_f32_16x16x32_bf16 v[60:63],v[112:115],v[192:195],v[60:63]
v_mfma_f32_16x16x32_bf16 v[28:31],a[64:67],v[112:115],v[28:31]
v_mfma_f32_16x16x32_bf16 v[48:51],a[200:203],v[108:111],v[48:51]
v_mfma_f32_16x16x32_bf16 v[64:67],v[108:111],v[200:203],v[64:67]
v_mfma_f32_16x16x32_bf16 v[32:35],a[72:75],v[108:111],v[32:35]
v_mfma_f32_16x16x32_bf16 v[52:55],a[200:203],v[112:115],v[52:55]
v_mfma_f32_16x16x32_bf16 v[68:71],v[112:115],v[200:203],v[68:71]
v_mfma_f32_16x16x32_bf16 v[36:39],a[72:75],v[112:115],v[36:39]
s_waitcnt lgkmcnt(2)
v_mfma_f32_16x16x32_bf16 v[40:43],a[196:199],v[72:75],v[40:43]
ds_read_b128 v[108:111],v7 offset:16384
v_mfma_f32_16x16x32_bf16 v[56:59],v[72:75],v[196:199],v[56:59]
v_mfma_f32_16x16x32_bf16 v[24:27],a[68:71],v[72:75],v[24:27]
ds_read_b128 v[112:115],v7 offset:20480
v_mfma_f32_16x16x32_bf16 v[44:47],a[196:199],v[76:79],v[44:47]
v_mfma_f32_16x16x32_bf16 v[60:63],v[76:79],v[196:199],v[60:63]
v_mfma_f32_16x16x32_bf16 v[28:31],a[68:71],v[76:79],v[28:31]
v_mfma_f32_16x16x32_bf16 v[48:51],a[204:207],v[72:75],v[48:51]
v_mfma_f32_16x16x32_bf16 v[64:67],v[72:75],v[204:207],v[64:67]
v_mfma_f32_16x16x32_bf16 v[32:35],a[76:79],v[72:75],v[32:35]
v_mfma_f32_16x16x32_bf16 v[52:55],a[204:207],v[76:79],v[52:55]
v_mfma_f32_16x16x32_bf16 v[68:71],v[76:79],v[204:207],v[68:71]
v_mfma_f32_16x16x32_bf16 v[36:39],a[76:79],v[76:79],v[36:39]
s_waitcnt vmcnt(1)
s_barrier
s_waitcnt lgkmcnt(2)
v_mfma_f32_16x16x32_bf16 v[40:43],a[208:211],v[80:83],v[40:43]
ds_read_b128 v[72:75],v4 offset:24576
v_mfma_f32_16x16x32_bf16 v[56:59],v[80:83],v[208:211],v[56:59]
v_mfma_f32_16x16x32_bf16 v[24:27],a[80:83],v[80:83],v[24:27]
ds_read_b128 v[76:79],v4 offset:28672
v_mfma_f32_16x16x32_bf16 v[44:47],a[208:211],v[84:87],v[44:47]
v_mfma_f32_16x16x32_bf16 v[60:63],v[84:87],v[208:211],v[60:63]
v_mfma_f32_16x16x32_bf16 v[28:31],a[80:83],v[84:87],v[28:31]
v_mfma_f32_16x16x32_bf16 v[48:51],a[216:219],v[80:83],v[48:51]
v_mfma_f32_16x16x32_bf16 v[64:67],v[80:83],v[216:219],v[64:67]
v_mfma_f32_16x16x32_bf16 v[32:35],a[88:91],v[80:83],v[32:35]
v_mfma_f32_16x16x32_bf16 v[52:55],a[216:219],v[84:87],v[52:55]
v_mfma_f32_16x16x32_bf16 v[68:71],v[84:87],v[216:219],v[68:71]
v_mfma_f32_16x16x32_bf16 v[36:39],a[88:91],v[84:87],v[36:39]
s_waitcnt lgkmcnt(2)
v_mfma_f32_16x16x32_bf16 v[40:43],a[212:215],v[108:111],v[40:43]
ds_read_b128 v[80:83],v5 offset:24576
v_mfma_f32_16x16x32_bf16 v[56:59],v[108:111],v[212:215],v[56:59]
v_mfma_f32_16x16x32_bf16 v[24:27],a[84:87],v[108:111],v[24:27]
ds_read_b128 v[84:87],v5 offset:28672
v_mfma_f32_16x16x32_bf16 v[44:47],a[212:215],v[112:115],v[44:47]
v_mfma_f32_16x16x32_bf16 v[60:63],v[112:115],v[212:215],v[60:63]
v_mfma_f32_16x16x32_bf16 v[28:31],a[84:87],v[112:115],v[28:31]
v_mfma_f32_16x16x32_bf16 v[48:51],a[220:223],v[108:111],v[48:51]
v_mfma_f32_16x16x32_bf16 v[64:67],v[108:111],v[220:223],v[64:67]
v_mfma_f32_16x16x32_bf16 v[32:35],a[92:95],v[108:111],v[32:35]
v_mfma_f32_16x16x32_bf16 v[52:55],a[220:223],v[112:115],v[52:55]
v_mfma_f32_16x16x32_bf16 v[68:71],v[112:115],v[220:223],v[68:71]
v_mfma_f32_16x16x32_bf16 v[36:39],a[92:95],v[112:115],v[36:39]
s_barrier
s_waitcnt lgkmcnt(2)
v_mfma_f32_16x16x32_bf16 v[40:43],a[224:227],v[72:75],v[40:43]
ds_read_b128 v[108:111],v6 offset:24576
v_mfma_f32_16x16x32_bf16 v[56:59],v[72:75],v[224:227],v[56:59]
s_add_u32 m0,s50,131072
v_mfma_f32_16x16x32_bf16 v[24:27],a[96:99],v[72:75],v[24:27]
ds_read_b128 v[112:115],v6 offset:28672
v_mfma_f32_16x16x32_bf16 v[44:47],a[224:227],v[76:79],v[44:47]
buffer_load_dwordx4 v20,s[8:11],s70 offen offset:0 sc1 lds
v_mfma_f32_16x16x32_bf16 v[60:63],v[76:79],v[224:227],v[60:63]
s_add_u32 m0,s50,135168
v_mfma_f32_16x16x32_bf16 v[28:31],a[96:99],v[76:79],v[28:31]
buffer_load_dwordx4 v20,s[8:11],s71 offen offset:0 sc1 lds
v_mfma_f32_16x16x32_bf16 v[48:51],a[232:235],v[72:75],v[48:51]
s_add_u32 m0,s50,139008
v_mfma_f32_16x16x32_bf16 v[64:67],v[72:75],v[232:235],v[64:67]
buffer_load_dwordx4 v20,s[8:11],s70 offen offset:256 sc1 lds
v_mfma_f32_16x16x32_bf16 v[32:35],a[104:107],v[72:75],v[32:35]
s_add_u32 m0,s50,143104
v_mfma_f32_16x16x32_bf16 v[52:55],a[232:235],v[76:79],v[52:55]
buffer_load_dwordx4 v20,s[8:11],s71 offen offset:256 sc1 lds
v_mfma_f32_16x16x32_bf16 v[68:71],v[76:79],v[232:235],v[68:71]
s_add_u32 m0,s50,146944
v_mfma_f32_16x16x32_bf16 v[36:39],a[104:107],v[76:79],v[36:39]
buffer_load_dwordx4 v20,s[8:11],s70 offen offset:512 sc1 lds
s_waitcnt lgkmcnt(2)
v_mfma_f32_16x16x32_bf16 v[40:43],a[228:231],v[80:83],v[40:43]
ds_read_b128 v[72:75],v7 offset:24576
v_mfma_f32_16x16x32_bf16 v[56:59],v[80:83],v[228:231],v[56:59]
s_add_u32 m0,s50,151040
v_mfma_f32_16x16x32_bf16 v[24:27],a[100:103],v[80:83],v[24:27]
ds_read_b128 v[76:79],v7 offset:28672
v_mfma_f32_16x16x32_bf16 v[44:47],a[228:231],v[84:87],v[44:47]
buffer_load_dwordx4 v20,s[8:11],s71 offen offset:512 sc1 lds
v_mfma_f32_16x16x32_bf16 v[60:63],v[84:87],v[228:231],v[60:63]
buffer_load_dword v125,v23,s[8:11],s76 offen sc1
v_mfma_f32_16x16x32_bf16 v[28:31],a[100:103],v[84:87],v[28:31]
v_mfma_f32_16x16x32_bf16 v[48:51],a[236:239],v[80:83],v[48:51]
v_mfma_f32_16x16x32_bf16 v[64:67],v[80:83],v[236:239],v[64:67]
v_mfma_f32_16x16x32_bf16 v[32:35],a[108:111],v[80:83],v[32:35]
v_mfma_f32_16x16x32_bf16 v[52:55],a[236:239],v[84:87],v[52:55]
v_mfma_f32_16x16x32_bf16 v[68:71],v[84:87],v[236:239],v[68:71]
v_mfma_f32_16x16x32_bf16 v[36:39],a[108:111],v[84:87],v[36:39]
s_waitcnt lgkmcnt(2)
v_mfma_f32_16x16x32_bf16 v[40:43],a[240:243],v[108:111],v[40:43]
v_mfma_f32_16x16x32_bf16 v[56:59],v[108:111],v[240:243],v[56:59]
v_mfma_f32_16x16x32_bf16 v[24:27],a[112:115],v[108:111],v[24:27]
v_mfma_f32_16x16x32_bf16 v[44:47],a[240:243],v[112:115],v[44:47]
v_mfma_f32_16x16x32_bf16 v[60:63],v[112:115],v[240:243],v[60:63]
v_mfma_f32_16x16x32_bf16 v[28:31],a[112:115],v[112:115],v[28:31]
v_mfma_f32_16x16x32_bf16 v[48:51],a[248:251],v[108:111],v[48:51]
v_mfma_f32_16x16x32_bf16 v[64:67],v[108:111],v[248:251],v[64:67]
v_mfma_f32_16x16x32_bf16 v[32:35],a[120:123],v[108:111],v[32:35]
v_mfma_f32_16x16x32_bf16 v[52:55],a[248:251],v[112:115],v[52:55]
v_mfma_f32_16x16x32_bf16 v[68:71],v[112:115],v[248:251],v[68:71]
v_mfma_f32_16x16x32_bf16 v[36:39],a[120:123],v[112:115],v[36:39]
s_waitcnt lgkmcnt(0)
v_mfma_f32_16x16x32_bf16 v[40:43],a[244:247],v[72:75],v[40:43]
v_mfma_f32_16x16x32_bf16 v[56:59],v[72:75],v[244:247],v[56:59]
v_mfma_f32_16x16x32_bf16 v[24:27],a[116:119],v[72:75],v[24:27]
v_mfma_f32_16x16x32_bf16 v[44:47],a[244:247],v[76:79],v[44:47]
v_mfma_f32_16x16x32_bf16 v[60:63],v[76:79],v[244:247],v[60:63]
v_mfma_f32_16x16x32_bf16 v[28:31],a[116:119],v[76:79],v[28:31]
v_mfma_f32_16x16x32_bf16 v[48:51],a[252:255],v[72:75],v[48:51]
v_mfma_f32_16x16x32_bf16 v[64:67],v[72:75],v[252:255],v[64:67]
v_mfma_f32_16x16x32_bf16 v[32:35],a[124:127],v[72:75],v[32:35]
v_mfma_f32_16x16x32_bf16 v[52:55],a[252:255],v[76:79],v[52:55]
v_mfma_f32_16x16x32_bf16 v[68:71],v[76:79],v[252:255],v[68:71]
v_mfma_f32_16x16x32_bf16 v[36:39],a[124:127],v[76:79],v[36:39]
s_lshl_b32 s56,s51,5
s_add_u32 s56,s56,s47
s_lshl_b32 s56,s56,13
s_add_u32 s56,s56,s50
s_add_u32 s56,s56,41943040
s_add_u32 s57,s56,4096
v_mov_b64 v[120:121],-1
v_mov_b64 v[122:123],-1
buffer_store_dwordx4 v[120:123],v0,s[8:11],s56 offen sc1
buffer_store_dwordx4 v[120:123],v0,s[8:11],s57 offen sc1
v_cvt_pk_bf16_f32 v72,v40,v48
v_cvt_pk_bf16_f32 v73,v41,v49
v_cvt_pk_bf16_f32 v74,v42,v50
v_cvt_pk_bf16_f32 v75,v43,v51
buffer_store_dwordx4 v[72:75],v0,s[8:11],s61 offen sc1
v_cvt_pk_bf16_f32 v76,v44,v52
v_cvt_pk_bf16_f32 v77,v45,v53
v_cvt_pk_bf16_f32 v78,v46,v54
v_cvt_pk_bf16_f32 v79,v47,v55
buffer_store_dwordx4 v[76:79],v0,s[8:11],s62 offen sc1
v_cvt_pk_bf16_f32 v80,v56,v57
v_cvt_pk_bf16_f32 v81,v58,v59
v_cvt_pk_bf16_f32 v82,v60,v61
v_cvt_pk_bf16_f32 v83,v62,v63
buffer_store_dwordx4 v[80:83],v0,s[8:11],s65 offen offset:0 sc1
v_cvt_pk_bf16_f32 v84,v64,v65
v_cvt_pk_bf16_f32 v85,v66,v67
v_cvt_pk_bf16_f32 v86,v68,v69
v_cvt_pk_bf16_f32 v87,v70,v71
buffer_store_dwordx4 v[84:87],v0,s[8:11],s65 offen offset:1024 sc1
v_cvt_pk_bf16_f32 v108,v24,v32
v_cvt_pk_bf16_f32 v109,v25,v33
v_cvt_pk_bf16_f32 v110,v26,v34
v_cvt_pk_bf16_f32 v111,v27,v35
buffer_store_dwordx4 v[108:111],v0,s[8:11],s63 offen sc1
v_cvt_pk_bf16_f32 v112,v28,v36
v_cvt_pk_bf16_f32 v113,v29,v37
v_cvt_pk_bf16_f32 v114,v30,v38
v_cvt_pk_bf16_f32 v115,v31,v39
buffer_store_dwordx4 v[112:115],v0,s[8:11],s64 offen sc1
s_lshl_b32 s72,s51,13
s_lshl2_add_u32 s72,s47,s72
s_add_u32 s72,s72,10485760
s_sub_u32 s53,s53,1
s_cmp_gt_i32 s53,0
s_cbranch_scc1 L_mo_283
s_add_u32 s73,s73,1
s_waitcnt vmcnt(8)
v_cmp_eq_u32 vcc,0,v125
s_cbranch_vccz L_mo_285
L_mo_282:
s_lshl_b32 s59,s31,13
s_add_u32 s59,s59,10487168
v_and_b32 v124,31,v1
v_lshlrev_b32 v124,2,v124
L_fw_290:
buffer_load_dword v125,v124,s[8:11],s59 offen sc1
s_sub_u32 s49,s49,1
s_cbranch_scc1 L_abort2
s_waitcnt vmcnt(0)
v_cmp_eq_u32 vcc,0,v125
s_cbranch_vccnz L_fw_290
L_mo_285:
v_max_u32_dpp v125,v125,v125 row_ror:8 row_mask:0xf bank_mask:0xf
s_nop 1
v_max_u32_dpp v125,v125,v125 row_ror:4 row_mask:0xf bank_mask:0xf
s_nop 1
v_max_u32_dpp v125,v125,v125 row_ror:2 row_mask:0xf bank_mask:0xf
s_nop 1
v_max_u32_dpp v125,v125,v125 row_ror:1 row_mask:0xf bank_mask:0xf
v_mov_b32 v124,v125
s_nop 1
v_permlane16_swap_b32 v125,v124
v_max_u32 v125,v125,v124
v_mov_b32 v124,v125
s_nop 1
v_permlane32_swap_b32 v125,v124
v_max_u32 v125,v125,v124
s_nop 0
v_readfirstlane_b32 s55,v125
s_sub_u32 s73,s73,1
s_max_i32 s73,s73,0
s_sub_u32 s77,s77,1
s_min_u32 s61,s73,3
s_cmp_gt_u32 s55,s54
s_cselect_b32 s60,2,1
s_cselect_b32 s77,s61,s77
s_cselect_b32 s54,s55,s54
s_cbranch_scc0 L_mo_288
s_bitset1_b64 s[84:85],s31
L_mo_288:
s_cmp_lg_u32 s31,63
s_cbranch_scc1 L_mo_289
s_min_i32 s77,s77,0
s_lshr_b64 s[88:89],s[84:85],1
s_lshr_b64 s[90:91],s[84:85],2
s_or_b64 s[88:89],s[88:89],s[90:91]
s_lshr_b64 s[90:91],s[84:85],3
s_or_b64 s[88:89],s[88:89],s[90:91]
s_lshr_b64 s[90:91],s[84:85],4
s_or_b64 s[88:89],s[88:89],s[90:91]
s_or_b32 s88,s88,268435455
s_or_b32 s89,s89,0
s_flbit_i32_b64 s61,s[84:85]
s_sub_u32 s61,63,s61
s_bfm_b64 s[90:91],s61,0
s_xor_b64 s[84:85],s[88:89],s[90:91]
s_or_b32 s84,s84,0
s_or_b32 s85,s85,4286578688
L_mo_289:
s_or_b32 s61,s47,s46
s_cmp_lg_u32 s61,0
s_cbranch_scc1 L_mo_284
v_mov_b32 v125,s60
s_lshl_b32 s59,s31,13
s_add_u32 s59,s59,10487040
buffer_store_dword v125,off,s[8:11],s59 sc1
s_cmp_lg_u32 s31,63
s_cbranch_scc1 L_mo_284
s_and_b32 s62,s54,0x7ff
s_sub_u32 s62,2048,s62
v_mov_b32 v120,s62
s_lshr_b64 s[88:89],s[84:85],0
s_and_b32 s88,s88,0x3fffff
s_bitset1_b32 s88,31
v_mov_b32 v121,s88
s_lshr_b64 s[88:89],s[84:85],22
s_and_b32 s88,s88,0x3fffff
s_bitset1_b32 s88,31
v_mov_b32 v122,s88
s_lshr_b64 s[88:89],s[84:85],44
s_and_b32 s88,s88,0x3fffff
s_bitset1_b32 s88,31
v_mov_b32 v123,s88
s_mov_b32 s59,11011712
buffer_store_dwordx4 v[120:123],off,s[8:11],s59 sc1
L_mo_284:
s_add_u32 s31,s31,1
s_cmp_gt_i32 s77,0
s_cbranch_scc1 L_mo_282
s_cmp_lg_u32 s77,0
s_cbranch_scc1 L_mo_286
s_waitcnt vmcnt(0)
s_barrier
s_or_b32 s72,s72,s52
buffer_store_dword v17,off,s[8:11],s72 sc1
s_mov_b32 s72,0x80000000
s_and_b32 s51,s54,0x7ff
s_sub_u32 s51,2047,s51
s_lshr_b32 s51,s51,5
s_add_u32 s73,s73,3
s_and_b32 s64,s54,0x7ff
s_sub_u32 s64,2047,s64
s_lshl_b32 s56,s64,10
s_add_u32 s58,s56,4194304
buffer_load_dwordx4 v[88:91],v0,s[8:11],s58 offen sc1
s_mov_b32 s4,s38
s_mov_b32 s5,s39
s_mov_b32 s6,1835008
s_mov_b32 s7,0x20000
v_and_b32 v9,15,v1
v_lshrrev_b32 v10,4,v1
v_lshlrev_b32 v8,14,v10
v_lshl_add_u32 v8,v9,4,v8
s_lshl_b32 s59,s47,16
s_lshl_b32 s60,s46,8
s_add_u32 s59,s59,s60
buffer_load_dwordx4 v[24:27],v8,s[4:7],s59 offen offset:0
buffer_load_dwordx4 v[28:31],v8,s[4:7],s59 offen offset:1024
buffer_load_dwordx4 v[32:35],v8,s[4:7],s59 offen offset:2048
buffer_load_dwordx4 v[36:39],v8,s[4:7],s59 offen offset:3072
s_add_u32 s59,s59,4096
buffer_load_dwordx4 v[40:43],v8,s[4:7],s59 offen offset:0
buffer_load_dwordx4 v[44:47],v8,s[4:7],s59 offen offset:1024
buffer_load_dwordx4 v[48:51],v8,s[4:7],s59 offen offset:2048
buffer_load_dwordx4 v[52:55],v8,s[4:7],s59 offen offset:3072
s_add_u32 s59,s59,4096
buffer_load_dwordx4 v[56:59],v8,s[4:7],s59 offen offset:0
buffer_load_dwordx4 v[60:63],v8,s[4:7],s59 offen offset:1024
buffer_load_dwordx4 v[64:67],v8,s[4:7],s59 offen offset:2048
buffer_load_dwordx4 v[68:71],v8,s[4:7],s59 offen offset:3072
s_add_u32 s59,s59,4096
buffer_load_dwordx4 v[72:75],v8,s[4:7],s59 offen offset:0
buffer_load_dwordx4 v[76:79],v8,s[4:7],s59 offen offset:1024
buffer_load_dwordx4 v[80:83],v8,s[4:7],s59 offen offset:2048
buffer_load_dwordx4 v[84:87],v8,s[4:7],s59 offen offset:3072
v_and_b32 v124,1,v1
v_lshlrev_b32 v124,4,v124
v_mov_b32 v125,0xffff
v_lshlrev_b32 v125,v124,v125
v_lshrrev_b32 v124,1,v9
v_cmp_eq_u32 vcc,0,v124
s_nop 1
v_cndmask_b32 v12,0,v125,vcc
v_cmp_eq_u32 vcc,1,v124
s_nop 1
v_cndmask_b32 v13,0,v125,vcc
v_cmp_eq_u32 vcc,2,v124
s_nop 1
v_cndmask_b32 v14,0,v125,vcc
v_cmp_eq_u32 vcc,3,v124
s_nop 1
v_cndmask_b32 v15,0,v125,vcc
s_waitcnt vmcnt(16)
L_mx_291:
v_max3_u32 v124,v88,v89,v90
v_max_u32 v124,v91,v124
v_cmp_eq_u32 vcc,-1,v124
s_cbranch_vccz L_mxd_292
buffer_load_dwordx4 v[88:91],v0,s[8:11],s58 offen sc1
s_sub_u32 s49,s49,1
s_cbranch_scc1 L_abort2
s_waitcnt vmcnt(0)
s_branch L_mx_291
L_mxd_292:
v_lshlrev_b32 v96,16,v88
v_and_b32 v97,0xffff0000,v88
v_lshlrev_b32 v98,16,v89
v_and_b32 v99,0xffff0000,v89
v_lshlrev_b32 v100,16,v90
v_and_b32 v101,0xffff0000,v90
v_lshlrev_b32 v102,16,v91
v_and_b32 v103,0xffff0000,v91
v_readfirstlane_b32 s78,v96
s_nop 1
v_pk_add_f32 v[108:109],v[96:97],s[78:79] op_sel_hi:[1,0] neg_lo:[0,1] neg_hi:[0,1]
v_pk_add_f32 v[110:111],v[98:99],s[78:79] op_sel_hi:[1,0] neg_lo:[0,1] neg_hi:[0,1]
v_pk_add_f32 v[112:113],v[100:101],s[78:79] op_sel_hi:[1,0] neg_lo:[0,1] neg_hi:[0,1]
v_pk_add_f32 v[114:115],v[102:103],s[78:79] op_sel_hi:[1,0] neg_lo:[0,1] neg_hi:[0,1]
v_pk_add_f32 v[116:117],v[108:109],v[110:111]
v_pk_mul_f32 v[118:119],v[108:109],v[108:109]
v_pk_add_f32 v[120:121],v[112:113],v[114:115]
v_pk_fma_f32 v[118:119],v[110:111],v[110:111],v[118:119]
v_pk_add_f32 v[116:117],v[116:117],v[120:121]
v_pk_fma_f32 v[118:119],v[112:113],v[112:113],v[118:119]
v_add_f32 v116,v116,v117
v_pk_fma_f32 v[118:119],v[114:115],v[114:115],v[118:119]
v_add_f32 v118,v118,v119
s_nop 1
v_permlane32_swap_b32 v116,v118
v_add_f32 v116,v116,v118
s_nop 1
v_add_f32_dpp v116,v116,v116 row_ror:8 row_mask:0xf bank_mask:0xf
s_nop 1
v_add_f32_dpp v116,v116,v116 row_ror:4 row_mask:0xf bank_mask:0xf
s_nop 1
v_add_f32_dpp v116,v116,v116 row_ror:2 row_mask:0xf bank_mask:0xf
s_nop 1
v_add_f32_dpp v116,v116,v116 row_ror:1 row_mask:0xf bank_mask:0xf
v_mov_b32 v118,v116
s_nop 1
v_permlane16_swap_b32 v116,v118
v_add_f32 v116,v116,v118
v_mul_f32 v116,0x3b000000,v116
v_mov_b32 v118,v116
s_nop 1
v_permlane32_swap_b32 v116,v118
v_fma_f32 v118,-v116,v116,v118
v_add_f32 v116,s78,v116
v_max_f32 v118,0,v118
v_cvt_pk_bf16_f32 v118,v116,v118
v_lshlrev_b32 v116,16,v118
v_and_b32 v118,0xffff0000,v118
v_add_f32 v118,0x3727c5ac,v118
v_cvt_pk_bf16_f32 v118,v118,v118
v_and_b32 v118,0xffff0000,v118
v_sqrt_f32 v118,v118
v_pk_add_f32 v[108:109],v[96:97],v[116:117] op_sel_hi:[1,0] neg_lo:[0,1] neg_hi:[0,1]
v_pk_add_f32 v[110:111],v[98:99],v[116:117] op_sel_hi:[1,0] neg_lo:[0,1] neg_hi:[0,1]
v_pk_add_f32 v[112:113],v[100:101],v[116:117] op_sel_hi:[1,0] neg_lo:[0,1] neg_hi:[0,1]
v_pk_add_f32 v[114:115],v[102:103],v[116:117] op_sel_hi:[1,0] neg_lo:[0,1] neg_hi:[0,1]
v_cvt_pk_bf16_f32 v118,v118,v118
v_and_b32 v118,0xffff0000,v118
v_rcp_f32 v118,v118
v_cvt_pk_bf16_f32 v104,v108,v109
v_cvt_pk_bf16_f32 v105,v110,v111
v_cvt_pk_bf16_f32 v106,v112,v113
v_cvt_pk_bf16_f32 v107,v114,v115
v_lshlrev_b32 v108,16,v104
v_and_b32 v109,0xffff0000,v104
v_lshlrev_b32 v110,16,v105
v_and_b32 v111,0xffff0000,v105
v_lshlrev_b32 v112,16,v106
v_and_b32 v113,0xffff0000,v106
v_lshlrev_b32 v114,16,v107
v_and_b32 v115,0xffff0000,v107
v_pk_mul_f32 v[108:109],v[108:109],v[118:119] op_sel_hi:[1,0]
v_pk_mul_f32 v[110:111],v[110:111],v[118:119] op_sel_hi:[1,0]
v_pk_mul_f32 v[112:113],v[112:113],v[118:119] op_sel_hi:[1,0]
v_pk_mul_f32 v[114:115],v[114:115],v[118:119] op_sel_hi:[1,0]
v_cvt_pk_bf16_f32 v104,v108,v109
v_cvt_pk_bf16_f32 v105,v110,v111
v_cvt_pk_bf16_f32 v106,v112,v113
v_cvt_pk_bf16_f32 v107,v114,v115
s_mov_b32 s58,0x01000100
s_mov_b32 s59,0x03020302
v_perm_b32 v88,v104,v104,s58
v_perm_b32 v89,v104,v104,s59
v_perm_b32 v90,v105,v105,s58
v_perm_b32 v91,v105,v105,s59
v_perm_b32 v92,v106,v106,s58
v_perm_b32 v93,v106,v106,s59
v_perm_b32 v94,v107,v107,s58
v_perm_b32 v95,v107,v107,s59
v_lshlrev_b32 v8,5,v1
s_lshl_b32 s58,s46,11
s_add_u32 s58,s58,139264
v_add_u32 v8,s58,v8
ds_write_b128 v8,v[88:91]
ds_write_b128 v8,v[92:95] offset:16
s_lshl_b32 s59,s46,9
s_add_u32 s59,s58,s59
v_lshlrev_b32 v8,7,v10
v_add_u32 v8,s59,v8
s_waitcnt lgkmcnt(0)
ds_read_b128 v[108:111],v18 offset:0
ds_read_b128 v[88:91],v8 offset:0
ds_read_b128 v[92:95],v8 offset:16
ds_read_b128 v[112:115],v18 offset:1024
s_waitcnt lgkmcnt(1)
v_and_b32 v124,v12,v88
v_and_b32 v125,v13,v88
v_and_b32 v126,v14,v88
v_and_b32 v127,v15,v88
s_nop 1
v_mfma_f32_16x16x32_bf16 v[116:119],v[124:127],v[108:111],0
ds_read_b128 v[108:111],v18 offset:2048
s_waitcnt lgkmcnt(1)
v_and_b32 v124,v12,v89
v_and_b32 v125,v13,v89
v_and_b32 v126,v14,v89
v_and_b32 v127,v15,v89
s_nop 1
v_mfma_f32_16x16x32_bf16 v[116:119],v[124:127],v[112:115],v[116:119]
ds_read_b128 v[112:115],v18 offset:3072
s_waitcnt lgkmcnt(1)
v_and_b32 v124,v12,v90
v_and_b32 v125,v13,v90
v_and_b32 v126,v14,v90
v_and_b32 v127,v15,v90
s_nop 1
v_mfma_f32_16x16x32_bf16 v[116:119],v[124:127],v[108:111],v[116:119]
ds_read_b128 v[108:111],v18 offset:4096
s_waitcnt lgkmcnt(1)
v_and_b32 v124,v12,v91
v_and_b32 v125,v13,v91
v_and_b32 v126,v14,v91
v_and_b32 v127,v15,v91
s_nop 1
v_mfma_f32_16x16x32_bf16 v[116:119],v[124:127],v[112:115],v[116:119]
ds_read_b128 v[112:115],v18 offset:5120
s_waitcnt lgkmcnt(1)
v_and_b32 v124,v12,v92
v_and_b32 v125,v13,v92
v_and_b32 v126,v14,v92
v_and_b32 v127,v15,v92
s_nop 1
v_mfma_f32_16x16x32_bf16 v[116:119],v[124:127],v[108:111],v[116:119]
ds_read_b128 v[108:111],v18 offset:6144
s_waitcnt lgkmcnt(1)
v_and_b32 v124,v12,v93
v_and_b32 v125,v13,v93
v_and_b32 v126,v14,v93
v_and_b32 v127,v15,v93
s_nop 1
v_mfma_f32_16x16x32_bf16 v[116:119],v[124:127],v[112:115],v[116:119]
ds_read_b128 v[112:115],v18 offset:7168
s_waitcnt lgkmcnt(1)
v_and_b32 v124,v12,v94
v_and_b32 v125,v13,v94
v_and_b32 v126,v14,v94
v_and_b32 v127,v15,v94
s_nop 1
v_mfma_f32_16x16x32_bf16 v[116:119],v[124:127],v[108:111],v[116:119]
ds_read_b128 v[108:111],v18 offset:8192
s_waitcnt lgkmcnt(1)
v_and_b32 v124,v12,v95
v_and_b32 v125,v13,v95
v_and_b32 v126,v14,v95
v_and_b32 v127,v15,v95
s_nop 1
v_mfma_f32_16x16x32_bf16 v[116:119],v[124:127],v[112:115],v[116:119]
ds_read_b128 v[88:91],v8 offset:32
ds_read_b128 v[92:95],v8 offset:48
ds_read_b128 v[112:115],v18 offset:9216
s_waitcnt lgkmcnt(1)
v_and_b32 v124,v12,v88
v_and_b32 v125,v13,v88
v_and_b32 v126,v14,v88
v_and_b32 v127,v15,v88
s_nop 1
v_mfma_f32_16x16x32_bf16 v[116:119],v[124:127],v[108:111],v[116:119]
ds_read_b128 v[108:111],v18 offset:10240
s_waitcnt lgkmcnt(1)
v_and_b32 v124,v12,v89
v_and_b32 v125,v13,v89
v_and_b32 v126,v14,v89
v_and_b32 v127,v15,v89
s_nop 1
v_mfma_f32_16x16x32_bf16 v[116:119],v[124:127],v[112:115],v[116:119]
ds_read_b128 v[112:115],v18 offset:11264
s_waitcnt lgkmcnt(1)
v_and_b32 v124,v12,v90
v_and_b32 v125,v13,v90
v_and_b32 v126,v14,v90
v_and_b32 v127,v15,v90
s_nop 1
v_mfma_f32_16x16x32_bf16 v[116:119],v[124:127],v[108:111],v[116:119]
ds_read_b128 v[108:111],v18 offset:12288
s_waitcnt lgkmcnt(1)
v_and_b32 v124,v12,v91
v_and_b32 v125,v13,v91
v_and_b32 v126,v14,v91
v_and_b32 v127,v15,v91
s_nop 1
v_mfma_f32_16x16x32_bf16 v[116:119],v[124:127],v[112:115],v[116:119]
ds_read_b128 v[112:115],v18 offset:13312
s_waitcnt lgkmcnt(1)
v_and_b32 v124,v12,v92
v_and_b32 v125,v13,v92
v_and_b32 v126,v14,v92
v_and_b32 v127,v15,v92
s_nop 1
v_mfma_f32_16x16x32_bf16 v[116:119],v[124:127],v[108:111],v[116:119]
ds_read_b128 v[108:111],v18 offset:14336
s_waitcnt lgkmcnt(1)
v_and_b32 v124,v12,v93
v_and_b32 v125,v13,v93
v_and_b32 v126,v14,v93
v_and_b32 v127,v15,v93
s_nop 1
v_mfma_f32_16x16x32_bf16 v[116:119],v[124:127],v[112:115],v[116:119]
ds_read_b128 v[112:115],v18 offset:15360
s_waitcnt lgkmcnt(1)
v_and_b32 v124,v12,v94
v_and_b32 v125,v13,v94
v_and_b32 v126,v14,v94
v_and_b32 v127,v15,v94
s_nop 1
v_mfma_f32_16x16x32_bf16 v[116:119],v[124:127],v[108:111],v[116:119]
ds_read_b128 v[108:111],v18 offset:16384
s_waitcnt lgkmcnt(1)
v_and_b32 v124,v12,v95
v_and_b32 v125,v13,v95
v_and_b32 v126,v14,v95
v_and_b32 v127,v15,v95
s_nop 1
v_mfma_f32_16x16x32_bf16 v[116:119],v[124:127],v[112:115],v[116:119]
ds_read_b128 v[88:91],v8 offset:64
ds_read_b128 v[92:95],v8 offset:80
ds_read_b128 v[112:115],v18 offset:17408
s_waitcnt lgkmcnt(1)
v_and_b32 v124,v12,v88
v_and_b32 v125,v13,v88
v_and_b32 v126,v14,v88
v_and_b32 v127,v15,v88
s_nop 1
v_mfma_f32_16x16x32_bf16 v[116:119],v[124:127],v[108:111],v[116:119]
ds_read_b128 v[108:111],v18 offset:18432
s_waitcnt lgkmcnt(1)
v_and_b32 v124,v12,v89
v_and_b32 v125,v13,v89
v_and_b32 v126,v14,v89
v_and_b32 v127,v15,v89
s_nop 1
v_mfma_f32_16x16x32_bf16 v[116:119],v[124:127],v[112:115],v[116:119]
ds_read_b128 v[112:115],v18 offset:19456
s_waitcnt lgkmcnt(1)
v_and_b32 v124,v12,v90
v_and_b32 v125,v13,v90
v_and_b32 v126,v14,v90
v_and_b32 v127,v15,v90
s_nop 1
v_mfma_f32_16x16x32_bf16 v[116:119],v[124:127],v[108:111],v[116:119]
ds_read_b128 v[108:111],v18 offset:20480
s_waitcnt lgkmcnt(1)
v_and_b32 v124,v12,v91
v_and_b32 v125,v13,v91
v_and_b32 v126,v14,v91
v_and_b32 v127,v15,v91
s_nop 1
v_mfma_f32_16x16x32_bf16 v[116:119],v[124:127],v[112:115],v[116:119]
ds_read_b128 v[112:115],v18 offset:21504
s_waitcnt lgkmcnt(1)
v_and_b32 v124,v12,v92
v_and_b32 v125,v13,v92
v_and_b32 v126,v14,v92
v_and_b32 v127,v15,v92
s_nop 1
v_mfma_f32_16x16x32_bf16 v[116:119],v[124:127],v[108:111],v[116:119]
ds_read_b128 v[108:111],v18 offset:22528
s_waitcnt lgkmcnt(1)
v_and_b32 v124,v12,v93
v_and_b32 v125,v13,v93
v_and_b32 v126,v14,v93
v_and_b32 v127,v15,v93
s_nop 1
v_mfma_f32_16x16x32_bf16 v[116:119],v[124:127],v[112:115],v[116:119]
ds_read_b128 v[112:115],v18 offset:23552
s_waitcnt lgkmcnt(1)
v_and_b32 v124,v12,v94
v_and_b32 v125,v13,v94
v_and_b32 v126,v14,v94
v_and_b32 v127,v15,v94
s_nop 1
v_mfma_f32_16x16x32_bf16 v[116:119],v[124:127],v[108:111],v[116:119]
ds_read_b128 v[108:111],v18 offset:24576
s_waitcnt lgkmcnt(1)
v_and_b32 v124,v12,v95
v_and_b32 v125,v13,v95
v_and_b32 v126,v14,v95
v_and_b32 v127,v15,v95
s_nop 1
v_mfma_f32_16x16x32_bf16 v[116:119],v[124:127],v[112:115],v[116:119]
ds_read_b128 v[88:91],v8 offset:96
ds_read_b128 v[92:95],v8 offset:112
ds_read_b128 v[112:115],v18 offset:25600
s_waitcnt lgkmcnt(1)
v_and_b32 v124,v12,v88
v_and_b32 v125,v13,v88
v_and_b32 v126,v14,v88
v_and_b32 v127,v15,v88
s_nop 1
v_mfma_f32_16x16x32_bf16 v[116:119],v[124:127],v[108:111],v[116:119]
ds_read_b128 v[108:111],v18 offset:26624
s_waitcnt lgkmcnt(1)
v_and_b32 v124,v12,v89
v_and_b32 v125,v13,v89
v_and_b32 v126,v14,v89
v_and_b32 v127,v15,v89
s_nop 1
v_mfma_f32_16x16x32_bf16 v[116:119],v[124:127],v[112:115],v[116:119]
ds_read_b128 v[112:115],v18 offset:27648
s_waitcnt lgkmcnt(1)
v_and_b32 v124,v12,v90
v_and_b32 v125,v13,v90
v_and_b32 v126,v14,v90
v_and_b32 v127,v15,v90
s_nop 1
v_mfma_f32_16x16x32_bf16 v[116:119],v[124:127],v[108:111],v[116:119]
ds_read_b128 v[108:111],v18 offset:28672
s_waitcnt lgkmcnt(1)
v_and_b32 v124,v12,v91
v_and_b32 v125,v13,v91
v_and_b32 v126,v14,v91
v_and_b32 v127,v15,v91
s_nop 1
v_mfma_f32_16x16x32_bf16 v[116:119],v[124:127],v[112:115],v[116:119]
ds_read_b128 v[112:115],v18 offset:29696
s_waitcnt lgkmcnt(1)
v_and_b32 v124,v12,v92
v_and_b32 v125,v13,v92
v_and_b32 v126,v14,v92
v_and_b32 v127,v15,v92
s_nop 1
v_mfma_f32_16x16x32_bf16 v[116:119],v[124:127],v[108:111],v[116:119]
ds_read_b128 v[108:111],v18 offset:30720
s_waitcnt lgkmcnt(1)
v_and_b32 v124,v12,v93
v_and_b32 v125,v13,v93
v_and_b32 v126,v14,v93
v_and_b32 v127,v15,v93
s_nop 1
v_mfma_f32_16x16x32_bf16 v[116:119],v[124:127],v[112:115],v[116:119]
ds_read_b128 v[112:115],v18 offset:31744
s_waitcnt lgkmcnt(1)
v_and_b32 v124,v12,v94
v_and_b32 v125,v13,v94
v_and_b32 v126,v14,v94
v_and_b32 v127,v15,v94
s_nop 1
v_mfma_f32_16x16x32_bf16 v[116:119],v[124:127],v[108:111],v[116:119]
s_waitcnt lgkmcnt(0)
v_and_b32 v124,v12,v95
v_and_b32 v125,v13,v95
v_and_b32 v126,v14,v95
v_and_b32 v127,v15,v95
s_nop 1
v_mfma_f32_16x16x32_bf16 v[116:119],v[124:127],v[112:115],v[116:119]
v_lshlrev_b32 v8,5,v9
v_and_b32 v124,1,v10
v_lshl_add_u32 v8,v124,4,v8
v_lshrrev_b32 v124,1,v10
v_lshl_add_u32 v8,v124,11,v8
s_lshl_b32 s60,s46,9
s_add_u32 s60,s60,147456
v_add_u32 v8,s60,v8
ds_write_b128 v8,v[116:119]
v_lshlrev_b32 v8,2,v1
v_add_u32 v8,147456,v8
s_waitcnt lgkmcnt(0)
s_barrier
ds_read2st64_b32 v[88:89],v8 offset0:0 offset1:1
ds_read2st64_b32 v[90:91],v8 offset0:2 offset1:3
ds_read2st64_b32 v[92:93],v8 offset0:4 offset1:5
ds_read2st64_b32 v[94:95],v8 offset0:6 offset1:7
s_waitcnt lgkmcnt(0)
v_pk_add_f32 v[88:89],v[88:89],v[90:91]
v_pk_add_f32 v[92:93],v[92:93],v[94:95]
v_pk_add_f32 v[88:89],v[88:89],v[92:93]
v_cvt_pk_bf16_f32 v88,v88,v88
v_and_b32 v88,0xffff0000,v88
v_cvt_pk_bf16_f32 v89,v89,v89
v_and_b32 v89,0xffff0000,v89
v_mul_f32 v90,0xbfb8aa3b,v88
v_exp_f32 v90,v90
s_nop 0
v_add_f32 v90,1.0,v90
v_rcp_f32 v90,v90
s_nop 0
v_mul_f32 v88,v88,v90
v_cvt_pk_bf16_f32 v88,v88,v88
v_and_b32 v88,0xffff0000,v88
v_mul_f32 v88,v88,v89
v_cvt_pk_bf16_f32 v88,v88,v88
v_lshlrev_b32 v8,2,v1
v_add_u32 v8,s58,v8
ds_write_b32 v8,v88
v_lshlrev_b32 v8,6,v10
v_add_u32 v8,s58,v8
s_waitcnt lgkmcnt(0)
ds_read_b128 v[88:91],v8
ds_read_b128 v[92:95],v8 offset:16
ds_read_b128 v[108:111],v8 offset:32
ds_read_b128 v[112:115],v8 offset:48
s_waitcnt vmcnt(0) lgkmcnt(0)
v_and_b32 v124,v12,v88
v_and_b32 v125,v13,v88
v_and_b32 v126,v14,v88
v_and_b32 v127,v15,v88
s_nop 1
v_mfma_f32_16x16x32_bf16 v[116:119],v[124:127],v[24:27],0
v_and_b32 v124,v12,v89
v_and_b32 v125,v13,v89
v_and_b32 v126,v14,v89
v_and_b32 v127,v15,v89
s_nop 1
v_mfma_f32_16x16x32_bf16 v[116:119],v[124:127],v[28:31],v[116:119]
v_and_b32 v124,v12,v90
v_and_b32 v125,v13,v90
v_and_b32 v126,v14,v90
v_and_b32 v127,v15,v90
s_nop 1
v_mfma_f32_16x16x32_bf16 v[116:119],v[124:127],v[32:35],v[116:119]
v_and_b32 v124,v12,v91
v_and_b32 v125,v13,v91
v_and_b32 v126,v14,v91
v_and_b32 v127,v15,v91
s_nop 1
v_mfma_f32_16x16x32_bf16 v[116:119],v[124:127],v[36:39],v[116:119]
v_and_b32 v124,v12,v92
v_and_b32 v125,v13,v92
v_and_b32 v126,v14,v92
v_and_b32 v127,v15,v92
s_nop 1
v_mfma_f32_16x16x32_bf16 v[116:119],v[124:127],v[40:43],v[116:119]
v_and_b32 v124,v12,v93
v_and_b32 v125,v13,v93
v_and_b32 v126,v14,v93
v_and_b32 v127,v15,v93
s_nop 1
v_mfma_f32_16x16x32_bf16 v[116:119],v[124:127],v[44:47],v[116:119]
v_and_b32 v124,v12,v94
v_and_b32 v125,v13,v94
v_and_b32 v126,v14,v94
v_and_b32 v127,v15,v94
s_nop 1
v_mfma_f32_16x16x32_bf16 v[116:119],v[124:127],v[48:51],v[116:119]
v_and_b32 v124,v12,v95
v_and_b32 v125,v13,v95
v_and_b32 v126,v14,v95
v_and_b32 v127,v15,v95
s_nop 1
v_mfma_f32_16x16x32_bf16 v[116:119],v[124:127],v[52:55],v[116:119]
v_and_b32 v124,v12,v108
v_and_b32 v125,v13,v108
v_and_b32 v126,v14,v108
v_and_b32 v127,v15,v108
s_nop 1
v_mfma_f32_16x16x32_bf16 v[116:119],v[124:127],v[56:59],v[116:119]
v_and_b32 v124,v12,v109
v_and_b32 v125,v13,v109
v_and_b32 v126,v14,v109
v_and_b32 v127,v15,v109
s_nop 1
v_mfma_f32_16x16x32_bf16 v[116:119],v[124:127],v[60:63],v[116:119]
v_and_b32 v124,v12,v110
v_and_b32 v125,v13,v110
v_and_b32 v126,v14,v110
v_and_b32 v127,v15,v110
s_nop 1
v_mfma_f32_16x16x32_bf16 v[116:119],v[124:127],v[64:67],v[116:119]
v_and_b32 v124,v12,v111
v_and_b32 v125,v13,v111
v_and_b32 v126,v14,v111
v_and_b32 v127,v15,v111
s_nop 1
v_mfma_f32_16x16x32_bf16 v[116:119],v[124:127],v[68:71],v[116:119]
v_and_b32 v124,v12,v112
v_and_b32 v125,v13,v112
v_and_b32 v126,v14,v112
v_and_b32 v127,v15,v112
s_nop 1
v_mfma_f32_16x16x32_bf16 v[116:119],v[124:127],v[72:75],v[116:119]
v_and_b32 v124,v12,v113
v_and_b32 v125,v13,v113
v_and_b32 v126,v14,v113
v_and_b32 v127,v15,v113
s_nop 1
v_mfma_f32_16x16x32_bf16 v[116:119],v[124:127],v[76:79],v[116:119]
v_and_b32 v124,v12,v114
v_and_b32 v125,v13,v114
v_and_b32 v126,v14,v114
v_and_b32 v127,v15,v114
s_nop 1
v_mfma_f32_16x16x32_bf16 v[116:119],v[124:127],v[80:83],v[116:119]
v_and_b32 v124,v12,v115
v_and_b32 v125,v13,v115
v_and_b32 v126,v14,v115
v_and_b32 v127,v15,v115
s_nop 1
v_mfma_f32_16x16x32_bf16 v[116:119],v[124:127],v[84:87],v[116:119]
v_lshlrev_b32 v8,4,v9
v_and_b32 v124,1,v10
v_lshl_add_u32 v8,v124,3,v8
v_and_b32 v124,2,v10
v_lshl_add_u32 v8,v124,30,v8
s_lshl_b32 s65,s51,15
s_add_u32 s65,s65,92274688
s_lshl_b32 s59,s47,10
s_lshl_b32 s60,s46,8
s_add_u32 s59,s59,s60
s_add_u32 s59,s59,s65
v_cvt_pk_bf16_f32 v24,v116,v117
v_cvt_pk_bf16_f32 v25,v118,v119
buffer_store_dwordx2 v[24:25],v8,s[8:11],s59 offen sc1
s_lshl_b32 s59,s51,13
s_lshl2_add_u32 s59,s47,s59
s_add_u32 s59,s59,10486912
s_waitcnt vmcnt(0)
s_barrier
s_or_b32 s59,s59,s52
buffer_store_dword v17,off,s[8:11],s59 sc1
s_lshl_b32 s59,s51,13
s_add_u32 s59,s59,10486912
v_and_b32 v124,31,v1
v_lshlrev_b32 v124,2,v124
L_fw_294:
buffer_load_dword v125,v124,s[8:11],s59 offen sc1
s_sub_u32 s49,s49,1
s_cbranch_scc1 L_abort2
s_waitcnt vmcnt(0)
v_cmp_eq_u32 vcc,0,v125
s_cbranch_vccnz L_fw_294
s_add_u32 s63,s65,0
buffer_load_dwordx4 v[24:27],v22,s[8:11],s63 offen sc1
s_add_u32 s63,s65,4096
buffer_load_dwordx4 v[28:31],v22,s[8:11],s63 offen sc1
s_add_u32 s63,s65,8192
buffer_load_dwordx4 v[32:35],v22,s[8:11],s63 offen sc1
s_add_u32 s63,s65,12288
buffer_load_dwordx4 v[36:39],v22,s[8:11],s63 offen sc1
s_add_u32 s63,s65,16384
buffer_load_dwordx4 v[40:43],v22,s[8:11],s63 offen sc1
s_add_u32 s63,s65,20480
buffer_load_dwordx4 v[44:47],v22,s[8:11],s63 offen sc1
s_add_u32 s63,s65,24576
buffer_load_dwordx4 v[48:51],v22,s[8:11],s63 offen sc1
s_add_u32 s63,s65,28672
buffer_load_dwordx4 v[52:55],v22,s[8:11],s63 offen sc1
v_and_b32 v64,15,v1
v_and_b32 v65,1,v1
v_lshlrev_b32 v65,4,v65
v_mov_b32 v66,0x3f80
v_lshlrev_b32 v66,v65,v66
v_lshrrev_b32 v64,1,v64
v_cmp_eq_u32 vcc,0,v64
s_nop 1
v_cndmask_b32 v56,0,v66,vcc
v_cmp_eq_u32 vcc,1,v64
s_nop 1
v_cndmask_b32 v57,0,v66,vcc
v_cmp_eq_u32 vcc,2,v64
s_nop 1
v_cndmask_b32 v58,0,v66,vcc
v_cmp_eq_u32 vcc,3,v64
s_nop 1
v_cndmask_b32 v59,0,v66,vcc
s_waitcnt vmcnt(7)
s_nop 0
v_mfma_f32_16x16x32_bf16 v[60:63],v[56:59],v[24:27],0
s_waitcnt vmcnt(6)
v_mfma_f32_16x16x32_bf16 v[60:63],v[56:59],v[28:31],v[60:63]
s_waitcnt vmcnt(5)
v_mfma_f32_16x16x32_bf16 v[60:63],v[56:59],v[32:35],v[60:63]
s_waitcnt vmcnt(4)
v_mfma_f32_16x16x32_bf16 v[60:63],v[56:59],v[36:39],v[60:63]
s_waitcnt vmcnt(3)
v_mfma_f32_16x16x32_bf16 v[60:63],v[56:59],v[40:43],v[60:63]
s_waitcnt vmcnt(2)
v_mfma_f32_16x16x32_bf16 v[60:63],v[56:59],v[44:47],v[60:63]
s_waitcnt vmcnt(1)
v_mfma_f32_16x16x32_bf16 v[60:63],v[56:59],v[48:51],v[60:63]
s_waitcnt vmcnt(0)
v_mfma_f32_16x16x32_bf16 v[60:63],v[56:59],v[52:55],v[60:63]
s_nop 7
ds_write_b128 v21,v[60:63]
s_waitcnt lgkmcnt(0)
s_barrier
s_cmp_lg_u32 s46,0
s_cbranch_scc1 L_moed_293
v_lshlrev_b32 v56,5,v1
v_add_u32 v56,155648,v56
ds_read_b128 v[24:27],v56
ds_read_b128 v[28:31],v56 offset:16
s_and_b32 s59,s54,0xffff0000
s_xor_b32 s60,s59,0x80000000
s_xor_b32 s61,s59,0xffff0000
s_cmp_lt_i32 s59,0
s_cselect_b32 s59,s60,s61
v_mov_b32 v56,s59
v_mul_f32 v56,0xbfb8aa3b,v56
v_exp_f32 v56,v56
s_nop 0
v_add_f32 v56,1.0,v56
v_rcp_f32 v56,v56
s_nop 0
v_cvt_pk_bf16_f32 v56,v56,v56
v_and_b32 v56,0xffff0000,v56
v_lshlrev_b32 v48,16,v104
v_and_b32 v49,0xffff0000,v104
v_lshlrev_b32 v50,16,v105
v_and_b32 v51,0xffff0000,v105
v_lshlrev_b32 v52,16,v106
v_and_b32 v53,0xffff0000,v106
v_lshlrev_b32 v54,16,v107
v_and_b32 v55,0xffff0000,v107
s_waitcnt lgkmcnt(0)
v_cvt_pk_bf16_f32 v40,v24,v25
v_cvt_pk_bf16_f32 v41,v26,v27
v_cvt_pk_bf16_f32 v42,v28,v29
v_cvt_pk_bf16_f32 v43,v30,v31
v_lshlrev_b32 v24,16,v40
v_and_b32 v25,0xffff0000,v40
v_lshlrev_b32 v26,16,v41
v_and_b32 v27,0xffff0000,v41
v_lshlrev_b32 v28,16,v42
v_and_b32 v29,0xffff0000,v42
v_lshlrev_b32 v30,16,v43
v_and_b32 v31,0xffff0000,v43
v_mul_f32 v24,v24,v56
v_mul_f32 v25,v25,v56
v_mul_f32 v26,v26,v56
v_mul_f32 v27,v27,v56
v_mul_f32 v28,v28,v56
v_mul_f32 v29,v29,v56
v_mul_f32 v30,v30,v56
v_mul_f32 v31,v31,v56
v_cvt_pk_bf16_f32 v40,v24,v25
v_cvt_pk_bf16_f32 v41,v26,v27
v_cvt_pk_bf16_f32 v42,v28,v29
v_cvt_pk_bf16_f32 v43,v30,v31
v_lshlrev_b32 v24,16,v40
v_and_b32 v25,0xffff0000,v40
v_lshlrev_b32 v26,16,v41
v_and_b32 v27,0xffff0000,v41
v_lshlrev_b32 v28,16,v42
v_and_b32 v29,0xffff0000,v42
v_lshlrev_b32 v30,16,v43
v_and_b32 v31,0xffff0000,v43
v_add_f32 v24,v24,v48
v_add_f32 v25,v25,v49
v_add_f32 v26,v26,v50
v_add_f32 v27,v27,v51
v_add_f32 v28,v28,v52
v_add_f32 v29,v29,v53
v_add_f32 v30,v30,v54
v_add_f32 v31,v31,v55
v_cvt_pk_bf16_f32 v40,v24,v25
v_cvt_pk_bf16_f32 v41,v26,v27
v_cvt_pk_bf16_f32 v42,v28,v29
v_cvt_pk_bf16_f32 v43,v30,v31
v_lshlrev_b32 v24,16,v40
v_and_b32 v25,0xffff0000,v40
v_lshlrev_b32 v26,16,v41
v_and_b32 v27,0xffff0000,v41
v_lshlrev_b32 v28,16,v42
v_and_b32 v29,0xffff0000,v42
v_lshlrev_b32 v30,16,v43
v_and_b32 v31,0xffff0000,v43
v_add_f32 v96,v96,v24
v_add_f32 v97,v97,v25
v_add_f32 v98,v98,v26
v_add_f32 v99,v99,v27
v_add_f32 v100,v100,v28
v_add_f32 v101,v101,v29
v_add_f32 v102,v102,v30
v_add_f32 v103,v103,v31
v_cvt_pk_bf16_f32 v80,v96,v97
v_cvt_pk_bf16_f32 v81,v98,v99
v_cvt_pk_bf16_f32 v82,v100,v101
v_cvt_pk_bf16_f32 v83,v102,v103
s_lshl_b32 s58,s51,10
s_add_u32 s58,s58,11272192
buffer_store_dwordx4 v[80:83],v0,s[8:11],s58 offen sc1
v_lshlrev_b32 v96,16,v80
v_and_b32 v97,0xffff0000,v80
v_lshlrev_b32 v98,16,v81
v_and_b32 v99,0xffff0000,v81
v_lshlrev_b32 v100,16,v82
v_and_b32 v101,0xffff0000,v82
v_lshlrev_b32 v102,16,v83
v_and_b32 v103,0xffff0000,v83
v_readfirstlane_b32 s78,v96
s_nop 1
v_pk_add_f32 v[58:59],v[96:97],s[78:79] op_sel_hi:[1,0] neg_lo:[0,1] neg_hi:[0,1]
v_pk_add_f32 v[60:61],v[98:99],s[78:79] op_sel_hi:[1,0] neg_lo:[0,1] neg_hi:[0,1]
v_pk_add_f32 v[62:63],v[100:101],s[78:79] op_sel_hi:[1,0] neg_lo:[0,1] neg_hi:[0,1]
v_pk_add_f32 v[64:65],v[102:103],s[78:79] op_sel_hi:[1,0] neg_lo:[0,1] neg_hi:[0,1]
v_pk_add_f32 v[66:67],v[58:59],v[60:61]
v_pk_mul_f32 v[68:69],v[58:59],v[58:59]
v_pk_add_f32 v[70:71],v[62:63],v[64:65]
v_pk_fma_f32 v[68:69],v[60:61],v[60:61],v[68:69]
v_pk_add_f32 v[66:67],v[66:67],v[70:71]
v_pk_fma_f32 v[68:69],v[62:63],v[62:63],v[68:69]
v_add_f32 v66,v66,v67
v_pk_fma_f32 v[68:69],v[64:65],v[64:65],v[68:69]
v_add_f32 v68,v68,v69
s_nop 1
v_permlane32_swap_b32 v66,v68
v_add_f32 v66,v66,v68
s_nop 1
v_add_f32_dpp v66,v66,v66 row_ror:8 row_mask:0xf bank_mask:0xf
s_nop 1
v_add_f32_dpp v66,v66,v66 row_ror:4 row_mask:0xf bank_mask:0xf
s_nop 1
v_add_f32_dpp v66,v66,v66 row_ror:2 row_mask:0xf bank_mask:0xf
s_nop 1
v_add_f32_dpp v66,v66,v66 row_ror:1 row_mask:0xf bank_mask:0xf
v_mov_b32 v68,v66
s_nop 1
v_permlane16_swap_b32 v66,v68
v_add_f32 v66,v66,v68
v_mul_f32 v66,0x3b000000,v66
v_mov_b32 v68,v66
s_nop 1
v_permlane32_swap_b32 v66,v68
v_fma_f32 v68,-v66,v66,v68
v_add_f32 v66,s78,v66
v_max_f32 v68,0,v68
v_cvt_pk_bf16_f32 v68,v66,v68
v_lshlrev_b32 v66,16,v68
v_and_b32 v68,0xffff0000,v68
v_add_f32 v68,0x3727c5ac,v68
v_cvt_pk_bf16_f32 v68,v68,v68
v_and_b32 v68,0xffff0000,v68
v_sqrt_f32 v68,v68
v_pk_add_f32 v[58:59],v[96:97],v[66:67] op_sel_hi:[1,0] neg_lo:[0,1] neg_hi:[0,1]
v_pk_add_f32 v[60:61],v[98:99],v[66:67] op_sel_hi:[1,0] neg_lo:[0,1] neg_hi:[0,1]
v_pk_add_f32 v[62:63],v[100:101],v[66:67] op_sel_hi:[1,0] neg_lo:[0,1] neg_hi:[0,1]
v_pk_add_f32 v[64:65],v[102:103],v[66:67] op_sel_hi:[1,0] neg_lo:[0,1] neg_hi:[0,1]
v_cvt_pk_bf16_f32 v68,v68,v68
v_and_b32 v68,0xffff0000,v68
v_rcp_f32 v68,v68
v_cvt_pk_bf16_f32 v84,v58,v59
v_cvt_pk_bf16_f32 v85,v60,v61
v_cvt_pk_bf16_f32 v86,v62,v63
v_cvt_pk_bf16_f32 v87,v64,v65
v_lshlrev_b32 v58,16,v84
v_and_b32 v59,0xffff0000,v84
v_lshlrev_b32 v60,16,v85
v_and_b32 v61,0xffff0000,v85
v_lshlrev_b32 v62,16,v86
v_and_b32 v63,0xffff0000,v86
v_lshlrev_b32 v64,16,v87
v_and_b32 v65,0xffff0000,v87
v_pk_mul_f32 v[58:59],v[58:59],v[68:69] op_sel_hi:[1,0]
v_pk_mul_f32 v[60:61],v[60:61],v[68:69] op_sel_hi:[1,0]
v_pk_mul_f32 v[62:63],v[62:63],v[68:69] op_sel_hi:[1,0]
v_pk_mul_f32 v[64:65],v[64:65],v[68:69] op_sel_hi:[1,0]
v_cvt_pk_bf16_f32 v84,v58,v59
v_cvt_pk_bf16_f32 v85,v60,v61
v_cvt_pk_bf16_f32 v86,v62,v63
v_cvt_pk_bf16_f32 v87,v64,v65
s_add_u32 s57,s56,98566144
buffer_store_dwordx4 v[84:87],v0,s[8:11],s57 offen sc1
L_moed_293:
s_and_b32 s56,s54,31
s_sub_u32 s56,31,s56
v_lshrrev_b32 v2,10,v20
v_add_u32 v3,16,v2
v_add_u32 v8,96468992,v20
v_cmp_eq_u32 vcc,s56,v2
s_nop 1
v_cndmask_b32 v2,v20,v8,vcc
v_cmp_eq_u32 vcc,s56,v3
s_nop 1
v_cndmask_b32 v3,v20,v8,vcc
s_lshl_b32 s59,s51,13
s_add_u32 s59,s59,10487552
v_and_b32 v124,31,v1
v_lshlrev_b32 v124,2,v124
L_fw_295:
buffer_load_dword v125,v124,s[8:11],s59 offen sc1
s_sub_u32 s49,s49,1
s_cbranch_scc1 L_abort2
s_waitcnt vmcnt(0)
v_cmp_eq_u32 vcc,0,v125
s_cbranch_vccnz L_fw_295
s_barrier
s_lshl_b32 s66,s51,15
s_add_u32 s66,s66,2097152
s_add_u32 s67,s66,16384
s_add_u32 m0,s50,131072
s_nop 0
buffer_load_dwordx4 v2,s[8:11],s66 offen offset:0 sc1 lds
s_add_u32 m0,s50,135168
s_nop 0
buffer_load_dwordx4 v3,s[8:11],s67 offen offset:0 sc1 lds
s_add_u32 m0,s50,139008
s_nop 0
buffer_load_dwordx4 v2,s[8:11],s66 offen offset:256 sc1 lds
s_add_u32 m0,s50,143104
s_nop 0
buffer_load_dwordx4 v3,s[8:11],s67 offen offset:256 sc1 lds
s_add_u32 m0,s50,146944
s_nop 0
buffer_load_dwordx4 v2,s[8:11],s66 offen offset:512 sc1 lds
s_add_u32 m0,s50,151040
s_nop 0
buffer_load_dwordx4 v3,s[8:11],s67 offen offset:512 sc1 lds
s_lshl_b32 s58,s51,5
s_add_u32 s58,s58,s47
s_mul_i32 s58,s58,24576
s_add_u32 s58,s58,201326592
s_add_u32 s61,s58,s50
s_add_u32 s62,s61,4096
s_add_u32 s63,s61,16384
s_add_u32 s64,s61,20480
s_add_u32 s65,s61,s50
s_add_u32 s65,s65,8192
s_waitcnt vmcnt(4)
s_barrier
ds_read_b128 v[104:107],v4 offset:0
ds_read_b128 v[108:111],v4 offset:4096
ds_read_b128 v[112:115],v5 offset:0
ds_read_b128 v[116:119],v5 offset:4096
s_add_u32 m0,s50,154880
s_nop 0
buffer_load_dwordx4 v2,s[8:11],s66 offen offset:768 sc1 lds
s_add_u32 m0,s50,158976
s_nop 0
buffer_load_dwordx4 v3,s[8:11],s67 offen offset:768 sc1 lds
s_waitcnt lgkmcnt(2)
v_mfma_f32_16x16x32_bf16 v[24:27],a[128:131],v[104:107],0
ds_read_b128 v[120:123],v6 offset:0
v_mfma_f32_16x16x32_bf16 v[40:43],v[104:107],v[128:131],0
v_mfma_f32_16x16x32_bf16 v[28:31],a[128:131],v[108:111],0
ds_read_b128 v[124:127],v6 offset:4096
v_mfma_f32_16x16x32_bf16 v[44:47],v[108:111],v[128:131],0
v_mfma_f32_16x16x32_bf16 v[32:35],a[136:139],v[104:107],0
v_mfma_f32_16x16x32_bf16 v[48:51],v[104:107],v[136:139],0
v_mfma_f32_16x16x32_bf16 v[36:39],a[136:139],v[108:111],0
v_mfma_f32_16x16x32_bf16 v[52:55],v[108:111],v[136:139],0
s_waitcnt lgkmcnt(2)
v_mfma_f32_16x16x32_bf16 v[24:27],a[132:135],v[112:115],v[24:27]
ds_read_b128 v[104:107],v7 offset:0
v_mfma_f32_16x16x32_bf16 v[40:43],v[112:115],v[132:135],v[40:43]
v_mfma_f32_16x16x32_bf16 v[28:31],a[132:135],v[116:119],v[28:31]
ds_read_b128 v[108:111],v7 offset:4096
v_mfma_f32_16x16x32_bf16 v[44:47],v[116:119],v[132:135],v[44:47]
v_mfma_f32_16x16x32_bf16 v[32:35],a[140:143],v[112:115],v[32:35]
v_mfma_f32_16x16x32_bf16 v[48:51],v[112:115],v[140:143],v[48:51]
v_mfma_f32_16x16x32_bf16 v[36:39],a[140:143],v[116:119],v[36:39]
v_mfma_f32_16x16x32_bf16 v[52:55],v[116:119],v[140:143],v[52:55]
s_waitcnt vmcnt(4)
s_barrier
s_waitcnt lgkmcnt(2)
v_mfma_f32_16x16x32_bf16 v[24:27],a[144:147],v[120:123],v[24:27]
ds_read_b128 v[112:115],v4 offset:8192
v_mfma_f32_16x16x32_bf16 v[40:43],v[120:123],v[144:147],v[40:43]
v_mfma_f32_16x16x32_bf16 v[28:31],a[144:147],v[124:127],v[28:31]
ds_read_b128 v[116:119],v4 offset:12288
v_mfma_f32_16x16x32_bf16 v[44:47],v[124:127],v[144:147],v[44:47]
v_mfma_f32_16x16x32_bf16 v[32:35],a[152:155],v[120:123],v[32:35]
v_mfma_f32_16x16x32_bf16 v[48:51],v[120:123],v[152:155],v[48:51]
v_mfma_f32_16x16x32_bf16 v[36:39],a[152:155],v[124:127],v[36:39]
v_mfma_f32_16x16x32_bf16 v[52:55],v[124:127],v[152:155],v[52:55]
s_waitcnt lgkmcnt(2)
v_mfma_f32_16x16x32_bf16 v[24:27],a[148:151],v[104:107],v[24:27]
ds_read_b128 v[120:123],v5 offset:8192
v_mfma_f32_16x16x32_bf16 v[40:43],v[104:107],v[148:151],v[40:43]
v_mfma_f32_16x16x32_bf16 v[28:31],a[148:151],v[108:111],v[28:31]
ds_read_b128 v[124:127],v5 offset:12288
v_mfma_f32_16x16x32_bf16 v[44:47],v[108:111],v[148:151],v[44:47]
v_mfma_f32_16x16x32_bf16 v[32:35],a[156:159],v[104:107],v[32:35]
v_mfma_f32_16x16x32_bf16 v[48:51],v[104:107],v[156:159],v[48:51]
v_mfma_f32_16x16x32_bf16 v[36:39],a[156:159],v[108:111],v[36:39]
v_mfma_f32_16x16x32_bf16 v[52:55],v[108:111],v[156:159],v[52:55]
s_waitcnt lgkmcnt(2)
v_mfma_f32_16x16x32_bf16 v[24:27],a[160:163],v[112:115],v[24:27]
ds_read_b128 v[104:107],v6 offset:8192
v_mfma_f32_16x16x32_bf16 v[40:43],v[112:115],v[160:163],v[40:43]
v_mfma_f32_16x16x32_bf16 v[28:31],a[160:163],v[116:119],v[28:31]
ds_read_b128 v[108:111],v6 offset:12288
v_mfma_f32_16x16x32_bf16 v[44:47],v[116:119],v[160:163],v[44:47]
v_mfma_f32_16x16x32_bf16 v[32:35],a[168:171],v[112:115],v[32:35]
v_mfma_f32_16x16x32_bf16 v[48:51],v[112:115],v[168:171],v[48:51]
v_mfma_f32_16x16x32_bf16 v[36:39],a[168:171],v[116:119],v[36:39]
v_mfma_f32_16x16x32_bf16 v[52:55],v[116:119],v[168:171],v[52:55]
s_waitcnt lgkmcnt(2)
v_mfma_f32_16x16x32_bf16 v[24:27],a[164:167],v[120:123],v[24:27]
ds_read_b128 v[112:115],v7 offset:8192
v_mfma_f32_16x16x32_bf16 v[40:43],v[120:123],v[164:167],v[40:43]
v_mfma_f32_16x16x32_bf16 v[28:31],a[164:167],v[124:127],v[28:31]
ds_read_b128 v[116:119],v7 offset:12288
v_mfma_f32_16x16x32_bf16 v[44:47],v[124:127],v[164:167],v[44:47]
v_mfma_f32_16x16x32_bf16 v[32:35],a[172:175],v[120:123],v[32:35]
v_mfma_f32_16x16x32_bf16 v[48:51],v[120:123],v[172:175],v[48:51]
v_mfma_f32_16x16x32_bf16 v[36:39],a[172:175],v[124:127],v[36:39]
v_mfma_f32_16x16x32_bf16 v[52:55],v[124:127],v[172:175],v[52:55]
s_waitcnt vmcnt(2)
s_barrier
s_waitcnt lgkmcnt(2)
v_mfma_f32_16x16x32_bf16 v[24:27],a[176:179],v[104:107],v[24:27]
ds_read_b128 v[120:123],v4 offset:16384
v_mfma_f32_16x16x32_bf16 v[40:43],v[104:107],v[176:179],v[40:43]
v_mfma_f32_16x16x32_bf16 v[28:31],a[176:179],v[108:111],v[28:31]
ds_read_b128 v[124:127],v4 offset:20480
v_mfma_f32_16x16x32_bf16 v[44:47],v[108:111],v[176:179],v[44:47]
v_mfma_f32_16x16x32_bf16 v[32:35],a[184:187],v[104:107],v[32:35]
v_mfma_f32_16x16x32_bf16 v[48:51],v[104:107],v[184:187],v[48:51]
v_mfma_f32_16x16x32_bf16 v[36:39],a[184:187],v[108:111],v[36:39]
v_mfma_f32_16x16x32_bf16 v[52:55],v[108:111],v[184:187],v[52:55]
s_waitcnt lgkmcnt(2)
v_mfma_f32_16x16x32_bf16 v[24:27],a[180:183],v[112:115],v[24:27]
ds_read_b128 v[104:107],v5 offset:16384
v_mfma_f32_16x16x32_bf16 v[40:43],v[112:115],v[180:183],v[40:43]
v_mfma_f32_16x16x32_bf16 v[28:31],a[180:183],v[116:119],v[28:31]
ds_read_b128 v[108:111],v5 offset:20480
v_mfma_f32_16x16x32_bf16 v[44:47],v[116:119],v[180:183],v[44:47]
v_mfma_f32_16x16x32_bf16 v[32:35],a[188:191],v[112:115],v[32:35]
v_mfma_f32_16x16x32_bf16 v[48:51],v[112:115],v[188:191],v[48:51]
v_mfma_f32_16x16x32_bf16 v[36:39],a[188:191],v[116:119],v[36:39]
v_mfma_f32_16x16x32_bf16 v[52:55],v[116:119],v[188:191],v[52:55]
s_waitcnt lgkmcnt(2)
v_mfma_f32_16x16x32_bf16 v[24:27],a[192:195],v[120:123],v[24:27]
ds_read_b128 v[112:115],v6 offset:16384
v_mfma_f32_16x16x32_bf16 v[40:43],v[120:123],v[192:195],v[40:43]
v_mfma_f32_16x16x32_bf16 v[28:31],a[192:195],v[124:127],v[28:31]
ds_read_b128 v[116:119],v6 offset:20480
v_mfma_f32_16x16x32_bf16 v[44:47],v[124:127],v[192:195],v[44:47]
v_mfma_f32_16x16x32_bf16 v[32:35],a[200:203],v[120:123],v[32:35]
v_mfma_f32_16x16x32_bf16 v[48:51],v[120:123],v[200:203],v[48:51]
v_mfma_f32_16x16x32_bf16 v[36:39],a[200:203],v[124:127],v[36:39]
v_mfma_f32_16x16x32_bf16 v[52:55],v[124:127],v[200:203],v[52:55]
s_waitcnt lgkmcnt(2)
v_mfma_f32_16x16x32_bf16 v[24:27],a[196:199],v[104:107],v[24:27]
ds_read_b128 v[120:123],v7 offset:16384
v_mfma_f32_16x16x32_bf16 v[40:43],v[104:107],v[196:199],v[40:43]
v_mfma_f32_16x16x32_bf16 v[28:31],a[196:199],v[108:111],v[28:31]
ds_read_b128 v[124:127],v7 offset:20480
v_mfma_f32_16x16x32_bf16 v[44:47],v[108:111],v[196:199],v[44:47]
v_mfma_f32_16x16x32_bf16 v[32:35],a[204:207],v[104:107],v[32:35]
v_mfma_f32_16x16x32_bf16 v[48:51],v[104:107],v[204:207],v[48:51]
v_mfma_f32_16x16x32_bf16 v[36:39],a[204:207],v[108:111],v[36:39]
v_mfma_f32_16x16x32_bf16 v[52:55],v[108:111],v[204:207],v[52:55]
s_waitcnt vmcnt(0)
s_barrier
s_waitcnt lgkmcnt(2)
v_mfma_f32_16x16x32_bf16 v[24:27],a[208:211],v[112:115],v[24:27]
ds_read_b128 v[104:107],v4 offset:24576
v_mfma_f32_16x16x32_bf16 v[40:43],v[112:115],v[208:211],v[40:43]
v_mfma_f32_16x16x32_bf16 v[28:31],a[208:211],v[116:119],v[28:31]
ds_read_b128 v[108:111],v4 offset:28672
v_mfma_f32_16x16x32_bf16 v[44:47],v[116:119],v[208:211],v[44:47]
v_mfma_f32_16x16x32_bf16 v[32:35],a[216:219],v[112:115],v[32:35]
v_mfma_f32_16x16x32_bf16 v[48:51],v[112:115],v[216:219],v[48:51]
v_mfma_f32_16x16x32_bf16 v[36:39],a[216:219],v[116:119],v[36:39]
v_mfma_f32_16x16x32_bf16 v[52:55],v[116:119],v[216:219],v[52:55]
s_waitcnt lgkmcnt(2)
v_mfma_f32_16x16x32_bf16 v[24:27],a[212:215],v[120:123],v[24:27]
ds_read_b128 v[112:115],v5 offset:24576
v_mfma_f32_16x16x32_bf16 v[40:43],v[120:123],v[212:215],v[40:43]
v_mfma_f32_16x16x32_bf16 v[28:31],a[212:215],v[124:127],v[28:31]
ds_read_b128 v[116:119],v5 offset:28672
v_mfma_f32_16x16x32_bf16 v[44:47],v[124:127],v[212:215],v[44:47]
v_mfma_f32_16x16x32_bf16 v[32:35],a[220:223],v[120:123],v[32:35]
v_mfma_f32_16x16x32_bf16 v[48:51],v[120:123],v[220:223],v[48:51]
v_mfma_f32_16x16x32_bf16 v[36:39],a[220:223],v[124:127],v[36:39]
v_mfma_f32_16x16x32_bf16 v[52:55],v[124:127],v[220:223],v[52:55]
s_waitcnt lgkmcnt(2)
v_mfma_f32_16x16x32_bf16 v[24:27],a[224:227],v[104:107],v[24:27]
ds_read_b128 v[120:123],v6 offset:24576
v_mfma_f32_16x16x32_bf16 v[40:43],v[104:107],v[224:227],v[40:43]
v_mfma_f32_16x16x32_bf16 v[28:31],a[224:227],v[108:111],v[28:31]
ds_read_b128 v[124:127],v6 offset:28672
v_mfma_f32_16x16x32_bf16 v[44:47],v[108:111],v[224:227],v[44:47]
v_mfma_f32_16x16x32_bf16 v[32:35],a[232:235],v[104:107],v[32:35]
v_mfma_f32_16x16x32_bf16 v[48:51],v[104:107],v[232:235],v[48:51]
v_mfma_f32_16x16x32_bf16 v[36:39],a[232:235],v[108:111],v[36:39]
v_mfma_f32_16x16x32_bf16 v[52:55],v[108:111],v[232:235],v[52:55]
s_waitcnt lgkmcnt(2)
v_mfma_f32_16x16x32_bf16 v[24:27],a[228:231],v[112:115],v[24:27]
ds_read_b128 v[104:107],v7 offset:24576
v_mfma_f32_16x16x32_bf16 v[40:43],v[112:115],v[228:231],v[40:43]
v_mfma_f32_16x16x32_bf16 v[28:31],a[228:231],v[116:119],v[28:31]
ds_read_b128 v[108:111],v7 offset:28672
v_mfma_f32_16x16x32_bf16 v[44:47],v[116:119],v[228:231],v[44:47]
v_mfma_f32_16x16x32_bf16 v[32:35],a[236:239],v[112:115],v[32:35]
v_mfma_f32_16x16x32_bf16 v[48:51],v[112:115],v[236:239],v[48:51]
v_mfma_f32_16x16x32_bf16 v[36:39],a[236:239],v[116:119],v[36:39]
v_mfma_f32_16x16x32_bf16 v[52:55],v[116:119],v[236:239],v[52:55]
s_waitcnt lgkmcnt(2)
v_mfma_f32_16x16x32_bf16 v[24:27],a[240:243],v[120:123],v[24:27]
ds_read_b128 v[112:115],v4 offset:0
v_mfma_f32_16x16x32_bf16 v[40:43],v[120:123],v[240:243],v[40:43]
v_mfma_f32_16x16x32_bf16 v[28:31],a[240:243],v[124:127],v[28:31]
ds_read_b128 v[116:119],v4 offset:4096
v_mfma_f32_16x16x32_bf16 v[44:47],v[124:127],v[240:243],v[44:47]
v_mfma_f32_16x16x32_bf16 v[32:35],a[248:251],v[120:123],v[32:35]
v_mfma_f32_16x16x32_bf16 v[48:51],v[120:123],v[248:251],v[48:51]
v_mfma_f32_16x16x32_bf16 v[36:39],a[248:251],v[124:127],v[36:39]
v_mfma_f32_16x16x32_bf16 v[52:55],v[124:127],v[248:251],v[52:55]
s_waitcnt lgkmcnt(2)
v_mfma_f32_16x16x32_bf16 v[24:27],a[244:247],v[104:107],v[24:27]
ds_read_b128 v[120:123],v5 offset:0
v_mfma_f32_16x16x32_bf16 v[40:43],v[104:107],v[244:247],v[40:43]
v_mfma_f32_16x16x32_bf16 v[28:31],a[244:247],v[108:111],v[28:31]
ds_read_b128 v[124:127],v5 offset:4096
v_mfma_f32_16x16x32_bf16 v[44:47],v[108:111],v[244:247],v[44:47]
v_mfma_f32_16x16x32_bf16 v[32:35],a[252:255],v[104:107],v[32:35]
v_mfma_f32_16x16x32_bf16 v[48:51],v[104:107],v[252:255],v[48:51]
v_mfma_f32_16x16x32_bf16 v[36:39],a[252:255],v[108:111],v[36:39]
v_mfma_f32_16x16x32_bf16 v[52:55],v[108:111],v[252:255],v[52:55]
s_waitcnt lgkmcnt(2)
v_mfma_f32_16x16x32_bf16 v[88:91],a[0:3],v[112:115],0
ds_read_b128 v[104:107],v6 offset:0
v_mfma_f32_16x16x32_bf16 v[92:95],a[0:3],v[116:119],0
v_mfma_f32_16x16x32_bf16 v[96:99],a[8:11],v[112:115],0
ds_read_b128 v[108:111],v6 offset:4096
v_mfma_f32_16x16x32_bf16 v[100:103],a[8:11],v[116:119],0
s_waitcnt lgkmcnt(2)
v_mfma_f32_16x16x32_bf16 v[88:91],a[4:7],v[120:123],v[88:91]
ds_read_b128 v[112:115],v7 offset:0
v_mfma_f32_16x16x32_bf16 v[92:95],a[4:7],v[124:127],v[92:95]
v_cvt_pk_bf16_f32 v56,v24,v32
v_cvt_pk_bf16_f32 v57,v25,v33
v_mfma_f32_16x16x32_bf16 v[96:99],a[12:15],v[120:123],v[96:99]
ds_read_b128 v[116:119],v7 offset:4096
v_mfma_f32_16x16x32_bf16 v[100:103],a[12:15],v[124:127],v[100:103]
v_cvt_pk_bf16_f32 v58,v26,v34
v_cvt_pk_bf16_f32 v59,v27,v35
s_waitcnt lgkmcnt(2)
v_mfma_f32_16x16x32_bf16 v[88:91],a[16:19],v[104:107],v[88:91]
ds_read_b128 v[120:123],v4 offset:8192
v_mfma_f32_16x16x32_bf16 v[92:95],a[16:19],v[108:111],v[92:95]
buffer_store_dwordx4 v[56:59],v0,s[8:11],s61 offen sc1
v_cvt_pk_bf16_f32 v60,v28,v36
v_mfma_f32_16x16x32_bf16 v[96:99],a[24:27],v[104:107],v[96:99]
ds_read_b128 v[124:127],v4 offset:12288
v_mfma_f32_16x16x32_bf16 v[100:103],a[24:27],v[108:111],v[100:103]
v_cvt_pk_bf16_f32 v61,v29,v37
v_cvt_pk_bf16_f32 v62,v30,v38
s_waitcnt lgkmcnt(2)
v_mfma_f32_16x16x32_bf16 v[88:91],a[20:23],v[112:115],v[88:91]
ds_read_b128 v[104:107],v5 offset:8192
v_mfma_f32_16x16x32_bf16 v[92:95],a[20:23],v[116:119],v[92:95]
v_cvt_pk_bf16_f32 v63,v31,v39
buffer_store_dwordx4 v[60:63],v0,s[8:11],s62 offen sc1
v_mfma_f32_16x16x32_bf16 v[96:99],a[28:31],v[112:115],v[96:99]
ds_read_b128 v[108:111],v5 offset:12288
v_mfma_f32_16x16x32_bf16 v[100:103],a[28:31],v[116:119],v[100:103]
v_cvt_pk_bf16_f32 v64,v40,v41
v_cvt_pk_bf16_f32 v65,v42,v43
s_waitcnt lgkmcnt(2)
v_mfma_f32_16x16x32_bf16 v[88:91],a[32:35],v[120:123],v[88:91]
ds_read_b128 v[112:115],v6 offset:8192
v_mfma_f32_16x16x32_bf16 v[92:95],a[32:35],v[124:127],v[92:95]
v_cvt_pk_bf16_f32 v66,v44,v45
v_cvt_pk_bf16_f32 v67,v46,v47
v_mfma_f32_16x16x32_bf16 v[96:99],a[40:43],v[120:123],v[96:99]
ds_read_b128 v[116:119],v6 offset:12288
v_mfma_f32_16x16x32_bf16 v[100:103],a[40:43],v[124:127],v[100:103]
buffer_store_dwordx4 v[64:67],v0,s[8:11],s65 offen offset:0 sc1
v_cvt_pk_bf16_f32 v68,v48,v49
s_waitcnt lgkmcnt(2)
v_mfma_f32_16x16x32_bf16 v[88:91],a[36:39],v[104:107],v[88:91]
ds_read_b128 v[120:123],v7 offset:8192
v_mfma_f32_16x16x32_bf16 v[92:95],a[36:39],v[108:111],v[92:95]
v_cvt_pk_bf16_f32 v69,v50,v51
v_cvt_pk_bf16_f32 v70,v52,v53
v_mfma_f32_16x16x32_bf16 v[96:99],a[44:47],v[104:107],v[96:99]
ds_read_b128 v[124:127],v7 offset:12288
v_mfma_f32_16x16x32_bf16 v[100:103],a[44:47],v[108:111],v[100:103]
v_cvt_pk_bf16_f32 v71,v54,v55
buffer_store_dwordx4 v[68:71],v0,s[8:11],s65 offen offset:1024 sc1
s_waitcnt lgkmcnt(2)
v_mfma_f32_16x16x32_bf16 v[88:91],a[48:51],v[112:115],v[88:91]
ds_read_b128 v[104:107],v4 offset:16384
v_mfma_f32_16x16x32_bf16 v[92:95],a[48:51],v[116:119],v[92:95]
v_mfma_f32_16x16x32_bf16 v[96:99],a[56:59],v[112:115],v[96:99]
ds_read_b128 v[108:111],v4 offset:20480
v_mfma_f32_16x16x32_bf16 v[100:103],a[56:59],v[116:119],v[100:103]
s_waitcnt lgkmcnt(2)
v_mfma_f32_16x16x32_bf16 v[88:91],a[52:55],v[120:123],v[88:91]
ds_read_b128 v[112:115],v5 offset:16384
v_mfma_f32_16x16x32_bf16 v[92:95],a[52:55],v[124:127],v[92:95]
v_mfma_f32_16x16x32_bf16 v[96:99],a[60:63],v[120:123],v[96:99]
ds_read_b128 v[116:119],v5 offset:20480
v_mfma_f32_16x16x32_bf16 v[100:103],a[60:63],v[124:127],v[100:103]
s_waitcnt lgkmcnt(2)
v_mfma_f32_16x16x32_bf16 v[88:91],a[64:67],v[104:107],v[88:91]
ds_read_b128 v[120:123],v6 offset:16384
v_mfma_f32_16x16x32_bf16 v[92:95],a[64:67],v[108:111],v[92:95]
v_mfma_f32_16x16x32_bf16 v[96:99],a[72:75],v[104:107],v[96:99]
ds_read_b128 v[124:127],v6 offset:20480
v_mfma_f32_16x16x32_bf16 v[100:103],a[72:75],v[108:111],v[100:103]
s_waitcnt lgkmcnt(2)
v_mfma_f32_16x16x32_bf16 v[88:91],a[68:71],v[112:115],v[88:91]
ds_read_b128 v[104:107],v7 offset:16384
v_mfma_f32_16x16x32_bf16 v[92:95],a[68:71],v[116:119],v[92:95]
v_mfma_f32_16x16x32_bf16 v[96:99],a[76:79],v[112:115],v[96:99]
ds_read_b128 v[108:111],v7 offset:20480
v_mfma_f32_16x16x32_bf16 v[100:103],a[76:79],v[116:119],v[100:103]
s_waitcnt lgkmcnt(2)
v_mfma_f32_16x16x32_bf16 v[88:91],a[80:83],v[120:123],v[88:91]
ds_read_b128 v[112:115],v4 offset:24576
v_mfma_f32_16x16x32_bf16 v[92:95],a[80:83],v[124:127],v[92:95]
v_mfma_f32_16x16x32_bf16 v[96:99],a[88:91],v[120:123],v[96:99]
ds_read_b128 v[116:119],v4 offset:28672
v_mfma_f32_16x16x32_bf16 v[100:103],a[88:91],v[124:127],v[100:103]
s_waitcnt lgkmcnt(2)
v_mfma_f32_16x16x32_bf16 v[88:91],a[84:87],v[104:107],v[88:91]
ds_read_b128 v[120:123],v5 offset:24576
v_mfma_f32_16x16x32_bf16 v[92:95],a[84:87],v[108:111],v[92:95]
v_mfma_f32_16x16x32_bf16 v[96:99],a[92:95],v[104:107],v[96:99]
ds_read_b128 v[124:127],v5 offset:28672
v_mfma_f32_16x16x32_bf16 v[100:103],a[92:95],v[108:111],v[100:103]
s_waitcnt lgkmcnt(2)
v_mfma_f32_16x16x32_bf16 v[88:91],a[96:99],v[112:115],v[88:91]
ds_read_b128 v[104:107],v6 offset:24576
v_mfma_f32_16x16x32_bf16 v[92:95],a[96:99],v[116:119],v[92:95]
v_mfma_f32_16x16x32_bf16 v[96:99],a[104:107],v[112:115],v[96:99]
ds_read_b128 v[108:111],v6 offset:28672
v_mfma_f32_16x16x32_bf16 v[100:103],a[104:107],v[116:119],v[100:103]
s_waitcnt lgkmcnt(2)
v_mfma_f32_16x16x32_bf16 v[88:91],a[100:103],v[120:123],v[88:91]
ds_read_b128 v[112:115],v7 offset:24576
v_mfma_f32_16x16x32_bf16 v[92:95],a[100:103],v[124:127],v[92:95]
v_mfma_f32_16x16x32_bf16 v[96:99],a[108:111],v[120:123],v[96:99]
ds_read_b128 v[116:119],v7 offset:28672
v_mfma_f32_16x16x32_bf16 v[100:103],a[108:111],v[124:127],v[100:103]
s_waitcnt lgkmcnt(2)
v_mfma_f32_16x16x32_bf16 v[88:91],a[112:115],v[104:107],v[88:91]
v_mfma_f32_16x16x32_bf16 v[92:95],a[112:115],v[108:111],v[92:95]
v_mfma_f32_16x16x32_bf16 v[96:99],a[120:123],v[104:107],v[96:99]
v_mfma_f32_16x16x32_bf16 v[100:103],a[120:123],v[108:111],v[100:103]
s_waitcnt lgkmcnt(0)
v_mfma_f32_16x16x32_bf16 v[88:91],a[116:119],v[112:115],v[88:91]
v_mfma_f32_16x16x32_bf16 v[92:95],a[116:119],v[116:119],v[92:95]
v_mfma_f32_16x16x32_bf16 v[96:99],a[124:127],v[112:115],v[96:99]
v_mfma_f32_16x16x32_bf16 v[100:103],a[124:127],v[116:119],v[100:103]
s_nop 3
v_cvt_pk_bf16_f32 v104,v88,v96
v_cvt_pk_bf16_f32 v105,v89,v97
v_cvt_pk_bf16_f32 v106,v90,v98
v_cvt_pk_bf16_f32 v107,v91,v99
v_cvt_pk_bf16_f32 v108,v92,v100
v_cvt_pk_bf16_f32 v109,v93,v101
v_cvt_pk_bf16_f32 v110,v94,v102
v_cvt_pk_bf16_f32 v111,v95,v103
buffer_store_dwordx4 v[104:107],v0,s[8:11],s63 offen sc1
buffer_store_dwordx4 v[108:111],v0,s[8:11],s64 offen sc1
s_lshl_b32 s59,s51,13
s_lshl2_add_u32 s59,s47,s59
s_add_u32 s59,s59,10486016
s_waitcnt vmcnt(2)
s_barrier
s_or_b32 s59,s59,s52
buffer_store_dword v17,off,s[8:11],s59 sc1
s_add_u32 m0,s50,131072
s_nop 0
buffer_load_dwordx4 v20,s[8:11],s70 offen offset:0 sc1 lds
s_add_u32 m0,s50,135168
s_nop 0
buffer_load_dwordx4 v20,s[8:11],s71 offen offset:0 sc1 lds
s_add_u32 m0,s50,139008
s_nop 0
buffer_load_dwordx4 v20,s[8:11],s70 offen offset:256 sc1 lds
s_add_u32 m0,s50,143104
s_nop 0
buffer_load_dwordx4 v20,s[8:11],s71 offen offset:256 sc1 lds
s_add_u32 m0,s50,146944
s_nop 0
buffer_load_dwordx4 v20,s[8:11],s70 offen offset:512 sc1 lds
s_add_u32 m0,s50,151040
s_nop 0
buffer_load_dwordx4 v20,s[8:11],s71 offen offset:512 sc1 lds
s_lshl_b32 s59,s51,13
s_lshl2_add_u32 s59,s47,s59
s_add_u32 s59,s59,10487680
s_waitcnt vmcnt(0)
s_barrier
s_or_b32 s59,s59,s52
buffer_store_dword v17,off,s[8:11],s59 sc1
L_mo_286:
s_mov_b32 s77,-1
s_sub_u32 s56,s30,s31
s_cmp_eq_u32 s73,0
s_cselect_b32 s57,22,8
s_add_u32 s57,s57,s73
s_min_u32 s57,s57,60
s_cmp_lt_i32 s56,s57
s_cbranch_scc1 L_mo_283
s_waitcnt vmcnt(0)
s_barrier
s_or_b32 s72,s72,s52
buffer_store_dword v17,off,s[8:11],s72 sc1
s_mov_b32 s72,0x80000000
s_cmp_lt_u32 s31,64
s_cbranch_scc1 L_mo_282
s_mov_b32 s51,64
v_lshrrev_b32 v2,3,v1
v_and_b32 v3,7,v1
v_lshlrev_b32 v3,4,v3
v_lshl_add_u32 v3,v2,13,v3
s_lshr_b64 s[88:89],s[84:85],0
v_lshrrev_b32 v60,v2,s88
v_and_b32 v60,1,v60
v_mul_u32_u24 v60,768,v60
v_sub_u32 v60,v3,v60
v_add_u32 v60,10487296,v60
s_lshr_b64 s[88:89],s[84:85],8
v_lshrrev_b32 v61,v2,s88
v_and_b32 v61,1,v61
v_mul_u32_u24 v61,768,v61
v_sub_u32 v61,v3,v61
v_add_u32 v61,10552832,v61
s_lshr_b64 s[88:89],s[84:85],16
v_lshrrev_b32 v62,v2,s88
v_and_b32 v62,1,v62
v_mul_u32_u24 v62,768,v62
v_sub_u32 v62,v3,v62
v_add_u32 v62,10618368,v62
s_lshr_b64 s[88:89],s[84:85],24
v_lshrrev_b32 v63,v2,s88
v_and_b32 v63,1,v63
v_mul_u32_u24 v63,768,v63
v_sub_u32 v63,v3,v63
v_add_u32 v63,10683904,v63
s_lshr_b64 s[88:89],s[84:85],32
v_lshrrev_b32 v64,v2,s88
v_and_b32 v64,1,v64
v_mul_u32_u24 v64,768,v64
v_sub_u32 v64,v3,v64
v_add_u32 v64,10749440,v64
s_lshr_b64 s[88:89],s[84:85],40
v_lshrrev_b32 v65,v2,s88
v_and_b32 v65,1,v65
v_mul_u32_u24 v65,768,v65
v_sub_u32 v65,v3,v65
v_add_u32 v65,10814976,v65
s_lshr_b64 s[88:89],s[84:85],48
v_lshrrev_b32 v66,v2,s88
v_and_b32 v66,1,v66
v_mul_u32_u24 v66,768,v66
v_sub_u32 v66,v3,v66
v_add_u32 v66,10880512,v66
s_lshr_b64 s[88:89],s[84:85],56
v_lshrrev_b32 v67,v2,s88
v_and_b32 v67,1,v67
v_mul_u32_u24 v67,768,v67
v_sub_u32 v67,v3,v67
v_add_u32 v67,10946048,v67
L_mw_296:
s_sleep 2
buffer_load_dwordx4 v[24:27],v60,s[8:11],0 offen sc1
buffer_load_dwordx4 v[28:31],v61,s[8:11],0 offen sc1
buffer_load_dwordx4 v[32:35],v62,s[8:11],0 offen sc1
buffer_load_dwordx4 v[36:39],v63,s[8:11],0 offen sc1
buffer_load_dwordx4 v[40:43],v64,s[8:11],0 offen sc1
buffer_load_dwordx4 v[44:47],v65,s[8:11],0 offen sc1
buffer_load_dwordx4 v[48:51],v66,s[8:11],0 offen sc1
buffer_load_dwordx4 v[52:55],v67,s[8:11],0 offen sc1
s_sub_u32 s49,s49,1
s_cbranch_scc1 L_abort2
s_waitcnt vmcnt(0)
v_min_u32 v56,v24,v25
v_min3_u32 v56,v26,v27,v56
v_min3_u32 v56,v28,v29,v56
v_min3_u32 v56,v30,v31,v56
v_min3_u32 v56,v32,v33,v56
v_min3_u32 v56,v34,v35,v56
v_min3_u32 v56,v36,v37,v56
v_min3_u32 v56,v38,v39,v56
v_min3_u32 v56,v40,v41,v56
v_min3_u32 v56,v42,v43,v56
v_min3_u32 v56,v44,v45,v56
v_min3_u32 v56,v46,v47,v56
v_min3_u32 v56,v48,v49,v56
v_min3_u32 v56,v50,v51,v56
v_min3_u32 v56,v52,v53,v56
v_min3_u32 v56,v54,v55,v56
v_cmp_eq_u32 vcc,0,v56
s_cbranch_vccnz L_mw_296
v_max_u32 v24,v24,v25
v_max3_u32 v24,v26,v27,v24
v_max3_u32 v24,v28,v29,v24
v_max3_u32 v24,v30,v31,v24
v_max3_u32 v24,v32,v33,v24
v_max3_u32 v24,v34,v35,v24
v_max3_u32 v24,v36,v37,v24
v_max3_u32 v24,v38,v39,v24
v_max3_u32 v24,v40,v41,v24
v_max3_u32 v24,v42,v43,v24
v_max3_u32 v24,v44,v45,v24
v_max3_u32 v24,v46,v47,v24
v_max3_u32 v24,v48,v49,v24
v_max3_u32 v24,v50,v51,v24
v_max3_u32 v24,v52,v53,v24
v_max3_u32 v24,v54,v55,v24
s_nop 1
v_max_u32_dpp v24,v24,v24 row_ror:8 row_mask:0xf bank_mask:0xf
s_nop 1
v_max_u32_dpp v24,v24,v24 row_ror:4 row_mask:0xf bank_mask:0xf
s_nop 1
v_max_u32_dpp v24,v24,v24 row_ror:2 row_mask:0xf bank_mask:0xf
s_nop 1
v_max_u32_dpp v24,v24,v24 row_ror:1 row_mask:0xf bank_mask:0xf
v_mov_b32 v25,v24
s_nop 1
v_permlane16_swap_b32 v24,v25
v_max_u32 v24,v24,v25
v_mov_b32 v25,v24
s_nop 1
v_permlane32_swap_b32 v24,v25
v_max_u32 v24,v24,v25
s_nop 0
v_readfirstlane_b32 s55,v24
s_and_b32 s64,s55,0x7ff
s_sub_u32 s64,2047,s64
s_lshl_b32 s56,s64,10
s_add_u32 s58,s56,6291456
buffer_load_dwordx4 v[88:91],v0,s[8:11],s58 offen sc1
s_mov_b32 s4,s38
s_mov_b32 s5,s39
s_mov_b32 s6,1835008
s_mov_b32 s7,0x20000
v_and_b32 v9,15,v1
v_lshrrev_b32 v10,4,v1
v_lshlrev_b32 v8,14,v10
v_lshl_add_u32 v8,v9,4,v8
s_lshl_b32 s59,s47,16
s_lshl_b32 s60,s46,8
s_add_u32 s59,s59,s60
buffer_load_dwordx4 v[24:27],v8,s[4:7],s59 offen offset:0
buffer_load_dwordx4 v[28:31],v8,s[4:7],s59 offen offset:1024
buffer_load_dwordx4 v[32:35],v8,s[4:7],s59 offen offset:2048
buffer_load_dwordx4 v[36:39],v8,s[4:7],s59 offen offset:3072
s_add_u32 s59,s59,4096
buffer_load_dwordx4 v[40:43],v8,s[4:7],s59 offen offset:0
buffer_load_dwordx4 v[44:47],v8,s[4:7],s59 offen offset:1024
buffer_load_dwordx4 v[48:51],v8,s[4:7],s59 offen offset:2048
buffer_load_dwordx4 v[52:55],v8,s[4:7],s59 offen offset:3072
s_add_u32 s59,s59,4096
buffer_load_dwordx4 v[56:59],v8,s[4:7],s59 offen offset:0
buffer_load_dwordx4 v[60:63],v8,s[4:7],s59 offen offset:1024
buffer_load_dwordx4 v[64:67],v8,s[4:7],s59 offen offset:2048
buffer_load_dwordx4 v[68:71],v8,s[4:7],s59 offen offset:3072
s_add_u32 s59,s59,4096
buffer_load_dwordx4 v[72:75],v8,s[4:7],s59 offen offset:0
buffer_load_dwordx4 v[76:79],v8,s[4:7],s59 offen offset:1024
buffer_load_dwordx4 v[80:83],v8,s[4:7],s59 offen offset:2048
buffer_load_dwordx4 v[84:87],v8,s[4:7],s59 offen offset:3072
v_and_b32 v124,1,v1
v_lshlrev_b32 v124,4,v124
v_mov_b32 v125,0xffff
v_lshlrev_b32 v125,v124,v125
v_lshrrev_b32 v124,1,v9
v_cmp_eq_u32 vcc,0,v124
s_nop 1
v_cndmask_b32 v12,0,v125,vcc
v_cmp_eq_u32 vcc,1,v124
s_nop 1
v_cndmask_b32 v13,0,v125,vcc
v_cmp_eq_u32 vcc,2,v124
s_nop 1
v_cndmask_b32 v14,0,v125,vcc
v_cmp_eq_u32 vcc,3,v124
s_nop 1
v_cndmask_b32 v15,0,v125,vcc
s_waitcnt vmcnt(16)
v_lshlrev_b32 v96,16,v88
v_and_b32 v97,0xffff0000,v88
v_lshlrev_b32 v98,16,v89
v_and_b32 v99,0xffff0000,v89
v_lshlrev_b32 v100,16,v90
v_and_b32 v101,0xffff0000,v90
v_lshlrev_b32 v102,16,v91
v_and_b32 v103,0xffff0000,v91
v_readfirstlane_b32 s78,v96
s_nop 1
v_pk_add_f32 v[108:109],v[96:97],s[78:79] op_sel_hi:[1,0] neg_lo:[0,1] neg_hi:[0,1]
v_pk_add_f32 v[110:111],v[98:99],s[78:79] op_sel_hi:[1,0] neg_lo:[0,1] neg_hi:[0,1]
v_pk_add_f32 v[112:113],v[100:101],s[78:79] op_sel_hi:[1,0] neg_lo:[0,1] neg_hi:[0,1]
v_pk_add_f32 v[114:115],v[102:103],s[78:79] op_sel_hi:[1,0] neg_lo:[0,1] neg_hi:[0,1]
v_pk_add_f32 v[116:117],v[108:109],v[110:111]
v_pk_mul_f32 v[118:119],v[108:109],v[108:109]
v_pk_add_f32 v[120:121],v[112:113],v[114:115]
v_pk_fma_f32 v[118:119],v[110:111],v[110:111],v[118:119]
v_pk_add_f32 v[116:117],v[116:117],v[120:121]
v_pk_fma_f32 v[118:119],v[112:113],v[112:113],v[118:119]
v_add_f32 v116,v116,v117
v_pk_fma_f32 v[118:119],v[114:115],v[114:115],v[118:119]
v_add_f32 v118,v118,v119
s_nop 1
v_permlane32_swap_b32 v116,v118
v_add_f32 v116,v116,v118
s_nop 1
v_add_f32_dpp v116,v116,v116 row_ror:8 row_mask:0xf bank_mask:0xf
s_nop 1
v_add_f32_dpp v116,v116,v116 row_ror:4 row_mask:0xf bank_mask:0xf
s_nop 1
v_add_f32_dpp v116,v116,v116 row_ror:2 row_mask:0xf bank_mask:0xf
s_nop 1
v_add_f32_dpp v116,v116,v116 row_ror:1 row_mask:0xf bank_mask:0xf
v_mov_b32 v118,v116
s_nop 1
v_permlane16_swap_b32 v116,v118
v_add_f32 v116,v116,v118
v_mul_f32 v116,0x3b000000,v116
v_mov_b32 v118,v116
s_nop 1
v_permlane32_swap_b32 v116,v118
v_fma_f32 v118,-v116,v116,v118
v_add_f32 v116,s78,v116
v_max_f32 v118,0,v118
v_cvt_pk_bf16_f32 v118,v116,v118
v_lshlrev_b32 v116,16,v118
v_and_b32 v118,0xffff0000,v118
v_add_f32 v118,0x3727c5ac,v118
v_cvt_pk_bf16_f32 v118,v118,v118
v_and_b32 v118,0xffff0000,v118
v_sqrt_f32 v118,v118
v_pk_add_f32 v[108:109],v[96:97],v[116:117] op_sel_hi:[1,0] neg_lo:[0,1] neg_hi:[0,1]
v_pk_add_f32 v[110:111],v[98:99],v[116:117] op_sel_hi:[1,0] neg_lo:[0,1] neg_hi:[0,1]
v_pk_add_f32 v[112:113],v[100:101],v[116:117] op_sel_hi:[1,0] neg_lo:[0,1] neg_hi:[0,1]
v_pk_add_f32 v[114:115],v[102:103],v[116:117] op_sel_hi:[1,0] neg_lo:[0,1] neg_hi:[0,1]
v_cvt_pk_bf16_f32 v118,v118,v118
v_and_b32 v118,0xffff0000,v118
v_rcp_f32 v118,v118
v_cvt_pk_bf16_f32 v104,v108,v109
v_cvt_pk_bf16_f32 v105,v110,v111
v_cvt_pk_bf16_f32 v106,v112,v113
v_cvt_pk_bf16_f32 v107,v114,v115
v_lshlrev_b32 v108,16,v104
v_and_b32 v109,0xffff0000,v104
v_lshlrev_b32 v110,16,v105
v_and_b32 v111,0xffff0000,v105
v_lshlrev_b32 v112,16,v106
v_and_b32 v113,0xffff0000,v106
v_lshlrev_b32 v114,16,v107
v_and_b32 v115,0xffff0000,v107
v_pk_mul_f32 v[108:109],v[108:109],v[118:119] op_sel_hi:[1,0]
v_pk_mul_f32 v[110:111],v[110:111],v[118:119] op_sel_hi:[1,0]
v_pk_mul_f32 v[112:113],v[112:113],v[118:119] op_sel_hi:[1,0]
v_pk_mul_f32 v[114:115],v[114:115],v[118:119] op_sel_hi:[1,0]
v_cvt_pk_bf16_f32 v104,v108,v109
v_cvt_pk_bf16_f32 v105,v110,v111
v_cvt_pk_bf16_f32 v106,v112,v113
v_cvt_pk_bf16_f32 v107,v114,v115
s_mov_b32 s58,0x01000100
s_mov_b32 s59,0x03020302
v_perm_b32 v88,v104,v104,s58
v_perm_b32 v89,v104,v104,s59
v_perm_b32 v90,v105,v105,s58
v_perm_b32 v91,v105,v105,s59
v_perm_b32 v92,v106,v106,s58
v_perm_b32 v93,v106,v106,s59
v_perm_b32 v94,v107,v107,s58
v_perm_b32 v95,v107,v107,s59
v_lshlrev_b32 v8,5,v1
s_lshl_b32 s58,s46,11
s_add_u32 s58,s58,139264
v_add_u32 v8,s58,v8
ds_write_b128 v8,v[88:91]
ds_write_b128 v8,v[92:95] offset:16
s_lshl_b32 s59,s46,9
s_add_u32 s59,s58,s59
v_lshlrev_b32 v8,7,v10
v_add_u32 v8,s59,v8
s_waitcnt lgkmcnt(0)
ds_read_b128 v[108:111],v18 offset:0
ds_read_b128 v[88:91],v8 offset:0
ds_read_b128 v[92:95],v8 offset:16
ds_read_b128 v[112:115],v18 offset:1024
s_waitcnt lgkmcnt(1)
v_and_b32 v124,v12,v88
v_and_b32 v125,v13,v88
v_and_b32 v126,v14,v88
v_and_b32 v127,v15,v88
s_nop 1
v_mfma_f32_16x16x32_bf16 v[116:119],v[124:127],v[108:111],0
ds_read_b128 v[108:111],v18 offset:2048
s_waitcnt lgkmcnt(1)
v_and_b32 v124,v12,v89
v_and_b32 v125,v13,v89
v_and_b32 v126,v14,v89
v_and_b32 v127,v15,v89
s_nop 1
v_mfma_f32_16x16x32_bf16 v[116:119],v[124:127],v[112:115],v[116:119]
ds_read_b128 v[112:115],v18 offset:3072
s_waitcnt lgkmcnt(1)
v_and_b32 v124,v12,v90
v_and_b32 v125,v13,v90
v_and_b32 v126,v14,v90
v_and_b32 v127,v15,v90
s_nop 1
v_mfma_f32_16x16x32_bf16 v[116:119],v[124:127],v[108:111],v[116:119]
ds_read_b128 v[108:111],v18 offset:4096
s_waitcnt lgkmcnt(1)
v_and_b32 v124,v12,v91
v_and_b32 v125,v13,v91
v_and_b32 v126,v14,v91
v_and_b32 v127,v15,v91
s_nop 1
v_mfma_f32_16x16x32_bf16 v[116:119],v[124:127],v[112:115],v[116:119]
ds_read_b128 v[112:115],v18 offset:5120
s_waitcnt lgkmcnt(1)
v_and_b32 v124,v12,v92
v_and_b32 v125,v13,v92
v_and_b32 v126,v14,v92
v_and_b32 v127,v15,v92
s_nop 1
v_mfma_f32_16x16x32_bf16 v[116:119],v[124:127],v[108:111],v[116:119]
ds_read_b128 v[108:111],v18 offset:6144
s_waitcnt lgkmcnt(1)
v_and_b32 v124,v12,v93
v_and_b32 v125,v13,v93
v_and_b32 v126,v14,v93
v_and_b32 v127,v15,v93
s_nop 1
v_mfma_f32_16x16x32_bf16 v[116:119],v[124:127],v[112:115],v[116:119]
ds_read_b128 v[112:115],v18 offset:7168
s_waitcnt lgkmcnt(1)
v_and_b32 v124,v12,v94
v_and_b32 v125,v13,v94
v_and_b32 v126,v14,v94
v_and_b32 v127,v15,v94
s_nop 1
v_mfma_f32_16x16x32_bf16 v[116:119],v[124:127],v[108:111],v[116:119]
ds_read_b128 v[108:111],v18 offset:8192
s_waitcnt lgkmcnt(1)
v_and_b32 v124,v12,v95
v_and_b32 v125,v13,v95
v_and_b32 v126,v14,v95
v_and_b32 v127,v15,v95
s_nop 1
v_mfma_f32_16x16x32_bf16 v[116:119],v[124:127],v[112:115],v[116:119]
ds_read_b128 v[88:91],v8 offset:32
ds_read_b128 v[92:95],v8 offset:48
ds_read_b128 v[112:115],v18 offset:9216
s_waitcnt lgkmcnt(1)
v_and_b32 v124,v12,v88
v_and_b32 v125,v13,v88
v_and_b32 v126,v14,v88
v_and_b32 v127,v15,v88
s_nop 1
v_mfma_f32_16x16x32_bf16 v[116:119],v[124:127],v[108:111],v[116:119]
ds_read_b128 v[108:111],v18 offset:10240
s_waitcnt lgkmcnt(1)
v_and_b32 v124,v12,v89
v_and_b32 v125,v13,v89
v_and_b32 v126,v14,v89
v_and_b32 v127,v15,v89
s_nop 1
v_mfma_f32_16x16x32_bf16 v[116:119],v[124:127],v[112:115],v[116:119]
ds_read_b128 v[112:115],v18 offset:11264
s_waitcnt lgkmcnt(1)
v_and_b32 v124,v12,v90
v_and_b32 v125,v13,v90
v_and_b32 v126,v14,v90
v_and_b32 v127,v15,v90
s_nop 1
v_mfma_f32_16x16x32_bf16 v[116:119],v[124:127],v[108:111],v[116:119]
ds_read_b128 v[108:111],v18 offset:12288
s_waitcnt lgkmcnt(1)
v_and_b32 v124,v12,v91
v_and_b32 v125,v13,v91
v_and_b32 v126,v14,v91
v_and_b32 v127,v15,v91
s_nop 1
v_mfma_f32_16x16x32_bf16 v[116:119],v[124:127],v[112:115],v[116:119]
ds_read_b128 v[112:115],v18 offset:13312
s_waitcnt lgkmcnt(1)
v_and_b32 v124,v12,v92
v_and_b32 v125,v13,v92
v_and_b32 v126,v14,v92
v_and_b32 v127,v15,v92
s_nop 1
v_mfma_f32_16x16x32_bf16 v[116:119],v[124:127],v[108:111],v[116:119]
ds_read_b128 v[108:111],v18 offset:14336
s_waitcnt lgkmcnt(1)
v_and_b32 v124,v12,v93
v_and_b32 v125,v13,v93
v_and_b32 v126,v14,v93
v_and_b32 v127,v15,v93
s_nop 1
v_mfma_f32_16x16x32_bf16 v[116:119],v[124:127],v[112:115],v[116:119]
ds_read_b128 v[112:115],v18 offset:15360
s_waitcnt lgkmcnt(1)
v_and_b32 v124,v12,v94
v_and_b32 v125,v13,v94
v_and_b32 v126,v14,v94
v_and_b32 v127,v15,v94
s_nop 1
v_mfma_f32_16x16x32_bf16 v[116:119],v[124:127],v[108:111],v[116:119]
ds_read_b128 v[108:111],v18 offset:16384
s_waitcnt lgkmcnt(1)
v_and_b32 v124,v12,v95
v_and_b32 v125,v13,v95
v_and_b32 v126,v14,v95
v_and_b32 v127,v15,v95
s_nop 1
v_mfma_f32_16x16x32_bf16 v[116:119],v[124:127],v[112:115],v[116:119]
ds_read_b128 v[88:91],v8 offset:64
ds_read_b128 v[92:95],v8 offset:80
ds_read_b128 v[112:115],v18 offset:17408
s_waitcnt lgkmcnt(1)
v_and_b32 v124,v12,v88
v_and_b32 v125,v13,v88
v_and_b32 v126,v14,v88
v_and_b32 v127,v15,v88
s_nop 1
v_mfma_f32_16x16x32_bf16 v[116:119],v[124:127],v[108:111],v[116:119]
ds_read_b128 v[108:111],v18 offset:18432
s_waitcnt lgkmcnt(1)
v_and_b32 v124,v12,v89
v_and_b32 v125,v13,v89
v_and_b32 v126,v14,v89
v_and_b32 v127,v15,v89
s_nop 1
v_mfma_f32_16x16x32_bf16 v[116:119],v[124:127],v[112:115],v[116:119]
ds_read_b128 v[112:115],v18 offset:19456
s_waitcnt lgkmcnt(1)
v_and_b32 v124,v12,v90
v_and_b32 v125,v13,v90
v_and_b32 v126,v14,v90
v_and_b32 v127,v15,v90
s_nop 1
v_mfma_f32_16x16x32_bf16 v[116:119],v[124:127],v[108:111],v[116:119]
ds_read_b128 v[108:111],v18 offset:20480
s_waitcnt lgkmcnt(1)
v_and_b32 v124,v12,v91
v_and_b32 v125,v13,v91
v_and_b32 v126,v14,v91
v_and_b32 v127,v15,v91
s_nop 1
v_mfma_f32_16x16x32_bf16 v[116:119],v[124:127],v[112:115],v[116:119]
ds_read_b128 v[112:115],v18 offset:21504
s_waitcnt lgkmcnt(1)
v_and_b32 v124,v12,v92
v_and_b32 v125,v13,v92
v_and_b32 v126,v14,v92
v_and_b32 v127,v15,v92
s_nop 1
v_mfma_f32_16x16x32_bf16 v[116:119],v[124:127],v[108:111],v[116:119]
ds_read_b128 v[108:111],v18 offset:22528
s_waitcnt lgkmcnt(1)
v_and_b32 v124,v12,v93
v_and_b32 v125,v13,v93
v_and_b32 v126,v14,v93
v_and_b32 v127,v15,v93
s_nop 1
v_mfma_f32_16x16x32_bf16 v[116:119],v[124:127],v[112:115],v[116:119]
ds_read_b128 v[112:115],v18 offset:23552
s_waitcnt lgkmcnt(1)
v_and_b32 v124,v12,v94
v_and_b32 v125,v13,v94
v_and_b32 v126,v14,v94
v_and_b32 v127,v15,v94
s_nop 1
v_mfma_f32_16x16x32_bf16 v[116:119],v[124:127],v[108:111],v[116:119]
ds_read_b128 v[108:111],v18 offset:24576
s_waitcnt lgkmcnt(1)
v_and_b32 v124,v12,v95
v_and_b32 v125,v13,v95
v_and_b32 v126,v14,v95
v_and_b32 v127,v15,v95
s_nop 1
v_mfma_f32_16x16x32_bf16 v[116:119],v[124:127],v[112:115],v[116:119]
ds_read_b128 v[88:91],v8 offset:96
ds_read_b128 v[92:95],v8 offset:112
ds_read_b128 v[112:115],v18 offset:25600
s_waitcnt lgkmcnt(1)
v_and_b32 v124,v12,v88
v_and_b32 v125,v13,v88
v_and_b32 v126,v14,v88
v_and_b32 v127,v15,v88
s_nop 1
v_mfma_f32_16x16x32_bf16 v[116:119],v[124:127],v[108:111],v[116:119]
ds_read_b128 v[108:111],v18 offset:26624
s_waitcnt lgkmcnt(1)
v_and_b32 v124,v12,v89
v_and_b32 v125,v13,v89
v_and_b32 v126,v14,v89
v_and_b32 v127,v15,v89
s_nop 1
v_mfma_f32_16x16x32_bf16 v[116:119],v[124:127],v[112:115],v[116:119]
ds_read_b128 v[112:115],v18 offset:27648
s_waitcnt lgkmcnt(1)
v_and_b32 v124,v12,v90
v_and_b32 v125,v13,v90
v_and_b32 v126,v14,v90
v_and_b32 v127,v15,v90
s_nop 1
v_mfma_f32_16x16x32_bf16 v[116:119],v[124:127],v[108:111],v[116:119]
ds_read_b128 v[108:111],v18 offset:28672
s_waitcnt lgkmcnt(1)
v_and_b32 v124,v12,v91
v_and_b32 v125,v13,v91
v_and_b32 v126,v14,v91
v_and_b32 v127,v15,v91
s_nop 1
v_mfma_f32_16x16x32_bf16 v[116:119],v[124:127],v[112:115],v[116:119]
ds_read_b128 v[112:115],v18 offset:29696
s_waitcnt lgkmcnt(1)
v_and_b32 v124,v12,v92
v_and_b32 v125,v13,v92
v_and_b32 v126,v14,v92
v_and_b32 v127,v15,v92
s_nop 1
v_mfma_f32_16x16x32_bf16 v[116:119],v[124:127],v[108:111],v[116:119]
ds_read_b128 v[108:111],v18 offset:30720
s_waitcnt lgkmcnt(1)
v_and_b32 v124,v12,v93
v_and_b32 v125,v13,v93
v_and_b32 v126,v14,v93
v_and_b32 v127,v15,v93
s_nop 1
v_mfma_f32_16x16x32_bf16 v[116:119],v[124:127],v[112:115],v[116:119]
ds_read_b128 v[112:115],v18 offset:31744
s_waitcnt lgkmcnt(1)
v_and_b32 v124,v12,v94
v_and_b32 v125,v13,v94
v_and_b32 v126,v14,v94
v_and_b32 v127,v15,v94
s_nop 1
v_mfma_f32_16x16x32_bf16 v[116:119],v[124:127],v[108:111],v[116:119]
s_waitcnt lgkmcnt(0)
v_and_b32 v124,v12,v95
v_and_b32 v125,v13,v95
v_and_b32 v126,v14,v95
v_and_b32 v127,v15,v95
s_nop 1
v_mfma_f32_16x16x32_bf16 v[116:119],v[124:127],v[112:115],v[116:119]
v_lshlrev_b32 v8,5,v9
v_and_b32 v124,1,v10
v_lshl_add_u32 v8,v124,4,v8
v_lshrrev_b32 v124,1,v10
v_lshl_add_u32 v8,v124,11,v8
s_lshl_b32 s60,s46,9
s_add_u32 s60,s60,147456
v_add_u32 v8,s60,v8
ds_write_b128 v8,v[116:119]
v_lshlrev_b32 v8,2,v1
v_add_u32 v8,147456,v8
s_waitcnt lgkmcnt(0)
s_barrier
ds_read2st64_b32 v[88:89],v8 offset0:0 offset1:1
ds_read2st64_b32 v[90:91],v8 offset0:2 offset1:3
ds_read2st64_b32 v[92:93],v8 offset0:4 offset1:5
ds_read2st64_b32 v[94:95],v8 offset0:6 offset1:7
s_waitcnt lgkmcnt(0)
v_pk_add_f32 v[88:89],v[88:89],v[90:91]
v_pk_add_f32 v[92:93],v[92:93],v[94:95]
v_pk_add_f32 v[88:89],v[88:89],v[92:93]
v_cvt_pk_bf16_f32 v88,v88,v88
v_and_b32 v88,0xffff0000,v88
v_cvt_pk_bf16_f32 v89,v89,v89
v_and_b32 v89,0xffff0000,v89
v_mul_f32 v90,0xbfb8aa3b,v88
v_exp_f32 v90,v90
s_nop 0
v_add_f32 v90,1.0,v90
v_rcp_f32 v90,v90
s_nop 0
v_mul_f32 v88,v88,v90
v_cvt_pk_bf16_f32 v88,v88,v88
v_and_b32 v88,0xffff0000,v88
v_mul_f32 v88,v88,v89
v_cvt_pk_bf16_f32 v88,v88,v88
v_lshlrev_b32 v8,2,v1
v_add_u32 v8,s58,v8
ds_write_b32 v8,v88
v_lshlrev_b32 v8,6,v10
v_add_u32 v8,s58,v8
s_waitcnt lgkmcnt(0)
ds_read_b128 v[88:91],v8
ds_read_b128 v[92:95],v8 offset:16
ds_read_b128 v[108:111],v8 offset:32
ds_read_b128 v[112:115],v8 offset:48
s_waitcnt vmcnt(0) lgkmcnt(0)
v_and_b32 v124,v12,v88
v_and_b32 v125,v13,v88
v_and_b32 v126,v14,v88
v_and_b32 v127,v15,v88
s_nop 1
v_mfma_f32_16x16x32_bf16 v[116:119],v[124:127],v[24:27],0
v_and_b32 v124,v12,v89
v_and_b32 v125,v13,v89
v_and_b32 v126,v14,v89
v_and_b32 v127,v15,v89
s_nop 1
v_mfma_f32_16x16x32_bf16 v[116:119],v[124:127],v[28:31],v[116:119]
v_and_b32 v124,v12,v90
v_and_b32 v125,v13,v90
v_and_b32 v126,v14,v90
v_and_b32 v127,v15,v90
s_nop 1
v_mfma_f32_16x16x32_bf16 v[116:119],v[124:127],v[32:35],v[116:119]
v_and_b32 v124,v12,v91
v_and_b32 v125,v13,v91
v_and_b32 v126,v14,v91
v_and_b32 v127,v15,v91
s_nop 1
v_mfma_f32_16x16x32_bf16 v[116:119],v[124:127],v[36:39],v[116:119]
v_and_b32 v124,v12,v92
v_and_b32 v125,v13,v92
v_and_b32 v126,v14,v92
v_and_b32 v127,v15,v92
s_nop 1
v_mfma_f32_16x16x32_bf16 v[116:119],v[124:127],v[40:43],v[116:119]
v_and_b32 v124,v12,v93
v_and_b32 v125,v13,v93
v_and_b32 v126,v14,v93
v_and_b32 v127,v15,v93
s_nop 1
v_mfma_f32_16x16x32_bf16 v[116:119],v[124:127],v[44:47],v[116:119]
v_and_b32 v124,v12,v94
v_and_b32 v125,v13,v94
v_and_b32 v126,v14,v94
v_and_b32 v127,v15,v94
s_nop 1
v_mfma_f32_16x16x32_bf16 v[116:119],v[124:127],v[48:51],v[116:119]
v_and_b32 v124,v12,v95
v_and_b32 v125,v13,v95
v_and_b32 v126,v14,v95
v_and_b32 v127,v15,v95
s_nop 1
v_mfma_f32_16x16x32_bf16 v[116:119],v[124:127],v[52:55],v[116:119]
v_and_b32 v124,v12,v108
v_and_b32 v125,v13,v108
v_and_b32 v126,v14,v108
v_and_b32 v127,v15,v108
s_nop 1
v_mfma_f32_16x16x32_bf16 v[116:119],v[124:127],v[56:59],v[116:119]
v_and_b32 v124,v12,v109
v_and_b32 v125,v13,v109
v_and_b32 v126,v14,v109
v_and_b32 v127,v15,v109
s_nop 1
v_mfma_f32_16x16x32_bf16 v[116:119],v[124:127],v[60:63],v[116:119]
v_and_b32 v124,v12,v110
v_and_b32 v125,v13,v110
v_and_b32 v126,v14,v110
v_and_b32 v127,v15,v110
s_nop 1
v_mfma_f32_16x16x32_bf16 v[116:119],v[124:127],v[64:67],v[116:119]
v_and_b32 v124,v12,v111
v_and_b32 v125,v13,v111
v_and_b32 v126,v14,v111
v_and_b32 v127,v15,v111
s_nop 1
v_mfma_f32_16x16x32_bf16 v[116:119],v[124:127],v[68:71],v[116:119]
v_and_b32 v124,v12,v112
v_and_b32 v125,v13,v112
v_and_b32 v126,v14,v112
v_and_b32 v127,v15,v112
s_nop 1
v_mfma_f32_16x16x32_bf16 v[116:119],v[124:127],v[72:75],v[116:119]
v_and_b32 v124,v12,v113
v_and_b32 v125,v13,v113
v_and_b32 v126,v14,v113
v_and_b32 v127,v15,v113
s_nop 1
v_mfma_f32_16x16x32_bf16 v[116:119],v[124:127],v[76:79],v[116:119]
v_and_b32 v124,v12,v114
v_and_b32 v125,v13,v114
v_and_b32 v126,v14,v114
v_and_b32 v127,v15,v114
s_nop 1
v_mfma_f32_16x16x32_bf16 v[116:119],v[124:127],v[80:83],v[116:119]
v_and_b32 v124,v12,v115
v_and_b32 v125,v13,v115
v_and_b32 v126,v14,v115
v_and_b32 v127,v15,v115
s_nop 1
v_mfma_f32_16x16x32_bf16 v[116:119],v[124:127],v[84:87],v[116:119]
v_lshlrev_b32 v8,4,v9
v_and_b32 v124,1,v10
v_lshl_add_u32 v8,v124,3,v8
v_and_b32 v124,2,v10
v_lshl_add_u32 v8,v124,30,v8
s_lshl_b32 s65,s51,15
s_add_u32 s65,s65,92274688
s_lshl_b32 s59,s47,10
s_lshl_b32 s60,s46,8
s_add_u32 s59,s59,s60
s_add_u32 s59,s59,s65
v_cvt_pk_bf16_f32 v24,v116,v117
v_cvt_pk_bf16_f32 v25,v118,v119
buffer_store_dwordx2 v[24:25],v8,s[8:11],s59 offen sc1
s_lshl_b32 s59,s51,13
s_lshl2_add_u32 s59,s47,s59
s_add_u32 s59,s59,10486912
s_waitcnt vmcnt(0)
s_barrier
s_or_b32 s59,s59,s52
buffer_store_dword v17,off,s[8:11],s59 sc1
s_cmp_lg_u32 s47,0
s_cbranch_scc1 L_moed_297
s_lshl_b32 s59,s51,13
s_add_u32 s59,s59,10486912
v_and_b32 v124,31,v1
v_lshlrev_b32 v124,2,v124
L_fw_298:
buffer_load_dword v125,v124,s[8:11],s59 offen sc1
s_sub_u32 s49,s49,1
s_cbranch_scc1 L_abort2
s_waitcnt vmcnt(0)
v_cmp_eq_u32 vcc,0,v125
s_cbranch_vccnz L_fw_298
s_add_u32 s63,s65,0
buffer_load_dwordx4 v[24:27],v22,s[8:11],s63 offen sc1
s_add_u32 s63,s65,4096
buffer_load_dwordx4 v[28:31],v22,s[8:11],s63 offen sc1
s_add_u32 s63,s65,8192
buffer_load_dwordx4 v[32:35],v22,s[8:11],s63 offen sc1
s_add_u32 s63,s65,12288
buffer_load_dwordx4 v[36:39],v22,s[8:11],s63 offen sc1
s_add_u32 s63,s65,16384
buffer_load_dwordx4 v[40:43],v22,s[8:11],s63 offen sc1
s_add_u32 s63,s65,20480
buffer_load_dwordx4 v[44:47],v22,s[8:11],s63 offen sc1
s_add_u32 s63,s65,24576
buffer_load_dwordx4 v[48:51],v22,s[8:11],s63 offen sc1
s_add_u32 s63,s65,28672
buffer_load_dwordx4 v[52:55],v22,s[8:11],s63 offen sc1
v_and_b32 v64,15,v1
v_and_b32 v65,1,v1
v_lshlrev_b32 v65,4,v65
v_mov_b32 v66,0x3f80
v_lshlrev_b32 v66,v65,v66
v_lshrrev_b32 v64,1,v64
v_cmp_eq_u32 vcc,0,v64
s_nop 1
v_cndmask_b32 v56,0,v66,vcc
v_cmp_eq_u32 vcc,1,v64
s_nop 1
v_cndmask_b32 v57,0,v66,vcc
v_cmp_eq_u32 vcc,2,v64
s_nop 1
v_cndmask_b32 v58,0,v66,vcc
v_cmp_eq_u32 vcc,3,v64
s_nop 1
v_cndmask_b32 v59,0,v66,vcc
s_waitcnt vmcnt(7)
s_nop 0
v_mfma_f32_16x16x32_bf16 v[60:63],v[56:59],v[24:27],0
s_waitcnt vmcnt(6)
v_mfma_f32_16x16x32_bf16 v[60:63],v[56:59],v[28:31],v[60:63]
s_waitcnt vmcnt(5)
v_mfma_f32_16x16x32_bf16 v[60:63],v[56:59],v[32:35],v[60:63]
s_waitcnt vmcnt(4)
v_mfma_f32_16x16x32_bf16 v[60:63],v[56:59],v[36:39],v[60:63]
s_waitcnt vmcnt(3)
v_mfma_f32_16x16x32_bf16 v[60:63],v[56:59],v[40:43],v[60:63]
s_waitcnt vmcnt(2)
v_mfma_f32_16x16x32_bf16 v[60:63],v[56:59],v[44:47],v[60:63]
s_waitcnt vmcnt(1)
v_mfma_f32_16x16x32_bf16 v[60:63],v[56:59],v[48:51],v[60:63]
s_waitcnt vmcnt(0)
v_mfma_f32_16x16x32_bf16 v[60:63],v[56:59],v[52:55],v[60:63]
s_nop 7
ds_write_b128 v21,v[60:63]
s_waitcnt lgkmcnt(0)
s_barrier
s_cmp_lg_u32 s46,0
s_cbranch_scc1 L_moed_297
v_lshlrev_b32 v56,5,v1
v_add_u32 v56,155648,v56
ds_read_b128 v[24:27],v56
ds_read_b128 v[28:31],v56 offset:16
s_and_b32 s59,s55,0xffff0000
s_xor_b32 s60,s59,0x80000000
s_xor_b32 s61,s59,0xffff0000
s_cmp_lt_i32 s59,0
s_cselect_b32 s59,s60,s61
v_mov_b32 v56,s59
v_mul_f32 v56,0xbfb8aa3b,v56
v_exp_f32 v56,v56
s_nop 0
v_add_f32 v56,1.0,v56
v_rcp_f32 v56,v56
s_nop 0
v_cvt_pk_bf16_f32 v56,v56,v56
v_and_b32 v56,0xffff0000,v56
v_lshlrev_b32 v48,16,v104
v_and_b32 v49,0xffff0000,v104
v_lshlrev_b32 v50,16,v105
v_and_b32 v51,0xffff0000,v105
v_lshlrev_b32 v52,16,v106
v_and_b32 v53,0xffff0000,v106
v_lshlrev_b32 v54,16,v107
v_and_b32 v55,0xffff0000,v107
s_waitcnt lgkmcnt(0)
v_cvt_pk_bf16_f32 v40,v24,v25
v_cvt_pk_bf16_f32 v41,v26,v27
v_cvt_pk_bf16_f32 v42,v28,v29
v_cvt_pk_bf16_f32 v43,v30,v31
v_lshlrev_b32 v24,16,v40
v_and_b32 v25,0xffff0000,v40
v_lshlrev_b32 v26,16,v41
v_and_b32 v27,0xffff0000,v41
v_lshlrev_b32 v28,16,v42
v_and_b32 v29,0xffff0000,v42
v_lshlrev_b32 v30,16,v43
v_and_b32 v31,0xffff0000,v43
v_mul_f32 v24,v24,v56
v_mul_f32 v25,v25,v56
v_mul_f32 v26,v26,v56
v_mul_f32 v27,v27,v56
v_mul_f32 v28,v28,v56
v_mul_f32 v29,v29,v56
v_mul_f32 v30,v30,v56
v_mul_f32 v31,v31,v56
v_cvt_pk_bf16_f32 v40,v24,v25
v_cvt_pk_bf16_f32 v41,v26,v27
v_cvt_pk_bf16_f32 v42,v28,v29
v_cvt_pk_bf16_f32 v43,v30,v31
v_lshlrev_b32 v24,16,v40
v_and_b32 v25,0xffff0000,v40
v_lshlrev_b32 v26,16,v41
v_and_b32 v27,0xffff0000,v41
v_lshlrev_b32 v28,16,v42
v_and_b32 v29,0xffff0000,v42
v_lshlrev_b32 v30,16,v43
v_and_b32 v31,0xffff0000,v43
v_add_f32 v24,v24,v48
v_add_f32 v25,v25,v49
v_add_f32 v26,v26,v50
v_add_f32 v27,v27,v51
v_add_f32 v28,v28,v52
v_add_f32 v29,v29,v53
v_add_f32 v30,v30,v54
v_add_f32 v31,v31,v55
v_cvt_pk_bf16_f32 v40,v24,v25
v_cvt_pk_bf16_f32 v41,v26,v27
v_cvt_pk_bf16_f32 v42,v28,v29
v_cvt_pk_bf16_f32 v43,v30,v31
v_lshlrev_b32 v24,16,v40
v_and_b32 v25,0xffff0000,v40
v_lshlrev_b32 v26,16,v41
v_and_b32 v27,0xffff0000,v41
v_lshlrev_b32 v28,16,v42
v_and_b32 v29,0xffff0000,v42
v_lshlrev_b32 v30,16,v43
v_and_b32 v31,0xffff0000,v43
v_add_f32 v96,v96,v24
v_add_f32 v97,v97,v25
v_add_f32 v98,v98,v26
v_add_f32 v99,v99,v27
v_add_f32 v100,v100,v28
v_add_f32 v101,v101,v29
v_add_f32 v102,v102,v30
v_add_f32 v103,v103,v31
v_cvt_pk_bf16_f32 v80,v96,v97
v_cvt_pk_bf16_f32 v81,v98,v99
v_cvt_pk_bf16_f32 v82,v100,v101
v_cvt_pk_bf16_f32 v83,v102,v103
s_mov_b32 s4,s40
s_mov_b32 s5,s41
s_mov_b32 s6,2097152
s_mov_b32 s7,0x20000
buffer_store_dwordx4 v[80:83],v0,s[4:7],s56 offen sc1
L_moed_297:
s_endpgm
.section .rodata,"a"
.p2align 6
.amdhsa_kernel interleave_layers__memory_aug_recurrent_mem_tr__moe_arch_mod__prompt_kernel
  .amdhsa_next_free_vgpr 512
  .amdhsa_next_free_sgpr 102
  .amdhsa_accum_offset 256
  .amdhsa_group_segment_fixed_size 0
  .amdhsa_kernarg_size 120
  .amdhsa_user_sgpr_count 2
  .amdhsa_user_sgpr_kernarg_segment_ptr 1
  .amdhsa_system_sgpr_workgroup_id_x 1
  .amdhsa_float_denorm_mode_32 3
.end_amdhsa_kernel
```

```asm
; @launch grid=(256,1,1) block=(256,1,1) lds=163840
.amdgcn_target "amdgcn-amd-amdhsa--gfx950"
.text
.globl interleave_layers__memory_aug_recurrent_mem_tr__moe_arch_mod__prompt_kernel
.p2align 8
.type interleave_layers__memory_aug_recurrent_mem_tr__moe_arch_mod__prompt_kernel,@function
interleave_layers__memory_aug_recurrent_mem_tr__moe_arch_mod__prompt_kernel:
s_cmp_ge_u32 s2,256
s_cbranch_scc1 L_abort
s_load_dwordx16 s[16:31],s[0:1],0
s_load_dwordx8 s[32:39],s[0:1],64
s_load_dwordx4 s[40:43],s[0:1],96
s_load_dwordx2 s[44:45],s[0:1],112
v_lshrrev_b32 v2,6,v0
v_and_b32 v1,63,v0
v_readfirstlane_b32 s46,v2
v_lshlrev_b32 v0,4,v1
s_getreg_b32 s48,hwreg(HW_REG_XCC_ID)
s_and_b32 s48,s48,7
s_lshl_b32 s48,s48,2
s_lshr_b32 s48,1399931488,s48
s_and_b32 s48,s48,7
s_mov_b32 s49,100000
s_mov_b32 s80,0x3e0293ee
s_waitcnt lgkmcnt(0)
s_mov_b32 s8,s44
s_mov_b32 s9,s45
s_mov_b32 s10,268435456
s_mov_b32 s11,0x20000
s_mov_b32 s12,s42
s_mov_b32 s13,s43
s_mov_b32 s14,256
s_mov_b32 s15,0x20000
s_cmp_lg_u32 s46,0
s_cbranch_scc1 L_tk_1
s_lshl_b32 s56,s48,2
v_mov_b32 v2,s56
v_mov_b32 v3,1
s_mov_b64 exec,1
buffer_atomic_add v3,v2,s[12:15],0 offen sc0
s_waitcnt vmcnt(0)
v_mov_b32 v4,159744
ds_write_b32 v4,v3
s_mov_b64 exec,-1
s_waitcnt lgkmcnt(0)
L_tk_1:
s_barrier
v_mov_b32 v4,159744
ds_read_b32 v3,v4
s_waitcnt lgkmcnt(0)
v_readfirstlane_b32 s47,v3
s_mov_b32 s3,0
s_cmp_ge_u32 s47,32
s_cselect_b32 s53,0x10001,1
s_and_b32 s47,s47,31
s_lshl_b32 s50,s46,10
s_cmp_eq_u32 s46,0
s_cselect_b32 s52,0,0x80000000
s_mov_b32 s28,0x3f803f80
s_mov_b32 s29,0x3f803f80
s_mov_b32 s51,0
s_bfe_u32 s56,s48,0x10001
s_and_b32 s57,s48,1
s_add_u32 s58,s56,6
s_sub_u32 s59,5,s57
s_cmp_ge_u32 s47,16
s_cselect_b32 s58,s58,s59
s_cselect_b32 s57,s57,s56
s_and_b32 s59,s47,15
s_lshl4_add_u32 s57,s57,s59
s_cmp_ge_u32 s48,4
s_cselect_b32 s48,s58,s48
s_cselect_b32 s47,s57,s47
s_lshl_b32 s56,s2,12
s_lshl_b32 s57,s46,10
s_add_u32 s56,s56,s57
v_add_u32 v2,s56,v0
v_mov_b32 v4,-1
v_mov_b32 v5,-1
v_mov_b32 v6,-1
v_mov_b32 v7,-1
v_mov_b32 v8,0
v_mov_b32 v9,0
v_mov_b32 v10,0
v_mov_b32 v11,0
v_cmp_gt_u32 vcc,524288,v2
v_mov_b32 v3,14155776
v_mov_b32 v12,11542528
v_cndmask_b32 v3,v3,v12,vcc
v_add_u32 v3,v3,v2
s_mov_b32 s56,0
buffer_store_dwordx4 v[4:7],v3,s[8:11],s56 offen sc1
s_mov_b32 s56,1048576
buffer_store_dwordx4 v[4:7],v3,s[8:11],s56 offen sc1
s_mov_b32 s56,2097152
buffer_store_dwordx4 v[4:7],v3,s[8:11],s56 offen sc1
s_mov_b32 s56,4194304
buffer_store_dwordx4 v[4:7],v2,s[8:11],s56 offen sc1
s_mov_b32 s56,5242880
buffer_store_dwordx4 v[4:7],v2,s[8:11],s56 offen sc1
v_add_u32 v3,17309696,v2
v_mov_b32 v12,0x80000000
v_cndmask_b32 v3,v3,v12,vcc
buffer_store_dwordx4 v[4:7],v3,s[8:11],0 offen sc1
v_cmp_gt_u32 vcc,147456,v2
v_lshrrev_b32 v3,11,v2
v_lshlrev_b32 v3,13,v3
v_and_b32 v13,0x7ff,v2
v_add_u32 v3,v3,v13
v_add_u32 v3,10485760,v3
v_cndmask_b32 v3,v12,v3,vcc
buffer_store_dwordx4 v[8:11],v3,s[8:11],0 offen sc1
v_add_u32 v3,11075584,v2
v_lshrrev_b32 v13,16,v2
v_cmp_eq_u32 vcc,4,v13
s_nop 1
v_cndmask_b32 v3,v12,v3,vcc
buffer_store_dwordx4 v[4:7],v3,s[8:11],0 offen sc1
s_mov_b32 s4,s16
s_mov_b32 s5,s17
s_mov_b32 s6,2097152
s_mov_b32 s7,0x20000
s_lshl_b32 s56,s2,3
s_lshl_b32 s57,s46,1
s_add_u32 s56,s56,s57
s_lshl_b32 s57,s56,10
buffer_load_dwordx4 v[24:27],v0,s[4:7],s57 offen
buffer_load_dwordx4 v[28:31],v0,s[4:7],s57 offen offset:1024
s_waitcnt vmcnt(0)
v_lshlrev_b32 v32,16,v24
v_and_b32 v33,0xffff0000,v24
v_lshlrev_b32 v34,16,v25
v_and_b32 v35,0xffff0000,v25
v_lshlrev_b32 v36,16,v26
v_and_b32 v37,0xffff0000,v26
v_lshlrev_b32 v38,16,v27
v_and_b32 v39,0xffff0000,v27
v_readfirstlane_b32 s78,v32
s_nop 1
v_pk_add_f32 v[48:49],v[32:33],s[78:79] op_sel_hi:[1,0] neg_lo:[0,1] neg_hi:[0,1]
v_pk_add_f32 v[50:51],v[34:35],s[78:79] op_sel_hi:[1,0] neg_lo:[0,1] neg_hi:[0,1]
v_pk_add_f32 v[52:53],v[36:37],s[78:79] op_sel_hi:[1,0] neg_lo:[0,1] neg_hi:[0,1]
v_pk_add_f32 v[54:55],v[38:39],s[78:79] op_sel_hi:[1,0] neg_lo:[0,1] neg_hi:[0,1]
v_pk_add_f32 v[56:57],v[48:49],v[50:51]
v_pk_mul_f32 v[58:59],v[48:49],v[48:49]
v_pk_add_f32 v[60:61],v[52:53],v[54:55]
v_pk_fma_f32 v[58:59],v[50:51],v[50:51],v[58:59]
v_pk_add_f32 v[56:57],v[56:57],v[60:61]
v_pk_fma_f32 v[58:59],v[52:53],v[52:53],v[58:59]
v_add_f32 v56,v56,v57
v_pk_fma_f32 v[58:59],v[54:55],v[54:55],v[58:59]
v_add_f32 v58,v58,v59
s_nop 1
v_permlane32_swap_b32 v56,v58
v_add_f32 v56,v56,v58
s_nop 1
v_add_f32_dpp v56,v56,v56 row_ror:8 row_mask:0xf bank_mask:0xf
s_nop 1
v_add_f32_dpp v56,v56,v56 row_ror:4 row_mask:0xf bank_mask:0xf
s_nop 1
v_add_f32_dpp v56,v56,v56 row_ror:2 row_mask:0xf bank_mask:0xf
s_nop 1
v_add_f32_dpp v56,v56,v56 row_ror:1 row_mask:0xf bank_mask:0xf
v_mov_b32 v58,v56
s_nop 1
v_permlane16_swap_b32 v56,v58
v_add_f32 v56,v56,v58
v_mul_f32 v56,0x3b000000,v56
v_mov_b32 v58,v56
s_nop 1
v_permlane32_swap_b32 v56,v58
v_fma_f32 v58,-v56,v56,v58
v_add_f32 v56,s78,v56
v_max_f32 v58,0,v58
v_cvt_pk_bf16_f32 v58,v56,v58
v_lshlrev_b32 v56,16,v58
v_and_b32 v58,0xffff0000,v58
v_add_f32 v58,0x3727c5ac,v58
v_cvt_pk_bf16_f32 v58,v58,v58
v_and_b32 v58,0xffff0000,v58
v_sqrt_f32 v58,v58
v_pk_add_f32 v[48:49],v[32:33],v[56:57] op_sel_hi:[1,0] neg_lo:[0,1] neg_hi:[0,1]
v_pk_add_f32 v[50:51],v[34:35],v[56:57] op_sel_hi:[1,0] neg_lo:[0,1] neg_hi:[0,1]
v_pk_add_f32 v[52:53],v[36:37],v[56:57] op_sel_hi:[1,0] neg_lo:[0,1] neg_hi:[0,1]
v_pk_add_f32 v[54:55],v[38:39],v[56:57] op_sel_hi:[1,0] neg_lo:[0,1] neg_hi:[0,1]
v_cvt_pk_bf16_f32 v58,v58,v58
v_and_b32 v58,0xffff0000,v58
v_rcp_f32 v58,v58
v_cvt_pk_bf16_f32 v40,v48,v49
v_cvt_pk_bf16_f32 v41,v50,v51
v_cvt_pk_bf16_f32 v42,v52,v53
v_cvt_pk_bf16_f32 v43,v54,v55
v_lshlrev_b32 v48,16,v40
v_and_b32 v49,0xffff0000,v40
v_lshlrev_b32 v50,16,v41
v_and_b32 v51,0xffff0000,v41
v_lshlrev_b32 v52,16,v42
v_and_b32 v53,0xffff0000,v42
v_lshlrev_b32 v54,16,v43
v_and_b32 v55,0xffff0000,v43
v_pk_mul_f32 v[48:49],v[48:49],v[58:59] op_sel_hi:[1,0]
v_pk_mul_f32 v[50:51],v[50:51],v[58:59] op_sel_hi:[1,0]
v_pk_mul_f32 v[52:53],v[52:53],v[58:59] op_sel_hi:[1,0]
v_pk_mul_f32 v[54:55],v[54:55],v[58:59] op_sel_hi:[1,0]
v_cvt_pk_bf16_f32 v40,v48,v49
v_cvt_pk_bf16_f32 v41,v50,v51
v_cvt_pk_bf16_f32 v42,v52,v53
v_cvt_pk_bf16_f32 v43,v54,v55
buffer_store_dwordx4 v[40:43],v0,s[8:11],s57 offen offset:0 sc1
v_lshlrev_b32 v32,16,v28
v_and_b32 v33,0xffff0000,v28
v_lshlrev_b32 v34,16,v29
v_and_b32 v35,0xffff0000,v29
v_lshlrev_b32 v36,16,v30
v_and_b32 v37,0xffff0000,v30
v_lshlrev_b32 v38,16,v31
v_and_b32 v39,0xffff0000,v31
v_readfirstlane_b32 s78,v32
s_nop 1
v_pk_add_f32 v[48:49],v[32:33],s[78:79] op_sel_hi:[1,0] neg_lo:[0,1] neg_hi:[0,1]
v_pk_add_f32 v[50:51],v[34:35],s[78:79] op_sel_hi:[1,0] neg_lo:[0,1] neg_hi:[0,1]
v_pk_add_f32 v[52:53],v[36:37],s[78:79] op_sel_hi:[1,0] neg_lo:[0,1] neg_hi:[0,1]
v_pk_add_f32 v[54:55],v[38:39],s[78:79] op_sel_hi:[1,0] neg_lo:[0,1] neg_hi:[0,1]
v_pk_add_f32 v[56:57],v[48:49],v[50:51]
v_pk_mul_f32 v[58:59],v[48:49],v[48:49]
v_pk_add_f32 v[60:61],v[52:53],v[54:55]
v_pk_fma_f32 v[58:59],v[50:51],v[50:51],v[58:59]
v_pk_add_f32 v[56:57],v[56:57],v[60:61]
v_pk_fma_f32 v[58:59],v[52:53],v[52:53],v[58:59]
v_add_f32 v56,v56,v57
v_pk_fma_f32 v[58:59],v[54:55],v[54:55],v[58:59]
v_add_f32 v58,v58,v59
s_nop 1
v_permlane32_swap_b32 v56,v58
v_add_f32 v56,v56,v58
s_nop 1
v_add_f32_dpp v56,v56,v56 row_ror:8 row_mask:0xf bank_mask:0xf
s_nop 1
v_add_f32_dpp v56,v56,v56 row_ror:4 row_mask:0xf bank_mask:0xf
s_nop 1
v_add_f32_dpp v56,v56,v56 row_ror:2 row_mask:0xf bank_mask:0xf
s_nop 1
v_add_f32_dpp v56,v56,v56 row_ror:1 row_mask:0xf bank_mask:0xf
v_mov_b32 v58,v56
s_nop 1
v_permlane16_swap_b32 v56,v58
v_add_f32 v56,v56,v58
v_mul_f32 v56,0x3b000000,v56
v_mov_b32 v58,v56
s_nop 1
v_permlane32_swap_b32 v56,v58
v_fma_f32 v58,-v56,v56,v58
v_add_f32 v56,s78,v56
v_max_f32 v58,0,v58
v_cvt_pk_bf16_f32 v58,v56,v58
v_lshlrev_b32 v56,16,v58
v_and_b32 v58,0xffff0000,v58
v_add_f32 v58,0x3727c5ac,v58
v_cvt_pk_bf16_f32 v58,v58,v58
v_and_b32 v58,0xffff0000,v58
v_sqrt_f32 v58,v58
v_pk_add_f32 v[48:49],v[32:33],v[56:57] op_sel_hi:[1,0] neg_lo:[0,1] neg_hi:[0,1]
v_pk_add_f32 v[50:51],v[34:35],v[56:57] op_sel_hi:[1,0] neg_lo:[0,1] neg_hi:[0,1]
v_pk_add_f32 v[52:53],v[36:37],v[56:57] op_sel_hi:[1,0] neg_lo:[0,1] neg_hi:[0,1]
v_pk_add_f32 v[54:55],v[38:39],v[56:57] op_sel_hi:[1,0] neg_lo:[0,1] neg_hi:[0,1]
v_cvt_pk_bf16_f32 v58,v58,v58
v_and_b32 v58,0xffff0000,v58
v_rcp_f32 v58,v58
v_cvt_pk_bf16_f32 v44,v48,v49
v_cvt_pk_bf16_f32 v45,v50,v51
v_cvt_pk_bf16_f32 v46,v52,v53
v_cvt_pk_bf16_f32 v47,v54,v55
v_lshlrev_b32 v48,16,v44
v_and_b32 v49,0xffff0000,v44
v_lshlrev_b32 v50,16,v45
v_and_b32 v51,0xffff0000,v45
v_lshlrev_b32 v52,16,v46
v_and_b32 v53,0xffff0000,v46
v_lshlrev_b32 v54,16,v47
v_and_b32 v55,0xffff0000,v47
v_pk_mul_f32 v[48:49],v[48:49],v[58:59] op_sel_hi:[1,0]
v_pk_mul_f32 v[50:51],v[50:51],v[58:59] op_sel_hi:[1,0]
v_pk_mul_f32 v[52:53],v[52:53],v[58:59] op_sel_hi:[1,0]
v_pk_mul_f32 v[54:55],v[54:55],v[58:59] op_sel_hi:[1,0]
v_cvt_pk_bf16_f32 v44,v48,v49
v_cvt_pk_bf16_f32 v45,v50,v51
v_cvt_pk_bf16_f32 v46,v52,v53
v_cvt_pk_bf16_f32 v47,v54,v55
buffer_store_dwordx4 v[44:47],v0,s[8:11],s57 offen offset:1024 sc1
s_mov_b32 s4,s18
s_mov_b32 s5,s19
s_mov_b32 s6,8192
s_mov_b32 s7,0x20000
s_cmp_ge_u32 s2,2
s_cbranch_scc1 L_m0_2
s_lshl_b32 s56,s2,2
s_add_u32 s56,s56,s46
v_bfe_u32 v2,v1,2,2
v_and_b32 v3,1,v1
v_lshl_add_u32 v2,v2,1,v3
v_lshlrev_b32 v2,10,v2
v_lshrrev_b32 v3,4,v1
v_lshl_add_u32 v2,v3,5,v2
v_and_b32 v3,2,v1
v_lshl_add_u32 v2,v3,1,v2
s_lshl_b32 s57,s56,7
buffer_load_dword v32,v2,s[4:7],s57 offen offset:0
buffer_load_dword v33,v2,s[4:7],s57 offen offset:8
buffer_load_dword v34,v2,s[4:7],s57 offen offset:16
buffer_load_dword v35,v2,s[4:7],s57 offen offset:24
v_lshrrev_b32 v2,3,v1
v_lshlrev_b32 v2,9,v2
v_and_b32 v3,7,v1
v_lshl_add_u32 v2,v3,4,v2
s_and_b32 s57,s56,1
s_lshl_b32 s57,s57,8
s_and_b32 s58,s56,2
s_lshl_b32 s58,s58,6
s_add_u32 s57,s57,s58
s_and_b32 s58,s56,4
s_lshl_b32 s58,s58,10
s_add_u32 s57,s57,s58
s_waitcnt vmcnt(0)
s_add_u32 s58,s57,11534336
buffer_store_dwordx4 v[32:35],v2,s[8:11],s58 offen sc1
s_add_u32 s58,s57,12582912
buffer_store_dwordx4 v[32:35],v2,s[8:11],s58 offen sc1
s_add_u32 s58,s57,17825792
buffer_store_dwordx4 v[32:35],v2,s[8:11],s58 offen sc1
L_m0_2:
s_waitcnt vmcnt(0) lgkmcnt(0)
s_barrier
s_cmp_lg_u32 s46,0
s_cbranch_scc1 L_ar_3
v_mov_b32 v124,128
v_mov_b32 v125,s53
s_mov_b64 exec,1
buffer_atomic_add v125,v124,s[12:15],0 offen
s_mov_b64 exec,-1
L_ar_3:
L_roles:
s_cmp_ge_u32 s48,6
s_cbranch_scc1 L_ra_6
v_and_b32 v2,15,v1
v_lshlrev_b32 v2,2,v2
v_lshrrev_b32 v3,4,v1
v_lshl_add_u32 v4,v3,16,v2
v_lshl_add_u32 v5,v3,13,v2
s_lshl_b32 s58,s47,8
s_lshl_b32 s57,s46,6
s_add_u32 s58,s58,s57
s_lshl_b32 s59,s47,17
s_add_u32 s59,s59,s57
s_lshl_b32 s60,s46,15
v_add_u32 v6,s60,v0
s_mov_b32 s61,0x05040100
s_mov_b32 s62,0x07060302
s_lshl_b32 s63,s46,19
s_cmp_lt_u32 s48,3
s_cselect_b32 s63,s63,0
s_mov_b32 s4,s22
s_mov_b32 s5,s23
s_mov_b32 s6,4194304
s_mov_b32 s7,0x20000
s_xor_b32 s56,s63,0
s_add_u32 s56,s56,s58
buffer_load_dword v24,v4,s[4:7],s56 offen
s_add_u32 s56,s56,8192
buffer_load_dword v25,v4,s[4:7],s56 offen
s_add_u32 s56,s56,8192
buffer_load_dword v26,v4,s[4:7],s56 offen
s_add_u32 s56,s56,8192
buffer_load_dword v27,v4,s[4:7],s56 offen
s_add_u32 s56,s56,8192
buffer_load_dword v28,v4,s[4:7],s56 offen
s_add_u32 s56,s56,8192
buffer_load_dword v29,v4,s[4:7],s56 offen
s_add_u32 s56,s56,8192
buffer_load_dword v30,v4,s[4:7],s56 offen
s_add_u32 s56,s56,8192
buffer_load_dword v31,v4,s[4:7],s56 offen
s_xor_b32 s56,s63,262144
s_add_u32 s56,s56,s58
buffer_load_dword v32,v4,s[4:7],s56 offen
s_add_u32 s56,s56,8192
buffer_load_dword v33,v4,s[4:7],s56 offen
s_add_u32 s56,s56,8192
buffer_load_dword v34,v4,s[4:7],s56 offen
s_add_u32 s56,s56,8192
buffer_load_dword v35,v4,s[4:7],s56 offen
s_add_u32 s56,s56,8192
buffer_load_dword v36,v4,s[4:7],s56 offen
s_add_u32 s56,s56,8192
buffer_load_dword v37,v4,s[4:7],s56 offen
s_add_u32 s56,s56,8192
buffer_load_dword v38,v4,s[4:7],s56 offen
s_add_u32 s56,s56,8192
buffer_load_dword v39,v4,s[4:7],s56 offen
s_xor_b32 s56,s63,524288
s_add_u32 s56,s56,s58
buffer_load_dword v40,v4,s[4:7],s56 offen
s_add_u32 s56,s56,8192
buffer_load_dword v41,v4,s[4:7],s56 offen
s_add_u32 s56,s56,8192
buffer_load_dword v42,v4,s[4:7],s56 offen
s_add_u32 s56,s56,8192
buffer_load_dword v43,v4,s[4:7],s56 offen
s_add_u32 s56,s56,8192
buffer_load_dword v44,v4,s[4:7],s56 offen
s_add_u32 s56,s56,8192
buffer_load_dword v45,v4,s[4:7],s56 offen
s_add_u32 s56,s56,8192
buffer_load_dword v46,v4,s[4:7],s56 offen
s_add_u32 s56,s56,8192
buffer_load_dword v47,v4,s[4:7],s56 offen
s_xor_b32 s56,s63,786432
s_add_u32 s56,s56,s58
buffer_load_dword v48,v4,s[4:7],s56 offen
s_add_u32 s56,s56,8192
buffer_load_dword v49,v4,s[4:7],s56 offen
s_add_u32 s56,s56,8192
buffer_load_dword v50,v4,s[4:7],s56 offen
s_add_u32 s56,s56,8192
buffer_load_dword v51,v4,s[4:7],s56 offen
s_add_u32 s56,s56,8192
buffer_load_dword v52,v4,s[4:7],s56 offen
s_add_u32 s56,s56,8192
buffer_load_dword v53,v4,s[4:7],s56 offen
s_add_u32 s56,s56,8192
buffer_load_dword v54,v4,s[4:7],s56 offen
s_add_u32 s56,s56,8192
buffer_load_dword v55,v4,s[4:7],s56 offen
s_xor_b32 s56,s63,1048576
s_add_u32 s56,s56,s58
buffer_load_dword v56,v4,s[4:7],s56 offen
s_add_u32 s56,s56,8192
buffer_load_dword v57,v4,s[4:7],s56 offen
s_add_u32 s56,s56,8192
buffer_load_dword v58,v4,s[4:7],s56 offen
s_add_u32 s56,s56,8192
buffer_load_dword v59,v4,s[4:7],s56 offen
s_add_u32 s56,s56,8192
buffer_load_dword v60,v4,s[4:7],s56 offen
s_add_u32 s56,s56,8192
buffer_load_dword v61,v4,s[4:7],s56 offen
s_add_u32 s56,s56,8192
buffer_load_dword v62,v4,s[4:7],s56 offen
s_add_u32 s56,s56,8192
buffer_load_dword v63,v4,s[4:7],s56 offen
s_xor_b32 s56,s63,1310720
s_add_u32 s56,s56,s58
buffer_load_dword v64,v4,s[4:7],s56 offen
s_add_u32 s56,s56,8192
buffer_load_dword v65,v4,s[4:7],s56 offen
s_add_u32 s56,s56,8192
buffer_load_dword v66,v4,s[4:7],s56 offen
s_add_u32 s56,s56,8192
buffer_load_dword v67,v4,s[4:7],s56 offen
s_add_u32 s56,s56,8192
buffer_load_dword v68,v4,s[4:7],s56 offen
s_add_u32 s56,s56,8192
buffer_load_dword v69,v4,s[4:7],s56 offen
s_add_u32 s56,s56,8192
buffer_load_dword v70,v4,s[4:7],s56 offen
s_add_u32 s56,s56,8192
buffer_load_dword v71,v4,s[4:7],s56 offen
s_xor_b32 s56,s63,1572864
s_add_u32 s56,s56,s58
buffer_load_dword v72,v4,s[4:7],s56 offen
s_add_u32 s56,s56,8192
buffer_load_dword v73,v4,s[4:7],s56 offen
s_add_u32 s56,s56,8192
buffer_load_dword v74,v4,s[4:7],s56 offen
s_add_u32 s56,s56,8192
buffer_load_dword v75,v4,s[4:7],s56 offen
s_add_u32 s56,s56,8192
buffer_load_dword v76,v4,s[4:7],s56 offen
s_add_u32 s56,s56,8192
buffer_load_dword v77,v4,s[4:7],s56 offen
s_add_u32 s56,s56,8192
buffer_load_dword v78,v4,s[4:7],s56 offen
s_add_u32 s56,s56,8192
buffer_load_dword v79,v4,s[4:7],s56 offen
s_waitcnt vmcnt(48)
v_perm_b32 v80,v25,v24,s61
v_perm_b32 v81,v27,v26,s61
v_perm_b32 v82,v29,v28,s61
v_perm_b32 v83,v31,v30,s61
v_perm_b32 v84,v25,v24,s62
v_perm_b32 v85,v27,v26,s62
v_perm_b32 v86,v29,v28,s62
v_perm_b32 v87,v31,v30,s62
v_accvgpr_write_b32 a128,v80
v_accvgpr_write_b32 a129,v81
v_accvgpr_write_b32 a130,v82
v_accvgpr_write_b32 a131,v83
v_accvgpr_write_b32 a136,v84
v_accvgpr_write_b32 a137,v85
v_accvgpr_write_b32 a138,v86
v_accvgpr_write_b32 a139,v87
s_xor_b32 s56,s63,1835008
s_add_u32 s56,s56,s58
buffer_load_dword v24,v4,s[4:7],s56 offen
s_add_u32 s56,s56,8192
buffer_load_dword v25,v4,s[4:7],s56 offen
s_add_u32 s56,s56,8192
buffer_load_dword v26,v4,s[4:7],s56 offen
s_add_u32 s56,s56,8192
buffer_load_dword v27,v4,s[4:7],s56 offen
s_add_u32 s56,s56,8192
buffer_load_dword v28,v4,s[4:7],s56 offen
s_add_u32 s56,s56,8192
buffer_load_dword v29,v4,s[4:7],s56 offen
s_add_u32 s56,s56,8192
buffer_load_dword v30,v4,s[4:7],s56 offen
s_add_u32 s56,s56,8192
buffer_load_dword v31,v4,s[4:7],s56 offen
s_waitcnt vmcnt(48)
v_perm_b32 v80,v33,v32,s61
v_perm_b32 v81,v35,v34,s61
v_perm_b32 v82,v37,v36,s61
v_perm_b32 v83,v39,v38,s61
v_perm_b32 v84,v33,v32,s62
v_perm_b32 v85,v35,v34,s62
v_perm_b32 v86,v37,v36,s62
v_perm_b32 v87,v39,v38,s62
v_accvgpr_write_b32 a132,v80
v_accvgpr_write_b32 a133,v81
v_accvgpr_write_b32 a134,v82
v_accvgpr_write_b32 a135,v83
v_accvgpr_write_b32 a140,v84
v_accvgpr_write_b32 a141,v85
v_accvgpr_write_b32 a142,v86
v_accvgpr_write_b32 a143,v87
s_xor_b32 s56,s63,2097152
s_add_u32 s56,s56,s58
buffer_load_dword v32,v4,s[4:7],s56 offen
s_add_u32 s56,s56,8192
buffer_load_dword v33,v4,s[4:7],s56 offen
s_add_u32 s56,s56,8192
buffer_load_dword v34,v4,s[4:7],s56 offen
s_add_u32 s56,s56,8192
buffer_load_dword v35,v4,s[4:7],s56 offen
s_add_u32 s56,s56,8192
buffer_load_dword v36,v4,s[4:7],s56 offen
s_add_u32 s56,s56,8192
buffer_load_dword v37,v4,s[4:7],s56 offen
s_add_u32 s56,s56,8192
buffer_load_dword v38,v4,s[4:7],s56 offen
s_add_u32 s56,s56,8192
buffer_load_dword v39,v4,s[4:7],s56 offen
s_waitcnt vmcnt(48)
v_perm_b32 v80,v41,v40,s61
v_perm_b32 v81,v43,v42,s61
v_perm_b32 v82,v45,v44,s61
v_perm_b32 v83,v47,v46,s61
v_perm_b32 v84,v41,v40,s62
v_perm_b32 v85,v43,v42,s62
v_perm_b32 v86,v45,v44,s62
v_perm_b32 v87,v47,v46,s62
v_accvgpr_write_b32 a144,v80
v_accvgpr_write_b32 a145,v81
v_accvgpr_write_b32 a146,v82
v_accvgpr_write_b32 a147,v83
v_accvgpr_write_b32 a152,v84
v_accvgpr_write_b32 a153,v85
v_accvgpr_write_b32 a154,v86
v_accvgpr_write_b32 a155,v87
s_xor_b32 s56,s63,2359296
s_add_u32 s56,s56,s58
buffer_load_dword v40,v4,s[4:7],s56 offen
s_add_u32 s56,s56,8192
buffer_load_dword v41,v4,s[4:7],s56 offen
s_add_u32 s56,s56,8192
buffer_load_dword v42,v4,s[4:7],s56 offen
s_add_u32 s56,s56,8192
buffer_load_dword v43,v4,s[4:7],s56 offen
s_add_u32 s56,s56,8192
buffer_load_dword v44,v4,s[4:7],s56 offen
s_add_u32 s56,s56,8192
buffer_load_dword v45,v4,s[4:7],s56 offen
s_add_u32 s56,s56,8192
buffer_load_dword v46,v4,s[4:7],s56 offen
s_add_u32 s56,s56,8192
buffer_load_dword v47,v4,s[4:7],s56 offen
s_waitcnt vmcnt(48)
v_perm_b32 v80,v49,v48,s61
v_perm_b32 v81,v51,v50,s61
v_perm_b32 v82,v53,v52,s61
v_perm_b32 v83,v55,v54,s61
v_perm_b32 v84,v49,v48,s62
v_perm_b32 v85,v51,v50,s62
v_perm_b32 v86,v53,v52,s62
v_perm_b32 v87,v55,v54,s62
v_accvgpr_write_b32 a148,v80
v_accvgpr_write_b32 a149,v81
v_accvgpr_write_b32 a150,v82
v_accvgpr_write_b32 a151,v83
v_accvgpr_write_b32 a156,v84
v_accvgpr_write_b32 a157,v85
v_accvgpr_write_b32 a158,v86
v_accvgpr_write_b32 a159,v87
s_xor_b32 s56,s63,2621440
s_add_u32 s56,s56,s58
buffer_load_dword v48,v4,s[4:7],s56 offen
s_add_u32 s56,s56,8192
buffer_load_dword v49,v4,s[4:7],s56 offen
s_add_u32 s56,s56,8192
buffer_load_dword v50,v4,s[4:7],s56 offen
s_add_u32 s56,s56,8192
buffer_load_dword v51,v4,s[4:7],s56 offen
s_add_u32 s56,s56,8192
buffer_load_dword v52,v4,s[4:7],s56 offen
s_add_u32 s56,s56,8192
buffer_load_dword v53,v4,s[4:7],s56 offen
s_add_u32 s56,s56,8192
buffer_load_dword v54,v4,s[4:7],s56 offen
s_add_u32 s56,s56,8192
buffer_load_dword v55,v4,s[4:7],s56 offen
s_waitcnt vmcnt(48)
v_perm_b32 v80,v57,v56,s61
v_perm_b32 v81,v59,v58,s61
v_perm_b32 v82,v61,v60,s61
v_perm_b32 v83,v63,v62,s61
v_perm_b32 v84,v57,v56,s62
v_perm_b32 v85,v59,v58,s62
v_perm_b32 v86,v61,v60,s62
v_perm_b32 v87,v63,v62,s62
v_accvgpr_write_b32 a160,v80
v_accvgpr_write_b32 a161,v81
v_accvgpr_write_b32 a162,v82
v_accvgpr_write_b32 a163,v83
v_accvgpr_write_b32 a168,v84
v_accvgpr_write_b32 a169,v85
v_accvgpr_write_b32 a170,v86
v_accvgpr_write_b32 a171,v87
s_xor_b32 s56,s63,2883584
s_add_u32 s56,s56,s58
buffer_load_dword v56,v4,s[4:7],s56 offen
s_add_u32 s56,s56,8192
buffer_load_dword v57,v4,s[4:7],s56 offen
s_add_u32 s56,s56,8192
buffer_load_dword v58,v4,s[4:7],s56 offen
s_add_u32 s56,s56,8192
buffer_load_dword v59,v4,s[4:7],s56 offen
s_add_u32 s56,s56,8192
buffer_load_dword v60,v4,s[4:7],s56 offen
s_add_u32 s56,s56,8192
buffer_load_dword v61,v4,s[4:7],s56 offen
s_add_u32 s56,s56,8192
buffer_load_dword v62,v4,s[4:7],s56 offen
s_add_u32 s56,s56,8192
buffer_load_dword v63,v4,s[4:7],s56 offen
s_waitcnt vmcnt(48)
v_perm_b32 v80,v65,v64,s61
v_perm_b32 v81,v67,v66,s61
v_perm_b32 v82,v69,v68,s61
v_perm_b32 v83,v71,v70,s61
v_perm_b32 v84,v65,v64,s62
v_perm_b32 v85,v67,v66,s62
v_perm_b32 v86,v69,v68,s62
v_perm_b32 v87,v71,v70,s62
v_accvgpr_write_b32 a164,v80
v_accvgpr_write_b32 a165,v81
v_accvgpr_write_b32 a166,v82
v_accvgpr_write_b32 a167,v83
v_accvgpr_write_b32 a172,v84
v_accvgpr_write_b32 a173,v85
v_accvgpr_write_b32 a174,v86
v_accvgpr_write_b32 a175,v87
s_xor_b32 s56,s63,3145728
s_add_u32 s56,s56,s58
buffer_load_dword v64,v4,s[4:7],s56 offen
s_add_u32 s56,s56,8192
buffer_load_dword v65,v4,s[4:7],s56 offen
s_add_u32 s56,s56,8192
buffer_load_dword v66,v4,s[4:7],s56 offen
s_add_u32 s56,s56,8192
buffer_load_dword v67,v4,s[4:7],s56 offen
s_add_u32 s56,s56,8192
buffer_load_dword v68,v4,s[4:7],s56 offen
s_add_u32 s56,s56,8192
buffer_load_dword v69,v4,s[4:7],s56 offen
s_add_u32 s56,s56,8192
buffer_load_dword v70,v4,s[4:7],s56 offen
s_add_u32 s56,s56,8192
buffer_load_dword v71,v4,s[4:7],s56 offen
s_waitcnt vmcnt(48)
v_perm_b32 v80,v73,v72,s61
v_perm_b32 v81,v75,v74,s61
v_perm_b32 v82,v77,v76,s61
v_perm_b32 v83,v79,v78,s61
v_perm_b32 v84,v73,v72,s62
v_perm_b32 v85,v75,v74,s62
v_perm_b32 v86,v77,v76,s62
v_perm_b32 v87,v79,v78,s62
v_accvgpr_write_b32 a176,v80
v_accvgpr_write_b32 a177,v81
v_accvgpr_write_b32 a178,v82
v_accvgpr_write_b32 a179,v83
v_accvgpr_write_b32 a184,v84
v_accvgpr_write_b32 a185,v85
v_accvgpr_write_b32 a186,v86
v_accvgpr_write_b32 a187,v87
s_xor_b32 s56,s63,3407872
s_add_u32 s56,s56,s58
buffer_load_dword v72,v4,s[4:7],s56 offen
s_add_u32 s56,s56,8192
buffer_load_dword v73,v4,s[4:7],s56 offen
s_add_u32 s56,s56,8192
buffer_load_dword v74,v4,s[4:7],s56 offen
s_add_u32 s56,s56,8192
buffer_load_dword v75,v4,s[4:7],s56 offen
s_add_u32 s56,s56,8192
buffer_load_dword v76,v4,s[4:7],s56 offen
s_add_u32 s56,s56,8192
buffer_load_dword v77,v4,s[4:7],s56 offen
s_add_u32 s56,s56,8192
buffer_load_dword v78,v4,s[4:7],s56 offen
s_add_u32 s56,s56,8192
buffer_load_dword v79,v4,s[4:7],s56 offen
s_waitcnt vmcnt(48)
v_perm_b32 v80,v25,v24,s61
v_perm_b32 v81,v27,v26,s61
v_perm_b32 v82,v29,v28,s61
v_perm_b32 v83,v31,v30,s61
v_perm_b32 v84,v25,v24,s62
v_perm_b32 v85,v27,v26,s62
v_perm_b32 v86,v29,v28,s62
v_perm_b32 v87,v31,v30,s62
v_accvgpr_write_b32 a180,v80
v_accvgpr_write_b32 a181,v81
v_accvgpr_write_b32 a182,v82
v_accvgpr_write_b32 a183,v83
v_accvgpr_write_b32 a188,v84
v_accvgpr_write_b32 a189,v85
v_accvgpr_write_b32 a190,v86
v_accvgpr_write_b32 a191,v87
s_xor_b32 s56,s63,3670016
s_add_u32 s56,s56,s58
buffer_load_dword v24,v4,s[4:7],s56 offen
s_add_u32 s56,s56,8192
buffer_load_dword v25,v4,s[4:7],s56 offen
s_add_u32 s56,s56,8192
buffer_load_dword v26,v4,s[4:7],s56 offen
s_add_u32 s56,s56,8192
buffer_load_dword v27,v4,s[4:7],s56 offen
s_add_u32 s56,s56,8192
buffer_load_dword v28,v4,s[4:7],s56 offen
s_add_u32 s56,s56,8192
buffer_load_dword v29,v4,s[4:7],s56 offen
s_add_u32 s56,s56,8192
buffer_load_dword v30,v4,s[4:7],s56 offen
s_add_u32 s56,s56,8192
buffer_load_dword v31,v4,s[4:7],s56 offen
s_waitcnt vmcnt(48)
v_perm_b32 v80,v33,v32,s61
v_perm_b32 v81,v35,v34,s61
v_perm_b32 v82,v37,v36,s61
v_perm_b32 v83,v39,v38,s61
v_perm_b32 v84,v33,v32,s62
v_perm_b32 v85,v35,v34,s62
v_perm_b32 v86,v37,v36,s62
v_perm_b32 v87,v39,v38,s62
v_accvgpr_write_b32 a192,v80
v_accvgpr_write_b32 a193,v81
v_accvgpr_write_b32 a194,v82
v_accvgpr_write_b32 a195,v83
v_accvgpr_write_b32 a200,v84
v_accvgpr_write_b32 a201,v85
v_accvgpr_write_b32 a202,v86
v_accvgpr_write_b32 a203,v87
s_xor_b32 s56,s63,3932160
s_add_u32 s56,s56,s58
buffer_load_dword v32,v4,s[4:7],s56 offen
s_add_u32 s56,s56,8192
buffer_load_dword v33,v4,s[4:7],s56 offen
s_add_u32 s56,s56,8192
buffer_load_dword v34,v4,s[4:7],s56 offen
s_add_u32 s56,s56,8192
buffer_load_dword v35,v4,s[4:7],s56 offen
s_add_u32 s56,s56,8192
buffer_load_dword v36,v4,s[4:7],s56 offen
s_add_u32 s56,s56,8192
buffer_load_dword v37,v4,s[4:7],s56 offen
s_add_u32 s56,s56,8192
buffer_load_dword v38,v4,s[4:7],s56 offen
s_add_u32 s56,s56,8192
buffer_load_dword v39,v4,s[4:7],s56 offen
s_waitcnt vmcnt(48)
v_perm_b32 v80,v41,v40,s61
v_perm_b32 v81,v43,v42,s61
v_perm_b32 v82,v45,v44,s61
v_perm_b32 v83,v47,v46,s61
v_perm_b32 v84,v41,v40,s62
v_perm_b32 v85,v43,v42,s62
v_perm_b32 v86,v45,v44,s62
v_perm_b32 v87,v47,v46,s62
v_accvgpr_write_b32 a196,v80
v_accvgpr_write_b32 a197,v81
v_accvgpr_write_b32 a198,v82
v_accvgpr_write_b32 a199,v83
v_accvgpr_write_b32 a204,v84
v_accvgpr_write_b32 a205,v85
v_accvgpr_write_b32 a206,v86
v_accvgpr_write_b32 a207,v87
s_mov_b32 s4,s24
s_mov_b32 s5,s25
s_mov_b32 s6,4194304
s_mov_b32 s7,0x20000
s_xor_b32 s56,s63,0
s_add_u32 s56,s56,s58
buffer_load_dword v40,v4,s[4:7],s56 offen
s_add_u32 s56,s56,8192
buffer_load_dword v41,v4,s[4:7],s56 offen
s_add_u32 s56,s56,8192
buffer_load_dword v42,v4,s[4:7],s56 offen
s_add_u32 s56,s56,8192
buffer_load_dword v43,v4,s[4:7],s56 offen
s_add_u32 s56,s56,8192
buffer_load_dword v44,v4,s[4:7],s56 offen
s_add_u32 s56,s56,8192
buffer_load_dword v45,v4,s[4:7],s56 offen
s_add_u32 s56,s56,8192
buffer_load_dword v46,v4,s[4:7],s56 offen
s_add_u32 s56,s56,8192
buffer_load_dword v47,v4,s[4:7],s56 offen
s_waitcnt vmcnt(48)
v_perm_b32 v80,v49,v48,s61
v_perm_b32 v81,v51,v50,s61
v_perm_b32 v82,v53,v52,s61
v_perm_b32 v83,v55,v54,s61
v_perm_b32 v84,v49,v48,s62
v_perm_b32 v85,v51,v50,s62
v_perm_b32 v86,v53,v52,s62
v_perm_b32 v87,v55,v54,s62
v_accvgpr_write_b32 a208,v80
v_accvgpr_write_b32 a209,v81
v_accvgpr_write_b32 a210,v82
v_accvgpr_write_b32 a211,v83
v_accvgpr_write_b32 a216,v84
v_accvgpr_write_b32 a217,v85
v_accvgpr_write_b32 a218,v86
v_accvgpr_write_b32 a219,v87
s_xor_b32 s56,s63,262144
s_add_u32 s56,s56,s58
buffer_load_dword v48,v4,s[4:7],s56 offen
s_add_u32 s56,s56,8192
buffer_load_dword v49,v4,s[4:7],s56 offen
s_add_u32 s56,s56,8192
buffer_load_dword v50,v4,s[4:7],s56 offen
s_add_u32 s56,s56,8192
buffer_load_dword v51,v4,s[4:7],s56 offen
s_add_u32 s56,s56,8192
buffer_load_dword v52,v4,s[4:7],s56 offen
s_add_u32 s56,s56,8192
buffer_load_dword v53,v4,s[4:7],s56 offen
s_add_u32 s56,s56,8192
buffer_load_dword v54,v4,s[4:7],s56 offen
s_add_u32 s56,s56,8192
buffer_load_dword v55,v4,s[4:7],s56 offen
s_waitcnt vmcnt(48)
v_perm_b32 v80,v57,v56,s61
v_perm_b32 v81,v59,v58,s61
v_perm_b32 v82,v61,v60,s61
v_perm_b32 v83,v63,v62,s61
v_perm_b32 v84,v57,v56,s62
v_perm_b32 v85,v59,v58,s62
v_perm_b32 v86,v61,v60,s62
v_perm_b32 v87,v63,v62,s62
v_accvgpr_write_b32 a212,v80
v_accvgpr_write_b32 a213,v81
v_accvgpr_write_b32 a214,v82
v_accvgpr_write_b32 a215,v83
v_accvgpr_write_b32 a220,v84
v_accvgpr_write_b32 a221,v85
v_accvgpr_write_b32 a222,v86
v_accvgpr_write_b32 a223,v87
s_xor_b32 s56,s63,524288
s_add_u32 s56,s56,s58
buffer_load_dword v56,v4,s[4:7],s56 offen
s_add_u32 s56,s56,8192
buffer_load_dword v57,v4,s[4:7],s56 offen
s_add_u32 s56,s56,8192
buffer_load_dword v58,v4,s[4:7],s56 offen
s_add_u32 s56,s56,8192
buffer_load_dword v59,v4,s[4:7],s56 offen
s_add_u32 s56,s56,8192
buffer_load_dword v60,v4,s[4:7],s56 offen
s_add_u32 s56,s56,8192
buffer_load_dword v61,v4,s[4:7],s56 offen
s_add_u32 s56,s56,8192
buffer_load_dword v62,v4,s[4:7],s56 offen
s_add_u32 s56,s56,8192
buffer_load_dword v63,v4,s[4:7],s56 offen
s_waitcnt vmcnt(48)
v_perm_b32 v80,v65,v64,s61
v_perm_b32 v81,v67,v66,s61
v_perm_b32 v82,v69,v68,s61
v_perm_b32 v83,v71,v70,s61
v_perm_b32 v84,v65,v64,s62
v_perm_b32 v85,v67,v66,s62
v_perm_b32 v86,v69,v68,s62
v_perm_b32 v87,v71,v70,s62
v_accvgpr_write_b32 a224,v80
v_accvgpr_write_b32 a225,v81
v_accvgpr_write_b32 a226,v82
v_accvgpr_write_b32 a227,v83
v_accvgpr_write_b32 a232,v84
v_accvgpr_write_b32 a233,v85
v_accvgpr_write_b32 a234,v86
v_accvgpr_write_b32 a235,v87
s_xor_b32 s56,s63,786432
s_add_u32 s56,s56,s58
buffer_load_dword v64,v4,s[4:7],s56 offen
s_add_u32 s56,s56,8192
buffer_load_dword v65,v4,s[4:7],s56 offen
s_add_u32 s56,s56,8192
buffer_load_dword v66,v4,s[4:7],s56 offen
s_add_u32 s56,s56,8192
buffer_load_dword v67,v4,s[4:7],s56 offen
s_add_u32 s56,s56,8192
buffer_load_dword v68,v4,s[4:7],s56 offen
s_add_u32 s56,s56,8192
buffer_load_dword v69,v4,s[4:7],s56 offen
s_add_u32 s56,s56,8192
buffer_load_dword v70,v4,s[4:7],s56 offen
s_add_u32 s56,s56,8192
buffer_load_dword v71,v4,s[4:7],s56 offen
s_waitcnt vmcnt(48)
v_perm_b32 v80,v73,v72,s61
v_perm_b32 v81,v75,v74,s61
v_perm_b32 v82,v77,v76,s61
v_perm_b32 v83,v79,v78,s61
v_perm_b32 v84,v73,v72,s62
v_perm_b32 v85,v75,v74,s62
v_perm_b32 v86,v77,v76,s62
v_perm_b32 v87,v79,v78,s62
v_accvgpr_write_b32 a228,v80
v_accvgpr_write_b32 a229,v81
v_accvgpr_write_b32 a230,v82
v_accvgpr_write_b32 a231,v83
v_accvgpr_write_b32 a236,v84
v_accvgpr_write_b32 a237,v85
v_accvgpr_write_b32 a238,v86
v_accvgpr_write_b32 a239,v87
s_xor_b32 s56,s63,1048576
s_add_u32 s56,s56,s58
buffer_load_dword v72,v4,s[4:7],s56 offen
s_add_u32 s56,s56,8192
buffer_load_dword v73,v4,s[4:7],s56 offen
s_add_u32 s56,s56,8192
buffer_load_dword v74,v4,s[4:7],s56 offen
s_add_u32 s56,s56,8192
buffer_load_dword v75,v4,s[4:7],s56 offen
s_add_u32 s56,s56,8192
buffer_load_dword v76,v4,s[4:7],s56 offen
s_add_u32 s56,s56,8192
buffer_load_dword v77,v4,s[4:7],s56 offen
s_add_u32 s56,s56,8192
buffer_load_dword v78,v4,s[4:7],s56 offen
s_add_u32 s56,s56,8192
buffer_load_dword v79,v4,s[4:7],s56 offen
s_waitcnt vmcnt(48)
v_perm_b32 v80,v25,v24,s61
v_perm_b32 v81,v27,v26,s61
v_perm_b32 v82,v29,v28,s61
v_perm_b32 v83,v31,v30,s61
v_perm_b32 v84,v25,v24,s62
v_perm_b32 v85,v27,v26,s62
v_perm_b32 v86,v29,v28,s62
v_perm_b32 v87,v31,v30,s62
v_accvgpr_write_b32 a240,v80
v_accvgpr_write_b32 a241,v81
v_accvgpr_write_b32 a242,v82
v_accvgpr_write_b32 a243,v83
v_accvgpr_write_b32 a248,v84
v_accvgpr_write_b32 a249,v85
v_accvgpr_write_b32 a250,v86
v_accvgpr_write_b32 a251,v87
s_xor_b32 s56,s63,1310720
s_add_u32 s56,s56,s58
buffer_load_dword v24,v4,s[4:7],s56 offen
s_add_u32 s56,s56,8192
buffer_load_dword v25,v4,s[4:7],s56 offen
s_add_u32 s56,s56,8192
buffer_load_dword v26,v4,s[4:7],s56 offen
s_add_u32 s56,s56,8192
buffer_load_dword v27,v4,s[4:7],s56 offen
s_add_u32 s56,s56,8192
buffer_load_dword v28,v4,s[4:7],s56 offen
s_add_u32 s56,s56,8192
buffer_load_dword v29,v4,s[4:7],s56 offen
s_add_u32 s56,s56,8192
buffer_load_dword v30,v4,s[4:7],s56 offen
s_add_u32 s56,s56,8192
buffer_load_dword v31,v4,s[4:7],s56 offen
s_waitcnt vmcnt(48)
v_perm_b32 v80,v33,v32,s61
v_perm_b32 v81,v35,v34,s61
v_perm_b32 v82,v37,v36,s61
v_perm_b32 v83,v39,v38,s61
v_perm_b32 v84,v33,v32,s62
v_perm_b32 v85,v35,v34,s62
v_perm_b32 v86,v37,v36,s62
v_perm_b32 v87,v39,v38,s62
v_accvgpr_write_b32 a244,v80
v_accvgpr_write_b32 a245,v81
v_accvgpr_write_b32 a246,v82
v_accvgpr_write_b32 a247,v83
v_accvgpr_write_b32 a252,v84
v_accvgpr_write_b32 a253,v85
v_accvgpr_write_b32 a254,v86
v_accvgpr_write_b32 a255,v87
s_xor_b32 s56,s63,1572864
s_add_u32 s56,s56,s58
buffer_load_dword v32,v4,s[4:7],s56 offen
s_add_u32 s56,s56,8192
buffer_load_dword v33,v4,s[4:7],s56 offen
s_add_u32 s56,s56,8192
buffer_load_dword v34,v4,s[4:7],s56 offen
s_add_u32 s56,s56,8192
buffer_load_dword v35,v4,s[4:7],s56 offen
s_add_u32 s56,s56,8192
buffer_load_dword v36,v4,s[4:7],s56 offen
s_add_u32 s56,s56,8192
buffer_load_dword v37,v4,s[4:7],s56 offen
s_add_u32 s56,s56,8192
buffer_load_dword v38,v4,s[4:7],s56 offen
s_add_u32 s56,s56,8192
buffer_load_dword v39,v4,s[4:7],s56 offen
s_waitcnt vmcnt(48)
v_perm_b32 v128,v41,v40,s61
v_perm_b32 v129,v43,v42,s61
v_perm_b32 v130,v45,v44,s61
v_perm_b32 v131,v47,v46,s61
v_perm_b32 v136,v41,v40,s62
v_perm_b32 v137,v43,v42,s62
v_perm_b32 v138,v45,v44,s62
v_perm_b32 v139,v47,v46,s62
s_xor_b32 s56,s63,1835008
s_add_u32 s56,s56,s58
buffer_load_dword v40,v4,s[4:7],s56 offen
s_add_u32 s56,s56,8192
buffer_load_dword v41,v4,s[4:7],s56 offen
s_add_u32 s56,s56,8192
buffer_load_dword v42,v4,s[4:7],s56 offen
s_add_u32 s56,s56,8192
buffer_load_dword v43,v4,s[4:7],s56 offen
s_add_u32 s56,s56,8192
buffer_load_dword v44,v4,s[4:7],s56 offen
s_add_u32 s56,s56,8192
buffer_load_dword v45,v4,s[4:7],s56 offen
s_add_u32 s56,s56,8192
buffer_load_dword v46,v4,s[4:7],s56 offen
s_add_u32 s56,s56,8192
buffer_load_dword v47,v4,s[4:7],s56 offen
s_waitcnt vmcnt(48)
v_perm_b32 v132,v49,v48,s61
v_perm_b32 v133,v51,v50,s61
v_perm_b32 v134,v53,v52,s61
v_perm_b32 v135,v55,v54,s61
v_perm_b32 v140,v49,v48,s62
v_perm_b32 v141,v51,v50,s62
v_perm_b32 v142,v53,v52,s62
v_perm_b32 v143,v55,v54,s62
s_xor_b32 s56,s63,2097152
s_add_u32 s56,s56,s58
buffer_load_dword v48,v4,s[4:7],s56 offen
s_add_u32 s56,s56,8192
buffer_load_dword v49,v4,s[4:7],s56 offen
s_add_u32 s56,s56,8192
buffer_load_dword v50,v4,s[4:7],s56 offen
s_add_u32 s56,s56,8192
buffer_load_dword v51,v4,s[4:7],s56 offen
s_add_u32 s56,s56,8192
buffer_load_dword v52,v4,s[4:7],s56 offen
s_add_u32 s56,s56,8192
buffer_load_dword v53,v4,s[4:7],s56 offen
s_add_u32 s56,s56,8192
buffer_load_dword v54,v4,s[4:7],s56 offen
s_add_u32 s56,s56,8192
buffer_load_dword v55,v4,s[4:7],s56 offen
s_waitcnt vmcnt(48)
v_perm_b32 v144,v57,v56,s61
v_perm_b32 v145,v59,v58,s61
v_perm_b32 v146,v61,v60,s61
v_perm_b32 v147,v63,v62,s61
v_perm_b32 v152,v57,v56,s62
v_perm_b32 v153,v59,v58,s62
v_perm_b32 v154,v61,v60,s62
v_perm_b32 v155,v63,v62,s62
s_xor_b32 s56,s63,2359296
s_add_u32 s56,s56,s58
buffer_load_dword v56,v4,s[4:7],s56 offen
s_add_u32 s56,s56,8192
buffer_load_dword v57,v4,s[4:7],s56 offen
s_add_u32 s56,s56,8192
buffer_load_dword v58,v4,s[4:7],s56 offen
s_add_u32 s56,s56,8192
buffer_load_dword v59,v4,s[4:7],s56 offen
s_add_u32 s56,s56,8192
buffer_load_dword v60,v4,s[4:7],s56 offen
s_add_u32 s56,s56,8192
buffer_load_dword v61,v4,s[4:7],s56 offen
s_add_u32 s56,s56,8192
buffer_load_dword v62,v4,s[4:7],s56 offen
s_add_u32 s56,s56,8192
buffer_load_dword v63,v4,s[4:7],s56 offen
s_waitcnt vmcnt(48)
v_perm_b32 v148,v65,v64,s61
v_perm_b32 v149,v67,v66,s61
v_perm_b32 v150,v69,v68,s61
v_perm_b32 v151,v71,v70,s61
v_perm_b32 v156,v65,v64,s62
v_perm_b32 v157,v67,v66,s62
v_perm_b32 v158,v69,v68,s62
v_perm_b32 v159,v71,v70,s62
s_xor_b32 s56,s63,2621440
s_add_u32 s56,s56,s58
buffer_load_dword v64,v4,s[4:7],s56 offen
s_add_u32 s56,s56,8192
buffer_load_dword v65,v4,s[4:7],s56 offen
s_add_u32 s56,s56,8192
buffer_load_dword v66,v4,s[4:7],s56 offen
s_add_u32 s56,s56,8192
buffer_load_dword v67,v4,s[4:7],s56 offen
s_add_u32 s56,s56,8192
buffer_load_dword v68,v4,s[4:7],s56 offen
s_add_u32 s56,s56,8192
buffer_load_dword v69,v4,s[4:7],s56 offen
s_add_u32 s56,s56,8192
buffer_load_dword v70,v4,s[4:7],s56 offen
s_add_u32 s56,s56,8192
buffer_load_dword v71,v4,s[4:7],s56 offen
s_waitcnt vmcnt(48)
v_perm_b32 v160,v73,v72,s61
v_perm_b32 v161,v75,v74,s61
v_perm_b32 v162,v77,v76,s61
v_perm_b32 v163,v79,v78,s61
v_perm_b32 v168,v73,v72,s62
v_perm_b32 v169,v75,v74,s62
v_perm_b32 v170,v77,v76,s62
v_perm_b32 v171,v79,v78,s62
s_xor_b32 s56,s63,2883584
s_add_u32 s56,s56,s58
buffer_load_dword v72,v4,s[4:7],s56 offen
s_add_u32 s56,s56,8192
buffer_load_dword v73,v4,s[4:7],s56 offen
s_add_u32 s56,s56,8192
buffer_load_dword v74,v4,s[4:7],s56 offen
s_add_u32 s56,s56,8192
buffer_load_dword v75,v4,s[4:7],s56 offen
s_add_u32 s56,s56,8192
buffer_load_dword v76,v4,s[4:7],s56 offen
s_add_u32 s56,s56,8192
buffer_load_dword v77,v4,s[4:7],s56 offen
s_add_u32 s56,s56,8192
buffer_load_dword v78,v4,s[4:7],s56 offen
s_add_u32 s56,s56,8192
buffer_load_dword v79,v4,s[4:7],s56 offen
s_waitcnt vmcnt(48)
v_perm_b32 v164,v25,v24,s61
v_perm_b32 v165,v27,v26,s61
v_perm_b32 v166,v29,v28,s61
v_perm_b32 v167,v31,v30,s61
v_perm_b32 v172,v25,v24,s62
v_perm_b32 v173,v27,v26,s62
v_perm_b32 v174,v29,v28,s62
v_perm_b32 v175,v31,v30,s62
s_xor_b32 s56,s63,3145728
s_add_u32 s56,s56,s58
buffer_load_dword v24,v4,s[4:7],s56 offen
s_add_u32 s56,s56,8192
buffer_load_dword v25,v4,s[4:7],s56 offen
s_add_u32 s56,s56,8192
buffer_load_dword v26,v4,s[4:7],s56 offen
s_add_u32 s56,s56,8192
buffer_load_dword v27,v4,s[4:7],s56 offen
s_add_u32 s56,s56,8192
buffer_load_dword v28,v4,s[4:7],s56 offen
s_add_u32 s56,s56,8192
buffer_load_dword v29,v4,s[4:7],s56 offen
s_add_u32 s56,s56,8192
buffer_load_dword v30,v4,s[4:7],s56 offen
s_add_u32 s56,s56,8192
buffer_load_dword v31,v4,s[4:7],s56 offen
s_waitcnt vmcnt(48)
v_perm_b32 v176,v33,v32,s61
v_perm_b32 v177,v35,v34,s61
v_perm_b32 v178,v37,v36,s61
v_perm_b32 v179,v39,v38,s61
v_perm_b32 v184,v33,v32,s62
v_perm_b32 v185,v35,v34,s62
v_perm_b32 v186,v37,v36,s62
v_perm_b32 v187,v39,v38,s62
s_xor_b32 s56,s63,3407872
s_add_u32 s56,s56,s58
buffer_load_dword v32,v4,s[4:7],s56 offen
s_add_u32 s56,s56,8192
buffer_load_dword v33,v4,s[4:7],s56 offen
s_add_u32 s56,s56,8192
buffer_load_dword v34,v4,s[4:7],s56 offen
s_add_u32 s56,s56,8192
buffer_load_dword v35,v4,s[4:7],s56 offen
s_add_u32 s56,s56,8192
buffer_load_dword v36,v4,s[4:7],s56 offen
s_add_u32 s56,s56,8192
buffer_load_dword v37,v4,s[4:7],s56 offen
s_add_u32 s56,s56,8192
buffer_load_dword v38,v4,s[4:7],s56 offen
s_add_u32 s56,s56,8192
buffer_load_dword v39,v4,s[4:7],s56 offen
s_waitcnt vmcnt(48)
v_perm_b32 v180,v41,v40,s61
v_perm_b32 v181,v43,v42,s61
v_perm_b32 v182,v45,v44,s61
v_perm_b32 v183,v47,v46,s61
v_perm_b32 v188,v41,v40,s62
v_perm_b32 v189,v43,v42,s62
v_perm_b32 v190,v45,v44,s62
v_perm_b32 v191,v47,v46,s62
s_xor_b32 s56,s63,3670016
s_add_u32 s56,s56,s58
buffer_load_dword v40,v4,s[4:7],s56 offen
s_add_u32 s56,s56,8192
buffer_load_dword v41,v4,s[4:7],s56 offen
s_add_u32 s56,s56,8192
buffer_load_dword v42,v4,s[4:7],s56 offen
s_add_u32 s56,s56,8192
buffer_load_dword v43,v4,s[4:7],s56 offen
s_add_u32 s56,s56,8192
buffer_load_dword v44,v4,s[4:7],s56 offen
s_add_u32 s56,s56,8192
buffer_load_dword v45,v4,s[4:7],s56 offen
s_add_u32 s56,s56,8192
buffer_load_dword v46,v4,s[4:7],s56 offen
s_add_u32 s56,s56,8192
buffer_load_dword v47,v4,s[4:7],s56 offen
s_waitcnt vmcnt(48)
v_perm_b32 v192,v49,v48,s61
v_perm_b32 v193,v51,v50,s61
v_perm_b32 v194,v53,v52,s61
v_perm_b32 v195,v55,v54,s61
v_perm_b32 v200,v49,v48,s62
v_perm_b32 v201,v51,v50,s62
v_perm_b32 v202,v53,v52,s62
v_perm_b32 v203,v55,v54,s62
s_xor_b32 s56,s63,3932160
s_add_u32 s56,s56,s58
buffer_load_dword v48,v4,s[4:7],s56 offen
s_add_u32 s56,s56,8192
buffer_load_dword v49,v4,s[4:7],s56 offen
s_add_u32 s56,s56,8192
buffer_load_dword v50,v4,s[4:7],s56 offen
s_add_u32 s56,s56,8192
buffer_load_dword v51,v4,s[4:7],s56 offen
s_add_u32 s56,s56,8192
buffer_load_dword v52,v4,s[4:7],s56 offen
s_add_u32 s56,s56,8192
buffer_load_dword v53,v4,s[4:7],s56 offen
s_add_u32 s56,s56,8192
buffer_load_dword v54,v4,s[4:7],s56 offen
s_add_u32 s56,s56,8192
buffer_load_dword v55,v4,s[4:7],s56 offen
s_waitcnt vmcnt(48)
v_perm_b32 v196,v57,v56,s61
v_perm_b32 v197,v59,v58,s61
v_perm_b32 v198,v61,v60,s61
v_perm_b32 v199,v63,v62,s61
v_perm_b32 v204,v57,v56,s62
v_perm_b32 v205,v59,v58,s62
v_perm_b32 v206,v61,v60,s62
v_perm_b32 v207,v63,v62,s62
s_mov_b32 s4,s20
s_mov_b32 s5,s21
s_mov_b32 s6,4194304
s_mov_b32 s7,0x20000
s_xor_b32 s56,s63,0
s_add_u32 s56,s56,s58
buffer_load_dword v56,v4,s[4:7],s56 offen
s_add_u32 s56,s56,8192
buffer_load_dword v57,v4,s[4:7],s56 offen
s_add_u32 s56,s56,8192
buffer_load_dword v58,v4,s[4:7],s56 offen
s_add_u32 s56,s56,8192
buffer_load_dword v59,v4,s[4:7],s56 offen
s_add_u32 s56,s56,8192
buffer_load_dword v60,v4,s[4:7],s56 offen
s_add_u32 s56,s56,8192
buffer_load_dword v61,v4,s[4:7],s56 offen
s_add_u32 s56,s56,8192
buffer_load_dword v62,v4,s[4:7],s56 offen
s_add_u32 s56,s56,8192
buffer_load_dword v63,v4,s[4:7],s56 offen
s_waitcnt vmcnt(48)
v_perm_b32 v208,v65,v64,s61
v_perm_b32 v209,v67,v66,s61
v_perm_b32 v210,v69,v68,s61
v_perm_b32 v211,v71,v70,s61
v_perm_b32 v216,v65,v64,s62
v_perm_b32 v217,v67,v66,s62
v_perm_b32 v218,v69,v68,s62
v_perm_b32 v219,v71,v70,s62
s_xor_b32 s56,s63,262144
s_add_u32 s56,s56,s58
buffer_load_dword v64,v4,s[4:7],s56 offen
s_add_u32 s56,s56,8192
buffer_load_dword v65,v4,s[4:7],s56 offen
s_add_u32 s56,s56,8192
buffer_load_dword v66,v4,s[4:7],s56 offen
s_add_u32 s56,s56,8192
buffer_load_dword v67,v4,s[4:7],s56 offen
s_add_u32 s56,s56,8192
buffer_load_dword v68,v4,s[4:7],s56 offen
s_add_u32 s56,s56,8192
buffer_load_dword v69,v4,s[4:7],s56 offen
s_add_u32 s56,s56,8192
buffer_load_dword v70,v4,s[4:7],s56 offen
s_add_u32 s56,s56,8192
buffer_load_dword v71,v4,s[4:7],s56 offen
s_waitcnt vmcnt(48)
v_perm_b32 v212,v73,v72,s61
v_perm_b32 v213,v75,v74,s61
v_perm_b32 v214,v77,v76,s61
v_perm_b32 v215,v79,v78,s61
v_perm_b32 v220,v73,v72,s62
v_perm_b32 v221,v75,v74,s62
v_perm_b32 v222,v77,v76,s62
v_perm_b32 v223,v79,v78,s62
s_xor_b32 s56,s63,524288
s_add_u32 s56,s56,s58
buffer_load_dword v72,v4,s[4:7],s56 offen
s_add_u32 s56,s56,8192
buffer_load_dword v73,v4,s[4:7],s56 offen
s_add_u32 s56,s56,8192
buffer_load_dword v74,v4,s[4:7],s56 offen
s_add_u32 s56,s56,8192
buffer_load_dword v75,v4,s[4:7],s56 offen
s_add_u32 s56,s56,8192
buffer_load_dword v76,v4,s[4:7],s56 offen
s_add_u32 s56,s56,8192
buffer_load_dword v77,v4,s[4:7],s56 offen
s_add_u32 s56,s56,8192
buffer_load_dword v78,v4,s[4:7],s56 offen
s_add_u32 s56,s56,8192
buffer_load_dword v79,v4,s[4:7],s56 offen
s_waitcnt vmcnt(48)
v_perm_b32 v224,v25,v24,s61
v_perm_b32 v225,v27,v26,s61
v_perm_b32 v226,v29,v28,s61
v_perm_b32 v227,v31,v30,s61
v_perm_b32 v232,v25,v24,s62
v_perm_b32 v233,v27,v26,s62
v_perm_b32 v234,v29,v28,s62
v_perm_b32 v235,v31,v30,s62
s_xor_b32 s56,s63,786432
s_add_u32 s56,s56,s58
buffer_load_dword v24,v4,s[4:7],s56 offen
s_add_u32 s56,s56,8192
buffer_load_dword v25,v4,s[4:7],s56 offen
s_add_u32 s56,s56,8192
buffer_load_dword v26,v4,s[4:7],s56 offen
s_add_u32 s56,s56,8192
buffer_load_dword v27,v4,s[4:7],s56 offen
s_add_u32 s56,s56,8192
buffer_load_dword v28,v4,s[4:7],s56 offen
s_add_u32 s56,s56,8192
buffer_load_dword v29,v4,s[4:7],s56 offen
s_add_u32 s56,s56,8192
buffer_load_dword v30,v4,s[4:7],s56 offen
s_add_u32 s56,s56,8192
buffer_load_dword v31,v4,s[4:7],s56 offen
s_waitcnt vmcnt(48)
v_perm_b32 v228,v33,v32,s61
v_perm_b32 v229,v35,v34,s61
v_perm_b32 v230,v37,v36,s61
v_perm_b32 v231,v39,v38,s61
v_perm_b32 v236,v33,v32,s62
v_perm_b32 v237,v35,v34,s62
v_perm_b32 v238,v37,v36,s62
v_perm_b32 v239,v39,v38,s62
s_xor_b32 s56,s63,1048576
s_add_u32 s56,s56,s58
buffer_load_dword v32,v4,s[4:7],s56 offen
s_add_u32 s56,s56,8192
buffer_load_dword v33,v4,s[4:7],s56 offen
s_add_u32 s56,s56,8192
buffer_load_dword v34,v4,s[4:7],s56 offen
s_add_u32 s56,s56,8192
buffer_load_dword v35,v4,s[4:7],s56 offen
s_add_u32 s56,s56,8192
buffer_load_dword v36,v4,s[4:7],s56 offen
s_add_u32 s56,s56,8192
buffer_load_dword v37,v4,s[4:7],s56 offen
s_add_u32 s56,s56,8192
buffer_load_dword v38,v4,s[4:7],s56 offen
s_add_u32 s56,s56,8192
buffer_load_dword v39,v4,s[4:7],s56 offen
s_waitcnt vmcnt(48)
v_perm_b32 v240,v41,v40,s61
v_perm_b32 v241,v43,v42,s61
v_perm_b32 v242,v45,v44,s61
v_perm_b32 v243,v47,v46,s61
v_perm_b32 v248,v41,v40,s62
v_perm_b32 v249,v43,v42,s62
v_perm_b32 v250,v45,v44,s62
v_perm_b32 v251,v47,v46,s62
s_xor_b32 s56,s63,1310720
s_add_u32 s56,s56,s58
buffer_load_dword v40,v4,s[4:7],s56 offen
s_add_u32 s56,s56,8192
buffer_load_dword v41,v4,s[4:7],s56 offen
s_add_u32 s56,s56,8192
buffer_load_dword v42,v4,s[4:7],s56 offen
s_add_u32 s56,s56,8192
buffer_load_dword v43,v4,s[4:7],s56 offen
s_add_u32 s56,s56,8192
buffer_load_dword v44,v4,s[4:7],s56 offen
s_add_u32 s56,s56,8192
buffer_load_dword v45,v4,s[4:7],s56 offen
s_add_u32 s56,s56,8192
buffer_load_dword v46,v4,s[4:7],s56 offen
s_add_u32 s56,s56,8192
buffer_load_dword v47,v4,s[4:7],s56 offen
s_waitcnt vmcnt(48)
v_perm_b32 v244,v49,v48,s61
v_perm_b32 v245,v51,v50,s61
v_perm_b32 v246,v53,v52,s61
v_perm_b32 v247,v55,v54,s61
v_perm_b32 v252,v49,v48,s62
v_perm_b32 v253,v51,v50,s62
v_perm_b32 v254,v53,v52,s62
v_perm_b32 v255,v55,v54,s62
s_xor_b32 s56,s63,1572864
s_add_u32 s56,s56,s58
buffer_load_dword v48,v4,s[4:7],s56 offen
s_add_u32 s56,s56,8192
buffer_load_dword v49,v4,s[4:7],s56 offen
s_add_u32 s56,s56,8192
buffer_load_dword v50,v4,s[4:7],s56 offen
s_add_u32 s56,s56,8192
buffer_load_dword v51,v4,s[4:7],s56 offen
s_add_u32 s56,s56,8192
buffer_load_dword v52,v4,s[4:7],s56 offen
s_add_u32 s56,s56,8192
buffer_load_dword v53,v4,s[4:7],s56 offen
s_add_u32 s56,s56,8192
buffer_load_dword v54,v4,s[4:7],s56 offen
s_add_u32 s56,s56,8192
buffer_load_dword v55,v4,s[4:7],s56 offen
s_waitcnt vmcnt(48)
v_perm_b32 v80,v57,v56,s61
v_perm_b32 v81,v59,v58,s61
v_perm_b32 v82,v61,v60,s61
v_perm_b32 v83,v63,v62,s61
v_perm_b32 v84,v57,v56,s62
v_perm_b32 v85,v59,v58,s62
v_perm_b32 v86,v61,v60,s62
v_perm_b32 v87,v63,v62,s62
v_accvgpr_write_b32 a0,v80
v_accvgpr_write_b32 a1,v81
v_accvgpr_write_b32 a2,v82
v_accvgpr_write_b32 a3,v83
v_accvgpr_write_b32 a8,v84
v_accvgpr_write_b32 a9,v85
v_accvgpr_write_b32 a10,v86
v_accvgpr_write_b32 a11,v87
s_xor_b32 s56,s63,1835008
s_add_u32 s56,s56,s58
buffer_load_dword v56,v4,s[4:7],s56 offen
s_add_u32 s56,s56,8192
buffer_load_dword v57,v4,s[4:7],s56 offen
s_add_u32 s56,s56,8192
buffer_load_dword v58,v4,s[4:7],s56 offen
s_add_u32 s56,s56,8192
buffer_load_dword v59,v4,s[4:7],s56 offen
s_add_u32 s56,s56,8192
buffer_load_dword v60,v4,s[4:7],s56 offen
s_add_u32 s56,s56,8192
buffer_load_dword v61,v4,s[4:7],s56 offen
s_add_u32 s56,s56,8192
buffer_load_dword v62,v4,s[4:7],s56 offen
s_add_u32 s56,s56,8192
buffer_load_dword v63,v4,s[4:7],s56 offen
s_waitcnt vmcnt(48)
v_perm_b32 v80,v65,v64,s61
v_perm_b32 v81,v67,v66,s61
v_perm_b32 v82,v69,v68,s61
v_perm_b32 v83,v71,v70,s61
v_perm_b32 v84,v65,v64,s62
v_perm_b32 v85,v67,v66,s62
v_perm_b32 v86,v69,v68,s62
v_perm_b32 v87,v71,v70,s62
v_accvgpr_write_b32 a4,v80
v_accvgpr_write_b32 a5,v81
v_accvgpr_write_b32 a6,v82
v_accvgpr_write_b32 a7,v83
v_accvgpr_write_b32 a12,v84
v_accvgpr_write_b32 a13,v85
v_accvgpr_write_b32 a14,v86
v_accvgpr_write_b32 a15,v87
s_xor_b32 s56,s63,2097152
s_add_u32 s56,s56,s58
buffer_load_dword v64,v4,s[4:7],s56 offen
s_add_u32 s56,s56,8192
buffer_load_dword v65,v4,s[4:7],s56 offen
s_add_u32 s56,s56,8192
buffer_load_dword v66,v4,s[4:7],s56 offen
s_add_u32 s56,s56,8192
buffer_load_dword v67,v4,s[4:7],s56 offen
s_add_u32 s56,s56,8192
buffer_load_dword v68,v4,s[4:7],s56 offen
s_add_u32 s56,s56,8192
buffer_load_dword v69,v4,s[4:7],s56 offen
s_add_u32 s56,s56,8192
buffer_load_dword v70,v4,s[4:7],s56 offen
s_add_u32 s56,s56,8192
buffer_load_dword v71,v4,s[4:7],s56 offen
s_waitcnt vmcnt(48)
v_perm_b32 v80,v73,v72,s61
v_perm_b32 v81,v75,v74,s61
v_perm_b32 v82,v77,v76,s61
v_perm_b32 v83,v79,v78,s61
v_perm_b32 v84,v73,v72,s62
v_perm_b32 v85,v75,v74,s62
v_perm_b32 v86,v77,v76,s62
v_perm_b32 v87,v79,v78,s62
v_accvgpr_write_b32 a16,v80
v_accvgpr_write_b32 a17,v81
v_accvgpr_write_b32 a18,v82
v_accvgpr_write_b32 a19,v83
v_accvgpr_write_b32 a24,v84
v_accvgpr_write_b32 a25,v85
v_accvgpr_write_b32 a26,v86
v_accvgpr_write_b32 a27,v87
s_xor_b32 s56,s63,2359296
s_add_u32 s56,s56,s58
buffer_load_dword v72,v4,s[4:7],s56 offen
s_add_u32 s56,s56,8192
buffer_load_dword v73,v4,s[4:7],s56 offen
s_add_u32 s56,s56,8192
buffer_load_dword v74,v4,s[4:7],s56 offen
s_add_u32 s56,s56,8192
buffer_load_dword v75,v4,s[4:7],s56 offen
s_add_u32 s56,s56,8192
buffer_load_dword v76,v4,s[4:7],s56 offen
s_add_u32 s56,s56,8192
buffer_load_dword v77,v4,s[4:7],s56 offen
s_add_u32 s56,s56,8192
buffer_load_dword v78,v4,s[4:7],s56 offen
s_add_u32 s56,s56,8192
buffer_load_dword v79,v4,s[4:7],s56 offen
s_waitcnt vmcnt(48)
v_perm_b32 v80,v25,v24,s61
v_perm_b32 v81,v27,v26,s61
v_perm_b32 v82,v29,v28,s61
v_perm_b32 v83,v31,v30,s61
v_perm_b32 v84,v25,v24,s62
v_perm_b32 v85,v27,v26,s62
v_perm_b32 v86,v29,v28,s62
v_perm_b32 v87,v31,v30,s62
v_accvgpr_write_b32 a20,v80
v_accvgpr_write_b32 a21,v81
v_accvgpr_write_b32 a22,v82
v_accvgpr_write_b32 a23,v83
v_accvgpr_write_b32 a28,v84
v_accvgpr_write_b32 a29,v85
v_accvgpr_write_b32 a30,v86
v_accvgpr_write_b32 a31,v87
s_xor_b32 s56,s63,2621440
s_add_u32 s56,s56,s58
buffer_load_dword v24,v4,s[4:7],s56 offen
s_add_u32 s56,s56,8192
buffer_load_dword v25,v4,s[4:7],s56 offen
s_add_u32 s56,s56,8192
buffer_load_dword v26,v4,s[4:7],s56 offen
s_add_u32 s56,s56,8192
buffer_load_dword v27,v4,s[4:7],s56 offen
s_add_u32 s56,s56,8192
buffer_load_dword v28,v4,s[4:7],s56 offen
s_add_u32 s56,s56,8192
buffer_load_dword v29,v4,s[4:7],s56 offen
s_add_u32 s56,s56,8192
buffer_load_dword v30,v4,s[4:7],s56 offen
s_add_u32 s56,s56,8192
buffer_load_dword v31,v4,s[4:7],s56 offen
s_waitcnt vmcnt(48)
v_perm_b32 v80,v33,v32,s61
v_perm_b32 v81,v35,v34,s61
v_perm_b32 v82,v37,v36,s61
v_perm_b32 v83,v39,v38,s61
v_perm_b32 v84,v33,v32,s62
v_perm_b32 v85,v35,v34,s62
v_perm_b32 v86,v37,v36,s62
v_perm_b32 v87,v39,v38,s62
v_accvgpr_write_b32 a32,v80
v_accvgpr_write_b32 a33,v81
v_accvgpr_write_b32 a34,v82
v_accvgpr_write_b32 a35,v83
v_accvgpr_write_b32 a40,v84
v_accvgpr_write_b32 a41,v85
v_accvgpr_write_b32 a42,v86
v_accvgpr_write_b32 a43,v87
s_xor_b32 s56,s63,2883584
s_add_u32 s56,s56,s58
buffer_load_dword v32,v4,s[4:7],s56 offen
s_add_u32 s56,s56,8192
buffer_load_dword v33,v4,s[4:7],s56 offen
s_add_u32 s56,s56,8192
buffer_load_dword v34,v4,s[4:7],s56 offen
s_add_u32 s56,s56,8192
buffer_load_dword v35,v4,s[4:7],s56 offen
s_add_u32 s56,s56,8192
buffer_load_dword v36,v4,s[4:7],s56 offen
s_add_u32 s56,s56,8192
buffer_load_dword v37,v4,s[4:7],s56 offen
s_add_u32 s56,s56,8192
buffer_load_dword v38,v4,s[4:7],s56 offen
s_add_u32 s56,s56,8192
buffer_load_dword v39,v4,s[4:7],s56 offen
s_waitcnt vmcnt(48)
v_perm_b32 v80,v41,v40,s61
v_perm_b32 v81,v43,v42,s61
v_perm_b32 v82,v45,v44,s61
v_perm_b32 v83,v47,v46,s61
v_perm_b32 v84,v41,v40,s62
v_perm_b32 v85,v43,v42,s62
v_perm_b32 v86,v45,v44,s62
v_perm_b32 v87,v47,v46,s62
v_accvgpr_write_b32 a36,v80
v_accvgpr_write_b32 a37,v81
v_accvgpr_write_b32 a38,v82
v_accvgpr_write_b32 a39,v83
v_accvgpr_write_b32 a44,v84
v_accvgpr_write_b32 a45,v85
v_accvgpr_write_b32 a46,v86
v_accvgpr_write_b32 a47,v87
s_xor_b32 s56,s63,3145728
s_add_u32 s56,s56,s58
buffer_load_dword v40,v4,s[4:7],s56 offen
s_add_u32 s56,s56,8192
buffer_load_dword v41,v4,s[4:7],s56 offen
s_add_u32 s56,s56,8192
buffer_load_dword v42,v4,s[4:7],s56 offen
s_add_u32 s56,s56,8192
buffer_load_dword v43,v4,s[4:7],s56 offen
s_add_u32 s56,s56,8192
buffer_load_dword v44,v4,s[4:7],s56 offen
s_add_u32 s56,s56,8192
buffer_load_dword v45,v4,s[4:7],s56 offen
s_add_u32 s56,s56,8192
buffer_load_dword v46,v4,s[4:7],s56 offen
s_add_u32 s56,s56,8192
buffer_load_dword v47,v4,s[4:7],s56 offen
s_waitcnt vmcnt(48)
v_perm_b32 v80,v49,v48,s61
v_perm_b32 v81,v51,v50,s61
v_perm_b32 v82,v53,v52,s61
v_perm_b32 v83,v55,v54,s61
v_perm_b32 v84,v49,v48,s62
v_perm_b32 v85,v51,v50,s62
v_perm_b32 v86,v53,v52,s62
v_perm_b32 v87,v55,v54,s62
v_accvgpr_write_b32 a48,v80
v_accvgpr_write_b32 a49,v81
v_accvgpr_write_b32 a50,v82
v_accvgpr_write_b32 a51,v83
v_accvgpr_write_b32 a56,v84
v_accvgpr_write_b32 a57,v85
v_accvgpr_write_b32 a58,v86
v_accvgpr_write_b32 a59,v87
s_xor_b32 s56,s63,3407872
s_add_u32 s56,s56,s58
buffer_load_dword v48,v4,s[4:7],s56 offen
s_add_u32 s56,s56,8192
buffer_load_dword v49,v4,s[4:7],s56 offen
s_add_u32 s56,s56,8192
buffer_load_dword v50,v4,s[4:7],s56 offen
s_add_u32 s56,s56,8192
buffer_load_dword v51,v4,s[4:7],s56 offen
s_add_u32 s56,s56,8192
buffer_load_dword v52,v4,s[4:7],s56 offen
s_add_u32 s56,s56,8192
buffer_load_dword v53,v4,s[4:7],s56 offen
s_add_u32 s56,s56,8192
buffer_load_dword v54,v4,s[4:7],s56 offen
s_add_u32 s56,s56,8192
buffer_load_dword v55,v4,s[4:7],s56 offen
s_waitcnt vmcnt(48)
v_perm_b32 v80,v57,v56,s61
v_perm_b32 v81,v59,v58,s61
v_perm_b32 v82,v61,v60,s61
v_perm_b32 v83,v63,v62,s61
v_perm_b32 v84,v57,v56,s62
v_perm_b32 v85,v59,v58,s62
v_perm_b32 v86,v61,v60,s62
v_perm_b32 v87,v63,v62,s62
v_accvgpr_write_b32 a52,v80
v_accvgpr_write_b32 a53,v81
v_accvgpr_write_b32 a54,v82
v_accvgpr_write_b32 a55,v83
v_accvgpr_write_b32 a60,v84
v_accvgpr_write_b32 a61,v85
v_accvgpr_write_b32 a62,v86
v_accvgpr_write_b32 a63,v87
s_xor_b32 s56,s63,3670016
s_add_u32 s56,s56,s58
buffer_load_dword v56,v4,s[4:7],s56 offen
s_add_u32 s56,s56,8192
buffer_load_dword v57,v4,s[4:7],s56 offen
s_add_u32 s56,s56,8192
buffer_load_dword v58,v4,s[4:7],s56 offen
s_add_u32 s56,s56,8192
buffer_load_dword v59,v4,s[4:7],s56 offen
s_add_u32 s56,s56,8192
buffer_load_dword v60,v4,s[4:7],s56 offen
s_add_u32 s56,s56,8192
buffer_load_dword v61,v4,s[4:7],s56 offen
s_add_u32 s56,s56,8192
buffer_load_dword v62,v4,s[4:7],s56 offen
s_add_u32 s56,s56,8192
buffer_load_dword v63,v4,s[4:7],s56 offen
s_waitcnt vmcnt(48)
v_perm_b32 v80,v65,v64,s61
v_perm_b32 v81,v67,v66,s61
v_perm_b32 v82,v69,v68,s61
v_perm_b32 v83,v71,v70,s61
v_perm_b32 v84,v65,v64,s62
v_perm_b32 v85,v67,v66,s62
v_perm_b32 v86,v69,v68,s62
v_perm_b32 v87,v71,v70,s62
v_accvgpr_write_b32 a64,v80
v_accvgpr_write_b32 a65,v81
v_accvgpr_write_b32 a66,v82
v_accvgpr_write_b32 a67,v83
v_accvgpr_write_b32 a72,v84
v_accvgpr_write_b32 a73,v85
v_accvgpr_write_b32 a74,v86
v_accvgpr_write_b32 a75,v87
s_xor_b32 s56,s63,3932160
s_add_u32 s56,s56,s58
buffer_load_dword v64,v4,s[4:7],s56 offen
s_add_u32 s56,s56,8192
buffer_load_dword v65,v4,s[4:7],s56 offen
s_add_u32 s56,s56,8192
buffer_load_dword v66,v4,s[4:7],s56 offen
s_add_u32 s56,s56,8192
buffer_load_dword v67,v4,s[4:7],s56 offen
s_add_u32 s56,s56,8192
buffer_load_dword v68,v4,s[4:7],s56 offen
s_add_u32 s56,s56,8192
buffer_load_dword v69,v4,s[4:7],s56 offen
s_add_u32 s56,s56,8192
buffer_load_dword v70,v4,s[4:7],s56 offen
s_add_u32 s56,s56,8192
buffer_load_dword v71,v4,s[4:7],s56 offen
s_waitcnt vmcnt(48)
v_perm_b32 v80,v73,v72,s61
v_perm_b32 v81,v75,v74,s61
v_perm_b32 v82,v77,v76,s61
v_perm_b32 v83,v79,v78,s61
v_perm_b32 v84,v73,v72,s62
v_perm_b32 v85,v75,v74,s62
v_perm_b32 v86,v77,v76,s62
v_perm_b32 v87,v79,v78,s62
v_accvgpr_write_b32 a68,v80
v_accvgpr_write_b32 a69,v81
v_accvgpr_write_b32 a70,v82
v_accvgpr_write_b32 a71,v83
v_accvgpr_write_b32 a76,v84
v_accvgpr_write_b32 a77,v85
v_accvgpr_write_b32 a78,v86
v_accvgpr_write_b32 a79,v87
s_waitcnt vmcnt(40)
v_perm_b32 v80,v25,v24,s61
v_perm_b32 v81,v27,v26,s61
v_perm_b32 v82,v29,v28,s61
v_perm_b32 v83,v31,v30,s61
v_perm_b32 v84,v25,v24,s62
v_perm_b32 v85,v27,v26,s62
v_perm_b32 v86,v29,v28,s62
v_perm_b32 v87,v31,v30,s62
v_accvgpr_write_b32 a80,v80
v_accvgpr_write_b32 a81,v81
v_accvgpr_write_b32 a82,v82
v_accvgpr_write_b32 a83,v83
v_accvgpr_write_b32 a88,v84
v_accvgpr_write_b32 a89,v85
v_accvgpr_write_b32 a90,v86
v_accvgpr_write_b32 a91,v87
s_waitcnt vmcnt(32)
v_perm_b32 v80,v33,v32,s61
v_perm_b32 v81,v35,v34,s61
v_perm_b32 v82,v37,v36,s61
v_perm_b32 v83,v39,v38,s61
v_perm_b32 v84,v33,v32,s62
v_perm_b32 v85,v35,v34,s62
v_perm_b32 v86,v37,v36,s62
v_perm_b32 v87,v39,v38,s62
v_accvgpr_write_b32 a84,v80
v_accvgpr_write_b32 a85,v81
v_accvgpr_write_b32 a86,v82
v_accvgpr_write_b32 a87,v83
v_accvgpr_write_b32 a92,v84
v_accvgpr_write_b32 a93,v85
v_accvgpr_write_b32 a94,v86
v_accvgpr_write_b32 a95,v87
s_waitcnt vmcnt(24)
v_perm_b32 v80,v41,v40,s61
v_perm_b32 v81,v43,v42,s61
v_perm_b32 v82,v45,v44,s61
v_perm_b32 v83,v47,v46,s61
v_perm_b32 v84,v41,v40,s62
v_perm_b32 v85,v43,v42,s62
v_perm_b32 v86,v45,v44,s62
v_perm_b32 v87,v47,v46,s62
v_accvgpr_write_b32 a96,v80
v_accvgpr_write_b32 a97,v81
v_accvgpr_write_b32 a98,v82
v_accvgpr_write_b32 a99,v83
v_accvgpr_write_b32 a104,v84
v_accvgpr_write_b32 a105,v85
v_accvgpr_write_b32 a106,v86
v_accvgpr_write_b32 a107,v87
s_waitcnt vmcnt(16)
v_perm_b32 v80,v49,v48,s61
v_perm_b32 v81,v51,v50,s61
v_perm_b32 v82,v53,v52,s61
v_perm_b32 v83,v55,v54,s61
v_perm_b32 v84,v49,v48,s62
v_perm_b32 v85,v51,v50,s62
v_perm_b32 v86,v53,v52,s62
v_perm_b32 v87,v55,v54,s62
v_accvgpr_write_b32 a100,v80
v_accvgpr_write_b32 a101,v81
v_accvgpr_write_b32 a102,v82
v_accvgpr_write_b32 a103,v83
v_accvgpr_write_b32 a108,v84
v_accvgpr_write_b32 a109,v85
v_accvgpr_write_b32 a110,v86
v_accvgpr_write_b32 a111,v87
s_waitcnt vmcnt(8)
v_perm_b32 v80,v57,v56,s61
v_perm_b32 v81,v59,v58,s61
v_perm_b32 v82,v61,v60,s61
v_perm_b32 v83,v63,v62,s61
v_perm_b32 v84,v57,v56,s62
v_perm_b32 v85,v59,v58,s62
v_perm_b32 v86,v61,v60,s62
v_perm_b32 v87,v63,v62,s62
v_accvgpr_write_b32 a112,v80
v_accvgpr_write_b32 a113,v81
v_accvgpr_write_b32 a114,v82
v_accvgpr_write_b32 a115,v83
v_accvgpr_write_b32 a120,v84
v_accvgpr_write_b32 a121,v85
v_accvgpr_write_b32 a122,v86
v_accvgpr_write_b32 a123,v87
s_waitcnt vmcnt(0)
v_perm_b32 v80,v65,v64,s61
v_perm_b32 v81,v67,v66,s61
v_perm_b32 v82,v69,v68,s61
v_perm_b32 v83,v71,v70,s61
v_perm_b32 v84,v65,v64,s62
v_perm_b32 v85,v67,v66,s62
v_perm_b32 v86,v69,v68,s62
v_perm_b32 v87,v71,v70,s62
v_accvgpr_write_b32 a116,v80
v_accvgpr_write_b32 a117,v81
v_accvgpr_write_b32 a118,v82
v_accvgpr_write_b32 a119,v83
v_accvgpr_write_b32 a124,v84
v_accvgpr_write_b32 a125,v85
v_accvgpr_write_b32 a126,v86
v_accvgpr_write_b32 a127,v87
s_cmp_lt_u32 s48,3
s_cbranch_scc1 L_rch_4
s_cmp_eq_u32 s48,3
s_cbranch_scc1 L_rm_5
v_mov_b32 v123,159744
s_cmp_lg_u32 s46,0
s_cbranch_scc1 L_gbd_11
v_mov_b32 v124,128
L_gb_10:
buffer_load_dword v125,v124,s[12:15],0 offen sc1
s_waitcnt vmcnt(0)
v_readfirstlane_b32 s56,v125
ds_write_b32 v123,v125
s_bitcmp1_b32 s56,8
s_cbranch_scc1 L_gbd_11
s_sleep 4
s_sub_u32 s49,s49,1
s_cmp_gt_i32 s49,0
s_cbranch_scc1 L_gb_10
s_branch L_abort
L_gbd_11:
s_waitcnt lgkmcnt(0)
s_barrier
ds_read_b32 v125,v123
s_waitcnt lgkmcnt(0)
v_readfirstlane_b32 s56,v125
s_barrier
s_lshr_b32 s56,s56,16
s_andn2_b32 s56,s56,s3
s_cbranch_scc1 L_spread
v_and_b32 v120,15,v1
v_lshrrev_b32 v121,4,v1
v_mov_b32 v17,1
s_lshl_b32 s56,s46,15
v_add_u32 v18,s56,v0
s_lshl_b32 s56,s46,2
v_add_u32 v125,s56,v121
v_xor_b32 v126,v125,v120
v_lshlrev_b32 v126,4,v126
v_lshl_add_u32 v20,v125,10,v126
v_add_u32 v125,0,v121
v_xor_b32 v125,v125,v120
v_lshlrev_b32 v125,4,v125
v_lshl_add_u32 v125,v120,8,v125
v_add_u32 v4,65536,v125
v_add_u32 v125,4,v121
v_xor_b32 v125,v125,v120
v_lshlrev_b32 v125,4,v125
v_lshl_add_u32 v125,v120,8,v125
v_add_u32 v5,65536,v125
v_add_u32 v125,8,v121
v_xor_b32 v125,v125,v120
v_lshlrev_b32 v125,4,v125
v_lshl_add_u32 v125,v120,8,v125
v_add_u32 v6,65536,v125
v_add_u32 v125,12,v121
v_xor_b32 v125,v125,v120
v_lshlrev_b32 v125,4,v125
v_lshl_add_u32 v125,v120,8,v125
v_add_u32 v7,65536,v125
v_lshlrev_b32 v21,5,v120
v_and_b32 v125,1,v121
v_lshl_add_u32 v21,v125,4,v21
s_lshl_b32 s56,s46,9
v_lshrrev_b32 v125,1,v121
v_lshl_add_u32 v21,v125,11,v21
s_add_u32 s56,s56,155648
v_add_u32 v21,s56,v21
v_lshlrev_b32 v22,4,v120
v_lshl_add_u32 v22,v121,10,v22
s_lshl_b32 s56,s46,8
v_add_u32 v22,s56,v22
s_sub_u32 s54,s48,4
s_cmp_eq_u32 s54,0
s_mov_b32 s72,1207959722
s_mov_b32 s73,2454267026
s_cmov_b32 s72,603979861
s_cmov_b32 s73,1227133513
s_mov_b32 s70,0x80000000
s_mov_b32 s53,6
s_mov_b32 s74,s50
s_xor_b32 s75,s74,32768
v_and_b32 v23,31,v1
v_lshlrev_b32 v23,2,v23
v_mov_b32 v19,s50
v_mov_b32 v16,0
s_ff1_i32_b64 s55,s[72:73]
s_bitset0_b64 s[72:73],s55
s_min_u32 s55,s55,127
s_lshl_b32 s68,s55,15
s_add_u32 s68,s68,0
s_add_u32 s69,s68,16384
s_add_u32 m0,s75,65536
s_nop 0
buffer_load_dwordx4 v20,s[8:11],s68 offen offset:0 sc1 lds
s_add_u32 m0,s75,69632
s_nop 0
buffer_load_dwordx4 v20,s[8:11],s69 offen offset:0 sc1 lds
s_add_u32 m0,s75,73472
s_nop 0
buffer_load_dwordx4 v20,s[8:11],s68 offen offset:256 sc1 lds
s_add_u32 m0,s75,77568
s_nop 0
buffer_load_dwordx4 v20,s[8:11],s69 offen offset:256 sc1 lds
s_add_u32 m0,s75,81408
s_nop 0
buffer_load_dwordx4 v20,s[8:11],s68 offen offset:512 sc1 lds
s_add_u32 m0,s75,85504
s_nop 0
buffer_load_dwordx4 v20,s[8:11],s69 offen offset:512 sc1 lds
s_add_u32 m0,s75,89344
s_nop 0
buffer_load_dwordx4 v20,s[8:11],s68 offen offset:768 sc1 lds
s_add_u32 m0,s75,93440
s_nop 0
buffer_load_dwordx4 v20,s[8:11],s69 offen offset:768 sc1 lds
s_waitcnt vmcnt(0)
s_barrier
L_p_12:
s_mov_b32 s75,s74
s_xor_b32 s74,s74,32768
v_xor_b32 v4,32768,v4
v_xor_b32 v5,32768,v5
v_xor_b32 v6,32768,v6
v_xor_b32 v7,32768,v7
s_mov_b32 s51,s55
s_sub_u32 s53,s53,1
s_ff1_i32_b64 s55,s[72:73]
s_bitset0_b64 s[72:73],s55
s_min_u32 s55,s55,127
s_lshl_b32 s58,s51,5
s_add_u32 s58,s58,s47
s_mul_i32 s58,s58,24576
s_add_u32 s58,s58,100663296
s_add_u32 s61,s58,s50
s_add_u32 s62,s61,4096
s_add_u32 s63,s61,16384
s_add_u32 s64,s61,20480
s_add_u32 s65,s61,s50
s_add_u32 s65,s65,8192
ds_read_b128 v[104:107],v4 offset:0
ds_read_b128 v[108:111],v4 offset:4096
ds_read_b128 v[112:115],v5 offset:0
ds_read_b128 v[116:119],v5 offset:4096
s_waitcnt lgkmcnt(2)
v_mfma_f32_16x16x32_bf16 v[24:27],a[128:131],v[104:107],0
ds_read_b128 v[120:123],v6 offset:0
v_mfma_f32_16x16x32_bf16 v[40:43],v[104:107],v[128:131],0
v_mfma_f32_16x16x32_bf16 v[28:31],a[128:131],v[108:111],0
ds_read_b128 v[124:127],v6 offset:4096
v_mfma_f32_16x16x32_bf16 v[44:47],v[108:111],v[128:131],0
v_mfma_f32_16x16x32_bf16 v[32:35],a[136:139],v[104:107],0
v_mfma_f32_16x16x32_bf16 v[48:51],v[104:107],v[136:139],0
v_mfma_f32_16x16x32_bf16 v[36:39],a[136:139],v[108:111],0
v_mfma_f32_16x16x32_bf16 v[52:55],v[108:111],v[136:139],0
s_waitcnt lgkmcnt(2)
v_mfma_f32_16x16x32_bf16 v[24:27],a[132:135],v[112:115],v[24:27]
ds_read_b128 v[104:107],v7 offset:0
v_mfma_f32_16x16x32_bf16 v[40:43],v[112:115],v[132:135],v[40:43]
v_mfma_f32_16x16x32_bf16 v[28:31],a[132:135],v[116:119],v[28:31]
ds_read_b128 v[108:111],v7 offset:4096
v_mfma_f32_16x16x32_bf16 v[44:47],v[116:119],v[132:135],v[44:47]
v_mfma_f32_16x16x32_bf16 v[32:35],a[140:143],v[112:115],v[32:35]
v_mfma_f32_16x16x32_bf16 v[48:51],v[112:115],v[140:143],v[48:51]
v_mfma_f32_16x16x32_bf16 v[36:39],a[140:143],v[116:119],v[36:39]
v_mfma_f32_16x16x32_bf16 v[52:55],v[116:119],v[140:143],v[52:55]
s_waitcnt lgkmcnt(2)
v_mfma_f32_16x16x32_bf16 v[24:27],a[144:147],v[120:123],v[24:27]
ds_read_b128 v[112:115],v4 offset:8192
v_mfma_f32_16x16x32_bf16 v[40:43],v[120:123],v[144:147],v[40:43]
v_mfma_f32_16x16x32_bf16 v[28:31],a[144:147],v[124:127],v[28:31]
ds_read_b128 v[116:119],v4 offset:12288
v_mfma_f32_16x16x32_bf16 v[44:47],v[124:127],v[144:147],v[44:47]
v_mfma_f32_16x16x32_bf16 v[32:35],a[152:155],v[120:123],v[32:35]
v_mfma_f32_16x16x32_bf16 v[48:51],v[120:123],v[152:155],v[48:51]
v_mfma_f32_16x16x32_bf16 v[36:39],a[152:155],v[124:127],v[36:39]
v_mfma_f32_16x16x32_bf16 v[52:55],v[124:127],v[152:155],v[52:55]
s_waitcnt lgkmcnt(2)
v_mfma_f32_16x16x32_bf16 v[24:27],a[148:151],v[104:107],v[24:27]
ds_read_b128 v[120:123],v5 offset:8192
v_mfma_f32_16x16x32_bf16 v[40:43],v[104:107],v[148:151],v[40:43]
s_lshl_b32 s56,s54,13
v_mfma_f32_16x16x32_bf16 v[28:31],a[148:151],v[108:111],v[28:31]
ds_read_b128 v[124:127],v5 offset:12288
v_mfma_f32_16x16x32_bf16 v[44:47],v[108:111],v[148:151],v[44:47]
s_add_u32 s56,s56,10487552
v_mfma_f32_16x16x32_bf16 v[32:35],a[156:159],v[104:107],v[32:35]
s_or_b32 s56,s56,s52
v_mfma_f32_16x16x32_bf16 v[48:51],v[104:107],v[156:159],v[48:51]
buffer_load_dword v76,v23,s[8:11],s56 offen sc1
v_mfma_f32_16x16x32_bf16 v[36:39],a[156:159],v[108:111],v[36:39]
v_mfma_f32_16x16x32_bf16 v[52:55],v[108:111],v[156:159],v[52:55]
s_waitcnt lgkmcnt(2)
v_mfma_f32_16x16x32_bf16 v[24:27],a[160:163],v[112:115],v[24:27]
ds_read_b128 v[104:107],v6 offset:8192
v_mfma_f32_16x16x32_bf16 v[40:43],v[112:115],v[160:163],v[40:43]
v_mfma_f32_16x16x32_bf16 v[28:31],a[160:163],v[116:119],v[28:31]
ds_read_b128 v[108:111],v6 offset:12288
v_mfma_f32_16x16x32_bf16 v[44:47],v[116:119],v[160:163],v[44:47]
v_mfma_f32_16x16x32_bf16 v[32:35],a[168:171],v[112:115],v[32:35]
v_mfma_f32_16x16x32_bf16 v[48:51],v[112:115],v[168:171],v[48:51]
v_mfma_f32_16x16x32_bf16 v[36:39],a[168:171],v[116:119],v[36:39]
v_mfma_f32_16x16x32_bf16 v[52:55],v[116:119],v[168:171],v[52:55]
s_waitcnt lgkmcnt(2)
v_mfma_f32_16x16x32_bf16 v[24:27],a[164:167],v[120:123],v[24:27]
ds_read_b128 v[112:115],v7 offset:8192
v_mfma_f32_16x16x32_bf16 v[40:43],v[120:123],v[164:167],v[40:43]
v_mfma_f32_16x16x32_bf16 v[28:31],a[164:167],v[124:127],v[28:31]
ds_read_b128 v[116:119],v7 offset:12288
v_mfma_f32_16x16x32_bf16 v[44:47],v[124:127],v[164:167],v[44:47]
v_mfma_f32_16x16x32_bf16 v[32:35],a[172:175],v[120:123],v[32:35]
v_mfma_f32_16x16x32_bf16 v[48:51],v[120:123],v[172:175],v[48:51]
v_mfma_f32_16x16x32_bf16 v[36:39],a[172:175],v[124:127],v[36:39]
v_mfma_f32_16x16x32_bf16 v[52:55],v[124:127],v[172:175],v[52:55]
s_waitcnt lgkmcnt(2)
v_mfma_f32_16x16x32_bf16 v[24:27],a[176:179],v[104:107],v[24:27]
ds_read_b128 v[120:123],v4 offset:16384
v_mfma_f32_16x16x32_bf16 v[40:43],v[104:107],v[176:179],v[40:43]
v_mfma_f32_16x16x32_bf16 v[28:31],a[176:179],v[108:111],v[28:31]
ds_read_b128 v[124:127],v4 offset:20480
v_mfma_f32_16x16x32_bf16 v[44:47],v[108:111],v[176:179],v[44:47]
v_mfma_f32_16x16x32_bf16 v[32:35],a[184:187],v[104:107],v[32:35]
v_mfma_f32_16x16x32_bf16 v[48:51],v[104:107],v[184:187],v[48:51]
v_mfma_f32_16x16x32_bf16 v[36:39],a[184:187],v[108:111],v[36:39]
v_mfma_f32_16x16x32_bf16 v[52:55],v[108:111],v[184:187],v[52:55]
s_waitcnt lgkmcnt(2)
v_mfma_f32_16x16x32_bf16 v[24:27],a[180:183],v[112:115],v[24:27]
ds_read_b128 v[104:107],v5 offset:16384
v_mfma_f32_16x16x32_bf16 v[40:43],v[112:115],v[180:183],v[40:43]
v_mfma_f32_16x16x32_bf16 v[28:31],a[180:183],v[116:119],v[28:31]
ds_read_b128 v[108:111],v5 offset:20480
v_mfma_f32_16x16x32_bf16 v[44:47],v[116:119],v[180:183],v[44:47]
v_mfma_f32_16x16x32_bf16 v[32:35],a[188:191],v[112:115],v[32:35]
v_mfma_f32_16x16x32_bf16 v[48:51],v[112:115],v[188:191],v[48:51]
v_mfma_f32_16x16x32_bf16 v[36:39],a[188:191],v[116:119],v[36:39]
v_mfma_f32_16x16x32_bf16 v[52:55],v[116:119],v[188:191],v[52:55]
s_waitcnt lgkmcnt(2)
v_mfma_f32_16x16x32_bf16 v[24:27],a[192:195],v[120:123],v[24:27]
ds_read_b128 v[112:115],v6 offset:16384
v_mfma_f32_16x16x32_bf16 v[40:43],v[120:123],v[192:195],v[40:43]
v_mfma_f32_16x16x32_bf16 v[28:31],a[192:195],v[124:127],v[28:31]
ds_read_b128 v[116:119],v6 offset:20480
v_mfma_f32_16x16x32_bf16 v[44:47],v[124:127],v[192:195],v[44:47]
v_mfma_f32_16x16x32_bf16 v[32:35],a[200:203],v[120:123],v[32:35]
v_mfma_f32_16x16x32_bf16 v[48:51],v[120:123],v[200:203],v[48:51]
v_mfma_f32_16x16x32_bf16 v[36:39],a[200:203],v[124:127],v[36:39]
v_mfma_f32_16x16x32_bf16 v[52:55],v[124:127],v[200:203],v[52:55]
s_waitcnt lgkmcnt(2)
v_mfma_f32_16x16x32_bf16 v[24:27],a[196:199],v[104:107],v[24:27]
ds_read_b128 v[120:123],v7 offset:16384
v_mfma_f32_16x16x32_bf16 v[40:43],v[104:107],v[196:199],v[40:43]
s_waitcnt vmcnt(0)
v_mfma_f32_16x16x32_bf16 v[28:31],a[196:199],v[108:111],v[28:31]
ds_read_b128 v[124:127],v7 offset:20480
v_mfma_f32_16x16x32_bf16 v[44:47],v[108:111],v[196:199],v[44:47]
v_cmp_eq_u32 vcc,0,v76
v_mfma_f32_16x16x32_bf16 v[32:35],a[204:207],v[104:107],v[32:35]
s_nop 0
v_mov_b32 v76,vcc_lo
v_mfma_f32_16x16x32_bf16 v[48:51],v[104:107],v[204:207],v[48:51]
ds_write_b32 v19,v76
v_mfma_f32_16x16x32_bf16 v[36:39],a[204:207],v[108:111],v[36:39]
v_mfma_f32_16x16x32_bf16 v[52:55],v[108:111],v[204:207],v[52:55]
s_waitcnt vmcnt(0) lgkmcnt(0)
s_barrier
s_or_b32 s70,s70,s52
buffer_store_dword v17,off,s[8:11],s70 sc1
ds_read_b32 v76,v16
v_mfma_f32_16x16x32_bf16 v[24:27],a[208:211],v[112:115],v[24:27]
ds_read_b128 v[104:107],v4 offset:24576
v_mfma_f32_16x16x32_bf16 v[40:43],v[112:115],v[208:211],v[40:43]
s_lshl_b32 s56,s51,5
s_add_u32 s56,s56,s47
s_lshl_b32 s56,s56,12
v_mfma_f32_16x16x32_bf16 v[28:31],a[208:211],v[116:119],v[28:31]
ds_read_b128 v[108:111],v4 offset:28672
v_mfma_f32_16x16x32_bf16 v[44:47],v[116:119],v[208:211],v[44:47]
s_add_u32 s56,s56,s50
s_add_u32 s56,s56,41943040
v_mfma_f32_16x16x32_bf16 v[32:35],a[216:219],v[112:115],v[32:35]
v_mov_b64 v[72:73],-1
v_mov_b64 v[74:75],-1
v_mfma_f32_16x16x32_bf16 v[48:51],v[112:115],v[216:219],v[48:51]
buffer_store_dwordx4 v[72:75],v0,s[8:11],s56 offen sc1
v_mfma_f32_16x16x32_bf16 v[36:39],a[216:219],v[116:119],v[36:39]
v_mfma_f32_16x16x32_bf16 v[52:55],v[116:119],v[216:219],v[52:55]
s_waitcnt lgkmcnt(2)
v_mfma_f32_16x16x32_bf16 v[24:27],a[212:215],v[120:123],v[24:27]
ds_read_b128 v[112:115],v5 offset:24576
v_mfma_f32_16x16x32_bf16 v[40:43],v[120:123],v[212:215],v[40:43]
v_readfirstlane_b32 s57,v76
v_mfma_f32_16x16x32_bf16 v[28:31],a[212:215],v[124:127],v[28:31]
ds_read_b128 v[116:119],v5 offset:28672
v_mfma_f32_16x16x32_bf16 v[44:47],v[124:127],v[212:215],v[44:47]
s_sub_u32 s59,s55,s54
s_cmp_lt_i32 s59,24
s_cselect_b32 s76,2,0
v_mfma_f32_16x16x32_bf16 v[32:35],a[220:223],v[120:123],v[32:35]
s_cmp_gt_i32 s53,0
s_cselect_b32 s76,s76,0
v_mfma_f32_16x16x32_bf16 v[48:51],v[120:123],v[220:223],v[48:51]
s_cmp_eq_u32 s57,0
s_cselect_b32 s76,1,s76
v_mfma_f32_16x16x32_bf16 v[36:39],a[220:223],v[124:127],v[36:39]
s_cmp_lt_i32 s59,12
s_cselect_b32 s76,2,s76
s_add_u32 s57,s54,64
v_mfma_f32_16x16x32_bf16 v[52:55],v[124:127],v[220:223],v[52:55]
s_cmp_eq_u32 s76,1
s_cselect_b32 s68,s57,s55
s_lshl_b32 s68,s68,15
s_waitcnt lgkmcnt(2)
v_mfma_f32_16x16x32_bf16 v[24:27],a[224:227],v[104:107],v[24:27]
ds_read_b128 v[120:123],v6 offset:24576
v_mfma_f32_16x16x32_bf16 v[40:43],v[104:107],v[224:227],v[40:43]
s_cmp_eq_u32 s76,0
s_cselect_b32 s68,0x80000000,s68
s_add_u32 s69,s68,16384
v_mfma_f32_16x16x32_bf16 v[28:31],a[224:227],v[108:111],v[28:31]
ds_read_b128 v[124:127],v6 offset:28672
v_mfma_f32_16x16x32_bf16 v[44:47],v[108:111],v[224:227],v[44:47]
s_add_u32 m0,s75,65536
v_mfma_f32_16x16x32_bf16 v[32:35],a[232:235],v[104:107],v[32:35]
buffer_load_dwordx4 v20,s[8:11],s68 offen offset:0 sc1 lds
v_mfma_f32_16x16x32_bf16 v[48:51],v[104:107],v[232:235],v[48:51]
s_add_u32 m0,s75,69632
v_mfma_f32_16x16x32_bf16 v[36:39],a[232:235],v[108:111],v[36:39]
buffer_load_dwordx4 v20,s[8:11],s69 offen offset:0 sc1 lds
v_mfma_f32_16x16x32_bf16 v[52:55],v[108:111],v[232:235],v[52:55]
s_add_u32 m0,s75,73472
s_waitcnt lgkmcnt(2)
v_mfma_f32_16x16x32_bf16 v[24:27],a[228:231],v[112:115],v[24:27]
ds_read_b128 v[104:107],v7 offset:24576
v_mfma_f32_16x16x32_bf16 v[40:43],v[112:115],v[228:231],v[40:43]
buffer_load_dwordx4 v20,s[8:11],s68 offen offset:256 sc1 lds
v_mfma_f32_16x16x32_bf16 v[28:31],a[228:231],v[116:119],v[28:31]
ds_read_b128 v[108:111],v7 offset:28672
v_mfma_f32_16x16x32_bf16 v[44:47],v[116:119],v[228:231],v[44:47]
s_add_u32 m0,s75,77568
v_mfma_f32_16x16x32_bf16 v[32:35],a[236:239],v[112:115],v[32:35]
buffer_load_dwordx4 v20,s[8:11],s69 offen offset:256 sc1 lds
v_mfma_f32_16x16x32_bf16 v[48:51],v[112:115],v[236:239],v[48:51]
s_add_u32 m0,s75,81408
v_mfma_f32_16x16x32_bf16 v[36:39],a[236:239],v[116:119],v[36:39]
buffer_load_dwordx4 v20,s[8:11],s68 offen offset:512 sc1 lds
v_mfma_f32_16x16x32_bf16 v[52:55],v[116:119],v[236:239],v[52:55]
s_add_u32 m0,s75,85504
s_waitcnt lgkmcnt(2)
v_mfma_f32_16x16x32_bf16 v[24:27],a[240:243],v[120:123],v[24:27]
ds_read_b128 v[112:115],v4 offset:0
v_mfma_f32_16x16x32_bf16 v[40:43],v[120:123],v[240:243],v[40:43]
buffer_load_dwordx4 v20,s[8:11],s69 offen offset:512 sc1 lds
v_mfma_f32_16x16x32_bf16 v[28:31],a[240:243],v[124:127],v[28:31]
ds_read_b128 v[116:119],v4 offset:4096
v_mfma_f32_16x16x32_bf16 v[44:47],v[124:127],v[240:243],v[44:47]
s_add_u32 m0,s75,89344
v_mfma_f32_16x16x32_bf16 v[32:35],a[248:251],v[120:123],v[32:35]
buffer_load_dwordx4 v20,s[8:11],s68 offen offset:768 sc1 lds
v_mfma_f32_16x16x32_bf16 v[48:51],v[120:123],v[248:251],v[48:51]
s_add_u32 m0,s75,93440
v_mfma_f32_16x16x32_bf16 v[36:39],a[248:251],v[124:127],v[36:39]
buffer_load_dwordx4 v20,s[8:11],s69 offen offset:768 sc1 lds
v_mfma_f32_16x16x32_bf16 v[52:55],v[124:127],v[248:251],v[52:55]
s_waitcnt lgkmcnt(2)
v_mfma_f32_16x16x32_bf16 v[24:27],a[244:247],v[104:107],v[24:27]
ds_read_b128 v[120:123],v5 offset:0
v_mfma_f32_16x16x32_bf16 v[40:43],v[104:107],v[244:247],v[40:43]
v_mfma_f32_16x16x32_bf16 v[28:31],a[244:247],v[108:111],v[28:31]
ds_read_b128 v[124:127],v5 offset:4096
v_mfma_f32_16x16x32_bf16 v[44:47],v[108:111],v[244:247],v[44:47]
v_mfma_f32_16x16x32_bf16 v[32:35],a[252:255],v[104:107],v[32:35]
v_mfma_f32_16x16x32_bf16 v[48:51],v[104:107],v[252:255],v[48:51]
v_mfma_f32_16x16x32_bf16 v[36:39],a[252:255],v[108:111],v[36:39]
v_mfma_f32_16x16x32_bf16 v[52:55],v[108:111],v[252:255],v[52:55]
s_waitcnt lgkmcnt(2)
v_mfma_f32_16x16x32_bf16 v[88:91],a[0:3],v[112:115],0
ds_read_b128 v[104:107],v6 offset:0
v_mfma_f32_16x16x32_bf16 v[92:95],a[0:3],v[116:119],0
v_mfma_f32_16x16x32_bf16 v[96:99],a[8:11],v[112:115],0
ds_read_b128 v[108:111],v6 offset:4096
v_mfma_f32_16x16x32_bf16 v[100:103],a[8:11],v[116:119],0
s_waitcnt lgkmcnt(2)
v_mfma_f32_16x16x32_bf16 v[88:91],a[4:7],v[120:123],v[88:91]
ds_read_b128 v[112:115],v7 offset:0
v_mfma_f32_16x16x32_bf16 v[92:95],a[4:7],v[124:127],v[92:95]
v_cvt_pk_bf16_f32 v56,v24,v32
v_cvt_pk_bf16_f32 v57,v25,v33
v_mfma_f32_16x16x32_bf16 v[96:99],a[12:15],v[120:123],v[96:99]
ds_read_b128 v[116:119],v7 offset:4096
v_mfma_f32_16x16x32_bf16 v[100:103],a[12:15],v[124:127],v[100:103]
v_cvt_pk_bf16_f32 v58,v26,v34
v_cvt_pk_bf16_f32 v59,v27,v35
s_waitcnt lgkmcnt(2)
v_mfma_f32_16x16x32_bf16 v[88:91],a[16:19],v[104:107],v[88:91]
ds_read_b128 v[120:123],v4 offset:8192
v_mfma_f32_16x16x32_bf16 v[92:95],a[16:19],v[108:111],v[92:95]
buffer_store_dwordx4 v[56:59],v0,s[8:11],s61 offen sc1
v_cvt_pk_bf16_f32 v60,v28,v36
v_mfma_f32_16x16x32_bf16 v[96:99],a[24:27],v[104:107],v[96:99]
ds_read_b128 v[124:127],v4 offset:12288
v_mfma_f32_16x16x32_bf16 v[100:103],a[24:27],v[108:111],v[100:103]
v_cvt_pk_bf16_f32 v61,v29,v37
v_cvt_pk_bf16_f32 v62,v30,v38
s_waitcnt lgkmcnt(2)
v_mfma_f32_16x16x32_bf16 v[88:91],a[20:23],v[112:115],v[88:91]
ds_read_b128 v[104:107],v5 offset:8192
v_mfma_f32_16x16x32_bf16 v[92:95],a[20:23],v[116:119],v[92:95]
v_cvt_pk_bf16_f32 v63,v31,v39
buffer_store_dwordx4 v[60:63],v0,s[8:11],s62 offen sc1
v_mfma_f32_16x16x32_bf16 v[96:99],a[28:31],v[112:115],v[96:99]
ds_read_b128 v[108:111],v5 offset:12288
v_mfma_f32_16x16x32_bf16 v[100:103],a[28:31],v[116:119],v[100:103]
v_cvt_pk_bf16_f32 v64,v40,v41
v_cvt_pk_bf16_f32 v65,v42,v43
s_waitcnt lgkmcnt(2)
v_mfma_f32_16x16x32_bf16 v[88:91],a[32:35],v[120:123],v[88:91]
ds_read_b128 v[112:115],v6 offset:8192
v_mfma_f32_16x16x32_bf16 v[92:95],a[32:35],v[124:127],v[92:95]
v_cvt_pk_bf16_f32 v66,v44,v45
v_cvt_pk_bf16_f32 v67,v46,v47
v_mfma_f32_16x16x32_bf16 v[96:99],a[40:43],v[120:123],v[96:99]
ds_read_b128 v[116:119],v6 offset:12288
v_mfma_f32_16x16x32_bf16 v[100:103],a[40:43],v[124:127],v[100:103]
buffer_store_dwordx4 v[64:67],v0,s[8:11],s65 offen offset:0 sc1
v_cvt_pk_bf16_f32 v68,v48,v49
s_waitcnt lgkmcnt(2)
v_mfma_f32_16x16x32_bf16 v[88:91],a[36:39],v[104:107],v[88:91]
ds_read_b128 v[120:123],v7 offset:8192
v_mfma_f32_16x16x32_bf16 v[92:95],a[36:39],v[108:111],v[92:95]
v_cvt_pk_bf16_f32 v69,v50,v51
v_cvt_pk_bf16_f32 v70,v52,v53
v_mfma_f32_16x16x32_bf16 v[96:99],a[44:47],v[104:107],v[96:99]
ds_read_b128 v[124:127],v7 offset:12288
v_mfma_f32_16x16x32_bf16 v[100:103],a[44:47],v[108:111],v[100:103]
v_cvt_pk_bf16_f32 v71,v54,v55
buffer_store_dwordx4 v[68:71],v0,s[8:11],s65 offen offset:1024 sc1
s_waitcnt lgkmcnt(2)
v_mfma_f32_16x16x32_bf16 v[88:91],a[48:51],v[112:115],v[88:91]
ds_read_b128 v[104:107],v4 offset:16384
v_mfma_f32_16x16x32_bf16 v[92:95],a[48:51],v[116:119],v[92:95]
v_mfma_f32_16x16x32_bf16 v[96:99],a[56:59],v[112:115],v[96:99]
ds_read_b128 v[108:111],v4 offset:20480
v_mfma_f32_16x16x32_bf16 v[100:103],a[56:59],v[116:119],v[100:103]
s_waitcnt lgkmcnt(2)
v_mfma_f32_16x16x32_bf16 v[88:91],a[52:55],v[120:123],v[88:91]
ds_read_b128 v[112:115],v5 offset:16384
v_mfma_f32_16x16x32_bf16 v[92:95],a[52:55],v[124:127],v[92:95]
v_mfma_f32_16x16x32_bf16 v[96:99],a[60:63],v[120:123],v[96:99]
ds_read_b128 v[116:119],v5 offset:20480
v_mfma_f32_16x16x32_bf16 v[100:103],a[60:63],v[124:127],v[100:103]
s_waitcnt lgkmcnt(2)
v_mfma_f32_16x16x32_bf16 v[88:91],a[64:67],v[104:107],v[88:91]
ds_read_b128 v[120:123],v6 offset:16384
v_mfma_f32_16x16x32_bf16 v[92:95],a[64:67],v[108:111],v[92:95]
v_mfma_f32_16x16x32_bf16 v[96:99],a[72:75],v[104:107],v[96:99]
ds_read_b128 v[124:127],v6 offset:20480
v_mfma_f32_16x16x32_bf16 v[100:103],a[72:75],v[108:111],v[100:103]
s_waitcnt lgkmcnt(2)
v_mfma_f32_16x16x32_bf16 v[88:91],a[68:71],v[112:115],v[88:91]
ds_read_b128 v[104:107],v7 offset:16384
v_mfma_f32_16x16x32_bf16 v[92:95],a[68:71],v[116:119],v[92:95]
v_mfma_f32_16x16x32_bf16 v[96:99],a[76:79],v[112:115],v[96:99]
ds_read_b128 v[108:111],v7 offset:20480
v_mfma_f32_16x16x32_bf16 v[100:103],a[76:79],v[116:119],v[100:103]
s_waitcnt lgkmcnt(2)
v_mfma_f32_16x16x32_bf16 v[88:91],a[80:83],v[120:123],v[88:91]
ds_read_b128 v[112:115],v4 offset:24576
v_mfma_f32_16x16x32_bf16 v[92:95],a[80:83],v[124:127],v[92:95]
v_mfma_f32_16x16x32_bf16 v[96:99],a[88:91],v[120:123],v[96:99]
ds_read_b128 v[116:119],v4 offset:28672
v_mfma_f32_16x16x32_bf16 v[100:103],a[88:91],v[124:127],v[100:103]
s_waitcnt lgkmcnt(2)
v_mfma_f32_16x16x32_bf16 v[88:91],a[84:87],v[104:107],v[88:91]
ds_read_b128 v[120:123],v5 offset:24576
v_mfma_f32_16x16x32_bf16 v[92:95],a[84:87],v[108:111],v[92:95]
v_mfma_f32_16x16x32_bf16 v[96:99],a[92:95],v[104:107],v[96:99]
ds_read_b128 v[124:127],v5 offset:28672
v_mfma_f32_16x16x32_bf16 v[100:103],a[92:95],v[108:111],v[100:103]
s_waitcnt lgkmcnt(2)
v_mfma_f32_16x16x32_bf16 v[88:91],a[96:99],v[112:115],v[88:91]
ds_read_b128 v[104:107],v6 offset:24576
v_mfma_f32_16x16x32_bf16 v[92:95],a[96:99],v[116:119],v[92:95]
v_mfma_f32_16x16x32_bf16 v[96:99],a[104:107],v[112:115],v[96:99]
ds_read_b128 v[108:111],v6 offset:28672
v_mfma_f32_16x16x32_bf16 v[100:103],a[104:107],v[116:119],v[100:103]
s_waitcnt lgkmcnt(2)
v_mfma_f32_16x16x32_bf16 v[88:91],a[100:103],v[120:123],v[88:91]
ds_read_b128 v[112:115],v7 offset:24576
v_mfma_f32_16x16x32_bf16 v[92:95],a[100:103],v[124:127],v[92:95]
v_mfma_f32_16x16x32_bf16 v[96:99],a[108:111],v[120:123],v[96:99]
ds_read_b128 v[116:119],v7 offset:28672
v_mfma_f32_16x16x32_bf16 v[100:103],a[108:111],v[124:127],v[100:103]
s_waitcnt lgkmcnt(2)
v_mfma_f32_16x16x32_bf16 v[88:91],a[112:115],v[104:107],v[88:91]
v_mfma_f32_16x16x32_bf16 v[92:95],a[112:115],v[108:111],v[92:95]
v_mfma_f32_16x16x32_bf16 v[96:99],a[120:123],v[104:107],v[96:99]
v_mfma_f32_16x16x32_bf16 v[100:103],a[120:123],v[108:111],v[100:103]
s_waitcnt lgkmcnt(0)
v_mfma_f32_16x16x32_bf16 v[88:91],a[116:119],v[112:115],v[88:91]
v_mfma_f32_16x16x32_bf16 v[92:95],a[116:119],v[116:119],v[92:95]
v_mfma_f32_16x16x32_bf16 v[96:99],a[124:127],v[112:115],v[96:99]
v_mfma_f32_16x16x32_bf16 v[100:103],a[124:127],v[116:119],v[100:103]
s_nop 3
v_cvt_pk_bf16_f32 v104,v88,v96
v_cvt_pk_bf16_f32 v105,v89,v97
v_cvt_pk_bf16_f32 v106,v90,v98
v_cvt_pk_bf16_f32 v107,v91,v99
v_cvt_pk_bf16_f32 v108,v92,v100
v_cvt_pk_bf16_f32 v109,v93,v101
v_cvt_pk_bf16_f32 v110,v94,v102
v_cvt_pk_bf16_f32 v111,v95,v103
buffer_store_dwordx4 v[104:107],v0,s[8:11],s63 offen sc1
buffer_store_dwordx4 v[108:111],v0,s[8:11],s64 offen sc1
s_waitcnt vmcnt(6)
s_barrier
s_lshl_b32 s70,s51,13
s_lshl2_add_u32 s70,s47,s70
s_add_u32 s70,s70,10485760
L_p_14:
s_cmp_eq_u32 s76,2
s_cbranch_scc1 L_p_12
s_mov_b32 s53,0
s_mov_b32 s51,s54
s_add_u32 s54,s54,2
s_cmp_eq_u32 s76,1
s_cbranch_scc1 L_p_13
s_waitcnt vmcnt(0)
s_barrier
s_or_b32 s70,s70,s52
buffer_store_dword v17,off,s[8:11],s70 sc1
s_mov_b32 s70,0x80000000
s_cmp_ge_u32 s51,64
s_cbranch_scc1 L_p_15
s_lshl_b32 s66,s51,15
s_add_u32 s66,s66,2097152
s_add_u32 s67,s66,16384
s_lshl_b32 s59,s51,13
s_add_u32 s59,s59,10487552
s_cmp_lg_u32 s46,0
s_cbranch_scc1 L_fd_17
v_and_b32 v124,31,v1
v_lshlrev_b32 v124,2,v124
s_branch L_ff_18
L_fw_16:
s_sleep 2
L_ff_18:
buffer_load_dword v125,v124,s[8:11],s59 offen sc1
s_sub_u32 s49,s49,1
s_cbranch_scc1 L_abort
s_waitcnt vmcnt(0)
v_cmp_eq_u32 vcc,0,v125
s_cbranch_vccnz L_fw_16
L_fd_17:
s_barrier
s_add_u32 m0,s74,65536
s_nop 0
buffer_load_dwordx4 v20,s[8:11],s66 offen offset:0 sc1 lds
s_add_u32 m0,s74,69632
s_nop 0
buffer_load_dwordx4 v20,s[8:11],s67 offen offset:0 sc1 lds
s_add_u32 m0,s74,73472
s_nop 0
buffer_load_dwordx4 v20,s[8:11],s66 offen offset:256 sc1 lds
s_add_u32 m0,s74,77568
s_nop 0
buffer_load_dwordx4 v20,s[8:11],s67 offen offset:256 sc1 lds
s_add_u32 m0,s74,81408
s_nop 0
buffer_load_dwordx4 v20,s[8:11],s66 offen offset:512 sc1 lds
s_add_u32 m0,s74,85504
s_nop 0
buffer_load_dwordx4 v20,s[8:11],s67 offen offset:512 sc1 lds
s_add_u32 m0,s74,89344
s_nop 0
buffer_load_dwordx4 v20,s[8:11],s66 offen offset:768 sc1 lds
s_add_u32 m0,s74,93440
s_nop 0
buffer_load_dwordx4 v20,s[8:11],s67 offen offset:768 sc1 lds
s_lshl_b32 s56,s54,13
s_add_u32 s56,s56,10487552
s_or_b32 s56,s56,s52
buffer_load_dword v76,v23,s[8:11],s56 offen sc1
s_lshl_b32 s58,s51,5
s_add_u32 s58,s58,s47
s_mul_i32 s58,s58,24576
s_add_u32 s58,s58,150994944
s_add_u32 s61,s58,s50
s_add_u32 s62,s61,4096
s_add_u32 s63,s61,16384
s_add_u32 s64,s61,20480
s_add_u32 s65,s61,s50
s_add_u32 s65,s65,8192
s_waitcnt vmcnt(7)
s_barrier
ds_read_b128 v[104:107],v4 offset:0
ds_read_b128 v[108:111],v4 offset:4096
ds_read_b128 v[112:115],v5 offset:0
ds_read_b128 v[116:119],v5 offset:4096
s_waitcnt lgkmcnt(2)
v_mfma_f32_16x16x32_bf16 v[24:27],a[128:131],v[104:107],0
ds_read_b128 v[120:123],v6 offset:0
v_mfma_f32_16x16x32_bf16 v[40:43],v[104:107],v[128:131],0
v_mfma_f32_16x16x32_bf16 v[28:31],a[128:131],v[108:111],0
ds_read_b128 v[124:127],v6 offset:4096
v_mfma_f32_16x16x32_bf16 v[44:47],v[108:111],v[128:131],0
v_mfma_f32_16x16x32_bf16 v[32:35],a[136:139],v[104:107],0
v_mfma_f32_16x16x32_bf16 v[48:51],v[104:107],v[136:139],0
v_mfma_f32_16x16x32_bf16 v[36:39],a[136:139],v[108:111],0
v_mfma_f32_16x16x32_bf16 v[52:55],v[108:111],v[136:139],0
s_waitcnt lgkmcnt(2)
v_mfma_f32_16x16x32_bf16 v[24:27],a[132:135],v[112:115],v[24:27]
ds_read_b128 v[104:107],v7 offset:0
v_mfma_f32_16x16x32_bf16 v[40:43],v[112:115],v[132:135],v[40:43]
v_mfma_f32_16x16x32_bf16 v[28:31],a[132:135],v[116:119],v[28:31]
ds_read_b128 v[108:111],v7 offset:4096
v_mfma_f32_16x16x32_bf16 v[44:47],v[116:119],v[132:135],v[44:47]
v_mfma_f32_16x16x32_bf16 v[32:35],a[140:143],v[112:115],v[32:35]
v_mfma_f32_16x16x32_bf16 v[48:51],v[112:115],v[140:143],v[48:51]
v_mfma_f32_16x16x32_bf16 v[36:39],a[140:143],v[116:119],v[36:39]
v_mfma_f32_16x16x32_bf16 v[52:55],v[116:119],v[140:143],v[52:55]
s_waitcnt vmcnt(5)
s_barrier
s_waitcnt lgkmcnt(2)
v_mfma_f32_16x16x32_bf16 v[24:27],a[144:147],v[120:123],v[24:27]
ds_read_b128 v[112:115],v4 offset:8192
v_mfma_f32_16x16x32_bf16 v[40:43],v[120:123],v[144:147],v[40:43]
v_mfma_f32_16x16x32_bf16 v[28:31],a[144:147],v[124:127],v[28:31]
ds_read_b128 v[116:119],v4 offset:12288
v_mfma_f32_16x16x32_bf16 v[44:47],v[124:127],v[144:147],v[44:47]
v_mfma_f32_16x16x32_bf16 v[32:35],a[152:155],v[120:123],v[32:35]
v_mfma_f32_16x16x32_bf16 v[48:51],v[120:123],v[152:155],v[48:51]
v_mfma_f32_16x16x32_bf16 v[36:39],a[152:155],v[124:127],v[36:39]
v_mfma_f32_16x16x32_bf16 v[52:55],v[124:127],v[152:155],v[52:55]
s_waitcnt lgkmcnt(2)
v_mfma_f32_16x16x32_bf16 v[24:27],a[148:151],v[104:107],v[24:27]
ds_read_b128 v[120:123],v5 offset:8192
v_mfma_f32_16x16x32_bf16 v[40:43],v[104:107],v[148:151],v[40:43]
v_mfma_f32_16x16x32_bf16 v[28:31],a[148:151],v[108:111],v[28:31]
ds_read_b128 v[124:127],v5 offset:12288
v_mfma_f32_16x16x32_bf16 v[44:47],v[108:111],v[148:151],v[44:47]
v_mfma_f32_16x16x32_bf16 v[32:35],a[156:159],v[104:107],v[32:35]
v_mfma_f32_16x16x32_bf16 v[48:51],v[104:107],v[156:159],v[48:51]
v_mfma_f32_16x16x32_bf16 v[36:39],a[156:159],v[108:111],v[36:39]
v_mfma_f32_16x16x32_bf16 v[52:55],v[108:111],v[156:159],v[52:55]
s_waitcnt lgkmcnt(2)
v_mfma_f32_16x16x32_bf16 v[24:27],a[160:163],v[112:115],v[24:27]
ds_read_b128 v[104:107],v6 offset:8192
v_mfma_f32_16x16x32_bf16 v[40:43],v[112:115],v[160:163],v[40:43]
v_mfma_f32_16x16x32_bf16 v[28:31],a[160:163],v[116:119],v[28:31]
ds_read_b128 v[108:111],v6 offset:12288
v_mfma_f32_16x16x32_bf16 v[44:47],v[116:119],v[160:163],v[44:47]
v_mfma_f32_16x16x32_bf16 v[32:35],a[168:171],v[112:115],v[32:35]
v_mfma_f32_16x16x32_bf16 v[48:51],v[112:115],v[168:171],v[48:51]
v_mfma_f32_16x16x32_bf16 v[36:39],a[168:171],v[116:119],v[36:39]
v_mfma_f32_16x16x32_bf16 v[52:55],v[116:119],v[168:171],v[52:55]
s_waitcnt lgkmcnt(2)
v_mfma_f32_16x16x32_bf16 v[24:27],a[164:167],v[120:123],v[24:27]
ds_read_b128 v[112:115],v7 offset:8192
v_mfma_f32_16x16x32_bf16 v[40:43],v[120:123],v[164:167],v[40:43]
v_mfma_f32_16x16x32_bf16 v[28:31],a[164:167],v[124:127],v[28:31]
ds_read_b128 v[116:119],v7 offset:12288
v_mfma_f32_16x16x32_bf16 v[44:47],v[124:127],v[164:167],v[44:47]
v_mfma_f32_16x16x32_bf16 v[32:35],a[172:175],v[120:123],v[32:35]
v_mfma_f32_16x16x32_bf16 v[48:51],v[120:123],v[172:175],v[48:51]
v_mfma_f32_16x16x32_bf16 v[36:39],a[172:175],v[124:127],v[36:39]
v_mfma_f32_16x16x32_bf16 v[52:55],v[124:127],v[172:175],v[52:55]
s_waitcnt vmcnt(3)
s_barrier
s_waitcnt lgkmcnt(2)
v_mfma_f32_16x16x32_bf16 v[24:27],a[176:179],v[104:107],v[24:27]
ds_read_b128 v[120:123],v4 offset:16384
v_mfma_f32_16x16x32_bf16 v[40:43],v[104:107],v[176:179],v[40:43]
v_mfma_f32_16x16x32_bf16 v[28:31],a[176:179],v[108:111],v[28:31]
ds_read_b128 v[124:127],v4 offset:20480
v_mfma_f32_16x16x32_bf16 v[44:47],v[108:111],v[176:179],v[44:47]
v_mfma_f32_16x16x32_bf16 v[32:35],a[184:187],v[104:107],v[32:35]
v_mfma_f32_16x16x32_bf16 v[48:51],v[104:107],v[184:187],v[48:51]
v_mfma_f32_16x16x32_bf16 v[36:39],a[184:187],v[108:111],v[36:39]
v_mfma_f32_16x16x32_bf16 v[52:55],v[108:111],v[184:187],v[52:55]
s_waitcnt lgkmcnt(2)
v_mfma_f32_16x16x32_bf16 v[24:27],a[180:183],v[112:115],v[24:27]
ds_read_b128 v[104:107],v5 offset:16384
v_mfma_f32_16x16x32_bf16 v[40:43],v[112:115],v[180:183],v[40:43]
v_mfma_f32_16x16x32_bf16 v[28:31],a[180:183],v[116:119],v[28:31]
ds_read_b128 v[108:111],v5 offset:20480
v_mfma_f32_16x16x32_bf16 v[44:47],v[116:119],v[180:183],v[44:47]
v_mfma_f32_16x16x32_bf16 v[32:35],a[188:191],v[112:115],v[32:35]
v_mfma_f32_16x16x32_bf16 v[48:51],v[112:115],v[188:191],v[48:51]
v_mfma_f32_16x16x32_bf16 v[36:39],a[188:191],v[116:119],v[36:39]
v_mfma_f32_16x16x32_bf16 v[52:55],v[116:119],v[188:191],v[52:55]
s_waitcnt lgkmcnt(2)
v_mfma_f32_16x16x32_bf16 v[24:27],a[192:195],v[120:123],v[24:27]
ds_read_b128 v[112:115],v6 offset:16384
v_mfma_f32_16x16x32_bf16 v[40:43],v[120:123],v[192:195],v[40:43]
v_mfma_f32_16x16x32_bf16 v[28:31],a[192:195],v[124:127],v[28:31]
ds_read_b128 v[116:119],v6 offset:20480
v_mfma_f32_16x16x32_bf16 v[44:47],v[124:127],v[192:195],v[44:47]
v_mfma_f32_16x16x32_bf16 v[32:35],a[200:203],v[120:123],v[32:35]
v_mfma_f32_16x16x32_bf16 v[48:51],v[120:123],v[200:203],v[48:51]
v_mfma_f32_16x16x32_bf16 v[36:39],a[200:203],v[124:127],v[36:39]
v_mfma_f32_16x16x32_bf16 v[52:55],v[124:127],v[200:203],v[52:55]
s_waitcnt lgkmcnt(2)
v_mfma_f32_16x16x32_bf16 v[24:27],a[196:199],v[104:107],v[24:27]
ds_read_b128 v[120:123],v7 offset:16384
v_mfma_f32_16x16x32_bf16 v[40:43],v[104:107],v[196:199],v[40:43]
s_waitcnt vmcnt(0)
v_mfma_f32_16x16x32_bf16 v[28:31],a[196:199],v[108:111],v[28:31]
ds_read_b128 v[124:127],v7 offset:20480
v_mfma_f32_16x16x32_bf16 v[44:47],v[108:111],v[196:199],v[44:47]
v_cmp_eq_u32 vcc,0,v76
v_mfma_f32_16x16x32_bf16 v[32:35],a[204:207],v[104:107],v[32:35]
s_nop 0
v_mov_b32 v76,vcc_lo
v_mfma_f32_16x16x32_bf16 v[48:51],v[104:107],v[204:207],v[48:51]
ds_write_b32 v19,v76
v_mfma_f32_16x16x32_bf16 v[36:39],a[204:207],v[108:111],v[36:39]
v_mfma_f32_16x16x32_bf16 v[52:55],v[108:111],v[204:207],v[52:55]
s_waitcnt vmcnt(0) lgkmcnt(0)
s_barrier
s_or_b32 s70,s70,s52
buffer_store_dword v17,off,s[8:11],s70 sc1
ds_read_b32 v76,v16
v_mfma_f32_16x16x32_bf16 v[24:27],a[208:211],v[112:115],v[24:27]
ds_read_b128 v[104:107],v4 offset:24576
v_mfma_f32_16x16x32_bf16 v[40:43],v[112:115],v[208:211],v[40:43]
v_mfma_f32_16x16x32_bf16 v[28:31],a[208:211],v[116:119],v[28:31]
ds_read_b128 v[108:111],v4 offset:28672
v_mfma_f32_16x16x32_bf16 v[44:47],v[116:119],v[208:211],v[44:47]
v_mfma_f32_16x16x32_bf16 v[32:35],a[216:219],v[112:115],v[32:35]
v_mfma_f32_16x16x32_bf16 v[48:51],v[112:115],v[216:219],v[48:51]
v_mfma_f32_16x16x32_bf16 v[36:39],a[216:219],v[116:119],v[36:39]
v_mfma_f32_16x16x32_bf16 v[52:55],v[116:119],v[216:219],v[52:55]
s_waitcnt lgkmcnt(2)
v_mfma_f32_16x16x32_bf16 v[24:27],a[212:215],v[120:123],v[24:27]
ds_read_b128 v[112:115],v5 offset:24576
v_mfma_f32_16x16x32_bf16 v[40:43],v[120:123],v[212:215],v[40:43]
v_readfirstlane_b32 s57,v76
v_mfma_f32_16x16x32_bf16 v[28:31],a[212:215],v[124:127],v[28:31]
ds_read_b128 v[116:119],v5 offset:28672
v_mfma_f32_16x16x32_bf16 v[44:47],v[124:127],v[212:215],v[44:47]
s_sub_u32 s59,s55,s54
s_cmp_lt_i32 s59,24
s_cselect_b32 s76,2,0
v_mfma_f32_16x16x32_bf16 v[32:35],a[220:223],v[120:123],v[32:35]
s_cmp_eq_u32 s57,0
s_cselect_b32 s76,1,s76
v_mfma_f32_16x16x32_bf16 v[48:51],v[120:123],v[220:223],v[48:51]
s_cmp_lt_i32 s59,12
s_cselect_b32 s76,2,s76
s_add_u32 s57,s54,64
v_mfma_f32_16x16x32_bf16 v[36:39],a[220:223],v[124:127],v[36:39]
s_cmp_eq_u32 s76,1
s_cselect_b32 s68,s57,s55
s_lshl_b32 s68,s68,15
v_mfma_f32_16x16x32_bf16 v[52:55],v[124:127],v[220:223],v[52:55]
s_cmp_eq_u32 s76,0
s_cselect_b32 s68,0x80000000,s68
s_add_u32 s69,s68,16384
s_waitcnt lgkmcnt(2)
v_mfma_f32_16x16x32_bf16 v[24:27],a[224:227],v[104:107],v[24:27]
ds_read_b128 v[120:123],v6 offset:24576
v_mfma_f32_16x16x32_bf16 v[40:43],v[104:107],v[224:227],v[40:43]
s_add_u32 m0,s75,65536
v_mfma_f32_16x16x32_bf16 v[28:31],a[224:227],v[108:111],v[28:31]
ds_read_b128 v[124:127],v6 offset:28672
v_mfma_f32_16x16x32_bf16 v[44:47],v[108:111],v[224:227],v[44:47]
buffer_load_dwordx4 v20,s[8:11],s68 offen offset:0 sc1 lds
v_mfma_f32_16x16x32_bf16 v[32:35],a[232:235],v[104:107],v[32:35]
s_add_u32 m0,s75,69632
v_mfma_f32_16x16x32_bf16 v[48:51],v[104:107],v[232:235],v[48:51]
buffer_load_dwordx4 v20,s[8:11],s69 offen offset:0 sc1 lds
v_mfma_f32_16x16x32_bf16 v[36:39],a[232:235],v[108:111],v[36:39]
s_add_u32 m0,s75,73472
v_mfma_f32_16x16x32_bf16 v[52:55],v[108:111],v[232:235],v[52:55]
buffer_load_dwordx4 v20,s[8:11],s68 offen offset:256 sc1 lds
s_waitcnt lgkmcnt(2)
v_mfma_f32_16x16x32_bf16 v[24:27],a[228:231],v[112:115],v[24:27]
ds_read_b128 v[104:107],v7 offset:24576
v_mfma_f32_16x16x32_bf16 v[40:43],v[112:115],v[228:231],v[40:43]
s_add_u32 m0,s75,77568
v_mfma_f32_16x16x32_bf16 v[28:31],a[228:231],v[116:119],v[28:31]
ds_read_b128 v[108:111],v7 offset:28672
v_mfma_f32_16x16x32_bf16 v[44:47],v[116:119],v[228:231],v[44:47]
buffer_load_dwordx4 v20,s[8:11],s69 offen offset:256 sc1 lds
v_mfma_f32_16x16x32_bf16 v[32:35],a[236:239],v[112:115],v[32:35]
s_add_u32 m0,s75,81408
v_mfma_f32_16x16x32_bf16 v[48:51],v[112:115],v[236:239],v[48:51]
buffer_load_dwordx4 v20,s[8:11],s68 offen offset:512 sc1 lds
v_mfma_f32_16x16x32_bf16 v[36:39],a[236:239],v[116:119],v[36:39]
s_add_u32 m0,s75,85504
v_mfma_f32_16x16x32_bf16 v[52:55],v[116:119],v[236:239],v[52:55]
buffer_load_dwordx4 v20,s[8:11],s69 offen offset:512 sc1 lds
s_waitcnt lgkmcnt(2)
v_mfma_f32_16x16x32_bf16 v[24:27],a[240:243],v[120:123],v[24:27]
ds_read_b128 v[112:115],v4 offset:0
v_mfma_f32_16x16x32_bf16 v[40:43],v[120:123],v[240:243],v[40:43]
s_add_u32 m0,s75,89344
v_mfma_f32_16x16x32_bf16 v[28:31],a[240:243],v[124:127],v[28:31]
ds_read_b128 v[116:119],v4 offset:4096
v_mfma_f32_16x16x32_bf16 v[44:47],v[124:127],v[240:243],v[44:47]
buffer_load_dwordx4 v20,s[8:11],s68 offen offset:768 sc1 lds
v_mfma_f32_16x16x32_bf16 v[32:35],a[248:251],v[120:123],v[32:35]
s_add_u32 m0,s75,93440
v_mfma_f32_16x16x32_bf16 v[48:51],v[120:123],v[248:251],v[48:51]
buffer_load_dwordx4 v20,s[8:11],s69 offen offset:768 sc1 lds
v_mfma_f32_16x16x32_bf16 v[36:39],a[248:251],v[124:127],v[36:39]
v_mfma_f32_16x16x32_bf16 v[52:55],v[124:127],v[248:251],v[52:55]
s_waitcnt lgkmcnt(2)
v_mfma_f32_16x16x32_bf16 v[24:27],a[244:247],v[104:107],v[24:27]
ds_read_b128 v[120:123],v5 offset:0
v_mfma_f32_16x16x32_bf16 v[40:43],v[104:107],v[244:247],v[40:43]
v_mfma_f32_16x16x32_bf16 v[28:31],a[244:247],v[108:111],v[28:31]
ds_read_b128 v[124:127],v5 offset:4096
v_mfma_f32_16x16x32_bf16 v[44:47],v[108:111],v[244:247],v[44:47]
v_mfma_f32_16x16x32_bf16 v[32:35],a[252:255],v[104:107],v[32:35]
v_mfma_f32_16x16x32_bf16 v[48:51],v[104:107],v[252:255],v[48:51]
v_mfma_f32_16x16x32_bf16 v[36:39],a[252:255],v[108:111],v[36:39]
v_mfma_f32_16x16x32_bf16 v[52:55],v[108:111],v[252:255],v[52:55]
s_waitcnt lgkmcnt(2)
v_mfma_f32_16x16x32_bf16 v[88:91],a[0:3],v[112:115],0
ds_read_b128 v[104:107],v6 offset:0
v_mfma_f32_16x16x32_bf16 v[92:95],a[0:3],v[116:119],0
v_mfma_f32_16x16x32_bf16 v[96:99],a[8:11],v[112:115],0
ds_read_b128 v[108:111],v6 offset:4096
v_mfma_f32_16x16x32_bf16 v[100:103],a[8:11],v[116:119],0
s_waitcnt lgkmcnt(2)
v_mfma_f32_16x16x32_bf16 v[88:91],a[4:7],v[120:123],v[88:91]
ds_read_b128 v[112:115],v7 offset:0
v_mfma_f32_16x16x32_bf16 v[92:95],a[4:7],v[124:127],v[92:95]
v_cvt_pk_bf16_f32 v56,v24,v32
v_cvt_pk_bf16_f32 v57,v25,v33
v_mfma_f32_16x16x32_bf16 v[96:99],a[12:15],v[120:123],v[96:99]
ds_read_b128 v[116:119],v7 offset:4096
v_mfma_f32_16x16x32_bf16 v[100:103],a[12:15],v[124:127],v[100:103]
v_cvt_pk_bf16_f32 v58,v26,v34
v_cvt_pk_bf16_f32 v59,v27,v35
s_waitcnt lgkmcnt(2)
v_mfma_f32_16x16x32_bf16 v[88:91],a[16:19],v[104:107],v[88:91]
ds_read_b128 v[120:123],v4 offset:8192
v_mfma_f32_16x16x32_bf16 v[92:95],a[16:19],v[108:111],v[92:95]
buffer_store_dwordx4 v[56:59],v0,s[8:11],s61 offen sc1
v_cvt_pk_bf16_f32 v60,v28,v36
v_mfma_f32_16x16x32_bf16 v[96:99],a[24:27],v[104:107],v[96:99]
ds_read_b128 v[124:127],v4 offset:12288
v_mfma_f32_16x16x32_bf16 v[100:103],a[24:27],v[108:111],v[100:103]
v_cvt_pk_bf16_f32 v61,v29,v37
v_cvt_pk_bf16_f32 v62,v30,v38
s_waitcnt lgkmcnt(2)
v_mfma_f32_16x16x32_bf16 v[88:91],a[20:23],v[112:115],v[88:91]
ds_read_b128 v[104:107],v5 offset:8192
v_mfma_f32_16x16x32_bf16 v[92:95],a[20:23],v[116:119],v[92:95]
v_cvt_pk_bf16_f32 v63,v31,v39
buffer_store_dwordx4 v[60:63],v0,s[8:11],s62 offen sc1
v_mfma_f32_16x16x32_bf16 v[96:99],a[28:31],v[112:115],v[96:99]
ds_read_b128 v[108:111],v5 offset:12288
v_mfma_f32_16x16x32_bf16 v[100:103],a[28:31],v[116:119],v[100:103]
v_cvt_pk_bf16_f32 v64,v40,v41
v_cvt_pk_bf16_f32 v65,v42,v43
s_waitcnt lgkmcnt(2)
v_mfma_f32_16x16x32_bf16 v[88:91],a[32:35],v[120:123],v[88:91]
ds_read_b128 v[112:115],v6 offset:8192
v_mfma_f32_16x16x32_bf16 v[92:95],a[32:35],v[124:127],v[92:95]
v_cvt_pk_bf16_f32 v66,v44,v45
v_cvt_pk_bf16_f32 v67,v46,v47
v_mfma_f32_16x16x32_bf16 v[96:99],a[40:43],v[120:123],v[96:99]
ds_read_b128 v[116:119],v6 offset:12288
v_mfma_f32_16x16x32_bf16 v[100:103],a[40:43],v[124:127],v[100:103]
buffer_store_dwordx4 v[64:67],v0,s[8:11],s65 offen offset:0 sc1
v_cvt_pk_bf16_f32 v68,v48,v49
s_waitcnt lgkmcnt(2)
v_mfma_f32_16x16x32_bf16 v[88:91],a[36:39],v[104:107],v[88:91]
ds_read_b128 v[120:123],v7 offset:8192
v_mfma_f32_16x16x32_bf16 v[92:95],a[36:39],v[108:111],v[92:95]
v_cvt_pk_bf16_f32 v69,v50,v51
v_cvt_pk_bf16_f32 v70,v52,v53
v_mfma_f32_16x16x32_bf16 v[96:99],a[44:47],v[104:107],v[96:99]
ds_read_b128 v[124:127],v7 offset:12288
v_mfma_f32_16x16x32_bf16 v[100:103],a[44:47],v[108:111],v[100:103]
v_cvt_pk_bf16_f32 v71,v54,v55
buffer_store_dwordx4 v[68:71],v0,s[8:11],s65 offen offset:1024 sc1
s_waitcnt lgkmcnt(2)
v_mfma_f32_16x16x32_bf16 v[88:91],a[48:51],v[112:115],v[88:91]
ds_read_b128 v[104:107],v4 offset:16384
v_mfma_f32_16x16x32_bf16 v[92:95],a[48:51],v[116:119],v[92:95]
v_mfma_f32_16x16x32_bf16 v[96:99],a[56:59],v[112:115],v[96:99]
ds_read_b128 v[108:111],v4 offset:20480
v_mfma_f32_16x16x32_bf16 v[100:103],a[56:59],v[116:119],v[100:103]
s_waitcnt lgkmcnt(2)
v_mfma_f32_16x16x32_bf16 v[88:91],a[52:55],v[120:123],v[88:91]
ds_read_b128 v[112:115],v5 offset:16384
v_mfma_f32_16x16x32_bf16 v[92:95],a[52:55],v[124:127],v[92:95]
v_mfma_f32_16x16x32_bf16 v[96:99],a[60:63],v[120:123],v[96:99]
ds_read_b128 v[116:119],v5 offset:20480
v_mfma_f32_16x16x32_bf16 v[100:103],a[60:63],v[124:127],v[100:103]
s_waitcnt lgkmcnt(2)
v_mfma_f32_16x16x32_bf16 v[88:91],a[64:67],v[104:107],v[88:91]
ds_read_b128 v[120:123],v6 offset:16384
v_mfma_f32_16x16x32_bf16 v[92:95],a[64:67],v[108:111],v[92:95]
v_mfma_f32_16x16x32_bf16 v[96:99],a[72:75],v[104:107],v[96:99]
ds_read_b128 v[124:127],v6 offset:20480
v_mfma_f32_16x16x32_bf16 v[100:103],a[72:75],v[108:111],v[100:103]
s_waitcnt lgkmcnt(2)
v_mfma_f32_16x16x32_bf16 v[88:91],a[68:71],v[112:115],v[88:91]
ds_read_b128 v[104:107],v7 offset:16384
v_mfma_f32_16x16x32_bf16 v[92:95],a[68:71],v[116:119],v[92:95]
v_mfma_f32_16x16x32_bf16 v[96:99],a[76:79],v[112:115],v[96:99]
ds_read_b128 v[108:111],v7 offset:20480
v_mfma_f32_16x16x32_bf16 v[100:103],a[76:79],v[116:119],v[100:103]
s_waitcnt lgkmcnt(2)
v_mfma_f32_16x16x32_bf16 v[88:91],a[80:83],v[120:123],v[88:91]
ds_read_b128 v[112:115],v4 offset:24576
v_mfma_f32_16x16x32_bf16 v[92:95],a[80:83],v[124:127],v[92:95]
v_mfma_f32_16x16x32_bf16 v[96:99],a[88:91],v[120:123],v[96:99]
ds_read_b128 v[116:119],v4 offset:28672
v_mfma_f32_16x16x32_bf16 v[100:103],a[88:91],v[124:127],v[100:103]
s_waitcnt lgkmcnt(2)
v_mfma_f32_16x16x32_bf16 v[88:91],a[84:87],v[104:107],v[88:91]
ds_read_b128 v[120:123],v5 offset:24576
v_mfma_f32_16x16x32_bf16 v[92:95],a[84:87],v[108:111],v[92:95]
v_mfma_f32_16x16x32_bf16 v[96:99],a[92:95],v[104:107],v[96:99]
ds_read_b128 v[124:127],v5 offset:28672
v_mfma_f32_16x16x32_bf16 v[100:103],a[92:95],v[108:111],v[100:103]
s_waitcnt lgkmcnt(2)
v_mfma_f32_16x16x32_bf16 v[88:91],a[96:99],v[112:115],v[88:91]
ds_read_b128 v[104:107],v6 offset:24576
v_mfma_f32_16x16x32_bf16 v[92:95],a[96:99],v[116:119],v[92:95]
v_mfma_f32_16x16x32_bf16 v[96:99],a[104:107],v[112:115],v[96:99]
ds_read_b128 v[108:111],v6 offset:28672
v_mfma_f32_16x16x32_bf16 v[100:103],a[104:107],v[116:119],v[100:103]
s_waitcnt lgkmcnt(2)
v_mfma_f32_16x16x32_bf16 v[88:91],a[100:103],v[120:123],v[88:91]
ds_read_b128 v[112:115],v7 offset:24576
v_mfma_f32_16x16x32_bf16 v[92:95],a[100:103],v[124:127],v[92:95]
v_mfma_f32_16x16x32_bf16 v[96:99],a[108:111],v[120:123],v[96:99]
ds_read_b128 v[116:119],v7 offset:28672
v_mfma_f32_16x16x32_bf16 v[100:103],a[108:111],v[124:127],v[100:103]
s_waitcnt lgkmcnt(2)
v_mfma_f32_16x16x32_bf16 v[88:91],a[112:115],v[104:107],v[88:91]
v_mfma_f32_16x16x32_bf16 v[92:95],a[112:115],v[108:111],v[92:95]
v_mfma_f32_16x16x32_bf16 v[96:99],a[120:123],v[104:107],v[96:99]
v_mfma_f32_16x16x32_bf16 v[100:103],a[120:123],v[108:111],v[100:103]
s_waitcnt lgkmcnt(0)
v_mfma_f32_16x16x32_bf16 v[88:91],a[116:119],v[112:115],v[88:91]
v_mfma_f32_16x16x32_bf16 v[92:95],a[116:119],v[116:119],v[92:95]
v_mfma_f32_16x16x32_bf16 v[96:99],a[124:127],v[112:115],v[96:99]
v_mfma_f32_16x16x32_bf16 v[100:103],a[124:127],v[116:119],v[100:103]
s_nop 3
v_cvt_pk_bf16_f32 v104,v88,v96
v_cvt_pk_bf16_f32 v105,v89,v97
v_cvt_pk_bf16_f32 v106,v90,v98
v_cvt_pk_bf16_f32 v107,v91,v99
v_cvt_pk_bf16_f32 v108,v92,v100
v_cvt_pk_bf16_f32 v109,v93,v101
v_cvt_pk_bf16_f32 v110,v94,v102
v_cvt_pk_bf16_f32 v111,v95,v103
buffer_store_dwordx4 v[104:107],v0,s[8:11],s63 offen sc1
buffer_store_dwordx4 v[108:111],v0,s[8:11],s64 offen sc1
s_lshl_b32 s59,s51,13
s_lshl2_add_u32 s59,s47,s59
s_add_u32 s59,s59,10485888
s_waitcnt vmcnt(2)
s_barrier
s_or_b32 s59,s59,s52
buffer_store_dword v17,off,s[8:11],s59 sc1
s_lshl_b32 s70,s51,13
s_lshl2_add_u32 s70,s47,s70
s_add_u32 s70,s70,10486144
s_branch L_p_14
L_p_13:
s_mov_b32 s75,s74
s_xor_b32 s74,s74,32768
v_xor_b32 v4,32768,v4
v_xor_b32 v5,32768,v5
v_xor_b32 v6,32768,v6
v_xor_b32 v7,32768,v7
s_lshl_b32 s58,s51,5
s_add_u32 s58,s58,s47
s_mul_i32 s58,s58,24576
s_add_u32 s58,s58,150994944
s_add_u32 s61,s58,s50
s_add_u32 s62,s61,4096
s_add_u32 s63,s61,16384
s_add_u32 s64,s61,20480
s_add_u32 s65,s61,s50
s_add_u32 s65,s65,8192
ds_read_b128 v[104:107],v4 offset:0
ds_read_b128 v[108:111],v4 offset:4096
ds_read_b128 v[112:115],v5 offset:0
ds_read_b128 v[116:119],v5 offset:4096
s_waitcnt lgkmcnt(2)
v_mfma_f32_16x16x32_bf16 v[24:27],a[128:131],v[104:107],0
ds_read_b128 v[120:123],v6 offset:0
v_mfma_f32_16x16x32_bf16 v[40:43],v[104:107],v[128:131],0
v_mfma_f32_16x16x32_bf16 v[28:31],a[128:131],v[108:111],0
ds_read_b128 v[124:127],v6 offset:4096
v_mfma_f32_16x16x32_bf16 v[44:47],v[108:111],v[128:131],0
v_mfma_f32_16x16x32_bf16 v[32:35],a[136:139],v[104:107],0
v_mfma_f32_16x16x32_bf16 v[48:51],v[104:107],v[136:139],0
v_mfma_f32_16x16x32_bf16 v[36:39],a[136:139],v[108:111],0
v_mfma_f32_16x16x32_bf16 v[52:55],v[108:111],v[136:139],0
s_waitcnt lgkmcnt(2)
v_mfma_f32_16x16x32_bf16 v[24:27],a[132:135],v[112:115],v[24:27]
ds_read_b128 v[104:107],v7 offset:0
v_mfma_f32_16x16x32_bf16 v[40:43],v[112:115],v[132:135],v[40:43]
v_mfma_f32_16x16x32_bf16 v[28:31],a[132:135],v[116:119],v[28:31]
ds_read_b128 v[108:111],v7 offset:4096
v_mfma_f32_16x16x32_bf16 v[44:47],v[116:119],v[132:135],v[44:47]
v_mfma_f32_16x16x32_bf16 v[32:35],a[140:143],v[112:115],v[32:35]
v_mfma_f32_16x16x32_bf16 v[48:51],v[112:115],v[140:143],v[48:51]
v_mfma_f32_16x16x32_bf16 v[36:39],a[140:143],v[116:119],v[36:39]
v_mfma_f32_16x16x32_bf16 v[52:55],v[116:119],v[140:143],v[52:55]
s_waitcnt lgkmcnt(2)
v_mfma_f32_16x16x32_bf16 v[24:27],a[144:147],v[120:123],v[24:27]
ds_read_b128 v[112:115],v4 offset:8192
v_mfma_f32_16x16x32_bf16 v[40:43],v[120:123],v[144:147],v[40:43]
v_mfma_f32_16x16x32_bf16 v[28:31],a[144:147],v[124:127],v[28:31]
ds_read_b128 v[116:119],v4 offset:12288
v_mfma_f32_16x16x32_bf16 v[44:47],v[124:127],v[144:147],v[44:47]
v_mfma_f32_16x16x32_bf16 v[32:35],a[152:155],v[120:123],v[32:35]
v_mfma_f32_16x16x32_bf16 v[48:51],v[120:123],v[152:155],v[48:51]
v_mfma_f32_16x16x32_bf16 v[36:39],a[152:155],v[124:127],v[36:39]
v_mfma_f32_16x16x32_bf16 v[52:55],v[124:127],v[152:155],v[52:55]
s_waitcnt lgkmcnt(2)
v_mfma_f32_16x16x32_bf16 v[24:27],a[148:151],v[104:107],v[24:27]
ds_read_b128 v[120:123],v5 offset:8192
v_mfma_f32_16x16x32_bf16 v[40:43],v[104:107],v[148:151],v[40:43]
s_lshl_b32 s56,s54,13
v_mfma_f32_16x16x32_bf16 v[28:31],a[148:151],v[108:111],v[28:31]
ds_read_b128 v[124:127],v5 offset:12288
v_mfma_f32_16x16x32_bf16 v[44:47],v[108:111],v[148:151],v[44:47]
s_add_u32 s56,s56,10487552
v_mfma_f32_16x16x32_bf16 v[32:35],a[156:159],v[104:107],v[32:35]
s_or_b32 s56,s56,s52
v_mfma_f32_16x16x32_bf16 v[48:51],v[104:107],v[156:159],v[48:51]
buffer_load_dword v76,v23,s[8:11],s56 offen sc1
v_mfma_f32_16x16x32_bf16 v[36:39],a[156:159],v[108:111],v[36:39]
v_mfma_f32_16x16x32_bf16 v[52:55],v[108:111],v[156:159],v[52:55]
s_waitcnt lgkmcnt(2)
v_mfma_f32_16x16x32_bf16 v[24:27],a[160:163],v[112:115],v[24:27]
ds_read_b128 v[104:107],v6 offset:8192
v_mfma_f32_16x16x32_bf16 v[40:43],v[112:115],v[160:163],v[40:43]
v_mfma_f32_16x16x32_bf16 v[28:31],a[160:163],v[116:119],v[28:31]
ds_read_b128 v[108:111],v6 offset:12288
v_mfma_f32_16x16x32_bf16 v[44:47],v[116:119],v[160:163],v[44:47]
v_mfma_f32_16x16x32_bf16 v[32:35],a[168:171],v[112:115],v[32:35]
v_mfma_f32_16x16x32_bf16 v[48:51],v[112:115],v[168:171],v[48:51]
v_mfma_f32_16x16x32_bf16 v[36:39],a[168:171],v[116:119],v[36:39]
v_mfma_f32_16x16x32_bf16 v[52:55],v[116:119],v[168:171],v[52:55]
s_waitcnt lgkmcnt(2)
v_mfma_f32_16x16x32_bf16 v[24:27],a[164:167],v[120:123],v[24:27]
ds_read_b128 v[112:115],v7 offset:8192
v_mfma_f32_16x16x32_bf16 v[40:43],v[120:123],v[164:167],v[40:43]
v_mfma_f32_16x16x32_bf16 v[28:31],a[164:167],v[124:127],v[28:31]
ds_read_b128 v[116:119],v7 offset:12288
v_mfma_f32_16x16x32_bf16 v[44:47],v[124:127],v[164:167],v[44:47]
v_mfma_f32_16x16x32_bf16 v[32:35],a[172:175],v[120:123],v[32:35]
v_mfma_f32_16x16x32_bf16 v[48:51],v[120:123],v[172:175],v[48:51]
v_mfma_f32_16x16x32_bf16 v[36:39],a[172:175],v[124:127],v[36:39]
v_mfma_f32_16x16x32_bf16 v[52:55],v[124:127],v[172:175],v[52:55]
s_waitcnt lgkmcnt(2)
v_mfma_f32_16x16x32_bf16 v[24:27],a[176:179],v[104:107],v[24:27]
ds_read_b128 v[120:123],v4 offset:16384
v_mfma_f32_16x16x32_bf16 v[40:43],v[104:107],v[176:179],v[40:43]
v_mfma_f32_16x16x32_bf16 v[28:31],a[176:179],v[108:111],v[28:31]
ds_read_b128 v[124:127],v4 offset:20480
v_mfma_f32_16x16x32_bf16 v[44:47],v[108:111],v[176:179],v[44:47]
v_mfma_f32_16x16x32_bf16 v[32:35],a[184:187],v[104:107],v[32:35]
v_mfma_f32_16x16x32_bf16 v[48:51],v[104:107],v[184:187],v[48:51]
v_mfma_f32_16x16x32_bf16 v[36:39],a[184:187],v[108:111],v[36:39]
v_mfma_f32_16x16x32_bf16 v[52:55],v[108:111],v[184:187],v[52:55]
s_waitcnt lgkmcnt(2)
v_mfma_f32_16x16x32_bf16 v[24:27],a[180:183],v[112:115],v[24:27]
ds_read_b128 v[104:107],v5 offset:16384
v_mfma_f32_16x16x32_bf16 v[40:43],v[112:115],v[180:183],v[40:43]
v_mfma_f32_16x16x32_bf16 v[28:31],a[180:183],v[116:119],v[28:31]
ds_read_b128 v[108:111],v5 offset:20480
v_mfma_f32_16x16x32_bf16 v[44:47],v[116:119],v[180:183],v[44:47]
v_mfma_f32_16x16x32_bf16 v[32:35],a[188:191],v[112:115],v[32:35]
v_mfma_f32_16x16x32_bf16 v[48:51],v[112:115],v[188:191],v[48:51]
v_mfma_f32_16x16x32_bf16 v[36:39],a[188:191],v[116:119],v[36:39]
v_mfma_f32_16x16x32_bf16 v[52:55],v[116:119],v[188:191],v[52:55]
s_waitcnt lgkmcnt(2)
v_mfma_f32_16x16x32_bf16 v[24:27],a[192:195],v[120:123],v[24:27]
ds_read_b128 v[112:115],v6 offset:16384
v_mfma_f32_16x16x32_bf16 v[40:43],v[120:123],v[192:195],v[40:43]
v_mfma_f32_16x16x32_bf16 v[28:31],a[192:195],v[124:127],v[28:31]
ds_read_b128 v[116:119],v6 offset:20480
v_mfma_f32_16x16x32_bf16 v[44:47],v[124:127],v[192:195],v[44:47]
v_mfma_f32_16x16x32_bf16 v[32:35],a[200:203],v[120:123],v[32:35]
v_mfma_f32_16x16x32_bf16 v[48:51],v[120:123],v[200:203],v[48:51]
v_mfma_f32_16x16x32_bf16 v[36:39],a[200:203],v[124:127],v[36:39]
v_mfma_f32_16x16x32_bf16 v[52:55],v[124:127],v[200:203],v[52:55]
s_waitcnt lgkmcnt(2)
v_mfma_f32_16x16x32_bf16 v[24:27],a[196:199],v[104:107],v[24:27]
ds_read_b128 v[120:123],v7 offset:16384
v_mfma_f32_16x16x32_bf16 v[40:43],v[104:107],v[196:199],v[40:43]
s_waitcnt vmcnt(0)
v_mfma_f32_16x16x32_bf16 v[28:31],a[196:199],v[108:111],v[28:31]
ds_read_b128 v[124:127],v7 offset:20480
v_mfma_f32_16x16x32_bf16 v[44:47],v[108:111],v[196:199],v[44:47]
v_cmp_eq_u32 vcc,0,v76
v_mfma_f32_16x16x32_bf16 v[32:35],a[204:207],v[104:107],v[32:35]
s_nop 0
v_mov_b32 v76,vcc_lo
v_mfma_f32_16x16x32_bf16 v[48:51],v[104:107],v[204:207],v[48:51]
ds_write_b32 v19,v76
v_mfma_f32_16x16x32_bf16 v[36:39],a[204:207],v[108:111],v[36:39]
v_mfma_f32_16x16x32_bf16 v[52:55],v[108:111],v[204:207],v[52:55]
s_waitcnt vmcnt(0) lgkmcnt(0)
s_barrier
s_or_b32 s70,s70,s52
buffer_store_dword v17,off,s[8:11],s70 sc1
ds_read_b32 v76,v16
v_mfma_f32_16x16x32_bf16 v[24:27],a[208:211],v[112:115],v[24:27]
ds_read_b128 v[104:107],v4 offset:24576
v_mfma_f32_16x16x32_bf16 v[40:43],v[112:115],v[208:211],v[40:43]
v_mfma_f32_16x16x32_bf16 v[28:31],a[208:211],v[116:119],v[28:31]
ds_read_b128 v[108:111],v4 offset:28672
v_mfma_f32_16x16x32_bf16 v[44:47],v[116:119],v[208:211],v[44:47]
v_mfma_f32_16x16x32_bf16 v[32:35],a[216:219],v[112:115],v[32:35]
v_mfma_f32_16x16x32_bf16 v[48:51],v[112:115],v[216:219],v[48:51]
v_mfma_f32_16x16x32_bf16 v[36:39],a[216:219],v[116:119],v[36:39]
v_mfma_f32_16x16x32_bf16 v[52:55],v[116:119],v[216:219],v[52:55]
s_waitcnt lgkmcnt(2)
v_mfma_f32_16x16x32_bf16 v[24:27],a[212:215],v[120:123],v[24:27]
ds_read_b128 v[112:115],v5 offset:24576
v_mfma_f32_16x16x32_bf16 v[40:43],v[120:123],v[212:215],v[40:43]
v_readfirstlane_b32 s57,v76
v_mfma_f32_16x16x32_bf16 v[28:31],a[212:215],v[124:127],v[28:31]
ds_read_b128 v[116:119],v5 offset:28672
v_mfma_f32_16x16x32_bf16 v[44:47],v[124:127],v[212:215],v[44:47]
s_sub_u32 s59,s55,s54
s_cmp_lt_i32 s59,24
s_cselect_b32 s76,2,0
v_mfma_f32_16x16x32_bf16 v[32:35],a[220:223],v[120:123],v[32:35]
s_cmp_eq_u32 s57,0
s_cselect_b32 s76,1,s76
v_mfma_f32_16x16x32_bf16 v[48:51],v[120:123],v[220:223],v[48:51]
s_cmp_lt_i32 s59,12
s_cselect_b32 s76,2,s76
s_add_u32 s57,s54,64
v_mfma_f32_16x16x32_bf16 v[36:39],a[220:223],v[124:127],v[36:39]
s_cmp_eq_u32 s76,1
s_cselect_b32 s68,s57,s55
s_lshl_b32 s68,s68,15
v_mfma_f32_16x16x32_bf16 v[52:55],v[124:127],v[220:223],v[52:55]
s_cmp_eq_u32 s76,0
s_cselect_b32 s68,0x80000000,s68
s_add_u32 s69,s68,16384
s_waitcnt lgkmcnt(2)
v_mfma_f32_16x16x32_bf16 v[24:27],a[224:227],v[104:107],v[24:27]
ds_read_b128 v[120:123],v6 offset:24576
v_mfma_f32_16x16x32_bf16 v[40:43],v[104:107],v[224:227],v[40:43]
s_add_u32 m0,s75,65536
v_mfma_f32_16x16x32_bf16 v[28:31],a[224:227],v[108:111],v[28:31]
ds_read_b128 v[124:127],v6 offset:28672
v_mfma_f32_16x16x32_bf16 v[44:47],v[108:111],v[224:227],v[44:47]
buffer_load_dwordx4 v20,s[8:11],s68 offen offset:0 sc1 lds
v_mfma_f32_16x16x32_bf16 v[32:35],a[232:235],v[104:107],v[32:35]
s_add_u32 m0,s75,69632
v_mfma_f32_16x16x32_bf16 v[48:51],v[104:107],v[232:235],v[48:51]
buffer_load_dwordx4 v20,s[8:11],s69 offen offset:0 sc1 lds
v_mfma_f32_16x16x32_bf16 v[36:39],a[232:235],v[108:111],v[36:39]
s_add_u32 m0,s75,73472
v_mfma_f32_16x16x32_bf16 v[52:55],v[108:111],v[232:235],v[52:55]
buffer_load_dwordx4 v20,s[8:11],s68 offen offset:256 sc1 lds
s_waitcnt lgkmcnt(2)
v_mfma_f32_16x16x32_bf16 v[24:27],a[228:231],v[112:115],v[24:27]
ds_read_b128 v[104:107],v7 offset:24576
v_mfma_f32_16x16x32_bf16 v[40:43],v[112:115],v[228:231],v[40:43]
s_add_u32 m0,s75,77568
v_mfma_f32_16x16x32_bf16 v[28:31],a[228:231],v[116:119],v[28:31]
ds_read_b128 v[108:111],v7 offset:28672
v_mfma_f32_16x16x32_bf16 v[44:47],v[116:119],v[228:231],v[44:47]
buffer_load_dwordx4 v20,s[8:11],s69 offen offset:256 sc1 lds
v_mfma_f32_16x16x32_bf16 v[32:35],a[236:239],v[112:115],v[32:35]
s_add_u32 m0,s75,81408
v_mfma_f32_16x16x32_bf16 v[48:51],v[112:115],v[236:239],v[48:51]
buffer_load_dwordx4 v20,s[8:11],s68 offen offset:512 sc1 lds
v_mfma_f32_16x16x32_bf16 v[36:39],a[236:239],v[116:119],v[36:39]
s_add_u32 m0,s75,85504
v_mfma_f32_16x16x32_bf16 v[52:55],v[116:119],v[236:239],v[52:55]
buffer_load_dwordx4 v20,s[8:11],s69 offen offset:512 sc1 lds
s_waitcnt lgkmcnt(2)
v_mfma_f32_16x16x32_bf16 v[24:27],a[240:243],v[120:123],v[24:27]
ds_read_b128 v[112:115],v4 offset:0
v_mfma_f32_16x16x32_bf16 v[40:43],v[120:123],v[240:243],v[40:43]
s_add_u32 m0,s75,89344
v_mfma_f32_16x16x32_bf16 v[28:31],a[240:243],v[124:127],v[28:31]
ds_read_b128 v[116:119],v4 offset:4096
v_mfma_f32_16x16x32_bf16 v[44:47],v[124:127],v[240:243],v[44:47]
buffer_load_dwordx4 v20,s[8:11],s68 offen offset:768 sc1 lds
v_mfma_f32_16x16x32_bf16 v[32:35],a[248:251],v[120:123],v[32:35]
s_add_u32 m0,s75,93440
v_mfma_f32_16x16x32_bf16 v[48:51],v[120:123],v[248:251],v[48:51]
buffer_load_dwordx4 v20,s[8:11],s69 offen offset:768 sc1 lds
v_mfma_f32_16x16x32_bf16 v[36:39],a[248:251],v[124:127],v[36:39]
v_mfma_f32_16x16x32_bf16 v[52:55],v[124:127],v[248:251],v[52:55]
s_waitcnt lgkmcnt(2)
v_mfma_f32_16x16x32_bf16 v[24:27],a[244:247],v[104:107],v[24:27]
ds_read_b128 v[120:123],v5 offset:0
v_mfma_f32_16x16x32_bf16 v[40:43],v[104:107],v[244:247],v[40:43]
v_mfma_f32_16x16x32_bf16 v[28:31],a[244:247],v[108:111],v[28:31]
ds_read_b128 v[124:127],v5 offset:4096
v_mfma_f32_16x16x32_bf16 v[44:47],v[108:111],v[244:247],v[44:47]
v_mfma_f32_16x16x32_bf16 v[32:35],a[252:255],v[104:107],v[32:35]
v_mfma_f32_16x16x32_bf16 v[48:51],v[104:107],v[252:255],v[48:51]
v_mfma_f32_16x16x32_bf16 v[36:39],a[252:255],v[108:111],v[36:39]
v_mfma_f32_16x16x32_bf16 v[52:55],v[108:111],v[252:255],v[52:55]
s_waitcnt lgkmcnt(2)
v_mfma_f32_16x16x32_bf16 v[88:91],a[0:3],v[112:115],0
ds_read_b128 v[104:107],v6 offset:0
v_mfma_f32_16x16x32_bf16 v[92:95],a[0:3],v[116:119],0
v_mfma_f32_16x16x32_bf16 v[96:99],a[8:11],v[112:115],0
ds_read_b128 v[108:111],v6 offset:4096
v_mfma_f32_16x16x32_bf16 v[100:103],a[8:11],v[116:119],0
s_waitcnt lgkmcnt(2)
v_mfma_f32_16x16x32_bf16 v[88:91],a[4:7],v[120:123],v[88:91]
ds_read_b128 v[112:115],v7 offset:0
v_mfma_f32_16x16x32_bf16 v[92:95],a[4:7],v[124:127],v[92:95]
v_cvt_pk_bf16_f32 v56,v24,v32
v_cvt_pk_bf16_f32 v57,v25,v33
v_mfma_f32_16x16x32_bf16 v[96:99],a[12:15],v[120:123],v[96:99]
ds_read_b128 v[116:119],v7 offset:4096
v_mfma_f32_16x16x32_bf16 v[100:103],a[12:15],v[124:127],v[100:103]
v_cvt_pk_bf16_f32 v58,v26,v34
v_cvt_pk_bf16_f32 v59,v27,v35
s_waitcnt lgkmcnt(2)
v_mfma_f32_16x16x32_bf16 v[88:91],a[16:19],v[104:107],v[88:91]
ds_read_b128 v[120:123],v4 offset:8192
v_mfma_f32_16x16x32_bf16 v[92:95],a[16:19],v[108:111],v[92:95]
buffer_store_dwordx4 v[56:59],v0,s[8:11],s61 offen sc1
v_cvt_pk_bf16_f32 v60,v28,v36
v_mfma_f32_16x16x32_bf16 v[96:99],a[24:27],v[104:107],v[96:99]
ds_read_b128 v[124:127],v4 offset:12288
v_mfma_f32_16x16x32_bf16 v[100:103],a[24:27],v[108:111],v[100:103]
v_cvt_pk_bf16_f32 v61,v29,v37
v_cvt_pk_bf16_f32 v62,v30,v38
s_waitcnt lgkmcnt(2)
v_mfma_f32_16x16x32_bf16 v[88:91],a[20:23],v[112:115],v[88:91]
ds_read_b128 v[104:107],v5 offset:8192
v_mfma_f32_16x16x32_bf16 v[92:95],a[20:23],v[116:119],v[92:95]
v_cvt_pk_bf16_f32 v63,v31,v39
buffer_store_dwordx4 v[60:63],v0,s[8:11],s62 offen sc1
v_mfma_f32_16x16x32_bf16 v[96:99],a[28:31],v[112:115],v[96:99]
ds_read_b128 v[108:111],v5 offset:12288
v_mfma_f32_16x16x32_bf16 v[100:103],a[28:31],v[116:119],v[100:103]
v_cvt_pk_bf16_f32 v64,v40,v41
v_cvt_pk_bf16_f32 v65,v42,v43
s_waitcnt lgkmcnt(2)
v_mfma_f32_16x16x32_bf16 v[88:91],a[32:35],v[120:123],v[88:91]
ds_read_b128 v[112:115],v6 offset:8192
v_mfma_f32_16x16x32_bf16 v[92:95],a[32:35],v[124:127],v[92:95]
v_cvt_pk_bf16_f32 v66,v44,v45
v_cvt_pk_bf16_f32 v67,v46,v47
v_mfma_f32_16x16x32_bf16 v[96:99],a[40:43],v[120:123],v[96:99]
ds_read_b128 v[116:119],v6 offset:12288
v_mfma_f32_16x16x32_bf16 v[100:103],a[40:43],v[124:127],v[100:103]
buffer_store_dwordx4 v[64:67],v0,s[8:11],s65 offen offset:0 sc1
v_cvt_pk_bf16_f32 v68,v48,v49
s_waitcnt lgkmcnt(2)
v_mfma_f32_16x16x32_bf16 v[88:91],a[36:39],v[104:107],v[88:91]
ds_read_b128 v[120:123],v7 offset:8192
v_mfma_f32_16x16x32_bf16 v[92:95],a[36:39],v[108:111],v[92:95]
v_cvt_pk_bf16_f32 v69,v50,v51
v_cvt_pk_bf16_f32 v70,v52,v53
v_mfma_f32_16x16x32_bf16 v[96:99],a[44:47],v[104:107],v[96:99]
ds_read_b128 v[124:127],v7 offset:12288
v_mfma_f32_16x16x32_bf16 v[100:103],a[44:47],v[108:111],v[100:103]
v_cvt_pk_bf16_f32 v71,v54,v55
buffer_store_dwordx4 v[68:71],v0,s[8:11],s65 offen offset:1024 sc1
s_waitcnt lgkmcnt(2)
v_mfma_f32_16x16x32_bf16 v[88:91],a[48:51],v[112:115],v[88:91]
ds_read_b128 v[104:107],v4 offset:16384
v_mfma_f32_16x16x32_bf16 v[92:95],a[48:51],v[116:119],v[92:95]
v_mfma_f32_16x16x32_bf16 v[96:99],a[56:59],v[112:115],v[96:99]
ds_read_b128 v[108:111],v4 offset:20480
v_mfma_f32_16x16x32_bf16 v[100:103],a[56:59],v[116:119],v[100:103]
s_waitcnt lgkmcnt(2)
v_mfma_f32_16x16x32_bf16 v[88:91],a[52:55],v[120:123],v[88:91]
ds_read_b128 v[112:115],v5 offset:16384
v_mfma_f32_16x16x32_bf16 v[92:95],a[52:55],v[124:127],v[92:95]
v_mfma_f32_16x16x32_bf16 v[96:99],a[60:63],v[120:123],v[96:99]
ds_read_b128 v[116:119],v5 offset:20480
v_mfma_f32_16x16x32_bf16 v[100:103],a[60:63],v[124:127],v[100:103]
s_waitcnt lgkmcnt(2)
v_mfma_f32_16x16x32_bf16 v[88:91],a[64:67],v[104:107],v[88:91]
ds_read_b128 v[120:123],v6 offset:16384
v_mfma_f32_16x16x32_bf16 v[92:95],a[64:67],v[108:111],v[92:95]
v_mfma_f32_16x16x32_bf16 v[96:99],a[72:75],v[104:107],v[96:99]
ds_read_b128 v[124:127],v6 offset:20480
v_mfma_f32_16x16x32_bf16 v[100:103],a[72:75],v[108:111],v[100:103]
s_waitcnt lgkmcnt(2)
v_mfma_f32_16x16x32_bf16 v[88:91],a[68:71],v[112:115],v[88:91]
ds_read_b128 v[104:107],v7 offset:16384
v_mfma_f32_16x16x32_bf16 v[92:95],a[68:71],v[116:119],v[92:95]
v_mfma_f32_16x16x32_bf16 v[96:99],a[76:79],v[112:115],v[96:99]
ds_read_b128 v[108:111],v7 offset:20480
v_mfma_f32_16x16x32_bf16 v[100:103],a[76:79],v[116:119],v[100:103]
s_waitcnt lgkmcnt(2)
v_mfma_f32_16x16x32_bf16 v[88:91],a[80:83],v[120:123],v[88:91]
ds_read_b128 v[112:115],v4 offset:24576
v_mfma_f32_16x16x32_bf16 v[92:95],a[80:83],v[124:127],v[92:95]
v_mfma_f32_16x16x32_bf16 v[96:99],a[88:91],v[120:123],v[96:99]
ds_read_b128 v[116:119],v4 offset:28672
v_mfma_f32_16x16x32_bf16 v[100:103],a[88:91],v[124:127],v[100:103]
s_waitcnt lgkmcnt(2)
v_mfma_f32_16x16x32_bf16 v[88:91],a[84:87],v[104:107],v[88:91]
ds_read_b128 v[120:123],v5 offset:24576
v_mfma_f32_16x16x32_bf16 v[92:95],a[84:87],v[108:111],v[92:95]
v_mfma_f32_16x16x32_bf16 v[96:99],a[92:95],v[104:107],v[96:99]
ds_read_b128 v[124:127],v5 offset:28672
v_mfma_f32_16x16x32_bf16 v[100:103],a[92:95],v[108:111],v[100:103]
s_waitcnt lgkmcnt(2)
v_mfma_f32_16x16x32_bf16 v[88:91],a[96:99],v[112:115],v[88:91]
ds_read_b128 v[104:107],v6 offset:24576
v_mfma_f32_16x16x32_bf16 v[92:95],a[96:99],v[116:119],v[92:95]
v_mfma_f32_16x16x32_bf16 v[96:99],a[104:107],v[112:115],v[96:99]
ds_read_b128 v[108:111],v6 offset:28672
v_mfma_f32_16x16x32_bf16 v[100:103],a[104:107],v[116:119],v[100:103]
s_waitcnt lgkmcnt(2)
v_mfma_f32_16x16x32_bf16 v[88:91],a[100:103],v[120:123],v[88:91]
ds_read_b128 v[112:115],v7 offset:24576
v_mfma_f32_16x16x32_bf16 v[92:95],a[100:103],v[124:127],v[92:95]
v_mfma_f32_16x16x32_bf16 v[96:99],a[108:111],v[120:123],v[96:99]
ds_read_b128 v[116:119],v7 offset:28672
v_mfma_f32_16x16x32_bf16 v[100:103],a[108:111],v[124:127],v[100:103]
s_waitcnt lgkmcnt(2)
v_mfma_f32_16x16x32_bf16 v[88:91],a[112:115],v[104:107],v[88:91]
v_mfma_f32_16x16x32_bf16 v[92:95],a[112:115],v[108:111],v[92:95]
v_mfma_f32_16x16x32_bf16 v[96:99],a[120:123],v[104:107],v[96:99]
v_mfma_f32_16x16x32_bf16 v[100:103],a[120:123],v[108:111],v[100:103]
s_waitcnt lgkmcnt(0)
v_mfma_f32_16x16x32_bf16 v[88:91],a[116:119],v[112:115],v[88:91]
v_mfma_f32_16x16x32_bf16 v[92:95],a[116:119],v[116:119],v[92:95]
v_mfma_f32_16x16x32_bf16 v[96:99],a[124:127],v[112:115],v[96:99]
v_mfma_f32_16x16x32_bf16 v[100:103],a[124:127],v[116:119],v[100:103]
s_nop 3
v_cvt_pk_bf16_f32 v104,v88,v96
v_cvt_pk_bf16_f32 v105,v89,v97
v_cvt_pk_bf16_f32 v106,v90,v98
v_cvt_pk_bf16_f32 v107,v91,v99
v_cvt_pk_bf16_f32 v108,v92,v100
v_cvt_pk_bf16_f32 v109,v93,v101
v_cvt_pk_bf16_f32 v110,v94,v102
v_cvt_pk_bf16_f32 v111,v95,v103
buffer_store_dwordx4 v[104:107],v0,s[8:11],s63 offen sc1
buffer_store_dwordx4 v[108:111],v0,s[8:11],s64 offen sc1
s_lshl_b32 s59,s51,13
s_lshl2_add_u32 s59,s47,s59
s_add_u32 s59,s59,10485888
s_waitcnt vmcnt(2)
s_barrier
s_or_b32 s59,s59,s52
buffer_store_dword v17,off,s[8:11],s59 sc1
s_lshl_b32 s70,s51,13
s_lshl2_add_u32 s70,s47,s70
s_add_u32 s70,s70,10486144
s_branch L_p_14
L_p_15:
s_endpgm
L_rm_5:
v_and_b32 v33,15,v1
v_lshrrev_b32 v34,4,v1
s_min_u32 s60,s47,27
s_lshl_b32 s60,s60,7
s_mul_i32 s59,s46,458752
s_add_u32 s60,s60,s59
v_mul_u32_u24 v36,114688,v34
v_and_b32 v35,7,v33
v_lshl_add_u32 v36,v35,4,v36
v_add_u32 v36,s60,v36
v_cmp_gt_u32 vcc,8,v33
v_mov_b32 v38,s36
v_mov_b32 v39,s37
v_mov_b32 v40,s34
v_mov_b32 v41,s35
v_cndmask_b32 v38,v38,v40,vcc
v_cndmask_b32 v39,v39,v41,vcc
v_add_co_u32 v38,vcc,v38,v36
s_nop 1
v_addc_co_u32 v39,vcc,0,v39,vcc
s_lshl_b32 s56,s46,15
v_add_u32 v37,s56,v0
global_load_dwordx4 v[44:47],v[38:39],off
v_add_co_u32 v38,vcc,3584,v38
s_nop 1
v_addc_co_u32 v39,vcc,0,v39,vcc
global_load_dwordx4 v[48:51],v[38:39],off
v_add_co_u32 v38,vcc,3584,v38
s_nop 1
v_addc_co_u32 v39,vcc,0,v39,vcc
global_load_dwordx4 v[52:55],v[38:39],off
v_add_co_u32 v38,vcc,3584,v38
s_nop 1
v_addc_co_u32 v39,vcc,0,v39,vcc
global_load_dwordx4 v[56:59],v[38:39],off
v_add_co_u32 v38,vcc,3584,v38
s_nop 1
v_addc_co_u32 v39,vcc,0,v39,vcc
global_load_dwordx4 v[60:63],v[38:39],off
v_add_co_u32 v38,vcc,3584,v38
s_nop 1
v_addc_co_u32 v39,vcc,0,v39,vcc
global_load_dwordx4 v[64:67],v[38:39],off
v_add_co_u32 v38,vcc,3584,v38
s_nop 1
v_addc_co_u32 v39,vcc,0,v39,vcc
global_load_dwordx4 v[68:71],v[38:39],off
v_add_co_u32 v38,vcc,3584,v38
s_nop 1
v_addc_co_u32 v39,vcc,0,v39,vcc
global_load_dwordx4 v[72:75],v[38:39],off
v_add_co_u32 v38,vcc,3584,v38
s_nop 1
v_addc_co_u32 v39,vcc,0,v39,vcc
global_load_dwordx4 v[76:79],v[38:39],off
v_add_co_u32 v38,vcc,3584,v38
s_nop 1
v_addc_co_u32 v39,vcc,0,v39,vcc
global_load_dwordx4 v[80:83],v[38:39],off
v_add_co_u32 v38,vcc,3584,v38
s_nop 1
v_addc_co_u32 v39,vcc,0,v39,vcc
global_load_dwordx4 v[84:87],v[38:39],off
v_add_co_u32 v38,vcc,3584,v38
s_nop 1
v_addc_co_u32 v39,vcc,0,v39,vcc
global_load_dwordx4 v[88:91],v[38:39],off
v_add_co_u32 v38,vcc,3584,v38
s_nop 1
v_addc_co_u32 v39,vcc,0,v39,vcc
global_load_dwordx4 v[92:95],v[38:39],off
v_add_co_u32 v38,vcc,3584,v38
s_nop 1
v_addc_co_u32 v39,vcc,0,v39,vcc
global_load_dwordx4 v[96:99],v[38:39],off
v_add_co_u32 v38,vcc,3584,v38
s_nop 1
v_addc_co_u32 v39,vcc,0,v39,vcc
global_load_dwordx4 v[100:103],v[38:39],off
v_add_co_u32 v38,vcc,3584,v38
s_nop 1
v_addc_co_u32 v39,vcc,0,v39,vcc
global_load_dwordx4 v[104:107],v[38:39],off
v_add_co_u32 v38,vcc,3584,v38
s_nop 1
v_addc_co_u32 v39,vcc,0,v39,vcc
s_waitcnt vmcnt(15)
ds_write_b128 v37,v[44:47] offset:0
s_waitcnt vmcnt(14)
ds_write_b128 v37,v[48:51] offset:1024
s_waitcnt vmcnt(13)
ds_write_b128 v37,v[52:55] offset:2048
s_waitcnt vmcnt(12)
ds_write_b128 v37,v[56:59] offset:3072
s_waitcnt vmcnt(11)
ds_write_b128 v37,v[60:63] offset:4096
s_waitcnt vmcnt(10)
ds_write_b128 v37,v[64:67] offset:5120
s_waitcnt vmcnt(9)
ds_write_b128 v37,v[68:71] offset:6144
s_waitcnt vmcnt(8)
ds_write_b128 v37,v[72:75] offset:7168
s_waitcnt lgkmcnt(0)
s_waitcnt vmcnt(7)
ds_write_b128 v37,v[76:79] offset:8192
s_waitcnt vmcnt(6)
ds_write_b128 v37,v[80:83] offset:9216
s_waitcnt vmcnt(5)
ds_write_b128 v37,v[84:87] offset:10240
s_waitcnt vmcnt(4)
ds_write_b128 v37,v[88:91] offset:11264
s_waitcnt vmcnt(3)
ds_write_b128 v37,v[92:95] offset:12288
s_waitcnt vmcnt(2)
ds_write_b128 v37,v[96:99] offset:13312
s_waitcnt vmcnt(1)
ds_write_b128 v37,v[100:103] offset:14336
s_waitcnt vmcnt(0)
ds_write_b128 v37,v[104:107] offset:15360
s_waitcnt lgkmcnt(0)
global_load_dwordx4 v[44:47],v[38:39],off
v_add_co_u32 v38,vcc,3584,v38
s_nop 1
v_addc_co_u32 v39,vcc,0,v39,vcc
global_load_dwordx4 v[48:51],v[38:39],off
v_add_co_u32 v38,vcc,3584,v38
s_nop 1
v_addc_co_u32 v39,vcc,0,v39,vcc
global_load_dwordx4 v[52:55],v[38:39],off
v_add_co_u32 v38,vcc,3584,v38
s_nop 1
v_addc_co_u32 v39,vcc,0,v39,vcc
global_load_dwordx4 v[56:59],v[38:39],off
v_add_co_u32 v38,vcc,3584,v38
s_nop 1
v_addc_co_u32 v39,vcc,0,v39,vcc
global_load_dwordx4 v[60:63],v[38:39],off
v_add_co_u32 v38,vcc,3584,v38
s_nop 1
v_addc_co_u32 v39,vcc,0,v39,vcc
global_load_dwordx4 v[64:67],v[38:39],off
v_add_co_u32 v38,vcc,3584,v38
s_nop 1
v_addc_co_u32 v39,vcc,0,v39,vcc
global_load_dwordx4 v[68:71],v[38:39],off
v_add_co_u32 v38,vcc,3584,v38
s_nop 1
v_addc_co_u32 v39,vcc,0,v39,vcc
global_load_dwordx4 v[72:75],v[38:39],off
v_add_co_u32 v38,vcc,3584,v38
s_nop 1
v_addc_co_u32 v39,vcc,0,v39,vcc
global_load_dwordx4 v[76:79],v[38:39],off
v_add_co_u32 v38,vcc,3584,v38
s_nop 1
v_addc_co_u32 v39,vcc,0,v39,vcc
global_load_dwordx4 v[80:83],v[38:39],off
v_add_co_u32 v38,vcc,3584,v38
s_nop 1
v_addc_co_u32 v39,vcc,0,v39,vcc
global_load_dwordx4 v[84:87],v[38:39],off
v_add_co_u32 v38,vcc,3584,v38
s_nop 1
v_addc_co_u32 v39,vcc,0,v39,vcc
global_load_dwordx4 v[88:91],v[38:39],off
v_add_co_u32 v38,vcc,3584,v38
s_nop 1
v_addc_co_u32 v39,vcc,0,v39,vcc
global_load_dwordx4 v[92:95],v[38:39],off
v_add_co_u32 v38,vcc,3584,v38
s_nop 1
v_addc_co_u32 v39,vcc,0,v39,vcc
global_load_dwordx4 v[96:99],v[38:39],off
v_add_co_u32 v38,vcc,3584,v38
s_nop 1
v_addc_co_u32 v39,vcc,0,v39,vcc
global_load_dwordx4 v[100:103],v[38:39],off
v_add_co_u32 v38,vcc,3584,v38
s_nop 1
v_addc_co_u32 v39,vcc,0,v39,vcc
global_load_dwordx4 v[104:107],v[38:39],off
v_add_co_u32 v38,vcc,3584,v38
s_nop 1
v_addc_co_u32 v39,vcc,0,v39,vcc
s_waitcnt vmcnt(15)
ds_write_b128 v37,v[44:47] offset:16384
s_waitcnt vmcnt(14)
ds_write_b128 v37,v[48:51] offset:17408
s_waitcnt vmcnt(13)
ds_write_b128 v37,v[52:55] offset:18432
s_waitcnt vmcnt(12)
ds_write_b128 v37,v[56:59] offset:19456
s_waitcnt vmcnt(11)
ds_write_b128 v37,v[60:63] offset:20480
s_waitcnt vmcnt(10)
ds_write_b128 v37,v[64:67] offset:21504
s_waitcnt vmcnt(9)
ds_write_b128 v37,v[68:71] offset:22528
s_waitcnt vmcnt(8)
ds_write_b128 v37,v[72:75] offset:23552
s_waitcnt lgkmcnt(0)
s_waitcnt vmcnt(7)
ds_write_b128 v37,v[76:79] offset:24576
s_waitcnt vmcnt(6)
ds_write_b128 v37,v[80:83] offset:25600
s_waitcnt vmcnt(5)
ds_write_b128 v37,v[84:87] offset:26624
s_waitcnt vmcnt(4)
ds_write_b128 v37,v[88:91] offset:27648
s_waitcnt vmcnt(3)
ds_write_b128 v37,v[92:95] offset:28672
s_waitcnt vmcnt(2)
ds_write_b128 v37,v[96:99] offset:29696
s_waitcnt vmcnt(1)
ds_write_b128 v37,v[100:103] offset:30720
s_waitcnt vmcnt(0)
ds_write_b128 v37,v[104:107] offset:31744
s_waitcnt lgkmcnt(0)
v_mov_b32 v123,159744
s_cmp_lg_u32 s46,0
s_cbranch_scc1 L_gbd_20
v_mov_b32 v124,128
L_gb_19:
buffer_load_dword v125,v124,s[12:15],0 offen sc1
s_waitcnt vmcnt(0)
v_readfirstlane_b32 s56,v125
ds_write_b32 v123,v125
s_bitcmp1_b32 s56,8
s_cbranch_scc1 L_gbd_20
s_sleep 4
s_sub_u32 s49,s49,1
s_cmp_gt_i32 s49,0
s_cbranch_scc1 L_gb_19
s_branch L_abort
L_gbd_20:
s_waitcnt lgkmcnt(0)
s_barrier
ds_read_b32 v125,v123
s_waitcnt lgkmcnt(0)
v_readfirstlane_b32 s56,v125
s_barrier
s_lshr_b32 s56,s56,16
s_andn2_b32 s56,s56,s3
s_cbranch_scc1 L_spread
s_cmp_lg_u32 s3,0
s_cbranch_scc1 L_wm
v_and_b32 v120,15,v1
v_lshrrev_b32 v121,4,v1
v_mov_b32 v17,1
s_lshl_b32 s56,s46,15
v_add_u32 v18,s56,v0
s_lshl_b32 s56,s46,2
v_add_u32 v125,s56,v121
v_xor_b32 v126,v125,v120
v_lshlrev_b32 v126,4,v126
v_lshl_add_u32 v20,v125,10,v126
v_add_u32 v125,0,v121
v_xor_b32 v125,v125,v120
v_lshlrev_b32 v125,4,v125
v_lshl_add_u32 v125,v120,8,v125
v_add_u32 v4,131072,v125
v_add_u32 v125,4,v121
v_xor_b32 v125,v125,v120
v_lshlrev_b32 v125,4,v125
v_lshl_add_u32 v125,v120,8,v125
v_add_u32 v5,131072,v125
v_add_u32 v125,8,v121
v_xor_b32 v125,v125,v120
v_lshlrev_b32 v125,4,v125
v_lshl_add_u32 v125,v120,8,v125
v_add_u32 v6,131072,v125
v_add_u32 v125,12,v121
v_xor_b32 v125,v125,v120
v_lshlrev_b32 v125,4,v125
v_lshl_add_u32 v125,v120,8,v125
v_add_u32 v7,131072,v125
v_lshlrev_b32 v21,5,v120
v_and_b32 v125,1,v121
v_lshl_add_u32 v21,v125,4,v21
s_lshl_b32 s56,s46,9
v_lshrrev_b32 v125,1,v121
v_lshl_add_u32 v21,v125,11,v21
s_add_u32 s56,s56,155648
v_add_u32 v21,s56,v21
v_lshlrev_b32 v22,4,v120
v_lshl_add_u32 v22,v121,10,v22
s_lshl_b32 s56,s46,8
v_add_u32 v22,s56,v22
s_mov_b32 s54,0
s_mov_b32 s31,0
s_mov_b32 s53,4
s_mov_b32 s72,0x80000000
s_mov_b32 s73,0
s_mov_b32 s77,-1
s_mov_b32 s86,0
s_mov_b32 s19,0
s_mov_b32 s74,2478833664
s_mov_b32 s75,613566756
v_and_b32 v23,15,v1
v_lshlrev_b32 v23,3,v23
v_lshrrev_b32 v16,4,v1
v_lshl_add_u32 v23,v16,13,v23
v_mov_b32 v19,159744
v_lshl_add_u32 v16,v16,2,v19
s_ff1_i32_b64 s30,s[74:75]
s_bitset0_b64 s[74:75],s30
s_min_u32 s30,s30,127
s_lshl_b32 s70,s30,15
s_add_u32 s70,s70,0
s_add_u32 s71,s70,16384
L_mo_23:
s_cmp_lg_u32 s19,0
s_cbranch_scc1 L_mo_24
s_add_u32 m0,s50,131072
s_nop 0
buffer_load_dwordx4 v20,s[8:11],s70 offen offset:0 sc1 lds
s_add_u32 m0,s50,135168
s_nop 0
buffer_load_dwordx4 v20,s[8:11],s71 offen offset:0 sc1 lds
s_add_u32 m0,s50,139008
s_nop 0
buffer_load_dwordx4 v20,s[8:11],s70 offen offset:256 sc1 lds
s_add_u32 m0,s50,143104
s_nop 0
buffer_load_dwordx4 v20,s[8:11],s71 offen offset:256 sc1 lds
s_add_u32 m0,s50,146944
s_nop 0
buffer_load_dwordx4 v20,s[8:11],s70 offen offset:512 sc1 lds
s_add_u32 m0,s50,151040
s_nop 0
buffer_load_dwordx4 v20,s[8:11],s71 offen offset:512 sc1 lds
s_mov_b32 s19,1
s_waitcnt vmcnt(0)
L_mo_24:
s_mov_b32 s51,s30
s_mov_b64 s[68:69],s[70:71]
s_ff1_i32_b64 s30,s[74:75]
s_bitset0_b64 s[74:75],s30
s_min_u32 s30,s30,127
s_lshl_b32 s70,s30,15
s_add_u32 s70,s70,0
s_add_u32 s71,s70,16384
s_lshl_b32 s76,s31,13
s_add_u32 s76,s76,10487040
s_lshl_b32 s58,s51,5
s_add_u32 s58,s58,s47
s_mul_i32 s58,s58,24576
s_add_u32 s58,s58,100663296
s_add_u32 s61,s58,s50
s_add_u32 s62,s61,4096
s_add_u32 s63,s61,16384
s_add_u32 s64,s61,20480
s_add_u32 s65,s61,s50
s_add_u32 s65,s65,8192
s_waitcnt vmcnt(12)
s_barrier
ds_read_b128 v[72:75],v4 offset:0
ds_read_b128 v[76:79],v4 offset:4096
ds_read_b128 v[80:83],v5 offset:0
ds_read_b128 v[84:87],v5 offset:4096
s_add_u32 m0,s50,154880
s_nop 0
buffer_load_dwordx4 v20,s[8:11],s68 offen offset:768 sc1 lds
s_add_u32 m0,s50,158976
s_nop 0
buffer_load_dwordx4 v20,s[8:11],s69 offen offset:768 sc1 lds
s_waitcnt lgkmcnt(2)
v_mfma_f32_16x16x32_bf16 v[40:43],a[128:131],v[72:75],0
ds_read_b128 v[108:111],v6 offset:0
v_mfma_f32_16x16x32_bf16 v[56:59],v[72:75],v[128:131],0
v_mfma_f32_16x16x32_bf16 v[24:27],a[0:3],v[72:75],0
ds_read_b128 v[112:115],v6 offset:4096
v_mfma_f32_16x16x32_bf16 v[44:47],a[128:131],v[76:79],0
v_mfma_f32_16x16x32_bf16 v[60:63],v[76:79],v[128:131],0
v_mfma_f32_16x16x32_bf16 v[28:31],a[0:3],v[76:79],0
v_mfma_f32_16x16x32_bf16 v[48:51],a[136:139],v[72:75],0
v_mfma_f32_16x16x32_bf16 v[64:67],v[72:75],v[136:139],0
v_mfma_f32_16x16x32_bf16 v[32:35],a[8:11],v[72:75],0
v_mfma_f32_16x16x32_bf16 v[52:55],a[136:139],v[76:79],0
v_mfma_f32_16x16x32_bf16 v[68:71],v[76:79],v[136:139],0
v_mfma_f32_16x16x32_bf16 v[36:39],a[8:11],v[76:79],0
s_waitcnt lgkmcnt(2)
v_mfma_f32_16x16x32_bf16 v[40:43],a[132:135],v[80:83],v[40:43]
ds_read_b128 v[72:75],v7 offset:0
v_mfma_f32_16x16x32_bf16 v[56:59],v[80:83],v[132:135],v[56:59]
v_mfma_f32_16x16x32_bf16 v[24:27],a[4:7],v[80:83],v[24:27]
ds_read_b128 v[76:79],v7 offset:4096
v_mfma_f32_16x16x32_bf16 v[44:47],a[132:135],v[84:87],v[44:47]
v_mfma_f32_16x16x32_bf16 v[60:63],v[84:87],v[132:135],v[60:63]
v_mfma_f32_16x16x32_bf16 v[28:31],a[4:7],v[84:87],v[28:31]
v_mfma_f32_16x16x32_bf16 v[48:51],a[140:143],v[80:83],v[48:51]
v_mfma_f32_16x16x32_bf16 v[64:67],v[80:83],v[140:143],v[64:67]
v_mfma_f32_16x16x32_bf16 v[32:35],a[12:15],v[80:83],v[32:35]
v_mfma_f32_16x16x32_bf16 v[52:55],a[140:143],v[84:87],v[52:55]
v_mfma_f32_16x16x32_bf16 v[68:71],v[84:87],v[140:143],v[68:71]
v_mfma_f32_16x16x32_bf16 v[36:39],a[12:15],v[84:87],v[36:39]
s_waitcnt vmcnt(12)
s_barrier
s_waitcnt lgkmcnt(2)
v_mfma_f32_16x16x32_bf16 v[40:43],a[144:147],v[108:111],v[40:43]
ds_read_b128 v[80:83],v4 offset:8192
v_mfma_f32_16x16x32_bf16 v[56:59],v[108:111],v[144:147],v[56:59]
v_mfma_f32_16x16x32_bf16 v[24:27],a[16:19],v[108:111],v[24:27]
ds_read_b128 v[84:87],v4 offset:12288
v_mfma_f32_16x16x32_bf16 v[44:47],a[144:147],v[112:115],v[44:47]
v_mfma_f32_16x16x32_bf16 v[60:63],v[112:115],v[144:147],v[60:63]
v_mfma_f32_16x16x32_bf16 v[28:31],a[16:19],v[112:115],v[28:31]
v_mfma_f32_16x16x32_bf16 v[48:51],a[152:155],v[108:111],v[48:51]
v_mfma_f32_16x16x32_bf16 v[64:67],v[108:111],v[152:155],v[64:67]
v_mfma_f32_16x16x32_bf16 v[32:35],a[24:27],v[108:111],v[32:35]
v_mfma_f32_16x16x32_bf16 v[52:55],a[152:155],v[112:115],v[52:55]
v_mfma_f32_16x16x32_bf16 v[68:71],v[112:115],v[152:155],v[68:71]
v_mfma_f32_16x16x32_bf16 v[36:39],a[24:27],v[112:115],v[36:39]
s_waitcnt lgkmcnt(2)
v_mfma_f32_16x16x32_bf16 v[40:43],a[148:151],v[72:75],v[40:43]
ds_read_b128 v[108:111],v5 offset:8192
v_mfma_f32_16x16x32_bf16 v[56:59],v[72:75],v[148:151],v[56:59]
v_mfma_f32_16x16x32_bf16 v[24:27],a[20:23],v[72:75],v[24:27]
ds_read_b128 v[112:115],v5 offset:12288
v_mfma_f32_16x16x32_bf16 v[44:47],a[148:151],v[76:79],v[44:47]
v_mfma_f32_16x16x32_bf16 v[60:63],v[76:79],v[148:151],v[60:63]
v_mfma_f32_16x16x32_bf16 v[28:31],a[20:23],v[76:79],v[28:31]
v_mfma_f32_16x16x32_bf16 v[48:51],a[156:159],v[72:75],v[48:51]
v_mfma_f32_16x16x32_bf16 v[64:67],v[72:75],v[156:159],v[64:67]
v_mfma_f32_16x16x32_bf16 v[32:35],a[28:31],v[72:75],v[32:35]
v_mfma_f32_16x16x32_bf16 v[52:55],a[156:159],v[76:79],v[52:55]
v_mfma_f32_16x16x32_bf16 v[68:71],v[76:79],v[156:159],v[68:71]
v_mfma_f32_16x16x32_bf16 v[36:39],a[28:31],v[76:79],v[36:39]
s_waitcnt lgkmcnt(2)
v_mfma_f32_16x16x32_bf16 v[40:43],a[160:163],v[80:83],v[40:43]
ds_read_b128 v[72:75],v6 offset:8192
v_mfma_f32_16x16x32_bf16 v[56:59],v[80:83],v[160:163],v[56:59]
v_mfma_f32_16x16x32_bf16 v[24:27],a[32:35],v[80:83],v[24:27]
ds_read_b128 v[76:79],v6 offset:12288
v_mfma_f32_16x16x32_bf16 v[44:47],a[160:163],v[84:87],v[44:47]
v_mfma_f32_16x16x32_bf16 v[60:63],v[84:87],v[160:163],v[60:63]
v_mfma_f32_16x16x32_bf16 v[28:31],a[32:35],v[84:87],v[28:31]
v_mfma_f32_16x16x32_bf16 v[48:51],a[168:171],v[80:83],v[48:51]
v_mfma_f32_16x16x32_bf16 v[64:67],v[80:83],v[168:171],v[64:67]
v_mfma_f32_16x16x32_bf16 v[32:35],a[40:43],v[80:83],v[32:35]
v_mfma_f32_16x16x32_bf16 v[52:55],a[168:171],v[84:87],v[52:55]
v_mfma_f32_16x16x32_bf16 v[68:71],v[84:87],v[168:171],v[68:71]
v_mfma_f32_16x16x32_bf16 v[36:39],a[40:43],v[84:87],v[36:39]
s_waitcnt lgkmcnt(2)
v_mfma_f32_16x16x32_bf16 v[40:43],a[164:167],v[108:111],v[40:43]
ds_read_b128 v[80:83],v7 offset:8192
v_mfma_f32_16x16x32_bf16 v[56:59],v[108:111],v[164:167],v[56:59]
v_mfma_f32_16x16x32_bf16 v[24:27],a[36:39],v[108:111],v[24:27]
ds_read_b128 v[84:87],v7 offset:12288
v_mfma_f32_16x16x32_bf16 v[44:47],a[164:167],v[112:115],v[44:47]
v_mfma_f32_16x16x32_bf16 v[60:63],v[112:115],v[164:167],v[60:63]
v_mfma_f32_16x16x32_bf16 v[28:31],a[36:39],v[112:115],v[28:31]
v_mfma_f32_16x16x32_bf16 v[48:51],a[172:175],v[108:111],v[48:51]
v_mfma_f32_16x16x32_bf16 v[64:67],v[108:111],v[172:175],v[64:67]
v_mfma_f32_16x16x32_bf16 v[32:35],a[44:47],v[108:111],v[32:35]
v_mfma_f32_16x16x32_bf16 v[52:55],a[172:175],v[112:115],v[52:55]
v_mfma_f32_16x16x32_bf16 v[68:71],v[112:115],v[172:175],v[68:71]
v_mfma_f32_16x16x32_bf16 v[36:39],a[44:47],v[112:115],v[36:39]
s_waitcnt vmcnt(10)
s_barrier
s_waitcnt lgkmcnt(2)
v_mfma_f32_16x16x32_bf16 v[40:43],a[176:179],v[72:75],v[40:43]
ds_read_b128 v[108:111],v4 offset:16384
v_mfma_f32_16x16x32_bf16 v[56:59],v[72:75],v[176:179],v[56:59]
v_mfma_f32_16x16x32_bf16 v[24:27],a[48:51],v[72:75],v[24:27]
ds_read_b128 v[112:115],v4 offset:20480
v_mfma_f32_16x16x32_bf16 v[44:47],a[176:179],v[76:79],v[44:47]
v_mfma_f32_16x16x32_bf16 v[60:63],v[76:79],v[176:179],v[60:63]
v_mfma_f32_16x16x32_bf16 v[28:31],a[48:51],v[76:79],v[28:31]
v_mfma_f32_16x16x32_bf16 v[48:51],a[184:187],v[72:75],v[48:51]
v_mfma_f32_16x16x32_bf16 v[64:67],v[72:75],v[184:187],v[64:67]
v_mfma_f32_16x16x32_bf16 v[32:35],a[56:59],v[72:75],v[32:35]
v_mfma_f32_16x16x32_bf16 v[52:55],a[184:187],v[76:79],v[52:55]
v_mfma_f32_16x16x32_bf16 v[68:71],v[76:79],v[184:187],v[68:71]
v_mfma_f32_16x16x32_bf16 v[36:39],a[56:59],v[76:79],v[36:39]
s_waitcnt vmcnt(2)
s_barrier
s_or_b32 s72,s72,s52
buffer_store_dword v17,off,s[8:11],s72 sc1
s_waitcnt lgkmcnt(2)
v_mfma_f32_16x16x32_bf16 v[40:43],a[180:183],v[80:83],v[40:43]
ds_read_b128 v[72:75],v5 offset:16384
v_mfma_f32_16x16x32_bf16 v[56:59],v[80:83],v[180:183],v[56:59]
v_mfma_f32_16x16x32_bf16 v[24:27],a[52:55],v[80:83],v[24:27]
ds_read_b128 v[76:79],v5 offset:20480
v_mfma_f32_16x16x32_bf16 v[44:47],a[180:183],v[84:87],v[44:47]
v_mfma_f32_16x16x32_bf16 v[60:63],v[84:87],v[180:183],v[60:63]
v_mfma_f32_16x16x32_bf16 v[28:31],a[52:55],v[84:87],v[28:31]
v_mfma_f32_16x16x32_bf16 v[48:51],a[188:191],v[80:83],v[48:51]
v_mfma_f32_16x16x32_bf16 v[64:67],v[80:83],v[188:191],v[64:67]
v_mfma_f32_16x16x32_bf16 v[32:35],a[60:63],v[80:83],v[32:35]
v_mfma_f32_16x16x32_bf16 v[52:55],a[188:191],v[84:87],v[52:55]
v_mfma_f32_16x16x32_bf16 v[68:71],v[84:87],v[188:191],v[68:71]
v_mfma_f32_16x16x32_bf16 v[36:39],a[60:63],v[84:87],v[36:39]
s_waitcnt lgkmcnt(2)
v_mfma_f32_16x16x32_bf16 v[40:43],a[192:195],v[108:111],v[40:43]
ds_read_b128 v[80:83],v6 offset:16384
v_mfma_f32_16x16x32_bf16 v[56:59],v[108:111],v[192:195],v[56:59]
v_mfma_f32_16x16x32_bf16 v[24:27],a[64:67],v[108:111],v[24:27]
ds_read_b128 v[84:87],v6 offset:20480
v_mfma_f32_16x16x32_bf16 v[44:47],a[192:195],v[112:115],v[44:47]
v_mfma_f32_16x16x32_bf16 v[60:63],v[112:115],v[192:195],v[60:63]
v_mfma_f32_16x16x32_bf16 v[28:31],a[64:67],v[112:115],v[28:31]
v_mfma_f32_16x16x32_bf16 v[48:51],a[200:203],v[108:111],v[48:51]
v_mfma_f32_16x16x32_bf16 v[64:67],v[108:111],v[200:203],v[64:67]
v_mfma_f32_16x16x32_bf16 v[32:35],a[72:75],v[108:111],v[32:35]
v_mfma_f32_16x16x32_bf16 v[52:55],a[200:203],v[112:115],v[52:55]
v_mfma_f32_16x16x32_bf16 v[68:71],v[112:115],v[200:203],v[68:71]
v_mfma_f32_16x16x32_bf16 v[36:39],a[72:75],v[112:115],v[36:39]
s_waitcnt lgkmcnt(2)
v_mfma_f32_16x16x32_bf16 v[40:43],a[196:199],v[72:75],v[40:43]
ds_read_b128 v[108:111],v7 offset:16384
v_mfma_f32_16x16x32_bf16 v[56:59],v[72:75],v[196:199],v[56:59]
v_mfma_f32_16x16x32_bf16 v[24:27],a[68:71],v[72:75],v[24:27]
ds_read_b128 v[112:115],v7 offset:20480
v_mfma_f32_16x16x32_bf16 v[44:47],a[196:199],v[76:79],v[44:47]
v_mfma_f32_16x16x32_bf16 v[60:63],v[76:79],v[196:199],v[60:63]
v_mfma_f32_16x16x32_bf16 v[28:31],a[68:71],v[76:79],v[28:31]
v_mfma_f32_16x16x32_bf16 v[48:51],a[204:207],v[72:75],v[48:51]
v_mfma_f32_16x16x32_bf16 v[64:67],v[72:75],v[204:207],v[64:67]
v_mfma_f32_16x16x32_bf16 v[32:35],a[76:79],v[72:75],v[32:35]
v_mfma_f32_16x16x32_bf16 v[52:55],a[204:207],v[76:79],v[52:55]
v_mfma_f32_16x16x32_bf16 v[68:71],v[76:79],v[204:207],v[68:71]
v_mfma_f32_16x16x32_bf16 v[36:39],a[76:79],v[76:79],v[36:39]
s_waitcnt vmcnt(1)
s_barrier
s_waitcnt lgkmcnt(2)
v_mfma_f32_16x16x32_bf16 v[40:43],a[208:211],v[80:83],v[40:43]
ds_read_b128 v[72:75],v4 offset:24576
v_mfma_f32_16x16x32_bf16 v[56:59],v[80:83],v[208:211],v[56:59]
v_mfma_f32_16x16x32_bf16 v[24:27],a[80:83],v[80:83],v[24:27]
ds_read_b128 v[76:79],v4 offset:28672
v_mfma_f32_16x16x32_bf16 v[44:47],a[208:211],v[84:87],v[44:47]
v_mfma_f32_16x16x32_bf16 v[60:63],v[84:87],v[208:211],v[60:63]
v_mfma_f32_16x16x32_bf16 v[28:31],a[80:83],v[84:87],v[28:31]
v_mfma_f32_16x16x32_bf16 v[48:51],a[216:219],v[80:83],v[48:51]
v_mfma_f32_16x16x32_bf16 v[64:67],v[80:83],v[216:219],v[64:67]
v_mfma_f32_16x16x32_bf16 v[32:35],a[88:91],v[80:83],v[32:35]
v_mfma_f32_16x16x32_bf16 v[52:55],a[216:219],v[84:87],v[52:55]
v_mfma_f32_16x16x32_bf16 v[68:71],v[84:87],v[216:219],v[68:71]
v_mfma_f32_16x16x32_bf16 v[36:39],a[88:91],v[84:87],v[36:39]
s_waitcnt lgkmcnt(2)
v_mfma_f32_16x16x32_bf16 v[40:43],a[212:215],v[108:111],v[40:43]
ds_read_b128 v[80:83],v5 offset:24576
v_mfma_f32_16x16x32_bf16 v[56:59],v[108:111],v[212:215],v[56:59]
v_mfma_f32_16x16x32_bf16 v[24:27],a[84:87],v[108:111],v[24:27]
ds_read_b128 v[84:87],v5 offset:28672
v_mfma_f32_16x16x32_bf16 v[44:47],a[212:215],v[112:115],v[44:47]
v_mfma_f32_16x16x32_bf16 v[60:63],v[112:115],v[212:215],v[60:63]
v_mfma_f32_16x16x32_bf16 v[28:31],a[84:87],v[112:115],v[28:31]
v_mfma_f32_16x16x32_bf16 v[48:51],a[220:223],v[108:111],v[48:51]
v_mfma_f32_16x16x32_bf16 v[64:67],v[108:111],v[220:223],v[64:67]
v_mfma_f32_16x16x32_bf16 v[32:35],a[92:95],v[108:111],v[32:35]
v_mfma_f32_16x16x32_bf16 v[52:55],a[220:223],v[112:115],v[52:55]
v_mfma_f32_16x16x32_bf16 v[68:71],v[112:115],v[220:223],v[68:71]
v_mfma_f32_16x16x32_bf16 v[36:39],a[92:95],v[112:115],v[36:39]
s_barrier
s_waitcnt lgkmcnt(2)
v_mfma_f32_16x16x32_bf16 v[40:43],a[224:227],v[72:75],v[40:43]
ds_read_b128 v[108:111],v6 offset:24576
v_mfma_f32_16x16x32_bf16 v[56:59],v[72:75],v[224:227],v[56:59]
s_add_u32 m0,s50,131072
v_mfma_f32_16x16x32_bf16 v[24:27],a[96:99],v[72:75],v[24:27]
ds_read_b128 v[112:115],v6 offset:28672
v_mfma_f32_16x16x32_bf16 v[44:47],a[224:227],v[76:79],v[44:47]
buffer_load_dwordx4 v20,s[8:11],s70 offen offset:0 sc1 lds
v_mfma_f32_16x16x32_bf16 v[60:63],v[76:79],v[224:227],v[60:63]
s_add_u32 m0,s50,135168
v_mfma_f32_16x16x32_bf16 v[28:31],a[96:99],v[76:79],v[28:31]
buffer_load_dwordx4 v20,s[8:11],s71 offen offset:0 sc1 lds
v_mfma_f32_16x16x32_bf16 v[48:51],a[232:235],v[72:75],v[48:51]
s_add_u32 m0,s50,139008
v_mfma_f32_16x16x32_bf16 v[64:67],v[72:75],v[232:235],v[64:67]
buffer_load_dwordx4 v20,s[8:11],s70 offen offset:256 sc1 lds
v_mfma_f32_16x16x32_bf16 v[32:35],a[104:107],v[72:75],v[32:35]
s_add_u32 m0,s50,143104
v_mfma_f32_16x16x32_bf16 v[52:55],a[232:235],v[76:79],v[52:55]
buffer_load_dwordx4 v20,s[8:11],s71 offen offset:256 sc1 lds
v_mfma_f32_16x16x32_bf16 v[68:71],v[76:79],v[232:235],v[68:71]
s_add_u32 m0,s50,146944
v_mfma_f32_16x16x32_bf16 v[36:39],a[104:107],v[76:79],v[36:39]
buffer_load_dwordx4 v20,s[8:11],s70 offen offset:512 sc1 lds
s_waitcnt lgkmcnt(2)
v_mfma_f32_16x16x32_bf16 v[40:43],a[228:231],v[80:83],v[40:43]
ds_read_b128 v[72:75],v7 offset:24576
v_mfma_f32_16x16x32_bf16 v[56:59],v[80:83],v[228:231],v[56:59]
s_add_u32 m0,s50,151040
v_mfma_f32_16x16x32_bf16 v[24:27],a[100:103],v[80:83],v[24:27]
ds_read_b128 v[76:79],v7 offset:28672
v_mfma_f32_16x16x32_bf16 v[44:47],a[228:231],v[84:87],v[44:47]
buffer_load_dwordx4 v20,s[8:11],s71 offen offset:512 sc1 lds
v_mfma_f32_16x16x32_bf16 v[60:63],v[84:87],v[228:231],v[60:63]
buffer_load_dwordx2 v[124:125],v23,s[8:11],s76 offen sc1
v_mfma_f32_16x16x32_bf16 v[28:31],a[100:103],v[84:87],v[28:31]
v_mfma_f32_16x16x32_bf16 v[48:51],a[236:239],v[80:83],v[48:51]
v_mfma_f32_16x16x32_bf16 v[64:67],v[80:83],v[236:239],v[64:67]
v_mfma_f32_16x16x32_bf16 v[32:35],a[108:111],v[80:83],v[32:35]
v_mfma_f32_16x16x32_bf16 v[52:55],a[236:239],v[84:87],v[52:55]
v_mfma_f32_16x16x32_bf16 v[68:71],v[84:87],v[236:239],v[68:71]
v_mfma_f32_16x16x32_bf16 v[36:39],a[108:111],v[84:87],v[36:39]
s_waitcnt lgkmcnt(2)
v_mfma_f32_16x16x32_bf16 v[40:43],a[240:243],v[108:111],v[40:43]
v_mfma_f32_16x16x32_bf16 v[56:59],v[108:111],v[240:243],v[56:59]
v_mfma_f32_16x16x32_bf16 v[24:27],a[112:115],v[108:111],v[24:27]
v_mfma_f32_16x16x32_bf16 v[44:47],a[240:243],v[112:115],v[44:47]
v_mfma_f32_16x16x32_bf16 v[60:63],v[112:115],v[240:243],v[60:63]
v_mfma_f32_16x16x32_bf16 v[28:31],a[112:115],v[112:115],v[28:31]
v_mfma_f32_16x16x32_bf16 v[48:51],a[248:251],v[108:111],v[48:51]
v_mfma_f32_16x16x32_bf16 v[64:67],v[108:111],v[248:251],v[64:67]
v_mfma_f32_16x16x32_bf16 v[32:35],a[120:123],v[108:111],v[32:35]
v_mfma_f32_16x16x32_bf16 v[52:55],a[248:251],v[112:115],v[52:55]
v_mfma_f32_16x16x32_bf16 v[68:71],v[112:115],v[248:251],v[68:71]
v_mfma_f32_16x16x32_bf16 v[36:39],a[120:123],v[112:115],v[36:39]
s_waitcnt lgkmcnt(0)
v_mfma_f32_16x16x32_bf16 v[40:43],a[244:247],v[72:75],v[40:43]
v_mfma_f32_16x16x32_bf16 v[56:59],v[72:75],v[244:247],v[56:59]
v_mfma_f32_16x16x32_bf16 v[24:27],a[116:119],v[72:75],v[24:27]
v_mfma_f32_16x16x32_bf16 v[44:47],a[244:247],v[76:79],v[44:47]
v_mfma_f32_16x16x32_bf16 v[60:63],v[76:79],v[244:247],v[60:63]
v_mfma_f32_16x16x32_bf16 v[28:31],a[116:119],v[76:79],v[28:31]
v_mfma_f32_16x16x32_bf16 v[48:51],a[252:255],v[72:75],v[48:51]
v_mfma_f32_16x16x32_bf16 v[64:67],v[72:75],v[252:255],v[64:67]
v_mfma_f32_16x16x32_bf16 v[32:35],a[124:127],v[72:75],v[32:35]
v_mfma_f32_16x16x32_bf16 v[52:55],a[252:255],v[76:79],v[52:55]
v_mfma_f32_16x16x32_bf16 v[68:71],v[76:79],v[252:255],v[68:71]
v_mfma_f32_16x16x32_bf16 v[36:39],a[124:127],v[76:79],v[36:39]
s_lshl_b32 s56,s51,5
s_add_u32 s56,s56,s47
s_lshl_b32 s56,s56,12
s_add_u32 s56,s56,s50
s_add_u32 s56,s56,41943040
v_mov_b64 v[120:121],-1
v_mov_b64 v[122:123],-1
buffer_store_dwordx4 v[120:123],v0,s[8:11],s56 offen sc1
v_cvt_pk_bf16_f32 v72,v40,v48
v_cvt_pk_bf16_f32 v73,v41,v49
v_cvt_pk_bf16_f32 v74,v42,v50
v_cvt_pk_bf16_f32 v75,v43,v51
buffer_store_dwordx4 v[72:75],v0,s[8:11],s61 offen sc1
v_cvt_pk_bf16_f32 v76,v44,v52
v_cvt_pk_bf16_f32 v77,v45,v53
v_cvt_pk_bf16_f32 v78,v46,v54
v_cvt_pk_bf16_f32 v79,v47,v55
buffer_store_dwordx4 v[76:79],v0,s[8:11],s62 offen sc1
v_cvt_pk_bf16_f32 v80,v56,v57
v_cvt_pk_bf16_f32 v81,v58,v59
v_cvt_pk_bf16_f32 v82,v60,v61
v_cvt_pk_bf16_f32 v83,v62,v63
buffer_store_dwordx4 v[80:83],v0,s[8:11],s65 offen offset:0 sc1
v_cvt_pk_bf16_f32 v84,v64,v65
v_cvt_pk_bf16_f32 v85,v66,v67
v_cvt_pk_bf16_f32 v86,v68,v69
v_cvt_pk_bf16_f32 v87,v70,v71
buffer_store_dwordx4 v[84:87],v0,s[8:11],s65 offen offset:1024 sc1
v_cvt_pk_bf16_f32 v108,v24,v32
v_cvt_pk_bf16_f32 v109,v25,v33
v_cvt_pk_bf16_f32 v110,v26,v34
v_cvt_pk_bf16_f32 v111,v27,v35
buffer_store_dwordx4 v[108:111],v0,s[8:11],s63 offen sc1
v_cvt_pk_bf16_f32 v112,v28,v36
v_cvt_pk_bf16_f32 v113,v29,v37
v_cvt_pk_bf16_f32 v114,v30,v38
v_cvt_pk_bf16_f32 v115,v31,v39
buffer_store_dwordx4 v[112:115],v0,s[8:11],s64 offen sc1
s_lshl_b32 s72,s51,13
s_lshl2_add_u32 s72,s47,s72
s_add_u32 s72,s72,10485760
s_sub_u32 s53,s53,1
s_cmp_gt_i32 s53,0
s_cbranch_scc1 L_mo_24
s_mov_b32 s87,3
s_mov_b32 s18,0
s_waitcnt vmcnt(7)
s_branch L_mo_29
L_mo_22:
s_mov_b32 s55,s22
s_mov_b32 s22,s23
s_mov_b32 s23,s24
s_mov_b32 s24,-1
s_cmp_lg_u32 s55,-1
s_cbranch_scc1 L_mp_21
s_sub_u32 s56,s30,s31
s_cmp_gt_i32 s77,0
s_cselect_b32 s57,6,12
s_cmp_lt_i32 s56,s57
s_cbranch_scc1 L_mo_23
s_cmp_lt_i32 s56,26
s_cselect_b32 s87,s18,0
s_cmp_ge_u32 s31,56
s_cselect_b32 s56,1,s18
s_and_b32 s56,s56,s86
s_cselect_b32 s87,2,s87
s_mul_i32 s56,s87,s18
s_cmp_lg_u32 s56,0
s_cbranch_scc1 L_mo_27
s_mov_b32 s18,0
s_lshr_b32 s56,s72,31
s_or_b32 s56,s56,s87
s_cbranch_scc1 L_mo_33
s_waitcnt vmcnt(0)
s_barrier
s_or_b32 s72,s72,s52
buffer_store_dword v17,off,s[8:11],s72 sc1
s_mov_b32 s72,0x80000000
L_mo_33:
s_cmp_lg_u32 s46,0
s_cbranch_scc1 L_mo_31
s_lshl_b32 s76,s31,13
s_add_u32 s76,s76,10487040
L_mo_30:
buffer_load_dwordx2 v[124:125],v23,s[8:11],s76 offen sc1
s_sub_u32 s49,s49,1
s_cbranch_scc1 L_abort
s_waitcnt vmcnt(0)
L_mo_29:
v_min_u32 v123,v124,v125
v_max_u32 v125,v124,v125
v_cmp_eq_u32 vcc,0,v123
s_nop 1
v_cndmask_b32 v125,v125,-1,vcc
s_and_b32 s56,vcc_lo,0xffff
s_cbranch_scc0 L_mo_34
s_cmp_lg_u32 s87,0
s_cbranch_scc1 L_mo_34
s_mov_b32 s18,1
s_sleep 2
s_branch L_mo_30
L_mo_34:
v_max_u32_dpp v125,v125,v125 row_ror:8 row_mask:0xf bank_mask:0xf
s_nop 1
v_max_u32_dpp v125,v125,v125 row_ror:4 row_mask:0xf bank_mask:0xf
s_nop 1
v_max_u32_dpp v125,v125,v125 row_ror:2 row_mask:0xf bank_mask:0xf
s_nop 1
v_max_u32_dpp v125,v125,v125 row_ror:1 row_mask:0xf bank_mask:0xf
L_mo_31:
s_sub_u32 s49,s49,1
s_cbranch_scc1 L_abort
v_mov_b32 v124,s18
s_barrier
s_cmp_lg_u32 s46,0
s_cbranch_scc1 L_mo_32
ds_write_b32 v16,v125
ds_write_b32 v19,v124 offset:16
s_waitcnt lgkmcnt(0)
L_mo_32:
s_barrier
ds_read_b128 v[120:123],v19
ds_read_b32 v124,v19 offset:16
s_waitcnt lgkmcnt(0)
v_readfirstlane_b32 s55,v120
v_readfirstlane_b32 s22,v121
v_readfirstlane_b32 s23,v122
v_readfirstlane_b32 s24,v123
v_readfirstlane_b32 s18,v124
s_cmp_lg_u32 s55,-1
s_cbranch_scc1 L_mp_21
L_mo_27:
s_mov_b32 s22,-1
s_cmp_eq_u32 s87,1
s_cbranch_scc1 L_mo_23
s_cmp_eq_u32 s87,2
s_cbranch_scc1 L_mo_28
s_branch L_mo_22
L_mp_21:
s_sub_u32 s73,s73,1
s_max_i32 s73,s73,0
s_sub_u32 s77,s77,1
s_min_u32 s61,s73,2
s_cmp_gt_u32 s55,s54
s_cselect_b32 s77,s61,s77
s_cselect_b32 s54,s55,s54
s_cselect_b32 s86,0,s86
s_cmp_lg_u32 s31,63
s_cbranch_scc1 L_mo_25
s_min_i32 s77,s77,0
s_or_b32 s61,s47,s46
s_cbranch_scc1 L_mo_25
s_mov_b32 s59,11018240
v_lshlrev_b32 v120,2,v1
L_fp_36:
s_sleep 0
buffer_load_dword v121,v120,s[8:11],s59 offen sc1
s_sub_u32 s49,s49,1
s_cbranch_scc1 L_abort
s_waitcnt vmcnt(0)
v_cmp_eq_u32 vcc,0,v121
s_cbranch_vccnz L_fp_36
s_andn2_b32 s62,0x7ff,s54
v_lshl_or_b32 v121,s62,8,v121
s_add_u32 s59,s59,8192
buffer_store_dword v121,v120,s[8:11],s59 offen sc1
s_add_u32 s59,s59,8192
buffer_store_dword v121,v120,s[8:11],s59 offen sc1
s_add_u32 s59,s59,8192
buffer_store_dword v121,v120,s[8:11],s59 offen sc1
s_add_u32 s59,s59,8192
buffer_store_dword v121,v120,s[8:11],s59 offen sc1
s_add_u32 s59,s59,8192
buffer_store_dword v121,v120,s[8:11],s59 offen sc1
s_add_u32 s59,s59,8192
buffer_store_dword v121,v120,s[8:11],s59 offen sc1
L_mo_25:
s_add_u32 s31,s31,1
s_cmp_gt_i32 s77,0
s_cmov_b32 s18,0
s_cbranch_scc1 L_mo_22
s_cmp_lg_u32 s77,0
s_cbranch_scc1 L_mo_26
s_andn2_b32 s51,0x7ff,s54
s_lshr_b32 s51,s51,5
s_add_u32 s73,s73,2
s_mov_b32 s86,1
s_mov_b32 s19,0
s_mov_b32 s18,0
s_waitcnt vmcnt(8)
s_barrier
s_and_b32 s64,s54,0x7ff
s_sub_u32 s64,2047,s64
s_lshl_b32 s56,s64,10
s_add_u32 s58,s56,4194304
buffer_load_dwordx4 v[88:91],v0,s[8:11],s58 offen sc1
s_mov_b32 s4,s38
s_mov_b32 s5,s39
s_mov_b32 s6,1835008
s_mov_b32 s7,0x20000
v_and_b32 v9,15,v1
v_lshrrev_b32 v10,4,v1
v_lshlrev_b32 v8,14,v10
v_lshl_add_u32 v8,v9,4,v8
s_lshl_b32 s59,s47,16
s_lshl_b32 s60,s46,8
s_add_u32 s59,s59,s60
buffer_load_dwordx4 v[24:27],v8,s[4:7],s59 offen offset:0
buffer_load_dwordx4 v[28:31],v8,s[4:7],s59 offen offset:1024
buffer_load_dwordx4 v[32:35],v8,s[4:7],s59 offen offset:2048
buffer_load_dwordx4 v[36:39],v8,s[4:7],s59 offen offset:3072
s_add_u32 s59,s59,4096
buffer_load_dwordx4 v[40:43],v8,s[4:7],s59 offen offset:0
buffer_load_dwordx4 v[44:47],v8,s[4:7],s59 offen offset:1024
buffer_load_dwordx4 v[48:51],v8,s[4:7],s59 offen offset:2048
buffer_load_dwordx4 v[52:55],v8,s[4:7],s59 offen offset:3072
s_add_u32 s59,s59,4096
buffer_load_dwordx4 v[56:59],v8,s[4:7],s59 offen offset:0
buffer_load_dwordx4 v[60:63],v8,s[4:7],s59 offen offset:1024
buffer_load_dwordx4 v[64:67],v8,s[4:7],s59 offen offset:2048
buffer_load_dwordx4 v[68:71],v8,s[4:7],s59 offen offset:3072
s_add_u32 s59,s59,4096
buffer_load_dwordx4 v[72:75],v8,s[4:7],s59 offen offset:0
buffer_load_dwordx4 v[76:79],v8,s[4:7],s59 offen offset:1024
buffer_load_dwordx4 v[80:83],v8,s[4:7],s59 offen offset:2048
buffer_load_dwordx4 v[84:87],v8,s[4:7],s59 offen offset:3072
v_and_b32 v124,1,v1
v_lshlrev_b32 v124,4,v124
v_mov_b32 v125,0xffff
v_lshlrev_b32 v125,v124,v125
v_lshrrev_b32 v124,1,v9
v_cmp_eq_u32 vcc,0,v124
s_nop 1
v_cndmask_b32 v12,0,v125,vcc
v_cmp_eq_u32 vcc,1,v124
s_nop 1
v_cndmask_b32 v13,0,v125,vcc
v_cmp_eq_u32 vcc,2,v124
s_nop 1
v_cndmask_b32 v14,0,v125,vcc
v_cmp_eq_u32 vcc,3,v124
s_nop 1
v_cndmask_b32 v15,0,v125,vcc
s_waitcnt vmcnt(16)
L_mx_37:
v_max3_u32 v124,v88,v89,v90
v_max_u32 v124,v91,v124
v_cmp_eq_u32 vcc,-1,v124
s_cbranch_vccz L_mxd_38
buffer_load_dwordx4 v[88:91],v0,s[8:11],s58 offen sc1
s_sub_u32 s49,s49,1
s_cbranch_scc1 L_abort
s_waitcnt vmcnt(0)
s_branch L_mx_37
L_mxd_38:
v_lshlrev_b32 v96,16,v88
v_and_b32 v97,0xffff0000,v88
v_lshlrev_b32 v98,16,v89
v_and_b32 v99,0xffff0000,v89
v_lshlrev_b32 v100,16,v90
v_and_b32 v101,0xffff0000,v90
v_lshlrev_b32 v102,16,v91
v_and_b32 v103,0xffff0000,v91
v_readfirstlane_b32 s78,v96
s_nop 1
v_pk_add_f32 v[108:109],v[96:97],s[78:79] op_sel_hi:[1,0] neg_lo:[0,1] neg_hi:[0,1]
v_pk_add_f32 v[110:111],v[98:99],s[78:79] op_sel_hi:[1,0] neg_lo:[0,1] neg_hi:[0,1]
v_pk_add_f32 v[112:113],v[100:101],s[78:79] op_sel_hi:[1,0] neg_lo:[0,1] neg_hi:[0,1]
v_pk_add_f32 v[114:115],v[102:103],s[78:79] op_sel_hi:[1,0] neg_lo:[0,1] neg_hi:[0,1]
v_pk_add_f32 v[116:117],v[108:109],v[110:111]
v_pk_mul_f32 v[118:119],v[108:109],v[108:109]
v_pk_add_f32 v[120:121],v[112:113],v[114:115]
v_pk_fma_f32 v[118:119],v[110:111],v[110:111],v[118:119]
v_pk_add_f32 v[116:117],v[116:117],v[120:121]
v_pk_fma_f32 v[118:119],v[112:113],v[112:113],v[118:119]
v_add_f32 v116,v116,v117
v_pk_fma_f32 v[118:119],v[114:115],v[114:115],v[118:119]
v_add_f32 v118,v118,v119
s_nop 1
v_permlane32_swap_b32 v116,v118
v_add_f32 v116,v116,v118
s_nop 1
v_add_f32_dpp v116,v116,v116 row_ror:8 row_mask:0xf bank_mask:0xf
s_nop 1
v_add_f32_dpp v116,v116,v116 row_ror:4 row_mask:0xf bank_mask:0xf
s_nop 1
v_add_f32_dpp v116,v116,v116 row_ror:2 row_mask:0xf bank_mask:0xf
s_nop 1
v_add_f32_dpp v116,v116,v116 row_ror:1 row_mask:0xf bank_mask:0xf
v_mov_b32 v118,v116
s_nop 1
v_permlane16_swap_b32 v116,v118
v_add_f32 v116,v116,v118
v_mul_f32 v116,0x3b000000,v116
v_mov_b32 v118,v116
s_nop 1
v_permlane32_swap_b32 v116,v118
v_fma_f32 v118,-v116,v116,v118
v_add_f32 v116,s78,v116
v_max_f32 v118,0,v118
v_cvt_pk_bf16_f32 v118,v116,v118
v_lshlrev_b32 v116,16,v118
v_and_b32 v118,0xffff0000,v118
v_add_f32 v118,0x3727c5ac,v118
v_cvt_pk_bf16_f32 v118,v118,v118
v_and_b32 v118,0xffff0000,v118
v_sqrt_f32 v118,v118
v_pk_add_f32 v[108:109],v[96:97],v[116:117] op_sel_hi:[1,0] neg_lo:[0,1] neg_hi:[0,1]
v_pk_add_f32 v[110:111],v[98:99],v[116:117] op_sel_hi:[1,0] neg_lo:[0,1] neg_hi:[0,1]
v_pk_add_f32 v[112:113],v[100:101],v[116:117] op_sel_hi:[1,0] neg_lo:[0,1] neg_hi:[0,1]
v_pk_add_f32 v[114:115],v[102:103],v[116:117] op_sel_hi:[1,0] neg_lo:[0,1] neg_hi:[0,1]
v_cvt_pk_bf16_f32 v118,v118,v118
v_and_b32 v118,0xffff0000,v118
v_rcp_f32 v118,v118
v_cvt_pk_bf16_f32 v104,v108,v109
v_cvt_pk_bf16_f32 v105,v110,v111
v_cvt_pk_bf16_f32 v106,v112,v113
v_cvt_pk_bf16_f32 v107,v114,v115
v_lshlrev_b32 v108,16,v104
v_and_b32 v109,0xffff0000,v104
v_lshlrev_b32 v110,16,v105
v_and_b32 v111,0xffff0000,v105
v_lshlrev_b32 v112,16,v106
v_and_b32 v113,0xffff0000,v106
v_lshlrev_b32 v114,16,v107
v_and_b32 v115,0xffff0000,v107
v_pk_mul_f32 v[108:109],v[108:109],v[118:119] op_sel_hi:[1,0]
v_pk_mul_f32 v[110:111],v[110:111],v[118:119] op_sel_hi:[1,0]
v_pk_mul_f32 v[112:113],v[112:113],v[118:119] op_sel_hi:[1,0]
v_pk_mul_f32 v[114:115],v[114:115],v[118:119] op_sel_hi:[1,0]
v_cvt_pk_bf16_f32 v104,v108,v109
v_cvt_pk_bf16_f32 v105,v110,v111
v_cvt_pk_bf16_f32 v106,v112,v113
v_cvt_pk_bf16_f32 v107,v114,v115
s_mov_b32 s58,0x01000100
s_mov_b32 s59,0x03020302
v_perm_b32 v88,v104,v104,s58
v_perm_b32 v89,v104,v104,s59
v_perm_b32 v90,v105,v105,s58
v_perm_b32 v91,v105,v105,s59
v_perm_b32 v92,v106,v106,s58
v_perm_b32 v93,v106,v106,s59
v_perm_b32 v94,v107,v107,s58
v_perm_b32 v95,v107,v107,s59
v_lshlrev_b32 v8,5,v1
s_lshl_b32 s58,s46,11
s_add_u32 s58,s58,139264
v_add_u32 v8,s58,v8
ds_write_b128 v8,v[88:91]
ds_write_b128 v8,v[92:95] offset:16
s_lshl_b32 s59,s46,9
s_add_u32 s59,s58,s59
v_lshlrev_b32 v8,7,v10
v_add_u32 v8,s59,v8
s_waitcnt lgkmcnt(0)
ds_read_b128 v[108:111],v18 offset:0
ds_read_b128 v[88:91],v8 offset:0
ds_read_b128 v[92:95],v8 offset:16
ds_read_b128 v[112:115],v18 offset:1024
s_waitcnt lgkmcnt(1)
v_and_b32 v124,v12,v88
v_and_b32 v125,v13,v88
v_and_b32 v126,v14,v88
v_and_b32 v127,v15,v88
s_nop 1
v_mfma_f32_16x16x32_bf16 v[116:119],v[124:127],v[108:111],0
ds_read_b128 v[108:111],v18 offset:2048
s_waitcnt lgkmcnt(1)
v_and_b32 v124,v12,v89
v_and_b32 v125,v13,v89
v_and_b32 v126,v14,v89
v_and_b32 v127,v15,v89
s_nop 1
v_mfma_f32_16x16x32_bf16 v[116:119],v[124:127],v[112:115],v[116:119]
ds_read_b128 v[112:115],v18 offset:3072
s_waitcnt lgkmcnt(1)
v_and_b32 v124,v12,v90
v_and_b32 v125,v13,v90
v_and_b32 v126,v14,v90
v_and_b32 v127,v15,v90
s_nop 1
v_mfma_f32_16x16x32_bf16 v[116:119],v[124:127],v[108:111],v[116:119]
ds_read_b128 v[108:111],v18 offset:4096
s_waitcnt lgkmcnt(1)
v_and_b32 v124,v12,v91
v_and_b32 v125,v13,v91
v_and_b32 v126,v14,v91
v_and_b32 v127,v15,v91
s_nop 1
v_mfma_f32_16x16x32_bf16 v[116:119],v[124:127],v[112:115],v[116:119]
ds_read_b128 v[112:115],v18 offset:5120
s_waitcnt lgkmcnt(1)
v_and_b32 v124,v12,v92
v_and_b32 v125,v13,v92
v_and_b32 v126,v14,v92
v_and_b32 v127,v15,v92
s_nop 1
v_mfma_f32_16x16x32_bf16 v[116:119],v[124:127],v[108:111],v[116:119]
ds_read_b128 v[108:111],v18 offset:6144
s_waitcnt lgkmcnt(1)
v_and_b32 v124,v12,v93
v_and_b32 v125,v13,v93
v_and_b32 v126,v14,v93
v_and_b32 v127,v15,v93
s_nop 1
v_mfma_f32_16x16x32_bf16 v[116:119],v[124:127],v[112:115],v[116:119]
ds_read_b128 v[112:115],v18 offset:7168
s_waitcnt lgkmcnt(1)
v_and_b32 v124,v12,v94
v_and_b32 v125,v13,v94
v_and_b32 v126,v14,v94
v_and_b32 v127,v15,v94
s_nop 1
v_mfma_f32_16x16x32_bf16 v[116:119],v[124:127],v[108:111],v[116:119]
ds_read_b128 v[108:111],v18 offset:8192
s_waitcnt lgkmcnt(1)
v_and_b32 v124,v12,v95
v_and_b32 v125,v13,v95
v_and_b32 v126,v14,v95
v_and_b32 v127,v15,v95
s_nop 1
v_mfma_f32_16x16x32_bf16 v[116:119],v[124:127],v[112:115],v[116:119]
ds_read_b128 v[88:91],v8 offset:32
ds_read_b128 v[92:95],v8 offset:48
ds_read_b128 v[112:115],v18 offset:9216
s_waitcnt lgkmcnt(1)
v_and_b32 v124,v12,v88
v_and_b32 v125,v13,v88
v_and_b32 v126,v14,v88
v_and_b32 v127,v15,v88
s_nop 1
v_mfma_f32_16x16x32_bf16 v[116:119],v[124:127],v[108:111],v[116:119]
ds_read_b128 v[108:111],v18 offset:10240
s_waitcnt lgkmcnt(1)
v_and_b32 v124,v12,v89
v_and_b32 v125,v13,v89
v_and_b32 v126,v14,v89
v_and_b32 v127,v15,v89
s_nop 1
v_mfma_f32_16x16x32_bf16 v[116:119],v[124:127],v[112:115],v[116:119]
ds_read_b128 v[112:115],v18 offset:11264
s_waitcnt lgkmcnt(1)
v_and_b32 v124,v12,v90
v_and_b32 v125,v13,v90
v_and_b32 v126,v14,v90
v_and_b32 v127,v15,v90
s_nop 1
v_mfma_f32_16x16x32_bf16 v[116:119],v[124:127],v[108:111],v[116:119]
ds_read_b128 v[108:111],v18 offset:12288
s_waitcnt lgkmcnt(1)
v_and_b32 v124,v12,v91
v_and_b32 v125,v13,v91
v_and_b32 v126,v14,v91
v_and_b32 v127,v15,v91
s_nop 1
v_mfma_f32_16x16x32_bf16 v[116:119],v[124:127],v[112:115],v[116:119]
ds_read_b128 v[112:115],v18 offset:13312
s_waitcnt lgkmcnt(1)
v_and_b32 v124,v12,v92
v_and_b32 v125,v13,v92
v_and_b32 v126,v14,v92
v_and_b32 v127,v15,v92
s_nop 1
v_mfma_f32_16x16x32_bf16 v[116:119],v[124:127],v[108:111],v[116:119]
ds_read_b128 v[108:111],v18 offset:14336
s_waitcnt lgkmcnt(1)
v_and_b32 v124,v12,v93
v_and_b32 v125,v13,v93
v_and_b32 v126,v14,v93
v_and_b32 v127,v15,v93
s_nop 1
v_mfma_f32_16x16x32_bf16 v[116:119],v[124:127],v[112:115],v[116:119]
ds_read_b128 v[112:115],v18 offset:15360
s_waitcnt lgkmcnt(1)
v_and_b32 v124,v12,v94
v_and_b32 v125,v13,v94
v_and_b32 v126,v14,v94
v_and_b32 v127,v15,v94
s_nop 1
v_mfma_f32_16x16x32_bf16 v[116:119],v[124:127],v[108:111],v[116:119]
ds_read_b128 v[108:111],v18 offset:16384
s_waitcnt lgkmcnt(1)
v_and_b32 v124,v12,v95
v_and_b32 v125,v13,v95
v_and_b32 v126,v14,v95
v_and_b32 v127,v15,v95
s_nop 1
v_mfma_f32_16x16x32_bf16 v[116:119],v[124:127],v[112:115],v[116:119]
ds_read_b128 v[88:91],v8 offset:64
ds_read_b128 v[92:95],v8 offset:80
ds_read_b128 v[112:115],v18 offset:17408
s_waitcnt lgkmcnt(1)
v_and_b32 v124,v12,v88
v_and_b32 v125,v13,v88
v_and_b32 v126,v14,v88
v_and_b32 v127,v15,v88
s_nop 1
v_mfma_f32_16x16x32_bf16 v[116:119],v[124:127],v[108:111],v[116:119]
ds_read_b128 v[108:111],v18 offset:18432
s_waitcnt lgkmcnt(1)
v_and_b32 v124,v12,v89
v_and_b32 v125,v13,v89
v_and_b32 v126,v14,v89
v_and_b32 v127,v15,v89
s_nop 1
v_mfma_f32_16x16x32_bf16 v[116:119],v[124:127],v[112:115],v[116:119]
ds_read_b128 v[112:115],v18 offset:19456
s_waitcnt lgkmcnt(1)
v_and_b32 v124,v12,v90
v_and_b32 v125,v13,v90
v_and_b32 v126,v14,v90
v_and_b32 v127,v15,v90
s_nop 1
v_mfma_f32_16x16x32_bf16 v[116:119],v[124:127],v[108:111],v[116:119]
ds_read_b128 v[108:111],v18 offset:20480
s_waitcnt lgkmcnt(1)
v_and_b32 v124,v12,v91
v_and_b32 v125,v13,v91
v_and_b32 v126,v14,v91
v_and_b32 v127,v15,v91
s_nop 1
v_mfma_f32_16x16x32_bf16 v[116:119],v[124:127],v[112:115],v[116:119]
ds_read_b128 v[112:115],v18 offset:21504
s_waitcnt lgkmcnt(1)
v_and_b32 v124,v12,v92
v_and_b32 v125,v13,v92
v_and_b32 v126,v14,v92
v_and_b32 v127,v15,v92
s_nop 1
v_mfma_f32_16x16x32_bf16 v[116:119],v[124:127],v[108:111],v[116:119]
ds_read_b128 v[108:111],v18 offset:22528
s_waitcnt lgkmcnt(1)
v_and_b32 v124,v12,v93
v_and_b32 v125,v13,v93
v_and_b32 v126,v14,v93
v_and_b32 v127,v15,v93
s_nop 1
v_mfma_f32_16x16x32_bf16 v[116:119],v[124:127],v[112:115],v[116:119]
ds_read_b128 v[112:115],v18 offset:23552
s_waitcnt lgkmcnt(1)
v_and_b32 v124,v12,v94
v_and_b32 v125,v13,v94
v_and_b32 v126,v14,v94
v_and_b32 v127,v15,v94
s_nop 1
v_mfma_f32_16x16x32_bf16 v[116:119],v[124:127],v[108:111],v[116:119]
ds_read_b128 v[108:111],v18 offset:24576
s_waitcnt lgkmcnt(1)
v_and_b32 v124,v12,v95
v_and_b32 v125,v13,v95
v_and_b32 v126,v14,v95
v_and_b32 v127,v15,v95
s_nop 1
v_mfma_f32_16x16x32_bf16 v[116:119],v[124:127],v[112:115],v[116:119]
ds_read_b128 v[88:91],v8 offset:96
ds_read_b128 v[92:95],v8 offset:112
ds_read_b128 v[112:115],v18 offset:25600
s_waitcnt lgkmcnt(1)
v_and_b32 v124,v12,v88
v_and_b32 v125,v13,v88
v_and_b32 v126,v14,v88
v_and_b32 v127,v15,v88
s_nop 1
v_mfma_f32_16x16x32_bf16 v[116:119],v[124:127],v[108:111],v[116:119]
ds_read_b128 v[108:111],v18 offset:26624
s_waitcnt lgkmcnt(1)
v_and_b32 v124,v12,v89
v_and_b32 v125,v13,v89
v_and_b32 v126,v14,v89
v_and_b32 v127,v15,v89
s_nop 1
v_mfma_f32_16x16x32_bf16 v[116:119],v[124:127],v[112:115],v[116:119]
ds_read_b128 v[112:115],v18 offset:27648
s_waitcnt lgkmcnt(1)
v_and_b32 v124,v12,v90
v_and_b32 v125,v13,v90
v_and_b32 v126,v14,v90
v_and_b32 v127,v15,v90
s_nop 1
v_mfma_f32_16x16x32_bf16 v[116:119],v[124:127],v[108:111],v[116:119]
ds_read_b128 v[108:111],v18 offset:28672
s_waitcnt lgkmcnt(1)
v_and_b32 v124,v12,v91
v_and_b32 v125,v13,v91
v_and_b32 v126,v14,v91
v_and_b32 v127,v15,v91
s_nop 1
v_mfma_f32_16x16x32_bf16 v[116:119],v[124:127],v[112:115],v[116:119]
ds_read_b128 v[112:115],v18 offset:29696
s_waitcnt lgkmcnt(1)
v_and_b32 v124,v12,v92
v_and_b32 v125,v13,v92
v_and_b32 v126,v14,v92
v_and_b32 v127,v15,v92
s_nop 1
v_mfma_f32_16x16x32_bf16 v[116:119],v[124:127],v[108:111],v[116:119]
ds_read_b128 v[108:111],v18 offset:30720
s_waitcnt lgkmcnt(1)
v_and_b32 v124,v12,v93
v_and_b32 v125,v13,v93
v_and_b32 v126,v14,v93
v_and_b32 v127,v15,v93
s_nop 1
v_mfma_f32_16x16x32_bf16 v[116:119],v[124:127],v[112:115],v[116:119]
ds_read_b128 v[112:115],v18 offset:31744
s_waitcnt lgkmcnt(1)
v_and_b32 v124,v12,v94
v_and_b32 v125,v13,v94
v_and_b32 v126,v14,v94
v_and_b32 v127,v15,v94
s_nop 1
v_mfma_f32_16x16x32_bf16 v[116:119],v[124:127],v[108:111],v[116:119]
s_waitcnt lgkmcnt(0)
v_and_b32 v124,v12,v95
v_and_b32 v125,v13,v95
v_and_b32 v126,v14,v95
v_and_b32 v127,v15,v95
s_nop 1
v_mfma_f32_16x16x32_bf16 v[116:119],v[124:127],v[112:115],v[116:119]
v_lshlrev_b32 v8,5,v9
v_and_b32 v124,1,v10
v_lshl_add_u32 v8,v124,4,v8
v_lshrrev_b32 v124,1,v10
v_lshl_add_u32 v8,v124,11,v8
s_lshl_b32 s60,s46,9
s_add_u32 s60,s60,147456
v_add_u32 v8,s60,v8
ds_write_b128 v8,v[116:119]
v_lshlrev_b32 v8,2,v1
v_add_u32 v8,147456,v8
s_waitcnt lgkmcnt(0)
s_barrier
ds_read2st64_b32 v[88:89],v8 offset0:0 offset1:1
ds_read2st64_b32 v[90:91],v8 offset0:2 offset1:3
ds_read2st64_b32 v[92:93],v8 offset0:4 offset1:5
ds_read2st64_b32 v[94:95],v8 offset0:6 offset1:7
s_waitcnt lgkmcnt(0)
v_pk_add_f32 v[88:89],v[88:89],v[90:91]
v_pk_add_f32 v[92:93],v[92:93],v[94:95]
v_pk_add_f32 v[88:89],v[88:89],v[92:93]
v_cvt_pk_bf16_f32 v88,v88,v88
v_and_b32 v88,0xffff0000,v88
v_cvt_pk_bf16_f32 v89,v89,v89
v_and_b32 v89,0xffff0000,v89
v_mul_f32 v90,0xbfb8aa3b,v88
v_exp_f32 v90,v90
s_nop 0
v_add_f32 v90,1.0,v90
v_rcp_f32 v90,v90
s_nop 0
v_mul_f32 v88,v88,v90
v_cvt_pk_bf16_f32 v88,v88,v88
v_and_b32 v88,0xffff0000,v88
v_mul_f32 v88,v88,v89
v_cvt_pk_bf16_f32 v88,v88,v88
v_lshlrev_b32 v8,2,v1
v_add_u32 v8,s58,v8
ds_write_b32 v8,v88
v_lshlrev_b32 v8,6,v10
v_add_u32 v8,s58,v8
s_waitcnt lgkmcnt(0)
ds_read_b128 v[88:91],v8
ds_read_b128 v[92:95],v8 offset:16
ds_read_b128 v[108:111],v8 offset:32
ds_read_b128 v[112:115],v8 offset:48
s_waitcnt vmcnt(0) lgkmcnt(0)
v_and_b32 v124,v12,v88
v_and_b32 v125,v13,v88
v_and_b32 v126,v14,v88
v_and_b32 v127,v15,v88
s_nop 1
v_mfma_f32_16x16x32_bf16 v[116:119],v[124:127],v[24:27],0
v_and_b32 v124,v12,v89
v_and_b32 v125,v13,v89
v_and_b32 v126,v14,v89
v_and_b32 v127,v15,v89
s_nop 1
v_mfma_f32_16x16x32_bf16 v[116:119],v[124:127],v[28:31],v[116:119]
v_and_b32 v124,v12,v90
v_and_b32 v125,v13,v90
v_and_b32 v126,v14,v90
v_and_b32 v127,v15,v90
s_nop 1
v_mfma_f32_16x16x32_bf16 v[116:119],v[124:127],v[32:35],v[116:119]
v_and_b32 v124,v12,v91
v_and_b32 v125,v13,v91
v_and_b32 v126,v14,v91
v_and_b32 v127,v15,v91
s_nop 1
v_mfma_f32_16x16x32_bf16 v[116:119],v[124:127],v[36:39],v[116:119]
v_and_b32 v124,v12,v92
v_and_b32 v125,v13,v92
v_and_b32 v126,v14,v92
v_and_b32 v127,v15,v92
s_nop 1
v_mfma_f32_16x16x32_bf16 v[116:119],v[124:127],v[40:43],v[116:119]
v_and_b32 v124,v12,v93
v_and_b32 v125,v13,v93
v_and_b32 v126,v14,v93
v_and_b32 v127,v15,v93
s_nop 1
v_mfma_f32_16x16x32_bf16 v[116:119],v[124:127],v[44:47],v[116:119]
v_and_b32 v124,v12,v94
v_and_b32 v125,v13,v94
v_and_b32 v126,v14,v94
v_and_b32 v127,v15,v94
s_nop 1
v_mfma_f32_16x16x32_bf16 v[116:119],v[124:127],v[48:51],v[116:119]
v_and_b32 v124,v12,v95
v_and_b32 v125,v13,v95
v_and_b32 v126,v14,v95
v_and_b32 v127,v15,v95
s_nop 1
v_mfma_f32_16x16x32_bf16 v[116:119],v[124:127],v[52:55],v[116:119]
v_and_b32 v124,v12,v108
v_and_b32 v125,v13,v108
v_and_b32 v126,v14,v108
v_and_b32 v127,v15,v108
s_nop 1
v_mfma_f32_16x16x32_bf16 v[116:119],v[124:127],v[56:59],v[116:119]
v_and_b32 v124,v12,v109
v_and_b32 v125,v13,v109
v_and_b32 v126,v14,v109
v_and_b32 v127,v15,v109
s_nop 1
v_mfma_f32_16x16x32_bf16 v[116:119],v[124:127],v[60:63],v[116:119]
v_and_b32 v124,v12,v110
v_and_b32 v125,v13,v110
v_and_b32 v126,v14,v110
v_and_b32 v127,v15,v110
s_nop 1
v_mfma_f32_16x16x32_bf16 v[116:119],v[124:127],v[64:67],v[116:119]
v_and_b32 v124,v12,v111
v_and_b32 v125,v13,v111
v_and_b32 v126,v14,v111
v_and_b32 v127,v15,v111
s_nop 1
v_mfma_f32_16x16x32_bf16 v[116:119],v[124:127],v[68:71],v[116:119]
v_and_b32 v124,v12,v112
v_and_b32 v125,v13,v112
v_and_b32 v126,v14,v112
v_and_b32 v127,v15,v112
s_nop 1
v_mfma_f32_16x16x32_bf16 v[116:119],v[124:127],v[72:75],v[116:119]
v_and_b32 v124,v12,v113
v_and_b32 v125,v13,v113
v_and_b32 v126,v14,v113
v_and_b32 v127,v15,v113
s_nop 1
v_mfma_f32_16x16x32_bf16 v[116:119],v[124:127],v[76:79],v[116:119]
v_and_b32 v124,v12,v114
v_and_b32 v125,v13,v114
v_and_b32 v126,v14,v114
v_and_b32 v127,v15,v114
s_nop 1
v_mfma_f32_16x16x32_bf16 v[116:119],v[124:127],v[80:83],v[116:119]
v_and_b32 v124,v12,v115
v_and_b32 v125,v13,v115
v_and_b32 v126,v14,v115
v_and_b32 v127,v15,v115
s_nop 1
v_mfma_f32_16x16x32_bf16 v[116:119],v[124:127],v[84:87],v[116:119]
v_lshlrev_b32 v8,4,v9
v_and_b32 v124,1,v10
v_lshl_add_u32 v8,v124,3,v8
v_and_b32 v124,2,v10
v_lshl_add_u32 v8,v124,30,v8
s_lshl_b32 s65,s51,15
s_add_u32 s65,s65,92274688
s_lshl_b32 s59,s47,10
s_lshl_b32 s60,s46,8
s_add_u32 s59,s59,s60
s_add_u32 s59,s59,s65
v_cvt_pk_bf16_f32 v24,v116,v117
v_cvt_pk_bf16_f32 v25,v118,v119
buffer_store_dwordx2 v[24:25],v8,s[8:11],s59 offen
s_lshl_b32 s59,s51,13
s_lshl2_add_u32 s59,s47,s59
s_add_u32 s59,s59,10486912
s_waitcnt vmcnt(0)
s_barrier
s_or_b32 s59,s59,s52
buffer_store_dword v17,off,s[8:11],s59
s_lshl_b32 s59,s51,13
s_add_u32 s59,s59,10486912
v_and_b32 v124,31,v1
v_lshlrev_b32 v124,2,v124
L_fw_40:
buffer_load_dword v125,v124,s[8:11],s59 offen sc1
s_sub_u32 s49,s49,1
s_cbranch_scc1 L_abort
s_waitcnt vmcnt(0)
v_cmp_eq_u32 vcc,0,v125
s_cbranch_vccnz L_fw_40
s_add_u32 s63,s65,0
buffer_load_dwordx4 v[24:27],v22,s[8:11],s63 offen sc1
s_add_u32 s63,s65,4096
buffer_load_dwordx4 v[28:31],v22,s[8:11],s63 offen sc1
s_add_u32 s63,s65,8192
buffer_load_dwordx4 v[32:35],v22,s[8:11],s63 offen sc1
s_add_u32 s63,s65,12288
buffer_load_dwordx4 v[36:39],v22,s[8:11],s63 offen sc1
s_add_u32 s63,s65,16384
buffer_load_dwordx4 v[40:43],v22,s[8:11],s63 offen sc1
s_add_u32 s63,s65,20480
buffer_load_dwordx4 v[44:47],v22,s[8:11],s63 offen sc1
s_add_u32 s63,s65,24576
buffer_load_dwordx4 v[48:51],v22,s[8:11],s63 offen sc1
s_add_u32 s63,s65,28672
buffer_load_dwordx4 v[52:55],v22,s[8:11],s63 offen sc1
v_and_b32 v64,15,v1
v_and_b32 v65,1,v1
v_lshlrev_b32 v65,4,v65
v_mov_b32 v66,0x3f80
v_lshlrev_b32 v66,v65,v66
v_lshrrev_b32 v64,1,v64
v_cmp_eq_u32 vcc,0,v64
s_nop 1
v_cndmask_b32 v56,0,v66,vcc
v_cmp_eq_u32 vcc,1,v64
s_nop 1
v_cndmask_b32 v57,0,v66,vcc
v_cmp_eq_u32 vcc,2,v64
s_nop 1
v_cndmask_b32 v58,0,v66,vcc
v_cmp_eq_u32 vcc,3,v64
s_nop 1
v_cndmask_b32 v59,0,v66,vcc
s_waitcnt vmcnt(7)
s_nop 0
v_mfma_f32_16x16x32_bf16 v[60:63],v[56:59],v[24:27],0
s_waitcnt vmcnt(6)
v_mfma_f32_16x16x32_bf16 v[60:63],v[56:59],v[28:31],v[60:63]
s_waitcnt vmcnt(5)
v_mfma_f32_16x16x32_bf16 v[60:63],v[56:59],v[32:35],v[60:63]
s_waitcnt vmcnt(4)
v_mfma_f32_16x16x32_bf16 v[60:63],v[56:59],v[36:39],v[60:63]
s_waitcnt vmcnt(3)
v_mfma_f32_16x16x32_bf16 v[60:63],v[56:59],v[40:43],v[60:63]
s_waitcnt vmcnt(2)
v_mfma_f32_16x16x32_bf16 v[60:63],v[56:59],v[44:47],v[60:63]
s_waitcnt vmcnt(1)
v_mfma_f32_16x16x32_bf16 v[60:63],v[56:59],v[48:51],v[60:63]
s_waitcnt vmcnt(0)
v_mfma_f32_16x16x32_bf16 v[60:63],v[56:59],v[52:55],v[60:63]
s_nop 7
ds_write_b128 v21,v[60:63]
s_waitcnt lgkmcnt(0)
s_barrier
s_cmp_lg_u32 s46,0
s_cbranch_scc1 L_moed_39
v_lshlrev_b32 v56,5,v1
v_add_u32 v56,155648,v56
ds_read_b128 v[24:27],v56
ds_read_b128 v[28:31],v56 offset:16
s_and_b32 s59,s54,0xffff0000
s_xor_b32 s60,s59,0x80000000
s_xor_b32 s61,s59,0xffff0000
s_cmp_lt_i32 s59,0
s_cselect_b32 s59,s60,s61
v_mov_b32 v56,s59
v_mul_f32 v56,0xbfb8aa3b,v56
v_exp_f32 v56,v56
s_nop 0
v_add_f32 v56,1.0,v56
v_rcp_f32 v56,v56
s_nop 0
v_cvt_pk_bf16_f32 v56,v56,v56
v_and_b32 v56,0xffff0000,v56
v_lshlrev_b32 v48,16,v104
v_and_b32 v49,0xffff0000,v104
v_lshlrev_b32 v50,16,v105
v_and_b32 v51,0xffff0000,v105
v_lshlrev_b32 v52,16,v106
v_and_b32 v53,0xffff0000,v106
v_lshlrev_b32 v54,16,v107
v_and_b32 v55,0xffff0000,v107
s_waitcnt lgkmcnt(0)
v_cvt_pk_bf16_f32 v40,v24,v25
v_cvt_pk_bf16_f32 v41,v26,v27
v_cvt_pk_bf16_f32 v42,v28,v29
v_cvt_pk_bf16_f32 v43,v30,v31
v_lshlrev_b32 v24,16,v40
v_and_b32 v25,0xffff0000,v40
v_lshlrev_b32 v26,16,v41
v_and_b32 v27,0xffff0000,v41
v_lshlrev_b32 v28,16,v42
v_and_b32 v29,0xffff0000,v42
v_lshlrev_b32 v30,16,v43
v_and_b32 v31,0xffff0000,v43
v_mul_f32 v24,v24,v56
v_mul_f32 v25,v25,v56
v_mul_f32 v26,v26,v56
v_mul_f32 v27,v27,v56
v_mul_f32 v28,v28,v56
v_mul_f32 v29,v29,v56
v_mul_f32 v30,v30,v56
v_mul_f32 v31,v31,v56
v_cvt_pk_bf16_f32 v40,v24,v25
v_cvt_pk_bf16_f32 v41,v26,v27
v_cvt_pk_bf16_f32 v42,v28,v29
v_cvt_pk_bf16_f32 v43,v30,v31
v_lshlrev_b32 v24,16,v40
v_and_b32 v25,0xffff0000,v40
v_lshlrev_b32 v26,16,v41
v_and_b32 v27,0xffff0000,v41
v_lshlrev_b32 v28,16,v42
v_and_b32 v29,0xffff0000,v42
v_lshlrev_b32 v30,16,v43
v_and_b32 v31,0xffff0000,v43
v_add_f32 v24,v24,v48
v_add_f32 v25,v25,v49
v_add_f32 v26,v26,v50
v_add_f32 v27,v27,v51
v_add_f32 v28,v28,v52
v_add_f32 v29,v29,v53
v_add_f32 v30,v30,v54
v_add_f32 v31,v31,v55
v_cvt_pk_bf16_f32 v40,v24,v25
v_cvt_pk_bf16_f32 v41,v26,v27
v_cvt_pk_bf16_f32 v42,v28,v29
v_cvt_pk_bf16_f32 v43,v30,v31
v_lshlrev_b32 v24,16,v40
v_and_b32 v25,0xffff0000,v40
v_lshlrev_b32 v26,16,v41
v_and_b32 v27,0xffff0000,v41
v_lshlrev_b32 v28,16,v42
v_and_b32 v29,0xffff0000,v42
v_lshlrev_b32 v30,16,v43
v_and_b32 v31,0xffff0000,v43
v_add_f32 v96,v96,v24
v_add_f32 v97,v97,v25
v_add_f32 v98,v98,v26
v_add_f32 v99,v99,v27
v_add_f32 v100,v100,v28
v_add_f32 v101,v101,v29
v_add_f32 v102,v102,v30
v_add_f32 v103,v103,v31
v_cvt_pk_bf16_f32 v80,v96,v97
v_cvt_pk_bf16_f32 v81,v98,v99
v_cvt_pk_bf16_f32 v82,v100,v101
v_cvt_pk_bf16_f32 v83,v102,v103
v_lshlrev_b32 v96,16,v80
v_and_b32 v97,0xffff0000,v80
v_lshlrev_b32 v98,16,v81
v_and_b32 v99,0xffff0000,v81
v_lshlrev_b32 v100,16,v82
v_and_b32 v101,0xffff0000,v82
v_lshlrev_b32 v102,16,v83
v_and_b32 v103,0xffff0000,v83
v_readfirstlane_b32 s78,v96
s_nop 1
v_pk_add_f32 v[58:59],v[96:97],s[78:79] op_sel_hi:[1,0] neg_lo:[0,1] neg_hi:[0,1]
v_pk_add_f32 v[60:61],v[98:99],s[78:79] op_sel_hi:[1,0] neg_lo:[0,1] neg_hi:[0,1]
v_pk_add_f32 v[62:63],v[100:101],s[78:79] op_sel_hi:[1,0] neg_lo:[0,1] neg_hi:[0,1]
v_pk_add_f32 v[64:65],v[102:103],s[78:79] op_sel_hi:[1,0] neg_lo:[0,1] neg_hi:[0,1]
v_pk_add_f32 v[66:67],v[58:59],v[60:61]
v_pk_mul_f32 v[68:69],v[58:59],v[58:59]
v_pk_add_f32 v[70:71],v[62:63],v[64:65]
v_pk_fma_f32 v[68:69],v[60:61],v[60:61],v[68:69]
v_pk_add_f32 v[66:67],v[66:67],v[70:71]
v_pk_fma_f32 v[68:69],v[62:63],v[62:63],v[68:69]
v_add_f32 v66,v66,v67
v_pk_fma_f32 v[68:69],v[64:65],v[64:65],v[68:69]
v_add_f32 v68,v68,v69
s_nop 1
v_permlane32_swap_b32 v66,v68
v_add_f32 v66,v66,v68
s_nop 1
v_add_f32_dpp v66,v66,v66 row_ror:8 row_mask:0xf bank_mask:0xf
s_nop 1
v_add_f32_dpp v66,v66,v66 row_ror:4 row_mask:0xf bank_mask:0xf
s_nop 1
v_add_f32_dpp v66,v66,v66 row_ror:2 row_mask:0xf bank_mask:0xf
s_nop 1
v_add_f32_dpp v66,v66,v66 row_ror:1 row_mask:0xf bank_mask:0xf
v_mov_b32 v68,v66
s_nop 1
v_permlane16_swap_b32 v66,v68
v_add_f32 v66,v66,v68
v_mul_f32 v66,0x3b000000,v66
v_mov_b32 v68,v66
s_nop 1
v_permlane32_swap_b32 v66,v68
v_fma_f32 v68,-v66,v66,v68
v_add_f32 v66,s78,v66
v_max_f32 v68,0,v68
v_cvt_pk_bf16_f32 v68,v66,v68
v_lshlrev_b32 v66,16,v68
v_and_b32 v68,0xffff0000,v68
v_add_f32 v68,0x3727c5ac,v68
v_cvt_pk_bf16_f32 v68,v68,v68
v_and_b32 v68,0xffff0000,v68
v_sqrt_f32 v68,v68
v_pk_add_f32 v[58:59],v[96:97],v[66:67] op_sel_hi:[1,0] neg_lo:[0,1] neg_hi:[0,1]
v_pk_add_f32 v[60:61],v[98:99],v[66:67] op_sel_hi:[1,0] neg_lo:[0,1] neg_hi:[0,1]
v_pk_add_f32 v[62:63],v[100:101],v[66:67] op_sel_hi:[1,0] neg_lo:[0,1] neg_hi:[0,1]
v_pk_add_f32 v[64:65],v[102:103],v[66:67] op_sel_hi:[1,0] neg_lo:[0,1] neg_hi:[0,1]
v_cvt_pk_bf16_f32 v68,v68,v68
v_and_b32 v68,0xffff0000,v68
v_rcp_f32 v68,v68
v_cvt_pk_bf16_f32 v84,v58,v59
v_cvt_pk_bf16_f32 v85,v60,v61
v_cvt_pk_bf16_f32 v86,v62,v63
v_cvt_pk_bf16_f32 v87,v64,v65
v_lshlrev_b32 v58,16,v84
v_and_b32 v59,0xffff0000,v84
v_lshlrev_b32 v60,16,v85
v_and_b32 v61,0xffff0000,v85
v_lshlrev_b32 v62,16,v86
v_and_b32 v63,0xffff0000,v86
v_lshlrev_b32 v64,16,v87
v_and_b32 v65,0xffff0000,v87
v_pk_mul_f32 v[58:59],v[58:59],v[68:69] op_sel_hi:[1,0]
v_pk_mul_f32 v[60:61],v[60:61],v[68:69] op_sel_hi:[1,0]
v_pk_mul_f32 v[62:63],v[62:63],v[68:69] op_sel_hi:[1,0]
v_pk_mul_f32 v[64:65],v[64:65],v[68:69] op_sel_hi:[1,0]
v_cvt_pk_bf16_f32 v84,v58,v59
v_cvt_pk_bf16_f32 v85,v60,v61
v_cvt_pk_bf16_f32 v86,v62,v63
v_cvt_pk_bf16_f32 v87,v64,v65
s_lshl_b32 s58,s51,10
s_add_u32 s58,s58,11272192
s_add_u32 s59,s58,65536
s_cmp_eq_u32 s47,0
s_cselect_b32 s59,s59,0x80000000
s_add_u32 s57,s56,98566144
buffer_store_dwordx4 v[84:87],v0,s[8:11],s59 offen sc1
buffer_store_dwordx4 v[80:83],v0,s[8:11],s58 offen sc1
buffer_store_dwordx4 v[84:87],v0,s[8:11],s57 offen sc1
L_moed_39:
s_barrier
L_mo_26:
s_mov_b32 s77,-1
s_cmp_lt_u32 s31,64
s_cbranch_scc1 L_mo_22
s_cmp_eq_u32 s86,0
s_cbranch_scc1 L_mo_35
L_mo_28:
s_andn2_b32 s51,0x7ff,s54
s_lshr_b32 s51,s51,5
s_andn2_b32 s56,31,s54
v_lshrrev_b32 v2,10,v20
v_add_u32 v3,16,v2
v_add_u32 v8,96468992,v20
v_cmp_eq_u32 vcc,s56,v2
s_nop 1
v_cndmask_b32 v2,v20,v8,vcc
v_cmp_eq_u32 vcc,s56,v3
s_nop 1
v_cndmask_b32 v3,v20,v8,vcc
s_waitcnt vmcnt(0)
s_lshl_b32 s59,s51,13
s_add_u32 s59,s59,10487552
s_cmp_lg_u32 s46,0
s_cbranch_scc1 L_fd_44
v_and_b32 v124,31,v1
v_lshlrev_b32 v124,2,v124
s_branch L_ff_45
L_fw_43:
s_sleep 2
L_ff_45:
buffer_load_dword v125,v124,s[8:11],s59 offen sc1
s_sub_u32 s49,s49,1
s_cbranch_scc1 L_abort
s_waitcnt vmcnt(0)
v_cmp_eq_u32 vcc,0,v125
s_cbranch_vccnz L_fw_43
L_fd_44:
s_barrier
s_or_b32 s72,s72,s52
buffer_store_dword v17,off,s[8:11],s72 sc1
s_lshl_b32 s66,s51,15
s_add_u32 s66,s66,2097152
s_add_u32 s67,s66,16384
s_add_u32 m0,s50,131072
s_nop 0
buffer_load_dwordx4 v2,s[8:11],s66 offen offset:0 sc1 lds
s_add_u32 m0,s50,135168
s_nop 0
buffer_load_dwordx4 v3,s[8:11],s67 offen offset:0 sc1 lds
s_add_u32 m0,s50,139008
s_nop 0
buffer_load_dwordx4 v2,s[8:11],s66 offen offset:256 sc1 lds
s_add_u32 m0,s50,143104
s_nop 0
buffer_load_dwordx4 v3,s[8:11],s67 offen offset:256 sc1 lds
s_add_u32 m0,s50,146944
s_nop 0
buffer_load_dwordx4 v2,s[8:11],s66 offen offset:512 sc1 lds
s_add_u32 m0,s50,151040
s_nop 0
buffer_load_dwordx4 v3,s[8:11],s67 offen offset:512 sc1 lds
s_lshl_b32 s58,s51,5
s_add_u32 s58,s58,s47
s_mul_i32 s58,s58,24576
s_add_u32 s58,s58,201326592
s_add_u32 s61,s58,s50
s_add_u32 s62,s61,4096
s_add_u32 s63,s61,16384
s_add_u32 s64,s61,20480
s_add_u32 s65,s61,s50
s_add_u32 s65,s65,8192
s_waitcnt vmcnt(4)
s_barrier
ds_read_b128 v[104:107],v4 offset:0
ds_read_b128 v[108:111],v4 offset:4096
ds_read_b128 v[112:115],v5 offset:0
ds_read_b128 v[116:119],v5 offset:4096
s_add_u32 m0,s50,154880
s_nop 0
buffer_load_dwordx4 v2,s[8:11],s66 offen offset:768 sc1 lds
s_add_u32 m0,s50,158976
s_nop 0
buffer_load_dwordx4 v3,s[8:11],s67 offen offset:768 sc1 lds
s_waitcnt lgkmcnt(2)
v_mfma_f32_16x16x32_bf16 v[24:27],a[128:131],v[104:107],0
ds_read_b128 v[120:123],v6 offset:0
v_mfma_f32_16x16x32_bf16 v[40:43],v[104:107],v[128:131],0
v_mfma_f32_16x16x32_bf16 v[28:31],a[128:131],v[108:111],0
ds_read_b128 v[124:127],v6 offset:4096
v_mfma_f32_16x16x32_bf16 v[44:47],v[108:111],v[128:131],0
v_mfma_f32_16x16x32_bf16 v[32:35],a[136:139],v[104:107],0
v_mfma_f32_16x16x32_bf16 v[48:51],v[104:107],v[136:139],0
v_mfma_f32_16x16x32_bf16 v[36:39],a[136:139],v[108:111],0
v_mfma_f32_16x16x32_bf16 v[52:55],v[108:111],v[136:139],0
s_waitcnt lgkmcnt(2)
v_mfma_f32_16x16x32_bf16 v[24:27],a[132:135],v[112:115],v[24:27]
ds_read_b128 v[104:107],v7 offset:0
v_mfma_f32_16x16x32_bf16 v[40:43],v[112:115],v[132:135],v[40:43]
v_mfma_f32_16x16x32_bf16 v[28:31],a[132:135],v[116:119],v[28:31]
ds_read_b128 v[108:111],v7 offset:4096
v_mfma_f32_16x16x32_bf16 v[44:47],v[116:119],v[132:135],v[44:47]
v_mfma_f32_16x16x32_bf16 v[32:35],a[140:143],v[112:115],v[32:35]
v_mfma_f32_16x16x32_bf16 v[48:51],v[112:115],v[140:143],v[48:51]
v_mfma_f32_16x16x32_bf16 v[36:39],a[140:143],v[116:119],v[36:39]
v_mfma_f32_16x16x32_bf16 v[52:55],v[116:119],v[140:143],v[52:55]
s_waitcnt vmcnt(4)
s_barrier
s_waitcnt lgkmcnt(2)
v_mfma_f32_16x16x32_bf16 v[24:27],a[144:147],v[120:123],v[24:27]
ds_read_b128 v[112:115],v4 offset:8192
v_mfma_f32_16x16x32_bf16 v[40:43],v[120:123],v[144:147],v[40:43]
v_mfma_f32_16x16x32_bf16 v[28:31],a[144:147],v[124:127],v[28:31]
ds_read_b128 v[116:119],v4 offset:12288
v_mfma_f32_16x16x32_bf16 v[44:47],v[124:127],v[144:147],v[44:47]
v_mfma_f32_16x16x32_bf16 v[32:35],a[152:155],v[120:123],v[32:35]
v_mfma_f32_16x16x32_bf16 v[48:51],v[120:123],v[152:155],v[48:51]
v_mfma_f32_16x16x32_bf16 v[36:39],a[152:155],v[124:127],v[36:39]
v_mfma_f32_16x16x32_bf16 v[52:55],v[124:127],v[152:155],v[52:55]
s_waitcnt lgkmcnt(2)
v_mfma_f32_16x16x32_bf16 v[24:27],a[148:151],v[104:107],v[24:27]
ds_read_b128 v[120:123],v5 offset:8192
v_mfma_f32_16x16x32_bf16 v[40:43],v[104:107],v[148:151],v[40:43]
v_mfma_f32_16x16x32_bf16 v[28:31],a[148:151],v[108:111],v[28:31]
ds_read_b128 v[124:127],v5 offset:12288
v_mfma_f32_16x16x32_bf16 v[44:47],v[108:111],v[148:151],v[44:47]
v_mfma_f32_16x16x32_bf16 v[32:35],a[156:159],v[104:107],v[32:35]
v_mfma_f32_16x16x32_bf16 v[48:51],v[104:107],v[156:159],v[48:51]
v_mfma_f32_16x16x32_bf16 v[36:39],a[156:159],v[108:111],v[36:39]
v_mfma_f32_16x16x32_bf16 v[52:55],v[108:111],v[156:159],v[52:55]
s_waitcnt lgkmcnt(2)
v_mfma_f32_16x16x32_bf16 v[24:27],a[160:163],v[112:115],v[24:27]
ds_read_b128 v[104:107],v6 offset:8192
v_mfma_f32_16x16x32_bf16 v[40:43],v[112:115],v[160:163],v[40:43]
v_mfma_f32_16x16x32_bf16 v[28:31],a[160:163],v[116:119],v[28:31]
ds_read_b128 v[108:111],v6 offset:12288
v_mfma_f32_16x16x32_bf16 v[44:47],v[116:119],v[160:163],v[44:47]
v_mfma_f32_16x16x32_bf16 v[32:35],a[168:171],v[112:115],v[32:35]
v_mfma_f32_16x16x32_bf16 v[48:51],v[112:115],v[168:171],v[48:51]
v_mfma_f32_16x16x32_bf16 v[36:39],a[168:171],v[116:119],v[36:39]
v_mfma_f32_16x16x32_bf16 v[52:55],v[116:119],v[168:171],v[52:55]
s_waitcnt lgkmcnt(2)
v_mfma_f32_16x16x32_bf16 v[24:27],a[164:167],v[120:123],v[24:27]
ds_read_b128 v[112:115],v7 offset:8192
v_mfma_f32_16x16x32_bf16 v[40:43],v[120:123],v[164:167],v[40:43]
v_mfma_f32_16x16x32_bf16 v[28:31],a[164:167],v[124:127],v[28:31]
ds_read_b128 v[116:119],v7 offset:12288
v_mfma_f32_16x16x32_bf16 v[44:47],v[124:127],v[164:167],v[44:47]
v_mfma_f32_16x16x32_bf16 v[32:35],a[172:175],v[120:123],v[32:35]
v_mfma_f32_16x16x32_bf16 v[48:51],v[120:123],v[172:175],v[48:51]
v_mfma_f32_16x16x32_bf16 v[36:39],a[172:175],v[124:127],v[36:39]
v_mfma_f32_16x16x32_bf16 v[52:55],v[124:127],v[172:175],v[52:55]
s_waitcnt vmcnt(2)
s_barrier
s_waitcnt lgkmcnt(2)
v_mfma_f32_16x16x32_bf16 v[24:27],a[176:179],v[104:107],v[24:27]
ds_read_b128 v[120:123],v4 offset:16384
v_mfma_f32_16x16x32_bf16 v[40:43],v[104:107],v[176:179],v[40:43]
v_mfma_f32_16x16x32_bf16 v[28:31],a[176:179],v[108:111],v[28:31]
ds_read_b128 v[124:127],v4 offset:20480
v_mfma_f32_16x16x32_bf16 v[44:47],v[108:111],v[176:179],v[44:47]
v_mfma_f32_16x16x32_bf16 v[32:35],a[184:187],v[104:107],v[32:35]
v_mfma_f32_16x16x32_bf16 v[48:51],v[104:107],v[184:187],v[48:51]
v_mfma_f32_16x16x32_bf16 v[36:39],a[184:187],v[108:111],v[36:39]
v_mfma_f32_16x16x32_bf16 v[52:55],v[108:111],v[184:187],v[52:55]
s_waitcnt lgkmcnt(2)
v_mfma_f32_16x16x32_bf16 v[24:27],a[180:183],v[112:115],v[24:27]
ds_read_b128 v[104:107],v5 offset:16384
v_mfma_f32_16x16x32_bf16 v[40:43],v[112:115],v[180:183],v[40:43]
v_mfma_f32_16x16x32_bf16 v[28:31],a[180:183],v[116:119],v[28:31]
ds_read_b128 v[108:111],v5 offset:20480
v_mfma_f32_16x16x32_bf16 v[44:47],v[116:119],v[180:183],v[44:47]
v_mfma_f32_16x16x32_bf16 v[32:35],a[188:191],v[112:115],v[32:35]
v_mfma_f32_16x16x32_bf16 v[48:51],v[112:115],v[188:191],v[48:51]
v_mfma_f32_16x16x32_bf16 v[36:39],a[188:191],v[116:119],v[36:39]
v_mfma_f32_16x16x32_bf16 v[52:55],v[116:119],v[188:191],v[52:55]
s_waitcnt lgkmcnt(2)
v_mfma_f32_16x16x32_bf16 v[24:27],a[192:195],v[120:123],v[24:27]
ds_read_b128 v[112:115],v6 offset:16384
v_mfma_f32_16x16x32_bf16 v[40:43],v[120:123],v[192:195],v[40:43]
v_mfma_f32_16x16x32_bf16 v[28:31],a[192:195],v[124:127],v[28:31]
ds_read_b128 v[116:119],v6 offset:20480
v_mfma_f32_16x16x32_bf16 v[44:47],v[124:127],v[192:195],v[44:47]
v_mfma_f32_16x16x32_bf16 v[32:35],a[200:203],v[120:123],v[32:35]
v_mfma_f32_16x16x32_bf16 v[48:51],v[120:123],v[200:203],v[48:51]
v_mfma_f32_16x16x32_bf16 v[36:39],a[200:203],v[124:127],v[36:39]
v_mfma_f32_16x16x32_bf16 v[52:55],v[124:127],v[200:203],v[52:55]
s_waitcnt lgkmcnt(2)
v_mfma_f32_16x16x32_bf16 v[24:27],a[196:199],v[104:107],v[24:27]
ds_read_b128 v[120:123],v7 offset:16384
v_mfma_f32_16x16x32_bf16 v[40:43],v[104:107],v[196:199],v[40:43]
v_mfma_f32_16x16x32_bf16 v[28:31],a[196:199],v[108:111],v[28:31]
ds_read_b128 v[124:127],v7 offset:20480
v_mfma_f32_16x16x32_bf16 v[44:47],v[108:111],v[196:199],v[44:47]
v_mfma_f32_16x16x32_bf16 v[32:35],a[204:207],v[104:107],v[32:35]
v_mfma_f32_16x16x32_bf16 v[48:51],v[104:107],v[204:207],v[48:51]
v_mfma_f32_16x16x32_bf16 v[36:39],a[204:207],v[108:111],v[36:39]
v_mfma_f32_16x16x32_bf16 v[52:55],v[108:111],v[204:207],v[52:55]
s_waitcnt vmcnt(0)
s_barrier
s_waitcnt lgkmcnt(2)
v_mfma_f32_16x16x32_bf16 v[24:27],a[208:211],v[112:115],v[24:27]
ds_read_b128 v[104:107],v4 offset:24576
v_mfma_f32_16x16x32_bf16 v[40:43],v[112:115],v[208:211],v[40:43]
v_mfma_f32_16x16x32_bf16 v[28:31],a[208:211],v[116:119],v[28:31]
ds_read_b128 v[108:111],v4 offset:28672
v_mfma_f32_16x16x32_bf16 v[44:47],v[116:119],v[208:211],v[44:47]
v_mfma_f32_16x16x32_bf16 v[32:35],a[216:219],v[112:115],v[32:35]
v_mfma_f32_16x16x32_bf16 v[48:51],v[112:115],v[216:219],v[48:51]
v_mfma_f32_16x16x32_bf16 v[36:39],a[216:219],v[116:119],v[36:39]
v_mfma_f32_16x16x32_bf16 v[52:55],v[116:119],v[216:219],v[52:55]
s_waitcnt lgkmcnt(2)
v_mfma_f32_16x16x32_bf16 v[24:27],a[212:215],v[120:123],v[24:27]
ds_read_b128 v[112:115],v5 offset:24576
v_mfma_f32_16x16x32_bf16 v[40:43],v[120:123],v[212:215],v[40:43]
v_mfma_f32_16x16x32_bf16 v[28:31],a[212:215],v[124:127],v[28:31]
ds_read_b128 v[116:119],v5 offset:28672
v_mfma_f32_16x16x32_bf16 v[44:47],v[124:127],v[212:215],v[44:47]
v_mfma_f32_16x16x32_bf16 v[32:35],a[220:223],v[120:123],v[32:35]
v_mfma_f32_16x16x32_bf16 v[48:51],v[120:123],v[220:223],v[48:51]
v_mfma_f32_16x16x32_bf16 v[36:39],a[220:223],v[124:127],v[36:39]
v_mfma_f32_16x16x32_bf16 v[52:55],v[124:127],v[220:223],v[52:55]
s_waitcnt lgkmcnt(2)
v_mfma_f32_16x16x32_bf16 v[24:27],a[224:227],v[104:107],v[24:27]
ds_read_b128 v[120:123],v6 offset:24576
v_mfma_f32_16x16x32_bf16 v[40:43],v[104:107],v[224:227],v[40:43]
v_mfma_f32_16x16x32_bf16 v[28:31],a[224:227],v[108:111],v[28:31]
ds_read_b128 v[124:127],v6 offset:28672
v_mfma_f32_16x16x32_bf16 v[44:47],v[108:111],v[224:227],v[44:47]
v_mfma_f32_16x16x32_bf16 v[32:35],a[232:235],v[104:107],v[32:35]
v_mfma_f32_16x16x32_bf16 v[48:51],v[104:107],v[232:235],v[48:51]
v_mfma_f32_16x16x32_bf16 v[36:39],a[232:235],v[108:111],v[36:39]
v_mfma_f32_16x16x32_bf16 v[52:55],v[108:111],v[232:235],v[52:55]
s_waitcnt lgkmcnt(2)
v_mfma_f32_16x16x32_bf16 v[24:27],a[228:231],v[112:115],v[24:27]
ds_read_b128 v[104:107],v7 offset:24576
v_mfma_f32_16x16x32_bf16 v[40:43],v[112:115],v[228:231],v[40:43]
v_mfma_f32_16x16x32_bf16 v[28:31],a[228:231],v[116:119],v[28:31]
ds_read_b128 v[108:111],v7 offset:28672
v_mfma_f32_16x16x32_bf16 v[44:47],v[116:119],v[228:231],v[44:47]
v_mfma_f32_16x16x32_bf16 v[32:35],a[236:239],v[112:115],v[32:35]
v_mfma_f32_16x16x32_bf16 v[48:51],v[112:115],v[236:239],v[48:51]
v_mfma_f32_16x16x32_bf16 v[36:39],a[236:239],v[116:119],v[36:39]
v_mfma_f32_16x16x32_bf16 v[52:55],v[116:119],v[236:239],v[52:55]
s_waitcnt lgkmcnt(2)
v_mfma_f32_16x16x32_bf16 v[24:27],a[240:243],v[120:123],v[24:27]
ds_read_b128 v[112:115],v4 offset:0
v_mfma_f32_16x16x32_bf16 v[40:43],v[120:123],v[240:243],v[40:43]
v_mfma_f32_16x16x32_bf16 v[28:31],a[240:243],v[124:127],v[28:31]
ds_read_b128 v[116:119],v4 offset:4096
v_mfma_f32_16x16x32_bf16 v[44:47],v[124:127],v[240:243],v[44:47]
v_mfma_f32_16x16x32_bf16 v[32:35],a[248:251],v[120:123],v[32:35]
v_mfma_f32_16x16x32_bf16 v[48:51],v[120:123],v[248:251],v[48:51]
v_mfma_f32_16x16x32_bf16 v[36:39],a[248:251],v[124:127],v[36:39]
v_mfma_f32_16x16x32_bf16 v[52:55],v[124:127],v[248:251],v[52:55]
s_waitcnt lgkmcnt(2)
v_mfma_f32_16x16x32_bf16 v[24:27],a[244:247],v[104:107],v[24:27]
ds_read_b128 v[120:123],v5 offset:0
v_mfma_f32_16x16x32_bf16 v[40:43],v[104:107],v[244:247],v[40:43]
v_mfma_f32_16x16x32_bf16 v[28:31],a[244:247],v[108:111],v[28:31]
ds_read_b128 v[124:127],v5 offset:4096
v_mfma_f32_16x16x32_bf16 v[44:47],v[108:111],v[244:247],v[44:47]
v_mfma_f32_16x16x32_bf16 v[32:35],a[252:255],v[104:107],v[32:35]
v_mfma_f32_16x16x32_bf16 v[48:51],v[104:107],v[252:255],v[48:51]
v_mfma_f32_16x16x32_bf16 v[36:39],a[252:255],v[108:111],v[36:39]
v_mfma_f32_16x16x32_bf16 v[52:55],v[108:111],v[252:255],v[52:55]
s_waitcnt lgkmcnt(2)
v_mfma_f32_16x16x32_bf16 v[88:91],a[0:3],v[112:115],0
ds_read_b128 v[104:107],v6 offset:0
v_mfma_f32_16x16x32_bf16 v[92:95],a[0:3],v[116:119],0
v_mfma_f32_16x16x32_bf16 v[96:99],a[8:11],v[112:115],0
ds_read_b128 v[108:111],v6 offset:4096
v_mfma_f32_16x16x32_bf16 v[100:103],a[8:11],v[116:119],0
s_waitcnt lgkmcnt(2)
v_mfma_f32_16x16x32_bf16 v[88:91],a[4:7],v[120:123],v[88:91]
ds_read_b128 v[112:115],v7 offset:0
v_mfma_f32_16x16x32_bf16 v[92:95],a[4:7],v[124:127],v[92:95]
v_cvt_pk_bf16_f32 v56,v24,v32
v_cvt_pk_bf16_f32 v57,v25,v33
v_mfma_f32_16x16x32_bf16 v[96:99],a[12:15],v[120:123],v[96:99]
ds_read_b128 v[116:119],v7 offset:4096
v_mfma_f32_16x16x32_bf16 v[100:103],a[12:15],v[124:127],v[100:103]
v_cvt_pk_bf16_f32 v58,v26,v34
v_cvt_pk_bf16_f32 v59,v27,v35
s_waitcnt lgkmcnt(2)
v_mfma_f32_16x16x32_bf16 v[88:91],a[16:19],v[104:107],v[88:91]
ds_read_b128 v[120:123],v4 offset:8192
v_mfma_f32_16x16x32_bf16 v[92:95],a[16:19],v[108:111],v[92:95]
buffer_store_dwordx4 v[56:59],v0,s[8:11],s61 offen sc1
v_cvt_pk_bf16_f32 v60,v28,v36
v_mfma_f32_16x16x32_bf16 v[96:99],a[24:27],v[104:107],v[96:99]
ds_read_b128 v[124:127],v4 offset:12288
v_mfma_f32_16x16x32_bf16 v[100:103],a[24:27],v[108:111],v[100:103]
v_cvt_pk_bf16_f32 v61,v29,v37
v_cvt_pk_bf16_f32 v62,v30,v38
s_waitcnt lgkmcnt(2)
v_mfma_f32_16x16x32_bf16 v[88:91],a[20:23],v[112:115],v[88:91]
ds_read_b128 v[104:107],v5 offset:8192
v_mfma_f32_16x16x32_bf16 v[92:95],a[20:23],v[116:119],v[92:95]
v_cvt_pk_bf16_f32 v63,v31,v39
buffer_store_dwordx4 v[60:63],v0,s[8:11],s62 offen sc1
v_mfma_f32_16x16x32_bf16 v[96:99],a[28:31],v[112:115],v[96:99]
ds_read_b128 v[108:111],v5 offset:12288
v_mfma_f32_16x16x32_bf16 v[100:103],a[28:31],v[116:119],v[100:103]
v_cvt_pk_bf16_f32 v64,v40,v41
v_cvt_pk_bf16_f32 v65,v42,v43
s_waitcnt lgkmcnt(2)
v_mfma_f32_16x16x32_bf16 v[88:91],a[32:35],v[120:123],v[88:91]
ds_read_b128 v[112:115],v6 offset:8192
v_mfma_f32_16x16x32_bf16 v[92:95],a[32:35],v[124:127],v[92:95]
v_cvt_pk_bf16_f32 v66,v44,v45
v_cvt_pk_bf16_f32 v67,v46,v47
v_mfma_f32_16x16x32_bf16 v[96:99],a[40:43],v[120:123],v[96:99]
ds_read_b128 v[116:119],v6 offset:12288
v_mfma_f32_16x16x32_bf16 v[100:103],a[40:43],v[124:127],v[100:103]
buffer_store_dwordx4 v[64:67],v0,s[8:11],s65 offen offset:0 sc1
v_cvt_pk_bf16_f32 v68,v48,v49
s_waitcnt lgkmcnt(2)
v_mfma_f32_16x16x32_bf16 v[88:91],a[36:39],v[104:107],v[88:91]
ds_read_b128 v[120:123],v7 offset:8192
v_mfma_f32_16x16x32_bf16 v[92:95],a[36:39],v[108:111],v[92:95]
v_cvt_pk_bf16_f32 v69,v50,v51
v_cvt_pk_bf16_f32 v70,v52,v53
v_mfma_f32_16x16x32_bf16 v[96:99],a[44:47],v[104:107],v[96:99]
ds_read_b128 v[124:127],v7 offset:12288
v_mfma_f32_16x16x32_bf16 v[100:103],a[44:47],v[108:111],v[100:103]
v_cvt_pk_bf16_f32 v71,v54,v55
buffer_store_dwordx4 v[68:71],v0,s[8:11],s65 offen offset:1024 sc1
s_waitcnt lgkmcnt(2)
v_mfma_f32_16x16x32_bf16 v[88:91],a[48:51],v[112:115],v[88:91]
ds_read_b128 v[104:107],v4 offset:16384
v_mfma_f32_16x16x32_bf16 v[92:95],a[48:51],v[116:119],v[92:95]
v_mfma_f32_16x16x32_bf16 v[96:99],a[56:59],v[112:115],v[96:99]
ds_read_b128 v[108:111],v4 offset:20480
v_mfma_f32_16x16x32_bf16 v[100:103],a[56:59],v[116:119],v[100:103]
s_waitcnt lgkmcnt(2)
v_mfma_f32_16x16x32_bf16 v[88:91],a[52:55],v[120:123],v[88:91]
ds_read_b128 v[112:115],v5 offset:16384
v_mfma_f32_16x16x32_bf16 v[92:95],a[52:55],v[124:127],v[92:95]
v_mfma_f32_16x16x32_bf16 v[96:99],a[60:63],v[120:123],v[96:99]
ds_read_b128 v[116:119],v5 offset:20480
v_mfma_f32_16x16x32_bf16 v[100:103],a[60:63],v[124:127],v[100:103]
s_waitcnt lgkmcnt(2)
v_mfma_f32_16x16x32_bf16 v[88:91],a[64:67],v[104:107],v[88:91]
ds_read_b128 v[120:123],v6 offset:16384
v_mfma_f32_16x16x32_bf16 v[92:95],a[64:67],v[108:111],v[92:95]
v_mfma_f32_16x16x32_bf16 v[96:99],a[72:75],v[104:107],v[96:99]
ds_read_b128 v[124:127],v6 offset:20480
v_mfma_f32_16x16x32_bf16 v[100:103],a[72:75],v[108:111],v[100:103]
s_waitcnt lgkmcnt(2)
v_mfma_f32_16x16x32_bf16 v[88:91],a[68:71],v[112:115],v[88:91]
ds_read_b128 v[104:107],v7 offset:16384
v_mfma_f32_16x16x32_bf16 v[92:95],a[68:71],v[116:119],v[92:95]
v_mfma_f32_16x16x32_bf16 v[96:99],a[76:79],v[112:115],v[96:99]
ds_read_b128 v[108:111],v7 offset:20480
v_mfma_f32_16x16x32_bf16 v[100:103],a[76:79],v[116:119],v[100:103]
s_waitcnt lgkmcnt(2)
v_mfma_f32_16x16x32_bf16 v[88:91],a[80:83],v[120:123],v[88:91]
ds_read_b128 v[112:115],v4 offset:24576
v_mfma_f32_16x16x32_bf16 v[92:95],a[80:83],v[124:127],v[92:95]
v_mfma_f32_16x16x32_bf16 v[96:99],a[88:91],v[120:123],v[96:99]
ds_read_b128 v[116:119],v4 offset:28672
v_mfma_f32_16x16x32_bf16 v[100:103],a[88:91],v[124:127],v[100:103]
s_waitcnt lgkmcnt(2)
v_mfma_f32_16x16x32_bf16 v[88:91],a[84:87],v[104:107],v[88:91]
ds_read_b128 v[120:123],v5 offset:24576
v_mfma_f32_16x16x32_bf16 v[92:95],a[84:87],v[108:111],v[92:95]
v_mfma_f32_16x16x32_bf16 v[96:99],a[92:95],v[104:107],v[96:99]
ds_read_b128 v[124:127],v5 offset:28672
v_mfma_f32_16x16x32_bf16 v[100:103],a[92:95],v[108:111],v[100:103]
s_waitcnt lgkmcnt(2)
v_mfma_f32_16x16x32_bf16 v[88:91],a[96:99],v[112:115],v[88:91]
ds_read_b128 v[104:107],v6 offset:24576
v_mfma_f32_16x16x32_bf16 v[92:95],a[96:99],v[116:119],v[92:95]
v_mfma_f32_16x16x32_bf16 v[96:99],a[104:107],v[112:115],v[96:99]
ds_read_b128 v[108:111],v6 offset:28672
v_mfma_f32_16x16x32_bf16 v[100:103],a[104:107],v[116:119],v[100:103]
s_waitcnt lgkmcnt(2)
v_mfma_f32_16x16x32_bf16 v[88:91],a[100:103],v[120:123],v[88:91]
ds_read_b128 v[112:115],v7 offset:24576
v_mfma_f32_16x16x32_bf16 v[92:95],a[100:103],v[124:127],v[92:95]
v_mfma_f32_16x16x32_bf16 v[96:99],a[108:111],v[120:123],v[96:99]
ds_read_b128 v[116:119],v7 offset:28672
v_mfma_f32_16x16x32_bf16 v[100:103],a[108:111],v[124:127],v[100:103]
s_waitcnt lgkmcnt(2)
v_mfma_f32_16x16x32_bf16 v[88:91],a[112:115],v[104:107],v[88:91]
v_mfma_f32_16x16x32_bf16 v[92:95],a[112:115],v[108:111],v[92:95]
v_mfma_f32_16x16x32_bf16 v[96:99],a[120:123],v[104:107],v[96:99]
v_mfma_f32_16x16x32_bf16 v[100:103],a[120:123],v[108:111],v[100:103]
s_waitcnt lgkmcnt(0)
v_mfma_f32_16x16x32_bf16 v[88:91],a[116:119],v[112:115],v[88:91]
v_mfma_f32_16x16x32_bf16 v[92:95],a[116:119],v[116:119],v[92:95]
v_mfma_f32_16x16x32_bf16 v[96:99],a[124:127],v[112:115],v[96:99]
v_mfma_f32_16x16x32_bf16 v[100:103],a[124:127],v[116:119],v[100:103]
s_nop 3
v_cvt_pk_bf16_f32 v104,v88,v96
v_cvt_pk_bf16_f32 v105,v89,v97
v_cvt_pk_bf16_f32 v106,v90,v98
v_cvt_pk_bf16_f32 v107,v91,v99
v_cvt_pk_bf16_f32 v108,v92,v100
v_cvt_pk_bf16_f32 v109,v93,v101
v_cvt_pk_bf16_f32 v110,v94,v102
v_cvt_pk_bf16_f32 v111,v95,v103
buffer_store_dwordx4 v[104:107],v0,s[8:11],s63 offen sc1
buffer_store_dwordx4 v[108:111],v0,s[8:11],s64 offen sc1
s_waitcnt vmcnt(6)
s_barrier
s_add_u32 m0,s50,131072
s_nop 0
buffer_load_dwordx4 v20,s[8:11],s70 offen offset:0 sc1 lds
s_add_u32 m0,s50,135168
s_nop 0
buffer_load_dwordx4 v20,s[8:11],s71 offen offset:0 sc1 lds
s_add_u32 m0,s50,139008
s_nop 0
buffer_load_dwordx4 v20,s[8:11],s70 offen offset:256 sc1 lds
s_add_u32 m0,s50,143104
s_nop 0
buffer_load_dwordx4 v20,s[8:11],s71 offen offset:256 sc1 lds
s_add_u32 m0,s50,146944
s_nop 0
buffer_load_dwordx4 v20,s[8:11],s70 offen offset:512 sc1 lds
s_add_u32 m0,s50,151040
s_nop 0
buffer_load_dwordx4 v20,s[8:11],s71 offen offset:512 sc1 lds
s_lshl_b32 s59,s51,13
s_lshl2_add_u32 s59,s47,s59
s_add_u32 s59,s59,10487680
s_waitcnt vmcnt(0)
s_barrier
s_or_b32 s59,s59,s52
buffer_store_dword v17,off,s[8:11],s59 sc1
s_mov_b32 s72,0x80000000
s_mov_b32 s86,0
s_mov_b32 s19,1
s_mov_b32 s18,0
s_cmp_lt_u32 s31,64
s_cbranch_scc1 L_mo_22
L_mo_35:
s_mov_b32 s51,64
s_and_b32 s61,s54,0x7ff
s_sub_u32 s61,2047,s61
s_lshr_b32 s61,s61,5
s_cmp_lg_u32 s46,0
s_cbranch_scc1 L_mw_46
s_mov_b32 s59,11018240
v_lshlrev_b32 v2,2,v1
L_fp_47:
s_sleep 2
buffer_load_dword v3,v2,s[8:11],s59 offen sc1
s_sub_u32 s49,s49,1
s_cbranch_scc1 L_abort
s_waitcnt vmcnt(0)
v_cmp_eq_u32 vcc,0,v3
s_cbranch_vccnz L_fp_47
v_cmp_le_u32 vcc,s61,v1
s_nop 1
v_cndmask_b32 v2,1,2,vcc
v_cmp_ne_u32 s[84:85],v2,v3
s_lshl_b32 s56,s47,1
s_lshr_b64 s[20:21],s[84:85],s56
v_lshrrev_b32 v2,5,v1
v_lshrrev_b32 v3,v2,s20
v_and_b32 v3,1,v3
v_mul_u32_u24 v3,768,v3
v_lshlrev_b32 v2,13,v2
v_sub_u32 v2,v2,v3
v_and_b32 v3,31,v1
v_lshl_add_u32 v2,v3,2,v2
v_add_u32 v2,1536,v2
s_lshl_b32 s59,s47,14
s_add_u32 s59,s59,10485760
L_fp_48:
s_sleep 1
buffer_load_dword v3,v2,s[8:11],s59 offen sc1
s_sub_u32 s49,s49,1
s_cbranch_scc1 L_abort
s_waitcnt vmcnt(0)
v_cmp_eq_u32 vcc,0,v3
s_cbranch_vccnz L_fp_48
v_max_u32_dpp v3,v3,v3 row_ror:8 row_mask:0xf bank_mask:0xf
s_nop 1
v_max_u32_dpp v3,v3,v3 row_ror:4 row_mask:0xf bank_mask:0xf
s_nop 1
v_max_u32_dpp v3,v3,v3 row_ror:2 row_mask:0xf bank_mask:0xf
s_nop 1
v_max_u32_dpp v3,v3,v3 row_ror:1 row_mask:0xf bank_mask:0xf
v_mov_b32 v2,v3
s_nop 1
v_permlane16_swap_b32 v3,v2
v_max_u32 v3,v3,v2
v_mov_b32 v2,v3
s_nop 1
v_permlane32_swap_b32 v3,v2
v_max_u32 v3,v3,v2
s_lshl_b32 s59,s51,13
s_lshl2_add_u32 s59,s47,s59
s_add_u32 s59,s59,10487424
buffer_store_dword v3,off,s[8:11],s59
L_mw_46:
s_barrier
s_lshl_b32 s59,s51,13
s_add_u32 s59,s59,10487424
v_and_b32 v124,31,v1
v_lshlrev_b32 v124,2,v124
s_branch L_ff_51
L_fw_49:
s_sleep 1
L_ff_51:
buffer_load_dword v125,v124,s[8:11],s59 offen sc1
s_sub_u32 s49,s49,1
s_cbranch_scc1 L_abort
s_waitcnt vmcnt(0)
v_cmp_eq_u32 vcc,0,v125
s_cbranch_vccnz L_fw_49
v_max_u32_dpp v125,v125,v125 row_ror:8 row_mask:0xf bank_mask:0xf
s_nop 1
v_max_u32_dpp v125,v125,v125 row_ror:4 row_mask:0xf bank_mask:0xf
s_nop 1
v_max_u32_dpp v125,v125,v125 row_ror:2 row_mask:0xf bank_mask:0xf
s_nop 1
v_max_u32_dpp v125,v125,v125 row_ror:1 row_mask:0xf bank_mask:0xf
v_mov_b32 v124,v125
s_nop 1
v_permlane16_swap_b32 v125,v124
v_max_u32 v125,v125,v124
v_mov_b32 v124,v125
s_nop 1
v_permlane32_swap_b32 v125,v124
v_max_u32 v125,v125,v124
s_nop 0
v_readfirstlane_b32 s55,v125
s_and_b32 s64,s55,0x7ff
s_sub_u32 s64,2047,s64
s_lshl_b32 s56,s64,10
s_add_u32 s58,s56,6291456
buffer_load_dwordx4 v[88:91],v0,s[8:11],s58 offen sc1
s_mov_b32 s4,s38
s_mov_b32 s5,s39
s_mov_b32 s6,1835008
s_mov_b32 s7,0x20000
v_and_b32 v9,15,v1
v_lshrrev_b32 v10,4,v1
v_lshlrev_b32 v8,14,v10
v_lshl_add_u32 v8,v9,4,v8
s_lshl_b32 s59,s47,16
s_lshl_b32 s60,s46,8
s_add_u32 s59,s59,s60
buffer_load_dwordx4 v[24:27],v8,s[4:7],s59 offen offset:0
buffer_load_dwordx4 v[28:31],v8,s[4:7],s59 offen offset:1024
buffer_load_dwordx4 v[32:35],v8,s[4:7],s59 offen offset:2048
buffer_load_dwordx4 v[36:39],v8,s[4:7],s59 offen offset:3072
s_add_u32 s59,s59,4096
buffer_load_dwordx4 v[40:43],v8,s[4:7],s59 offen offset:0
buffer_load_dwordx4 v[44:47],v8,s[4:7],s59 offen offset:1024
buffer_load_dwordx4 v[48:51],v8,s[4:7],s59 offen offset:2048
buffer_load_dwordx4 v[52:55],v8,s[4:7],s59 offen offset:3072
s_add_u32 s59,s59,4096
buffer_load_dwordx4 v[56:59],v8,s[4:7],s59 offen offset:0
buffer_load_dwordx4 v[60:63],v8,s[4:7],s59 offen offset:1024
buffer_load_dwordx4 v[64:67],v8,s[4:7],s59 offen offset:2048
buffer_load_dwordx4 v[68:71],v8,s[4:7],s59 offen offset:3072
s_add_u32 s59,s59,4096
buffer_load_dwordx4 v[72:75],v8,s[4:7],s59 offen offset:0
buffer_load_dwordx4 v[76:79],v8,s[4:7],s59 offen offset:1024
buffer_load_dwordx4 v[80:83],v8,s[4:7],s59 offen offset:2048
buffer_load_dwordx4 v[84:87],v8,s[4:7],s59 offen offset:3072
v_and_b32 v124,1,v1
v_lshlrev_b32 v124,4,v124
v_mov_b32 v125,0xffff
v_lshlrev_b32 v125,v124,v125
v_lshrrev_b32 v124,1,v9
v_cmp_eq_u32 vcc,0,v124
s_nop 1
v_cndmask_b32 v12,0,v125,vcc
v_cmp_eq_u32 vcc,1,v124
s_nop 1
v_cndmask_b32 v13,0,v125,vcc
v_cmp_eq_u32 vcc,2,v124
s_nop 1
v_cndmask_b32 v14,0,v125,vcc
v_cmp_eq_u32 vcc,3,v124
s_nop 1
v_cndmask_b32 v15,0,v125,vcc
s_waitcnt vmcnt(16)
v_lshlrev_b32 v96,16,v88
v_and_b32 v97,0xffff0000,v88
v_lshlrev_b32 v98,16,v89
v_and_b32 v99,0xffff0000,v89
v_lshlrev_b32 v100,16,v90
v_and_b32 v101,0xffff0000,v90
v_lshlrev_b32 v102,16,v91
v_and_b32 v103,0xffff0000,v91
v_readfirstlane_b32 s78,v96
s_nop 1
v_pk_add_f32 v[108:109],v[96:97],s[78:79] op_sel_hi:[1,0] neg_lo:[0,1] neg_hi:[0,1]
v_pk_add_f32 v[110:111],v[98:99],s[78:79] op_sel_hi:[1,0] neg_lo:[0,1] neg_hi:[0,1]
v_pk_add_f32 v[112:113],v[100:101],s[78:79] op_sel_hi:[1,0] neg_lo:[0,1] neg_hi:[0,1]
v_pk_add_f32 v[114:115],v[102:103],s[78:79] op_sel_hi:[1,0] neg_lo:[0,1] neg_hi:[0,1]
v_pk_add_f32 v[116:117],v[108:109],v[110:111]
v_pk_mul_f32 v[118:119],v[108:109],v[108:109]
v_pk_add_f32 v[120:121],v[112:113],v[114:115]
v_pk_fma_f32 v[118:119],v[110:111],v[110:111],v[118:119]
v_pk_add_f32 v[116:117],v[116:117],v[120:121]
v_pk_fma_f32 v[118:119],v[112:113],v[112:113],v[118:119]
v_add_f32 v116,v116,v117
v_pk_fma_f32 v[118:119],v[114:115],v[114:115],v[118:119]
v_add_f32 v118,v118,v119
s_nop 1
v_permlane32_swap_b32 v116,v118
v_add_f32 v116,v116,v118
s_nop 1
v_add_f32_dpp v116,v116,v116 row_ror:8 row_mask:0xf bank_mask:0xf
s_nop 1
v_add_f32_dpp v116,v116,v116 row_ror:4 row_mask:0xf bank_mask:0xf
s_nop 1
v_add_f32_dpp v116,v116,v116 row_ror:2 row_mask:0xf bank_mask:0xf
s_nop 1
v_add_f32_dpp v116,v116,v116 row_ror:1 row_mask:0xf bank_mask:0xf
v_mov_b32 v118,v116
s_nop 1
v_permlane16_swap_b32 v116,v118
v_add_f32 v116,v116,v118
v_mul_f32 v116,0x3b000000,v116
v_mov_b32 v118,v116
s_nop 1
v_permlane32_swap_b32 v116,v118
v_fma_f32 v118,-v116,v116,v118
v_add_f32 v116,s78,v116
v_max_f32 v118,0,v118
v_cvt_pk_bf16_f32 v118,v116,v118
v_lshlrev_b32 v116,16,v118
v_and_b32 v118,0xffff0000,v118
v_add_f32 v118,0x3727c5ac,v118
v_cvt_pk_bf16_f32 v118,v118,v118
v_and_b32 v118,0xffff0000,v118
v_sqrt_f32 v118,v118
v_pk_add_f32 v[108:109],v[96:97],v[116:117] op_sel_hi:[1,0] neg_lo:[0,1] neg_hi:[0,1]
v_pk_add_f32 v[110:111],v[98:99],v[116:117] op_sel_hi:[1,0] neg_lo:[0,1] neg_hi:[0,1]
v_pk_add_f32 v[112:113],v[100:101],v[116:117] op_sel_hi:[1,0] neg_lo:[0,1] neg_hi:[0,1]
v_pk_add_f32 v[114:115],v[102:103],v[116:117] op_sel_hi:[1,0] neg_lo:[0,1] neg_hi:[0,1]
v_cvt_pk_bf16_f32 v118,v118,v118
v_and_b32 v118,0xffff0000,v118
v_rcp_f32 v118,v118
v_cvt_pk_bf16_f32 v104,v108,v109
v_cvt_pk_bf16_f32 v105,v110,v111
v_cvt_pk_bf16_f32 v106,v112,v113
v_cvt_pk_bf16_f32 v107,v114,v115
v_lshlrev_b32 v108,16,v104
v_and_b32 v109,0xffff0000,v104
v_lshlrev_b32 v110,16,v105
v_and_b32 v111,0xffff0000,v105
v_lshlrev_b32 v112,16,v106
v_and_b32 v113,0xffff0000,v106
v_lshlrev_b32 v114,16,v107
v_and_b32 v115,0xffff0000,v107
v_pk_mul_f32 v[108:109],v[108:109],v[118:119] op_sel_hi:[1,0]
v_pk_mul_f32 v[110:111],v[110:111],v[118:119] op_sel_hi:[1,0]
v_pk_mul_f32 v[112:113],v[112:113],v[118:119] op_sel_hi:[1,0]
v_pk_mul_f32 v[114:115],v[114:115],v[118:119] op_sel_hi:[1,0]
v_cvt_pk_bf16_f32 v104,v108,v109
v_cvt_pk_bf16_f32 v105,v110,v111
v_cvt_pk_bf16_f32 v106,v112,v113
v_cvt_pk_bf16_f32 v107,v114,v115
s_mov_b32 s58,0x01000100
s_mov_b32 s59,0x03020302
v_perm_b32 v88,v104,v104,s58
v_perm_b32 v89,v104,v104,s59
v_perm_b32 v90,v105,v105,s58
v_perm_b32 v91,v105,v105,s59
v_perm_b32 v92,v106,v106,s58
v_perm_b32 v93,v106,v106,s59
v_perm_b32 v94,v107,v107,s58
v_perm_b32 v95,v107,v107,s59
v_lshlrev_b32 v8,5,v1
s_lshl_b32 s58,s46,11
s_add_u32 s58,s58,139264
v_add_u32 v8,s58,v8
ds_write_b128 v8,v[88:91]
ds_write_b128 v8,v[92:95] offset:16
s_lshl_b32 s59,s46,9
s_add_u32 s59,s58,s59
v_lshlrev_b32 v8,7,v10
v_add_u32 v8,s59,v8
s_waitcnt lgkmcnt(0)
ds_read_b128 v[108:111],v18 offset:0
ds_read_b128 v[88:91],v8 offset:0
ds_read_b128 v[92:95],v8 offset:16
ds_read_b128 v[112:115],v18 offset:1024
s_waitcnt lgkmcnt(1)
v_and_b32 v124,v12,v88
v_and_b32 v125,v13,v88
v_and_b32 v126,v14,v88
v_and_b32 v127,v15,v88
s_nop 1
v_mfma_f32_16x16x32_bf16 v[116:119],v[124:127],v[108:111],0
ds_read_b128 v[108:111],v18 offset:2048
s_waitcnt lgkmcnt(1)
v_and_b32 v124,v12,v89
v_and_b32 v125,v13,v89
v_and_b32 v126,v14,v89
v_and_b32 v127,v15,v89
s_nop 1
v_mfma_f32_16x16x32_bf16 v[116:119],v[124:127],v[112:115],v[116:119]
ds_read_b128 v[112:115],v18 offset:3072
s_waitcnt lgkmcnt(1)
v_and_b32 v124,v12,v90
v_and_b32 v125,v13,v90
v_and_b32 v126,v14,v90
v_and_b32 v127,v15,v90
s_nop 1
v_mfma_f32_16x16x32_bf16 v[116:119],v[124:127],v[108:111],v[116:119]
ds_read_b128 v[108:111],v18 offset:4096
s_waitcnt lgkmcnt(1)
v_and_b32 v124,v12,v91
v_and_b32 v125,v13,v91
v_and_b32 v126,v14,v91
v_and_b32 v127,v15,v91
s_nop 1
v_mfma_f32_16x16x32_bf16 v[116:119],v[124:127],v[112:115],v[116:119]
ds_read_b128 v[112:115],v18 offset:5120
s_waitcnt lgkmcnt(1)
v_and_b32 v124,v12,v92
v_and_b32 v125,v13,v92
v_and_b32 v126,v14,v92
v_and_b32 v127,v15,v92
s_nop 1
v_mfma_f32_16x16x32_bf16 v[116:119],v[124:127],v[108:111],v[116:119]
ds_read_b128 v[108:111],v18 offset:6144
s_waitcnt lgkmcnt(1)
v_and_b32 v124,v12,v93
v_and_b32 v125,v13,v93
v_and_b32 v126,v14,v93
v_and_b32 v127,v15,v93
s_nop 1
v_mfma_f32_16x16x32_bf16 v[116:119],v[124:127],v[112:115],v[116:119]
ds_read_b128 v[112:115],v18 offset:7168
s_waitcnt lgkmcnt(1)
v_and_b32 v124,v12,v94
v_and_b32 v125,v13,v94
v_and_b32 v126,v14,v94
v_and_b32 v127,v15,v94
s_nop 1
v_mfma_f32_16x16x32_bf16 v[116:119],v[124:127],v[108:111],v[116:119]
ds_read_b128 v[108:111],v18 offset:8192
s_waitcnt lgkmcnt(1)
v_and_b32 v124,v12,v95
v_and_b32 v125,v13,v95
v_and_b32 v126,v14,v95
v_and_b32 v127,v15,v95
s_nop 1
v_mfma_f32_16x16x32_bf16 v[116:119],v[124:127],v[112:115],v[116:119]
ds_read_b128 v[88:91],v8 offset:32
ds_read_b128 v[92:95],v8 offset:48
ds_read_b128 v[112:115],v18 offset:9216
s_waitcnt lgkmcnt(1)
v_and_b32 v124,v12,v88
v_and_b32 v125,v13,v88
v_and_b32 v126,v14,v88
v_and_b32 v127,v15,v88
s_nop 1
v_mfma_f32_16x16x32_bf16 v[116:119],v[124:127],v[108:111],v[116:119]
ds_read_b128 v[108:111],v18 offset:10240
s_waitcnt lgkmcnt(1)
v_and_b32 v124,v12,v89
v_and_b32 v125,v13,v89
v_and_b32 v126,v14,v89
v_and_b32 v127,v15,v89
s_nop 1
v_mfma_f32_16x16x32_bf16 v[116:119],v[124:127],v[112:115],v[116:119]
ds_read_b128 v[112:115],v18 offset:11264
s_waitcnt lgkmcnt(1)
v_and_b32 v124,v12,v90
v_and_b32 v125,v13,v90
v_and_b32 v126,v14,v90
v_and_b32 v127,v15,v90
s_nop 1
v_mfma_f32_16x16x32_bf16 v[116:119],v[124:127],v[108:111],v[116:119]
ds_read_b128 v[108:111],v18 offset:12288
s_waitcnt lgkmcnt(1)
v_and_b32 v124,v12,v91
v_and_b32 v125,v13,v91
v_and_b32 v126,v14,v91
v_and_b32 v127,v15,v91
s_nop 1
v_mfma_f32_16x16x32_bf16 v[116:119],v[124:127],v[112:115],v[116:119]
ds_read_b128 v[112:115],v18 offset:13312
s_waitcnt lgkmcnt(1)
v_and_b32 v124,v12,v92
v_and_b32 v125,v13,v92
v_and_b32 v126,v14,v92
v_and_b32 v127,v15,v92
s_nop 1
v_mfma_f32_16x16x32_bf16 v[116:119],v[124:127],v[108:111],v[116:119]
ds_read_b128 v[108:111],v18 offset:14336
s_waitcnt lgkmcnt(1)
v_and_b32 v124,v12,v93
v_and_b32 v125,v13,v93
v_and_b32 v126,v14,v93
v_and_b32 v127,v15,v93
s_nop 1
v_mfma_f32_16x16x32_bf16 v[116:119],v[124:127],v[112:115],v[116:119]
ds_read_b128 v[112:115],v18 offset:15360
s_waitcnt lgkmcnt(1)
v_and_b32 v124,v12,v94
v_and_b32 v125,v13,v94
v_and_b32 v126,v14,v94
v_and_b32 v127,v15,v94
s_nop 1
v_mfma_f32_16x16x32_bf16 v[116:119],v[124:127],v[108:111],v[116:119]
ds_read_b128 v[108:111],v18 offset:16384
s_waitcnt lgkmcnt(1)
v_and_b32 v124,v12,v95
v_and_b32 v125,v13,v95
v_and_b32 v126,v14,v95
v_and_b32 v127,v15,v95
s_nop 1
v_mfma_f32_16x16x32_bf16 v[116:119],v[124:127],v[112:115],v[116:119]
ds_read_b128 v[88:91],v8 offset:64
ds_read_b128 v[92:95],v8 offset:80
ds_read_b128 v[112:115],v18 offset:17408
s_waitcnt lgkmcnt(1)
v_and_b32 v124,v12,v88
v_and_b32 v125,v13,v88
v_and_b32 v126,v14,v88
v_and_b32 v127,v15,v88
s_nop 1
v_mfma_f32_16x16x32_bf16 v[116:119],v[124:127],v[108:111],v[116:119]
ds_read_b128 v[108:111],v18 offset:18432
s_waitcnt lgkmcnt(1)
v_and_b32 v124,v12,v89
v_and_b32 v125,v13,v89
v_and_b32 v126,v14,v89
v_and_b32 v127,v15,v89
s_nop 1
v_mfma_f32_16x16x32_bf16 v[116:119],v[124:127],v[112:115],v[116:119]
ds_read_b128 v[112:115],v18 offset:19456
s_waitcnt lgkmcnt(1)
v_and_b32 v124,v12,v90
v_and_b32 v125,v13,v90
v_and_b32 v126,v14,v90
v_and_b32 v127,v15,v90
s_nop 1
v_mfma_f32_16x16x32_bf16 v[116:119],v[124:127],v[108:111],v[116:119]
ds_read_b128 v[108:111],v18 offset:20480
s_waitcnt lgkmcnt(1)
v_and_b32 v124,v12,v91
v_and_b32 v125,v13,v91
v_and_b32 v126,v14,v91
v_and_b32 v127,v15,v91
s_nop 1
v_mfma_f32_16x16x32_bf16 v[116:119],v[124:127],v[112:115],v[116:119]
ds_read_b128 v[112:115],v18 offset:21504
s_waitcnt lgkmcnt(1)
v_and_b32 v124,v12,v92
v_and_b32 v125,v13,v92
v_and_b32 v126,v14,v92
v_and_b32 v127,v15,v92
s_nop 1
v_mfma_f32_16x16x32_bf16 v[116:119],v[124:127],v[108:111],v[116:119]
ds_read_b128 v[108:111],v18 offset:22528
s_waitcnt lgkmcnt(1)
v_and_b32 v124,v12,v93
v_and_b32 v125,v13,v93
v_and_b32 v126,v14,v93
v_and_b32 v127,v15,v93
s_nop 1
v_mfma_f32_16x16x32_bf16 v[116:119],v[124:127],v[112:115],v[116:119]
ds_read_b128 v[112:115],v18 offset:23552
s_waitcnt lgkmcnt(1)
v_and_b32 v124,v12,v94
v_and_b32 v125,v13,v94
v_and_b32 v126,v14,v94
v_and_b32 v127,v15,v94
s_nop 1
v_mfma_f32_16x16x32_bf16 v[116:119],v[124:127],v[108:111],v[116:119]
ds_read_b128 v[108:111],v18 offset:24576
s_waitcnt lgkmcnt(1)
v_and_b32 v124,v12,v95
v_and_b32 v125,v13,v95
v_and_b32 v126,v14,v95
v_and_b32 v127,v15,v95
s_nop 1
v_mfma_f32_16x16x32_bf16 v[116:119],v[124:127],v[112:115],v[116:119]
ds_read_b128 v[88:91],v8 offset:96
ds_read_b128 v[92:95],v8 offset:112
ds_read_b128 v[112:115],v18 offset:25600
s_waitcnt lgkmcnt(1)
v_and_b32 v124,v12,v88
v_and_b32 v125,v13,v88
v_and_b32 v126,v14,v88
v_and_b32 v127,v15,v88
s_nop 1
v_mfma_f32_16x16x32_bf16 v[116:119],v[124:127],v[108:111],v[116:119]
ds_read_b128 v[108:111],v18 offset:26624
s_waitcnt lgkmcnt(1)
v_and_b32 v124,v12,v89
v_and_b32 v125,v13,v89
v_and_b32 v126,v14,v89
v_and_b32 v127,v15,v89
s_nop 1
v_mfma_f32_16x16x32_bf16 v[116:119],v[124:127],v[112:115],v[116:119]
ds_read_b128 v[112:115],v18 offset:27648
s_waitcnt lgkmcnt(1)
v_and_b32 v124,v12,v90
v_and_b32 v125,v13,v90
v_and_b32 v126,v14,v90
v_and_b32 v127,v15,v90
s_nop 1
v_mfma_f32_16x16x32_bf16 v[116:119],v[124:127],v[108:111],v[116:119]
ds_read_b128 v[108:111],v18 offset:28672
s_waitcnt lgkmcnt(1)
v_and_b32 v124,v12,v91
v_and_b32 v125,v13,v91
v_and_b32 v126,v14,v91
v_and_b32 v127,v15,v91
s_nop 1
v_mfma_f32_16x16x32_bf16 v[116:119],v[124:127],v[112:115],v[116:119]
ds_read_b128 v[112:115],v18 offset:29696
s_waitcnt lgkmcnt(1)
v_and_b32 v124,v12,v92
v_and_b32 v125,v13,v92
v_and_b32 v126,v14,v92
v_and_b32 v127,v15,v92
s_nop 1
v_mfma_f32_16x16x32_bf16 v[116:119],v[124:127],v[108:111],v[116:119]
ds_read_b128 v[108:111],v18 offset:30720
s_waitcnt lgkmcnt(1)
v_and_b32 v124,v12,v93
v_and_b32 v125,v13,v93
v_and_b32 v126,v14,v93
v_and_b32 v127,v15,v93
s_nop 1
v_mfma_f32_16x16x32_bf16 v[116:119],v[124:127],v[112:115],v[116:119]
ds_read_b128 v[112:115],v18 offset:31744
s_waitcnt lgkmcnt(1)
v_and_b32 v124,v12,v94
v_and_b32 v125,v13,v94
v_and_b32 v126,v14,v94
v_and_b32 v127,v15,v94
s_nop 1
v_mfma_f32_16x16x32_bf16 v[116:119],v[124:127],v[108:111],v[116:119]
s_waitcnt lgkmcnt(0)
v_and_b32 v124,v12,v95
v_and_b32 v125,v13,v95
v_and_b32 v126,v14,v95
v_and_b32 v127,v15,v95
s_nop 1
v_mfma_f32_16x16x32_bf16 v[116:119],v[124:127],v[112:115],v[116:119]
v_lshlrev_b32 v8,5,v9
v_and_b32 v124,1,v10
v_lshl_add_u32 v8,v124,4,v8
v_lshrrev_b32 v124,1,v10
v_lshl_add_u32 v8,v124,11,v8
s_lshl_b32 s60,s46,9
s_add_u32 s60,s60,147456
v_add_u32 v8,s60,v8
ds_write_b128 v8,v[116:119]
v_lshlrev_b32 v8,2,v1
v_add_u32 v8,147456,v8
s_waitcnt lgkmcnt(0)
s_barrier
ds_read2st64_b32 v[88:89],v8 offset0:0 offset1:1
ds_read2st64_b32 v[90:91],v8 offset0:2 offset1:3
ds_read2st64_b32 v[92:93],v8 offset0:4 offset1:5
ds_read2st64_b32 v[94:95],v8 offset0:6 offset1:7
s_waitcnt lgkmcnt(0)
v_pk_add_f32 v[88:89],v[88:89],v[90:91]
v_pk_add_f32 v[92:93],v[92:93],v[94:95]
v_pk_add_f32 v[88:89],v[88:89],v[92:93]
v_cvt_pk_bf16_f32 v88,v88,v88
v_and_b32 v88,0xffff0000,v88
v_cvt_pk_bf16_f32 v89,v89,v89
v_and_b32 v89,0xffff0000,v89
v_mul_f32 v90,0xbfb8aa3b,v88
v_exp_f32 v90,v90
s_nop 0
v_add_f32 v90,1.0,v90
v_rcp_f32 v90,v90
s_nop 0
v_mul_f32 v88,v88,v90
v_cvt_pk_bf16_f32 v88,v88,v88
v_and_b32 v88,0xffff0000,v88
v_mul_f32 v88,v88,v89
v_cvt_pk_bf16_f32 v88,v88,v88
v_lshlrev_b32 v8,2,v1
v_add_u32 v8,s58,v8
ds_write_b32 v8,v88
v_lshlrev_b32 v8,6,v10
v_add_u32 v8,s58,v8
s_waitcnt lgkmcnt(0)
ds_read_b128 v[88:91],v8
ds_read_b128 v[92:95],v8 offset:16
ds_read_b128 v[108:111],v8 offset:32
ds_read_b128 v[112:115],v8 offset:48
s_waitcnt vmcnt(0) lgkmcnt(0)
v_and_b32 v124,v12,v88
v_and_b32 v125,v13,v88
v_and_b32 v126,v14,v88
v_and_b32 v127,v15,v88
s_nop 1
v_mfma_f32_16x16x32_bf16 v[116:119],v[124:127],v[24:27],0
v_and_b32 v124,v12,v89
v_and_b32 v125,v13,v89
v_and_b32 v126,v14,v89
v_and_b32 v127,v15,v89
s_nop 1
v_mfma_f32_16x16x32_bf16 v[116:119],v[124:127],v[28:31],v[116:119]
v_and_b32 v124,v12,v90
v_and_b32 v125,v13,v90
v_and_b32 v126,v14,v90
v_and_b32 v127,v15,v90
s_nop 1
v_mfma_f32_16x16x32_bf16 v[116:119],v[124:127],v[32:35],v[116:119]
v_and_b32 v124,v12,v91
v_and_b32 v125,v13,v91
v_and_b32 v126,v14,v91
v_and_b32 v127,v15,v91
s_nop 1
v_mfma_f32_16x16x32_bf16 v[116:119],v[124:127],v[36:39],v[116:119]
v_and_b32 v124,v12,v92
v_and_b32 v125,v13,v92
v_and_b32 v126,v14,v92
v_and_b32 v127,v15,v92
s_nop 1
v_mfma_f32_16x16x32_bf16 v[116:119],v[124:127],v[40:43],v[116:119]
v_and_b32 v124,v12,v93
v_and_b32 v125,v13,v93
v_and_b32 v126,v14,v93
v_and_b32 v127,v15,v93
s_nop 1
v_mfma_f32_16x16x32_bf16 v[116:119],v[124:127],v[44:47],v[116:119]
v_and_b32 v124,v12,v94
v_and_b32 v125,v13,v94
v_and_b32 v126,v14,v94
v_and_b32 v127,v15,v94
s_nop 1
v_mfma_f32_16x16x32_bf16 v[116:119],v[124:127],v[48:51],v[116:119]
v_and_b32 v124,v12,v95
v_and_b32 v125,v13,v95
v_and_b32 v126,v14,v95
v_and_b32 v127,v15,v95
s_nop 1
v_mfma_f32_16x16x32_bf16 v[116:119],v[124:127],v[52:55],v[116:119]
v_and_b32 v124,v12,v108
v_and_b32 v125,v13,v108
v_and_b32 v126,v14,v108
v_and_b32 v127,v15,v108
s_nop 1
v_mfma_f32_16x16x32_bf16 v[116:119],v[124:127],v[56:59],v[116:119]
v_and_b32 v124,v12,v109
v_and_b32 v125,v13,v109
v_and_b32 v126,v14,v109
v_and_b32 v127,v15,v109
s_nop 1
v_mfma_f32_16x16x32_bf16 v[116:119],v[124:127],v[60:63],v[116:119]
v_and_b32 v124,v12,v110
v_and_b32 v125,v13,v110
v_and_b32 v126,v14,v110
v_and_b32 v127,v15,v110
s_nop 1
v_mfma_f32_16x16x32_bf16 v[116:119],v[124:127],v[64:67],v[116:119]
v_and_b32 v124,v12,v111
v_and_b32 v125,v13,v111
v_and_b32 v126,v14,v111
v_and_b32 v127,v15,v111
s_nop 1
v_mfma_f32_16x16x32_bf16 v[116:119],v[124:127],v[68:71],v[116:119]
v_and_b32 v124,v12,v112
v_and_b32 v125,v13,v112
v_and_b32 v126,v14,v112
v_and_b32 v127,v15,v112
s_nop 1
v_mfma_f32_16x16x32_bf16 v[116:119],v[124:127],v[72:75],v[116:119]
v_and_b32 v124,v12,v113
v_and_b32 v125,v13,v113
v_and_b32 v126,v14,v113
v_and_b32 v127,v15,v113
s_nop 1
v_mfma_f32_16x16x32_bf16 v[116:119],v[124:127],v[76:79],v[116:119]
v_and_b32 v124,v12,v114
v_and_b32 v125,v13,v114
v_and_b32 v126,v14,v114
v_and_b32 v127,v15,v114
s_nop 1
v_mfma_f32_16x16x32_bf16 v[116:119],v[124:127],v[80:83],v[116:119]
v_and_b32 v124,v12,v115
v_and_b32 v125,v13,v115
v_and_b32 v126,v14,v115
v_and_b32 v127,v15,v115
s_nop 1
v_mfma_f32_16x16x32_bf16 v[116:119],v[124:127],v[84:87],v[116:119]
v_lshlrev_b32 v8,4,v9
v_and_b32 v124,1,v10
v_lshl_add_u32 v8,v124,3,v8
v_and_b32 v124,2,v10
v_lshl_add_u32 v8,v124,30,v8
s_lshl_b32 s65,s51,15
s_add_u32 s65,s65,92274688
s_lshl_b32 s59,s47,10
s_lshl_b32 s60,s46,8
s_add_u32 s59,s59,s60
s_add_u32 s59,s59,s65
v_cvt_pk_bf16_f32 v24,v116,v117
v_cvt_pk_bf16_f32 v25,v118,v119
buffer_store_dwordx2 v[24:25],v8,s[8:11],s59 offen
s_lshl_b32 s59,s51,13
s_lshl2_add_u32 s59,s47,s59
s_add_u32 s59,s59,10486912
s_waitcnt vmcnt(0)
s_barrier
s_or_b32 s59,s59,s52
buffer_store_dword v17,off,s[8:11],s59
s_cmp_lg_u32 s47,0
s_cbranch_scc1 L_moed_52
s_lshl_b32 s59,s51,13
s_add_u32 s59,s59,10486912
v_and_b32 v124,31,v1
v_lshlrev_b32 v124,2,v124
L_fw_53:
buffer_load_dword v125,v124,s[8:11],s59 offen sc1
s_sub_u32 s49,s49,1
s_cbranch_scc1 L_abort
s_waitcnt vmcnt(0)
v_cmp_eq_u32 vcc,0,v125
s_cbranch_vccnz L_fw_53
s_add_u32 s63,s65,0
buffer_load_dwordx4 v[24:27],v22,s[8:11],s63 offen sc1
s_add_u32 s63,s65,4096
buffer_load_dwordx4 v[28:31],v22,s[8:11],s63 offen sc1
s_add_u32 s63,s65,8192
buffer_load_dwordx4 v[32:35],v22,s[8:11],s63 offen sc1
s_add_u32 s63,s65,12288
buffer_load_dwordx4 v[36:39],v22,s[8:11],s63 offen sc1
s_add_u32 s63,s65,16384
buffer_load_dwordx4 v[40:43],v22,s[8:11],s63 offen sc1
s_add_u32 s63,s65,20480
buffer_load_dwordx4 v[44:47],v22,s[8:11],s63 offen sc1
s_add_u32 s63,s65,24576
buffer_load_dwordx4 v[48:51],v22,s[8:11],s63 offen sc1
s_add_u32 s63,s65,28672
buffer_load_dwordx4 v[52:55],v22,s[8:11],s63 offen sc1
v_and_b32 v64,15,v1
v_and_b32 v65,1,v1
v_lshlrev_b32 v65,4,v65
v_mov_b32 v66,0x3f80
v_lshlrev_b32 v66,v65,v66
v_lshrrev_b32 v64,1,v64
v_cmp_eq_u32 vcc,0,v64
s_nop 1
v_cndmask_b32 v56,0,v66,vcc
v_cmp_eq_u32 vcc,1,v64
s_nop 1
v_cndmask_b32 v57,0,v66,vcc
v_cmp_eq_u32 vcc,2,v64
s_nop 1
v_cndmask_b32 v58,0,v66,vcc
v_cmp_eq_u32 vcc,3,v64
s_nop 1
v_cndmask_b32 v59,0,v66,vcc
s_waitcnt vmcnt(7)
s_nop 0
v_mfma_f32_16x16x32_bf16 v[60:63],v[56:59],v[24:27],0
s_waitcnt vmcnt(6)
v_mfma_f32_16x16x32_bf16 v[60:63],v[56:59],v[28:31],v[60:63]
s_waitcnt vmcnt(5)
v_mfma_f32_16x16x32_bf16 v[60:63],v[56:59],v[32:35],v[60:63]
s_waitcnt vmcnt(4)
v_mfma_f32_16x16x32_bf16 v[60:63],v[56:59],v[36:39],v[60:63]
s_waitcnt vmcnt(3)
v_mfma_f32_16x16x32_bf16 v[60:63],v[56:59],v[40:43],v[60:63]
s_waitcnt vmcnt(2)
v_mfma_f32_16x16x32_bf16 v[60:63],v[56:59],v[44:47],v[60:63]
s_waitcnt vmcnt(1)
v_mfma_f32_16x16x32_bf16 v[60:63],v[56:59],v[48:51],v[60:63]
s_waitcnt vmcnt(0)
v_mfma_f32_16x16x32_bf16 v[60:63],v[56:59],v[52:55],v[60:63]
s_nop 7
ds_write_b128 v21,v[60:63]
s_waitcnt lgkmcnt(0)
s_barrier
s_cmp_lg_u32 s46,0
s_cbranch_scc1 L_moed_52
v_lshlrev_b32 v56,5,v1
v_add_u32 v56,155648,v56
ds_read_b128 v[24:27],v56
ds_read_b128 v[28:31],v56 offset:16
s_and_b32 s59,s55,0xffff0000
s_xor_b32 s60,s59,0x80000000
s_xor_b32 s61,s59,0xffff0000
s_cmp_lt_i32 s59,0
s_cselect_b32 s59,s60,s61
v_mov_b32 v56,s59
v_mul_f32 v56,0xbfb8aa3b,v56
v_exp_f32 v56,v56
s_nop 0
v_add_f32 v56,1.0,v56
v_rcp_f32 v56,v56
s_nop 0
v_cvt_pk_bf16_f32 v56,v56,v56
v_and_b32 v56,0xffff0000,v56
v_lshlrev_b32 v48,16,v104
v_and_b32 v49,0xffff0000,v104
v_lshlrev_b32 v50,16,v105
v_and_b32 v51,0xffff0000,v105
v_lshlrev_b32 v52,16,v106
v_and_b32 v53,0xffff0000,v106
v_lshlrev_b32 v54,16,v107
v_and_b32 v55,0xffff0000,v107
s_waitcnt lgkmcnt(0)
v_cvt_pk_bf16_f32 v40,v24,v25
v_cvt_pk_bf16_f32 v41,v26,v27
v_cvt_pk_bf16_f32 v42,v28,v29
v_cvt_pk_bf16_f32 v43,v30,v31
v_lshlrev_b32 v24,16,v40
v_and_b32 v25,0xffff0000,v40
v_lshlrev_b32 v26,16,v41
v_and_b32 v27,0xffff0000,v41
v_lshlrev_b32 v28,16,v42
v_and_b32 v29,0xffff0000,v42
v_lshlrev_b32 v30,16,v43
v_and_b32 v31,0xffff0000,v43
v_mul_f32 v24,v24,v56
v_mul_f32 v25,v25,v56
v_mul_f32 v26,v26,v56
v_mul_f32 v27,v27,v56
v_mul_f32 v28,v28,v56
v_mul_f32 v29,v29,v56
v_mul_f32 v30,v30,v56
v_mul_f32 v31,v31,v56
v_cvt_pk_bf16_f32 v40,v24,v25
v_cvt_pk_bf16_f32 v41,v26,v27
v_cvt_pk_bf16_f32 v42,v28,v29
v_cvt_pk_bf16_f32 v43,v30,v31
v_lshlrev_b32 v24,16,v40
v_and_b32 v25,0xffff0000,v40
v_lshlrev_b32 v26,16,v41
v_and_b32 v27,0xffff0000,v41
v_lshlrev_b32 v28,16,v42
v_and_b32 v29,0xffff0000,v42
v_lshlrev_b32 v30,16,v43
v_and_b32 v31,0xffff0000,v43
v_add_f32 v24,v24,v48
v_add_f32 v25,v25,v49
v_add_f32 v26,v26,v50
v_add_f32 v27,v27,v51
v_add_f32 v28,v28,v52
v_add_f32 v29,v29,v53
v_add_f32 v30,v30,v54
v_add_f32 v31,v31,v55
v_cvt_pk_bf16_f32 v40,v24,v25
v_cvt_pk_bf16_f32 v41,v26,v27
v_cvt_pk_bf16_f32 v42,v28,v29
v_cvt_pk_bf16_f32 v43,v30,v31
v_lshlrev_b32 v24,16,v40
v_and_b32 v25,0xffff0000,v40
v_lshlrev_b32 v26,16,v41
v_and_b32 v27,0xffff0000,v41
v_lshlrev_b32 v28,16,v42
v_and_b32 v29,0xffff0000,v42
v_lshlrev_b32 v30,16,v43
v_and_b32 v31,0xffff0000,v43
v_add_f32 v96,v96,v24
v_add_f32 v97,v97,v25
v_add_f32 v98,v98,v26
v_add_f32 v99,v99,v27
v_add_f32 v100,v100,v28
v_add_f32 v101,v101,v29
v_add_f32 v102,v102,v30
v_add_f32 v103,v103,v31
v_cvt_pk_bf16_f32 v80,v96,v97
v_cvt_pk_bf16_f32 v81,v98,v99
v_cvt_pk_bf16_f32 v82,v100,v101
v_cvt_pk_bf16_f32 v83,v102,v103
s_mov_b32 s4,s40
s_mov_b32 s5,s41
s_mov_b32 s6,2097152
s_mov_b32 s7,0x20000
buffer_store_dwordx4 v[80:83],v0,s[4:7],s56 offen sc1
L_moed_52:
s_endpgm
L_abort:
s_endpgm
L_spread:
s_mov_b32 s3,-1
s_lshr_b32 s48,s2,5
s_and_b32 s47,s2,31
s_branch L_roles
L_ra_6:
s_mov_b32 s4,s26
s_mov_b32 s5,s27
s_mov_b32 s6,4194304
s_mov_b32 s7,0x20000
v_and_b32 v2,15,v1
v_lshlrev_b32 v2,4,v2
v_lshrrev_b32 v3,4,v1
v_lshl_add_u32 v2,v3,13,v2
s_and_b32 s56,s47,15
s_lshl_b32 s56,s56,18
s_lshl_b32 s57,s46,8
s_add_u32 s56,s56,s57
s_mov_b32 s61,0x05040100
s_mov_b32 s62,0x07060302
s_add_u32 s57,s56,0
buffer_load_dwordx4 v[24:27],v2,s[4:7],s57 offen offset:0
buffer_load_dwordx4 v[28:31],v2,s[4:7],s57 offen offset:1024
buffer_load_dwordx4 v[32:35],v2,s[4:7],s57 offen offset:2048
buffer_load_dwordx4 v[36:39],v2,s[4:7],s57 offen offset:3072
s_add_u32 s57,s56,4096
buffer_load_dwordx4 v[40:43],v2,s[4:7],s57 offen offset:0
buffer_load_dwordx4 v[44:47],v2,s[4:7],s57 offen offset:1024
buffer_load_dwordx4 v[48:51],v2,s[4:7],s57 offen offset:2048
buffer_load_dwordx4 v[52:55],v2,s[4:7],s57 offen offset:3072
s_add_u32 s57,s56,32768
buffer_load_dwordx4 v[56:59],v2,s[4:7],s57 offen offset:0
buffer_load_dwordx4 v[60:63],v2,s[4:7],s57 offen offset:1024
buffer_load_dwordx4 v[64:67],v2,s[4:7],s57 offen offset:2048
buffer_load_dwordx4 v[68:71],v2,s[4:7],s57 offen offset:3072
s_add_u32 s57,s56,36864
buffer_load_dwordx4 v[72:75],v2,s[4:7],s57 offen offset:0
buffer_load_dwordx4 v[76:79],v2,s[4:7],s57 offen offset:1024
buffer_load_dwordx4 v[80:83],v2,s[4:7],s57 offen offset:2048
buffer_load_dwordx4 v[84:87],v2,s[4:7],s57 offen offset:3072
s_add_u32 s57,s56,65536
buffer_load_dwordx4 v[88:91],v2,s[4:7],s57 offen offset:0
buffer_load_dwordx4 v[92:95],v2,s[4:7],s57 offen offset:1024
buffer_load_dwordx4 v[96:99],v2,s[4:7],s57 offen offset:2048
buffer_load_dwordx4 v[100:103],v2,s[4:7],s57 offen offset:3072
s_add_u32 s57,s56,69632
buffer_load_dwordx4 v[104:107],v2,s[4:7],s57 offen offset:0
buffer_load_dwordx4 v[108:111],v2,s[4:7],s57 offen offset:1024
buffer_load_dwordx4 v[112:115],v2,s[4:7],s57 offen offset:2048
buffer_load_dwordx4 v[116:119],v2,s[4:7],s57 offen offset:3072
s_add_u32 s57,s56,98304
buffer_load_dwordx4 v[120:123],v2,s[4:7],s57 offen offset:0
buffer_load_dwordx4 v[124:127],v2,s[4:7],s57 offen offset:1024
buffer_load_dwordx4 v[128:131],v2,s[4:7],s57 offen offset:2048
buffer_load_dwordx4 v[132:135],v2,s[4:7],s57 offen offset:3072
s_add_u32 s57,s56,102400
buffer_load_dwordx4 v[136:139],v2,s[4:7],s57 offen offset:0
buffer_load_dwordx4 v[140:143],v2,s[4:7],s57 offen offset:1024
buffer_load_dwordx4 v[144:147],v2,s[4:7],s57 offen offset:2048
buffer_load_dwordx4 v[148:151],v2,s[4:7],s57 offen offset:3072
s_add_u32 s57,s56,131072
buffer_load_dwordx4 v[152:155],v2,s[4:7],s57 offen offset:0
buffer_load_dwordx4 v[156:159],v2,s[4:7],s57 offen offset:1024
buffer_load_dwordx4 v[160:163],v2,s[4:7],s57 offen offset:2048
buffer_load_dwordx4 v[164:167],v2,s[4:7],s57 offen offset:3072
s_add_u32 s57,s56,135168
buffer_load_dwordx4 v[168:171],v2,s[4:7],s57 offen offset:0
buffer_load_dwordx4 v[172:175],v2,s[4:7],s57 offen offset:1024
buffer_load_dwordx4 v[176:179],v2,s[4:7],s57 offen offset:2048
buffer_load_dwordx4 v[180:183],v2,s[4:7],s57 offen offset:3072
s_add_u32 s57,s56,163840
buffer_load_dwordx4 v[184:187],v2,s[4:7],s57 offen offset:0
buffer_load_dwordx4 v[188:191],v2,s[4:7],s57 offen offset:1024
buffer_load_dwordx4 v[192:195],v2,s[4:7],s57 offen offset:2048
buffer_load_dwordx4 v[196:199],v2,s[4:7],s57 offen offset:3072
s_add_u32 s57,s56,167936
buffer_load_dwordx4 v[200:203],v2,s[4:7],s57 offen offset:0
buffer_load_dwordx4 v[204:207],v2,s[4:7],s57 offen offset:1024
buffer_load_dwordx4 v[208:211],v2,s[4:7],s57 offen offset:2048
buffer_load_dwordx4 v[212:215],v2,s[4:7],s57 offen offset:3072
s_waitcnt vmcnt(40)
v_perm_b32 v216,v28,v24,s61
v_perm_b32 v217,v36,v32,s61
v_perm_b32 v218,v44,v40,s61
v_perm_b32 v219,v52,v48,s61
v_accvgpr_write_b32 a0,v216
v_accvgpr_write_b32 a1,v217
v_accvgpr_write_b32 a2,v218
v_accvgpr_write_b32 a3,v219
v_perm_b32 v216,v28,v24,s62
v_perm_b32 v217,v36,v32,s62
v_perm_b32 v218,v44,v40,s62
v_perm_b32 v219,v52,v48,s62
v_accvgpr_write_b32 a4,v216
v_accvgpr_write_b32 a5,v217
v_accvgpr_write_b32 a6,v218
v_accvgpr_write_b32 a7,v219
v_perm_b32 v216,v29,v25,s61
v_perm_b32 v217,v37,v33,s61
v_perm_b32 v218,v45,v41,s61
v_perm_b32 v219,v53,v49,s61
v_accvgpr_write_b32 a8,v216
v_accvgpr_write_b32 a9,v217
v_accvgpr_write_b32 a10,v218
v_accvgpr_write_b32 a11,v219
v_perm_b32 v216,v29,v25,s62
v_perm_b32 v217,v37,v33,s62
v_perm_b32 v218,v45,v41,s62
v_perm_b32 v219,v53,v49,s62
v_accvgpr_write_b32 a12,v216
v_accvgpr_write_b32 a13,v217
v_accvgpr_write_b32 a14,v218
v_accvgpr_write_b32 a15,v219
v_perm_b32 v216,v30,v26,s61
v_perm_b32 v217,v38,v34,s61
v_perm_b32 v218,v46,v42,s61
v_perm_b32 v219,v54,v50,s61
v_accvgpr_write_b32 a16,v216
v_accvgpr_write_b32 a17,v217
v_accvgpr_write_b32 a18,v218
v_accvgpr_write_b32 a19,v219
v_perm_b32 v216,v30,v26,s62
v_perm_b32 v217,v38,v34,s62
v_perm_b32 v218,v46,v42,s62
v_perm_b32 v219,v54,v50,s62
v_accvgpr_write_b32 a20,v216
v_accvgpr_write_b32 a21,v217
v_accvgpr_write_b32 a22,v218
v_accvgpr_write_b32 a23,v219
v_perm_b32 v216,v31,v27,s61
v_perm_b32 v217,v39,v35,s61
v_perm_b32 v218,v47,v43,s61
v_perm_b32 v219,v55,v51,s61
v_accvgpr_write_b32 a24,v216
v_accvgpr_write_b32 a25,v217
v_accvgpr_write_b32 a26,v218
v_accvgpr_write_b32 a27,v219
v_perm_b32 v216,v31,v27,s62
v_perm_b32 v217,v39,v35,s62
v_perm_b32 v218,v47,v43,s62
v_perm_b32 v219,v55,v51,s62
v_accvgpr_write_b32 a28,v216
v_accvgpr_write_b32 a29,v217
v_accvgpr_write_b32 a30,v218
v_accvgpr_write_b32 a31,v219
s_add_u32 s57,s56,196608
buffer_load_dwordx4 v[24:27],v2,s[4:7],s57 offen offset:0
buffer_load_dwordx4 v[28:31],v2,s[4:7],s57 offen offset:1024
buffer_load_dwordx4 v[32:35],v2,s[4:7],s57 offen offset:2048
buffer_load_dwordx4 v[36:39],v2,s[4:7],s57 offen offset:3072
s_add_u32 s57,s56,200704
buffer_load_dwordx4 v[40:43],v2,s[4:7],s57 offen offset:0
buffer_load_dwordx4 v[44:47],v2,s[4:7],s57 offen offset:1024
buffer_load_dwordx4 v[48:51],v2,s[4:7],s57 offen offset:2048
buffer_load_dwordx4 v[52:55],v2,s[4:7],s57 offen offset:3072
s_waitcnt vmcnt(40)
v_perm_b32 v216,v60,v56,s61
v_perm_b32 v217,v68,v64,s61
v_perm_b32 v218,v76,v72,s61
v_perm_b32 v219,v84,v80,s61
v_accvgpr_write_b32 a32,v216
v_accvgpr_write_b32 a33,v217
v_accvgpr_write_b32 a34,v218
v_accvgpr_write_b32 a35,v219
v_perm_b32 v216,v60,v56,s62
v_perm_b32 v217,v68,v64,s62
v_perm_b32 v218,v76,v72,s62
v_perm_b32 v219,v84,v80,s62
v_accvgpr_write_b32 a36,v216
v_accvgpr_write_b32 a37,v217
v_accvgpr_write_b32 a38,v218
v_accvgpr_write_b32 a39,v219
v_perm_b32 v216,v61,v57,s61
v_perm_b32 v217,v69,v65,s61
v_perm_b32 v218,v77,v73,s61
v_perm_b32 v219,v85,v81,s61
v_accvgpr_write_b32 a40,v216
v_accvgpr_write_b32 a41,v217
v_accvgpr_write_b32 a42,v218
v_accvgpr_write_b32 a43,v219
v_perm_b32 v216,v61,v57,s62
v_perm_b32 v217,v69,v65,s62
v_perm_b32 v218,v77,v73,s62
v_perm_b32 v219,v85,v81,s62
v_accvgpr_write_b32 a44,v216
v_accvgpr_write_b32 a45,v217
v_accvgpr_write_b32 a46,v218
v_accvgpr_write_b32 a47,v219
v_perm_b32 v216,v62,v58,s61
v_perm_b32 v217,v70,v66,s61
v_perm_b32 v218,v78,v74,s61
v_perm_b32 v219,v86,v82,s61
v_accvgpr_write_b32 a48,v216
v_accvgpr_write_b32 a49,v217
v_accvgpr_write_b32 a50,v218
v_accvgpr_write_b32 a51,v219
v_perm_b32 v216,v62,v58,s62
v_perm_b32 v217,v70,v66,s62
v_perm_b32 v218,v78,v74,s62
v_perm_b32 v219,v86,v82,s62
v_accvgpr_write_b32 a52,v216
v_accvgpr_write_b32 a53,v217
v_accvgpr_write_b32 a54,v218
v_accvgpr_write_b32 a55,v219
v_perm_b32 v216,v63,v59,s61
v_perm_b32 v217,v71,v67,s61
v_perm_b32 v218,v79,v75,s61
v_perm_b32 v219,v87,v83,s61
v_accvgpr_write_b32 a56,v216
v_accvgpr_write_b32 a57,v217
v_accvgpr_write_b32 a58,v218
v_accvgpr_write_b32 a59,v219
v_perm_b32 v216,v63,v59,s62
v_perm_b32 v217,v71,v67,s62
v_perm_b32 v218,v79,v75,s62
v_perm_b32 v219,v87,v83,s62
v_accvgpr_write_b32 a60,v216
v_accvgpr_write_b32 a61,v217
v_accvgpr_write_b32 a62,v218
v_accvgpr_write_b32 a63,v219
s_add_u32 s57,s56,229376
buffer_load_dwordx4 v[56:59],v2,s[4:7],s57 offen offset:0
buffer_load_dwordx4 v[60:63],v2,s[4:7],s57 offen offset:1024
buffer_load_dwordx4 v[64:67],v2,s[4:7],s57 offen offset:2048
buffer_load_dwordx4 v[68:71],v2,s[4:7],s57 offen offset:3072
s_add_u32 s57,s56,233472
buffer_load_dwordx4 v[72:75],v2,s[4:7],s57 offen offset:0
buffer_load_dwordx4 v[76:79],v2,s[4:7],s57 offen offset:1024
buffer_load_dwordx4 v[80:83],v2,s[4:7],s57 offen offset:2048
buffer_load_dwordx4 v[84:87],v2,s[4:7],s57 offen offset:3072
s_waitcnt vmcnt(40)
v_perm_b32 v216,v92,v88,s61
v_perm_b32 v217,v100,v96,s61
v_perm_b32 v218,v108,v104,s61
v_perm_b32 v219,v116,v112,s61
v_accvgpr_write_b32 a64,v216
v_accvgpr_write_b32 a65,v217
v_accvgpr_write_b32 a66,v218
v_accvgpr_write_b32 a67,v219
v_perm_b32 v216,v92,v88,s62
v_perm_b32 v217,v100,v96,s62
v_perm_b32 v218,v108,v104,s62
v_perm_b32 v219,v116,v112,s62
v_accvgpr_write_b32 a68,v216
v_accvgpr_write_b32 a69,v217
v_accvgpr_write_b32 a70,v218
v_accvgpr_write_b32 a71,v219
v_perm_b32 v216,v93,v89,s61
v_perm_b32 v217,v101,v97,s61
v_perm_b32 v218,v109,v105,s61
v_perm_b32 v219,v117,v113,s61
v_accvgpr_write_b32 a72,v216
v_accvgpr_write_b32 a73,v217
v_accvgpr_write_b32 a74,v218
v_accvgpr_write_b32 a75,v219
v_perm_b32 v216,v93,v89,s62
v_perm_b32 v217,v101,v97,s62
v_perm_b32 v218,v109,v105,s62
v_perm_b32 v219,v117,v113,s62
v_accvgpr_write_b32 a76,v216
v_accvgpr_write_b32 a77,v217
v_accvgpr_write_b32 a78,v218
v_accvgpr_write_b32 a79,v219
v_perm_b32 v216,v94,v90,s61
v_perm_b32 v217,v102,v98,s61
v_perm_b32 v218,v110,v106,s61
v_perm_b32 v219,v118,v114,s61
v_accvgpr_write_b32 a80,v216
v_accvgpr_write_b32 a81,v217
v_accvgpr_write_b32 a82,v218
v_accvgpr_write_b32 a83,v219
v_perm_b32 v216,v94,v90,s62
v_perm_b32 v217,v102,v98,s62
v_perm_b32 v218,v110,v106,s62
v_perm_b32 v219,v118,v114,s62
v_accvgpr_write_b32 a84,v216
v_accvgpr_write_b32 a85,v217
v_accvgpr_write_b32 a86,v218
v_accvgpr_write_b32 a87,v219
v_perm_b32 v216,v95,v91,s61
v_perm_b32 v217,v103,v99,s61
v_perm_b32 v218,v111,v107,s61
v_perm_b32 v219,v119,v115,s61
v_accvgpr_write_b32 a88,v216
v_accvgpr_write_b32 a89,v217
v_accvgpr_write_b32 a90,v218
v_accvgpr_write_b32 a91,v219
v_perm_b32 v216,v95,v91,s62
v_perm_b32 v217,v103,v99,s62
v_perm_b32 v218,v111,v107,s62
v_perm_b32 v219,v119,v115,s62
v_accvgpr_write_b32 a92,v216
v_accvgpr_write_b32 a93,v217
v_accvgpr_write_b32 a94,v218
v_accvgpr_write_b32 a95,v219
s_waitcnt vmcnt(32)
v_perm_b32 v216,v124,v120,s61
v_perm_b32 v217,v132,v128,s61
v_perm_b32 v218,v140,v136,s61
v_perm_b32 v219,v148,v144,s61
v_accvgpr_write_b32 a96,v216
v_accvgpr_write_b32 a97,v217
v_accvgpr_write_b32 a98,v218
v_accvgpr_write_b32 a99,v219
v_perm_b32 v216,v124,v120,s62
v_perm_b32 v217,v132,v128,s62
v_perm_b32 v218,v140,v136,s62
v_perm_b32 v219,v148,v144,s62
v_accvgpr_write_b32 a100,v216
v_accvgpr_write_b32 a101,v217
v_accvgpr_write_b32 a102,v218
v_accvgpr_write_b32 a103,v219
v_perm_b32 v216,v125,v121,s61
v_perm_b32 v217,v133,v129,s61
v_perm_b32 v218,v141,v137,s61
v_perm_b32 v219,v149,v145,s61
v_accvgpr_write_b32 a104,v216
v_accvgpr_write_b32 a105,v217
v_accvgpr_write_b32 a106,v218
v_accvgpr_write_b32 a107,v219
v_perm_b32 v216,v125,v121,s62
v_perm_b32 v217,v133,v129,s62
v_perm_b32 v218,v141,v137,s62
v_perm_b32 v219,v149,v145,s62
v_accvgpr_write_b32 a108,v216
v_accvgpr_write_b32 a109,v217
v_accvgpr_write_b32 a110,v218
v_accvgpr_write_b32 a111,v219
v_perm_b32 v216,v126,v122,s61
v_perm_b32 v217,v134,v130,s61
v_perm_b32 v218,v142,v138,s61
v_perm_b32 v219,v150,v146,s61
v_accvgpr_write_b32 a112,v216
v_accvgpr_write_b32 a113,v217
v_accvgpr_write_b32 a114,v218
v_accvgpr_write_b32 a115,v219
v_perm_b32 v216,v126,v122,s62
v_perm_b32 v217,v134,v130,s62
v_perm_b32 v218,v142,v138,s62
v_perm_b32 v219,v150,v146,s62
v_accvgpr_write_b32 a116,v216
v_accvgpr_write_b32 a117,v217
v_accvgpr_write_b32 a118,v218
v_accvgpr_write_b32 a119,v219
v_perm_b32 v216,v127,v123,s61
v_perm_b32 v217,v135,v131,s61
v_perm_b32 v218,v143,v139,s61
v_perm_b32 v219,v151,v147,s61
v_accvgpr_write_b32 a120,v216
v_accvgpr_write_b32 a121,v217
v_accvgpr_write_b32 a122,v218
v_accvgpr_write_b32 a123,v219
v_perm_b32 v216,v127,v123,s62
v_perm_b32 v217,v135,v131,s62
v_perm_b32 v218,v143,v139,s62
v_perm_b32 v219,v151,v147,s62
v_accvgpr_write_b32 a124,v216
v_accvgpr_write_b32 a125,v217
v_accvgpr_write_b32 a126,v218
v_accvgpr_write_b32 a127,v219
s_waitcnt vmcnt(24)
v_perm_b32 v216,v156,v152,s61
v_perm_b32 v217,v164,v160,s61
v_perm_b32 v218,v172,v168,s61
v_perm_b32 v219,v180,v176,s61
v_accvgpr_write_b32 a128,v216
v_accvgpr_write_b32 a129,v217
v_accvgpr_write_b32 a130,v218
v_accvgpr_write_b32 a131,v219
v_perm_b32 v216,v156,v152,s62
v_perm_b32 v217,v164,v160,s62
v_perm_b32 v218,v172,v168,s62
v_perm_b32 v219,v180,v176,s62
v_accvgpr_write_b32 a132,v216
v_accvgpr_write_b32 a133,v217
v_accvgpr_write_b32 a134,v218
v_accvgpr_write_b32 a135,v219
v_perm_b32 v216,v157,v153,s61
v_perm_b32 v217,v165,v161,s61
v_perm_b32 v218,v173,v169,s61
v_perm_b32 v219,v181,v177,s61
v_accvgpr_write_b32 a136,v216
v_accvgpr_write_b32 a137,v217
v_accvgpr_write_b32 a138,v218
v_accvgpr_write_b32 a139,v219
v_perm_b32 v216,v157,v153,s62
v_perm_b32 v217,v165,v161,s62
v_perm_b32 v218,v173,v169,s62
v_perm_b32 v219,v181,v177,s62
v_accvgpr_write_b32 a140,v216
v_accvgpr_write_b32 a141,v217
v_accvgpr_write_b32 a142,v218
v_accvgpr_write_b32 a143,v219
v_perm_b32 v216,v158,v154,s61
v_perm_b32 v217,v166,v162,s61
v_perm_b32 v218,v174,v170,s61
v_perm_b32 v219,v182,v178,s61
v_accvgpr_write_b32 a144,v216
v_accvgpr_write_b32 a145,v217
v_accvgpr_write_b32 a146,v218
v_accvgpr_write_b32 a147,v219
v_perm_b32 v216,v158,v154,s62
v_perm_b32 v217,v166,v162,s62
v_perm_b32 v218,v174,v170,s62
v_perm_b32 v219,v182,v178,s62
v_accvgpr_write_b32 a148,v216
v_accvgpr_write_b32 a149,v217
v_accvgpr_write_b32 a150,v218
v_accvgpr_write_b32 a151,v219
v_perm_b32 v216,v159,v155,s61
v_perm_b32 v217,v167,v163,s61
v_perm_b32 v218,v175,v171,s61
v_perm_b32 v219,v183,v179,s61
v_accvgpr_write_b32 a152,v216
v_accvgpr_write_b32 a153,v217
v_accvgpr_write_b32 a154,v218
v_accvgpr_write_b32 a155,v219
v_perm_b32 v216,v159,v155,s62
v_perm_b32 v217,v167,v163,s62
v_perm_b32 v218,v175,v171,s62
v_perm_b32 v219,v183,v179,s62
v_accvgpr_write_b32 a156,v216
v_accvgpr_write_b32 a157,v217
v_accvgpr_write_b32 a158,v218
v_accvgpr_write_b32 a159,v219
s_waitcnt vmcnt(16)
v_perm_b32 v216,v188,v184,s61
v_perm_b32 v217,v196,v192,s61
v_perm_b32 v218,v204,v200,s61
v_perm_b32 v219,v212,v208,s61
v_accvgpr_write_b32 a160,v216
v_accvgpr_write_b32 a161,v217
v_accvgpr_write_b32 a162,v218
v_accvgpr_write_b32 a163,v219
v_perm_b32 v216,v188,v184,s62
v_perm_b32 v217,v196,v192,s62
v_perm_b32 v218,v204,v200,s62
v_perm_b32 v219,v212,v208,s62
v_accvgpr_write_b32 a164,v216
v_accvgpr_write_b32 a165,v217
v_accvgpr_write_b32 a166,v218
v_accvgpr_write_b32 a167,v219
v_perm_b32 v216,v189,v185,s61
v_perm_b32 v217,v197,v193,s61
v_perm_b32 v218,v205,v201,s61
v_perm_b32 v219,v213,v209,s61
v_accvgpr_write_b32 a168,v216
v_accvgpr_write_b32 a169,v217
v_accvgpr_write_b32 a170,v218
v_accvgpr_write_b32 a171,v219
v_perm_b32 v216,v189,v185,s62
v_perm_b32 v217,v197,v193,s62
v_perm_b32 v218,v205,v201,s62
v_perm_b32 v219,v213,v209,s62
v_accvgpr_write_b32 a172,v216
v_accvgpr_write_b32 a173,v217
v_accvgpr_write_b32 a174,v218
v_accvgpr_write_b32 a175,v219
v_perm_b32 v216,v190,v186,s61
v_perm_b32 v217,v198,v194,s61
v_perm_b32 v218,v206,v202,s61
v_perm_b32 v219,v214,v210,s61
v_accvgpr_write_b32 a176,v216
v_accvgpr_write_b32 a177,v217
v_accvgpr_write_b32 a178,v218
v_accvgpr_write_b32 a179,v219
v_perm_b32 v216,v190,v186,s62
v_perm_b32 v217,v198,v194,s62
v_perm_b32 v218,v206,v202,s62
v_perm_b32 v219,v214,v210,s62
v_accvgpr_write_b32 a180,v216
v_accvgpr_write_b32 a181,v217
v_accvgpr_write_b32 a182,v218
v_accvgpr_write_b32 a183,v219
v_perm_b32 v216,v191,v187,s61
v_perm_b32 v217,v199,v195,s61
v_perm_b32 v218,v207,v203,s61
v_perm_b32 v219,v215,v211,s61
v_accvgpr_write_b32 a184,v216
v_accvgpr_write_b32 a185,v217
v_accvgpr_write_b32 a186,v218
v_accvgpr_write_b32 a187,v219
v_perm_b32 v216,v191,v187,s62
v_perm_b32 v217,v199,v195,s62
v_perm_b32 v218,v207,v203,s62
v_perm_b32 v219,v215,v211,s62
v_accvgpr_write_b32 a188,v216
v_accvgpr_write_b32 a189,v217
v_accvgpr_write_b32 a190,v218
v_accvgpr_write_b32 a191,v219
s_waitcnt vmcnt(8)
v_perm_b32 v216,v28,v24,s61
v_perm_b32 v217,v36,v32,s61
v_perm_b32 v218,v44,v40,s61
v_perm_b32 v219,v52,v48,s61
v_accvgpr_write_b32 a192,v216
v_accvgpr_write_b32 a193,v217
v_accvgpr_write_b32 a194,v218
v_accvgpr_write_b32 a195,v219
v_perm_b32 v216,v28,v24,s62
v_perm_b32 v217,v36,v32,s62
v_perm_b32 v218,v44,v40,s62
v_perm_b32 v219,v52,v48,s62
v_accvgpr_write_b32 a196,v216
v_accvgpr_write_b32 a197,v217
v_accvgpr_write_b32 a198,v218
v_accvgpr_write_b32 a199,v219
v_perm_b32 v216,v29,v25,s61
v_perm_b32 v217,v37,v33,s61
v_perm_b32 v218,v45,v41,s61
v_perm_b32 v219,v53,v49,s61
v_accvgpr_write_b32 a200,v216
v_accvgpr_write_b32 a201,v217
v_accvgpr_write_b32 a202,v218
v_accvgpr_write_b32 a203,v219
v_perm_b32 v216,v29,v25,s62
v_perm_b32 v217,v37,v33,s62
v_perm_b32 v218,v45,v41,s62
v_perm_b32 v219,v53,v49,s62
v_accvgpr_write_b32 a204,v216
v_accvgpr_write_b32 a205,v217
v_accvgpr_write_b32 a206,v218
v_accvgpr_write_b32 a207,v219
v_perm_b32 v216,v30,v26,s61
v_perm_b32 v217,v38,v34,s61
v_perm_b32 v218,v46,v42,s61
v_perm_b32 v219,v54,v50,s61
v_accvgpr_write_b32 a208,v216
v_accvgpr_write_b32 a209,v217
v_accvgpr_write_b32 a210,v218
v_accvgpr_write_b32 a211,v219
v_perm_b32 v216,v30,v26,s62
v_perm_b32 v217,v38,v34,s62
v_perm_b32 v218,v46,v42,s62
v_perm_b32 v219,v54,v50,s62
v_accvgpr_write_b32 a212,v216
v_accvgpr_write_b32 a213,v217
v_accvgpr_write_b32 a214,v218
v_accvgpr_write_b32 a215,v219
v_perm_b32 v216,v31,v27,s61
v_perm_b32 v217,v39,v35,s61
v_perm_b32 v218,v47,v43,s61
v_perm_b32 v219,v55,v51,s61
v_accvgpr_write_b32 a216,v216
v_accvgpr_write_b32 a217,v217
v_accvgpr_write_b32 a218,v218
v_accvgpr_write_b32 a219,v219
v_perm_b32 v216,v31,v27,s62
v_perm_b32 v217,v39,v35,s62
v_perm_b32 v218,v47,v43,s62
v_perm_b32 v219,v55,v51,s62
v_accvgpr_write_b32 a220,v216
v_accvgpr_write_b32 a221,v217
v_accvgpr_write_b32 a222,v218
v_accvgpr_write_b32 a223,v219
s_waitcnt vmcnt(0)
v_perm_b32 v216,v60,v56,s61
v_perm_b32 v217,v68,v64,s61
v_perm_b32 v218,v76,v72,s61
v_perm_b32 v219,v84,v80,s61
v_accvgpr_write_b32 a224,v216
v_accvgpr_write_b32 a225,v217
v_accvgpr_write_b32 a226,v218
v_accvgpr_write_b32 a227,v219
v_perm_b32 v216,v60,v56,s62
v_perm_b32 v217,v68,v64,s62
v_perm_b32 v218,v76,v72,s62
v_perm_b32 v219,v84,v80,s62
v_accvgpr_write_b32 a228,v216
v_accvgpr_write_b32 a229,v217
v_accvgpr_write_b32 a230,v218
v_accvgpr_write_b32 a231,v219
v_perm_b32 v216,v61,v57,s61
v_perm_b32 v217,v69,v65,s61
v_perm_b32 v218,v77,v73,s61
v_perm_b32 v219,v85,v81,s61
v_accvgpr_write_b32 a232,v216
v_accvgpr_write_b32 a233,v217
v_accvgpr_write_b32 a234,v218
v_accvgpr_write_b32 a235,v219
v_perm_b32 v216,v61,v57,s62
v_perm_b32 v217,v69,v65,s62
v_perm_b32 v218,v77,v73,s62
v_perm_b32 v219,v85,v81,s62
v_accvgpr_write_b32 a236,v216
v_accvgpr_write_b32 a237,v217
v_accvgpr_write_b32 a238,v218
v_accvgpr_write_b32 a239,v219
v_perm_b32 v216,v62,v58,s61
v_perm_b32 v217,v70,v66,s61
v_perm_b32 v218,v78,v74,s61
v_perm_b32 v219,v86,v82,s61
v_accvgpr_write_b32 a240,v216
v_accvgpr_write_b32 a241,v217
v_accvgpr_write_b32 a242,v218
v_accvgpr_write_b32 a243,v219
v_perm_b32 v216,v62,v58,s62
v_perm_b32 v217,v70,v66,s62
v_perm_b32 v218,v78,v74,s62
v_perm_b32 v219,v86,v82,s62
v_accvgpr_write_b32 a244,v216
v_accvgpr_write_b32 a245,v217
v_accvgpr_write_b32 a246,v218
v_accvgpr_write_b32 a247,v219
v_perm_b32 v216,v63,v59,s61
v_perm_b32 v217,v71,v67,s61
v_perm_b32 v218,v79,v75,s61
v_perm_b32 v219,v87,v83,s61
v_accvgpr_write_b32 a248,v216
v_accvgpr_write_b32 a249,v217
v_accvgpr_write_b32 a250,v218
v_accvgpr_write_b32 a251,v219
v_perm_b32 v216,v63,v59,s62
v_perm_b32 v217,v71,v67,s62
v_perm_b32 v218,v79,v75,s62
v_perm_b32 v219,v87,v83,s62
v_accvgpr_write_b32 a252,v216
v_accvgpr_write_b32 a253,v217
v_accvgpr_write_b32 a254,v218
v_accvgpr_write_b32 a255,v219
v_mov_b32 v123,159744
s_cmp_lg_u32 s46,0
s_cbranch_scc1 L_gbd_57
v_mov_b32 v124,128
L_gb_56:
buffer_load_dword v125,v124,s[12:15],0 offen sc1
s_waitcnt vmcnt(0)
v_readfirstlane_b32 s56,v125
ds_write_b32 v123,v125
s_bitcmp1_b32 s56,8
s_cbranch_scc1 L_gbd_57
s_sleep 4
s_sub_u32 s49,s49,1
s_cmp_gt_i32 s49,0
s_cbranch_scc1 L_gb_56
s_branch L_abort
L_gbd_57:
s_waitcnt lgkmcnt(0)
s_barrier
ds_read_b32 v125,v123
s_waitcnt lgkmcnt(0)
v_readfirstlane_b32 s56,v125
s_barrier
s_lshr_b32 s56,s56,16
s_andn2_b32 s56,s56,s3
s_cbranch_scc1 L_spread
s_max_u32 s54,s48,5
s_sub_u32 s54,s54,5
s_lshl_b32 s54,s54,1
s_lshr_b32 s56,s47,4
s_add_u32 s54,s54,s56
s_cmp_lg_u32 s3,0
s_cbranch_scc1 L_wa
v_and_b32 v238,15,v1
v_and_b32 v239,1,v1
v_lshlrev_b32 v239,4,v239
v_mov_b32 v240,0x3f80
v_lshlrev_b32 v240,v239,v240
v_lshrrev_b32 v238,1,v238
v_cmp_eq_u32 vcc,0,v238
s_nop 1
v_cndmask_b32 v156,0,v240,vcc
v_cmp_eq_u32 vcc,1,v238
s_nop 1
v_cndmask_b32 v157,0,v240,vcc
v_cmp_eq_u32 vcc,2,v238
s_nop 1
v_cndmask_b32 v158,0,v240,vcc
v_cmp_eq_u32 vcc,3,v238
s_nop 1
v_cndmask_b32 v159,0,v240,vcc
s_mov_b32 s4,s32
s_mov_b32 s5,s33
s_mov_b32 s6,1024
s_mov_b32 s7,0x20000
buffer_load_dwordx4 v[224:227],v0,s[4:7],0 offen
v_and_b32 v238,15,v1
v_lshrrev_b32 v239,4,v1
v_lshlrev_b32 v240,2,v239
v_mov_b32 v241,0xf149f2ca
s_and_b32 s56,s46,1
s_lshl_b32 s56,s56,4
v_add_u32 v242,s56,v238
v_add_u32 v243,0,v240
v_cmp_gt_u32 vcc,v243,v242
s_nop 1
v_cndmask_b32 v8,0,v241,vcc
v_add_u32 v243,1,v240
v_cmp_gt_u32 vcc,v243,v242
s_nop 1
v_cndmask_b32 v9,0,v241,vcc
v_add_u32 v243,2,v240
v_cmp_gt_u32 vcc,v243,v242
s_nop 1
v_cndmask_b32 v10,0,v241,vcc
v_add_u32 v243,3,v240
v_cmp_gt_u32 vcc,v243,v242
s_nop 1
v_cndmask_b32 v11,0,v241,vcc
v_add_u32 v243,16,v240
v_cmp_gt_u32 vcc,v243,v242
s_nop 1
v_cndmask_b32 v12,0,v241,vcc
v_add_u32 v243,17,v240
v_cmp_gt_u32 vcc,v243,v242
s_nop 1
v_cndmask_b32 v13,0,v241,vcc
v_add_u32 v243,18,v240
v_cmp_gt_u32 vcc,v243,v242
s_nop 1
v_cndmask_b32 v14,0,v241,vcc
v_add_u32 v243,19,v240
v_cmp_gt_u32 vcc,v243,v242
s_nop 1
v_cndmask_b32 v15,0,v241,vcc
v_mov_b64 v[152:153],s[28:29]
v_mov_b64 v[154:155],s[28:29]
v_mov_b32 v145,0
v_mov_b32 v146,0
s_lshl_b32 s56,s46,12
s_add_u32 s56,s56,131072
v_add_u32 v3,s56,v0
v_add_u32 v4,131072,v0
s_lshl_b32 s56,s46,8
v_lshlrev_b32 v7,4,v238
v_add_u32 v7,s56,v7
v_lshl_add_u32 v5,v239,16,v7
v_lshlrev_b32 v6,1,v7
v_lshl_add_u32 v7,v239,10,v7
v_and_b32 v243,1,v239
v_lshl_add_u32 v6,v243,4,v6
v_lshrrev_b32 v243,1,v239
v_lshl_add_u32 v6,v243,12,v6
v_add_u32 v6,147456,v6
v_lshlrev_b32 v16,2,v238
v_lshlrev_b32 v21,3,v238
s_and_b32 s68,s47,15
s_lshl_b32 s56,s68,10
v_add_u32 v5,s56,v5
s_lshl_b32 s56,s68,15
v_add_u32 v7,s56,v7
s_lshl_b32 s69,s54,20
s_add_u32 s69,s69,20971520
s_lshl_b32 s87,s54,13
s_add_u32 s87,s87,10486656
s_lshl2_add_u32 s74,s68,s87
s_or_b32 s74,s74,s52
s_lshl_b32 s68,s68,1
s_lshr_b32 s56,s46,1
s_add_u32 s68,s68,s56
s_mov_b32 s66,0
s_mov_b32 s67,0
s_mov_b32 s73,0x80000000
s_mov_b32 s75,0
s_mov_b32 s37,0
s_mov_b64 s[38:39],0
s_sub_u32 s36,s54,11
s_and_b32 s36,s36,3
s_mov_b32 s12,s40
s_mov_b32 s13,s41
s_mov_b32 s14,2097152
s_mov_b32 s15,0x20000
v_add_u32 v21,10487168,v21
v_mov_b32 v244,v21
s_and_b32 s56,s50,2048
s_add_u32 s56,s56,147456
v_lshlrev_b32 v23,5,v1
v_add_u32 v23,s56,v23
v_and_b32 v253,32,v0
v_lshrrev_b32 v245,2,v253
v_add_u32 v253,v253,v245
v_sub_u32 v253,v0,v253
v_add_u32 v253,8,v253
v_mov_b32 v254,0x80000000
s_mov_b32 s56,1408
v_writelane_b32 v254,s56,0
s_mov_b32 s56,256
v_writelane_b32 v254,s56,1
s_mov_b32 s56,1280
v_writelane_b32 v254,s56,2
v_mov_b32 v245,155648
s_lshl_b32 s56,s46,2
v_add_u32 v247,s56,v245
s_waitcnt vmcnt(0)
v_lshlrev_b32 v228,16,v224
v_and_b32 v229,0xffff0000,v224
v_lshlrev_b32 v230,16,v225
v_and_b32 v231,0xffff0000,v225
v_lshlrev_b32 v232,16,v226
v_and_b32 v233,0xffff0000,v226
v_lshlrev_b32 v234,16,v227
v_and_b32 v235,0xffff0000,v227
s_cmp_lt_u32 s54,2
s_cbranch_scc1 L_aa_58
s_sub_u32 s77,s54,2
s_mov_b32 s30,0
s_mov_b32 s86,1536
s_lshl_b32 s56,s77,5
s_add_u32 s56,s56,s68
s_mul_i32 s70,s56,24576
s_lshl_b32 s71,s56,12
s_lshl_b32 s59,s77,13
s_lshl2_add_u32 s59,s68,s59
s_add_u32 s59,s59,10485760
s_buffer_load_dword s32,s[8:11],s59 glc
s_mov_b32 s33,1
s_add_u32 s70,s70,100663296
s_add_u32 s71,s71,41943040
v_mov_b32 v19,s59
s_branch L_aa_66
L_aa_72:
s_bitcmp1_b32 s46,0
s_cbranch_scc1 L_av_73
ds_read_b128 v[24:27],v4 offset:0
ds_read_b128 v[28:31],v4 offset:1024
s_min_u32 s56,s32,s33
s_cmp_lt_u32 s77,64
s_cselect_b32 s56,s56,0
s_cmp_eq_u32 s56,0
s_cselect_b32 s72,0x80000000,0
v_mov_b32 v248,s72
s_or_b32 s64,s70,s72
s_or_b32 s65,s71,s72
s_and_b32 s57,s46,1
s_mul_i32 s58,s57,12288
s_add_u32 s64,s64,s58
s_lshl_b32 s57,s57,11
s_waitcnt lgkmcnt(1)
v_mfma_f32_16x16x32_bf16 v[160:163],v[24:27],a[0:3],0
ds_read_b128 v[32:35],v4 offset:2048
s_add_u32 s65,s65,s57
s_and_b32 s59,s50,2048
v_mfma_f32_16x16x32_bf16 v[164:167],v[24:27],a[4:7],0
ds_read_b128 v[36:39],v4 offset:3072
s_lshl_b32 s59,s59,4
s_xor_b32 s60,s67,65536
v_mfma_f32_16x16x32_bf16 v[168:171],v[24:27],a[8:11],0
ds_read_b128 v[40:43],v4 offset:8192
s_add_u32 s59,s59,s60
s_add_u32 s58,s58,s59
v_mfma_f32_16x16x32_bf16 v[172:175],v[24:27],a[12:15],0
ds_read_b128 v[44:47],v4 offset:9216
s_add_u32 s57,s57,s59
s_add_u32 m0,s58,0
v_mfma_f32_16x16x32_bf16 v[176:179],v[24:27],a[16:19],0
buffer_load_dwordx4 v0,s[8:11],s64 offen offset:0 sc1 lds
v_lshlrev_b32 v88,16,v224
v_and_b32 v89,0xffff0000,v224
v_mfma_f32_16x16x32_bf16 v[180:183],v[24:27],a[20:23],0
ds_read_b128 v[48:51],v4 offset:10240
v_lshlrev_b32 v90,16,v225
v_and_b32 v91,0xffff0000,v225
v_mfma_f32_16x16x32_bf16 v[184:187],v[24:27],a[24:27],0
ds_read_b128 v[52:55],v4 offset:11264
s_waitcnt vmcnt(8)
v_mfma_f32_16x16x32_bf16 v[128:131],v[156:159],v[192:195],0
ds_write_b32 v247,v248
v_lshlrev_b32 v92,16,v226
v_and_b32 v93,0xffff0000,v226
v_mfma_f32_16x16x32_bf16 v[188:191],v[24:27],a[28:31],0
ds_read_b128 v[56:59],v4 offset:4096
s_waitcnt vmcnt(7)
v_mfma_f32_16x16x32_bf16 v[128:131],v[156:159],v[196:199],v[128:131]
ds_read_b128 v[60:63],v4 offset:5120
v_lshlrev_b32 v94,16,v227
v_and_b32 v95,0xffff0000,v227
s_waitcnt lgkmcnt(9)
v_mfma_f32_16x16x32_bf16 v[160:163],v[28:31],a[32:35],v[160:163]
buffer_load_dwordx4 v0,s[8:11],s64 offen offset:1024 sc1 lds
s_waitcnt vmcnt(7)
v_mfma_f32_16x16x32_bf16 v[128:131],v[156:159],v[200:203],v[128:131]
ds_read_b128 v[64:67],v4 offset:6144
v_readfirstlane_b32 s22,v246
s_cmp_eq_u32 s22,0
s_cbranch_scc1 L_ag_74
L_agb_75:
v_mfma_f32_16x16x32_bf16 v[164:167],v[28:31],a[36:39],v[164:167]
ds_read_b128 v[68:71],v4 offset:7168
s_waitcnt vmcnt(6)
v_mfma_f32_16x16x32_bf16 v[128:131],v[156:159],v[204:207],v[128:131]
ds_read_b128 v[72:75],v4 offset:12288
s_lshl_b32 s18,s26,5
s_add_u32 s18,s18,s68
v_mfma_f32_16x16x32_bf16 v[168:171],v[28:31],a[40:43],v[168:171]
ds_read_b128 v[76:79],v4 offset:13312
s_waitcnt vmcnt(5)
v_mfma_f32_16x16x32_bf16 v[132:135],v[156:159],v[208:211],0
ds_read_b128 v[80:83],v4 offset:14336
s_lshl_b32 s19,s18,10
s_add_u32 s20,s19,6291456
v_mfma_f32_16x16x32_bf16 v[172:175],v[28:31],a[44:47],v[172:175]
ds_read_b128 v[84:87],v4 offset:15360
s_waitcnt vmcnt(4)
v_mfma_f32_16x16x32_bf16 v[132:135],v[156:159],v[212:215],v[132:135]
s_lshl_b32 s23,s51,5
s_add_u32 s23,s23,s68
s_lshl_b32 s24,s23,10
v_mfma_f32_16x16x32_bf16 v[176:179],v[28:31],a[48:51],v[176:179]
buffer_load_dwordx4 v0,s[8:11],s64 offen offset:2048 sc1 lds
s_waitcnt vmcnt(4)
v_mfma_f32_16x16x32_bf16 v[132:135],v[156:159],v[216:219],v[132:135]
s_lshl_b32 s25,s51,10
s_add_u32 s25,s25,2883584
s_cmp_eq_u32 s23,s55
s_cselect_b32 s25,s25,s24
v_mfma_f32_16x16x32_bf16 v[180:183],v[28:31],a[52:55],v[180:183]
ds_write_b128 v6,v[128:131]
s_waitcnt vmcnt(3)
v_mfma_f32_16x16x32_bf16 v[132:135],v[156:159],v[220:223],v[132:135]
s_add_u32 s25,s25,8388608
s_mov_b32 s6,268435456
s_cmp_eq_u32 s31,0
s_cselect_b32 s25,s24,s25
s_cselect_b64 s[4:5],s[16:17],s[44:45]
s_cmov_b32 s6,2097152
v_mfma_f32_16x16x32_bf16 v[184:187],v[28:31],a[56:59],v[184:187]
buffer_load_dwordx4 v[224:227],v0,s[4:7],s25 offen sc1
s_lshr_b32 s24,s55,5
s_cmp_lt_u32 s51,s24
s_cselect_b32 s24,1,2
v_mfma_f32_16x16x32_bf16 v[188:191],v[28:31],a[60:63],v[188:191]
v_mov_b32 v252,s24
s_lshl2_add_u32 s25,s51,11018240
s_waitcnt lgkmcnt(15)
v_mfma_f32_16x16x32_bf16 v[160:163],v[32:35],a[64:67],v[160:163]
ds_write_b128 v6,v[132:135] offset:2048
s_lshl_b32 s24,s68,16
s_add_u32 s24,s24,s31
v_mfma_f32_16x16x32_bf16 v[164:167],v[32:35],a[68:71],v[164:167]
buffer_load_dwordx4 v0,s[8:11],s64 offen offset:3072 sc1 lds
s_add_u32 s24,s24,s86
s_cmp_eq_u32 s24,1537
s_cselect_b32 s25,s25,0x80000000
v_mfma_f32_16x16x32_bf16 v[168:171],v[32:35],a[72:75],v[168:171]
buffer_store_dword v252,off,s[8:11],s25 sc1
s_bitcmp1_b64 s[38:39],s51
s_cselect_b32 s24,128,0
v_mfma_f32_16x16x32_bf16 v[172:175],v[32:35],a[76:79],v[172:175]
s_lshl_b32 s23,s51,13
s_lshl2_add_u32 s23,s68,s23
s_add_u32 s23,s23,10487168
v_mfma_f32_16x16x32_bf16 v[176:179],v[32:35],a[80:83],v[176:179]
s_waitcnt lgkmcnt(0)
s_barrier
s_add_u32 s23,s23,s24
v_mfma_f32_16x16x32_bf16 v[180:183],v[32:35],a[84:87],v[180:183]
ds_read_b128 v[96:99],v23
s_add_u32 m0,s58,4096
s_add_u32 s64,s64,4096
v_mfma_f32_16x16x32_bf16 v[184:187],v[32:35],a[88:91],v[184:187]
ds_read_b128 v[100:103],v23 offset:16
v_mfma_f32_16x16x32_bf16 v[188:191],v[32:35],a[92:95],v[188:191]
buffer_load_dwordx4 v0,s[8:11],s64 offen offset:0 sc1 lds
v_mfma_f32_16x16x32_bf16 v[160:163],v[36:39],a[96:99],v[160:163]
ds_read_b128 v[248:251],v245
v_mfma_f32_16x16x32_bf16 v[164:167],v[36:39],a[100:103],v[164:167]
buffer_load_dword v246,off,s[8:11],s23 sc1
v_lshrrev_b32 v244,4,v1
s_sub_u32 s23,s77,8
v_add_u32 v244,s23,v244
v_mfma_f32_16x16x32_bf16 v[168:171],v[36:39],a[104:107],v[168:171]
v_max_i32 v244,0,v244
v_lshl_add_u32 v244,v244,13,v21
v_mfma_f32_16x16x32_bf16 v[172:175],v[36:39],a[108:111],v[172:175]
buffer_load_dwordx4 v0,s[8:11],s64 offen offset:1024 sc1 lds
s_waitcnt lgkmcnt(1)
v_cvt_pk_bf16_f32 v104,v96,v97
v_cvt_pk_bf16_f32 v105,v98,v99
v_mfma_f32_16x16x32_bf16 v[176:179],v[36:39],a[112:115],v[176:179]
buffer_load_dwordx2 v[242:243],v244,s[8:11],0 offen sc1
v_cvt_pk_bf16_f32 v106,v100,v101
v_cvt_pk_bf16_f32 v107,v102,v103
v_lshlrev_b32 v96,16,v104
v_mfma_f32_16x16x32_bf16 v[180:183],v[36:39],a[116:119],v[180:183]
v_and_b32 v97,0xffff0000,v104
v_lshlrev_b32 v98,16,v105
v_mfma_f32_16x16x32_bf16 v[184:187],v[36:39],a[120:123],v[184:187]
s_waitcnt lgkmcnt(0)
v_or3_b32 v248,v248,v249,v250
v_or_b32 v248,v248,v251
v_mfma_f32_16x16x32_bf16 v[188:191],v[36:39],a[124:127],v[188:191]
buffer_load_dwordx4 v0,s[8:11],s64 offen offset:2048 sc1 lds
v_and_b32 v99,0xffff0000,v105
v_lshlrev_b32 v100,16,v106
v_mfma_f32_16x16x32_bf16 v[160:163],v[40:43],a[128:131],v[160:163]
v_readfirstlane_b32 s72,v248
v_and_b32 v101,0xffff0000,v106
v_mfma_f32_16x16x32_bf16 v[164:167],v[40:43],a[132:135],v[164:167]
v_lshlrev_b32 v102,16,v107
v_and_b32 v103,0xffff0000,v107
v_mfma_f32_16x16x32_bf16 v[168:171],v[40:43],a[136:139],v[168:171]
v_add_f32 v88,v88,v96
v_add_f32 v89,v89,v97
v_mfma_f32_16x16x32_bf16 v[172:175],v[40:43],a[140:143],v[172:175]
buffer_load_dwordx4 v0,s[8:11],s64 offen offset:3072 sc1 lds
v_add_f32 v90,v90,v98
v_add_f32 v91,v91,v99
v_mfma_f32_16x16x32_bf16 v[176:179],v[40:43],a[144:147],v[176:179]
v_add_f32 v92,v92,v100
v_add_f32 v93,v93,v101
v_mfma_f32_16x16x32_bf16 v[180:183],v[40:43],a[148:151],v[180:183]
v_add_f32 v94,v94,v102
v_add_f32 v95,v95,v103
v_mfma_f32_16x16x32_bf16 v[184:187],v[40:43],a[152:155],v[184:187]
v_cvt_pk_bf16_f32 v104,v88,v89
v_cvt_pk_bf16_f32 v105,v90,v91
v_mfma_f32_16x16x32_bf16 v[188:191],v[40:43],a[156:159],v[188:191]
s_add_u32 m0,s58,8192
s_add_u32 s64,s64,4096
v_cvt_pk_bf16_f32 v106,v92,v93
v_mfma_f32_16x16x32_bf16 v[160:163],v[44:47],a[160:163],v[160:163]
buffer_load_dwordx4 v0,s[8:11],s64 offen offset:0 sc1 lds
v_cvt_pk_bf16_f32 v107,v94,v95
v_mfma_f32_16x16x32_bf16 v[164:167],v[44:47],a[164:167],v[164:167]
buffer_store_dwordx4 v[104:107],v0,s[8:11],s20 offen sc1
v_lshlrev_b32 v88,16,v104
v_and_b32 v89,0xffff0000,v104
v_lshlrev_b32 v90,16,v105
v_mfma_f32_16x16x32_bf16 v[168:171],v[44:47],a[168:171],v[168:171]
v_and_b32 v91,0xffff0000,v105
v_lshlrev_b32 v92,16,v106
v_and_b32 v93,0xffff0000,v106
v_mfma_f32_16x16x32_bf16 v[172:175],v[44:47],a[172:175],v[172:175]
v_lshlrev_b32 v94,16,v107
v_and_b32 v95,0xffff0000,v107
v_mfma_f32_16x16x32_bf16 v[176:179],v[44:47],a[176:179],v[176:179]
buffer_load_dwordx4 v0,s[8:11],s64 offen offset:1024 sc1 lds
v_readfirstlane_b32 s78,v88
v_mfma_f32_16x16x32_bf16 v[180:183],v[44:47],a[180:183],v[180:183]
s_nop 0
v_add_f32 v120,v88,-s78
v_add_f32 v121,v89,-s78
v_add_f32 v122,v90,-s78
v_mfma_f32_16x16x32_bf16 v[184:187],v[44:47],a[184:187],v[184:187]
v_add_f32 v123,v91,-s78
v_add_f32 v124,v92,-s78
v_mfma_f32_16x16x32_bf16 v[188:191],v[44:47],a[188:191],v[188:191]
v_add_f32 v125,v93,-s78
v_add_f32 v126,v94,-s78
v_mfma_f32_16x16x32_bf16 v[160:163],v[48:51],a[192:195],v[160:163]
buffer_load_dwordx4 v0,s[8:11],s64 offen offset:2048 sc1 lds
v_add_f32 v127,v95,-s78
v_add_f32 v128,v120,v122
v_mfma_f32_16x16x32_bf16 v[164:167],v[48:51],a[196:199],v[164:167]
v_add_f32 v129,v121,v123
v_mul_f32 v130,v120,v120
v_mfma_f32_16x16x32_bf16 v[168:171],v[48:51],a[200:203],v[168:171]
v_mul_f32 v131,v121,v121
v_add_f32 v132,v124,v126
v_mfma_f32_16x16x32_bf16 v[172:175],v[48:51],a[204:207],v[172:175]
v_add_f32 v133,v125,v127
v_fma_f32 v130,v122,v122,v130
v_mfma_f32_16x16x32_bf16 v[176:179],v[48:51],a[208:211],v[176:179]
buffer_load_dwordx4 v0,s[8:11],s64 offen offset:3072 sc1 lds
v_fma_f32 v131,v123,v123,v131
v_add_f32 v128,v128,v132
v_mfma_f32_16x16x32_bf16 v[180:183],v[48:51],a[212:215],v[180:183]
v_add_f32 v129,v129,v133
v_fma_f32 v130,v124,v124,v130
v_mfma_f32_16x16x32_bf16 v[184:187],v[48:51],a[216:219],v[184:187]
v_fma_f32 v131,v125,v125,v131
v_add_f32 v128,v128,v129
v_mfma_f32_16x16x32_bf16 v[188:191],v[48:51],a[220:223],v[188:191]
v_fma_f32 v130,v126,v126,v130
v_fma_f32 v131,v127,v127,v131
v_mfma_f32_16x16x32_bf16 v[160:163],v[52:55],a[224:227],v[160:163]
s_add_u32 m0,s57,24576
v_add_f32 v130,v130,v131
v_mfma_f32_16x16x32_bf16 v[164:167],v[52:55],a[228:231],v[164:167]
buffer_load_dwordx4 v0,s[8:11],s65 offen offset:0 sc1 lds
v_permlane32_swap_b32 v128,v130
v_add_f32 v128,v128,v130
v_mfma_f32_16x16x32_bf16 v[168:171],v[52:55],a[232:235],v[168:171]
s_nop 0
v_add_f32_dpp v128,v128,v128 row_ror:8 row_mask:0xf bank_mask:0xf
v_mfma_f32_16x16x32_bf16 v[172:175],v[52:55],a[236:239],v[172:175]
s_nop 0
v_add_f32_dpp v128,v128,v128 row_ror:4 row_mask:0xf bank_mask:0xf
v_mfma_f32_16x16x32_bf16 v[176:179],v[52:55],a[240:243],v[176:179]
s_nop 0
v_add_f32_dpp v128,v128,v128 row_ror:2 row_mask:0xf bank_mask:0xf
v_mfma_f32_16x16x32_bf16 v[180:183],v[52:55],a[244:247],v[180:183]
buffer_load_dwordx4 v0,s[8:11],s65 offen offset:1024 sc1 lds
v_add_f32_dpp v128,v128,v128 row_ror:1 row_mask:0xf bank_mask:0xf
v_mov_b32 v130,v128
v_mfma_f32_16x16x32_bf16 v[184:187],v[52:55],a[248:251],v[184:187]
s_nop 0
v_permlane16_swap_b32 v128,v130
v_add_f32 v128,v128,v130
v_mul_f32 v128,0x3b000000,v128
v_mfma_f32_16x16x32_bf16 v[188:191],v[52:55],a[252:255],v[188:191]
v_mov_b32 v130,v128
v_mfma_f32_16x16x32_bf16 v[192:195],v[56:59],a[0:3],0
s_nop 0
v_permlane32_swap_b32 v128,v130
v_fma_f32 v130,-v128,v128,v130
v_add_f32 v128,s78,v128
v_mfma_f32_16x16x32_bf16 v[196:199],v[56:59],a[4:7],0
v_max_f32 v130,0,v130
v_cvt_pk_bf16_f32 v130,v128,v130
v_lshlrev_b32 v128,16,v130
v_mfma_f32_16x16x32_bf16 v[200:203],v[56:59],a[8:11],0
v_and_b32 v130,0xffff0000,v130
v_add_f32 v130,0x3727c5ac,v130
v_cvt_pk_bf16_f32 v130,v130,v130
v_mfma_f32_16x16x32_bf16 v[204:207],v[56:59],a[12:15],0
v_and_b32 v130,0xffff0000,v130
v_sqrt_f32 v130,v130
v_add_f32 v120,v88,-v128
v_mfma_f32_16x16x32_bf16 v[208:211],v[56:59],a[16:19],0
v_add_f32 v121,v89,-v128
v_add_f32 v122,v90,-v128
v_mfma_f32_16x16x32_bf16 v[212:215],v[56:59],a[20:23],0
v_add_f32 v123,v91,-v128
v_add_f32 v124,v92,-v128
v_mfma_f32_16x16x32_bf16 v[216:219],v[56:59],a[24:27],0
v_add_f32 v125,v93,-v128
v_add_f32 v126,v94,-v128
v_mfma_f32_16x16x32_bf16 v[220:223],v[56:59],a[28:31],0
v_add_f32 v127,v95,-v128
v_cvt_pk_bf16_f32 v130,v130,v130
v_mfma_f32_16x16x32_bf16 v[192:195],v[60:63],a[32:35],v[192:195]
v_and_b32 v130,0xffff0000,v130
v_rcp_f32 v130,v130
v_mfma_f32_16x16x32_bf16 v[196:199],v[60:63],a[36:39],v[196:199]
v_cvt_pk_bf16_f32 v108,v120,v121
v_cvt_pk_bf16_f32 v109,v122,v123
v_mfma_f32_16x16x32_bf16 v[200:203],v[60:63],a[40:43],v[200:203]
v_cvt_pk_bf16_f32 v110,v124,v125
v_cvt_pk_bf16_f32 v111,v126,v127
v_mfma_f32_16x16x32_bf16 v[204:207],v[60:63],a[44:47],v[204:207]
v_lshlrev_b32 v120,16,v108
v_and_b32 v121,0xffff0000,v108
v_mfma_f32_16x16x32_bf16 v[208:211],v[60:63],a[48:51],v[208:211]
v_lshlrev_b32 v122,16,v109
v_and_b32 v123,0xffff0000,v109
v_mfma_f32_16x16x32_bf16 v[212:215],v[60:63],a[52:55],v[212:215]
v_lshlrev_b32 v124,16,v110
v_and_b32 v125,0xffff0000,v110
v_mfma_f32_16x16x32_bf16 v[216:219],v[60:63],a[56:59],v[216:219]
v_lshlrev_b32 v126,16,v111
v_and_b32 v127,0xffff0000,v111
v_mfma_f32_16x16x32_bf16 v[220:223],v[60:63],a[60:63],v[220:223]
v_mul_f32 v120,v120,v130
v_mul_f32 v121,v121,v130
v_mfma_f32_16x16x32_bf16 v[192:195],v[64:67],a[64:67],v[192:195]
v_mul_f32 v122,v122,v130
v_mul_f32 v123,v123,v130
v_mfma_f32_16x16x32_bf16 v[196:199],v[64:67],a[68:71],v[196:199]
v_mul_f32 v124,v124,v130
v_mul_f32 v125,v125,v130
v_mfma_f32_16x16x32_bf16 v[200:203],v[64:67],a[72:75],v[200:203]
v_mul_f32 v126,v126,v130
v_mul_f32 v127,v127,v130
v_mfma_f32_16x16x32_bf16 v[204:207],v[64:67],a[76:79],v[204:207]
v_cvt_pk_bf16_f32 v108,v120,v121
v_cvt_pk_bf16_f32 v109,v122,v123
v_mfma_f32_16x16x32_bf16 v[208:211],v[64:67],a[80:83],v[208:211]
v_cvt_pk_bf16_f32 v24,v160,v164
v_cvt_pk_bf16_f32 v25,v168,v172
v_mfma_f32_16x16x32_bf16 v[212:215],v[64:67],a[84:87],v[212:215]
v_cvt_pk_bf16_f32 v26,v176,v180
v_cvt_pk_bf16_f32 v27,v184,v188
v_mfma_f32_16x16x32_bf16 v[216:219],v[64:67],a[88:91],v[216:219]
v_cvt_pk_bf16_f32 v28,v161,v165
v_cvt_pk_bf16_f32 v29,v169,v173
v_mfma_f32_16x16x32_bf16 v[220:223],v[64:67],a[92:95],v[220:223]
v_cvt_pk_bf16_f32 v30,v177,v181
v_cvt_pk_bf16_f32 v31,v185,v189
v_mfma_f32_16x16x32_bf16 v[192:195],v[68:71],a[96:99],v[192:195]
v_cvt_pk_bf16_f32 v32,v162,v166
v_cvt_pk_bf16_f32 v33,v170,v174
v_mfma_f32_16x16x32_bf16 v[196:199],v[68:71],a[100:103],v[196:199]
v_cvt_pk_bf16_f32 v34,v178,v182
v_cvt_pk_bf16_f32 v35,v186,v190
v_mfma_f32_16x16x32_bf16 v[200:203],v[68:71],a[104:107],v[200:203]
v_cvt_pk_bf16_f32 v36,v163,v167
v_cvt_pk_bf16_f32 v37,v171,v175
v_mfma_f32_16x16x32_bf16 v[204:207],v[68:71],a[108:111],v[204:207]
v_cvt_pk_bf16_f32 v38,v179,v183
v_cvt_pk_bf16_f32 v39,v187,v191
v_mfma_f32_16x16x32_bf16 v[208:211],v[68:71],a[112:115],v[208:211]
s_add_u32 s62,s69,0
v_cvt_pk_bf16_f32 v110,v124,v125
v_cvt_pk_bf16_f32 v111,v126,v127
v_mfma_f32_16x16x32_bf16 v[212:215],v[68:71],a[116:119],v[212:215]
buffer_store_dwordx4 v[24:27],v5,s[8:11],s62 offen
v_lshlrev_b32 v112,16,v108
v_and_b32 v113,0xffff0000,v108
v_mfma_f32_16x16x32_bf16 v[216:219],v[68:71],a[120:123],v[216:219]
v_lshlrev_b32 v114,16,v109
v_and_b32 v115,0xffff0000,v109
v_mfma_f32_16x16x32_bf16 v[220:223],v[68:71],a[124:127],v[220:223]
v_lshlrev_b32 v116,16,v110
v_and_b32 v117,0xffff0000,v110
v_mfma_f32_16x16x32_bf16 v[192:195],v[72:75],a[128:131],v[192:195]
s_add_u32 s62,s69,16384
v_lshlrev_b32 v118,16,v111
v_and_b32 v119,0xffff0000,v111
v_mfma_f32_16x16x32_bf16 v[196:199],v[72:75],a[132:135],v[196:199]
buffer_store_dwordx4 v[28:31],v5,s[8:11],s62 offen
v_add_f32 v88,v88,v112
v_add_f32 v89,v89,v113
v_mfma_f32_16x16x32_bf16 v[200:203],v[72:75],a[136:139],v[200:203]
v_add_f32 v90,v90,v114
v_add_f32 v91,v91,v115
v_mfma_f32_16x16x32_bf16 v[204:207],v[72:75],a[140:143],v[204:207]
v_add_f32 v92,v92,v116
v_add_f32 v93,v93,v117
v_mfma_f32_16x16x32_bf16 v[208:211],v[72:75],a[144:147],v[208:211]
s_add_u32 s62,s69,32768
v_add_f32 v94,v94,v118
v_add_f32 v95,v95,v119
v_mfma_f32_16x16x32_bf16 v[212:215],v[72:75],a[148:151],v[212:215]
buffer_store_dwordx4 v[32:35],v5,s[8:11],s62 offen
v_cvt_pk_bf16_f32 v96,v88,v89
v_cvt_pk_bf16_f32 v97,v90,v91
v_mfma_f32_16x16x32_bf16 v[216:219],v[72:75],a[152:155],v[216:219]
v_cvt_pk_bf16_f32 v98,v92,v93
v_cvt_pk_bf16_f32 v99,v94,v95
v_mfma_f32_16x16x32_bf16 v[220:223],v[72:75],a[156:159],v[220:223]
buffer_store_dwordx4 v[96:99],v0,s[12:15],s19 offen sc1
v_mul_f32 v236,v112,v228
v_mul_f32 v237,v113,v229
v_mfma_f32_16x16x32_bf16 v[192:195],v[76:79],a[160:163],v[192:195]
s_add_u32 s62,s69,49152
v_fma_f32 v236,v114,v230,v236
v_fma_f32 v237,v115,v231,v237
v_mfma_f32_16x16x32_bf16 v[196:199],v[76:79],a[164:167],v[196:199]
buffer_store_dwordx4 v[36:39],v5,s[8:11],s62 offen
v_fma_f32 v236,v116,v232,v236
v_fma_f32 v237,v117,v233,v237
v_mfma_f32_16x16x32_bf16 v[200:203],v[76:79],a[168:171],v[200:203]
v_fma_f32 v236,v118,v234,v236
v_fma_f32 v237,v119,v235,v237
v_mfma_f32_16x16x32_bf16 v[204:207],v[76:79],a[172:175],v[204:207]
v_add_f32 v236,v236,v237
v_mfma_f32_16x16x32_bf16 v[208:211],v[76:79],a[176:179],v[208:211]
s_nop 0
v_add_f32_dpp v236,v236,v236 row_ror:8 row_mask:0xf bank_mask:0xf
v_mfma_f32_16x16x32_bf16 v[212:215],v[76:79],a[180:183],v[212:215]
s_nop 0
v_add_f32_dpp v236,v236,v236 row_ror:4 row_mask:0xf bank_mask:0xf
v_mfma_f32_16x16x32_bf16 v[216:219],v[76:79],a[184:187],v[216:219]
s_nop 0
v_add_f32_dpp v236,v236,v236 row_ror:2 row_mask:0xf bank_mask:0xf
v_mfma_f32_16x16x32_bf16 v[220:223],v[76:79],a[188:191],v[220:223]
s_nop 0
v_add_f32_dpp v236,v236,v236 row_ror:1 row_mask:0xf bank_mask:0xf
v_mov_b32 v237,v236
v_mfma_f32_16x16x32_bf16 v[192:195],v[80:83],a[192:195],v[192:195]
s_nop 0
v_permlane16_swap_b32 v236,v237
v_add_f32 v236,v236,v237
v_mov_b32 v237,v236
v_mfma_f32_16x16x32_bf16 v[196:199],v[80:83],a[196:199],v[196:199]
s_nop 0
v_permlane32_swap_b32 v236,v237
v_add_f32 v236,v236,v237
v_cvt_pk_bf16_f32 v236,v236,v236
v_mfma_f32_16x16x32_bf16 v[200:203],v[80:83],a[200:203],v[200:203]
v_and_b32 v236,0xffff0000,v236
v_ashrrev_i32 v237,31,v236
v_or_b32 v237,0x80000000,v237
v_mfma_f32_16x16x32_bf16 v[204:207],v[80:83],a[204:207],v[204:207]
v_xor_b32 v236,v236,v237
v_and_b32 v236,0xffff0000,v236
s_sub_u32 s20,4095,s18
v_mfma_f32_16x16x32_bf16 v[208:211],v[80:83],a[208:211],v[208:211]
v_or_b32 v20,s20,v236
s_lshl_b32 s73,s26,13
s_lshl2_add_u32 s73,s68,s73
v_mfma_f32_16x16x32_bf16 v[212:215],v[80:83],a[212:215],v[212:215]
s_add_u32 s73,s73,10485760
s_add_u32 s73,s73,s86
v_mfma_f32_16x16x32_bf16 v[216:219],v[80:83],a[216:219],v[216:219]
v_mfma_f32_16x16x32_bf16 v[220:223],v[80:83],a[220:223],v[220:223]
v_mfma_f32_16x16x32_bf16 v[192:195],v[84:87],a[224:227],v[192:195]
v_mfma_f32_16x16x32_bf16 v[196:199],v[84:87],a[228:231],v[196:199]
v_mfma_f32_16x16x32_bf16 v[200:203],v[84:87],a[232:235],v[200:203]
v_mfma_f32_16x16x32_bf16 v[204:207],v[84:87],a[236:239],v[204:207]
v_mfma_f32_16x16x32_bf16 v[208:211],v[84:87],a[240:243],v[208:211]
v_mfma_f32_16x16x32_bf16 v[212:215],v[84:87],a[244:247],v[212:215]
v_mfma_f32_16x16x32_bf16 v[216:219],v[84:87],a[248:251],v[216:219]
v_mfma_f32_16x16x32_bf16 v[220:223],v[84:87],a[252:255],v[220:223]
v_cvt_pk_bf16_f32 v40,v192,v196
v_cvt_pk_bf16_f32 v41,v200,v204
v_cvt_pk_bf16_f32 v42,v208,v212
s_nop 4
v_cvt_pk_bf16_f32 v43,v216,v220
s_add_u32 s62,s69,262144
buffer_store_dwordx4 v[40:43],v5,s[8:11],s62 offen
v_cvt_pk_bf16_f32 v44,v193,v197
v_cvt_pk_bf16_f32 v45,v201,v205
v_cvt_pk_bf16_f32 v46,v209,v213
v_cvt_pk_bf16_f32 v47,v217,v221
s_add_u32 s62,s69,278528
buffer_store_dwordx4 v[44:47],v5,s[8:11],s62 offen
v_cvt_pk_bf16_f32 v48,v194,v198
v_cvt_pk_bf16_f32 v49,v202,v206
v_cvt_pk_bf16_f32 v50,v210,v214
v_cvt_pk_bf16_f32 v51,v218,v222
s_add_u32 s62,s69,294912
buffer_store_dwordx4 v[48:51],v5,s[8:11],s62 offen
v_cvt_pk_bf16_f32 v52,v195,v199
v_cvt_pk_bf16_f32 v53,v203,v207
v_cvt_pk_bf16_f32 v54,v211,v215
v_cvt_pk_bf16_f32 v55,v219,v223
s_add_u32 s62,s69,311296
buffer_store_dwordx4 v[52:55],v5,s[8:11],s62 offen
s_cmp_lg_u32 s72,0
s_cbranch_scc1 L_aa_61
s_waitcnt vmcnt(9)
s_branch L_aa_71
L_av_73:
ds_read_b128 v[24:27],v4 offset:0
ds_read_b128 v[28:31],v4 offset:1024
s_min_u32 s56,s32,s33
s_cmp_lt_u32 s77,64
s_cselect_b32 s56,s56,0
s_cmp_eq_u32 s56,0
s_cselect_b32 s72,0x80000000,0
v_mov_b32 v248,s72
s_or_b32 s64,s70,s72
s_or_b32 s65,s71,s72
s_and_b32 s57,s46,1
s_mul_i32 s58,s57,12288
s_add_u32 s64,s64,s58
s_lshl_b32 s57,s57,11
s_waitcnt lgkmcnt(1)
v_mfma_f32_16x16x32_bf16 v[160:163],v[24:27],a[0:3],0
ds_read_b128 v[32:35],v4 offset:2048
s_add_u32 s65,s65,s57
s_and_b32 s59,s50,2048
v_mfma_f32_16x16x32_bf16 v[164:167],v[24:27],a[4:7],0
ds_read_b128 v[36:39],v4 offset:3072
s_lshl_b32 s59,s59,4
s_xor_b32 s60,s67,65536
v_mfma_f32_16x16x32_bf16 v[168:171],v[24:27],a[8:11],0
ds_read_b128 v[40:43],v4 offset:8192
s_add_u32 s59,s59,s60
s_add_u32 s58,s58,s59
v_mfma_f32_16x16x32_bf16 v[172:175],v[24:27],a[12:15],0
ds_read_b128 v[44:47],v4 offset:9216
s_add_u32 s57,s57,s59
s_add_u32 m0,s58,0
v_mfma_f32_16x16x32_bf16 v[176:179],v[24:27],a[16:19],0
buffer_load_dwordx4 v0,s[8:11],s64 offen offset:0 sc1 lds
s_lshl_b32 s23,s51,5
s_add_u32 s23,s23,s68
v_mfma_f32_16x16x32_bf16 v[180:183],v[24:27],a[20:23],0
ds_read_b128 v[48:51],v4 offset:10240
s_lshl_b32 s24,s23,10
s_lshl_b32 s25,s51,10
v_mfma_f32_16x16x32_bf16 v[184:187],v[24:27],a[24:27],0
ds_read_b128 v[52:55],v4 offset:11264
s_waitcnt vmcnt(8)
v_mfma_f32_16x16x32_bf16 v[128:131],v[156:159],v[192:195],0
ds_write_b32 v247,v248
s_add_u32 s25,s25,2883584
s_cmp_eq_u32 s23,s55
s_cselect_b32 s25,s25,s24
v_mfma_f32_16x16x32_bf16 v[188:191],v[24:27],a[28:31],0
ds_read_b128 v[56:59],v4 offset:4096
s_waitcnt vmcnt(7)
v_mfma_f32_16x16x32_bf16 v[128:131],v[156:159],v[196:199],v[128:131]
ds_read_b128 v[60:63],v4 offset:5120
s_add_u32 s25,s25,8388608
s_mov_b32 s6,268435456
s_waitcnt lgkmcnt(9)
v_mfma_f32_16x16x32_bf16 v[160:163],v[28:31],a[32:35],v[160:163]
buffer_load_dwordx4 v0,s[8:11],s64 offen offset:1024 sc1 lds
s_waitcnt vmcnt(7)
v_mfma_f32_16x16x32_bf16 v[128:131],v[156:159],v[200:203],v[128:131]
ds_read_b128 v[64:67],v4 offset:6144
s_cmp_eq_u32 s31,0
s_cselect_b32 s25,s24,s25
s_cselect_b64 s[4:5],s[16:17],s[44:45]
s_cmov_b32 s6,2097152
v_mfma_f32_16x16x32_bf16 v[164:167],v[28:31],a[36:39],v[164:167]
ds_read_b128 v[68:71],v4 offset:7168
s_waitcnt vmcnt(6)
v_mfma_f32_16x16x32_bf16 v[128:131],v[156:159],v[204:207],v[128:131]
ds_read_b128 v[72:75],v4 offset:12288
v_mfma_f32_16x16x32_bf16 v[168:171],v[28:31],a[40:43],v[168:171]
ds_read_b128 v[76:79],v4 offset:13312
s_waitcnt vmcnt(5)
v_mfma_f32_16x16x32_bf16 v[132:135],v[156:159],v[208:211],0
ds_read_b128 v[80:83],v4 offset:14336
v_mfma_f32_16x16x32_bf16 v[172:175],v[28:31],a[44:47],v[172:175]
ds_read_b128 v[84:87],v4 offset:15360
s_waitcnt vmcnt(4)
v_mfma_f32_16x16x32_bf16 v[132:135],v[156:159],v[212:215],v[132:135]
buffer_load_dwordx4 v[224:227],v0,s[4:7],s25 offen sc1
s_lshr_b32 s24,s55,5
s_cmp_lt_u32 s51,s24
s_cselect_b32 s24,1,2
v_mfma_f32_16x16x32_bf16 v[176:179],v[28:31],a[48:51],v[176:179]
buffer_load_dwordx4 v0,s[8:11],s64 offen offset:2048 sc1 lds
s_waitcnt vmcnt(5)
v_mfma_f32_16x16x32_bf16 v[132:135],v[156:159],v[216:219],v[132:135]
v_mov_b32 v252,s24
s_lshl2_add_u32 s25,s51,11018240
v_mfma_f32_16x16x32_bf16 v[180:183],v[28:31],a[52:55],v[180:183]
ds_write_b128 v6,v[128:131]
s_waitcnt vmcnt(4)
v_mfma_f32_16x16x32_bf16 v[132:135],v[156:159],v[220:223],v[132:135]
s_lshl_b32 s24,s68,16
s_add_u32 s24,s24,s31
s_add_u32 s24,s24,s86
v_mfma_f32_16x16x32_bf16 v[184:187],v[28:31],a[56:59],v[184:187]
s_cmp_eq_u32 s24,1537
s_cselect_b32 s25,s25,0x80000000
v_mfma_f32_16x16x32_bf16 v[188:191],v[28:31],a[60:63],v[188:191]
buffer_store_dword v252,off,s[8:11],s25 sc1
s_bitcmp1_b64 s[38:39],s51
s_cselect_b32 s24,128,0
s_waitcnt lgkmcnt(15)
v_mfma_f32_16x16x32_bf16 v[160:163],v[32:35],a[64:67],v[160:163]
ds_write_b128 v6,v[132:135] offset:2048
s_lshl_b32 s23,s51,13
s_lshl2_add_u32 s23,s68,s23
v_mfma_f32_16x16x32_bf16 v[164:167],v[32:35],a[68:71],v[164:167]
buffer_load_dwordx4 v0,s[8:11],s64 offen offset:3072 sc1 lds
s_add_u32 s23,s23,10487168
s_add_u32 s23,s23,s24
v_mfma_f32_16x16x32_bf16 v[168:171],v[32:35],a[72:75],v[168:171]
buffer_load_dword v246,off,s[8:11],s23 sc1
v_lshrrev_b32 v244,4,v1
s_sub_u32 s23,s77,8
v_mfma_f32_16x16x32_bf16 v[172:175],v[32:35],a[76:79],v[172:175]
v_add_u32 v244,s23,v244
v_max_i32 v244,0,v244
v_mfma_f32_16x16x32_bf16 v[176:179],v[32:35],a[80:83],v[176:179]
s_waitcnt lgkmcnt(0)
s_barrier
v_lshl_add_u32 v244,v244,13,v21
v_mfma_f32_16x16x32_bf16 v[180:183],v[32:35],a[84:87],v[180:183]
ds_read_b128 v[248:251],v245
s_add_u32 m0,s58,4096
s_add_u32 s64,s64,4096
v_mfma_f32_16x16x32_bf16 v[184:187],v[32:35],a[88:91],v[184:187]
buffer_load_dwordx4 v0,s[8:11],s64 offen offset:0 sc1 lds
v_mfma_f32_16x16x32_bf16 v[188:191],v[32:35],a[92:95],v[188:191]
buffer_load_dwordx2 v[242:243],v244,s[8:11],0 offen sc1
v_mfma_f32_16x16x32_bf16 v[160:163],v[36:39],a[96:99],v[160:163]
v_mfma_f32_16x16x32_bf16 v[164:167],v[36:39],a[100:103],v[164:167]
v_mfma_f32_16x16x32_bf16 v[168:171],v[36:39],a[104:107],v[168:171]
buffer_load_dwordx4 v0,s[8:11],s64 offen offset:1024 sc1 lds
v_mfma_f32_16x16x32_bf16 v[172:175],v[36:39],a[108:111],v[172:175]
v_mfma_f32_16x16x32_bf16 v[176:179],v[36:39],a[112:115],v[176:179]
s_waitcnt lgkmcnt(0)
v_or3_b32 v248,v248,v249,v250
v_or_b32 v248,v248,v251
v_mfma_f32_16x16x32_bf16 v[180:183],v[36:39],a[116:119],v[180:183]
v_mfma_f32_16x16x32_bf16 v[184:187],v[36:39],a[120:123],v[184:187]
buffer_load_dwordx4 v0,s[8:11],s64 offen offset:2048 sc1 lds
v_readfirstlane_b32 s72,v248
v_mfma_f32_16x16x32_bf16 v[188:191],v[36:39],a[124:127],v[188:191]
v_mfma_f32_16x16x32_bf16 v[160:163],v[40:43],a[128:131],v[160:163]
v_mfma_f32_16x16x32_bf16 v[164:167],v[40:43],a[132:135],v[164:167]
v_mfma_f32_16x16x32_bf16 v[168:171],v[40:43],a[136:139],v[168:171]
buffer_load_dwordx4 v0,s[8:11],s64 offen offset:3072 sc1 lds
v_mfma_f32_16x16x32_bf16 v[172:175],v[40:43],a[140:143],v[172:175]
v_mfma_f32_16x16x32_bf16 v[176:179],v[40:43],a[144:147],v[176:179]
v_mfma_f32_16x16x32_bf16 v[180:183],v[40:43],a[148:151],v[180:183]
v_mfma_f32_16x16x32_bf16 v[184:187],v[40:43],a[152:155],v[184:187]
s_add_u32 m0,s58,8192
s_add_u32 s64,s64,4096
v_mfma_f32_16x16x32_bf16 v[188:191],v[40:43],a[156:159],v[188:191]
buffer_load_dwordx4 v0,s[8:11],s64 offen offset:0 sc1 lds
v_mfma_f32_16x16x32_bf16 v[160:163],v[44:47],a[160:163],v[160:163]
v_mfma_f32_16x16x32_bf16 v[164:167],v[44:47],a[164:167],v[164:167]
v_mfma_f32_16x16x32_bf16 v[168:171],v[44:47],a[168:171],v[168:171]
v_mfma_f32_16x16x32_bf16 v[172:175],v[44:47],a[172:175],v[172:175]
buffer_load_dwordx4 v0,s[8:11],s64 offen offset:1024 sc1 lds
v_mfma_f32_16x16x32_bf16 v[176:179],v[44:47],a[176:179],v[176:179]
v_mfma_f32_16x16x32_bf16 v[180:183],v[44:47],a[180:183],v[180:183]
v_mfma_f32_16x16x32_bf16 v[184:187],v[44:47],a[184:187],v[184:187]
v_mfma_f32_16x16x32_bf16 v[188:191],v[44:47],a[188:191],v[188:191]
buffer_load_dwordx4 v0,s[8:11],s64 offen offset:2048 sc1 lds
v_mfma_f32_16x16x32_bf16 v[160:163],v[48:51],a[192:195],v[160:163]
v_mfma_f32_16x16x32_bf16 v[164:167],v[48:51],a[196:199],v[164:167]
v_mfma_f32_16x16x32_bf16 v[168:171],v[48:51],a[200:203],v[168:171]
v_mfma_f32_16x16x32_bf16 v[172:175],v[48:51],a[204:207],v[172:175]
buffer_load_dwordx4 v0,s[8:11],s64 offen offset:3072 sc1 lds
v_mfma_f32_16x16x32_bf16 v[176:179],v[48:51],a[208:211],v[176:179]
v_mfma_f32_16x16x32_bf16 v[180:183],v[48:51],a[212:215],v[180:183]
v_mfma_f32_16x16x32_bf16 v[184:187],v[48:51],a[216:219],v[184:187]
v_mfma_f32_16x16x32_bf16 v[188:191],v[48:51],a[220:223],v[188:191]
s_add_u32 m0,s57,24576
v_mfma_f32_16x16x32_bf16 v[160:163],v[52:55],a[224:227],v[160:163]
buffer_load_dwordx4 v0,s[8:11],s65 offen offset:0 sc1 lds
v_mfma_f32_16x16x32_bf16 v[164:167],v[52:55],a[228:231],v[164:167]
v_mfma_f32_16x16x32_bf16 v[168:171],v[52:55],a[232:235],v[168:171]
v_mfma_f32_16x16x32_bf16 v[172:175],v[52:55],a[236:239],v[172:175]
v_mfma_f32_16x16x32_bf16 v[176:179],v[52:55],a[240:243],v[176:179]
buffer_load_dwordx4 v0,s[8:11],s65 offen offset:1024 sc1 lds
v_mfma_f32_16x16x32_bf16 v[180:183],v[52:55],a[244:247],v[180:183]
v_mfma_f32_16x16x32_bf16 v[184:187],v[52:55],a[248:251],v[184:187]
v_mfma_f32_16x16x32_bf16 v[188:191],v[52:55],a[252:255],v[188:191]
v_mfma_f32_16x16x32_bf16 v[192:195],v[56:59],a[0:3],0
v_mfma_f32_16x16x32_bf16 v[196:199],v[56:59],a[4:7],0
v_mfma_f32_16x16x32_bf16 v[200:203],v[56:59],a[8:11],0
v_cvt_pk_bf16_f32 v24,v160,v164
v_cvt_pk_bf16_f32 v25,v168,v172
v_mfma_f32_16x16x32_bf16 v[204:207],v[56:59],a[12:15],0
v_cvt_pk_bf16_f32 v26,v176,v180
v_cvt_pk_bf16_f32 v27,v184,v188
v_mfma_f32_16x16x32_bf16 v[208:211],v[56:59],a[16:19],0
v_cvt_pk_bf16_f32 v28,v161,v165
v_cvt_pk_bf16_f32 v29,v169,v173
v_mfma_f32_16x16x32_bf16 v[212:215],v[56:59],a[20:23],0
v_cvt_pk_bf16_f32 v30,v177,v181
v_cvt_pk_bf16_f32 v31,v185,v189
v_mfma_f32_16x16x32_bf16 v[216:219],v[56:59],a[24:27],0
v_cvt_pk_bf16_f32 v32,v162,v166
v_cvt_pk_bf16_f32 v33,v170,v174
v_mfma_f32_16x16x32_bf16 v[220:223],v[56:59],a[28:31],0
v_cvt_pk_bf16_f32 v34,v178,v182
v_cvt_pk_bf16_f32 v35,v186,v190
v_mfma_f32_16x16x32_bf16 v[192:195],v[60:63],a[32:35],v[192:195]
v_cvt_pk_bf16_f32 v36,v163,v167
v_cvt_pk_bf16_f32 v37,v171,v175
v_mfma_f32_16x16x32_bf16 v[196:199],v[60:63],a[36:39],v[196:199]
v_cvt_pk_bf16_f32 v38,v179,v183
v_cvt_pk_bf16_f32 v39,v187,v191
v_mfma_f32_16x16x32_bf16 v[200:203],v[60:63],a[40:43],v[200:203]
v_mfma_f32_16x16x32_bf16 v[204:207],v[60:63],a[44:47],v[204:207]
v_mfma_f32_16x16x32_bf16 v[208:211],v[60:63],a[48:51],v[208:211]
v_mfma_f32_16x16x32_bf16 v[212:215],v[60:63],a[52:55],v[212:215]
v_mfma_f32_16x16x32_bf16 v[216:219],v[60:63],a[56:59],v[216:219]
v_mfma_f32_16x16x32_bf16 v[220:223],v[60:63],a[60:63],v[220:223]
v_mfma_f32_16x16x32_bf16 v[192:195],v[64:67],a[64:67],v[192:195]
v_mfma_f32_16x16x32_bf16 v[196:199],v[64:67],a[68:71],v[196:199]
v_mfma_f32_16x16x32_bf16 v[200:203],v[64:67],a[72:75],v[200:203]
v_mfma_f32_16x16x32_bf16 v[204:207],v[64:67],a[76:79],v[204:207]
v_mfma_f32_16x16x32_bf16 v[208:211],v[64:67],a[80:83],v[208:211]
v_mfma_f32_16x16x32_bf16 v[212:215],v[64:67],a[84:87],v[212:215]
v_mfma_f32_16x16x32_bf16 v[216:219],v[64:67],a[88:91],v[216:219]
v_mfma_f32_16x16x32_bf16 v[220:223],v[64:67],a[92:95],v[220:223]
v_mfma_f32_16x16x32_bf16 v[192:195],v[68:71],a[96:99],v[192:195]
v_mfma_f32_16x16x32_bf16 v[196:199],v[68:71],a[100:103],v[196:199]
v_mfma_f32_16x16x32_bf16 v[200:203],v[68:71],a[104:107],v[200:203]
v_mfma_f32_16x16x32_bf16 v[204:207],v[68:71],a[108:111],v[204:207]
v_mfma_f32_16x16x32_bf16 v[208:211],v[68:71],a[112:115],v[208:211]
s_add_u32 s62,s69,0
v_mfma_f32_16x16x32_bf16 v[212:215],v[68:71],a[116:119],v[212:215]
buffer_store_dwordx4 v[24:27],v5,s[8:11],s62 offen
v_mfma_f32_16x16x32_bf16 v[216:219],v[68:71],a[120:123],v[216:219]
v_mfma_f32_16x16x32_bf16 v[220:223],v[68:71],a[124:127],v[220:223]
v_mfma_f32_16x16x32_bf16 v[192:195],v[72:75],a[128:131],v[192:195]
s_add_u32 s62,s69,16384
v_mfma_f32_16x16x32_bf16 v[196:199],v[72:75],a[132:135],v[196:199]
buffer_store_dwordx4 v[28:31],v5,s[8:11],s62 offen
v_mfma_f32_16x16x32_bf16 v[200:203],v[72:75],a[136:139],v[200:203]
v_mfma_f32_16x16x32_bf16 v[204:207],v[72:75],a[140:143],v[204:207]
v_mfma_f32_16x16x32_bf16 v[208:211],v[72:75],a[144:147],v[208:211]
s_add_u32 s62,s69,32768
v_mfma_f32_16x16x32_bf16 v[212:215],v[72:75],a[148:151],v[212:215]
buffer_store_dwordx4 v[32:35],v5,s[8:11],s62 offen
v_mfma_f32_16x16x32_bf16 v[216:219],v[72:75],a[152:155],v[216:219]
v_mfma_f32_16x16x32_bf16 v[220:223],v[72:75],a[156:159],v[220:223]
v_mfma_f32_16x16x32_bf16 v[192:195],v[76:79],a[160:163],v[192:195]
s_add_u32 s62,s69,49152
v_mfma_f32_16x16x32_bf16 v[196:199],v[76:79],a[164:167],v[196:199]
buffer_store_dwordx4 v[36:39],v5,s[8:11],s62 offen
v_mfma_f32_16x16x32_bf16 v[200:203],v[76:79],a[168:171],v[200:203]
v_mfma_f32_16x16x32_bf16 v[204:207],v[76:79],a[172:175],v[204:207]
v_mfma_f32_16x16x32_bf16 v[208:211],v[76:79],a[176:179],v[208:211]
v_mfma_f32_16x16x32_bf16 v[212:215],v[76:79],a[180:183],v[212:215]
v_mfma_f32_16x16x32_bf16 v[216:219],v[76:79],a[184:187],v[216:219]
v_mfma_f32_16x16x32_bf16 v[220:223],v[76:79],a[188:191],v[220:223]
v_mfma_f32_16x16x32_bf16 v[192:195],v[80:83],a[192:195],v[192:195]
v_mfma_f32_16x16x32_bf16 v[196:199],v[80:83],a[196:199],v[196:199]
v_mfma_f32_16x16x32_bf16 v[200:203],v[80:83],a[200:203],v[200:203]
v_mfma_f32_16x16x32_bf16 v[204:207],v[80:83],a[204:207],v[204:207]
v_mfma_f32_16x16x32_bf16 v[208:211],v[80:83],a[208:211],v[208:211]
v_mfma_f32_16x16x32_bf16 v[212:215],v[80:83],a[212:215],v[212:215]
v_mfma_f32_16x16x32_bf16 v[216:219],v[80:83],a[216:219],v[216:219]
v_mfma_f32_16x16x32_bf16 v[220:223],v[80:83],a[220:223],v[220:223]
v_mfma_f32_16x16x32_bf16 v[192:195],v[84:87],a[224:227],v[192:195]
v_mfma_f32_16x16x32_bf16 v[196:199],v[84:87],a[228:231],v[196:199]
v_mfma_f32_16x16x32_bf16 v[200:203],v[84:87],a[232:235],v[200:203]
v_mfma_f32_16x16x32_bf16 v[204:207],v[84:87],a[236:239],v[204:207]
v_mfma_f32_16x16x32_bf16 v[208:211],v[84:87],a[240:243],v[208:211]
v_mfma_f32_16x16x32_bf16 v[212:215],v[84:87],a[244:247],v[212:215]
v_mfma_f32_16x16x32_bf16 v[216:219],v[84:87],a[248:251],v[216:219]
v_mfma_f32_16x16x32_bf16 v[220:223],v[84:87],a[252:255],v[220:223]
v_cvt_pk_bf16_f32 v40,v192,v196
v_cvt_pk_bf16_f32 v41,v200,v204
v_cvt_pk_bf16_f32 v42,v208,v212
s_nop 4
v_cvt_pk_bf16_f32 v43,v216,v220
s_add_u32 s62,s69,262144
buffer_store_dwordx4 v[40:43],v5,s[8:11],s62 offen
v_cvt_pk_bf16_f32 v44,v193,v197
v_cvt_pk_bf16_f32 v45,v201,v205
v_cvt_pk_bf16_f32 v46,v209,v213
v_cvt_pk_bf16_f32 v47,v217,v221
s_add_u32 s62,s69,278528
buffer_store_dwordx4 v[44:47],v5,s[8:11],s62 offen
v_cvt_pk_bf16_f32 v48,v194,v198
v_cvt_pk_bf16_f32 v49,v202,v206
v_cvt_pk_bf16_f32 v50,v210,v214
v_cvt_pk_bf16_f32 v51,v218,v222
s_add_u32 s62,s69,294912
buffer_store_dwordx4 v[48:51],v5,s[8:11],s62 offen
v_cvt_pk_bf16_f32 v52,v195,v199
v_cvt_pk_bf16_f32 v53,v203,v207
v_cvt_pk_bf16_f32 v54,v211,v215
v_cvt_pk_bf16_f32 v55,v219,v223
s_add_u32 s62,s69,311296
buffer_store_dwordx4 v[52:55],v5,s[8:11],s62 offen
s_cmp_lg_u32 s72,0
s_cbranch_scc1 L_aa_61
s_waitcnt vmcnt(8)
s_branch L_aa_71
L_aa_59:
ds_read_b128 v[24:27],v4 offset:0
ds_read_b128 v[28:31],v4 offset:1024
s_min_u32 s56,s32,s33
s_cmp_lt_u32 s77,64
s_cselect_b32 s56,s56,0
s_cmp_eq_u32 s56,0
s_cselect_b32 s72,0x80000000,0
v_mov_b32 v248,s72
s_or_b32 s64,s70,s72
s_or_b32 s65,s71,s72
s_and_b32 s57,s46,1
s_mul_i32 s58,s57,12288
s_add_u32 s64,s64,s58
s_lshl_b32 s57,s57,11
s_waitcnt lgkmcnt(1)
v_mfma_f32_16x16x32_bf16 v[160:163],v[24:27],a[0:3],0
ds_read_b128 v[32:35],v4 offset:2048
s_add_u32 s65,s65,s57
s_and_b32 s59,s50,2048
v_mfma_f32_16x16x32_bf16 v[164:167],v[24:27],a[4:7],0
ds_read_b128 v[36:39],v4 offset:3072
s_lshl_b32 s59,s59,4
s_xor_b32 s60,s67,65536
v_mfma_f32_16x16x32_bf16 v[168:171],v[24:27],a[8:11],0
ds_read_b128 v[40:43],v4 offset:8192
s_add_u32 s59,s59,s60
s_add_u32 s58,s58,s59
v_mfma_f32_16x16x32_bf16 v[172:175],v[24:27],a[12:15],0
ds_read_b128 v[44:47],v4 offset:9216
s_add_u32 s57,s57,s59
s_add_u32 m0,s58,0
v_mfma_f32_16x16x32_bf16 v[176:179],v[24:27],a[16:19],0
buffer_load_dwordx4 v0,s[8:11],s64 offen offset:0 sc1 lds
s_lshl_b32 s23,s51,5
s_add_u32 s23,s23,s68
v_mfma_f32_16x16x32_bf16 v[180:183],v[24:27],a[20:23],0
ds_read_b128 v[48:51],v4 offset:10240
s_lshl_b32 s24,s23,10
s_lshl_b32 s25,s51,10
v_mfma_f32_16x16x32_bf16 v[184:187],v[24:27],a[24:27],0
ds_read_b128 v[52:55],v4 offset:11264
s_add_u32 s25,s25,2883584
s_cmp_eq_u32 s23,s55
s_cselect_b32 s25,s25,s24
v_mfma_f32_16x16x32_bf16 v[188:191],v[24:27],a[28:31],0
ds_write_b32 v247,v248
s_add_u32 s25,s25,8388608
s_mov_b32 s6,268435456
s_waitcnt lgkmcnt(7)
v_mfma_f32_16x16x32_bf16 v[160:163],v[28:31],a[32:35],v[160:163]
buffer_load_dwordx4 v0,s[8:11],s64 offen offset:1024 sc1 lds
s_cmp_eq_u32 s31,0
s_cselect_b32 s25,s24,s25
s_cselect_b64 s[4:5],s[16:17],s[44:45]
s_cmov_b32 s6,2097152
v_mfma_f32_16x16x32_bf16 v[164:167],v[28:31],a[36:39],v[164:167]
ds_read_b128 v[56:59],v4 offset:4096
v_mfma_f32_16x16x32_bf16 v[168:171],v[28:31],a[40:43],v[168:171]
ds_read_b128 v[60:63],v4 offset:5120
v_mfma_f32_16x16x32_bf16 v[172:175],v[28:31],a[44:47],v[172:175]
ds_read_b128 v[64:67],v4 offset:6144
v_mfma_f32_16x16x32_bf16 v[176:179],v[28:31],a[48:51],v[176:179]
buffer_load_dwordx4 v0,s[8:11],s64 offen offset:2048 sc1 lds
v_mfma_f32_16x16x32_bf16 v[180:183],v[28:31],a[52:55],v[180:183]
ds_read_b128 v[68:71],v4 offset:7168
v_mfma_f32_16x16x32_bf16 v[184:187],v[28:31],a[56:59],v[184:187]
ds_read_b128 v[72:75],v4 offset:12288
v_mfma_f32_16x16x32_bf16 v[188:191],v[28:31],a[60:63],v[188:191]
ds_read_b128 v[76:79],v4 offset:13312
s_waitcnt lgkmcnt(12)
v_mfma_f32_16x16x32_bf16 v[160:163],v[32:35],a[64:67],v[160:163]
buffer_load_dwordx4 v0,s[8:11],s64 offen offset:3072 sc1 lds
v_mfma_f32_16x16x32_bf16 v[164:167],v[32:35],a[68:71],v[164:167]
ds_read_b128 v[80:83],v4 offset:14336
v_mfma_f32_16x16x32_bf16 v[168:171],v[32:35],a[72:75],v[168:171]
ds_read_b128 v[84:87],v4 offset:15360
v_mfma_f32_16x16x32_bf16 v[172:175],v[32:35],a[76:79],v[172:175]
buffer_load_dwordx4 v[224:227],v0,s[4:7],s25 offen sc1
s_lshr_b32 s24,s55,5
s_cmp_lt_u32 s51,s24
s_cselect_b32 s24,1,2
v_mfma_f32_16x16x32_bf16 v[176:179],v[32:35],a[80:83],v[176:179]
s_add_u32 m0,s58,4096
s_add_u32 s64,s64,4096
v_mov_b32 v252,s24
v_mfma_f32_16x16x32_bf16 v[180:183],v[32:35],a[84:87],v[180:183]
buffer_load_dwordx4 v0,s[8:11],s64 offen offset:0 sc1 lds
s_lshl2_add_u32 s25,s51,11018240
s_lshl_b32 s24,s68,16
v_mfma_f32_16x16x32_bf16 v[184:187],v[32:35],a[88:91],v[184:187]
s_add_u32 s24,s24,s31
s_add_u32 s24,s24,s86
s_cmp_eq_u32 s24,1537
s_cselect_b32 s25,s25,0x80000000
v_mfma_f32_16x16x32_bf16 v[188:191],v[32:35],a[92:95],v[188:191]
buffer_store_dword v252,off,s[8:11],s25 sc1
s_waitcnt lgkmcnt(0)
s_barrier
s_waitcnt lgkmcnt(13)
v_mfma_f32_16x16x32_bf16 v[160:163],v[36:39],a[96:99],v[160:163]
ds_read_b128 v[248:251],v245
s_bitcmp1_b64 s[38:39],s51
s_cselect_b32 s24,128,0
v_mfma_f32_16x16x32_bf16 v[164:167],v[36:39],a[100:103],v[164:167]
buffer_load_dwordx4 v0,s[8:11],s64 offen offset:1024 sc1 lds
s_lshl_b32 s23,s51,13
s_lshl2_add_u32 s23,s68,s23
v_mfma_f32_16x16x32_bf16 v[168:171],v[36:39],a[104:107],v[168:171]
s_add_u32 s23,s23,10487168
s_add_u32 s23,s23,s24
v_mfma_f32_16x16x32_bf16 v[172:175],v[36:39],a[108:111],v[172:175]
buffer_load_dword v246,off,s[8:11],s23 sc1
v_lshrrev_b32 v244,4,v1
s_sub_u32 s23,s77,8
v_mfma_f32_16x16x32_bf16 v[176:179],v[36:39],a[112:115],v[176:179]
v_add_u32 v244,s23,v244
v_max_i32 v244,0,v244
v_mfma_f32_16x16x32_bf16 v[180:183],v[36:39],a[116:119],v[180:183]
buffer_load_dwordx4 v0,s[8:11],s64 offen offset:2048 sc1 lds
v_lshl_add_u32 v244,v244,13,v21
v_mfma_f32_16x16x32_bf16 v[184:187],v[36:39],a[120:123],v[184:187]
buffer_load_dwordx2 v[242:243],v244,s[8:11],0 offen sc1
s_waitcnt lgkmcnt(0)
v_or3_b32 v248,v248,v249,v250
v_mfma_f32_16x16x32_bf16 v[188:191],v[36:39],a[124:127],v[188:191]
v_or_b32 v248,v248,v251
v_mfma_f32_16x16x32_bf16 v[160:163],v[40:43],a[128:131],v[160:163]
v_readfirstlane_b32 s72,v248
v_mfma_f32_16x16x32_bf16 v[164:167],v[40:43],a[132:135],v[164:167]
buffer_load_dwordx4 v0,s[8:11],s64 offen offset:3072 sc1 lds
v_mfma_f32_16x16x32_bf16 v[168:171],v[40:43],a[136:139],v[168:171]
v_mfma_f32_16x16x32_bf16 v[172:175],v[40:43],a[140:143],v[172:175]
v_mfma_f32_16x16x32_bf16 v[176:179],v[40:43],a[144:147],v[176:179]
s_waitcnt vmcnt(12)
v_mfma_f32_16x16x32_bf16 v[180:183],v[40:43],a[148:151],v[180:183]
buffer_store_dword v20,off,s[8:11],s73 sc1
s_add_u32 m0,s58,8192
s_add_u32 s64,s64,4096
v_mfma_f32_16x16x32_bf16 v[184:187],v[40:43],a[152:155],v[184:187]
buffer_load_dwordx4 v0,s[8:11],s64 offen offset:0 sc1 lds
s_mov_b32 s73,0x80000000
v_mfma_f32_16x16x32_bf16 v[188:191],v[40:43],a[156:159],v[188:191]
v_mfma_f32_16x16x32_bf16 v[160:163],v[44:47],a[160:163],v[160:163]
v_mfma_f32_16x16x32_bf16 v[164:167],v[44:47],a[164:167],v[164:167]
v_mfma_f32_16x16x32_bf16 v[168:171],v[44:47],a[168:171],v[168:171]
buffer_load_dwordx4 v0,s[8:11],s64 offen offset:1024 sc1 lds
v_mfma_f32_16x16x32_bf16 v[172:175],v[44:47],a[172:175],v[172:175]
v_mfma_f32_16x16x32_bf16 v[176:179],v[44:47],a[176:179],v[176:179]
v_mfma_f32_16x16x32_bf16 v[180:183],v[44:47],a[180:183],v[180:183]
v_mfma_f32_16x16x32_bf16 v[184:187],v[44:47],a[184:187],v[184:187]
buffer_load_dwordx4 v0,s[8:11],s64 offen offset:2048 sc1 lds
v_mfma_f32_16x16x32_bf16 v[188:191],v[44:47],a[188:191],v[188:191]
v_mfma_f32_16x16x32_bf16 v[160:163],v[48:51],a[192:195],v[160:163]
v_mfma_f32_16x16x32_bf16 v[164:167],v[48:51],a[196:199],v[164:167]
v_mfma_f32_16x16x32_bf16 v[168:171],v[48:51],a[200:203],v[168:171]
buffer_load_dwordx4 v0,s[8:11],s64 offen offset:3072 sc1 lds
v_mfma_f32_16x16x32_bf16 v[172:175],v[48:51],a[204:207],v[172:175]
v_mfma_f32_16x16x32_bf16 v[176:179],v[48:51],a[208:211],v[176:179]
v_mfma_f32_16x16x32_bf16 v[180:183],v[48:51],a[212:215],v[180:183]
v_mfma_f32_16x16x32_bf16 v[184:187],v[48:51],a[216:219],v[184:187]
s_add_u32 m0,s57,24576
v_mfma_f32_16x16x32_bf16 v[188:191],v[48:51],a[220:223],v[188:191]
buffer_load_dwordx4 v0,s[8:11],s65 offen offset:0 sc1 lds
v_mfma_f32_16x16x32_bf16 v[160:163],v[52:55],a[224:227],v[160:163]
v_mfma_f32_16x16x32_bf16 v[164:167],v[52:55],a[228:231],v[164:167]
v_mfma_f32_16x16x32_bf16 v[168:171],v[52:55],a[232:235],v[168:171]
v_mfma_f32_16x16x32_bf16 v[172:175],v[52:55],a[236:239],v[172:175]
buffer_load_dwordx4 v0,s[8:11],s65 offen offset:1024 sc1 lds
v_mfma_f32_16x16x32_bf16 v[176:179],v[52:55],a[240:243],v[176:179]
v_mfma_f32_16x16x32_bf16 v[180:183],v[52:55],a[244:247],v[180:183]
v_mfma_f32_16x16x32_bf16 v[184:187],v[52:55],a[248:251],v[184:187]
v_mfma_f32_16x16x32_bf16 v[188:191],v[52:55],a[252:255],v[188:191]
v_mfma_f32_16x16x32_bf16 v[192:195],v[56:59],a[0:3],0
v_mfma_f32_16x16x32_bf16 v[196:199],v[56:59],a[4:7],0
v_mfma_f32_16x16x32_bf16 v[200:203],v[56:59],a[8:11],0
v_cvt_pk_bf16_f32 v24,v160,v164
v_cvt_pk_bf16_f32 v25,v168,v172
v_mfma_f32_16x16x32_bf16 v[204:207],v[56:59],a[12:15],0
v_cvt_pk_bf16_f32 v26,v176,v180
v_cvt_pk_bf16_f32 v27,v184,v188
v_mfma_f32_16x16x32_bf16 v[208:211],v[56:59],a[16:19],0
v_cvt_pk_bf16_f32 v28,v161,v165
v_cvt_pk_bf16_f32 v29,v169,v173
v_mfma_f32_16x16x32_bf16 v[212:215],v[56:59],a[20:23],0
v_cvt_pk_bf16_f32 v30,v177,v181
v_cvt_pk_bf16_f32 v31,v185,v189
v_mfma_f32_16x16x32_bf16 v[216:219],v[56:59],a[24:27],0
v_cvt_pk_bf16_f32 v32,v162,v166
v_cvt_pk_bf16_f32 v33,v170,v174
v_mfma_f32_16x16x32_bf16 v[220:223],v[56:59],a[28:31],0
v_cvt_pk_bf16_f32 v34,v178,v182
v_cvt_pk_bf16_f32 v35,v186,v190
v_mfma_f32_16x16x32_bf16 v[192:195],v[60:63],a[32:35],v[192:195]
v_cvt_pk_bf16_f32 v36,v163,v167
v_cvt_pk_bf16_f32 v37,v171,v175
v_mfma_f32_16x16x32_bf16 v[196:199],v[60:63],a[36:39],v[196:199]
v_cvt_pk_bf16_f32 v38,v179,v183
v_cvt_pk_bf16_f32 v39,v187,v191
v_mfma_f32_16x16x32_bf16 v[200:203],v[60:63],a[40:43],v[200:203]
v_mfma_f32_16x16x32_bf16 v[204:207],v[60:63],a[44:47],v[204:207]
v_mfma_f32_16x16x32_bf16 v[208:211],v[60:63],a[48:51],v[208:211]
v_mfma_f32_16x16x32_bf16 v[212:215],v[60:63],a[52:55],v[212:215]
v_mfma_f32_16x16x32_bf16 v[216:219],v[60:63],a[56:59],v[216:219]
v_mfma_f32_16x16x32_bf16 v[220:223],v[60:63],a[60:63],v[220:223]
v_mfma_f32_16x16x32_bf16 v[192:195],v[64:67],a[64:67],v[192:195]
v_mfma_f32_16x16x32_bf16 v[196:199],v[64:67],a[68:71],v[196:199]
v_mfma_f32_16x16x32_bf16 v[200:203],v[64:67],a[72:75],v[200:203]
v_mfma_f32_16x16x32_bf16 v[204:207],v[64:67],a[76:79],v[204:207]
v_mfma_f32_16x16x32_bf16 v[208:211],v[64:67],a[80:83],v[208:211]
v_mfma_f32_16x16x32_bf16 v[212:215],v[64:67],a[84:87],v[212:215]
v_mfma_f32_16x16x32_bf16 v[216:219],v[64:67],a[88:91],v[216:219]
v_mfma_f32_16x16x32_bf16 v[220:223],v[64:67],a[92:95],v[220:223]
v_mfma_f32_16x16x32_bf16 v[192:195],v[68:71],a[96:99],v[192:195]
v_mfma_f32_16x16x32_bf16 v[196:199],v[68:71],a[100:103],v[196:199]
v_mfma_f32_16x16x32_bf16 v[200:203],v[68:71],a[104:107],v[200:203]
v_mfma_f32_16x16x32_bf16 v[204:207],v[68:71],a[108:111],v[204:207]
v_mfma_f32_16x16x32_bf16 v[208:211],v[68:71],a[112:115],v[208:211]
s_add_u32 s62,s69,0
v_mfma_f32_16x16x32_bf16 v[212:215],v[68:71],a[116:119],v[212:215]
buffer_store_dwordx4 v[24:27],v5,s[8:11],s62 offen
v_mfma_f32_16x16x32_bf16 v[216:219],v[68:71],a[120:123],v[216:219]
v_mfma_f32_16x16x32_bf16 v[220:223],v[68:71],a[124:127],v[220:223]
v_mfma_f32_16x16x32_bf16 v[192:195],v[72:75],a[128:131],v[192:195]
s_add_u32 s62,s69,16384
v_mfma_f32_16x16x32_bf16 v[196:199],v[72:75],a[132:135],v[196:199]
buffer_store_dwordx4 v[28:31],v5,s[8:11],s62 offen
v_mfma_f32_16x16x32_bf16 v[200:203],v[72:75],a[136:139],v[200:203]
v_mfma_f32_16x16x32_bf16 v[204:207],v[72:75],a[140:143],v[204:207]
v_mfma_f32_16x16x32_bf16 v[208:211],v[72:75],a[144:147],v[208:211]
s_add_u32 s62,s69,32768
v_mfma_f32_16x16x32_bf16 v[212:215],v[72:75],a[148:151],v[212:215]
buffer_store_dwordx4 v[32:35],v5,s[8:11],s62 offen
v_mfma_f32_16x16x32_bf16 v[216:219],v[72:75],a[152:155],v[216:219]
v_mfma_f32_16x16x32_bf16 v[220:223],v[72:75],a[156:159],v[220:223]
v_mfma_f32_16x16x32_bf16 v[192:195],v[76:79],a[160:163],v[192:195]
s_add_u32 s62,s69,49152
v_mfma_f32_16x16x32_bf16 v[196:199],v[76:79],a[164:167],v[196:199]
buffer_store_dwordx4 v[36:39],v5,s[8:11],s62 offen
v_mfma_f32_16x16x32_bf16 v[200:203],v[76:79],a[168:171],v[200:203]
v_mfma_f32_16x16x32_bf16 v[204:207],v[76:79],a[172:175],v[204:207]
v_mfma_f32_16x16x32_bf16 v[208:211],v[76:79],a[176:179],v[208:211]
v_mfma_f32_16x16x32_bf16 v[212:215],v[76:79],a[180:183],v[212:215]
v_mfma_f32_16x16x32_bf16 v[216:219],v[76:79],a[184:187],v[216:219]
v_mfma_f32_16x16x32_bf16 v[220:223],v[76:79],a[188:191],v[220:223]
v_mfma_f32_16x16x32_bf16 v[192:195],v[80:83],a[192:195],v[192:195]
v_mfma_f32_16x16x32_bf16 v[196:199],v[80:83],a[196:199],v[196:199]
v_mfma_f32_16x16x32_bf16 v[200:203],v[80:83],a[200:203],v[200:203]
v_mfma_f32_16x16x32_bf16 v[204:207],v[80:83],a[204:207],v[204:207]
v_mfma_f32_16x16x32_bf16 v[208:211],v[80:83],a[208:211],v[208:211]
v_mfma_f32_16x16x32_bf16 v[212:215],v[80:83],a[212:215],v[212:215]
v_mfma_f32_16x16x32_bf16 v[216:219],v[80:83],a[216:219],v[216:219]
v_mfma_f32_16x16x32_bf16 v[220:223],v[80:83],a[220:223],v[220:223]
v_mfma_f32_16x16x32_bf16 v[192:195],v[84:87],a[224:227],v[192:195]
v_mfma_f32_16x16x32_bf16 v[196:199],v[84:87],a[228:231],v[196:199]
v_mfma_f32_16x16x32_bf16 v[200:203],v[84:87],a[232:235],v[200:203]
v_mfma_f32_16x16x32_bf16 v[204:207],v[84:87],a[236:239],v[204:207]
v_mfma_f32_16x16x32_bf16 v[208:211],v[84:87],a[240:243],v[208:211]
v_mfma_f32_16x16x32_bf16 v[212:215],v[84:87],a[244:247],v[212:215]
v_mfma_f32_16x16x32_bf16 v[216:219],v[84:87],a[248:251],v[216:219]
v_mfma_f32_16x16x32_bf16 v[220:223],v[84:87],a[252:255],v[220:223]
v_cvt_pk_bf16_f32 v40,v192,v196
v_cvt_pk_bf16_f32 v41,v200,v204
v_cvt_pk_bf16_f32 v42,v208,v212
s_nop 4
v_cvt_pk_bf16_f32 v43,v216,v220
s_add_u32 s62,s69,262144
buffer_store_dwordx4 v[40:43],v5,s[8:11],s62 offen
v_cvt_pk_bf16_f32 v44,v193,v197
v_cvt_pk_bf16_f32 v45,v201,v205
v_cvt_pk_bf16_f32 v46,v209,v213
v_cvt_pk_bf16_f32 v47,v217,v221
s_add_u32 s62,s69,278528
buffer_store_dwordx4 v[44:47],v5,s[8:11],s62 offen
v_cvt_pk_bf16_f32 v48,v194,v198
v_cvt_pk_bf16_f32 v49,v202,v206
v_cvt_pk_bf16_f32 v50,v210,v214
v_cvt_pk_bf16_f32 v51,v218,v222
s_add_u32 s62,s69,294912
buffer_store_dwordx4 v[48:51],v5,s[8:11],s62 offen
v_cvt_pk_bf16_f32 v52,v195,v199
v_cvt_pk_bf16_f32 v53,v203,v207
v_cvt_pk_bf16_f32 v54,v211,v215
v_cvt_pk_bf16_f32 v55,v219,v223
s_add_u32 s62,s69,311296
buffer_store_dwordx4 v[52:55],v5,s[8:11],s62 offen
s_cmp_lg_u32 s72,0
s_cbranch_scc1 L_aa_61
s_waitcnt vmcnt(8)
L_aa_71:
s_barrier
s_xor_b32 s67,s67,65536
s_and_b32 s56,s50,2048
s_lshl_b32 s56,s56,4
s_add_u32 s56,s56,s67
v_add_u32 v2,s56,v0
v_add_u32 v239,s56,v253
s_and_b32 s56,s50,1024
s_lshl_b32 s56,s56,2
v_add_u32 v238,s56,v2
s_mov_b32 s76,s71
s_mov_b32 s53,s77
ds_read_b128 v[24:27],v238 offset:16384
ds_read_b128 v[40:43],v2 offset:0
ds_read_b128 v[56:59],v2 offset:4096
ds_read_b128 v[28:31],v238 offset:17408
ds_read_b128 v[44:47],v2 offset:1024
ds_read_b128 v[60:63],v2 offset:5120
ds_read_b128 v[32:35],v238 offset:18432
ds_read_b128 v[48:51],v2 offset:2048
ds_read_b128 v[64:67],v2 offset:6144
ds_read_b128 v[36:39],v238 offset:19456
ds_read_b128 v[52:55],v2 offset:3072
ds_read_b128 v[68:71],v2 offset:7168
s_waitcnt lgkmcnt(9)
v_mfma_f32_16x16x32_bf16 v[128:131],v[40:43],v[24:27],v[8:11]
ds_read_b128 v[72:75],v2 offset:24576
v_mfma_f32_16x16x32_bf16 v[132:135],v[56:59],v[24:27],v[12:15]
ds_read_b128 v[76:79],v2 offset:25600
s_waitcnt lgkmcnt(8)
v_mfma_f32_16x16x32_bf16 v[128:131],v[44:47],v[28:31],v[128:131]
ds_read_b128 v[80:83],v2 offset:26624
v_mfma_f32_16x16x32_bf16 v[132:135],v[60:63],v[28:31],v[132:135]
ds_read_b128 v[84:87],v2 offset:27648
s_waitcnt lgkmcnt(7)
v_mfma_f32_16x16x32_bf16 v[128:131],v[48:51],v[32:35],v[128:131]
ds_read_b64 v[120:121],v239 offset:24576
v_mfma_f32_16x16x32_bf16 v[132:135],v[64:67],v[32:35],v[132:135]
ds_read_b64 v[122:123],v239 offset:25600
s_waitcnt lgkmcnt(6)
v_mfma_f32_16x16x32_bf16 v[128:131],v[52:55],v[36:39],v[128:131]
ds_read_b64 v[124:125],v239 offset:26624
v_mfma_f32_16x16x32_bf16 v[132:135],v[68:71],v[36:39],v[132:135]
ds_read_b64 v[126:127],v239 offset:27648
s_waitcnt lgkmcnt(4)
v_mfma_f32_16x16x32_bf16 v[136:139],v[72:75],v[24:27],0
ds_read_b128 v[88:91],v2 offset:8192
ds_read_b128 v[92:95],v2 offset:9216
v_mfma_f32_16x16x32_bf16 v[136:139],v[76:79],v[28:31],v[136:139]
ds_read_b128 v[96:99],v2 offset:10240
ds_read_b128 v[100:103],v2 offset:11264
v_mfma_f32_16x16x32_bf16 v[136:139],v[80:83],v[32:35],v[136:139]
ds_read_b128 v[104:107],v2 offset:12288
ds_read_b128 v[108:111],v2 offset:13312
v_mfma_f32_16x16x32_bf16 v[136:139],v[84:87],v[36:39],v[136:139]
ds_read_b128 v[112:115],v2 offset:14336
ds_read_b128 v[116:119],v2 offset:15360
s_cmp_eq_u32 s30,0
s_cbranch_scc1 L_aa_60
s_add_u32 s66,s66,4
s_bfe_u32 s56,s66,0x10002
s_bitset0_b32 s37,s56
s_or_b32 s56,s37,s66
v_mov_b32 v22,s56
s_xor_b32 s69,s69,524288
s_waitcnt vmcnt(0) lgkmcnt(0)
s_barrier
buffer_store_dword v22,off,s[8:11],s74
buffer_store_dword v20,off,s[8:11],s73 sc1
s_mov_b32 s73,0x80000000
s_cmp_lg_u32 s86,1536
s_cbranch_scc1 L_ae_78
s_mov_b32 s77,s35
s_mov_b32 s30,0
s_lshl_b32 s56,s77,5
s_add_u32 s56,s56,s68
s_mul_i32 s70,s56,24576
s_lshl_b32 s71,s56,12
s_lshl_b32 s59,s77,13
s_lshl2_add_u32 s59,s68,s59
s_add_u32 s59,s59,10485760
s_buffer_load_dword s32,s[8:11],s59 glc
s_mov_b32 s33,1
s_add_u32 s70,s70,100663296
s_add_u32 s71,s71,41943040
v_mov_b32 v19,s59
s_branch L_af_79
L_ae_78:
s_ff1_i32_b64 s77,s[84:85]
s_bitset0_b64 s[84:85],s77
s_min_u32 s77,s77,64
s_lshr_b32 s61,s55,5
s_lshl_b32 s56,s77,5
s_add_u32 s56,s56,s68
s_mul_i32 s70,s56,24576
s_lshl_b32 s71,s56,12
s_lshl_b32 s59,s77,13
s_lshl2_add_u32 s59,s68,s59
s_add_u32 s59,s59,10486144
s_cmp_lt_u32 s77,s61
s_cselect_b32 s57,0,16777216
s_cselect_b32 s60,0,128
s_add_u32 s60,s60,s59
s_add_u32 s60,s60,128
s_buffer_load_dword s33,s[8:11],s60 glc
s_add_u32 s71,s71,s57
s_add_u32 s71,s71,58720256
s_cmp_eq_u32 s77,s61
s_cselect_b32 s57,50331648,0
s_cselect_b32 s58,1536,0
s_add_u32 s59,s59,s58
s_buffer_load_dword s32,s[8:11],s59 glc
s_add_u32 s70,s70,s57
s_add_u32 s70,s70,150994944
v_mov_b32 v19,s59
v_writelane_b32 v19,s60,1
L_af_79:
v_max3_f32 v238,v128,v129,v130
v_max3_f32 v239,v131,v132,v133
v_max3_f32 v238,v134,v135,v238
v_max3_f32 v239,v138,v139,v239
v_max_f32 v238,v238,v239
v_max_f32 v239,v238,v239
s_nop 1
v_permlane16_swap_b32 v238,v239
v_max_f32 v238,v238,v239
v_max_f32 v239,v238,v239
s_nop 1
v_permlane32_swap_b32 v238,v239
v_max_f32 v238,v238,v239
v_mul_f32 v238,s80,v238
v_fma_f32 v128,v128,s80,-v238
v_fma_f32 v129,v129,s80,-v238
v_exp_f32 v128,v128
v_fma_f32 v130,v130,s80,-v238
v_exp_f32 v129,v129
v_fma_f32 v131,v131,s80,-v238
v_exp_f32 v130,v130
v_fma_f32 v132,v132,s80,-v238
v_exp_f32 v131,v131
v_fma_f32 v133,v133,s80,-v238
v_exp_f32 v132,v132
v_fma_f32 v134,v134,s80,-v238
v_exp_f32 v133,v133
v_fma_f32 v135,v135,s80,-v238
v_exp_f32 v134,v134
v_fma_f32 v138,v138,s80,-v238
v_exp_f32 v135,v135
v_fma_f32 v139,v139,s80,-v238
v_exp_f32 v138,v138
v_exp_f32 v139,v139
v_cvt_pk_bf16_f32 v140,v128,v129
v_cvt_pk_bf16_f32 v141,v130,v131
v_cvt_pk_bf16_f32 v142,v132,v133
v_cvt_pk_bf16_f32 v143,v134,v135
v_cvt_pk_bf16_f32 v144,v138,v139
v_mov_b32 v147,v144
buffer_load_dword v17,v16,s[8:11],s87 offen sc1
v_mfma_f32_16x16x32_bf16 v[148:151],v[152:155],v[140:143],0
v_mfma_f32_16x16x32_bf16 v[24:27],v[88:91],v[140:143],0
v_mfma_f32_16x16x32_bf16 v[28:31],v[92:95],v[140:143],0
v_mfma_f32_16x16x16_bf16 v[148:151],v[152:153],v[144:145],v[148:151]
v_mfma_f32_16x16x32_bf16 v[32:35],v[96:99],v[140:143],0
v_mfma_f32_16x16x32_bf16 v[36:39],v[100:103],v[140:143],0
v_mfma_f32_16x16x32_bf16 v[40:43],v[104:107],v[140:143],0
v_mfma_f32_16x16x32_bf16 v[44:47],v[108:111],v[140:143],0
v_mfma_f32_16x16x32_bf16 v[48:51],v[112:115],v[140:143],0
v_mfma_f32_16x16x32_bf16 v[52:55],v[116:119],v[140:143],0
v_rcp_f32 v148,v148
v_mfma_f32_16x16x16_bf16 v[24:27],v[120:121],v[144:145],v[24:27]
v_mfma_f32_16x16x16_bf16 v[28:31],v[120:121],v[146:147],v[28:31]
v_mfma_f32_16x16x16_bf16 v[32:35],v[122:123],v[144:145],v[32:35]
v_mfma_f32_16x16x16_bf16 v[36:39],v[122:123],v[146:147],v[36:39]
v_mfma_f32_16x16x16_bf16 v[40:43],v[124:125],v[144:145],v[40:43]
v_pk_mul_f32 v[24:25],v[24:25],v[148:149] op_sel_hi:[1,0]
v_pk_mul_f32 v[26:27],v[26:27],v[148:149] op_sel_hi:[1,0]
v_mfma_f32_16x16x16_bf16 v[44:47],v[124:125],v[146:147],v[44:47]
v_pk_mul_f32 v[28:29],v[28:29],v[148:149] op_sel_hi:[1,0]
v_pk_mul_f32 v[30:31],v[30:31],v[148:149] op_sel_hi:[1,0]
v_mfma_f32_16x16x16_bf16 v[48:51],v[126:127],v[144:145],v[48:51]
v_cvt_pk_bf16_f32 v72,v24,v28
v_cvt_pk_bf16_f32 v73,v25,v29
v_mfma_f32_16x16x16_bf16 v[52:55],v[126:127],v[146:147],v[52:55]
v_cvt_pk_bf16_f32 v74,v26,v30
v_cvt_pk_bf16_f32 v75,v27,v31
ds_write_b128 v3,v[72:75] offset:0
v_pk_mul_f32 v[32:33],v[32:33],v[148:149] op_sel_hi:[1,0]
v_pk_mul_f32 v[34:35],v[34:35],v[148:149] op_sel_hi:[1,0]
v_pk_mul_f32 v[36:37],v[36:37],v[148:149] op_sel_hi:[1,0]
v_pk_mul_f32 v[38:39],v[38:39],v[148:149] op_sel_hi:[1,0]
v_cvt_pk_bf16_f32 v76,v32,v36
v_cvt_pk_bf16_f32 v77,v33,v37
v_cvt_pk_bf16_f32 v78,v34,v38
v_cvt_pk_bf16_f32 v79,v35,v39
ds_write_b128 v3,v[76:79] offset:1024
s_waitcnt vmcnt(0)
v_cmp_gt_u32 vcc,s66,v17
v_pk_mul_f32 v[40:41],v[40:41],v[148:149] op_sel_hi:[1,0]
v_pk_mul_f32 v[42:43],v[42:43],v[148:149] op_sel_hi:[1,0]
v_pk_mul_f32 v[44:45],v[44:45],v[148:149] op_sel_hi:[1,0]
v_pk_mul_f32 v[46:47],v[46:47],v[148:149] op_sel_hi:[1,0]
s_cbranch_vccnz L_ap_81
L_apb_82:
s_bfe_u32 s56,s66,0x10002
v_lshrrev_b32 v238,s56,v17
v_and_b32 v238,1,v238
v_cmp_ne_u32 vcc,0,v238
v_cvt_pk_bf16_f32 v80,v40,v44
v_cvt_pk_bf16_f32 v81,v41,v45
v_cvt_pk_bf16_f32 v82,v42,v46
s_cbranch_vccnz L_ak_77
s_add_u32 s36,s36,4
s_xor_b32 s34,s69,524288
buffer_load_dwordx4 v[192:195],v7,s[8:11],s34 offen sc1
v_cvt_pk_bf16_f32 v83,v43,v47
ds_write_b128 v3,v[80:83] offset:2048
s_add_u32 s34,s34,4096
buffer_load_dwordx4 v[196:199],v7,s[8:11],s34 offen sc1
v_pk_mul_f32 v[48:49],v[48:49],v[148:149] op_sel_hi:[1,0]
v_pk_mul_f32 v[50:51],v[50:51],v[148:149] op_sel_hi:[1,0]
s_add_u32 s34,s34,4096
buffer_load_dwordx4 v[200:203],v7,s[8:11],s34 offen sc1
v_pk_mul_f32 v[52:53],v[52:53],v[148:149] op_sel_hi:[1,0]
v_pk_mul_f32 v[54:55],v[54:55],v[148:149] op_sel_hi:[1,0]
s_add_u32 s34,s34,4096
buffer_load_dwordx4 v[204:207],v7,s[8:11],s34 offen sc1
v_cvt_pk_bf16_f32 v84,v48,v52
v_cvt_pk_bf16_f32 v85,v49,v53
s_add_u32 s34,s34,4096
buffer_load_dwordx4 v[208:211],v7,s[8:11],s34 offen sc1
v_cvt_pk_bf16_f32 v86,v50,v54
v_cvt_pk_bf16_f32 v87,v51,v55
s_add_u32 s34,s34,4096
buffer_load_dwordx4 v[212:215],v7,s[8:11],s34 offen sc1
ds_write_b128 v3,v[84:87] offset:3072
s_add_u32 s34,s34,4096
buffer_load_dwordx4 v[216:219],v7,s[8:11],s34 offen sc1
s_add_u32 s34,s34,4096
buffer_load_dwordx4 v[220:223],v7,s[8:11],s34 offen sc1
s_cmp_eq_u32 s31,0
s_cbranch_scc1 L_ah_80
s_waitcnt lgkmcnt(0)
s_barrier
s_mov_b32 s26,s51
s_mov_b32 s51,s53
s_branch L_aa_72
L_ah_80:
s_waitcnt vmcnt(7)
v_mfma_f32_16x16x32_bf16 v[160:163],v[156:159],v[192:195],0
s_waitcnt vmcnt(6)
v_mfma_f32_16x16x32_bf16 v[160:163],v[156:159],v[196:199],v[160:163]
s_waitcnt vmcnt(5)
v_mfma_f32_16x16x32_bf16 v[160:163],v[156:159],v[200:203],v[160:163]
s_waitcnt vmcnt(4)
v_mfma_f32_16x16x32_bf16 v[160:163],v[156:159],v[204:207],v[160:163]
s_waitcnt vmcnt(3)
v_mfma_f32_16x16x32_bf16 v[164:167],v[156:159],v[208:211],0
s_waitcnt vmcnt(2)
v_mfma_f32_16x16x32_bf16 v[164:167],v[156:159],v[212:215],v[164:167]
s_waitcnt vmcnt(1)
v_mfma_f32_16x16x32_bf16 v[164:167],v[156:159],v[216:219],v[164:167]
ds_write_b128 v6,v[160:163]
s_waitcnt vmcnt(0)
v_mfma_f32_16x16x32_bf16 v[164:167],v[156:159],v[220:223],v[164:167]
s_nop 7
ds_write_b128 v6,v[164:167] offset:2048
s_waitcnt lgkmcnt(0)
s_barrier
s_mov_b32 s27,1
s_branch L_aa_63
L_aa_60:
s_add_u32 s66,s66,4
s_bfe_u32 s56,s66,0x10002
s_bitset0_b32 s37,s56
s_or_b32 s56,s37,s66
v_mov_b32 v22,s56
s_xor_b32 s69,s69,524288
s_waitcnt vmcnt(0) lgkmcnt(0)
s_barrier
buffer_store_dword v22,off,s[8:11],s74
buffer_store_dword v20,off,s[8:11],s73 sc1
s_mov_b32 s73,0x80000000
s_cmp_eq_u32 s31,0
s_cbranch_scc1 L_aa_62
s_mov_b32 s26,s51
s_mov_b32 s27,3
s_branch L_aa_67
L_aa_62:
L_aq_83:
buffer_load_dword v17,v16,s[8:11],s87 offen sc1
s_sub_u32 s49,s49,1
s_cbranch_scc1 L_abort
s_waitcnt vmcnt(0)
v_cmp_gt_u32 vcc,s66,v17
s_cbranch_vccnz L_aq_83
s_xor_b32 s34,s69,524288
buffer_load_dwordx4 v[160:163],v7,s[8:11],s34 offen sc1
s_add_u32 s34,s34,4096
buffer_load_dwordx4 v[164:167],v7,s[8:11],s34 offen sc1
s_add_u32 s34,s34,4096
buffer_load_dwordx4 v[168:171],v7,s[8:11],s34 offen sc1
s_add_u32 s34,s34,4096
buffer_load_dwordx4 v[172:175],v7,s[8:11],s34 offen sc1
s_add_u32 s34,s34,4096
buffer_load_dwordx4 v[176:179],v7,s[8:11],s34 offen sc1
s_add_u32 s34,s34,4096
buffer_load_dwordx4 v[180:183],v7,s[8:11],s34 offen sc1
s_add_u32 s34,s34,4096
buffer_load_dwordx4 v[184:187],v7,s[8:11],s34 offen sc1
s_add_u32 s34,s34,4096
buffer_load_dwordx4 v[188:191],v7,s[8:11],s34 offen sc1
buffer_load_dwordx4 v[72:75],v0,s[8:11],s76 offen offset:0 sc1
buffer_load_dwordx4 v[76:79],v0,s[8:11],s76 offen offset:1024 sc1
buffer_load_dwordx4 v[80:83],v0,s[8:11],s76 offen offset:2048 sc1
buffer_load_dwordx4 v[84:87],v0,s[8:11],s76 offen offset:3072 sc1
buffer_load_dwordx2 v[120:121],v253,s[8:11],s76 offen offset:0 sc1
buffer_load_dwordx2 v[122:123],v253,s[8:11],s76 offen offset:1024 sc1
buffer_load_dwordx2 v[124:125],v253,s[8:11],s76 offen offset:2048 sc1
buffer_load_dwordx2 v[126:127],v253,s[8:11],s76 offen offset:3072 sc1
s_waitcnt vmcnt(15)
v_mfma_f32_16x16x32_bf16 v[192:195],v[156:159],v[160:163],0
s_waitcnt vmcnt(14)
v_mfma_f32_16x16x32_bf16 v[192:195],v[156:159],v[164:167],v[192:195]
s_waitcnt vmcnt(13)
v_mfma_f32_16x16x32_bf16 v[192:195],v[156:159],v[168:171],v[192:195]
s_waitcnt vmcnt(12)
v_mfma_f32_16x16x32_bf16 v[192:195],v[156:159],v[172:175],v[192:195]
s_waitcnt vmcnt(11)
v_mfma_f32_16x16x32_bf16 v[196:199],v[156:159],v[176:179],0
s_waitcnt vmcnt(10)
v_mfma_f32_16x16x32_bf16 v[196:199],v[156:159],v[180:183],v[196:199]
s_waitcnt vmcnt(9)
v_mfma_f32_16x16x32_bf16 v[196:199],v[156:159],v[184:187],v[196:199]
ds_write_b128 v6,v[192:195]
s_waitcnt vmcnt(8)
v_mfma_f32_16x16x32_bf16 v[196:199],v[156:159],v[188:191],v[196:199]
s_nop 7
ds_write_b128 v6,v[196:199] offset:2048
s_waitcnt lgkmcnt(0)
s_barrier
s_mov_b32 s27,0
s_branch L_aa_63
L_aa_61:
s_add_u32 s56,s30,s86
s_cmp_lg_u32 s56,1537
s_cbranch_scc1 L_al_76
s_add_u32 s66,s66,4
s_bfe_u32 s56,s66,0x10002
s_bitset1_b32 s37,s56
s_or_b32 s56,s37,s66
v_mov_b32 v22,s56
s_xor_b32 s69,s69,524288
s_waitcnt vmcnt(0) lgkmcnt(0)
s_barrier
buffer_store_dword v22,off,s[8:11],s74
buffer_store_dword v20,off,s[8:11],s73 sc1
s_mov_b32 s73,0x80000000
s_cmp_lg_u32 s86,1536
s_cbranch_scc1 L_ae_84
s_mov_b32 s77,s35
s_mov_b32 s30,0
s_lshl_b32 s56,s77,5
s_add_u32 s56,s56,s68
s_mul_i32 s70,s56,24576
s_lshl_b32 s71,s56,12
s_lshl_b32 s59,s77,13
s_lshl2_add_u32 s59,s68,s59
s_add_u32 s59,s59,10485760
s_buffer_load_dword s32,s[8:11],s59 glc
s_mov_b32 s33,1
s_add_u32 s70,s70,100663296
s_add_u32 s71,s71,41943040
v_mov_b32 v19,s59
s_branch L_af_85
L_ae_84:
s_ff1_i32_b64 s77,s[84:85]
s_bitset0_b64 s[84:85],s77
s_min_u32 s77,s77,64
s_lshr_b32 s61,s55,5
s_lshl_b32 s56,s77,5
s_add_u32 s56,s56,s68
s_mul_i32 s70,s56,24576
s_lshl_b32 s71,s56,12
s_lshl_b32 s59,s77,13
s_lshl2_add_u32 s59,s68,s59
s_add_u32 s59,s59,10486144
s_cmp_lt_u32 s77,s61
s_cselect_b32 s57,0,16777216
s_cselect_b32 s60,0,128
s_add_u32 s60,s60,s59
s_add_u32 s60,s60,128
s_buffer_load_dword s33,s[8:11],s60 glc
s_add_u32 s71,s71,s57
s_add_u32 s71,s71,58720256
s_cmp_eq_u32 s77,s61
s_cselect_b32 s57,50331648,0
s_cselect_b32 s58,1536,0
s_add_u32 s59,s59,s58
s_buffer_load_dword s32,s[8:11],s59 glc
s_add_u32 s70,s70,s57
s_add_u32 s70,s70,150994944
v_mov_b32 v19,s59
v_writelane_b32 v19,s60,1
L_af_85:
s_branch L_ak_77
L_al_76:
s_add_u32 s66,s66,4
s_bfe_u32 s56,s66,0x10002
s_bitset0_b32 s37,s56
s_or_b32 s56,s37,s66
v_mov_b32 v22,s56
s_xor_b32 s69,s69,524288
s_waitcnt vmcnt(0) lgkmcnt(0)
s_barrier
buffer_store_dword v22,off,s[8:11],s74
buffer_store_dword v20,off,s[8:11],s73 sc1
s_mov_b32 s73,0x80000000
L_ak_77:
L_aq_86:
buffer_load_dword v17,v16,s[8:11],s87 offen sc1
s_sub_u32 s49,s49,1
s_cbranch_scc1 L_abort
s_waitcnt vmcnt(0)
v_cmp_gt_u32 vcc,s66,v17
s_cbranch_vccnz L_aq_86
s_xor_b32 s34,s69,524288
buffer_load_dwordx4 v[160:163],v7,s[8:11],s34 offen sc1
s_add_u32 s34,s34,4096
buffer_load_dwordx4 v[164:167],v7,s[8:11],s34 offen sc1
s_add_u32 s34,s34,4096
buffer_load_dwordx4 v[168:171],v7,s[8:11],s34 offen sc1
s_add_u32 s34,s34,4096
buffer_load_dwordx4 v[172:175],v7,s[8:11],s34 offen sc1
s_add_u32 s34,s34,4096
buffer_load_dwordx4 v[176:179],v7,s[8:11],s34 offen sc1
s_add_u32 s34,s34,4096
buffer_load_dwordx4 v[180:183],v7,s[8:11],s34 offen sc1
s_add_u32 s34,s34,4096
buffer_load_dwordx4 v[184:187],v7,s[8:11],s34 offen sc1
s_add_u32 s34,s34,4096
buffer_load_dwordx4 v[188:191],v7,s[8:11],s34 offen sc1
s_waitcnt vmcnt(7)
v_mfma_f32_16x16x32_bf16 v[192:195],v[156:159],v[160:163],0
s_waitcnt vmcnt(6)
v_mfma_f32_16x16x32_bf16 v[192:195],v[156:159],v[164:167],v[192:195]
s_waitcnt vmcnt(5)
v_mfma_f32_16x16x32_bf16 v[192:195],v[156:159],v[168:171],v[192:195]
s_waitcnt vmcnt(4)
v_mfma_f32_16x16x32_bf16 v[192:195],v[156:159],v[172:175],v[192:195]
s_waitcnt vmcnt(3)
v_mfma_f32_16x16x32_bf16 v[196:199],v[156:159],v[176:179],0
s_waitcnt vmcnt(2)
v_mfma_f32_16x16x32_bf16 v[196:199],v[156:159],v[180:183],v[196:199]
s_waitcnt vmcnt(1)
v_mfma_f32_16x16x32_bf16 v[196:199],v[156:159],v[184:187],v[196:199]
ds_write_b128 v6,v[192:195]
s_waitcnt vmcnt(0)
v_mfma_f32_16x16x32_bf16 v[196:199],v[156:159],v[188:191],v[196:199]
s_nop 7
ds_write_b128 v6,v[196:199] offset:2048
s_waitcnt lgkmcnt(0)
s_barrier
s_mov_b32 s27,2
L_aa_63:
s_cmp_lg_u32 s31,0
s_cbranch_scc1 L_ar_89
s_bitcmp1_b32 s46,0
s_cbranch_scc1 L_ar_88
L_ar_87:
ds_read_b128 v[160:163],v23
ds_read_b128 v[164:167],v23 offset:16
v_lshlrev_b32 v200,16,v224
v_and_b32 v201,0xffff0000,v224
v_lshlrev_b32 v202,16,v225
v_and_b32 v203,0xffff0000,v225
v_lshlrev_b32 v204,16,v226
v_and_b32 v205,0xffff0000,v226
v_lshlrev_b32 v206,16,v227
v_and_b32 v207,0xffff0000,v227
s_lshl_b32 s18,s51,5
s_add_u32 s18,s18,s68
s_lshl_b32 s19,s18,10
s_add_u32 s20,s19,8388608
s_waitcnt lgkmcnt(0)
v_cvt_pk_bf16_f32 v168,v160,v161
v_cvt_pk_bf16_f32 v169,v162,v163
v_cvt_pk_bf16_f32 v170,v164,v165
v_cvt_pk_bf16_f32 v171,v166,v167
v_lshlrev_b32 v160,16,v168
v_and_b32 v161,0xffff0000,v168
v_lshlrev_b32 v162,16,v169
v_and_b32 v163,0xffff0000,v169
v_lshlrev_b32 v164,16,v170
v_and_b32 v165,0xffff0000,v170
v_lshlrev_b32 v166,16,v171
v_and_b32 v167,0xffff0000,v171
v_pk_add_f32 v[200:201],v[200:201],v[160:161]
v_pk_add_f32 v[202:203],v[202:203],v[162:163]
v_pk_add_f32 v[204:205],v[204:205],v[164:165]
v_pk_add_f32 v[206:207],v[206:207],v[166:167]
v_cvt_pk_bf16_f32 v168,v200,v201
v_cvt_pk_bf16_f32 v169,v202,v203
v_cvt_pk_bf16_f32 v170,v204,v205
v_cvt_pk_bf16_f32 v171,v206,v207
v_lshlrev_b32 v200,16,v168
v_and_b32 v201,0xffff0000,v168
v_lshlrev_b32 v202,16,v169
v_and_b32 v203,0xffff0000,v169
v_lshlrev_b32 v204,16,v170
v_and_b32 v205,0xffff0000,v170
v_lshlrev_b32 v206,16,v171
v_and_b32 v207,0xffff0000,v171
v_readfirstlane_b32 s78,v200
s_nop 1
v_pk_add_f32 v[184:185],v[200:201],s[78:79] op_sel_hi:[1,0] neg_lo:[0,1] neg_hi:[0,1]
v_pk_add_f32 v[186:187],v[202:203],s[78:79] op_sel_hi:[1,0] neg_lo:[0,1] neg_hi:[0,1]
v_pk_add_f32 v[188:189],v[204:205],s[78:79] op_sel_hi:[1,0] neg_lo:[0,1] neg_hi:[0,1]
v_pk_add_f32 v[190:191],v[206:207],s[78:79] op_sel_hi:[1,0] neg_lo:[0,1] neg_hi:[0,1]
v_pk_add_f32 v[192:193],v[184:185],v[186:187]
v_pk_mul_f32 v[194:195],v[184:185],v[184:185]
v_pk_add_f32 v[196:197],v[188:189],v[190:191]
v_pk_fma_f32 v[194:195],v[186:187],v[186:187],v[194:195]
v_pk_add_f32 v[192:193],v[192:193],v[196:197]
v_pk_fma_f32 v[194:195],v[188:189],v[188:189],v[194:195]
v_add_f32 v192,v192,v193
v_pk_fma_f32 v[194:195],v[190:191],v[190:191],v[194:195]
v_add_f32 v194,v194,v195
s_nop 1
v_permlane32_swap_b32 v192,v194
v_add_f32 v192,v192,v194
s_nop 1
v_add_f32_dpp v192,v192,v192 row_ror:8 row_mask:0xf bank_mask:0xf
s_nop 1
v_add_f32_dpp v192,v192,v192 row_ror:4 row_mask:0xf bank_mask:0xf
s_nop 1
v_add_f32_dpp v192,v192,v192 row_ror:2 row_mask:0xf bank_mask:0xf
s_nop 1
v_add_f32_dpp v192,v192,v192 row_ror:1 row_mask:0xf bank_mask:0xf
v_mov_b32 v194,v192
s_nop 1
v_permlane16_swap_b32 v192,v194
v_add_f32 v192,v192,v194
v_mul_f32 v192,0x3b000000,v192
v_mov_b32 v194,v192
s_nop 1
v_permlane32_swap_b32 v192,v194
v_fma_f32 v194,-v192,v192,v194
v_add_f32 v192,s78,v192
v_max_f32 v194,0,v194
v_cvt_pk_bf16_f32 v194,v192,v194
v_lshlrev_b32 v192,16,v194
v_and_b32 v194,0xffff0000,v194
v_add_f32 v194,0x3727c5ac,v194
v_cvt_pk_bf16_f32 v194,v194,v194
v_and_b32 v194,0xffff0000,v194
v_sqrt_f32 v194,v194
v_pk_add_f32 v[184:185],v[200:201],v[192:193] op_sel_hi:[1,0] neg_lo:[0,1] neg_hi:[0,1]
v_pk_add_f32 v[186:187],v[202:203],v[192:193] op_sel_hi:[1,0] neg_lo:[0,1] neg_hi:[0,1]
v_pk_add_f32 v[188:189],v[204:205],v[192:193] op_sel_hi:[1,0] neg_lo:[0,1] neg_hi:[0,1]
v_pk_add_f32 v[190:191],v[206:207],v[192:193] op_sel_hi:[1,0] neg_lo:[0,1] neg_hi:[0,1]
v_cvt_pk_bf16_f32 v194,v194,v194
v_and_b32 v194,0xffff0000,v194
v_rcp_f32 v194,v194
v_cvt_pk_bf16_f32 v172,v184,v185
v_cvt_pk_bf16_f32 v173,v186,v187
v_cvt_pk_bf16_f32 v174,v188,v189
v_cvt_pk_bf16_f32 v175,v190,v191
v_lshlrev_b32 v184,16,v172
v_and_b32 v185,0xffff0000,v172
v_lshlrev_b32 v186,16,v173
v_and_b32 v187,0xffff0000,v173
v_lshlrev_b32 v188,16,v174
v_and_b32 v189,0xffff0000,v174
v_lshlrev_b32 v190,16,v175
v_and_b32 v191,0xffff0000,v175
v_pk_mul_f32 v[184:185],v[184:185],v[194:195] op_sel_hi:[1,0]
v_pk_mul_f32 v[186:187],v[186:187],v[194:195] op_sel_hi:[1,0]
v_pk_mul_f32 v[188:189],v[188:189],v[194:195] op_sel_hi:[1,0]
v_pk_mul_f32 v[190:191],v[190:191],v[194:195] op_sel_hi:[1,0]
v_cvt_pk_bf16_f32 v172,v184,v185
v_cvt_pk_bf16_f32 v173,v186,v187
v_cvt_pk_bf16_f32 v174,v188,v189
v_cvt_pk_bf16_f32 v175,v190,v191
v_lshlrev_b32 v176,16,v172
v_and_b32 v177,0xffff0000,v172
v_lshlrev_b32 v178,16,v173
v_and_b32 v179,0xffff0000,v173
v_lshlrev_b32 v180,16,v174
v_and_b32 v181,0xffff0000,v174
v_lshlrev_b32 v182,16,v175
v_and_b32 v183,0xffff0000,v175
v_pk_add_f32 v[200:201],v[200:201],v[176:177]
v_pk_add_f32 v[202:203],v[202:203],v[178:179]
v_pk_add_f32 v[204:205],v[204:205],v[180:181]
v_pk_add_f32 v[206:207],v[206:207],v[182:183]
v_cvt_pk_bf16_f32 v160,v200,v201
v_cvt_pk_bf16_f32 v161,v202,v203
v_cvt_pk_bf16_f32 v162,v204,v205
v_cvt_pk_bf16_f32 v163,v206,v207
buffer_store_dwordx4 v[160:163],v0,s[8:11],s20 offen sc1
v_lshlrev_b32 v200,16,v160
v_and_b32 v201,0xffff0000,v160
v_lshlrev_b32 v202,16,v161
v_and_b32 v203,0xffff0000,v161
v_lshlrev_b32 v204,16,v162
v_and_b32 v205,0xffff0000,v162
v_lshlrev_b32 v206,16,v163
v_and_b32 v207,0xffff0000,v163
v_readfirstlane_b32 s78,v200
s_nop 1
v_pk_add_f32 v[184:185],v[200:201],s[78:79] op_sel_hi:[1,0] neg_lo:[0,1] neg_hi:[0,1]
v_pk_add_f32 v[186:187],v[202:203],s[78:79] op_sel_hi:[1,0] neg_lo:[0,1] neg_hi:[0,1]
v_pk_add_f32 v[188:189],v[204:205],s[78:79] op_sel_hi:[1,0] neg_lo:[0,1] neg_hi:[0,1]
v_pk_add_f32 v[190:191],v[206:207],s[78:79] op_sel_hi:[1,0] neg_lo:[0,1] neg_hi:[0,1]
v_pk_add_f32 v[192:193],v[184:185],v[186:187]
v_pk_mul_f32 v[194:195],v[184:185],v[184:185]
v_pk_add_f32 v[196:197],v[188:189],v[190:191]
v_pk_fma_f32 v[194:195],v[186:187],v[186:187],v[194:195]
v_pk_add_f32 v[192:193],v[192:193],v[196:197]
v_pk_fma_f32 v[194:195],v[188:189],v[188:189],v[194:195]
v_add_f32 v192,v192,v193
v_pk_fma_f32 v[194:195],v[190:191],v[190:191],v[194:195]
v_add_f32 v194,v194,v195
s_nop 1
v_permlane32_swap_b32 v192,v194
v_add_f32 v192,v192,v194
s_nop 1
v_add_f32_dpp v192,v192,v192 row_ror:8 row_mask:0xf bank_mask:0xf
s_nop 1
v_add_f32_dpp v192,v192,v192 row_ror:4 row_mask:0xf bank_mask:0xf
s_nop 1
v_add_f32_dpp v192,v192,v192 row_ror:2 row_mask:0xf bank_mask:0xf
s_nop 1
v_add_f32_dpp v192,v192,v192 row_ror:1 row_mask:0xf bank_mask:0xf
v_mov_b32 v194,v192
s_nop 1
v_permlane16_swap_b32 v192,v194
v_add_f32 v192,v192,v194
v_mul_f32 v192,0x3b000000,v192
v_mov_b32 v194,v192
s_nop 1
v_permlane32_swap_b32 v192,v194
v_fma_f32 v194,-v192,v192,v194
v_add_f32 v192,s78,v192
v_max_f32 v194,0,v194
v_cvt_pk_bf16_f32 v194,v192,v194
v_lshlrev_b32 v192,16,v194
v_and_b32 v194,0xffff0000,v194
v_add_f32 v194,0x3727c5ac,v194
v_cvt_pk_bf16_f32 v194,v194,v194
v_and_b32 v194,0xffff0000,v194
v_sqrt_f32 v194,v194
v_pk_add_f32 v[184:185],v[200:201],v[192:193] op_sel_hi:[1,0] neg_lo:[0,1] neg_hi:[0,1]
v_pk_add_f32 v[186:187],v[202:203],v[192:193] op_sel_hi:[1,0] neg_lo:[0,1] neg_hi:[0,1]
v_pk_add_f32 v[188:189],v[204:205],v[192:193] op_sel_hi:[1,0] neg_lo:[0,1] neg_hi:[0,1]
v_pk_add_f32 v[190:191],v[206:207],v[192:193] op_sel_hi:[1,0] neg_lo:[0,1] neg_hi:[0,1]
v_cvt_pk_bf16_f32 v194,v194,v194
v_and_b32 v194,0xffff0000,v194
v_rcp_f32 v194,v194
v_cvt_pk_bf16_f32 v164,v184,v185
v_cvt_pk_bf16_f32 v165,v186,v187
v_cvt_pk_bf16_f32 v166,v188,v189
v_cvt_pk_bf16_f32 v167,v190,v191
v_lshlrev_b32 v184,16,v164
v_and_b32 v185,0xffff0000,v164
v_lshlrev_b32 v186,16,v165
v_and_b32 v187,0xffff0000,v165
v_lshlrev_b32 v188,16,v166
v_and_b32 v189,0xffff0000,v166
v_lshlrev_b32 v190,16,v167
v_and_b32 v191,0xffff0000,v167
v_pk_mul_f32 v[184:185],v[184:185],v[194:195] op_sel_hi:[1,0]
v_pk_mul_f32 v[186:187],v[186:187],v[194:195] op_sel_hi:[1,0]
v_pk_mul_f32 v[188:189],v[188:189],v[194:195] op_sel_hi:[1,0]
v_pk_mul_f32 v[190:191],v[190:191],v[194:195] op_sel_hi:[1,0]
v_cvt_pk_bf16_f32 v164,v184,v185
v_cvt_pk_bf16_f32 v165,v186,v187
v_cvt_pk_bf16_f32 v166,v188,v189
v_cvt_pk_bf16_f32 v167,v190,v191
s_add_u32 s20,s19,2097152
buffer_store_dwordx4 v[164:167],v0,s[8:11],s20 offen sc1
v_mov_b32 v20,1
s_lshl_b32 s73,s51,13
s_lshl2_add_u32 s73,s68,s73
s_add_u32 s73,s73,10487552
s_branch L_aa_64
L_ar_88:
ds_read_b128 v[160:163],v23
ds_read_b128 v[164:167],v23 offset:16
v_lshlrev_b32 v200,16,v224
v_and_b32 v201,0xffff0000,v224
v_lshlrev_b32 v202,16,v225
v_and_b32 v203,0xffff0000,v225
v_lshlrev_b32 v204,16,v226
v_and_b32 v205,0xffff0000,v226
v_lshlrev_b32 v206,16,v227
v_and_b32 v207,0xffff0000,v227
s_lshl_b32 s18,s51,5
s_add_u32 s18,s18,s68
s_lshl_b32 s19,s18,10
s_add_u32 s20,s19,4194304
s_waitcnt lgkmcnt(0)
v_cvt_pk_bf16_f32 v168,v160,v161
v_cvt_pk_bf16_f32 v169,v162,v163
v_cvt_pk_bf16_f32 v170,v164,v165
v_cvt_pk_bf16_f32 v171,v166,v167
v_lshlrev_b32 v160,16,v168
v_and_b32 v161,0xffff0000,v168
v_lshlrev_b32 v162,16,v169
v_and_b32 v163,0xffff0000,v169
v_lshlrev_b32 v164,16,v170
v_and_b32 v165,0xffff0000,v170
v_lshlrev_b32 v166,16,v171
v_and_b32 v167,0xffff0000,v171
v_pk_add_f32 v[200:201],v[200:201],v[160:161]
v_pk_add_f32 v[202:203],v[202:203],v[162:163]
v_pk_add_f32 v[204:205],v[204:205],v[164:165]
v_pk_add_f32 v[206:207],v[206:207],v[166:167]
v_cvt_pk_bf16_f32 v168,v200,v201
v_cvt_pk_bf16_f32 v169,v202,v203
v_cvt_pk_bf16_f32 v170,v204,v205
v_cvt_pk_bf16_f32 v171,v206,v207
buffer_store_dwordx4 v[168:171],v0,s[8:11],s20 offen sc1
v_lshlrev_b32 v200,16,v168
v_and_b32 v201,0xffff0000,v168
v_lshlrev_b32 v202,16,v169
v_and_b32 v203,0xffff0000,v169
v_lshlrev_b32 v204,16,v170
v_and_b32 v205,0xffff0000,v170
v_lshlrev_b32 v206,16,v171
v_and_b32 v207,0xffff0000,v171
v_readfirstlane_b32 s78,v200
s_nop 1
v_pk_add_f32 v[184:185],v[200:201],s[78:79] op_sel_hi:[1,0] neg_lo:[0,1] neg_hi:[0,1]
v_pk_add_f32 v[186:187],v[202:203],s[78:79] op_sel_hi:[1,0] neg_lo:[0,1] neg_hi:[0,1]
v_pk_add_f32 v[188:189],v[204:205],s[78:79] op_sel_hi:[1,0] neg_lo:[0,1] neg_hi:[0,1]
v_pk_add_f32 v[190:191],v[206:207],s[78:79] op_sel_hi:[1,0] neg_lo:[0,1] neg_hi:[0,1]
v_pk_add_f32 v[192:193],v[184:185],v[186:187]
v_pk_mul_f32 v[194:195],v[184:185],v[184:185]
v_pk_add_f32 v[196:197],v[188:189],v[190:191]
v_pk_fma_f32 v[194:195],v[186:187],v[186:187],v[194:195]
v_pk_add_f32 v[192:193],v[192:193],v[196:197]
v_pk_fma_f32 v[194:195],v[188:189],v[188:189],v[194:195]
v_add_f32 v192,v192,v193
v_pk_fma_f32 v[194:195],v[190:191],v[190:191],v[194:195]
v_add_f32 v194,v194,v195
s_nop 1
v_permlane32_swap_b32 v192,v194
v_add_f32 v192,v192,v194
s_nop 1
v_add_f32_dpp v192,v192,v192 row_ror:8 row_mask:0xf bank_mask:0xf
s_nop 1
v_add_f32_dpp v192,v192,v192 row_ror:4 row_mask:0xf bank_mask:0xf
s_nop 1
v_add_f32_dpp v192,v192,v192 row_ror:2 row_mask:0xf bank_mask:0xf
s_nop 1
v_add_f32_dpp v192,v192,v192 row_ror:1 row_mask:0xf bank_mask:0xf
v_mov_b32 v194,v192
s_nop 1
v_permlane16_swap_b32 v192,v194
v_add_f32 v192,v192,v194
v_mul_f32 v192,0x3b000000,v192
v_mov_b32 v194,v192
s_nop 1
v_permlane32_swap_b32 v192,v194
v_fma_f32 v194,-v192,v192,v194
v_add_f32 v192,s78,v192
v_max_f32 v194,0,v194
v_cvt_pk_bf16_f32 v194,v192,v194
v_lshlrev_b32 v192,16,v194
v_and_b32 v194,0xffff0000,v194
v_add_f32 v194,0x3727c5ac,v194
v_cvt_pk_bf16_f32 v194,v194,v194
v_and_b32 v194,0xffff0000,v194
v_sqrt_f32 v194,v194
v_pk_add_f32 v[184:185],v[200:201],v[192:193] op_sel_hi:[1,0] neg_lo:[0,1] neg_hi:[0,1]
v_pk_add_f32 v[186:187],v[202:203],v[192:193] op_sel_hi:[1,0] neg_lo:[0,1] neg_hi:[0,1]
v_pk_add_f32 v[188:189],v[204:205],v[192:193] op_sel_hi:[1,0] neg_lo:[0,1] neg_hi:[0,1]
v_pk_add_f32 v[190:191],v[206:207],v[192:193] op_sel_hi:[1,0] neg_lo:[0,1] neg_hi:[0,1]
v_cvt_pk_bf16_f32 v194,v194,v194
v_and_b32 v194,0xffff0000,v194
v_rcp_f32 v194,v194
v_cvt_pk_bf16_f32 v172,v184,v185
v_cvt_pk_bf16_f32 v173,v186,v187
v_cvt_pk_bf16_f32 v174,v188,v189
v_cvt_pk_bf16_f32 v175,v190,v191
v_lshlrev_b32 v184,16,v172
v_and_b32 v185,0xffff0000,v172
v_lshlrev_b32 v186,16,v173
v_and_b32 v187,0xffff0000,v173
v_lshlrev_b32 v188,16,v174
v_and_b32 v189,0xffff0000,v174
v_lshlrev_b32 v190,16,v175
v_and_b32 v191,0xffff0000,v175
v_pk_mul_f32 v[184:185],v[184:185],v[194:195] op_sel_hi:[1,0]
v_pk_mul_f32 v[186:187],v[186:187],v[194:195] op_sel_hi:[1,0]
v_pk_mul_f32 v[188:189],v[188:189],v[194:195] op_sel_hi:[1,0]
v_pk_mul_f32 v[190:191],v[190:191],v[194:195] op_sel_hi:[1,0]
v_cvt_pk_bf16_f32 v172,v184,v185
v_cvt_pk_bf16_f32 v173,v186,v187
v_cvt_pk_bf16_f32 v174,v188,v189
v_cvt_pk_bf16_f32 v175,v190,v191
v_lshlrev_b32 v176,16,v172
v_and_b32 v177,0xffff0000,v172
v_lshlrev_b32 v178,16,v173
v_and_b32 v179,0xffff0000,v173
v_lshlrev_b32 v180,16,v174
v_and_b32 v181,0xffff0000,v174
v_lshlrev_b32 v182,16,v175
v_and_b32 v183,0xffff0000,v175
v_pk_mul_f32 v[236:237],v[176:177],v[228:229]
v_pk_fma_f32 v[236:237],v[178:179],v[230:231],v[236:237]
v_pk_fma_f32 v[236:237],v[180:181],v[232:233],v[236:237]
v_pk_fma_f32 v[236:237],v[182:183],v[234:235],v[236:237]
v_add_f32 v236,v236,v237
s_nop 1
v_add_f32_dpp v236,v236,v236 row_ror:8 row_mask:0xf bank_mask:0xf
s_nop 1
v_add_f32_dpp v236,v236,v236 row_ror:4 row_mask:0xf bank_mask:0xf
s_nop 1
v_add_f32_dpp v236,v236,v236 row_ror:2 row_mask:0xf bank_mask:0xf
s_nop 1
v_add_f32_dpp v236,v236,v236 row_ror:1 row_mask:0xf bank_mask:0xf
v_mov_b32 v237,v236
s_nop 1
v_permlane16_swap_b32 v236,v237
v_add_f32 v236,v236,v237
v_mov_b32 v237,v236
s_nop 1
v_permlane32_swap_b32 v236,v237
v_add_f32 v236,v236,v237
v_cvt_pk_bf16_f32 v236,v236,v236
v_and_b32 v236,0xffff0000,v236
v_ashrrev_i32 v237,31,v236
v_or_b32 v237,0x80000000,v237
v_xor_b32 v236,v236,v237
v_and_b32 v236,0xffff0000,v236
s_sub_u32 s20,4095,s18
v_or_b32 v20,s20,v236
s_lshl_b32 s20,s51,13
s_lshl2_add_u32 s20,s68,s20
s_add_u32 s20,s20,10485760
buffer_store_dword v20,v254,s[8:11],s20 offen sc1
s_branch L_aa_64
L_ar_89:
s_bitcmp1_b32 s46,0
s_cbranch_scc1 L_aa_64
ds_read_b128 v[160:163],v23
ds_read_b128 v[164:167],v23 offset:16
v_lshlrev_b32 v200,16,v224
v_and_b32 v201,0xffff0000,v224
v_lshlrev_b32 v202,16,v225
v_and_b32 v203,0xffff0000,v225
v_lshlrev_b32 v204,16,v226
v_and_b32 v205,0xffff0000,v226
v_lshlrev_b32 v206,16,v227
v_and_b32 v207,0xffff0000,v227
v_readfirstlane_b32 s22,v246
s_cmp_eq_u32 s22,0
s_cbranch_scc1 L_ag_90
L_agb_91:
s_lshl_b32 s18,s51,5
s_add_u32 s18,s18,s68
s_lshl_b32 s19,s18,10
s_add_u32 s20,s19,6291456
s_waitcnt lgkmcnt(0)
v_cvt_pk_bf16_f32 v168,v160,v161
v_cvt_pk_bf16_f32 v169,v162,v163
v_cvt_pk_bf16_f32 v170,v164,v165
v_cvt_pk_bf16_f32 v171,v166,v167
v_lshlrev_b32 v160,16,v168
v_and_b32 v161,0xffff0000,v168
v_lshlrev_b32 v162,16,v169
v_and_b32 v163,0xffff0000,v169
v_lshlrev_b32 v164,16,v170
v_and_b32 v165,0xffff0000,v170
v_lshlrev_b32 v166,16,v171
v_and_b32 v167,0xffff0000,v171
v_pk_add_f32 v[200:201],v[200:201],v[160:161]
v_pk_add_f32 v[202:203],v[202:203],v[162:163]
v_pk_add_f32 v[204:205],v[204:205],v[164:165]
v_pk_add_f32 v[206:207],v[206:207],v[166:167]
v_cvt_pk_bf16_f32 v168,v200,v201
v_cvt_pk_bf16_f32 v169,v202,v203
v_cvt_pk_bf16_f32 v170,v204,v205
v_cvt_pk_bf16_f32 v171,v206,v207
buffer_store_dwordx4 v[168:171],v0,s[8:11],s20 offen sc1
v_lshlrev_b32 v200,16,v168
v_and_b32 v201,0xffff0000,v168
v_lshlrev_b32 v202,16,v169
v_and_b32 v203,0xffff0000,v169
v_lshlrev_b32 v204,16,v170
v_and_b32 v205,0xffff0000,v170
v_lshlrev_b32 v206,16,v171
v_and_b32 v207,0xffff0000,v171
v_readfirstlane_b32 s78,v200
s_nop 1
v_pk_add_f32 v[184:185],v[200:201],s[78:79] op_sel_hi:[1,0] neg_lo:[0,1] neg_hi:[0,1]
v_pk_add_f32 v[186:187],v[202:203],s[78:79] op_sel_hi:[1,0] neg_lo:[0,1] neg_hi:[0,1]
v_pk_add_f32 v[188:189],v[204:205],s[78:79] op_sel_hi:[1,0] neg_lo:[0,1] neg_hi:[0,1]
v_pk_add_f32 v[190:191],v[206:207],s[78:79] op_sel_hi:[1,0] neg_lo:[0,1] neg_hi:[0,1]
v_pk_add_f32 v[192:193],v[184:185],v[186:187]
v_pk_mul_f32 v[194:195],v[184:185],v[184:185]
v_pk_add_f32 v[196:197],v[188:189],v[190:191]
v_pk_fma_f32 v[194:195],v[186:187],v[186:187],v[194:195]
v_pk_add_f32 v[192:193],v[192:193],v[196:197]
v_pk_fma_f32 v[194:195],v[188:189],v[188:189],v[194:195]
v_add_f32 v192,v192,v193
v_pk_fma_f32 v[194:195],v[190:191],v[190:191],v[194:195]
v_add_f32 v194,v194,v195
s_nop 1
v_permlane32_swap_b32 v192,v194
v_add_f32 v192,v192,v194
s_nop 1
v_add_f32_dpp v192,v192,v192 row_ror:8 row_mask:0xf bank_mask:0xf
s_nop 1
v_add_f32_dpp v192,v192,v192 row_ror:4 row_mask:0xf bank_mask:0xf
s_nop 1
v_add_f32_dpp v192,v192,v192 row_ror:2 row_mask:0xf bank_mask:0xf
s_nop 1
v_add_f32_dpp v192,v192,v192 row_ror:1 row_mask:0xf bank_mask:0xf
v_mov_b32 v194,v192
s_nop 1
v_permlane16_swap_b32 v192,v194
v_add_f32 v192,v192,v194
v_mul_f32 v192,0x3b000000,v192
v_mov_b32 v194,v192
s_nop 1
v_permlane32_swap_b32 v192,v194
v_fma_f32 v194,-v192,v192,v194
v_add_f32 v192,s78,v192
v_max_f32 v194,0,v194
v_cvt_pk_bf16_f32 v194,v192,v194
v_lshlrev_b32 v192,16,v194
v_and_b32 v194,0xffff0000,v194
v_add_f32 v194,0x3727c5ac,v194
v_cvt_pk_bf16_f32 v194,v194,v194
v_and_b32 v194,0xffff0000,v194
v_sqrt_f32 v194,v194
v_pk_add_f32 v[184:185],v[200:201],v[192:193] op_sel_hi:[1,0] neg_lo:[0,1] neg_hi:[0,1]
v_pk_add_f32 v[186:187],v[202:203],v[192:193] op_sel_hi:[1,0] neg_lo:[0,1] neg_hi:[0,1]
v_pk_add_f32 v[188:189],v[204:205],v[192:193] op_sel_hi:[1,0] neg_lo:[0,1] neg_hi:[0,1]
v_pk_add_f32 v[190:191],v[206:207],v[192:193] op_sel_hi:[1,0] neg_lo:[0,1] neg_hi:[0,1]
v_cvt_pk_bf16_f32 v194,v194,v194
v_and_b32 v194,0xffff0000,v194
v_rcp_f32 v194,v194
v_cvt_pk_bf16_f32 v172,v184,v185
v_cvt_pk_bf16_f32 v173,v186,v187
v_cvt_pk_bf16_f32 v174,v188,v189
v_cvt_pk_bf16_f32 v175,v190,v191
v_lshlrev_b32 v184,16,v172
v_and_b32 v185,0xffff0000,v172
v_lshlrev_b32 v186,16,v173
v_and_b32 v187,0xffff0000,v173
v_lshlrev_b32 v188,16,v174
v_and_b32 v189,0xffff0000,v174
v_lshlrev_b32 v190,16,v175
v_and_b32 v191,0xffff0000,v175
v_pk_mul_f32 v[184:185],v[184:185],v[194:195] op_sel_hi:[1,0]
v_pk_mul_f32 v[186:187],v[186:187],v[194:195] op_sel_hi:[1,0]
v_pk_mul_f32 v[188:189],v[188:189],v[194:195] op_sel_hi:[1,0]
v_pk_mul_f32 v[190:191],v[190:191],v[194:195] op_sel_hi:[1,0]
v_cvt_pk_bf16_f32 v172,v184,v185
v_cvt_pk_bf16_f32 v173,v186,v187
v_cvt_pk_bf16_f32 v174,v188,v189
v_cvt_pk_bf16_f32 v175,v190,v191
v_lshlrev_b32 v176,16,v172
v_and_b32 v177,0xffff0000,v172
v_lshlrev_b32 v178,16,v173
v_and_b32 v179,0xffff0000,v173
v_lshlrev_b32 v180,16,v174
v_and_b32 v181,0xffff0000,v174
v_lshlrev_b32 v182,16,v175
v_and_b32 v183,0xffff0000,v175
v_pk_add_f32 v[200:201],v[200:201],v[176:177]
v_pk_add_f32 v[202:203],v[202:203],v[178:179]
v_pk_add_f32 v[204:205],v[204:205],v[180:181]
v_pk_add_f32 v[206:207],v[206:207],v[182:183]
v_cvt_pk_bf16_f32 v160,v200,v201
v_cvt_pk_bf16_f32 v161,v202,v203
v_cvt_pk_bf16_f32 v162,v204,v205
v_cvt_pk_bf16_f32 v163,v206,v207
buffer_store_dwordx4 v[160:163],v0,s[12:15],s19 offen sc1
v_pk_mul_f32 v[236:237],v[176:177],v[228:229]
v_pk_fma_f32 v[236:237],v[178:179],v[230:231],v[236:237]
v_pk_fma_f32 v[236:237],v[180:181],v[232:233],v[236:237]
v_pk_fma_f32 v[236:237],v[182:183],v[234:235],v[236:237]
v_add_f32 v236,v236,v237
s_nop 1
v_add_f32_dpp v236,v236,v236 row_ror:8 row_mask:0xf bank_mask:0xf
s_nop 1
v_add_f32_dpp v236,v236,v236 row_ror:4 row_mask:0xf bank_mask:0xf
s_nop 1
v_add_f32_dpp v236,v236,v236 row_ror:2 row_mask:0xf bank_mask:0xf
s_nop 1
v_add_f32_dpp v236,v236,v236 row_ror:1 row_mask:0xf bank_mask:0xf
v_mov_b32 v237,v236
s_nop 1
v_permlane16_swap_b32 v236,v237
v_add_f32 v236,v236,v237
v_mov_b32 v237,v236
s_nop 1
v_permlane32_swap_b32 v236,v237
v_add_f32 v236,v236,v237
v_cvt_pk_bf16_f32 v236,v236,v236
v_and_b32 v236,0xffff0000,v236
v_ashrrev_i32 v237,31,v236
v_or_b32 v237,0x80000000,v237
v_xor_b32 v236,v236,v237
v_and_b32 v236,0xffff0000,v236
s_sub_u32 s20,4095,s18
v_or_b32 v20,s20,v236
s_lshl_b32 s73,s51,13
s_lshl2_add_u32 s73,s68,s73
s_add_u32 s73,s73,10485760
s_add_u32 s73,s73,s86
L_aa_64:
s_cmp_eq_u32 s27,1
s_cbranch_scc1 L_ad_92
s_cmp_eq_u32 s27,0
s_cbranch_scc1 L_aa_65
s_cmp_ge_u32 s77,64
s_cbranch_scc1 L_aa_68
L_aa_66:
s_waitcnt vmcnt(0)
buffer_store_dword v20,off,s[8:11],s73 sc1
s_mov_b32 s73,0x80000000
v_mov_b32 v18,0
s_mov_b32 s27,0
L_aw_93:
v_cmp_eq_u32 vcc,0,v18
s_cbranch_vccz L_awd_94
buffer_load_dword v18,v19,s[8:11],0 offen sc1
s_sub_u32 s49,s49,1
s_cbranch_scc1 L_abort
s_waitcnt vmcnt(0)
s_branch L_aw_93
L_awd_94:
s_mov_b32 s64,s70
s_mov_b32 s65,s71
s_and_b32 s57,s46,1
s_mul_i32 s58,s57,12288
s_add_u32 s64,s64,s58
s_lshl_b32 s57,s57,11
s_add_u32 s65,s65,s57
s_and_b32 s59,s50,2048
s_lshl_b32 s59,s59,4
s_xor_b32 s60,s67,65536
s_add_u32 s59,s59,s60
s_add_u32 s58,s58,s59
s_add_u32 s57,s57,s59
s_add_u32 m0,s58,0
s_nop 0
buffer_load_dwordx4 v0,s[8:11],s64 offen offset:0 sc1 lds
buffer_load_dwordx4 v0,s[8:11],s64 offen offset:1024 sc1 lds
buffer_load_dwordx4 v0,s[8:11],s64 offen offset:2048 sc1 lds
buffer_load_dwordx4 v0,s[8:11],s64 offen offset:3072 sc1 lds
s_add_u32 m0,s58,4096
s_add_u32 s64,s64,4096
buffer_load_dwordx4 v0,s[8:11],s64 offen offset:0 sc1 lds
buffer_load_dwordx4 v0,s[8:11],s64 offen offset:1024 sc1 lds
buffer_load_dwordx4 v0,s[8:11],s64 offen offset:2048 sc1 lds
buffer_load_dwordx4 v0,s[8:11],s64 offen offset:3072 sc1 lds
s_add_u32 m0,s58,8192
s_add_u32 s64,s64,4096
buffer_load_dwordx4 v0,s[8:11],s64 offen offset:0 sc1 lds
buffer_load_dwordx4 v0,s[8:11],s64 offen offset:1024 sc1 lds
buffer_load_dwordx4 v0,s[8:11],s64 offen offset:2048 sc1 lds
buffer_load_dwordx4 v0,s[8:11],s64 offen offset:3072 sc1 lds
s_add_u32 m0,s57,24576
s_nop 0
buffer_load_dwordx4 v0,s[8:11],s65 offen offset:0 sc1 lds
buffer_load_dwordx4 v0,s[8:11],s65 offen offset:1024 sc1 lds
v_lshrrev_b32 v244,4,v1
s_sub_u32 s56,s77,8
v_add_u32 v244,s56,v244
v_max_i32 v244,0,v244
v_lshl_add_u32 v244,v244,13,v21
buffer_load_dwordx2 v[242:243],v244,s[8:11],0 offen sc1
s_waitcnt vmcnt(0) lgkmcnt(0)
s_barrier
s_xor_b32 s67,s67,65536
s_and_b32 s56,s50,2048
s_lshl_b32 s56,s56,4
s_add_u32 s56,s56,s67
v_add_u32 v2,s56,v0
v_add_u32 v239,s56,v253
s_and_b32 s56,s50,1024
s_lshl_b32 s56,s56,2
v_add_u32 v238,s56,v2
s_mov_b32 s76,s71
s_mov_b32 s53,s77
ds_read_b128 v[24:27],v238 offset:16384
ds_read_b128 v[40:43],v2 offset:0
ds_read_b128 v[56:59],v2 offset:4096
ds_read_b128 v[28:31],v238 offset:17408
ds_read_b128 v[44:47],v2 offset:1024
ds_read_b128 v[60:63],v2 offset:5120
ds_read_b128 v[32:35],v238 offset:18432
ds_read_b128 v[48:51],v2 offset:2048
ds_read_b128 v[64:67],v2 offset:6144
ds_read_b128 v[36:39],v238 offset:19456
ds_read_b128 v[52:55],v2 offset:3072
ds_read_b128 v[68:71],v2 offset:7168
s_waitcnt lgkmcnt(9)
v_mfma_f32_16x16x32_bf16 v[128:131],v[40:43],v[24:27],v[8:11]
ds_read_b128 v[72:75],v2 offset:24576
v_mfma_f32_16x16x32_bf16 v[132:135],v[56:59],v[24:27],v[12:15]
ds_read_b128 v[76:79],v2 offset:25600
s_waitcnt lgkmcnt(8)
v_mfma_f32_16x16x32_bf16 v[128:131],v[44:47],v[28:31],v[128:131]
ds_read_b128 v[80:83],v2 offset:26624
v_mfma_f32_16x16x32_bf16 v[132:135],v[60:63],v[28:31],v[132:135]
ds_read_b128 v[84:87],v2 offset:27648
s_waitcnt lgkmcnt(7)
v_mfma_f32_16x16x32_bf16 v[128:131],v[48:51],v[32:35],v[128:131]
ds_read_b64 v[120:121],v239 offset:24576
v_mfma_f32_16x16x32_bf16 v[132:135],v[64:67],v[32:35],v[132:135]
ds_read_b64 v[122:123],v239 offset:25600
s_waitcnt lgkmcnt(6)
v_mfma_f32_16x16x32_bf16 v[128:131],v[52:55],v[36:39],v[128:131]
ds_read_b64 v[124:125],v239 offset:26624
v_mfma_f32_16x16x32_bf16 v[132:135],v[68:71],v[36:39],v[132:135]
ds_read_b64 v[126:127],v239 offset:27648
s_waitcnt lgkmcnt(4)
v_mfma_f32_16x16x32_bf16 v[136:139],v[72:75],v[24:27],0
ds_read_b128 v[88:91],v2 offset:8192
ds_read_b128 v[92:95],v2 offset:9216
v_mfma_f32_16x16x32_bf16 v[136:139],v[76:79],v[28:31],v[136:139]
ds_read_b128 v[96:99],v2 offset:10240
ds_read_b128 v[100:103],v2 offset:11264
v_mfma_f32_16x16x32_bf16 v[136:139],v[80:83],v[32:35],v[136:139]
ds_read_b128 v[104:107],v2 offset:12288
ds_read_b128 v[108:111],v2 offset:13312
v_mfma_f32_16x16x32_bf16 v[136:139],v[84:87],v[36:39],v[136:139]
ds_read_b128 v[112:115],v2 offset:14336
ds_read_b128 v[116:119],v2 offset:15360
s_waitcnt lgkmcnt(0)
s_cmp_eq_u32 s30,0
s_cbranch_scc1 L_aa_67
s_cmp_lg_u32 s86,1536
s_cbranch_scc1 L_ae_95
s_mov_b32 s77,s35
s_mov_b32 s30,0
s_lshl_b32 s56,s77,5
s_add_u32 s56,s56,s68
s_mul_i32 s70,s56,24576
s_lshl_b32 s71,s56,12
s_lshl_b32 s59,s77,13
s_lshl2_add_u32 s59,s68,s59
s_add_u32 s59,s59,10485760
s_buffer_load_dword s32,s[8:11],s59 glc
s_mov_b32 s33,1
s_add_u32 s70,s70,100663296
s_add_u32 s71,s71,41943040
v_mov_b32 v19,s59
s_branch L_af_96
L_ae_95:
s_ff1_i32_b64 s77,s[84:85]
s_bitset0_b64 s[84:85],s77
s_min_u32 s77,s77,64
s_lshr_b32 s61,s55,5
s_lshl_b32 s56,s77,5
s_add_u32 s56,s56,s68
s_mul_i32 s70,s56,24576
s_lshl_b32 s71,s56,12
s_lshl_b32 s59,s77,13
s_lshl2_add_u32 s59,s68,s59
s_add_u32 s59,s59,10486144
s_cmp_lt_u32 s77,s61
s_cselect_b32 s57,0,16777216
s_cselect_b32 s60,0,128
s_add_u32 s60,s60,s59
s_add_u32 s60,s60,128
s_buffer_load_dword s33,s[8:11],s60 glc
s_add_u32 s71,s71,s57
s_add_u32 s71,s71,58720256
s_cmp_eq_u32 s77,s61
s_cselect_b32 s57,50331648,0
s_cselect_b32 s58,1536,0
s_add_u32 s59,s59,s58
s_buffer_load_dword s32,s[8:11],s59 glc
s_add_u32 s70,s70,s57
s_add_u32 s70,s70,150994944
v_mov_b32 v19,s59
v_writelane_b32 v19,s60,1
L_af_96:
v_max3_f32 v238,v128,v129,v130
v_max3_f32 v239,v131,v132,v133
v_max3_f32 v238,v134,v135,v238
v_max3_f32 v239,v138,v139,v239
v_max_f32 v238,v238,v239
v_max_f32 v239,v238,v239
s_nop 1
v_permlane16_swap_b32 v238,v239
v_max_f32 v238,v238,v239
v_max_f32 v239,v238,v239
s_nop 1
v_permlane32_swap_b32 v238,v239
v_max_f32 v238,v238,v239
v_mul_f32 v238,s80,v238
v_fma_f32 v128,v128,s80,-v238
v_fma_f32 v129,v129,s80,-v238
v_exp_f32 v128,v128
v_fma_f32 v130,v130,s80,-v238
v_exp_f32 v129,v129
v_fma_f32 v131,v131,s80,-v238
v_exp_f32 v130,v130
v_fma_f32 v132,v132,s80,-v238
v_exp_f32 v131,v131
v_fma_f32 v133,v133,s80,-v238
v_exp_f32 v132,v132
v_fma_f32 v134,v134,s80,-v238
v_exp_f32 v133,v133
v_fma_f32 v135,v135,s80,-v238
v_exp_f32 v134,v134
v_fma_f32 v138,v138,s80,-v238
v_exp_f32 v135,v135
v_fma_f32 v139,v139,s80,-v238
v_exp_f32 v138,v138
v_exp_f32 v139,v139
v_cvt_pk_bf16_f32 v140,v128,v129
v_cvt_pk_bf16_f32 v141,v130,v131
v_cvt_pk_bf16_f32 v142,v132,v133
v_cvt_pk_bf16_f32 v143,v134,v135
v_cvt_pk_bf16_f32 v144,v138,v139
v_mov_b32 v147,v144
v_mfma_f32_16x16x32_bf16 v[148:151],v[152:155],v[140:143],0
v_mfma_f32_16x16x32_bf16 v[24:27],v[88:91],v[140:143],0
v_mfma_f32_16x16x32_bf16 v[28:31],v[92:95],v[140:143],0
v_mfma_f32_16x16x16_bf16 v[148:151],v[152:153],v[144:145],v[148:151]
v_mfma_f32_16x16x32_bf16 v[32:35],v[96:99],v[140:143],0
v_mfma_f32_16x16x32_bf16 v[36:39],v[100:103],v[140:143],0
v_mfma_f32_16x16x32_bf16 v[40:43],v[104:107],v[140:143],0
v_mfma_f32_16x16x32_bf16 v[44:47],v[108:111],v[140:143],0
v_mfma_f32_16x16x32_bf16 v[48:51],v[112:115],v[140:143],0
v_mfma_f32_16x16x32_bf16 v[52:55],v[116:119],v[140:143],0
v_rcp_f32 v148,v148
v_mfma_f32_16x16x16_bf16 v[24:27],v[120:121],v[144:145],v[24:27]
v_mfma_f32_16x16x16_bf16 v[28:31],v[120:121],v[146:147],v[28:31]
v_mfma_f32_16x16x16_bf16 v[32:35],v[122:123],v[144:145],v[32:35]
v_mfma_f32_16x16x16_bf16 v[36:39],v[122:123],v[146:147],v[36:39]
v_mfma_f32_16x16x16_bf16 v[40:43],v[124:125],v[144:145],v[40:43]
v_pk_mul_f32 v[24:25],v[24:25],v[148:149] op_sel_hi:[1,0]
v_pk_mul_f32 v[26:27],v[26:27],v[148:149] op_sel_hi:[1,0]
v_mfma_f32_16x16x16_bf16 v[44:47],v[124:125],v[146:147],v[44:47]
v_pk_mul_f32 v[28:29],v[28:29],v[148:149] op_sel_hi:[1,0]
v_pk_mul_f32 v[30:31],v[30:31],v[148:149] op_sel_hi:[1,0]
v_mfma_f32_16x16x16_bf16 v[48:51],v[126:127],v[144:145],v[48:51]
v_cvt_pk_bf16_f32 v72,v24,v28
v_cvt_pk_bf16_f32 v73,v25,v29
v_mfma_f32_16x16x16_bf16 v[52:55],v[126:127],v[146:147],v[52:55]
v_cvt_pk_bf16_f32 v74,v26,v30
v_cvt_pk_bf16_f32 v75,v27,v31
ds_write_b128 v3,v[72:75] offset:0
v_pk_mul_f32 v[32:33],v[32:33],v[148:149] op_sel_hi:[1,0]
v_pk_mul_f32 v[34:35],v[34:35],v[148:149] op_sel_hi:[1,0]
v_pk_mul_f32 v[36:37],v[36:37],v[148:149] op_sel_hi:[1,0]
v_pk_mul_f32 v[38:39],v[38:39],v[148:149] op_sel_hi:[1,0]
v_cvt_pk_bf16_f32 v76,v32,v36
v_cvt_pk_bf16_f32 v77,v33,v37
v_cvt_pk_bf16_f32 v78,v34,v38
v_cvt_pk_bf16_f32 v79,v35,v39
ds_write_b128 v3,v[76:79] offset:1024
v_pk_mul_f32 v[40:41],v[40:41],v[148:149] op_sel_hi:[1,0]
v_pk_mul_f32 v[42:43],v[42:43],v[148:149] op_sel_hi:[1,0]
v_pk_mul_f32 v[44:45],v[44:45],v[148:149] op_sel_hi:[1,0]
v_pk_mul_f32 v[46:47],v[46:47],v[148:149] op_sel_hi:[1,0]
v_cvt_pk_bf16_f32 v80,v40,v44
v_cvt_pk_bf16_f32 v81,v41,v45
v_cvt_pk_bf16_f32 v82,v42,v46
v_cvt_pk_bf16_f32 v83,v43,v47
ds_write_b128 v3,v[80:83] offset:2048
v_pk_mul_f32 v[48:49],v[48:49],v[148:149] op_sel_hi:[1,0]
v_pk_mul_f32 v[50:51],v[50:51],v[148:149] op_sel_hi:[1,0]
v_pk_mul_f32 v[52:53],v[52:53],v[148:149] op_sel_hi:[1,0]
v_pk_mul_f32 v[54:55],v[54:55],v[148:149] op_sel_hi:[1,0]
v_cvt_pk_bf16_f32 v84,v48,v52
v_cvt_pk_bf16_f32 v85,v49,v53
v_cvt_pk_bf16_f32 v86,v50,v54
v_cvt_pk_bf16_f32 v87,v51,v55
ds_write_b128 v3,v[84:87] offset:3072
s_waitcnt lgkmcnt(0)
s_barrier
L_ad_92:
s_mov_b32 s51,s53
s_mov_b32 s31,1
s_branch L_aa_59
L_aa_65:
s_waitcnt vmcnt(0)
buffer_store_dword v20,off,s[8:11],s73 sc1
s_mov_b32 s73,0x80000000
L_aa_67:
s_mov_b32 s51,s53
s_mov_b32 s31,0
s_add_u32 s35,s53,4
s_cmp_lt_u32 s53,5
s_cbranch_scc1 L_ab_97
s_cmp_ge_u32 s53,62
s_cbranch_scc1 L_am_99
L_aw_100:
v_min_u32 v239,v242,v243
v_cmp_eq_u32 vcc,0,v239
s_cbranch_vccz L_awd_101
s_sleep 4
buffer_load_dwordx2 v[242:243],v244,s[8:11],0 offen sc1
s_sub_u32 s49,s49,1
s_cbranch_scc1 L_abort
s_waitcnt vmcnt(0)
s_branch L_aw_100
L_awd_101:
v_max_u32 v242,v242,v243
s_nop 1
v_max_u32_dpp v242,v242,v242 row_ror:8 row_mask:0xf bank_mask:0xf
s_nop 1
v_max_u32_dpp v242,v242,v242 row_ror:4 row_mask:0xf bank_mask:0xf
s_nop 1
v_max_u32_dpp v242,v242,v242 row_ror:2 row_mask:0xf bank_mask:0xf
s_nop 1
v_max_u32_dpp v242,v242,v242 row_ror:1 row_mask:0xf bank_mask:0xf
v_mov_b32 v243,v242
s_nop 1
v_permlane16_swap_b32 v242,v243
v_max_u32 v242,v242,v243
v_mov_b32 v243,v242
s_nop 1
v_permlane32_swap_b32 v242,v243
v_max_u32 v242,v242,v243
s_nop 0
v_readfirstlane_b32 s56,v242
s_max_u32 s75,s75,s56
s_cmp_lt_u32 s53,9
s_cbranch_scc1 L_ab_97
s_mov_b32 s77,s36
s_and_b32 s55,s75,0x7ff
s_sub_u32 s55,2047,s55
s_cmp_lt_u32 s53,37
s_cselect_b32 s55,4095,s55
s_lshr_b32 s61,s55,5
s_mov_b32 s30,1
s_lshl_b32 s56,s77,5
s_add_u32 s56,s56,s68
s_mul_i32 s70,s56,24576
s_lshl_b32 s71,s56,12
s_lshl_b32 s59,s77,13
s_lshl2_add_u32 s59,s68,s59
s_add_u32 s59,s59,10486144
s_cmp_lt_u32 s77,s61
s_cselect_b32 s57,0,16777216
s_cselect_b32 s60,0,128
s_add_u32 s60,s60,s59
s_add_u32 s60,s60,128
s_add_u32 s71,s71,s57
s_add_u32 s71,s71,58720256
s_cmp_eq_u32 s77,s61
s_cselect_b32 s57,50331648,0
s_cselect_b32 s58,1536,0
s_add_u32 s59,s59,s58
s_add_u32 s70,s70,s57
s_add_u32 s70,s70,150994944
v_mov_b32 v19,s59
v_writelane_b32 v19,s60,1
s_branch L_aj_98
L_ab_97:
s_mov_b32 s77,s35
s_mov_b32 s30,0
s_lshl_b32 s56,s77,5
s_add_u32 s56,s56,s68
s_mul_i32 s70,s56,24576
s_lshl_b32 s71,s56,12
s_lshl_b32 s59,s77,13
s_lshl2_add_u32 s59,s68,s59
s_add_u32 s59,s59,10485760
s_mov_b32 s33,1
s_add_u32 s70,s70,100663296
s_add_u32 s71,s71,41943040
v_mov_b32 v19,s59
L_aj_98:
buffer_load_dword v18,v19,s[8:11],0 offen sc1
v_mfma_f32_16x16x32_bf16 v[136:139],v[72:75],v[24:27],0
v_max3_u32 v238,v72,v73,v74
v_max3_u32 v238,v74,v75,v238
v_mfma_f32_16x16x32_bf16 v[136:139],v[76:79],v[28:31],v[136:139]
v_max3_u32 v238,v76,v77,v238
v_max3_u32 v238,v78,v79,v238
v_mfma_f32_16x16x32_bf16 v[136:139],v[80:83],v[32:35],v[136:139]
v_max3_u32 v238,v80,v81,v238
v_max3_u32 v238,v82,v83,v238
v_mfma_f32_16x16x32_bf16 v[136:139],v[84:87],v[36:39],v[136:139]
v_max3_u32 v238,v84,v85,v238
v_max3_u32 v238,v86,v87,v238
v_max3_u32 v238,v120,v121,v238
v_max3_u32 v238,v122,v123,v238
v_max3_u32 v238,v124,v125,v238
v_max3_u32 v238,v126,v127,v238
v_cmp_eq_u32 vcc,-1,v238
s_cbranch_vccz L_aa_70
L_aa_69:
buffer_load_dwordx4 v[72:75],v0,s[8:11],s76 offen offset:0 sc1
buffer_load_dwordx4 v[76:79],v0,s[8:11],s76 offen offset:1024 sc1
buffer_load_dwordx4 v[80:83],v0,s[8:11],s76 offen offset:2048 sc1
buffer_load_dwordx4 v[84:87],v0,s[8:11],s76 offen offset:3072 sc1
buffer_load_dwordx2 v[120:121],v253,s[8:11],s76 offen offset:0 sc1
buffer_load_dwordx2 v[122:123],v253,s[8:11],s76 offen offset:1024 sc1
buffer_load_dwordx2 v[124:125],v253,s[8:11],s76 offen offset:2048 sc1
buffer_load_dwordx2 v[126:127],v253,s[8:11],s76 offen offset:3072 sc1
buffer_load_dword v18,v19,s[8:11],0 offen sc1
s_sub_u32 s49,s49,1
s_cbranch_scc1 L_abort
s_waitcnt vmcnt(8)
v_mfma_f32_16x16x32_bf16 v[136:139],v[72:75],v[24:27],0
v_max3_u32 v238,v72,v73,v74
v_max3_u32 v238,v74,v75,v238
s_waitcnt vmcnt(7)
v_mfma_f32_16x16x32_bf16 v[136:139],v[76:79],v[28:31],v[136:139]
v_max3_u32 v238,v76,v77,v238
v_max3_u32 v238,v78,v79,v238
s_waitcnt vmcnt(6)
v_mfma_f32_16x16x32_bf16 v[136:139],v[80:83],v[32:35],v[136:139]
v_max3_u32 v238,v80,v81,v238
v_max3_u32 v238,v82,v83,v238
s_waitcnt vmcnt(5)
v_mfma_f32_16x16x32_bf16 v[136:139],v[84:87],v[36:39],v[136:139]
v_max3_u32 v238,v84,v85,v238
v_max3_u32 v238,v86,v87,v238
s_waitcnt vmcnt(1)
v_max3_u32 v238,v120,v121,v238
v_max3_u32 v238,v122,v123,v238
v_max3_u32 v238,v124,v125,v238
v_max3_u32 v238,v126,v127,v238
v_cmp_eq_u32 vcc,-1,v238
s_cbranch_vccnz L_aa_69
L_aa_70:
s_cmp_lg_u32 s27,3
s_cbranch_scc1 L_ai_102
v_max3_f32 v238,v128,v129,v130
v_max3_f32 v239,v131,v132,v133
v_max3_f32 v238,v134,v135,v238
v_max3_f32 v239,v138,v139,v239
v_max_f32 v238,v238,v239
v_max_f32 v239,v238,v239
s_nop 1
v_permlane16_swap_b32 v238,v239
v_max_f32 v238,v238,v239
v_max_f32 v239,v238,v239
s_nop 1
v_permlane32_swap_b32 v238,v239
v_max_f32 v238,v238,v239
v_mul_f32 v238,s80,v238
v_fma_f32 v128,v128,s80,-v238
v_fma_f32 v129,v129,s80,-v238
v_exp_f32 v128,v128
v_fma_f32 v130,v130,s80,-v238
v_exp_f32 v129,v129
v_fma_f32 v131,v131,s80,-v238
v_exp_f32 v130,v130
v_fma_f32 v132,v132,s80,-v238
v_exp_f32 v131,v131
v_fma_f32 v133,v133,s80,-v238
v_exp_f32 v132,v132
v_fma_f32 v134,v134,s80,-v238
v_exp_f32 v133,v133
v_fma_f32 v135,v135,s80,-v238
v_exp_f32 v134,v134
v_fma_f32 v138,v138,s80,-v238
v_exp_f32 v135,v135
v_fma_f32 v139,v139,s80,-v238
v_exp_f32 v138,v138
v_exp_f32 v139,v139
v_cvt_pk_bf16_f32 v140,v128,v129
v_cvt_pk_bf16_f32 v141,v130,v131
v_cvt_pk_bf16_f32 v142,v132,v133
v_cvt_pk_bf16_f32 v143,v134,v135
v_cvt_pk_bf16_f32 v144,v138,v139
v_mov_b32 v147,v144
buffer_load_dword v17,v16,s[8:11],s87 offen sc1
v_mfma_f32_16x16x32_bf16 v[148:151],v[152:155],v[140:143],0
v_mfma_f32_16x16x32_bf16 v[24:27],v[88:91],v[140:143],0
v_mfma_f32_16x16x32_bf16 v[28:31],v[92:95],v[140:143],0
v_mfma_f32_16x16x16_bf16 v[148:151],v[152:153],v[144:145],v[148:151]
v_mfma_f32_16x16x32_bf16 v[32:35],v[96:99],v[140:143],0
v_mfma_f32_16x16x32_bf16 v[36:39],v[100:103],v[140:143],0
v_mfma_f32_16x16x32_bf16 v[40:43],v[104:107],v[140:143],0
v_mfma_f32_16x16x32_bf16 v[44:47],v[108:111],v[140:143],0
v_mfma_f32_16x16x32_bf16 v[48:51],v[112:115],v[140:143],0
v_mfma_f32_16x16x32_bf16 v[52:55],v[116:119],v[140:143],0
v_rcp_f32 v148,v148
v_mfma_f32_16x16x16_bf16 v[24:27],v[120:121],v[144:145],v[24:27]
v_mfma_f32_16x16x16_bf16 v[28:31],v[120:121],v[146:147],v[28:31]
v_mfma_f32_16x16x16_bf16 v[32:35],v[122:123],v[144:145],v[32:35]
v_mfma_f32_16x16x16_bf16 v[36:39],v[122:123],v[146:147],v[36:39]
v_mfma_f32_16x16x16_bf16 v[40:43],v[124:125],v[144:145],v[40:43]
v_pk_mul_f32 v[24:25],v[24:25],v[148:149] op_sel_hi:[1,0]
v_pk_mul_f32 v[26:27],v[26:27],v[148:149] op_sel_hi:[1,0]
v_mfma_f32_16x16x16_bf16 v[44:47],v[124:125],v[146:147],v[44:47]
v_pk_mul_f32 v[28:29],v[28:29],v[148:149] op_sel_hi:[1,0]
v_pk_mul_f32 v[30:31],v[30:31],v[148:149] op_sel_hi:[1,0]
v_mfma_f32_16x16x16_bf16 v[48:51],v[126:127],v[144:145],v[48:51]
v_cvt_pk_bf16_f32 v72,v24,v28
v_cvt_pk_bf16_f32 v73,v25,v29
v_mfma_f32_16x16x16_bf16 v[52:55],v[126:127],v[146:147],v[52:55]
v_cvt_pk_bf16_f32 v74,v26,v30
v_cvt_pk_bf16_f32 v75,v27,v31
ds_write_b128 v3,v[72:75] offset:0
v_pk_mul_f32 v[32:33],v[32:33],v[148:149] op_sel_hi:[1,0]
v_pk_mul_f32 v[34:35],v[34:35],v[148:149] op_sel_hi:[1,0]
v_pk_mul_f32 v[36:37],v[36:37],v[148:149] op_sel_hi:[1,0]
v_pk_mul_f32 v[38:39],v[38:39],v[148:149] op_sel_hi:[1,0]
v_cvt_pk_bf16_f32 v76,v32,v36
v_cvt_pk_bf16_f32 v77,v33,v37
v_cvt_pk_bf16_f32 v78,v34,v38
v_cvt_pk_bf16_f32 v79,v35,v39
ds_write_b128 v3,v[76:79] offset:1024
s_waitcnt vmcnt(0)
v_cmp_gt_u32 vcc,s66,v17
v_pk_mul_f32 v[40:41],v[40:41],v[148:149] op_sel_hi:[1,0]
v_pk_mul_f32 v[42:43],v[42:43],v[148:149] op_sel_hi:[1,0]
v_pk_mul_f32 v[44:45],v[44:45],v[148:149] op_sel_hi:[1,0]
v_pk_mul_f32 v[46:47],v[46:47],v[148:149] op_sel_hi:[1,0]
s_cbranch_vccnz L_ap_103
L_apb_104:
s_xor_b32 s34,s69,524288
buffer_load_dwordx4 v[192:195],v7,s[8:11],s34 offen sc1
v_cvt_pk_bf16_f32 v80,v40,v44
v_cvt_pk_bf16_f32 v81,v41,v45
s_add_u32 s34,s34,4096
buffer_load_dwordx4 v[196:199],v7,s[8:11],s34 offen sc1
v_cvt_pk_bf16_f32 v82,v42,v46
v_cvt_pk_bf16_f32 v83,v43,v47
s_add_u32 s34,s34,4096
buffer_load_dwordx4 v[200:203],v7,s[8:11],s34 offen sc1
ds_write_b128 v3,v[80:83] offset:2048
v_pk_mul_f32 v[48:49],v[48:49],v[148:149] op_sel_hi:[1,0]
s_add_u32 s34,s34,4096
buffer_load_dwordx4 v[204:207],v7,s[8:11],s34 offen sc1
v_pk_mul_f32 v[50:51],v[50:51],v[148:149] op_sel_hi:[1,0]
v_pk_mul_f32 v[52:53],v[52:53],v[148:149] op_sel_hi:[1,0]
s_add_u32 s34,s34,4096
buffer_load_dwordx4 v[208:211],v7,s[8:11],s34 offen sc1
v_pk_mul_f32 v[54:55],v[54:55],v[148:149] op_sel_hi:[1,0]
v_cvt_pk_bf16_f32 v84,v48,v52
s_add_u32 s34,s34,4096
buffer_load_dwordx4 v[212:215],v7,s[8:11],s34 offen sc1
v_cvt_pk_bf16_f32 v85,v49,v53
v_cvt_pk_bf16_f32 v86,v50,v54
s_add_u32 s34,s34,4096
buffer_load_dwordx4 v[216:219],v7,s[8:11],s34 offen sc1
v_cvt_pk_bf16_f32 v87,v51,v55
ds_write_b128 v3,v[84:87] offset:3072
s_add_u32 s34,s34,4096
buffer_load_dwordx4 v[220:223],v7,s[8:11],s34 offen sc1
v_readlane_b32 s32,v18,0
v_readlane_b32 s33,v18,1
s_waitcnt lgkmcnt(0)
s_barrier
s_branch L_aa_72
L_ai_102:
v_max3_f32 v238,v128,v129,v130
v_max3_f32 v239,v131,v132,v133
v_max3_f32 v238,v134,v135,v238
v_max3_f32 v239,v138,v139,v239
v_max_f32 v238,v238,v239
v_max_f32 v239,v238,v239
s_nop 1
v_permlane16_swap_b32 v238,v239
v_max_f32 v238,v238,v239
v_max_f32 v239,v238,v239
s_nop 1
v_permlane32_swap_b32 v238,v239
v_max_f32 v238,v238,v239
v_mul_f32 v238,s80,v238
v_fma_f32 v128,v128,s80,-v238
v_fma_f32 v129,v129,s80,-v238
v_exp_f32 v128,v128
v_fma_f32 v130,v130,s80,-v238
v_exp_f32 v129,v129
v_fma_f32 v131,v131,s80,-v238
v_exp_f32 v130,v130
v_fma_f32 v132,v132,s80,-v238
v_exp_f32 v131,v131
v_fma_f32 v133,v133,s80,-v238
v_exp_f32 v132,v132
v_fma_f32 v134,v134,s80,-v238
v_exp_f32 v133,v133
v_fma_f32 v135,v135,s80,-v238
v_exp_f32 v134,v134
v_fma_f32 v138,v138,s80,-v238
v_exp_f32 v135,v135
v_fma_f32 v139,v139,s80,-v238
v_exp_f32 v138,v138
v_exp_f32 v139,v139
v_cvt_pk_bf16_f32 v140,v128,v129
v_cvt_pk_bf16_f32 v141,v130,v131
v_cvt_pk_bf16_f32 v142,v132,v133
v_cvt_pk_bf16_f32 v143,v134,v135
v_cvt_pk_bf16_f32 v144,v138,v139
v_mov_b32 v147,v144
v_mfma_f32_16x16x32_bf16 v[148:151],v[152:155],v[140:143],0
v_mfma_f32_16x16x32_bf16 v[24:27],v[88:91],v[140:143],0
v_mfma_f32_16x16x32_bf16 v[28:31],v[92:95],v[140:143],0
v_mfma_f32_16x16x16_bf16 v[148:151],v[152:153],v[144:145],v[148:151]
v_mfma_f32_16x16x32_bf16 v[32:35],v[96:99],v[140:143],0
v_mfma_f32_16x16x32_bf16 v[36:39],v[100:103],v[140:143],0
v_mfma_f32_16x16x32_bf16 v[40:43],v[104:107],v[140:143],0
v_mfma_f32_16x16x32_bf16 v[44:47],v[108:111],v[140:143],0
v_mfma_f32_16x16x32_bf16 v[48:51],v[112:115],v[140:143],0
v_mfma_f32_16x16x32_bf16 v[52:55],v[116:119],v[140:143],0
v_rcp_f32 v148,v148
v_mfma_f32_16x16x16_bf16 v[24:27],v[120:121],v[144:145],v[24:27]
v_mfma_f32_16x16x16_bf16 v[28:31],v[120:121],v[146:147],v[28:31]
v_mfma_f32_16x16x16_bf16 v[32:35],v[122:123],v[144:145],v[32:35]
v_mfma_f32_16x16x16_bf16 v[36:39],v[122:123],v[146:147],v[36:39]
v_mfma_f32_16x16x16_bf16 v[40:43],v[124:125],v[144:145],v[40:43]
v_pk_mul_f32 v[24:25],v[24:25],v[148:149] op_sel_hi:[1,0]
v_pk_mul_f32 v[26:27],v[26:27],v[148:149] op_sel_hi:[1,0]
v_mfma_f32_16x16x16_bf16 v[44:47],v[124:125],v[146:147],v[44:47]
v_pk_mul_f32 v[28:29],v[28:29],v[148:149] op_sel_hi:[1,0]
v_pk_mul_f32 v[30:31],v[30:31],v[148:149] op_sel_hi:[1,0]
v_mfma_f32_16x16x16_bf16 v[48:51],v[126:127],v[144:145],v[48:51]
v_cvt_pk_bf16_f32 v72,v24,v28
v_cvt_pk_bf16_f32 v73,v25,v29
v_mfma_f32_16x16x16_bf16 v[52:55],v[126:127],v[146:147],v[52:55]
v_cvt_pk_bf16_f32 v74,v26,v30
v_cvt_pk_bf16_f32 v75,v27,v31
ds_write_b128 v3,v[72:75] offset:0
v_pk_mul_f32 v[32:33],v[32:33],v[148:149] op_sel_hi:[1,0]
v_pk_mul_f32 v[34:35],v[34:35],v[148:149] op_sel_hi:[1,0]
v_pk_mul_f32 v[36:37],v[36:37],v[148:149] op_sel_hi:[1,0]
v_pk_mul_f32 v[38:39],v[38:39],v[148:149] op_sel_hi:[1,0]
v_cvt_pk_bf16_f32 v76,v32,v36
v_cvt_pk_bf16_f32 v77,v33,v37
v_cvt_pk_bf16_f32 v78,v34,v38
v_cvt_pk_bf16_f32 v79,v35,v39
ds_write_b128 v3,v[76:79] offset:1024
v_pk_mul_f32 v[40:41],v[40:41],v[148:149] op_sel_hi:[1,0]
v_pk_mul_f32 v[42:43],v[42:43],v[148:149] op_sel_hi:[1,0]
v_pk_mul_f32 v[44:45],v[44:45],v[148:149] op_sel_hi:[1,0]
v_pk_mul_f32 v[46:47],v[46:47],v[148:149] op_sel_hi:[1,0]
v_cvt_pk_bf16_f32 v80,v40,v44
v_cvt_pk_bf16_f32 v81,v41,v45
v_cvt_pk_bf16_f32 v82,v42,v46
v_cvt_pk_bf16_f32 v83,v43,v47
ds_write_b128 v3,v[80:83] offset:2048
v_pk_mul_f32 v[48:49],v[48:49],v[148:149] op_sel_hi:[1,0]
v_pk_mul_f32 v[50:51],v[50:51],v[148:149] op_sel_hi:[1,0]
v_pk_mul_f32 v[52:53],v[52:53],v[148:149] op_sel_hi:[1,0]
v_pk_mul_f32 v[54:55],v[54:55],v[148:149] op_sel_hi:[1,0]
v_cvt_pk_bf16_f32 v84,v48,v52
v_cvt_pk_bf16_f32 v85,v49,v53
v_cvt_pk_bf16_f32 v86,v50,v54
v_cvt_pk_bf16_f32 v87,v51,v55
ds_write_b128 v3,v[84:87] offset:3072
s_waitcnt vmcnt(0)
v_readlane_b32 s32,v18,0
v_readlane_b32 s33,v18,1
s_waitcnt lgkmcnt(0)
s_barrier
s_branch L_aa_59
L_aa_68:
s_cmp_lg_u32 s86,1536
s_cbranch_scc1 L_az_105
s_cmp_ge_u32 s35,66
s_cbranch_scc1 L_aa_58
v_subrev_u32 v248,s36,v1
v_and_b32 v248,0x80000003,v248
v_cmp_eq_u32 vcc,0,v248
v_lshlrev_b32 v248,2,v1
v_mov_b32 v249,0x40000000
v_cndmask_b32 v248,v249,v248,vcc
v_mov_b32 v249,3
s_or_b32 s59,s68,s46
s_mov_b32 s59,11018240
s_cmov_b32 s59,0x80000000
buffer_store_dword v249,v248,s[8:11],s59 offen sc1
L_aa_58:
s_waitcnt vmcnt(0)
buffer_store_dword v20,off,s[8:11],s73 sc1
s_mov_b32 s73,0x80000000
v_lshlrev_b32 v238,2,v1
v_add_u32 v248,155712,v238
s_cmp_lg_u32 s46,0
s_cbranch_scc1 L_an_106
s_lshl_b32 s59,s54,13
s_add_u32 s59,s59,11026432
L_fp_107:
s_sleep 1
buffer_load_dword v239,v238,s[8:11],s59 offen sc1
s_sub_u32 s49,s49,1
s_cbranch_scc1 L_abort
s_waitcnt vmcnt(0)
v_cmp_eq_u32 vcc,0,v239
s_cbranch_vccnz L_fp_107
ds_write_b32 v248,v239
s_waitcnt lgkmcnt(0)
L_an_106:
s_barrier
ds_read_b32 v239,v248
s_mov_b32 s86,768
s_mov_b32 s30,1
s_waitcnt lgkmcnt(0)
v_readfirstlane_b32 s55,v239
v_and_b32 v239,255,v239
s_lshr_b32 s55,s55,8
s_lshr_b32 s61,s55,5
v_cmp_ne_u32 s[38:39],3,v239
v_cmp_le_u32 vcc,s61,v1
s_nop 1
v_cndmask_b32 v238,1,2,vcc
v_cmp_ne_u32 s[84:85],v238,v239
s_bcnt1_i32_b64 s56,s[84:85]
s_nop 0
v_mbcnt_lo_u32_b32 v238,s84,0
v_mbcnt_hi_u32_b32 v238,s85,v238
s_mul_i32 s56,s56,17
s_add_u32 s56,s56,48
s_lshr_b32 s56,s56,7
s_lshl_b32 s56,s56,1
v_cmp_gt_u32 vcc,s56,v238
v_and_b32 v239,1,v238
v_and_b32 v238,3,v238
v_add_u32 v238,2,v238
v_cndmask_b32 v238,v238,v239,vcc
v_cmp_eq_u32 vcc,s54,v238
s_and_b64 s[84:85],s[84:85],vcc
s_ff1_i32_b64 s77,s[84:85]
s_bitset0_b64 s[84:85],s77
s_min_u32 s77,s77,64
s_lshl_b32 s56,s77,5
s_add_u32 s56,s56,s68
s_mul_i32 s70,s56,24576
s_lshl_b32 s71,s56,12
s_lshl_b32 s59,s77,13
s_lshl2_add_u32 s59,s68,s59
s_add_u32 s59,s59,10486144
s_cmp_lt_u32 s77,s61
s_cselect_b32 s57,0,16777216
s_cselect_b32 s60,0,128
s_add_u32 s60,s60,s59
s_add_u32 s60,s60,128
s_buffer_load_dword s33,s[8:11],s60 glc
s_add_u32 s71,s71,s57
s_add_u32 s71,s71,58720256
s_cmp_eq_u32 s77,s61
s_cselect_b32 s57,50331648,0
s_cselect_b32 s58,1536,0
s_add_u32 s59,s59,s58
s_buffer_load_dword s32,s[8:11],s59 glc
s_add_u32 s70,s70,s57
s_add_u32 s70,s70,150994944
v_mov_b32 v19,s59
v_writelane_b32 v19,s60,1
s_cmp_lt_u32 s77,64
s_cbranch_scc1 L_aa_66
L_az_105:
s_waitcnt vmcnt(0)
buffer_store_dword v20,off,s[8:11],s73 sc1
s_mov_b32 s73,0x80000000
s_endpgm
L_ag_74:
s_lshl_b32 s21,s26,13
s_lshl2_add_u32 s21,s68,s21
s_add_u32 s21,s21,10487296
L_ww_108:
buffer_load_dword v246,off,s[8:11],s21 sc1
s_sub_u32 s49,s49,1
s_cbranch_scc1 L_abort
s_waitcnt vmcnt(0)
v_readfirstlane_b32 s22,v246
s_cmp_eq_u32 s22,0
s_cbranch_scc1 L_ww_108
L_wwd_109:
s_branch L_agb_75
L_ap_81:
L_aw_110:
v_cmp_gt_u32 vcc,s66,v17
s_cbranch_vccz L_awd_111
buffer_load_dword v17,v16,s[8:11],s87 offen sc1
s_sub_u32 s49,s49,1
s_cbranch_scc1 L_abort
s_waitcnt vmcnt(0)
s_branch L_aw_110
L_awd_111:
s_branch L_apb_82
L_ag_90:
s_lshl_b32 s21,s51,13
s_lshl2_add_u32 s21,s68,s21
s_add_u32 s21,s21,10487296
L_ww_112:
buffer_load_dword v246,off,s[8:11],s21 sc1
s_sub_u32 s49,s49,1
s_cbranch_scc1 L_abort
s_waitcnt vmcnt(0)
v_readfirstlane_b32 s22,v246
s_cmp_eq_u32 s22,0
s_cbranch_scc1 L_ww_112
L_wwd_113:
s_branch L_agb_91
L_am_99:
v_subrev_u32 v248,s36,v1
v_and_b32 v248,0x80000003,v248
v_cmp_eq_u32 vcc,0,v248
v_lshlrev_b32 v248,2,v1
v_mov_b32 v249,0x40000000
v_cndmask_b32 v248,v249,v248,vcc
v_mov_b32 v249,3
s_or_b32 s59,s68,s46
s_mov_b32 s59,11018240
s_cmov_b32 s59,0x80000000
buffer_store_dword v249,v248,s[8:11],s59 offen sc1
s_branch L_ab_97
L_ap_103:
L_aw_114:
v_cmp_gt_u32 vcc,s66,v17
s_cbranch_vccz L_awd_115
buffer_load_dword v17,v16,s[8:11],s87 offen sc1
s_sub_u32 s49,s49,1
s_cbranch_scc1 L_abort
s_waitcnt vmcnt(0)
s_branch L_aw_114
L_awd_115:
s_branch L_apb_104
s_endpgm
L_rch_4:
v_and_b32 v2,15,v1
v_lshlrev_b32 v2,2,v2
v_lshrrev_b32 v3,4,v1
v_lshl_add_u32 v4,v3,16,v2
v_lshl_add_u32 v5,v3,12,v2
s_lshl_b32 s58,s47,8
s_lshl_b32 s57,s46,6
s_add_u32 s58,s58,s57
s_lshl_b32 s59,s47,17
s_add_u32 s59,s59,s57
s_lshl_b32 s60,s46,15
v_add_u32 v6,s60,v0
s_mov_b32 s61,0x05040100
s_mov_b32 s62,0x07060302
s_lshl_b32 s63,s46,19
s_cmp_lt_u32 s48,3
s_cselect_b32 s63,s63,0
s_mov_b32 s4,s26
s_mov_b32 s5,s27
s_mov_b32 s6,4194304
s_mov_b32 s7,0x20000
s_add_u32 s56,s59,0
buffer_load_dword v24,v5,s[4:7],s56 offen offset:0
buffer_load_dword v25,v5,s[4:7],s56 offen offset:1024
buffer_load_dword v26,v5,s[4:7],s56 offen offset:2048
buffer_load_dword v27,v5,s[4:7],s56 offen offset:3072
s_add_u32 s56,s59,16384
buffer_load_dword v28,v5,s[4:7],s56 offen offset:0
buffer_load_dword v29,v5,s[4:7],s56 offen offset:1024
buffer_load_dword v30,v5,s[4:7],s56 offen offset:2048
buffer_load_dword v31,v5,s[4:7],s56 offen offset:3072
s_add_u32 s56,s59,32768
buffer_load_dword v32,v5,s[4:7],s56 offen offset:0
buffer_load_dword v33,v5,s[4:7],s56 offen offset:1024
buffer_load_dword v34,v5,s[4:7],s56 offen offset:2048
buffer_load_dword v35,v5,s[4:7],s56 offen offset:3072
s_add_u32 s56,s59,49152
buffer_load_dword v36,v5,s[4:7],s56 offen offset:0
buffer_load_dword v37,v5,s[4:7],s56 offen offset:1024
buffer_load_dword v38,v5,s[4:7],s56 offen offset:2048
buffer_load_dword v39,v5,s[4:7],s56 offen offset:3072
s_add_u32 s56,s59,65536
buffer_load_dword v40,v5,s[4:7],s56 offen offset:0
buffer_load_dword v41,v5,s[4:7],s56 offen offset:1024
buffer_load_dword v42,v5,s[4:7],s56 offen offset:2048
buffer_load_dword v43,v5,s[4:7],s56 offen offset:3072
s_add_u32 s56,s59,81920
buffer_load_dword v44,v5,s[4:7],s56 offen offset:0
buffer_load_dword v45,v5,s[4:7],s56 offen offset:1024
buffer_load_dword v46,v5,s[4:7],s56 offen offset:2048
buffer_load_dword v47,v5,s[4:7],s56 offen offset:3072
s_add_u32 s56,s59,98304
buffer_load_dword v48,v5,s[4:7],s56 offen offset:0
buffer_load_dword v49,v5,s[4:7],s56 offen offset:1024
buffer_load_dword v50,v5,s[4:7],s56 offen offset:2048
buffer_load_dword v51,v5,s[4:7],s56 offen offset:3072
s_add_u32 s56,s59,114688
buffer_load_dword v52,v5,s[4:7],s56 offen offset:0
buffer_load_dword v53,v5,s[4:7],s56 offen offset:1024
buffer_load_dword v54,v5,s[4:7],s56 offen offset:2048
buffer_load_dword v55,v5,s[4:7],s56 offen offset:3072
s_add_u32 s56,s59,256
buffer_load_dword v56,v5,s[4:7],s56 offen offset:0
buffer_load_dword v57,v5,s[4:7],s56 offen offset:1024
buffer_load_dword v58,v5,s[4:7],s56 offen offset:2048
buffer_load_dword v59,v5,s[4:7],s56 offen offset:3072
s_add_u32 s56,s59,16640
buffer_load_dword v60,v5,s[4:7],s56 offen offset:0
buffer_load_dword v61,v5,s[4:7],s56 offen offset:1024
buffer_load_dword v62,v5,s[4:7],s56 offen offset:2048
buffer_load_dword v63,v5,s[4:7],s56 offen offset:3072
s_add_u32 s56,s59,33024
buffer_load_dword v64,v5,s[4:7],s56 offen offset:0
buffer_load_dword v65,v5,s[4:7],s56 offen offset:1024
buffer_load_dword v66,v5,s[4:7],s56 offen offset:2048
buffer_load_dword v67,v5,s[4:7],s56 offen offset:3072
s_add_u32 s56,s59,49408
buffer_load_dword v68,v5,s[4:7],s56 offen offset:0
buffer_load_dword v69,v5,s[4:7],s56 offen offset:1024
buffer_load_dword v70,v5,s[4:7],s56 offen offset:2048
buffer_load_dword v71,v5,s[4:7],s56 offen offset:3072
s_add_u32 s56,s59,65792
buffer_load_dword v72,v5,s[4:7],s56 offen offset:0
buffer_load_dword v73,v5,s[4:7],s56 offen offset:1024
buffer_load_dword v74,v5,s[4:7],s56 offen offset:2048
buffer_load_dword v75,v5,s[4:7],s56 offen offset:3072
s_add_u32 s56,s59,82176
buffer_load_dword v76,v5,s[4:7],s56 offen offset:0
buffer_load_dword v77,v5,s[4:7],s56 offen offset:1024
buffer_load_dword v78,v5,s[4:7],s56 offen offset:2048
buffer_load_dword v79,v5,s[4:7],s56 offen offset:3072
s_waitcnt vmcnt(48)
ds_write_b128 v6,v[24:27] offset:0
ds_write_b128 v6,v[28:31] offset:1024
s_waitcnt lgkmcnt(0)
s_add_u32 s56,s59,98560
buffer_load_dword v24,v5,s[4:7],s56 offen offset:0
buffer_load_dword v25,v5,s[4:7],s56 offen offset:1024
buffer_load_dword v26,v5,s[4:7],s56 offen offset:2048
buffer_load_dword v27,v5,s[4:7],s56 offen offset:3072
s_add_u32 s56,s59,114944
buffer_load_dword v28,v5,s[4:7],s56 offen offset:0
buffer_load_dword v29,v5,s[4:7],s56 offen offset:1024
buffer_load_dword v30,v5,s[4:7],s56 offen offset:2048
buffer_load_dword v31,v5,s[4:7],s56 offen offset:3072
s_waitcnt vmcnt(48)
ds_write_b128 v6,v[32:35] offset:2048
ds_write_b128 v6,v[36:39] offset:3072
s_waitcnt lgkmcnt(0)
s_add_u32 s56,s59,512
buffer_load_dword v32,v5,s[4:7],s56 offen offset:0
buffer_load_dword v33,v5,s[4:7],s56 offen offset:1024
buffer_load_dword v34,v5,s[4:7],s56 offen offset:2048
buffer_load_dword v35,v5,s[4:7],s56 offen offset:3072
s_add_u32 s56,s59,16896
buffer_load_dword v36,v5,s[4:7],s56 offen offset:0
buffer_load_dword v37,v5,s[4:7],s56 offen offset:1024
buffer_load_dword v38,v5,s[4:7],s56 offen offset:2048
buffer_load_dword v39,v5,s[4:7],s56 offen offset:3072
s_waitcnt vmcnt(48)
ds_write_b128 v6,v[40:43] offset:4096
ds_write_b128 v6,v[44:47] offset:5120
s_waitcnt lgkmcnt(0)
s_add_u32 s56,s59,33280
buffer_load_dword v40,v5,s[4:7],s56 offen offset:0
buffer_load_dword v41,v5,s[4:7],s56 offen offset:1024
buffer_load_dword v42,v5,s[4:7],s56 offen offset:2048
buffer_load_dword v43,v5,s[4:7],s56 offen offset:3072
s_add_u32 s56,s59,49664
buffer_load_dword v44,v5,s[4:7],s56 offen offset:0
buffer_load_dword v45,v5,s[4:7],s56 offen offset:1024
buffer_load_dword v46,v5,s[4:7],s56 offen offset:2048
buffer_load_dword v47,v5,s[4:7],s56 offen offset:3072
s_waitcnt vmcnt(48)
ds_write_b128 v6,v[48:51] offset:6144
ds_write_b128 v6,v[52:55] offset:7168
s_waitcnt lgkmcnt(0)
s_add_u32 s56,s59,66048
buffer_load_dword v48,v5,s[4:7],s56 offen offset:0
buffer_load_dword v49,v5,s[4:7],s56 offen offset:1024
buffer_load_dword v50,v5,s[4:7],s56 offen offset:2048
buffer_load_dword v51,v5,s[4:7],s56 offen offset:3072
s_add_u32 s56,s59,82432
buffer_load_dword v52,v5,s[4:7],s56 offen offset:0
buffer_load_dword v53,v5,s[4:7],s56 offen offset:1024
buffer_load_dword v54,v5,s[4:7],s56 offen offset:2048
buffer_load_dword v55,v5,s[4:7],s56 offen offset:3072
s_waitcnt vmcnt(48)
ds_write_b128 v6,v[56:59] offset:8192
ds_write_b128 v6,v[60:63] offset:9216
s_waitcnt lgkmcnt(0)
s_add_u32 s56,s59,98816
buffer_load_dword v56,v5,s[4:7],s56 offen offset:0
buffer_load_dword v57,v5,s[4:7],s56 offen offset:1024
buffer_load_dword v58,v5,s[4:7],s56 offen offset:2048
buffer_load_dword v59,v5,s[4:7],s56 offen offset:3072
s_add_u32 s56,s59,115200
buffer_load_dword v60,v5,s[4:7],s56 offen offset:0
buffer_load_dword v61,v5,s[4:7],s56 offen offset:1024
buffer_load_dword v62,v5,s[4:7],s56 offen offset:2048
buffer_load_dword v63,v5,s[4:7],s56 offen offset:3072
s_waitcnt vmcnt(48)
ds_write_b128 v6,v[64:67] offset:10240
ds_write_b128 v6,v[68:71] offset:11264
s_waitcnt lgkmcnt(0)
s_add_u32 s56,s59,768
buffer_load_dword v64,v5,s[4:7],s56 offen offset:0
buffer_load_dword v65,v5,s[4:7],s56 offen offset:1024
buffer_load_dword v66,v5,s[4:7],s56 offen offset:2048
buffer_load_dword v67,v5,s[4:7],s56 offen offset:3072
s_add_u32 s56,s59,17152
buffer_load_dword v68,v5,s[4:7],s56 offen offset:0
buffer_load_dword v69,v5,s[4:7],s56 offen offset:1024
buffer_load_dword v70,v5,s[4:7],s56 offen offset:2048
buffer_load_dword v71,v5,s[4:7],s56 offen offset:3072
s_waitcnt vmcnt(48)
ds_write_b128 v6,v[72:75] offset:12288
ds_write_b128 v6,v[76:79] offset:13312
s_waitcnt lgkmcnt(0)
s_add_u32 s56,s59,33536
buffer_load_dword v72,v5,s[4:7],s56 offen offset:0
buffer_load_dword v73,v5,s[4:7],s56 offen offset:1024
buffer_load_dword v74,v5,s[4:7],s56 offen offset:2048
buffer_load_dword v75,v5,s[4:7],s56 offen offset:3072
s_add_u32 s56,s59,49920
buffer_load_dword v76,v5,s[4:7],s56 offen offset:0
buffer_load_dword v77,v5,s[4:7],s56 offen offset:1024
buffer_load_dword v78,v5,s[4:7],s56 offen offset:2048
buffer_load_dword v79,v5,s[4:7],s56 offen offset:3072
s_waitcnt vmcnt(48)
ds_write_b128 v6,v[24:27] offset:14336
ds_write_b128 v6,v[28:31] offset:15360
s_waitcnt lgkmcnt(0)
s_add_u32 s56,s59,66304
buffer_load_dword v24,v5,s[4:7],s56 offen offset:0
buffer_load_dword v25,v5,s[4:7],s56 offen offset:1024
buffer_load_dword v26,v5,s[4:7],s56 offen offset:2048
buffer_load_dword v27,v5,s[4:7],s56 offen offset:3072
s_add_u32 s56,s59,82688
buffer_load_dword v28,v5,s[4:7],s56 offen offset:0
buffer_load_dword v29,v5,s[4:7],s56 offen offset:1024
buffer_load_dword v30,v5,s[4:7],s56 offen offset:2048
buffer_load_dword v31,v5,s[4:7],s56 offen offset:3072
s_waitcnt vmcnt(48)
ds_write_b128 v6,v[32:35] offset:16384
ds_write_b128 v6,v[36:39] offset:17408
s_waitcnt lgkmcnt(0)
s_add_u32 s56,s59,99072
buffer_load_dword v32,v5,s[4:7],s56 offen offset:0
buffer_load_dword v33,v5,s[4:7],s56 offen offset:1024
buffer_load_dword v34,v5,s[4:7],s56 offen offset:2048
buffer_load_dword v35,v5,s[4:7],s56 offen offset:3072
s_add_u32 s56,s59,115456
buffer_load_dword v36,v5,s[4:7],s56 offen offset:0
buffer_load_dword v37,v5,s[4:7],s56 offen offset:1024
buffer_load_dword v38,v5,s[4:7],s56 offen offset:2048
buffer_load_dword v39,v5,s[4:7],s56 offen offset:3072
s_waitcnt vmcnt(48)
ds_write_b128 v6,v[40:43] offset:18432
ds_write_b128 v6,v[44:47] offset:19456
s_waitcnt lgkmcnt(0)
s_waitcnt vmcnt(40)
ds_write_b128 v6,v[48:51] offset:20480
ds_write_b128 v6,v[52:55] offset:21504
s_waitcnt lgkmcnt(0)
s_waitcnt vmcnt(32)
ds_write_b128 v6,v[56:59] offset:22528
ds_write_b128 v6,v[60:63] offset:23552
s_waitcnt lgkmcnt(0)
s_waitcnt vmcnt(24)
ds_write_b128 v6,v[64:67] offset:24576
ds_write_b128 v6,v[68:71] offset:25600
s_waitcnt lgkmcnt(0)
s_waitcnt vmcnt(16)
ds_write_b128 v6,v[72:75] offset:26624
ds_write_b128 v6,v[76:79] offset:27648
s_waitcnt lgkmcnt(0)
s_waitcnt vmcnt(8)
ds_write_b128 v6,v[24:27] offset:28672
ds_write_b128 v6,v[28:31] offset:29696
s_waitcnt lgkmcnt(0)
s_waitcnt vmcnt(0)
ds_write_b128 v6,v[32:35] offset:30720
ds_write_b128 v6,v[36:39] offset:31744
s_waitcnt lgkmcnt(0)
v_mov_b32 v123,159744
s_cmp_lg_u32 s46,0
s_cbranch_scc1 L_gbd_117
v_mov_b32 v124,128
L_gb_116:
buffer_load_dword v125,v124,s[12:15],0 offen sc1
s_waitcnt vmcnt(0)
v_readfirstlane_b32 s56,v125
ds_write_b32 v123,v125
s_bitcmp1_b32 s56,8
s_cbranch_scc1 L_gbd_117
s_sleep 4
s_sub_u32 s49,s49,1
s_cmp_gt_i32 s49,0
s_cbranch_scc1 L_gb_116
s_branch L_abort
L_gbd_117:
s_waitcnt lgkmcnt(0)
s_barrier
ds_read_b32 v125,v123
s_waitcnt lgkmcnt(0)
v_readfirstlane_b32 s56,v125
s_barrier
s_lshr_b32 s56,s56,16
s_andn2_b32 s56,s56,s3
s_cbranch_scc1 L_spread
s_cmp_eq_u32 s48,0
s_cbranch_scc1 L_chd_118
v_and_b32 v120,15,v1
v_lshrrev_b32 v121,4,v1
v_mov_b32 v17,1
s_lshl_b32 s56,s46,2
v_add_u32 v125,s56,v121
v_xor_b32 v126,v125,v120
v_lshlrev_b32 v126,4,v126
v_lshl_add_u32 v20,v125,10,v126
s_lshl_b32 s56,s46,1
s_xor_b32 s56,s56,0
s_and_b32 s57,s56,3
s_lshl_b32 s57,s57,2
s_lshr_b32 s56,s56,2
s_lshl_b32 s56,s56,13
s_add_u32 s56,s56,131072
v_add_u32 v125,s57,v121
v_xor_b32 v125,v125,v120
v_lshlrev_b32 v125,4,v125
v_lshl_add_u32 v125,v120,8,v125
v_add_u32 v4,s56,v125
s_lshl_b32 s56,s46,1
s_xor_b32 s56,s56,1
s_and_b32 s57,s56,3
s_lshl_b32 s57,s57,2
s_lshr_b32 s56,s56,2
s_lshl_b32 s56,s56,13
s_add_u32 s56,s56,131072
v_add_u32 v125,s57,v121
v_xor_b32 v125,v125,v120
v_lshlrev_b32 v125,4,v125
v_lshl_add_u32 v125,v120,8,v125
v_add_u32 v5,s56,v125
s_lshl_b32 s56,s46,1
s_xor_b32 s56,s56,2
s_and_b32 s57,s56,3
s_lshl_b32 s57,s57,2
s_lshr_b32 s56,s56,2
s_lshl_b32 s56,s56,13
s_add_u32 s56,s56,131072
v_add_u32 v125,s57,v121
v_xor_b32 v125,v125,v120
v_lshlrev_b32 v125,4,v125
v_lshl_add_u32 v125,v120,8,v125
v_add_u32 v6,s56,v125
s_lshl_b32 s56,s46,1
s_xor_b32 s56,s56,3
s_and_b32 s57,s56,3
s_lshl_b32 s57,s57,2
s_lshr_b32 s56,s56,2
s_lshl_b32 s56,s56,13
s_add_u32 s56,s56,131072
v_add_u32 v125,s57,v121
v_xor_b32 v125,v125,v120
v_lshlrev_b32 v125,4,v125
v_lshl_add_u32 v125,v120,8,v125
v_add_u32 v7,s56,v125
s_lshl_b32 s56,s46,1
s_xor_b32 s56,s56,4
s_and_b32 s57,s56,3
s_lshl_b32 s57,s57,2
s_lshr_b32 s56,s56,2
s_lshl_b32 s56,s56,13
s_add_u32 s56,s56,131072
v_add_u32 v125,s57,v121
v_xor_b32 v125,v125,v120
v_lshlrev_b32 v125,4,v125
v_lshl_add_u32 v125,v120,8,v125
v_add_u32 v8,s56,v125
s_lshl_b32 s56,s46,1
s_xor_b32 s56,s56,5
s_and_b32 s57,s56,3
s_lshl_b32 s57,s57,2
s_lshr_b32 s56,s56,2
s_lshl_b32 s56,s56,13
s_add_u32 s56,s56,131072
v_add_u32 v125,s57,v121
v_xor_b32 v125,v125,v120
v_lshlrev_b32 v125,4,v125
v_lshl_add_u32 v125,v120,8,v125
v_add_u32 v9,s56,v125
s_lshl_b32 s56,s46,1
s_xor_b32 s56,s56,6
s_and_b32 s57,s56,3
s_lshl_b32 s57,s57,2
s_lshr_b32 s56,s56,2
s_lshl_b32 s56,s56,13
s_add_u32 s56,s56,131072
v_add_u32 v125,s57,v121
v_xor_b32 v125,v125,v120
v_lshlrev_b32 v125,4,v125
v_lshl_add_u32 v125,v120,8,v125
v_add_u32 v10,s56,v125
s_lshl_b32 s56,s46,1
s_xor_b32 s56,s56,7
s_and_b32 s57,s56,3
s_lshl_b32 s57,s57,2
s_lshr_b32 s56,s56,2
s_lshl_b32 s56,s56,13
s_add_u32 s56,s56,131072
v_add_u32 v125,s57,v121
v_xor_b32 v125,v125,v120
v_lshlrev_b32 v125,4,v125
v_lshl_add_u32 v125,v120,8,v125
v_add_u32 v11,s56,v125
s_cmp_eq_u32 s48,1
s_cselect_b32 s51,8,14
s_cselect_b32 s53,6,8
s_mov_b32 s72,0x80000000
s_lshl_b32 s70,s51,15
s_add_u32 s70,s70,0
s_add_u32 s71,s70,16384
s_add_u32 m0,s50,131072
s_nop 0
buffer_load_dwordx4 v20,s[8:11],s70 offen offset:0 sc1 lds
s_add_u32 m0,s50,135168
s_nop 0
buffer_load_dwordx4 v20,s[8:11],s71 offen offset:0 sc1 lds
s_add_u32 m0,s50,139008
s_nop 0
buffer_load_dwordx4 v20,s[8:11],s70 offen offset:256 sc1 lds
s_add_u32 m0,s50,143104
s_nop 0
buffer_load_dwordx4 v20,s[8:11],s71 offen offset:256 sc1 lds
s_waitcnt vmcnt(0)
L_chl_119:
s_mov_b64 s[68:69],s[70:71]
s_add_u32 s70,s70,32768
s_add_u32 s71,s71,32768
s_lshl_b32 s58,s51,5
s_add_u32 s58,s58,s47
s_mul_i32 s58,s58,24576
s_add_u32 s58,s58,100663296
s_add_u32 s61,s58,s50
s_add_u32 s62,s61,4096
s_add_u32 s63,s61,16384
s_add_u32 s64,s61,20480
s_add_u32 s65,s61,s50
s_add_u32 s65,s65,8192
s_waitcnt vmcnt(7)
s_barrier
ds_read_b128 v[72:75],v4 offset:0
ds_read_b128 v[76:79],v4 offset:4096
ds_read_b128 v[80:83],v5 offset:0
ds_read_b128 v[84:87],v5 offset:4096
s_add_u32 m0,s50,146944
s_nop 0
buffer_load_dwordx4 v20,s[8:11],s68 offen offset:512 sc1 lds
s_add_u32 m0,s50,151040
s_nop 0
buffer_load_dwordx4 v20,s[8:11],s69 offen offset:512 sc1 lds
s_add_u32 m0,s50,154880
s_nop 0
buffer_load_dwordx4 v20,s[8:11],s68 offen offset:768 sc1 lds
s_add_u32 m0,s50,158976
s_nop 0
buffer_load_dwordx4 v20,s[8:11],s69 offen offset:768 sc1 lds
s_waitcnt lgkmcnt(2)
v_mfma_f32_16x16x32_bf16 v[40:43],a[128:131],v[72:75],0
ds_read_b128 v[108:111],v6 offset:0
v_mfma_f32_16x16x32_bf16 v[56:59],v[72:75],v[128:131],0
v_mfma_f32_16x16x32_bf16 v[24:27],a[0:3],v[72:75],0
ds_read_b128 v[112:115],v6 offset:4096
v_mfma_f32_16x16x32_bf16 v[44:47],a[128:131],v[76:79],0
v_mfma_f32_16x16x32_bf16 v[60:63],v[76:79],v[128:131],0
v_mfma_f32_16x16x32_bf16 v[28:31],a[0:3],v[76:79],0
v_mfma_f32_16x16x32_bf16 v[48:51],a[136:139],v[72:75],0
v_mfma_f32_16x16x32_bf16 v[64:67],v[72:75],v[136:139],0
v_mfma_f32_16x16x32_bf16 v[32:35],a[8:11],v[72:75],0
v_mfma_f32_16x16x32_bf16 v[52:55],a[136:139],v[76:79],0
v_mfma_f32_16x16x32_bf16 v[68:71],v[76:79],v[136:139],0
v_mfma_f32_16x16x32_bf16 v[36:39],a[8:11],v[76:79],0
s_waitcnt lgkmcnt(2)
v_mfma_f32_16x16x32_bf16 v[40:43],a[132:135],v[80:83],v[40:43]
ds_read_b128 v[72:75],v7 offset:0
v_mfma_f32_16x16x32_bf16 v[56:59],v[80:83],v[132:135],v[56:59]
v_mfma_f32_16x16x32_bf16 v[24:27],a[4:7],v[80:83],v[24:27]
ds_read_b128 v[76:79],v7 offset:4096
v_mfma_f32_16x16x32_bf16 v[44:47],a[132:135],v[84:87],v[44:47]
v_mfma_f32_16x16x32_bf16 v[60:63],v[84:87],v[132:135],v[60:63]
v_mfma_f32_16x16x32_bf16 v[28:31],a[4:7],v[84:87],v[28:31]
v_mfma_f32_16x16x32_bf16 v[48:51],a[140:143],v[80:83],v[48:51]
v_mfma_f32_16x16x32_bf16 v[64:67],v[80:83],v[140:143],v[64:67]
v_mfma_f32_16x16x32_bf16 v[32:35],a[12:15],v[80:83],v[32:35]
v_mfma_f32_16x16x32_bf16 v[52:55],a[140:143],v[84:87],v[52:55]
v_mfma_f32_16x16x32_bf16 v[68:71],v[84:87],v[140:143],v[68:71]
v_mfma_f32_16x16x32_bf16 v[36:39],a[12:15],v[84:87],v[36:39]
s_waitcnt lgkmcnt(2)
v_mfma_f32_16x16x32_bf16 v[40:43],a[144:147],v[108:111],v[40:43]
ds_read_b128 v[80:83],v8 offset:0
v_mfma_f32_16x16x32_bf16 v[56:59],v[108:111],v[144:147],v[56:59]
v_mfma_f32_16x16x32_bf16 v[24:27],a[16:19],v[108:111],v[24:27]
ds_read_b128 v[84:87],v8 offset:4096
v_mfma_f32_16x16x32_bf16 v[44:47],a[144:147],v[112:115],v[44:47]
v_mfma_f32_16x16x32_bf16 v[60:63],v[112:115],v[144:147],v[60:63]
v_mfma_f32_16x16x32_bf16 v[28:31],a[16:19],v[112:115],v[28:31]
v_mfma_f32_16x16x32_bf16 v[48:51],a[152:155],v[108:111],v[48:51]
v_mfma_f32_16x16x32_bf16 v[64:67],v[108:111],v[152:155],v[64:67]
v_mfma_f32_16x16x32_bf16 v[32:35],a[24:27],v[108:111],v[32:35]
v_mfma_f32_16x16x32_bf16 v[52:55],a[152:155],v[112:115],v[52:55]
v_mfma_f32_16x16x32_bf16 v[68:71],v[112:115],v[152:155],v[68:71]
v_mfma_f32_16x16x32_bf16 v[36:39],a[24:27],v[112:115],v[36:39]
s_waitcnt lgkmcnt(2)
v_mfma_f32_16x16x32_bf16 v[40:43],a[148:151],v[72:75],v[40:43]
ds_read_b128 v[108:111],v9 offset:0
v_mfma_f32_16x16x32_bf16 v[56:59],v[72:75],v[148:151],v[56:59]
v_mfma_f32_16x16x32_bf16 v[24:27],a[20:23],v[72:75],v[24:27]
ds_read_b128 v[112:115],v9 offset:4096
v_mfma_f32_16x16x32_bf16 v[44:47],a[148:151],v[76:79],v[44:47]
v_mfma_f32_16x16x32_bf16 v[60:63],v[76:79],v[148:151],v[60:63]
v_mfma_f32_16x16x32_bf16 v[28:31],a[20:23],v[76:79],v[28:31]
v_mfma_f32_16x16x32_bf16 v[48:51],a[156:159],v[72:75],v[48:51]
v_mfma_f32_16x16x32_bf16 v[64:67],v[72:75],v[156:159],v[64:67]
v_mfma_f32_16x16x32_bf16 v[32:35],a[28:31],v[72:75],v[32:35]
v_mfma_f32_16x16x32_bf16 v[52:55],a[156:159],v[76:79],v[52:55]
v_mfma_f32_16x16x32_bf16 v[68:71],v[76:79],v[156:159],v[68:71]
v_mfma_f32_16x16x32_bf16 v[36:39],a[28:31],v[76:79],v[36:39]
s_waitcnt lgkmcnt(2)
v_mfma_f32_16x16x32_bf16 v[40:43],a[160:163],v[80:83],v[40:43]
ds_read_b128 v[72:75],v10 offset:0
v_mfma_f32_16x16x32_bf16 v[56:59],v[80:83],v[160:163],v[56:59]
v_mfma_f32_16x16x32_bf16 v[24:27],a[32:35],v[80:83],v[24:27]
ds_read_b128 v[76:79],v10 offset:4096
v_mfma_f32_16x16x32_bf16 v[44:47],a[160:163],v[84:87],v[44:47]
v_mfma_f32_16x16x32_bf16 v[60:63],v[84:87],v[160:163],v[60:63]
v_mfma_f32_16x16x32_bf16 v[28:31],a[32:35],v[84:87],v[28:31]
v_mfma_f32_16x16x32_bf16 v[48:51],a[168:171],v[80:83],v[48:51]
v_mfma_f32_16x16x32_bf16 v[64:67],v[80:83],v[168:171],v[64:67]
v_mfma_f32_16x16x32_bf16 v[32:35],a[40:43],v[80:83],v[32:35]
v_mfma_f32_16x16x32_bf16 v[52:55],a[168:171],v[84:87],v[52:55]
v_mfma_f32_16x16x32_bf16 v[68:71],v[84:87],v[168:171],v[68:71]
v_mfma_f32_16x16x32_bf16 v[36:39],a[40:43],v[84:87],v[36:39]
s_waitcnt lgkmcnt(2)
v_mfma_f32_16x16x32_bf16 v[40:43],a[164:167],v[108:111],v[40:43]
ds_read_b128 v[80:83],v11 offset:0
v_mfma_f32_16x16x32_bf16 v[56:59],v[108:111],v[164:167],v[56:59]
v_mfma_f32_16x16x32_bf16 v[24:27],a[36:39],v[108:111],v[24:27]
ds_read_b128 v[84:87],v11 offset:4096
v_mfma_f32_16x16x32_bf16 v[44:47],a[164:167],v[112:115],v[44:47]
v_mfma_f32_16x16x32_bf16 v[60:63],v[112:115],v[164:167],v[60:63]
v_mfma_f32_16x16x32_bf16 v[28:31],a[36:39],v[112:115],v[28:31]
v_mfma_f32_16x16x32_bf16 v[48:51],a[172:175],v[108:111],v[48:51]
v_mfma_f32_16x16x32_bf16 v[64:67],v[108:111],v[172:175],v[64:67]
v_mfma_f32_16x16x32_bf16 v[32:35],a[44:47],v[108:111],v[32:35]
v_mfma_f32_16x16x32_bf16 v[52:55],a[172:175],v[112:115],v[52:55]
v_mfma_f32_16x16x32_bf16 v[68:71],v[112:115],v[172:175],v[68:71]
v_mfma_f32_16x16x32_bf16 v[36:39],a[44:47],v[112:115],v[36:39]
s_waitcnt vmcnt(0)
s_barrier
s_or_b32 s72,s72,s52
buffer_store_dword v17,off,s[8:11],s72 sc1
s_waitcnt lgkmcnt(2)
v_mfma_f32_16x16x32_bf16 v[40:43],a[176:179],v[72:75],v[40:43]
ds_read_b128 v[108:111],v4 offset:16384
v_mfma_f32_16x16x32_bf16 v[56:59],v[72:75],v[176:179],v[56:59]
v_mfma_f32_16x16x32_bf16 v[24:27],a[48:51],v[72:75],v[24:27]
ds_read_b128 v[112:115],v4 offset:20480
v_mfma_f32_16x16x32_bf16 v[44:47],a[176:179],v[76:79],v[44:47]
v_mfma_f32_16x16x32_bf16 v[60:63],v[76:79],v[176:179],v[60:63]
v_mfma_f32_16x16x32_bf16 v[28:31],a[48:51],v[76:79],v[28:31]
v_mfma_f32_16x16x32_bf16 v[48:51],a[184:187],v[72:75],v[48:51]
v_mfma_f32_16x16x32_bf16 v[64:67],v[72:75],v[184:187],v[64:67]
v_mfma_f32_16x16x32_bf16 v[32:35],a[56:59],v[72:75],v[32:35]
v_mfma_f32_16x16x32_bf16 v[52:55],a[184:187],v[76:79],v[52:55]
v_mfma_f32_16x16x32_bf16 v[68:71],v[76:79],v[184:187],v[68:71]
v_mfma_f32_16x16x32_bf16 v[36:39],a[56:59],v[76:79],v[36:39]
s_waitcnt lgkmcnt(2)
v_mfma_f32_16x16x32_bf16 v[40:43],a[180:183],v[80:83],v[40:43]
ds_read_b128 v[72:75],v5 offset:16384
v_mfma_f32_16x16x32_bf16 v[56:59],v[80:83],v[180:183],v[56:59]
v_mfma_f32_16x16x32_bf16 v[24:27],a[52:55],v[80:83],v[24:27]
ds_read_b128 v[76:79],v5 offset:20480
v_mfma_f32_16x16x32_bf16 v[44:47],a[180:183],v[84:87],v[44:47]
v_mfma_f32_16x16x32_bf16 v[60:63],v[84:87],v[180:183],v[60:63]
v_mfma_f32_16x16x32_bf16 v[28:31],a[52:55],v[84:87],v[28:31]
v_mfma_f32_16x16x32_bf16 v[48:51],a[188:191],v[80:83],v[48:51]
v_mfma_f32_16x16x32_bf16 v[64:67],v[80:83],v[188:191],v[64:67]
v_mfma_f32_16x16x32_bf16 v[32:35],a[60:63],v[80:83],v[32:35]
v_mfma_f32_16x16x32_bf16 v[52:55],a[188:191],v[84:87],v[52:55]
v_mfma_f32_16x16x32_bf16 v[68:71],v[84:87],v[188:191],v[68:71]
v_mfma_f32_16x16x32_bf16 v[36:39],a[60:63],v[84:87],v[36:39]
s_waitcnt lgkmcnt(2)
v_mfma_f32_16x16x32_bf16 v[40:43],a[192:195],v[108:111],v[40:43]
ds_read_b128 v[80:83],v6 offset:16384
v_mfma_f32_16x16x32_bf16 v[56:59],v[108:111],v[192:195],v[56:59]
v_mfma_f32_16x16x32_bf16 v[24:27],a[64:67],v[108:111],v[24:27]
ds_read_b128 v[84:87],v6 offset:20480
v_mfma_f32_16x16x32_bf16 v[44:47],a[192:195],v[112:115],v[44:47]
v_mfma_f32_16x16x32_bf16 v[60:63],v[112:115],v[192:195],v[60:63]
v_mfma_f32_16x16x32_bf16 v[28:31],a[64:67],v[112:115],v[28:31]
v_mfma_f32_16x16x32_bf16 v[48:51],a[200:203],v[108:111],v[48:51]
v_mfma_f32_16x16x32_bf16 v[64:67],v[108:111],v[200:203],v[64:67]
v_mfma_f32_16x16x32_bf16 v[32:35],a[72:75],v[108:111],v[32:35]
v_mfma_f32_16x16x32_bf16 v[52:55],a[200:203],v[112:115],v[52:55]
v_mfma_f32_16x16x32_bf16 v[68:71],v[112:115],v[200:203],v[68:71]
v_mfma_f32_16x16x32_bf16 v[36:39],a[72:75],v[112:115],v[36:39]
s_waitcnt lgkmcnt(2)
v_mfma_f32_16x16x32_bf16 v[40:43],a[196:199],v[72:75],v[40:43]
ds_read_b128 v[108:111],v7 offset:16384
v_mfma_f32_16x16x32_bf16 v[56:59],v[72:75],v[196:199],v[56:59]
v_mfma_f32_16x16x32_bf16 v[24:27],a[68:71],v[72:75],v[24:27]
ds_read_b128 v[112:115],v7 offset:20480
v_mfma_f32_16x16x32_bf16 v[44:47],a[196:199],v[76:79],v[44:47]
v_mfma_f32_16x16x32_bf16 v[60:63],v[76:79],v[196:199],v[60:63]
v_mfma_f32_16x16x32_bf16 v[28:31],a[68:71],v[76:79],v[28:31]
v_mfma_f32_16x16x32_bf16 v[48:51],a[204:207],v[72:75],v[48:51]
v_mfma_f32_16x16x32_bf16 v[64:67],v[72:75],v[204:207],v[64:67]
v_mfma_f32_16x16x32_bf16 v[32:35],a[76:79],v[72:75],v[32:35]
v_mfma_f32_16x16x32_bf16 v[52:55],a[204:207],v[76:79],v[52:55]
v_mfma_f32_16x16x32_bf16 v[68:71],v[76:79],v[204:207],v[68:71]
v_mfma_f32_16x16x32_bf16 v[36:39],a[76:79],v[76:79],v[36:39]
s_waitcnt lgkmcnt(2)
v_mfma_f32_16x16x32_bf16 v[40:43],a[208:211],v[80:83],v[40:43]
ds_read_b128 v[72:75],v8 offset:16384
v_mfma_f32_16x16x32_bf16 v[56:59],v[80:83],v[208:211],v[56:59]
v_mfma_f32_16x16x32_bf16 v[24:27],a[80:83],v[80:83],v[24:27]
ds_read_b128 v[76:79],v8 offset:20480
v_mfma_f32_16x16x32_bf16 v[44:47],a[208:211],v[84:87],v[44:47]
v_mfma_f32_16x16x32_bf16 v[60:63],v[84:87],v[208:211],v[60:63]
v_mfma_f32_16x16x32_bf16 v[28:31],a[80:83],v[84:87],v[28:31]
v_mfma_f32_16x16x32_bf16 v[48:51],a[216:219],v[80:83],v[48:51]
v_mfma_f32_16x16x32_bf16 v[64:67],v[80:83],v[216:219],v[64:67]
v_mfma_f32_16x16x32_bf16 v[32:35],a[88:91],v[80:83],v[32:35]
v_mfma_f32_16x16x32_bf16 v[52:55],a[216:219],v[84:87],v[52:55]
v_mfma_f32_16x16x32_bf16 v[68:71],v[84:87],v[216:219],v[68:71]
v_mfma_f32_16x16x32_bf16 v[36:39],a[88:91],v[84:87],v[36:39]
s_waitcnt lgkmcnt(2)
v_mfma_f32_16x16x32_bf16 v[40:43],a[212:215],v[108:111],v[40:43]
ds_read_b128 v[80:83],v9 offset:16384
v_mfma_f32_16x16x32_bf16 v[56:59],v[108:111],v[212:215],v[56:59]
v_mfma_f32_16x16x32_bf16 v[24:27],a[84:87],v[108:111],v[24:27]
ds_read_b128 v[84:87],v9 offset:20480
v_mfma_f32_16x16x32_bf16 v[44:47],a[212:215],v[112:115],v[44:47]
v_mfma_f32_16x16x32_bf16 v[60:63],v[112:115],v[212:215],v[60:63]
v_mfma_f32_16x16x32_bf16 v[28:31],a[84:87],v[112:115],v[28:31]
v_mfma_f32_16x16x32_bf16 v[48:51],a[220:223],v[108:111],v[48:51]
v_mfma_f32_16x16x32_bf16 v[64:67],v[108:111],v[220:223],v[64:67]
v_mfma_f32_16x16x32_bf16 v[32:35],a[92:95],v[108:111],v[32:35]
v_mfma_f32_16x16x32_bf16 v[52:55],a[220:223],v[112:115],v[52:55]
v_mfma_f32_16x16x32_bf16 v[68:71],v[112:115],v[220:223],v[68:71]
v_mfma_f32_16x16x32_bf16 v[36:39],a[92:95],v[112:115],v[36:39]
s_barrier
s_waitcnt lgkmcnt(2)
v_mfma_f32_16x16x32_bf16 v[40:43],a[224:227],v[72:75],v[40:43]
ds_read_b128 v[108:111],v10 offset:16384
v_mfma_f32_16x16x32_bf16 v[56:59],v[72:75],v[224:227],v[56:59]
s_add_u32 m0,s50,131072
v_mfma_f32_16x16x32_bf16 v[24:27],a[96:99],v[72:75],v[24:27]
ds_read_b128 v[112:115],v10 offset:20480
v_mfma_f32_16x16x32_bf16 v[44:47],a[224:227],v[76:79],v[44:47]
buffer_load_dwordx4 v20,s[8:11],s70 offen offset:0 sc1 lds
v_mfma_f32_16x16x32_bf16 v[60:63],v[76:79],v[224:227],v[60:63]
s_add_u32 m0,s50,135168
v_mfma_f32_16x16x32_bf16 v[28:31],a[96:99],v[76:79],v[28:31]
buffer_load_dwordx4 v20,s[8:11],s71 offen offset:0 sc1 lds
v_mfma_f32_16x16x32_bf16 v[48:51],a[232:235],v[72:75],v[48:51]
s_add_u32 m0,s50,139008
v_mfma_f32_16x16x32_bf16 v[64:67],v[72:75],v[232:235],v[64:67]
buffer_load_dwordx4 v20,s[8:11],s70 offen offset:256 sc1 lds
v_mfma_f32_16x16x32_bf16 v[32:35],a[104:107],v[72:75],v[32:35]
s_add_u32 m0,s50,143104
v_mfma_f32_16x16x32_bf16 v[52:55],a[232:235],v[76:79],v[52:55]
buffer_load_dwordx4 v20,s[8:11],s71 offen offset:256 sc1 lds
v_mfma_f32_16x16x32_bf16 v[68:71],v[76:79],v[232:235],v[68:71]
v_mfma_f32_16x16x32_bf16 v[36:39],a[104:107],v[76:79],v[36:39]
s_waitcnt lgkmcnt(2)
v_mfma_f32_16x16x32_bf16 v[40:43],a[228:231],v[80:83],v[40:43]
ds_read_b128 v[72:75],v11 offset:16384
v_mfma_f32_16x16x32_bf16 v[56:59],v[80:83],v[228:231],v[56:59]
v_mfma_f32_16x16x32_bf16 v[24:27],a[100:103],v[80:83],v[24:27]
ds_read_b128 v[76:79],v11 offset:20480
v_mfma_f32_16x16x32_bf16 v[44:47],a[228:231],v[84:87],v[44:47]
v_mfma_f32_16x16x32_bf16 v[60:63],v[84:87],v[228:231],v[60:63]
v_mfma_f32_16x16x32_bf16 v[28:31],a[100:103],v[84:87],v[28:31]
v_mfma_f32_16x16x32_bf16 v[48:51],a[236:239],v[80:83],v[48:51]
v_mfma_f32_16x16x32_bf16 v[64:67],v[80:83],v[236:239],v[64:67]
v_mfma_f32_16x16x32_bf16 v[32:35],a[108:111],v[80:83],v[32:35]
v_mfma_f32_16x16x32_bf16 v[52:55],a[236:239],v[84:87],v[52:55]
v_mfma_f32_16x16x32_bf16 v[68:71],v[84:87],v[236:239],v[68:71]
v_mfma_f32_16x16x32_bf16 v[36:39],a[108:111],v[84:87],v[36:39]
s_waitcnt lgkmcnt(2)
v_mfma_f32_16x16x32_bf16 v[40:43],a[240:243],v[108:111],v[40:43]
v_mfma_f32_16x16x32_bf16 v[56:59],v[108:111],v[240:243],v[56:59]
v_mfma_f32_16x16x32_bf16 v[24:27],a[112:115],v[108:111],v[24:27]
v_mfma_f32_16x16x32_bf16 v[44:47],a[240:243],v[112:115],v[44:47]
v_mfma_f32_16x16x32_bf16 v[60:63],v[112:115],v[240:243],v[60:63]
v_mfma_f32_16x16x32_bf16 v[28:31],a[112:115],v[112:115],v[28:31]
v_mfma_f32_16x16x32_bf16 v[48:51],a[248:251],v[108:111],v[48:51]
v_mfma_f32_16x16x32_bf16 v[64:67],v[108:111],v[248:251],v[64:67]
v_mfma_f32_16x16x32_bf16 v[32:35],a[120:123],v[108:111],v[32:35]
v_mfma_f32_16x16x32_bf16 v[52:55],a[248:251],v[112:115],v[52:55]
v_mfma_f32_16x16x32_bf16 v[68:71],v[112:115],v[248:251],v[68:71]
v_mfma_f32_16x16x32_bf16 v[36:39],a[120:123],v[112:115],v[36:39]
s_waitcnt lgkmcnt(0)
v_mfma_f32_16x16x32_bf16 v[40:43],a[244:247],v[72:75],v[40:43]
v_mfma_f32_16x16x32_bf16 v[56:59],v[72:75],v[244:247],v[56:59]
v_mfma_f32_16x16x32_bf16 v[24:27],a[116:119],v[72:75],v[24:27]
v_mfma_f32_16x16x32_bf16 v[44:47],a[244:247],v[76:79],v[44:47]
v_mfma_f32_16x16x32_bf16 v[60:63],v[76:79],v[244:247],v[60:63]
v_mfma_f32_16x16x32_bf16 v[28:31],a[116:119],v[76:79],v[28:31]
v_mfma_f32_16x16x32_bf16 v[48:51],a[252:255],v[72:75],v[48:51]
v_mfma_f32_16x16x32_bf16 v[64:67],v[72:75],v[252:255],v[64:67]
v_mfma_f32_16x16x32_bf16 v[32:35],a[124:127],v[72:75],v[32:35]
v_mfma_f32_16x16x32_bf16 v[52:55],a[252:255],v[76:79],v[52:55]
v_mfma_f32_16x16x32_bf16 v[68:71],v[76:79],v[252:255],v[68:71]
v_mfma_f32_16x16x32_bf16 v[36:39],a[124:127],v[76:79],v[36:39]
s_lshl_b32 s56,s51,5
s_add_u32 s56,s56,s47
s_lshl_b32 s56,s56,12
s_add_u32 s56,s56,s50
s_add_u32 s56,s56,41943040
v_mov_b64 v[120:121],-1
v_mov_b64 v[122:123],-1
buffer_store_dwordx4 v[120:123],v0,s[8:11],s56 offen sc1
v_cvt_pk_bf16_f32 v72,v40,v48
v_cvt_pk_bf16_f32 v73,v41,v49
v_cvt_pk_bf16_f32 v74,v42,v50
v_cvt_pk_bf16_f32 v75,v43,v51
buffer_store_dwordx4 v[72:75],v0,s[8:11],s61 offen sc1
v_cvt_pk_bf16_f32 v76,v44,v52
v_cvt_pk_bf16_f32 v77,v45,v53
v_cvt_pk_bf16_f32 v78,v46,v54
v_cvt_pk_bf16_f32 v79,v47,v55
buffer_store_dwordx4 v[76:79],v0,s[8:11],s62 offen sc1
v_cvt_pk_bf16_f32 v80,v56,v57
v_cvt_pk_bf16_f32 v81,v58,v59
v_cvt_pk_bf16_f32 v82,v60,v61
v_cvt_pk_bf16_f32 v83,v62,v63
buffer_store_dwordx4 v[80:83],v0,s[8:11],s65 offen offset:0 sc1
v_cvt_pk_bf16_f32 v84,v64,v65
v_cvt_pk_bf16_f32 v85,v66,v67
v_cvt_pk_bf16_f32 v86,v68,v69
v_cvt_pk_bf16_f32 v87,v70,v71
buffer_store_dwordx4 v[84:87],v0,s[8:11],s65 offen offset:1024 sc1
v_cvt_pk_bf16_f32 v108,v24,v32
v_cvt_pk_bf16_f32 v109,v25,v33
v_cvt_pk_bf16_f32 v110,v26,v34
v_cvt_pk_bf16_f32 v111,v27,v35
buffer_store_dwordx4 v[108:111],v0,s[8:11],s63 offen sc1
v_cvt_pk_bf16_f32 v112,v28,v36
v_cvt_pk_bf16_f32 v113,v29,v37
v_cvt_pk_bf16_f32 v114,v30,v38
v_cvt_pk_bf16_f32 v115,v31,v39
buffer_store_dwordx4 v[112:115],v0,s[8:11],s64 offen sc1
s_lshl_b32 s72,s51,13
s_lshl2_add_u32 s72,s47,s72
s_add_u32 s72,s72,10485760
s_add_u32 s51,s51,1
s_sub_u32 s53,s53,1
s_cmp_gt_u32 s53,0
s_cbranch_scc1 L_chl_119
s_waitcnt vmcnt(0)
s_barrier
s_or_b32 s72,s72,s52
buffer_store_dword v17,off,s[8:11],s72 sc1
L_chd_118:
s_cmp_lg_u32 s3,0
s_cbranch_scc1 L_wc
s_cmp_eq_u32 s48,1
s_cbranch_scc1 L_rc1_120
s_cmp_eq_u32 s48,2
s_cbranch_scc1 L_rc2_121
v_and_b32 v120,15,v1
v_lshrrev_b32 v121,4,v1
v_and_b32 v122,2,v1
v_cmp_eq_u32 vcc,0,v122
v_mov_b32 v2,0xeeee
v_mov_b32 v123,0x4444
v_cndmask_b32 v2,v2,v123,vcc
v_and_b32 v122,1,v1
v_cmp_eq_u32 vcc,0,v122
v_mov_b32 v3,0xdddd
v_mov_b32 v123,0x8888
v_cndmask_b32 v3,v3,v123,vcc
v_lshrrev_b32 v122,1,v120
v_bfe_u32 v123,v120,2,1
v_xor_b32 v123,v123,v122
v_lshlrev_b32 v4,7,v123
v_and_b32 v123,1,v120
v_lshl_add_u32 v4,v123,6,v4
v_xor_b32 v123,v121,v122
v_and_b32 v123,3,v123
v_lshl_add_u32 v4,v123,4,v4
s_lshl_b32 s56,s46,10
s_add_u32 s56,s56,147456
v_add_u32 v4,s56,v4
v_lshlrev_b32 v122,1,v121
v_add_u32 v122,0,v122
v_and_b32 v123,1,v121
v_xor_b32 v123,v123,v122
v_lshlrev_b32 v5,7,v123
v_bfe_u32 v123,v120,3,1
v_lshl_add_u32 v5,v123,6,v5
v_xor_b32 v123,v120,v122
v_and_b32 v123,3,v123
v_lshl_add_u32 v5,v123,4,v5
v_bfe_u32 v123,v120,2,1
v_lshl_add_u32 v5,v123,3,v5
v_add_u32 v5,147456,v5
v_lshlrev_b32 v122,1,v121
v_add_u32 v122,1,v122
v_and_b32 v123,1,v121
v_xor_b32 v123,v123,v122
v_lshlrev_b32 v6,7,v123
v_bfe_u32 v123,v120,3,1
v_lshl_add_u32 v6,v123,6,v6
v_xor_b32 v123,v120,v122
v_and_b32 v123,3,v123
v_lshl_add_u32 v6,v123,4,v6
v_bfe_u32 v123,v120,2,1
v_lshl_add_u32 v6,v123,3,v6
v_add_u32 v6,147456,v6
v_lshlrev_b32 v7,7,v121
v_lshrrev_b32 v122,1,v120
v_lshl_add_u32 v8,v122,4,v7
v_add_u32 v8,151552,v8
v_lshrrev_b32 v122,2,v120
v_lshl_add_u32 v7,v122,5,v7
v_and_b32 v122,1,v120
v_lshl_add_u32 v7,v122,4,v7
v_and_b32 v122,2,v120
v_cmp_eq_u32 vcc,0,v122
s_lshl_b32 s56,s46,9
v_mov_b32 v122,2048
v_mov_b32 v123,s56
v_cndmask_b32 v122,v122,v123,vcc
v_add_u32 v7,v122,v7
v_add_u32 v7,151552,v7
v_lshrrev_b32 v122,3,v1
v_lshlrev_b32 v9,11,v122
v_and_b32 v122,7,v1
v_lshl_add_u32 v9,v122,3,v9
s_lshl_b32 s56,s46,14
s_lshl_b32 s57,s47,6
s_add_u32 s56,s56,s57
v_add_u32 v9,s56,v9
s_lshl_b32 s71,s47,2
s_add_u32 s71,s71,s46
s_bfe_u32 s56,s71,0x10003
s_lshl_b32 s56,s56,11
s_and_b32 s57,s71,1
s_lshl_b32 s57,s57,10
s_add_u32 s56,s56,s57
s_bfe_u32 s57,s71,0x10002
s_lshl_b32 s57,s57,9
s_add_u32 s56,s56,s57
s_bfe_u32 s57,s71,0x10001
s_lshl_b32 s57,s57,6
s_add_u32 s56,s56,s57
s_bfe_u32 s57,s71,0x10004
s_lshl_b32 s57,s57,8
s_add_u32 s56,s56,s57
s_bfe_u32 s57,s71,0x10005
s_lshl_b32 s57,s57,7
s_add_u32 s56,s56,s57
s_bfe_u32 s57,s71,0x10006
s_lshl_b32 s57,s57,12
s_add_u32 s56,s56,s57
v_and_b32 v122,3,v120
v_lshlrev_b32 v10,2,v122
v_bfe_u32 v122,v120,3,1
v_lshl_add_u32 v10,v122,4,v10
v_and_b32 v122,1,v121
v_lshl_add_u32 v10,v122,5,v10
v_add_u32 v10,s56,v10
v_and_b32 v123,36,v1
v_mov_b32 v122,0x80000000
v_cmp_eq_u32 vcc,0,v123
s_nop 1
v_cndmask_b32 v10,v122,v10,vcc
s_lshl_b32 s56,s46,15
v_add_u32 v11,s56,v0
s_lshl_b32 s71,s71,11
s_lshl_b32 s73,s46,11
s_mov_b32 s72,0xffc00000
s_mov_b32 s74,0
v_lshrrev_b32 v13,3,v1
v_lshlrev_b32 v13,9,v13
v_and_b32 v122,7,v1
v_lshl_add_u32 v13,v122,4,v13
v_and_b32 v122,15,v1
v_and_b32 v123,1,v1
v_lshlrev_b32 v123,4,v123
v_mov_b32 v124,0x3f80
v_lshlrev_b32 v124,v123,v124
v_lshrrev_b32 v122,1,v122
v_cmp_eq_u32 vcc,0,v122
s_nop 1
v_cndmask_b32 v18,0,v124,vcc
v_cmp_eq_u32 vcc,1,v122
s_nop 1
v_cndmask_b32 v19,0,v124,vcc
v_cmp_eq_u32 vcc,2,v122
s_nop 1
v_cndmask_b32 v20,0,v124,vcc
v_cmp_eq_u32 vcc,3,v122
s_nop 1
v_cndmask_b32 v21,0,v124,vcc
s_and_b32 s56,s46,1
s_lshl_b32 s56,s56,8
s_and_b32 s57,s46,2
s_lshl_b32 s57,s57,6
s_add_u32 s56,s56,s57
v_add_u32 v13,s56,v13
s_add_u32 s56,s50,155648
v_add_u32 v12,s56,v0
v_mov_b64 v[14:15],s[28:29]
v_mov_b64 v[16:17],s[28:29]
v_add_u32 v22,11550720,v10
s_lshl_b32 s56,s47,2
s_add_u32 s56,s56,10502144
s_or_b32 s56,s56,s52
v_writelane_b32 v22,s56,4
v_mov_b32 v1,s80
s_mov_b32 s65,14680064
s_add_u32 s66,s71,14680064
s_add_u32 s69,s71,14942208
s_lshl_b32 s79,s47,2
s_add_u32 s79,s79,10485760
s_cmp_eq_u32 s46,0
s_cselect_b32 s79,s79,0x80000000
s_mov_b32 s30,0x40000000
s_mov_b32 s51,0
L_cst_122:
s_cmp_lg_u32 s46,0
s_cbranch_scc1 L_csw_127
s_lshl_b32 s59,s51,13
s_lshl2_add_u32 s59,s47,s59
s_add_u32 s59,s59,10485760
L_ww_128:
s_sleep 1
buffer_load_dword v122,off,s[8:11],s59 sc1
s_sub_u32 s49,s49,1
s_cbranch_scc1 L_abort
s_waitcnt vmcnt(0)
v_readfirstlane_b32 s61,v122
s_cmp_eq_u32 s61,0
s_cbranch_scc1 L_ww_128
L_wwd_129:
L_csw_127:
s_waitcnt lgkmcnt(0)
s_barrier
s_lshl_b32 s56,s51,5
s_add_u32 s56,s56,s47
s_mul_i32 s56,s56,24576
s_add_u32 s56,s56,100663296
s_add_u32 s67,s56,s73
s_add_u32 m0,s73,131072
s_add_u32 s57,s67,8192
buffer_load_dwordx4 v0,s[8:11],s67 offen sc1 lds
buffer_load_dwordx4 v0,s[8:11],s67 offen offset:1024 sc1 lds
s_add_u32 m0,s73,139264
s_add_u32 s67,s67,786432
buffer_load_dwordx4 v0,s[8:11],s57 offen sc1 lds
buffer_load_dwordx4 v0,s[8:11],s57 offen offset:1024 sc1 lds
s_lshl_b32 s75,s51,13
s_add_u32 s64,s75,11534336
s_add_u32 s70,s64,4096
s_lshl_b32 s68,s51,5
s_add_u32 s68,s68,s47
s_lshl_b32 s68,s68,12
s_lshl_b32 s56,s46,10
s_add_u32 s68,s68,s56
s_add_u32 s68,s68,41943040
s_mov_b32 s78,0x80000000
s_mov_b32 s55,0x80000000
s_mov_b32 s54,0x80000000
s_mov_b32 s77,0
s_cmp_eq_u32 s51,63
s_cselect_b32 s76,1,s46
v_mov_b64 v[96:97],0
v_mov_b64 v[98:99],0
v_mov_b64 v[100:101],0
v_mov_b64 v[102:103],0
v_mov_b64 v[104:105],0
v_mov_b64 v[106:107],0
v_mov_b64 v[108:109],0
v_mov_b64 v[110:111],0
v_mov_b64 v[112:113],0
v_mov_b64 v[114:115],0
v_mov_b64 v[116:117],0
v_mov_b64 v[118:119],0
s_waitcnt vmcnt(0) lgkmcnt(0)
s_barrier
v_add_u32 v55,131072,v0
ds_read_b128 v[56:59],v55 offset:0
ds_read_b128 v[60:63],v55 offset:4096
ds_read_b128 v[64:67],v55 offset:1024
ds_read_b128 v[68:71],v55 offset:5120
ds_read_b128 v[72:75],v55 offset:2048
ds_read_b128 v[76:79],v55 offset:6144
ds_read_b128 v[80:83],v55 offset:3072
ds_read_b128 v[84:87],v55 offset:7168
v_add_u32 v123,s73,v55
ds_read_b128 v[88:91],v123 offset:8192
ds_read_b128 v[92:95],v123 offset:9216
v_xor_b32 v120,1024,v12
v_xor_b32 v121,2048,v12
v_xor_b32 v122,3072,v12
buffer_load_dwordx4 v[24:27],v13,s[8:11],s64 offen sc1
buffer_load_dwordx4 v[40:43],v13,s[8:11],s70 offen sc1
L_chain_130:
L_cpa_131:
buffer_load_dwordx4 v[24:27],v13,s[8:11],s64 offen sc1
buffer_load_dwordx4 v[40:43],v13,s[8:11],s70 offen sc1
s_sub_u32 s49,s49,1
s_cbranch_scc1 L_abort
s_waitcnt vmcnt(2)
v_max3_u32 v123,v24,v25,v26
v_max3_u32 v123,v27,v40,v123
v_max3_u32 v123,v41,v42,v123
v_max_u32 v123,v43,v123
v_cmp_le_u32 vcc,s72,v123
s_cbranch_vccnz L_cpa_131
ds_write_b128 v12,v[24:27] offset:0
ds_write_b128 v12,v[40:43] offset:4096
v_smfmac_f32_16x16x64_bf16 v[96:99],v[24:27],a[0:7],v2
buffer_store_dwordx4 v[124:127],v0,s[8:11],s54 offen sc1
v_smfmac_f32_16x16x64_bf16 v[100:103],v[24:27],a[128:135],v2
s_add_u32 m0,s73,131072
s_add_u32 s57,s67,8192
v_smfmac_f32_16x16x64_bf16 v[104:107],v[24:27],a[8:15],v2
s_cmp_eq_u32 s76,0
v_smfmac_f32_16x16x64_bf16 v[108:111],v[24:27],a[136:143],v2
s_cbranch_scc1 L_ckw_123
L_ckb_124:
s_waitcnt lgkmcnt(0)
s_barrier
ds_read_b128 v[28:31],v120 offset:0
ds_read_b128 v[32:35],v121 offset:0
v_smfmac_f32_16x16x64_bf16 v[96:99],v[40:43],a[64:71],v2
ds_read_b128 v[36:39],v122 offset:0
v_smfmac_f32_16x16x64_bf16 v[100:103],v[40:43],a[192:199],v2
ds_read_b128 v[44:47],v120 offset:4096
v_smfmac_f32_16x16x64_bf16 v[104:107],v[40:43],a[72:79],v2
ds_read_b128 v[48:51],v121 offset:4096
v_smfmac_f32_16x16x64_bf16 v[108:111],v[40:43],a[200:207],v2
ds_read_b128 v[52:55],v122 offset:4096
v_smfmac_f32_16x16x64_bf16 v[112:115],v[24:27],v[128:135],v2
buffer_load_dwordx4 v0,s[8:11],s67 offen sc1 lds
v_smfmac_f32_16x16x64_bf16 v[116:119],v[24:27],v[136:143],v2
v_smfmac_f32_16x16x64_bf16 v[112:115],v[40:43],v[192:199],v2
buffer_load_dwordx4 v0,s[8:11],s67 offen offset:1024 sc1 lds
v_smfmac_f32_16x16x64_bf16 v[116:119],v[40:43],v[200:207],v2
s_waitcnt lgkmcnt(5)
v_smfmac_f32_16x16x64_bf16 v[96:99],v[28:31],a[16:23],v2
s_add_u32 m0,s73,139264
v_smfmac_f32_16x16x64_bf16 v[100:103],v[28:31],a[144:151],v2
buffer_load_dwordx4 v0,s[8:11],s57 offen sc1 lds
v_smfmac_f32_16x16x64_bf16 v[104:107],v[28:31],a[24:31],v2
s_add_u32 s67,s67,786432
v_smfmac_f32_16x16x64_bf16 v[108:111],v[28:31],a[152:159],v2
s_waitcnt lgkmcnt(4)
v_smfmac_f32_16x16x64_bf16 v[96:99],v[32:35],a[32:39],v2
buffer_load_dwordx4 v0,s[8:11],s57 offen offset:1024 sc1 lds
v_smfmac_f32_16x16x64_bf16 v[100:103],v[32:35],a[160:167],v2
v_smfmac_f32_16x16x64_bf16 v[104:107],v[32:35],a[40:47],v2
v_smfmac_f32_16x16x64_bf16 v[108:111],v[32:35],a[168:175],v2
buffer_load_dword v23,v22,s[8:11],s75 offen sc1
s_waitcnt lgkmcnt(3)
v_smfmac_f32_16x16x64_bf16 v[96:99],v[36:39],a[48:55],v2
v_mov_b32 v125,0
v_smfmac_f32_16x16x64_bf16 v[100:103],v[36:39],a[176:183],v2
v_smfmac_f32_16x16x64_bf16 v[104:107],v[36:39],a[56:63],v2
v_smfmac_f32_16x16x64_bf16 v[108:111],v[36:39],a[184:191],v2
s_waitcnt lgkmcnt(0)
v_smfmac_f32_16x16x64_bf16 v[96:99],v[44:47],a[80:87],v2
v_smfmac_f32_16x16x64_bf16 v[100:103],v[44:47],a[208:215],v2
v_smfmac_f32_16x16x64_bf16 v[96:99],v[48:51],a[96:103],v2
v_smfmac_f32_16x16x64_bf16 v[100:103],v[48:51],a[224:231],v2
v_smfmac_f32_16x16x64_bf16 v[96:99],v[52:55],a[112:119],v2
v_smfmac_f32_16x16x64_bf16 v[100:103],v[52:55],a[240:247],v2
v_smfmac_f32_16x16x64_bf16 v[104:107],v[44:47],a[88:95],v2
v_smfmac_f32_16x16x64_bf16 v[108:111],v[44:47],a[216:223],v2
v_smfmac_f32_16x16x64_bf16 v[104:107],v[48:51],a[104:111],v2
v_add_f32 v96,v96,v98
v_smfmac_f32_16x16x64_bf16 v[108:111],v[48:51],a[232:239],v2
v_add_f32 v97,v97,v99
v_smfmac_f32_16x16x64_bf16 v[104:107],v[52:55],a[120:127],v2
v_cvt_pk_bf16_f32 v120,v96,v97
v_smfmac_f32_16x16x64_bf16 v[108:111],v[52:55],a[248:255],v2
v_add_f32 v100,v100,v102
v_smfmac_f32_16x16x64_bf16 v[112:115],v[28:31],v[144:151],v2
v_add_f32 v101,v101,v103
v_smfmac_f32_16x16x64_bf16 v[116:119],v[28:31],v[152:159],v2
v_cvt_pk_bf16_f32 v121,v100,v101
v_add_f32 v104,v104,v106
v_add_f32 v105,v105,v107
v_cvt_pk_bf16_f32 v122,v104,v105
v_add_f32 v108,v108,v110
v_add_f32 v109,v109,v111
v_cvt_pk_bf16_f32 v123,v108,v109
ds_write_b128 v4,v[120:123]
v_smfmac_f32_16x16x64_bf16 v[112:115],v[32:35],v[160:167],v2
v_smfmac_f32_16x16x64_bf16 v[116:119],v[32:35],v[168:175],v2
v_smfmac_f32_16x16x64_bf16 v[112:115],v[36:39],v[176:183],v2
v_smfmac_f32_16x16x64_bf16 v[116:119],v[36:39],v[184:191],v2
s_waitcnt vmcnt(6) lgkmcnt(0)
s_barrier
ds_read_b64_tr_b16 v[96:97],v5 offset:0
ds_read_b64_tr_b16 v[98:99],v6 offset:0
v_smfmac_f32_16x16x64_bf16 v[112:115],v[44:47],v[208:215],v2
ds_read_b64_tr_b16 v[100:101],v5 offset:1024
v_smfmac_f32_16x16x64_bf16 v[116:119],v[44:47],v[216:223],v2
ds_read_b64_tr_b16 v[102:103],v6 offset:1024
v_smfmac_f32_16x16x64_bf16 v[112:115],v[48:51],v[224:231],v2
ds_read_b64_tr_b16 v[104:105],v5 offset:2048
v_smfmac_f32_16x16x64_bf16 v[116:119],v[48:51],v[232:239],v2
ds_read_b64_tr_b16 v[106:107],v6 offset:2048
s_waitcnt lgkmcnt(4)
v_mfma_f32_16x16x32_bf16 v[24:27],v[56:59],v[96:99],0
ds_read_b64_tr_b16 v[108:109],v5 offset:3072
v_mfma_f32_16x16x32_bf16 v[28:31],v[60:63],v[96:99],0
ds_read_b64_tr_b16 v[110:111],v6 offset:3072
v_mfma_f32_16x16x32_bf16 v[32:35],v[96:99],v[96:99],0
ds_read_b128 v[40:43],v11 offset:12288
s_waitcnt lgkmcnt(5)
v_mfma_f32_16x16x32_bf16 v[24:27],v[64:67],v[100:103],v[24:27]
ds_read_b128 v[56:59],v11 offset:0
v_mfma_f32_16x16x32_bf16 v[28:31],v[68:71],v[100:103],v[28:31]
ds_read_b128 v[60:63],v11 offset:1024
v_mfma_f32_16x16x32_bf16 v[32:35],v[100:103],v[100:103],v[32:35]
ds_read_b128 v[96:99],v11 offset:8192
s_waitcnt lgkmcnt(6)
v_mfma_f32_16x16x32_bf16 v[24:27],v[72:75],v[104:107],v[24:27]
ds_read_b128 v[64:67],v11 offset:2048
v_mfma_f32_16x16x32_bf16 v[28:31],v[76:79],v[104:107],v[28:31]
ds_read_b128 v[68:71],v11 offset:3072
v_mfma_f32_16x16x32_bf16 v[32:35],v[104:107],v[104:107],v[32:35]
ds_read_b128 v[100:103],v11 offset:9216
s_waitcnt lgkmcnt(7)
v_mfma_f32_16x16x32_bf16 v[24:27],v[80:83],v[108:111],v[24:27]
ds_read_b128 v[72:75],v11 offset:4096
v_mfma_f32_16x16x32_bf16 v[28:31],v[84:87],v[108:111],v[28:31]
ds_read_b128 v[76:79],v11 offset:5120
v_mfma_f32_16x16x32_bf16 v[32:35],v[108:111],v[108:111],v[32:35]
ds_read_b128 v[104:107],v11 offset:10240
v_smfmac_f32_16x16x64_bf16 v[112:115],v[52:55],v[240:247],v2
ds_read_b128 v[80:83],v11 offset:6144
v_smfmac_f32_16x16x64_bf16 v[116:119],v[52:55],v[248:255],v2
ds_read_b128 v[84:87],v11 offset:7168
v_max3_f32 v126,v24,v25,v26
v_max3_f32 v127,v27,v28,v29
v_max3_f32 v126,v30,v31,v126
v_max3_f32 v127,v34,v35,v127
v_max_f32 v126,v126,v127
v_max_f32 v127,v126,v127
v_pk_mul_f32 v[34:35],v[34:35],v[0:1] op_sel:[0,1]
v_pk_mul_f32 v[24:25],v[24:25],v[0:1] op_sel:[0,1]
v_permlane16_swap_b32 v126,v127
v_max_f32 v126,v126,v127
v_max_f32 v127,v126,v127
v_pk_mul_f32 v[26:27],v[26:27],v[0:1] op_sel:[0,1]
v_pk_mul_f32 v[28:29],v[28:29],v[0:1] op_sel:[0,1]
v_permlane32_swap_b32 v126,v127
v_max_f32 v126,v126,v127
v_mul_f32 v126,v1,v126
v_pk_mul_f32 v[30:31],v[30:31],v[0:1] op_sel:[0,1]
v_pk_add_f32 v[34:35],v[34:35],v[126:127] op_sel_hi:[1,0] neg_lo:[0,1] neg_hi:[0,1]
v_pk_add_f32 v[112:113],v[112:113],v[114:115]
v_pk_add_f32 v[116:117],v[116:117],v[118:119]
v_pk_add_f32 v[24:25],v[24:25],v[126:127] op_sel_hi:[1,0] neg_lo:[0,1] neg_hi:[0,1]
v_pk_add_f32 v[26:27],v[26:27],v[126:127] op_sel_hi:[1,0] neg_lo:[0,1] neg_hi:[0,1]
v_pk_add_f32 v[28:29],v[28:29],v[126:127] op_sel_hi:[1,0] neg_lo:[0,1] neg_hi:[0,1]
v_pk_add_f32 v[30:31],v[30:31],v[126:127] op_sel_hi:[1,0] neg_lo:[0,1] neg_hi:[0,1]
v_exp_f32 v34,v34
v_exp_f32 v35,v35
v_cvt_pk_bf16_f32 v126,v112,v113
v_cvt_pk_bf16_f32 v124,v34,v35
v_cvt_pk_bf16_f32 v127,v116,v117
v_cvt_pk_bf16_f32 v36,v116,v117
v_mfma_f32_16x16x16_bf16 v[32:35],v[14:15],v[124:125],0
ds_read_b128 v[108:111],v11 offset:11264
v_exp_f32 v24,v24
v_mfma_f32_16x16x16_bf16 v[112:115],v[126:127],v[124:125],0
ds_read_b128 v[44:47],v11 offset:13312
v_exp_f32 v25,v25
v_mfma_f32_16x16x16_bf16 v[116:119],v[36:37],v[124:125],0
ds_read_b128 v[48:51],v11 offset:14336
v_exp_f32 v26,v26
v_exp_f32 v27,v27
v_cvt_pk_bf16_f32 v120,v24,v25
v_exp_f32 v28,v28
v_exp_f32 v29,v29
v_cvt_pk_bf16_f32 v121,v26,v27
v_exp_f32 v30,v30
v_exp_f32 v31,v31
v_cvt_pk_bf16_f32 v122,v28,v29
v_cvt_pk_bf16_f32 v123,v30,v31
s_mov_b32 s78,s55
s_add_u32 s55,s79,s75
v_mfma_f32_16x16x32_bf16 v[32:35],v[14:17],v[120:123],v[32:35]
ds_read_b128 v[52:55],v11 offset:15360
v_mfma_f32_16x16x32_bf16 v[112:115],v[88:91],v[120:123],v[112:115]
ds_read_b128 v[88:91],v11 offset:16384
v_mfma_f32_16x16x32_bf16 v[116:119],v[92:95],v[120:123],v[116:119]
ds_read_b128 v[92:95],v11 offset:17408
v_rcp_f32 v32,v32
v_mov_b64 v[24:25],-1
v_mov_b64 v[26:27],-1
s_mov_b32 s54,s68
s_add_u32 s75,s75,8192
v_pk_mul_f32 v[112:113],v[112:113],v[32:33] op_sel_hi:[1,0]
v_pk_mul_f32 v[114:115],v[114:115],v[32:33] op_sel_hi:[1,0]
v_pk_mul_f32 v[116:117],v[116:117],v[32:33] op_sel_hi:[1,0]
v_pk_mul_f32 v[118:119],v[118:119],v[32:33] op_sel_hi:[1,0]
v_cvt_pk_bf16_f32 v120,v112,v116
v_cvt_pk_bf16_f32 v121,v113,v117
v_cvt_pk_bf16_f32 v122,v114,v118
v_cvt_pk_bf16_f32 v123,v115,v119
ds_write_b128 v7,v[120:123]
buffer_store_dwordx4 v[24:27],v0,s[8:11],s69 offen
buffer_store_dwordx4 v[24:27],v0,s[8:11],s69 offen offset:1024
s_waitcnt lgkmcnt(0)
s_barrier
ds_read_b128 v[24:27],v8 offset:0
ds_read_b128 v[28:31],v8 offset:512
ds_read_b128 v[32:35],v8 offset:1024
ds_read_b128 v[36:39],v8 offset:1536
v_mov_b64 v[112:113],0
v_mov_b64 v[114:115],0
v_mov_b64 v[116:117],0
v_mov_b64 v[118:119],0
v_mov_b64 v[120:121],0
v_mov_b64 v[122:123],0
s_add_u32 s64,s75,11534336
s_add_u32 s70,s64,4096
s_add_u32 s68,s68,131072
s_add_u32 s51,s51,1
s_cmp_eq_u32 s51,64
s_cbranch_scc1 L_cend_133
s_waitcnt lgkmcnt(3)
v_smfmac_f32_16x16x64_bf16 v[112:115],v[24:27],v[56:63],v3
ds_read_b128 v[56:59],v11 offset:18432
s_add_u32 s57,s65,65536
s_waitcnt lgkmcnt(3)
v_smfmac_f32_16x16x64_bf16 v[112:115],v[28:31],v[64:71],v3
ds_read_b128 v[60:63],v11 offset:19456
s_add_u32 s58,s65,131072
s_waitcnt lgkmcnt(3)
v_smfmac_f32_16x16x64_bf16 v[112:115],v[32:35],v[72:79],v3
ds_read_b128 v[64:67],v11 offset:20480
s_add_u32 s59,s65,196608
s_waitcnt lgkmcnt(3)
v_smfmac_f32_16x16x64_bf16 v[112:115],v[36:39],v[80:87],v3
ds_read_b128 v[68:71],v11 offset:21504
v_smfmac_f32_16x16x64_bf16 v[116:119],v[24:27],v[96:103],v3
ds_read_b128 v[72:75],v11 offset:22528
v_smfmac_f32_16x16x64_bf16 v[116:119],v[28:31],v[104:111],v3
ds_read_b128 v[76:79],v11 offset:23552
v_cvt_pk_bf16_f32 v112,v112,v113
v_smfmac_f32_16x16x64_bf16 v[116:119],v[32:35],v[40:47],v3
ds_read_b128 v[80:83],v11 offset:24576
v_cvt_pk_bf16_f32 v113,v114,v115
buffer_store_dwordx2 v[112:113],v9,s[8:11],s65 offen
v_smfmac_f32_16x16x64_bf16 v[116:119],v[36:39],v[48:55],v3
ds_read_b128 v[84:87],v11 offset:25600
v_mov_b64 v[112:113],0
v_smfmac_f32_16x16x64_bf16 v[120:123],v[24:27],v[88:95],v3
ds_read_b128 v[96:99],v11 offset:26624
ds_read_b128 v[100:103],v11 offset:27648
v_mov_b64 v[114:115],0
s_waitcnt lgkmcnt(8)
v_smfmac_f32_16x16x64_bf16 v[120:123],v[28:31],v[56:63],v3
ds_read_b128 v[104:107],v11 offset:28672
v_cvt_pk_bf16_f32 v116,v116,v117
s_waitcnt lgkmcnt(7)
v_smfmac_f32_16x16x64_bf16 v[120:123],v[32:35],v[64:71],v3
ds_read_b128 v[108:111],v11 offset:29696
ds_read_b128 v[40:43],v11 offset:30720
v_cvt_pk_bf16_f32 v117,v118,v119
buffer_store_dwordx2 v[116:117],v9,s[8:11],s57 offen
s_waitcnt lgkmcnt(7)
v_smfmac_f32_16x16x64_bf16 v[120:123],v[36:39],v[72:79],v3
ds_read_b128 v[44:47],v11 offset:31744
s_waitcnt lgkmcnt(6)
v_smfmac_f32_16x16x64_bf16 v[112:115],v[24:27],v[80:87],v3
s_waitcnt lgkmcnt(4)
v_smfmac_f32_16x16x64_bf16 v[112:115],v[28:31],v[96:103],v3
v_cvt_pk_bf16_f32 v120,v120,v121
s_waitcnt lgkmcnt(2)
v_smfmac_f32_16x16x64_bf16 v[112:115],v[32:35],v[104:111],v3
v_cvt_pk_bf16_f32 v121,v122,v123
buffer_store_dwordx2 v[120:121],v9,s[8:11],s58 offen
s_waitcnt lgkmcnt(0)
v_smfmac_f32_16x16x64_bf16 v[112:115],v[36:39],v[40:47],v3
v_mov_b64 v[116:117],0
v_mov_b64 v[118:119],0
s_xor_b32 s65,s65,262144
v_add_u32 v52,s50,v5
v_add_u32 v54,s50,v6
v_mov_b32_dpp v124,v126 quad_perm:[2,3,2,3] row_mask:0xf bank_mask:0xf
v_mov_b32_dpp v125,v127 quad_perm:[2,3,2,3] row_mask:0xf bank_mask:0xf
s_nop 0
v_cvt_pk_bf16_f32 v112,v112,v113
v_cvt_pk_bf16_f32 v113,v114,v115
buffer_store_dwordx2 v[112:113],v9,s[8:11],s59 offen
ds_read_b64_tr_b16 v[52:53],v52
ds_read_b64_tr_b16 v[54:55],v54
s_mov_b32 vcc_lo,0xcccccccc
s_mov_b32 vcc_hi,0xcccccccc
v_mov_b64 v[96:97],0
v_mov_b64 v[98:99],0
v_mov_b64 v[100:101],0
v_mov_b64 v[102:103],0
v_mov_b64 v[104:105],0
v_mov_b64 v[106:107],0
v_mov_b64 v[108:109],0
v_mov_b64 v[110:111],0
v_mov_b64 v[112:113],0
v_mov_b64 v[114:115],0
s_waitcnt lgkmcnt(0)
v_cndmask_b32 v124,v124,v52,vcc
v_cndmask_b32 v125,v125,v53,vcc
v_cndmask_b32 v126,v126,v54,vcc
v_cndmask_b32 v127,v127,v55,vcc
v_add_u32 v55,131072,v0
v_add_u32 v123,s73,v55
v_xor_b32 v120,1024,v12
v_xor_b32 v121,2048,v12
v_xor_b32 v122,3072,v12
s_waitcnt vmcnt(0)
buffer_load_dwordx4 v[32:35],v0,s[8:11],s66 offen offset:0 sc1
buffer_load_dwordx4 v[36:39],v0,s[8:11],s66 offen offset:1024 sc1
v_readlane_b32 s76,v23,4
s_cmp_ge_u32 s51,63
s_cselect_b32 s76,1,s76
s_or_b32 s76,s76,s46
s_waitcnt vmcnt(1)
v_mfma_f32_16x16x32_bf16 v[28:31],v[18:21],v[32:35],0
s_waitcnt vmcnt(0)
v_mfma_f32_16x16x32_bf16 v[28:31],v[18:21],v[36:39],v[28:31]
s_nop 7
v_cmp_u_f32 vcc,v28,v28
v_add_f32_dpp v52,v28,v28 row_ror:8 row_mask:0xf bank_mask:0x3
v_add_f32_dpp v53,v29,v29 row_ror:8 row_mask:0xf bank_mask:0x3
v_add_f32_dpp v52,v30,v30 row_ror:8 row_mask:0xf bank_mask:0xc
v_add_f32_dpp v53,v31,v31 row_ror:8 row_mask:0xf bank_mask:0xc
s_nop 0
v_add_f32_dpp v52,v52,v52 row_shl:4 row_mask:0xf bank_mask:0x5
v_add_f32_dpp v53,v53,v53 row_shl:4 row_mask:0xf bank_mask:0x5
s_cbranch_vccnz L_crp_135
L_cok_140:
v_cvt_pk_bf16_f32 v54,v52,v53
buffer_store_dword v54,v10,s[8:11],s64 offen
s_mov_b32 s69,s66
s_xor_b32 s66,s66,262144
s_barrier
ds_read_b128 v[56:59],v55 offset:0
ds_read_b128 v[60:63],v55 offset:4096
buffer_load_dwordx4 v[24:27],v13,s[8:11],s64 offen sc1
buffer_load_dwordx4 v[40:43],v13,s[8:11],s70 offen sc1
ds_read_b128 v[64:67],v55 offset:1024
ds_read_b128 v[68:71],v55 offset:5120
ds_read_b128 v[72:75],v55 offset:2048
ds_read_b128 v[76:79],v55 offset:6144
ds_read_b128 v[80:83],v55 offset:3072
ds_read_b128 v[84:87],v55 offset:7168
ds_read_b128 v[88:91],v123 offset:8192
ds_read_b128 v[92:95],v123 offset:9216
s_branch L_chain_130
L_crp_135:
buffer_load_dwordx4 v[32:35],v0,s[8:11],s66 offen offset:0 sc1
buffer_load_dwordx4 v[36:39],v0,s[8:11],s66 offen offset:1024 sc1
s_sub_u32 s49,s49,1
s_cbranch_scc1 L_abort
s_waitcnt vmcnt(1)
v_mfma_f32_16x16x32_bf16 v[28:31],v[18:21],v[32:35],0
s_waitcnt vmcnt(0)
v_mfma_f32_16x16x32_bf16 v[28:31],v[18:21],v[36:39],v[28:31]
s_nop 7
v_cmp_u_f32 vcc,v28,v28
v_add_f32_dpp v52,v28,v28 row_ror:8 row_mask:0xf bank_mask:0x3
v_add_f32_dpp v53,v29,v29 row_ror:8 row_mask:0xf bank_mask:0x3
v_add_f32_dpp v52,v30,v30 row_ror:8 row_mask:0xf bank_mask:0xc
v_add_f32_dpp v53,v31,v31 row_ror:8 row_mask:0xf bank_mask:0xc
s_nop 0
v_add_f32_dpp v52,v52,v52 row_shl:4 row_mask:0xf bank_mask:0x5
v_add_f32_dpp v53,v53,v53 row_shl:4 row_mask:0xf bank_mask:0x5
s_cbranch_vccz L_cok_140
s_branch L_crp_135
L_ckw_123:
s_lshl2_add_u32 s59,s47,s75
s_add_u32 s59,s59,10493952
L_ww_141:
s_sleep 1
buffer_load_dword v23,off,s[8:11],s59 sc1
s_sub_u32 s49,s49,1
s_cbranch_scc1 L_abort
s_waitcnt vmcnt(0)
v_readfirstlane_b32 s76,v23
s_cmp_eq_u32 s76,0
s_cbranch_scc1 L_ww_141
L_wwd_142:
s_branch L_ckb_124
L_cend_133:
v_add_u32 v52,s50,v5
v_add_u32 v54,s50,v6
ds_read_b64_tr_b16 v[52:53],v52
ds_read_b64_tr_b16 v[54:55],v54
v_mov_b32_dpp v124,v126 quad_perm:[2,3,2,3] row_mask:0xf bank_mask:0xf
v_mov_b32_dpp v125,v127 quad_perm:[2,3,2,3] row_mask:0xf bank_mask:0xf
s_mov_b32 vcc_lo,0xcccccccc
s_mov_b32 vcc_hi,0xcccccccc
s_waitcnt lgkmcnt(0)
v_cndmask_b32 v124,v124,v52,vcc
v_cndmask_b32 v125,v125,v53,vcc
v_cndmask_b32 v126,v126,v54,vcc
v_cndmask_b32 v127,v127,v55,vcc
buffer_store_dwordx4 v[124:127],v0,s[8:11],s54 offen sc1
s_waitcnt vmcnt(0)
s_barrier
s_nop 11
v_lshrrev_b32 v1,4,v0
s_branch L_ra_6
L_rc1_120:
v_and_b32 v120,15,v1
v_lshrrev_b32 v121,4,v1
v_and_b32 v122,2,v1
v_cmp_eq_u32 vcc,0,v122
v_mov_b32 v2,0xeeee
v_mov_b32 v123,0x4444
v_cndmask_b32 v2,v2,v123,vcc
v_and_b32 v122,1,v1
v_cmp_eq_u32 vcc,0,v122
v_mov_b32 v3,0xdddd
v_mov_b32 v123,0x8888
v_cndmask_b32 v3,v3,v123,vcc
v_lshrrev_b32 v122,1,v120
v_bfe_u32 v123,v120,2,1
v_xor_b32 v123,v123,v122
v_lshlrev_b32 v4,7,v123
v_and_b32 v123,1,v120
v_lshl_add_u32 v4,v123,6,v4
v_xor_b32 v123,v121,v122
v_and_b32 v123,3,v123
v_lshl_add_u32 v4,v123,4,v4
s_lshl_b32 s56,s46,10
s_add_u32 s56,s56,147456
v_add_u32 v4,s56,v4
v_lshlrev_b32 v122,1,v121
v_add_u32 v122,0,v122
v_and_b32 v123,1,v121
v_xor_b32 v123,v123,v122
v_lshlrev_b32 v5,7,v123
v_bfe_u32 v123,v120,3,1
v_lshl_add_u32 v5,v123,6,v5
v_xor_b32 v123,v120,v122
v_and_b32 v123,3,v123
v_lshl_add_u32 v5,v123,4,v5
v_bfe_u32 v123,v120,2,1
v_lshl_add_u32 v5,v123,3,v5
v_add_u32 v5,147456,v5
v_lshlrev_b32 v122,1,v121
v_add_u32 v122,1,v122
v_and_b32 v123,1,v121
v_xor_b32 v123,v123,v122
v_lshlrev_b32 v6,7,v123
v_bfe_u32 v123,v120,3,1
v_lshl_add_u32 v6,v123,6,v6
v_xor_b32 v123,v120,v122
v_and_b32 v123,3,v123
v_lshl_add_u32 v6,v123,4,v6
v_bfe_u32 v123,v120,2,1
v_lshl_add_u32 v6,v123,3,v6
v_add_u32 v6,147456,v6
v_lshlrev_b32 v7,7,v121
v_lshrrev_b32 v122,1,v120
v_lshl_add_u32 v8,v122,4,v7
v_add_u32 v8,151552,v8
v_lshrrev_b32 v122,2,v120
v_lshl_add_u32 v7,v122,5,v7
v_and_b32 v122,1,v120
v_lshl_add_u32 v7,v122,4,v7
v_and_b32 v122,2,v120
v_cmp_eq_u32 vcc,0,v122
s_lshl_b32 s56,s46,9
v_mov_b32 v122,2048
v_mov_b32 v123,s56
v_cndmask_b32 v122,v122,v123,vcc
v_add_u32 v7,v122,v7
v_add_u32 v7,151552,v7
v_lshrrev_b32 v122,3,v1
v_lshlrev_b32 v9,11,v122
v_and_b32 v122,7,v1
v_lshl_add_u32 v9,v122,3,v9
s_lshl_b32 s56,s46,14
s_lshl_b32 s57,s47,6
s_add_u32 s56,s56,s57
v_add_u32 v9,s56,v9
s_lshl_b32 s71,s47,2
s_add_u32 s71,s71,s46
s_bfe_u32 s56,s71,0x10003
s_lshl_b32 s56,s56,11
s_and_b32 s57,s71,1
s_lshl_b32 s57,s57,10
s_add_u32 s56,s56,s57
s_bfe_u32 s57,s71,0x10002
s_lshl_b32 s57,s57,9
s_add_u32 s56,s56,s57
s_bfe_u32 s57,s71,0x10001
s_lshl_b32 s57,s57,6
s_add_u32 s56,s56,s57
s_bfe_u32 s57,s71,0x10004
s_lshl_b32 s57,s57,8
s_add_u32 s56,s56,s57
s_bfe_u32 s57,s71,0x10005
s_lshl_b32 s57,s57,7
s_add_u32 s56,s56,s57
s_bfe_u32 s57,s71,0x10006
s_lshl_b32 s57,s57,12
s_add_u32 s56,s56,s57
v_and_b32 v122,3,v120
v_lshlrev_b32 v10,2,v122
v_bfe_u32 v122,v120,3,1
v_lshl_add_u32 v10,v122,4,v10
v_and_b32 v122,1,v121
v_lshl_add_u32 v10,v122,5,v10
v_add_u32 v10,s56,v10
v_and_b32 v123,36,v1
v_mov_b32 v122,0x80000000
v_cmp_eq_u32 vcc,0,v123
s_nop 1
v_cndmask_b32 v10,v122,v10,vcc
s_lshl_b32 s56,s46,15
v_add_u32 v11,s56,v0
s_lshl_b32 s71,s71,11
s_lshl_b32 s73,s46,11
s_mov_b32 s72,0xffc00000
s_mov_b32 s74,0
v_lshrrev_b32 v13,3,v1
v_lshlrev_b32 v13,9,v13
v_and_b32 v122,7,v1
v_lshl_add_u32 v13,v122,4,v13
v_and_b32 v122,15,v1
v_and_b32 v123,1,v1
v_lshlrev_b32 v123,4,v123
v_mov_b32 v124,0x3f80
v_lshlrev_b32 v124,v123,v124
v_lshrrev_b32 v122,1,v122
v_cmp_eq_u32 vcc,0,v122
s_nop 1
v_cndmask_b32 v18,0,v124,vcc
v_cmp_eq_u32 vcc,1,v122
s_nop 1
v_cndmask_b32 v19,0,v124,vcc
v_cmp_eq_u32 vcc,2,v122
s_nop 1
v_cndmask_b32 v20,0,v124,vcc
v_cmp_eq_u32 vcc,3,v122
s_nop 1
v_cndmask_b32 v21,0,v124,vcc
s_and_b32 s56,s46,1
s_lshl_b32 s56,s56,8
s_and_b32 s57,s46,2
s_lshl_b32 s57,s57,6
s_add_u32 s56,s56,s57
v_add_u32 v13,s56,v13
s_add_u32 s56,s50,155648
v_add_u32 v12,s56,v0
v_mov_b64 v[14:15],s[28:29]
v_mov_b64 v[16:17],s[28:29]
v_add_u32 v22,12599296,v10
s_lshl_b32 s56,s47,2
s_add_u32 s56,s56,10502272
s_or_b32 s56,s56,s52
v_writelane_b32 v22,s56,4
v_mov_b32 v1,s80
s_mov_b32 s65,15728640
s_add_u32 s66,s71,15728640
s_add_u32 s69,s71,15990784
s_lshl_b32 s79,s47,2
s_add_u32 s79,s79,10486272
s_cmp_eq_u32 s46,0
s_cselect_b32 s79,s79,0x80000000
s_mov_b32 s30,0x40000000
s_mov_b32 s51,0
L_cst_143:
s_cmp_lg_u32 s46,0
s_cbranch_scc1 L_csw_148
s_lshl_b32 s59,s51,13
s_lshl2_add_u32 s59,s47,s59
s_add_u32 s59,s59,10485888
L_ww_149:
s_sleep 1
buffer_load_dword v122,off,s[8:11],s59 sc1
s_sub_u32 s49,s49,1
s_cbranch_scc1 L_abort
s_waitcnt vmcnt(0)
v_readfirstlane_b32 s61,v122
s_cmp_eq_u32 s61,0
s_cbranch_scc1 L_ww_149
L_wwd_150:
L_csw_148:
s_waitcnt lgkmcnt(0)
s_barrier
s_lshl_b32 s56,s51,5
s_add_u32 s56,s56,s47
s_mul_i32 s56,s56,24576
s_add_u32 s56,s56,150994944
s_add_u32 s67,s56,s73
s_add_u32 m0,s73,131072
s_add_u32 s57,s67,8192
buffer_load_dwordx4 v0,s[8:11],s67 offen sc1 lds
buffer_load_dwordx4 v0,s[8:11],s67 offen offset:1024 sc1 lds
s_add_u32 m0,s73,139264
s_add_u32 s67,s67,786432
buffer_load_dwordx4 v0,s[8:11],s57 offen sc1 lds
buffer_load_dwordx4 v0,s[8:11],s57 offen offset:1024 sc1 lds
s_lshl_b32 s75,s51,13
s_add_u32 s64,s75,12582912
s_add_u32 s70,s64,4096
s_lshl_b32 s68,s51,5
s_add_u32 s68,s68,s47
s_lshl_b32 s68,s68,12
s_lshl_b32 s56,s46,10
s_add_u32 s68,s68,s56
s_add_u32 s68,s68,58720256
s_mov_b32 s78,0x80000000
s_mov_b32 s55,0x80000000
s_mov_b32 s54,0x80000000
s_mov_b32 s77,0
s_cmp_eq_u32 s51,63
s_cselect_b32 s76,1,s46
v_mov_b64 v[96:97],0
v_mov_b64 v[98:99],0
v_mov_b64 v[100:101],0
v_mov_b64 v[102:103],0
v_mov_b64 v[104:105],0
v_mov_b64 v[106:107],0
v_mov_b64 v[108:109],0
v_mov_b64 v[110:111],0
v_mov_b64 v[112:113],0
v_mov_b64 v[114:115],0
v_mov_b64 v[116:117],0
v_mov_b64 v[118:119],0
s_waitcnt vmcnt(0) lgkmcnt(0)
s_barrier
v_add_u32 v55,131072,v0
ds_read_b128 v[56:59],v55 offset:0
ds_read_b128 v[60:63],v55 offset:4096
ds_read_b128 v[64:67],v55 offset:1024
ds_read_b128 v[68:71],v55 offset:5120
ds_read_b128 v[72:75],v55 offset:2048
ds_read_b128 v[76:79],v55 offset:6144
ds_read_b128 v[80:83],v55 offset:3072
ds_read_b128 v[84:87],v55 offset:7168
v_add_u32 v123,s73,v55
ds_read_b128 v[88:91],v123 offset:8192
ds_read_b128 v[92:95],v123 offset:9216
v_xor_b32 v120,1024,v12
v_xor_b32 v121,2048,v12
v_xor_b32 v122,3072,v12
buffer_load_dwordx4 v[24:27],v13,s[8:11],s64 offen sc1
buffer_load_dwordx4 v[40:43],v13,s[8:11],s70 offen sc1
L_chain_151:
L_cpa_152:
buffer_load_dwordx4 v[24:27],v13,s[8:11],s64 offen sc1
buffer_load_dwordx4 v[40:43],v13,s[8:11],s70 offen sc1
s_sub_u32 s49,s49,1
s_cbranch_scc1 L_abort
s_waitcnt vmcnt(2)
v_max3_u32 v123,v24,v25,v26
v_max3_u32 v123,v27,v40,v123
v_max3_u32 v123,v41,v42,v123
v_max_u32 v123,v43,v123
v_cmp_le_u32 vcc,s72,v123
s_cbranch_vccnz L_cpa_152
ds_write_b128 v12,v[24:27] offset:0
ds_write_b128 v12,v[40:43] offset:4096
v_smfmac_f32_16x16x64_bf16 v[96:99],v[24:27],a[0:7],v2
buffer_store_dwordx4 v[124:127],v0,s[8:11],s54 offen sc1
v_smfmac_f32_16x16x64_bf16 v[100:103],v[24:27],a[128:135],v2
buffer_store_dword v54,v10,s[8:11],s30 offen sc1
s_add_u32 m0,s73,131072
s_add_u32 s57,s67,8192
v_smfmac_f32_16x16x64_bf16 v[104:107],v[24:27],a[8:15],v2
s_cmp_eq_u32 s76,0
v_smfmac_f32_16x16x64_bf16 v[108:111],v[24:27],a[136:143],v2
s_cbranch_scc1 L_ckw_144
L_ckb_145:
s_waitcnt lgkmcnt(0)
s_barrier
ds_read_b128 v[28:31],v120 offset:0
ds_read_b128 v[32:35],v121 offset:0
v_smfmac_f32_16x16x64_bf16 v[96:99],v[40:43],a[64:71],v2
ds_read_b128 v[36:39],v122 offset:0
v_smfmac_f32_16x16x64_bf16 v[100:103],v[40:43],a[192:199],v2
ds_read_b128 v[44:47],v120 offset:4096
v_smfmac_f32_16x16x64_bf16 v[104:107],v[40:43],a[72:79],v2
ds_read_b128 v[48:51],v121 offset:4096
v_smfmac_f32_16x16x64_bf16 v[108:111],v[40:43],a[200:207],v2
ds_read_b128 v[52:55],v122 offset:4096
v_smfmac_f32_16x16x64_bf16 v[112:115],v[24:27],v[128:135],v2
buffer_load_dwordx4 v0,s[8:11],s67 offen sc1 lds
v_smfmac_f32_16x16x64_bf16 v[116:119],v[24:27],v[136:143],v2
v_smfmac_f32_16x16x64_bf16 v[112:115],v[40:43],v[192:199],v2
buffer_load_dwordx4 v0,s[8:11],s67 offen offset:1024 sc1 lds
v_smfmac_f32_16x16x64_bf16 v[116:119],v[40:43],v[200:207],v2
s_waitcnt lgkmcnt(5)
v_smfmac_f32_16x16x64_bf16 v[96:99],v[28:31],a[16:23],v2
s_add_u32 m0,s73,139264
v_smfmac_f32_16x16x64_bf16 v[100:103],v[28:31],a[144:151],v2
buffer_load_dwordx4 v0,s[8:11],s57 offen sc1 lds
v_smfmac_f32_16x16x64_bf16 v[104:107],v[28:31],a[24:31],v2
s_add_u32 s67,s67,786432
v_smfmac_f32_16x16x64_bf16 v[108:111],v[28:31],a[152:159],v2
s_waitcnt lgkmcnt(4)
v_smfmac_f32_16x16x64_bf16 v[96:99],v[32:35],a[32:39],v2
buffer_load_dwordx4 v0,s[8:11],s57 offen offset:1024 sc1 lds
v_smfmac_f32_16x16x64_bf16 v[100:103],v[32:35],a[160:167],v2
v_smfmac_f32_16x16x64_bf16 v[104:107],v[32:35],a[40:47],v2
v_smfmac_f32_16x16x64_bf16 v[108:111],v[32:35],a[168:175],v2
buffer_load_dword v23,v22,s[8:11],s75 offen sc1
s_waitcnt lgkmcnt(3)
v_smfmac_f32_16x16x64_bf16 v[96:99],v[36:39],a[48:55],v2
v_mov_b32 v125,0
v_smfmac_f32_16x16x64_bf16 v[100:103],v[36:39],a[176:183],v2
v_smfmac_f32_16x16x64_bf16 v[104:107],v[36:39],a[56:63],v2
buffer_store_dword v2,off,s[8:11],s78 sc1
v_smfmac_f32_16x16x64_bf16 v[108:111],v[36:39],a[184:191],v2
s_waitcnt lgkmcnt(0)
v_smfmac_f32_16x16x64_bf16 v[96:99],v[44:47],a[80:87],v2
v_smfmac_f32_16x16x64_bf16 v[100:103],v[44:47],a[208:215],v2
v_smfmac_f32_16x16x64_bf16 v[96:99],v[48:51],a[96:103],v2
v_smfmac_f32_16x16x64_bf16 v[100:103],v[48:51],a[224:231],v2
v_smfmac_f32_16x16x64_bf16 v[96:99],v[52:55],a[112:119],v2
v_smfmac_f32_16x16x64_bf16 v[100:103],v[52:55],a[240:247],v2
v_smfmac_f32_16x16x64_bf16 v[104:107],v[44:47],a[88:95],v2
v_smfmac_f32_16x16x64_bf16 v[108:111],v[44:47],a[216:223],v2
v_smfmac_f32_16x16x64_bf16 v[104:107],v[48:51],a[104:111],v2
v_add_f32 v96,v96,v98
v_smfmac_f32_16x16x64_bf16 v[108:111],v[48:51],a[232:239],v2
v_add_f32 v97,v97,v99
v_smfmac_f32_16x16x64_bf16 v[104:107],v[52:55],a[120:127],v2
v_cvt_pk_bf16_f32 v120,v96,v97
v_smfmac_f32_16x16x64_bf16 v[108:111],v[52:55],a[248:255],v2
v_add_f32 v100,v100,v102
v_smfmac_f32_16x16x64_bf16 v[112:115],v[28:31],v[144:151],v2
v_add_f32 v101,v101,v103
v_smfmac_f32_16x16x64_bf16 v[116:119],v[28:31],v[152:159],v2
v_cvt_pk_bf16_f32 v121,v100,v101
v_add_f32 v104,v104,v106
v_add_f32 v105,v105,v107
v_cvt_pk_bf16_f32 v122,v104,v105
v_add_f32 v108,v108,v110
v_add_f32 v109,v109,v111
v_cvt_pk_bf16_f32 v123,v108,v109
ds_write_b128 v4,v[120:123]
v_smfmac_f32_16x16x64_bf16 v[112:115],v[32:35],v[160:167],v2
v_smfmac_f32_16x16x64_bf16 v[116:119],v[32:35],v[168:175],v2
v_smfmac_f32_16x16x64_bf16 v[112:115],v[36:39],v[176:183],v2
v_smfmac_f32_16x16x64_bf16 v[116:119],v[36:39],v[184:191],v2
s_waitcnt vmcnt(8) lgkmcnt(0)
s_barrier
ds_read_b64_tr_b16 v[96:97],v5 offset:0
ds_read_b64_tr_b16 v[98:99],v6 offset:0
v_smfmac_f32_16x16x64_bf16 v[112:115],v[44:47],v[208:215],v2
ds_read_b64_tr_b16 v[100:101],v5 offset:1024
v_smfmac_f32_16x16x64_bf16 v[116:119],v[44:47],v[216:223],v2
ds_read_b64_tr_b16 v[102:103],v6 offset:1024
v_smfmac_f32_16x16x64_bf16 v[112:115],v[48:51],v[224:231],v2
ds_read_b64_tr_b16 v[104:105],v5 offset:2048
v_smfmac_f32_16x16x64_bf16 v[116:119],v[48:51],v[232:239],v2
ds_read_b64_tr_b16 v[106:107],v6 offset:2048
s_waitcnt lgkmcnt(4)
v_mfma_f32_16x16x32_bf16 v[24:27],v[56:59],v[96:99],0
ds_read_b64_tr_b16 v[108:109],v5 offset:3072
v_mfma_f32_16x16x32_bf16 v[28:31],v[60:63],v[96:99],0
ds_read_b64_tr_b16 v[110:111],v6 offset:3072
v_mfma_f32_16x16x32_bf16 v[32:35],v[96:99],v[96:99],0
ds_read_b128 v[40:43],v11 offset:12288
s_waitcnt lgkmcnt(5)
v_mfma_f32_16x16x32_bf16 v[24:27],v[64:67],v[100:103],v[24:27]
ds_read_b128 v[56:59],v11 offset:0
v_mfma_f32_16x16x32_bf16 v[28:31],v[68:71],v[100:103],v[28:31]
ds_read_b128 v[60:63],v11 offset:1024
v_mfma_f32_16x16x32_bf16 v[32:35],v[100:103],v[100:103],v[32:35]
ds_read_b128 v[96:99],v11 offset:8192
s_waitcnt lgkmcnt(6)
v_mfma_f32_16x16x32_bf16 v[24:27],v[72:75],v[104:107],v[24:27]
ds_read_b128 v[64:67],v11 offset:2048
v_mfma_f32_16x16x32_bf16 v[28:31],v[76:79],v[104:107],v[28:31]
ds_read_b128 v[68:71],v11 offset:3072
v_mfma_f32_16x16x32_bf16 v[32:35],v[104:107],v[104:107],v[32:35]
ds_read_b128 v[100:103],v11 offset:9216
s_waitcnt lgkmcnt(7)
v_mfma_f32_16x16x32_bf16 v[24:27],v[80:83],v[108:111],v[24:27]
ds_read_b128 v[72:75],v11 offset:4096
v_mfma_f32_16x16x32_bf16 v[28:31],v[84:87],v[108:111],v[28:31]
ds_read_b128 v[76:79],v11 offset:5120
v_mfma_f32_16x16x32_bf16 v[32:35],v[108:111],v[108:111],v[32:35]
ds_read_b128 v[104:107],v11 offset:10240
v_smfmac_f32_16x16x64_bf16 v[112:115],v[52:55],v[240:247],v2
ds_read_b128 v[80:83],v11 offset:6144
v_smfmac_f32_16x16x64_bf16 v[116:119],v[52:55],v[248:255],v2
ds_read_b128 v[84:87],v11 offset:7168
v_max3_f32 v126,v24,v25,v26
v_max3_f32 v127,v27,v28,v29
v_max3_f32 v126,v30,v31,v126
v_max3_f32 v127,v34,v35,v127
v_max_f32 v126,v126,v127
v_max_f32 v127,v126,v127
v_pk_mul_f32 v[34:35],v[34:35],v[0:1] op_sel:[0,1]
v_pk_mul_f32 v[24:25],v[24:25],v[0:1] op_sel:[0,1]
v_permlane16_swap_b32 v126,v127
v_max_f32 v126,v126,v127
v_max_f32 v127,v126,v127
v_pk_mul_f32 v[26:27],v[26:27],v[0:1] op_sel:[0,1]
v_pk_mul_f32 v[28:29],v[28:29],v[0:1] op_sel:[0,1]
v_permlane32_swap_b32 v126,v127
v_max_f32 v126,v126,v127
v_mul_f32 v126,v1,v126
v_pk_mul_f32 v[30:31],v[30:31],v[0:1] op_sel:[0,1]
v_pk_add_f32 v[34:35],v[34:35],v[126:127] op_sel_hi:[1,0] neg_lo:[0,1] neg_hi:[0,1]
v_pk_add_f32 v[112:113],v[112:113],v[114:115]
v_pk_add_f32 v[116:117],v[116:117],v[118:119]
v_pk_add_f32 v[24:25],v[24:25],v[126:127] op_sel_hi:[1,0] neg_lo:[0,1] neg_hi:[0,1]
v_pk_add_f32 v[26:27],v[26:27],v[126:127] op_sel_hi:[1,0] neg_lo:[0,1] neg_hi:[0,1]
v_pk_add_f32 v[28:29],v[28:29],v[126:127] op_sel_hi:[1,0] neg_lo:[0,1] neg_hi:[0,1]
v_pk_add_f32 v[30:31],v[30:31],v[126:127] op_sel_hi:[1,0] neg_lo:[0,1] neg_hi:[0,1]
v_exp_f32 v34,v34
v_exp_f32 v35,v35
v_cvt_pk_bf16_f32 v126,v112,v113
v_cvt_pk_bf16_f32 v124,v34,v35
v_cvt_pk_bf16_f32 v127,v116,v117
v_cvt_pk_bf16_f32 v36,v116,v117
v_mfma_f32_16x16x16_bf16 v[32:35],v[14:15],v[124:125],0
ds_read_b128 v[108:111],v11 offset:11264
v_exp_f32 v24,v24
v_mfma_f32_16x16x16_bf16 v[112:115],v[126:127],v[124:125],0
ds_read_b128 v[44:47],v11 offset:13312
v_exp_f32 v25,v25
v_mfma_f32_16x16x16_bf16 v[116:119],v[36:37],v[124:125],0
ds_read_b128 v[48:51],v11 offset:14336
v_exp_f32 v26,v26
v_exp_f32 v27,v27
v_cvt_pk_bf16_f32 v120,v24,v25
v_exp_f32 v28,v28
v_exp_f32 v29,v29
v_cvt_pk_bf16_f32 v121,v26,v27
v_exp_f32 v30,v30
v_exp_f32 v31,v31
v_cvt_pk_bf16_f32 v122,v28,v29
v_cvt_pk_bf16_f32 v123,v30,v31
s_mov_b32 s78,s55
s_add_u32 s55,s79,s75
v_mfma_f32_16x16x32_bf16 v[32:35],v[14:17],v[120:123],v[32:35]
ds_read_b128 v[52:55],v11 offset:15360
v_mfma_f32_16x16x32_bf16 v[112:115],v[88:91],v[120:123],v[112:115]
ds_read_b128 v[88:91],v11 offset:16384
v_mfma_f32_16x16x32_bf16 v[116:119],v[92:95],v[120:123],v[116:119]
ds_read_b128 v[92:95],v11 offset:17408
v_rcp_f32 v32,v32
v_mov_b64 v[24:25],-1
v_mov_b64 v[26:27],-1
s_mov_b32 s54,s68
s_add_u32 s75,s75,8192
v_pk_mul_f32 v[112:113],v[112:113],v[32:33] op_sel_hi:[1,0]
v_pk_mul_f32 v[114:115],v[114:115],v[32:33] op_sel_hi:[1,0]
v_pk_mul_f32 v[116:117],v[116:117],v[32:33] op_sel_hi:[1,0]
v_pk_mul_f32 v[118:119],v[118:119],v[32:33] op_sel_hi:[1,0]
v_cvt_pk_bf16_f32 v120,v112,v116
v_cvt_pk_bf16_f32 v121,v113,v117
v_cvt_pk_bf16_f32 v122,v114,v118
v_cvt_pk_bf16_f32 v123,v115,v119
ds_write_b128 v7,v[120:123]
buffer_store_dwordx4 v[24:27],v0,s[8:11],s69 offen
buffer_store_dwordx4 v[24:27],v0,s[8:11],s69 offen offset:1024
s_waitcnt lgkmcnt(0)
s_barrier
ds_read_b128 v[24:27],v8 offset:0
ds_read_b128 v[28:31],v8 offset:512
ds_read_b128 v[32:35],v8 offset:1024
ds_read_b128 v[36:39],v8 offset:1536
v_mov_b64 v[112:113],0
v_mov_b64 v[114:115],0
v_mov_b64 v[116:117],0
v_mov_b64 v[118:119],0
v_mov_b64 v[120:121],0
v_mov_b64 v[122:123],0
s_add_u32 s30,s75,17825792
s_add_u32 s64,s75,12582912
s_add_u32 s70,s64,4096
s_add_u32 s68,s68,131072
s_add_u32 s51,s51,1
s_cmp_eq_u32 s51,64
s_cbranch_scc1 L_cend_154
s_waitcnt lgkmcnt(3)
v_smfmac_f32_16x16x64_bf16 v[112:115],v[24:27],v[56:63],v3
ds_read_b128 v[56:59],v11 offset:18432
s_add_u32 s57,s65,65536
s_waitcnt lgkmcnt(3)
v_smfmac_f32_16x16x64_bf16 v[112:115],v[28:31],v[64:71],v3
ds_read_b128 v[60:63],v11 offset:19456
s_add_u32 s58,s65,131072
s_waitcnt lgkmcnt(3)
v_smfmac_f32_16x16x64_bf16 v[112:115],v[32:35],v[72:79],v3
ds_read_b128 v[64:67],v11 offset:20480
s_add_u32 s59,s65,196608
s_waitcnt lgkmcnt(3)
v_smfmac_f32_16x16x64_bf16 v[112:115],v[36:39],v[80:87],v3
ds_read_b128 v[68:71],v11 offset:21504
v_smfmac_f32_16x16x64_bf16 v[116:119],v[24:27],v[96:103],v3
ds_read_b128 v[72:75],v11 offset:22528
v_smfmac_f32_16x16x64_bf16 v[116:119],v[28:31],v[104:111],v3
ds_read_b128 v[76:79],v11 offset:23552
v_cvt_pk_bf16_f32 v112,v112,v113
v_smfmac_f32_16x16x64_bf16 v[116:119],v[32:35],v[40:47],v3
ds_read_b128 v[80:83],v11 offset:24576
v_cvt_pk_bf16_f32 v113,v114,v115
buffer_store_dwordx2 v[112:113],v9,s[8:11],s65 offen
v_smfmac_f32_16x16x64_bf16 v[116:119],v[36:39],v[48:55],v3
ds_read_b128 v[84:87],v11 offset:25600
v_mov_b64 v[112:113],0
v_smfmac_f32_16x16x64_bf16 v[120:123],v[24:27],v[88:95],v3
ds_read_b128 v[96:99],v11 offset:26624
ds_read_b128 v[100:103],v11 offset:27648
v_mov_b64 v[114:115],0
s_waitcnt lgkmcnt(8)
v_smfmac_f32_16x16x64_bf16 v[120:123],v[28:31],v[56:63],v3
ds_read_b128 v[104:107],v11 offset:28672
v_cvt_pk_bf16_f32 v116,v116,v117
s_waitcnt lgkmcnt(7)
v_smfmac_f32_16x16x64_bf16 v[120:123],v[32:35],v[64:71],v3
ds_read_b128 v[108:111],v11 offset:29696
ds_read_b128 v[40:43],v11 offset:30720
v_cvt_pk_bf16_f32 v117,v118,v119
buffer_store_dwordx2 v[116:117],v9,s[8:11],s57 offen
s_waitcnt lgkmcnt(7)
v_smfmac_f32_16x16x64_bf16 v[120:123],v[36:39],v[72:79],v3
ds_read_b128 v[44:47],v11 offset:31744
s_waitcnt lgkmcnt(6)
v_smfmac_f32_16x16x64_bf16 v[112:115],v[24:27],v[80:87],v3
s_waitcnt lgkmcnt(4)
v_smfmac_f32_16x16x64_bf16 v[112:115],v[28:31],v[96:103],v3
v_cvt_pk_bf16_f32 v120,v120,v121
s_waitcnt lgkmcnt(2)
v_smfmac_f32_16x16x64_bf16 v[112:115],v[32:35],v[104:111],v3
v_cvt_pk_bf16_f32 v121,v122,v123
buffer_store_dwordx2 v[120:121],v9,s[8:11],s58 offen
s_waitcnt lgkmcnt(0)
v_smfmac_f32_16x16x64_bf16 v[112:115],v[36:39],v[40:47],v3
v_mov_b64 v[116:117],0
v_mov_b64 v[118:119],0
s_xor_b32 s65,s65,262144
v_add_u32 v52,s50,v5
v_add_u32 v54,s50,v6
v_mov_b32_dpp v124,v126 quad_perm:[2,3,2,3] row_mask:0xf bank_mask:0xf
v_mov_b32_dpp v125,v127 quad_perm:[2,3,2,3] row_mask:0xf bank_mask:0xf
s_nop 0
v_cvt_pk_bf16_f32 v112,v112,v113
v_cvt_pk_bf16_f32 v113,v114,v115
buffer_store_dwordx2 v[112:113],v9,s[8:11],s59 offen
ds_read_b64_tr_b16 v[52:53],v52
ds_read_b64_tr_b16 v[54:55],v54
s_mov_b32 vcc_lo,0xcccccccc
s_mov_b32 vcc_hi,0xcccccccc
v_mov_b64 v[96:97],0
v_mov_b64 v[98:99],0
v_mov_b64 v[100:101],0
v_mov_b64 v[102:103],0
v_mov_b64 v[104:105],0
v_mov_b64 v[106:107],0
v_mov_b64 v[108:109],0
v_mov_b64 v[110:111],0
v_mov_b64 v[112:113],0
v_mov_b64 v[114:115],0
s_waitcnt lgkmcnt(0)
v_cndmask_b32 v124,v124,v52,vcc
v_cndmask_b32 v125,v125,v53,vcc
v_cndmask_b32 v126,v126,v54,vcc
v_cndmask_b32 v127,v127,v55,vcc
v_add_u32 v55,131072,v0
v_add_u32 v123,s73,v55
v_xor_b32 v120,1024,v12
v_xor_b32 v121,2048,v12
v_xor_b32 v122,3072,v12
s_waitcnt vmcnt(0)
buffer_load_dwordx4 v[32:35],v0,s[8:11],s66 offen offset:0 sc1
buffer_load_dwordx4 v[36:39],v0,s[8:11],s66 offen offset:1024 sc1
v_readlane_b32 s76,v23,4
s_cmp_ge_u32 s51,63
s_cselect_b32 s76,1,s76
s_or_b32 s76,s76,s46
s_waitcnt vmcnt(1)
v_mfma_f32_16x16x32_bf16 v[28:31],v[18:21],v[32:35],0
s_waitcnt vmcnt(0)
v_mfma_f32_16x16x32_bf16 v[28:31],v[18:21],v[36:39],v[28:31]
s_nop 7
v_cmp_u_f32 vcc,v28,v28
v_add_f32_dpp v52,v28,v28 row_ror:8 row_mask:0xf bank_mask:0x3
v_add_f32_dpp v53,v29,v29 row_ror:8 row_mask:0xf bank_mask:0x3
v_add_f32_dpp v52,v30,v30 row_ror:8 row_mask:0xf bank_mask:0xc
v_add_f32_dpp v53,v31,v31 row_ror:8 row_mask:0xf bank_mask:0xc
s_nop 0
v_add_f32_dpp v52,v52,v52 row_shl:4 row_mask:0xf bank_mask:0x5
v_add_f32_dpp v53,v53,v53 row_shl:4 row_mask:0xf bank_mask:0x5
s_cbranch_vccnz L_crp_156
L_cok_161:
v_cvt_pk_bf16_f32 v54,v52,v53
buffer_store_dword v54,v10,s[8:11],s64 offen
s_mov_b32 s69,s66
s_xor_b32 s66,s66,262144
s_barrier
ds_read_b128 v[56:59],v55 offset:0
ds_read_b128 v[60:63],v55 offset:4096
buffer_load_dwordx4 v[24:27],v13,s[8:11],s64 offen sc1
buffer_load_dwordx4 v[40:43],v13,s[8:11],s70 offen sc1
ds_read_b128 v[64:67],v55 offset:1024
ds_read_b128 v[68:71],v55 offset:5120
ds_read_b128 v[72:75],v55 offset:2048
ds_read_b128 v[76:79],v55 offset:6144
ds_read_b128 v[80:83],v55 offset:3072
ds_read_b128 v[84:87],v55 offset:7168
ds_read_b128 v[88:91],v123 offset:8192
ds_read_b128 v[92:95],v123 offset:9216
s_branch L_chain_151
L_crp_156:
buffer_load_dwordx4 v[32:35],v0,s[8:11],s66 offen offset:0 sc1
buffer_load_dwordx4 v[36:39],v0,s[8:11],s66 offen offset:1024 sc1
s_sub_u32 s49,s49,1
s_cbranch_scc1 L_abort
s_waitcnt vmcnt(1)
v_mfma_f32_16x16x32_bf16 v[28:31],v[18:21],v[32:35],0
s_waitcnt vmcnt(0)
v_mfma_f32_16x16x32_bf16 v[28:31],v[18:21],v[36:39],v[28:31]
s_nop 7
v_cmp_u_f32 vcc,v28,v28
v_add_f32_dpp v52,v28,v28 row_ror:8 row_mask:0xf bank_mask:0x3
v_add_f32_dpp v53,v29,v29 row_ror:8 row_mask:0xf bank_mask:0x3
v_add_f32_dpp v52,v30,v30 row_ror:8 row_mask:0xf bank_mask:0xc
v_add_f32_dpp v53,v31,v31 row_ror:8 row_mask:0xf bank_mask:0xc
s_nop 0
v_add_f32_dpp v52,v52,v52 row_shl:4 row_mask:0xf bank_mask:0x5
v_add_f32_dpp v53,v53,v53 row_shl:4 row_mask:0xf bank_mask:0x5
s_cbranch_vccz L_cok_161
s_branch L_crp_156
L_ckw_144:
s_lshl2_add_u32 s59,s47,s75
s_add_u32 s59,s59,10494080
L_ww_162:
s_sleep 1
buffer_load_dword v23,off,s[8:11],s59 sc1
s_sub_u32 s49,s49,1
s_cbranch_scc1 L_abort
s_waitcnt vmcnt(0)
v_readfirstlane_b32 s76,v23
s_cmp_eq_u32 s76,0
s_cbranch_scc1 L_ww_162
L_wwd_163:
s_branch L_ckb_145
L_cend_154:
v_add_u32 v52,s50,v5
v_add_u32 v54,s50,v6
ds_read_b64_tr_b16 v[52:53],v52
ds_read_b64_tr_b16 v[54:55],v54
v_mov_b32_dpp v124,v126 quad_perm:[2,3,2,3] row_mask:0xf bank_mask:0xf
v_mov_b32_dpp v125,v127 quad_perm:[2,3,2,3] row_mask:0xf bank_mask:0xf
s_mov_b32 vcc_lo,0xcccccccc
s_mov_b32 vcc_hi,0xcccccccc
s_waitcnt lgkmcnt(0)
v_cndmask_b32 v124,v124,v52,vcc
v_cndmask_b32 v125,v125,v53,vcc
v_cndmask_b32 v126,v126,v54,vcc
v_cndmask_b32 v127,v127,v55,vcc
buffer_store_dwordx4 v[124:127],v0,s[8:11],s54 offen sc1
s_waitcnt vmcnt(0)
s_barrier
buffer_store_dword v2,off,s[8:11],s78 sc1
buffer_store_dword v2,off,s[8:11],s55 sc1
s_nop 11
v_lshrrev_b32 v1,4,v0
s_endpgm
L_rc2_121:
v_and_b32 v120,15,v1
v_lshrrev_b32 v121,4,v1
v_and_b32 v122,2,v1
v_cmp_eq_u32 vcc,0,v122
v_mov_b32 v2,0xeeee
v_mov_b32 v123,0x4444
v_cndmask_b32 v2,v2,v123,vcc
v_and_b32 v122,1,v1
v_cmp_eq_u32 vcc,0,v122
v_mov_b32 v3,0xdddd
v_mov_b32 v123,0x8888
v_cndmask_b32 v3,v3,v123,vcc
v_lshrrev_b32 v122,1,v120
v_bfe_u32 v123,v120,2,1
v_xor_b32 v123,v123,v122
v_lshlrev_b32 v4,7,v123
v_and_b32 v123,1,v120
v_lshl_add_u32 v4,v123,6,v4
v_xor_b32 v123,v121,v122
v_and_b32 v123,3,v123
v_lshl_add_u32 v4,v123,4,v4
s_lshl_b32 s56,s46,10
s_add_u32 s56,s56,147456
v_add_u32 v4,s56,v4
v_lshlrev_b32 v122,1,v121
v_add_u32 v122,0,v122
v_and_b32 v123,1,v121
v_xor_b32 v123,v123,v122
v_lshlrev_b32 v5,7,v123
v_bfe_u32 v123,v120,3,1
v_lshl_add_u32 v5,v123,6,v5
v_xor_b32 v123,v120,v122
v_and_b32 v123,3,v123
v_lshl_add_u32 v5,v123,4,v5
v_bfe_u32 v123,v120,2,1
v_lshl_add_u32 v5,v123,3,v5
v_add_u32 v5,147456,v5
v_lshlrev_b32 v122,1,v121
v_add_u32 v122,1,v122
v_and_b32 v123,1,v121
v_xor_b32 v123,v123,v122
v_lshlrev_b32 v6,7,v123
v_bfe_u32 v123,v120,3,1
v_lshl_add_u32 v6,v123,6,v6
v_xor_b32 v123,v120,v122
v_and_b32 v123,3,v123
v_lshl_add_u32 v6,v123,4,v6
v_bfe_u32 v123,v120,2,1
v_lshl_add_u32 v6,v123,3,v6
v_add_u32 v6,147456,v6
v_lshlrev_b32 v7,7,v121
v_lshrrev_b32 v122,1,v120
v_lshl_add_u32 v8,v122,4,v7
v_add_u32 v8,151552,v8
v_lshrrev_b32 v122,2,v120
v_lshl_add_u32 v7,v122,5,v7
v_and_b32 v122,1,v120
v_lshl_add_u32 v7,v122,4,v7
v_and_b32 v122,2,v120
v_cmp_eq_u32 vcc,0,v122
s_lshl_b32 s56,s46,9
v_mov_b32 v122,2048
v_mov_b32 v123,s56
v_cndmask_b32 v122,v122,v123,vcc
v_add_u32 v7,v122,v7
v_add_u32 v7,151552,v7
v_lshrrev_b32 v122,3,v1
v_lshlrev_b32 v9,11,v122
v_and_b32 v122,7,v1
v_lshl_add_u32 v9,v122,3,v9
s_lshl_b32 s56,s46,14
s_lshl_b32 s57,s47,6
s_add_u32 s56,s56,s57
v_add_u32 v9,s56,v9
s_lshl_b32 s71,s47,2
s_add_u32 s71,s71,s46
s_bfe_u32 s56,s71,0x10003
s_lshl_b32 s56,s56,11
s_and_b32 s57,s71,1
s_lshl_b32 s57,s57,10
s_add_u32 s56,s56,s57
s_bfe_u32 s57,s71,0x10002
s_lshl_b32 s57,s57,9
s_add_u32 s56,s56,s57
s_bfe_u32 s57,s71,0x10001
s_lshl_b32 s57,s57,6
s_add_u32 s56,s56,s57
s_bfe_u32 s57,s71,0x10004
s_lshl_b32 s57,s57,8
s_add_u32 s56,s56,s57
s_bfe_u32 s57,s71,0x10005
s_lshl_b32 s57,s57,7
s_add_u32 s56,s56,s57
s_bfe_u32 s57,s71,0x10006
s_lshl_b32 s57,s57,12
s_add_u32 s56,s56,s57
v_and_b32 v122,3,v120
v_lshlrev_b32 v10,2,v122
v_bfe_u32 v122,v120,3,1
v_lshl_add_u32 v10,v122,4,v10
v_and_b32 v122,1,v121
v_lshl_add_u32 v10,v122,5,v10
v_add_u32 v10,s56,v10
v_and_b32 v123,36,v1
v_mov_b32 v122,0x80000000
v_cmp_eq_u32 vcc,0,v123
s_nop 1
v_cndmask_b32 v10,v122,v10,vcc
s_lshl_b32 s56,s46,15
v_add_u32 v11,s56,v0
s_lshl_b32 s71,s71,11
s_lshl_b32 s73,s46,11
s_mov_b32 s72,0xffc00000
s_mov_b32 s74,0
v_lshrrev_b32 v13,3,v1
v_lshlrev_b32 v13,9,v13
v_and_b32 v122,7,v1
v_lshl_add_u32 v13,v122,4,v13
v_and_b32 v122,15,v1
v_and_b32 v123,1,v1
v_lshlrev_b32 v123,4,v123
v_mov_b32 v124,0x3f80
v_lshlrev_b32 v124,v123,v124
v_lshrrev_b32 v122,1,v122
v_cmp_eq_u32 vcc,0,v122
s_nop 1
v_cndmask_b32 v18,0,v124,vcc
v_cmp_eq_u32 vcc,1,v122
s_nop 1
v_cndmask_b32 v19,0,v124,vcc
v_cmp_eq_u32 vcc,2,v122
s_nop 1
v_cndmask_b32 v20,0,v124,vcc
v_cmp_eq_u32 vcc,3,v122
s_nop 1
v_cndmask_b32 v21,0,v124,vcc
s_and_b32 s56,s46,1
s_lshl_b32 s56,s56,8
s_and_b32 s57,s46,2
s_lshl_b32 s57,s57,6
s_add_u32 s56,s56,s57
v_add_u32 v13,s56,v13
s_add_u32 s56,s50,155648
v_add_u32 v12,s56,v0
v_mov_b64 v[14:15],s[28:29]
v_mov_b64 v[16:17],s[28:29]
v_add_u32 v22,13647872,v10
s_lshl_b32 s56,s47,2
s_add_u32 s56,s56,10502272
s_or_b32 s56,s56,s52
v_writelane_b32 v22,s56,4
v_mov_b32 v1,s80
s_mov_b32 s65,16777216
s_add_u32 s66,s71,16777216
s_add_u32 s69,s71,17039360
s_lshl_b32 s79,s47,2
s_add_u32 s79,s79,10486400
s_cmp_eq_u32 s46,0
s_cselect_b32 s79,s79,0x80000000
s_mov_b32 s30,0x40000000
s_mov_b32 s51,0
v_lshrrev_b32 v120,2,v0
v_add_u32 v120,10510464,v120
v_or_b32 v120,s52,v120
s_mov_b64 vcc,-1
s_mov_b32 vcc_lo,0
v_cndmask_b32 v22,v22,v120,vcc
s_mov_b32 s30,0
s_mov_b32 s31,0
L_cst_164:
s_cmp_lg_u32 s46,0
s_cbranch_scc1 L_csw_169
s_lshl_b32 s59,s31,13
s_add_u32 s59,s59,10486016
v_lshrrev_b32 v121,2,v0
v_and_b32 v121,127,v121
L_ckk_170:
s_sleep 1
buffer_load_dword v120,v121,s[8:11],s59 offen sc1
s_sub_u32 s49,s49,1
s_cbranch_scc1 L_abort
s_waitcnt vmcnt(0)
v_cmp_eq_u32 vcc,0,v120
s_cbranch_vccnz L_ckk_170
v_max_u32_dpp v120,v120,v120 row_ror:8 row_mask:0xf bank_mask:0xf
s_nop 1
v_max_u32_dpp v120,v120,v120 row_ror:4 row_mask:0xf bank_mask:0xf
s_nop 1
v_max_u32_dpp v120,v120,v120 row_ror:2 row_mask:0xf bank_mask:0xf
s_nop 1
v_max_u32_dpp v120,v120,v120 row_ror:1 row_mask:0xf bank_mask:0xf
v_mov_b32 v121,v120
s_nop 1
v_permlane16_swap_b32 v120,v121
v_max_u32 v120,v120,v121
v_mov_b32 v121,v120
s_nop 1
v_permlane32_swap_b32 v120,v121
v_max_u32 v120,v120,v121
s_nop 0
v_readfirstlane_b32 s61,v120
s_max_u32 s30,s30,s61
s_add_u32 s31,s31,1
s_andn2_b32 s51,0x7ff,s30
s_lshr_b32 s51,s51,5
s_add_u32 s61,s51,2
s_min_u32 s61,s61,63
s_cmp_le_u32 s31,s61
s_cbranch_scc1 L_cst_164
v_mov_b32 v120,0
v_mov_b32 v121,s30
ds_write_b32 v8,v120 offset:2560
ds_write_b32 v8,v121 offset:3072
s_lshl_b32 s59,s51,13
s_lshl2_add_u32 s59,s47,s59
s_add_u32 s59,s59,10485888
L_ww_171:
s_sleep 1
buffer_load_dword v122,off,s[8:11],s59 sc1
s_sub_u32 s49,s49,1
s_cbranch_scc1 L_abort
s_waitcnt vmcnt(0)
v_readfirstlane_b32 s61,v122
s_cmp_eq_u32 s61,0
s_cbranch_scc1 L_ww_171
L_wwd_172:
L_csw_169:
s_waitcnt lgkmcnt(0)
s_barrier
ds_read_b32 v120,v8 offset:3072
s_waitcnt lgkmcnt(0)
v_readfirstlane_b32 s30,v120
s_andn2_b32 s51,0x7ff,s30
s_lshr_b32 s51,s51,5
s_lshl_b32 s56,s51,5
s_add_u32 s56,s56,s47
s_mul_i32 s56,s56,24576
s_add_u32 s56,s56,150994944
s_add_u32 s67,s56,s73
s_add_u32 m0,s73,131072
s_add_u32 s57,s67,8192
buffer_load_dwordx4 v0,s[8:11],s67 offen sc1 lds
buffer_load_dwordx4 v0,s[8:11],s67 offen offset:1024 sc1 lds
s_add_u32 m0,s73,139264
s_add_u32 s67,s67,786432
buffer_load_dwordx4 v0,s[8:11],s57 offen sc1 lds
buffer_load_dwordx4 v0,s[8:11],s57 offen offset:1024 sc1 lds
s_lshl_b32 s75,s51,13
s_add_u32 s64,s75,17825792
s_add_u32 s70,s64,4096
s_lshl_b32 s68,s51,5
s_add_u32 s68,s68,s47
s_lshl_b32 s68,s68,12
s_lshl_b32 s56,s46,10
s_add_u32 s68,s68,s56
s_add_u32 s68,s68,75497472
s_mov_b32 s78,0x80000000
s_mov_b32 s55,0x80000000
s_mov_b32 s54,0x80000000
s_mov_b32 s77,0
s_cmp_eq_u32 s51,63
s_cselect_b32 s76,1,s46
v_mov_b64 v[96:97],0
v_mov_b64 v[98:99],0
v_mov_b64 v[100:101],0
v_mov_b64 v[102:103],0
v_mov_b64 v[104:105],0
v_mov_b64 v[106:107],0
v_mov_b64 v[108:109],0
v_mov_b64 v[110:111],0
v_mov_b64 v[112:113],0
v_mov_b64 v[114:115],0
v_mov_b64 v[116:117],0
v_mov_b64 v[118:119],0
v_lshrrev_b32 v56,8,v0
v_lshlrev_b32 v56,5,v56
v_bfe_u32 v57,v0,5,1
v_lshl_add_u32 v56,v57,2,v56
s_lshl_b32 s56,s46,7
s_add_u32 s56,s56,155648
v_add_u32 v56,s56,v56
v_xor_b32 v57,128,v56
v_xor_b32 v58,256,v56
v_xor_b32 v59,384,v56
s_andn2_b32 s56,31,s30
s_lshr_b32 s57,s56,4
s_lshl_b32 s58,s57,12
s_and_b32 s59,s56,15
s_lshl4_add_u32 s58,s59,s58
s_add_u32 s58,s58,s50
s_add_u32 s58,s58,131072
v_bfe_u32 v60,v0,6,2
v_lshlrev_b32 v60,8,v60
v_bfe_u32 v61,v0,4,2
v_lshl_add_u32 v60,v61,2,v60
v_add_u32 v60,s58,v60
s_lshr_b32 s58,s59,2
s_lshl_b32 s58,s58,8
s_lshl3_add_u32 s58,s57,s58
s_and_b32 s59,s56,3
s_lshl1_add_u32 s58,s59,s58
s_add_u32 s58,s58,s73
s_add_u32 s58,s58,139264
v_and_b32 v61,255,v0
v_add_u32 v61,s58,v61
s_cmp_lg_u32 s46,0
s_cbranch_scc1 L_chd_174
s_lshl_b32 s59,s51,10
s_add_u32 s59,s59,11337728
L_chp_173:
buffer_load_dwordx4 v[120:123],v0,s[8:11],s59 offen sc1
s_sub_u32 s49,s49,1
s_cbranch_scc1 L_abort
s_waitcnt vmcnt(0)
v_max3_u32 v124,v120,v121,v122
v_max_u32 v124,v123,v124
v_cmp_eq_u32 vcc,-1,v124
s_cbranch_vccnz L_chp_173
ds_write_b128 v12,v[120:123]
L_chd_174:
s_waitcnt vmcnt(0) lgkmcnt(0)
s_barrier
ds_read2_b32 v[24:25],v56 offset0:0 offset1:2
ds_read2_b32 v[26:27],v56 offset0:4 offset1:6
ds_read2_b32 v[28:29],v57 offset0:0 offset1:2
ds_read2_b32 v[30:31],v57 offset0:4 offset1:6
ds_read2_b32 v[32:33],v58 offset0:0 offset1:2
ds_read2_b32 v[34:35],v58 offset0:4 offset1:6
ds_read2_b32 v[36:37],v59 offset0:0 offset1:2
ds_read2_b32 v[38:39],v59 offset0:4 offset1:6
s_waitcnt lgkmcnt(4)
ds_read2_b32 v[40:41],v56 offset0:128 offset1:130
ds_read2_b32 v[42:43],v56 offset0:132 offset1:134
ds_read2_b32 v[44:45],v57 offset0:128 offset1:130
ds_read2_b32 v[46:47],v57 offset0:132 offset1:134
ds_read2_b32 v[48:49],v58 offset0:128 offset1:130
ds_read2_b32 v[50:51],v58 offset0:132 offset1:134
ds_read2_b32 v[52:53],v59 offset0:128 offset1:130
ds_read2_b32 v[54:55],v59 offset0:132 offset1:134
s_waitcnt lgkmcnt(12)
v_smfmac_f32_16x16x64_bf16 v[100:103],v[24:27],a[128:135],v2
v_smfmac_f32_16x16x64_bf16 v[112:115],v[24:27],v[128:135],v2
v_smfmac_f32_16x16x64_bf16 v[108:111],v[24:27],a[136:143],v2
v_smfmac_f32_16x16x64_bf16 v[116:119],v[24:27],v[136:143],v2
s_waitcnt lgkmcnt(12)
v_smfmac_f32_16x16x64_bf16 v[100:103],v[28:31],a[144:151],v2
v_smfmac_f32_16x16x64_bf16 v[112:115],v[28:31],v[144:151],v2
v_smfmac_f32_16x16x64_bf16 v[108:111],v[28:31],a[152:159],v2
v_smfmac_f32_16x16x64_bf16 v[116:119],v[28:31],v[152:159],v2
s_waitcnt lgkmcnt(10)
v_smfmac_f32_16x16x64_bf16 v[100:103],v[32:35],a[160:167],v2
v_smfmac_f32_16x16x64_bf16 v[112:115],v[32:35],v[160:167],v2
v_smfmac_f32_16x16x64_bf16 v[108:111],v[32:35],a[168:175],v2
v_smfmac_f32_16x16x64_bf16 v[116:119],v[32:35],v[168:175],v2
s_waitcnt lgkmcnt(8)
v_smfmac_f32_16x16x64_bf16 v[100:103],v[36:39],a[176:183],v2
v_smfmac_f32_16x16x64_bf16 v[112:115],v[36:39],v[176:183],v2
v_smfmac_f32_16x16x64_bf16 v[108:111],v[36:39],a[184:191],v2
v_smfmac_f32_16x16x64_bf16 v[116:119],v[36:39],v[184:191],v2
s_waitcnt lgkmcnt(6)
v_smfmac_f32_16x16x64_bf16 v[100:103],v[40:43],a[192:199],v2
v_smfmac_f32_16x16x64_bf16 v[112:115],v[40:43],v[192:199],v2
v_smfmac_f32_16x16x64_bf16 v[108:111],v[40:43],a[200:207],v2
v_smfmac_f32_16x16x64_bf16 v[116:119],v[40:43],v[200:207],v2
s_waitcnt lgkmcnt(4)
v_smfmac_f32_16x16x64_bf16 v[100:103],v[44:47],a[208:215],v2
v_smfmac_f32_16x16x64_bf16 v[112:115],v[44:47],v[208:215],v2
v_smfmac_f32_16x16x64_bf16 v[108:111],v[44:47],a[216:223],v2
v_smfmac_f32_16x16x64_bf16 v[116:119],v[44:47],v[216:223],v2
s_waitcnt lgkmcnt(2)
v_smfmac_f32_16x16x64_bf16 v[100:103],v[48:51],a[224:231],v2
v_smfmac_f32_16x16x64_bf16 v[112:115],v[48:51],v[224:231],v2
v_smfmac_f32_16x16x64_bf16 v[108:111],v[48:51],a[232:239],v2
v_smfmac_f32_16x16x64_bf16 v[116:119],v[48:51],v[232:239],v2
s_waitcnt lgkmcnt(0)
v_smfmac_f32_16x16x64_bf16 v[100:103],v[52:55],a[240:247],v2
v_smfmac_f32_16x16x64_bf16 v[112:115],v[52:55],v[240:247],v2
v_smfmac_f32_16x16x64_bf16 v[108:111],v[52:55],a[248:255],v2
v_smfmac_f32_16x16x64_bf16 v[116:119],v[52:55],v[248:255],v2
v_add_f32 v100,v100,v102
v_add_f32 v112,v112,v114
s_nop 1
v_add_f32 v108,v108,v110
s_nop 2
v_add_f32 v116,v116,v118
v_cvt_pk_bf16_f32 v120,v100,v108
v_cvt_pk_bf16_f32 v121,v112,v116
ds_write_b32 v60,v120
ds_write_b16 v61,v121
ds_write_b16_d16_hi v61,v121 offset:1024
v_mov_b64 v[96:97],0
v_mov_b64 v[98:99],0
v_mov_b64 v[100:101],0
v_mov_b64 v[102:103],0
v_mov_b64 v[104:105],0
v_mov_b64 v[106:107],0
v_mov_b64 v[108:109],0
v_mov_b64 v[110:111],0
v_mov_b64 v[112:113],0
v_mov_b64 v[114:115],0
v_mov_b64 v[116:117],0
v_mov_b64 v[118:119],0
s_waitcnt vmcnt(0) lgkmcnt(0)
s_barrier
v_add_u32 v55,131072,v0
ds_read_b128 v[56:59],v55 offset:0
ds_read_b128 v[60:63],v55 offset:4096
ds_read_b128 v[64:67],v55 offset:1024
ds_read_b128 v[68:71],v55 offset:5120
ds_read_b128 v[72:75],v55 offset:2048
ds_read_b128 v[76:79],v55 offset:6144
ds_read_b128 v[80:83],v55 offset:3072
ds_read_b128 v[84:87],v55 offset:7168
v_add_u32 v123,s73,v55
ds_read_b128 v[88:91],v123 offset:8192
ds_read_b128 v[92:95],v123 offset:9216
v_xor_b32 v120,1024,v12
v_xor_b32 v121,2048,v12
v_xor_b32 v122,3072,v12
buffer_load_dwordx4 v[24:27],v13,s[8:11],s64 offen sc1
buffer_load_dwordx4 v[40:43],v13,s[8:11],s70 offen sc1
L_chain_175:
L_cpa_176:
buffer_load_dwordx4 v[24:27],v13,s[8:11],s64 offen sc1
buffer_load_dwordx4 v[40:43],v13,s[8:11],s70 offen sc1
s_sub_u32 s49,s49,1
s_cbranch_scc1 L_abort
s_waitcnt vmcnt(2)
v_max3_u32 v123,v24,v25,v26
v_max3_u32 v123,v27,v40,v123
v_max3_u32 v123,v41,v42,v123
v_max_u32 v123,v43,v123
v_cmp_le_u32 vcc,s72,v123
s_cbranch_vccnz L_cpa_176
ds_write_b128 v12,v[24:27] offset:0
ds_write_b128 v12,v[40:43] offset:4096
v_smfmac_f32_16x16x64_bf16 v[96:99],v[24:27],a[0:7],v2
buffer_store_dwordx4 v[124:127],v0,s[8:11],s54 offen sc1
v_smfmac_f32_16x16x64_bf16 v[100:103],v[24:27],a[128:135],v2
s_add_u32 m0,s73,131072
s_add_u32 s57,s67,8192
v_smfmac_f32_16x16x64_bf16 v[104:107],v[24:27],a[8:15],v2
s_cmp_eq_u32 s76,0
v_smfmac_f32_16x16x64_bf16 v[108:111],v[24:27],a[136:143],v2
s_cbranch_scc1 L_ckw_165
L_ckb_166:
s_waitcnt lgkmcnt(0)
s_barrier
ds_read_b32 v123,v8 offset:2560
ds_read_b128 v[28:31],v120 offset:0
ds_read_b128 v[32:35],v121 offset:0
v_smfmac_f32_16x16x64_bf16 v[96:99],v[40:43],a[64:71],v2
ds_read_b128 v[36:39],v122 offset:0
v_smfmac_f32_16x16x64_bf16 v[100:103],v[40:43],a[192:199],v2
ds_read_b128 v[44:47],v120 offset:4096
v_smfmac_f32_16x16x64_bf16 v[104:107],v[40:43],a[72:79],v2
ds_read_b128 v[48:51],v121 offset:4096
v_smfmac_f32_16x16x64_bf16 v[108:111],v[40:43],a[200:207],v2
ds_read_b128 v[52:55],v122 offset:4096
v_smfmac_f32_16x16x64_bf16 v[112:115],v[24:27],v[128:135],v2
buffer_load_dwordx4 v0,s[8:11],s67 offen sc1 lds
v_smfmac_f32_16x16x64_bf16 v[116:119],v[24:27],v[136:143],v2
v_smfmac_f32_16x16x64_bf16 v[112:115],v[40:43],v[192:199],v2
buffer_load_dwordx4 v0,s[8:11],s67 offen offset:1024 sc1 lds
v_smfmac_f32_16x16x64_bf16 v[116:119],v[40:43],v[200:207],v2
s_waitcnt lgkmcnt(5)
v_smfmac_f32_16x16x64_bf16 v[96:99],v[28:31],a[16:23],v2
s_add_u32 m0,s73,139264
v_smfmac_f32_16x16x64_bf16 v[100:103],v[28:31],a[144:151],v2
buffer_load_dwordx4 v0,s[8:11],s57 offen sc1 lds
v_smfmac_f32_16x16x64_bf16 v[104:107],v[28:31],a[24:31],v2
s_add_u32 s67,s67,786432
v_smfmac_f32_16x16x64_bf16 v[108:111],v[28:31],a[152:159],v2
v_readfirstlane_b32 s58,v123
s_waitcnt lgkmcnt(4)
v_smfmac_f32_16x16x64_bf16 v[96:99],v[32:35],a[32:39],v2
buffer_load_dwordx4 v0,s[8:11],s57 offen offset:1024 sc1 lds
v_smfmac_f32_16x16x64_bf16 v[100:103],v[32:35],a[160:167],v2
s_cmp_lg_u32 s58,0
s_cbranch_scc1 L_cjump_168
v_smfmac_f32_16x16x64_bf16 v[104:107],v[32:35],a[40:47],v2
v_smfmac_f32_16x16x64_bf16 v[108:111],v[32:35],a[168:175],v2
buffer_load_dword v23,v22,s[8:11],s75 offen sc1
s_waitcnt lgkmcnt(3)
v_smfmac_f32_16x16x64_bf16 v[96:99],v[36:39],a[48:55],v2
v_mov_b32 v125,0
v_smfmac_f32_16x16x64_bf16 v[100:103],v[36:39],a[176:183],v2
v_smfmac_f32_16x16x64_bf16 v[104:107],v[36:39],a[56:63],v2
buffer_store_dword v2,off,s[8:11],s78 sc1
v_smfmac_f32_16x16x64_bf16 v[108:111],v[36:39],a[184:191],v2
s_waitcnt lgkmcnt(0)
v_smfmac_f32_16x16x64_bf16 v[96:99],v[44:47],a[80:87],v2
v_smfmac_f32_16x16x64_bf16 v[100:103],v[44:47],a[208:215],v2
v_smfmac_f32_16x16x64_bf16 v[96:99],v[48:51],a[96:103],v2
v_smfmac_f32_16x16x64_bf16 v[100:103],v[48:51],a[224:231],v2
v_smfmac_f32_16x16x64_bf16 v[96:99],v[52:55],a[112:119],v2
v_smfmac_f32_16x16x64_bf16 v[100:103],v[52:55],a[240:247],v2
v_smfmac_f32_16x16x64_bf16 v[104:107],v[44:47],a[88:95],v2
v_smfmac_f32_16x16x64_bf16 v[108:111],v[44:47],a[216:223],v2
v_smfmac_f32_16x16x64_bf16 v[104:107],v[48:51],a[104:111],v2
v_add_f32 v96,v96,v98
v_smfmac_f32_16x16x64_bf16 v[108:111],v[48:51],a[232:239],v2
v_add_f32 v97,v97,v99
v_smfmac_f32_16x16x64_bf16 v[104:107],v[52:55],a[120:127],v2
v_cvt_pk_bf16_f32 v120,v96,v97
v_smfmac_f32_16x16x64_bf16 v[108:111],v[52:55],a[248:255],v2
v_add_f32 v100,v100,v102
v_smfmac_f32_16x16x64_bf16 v[112:115],v[28:31],v[144:151],v2
v_add_f32 v101,v101,v103
v_smfmac_f32_16x16x64_bf16 v[116:119],v[28:31],v[152:159],v2
v_cvt_pk_bf16_f32 v121,v100,v101
v_add_f32 v104,v104,v106
v_add_f32 v105,v105,v107
v_cvt_pk_bf16_f32 v122,v104,v105
v_add_f32 v108,v108,v110
v_add_f32 v109,v109,v111
v_cvt_pk_bf16_f32 v123,v108,v109
ds_write_b128 v4,v[120:123]
v_smfmac_f32_16x16x64_bf16 v[112:115],v[32:35],v[160:167],v2
v_smfmac_f32_16x16x64_bf16 v[116:119],v[32:35],v[168:175],v2
v_smfmac_f32_16x16x64_bf16 v[112:115],v[36:39],v[176:183],v2
v_smfmac_f32_16x16x64_bf16 v[116:119],v[36:39],v[184:191],v2
s_waitcnt vmcnt(7) lgkmcnt(0)
s_barrier
ds_read_b64_tr_b16 v[96:97],v5 offset:0
ds_read_b64_tr_b16 v[98:99],v6 offset:0
v_smfmac_f32_16x16x64_bf16 v[112:115],v[44:47],v[208:215],v2
ds_read_b64_tr_b16 v[100:101],v5 offset:1024
v_smfmac_f32_16x16x64_bf16 v[116:119],v[44:47],v[216:223],v2
ds_read_b64_tr_b16 v[102:103],v6 offset:1024
v_smfmac_f32_16x16x64_bf16 v[112:115],v[48:51],v[224:231],v2
ds_read_b64_tr_b16 v[104:105],v5 offset:2048
v_smfmac_f32_16x16x64_bf16 v[116:119],v[48:51],v[232:239],v2
ds_read_b64_tr_b16 v[106:107],v6 offset:2048
s_waitcnt lgkmcnt(4)
v_mfma_f32_16x16x32_bf16 v[24:27],v[56:59],v[96:99],0
ds_read_b64_tr_b16 v[108:109],v5 offset:3072
v_mfma_f32_16x16x32_bf16 v[28:31],v[60:63],v[96:99],0
ds_read_b64_tr_b16 v[110:111],v6 offset:3072
v_mfma_f32_16x16x32_bf16 v[32:35],v[96:99],v[96:99],0
ds_read_b128 v[40:43],v11 offset:12288
s_waitcnt lgkmcnt(5)
v_mfma_f32_16x16x32_bf16 v[24:27],v[64:67],v[100:103],v[24:27]
ds_read_b128 v[56:59],v11 offset:0
v_mfma_f32_16x16x32_bf16 v[28:31],v[68:71],v[100:103],v[28:31]
ds_read_b128 v[60:63],v11 offset:1024
v_mfma_f32_16x16x32_bf16 v[32:35],v[100:103],v[100:103],v[32:35]
ds_read_b128 v[96:99],v11 offset:8192
s_waitcnt lgkmcnt(6)
v_mfma_f32_16x16x32_bf16 v[24:27],v[72:75],v[104:107],v[24:27]
ds_read_b128 v[64:67],v11 offset:2048
v_mfma_f32_16x16x32_bf16 v[28:31],v[76:79],v[104:107],v[28:31]
ds_read_b128 v[68:71],v11 offset:3072
v_mfma_f32_16x16x32_bf16 v[32:35],v[104:107],v[104:107],v[32:35]
ds_read_b128 v[100:103],v11 offset:9216
s_waitcnt lgkmcnt(7)
v_mfma_f32_16x16x32_bf16 v[24:27],v[80:83],v[108:111],v[24:27]
ds_read_b128 v[72:75],v11 offset:4096
v_mfma_f32_16x16x32_bf16 v[28:31],v[84:87],v[108:111],v[28:31]
ds_read_b128 v[76:79],v11 offset:5120
v_mfma_f32_16x16x32_bf16 v[32:35],v[108:111],v[108:111],v[32:35]
ds_read_b128 v[104:107],v11 offset:10240
v_smfmac_f32_16x16x64_bf16 v[112:115],v[52:55],v[240:247],v2
ds_read_b128 v[80:83],v11 offset:6144
v_smfmac_f32_16x16x64_bf16 v[116:119],v[52:55],v[248:255],v2
ds_read_b128 v[84:87],v11 offset:7168
v_max3_f32 v126,v24,v25,v26
v_max3_f32 v127,v27,v28,v29
v_max3_f32 v126,v30,v31,v126
v_max3_f32 v127,v34,v35,v127
v_max_f32 v126,v126,v127
v_max_f32 v127,v126,v127
v_pk_mul_f32 v[34:35],v[34:35],v[0:1] op_sel:[0,1]
v_pk_mul_f32 v[24:25],v[24:25],v[0:1] op_sel:[0,1]
v_permlane16_swap_b32 v126,v127
v_max_f32 v126,v126,v127
v_max_f32 v127,v126,v127
v_pk_mul_f32 v[26:27],v[26:27],v[0:1] op_sel:[0,1]
v_pk_mul_f32 v[28:29],v[28:29],v[0:1] op_sel:[0,1]
v_permlane32_swap_b32 v126,v127
v_max_f32 v126,v126,v127
v_mul_f32 v126,v1,v126
v_pk_mul_f32 v[30:31],v[30:31],v[0:1] op_sel:[0,1]
v_pk_add_f32 v[34:35],v[34:35],v[126:127] op_sel_hi:[1,0] neg_lo:[0,1] neg_hi:[0,1]
v_pk_add_f32 v[112:113],v[112:113],v[114:115]
v_pk_add_f32 v[116:117],v[116:117],v[118:119]
v_pk_add_f32 v[24:25],v[24:25],v[126:127] op_sel_hi:[1,0] neg_lo:[0,1] neg_hi:[0,1]
v_pk_add_f32 v[26:27],v[26:27],v[126:127] op_sel_hi:[1,0] neg_lo:[0,1] neg_hi:[0,1]
v_pk_add_f32 v[28:29],v[28:29],v[126:127] op_sel_hi:[1,0] neg_lo:[0,1] neg_hi:[0,1]
v_pk_add_f32 v[30:31],v[30:31],v[126:127] op_sel_hi:[1,0] neg_lo:[0,1] neg_hi:[0,1]
v_exp_f32 v34,v34
v_exp_f32 v35,v35
v_cvt_pk_bf16_f32 v126,v112,v113
v_cvt_pk_bf16_f32 v124,v34,v35
v_cvt_pk_bf16_f32 v127,v116,v117
v_cvt_pk_bf16_f32 v36,v116,v117
v_mfma_f32_16x16x16_bf16 v[32:35],v[14:15],v[124:125],0
ds_read_b128 v[108:111],v11 offset:11264
v_exp_f32 v24,v24
v_mfma_f32_16x16x16_bf16 v[112:115],v[126:127],v[124:125],0
ds_read_b128 v[44:47],v11 offset:13312
v_exp_f32 v25,v25
v_mfma_f32_16x16x16_bf16 v[116:119],v[36:37],v[124:125],0
ds_read_b128 v[48:51],v11 offset:14336
v_exp_f32 v26,v26
v_exp_f32 v27,v27
v_cvt_pk_bf16_f32 v120,v24,v25
v_exp_f32 v28,v28
v_exp_f32 v29,v29
v_cvt_pk_bf16_f32 v121,v26,v27
v_exp_f32 v30,v30
v_exp_f32 v31,v31
v_cvt_pk_bf16_f32 v122,v28,v29
v_cvt_pk_bf16_f32 v123,v30,v31
s_mov_b32 s78,s55
s_add_u32 s55,s79,s75
v_mfma_f32_16x16x32_bf16 v[32:35],v[14:17],v[120:123],v[32:35]
ds_read_b128 v[52:55],v11 offset:15360
v_mfma_f32_16x16x32_bf16 v[112:115],v[88:91],v[120:123],v[112:115]
ds_read_b128 v[88:91],v11 offset:16384
v_mfma_f32_16x16x32_bf16 v[116:119],v[92:95],v[120:123],v[116:119]
ds_read_b128 v[92:95],v11 offset:17408
v_rcp_f32 v32,v32
v_mov_b64 v[24:25],-1
v_mov_b64 v[26:27],-1
s_mov_b32 s54,s68
s_add_u32 s75,s75,8192
v_pk_mul_f32 v[112:113],v[112:113],v[32:33] op_sel_hi:[1,0]
v_pk_mul_f32 v[114:115],v[114:115],v[32:33] op_sel_hi:[1,0]
v_pk_mul_f32 v[116:117],v[116:117],v[32:33] op_sel_hi:[1,0]
v_pk_mul_f32 v[118:119],v[118:119],v[32:33] op_sel_hi:[1,0]
v_cvt_pk_bf16_f32 v120,v112,v116
v_cvt_pk_bf16_f32 v121,v113,v117
v_cvt_pk_bf16_f32 v122,v114,v118
v_cvt_pk_bf16_f32 v123,v115,v119
ds_write_b128 v7,v[120:123]
buffer_store_dwordx4 v[24:27],v0,s[8:11],s69 offen
buffer_store_dwordx4 v[24:27],v0,s[8:11],s69 offen offset:1024
s_waitcnt lgkmcnt(0)
s_barrier
ds_read_b128 v[24:27],v8 offset:0
ds_read_b128 v[28:31],v8 offset:512
ds_read_b128 v[32:35],v8 offset:1024
ds_read_b128 v[36:39],v8 offset:1536
v_mov_b64 v[112:113],0
v_mov_b64 v[114:115],0
v_mov_b64 v[116:117],0
v_mov_b64 v[118:119],0
v_mov_b64 v[120:121],0
v_mov_b64 v[122:123],0
s_add_u32 s64,s75,13631488
s_add_u32 s70,s64,4096
s_add_u32 s68,s68,131072
s_add_u32 s51,s51,1
s_cmp_eq_u32 s51,64
s_cbranch_scc1 L_cend_178
s_waitcnt lgkmcnt(3)
v_smfmac_f32_16x16x64_bf16 v[112:115],v[24:27],v[56:63],v3
ds_read_b128 v[56:59],v11 offset:18432
s_add_u32 s57,s65,65536
s_waitcnt lgkmcnt(3)
v_smfmac_f32_16x16x64_bf16 v[112:115],v[28:31],v[64:71],v3
ds_read_b128 v[60:63],v11 offset:19456
s_add_u32 s58,s65,131072
s_waitcnt lgkmcnt(3)
v_smfmac_f32_16x16x64_bf16 v[112:115],v[32:35],v[72:79],v3
ds_read_b128 v[64:67],v11 offset:20480
s_add_u32 s59,s65,196608
s_waitcnt lgkmcnt(3)
v_smfmac_f32_16x16x64_bf16 v[112:115],v[36:39],v[80:87],v3
ds_read_b128 v[68:71],v11 offset:21504
v_smfmac_f32_16x16x64_bf16 v[116:119],v[24:27],v[96:103],v3
ds_read_b128 v[72:75],v11 offset:22528
v_smfmac_f32_16x16x64_bf16 v[116:119],v[28:31],v[104:111],v3
ds_read_b128 v[76:79],v11 offset:23552
v_cvt_pk_bf16_f32 v112,v112,v113
v_smfmac_f32_16x16x64_bf16 v[116:119],v[32:35],v[40:47],v3
ds_read_b128 v[80:83],v11 offset:24576
v_cvt_pk_bf16_f32 v113,v114,v115
buffer_store_dwordx2 v[112:113],v9,s[8:11],s65 offen
v_smfmac_f32_16x16x64_bf16 v[116:119],v[36:39],v[48:55],v3
ds_read_b128 v[84:87],v11 offset:25600
v_mov_b64 v[112:113],0
v_smfmac_f32_16x16x64_bf16 v[120:123],v[24:27],v[88:95],v3
ds_read_b128 v[96:99],v11 offset:26624
ds_read_b128 v[100:103],v11 offset:27648
v_mov_b64 v[114:115],0
s_waitcnt lgkmcnt(8)
v_smfmac_f32_16x16x64_bf16 v[120:123],v[28:31],v[56:63],v3
ds_read_b128 v[104:107],v11 offset:28672
v_cvt_pk_bf16_f32 v116,v116,v117
s_waitcnt lgkmcnt(7)
v_smfmac_f32_16x16x64_bf16 v[120:123],v[32:35],v[64:71],v3
ds_read_b128 v[108:111],v11 offset:29696
ds_read_b128 v[40:43],v11 offset:30720
v_cvt_pk_bf16_f32 v117,v118,v119
buffer_store_dwordx2 v[116:117],v9,s[8:11],s57 offen
s_waitcnt lgkmcnt(7)
v_smfmac_f32_16x16x64_bf16 v[120:123],v[36:39],v[72:79],v3
ds_read_b128 v[44:47],v11 offset:31744
s_waitcnt lgkmcnt(6)
v_smfmac_f32_16x16x64_bf16 v[112:115],v[24:27],v[80:87],v3
s_waitcnt lgkmcnt(4)
v_smfmac_f32_16x16x64_bf16 v[112:115],v[28:31],v[96:103],v3
v_cvt_pk_bf16_f32 v120,v120,v121
s_waitcnt lgkmcnt(2)
v_smfmac_f32_16x16x64_bf16 v[112:115],v[32:35],v[104:111],v3
v_cvt_pk_bf16_f32 v121,v122,v123
buffer_store_dwordx2 v[120:121],v9,s[8:11],s58 offen
s_waitcnt lgkmcnt(0)
v_smfmac_f32_16x16x64_bf16 v[112:115],v[36:39],v[40:47],v3
v_mov_b64 v[116:117],0
v_mov_b64 v[118:119],0
s_xor_b32 s65,s65,262144
v_add_u32 v52,s50,v5
v_add_u32 v54,s50,v6
v_mov_b32_dpp v124,v126 quad_perm:[2,3,2,3] row_mask:0xf bank_mask:0xf
v_mov_b32_dpp v125,v127 quad_perm:[2,3,2,3] row_mask:0xf bank_mask:0xf
s_nop 0
v_cvt_pk_bf16_f32 v112,v112,v113
v_cvt_pk_bf16_f32 v113,v114,v115
buffer_store_dwordx2 v[112:113],v9,s[8:11],s59 offen
ds_read_b64_tr_b16 v[52:53],v52
ds_read_b64_tr_b16 v[54:55],v54
s_mov_b32 vcc_lo,0xcccccccc
s_mov_b32 vcc_hi,0xcccccccc
v_mov_b64 v[96:97],0
v_mov_b64 v[98:99],0
v_mov_b64 v[100:101],0
v_mov_b64 v[102:103],0
v_mov_b64 v[104:105],0
v_mov_b64 v[106:107],0
v_mov_b64 v[108:109],0
v_mov_b64 v[110:111],0
v_mov_b64 v[112:113],0
v_mov_b64 v[114:115],0
s_waitcnt lgkmcnt(0)
v_cndmask_b32 v124,v124,v52,vcc
v_cndmask_b32 v125,v125,v53,vcc
v_cndmask_b32 v126,v126,v54,vcc
v_cndmask_b32 v127,v127,v55,vcc
v_add_u32 v55,131072,v0
v_add_u32 v123,s73,v55
v_xor_b32 v120,1024,v12
v_xor_b32 v121,2048,v12
v_xor_b32 v122,3072,v12
s_waitcnt vmcnt(0)
buffer_load_dwordx4 v[32:35],v0,s[8:11],s66 offen offset:0 sc1
buffer_load_dwordx4 v[36:39],v0,s[8:11],s66 offen offset:1024 sc1
v_readlane_b32 s76,v23,4
s_cmp_ge_u32 s51,63
s_cselect_b32 s76,1,s76
v_add_u32 v23,-1,v23
v_cmp_le_u32 vcc,s30,v23
s_cmp_gt_u32 s51,61
s_cselect_b32 s77,0,vcc_hi
s_cmp_lg_u32 s77,0
s_cselect_b32 s76,0,s76
s_or_b32 s76,s76,s46
s_waitcnt vmcnt(1)
v_mfma_f32_16x16x32_bf16 v[28:31],v[18:21],v[32:35],0
s_waitcnt vmcnt(0)
v_mfma_f32_16x16x32_bf16 v[28:31],v[18:21],v[36:39],v[28:31]
s_nop 7
v_cmp_u_f32 vcc,v28,v28
v_add_f32_dpp v52,v28,v28 row_ror:8 row_mask:0xf bank_mask:0x3
v_add_f32_dpp v53,v29,v29 row_ror:8 row_mask:0xf bank_mask:0x3
v_add_f32_dpp v52,v30,v30 row_ror:8 row_mask:0xf bank_mask:0xc
v_add_f32_dpp v53,v31,v31 row_ror:8 row_mask:0xf bank_mask:0xc
s_nop 0
v_add_f32_dpp v52,v52,v52 row_shl:4 row_mask:0xf bank_mask:0x5
v_add_f32_dpp v53,v53,v53 row_shl:4 row_mask:0xf bank_mask:0x5
s_cbranch_vccnz L_crp_180
L_cok_185:
v_cvt_pk_bf16_f32 v54,v52,v53
buffer_store_dword v54,v10,s[8:11],s64 offen
s_mov_b32 s69,s66
s_xor_b32 s66,s66,262144
s_barrier
ds_read_b128 v[56:59],v55 offset:0
ds_read_b128 v[60:63],v55 offset:4096
buffer_load_dwordx4 v[24:27],v13,s[8:11],s64 offen sc1
buffer_load_dwordx4 v[40:43],v13,s[8:11],s70 offen sc1
ds_read_b128 v[64:67],v55 offset:1024
ds_read_b128 v[68:71],v55 offset:5120
ds_read_b128 v[72:75],v55 offset:2048
ds_read_b128 v[76:79],v55 offset:6144
ds_read_b128 v[80:83],v55 offset:3072
ds_read_b128 v[84:87],v55 offset:7168
ds_read_b128 v[88:91],v123 offset:8192
ds_read_b128 v[92:95],v123 offset:9216
s_branch L_chain_175
L_crp_180:
buffer_load_dwordx4 v[32:35],v0,s[8:11],s66 offen offset:0 sc1
buffer_load_dwordx4 v[36:39],v0,s[8:11],s66 offen offset:1024 sc1
s_sub_u32 s49,s49,1
s_cbranch_scc1 L_abort
s_waitcnt vmcnt(1)
v_mfma_f32_16x16x32_bf16 v[28:31],v[18:21],v[32:35],0
s_waitcnt vmcnt(0)
v_mfma_f32_16x16x32_bf16 v[28:31],v[18:21],v[36:39],v[28:31]
s_nop 7
v_cmp_u_f32 vcc,v28,v28
v_add_f32_dpp v52,v28,v28 row_ror:8 row_mask:0xf bank_mask:0x3
v_add_f32_dpp v53,v29,v29 row_ror:8 row_mask:0xf bank_mask:0x3
v_add_f32_dpp v52,v30,v30 row_ror:8 row_mask:0xf bank_mask:0xc
v_add_f32_dpp v53,v31,v31 row_ror:8 row_mask:0xf bank_mask:0xc
s_nop 0
v_add_f32_dpp v52,v52,v52 row_shl:4 row_mask:0xf bank_mask:0x5
v_add_f32_dpp v53,v53,v53 row_shl:4 row_mask:0xf bank_mask:0x5
s_cbranch_vccz L_cok_185
s_branch L_crp_180
L_ckw_165:
s_cmp_eq_u32 s77,0
s_cbranch_scc1 L_cjw_167
s_add_u32 s31,s51,2
s_lshl_b32 s59,s31,13
s_add_u32 s59,s59,10486016
v_lshrrev_b32 v29,2,v0
v_and_b32 v29,127,v29
L_ckk_186:
s_sleep 1
buffer_load_dword v28,v29,s[8:11],s59 offen sc1
s_sub_u32 s49,s49,1
s_cbranch_scc1 L_abort
s_waitcnt vmcnt(0)
v_cmp_eq_u32 vcc,0,v28
s_cbranch_vccnz L_ckk_186
v_cmp_lt_u32 vcc,s30,v28
s_cbranch_vccz L_cjw_167
s_mov_b32 s67,0x80000000
ds_write_b32 v8,v2 offset:2560
s_branch L_ckb_166
L_cjw_167:
s_lshl2_add_u32 s59,s47,s75
s_add_u32 s59,s59,10494080
L_ww_187:
s_sleep 1
buffer_load_dword v23,off,s[8:11],s59 sc1
s_sub_u32 s49,s49,1
s_cbranch_scc1 L_abort
s_waitcnt vmcnt(0)
v_readfirstlane_b32 s76,v23
s_cmp_eq_u32 s76,0
s_cbranch_scc1 L_ww_187
L_wwd_188:
s_branch L_ckb_166
L_cjump_168:
s_waitcnt vmcnt(0) lgkmcnt(0)
s_barrier
s_branch L_cst_164
L_cend_178:
v_add_u32 v52,s50,v5
v_add_u32 v54,s50,v6
ds_read_b64_tr_b16 v[52:53],v52
ds_read_b64_tr_b16 v[54:55],v54
v_mov_b32_dpp v124,v126 quad_perm:[2,3,2,3] row_mask:0xf bank_mask:0xf
v_mov_b32_dpp v125,v127 quad_perm:[2,3,2,3] row_mask:0xf bank_mask:0xf
s_mov_b32 vcc_lo,0xcccccccc
s_mov_b32 vcc_hi,0xcccccccc
s_waitcnt lgkmcnt(0)
v_cndmask_b32 v124,v124,v52,vcc
v_cndmask_b32 v125,v125,v53,vcc
v_cndmask_b32 v126,v126,v54,vcc
v_cndmask_b32 v127,v127,v55,vcc
buffer_store_dwordx4 v[124:127],v0,s[8:11],s54 offen sc1
s_waitcnt vmcnt(0)
s_barrier
buffer_store_dword v2,off,s[8:11],s78 sc1
buffer_store_dword v2,off,s[8:11],s55 sc1
s_nop 11
v_lshrrev_b32 v1,4,v0
s_endpgm
L_abort2:
s_endpgm
L_wc:
s_nop 11
s_cmp_eq_u32 s48,1
s_cbranch_scc1 L_rc1_189
s_cmp_eq_u32 s48,2
s_cbranch_scc1 L_rc2_190
v_and_b32 v120,15,v1
v_lshrrev_b32 v121,4,v1
v_and_b32 v122,2,v1
v_cmp_eq_u32 vcc,0,v122
v_mov_b32 v2,0xeeee
v_mov_b32 v123,0x4444
v_cndmask_b32 v2,v2,v123,vcc
v_and_b32 v122,1,v1
v_cmp_eq_u32 vcc,0,v122
v_mov_b32 v3,0xdddd
v_mov_b32 v123,0x8888
v_cndmask_b32 v3,v3,v123,vcc
v_lshrrev_b32 v122,1,v120
v_bfe_u32 v123,v120,2,1
v_xor_b32 v123,v123,v122
v_lshlrev_b32 v4,7,v123
v_and_b32 v123,1,v120
v_lshl_add_u32 v4,v123,6,v4
v_xor_b32 v123,v121,v122
v_and_b32 v123,3,v123
v_lshl_add_u32 v4,v123,4,v4
s_lshl_b32 s56,s46,10
s_add_u32 s56,s56,147456
v_add_u32 v4,s56,v4
v_lshlrev_b32 v122,1,v121
v_add_u32 v122,0,v122
v_and_b32 v123,1,v121
v_xor_b32 v123,v123,v122
v_lshlrev_b32 v5,7,v123
v_bfe_u32 v123,v120,3,1
v_lshl_add_u32 v5,v123,6,v5
v_xor_b32 v123,v120,v122
v_and_b32 v123,3,v123
v_lshl_add_u32 v5,v123,4,v5
v_bfe_u32 v123,v120,2,1
v_lshl_add_u32 v5,v123,3,v5
v_add_u32 v5,147456,v5
v_lshlrev_b32 v122,1,v121
v_add_u32 v122,1,v122
v_and_b32 v123,1,v121
v_xor_b32 v123,v123,v122
v_lshlrev_b32 v6,7,v123
v_bfe_u32 v123,v120,3,1
v_lshl_add_u32 v6,v123,6,v6
v_xor_b32 v123,v120,v122
v_and_b32 v123,3,v123
v_lshl_add_u32 v6,v123,4,v6
v_bfe_u32 v123,v120,2,1
v_lshl_add_u32 v6,v123,3,v6
v_add_u32 v6,147456,v6
v_lshlrev_b32 v7,7,v121
v_lshrrev_b32 v122,1,v120
v_lshl_add_u32 v8,v122,4,v7
v_add_u32 v8,151552,v8
v_lshrrev_b32 v122,2,v120
v_lshl_add_u32 v7,v122,5,v7
v_and_b32 v122,1,v120
v_lshl_add_u32 v7,v122,4,v7
v_and_b32 v122,2,v120
v_cmp_eq_u32 vcc,0,v122
s_lshl_b32 s56,s46,9
v_mov_b32 v122,2048
v_mov_b32 v123,s56
v_cndmask_b32 v122,v122,v123,vcc
v_add_u32 v7,v122,v7
v_add_u32 v7,151552,v7
v_lshrrev_b32 v122,3,v1
v_lshlrev_b32 v9,11,v122
v_and_b32 v122,7,v1
v_lshl_add_u32 v9,v122,3,v9
s_lshl_b32 s56,s46,14
s_lshl_b32 s57,s47,6
s_add_u32 s56,s56,s57
v_add_u32 v9,s56,v9
s_lshl_b32 s71,s47,2
s_add_u32 s71,s71,s46
s_bfe_u32 s56,s71,0x10003
s_lshl_b32 s56,s56,11
s_and_b32 s57,s71,1
s_lshl_b32 s57,s57,10
s_add_u32 s56,s56,s57
s_bfe_u32 s57,s71,0x10002
s_lshl_b32 s57,s57,9
s_add_u32 s56,s56,s57
s_bfe_u32 s57,s71,0x10001
s_lshl_b32 s57,s57,6
s_add_u32 s56,s56,s57
s_bfe_u32 s57,s71,0x10004
s_lshl_b32 s57,s57,8
s_add_u32 s56,s56,s57
s_bfe_u32 s57,s71,0x10005
s_lshl_b32 s57,s57,7
s_add_u32 s56,s56,s57
s_bfe_u32 s57,s71,0x10006
s_lshl_b32 s57,s57,12
s_add_u32 s56,s56,s57
v_and_b32 v122,3,v120
v_lshlrev_b32 v10,2,v122
v_bfe_u32 v122,v120,3,1
v_lshl_add_u32 v10,v122,4,v10
v_and_b32 v122,1,v121
v_lshl_add_u32 v10,v122,5,v10
v_add_u32 v10,s56,v10
v_and_b32 v123,36,v1
v_mov_b32 v122,0x80000000
v_cmp_eq_u32 vcc,0,v123
s_nop 1
v_cndmask_b32 v10,v122,v10,vcc
s_lshl_b32 s56,s46,15
v_add_u32 v11,s56,v0
s_lshl_b32 s71,s71,11
s_lshl_b32 s73,s46,11
s_mov_b32 s72,0xffc00000
s_mov_b32 s74,0
v_lshrrev_b32 v13,3,v1
v_lshlrev_b32 v13,9,v13
v_and_b32 v122,7,v1
v_lshl_add_u32 v13,v122,4,v13
v_and_b32 v122,15,v1
v_and_b32 v123,1,v1
v_lshlrev_b32 v123,4,v123
v_mov_b32 v124,0x3f80
v_lshlrev_b32 v124,v123,v124
v_lshrrev_b32 v122,1,v122
v_cmp_eq_u32 vcc,0,v122
s_nop 1
v_cndmask_b32 v18,0,v124,vcc
v_cmp_eq_u32 vcc,1,v122
s_nop 1
v_cndmask_b32 v19,0,v124,vcc
v_cmp_eq_u32 vcc,2,v122
s_nop 1
v_cndmask_b32 v20,0,v124,vcc
v_cmp_eq_u32 vcc,3,v122
s_nop 1
v_cndmask_b32 v21,0,v124,vcc
s_and_b32 s56,s46,1
s_lshl_b32 s56,s56,8
s_and_b32 s57,s46,2
s_lshl_b32 s57,s57,6
s_add_u32 s56,s56,s57
v_add_u32 v13,s56,v13
s_add_u32 s56,s50,155648
v_add_u32 v12,s56,v0
v_mov_b64 v[14:15],s[28:29]
v_mov_b64 v[16:17],s[28:29]
v_add_u32 v22,11550720,v10
s_lshl_b32 s56,s47,2
s_add_u32 s56,s56,10502144
s_or_b32 s56,s56,s52
v_writelane_b32 v22,s56,4
v_mov_b32 v1,s80
s_mov_b32 s65,14680064
s_add_u32 s66,s71,14680064
s_add_u32 s69,s71,14942208
s_lshl_b32 s79,s47,2
s_add_u32 s79,s79,10485760
s_cmp_eq_u32 s46,0
s_cselect_b32 s79,s79,0x80000000
s_mov_b32 s30,0x40000000
s_mov_b32 s51,0
L_cst_191:
s_cmp_lg_u32 s46,0
s_cbranch_scc1 L_csw_196
s_lshl_b32 s59,s51,13
s_lshl2_add_u32 s59,s47,s59
s_add_u32 s59,s59,10485760
L_ww_197:
s_sleep 1
buffer_load_dword v122,off,s[8:11],s59 sc1
s_sub_u32 s49,s49,1
s_cbranch_scc1 L_abort2
s_waitcnt vmcnt(0)
v_readfirstlane_b32 s61,v122
s_cmp_eq_u32 s61,0
s_cbranch_scc1 L_ww_197
L_wwd_198:
L_csw_196:
s_waitcnt lgkmcnt(0)
s_barrier
s_lshl_b32 s56,s51,5
s_add_u32 s56,s56,s47
s_mul_i32 s56,s56,24576
s_add_u32 s56,s56,100663296
s_add_u32 s67,s56,s73
s_add_u32 m0,s73,131072
s_add_u32 s57,s67,8192
buffer_load_dwordx4 v0,s[8:11],s67 offen sc1 lds
buffer_load_dwordx4 v0,s[8:11],s67 offen offset:1024 sc1 lds
s_add_u32 m0,s73,139264
s_add_u32 s67,s67,786432
buffer_load_dwordx4 v0,s[8:11],s57 offen sc1 lds
buffer_load_dwordx4 v0,s[8:11],s57 offen offset:1024 sc1 lds
s_lshl_b32 s75,s51,13
s_add_u32 s64,s75,11534336
s_add_u32 s70,s64,4096
s_lshl_b32 s68,s51,5
s_add_u32 s68,s68,s47
s_lshl_b32 s68,s68,12
s_lshl_b32 s56,s46,10
s_add_u32 s68,s68,s56
s_add_u32 s68,s68,41943040
s_mov_b32 s78,0x80000000
s_mov_b32 s55,0x80000000
s_mov_b32 s54,0x80000000
s_mov_b32 s77,0
s_cmp_eq_u32 s51,63
s_cselect_b32 s76,1,s46
v_mov_b64 v[96:97],0
v_mov_b64 v[98:99],0
v_mov_b64 v[100:101],0
v_mov_b64 v[102:103],0
v_mov_b64 v[104:105],0
v_mov_b64 v[106:107],0
v_mov_b64 v[108:109],0
v_mov_b64 v[110:111],0
v_mov_b64 v[112:113],0
v_mov_b64 v[114:115],0
v_mov_b64 v[116:117],0
v_mov_b64 v[118:119],0
s_waitcnt vmcnt(0) lgkmcnt(0)
s_barrier
v_add_u32 v55,131072,v0
ds_read_b128 v[56:59],v55 offset:0
ds_read_b128 v[60:63],v55 offset:4096
ds_read_b128 v[64:67],v55 offset:1024
ds_read_b128 v[68:71],v55 offset:5120
ds_read_b128 v[72:75],v55 offset:2048
ds_read_b128 v[76:79],v55 offset:6144
ds_read_b128 v[80:83],v55 offset:3072
ds_read_b128 v[84:87],v55 offset:7168
v_add_u32 v123,s73,v55
ds_read_b128 v[88:91],v123 offset:8192
ds_read_b128 v[92:95],v123 offset:9216
v_xor_b32 v120,1024,v12
v_xor_b32 v121,2048,v12
v_xor_b32 v122,3072,v12
buffer_load_dwordx4 v[24:27],v13,s[8:11],s64 offen sc1
buffer_load_dwordx4 v[40:43],v13,s[8:11],s70 offen sc1
L_chain_199:
L_cpa_200:
buffer_load_dwordx4 v[24:27],v13,s[8:11],s64 offen sc1
buffer_load_dwordx4 v[40:43],v13,s[8:11],s70 offen sc1
s_sub_u32 s49,s49,1
s_cbranch_scc1 L_abort2
s_waitcnt vmcnt(2)
v_max3_u32 v123,v24,v25,v26
v_max3_u32 v123,v27,v40,v123
v_max3_u32 v123,v41,v42,v123
v_max_u32 v123,v43,v123
v_cmp_le_u32 vcc,s72,v123
s_cbranch_vccnz L_cpa_200
ds_write_b128 v12,v[24:27] offset:0
ds_write_b128 v12,v[40:43] offset:4096
v_smfmac_f32_16x16x64_bf16 v[96:99],v[24:27],a[0:7],v2
buffer_store_dwordx4 v[124:127],v0,s[8:11],s54 offen sc1
v_smfmac_f32_16x16x64_bf16 v[100:103],v[24:27],a[128:135],v2
s_add_u32 m0,s73,131072
s_add_u32 s57,s67,8192
v_smfmac_f32_16x16x64_bf16 v[104:107],v[24:27],a[8:15],v2
s_cmp_eq_u32 s76,0
v_smfmac_f32_16x16x64_bf16 v[108:111],v[24:27],a[136:143],v2
s_cbranch_scc1 L_ckw_192
L_ckb_193:
s_waitcnt lgkmcnt(0)
s_barrier
ds_read_b128 v[28:31],v120 offset:0
ds_read_b128 v[32:35],v121 offset:0
v_smfmac_f32_16x16x64_bf16 v[96:99],v[40:43],a[64:71],v2
ds_read_b128 v[36:39],v122 offset:0
v_smfmac_f32_16x16x64_bf16 v[100:103],v[40:43],a[192:199],v2
ds_read_b128 v[44:47],v120 offset:4096
v_smfmac_f32_16x16x64_bf16 v[104:107],v[40:43],a[72:79],v2
ds_read_b128 v[48:51],v121 offset:4096
v_smfmac_f32_16x16x64_bf16 v[108:111],v[40:43],a[200:207],v2
ds_read_b128 v[52:55],v122 offset:4096
v_smfmac_f32_16x16x64_bf16 v[112:115],v[24:27],v[128:135],v2
buffer_load_dwordx4 v0,s[8:11],s67 offen sc1 lds
v_smfmac_f32_16x16x64_bf16 v[116:119],v[24:27],v[136:143],v2
v_smfmac_f32_16x16x64_bf16 v[112:115],v[40:43],v[192:199],v2
buffer_load_dwordx4 v0,s[8:11],s67 offen offset:1024 sc1 lds
v_smfmac_f32_16x16x64_bf16 v[116:119],v[40:43],v[200:207],v2
s_waitcnt lgkmcnt(5)
v_smfmac_f32_16x16x64_bf16 v[96:99],v[28:31],a[16:23],v2
s_add_u32 m0,s73,139264
v_smfmac_f32_16x16x64_bf16 v[100:103],v[28:31],a[144:151],v2
buffer_load_dwordx4 v0,s[8:11],s57 offen sc1 lds
v_smfmac_f32_16x16x64_bf16 v[104:107],v[28:31],a[24:31],v2
s_add_u32 s67,s67,786432
v_smfmac_f32_16x16x64_bf16 v[108:111],v[28:31],a[152:159],v2
s_waitcnt lgkmcnt(4)
v_smfmac_f32_16x16x64_bf16 v[96:99],v[32:35],a[32:39],v2
buffer_load_dwordx4 v0,s[8:11],s57 offen offset:1024 sc1 lds
v_smfmac_f32_16x16x64_bf16 v[100:103],v[32:35],a[160:167],v2
v_smfmac_f32_16x16x64_bf16 v[104:107],v[32:35],a[40:47],v2
v_smfmac_f32_16x16x64_bf16 v[108:111],v[32:35],a[168:175],v2
buffer_load_dword v23,v22,s[8:11],s75 offen sc1
s_waitcnt lgkmcnt(3)
v_smfmac_f32_16x16x64_bf16 v[96:99],v[36:39],a[48:55],v2
v_mov_b32 v125,0
v_smfmac_f32_16x16x64_bf16 v[100:103],v[36:39],a[176:183],v2
v_smfmac_f32_16x16x64_bf16 v[104:107],v[36:39],a[56:63],v2
v_smfmac_f32_16x16x64_bf16 v[108:111],v[36:39],a[184:191],v2
s_waitcnt lgkmcnt(0)
v_smfmac_f32_16x16x64_bf16 v[96:99],v[44:47],a[80:87],v2
v_smfmac_f32_16x16x64_bf16 v[100:103],v[44:47],a[208:215],v2
v_smfmac_f32_16x16x64_bf16 v[96:99],v[48:51],a[96:103],v2
v_smfmac_f32_16x16x64_bf16 v[100:103],v[48:51],a[224:231],v2
v_smfmac_f32_16x16x64_bf16 v[96:99],v[52:55],a[112:119],v2
v_smfmac_f32_16x16x64_bf16 v[100:103],v[52:55],a[240:247],v2
v_smfmac_f32_16x16x64_bf16 v[104:107],v[44:47],a[88:95],v2
v_smfmac_f32_16x16x64_bf16 v[108:111],v[44:47],a[216:223],v2
v_smfmac_f32_16x16x64_bf16 v[104:107],v[48:51],a[104:111],v2
v_add_f32 v96,v96,v98
v_smfmac_f32_16x16x64_bf16 v[108:111],v[48:51],a[232:239],v2
v_add_f32 v97,v97,v99
v_smfmac_f32_16x16x64_bf16 v[104:107],v[52:55],a[120:127],v2
v_cvt_pk_bf16_f32 v120,v96,v97
v_smfmac_f32_16x16x64_bf16 v[108:111],v[52:55],a[248:255],v2
v_add_f32 v100,v100,v102
v_smfmac_f32_16x16x64_bf16 v[112:115],v[28:31],v[144:151],v2
v_add_f32 v101,v101,v103
v_smfmac_f32_16x16x64_bf16 v[116:119],v[28:31],v[152:159],v2
v_cvt_pk_bf16_f32 v121,v100,v101
v_add_f32 v104,v104,v106
v_add_f32 v105,v105,v107
v_cvt_pk_bf16_f32 v122,v104,v105
v_add_f32 v108,v108,v110
v_add_f32 v109,v109,v111
v_cvt_pk_bf16_f32 v123,v108,v109
ds_write_b128 v4,v[120:123]
v_smfmac_f32_16x16x64_bf16 v[112:115],v[32:35],v[160:167],v2
v_smfmac_f32_16x16x64_bf16 v[116:119],v[32:35],v[168:175],v2
v_smfmac_f32_16x16x64_bf16 v[112:115],v[36:39],v[176:183],v2
v_smfmac_f32_16x16x64_bf16 v[116:119],v[36:39],v[184:191],v2
s_waitcnt vmcnt(6) lgkmcnt(0)
s_barrier
ds_read_b64_tr_b16 v[96:97],v5 offset:0
ds_read_b64_tr_b16 v[98:99],v6 offset:0
v_smfmac_f32_16x16x64_bf16 v[112:115],v[44:47],v[208:215],v2
ds_read_b64_tr_b16 v[100:101],v5 offset:1024
v_smfmac_f32_16x16x64_bf16 v[116:119],v[44:47],v[216:223],v2
ds_read_b64_tr_b16 v[102:103],v6 offset:1024
v_smfmac_f32_16x16x64_bf16 v[112:115],v[48:51],v[224:231],v2
ds_read_b64_tr_b16 v[104:105],v5 offset:2048
v_smfmac_f32_16x16x64_bf16 v[116:119],v[48:51],v[232:239],v2
ds_read_b64_tr_b16 v[106:107],v6 offset:2048
s_waitcnt lgkmcnt(4)
v_mfma_f32_16x16x32_bf16 v[24:27],v[56:59],v[96:99],0
ds_read_b64_tr_b16 v[108:109],v5 offset:3072
v_mfma_f32_16x16x32_bf16 v[28:31],v[60:63],v[96:99],0
ds_read_b64_tr_b16 v[110:111],v6 offset:3072
v_mfma_f32_16x16x32_bf16 v[32:35],v[96:99],v[96:99],0
ds_read_b128 v[40:43],v11 offset:12288
s_waitcnt lgkmcnt(5)
v_mfma_f32_16x16x32_bf16 v[24:27],v[64:67],v[100:103],v[24:27]
ds_read_b128 v[56:59],v11 offset:0
v_mfma_f32_16x16x32_bf16 v[28:31],v[68:71],v[100:103],v[28:31]
ds_read_b128 v[60:63],v11 offset:1024
v_mfma_f32_16x16x32_bf16 v[32:35],v[100:103],v[100:103],v[32:35]
ds_read_b128 v[96:99],v11 offset:8192
s_waitcnt lgkmcnt(6)
v_mfma_f32_16x16x32_bf16 v[24:27],v[72:75],v[104:107],v[24:27]
ds_read_b128 v[64:67],v11 offset:2048
v_mfma_f32_16x16x32_bf16 v[28:31],v[76:79],v[104:107],v[28:31]
ds_read_b128 v[68:71],v11 offset:3072
v_mfma_f32_16x16x32_bf16 v[32:35],v[104:107],v[104:107],v[32:35]
ds_read_b128 v[100:103],v11 offset:9216
s_waitcnt lgkmcnt(7)
v_mfma_f32_16x16x32_bf16 v[24:27],v[80:83],v[108:111],v[24:27]
ds_read_b128 v[72:75],v11 offset:4096
v_mfma_f32_16x16x32_bf16 v[28:31],v[84:87],v[108:111],v[28:31]
ds_read_b128 v[76:79],v11 offset:5120
v_mfma_f32_16x16x32_bf16 v[32:35],v[108:111],v[108:111],v[32:35]
ds_read_b128 v[104:107],v11 offset:10240
v_smfmac_f32_16x16x64_bf16 v[112:115],v[52:55],v[240:247],v2
ds_read_b128 v[80:83],v11 offset:6144
v_smfmac_f32_16x16x64_bf16 v[116:119],v[52:55],v[248:255],v2
ds_read_b128 v[84:87],v11 offset:7168
v_max3_f32 v126,v24,v25,v26
v_max3_f32 v127,v27,v28,v29
v_max3_f32 v126,v30,v31,v126
v_max3_f32 v127,v34,v35,v127
v_max_f32 v126,v126,v127
v_max_f32 v127,v126,v127
v_pk_mul_f32 v[34:35],v[34:35],v[0:1] op_sel:[0,1]
v_pk_mul_f32 v[24:25],v[24:25],v[0:1] op_sel:[0,1]
v_permlane16_swap_b32 v126,v127
v_max_f32 v126,v126,v127
v_max_f32 v127,v126,v127
v_pk_mul_f32 v[26:27],v[26:27],v[0:1] op_sel:[0,1]
v_pk_mul_f32 v[28:29],v[28:29],v[0:1] op_sel:[0,1]
v_permlane32_swap_b32 v126,v127
v_max_f32 v126,v126,v127
v_mul_f32 v126,v1,v126
v_pk_mul_f32 v[30:31],v[30:31],v[0:1] op_sel:[0,1]
v_pk_add_f32 v[34:35],v[34:35],v[126:127] op_sel_hi:[1,0] neg_lo:[0,1] neg_hi:[0,1]
v_pk_add_f32 v[112:113],v[112:113],v[114:115]
v_pk_add_f32 v[116:117],v[116:117],v[118:119]
v_pk_add_f32 v[24:25],v[24:25],v[126:127] op_sel_hi:[1,0] neg_lo:[0,1] neg_hi:[0,1]
v_pk_add_f32 v[26:27],v[26:27],v[126:127] op_sel_hi:[1,0] neg_lo:[0,1] neg_hi:[0,1]
v_pk_add_f32 v[28:29],v[28:29],v[126:127] op_sel_hi:[1,0] neg_lo:[0,1] neg_hi:[0,1]
v_pk_add_f32 v[30:31],v[30:31],v[126:127] op_sel_hi:[1,0] neg_lo:[0,1] neg_hi:[0,1]
v_exp_f32 v34,v34
v_exp_f32 v35,v35
v_cvt_pk_bf16_f32 v126,v112,v113
v_cvt_pk_bf16_f32 v124,v34,v35
v_cvt_pk_bf16_f32 v127,v116,v117
v_cvt_pk_bf16_f32 v36,v116,v117
v_mfma_f32_16x16x16_bf16 v[32:35],v[14:15],v[124:125],0
ds_read_b128 v[108:111],v11 offset:11264
v_exp_f32 v24,v24
v_mfma_f32_16x16x16_bf16 v[112:115],v[126:127],v[124:125],0
ds_read_b128 v[44:47],v11 offset:13312
v_exp_f32 v25,v25
v_mfma_f32_16x16x16_bf16 v[116:119],v[36:37],v[124:125],0
ds_read_b128 v[48:51],v11 offset:14336
v_exp_f32 v26,v26
v_exp_f32 v27,v27
v_cvt_pk_bf16_f32 v120,v24,v25
v_exp_f32 v28,v28
v_exp_f32 v29,v29
v_cvt_pk_bf16_f32 v121,v26,v27
v_exp_f32 v30,v30
v_exp_f32 v31,v31
v_cvt_pk_bf16_f32 v122,v28,v29
v_cvt_pk_bf16_f32 v123,v30,v31
s_mov_b32 s78,s55
s_add_u32 s55,s79,s75
v_mfma_f32_16x16x32_bf16 v[32:35],v[14:17],v[120:123],v[32:35]
ds_read_b128 v[52:55],v11 offset:15360
v_mfma_f32_16x16x32_bf16 v[112:115],v[88:91],v[120:123],v[112:115]
ds_read_b128 v[88:91],v11 offset:16384
v_mfma_f32_16x16x32_bf16 v[116:119],v[92:95],v[120:123],v[116:119]
ds_read_b128 v[92:95],v11 offset:17408
v_rcp_f32 v32,v32
v_mov_b64 v[24:25],-1
v_mov_b64 v[26:27],-1
s_mov_b32 s54,s68
s_add_u32 s75,s75,8192
v_pk_mul_f32 v[112:113],v[112:113],v[32:33] op_sel_hi:[1,0]
v_pk_mul_f32 v[114:115],v[114:115],v[32:33] op_sel_hi:[1,0]
v_pk_mul_f32 v[116:117],v[116:117],v[32:33] op_sel_hi:[1,0]
v_pk_mul_f32 v[118:119],v[118:119],v[32:33] op_sel_hi:[1,0]
v_cvt_pk_bf16_f32 v120,v112,v116
v_cvt_pk_bf16_f32 v121,v113,v117
v_cvt_pk_bf16_f32 v122,v114,v118
v_cvt_pk_bf16_f32 v123,v115,v119
ds_write_b128 v7,v[120:123]
buffer_store_dwordx4 v[24:27],v0,s[8:11],s69 offen sc1
buffer_store_dwordx4 v[24:27],v0,s[8:11],s69 offen offset:1024 sc1
s_waitcnt lgkmcnt(0)
s_barrier
ds_read_b128 v[24:27],v8 offset:0
ds_read_b128 v[28:31],v8 offset:512
ds_read_b128 v[32:35],v8 offset:1024
ds_read_b128 v[36:39],v8 offset:1536
v_mov_b64 v[112:113],0
v_mov_b64 v[114:115],0
v_mov_b64 v[116:117],0
v_mov_b64 v[118:119],0
v_mov_b64 v[120:121],0
v_mov_b64 v[122:123],0
s_add_u32 s64,s75,11534336
s_add_u32 s70,s64,4096
s_add_u32 s68,s68,131072
s_add_u32 s51,s51,1
s_cmp_eq_u32 s51,64
s_cbranch_scc1 L_cend_202
s_waitcnt lgkmcnt(3)
v_smfmac_f32_16x16x64_bf16 v[112:115],v[24:27],v[56:63],v3
ds_read_b128 v[56:59],v11 offset:18432
s_add_u32 s57,s65,65536
s_waitcnt lgkmcnt(3)
v_smfmac_f32_16x16x64_bf16 v[112:115],v[28:31],v[64:71],v3
ds_read_b128 v[60:63],v11 offset:19456
s_add_u32 s58,s65,131072
s_waitcnt lgkmcnt(3)
v_smfmac_f32_16x16x64_bf16 v[112:115],v[32:35],v[72:79],v3
ds_read_b128 v[64:67],v11 offset:20480
s_add_u32 s59,s65,196608
s_waitcnt lgkmcnt(3)
v_smfmac_f32_16x16x64_bf16 v[112:115],v[36:39],v[80:87],v3
ds_read_b128 v[68:71],v11 offset:21504
v_smfmac_f32_16x16x64_bf16 v[116:119],v[24:27],v[96:103],v3
ds_read_b128 v[72:75],v11 offset:22528
v_smfmac_f32_16x16x64_bf16 v[116:119],v[28:31],v[104:111],v3
ds_read_b128 v[76:79],v11 offset:23552
v_cvt_pk_bf16_f32 v112,v112,v113
v_smfmac_f32_16x16x64_bf16 v[116:119],v[32:35],v[40:47],v3
ds_read_b128 v[80:83],v11 offset:24576
v_cvt_pk_bf16_f32 v113,v114,v115
buffer_store_dwordx2 v[112:113],v9,s[8:11],s65 offen sc1
v_smfmac_f32_16x16x64_bf16 v[116:119],v[36:39],v[48:55],v3
ds_read_b128 v[84:87],v11 offset:25600
v_mov_b64 v[112:113],0
v_smfmac_f32_16x16x64_bf16 v[120:123],v[24:27],v[88:95],v3
ds_read_b128 v[96:99],v11 offset:26624
ds_read_b128 v[100:103],v11 offset:27648
v_mov_b64 v[114:115],0
s_waitcnt lgkmcnt(8)
v_smfmac_f32_16x16x64_bf16 v[120:123],v[28:31],v[56:63],v3
ds_read_b128 v[104:107],v11 offset:28672
v_cvt_pk_bf16_f32 v116,v116,v117
s_waitcnt lgkmcnt(7)
v_smfmac_f32_16x16x64_bf16 v[120:123],v[32:35],v[64:71],v3
ds_read_b128 v[108:111],v11 offset:29696
ds_read_b128 v[40:43],v11 offset:30720
v_cvt_pk_bf16_f32 v117,v118,v119
buffer_store_dwordx2 v[116:117],v9,s[8:11],s57 offen sc1
s_waitcnt lgkmcnt(7)
v_smfmac_f32_16x16x64_bf16 v[120:123],v[36:39],v[72:79],v3
ds_read_b128 v[44:47],v11 offset:31744
s_waitcnt lgkmcnt(6)
v_smfmac_f32_16x16x64_bf16 v[112:115],v[24:27],v[80:87],v3
s_waitcnt lgkmcnt(4)
v_smfmac_f32_16x16x64_bf16 v[112:115],v[28:31],v[96:103],v3
v_cvt_pk_bf16_f32 v120,v120,v121
s_waitcnt lgkmcnt(2)
v_smfmac_f32_16x16x64_bf16 v[112:115],v[32:35],v[104:111],v3
v_cvt_pk_bf16_f32 v121,v122,v123
buffer_store_dwordx2 v[120:121],v9,s[8:11],s58 offen sc1
s_waitcnt lgkmcnt(0)
v_smfmac_f32_16x16x64_bf16 v[112:115],v[36:39],v[40:47],v3
v_mov_b64 v[116:117],0
v_mov_b64 v[118:119],0
s_xor_b32 s65,s65,262144
v_add_u32 v52,s50,v5
v_add_u32 v54,s50,v6
v_mov_b32_dpp v124,v126 quad_perm:[2,3,2,3] row_mask:0xf bank_mask:0xf
v_mov_b32_dpp v125,v127 quad_perm:[2,3,2,3] row_mask:0xf bank_mask:0xf
s_nop 0
v_cvt_pk_bf16_f32 v112,v112,v113
v_cvt_pk_bf16_f32 v113,v114,v115
buffer_store_dwordx2 v[112:113],v9,s[8:11],s59 offen sc1
ds_read_b64_tr_b16 v[52:53],v52
ds_read_b64_tr_b16 v[54:55],v54
s_mov_b32 vcc_lo,0xcccccccc
s_mov_b32 vcc_hi,0xcccccccc
v_mov_b64 v[96:97],0
v_mov_b64 v[98:99],0
v_mov_b64 v[100:101],0
v_mov_b64 v[102:103],0
v_mov_b64 v[104:105],0
v_mov_b64 v[106:107],0
v_mov_b64 v[108:109],0
v_mov_b64 v[110:111],0
v_mov_b64 v[112:113],0
v_mov_b64 v[114:115],0
s_waitcnt lgkmcnt(0)
v_cndmask_b32 v124,v124,v52,vcc
v_cndmask_b32 v125,v125,v53,vcc
v_cndmask_b32 v126,v126,v54,vcc
v_cndmask_b32 v127,v127,v55,vcc
v_add_u32 v55,131072,v0
v_add_u32 v123,s73,v55
v_xor_b32 v120,1024,v12
v_xor_b32 v121,2048,v12
v_xor_b32 v122,3072,v12
s_waitcnt vmcnt(0)
buffer_load_dwordx4 v[32:35],v0,s[8:11],s66 offen offset:0 sc1
buffer_load_dwordx4 v[36:39],v0,s[8:11],s66 offen offset:1024 sc1
v_readlane_b32 s76,v23,4
s_cmp_ge_u32 s51,63
s_cselect_b32 s76,1,s76
s_or_b32 s76,s76,s46
s_waitcnt vmcnt(1)
v_mfma_f32_16x16x32_bf16 v[28:31],v[18:21],v[32:35],0
s_waitcnt vmcnt(0)
v_mfma_f32_16x16x32_bf16 v[28:31],v[18:21],v[36:39],v[28:31]
s_nop 7
v_cmp_u_f32 vcc,v28,v28
v_add_f32_dpp v52,v28,v28 row_ror:8 row_mask:0xf bank_mask:0x3
v_add_f32_dpp v53,v29,v29 row_ror:8 row_mask:0xf bank_mask:0x3
v_add_f32_dpp v52,v30,v30 row_ror:8 row_mask:0xf bank_mask:0xc
v_add_f32_dpp v53,v31,v31 row_ror:8 row_mask:0xf bank_mask:0xc
s_nop 0
v_add_f32_dpp v52,v52,v52 row_shl:4 row_mask:0xf bank_mask:0x5
v_add_f32_dpp v53,v53,v53 row_shl:4 row_mask:0xf bank_mask:0x5
s_cbranch_vccnz L_crp_204
L_cok_209:
v_cvt_pk_bf16_f32 v54,v52,v53
buffer_store_dword v54,v10,s[8:11],s64 offen sc1
s_mov_b32 s69,s66
s_xor_b32 s66,s66,262144
s_barrier
ds_read_b128 v[56:59],v55 offset:0
ds_read_b128 v[60:63],v55 offset:4096
buffer_load_dwordx4 v[24:27],v13,s[8:11],s64 offen sc1
buffer_load_dwordx4 v[40:43],v13,s[8:11],s70 offen sc1
ds_read_b128 v[64:67],v55 offset:1024
ds_read_b128 v[68:71],v55 offset:5120
ds_read_b128 v[72:75],v55 offset:2048
ds_read_b128 v[76:79],v55 offset:6144
ds_read_b128 v[80:83],v55 offset:3072
ds_read_b128 v[84:87],v55 offset:7168
ds_read_b128 v[88:91],v123 offset:8192
ds_read_b128 v[92:95],v123 offset:9216
s_branch L_chain_199
L_crp_204:
buffer_load_dwordx4 v[32:35],v0,s[8:11],s66 offen offset:0 sc1
buffer_load_dwordx4 v[36:39],v0,s[8:11],s66 offen offset:1024 sc1
s_sub_u32 s49,s49,1
s_cbranch_scc1 L_abort2
s_waitcnt vmcnt(1)
v_mfma_f32_16x16x32_bf16 v[28:31],v[18:21],v[32:35],0
s_waitcnt vmcnt(0)
v_mfma_f32_16x16x32_bf16 v[28:31],v[18:21],v[36:39],v[28:31]
s_nop 7
v_cmp_u_f32 vcc,v28,v28
v_add_f32_dpp v52,v28,v28 row_ror:8 row_mask:0xf bank_mask:0x3
v_add_f32_dpp v53,v29,v29 row_ror:8 row_mask:0xf bank_mask:0x3
v_add_f32_dpp v52,v30,v30 row_ror:8 row_mask:0xf bank_mask:0xc
v_add_f32_dpp v53,v31,v31 row_ror:8 row_mask:0xf bank_mask:0xc
s_nop 0
v_add_f32_dpp v52,v52,v52 row_shl:4 row_mask:0xf bank_mask:0x5
v_add_f32_dpp v53,v53,v53 row_shl:4 row_mask:0xf bank_mask:0x5
s_cbranch_vccz L_cok_209
s_branch L_crp_204
L_ckw_192:
s_lshl2_add_u32 s59,s47,s75
s_add_u32 s59,s59,10493952
L_ww_210:
s_sleep 1
buffer_load_dword v23,off,s[8:11],s59 sc1
s_sub_u32 s49,s49,1
s_cbranch_scc1 L_abort2
s_waitcnt vmcnt(0)
v_readfirstlane_b32 s76,v23
s_cmp_eq_u32 s76,0
s_cbranch_scc1 L_ww_210
L_wwd_211:
s_branch L_ckb_193
L_cend_202:
v_add_u32 v52,s50,v5
v_add_u32 v54,s50,v6
ds_read_b64_tr_b16 v[52:53],v52
ds_read_b64_tr_b16 v[54:55],v54
v_mov_b32_dpp v124,v126 quad_perm:[2,3,2,3] row_mask:0xf bank_mask:0xf
v_mov_b32_dpp v125,v127 quad_perm:[2,3,2,3] row_mask:0xf bank_mask:0xf
s_mov_b32 vcc_lo,0xcccccccc
s_mov_b32 vcc_hi,0xcccccccc
s_waitcnt lgkmcnt(0)
v_cndmask_b32 v124,v124,v52,vcc
v_cndmask_b32 v125,v125,v53,vcc
v_cndmask_b32 v126,v126,v54,vcc
v_cndmask_b32 v127,v127,v55,vcc
buffer_store_dwordx4 v[124:127],v0,s[8:11],s54 offen sc1
s_waitcnt vmcnt(0)
s_barrier
s_nop 11
v_lshrrev_b32 v1,4,v0
s_branch L_ra_6
L_rc1_189:
v_and_b32 v120,15,v1
v_lshrrev_b32 v121,4,v1
v_and_b32 v122,2,v1
v_cmp_eq_u32 vcc,0,v122
v_mov_b32 v2,0xeeee
v_mov_b32 v123,0x4444
v_cndmask_b32 v2,v2,v123,vcc
v_and_b32 v122,1,v1
v_cmp_eq_u32 vcc,0,v122
v_mov_b32 v3,0xdddd
v_mov_b32 v123,0x8888
v_cndmask_b32 v3,v3,v123,vcc
v_lshrrev_b32 v122,1,v120
v_bfe_u32 v123,v120,2,1
v_xor_b32 v123,v123,v122
v_lshlrev_b32 v4,7,v123
v_and_b32 v123,1,v120
v_lshl_add_u32 v4,v123,6,v4
v_xor_b32 v123,v121,v122
v_and_b32 v123,3,v123
v_lshl_add_u32 v4,v123,4,v4
s_lshl_b32 s56,s46,10
s_add_u32 s56,s56,147456
v_add_u32 v4,s56,v4
v_lshlrev_b32 v122,1,v121
v_add_u32 v122,0,v122
v_and_b32 v123,1,v121
v_xor_b32 v123,v123,v122
v_lshlrev_b32 v5,7,v123
v_bfe_u32 v123,v120,3,1
v_lshl_add_u32 v5,v123,6,v5
v_xor_b32 v123,v120,v122
v_and_b32 v123,3,v123
v_lshl_add_u32 v5,v123,4,v5
v_bfe_u32 v123,v120,2,1
v_lshl_add_u32 v5,v123,3,v5
v_add_u32 v5,147456,v5
v_lshlrev_b32 v122,1,v121
v_add_u32 v122,1,v122
v_and_b32 v123,1,v121
v_xor_b32 v123,v123,v122
v_lshlrev_b32 v6,7,v123
v_bfe_u32 v123,v120,3,1
v_lshl_add_u32 v6,v123,6,v6
v_xor_b32 v123,v120,v122
v_and_b32 v123,3,v123
v_lshl_add_u32 v6,v123,4,v6
v_bfe_u32 v123,v120,2,1
v_lshl_add_u32 v6,v123,3,v6
v_add_u32 v6,147456,v6
v_lshlrev_b32 v7,7,v121
v_lshrrev_b32 v122,1,v120
v_lshl_add_u32 v8,v122,4,v7
v_add_u32 v8,151552,v8
v_lshrrev_b32 v122,2,v120
v_lshl_add_u32 v7,v122,5,v7
v_and_b32 v122,1,v120
v_lshl_add_u32 v7,v122,4,v7
v_and_b32 v122,2,v120
v_cmp_eq_u32 vcc,0,v122
s_lshl_b32 s56,s46,9
v_mov_b32 v122,2048
v_mov_b32 v123,s56
v_cndmask_b32 v122,v122,v123,vcc
v_add_u32 v7,v122,v7
v_add_u32 v7,151552,v7
v_lshrrev_b32 v122,3,v1
v_lshlrev_b32 v9,11,v122
v_and_b32 v122,7,v1
v_lshl_add_u32 v9,v122,3,v9
s_lshl_b32 s56,s46,14
s_lshl_b32 s57,s47,6
s_add_u32 s56,s56,s57
v_add_u32 v9,s56,v9
s_lshl_b32 s71,s47,2
s_add_u32 s71,s71,s46
s_bfe_u32 s56,s71,0x10003
s_lshl_b32 s56,s56,11
s_and_b32 s57,s71,1
s_lshl_b32 s57,s57,10
s_add_u32 s56,s56,s57
s_bfe_u32 s57,s71,0x10002
s_lshl_b32 s57,s57,9
s_add_u32 s56,s56,s57
s_bfe_u32 s57,s71,0x10001
s_lshl_b32 s57,s57,6
s_add_u32 s56,s56,s57
s_bfe_u32 s57,s71,0x10004
s_lshl_b32 s57,s57,8
s_add_u32 s56,s56,s57
s_bfe_u32 s57,s71,0x10005
s_lshl_b32 s57,s57,7
s_add_u32 s56,s56,s57
s_bfe_u32 s57,s71,0x10006
s_lshl_b32 s57,s57,12
s_add_u32 s56,s56,s57
v_and_b32 v122,3,v120
v_lshlrev_b32 v10,2,v122
v_bfe_u32 v122,v120,3,1
v_lshl_add_u32 v10,v122,4,v10
v_and_b32 v122,1,v121
v_lshl_add_u32 v10,v122,5,v10
v_add_u32 v10,s56,v10
v_and_b32 v123,36,v1
v_mov_b32 v122,0x80000000
v_cmp_eq_u32 vcc,0,v123
s_nop 1
v_cndmask_b32 v10,v122,v10,vcc
s_lshl_b32 s56,s46,15
v_add_u32 v11,s56,v0
s_lshl_b32 s71,s71,11
s_lshl_b32 s73,s46,11
s_mov_b32 s72,0xffc00000
s_mov_b32 s74,0
v_lshrrev_b32 v13,3,v1
v_lshlrev_b32 v13,9,v13
v_and_b32 v122,7,v1
v_lshl_add_u32 v13,v122,4,v13
v_and_b32 v122,15,v1
v_and_b32 v123,1,v1
v_lshlrev_b32 v123,4,v123
v_mov_b32 v124,0x3f80
v_lshlrev_b32 v124,v123,v124
v_lshrrev_b32 v122,1,v122
v_cmp_eq_u32 vcc,0,v122
s_nop 1
v_cndmask_b32 v18,0,v124,vcc
v_cmp_eq_u32 vcc,1,v122
s_nop 1
v_cndmask_b32 v19,0,v124,vcc
v_cmp_eq_u32 vcc,2,v122
s_nop 1
v_cndmask_b32 v20,0,v124,vcc
v_cmp_eq_u32 vcc,3,v122
s_nop 1
v_cndmask_b32 v21,0,v124,vcc
s_and_b32 s56,s46,1
s_lshl_b32 s56,s56,8
s_and_b32 s57,s46,2
s_lshl_b32 s57,s57,6
s_add_u32 s56,s56,s57
v_add_u32 v13,s56,v13
s_add_u32 s56,s50,155648
v_add_u32 v12,s56,v0
v_mov_b64 v[14:15],s[28:29]
v_mov_b64 v[16:17],s[28:29]
v_add_u32 v22,12599296,v10
s_lshl_b32 s56,s47,2
s_add_u32 s56,s56,10502272
s_or_b32 s56,s56,s52
v_writelane_b32 v22,s56,4
v_mov_b32 v1,s80
s_mov_b32 s65,15728640
s_add_u32 s66,s71,15728640
s_add_u32 s69,s71,15990784
s_lshl_b32 s79,s47,2
s_add_u32 s79,s79,10486272
s_cmp_eq_u32 s46,0
s_cselect_b32 s79,s79,0x80000000
s_mov_b32 s30,0x40000000
s_mov_b32 s51,0
L_cst_212:
s_cmp_lg_u32 s46,0
s_cbranch_scc1 L_csw_217
s_lshl_b32 s59,s51,13
s_lshl2_add_u32 s59,s47,s59
s_add_u32 s59,s59,10485888
L_ww_218:
s_sleep 1
buffer_load_dword v122,off,s[8:11],s59 sc1
s_sub_u32 s49,s49,1
s_cbranch_scc1 L_abort2
s_waitcnt vmcnt(0)
v_readfirstlane_b32 s61,v122
s_cmp_eq_u32 s61,0
s_cbranch_scc1 L_ww_218
L_wwd_219:
L_csw_217:
s_waitcnt lgkmcnt(0)
s_barrier
s_lshl_b32 s56,s51,5
s_add_u32 s56,s56,s47
s_mul_i32 s56,s56,24576
s_add_u32 s56,s56,150994944
s_add_u32 s67,s56,s73
s_add_u32 m0,s73,131072
s_add_u32 s57,s67,8192
buffer_load_dwordx4 v0,s[8:11],s67 offen sc1 lds
buffer_load_dwordx4 v0,s[8:11],s67 offen offset:1024 sc1 lds
s_add_u32 m0,s73,139264
s_add_u32 s67,s67,786432
buffer_load_dwordx4 v0,s[8:11],s57 offen sc1 lds
buffer_load_dwordx4 v0,s[8:11],s57 offen offset:1024 sc1 lds
s_lshl_b32 s75,s51,13
s_add_u32 s64,s75,12582912
s_add_u32 s70,s64,4096
s_lshl_b32 s68,s51,5
s_add_u32 s68,s68,s47
s_lshl_b32 s68,s68,12
s_lshl_b32 s56,s46,10
s_add_u32 s68,s68,s56
s_add_u32 s68,s68,58720256
s_mov_b32 s78,0x80000000
s_mov_b32 s55,0x80000000
s_mov_b32 s54,0x80000000
s_mov_b32 s77,0
s_cmp_eq_u32 s51,63
s_cselect_b32 s76,1,s46
v_mov_b64 v[96:97],0
v_mov_b64 v[98:99],0
v_mov_b64 v[100:101],0
v_mov_b64 v[102:103],0
v_mov_b64 v[104:105],0
v_mov_b64 v[106:107],0
v_mov_b64 v[108:109],0
v_mov_b64 v[110:111],0
v_mov_b64 v[112:113],0
v_mov_b64 v[114:115],0
v_mov_b64 v[116:117],0
v_mov_b64 v[118:119],0
s_waitcnt vmcnt(0) lgkmcnt(0)
s_barrier
v_add_u32 v55,131072,v0
ds_read_b128 v[56:59],v55 offset:0
ds_read_b128 v[60:63],v55 offset:4096
ds_read_b128 v[64:67],v55 offset:1024
ds_read_b128 v[68:71],v55 offset:5120
ds_read_b128 v[72:75],v55 offset:2048
ds_read_b128 v[76:79],v55 offset:6144
ds_read_b128 v[80:83],v55 offset:3072
ds_read_b128 v[84:87],v55 offset:7168
v_add_u32 v123,s73,v55
ds_read_b128 v[88:91],v123 offset:8192
ds_read_b128 v[92:95],v123 offset:9216
v_xor_b32 v120,1024,v12
v_xor_b32 v121,2048,v12
v_xor_b32 v122,3072,v12
buffer_load_dwordx4 v[24:27],v13,s[8:11],s64 offen sc1
buffer_load_dwordx4 v[40:43],v13,s[8:11],s70 offen sc1
L_chain_220:
L_cpa_221:
buffer_load_dwordx4 v[24:27],v13,s[8:11],s64 offen sc1
buffer_load_dwordx4 v[40:43],v13,s[8:11],s70 offen sc1
s_sub_u32 s49,s49,1
s_cbranch_scc1 L_abort2
s_waitcnt vmcnt(2)
v_max3_u32 v123,v24,v25,v26
v_max3_u32 v123,v27,v40,v123
v_max3_u32 v123,v41,v42,v123
v_max_u32 v123,v43,v123
v_cmp_le_u32 vcc,s72,v123
s_cbranch_vccnz L_cpa_221
ds_write_b128 v12,v[24:27] offset:0
ds_write_b128 v12,v[40:43] offset:4096
v_smfmac_f32_16x16x64_bf16 v[96:99],v[24:27],a[0:7],v2
buffer_store_dwordx4 v[124:127],v0,s[8:11],s54 offen sc1
v_smfmac_f32_16x16x64_bf16 v[100:103],v[24:27],a[128:135],v2
buffer_store_dword v54,v10,s[8:11],s30 offen sc1
s_add_u32 m0,s73,131072
s_add_u32 s57,s67,8192
v_smfmac_f32_16x16x64_bf16 v[104:107],v[24:27],a[8:15],v2
s_cmp_eq_u32 s76,0
v_smfmac_f32_16x16x64_bf16 v[108:111],v[24:27],a[136:143],v2
s_cbranch_scc1 L_ckw_213
L_ckb_214:
s_waitcnt lgkmcnt(0)
s_barrier
ds_read_b128 v[28:31],v120 offset:0
ds_read_b128 v[32:35],v121 offset:0
v_smfmac_f32_16x16x64_bf16 v[96:99],v[40:43],a[64:71],v2
ds_read_b128 v[36:39],v122 offset:0
v_smfmac_f32_16x16x64_bf16 v[100:103],v[40:43],a[192:199],v2
ds_read_b128 v[44:47],v120 offset:4096
v_smfmac_f32_16x16x64_bf16 v[104:107],v[40:43],a[72:79],v2
ds_read_b128 v[48:51],v121 offset:4096
v_smfmac_f32_16x16x64_bf16 v[108:111],v[40:43],a[200:207],v2
ds_read_b128 v[52:55],v122 offset:4096
v_smfmac_f32_16x16x64_bf16 v[112:115],v[24:27],v[128:135],v2
buffer_load_dwordx4 v0,s[8:11],s67 offen sc1 lds
v_smfmac_f32_16x16x64_bf16 v[116:119],v[24:27],v[136:143],v2
v_smfmac_f32_16x16x64_bf16 v[112:115],v[40:43],v[192:199],v2
buffer_load_dwordx4 v0,s[8:11],s67 offen offset:1024 sc1 lds
v_smfmac_f32_16x16x64_bf16 v[116:119],v[40:43],v[200:207],v2
s_waitcnt lgkmcnt(5)
v_smfmac_f32_16x16x64_bf16 v[96:99],v[28:31],a[16:23],v2
s_add_u32 m0,s73,139264
v_smfmac_f32_16x16x64_bf16 v[100:103],v[28:31],a[144:151],v2
buffer_load_dwordx4 v0,s[8:11],s57 offen sc1 lds
v_smfmac_f32_16x16x64_bf16 v[104:107],v[28:31],a[24:31],v2
s_add_u32 s67,s67,786432
v_smfmac_f32_16x16x64_bf16 v[108:111],v[28:31],a[152:159],v2
s_waitcnt lgkmcnt(4)
v_smfmac_f32_16x16x64_bf16 v[96:99],v[32:35],a[32:39],v2
buffer_load_dwordx4 v0,s[8:11],s57 offen offset:1024 sc1 lds
v_smfmac_f32_16x16x64_bf16 v[100:103],v[32:35],a[160:167],v2
v_smfmac_f32_16x16x64_bf16 v[104:107],v[32:35],a[40:47],v2
v_smfmac_f32_16x16x64_bf16 v[108:111],v[32:35],a[168:175],v2
buffer_load_dword v23,v22,s[8:11],s75 offen sc1
s_waitcnt lgkmcnt(3)
v_smfmac_f32_16x16x64_bf16 v[96:99],v[36:39],a[48:55],v2
v_mov_b32 v125,0
v_smfmac_f32_16x16x64_bf16 v[100:103],v[36:39],a[176:183],v2
v_smfmac_f32_16x16x64_bf16 v[104:107],v[36:39],a[56:63],v2
buffer_store_dword v2,off,s[8:11],s78 sc1
v_smfmac_f32_16x16x64_bf16 v[108:111],v[36:39],a[184:191],v2
s_waitcnt lgkmcnt(0)
v_smfmac_f32_16x16x64_bf16 v[96:99],v[44:47],a[80:87],v2
v_smfmac_f32_16x16x64_bf16 v[100:103],v[44:47],a[208:215],v2
v_smfmac_f32_16x16x64_bf16 v[96:99],v[48:51],a[96:103],v2
v_smfmac_f32_16x16x64_bf16 v[100:103],v[48:51],a[224:231],v2
v_smfmac_f32_16x16x64_bf16 v[96:99],v[52:55],a[112:119],v2
v_smfmac_f32_16x16x64_bf16 v[100:103],v[52:55],a[240:247],v2
v_smfmac_f32_16x16x64_bf16 v[104:107],v[44:47],a[88:95],v2
v_smfmac_f32_16x16x64_bf16 v[108:111],v[44:47],a[216:223],v2
v_smfmac_f32_16x16x64_bf16 v[104:107],v[48:51],a[104:111],v2
v_add_f32 v96,v96,v98
v_smfmac_f32_16x16x64_bf16 v[108:111],v[48:51],a[232:239],v2
v_add_f32 v97,v97,v99
v_smfmac_f32_16x16x64_bf16 v[104:107],v[52:55],a[120:127],v2
v_cvt_pk_bf16_f32 v120,v96,v97
v_smfmac_f32_16x16x64_bf16 v[108:111],v[52:55],a[248:255],v2
v_add_f32 v100,v100,v102
v_smfmac_f32_16x16x64_bf16 v[112:115],v[28:31],v[144:151],v2
v_add_f32 v101,v101,v103
v_smfmac_f32_16x16x64_bf16 v[116:119],v[28:31],v[152:159],v2
v_cvt_pk_bf16_f32 v121,v100,v101
v_add_f32 v104,v104,v106
v_add_f32 v105,v105,v107
v_cvt_pk_bf16_f32 v122,v104,v105
v_add_f32 v108,v108,v110
v_add_f32 v109,v109,v111
v_cvt_pk_bf16_f32 v123,v108,v109
ds_write_b128 v4,v[120:123]
v_smfmac_f32_16x16x64_bf16 v[112:115],v[32:35],v[160:167],v2
v_smfmac_f32_16x16x64_bf16 v[116:119],v[32:35],v[168:175],v2
v_smfmac_f32_16x16x64_bf16 v[112:115],v[36:39],v[176:183],v2
v_smfmac_f32_16x16x64_bf16 v[116:119],v[36:39],v[184:191],v2
s_waitcnt vmcnt(8) lgkmcnt(0)
s_barrier
ds_read_b64_tr_b16 v[96:97],v5 offset:0
ds_read_b64_tr_b16 v[98:99],v6 offset:0
v_smfmac_f32_16x16x64_bf16 v[112:115],v[44:47],v[208:215],v2
ds_read_b64_tr_b16 v[100:101],v5 offset:1024
v_smfmac_f32_16x16x64_bf16 v[116:119],v[44:47],v[216:223],v2
ds_read_b64_tr_b16 v[102:103],v6 offset:1024
v_smfmac_f32_16x16x64_bf16 v[112:115],v[48:51],v[224:231],v2
ds_read_b64_tr_b16 v[104:105],v5 offset:2048
v_smfmac_f32_16x16x64_bf16 v[116:119],v[48:51],v[232:239],v2
ds_read_b64_tr_b16 v[106:107],v6 offset:2048
s_waitcnt lgkmcnt(4)
v_mfma_f32_16x16x32_bf16 v[24:27],v[56:59],v[96:99],0
ds_read_b64_tr_b16 v[108:109],v5 offset:3072
v_mfma_f32_16x16x32_bf16 v[28:31],v[60:63],v[96:99],0
ds_read_b64_tr_b16 v[110:111],v6 offset:3072
v_mfma_f32_16x16x32_bf16 v[32:35],v[96:99],v[96:99],0
ds_read_b128 v[40:43],v11 offset:12288
s_waitcnt lgkmcnt(5)
v_mfma_f32_16x16x32_bf16 v[24:27],v[64:67],v[100:103],v[24:27]
ds_read_b128 v[56:59],v11 offset:0
v_mfma_f32_16x16x32_bf16 v[28:31],v[68:71],v[100:103],v[28:31]
ds_read_b128 v[60:63],v11 offset:1024
v_mfma_f32_16x16x32_bf16 v[32:35],v[100:103],v[100:103],v[32:35]
ds_read_b128 v[96:99],v11 offset:8192
s_waitcnt lgkmcnt(6)
v_mfma_f32_16x16x32_bf16 v[24:27],v[72:75],v[104:107],v[24:27]
ds_read_b128 v[64:67],v11 offset:2048
v_mfma_f32_16x16x32_bf16 v[28:31],v[76:79],v[104:107],v[28:31]
ds_read_b128 v[68:71],v11 offset:3072
v_mfma_f32_16x16x32_bf16 v[32:35],v[104:107],v[104:107],v[32:35]
ds_read_b128 v[100:103],v11 offset:9216
s_waitcnt lgkmcnt(7)
v_mfma_f32_16x16x32_bf16 v[24:27],v[80:83],v[108:111],v[24:27]
ds_read_b128 v[72:75],v11 offset:4096
v_mfma_f32_16x16x32_bf16 v[28:31],v[84:87],v[108:111],v[28:31]
ds_read_b128 v[76:79],v11 offset:5120
v_mfma_f32_16x16x32_bf16 v[32:35],v[108:111],v[108:111],v[32:35]
ds_read_b128 v[104:107],v11 offset:10240
v_smfmac_f32_16x16x64_bf16 v[112:115],v[52:55],v[240:247],v2
ds_read_b128 v[80:83],v11 offset:6144
v_smfmac_f32_16x16x64_bf16 v[116:119],v[52:55],v[248:255],v2
ds_read_b128 v[84:87],v11 offset:7168
v_max3_f32 v126,v24,v25,v26
v_max3_f32 v127,v27,v28,v29
v_max3_f32 v126,v30,v31,v126
v_max3_f32 v127,v34,v35,v127
v_max_f32 v126,v126,v127
v_max_f32 v127,v126,v127
v_pk_mul_f32 v[34:35],v[34:35],v[0:1] op_sel:[0,1]
v_pk_mul_f32 v[24:25],v[24:25],v[0:1] op_sel:[0,1]
v_permlane16_swap_b32 v126,v127
v_max_f32 v126,v126,v127
v_max_f32 v127,v126,v127
v_pk_mul_f32 v[26:27],v[26:27],v[0:1] op_sel:[0,1]
v_pk_mul_f32 v[28:29],v[28:29],v[0:1] op_sel:[0,1]
v_permlane32_swap_b32 v126,v127
v_max_f32 v126,v126,v127
v_mul_f32 v126,v1,v126
v_pk_mul_f32 v[30:31],v[30:31],v[0:1] op_sel:[0,1]
v_pk_add_f32 v[34:35],v[34:35],v[126:127] op_sel_hi:[1,0] neg_lo:[0,1] neg_hi:[0,1]
v_pk_add_f32 v[112:113],v[112:113],v[114:115]
v_pk_add_f32 v[116:117],v[116:117],v[118:119]
v_pk_add_f32 v[24:25],v[24:25],v[126:127] op_sel_hi:[1,0] neg_lo:[0,1] neg_hi:[0,1]
v_pk_add_f32 v[26:27],v[26:27],v[126:127] op_sel_hi:[1,0] neg_lo:[0,1] neg_hi:[0,1]
v_pk_add_f32 v[28:29],v[28:29],v[126:127] op_sel_hi:[1,0] neg_lo:[0,1] neg_hi:[0,1]
v_pk_add_f32 v[30:31],v[30:31],v[126:127] op_sel_hi:[1,0] neg_lo:[0,1] neg_hi:[0,1]
v_exp_f32 v34,v34
v_exp_f32 v35,v35
v_cvt_pk_bf16_f32 v126,v112,v113
v_cvt_pk_bf16_f32 v124,v34,v35
v_cvt_pk_bf16_f32 v127,v116,v117
v_cvt_pk_bf16_f32 v36,v116,v117
v_mfma_f32_16x16x16_bf16 v[32:35],v[14:15],v[124:125],0
ds_read_b128 v[108:111],v11 offset:11264
v_exp_f32 v24,v24
v_mfma_f32_16x16x16_bf16 v[112:115],v[126:127],v[124:125],0
ds_read_b128 v[44:47],v11 offset:13312
v_exp_f32 v25,v25
v_mfma_f32_16x16x16_bf16 v[116:119],v[36:37],v[124:125],0
ds_read_b128 v[48:51],v11 offset:14336
v_exp_f32 v26,v26
v_exp_f32 v27,v27
v_cvt_pk_bf16_f32 v120,v24,v25
v_exp_f32 v28,v28
v_exp_f32 v29,v29
v_cvt_pk_bf16_f32 v121,v26,v27
v_exp_f32 v30,v30
v_exp_f32 v31,v31
v_cvt_pk_bf16_f32 v122,v28,v29
v_cvt_pk_bf16_f32 v123,v30,v31
s_mov_b32 s78,s55
s_add_u32 s55,s79,s75
v_mfma_f32_16x16x32_bf16 v[32:35],v[14:17],v[120:123],v[32:35]
ds_read_b128 v[52:55],v11 offset:15360
v_mfma_f32_16x16x32_bf16 v[112:115],v[88:91],v[120:123],v[112:115]
ds_read_b128 v[88:91],v11 offset:16384
v_mfma_f32_16x16x32_bf16 v[116:119],v[92:95],v[120:123],v[116:119]
ds_read_b128 v[92:95],v11 offset:17408
v_rcp_f32 v32,v32
v_mov_b64 v[24:25],-1
v_mov_b64 v[26:27],-1
s_mov_b32 s54,s68
s_add_u32 s75,s75,8192
v_pk_mul_f32 v[112:113],v[112:113],v[32:33] op_sel_hi:[1,0]
v_pk_mul_f32 v[114:115],v[114:115],v[32:33] op_sel_hi:[1,0]
v_pk_mul_f32 v[116:117],v[116:117],v[32:33] op_sel_hi:[1,0]
v_pk_mul_f32 v[118:119],v[118:119],v[32:33] op_sel_hi:[1,0]
v_cvt_pk_bf16_f32 v120,v112,v116
v_cvt_pk_bf16_f32 v121,v113,v117
v_cvt_pk_bf16_f32 v122,v114,v118
v_cvt_pk_bf16_f32 v123,v115,v119
ds_write_b128 v7,v[120:123]
buffer_store_dwordx4 v[24:27],v0,s[8:11],s69 offen sc1
buffer_store_dwordx4 v[24:27],v0,s[8:11],s69 offen offset:1024 sc1
s_waitcnt lgkmcnt(0)
s_barrier
ds_read_b128 v[24:27],v8 offset:0
ds_read_b128 v[28:31],v8 offset:512
ds_read_b128 v[32:35],v8 offset:1024
ds_read_b128 v[36:39],v8 offset:1536
v_mov_b64 v[112:113],0
v_mov_b64 v[114:115],0
v_mov_b64 v[116:117],0
v_mov_b64 v[118:119],0
v_mov_b64 v[120:121],0
v_mov_b64 v[122:123],0
s_add_u32 s30,s75,17825792
s_add_u32 s64,s75,12582912
s_add_u32 s70,s64,4096
s_add_u32 s68,s68,131072
s_add_u32 s51,s51,1
s_cmp_eq_u32 s51,64
s_cbranch_scc1 L_cend_223
s_waitcnt lgkmcnt(3)
v_smfmac_f32_16x16x64_bf16 v[112:115],v[24:27],v[56:63],v3
ds_read_b128 v[56:59],v11 offset:18432
s_add_u32 s57,s65,65536
s_waitcnt lgkmcnt(3)
v_smfmac_f32_16x16x64_bf16 v[112:115],v[28:31],v[64:71],v3
ds_read_b128 v[60:63],v11 offset:19456
s_add_u32 s58,s65,131072
s_waitcnt lgkmcnt(3)
v_smfmac_f32_16x16x64_bf16 v[112:115],v[32:35],v[72:79],v3
ds_read_b128 v[64:67],v11 offset:20480
s_add_u32 s59,s65,196608
s_waitcnt lgkmcnt(3)
v_smfmac_f32_16x16x64_bf16 v[112:115],v[36:39],v[80:87],v3
ds_read_b128 v[68:71],v11 offset:21504
v_smfmac_f32_16x16x64_bf16 v[116:119],v[24:27],v[96:103],v3
ds_read_b128 v[72:75],v11 offset:22528
v_smfmac_f32_16x16x64_bf16 v[116:119],v[28:31],v[104:111],v3
ds_read_b128 v[76:79],v11 offset:23552
v_cvt_pk_bf16_f32 v112,v112,v113
v_smfmac_f32_16x16x64_bf16 v[116:119],v[32:35],v[40:47],v3
ds_read_b128 v[80:83],v11 offset:24576
v_cvt_pk_bf16_f32 v113,v114,v115
buffer_store_dwordx2 v[112:113],v9,s[8:11],s65 offen sc1
v_smfmac_f32_16x16x64_bf16 v[116:119],v[36:39],v[48:55],v3
ds_read_b128 v[84:87],v11 offset:25600
v_mov_b64 v[112:113],0
v_smfmac_f32_16x16x64_bf16 v[120:123],v[24:27],v[88:95],v3
ds_read_b128 v[96:99],v11 offset:26624
ds_read_b128 v[100:103],v11 offset:27648
v_mov_b64 v[114:115],0
s_waitcnt lgkmcnt(8)
v_smfmac_f32_16x16x64_bf16 v[120:123],v[28:31],v[56:63],v3
ds_read_b128 v[104:107],v11 offset:28672
v_cvt_pk_bf16_f32 v116,v116,v117
s_waitcnt lgkmcnt(7)
v_smfmac_f32_16x16x64_bf16 v[120:123],v[32:35],v[64:71],v3
ds_read_b128 v[108:111],v11 offset:29696
ds_read_b128 v[40:43],v11 offset:30720
v_cvt_pk_bf16_f32 v117,v118,v119
buffer_store_dwordx2 v[116:117],v9,s[8:11],s57 offen sc1
s_waitcnt lgkmcnt(7)
v_smfmac_f32_16x16x64_bf16 v[120:123],v[36:39],v[72:79],v3
ds_read_b128 v[44:47],v11 offset:31744
s_waitcnt lgkmcnt(6)
v_smfmac_f32_16x16x64_bf16 v[112:115],v[24:27],v[80:87],v3
s_waitcnt lgkmcnt(4)
v_smfmac_f32_16x16x64_bf16 v[112:115],v[28:31],v[96:103],v3
v_cvt_pk_bf16_f32 v120,v120,v121
s_waitcnt lgkmcnt(2)
v_smfmac_f32_16x16x64_bf16 v[112:115],v[32:35],v[104:111],v3
v_cvt_pk_bf16_f32 v121,v122,v123
buffer_store_dwordx2 v[120:121],v9,s[8:11],s58 offen sc1
s_waitcnt lgkmcnt(0)
v_smfmac_f32_16x16x64_bf16 v[112:115],v[36:39],v[40:47],v3
v_mov_b64 v[116:117],0
v_mov_b64 v[118:119],0
s_xor_b32 s65,s65,262144
v_add_u32 v52,s50,v5
v_add_u32 v54,s50,v6
v_mov_b32_dpp v124,v126 quad_perm:[2,3,2,3] row_mask:0xf bank_mask:0xf
v_mov_b32_dpp v125,v127 quad_perm:[2,3,2,3] row_mask:0xf bank_mask:0xf
s_nop 0
v_cvt_pk_bf16_f32 v112,v112,v113
v_cvt_pk_bf16_f32 v113,v114,v115
buffer_store_dwordx2 v[112:113],v9,s[8:11],s59 offen sc1
ds_read_b64_tr_b16 v[52:53],v52
ds_read_b64_tr_b16 v[54:55],v54
s_mov_b32 vcc_lo,0xcccccccc
s_mov_b32 vcc_hi,0xcccccccc
v_mov_b64 v[96:97],0
v_mov_b64 v[98:99],0
v_mov_b64 v[100:101],0
v_mov_b64 v[102:103],0
v_mov_b64 v[104:105],0
v_mov_b64 v[106:107],0
v_mov_b64 v[108:109],0
v_mov_b64 v[110:111],0
v_mov_b64 v[112:113],0
v_mov_b64 v[114:115],0
s_waitcnt lgkmcnt(0)
v_cndmask_b32 v124,v124,v52,vcc
v_cndmask_b32 v125,v125,v53,vcc
v_cndmask_b32 v126,v126,v54,vcc
v_cndmask_b32 v127,v127,v55,vcc
v_add_u32 v55,131072,v0
v_add_u32 v123,s73,v55
v_xor_b32 v120,1024,v12
v_xor_b32 v121,2048,v12
v_xor_b32 v122,3072,v12
s_waitcnt vmcnt(0)
buffer_load_dwordx4 v[32:35],v0,s[8:11],s66 offen offset:0 sc1
buffer_load_dwordx4 v[36:39],v0,s[8:11],s66 offen offset:1024 sc1
v_readlane_b32 s76,v23,4
s_cmp_ge_u32 s51,63
s_cselect_b32 s76,1,s76
s_or_b32 s76,s76,s46
s_waitcnt vmcnt(1)
v_mfma_f32_16x16x32_bf16 v[28:31],v[18:21],v[32:35],0
s_waitcnt vmcnt(0)
v_mfma_f32_16x16x32_bf16 v[28:31],v[18:21],v[36:39],v[28:31]
s_nop 7
v_cmp_u_f32 vcc,v28,v28
v_add_f32_dpp v52,v28,v28 row_ror:8 row_mask:0xf bank_mask:0x3
v_add_f32_dpp v53,v29,v29 row_ror:8 row_mask:0xf bank_mask:0x3
v_add_f32_dpp v52,v30,v30 row_ror:8 row_mask:0xf bank_mask:0xc
v_add_f32_dpp v53,v31,v31 row_ror:8 row_mask:0xf bank_mask:0xc
s_nop 0
v_add_f32_dpp v52,v52,v52 row_shl:4 row_mask:0xf bank_mask:0x5
v_add_f32_dpp v53,v53,v53 row_shl:4 row_mask:0xf bank_mask:0x5
s_cbranch_vccnz L_crp_225
L_cok_230:
v_cvt_pk_bf16_f32 v54,v52,v53
buffer_store_dword v54,v10,s[8:11],s64 offen sc1
s_mov_b32 s69,s66
s_xor_b32 s66,s66,262144
s_barrier
ds_read_b128 v[56:59],v55 offset:0
ds_read_b128 v[60:63],v55 offset:4096
buffer_load_dwordx4 v[24:27],v13,s[8:11],s64 offen sc1
buffer_load_dwordx4 v[40:43],v13,s[8:11],s70 offen sc1
ds_read_b128 v[64:67],v55 offset:1024
ds_read_b128 v[68:71],v55 offset:5120
ds_read_b128 v[72:75],v55 offset:2048
ds_read_b128 v[76:79],v55 offset:6144
ds_read_b128 v[80:83],v55 offset:3072
ds_read_b128 v[84:87],v55 offset:7168
ds_read_b128 v[88:91],v123 offset:8192
ds_read_b128 v[92:95],v123 offset:9216
s_branch L_chain_220
L_crp_225:
buffer_load_dwordx4 v[32:35],v0,s[8:11],s66 offen offset:0 sc1
buffer_load_dwordx4 v[36:39],v0,s[8:11],s66 offen offset:1024 sc1
s_sub_u32 s49,s49,1
s_cbranch_scc1 L_abort2
s_waitcnt vmcnt(1)
v_mfma_f32_16x16x32_bf16 v[28:31],v[18:21],v[32:35],0
s_waitcnt vmcnt(0)
v_mfma_f32_16x16x32_bf16 v[28:31],v[18:21],v[36:39],v[28:31]
s_nop 7
v_cmp_u_f32 vcc,v28,v28
v_add_f32_dpp v52,v28,v28 row_ror:8 row_mask:0xf bank_mask:0x3
v_add_f32_dpp v53,v29,v29 row_ror:8 row_mask:0xf bank_mask:0x3
v_add_f32_dpp v52,v30,v30 row_ror:8 row_mask:0xf bank_mask:0xc
v_add_f32_dpp v53,v31,v31 row_ror:8 row_mask:0xf bank_mask:0xc
s_nop 0
v_add_f32_dpp v52,v52,v52 row_shl:4 row_mask:0xf bank_mask:0x5
v_add_f32_dpp v53,v53,v53 row_shl:4 row_mask:0xf bank_mask:0x5
s_cbranch_vccz L_cok_230
s_branch L_crp_225
L_ckw_213:
s_lshl2_add_u32 s59,s47,s75
s_add_u32 s59,s59,10494080
L_ww_231:
s_sleep 1
buffer_load_dword v23,off,s[8:11],s59 sc1
s_sub_u32 s49,s49,1
s_cbranch_scc1 L_abort2
s_waitcnt vmcnt(0)
v_readfirstlane_b32 s76,v23
s_cmp_eq_u32 s76,0
s_cbranch_scc1 L_ww_231
L_wwd_232:
s_branch L_ckb_214
L_cend_223:
v_add_u32 v52,s50,v5
v_add_u32 v54,s50,v6
ds_read_b64_tr_b16 v[52:53],v52
ds_read_b64_tr_b16 v[54:55],v54
v_mov_b32_dpp v124,v126 quad_perm:[2,3,2,3] row_mask:0xf bank_mask:0xf
v_mov_b32_dpp v125,v127 quad_perm:[2,3,2,3] row_mask:0xf bank_mask:0xf
s_mov_b32 vcc_lo,0xcccccccc
s_mov_b32 vcc_hi,0xcccccccc
s_waitcnt lgkmcnt(0)
v_cndmask_b32 v124,v124,v52,vcc
v_cndmask_b32 v125,v125,v53,vcc
v_cndmask_b32 v126,v126,v54,vcc
v_cndmask_b32 v127,v127,v55,vcc
buffer_store_dwordx4 v[124:127],v0,s[8:11],s54 offen sc1
s_waitcnt vmcnt(0)
s_barrier
buffer_store_dword v2,off,s[8:11],s78 sc1
buffer_store_dword v2,off,s[8:11],s55 sc1
s_nop 11
v_lshrrev_b32 v1,4,v0
s_endpgm
L_rc2_190:
v_and_b32 v120,15,v1
v_lshrrev_b32 v121,4,v1
v_and_b32 v122,2,v1
v_cmp_eq_u32 vcc,0,v122
v_mov_b32 v2,0xeeee
v_mov_b32 v123,0x4444
v_cndmask_b32 v2,v2,v123,vcc
v_and_b32 v122,1,v1
v_cmp_eq_u32 vcc,0,v122
v_mov_b32 v3,0xdddd
v_mov_b32 v123,0x8888
v_cndmask_b32 v3,v3,v123,vcc
v_lshrrev_b32 v122,1,v120
v_bfe_u32 v123,v120,2,1
v_xor_b32 v123,v123,v122
v_lshlrev_b32 v4,7,v123
v_and_b32 v123,1,v120
v_lshl_add_u32 v4,v123,6,v4
v_xor_b32 v123,v121,v122
v_and_b32 v123,3,v123
v_lshl_add_u32 v4,v123,4,v4
s_lshl_b32 s56,s46,10
s_add_u32 s56,s56,147456
v_add_u32 v4,s56,v4
v_lshlrev_b32 v122,1,v121
v_add_u32 v122,0,v122
v_and_b32 v123,1,v121
v_xor_b32 v123,v123,v122
v_lshlrev_b32 v5,7,v123
v_bfe_u32 v123,v120,3,1
v_lshl_add_u32 v5,v123,6,v5
v_xor_b32 v123,v120,v122
v_and_b32 v123,3,v123
v_lshl_add_u32 v5,v123,4,v5
v_bfe_u32 v123,v120,2,1
v_lshl_add_u32 v5,v123,3,v5
v_add_u32 v5,147456,v5
v_lshlrev_b32 v122,1,v121
v_add_u32 v122,1,v122
v_and_b32 v123,1,v121
v_xor_b32 v123,v123,v122
v_lshlrev_b32 v6,7,v123
v_bfe_u32 v123,v120,3,1
v_lshl_add_u32 v6,v123,6,v6
v_xor_b32 v123,v120,v122
v_and_b32 v123,3,v123
v_lshl_add_u32 v6,v123,4,v6
v_bfe_u32 v123,v120,2,1
v_lshl_add_u32 v6,v123,3,v6
v_add_u32 v6,147456,v6
v_lshlrev_b32 v7,7,v121
v_lshrrev_b32 v122,1,v120
v_lshl_add_u32 v8,v122,4,v7
v_add_u32 v8,151552,v8
v_lshrrev_b32 v122,2,v120
v_lshl_add_u32 v7,v122,5,v7
v_and_b32 v122,1,v120
v_lshl_add_u32 v7,v122,4,v7
v_and_b32 v122,2,v120
v_cmp_eq_u32 vcc,0,v122
s_lshl_b32 s56,s46,9
v_mov_b32 v122,2048
v_mov_b32 v123,s56
v_cndmask_b32 v122,v122,v123,vcc
v_add_u32 v7,v122,v7
v_add_u32 v7,151552,v7
v_lshrrev_b32 v122,3,v1
v_lshlrev_b32 v9,11,v122
v_and_b32 v122,7,v1
v_lshl_add_u32 v9,v122,3,v9
s_lshl_b32 s56,s46,14
s_lshl_b32 s57,s47,6
s_add_u32 s56,s56,s57
v_add_u32 v9,s56,v9
s_lshl_b32 s71,s47,2
s_add_u32 s71,s71,s46
s_bfe_u32 s56,s71,0x10003
s_lshl_b32 s56,s56,11
s_and_b32 s57,s71,1
s_lshl_b32 s57,s57,10
s_add_u32 s56,s56,s57
s_bfe_u32 s57,s71,0x10002
s_lshl_b32 s57,s57,9
s_add_u32 s56,s56,s57
s_bfe_u32 s57,s71,0x10001
s_lshl_b32 s57,s57,6
s_add_u32 s56,s56,s57
s_bfe_u32 s57,s71,0x10004
s_lshl_b32 s57,s57,8
s_add_u32 s56,s56,s57
s_bfe_u32 s57,s71,0x10005
s_lshl_b32 s57,s57,7
s_add_u32 s56,s56,s57
s_bfe_u32 s57,s71,0x10006
s_lshl_b32 s57,s57,12
s_add_u32 s56,s56,s57
v_and_b32 v122,3,v120
v_lshlrev_b32 v10,2,v122
v_bfe_u32 v122,v120,3,1
v_lshl_add_u32 v10,v122,4,v10
v_and_b32 v122,1,v121
v_lshl_add_u32 v10,v122,5,v10
v_add_u32 v10,s56,v10
v_and_b32 v123,36,v1
v_mov_b32 v122,0x80000000
v_cmp_eq_u32 vcc,0,v123
s_nop 1
v_cndmask_b32 v10,v122,v10,vcc
s_lshl_b32 s56,s46,15
v_add_u32 v11,s56,v0
s_lshl_b32 s71,s71,11
s_lshl_b32 s73,s46,11
s_mov_b32 s72,0xffc00000
s_mov_b32 s74,0
v_lshrrev_b32 v13,3,v1
v_lshlrev_b32 v13,9,v13
v_and_b32 v122,7,v1
v_lshl_add_u32 v13,v122,4,v13
v_and_b32 v122,15,v1
v_and_b32 v123,1,v1
v_lshlrev_b32 v123,4,v123
v_mov_b32 v124,0x3f80
v_lshlrev_b32 v124,v123,v124
v_lshrrev_b32 v122,1,v122
v_cmp_eq_u32 vcc,0,v122
s_nop 1
v_cndmask_b32 v18,0,v124,vcc
v_cmp_eq_u32 vcc,1,v122
s_nop 1
v_cndmask_b32 v19,0,v124,vcc
v_cmp_eq_u32 vcc,2,v122
s_nop 1
v_cndmask_b32 v20,0,v124,vcc
v_cmp_eq_u32 vcc,3,v122
s_nop 1
v_cndmask_b32 v21,0,v124,vcc
s_and_b32 s56,s46,1
s_lshl_b32 s56,s56,8
s_and_b32 s57,s46,2
s_lshl_b32 s57,s57,6
s_add_u32 s56,s56,s57
v_add_u32 v13,s56,v13
s_add_u32 s56,s50,155648
v_add_u32 v12,s56,v0
v_mov_b64 v[14:15],s[28:29]
v_mov_b64 v[16:17],s[28:29]
v_add_u32 v22,13647872,v10
s_lshl_b32 s56,s47,2
s_add_u32 s56,s56,10502272
s_or_b32 s56,s56,s52
v_writelane_b32 v22,s56,4
v_mov_b32 v1,s80
s_mov_b32 s65,16777216
s_add_u32 s66,s71,16777216
s_add_u32 s69,s71,17039360
s_lshl_b32 s79,s47,2
s_add_u32 s79,s79,10486400
s_cmp_eq_u32 s46,0
s_cselect_b32 s79,s79,0x80000000
s_mov_b32 s30,0x40000000
s_mov_b32 s51,0
v_lshrrev_b32 v120,2,v0
v_add_u32 v120,10510464,v120
v_or_b32 v120,s52,v120
s_mov_b64 vcc,-1
s_mov_b32 vcc_lo,0
v_cndmask_b32 v22,v22,v120,vcc
s_mov_b32 s30,0
s_mov_b32 s31,0
L_cst_233:
s_cmp_lg_u32 s46,0
s_cbranch_scc1 L_csw_238
s_lshl_b32 s59,s31,13
s_add_u32 s59,s59,10486016
v_lshrrev_b32 v121,2,v0
v_and_b32 v121,127,v121
L_ckk_239:
s_sleep 1
buffer_load_dword v120,v121,s[8:11],s59 offen sc1
s_sub_u32 s49,s49,1
s_cbranch_scc1 L_abort2
s_waitcnt vmcnt(0)
v_cmp_eq_u32 vcc,0,v120
s_cbranch_vccnz L_ckk_239
v_max_u32_dpp v120,v120,v120 row_ror:8 row_mask:0xf bank_mask:0xf
s_nop 1
v_max_u32_dpp v120,v120,v120 row_ror:4 row_mask:0xf bank_mask:0xf
s_nop 1
v_max_u32_dpp v120,v120,v120 row_ror:2 row_mask:0xf bank_mask:0xf
s_nop 1
v_max_u32_dpp v120,v120,v120 row_ror:1 row_mask:0xf bank_mask:0xf
v_mov_b32 v121,v120
s_nop 1
v_permlane16_swap_b32 v120,v121
v_max_u32 v120,v120,v121
v_mov_b32 v121,v120
s_nop 1
v_permlane32_swap_b32 v120,v121
v_max_u32 v120,v120,v121
s_nop 0
v_readfirstlane_b32 s61,v120
s_max_u32 s30,s30,s61
s_add_u32 s31,s31,1
s_andn2_b32 s51,0x7ff,s30
s_lshr_b32 s51,s51,5
s_add_u32 s61,s51,2
s_min_u32 s61,s61,63
s_cmp_le_u32 s31,s61
s_cbranch_scc1 L_cst_233
v_mov_b32 v120,0
v_mov_b32 v121,s30
ds_write_b32 v8,v120 offset:2560
ds_write_b32 v8,v121 offset:3072
s_lshl_b32 s59,s51,13
s_lshl2_add_u32 s59,s47,s59
s_add_u32 s59,s59,10485888
L_ww_240:
s_sleep 1
buffer_load_dword v122,off,s[8:11],s59 sc1
s_sub_u32 s49,s49,1
s_cbranch_scc1 L_abort2
s_waitcnt vmcnt(0)
v_readfirstlane_b32 s61,v122
s_cmp_eq_u32 s61,0
s_cbranch_scc1 L_ww_240
L_wwd_241:
L_csw_238:
s_waitcnt lgkmcnt(0)
s_barrier
ds_read_b32 v120,v8 offset:3072
s_waitcnt lgkmcnt(0)
v_readfirstlane_b32 s30,v120
s_andn2_b32 s51,0x7ff,s30
s_lshr_b32 s51,s51,5
s_lshl_b32 s56,s51,5
s_add_u32 s56,s56,s47
s_mul_i32 s56,s56,24576
s_add_u32 s56,s56,150994944
s_add_u32 s67,s56,s73
s_add_u32 m0,s73,131072
s_add_u32 s57,s67,8192
buffer_load_dwordx4 v0,s[8:11],s67 offen sc1 lds
buffer_load_dwordx4 v0,s[8:11],s67 offen offset:1024 sc1 lds
s_add_u32 m0,s73,139264
s_add_u32 s67,s67,786432
buffer_load_dwordx4 v0,s[8:11],s57 offen sc1 lds
buffer_load_dwordx4 v0,s[8:11],s57 offen offset:1024 sc1 lds
s_lshl_b32 s75,s51,13
s_add_u32 s64,s75,17825792
s_add_u32 s70,s64,4096
s_lshl_b32 s68,s51,5
s_add_u32 s68,s68,s47
s_lshl_b32 s68,s68,12
s_lshl_b32 s56,s46,10
s_add_u32 s68,s68,s56
s_add_u32 s68,s68,75497472
s_mov_b32 s78,0x80000000
s_mov_b32 s55,0x80000000
s_mov_b32 s54,0x80000000
s_mov_b32 s77,0
s_cmp_eq_u32 s51,63
s_cselect_b32 s76,1,s46
v_mov_b64 v[96:97],0
v_mov_b64 v[98:99],0
v_mov_b64 v[100:101],0
v_mov_b64 v[102:103],0
v_mov_b64 v[104:105],0
v_mov_b64 v[106:107],0
v_mov_b64 v[108:109],0
v_mov_b64 v[110:111],0
v_mov_b64 v[112:113],0
v_mov_b64 v[114:115],0
v_mov_b64 v[116:117],0
v_mov_b64 v[118:119],0
v_lshrrev_b32 v56,8,v0
v_lshlrev_b32 v56,5,v56
v_bfe_u32 v57,v0,5,1
v_lshl_add_u32 v56,v57,2,v56
s_lshl_b32 s56,s46,7
s_add_u32 s56,s56,155648
v_add_u32 v56,s56,v56
v_xor_b32 v57,128,v56
v_xor_b32 v58,256,v56
v_xor_b32 v59,384,v56
s_andn2_b32 s56,31,s30
s_lshr_b32 s57,s56,4
s_lshl_b32 s58,s57,12
s_and_b32 s59,s56,15
s_lshl4_add_u32 s58,s59,s58
s_add_u32 s58,s58,s50
s_add_u32 s58,s58,131072
v_bfe_u32 v60,v0,6,2
v_lshlrev_b32 v60,8,v60
v_bfe_u32 v61,v0,4,2
v_lshl_add_u32 v60,v61,2,v60
v_add_u32 v60,s58,v60
s_lshr_b32 s58,s59,2
s_lshl_b32 s58,s58,8
s_lshl3_add_u32 s58,s57,s58
s_and_b32 s59,s56,3
s_lshl1_add_u32 s58,s59,s58
s_add_u32 s58,s58,s73
s_add_u32 s58,s58,139264
v_and_b32 v61,255,v0
v_add_u32 v61,s58,v61
s_cmp_lg_u32 s46,0
s_cbranch_scc1 L_chd_243
s_lshl_b32 s59,s51,10
s_add_u32 s59,s59,11337728
L_chp_242:
buffer_load_dwordx4 v[120:123],v0,s[8:11],s59 offen sc1
s_sub_u32 s49,s49,1
s_cbranch_scc1 L_abort2
s_waitcnt vmcnt(0)
v_max3_u32 v124,v120,v121,v122
v_max_u32 v124,v123,v124
v_cmp_eq_u32 vcc,-1,v124
s_cbranch_vccnz L_chp_242
ds_write_b128 v12,v[120:123]
L_chd_243:
s_waitcnt vmcnt(0) lgkmcnt(0)
s_barrier
ds_read2_b32 v[24:25],v56 offset0:0 offset1:2
ds_read2_b32 v[26:27],v56 offset0:4 offset1:6
ds_read2_b32 v[28:29],v57 offset0:0 offset1:2
ds_read2_b32 v[30:31],v57 offset0:4 offset1:6
ds_read2_b32 v[32:33],v58 offset0:0 offset1:2
ds_read2_b32 v[34:35],v58 offset0:4 offset1:6
ds_read2_b32 v[36:37],v59 offset0:0 offset1:2
ds_read2_b32 v[38:39],v59 offset0:4 offset1:6
s_waitcnt lgkmcnt(4)
ds_read2_b32 v[40:41],v56 offset0:128 offset1:130
ds_read2_b32 v[42:43],v56 offset0:132 offset1:134
ds_read2_b32 v[44:45],v57 offset0:128 offset1:130
ds_read2_b32 v[46:47],v57 offset0:132 offset1:134
ds_read2_b32 v[48:49],v58 offset0:128 offset1:130
ds_read2_b32 v[50:51],v58 offset0:132 offset1:134
ds_read2_b32 v[52:53],v59 offset0:128 offset1:130
ds_read2_b32 v[54:55],v59 offset0:132 offset1:134
s_waitcnt lgkmcnt(12)
v_smfmac_f32_16x16x64_bf16 v[100:103],v[24:27],a[128:135],v2
v_smfmac_f32_16x16x64_bf16 v[112:115],v[24:27],v[128:135],v2
v_smfmac_f32_16x16x64_bf16 v[108:111],v[24:27],a[136:143],v2
v_smfmac_f32_16x16x64_bf16 v[116:119],v[24:27],v[136:143],v2
s_waitcnt lgkmcnt(12)
v_smfmac_f32_16x16x64_bf16 v[100:103],v[28:31],a[144:151],v2
v_smfmac_f32_16x16x64_bf16 v[112:115],v[28:31],v[144:151],v2
v_smfmac_f32_16x16x64_bf16 v[108:111],v[28:31],a[152:159],v2
v_smfmac_f32_16x16x64_bf16 v[116:119],v[28:31],v[152:159],v2
s_waitcnt lgkmcnt(10)
v_smfmac_f32_16x16x64_bf16 v[100:103],v[32:35],a[160:167],v2
v_smfmac_f32_16x16x64_bf16 v[112:115],v[32:35],v[160:167],v2
v_smfmac_f32_16x16x64_bf16 v[108:111],v[32:35],a[168:175],v2
v_smfmac_f32_16x16x64_bf16 v[116:119],v[32:35],v[168:175],v2
s_waitcnt lgkmcnt(8)
v_smfmac_f32_16x16x64_bf16 v[100:103],v[36:39],a[176:183],v2
v_smfmac_f32_16x16x64_bf16 v[112:115],v[36:39],v[176:183],v2
v_smfmac_f32_16x16x64_bf16 v[108:111],v[36:39],a[184:191],v2
v_smfmac_f32_16x16x64_bf16 v[116:119],v[36:39],v[184:191],v2
s_waitcnt lgkmcnt(6)
v_smfmac_f32_16x16x64_bf16 v[100:103],v[40:43],a[192:199],v2
v_smfmac_f32_16x16x64_bf16 v[112:115],v[40:43],v[192:199],v2
v_smfmac_f32_16x16x64_bf16 v[108:111],v[40:43],a[200:207],v2
v_smfmac_f32_16x16x64_bf16 v[116:119],v[40:43],v[200:207],v2
s_waitcnt lgkmcnt(4)
v_smfmac_f32_16x16x64_bf16 v[100:103],v[44:47],a[208:215],v2
v_smfmac_f32_16x16x64_bf16 v[112:115],v[44:47],v[208:215],v2
v_smfmac_f32_16x16x64_bf16 v[108:111],v[44:47],a[216:223],v2
v_smfmac_f32_16x16x64_bf16 v[116:119],v[44:47],v[216:223],v2
s_waitcnt lgkmcnt(2)
v_smfmac_f32_16x16x64_bf16 v[100:103],v[48:51],a[224:231],v2
v_smfmac_f32_16x16x64_bf16 v[112:115],v[48:51],v[224:231],v2
v_smfmac_f32_16x16x64_bf16 v[108:111],v[48:51],a[232:239],v2
v_smfmac_f32_16x16x64_bf16 v[116:119],v[48:51],v[232:239],v2
s_waitcnt lgkmcnt(0)
v_smfmac_f32_16x16x64_bf16 v[100:103],v[52:55],a[240:247],v2
v_smfmac_f32_16x16x64_bf16 v[112:115],v[52:55],v[240:247],v2
v_smfmac_f32_16x16x64_bf16 v[108:111],v[52:55],a[248:255],v2
v_smfmac_f32_16x16x64_bf16 v[116:119],v[52:55],v[248:255],v2
v_add_f32 v100,v100,v102
v_add_f32 v112,v112,v114
s_nop 1
v_add_f32 v108,v108,v110
s_nop 2
v_add_f32 v116,v116,v118
v_cvt_pk_bf16_f32 v120,v100,v108
v_cvt_pk_bf16_f32 v121,v112,v116
ds_write_b32 v60,v120
ds_write_b16 v61,v121
ds_write_b16_d16_hi v61,v121 offset:1024
v_mov_b64 v[96:97],0
v_mov_b64 v[98:99],0
v_mov_b64 v[100:101],0
v_mov_b64 v[102:103],0
v_mov_b64 v[104:105],0
v_mov_b64 v[106:107],0
v_mov_b64 v[108:109],0
v_mov_b64 v[110:111],0
v_mov_b64 v[112:113],0
v_mov_b64 v[114:115],0
v_mov_b64 v[116:117],0
v_mov_b64 v[118:119],0
s_waitcnt vmcnt(0) lgkmcnt(0)
s_barrier
v_add_u32 v55,131072,v0
ds_read_b128 v[56:59],v55 offset:0
ds_read_b128 v[60:63],v55 offset:4096
ds_read_b128 v[64:67],v55 offset:1024
ds_read_b128 v[68:71],v55 offset:5120
ds_read_b128 v[72:75],v55 offset:2048
ds_read_b128 v[76:79],v55 offset:6144
ds_read_b128 v[80:83],v55 offset:3072
ds_read_b128 v[84:87],v55 offset:7168
v_add_u32 v123,s73,v55
ds_read_b128 v[88:91],v123 offset:8192
ds_read_b128 v[92:95],v123 offset:9216
v_xor_b32 v120,1024,v12
v_xor_b32 v121,2048,v12
v_xor_b32 v122,3072,v12
buffer_load_dwordx4 v[24:27],v13,s[8:11],s64 offen sc1
buffer_load_dwordx4 v[40:43],v13,s[8:11],s70 offen sc1
L_chain_244:
L_cpa_245:
buffer_load_dwordx4 v[24:27],v13,s[8:11],s64 offen sc1
buffer_load_dwordx4 v[40:43],v13,s[8:11],s70 offen sc1
s_sub_u32 s49,s49,1
s_cbranch_scc1 L_abort2
s_waitcnt vmcnt(2)
v_max3_u32 v123,v24,v25,v26
v_max3_u32 v123,v27,v40,v123
v_max3_u32 v123,v41,v42,v123
v_max_u32 v123,v43,v123
v_cmp_le_u32 vcc,s72,v123
s_cbranch_vccnz L_cpa_245
ds_write_b128 v12,v[24:27] offset:0
ds_write_b128 v12,v[40:43] offset:4096
v_smfmac_f32_16x16x64_bf16 v[96:99],v[24:27],a[0:7],v2
buffer_store_dwordx4 v[124:127],v0,s[8:11],s54 offen sc1
v_smfmac_f32_16x16x64_bf16 v[100:103],v[24:27],a[128:135],v2
s_add_u32 m0,s73,131072
s_add_u32 s57,s67,8192
v_smfmac_f32_16x16x64_bf16 v[104:107],v[24:27],a[8:15],v2
s_cmp_eq_u32 s76,0
v_smfmac_f32_16x16x64_bf16 v[108:111],v[24:27],a[136:143],v2
s_cbranch_scc1 L_ckw_234
L_ckb_235:
s_waitcnt lgkmcnt(0)
s_barrier
ds_read_b32 v123,v8 offset:2560
ds_read_b128 v[28:31],v120 offset:0
ds_read_b128 v[32:35],v121 offset:0
v_smfmac_f32_16x16x64_bf16 v[96:99],v[40:43],a[64:71],v2
ds_read_b128 v[36:39],v122 offset:0
v_smfmac_f32_16x16x64_bf16 v[100:103],v[40:43],a[192:199],v2
ds_read_b128 v[44:47],v120 offset:4096
v_smfmac_f32_16x16x64_bf16 v[104:107],v[40:43],a[72:79],v2
ds_read_b128 v[48:51],v121 offset:4096
v_smfmac_f32_16x16x64_bf16 v[108:111],v[40:43],a[200:207],v2
ds_read_b128 v[52:55],v122 offset:4096
v_smfmac_f32_16x16x64_bf16 v[112:115],v[24:27],v[128:135],v2
buffer_load_dwordx4 v0,s[8:11],s67 offen sc1 lds
v_smfmac_f32_16x16x64_bf16 v[116:119],v[24:27],v[136:143],v2
v_smfmac_f32_16x16x64_bf16 v[112:115],v[40:43],v[192:199],v2
buffer_load_dwordx4 v0,s[8:11],s67 offen offset:1024 sc1 lds
v_smfmac_f32_16x16x64_bf16 v[116:119],v[40:43],v[200:207],v2
s_waitcnt lgkmcnt(5)
v_smfmac_f32_16x16x64_bf16 v[96:99],v[28:31],a[16:23],v2
s_add_u32 m0,s73,139264
v_smfmac_f32_16x16x64_bf16 v[100:103],v[28:31],a[144:151],v2
buffer_load_dwordx4 v0,s[8:11],s57 offen sc1 lds
v_smfmac_f32_16x16x64_bf16 v[104:107],v[28:31],a[24:31],v2
s_add_u32 s67,s67,786432
v_smfmac_f32_16x16x64_bf16 v[108:111],v[28:31],a[152:159],v2
v_readfirstlane_b32 s58,v123
s_waitcnt lgkmcnt(4)
v_smfmac_f32_16x16x64_bf16 v[96:99],v[32:35],a[32:39],v2
buffer_load_dwordx4 v0,s[8:11],s57 offen offset:1024 sc1 lds
v_smfmac_f32_16x16x64_bf16 v[100:103],v[32:35],a[160:167],v2
s_cmp_lg_u32 s58,0
s_cbranch_scc1 L_cjump_237
v_smfmac_f32_16x16x64_bf16 v[104:107],v[32:35],a[40:47],v2
v_smfmac_f32_16x16x64_bf16 v[108:111],v[32:35],a[168:175],v2
buffer_load_dword v23,v22,s[8:11],s75 offen sc1
s_waitcnt lgkmcnt(3)
v_smfmac_f32_16x16x64_bf16 v[96:99],v[36:39],a[48:55],v2
v_mov_b32 v125,0
v_smfmac_f32_16x16x64_bf16 v[100:103],v[36:39],a[176:183],v2
v_smfmac_f32_16x16x64_bf16 v[104:107],v[36:39],a[56:63],v2
buffer_store_dword v2,off,s[8:11],s78 sc1
v_smfmac_f32_16x16x64_bf16 v[108:111],v[36:39],a[184:191],v2
s_waitcnt lgkmcnt(0)
v_smfmac_f32_16x16x64_bf16 v[96:99],v[44:47],a[80:87],v2
v_smfmac_f32_16x16x64_bf16 v[100:103],v[44:47],a[208:215],v2
v_smfmac_f32_16x16x64_bf16 v[96:99],v[48:51],a[96:103],v2
v_smfmac_f32_16x16x64_bf16 v[100:103],v[48:51],a[224:231],v2
v_smfmac_f32_16x16x64_bf16 v[96:99],v[52:55],a[112:119],v2
v_smfmac_f32_16x16x64_bf16 v[100:103],v[52:55],a[240:247],v2
v_smfmac_f32_16x16x64_bf16 v[104:107],v[44:47],a[88:95],v2
v_smfmac_f32_16x16x64_bf16 v[108:111],v[44:47],a[216:223],v2
v_smfmac_f32_16x16x64_bf16 v[104:107],v[48:51],a[104:111],v2
v_add_f32 v96,v96,v98
v_smfmac_f32_16x16x64_bf16 v[108:111],v[48:51],a[232:239],v2
v_add_f32 v97,v97,v99
v_smfmac_f32_16x16x64_bf16 v[104:107],v[52:55],a[120:127],v2
v_cvt_pk_bf16_f32 v120,v96,v97
v_smfmac_f32_16x16x64_bf16 v[108:111],v[52:55],a[248:255],v2
v_add_f32 v100,v100,v102
v_smfmac_f32_16x16x64_bf16 v[112:115],v[28:31],v[144:151],v2
v_add_f32 v101,v101,v103
v_smfmac_f32_16x16x64_bf16 v[116:119],v[28:31],v[152:159],v2
v_cvt_pk_bf16_f32 v121,v100,v101
v_add_f32 v104,v104,v106
v_add_f32 v105,v105,v107
v_cvt_pk_bf16_f32 v122,v104,v105
v_add_f32 v108,v108,v110
v_add_f32 v109,v109,v111
v_cvt_pk_bf16_f32 v123,v108,v109
ds_write_b128 v4,v[120:123]
v_smfmac_f32_16x16x64_bf16 v[112:115],v[32:35],v[160:167],v2
v_smfmac_f32_16x16x64_bf16 v[116:119],v[32:35],v[168:175],v2
v_smfmac_f32_16x16x64_bf16 v[112:115],v[36:39],v[176:183],v2
v_smfmac_f32_16x16x64_bf16 v[116:119],v[36:39],v[184:191],v2
s_waitcnt vmcnt(7) lgkmcnt(0)
s_barrier
ds_read_b64_tr_b16 v[96:97],v5 offset:0
ds_read_b64_tr_b16 v[98:99],v6 offset:0
v_smfmac_f32_16x16x64_bf16 v[112:115],v[44:47],v[208:215],v2
ds_read_b64_tr_b16 v[100:101],v5 offset:1024
v_smfmac_f32_16x16x64_bf16 v[116:119],v[44:47],v[216:223],v2
ds_read_b64_tr_b16 v[102:103],v6 offset:1024
v_smfmac_f32_16x16x64_bf16 v[112:115],v[48:51],v[224:231],v2
ds_read_b64_tr_b16 v[104:105],v5 offset:2048
v_smfmac_f32_16x16x64_bf16 v[116:119],v[48:51],v[232:239],v2
ds_read_b64_tr_b16 v[106:107],v6 offset:2048
s_waitcnt lgkmcnt(4)
v_mfma_f32_16x16x32_bf16 v[24:27],v[56:59],v[96:99],0
ds_read_b64_tr_b16 v[108:109],v5 offset:3072
v_mfma_f32_16x16x32_bf16 v[28:31],v[60:63],v[96:99],0
ds_read_b64_tr_b16 v[110:111],v6 offset:3072
v_mfma_f32_16x16x32_bf16 v[32:35],v[96:99],v[96:99],0
ds_read_b128 v[40:43],v11 offset:12288
s_waitcnt lgkmcnt(5)
v_mfma_f32_16x16x32_bf16 v[24:27],v[64:67],v[100:103],v[24:27]
ds_read_b128 v[56:59],v11 offset:0
v_mfma_f32_16x16x32_bf16 v[28:31],v[68:71],v[100:103],v[28:31]
ds_read_b128 v[60:63],v11 offset:1024
v_mfma_f32_16x16x32_bf16 v[32:35],v[100:103],v[100:103],v[32:35]
ds_read_b128 v[96:99],v11 offset:8192
s_waitcnt lgkmcnt(6)
v_mfma_f32_16x16x32_bf16 v[24:27],v[72:75],v[104:107],v[24:27]
ds_read_b128 v[64:67],v11 offset:2048
v_mfma_f32_16x16x32_bf16 v[28:31],v[76:79],v[104:107],v[28:31]
ds_read_b128 v[68:71],v11 offset:3072
v_mfma_f32_16x16x32_bf16 v[32:35],v[104:107],v[104:107],v[32:35]
ds_read_b128 v[100:103],v11 offset:9216
s_waitcnt lgkmcnt(7)
v_mfma_f32_16x16x32_bf16 v[24:27],v[80:83],v[108:111],v[24:27]
ds_read_b128 v[72:75],v11 offset:4096
v_mfma_f32_16x16x32_bf16 v[28:31],v[84:87],v[108:111],v[28:31]
ds_read_b128 v[76:79],v11 offset:5120
v_mfma_f32_16x16x32_bf16 v[32:35],v[108:111],v[108:111],v[32:35]
ds_read_b128 v[104:107],v11 offset:10240
v_smfmac_f32_16x16x64_bf16 v[112:115],v[52:55],v[240:247],v2
ds_read_b128 v[80:83],v11 offset:6144
v_smfmac_f32_16x16x64_bf16 v[116:119],v[52:55],v[248:255],v2
ds_read_b128 v[84:87],v11 offset:7168
v_max3_f32 v126,v24,v25,v26
v_max3_f32 v127,v27,v28,v29
v_max3_f32 v126,v30,v31,v126
v_max3_f32 v127,v34,v35,v127
v_max_f32 v126,v126,v127
v_max_f32 v127,v126,v127
v_pk_mul_f32 v[34:35],v[34:35],v[0:1] op_sel:[0,1]
v_pk_mul_f32 v[24:25],v[24:25],v[0:1] op_sel:[0,1]
v_permlane16_swap_b32 v126,v127
v_max_f32 v126,v126,v127
v_max_f32 v127,v126,v127
v_pk_mul_f32 v[26:27],v[26:27],v[0:1] op_sel:[0,1]
v_pk_mul_f32 v[28:29],v[28:29],v[0:1] op_sel:[0,1]
v_permlane32_swap_b32 v126,v127
v_max_f32 v126,v126,v127
v_mul_f32 v126,v1,v126
v_pk_mul_f32 v[30:31],v[30:31],v[0:1] op_sel:[0,1]
v_pk_add_f32 v[34:35],v[34:35],v[126:127] op_sel_hi:[1,0] neg_lo:[0,1] neg_hi:[0,1]
v_pk_add_f32 v[112:113],v[112:113],v[114:115]
v_pk_add_f32 v[116:117],v[116:117],v[118:119]
v_pk_add_f32 v[24:25],v[24:25],v[126:127] op_sel_hi:[1,0] neg_lo:[0,1] neg_hi:[0,1]
v_pk_add_f32 v[26:27],v[26:27],v[126:127] op_sel_hi:[1,0] neg_lo:[0,1] neg_hi:[0,1]
v_pk_add_f32 v[28:29],v[28:29],v[126:127] op_sel_hi:[1,0] neg_lo:[0,1] neg_hi:[0,1]
v_pk_add_f32 v[30:31],v[30:31],v[126:127] op_sel_hi:[1,0] neg_lo:[0,1] neg_hi:[0,1]
v_exp_f32 v34,v34
v_exp_f32 v35,v35
v_cvt_pk_bf16_f32 v126,v112,v113
v_cvt_pk_bf16_f32 v124,v34,v35
v_cvt_pk_bf16_f32 v127,v116,v117
v_cvt_pk_bf16_f32 v36,v116,v117
v_mfma_f32_16x16x16_bf16 v[32:35],v[14:15],v[124:125],0
ds_read_b128 v[108:111],v11 offset:11264
v_exp_f32 v24,v24
v_mfma_f32_16x16x16_bf16 v[112:115],v[126:127],v[124:125],0
ds_read_b128 v[44:47],v11 offset:13312
v_exp_f32 v25,v25
v_mfma_f32_16x16x16_bf16 v[116:119],v[36:37],v[124:125],0
ds_read_b128 v[48:51],v11 offset:14336
v_exp_f32 v26,v26
v_exp_f32 v27,v27
v_cvt_pk_bf16_f32 v120,v24,v25
v_exp_f32 v28,v28
v_exp_f32 v29,v29
v_cvt_pk_bf16_f32 v121,v26,v27
v_exp_f32 v30,v30
v_exp_f32 v31,v31
v_cvt_pk_bf16_f32 v122,v28,v29
v_cvt_pk_bf16_f32 v123,v30,v31
s_mov_b32 s78,s55
s_add_u32 s55,s79,s75
v_mfma_f32_16x16x32_bf16 v[32:35],v[14:17],v[120:123],v[32:35]
ds_read_b128 v[52:55],v11 offset:15360
v_mfma_f32_16x16x32_bf16 v[112:115],v[88:91],v[120:123],v[112:115]
ds_read_b128 v[88:91],v11 offset:16384
v_mfma_f32_16x16x32_bf16 v[116:119],v[92:95],v[120:123],v[116:119]
ds_read_b128 v[92:95],v11 offset:17408
v_rcp_f32 v32,v32
v_mov_b64 v[24:25],-1
v_mov_b64 v[26:27],-1
s_mov_b32 s54,s68
s_add_u32 s75,s75,8192
v_pk_mul_f32 v[112:113],v[112:113],v[32:33] op_sel_hi:[1,0]
v_pk_mul_f32 v[114:115],v[114:115],v[32:33] op_sel_hi:[1,0]
v_pk_mul_f32 v[116:117],v[116:117],v[32:33] op_sel_hi:[1,0]
v_pk_mul_f32 v[118:119],v[118:119],v[32:33] op_sel_hi:[1,0]
v_cvt_pk_bf16_f32 v120,v112,v116
v_cvt_pk_bf16_f32 v121,v113,v117
v_cvt_pk_bf16_f32 v122,v114,v118
v_cvt_pk_bf16_f32 v123,v115,v119
ds_write_b128 v7,v[120:123]
buffer_store_dwordx4 v[24:27],v0,s[8:11],s69 offen sc1
buffer_store_dwordx4 v[24:27],v0,s[8:11],s69 offen offset:1024 sc1
s_waitcnt lgkmcnt(0)
s_barrier
ds_read_b128 v[24:27],v8 offset:0
ds_read_b128 v[28:31],v8 offset:512
ds_read_b128 v[32:35],v8 offset:1024
ds_read_b128 v[36:39],v8 offset:1536
v_mov_b64 v[112:113],0
v_mov_b64 v[114:115],0
v_mov_b64 v[116:117],0
v_mov_b64 v[118:119],0
v_mov_b64 v[120:121],0
v_mov_b64 v[122:123],0
s_add_u32 s64,s75,13631488
s_add_u32 s70,s64,4096
s_add_u32 s68,s68,131072
s_add_u32 s51,s51,1
s_cmp_eq_u32 s51,64
s_cbranch_scc1 L_cend_247
s_waitcnt lgkmcnt(3)
v_smfmac_f32_16x16x64_bf16 v[112:115],v[24:27],v[56:63],v3
ds_read_b128 v[56:59],v11 offset:18432
s_add_u32 s57,s65,65536
s_waitcnt lgkmcnt(3)
v_smfmac_f32_16x16x64_bf16 v[112:115],v[28:31],v[64:71],v3
ds_read_b128 v[60:63],v11 offset:19456
s_add_u32 s58,s65,131072
s_waitcnt lgkmcnt(3)
v_smfmac_f32_16x16x64_bf16 v[112:115],v[32:35],v[72:79],v3
ds_read_b128 v[64:67],v11 offset:20480
s_add_u32 s59,s65,196608
s_waitcnt lgkmcnt(3)
v_smfmac_f32_16x16x64_bf16 v[112:115],v[36:39],v[80:87],v3
ds_read_b128 v[68:71],v11 offset:21504
v_smfmac_f32_16x16x64_bf16 v[116:119],v[24:27],v[96:103],v3
ds_read_b128 v[72:75],v11 offset:22528
v_smfmac_f32_16x16x64_bf16 v[116:119],v[28:31],v[104:111],v3
ds_read_b128 v[76:79],v11 offset:23552
v_cvt_pk_bf16_f32 v112,v112,v113
v_smfmac_f32_16x16x64_bf16 v[116:119],v[32:35],v[40:47],v3
ds_read_b128 v[80:83],v11 offset:24576
v_cvt_pk_bf16_f32 v113,v114,v115
buffer_store_dwordx2 v[112:113],v9,s[8:11],s65 offen sc1
v_smfmac_f32_16x16x64_bf16 v[116:119],v[36:39],v[48:55],v3
ds_read_b128 v[84:87],v11 offset:25600
v_mov_b64 v[112:113],0
v_smfmac_f32_16x16x64_bf16 v[120:123],v[24:27],v[88:95],v3
ds_read_b128 v[96:99],v11 offset:26624
ds_read_b128 v[100:103],v11 offset:27648
v_mov_b64 v[114:115],0
s_waitcnt lgkmcnt(8)
v_smfmac_f32_16x16x64_bf16 v[120:123],v[28:31],v[56:63],v3
ds_read_b128 v[104:107],v11 offset:28672
v_cvt_pk_bf16_f32 v116,v116,v117
s_waitcnt lgkmcnt(7)
v_smfmac_f32_16x16x64_bf16 v[120:123],v[32:35],v[64:71],v3
ds_read_b128 v[108:111],v11 offset:29696
ds_read_b128 v[40:43],v11 offset:30720
v_cvt_pk_bf16_f32 v117,v118,v119
buffer_store_dwordx2 v[116:117],v9,s[8:11],s57 offen sc1
s_waitcnt lgkmcnt(7)
v_smfmac_f32_16x16x64_bf16 v[120:123],v[36:39],v[72:79],v3
ds_read_b128 v[44:47],v11 offset:31744
s_waitcnt lgkmcnt(6)
v_smfmac_f32_16x16x64_bf16 v[112:115],v[24:27],v[80:87],v3
s_waitcnt lgkmcnt(4)
v_smfmac_f32_16x16x64_bf16 v[112:115],v[28:31],v[96:103],v3
v_cvt_pk_bf16_f32 v120,v120,v121
s_waitcnt lgkmcnt(2)
v_smfmac_f32_16x16x64_bf16 v[112:115],v[32:35],v[104:111],v3
v_cvt_pk_bf16_f32 v121,v122,v123
buffer_store_dwordx2 v[120:121],v9,s[8:11],s58 offen sc1
s_waitcnt lgkmcnt(0)
v_smfmac_f32_16x16x64_bf16 v[112:115],v[36:39],v[40:47],v3
v_mov_b64 v[116:117],0
v_mov_b64 v[118:119],0
s_xor_b32 s65,s65,262144
v_add_u32 v52,s50,v5
v_add_u32 v54,s50,v6
v_mov_b32_dpp v124,v126 quad_perm:[2,3,2,3] row_mask:0xf bank_mask:0xf
v_mov_b32_dpp v125,v127 quad_perm:[2,3,2,3] row_mask:0xf bank_mask:0xf
s_nop 0
v_cvt_pk_bf16_f32 v112,v112,v113
v_cvt_pk_bf16_f32 v113,v114,v115
buffer_store_dwordx2 v[112:113],v9,s[8:11],s59 offen sc1
ds_read_b64_tr_b16 v[52:53],v52
ds_read_b64_tr_b16 v[54:55],v54
s_mov_b32 vcc_lo,0xcccccccc
s_mov_b32 vcc_hi,0xcccccccc
v_mov_b64 v[96:97],0
v_mov_b64 v[98:99],0
v_mov_b64 v[100:101],0
v_mov_b64 v[102:103],0
v_mov_b64 v[104:105],0
v_mov_b64 v[106:107],0
v_mov_b64 v[108:109],0
v_mov_b64 v[110:111],0
v_mov_b64 v[112:113],0
v_mov_b64 v[114:115],0
s_waitcnt lgkmcnt(0)
v_cndmask_b32 v124,v124,v52,vcc
v_cndmask_b32 v125,v125,v53,vcc
v_cndmask_b32 v126,v126,v54,vcc
v_cndmask_b32 v127,v127,v55,vcc
v_add_u32 v55,131072,v0
v_add_u32 v123,s73,v55
v_xor_b32 v120,1024,v12
v_xor_b32 v121,2048,v12
v_xor_b32 v122,3072,v12
s_waitcnt vmcnt(0)
buffer_load_dwordx4 v[32:35],v0,s[8:11],s66 offen offset:0 sc1
buffer_load_dwordx4 v[36:39],v0,s[8:11],s66 offen offset:1024 sc1
v_readlane_b32 s76,v23,4
s_cmp_ge_u32 s51,63
s_cselect_b32 s76,1,s76
v_add_u32 v23,-1,v23
v_cmp_le_u32 vcc,s30,v23
s_cmp_gt_u32 s51,61
s_cselect_b32 s77,0,vcc_hi
s_cmp_lg_u32 s77,0
s_cselect_b32 s76,0,s76
s_or_b32 s76,s76,s46
s_waitcnt vmcnt(1)
v_mfma_f32_16x16x32_bf16 v[28:31],v[18:21],v[32:35],0
s_waitcnt vmcnt(0)
v_mfma_f32_16x16x32_bf16 v[28:31],v[18:21],v[36:39],v[28:31]
s_nop 7
v_cmp_u_f32 vcc,v28,v28
v_add_f32_dpp v52,v28,v28 row_ror:8 row_mask:0xf bank_mask:0x3
v_add_f32_dpp v53,v29,v29 row_ror:8 row_mask:0xf bank_mask:0x3
v_add_f32_dpp v52,v30,v30 row_ror:8 row_mask:0xf bank_mask:0xc
v_add_f32_dpp v53,v31,v31 row_ror:8 row_mask:0xf bank_mask:0xc
s_nop 0
v_add_f32_dpp v52,v52,v52 row_shl:4 row_mask:0xf bank_mask:0x5
v_add_f32_dpp v53,v53,v53 row_shl:4 row_mask:0xf bank_mask:0x5
s_cbranch_vccnz L_crp_249
L_cok_254:
v_cvt_pk_bf16_f32 v54,v52,v53
buffer_store_dword v54,v10,s[8:11],s64 offen sc1
s_mov_b32 s69,s66
s_xor_b32 s66,s66,262144
s_barrier
ds_read_b128 v[56:59],v55 offset:0
ds_read_b128 v[60:63],v55 offset:4096
buffer_load_dwordx4 v[24:27],v13,s[8:11],s64 offen sc1
buffer_load_dwordx4 v[40:43],v13,s[8:11],s70 offen sc1
ds_read_b128 v[64:67],v55 offset:1024
ds_read_b128 v[68:71],v55 offset:5120
ds_read_b128 v[72:75],v55 offset:2048
ds_read_b128 v[76:79],v55 offset:6144
ds_read_b128 v[80:83],v55 offset:3072
ds_read_b128 v[84:87],v55 offset:7168
ds_read_b128 v[88:91],v123 offset:8192
ds_read_b128 v[92:95],v123 offset:9216
s_branch L_chain_244
L_crp_249:
buffer_load_dwordx4 v[32:35],v0,s[8:11],s66 offen offset:0 sc1
buffer_load_dwordx4 v[36:39],v0,s[8:11],s66 offen offset:1024 sc1
s_sub_u32 s49,s49,1
s_cbranch_scc1 L_abort2
s_waitcnt vmcnt(1)
v_mfma_f32_16x16x32_bf16 v[28:31],v[18:21],v[32:35],0
s_waitcnt vmcnt(0)
v_mfma_f32_16x16x32_bf16 v[28:31],v[18:21],v[36:39],v[28:31]
s_nop 7
v_cmp_u_f32 vcc,v28,v28
v_add_f32_dpp v52,v28,v28 row_ror:8 row_mask:0xf bank_mask:0x3
v_add_f32_dpp v53,v29,v29 row_ror:8 row_mask:0xf bank_mask:0x3
v_add_f32_dpp v52,v30,v30 row_ror:8 row_mask:0xf bank_mask:0xc
v_add_f32_dpp v53,v31,v31 row_ror:8 row_mask:0xf bank_mask:0xc
s_nop 0
v_add_f32_dpp v52,v52,v52 row_shl:4 row_mask:0xf bank_mask:0x5
v_add_f32_dpp v53,v53,v53 row_shl:4 row_mask:0xf bank_mask:0x5
s_cbranch_vccz L_cok_254
s_branch L_crp_249
L_ckw_234:
s_cmp_eq_u32 s77,0
s_cbranch_scc1 L_cjw_236
s_add_u32 s31,s51,2
s_lshl_b32 s59,s31,13
s_add_u32 s59,s59,10486016
v_lshrrev_b32 v29,2,v0
v_and_b32 v29,127,v29
L_ckk_255:
s_sleep 1
buffer_load_dword v28,v29,s[8:11],s59 offen sc1
s_sub_u32 s49,s49,1
s_cbranch_scc1 L_abort2
s_waitcnt vmcnt(0)
v_cmp_eq_u32 vcc,0,v28
s_cbranch_vccnz L_ckk_255
v_cmp_lt_u32 vcc,s30,v28
s_cbranch_vccz L_cjw_236
s_mov_b32 s67,0x80000000
ds_write_b32 v8,v2 offset:2560
s_branch L_ckb_235
L_cjw_236:
s_lshl2_add_u32 s59,s47,s75
s_add_u32 s59,s59,10494080
L_ww_256:
s_sleep 1
buffer_load_dword v23,off,s[8:11],s59 sc1
s_sub_u32 s49,s49,1
s_cbranch_scc1 L_abort2
s_waitcnt vmcnt(0)
v_readfirstlane_b32 s76,v23
s_cmp_eq_u32 s76,0
s_cbranch_scc1 L_ww_256
L_wwd_257:
s_branch L_ckb_235
L_cjump_237:
s_waitcnt vmcnt(0) lgkmcnt(0)
s_barrier
s_branch L_cst_233
L_cend_247:
v_add_u32 v52,s50,v5
v_add_u32 v54,s50,v6
ds_read_b64_tr_b16 v[52:53],v52
ds_read_b64_tr_b16 v[54:55],v54
v_mov_b32_dpp v124,v126 quad_perm:[2,3,2,3] row_mask:0xf bank_mask:0xf
v_mov_b32_dpp v125,v127 quad_perm:[2,3,2,3] row_mask:0xf bank_mask:0xf
s_mov_b32 vcc_lo,0xcccccccc
s_mov_b32 vcc_hi,0xcccccccc
s_waitcnt lgkmcnt(0)
v_cndmask_b32 v124,v124,v52,vcc
v_cndmask_b32 v125,v125,v53,vcc
v_cndmask_b32 v126,v126,v54,vcc
v_cndmask_b32 v127,v127,v55,vcc
buffer_store_dwordx4 v[124:127],v0,s[8:11],s54 offen sc1
s_waitcnt vmcnt(0)
s_barrier
buffer_store_dword v2,off,s[8:11],s78 sc1
buffer_store_dword v2,off,s[8:11],s55 sc1
s_nop 11
v_lshrrev_b32 v1,4,v0
s_endpgm
L_wa:
s_nop 11
v_and_b32 v238,15,v1
v_and_b32 v239,1,v1
v_lshlrev_b32 v239,4,v239
v_mov_b32 v240,0x3f80
v_lshlrev_b32 v240,v239,v240
v_lshrrev_b32 v238,1,v238
v_cmp_eq_u32 vcc,0,v238
s_nop 1
v_cndmask_b32 v156,0,v240,vcc
v_cmp_eq_u32 vcc,1,v238
s_nop 1
v_cndmask_b32 v157,0,v240,vcc
v_cmp_eq_u32 vcc,2,v238
s_nop 1
v_cndmask_b32 v158,0,v240,vcc
v_cmp_eq_u32 vcc,3,v238
s_nop 1
v_cndmask_b32 v159,0,v240,vcc
s_mov_b32 s4,s32
s_mov_b32 s5,s33
s_mov_b32 s6,1024
s_mov_b32 s7,0x20000
buffer_load_dwordx4 v[224:227],v0,s[4:7],0 offen
v_and_b32 v238,15,v1
v_lshrrev_b32 v239,4,v1
v_lshlrev_b32 v240,2,v239
v_mov_b32 v241,0xf149f2ca
s_and_b32 s56,s46,1
s_lshl_b32 s56,s56,4
v_add_u32 v242,s56,v238
v_add_u32 v243,0,v240
v_cmp_gt_u32 vcc,v243,v242
s_nop 1
v_cndmask_b32 v8,0,v241,vcc
v_add_u32 v243,1,v240
v_cmp_gt_u32 vcc,v243,v242
s_nop 1
v_cndmask_b32 v9,0,v241,vcc
v_add_u32 v243,2,v240
v_cmp_gt_u32 vcc,v243,v242
s_nop 1
v_cndmask_b32 v10,0,v241,vcc
v_add_u32 v243,3,v240
v_cmp_gt_u32 vcc,v243,v242
s_nop 1
v_cndmask_b32 v11,0,v241,vcc
v_add_u32 v243,16,v240
v_cmp_gt_u32 vcc,v243,v242
s_nop 1
v_cndmask_b32 v12,0,v241,vcc
v_add_u32 v243,17,v240
v_cmp_gt_u32 vcc,v243,v242
s_nop 1
v_cndmask_b32 v13,0,v241,vcc
v_add_u32 v243,18,v240
v_cmp_gt_u32 vcc,v243,v242
s_nop 1
v_cndmask_b32 v14,0,v241,vcc
v_add_u32 v243,19,v240
v_cmp_gt_u32 vcc,v243,v242
s_nop 1
v_cndmask_b32 v15,0,v241,vcc
v_mov_b64 v[152:153],s[28:29]
v_mov_b64 v[154:155],s[28:29]
v_mov_b32 v145,0
v_mov_b32 v146,0
s_lshl_b32 s56,s46,12
s_add_u32 s56,s56,131072
v_add_u32 v3,s56,v0
v_add_u32 v4,131072,v0
s_lshl_b32 s56,s46,8
v_lshlrev_b32 v7,4,v238
v_add_u32 v7,s56,v7
v_lshl_add_u32 v5,v239,16,v7
v_lshlrev_b32 v6,1,v7
v_lshl_add_u32 v7,v239,10,v7
v_and_b32 v243,1,v239
v_lshl_add_u32 v6,v243,4,v6
v_lshrrev_b32 v243,1,v239
v_lshl_add_u32 v6,v243,12,v6
v_add_u32 v6,147456,v6
v_lshlrev_b32 v16,2,v238
v_lshlrev_b32 v21,3,v238
s_and_b32 s68,s47,15
s_lshl_b32 s56,s68,10
v_add_u32 v5,s56,v5
s_lshl_b32 s56,s68,15
v_add_u32 v7,s56,v7
s_lshl_b32 s69,s54,20
s_add_u32 s69,s69,20971520
s_lshl_b32 s87,s54,13
s_add_u32 s87,s87,10486656
s_lshl2_add_u32 s74,s68,s87
s_or_b32 s74,s74,s52
s_lshl_b32 s68,s68,1
s_lshr_b32 s56,s46,1
s_add_u32 s68,s68,s56
s_mov_b32 s66,0
s_mov_b32 s67,0
s_mov_b32 s73,0x80000000
s_mov_b32 s75,0
s_mov_b32 s37,0
s_mov_b64 s[38:39],0
s_sub_u32 s36,s54,11
s_and_b32 s36,s36,3
s_mov_b32 s12,s40
s_mov_b32 s13,s41
s_mov_b32 s14,2097152
s_mov_b32 s15,0x20000
v_add_u32 v21,10487168,v21
v_mov_b32 v244,v21
s_and_b32 s56,s50,2048
s_add_u32 s56,s56,147456
v_lshlrev_b32 v23,5,v1
v_add_u32 v23,s56,v23
v_and_b32 v253,32,v0
v_lshrrev_b32 v245,2,v253
v_add_u32 v253,v253,v245
v_sub_u32 v253,v0,v253
v_add_u32 v253,8,v253
v_mov_b32 v254,0x80000000
s_mov_b32 s56,1408
v_writelane_b32 v254,s56,0
s_mov_b32 s56,256
v_writelane_b32 v254,s56,1
s_mov_b32 s56,1280
v_writelane_b32 v254,s56,2
v_mov_b32 v245,155648
s_lshl_b32 s56,s46,2
v_add_u32 v247,s56,v245
s_waitcnt vmcnt(0)
v_lshlrev_b32 v228,16,v224
v_and_b32 v229,0xffff0000,v224
v_lshlrev_b32 v230,16,v225
v_and_b32 v231,0xffff0000,v225
v_lshlrev_b32 v232,16,v226
v_and_b32 v233,0xffff0000,v226
v_lshlrev_b32 v234,16,v227
v_and_b32 v235,0xffff0000,v227
s_cmp_lt_u32 s54,2
s_cbranch_scc1 L_aa_258
s_sub_u32 s77,s54,2
s_mov_b32 s30,0
s_mov_b32 s86,1536
s_lshl_b32 s56,s77,5
s_add_u32 s56,s56,s68
s_mul_i32 s70,s56,24576
s_lshl_b32 s71,s56,12
s_lshl_b32 s59,s77,13
s_lshl2_add_u32 s59,s68,s59
s_add_u32 s59,s59,10485760
s_buffer_load_dword s32,s[8:11],s59 glc
s_mov_b32 s33,1
s_add_u32 s70,s70,100663296
s_add_u32 s71,s71,41943040
v_mov_b32 v19,s59
s_branch L_aa_266
L_aa_272:
s_bitcmp1_b32 s46,0
s_cbranch_scc1 L_av_273
ds_read_b128 v[24:27],v4 offset:0
ds_read_b128 v[28:31],v4 offset:1024
s_min_u32 s56,s32,s33
s_cmp_lt_u32 s77,64
s_cselect_b32 s56,s56,0
s_cmp_eq_u32 s56,0
s_cselect_b32 s72,0x80000000,0
v_mov_b32 v248,s72
s_or_b32 s64,s70,s72
s_or_b32 s65,s71,s72
s_and_b32 s57,s46,1
s_mul_i32 s58,s57,12288
s_add_u32 s64,s64,s58
s_lshl_b32 s57,s57,11
s_waitcnt lgkmcnt(1)
v_mfma_f32_16x16x32_bf16 v[160:163],v[24:27],a[0:3],0
ds_read_b128 v[32:35],v4 offset:2048
s_add_u32 s65,s65,s57
s_and_b32 s59,s50,2048
v_mfma_f32_16x16x32_bf16 v[164:167],v[24:27],a[4:7],0
ds_read_b128 v[36:39],v4 offset:3072
s_lshl_b32 s59,s59,4
s_xor_b32 s60,s67,65536
v_mfma_f32_16x16x32_bf16 v[168:171],v[24:27],a[8:11],0
ds_read_b128 v[40:43],v4 offset:8192
s_add_u32 s59,s59,s60
s_add_u32 s58,s58,s59
v_mfma_f32_16x16x32_bf16 v[172:175],v[24:27],a[12:15],0
ds_read_b128 v[44:47],v4 offset:9216
s_add_u32 s57,s57,s59
s_add_u32 m0,s58,0
v_mfma_f32_16x16x32_bf16 v[176:179],v[24:27],a[16:19],0
buffer_load_dwordx4 v0,s[8:11],s64 offen offset:0 sc1 lds
v_lshlrev_b32 v88,16,v224
v_and_b32 v89,0xffff0000,v224
v_mfma_f32_16x16x32_bf16 v[180:183],v[24:27],a[20:23],0
ds_read_b128 v[48:51],v4 offset:10240
v_lshlrev_b32 v90,16,v225
v_and_b32 v91,0xffff0000,v225
v_mfma_f32_16x16x32_bf16 v[184:187],v[24:27],a[24:27],0
ds_read_b128 v[52:55],v4 offset:11264
s_waitcnt vmcnt(8)
v_mfma_f32_16x16x32_bf16 v[128:131],v[156:159],v[192:195],0
ds_write_b32 v247,v248
v_lshlrev_b32 v92,16,v226
v_and_b32 v93,0xffff0000,v226
v_mfma_f32_16x16x32_bf16 v[188:191],v[24:27],a[28:31],0
ds_read_b128 v[56:59],v4 offset:4096
s_waitcnt vmcnt(7)
v_mfma_f32_16x16x32_bf16 v[128:131],v[156:159],v[196:199],v[128:131]
ds_read_b128 v[60:63],v4 offset:5120
v_lshlrev_b32 v94,16,v227
v_and_b32 v95,0xffff0000,v227
s_waitcnt lgkmcnt(9)
v_mfma_f32_16x16x32_bf16 v[160:163],v[28:31],a[32:35],v[160:163]
buffer_load_dwordx4 v0,s[8:11],s64 offen offset:1024 sc1 lds
s_waitcnt vmcnt(7)
v_mfma_f32_16x16x32_bf16 v[128:131],v[156:159],v[200:203],v[128:131]
ds_read_b128 v[64:67],v4 offset:6144
v_readfirstlane_b32 s22,v246
s_cmp_eq_u32 s22,0
s_cbranch_scc1 L_ag_274
L_agb_275:
v_mfma_f32_16x16x32_bf16 v[164:167],v[28:31],a[36:39],v[164:167]
ds_read_b128 v[68:71],v4 offset:7168
s_waitcnt vmcnt(6)
v_mfma_f32_16x16x32_bf16 v[128:131],v[156:159],v[204:207],v[128:131]
ds_read_b128 v[72:75],v4 offset:12288
s_lshl_b32 s18,s26,5
s_add_u32 s18,s18,s68
v_mfma_f32_16x16x32_bf16 v[168:171],v[28:31],a[40:43],v[168:171]
ds_read_b128 v[76:79],v4 offset:13312
s_waitcnt vmcnt(5)
v_mfma_f32_16x16x32_bf16 v[132:135],v[156:159],v[208:211],0
ds_read_b128 v[80:83],v4 offset:14336
s_lshl_b32 s19,s18,10
s_add_u32 s20,s19,6291456
v_mfma_f32_16x16x32_bf16 v[172:175],v[28:31],a[44:47],v[172:175]
ds_read_b128 v[84:87],v4 offset:15360
s_waitcnt vmcnt(4)
v_mfma_f32_16x16x32_bf16 v[132:135],v[156:159],v[212:215],v[132:135]
s_lshl_b32 s23,s51,5
s_add_u32 s23,s23,s68
s_lshl_b32 s24,s23,10
v_mfma_f32_16x16x32_bf16 v[176:179],v[28:31],a[48:51],v[176:179]
buffer_load_dwordx4 v0,s[8:11],s64 offen offset:2048 sc1 lds
s_waitcnt vmcnt(4)
v_mfma_f32_16x16x32_bf16 v[132:135],v[156:159],v[216:219],v[132:135]
s_lshl_b32 s25,s51,10
s_add_u32 s25,s25,2883584
s_cmp_eq_u32 s23,s55
s_cselect_b32 s25,s25,s24
v_mfma_f32_16x16x32_bf16 v[180:183],v[28:31],a[52:55],v[180:183]
ds_write_b128 v6,v[128:131]
s_waitcnt vmcnt(3)
v_mfma_f32_16x16x32_bf16 v[132:135],v[156:159],v[220:223],v[132:135]
s_add_u32 s25,s25,8388608
s_mov_b32 s6,268435456
s_cmp_eq_u32 s31,0
s_cselect_b32 s25,s24,s25
s_cselect_b64 s[4:5],s[16:17],s[44:45]
s_cmov_b32 s6,2097152
v_mfma_f32_16x16x32_bf16 v[184:187],v[28:31],a[56:59],v[184:187]
buffer_load_dwordx4 v[224:227],v0,s[4:7],s25 offen sc1
s_lshr_b32 s24,s55,5
s_cmp_lt_u32 s51,s24
s_cselect_b32 s24,1,2
v_mfma_f32_16x16x32_bf16 v[188:191],v[28:31],a[60:63],v[188:191]
v_mov_b32 v252,s24
s_lshl2_add_u32 s25,s51,11018240
s_waitcnt lgkmcnt(15)
v_mfma_f32_16x16x32_bf16 v[160:163],v[32:35],a[64:67],v[160:163]
ds_write_b128 v6,v[132:135] offset:2048
s_lshl_b32 s24,s68,16
s_add_u32 s24,s24,s31
v_mfma_f32_16x16x32_bf16 v[164:167],v[32:35],a[68:71],v[164:167]
buffer_load_dwordx4 v0,s[8:11],s64 offen offset:3072 sc1 lds
s_add_u32 s24,s24,s86
s_cmp_eq_u32 s24,1537
s_cselect_b32 s25,s25,0x80000000
v_mfma_f32_16x16x32_bf16 v[168:171],v[32:35],a[72:75],v[168:171]
buffer_store_dword v252,off,s[8:11],s25 sc1
s_bitcmp1_b64 s[38:39],s51
s_cselect_b32 s24,128,0
v_mfma_f32_16x16x32_bf16 v[172:175],v[32:35],a[76:79],v[172:175]
s_lshl_b32 s23,s51,13
s_lshl2_add_u32 s23,s68,s23
s_add_u32 s23,s23,10487168
v_mfma_f32_16x16x32_bf16 v[176:179],v[32:35],a[80:83],v[176:179]
s_waitcnt lgkmcnt(0)
s_barrier
s_add_u32 s23,s23,s24
v_mfma_f32_16x16x32_bf16 v[180:183],v[32:35],a[84:87],v[180:183]
ds_read_b128 v[96:99],v23
s_add_u32 m0,s58,4096
s_add_u32 s64,s64,4096
v_mfma_f32_16x16x32_bf16 v[184:187],v[32:35],a[88:91],v[184:187]
ds_read_b128 v[100:103],v23 offset:16
v_mfma_f32_16x16x32_bf16 v[188:191],v[32:35],a[92:95],v[188:191]
buffer_load_dwordx4 v0,s[8:11],s64 offen offset:0 sc1 lds
v_mfma_f32_16x16x32_bf16 v[160:163],v[36:39],a[96:99],v[160:163]
ds_read_b128 v[248:251],v245
v_mfma_f32_16x16x32_bf16 v[164:167],v[36:39],a[100:103],v[164:167]
buffer_load_dword v246,off,s[8:11],s23 sc1
v_lshrrev_b32 v244,4,v1
s_sub_u32 s23,s77,8
v_add_u32 v244,s23,v244
v_mfma_f32_16x16x32_bf16 v[168:171],v[36:39],a[104:107],v[168:171]
v_max_i32 v244,0,v244
v_lshl_add_u32 v244,v244,13,v21
v_mfma_f32_16x16x32_bf16 v[172:175],v[36:39],a[108:111],v[172:175]
buffer_load_dwordx4 v0,s[8:11],s64 offen offset:1024 sc1 lds
s_waitcnt lgkmcnt(1)
v_cvt_pk_bf16_f32 v104,v96,v97
v_cvt_pk_bf16_f32 v105,v98,v99
v_mfma_f32_16x16x32_bf16 v[176:179],v[36:39],a[112:115],v[176:179]
buffer_load_dwordx2 v[242:243],v244,s[8:11],0 offen sc1
v_cvt_pk_bf16_f32 v106,v100,v101
v_cvt_pk_bf16_f32 v107,v102,v103
v_lshlrev_b32 v96,16,v104
v_mfma_f32_16x16x32_bf16 v[180:183],v[36:39],a[116:119],v[180:183]
v_and_b32 v97,0xffff0000,v104
v_lshlrev_b32 v98,16,v105
v_mfma_f32_16x16x32_bf16 v[184:187],v[36:39],a[120:123],v[184:187]
s_waitcnt lgkmcnt(0)
v_or3_b32 v248,v248,v249,v250
v_or_b32 v248,v248,v251
v_mfma_f32_16x16x32_bf16 v[188:191],v[36:39],a[124:127],v[188:191]
buffer_load_dwordx4 v0,s[8:11],s64 offen offset:2048 sc1 lds
v_and_b32 v99,0xffff0000,v105
v_lshlrev_b32 v100,16,v106
v_mfma_f32_16x16x32_bf16 v[160:163],v[40:43],a[128:131],v[160:163]
v_readfirstlane_b32 s72,v248
v_and_b32 v101,0xffff0000,v106
v_mfma_f32_16x16x32_bf16 v[164:167],v[40:43],a[132:135],v[164:167]
v_lshlrev_b32 v102,16,v107
v_and_b32 v103,0xffff0000,v107
v_mfma_f32_16x16x32_bf16 v[168:171],v[40:43],a[136:139],v[168:171]
v_add_f32 v88,v88,v96
v_add_f32 v89,v89,v97
v_mfma_f32_16x16x32_bf16 v[172:175],v[40:43],a[140:143],v[172:175]
buffer_load_dwordx4 v0,s[8:11],s64 offen offset:3072 sc1 lds
v_add_f32 v90,v90,v98
v_add_f32 v91,v91,v99
v_mfma_f32_16x16x32_bf16 v[176:179],v[40:43],a[144:147],v[176:179]
v_add_f32 v92,v92,v100
v_add_f32 v93,v93,v101
v_mfma_f32_16x16x32_bf16 v[180:183],v[40:43],a[148:151],v[180:183]
v_add_f32 v94,v94,v102
v_add_f32 v95,v95,v103
v_mfma_f32_16x16x32_bf16 v[184:187],v[40:43],a[152:155],v[184:187]
v_cvt_pk_bf16_f32 v104,v88,v89
v_cvt_pk_bf16_f32 v105,v90,v91
v_mfma_f32_16x16x32_bf16 v[188:191],v[40:43],a[156:159],v[188:191]
s_add_u32 m0,s58,8192
s_add_u32 s64,s64,4096
v_cvt_pk_bf16_f32 v106,v92,v93
v_mfma_f32_16x16x32_bf16 v[160:163],v[44:47],a[160:163],v[160:163]
buffer_load_dwordx4 v0,s[8:11],s64 offen offset:0 sc1 lds
v_cvt_pk_bf16_f32 v107,v94,v95
v_mfma_f32_16x16x32_bf16 v[164:167],v[44:47],a[164:167],v[164:167]
buffer_store_dwordx4 v[104:107],v0,s[8:11],s20 offen sc1
v_lshlrev_b32 v88,16,v104
v_and_b32 v89,0xffff0000,v104
v_lshlrev_b32 v90,16,v105
v_mfma_f32_16x16x32_bf16 v[168:171],v[44:47],a[168:171],v[168:171]
v_and_b32 v91,0xffff0000,v105
v_lshlrev_b32 v92,16,v106
v_and_b32 v93,0xffff0000,v106
v_mfma_f32_16x16x32_bf16 v[172:175],v[44:47],a[172:175],v[172:175]
v_lshlrev_b32 v94,16,v107
v_and_b32 v95,0xffff0000,v107
v_mfma_f32_16x16x32_bf16 v[176:179],v[44:47],a[176:179],v[176:179]
buffer_load_dwordx4 v0,s[8:11],s64 offen offset:1024 sc1 lds
v_readfirstlane_b32 s78,v88
v_mfma_f32_16x16x32_bf16 v[180:183],v[44:47],a[180:183],v[180:183]
s_nop 0
v_add_f32 v120,v88,-s78
v_add_f32 v121,v89,-s78
v_add_f32 v122,v90,-s78
v_mfma_f32_16x16x32_bf16 v[184:187],v[44:47],a[184:187],v[184:187]
v_add_f32 v123,v91,-s78
v_add_f32 v124,v92,-s78
v_mfma_f32_16x16x32_bf16 v[188:191],v[44:47],a[188:191],v[188:191]
v_add_f32 v125,v93,-s78
v_add_f32 v126,v94,-s78
v_mfma_f32_16x16x32_bf16 v[160:163],v[48:51],a[192:195],v[160:163]
buffer_load_dwordx4 v0,s[8:11],s64 offen offset:2048 sc1 lds
v_add_f32 v127,v95,-s78
v_add_f32 v128,v120,v122
v_mfma_f32_16x16x32_bf16 v[164:167],v[48:51],a[196:199],v[164:167]
v_add_f32 v129,v121,v123
v_mul_f32 v130,v120,v120
v_mfma_f32_16x16x32_bf16 v[168:171],v[48:51],a[200:203],v[168:171]
v_mul_f32 v131,v121,v121
v_add_f32 v132,v124,v126
v_mfma_f32_16x16x32_bf16 v[172:175],v[48:51],a[204:207],v[172:175]
v_add_f32 v133,v125,v127
v_fma_f32 v130,v122,v122,v130
v_mfma_f32_16x16x32_bf16 v[176:179],v[48:51],a[208:211],v[176:179]
buffer_load_dwordx4 v0,s[8:11],s64 offen offset:3072 sc1 lds
v_fma_f32 v131,v123,v123,v131
v_add_f32 v128,v128,v132
v_mfma_f32_16x16x32_bf16 v[180:183],v[48:51],a[212:215],v[180:183]
v_add_f32 v129,v129,v133
v_fma_f32 v130,v124,v124,v130
v_mfma_f32_16x16x32_bf16 v[184:187],v[48:51],a[216:219],v[184:187]
v_fma_f32 v131,v125,v125,v131
v_add_f32 v128,v128,v129
v_mfma_f32_16x16x32_bf16 v[188:191],v[48:51],a[220:223],v[188:191]
v_fma_f32 v130,v126,v126,v130
v_fma_f32 v131,v127,v127,v131
v_mfma_f32_16x16x32_bf16 v[160:163],v[52:55],a[224:227],v[160:163]
s_add_u32 m0,s57,24576
v_add_f32 v130,v130,v131
v_mfma_f32_16x16x32_bf16 v[164:167],v[52:55],a[228:231],v[164:167]
buffer_load_dwordx4 v0,s[8:11],s65 offen offset:0 sc1 lds
v_permlane32_swap_b32 v128,v130
v_add_f32 v128,v128,v130
v_mfma_f32_16x16x32_bf16 v[168:171],v[52:55],a[232:235],v[168:171]
s_nop 0
v_add_f32_dpp v128,v128,v128 row_ror:8 row_mask:0xf bank_mask:0xf
v_mfma_f32_16x16x32_bf16 v[172:175],v[52:55],a[236:239],v[172:175]
s_nop 0
v_add_f32_dpp v128,v128,v128 row_ror:4 row_mask:0xf bank_mask:0xf
v_mfma_f32_16x16x32_bf16 v[176:179],v[52:55],a[240:243],v[176:179]
s_nop 0
v_add_f32_dpp v128,v128,v128 row_ror:2 row_mask:0xf bank_mask:0xf
v_mfma_f32_16x16x32_bf16 v[180:183],v[52:55],a[244:247],v[180:183]
buffer_load_dwordx4 v0,s[8:11],s65 offen offset:1024 sc1 lds
v_add_f32_dpp v128,v128,v128 row_ror:1 row_mask:0xf bank_mask:0xf
v_mov_b32 v130,v128
v_mfma_f32_16x16x32_bf16 v[184:187],v[52:55],a[248:251],v[184:187]
s_nop 0
v_permlane16_swap_b32 v128,v130
v_add_f32 v128,v128,v130
v_mul_f32 v128,0x3b000000,v128
v_mfma_f32_16x16x32_bf16 v[188:191],v[52:55],a[252:255],v[188:191]
v_mov_b32 v130,v128
v_mfma_f32_16x16x32_bf16 v[192:195],v[56:59],a[0:3],0
s_nop 0
v_permlane32_swap_b32 v128,v130
v_fma_f32 v130,-v128,v128,v130
v_add_f32 v128,s78,v128
v_mfma_f32_16x16x32_bf16 v[196:199],v[56:59],a[4:7],0
v_max_f32 v130,0,v130
v_cvt_pk_bf16_f32 v130,v128,v130
v_lshlrev_b32 v128,16,v130
v_mfma_f32_16x16x32_bf16 v[200:203],v[56:59],a[8:11],0
v_and_b32 v130,0xffff0000,v130
v_add_f32 v130,0x3727c5ac,v130
v_cvt_pk_bf16_f32 v130,v130,v130
v_mfma_f32_16x16x32_bf16 v[204:207],v[56:59],a[12:15],0
v_and_b32 v130,0xffff0000,v130
v_sqrt_f32 v130,v130
v_add_f32 v120,v88,-v128
v_mfma_f32_16x16x32_bf16 v[208:211],v[56:59],a[16:19],0
v_add_f32 v121,v89,-v128
v_add_f32 v122,v90,-v128
v_mfma_f32_16x16x32_bf16 v[212:215],v[56:59],a[20:23],0
v_add_f32 v123,v91,-v128
v_add_f32 v124,v92,-v128
v_mfma_f32_16x16x32_bf16 v[216:219],v[56:59],a[24:27],0
v_add_f32 v125,v93,-v128
v_add_f32 v126,v94,-v128
v_mfma_f32_16x16x32_bf16 v[220:223],v[56:59],a[28:31],0
v_add_f32 v127,v95,-v128
v_cvt_pk_bf16_f32 v130,v130,v130
v_mfma_f32_16x16x32_bf16 v[192:195],v[60:63],a[32:35],v[192:195]
v_and_b32 v130,0xffff0000,v130
v_rcp_f32 v130,v130
v_mfma_f32_16x16x32_bf16 v[196:199],v[60:63],a[36:39],v[196:199]
v_cvt_pk_bf16_f32 v108,v120,v121
v_cvt_pk_bf16_f32 v109,v122,v123
v_mfma_f32_16x16x32_bf16 v[200:203],v[60:63],a[40:43],v[200:203]
v_cvt_pk_bf16_f32 v110,v124,v125
v_cvt_pk_bf16_f32 v111,v126,v127
v_mfma_f32_16x16x32_bf16 v[204:207],v[60:63],a[44:47],v[204:207]
v_lshlrev_b32 v120,16,v108
v_and_b32 v121,0xffff0000,v108
v_mfma_f32_16x16x32_bf16 v[208:211],v[60:63],a[48:51],v[208:211]
v_lshlrev_b32 v122,16,v109
v_and_b32 v123,0xffff0000,v109
v_mfma_f32_16x16x32_bf16 v[212:215],v[60:63],a[52:55],v[212:215]
v_lshlrev_b32 v124,16,v110
v_and_b32 v125,0xffff0000,v110
v_mfma_f32_16x16x32_bf16 v[216:219],v[60:63],a[56:59],v[216:219]
v_lshlrev_b32 v126,16,v111
v_and_b32 v127,0xffff0000,v111
v_mfma_f32_16x16x32_bf16 v[220:223],v[60:63],a[60:63],v[220:223]
v_mul_f32 v120,v120,v130
v_mul_f32 v121,v121,v130
v_mfma_f32_16x16x32_bf16 v[192:195],v[64:67],a[64:67],v[192:195]
v_mul_f32 v122,v122,v130
v_mul_f32 v123,v123,v130
v_mfma_f32_16x16x32_bf16 v[196:199],v[64:67],a[68:71],v[196:199]
v_mul_f32 v124,v124,v130
v_mul_f32 v125,v125,v130
v_mfma_f32_16x16x32_bf16 v[200:203],v[64:67],a[72:75],v[200:203]
v_mul_f32 v126,v126,v130
v_mul_f32 v127,v127,v130
v_mfma_f32_16x16x32_bf16 v[204:207],v[64:67],a[76:79],v[204:207]
v_cvt_pk_bf16_f32 v108,v120,v121
v_cvt_pk_bf16_f32 v109,v122,v123
v_mfma_f32_16x16x32_bf16 v[208:211],v[64:67],a[80:83],v[208:211]
v_cvt_pk_bf16_f32 v24,v160,v164
v_cvt_pk_bf16_f32 v25,v168,v172
v_mfma_f32_16x16x32_bf16 v[212:215],v[64:67],a[84:87],v[212:215]
v_cvt_pk_bf16_f32 v26,v176,v180
v_cvt_pk_bf16_f32 v27,v184,v188
v_mfma_f32_16x16x32_bf16 v[216:219],v[64:67],a[88:91],v[216:219]
v_cvt_pk_bf16_f32 v28,v161,v165
v_cvt_pk_bf16_f32 v29,v169,v173
v_mfma_f32_16x16x32_bf16 v[220:223],v[64:67],a[92:95],v[220:223]
v_cvt_pk_bf16_f32 v30,v177,v181
v_cvt_pk_bf16_f32 v31,v185,v189
v_mfma_f32_16x16x32_bf16 v[192:195],v[68:71],a[96:99],v[192:195]
v_cvt_pk_bf16_f32 v32,v162,v166
v_cvt_pk_bf16_f32 v33,v170,v174
v_mfma_f32_16x16x32_bf16 v[196:199],v[68:71],a[100:103],v[196:199]
v_cvt_pk_bf16_f32 v34,v178,v182
v_cvt_pk_bf16_f32 v35,v186,v190
v_mfma_f32_16x16x32_bf16 v[200:203],v[68:71],a[104:107],v[200:203]
v_cvt_pk_bf16_f32 v36,v163,v167
v_cvt_pk_bf16_f32 v37,v171,v175
v_mfma_f32_16x16x32_bf16 v[204:207],v[68:71],a[108:111],v[204:207]
v_cvt_pk_bf16_f32 v38,v179,v183
v_cvt_pk_bf16_f32 v39,v187,v191
v_mfma_f32_16x16x32_bf16 v[208:211],v[68:71],a[112:115],v[208:211]
s_add_u32 s62,s69,0
v_cvt_pk_bf16_f32 v110,v124,v125
v_cvt_pk_bf16_f32 v111,v126,v127
v_mfma_f32_16x16x32_bf16 v[212:215],v[68:71],a[116:119],v[212:215]
buffer_store_dwordx4 v[24:27],v5,s[8:11],s62 offen sc1
v_lshlrev_b32 v112,16,v108
v_and_b32 v113,0xffff0000,v108
v_mfma_f32_16x16x32_bf16 v[216:219],v[68:71],a[120:123],v[216:219]
v_lshlrev_b32 v114,16,v109
v_and_b32 v115,0xffff0000,v109
v_mfma_f32_16x16x32_bf16 v[220:223],v[68:71],a[124:127],v[220:223]
v_lshlrev_b32 v116,16,v110
v_and_b32 v117,0xffff0000,v110
v_mfma_f32_16x16x32_bf16 v[192:195],v[72:75],a[128:131],v[192:195]
s_add_u32 s62,s69,16384
v_lshlrev_b32 v118,16,v111
v_and_b32 v119,0xffff0000,v111
v_mfma_f32_16x16x32_bf16 v[196:199],v[72:75],a[132:135],v[196:199]
buffer_store_dwordx4 v[28:31],v5,s[8:11],s62 offen sc1
v_add_f32 v88,v88,v112
v_add_f32 v89,v89,v113
v_mfma_f32_16x16x32_bf16 v[200:203],v[72:75],a[136:139],v[200:203]
v_add_f32 v90,v90,v114
v_add_f32 v91,v91,v115
v_mfma_f32_16x16x32_bf16 v[204:207],v[72:75],a[140:143],v[204:207]
v_add_f32 v92,v92,v116
v_add_f32 v93,v93,v117
v_mfma_f32_16x16x32_bf16 v[208:211],v[72:75],a[144:147],v[208:211]
s_add_u32 s62,s69,32768
v_add_f32 v94,v94,v118
v_add_f32 v95,v95,v119
v_mfma_f32_16x16x32_bf16 v[212:215],v[72:75],a[148:151],v[212:215]
buffer_store_dwordx4 v[32:35],v5,s[8:11],s62 offen sc1
v_cvt_pk_bf16_f32 v96,v88,v89
v_cvt_pk_bf16_f32 v97,v90,v91
v_mfma_f32_16x16x32_bf16 v[216:219],v[72:75],a[152:155],v[216:219]
v_cvt_pk_bf16_f32 v98,v92,v93
v_cvt_pk_bf16_f32 v99,v94,v95
v_mfma_f32_16x16x32_bf16 v[220:223],v[72:75],a[156:159],v[220:223]
buffer_store_dwordx4 v[96:99],v0,s[12:15],s19 offen sc1
v_mul_f32 v236,v112,v228
v_mul_f32 v237,v113,v229
v_mfma_f32_16x16x32_bf16 v[192:195],v[76:79],a[160:163],v[192:195]
s_add_u32 s62,s69,49152
v_fma_f32 v236,v114,v230,v236
v_fma_f32 v237,v115,v231,v237
v_mfma_f32_16x16x32_bf16 v[196:199],v[76:79],a[164:167],v[196:199]
buffer_store_dwordx4 v[36:39],v5,s[8:11],s62 offen sc1
v_fma_f32 v236,v116,v232,v236
v_fma_f32 v237,v117,v233,v237
v_mfma_f32_16x16x32_bf16 v[200:203],v[76:79],a[168:171],v[200:203]
v_fma_f32 v236,v118,v234,v236
v_fma_f32 v237,v119,v235,v237
v_mfma_f32_16x16x32_bf16 v[204:207],v[76:79],a[172:175],v[204:207]
v_add_f32 v236,v236,v237
v_mfma_f32_16x16x32_bf16 v[208:211],v[76:79],a[176:179],v[208:211]
s_nop 0
v_add_f32_dpp v236,v236,v236 row_ror:8 row_mask:0xf bank_mask:0xf
v_mfma_f32_16x16x32_bf16 v[212:215],v[76:79],a[180:183],v[212:215]
s_nop 0
v_add_f32_dpp v236,v236,v236 row_ror:4 row_mask:0xf bank_mask:0xf
v_mfma_f32_16x16x32_bf16 v[216:219],v[76:79],a[184:187],v[216:219]
s_nop 0
v_add_f32_dpp v236,v236,v236 row_ror:2 row_mask:0xf bank_mask:0xf
v_mfma_f32_16x16x32_bf16 v[220:223],v[76:79],a[188:191],v[220:223]
s_nop 0
v_add_f32_dpp v236,v236,v236 row_ror:1 row_mask:0xf bank_mask:0xf
v_mov_b32 v237,v236
v_mfma_f32_16x16x32_bf16 v[192:195],v[80:83],a[192:195],v[192:195]
s_nop 0
v_permlane16_swap_b32 v236,v237
v_add_f32 v236,v236,v237
v_mov_b32 v237,v236
v_mfma_f32_16x16x32_bf16 v[196:199],v[80:83],a[196:199],v[196:199]
s_nop 0
v_permlane32_swap_b32 v236,v237
v_add_f32 v236,v236,v237
v_cvt_pk_bf16_f32 v236,v236,v236
v_mfma_f32_16x16x32_bf16 v[200:203],v[80:83],a[200:203],v[200:203]
v_and_b32 v236,0xffff0000,v236
v_ashrrev_i32 v237,31,v236
v_or_b32 v237,0x80000000,v237
v_mfma_f32_16x16x32_bf16 v[204:207],v[80:83],a[204:207],v[204:207]
v_xor_b32 v236,v236,v237
v_and_b32 v236,0xffff0000,v236
s_sub_u32 s20,4095,s18
v_mfma_f32_16x16x32_bf16 v[208:211],v[80:83],a[208:211],v[208:211]
v_or_b32 v20,s20,v236
s_lshl_b32 s73,s26,13
s_lshl2_add_u32 s73,s68,s73
v_mfma_f32_16x16x32_bf16 v[212:215],v[80:83],a[212:215],v[212:215]
s_add_u32 s73,s73,10485760
s_add_u32 s73,s73,s86
v_mfma_f32_16x16x32_bf16 v[216:219],v[80:83],a[216:219],v[216:219]
v_mfma_f32_16x16x32_bf16 v[220:223],v[80:83],a[220:223],v[220:223]
v_mfma_f32_16x16x32_bf16 v[192:195],v[84:87],a[224:227],v[192:195]
v_mfma_f32_16x16x32_bf16 v[196:199],v[84:87],a[228:231],v[196:199]
v_mfma_f32_16x16x32_bf16 v[200:203],v[84:87],a[232:235],v[200:203]
v_mfma_f32_16x16x32_bf16 v[204:207],v[84:87],a[236:239],v[204:207]
v_mfma_f32_16x16x32_bf16 v[208:211],v[84:87],a[240:243],v[208:211]
v_mfma_f32_16x16x32_bf16 v[212:215],v[84:87],a[244:247],v[212:215]
v_mfma_f32_16x16x32_bf16 v[216:219],v[84:87],a[248:251],v[216:219]
v_mfma_f32_16x16x32_bf16 v[220:223],v[84:87],a[252:255],v[220:223]
v_cvt_pk_bf16_f32 v40,v192,v196
v_cvt_pk_bf16_f32 v41,v200,v204
v_cvt_pk_bf16_f32 v42,v208,v212
s_nop 4
v_cvt_pk_bf16_f32 v43,v216,v220
s_add_u32 s62,s69,262144
buffer_store_dwordx4 v[40:43],v5,s[8:11],s62 offen sc1
v_cvt_pk_bf16_f32 v44,v193,v197
v_cvt_pk_bf16_f32 v45,v201,v205
v_cvt_pk_bf16_f32 v46,v209,v213
v_cvt_pk_bf16_f32 v47,v217,v221
s_add_u32 s62,s69,278528
buffer_store_dwordx4 v[44:47],v5,s[8:11],s62 offen sc1
v_cvt_pk_bf16_f32 v48,v194,v198
v_cvt_pk_bf16_f32 v49,v202,v206
v_cvt_pk_bf16_f32 v50,v210,v214
v_cvt_pk_bf16_f32 v51,v218,v222
s_add_u32 s62,s69,294912
buffer_store_dwordx4 v[48:51],v5,s[8:11],s62 offen sc1
v_cvt_pk_bf16_f32 v52,v195,v199
v_cvt_pk_bf16_f32 v53,v203,v207
v_cvt_pk_bf16_f32 v54,v211,v215
v_cvt_pk_bf16_f32 v55,v219,v223
s_add_u32 s62,s69,311296
buffer_store_dwordx4 v[52:55],v5,s[8:11],s62 offen sc1
s_cmp_lg_u32 s72,0
s_cbranch_scc1 L_aa_261
s_waitcnt vmcnt(9)
s_branch L_aa_271
L_av_273:
ds_read_b128 v[24:27],v4 offset:0
ds_read_b128 v[28:31],v4 offset:1024
s_min_u32 s56,s32,s33
s_cmp_lt_u32 s77,64
s_cselect_b32 s56,s56,0
s_cmp_eq_u32 s56,0
s_cselect_b32 s72,0x80000000,0
v_mov_b32 v248,s72
s_or_b32 s64,s70,s72
s_or_b32 s65,s71,s72
s_and_b32 s57,s46,1
s_mul_i32 s58,s57,12288
s_add_u32 s64,s64,s58
s_lshl_b32 s57,s57,11
s_waitcnt lgkmcnt(1)
v_mfma_f32_16x16x32_bf16 v[160:163],v[24:27],a[0:3],0
ds_read_b128 v[32:35],v4 offset:2048
s_add_u32 s65,s65,s57
s_and_b32 s59,s50,2048
v_mfma_f32_16x16x32_bf16 v[164:167],v[24:27],a[4:7],0
ds_read_b128 v[36:39],v4 offset:3072
s_lshl_b32 s59,s59,4
s_xor_b32 s60,s67,65536
v_mfma_f32_16x16x32_bf16 v[168:171],v[24:27],a[8:11],0
ds_read_b128 v[40:43],v4 offset:8192
s_add_u32 s59,s59,s60
s_add_u32 s58,s58,s59
v_mfma_f32_16x16x32_bf16 v[172:175],v[24:27],a[12:15],0
ds_read_b128 v[44:47],v4 offset:9216
s_add_u32 s57,s57,s59
s_add_u32 m0,s58,0
v_mfma_f32_16x16x32_bf16 v[176:179],v[24:27],a[16:19],0
buffer_load_dwordx4 v0,s[8:11],s64 offen offset:0 sc1 lds
s_lshl_b32 s23,s51,5
s_add_u32 s23,s23,s68
v_mfma_f32_16x16x32_bf16 v[180:183],v[24:27],a[20:23],0
ds_read_b128 v[48:51],v4 offset:10240
s_lshl_b32 s24,s23,10
s_lshl_b32 s25,s51,10
v_mfma_f32_16x16x32_bf16 v[184:187],v[24:27],a[24:27],0
ds_read_b128 v[52:55],v4 offset:11264
s_waitcnt vmcnt(8)
v_mfma_f32_16x16x32_bf16 v[128:131],v[156:159],v[192:195],0
ds_write_b32 v247,v248
s_add_u32 s25,s25,2883584
s_cmp_eq_u32 s23,s55
s_cselect_b32 s25,s25,s24
v_mfma_f32_16x16x32_bf16 v[188:191],v[24:27],a[28:31],0
ds_read_b128 v[56:59],v4 offset:4096
s_waitcnt vmcnt(7)
v_mfma_f32_16x16x32_bf16 v[128:131],v[156:159],v[196:199],v[128:131]
ds_read_b128 v[60:63],v4 offset:5120
s_add_u32 s25,s25,8388608
s_mov_b32 s6,268435456
s_waitcnt lgkmcnt(9)
v_mfma_f32_16x16x32_bf16 v[160:163],v[28:31],a[32:35],v[160:163]
buffer_load_dwordx4 v0,s[8:11],s64 offen offset:1024 sc1 lds
s_waitcnt vmcnt(7)
v_mfma_f32_16x16x32_bf16 v[128:131],v[156:159],v[200:203],v[128:131]
ds_read_b128 v[64:67],v4 offset:6144
s_cmp_eq_u32 s31,0
s_cselect_b32 s25,s24,s25
s_cselect_b64 s[4:5],s[16:17],s[44:45]
s_cmov_b32 s6,2097152
v_mfma_f32_16x16x32_bf16 v[164:167],v[28:31],a[36:39],v[164:167]
ds_read_b128 v[68:71],v4 offset:7168
s_waitcnt vmcnt(6)
v_mfma_f32_16x16x32_bf16 v[128:131],v[156:159],v[204:207],v[128:131]
ds_read_b128 v[72:75],v4 offset:12288
v_mfma_f32_16x16x32_bf16 v[168:171],v[28:31],a[40:43],v[168:171]
ds_read_b128 v[76:79],v4 offset:13312
s_waitcnt vmcnt(5)
v_mfma_f32_16x16x32_bf16 v[132:135],v[156:159],v[208:211],0
ds_read_b128 v[80:83],v4 offset:14336
v_mfma_f32_16x16x32_bf16 v[172:175],v[28:31],a[44:47],v[172:175]
ds_read_b128 v[84:87],v4 offset:15360
s_waitcnt vmcnt(4)
v_mfma_f32_16x16x32_bf16 v[132:135],v[156:159],v[212:215],v[132:135]
buffer_load_dwordx4 v[224:227],v0,s[4:7],s25 offen sc1
s_lshr_b32 s24,s55,5
s_cmp_lt_u32 s51,s24
s_cselect_b32 s24,1,2
v_mfma_f32_16x16x32_bf16 v[176:179],v[28:31],a[48:51],v[176:179]
buffer_load_dwordx4 v0,s[8:11],s64 offen offset:2048 sc1 lds
s_waitcnt vmcnt(5)
v_mfma_f32_16x16x32_bf16 v[132:135],v[156:159],v[216:219],v[132:135]
v_mov_b32 v252,s24
s_lshl2_add_u32 s25,s51,11018240
v_mfma_f32_16x16x32_bf16 v[180:183],v[28:31],a[52:55],v[180:183]
ds_write_b128 v6,v[128:131]
s_waitcnt vmcnt(4)
v_mfma_f32_16x16x32_bf16 v[132:135],v[156:159],v[220:223],v[132:135]
s_lshl_b32 s24,s68,16
s_add_u32 s24,s24,s31
s_add_u32 s24,s24,s86
v_mfma_f32_16x16x32_bf16 v[184:187],v[28:31],a[56:59],v[184:187]
s_cmp_eq_u32 s24,1537
s_cselect_b32 s25,s25,0x80000000
v_mfma_f32_16x16x32_bf16 v[188:191],v[28:31],a[60:63],v[188:191]
buffer_store_dword v252,off,s[8:11],s25 sc1
s_bitcmp1_b64 s[38:39],s51
s_cselect_b32 s24,128,0
s_waitcnt lgkmcnt(15)
v_mfma_f32_16x16x32_bf16 v[160:163],v[32:35],a[64:67],v[160:163]
ds_write_b128 v6,v[132:135] offset:2048
s_lshl_b32 s23,s51,13
s_lshl2_add_u32 s23,s68,s23
v_mfma_f32_16x16x32_bf16 v[164:167],v[32:35],a[68:71],v[164:167]
buffer_load_dwordx4 v0,s[8:11],s64 offen offset:3072 sc1 lds
s_add_u32 s23,s23,10487168
s_add_u32 s23,s23,s24
v_mfma_f32_16x16x32_bf16 v[168:171],v[32:35],a[72:75],v[168:171]
buffer_load_dword v246,off,s[8:11],s23 sc1
v_lshrrev_b32 v244,4,v1
s_sub_u32 s23,s77,8
v_mfma_f32_16x16x32_bf16 v[172:175],v[32:35],a[76:79],v[172:175]
v_add_u32 v244,s23,v244
v_max_i32 v244,0,v244
v_mfma_f32_16x16x32_bf16 v[176:179],v[32:35],a[80:83],v[176:179]
s_waitcnt lgkmcnt(0)
s_barrier
v_lshl_add_u32 v244,v244,13,v21
v_mfma_f32_16x16x32_bf16 v[180:183],v[32:35],a[84:87],v[180:183]
ds_read_b128 v[248:251],v245
s_add_u32 m0,s58,4096
s_add_u32 s64,s64,4096
v_mfma_f32_16x16x32_bf16 v[184:187],v[32:35],a[88:91],v[184:187]
buffer_load_dwordx4 v0,s[8:11],s64 offen offset:0 sc1 lds
v_mfma_f32_16x16x32_bf16 v[188:191],v[32:35],a[92:95],v[188:191]
buffer_load_dwordx2 v[242:243],v244,s[8:11],0 offen sc1
v_mfma_f32_16x16x32_bf16 v[160:163],v[36:39],a[96:99],v[160:163]
v_mfma_f32_16x16x32_bf16 v[164:167],v[36:39],a[100:103],v[164:167]
v_mfma_f32_16x16x32_bf16 v[168:171],v[36:39],a[104:107],v[168:171]
buffer_load_dwordx4 v0,s[8:11],s64 offen offset:1024 sc1 lds
v_mfma_f32_16x16x32_bf16 v[172:175],v[36:39],a[108:111],v[172:175]
v_mfma_f32_16x16x32_bf16 v[176:179],v[36:39],a[112:115],v[176:179]
s_waitcnt lgkmcnt(0)
v_or3_b32 v248,v248,v249,v250
v_or_b32 v248,v248,v251
v_mfma_f32_16x16x32_bf16 v[180:183],v[36:39],a[116:119],v[180:183]
v_mfma_f32_16x16x32_bf16 v[184:187],v[36:39],a[120:123],v[184:187]
buffer_load_dwordx4 v0,s[8:11],s64 offen offset:2048 sc1 lds
v_readfirstlane_b32 s72,v248
v_mfma_f32_16x16x32_bf16 v[188:191],v[36:39],a[124:127],v[188:191]
v_mfma_f32_16x16x32_bf16 v[160:163],v[40:43],a[128:131],v[160:163]
v_mfma_f32_16x16x32_bf16 v[164:167],v[40:43],a[132:135],v[164:167]
v_mfma_f32_16x16x32_bf16 v[168:171],v[40:43],a[136:139],v[168:171]
buffer_load_dwordx4 v0,s[8:11],s64 offen offset:3072 sc1 lds
v_mfma_f32_16x16x32_bf16 v[172:175],v[40:43],a[140:143],v[172:175]
v_mfma_f32_16x16x32_bf16 v[176:179],v[40:43],a[144:147],v[176:179]
v_mfma_f32_16x16x32_bf16 v[180:183],v[40:43],a[148:151],v[180:183]
v_mfma_f32_16x16x32_bf16 v[184:187],v[40:43],a[152:155],v[184:187]
s_add_u32 m0,s58,8192
s_add_u32 s64,s64,4096
v_mfma_f32_16x16x32_bf16 v[188:191],v[40:43],a[156:159],v[188:191]
buffer_load_dwordx4 v0,s[8:11],s64 offen offset:0 sc1 lds
v_mfma_f32_16x16x32_bf16 v[160:163],v[44:47],a[160:163],v[160:163]
v_mfma_f32_16x16x32_bf16 v[164:167],v[44:47],a[164:167],v[164:167]
v_mfma_f32_16x16x32_bf16 v[168:171],v[44:47],a[168:171],v[168:171]
v_mfma_f32_16x16x32_bf16 v[172:175],v[44:47],a[172:175],v[172:175]
buffer_load_dwordx4 v0,s[8:11],s64 offen offset:1024 sc1 lds
v_mfma_f32_16x16x32_bf16 v[176:179],v[44:47],a[176:179],v[176:179]
v_mfma_f32_16x16x32_bf16 v[180:183],v[44:47],a[180:183],v[180:183]
v_mfma_f32_16x16x32_bf16 v[184:187],v[44:47],a[184:187],v[184:187]
v_mfma_f32_16x16x32_bf16 v[188:191],v[44:47],a[188:191],v[188:191]
buffer_load_dwordx4 v0,s[8:11],s64 offen offset:2048 sc1 lds
v_mfma_f32_16x16x32_bf16 v[160:163],v[48:51],a[192:195],v[160:163]
v_mfma_f32_16x16x32_bf16 v[164:167],v[48:51],a[196:199],v[164:167]
v_mfma_f32_16x16x32_bf16 v[168:171],v[48:51],a[200:203],v[168:171]
v_mfma_f32_16x16x32_bf16 v[172:175],v[48:51],a[204:207],v[172:175]
buffer_load_dwordx4 v0,s[8:11],s64 offen offset:3072 sc1 lds
v_mfma_f32_16x16x32_bf16 v[176:179],v[48:51],a[208:211],v[176:179]
v_mfma_f32_16x16x32_bf16 v[180:183],v[48:51],a[212:215],v[180:183]
v_mfma_f32_16x16x32_bf16 v[184:187],v[48:51],a[216:219],v[184:187]
v_mfma_f32_16x16x32_bf16 v[188:191],v[48:51],a[220:223],v[188:191]
s_add_u32 m0,s57,24576
v_mfma_f32_16x16x32_bf16 v[160:163],v[52:55],a[224:227],v[160:163]
buffer_load_dwordx4 v0,s[8:11],s65 offen offset:0 sc1 lds
v_mfma_f32_16x16x32_bf16 v[164:167],v[52:55],a[228:231],v[164:167]
v_mfma_f32_16x16x32_bf16 v[168:171],v[52:55],a[232:235],v[168:171]
v_mfma_f32_16x16x32_bf16 v[172:175],v[52:55],a[236:239],v[172:175]
v_mfma_f32_16x16x32_bf16 v[176:179],v[52:55],a[240:243],v[176:179]
buffer_load_dwordx4 v0,s[8:11],s65 offen offset:1024 sc1 lds
v_mfma_f32_16x16x32_bf16 v[180:183],v[52:55],a[244:247],v[180:183]
v_mfma_f32_16x16x32_bf16 v[184:187],v[52:55],a[248:251],v[184:187]
v_mfma_f32_16x16x32_bf16 v[188:191],v[52:55],a[252:255],v[188:191]
v_mfma_f32_16x16x32_bf16 v[192:195],v[56:59],a[0:3],0
v_mfma_f32_16x16x32_bf16 v[196:199],v[56:59],a[4:7],0
v_mfma_f32_16x16x32_bf16 v[200:203],v[56:59],a[8:11],0
v_cvt_pk_bf16_f32 v24,v160,v164
v_cvt_pk_bf16_f32 v25,v168,v172
v_mfma_f32_16x16x32_bf16 v[204:207],v[56:59],a[12:15],0
v_cvt_pk_bf16_f32 v26,v176,v180
v_cvt_pk_bf16_f32 v27,v184,v188
v_mfma_f32_16x16x32_bf16 v[208:211],v[56:59],a[16:19],0
v_cvt_pk_bf16_f32 v28,v161,v165
v_cvt_pk_bf16_f32 v29,v169,v173
v_mfma_f32_16x16x32_bf16 v[212:215],v[56:59],a[20:23],0
v_cvt_pk_bf16_f32 v30,v177,v181
v_cvt_pk_bf16_f32 v31,v185,v189
v_mfma_f32_16x16x32_bf16 v[216:219],v[56:59],a[24:27],0
v_cvt_pk_bf16_f32 v32,v162,v166
v_cvt_pk_bf16_f32 v33,v170,v174
v_mfma_f32_16x16x32_bf16 v[220:223],v[56:59],a[28:31],0
v_cvt_pk_bf16_f32 v34,v178,v182
v_cvt_pk_bf16_f32 v35,v186,v190
v_mfma_f32_16x16x32_bf16 v[192:195],v[60:63],a[32:35],v[192:195]
v_cvt_pk_bf16_f32 v36,v163,v167
v_cvt_pk_bf16_f32 v37,v171,v175
v_mfma_f32_16x16x32_bf16 v[196:199],v[60:63],a[36:39],v[196:199]
v_cvt_pk_bf16_f32 v38,v179,v183
v_cvt_pk_bf16_f32 v39,v187,v191
v_mfma_f32_16x16x32_bf16 v[200:203],v[60:63],a[40:43],v[200:203]
v_mfma_f32_16x16x32_bf16 v[204:207],v[60:63],a[44:47],v[204:207]
v_mfma_f32_16x16x32_bf16 v[208:211],v[60:63],a[48:51],v[208:211]
v_mfma_f32_16x16x32_bf16 v[212:215],v[60:63],a[52:55],v[212:215]
v_mfma_f32_16x16x32_bf16 v[216:219],v[60:63],a[56:59],v[216:219]
v_mfma_f32_16x16x32_bf16 v[220:223],v[60:63],a[60:63],v[220:223]
v_mfma_f32_16x16x32_bf16 v[192:195],v[64:67],a[64:67],v[192:195]
v_mfma_f32_16x16x32_bf16 v[196:199],v[64:67],a[68:71],v[196:199]
v_mfma_f32_16x16x32_bf16 v[200:203],v[64:67],a[72:75],v[200:203]
v_mfma_f32_16x16x32_bf16 v[204:207],v[64:67],a[76:79],v[204:207]
v_mfma_f32_16x16x32_bf16 v[208:211],v[64:67],a[80:83],v[208:211]
v_mfma_f32_16x16x32_bf16 v[212:215],v[64:67],a[84:87],v[212:215]
v_mfma_f32_16x16x32_bf16 v[216:219],v[64:67],a[88:91],v[216:219]
v_mfma_f32_16x16x32_bf16 v[220:223],v[64:67],a[92:95],v[220:223]
v_mfma_f32_16x16x32_bf16 v[192:195],v[68:71],a[96:99],v[192:195]
v_mfma_f32_16x16x32_bf16 v[196:199],v[68:71],a[100:103],v[196:199]
v_mfma_f32_16x16x32_bf16 v[200:203],v[68:71],a[104:107],v[200:203]
v_mfma_f32_16x16x32_bf16 v[204:207],v[68:71],a[108:111],v[204:207]
v_mfma_f32_16x16x32_bf16 v[208:211],v[68:71],a[112:115],v[208:211]
s_add_u32 s62,s69,0
v_mfma_f32_16x16x32_bf16 v[212:215],v[68:71],a[116:119],v[212:215]
buffer_store_dwordx4 v[24:27],v5,s[8:11],s62 offen sc1
v_mfma_f32_16x16x32_bf16 v[216:219],v[68:71],a[120:123],v[216:219]
v_mfma_f32_16x16x32_bf16 v[220:223],v[68:71],a[124:127],v[220:223]
v_mfma_f32_16x16x32_bf16 v[192:195],v[72:75],a[128:131],v[192:195]
s_add_u32 s62,s69,16384
v_mfma_f32_16x16x32_bf16 v[196:199],v[72:75],a[132:135],v[196:199]
buffer_store_dwordx4 v[28:31],v5,s[8:11],s62 offen sc1
v_mfma_f32_16x16x32_bf16 v[200:203],v[72:75],a[136:139],v[200:203]
v_mfma_f32_16x16x32_bf16 v[204:207],v[72:75],a[140:143],v[204:207]
v_mfma_f32_16x16x32_bf16 v[208:211],v[72:75],a[144:147],v[208:211]
s_add_u32 s62,s69,32768
v_mfma_f32_16x16x32_bf16 v[212:215],v[72:75],a[148:151],v[212:215]
buffer_store_dwordx4 v[32:35],v5,s[8:11],s62 offen sc1
v_mfma_f32_16x16x32_bf16 v[216:219],v[72:75],a[152:155],v[216:219]
v_mfma_f32_16x16x32_bf16 v[220:223],v[72:75],a[156:159],v[220:223]
v_mfma_f32_16x16x32_bf16 v[192:195],v[76:79],a[160:163],v[192:195]
s_add_u32 s62,s69,49152
v_mfma_f32_16x16x32_bf16 v[196:199],v[76:79],a[164:167],v[196:199]
buffer_store_dwordx4 v[36:39],v5,s[8:11],s62 offen sc1
v_mfma_f32_16x16x32_bf16 v[200:203],v[76:79],a[168:171],v[200:203]
v_mfma_f32_16x16x32_bf16 v[204:207],v[76:79],a[172:175],v[204:207]
v_mfma_f32_16x16x32_bf16 v[208:211],v[76:79],a[176:179],v[208:211]
v_mfma_f32_16x16x32_bf16 v[212:215],v[76:79],a[180:183],v[212:215]
v_mfma_f32_16x16x32_bf16 v[216:219],v[76:79],a[184:187],v[216:219]
v_mfma_f32_16x16x32_bf16 v[220:223],v[76:79],a[188:191],v[220:223]
v_mfma_f32_16x16x32_bf16 v[192:195],v[80:83],a[192:195],v[192:195]
v_mfma_f32_16x16x32_bf16 v[196:199],v[80:83],a[196:199],v[196:199]
v_mfma_f32_16x16x32_bf16 v[200:203],v[80:83],a[200:203],v[200:203]
v_mfma_f32_16x16x32_bf16 v[204:207],v[80:83],a[204:207],v[204:207]
v_mfma_f32_16x16x32_bf16 v[208:211],v[80:83],a[208:211],v[208:211]
v_mfma_f32_16x16x32_bf16 v[212:215],v[80:83],a[212:215],v[212:215]
v_mfma_f32_16x16x32_bf16 v[216:219],v[80:83],a[216:219],v[216:219]
v_mfma_f32_16x16x32_bf16 v[220:223],v[80:83],a[220:223],v[220:223]
v_mfma_f32_16x16x32_bf16 v[192:195],v[84:87],a[224:227],v[192:195]
v_mfma_f32_16x16x32_bf16 v[196:199],v[84:87],a[228:231],v[196:199]
v_mfma_f32_16x16x32_bf16 v[200:203],v[84:87],a[232:235],v[200:203]
v_mfma_f32_16x16x32_bf16 v[204:207],v[84:87],a[236:239],v[204:207]
v_mfma_f32_16x16x32_bf16 v[208:211],v[84:87],a[240:243],v[208:211]
v_mfma_f32_16x16x32_bf16 v[212:215],v[84:87],a[244:247],v[212:215]
v_mfma_f32_16x16x32_bf16 v[216:219],v[84:87],a[248:251],v[216:219]
v_mfma_f32_16x16x32_bf16 v[220:223],v[84:87],a[252:255],v[220:223]
v_cvt_pk_bf16_f32 v40,v192,v196
v_cvt_pk_bf16_f32 v41,v200,v204
v_cvt_pk_bf16_f32 v42,v208,v212
s_nop 4
v_cvt_pk_bf16_f32 v43,v216,v220
s_add_u32 s62,s69,262144
buffer_store_dwordx4 v[40:43],v5,s[8:11],s62 offen sc1
v_cvt_pk_bf16_f32 v44,v193,v197
v_cvt_pk_bf16_f32 v45,v201,v205
v_cvt_pk_bf16_f32 v46,v209,v213
v_cvt_pk_bf16_f32 v47,v217,v221
s_add_u32 s62,s69,278528
buffer_store_dwordx4 v[44:47],v5,s[8:11],s62 offen sc1
v_cvt_pk_bf16_f32 v48,v194,v198
v_cvt_pk_bf16_f32 v49,v202,v206
v_cvt_pk_bf16_f32 v50,v210,v214
v_cvt_pk_bf16_f32 v51,v218,v222
s_add_u32 s62,s69,294912
buffer_store_dwordx4 v[48:51],v5,s[8:11],s62 offen sc1
v_cvt_pk_bf16_f32 v52,v195,v199
v_cvt_pk_bf16_f32 v53,v203,v207
v_cvt_pk_bf16_f32 v54,v211,v215
v_cvt_pk_bf16_f32 v55,v219,v223
s_add_u32 s62,s69,311296
buffer_store_dwordx4 v[52:55],v5,s[8:11],s62 offen sc1
s_cmp_lg_u32 s72,0
s_cbranch_scc1 L_aa_261
s_waitcnt vmcnt(8)
s_branch L_aa_271
L_aa_259:
ds_read_b128 v[24:27],v4 offset:0
ds_read_b128 v[28:31],v4 offset:1024
s_min_u32 s56,s32,s33
s_cmp_lt_u32 s77,64
s_cselect_b32 s56,s56,0
s_cmp_eq_u32 s56,0
s_cselect_b32 s72,0x80000000,0
v_mov_b32 v248,s72
s_or_b32 s64,s70,s72
s_or_b32 s65,s71,s72
s_and_b32 s57,s46,1
s_mul_i32 s58,s57,12288
s_add_u32 s64,s64,s58
s_lshl_b32 s57,s57,11
s_waitcnt lgkmcnt(1)
v_mfma_f32_16x16x32_bf16 v[160:163],v[24:27],a[0:3],0
ds_read_b128 v[32:35],v4 offset:2048
s_add_u32 s65,s65,s57
s_and_b32 s59,s50,2048
v_mfma_f32_16x16x32_bf16 v[164:167],v[24:27],a[4:7],0
ds_read_b128 v[36:39],v4 offset:3072
s_lshl_b32 s59,s59,4
s_xor_b32 s60,s67,65536
v_mfma_f32_16x16x32_bf16 v[168:171],v[24:27],a[8:11],0
ds_read_b128 v[40:43],v4 offset:8192
s_add_u32 s59,s59,s60
s_add_u32 s58,s58,s59
v_mfma_f32_16x16x32_bf16 v[172:175],v[24:27],a[12:15],0
ds_read_b128 v[44:47],v4 offset:9216
s_add_u32 s57,s57,s59
s_add_u32 m0,s58,0
v_mfma_f32_16x16x32_bf16 v[176:179],v[24:27],a[16:19],0
buffer_load_dwordx4 v0,s[8:11],s64 offen offset:0 sc1 lds
s_lshl_b32 s23,s51,5
s_add_u32 s23,s23,s68
v_mfma_f32_16x16x32_bf16 v[180:183],v[24:27],a[20:23],0
ds_read_b128 v[48:51],v4 offset:10240
s_lshl_b32 s24,s23,10
s_lshl_b32 s25,s51,10
v_mfma_f32_16x16x32_bf16 v[184:187],v[24:27],a[24:27],0
ds_read_b128 v[52:55],v4 offset:11264
s_add_u32 s25,s25,2883584
s_cmp_eq_u32 s23,s55
s_cselect_b32 s25,s25,s24
v_mfma_f32_16x16x32_bf16 v[188:191],v[24:27],a[28:31],0
ds_write_b32 v247,v248
s_add_u32 s25,s25,8388608
s_mov_b32 s6,268435456
s_waitcnt lgkmcnt(7)
v_mfma_f32_16x16x32_bf16 v[160:163],v[28:31],a[32:35],v[160:163]
buffer_load_dwordx4 v0,s[8:11],s64 offen offset:1024 sc1 lds
s_cmp_eq_u32 s31,0
s_cselect_b32 s25,s24,s25
s_cselect_b64 s[4:5],s[16:17],s[44:45]
s_cmov_b32 s6,2097152
v_mfma_f32_16x16x32_bf16 v[164:167],v[28:31],a[36:39],v[164:167]
ds_read_b128 v[56:59],v4 offset:4096
v_mfma_f32_16x16x32_bf16 v[168:171],v[28:31],a[40:43],v[168:171]
ds_read_b128 v[60:63],v4 offset:5120
v_mfma_f32_16x16x32_bf16 v[172:175],v[28:31],a[44:47],v[172:175]
ds_read_b128 v[64:67],v4 offset:6144
v_mfma_f32_16x16x32_bf16 v[176:179],v[28:31],a[48:51],v[176:179]
buffer_load_dwordx4 v0,s[8:11],s64 offen offset:2048 sc1 lds
v_mfma_f32_16x16x32_bf16 v[180:183],v[28:31],a[52:55],v[180:183]
ds_read_b128 v[68:71],v4 offset:7168
v_mfma_f32_16x16x32_bf16 v[184:187],v[28:31],a[56:59],v[184:187]
ds_read_b128 v[72:75],v4 offset:12288
v_mfma_f32_16x16x32_bf16 v[188:191],v[28:31],a[60:63],v[188:191]
ds_read_b128 v[76:79],v4 offset:13312
s_waitcnt lgkmcnt(12)
v_mfma_f32_16x16x32_bf16 v[160:163],v[32:35],a[64:67],v[160:163]
buffer_load_dwordx4 v0,s[8:11],s64 offen offset:3072 sc1 lds
v_mfma_f32_16x16x32_bf16 v[164:167],v[32:35],a[68:71],v[164:167]
ds_read_b128 v[80:83],v4 offset:14336
v_mfma_f32_16x16x32_bf16 v[168:171],v[32:35],a[72:75],v[168:171]
ds_read_b128 v[84:87],v4 offset:15360
v_mfma_f32_16x16x32_bf16 v[172:175],v[32:35],a[76:79],v[172:175]
buffer_load_dwordx4 v[224:227],v0,s[4:7],s25 offen sc1
s_lshr_b32 s24,s55,5
s_cmp_lt_u32 s51,s24
s_cselect_b32 s24,1,2
v_mfma_f32_16x16x32_bf16 v[176:179],v[32:35],a[80:83],v[176:179]
s_add_u32 m0,s58,4096
s_add_u32 s64,s64,4096
v_mov_b32 v252,s24
v_mfma_f32_16x16x32_bf16 v[180:183],v[32:35],a[84:87],v[180:183]
buffer_load_dwordx4 v0,s[8:11],s64 offen offset:0 sc1 lds
s_lshl2_add_u32 s25,s51,11018240
s_lshl_b32 s24,s68,16
v_mfma_f32_16x16x32_bf16 v[184:187],v[32:35],a[88:91],v[184:187]
s_add_u32 s24,s24,s31
s_add_u32 s24,s24,s86
s_cmp_eq_u32 s24,1537
s_cselect_b32 s25,s25,0x80000000
v_mfma_f32_16x16x32_bf16 v[188:191],v[32:35],a[92:95],v[188:191]
buffer_store_dword v252,off,s[8:11],s25 sc1
s_waitcnt lgkmcnt(0)
s_barrier
s_waitcnt lgkmcnt(13)
v_mfma_f32_16x16x32_bf16 v[160:163],v[36:39],a[96:99],v[160:163]
ds_read_b128 v[248:251],v245
s_bitcmp1_b64 s[38:39],s51
s_cselect_b32 s24,128,0
v_mfma_f32_16x16x32_bf16 v[164:167],v[36:39],a[100:103],v[164:167]
buffer_load_dwordx4 v0,s[8:11],s64 offen offset:1024 sc1 lds
s_lshl_b32 s23,s51,13
s_lshl2_add_u32 s23,s68,s23
v_mfma_f32_16x16x32_bf16 v[168:171],v[36:39],a[104:107],v[168:171]
s_add_u32 s23,s23,10487168
s_add_u32 s23,s23,s24
v_mfma_f32_16x16x32_bf16 v[172:175],v[36:39],a[108:111],v[172:175]
buffer_load_dword v246,off,s[8:11],s23 sc1
v_lshrrev_b32 v244,4,v1
s_sub_u32 s23,s77,8
v_mfma_f32_16x16x32_bf16 v[176:179],v[36:39],a[112:115],v[176:179]
v_add_u32 v244,s23,v244
v_max_i32 v244,0,v244
v_mfma_f32_16x16x32_bf16 v[180:183],v[36:39],a[116:119],v[180:183]
buffer_load_dwordx4 v0,s[8:11],s64 offen offset:2048 sc1 lds
v_lshl_add_u32 v244,v244,13,v21
v_mfma_f32_16x16x32_bf16 v[184:187],v[36:39],a[120:123],v[184:187]
buffer_load_dwordx2 v[242:243],v244,s[8:11],0 offen sc1
s_waitcnt lgkmcnt(0)
v_or3_b32 v248,v248,v249,v250
v_mfma_f32_16x16x32_bf16 v[188:191],v[36:39],a[124:127],v[188:191]
v_or_b32 v248,v248,v251
v_mfma_f32_16x16x32_bf16 v[160:163],v[40:43],a[128:131],v[160:163]
v_readfirstlane_b32 s72,v248
v_mfma_f32_16x16x32_bf16 v[164:167],v[40:43],a[132:135],v[164:167]
buffer_load_dwordx4 v0,s[8:11],s64 offen offset:3072 sc1 lds
v_mfma_f32_16x16x32_bf16 v[168:171],v[40:43],a[136:139],v[168:171]
v_mfma_f32_16x16x32_bf16 v[172:175],v[40:43],a[140:143],v[172:175]
v_mfma_f32_16x16x32_bf16 v[176:179],v[40:43],a[144:147],v[176:179]
s_waitcnt vmcnt(12)
v_mfma_f32_16x16x32_bf16 v[180:183],v[40:43],a[148:151],v[180:183]
buffer_store_dword v20,off,s[8:11],s73 sc1
s_add_u32 m0,s58,8192
s_add_u32 s64,s64,4096
v_mfma_f32_16x16x32_bf16 v[184:187],v[40:43],a[152:155],v[184:187]
buffer_load_dwordx4 v0,s[8:11],s64 offen offset:0 sc1 lds
s_mov_b32 s73,0x80000000
v_mfma_f32_16x16x32_bf16 v[188:191],v[40:43],a[156:159],v[188:191]
v_mfma_f32_16x16x32_bf16 v[160:163],v[44:47],a[160:163],v[160:163]
v_mfma_f32_16x16x32_bf16 v[164:167],v[44:47],a[164:167],v[164:167]
v_mfma_f32_16x16x32_bf16 v[168:171],v[44:47],a[168:171],v[168:171]
buffer_load_dwordx4 v0,s[8:11],s64 offen offset:1024 sc1 lds
v_mfma_f32_16x16x32_bf16 v[172:175],v[44:47],a[172:175],v[172:175]
v_mfma_f32_16x16x32_bf16 v[176:179],v[44:47],a[176:179],v[176:179]
v_mfma_f32_16x16x32_bf16 v[180:183],v[44:47],a[180:183],v[180:183]
v_mfma_f32_16x16x32_bf16 v[184:187],v[44:47],a[184:187],v[184:187]
buffer_load_dwordx4 v0,s[8:11],s64 offen offset:2048 sc1 lds
v_mfma_f32_16x16x32_bf16 v[188:191],v[44:47],a[188:191],v[188:191]
v_mfma_f32_16x16x32_bf16 v[160:163],v[48:51],a[192:195],v[160:163]
v_mfma_f32_16x16x32_bf16 v[164:167],v[48:51],a[196:199],v[164:167]
v_mfma_f32_16x16x32_bf16 v[168:171],v[48:51],a[200:203],v[168:171]
buffer_load_dwordx4 v0,s[8:11],s64 offen offset:3072 sc1 lds
v_mfma_f32_16x16x32_bf16 v[172:175],v[48:51],a[204:207],v[172:175]
v_mfma_f32_16x16x32_bf16 v[176:179],v[48:51],a[208:211],v[176:179]
v_mfma_f32_16x16x32_bf16 v[180:183],v[48:51],a[212:215],v[180:183]
v_mfma_f32_16x16x32_bf16 v[184:187],v[48:51],a[216:219],v[184:187]
s_add_u32 m0,s57,24576
v_mfma_f32_16x16x32_bf16 v[188:191],v[48:51],a[220:223],v[188:191]
buffer_load_dwordx4 v0,s[8:11],s65 offen offset:0 sc1 lds
v_mfma_f32_16x16x32_bf16 v[160:163],v[52:55],a[224:227],v[160:163]
v_mfma_f32_16x16x32_bf16 v[164:167],v[52:55],a[228:231],v[164:167]
v_mfma_f32_16x16x32_bf16 v[168:171],v[52:55],a[232:235],v[168:171]
v_mfma_f32_16x16x32_bf16 v[172:175],v[52:55],a[236:239],v[172:175]
buffer_load_dwordx4 v0,s[8:11],s65 offen offset:1024 sc1 lds
v_mfma_f32_16x16x32_bf16 v[176:179],v[52:55],a[240:243],v[176:179]
v_mfma_f32_16x16x32_bf16 v[180:183],v[52:55],a[244:247],v[180:183]
v_mfma_f32_16x16x32_bf16 v[184:187],v[52:55],a[248:251],v[184:187]
v_mfma_f32_16x16x32_bf16 v[188:191],v[52:55],a[252:255],v[188:191]
v_mfma_f32_16x16x32_bf16 v[192:195],v[56:59],a[0:3],0
v_mfma_f32_16x16x32_bf16 v[196:199],v[56:59],a[4:7],0
v_mfma_f32_16x16x32_bf16 v[200:203],v[56:59],a[8:11],0
v_cvt_pk_bf16_f32 v24,v160,v164
v_cvt_pk_bf16_f32 v25,v168,v172
v_mfma_f32_16x16x32_bf16 v[204:207],v[56:59],a[12:15],0
v_cvt_pk_bf16_f32 v26,v176,v180
v_cvt_pk_bf16_f32 v27,v184,v188
v_mfma_f32_16x16x32_bf16 v[208:211],v[56:59],a[16:19],0
v_cvt_pk_bf16_f32 v28,v161,v165
v_cvt_pk_bf16_f32 v29,v169,v173
v_mfma_f32_16x16x32_bf16 v[212:215],v[56:59],a[20:23],0
v_cvt_pk_bf16_f32 v30,v177,v181
v_cvt_pk_bf16_f32 v31,v185,v189
v_mfma_f32_16x16x32_bf16 v[216:219],v[56:59],a[24:27],0
v_cvt_pk_bf16_f32 v32,v162,v166
v_cvt_pk_bf16_f32 v33,v170,v174
v_mfma_f32_16x16x32_bf16 v[220:223],v[56:59],a[28:31],0
v_cvt_pk_bf16_f32 v34,v178,v182
v_cvt_pk_bf16_f32 v35,v186,v190
v_mfma_f32_16x16x32_bf16 v[192:195],v[60:63],a[32:35],v[192:195]
v_cvt_pk_bf16_f32 v36,v163,v167
v_cvt_pk_bf16_f32 v37,v171,v175
v_mfma_f32_16x16x32_bf16 v[196:199],v[60:63],a[36:39],v[196:199]
v_cvt_pk_bf16_f32 v38,v179,v183
v_cvt_pk_bf16_f32 v39,v187,v191
v_mfma_f32_16x16x32_bf16 v[200:203],v[60:63],a[40:43],v[200:203]
v_mfma_f32_16x16x32_bf16 v[204:207],v[60:63],a[44:47],v[204:207]
v_mfma_f32_16x16x32_bf16 v[208:211],v[60:63],a[48:51],v[208:211]
v_mfma_f32_16x16x32_bf16 v[212:215],v[60:63],a[52:55],v[212:215]
v_mfma_f32_16x16x32_bf16 v[216:219],v[60:63],a[56:59],v[216:219]
v_mfma_f32_16x16x32_bf16 v[220:223],v[60:63],a[60:63],v[220:223]
v_mfma_f32_16x16x32_bf16 v[192:195],v[64:67],a[64:67],v[192:195]
v_mfma_f32_16x16x32_bf16 v[196:199],v[64:67],a[68:71],v[196:199]
v_mfma_f32_16x16x32_bf16 v[200:203],v[64:67],a[72:75],v[200:203]
v_mfma_f32_16x16x32_bf16 v[204:207],v[64:67],a[76:79],v[204:207]
v_mfma_f32_16x16x32_bf16 v[208:211],v[64:67],a[80:83],v[208:211]
v_mfma_f32_16x16x32_bf16 v[212:215],v[64:67],a[84:87],v[212:215]
v_mfma_f32_16x16x32_bf16 v[216:219],v[64:67],a[88:91],v[216:219]
v_mfma_f32_16x16x32_bf16 v[220:223],v[64:67],a[92:95],v[220:223]
v_mfma_f32_16x16x32_bf16 v[192:195],v[68:71],a[96:99],v[192:195]
v_mfma_f32_16x16x32_bf16 v[196:199],v[68:71],a[100:103],v[196:199]
v_mfma_f32_16x16x32_bf16 v[200:203],v[68:71],a[104:107],v[200:203]
v_mfma_f32_16x16x32_bf16 v[204:207],v[68:71],a[108:111],v[204:207]
v_mfma_f32_16x16x32_bf16 v[208:211],v[68:71],a[112:115],v[208:211]
s_add_u32 s62,s69,0
v_mfma_f32_16x16x32_bf16 v[212:215],v[68:71],a[116:119],v[212:215]
buffer_store_dwordx4 v[24:27],v5,s[8:11],s62 offen sc1
v_mfma_f32_16x16x32_bf16 v[216:219],v[68:71],a[120:123],v[216:219]
v_mfma_f32_16x16x32_bf16 v[220:223],v[68:71],a[124:127],v[220:223]
v_mfma_f32_16x16x32_bf16 v[192:195],v[72:75],a[128:131],v[192:195]
s_add_u32 s62,s69,16384
v_mfma_f32_16x16x32_bf16 v[196:199],v[72:75],a[132:135],v[196:199]
buffer_store_dwordx4 v[28:31],v5,s[8:11],s62 offen sc1
v_mfma_f32_16x16x32_bf16 v[200:203],v[72:75],a[136:139],v[200:203]
v_mfma_f32_16x16x32_bf16 v[204:207],v[72:75],a[140:143],v[204:207]
v_mfma_f32_16x16x32_bf16 v[208:211],v[72:75],a[144:147],v[208:211]
s_add_u32 s62,s69,32768
v_mfma_f32_16x16x32_bf16 v[212:215],v[72:75],a[148:151],v[212:215]
buffer_store_dwordx4 v[32:35],v5,s[8:11],s62 offen sc1
v_mfma_f32_16x16x32_bf16 v[216:219],v[72:75],a[152:155],v[216:219]
v_mfma_f32_16x16x32_bf16 v[220:223],v[72:75],a[156:159],v[220:223]
v_mfma_f32_16x16x32_bf16 v[192:195],v[76:79],a[160:163],v[192:195]
s_add_u32 s62,s69,49152
v_mfma_f32_16x16x32_bf16 v[196:199],v[76:79],a[164:167],v[196:199]
buffer_store_dwordx4 v[36:39],v5,s[8:11],s62 offen sc1
v_mfma_f32_16x16x32_bf16 v[200:203],v[76:79],a[168:171],v[200:203]
v_mfma_f32_16x16x32_bf16 v[204:207],v[76:79],a[172:175],v[204:207]
v_mfma_f32_16x16x32_bf16 v[208:211],v[76:79],a[176:179],v[208:211]
v_mfma_f32_16x16x32_bf16 v[212:215],v[76:79],a[180:183],v[212:215]
v_mfma_f32_16x16x32_bf16 v[216:219],v[76:79],a[184:187],v[216:219]
v_mfma_f32_16x16x32_bf16 v[220:223],v[76:79],a[188:191],v[220:223]
v_mfma_f32_16x16x32_bf16 v[192:195],v[80:83],a[192:195],v[192:195]
v_mfma_f32_16x16x32_bf16 v[196:199],v[80:83],a[196:199],v[196:199]
v_mfma_f32_16x16x32_bf16 v[200:203],v[80:83],a[200:203],v[200:203]
v_mfma_f32_16x16x32_bf16 v[204:207],v[80:83],a[204:207],v[204:207]
v_mfma_f32_16x16x32_bf16 v[208:211],v[80:83],a[208:211],v[208:211]
v_mfma_f32_16x16x32_bf16 v[212:215],v[80:83],a[212:215],v[212:215]
v_mfma_f32_16x16x32_bf16 v[216:219],v[80:83],a[216:219],v[216:219]
v_mfma_f32_16x16x32_bf16 v[220:223],v[80:83],a[220:223],v[220:223]
v_mfma_f32_16x16x32_bf16 v[192:195],v[84:87],a[224:227],v[192:195]
v_mfma_f32_16x16x32_bf16 v[196:199],v[84:87],a[228:231],v[196:199]
v_mfma_f32_16x16x32_bf16 v[200:203],v[84:87],a[232:235],v[200:203]
v_mfma_f32_16x16x32_bf16 v[204:207],v[84:87],a[236:239],v[204:207]
v_mfma_f32_16x16x32_bf16 v[208:211],v[84:87],a[240:243],v[208:211]
v_mfma_f32_16x16x32_bf16 v[212:215],v[84:87],a[244:247],v[212:215]
v_mfma_f32_16x16x32_bf16 v[216:219],v[84:87],a[248:251],v[216:219]
v_mfma_f32_16x16x32_bf16 v[220:223],v[84:87],a[252:255],v[220:223]
v_cvt_pk_bf16_f32 v40,v192,v196
v_cvt_pk_bf16_f32 v41,v200,v204
v_cvt_pk_bf16_f32 v42,v208,v212
s_nop 4
v_cvt_pk_bf16_f32 v43,v216,v220
s_add_u32 s62,s69,262144
buffer_store_dwordx4 v[40:43],v5,s[8:11],s62 offen sc1
v_cvt_pk_bf16_f32 v44,v193,v197
v_cvt_pk_bf16_f32 v45,v201,v205
v_cvt_pk_bf16_f32 v46,v209,v213
v_cvt_pk_bf16_f32 v47,v217,v221
s_add_u32 s62,s69,278528
buffer_store_dwordx4 v[44:47],v5,s[8:11],s62 offen sc1
v_cvt_pk_bf16_f32 v48,v194,v198
v_cvt_pk_bf16_f32 v49,v202,v206
v_cvt_pk_bf16_f32 v50,v210,v214
v_cvt_pk_bf16_f32 v51,v218,v222
s_add_u32 s62,s69,294912
buffer_store_dwordx4 v[48:51],v5,s[8:11],s62 offen sc1
v_cvt_pk_bf16_f32 v52,v195,v199
v_cvt_pk_bf16_f32 v53,v203,v207
v_cvt_pk_bf16_f32 v54,v211,v215
v_cvt_pk_bf16_f32 v55,v219,v223
s_add_u32 s62,s69,311296
buffer_store_dwordx4 v[52:55],v5,s[8:11],s62 offen sc1
s_cmp_lg_u32 s72,0
s_cbranch_scc1 L_aa_261
s_waitcnt vmcnt(8)
L_aa_271:
s_barrier
s_xor_b32 s67,s67,65536
s_and_b32 s56,s50,2048
s_lshl_b32 s56,s56,4
s_add_u32 s56,s56,s67
v_add_u32 v2,s56,v0
v_add_u32 v239,s56,v253
s_and_b32 s56,s50,1024
s_lshl_b32 s56,s56,2
v_add_u32 v238,s56,v2
s_mov_b32 s76,s71
s_mov_b32 s53,s77
ds_read_b128 v[24:27],v238 offset:16384
ds_read_b128 v[40:43],v2 offset:0
ds_read_b128 v[56:59],v2 offset:4096
ds_read_b128 v[28:31],v238 offset:17408
ds_read_b128 v[44:47],v2 offset:1024
ds_read_b128 v[60:63],v2 offset:5120
ds_read_b128 v[32:35],v238 offset:18432
ds_read_b128 v[48:51],v2 offset:2048
ds_read_b128 v[64:67],v2 offset:6144
ds_read_b128 v[36:39],v238 offset:19456
ds_read_b128 v[52:55],v2 offset:3072
ds_read_b128 v[68:71],v2 offset:7168
s_waitcnt lgkmcnt(9)
v_mfma_f32_16x16x32_bf16 v[128:131],v[40:43],v[24:27],v[8:11]
ds_read_b128 v[72:75],v2 offset:24576
v_mfma_f32_16x16x32_bf16 v[132:135],v[56:59],v[24:27],v[12:15]
ds_read_b128 v[76:79],v2 offset:25600
s_waitcnt lgkmcnt(8)
v_mfma_f32_16x16x32_bf16 v[128:131],v[44:47],v[28:31],v[128:131]
ds_read_b128 v[80:83],v2 offset:26624
v_mfma_f32_16x16x32_bf16 v[132:135],v[60:63],v[28:31],v[132:135]
ds_read_b128 v[84:87],v2 offset:27648
s_waitcnt lgkmcnt(7)
v_mfma_f32_16x16x32_bf16 v[128:131],v[48:51],v[32:35],v[128:131]
ds_read_b64 v[120:121],v239 offset:24576
v_mfma_f32_16x16x32_bf16 v[132:135],v[64:67],v[32:35],v[132:135]
ds_read_b64 v[122:123],v239 offset:25600
s_waitcnt lgkmcnt(6)
v_mfma_f32_16x16x32_bf16 v[128:131],v[52:55],v[36:39],v[128:131]
ds_read_b64 v[124:125],v239 offset:26624
v_mfma_f32_16x16x32_bf16 v[132:135],v[68:71],v[36:39],v[132:135]
ds_read_b64 v[126:127],v239 offset:27648
s_waitcnt lgkmcnt(4)
v_mfma_f32_16x16x32_bf16 v[136:139],v[72:75],v[24:27],0
ds_read_b128 v[88:91],v2 offset:8192
ds_read_b128 v[92:95],v2 offset:9216
v_mfma_f32_16x16x32_bf16 v[136:139],v[76:79],v[28:31],v[136:139]
ds_read_b128 v[96:99],v2 offset:10240
ds_read_b128 v[100:103],v2 offset:11264
v_mfma_f32_16x16x32_bf16 v[136:139],v[80:83],v[32:35],v[136:139]
ds_read_b128 v[104:107],v2 offset:12288
ds_read_b128 v[108:111],v2 offset:13312
v_mfma_f32_16x16x32_bf16 v[136:139],v[84:87],v[36:39],v[136:139]
ds_read_b128 v[112:115],v2 offset:14336
ds_read_b128 v[116:119],v2 offset:15360
s_cmp_eq_u32 s30,0
s_cbranch_scc1 L_aa_260
s_add_u32 s66,s66,4
s_bfe_u32 s56,s66,0x10002
s_bitset0_b32 s37,s56
s_or_b32 s56,s37,s66
v_mov_b32 v22,s56
s_xor_b32 s69,s69,524288
s_waitcnt vmcnt(0) lgkmcnt(0)
s_barrier
buffer_store_dword v22,off,s[8:11],s74 sc1
buffer_store_dword v20,off,s[8:11],s73 sc1
s_mov_b32 s73,0x80000000
s_cmp_lg_u32 s86,1536
s_cbranch_scc1 L_ae_278
s_mov_b32 s77,s35
s_mov_b32 s30,0
s_lshl_b32 s56,s77,5
s_add_u32 s56,s56,s68
s_mul_i32 s70,s56,24576
s_lshl_b32 s71,s56,12
s_lshl_b32 s59,s77,13
s_lshl2_add_u32 s59,s68,s59
s_add_u32 s59,s59,10485760
s_buffer_load_dword s32,s[8:11],s59 glc
s_mov_b32 s33,1
s_add_u32 s70,s70,100663296
s_add_u32 s71,s71,41943040
v_mov_b32 v19,s59
s_branch L_af_279
L_ae_278:
s_ff1_i32_b64 s77,s[84:85]
s_bitset0_b64 s[84:85],s77
s_min_u32 s77,s77,64
s_lshr_b32 s61,s55,5
s_lshl_b32 s56,s77,5
s_add_u32 s56,s56,s68
s_mul_i32 s70,s56,24576
s_lshl_b32 s71,s56,12
s_lshl_b32 s59,s77,13
s_lshl2_add_u32 s59,s68,s59
s_add_u32 s59,s59,10486144
s_cmp_lt_u32 s77,s61
s_cselect_b32 s57,0,16777216
s_cselect_b32 s60,0,128
s_add_u32 s60,s60,s59
s_add_u32 s60,s60,128
s_buffer_load_dword s33,s[8:11],s60 glc
s_add_u32 s71,s71,s57
s_add_u32 s71,s71,58720256
s_cmp_eq_u32 s77,s61
s_cselect_b32 s57,50331648,0
s_cselect_b32 s58,1536,0
s_add_u32 s59,s59,s58
s_buffer_load_dword s32,s[8:11],s59 glc
s_add_u32 s70,s70,s57
s_add_u32 s70,s70,150994944
v_mov_b32 v19,s59
v_writelane_b32 v19,s60,1
L_af_279:
v_max3_f32 v238,v128,v129,v130
v_max3_f32 v239,v131,v132,v133
v_max3_f32 v238,v134,v135,v238
v_max3_f32 v239,v138,v139,v239
v_max_f32 v238,v238,v239
v_max_f32 v239,v238,v239
s_nop 1
v_permlane16_swap_b32 v238,v239
v_max_f32 v238,v238,v239
v_max_f32 v239,v238,v239
s_nop 1
v_permlane32_swap_b32 v238,v239
v_max_f32 v238,v238,v239
v_mul_f32 v238,s80,v238
v_fma_f32 v128,v128,s80,-v238
v_fma_f32 v129,v129,s80,-v238
v_exp_f32 v128,v128
v_fma_f32 v130,v130,s80,-v238
v_exp_f32 v129,v129
v_fma_f32 v131,v131,s80,-v238
v_exp_f32 v130,v130
v_fma_f32 v132,v132,s80,-v238
v_exp_f32 v131,v131
v_fma_f32 v133,v133,s80,-v238
v_exp_f32 v132,v132
v_fma_f32 v134,v134,s80,-v238
v_exp_f32 v133,v133
v_fma_f32 v135,v135,s80,-v238
v_exp_f32 v134,v134
v_fma_f32 v138,v138,s80,-v238
v_exp_f32 v135,v135
v_fma_f32 v139,v139,s80,-v238
v_exp_f32 v138,v138
v_exp_f32 v139,v139
v_cvt_pk_bf16_f32 v140,v128,v129
v_cvt_pk_bf16_f32 v141,v130,v131
v_cvt_pk_bf16_f32 v142,v132,v133
v_cvt_pk_bf16_f32 v143,v134,v135
v_cvt_pk_bf16_f32 v144,v138,v139
v_mov_b32 v147,v144
buffer_load_dword v17,v16,s[8:11],s87 offen sc1
v_mfma_f32_16x16x32_bf16 v[148:151],v[152:155],v[140:143],0
v_mfma_f32_16x16x32_bf16 v[24:27],v[88:91],v[140:143],0
v_mfma_f32_16x16x32_bf16 v[28:31],v[92:95],v[140:143],0
v_mfma_f32_16x16x16_bf16 v[148:151],v[152:153],v[144:145],v[148:151]
v_mfma_f32_16x16x32_bf16 v[32:35],v[96:99],v[140:143],0
v_mfma_f32_16x16x32_bf16 v[36:39],v[100:103],v[140:143],0
v_mfma_f32_16x16x32_bf16 v[40:43],v[104:107],v[140:143],0
v_mfma_f32_16x16x32_bf16 v[44:47],v[108:111],v[140:143],0
v_mfma_f32_16x16x32_bf16 v[48:51],v[112:115],v[140:143],0
v_mfma_f32_16x16x32_bf16 v[52:55],v[116:119],v[140:143],0
v_rcp_f32 v148,v148
v_mfma_f32_16x16x16_bf16 v[24:27],v[120:121],v[144:145],v[24:27]
v_mfma_f32_16x16x16_bf16 v[28:31],v[120:121],v[146:147],v[28:31]
v_mfma_f32_16x16x16_bf16 v[32:35],v[122:123],v[144:145],v[32:35]
v_mfma_f32_16x16x16_bf16 v[36:39],v[122:123],v[146:147],v[36:39]
v_mfma_f32_16x16x16_bf16 v[40:43],v[124:125],v[144:145],v[40:43]
v_pk_mul_f32 v[24:25],v[24:25],v[148:149] op_sel_hi:[1,0]
v_pk_mul_f32 v[26:27],v[26:27],v[148:149] op_sel_hi:[1,0]
v_mfma_f32_16x16x16_bf16 v[44:47],v[124:125],v[146:147],v[44:47]
v_pk_mul_f32 v[28:29],v[28:29],v[148:149] op_sel_hi:[1,0]
v_pk_mul_f32 v[30:31],v[30:31],v[148:149] op_sel_hi:[1,0]
v_mfma_f32_16x16x16_bf16 v[48:51],v[126:127],v[144:145],v[48:51]
v_cvt_pk_bf16_f32 v72,v24,v28
v_cvt_pk_bf16_f32 v73,v25,v29
v_mfma_f32_16x16x16_bf16 v[52:55],v[126:127],v[146:147],v[52:55]
v_cvt_pk_bf16_f32 v74,v26,v30
v_cvt_pk_bf16_f32 v75,v27,v31
ds_write_b128 v3,v[72:75] offset:0
v_pk_mul_f32 v[32:33],v[32:33],v[148:149] op_sel_hi:[1,0]
v_pk_mul_f32 v[34:35],v[34:35],v[148:149] op_sel_hi:[1,0]
v_pk_mul_f32 v[36:37],v[36:37],v[148:149] op_sel_hi:[1,0]
v_pk_mul_f32 v[38:39],v[38:39],v[148:149] op_sel_hi:[1,0]
v_cvt_pk_bf16_f32 v76,v32,v36
v_cvt_pk_bf16_f32 v77,v33,v37
v_cvt_pk_bf16_f32 v78,v34,v38
v_cvt_pk_bf16_f32 v79,v35,v39
ds_write_b128 v3,v[76:79] offset:1024
s_waitcnt vmcnt(0)
v_cmp_gt_u32 vcc,s66,v17
v_pk_mul_f32 v[40:41],v[40:41],v[148:149] op_sel_hi:[1,0]
v_pk_mul_f32 v[42:43],v[42:43],v[148:149] op_sel_hi:[1,0]
v_pk_mul_f32 v[44:45],v[44:45],v[148:149] op_sel_hi:[1,0]
v_pk_mul_f32 v[46:47],v[46:47],v[148:149] op_sel_hi:[1,0]
s_cbranch_vccnz L_ap_281
L_apb_282:
s_bfe_u32 s56,s66,0x10002
v_lshrrev_b32 v238,s56,v17
v_and_b32 v238,1,v238
v_cmp_ne_u32 vcc,0,v238
v_cvt_pk_bf16_f32 v80,v40,v44
v_cvt_pk_bf16_f32 v81,v41,v45
v_cvt_pk_bf16_f32 v82,v42,v46
s_cbranch_vccnz L_ak_277
s_add_u32 s36,s36,4
s_xor_b32 s34,s69,524288
buffer_load_dwordx4 v[192:195],v7,s[8:11],s34 offen sc1
v_cvt_pk_bf16_f32 v83,v43,v47
ds_write_b128 v3,v[80:83] offset:2048
s_add_u32 s34,s34,4096
buffer_load_dwordx4 v[196:199],v7,s[8:11],s34 offen sc1
v_pk_mul_f32 v[48:49],v[48:49],v[148:149] op_sel_hi:[1,0]
v_pk_mul_f32 v[50:51],v[50:51],v[148:149] op_sel_hi:[1,0]
s_add_u32 s34,s34,4096
buffer_load_dwordx4 v[200:203],v7,s[8:11],s34 offen sc1
v_pk_mul_f32 v[52:53],v[52:53],v[148:149] op_sel_hi:[1,0]
v_pk_mul_f32 v[54:55],v[54:55],v[148:149] op_sel_hi:[1,0]
s_add_u32 s34,s34,4096
buffer_load_dwordx4 v[204:207],v7,s[8:11],s34 offen sc1
v_cvt_pk_bf16_f32 v84,v48,v52
v_cvt_pk_bf16_f32 v85,v49,v53
s_add_u32 s34,s34,4096
buffer_load_dwordx4 v[208:211],v7,s[8:11],s34 offen sc1
v_cvt_pk_bf16_f32 v86,v50,v54
v_cvt_pk_bf16_f32 v87,v51,v55
s_add_u32 s34,s34,4096
buffer_load_dwordx4 v[212:215],v7,s[8:11],s34 offen sc1
ds_write_b128 v3,v[84:87] offset:3072
s_add_u32 s34,s34,4096
buffer_load_dwordx4 v[216:219],v7,s[8:11],s34 offen sc1
s_add_u32 s34,s34,4096
buffer_load_dwordx4 v[220:223],v7,s[8:11],s34 offen sc1
s_cmp_eq_u32 s31,0
s_cbranch_scc1 L_ah_280
s_waitcnt lgkmcnt(0)
s_barrier
s_mov_b32 s26,s51
s_mov_b32 s51,s53
s_branch L_aa_272
L_ah_280:
s_waitcnt vmcnt(7)
v_mfma_f32_16x16x32_bf16 v[160:163],v[156:159],v[192:195],0
s_waitcnt vmcnt(6)
v_mfma_f32_16x16x32_bf16 v[160:163],v[156:159],v[196:199],v[160:163]
s_waitcnt vmcnt(5)
v_mfma_f32_16x16x32_bf16 v[160:163],v[156:159],v[200:203],v[160:163]
s_waitcnt vmcnt(4)
v_mfma_f32_16x16x32_bf16 v[160:163],v[156:159],v[204:207],v[160:163]
s_waitcnt vmcnt(3)
v_mfma_f32_16x16x32_bf16 v[164:167],v[156:159],v[208:211],0
s_waitcnt vmcnt(2)
v_mfma_f32_16x16x32_bf16 v[164:167],v[156:159],v[212:215],v[164:167]
s_waitcnt vmcnt(1)
v_mfma_f32_16x16x32_bf16 v[164:167],v[156:159],v[216:219],v[164:167]
ds_write_b128 v6,v[160:163]
s_waitcnt vmcnt(0)
v_mfma_f32_16x16x32_bf16 v[164:167],v[156:159],v[220:223],v[164:167]
s_nop 7
ds_write_b128 v6,v[164:167] offset:2048
s_waitcnt lgkmcnt(0)
s_barrier
s_mov_b32 s27,1
s_branch L_aa_263
L_aa_260:
s_add_u32 s66,s66,4
s_bfe_u32 s56,s66,0x10002
s_bitset0_b32 s37,s56
s_or_b32 s56,s37,s66
v_mov_b32 v22,s56
s_xor_b32 s69,s69,524288
s_waitcnt vmcnt(0) lgkmcnt(0)
s_barrier
buffer_store_dword v22,off,s[8:11],s74 sc1
buffer_store_dword v20,off,s[8:11],s73 sc1
s_mov_b32 s73,0x80000000
s_cmp_eq_u32 s31,0
s_cbranch_scc1 L_aa_262
s_mov_b32 s26,s51
s_mov_b32 s27,3
s_branch L_aa_267
L_aa_262:
L_aq_283:
buffer_load_dword v17,v16,s[8:11],s87 offen sc1
s_sub_u32 s49,s49,1
s_cbranch_scc1 L_abort2
s_waitcnt vmcnt(0)
v_cmp_gt_u32 vcc,s66,v17
s_cbranch_vccnz L_aq_283
s_xor_b32 s34,s69,524288
buffer_load_dwordx4 v[160:163],v7,s[8:11],s34 offen sc1
s_add_u32 s34,s34,4096
buffer_load_dwordx4 v[164:167],v7,s[8:11],s34 offen sc1
s_add_u32 s34,s34,4096
buffer_load_dwordx4 v[168:171],v7,s[8:11],s34 offen sc1
s_add_u32 s34,s34,4096
buffer_load_dwordx4 v[172:175],v7,s[8:11],s34 offen sc1
s_add_u32 s34,s34,4096
buffer_load_dwordx4 v[176:179],v7,s[8:11],s34 offen sc1
s_add_u32 s34,s34,4096
buffer_load_dwordx4 v[180:183],v7,s[8:11],s34 offen sc1
s_add_u32 s34,s34,4096
buffer_load_dwordx4 v[184:187],v7,s[8:11],s34 offen sc1
s_add_u32 s34,s34,4096
buffer_load_dwordx4 v[188:191],v7,s[8:11],s34 offen sc1
buffer_load_dwordx4 v[72:75],v0,s[8:11],s76 offen offset:0 sc1
buffer_load_dwordx4 v[76:79],v0,s[8:11],s76 offen offset:1024 sc1
buffer_load_dwordx4 v[80:83],v0,s[8:11],s76 offen offset:2048 sc1
buffer_load_dwordx4 v[84:87],v0,s[8:11],s76 offen offset:3072 sc1
buffer_load_dwordx2 v[120:121],v253,s[8:11],s76 offen offset:0 sc1
buffer_load_dwordx2 v[122:123],v253,s[8:11],s76 offen offset:1024 sc1
buffer_load_dwordx2 v[124:125],v253,s[8:11],s76 offen offset:2048 sc1
buffer_load_dwordx2 v[126:127],v253,s[8:11],s76 offen offset:3072 sc1
s_waitcnt vmcnt(15)
v_mfma_f32_16x16x32_bf16 v[192:195],v[156:159],v[160:163],0
s_waitcnt vmcnt(14)
v_mfma_f32_16x16x32_bf16 v[192:195],v[156:159],v[164:167],v[192:195]
s_waitcnt vmcnt(13)
v_mfma_f32_16x16x32_bf16 v[192:195],v[156:159],v[168:171],v[192:195]
s_waitcnt vmcnt(12)
v_mfma_f32_16x16x32_bf16 v[192:195],v[156:159],v[172:175],v[192:195]
s_waitcnt vmcnt(11)
v_mfma_f32_16x16x32_bf16 v[196:199],v[156:159],v[176:179],0
s_waitcnt vmcnt(10)
v_mfma_f32_16x16x32_bf16 v[196:199],v[156:159],v[180:183],v[196:199]
s_waitcnt vmcnt(9)
v_mfma_f32_16x16x32_bf16 v[196:199],v[156:159],v[184:187],v[196:199]
ds_write_b128 v6,v[192:195]
s_waitcnt vmcnt(8)
v_mfma_f32_16x16x32_bf16 v[196:199],v[156:159],v[188:191],v[196:199]
s_nop 7
ds_write_b128 v6,v[196:199] offset:2048
s_waitcnt lgkmcnt(0)
s_barrier
s_mov_b32 s27,0
s_branch L_aa_263
L_aa_261:
s_add_u32 s56,s30,s86
s_cmp_lg_u32 s56,1537
s_cbranch_scc1 L_al_276
s_add_u32 s66,s66,4
s_bfe_u32 s56,s66,0x10002
s_bitset1_b32 s37,s56
s_or_b32 s56,s37,s66
v_mov_b32 v22,s56
s_xor_b32 s69,s69,524288
s_waitcnt vmcnt(0) lgkmcnt(0)
s_barrier
buffer_store_dword v22,off,s[8:11],s74 sc1
buffer_store_dword v20,off,s[8:11],s73 sc1
s_mov_b32 s73,0x80000000
s_cmp_lg_u32 s86,1536
s_cbranch_scc1 L_ae_284
s_mov_b32 s77,s35
s_mov_b32 s30,0
s_lshl_b32 s56,s77,5
s_add_u32 s56,s56,s68
s_mul_i32 s70,s56,24576
s_lshl_b32 s71,s56,12
s_lshl_b32 s59,s77,13
s_lshl2_add_u32 s59,s68,s59
s_add_u32 s59,s59,10485760
s_buffer_load_dword s32,s[8:11],s59 glc
s_mov_b32 s33,1
s_add_u32 s70,s70,100663296
s_add_u32 s71,s71,41943040
v_mov_b32 v19,s59
s_branch L_af_285
L_ae_284:
s_ff1_i32_b64 s77,s[84:85]
s_bitset0_b64 s[84:85],s77
s_min_u32 s77,s77,64
s_lshr_b32 s61,s55,5
s_lshl_b32 s56,s77,5
s_add_u32 s56,s56,s68
s_mul_i32 s70,s56,24576
s_lshl_b32 s71,s56,12
s_lshl_b32 s59,s77,13
s_lshl2_add_u32 s59,s68,s59
s_add_u32 s59,s59,10486144
s_cmp_lt_u32 s77,s61
s_cselect_b32 s57,0,16777216
s_cselect_b32 s60,0,128
s_add_u32 s60,s60,s59
s_add_u32 s60,s60,128
s_buffer_load_dword s33,s[8:11],s60 glc
s_add_u32 s71,s71,s57
s_add_u32 s71,s71,58720256
s_cmp_eq_u32 s77,s61
s_cselect_b32 s57,50331648,0
s_cselect_b32 s58,1536,0
s_add_u32 s59,s59,s58
s_buffer_load_dword s32,s[8:11],s59 glc
s_add_u32 s70,s70,s57
s_add_u32 s70,s70,150994944
v_mov_b32 v19,s59
v_writelane_b32 v19,s60,1
L_af_285:
s_branch L_ak_277
L_al_276:
s_add_u32 s66,s66,4
s_bfe_u32 s56,s66,0x10002
s_bitset0_b32 s37,s56
s_or_b32 s56,s37,s66
v_mov_b32 v22,s56
s_xor_b32 s69,s69,524288
s_waitcnt vmcnt(0) lgkmcnt(0)
s_barrier
buffer_store_dword v22,off,s[8:11],s74 sc1
buffer_store_dword v20,off,s[8:11],s73 sc1
s_mov_b32 s73,0x80000000
L_ak_277:
L_aq_286:
buffer_load_dword v17,v16,s[8:11],s87 offen sc1
s_sub_u32 s49,s49,1
s_cbranch_scc1 L_abort2
s_waitcnt vmcnt(0)
v_cmp_gt_u32 vcc,s66,v17
s_cbranch_vccnz L_aq_286
s_xor_b32 s34,s69,524288
buffer_load_dwordx4 v[160:163],v7,s[8:11],s34 offen sc1
s_add_u32 s34,s34,4096
buffer_load_dwordx4 v[164:167],v7,s[8:11],s34 offen sc1
s_add_u32 s34,s34,4096
buffer_load_dwordx4 v[168:171],v7,s[8:11],s34 offen sc1
s_add_u32 s34,s34,4096
buffer_load_dwordx4 v[172:175],v7,s[8:11],s34 offen sc1
s_add_u32 s34,s34,4096
buffer_load_dwordx4 v[176:179],v7,s[8:11],s34 offen sc1
s_add_u32 s34,s34,4096
buffer_load_dwordx4 v[180:183],v7,s[8:11],s34 offen sc1
s_add_u32 s34,s34,4096
buffer_load_dwordx4 v[184:187],v7,s[8:11],s34 offen sc1
s_add_u32 s34,s34,4096
buffer_load_dwordx4 v[188:191],v7,s[8:11],s34 offen sc1
s_waitcnt vmcnt(7)
v_mfma_f32_16x16x32_bf16 v[192:195],v[156:159],v[160:163],0
s_waitcnt vmcnt(6)
v_mfma_f32_16x16x32_bf16 v[192:195],v[156:159],v[164:167],v[192:195]
s_waitcnt vmcnt(5)
v_mfma_f32_16x16x32_bf16 v[192:195],v[156:159],v[168:171],v[192:195]
s_waitcnt vmcnt(4)
v_mfma_f32_16x16x32_bf16 v[192:195],v[156:159],v[172:175],v[192:195]
s_waitcnt vmcnt(3)
v_mfma_f32_16x16x32_bf16 v[196:199],v[156:159],v[176:179],0
s_waitcnt vmcnt(2)
v_mfma_f32_16x16x32_bf16 v[196:199],v[156:159],v[180:183],v[196:199]
s_waitcnt vmcnt(1)
v_mfma_f32_16x16x32_bf16 v[196:199],v[156:159],v[184:187],v[196:199]
ds_write_b128 v6,v[192:195]
s_waitcnt vmcnt(0)
v_mfma_f32_16x16x32_bf16 v[196:199],v[156:159],v[188:191],v[196:199]
s_nop 7
ds_write_b128 v6,v[196:199] offset:2048
s_waitcnt lgkmcnt(0)
s_barrier
s_mov_b32 s27,2
L_aa_263:
s_cmp_lg_u32 s31,0
s_cbranch_scc1 L_ar_289
s_bitcmp1_b32 s46,0
s_cbranch_scc1 L_ar_288
L_ar_287:
ds_read_b128 v[160:163],v23
ds_read_b128 v[164:167],v23 offset:16
v_lshlrev_b32 v200,16,v224
v_and_b32 v201,0xffff0000,v224
v_lshlrev_b32 v202,16,v225
v_and_b32 v203,0xffff0000,v225
v_lshlrev_b32 v204,16,v226
v_and_b32 v205,0xffff0000,v226
v_lshlrev_b32 v206,16,v227
v_and_b32 v207,0xffff0000,v227
s_lshl_b32 s18,s51,5
s_add_u32 s18,s18,s68
s_lshl_b32 s19,s18,10
s_add_u32 s20,s19,8388608
s_waitcnt lgkmcnt(0)
v_cvt_pk_bf16_f32 v168,v160,v161
v_cvt_pk_bf16_f32 v169,v162,v163
v_cvt_pk_bf16_f32 v170,v164,v165
v_cvt_pk_bf16_f32 v171,v166,v167
v_lshlrev_b32 v160,16,v168
v_and_b32 v161,0xffff0000,v168
v_lshlrev_b32 v162,16,v169
v_and_b32 v163,0xffff0000,v169
v_lshlrev_b32 v164,16,v170
v_and_b32 v165,0xffff0000,v170
v_lshlrev_b32 v166,16,v171
v_and_b32 v167,0xffff0000,v171
v_pk_add_f32 v[200:201],v[200:201],v[160:161]
v_pk_add_f32 v[202:203],v[202:203],v[162:163]
v_pk_add_f32 v[204:205],v[204:205],v[164:165]
v_pk_add_f32 v[206:207],v[206:207],v[166:167]
v_cvt_pk_bf16_f32 v168,v200,v201
v_cvt_pk_bf16_f32 v169,v202,v203
v_cvt_pk_bf16_f32 v170,v204,v205
v_cvt_pk_bf16_f32 v171,v206,v207
v_lshlrev_b32 v200,16,v168
v_and_b32 v201,0xffff0000,v168
v_lshlrev_b32 v202,16,v169
v_and_b32 v203,0xffff0000,v169
v_lshlrev_b32 v204,16,v170
v_and_b32 v205,0xffff0000,v170
v_lshlrev_b32 v206,16,v171
v_and_b32 v207,0xffff0000,v171
v_readfirstlane_b32 s78,v200
s_nop 1
v_pk_add_f32 v[184:185],v[200:201],s[78:79] op_sel_hi:[1,0] neg_lo:[0,1] neg_hi:[0,1]
v_pk_add_f32 v[186:187],v[202:203],s[78:79] op_sel_hi:[1,0] neg_lo:[0,1] neg_hi:[0,1]
v_pk_add_f32 v[188:189],v[204:205],s[78:79] op_sel_hi:[1,0] neg_lo:[0,1] neg_hi:[0,1]
v_pk_add_f32 v[190:191],v[206:207],s[78:79] op_sel_hi:[1,0] neg_lo:[0,1] neg_hi:[0,1]
v_pk_add_f32 v[192:193],v[184:185],v[186:187]
v_pk_mul_f32 v[194:195],v[184:185],v[184:185]
v_pk_add_f32 v[196:197],v[188:189],v[190:191]
v_pk_fma_f32 v[194:195],v[186:187],v[186:187],v[194:195]
v_pk_add_f32 v[192:193],v[192:193],v[196:197]
v_pk_fma_f32 v[194:195],v[188:189],v[188:189],v[194:195]
v_add_f32 v192,v192,v193
v_pk_fma_f32 v[194:195],v[190:191],v[190:191],v[194:195]
v_add_f32 v194,v194,v195
s_nop 1
v_permlane32_swap_b32 v192,v194
v_add_f32 v192,v192,v194
s_nop 1
v_add_f32_dpp v192,v192,v192 row_ror:8 row_mask:0xf bank_mask:0xf
s_nop 1
v_add_f32_dpp v192,v192,v192 row_ror:4 row_mask:0xf bank_mask:0xf
s_nop 1
v_add_f32_dpp v192,v192,v192 row_ror:2 row_mask:0xf bank_mask:0xf
s_nop 1
v_add_f32_dpp v192,v192,v192 row_ror:1 row_mask:0xf bank_mask:0xf
v_mov_b32 v194,v192
s_nop 1
v_permlane16_swap_b32 v192,v194
v_add_f32 v192,v192,v194
v_mul_f32 v192,0x3b000000,v192
v_mov_b32 v194,v192
s_nop 1
v_permlane32_swap_b32 v192,v194
v_fma_f32 v194,-v192,v192,v194
v_add_f32 v192,s78,v192
v_max_f32 v194,0,v194
v_cvt_pk_bf16_f32 v194,v192,v194
v_lshlrev_b32 v192,16,v194
v_and_b32 v194,0xffff0000,v194
v_add_f32 v194,0x3727c5ac,v194
v_cvt_pk_bf16_f32 v194,v194,v194
v_and_b32 v194,0xffff0000,v194
v_sqrt_f32 v194,v194
v_pk_add_f32 v[184:185],v[200:201],v[192:193] op_sel_hi:[1,0] neg_lo:[0,1] neg_hi:[0,1]
v_pk_add_f32 v[186:187],v[202:203],v[192:193] op_sel_hi:[1,0] neg_lo:[0,1] neg_hi:[0,1]
v_pk_add_f32 v[188:189],v[204:205],v[192:193] op_sel_hi:[1,0] neg_lo:[0,1] neg_hi:[0,1]
v_pk_add_f32 v[190:191],v[206:207],v[192:193] op_sel_hi:[1,0] neg_lo:[0,1] neg_hi:[0,1]
v_cvt_pk_bf16_f32 v194,v194,v194
v_and_b32 v194,0xffff0000,v194
v_rcp_f32 v194,v194
v_cvt_pk_bf16_f32 v172,v184,v185
v_cvt_pk_bf16_f32 v173,v186,v187
v_cvt_pk_bf16_f32 v174,v188,v189
v_cvt_pk_bf16_f32 v175,v190,v191
v_lshlrev_b32 v184,16,v172
v_and_b32 v185,0xffff0000,v172
v_lshlrev_b32 v186,16,v173
v_and_b32 v187,0xffff0000,v173
v_lshlrev_b32 v188,16,v174
v_and_b32 v189,0xffff0000,v174
v_lshlrev_b32 v190,16,v175
v_and_b32 v191,0xffff0000,v175
v_pk_mul_f32 v[184:185],v[184:185],v[194:195] op_sel_hi:[1,0]
v_pk_mul_f32 v[186:187],v[186:187],v[194:195] op_sel_hi:[1,0]
v_pk_mul_f32 v[188:189],v[188:189],v[194:195] op_sel_hi:[1,0]
v_pk_mul_f32 v[190:191],v[190:191],v[194:195] op_sel_hi:[1,0]
v_cvt_pk_bf16_f32 v172,v184,v185
v_cvt_pk_bf16_f32 v173,v186,v187
v_cvt_pk_bf16_f32 v174,v188,v189
v_cvt_pk_bf16_f32 v175,v190,v191
v_lshlrev_b32 v176,16,v172
v_and_b32 v177,0xffff0000,v172
v_lshlrev_b32 v178,16,v173
v_and_b32 v179,0xffff0000,v173
v_lshlrev_b32 v180,16,v174
v_and_b32 v181,0xffff0000,v174
v_lshlrev_b32 v182,16,v175
v_and_b32 v183,0xffff0000,v175
v_pk_add_f32 v[200:201],v[200:201],v[176:177]
v_pk_add_f32 v[202:203],v[202:203],v[178:179]
v_pk_add_f32 v[204:205],v[204:205],v[180:181]
v_pk_add_f32 v[206:207],v[206:207],v[182:183]
v_cvt_pk_bf16_f32 v160,v200,v201
v_cvt_pk_bf16_f32 v161,v202,v203
v_cvt_pk_bf16_f32 v162,v204,v205
v_cvt_pk_bf16_f32 v163,v206,v207
buffer_store_dwordx4 v[160:163],v0,s[8:11],s20 offen sc1
v_lshlrev_b32 v200,16,v160
v_and_b32 v201,0xffff0000,v160
v_lshlrev_b32 v202,16,v161
v_and_b32 v203,0xffff0000,v161
v_lshlrev_b32 v204,16,v162
v_and_b32 v205,0xffff0000,v162
v_lshlrev_b32 v206,16,v163
v_and_b32 v207,0xffff0000,v163
v_readfirstlane_b32 s78,v200
s_nop 1
v_pk_add_f32 v[184:185],v[200:201],s[78:79] op_sel_hi:[1,0] neg_lo:[0,1] neg_hi:[0,1]
v_pk_add_f32 v[186:187],v[202:203],s[78:79] op_sel_hi:[1,0] neg_lo:[0,1] neg_hi:[0,1]
v_pk_add_f32 v[188:189],v[204:205],s[78:79] op_sel_hi:[1,0] neg_lo:[0,1] neg_hi:[0,1]
v_pk_add_f32 v[190:191],v[206:207],s[78:79] op_sel_hi:[1,0] neg_lo:[0,1] neg_hi:[0,1]
v_pk_add_f32 v[192:193],v[184:185],v[186:187]
v_pk_mul_f32 v[194:195],v[184:185],v[184:185]
v_pk_add_f32 v[196:197],v[188:189],v[190:191]
v_pk_fma_f32 v[194:195],v[186:187],v[186:187],v[194:195]
v_pk_add_f32 v[192:193],v[192:193],v[196:197]
v_pk_fma_f32 v[194:195],v[188:189],v[188:189],v[194:195]
v_add_f32 v192,v192,v193
v_pk_fma_f32 v[194:195],v[190:191],v[190:191],v[194:195]
v_add_f32 v194,v194,v195
s_nop 1
v_permlane32_swap_b32 v192,v194
v_add_f32 v192,v192,v194
s_nop 1
v_add_f32_dpp v192,v192,v192 row_ror:8 row_mask:0xf bank_mask:0xf
s_nop 1
v_add_f32_dpp v192,v192,v192 row_ror:4 row_mask:0xf bank_mask:0xf
s_nop 1
v_add_f32_dpp v192,v192,v192 row_ror:2 row_mask:0xf bank_mask:0xf
s_nop 1
v_add_f32_dpp v192,v192,v192 row_ror:1 row_mask:0xf bank_mask:0xf
v_mov_b32 v194,v192
s_nop 1
v_permlane16_swap_b32 v192,v194
v_add_f32 v192,v192,v194
v_mul_f32 v192,0x3b000000,v192
v_mov_b32 v194,v192
s_nop 1
v_permlane32_swap_b32 v192,v194
v_fma_f32 v194,-v192,v192,v194
v_add_f32 v192,s78,v192
v_max_f32 v194,0,v194
v_cvt_pk_bf16_f32 v194,v192,v194
v_lshlrev_b32 v192,16,v194
v_and_b32 v194,0xffff0000,v194
v_add_f32 v194,0x3727c5ac,v194
v_cvt_pk_bf16_f32 v194,v194,v194
v_and_b32 v194,0xffff0000,v194
v_sqrt_f32 v194,v194
v_pk_add_f32 v[184:185],v[200:201],v[192:193] op_sel_hi:[1,0] neg_lo:[0,1] neg_hi:[0,1]
v_pk_add_f32 v[186:187],v[202:203],v[192:193] op_sel_hi:[1,0] neg_lo:[0,1] neg_hi:[0,1]
v_pk_add_f32 v[188:189],v[204:205],v[192:193] op_sel_hi:[1,0] neg_lo:[0,1] neg_hi:[0,1]
v_pk_add_f32 v[190:191],v[206:207],v[192:193] op_sel_hi:[1,0] neg_lo:[0,1] neg_hi:[0,1]
v_cvt_pk_bf16_f32 v194,v194,v194
v_and_b32 v194,0xffff0000,v194
v_rcp_f32 v194,v194
v_cvt_pk_bf16_f32 v164,v184,v185
v_cvt_pk_bf16_f32 v165,v186,v187
v_cvt_pk_bf16_f32 v166,v188,v189
v_cvt_pk_bf16_f32 v167,v190,v191
v_lshlrev_b32 v184,16,v164
v_and_b32 v185,0xffff0000,v164
v_lshlrev_b32 v186,16,v165
v_and_b32 v187,0xffff0000,v165
v_lshlrev_b32 v188,16,v166
v_and_b32 v189,0xffff0000,v166
v_lshlrev_b32 v190,16,v167
v_and_b32 v191,0xffff0000,v167
v_pk_mul_f32 v[184:185],v[184:185],v[194:195] op_sel_hi:[1,0]
v_pk_mul_f32 v[186:187],v[186:187],v[194:195] op_sel_hi:[1,0]
v_pk_mul_f32 v[188:189],v[188:189],v[194:195] op_sel_hi:[1,0]
v_pk_mul_f32 v[190:191],v[190:191],v[194:195] op_sel_hi:[1,0]
v_cvt_pk_bf16_f32 v164,v184,v185
v_cvt_pk_bf16_f32 v165,v186,v187
v_cvt_pk_bf16_f32 v166,v188,v189
v_cvt_pk_bf16_f32 v167,v190,v191
s_add_u32 s20,s19,2097152
buffer_store_dwordx4 v[164:167],v0,s[8:11],s20 offen sc1
v_mov_b32 v20,1
s_lshl_b32 s73,s51,13
s_lshl2_add_u32 s73,s68,s73
s_add_u32 s73,s73,10487552
s_branch L_aa_264
L_ar_288:
ds_read_b128 v[160:163],v23
ds_read_b128 v[164:167],v23 offset:16
v_lshlrev_b32 v200,16,v224
v_and_b32 v201,0xffff0000,v224
v_lshlrev_b32 v202,16,v225
v_and_b32 v203,0xffff0000,v225
v_lshlrev_b32 v204,16,v226
v_and_b32 v205,0xffff0000,v226
v_lshlrev_b32 v206,16,v227
v_and_b32 v207,0xffff0000,v227
s_lshl_b32 s18,s51,5
s_add_u32 s18,s18,s68
s_lshl_b32 s19,s18,10
s_add_u32 s20,s19,4194304
s_waitcnt lgkmcnt(0)
v_cvt_pk_bf16_f32 v168,v160,v161
v_cvt_pk_bf16_f32 v169,v162,v163
v_cvt_pk_bf16_f32 v170,v164,v165
v_cvt_pk_bf16_f32 v171,v166,v167
v_lshlrev_b32 v160,16,v168
v_and_b32 v161,0xffff0000,v168
v_lshlrev_b32 v162,16,v169
v_and_b32 v163,0xffff0000,v169
v_lshlrev_b32 v164,16,v170
v_and_b32 v165,0xffff0000,v170
v_lshlrev_b32 v166,16,v171
v_and_b32 v167,0xffff0000,v171
v_pk_add_f32 v[200:201],v[200:201],v[160:161]
v_pk_add_f32 v[202:203],v[202:203],v[162:163]
v_pk_add_f32 v[204:205],v[204:205],v[164:165]
v_pk_add_f32 v[206:207],v[206:207],v[166:167]
v_cvt_pk_bf16_f32 v168,v200,v201
v_cvt_pk_bf16_f32 v169,v202,v203
v_cvt_pk_bf16_f32 v170,v204,v205
v_cvt_pk_bf16_f32 v171,v206,v207
buffer_store_dwordx4 v[168:171],v0,s[8:11],s20 offen sc1
v_lshlrev_b32 v200,16,v168
v_and_b32 v201,0xffff0000,v168
v_lshlrev_b32 v202,16,v169
v_and_b32 v203,0xffff0000,v169
v_lshlrev_b32 v204,16,v170
v_and_b32 v205,0xffff0000,v170
v_lshlrev_b32 v206,16,v171
v_and_b32 v207,0xffff0000,v171
v_readfirstlane_b32 s78,v200
s_nop 1
v_pk_add_f32 v[184:185],v[200:201],s[78:79] op_sel_hi:[1,0] neg_lo:[0,1] neg_hi:[0,1]
v_pk_add_f32 v[186:187],v[202:203],s[78:79] op_sel_hi:[1,0] neg_lo:[0,1] neg_hi:[0,1]
v_pk_add_f32 v[188:189],v[204:205],s[78:79] op_sel_hi:[1,0] neg_lo:[0,1] neg_hi:[0,1]
v_pk_add_f32 v[190:191],v[206:207],s[78:79] op_sel_hi:[1,0] neg_lo:[0,1] neg_hi:[0,1]
v_pk_add_f32 v[192:193],v[184:185],v[186:187]
v_pk_mul_f32 v[194:195],v[184:185],v[184:185]
v_pk_add_f32 v[196:197],v[188:189],v[190:191]
v_pk_fma_f32 v[194:195],v[186:187],v[186:187],v[194:195]
v_pk_add_f32 v[192:193],v[192:193],v[196:197]
v_pk_fma_f32 v[194:195],v[188:189],v[188:189],v[194:195]
v_add_f32 v192,v192,v193
v_pk_fma_f32 v[194:195],v[190:191],v[190:191],v[194:195]
v_add_f32 v194,v194,v195
s_nop 1
v_permlane32_swap_b32 v192,v194
v_add_f32 v192,v192,v194
s_nop 1
v_add_f32_dpp v192,v192,v192 row_ror:8 row_mask:0xf bank_mask:0xf
s_nop 1
v_add_f32_dpp v192,v192,v192 row_ror:4 row_mask:0xf bank_mask:0xf
s_nop 1
v_add_f32_dpp v192,v192,v192 row_ror:2 row_mask:0xf bank_mask:0xf
s_nop 1
v_add_f32_dpp v192,v192,v192 row_ror:1 row_mask:0xf bank_mask:0xf
v_mov_b32 v194,v192
s_nop 1
v_permlane16_swap_b32 v192,v194
v_add_f32 v192,v192,v194
v_mul_f32 v192,0x3b000000,v192
v_mov_b32 v194,v192
s_nop 1
v_permlane32_swap_b32 v192,v194
v_fma_f32 v194,-v192,v192,v194
v_add_f32 v192,s78,v192
v_max_f32 v194,0,v194
v_cvt_pk_bf16_f32 v194,v192,v194
v_lshlrev_b32 v192,16,v194
v_and_b32 v194,0xffff0000,v194
v_add_f32 v194,0x3727c5ac,v194
v_cvt_pk_bf16_f32 v194,v194,v194
v_and_b32 v194,0xffff0000,v194
v_sqrt_f32 v194,v194
v_pk_add_f32 v[184:185],v[200:201],v[192:193] op_sel_hi:[1,0] neg_lo:[0,1] neg_hi:[0,1]
v_pk_add_f32 v[186:187],v[202:203],v[192:193] op_sel_hi:[1,0] neg_lo:[0,1] neg_hi:[0,1]
v_pk_add_f32 v[188:189],v[204:205],v[192:193] op_sel_hi:[1,0] neg_lo:[0,1] neg_hi:[0,1]
v_pk_add_f32 v[190:191],v[206:207],v[192:193] op_sel_hi:[1,0] neg_lo:[0,1] neg_hi:[0,1]
v_cvt_pk_bf16_f32 v194,v194,v194
v_and_b32 v194,0xffff0000,v194
v_rcp_f32 v194,v194
v_cvt_pk_bf16_f32 v172,v184,v185
v_cvt_pk_bf16_f32 v173,v186,v187
v_cvt_pk_bf16_f32 v174,v188,v189
v_cvt_pk_bf16_f32 v175,v190,v191
v_lshlrev_b32 v184,16,v172
v_and_b32 v185,0xffff0000,v172
v_lshlrev_b32 v186,16,v173
v_and_b32 v187,0xffff0000,v173
v_lshlrev_b32 v188,16,v174
v_and_b32 v189,0xffff0000,v174
v_lshlrev_b32 v190,16,v175
v_and_b32 v191,0xffff0000,v175
v_pk_mul_f32 v[184:185],v[184:185],v[194:195] op_sel_hi:[1,0]
v_pk_mul_f32 v[186:187],v[186:187],v[194:195] op_sel_hi:[1,0]
v_pk_mul_f32 v[188:189],v[188:189],v[194:195] op_sel_hi:[1,0]
v_pk_mul_f32 v[190:191],v[190:191],v[194:195] op_sel_hi:[1,0]
v_cvt_pk_bf16_f32 v172,v184,v185
v_cvt_pk_bf16_f32 v173,v186,v187
v_cvt_pk_bf16_f32 v174,v188,v189
v_cvt_pk_bf16_f32 v175,v190,v191
v_lshlrev_b32 v176,16,v172
v_and_b32 v177,0xffff0000,v172
v_lshlrev_b32 v178,16,v173
v_and_b32 v179,0xffff0000,v173
v_lshlrev_b32 v180,16,v174
v_and_b32 v181,0xffff0000,v174
v_lshlrev_b32 v182,16,v175
v_and_b32 v183,0xffff0000,v175
v_pk_mul_f32 v[236:237],v[176:177],v[228:229]
v_pk_fma_f32 v[236:237],v[178:179],v[230:231],v[236:237]
v_pk_fma_f32 v[236:237],v[180:181],v[232:233],v[236:237]
v_pk_fma_f32 v[236:237],v[182:183],v[234:235],v[236:237]
v_add_f32 v236,v236,v237
s_nop 1
v_add_f32_dpp v236,v236,v236 row_ror:8 row_mask:0xf bank_mask:0xf
s_nop 1
v_add_f32_dpp v236,v236,v236 row_ror:4 row_mask:0xf bank_mask:0xf
s_nop 1
v_add_f32_dpp v236,v236,v236 row_ror:2 row_mask:0xf bank_mask:0xf
s_nop 1
v_add_f32_dpp v236,v236,v236 row_ror:1 row_mask:0xf bank_mask:0xf
v_mov_b32 v237,v236
s_nop 1
v_permlane16_swap_b32 v236,v237
v_add_f32 v236,v236,v237
v_mov_b32 v237,v236
s_nop 1
v_permlane32_swap_b32 v236,v237
v_add_f32 v236,v236,v237
v_cvt_pk_bf16_f32 v236,v236,v236
v_and_b32 v236,0xffff0000,v236
v_ashrrev_i32 v237,31,v236
v_or_b32 v237,0x80000000,v237
v_xor_b32 v236,v236,v237
v_and_b32 v236,0xffff0000,v236
s_sub_u32 s20,4095,s18
v_or_b32 v20,s20,v236
s_lshl_b32 s20,s51,13
s_lshl2_add_u32 s20,s68,s20
s_add_u32 s20,s20,10485760
buffer_store_dword v20,v254,s[8:11],s20 offen sc1
s_branch L_aa_264
L_ar_289:
s_bitcmp1_b32 s46,0
s_cbranch_scc1 L_aa_264
ds_read_b128 v[160:163],v23
ds_read_b128 v[164:167],v23 offset:16
v_lshlrev_b32 v200,16,v224
v_and_b32 v201,0xffff0000,v224
v_lshlrev_b32 v202,16,v225
v_and_b32 v203,0xffff0000,v225
v_lshlrev_b32 v204,16,v226
v_and_b32 v205,0xffff0000,v226
v_lshlrev_b32 v206,16,v227
v_and_b32 v207,0xffff0000,v227
v_readfirstlane_b32 s22,v246
s_cmp_eq_u32 s22,0
s_cbranch_scc1 L_ag_290
L_agb_291:
s_lshl_b32 s18,s51,5
s_add_u32 s18,s18,s68
s_lshl_b32 s19,s18,10
s_add_u32 s20,s19,6291456
s_waitcnt lgkmcnt(0)
v_cvt_pk_bf16_f32 v168,v160,v161
v_cvt_pk_bf16_f32 v169,v162,v163
v_cvt_pk_bf16_f32 v170,v164,v165
v_cvt_pk_bf16_f32 v171,v166,v167
v_lshlrev_b32 v160,16,v168
v_and_b32 v161,0xffff0000,v168
v_lshlrev_b32 v162,16,v169
v_and_b32 v163,0xffff0000,v169
v_lshlrev_b32 v164,16,v170
v_and_b32 v165,0xffff0000,v170
v_lshlrev_b32 v166,16,v171
v_and_b32 v167,0xffff0000,v171
v_pk_add_f32 v[200:201],v[200:201],v[160:161]
v_pk_add_f32 v[202:203],v[202:203],v[162:163]
v_pk_add_f32 v[204:205],v[204:205],v[164:165]
v_pk_add_f32 v[206:207],v[206:207],v[166:167]
v_cvt_pk_bf16_f32 v168,v200,v201
v_cvt_pk_bf16_f32 v169,v202,v203
v_cvt_pk_bf16_f32 v170,v204,v205
v_cvt_pk_bf16_f32 v171,v206,v207
buffer_store_dwordx4 v[168:171],v0,s[8:11],s20 offen sc1
v_lshlrev_b32 v200,16,v168
v_and_b32 v201,0xffff0000,v168
v_lshlrev_b32 v202,16,v169
v_and_b32 v203,0xffff0000,v169
v_lshlrev_b32 v204,16,v170
v_and_b32 v205,0xffff0000,v170
v_lshlrev_b32 v206,16,v171
v_and_b32 v207,0xffff0000,v171
v_readfirstlane_b32 s78,v200
s_nop 1
v_pk_add_f32 v[184:185],v[200:201],s[78:79] op_sel_hi:[1,0] neg_lo:[0,1] neg_hi:[0,1]
v_pk_add_f32 v[186:187],v[202:203],s[78:79] op_sel_hi:[1,0] neg_lo:[0,1] neg_hi:[0,1]
v_pk_add_f32 v[188:189],v[204:205],s[78:79] op_sel_hi:[1,0] neg_lo:[0,1] neg_hi:[0,1]
v_pk_add_f32 v[190:191],v[206:207],s[78:79] op_sel_hi:[1,0] neg_lo:[0,1] neg_hi:[0,1]
v_pk_add_f32 v[192:193],v[184:185],v[186:187]
v_pk_mul_f32 v[194:195],v[184:185],v[184:185]
v_pk_add_f32 v[196:197],v[188:189],v[190:191]
v_pk_fma_f32 v[194:195],v[186:187],v[186:187],v[194:195]
v_pk_add_f32 v[192:193],v[192:193],v[196:197]
v_pk_fma_f32 v[194:195],v[188:189],v[188:189],v[194:195]
v_add_f32 v192,v192,v193
v_pk_fma_f32 v[194:195],v[190:191],v[190:191],v[194:195]
v_add_f32 v194,v194,v195
s_nop 1
v_permlane32_swap_b32 v192,v194
v_add_f32 v192,v192,v194
s_nop 1
v_add_f32_dpp v192,v192,v192 row_ror:8 row_mask:0xf bank_mask:0xf
s_nop 1
v_add_f32_dpp v192,v192,v192 row_ror:4 row_mask:0xf bank_mask:0xf
s_nop 1
v_add_f32_dpp v192,v192,v192 row_ror:2 row_mask:0xf bank_mask:0xf
s_nop 1
v_add_f32_dpp v192,v192,v192 row_ror:1 row_mask:0xf bank_mask:0xf
v_mov_b32 v194,v192
s_nop 1
v_permlane16_swap_b32 v192,v194
v_add_f32 v192,v192,v194
v_mul_f32 v192,0x3b000000,v192
v_mov_b32 v194,v192
s_nop 1
v_permlane32_swap_b32 v192,v194
v_fma_f32 v194,-v192,v192,v194
v_add_f32 v192,s78,v192
v_max_f32 v194,0,v194
v_cvt_pk_bf16_f32 v194,v192,v194
v_lshlrev_b32 v192,16,v194
v_and_b32 v194,0xffff0000,v194
v_add_f32 v194,0x3727c5ac,v194
v_cvt_pk_bf16_f32 v194,v194,v194
v_and_b32 v194,0xffff0000,v194
v_sqrt_f32 v194,v194
v_pk_add_f32 v[184:185],v[200:201],v[192:193] op_sel_hi:[1,0] neg_lo:[0,1] neg_hi:[0,1]
v_pk_add_f32 v[186:187],v[202:203],v[192:193] op_sel_hi:[1,0] neg_lo:[0,1] neg_hi:[0,1]
v_pk_add_f32 v[188:189],v[204:205],v[192:193] op_sel_hi:[1,0] neg_lo:[0,1] neg_hi:[0,1]
v_pk_add_f32 v[190:191],v[206:207],v[192:193] op_sel_hi:[1,0] neg_lo:[0,1] neg_hi:[0,1]
v_cvt_pk_bf16_f32 v194,v194,v194
v_and_b32 v194,0xffff0000,v194
v_rcp_f32 v194,v194
v_cvt_pk_bf16_f32 v172,v184,v185
v_cvt_pk_bf16_f32 v173,v186,v187
v_cvt_pk_bf16_f32 v174,v188,v189
v_cvt_pk_bf16_f32 v175,v190,v191
v_lshlrev_b32 v184,16,v172
v_and_b32 v185,0xffff0000,v172
v_lshlrev_b32 v186,16,v173
v_and_b32 v187,0xffff0000,v173
v_lshlrev_b32 v188,16,v174
v_and_b32 v189,0xffff0000,v174
v_lshlrev_b32 v190,16,v175
v_and_b32 v191,0xffff0000,v175
v_pk_mul_f32 v[184:185],v[184:185],v[194:195] op_sel_hi:[1,0]
v_pk_mul_f32 v[186:187],v[186:187],v[194:195] op_sel_hi:[1,0]
v_pk_mul_f32 v[188:189],v[188:189],v[194:195] op_sel_hi:[1,0]
v_pk_mul_f32 v[190:191],v[190:191],v[194:195] op_sel_hi:[1,0]
v_cvt_pk_bf16_f32 v172,v184,v185
v_cvt_pk_bf16_f32 v173,v186,v187
v_cvt_pk_bf16_f32 v174,v188,v189
v_cvt_pk_bf16_f32 v175,v190,v191
v_lshlrev_b32 v176,16,v172
v_and_b32 v177,0xffff0000,v172
v_lshlrev_b32 v178,16,v173
v_and_b32 v179,0xffff0000,v173
v_lshlrev_b32 v180,16,v174
v_and_b32 v181,0xffff0000,v174
v_lshlrev_b32 v182,16,v175
v_and_b32 v183,0xffff0000,v175
v_pk_add_f32 v[200:201],v[200:201],v[176:177]
v_pk_add_f32 v[202:203],v[202:203],v[178:179]
v_pk_add_f32 v[204:205],v[204:205],v[180:181]
v_pk_add_f32 v[206:207],v[206:207],v[182:183]
v_cvt_pk_bf16_f32 v160,v200,v201
v_cvt_pk_bf16_f32 v161,v202,v203
v_cvt_pk_bf16_f32 v162,v204,v205
v_cvt_pk_bf16_f32 v163,v206,v207
buffer_store_dwordx4 v[160:163],v0,s[12:15],s19 offen sc1
v_pk_mul_f32 v[236:237],v[176:177],v[228:229]
v_pk_fma_f32 v[236:237],v[178:179],v[230:231],v[236:237]
v_pk_fma_f32 v[236:237],v[180:181],v[232:233],v[236:237]
v_pk_fma_f32 v[236:237],v[182:183],v[234:235],v[236:237]
v_add_f32 v236,v236,v237
s_nop 1
v_add_f32_dpp v236,v236,v236 row_ror:8 row_mask:0xf bank_mask:0xf
s_nop 1
v_add_f32_dpp v236,v236,v236 row_ror:4 row_mask:0xf bank_mask:0xf
s_nop 1
v_add_f32_dpp v236,v236,v236 row_ror:2 row_mask:0xf bank_mask:0xf
s_nop 1
v_add_f32_dpp v236,v236,v236 row_ror:1 row_mask:0xf bank_mask:0xf
v_mov_b32 v237,v236
s_nop 1
v_permlane16_swap_b32 v236,v237
v_add_f32 v236,v236,v237
v_mov_b32 v237,v236
s_nop 1
v_permlane32_swap_b32 v236,v237
v_add_f32 v236,v236,v237
v_cvt_pk_bf16_f32 v236,v236,v236
v_and_b32 v236,0xffff0000,v236
v_ashrrev_i32 v237,31,v236
v_or_b32 v237,0x80000000,v237
v_xor_b32 v236,v236,v237
v_and_b32 v236,0xffff0000,v236
s_sub_u32 s20,4095,s18
v_or_b32 v20,s20,v236
s_lshl_b32 s73,s51,13
s_lshl2_add_u32 s73,s68,s73
s_add_u32 s73,s73,10485760
s_add_u32 s73,s73,s86
L_aa_264:
s_cmp_eq_u32 s27,1
s_cbranch_scc1 L_ad_292
s_cmp_eq_u32 s27,0
s_cbranch_scc1 L_aa_265
s_cmp_ge_u32 s77,64
s_cbranch_scc1 L_aa_268
L_aa_266:
s_waitcnt vmcnt(0)
buffer_store_dword v20,off,s[8:11],s73 sc1
s_mov_b32 s73,0x80000000
v_mov_b32 v18,0
s_mov_b32 s27,0
L_aw_293:
v_cmp_eq_u32 vcc,0,v18
s_cbranch_vccz L_awd_294
buffer_load_dword v18,v19,s[8:11],0 offen sc1
s_sub_u32 s49,s49,1
s_cbranch_scc1 L_abort2
s_waitcnt vmcnt(0)
s_branch L_aw_293
L_awd_294:
s_mov_b32 s64,s70
s_mov_b32 s65,s71
s_and_b32 s57,s46,1
s_mul_i32 s58,s57,12288
s_add_u32 s64,s64,s58
s_lshl_b32 s57,s57,11
s_add_u32 s65,s65,s57
s_and_b32 s59,s50,2048
s_lshl_b32 s59,s59,4
s_xor_b32 s60,s67,65536
s_add_u32 s59,s59,s60
s_add_u32 s58,s58,s59
s_add_u32 s57,s57,s59
s_add_u32 m0,s58,0
s_nop 0
buffer_load_dwordx4 v0,s[8:11],s64 offen offset:0 sc1 lds
buffer_load_dwordx4 v0,s[8:11],s64 offen offset:1024 sc1 lds
buffer_load_dwordx4 v0,s[8:11],s64 offen offset:2048 sc1 lds
buffer_load_dwordx4 v0,s[8:11],s64 offen offset:3072 sc1 lds
s_add_u32 m0,s58,4096
s_add_u32 s64,s64,4096
buffer_load_dwordx4 v0,s[8:11],s64 offen offset:0 sc1 lds
buffer_load_dwordx4 v0,s[8:11],s64 offen offset:1024 sc1 lds
buffer_load_dwordx4 v0,s[8:11],s64 offen offset:2048 sc1 lds
buffer_load_dwordx4 v0,s[8:11],s64 offen offset:3072 sc1 lds
s_add_u32 m0,s58,8192
s_add_u32 s64,s64,4096
buffer_load_dwordx4 v0,s[8:11],s64 offen offset:0 sc1 lds
buffer_load_dwordx4 v0,s[8:11],s64 offen offset:1024 sc1 lds
buffer_load_dwordx4 v0,s[8:11],s64 offen offset:2048 sc1 lds
buffer_load_dwordx4 v0,s[8:11],s64 offen offset:3072 sc1 lds
s_add_u32 m0,s57,24576
s_nop 0
buffer_load_dwordx4 v0,s[8:11],s65 offen offset:0 sc1 lds
buffer_load_dwordx4 v0,s[8:11],s65 offen offset:1024 sc1 lds
v_lshrrev_b32 v244,4,v1
s_sub_u32 s56,s77,8
v_add_u32 v244,s56,v244
v_max_i32 v244,0,v244
v_lshl_add_u32 v244,v244,13,v21
buffer_load_dwordx2 v[242:243],v244,s[8:11],0 offen sc1
s_waitcnt vmcnt(0) lgkmcnt(0)
s_barrier
s_xor_b32 s67,s67,65536
s_and_b32 s56,s50,2048
s_lshl_b32 s56,s56,4
s_add_u32 s56,s56,s67
v_add_u32 v2,s56,v0
v_add_u32 v239,s56,v253
s_and_b32 s56,s50,1024
s_lshl_b32 s56,s56,2
v_add_u32 v238,s56,v2
s_mov_b32 s76,s71
s_mov_b32 s53,s77
ds_read_b128 v[24:27],v238 offset:16384
ds_read_b128 v[40:43],v2 offset:0
ds_read_b128 v[56:59],v2 offset:4096
ds_read_b128 v[28:31],v238 offset:17408
ds_read_b128 v[44:47],v2 offset:1024
ds_read_b128 v[60:63],v2 offset:5120
ds_read_b128 v[32:35],v238 offset:18432
ds_read_b128 v[48:51],v2 offset:2048
ds_read_b128 v[64:67],v2 offset:6144
ds_read_b128 v[36:39],v238 offset:19456
ds_read_b128 v[52:55],v2 offset:3072
ds_read_b128 v[68:71],v2 offset:7168
s_waitcnt lgkmcnt(9)
v_mfma_f32_16x16x32_bf16 v[128:131],v[40:43],v[24:27],v[8:11]
ds_read_b128 v[72:75],v2 offset:24576
v_mfma_f32_16x16x32_bf16 v[132:135],v[56:59],v[24:27],v[12:15]
ds_read_b128 v[76:79],v2 offset:25600
s_waitcnt lgkmcnt(8)
v_mfma_f32_16x16x32_bf16 v[128:131],v[44:47],v[28:31],v[128:131]
ds_read_b128 v[80:83],v2 offset:26624
v_mfma_f32_16x16x32_bf16 v[132:135],v[60:63],v[28:31],v[132:135]
ds_read_b128 v[84:87],v2 offset:27648
s_waitcnt lgkmcnt(7)
v_mfma_f32_16x16x32_bf16 v[128:131],v[48:51],v[32:35],v[128:131]
ds_read_b64 v[120:121],v239 offset:24576
v_mfma_f32_16x16x32_bf16 v[132:135],v[64:67],v[32:35],v[132:135]
ds_read_b64 v[122:123],v239 offset:25600
s_waitcnt lgkmcnt(6)
v_mfma_f32_16x16x32_bf16 v[128:131],v[52:55],v[36:39],v[128:131]
ds_read_b64 v[124:125],v239 offset:26624
v_mfma_f32_16x16x32_bf16 v[132:135],v[68:71],v[36:39],v[132:135]
ds_read_b64 v[126:127],v239 offset:27648
s_waitcnt lgkmcnt(4)
v_mfma_f32_16x16x32_bf16 v[136:139],v[72:75],v[24:27],0
ds_read_b128 v[88:91],v2 offset:8192
ds_read_b128 v[92:95],v2 offset:9216
v_mfma_f32_16x16x32_bf16 v[136:139],v[76:79],v[28:31],v[136:139]
ds_read_b128 v[96:99],v2 offset:10240
ds_read_b128 v[100:103],v2 offset:11264
v_mfma_f32_16x16x32_bf16 v[136:139],v[80:83],v[32:35],v[136:139]
ds_read_b128 v[104:107],v2 offset:12288
ds_read_b128 v[108:111],v2 offset:13312
v_mfma_f32_16x16x32_bf16 v[136:139],v[84:87],v[36:39],v[136:139]
ds_read_b128 v[112:115],v2 offset:14336
ds_read_b128 v[116:119],v2 offset:15360
s_waitcnt lgkmcnt(0)
s_cmp_eq_u32 s30,0
s_cbranch_scc1 L_aa_267
s_cmp_lg_u32 s86,1536
s_cbranch_scc1 L_ae_295
s_mov_b32 s77,s35
s_mov_b32 s30,0
s_lshl_b32 s56,s77,5
s_add_u32 s56,s56,s68
s_mul_i32 s70,s56,24576
s_lshl_b32 s71,s56,12
s_lshl_b32 s59,s77,13
s_lshl2_add_u32 s59,s68,s59
s_add_u32 s59,s59,10485760
s_buffer_load_dword s32,s[8:11],s59 glc
s_mov_b32 s33,1
s_add_u32 s70,s70,100663296
s_add_u32 s71,s71,41943040
v_mov_b32 v19,s59
s_branch L_af_296
L_ae_295:
s_ff1_i32_b64 s77,s[84:85]
s_bitset0_b64 s[84:85],s77
s_min_u32 s77,s77,64
s_lshr_b32 s61,s55,5
s_lshl_b32 s56,s77,5
s_add_u32 s56,s56,s68
s_mul_i32 s70,s56,24576
s_lshl_b32 s71,s56,12
s_lshl_b32 s59,s77,13
s_lshl2_add_u32 s59,s68,s59
s_add_u32 s59,s59,10486144
s_cmp_lt_u32 s77,s61
s_cselect_b32 s57,0,16777216
s_cselect_b32 s60,0,128
s_add_u32 s60,s60,s59
s_add_u32 s60,s60,128
s_buffer_load_dword s33,s[8:11],s60 glc
s_add_u32 s71,s71,s57
s_add_u32 s71,s71,58720256
s_cmp_eq_u32 s77,s61
s_cselect_b32 s57,50331648,0
s_cselect_b32 s58,1536,0
s_add_u32 s59,s59,s58
s_buffer_load_dword s32,s[8:11],s59 glc
s_add_u32 s70,s70,s57
s_add_u32 s70,s70,150994944
v_mov_b32 v19,s59
v_writelane_b32 v19,s60,1
L_af_296:
v_max3_f32 v238,v128,v129,v130
v_max3_f32 v239,v131,v132,v133
v_max3_f32 v238,v134,v135,v238
v_max3_f32 v239,v138,v139,v239
v_max_f32 v238,v238,v239
v_max_f32 v239,v238,v239
s_nop 1
v_permlane16_swap_b32 v238,v239
v_max_f32 v238,v238,v239
v_max_f32 v239,v238,v239
s_nop 1
v_permlane32_swap_b32 v238,v239
v_max_f32 v238,v238,v239
v_mul_f32 v238,s80,v238
v_fma_f32 v128,v128,s80,-v238
v_fma_f32 v129,v129,s80,-v238
v_exp_f32 v128,v128
v_fma_f32 v130,v130,s80,-v238
v_exp_f32 v129,v129
v_fma_f32 v131,v131,s80,-v238
v_exp_f32 v130,v130
v_fma_f32 v132,v132,s80,-v238
v_exp_f32 v131,v131
v_fma_f32 v133,v133,s80,-v238
v_exp_f32 v132,v132
v_fma_f32 v134,v134,s80,-v238
v_exp_f32 v133,v133
v_fma_f32 v135,v135,s80,-v238
v_exp_f32 v134,v134
v_fma_f32 v138,v138,s80,-v238
v_exp_f32 v135,v135
v_fma_f32 v139,v139,s80,-v238
v_exp_f32 v138,v138
v_exp_f32 v139,v139
v_cvt_pk_bf16_f32 v140,v128,v129
v_cvt_pk_bf16_f32 v141,v130,v131
v_cvt_pk_bf16_f32 v142,v132,v133
v_cvt_pk_bf16_f32 v143,v134,v135
v_cvt_pk_bf16_f32 v144,v138,v139
v_mov_b32 v147,v144
v_mfma_f32_16x16x32_bf16 v[148:151],v[152:155],v[140:143],0
v_mfma_f32_16x16x32_bf16 v[24:27],v[88:91],v[140:143],0
v_mfma_f32_16x16x32_bf16 v[28:31],v[92:95],v[140:143],0
v_mfma_f32_16x16x16_bf16 v[148:151],v[152:153],v[144:145],v[148:151]
v_mfma_f32_16x16x32_bf16 v[32:35],v[96:99],v[140:143],0
v_mfma_f32_16x16x32_bf16 v[36:39],v[100:103],v[140:143],0
v_mfma_f32_16x16x32_bf16 v[40:43],v[104:107],v[140:143],0
v_mfma_f32_16x16x32_bf16 v[44:47],v[108:111],v[140:143],0
v_mfma_f32_16x16x32_bf16 v[48:51],v[112:115],v[140:143],0
v_mfma_f32_16x16x32_bf16 v[52:55],v[116:119],v[140:143],0
v_rcp_f32 v148,v148
v_mfma_f32_16x16x16_bf16 v[24:27],v[120:121],v[144:145],v[24:27]
v_mfma_f32_16x16x16_bf16 v[28:31],v[120:121],v[146:147],v[28:31]
v_mfma_f32_16x16x16_bf16 v[32:35],v[122:123],v[144:145],v[32:35]
v_mfma_f32_16x16x16_bf16 v[36:39],v[122:123],v[146:147],v[36:39]
v_mfma_f32_16x16x16_bf16 v[40:43],v[124:125],v[144:145],v[40:43]
v_pk_mul_f32 v[24:25],v[24:25],v[148:149] op_sel_hi:[1,0]
v_pk_mul_f32 v[26:27],v[26:27],v[148:149] op_sel_hi:[1,0]
v_mfma_f32_16x16x16_bf16 v[44:47],v[124:125],v[146:147],v[44:47]
v_pk_mul_f32 v[28:29],v[28:29],v[148:149] op_sel_hi:[1,0]
v_pk_mul_f32 v[30:31],v[30:31],v[148:149] op_sel_hi:[1,0]
v_mfma_f32_16x16x16_bf16 v[48:51],v[126:127],v[144:145],v[48:51]
v_cvt_pk_bf16_f32 v72,v24,v28
v_cvt_pk_bf16_f32 v73,v25,v29
v_mfma_f32_16x16x16_bf16 v[52:55],v[126:127],v[146:147],v[52:55]
v_cvt_pk_bf16_f32 v74,v26,v30
v_cvt_pk_bf16_f32 v75,v27,v31
ds_write_b128 v3,v[72:75] offset:0
v_pk_mul_f32 v[32:33],v[32:33],v[148:149] op_sel_hi:[1,0]
v_pk_mul_f32 v[34:35],v[34:35],v[148:149] op_sel_hi:[1,0]
v_pk_mul_f32 v[36:37],v[36:37],v[148:149] op_sel_hi:[1,0]
v_pk_mul_f32 v[38:39],v[38:39],v[148:149] op_sel_hi:[1,0]
v_cvt_pk_bf16_f32 v76,v32,v36
v_cvt_pk_bf16_f32 v77,v33,v37
v_cvt_pk_bf16_f32 v78,v34,v38
v_cvt_pk_bf16_f32 v79,v35,v39
ds_write_b128 v3,v[76:79] offset:1024
v_pk_mul_f32 v[40:41],v[40:41],v[148:149] op_sel_hi:[1,0]
v_pk_mul_f32 v[42:43],v[42:43],v[148:149] op_sel_hi:[1,0]
v_pk_mul_f32 v[44:45],v[44:45],v[148:149] op_sel_hi:[1,0]
v_pk_mul_f32 v[46:47],v[46:47],v[148:149] op_sel_hi:[1,0]
v_cvt_pk_bf16_f32 v80,v40,v44
v_cvt_pk_bf16_f32 v81,v41,v45
v_cvt_pk_bf16_f32 v82,v42,v46
v_cvt_pk_bf16_f32 v83,v43,v47
ds_write_b128 v3,v[80:83] offset:2048
v_pk_mul_f32 v[48:49],v[48:49],v[148:149] op_sel_hi:[1,0]
v_pk_mul_f32 v[50:51],v[50:51],v[148:149] op_sel_hi:[1,0]
v_pk_mul_f32 v[52:53],v[52:53],v[148:149] op_sel_hi:[1,0]
v_pk_mul_f32 v[54:55],v[54:55],v[148:149] op_sel_hi:[1,0]
v_cvt_pk_bf16_f32 v84,v48,v52
v_cvt_pk_bf16_f32 v85,v49,v53
v_cvt_pk_bf16_f32 v86,v50,v54
v_cvt_pk_bf16_f32 v87,v51,v55
ds_write_b128 v3,v[84:87] offset:3072
s_waitcnt lgkmcnt(0)
s_barrier
L_ad_292:
s_mov_b32 s51,s53
s_mov_b32 s31,1
s_branch L_aa_259
L_aa_265:
s_waitcnt vmcnt(0)
buffer_store_dword v20,off,s[8:11],s73 sc1
s_mov_b32 s73,0x80000000
L_aa_267:
s_mov_b32 s51,s53
s_mov_b32 s31,0
s_add_u32 s35,s53,4
s_cmp_lt_u32 s53,5
s_cbranch_scc1 L_ab_297
s_cmp_ge_u32 s53,62
s_cbranch_scc1 L_am_299
L_aw_300:
v_min_u32 v239,v242,v243
v_cmp_eq_u32 vcc,0,v239
s_cbranch_vccz L_awd_301
s_sleep 4
buffer_load_dwordx2 v[242:243],v244,s[8:11],0 offen sc1
s_sub_u32 s49,s49,1
s_cbranch_scc1 L_abort2
s_waitcnt vmcnt(0)
s_branch L_aw_300
L_awd_301:
v_max_u32 v242,v242,v243
s_nop 1
v_max_u32_dpp v242,v242,v242 row_ror:8 row_mask:0xf bank_mask:0xf
s_nop 1
v_max_u32_dpp v242,v242,v242 row_ror:4 row_mask:0xf bank_mask:0xf
s_nop 1
v_max_u32_dpp v242,v242,v242 row_ror:2 row_mask:0xf bank_mask:0xf
s_nop 1
v_max_u32_dpp v242,v242,v242 row_ror:1 row_mask:0xf bank_mask:0xf
v_mov_b32 v243,v242
s_nop 1
v_permlane16_swap_b32 v242,v243
v_max_u32 v242,v242,v243
v_mov_b32 v243,v242
s_nop 1
v_permlane32_swap_b32 v242,v243
v_max_u32 v242,v242,v243
s_nop 0
v_readfirstlane_b32 s56,v242
s_max_u32 s75,s75,s56
s_cmp_lt_u32 s53,9
s_cbranch_scc1 L_ab_297
s_mov_b32 s77,s36
s_and_b32 s55,s75,0x7ff
s_sub_u32 s55,2047,s55
s_cmp_lt_u32 s53,37
s_cselect_b32 s55,4095,s55
s_lshr_b32 s61,s55,5
s_mov_b32 s30,1
s_lshl_b32 s56,s77,5
s_add_u32 s56,s56,s68
s_mul_i32 s70,s56,24576
s_lshl_b32 s71,s56,12
s_lshl_b32 s59,s77,13
s_lshl2_add_u32 s59,s68,s59
s_add_u32 s59,s59,10486144
s_cmp_lt_u32 s77,s61
s_cselect_b32 s57,0,16777216
s_cselect_b32 s60,0,128
s_add_u32 s60,s60,s59
s_add_u32 s60,s60,128
s_add_u32 s71,s71,s57
s_add_u32 s71,s71,58720256
s_cmp_eq_u32 s77,s61
s_cselect_b32 s57,50331648,0
s_cselect_b32 s58,1536,0
s_add_u32 s59,s59,s58
s_add_u32 s70,s70,s57
s_add_u32 s70,s70,150994944
v_mov_b32 v19,s59
v_writelane_b32 v19,s60,1
s_branch L_aj_298
L_ab_297:
s_mov_b32 s77,s35
s_mov_b32 s30,0
s_lshl_b32 s56,s77,5
s_add_u32 s56,s56,s68
s_mul_i32 s70,s56,24576
s_lshl_b32 s71,s56,12
s_lshl_b32 s59,s77,13
s_lshl2_add_u32 s59,s68,s59
s_add_u32 s59,s59,10485760
s_mov_b32 s33,1
s_add_u32 s70,s70,100663296
s_add_u32 s71,s71,41943040
v_mov_b32 v19,s59
L_aj_298:
buffer_load_dword v18,v19,s[8:11],0 offen sc1
v_mfma_f32_16x16x32_bf16 v[136:139],v[72:75],v[24:27],0
v_max3_u32 v238,v72,v73,v74
v_max3_u32 v238,v74,v75,v238
v_mfma_f32_16x16x32_bf16 v[136:139],v[76:79],v[28:31],v[136:139]
v_max3_u32 v238,v76,v77,v238
v_max3_u32 v238,v78,v79,v238
v_mfma_f32_16x16x32_bf16 v[136:139],v[80:83],v[32:35],v[136:139]
v_max3_u32 v238,v80,v81,v238
v_max3_u32 v238,v82,v83,v238
v_mfma_f32_16x16x32_bf16 v[136:139],v[84:87],v[36:39],v[136:139]
v_max3_u32 v238,v84,v85,v238
v_max3_u32 v238,v86,v87,v238
v_max3_u32 v238,v120,v121,v238
v_max3_u32 v238,v122,v123,v238
v_max3_u32 v238,v124,v125,v238
v_max3_u32 v238,v126,v127,v238
v_cmp_eq_u32 vcc,-1,v238
s_cbranch_vccz L_aa_270
L_aa_269:
buffer_load_dwordx4 v[72:75],v0,s[8:11],s76 offen offset:0 sc1
buffer_load_dwordx4 v[76:79],v0,s[8:11],s76 offen offset:1024 sc1
buffer_load_dwordx4 v[80:83],v0,s[8:11],s76 offen offset:2048 sc1
buffer_load_dwordx4 v[84:87],v0,s[8:11],s76 offen offset:3072 sc1
buffer_load_dwordx2 v[120:121],v253,s[8:11],s76 offen offset:0 sc1
buffer_load_dwordx2 v[122:123],v253,s[8:11],s76 offen offset:1024 sc1
buffer_load_dwordx2 v[124:125],v253,s[8:11],s76 offen offset:2048 sc1
buffer_load_dwordx2 v[126:127],v253,s[8:11],s76 offen offset:3072 sc1
buffer_load_dword v18,v19,s[8:11],0 offen sc1
s_sub_u32 s49,s49,1
s_cbranch_scc1 L_abort2
s_waitcnt vmcnt(8)
v_mfma_f32_16x16x32_bf16 v[136:139],v[72:75],v[24:27],0
v_max3_u32 v238,v72,v73,v74
v_max3_u32 v238,v74,v75,v238
s_waitcnt vmcnt(7)
v_mfma_f32_16x16x32_bf16 v[136:139],v[76:79],v[28:31],v[136:139]
v_max3_u32 v238,v76,v77,v238
v_max3_u32 v238,v78,v79,v238
s_waitcnt vmcnt(6)
v_mfma_f32_16x16x32_bf16 v[136:139],v[80:83],v[32:35],v[136:139]
v_max3_u32 v238,v80,v81,v238
v_max3_u32 v238,v82,v83,v238
s_waitcnt vmcnt(5)
v_mfma_f32_16x16x32_bf16 v[136:139],v[84:87],v[36:39],v[136:139]
v_max3_u32 v238,v84,v85,v238
v_max3_u32 v238,v86,v87,v238
s_waitcnt vmcnt(1)
v_max3_u32 v238,v120,v121,v238
v_max3_u32 v238,v122,v123,v238
v_max3_u32 v238,v124,v125,v238
v_max3_u32 v238,v126,v127,v238
v_cmp_eq_u32 vcc,-1,v238
s_cbranch_vccnz L_aa_269
L_aa_270:
s_cmp_lg_u32 s27,3
s_cbranch_scc1 L_ai_302
v_max3_f32 v238,v128,v129,v130
v_max3_f32 v239,v131,v132,v133
v_max3_f32 v238,v134,v135,v238
v_max3_f32 v239,v138,v139,v239
v_max_f32 v238,v238,v239
v_max_f32 v239,v238,v239
s_nop 1
v_permlane16_swap_b32 v238,v239
v_max_f32 v238,v238,v239
v_max_f32 v239,v238,v239
s_nop 1
v_permlane32_swap_b32 v238,v239
v_max_f32 v238,v238,v239
v_mul_f32 v238,s80,v238
v_fma_f32 v128,v128,s80,-v238
v_fma_f32 v129,v129,s80,-v238
v_exp_f32 v128,v128
v_fma_f32 v130,v130,s80,-v238
v_exp_f32 v129,v129
v_fma_f32 v131,v131,s80,-v238
v_exp_f32 v130,v130
v_fma_f32 v132,v132,s80,-v238
v_exp_f32 v131,v131
v_fma_f32 v133,v133,s80,-v238
v_exp_f32 v132,v132
v_fma_f32 v134,v134,s80,-v238
v_exp_f32 v133,v133
v_fma_f32 v135,v135,s80,-v238
v_exp_f32 v134,v134
v_fma_f32 v138,v138,s80,-v238
v_exp_f32 v135,v135
v_fma_f32 v139,v139,s80,-v238
v_exp_f32 v138,v138
v_exp_f32 v139,v139
v_cvt_pk_bf16_f32 v140,v128,v129
v_cvt_pk_bf16_f32 v141,v130,v131
v_cvt_pk_bf16_f32 v142,v132,v133
v_cvt_pk_bf16_f32 v143,v134,v135
v_cvt_pk_bf16_f32 v144,v138,v139
v_mov_b32 v147,v144
buffer_load_dword v17,v16,s[8:11],s87 offen sc1
v_mfma_f32_16x16x32_bf16 v[148:151],v[152:155],v[140:143],0
v_mfma_f32_16x16x32_bf16 v[24:27],v[88:91],v[140:143],0
v_mfma_f32_16x16x32_bf16 v[28:31],v[92:95],v[140:143],0
v_mfma_f32_16x16x16_bf16 v[148:151],v[152:153],v[144:145],v[148:151]
v_mfma_f32_16x16x32_bf16 v[32:35],v[96:99],v[140:143],0
v_mfma_f32_16x16x32_bf16 v[36:39],v[100:103],v[140:143],0
v_mfma_f32_16x16x32_bf16 v[40:43],v[104:107],v[140:143],0
v_mfma_f32_16x16x32_bf16 v[44:47],v[108:111],v[140:143],0
v_mfma_f32_16x16x32_bf16 v[48:51],v[112:115],v[140:143],0
v_mfma_f32_16x16x32_bf16 v[52:55],v[116:119],v[140:143],0
v_rcp_f32 v148,v148
v_mfma_f32_16x16x16_bf16 v[24:27],v[120:121],v[144:145],v[24:27]
v_mfma_f32_16x16x16_bf16 v[28:31],v[120:121],v[146:147],v[28:31]
v_mfma_f32_16x16x16_bf16 v[32:35],v[122:123],v[144:145],v[32:35]
v_mfma_f32_16x16x16_bf16 v[36:39],v[122:123],v[146:147],v[36:39]
v_mfma_f32_16x16x16_bf16 v[40:43],v[124:125],v[144:145],v[40:43]
v_pk_mul_f32 v[24:25],v[24:25],v[148:149] op_sel_hi:[1,0]
v_pk_mul_f32 v[26:27],v[26:27],v[148:149] op_sel_hi:[1,0]
v_mfma_f32_16x16x16_bf16 v[44:47],v[124:125],v[146:147],v[44:47]
v_pk_mul_f32 v[28:29],v[28:29],v[148:149] op_sel_hi:[1,0]
v_pk_mul_f32 v[30:31],v[30:31],v[148:149] op_sel_hi:[1,0]
v_mfma_f32_16x16x16_bf16 v[48:51],v[126:127],v[144:145],v[48:51]
v_cvt_pk_bf16_f32 v72,v24,v28
v_cvt_pk_bf16_f32 v73,v25,v29
v_mfma_f32_16x16x16_bf16 v[52:55],v[126:127],v[146:147],v[52:55]
v_cvt_pk_bf16_f32 v74,v26,v30
v_cvt_pk_bf16_f32 v75,v27,v31
ds_write_b128 v3,v[72:75] offset:0
v_pk_mul_f32 v[32:33],v[32:33],v[148:149] op_sel_hi:[1,0]
v_pk_mul_f32 v[34:35],v[34:35],v[148:149] op_sel_hi:[1,0]
v_pk_mul_f32 v[36:37],v[36:37],v[148:149] op_sel_hi:[1,0]
v_pk_mul_f32 v[38:39],v[38:39],v[148:149] op_sel_hi:[1,0]
v_cvt_pk_bf16_f32 v76,v32,v36
v_cvt_pk_bf16_f32 v77,v33,v37
v_cvt_pk_bf16_f32 v78,v34,v38
v_cvt_pk_bf16_f32 v79,v35,v39
ds_write_b128 v3,v[76:79] offset:1024
s_waitcnt vmcnt(0)
v_cmp_gt_u32 vcc,s66,v17
v_pk_mul_f32 v[40:41],v[40:41],v[148:149] op_sel_hi:[1,0]
v_pk_mul_f32 v[42:43],v[42:43],v[148:149] op_sel_hi:[1,0]
v_pk_mul_f32 v[44:45],v[44:45],v[148:149] op_sel_hi:[1,0]
v_pk_mul_f32 v[46:47],v[46:47],v[148:149] op_sel_hi:[1,0]
s_cbranch_vccnz L_ap_303
L_apb_304:
s_xor_b32 s34,s69,524288
buffer_load_dwordx4 v[192:195],v7,s[8:11],s34 offen sc1
v_cvt_pk_bf16_f32 v80,v40,v44
v_cvt_pk_bf16_f32 v81,v41,v45
s_add_u32 s34,s34,4096
buffer_load_dwordx4 v[196:199],v7,s[8:11],s34 offen sc1
v_cvt_pk_bf16_f32 v82,v42,v46
v_cvt_pk_bf16_f32 v83,v43,v47
s_add_u32 s34,s34,4096
buffer_load_dwordx4 v[200:203],v7,s[8:11],s34 offen sc1
ds_write_b128 v3,v[80:83] offset:2048
v_pk_mul_f32 v[48:49],v[48:49],v[148:149] op_sel_hi:[1,0]
s_add_u32 s34,s34,4096
buffer_load_dwordx4 v[204:207],v7,s[8:11],s34 offen sc1
v_pk_mul_f32 v[50:51],v[50:51],v[148:149] op_sel_hi:[1,0]
v_pk_mul_f32 v[52:53],v[52:53],v[148:149] op_sel_hi:[1,0]
s_add_u32 s34,s34,4096
buffer_load_dwordx4 v[208:211],v7,s[8:11],s34 offen sc1
v_pk_mul_f32 v[54:55],v[54:55],v[148:149] op_sel_hi:[1,0]
v_cvt_pk_bf16_f32 v84,v48,v52
s_add_u32 s34,s34,4096
buffer_load_dwordx4 v[212:215],v7,s[8:11],s34 offen sc1
v_cvt_pk_bf16_f32 v85,v49,v53
v_cvt_pk_bf16_f32 v86,v50,v54
s_add_u32 s34,s34,4096
buffer_load_dwordx4 v[216:219],v7,s[8:11],s34 offen sc1
v_cvt_pk_bf16_f32 v87,v51,v55
ds_write_b128 v3,v[84:87] offset:3072
s_add_u32 s34,s34,4096
buffer_load_dwordx4 v[220:223],v7,s[8:11],s34 offen sc1
v_readlane_b32 s32,v18,0
v_readlane_b32 s33,v18,1
s_waitcnt lgkmcnt(0)
s_barrier
s_branch L_aa_272
L_ai_302:
v_max3_f32 v238,v128,v129,v130
v_max3_f32 v239,v131,v132,v133
v_max3_f32 v238,v134,v135,v238
v_max3_f32 v239,v138,v139,v239
v_max_f32 v238,v238,v239
v_max_f32 v239,v238,v239
s_nop 1
v_permlane16_swap_b32 v238,v239
v_max_f32 v238,v238,v239
v_max_f32 v239,v238,v239
s_nop 1
v_permlane32_swap_b32 v238,v239
v_max_f32 v238,v238,v239
v_mul_f32 v238,s80,v238
v_fma_f32 v128,v128,s80,-v238
v_fma_f32 v129,v129,s80,-v238
v_exp_f32 v128,v128
v_fma_f32 v130,v130,s80,-v238
v_exp_f32 v129,v129
v_fma_f32 v131,v131,s80,-v238
v_exp_f32 v130,v130
v_fma_f32 v132,v132,s80,-v238
v_exp_f32 v131,v131
v_fma_f32 v133,v133,s80,-v238
v_exp_f32 v132,v132
v_fma_f32 v134,v134,s80,-v238
v_exp_f32 v133,v133
v_fma_f32 v135,v135,s80,-v238
v_exp_f32 v134,v134
v_fma_f32 v138,v138,s80,-v238
v_exp_f32 v135,v135
v_fma_f32 v139,v139,s80,-v238
v_exp_f32 v138,v138
v_exp_f32 v139,v139
v_cvt_pk_bf16_f32 v140,v128,v129
v_cvt_pk_bf16_f32 v141,v130,v131
v_cvt_pk_bf16_f32 v142,v132,v133
v_cvt_pk_bf16_f32 v143,v134,v135
v_cvt_pk_bf16_f32 v144,v138,v139
v_mov_b32 v147,v144
v_mfma_f32_16x16x32_bf16 v[148:151],v[152:155],v[140:143],0
v_mfma_f32_16x16x32_bf16 v[24:27],v[88:91],v[140:143],0
v_mfma_f32_16x16x32_bf16 v[28:31],v[92:95],v[140:143],0
v_mfma_f32_16x16x16_bf16 v[148:151],v[152:153],v[144:145],v[148:151]
v_mfma_f32_16x16x32_bf16 v[32:35],v[96:99],v[140:143],0
v_mfma_f32_16x16x32_bf16 v[36:39],v[100:103],v[140:143],0
v_mfma_f32_16x16x32_bf16 v[40:43],v[104:107],v[140:143],0
v_mfma_f32_16x16x32_bf16 v[44:47],v[108:111],v[140:143],0
v_mfma_f32_16x16x32_bf16 v[48:51],v[112:115],v[140:143],0
v_mfma_f32_16x16x32_bf16 v[52:55],v[116:119],v[140:143],0
v_rcp_f32 v148,v148
v_mfma_f32_16x16x16_bf16 v[24:27],v[120:121],v[144:145],v[24:27]
v_mfma_f32_16x16x16_bf16 v[28:31],v[120:121],v[146:147],v[28:31]
v_mfma_f32_16x16x16_bf16 v[32:35],v[122:123],v[144:145],v[32:35]
v_mfma_f32_16x16x16_bf16 v[36:39],v[122:123],v[146:147],v[36:39]
v_mfma_f32_16x16x16_bf16 v[40:43],v[124:125],v[144:145],v[40:43]
v_pk_mul_f32 v[24:25],v[24:25],v[148:149] op_sel_hi:[1,0]
v_pk_mul_f32 v[26:27],v[26:27],v[148:149] op_sel_hi:[1,0]
v_mfma_f32_16x16x16_bf16 v[44:47],v[124:125],v[146:147],v[44:47]
v_pk_mul_f32 v[28:29],v[28:29],v[148:149] op_sel_hi:[1,0]
v_pk_mul_f32 v[30:31],v[30:31],v[148:149] op_sel_hi:[1,0]
v_mfma_f32_16x16x16_bf16 v[48:51],v[126:127],v[144:145],v[48:51]
v_cvt_pk_bf16_f32 v72,v24,v28
v_cvt_pk_bf16_f32 v73,v25,v29
v_mfma_f32_16x16x16_bf16 v[52:55],v[126:127],v[146:147],v[52:55]
v_cvt_pk_bf16_f32 v74,v26,v30
v_cvt_pk_bf16_f32 v75,v27,v31
ds_write_b128 v3,v[72:75] offset:0
v_pk_mul_f32 v[32:33],v[32:33],v[148:149] op_sel_hi:[1,0]
v_pk_mul_f32 v[34:35],v[34:35],v[148:149] op_sel_hi:[1,0]
v_pk_mul_f32 v[36:37],v[36:37],v[148:149] op_sel_hi:[1,0]
v_pk_mul_f32 v[38:39],v[38:39],v[148:149] op_sel_hi:[1,0]
v_cvt_pk_bf16_f32 v76,v32,v36
v_cvt_pk_bf16_f32 v77,v33,v37
v_cvt_pk_bf16_f32 v78,v34,v38
v_cvt_pk_bf16_f32 v79,v35,v39
ds_write_b128 v3,v[76:79] offset:1024
v_pk_mul_f32 v[40:41],v[40:41],v[148:149] op_sel_hi:[1,0]
v_pk_mul_f32 v[42:43],v[42:43],v[148:149] op_sel_hi:[1,0]
v_pk_mul_f32 v[44:45],v[44:45],v[148:149] op_sel_hi:[1,0]
v_pk_mul_f32 v[46:47],v[46:47],v[148:149] op_sel_hi:[1,0]
v_cvt_pk_bf16_f32 v80,v40,v44
v_cvt_pk_bf16_f32 v81,v41,v45
v_cvt_pk_bf16_f32 v82,v42,v46
v_cvt_pk_bf16_f32 v83,v43,v47
ds_write_b128 v3,v[80:83] offset:2048
v_pk_mul_f32 v[48:49],v[48:49],v[148:149] op_sel_hi:[1,0]
v_pk_mul_f32 v[50:51],v[50:51],v[148:149] op_sel_hi:[1,0]
v_pk_mul_f32 v[52:53],v[52:53],v[148:149] op_sel_hi:[1,0]
v_pk_mul_f32 v[54:55],v[54:55],v[148:149] op_sel_hi:[1,0]
v_cvt_pk_bf16_f32 v84,v48,v52
v_cvt_pk_bf16_f32 v85,v49,v53
v_cvt_pk_bf16_f32 v86,v50,v54
v_cvt_pk_bf16_f32 v87,v51,v55
ds_write_b128 v3,v[84:87] offset:3072
s_waitcnt vmcnt(0)
v_readlane_b32 s32,v18,0
v_readlane_b32 s33,v18,1
s_waitcnt lgkmcnt(0)
s_barrier
s_branch L_aa_259
L_aa_268:
s_cmp_lg_u32 s86,1536
s_cbranch_scc1 L_az_305
s_cmp_ge_u32 s35,66
s_cbranch_scc1 L_aa_258
v_subrev_u32 v248,s36,v1
v_and_b32 v248,0x80000003,v248
v_cmp_eq_u32 vcc,0,v248
v_lshlrev_b32 v248,2,v1
v_mov_b32 v249,0x40000000
v_cndmask_b32 v248,v249,v248,vcc
v_mov_b32 v249,3
s_or_b32 s59,s68,s46
s_mov_b32 s59,11018240
s_cmov_b32 s59,0x80000000
buffer_store_dword v249,v248,s[8:11],s59 offen sc1
L_aa_258:
s_waitcnt vmcnt(0)
buffer_store_dword v20,off,s[8:11],s73 sc1
s_mov_b32 s73,0x80000000
v_lshlrev_b32 v238,2,v1
v_add_u32 v248,155712,v238
s_cmp_lg_u32 s46,0
s_cbranch_scc1 L_an_306
s_lshl_b32 s59,s54,13
s_add_u32 s59,s59,11026432
L_fp_307:
s_sleep 1
buffer_load_dword v239,v238,s[8:11],s59 offen sc1
s_sub_u32 s49,s49,1
s_cbranch_scc1 L_abort2
s_waitcnt vmcnt(0)
v_cmp_eq_u32 vcc,0,v239
s_cbranch_vccnz L_fp_307
ds_write_b32 v248,v239
s_waitcnt lgkmcnt(0)
L_an_306:
s_barrier
ds_read_b32 v239,v248
s_mov_b32 s86,768
s_mov_b32 s30,1
s_waitcnt lgkmcnt(0)
v_readfirstlane_b32 s55,v239
v_and_b32 v239,255,v239
s_lshr_b32 s55,s55,8
s_lshr_b32 s61,s55,5
v_cmp_ne_u32 s[38:39],3,v239
v_cmp_le_u32 vcc,s61,v1
s_nop 1
v_cndmask_b32 v238,1,2,vcc
v_cmp_ne_u32 s[84:85],v238,v239
s_bcnt1_i32_b64 s56,s[84:85]
s_nop 0
v_mbcnt_lo_u32_b32 v238,s84,0
v_mbcnt_hi_u32_b32 v238,s85,v238
s_mul_i32 s56,s56,17
s_add_u32 s56,s56,48
s_lshr_b32 s56,s56,7
s_lshl_b32 s56,s56,1
v_cmp_gt_u32 vcc,s56,v238
v_and_b32 v239,1,v238
v_and_b32 v238,3,v238
v_add_u32 v238,2,v238
v_cndmask_b32 v238,v238,v239,vcc
v_cmp_eq_u32 vcc,s54,v238
s_and_b64 s[84:85],s[84:85],vcc
s_ff1_i32_b64 s77,s[84:85]
s_bitset0_b64 s[84:85],s77
s_min_u32 s77,s77,64
s_lshl_b32 s56,s77,5
s_add_u32 s56,s56,s68
s_mul_i32 s70,s56,24576
s_lshl_b32 s71,s56,12
s_lshl_b32 s59,s77,13
s_lshl2_add_u32 s59,s68,s59
s_add_u32 s59,s59,10486144
s_cmp_lt_u32 s77,s61
s_cselect_b32 s57,0,16777216
s_cselect_b32 s60,0,128
s_add_u32 s60,s60,s59
s_add_u32 s60,s60,128
s_buffer_load_dword s33,s[8:11],s60 glc
s_add_u32 s71,s71,s57
s_add_u32 s71,s71,58720256
s_cmp_eq_u32 s77,s61
s_cselect_b32 s57,50331648,0
s_cselect_b32 s58,1536,0
s_add_u32 s59,s59,s58
s_buffer_load_dword s32,s[8:11],s59 glc
s_add_u32 s70,s70,s57
s_add_u32 s70,s70,150994944
v_mov_b32 v19,s59
v_writelane_b32 v19,s60,1
s_cmp_lt_u32 s77,64
s_cbranch_scc1 L_aa_266
L_az_305:
s_waitcnt vmcnt(0)
buffer_store_dword v20,off,s[8:11],s73 sc1
s_mov_b32 s73,0x80000000
s_endpgm
L_ag_274:
s_lshl_b32 s21,s26,13
s_lshl2_add_u32 s21,s68,s21
s_add_u32 s21,s21,10487296
L_ww_308:
buffer_load_dword v246,off,s[8:11],s21 sc1
s_sub_u32 s49,s49,1
s_cbranch_scc1 L_abort2
s_waitcnt vmcnt(0)
v_readfirstlane_b32 s22,v246
s_cmp_eq_u32 s22,0
s_cbranch_scc1 L_ww_308
L_wwd_309:
s_branch L_agb_275
L_ap_281:
L_aw_310:
v_cmp_gt_u32 vcc,s66,v17
s_cbranch_vccz L_awd_311
buffer_load_dword v17,v16,s[8:11],s87 offen sc1
s_sub_u32 s49,s49,1
s_cbranch_scc1 L_abort2
s_waitcnt vmcnt(0)
s_branch L_aw_310
L_awd_311:
s_branch L_apb_282
L_ag_290:
s_lshl_b32 s21,s51,13
s_lshl2_add_u32 s21,s68,s21
s_add_u32 s21,s21,10487296
L_ww_312:
buffer_load_dword v246,off,s[8:11],s21 sc1
s_sub_u32 s49,s49,1
s_cbranch_scc1 L_abort2
s_waitcnt vmcnt(0)
v_readfirstlane_b32 s22,v246
s_cmp_eq_u32 s22,0
s_cbranch_scc1 L_ww_312
L_wwd_313:
s_branch L_agb_291
L_am_299:
v_subrev_u32 v248,s36,v1
v_and_b32 v248,0x80000003,v248
v_cmp_eq_u32 vcc,0,v248
v_lshlrev_b32 v248,2,v1
v_mov_b32 v249,0x40000000
v_cndmask_b32 v248,v249,v248,vcc
v_mov_b32 v249,3
s_or_b32 s59,s68,s46
s_mov_b32 s59,11018240
s_cmov_b32 s59,0x80000000
buffer_store_dword v249,v248,s[8:11],s59 offen sc1
s_branch L_ab_297
L_ap_303:
L_aw_314:
v_cmp_gt_u32 vcc,s66,v17
s_cbranch_vccz L_awd_315
buffer_load_dword v17,v16,s[8:11],s87 offen sc1
s_sub_u32 s49,s49,1
s_cbranch_scc1 L_abort2
s_waitcnt vmcnt(0)
s_branch L_aw_314
L_awd_315:
s_branch L_apb_304
s_endpgm
L_wm:
s_nop 11
v_and_b32 v120,15,v1
v_lshrrev_b32 v121,4,v1
v_mov_b32 v17,1
s_lshl_b32 s56,s46,15
v_add_u32 v18,s56,v0
s_lshl_b32 s56,s46,2
v_add_u32 v125,s56,v121
v_xor_b32 v126,v125,v120
v_lshlrev_b32 v126,4,v126
v_lshl_add_u32 v20,v125,10,v126
v_add_u32 v125,0,v121
v_xor_b32 v125,v125,v120
v_lshlrev_b32 v125,4,v125
v_lshl_add_u32 v125,v120,8,v125
v_add_u32 v4,131072,v125
v_add_u32 v125,4,v121
v_xor_b32 v125,v125,v120
v_lshlrev_b32 v125,4,v125
v_lshl_add_u32 v125,v120,8,v125
v_add_u32 v5,131072,v125
v_add_u32 v125,8,v121
v_xor_b32 v125,v125,v120
v_lshlrev_b32 v125,4,v125
v_lshl_add_u32 v125,v120,8,v125
v_add_u32 v6,131072,v125
v_add_u32 v125,12,v121
v_xor_b32 v125,v125,v120
v_lshlrev_b32 v125,4,v125
v_lshl_add_u32 v125,v120,8,v125
v_add_u32 v7,131072,v125
v_lshlrev_b32 v21,5,v120
v_and_b32 v125,1,v121
v_lshl_add_u32 v21,v125,4,v21
s_lshl_b32 s56,s46,9
v_lshrrev_b32 v125,1,v121
v_lshl_add_u32 v21,v125,11,v21
s_add_u32 s56,s56,155648
v_add_u32 v21,s56,v21
v_lshlrev_b32 v22,4,v120
v_lshl_add_u32 v22,v121,10,v22
s_lshl_b32 s56,s46,8
v_add_u32 v22,s56,v22
s_mov_b32 s54,0
s_mov_b32 s31,0
s_mov_b32 s53,4
s_mov_b32 s72,0x80000000
s_mov_b32 s73,0
s_mov_b32 s77,-1
s_mov_b32 s86,0
s_mov_b32 s19,0
s_mov_b32 s74,2478833664
s_mov_b32 s75,613566756
v_and_b32 v23,15,v1
v_lshlrev_b32 v23,3,v23
v_lshrrev_b32 v16,4,v1
v_lshl_add_u32 v23,v16,13,v23
v_mov_b32 v19,159744
v_lshl_add_u32 v16,v16,2,v19
s_ff1_i32_b64 s30,s[74:75]
s_bitset0_b64 s[74:75],s30
s_min_u32 s30,s30,127
s_lshl_b32 s70,s30,15
s_add_u32 s70,s70,0
s_add_u32 s71,s70,16384
L_mo_318:
s_cmp_lg_u32 s19,0
s_cbranch_scc1 L_mo_319
s_add_u32 m0,s50,131072
s_nop 0
buffer_load_dwordx4 v20,s[8:11],s70 offen offset:0 sc1 lds
s_add_u32 m0,s50,135168
s_nop 0
buffer_load_dwordx4 v20,s[8:11],s71 offen offset:0 sc1 lds
s_add_u32 m0,s50,139008
s_nop 0
buffer_load_dwordx4 v20,s[8:11],s70 offen offset:256 sc1 lds
s_add_u32 m0,s50,143104
s_nop 0
buffer_load_dwordx4 v20,s[8:11],s71 offen offset:256 sc1 lds
s_add_u32 m0,s50,146944
s_nop 0
buffer_load_dwordx4 v20,s[8:11],s70 offen offset:512 sc1 lds
s_add_u32 m0,s50,151040
s_nop 0
buffer_load_dwordx4 v20,s[8:11],s71 offen offset:512 sc1 lds
s_mov_b32 s19,1
s_waitcnt vmcnt(0)
L_mo_319:
s_mov_b32 s51,s30
s_mov_b64 s[68:69],s[70:71]
s_ff1_i32_b64 s30,s[74:75]
s_bitset0_b64 s[74:75],s30
s_min_u32 s30,s30,127
s_lshl_b32 s70,s30,15
s_add_u32 s70,s70,0
s_add_u32 s71,s70,16384
s_lshl_b32 s76,s31,13
s_add_u32 s76,s76,10487040
s_lshl_b32 s58,s51,5
s_add_u32 s58,s58,s47
s_mul_i32 s58,s58,24576
s_add_u32 s58,s58,100663296
s_add_u32 s61,s58,s50
s_add_u32 s62,s61,4096
s_add_u32 s63,s61,16384
s_add_u32 s64,s61,20480
s_add_u32 s65,s61,s50
s_add_u32 s65,s65,8192
s_waitcnt vmcnt(12)
s_barrier
ds_read_b128 v[72:75],v4 offset:0
ds_read_b128 v[76:79],v4 offset:4096
ds_read_b128 v[80:83],v5 offset:0
ds_read_b128 v[84:87],v5 offset:4096
s_add_u32 m0,s50,154880
s_nop 0
buffer_load_dwordx4 v20,s[8:11],s68 offen offset:768 sc1 lds
s_add_u32 m0,s50,158976
s_nop 0
buffer_load_dwordx4 v20,s[8:11],s69 offen offset:768 sc1 lds
s_waitcnt lgkmcnt(2)
v_mfma_f32_16x16x32_bf16 v[40:43],a[128:131],v[72:75],0
ds_read_b128 v[108:111],v6 offset:0
v_mfma_f32_16x16x32_bf16 v[56:59],v[72:75],v[128:131],0
v_mfma_f32_16x16x32_bf16 v[24:27],a[0:3],v[72:75],0
ds_read_b128 v[112:115],v6 offset:4096
v_mfma_f32_16x16x32_bf16 v[44:47],a[128:131],v[76:79],0
v_mfma_f32_16x16x32_bf16 v[60:63],v[76:79],v[128:131],0
v_mfma_f32_16x16x32_bf16 v[28:31],a[0:3],v[76:79],0
v_mfma_f32_16x16x32_bf16 v[48:51],a[136:139],v[72:75],0
v_mfma_f32_16x16x32_bf16 v[64:67],v[72:75],v[136:139],0
v_mfma_f32_16x16x32_bf16 v[32:35],a[8:11],v[72:75],0
v_mfma_f32_16x16x32_bf16 v[52:55],a[136:139],v[76:79],0
v_mfma_f32_16x16x32_bf16 v[68:71],v[76:79],v[136:139],0
v_mfma_f32_16x16x32_bf16 v[36:39],a[8:11],v[76:79],0
s_waitcnt lgkmcnt(2)
v_mfma_f32_16x16x32_bf16 v[40:43],a[132:135],v[80:83],v[40:43]
ds_read_b128 v[72:75],v7 offset:0
v_mfma_f32_16x16x32_bf16 v[56:59],v[80:83],v[132:135],v[56:59]
v_mfma_f32_16x16x32_bf16 v[24:27],a[4:7],v[80:83],v[24:27]
ds_read_b128 v[76:79],v7 offset:4096
v_mfma_f32_16x16x32_bf16 v[44:47],a[132:135],v[84:87],v[44:47]
v_mfma_f32_16x16x32_bf16 v[60:63],v[84:87],v[132:135],v[60:63]
v_mfma_f32_16x16x32_bf16 v[28:31],a[4:7],v[84:87],v[28:31]
v_mfma_f32_16x16x32_bf16 v[48:51],a[140:143],v[80:83],v[48:51]
v_mfma_f32_16x16x32_bf16 v[64:67],v[80:83],v[140:143],v[64:67]
v_mfma_f32_16x16x32_bf16 v[32:35],a[12:15],v[80:83],v[32:35]
v_mfma_f32_16x16x32_bf16 v[52:55],a[140:143],v[84:87],v[52:55]
v_mfma_f32_16x16x32_bf16 v[68:71],v[84:87],v[140:143],v[68:71]
v_mfma_f32_16x16x32_bf16 v[36:39],a[12:15],v[84:87],v[36:39]
s_waitcnt vmcnt(12)
s_barrier
s_waitcnt lgkmcnt(2)
v_mfma_f32_16x16x32_bf16 v[40:43],a[144:147],v[108:111],v[40:43]
ds_read_b128 v[80:83],v4 offset:8192
v_mfma_f32_16x16x32_bf16 v[56:59],v[108:111],v[144:147],v[56:59]
v_mfma_f32_16x16x32_bf16 v[24:27],a[16:19],v[108:111],v[24:27]
ds_read_b128 v[84:87],v4 offset:12288
v_mfma_f32_16x16x32_bf16 v[44:47],a[144:147],v[112:115],v[44:47]
v_mfma_f32_16x16x32_bf16 v[60:63],v[112:115],v[144:147],v[60:63]
v_mfma_f32_16x16x32_bf16 v[28:31],a[16:19],v[112:115],v[28:31]
v_mfma_f32_16x16x32_bf16 v[48:51],a[152:155],v[108:111],v[48:51]
v_mfma_f32_16x16x32_bf16 v[64:67],v[108:111],v[152:155],v[64:67]
v_mfma_f32_16x16x32_bf16 v[32:35],a[24:27],v[108:111],v[32:35]
v_mfma_f32_16x16x32_bf16 v[52:55],a[152:155],v[112:115],v[52:55]
v_mfma_f32_16x16x32_bf16 v[68:71],v[112:115],v[152:155],v[68:71]
v_mfma_f32_16x16x32_bf16 v[36:39],a[24:27],v[112:115],v[36:39]
s_waitcnt lgkmcnt(2)
v_mfma_f32_16x16x32_bf16 v[40:43],a[148:151],v[72:75],v[40:43]
ds_read_b128 v[108:111],v5 offset:8192
v_mfma_f32_16x16x32_bf16 v[56:59],v[72:75],v[148:151],v[56:59]
v_mfma_f32_16x16x32_bf16 v[24:27],a[20:23],v[72:75],v[24:27]
ds_read_b128 v[112:115],v5 offset:12288
v_mfma_f32_16x16x32_bf16 v[44:47],a[148:151],v[76:79],v[44:47]
v_mfma_f32_16x16x32_bf16 v[60:63],v[76:79],v[148:151],v[60:63]
v_mfma_f32_16x16x32_bf16 v[28:31],a[20:23],v[76:79],v[28:31]
v_mfma_f32_16x16x32_bf16 v[48:51],a[156:159],v[72:75],v[48:51]
v_mfma_f32_16x16x32_bf16 v[64:67],v[72:75],v[156:159],v[64:67]
v_mfma_f32_16x16x32_bf16 v[32:35],a[28:31],v[72:75],v[32:35]
v_mfma_f32_16x16x32_bf16 v[52:55],a[156:159],v[76:79],v[52:55]
v_mfma_f32_16x16x32_bf16 v[68:71],v[76:79],v[156:159],v[68:71]
v_mfma_f32_16x16x32_bf16 v[36:39],a[28:31],v[76:79],v[36:39]
s_waitcnt lgkmcnt(2)
v_mfma_f32_16x16x32_bf16 v[40:43],a[160:163],v[80:83],v[40:43]
ds_read_b128 v[72:75],v6 offset:8192
v_mfma_f32_16x16x32_bf16 v[56:59],v[80:83],v[160:163],v[56:59]
v_mfma_f32_16x16x32_bf16 v[24:27],a[32:35],v[80:83],v[24:27]
ds_read_b128 v[76:79],v6 offset:12288
v_mfma_f32_16x16x32_bf16 v[44:47],a[160:163],v[84:87],v[44:47]
v_mfma_f32_16x16x32_bf16 v[60:63],v[84:87],v[160:163],v[60:63]
v_mfma_f32_16x16x32_bf16 v[28:31],a[32:35],v[84:87],v[28:31]
v_mfma_f32_16x16x32_bf16 v[48:51],a[168:171],v[80:83],v[48:51]
v_mfma_f32_16x16x32_bf16 v[64:67],v[80:83],v[168:171],v[64:67]
v_mfma_f32_16x16x32_bf16 v[32:35],a[40:43],v[80:83],v[32:35]
v_mfma_f32_16x16x32_bf16 v[52:55],a[168:171],v[84:87],v[52:55]
v_mfma_f32_16x16x32_bf16 v[68:71],v[84:87],v[168:171],v[68:71]
v_mfma_f32_16x16x32_bf16 v[36:39],a[40:43],v[84:87],v[36:39]
s_waitcnt lgkmcnt(2)
v_mfma_f32_16x16x32_bf16 v[40:43],a[164:167],v[108:111],v[40:43]
ds_read_b128 v[80:83],v7 offset:8192
v_mfma_f32_16x16x32_bf16 v[56:59],v[108:111],v[164:167],v[56:59]
v_mfma_f32_16x16x32_bf16 v[24:27],a[36:39],v[108:111],v[24:27]
ds_read_b128 v[84:87],v7 offset:12288
v_mfma_f32_16x16x32_bf16 v[44:47],a[164:167],v[112:115],v[44:47]
v_mfma_f32_16x16x32_bf16 v[60:63],v[112:115],v[164:167],v[60:63]
v_mfma_f32_16x16x32_bf16 v[28:31],a[36:39],v[112:115],v[28:31]
v_mfma_f32_16x16x32_bf16 v[48:51],a[172:175],v[108:111],v[48:51]
v_mfma_f32_16x16x32_bf16 v[64:67],v[108:111],v[172:175],v[64:67]
v_mfma_f32_16x16x32_bf16 v[32:35],a[44:47],v[108:111],v[32:35]
v_mfma_f32_16x16x32_bf16 v[52:55],a[172:175],v[112:115],v[52:55]
v_mfma_f32_16x16x32_bf16 v[68:71],v[112:115],v[172:175],v[68:71]
v_mfma_f32_16x16x32_bf16 v[36:39],a[44:47],v[112:115],v[36:39]
s_waitcnt vmcnt(10)
s_barrier
s_waitcnt lgkmcnt(2)
v_mfma_f32_16x16x32_bf16 v[40:43],a[176:179],v[72:75],v[40:43]
ds_read_b128 v[108:111],v4 offset:16384
v_mfma_f32_16x16x32_bf16 v[56:59],v[72:75],v[176:179],v[56:59]
v_mfma_f32_16x16x32_bf16 v[24:27],a[48:51],v[72:75],v[24:27]
ds_read_b128 v[112:115],v4 offset:20480
v_mfma_f32_16x16x32_bf16 v[44:47],a[176:179],v[76:79],v[44:47]
v_mfma_f32_16x16x32_bf16 v[60:63],v[76:79],v[176:179],v[60:63]
v_mfma_f32_16x16x32_bf16 v[28:31],a[48:51],v[76:79],v[28:31]
v_mfma_f32_16x16x32_bf16 v[48:51],a[184:187],v[72:75],v[48:51]
v_mfma_f32_16x16x32_bf16 v[64:67],v[72:75],v[184:187],v[64:67]
v_mfma_f32_16x16x32_bf16 v[32:35],a[56:59],v[72:75],v[32:35]
v_mfma_f32_16x16x32_bf16 v[52:55],a[184:187],v[76:79],v[52:55]
v_mfma_f32_16x16x32_bf16 v[68:71],v[76:79],v[184:187],v[68:71]
v_mfma_f32_16x16x32_bf16 v[36:39],a[56:59],v[76:79],v[36:39]
s_waitcnt vmcnt(2)
s_barrier
s_or_b32 s72,s72,s52
buffer_store_dword v17,off,s[8:11],s72 sc1
s_waitcnt lgkmcnt(2)
v_mfma_f32_16x16x32_bf16 v[40:43],a[180:183],v[80:83],v[40:43]
ds_read_b128 v[72:75],v5 offset:16384
v_mfma_f32_16x16x32_bf16 v[56:59],v[80:83],v[180:183],v[56:59]
v_mfma_f32_16x16x32_bf16 v[24:27],a[52:55],v[80:83],v[24:27]
ds_read_b128 v[76:79],v5 offset:20480
v_mfma_f32_16x16x32_bf16 v[44:47],a[180:183],v[84:87],v[44:47]
v_mfma_f32_16x16x32_bf16 v[60:63],v[84:87],v[180:183],v[60:63]
v_mfma_f32_16x16x32_bf16 v[28:31],a[52:55],v[84:87],v[28:31]
v_mfma_f32_16x16x32_bf16 v[48:51],a[188:191],v[80:83],v[48:51]
v_mfma_f32_16x16x32_bf16 v[64:67],v[80:83],v[188:191],v[64:67]
v_mfma_f32_16x16x32_bf16 v[32:35],a[60:63],v[80:83],v[32:35]
v_mfma_f32_16x16x32_bf16 v[52:55],a[188:191],v[84:87],v[52:55]
v_mfma_f32_16x16x32_bf16 v[68:71],v[84:87],v[188:191],v[68:71]
v_mfma_f32_16x16x32_bf16 v[36:39],a[60:63],v[84:87],v[36:39]
s_waitcnt lgkmcnt(2)
v_mfma_f32_16x16x32_bf16 v[40:43],a[192:195],v[108:111],v[40:43]
ds_read_b128 v[80:83],v6 offset:16384
v_mfma_f32_16x16x32_bf16 v[56:59],v[108:111],v[192:195],v[56:59]
v_mfma_f32_16x16x32_bf16 v[24:27],a[64:67],v[108:111],v[24:27]
ds_read_b128 v[84:87],v6 offset:20480
v_mfma_f32_16x16x32_bf16 v[44:47],a[192:195],v[112:115],v[44:47]
v_mfma_f32_16x16x32_bf16 v[60:63],v[112:115],v[192:195],v[60:63]
v_mfma_f32_16x16x32_bf16 v[28:31],a[64:67],v[112:115],v[28:31]
v_mfma_f32_16x16x32_bf16 v[48:51],a[200:203],v[108:111],v[48:51]
v_mfma_f32_16x16x32_bf16 v[64:67],v[108:111],v[200:203],v[64:67]
v_mfma_f32_16x16x32_bf16 v[32:35],a[72:75],v[108:111],v[32:35]
v_mfma_f32_16x16x32_bf16 v[52:55],a[200:203],v[112:115],v[52:55]
v_mfma_f32_16x16x32_bf16 v[68:71],v[112:115],v[200:203],v[68:71]
v_mfma_f32_16x16x32_bf16 v[36:39],a[72:75],v[112:115],v[36:39]
s_waitcnt lgkmcnt(2)
v_mfma_f32_16x16x32_bf16 v[40:43],a[196:199],v[72:75],v[40:43]
ds_read_b128 v[108:111],v7 offset:16384
v_mfma_f32_16x16x32_bf16 v[56:59],v[72:75],v[196:199],v[56:59]
v_mfma_f32_16x16x32_bf16 v[24:27],a[68:71],v[72:75],v[24:27]
ds_read_b128 v[112:115],v7 offset:20480
v_mfma_f32_16x16x32_bf16 v[44:47],a[196:199],v[76:79],v[44:47]
v_mfma_f32_16x16x32_bf16 v[60:63],v[76:79],v[196:199],v[60:63]
v_mfma_f32_16x16x32_bf16 v[28:31],a[68:71],v[76:79],v[28:31]
v_mfma_f32_16x16x32_bf16 v[48:51],a[204:207],v[72:75],v[48:51]
v_mfma_f32_16x16x32_bf16 v[64:67],v[72:75],v[204:207],v[64:67]
v_mfma_f32_16x16x32_bf16 v[32:35],a[76:79],v[72:75],v[32:35]
v_mfma_f32_16x16x32_bf16 v[52:55],a[204:207],v[76:79],v[52:55]
v_mfma_f32_16x16x32_bf16 v[68:71],v[76:79],v[204:207],v[68:71]
v_mfma_f32_16x16x32_bf16 v[36:39],a[76:79],v[76:79],v[36:39]
s_waitcnt vmcnt(1)
s_barrier
s_waitcnt lgkmcnt(2)
v_mfma_f32_16x16x32_bf16 v[40:43],a[208:211],v[80:83],v[40:43]
ds_read_b128 v[72:75],v4 offset:24576
v_mfma_f32_16x16x32_bf16 v[56:59],v[80:83],v[208:211],v[56:59]
v_mfma_f32_16x16x32_bf16 v[24:27],a[80:83],v[80:83],v[24:27]
ds_read_b128 v[76:79],v4 offset:28672
v_mfma_f32_16x16x32_bf16 v[44:47],a[208:211],v[84:87],v[44:47]
v_mfma_f32_16x16x32_bf16 v[60:63],v[84:87],v[208:211],v[60:63]
v_mfma_f32_16x16x32_bf16 v[28:31],a[80:83],v[84:87],v[28:31]
v_mfma_f32_16x16x32_bf16 v[48:51],a[216:219],v[80:83],v[48:51]
v_mfma_f32_16x16x32_bf16 v[64:67],v[80:83],v[216:219],v[64:67]
v_mfma_f32_16x16x32_bf16 v[32:35],a[88:91],v[80:83],v[32:35]
v_mfma_f32_16x16x32_bf16 v[52:55],a[216:219],v[84:87],v[52:55]
v_mfma_f32_16x16x32_bf16 v[68:71],v[84:87],v[216:219],v[68:71]
v_mfma_f32_16x16x32_bf16 v[36:39],a[88:91],v[84:87],v[36:39]
s_waitcnt lgkmcnt(2)
v_mfma_f32_16x16x32_bf16 v[40:43],a[212:215],v[108:111],v[40:43]
ds_read_b128 v[80:83],v5 offset:24576
v_mfma_f32_16x16x32_bf16 v[56:59],v[108:111],v[212:215],v[56:59]
v_mfma_f32_16x16x32_bf16 v[24:27],a[84:87],v[108:111],v[24:27]
ds_read_b128 v[84:87],v5 offset:28672
v_mfma_f32_16x16x32_bf16 v[44:47],a[212:215],v[112:115],v[44:47]
v_mfma_f32_16x16x32_bf16 v[60:63],v[112:115],v[212:215],v[60:63]
v_mfma_f32_16x16x32_bf16 v[28:31],a[84:87],v[112:115],v[28:31]
v_mfma_f32_16x16x32_bf16 v[48:51],a[220:223],v[108:111],v[48:51]
v_mfma_f32_16x16x32_bf16 v[64:67],v[108:111],v[220:223],v[64:67]
v_mfma_f32_16x16x32_bf16 v[32:35],a[92:95],v[108:111],v[32:35]
v_mfma_f32_16x16x32_bf16 v[52:55],a[220:223],v[112:115],v[52:55]
v_mfma_f32_16x16x32_bf16 v[68:71],v[112:115],v[220:223],v[68:71]
v_mfma_f32_16x16x32_bf16 v[36:39],a[92:95],v[112:115],v[36:39]
s_barrier
s_waitcnt lgkmcnt(2)
v_mfma_f32_16x16x32_bf16 v[40:43],a[224:227],v[72:75],v[40:43]
ds_read_b128 v[108:111],v6 offset:24576
v_mfma_f32_16x16x32_bf16 v[56:59],v[72:75],v[224:227],v[56:59]
s_add_u32 m0,s50,131072
v_mfma_f32_16x16x32_bf16 v[24:27],a[96:99],v[72:75],v[24:27]
ds_read_b128 v[112:115],v6 offset:28672
v_mfma_f32_16x16x32_bf16 v[44:47],a[224:227],v[76:79],v[44:47]
buffer_load_dwordx4 v20,s[8:11],s70 offen offset:0 sc1 lds
v_mfma_f32_16x16x32_bf16 v[60:63],v[76:79],v[224:227],v[60:63]
s_add_u32 m0,s50,135168
v_mfma_f32_16x16x32_bf16 v[28:31],a[96:99],v[76:79],v[28:31]
buffer_load_dwordx4 v20,s[8:11],s71 offen offset:0 sc1 lds
v_mfma_f32_16x16x32_bf16 v[48:51],a[232:235],v[72:75],v[48:51]
s_add_u32 m0,s50,139008
v_mfma_f32_16x16x32_bf16 v[64:67],v[72:75],v[232:235],v[64:67]
buffer_load_dwordx4 v20,s[8:11],s70 offen offset:256 sc1 lds
v_mfma_f32_16x16x32_bf16 v[32:35],a[104:107],v[72:75],v[32:35]
s_add_u32 m0,s50,143104
v_mfma_f32_16x16x32_bf16 v[52:55],a[232:235],v[76:79],v[52:55]
buffer_load_dwordx4 v20,s[8:11],s71 offen offset:256 sc1 lds
v_mfma_f32_16x16x32_bf16 v[68:71],v[76:79],v[232:235],v[68:71]
s_add_u32 m0,s50,146944
v_mfma_f32_16x16x32_bf16 v[36:39],a[104:107],v[76:79],v[36:39]
buffer_load_dwordx4 v20,s[8:11],s70 offen offset:512 sc1 lds
s_waitcnt lgkmcnt(2)
v_mfma_f32_16x16x32_bf16 v[40:43],a[228:231],v[80:83],v[40:43]
ds_read_b128 v[72:75],v7 offset:24576
v_mfma_f32_16x16x32_bf16 v[56:59],v[80:83],v[228:231],v[56:59]
s_add_u32 m0,s50,151040
v_mfma_f32_16x16x32_bf16 v[24:27],a[100:103],v[80:83],v[24:27]
ds_read_b128 v[76:79],v7 offset:28672
v_mfma_f32_16x16x32_bf16 v[44:47],a[228:231],v[84:87],v[44:47]
buffer_load_dwordx4 v20,s[8:11],s71 offen offset:512 sc1 lds
v_mfma_f32_16x16x32_bf16 v[60:63],v[84:87],v[228:231],v[60:63]
buffer_load_dwordx2 v[124:125],v23,s[8:11],s76 offen sc1
v_mfma_f32_16x16x32_bf16 v[28:31],a[100:103],v[84:87],v[28:31]
v_mfma_f32_16x16x32_bf16 v[48:51],a[236:239],v[80:83],v[48:51]
v_mfma_f32_16x16x32_bf16 v[64:67],v[80:83],v[236:239],v[64:67]
v_mfma_f32_16x16x32_bf16 v[32:35],a[108:111],v[80:83],v[32:35]
v_mfma_f32_16x16x32_bf16 v[52:55],a[236:239],v[84:87],v[52:55]
v_mfma_f32_16x16x32_bf16 v[68:71],v[84:87],v[236:239],v[68:71]
v_mfma_f32_16x16x32_bf16 v[36:39],a[108:111],v[84:87],v[36:39]
s_waitcnt lgkmcnt(2)
v_mfma_f32_16x16x32_bf16 v[40:43],a[240:243],v[108:111],v[40:43]
v_mfma_f32_16x16x32_bf16 v[56:59],v[108:111],v[240:243],v[56:59]
v_mfma_f32_16x16x32_bf16 v[24:27],a[112:115],v[108:111],v[24:27]
v_mfma_f32_16x16x32_bf16 v[44:47],a[240:243],v[112:115],v[44:47]
v_mfma_f32_16x16x32_bf16 v[60:63],v[112:115],v[240:243],v[60:63]
v_mfma_f32_16x16x32_bf16 v[28:31],a[112:115],v[112:115],v[28:31]
v_mfma_f32_16x16x32_bf16 v[48:51],a[248:251],v[108:111],v[48:51]
v_mfma_f32_16x16x32_bf16 v[64:67],v[108:111],v[248:251],v[64:67]
v_mfma_f32_16x16x32_bf16 v[32:35],a[120:123],v[108:111],v[32:35]
v_mfma_f32_16x16x32_bf16 v[52:55],a[248:251],v[112:115],v[52:55]
v_mfma_f32_16x16x32_bf16 v[68:71],v[112:115],v[248:251],v[68:71]
v_mfma_f32_16x16x32_bf16 v[36:39],a[120:123],v[112:115],v[36:39]
s_waitcnt lgkmcnt(0)
v_mfma_f32_16x16x32_bf16 v[40:43],a[244:247],v[72:75],v[40:43]
v_mfma_f32_16x16x32_bf16 v[56:59],v[72:75],v[244:247],v[56:59]
v_mfma_f32_16x16x32_bf16 v[24:27],a[116:119],v[72:75],v[24:27]
v_mfma_f32_16x16x32_bf16 v[44:47],a[244:247],v[76:79],v[44:47]
v_mfma_f32_16x16x32_bf16 v[60:63],v[76:79],v[244:247],v[60:63]
v_mfma_f32_16x16x32_bf16 v[28:31],a[116:119],v[76:79],v[28:31]
v_mfma_f32_16x16x32_bf16 v[48:51],a[252:255],v[72:75],v[48:51]
v_mfma_f32_16x16x32_bf16 v[64:67],v[72:75],v[252:255],v[64:67]
v_mfma_f32_16x16x32_bf16 v[32:35],a[124:127],v[72:75],v[32:35]
v_mfma_f32_16x16x32_bf16 v[52:55],a[252:255],v[76:79],v[52:55]
v_mfma_f32_16x16x32_bf16 v[68:71],v[76:79],v[252:255],v[68:71]
v_mfma_f32_16x16x32_bf16 v[36:39],a[124:127],v[76:79],v[36:39]
s_lshl_b32 s56,s51,5
s_add_u32 s56,s56,s47
s_lshl_b32 s56,s56,12
s_add_u32 s56,s56,s50
s_add_u32 s56,s56,41943040
v_mov_b64 v[120:121],-1
v_mov_b64 v[122:123],-1
buffer_store_dwordx4 v[120:123],v0,s[8:11],s56 offen sc1
v_cvt_pk_bf16_f32 v72,v40,v48
v_cvt_pk_bf16_f32 v73,v41,v49
v_cvt_pk_bf16_f32 v74,v42,v50
v_cvt_pk_bf16_f32 v75,v43,v51
buffer_store_dwordx4 v[72:75],v0,s[8:11],s61 offen sc1
v_cvt_pk_bf16_f32 v76,v44,v52
v_cvt_pk_bf16_f32 v77,v45,v53
v_cvt_pk_bf16_f32 v78,v46,v54
v_cvt_pk_bf16_f32 v79,v47,v55
buffer_store_dwordx4 v[76:79],v0,s[8:11],s62 offen sc1
v_cvt_pk_bf16_f32 v80,v56,v57
v_cvt_pk_bf16_f32 v81,v58,v59
v_cvt_pk_bf16_f32 v82,v60,v61
v_cvt_pk_bf16_f32 v83,v62,v63
buffer_store_dwordx4 v[80:83],v0,s[8:11],s65 offen offset:0 sc1
v_cvt_pk_bf16_f32 v84,v64,v65
v_cvt_pk_bf16_f32 v85,v66,v67
v_cvt_pk_bf16_f32 v86,v68,v69
v_cvt_pk_bf16_f32 v87,v70,v71
buffer_store_dwordx4 v[84:87],v0,s[8:11],s65 offen offset:1024 sc1
v_cvt_pk_bf16_f32 v108,v24,v32
v_cvt_pk_bf16_f32 v109,v25,v33
v_cvt_pk_bf16_f32 v110,v26,v34
v_cvt_pk_bf16_f32 v111,v27,v35
buffer_store_dwordx4 v[108:111],v0,s[8:11],s63 offen sc1
v_cvt_pk_bf16_f32 v112,v28,v36
v_cvt_pk_bf16_f32 v113,v29,v37
v_cvt_pk_bf16_f32 v114,v30,v38
v_cvt_pk_bf16_f32 v115,v31,v39
buffer_store_dwordx4 v[112:115],v0,s[8:11],s64 offen sc1
s_lshl_b32 s72,s51,13
s_lshl2_add_u32 s72,s47,s72
s_add_u32 s72,s72,10485760
s_sub_u32 s53,s53,1
s_cmp_gt_i32 s53,0
s_cbranch_scc1 L_mo_319
s_mov_b32 s87,3
s_mov_b32 s18,0
s_waitcnt vmcnt(7)
s_branch L_mo_324
L_mo_317:
s_mov_b32 s55,s22
s_mov_b32 s22,s23
s_mov_b32 s23,s24
s_mov_b32 s24,-1
s_cmp_lg_u32 s55,-1
s_cbranch_scc1 L_mp_316
s_sub_u32 s56,s30,s31
s_cmp_gt_i32 s77,0
s_cselect_b32 s57,6,12
s_cmp_lt_i32 s56,s57
s_cbranch_scc1 L_mo_318
s_cmp_lt_i32 s56,26
s_cselect_b32 s87,s18,0
s_cmp_ge_u32 s31,56
s_cselect_b32 s56,1,s18
s_and_b32 s56,s56,s86
s_cselect_b32 s87,2,s87
s_mul_i32 s56,s87,s18
s_cmp_lg_u32 s56,0
s_cbranch_scc1 L_mo_322
s_mov_b32 s18,0
s_lshr_b32 s56,s72,31
s_or_b32 s56,s56,s87
s_cbranch_scc1 L_mo_328
s_waitcnt vmcnt(0)
s_barrier
s_or_b32 s72,s72,s52
buffer_store_dword v17,off,s[8:11],s72 sc1
s_mov_b32 s72,0x80000000
L_mo_328:
s_cmp_lg_u32 s46,0
s_cbranch_scc1 L_mo_326
s_lshl_b32 s76,s31,13
s_add_u32 s76,s76,10487040
L_mo_325:
buffer_load_dwordx2 v[124:125],v23,s[8:11],s76 offen sc1
s_sub_u32 s49,s49,1
s_cbranch_scc1 L_abort2
s_waitcnt vmcnt(0)
L_mo_324:
v_min_u32 v123,v124,v125
v_max_u32 v125,v124,v125
v_cmp_eq_u32 vcc,0,v123
s_nop 1
v_cndmask_b32 v125,v125,-1,vcc
s_and_b32 s56,vcc_lo,0xffff
s_cbranch_scc0 L_mo_329
s_cmp_lg_u32 s87,0
s_cbranch_scc1 L_mo_329
s_mov_b32 s18,1
s_sleep 2
s_branch L_mo_325
L_mo_329:
v_max_u32_dpp v125,v125,v125 row_ror:8 row_mask:0xf bank_mask:0xf
s_nop 1
v_max_u32_dpp v125,v125,v125 row_ror:4 row_mask:0xf bank_mask:0xf
s_nop 1
v_max_u32_dpp v125,v125,v125 row_ror:2 row_mask:0xf bank_mask:0xf
s_nop 1
v_max_u32_dpp v125,v125,v125 row_ror:1 row_mask:0xf bank_mask:0xf
L_mo_326:
s_sub_u32 s49,s49,1
s_cbranch_scc1 L_abort2
v_mov_b32 v124,s18
s_barrier
s_cmp_lg_u32 s46,0
s_cbranch_scc1 L_mo_327
ds_write_b32 v16,v125
ds_write_b32 v19,v124 offset:16
s_waitcnt lgkmcnt(0)
L_mo_327:
s_barrier
ds_read_b128 v[120:123],v19
ds_read_b32 v124,v19 offset:16
s_waitcnt lgkmcnt(0)
v_readfirstlane_b32 s55,v120
v_readfirstlane_b32 s22,v121
v_readfirstlane_b32 s23,v122
v_readfirstlane_b32 s24,v123
v_readfirstlane_b32 s18,v124
s_cmp_lg_u32 s55,-1
s_cbranch_scc1 L_mp_316
L_mo_322:
s_mov_b32 s22,-1
s_cmp_eq_u32 s87,1
s_cbranch_scc1 L_mo_318
s_cmp_eq_u32 s87,2
s_cbranch_scc1 L_mo_323
s_branch L_mo_317
L_mp_316:
s_sub_u32 s73,s73,1
s_max_i32 s73,s73,0
s_sub_u32 s77,s77,1
s_min_u32 s61,s73,2
s_cmp_gt_u32 s55,s54
s_cselect_b32 s77,s61,s77
s_cselect_b32 s54,s55,s54
s_cselect_b32 s86,0,s86
s_cmp_lg_u32 s31,63
s_cbranch_scc1 L_mo_320
s_min_i32 s77,s77,0
s_or_b32 s61,s47,s46
s_cbranch_scc1 L_mo_320
s_mov_b32 s59,11018240
v_lshlrev_b32 v120,2,v1
L_fp_331:
s_sleep 0
buffer_load_dword v121,v120,s[8:11],s59 offen sc1
s_sub_u32 s49,s49,1
s_cbranch_scc1 L_abort2
s_waitcnt vmcnt(0)
v_cmp_eq_u32 vcc,0,v121
s_cbranch_vccnz L_fp_331
s_andn2_b32 s62,0x7ff,s54
v_lshl_or_b32 v121,s62,8,v121
s_add_u32 s59,s59,8192
buffer_store_dword v121,v120,s[8:11],s59 offen sc1
s_add_u32 s59,s59,8192
buffer_store_dword v121,v120,s[8:11],s59 offen sc1
s_add_u32 s59,s59,8192
buffer_store_dword v121,v120,s[8:11],s59 offen sc1
s_add_u32 s59,s59,8192
buffer_store_dword v121,v120,s[8:11],s59 offen sc1
s_add_u32 s59,s59,8192
buffer_store_dword v121,v120,s[8:11],s59 offen sc1
s_add_u32 s59,s59,8192
buffer_store_dword v121,v120,s[8:11],s59 offen sc1
L_mo_320:
s_add_u32 s31,s31,1
s_cmp_gt_i32 s77,0
s_cmov_b32 s18,0
s_cbranch_scc1 L_mo_317
s_cmp_lg_u32 s77,0
s_cbranch_scc1 L_mo_321
s_andn2_b32 s51,0x7ff,s54
s_lshr_b32 s51,s51,5
s_add_u32 s73,s73,2
s_mov_b32 s86,1
s_mov_b32 s19,0
s_mov_b32 s18,0
s_waitcnt vmcnt(8)
s_barrier
s_and_b32 s64,s54,0x7ff
s_sub_u32 s64,2047,s64
s_lshl_b32 s56,s64,10
s_add_u32 s58,s56,4194304
buffer_load_dwordx4 v[88:91],v0,s[8:11],s58 offen sc1
s_mov_b32 s4,s38
s_mov_b32 s5,s39
s_mov_b32 s6,1835008
s_mov_b32 s7,0x20000
v_and_b32 v9,15,v1
v_lshrrev_b32 v10,4,v1
v_lshlrev_b32 v8,14,v10
v_lshl_add_u32 v8,v9,4,v8
s_lshl_b32 s59,s47,16
s_lshl_b32 s60,s46,8
s_add_u32 s59,s59,s60
buffer_load_dwordx4 v[24:27],v8,s[4:7],s59 offen offset:0
buffer_load_dwordx4 v[28:31],v8,s[4:7],s59 offen offset:1024
buffer_load_dwordx4 v[32:35],v8,s[4:7],s59 offen offset:2048
buffer_load_dwordx4 v[36:39],v8,s[4:7],s59 offen offset:3072
s_add_u32 s59,s59,4096
buffer_load_dwordx4 v[40:43],v8,s[4:7],s59 offen offset:0
buffer_load_dwordx4 v[44:47],v8,s[4:7],s59 offen offset:1024
buffer_load_dwordx4 v[48:51],v8,s[4:7],s59 offen offset:2048
buffer_load_dwordx4 v[52:55],v8,s[4:7],s59 offen offset:3072
s_add_u32 s59,s59,4096
buffer_load_dwordx4 v[56:59],v8,s[4:7],s59 offen offset:0
buffer_load_dwordx4 v[60:63],v8,s[4:7],s59 offen offset:1024
buffer_load_dwordx4 v[64:67],v8,s[4:7],s59 offen offset:2048
buffer_load_dwordx4 v[68:71],v8,s[4:7],s59 offen offset:3072
s_add_u32 s59,s59,4096
buffer_load_dwordx4 v[72:75],v8,s[4:7],s59 offen offset:0
buffer_load_dwordx4 v[76:79],v8,s[4:7],s59 offen offset:1024
buffer_load_dwordx4 v[80:83],v8,s[4:7],s59 offen offset:2048
buffer_load_dwordx4 v[84:87],v8,s[4:7],s59 offen offset:3072
v_and_b32 v124,1,v1
v_lshlrev_b32 v124,4,v124
v_mov_b32 v125,0xffff
v_lshlrev_b32 v125,v124,v125
v_lshrrev_b32 v124,1,v9
v_cmp_eq_u32 vcc,0,v124
s_nop 1
v_cndmask_b32 v12,0,v125,vcc
v_cmp_eq_u32 vcc,1,v124
s_nop 1
v_cndmask_b32 v13,0,v125,vcc
v_cmp_eq_u32 vcc,2,v124
s_nop 1
v_cndmask_b32 v14,0,v125,vcc
v_cmp_eq_u32 vcc,3,v124
s_nop 1
v_cndmask_b32 v15,0,v125,vcc
s_waitcnt vmcnt(16)
L_mx_332:
v_max3_u32 v124,v88,v89,v90
v_max_u32 v124,v91,v124
v_cmp_eq_u32 vcc,-1,v124
s_cbranch_vccz L_mxd_333
buffer_load_dwordx4 v[88:91],v0,s[8:11],s58 offen sc1
s_sub_u32 s49,s49,1
s_cbranch_scc1 L_abort2
s_waitcnt vmcnt(0)
s_branch L_mx_332
L_mxd_333:
v_lshlrev_b32 v96,16,v88
v_and_b32 v97,0xffff0000,v88
v_lshlrev_b32 v98,16,v89
v_and_b32 v99,0xffff0000,v89
v_lshlrev_b32 v100,16,v90
v_and_b32 v101,0xffff0000,v90
v_lshlrev_b32 v102,16,v91
v_and_b32 v103,0xffff0000,v91
v_readfirstlane_b32 s78,v96
s_nop 1
v_pk_add_f32 v[108:109],v[96:97],s[78:79] op_sel_hi:[1,0] neg_lo:[0,1] neg_hi:[0,1]
v_pk_add_f32 v[110:111],v[98:99],s[78:79] op_sel_hi:[1,0] neg_lo:[0,1] neg_hi:[0,1]
v_pk_add_f32 v[112:113],v[100:101],s[78:79] op_sel_hi:[1,0] neg_lo:[0,1] neg_hi:[0,1]
v_pk_add_f32 v[114:115],v[102:103],s[78:79] op_sel_hi:[1,0] neg_lo:[0,1] neg_hi:[0,1]
v_pk_add_f32 v[116:117],v[108:109],v[110:111]
v_pk_mul_f32 v[118:119],v[108:109],v[108:109]
v_pk_add_f32 v[120:121],v[112:113],v[114:115]
v_pk_fma_f32 v[118:119],v[110:111],v[110:111],v[118:119]
v_pk_add_f32 v[116:117],v[116:117],v[120:121]
v_pk_fma_f32 v[118:119],v[112:113],v[112:113],v[118:119]
v_add_f32 v116,v116,v117
v_pk_fma_f32 v[118:119],v[114:115],v[114:115],v[118:119]
v_add_f32 v118,v118,v119
s_nop 1
v_permlane32_swap_b32 v116,v118
v_add_f32 v116,v116,v118
s_nop 1
v_add_f32_dpp v116,v116,v116 row_ror:8 row_mask:0xf bank_mask:0xf
s_nop 1
v_add_f32_dpp v116,v116,v116 row_ror:4 row_mask:0xf bank_mask:0xf
s_nop 1
v_add_f32_dpp v116,v116,v116 row_ror:2 row_mask:0xf bank_mask:0xf
s_nop 1
v_add_f32_dpp v116,v116,v116 row_ror:1 row_mask:0xf bank_mask:0xf
v_mov_b32 v118,v116
s_nop 1
v_permlane16_swap_b32 v116,v118
v_add_f32 v116,v116,v118
v_mul_f32 v116,0x3b000000,v116
v_mov_b32 v118,v116
s_nop 1
v_permlane32_swap_b32 v116,v118
v_fma_f32 v118,-v116,v116,v118
v_add_f32 v116,s78,v116
v_max_f32 v118,0,v118
v_cvt_pk_bf16_f32 v118,v116,v118
v_lshlrev_b32 v116,16,v118
v_and_b32 v118,0xffff0000,v118
v_add_f32 v118,0x3727c5ac,v118
v_cvt_pk_bf16_f32 v118,v118,v118
v_and_b32 v118,0xffff0000,v118
v_sqrt_f32 v118,v118
v_pk_add_f32 v[108:109],v[96:97],v[116:117] op_sel_hi:[1,0] neg_lo:[0,1] neg_hi:[0,1]
v_pk_add_f32 v[110:111],v[98:99],v[116:117] op_sel_hi:[1,0] neg_lo:[0,1] neg_hi:[0,1]
v_pk_add_f32 v[112:113],v[100:101],v[116:117] op_sel_hi:[1,0] neg_lo:[0,1] neg_hi:[0,1]
v_pk_add_f32 v[114:115],v[102:103],v[116:117] op_sel_hi:[1,0] neg_lo:[0,1] neg_hi:[0,1]
v_cvt_pk_bf16_f32 v118,v118,v118
v_and_b32 v118,0xffff0000,v118
v_rcp_f32 v118,v118
v_cvt_pk_bf16_f32 v104,v108,v109
v_cvt_pk_bf16_f32 v105,v110,v111
v_cvt_pk_bf16_f32 v106,v112,v113
v_cvt_pk_bf16_f32 v107,v114,v115
v_lshlrev_b32 v108,16,v104
v_and_b32 v109,0xffff0000,v104
v_lshlrev_b32 v110,16,v105
v_and_b32 v111,0xffff0000,v105
v_lshlrev_b32 v112,16,v106
v_and_b32 v113,0xffff0000,v106
v_lshlrev_b32 v114,16,v107
v_and_b32 v115,0xffff0000,v107
v_pk_mul_f32 v[108:109],v[108:109],v[118:119] op_sel_hi:[1,0]
v_pk_mul_f32 v[110:111],v[110:111],v[118:119] op_sel_hi:[1,0]
v_pk_mul_f32 v[112:113],v[112:113],v[118:119] op_sel_hi:[1,0]
v_pk_mul_f32 v[114:115],v[114:115],v[118:119] op_sel_hi:[1,0]
v_cvt_pk_bf16_f32 v104,v108,v109
v_cvt_pk_bf16_f32 v105,v110,v111
v_cvt_pk_bf16_f32 v106,v112,v113
v_cvt_pk_bf16_f32 v107,v114,v115
s_mov_b32 s58,0x01000100
s_mov_b32 s59,0x03020302
v_perm_b32 v88,v104,v104,s58
v_perm_b32 v89,v104,v104,s59
v_perm_b32 v90,v105,v105,s58
v_perm_b32 v91,v105,v105,s59
v_perm_b32 v92,v106,v106,s58
v_perm_b32 v93,v106,v106,s59
v_perm_b32 v94,v107,v107,s58
v_perm_b32 v95,v107,v107,s59
v_lshlrev_b32 v8,5,v1
s_lshl_b32 s58,s46,11
s_add_u32 s58,s58,139264
v_add_u32 v8,s58,v8
ds_write_b128 v8,v[88:91]
ds_write_b128 v8,v[92:95] offset:16
s_lshl_b32 s59,s46,9
s_add_u32 s59,s58,s59
v_lshlrev_b32 v8,7,v10
v_add_u32 v8,s59,v8
s_waitcnt lgkmcnt(0)
ds_read_b128 v[108:111],v18 offset:0
ds_read_b128 v[88:91],v8 offset:0
ds_read_b128 v[92:95],v8 offset:16
ds_read_b128 v[112:115],v18 offset:1024
s_waitcnt lgkmcnt(1)
v_and_b32 v124,v12,v88
v_and_b32 v125,v13,v88
v_and_b32 v126,v14,v88
v_and_b32 v127,v15,v88
s_nop 1
v_mfma_f32_16x16x32_bf16 v[116:119],v[124:127],v[108:111],0
ds_read_b128 v[108:111],v18 offset:2048
s_waitcnt lgkmcnt(1)
v_and_b32 v124,v12,v89
v_and_b32 v125,v13,v89
v_and_b32 v126,v14,v89
v_and_b32 v127,v15,v89
s_nop 1
v_mfma_f32_16x16x32_bf16 v[116:119],v[124:127],v[112:115],v[116:119]
ds_read_b128 v[112:115],v18 offset:3072
s_waitcnt lgkmcnt(1)
v_and_b32 v124,v12,v90
v_and_b32 v125,v13,v90
v_and_b32 v126,v14,v90
v_and_b32 v127,v15,v90
s_nop 1
v_mfma_f32_16x16x32_bf16 v[116:119],v[124:127],v[108:111],v[116:119]
ds_read_b128 v[108:111],v18 offset:4096
s_waitcnt lgkmcnt(1)
v_and_b32 v124,v12,v91
v_and_b32 v125,v13,v91
v_and_b32 v126,v14,v91
v_and_b32 v127,v15,v91
s_nop 1
v_mfma_f32_16x16x32_bf16 v[116:119],v[124:127],v[112:115],v[116:119]
ds_read_b128 v[112:115],v18 offset:5120
s_waitcnt lgkmcnt(1)
v_and_b32 v124,v12,v92
v_and_b32 v125,v13,v92
v_and_b32 v126,v14,v92
v_and_b32 v127,v15,v92
s_nop 1
v_mfma_f32_16x16x32_bf16 v[116:119],v[124:127],v[108:111],v[116:119]
ds_read_b128 v[108:111],v18 offset:6144
s_waitcnt lgkmcnt(1)
v_and_b32 v124,v12,v93
v_and_b32 v125,v13,v93
v_and_b32 v126,v14,v93
v_and_b32 v127,v15,v93
s_nop 1
v_mfma_f32_16x16x32_bf16 v[116:119],v[124:127],v[112:115],v[116:119]
ds_read_b128 v[112:115],v18 offset:7168
s_waitcnt lgkmcnt(1)
v_and_b32 v124,v12,v94
v_and_b32 v125,v13,v94
v_and_b32 v126,v14,v94
v_and_b32 v127,v15,v94
s_nop 1
v_mfma_f32_16x16x32_bf16 v[116:119],v[124:127],v[108:111],v[116:119]
ds_read_b128 v[108:111],v18 offset:8192
s_waitcnt lgkmcnt(1)
v_and_b32 v124,v12,v95
v_and_b32 v125,v13,v95
v_and_b32 v126,v14,v95
v_and_b32 v127,v15,v95
s_nop 1
v_mfma_f32_16x16x32_bf16 v[116:119],v[124:127],v[112:115],v[116:119]
ds_read_b128 v[88:91],v8 offset:32
ds_read_b128 v[92:95],v8 offset:48
ds_read_b128 v[112:115],v18 offset:9216
s_waitcnt lgkmcnt(1)
v_and_b32 v124,v12,v88
v_and_b32 v125,v13,v88
v_and_b32 v126,v14,v88
v_and_b32 v127,v15,v88
s_nop 1
v_mfma_f32_16x16x32_bf16 v[116:119],v[124:127],v[108:111],v[116:119]
ds_read_b128 v[108:111],v18 offset:10240
s_waitcnt lgkmcnt(1)
v_and_b32 v124,v12,v89
v_and_b32 v125,v13,v89
v_and_b32 v126,v14,v89
v_and_b32 v127,v15,v89
s_nop 1
v_mfma_f32_16x16x32_bf16 v[116:119],v[124:127],v[112:115],v[116:119]
ds_read_b128 v[112:115],v18 offset:11264
s_waitcnt lgkmcnt(1)
v_and_b32 v124,v12,v90
v_and_b32 v125,v13,v90
v_and_b32 v126,v14,v90
v_and_b32 v127,v15,v90
s_nop 1
v_mfma_f32_16x16x32_bf16 v[116:119],v[124:127],v[108:111],v[116:119]
ds_read_b128 v[108:111],v18 offset:12288
s_waitcnt lgkmcnt(1)
v_and_b32 v124,v12,v91
v_and_b32 v125,v13,v91
v_and_b32 v126,v14,v91
v_and_b32 v127,v15,v91
s_nop 1
v_mfma_f32_16x16x32_bf16 v[116:119],v[124:127],v[112:115],v[116:119]
ds_read_b128 v[112:115],v18 offset:13312
s_waitcnt lgkmcnt(1)
v_and_b32 v124,v12,v92
v_and_b32 v125,v13,v92
v_and_b32 v126,v14,v92
v_and_b32 v127,v15,v92
s_nop 1
v_mfma_f32_16x16x32_bf16 v[116:119],v[124:127],v[108:111],v[116:119]
ds_read_b128 v[108:111],v18 offset:14336
s_waitcnt lgkmcnt(1)
v_and_b32 v124,v12,v93
v_and_b32 v125,v13,v93
v_and_b32 v126,v14,v93
v_and_b32 v127,v15,v93
s_nop 1
v_mfma_f32_16x16x32_bf16 v[116:119],v[124:127],v[112:115],v[116:119]
ds_read_b128 v[112:115],v18 offset:15360
s_waitcnt lgkmcnt(1)
v_and_b32 v124,v12,v94
v_and_b32 v125,v13,v94
v_and_b32 v126,v14,v94
v_and_b32 v127,v15,v94
s_nop 1
v_mfma_f32_16x16x32_bf16 v[116:119],v[124:127],v[108:111],v[116:119]
ds_read_b128 v[108:111],v18 offset:16384
s_waitcnt lgkmcnt(1)
v_and_b32 v124,v12,v95
v_and_b32 v125,v13,v95
v_and_b32 v126,v14,v95
v_and_b32 v127,v15,v95
s_nop 1
v_mfma_f32_16x16x32_bf16 v[116:119],v[124:127],v[112:115],v[116:119]
ds_read_b128 v[88:91],v8 offset:64
ds_read_b128 v[92:95],v8 offset:80
ds_read_b128 v[112:115],v18 offset:17408
s_waitcnt lgkmcnt(1)
v_and_b32 v124,v12,v88
v_and_b32 v125,v13,v88
v_and_b32 v126,v14,v88
v_and_b32 v127,v15,v88
s_nop 1
v_mfma_f32_16x16x32_bf16 v[116:119],v[124:127],v[108:111],v[116:119]
ds_read_b128 v[108:111],v18 offset:18432
s_waitcnt lgkmcnt(1)
v_and_b32 v124,v12,v89
v_and_b32 v125,v13,v89
v_and_b32 v126,v14,v89
v_and_b32 v127,v15,v89
s_nop 1
v_mfma_f32_16x16x32_bf16 v[116:119],v[124:127],v[112:115],v[116:119]
ds_read_b128 v[112:115],v18 offset:19456
s_waitcnt lgkmcnt(1)
v_and_b32 v124,v12,v90
v_and_b32 v125,v13,v90
v_and_b32 v126,v14,v90
v_and_b32 v127,v15,v90
s_nop 1
v_mfma_f32_16x16x32_bf16 v[116:119],v[124:127],v[108:111],v[116:119]
ds_read_b128 v[108:111],v18 offset:20480
s_waitcnt lgkmcnt(1)
v_and_b32 v124,v12,v91
v_and_b32 v125,v13,v91
v_and_b32 v126,v14,v91
v_and_b32 v127,v15,v91
s_nop 1
v_mfma_f32_16x16x32_bf16 v[116:119],v[124:127],v[112:115],v[116:119]
ds_read_b128 v[112:115],v18 offset:21504
s_waitcnt lgkmcnt(1)
v_and_b32 v124,v12,v92
v_and_b32 v125,v13,v92
v_and_b32 v126,v14,v92
v_and_b32 v127,v15,v92
s_nop 1
v_mfma_f32_16x16x32_bf16 v[116:119],v[124:127],v[108:111],v[116:119]
ds_read_b128 v[108:111],v18 offset:22528
s_waitcnt lgkmcnt(1)
v_and_b32 v124,v12,v93
v_and_b32 v125,v13,v93
v_and_b32 v126,v14,v93
v_and_b32 v127,v15,v93
s_nop 1
v_mfma_f32_16x16x32_bf16 v[116:119],v[124:127],v[112:115],v[116:119]
ds_read_b128 v[112:115],v18 offset:23552
s_waitcnt lgkmcnt(1)
v_and_b32 v124,v12,v94
v_and_b32 v125,v13,v94
v_and_b32 v126,v14,v94
v_and_b32 v127,v15,v94
s_nop 1
v_mfma_f32_16x16x32_bf16 v[116:119],v[124:127],v[108:111],v[116:119]
ds_read_b128 v[108:111],v18 offset:24576
s_waitcnt lgkmcnt(1)
v_and_b32 v124,v12,v95
v_and_b32 v125,v13,v95
v_and_b32 v126,v14,v95
v_and_b32 v127,v15,v95
s_nop 1
v_mfma_f32_16x16x32_bf16 v[116:119],v[124:127],v[112:115],v[116:119]
ds_read_b128 v[88:91],v8 offset:96
ds_read_b128 v[92:95],v8 offset:112
ds_read_b128 v[112:115],v18 offset:25600
s_waitcnt lgkmcnt(1)
v_and_b32 v124,v12,v88
v_and_b32 v125,v13,v88
v_and_b32 v126,v14,v88
v_and_b32 v127,v15,v88
s_nop 1
v_mfma_f32_16x16x32_bf16 v[116:119],v[124:127],v[108:111],v[116:119]
ds_read_b128 v[108:111],v18 offset:26624
s_waitcnt lgkmcnt(1)
v_and_b32 v124,v12,v89
v_and_b32 v125,v13,v89
v_and_b32 v126,v14,v89
v_and_b32 v127,v15,v89
s_nop 1
v_mfma_f32_16x16x32_bf16 v[116:119],v[124:127],v[112:115],v[116:119]
ds_read_b128 v[112:115],v18 offset:27648
s_waitcnt lgkmcnt(1)
v_and_b32 v124,v12,v90
v_and_b32 v125,v13,v90
v_and_b32 v126,v14,v90
v_and_b32 v127,v15,v90
s_nop 1
v_mfma_f32_16x16x32_bf16 v[116:119],v[124:127],v[108:111],v[116:119]
ds_read_b128 v[108:111],v18 offset:28672
s_waitcnt lgkmcnt(1)
v_and_b32 v124,v12,v91
v_and_b32 v125,v13,v91
v_and_b32 v126,v14,v91
v_and_b32 v127,v15,v91
s_nop 1
v_mfma_f32_16x16x32_bf16 v[116:119],v[124:127],v[112:115],v[116:119]
ds_read_b128 v[112:115],v18 offset:29696
s_waitcnt lgkmcnt(1)
v_and_b32 v124,v12,v92
v_and_b32 v125,v13,v92
v_and_b32 v126,v14,v92
v_and_b32 v127,v15,v92
s_nop 1
v_mfma_f32_16x16x32_bf16 v[116:119],v[124:127],v[108:111],v[116:119]
ds_read_b128 v[108:111],v18 offset:30720
s_waitcnt lgkmcnt(1)
v_and_b32 v124,v12,v93
v_and_b32 v125,v13,v93
v_and_b32 v126,v14,v93
v_and_b32 v127,v15,v93
s_nop 1
v_mfma_f32_16x16x32_bf16 v[116:119],v[124:127],v[112:115],v[116:119]
ds_read_b128 v[112:115],v18 offset:31744
s_waitcnt lgkmcnt(1)
v_and_b32 v124,v12,v94
v_and_b32 v125,v13,v94
v_and_b32 v126,v14,v94
v_and_b32 v127,v15,v94
s_nop 1
v_mfma_f32_16x16x32_bf16 v[116:119],v[124:127],v[108:111],v[116:119]
s_waitcnt lgkmcnt(0)
v_and_b32 v124,v12,v95
v_and_b32 v125,v13,v95
v_and_b32 v126,v14,v95
v_and_b32 v127,v15,v95
s_nop 1
v_mfma_f32_16x16x32_bf16 v[116:119],v[124:127],v[112:115],v[116:119]
v_lshlrev_b32 v8,5,v9
v_and_b32 v124,1,v10
v_lshl_add_u32 v8,v124,4,v8
v_lshrrev_b32 v124,1,v10
v_lshl_add_u32 v8,v124,11,v8
s_lshl_b32 s60,s46,9
s_add_u32 s60,s60,147456
v_add_u32 v8,s60,v8
ds_write_b128 v8,v[116:119]
v_lshlrev_b32 v8,2,v1
v_add_u32 v8,147456,v8
s_waitcnt lgkmcnt(0)
s_barrier
ds_read2st64_b32 v[88:89],v8 offset0:0 offset1:1
ds_read2st64_b32 v[90:91],v8 offset0:2 offset1:3
ds_read2st64_b32 v[92:93],v8 offset0:4 offset1:5
ds_read2st64_b32 v[94:95],v8 offset0:6 offset1:7
s_waitcnt lgkmcnt(0)
v_pk_add_f32 v[88:89],v[88:89],v[90:91]
v_pk_add_f32 v[92:93],v[92:93],v[94:95]
v_pk_add_f32 v[88:89],v[88:89],v[92:93]
v_cvt_pk_bf16_f32 v88,v88,v88
v_and_b32 v88,0xffff0000,v88
v_cvt_pk_bf16_f32 v89,v89,v89
v_and_b32 v89,0xffff0000,v89
v_mul_f32 v90,0xbfb8aa3b,v88
v_exp_f32 v90,v90
s_nop 0
v_add_f32 v90,1.0,v90
v_rcp_f32 v90,v90
s_nop 0
v_mul_f32 v88,v88,v90
v_cvt_pk_bf16_f32 v88,v88,v88
v_and_b32 v88,0xffff0000,v88
v_mul_f32 v88,v88,v89
v_cvt_pk_bf16_f32 v88,v88,v88
v_lshlrev_b32 v8,2,v1
v_add_u32 v8,s58,v8
ds_write_b32 v8,v88
v_lshlrev_b32 v8,6,v10
v_add_u32 v8,s58,v8
s_waitcnt lgkmcnt(0)
ds_read_b128 v[88:91],v8
ds_read_b128 v[92:95],v8 offset:16
ds_read_b128 v[108:111],v8 offset:32
ds_read_b128 v[112:115],v8 offset:48
s_waitcnt vmcnt(0) lgkmcnt(0)
v_and_b32 v124,v12,v88
v_and_b32 v125,v13,v88
v_and_b32 v126,v14,v88
v_and_b32 v127,v15,v88
s_nop 1
v_mfma_f32_16x16x32_bf16 v[116:119],v[124:127],v[24:27],0
v_and_b32 v124,v12,v89
v_and_b32 v125,v13,v89
v_and_b32 v126,v14,v89
v_and_b32 v127,v15,v89
s_nop 1
v_mfma_f32_16x16x32_bf16 v[116:119],v[124:127],v[28:31],v[116:119]
v_and_b32 v124,v12,v90
v_and_b32 v125,v13,v90
v_and_b32 v126,v14,v90
v_and_b32 v127,v15,v90
s_nop 1
v_mfma_f32_16x16x32_bf16 v[116:119],v[124:127],v[32:35],v[116:119]
v_and_b32 v124,v12,v91
v_and_b32 v125,v13,v91
v_and_b32 v126,v14,v91
v_and_b32 v127,v15,v91
s_nop 1
v_mfma_f32_16x16x32_bf16 v[116:119],v[124:127],v[36:39],v[116:119]
v_and_b32 v124,v12,v92
v_and_b32 v125,v13,v92
v_and_b32 v126,v14,v92
v_and_b32 v127,v15,v92
s_nop 1
v_mfma_f32_16x16x32_bf16 v[116:119],v[124:127],v[40:43],v[116:119]
v_and_b32 v124,v12,v93
v_and_b32 v125,v13,v93
v_and_b32 v126,v14,v93
v_and_b32 v127,v15,v93
s_nop 1
v_mfma_f32_16x16x32_bf16 v[116:119],v[124:127],v[44:47],v[116:119]
v_and_b32 v124,v12,v94
v_and_b32 v125,v13,v94
v_and_b32 v126,v14,v94
v_and_b32 v127,v15,v94
s_nop 1
v_mfma_f32_16x16x32_bf16 v[116:119],v[124:127],v[48:51],v[116:119]
v_and_b32 v124,v12,v95
v_and_b32 v125,v13,v95
v_and_b32 v126,v14,v95
v_and_b32 v127,v15,v95
s_nop 1
v_mfma_f32_16x16x32_bf16 v[116:119],v[124:127],v[52:55],v[116:119]
v_and_b32 v124,v12,v108
v_and_b32 v125,v13,v108
v_and_b32 v126,v14,v108
v_and_b32 v127,v15,v108
s_nop 1
v_mfma_f32_16x16x32_bf16 v[116:119],v[124:127],v[56:59],v[116:119]
v_and_b32 v124,v12,v109
v_and_b32 v125,v13,v109
v_and_b32 v126,v14,v109
v_and_b32 v127,v15,v109
s_nop 1
v_mfma_f32_16x16x32_bf16 v[116:119],v[124:127],v[60:63],v[116:119]
v_and_b32 v124,v12,v110
v_and_b32 v125,v13,v110
v_and_b32 v126,v14,v110
v_and_b32 v127,v15,v110
s_nop 1
v_mfma_f32_16x16x32_bf16 v[116:119],v[124:127],v[64:67],v[116:119]
v_and_b32 v124,v12,v111
v_and_b32 v125,v13,v111
v_and_b32 v126,v14,v111
v_and_b32 v127,v15,v111
s_nop 1
v_mfma_f32_16x16x32_bf16 v[116:119],v[124:127],v[68:71],v[116:119]
v_and_b32 v124,v12,v112
v_and_b32 v125,v13,v112
v_and_b32 v126,v14,v112
v_and_b32 v127,v15,v112
s_nop 1
v_mfma_f32_16x16x32_bf16 v[116:119],v[124:127],v[72:75],v[116:119]
v_and_b32 v124,v12,v113
v_and_b32 v125,v13,v113
v_and_b32 v126,v14,v113
v_and_b32 v127,v15,v113
s_nop 1
v_mfma_f32_16x16x32_bf16 v[116:119],v[124:127],v[76:79],v[116:119]
v_and_b32 v124,v12,v114
v_and_b32 v125,v13,v114
v_and_b32 v126,v14,v114
v_and_b32 v127,v15,v114
s_nop 1
v_mfma_f32_16x16x32_bf16 v[116:119],v[124:127],v[80:83],v[116:119]
v_and_b32 v124,v12,v115
v_and_b32 v125,v13,v115
v_and_b32 v126,v14,v115
v_and_b32 v127,v15,v115
s_nop 1
v_mfma_f32_16x16x32_bf16 v[116:119],v[124:127],v[84:87],v[116:119]
v_lshlrev_b32 v8,4,v9
v_and_b32 v124,1,v10
v_lshl_add_u32 v8,v124,3,v8
v_and_b32 v124,2,v10
v_lshl_add_u32 v8,v124,30,v8
s_lshl_b32 s65,s51,15
s_add_u32 s65,s65,92274688
s_lshl_b32 s59,s47,10
s_lshl_b32 s60,s46,8
s_add_u32 s59,s59,s60
s_add_u32 s59,s59,s65
v_cvt_pk_bf16_f32 v24,v116,v117
v_cvt_pk_bf16_f32 v25,v118,v119
buffer_store_dwordx2 v[24:25],v8,s[8:11],s59 offen sc1
s_lshl_b32 s59,s51,13
s_lshl2_add_u32 s59,s47,s59
s_add_u32 s59,s59,10486912
s_waitcnt vmcnt(0)
s_barrier
s_or_b32 s59,s59,s52
buffer_store_dword v17,off,s[8:11],s59 sc1
s_lshl_b32 s59,s51,13
s_add_u32 s59,s59,10486912
v_and_b32 v124,31,v1
v_lshlrev_b32 v124,2,v124
L_fw_335:
buffer_load_dword v125,v124,s[8:11],s59 offen sc1
s_sub_u32 s49,s49,1
s_cbranch_scc1 L_abort2
s_waitcnt vmcnt(0)
v_cmp_eq_u32 vcc,0,v125
s_cbranch_vccnz L_fw_335
s_add_u32 s63,s65,0
buffer_load_dwordx4 v[24:27],v22,s[8:11],s63 offen sc1
s_add_u32 s63,s65,4096
buffer_load_dwordx4 v[28:31],v22,s[8:11],s63 offen sc1
s_add_u32 s63,s65,8192
buffer_load_dwordx4 v[32:35],v22,s[8:11],s63 offen sc1
s_add_u32 s63,s65,12288
buffer_load_dwordx4 v[36:39],v22,s[8:11],s63 offen sc1
s_add_u32 s63,s65,16384
buffer_load_dwordx4 v[40:43],v22,s[8:11],s63 offen sc1
s_add_u32 s63,s65,20480
buffer_load_dwordx4 v[44:47],v22,s[8:11],s63 offen sc1
s_add_u32 s63,s65,24576
buffer_load_dwordx4 v[48:51],v22,s[8:11],s63 offen sc1
s_add_u32 s63,s65,28672
buffer_load_dwordx4 v[52:55],v22,s[8:11],s63 offen sc1
v_and_b32 v64,15,v1
v_and_b32 v65,1,v1
v_lshlrev_b32 v65,4,v65
v_mov_b32 v66,0x3f80
v_lshlrev_b32 v66,v65,v66
v_lshrrev_b32 v64,1,v64
v_cmp_eq_u32 vcc,0,v64
s_nop 1
v_cndmask_b32 v56,0,v66,vcc
v_cmp_eq_u32 vcc,1,v64
s_nop 1
v_cndmask_b32 v57,0,v66,vcc
v_cmp_eq_u32 vcc,2,v64
s_nop 1
v_cndmask_b32 v58,0,v66,vcc
v_cmp_eq_u32 vcc,3,v64
s_nop 1
v_cndmask_b32 v59,0,v66,vcc
s_waitcnt vmcnt(7)
s_nop 0
v_mfma_f32_16x16x32_bf16 v[60:63],v[56:59],v[24:27],0
s_waitcnt vmcnt(6)
v_mfma_f32_16x16x32_bf16 v[60:63],v[56:59],v[28:31],v[60:63]
s_waitcnt vmcnt(5)
v_mfma_f32_16x16x32_bf16 v[60:63],v[56:59],v[32:35],v[60:63]
s_waitcnt vmcnt(4)
v_mfma_f32_16x16x32_bf16 v[60:63],v[56:59],v[36:39],v[60:63]
s_waitcnt vmcnt(3)
v_mfma_f32_16x16x32_bf16 v[60:63],v[56:59],v[40:43],v[60:63]
s_waitcnt vmcnt(2)
v_mfma_f32_16x16x32_bf16 v[60:63],v[56:59],v[44:47],v[60:63]
s_waitcnt vmcnt(1)
v_mfma_f32_16x16x32_bf16 v[60:63],v[56:59],v[48:51],v[60:63]
s_waitcnt vmcnt(0)
v_mfma_f32_16x16x32_bf16 v[60:63],v[56:59],v[52:55],v[60:63]
s_nop 7
ds_write_b128 v21,v[60:63]
s_waitcnt lgkmcnt(0)
s_barrier
s_cmp_lg_u32 s46,0
s_cbranch_scc1 L_moed_334
v_lshlrev_b32 v56,5,v1
v_add_u32 v56,155648,v56
ds_read_b128 v[24:27],v56
ds_read_b128 v[28:31],v56 offset:16
s_and_b32 s59,s54,0xffff0000
s_xor_b32 s60,s59,0x80000000
s_xor_b32 s61,s59,0xffff0000
s_cmp_lt_i32 s59,0
s_cselect_b32 s59,s60,s61
v_mov_b32 v56,s59
v_mul_f32 v56,0xbfb8aa3b,v56
v_exp_f32 v56,v56
s_nop 0
v_add_f32 v56,1.0,v56
v_rcp_f32 v56,v56
s_nop 0
v_cvt_pk_bf16_f32 v56,v56,v56
v_and_b32 v56,0xffff0000,v56
v_lshlrev_b32 v48,16,v104
v_and_b32 v49,0xffff0000,v104
v_lshlrev_b32 v50,16,v105
v_and_b32 v51,0xffff0000,v105
v_lshlrev_b32 v52,16,v106
v_and_b32 v53,0xffff0000,v106
v_lshlrev_b32 v54,16,v107
v_and_b32 v55,0xffff0000,v107
s_waitcnt lgkmcnt(0)
v_cvt_pk_bf16_f32 v40,v24,v25
v_cvt_pk_bf16_f32 v41,v26,v27
v_cvt_pk_bf16_f32 v42,v28,v29
v_cvt_pk_bf16_f32 v43,v30,v31
v_lshlrev_b32 v24,16,v40
v_and_b32 v25,0xffff0000,v40
v_lshlrev_b32 v26,16,v41
v_and_b32 v27,0xffff0000,v41
v_lshlrev_b32 v28,16,v42
v_and_b32 v29,0xffff0000,v42
v_lshlrev_b32 v30,16,v43
v_and_b32 v31,0xffff0000,v43
v_mul_f32 v24,v24,v56
v_mul_f32 v25,v25,v56
v_mul_f32 v26,v26,v56
v_mul_f32 v27,v27,v56
v_mul_f32 v28,v28,v56
v_mul_f32 v29,v29,v56
v_mul_f32 v30,v30,v56
v_mul_f32 v31,v31,v56
v_cvt_pk_bf16_f32 v40,v24,v25
v_cvt_pk_bf16_f32 v41,v26,v27
v_cvt_pk_bf16_f32 v42,v28,v29
v_cvt_pk_bf16_f32 v43,v30,v31
v_lshlrev_b32 v24,16,v40
v_and_b32 v25,0xffff0000,v40
v_lshlrev_b32 v26,16,v41
v_and_b32 v27,0xffff0000,v41
v_lshlrev_b32 v28,16,v42
v_and_b32 v29,0xffff0000,v42
v_lshlrev_b32 v30,16,v43
v_and_b32 v31,0xffff0000,v43
v_add_f32 v24,v24,v48
v_add_f32 v25,v25,v49
v_add_f32 v26,v26,v50
v_add_f32 v27,v27,v51
v_add_f32 v28,v28,v52
v_add_f32 v29,v29,v53
v_add_f32 v30,v30,v54
v_add_f32 v31,v31,v55
v_cvt_pk_bf16_f32 v40,v24,v25
v_cvt_pk_bf16_f32 v41,v26,v27
v_cvt_pk_bf16_f32 v42,v28,v29
v_cvt_pk_bf16_f32 v43,v30,v31
v_lshlrev_b32 v24,16,v40
v_and_b32 v25,0xffff0000,v40
v_lshlrev_b32 v26,16,v41
v_and_b32 v27,0xffff0000,v41
v_lshlrev_b32 v28,16,v42
v_and_b32 v29,0xffff0000,v42
v_lshlrev_b32 v30,16,v43
v_and_b32 v31,0xffff0000,v43
v_add_f32 v96,v96,v24
v_add_f32 v97,v97,v25
v_add_f32 v98,v98,v26
v_add_f32 v99,v99,v27
v_add_f32 v100,v100,v28
v_add_f32 v101,v101,v29
v_add_f32 v102,v102,v30
v_add_f32 v103,v103,v31
v_cvt_pk_bf16_f32 v80,v96,v97
v_cvt_pk_bf16_f32 v81,v98,v99
v_cvt_pk_bf16_f32 v82,v100,v101
v_cvt_pk_bf16_f32 v83,v102,v103
v_lshlrev_b32 v96,16,v80
v_and_b32 v97,0xffff0000,v80
v_lshlrev_b32 v98,16,v81
v_and_b32 v99,0xffff0000,v81
v_lshlrev_b32 v100,16,v82
v_and_b32 v101,0xffff0000,v82
v_lshlrev_b32 v102,16,v83
v_and_b32 v103,0xffff0000,v83
v_readfirstlane_b32 s78,v96
s_nop 1
v_pk_add_f32 v[58:59],v[96:97],s[78:79] op_sel_hi:[1,0] neg_lo:[0,1] neg_hi:[0,1]
v_pk_add_f32 v[60:61],v[98:99],s[78:79] op_sel_hi:[1,0] neg_lo:[0,1] neg_hi:[0,1]
v_pk_add_f32 v[62:63],v[100:101],s[78:79] op_sel_hi:[1,0] neg_lo:[0,1] neg_hi:[0,1]
v_pk_add_f32 v[64:65],v[102:103],s[78:79] op_sel_hi:[1,0] neg_lo:[0,1] neg_hi:[0,1]
v_pk_add_f32 v[66:67],v[58:59],v[60:61]
v_pk_mul_f32 v[68:69],v[58:59],v[58:59]
v_pk_add_f32 v[70:71],v[62:63],v[64:65]
v_pk_fma_f32 v[68:69],v[60:61],v[60:61],v[68:69]
v_pk_add_f32 v[66:67],v[66:67],v[70:71]
v_pk_fma_f32 v[68:69],v[62:63],v[62:63],v[68:69]
v_add_f32 v66,v66,v67
v_pk_fma_f32 v[68:69],v[64:65],v[64:65],v[68:69]
v_add_f32 v68,v68,v69
s_nop 1
v_permlane32_swap_b32 v66,v68
v_add_f32 v66,v66,v68
s_nop 1
v_add_f32_dpp v66,v66,v66 row_ror:8 row_mask:0xf bank_mask:0xf
s_nop 1
v_add_f32_dpp v66,v66,v66 row_ror:4 row_mask:0xf bank_mask:0xf
s_nop 1
v_add_f32_dpp v66,v66,v66 row_ror:2 row_mask:0xf bank_mask:0xf
s_nop 1
v_add_f32_dpp v66,v66,v66 row_ror:1 row_mask:0xf bank_mask:0xf
v_mov_b32 v68,v66
s_nop 1
v_permlane16_swap_b32 v66,v68
v_add_f32 v66,v66,v68
v_mul_f32 v66,0x3b000000,v66
v_mov_b32 v68,v66
s_nop 1
v_permlane32_swap_b32 v66,v68
v_fma_f32 v68,-v66,v66,v68
v_add_f32 v66,s78,v66
v_max_f32 v68,0,v68
v_cvt_pk_bf16_f32 v68,v66,v68
v_lshlrev_b32 v66,16,v68
v_and_b32 v68,0xffff0000,v68
v_add_f32 v68,0x3727c5ac,v68
v_cvt_pk_bf16_f32 v68,v68,v68
v_and_b32 v68,0xffff0000,v68
v_sqrt_f32 v68,v68
v_pk_add_f32 v[58:59],v[96:97],v[66:67] op_sel_hi:[1,0] neg_lo:[0,1] neg_hi:[0,1]
v_pk_add_f32 v[60:61],v[98:99],v[66:67] op_sel_hi:[1,0] neg_lo:[0,1] neg_hi:[0,1]
v_pk_add_f32 v[62:63],v[100:101],v[66:67] op_sel_hi:[1,0] neg_lo:[0,1] neg_hi:[0,1]
v_pk_add_f32 v[64:65],v[102:103],v[66:67] op_sel_hi:[1,0] neg_lo:[0,1] neg_hi:[0,1]
v_cvt_pk_bf16_f32 v68,v68,v68
v_and_b32 v68,0xffff0000,v68
v_rcp_f32 v68,v68
v_cvt_pk_bf16_f32 v84,v58,v59
v_cvt_pk_bf16_f32 v85,v60,v61
v_cvt_pk_bf16_f32 v86,v62,v63
v_cvt_pk_bf16_f32 v87,v64,v65
v_lshlrev_b32 v58,16,v84
v_and_b32 v59,0xffff0000,v84
v_lshlrev_b32 v60,16,v85
v_and_b32 v61,0xffff0000,v85
v_lshlrev_b32 v62,16,v86
v_and_b32 v63,0xffff0000,v86
v_lshlrev_b32 v64,16,v87
v_and_b32 v65,0xffff0000,v87
v_pk_mul_f32 v[58:59],v[58:59],v[68:69] op_sel_hi:[1,0]
v_pk_mul_f32 v[60:61],v[60:61],v[68:69] op_sel_hi:[1,0]
v_pk_mul_f32 v[62:63],v[62:63],v[68:69] op_sel_hi:[1,0]
v_pk_mul_f32 v[64:65],v[64:65],v[68:69] op_sel_hi:[1,0]
v_cvt_pk_bf16_f32 v84,v58,v59
v_cvt_pk_bf16_f32 v85,v60,v61
v_cvt_pk_bf16_f32 v86,v62,v63
v_cvt_pk_bf16_f32 v87,v64,v65
s_lshl_b32 s58,s51,10
s_add_u32 s58,s58,11272192
s_add_u32 s59,s58,65536
s_cmp_eq_u32 s47,0
s_cselect_b32 s59,s59,0x80000000
s_add_u32 s57,s56,98566144
buffer_store_dwordx4 v[84:87],v0,s[8:11],s59 offen sc1
buffer_store_dwordx4 v[80:83],v0,s[8:11],s58 offen sc1
buffer_store_dwordx4 v[84:87],v0,s[8:11],s57 offen sc1
L_moed_334:
s_barrier
L_mo_321:
s_mov_b32 s77,-1
s_cmp_lt_u32 s31,64
s_cbranch_scc1 L_mo_317
s_cmp_eq_u32 s86,0
s_cbranch_scc1 L_mo_330
L_mo_323:
s_andn2_b32 s51,0x7ff,s54
s_lshr_b32 s51,s51,5
s_andn2_b32 s56,31,s54
v_lshrrev_b32 v2,10,v20
v_add_u32 v3,16,v2
v_add_u32 v8,96468992,v20
v_cmp_eq_u32 vcc,s56,v2
s_nop 1
v_cndmask_b32 v2,v20,v8,vcc
v_cmp_eq_u32 vcc,s56,v3
s_nop 1
v_cndmask_b32 v3,v20,v8,vcc
s_waitcnt vmcnt(0)
s_lshl_b32 s59,s51,13
s_add_u32 s59,s59,10487552
s_cmp_lg_u32 s46,0
s_cbranch_scc1 L_fd_339
v_and_b32 v124,31,v1
v_lshlrev_b32 v124,2,v124
s_branch L_ff_340
L_fw_338:
s_sleep 2
L_ff_340:
buffer_load_dword v125,v124,s[8:11],s59 offen sc1
s_sub_u32 s49,s49,1
s_cbranch_scc1 L_abort2
s_waitcnt vmcnt(0)
v_cmp_eq_u32 vcc,0,v125
s_cbranch_vccnz L_fw_338
L_fd_339:
s_barrier
s_or_b32 s72,s72,s52
buffer_store_dword v17,off,s[8:11],s72 sc1
s_lshl_b32 s66,s51,15
s_add_u32 s66,s66,2097152
s_add_u32 s67,s66,16384
s_add_u32 m0,s50,131072
s_nop 0
buffer_load_dwordx4 v2,s[8:11],s66 offen offset:0 sc1 lds
s_add_u32 m0,s50,135168
s_nop 0
buffer_load_dwordx4 v3,s[8:11],s67 offen offset:0 sc1 lds
s_add_u32 m0,s50,139008
s_nop 0
buffer_load_dwordx4 v2,s[8:11],s66 offen offset:256 sc1 lds
s_add_u32 m0,s50,143104
s_nop 0
buffer_load_dwordx4 v3,s[8:11],s67 offen offset:256 sc1 lds
s_add_u32 m0,s50,146944
s_nop 0
buffer_load_dwordx4 v2,s[8:11],s66 offen offset:512 sc1 lds
s_add_u32 m0,s50,151040
s_nop 0
buffer_load_dwordx4 v3,s[8:11],s67 offen offset:512 sc1 lds
s_lshl_b32 s58,s51,5
s_add_u32 s58,s58,s47
s_mul_i32 s58,s58,24576
s_add_u32 s58,s58,201326592
s_add_u32 s61,s58,s50
s_add_u32 s62,s61,4096
s_add_u32 s63,s61,16384
s_add_u32 s64,s61,20480
s_add_u32 s65,s61,s50
s_add_u32 s65,s65,8192
s_waitcnt vmcnt(4)
s_barrier
ds_read_b128 v[104:107],v4 offset:0
ds_read_b128 v[108:111],v4 offset:4096
ds_read_b128 v[112:115],v5 offset:0
ds_read_b128 v[116:119],v5 offset:4096
s_add_u32 m0,s50,154880
s_nop 0
buffer_load_dwordx4 v2,s[8:11],s66 offen offset:768 sc1 lds
s_add_u32 m0,s50,158976
s_nop 0
buffer_load_dwordx4 v3,s[8:11],s67 offen offset:768 sc1 lds
s_waitcnt lgkmcnt(2)
v_mfma_f32_16x16x32_bf16 v[24:27],a[128:131],v[104:107],0
ds_read_b128 v[120:123],v6 offset:0
v_mfma_f32_16x16x32_bf16 v[40:43],v[104:107],v[128:131],0
v_mfma_f32_16x16x32_bf16 v[28:31],a[128:131],v[108:111],0
ds_read_b128 v[124:127],v6 offset:4096
v_mfma_f32_16x16x32_bf16 v[44:47],v[108:111],v[128:131],0
v_mfma_f32_16x16x32_bf16 v[32:35],a[136:139],v[104:107],0
v_mfma_f32_16x16x32_bf16 v[48:51],v[104:107],v[136:139],0
v_mfma_f32_16x16x32_bf16 v[36:39],a[136:139],v[108:111],0
v_mfma_f32_16x16x32_bf16 v[52:55],v[108:111],v[136:139],0
s_waitcnt lgkmcnt(2)
v_mfma_f32_16x16x32_bf16 v[24:27],a[132:135],v[112:115],v[24:27]
ds_read_b128 v[104:107],v7 offset:0
v_mfma_f32_16x16x32_bf16 v[40:43],v[112:115],v[132:135],v[40:43]
v_mfma_f32_16x16x32_bf16 v[28:31],a[132:135],v[116:119],v[28:31]
ds_read_b128 v[108:111],v7 offset:4096
v_mfma_f32_16x16x32_bf16 v[44:47],v[116:119],v[132:135],v[44:47]
v_mfma_f32_16x16x32_bf16 v[32:35],a[140:143],v[112:115],v[32:35]
v_mfma_f32_16x16x32_bf16 v[48:51],v[112:115],v[140:143],v[48:51]
v_mfma_f32_16x16x32_bf16 v[36:39],a[140:143],v[116:119],v[36:39]
v_mfma_f32_16x16x32_bf16 v[52:55],v[116:119],v[140:143],v[52:55]
s_waitcnt vmcnt(4)
s_barrier
s_waitcnt lgkmcnt(2)
v_mfma_f32_16x16x32_bf16 v[24:27],a[144:147],v[120:123],v[24:27]
ds_read_b128 v[112:115],v4 offset:8192
v_mfma_f32_16x16x32_bf16 v[40:43],v[120:123],v[144:147],v[40:43]
v_mfma_f32_16x16x32_bf16 v[28:31],a[144:147],v[124:127],v[28:31]
ds_read_b128 v[116:119],v4 offset:12288
v_mfma_f32_16x16x32_bf16 v[44:47],v[124:127],v[144:147],v[44:47]
v_mfma_f32_16x16x32_bf16 v[32:35],a[152:155],v[120:123],v[32:35]
v_mfma_f32_16x16x32_bf16 v[48:51],v[120:123],v[152:155],v[48:51]
v_mfma_f32_16x16x32_bf16 v[36:39],a[152:155],v[124:127],v[36:39]
v_mfma_f32_16x16x32_bf16 v[52:55],v[124:127],v[152:155],v[52:55]
s_waitcnt lgkmcnt(2)
v_mfma_f32_16x16x32_bf16 v[24:27],a[148:151],v[104:107],v[24:27]
ds_read_b128 v[120:123],v5 offset:8192
v_mfma_f32_16x16x32_bf16 v[40:43],v[104:107],v[148:151],v[40:43]
v_mfma_f32_16x16x32_bf16 v[28:31],a[148:151],v[108:111],v[28:31]
ds_read_b128 v[124:127],v5 offset:12288
v_mfma_f32_16x16x32_bf16 v[44:47],v[108:111],v[148:151],v[44:47]
v_mfma_f32_16x16x32_bf16 v[32:35],a[156:159],v[104:107],v[32:35]
v_mfma_f32_16x16x32_bf16 v[48:51],v[104:107],v[156:159],v[48:51]
v_mfma_f32_16x16x32_bf16 v[36:39],a[156:159],v[108:111],v[36:39]
v_mfma_f32_16x16x32_bf16 v[52:55],v[108:111],v[156:159],v[52:55]
s_waitcnt lgkmcnt(2)
v_mfma_f32_16x16x32_bf16 v[24:27],a[160:163],v[112:115],v[24:27]
ds_read_b128 v[104:107],v6 offset:8192
v_mfma_f32_16x16x32_bf16 v[40:43],v[112:115],v[160:163],v[40:43]
v_mfma_f32_16x16x32_bf16 v[28:31],a[160:163],v[116:119],v[28:31]
ds_read_b128 v[108:111],v6 offset:12288
v_mfma_f32_16x16x32_bf16 v[44:47],v[116:119],v[160:163],v[44:47]
v_mfma_f32_16x16x32_bf16 v[32:35],a[168:171],v[112:115],v[32:35]
v_mfma_f32_16x16x32_bf16 v[48:51],v[112:115],v[168:171],v[48:51]
v_mfma_f32_16x16x32_bf16 v[36:39],a[168:171],v[116:119],v[36:39]
v_mfma_f32_16x16x32_bf16 v[52:55],v[116:119],v[168:171],v[52:55]
s_waitcnt lgkmcnt(2)
v_mfma_f32_16x16x32_bf16 v[24:27],a[164:167],v[120:123],v[24:27]
ds_read_b128 v[112:115],v7 offset:8192
v_mfma_f32_16x16x32_bf16 v[40:43],v[120:123],v[164:167],v[40:43]
v_mfma_f32_16x16x32_bf16 v[28:31],a[164:167],v[124:127],v[28:31]
ds_read_b128 v[116:119],v7 offset:12288
v_mfma_f32_16x16x32_bf16 v[44:47],v[124:127],v[164:167],v[44:47]
v_mfma_f32_16x16x32_bf16 v[32:35],a[172:175],v[120:123],v[32:35]
v_mfma_f32_16x16x32_bf16 v[48:51],v[120:123],v[172:175],v[48:51]
v_mfma_f32_16x16x32_bf16 v[36:39],a[172:175],v[124:127],v[36:39]
v_mfma_f32_16x16x32_bf16 v[52:55],v[124:127],v[172:175],v[52:55]
s_waitcnt vmcnt(2)
s_barrier
s_waitcnt lgkmcnt(2)
v_mfma_f32_16x16x32_bf16 v[24:27],a[176:179],v[104:107],v[24:27]
ds_read_b128 v[120:123],v4 offset:16384
v_mfma_f32_16x16x32_bf16 v[40:43],v[104:107],v[176:179],v[40:43]
v_mfma_f32_16x16x32_bf16 v[28:31],a[176:179],v[108:111],v[28:31]
ds_read_b128 v[124:127],v4 offset:20480
v_mfma_f32_16x16x32_bf16 v[44:47],v[108:111],v[176:179],v[44:47]
v_mfma_f32_16x16x32_bf16 v[32:35],a[184:187],v[104:107],v[32:35]
v_mfma_f32_16x16x32_bf16 v[48:51],v[104:107],v[184:187],v[48:51]
v_mfma_f32_16x16x32_bf16 v[36:39],a[184:187],v[108:111],v[36:39]
v_mfma_f32_16x16x32_bf16 v[52:55],v[108:111],v[184:187],v[52:55]
s_waitcnt lgkmcnt(2)
v_mfma_f32_16x16x32_bf16 v[24:27],a[180:183],v[112:115],v[24:27]
ds_read_b128 v[104:107],v5 offset:16384
v_mfma_f32_16x16x32_bf16 v[40:43],v[112:115],v[180:183],v[40:43]
v_mfma_f32_16x16x32_bf16 v[28:31],a[180:183],v[116:119],v[28:31]
ds_read_b128 v[108:111],v5 offset:20480
v_mfma_f32_16x16x32_bf16 v[44:47],v[116:119],v[180:183],v[44:47]
v_mfma_f32_16x16x32_bf16 v[32:35],a[188:191],v[112:115],v[32:35]
v_mfma_f32_16x16x32_bf16 v[48:51],v[112:115],v[188:191],v[48:51]
v_mfma_f32_16x16x32_bf16 v[36:39],a[188:191],v[116:119],v[36:39]
v_mfma_f32_16x16x32_bf16 v[52:55],v[116:119],v[188:191],v[52:55]
s_waitcnt lgkmcnt(2)
v_mfma_f32_16x16x32_bf16 v[24:27],a[192:195],v[120:123],v[24:27]
ds_read_b128 v[112:115],v6 offset:16384
v_mfma_f32_16x16x32_bf16 v[40:43],v[120:123],v[192:195],v[40:43]
v_mfma_f32_16x16x32_bf16 v[28:31],a[192:195],v[124:127],v[28:31]
ds_read_b128 v[116:119],v6 offset:20480
v_mfma_f32_16x16x32_bf16 v[44:47],v[124:127],v[192:195],v[44:47]
v_mfma_f32_16x16x32_bf16 v[32:35],a[200:203],v[120:123],v[32:35]
v_mfma_f32_16x16x32_bf16 v[48:51],v[120:123],v[200:203],v[48:51]
v_mfma_f32_16x16x32_bf16 v[36:39],a[200:203],v[124:127],v[36:39]
v_mfma_f32_16x16x32_bf16 v[52:55],v[124:127],v[200:203],v[52:55]
s_waitcnt lgkmcnt(2)
v_mfma_f32_16x16x32_bf16 v[24:27],a[196:199],v[104:107],v[24:27]
ds_read_b128 v[120:123],v7 offset:16384
v_mfma_f32_16x16x32_bf16 v[40:43],v[104:107],v[196:199],v[40:43]
v_mfma_f32_16x16x32_bf16 v[28:31],a[196:199],v[108:111],v[28:31]
ds_read_b128 v[124:127],v7 offset:20480
v_mfma_f32_16x16x32_bf16 v[44:47],v[108:111],v[196:199],v[44:47]
v_mfma_f32_16x16x32_bf16 v[32:35],a[204:207],v[104:107],v[32:35]
v_mfma_f32_16x16x32_bf16 v[48:51],v[104:107],v[204:207],v[48:51]
v_mfma_f32_16x16x32_bf16 v[36:39],a[204:207],v[108:111],v[36:39]
v_mfma_f32_16x16x32_bf16 v[52:55],v[108:111],v[204:207],v[52:55]
s_waitcnt vmcnt(0)
s_barrier
s_waitcnt lgkmcnt(2)
v_mfma_f32_16x16x32_bf16 v[24:27],a[208:211],v[112:115],v[24:27]
ds_read_b128 v[104:107],v4 offset:24576
v_mfma_f32_16x16x32_bf16 v[40:43],v[112:115],v[208:211],v[40:43]
v_mfma_f32_16x16x32_bf16 v[28:31],a[208:211],v[116:119],v[28:31]
ds_read_b128 v[108:111],v4 offset:28672
v_mfma_f32_16x16x32_bf16 v[44:47],v[116:119],v[208:211],v[44:47]
v_mfma_f32_16x16x32_bf16 v[32:35],a[216:219],v[112:115],v[32:35]
v_mfma_f32_16x16x32_bf16 v[48:51],v[112:115],v[216:219],v[48:51]
v_mfma_f32_16x16x32_bf16 v[36:39],a[216:219],v[116:119],v[36:39]
v_mfma_f32_16x16x32_bf16 v[52:55],v[116:119],v[216:219],v[52:55]
s_waitcnt lgkmcnt(2)
v_mfma_f32_16x16x32_bf16 v[24:27],a[212:215],v[120:123],v[24:27]
ds_read_b128 v[112:115],v5 offset:24576
v_mfma_f32_16x16x32_bf16 v[40:43],v[120:123],v[212:215],v[40:43]
v_mfma_f32_16x16x32_bf16 v[28:31],a[212:215],v[124:127],v[28:31]
ds_read_b128 v[116:119],v5 offset:28672
v_mfma_f32_16x16x32_bf16 v[44:47],v[124:127],v[212:215],v[44:47]
v_mfma_f32_16x16x32_bf16 v[32:35],a[220:223],v[120:123],v[32:35]
v_mfma_f32_16x16x32_bf16 v[48:51],v[120:123],v[220:223],v[48:51]
v_mfma_f32_16x16x32_bf16 v[36:39],a[220:223],v[124:127],v[36:39]
v_mfma_f32_16x16x32_bf16 v[52:55],v[124:127],v[220:223],v[52:55]
s_waitcnt lgkmcnt(2)
v_mfma_f32_16x16x32_bf16 v[24:27],a[224:227],v[104:107],v[24:27]
ds_read_b128 v[120:123],v6 offset:24576
v_mfma_f32_16x16x32_bf16 v[40:43],v[104:107],v[224:227],v[40:43]
v_mfma_f32_16x16x32_bf16 v[28:31],a[224:227],v[108:111],v[28:31]
ds_read_b128 v[124:127],v6 offset:28672
v_mfma_f32_16x16x32_bf16 v[44:47],v[108:111],v[224:227],v[44:47]
v_mfma_f32_16x16x32_bf16 v[32:35],a[232:235],v[104:107],v[32:35]
v_mfma_f32_16x16x32_bf16 v[48:51],v[104:107],v[232:235],v[48:51]
v_mfma_f32_16x16x32_bf16 v[36:39],a[232:235],v[108:111],v[36:39]
v_mfma_f32_16x16x32_bf16 v[52:55],v[108:111],v[232:235],v[52:55]
s_waitcnt lgkmcnt(2)
v_mfma_f32_16x16x32_bf16 v[24:27],a[228:231],v[112:115],v[24:27]
ds_read_b128 v[104:107],v7 offset:24576
v_mfma_f32_16x16x32_bf16 v[40:43],v[112:115],v[228:231],v[40:43]
v_mfma_f32_16x16x32_bf16 v[28:31],a[228:231],v[116:119],v[28:31]
ds_read_b128 v[108:111],v7 offset:28672
v_mfma_f32_16x16x32_bf16 v[44:47],v[116:119],v[228:231],v[44:47]
v_mfma_f32_16x16x32_bf16 v[32:35],a[236:239],v[112:115],v[32:35]
v_mfma_f32_16x16x32_bf16 v[48:51],v[112:115],v[236:239],v[48:51]
v_mfma_f32_16x16x32_bf16 v[36:39],a[236:239],v[116:119],v[36:39]
v_mfma_f32_16x16x32_bf16 v[52:55],v[116:119],v[236:239],v[52:55]
s_waitcnt lgkmcnt(2)
v_mfma_f32_16x16x32_bf16 v[24:27],a[240:243],v[120:123],v[24:27]
ds_read_b128 v[112:115],v4 offset:0
v_mfma_f32_16x16x32_bf16 v[40:43],v[120:123],v[240:243],v[40:43]
v_mfma_f32_16x16x32_bf16 v[28:31],a[240:243],v[124:127],v[28:31]
ds_read_b128 v[116:119],v4 offset:4096
v_mfma_f32_16x16x32_bf16 v[44:47],v[124:127],v[240:243],v[44:47]
v_mfma_f32_16x16x32_bf16 v[32:35],a[248:251],v[120:123],v[32:35]
v_mfma_f32_16x16x32_bf16 v[48:51],v[120:123],v[248:251],v[48:51]
v_mfma_f32_16x16x32_bf16 v[36:39],a[248:251],v[124:127],v[36:39]
v_mfma_f32_16x16x32_bf16 v[52:55],v[124:127],v[248:251],v[52:55]
s_waitcnt lgkmcnt(2)
v_mfma_f32_16x16x32_bf16 v[24:27],a[244:247],v[104:107],v[24:27]
ds_read_b128 v[120:123],v5 offset:0
v_mfma_f32_16x16x32_bf16 v[40:43],v[104:107],v[244:247],v[40:43]
v_mfma_f32_16x16x32_bf16 v[28:31],a[244:247],v[108:111],v[28:31]
ds_read_b128 v[124:127],v5 offset:4096
v_mfma_f32_16x16x32_bf16 v[44:47],v[108:111],v[244:247],v[44:47]
v_mfma_f32_16x16x32_bf16 v[32:35],a[252:255],v[104:107],v[32:35]
v_mfma_f32_16x16x32_bf16 v[48:51],v[104:107],v[252:255],v[48:51]
v_mfma_f32_16x16x32_bf16 v[36:39],a[252:255],v[108:111],v[36:39]
v_mfma_f32_16x16x32_bf16 v[52:55],v[108:111],v[252:255],v[52:55]
s_waitcnt lgkmcnt(2)
v_mfma_f32_16x16x32_bf16 v[88:91],a[0:3],v[112:115],0
ds_read_b128 v[104:107],v6 offset:0
v_mfma_f32_16x16x32_bf16 v[92:95],a[0:3],v[116:119],0
v_mfma_f32_16x16x32_bf16 v[96:99],a[8:11],v[112:115],0
ds_read_b128 v[108:111],v6 offset:4096
v_mfma_f32_16x16x32_bf16 v[100:103],a[8:11],v[116:119],0
s_waitcnt lgkmcnt(2)
v_mfma_f32_16x16x32_bf16 v[88:91],a[4:7],v[120:123],v[88:91]
ds_read_b128 v[112:115],v7 offset:0
v_mfma_f32_16x16x32_bf16 v[92:95],a[4:7],v[124:127],v[92:95]
v_cvt_pk_bf16_f32 v56,v24,v32
v_cvt_pk_bf16_f32 v57,v25,v33
v_mfma_f32_16x16x32_bf16 v[96:99],a[12:15],v[120:123],v[96:99]
ds_read_b128 v[116:119],v7 offset:4096
v_mfma_f32_16x16x32_bf16 v[100:103],a[12:15],v[124:127],v[100:103]
v_cvt_pk_bf16_f32 v58,v26,v34
v_cvt_pk_bf16_f32 v59,v27,v35
s_waitcnt lgkmcnt(2)
v_mfma_f32_16x16x32_bf16 v[88:91],a[16:19],v[104:107],v[88:91]
ds_read_b128 v[120:123],v4 offset:8192
v_mfma_f32_16x16x32_bf16 v[92:95],a[16:19],v[108:111],v[92:95]
buffer_store_dwordx4 v[56:59],v0,s[8:11],s61 offen sc1
v_cvt_pk_bf16_f32 v60,v28,v36
v_mfma_f32_16x16x32_bf16 v[96:99],a[24:27],v[104:107],v[96:99]
ds_read_b128 v[124:127],v4 offset:12288
v_mfma_f32_16x16x32_bf16 v[100:103],a[24:27],v[108:111],v[100:103]
v_cvt_pk_bf16_f32 v61,v29,v37
v_cvt_pk_bf16_f32 v62,v30,v38
s_waitcnt lgkmcnt(2)
v_mfma_f32_16x16x32_bf16 v[88:91],a[20:23],v[112:115],v[88:91]
ds_read_b128 v[104:107],v5 offset:8192
v_mfma_f32_16x16x32_bf16 v[92:95],a[20:23],v[116:119],v[92:95]
v_cvt_pk_bf16_f32 v63,v31,v39
buffer_store_dwordx4 v[60:63],v0,s[8:11],s62 offen sc1
v_mfma_f32_16x16x32_bf16 v[96:99],a[28:31],v[112:115],v[96:99]
ds_read_b128 v[108:111],v5 offset:12288
v_mfma_f32_16x16x32_bf16 v[100:103],a[28:31],v[116:119],v[100:103]
v_cvt_pk_bf16_f32 v64,v40,v41
v_cvt_pk_bf16_f32 v65,v42,v43
s_waitcnt lgkmcnt(2)
v_mfma_f32_16x16x32_bf16 v[88:91],a[32:35],v[120:123],v[88:91]
ds_read_b128 v[112:115],v6 offset:8192
v_mfma_f32_16x16x32_bf16 v[92:95],a[32:35],v[124:127],v[92:95]
v_cvt_pk_bf16_f32 v66,v44,v45
v_cvt_pk_bf16_f32 v67,v46,v47
v_mfma_f32_16x16x32_bf16 v[96:99],a[40:43],v[120:123],v[96:99]
ds_read_b128 v[116:119],v6 offset:12288
v_mfma_f32_16x16x32_bf16 v[100:103],a[40:43],v[124:127],v[100:103]
buffer_store_dwordx4 v[64:67],v0,s[8:11],s65 offen offset:0 sc1
v_cvt_pk_bf16_f32 v68,v48,v49
s_waitcnt lgkmcnt(2)
v_mfma_f32_16x16x32_bf16 v[88:91],a[36:39],v[104:107],v[88:91]
ds_read_b128 v[120:123],v7 offset:8192
v_mfma_f32_16x16x32_bf16 v[92:95],a[36:39],v[108:111],v[92:95]
v_cvt_pk_bf16_f32 v69,v50,v51
v_cvt_pk_bf16_f32 v70,v52,v53
v_mfma_f32_16x16x32_bf16 v[96:99],a[44:47],v[104:107],v[96:99]
ds_read_b128 v[124:127],v7 offset:12288
v_mfma_f32_16x16x32_bf16 v[100:103],a[44:47],v[108:111],v[100:103]
v_cvt_pk_bf16_f32 v71,v54,v55
buffer_store_dwordx4 v[68:71],v0,s[8:11],s65 offen offset:1024 sc1
s_waitcnt lgkmcnt(2)
v_mfma_f32_16x16x32_bf16 v[88:91],a[48:51],v[112:115],v[88:91]
ds_read_b128 v[104:107],v4 offset:16384
v_mfma_f32_16x16x32_bf16 v[92:95],a[48:51],v[116:119],v[92:95]
v_mfma_f32_16x16x32_bf16 v[96:99],a[56:59],v[112:115],v[96:99]
ds_read_b128 v[108:111],v4 offset:20480
v_mfma_f32_16x16x32_bf16 v[100:103],a[56:59],v[116:119],v[100:103]
s_waitcnt lgkmcnt(2)
v_mfma_f32_16x16x32_bf16 v[88:91],a[52:55],v[120:123],v[88:91]
ds_read_b128 v[112:115],v5 offset:16384
v_mfma_f32_16x16x32_bf16 v[92:95],a[52:55],v[124:127],v[92:95]
v_mfma_f32_16x16x32_bf16 v[96:99],a[60:63],v[120:123],v[96:99]
ds_read_b128 v[116:119],v5 offset:20480
v_mfma_f32_16x16x32_bf16 v[100:103],a[60:63],v[124:127],v[100:103]
s_waitcnt lgkmcnt(2)
v_mfma_f32_16x16x32_bf16 v[88:91],a[64:67],v[104:107],v[88:91]
ds_read_b128 v[120:123],v6 offset:16384
v_mfma_f32_16x16x32_bf16 v[92:95],a[64:67],v[108:111],v[92:95]
v_mfma_f32_16x16x32_bf16 v[96:99],a[72:75],v[104:107],v[96:99]
ds_read_b128 v[124:127],v6 offset:20480
v_mfma_f32_16x16x32_bf16 v[100:103],a[72:75],v[108:111],v[100:103]
s_waitcnt lgkmcnt(2)
v_mfma_f32_16x16x32_bf16 v[88:91],a[68:71],v[112:115],v[88:91]
ds_read_b128 v[104:107],v7 offset:16384
v_mfma_f32_16x16x32_bf16 v[92:95],a[68:71],v[116:119],v[92:95]
v_mfma_f32_16x16x32_bf16 v[96:99],a[76:79],v[112:115],v[96:99]
ds_read_b128 v[108:111],v7 offset:20480
v_mfma_f32_16x16x32_bf16 v[100:103],a[76:79],v[116:119],v[100:103]
s_waitcnt lgkmcnt(2)
v_mfma_f32_16x16x32_bf16 v[88:91],a[80:83],v[120:123],v[88:91]
ds_read_b128 v[112:115],v4 offset:24576
v_mfma_f32_16x16x32_bf16 v[92:95],a[80:83],v[124:127],v[92:95]
v_mfma_f32_16x16x32_bf16 v[96:99],a[88:91],v[120:123],v[96:99]
ds_read_b128 v[116:119],v4 offset:28672
v_mfma_f32_16x16x32_bf16 v[100:103],a[88:91],v[124:127],v[100:103]
s_waitcnt lgkmcnt(2)
v_mfma_f32_16x16x32_bf16 v[88:91],a[84:87],v[104:107],v[88:91]
ds_read_b128 v[120:123],v5 offset:24576
v_mfma_f32_16x16x32_bf16 v[92:95],a[84:87],v[108:111],v[92:95]
v_mfma_f32_16x16x32_bf16 v[96:99],a[92:95],v[104:107],v[96:99]
ds_read_b128 v[124:127],v5 offset:28672
v_mfma_f32_16x16x32_bf16 v[100:103],a[92:95],v[108:111],v[100:103]
s_waitcnt lgkmcnt(2)
v_mfma_f32_16x16x32_bf16 v[88:91],a[96:99],v[112:115],v[88:91]
ds_read_b128 v[104:107],v6 offset:24576
v_mfma_f32_16x16x32_bf16 v[92:95],a[96:99],v[116:119],v[92:95]
v_mfma_f32_16x16x32_bf16 v[96:99],a[104:107],v[112:115],v[96:99]
ds_read_b128 v[108:111],v6 offset:28672
v_mfma_f32_16x16x32_bf16 v[100:103],a[104:107],v[116:119],v[100:103]
s_waitcnt lgkmcnt(2)
v_mfma_f32_16x16x32_bf16 v[88:91],a[100:103],v[120:123],v[88:91]
ds_read_b128 v[112:115],v7 offset:24576
v_mfma_f32_16x16x32_bf16 v[92:95],a[100:103],v[124:127],v[92:95]
v_mfma_f32_16x16x32_bf16 v[96:99],a[108:111],v[120:123],v[96:99]
ds_read_b128 v[116:119],v7 offset:28672
v_mfma_f32_16x16x32_bf16 v[100:103],a[108:111],v[124:127],v[100:103]
s_waitcnt lgkmcnt(2)
v_mfma_f32_16x16x32_bf16 v[88:91],a[112:115],v[104:107],v[88:91]
v_mfma_f32_16x16x32_bf16 v[92:95],a[112:115],v[108:111],v[92:95]
v_mfma_f32_16x16x32_bf16 v[96:99],a[120:123],v[104:107],v[96:99]
v_mfma_f32_16x16x32_bf16 v[100:103],a[120:123],v[108:111],v[100:103]
s_waitcnt lgkmcnt(0)
v_mfma_f32_16x16x32_bf16 v[88:91],a[116:119],v[112:115],v[88:91]
v_mfma_f32_16x16x32_bf16 v[92:95],a[116:119],v[116:119],v[92:95]
v_mfma_f32_16x16x32_bf16 v[96:99],a[124:127],v[112:115],v[96:99]
v_mfma_f32_16x16x32_bf16 v[100:103],a[124:127],v[116:119],v[100:103]
s_nop 3
v_cvt_pk_bf16_f32 v104,v88,v96
v_cvt_pk_bf16_f32 v105,v89,v97
v_cvt_pk_bf16_f32 v106,v90,v98
v_cvt_pk_bf16_f32 v107,v91,v99
v_cvt_pk_bf16_f32 v108,v92,v100
v_cvt_pk_bf16_f32 v109,v93,v101
v_cvt_pk_bf16_f32 v110,v94,v102
v_cvt_pk_bf16_f32 v111,v95,v103
buffer_store_dwordx4 v[104:107],v0,s[8:11],s63 offen sc1
buffer_store_dwordx4 v[108:111],v0,s[8:11],s64 offen sc1
s_waitcnt vmcnt(6)
s_barrier
s_add_u32 m0,s50,131072
s_nop 0
buffer_load_dwordx4 v20,s[8:11],s70 offen offset:0 sc1 lds
s_add_u32 m0,s50,135168
s_nop 0
buffer_load_dwordx4 v20,s[8:11],s71 offen offset:0 sc1 lds
s_add_u32 m0,s50,139008
s_nop 0
buffer_load_dwordx4 v20,s[8:11],s70 offen offset:256 sc1 lds
s_add_u32 m0,s50,143104
s_nop 0
buffer_load_dwordx4 v20,s[8:11],s71 offen offset:256 sc1 lds
s_add_u32 m0,s50,146944
s_nop 0
buffer_load_dwordx4 v20,s[8:11],s70 offen offset:512 sc1 lds
s_add_u32 m0,s50,151040
s_nop 0
buffer_load_dwordx4 v20,s[8:11],s71 offen offset:512 sc1 lds
s_lshl_b32 s59,s51,13
s_lshl2_add_u32 s59,s47,s59
s_add_u32 s59,s59,10487680
s_waitcnt vmcnt(0)
s_barrier
s_or_b32 s59,s59,s52
buffer_store_dword v17,off,s[8:11],s59 sc1
s_mov_b32 s72,0x80000000
s_mov_b32 s86,0
s_mov_b32 s19,1
s_mov_b32 s18,0
s_cmp_lt_u32 s31,64
s_cbranch_scc1 L_mo_317
L_mo_330:
s_mov_b32 s51,64
s_and_b32 s61,s54,0x7ff
s_sub_u32 s61,2047,s61
s_lshr_b32 s61,s61,5
s_cmp_lg_u32 s46,0
s_cbranch_scc1 L_mw_341
s_mov_b32 s59,11018240
v_lshlrev_b32 v2,2,v1
L_fp_342:
s_sleep 2
buffer_load_dword v3,v2,s[8:11],s59 offen sc1
s_sub_u32 s49,s49,1
s_cbranch_scc1 L_abort2
s_waitcnt vmcnt(0)
v_cmp_eq_u32 vcc,0,v3
s_cbranch_vccnz L_fp_342
v_cmp_le_u32 vcc,s61,v1
s_nop 1
v_cndmask_b32 v2,1,2,vcc
v_cmp_ne_u32 s[84:85],v2,v3
s_lshl_b32 s56,s47,1
s_lshr_b64 s[20:21],s[84:85],s56
v_lshrrev_b32 v2,5,v1
v_lshrrev_b32 v3,v2,s20
v_and_b32 v3,1,v3
v_mul_u32_u24 v3,768,v3
v_lshlrev_b32 v2,13,v2
v_sub_u32 v2,v2,v3
v_and_b32 v3,31,v1
v_lshl_add_u32 v2,v3,2,v2
v_add_u32 v2,1536,v2
s_lshl_b32 s59,s47,14
s_add_u32 s59,s59,10485760
L_fp_343:
s_sleep 1
buffer_load_dword v3,v2,s[8:11],s59 offen sc1
s_sub_u32 s49,s49,1
s_cbranch_scc1 L_abort2
s_waitcnt vmcnt(0)
v_cmp_eq_u32 vcc,0,v3
s_cbranch_vccnz L_fp_343
v_max_u32_dpp v3,v3,v3 row_ror:8 row_mask:0xf bank_mask:0xf
s_nop 1
v_max_u32_dpp v3,v3,v3 row_ror:4 row_mask:0xf bank_mask:0xf
s_nop 1
v_max_u32_dpp v3,v3,v3 row_ror:2 row_mask:0xf bank_mask:0xf
s_nop 1
v_max_u32_dpp v3,v3,v3 row_ror:1 row_mask:0xf bank_mask:0xf
v_mov_b32 v2,v3
s_nop 1
v_permlane16_swap_b32 v3,v2
v_max_u32 v3,v3,v2
v_mov_b32 v2,v3
s_nop 1
v_permlane32_swap_b32 v3,v2
v_max_u32 v3,v3,v2
s_lshl_b32 s59,s51,13
s_lshl2_add_u32 s59,s47,s59
s_add_u32 s59,s59,10487424
buffer_store_dword v3,off,s[8:11],s59 sc1
L_mw_341:
s_barrier
s_lshl_b32 s59,s51,13
s_add_u32 s59,s59,10487424
v_and_b32 v124,31,v1
v_lshlrev_b32 v124,2,v124
s_branch L_ff_346
L_fw_344:
s_sleep 1
L_ff_346:
buffer_load_dword v125,v124,s[8:11],s59 offen sc1
s_sub_u32 s49,s49,1
s_cbranch_scc1 L_abort2
s_waitcnt vmcnt(0)
v_cmp_eq_u32 vcc,0,v125
s_cbranch_vccnz L_fw_344
v_max_u32_dpp v125,v125,v125 row_ror:8 row_mask:0xf bank_mask:0xf
s_nop 1
v_max_u32_dpp v125,v125,v125 row_ror:4 row_mask:0xf bank_mask:0xf
s_nop 1
v_max_u32_dpp v125,v125,v125 row_ror:2 row_mask:0xf bank_mask:0xf
s_nop 1
v_max_u32_dpp v125,v125,v125 row_ror:1 row_mask:0xf bank_mask:0xf
v_mov_b32 v124,v125
s_nop 1
v_permlane16_swap_b32 v125,v124
v_max_u32 v125,v125,v124
v_mov_b32 v124,v125
s_nop 1
v_permlane32_swap_b32 v125,v124
v_max_u32 v125,v125,v124
s_nop 0
v_readfirstlane_b32 s55,v125
s_and_b32 s64,s55,0x7ff
s_sub_u32 s64,2047,s64
s_lshl_b32 s56,s64,10
s_add_u32 s58,s56,6291456
buffer_load_dwordx4 v[88:91],v0,s[8:11],s58 offen sc1
s_mov_b32 s4,s38
s_mov_b32 s5,s39
s_mov_b32 s6,1835008
s_mov_b32 s7,0x20000
v_and_b32 v9,15,v1
v_lshrrev_b32 v10,4,v1
v_lshlrev_b32 v8,14,v10
v_lshl_add_u32 v8,v9,4,v8
s_lshl_b32 s59,s47,16
s_lshl_b32 s60,s46,8
s_add_u32 s59,s59,s60
buffer_load_dwordx4 v[24:27],v8,s[4:7],s59 offen offset:0
buffer_load_dwordx4 v[28:31],v8,s[4:7],s59 offen offset:1024
buffer_load_dwordx4 v[32:35],v8,s[4:7],s59 offen offset:2048
buffer_load_dwordx4 v[36:39],v8,s[4:7],s59 offen offset:3072
s_add_u32 s59,s59,4096
buffer_load_dwordx4 v[40:43],v8,s[4:7],s59 offen offset:0
buffer_load_dwordx4 v[44:47],v8,s[4:7],s59 offen offset:1024
buffer_load_dwordx4 v[48:51],v8,s[4:7],s59 offen offset:2048
buffer_load_dwordx4 v[52:55],v8,s[4:7],s59 offen offset:3072
s_add_u32 s59,s59,4096
buffer_load_dwordx4 v[56:59],v8,s[4:7],s59 offen offset:0
buffer_load_dwordx4 v[60:63],v8,s[4:7],s59 offen offset:1024
buffer_load_dwordx4 v[64:67],v8,s[4:7],s59 offen offset:2048
buffer_load_dwordx4 v[68:71],v8,s[4:7],s59 offen offset:3072
s_add_u32 s59,s59,4096
buffer_load_dwordx4 v[72:75],v8,s[4:7],s59 offen offset:0
buffer_load_dwordx4 v[76:79],v8,s[4:7],s59 offen offset:1024
buffer_load_dwordx4 v[80:83],v8,s[4:7],s59 offen offset:2048
buffer_load_dwordx4 v[84:87],v8,s[4:7],s59 offen offset:3072
v_and_b32 v124,1,v1
v_lshlrev_b32 v124,4,v124
v_mov_b32 v125,0xffff
v_lshlrev_b32 v125,v124,v125
v_lshrrev_b32 v124,1,v9
v_cmp_eq_u32 vcc,0,v124
s_nop 1
v_cndmask_b32 v12,0,v125,vcc
v_cmp_eq_u32 vcc,1,v124
s_nop 1
v_cndmask_b32 v13,0,v125,vcc
v_cmp_eq_u32 vcc,2,v124
s_nop 1
v_cndmask_b32 v14,0,v125,vcc
v_cmp_eq_u32 vcc,3,v124
s_nop 1
v_cndmask_b32 v15,0,v125,vcc
s_waitcnt vmcnt(16)
v_lshlrev_b32 v96,16,v88
v_and_b32 v97,0xffff0000,v88
v_lshlrev_b32 v98,16,v89
v_and_b32 v99,0xffff0000,v89
v_lshlrev_b32 v100,16,v90
v_and_b32 v101,0xffff0000,v90
v_lshlrev_b32 v102,16,v91
v_and_b32 v103,0xffff0000,v91
v_readfirstlane_b32 s78,v96
s_nop 1
v_pk_add_f32 v[108:109],v[96:97],s[78:79] op_sel_hi:[1,0] neg_lo:[0,1] neg_hi:[0,1]
v_pk_add_f32 v[110:111],v[98:99],s[78:79] op_sel_hi:[1,0] neg_lo:[0,1] neg_hi:[0,1]
v_pk_add_f32 v[112:113],v[100:101],s[78:79] op_sel_hi:[1,0] neg_lo:[0,1] neg_hi:[0,1]
v_pk_add_f32 v[114:115],v[102:103],s[78:79] op_sel_hi:[1,0] neg_lo:[0,1] neg_hi:[0,1]
v_pk_add_f32 v[116:117],v[108:109],v[110:111]
v_pk_mul_f32 v[118:119],v[108:109],v[108:109]
v_pk_add_f32 v[120:121],v[112:113],v[114:115]
v_pk_fma_f32 v[118:119],v[110:111],v[110:111],v[118:119]
v_pk_add_f32 v[116:117],v[116:117],v[120:121]
v_pk_fma_f32 v[118:119],v[112:113],v[112:113],v[118:119]
v_add_f32 v116,v116,v117
v_pk_fma_f32 v[118:119],v[114:115],v[114:115],v[118:119]
v_add_f32 v118,v118,v119
s_nop 1
v_permlane32_swap_b32 v116,v118
v_add_f32 v116,v116,v118
s_nop 1
v_add_f32_dpp v116,v116,v116 row_ror:8 row_mask:0xf bank_mask:0xf
s_nop 1
v_add_f32_dpp v116,v116,v116 row_ror:4 row_mask:0xf bank_mask:0xf
s_nop 1
v_add_f32_dpp v116,v116,v116 row_ror:2 row_mask:0xf bank_mask:0xf
s_nop 1
v_add_f32_dpp v116,v116,v116 row_ror:1 row_mask:0xf bank_mask:0xf
v_mov_b32 v118,v116
s_nop 1
v_permlane16_swap_b32 v116,v118
v_add_f32 v116,v116,v118
v_mul_f32 v116,0x3b000000,v116
v_mov_b32 v118,v116
s_nop 1
v_permlane32_swap_b32 v116,v118
v_fma_f32 v118,-v116,v116,v118
v_add_f32 v116,s78,v116
v_max_f32 v118,0,v118
v_cvt_pk_bf16_f32 v118,v116,v118
v_lshlrev_b32 v116,16,v118
v_and_b32 v118,0xffff0000,v118
v_add_f32 v118,0x3727c5ac,v118
v_cvt_pk_bf16_f32 v118,v118,v118
v_and_b32 v118,0xffff0000,v118
v_sqrt_f32 v118,v118
v_pk_add_f32 v[108:109],v[96:97],v[116:117] op_sel_hi:[1,0] neg_lo:[0,1] neg_hi:[0,1]
v_pk_add_f32 v[110:111],v[98:99],v[116:117] op_sel_hi:[1,0] neg_lo:[0,1] neg_hi:[0,1]
v_pk_add_f32 v[112:113],v[100:101],v[116:117] op_sel_hi:[1,0] neg_lo:[0,1] neg_hi:[0,1]
v_pk_add_f32 v[114:115],v[102:103],v[116:117] op_sel_hi:[1,0] neg_lo:[0,1] neg_hi:[0,1]
v_cvt_pk_bf16_f32 v118,v118,v118
v_and_b32 v118,0xffff0000,v118
v_rcp_f32 v118,v118
v_cvt_pk_bf16_f32 v104,v108,v109
v_cvt_pk_bf16_f32 v105,v110,v111
v_cvt_pk_bf16_f32 v106,v112,v113
v_cvt_pk_bf16_f32 v107,v114,v115
v_lshlrev_b32 v108,16,v104
v_and_b32 v109,0xffff0000,v104
v_lshlrev_b32 v110,16,v105
v_and_b32 v111,0xffff0000,v105
v_lshlrev_b32 v112,16,v106
v_and_b32 v113,0xffff0000,v106
v_lshlrev_b32 v114,16,v107
v_and_b32 v115,0xffff0000,v107
v_pk_mul_f32 v[108:109],v[108:109],v[118:119] op_sel_hi:[1,0]
v_pk_mul_f32 v[110:111],v[110:111],v[118:119] op_sel_hi:[1,0]
v_pk_mul_f32 v[112:113],v[112:113],v[118:119] op_sel_hi:[1,0]
v_pk_mul_f32 v[114:115],v[114:115],v[118:119] op_sel_hi:[1,0]
v_cvt_pk_bf16_f32 v104,v108,v109
v_cvt_pk_bf16_f32 v105,v110,v111
v_cvt_pk_bf16_f32 v106,v112,v113
v_cvt_pk_bf16_f32 v107,v114,v115
s_mov_b32 s58,0x01000100
s_mov_b32 s59,0x03020302
v_perm_b32 v88,v104,v104,s58
v_perm_b32 v89,v104,v104,s59
v_perm_b32 v90,v105,v105,s58
v_perm_b32 v91,v105,v105,s59
v_perm_b32 v92,v106,v106,s58
v_perm_b32 v93,v106,v106,s59
v_perm_b32 v94,v107,v107,s58
v_perm_b32 v95,v107,v107,s59
v_lshlrev_b32 v8,5,v1
s_lshl_b32 s58,s46,11
s_add_u32 s58,s58,139264
v_add_u32 v8,s58,v8
ds_write_b128 v8,v[88:91]
ds_write_b128 v8,v[92:95] offset:16
s_lshl_b32 s59,s46,9
s_add_u32 s59,s58,s59
v_lshlrev_b32 v8,7,v10
v_add_u32 v8,s59,v8
s_waitcnt lgkmcnt(0)
ds_read_b128 v[108:111],v18 offset:0
ds_read_b128 v[88:91],v8 offset:0
ds_read_b128 v[92:95],v8 offset:16
ds_read_b128 v[112:115],v18 offset:1024
s_waitcnt lgkmcnt(1)
v_and_b32 v124,v12,v88
v_and_b32 v125,v13,v88
v_and_b32 v126,v14,v88
v_and_b32 v127,v15,v88
s_nop 1
v_mfma_f32_16x16x32_bf16 v[116:119],v[124:127],v[108:111],0
ds_read_b128 v[108:111],v18 offset:2048
s_waitcnt lgkmcnt(1)
v_and_b32 v124,v12,v89
v_and_b32 v125,v13,v89
v_and_b32 v126,v14,v89
v_and_b32 v127,v15,v89
s_nop 1
v_mfma_f32_16x16x32_bf16 v[116:119],v[124:127],v[112:115],v[116:119]
ds_read_b128 v[112:115],v18 offset:3072
s_waitcnt lgkmcnt(1)
v_and_b32 v124,v12,v90
v_and_b32 v125,v13,v90
v_and_b32 v126,v14,v90
v_and_b32 v127,v15,v90
s_nop 1
v_mfma_f32_16x16x32_bf16 v[116:119],v[124:127],v[108:111],v[116:119]
ds_read_b128 v[108:111],v18 offset:4096
s_waitcnt lgkmcnt(1)
v_and_b32 v124,v12,v91
v_and_b32 v125,v13,v91
v_and_b32 v126,v14,v91
v_and_b32 v127,v15,v91
s_nop 1
v_mfma_f32_16x16x32_bf16 v[116:119],v[124:127],v[112:115],v[116:119]
ds_read_b128 v[112:115],v18 offset:5120
s_waitcnt lgkmcnt(1)
v_and_b32 v124,v12,v92
v_and_b32 v125,v13,v92
v_and_b32 v126,v14,v92
v_and_b32 v127,v15,v92
s_nop 1
v_mfma_f32_16x16x32_bf16 v[116:119],v[124:127],v[108:111],v[116:119]
ds_read_b128 v[108:111],v18 offset:6144
s_waitcnt lgkmcnt(1)
v_and_b32 v124,v12,v93
v_and_b32 v125,v13,v93
v_and_b32 v126,v14,v93
v_and_b32 v127,v15,v93
s_nop 1
v_mfma_f32_16x16x32_bf16 v[116:119],v[124:127],v[112:115],v[116:119]
ds_read_b128 v[112:115],v18 offset:7168
s_waitcnt lgkmcnt(1)
v_and_b32 v124,v12,v94
v_and_b32 v125,v13,v94
v_and_b32 v126,v14,v94
v_and_b32 v127,v15,v94
s_nop 1
v_mfma_f32_16x16x32_bf16 v[116:119],v[124:127],v[108:111],v[116:119]
ds_read_b128 v[108:111],v18 offset:8192
s_waitcnt lgkmcnt(1)
v_and_b32 v124,v12,v95
v_and_b32 v125,v13,v95
v_and_b32 v126,v14,v95
v_and_b32 v127,v15,v95
s_nop 1
v_mfma_f32_16x16x32_bf16 v[116:119],v[124:127],v[112:115],v[116:119]
ds_read_b128 v[88:91],v8 offset:32
ds_read_b128 v[92:95],v8 offset:48
ds_read_b128 v[112:115],v18 offset:9216
s_waitcnt lgkmcnt(1)
v_and_b32 v124,v12,v88
v_and_b32 v125,v13,v88
v_and_b32 v126,v14,v88
v_and_b32 v127,v15,v88
s_nop 1
v_mfma_f32_16x16x32_bf16 v[116:119],v[124:127],v[108:111],v[116:119]
ds_read_b128 v[108:111],v18 offset:10240
s_waitcnt lgkmcnt(1)
v_and_b32 v124,v12,v89
v_and_b32 v125,v13,v89
v_and_b32 v126,v14,v89
v_and_b32 v127,v15,v89
s_nop 1
v_mfma_f32_16x16x32_bf16 v[116:119],v[124:127],v[112:115],v[116:119]
ds_read_b128 v[112:115],v18 offset:11264
s_waitcnt lgkmcnt(1)
v_and_b32 v124,v12,v90
v_and_b32 v125,v13,v90
v_and_b32 v126,v14,v90
v_and_b32 v127,v15,v90
s_nop 1
v_mfma_f32_16x16x32_bf16 v[116:119],v[124:127],v[108:111],v[116:119]
ds_read_b128 v[108:111],v18 offset:12288
s_waitcnt lgkmcnt(1)
v_and_b32 v124,v12,v91
v_and_b32 v125,v13,v91
v_and_b32 v126,v14,v91
v_and_b32 v127,v15,v91
s_nop 1
v_mfma_f32_16x16x32_bf16 v[116:119],v[124:127],v[112:115],v[116:119]
ds_read_b128 v[112:115],v18 offset:13312
s_waitcnt lgkmcnt(1)
v_and_b32 v124,v12,v92
v_and_b32 v125,v13,v92
v_and_b32 v126,v14,v92
v_and_b32 v127,v15,v92
s_nop 1
v_mfma_f32_16x16x32_bf16 v[116:119],v[124:127],v[108:111],v[116:119]
ds_read_b128 v[108:111],v18 offset:14336
s_waitcnt lgkmcnt(1)
v_and_b32 v124,v12,v93
v_and_b32 v125,v13,v93
v_and_b32 v126,v14,v93
v_and_b32 v127,v15,v93
s_nop 1
v_mfma_f32_16x16x32_bf16 v[116:119],v[124:127],v[112:115],v[116:119]
ds_read_b128 v[112:115],v18 offset:15360
s_waitcnt lgkmcnt(1)
v_and_b32 v124,v12,v94
v_and_b32 v125,v13,v94
v_and_b32 v126,v14,v94
v_and_b32 v127,v15,v94
s_nop 1
v_mfma_f32_16x16x32_bf16 v[116:119],v[124:127],v[108:111],v[116:119]
ds_read_b128 v[108:111],v18 offset:16384
s_waitcnt lgkmcnt(1)
v_and_b32 v124,v12,v95
v_and_b32 v125,v13,v95
v_and_b32 v126,v14,v95
v_and_b32 v127,v15,v95
s_nop 1
v_mfma_f32_16x16x32_bf16 v[116:119],v[124:127],v[112:115],v[116:119]
ds_read_b128 v[88:91],v8 offset:64
ds_read_b128 v[92:95],v8 offset:80
ds_read_b128 v[112:115],v18 offset:17408
s_waitcnt lgkmcnt(1)
v_and_b32 v124,v12,v88
v_and_b32 v125,v13,v88
v_and_b32 v126,v14,v88
v_and_b32 v127,v15,v88
s_nop 1
v_mfma_f32_16x16x32_bf16 v[116:119],v[124:127],v[108:111],v[116:119]
ds_read_b128 v[108:111],v18 offset:18432
s_waitcnt lgkmcnt(1)
v_and_b32 v124,v12,v89
v_and_b32 v125,v13,v89
v_and_b32 v126,v14,v89
v_and_b32 v127,v15,v89
s_nop 1
v_mfma_f32_16x16x32_bf16 v[116:119],v[124:127],v[112:115],v[116:119]
ds_read_b128 v[112:115],v18 offset:19456
s_waitcnt lgkmcnt(1)
v_and_b32 v124,v12,v90
v_and_b32 v125,v13,v90
v_and_b32 v126,v14,v90
v_and_b32 v127,v15,v90
s_nop 1
v_mfma_f32_16x16x32_bf16 v[116:119],v[124:127],v[108:111],v[116:119]
ds_read_b128 v[108:111],v18 offset:20480
s_waitcnt lgkmcnt(1)
v_and_b32 v124,v12,v91
v_and_b32 v125,v13,v91
v_and_b32 v126,v14,v91
v_and_b32 v127,v15,v91
s_nop 1
v_mfma_f32_16x16x32_bf16 v[116:119],v[124:127],v[112:115],v[116:119]
ds_read_b128 v[112:115],v18 offset:21504
s_waitcnt lgkmcnt(1)
v_and_b32 v124,v12,v92
v_and_b32 v125,v13,v92
v_and_b32 v126,v14,v92
v_and_b32 v127,v15,v92
s_nop 1
v_mfma_f32_16x16x32_bf16 v[116:119],v[124:127],v[108:111],v[116:119]
ds_read_b128 v[108:111],v18 offset:22528
s_waitcnt lgkmcnt(1)
v_and_b32 v124,v12,v93
v_and_b32 v125,v13,v93
v_and_b32 v126,v14,v93
v_and_b32 v127,v15,v93
s_nop 1
v_mfma_f32_16x16x32_bf16 v[116:119],v[124:127],v[112:115],v[116:119]
ds_read_b128 v[112:115],v18 offset:23552
s_waitcnt lgkmcnt(1)
v_and_b32 v124,v12,v94
v_and_b32 v125,v13,v94
v_and_b32 v126,v14,v94
v_and_b32 v127,v15,v94
s_nop 1
v_mfma_f32_16x16x32_bf16 v[116:119],v[124:127],v[108:111],v[116:119]
ds_read_b128 v[108:111],v18 offset:24576
s_waitcnt lgkmcnt(1)
v_and_b32 v124,v12,v95
v_and_b32 v125,v13,v95
v_and_b32 v126,v14,v95
v_and_b32 v127,v15,v95
s_nop 1
v_mfma_f32_16x16x32_bf16 v[116:119],v[124:127],v[112:115],v[116:119]
ds_read_b128 v[88:91],v8 offset:96
ds_read_b128 v[92:95],v8 offset:112
ds_read_b128 v[112:115],v18 offset:25600
s_waitcnt lgkmcnt(1)
v_and_b32 v124,v12,v88
v_and_b32 v125,v13,v88
v_and_b32 v126,v14,v88
v_and_b32 v127,v15,v88
s_nop 1
v_mfma_f32_16x16x32_bf16 v[116:119],v[124:127],v[108:111],v[116:119]
ds_read_b128 v[108:111],v18 offset:26624
s_waitcnt lgkmcnt(1)
v_and_b32 v124,v12,v89
v_and_b32 v125,v13,v89
v_and_b32 v126,v14,v89
v_and_b32 v127,v15,v89
s_nop 1
v_mfma_f32_16x16x32_bf16 v[116:119],v[124:127],v[112:115],v[116:119]
ds_read_b128 v[112:115],v18 offset:27648
s_waitcnt lgkmcnt(1)
v_and_b32 v124,v12,v90
v_and_b32 v125,v13,v90
v_and_b32 v126,v14,v90
v_and_b32 v127,v15,v90
s_nop 1
v_mfma_f32_16x16x32_bf16 v[116:119],v[124:127],v[108:111],v[116:119]
ds_read_b128 v[108:111],v18 offset:28672
s_waitcnt lgkmcnt(1)
v_and_b32 v124,v12,v91
v_and_b32 v125,v13,v91
v_and_b32 v126,v14,v91
v_and_b32 v127,v15,v91
s_nop 1
v_mfma_f32_16x16x32_bf16 v[116:119],v[124:127],v[112:115],v[116:119]
ds_read_b128 v[112:115],v18 offset:29696
s_waitcnt lgkmcnt(1)
v_and_b32 v124,v12,v92
v_and_b32 v125,v13,v92
v_and_b32 v126,v14,v92
v_and_b32 v127,v15,v92
s_nop 1
v_mfma_f32_16x16x32_bf16 v[116:119],v[124:127],v[108:111],v[116:119]
ds_read_b128 v[108:111],v18 offset:30720
s_waitcnt lgkmcnt(1)
v_and_b32 v124,v12,v93
v_and_b32 v125,v13,v93
v_and_b32 v126,v14,v93
v_and_b32 v127,v15,v93
s_nop 1
v_mfma_f32_16x16x32_bf16 v[116:119],v[124:127],v[112:115],v[116:119]
ds_read_b128 v[112:115],v18 offset:31744
s_waitcnt lgkmcnt(1)
v_and_b32 v124,v12,v94
v_and_b32 v125,v13,v94
v_and_b32 v126,v14,v94
v_and_b32 v127,v15,v94
s_nop 1
v_mfma_f32_16x16x32_bf16 v[116:119],v[124:127],v[108:111],v[116:119]
s_waitcnt lgkmcnt(0)
v_and_b32 v124,v12,v95
v_and_b32 v125,v13,v95
v_and_b32 v126,v14,v95
v_and_b32 v127,v15,v95
s_nop 1
v_mfma_f32_16x16x32_bf16 v[116:119],v[124:127],v[112:115],v[116:119]
v_lshlrev_b32 v8,5,v9
v_and_b32 v124,1,v10
v_lshl_add_u32 v8,v124,4,v8
v_lshrrev_b32 v124,1,v10
v_lshl_add_u32 v8,v124,11,v8
s_lshl_b32 s60,s46,9
s_add_u32 s60,s60,147456
v_add_u32 v8,s60,v8
ds_write_b128 v8,v[116:119]
v_lshlrev_b32 v8,2,v1
v_add_u32 v8,147456,v8
s_waitcnt lgkmcnt(0)
s_barrier
ds_read2st64_b32 v[88:89],v8 offset0:0 offset1:1
ds_read2st64_b32 v[90:91],v8 offset0:2 offset1:3
ds_read2st64_b32 v[92:93],v8 offset0:4 offset1:5
ds_read2st64_b32 v[94:95],v8 offset0:6 offset1:7
s_waitcnt lgkmcnt(0)
v_pk_add_f32 v[88:89],v[88:89],v[90:91]
v_pk_add_f32 v[92:93],v[92:93],v[94:95]
v_pk_add_f32 v[88:89],v[88:89],v[92:93]
v_cvt_pk_bf16_f32 v88,v88,v88
v_and_b32 v88,0xffff0000,v88
v_cvt_pk_bf16_f32 v89,v89,v89
v_and_b32 v89,0xffff0000,v89
v_mul_f32 v90,0xbfb8aa3b,v88
v_exp_f32 v90,v90
s_nop 0
v_add_f32 v90,1.0,v90
v_rcp_f32 v90,v90
s_nop 0
v_mul_f32 v88,v88,v90
v_cvt_pk_bf16_f32 v88,v88,v88
v_and_b32 v88,0xffff0000,v88
v_mul_f32 v88,v88,v89
v_cvt_pk_bf16_f32 v88,v88,v88
v_lshlrev_b32 v8,2,v1
v_add_u32 v8,s58,v8
ds_write_b32 v8,v88
v_lshlrev_b32 v8,6,v10
v_add_u32 v8,s58,v8
s_waitcnt lgkmcnt(0)
ds_read_b128 v[88:91],v8
ds_read_b128 v[92:95],v8 offset:16
ds_read_b128 v[108:111],v8 offset:32
ds_read_b128 v[112:115],v8 offset:48
s_waitcnt vmcnt(0) lgkmcnt(0)
v_and_b32 v124,v12,v88
v_and_b32 v125,v13,v88
v_and_b32 v126,v14,v88
v_and_b32 v127,v15,v88
s_nop 1
v_mfma_f32_16x16x32_bf16 v[116:119],v[124:127],v[24:27],0
v_and_b32 v124,v12,v89
v_and_b32 v125,v13,v89
v_and_b32 v126,v14,v89
v_and_b32 v127,v15,v89
s_nop 1
v_mfma_f32_16x16x32_bf16 v[116:119],v[124:127],v[28:31],v[116:119]
v_and_b32 v124,v12,v90
v_and_b32 v125,v13,v90
v_and_b32 v126,v14,v90
v_and_b32 v127,v15,v90
s_nop 1
v_mfma_f32_16x16x32_bf16 v[116:119],v[124:127],v[32:35],v[116:119]
v_and_b32 v124,v12,v91
v_and_b32 v125,v13,v91
v_and_b32 v126,v14,v91
v_and_b32 v127,v15,v91
s_nop 1
v_mfma_f32_16x16x32_bf16 v[116:119],v[124:127],v[36:39],v[116:119]
v_and_b32 v124,v12,v92
v_and_b32 v125,v13,v92
v_and_b32 v126,v14,v92
v_and_b32 v127,v15,v92
s_nop 1
v_mfma_f32_16x16x32_bf16 v[116:119],v[124:127],v[40:43],v[116:119]
v_and_b32 v124,v12,v93
v_and_b32 v125,v13,v93
v_and_b32 v126,v14,v93
v_and_b32 v127,v15,v93
s_nop 1
v_mfma_f32_16x16x32_bf16 v[116:119],v[124:127],v[44:47],v[116:119]
v_and_b32 v124,v12,v94
v_and_b32 v125,v13,v94
v_and_b32 v126,v14,v94
v_and_b32 v127,v15,v94
s_nop 1
v_mfma_f32_16x16x32_bf16 v[116:119],v[124:127],v[48:51],v[116:119]
v_and_b32 v124,v12,v95
v_and_b32 v125,v13,v95
v_and_b32 v126,v14,v95
v_and_b32 v127,v15,v95
s_nop 1
v_mfma_f32_16x16x32_bf16 v[116:119],v[124:127],v[52:55],v[116:119]
v_and_b32 v124,v12,v108
v_and_b32 v125,v13,v108
v_and_b32 v126,v14,v108
v_and_b32 v127,v15,v108
s_nop 1
v_mfma_f32_16x16x32_bf16 v[116:119],v[124:127],v[56:59],v[116:119]
v_and_b32 v124,v12,v109
v_and_b32 v125,v13,v109
v_and_b32 v126,v14,v109
v_and_b32 v127,v15,v109
s_nop 1
v_mfma_f32_16x16x32_bf16 v[116:119],v[124:127],v[60:63],v[116:119]
v_and_b32 v124,v12,v110
v_and_b32 v125,v13,v110
v_and_b32 v126,v14,v110
v_and_b32 v127,v15,v110
s_nop 1
v_mfma_f32_16x16x32_bf16 v[116:119],v[124:127],v[64:67],v[116:119]
v_and_b32 v124,v12,v111
v_and_b32 v125,v13,v111
v_and_b32 v126,v14,v111
v_and_b32 v127,v15,v111
s_nop 1
v_mfma_f32_16x16x32_bf16 v[116:119],v[124:127],v[68:71],v[116:119]
v_and_b32 v124,v12,v112
v_and_b32 v125,v13,v112
v_and_b32 v126,v14,v112
v_and_b32 v127,v15,v112
s_nop 1
v_mfma_f32_16x16x32_bf16 v[116:119],v[124:127],v[72:75],v[116:119]
v_and_b32 v124,v12,v113
v_and_b32 v125,v13,v113
v_and_b32 v126,v14,v113
v_and_b32 v127,v15,v113
s_nop 1
v_mfma_f32_16x16x32_bf16 v[116:119],v[124:127],v[76:79],v[116:119]
v_and_b32 v124,v12,v114
v_and_b32 v125,v13,v114
v_and_b32 v126,v14,v114
v_and_b32 v127,v15,v114
s_nop 1
v_mfma_f32_16x16x32_bf16 v[116:119],v[124:127],v[80:83],v[116:119]
v_and_b32 v124,v12,v115
v_and_b32 v125,v13,v115
v_and_b32 v126,v14,v115
v_and_b32 v127,v15,v115
s_nop 1
v_mfma_f32_16x16x32_bf16 v[116:119],v[124:127],v[84:87],v[116:119]
v_lshlrev_b32 v8,4,v9
v_and_b32 v124,1,v10
v_lshl_add_u32 v8,v124,3,v8
v_and_b32 v124,2,v10
v_lshl_add_u32 v8,v124,30,v8
s_lshl_b32 s65,s51,15
s_add_u32 s65,s65,92274688
s_lshl_b32 s59,s47,10
s_lshl_b32 s60,s46,8
s_add_u32 s59,s59,s60
s_add_u32 s59,s59,s65
v_cvt_pk_bf16_f32 v24,v116,v117
v_cvt_pk_bf16_f32 v25,v118,v119
buffer_store_dwordx2 v[24:25],v8,s[8:11],s59 offen sc1
s_lshl_b32 s59,s51,13
s_lshl2_add_u32 s59,s47,s59
s_add_u32 s59,s59,10486912
s_waitcnt vmcnt(0)
s_barrier
s_or_b32 s59,s59,s52
buffer_store_dword v17,off,s[8:11],s59 sc1
s_cmp_lg_u32 s47,0
s_cbranch_scc1 L_moed_347
s_lshl_b32 s59,s51,13
s_add_u32 s59,s59,10486912
v_and_b32 v124,31,v1
v_lshlrev_b32 v124,2,v124
L_fw_348:
buffer_load_dword v125,v124,s[8:11],s59 offen sc1
s_sub_u32 s49,s49,1
s_cbranch_scc1 L_abort2
s_waitcnt vmcnt(0)
v_cmp_eq_u32 vcc,0,v125
s_cbranch_vccnz L_fw_348
s_add_u32 s63,s65,0
buffer_load_dwordx4 v[24:27],v22,s[8:11],s63 offen sc1
s_add_u32 s63,s65,4096
buffer_load_dwordx4 v[28:31],v22,s[8:11],s63 offen sc1
s_add_u32 s63,s65,8192
buffer_load_dwordx4 v[32:35],v22,s[8:11],s63 offen sc1
s_add_u32 s63,s65,12288
buffer_load_dwordx4 v[36:39],v22,s[8:11],s63 offen sc1
s_add_u32 s63,s65,16384
buffer_load_dwordx4 v[40:43],v22,s[8:11],s63 offen sc1
s_add_u32 s63,s65,20480
buffer_load_dwordx4 v[44:47],v22,s[8:11],s63 offen sc1
s_add_u32 s63,s65,24576
buffer_load_dwordx4 v[48:51],v22,s[8:11],s63 offen sc1
s_add_u32 s63,s65,28672
buffer_load_dwordx4 v[52:55],v22,s[8:11],s63 offen sc1
v_and_b32 v64,15,v1
v_and_b32 v65,1,v1
v_lshlrev_b32 v65,4,v65
v_mov_b32 v66,0x3f80
v_lshlrev_b32 v66,v65,v66
v_lshrrev_b32 v64,1,v64
v_cmp_eq_u32 vcc,0,v64
s_nop 1
v_cndmask_b32 v56,0,v66,vcc
v_cmp_eq_u32 vcc,1,v64
s_nop 1
v_cndmask_b32 v57,0,v66,vcc
v_cmp_eq_u32 vcc,2,v64
s_nop 1
v_cndmask_b32 v58,0,v66,vcc
v_cmp_eq_u32 vcc,3,v64
s_nop 1
v_cndmask_b32 v59,0,v66,vcc
s_waitcnt vmcnt(7)
s_nop 0
v_mfma_f32_16x16x32_bf16 v[60:63],v[56:59],v[24:27],0
s_waitcnt vmcnt(6)
v_mfma_f32_16x16x32_bf16 v[60:63],v[56:59],v[28:31],v[60:63]
s_waitcnt vmcnt(5)
v_mfma_f32_16x16x32_bf16 v[60:63],v[56:59],v[32:35],v[60:63]
s_waitcnt vmcnt(4)
v_mfma_f32_16x16x32_bf16 v[60:63],v[56:59],v[36:39],v[60:63]
s_waitcnt vmcnt(3)
v_mfma_f32_16x16x32_bf16 v[60:63],v[56:59],v[40:43],v[60:63]
s_waitcnt vmcnt(2)
v_mfma_f32_16x16x32_bf16 v[60:63],v[56:59],v[44:47],v[60:63]
s_waitcnt vmcnt(1)
v_mfma_f32_16x16x32_bf16 v[60:63],v[56:59],v[48:51],v[60:63]
s_waitcnt vmcnt(0)
v_mfma_f32_16x16x32_bf16 v[60:63],v[56:59],v[52:55],v[60:63]
s_nop 7
ds_write_b128 v21,v[60:63]
s_waitcnt lgkmcnt(0)
s_barrier
s_cmp_lg_u32 s46,0
s_cbranch_scc1 L_moed_347
v_lshlrev_b32 v56,5,v1
v_add_u32 v56,155648,v56
ds_read_b128 v[24:27],v56
ds_read_b128 v[28:31],v56 offset:16
s_and_b32 s59,s55,0xffff0000
s_xor_b32 s60,s59,0x80000000
s_xor_b32 s61,s59,0xffff0000
s_cmp_lt_i32 s59,0
s_cselect_b32 s59,s60,s61
v_mov_b32 v56,s59
v_mul_f32 v56,0xbfb8aa3b,v56
v_exp_f32 v56,v56
s_nop 0
v_add_f32 v56,1.0,v56
v_rcp_f32 v56,v56
s_nop 0
v_cvt_pk_bf16_f32 v56,v56,v56
v_and_b32 v56,0xffff0000,v56
v_lshlrev_b32 v48,16,v104
v_and_b32 v49,0xffff0000,v104
v_lshlrev_b32 v50,16,v105
v_and_b32 v51,0xffff0000,v105
v_lshlrev_b32 v52,16,v106
v_and_b32 v53,0xffff0000,v106
v_lshlrev_b32 v54,16,v107
v_and_b32 v55,0xffff0000,v107
s_waitcnt lgkmcnt(0)
v_cvt_pk_bf16_f32 v40,v24,v25
v_cvt_pk_bf16_f32 v41,v26,v27
v_cvt_pk_bf16_f32 v42,v28,v29
v_cvt_pk_bf16_f32 v43,v30,v31
v_lshlrev_b32 v24,16,v40
v_and_b32 v25,0xffff0000,v40
v_lshlrev_b32 v26,16,v41
v_and_b32 v27,0xffff0000,v41
v_lshlrev_b32 v28,16,v42
v_and_b32 v29,0xffff0000,v42
v_lshlrev_b32 v30,16,v43
v_and_b32 v31,0xffff0000,v43
v_mul_f32 v24,v24,v56
v_mul_f32 v25,v25,v56
v_mul_f32 v26,v26,v56
v_mul_f32 v27,v27,v56
v_mul_f32 v28,v28,v56
v_mul_f32 v29,v29,v56
v_mul_f32 v30,v30,v56
v_mul_f32 v31,v31,v56
v_cvt_pk_bf16_f32 v40,v24,v25
v_cvt_pk_bf16_f32 v41,v26,v27
v_cvt_pk_bf16_f32 v42,v28,v29
v_cvt_pk_bf16_f32 v43,v30,v31
v_lshlrev_b32 v24,16,v40
v_and_b32 v25,0xffff0000,v40
v_lshlrev_b32 v26,16,v41
v_and_b32 v27,0xffff0000,v41
v_lshlrev_b32 v28,16,v42
v_and_b32 v29,0xffff0000,v42
v_lshlrev_b32 v30,16,v43
v_and_b32 v31,0xffff0000,v43
v_add_f32 v24,v24,v48
v_add_f32 v25,v25,v49
v_add_f32 v26,v26,v50
v_add_f32 v27,v27,v51
v_add_f32 v28,v28,v52
v_add_f32 v29,v29,v53
v_add_f32 v30,v30,v54
v_add_f32 v31,v31,v55
v_cvt_pk_bf16_f32 v40,v24,v25
v_cvt_pk_bf16_f32 v41,v26,v27
v_cvt_pk_bf16_f32 v42,v28,v29
v_cvt_pk_bf16_f32 v43,v30,v31
v_lshlrev_b32 v24,16,v40
v_and_b32 v25,0xffff0000,v40
v_lshlrev_b32 v26,16,v41
v_and_b32 v27,0xffff0000,v41
v_lshlrev_b32 v28,16,v42
v_and_b32 v29,0xffff0000,v42
v_lshlrev_b32 v30,16,v43
v_and_b32 v31,0xffff0000,v43
v_add_f32 v96,v96,v24
v_add_f32 v97,v97,v25
v_add_f32 v98,v98,v26
v_add_f32 v99,v99,v27
v_add_f32 v100,v100,v28
v_add_f32 v101,v101,v29
v_add_f32 v102,v102,v30
v_add_f32 v103,v103,v31
v_cvt_pk_bf16_f32 v80,v96,v97
v_cvt_pk_bf16_f32 v81,v98,v99
v_cvt_pk_bf16_f32 v82,v100,v101
v_cvt_pk_bf16_f32 v83,v102,v103
s_mov_b32 s4,s40
s_mov_b32 s5,s41
s_mov_b32 s6,2097152
s_mov_b32 s7,0x20000
buffer_store_dwordx4 v[80:83],v0,s[4:7],s56 offen sc1
L_moed_347:
s_endpgm
.section .rodata,"a"
.p2align 6
.amdhsa_kernel interleave_layers__memory_aug_recurrent_mem_tr__moe_arch_mod__prompt_kernel
  .amdhsa_next_free_vgpr 512
  .amdhsa_next_free_sgpr 102
  .amdhsa_accum_offset 256
  .amdhsa_group_segment_fixed_size 0
  .amdhsa_kernarg_size 120
  .amdhsa_user_sgpr_count 2
  .amdhsa_user_sgpr_kernarg_segment_ptr 1
  .amdhsa_system_sgpr_workgroup_id_x 1
  .amdhsa_float_denorm_mode_32 3
.end_amdhsa_kernel
```

```asm
; @launch grid=(256,1,1) block=(256,1,1) lds=163840
.amdgcn_target "amdgcn-amd-amdhsa--gfx950"
.text
.globl interleave_layers__memory_aug_recurrent_mem_tr__moe_arch_mod__prompt_kernel
.p2align 8
.type interleave_layers__memory_aug_recurrent_mem_tr__moe_arch_mod__prompt_kernel,@function
interleave_layers__memory_aug_recurrent_mem_tr__moe_arch_mod__prompt_kernel:
s_cmp_ge_u32 s2,256
s_cbranch_scc1 L_abort
s_load_dwordx16 s[16:31],s[0:1],0
s_load_dwordx8 s[32:39],s[0:1],64
s_load_dwordx4 s[40:43],s[0:1],96
s_load_dwordx2 s[44:45],s[0:1],112
v_lshrrev_b32 v2,6,v0
v_and_b32 v1,63,v0
v_readfirstlane_b32 s46,v2
v_lshlrev_b32 v0,4,v1
s_getreg_b32 s48,hwreg(HW_REG_XCC_ID)
s_and_b32 s48,s48,7
s_lshl_b32 s48,s48,2
s_lshr_b32 s48,1399931488,s48
s_and_b32 s48,s48,7
s_mov_b32 s49,100000
s_mov_b32 s80,0x3e0293ee
s_waitcnt lgkmcnt(0)
s_mov_b32 s8,s44
s_mov_b32 s9,s45
s_mov_b32 s10,268435456
s_mov_b32 s11,0x20000
s_mov_b32 s12,s42
s_mov_b32 s13,s43
s_mov_b32 s14,256
s_mov_b32 s15,0x20000
s_cmp_lg_u32 s46,0
s_cbranch_scc1 L_tk_1
s_lshl_b32 s56,s48,2
v_mov_b32 v14,s56
v_mov_b32 v15,1
s_mov_b64 exec,1
buffer_atomic_add v15,v14,s[12:15],0 offen sc0
s_mov_b64 exec,-1
L_tk_1:
s_mov_b32 s4,s16
s_mov_b32 s5,s17
s_mov_b32 s6,2097152
s_mov_b32 s7,0x20000
s_lshl_b32 s56,s2,3
s_lshl_b32 s59,s46,1
s_add_u32 s56,s56,s59
s_lshl_b32 s59,s56,10
buffer_load_dwordx4 v[24:27],v0,s[4:7],s59 offen
buffer_load_dwordx4 v[28:31],v0,s[4:7],s59 offen offset:1024
s_lshl_b32 s56,s2,12
s_lshl_b32 s57,s46,10
s_add_u32 s56,s56,s57
v_add_u32 v2,s56,v0
v_mov_b32 v4,-1
v_mov_b32 v5,-1
v_mov_b32 v6,-1
v_mov_b32 v7,-1
v_mov_b32 v8,0
v_mov_b32 v9,0
v_mov_b32 v10,0
v_mov_b32 v11,0
v_cmp_gt_u32 vcc,524288,v2
v_mov_b32 v3,14155776
v_mov_b32 v12,11542528
v_cndmask_b32 v3,v3,v12,vcc
v_add_u32 v3,v3,v2
s_mov_b32 s56,0
buffer_store_dwordx4 v[4:7],v3,s[8:11],s56 offen sc1
s_mov_b32 s56,1048576
buffer_store_dwordx4 v[4:7],v3,s[8:11],s56 offen sc1
s_mov_b32 s56,2097152
buffer_store_dwordx4 v[4:7],v3,s[8:11],s56 offen sc1
s_mov_b32 s56,4194304
buffer_store_dwordx4 v[4:7],v2,s[8:11],s56 offen sc1
s_mov_b32 s56,5242880
buffer_store_dwordx4 v[4:7],v2,s[8:11],s56 offen sc1
v_add_u32 v3,17309696,v2
v_mov_b32 v12,0x80000000
v_cndmask_b32 v3,v3,v12,vcc
buffer_store_dwordx4 v[4:7],v3,s[8:11],0 offen sc1
v_cmp_gt_u32 vcc,147456,v2
v_lshrrev_b32 v3,11,v2
v_lshlrev_b32 v3,13,v3
v_and_b32 v13,0x7ff,v2
v_add_u32 v3,v3,v13
v_add_u32 v3,10485760,v3
v_cndmask_b32 v3,v12,v3,vcc
buffer_store_dwordx4 v[8:11],v3,s[8:11],0 offen sc1
v_add_u32 v3,11075584,v2
v_lshrrev_b32 v13,16,v2
v_cmp_eq_u32 vcc,4,v13
s_nop 1
v_cndmask_b32 v3,v12,v3,vcc
buffer_store_dwordx4 v[4:7],v3,s[8:11],0 offen sc1
s_waitcnt vmcnt(8)
v_lshlrev_b32 v32,16,v24
v_and_b32 v33,0xffff0000,v24
v_lshlrev_b32 v34,16,v25
v_and_b32 v35,0xffff0000,v25
v_lshlrev_b32 v36,16,v26
v_and_b32 v37,0xffff0000,v26
v_lshlrev_b32 v38,16,v27
v_and_b32 v39,0xffff0000,v27
v_readfirstlane_b32 s78,v32
s_nop 1
v_pk_add_f32 v[48:49],v[32:33],s[78:79] op_sel_hi:[1,0] neg_lo:[0,1] neg_hi:[0,1]
v_pk_add_f32 v[50:51],v[34:35],s[78:79] op_sel_hi:[1,0] neg_lo:[0,1] neg_hi:[0,1]
v_pk_add_f32 v[52:53],v[36:37],s[78:79] op_sel_hi:[1,0] neg_lo:[0,1] neg_hi:[0,1]
v_pk_add_f32 v[54:55],v[38:39],s[78:79] op_sel_hi:[1,0] neg_lo:[0,1] neg_hi:[0,1]
v_pk_add_f32 v[56:57],v[48:49],v[50:51]
v_pk_mul_f32 v[58:59],v[48:49],v[48:49]
v_pk_add_f32 v[60:61],v[52:53],v[54:55]
v_pk_fma_f32 v[58:59],v[50:51],v[50:51],v[58:59]
v_pk_add_f32 v[56:57],v[56:57],v[60:61]
v_pk_fma_f32 v[58:59],v[52:53],v[52:53],v[58:59]
v_add_f32 v56,v56,v57
v_pk_fma_f32 v[58:59],v[54:55],v[54:55],v[58:59]
v_add_f32 v58,v58,v59
s_nop 1
v_permlane32_swap_b32 v56,v58
v_add_f32 v56,v56,v58
s_nop 1
v_add_f32_dpp v56,v56,v56 row_ror:8 row_mask:0xf bank_mask:0xf
s_nop 1
v_add_f32_dpp v56,v56,v56 row_ror:4 row_mask:0xf bank_mask:0xf
s_nop 1
v_add_f32_dpp v56,v56,v56 row_ror:2 row_mask:0xf bank_mask:0xf
s_nop 1
v_add_f32_dpp v56,v56,v56 row_ror:1 row_mask:0xf bank_mask:0xf
v_mov_b32 v58,v56
s_nop 1
v_permlane16_swap_b32 v56,v58
v_add_f32 v56,v56,v58
v_mul_f32 v56,0x3b000000,v56
v_mov_b32 v58,v56
s_nop 1
v_permlane32_swap_b32 v56,v58
v_fma_f32 v58,-v56,v56,v58
v_add_f32 v56,s78,v56
v_max_f32 v58,0,v58
v_cvt_pk_bf16_f32 v58,v56,v58
v_lshlrev_b32 v56,16,v58
v_and_b32 v58,0xffff0000,v58
v_add_f32 v58,0x3727c5ac,v58
v_cvt_pk_bf16_f32 v58,v58,v58
v_and_b32 v58,0xffff0000,v58
v_sqrt_f32 v58,v58
v_pk_add_f32 v[48:49],v[32:33],v[56:57] op_sel_hi:[1,0] neg_lo:[0,1] neg_hi:[0,1]
v_pk_add_f32 v[50:51],v[34:35],v[56:57] op_sel_hi:[1,0] neg_lo:[0,1] neg_hi:[0,1]
v_pk_add_f32 v[52:53],v[36:37],v[56:57] op_sel_hi:[1,0] neg_lo:[0,1] neg_hi:[0,1]
v_pk_add_f32 v[54:55],v[38:39],v[56:57] op_sel_hi:[1,0] neg_lo:[0,1] neg_hi:[0,1]
v_cvt_pk_bf16_f32 v58,v58,v58
v_and_b32 v58,0xffff0000,v58
v_rcp_f32 v58,v58
v_cvt_pk_bf16_f32 v40,v48,v49
v_cvt_pk_bf16_f32 v41,v50,v51
v_cvt_pk_bf16_f32 v42,v52,v53
v_cvt_pk_bf16_f32 v43,v54,v55
v_lshlrev_b32 v48,16,v40
v_and_b32 v49,0xffff0000,v40
v_lshlrev_b32 v50,16,v41
v_and_b32 v51,0xffff0000,v41
v_lshlrev_b32 v52,16,v42
v_and_b32 v53,0xffff0000,v42
v_lshlrev_b32 v54,16,v43
v_and_b32 v55,0xffff0000,v43
v_pk_mul_f32 v[48:49],v[48:49],v[58:59] op_sel_hi:[1,0]
v_pk_mul_f32 v[50:51],v[50:51],v[58:59] op_sel_hi:[1,0]
v_pk_mul_f32 v[52:53],v[52:53],v[58:59] op_sel_hi:[1,0]
v_pk_mul_f32 v[54:55],v[54:55],v[58:59] op_sel_hi:[1,0]
v_cvt_pk_bf16_f32 v40,v48,v49
v_cvt_pk_bf16_f32 v41,v50,v51
v_cvt_pk_bf16_f32 v42,v52,v53
v_cvt_pk_bf16_f32 v43,v54,v55
buffer_store_dwordx4 v[40:43],v0,s[8:11],s59 offen offset:0 sc1
v_lshlrev_b32 v32,16,v28
v_and_b32 v33,0xffff0000,v28
v_lshlrev_b32 v34,16,v29
v_and_b32 v35,0xffff0000,v29
v_lshlrev_b32 v36,16,v30
v_and_b32 v37,0xffff0000,v30
v_lshlrev_b32 v38,16,v31
v_and_b32 v39,0xffff0000,v31
v_readfirstlane_b32 s78,v32
s_nop 1
v_pk_add_f32 v[48:49],v[32:33],s[78:79] op_sel_hi:[1,0] neg_lo:[0,1] neg_hi:[0,1]
v_pk_add_f32 v[50:51],v[34:35],s[78:79] op_sel_hi:[1,0] neg_lo:[0,1] neg_hi:[0,1]
v_pk_add_f32 v[52:53],v[36:37],s[78:79] op_sel_hi:[1,0] neg_lo:[0,1] neg_hi:[0,1]
v_pk_add_f32 v[54:55],v[38:39],s[78:79] op_sel_hi:[1,0] neg_lo:[0,1] neg_hi:[0,1]
v_pk_add_f32 v[56:57],v[48:49],v[50:51]
v_pk_mul_f32 v[58:59],v[48:49],v[48:49]
v_pk_add_f32 v[60:61],v[52:53],v[54:55]
v_pk_fma_f32 v[58:59],v[50:51],v[50:51],v[58:59]
v_pk_add_f32 v[56:57],v[56:57],v[60:61]
v_pk_fma_f32 v[58:59],v[52:53],v[52:53],v[58:59]
v_add_f32 v56,v56,v57
v_pk_fma_f32 v[58:59],v[54:55],v[54:55],v[58:59]
v_add_f32 v58,v58,v59
s_nop 1
v_permlane32_swap_b32 v56,v58
v_add_f32 v56,v56,v58
s_nop 1
v_add_f32_dpp v56,v56,v56 row_ror:8 row_mask:0xf bank_mask:0xf
s_nop 1
v_add_f32_dpp v56,v56,v56 row_ror:4 row_mask:0xf bank_mask:0xf
s_nop 1
v_add_f32_dpp v56,v56,v56 row_ror:2 row_mask:0xf bank_mask:0xf
s_nop 1
v_add_f32_dpp v56,v56,v56 row_ror:1 row_mask:0xf bank_mask:0xf
v_mov_b32 v58,v56
s_nop 1
v_permlane16_swap_b32 v56,v58
v_add_f32 v56,v56,v58
v_mul_f32 v56,0x3b000000,v56
v_mov_b32 v58,v56
s_nop 1
v_permlane32_swap_b32 v56,v58
v_fma_f32 v58,-v56,v56,v58
v_add_f32 v56,s78,v56
v_max_f32 v58,0,v58
v_cvt_pk_bf16_f32 v58,v56,v58
v_lshlrev_b32 v56,16,v58
v_and_b32 v58,0xffff0000,v58
v_add_f32 v58,0x3727c5ac,v58
v_cvt_pk_bf16_f32 v58,v58,v58
v_and_b32 v58,0xffff0000,v58
v_sqrt_f32 v58,v58
v_pk_add_f32 v[48:49],v[32:33],v[56:57] op_sel_hi:[1,0] neg_lo:[0,1] neg_hi:[0,1]
v_pk_add_f32 v[50:51],v[34:35],v[56:57] op_sel_hi:[1,0] neg_lo:[0,1] neg_hi:[0,1]
v_pk_add_f32 v[52:53],v[36:37],v[56:57] op_sel_hi:[1,0] neg_lo:[0,1] neg_hi:[0,1]
v_pk_add_f32 v[54:55],v[38:39],v[56:57] op_sel_hi:[1,0] neg_lo:[0,1] neg_hi:[0,1]
v_cvt_pk_bf16_f32 v58,v58,v58
v_and_b32 v58,0xffff0000,v58
v_rcp_f32 v58,v58
v_cvt_pk_bf16_f32 v44,v48,v49
v_cvt_pk_bf16_f32 v45,v50,v51
v_cvt_pk_bf16_f32 v46,v52,v53
v_cvt_pk_bf16_f32 v47,v54,v55
v_lshlrev_b32 v48,16,v44
v_and_b32 v49,0xffff0000,v44
v_lshlrev_b32 v50,16,v45
v_and_b32 v51,0xffff0000,v45
v_lshlrev_b32 v52,16,v46
v_and_b32 v53,0xffff0000,v46
v_lshlrev_b32 v54,16,v47
v_and_b32 v55,0xffff0000,v47
v_pk_mul_f32 v[48:49],v[48:49],v[58:59] op_sel_hi:[1,0]
v_pk_mul_f32 v[50:51],v[50:51],v[58:59] op_sel_hi:[1,0]
v_pk_mul_f32 v[52:53],v[52:53],v[58:59] op_sel_hi:[1,0]
v_pk_mul_f32 v[54:55],v[54:55],v[58:59] op_sel_hi:[1,0]
v_cvt_pk_bf16_f32 v44,v48,v49
v_cvt_pk_bf16_f32 v45,v50,v51
v_cvt_pk_bf16_f32 v46,v52,v53
v_cvt_pk_bf16_f32 v47,v54,v55
buffer_store_dwordx4 v[44:47],v0,s[8:11],s59 offen offset:1024 sc1
s_mov_b32 s4,s18
s_mov_b32 s5,s19
s_mov_b32 s6,8192
s_mov_b32 s7,0x20000
s_cmp_ge_u32 s2,2
s_cbranch_scc1 L_m0_2
s_lshl_b32 s56,s2,2
s_add_u32 s56,s56,s46
v_bfe_u32 v2,v1,2,2
v_and_b32 v3,1,v1
v_lshl_add_u32 v2,v2,1,v3
v_lshlrev_b32 v2,10,v2
v_lshrrev_b32 v3,4,v1
v_lshl_add_u32 v2,v3,5,v2
v_and_b32 v3,2,v1
v_lshl_add_u32 v2,v3,1,v2
s_lshl_b32 s57,s56,7
buffer_load_dword v32,v2,s[4:7],s57 offen offset:0
buffer_load_dword v33,v2,s[4:7],s57 offen offset:8
buffer_load_dword v34,v2,s[4:7],s57 offen offset:16
buffer_load_dword v35,v2,s[4:7],s57 offen offset:24
v_lshrrev_b32 v2,3,v1
v_lshlrev_b32 v2,9,v2
v_and_b32 v3,7,v1
v_lshl_add_u32 v2,v3,4,v2
s_and_b32 s57,s56,1
s_lshl_b32 s57,s57,8
s_and_b32 s58,s56,2
s_lshl_b32 s58,s58,6
s_add_u32 s57,s57,s58
s_and_b32 s58,s56,4
s_lshl_b32 s58,s58,10
s_add_u32 s57,s57,s58
s_waitcnt vmcnt(0)
s_add_u32 s58,s57,11534336
buffer_store_dwordx4 v[32:35],v2,s[8:11],s58 offen sc1
s_add_u32 s58,s57,12582912
buffer_store_dwordx4 v[32:35],v2,s[8:11],s58 offen sc1
s_add_u32 s58,s57,17825792
buffer_store_dwordx4 v[32:35],v2,s[8:11],s58 offen sc1
L_m0_2:
s_cmp_lg_u32 s46,0
s_cbranch_scc1 L_tk_3
s_mov_b64 exec,1
v_mov_b32 v4,159744
ds_write_b32 v4,v15
s_mov_b64 exec,-1
s_waitcnt lgkmcnt(0)
L_tk_3:
s_barrier
v_mov_b32 v4,159744
ds_read_b32 v3,v4
s_waitcnt lgkmcnt(0)
v_readfirstlane_b32 s47,v3
s_mov_b32 s3,0
s_cmp_ge_u32 s47,32
s_cselect_b32 s53,0x10001,1
s_and_b32 s47,s47,31
s_lshl_b32 s50,s46,10
s_cmp_eq_u32 s46,0
s_cselect_b32 s52,0,0x80000000
s_mov_b32 s28,0x3f803f80
s_mov_b32 s29,0x3f803f80
s_mov_b32 s51,0
s_bfe_u32 s56,s48,0x10001
s_and_b32 s57,s48,1
s_add_u32 s58,s56,6
s_sub_u32 s59,5,s57
s_cmp_ge_u32 s47,16
s_cselect_b32 s58,s58,s59
s_cselect_b32 s57,s57,s56
s_and_b32 s59,s47,15
s_lshl4_add_u32 s57,s57,s59
s_cmp_ge_u32 s48,4
s_cselect_b32 s48,s58,s48
s_cselect_b32 s47,s57,s47
L_roles:
s_cmp_ge_u32 s48,6
s_cbranch_scc1 L_ra_6
v_and_b32 v2,15,v1
v_lshlrev_b32 v2,2,v2
v_lshrrev_b32 v3,4,v1
v_lshl_add_u32 v4,v3,16,v2
v_lshl_add_u32 v5,v3,13,v2
s_lshl_b32 s58,s47,8
s_lshl_b32 s57,s46,6
s_add_u32 s58,s58,s57
s_lshl_b32 s59,s47,17
s_add_u32 s59,s59,s57
s_lshl_b32 s60,s46,15
v_add_u32 v6,s60,v0
s_mov_b32 s61,0x05040100
s_mov_b32 s62,0x07060302
s_lshl_b32 s63,s46,19
s_cmp_lt_u32 s48,3
s_cselect_b32 s63,s63,0
s_mov_b32 s4,s22
s_mov_b32 s5,s23
s_mov_b32 s6,4194304
s_mov_b32 s7,0x20000
s_xor_b32 s56,s63,0
s_add_u32 s56,s56,s58
buffer_load_dword v24,v4,s[4:7],s56 offen
s_add_u32 s56,s56,8192
buffer_load_dword v25,v4,s[4:7],s56 offen
s_add_u32 s56,s56,8192
buffer_load_dword v26,v4,s[4:7],s56 offen
s_add_u32 s56,s56,8192
buffer_load_dword v27,v4,s[4:7],s56 offen
s_add_u32 s56,s56,8192
buffer_load_dword v28,v4,s[4:7],s56 offen
s_add_u32 s56,s56,8192
buffer_load_dword v29,v4,s[4:7],s56 offen
s_add_u32 s56,s56,8192
buffer_load_dword v30,v4,s[4:7],s56 offen
s_add_u32 s56,s56,8192
buffer_load_dword v31,v4,s[4:7],s56 offen
s_xor_b32 s56,s63,262144
s_add_u32 s56,s56,s58
buffer_load_dword v32,v4,s[4:7],s56 offen
s_add_u32 s56,s56,8192
buffer_load_dword v33,v4,s[4:7],s56 offen
s_add_u32 s56,s56,8192
buffer_load_dword v34,v4,s[4:7],s56 offen
s_add_u32 s56,s56,8192
buffer_load_dword v35,v4,s[4:7],s56 offen
s_add_u32 s56,s56,8192
buffer_load_dword v36,v4,s[4:7],s56 offen
s_add_u32 s56,s56,8192
buffer_load_dword v37,v4,s[4:7],s56 offen
s_add_u32 s56,s56,8192
buffer_load_dword v38,v4,s[4:7],s56 offen
s_add_u32 s56,s56,8192
buffer_load_dword v39,v4,s[4:7],s56 offen
s_xor_b32 s56,s63,524288
s_add_u32 s56,s56,s58
buffer_load_dword v40,v4,s[4:7],s56 offen
s_add_u32 s56,s56,8192
buffer_load_dword v41,v4,s[4:7],s56 offen
s_add_u32 s56,s56,8192
buffer_load_dword v42,v4,s[4:7],s56 offen
s_add_u32 s56,s56,8192
buffer_load_dword v43,v4,s[4:7],s56 offen
s_add_u32 s56,s56,8192
buffer_load_dword v44,v4,s[4:7],s56 offen
s_add_u32 s56,s56,8192
buffer_load_dword v45,v4,s[4:7],s56 offen
s_add_u32 s56,s56,8192
buffer_load_dword v46,v4,s[4:7],s56 offen
s_add_u32 s56,s56,8192
buffer_load_dword v47,v4,s[4:7],s56 offen
s_xor_b32 s56,s63,786432
s_add_u32 s56,s56,s58
buffer_load_dword v48,v4,s[4:7],s56 offen
s_add_u32 s56,s56,8192
buffer_load_dword v49,v4,s[4:7],s56 offen
s_add_u32 s56,s56,8192
buffer_load_dword v50,v4,s[4:7],s56 offen
s_add_u32 s56,s56,8192
buffer_load_dword v51,v4,s[4:7],s56 offen
s_add_u32 s56,s56,8192
buffer_load_dword v52,v4,s[4:7],s56 offen
s_add_u32 s56,s56,8192
buffer_load_dword v53,v4,s[4:7],s56 offen
s_add_u32 s56,s56,8192
buffer_load_dword v54,v4,s[4:7],s56 offen
s_add_u32 s56,s56,8192
buffer_load_dword v55,v4,s[4:7],s56 offen
s_xor_b32 s56,s63,1048576
s_add_u32 s56,s56,s58
buffer_load_dword v56,v4,s[4:7],s56 offen
s_add_u32 s56,s56,8192
buffer_load_dword v57,v4,s[4:7],s56 offen
s_add_u32 s56,s56,8192
buffer_load_dword v58,v4,s[4:7],s56 offen
s_add_u32 s56,s56,8192
buffer_load_dword v59,v4,s[4:7],s56 offen
s_add_u32 s56,s56,8192
buffer_load_dword v60,v4,s[4:7],s56 offen
s_add_u32 s56,s56,8192
buffer_load_dword v61,v4,s[4:7],s56 offen
s_add_u32 s56,s56,8192
buffer_load_dword v62,v4,s[4:7],s56 offen
s_add_u32 s56,s56,8192
buffer_load_dword v63,v4,s[4:7],s56 offen
s_xor_b32 s56,s63,1310720
s_add_u32 s56,s56,s58
buffer_load_dword v64,v4,s[4:7],s56 offen
s_add_u32 s56,s56,8192
buffer_load_dword v65,v4,s[4:7],s56 offen
s_add_u32 s56,s56,8192
buffer_load_dword v66,v4,s[4:7],s56 offen
s_add_u32 s56,s56,8192
buffer_load_dword v67,v4,s[4:7],s56 offen
s_add_u32 s56,s56,8192
buffer_load_dword v68,v4,s[4:7],s56 offen
s_add_u32 s56,s56,8192
buffer_load_dword v69,v4,s[4:7],s56 offen
s_add_u32 s56,s56,8192
buffer_load_dword v70,v4,s[4:7],s56 offen
s_add_u32 s56,s56,8192
buffer_load_dword v71,v4,s[4:7],s56 offen
s_xor_b32 s56,s63,1572864
s_add_u32 s56,s56,s58
buffer_load_dword v72,v4,s[4:7],s56 offen
s_add_u32 s56,s56,8192
buffer_load_dword v73,v4,s[4:7],s56 offen
s_add_u32 s56,s56,8192
buffer_load_dword v74,v4,s[4:7],s56 offen
s_add_u32 s56,s56,8192
buffer_load_dword v75,v4,s[4:7],s56 offen
s_add_u32 s56,s56,8192
buffer_load_dword v76,v4,s[4:7],s56 offen
s_add_u32 s56,s56,8192
buffer_load_dword v77,v4,s[4:7],s56 offen
s_add_u32 s56,s56,8192
buffer_load_dword v78,v4,s[4:7],s56 offen
s_add_u32 s56,s56,8192
buffer_load_dword v79,v4,s[4:7],s56 offen
s_waitcnt vmcnt(48)
v_perm_b32 v80,v25,v24,s61
v_perm_b32 v81,v27,v26,s61
v_perm_b32 v82,v29,v28,s61
v_perm_b32 v83,v31,v30,s61
v_perm_b32 v84,v25,v24,s62
v_perm_b32 v85,v27,v26,s62
v_perm_b32 v86,v29,v28,s62
v_perm_b32 v87,v31,v30,s62
v_accvgpr_write_b32 a128,v80
v_accvgpr_write_b32 a129,v81
v_accvgpr_write_b32 a130,v82
v_accvgpr_write_b32 a131,v83
v_accvgpr_write_b32 a136,v84
v_accvgpr_write_b32 a137,v85
v_accvgpr_write_b32 a138,v86
v_accvgpr_write_b32 a139,v87
s_xor_b32 s56,s63,1835008
s_add_u32 s56,s56,s58
buffer_load_dword v24,v4,s[4:7],s56 offen
s_add_u32 s56,s56,8192
buffer_load_dword v25,v4,s[4:7],s56 offen
s_add_u32 s56,s56,8192
buffer_load_dword v26,v4,s[4:7],s56 offen
s_add_u32 s56,s56,8192
buffer_load_dword v27,v4,s[4:7],s56 offen
s_add_u32 s56,s56,8192
buffer_load_dword v28,v4,s[4:7],s56 offen
s_add_u32 s56,s56,8192
buffer_load_dword v29,v4,s[4:7],s56 offen
s_add_u32 s56,s56,8192
buffer_load_dword v30,v4,s[4:7],s56 offen
s_add_u32 s56,s56,8192
buffer_load_dword v31,v4,s[4:7],s56 offen
s_barrier
s_cmp_lg_u32 s46,0
s_cbranch_scc1 L_ar_10
v_mov_b32 v8,128
v_mov_b32 v9,s53
s_mov_b64 exec,1
buffer_atomic_add v9,v8,s[12:15],0 offen
s_mov_b64 exec,-1
L_ar_10:
s_mov_b32 s53,0
s_waitcnt vmcnt(48)
v_perm_b32 v80,v33,v32,s61
v_perm_b32 v81,v35,v34,s61
v_perm_b32 v82,v37,v36,s61
v_perm_b32 v83,v39,v38,s61
v_perm_b32 v84,v33,v32,s62
v_perm_b32 v85,v35,v34,s62
v_perm_b32 v86,v37,v36,s62
v_perm_b32 v87,v39,v38,s62
v_accvgpr_write_b32 a132,v80
v_accvgpr_write_b32 a133,v81
v_accvgpr_write_b32 a134,v82
v_accvgpr_write_b32 a135,v83
v_accvgpr_write_b32 a140,v84
v_accvgpr_write_b32 a141,v85
v_accvgpr_write_b32 a142,v86
v_accvgpr_write_b32 a143,v87
s_xor_b32 s56,s63,2097152
s_add_u32 s56,s56,s58
buffer_load_dword v32,v4,s[4:7],s56 offen
s_add_u32 s56,s56,8192
buffer_load_dword v33,v4,s[4:7],s56 offen
s_add_u32 s56,s56,8192
buffer_load_dword v34,v4,s[4:7],s56 offen
s_add_u32 s56,s56,8192
buffer_load_dword v35,v4,s[4:7],s56 offen
s_add_u32 s56,s56,8192
buffer_load_dword v36,v4,s[4:7],s56 offen
s_add_u32 s56,s56,8192
buffer_load_dword v37,v4,s[4:7],s56 offen
s_add_u32 s56,s56,8192
buffer_load_dword v38,v4,s[4:7],s56 offen
s_add_u32 s56,s56,8192
buffer_load_dword v39,v4,s[4:7],s56 offen
s_waitcnt vmcnt(48)
v_perm_b32 v80,v41,v40,s61
v_perm_b32 v81,v43,v42,s61
v_perm_b32 v82,v45,v44,s61
v_perm_b32 v83,v47,v46,s61
v_perm_b32 v84,v41,v40,s62
v_perm_b32 v85,v43,v42,s62
v_perm_b32 v86,v45,v44,s62
v_perm_b32 v87,v47,v46,s62
v_accvgpr_write_b32 a144,v80
v_accvgpr_write_b32 a145,v81
v_accvgpr_write_b32 a146,v82
v_accvgpr_write_b32 a147,v83
v_accvgpr_write_b32 a152,v84
v_accvgpr_write_b32 a153,v85
v_accvgpr_write_b32 a154,v86
v_accvgpr_write_b32 a155,v87
s_xor_b32 s56,s63,2359296
s_add_u32 s56,s56,s58
buffer_load_dword v40,v4,s[4:7],s56 offen
s_add_u32 s56,s56,8192
buffer_load_dword v41,v4,s[4:7],s56 offen
s_add_u32 s56,s56,8192
buffer_load_dword v42,v4,s[4:7],s56 offen
s_add_u32 s56,s56,8192
buffer_load_dword v43,v4,s[4:7],s56 offen
s_add_u32 s56,s56,8192
buffer_load_dword v44,v4,s[4:7],s56 offen
s_add_u32 s56,s56,8192
buffer_load_dword v45,v4,s[4:7],s56 offen
s_add_u32 s56,s56,8192
buffer_load_dword v46,v4,s[4:7],s56 offen
s_add_u32 s56,s56,8192
buffer_load_dword v47,v4,s[4:7],s56 offen
s_waitcnt vmcnt(48)
v_perm_b32 v80,v49,v48,s61
v_perm_b32 v81,v51,v50,s61
v_perm_b32 v82,v53,v52,s61
v_perm_b32 v83,v55,v54,s61
v_perm_b32 v84,v49,v48,s62
v_perm_b32 v85,v51,v50,s62
v_perm_b32 v86,v53,v52,s62
v_perm_b32 v87,v55,v54,s62
v_accvgpr_write_b32 a148,v80
v_accvgpr_write_b32 a149,v81
v_accvgpr_write_b32 a150,v82
v_accvgpr_write_b32 a151,v83
v_accvgpr_write_b32 a156,v84
v_accvgpr_write_b32 a157,v85
v_accvgpr_write_b32 a158,v86
v_accvgpr_write_b32 a159,v87
s_xor_b32 s56,s63,2621440
s_add_u32 s56,s56,s58
buffer_load_dword v48,v4,s[4:7],s56 offen
s_add_u32 s56,s56,8192
buffer_load_dword v49,v4,s[4:7],s56 offen
s_add_u32 s56,s56,8192
buffer_load_dword v50,v4,s[4:7],s56 offen
s_add_u32 s56,s56,8192
buffer_load_dword v51,v4,s[4:7],s56 offen
s_add_u32 s56,s56,8192
buffer_load_dword v52,v4,s[4:7],s56 offen
s_add_u32 s56,s56,8192
buffer_load_dword v53,v4,s[4:7],s56 offen
s_add_u32 s56,s56,8192
buffer_load_dword v54,v4,s[4:7],s56 offen
s_add_u32 s56,s56,8192
buffer_load_dword v55,v4,s[4:7],s56 offen
s_waitcnt vmcnt(48)
v_perm_b32 v80,v57,v56,s61
v_perm_b32 v81,v59,v58,s61
v_perm_b32 v82,v61,v60,s61
v_perm_b32 v83,v63,v62,s61
v_perm_b32 v84,v57,v56,s62
v_perm_b32 v85,v59,v58,s62
v_perm_b32 v86,v61,v60,s62
v_perm_b32 v87,v63,v62,s62
v_accvgpr_write_b32 a160,v80
v_accvgpr_write_b32 a161,v81
v_accvgpr_write_b32 a162,v82
v_accvgpr_write_b32 a163,v83
v_accvgpr_write_b32 a168,v84
v_accvgpr_write_b32 a169,v85
v_accvgpr_write_b32 a170,v86
v_accvgpr_write_b32 a171,v87
s_xor_b32 s56,s63,2883584
s_add_u32 s56,s56,s58
buffer_load_dword v56,v4,s[4:7],s56 offen
s_add_u32 s56,s56,8192
buffer_load_dword v57,v4,s[4:7],s56 offen
s_add_u32 s56,s56,8192
buffer_load_dword v58,v4,s[4:7],s56 offen
s_add_u32 s56,s56,8192
buffer_load_dword v59,v4,s[4:7],s56 offen
s_add_u32 s56,s56,8192
buffer_load_dword v60,v4,s[4:7],s56 offen
s_add_u32 s56,s56,8192
buffer_load_dword v61,v4,s[4:7],s56 offen
s_add_u32 s56,s56,8192
buffer_load_dword v62,v4,s[4:7],s56 offen
s_add_u32 s56,s56,8192
buffer_load_dword v63,v4,s[4:7],s56 offen
s_waitcnt vmcnt(48)
v_perm_b32 v80,v65,v64,s61
v_perm_b32 v81,v67,v66,s61
v_perm_b32 v82,v69,v68,s61
v_perm_b32 v83,v71,v70,s61
v_perm_b32 v84,v65,v64,s62
v_perm_b32 v85,v67,v66,s62
v_perm_b32 v86,v69,v68,s62
v_perm_b32 v87,v71,v70,s62
v_accvgpr_write_b32 a164,v80
v_accvgpr_write_b32 a165,v81
v_accvgpr_write_b32 a166,v82
v_accvgpr_write_b32 a167,v83
v_accvgpr_write_b32 a172,v84
v_accvgpr_write_b32 a173,v85
v_accvgpr_write_b32 a174,v86
v_accvgpr_write_b32 a175,v87
s_xor_b32 s56,s63,3145728
s_add_u32 s56,s56,s58
buffer_load_dword v64,v4,s[4:7],s56 offen
s_add_u32 s56,s56,8192
buffer_load_dword v65,v4,s[4:7],s56 offen
s_add_u32 s56,s56,8192
buffer_load_dword v66,v4,s[4:7],s56 offen
s_add_u32 s56,s56,8192
buffer_load_dword v67,v4,s[4:7],s56 offen
s_add_u32 s56,s56,8192
buffer_load_dword v68,v4,s[4:7],s56 offen
s_add_u32 s56,s56,8192
buffer_load_dword v69,v4,s[4:7],s56 offen
s_add_u32 s56,s56,8192
buffer_load_dword v70,v4,s[4:7],s56 offen
s_add_u32 s56,s56,8192
buffer_load_dword v71,v4,s[4:7],s56 offen
s_waitcnt vmcnt(48)
v_perm_b32 v80,v73,v72,s61
v_perm_b32 v81,v75,v74,s61
v_perm_b32 v82,v77,v76,s61
v_perm_b32 v83,v79,v78,s61
v_perm_b32 v84,v73,v72,s62
v_perm_b32 v85,v75,v74,s62
v_perm_b32 v86,v77,v76,s62
v_perm_b32 v87,v79,v78,s62
v_accvgpr_write_b32 a176,v80
v_accvgpr_write_b32 a177,v81
v_accvgpr_write_b32 a178,v82
v_accvgpr_write_b32 a179,v83
v_accvgpr_write_b32 a184,v84
v_accvgpr_write_b32 a185,v85
v_accvgpr_write_b32 a186,v86
v_accvgpr_write_b32 a187,v87
s_xor_b32 s56,s63,3407872
s_add_u32 s56,s56,s58
buffer_load_dword v72,v4,s[4:7],s56 offen
s_add_u32 s56,s56,8192
buffer_load_dword v73,v4,s[4:7],s56 offen
s_add_u32 s56,s56,8192
buffer_load_dword v74,v4,s[4:7],s56 offen
s_add_u32 s56,s56,8192
buffer_load_dword v75,v4,s[4:7],s56 offen
s_add_u32 s56,s56,8192
buffer_load_dword v76,v4,s[4:7],s56 offen
s_add_u32 s56,s56,8192
buffer_load_dword v77,v4,s[4:7],s56 offen
s_add_u32 s56,s56,8192
buffer_load_dword v78,v4,s[4:7],s56 offen
s_add_u32 s56,s56,8192
buffer_load_dword v79,v4,s[4:7],s56 offen
s_waitcnt vmcnt(48)
v_perm_b32 v80,v25,v24,s61
v_perm_b32 v81,v27,v26,s61
v_perm_b32 v82,v29,v28,s61
v_perm_b32 v83,v31,v30,s61
v_perm_b32 v84,v25,v24,s62
v_perm_b32 v85,v27,v26,s62
v_perm_b32 v86,v29,v28,s62
v_perm_b32 v87,v31,v30,s62
v_accvgpr_write_b32 a180,v80
v_accvgpr_write_b32 a181,v81
v_accvgpr_write_b32 a182,v82
v_accvgpr_write_b32 a183,v83
v_accvgpr_write_b32 a188,v84
v_accvgpr_write_b32 a189,v85
v_accvgpr_write_b32 a190,v86
v_accvgpr_write_b32 a191,v87
s_xor_b32 s56,s63,3670016
s_add_u32 s56,s56,s58
buffer_load_dword v24,v4,s[4:7],s56 offen
s_add_u32 s56,s56,8192
buffer_load_dword v25,v4,s[4:7],s56 offen
s_add_u32 s56,s56,8192
buffer_load_dword v26,v4,s[4:7],s56 offen
s_add_u32 s56,s56,8192
buffer_load_dword v27,v4,s[4:7],s56 offen
s_add_u32 s56,s56,8192
buffer_load_dword v28,v4,s[4:7],s56 offen
s_add_u32 s56,s56,8192
buffer_load_dword v29,v4,s[4:7],s56 offen
s_add_u32 s56,s56,8192
buffer_load_dword v30,v4,s[4:7],s56 offen
s_add_u32 s56,s56,8192
buffer_load_dword v31,v4,s[4:7],s56 offen
s_waitcnt vmcnt(48)
v_perm_b32 v80,v33,v32,s61
v_perm_b32 v81,v35,v34,s61
v_perm_b32 v82,v37,v36,s61
v_perm_b32 v83,v39,v38,s61
v_perm_b32 v84,v33,v32,s62
v_perm_b32 v85,v35,v34,s62
v_perm_b32 v86,v37,v36,s62
v_perm_b32 v87,v39,v38,s62
v_accvgpr_write_b32 a192,v80
v_accvgpr_write_b32 a193,v81
v_accvgpr_write_b32 a194,v82
v_accvgpr_write_b32 a195,v83
v_accvgpr_write_b32 a200,v84
v_accvgpr_write_b32 a201,v85
v_accvgpr_write_b32 a202,v86
v_accvgpr_write_b32 a203,v87
s_xor_b32 s56,s63,3932160
s_add_u32 s56,s56,s58
buffer_load_dword v32,v4,s[4:7],s56 offen
s_add_u32 s56,s56,8192
buffer_load_dword v33,v4,s[4:7],s56 offen
s_add_u32 s56,s56,8192
buffer_load_dword v34,v4,s[4:7],s56 offen
s_add_u32 s56,s56,8192
buffer_load_dword v35,v4,s[4:7],s56 offen
s_add_u32 s56,s56,8192
buffer_load_dword v36,v4,s[4:7],s56 offen
s_add_u32 s56,s56,8192
buffer_load_dword v37,v4,s[4:7],s56 offen
s_add_u32 s56,s56,8192
buffer_load_dword v38,v4,s[4:7],s56 offen
s_add_u32 s56,s56,8192
buffer_load_dword v39,v4,s[4:7],s56 offen
s_waitcnt vmcnt(48)
v_perm_b32 v80,v41,v40,s61
v_perm_b32 v81,v43,v42,s61
v_perm_b32 v82,v45,v44,s61
v_perm_b32 v83,v47,v46,s61
v_perm_b32 v84,v41,v40,s62
v_perm_b32 v85,v43,v42,s62
v_perm_b32 v86,v45,v44,s62
v_perm_b32 v87,v47,v46,s62
v_accvgpr_write_b32 a196,v80
v_accvgpr_write_b32 a197,v81
v_accvgpr_write_b32 a198,v82
v_accvgpr_write_b32 a199,v83
v_accvgpr_write_b32 a204,v84
v_accvgpr_write_b32 a205,v85
v_accvgpr_write_b32 a206,v86
v_accvgpr_write_b32 a207,v87
s_mov_b32 s4,s24
s_mov_b32 s5,s25
s_mov_b32 s6,4194304
s_mov_b32 s7,0x20000
s_xor_b32 s56,s63,0
s_add_u32 s56,s56,s58
buffer_load_dword v40,v4,s[4:7],s56 offen
s_add_u32 s56,s56,8192
buffer_load_dword v41,v4,s[4:7],s56 offen
s_add_u32 s56,s56,8192
buffer_load_dword v42,v4,s[4:7],s56 offen
s_add_u32 s56,s56,8192
buffer_load_dword v43,v4,s[4:7],s56 offen
s_add_u32 s56,s56,8192
buffer_load_dword v44,v4,s[4:7],s56 offen
s_add_u32 s56,s56,8192
buffer_load_dword v45,v4,s[4:7],s56 offen
s_add_u32 s56,s56,8192
buffer_load_dword v46,v4,s[4:7],s56 offen
s_add_u32 s56,s56,8192
buffer_load_dword v47,v4,s[4:7],s56 offen
s_waitcnt vmcnt(48)
v_perm_b32 v80,v49,v48,s61
v_perm_b32 v81,v51,v50,s61
v_perm_b32 v82,v53,v52,s61
v_perm_b32 v83,v55,v54,s61
v_perm_b32 v84,v49,v48,s62
v_perm_b32 v85,v51,v50,s62
v_perm_b32 v86,v53,v52,s62
v_perm_b32 v87,v55,v54,s62
v_accvgpr_write_b32 a208,v80
v_accvgpr_write_b32 a209,v81
v_accvgpr_write_b32 a210,v82
v_accvgpr_write_b32 a211,v83
v_accvgpr_write_b32 a216,v84
v_accvgpr_write_b32 a217,v85
v_accvgpr_write_b32 a218,v86
v_accvgpr_write_b32 a219,v87
s_xor_b32 s56,s63,262144
s_add_u32 s56,s56,s58
buffer_load_dword v48,v4,s[4:7],s56 offen
s_add_u32 s56,s56,8192
buffer_load_dword v49,v4,s[4:7],s56 offen
s_add_u32 s56,s56,8192
buffer_load_dword v50,v4,s[4:7],s56 offen
s_add_u32 s56,s56,8192
buffer_load_dword v51,v4,s[4:7],s56 offen
s_add_u32 s56,s56,8192
buffer_load_dword v52,v4,s[4:7],s56 offen
s_add_u32 s56,s56,8192
buffer_load_dword v53,v4,s[4:7],s56 offen
s_add_u32 s56,s56,8192
buffer_load_dword v54,v4,s[4:7],s56 offen
s_add_u32 s56,s56,8192
buffer_load_dword v55,v4,s[4:7],s56 offen
s_waitcnt vmcnt(48)
v_perm_b32 v80,v57,v56,s61
v_perm_b32 v81,v59,v58,s61
v_perm_b32 v82,v61,v60,s61
v_perm_b32 v83,v63,v62,s61
v_perm_b32 v84,v57,v56,s62
v_perm_b32 v85,v59,v58,s62
v_perm_b32 v86,v61,v60,s62
v_perm_b32 v87,v63,v62,s62
v_accvgpr_write_b32 a212,v80
v_accvgpr_write_b32 a213,v81
v_accvgpr_write_b32 a214,v82
v_accvgpr_write_b32 a215,v83
v_accvgpr_write_b32 a220,v84
v_accvgpr_write_b32 a221,v85
v_accvgpr_write_b32 a222,v86
v_accvgpr_write_b32 a223,v87
s_xor_b32 s56,s63,524288
s_add_u32 s56,s56,s58
buffer_load_dword v56,v4,s[4:7],s56 offen
s_add_u32 s56,s56,8192
buffer_load_dword v57,v4,s[4:7],s56 offen
s_add_u32 s56,s56,8192
buffer_load_dword v58,v4,s[4:7],s56 offen
s_add_u32 s56,s56,8192
buffer_load_dword v59,v4,s[4:7],s56 offen
s_add_u32 s56,s56,8192
buffer_load_dword v60,v4,s[4:7],s56 offen
s_add_u32 s56,s56,8192
buffer_load_dword v61,v4,s[4:7],s56 offen
s_add_u32 s56,s56,8192
buffer_load_dword v62,v4,s[4:7],s56 offen
s_add_u32 s56,s56,8192
buffer_load_dword v63,v4,s[4:7],s56 offen
s_waitcnt vmcnt(48)
v_perm_b32 v80,v65,v64,s61
v_perm_b32 v81,v67,v66,s61
v_perm_b32 v82,v69,v68,s61
v_perm_b32 v83,v71,v70,s61
v_perm_b32 v84,v65,v64,s62
v_perm_b32 v85,v67,v66,s62
v_perm_b32 v86,v69,v68,s62
v_perm_b32 v87,v71,v70,s62
v_accvgpr_write_b32 a224,v80
v_accvgpr_write_b32 a225,v81
v_accvgpr_write_b32 a226,v82
v_accvgpr_write_b32 a227,v83
v_accvgpr_write_b32 a232,v84
v_accvgpr_write_b32 a233,v85
v_accvgpr_write_b32 a234,v86
v_accvgpr_write_b32 a235,v87
s_xor_b32 s56,s63,786432
s_add_u32 s56,s56,s58
buffer_load_dword v64,v4,s[4:7],s56 offen
s_add_u32 s56,s56,8192
buffer_load_dword v65,v4,s[4:7],s56 offen
s_add_u32 s56,s56,8192
buffer_load_dword v66,v4,s[4:7],s56 offen
s_add_u32 s56,s56,8192
buffer_load_dword v67,v4,s[4:7],s56 offen
s_add_u32 s56,s56,8192
buffer_load_dword v68,v4,s[4:7],s56 offen
s_add_u32 s56,s56,8192
buffer_load_dword v69,v4,s[4:7],s56 offen
s_add_u32 s56,s56,8192
buffer_load_dword v70,v4,s[4:7],s56 offen
s_add_u32 s56,s56,8192
buffer_load_dword v71,v4,s[4:7],s56 offen
s_waitcnt vmcnt(48)
v_perm_b32 v80,v73,v72,s61
v_perm_b32 v81,v75,v74,s61
v_perm_b32 v82,v77,v76,s61
v_perm_b32 v83,v79,v78,s61
v_perm_b32 v84,v73,v72,s62
v_perm_b32 v85,v75,v74,s62
v_perm_b32 v86,v77,v76,s62
v_perm_b32 v87,v79,v78,s62
v_accvgpr_write_b32 a228,v80
v_accvgpr_write_b32 a229,v81
v_accvgpr_write_b32 a230,v82
v_accvgpr_write_b32 a231,v83
v_accvgpr_write_b32 a236,v84
v_accvgpr_write_b32 a237,v85
v_accvgpr_write_b32 a238,v86
v_accvgpr_write_b32 a239,v87
s_xor_b32 s56,s63,1048576
s_add_u32 s56,s56,s58
buffer_load_dword v72,v4,s[4:7],s56 offen
s_add_u32 s56,s56,8192
buffer_load_dword v73,v4,s[4:7],s56 offen
s_add_u32 s56,s56,8192
buffer_load_dword v74,v4,s[4:7],s56 offen
s_add_u32 s56,s56,8192
buffer_load_dword v75,v4,s[4:7],s56 offen
s_add_u32 s56,s56,8192
buffer_load_dword v76,v4,s[4:7],s56 offen
s_add_u32 s56,s56,8192
buffer_load_dword v77,v4,s[4:7],s56 offen
s_add_u32 s56,s56,8192
buffer_load_dword v78,v4,s[4:7],s56 offen
s_add_u32 s56,s56,8192
buffer_load_dword v79,v4,s[4:7],s56 offen
s_waitcnt vmcnt(48)
v_perm_b32 v80,v25,v24,s61
v_perm_b32 v81,v27,v26,s61
v_perm_b32 v82,v29,v28,s61
v_perm_b32 v83,v31,v30,s61
v_perm_b32 v84,v25,v24,s62
v_perm_b32 v85,v27,v26,s62
v_perm_b32 v86,v29,v28,s62
v_perm_b32 v87,v31,v30,s62
v_accvgpr_write_b32 a240,v80
v_accvgpr_write_b32 a241,v81
v_accvgpr_write_b32 a242,v82
v_accvgpr_write_b32 a243,v83
v_accvgpr_write_b32 a248,v84
v_accvgpr_write_b32 a249,v85
v_accvgpr_write_b32 a250,v86
v_accvgpr_write_b32 a251,v87
s_xor_b32 s56,s63,1310720
s_add_u32 s56,s56,s58
buffer_load_dword v24,v4,s[4:7],s56 offen
s_add_u32 s56,s56,8192
buffer_load_dword v25,v4,s[4:7],s56 offen
s_add_u32 s56,s56,8192
buffer_load_dword v26,v4,s[4:7],s56 offen
s_add_u32 s56,s56,8192
buffer_load_dword v27,v4,s[4:7],s56 offen
s_add_u32 s56,s56,8192
buffer_load_dword v28,v4,s[4:7],s56 offen
s_add_u32 s56,s56,8192
buffer_load_dword v29,v4,s[4:7],s56 offen
s_add_u32 s56,s56,8192
buffer_load_dword v30,v4,s[4:7],s56 offen
s_add_u32 s56,s56,8192
buffer_load_dword v31,v4,s[4:7],s56 offen
s_waitcnt vmcnt(48)
v_perm_b32 v80,v33,v32,s61
v_perm_b32 v81,v35,v34,s61
v_perm_b32 v82,v37,v36,s61
v_perm_b32 v83,v39,v38,s61
v_perm_b32 v84,v33,v32,s62
v_perm_b32 v85,v35,v34,s62
v_perm_b32 v86,v37,v36,s62
v_perm_b32 v87,v39,v38,s62
v_accvgpr_write_b32 a244,v80
v_accvgpr_write_b32 a245,v81
v_accvgpr_write_b32 a246,v82
v_accvgpr_write_b32 a247,v83
v_accvgpr_write_b32 a252,v84
v_accvgpr_write_b32 a253,v85
v_accvgpr_write_b32 a254,v86
v_accvgpr_write_b32 a255,v87
s_xor_b32 s56,s63,1572864
s_add_u32 s56,s56,s58
buffer_load_dword v32,v4,s[4:7],s56 offen
s_add_u32 s56,s56,8192
buffer_load_dword v33,v4,s[4:7],s56 offen
s_add_u32 s56,s56,8192
buffer_load_dword v34,v4,s[4:7],s56 offen
s_add_u32 s56,s56,8192
buffer_load_dword v35,v4,s[4:7],s56 offen
s_add_u32 s56,s56,8192
buffer_load_dword v36,v4,s[4:7],s56 offen
s_add_u32 s56,s56,8192
buffer_load_dword v37,v4,s[4:7],s56 offen
s_add_u32 s56,s56,8192
buffer_load_dword v38,v4,s[4:7],s56 offen
s_add_u32 s56,s56,8192
buffer_load_dword v39,v4,s[4:7],s56 offen
s_waitcnt vmcnt(48)
v_perm_b32 v128,v41,v40,s61
v_perm_b32 v129,v43,v42,s61
v_perm_b32 v130,v45,v44,s61
v_perm_b32 v131,v47,v46,s61
v_perm_b32 v136,v41,v40,s62
v_perm_b32 v137,v43,v42,s62
v_perm_b32 v138,v45,v44,s62
v_perm_b32 v139,v47,v46,s62
s_xor_b32 s56,s63,1835008
s_add_u32 s56,s56,s58
buffer_load_dword v40,v4,s[4:7],s56 offen
s_add_u32 s56,s56,8192
buffer_load_dword v41,v4,s[4:7],s56 offen
s_add_u32 s56,s56,8192
buffer_load_dword v42,v4,s[4:7],s56 offen
s_add_u32 s56,s56,8192
buffer_load_dword v43,v4,s[4:7],s56 offen
s_add_u32 s56,s56,8192
buffer_load_dword v44,v4,s[4:7],s56 offen
s_add_u32 s56,s56,8192
buffer_load_dword v45,v4,s[4:7],s56 offen
s_add_u32 s56,s56,8192
buffer_load_dword v46,v4,s[4:7],s56 offen
s_add_u32 s56,s56,8192
buffer_load_dword v47,v4,s[4:7],s56 offen
s_waitcnt vmcnt(48)
v_perm_b32 v132,v49,v48,s61
v_perm_b32 v133,v51,v50,s61
v_perm_b32 v134,v53,v52,s61
v_perm_b32 v135,v55,v54,s61
v_perm_b32 v140,v49,v48,s62
v_perm_b32 v141,v51,v50,s62
v_perm_b32 v142,v53,v52,s62
v_perm_b32 v143,v55,v54,s62
s_xor_b32 s56,s63,2097152
s_add_u32 s56,s56,s58
buffer_load_dword v48,v4,s[4:7],s56 offen
s_add_u32 s56,s56,8192
buffer_load_dword v49,v4,s[4:7],s56 offen
s_add_u32 s56,s56,8192
buffer_load_dword v50,v4,s[4:7],s56 offen
s_add_u32 s56,s56,8192
buffer_load_dword v51,v4,s[4:7],s56 offen
s_add_u32 s56,s56,8192
buffer_load_dword v52,v4,s[4:7],s56 offen
s_add_u32 s56,s56,8192
buffer_load_dword v53,v4,s[4:7],s56 offen
s_add_u32 s56,s56,8192
buffer_load_dword v54,v4,s[4:7],s56 offen
s_add_u32 s56,s56,8192
buffer_load_dword v55,v4,s[4:7],s56 offen
s_waitcnt vmcnt(48)
v_perm_b32 v144,v57,v56,s61
v_perm_b32 v145,v59,v58,s61
v_perm_b32 v146,v61,v60,s61
v_perm_b32 v147,v63,v62,s61
v_perm_b32 v152,v57,v56,s62
v_perm_b32 v153,v59,v58,s62
v_perm_b32 v154,v61,v60,s62
v_perm_b32 v155,v63,v62,s62
s_xor_b32 s56,s63,2359296
s_add_u32 s56,s56,s58
buffer_load_dword v56,v4,s[4:7],s56 offen
s_add_u32 s56,s56,8192
buffer_load_dword v57,v4,s[4:7],s56 offen
s_add_u32 s56,s56,8192
buffer_load_dword v58,v4,s[4:7],s56 offen
s_add_u32 s56,s56,8192
buffer_load_dword v59,v4,s[4:7],s56 offen
s_add_u32 s56,s56,8192
buffer_load_dword v60,v4,s[4:7],s56 offen
s_add_u32 s56,s56,8192
buffer_load_dword v61,v4,s[4:7],s56 offen
s_add_u32 s56,s56,8192
buffer_load_dword v62,v4,s[4:7],s56 offen
s_add_u32 s56,s56,8192
buffer_load_dword v63,v4,s[4:7],s56 offen
s_waitcnt vmcnt(48)
v_perm_b32 v148,v65,v64,s61
v_perm_b32 v149,v67,v66,s61
v_perm_b32 v150,v69,v68,s61
v_perm_b32 v151,v71,v70,s61
v_perm_b32 v156,v65,v64,s62
v_perm_b32 v157,v67,v66,s62
v_perm_b32 v158,v69,v68,s62
v_perm_b32 v159,v71,v70,s62
s_xor_b32 s56,s63,2621440
s_add_u32 s56,s56,s58
buffer_load_dword v64,v4,s[4:7],s56 offen
s_add_u32 s56,s56,8192
buffer_load_dword v65,v4,s[4:7],s56 offen
s_add_u32 s56,s56,8192
buffer_load_dword v66,v4,s[4:7],s56 offen
s_add_u32 s56,s56,8192
buffer_load_dword v67,v4,s[4:7],s56 offen
s_add_u32 s56,s56,8192
buffer_load_dword v68,v4,s[4:7],s56 offen
s_add_u32 s56,s56,8192
buffer_load_dword v69,v4,s[4:7],s56 offen
s_add_u32 s56,s56,8192
buffer_load_dword v70,v4,s[4:7],s56 offen
s_add_u32 s56,s56,8192
buffer_load_dword v71,v4,s[4:7],s56 offen
s_waitcnt vmcnt(48)
v_perm_b32 v160,v73,v72,s61
v_perm_b32 v161,v75,v74,s61
v_perm_b32 v162,v77,v76,s61
v_perm_b32 v163,v79,v78,s61
v_perm_b32 v168,v73,v72,s62
v_perm_b32 v169,v75,v74,s62
v_perm_b32 v170,v77,v76,s62
v_perm_b32 v171,v79,v78,s62
s_xor_b32 s56,s63,2883584
s_add_u32 s56,s56,s58
buffer_load_dword v72,v4,s[4:7],s56 offen
s_add_u32 s56,s56,8192
buffer_load_dword v73,v4,s[4:7],s56 offen
s_add_u32 s56,s56,8192
buffer_load_dword v74,v4,s[4:7],s56 offen
s_add_u32 s56,s56,8192
buffer_load_dword v75,v4,s[4:7],s56 offen
s_add_u32 s56,s56,8192
buffer_load_dword v76,v4,s[4:7],s56 offen
s_add_u32 s56,s56,8192
buffer_load_dword v77,v4,s[4:7],s56 offen
s_add_u32 s56,s56,8192
buffer_load_dword v78,v4,s[4:7],s56 offen
s_add_u32 s56,s56,8192
buffer_load_dword v79,v4,s[4:7],s56 offen
s_waitcnt vmcnt(48)
v_perm_b32 v164,v25,v24,s61
v_perm_b32 v165,v27,v26,s61
v_perm_b32 v166,v29,v28,s61
v_perm_b32 v167,v31,v30,s61
v_perm_b32 v172,v25,v24,s62
v_perm_b32 v173,v27,v26,s62
v_perm_b32 v174,v29,v28,s62
v_perm_b32 v175,v31,v30,s62
s_xor_b32 s56,s63,3145728
s_add_u32 s56,s56,s58
buffer_load_dword v24,v4,s[4:7],s56 offen
s_add_u32 s56,s56,8192
buffer_load_dword v25,v4,s[4:7],s56 offen
s_add_u32 s56,s56,8192
buffer_load_dword v26,v4,s[4:7],s56 offen
s_add_u32 s56,s56,8192
buffer_load_dword v27,v4,s[4:7],s56 offen
s_add_u32 s56,s56,8192
buffer_load_dword v28,v4,s[4:7],s56 offen
s_add_u32 s56,s56,8192
buffer_load_dword v29,v4,s[4:7],s56 offen
s_add_u32 s56,s56,8192
buffer_load_dword v30,v4,s[4:7],s56 offen
s_add_u32 s56,s56,8192
buffer_load_dword v31,v4,s[4:7],s56 offen
s_waitcnt vmcnt(48)
v_perm_b32 v176,v33,v32,s61
v_perm_b32 v177,v35,v34,s61
v_perm_b32 v178,v37,v36,s61
v_perm_b32 v179,v39,v38,s61
v_perm_b32 v184,v33,v32,s62
v_perm_b32 v185,v35,v34,s62
v_perm_b32 v186,v37,v36,s62
v_perm_b32 v187,v39,v38,s62
s_xor_b32 s56,s63,3407872
s_add_u32 s56,s56,s58
buffer_load_dword v32,v4,s[4:7],s56 offen
s_add_u32 s56,s56,8192
buffer_load_dword v33,v4,s[4:7],s56 offen
s_add_u32 s56,s56,8192
buffer_load_dword v34,v4,s[4:7],s56 offen
s_add_u32 s56,s56,8192
buffer_load_dword v35,v4,s[4:7],s56 offen
s_add_u32 s56,s56,8192
buffer_load_dword v36,v4,s[4:7],s56 offen
s_add_u32 s56,s56,8192
buffer_load_dword v37,v4,s[4:7],s56 offen
s_add_u32 s56,s56,8192
buffer_load_dword v38,v4,s[4:7],s56 offen
s_add_u32 s56,s56,8192
buffer_load_dword v39,v4,s[4:7],s56 offen
s_waitcnt vmcnt(48)
v_perm_b32 v180,v41,v40,s61
v_perm_b32 v181,v43,v42,s61
v_perm_b32 v182,v45,v44,s61
v_perm_b32 v183,v47,v46,s61
v_perm_b32 v188,v41,v40,s62
v_perm_b32 v189,v43,v42,s62
v_perm_b32 v190,v45,v44,s62
v_perm_b32 v191,v47,v46,s62
s_xor_b32 s56,s63,3670016
s_add_u32 s56,s56,s58
buffer_load_dword v40,v4,s[4:7],s56 offen
s_add_u32 s56,s56,8192
buffer_load_dword v41,v4,s[4:7],s56 offen
s_add_u32 s56,s56,8192
buffer_load_dword v42,v4,s[4:7],s56 offen
s_add_u32 s56,s56,8192
buffer_load_dword v43,v4,s[4:7],s56 offen
s_add_u32 s56,s56,8192
buffer_load_dword v44,v4,s[4:7],s56 offen
s_add_u32 s56,s56,8192
buffer_load_dword v45,v4,s[4:7],s56 offen
s_add_u32 s56,s56,8192
buffer_load_dword v46,v4,s[4:7],s56 offen
s_add_u32 s56,s56,8192
buffer_load_dword v47,v4,s[4:7],s56 offen
s_waitcnt vmcnt(48)
v_perm_b32 v192,v49,v48,s61
v_perm_b32 v193,v51,v50,s61
v_perm_b32 v194,v53,v52,s61
v_perm_b32 v195,v55,v54,s61
v_perm_b32 v200,v49,v48,s62
v_perm_b32 v201,v51,v50,s62
v_perm_b32 v202,v53,v52,s62
v_perm_b32 v203,v55,v54,s62
s_xor_b32 s56,s63,3932160
s_add_u32 s56,s56,s58
buffer_load_dword v48,v4,s[4:7],s56 offen
s_add_u32 s56,s56,8192
buffer_load_dword v49,v4,s[4:7],s56 offen
s_add_u32 s56,s56,8192
buffer_load_dword v50,v4,s[4:7],s56 offen
s_add_u32 s56,s56,8192
buffer_load_dword v51,v4,s[4:7],s56 offen
s_add_u32 s56,s56,8192
buffer_load_dword v52,v4,s[4:7],s56 offen
s_add_u32 s56,s56,8192
buffer_load_dword v53,v4,s[4:7],s56 offen
s_add_u32 s56,s56,8192
buffer_load_dword v54,v4,s[4:7],s56 offen
s_add_u32 s56,s56,8192
buffer_load_dword v55,v4,s[4:7],s56 offen
s_waitcnt vmcnt(48)
v_perm_b32 v196,v57,v56,s61
v_perm_b32 v197,v59,v58,s61
v_perm_b32 v198,v61,v60,s61
v_perm_b32 v199,v63,v62,s61
v_perm_b32 v204,v57,v56,s62
v_perm_b32 v205,v59,v58,s62
v_perm_b32 v206,v61,v60,s62
v_perm_b32 v207,v63,v62,s62
s_mov_b32 s4,s20
s_mov_b32 s5,s21
s_mov_b32 s6,4194304
s_mov_b32 s7,0x20000
s_xor_b32 s56,s63,0
s_add_u32 s56,s56,s58
buffer_load_dword v56,v4,s[4:7],s56 offen
s_add_u32 s56,s56,8192
buffer_load_dword v57,v4,s[4:7],s56 offen
s_add_u32 s56,s56,8192
buffer_load_dword v58,v4,s[4:7],s56 offen
s_add_u32 s56,s56,8192
buffer_load_dword v59,v4,s[4:7],s56 offen
s_add_u32 s56,s56,8192
buffer_load_dword v60,v4,s[4:7],s56 offen
s_add_u32 s56,s56,8192
buffer_load_dword v61,v4,s[4:7],s56 offen
s_add_u32 s56,s56,8192
buffer_load_dword v62,v4,s[4:7],s56 offen
s_add_u32 s56,s56,8192
buffer_load_dword v63,v4,s[4:7],s56 offen
s_waitcnt vmcnt(48)
v_perm_b32 v208,v65,v64,s61
v_perm_b32 v209,v67,v66,s61
v_perm_b32 v210,v69,v68,s61
v_perm_b32 v211,v71,v70,s61
v_perm_b32 v216,v65,v64,s62
v_perm_b32 v217,v67,v66,s62
v_perm_b32 v218,v69,v68,s62
v_perm_b32 v219,v71,v70,s62
s_xor_b32 s56,s63,262144
s_add_u32 s56,s56,s58
buffer_load_dword v64,v4,s[4:7],s56 offen
s_add_u32 s56,s56,8192
buffer_load_dword v65,v4,s[4:7],s56 offen
s_add_u32 s56,s56,8192
buffer_load_dword v66,v4,s[4:7],s56 offen
s_add_u32 s56,s56,8192
buffer_load_dword v67,v4,s[4:7],s56 offen
s_add_u32 s56,s56,8192
buffer_load_dword v68,v4,s[4:7],s56 offen
s_add_u32 s56,s56,8192
buffer_load_dword v69,v4,s[4:7],s56 offen
s_add_u32 s56,s56,8192
buffer_load_dword v70,v4,s[4:7],s56 offen
s_add_u32 s56,s56,8192
buffer_load_dword v71,v4,s[4:7],s56 offen
s_waitcnt vmcnt(48)
v_perm_b32 v212,v73,v72,s61
v_perm_b32 v213,v75,v74,s61
v_perm_b32 v214,v77,v76,s61
v_perm_b32 v215,v79,v78,s61
v_perm_b32 v220,v73,v72,s62
v_perm_b32 v221,v75,v74,s62
v_perm_b32 v222,v77,v76,s62
v_perm_b32 v223,v79,v78,s62
s_xor_b32 s56,s63,524288
s_add_u32 s56,s56,s58
buffer_load_dword v72,v4,s[4:7],s56 offen
s_add_u32 s56,s56,8192
buffer_load_dword v73,v4,s[4:7],s56 offen
s_add_u32 s56,s56,8192
buffer_load_dword v74,v4,s[4:7],s56 offen
s_add_u32 s56,s56,8192
buffer_load_dword v75,v4,s[4:7],s56 offen
s_add_u32 s56,s56,8192
buffer_load_dword v76,v4,s[4:7],s56 offen
s_add_u32 s56,s56,8192
buffer_load_dword v77,v4,s[4:7],s56 offen
s_add_u32 s56,s56,8192
buffer_load_dword v78,v4,s[4:7],s56 offen
s_add_u32 s56,s56,8192
buffer_load_dword v79,v4,s[4:7],s56 offen
s_waitcnt vmcnt(48)
v_perm_b32 v224,v25,v24,s61
v_perm_b32 v225,v27,v26,s61
v_perm_b32 v226,v29,v28,s61
v_perm_b32 v227,v31,v30,s61
v_perm_b32 v232,v25,v24,s62
v_perm_b32 v233,v27,v26,s62
v_perm_b32 v234,v29,v28,s62
v_perm_b32 v235,v31,v30,s62
s_xor_b32 s56,s63,786432
s_add_u32 s56,s56,s58
buffer_load_dword v24,v4,s[4:7],s56 offen
s_add_u32 s56,s56,8192
buffer_load_dword v25,v4,s[4:7],s56 offen
s_add_u32 s56,s56,8192
buffer_load_dword v26,v4,s[4:7],s56 offen
s_add_u32 s56,s56,8192
buffer_load_dword v27,v4,s[4:7],s56 offen
s_add_u32 s56,s56,8192
buffer_load_dword v28,v4,s[4:7],s56 offen
s_add_u32 s56,s56,8192
buffer_load_dword v29,v4,s[4:7],s56 offen
s_add_u32 s56,s56,8192
buffer_load_dword v30,v4,s[4:7],s56 offen
s_add_u32 s56,s56,8192
buffer_load_dword v31,v4,s[4:7],s56 offen
s_waitcnt vmcnt(48)
v_perm_b32 v228,v33,v32,s61
v_perm_b32 v229,v35,v34,s61
v_perm_b32 v230,v37,v36,s61
v_perm_b32 v231,v39,v38,s61
v_perm_b32 v236,v33,v32,s62
v_perm_b32 v237,v35,v34,s62
v_perm_b32 v238,v37,v36,s62
v_perm_b32 v239,v39,v38,s62
s_xor_b32 s56,s63,1048576
s_add_u32 s56,s56,s58
buffer_load_dword v32,v4,s[4:7],s56 offen
s_add_u32 s56,s56,8192
buffer_load_dword v33,v4,s[4:7],s56 offen
s_add_u32 s56,s56,8192
buffer_load_dword v34,v4,s[4:7],s56 offen
s_add_u32 s56,s56,8192
buffer_load_dword v35,v4,s[4:7],s56 offen
s_add_u32 s56,s56,8192
buffer_load_dword v36,v4,s[4:7],s56 offen
s_add_u32 s56,s56,8192
buffer_load_dword v37,v4,s[4:7],s56 offen
s_add_u32 s56,s56,8192
buffer_load_dword v38,v4,s[4:7],s56 offen
s_add_u32 s56,s56,8192
buffer_load_dword v39,v4,s[4:7],s56 offen
s_waitcnt vmcnt(48)
v_perm_b32 v240,v41,v40,s61
v_perm_b32 v241,v43,v42,s61
v_perm_b32 v242,v45,v44,s61
v_perm_b32 v243,v47,v46,s61
v_perm_b32 v248,v41,v40,s62
v_perm_b32 v249,v43,v42,s62
v_perm_b32 v250,v45,v44,s62
v_perm_b32 v251,v47,v46,s62
s_xor_b32 s56,s63,1310720
s_add_u32 s56,s56,s58
buffer_load_dword v40,v4,s[4:7],s56 offen
s_add_u32 s56,s56,8192
buffer_load_dword v41,v4,s[4:7],s56 offen
s_add_u32 s56,s56,8192
buffer_load_dword v42,v4,s[4:7],s56 offen
s_add_u32 s56,s56,8192
buffer_load_dword v43,v4,s[4:7],s56 offen
s_add_u32 s56,s56,8192
buffer_load_dword v44,v4,s[4:7],s56 offen
s_add_u32 s56,s56,8192
buffer_load_dword v45,v4,s[4:7],s56 offen
s_add_u32 s56,s56,8192
buffer_load_dword v46,v4,s[4:7],s56 offen
s_add_u32 s56,s56,8192
buffer_load_dword v47,v4,s[4:7],s56 offen
s_waitcnt vmcnt(48)
v_perm_b32 v244,v49,v48,s61
v_perm_b32 v245,v51,v50,s61
v_perm_b32 v246,v53,v52,s61
v_perm_b32 v247,v55,v54,s61
v_perm_b32 v252,v49,v48,s62
v_perm_b32 v253,v51,v50,s62
v_perm_b32 v254,v53,v52,s62
v_perm_b32 v255,v55,v54,s62
s_xor_b32 s56,s63,1572864
s_add_u32 s56,s56,s58
buffer_load_dword v48,v4,s[4:7],s56 offen
s_add_u32 s56,s56,8192
buffer_load_dword v49,v4,s[4:7],s56 offen
s_add_u32 s56,s56,8192
buffer_load_dword v50,v4,s[4:7],s56 offen
s_add_u32 s56,s56,8192
buffer_load_dword v51,v4,s[4:7],s56 offen
s_add_u32 s56,s56,8192
buffer_load_dword v52,v4,s[4:7],s56 offen
s_add_u32 s56,s56,8192
buffer_load_dword v53,v4,s[4:7],s56 offen
s_add_u32 s56,s56,8192
buffer_load_dword v54,v4,s[4:7],s56 offen
s_add_u32 s56,s56,8192
buffer_load_dword v55,v4,s[4:7],s56 offen
s_waitcnt vmcnt(48)
v_perm_b32 v80,v57,v56,s61
v_perm_b32 v81,v59,v58,s61
v_perm_b32 v82,v61,v60,s61
v_perm_b32 v83,v63,v62,s61
v_perm_b32 v84,v57,v56,s62
v_perm_b32 v85,v59,v58,s62
v_perm_b32 v86,v61,v60,s62
v_perm_b32 v87,v63,v62,s62
v_accvgpr_write_b32 a0,v80
v_accvgpr_write_b32 a1,v81
v_accvgpr_write_b32 a2,v82
v_accvgpr_write_b32 a3,v83
v_accvgpr_write_b32 a8,v84
v_accvgpr_write_b32 a9,v85
v_accvgpr_write_b32 a10,v86
v_accvgpr_write_b32 a11,v87
s_xor_b32 s56,s63,1835008
s_add_u32 s56,s56,s58
buffer_load_dword v56,v4,s[4:7],s56 offen
s_add_u32 s56,s56,8192
buffer_load_dword v57,v4,s[4:7],s56 offen
s_add_u32 s56,s56,8192
buffer_load_dword v58,v4,s[4:7],s56 offen
s_add_u32 s56,s56,8192
buffer_load_dword v59,v4,s[4:7],s56 offen
s_add_u32 s56,s56,8192
buffer_load_dword v60,v4,s[4:7],s56 offen
s_add_u32 s56,s56,8192
buffer_load_dword v61,v4,s[4:7],s56 offen
s_add_u32 s56,s56,8192
buffer_load_dword v62,v4,s[4:7],s56 offen
s_add_u32 s56,s56,8192
buffer_load_dword v63,v4,s[4:7],s56 offen
s_waitcnt vmcnt(48)
v_perm_b32 v80,v65,v64,s61
v_perm_b32 v81,v67,v66,s61
v_perm_b32 v82,v69,v68,s61
v_perm_b32 v83,v71,v70,s61
v_perm_b32 v84,v65,v64,s62
v_perm_b32 v85,v67,v66,s62
v_perm_b32 v86,v69,v68,s62
v_perm_b32 v87,v71,v70,s62
v_accvgpr_write_b32 a4,v80
v_accvgpr_write_b32 a5,v81
v_accvgpr_write_b32 a6,v82
v_accvgpr_write_b32 a7,v83
v_accvgpr_write_b32 a12,v84
v_accvgpr_write_b32 a13,v85
v_accvgpr_write_b32 a14,v86
v_accvgpr_write_b32 a15,v87
s_xor_b32 s56,s63,2097152
s_add_u32 s56,s56,s58
buffer_load_dword v64,v4,s[4:7],s56 offen
s_add_u32 s56,s56,8192
buffer_load_dword v65,v4,s[4:7],s56 offen
s_add_u32 s56,s56,8192
buffer_load_dword v66,v4,s[4:7],s56 offen
s_add_u32 s56,s56,8192
buffer_load_dword v67,v4,s[4:7],s56 offen
s_add_u32 s56,s56,8192
buffer_load_dword v68,v4,s[4:7],s56 offen
s_add_u32 s56,s56,8192
buffer_load_dword v69,v4,s[4:7],s56 offen
s_add_u32 s56,s56,8192
buffer_load_dword v70,v4,s[4:7],s56 offen
s_add_u32 s56,s56,8192
buffer_load_dword v71,v4,s[4:7],s56 offen
s_waitcnt vmcnt(48)
v_perm_b32 v80,v73,v72,s61
v_perm_b32 v81,v75,v74,s61
v_perm_b32 v82,v77,v76,s61
v_perm_b32 v83,v79,v78,s61
v_perm_b32 v84,v73,v72,s62
v_perm_b32 v85,v75,v74,s62
v_perm_b32 v86,v77,v76,s62
v_perm_b32 v87,v79,v78,s62
v_accvgpr_write_b32 a16,v80
v_accvgpr_write_b32 a17,v81
v_accvgpr_write_b32 a18,v82
v_accvgpr_write_b32 a19,v83
v_accvgpr_write_b32 a24,v84
v_accvgpr_write_b32 a25,v85
v_accvgpr_write_b32 a26,v86
v_accvgpr_write_b32 a27,v87
s_xor_b32 s56,s63,2359296
s_add_u32 s56,s56,s58
buffer_load_dword v72,v4,s[4:7],s56 offen
s_add_u32 s56,s56,8192
buffer_load_dword v73,v4,s[4:7],s56 offen
s_add_u32 s56,s56,8192
buffer_load_dword v74,v4,s[4:7],s56 offen
s_add_u32 s56,s56,8192
buffer_load_dword v75,v4,s[4:7],s56 offen
s_add_u32 s56,s56,8192
buffer_load_dword v76,v4,s[4:7],s56 offen
s_add_u32 s56,s56,8192
buffer_load_dword v77,v4,s[4:7],s56 offen
s_add_u32 s56,s56,8192
buffer_load_dword v78,v4,s[4:7],s56 offen
s_add_u32 s56,s56,8192
buffer_load_dword v79,v4,s[4:7],s56 offen
s_waitcnt vmcnt(48)
v_perm_b32 v80,v25,v24,s61
v_perm_b32 v81,v27,v26,s61
v_perm_b32 v82,v29,v28,s61
v_perm_b32 v83,v31,v30,s61
v_perm_b32 v84,v25,v24,s62
v_perm_b32 v85,v27,v26,s62
v_perm_b32 v86,v29,v28,s62
v_perm_b32 v87,v31,v30,s62
v_accvgpr_write_b32 a20,v80
v_accvgpr_write_b32 a21,v81
v_accvgpr_write_b32 a22,v82
v_accvgpr_write_b32 a23,v83
v_accvgpr_write_b32 a28,v84
v_accvgpr_write_b32 a29,v85
v_accvgpr_write_b32 a30,v86
v_accvgpr_write_b32 a31,v87
s_xor_b32 s56,s63,2621440
s_add_u32 s56,s56,s58
buffer_load_dword v24,v4,s[4:7],s56 offen
s_add_u32 s56,s56,8192
buffer_load_dword v25,v4,s[4:7],s56 offen
s_add_u32 s56,s56,8192
buffer_load_dword v26,v4,s[4:7],s56 offen
s_add_u32 s56,s56,8192
buffer_load_dword v27,v4,s[4:7],s56 offen
s_add_u32 s56,s56,8192
buffer_load_dword v28,v4,s[4:7],s56 offen
s_add_u32 s56,s56,8192
buffer_load_dword v29,v4,s[4:7],s56 offen
s_add_u32 s56,s56,8192
buffer_load_dword v30,v4,s[4:7],s56 offen
s_add_u32 s56,s56,8192
buffer_load_dword v31,v4,s[4:7],s56 offen
s_waitcnt vmcnt(48)
v_perm_b32 v80,v33,v32,s61
v_perm_b32 v81,v35,v34,s61
v_perm_b32 v82,v37,v36,s61
v_perm_b32 v83,v39,v38,s61
v_perm_b32 v84,v33,v32,s62
v_perm_b32 v85,v35,v34,s62
v_perm_b32 v86,v37,v36,s62
v_perm_b32 v87,v39,v38,s62
v_accvgpr_write_b32 a32,v80
v_accvgpr_write_b32 a33,v81
v_accvgpr_write_b32 a34,v82
v_accvgpr_write_b32 a35,v83
v_accvgpr_write_b32 a40,v84
v_accvgpr_write_b32 a41,v85
v_accvgpr_write_b32 a42,v86
v_accvgpr_write_b32 a43,v87
s_xor_b32 s56,s63,2883584
s_add_u32 s56,s56,s58
buffer_load_dword v32,v4,s[4:7],s56 offen
s_add_u32 s56,s56,8192
buffer_load_dword v33,v4,s[4:7],s56 offen
s_add_u32 s56,s56,8192
buffer_load_dword v34,v4,s[4:7],s56 offen
s_add_u32 s56,s56,8192
buffer_load_dword v35,v4,s[4:7],s56 offen
s_add_u32 s56,s56,8192
buffer_load_dword v36,v4,s[4:7],s56 offen
s_add_u32 s56,s56,8192
buffer_load_dword v37,v4,s[4:7],s56 offen
s_add_u32 s56,s56,8192
buffer_load_dword v38,v4,s[4:7],s56 offen
s_add_u32 s56,s56,8192
buffer_load_dword v39,v4,s[4:7],s56 offen
s_waitcnt vmcnt(48)
v_perm_b32 v80,v41,v40,s61
v_perm_b32 v81,v43,v42,s61
v_perm_b32 v82,v45,v44,s61
v_perm_b32 v83,v47,v46,s61
v_perm_b32 v84,v41,v40,s62
v_perm_b32 v85,v43,v42,s62
v_perm_b32 v86,v45,v44,s62
v_perm_b32 v87,v47,v46,s62
v_accvgpr_write_b32 a36,v80
v_accvgpr_write_b32 a37,v81
v_accvgpr_write_b32 a38,v82
v_accvgpr_write_b32 a39,v83
v_accvgpr_write_b32 a44,v84
v_accvgpr_write_b32 a45,v85
v_accvgpr_write_b32 a46,v86
v_accvgpr_write_b32 a47,v87
s_xor_b32 s56,s63,3145728
s_add_u32 s56,s56,s58
buffer_load_dword v40,v4,s[4:7],s56 offen
s_add_u32 s56,s56,8192
buffer_load_dword v41,v4,s[4:7],s56 offen
s_add_u32 s56,s56,8192
buffer_load_dword v42,v4,s[4:7],s56 offen
s_add_u32 s56,s56,8192
buffer_load_dword v43,v4,s[4:7],s56 offen
s_add_u32 s56,s56,8192
buffer_load_dword v44,v4,s[4:7],s56 offen
s_add_u32 s56,s56,8192
buffer_load_dword v45,v4,s[4:7],s56 offen
s_add_u32 s56,s56,8192
buffer_load_dword v46,v4,s[4:7],s56 offen
s_add_u32 s56,s56,8192
buffer_load_dword v47,v4,s[4:7],s56 offen
s_waitcnt vmcnt(48)
v_perm_b32 v80,v49,v48,s61
v_perm_b32 v81,v51,v50,s61
v_perm_b32 v82,v53,v52,s61
v_perm_b32 v83,v55,v54,s61
v_perm_b32 v84,v49,v48,s62
v_perm_b32 v85,v51,v50,s62
v_perm_b32 v86,v53,v52,s62
v_perm_b32 v87,v55,v54,s62
v_accvgpr_write_b32 a48,v80
v_accvgpr_write_b32 a49,v81
v_accvgpr_write_b32 a50,v82
v_accvgpr_write_b32 a51,v83
v_accvgpr_write_b32 a56,v84
v_accvgpr_write_b32 a57,v85
v_accvgpr_write_b32 a58,v86
v_accvgpr_write_b32 a59,v87
s_xor_b32 s56,s63,3407872
s_add_u32 s56,s56,s58
buffer_load_dword v48,v4,s[4:7],s56 offen
s_add_u32 s56,s56,8192
buffer_load_dword v49,v4,s[4:7],s56 offen
s_add_u32 s56,s56,8192
buffer_load_dword v50,v4,s[4:7],s56 offen
s_add_u32 s56,s56,8192
buffer_load_dword v51,v4,s[4:7],s56 offen
s_add_u32 s56,s56,8192
buffer_load_dword v52,v4,s[4:7],s56 offen
s_add_u32 s56,s56,8192
buffer_load_dword v53,v4,s[4:7],s56 offen
s_add_u32 s56,s56,8192
buffer_load_dword v54,v4,s[4:7],s56 offen
s_add_u32 s56,s56,8192
buffer_load_dword v55,v4,s[4:7],s56 offen
s_waitcnt vmcnt(48)
v_perm_b32 v80,v57,v56,s61
v_perm_b32 v81,v59,v58,s61
v_perm_b32 v82,v61,v60,s61
v_perm_b32 v83,v63,v62,s61
v_perm_b32 v84,v57,v56,s62
v_perm_b32 v85,v59,v58,s62
v_perm_b32 v86,v61,v60,s62
v_perm_b32 v87,v63,v62,s62
v_accvgpr_write_b32 a52,v80
v_accvgpr_write_b32 a53,v81
v_accvgpr_write_b32 a54,v82
v_accvgpr_write_b32 a55,v83
v_accvgpr_write_b32 a60,v84
v_accvgpr_write_b32 a61,v85
v_accvgpr_write_b32 a62,v86
v_accvgpr_write_b32 a63,v87
s_xor_b32 s56,s63,3670016
s_add_u32 s56,s56,s58
buffer_load_dword v56,v4,s[4:7],s56 offen
s_add_u32 s56,s56,8192
buffer_load_dword v57,v4,s[4:7],s56 offen
s_add_u32 s56,s56,8192
buffer_load_dword v58,v4,s[4:7],s56 offen
s_add_u32 s56,s56,8192
buffer_load_dword v59,v4,s[4:7],s56 offen
s_add_u32 s56,s56,8192
buffer_load_dword v60,v4,s[4:7],s56 offen
s_add_u32 s56,s56,8192
buffer_load_dword v61,v4,s[4:7],s56 offen
s_add_u32 s56,s56,8192
buffer_load_dword v62,v4,s[4:7],s56 offen
s_add_u32 s56,s56,8192
buffer_load_dword v63,v4,s[4:7],s56 offen
s_waitcnt vmcnt(48)
v_perm_b32 v80,v65,v64,s61
v_perm_b32 v81,v67,v66,s61
v_perm_b32 v82,v69,v68,s61
v_perm_b32 v83,v71,v70,s61
v_perm_b32 v84,v65,v64,s62
v_perm_b32 v85,v67,v66,s62
v_perm_b32 v86,v69,v68,s62
v_perm_b32 v87,v71,v70,s62
v_accvgpr_write_b32 a64,v80
v_accvgpr_write_b32 a65,v81
v_accvgpr_write_b32 a66,v82
v_accvgpr_write_b32 a67,v83
v_accvgpr_write_b32 a72,v84
v_accvgpr_write_b32 a73,v85
v_accvgpr_write_b32 a74,v86
v_accvgpr_write_b32 a75,v87
s_xor_b32 s56,s63,3932160
s_add_u32 s56,s56,s58
buffer_load_dword v64,v4,s[4:7],s56 offen
s_add_u32 s56,s56,8192
buffer_load_dword v65,v4,s[4:7],s56 offen
s_add_u32 s56,s56,8192
buffer_load_dword v66,v4,s[4:7],s56 offen
s_add_u32 s56,s56,8192
buffer_load_dword v67,v4,s[4:7],s56 offen
s_add_u32 s56,s56,8192
buffer_load_dword v68,v4,s[4:7],s56 offen
s_add_u32 s56,s56,8192
buffer_load_dword v69,v4,s[4:7],s56 offen
s_add_u32 s56,s56,8192
buffer_load_dword v70,v4,s[4:7],s56 offen
s_add_u32 s56,s56,8192
buffer_load_dword v71,v4,s[4:7],s56 offen
s_waitcnt vmcnt(48)
v_perm_b32 v80,v73,v72,s61
v_perm_b32 v81,v75,v74,s61
v_perm_b32 v82,v77,v76,s61
v_perm_b32 v83,v79,v78,s61
v_perm_b32 v84,v73,v72,s62
v_perm_b32 v85,v75,v74,s62
v_perm_b32 v86,v77,v76,s62
v_perm_b32 v87,v79,v78,s62
v_accvgpr_write_b32 a68,v80
v_accvgpr_write_b32 a69,v81
v_accvgpr_write_b32 a70,v82
v_accvgpr_write_b32 a71,v83
v_accvgpr_write_b32 a76,v84
v_accvgpr_write_b32 a77,v85
v_accvgpr_write_b32 a78,v86
v_accvgpr_write_b32 a79,v87
s_waitcnt vmcnt(40)
v_perm_b32 v80,v25,v24,s61
v_perm_b32 v81,v27,v26,s61
v_perm_b32 v82,v29,v28,s61
v_perm_b32 v83,v31,v30,s61
v_perm_b32 v84,v25,v24,s62
v_perm_b32 v85,v27,v26,s62
v_perm_b32 v86,v29,v28,s62
v_perm_b32 v87,v31,v30,s62
v_accvgpr_write_b32 a80,v80
v_accvgpr_write_b32 a81,v81
v_accvgpr_write_b32 a82,v82
v_accvgpr_write_b32 a83,v83
v_accvgpr_write_b32 a88,v84
v_accvgpr_write_b32 a89,v85
v_accvgpr_write_b32 a90,v86
v_accvgpr_write_b32 a91,v87
s_waitcnt vmcnt(32)
v_perm_b32 v80,v33,v32,s61
v_perm_b32 v81,v35,v34,s61
v_perm_b32 v82,v37,v36,s61
v_perm_b32 v83,v39,v38,s61
v_perm_b32 v84,v33,v32,s62
v_perm_b32 v85,v35,v34,s62
v_perm_b32 v86,v37,v36,s62
v_perm_b32 v87,v39,v38,s62
v_accvgpr_write_b32 a84,v80
v_accvgpr_write_b32 a85,v81
v_accvgpr_write_b32 a86,v82
v_accvgpr_write_b32 a87,v83
v_accvgpr_write_b32 a92,v84
v_accvgpr_write_b32 a93,v85
v_accvgpr_write_b32 a94,v86
v_accvgpr_write_b32 a95,v87
s_waitcnt vmcnt(24)
v_perm_b32 v80,v41,v40,s61
v_perm_b32 v81,v43,v42,s61
v_perm_b32 v82,v45,v44,s61
v_perm_b32 v83,v47,v46,s61
v_perm_b32 v84,v41,v40,s62
v_perm_b32 v85,v43,v42,s62
v_perm_b32 v86,v45,v44,s62
v_perm_b32 v87,v47,v46,s62
v_accvgpr_write_b32 a96,v80
v_accvgpr_write_b32 a97,v81
v_accvgpr_write_b32 a98,v82
v_accvgpr_write_b32 a99,v83
v_accvgpr_write_b32 a104,v84
v_accvgpr_write_b32 a105,v85
v_accvgpr_write_b32 a106,v86
v_accvgpr_write_b32 a107,v87
s_waitcnt vmcnt(16)
v_perm_b32 v80,v49,v48,s61
v_perm_b32 v81,v51,v50,s61
v_perm_b32 v82,v53,v52,s61
v_perm_b32 v83,v55,v54,s61
v_perm_b32 v84,v49,v48,s62
v_perm_b32 v85,v51,v50,s62
v_perm_b32 v86,v53,v52,s62
v_perm_b32 v87,v55,v54,s62
v_accvgpr_write_b32 a100,v80
v_accvgpr_write_b32 a101,v81
v_accvgpr_write_b32 a102,v82
v_accvgpr_write_b32 a103,v83
v_accvgpr_write_b32 a108,v84
v_accvgpr_write_b32 a109,v85
v_accvgpr_write_b32 a110,v86
v_accvgpr_write_b32 a111,v87
s_waitcnt vmcnt(8)
v_perm_b32 v80,v57,v56,s61
v_perm_b32 v81,v59,v58,s61
v_perm_b32 v82,v61,v60,s61
v_perm_b32 v83,v63,v62,s61
v_perm_b32 v84,v57,v56,s62
v_perm_b32 v85,v59,v58,s62
v_perm_b32 v86,v61,v60,s62
v_perm_b32 v87,v63,v62,s62
v_accvgpr_write_b32 a112,v80
v_accvgpr_write_b32 a113,v81
v_accvgpr_write_b32 a114,v82
v_accvgpr_write_b32 a115,v83
v_accvgpr_write_b32 a120,v84
v_accvgpr_write_b32 a121,v85
v_accvgpr_write_b32 a122,v86
v_accvgpr_write_b32 a123,v87
s_waitcnt vmcnt(0)
v_perm_b32 v80,v65,v64,s61
v_perm_b32 v81,v67,v66,s61
v_perm_b32 v82,v69,v68,s61
v_perm_b32 v83,v71,v70,s61
v_perm_b32 v84,v65,v64,s62
v_perm_b32 v85,v67,v66,s62
v_perm_b32 v86,v69,v68,s62
v_perm_b32 v87,v71,v70,s62
v_accvgpr_write_b32 a116,v80
v_accvgpr_write_b32 a117,v81
v_accvgpr_write_b32 a118,v82
v_accvgpr_write_b32 a119,v83
v_accvgpr_write_b32 a124,v84
v_accvgpr_write_b32 a125,v85
v_accvgpr_write_b32 a126,v86
v_accvgpr_write_b32 a127,v87
s_cmp_lt_u32 s48,3
s_cbranch_scc1 L_rch_4
s_cmp_eq_u32 s48,3
s_cbranch_scc1 L_rm_5
v_mov_b32 v123,159744
s_cmp_lg_u32 s46,0
s_cbranch_scc1 L_gbd_12
v_mov_b32 v124,128
L_gb_11:
buffer_load_dword v125,v124,s[12:15],0 offen sc1
s_waitcnt vmcnt(0)
v_readfirstlane_b32 s56,v125
ds_write_b32 v123,v125
s_bitcmp1_b32 s56,8
s_cbranch_scc1 L_gbd_12
s_sleep 4
s_sub_u32 s49,s49,1
s_cmp_gt_i32 s49,0
s_cbranch_scc1 L_gb_11
s_branch L_abort
L_gbd_12:
s_waitcnt lgkmcnt(0)
s_barrier
ds_read_b32 v125,v123
s_waitcnt lgkmcnt(0)
v_readfirstlane_b32 s56,v125
s_barrier
s_lshr_b32 s56,s56,16
s_andn2_b32 s56,s56,s3
s_cbranch_scc1 L_spread
v_and_b32 v120,15,v1
v_lshrrev_b32 v121,4,v1
v_mov_b32 v17,1
s_lshl_b32 s56,s46,15
v_add_u32 v18,s56,v0
s_lshl_b32 s56,s46,2
v_add_u32 v125,s56,v121
v_xor_b32 v126,v125,v120
v_lshlrev_b32 v126,4,v126
v_lshl_add_u32 v20,v125,10,v126
v_add_u32 v125,0,v121
v_xor_b32 v125,v125,v120
v_lshlrev_b32 v125,4,v125
v_lshl_add_u32 v125,v120,8,v125
v_add_u32 v4,65536,v125
v_add_u32 v125,4,v121
v_xor_b32 v125,v125,v120
v_lshlrev_b32 v125,4,v125
v_lshl_add_u32 v125,v120,8,v125
v_add_u32 v5,65536,v125
v_add_u32 v125,8,v121
v_xor_b32 v125,v125,v120
v_lshlrev_b32 v125,4,v125
v_lshl_add_u32 v125,v120,8,v125
v_add_u32 v6,65536,v125
v_add_u32 v125,12,v121
v_xor_b32 v125,v125,v120
v_lshlrev_b32 v125,4,v125
v_lshl_add_u32 v125,v120,8,v125
v_add_u32 v7,65536,v125
v_lshlrev_b32 v21,5,v120
v_and_b32 v125,1,v121
v_lshl_add_u32 v21,v125,4,v21
s_lshl_b32 s56,s46,9
v_lshrrev_b32 v125,1,v121
v_lshl_add_u32 v21,v125,11,v21
s_add_u32 s56,s56,155648
v_add_u32 v21,s56,v21
v_lshlrev_b32 v22,4,v120
v_lshl_add_u32 v22,v121,10,v22
s_lshl_b32 s56,s46,8
v_add_u32 v22,s56,v22
s_sub_u32 s54,s48,4
s_cmp_eq_u32 s54,0
s_mov_b32 s72,536914602
s_mov_b32 s73,1227133513
s_cmov_b32 s72,2415940949
s_cmov_b32 s73,613566756
s_mov_b32 s70,0x80000000
s_mov_b32 s53,7
s_mov_b32 s74,s50
s_xor_b32 s75,s74,32768
v_and_b32 v23,31,v1
v_lshlrev_b32 v23,2,v23
v_mov_b32 v19,s50
v_mov_b32 v16,0
s_ff1_i32_b64 s55,s[72:73]
s_bitset0_b64 s[72:73],s55
s_min_u32 s55,s55,127
s_lshl_b32 s68,s55,15
s_add_u32 s68,s68,0
s_add_u32 s69,s68,16384
s_add_u32 m0,s75,65536
s_nop 0
buffer_load_dwordx4 v20,s[8:11],s68 offen offset:0 sc1 lds
s_add_u32 m0,s75,69632
s_nop 0
buffer_load_dwordx4 v20,s[8:11],s69 offen offset:0 sc1 lds
s_add_u32 m0,s75,73472
s_nop 0
buffer_load_dwordx4 v20,s[8:11],s68 offen offset:256 sc1 lds
s_add_u32 m0,s75,77568
s_nop 0
buffer_load_dwordx4 v20,s[8:11],s69 offen offset:256 sc1 lds
s_add_u32 m0,s75,81408
s_nop 0
buffer_load_dwordx4 v20,s[8:11],s68 offen offset:512 sc1 lds
s_add_u32 m0,s75,85504
s_nop 0
buffer_load_dwordx4 v20,s[8:11],s69 offen offset:512 sc1 lds
s_add_u32 m0,s75,89344
s_nop 0
buffer_load_dwordx4 v20,s[8:11],s68 offen offset:768 sc1 lds
s_add_u32 m0,s75,93440
s_nop 0
buffer_load_dwordx4 v20,s[8:11],s69 offen offset:768 sc1 lds
s_waitcnt vmcnt(0)
s_barrier
L_p_13:
s_mov_b32 s75,s74
s_xor_b32 s74,s74,32768
v_xor_b32 v4,32768,v4
v_xor_b32 v5,32768,v5
v_xor_b32 v6,32768,v6
v_xor_b32 v7,32768,v7
s_mov_b32 s51,s55
s_sub_u32 s53,s53,1
s_ff1_i32_b64 s55,s[72:73]
s_bitset0_b64 s[72:73],s55
s_min_u32 s55,s55,127
s_lshl_b32 s58,s51,5
s_add_u32 s58,s58,s47
s_mul_i32 s58,s58,24576
s_add_u32 s58,s58,100663296
s_add_u32 s61,s58,s50
s_add_u32 s62,s61,4096
s_add_u32 s63,s61,16384
s_add_u32 s64,s61,20480
s_add_u32 s65,s61,s50
s_add_u32 s65,s65,8192
ds_read_b128 v[104:107],v4 offset:0
ds_read_b128 v[108:111],v4 offset:4096
ds_read_b128 v[112:115],v5 offset:0
ds_read_b128 v[116:119],v5 offset:4096
s_waitcnt lgkmcnt(2)
v_mfma_f32_16x16x32_bf16 v[24:27],a[128:131],v[104:107],0
ds_read_b128 v[120:123],v6 offset:0
v_mfma_f32_16x16x32_bf16 v[40:43],v[104:107],v[128:131],0
v_mfma_f32_16x16x32_bf16 v[28:31],a[128:131],v[108:111],0
ds_read_b128 v[124:127],v6 offset:4096
v_mfma_f32_16x16x32_bf16 v[44:47],v[108:111],v[128:131],0
v_mfma_f32_16x16x32_bf16 v[32:35],a[136:139],v[104:107],0
v_mfma_f32_16x16x32_bf16 v[48:51],v[104:107],v[136:139],0
v_mfma_f32_16x16x32_bf16 v[36:39],a[136:139],v[108:111],0
v_mfma_f32_16x16x32_bf16 v[52:55],v[108:111],v[136:139],0
s_waitcnt lgkmcnt(2)
v_mfma_f32_16x16x32_bf16 v[24:27],a[132:135],v[112:115],v[24:27]
ds_read_b128 v[104:107],v7 offset:0
v_mfma_f32_16x16x32_bf16 v[40:43],v[112:115],v[132:135],v[40:43]
v_mfma_f32_16x16x32_bf16 v[28:31],a[132:135],v[116:119],v[28:31]
ds_read_b128 v[108:111],v7 offset:4096
v_mfma_f32_16x16x32_bf16 v[44:47],v[116:119],v[132:135],v[44:47]
v_mfma_f32_16x16x32_bf16 v[32:35],a[140:143],v[112:115],v[32:35]
v_mfma_f32_16x16x32_bf16 v[48:51],v[112:115],v[140:143],v[48:51]
v_mfma_f32_16x16x32_bf16 v[36:39],a[140:143],v[116:119],v[36:39]
v_mfma_f32_16x16x32_bf16 v[52:55],v[116:119],v[140:143],v[52:55]
s_waitcnt lgkmcnt(2)
v_mfma_f32_16x16x32_bf16 v[24:27],a[144:147],v[120:123],v[24:27]
ds_read_b128 v[112:115],v4 offset:8192
v_mfma_f32_16x16x32_bf16 v[40:43],v[120:123],v[144:147],v[40:43]
v_mfma_f32_16x16x32_bf16 v[28:31],a[144:147],v[124:127],v[28:31]
ds_read_b128 v[116:119],v4 offset:12288
v_mfma_f32_16x16x32_bf16 v[44:47],v[124:127],v[144:147],v[44:47]
v_mfma_f32_16x16x32_bf16 v[32:35],a[152:155],v[120:123],v[32:35]
v_mfma_f32_16x16x32_bf16 v[48:51],v[120:123],v[152:155],v[48:51]
v_mfma_f32_16x16x32_bf16 v[36:39],a[152:155],v[124:127],v[36:39]
v_mfma_f32_16x16x32_bf16 v[52:55],v[124:127],v[152:155],v[52:55]
s_waitcnt lgkmcnt(2)
v_mfma_f32_16x16x32_bf16 v[24:27],a[148:151],v[104:107],v[24:27]
ds_read_b128 v[120:123],v5 offset:8192
v_mfma_f32_16x16x32_bf16 v[40:43],v[104:107],v[148:151],v[40:43]
v_mfma_f32_16x16x32_bf16 v[28:31],a[148:151],v[108:111],v[28:31]
ds_read_b128 v[124:127],v5 offset:12288
v_mfma_f32_16x16x32_bf16 v[44:47],v[108:111],v[148:151],v[44:47]
v_mfma_f32_16x16x32_bf16 v[32:35],a[156:159],v[104:107],v[32:35]
v_mfma_f32_16x16x32_bf16 v[48:51],v[104:107],v[156:159],v[48:51]
v_mfma_f32_16x16x32_bf16 v[36:39],a[156:159],v[108:111],v[36:39]
v_mfma_f32_16x16x32_bf16 v[52:55],v[108:111],v[156:159],v[52:55]
s_waitcnt lgkmcnt(2)
v_mfma_f32_16x16x32_bf16 v[24:27],a[160:163],v[112:115],v[24:27]
ds_read_b128 v[104:107],v6 offset:8192
v_mfma_f32_16x16x32_bf16 v[40:43],v[112:115],v[160:163],v[40:43]
v_mfma_f32_16x16x32_bf16 v[28:31],a[160:163],v[116:119],v[28:31]
ds_read_b128 v[108:111],v6 offset:12288
v_mfma_f32_16x16x32_bf16 v[44:47],v[116:119],v[160:163],v[44:47]
v_mfma_f32_16x16x32_bf16 v[32:35],a[168:171],v[112:115],v[32:35]
v_mfma_f32_16x16x32_bf16 v[48:51],v[112:115],v[168:171],v[48:51]
v_mfma_f32_16x16x32_bf16 v[36:39],a[168:171],v[116:119],v[36:39]
v_mfma_f32_16x16x32_bf16 v[52:55],v[116:119],v[168:171],v[52:55]
s_waitcnt lgkmcnt(2)
v_mfma_f32_16x16x32_bf16 v[24:27],a[164:167],v[120:123],v[24:27]
ds_read_b128 v[112:115],v7 offset:8192
v_mfma_f32_16x16x32_bf16 v[40:43],v[120:123],v[164:167],v[40:43]
s_lshl_b32 s56,s54,13
v_mfma_f32_16x16x32_bf16 v[28:31],a[164:167],v[124:127],v[28:31]
ds_read_b128 v[116:119],v7 offset:12288
v_mfma_f32_16x16x32_bf16 v[44:47],v[124:127],v[164:167],v[44:47]
s_add_u32 s56,s56,10487552
v_mfma_f32_16x16x32_bf16 v[32:35],a[172:175],v[120:123],v[32:35]
s_or_b32 s56,s56,s52
v_mfma_f32_16x16x32_bf16 v[48:51],v[120:123],v[172:175],v[48:51]
buffer_load_dword v76,v23,s[8:11],s56 offen sc1
v_mfma_f32_16x16x32_bf16 v[36:39],a[172:175],v[124:127],v[36:39]
v_mfma_f32_16x16x32_bf16 v[52:55],v[124:127],v[172:175],v[52:55]
s_waitcnt lgkmcnt(2)
v_mfma_f32_16x16x32_bf16 v[24:27],a[176:179],v[104:107],v[24:27]
ds_read_b128 v[120:123],v4 offset:16384
v_mfma_f32_16x16x32_bf16 v[40:43],v[104:107],v[176:179],v[40:43]
v_mfma_f32_16x16x32_bf16 v[28:31],a[176:179],v[108:111],v[28:31]
ds_read_b128 v[124:127],v4 offset:20480
v_mfma_f32_16x16x32_bf16 v[44:47],v[108:111],v[176:179],v[44:47]
v_mfma_f32_16x16x32_bf16 v[32:35],a[184:187],v[104:107],v[32:35]
v_mfma_f32_16x16x32_bf16 v[48:51],v[104:107],v[184:187],v[48:51]
v_mfma_f32_16x16x32_bf16 v[36:39],a[184:187],v[108:111],v[36:39]
v_mfma_f32_16x16x32_bf16 v[52:55],v[108:111],v[184:187],v[52:55]
s_waitcnt lgkmcnt(2)
v_mfma_f32_16x16x32_bf16 v[24:27],a[180:183],v[112:115],v[24:27]
ds_read_b128 v[104:107],v5 offset:16384
v_mfma_f32_16x16x32_bf16 v[40:43],v[112:115],v[180:183],v[40:43]
v_mfma_f32_16x16x32_bf16 v[28:31],a[180:183],v[116:119],v[28:31]
ds_read_b128 v[108:111],v5 offset:20480
v_mfma_f32_16x16x32_bf16 v[44:47],v[116:119],v[180:183],v[44:47]
v_mfma_f32_16x16x32_bf16 v[32:35],a[188:191],v[112:115],v[32:35]
v_mfma_f32_16x16x32_bf16 v[48:51],v[112:115],v[188:191],v[48:51]
v_mfma_f32_16x16x32_bf16 v[36:39],a[188:191],v[116:119],v[36:39]
v_mfma_f32_16x16x32_bf16 v[52:55],v[116:119],v[188:191],v[52:55]
s_waitcnt lgkmcnt(2)
v_mfma_f32_16x16x32_bf16 v[24:27],a[192:195],v[120:123],v[24:27]
ds_read_b128 v[112:115],v6 offset:16384
v_mfma_f32_16x16x32_bf16 v[40:43],v[120:123],v[192:195],v[40:43]
v_mfma_f32_16x16x32_bf16 v[28:31],a[192:195],v[124:127],v[28:31]
ds_read_b128 v[116:119],v6 offset:20480
v_mfma_f32_16x16x32_bf16 v[44:47],v[124:127],v[192:195],v[44:47]
v_mfma_f32_16x16x32_bf16 v[32:35],a[200:203],v[120:123],v[32:35]
v_mfma_f32_16x16x32_bf16 v[48:51],v[120:123],v[200:203],v[48:51]
v_mfma_f32_16x16x32_bf16 v[36:39],a[200:203],v[124:127],v[36:39]
v_mfma_f32_16x16x32_bf16 v[52:55],v[124:127],v[200:203],v[52:55]
s_waitcnt lgkmcnt(2)
v_mfma_f32_16x16x32_bf16 v[24:27],a[196:199],v[104:107],v[24:27]
ds_read_b128 v[120:123],v7 offset:16384
v_mfma_f32_16x16x32_bf16 v[40:43],v[104:107],v[196:199],v[40:43]
s_waitcnt vmcnt(0)
v_mfma_f32_16x16x32_bf16 v[28:31],a[196:199],v[108:111],v[28:31]
ds_read_b128 v[124:127],v7 offset:20480
v_mfma_f32_16x16x32_bf16 v[44:47],v[108:111],v[196:199],v[44:47]
v_cmp_eq_u32 vcc,0,v76
v_mfma_f32_16x16x32_bf16 v[32:35],a[204:207],v[104:107],v[32:35]
s_nop 0
v_mov_b32 v76,vcc_lo
v_mfma_f32_16x16x32_bf16 v[48:51],v[104:107],v[204:207],v[48:51]
ds_write_b32 v19,v76
v_mfma_f32_16x16x32_bf16 v[36:39],a[204:207],v[108:111],v[36:39]
v_mfma_f32_16x16x32_bf16 v[52:55],v[108:111],v[204:207],v[52:55]
s_waitcnt vmcnt(0) lgkmcnt(0)
s_barrier
s_or_b32 s70,s70,s52
buffer_store_dword v17,off,s[8:11],s70 sc1
ds_read_b32 v76,v16
v_mfma_f32_16x16x32_bf16 v[24:27],a[208:211],v[112:115],v[24:27]
ds_read_b128 v[104:107],v4 offset:24576
v_mfma_f32_16x16x32_bf16 v[40:43],v[112:115],v[208:211],v[40:43]
s_lshl_b32 s56,s51,5
s_add_u32 s56,s56,s47
s_lshl_b32 s56,s56,12
v_mfma_f32_16x16x32_bf16 v[28:31],a[208:211],v[116:119],v[28:31]
ds_read_b128 v[108:111],v4 offset:28672
v_mfma_f32_16x16x32_bf16 v[44:47],v[116:119],v[208:211],v[44:47]
s_add_u32 s56,s56,s50
s_add_u32 s56,s56,41943040
v_mfma_f32_16x16x32_bf16 v[32:35],a[216:219],v[112:115],v[32:35]
v_mov_b64 v[72:73],-1
v_mov_b64 v[74:75],-1
v_mfma_f32_16x16x32_bf16 v[48:51],v[112:115],v[216:219],v[48:51]
buffer_store_dwordx4 v[72:75],v0,s[8:11],s56 offen sc1
v_mfma_f32_16x16x32_bf16 v[36:39],a[216:219],v[116:119],v[36:39]
v_mfma_f32_16x16x32_bf16 v[52:55],v[116:119],v[216:219],v[52:55]
s_waitcnt lgkmcnt(2)
v_mfma_f32_16x16x32_bf16 v[24:27],a[212:215],v[120:123],v[24:27]
ds_read_b128 v[112:115],v5 offset:24576
v_mfma_f32_16x16x32_bf16 v[40:43],v[120:123],v[212:215],v[40:43]
v_readfirstlane_b32 s57,v76
v_mfma_f32_16x16x32_bf16 v[28:31],a[212:215],v[124:127],v[28:31]
ds_read_b128 v[116:119],v5 offset:28672
v_mfma_f32_16x16x32_bf16 v[44:47],v[124:127],v[212:215],v[44:47]
s_sub_u32 s59,s55,s54
s_cmp_lt_i32 s59,36
s_cselect_b32 s76,2,0
v_mfma_f32_16x16x32_bf16 v[32:35],a[220:223],v[120:123],v[32:35]
s_cmp_gt_i32 s53,0
s_cselect_b32 s76,s76,0
v_mfma_f32_16x16x32_bf16 v[48:51],v[120:123],v[220:223],v[48:51]
s_cmp_eq_u32 s57,0
s_cselect_b32 s76,1,s76
v_mfma_f32_16x16x32_bf16 v[36:39],a[220:223],v[124:127],v[36:39]
s_cmp_lt_i32 s59,12
s_cselect_b32 s76,2,s76
s_add_u32 s57,s54,64
v_mfma_f32_16x16x32_bf16 v[52:55],v[124:127],v[220:223],v[52:55]
s_cmp_eq_u32 s76,1
s_cselect_b32 s68,s57,s55
s_lshl_b32 s68,s68,15
s_waitcnt lgkmcnt(2)
v_mfma_f32_16x16x32_bf16 v[24:27],a[224:227],v[104:107],v[24:27]
ds_read_b128 v[120:123],v6 offset:24576
v_mfma_f32_16x16x32_bf16 v[40:43],v[104:107],v[224:227],v[40:43]
s_cmp_eq_u32 s76,0
s_cselect_b32 s68,0x80000000,s68
s_add_u32 s69,s68,16384
v_mfma_f32_16x16x32_bf16 v[28:31],a[224:227],v[108:111],v[28:31]
ds_read_b128 v[124:127],v6 offset:28672
v_mfma_f32_16x16x32_bf16 v[44:47],v[108:111],v[224:227],v[44:47]
s_add_u32 m0,s75,65536
v_mfma_f32_16x16x32_bf16 v[32:35],a[232:235],v[104:107],v[32:35]
buffer_load_dwordx4 v20,s[8:11],s68 offen offset:0 sc1 lds
v_mfma_f32_16x16x32_bf16 v[48:51],v[104:107],v[232:235],v[48:51]
s_add_u32 m0,s75,69632
v_mfma_f32_16x16x32_bf16 v[36:39],a[232:235],v[108:111],v[36:39]
buffer_load_dwordx4 v20,s[8:11],s69 offen offset:0 sc1 lds
v_mfma_f32_16x16x32_bf16 v[52:55],v[108:111],v[232:235],v[52:55]
s_add_u32 m0,s75,73472
s_waitcnt lgkmcnt(2)
v_mfma_f32_16x16x32_bf16 v[24:27],a[228:231],v[112:115],v[24:27]
ds_read_b128 v[104:107],v7 offset:24576
v_mfma_f32_16x16x32_bf16 v[40:43],v[112:115],v[228:231],v[40:43]
buffer_load_dwordx4 v20,s[8:11],s68 offen offset:256 sc1 lds
v_mfma_f32_16x16x32_bf16 v[28:31],a[228:231],v[116:119],v[28:31]
ds_read_b128 v[108:111],v7 offset:28672
v_mfma_f32_16x16x32_bf16 v[44:47],v[116:119],v[228:231],v[44:47]
s_add_u32 m0,s75,77568
v_mfma_f32_16x16x32_bf16 v[32:35],a[236:239],v[112:115],v[32:35]
buffer_load_dwordx4 v20,s[8:11],s69 offen offset:256 sc1 lds
v_mfma_f32_16x16x32_bf16 v[48:51],v[112:115],v[236:239],v[48:51]
s_add_u32 m0,s75,81408
v_mfma_f32_16x16x32_bf16 v[36:39],a[236:239],v[116:119],v[36:39]
buffer_load_dwordx4 v20,s[8:11],s68 offen offset:512 sc1 lds
v_mfma_f32_16x16x32_bf16 v[52:55],v[116:119],v[236:239],v[52:55]
s_add_u32 m0,s75,85504
s_waitcnt lgkmcnt(2)
v_mfma_f32_16x16x32_bf16 v[24:27],a[240:243],v[120:123],v[24:27]
ds_read_b128 v[112:115],v4 offset:0
v_mfma_f32_16x16x32_bf16 v[40:43],v[120:123],v[240:243],v[40:43]
buffer_load_dwordx4 v20,s[8:11],s69 offen offset:512 sc1 lds
v_mfma_f32_16x16x32_bf16 v[28:31],a[240:243],v[124:127],v[28:31]
ds_read_b128 v[116:119],v4 offset:4096
v_mfma_f32_16x16x32_bf16 v[44:47],v[124:127],v[240:243],v[44:47]
s_add_u32 m0,s75,89344
v_mfma_f32_16x16x32_bf16 v[32:35],a[248:251],v[120:123],v[32:35]
buffer_load_dwordx4 v20,s[8:11],s68 offen offset:768 sc1 lds
v_mfma_f32_16x16x32_bf16 v[48:51],v[120:123],v[248:251],v[48:51]
s_add_u32 m0,s75,93440
v_mfma_f32_16x16x32_bf16 v[36:39],a[248:251],v[124:127],v[36:39]
buffer_load_dwordx4 v20,s[8:11],s69 offen offset:768 sc1 lds
v_mfma_f32_16x16x32_bf16 v[52:55],v[124:127],v[248:251],v[52:55]
s_waitcnt lgkmcnt(2)
v_mfma_f32_16x16x32_bf16 v[24:27],a[244:247],v[104:107],v[24:27]
ds_read_b128 v[120:123],v5 offset:0
v_mfma_f32_16x16x32_bf16 v[40:43],v[104:107],v[244:247],v[40:43]
v_mfma_f32_16x16x32_bf16 v[28:31],a[244:247],v[108:111],v[28:31]
ds_read_b128 v[124:127],v5 offset:4096
v_mfma_f32_16x16x32_bf16 v[44:47],v[108:111],v[244:247],v[44:47]
v_mfma_f32_16x16x32_bf16 v[32:35],a[252:255],v[104:107],v[32:35]
v_mfma_f32_16x16x32_bf16 v[48:51],v[104:107],v[252:255],v[48:51]
v_mfma_f32_16x16x32_bf16 v[36:39],a[252:255],v[108:111],v[36:39]
v_mfma_f32_16x16x32_bf16 v[52:55],v[108:111],v[252:255],v[52:55]
s_waitcnt lgkmcnt(2)
v_mfma_f32_16x16x32_bf16 v[88:91],a[0:3],v[112:115],0
ds_read_b128 v[104:107],v6 offset:0
v_mfma_f32_16x16x32_bf16 v[92:95],a[0:3],v[116:119],0
v_mfma_f32_16x16x32_bf16 v[96:99],a[8:11],v[112:115],0
ds_read_b128 v[108:111],v6 offset:4096
v_mfma_f32_16x16x32_bf16 v[100:103],a[8:11],v[116:119],0
s_waitcnt lgkmcnt(2)
v_mfma_f32_16x16x32_bf16 v[88:91],a[4:7],v[120:123],v[88:91]
ds_read_b128 v[112:115],v7 offset:0
v_mfma_f32_16x16x32_bf16 v[92:95],a[4:7],v[124:127],v[92:95]
v_cvt_pk_bf16_f32 v56,v24,v32
v_cvt_pk_bf16_f32 v57,v25,v33
v_mfma_f32_16x16x32_bf16 v[96:99],a[12:15],v[120:123],v[96:99]
ds_read_b128 v[116:119],v7 offset:4096
v_mfma_f32_16x16x32_bf16 v[100:103],a[12:15],v[124:127],v[100:103]
v_cvt_pk_bf16_f32 v58,v26,v34
v_cvt_pk_bf16_f32 v59,v27,v35
s_waitcnt lgkmcnt(2)
v_mfma_f32_16x16x32_bf16 v[88:91],a[16:19],v[104:107],v[88:91]
ds_read_b128 v[120:123],v4 offset:8192
v_mfma_f32_16x16x32_bf16 v[92:95],a[16:19],v[108:111],v[92:95]
buffer_store_dwordx4 v[56:59],v0,s[8:11],s61 offen sc1
v_cvt_pk_bf16_f32 v60,v28,v36
v_mfma_f32_16x16x32_bf16 v[96:99],a[24:27],v[104:107],v[96:99]
ds_read_b128 v[124:127],v4 offset:12288
v_mfma_f32_16x16x32_bf16 v[100:103],a[24:27],v[108:111],v[100:103]
v_cvt_pk_bf16_f32 v61,v29,v37
v_cvt_pk_bf16_f32 v62,v30,v38
s_waitcnt lgkmcnt(2)
v_mfma_f32_16x16x32_bf16 v[88:91],a[20:23],v[112:115],v[88:91]
ds_read_b128 v[104:107],v5 offset:8192
v_mfma_f32_16x16x32_bf16 v[92:95],a[20:23],v[116:119],v[92:95]
v_cvt_pk_bf16_f32 v63,v31,v39
buffer_store_dwordx4 v[60:63],v0,s[8:11],s62 offen sc1
v_mfma_f32_16x16x32_bf16 v[96:99],a[28:31],v[112:115],v[96:99]
ds_read_b128 v[108:111],v5 offset:12288
v_mfma_f32_16x16x32_bf16 v[100:103],a[28:31],v[116:119],v[100:103]
v_cvt_pk_bf16_f32 v64,v40,v41
v_cvt_pk_bf16_f32 v65,v42,v43
s_waitcnt lgkmcnt(2)
v_mfma_f32_16x16x32_bf16 v[88:91],a[32:35],v[120:123],v[88:91]
ds_read_b128 v[112:115],v6 offset:8192
v_mfma_f32_16x16x32_bf16 v[92:95],a[32:35],v[124:127],v[92:95]
v_cvt_pk_bf16_f32 v66,v44,v45
v_cvt_pk_bf16_f32 v67,v46,v47
v_mfma_f32_16x16x32_bf16 v[96:99],a[40:43],v[120:123],v[96:99]
ds_read_b128 v[116:119],v6 offset:12288
v_mfma_f32_16x16x32_bf16 v[100:103],a[40:43],v[124:127],v[100:103]
buffer_store_dwordx4 v[64:67],v0,s[8:11],s65 offen offset:0 sc1
v_cvt_pk_bf16_f32 v68,v48,v49
s_waitcnt lgkmcnt(2)
v_mfma_f32_16x16x32_bf16 v[88:91],a[36:39],v[104:107],v[88:91]
ds_read_b128 v[120:123],v7 offset:8192
v_mfma_f32_16x16x32_bf16 v[92:95],a[36:39],v[108:111],v[92:95]
v_cvt_pk_bf16_f32 v69,v50,v51
v_cvt_pk_bf16_f32 v70,v52,v53
v_mfma_f32_16x16x32_bf16 v[96:99],a[44:47],v[104:107],v[96:99]
ds_read_b128 v[124:127],v7 offset:12288
v_mfma_f32_16x16x32_bf16 v[100:103],a[44:47],v[108:111],v[100:103]
v_cvt_pk_bf16_f32 v71,v54,v55
buffer_store_dwordx4 v[68:71],v0,s[8:11],s65 offen offset:1024 sc1
s_waitcnt lgkmcnt(2)
v_mfma_f32_16x16x32_bf16 v[88:91],a[48:51],v[112:115],v[88:91]
ds_read_b128 v[104:107],v4 offset:16384
v_mfma_f32_16x16x32_bf16 v[92:95],a[48:51],v[116:119],v[92:95]
v_mfma_f32_16x16x32_bf16 v[96:99],a[56:59],v[112:115],v[96:99]
ds_read_b128 v[108:111],v4 offset:20480
v_mfma_f32_16x16x32_bf16 v[100:103],a[56:59],v[116:119],v[100:103]
s_waitcnt lgkmcnt(2)
v_mfma_f32_16x16x32_bf16 v[88:91],a[52:55],v[120:123],v[88:91]
ds_read_b128 v[112:115],v5 offset:16384
v_mfma_f32_16x16x32_bf16 v[92:95],a[52:55],v[124:127],v[92:95]
v_mfma_f32_16x16x32_bf16 v[96:99],a[60:63],v[120:123],v[96:99]
ds_read_b128 v[116:119],v5 offset:20480
v_mfma_f32_16x16x32_bf16 v[100:103],a[60:63],v[124:127],v[100:103]
s_waitcnt lgkmcnt(2)
v_mfma_f32_16x16x32_bf16 v[88:91],a[64:67],v[104:107],v[88:91]
ds_read_b128 v[120:123],v6 offset:16384
v_mfma_f32_16x16x32_bf16 v[92:95],a[64:67],v[108:111],v[92:95]
v_mfma_f32_16x16x32_bf16 v[96:99],a[72:75],v[104:107],v[96:99]
ds_read_b128 v[124:127],v6 offset:20480
v_mfma_f32_16x16x32_bf16 v[100:103],a[72:75],v[108:111],v[100:103]
s_waitcnt lgkmcnt(2)
v_mfma_f32_16x16x32_bf16 v[88:91],a[68:71],v[112:115],v[88:91]
ds_read_b128 v[104:107],v7 offset:16384
v_mfma_f32_16x16x32_bf16 v[92:95],a[68:71],v[116:119],v[92:95]
v_mfma_f32_16x16x32_bf16 v[96:99],a[76:79],v[112:115],v[96:99]
ds_read_b128 v[108:111],v7 offset:20480
v_mfma_f32_16x16x32_bf16 v[100:103],a[76:79],v[116:119],v[100:103]
s_waitcnt lgkmcnt(2)
v_mfma_f32_16x16x32_bf16 v[88:91],a[80:83],v[120:123],v[88:91]
ds_read_b128 v[112:115],v4 offset:24576
v_mfma_f32_16x16x32_bf16 v[92:95],a[80:83],v[124:127],v[92:95]
v_mfma_f32_16x16x32_bf16 v[96:99],a[88:91],v[120:123],v[96:99]
ds_read_b128 v[116:119],v4 offset:28672
v_mfma_f32_16x16x32_bf16 v[100:103],a[88:91],v[124:127],v[100:103]
s_waitcnt lgkmcnt(2)
v_mfma_f32_16x16x32_bf16 v[88:91],a[84:87],v[104:107],v[88:91]
ds_read_b128 v[120:123],v5 offset:24576
v_mfma_f32_16x16x32_bf16 v[92:95],a[84:87],v[108:111],v[92:95]
v_mfma_f32_16x16x32_bf16 v[96:99],a[92:95],v[104:107],v[96:99]
ds_read_b128 v[124:127],v5 offset:28672
v_mfma_f32_16x16x32_bf16 v[100:103],a[92:95],v[108:111],v[100:103]
s_waitcnt lgkmcnt(2)
v_mfma_f32_16x16x32_bf16 v[88:91],a[96:99],v[112:115],v[88:91]
ds_read_b128 v[104:107],v6 offset:24576
v_mfma_f32_16x16x32_bf16 v[92:95],a[96:99],v[116:119],v[92:95]
v_mfma_f32_16x16x32_bf16 v[96:99],a[104:107],v[112:115],v[96:99]
ds_read_b128 v[108:111],v6 offset:28672
v_mfma_f32_16x16x32_bf16 v[100:103],a[104:107],v[116:119],v[100:103]
s_waitcnt lgkmcnt(2)
v_mfma_f32_16x16x32_bf16 v[88:91],a[100:103],v[120:123],v[88:91]
ds_read_b128 v[112:115],v7 offset:24576
v_mfma_f32_16x16x32_bf16 v[92:95],a[100:103],v[124:127],v[92:95]
v_mfma_f32_16x16x32_bf16 v[96:99],a[108:111],v[120:123],v[96:99]
ds_read_b128 v[116:119],v7 offset:28672
v_mfma_f32_16x16x32_bf16 v[100:103],a[108:111],v[124:127],v[100:103]
s_waitcnt lgkmcnt(2)
v_mfma_f32_16x16x32_bf16 v[88:91],a[112:115],v[104:107],v[88:91]
v_mfma_f32_16x16x32_bf16 v[92:95],a[112:115],v[108:111],v[92:95]
v_mfma_f32_16x16x32_bf16 v[96:99],a[120:123],v[104:107],v[96:99]
v_mfma_f32_16x16x32_bf16 v[100:103],a[120:123],v[108:111],v[100:103]
s_waitcnt lgkmcnt(0)
v_mfma_f32_16x16x32_bf16 v[88:91],a[116:119],v[112:115],v[88:91]
v_mfma_f32_16x16x32_bf16 v[92:95],a[116:119],v[116:119],v[92:95]
v_mfma_f32_16x16x32_bf16 v[96:99],a[124:127],v[112:115],v[96:99]
v_mfma_f32_16x16x32_bf16 v[100:103],a[124:127],v[116:119],v[100:103]
s_nop 3
v_cvt_pk_bf16_f32 v104,v88,v96
v_cvt_pk_bf16_f32 v105,v89,v97
v_cvt_pk_bf16_f32 v106,v90,v98
v_cvt_pk_bf16_f32 v107,v91,v99
v_cvt_pk_bf16_f32 v108,v92,v100
v_cvt_pk_bf16_f32 v109,v93,v101
v_cvt_pk_bf16_f32 v110,v94,v102
v_cvt_pk_bf16_f32 v111,v95,v103
buffer_store_dwordx4 v[104:107],v0,s[8:11],s63 offen sc1
buffer_store_dwordx4 v[108:111],v0,s[8:11],s64 offen sc1
s_waitcnt vmcnt(6)
s_barrier
s_lshl_b32 s70,s51,13
s_lshl2_add_u32 s70,s47,s70
s_add_u32 s70,s70,10485760
s_cmp_ge_u32 s51,2
s_cbranch_scc1 L_p_15
s_waitcnt vmcnt(0)
s_barrier
s_or_b32 s70,s70,s52
buffer_store_dword v17,off,s[8:11],s70 sc1
L_p_15:
s_cmp_eq_u32 s76,2
s_cbranch_scc1 L_p_13
s_mov_b32 s53,0
s_mov_b32 s51,s54
s_add_u32 s54,s54,2
s_cmp_eq_u32 s76,1
s_cbranch_scc1 L_p_14
s_waitcnt vmcnt(0)
s_barrier
s_or_b32 s70,s70,s52
buffer_store_dword v17,off,s[8:11],s70 sc1
s_mov_b32 s70,0x80000000
s_cmp_ge_u32 s51,64
s_cbranch_scc1 L_p_16
s_lshl_b32 s66,s51,15
s_add_u32 s66,s66,2097152
s_add_u32 s67,s66,16384
s_lshl_b32 s59,s51,13
s_add_u32 s59,s59,10487552
s_cmp_lg_u32 s46,0
s_cbranch_scc1 L_fd_18
v_and_b32 v124,31,v1
v_lshlrev_b32 v124,2,v124
s_branch L_ff_19
L_fw_17:
s_sleep 2
L_ff_19:
buffer_load_dword v125,v124,s[8:11],s59 offen sc1
s_sub_u32 s49,s49,1
s_cbranch_scc1 L_abort
s_waitcnt vmcnt(0)
v_cmp_eq_u32 vcc,0,v125
s_cbranch_vccnz L_fw_17
L_fd_18:
s_barrier
s_add_u32 m0,s74,65536
s_nop 0
buffer_load_dwordx4 v20,s[8:11],s66 offen offset:0 sc1 lds
s_add_u32 m0,s74,69632
s_nop 0
buffer_load_dwordx4 v20,s[8:11],s67 offen offset:0 sc1 lds
s_add_u32 m0,s74,73472
s_nop 0
buffer_load_dwordx4 v20,s[8:11],s66 offen offset:256 sc1 lds
s_add_u32 m0,s74,77568
s_nop 0
buffer_load_dwordx4 v20,s[8:11],s67 offen offset:256 sc1 lds
s_add_u32 m0,s74,81408
s_nop 0
buffer_load_dwordx4 v20,s[8:11],s66 offen offset:512 sc1 lds
s_add_u32 m0,s74,85504
s_nop 0
buffer_load_dwordx4 v20,s[8:11],s67 offen offset:512 sc1 lds
s_add_u32 m0,s74,89344
s_nop 0
buffer_load_dwordx4 v20,s[8:11],s66 offen offset:768 sc1 lds
s_add_u32 m0,s74,93440
s_nop 0
buffer_load_dwordx4 v20,s[8:11],s67 offen offset:768 sc1 lds
s_lshl_b32 s56,s54,13
s_add_u32 s56,s56,10487552
s_or_b32 s56,s56,s52
buffer_load_dword v76,v23,s[8:11],s56 offen sc1
s_lshl_b32 s58,s51,5
s_add_u32 s58,s58,s47
s_mul_i32 s58,s58,24576
s_add_u32 s58,s58,150994944
s_add_u32 s61,s58,s50
s_add_u32 s62,s61,4096
s_add_u32 s63,s61,16384
s_add_u32 s64,s61,20480
s_add_u32 s65,s61,s50
s_add_u32 s65,s65,8192
s_waitcnt vmcnt(7)
s_barrier
ds_read_b128 v[104:107],v4 offset:0
ds_read_b128 v[108:111],v4 offset:4096
ds_read_b128 v[112:115],v5 offset:0
ds_read_b128 v[116:119],v5 offset:4096
s_waitcnt lgkmcnt(2)
v_mfma_f32_16x16x32_bf16 v[24:27],a[128:131],v[104:107],0
ds_read_b128 v[120:123],v6 offset:0
v_mfma_f32_16x16x32_bf16 v[40:43],v[104:107],v[128:131],0
v_mfma_f32_16x16x32_bf16 v[28:31],a[128:131],v[108:111],0
ds_read_b128 v[124:127],v6 offset:4096
v_mfma_f32_16x16x32_bf16 v[44:47],v[108:111],v[128:131],0
v_mfma_f32_16x16x32_bf16 v[32:35],a[136:139],v[104:107],0
v_mfma_f32_16x16x32_bf16 v[48:51],v[104:107],v[136:139],0
v_mfma_f32_16x16x32_bf16 v[36:39],a[136:139],v[108:111],0
v_mfma_f32_16x16x32_bf16 v[52:55],v[108:111],v[136:139],0
s_waitcnt lgkmcnt(2)
v_mfma_f32_16x16x32_bf16 v[24:27],a[132:135],v[112:115],v[24:27]
ds_read_b128 v[104:107],v7 offset:0
v_mfma_f32_16x16x32_bf16 v[40:43],v[112:115],v[132:135],v[40:43]
v_mfma_f32_16x16x32_bf16 v[28:31],a[132:135],v[116:119],v[28:31]
ds_read_b128 v[108:111],v7 offset:4096
v_mfma_f32_16x16x32_bf16 v[44:47],v[116:119],v[132:135],v[44:47]
v_mfma_f32_16x16x32_bf16 v[32:35],a[140:143],v[112:115],v[32:35]
v_mfma_f32_16x16x32_bf16 v[48:51],v[112:115],v[140:143],v[48:51]
v_mfma_f32_16x16x32_bf16 v[36:39],a[140:143],v[116:119],v[36:39]
v_mfma_f32_16x16x32_bf16 v[52:55],v[116:119],v[140:143],v[52:55]
s_waitcnt vmcnt(5)
s_barrier
s_waitcnt lgkmcnt(2)
v_mfma_f32_16x16x32_bf16 v[24:27],a[144:147],v[120:123],v[24:27]
ds_read_b128 v[112:115],v4 offset:8192
v_mfma_f32_16x16x32_bf16 v[40:43],v[120:123],v[144:147],v[40:43]
v_mfma_f32_16x16x32_bf16 v[28:31],a[144:147],v[124:127],v[28:31]
ds_read_b128 v[116:119],v4 offset:12288
v_mfma_f32_16x16x32_bf16 v[44:47],v[124:127],v[144:147],v[44:47]
v_mfma_f32_16x16x32_bf16 v[32:35],a[152:155],v[120:123],v[32:35]
v_mfma_f32_16x16x32_bf16 v[48:51],v[120:123],v[152:155],v[48:51]
v_mfma_f32_16x16x32_bf16 v[36:39],a[152:155],v[124:127],v[36:39]
v_mfma_f32_16x16x32_bf16 v[52:55],v[124:127],v[152:155],v[52:55]
s_waitcnt lgkmcnt(2)
v_mfma_f32_16x16x32_bf16 v[24:27],a[148:151],v[104:107],v[24:27]
ds_read_b128 v[120:123],v5 offset:8192
v_mfma_f32_16x16x32_bf16 v[40:43],v[104:107],v[148:151],v[40:43]
v_mfma_f32_16x16x32_bf16 v[28:31],a[148:151],v[108:111],v[28:31]
ds_read_b128 v[124:127],v5 offset:12288
v_mfma_f32_16x16x32_bf16 v[44:47],v[108:111],v[148:151],v[44:47]
v_mfma_f32_16x16x32_bf16 v[32:35],a[156:159],v[104:107],v[32:35]
v_mfma_f32_16x16x32_bf16 v[48:51],v[104:107],v[156:159],v[48:51]
v_mfma_f32_16x16x32_bf16 v[36:39],a[156:159],v[108:111],v[36:39]
v_mfma_f32_16x16x32_bf16 v[52:55],v[108:111],v[156:159],v[52:55]
s_waitcnt lgkmcnt(2)
v_mfma_f32_16x16x32_bf16 v[24:27],a[160:163],v[112:115],v[24:27]
ds_read_b128 v[104:107],v6 offset:8192
v_mfma_f32_16x16x32_bf16 v[40:43],v[112:115],v[160:163],v[40:43]
v_mfma_f32_16x16x32_bf16 v[28:31],a[160:163],v[116:119],v[28:31]
ds_read_b128 v[108:111],v6 offset:12288
v_mfma_f32_16x16x32_bf16 v[44:47],v[116:119],v[160:163],v[44:47]
v_mfma_f32_16x16x32_bf16 v[32:35],a[168:171],v[112:115],v[32:35]
v_mfma_f32_16x16x32_bf16 v[48:51],v[112:115],v[168:171],v[48:51]
v_mfma_f32_16x16x32_bf16 v[36:39],a[168:171],v[116:119],v[36:39]
v_mfma_f32_16x16x32_bf16 v[52:55],v[116:119],v[168:171],v[52:55]
s_waitcnt lgkmcnt(2)
v_mfma_f32_16x16x32_bf16 v[24:27],a[164:167],v[120:123],v[24:27]
ds_read_b128 v[112:115],v7 offset:8192
v_mfma_f32_16x16x32_bf16 v[40:43],v[120:123],v[164:167],v[40:43]
v_mfma_f32_16x16x32_bf16 v[28:31],a[164:167],v[124:127],v[28:31]
ds_read_b128 v[116:119],v7 offset:12288
v_mfma_f32_16x16x32_bf16 v[44:47],v[124:127],v[164:167],v[44:47]
v_mfma_f32_16x16x32_bf16 v[32:35],a[172:175],v[120:123],v[32:35]
v_mfma_f32_16x16x32_bf16 v[48:51],v[120:123],v[172:175],v[48:51]
v_mfma_f32_16x16x32_bf16 v[36:39],a[172:175],v[124:127],v[36:39]
v_mfma_f32_16x16x32_bf16 v[52:55],v[124:127],v[172:175],v[52:55]
s_waitcnt vmcnt(3)
s_barrier
s_waitcnt lgkmcnt(2)
v_mfma_f32_16x16x32_bf16 v[24:27],a[176:179],v[104:107],v[24:27]
ds_read_b128 v[120:123],v4 offset:16384
v_mfma_f32_16x16x32_bf16 v[40:43],v[104:107],v[176:179],v[40:43]
v_mfma_f32_16x16x32_bf16 v[28:31],a[176:179],v[108:111],v[28:31]
ds_read_b128 v[124:127],v4 offset:20480
v_mfma_f32_16x16x32_bf16 v[44:47],v[108:111],v[176:179],v[44:47]
v_mfma_f32_16x16x32_bf16 v[32:35],a[184:187],v[104:107],v[32:35]
v_mfma_f32_16x16x32_bf16 v[48:51],v[104:107],v[184:187],v[48:51]
v_mfma_f32_16x16x32_bf16 v[36:39],a[184:187],v[108:111],v[36:39]
v_mfma_f32_16x16x32_bf16 v[52:55],v[108:111],v[184:187],v[52:55]
s_waitcnt lgkmcnt(2)
v_mfma_f32_16x16x32_bf16 v[24:27],a[180:183],v[112:115],v[24:27]
ds_read_b128 v[104:107],v5 offset:16384
v_mfma_f32_16x16x32_bf16 v[40:43],v[112:115],v[180:183],v[40:43]
v_mfma_f32_16x16x32_bf16 v[28:31],a[180:183],v[116:119],v[28:31]
ds_read_b128 v[108:111],v5 offset:20480
v_mfma_f32_16x16x32_bf16 v[44:47],v[116:119],v[180:183],v[44:47]
v_mfma_f32_16x16x32_bf16 v[32:35],a[188:191],v[112:115],v[32:35]
v_mfma_f32_16x16x32_bf16 v[48:51],v[112:115],v[188:191],v[48:51]
v_mfma_f32_16x16x32_bf16 v[36:39],a[188:191],v[116:119],v[36:39]
v_mfma_f32_16x16x32_bf16 v[52:55],v[116:119],v[188:191],v[52:55]
s_waitcnt lgkmcnt(2)
v_mfma_f32_16x16x32_bf16 v[24:27],a[192:195],v[120:123],v[24:27]
ds_read_b128 v[112:115],v6 offset:16384
v_mfma_f32_16x16x32_bf16 v[40:43],v[120:123],v[192:195],v[40:43]
v_mfma_f32_16x16x32_bf16 v[28:31],a[192:195],v[124:127],v[28:31]
ds_read_b128 v[116:119],v6 offset:20480
v_mfma_f32_16x16x32_bf16 v[44:47],v[124:127],v[192:195],v[44:47]
v_mfma_f32_16x16x32_bf16 v[32:35],a[200:203],v[120:123],v[32:35]
v_mfma_f32_16x16x32_bf16 v[48:51],v[120:123],v[200:203],v[48:51]
v_mfma_f32_16x16x32_bf16 v[36:39],a[200:203],v[124:127],v[36:39]
v_mfma_f32_16x16x32_bf16 v[52:55],v[124:127],v[200:203],v[52:55]
s_waitcnt lgkmcnt(2)
v_mfma_f32_16x16x32_bf16 v[24:27],a[196:199],v[104:107],v[24:27]
ds_read_b128 v[120:123],v7 offset:16384
v_mfma_f32_16x16x32_bf16 v[40:43],v[104:107],v[196:199],v[40:43]
s_waitcnt vmcnt(0)
v_mfma_f32_16x16x32_bf16 v[28:31],a[196:199],v[108:111],v[28:31]
ds_read_b128 v[124:127],v7 offset:20480
v_mfma_f32_16x16x32_bf16 v[44:47],v[108:111],v[196:199],v[44:47]
v_cmp_eq_u32 vcc,0,v76
v_mfma_f32_16x16x32_bf16 v[32:35],a[204:207],v[104:107],v[32:35]
s_nop 0
v_mov_b32 v76,vcc_lo
v_mfma_f32_16x16x32_bf16 v[48:51],v[104:107],v[204:207],v[48:51]
ds_write_b32 v19,v76
v_mfma_f32_16x16x32_bf16 v[36:39],a[204:207],v[108:111],v[36:39]
v_mfma_f32_16x16x32_bf16 v[52:55],v[108:111],v[204:207],v[52:55]
s_waitcnt vmcnt(0) lgkmcnt(0)
s_barrier
s_or_b32 s70,s70,s52
buffer_store_dword v17,off,s[8:11],s70 sc1
ds_read_b32 v76,v16
v_mfma_f32_16x16x32_bf16 v[24:27],a[208:211],v[112:115],v[24:27]
ds_read_b128 v[104:107],v4 offset:24576
v_mfma_f32_16x16x32_bf16 v[40:43],v[112:115],v[208:211],v[40:43]
v_mfma_f32_16x16x32_bf16 v[28:31],a[208:211],v[116:119],v[28:31]
ds_read_b128 v[108:111],v4 offset:28672
v_mfma_f32_16x16x32_bf16 v[44:47],v[116:119],v[208:211],v[44:47]
v_mfma_f32_16x16x32_bf16 v[32:35],a[216:219],v[112:115],v[32:35]
v_mfma_f32_16x16x32_bf16 v[48:51],v[112:115],v[216:219],v[48:51]
v_mfma_f32_16x16x32_bf16 v[36:39],a[216:219],v[116:119],v[36:39]
v_mfma_f32_16x16x32_bf16 v[52:55],v[116:119],v[216:219],v[52:55]
s_waitcnt lgkmcnt(2)
v_mfma_f32_16x16x32_bf16 v[24:27],a[212:215],v[120:123],v[24:27]
ds_read_b128 v[112:115],v5 offset:24576
v_mfma_f32_16x16x32_bf16 v[40:43],v[120:123],v[212:215],v[40:43]
v_readfirstlane_b32 s57,v76
v_mfma_f32_16x16x32_bf16 v[28:31],a[212:215],v[124:127],v[28:31]
ds_read_b128 v[116:119],v5 offset:28672
v_mfma_f32_16x16x32_bf16 v[44:47],v[124:127],v[212:215],v[44:47]
s_sub_u32 s59,s55,s54
s_cmp_lt_i32 s59,36
s_cselect_b32 s76,2,0
v_mfma_f32_16x16x32_bf16 v[32:35],a[220:223],v[120:123],v[32:35]
s_cmp_eq_u32 s57,0
s_cselect_b32 s76,1,s76
v_mfma_f32_16x16x32_bf16 v[48:51],v[120:123],v[220:223],v[48:51]
s_cmp_lt_i32 s59,12
s_cselect_b32 s76,2,s76
s_add_u32 s57,s54,64
v_mfma_f32_16x16x32_bf16 v[36:39],a[220:223],v[124:127],v[36:39]
s_cmp_eq_u32 s76,1
s_cselect_b32 s68,s57,s55
s_lshl_b32 s68,s68,15
v_mfma_f32_16x16x32_bf16 v[52:55],v[124:127],v[220:223],v[52:55]
s_cmp_eq_u32 s76,0
s_cselect_b32 s68,0x80000000,s68
s_add_u32 s69,s68,16384
s_waitcnt lgkmcnt(2)
v_mfma_f32_16x16x32_bf16 v[24:27],a[224:227],v[104:107],v[24:27]
ds_read_b128 v[120:123],v6 offset:24576
v_mfma_f32_16x16x32_bf16 v[40:43],v[104:107],v[224:227],v[40:43]
s_add_u32 m0,s75,65536
v_mfma_f32_16x16x32_bf16 v[28:31],a[224:227],v[108:111],v[28:31]
ds_read_b128 v[124:127],v6 offset:28672
v_mfma_f32_16x16x32_bf16 v[44:47],v[108:111],v[224:227],v[44:47]
buffer_load_dwordx4 v20,s[8:11],s68 offen offset:0 sc1 lds
v_mfma_f32_16x16x32_bf16 v[32:35],a[232:235],v[104:107],v[32:35]
s_add_u32 m0,s75,69632
v_mfma_f32_16x16x32_bf16 v[48:51],v[104:107],v[232:235],v[48:51]
buffer_load_dwordx4 v20,s[8:11],s69 offen offset:0 sc1 lds
v_mfma_f32_16x16x32_bf16 v[36:39],a[232:235],v[108:111],v[36:39]
s_add_u32 m0,s75,73472
v_mfma_f32_16x16x32_bf16 v[52:55],v[108:111],v[232:235],v[52:55]
buffer_load_dwordx4 v20,s[8:11],s68 offen offset:256 sc1 lds
s_waitcnt lgkmcnt(2)
v_mfma_f32_16x16x32_bf16 v[24:27],a[228:231],v[112:115],v[24:27]
ds_read_b128 v[104:107],v7 offset:24576
v_mfma_f32_16x16x32_bf16 v[40:43],v[112:115],v[228:231],v[40:43]
s_add_u32 m0,s75,77568
v_mfma_f32_16x16x32_bf16 v[28:31],a[228:231],v[116:119],v[28:31]
ds_read_b128 v[108:111],v7 offset:28672
v_mfma_f32_16x16x32_bf16 v[44:47],v[116:119],v[228:231],v[44:47]
buffer_load_dwordx4 v20,s[8:11],s69 offen offset:256 sc1 lds
v_mfma_f32_16x16x32_bf16 v[32:35],a[236:239],v[112:115],v[32:35]
s_add_u32 m0,s75,81408
v_mfma_f32_16x16x32_bf16 v[48:51],v[112:115],v[236:239],v[48:51]
buffer_load_dwordx4 v20,s[8:11],s68 offen offset:512 sc1 lds
v_mfma_f32_16x16x32_bf16 v[36:39],a[236:239],v[116:119],v[36:39]
s_add_u32 m0,s75,85504
v_mfma_f32_16x16x32_bf16 v[52:55],v[116:119],v[236:239],v[52:55]
buffer_load_dwordx4 v20,s[8:11],s69 offen offset:512 sc1 lds
s_waitcnt lgkmcnt(2)
v_mfma_f32_16x16x32_bf16 v[24:27],a[240:243],v[120:123],v[24:27]
ds_read_b128 v[112:115],v4 offset:0
v_mfma_f32_16x16x32_bf16 v[40:43],v[120:123],v[240:243],v[40:43]
s_add_u32 m0,s75,89344
v_mfma_f32_16x16x32_bf16 v[28:31],a[240:243],v[124:127],v[28:31]
ds_read_b128 v[116:119],v4 offset:4096
v_mfma_f32_16x16x32_bf16 v[44:47],v[124:127],v[240:243],v[44:47]
buffer_load_dwordx4 v20,s[8:11],s68 offen offset:768 sc1 lds
v_mfma_f32_16x16x32_bf16 v[32:35],a[248:251],v[120:123],v[32:35]
s_add_u32 m0,s75,93440
v_mfma_f32_16x16x32_bf16 v[48:51],v[120:123],v[248:251],v[48:51]
buffer_load_dwordx4 v20,s[8:11],s69 offen offset:768 sc1 lds
v_mfma_f32_16x16x32_bf16 v[36:39],a[248:251],v[124:127],v[36:39]
v_mfma_f32_16x16x32_bf16 v[52:55],v[124:127],v[248:251],v[52:55]
s_waitcnt lgkmcnt(2)
v_mfma_f32_16x16x32_bf16 v[24:27],a[244:247],v[104:107],v[24:27]
ds_read_b128 v[120:123],v5 offset:0
v_mfma_f32_16x16x32_bf16 v[40:43],v[104:107],v[244:247],v[40:43]
v_mfma_f32_16x16x32_bf16 v[28:31],a[244:247],v[108:111],v[28:31]
ds_read_b128 v[124:127],v5 offset:4096
v_mfma_f32_16x16x32_bf16 v[44:47],v[108:111],v[244:247],v[44:47]
v_mfma_f32_16x16x32_bf16 v[32:35],a[252:255],v[104:107],v[32:35]
v_mfma_f32_16x16x32_bf16 v[48:51],v[104:107],v[252:255],v[48:51]
v_mfma_f32_16x16x32_bf16 v[36:39],a[252:255],v[108:111],v[36:39]
v_mfma_f32_16x16x32_bf16 v[52:55],v[108:111],v[252:255],v[52:55]
s_waitcnt lgkmcnt(2)
v_mfma_f32_16x16x32_bf16 v[88:91],a[0:3],v[112:115],0
ds_read_b128 v[104:107],v6 offset:0
v_mfma_f32_16x16x32_bf16 v[92:95],a[0:3],v[116:119],0
v_mfma_f32_16x16x32_bf16 v[96:99],a[8:11],v[112:115],0
ds_read_b128 v[108:111],v6 offset:4096
v_mfma_f32_16x16x32_bf16 v[100:103],a[8:11],v[116:119],0
s_waitcnt lgkmcnt(2)
v_mfma_f32_16x16x32_bf16 v[88:91],a[4:7],v[120:123],v[88:91]
ds_read_b128 v[112:115],v7 offset:0
v_mfma_f32_16x16x32_bf16 v[92:95],a[4:7],v[124:127],v[92:95]
v_cvt_pk_bf16_f32 v56,v24,v32
v_cvt_pk_bf16_f32 v57,v25,v33
v_mfma_f32_16x16x32_bf16 v[96:99],a[12:15],v[120:123],v[96:99]
ds_read_b128 v[116:119],v7 offset:4096
v_mfma_f32_16x16x32_bf16 v[100:103],a[12:15],v[124:127],v[100:103]
v_cvt_pk_bf16_f32 v58,v26,v34
v_cvt_pk_bf16_f32 v59,v27,v35
s_waitcnt lgkmcnt(2)
v_mfma_f32_16x16x32_bf16 v[88:91],a[16:19],v[104:107],v[88:91]
ds_read_b128 v[120:123],v4 offset:8192
v_mfma_f32_16x16x32_bf16 v[92:95],a[16:19],v[108:111],v[92:95]
buffer_store_dwordx4 v[56:59],v0,s[8:11],s61 offen sc1
v_cvt_pk_bf16_f32 v60,v28,v36
v_mfma_f32_16x16x32_bf16 v[96:99],a[24:27],v[104:107],v[96:99]
ds_read_b128 v[124:127],v4 offset:12288
v_mfma_f32_16x16x32_bf16 v[100:103],a[24:27],v[108:111],v[100:103]
v_cvt_pk_bf16_f32 v61,v29,v37
v_cvt_pk_bf16_f32 v62,v30,v38
s_waitcnt lgkmcnt(2)
v_mfma_f32_16x16x32_bf16 v[88:91],a[20:23],v[112:115],v[88:91]
ds_read_b128 v[104:107],v5 offset:8192
v_mfma_f32_16x16x32_bf16 v[92:95],a[20:23],v[116:119],v[92:95]
v_cvt_pk_bf16_f32 v63,v31,v39
buffer_store_dwordx4 v[60:63],v0,s[8:11],s62 offen sc1
v_mfma_f32_16x16x32_bf16 v[96:99],a[28:31],v[112:115],v[96:99]
ds_read_b128 v[108:111],v5 offset:12288
v_mfma_f32_16x16x32_bf16 v[100:103],a[28:31],v[116:119],v[100:103]
v_cvt_pk_bf16_f32 v64,v40,v41
v_cvt_pk_bf16_f32 v65,v42,v43
s_waitcnt lgkmcnt(2)
v_mfma_f32_16x16x32_bf16 v[88:91],a[32:35],v[120:123],v[88:91]
ds_read_b128 v[112:115],v6 offset:8192
v_mfma_f32_16x16x32_bf16 v[92:95],a[32:35],v[124:127],v[92:95]
v_cvt_pk_bf16_f32 v66,v44,v45
v_cvt_pk_bf16_f32 v67,v46,v47
v_mfma_f32_16x16x32_bf16 v[96:99],a[40:43],v[120:123],v[96:99]
ds_read_b128 v[116:119],v6 offset:12288
v_mfma_f32_16x16x32_bf16 v[100:103],a[40:43],v[124:127],v[100:103]
buffer_store_dwordx4 v[64:67],v0,s[8:11],s65 offen offset:0 sc1
v_cvt_pk_bf16_f32 v68,v48,v49
s_waitcnt lgkmcnt(2)
v_mfma_f32_16x16x32_bf16 v[88:91],a[36:39],v[104:107],v[88:91]
ds_read_b128 v[120:123],v7 offset:8192
v_mfma_f32_16x16x32_bf16 v[92:95],a[36:39],v[108:111],v[92:95]
v_cvt_pk_bf16_f32 v69,v50,v51
v_cvt_pk_bf16_f32 v70,v52,v53
v_mfma_f32_16x16x32_bf16 v[96:99],a[44:47],v[104:107],v[96:99]
ds_read_b128 v[124:127],v7 offset:12288
v_mfma_f32_16x16x32_bf16 v[100:103],a[44:47],v[108:111],v[100:103]
v_cvt_pk_bf16_f32 v71,v54,v55
buffer_store_dwordx4 v[68:71],v0,s[8:11],s65 offen offset:1024 sc1
s_waitcnt lgkmcnt(2)
v_mfma_f32_16x16x32_bf16 v[88:91],a[48:51],v[112:115],v[88:91]
ds_read_b128 v[104:107],v4 offset:16384
v_mfma_f32_16x16x32_bf16 v[92:95],a[48:51],v[116:119],v[92:95]
v_mfma_f32_16x16x32_bf16 v[96:99],a[56:59],v[112:115],v[96:99]
ds_read_b128 v[108:111],v4 offset:20480
v_mfma_f32_16x16x32_bf16 v[100:103],a[56:59],v[116:119],v[100:103]
s_waitcnt lgkmcnt(2)
v_mfma_f32_16x16x32_bf16 v[88:91],a[52:55],v[120:123],v[88:91]
ds_read_b128 v[112:115],v5 offset:16384
v_mfma_f32_16x16x32_bf16 v[92:95],a[52:55],v[124:127],v[92:95]
v_mfma_f32_16x16x32_bf16 v[96:99],a[60:63],v[120:123],v[96:99]
ds_read_b128 v[116:119],v5 offset:20480
v_mfma_f32_16x16x32_bf16 v[100:103],a[60:63],v[124:127],v[100:103]
s_waitcnt lgkmcnt(2)
v_mfma_f32_16x16x32_bf16 v[88:91],a[64:67],v[104:107],v[88:91]
ds_read_b128 v[120:123],v6 offset:16384
v_mfma_f32_16x16x32_bf16 v[92:95],a[64:67],v[108:111],v[92:95]
v_mfma_f32_16x16x32_bf16 v[96:99],a[72:75],v[104:107],v[96:99]
ds_read_b128 v[124:127],v6 offset:20480
v_mfma_f32_16x16x32_bf16 v[100:103],a[72:75],v[108:111],v[100:103]
s_waitcnt lgkmcnt(2)
v_mfma_f32_16x16x32_bf16 v[88:91],a[68:71],v[112:115],v[88:91]
ds_read_b128 v[104:107],v7 offset:16384
v_mfma_f32_16x16x32_bf16 v[92:95],a[68:71],v[116:119],v[92:95]
v_mfma_f32_16x16x32_bf16 v[96:99],a[76:79],v[112:115],v[96:99]
ds_read_b128 v[108:111],v7 offset:20480
v_mfma_f32_16x16x32_bf16 v[100:103],a[76:79],v[116:119],v[100:103]
s_waitcnt lgkmcnt(2)
v_mfma_f32_16x16x32_bf16 v[88:91],a[80:83],v[120:123],v[88:91]
ds_read_b128 v[112:115],v4 offset:24576
v_mfma_f32_16x16x32_bf16 v[92:95],a[80:83],v[124:127],v[92:95]
v_mfma_f32_16x16x32_bf16 v[96:99],a[88:91],v[120:123],v[96:99]
ds_read_b128 v[116:119],v4 offset:28672
v_mfma_f32_16x16x32_bf16 v[100:103],a[88:91],v[124:127],v[100:103]
s_waitcnt lgkmcnt(2)
v_mfma_f32_16x16x32_bf16 v[88:91],a[84:87],v[104:107],v[88:91]
ds_read_b128 v[120:123],v5 offset:24576
v_mfma_f32_16x16x32_bf16 v[92:95],a[84:87],v[108:111],v[92:95]
v_mfma_f32_16x16x32_bf16 v[96:99],a[92:95],v[104:107],v[96:99]
ds_read_b128 v[124:127],v5 offset:28672
v_mfma_f32_16x16x32_bf16 v[100:103],a[92:95],v[108:111],v[100:103]
s_waitcnt lgkmcnt(2)
v_mfma_f32_16x16x32_bf16 v[88:91],a[96:99],v[112:115],v[88:91]
ds_read_b128 v[104:107],v6 offset:24576
v_mfma_f32_16x16x32_bf16 v[92:95],a[96:99],v[116:119],v[92:95]
v_mfma_f32_16x16x32_bf16 v[96:99],a[104:107],v[112:115],v[96:99]
ds_read_b128 v[108:111],v6 offset:28672
v_mfma_f32_16x16x32_bf16 v[100:103],a[104:107],v[116:119],v[100:103]
s_waitcnt lgkmcnt(2)
v_mfma_f32_16x16x32_bf16 v[88:91],a[100:103],v[120:123],v[88:91]
ds_read_b128 v[112:115],v7 offset:24576
v_mfma_f32_16x16x32_bf16 v[92:95],a[100:103],v[124:127],v[92:95]
v_mfma_f32_16x16x32_bf16 v[96:99],a[108:111],v[120:123],v[96:99]
ds_read_b128 v[116:119],v7 offset:28672
v_mfma_f32_16x16x32_bf16 v[100:103],a[108:111],v[124:127],v[100:103]
s_waitcnt lgkmcnt(2)
v_mfma_f32_16x16x32_bf16 v[88:91],a[112:115],v[104:107],v[88:91]
v_mfma_f32_16x16x32_bf16 v[92:95],a[112:115],v[108:111],v[92:95]
v_mfma_f32_16x16x32_bf16 v[96:99],a[120:123],v[104:107],v[96:99]
v_mfma_f32_16x16x32_bf16 v[100:103],a[120:123],v[108:111],v[100:103]
s_waitcnt lgkmcnt(0)
v_mfma_f32_16x16x32_bf16 v[88:91],a[116:119],v[112:115],v[88:91]
v_mfma_f32_16x16x32_bf16 v[92:95],a[116:119],v[116:119],v[92:95]
v_mfma_f32_16x16x32_bf16 v[96:99],a[124:127],v[112:115],v[96:99]
v_mfma_f32_16x16x32_bf16 v[100:103],a[124:127],v[116:119],v[100:103]
s_nop 3
v_cvt_pk_bf16_f32 v104,v88,v96
v_cvt_pk_bf16_f32 v105,v89,v97
v_cvt_pk_bf16_f32 v106,v90,v98
v_cvt_pk_bf16_f32 v107,v91,v99
v_cvt_pk_bf16_f32 v108,v92,v100
v_cvt_pk_bf16_f32 v109,v93,v101
v_cvt_pk_bf16_f32 v110,v94,v102
v_cvt_pk_bf16_f32 v111,v95,v103
buffer_store_dwordx4 v[104:107],v0,s[8:11],s63 offen sc1
buffer_store_dwordx4 v[108:111],v0,s[8:11],s64 offen sc1
s_lshl_b32 s59,s51,13
s_lshl2_add_u32 s59,s47,s59
s_add_u32 s59,s59,10485888
s_waitcnt vmcnt(2)
s_barrier
s_or_b32 s59,s59,s52
buffer_store_dword v17,off,s[8:11],s59 sc1
s_lshl_b32 s70,s51,13
s_lshl2_add_u32 s70,s47,s70
s_add_u32 s70,s70,10486144
s_branch L_p_15
L_p_14:
s_mov_b32 s75,s74
s_xor_b32 s74,s74,32768
v_xor_b32 v4,32768,v4
v_xor_b32 v5,32768,v5
v_xor_b32 v6,32768,v6
v_xor_b32 v7,32768,v7
s_lshl_b32 s58,s51,5
s_add_u32 s58,s58,s47
s_mul_i32 s58,s58,24576
s_add_u32 s58,s58,150994944
s_add_u32 s61,s58,s50
s_add_u32 s62,s61,4096
s_add_u32 s63,s61,16384
s_add_u32 s64,s61,20480
s_add_u32 s65,s61,s50
s_add_u32 s65,s65,8192
ds_read_b128 v[104:107],v4 offset:0
ds_read_b128 v[108:111],v4 offset:4096
ds_read_b128 v[112:115],v5 offset:0
ds_read_b128 v[116:119],v5 offset:4096
s_waitcnt lgkmcnt(2)
v_mfma_f32_16x16x32_bf16 v[24:27],a[128:131],v[104:107],0
ds_read_b128 v[120:123],v6 offset:0
v_mfma_f32_16x16x32_bf16 v[40:43],v[104:107],v[128:131],0
v_mfma_f32_16x16x32_bf16 v[28:31],a[128:131],v[108:111],0
ds_read_b128 v[124:127],v6 offset:4096
v_mfma_f32_16x16x32_bf16 v[44:47],v[108:111],v[128:131],0
v_mfma_f32_16x16x32_bf16 v[32:35],a[136:139],v[104:107],0
v_mfma_f32_16x16x32_bf16 v[48:51],v[104:107],v[136:139],0
v_mfma_f32_16x16x32_bf16 v[36:39],a[136:139],v[108:111],0
v_mfma_f32_16x16x32_bf16 v[52:55],v[108:111],v[136:139],0
s_waitcnt lgkmcnt(2)
v_mfma_f32_16x16x32_bf16 v[24:27],a[132:135],v[112:115],v[24:27]
ds_read_b128 v[104:107],v7 offset:0
v_mfma_f32_16x16x32_bf16 v[40:43],v[112:115],v[132:135],v[40:43]
v_mfma_f32_16x16x32_bf16 v[28:31],a[132:135],v[116:119],v[28:31]
ds_read_b128 v[108:111],v7 offset:4096
v_mfma_f32_16x16x32_bf16 v[44:47],v[116:119],v[132:135],v[44:47]
v_mfma_f32_16x16x32_bf16 v[32:35],a[140:143],v[112:115],v[32:35]
v_mfma_f32_16x16x32_bf16 v[48:51],v[112:115],v[140:143],v[48:51]
v_mfma_f32_16x16x32_bf16 v[36:39],a[140:143],v[116:119],v[36:39]
v_mfma_f32_16x16x32_bf16 v[52:55],v[116:119],v[140:143],v[52:55]
s_waitcnt lgkmcnt(2)
v_mfma_f32_16x16x32_bf16 v[24:27],a[144:147],v[120:123],v[24:27]
ds_read_b128 v[112:115],v4 offset:8192
v_mfma_f32_16x16x32_bf16 v[40:43],v[120:123],v[144:147],v[40:43]
v_mfma_f32_16x16x32_bf16 v[28:31],a[144:147],v[124:127],v[28:31]
ds_read_b128 v[116:119],v4 offset:12288
v_mfma_f32_16x16x32_bf16 v[44:47],v[124:127],v[144:147],v[44:47]
v_mfma_f32_16x16x32_bf16 v[32:35],a[152:155],v[120:123],v[32:35]
v_mfma_f32_16x16x32_bf16 v[48:51],v[120:123],v[152:155],v[48:51]
v_mfma_f32_16x16x32_bf16 v[36:39],a[152:155],v[124:127],v[36:39]
v_mfma_f32_16x16x32_bf16 v[52:55],v[124:127],v[152:155],v[52:55]
s_waitcnt lgkmcnt(2)
v_mfma_f32_16x16x32_bf16 v[24:27],a[148:151],v[104:107],v[24:27]
ds_read_b128 v[120:123],v5 offset:8192
v_mfma_f32_16x16x32_bf16 v[40:43],v[104:107],v[148:151],v[40:43]
v_mfma_f32_16x16x32_bf16 v[28:31],a[148:151],v[108:111],v[28:31]
ds_read_b128 v[124:127],v5 offset:12288
v_mfma_f32_16x16x32_bf16 v[44:47],v[108:111],v[148:151],v[44:47]
v_mfma_f32_16x16x32_bf16 v[32:35],a[156:159],v[104:107],v[32:35]
v_mfma_f32_16x16x32_bf16 v[48:51],v[104:107],v[156:159],v[48:51]
v_mfma_f32_16x16x32_bf16 v[36:39],a[156:159],v[108:111],v[36:39]
v_mfma_f32_16x16x32_bf16 v[52:55],v[108:111],v[156:159],v[52:55]
s_waitcnt lgkmcnt(2)
v_mfma_f32_16x16x32_bf16 v[24:27],a[160:163],v[112:115],v[24:27]
ds_read_b128 v[104:107],v6 offset:8192
v_mfma_f32_16x16x32_bf16 v[40:43],v[112:115],v[160:163],v[40:43]
v_mfma_f32_16x16x32_bf16 v[28:31],a[160:163],v[116:119],v[28:31]
ds_read_b128 v[108:111],v6 offset:12288
v_mfma_f32_16x16x32_bf16 v[44:47],v[116:119],v[160:163],v[44:47]
v_mfma_f32_16x16x32_bf16 v[32:35],a[168:171],v[112:115],v[32:35]
v_mfma_f32_16x16x32_bf16 v[48:51],v[112:115],v[168:171],v[48:51]
v_mfma_f32_16x16x32_bf16 v[36:39],a[168:171],v[116:119],v[36:39]
v_mfma_f32_16x16x32_bf16 v[52:55],v[116:119],v[168:171],v[52:55]
s_waitcnt lgkmcnt(2)
v_mfma_f32_16x16x32_bf16 v[24:27],a[164:167],v[120:123],v[24:27]
ds_read_b128 v[112:115],v7 offset:8192
v_mfma_f32_16x16x32_bf16 v[40:43],v[120:123],v[164:167],v[40:43]
s_lshl_b32 s56,s54,13
v_mfma_f32_16x16x32_bf16 v[28:31],a[164:167],v[124:127],v[28:31]
ds_read_b128 v[116:119],v7 offset:12288
v_mfma_f32_16x16x32_bf16 v[44:47],v[124:127],v[164:167],v[44:47]
s_add_u32 s56,s56,10487552
v_mfma_f32_16x16x32_bf16 v[32:35],a[172:175],v[120:123],v[32:35]
s_or_b32 s56,s56,s52
v_mfma_f32_16x16x32_bf16 v[48:51],v[120:123],v[172:175],v[48:51]
buffer_load_dword v76,v23,s[8:11],s56 offen sc1
v_mfma_f32_16x16x32_bf16 v[36:39],a[172:175],v[124:127],v[36:39]
v_mfma_f32_16x16x32_bf16 v[52:55],v[124:127],v[172:175],v[52:55]
s_waitcnt lgkmcnt(2)
v_mfma_f32_16x16x32_bf16 v[24:27],a[176:179],v[104:107],v[24:27]
ds_read_b128 v[120:123],v4 offset:16384
v_mfma_f32_16x16x32_bf16 v[40:43],v[104:107],v[176:179],v[40:43]
v_mfma_f32_16x16x32_bf16 v[28:31],a[176:179],v[108:111],v[28:31]
ds_read_b128 v[124:127],v4 offset:20480
v_mfma_f32_16x16x32_bf16 v[44:47],v[108:111],v[176:179],v[44:47]
v_mfma_f32_16x16x32_bf16 v[32:35],a[184:187],v[104:107],v[32:35]
v_mfma_f32_16x16x32_bf16 v[48:51],v[104:107],v[184:187],v[48:51]
v_mfma_f32_16x16x32_bf16 v[36:39],a[184:187],v[108:111],v[36:39]
v_mfma_f32_16x16x32_bf16 v[52:55],v[108:111],v[184:187],v[52:55]
s_waitcnt lgkmcnt(2)
v_mfma_f32_16x16x32_bf16 v[24:27],a[180:183],v[112:115],v[24:27]
ds_read_b128 v[104:107],v5 offset:16384
v_mfma_f32_16x16x32_bf16 v[40:43],v[112:115],v[180:183],v[40:43]
v_mfma_f32_16x16x32_bf16 v[28:31],a[180:183],v[116:119],v[28:31]
ds_read_b128 v[108:111],v5 offset:20480
v_mfma_f32_16x16x32_bf16 v[44:47],v[116:119],v[180:183],v[44:47]
v_mfma_f32_16x16x32_bf16 v[32:35],a[188:191],v[112:115],v[32:35]
v_mfma_f32_16x16x32_bf16 v[48:51],v[112:115],v[188:191],v[48:51]
v_mfma_f32_16x16x32_bf16 v[36:39],a[188:191],v[116:119],v[36:39]
v_mfma_f32_16x16x32_bf16 v[52:55],v[116:119],v[188:191],v[52:55]
s_waitcnt lgkmcnt(2)
v_mfma_f32_16x16x32_bf16 v[24:27],a[192:195],v[120:123],v[24:27]
ds_read_b128 v[112:115],v6 offset:16384
v_mfma_f32_16x16x32_bf16 v[40:43],v[120:123],v[192:195],v[40:43]
v_mfma_f32_16x16x32_bf16 v[28:31],a[192:195],v[124:127],v[28:31]
ds_read_b128 v[116:119],v6 offset:20480
v_mfma_f32_16x16x32_bf16 v[44:47],v[124:127],v[192:195],v[44:47]
v_mfma_f32_16x16x32_bf16 v[32:35],a[200:203],v[120:123],v[32:35]
v_mfma_f32_16x16x32_bf16 v[48:51],v[120:123],v[200:203],v[48:51]
v_mfma_f32_16x16x32_bf16 v[36:39],a[200:203],v[124:127],v[36:39]
v_mfma_f32_16x16x32_bf16 v[52:55],v[124:127],v[200:203],v[52:55]
s_waitcnt lgkmcnt(2)
v_mfma_f32_16x16x32_bf16 v[24:27],a[196:199],v[104:107],v[24:27]
ds_read_b128 v[120:123],v7 offset:16384
v_mfma_f32_16x16x32_bf16 v[40:43],v[104:107],v[196:199],v[40:43]
s_waitcnt vmcnt(0)
v_mfma_f32_16x16x32_bf16 v[28:31],a[196:199],v[108:111],v[28:31]
ds_read_b128 v[124:127],v7 offset:20480
v_mfma_f32_16x16x32_bf16 v[44:47],v[108:111],v[196:199],v[44:47]
v_cmp_eq_u32 vcc,0,v76
v_mfma_f32_16x16x32_bf16 v[32:35],a[204:207],v[104:107],v[32:35]
s_nop 0
v_mov_b32 v76,vcc_lo
v_mfma_f32_16x16x32_bf16 v[48:51],v[104:107],v[204:207],v[48:51]
ds_write_b32 v19,v76
v_mfma_f32_16x16x32_bf16 v[36:39],a[204:207],v[108:111],v[36:39]
v_mfma_f32_16x16x32_bf16 v[52:55],v[108:111],v[204:207],v[52:55]
s_waitcnt vmcnt(0) lgkmcnt(0)
s_barrier
s_or_b32 s70,s70,s52
buffer_store_dword v17,off,s[8:11],s70 sc1
ds_read_b32 v76,v16
v_mfma_f32_16x16x32_bf16 v[24:27],a[208:211],v[112:115],v[24:27]
ds_read_b128 v[104:107],v4 offset:24576
v_mfma_f32_16x16x32_bf16 v[40:43],v[112:115],v[208:211],v[40:43]
v_mfma_f32_16x16x32_bf16 v[28:31],a[208:211],v[116:119],v[28:31]
ds_read_b128 v[108:111],v4 offset:28672
v_mfma_f32_16x16x32_bf16 v[44:47],v[116:119],v[208:211],v[44:47]
v_mfma_f32_16x16x32_bf16 v[32:35],a[216:219],v[112:115],v[32:35]
v_mfma_f32_16x16x32_bf16 v[48:51],v[112:115],v[216:219],v[48:51]
v_mfma_f32_16x16x32_bf16 v[36:39],a[216:219],v[116:119],v[36:39]
v_mfma_f32_16x16x32_bf16 v[52:55],v[116:119],v[216:219],v[52:55]
s_waitcnt lgkmcnt(2)
v_mfma_f32_16x16x32_bf16 v[24:27],a[212:215],v[120:123],v[24:27]
ds_read_b128 v[112:115],v5 offset:24576
v_mfma_f32_16x16x32_bf16 v[40:43],v[120:123],v[212:215],v[40:43]
v_readfirstlane_b32 s57,v76
v_mfma_f32_16x16x32_bf16 v[28:31],a[212:215],v[124:127],v[28:31]
ds_read_b128 v[116:119],v5 offset:28672
v_mfma_f32_16x16x32_bf16 v[44:47],v[124:127],v[212:215],v[44:47]
s_sub_u32 s59,s55,s54
s_cmp_lt_i32 s59,36
s_cselect_b32 s76,2,0
v_mfma_f32_16x16x32_bf16 v[32:35],a[220:223],v[120:123],v[32:35]
s_cmp_gt_i32 s53,0
s_cselect_b32 s76,s76,0
v_mfma_f32_16x16x32_bf16 v[48:51],v[120:123],v[220:223],v[48:51]
s_cmp_eq_u32 s57,0
s_cselect_b32 s76,1,s76
v_mfma_f32_16x16x32_bf16 v[36:39],a[220:223],v[124:127],v[36:39]
s_cmp_lt_i32 s59,12
s_cselect_b32 s76,2,s76
s_add_u32 s57,s54,64
v_mfma_f32_16x16x32_bf16 v[52:55],v[124:127],v[220:223],v[52:55]
s_cmp_eq_u32 s76,1
s_cselect_b32 s68,s57,s55
s_lshl_b32 s68,s68,15
s_waitcnt lgkmcnt(2)
v_mfma_f32_16x16x32_bf16 v[24:27],a[224:227],v[104:107],v[24:27]
ds_read_b128 v[120:123],v6 offset:24576
v_mfma_f32_16x16x32_bf16 v[40:43],v[104:107],v[224:227],v[40:43]
s_cmp_eq_u32 s76,0
s_cselect_b32 s68,0x80000000,s68
s_add_u32 s69,s68,16384
v_mfma_f32_16x16x32_bf16 v[28:31],a[224:227],v[108:111],v[28:31]
ds_read_b128 v[124:127],v6 offset:28672
v_mfma_f32_16x16x32_bf16 v[44:47],v[108:111],v[224:227],v[44:47]
s_add_u32 m0,s75,65536
v_mfma_f32_16x16x32_bf16 v[32:35],a[232:235],v[104:107],v[32:35]
buffer_load_dwordx4 v20,s[8:11],s68 offen offset:0 sc1 lds
v_mfma_f32_16x16x32_bf16 v[48:51],v[104:107],v[232:235],v[48:51]
s_add_u32 m0,s75,69632
v_mfma_f32_16x16x32_bf16 v[36:39],a[232:235],v[108:111],v[36:39]
buffer_load_dwordx4 v20,s[8:11],s69 offen offset:0 sc1 lds
v_mfma_f32_16x16x32_bf16 v[52:55],v[108:111],v[232:235],v[52:55]
s_add_u32 m0,s75,73472
s_waitcnt lgkmcnt(2)
v_mfma_f32_16x16x32_bf16 v[24:27],a[228:231],v[112:115],v[24:27]
ds_read_b128 v[104:107],v7 offset:24576
v_mfma_f32_16x16x32_bf16 v[40:43],v[112:115],v[228:231],v[40:43]
buffer_load_dwordx4 v20,s[8:11],s68 offen offset:256 sc1 lds
v_mfma_f32_16x16x32_bf16 v[28:31],a[228:231],v[116:119],v[28:31]
ds_read_b128 v[108:111],v7 offset:28672
v_mfma_f32_16x16x32_bf16 v[44:47],v[116:119],v[228:231],v[44:47]
s_add_u32 m0,s75,77568
v_mfma_f32_16x16x32_bf16 v[32:35],a[236:239],v[112:115],v[32:35]
buffer_load_dwordx4 v20,s[8:11],s69 offen offset:256 sc1 lds
v_mfma_f32_16x16x32_bf16 v[48:51],v[112:115],v[236:239],v[48:51]
s_add_u32 m0,s75,81408
v_mfma_f32_16x16x32_bf16 v[36:39],a[236:239],v[116:119],v[36:39]
buffer_load_dwordx4 v20,s[8:11],s68 offen offset:512 sc1 lds
v_mfma_f32_16x16x32_bf16 v[52:55],v[116:119],v[236:239],v[52:55]
s_add_u32 m0,s75,85504
s_waitcnt lgkmcnt(2)
v_mfma_f32_16x16x32_bf16 v[24:27],a[240:243],v[120:123],v[24:27]
ds_read_b128 v[112:115],v4 offset:0
v_mfma_f32_16x16x32_bf16 v[40:43],v[120:123],v[240:243],v[40:43]
buffer_load_dwordx4 v20,s[8:11],s69 offen offset:512 sc1 lds
v_mfma_f32_16x16x32_bf16 v[28:31],a[240:243],v[124:127],v[28:31]
ds_read_b128 v[116:119],v4 offset:4096
v_mfma_f32_16x16x32_bf16 v[44:47],v[124:127],v[240:243],v[44:47]
s_add_u32 m0,s75,89344
v_mfma_f32_16x16x32_bf16 v[32:35],a[248:251],v[120:123],v[32:35]
buffer_load_dwordx4 v20,s[8:11],s68 offen offset:768 sc1 lds
v_mfma_f32_16x16x32_bf16 v[48:51],v[120:123],v[248:251],v[48:51]
s_add_u32 m0,s75,93440
v_mfma_f32_16x16x32_bf16 v[36:39],a[248:251],v[124:127],v[36:39]
buffer_load_dwordx4 v20,s[8:11],s69 offen offset:768 sc1 lds
v_mfma_f32_16x16x32_bf16 v[52:55],v[124:127],v[248:251],v[52:55]
s_waitcnt lgkmcnt(2)
v_mfma_f32_16x16x32_bf16 v[24:27],a[244:247],v[104:107],v[24:27]
ds_read_b128 v[120:123],v5 offset:0
v_mfma_f32_16x16x32_bf16 v[40:43],v[104:107],v[244:247],v[40:43]
v_mfma_f32_16x16x32_bf16 v[28:31],a[244:247],v[108:111],v[28:31]
ds_read_b128 v[124:127],v5 offset:4096
v_mfma_f32_16x16x32_bf16 v[44:47],v[108:111],v[244:247],v[44:47]
v_mfma_f32_16x16x32_bf16 v[32:35],a[252:255],v[104:107],v[32:35]
v_mfma_f32_16x16x32_bf16 v[48:51],v[104:107],v[252:255],v[48:51]
v_mfma_f32_16x16x32_bf16 v[36:39],a[252:255],v[108:111],v[36:39]
v_mfma_f32_16x16x32_bf16 v[52:55],v[108:111],v[252:255],v[52:55]
s_waitcnt lgkmcnt(2)
v_mfma_f32_16x16x32_bf16 v[88:91],a[0:3],v[112:115],0
ds_read_b128 v[104:107],v6 offset:0
v_mfma_f32_16x16x32_bf16 v[92:95],a[0:3],v[116:119],0
v_mfma_f32_16x16x32_bf16 v[96:99],a[8:11],v[112:115],0
ds_read_b128 v[108:111],v6 offset:4096
v_mfma_f32_16x16x32_bf16 v[100:103],a[8:11],v[116:119],0
s_waitcnt lgkmcnt(2)
v_mfma_f32_16x16x32_bf16 v[88:91],a[4:7],v[120:123],v[88:91]
ds_read_b128 v[112:115],v7 offset:0
v_mfma_f32_16x16x32_bf16 v[92:95],a[4:7],v[124:127],v[92:95]
v_cvt_pk_bf16_f32 v56,v24,v32
v_cvt_pk_bf16_f32 v57,v25,v33
v_mfma_f32_16x16x32_bf16 v[96:99],a[12:15],v[120:123],v[96:99]
ds_read_b128 v[116:119],v7 offset:4096
v_mfma_f32_16x16x32_bf16 v[100:103],a[12:15],v[124:127],v[100:103]
v_cvt_pk_bf16_f32 v58,v26,v34
v_cvt_pk_bf16_f32 v59,v27,v35
s_waitcnt lgkmcnt(2)
v_mfma_f32_16x16x32_bf16 v[88:91],a[16:19],v[104:107],v[88:91]
ds_read_b128 v[120:123],v4 offset:8192
v_mfma_f32_16x16x32_bf16 v[92:95],a[16:19],v[108:111],v[92:95]
buffer_store_dwordx4 v[56:59],v0,s[8:11],s61 offen sc1
v_cvt_pk_bf16_f32 v60,v28,v36
v_mfma_f32_16x16x32_bf16 v[96:99],a[24:27],v[104:107],v[96:99]
ds_read_b128 v[124:127],v4 offset:12288
v_mfma_f32_16x16x32_bf16 v[100:103],a[24:27],v[108:111],v[100:103]
v_cvt_pk_bf16_f32 v61,v29,v37
v_cvt_pk_bf16_f32 v62,v30,v38
s_waitcnt lgkmcnt(2)
v_mfma_f32_16x16x32_bf16 v[88:91],a[20:23],v[112:115],v[88:91]
ds_read_b128 v[104:107],v5 offset:8192
v_mfma_f32_16x16x32_bf16 v[92:95],a[20:23],v[116:119],v[92:95]
v_cvt_pk_bf16_f32 v63,v31,v39
buffer_store_dwordx4 v[60:63],v0,s[8:11],s62 offen sc1
v_mfma_f32_16x16x32_bf16 v[96:99],a[28:31],v[112:115],v[96:99]
ds_read_b128 v[108:111],v5 offset:12288
v_mfma_f32_16x16x32_bf16 v[100:103],a[28:31],v[116:119],v[100:103]
v_cvt_pk_bf16_f32 v64,v40,v41
v_cvt_pk_bf16_f32 v65,v42,v43
s_waitcnt lgkmcnt(2)
v_mfma_f32_16x16x32_bf16 v[88:91],a[32:35],v[120:123],v[88:91]
ds_read_b128 v[112:115],v6 offset:8192
v_mfma_f32_16x16x32_bf16 v[92:95],a[32:35],v[124:127],v[92:95]
v_cvt_pk_bf16_f32 v66,v44,v45
v_cvt_pk_bf16_f32 v67,v46,v47
v_mfma_f32_16x16x32_bf16 v[96:99],a[40:43],v[120:123],v[96:99]
ds_read_b128 v[116:119],v6 offset:12288
v_mfma_f32_16x16x32_bf16 v[100:103],a[40:43],v[124:127],v[100:103]
buffer_store_dwordx4 v[64:67],v0,s[8:11],s65 offen offset:0 sc1
v_cvt_pk_bf16_f32 v68,v48,v49
s_waitcnt lgkmcnt(2)
v_mfma_f32_16x16x32_bf16 v[88:91],a[36:39],v[104:107],v[88:91]
ds_read_b128 v[120:123],v7 offset:8192
v_mfma_f32_16x16x32_bf16 v[92:95],a[36:39],v[108:111],v[92:95]
v_cvt_pk_bf16_f32 v69,v50,v51
v_cvt_pk_bf16_f32 v70,v52,v53
v_mfma_f32_16x16x32_bf16 v[96:99],a[44:47],v[104:107],v[96:99]
ds_read_b128 v[124:127],v7 offset:12288
v_mfma_f32_16x16x32_bf16 v[100:103],a[44:47],v[108:111],v[100:103]
v_cvt_pk_bf16_f32 v71,v54,v55
buffer_store_dwordx4 v[68:71],v0,s[8:11],s65 offen offset:1024 sc1
s_waitcnt lgkmcnt(2)
v_mfma_f32_16x16x32_bf16 v[88:91],a[48:51],v[112:115],v[88:91]
ds_read_b128 v[104:107],v4 offset:16384
v_mfma_f32_16x16x32_bf16 v[92:95],a[48:51],v[116:119],v[92:95]
v_mfma_f32_16x16x32_bf16 v[96:99],a[56:59],v[112:115],v[96:99]
ds_read_b128 v[108:111],v4 offset:20480
v_mfma_f32_16x16x32_bf16 v[100:103],a[56:59],v[116:119],v[100:103]
s_waitcnt lgkmcnt(2)
v_mfma_f32_16x16x32_bf16 v[88:91],a[52:55],v[120:123],v[88:91]
ds_read_b128 v[112:115],v5 offset:16384
v_mfma_f32_16x16x32_bf16 v[92:95],a[52:55],v[124:127],v[92:95]
v_mfma_f32_16x16x32_bf16 v[96:99],a[60:63],v[120:123],v[96:99]
ds_read_b128 v[116:119],v5 offset:20480
v_mfma_f32_16x16x32_bf16 v[100:103],a[60:63],v[124:127],v[100:103]
s_waitcnt lgkmcnt(2)
v_mfma_f32_16x16x32_bf16 v[88:91],a[64:67],v[104:107],v[88:91]
ds_read_b128 v[120:123],v6 offset:16384
v_mfma_f32_16x16x32_bf16 v[92:95],a[64:67],v[108:111],v[92:95]
v_mfma_f32_16x16x32_bf16 v[96:99],a[72:75],v[104:107],v[96:99]
ds_read_b128 v[124:127],v6 offset:20480
v_mfma_f32_16x16x32_bf16 v[100:103],a[72:75],v[108:111],v[100:103]
s_waitcnt lgkmcnt(2)
v_mfma_f32_16x16x32_bf16 v[88:91],a[68:71],v[112:115],v[88:91]
ds_read_b128 v[104:107],v7 offset:16384
v_mfma_f32_16x16x32_bf16 v[92:95],a[68:71],v[116:119],v[92:95]
v_mfma_f32_16x16x32_bf16 v[96:99],a[76:79],v[112:115],v[96:99]
ds_read_b128 v[108:111],v7 offset:20480
v_mfma_f32_16x16x32_bf16 v[100:103],a[76:79],v[116:119],v[100:103]
s_waitcnt lgkmcnt(2)
v_mfma_f32_16x16x32_bf16 v[88:91],a[80:83],v[120:123],v[88:91]
ds_read_b128 v[112:115],v4 offset:24576
v_mfma_f32_16x16x32_bf16 v[92:95],a[80:83],v[124:127],v[92:95]
v_mfma_f32_16x16x32_bf16 v[96:99],a[88:91],v[120:123],v[96:99]
ds_read_b128 v[116:119],v4 offset:28672
v_mfma_f32_16x16x32_bf16 v[100:103],a[88:91],v[124:127],v[100:103]
s_waitcnt lgkmcnt(2)
v_mfma_f32_16x16x32_bf16 v[88:91],a[84:87],v[104:107],v[88:91]
ds_read_b128 v[120:123],v5 offset:24576
v_mfma_f32_16x16x32_bf16 v[92:95],a[84:87],v[108:111],v[92:95]
v_mfma_f32_16x16x32_bf16 v[96:99],a[92:95],v[104:107],v[96:99]
ds_read_b128 v[124:127],v5 offset:28672
v_mfma_f32_16x16x32_bf16 v[100:103],a[92:95],v[108:111],v[100:103]
s_waitcnt lgkmcnt(2)
v_mfma_f32_16x16x32_bf16 v[88:91],a[96:99],v[112:115],v[88:91]
ds_read_b128 v[104:107],v6 offset:24576
v_mfma_f32_16x16x32_bf16 v[92:95],a[96:99],v[116:119],v[92:95]
v_mfma_f32_16x16x32_bf16 v[96:99],a[104:107],v[112:115],v[96:99]
ds_read_b128 v[108:111],v6 offset:28672
v_mfma_f32_16x16x32_bf16 v[100:103],a[104:107],v[116:119],v[100:103]
s_waitcnt lgkmcnt(2)
v_mfma_f32_16x16x32_bf16 v[88:91],a[100:103],v[120:123],v[88:91]
ds_read_b128 v[112:115],v7 offset:24576
v_mfma_f32_16x16x32_bf16 v[92:95],a[100:103],v[124:127],v[92:95]
v_mfma_f32_16x16x32_bf16 v[96:99],a[108:111],v[120:123],v[96:99]
ds_read_b128 v[116:119],v7 offset:28672
v_mfma_f32_16x16x32_bf16 v[100:103],a[108:111],v[124:127],v[100:103]
s_waitcnt lgkmcnt(2)
v_mfma_f32_16x16x32_bf16 v[88:91],a[112:115],v[104:107],v[88:91]
v_mfma_f32_16x16x32_bf16 v[92:95],a[112:115],v[108:111],v[92:95]
v_mfma_f32_16x16x32_bf16 v[96:99],a[120:123],v[104:107],v[96:99]
v_mfma_f32_16x16x32_bf16 v[100:103],a[120:123],v[108:111],v[100:103]
s_waitcnt lgkmcnt(0)
v_mfma_f32_16x16x32_bf16 v[88:91],a[116:119],v[112:115],v[88:91]
v_mfma_f32_16x16x32_bf16 v[92:95],a[116:119],v[116:119],v[92:95]
v_mfma_f32_16x16x32_bf16 v[96:99],a[124:127],v[112:115],v[96:99]
v_mfma_f32_16x16x32_bf16 v[100:103],a[124:127],v[116:119],v[100:103]
s_nop 3
v_cvt_pk_bf16_f32 v104,v88,v96
v_cvt_pk_bf16_f32 v105,v89,v97
v_cvt_pk_bf16_f32 v106,v90,v98
v_cvt_pk_bf16_f32 v107,v91,v99
v_cvt_pk_bf16_f32 v108,v92,v100
v_cvt_pk_bf16_f32 v109,v93,v101
v_cvt_pk_bf16_f32 v110,v94,v102
v_cvt_pk_bf16_f32 v111,v95,v103
buffer_store_dwordx4 v[104:107],v0,s[8:11],s63 offen sc1
buffer_store_dwordx4 v[108:111],v0,s[8:11],s64 offen sc1
s_lshl_b32 s59,s51,13
s_lshl2_add_u32 s59,s47,s59
s_add_u32 s59,s59,10485888
s_waitcnt vmcnt(2)
s_barrier
s_or_b32 s59,s59,s52
buffer_store_dword v17,off,s[8:11],s59 sc1
s_lshl_b32 s70,s51,13
s_lshl2_add_u32 s70,s47,s70
s_add_u32 s70,s70,10486144
s_branch L_p_15
L_p_16:
s_endpgm
L_rm_5:
v_and_b32 v33,15,v1
v_lshrrev_b32 v34,4,v1
s_min_u32 s60,s47,27
s_lshl_b32 s60,s60,7
s_mul_i32 s59,s46,458752
s_add_u32 s60,s60,s59
v_mul_u32_u24 v36,114688,v34
v_and_b32 v35,7,v33
v_lshl_add_u32 v36,v35,4,v36
v_add_u32 v36,s60,v36
v_cmp_gt_u32 vcc,8,v33
v_mov_b32 v38,s36
v_mov_b32 v39,s37
v_mov_b32 v40,s34
v_mov_b32 v41,s35
v_cndmask_b32 v38,v38,v40,vcc
v_cndmask_b32 v39,v39,v41,vcc
v_add_co_u32 v38,vcc,v38,v36
s_nop 1
v_addc_co_u32 v39,vcc,0,v39,vcc
s_lshl_b32 s56,s46,15
v_add_u32 v37,s56,v0
global_load_dwordx4 v[44:47],v[38:39],off
v_add_co_u32 v38,vcc,3584,v38
s_nop 1
v_addc_co_u32 v39,vcc,0,v39,vcc
global_load_dwordx4 v[48:51],v[38:39],off
v_add_co_u32 v38,vcc,3584,v38
s_nop 1
v_addc_co_u32 v39,vcc,0,v39,vcc
global_load_dwordx4 v[52:55],v[38:39],off
v_add_co_u32 v38,vcc,3584,v38
s_nop 1
v_addc_co_u32 v39,vcc,0,v39,vcc
global_load_dwordx4 v[56:59],v[38:39],off
v_add_co_u32 v38,vcc,3584,v38
s_nop 1
v_addc_co_u32 v39,vcc,0,v39,vcc
global_load_dwordx4 v[60:63],v[38:39],off
v_add_co_u32 v38,vcc,3584,v38
s_nop 1
v_addc_co_u32 v39,vcc,0,v39,vcc
global_load_dwordx4 v[64:67],v[38:39],off
v_add_co_u32 v38,vcc,3584,v38
s_nop 1
v_addc_co_u32 v39,vcc,0,v39,vcc
global_load_dwordx4 v[68:71],v[38:39],off
v_add_co_u32 v38,vcc,3584,v38
s_nop 1
v_addc_co_u32 v39,vcc,0,v39,vcc
global_load_dwordx4 v[72:75],v[38:39],off
v_add_co_u32 v38,vcc,3584,v38
s_nop 1
v_addc_co_u32 v39,vcc,0,v39,vcc
global_load_dwordx4 v[76:79],v[38:39],off
v_add_co_u32 v38,vcc,3584,v38
s_nop 1
v_addc_co_u32 v39,vcc,0,v39,vcc
global_load_dwordx4 v[80:83],v[38:39],off
v_add_co_u32 v38,vcc,3584,v38
s_nop 1
v_addc_co_u32 v39,vcc,0,v39,vcc
global_load_dwordx4 v[84:87],v[38:39],off
v_add_co_u32 v38,vcc,3584,v38
s_nop 1
v_addc_co_u32 v39,vcc,0,v39,vcc
global_load_dwordx4 v[88:91],v[38:39],off
v_add_co_u32 v38,vcc,3584,v38
s_nop 1
v_addc_co_u32 v39,vcc,0,v39,vcc
global_load_dwordx4 v[92:95],v[38:39],off
v_add_co_u32 v38,vcc,3584,v38
s_nop 1
v_addc_co_u32 v39,vcc,0,v39,vcc
global_load_dwordx4 v[96:99],v[38:39],off
v_add_co_u32 v38,vcc,3584,v38
s_nop 1
v_addc_co_u32 v39,vcc,0,v39,vcc
global_load_dwordx4 v[100:103],v[38:39],off
v_add_co_u32 v38,vcc,3584,v38
s_nop 1
v_addc_co_u32 v39,vcc,0,v39,vcc
global_load_dwordx4 v[104:107],v[38:39],off
v_add_co_u32 v38,vcc,3584,v38
s_nop 1
v_addc_co_u32 v39,vcc,0,v39,vcc
s_waitcnt vmcnt(15)
ds_write_b128 v37,v[44:47] offset:0
s_waitcnt vmcnt(14)
ds_write_b128 v37,v[48:51] offset:1024
s_waitcnt vmcnt(13)
ds_write_b128 v37,v[52:55] offset:2048
s_waitcnt vmcnt(12)
ds_write_b128 v37,v[56:59] offset:3072
s_waitcnt vmcnt(11)
ds_write_b128 v37,v[60:63] offset:4096
s_waitcnt vmcnt(10)
ds_write_b128 v37,v[64:67] offset:5120
s_waitcnt vmcnt(9)
ds_write_b128 v37,v[68:71] offset:6144
s_waitcnt vmcnt(8)
ds_write_b128 v37,v[72:75] offset:7168
s_waitcnt lgkmcnt(0)
s_waitcnt vmcnt(7)
ds_write_b128 v37,v[76:79] offset:8192
s_waitcnt vmcnt(6)
ds_write_b128 v37,v[80:83] offset:9216
s_waitcnt vmcnt(5)
ds_write_b128 v37,v[84:87] offset:10240
s_waitcnt vmcnt(4)
ds_write_b128 v37,v[88:91] offset:11264
s_waitcnt vmcnt(3)
ds_write_b128 v37,v[92:95] offset:12288
s_waitcnt vmcnt(2)
ds_write_b128 v37,v[96:99] offset:13312
s_waitcnt vmcnt(1)
ds_write_b128 v37,v[100:103] offset:14336
s_waitcnt vmcnt(0)
ds_write_b128 v37,v[104:107] offset:15360
s_waitcnt lgkmcnt(0)
global_load_dwordx4 v[44:47],v[38:39],off
v_add_co_u32 v38,vcc,3584,v38
s_nop 1
v_addc_co_u32 v39,vcc,0,v39,vcc
global_load_dwordx4 v[48:51],v[38:39],off
v_add_co_u32 v38,vcc,3584,v38
s_nop 1
v_addc_co_u32 v39,vcc,0,v39,vcc
global_load_dwordx4 v[52:55],v[38:39],off
v_add_co_u32 v38,vcc,3584,v38
s_nop 1
v_addc_co_u32 v39,vcc,0,v39,vcc
global_load_dwordx4 v[56:59],v[38:39],off
v_add_co_u32 v38,vcc,3584,v38
s_nop 1
v_addc_co_u32 v39,vcc,0,v39,vcc
global_load_dwordx4 v[60:63],v[38:39],off
v_add_co_u32 v38,vcc,3584,v38
s_nop 1
v_addc_co_u32 v39,vcc,0,v39,vcc
global_load_dwordx4 v[64:67],v[38:39],off
v_add_co_u32 v38,vcc,3584,v38
s_nop 1
v_addc_co_u32 v39,vcc,0,v39,vcc
global_load_dwordx4 v[68:71],v[38:39],off
v_add_co_u32 v38,vcc,3584,v38
s_nop 1
v_addc_co_u32 v39,vcc,0,v39,vcc
global_load_dwordx4 v[72:75],v[38:39],off
v_add_co_u32 v38,vcc,3584,v38
s_nop 1
v_addc_co_u32 v39,vcc,0,v39,vcc
global_load_dwordx4 v[76:79],v[38:39],off
v_add_co_u32 v38,vcc,3584,v38
s_nop 1
v_addc_co_u32 v39,vcc,0,v39,vcc
global_load_dwordx4 v[80:83],v[38:39],off
v_add_co_u32 v38,vcc,3584,v38
s_nop 1
v_addc_co_u32 v39,vcc,0,v39,vcc
global_load_dwordx4 v[84:87],v[38:39],off
v_add_co_u32 v38,vcc,3584,v38
s_nop 1
v_addc_co_u32 v39,vcc,0,v39,vcc
global_load_dwordx4 v[88:91],v[38:39],off
v_add_co_u32 v38,vcc,3584,v38
s_nop 1
v_addc_co_u32 v39,vcc,0,v39,vcc
global_load_dwordx4 v[92:95],v[38:39],off
v_add_co_u32 v38,vcc,3584,v38
s_nop 1
v_addc_co_u32 v39,vcc,0,v39,vcc
global_load_dwordx4 v[96:99],v[38:39],off
v_add_co_u32 v38,vcc,3584,v38
s_nop 1
v_addc_co_u32 v39,vcc,0,v39,vcc
global_load_dwordx4 v[100:103],v[38:39],off
v_add_co_u32 v38,vcc,3584,v38
s_nop 1
v_addc_co_u32 v39,vcc,0,v39,vcc
global_load_dwordx4 v[104:107],v[38:39],off
v_add_co_u32 v38,vcc,3584,v38
s_nop 1
v_addc_co_u32 v39,vcc,0,v39,vcc
s_waitcnt vmcnt(15)
ds_write_b128 v37,v[44:47] offset:16384
s_waitcnt vmcnt(14)
ds_write_b128 v37,v[48:51] offset:17408
s_waitcnt vmcnt(13)
ds_write_b128 v37,v[52:55] offset:18432
s_waitcnt vmcnt(12)
ds_write_b128 v37,v[56:59] offset:19456
s_waitcnt vmcnt(11)
ds_write_b128 v37,v[60:63] offset:20480
s_waitcnt vmcnt(10)
ds_write_b128 v37,v[64:67] offset:21504
s_waitcnt vmcnt(9)
ds_write_b128 v37,v[68:71] offset:22528
s_waitcnt vmcnt(8)
ds_write_b128 v37,v[72:75] offset:23552
s_waitcnt lgkmcnt(0)
s_waitcnt vmcnt(7)
ds_write_b128 v37,v[76:79] offset:24576
s_waitcnt vmcnt(6)
ds_write_b128 v37,v[80:83] offset:25600
s_waitcnt vmcnt(5)
ds_write_b128 v37,v[84:87] offset:26624
s_waitcnt vmcnt(4)
ds_write_b128 v37,v[88:91] offset:27648
s_waitcnt vmcnt(3)
ds_write_b128 v37,v[92:95] offset:28672
s_waitcnt vmcnt(2)
ds_write_b128 v37,v[96:99] offset:29696
s_waitcnt vmcnt(1)
ds_write_b128 v37,v[100:103] offset:30720
s_waitcnt vmcnt(0)
ds_write_b128 v37,v[104:107] offset:31744
s_waitcnt lgkmcnt(0)
v_mov_b32 v123,159744
s_cmp_lg_u32 s46,0
s_cbranch_scc1 L_gbd_21
v_mov_b32 v124,128
L_gb_20:
buffer_load_dword v125,v124,s[12:15],0 offen sc1
s_waitcnt vmcnt(0)
v_readfirstlane_b32 s56,v125
ds_write_b32 v123,v125
s_bitcmp1_b32 s56,8
s_cbranch_scc1 L_gbd_21
s_sleep 4
s_sub_u32 s49,s49,1
s_cmp_gt_i32 s49,0
s_cbranch_scc1 L_gb_20
s_branch L_abort
L_gbd_21:
s_waitcnt lgkmcnt(0)
s_barrier
ds_read_b32 v125,v123
s_waitcnt lgkmcnt(0)
v_readfirstlane_b32 s56,v125
s_barrier
s_lshr_b32 s56,s56,16
s_andn2_b32 s56,s56,s3
s_cbranch_scc1 L_spread
s_cmp_lg_u32 s3,0
s_cbranch_scc1 L_wm
v_and_b32 v120,15,v1
v_lshrrev_b32 v121,4,v1
v_mov_b32 v17,1
s_lshl_b32 s56,s46,15
v_add_u32 v18,s56,v0
s_lshl_b32 s56,s46,2
v_add_u32 v125,s56,v121
v_xor_b32 v126,v125,v120
v_lshlrev_b32 v126,4,v126
v_lshl_add_u32 v20,v125,10,v126
v_add_u32 v125,0,v121
v_xor_b32 v125,v125,v120
v_lshlrev_b32 v125,4,v125
v_lshl_add_u32 v125,v120,8,v125
v_add_u32 v4,131072,v125
v_add_u32 v125,4,v121
v_xor_b32 v125,v125,v120
v_lshlrev_b32 v125,4,v125
v_lshl_add_u32 v125,v120,8,v125
v_add_u32 v5,131072,v125
v_add_u32 v125,8,v121
v_xor_b32 v125,v125,v120
v_lshlrev_b32 v125,4,v125
v_lshl_add_u32 v125,v120,8,v125
v_add_u32 v6,131072,v125
v_add_u32 v125,12,v121
v_xor_b32 v125,v125,v120
v_lshlrev_b32 v125,4,v125
v_lshl_add_u32 v125,v120,8,v125
v_add_u32 v7,131072,v125
v_lshlrev_b32 v21,5,v120
v_and_b32 v125,1,v121
v_lshl_add_u32 v21,v125,4,v21
s_lshl_b32 s56,s46,9
v_lshrrev_b32 v125,1,v121
v_lshl_add_u32 v21,v125,11,v21
s_add_u32 s56,s56,155648
v_add_u32 v21,s56,v21
v_lshlrev_b32 v22,4,v120
v_lshl_add_u32 v22,v121,10,v22
s_lshl_b32 s56,s46,8
v_add_u32 v22,s56,v22
s_mov_b32 s54,0
s_mov_b32 s31,0
s_mov_b32 s53,3
s_mov_b32 s72,0x80000000
s_mov_b32 s73,0
s_mov_b32 s77,-1
s_mov_b32 s86,0
s_mov_b32 s19,0
s_mov_b32 s74,1308622848
s_mov_b32 s75,2454267026
v_and_b32 v23,15,v1
v_lshlrev_b32 v23,3,v23
v_lshrrev_b32 v16,4,v1
v_lshl_add_u32 v23,v16,13,v23
v_mov_b32 v19,159744
v_lshl_add_u32 v16,v16,2,v19
s_ff1_i32_b64 s30,s[74:75]
s_bitset0_b64 s[74:75],s30
s_min_u32 s30,s30,127
s_lshl_b32 s70,s30,15
s_add_u32 s70,s70,0
s_add_u32 s71,s70,16384
L_mo_25:
s_cmp_lg_u32 s19,0
s_cbranch_scc1 L_mo_26
s_add_u32 m0,s50,131072
s_nop 0
buffer_load_dwordx4 v20,s[8:11],s70 offen offset:0 sc1 lds
s_add_u32 m0,s50,135168
s_nop 0
buffer_load_dwordx4 v20,s[8:11],s71 offen offset:0 sc1 lds
s_add_u32 m0,s50,139008
s_nop 0
buffer_load_dwordx4 v20,s[8:11],s70 offen offset:256 sc1 lds
s_add_u32 m0,s50,143104
s_nop 0
buffer_load_dwordx4 v20,s[8:11],s71 offen offset:256 sc1 lds
s_add_u32 m0,s50,146944
s_nop 0
buffer_load_dwordx4 v20,s[8:11],s70 offen offset:512 sc1 lds
s_add_u32 m0,s50,151040
s_nop 0
buffer_load_dwordx4 v20,s[8:11],s71 offen offset:512 sc1 lds
s_mov_b32 s19,1
s_waitcnt vmcnt(0)
L_mo_26:
s_mov_b32 s51,s30
s_mov_b64 s[68:69],s[70:71]
s_ff1_i32_b64 s30,s[74:75]
s_bitset0_b64 s[74:75],s30
s_min_u32 s30,s30,127
s_lshl_b32 s70,s30,15
s_add_u32 s70,s70,0
s_add_u32 s71,s70,16384
s_lshl_b32 s76,s31,13
s_add_u32 s76,s76,10487040
s_lshl_b32 s58,s51,5
s_add_u32 s58,s58,s47
s_mul_i32 s58,s58,24576
s_add_u32 s58,s58,100663296
s_add_u32 s61,s58,s50
s_add_u32 s62,s61,4096
s_add_u32 s63,s61,16384
s_add_u32 s64,s61,20480
s_add_u32 s65,s61,s50
s_add_u32 s65,s65,8192
s_waitcnt vmcnt(12)
s_barrier
ds_read_b128 v[72:75],v4 offset:0
ds_read_b128 v[76:79],v4 offset:4096
ds_read_b128 v[80:83],v5 offset:0
ds_read_b128 v[84:87],v5 offset:4096
s_add_u32 m0,s50,154880
s_nop 0
buffer_load_dwordx4 v20,s[8:11],s68 offen offset:768 sc1 lds
s_add_u32 m0,s50,158976
s_nop 0
buffer_load_dwordx4 v20,s[8:11],s69 offen offset:768 sc1 lds
s_waitcnt lgkmcnt(2)
v_mfma_f32_16x16x32_bf16 v[40:43],a[128:131],v[72:75],0
ds_read_b128 v[108:111],v6 offset:0
v_mfma_f32_16x16x32_bf16 v[56:59],v[72:75],v[128:131],0
v_mfma_f32_16x16x32_bf16 v[24:27],a[0:3],v[72:75],0
ds_read_b128 v[112:115],v6 offset:4096
v_mfma_f32_16x16x32_bf16 v[44:47],a[128:131],v[76:79],0
v_mfma_f32_16x16x32_bf16 v[60:63],v[76:79],v[128:131],0
v_mfma_f32_16x16x32_bf16 v[28:31],a[0:3],v[76:79],0
v_mfma_f32_16x16x32_bf16 v[48:51],a[136:139],v[72:75],0
v_mfma_f32_16x16x32_bf16 v[64:67],v[72:75],v[136:139],0
v_mfma_f32_16x16x32_bf16 v[32:35],a[8:11],v[72:75],0
v_mfma_f32_16x16x32_bf16 v[52:55],a[136:139],v[76:79],0
v_mfma_f32_16x16x32_bf16 v[68:71],v[76:79],v[136:139],0
v_mfma_f32_16x16x32_bf16 v[36:39],a[8:11],v[76:79],0
s_waitcnt lgkmcnt(2)
v_mfma_f32_16x16x32_bf16 v[40:43],a[132:135],v[80:83],v[40:43]
ds_read_b128 v[72:75],v7 offset:0
v_mfma_f32_16x16x32_bf16 v[56:59],v[80:83],v[132:135],v[56:59]
v_mfma_f32_16x16x32_bf16 v[24:27],a[4:7],v[80:83],v[24:27]
ds_read_b128 v[76:79],v7 offset:4096
v_mfma_f32_16x16x32_bf16 v[44:47],a[132:135],v[84:87],v[44:47]
v_mfma_f32_16x16x32_bf16 v[60:63],v[84:87],v[132:135],v[60:63]
v_mfma_f32_16x16x32_bf16 v[28:31],a[4:7],v[84:87],v[28:31]
v_mfma_f32_16x16x32_bf16 v[48:51],a[140:143],v[80:83],v[48:51]
v_mfma_f32_16x16x32_bf16 v[64:67],v[80:83],v[140:143],v[64:67]
v_mfma_f32_16x16x32_bf16 v[32:35],a[12:15],v[80:83],v[32:35]
v_mfma_f32_16x16x32_bf16 v[52:55],a[140:143],v[84:87],v[52:55]
v_mfma_f32_16x16x32_bf16 v[68:71],v[84:87],v[140:143],v[68:71]
v_mfma_f32_16x16x32_bf16 v[36:39],a[12:15],v[84:87],v[36:39]
s_waitcnt vmcnt(12)
s_barrier
s_waitcnt lgkmcnt(2)
v_mfma_f32_16x16x32_bf16 v[40:43],a[144:147],v[108:111],v[40:43]
ds_read_b128 v[80:83],v4 offset:8192
v_mfma_f32_16x16x32_bf16 v[56:59],v[108:111],v[144:147],v[56:59]
v_mfma_f32_16x16x32_bf16 v[24:27],a[16:19],v[108:111],v[24:27]
ds_read_b128 v[84:87],v4 offset:12288
v_mfma_f32_16x16x32_bf16 v[44:47],a[144:147],v[112:115],v[44:47]
v_mfma_f32_16x16x32_bf16 v[60:63],v[112:115],v[144:147],v[60:63]
v_mfma_f32_16x16x32_bf16 v[28:31],a[16:19],v[112:115],v[28:31]
v_mfma_f32_16x16x32_bf16 v[48:51],a[152:155],v[108:111],v[48:51]
v_mfma_f32_16x16x32_bf16 v[64:67],v[108:111],v[152:155],v[64:67]
v_mfma_f32_16x16x32_bf16 v[32:35],a[24:27],v[108:111],v[32:35]
v_mfma_f32_16x16x32_bf16 v[52:55],a[152:155],v[112:115],v[52:55]
v_mfma_f32_16x16x32_bf16 v[68:71],v[112:115],v[152:155],v[68:71]
v_mfma_f32_16x16x32_bf16 v[36:39],a[24:27],v[112:115],v[36:39]
s_waitcnt lgkmcnt(2)
v_mfma_f32_16x16x32_bf16 v[40:43],a[148:151],v[72:75],v[40:43]
ds_read_b128 v[108:111],v5 offset:8192
v_mfma_f32_16x16x32_bf16 v[56:59],v[72:75],v[148:151],v[56:59]
v_mfma_f32_16x16x32_bf16 v[24:27],a[20:23],v[72:75],v[24:27]
ds_read_b128 v[112:115],v5 offset:12288
v_mfma_f32_16x16x32_bf16 v[44:47],a[148:151],v[76:79],v[44:47]
v_mfma_f32_16x16x32_bf16 v[60:63],v[76:79],v[148:151],v[60:63]
v_mfma_f32_16x16x32_bf16 v[28:31],a[20:23],v[76:79],v[28:31]
v_mfma_f32_16x16x32_bf16 v[48:51],a[156:159],v[72:75],v[48:51]
v_mfma_f32_16x16x32_bf16 v[64:67],v[72:75],v[156:159],v[64:67]
v_mfma_f32_16x16x32_bf16 v[32:35],a[28:31],v[72:75],v[32:35]
v_mfma_f32_16x16x32_bf16 v[52:55],a[156:159],v[76:79],v[52:55]
v_mfma_f32_16x16x32_bf16 v[68:71],v[76:79],v[156:159],v[68:71]
v_mfma_f32_16x16x32_bf16 v[36:39],a[28:31],v[76:79],v[36:39]
s_waitcnt lgkmcnt(2)
v_mfma_f32_16x16x32_bf16 v[40:43],a[160:163],v[80:83],v[40:43]
ds_read_b128 v[72:75],v6 offset:8192
v_mfma_f32_16x16x32_bf16 v[56:59],v[80:83],v[160:163],v[56:59]
v_mfma_f32_16x16x32_bf16 v[24:27],a[32:35],v[80:83],v[24:27]
ds_read_b128 v[76:79],v6 offset:12288
v_mfma_f32_16x16x32_bf16 v[44:47],a[160:163],v[84:87],v[44:47]
v_mfma_f32_16x16x32_bf16 v[60:63],v[84:87],v[160:163],v[60:63]
v_mfma_f32_16x16x32_bf16 v[28:31],a[32:35],v[84:87],v[28:31]
v_mfma_f32_16x16x32_bf16 v[48:51],a[168:171],v[80:83],v[48:51]
v_mfma_f32_16x16x32_bf16 v[64:67],v[80:83],v[168:171],v[64:67]
v_mfma_f32_16x16x32_bf16 v[32:35],a[40:43],v[80:83],v[32:35]
v_mfma_f32_16x16x32_bf16 v[52:55],a[168:171],v[84:87],v[52:55]
v_mfma_f32_16x16x32_bf16 v[68:71],v[84:87],v[168:171],v[68:71]
v_mfma_f32_16x16x32_bf16 v[36:39],a[40:43],v[84:87],v[36:39]
s_waitcnt lgkmcnt(2)
v_mfma_f32_16x16x32_bf16 v[40:43],a[164:167],v[108:111],v[40:43]
ds_read_b128 v[80:83],v7 offset:8192
v_mfma_f32_16x16x32_bf16 v[56:59],v[108:111],v[164:167],v[56:59]
v_mfma_f32_16x16x32_bf16 v[24:27],a[36:39],v[108:111],v[24:27]
ds_read_b128 v[84:87],v7 offset:12288
v_mfma_f32_16x16x32_bf16 v[44:47],a[164:167],v[112:115],v[44:47]
v_mfma_f32_16x16x32_bf16 v[60:63],v[112:115],v[164:167],v[60:63]
v_mfma_f32_16x16x32_bf16 v[28:31],a[36:39],v[112:115],v[28:31]
v_mfma_f32_16x16x32_bf16 v[48:51],a[172:175],v[108:111],v[48:51]
v_mfma_f32_16x16x32_bf16 v[64:67],v[108:111],v[172:175],v[64:67]
v_mfma_f32_16x16x32_bf16 v[32:35],a[44:47],v[108:111],v[32:35]
v_mfma_f32_16x16x32_bf16 v[52:55],a[172:175],v[112:115],v[52:55]
v_mfma_f32_16x16x32_bf16 v[68:71],v[112:115],v[172:175],v[68:71]
v_mfma_f32_16x16x32_bf16 v[36:39],a[44:47],v[112:115],v[36:39]
s_waitcnt vmcnt(10)
s_barrier
s_waitcnt lgkmcnt(2)
v_mfma_f32_16x16x32_bf16 v[40:43],a[176:179],v[72:75],v[40:43]
ds_read_b128 v[108:111],v4 offset:16384
v_mfma_f32_16x16x32_bf16 v[56:59],v[72:75],v[176:179],v[56:59]
v_mfma_f32_16x16x32_bf16 v[24:27],a[48:51],v[72:75],v[24:27]
ds_read_b128 v[112:115],v4 offset:20480
v_mfma_f32_16x16x32_bf16 v[44:47],a[176:179],v[76:79],v[44:47]
v_mfma_f32_16x16x32_bf16 v[60:63],v[76:79],v[176:179],v[60:63]
v_mfma_f32_16x16x32_bf16 v[28:31],a[48:51],v[76:79],v[28:31]
v_mfma_f32_16x16x32_bf16 v[48:51],a[184:187],v[72:75],v[48:51]
v_mfma_f32_16x16x32_bf16 v[64:67],v[72:75],v[184:187],v[64:67]
v_mfma_f32_16x16x32_bf16 v[32:35],a[56:59],v[72:75],v[32:35]
v_mfma_f32_16x16x32_bf16 v[52:55],a[184:187],v[76:79],v[52:55]
v_mfma_f32_16x16x32_bf16 v[68:71],v[76:79],v[184:187],v[68:71]
v_mfma_f32_16x16x32_bf16 v[36:39],a[56:59],v[76:79],v[36:39]
s_waitcnt vmcnt(2)
s_barrier
s_or_b32 s72,s72,s52
buffer_store_dword v17,off,s[8:11],s72 sc1
s_waitcnt lgkmcnt(2)
v_mfma_f32_16x16x32_bf16 v[40:43],a[180:183],v[80:83],v[40:43]
ds_read_b128 v[72:75],v5 offset:16384
v_mfma_f32_16x16x32_bf16 v[56:59],v[80:83],v[180:183],v[56:59]
v_mfma_f32_16x16x32_bf16 v[24:27],a[52:55],v[80:83],v[24:27]
ds_read_b128 v[76:79],v5 offset:20480
v_mfma_f32_16x16x32_bf16 v[44:47],a[180:183],v[84:87],v[44:47]
v_mfma_f32_16x16x32_bf16 v[60:63],v[84:87],v[180:183],v[60:63]
v_mfma_f32_16x16x32_bf16 v[28:31],a[52:55],v[84:87],v[28:31]
v_mfma_f32_16x16x32_bf16 v[48:51],a[188:191],v[80:83],v[48:51]
v_mfma_f32_16x16x32_bf16 v[64:67],v[80:83],v[188:191],v[64:67]
v_mfma_f32_16x16x32_bf16 v[32:35],a[60:63],v[80:83],v[32:35]
v_mfma_f32_16x16x32_bf16 v[52:55],a[188:191],v[84:87],v[52:55]
v_mfma_f32_16x16x32_bf16 v[68:71],v[84:87],v[188:191],v[68:71]
v_mfma_f32_16x16x32_bf16 v[36:39],a[60:63],v[84:87],v[36:39]
s_waitcnt lgkmcnt(2)
v_mfma_f32_16x16x32_bf16 v[40:43],a[192:195],v[108:111],v[40:43]
ds_read_b128 v[80:83],v6 offset:16384
v_mfma_f32_16x16x32_bf16 v[56:59],v[108:111],v[192:195],v[56:59]
v_mfma_f32_16x16x32_bf16 v[24:27],a[64:67],v[108:111],v[24:27]
ds_read_b128 v[84:87],v6 offset:20480
v_mfma_f32_16x16x32_bf16 v[44:47],a[192:195],v[112:115],v[44:47]
v_mfma_f32_16x16x32_bf16 v[60:63],v[112:115],v[192:195],v[60:63]
v_mfma_f32_16x16x32_bf16 v[28:31],a[64:67],v[112:115],v[28:31]
v_mfma_f32_16x16x32_bf16 v[48:51],a[200:203],v[108:111],v[48:51]
v_mfma_f32_16x16x32_bf16 v[64:67],v[108:111],v[200:203],v[64:67]
v_mfma_f32_16x16x32_bf16 v[32:35],a[72:75],v[108:111],v[32:35]
v_mfma_f32_16x16x32_bf16 v[52:55],a[200:203],v[112:115],v[52:55]
v_mfma_f32_16x16x32_bf16 v[68:71],v[112:115],v[200:203],v[68:71]
v_mfma_f32_16x16x32_bf16 v[36:39],a[72:75],v[112:115],v[36:39]
s_waitcnt lgkmcnt(2)
v_mfma_f32_16x16x32_bf16 v[40:43],a[196:199],v[72:75],v[40:43]
ds_read_b128 v[108:111],v7 offset:16384
v_mfma_f32_16x16x32_bf16 v[56:59],v[72:75],v[196:199],v[56:59]
v_mfma_f32_16x16x32_bf16 v[24:27],a[68:71],v[72:75],v[24:27]
ds_read_b128 v[112:115],v7 offset:20480
v_mfma_f32_16x16x32_bf16 v[44:47],a[196:199],v[76:79],v[44:47]
v_mfma_f32_16x16x32_bf16 v[60:63],v[76:79],v[196:199],v[60:63]
v_mfma_f32_16x16x32_bf16 v[28:31],a[68:71],v[76:79],v[28:31]
v_mfma_f32_16x16x32_bf16 v[48:51],a[204:207],v[72:75],v[48:51]
v_mfma_f32_16x16x32_bf16 v[64:67],v[72:75],v[204:207],v[64:67]
v_mfma_f32_16x16x32_bf16 v[32:35],a[76:79],v[72:75],v[32:35]
v_mfma_f32_16x16x32_bf16 v[52:55],a[204:207],v[76:79],v[52:55]
v_mfma_f32_16x16x32_bf16 v[68:71],v[76:79],v[204:207],v[68:71]
v_mfma_f32_16x16x32_bf16 v[36:39],a[76:79],v[76:79],v[36:39]
s_waitcnt vmcnt(1)
s_barrier
s_waitcnt lgkmcnt(2)
v_mfma_f32_16x16x32_bf16 v[40:43],a[208:211],v[80:83],v[40:43]
ds_read_b128 v[72:75],v4 offset:24576
v_mfma_f32_16x16x32_bf16 v[56:59],v[80:83],v[208:211],v[56:59]
v_mfma_f32_16x16x32_bf16 v[24:27],a[80:83],v[80:83],v[24:27]
ds_read_b128 v[76:79],v4 offset:28672
v_mfma_f32_16x16x32_bf16 v[44:47],a[208:211],v[84:87],v[44:47]
v_mfma_f32_16x16x32_bf16 v[60:63],v[84:87],v[208:211],v[60:63]
v_mfma_f32_16x16x32_bf16 v[28:31],a[80:83],v[84:87],v[28:31]
v_mfma_f32_16x16x32_bf16 v[48:51],a[216:219],v[80:83],v[48:51]
v_mfma_f32_16x16x32_bf16 v[64:67],v[80:83],v[216:219],v[64:67]
v_mfma_f32_16x16x32_bf16 v[32:35],a[88:91],v[80:83],v[32:35]
v_mfma_f32_16x16x32_bf16 v[52:55],a[216:219],v[84:87],v[52:55]
v_mfma_f32_16x16x32_bf16 v[68:71],v[84:87],v[216:219],v[68:71]
v_mfma_f32_16x16x32_bf16 v[36:39],a[88:91],v[84:87],v[36:39]
s_waitcnt lgkmcnt(2)
v_mfma_f32_16x16x32_bf16 v[40:43],a[212:215],v[108:111],v[40:43]
ds_read_b128 v[80:83],v5 offset:24576
v_mfma_f32_16x16x32_bf16 v[56:59],v[108:111],v[212:215],v[56:59]
v_mfma_f32_16x16x32_bf16 v[24:27],a[84:87],v[108:111],v[24:27]
ds_read_b128 v[84:87],v5 offset:28672
v_mfma_f32_16x16x32_bf16 v[44:47],a[212:215],v[112:115],v[44:47]
v_mfma_f32_16x16x32_bf16 v[60:63],v[112:115],v[212:215],v[60:63]
v_mfma_f32_16x16x32_bf16 v[28:31],a[84:87],v[112:115],v[28:31]
v_mfma_f32_16x16x32_bf16 v[48:51],a[220:223],v[108:111],v[48:51]
v_mfma_f32_16x16x32_bf16 v[64:67],v[108:111],v[220:223],v[64:67]
v_mfma_f32_16x16x32_bf16 v[32:35],a[92:95],v[108:111],v[32:35]
v_mfma_f32_16x16x32_bf16 v[52:55],a[220:223],v[112:115],v[52:55]
v_mfma_f32_16x16x32_bf16 v[68:71],v[112:115],v[220:223],v[68:71]
v_mfma_f32_16x16x32_bf16 v[36:39],a[92:95],v[112:115],v[36:39]
s_barrier
s_waitcnt lgkmcnt(2)
v_mfma_f32_16x16x32_bf16 v[40:43],a[224:227],v[72:75],v[40:43]
ds_read_b128 v[108:111],v6 offset:24576
v_mfma_f32_16x16x32_bf16 v[56:59],v[72:75],v[224:227],v[56:59]
s_add_u32 m0,s50,131072
v_mfma_f32_16x16x32_bf16 v[24:27],a[96:99],v[72:75],v[24:27]
ds_read_b128 v[112:115],v6 offset:28672
v_mfma_f32_16x16x32_bf16 v[44:47],a[224:227],v[76:79],v[44:47]
buffer_load_dwordx4 v20,s[8:11],s70 offen offset:0 sc1 lds
v_mfma_f32_16x16x32_bf16 v[60:63],v[76:79],v[224:227],v[60:63]
s_add_u32 m0,s50,135168
v_mfma_f32_16x16x32_bf16 v[28:31],a[96:99],v[76:79],v[28:31]
buffer_load_dwordx4 v20,s[8:11],s71 offen offset:0 sc1 lds
v_mfma_f32_16x16x32_bf16 v[48:51],a[232:235],v[72:75],v[48:51]
s_add_u32 m0,s50,139008
v_mfma_f32_16x16x32_bf16 v[64:67],v[72:75],v[232:235],v[64:67]
buffer_load_dwordx4 v20,s[8:11],s70 offen offset:256 sc1 lds
v_mfma_f32_16x16x32_bf16 v[32:35],a[104:107],v[72:75],v[32:35]
s_add_u32 m0,s50,143104
v_mfma_f32_16x16x32_bf16 v[52:55],a[232:235],v[76:79],v[52:55]
buffer_load_dwordx4 v20,s[8:11],s71 offen offset:256 sc1 lds
v_mfma_f32_16x16x32_bf16 v[68:71],v[76:79],v[232:235],v[68:71]
s_add_u32 m0,s50,146944
v_mfma_f32_16x16x32_bf16 v[36:39],a[104:107],v[76:79],v[36:39]
buffer_load_dwordx4 v20,s[8:11],s70 offen offset:512 sc1 lds
s_waitcnt lgkmcnt(2)
v_mfma_f32_16x16x32_bf16 v[40:43],a[228:231],v[80:83],v[40:43]
ds_read_b128 v[72:75],v7 offset:24576
v_mfma_f32_16x16x32_bf16 v[56:59],v[80:83],v[228:231],v[56:59]
s_add_u32 m0,s50,151040
v_mfma_f32_16x16x32_bf16 v[24:27],a[100:103],v[80:83],v[24:27]
ds_read_b128 v[76:79],v7 offset:28672
v_mfma_f32_16x16x32_bf16 v[44:47],a[228:231],v[84:87],v[44:47]
buffer_load_dwordx4 v20,s[8:11],s71 offen offset:512 sc1 lds
v_mfma_f32_16x16x32_bf16 v[60:63],v[84:87],v[228:231],v[60:63]
buffer_load_dwordx2 v[124:125],v23,s[8:11],s76 offen sc1
v_mfma_f32_16x16x32_bf16 v[28:31],a[100:103],v[84:87],v[28:31]
v_mfma_f32_16x16x32_bf16 v[48:51],a[236:239],v[80:83],v[48:51]
v_mfma_f32_16x16x32_bf16 v[64:67],v[80:83],v[236:239],v[64:67]
v_mfma_f32_16x16x32_bf16 v[32:35],a[108:111],v[80:83],v[32:35]
v_mfma_f32_16x16x32_bf16 v[52:55],a[236:239],v[84:87],v[52:55]
v_mfma_f32_16x16x32_bf16 v[68:71],v[84:87],v[236:239],v[68:71]
v_mfma_f32_16x16x32_bf16 v[36:39],a[108:111],v[84:87],v[36:39]
s_waitcnt lgkmcnt(2)
v_mfma_f32_16x16x32_bf16 v[40:43],a[240:243],v[108:111],v[40:43]
v_mfma_f32_16x16x32_bf16 v[56:59],v[108:111],v[240:243],v[56:59]
v_mfma_f32_16x16x32_bf16 v[24:27],a[112:115],v[108:111],v[24:27]
v_mfma_f32_16x16x32_bf16 v[44:47],a[240:243],v[112:115],v[44:47]
v_mfma_f32_16x16x32_bf16 v[60:63],v[112:115],v[240:243],v[60:63]
v_mfma_f32_16x16x32_bf16 v[28:31],a[112:115],v[112:115],v[28:31]
v_mfma_f32_16x16x32_bf16 v[48:51],a[248:251],v[108:111],v[48:51]
v_mfma_f32_16x16x32_bf16 v[64:67],v[108:111],v[248:251],v[64:67]
v_mfma_f32_16x16x32_bf16 v[32:35],a[120:123],v[108:111],v[32:35]
v_mfma_f32_16x16x32_bf16 v[52:55],a[248:251],v[112:115],v[52:55]
v_mfma_f32_16x16x32_bf16 v[68:71],v[112:115],v[248:251],v[68:71]
v_mfma_f32_16x16x32_bf16 v[36:39],a[120:123],v[112:115],v[36:39]
s_waitcnt lgkmcnt(0)
v_mfma_f32_16x16x32_bf16 v[40:43],a[244:247],v[72:75],v[40:43]
v_mfma_f32_16x16x32_bf16 v[56:59],v[72:75],v[244:247],v[56:59]
v_mfma_f32_16x16x32_bf16 v[24:27],a[116:119],v[72:75],v[24:27]
v_mfma_f32_16x16x32_bf16 v[44:47],a[244:247],v[76:79],v[44:47]
v_mfma_f32_16x16x32_bf16 v[60:63],v[76:79],v[244:247],v[60:63]
v_mfma_f32_16x16x32_bf16 v[28:31],a[116:119],v[76:79],v[28:31]
v_mfma_f32_16x16x32_bf16 v[48:51],a[252:255],v[72:75],v[48:51]
v_mfma_f32_16x16x32_bf16 v[64:67],v[72:75],v[252:255],v[64:67]
v_mfma_f32_16x16x32_bf16 v[32:35],a[124:127],v[72:75],v[32:35]
v_mfma_f32_16x16x32_bf16 v[52:55],a[252:255],v[76:79],v[52:55]
v_mfma_f32_16x16x32_bf16 v[68:71],v[76:79],v[252:255],v[68:71]
v_mfma_f32_16x16x32_bf16 v[36:39],a[124:127],v[76:79],v[36:39]
s_lshl_b32 s56,s51,5
s_add_u32 s56,s56,s47
s_lshl_b32 s56,s56,12
s_add_u32 s56,s56,s50
s_add_u32 s56,s56,41943040
v_mov_b64 v[120:121],-1
v_mov_b64 v[122:123],-1
buffer_store_dwordx4 v[120:123],v0,s[8:11],s56 offen sc1
v_cvt_pk_bf16_f32 v72,v40,v48
v_cvt_pk_bf16_f32 v73,v41,v49
v_cvt_pk_bf16_f32 v74,v42,v50
v_cvt_pk_bf16_f32 v75,v43,v51
buffer_store_dwordx4 v[72:75],v0,s[8:11],s61 offen sc1
v_cvt_pk_bf16_f32 v76,v44,v52
v_cvt_pk_bf16_f32 v77,v45,v53
v_cvt_pk_bf16_f32 v78,v46,v54
v_cvt_pk_bf16_f32 v79,v47,v55
buffer_store_dwordx4 v[76:79],v0,s[8:11],s62 offen sc1
v_cvt_pk_bf16_f32 v80,v56,v57
v_cvt_pk_bf16_f32 v81,v58,v59
v_cvt_pk_bf16_f32 v82,v60,v61
v_cvt_pk_bf16_f32 v83,v62,v63
buffer_store_dwordx4 v[80:83],v0,s[8:11],s65 offen offset:0 sc1
v_cvt_pk_bf16_f32 v84,v64,v65
v_cvt_pk_bf16_f32 v85,v66,v67
v_cvt_pk_bf16_f32 v86,v68,v69
v_cvt_pk_bf16_f32 v87,v70,v71
buffer_store_dwordx4 v[84:87],v0,s[8:11],s65 offen offset:1024 sc1
v_cvt_pk_bf16_f32 v108,v24,v32
v_cvt_pk_bf16_f32 v109,v25,v33
v_cvt_pk_bf16_f32 v110,v26,v34
v_cvt_pk_bf16_f32 v111,v27,v35
buffer_store_dwordx4 v[108:111],v0,s[8:11],s63 offen sc1
v_cvt_pk_bf16_f32 v112,v28,v36
v_cvt_pk_bf16_f32 v113,v29,v37
v_cvt_pk_bf16_f32 v114,v30,v38
v_cvt_pk_bf16_f32 v115,v31,v39
buffer_store_dwordx4 v[112:115],v0,s[8:11],s64 offen sc1
s_lshl_b32 s72,s51,13
s_lshl2_add_u32 s72,s47,s72
s_add_u32 s72,s72,10485760
s_sub_u32 s53,s53,1
s_cmp_gt_i32 s53,0
s_cbranch_scc1 L_mo_26
s_mov_b32 s87,3
s_mov_b32 s18,0
s_waitcnt vmcnt(7)
s_branch L_mo_31
L_mo_24:
s_mov_b32 s55,s22
s_mov_b32 s22,s23
s_mov_b32 s23,s24
s_mov_b32 s24,-1
s_cmp_lg_u32 s55,-1
s_cbranch_scc1 L_mp_22
s_sub_u32 s56,s30,s31
s_cmp_gt_i32 s77,0
s_cselect_b32 s57,6,12
s_cmp_lt_i32 s56,s57
s_cbranch_scc1 L_mo_25
s_cmp_lt_i32 s56,26
s_cselect_b32 s87,s18,0
s_cmp_ge_u32 s31,56
s_cselect_b32 s56,1,s18
s_and_b32 s56,s56,s86
s_cselect_b32 s87,2,s87
s_mul_i32 s56,s87,s18
s_cmp_lg_u32 s56,0
s_cbranch_scc1 L_mo_29
s_mov_b32 s18,0
s_lshr_b32 s56,s72,31
s_or_b32 s56,s56,s87
s_cbranch_scc1 L_mo_35
s_waitcnt vmcnt(0)
s_barrier
s_or_b32 s72,s72,s52
buffer_store_dword v17,off,s[8:11],s72 sc1
s_mov_b32 s72,0x80000000
L_mo_35:
s_cmp_lg_u32 s46,0
s_cbranch_scc1 L_mo_33
s_lshl_b32 s76,s31,13
s_add_u32 s76,s76,10487040
L_mo_32:
buffer_load_dwordx2 v[124:125],v23,s[8:11],s76 offen sc1
s_sub_u32 s49,s49,1
s_cbranch_scc1 L_abort
s_waitcnt vmcnt(0)
L_mo_31:
v_min_u32 v123,v124,v125
v_max_u32 v125,v124,v125
v_cmp_eq_u32 vcc,0,v123
s_nop 1
v_cndmask_b32 v125,v125,-1,vcc
s_and_b32 s56,vcc_lo,0xffff
s_cbranch_scc0 L_mo_36
s_cmp_lg_u32 s87,0
s_cbranch_scc1 L_mo_36
s_mov_b32 s18,1
s_sleep 2
s_branch L_mo_32
L_mo_36:
v_max_u32_dpp v125,v125,v125 row_ror:8 row_mask:0xf bank_mask:0xf
s_nop 1
v_max_u32_dpp v125,v125,v125 row_ror:4 row_mask:0xf bank_mask:0xf
s_nop 1
v_max_u32_dpp v125,v125,v125 row_ror:2 row_mask:0xf bank_mask:0xf
s_nop 1
v_max_u32_dpp v125,v125,v125 row_ror:1 row_mask:0xf bank_mask:0xf
L_mo_33:
s_sub_u32 s49,s49,1
s_cbranch_scc1 L_abort
v_mov_b32 v124,s18
s_barrier
s_cmp_lg_u32 s46,0
s_cbranch_scc1 L_mo_34
ds_write_b32 v16,v125
ds_write_b32 v19,v124 offset:16
s_waitcnt lgkmcnt(0)
L_mo_34:
s_barrier
ds_read_b128 v[120:123],v19
ds_read_b32 v124,v19 offset:16
s_waitcnt lgkmcnt(0)
v_readfirstlane_b32 s55,v120
v_readfirstlane_b32 s22,v121
v_readfirstlane_b32 s23,v122
v_readfirstlane_b32 s24,v123
v_readfirstlane_b32 s18,v124
s_cmp_lg_u32 s55,-1
s_cbranch_scc1 L_mp_22
L_mo_29:
s_mov_b32 s22,-1
s_cmp_eq_u32 s87,1
s_cbranch_scc1 L_mo_25
s_cmp_eq_u32 s87,2
s_cbranch_scc1 L_mo_30
s_branch L_mo_24
L_mp_22:
s_sub_u32 s73,s73,1
s_max_i32 s73,s73,0
s_sub_u32 s77,s77,1
s_min_u32 s61,s73,2
s_cmp_lt_u32 s31,5
s_cselect_b32 s61,2,s61
s_cmp_le_u32 s55,s54
s_cbranch_scc1 L_mr_23
s_mov_b32 s77,s61
s_mov_b32 s54,s55
s_mov_b32 s86,0
s_or_b32 s61,s47,s46
s_cbranch_scc1 L_mr_23
v_mov_b32 v120,s54
v_lshlrev_b32 v121,13,v1
s_mov_b32 s61,10486784
buffer_store_dword v120,v121,s[8:11],s61 offen sc1
L_mr_23:
s_cmp_lg_u32 s31,63
s_cbranch_scc1 L_mo_27
s_min_i32 s77,s77,0
s_or_b32 s61,s47,s46
s_cbranch_scc1 L_mo_27
s_mov_b32 s59,11018240
v_lshlrev_b32 v120,2,v1
L_fp_38:
s_sleep 0
buffer_load_dword v121,v120,s[8:11],s59 offen sc1
s_sub_u32 s49,s49,1
s_cbranch_scc1 L_abort
s_waitcnt vmcnt(0)
v_cmp_eq_u32 vcc,0,v121
s_cbranch_vccnz L_fp_38
s_andn2_b32 s62,0x7ff,s54
v_lshl_or_b32 v121,s62,8,v121
s_add_u32 s59,s59,8192
buffer_store_dword v121,v120,s[8:11],s59 offen sc1
s_add_u32 s59,s59,8192
buffer_store_dword v121,v120,s[8:11],s59 offen sc1
s_add_u32 s59,s59,8192
buffer_store_dword v121,v120,s[8:11],s59 offen sc1
s_add_u32 s59,s59,8192
buffer_store_dword v121,v120,s[8:11],s59 offen sc1
s_add_u32 s59,s59,8192
buffer_store_dword v121,v120,s[8:11],s59 offen sc1
s_add_u32 s59,s59,8192
buffer_store_dword v121,v120,s[8:11],s59 offen sc1
L_mo_27:
s_add_u32 s31,s31,1
s_cmp_gt_i32 s77,0
s_cmov_b32 s18,0
s_cbranch_scc1 L_mo_24
s_cmp_lg_u32 s77,0
s_cbranch_scc1 L_mo_28
s_andn2_b32 s51,0x7ff,s54
s_lshr_b32 s51,s51,5
s_add_u32 s73,s73,2
s_mov_b32 s86,1
s_mov_b32 s19,0
s_mov_b32 s18,0
s_waitcnt vmcnt(8)
s_barrier
s_and_b32 s64,s54,0x7ff
s_sub_u32 s64,2047,s64
s_lshl_b32 s56,s64,10
s_add_u32 s58,s56,4194304
buffer_load_dwordx4 v[88:91],v0,s[8:11],s58 offen sc1
s_mov_b32 s4,s38
s_mov_b32 s5,s39
s_mov_b32 s6,1835008
s_mov_b32 s7,0x20000
v_and_b32 v9,15,v1
v_lshrrev_b32 v10,4,v1
v_lshlrev_b32 v8,14,v10
v_lshl_add_u32 v8,v9,4,v8
s_lshl_b32 s59,s47,16
s_lshl_b32 s60,s46,8
s_add_u32 s59,s59,s60
buffer_load_dwordx4 v[24:27],v8,s[4:7],s59 offen offset:0
buffer_load_dwordx4 v[28:31],v8,s[4:7],s59 offen offset:1024
buffer_load_dwordx4 v[32:35],v8,s[4:7],s59 offen offset:2048
buffer_load_dwordx4 v[36:39],v8,s[4:7],s59 offen offset:3072
s_add_u32 s59,s59,4096
buffer_load_dwordx4 v[40:43],v8,s[4:7],s59 offen offset:0
buffer_load_dwordx4 v[44:47],v8,s[4:7],s59 offen offset:1024
buffer_load_dwordx4 v[48:51],v8,s[4:7],s59 offen offset:2048
buffer_load_dwordx4 v[52:55],v8,s[4:7],s59 offen offset:3072
s_add_u32 s59,s59,4096
buffer_load_dwordx4 v[56:59],v8,s[4:7],s59 offen offset:0
buffer_load_dwordx4 v[60:63],v8,s[4:7],s59 offen offset:1024
buffer_load_dwordx4 v[64:67],v8,s[4:7],s59 offen offset:2048
buffer_load_dwordx4 v[68:71],v8,s[4:7],s59 offen offset:3072
s_add_u32 s59,s59,4096
buffer_load_dwordx4 v[72:75],v8,s[4:7],s59 offen offset:0
buffer_load_dwordx4 v[76:79],v8,s[4:7],s59 offen offset:1024
buffer_load_dwordx4 v[80:83],v8,s[4:7],s59 offen offset:2048
buffer_load_dwordx4 v[84:87],v8,s[4:7],s59 offen offset:3072
v_and_b32 v124,1,v1
v_lshlrev_b32 v124,4,v124
v_mov_b32 v125,0xffff
v_lshlrev_b32 v125,v124,v125
v_lshrrev_b32 v124,1,v9
v_cmp_eq_u32 vcc,0,v124
s_nop 1
v_cndmask_b32 v12,0,v125,vcc
v_cmp_eq_u32 vcc,1,v124
s_nop 1
v_cndmask_b32 v13,0,v125,vcc
v_cmp_eq_u32 vcc,2,v124
s_nop 1
v_cndmask_b32 v14,0,v125,vcc
v_cmp_eq_u32 vcc,3,v124
s_nop 1
v_cndmask_b32 v15,0,v125,vcc
s_waitcnt vmcnt(16)
L_mx_39:
v_max3_u32 v124,v88,v89,v90
v_max_u32 v124,v91,v124
v_cmp_eq_u32 vcc,-1,v124
s_cbranch_vccz L_mxd_40
buffer_load_dwordx4 v[88:91],v0,s[8:11],s58 offen sc1
s_sub_u32 s49,s49,1
s_cbranch_scc1 L_abort
s_waitcnt vmcnt(0)
s_branch L_mx_39
L_mxd_40:
v_lshlrev_b32 v96,16,v88
v_and_b32 v97,0xffff0000,v88
v_lshlrev_b32 v98,16,v89
v_and_b32 v99,0xffff0000,v89
v_lshlrev_b32 v100,16,v90
v_and_b32 v101,0xffff0000,v90
v_lshlrev_b32 v102,16,v91
v_and_b32 v103,0xffff0000,v91
v_readfirstlane_b32 s78,v96
s_nop 1
v_pk_add_f32 v[108:109],v[96:97],s[78:79] op_sel_hi:[1,0] neg_lo:[0,1] neg_hi:[0,1]
v_pk_add_f32 v[110:111],v[98:99],s[78:79] op_sel_hi:[1,0] neg_lo:[0,1] neg_hi:[0,1]
v_pk_add_f32 v[112:113],v[100:101],s[78:79] op_sel_hi:[1,0] neg_lo:[0,1] neg_hi:[0,1]
v_pk_add_f32 v[114:115],v[102:103],s[78:79] op_sel_hi:[1,0] neg_lo:[0,1] neg_hi:[0,1]
v_pk_add_f32 v[116:117],v[108:109],v[110:111]
v_pk_mul_f32 v[118:119],v[108:109],v[108:109]
v_pk_add_f32 v[120:121],v[112:113],v[114:115]
v_pk_fma_f32 v[118:119],v[110:111],v[110:111],v[118:119]
v_pk_add_f32 v[116:117],v[116:117],v[120:121]
v_pk_fma_f32 v[118:119],v[112:113],v[112:113],v[118:119]
v_add_f32 v116,v116,v117
v_pk_fma_f32 v[118:119],v[114:115],v[114:115],v[118:119]
v_add_f32 v118,v118,v119
s_nop 1
v_permlane32_swap_b32 v116,v118
v_add_f32 v116,v116,v118
s_nop 1
v_add_f32_dpp v116,v116,v116 row_ror:8 row_mask:0xf bank_mask:0xf
s_nop 1
v_add_f32_dpp v116,v116,v116 row_ror:4 row_mask:0xf bank_mask:0xf
s_nop 1
v_add_f32_dpp v116,v116,v116 row_ror:2 row_mask:0xf bank_mask:0xf
s_nop 1
v_add_f32_dpp v116,v116,v116 row_ror:1 row_mask:0xf bank_mask:0xf
v_mov_b32 v118,v116
s_nop 1
v_permlane16_swap_b32 v116,v118
v_add_f32 v116,v116,v118
v_mul_f32 v116,0x3b000000,v116
v_mov_b32 v118,v116
s_nop 1
v_permlane32_swap_b32 v116,v118
v_fma_f32 v118,-v116,v116,v118
v_add_f32 v116,s78,v116
v_max_f32 v118,0,v118
v_cvt_pk_bf16_f32 v118,v116,v118
v_lshlrev_b32 v116,16,v118
v_and_b32 v118,0xffff0000,v118
v_add_f32 v118,0x3727c5ac,v118
v_cvt_pk_bf16_f32 v118,v118,v118
v_and_b32 v118,0xffff0000,v118
v_sqrt_f32 v118,v118
v_pk_add_f32 v[108:109],v[96:97],v[116:117] op_sel_hi:[1,0] neg_lo:[0,1] neg_hi:[0,1]
v_pk_add_f32 v[110:111],v[98:99],v[116:117] op_sel_hi:[1,0] neg_lo:[0,1] neg_hi:[0,1]
v_pk_add_f32 v[112:113],v[100:101],v[116:117] op_sel_hi:[1,0] neg_lo:[0,1] neg_hi:[0,1]
v_pk_add_f32 v[114:115],v[102:103],v[116:117] op_sel_hi:[1,0] neg_lo:[0,1] neg_hi:[0,1]
v_cvt_pk_bf16_f32 v118,v118,v118
v_and_b32 v118,0xffff0000,v118
v_rcp_f32 v118,v118
v_cvt_pk_bf16_f32 v104,v108,v109
v_cvt_pk_bf16_f32 v105,v110,v111
v_cvt_pk_bf16_f32 v106,v112,v113
v_cvt_pk_bf16_f32 v107,v114,v115
v_lshlrev_b32 v108,16,v104
v_and_b32 v109,0xffff0000,v104
v_lshlrev_b32 v110,16,v105
v_and_b32 v111,0xffff0000,v105
v_lshlrev_b32 v112,16,v106
v_and_b32 v113,0xffff0000,v106
v_lshlrev_b32 v114,16,v107
v_and_b32 v115,0xffff0000,v107
v_pk_mul_f32 v[108:109],v[108:109],v[118:119] op_sel_hi:[1,0]
v_pk_mul_f32 v[110:111],v[110:111],v[118:119] op_sel_hi:[1,0]
v_pk_mul_f32 v[112:113],v[112:113],v[118:119] op_sel_hi:[1,0]
v_pk_mul_f32 v[114:115],v[114:115],v[118:119] op_sel_hi:[1,0]
v_cvt_pk_bf16_f32 v104,v108,v109
v_cvt_pk_bf16_f32 v105,v110,v111
v_cvt_pk_bf16_f32 v106,v112,v113
v_cvt_pk_bf16_f32 v107,v114,v115
s_mov_b32 s58,0x01000100
s_mov_b32 s59,0x03020302
v_perm_b32 v88,v104,v104,s58
v_perm_b32 v89,v104,v104,s59
v_perm_b32 v90,v105,v105,s58
v_perm_b32 v91,v105,v105,s59
v_perm_b32 v92,v106,v106,s58
v_perm_b32 v93,v106,v106,s59
v_perm_b32 v94,v107,v107,s58
v_perm_b32 v95,v107,v107,s59
v_lshlrev_b32 v8,5,v1
s_lshl_b32 s58,s46,11
s_add_u32 s58,s58,139264
v_add_u32 v8,s58,v8
ds_write_b128 v8,v[88:91]
ds_write_b128 v8,v[92:95] offset:16
s_lshl_b32 s59,s46,9
s_add_u32 s59,s58,s59
v_lshlrev_b32 v8,7,v10
v_add_u32 v8,s59,v8
s_waitcnt lgkmcnt(0)
ds_read_b128 v[108:111],v18 offset:0
ds_read_b128 v[88:91],v8 offset:0
ds_read_b128 v[92:95],v8 offset:16
ds_read_b128 v[112:115],v18 offset:1024
s_waitcnt lgkmcnt(1)
v_and_b32 v124,v12,v88
v_and_b32 v125,v13,v88
v_and_b32 v126,v14,v88
v_and_b32 v127,v15,v88
s_nop 1
v_mfma_f32_16x16x32_bf16 v[116:119],v[124:127],v[108:111],0
ds_read_b128 v[108:111],v18 offset:2048
s_waitcnt lgkmcnt(1)
v_and_b32 v124,v12,v89
v_and_b32 v125,v13,v89
v_and_b32 v126,v14,v89
v_and_b32 v127,v15,v89
s_nop 1
v_mfma_f32_16x16x32_bf16 v[116:119],v[124:127],v[112:115],v[116:119]
ds_read_b128 v[112:115],v18 offset:3072
s_waitcnt lgkmcnt(1)
v_and_b32 v124,v12,v90
v_and_b32 v125,v13,v90
v_and_b32 v126,v14,v90
v_and_b32 v127,v15,v90
s_nop 1
v_mfma_f32_16x16x32_bf16 v[116:119],v[124:127],v[108:111],v[116:119]
ds_read_b128 v[108:111],v18 offset:4096
s_waitcnt lgkmcnt(1)
v_and_b32 v124,v12,v91
v_and_b32 v125,v13,v91
v_and_b32 v126,v14,v91
v_and_b32 v127,v15,v91
s_nop 1
v_mfma_f32_16x16x32_bf16 v[116:119],v[124:127],v[112:115],v[116:119]
ds_read_b128 v[112:115],v18 offset:5120
s_waitcnt lgkmcnt(1)
v_and_b32 v124,v12,v92
v_and_b32 v125,v13,v92
v_and_b32 v126,v14,v92
v_and_b32 v127,v15,v92
s_nop 1
v_mfma_f32_16x16x32_bf16 v[116:119],v[124:127],v[108:111],v[116:119]
ds_read_b128 v[108:111],v18 offset:6144
s_waitcnt lgkmcnt(1)
v_and_b32 v124,v12,v93
v_and_b32 v125,v13,v93
v_and_b32 v126,v14,v93
v_and_b32 v127,v15,v93
s_nop 1
v_mfma_f32_16x16x32_bf16 v[116:119],v[124:127],v[112:115],v[116:119]
ds_read_b128 v[112:115],v18 offset:7168
s_waitcnt lgkmcnt(1)
v_and_b32 v124,v12,v94
v_and_b32 v125,v13,v94
v_and_b32 v126,v14,v94
v_and_b32 v127,v15,v94
s_nop 1
v_mfma_f32_16x16x32_bf16 v[116:119],v[124:127],v[108:111],v[116:119]
ds_read_b128 v[108:111],v18 offset:8192
s_waitcnt lgkmcnt(1)
v_and_b32 v124,v12,v95
v_and_b32 v125,v13,v95
v_and_b32 v126,v14,v95
v_and_b32 v127,v15,v95
s_nop 1
v_mfma_f32_16x16x32_bf16 v[116:119],v[124:127],v[112:115],v[116:119]
ds_read_b128 v[88:91],v8 offset:32
ds_read_b128 v[92:95],v8 offset:48
ds_read_b128 v[112:115],v18 offset:9216
s_waitcnt lgkmcnt(1)
v_and_b32 v124,v12,v88
v_and_b32 v125,v13,v88
v_and_b32 v126,v14,v88
v_and_b32 v127,v15,v88
s_nop 1
v_mfma_f32_16x16x32_bf16 v[116:119],v[124:127],v[108:111],v[116:119]
ds_read_b128 v[108:111],v18 offset:10240
s_waitcnt lgkmcnt(1)
v_and_b32 v124,v12,v89
v_and_b32 v125,v13,v89
v_and_b32 v126,v14,v89
v_and_b32 v127,v15,v89
s_nop 1
v_mfma_f32_16x16x32_bf16 v[116:119],v[124:127],v[112:115],v[116:119]
ds_read_b128 v[112:115],v18 offset:11264
s_waitcnt lgkmcnt(1)
v_and_b32 v124,v12,v90
v_and_b32 v125,v13,v90
v_and_b32 v126,v14,v90
v_and_b32 v127,v15,v90
s_nop 1
v_mfma_f32_16x16x32_bf16 v[116:119],v[124:127],v[108:111],v[116:119]
ds_read_b128 v[108:111],v18 offset:12288
s_waitcnt lgkmcnt(1)
v_and_b32 v124,v12,v91
v_and_b32 v125,v13,v91
v_and_b32 v126,v14,v91
v_and_b32 v127,v15,v91
s_nop 1
v_mfma_f32_16x16x32_bf16 v[116:119],v[124:127],v[112:115],v[116:119]
ds_read_b128 v[112:115],v18 offset:13312
s_waitcnt lgkmcnt(1)
v_and_b32 v124,v12,v92
v_and_b32 v125,v13,v92
v_and_b32 v126,v14,v92
v_and_b32 v127,v15,v92
s_nop 1
v_mfma_f32_16x16x32_bf16 v[116:119],v[124:127],v[108:111],v[116:119]
ds_read_b128 v[108:111],v18 offset:14336
s_waitcnt lgkmcnt(1)
v_and_b32 v124,v12,v93
v_and_b32 v125,v13,v93
v_and_b32 v126,v14,v93
v_and_b32 v127,v15,v93
s_nop 1
v_mfma_f32_16x16x32_bf16 v[116:119],v[124:127],v[112:115],v[116:119]
ds_read_b128 v[112:115],v18 offset:15360
s_waitcnt lgkmcnt(1)
v_and_b32 v124,v12,v94
v_and_b32 v125,v13,v94
v_and_b32 v126,v14,v94
v_and_b32 v127,v15,v94
s_nop 1
v_mfma_f32_16x16x32_bf16 v[116:119],v[124:127],v[108:111],v[116:119]
ds_read_b128 v[108:111],v18 offset:16384
s_waitcnt lgkmcnt(1)
v_and_b32 v124,v12,v95
v_and_b32 v125,v13,v95
v_and_b32 v126,v14,v95
v_and_b32 v127,v15,v95
s_nop 1
v_mfma_f32_16x16x32_bf16 v[116:119],v[124:127],v[112:115],v[116:119]
ds_read_b128 v[88:91],v8 offset:64
ds_read_b128 v[92:95],v8 offset:80
ds_read_b128 v[112:115],v18 offset:17408
s_waitcnt lgkmcnt(1)
v_and_b32 v124,v12,v88
v_and_b32 v125,v13,v88
v_and_b32 v126,v14,v88
v_and_b32 v127,v15,v88
s_nop 1
v_mfma_f32_16x16x32_bf16 v[116:119],v[124:127],v[108:111],v[116:119]
ds_read_b128 v[108:111],v18 offset:18432
s_waitcnt lgkmcnt(1)
v_and_b32 v124,v12,v89
v_and_b32 v125,v13,v89
v_and_b32 v126,v14,v89
v_and_b32 v127,v15,v89
s_nop 1
v_mfma_f32_16x16x32_bf16 v[116:119],v[124:127],v[112:115],v[116:119]
ds_read_b128 v[112:115],v18 offset:19456
s_waitcnt lgkmcnt(1)
v_and_b32 v124,v12,v90
v_and_b32 v125,v13,v90
v_and_b32 v126,v14,v90
v_and_b32 v127,v15,v90
s_nop 1
v_mfma_f32_16x16x32_bf16 v[116:119],v[124:127],v[108:111],v[116:119]
ds_read_b128 v[108:111],v18 offset:20480
s_waitcnt lgkmcnt(1)
v_and_b32 v124,v12,v91
v_and_b32 v125,v13,v91
v_and_b32 v126,v14,v91
v_and_b32 v127,v15,v91
s_nop 1
v_mfma_f32_16x16x32_bf16 v[116:119],v[124:127],v[112:115],v[116:119]
ds_read_b128 v[112:115],v18 offset:21504
s_waitcnt lgkmcnt(1)
v_and_b32 v124,v12,v92
v_and_b32 v125,v13,v92
v_and_b32 v126,v14,v92
v_and_b32 v127,v15,v92
s_nop 1
v_mfma_f32_16x16x32_bf16 v[116:119],v[124:127],v[108:111],v[116:119]
ds_read_b128 v[108:111],v18 offset:22528
s_waitcnt lgkmcnt(1)
v_and_b32 v124,v12,v93
v_and_b32 v125,v13,v93
v_and_b32 v126,v14,v93
v_and_b32 v127,v15,v93
s_nop 1
v_mfma_f32_16x16x32_bf16 v[116:119],v[124:127],v[112:115],v[116:119]
ds_read_b128 v[112:115],v18 offset:23552
s_waitcnt lgkmcnt(1)
v_and_b32 v124,v12,v94
v_and_b32 v125,v13,v94
v_and_b32 v126,v14,v94
v_and_b32 v127,v15,v94
s_nop 1
v_mfma_f32_16x16x32_bf16 v[116:119],v[124:127],v[108:111],v[116:119]
ds_read_b128 v[108:111],v18 offset:24576
s_waitcnt lgkmcnt(1)
v_and_b32 v124,v12,v95
v_and_b32 v125,v13,v95
v_and_b32 v126,v14,v95
v_and_b32 v127,v15,v95
s_nop 1
v_mfma_f32_16x16x32_bf16 v[116:119],v[124:127],v[112:115],v[116:119]
ds_read_b128 v[88:91],v8 offset:96
ds_read_b128 v[92:95],v8 offset:112
ds_read_b128 v[112:115],v18 offset:25600
s_waitcnt lgkmcnt(1)
v_and_b32 v124,v12,v88
v_and_b32 v125,v13,v88
v_and_b32 v126,v14,v88
v_and_b32 v127,v15,v88
s_nop 1
v_mfma_f32_16x16x32_bf16 v[116:119],v[124:127],v[108:111],v[116:119]
ds_read_b128 v[108:111],v18 offset:26624
s_waitcnt lgkmcnt(1)
v_and_b32 v124,v12,v89
v_and_b32 v125,v13,v89
v_and_b32 v126,v14,v89
v_and_b32 v127,v15,v89
s_nop 1
v_mfma_f32_16x16x32_bf16 v[116:119],v[124:127],v[112:115],v[116:119]
ds_read_b128 v[112:115],v18 offset:27648
s_waitcnt lgkmcnt(1)
v_and_b32 v124,v12,v90
v_and_b32 v125,v13,v90
v_and_b32 v126,v14,v90
v_and_b32 v127,v15,v90
s_nop 1
v_mfma_f32_16x16x32_bf16 v[116:119],v[124:127],v[108:111],v[116:119]
ds_read_b128 v[108:111],v18 offset:28672
s_waitcnt lgkmcnt(1)
v_and_b32 v124,v12,v91
v_and_b32 v125,v13,v91
v_and_b32 v126,v14,v91
v_and_b32 v127,v15,v91
s_nop 1
v_mfma_f32_16x16x32_bf16 v[116:119],v[124:127],v[112:115],v[116:119]
ds_read_b128 v[112:115],v18 offset:29696
s_waitcnt lgkmcnt(1)
v_and_b32 v124,v12,v92
v_and_b32 v125,v13,v92
v_and_b32 v126,v14,v92
v_and_b32 v127,v15,v92
s_nop 1
v_mfma_f32_16x16x32_bf16 v[116:119],v[124:127],v[108:111],v[116:119]
ds_read_b128 v[108:111],v18 offset:30720
s_waitcnt lgkmcnt(1)
v_and_b32 v124,v12,v93
v_and_b32 v125,v13,v93
v_and_b32 v126,v14,v93
v_and_b32 v127,v15,v93
s_nop 1
v_mfma_f32_16x16x32_bf16 v[116:119],v[124:127],v[112:115],v[116:119]
ds_read_b128 v[112:115],v18 offset:31744
s_waitcnt lgkmcnt(1)
v_and_b32 v124,v12,v94
v_and_b32 v125,v13,v94
v_and_b32 v126,v14,v94
v_and_b32 v127,v15,v94
s_nop 1
v_mfma_f32_16x16x32_bf16 v[116:119],v[124:127],v[108:111],v[116:119]
s_waitcnt lgkmcnt(0)
v_and_b32 v124,v12,v95
v_and_b32 v125,v13,v95
v_and_b32 v126,v14,v95
v_and_b32 v127,v15,v95
s_nop 1
v_mfma_f32_16x16x32_bf16 v[116:119],v[124:127],v[112:115],v[116:119]
v_lshlrev_b32 v8,5,v9
v_and_b32 v124,1,v10
v_lshl_add_u32 v8,v124,4,v8
v_lshrrev_b32 v124,1,v10
v_lshl_add_u32 v8,v124,11,v8
s_lshl_b32 s60,s46,9
s_add_u32 s60,s60,147456
v_add_u32 v8,s60,v8
ds_write_b128 v8,v[116:119]
v_lshlrev_b32 v8,2,v1
v_add_u32 v8,147456,v8
s_waitcnt lgkmcnt(0)
s_barrier
ds_read2st64_b32 v[88:89],v8 offset0:0 offset1:1
ds_read2st64_b32 v[90:91],v8 offset0:2 offset1:3
ds_read2st64_b32 v[92:93],v8 offset0:4 offset1:5
ds_read2st64_b32 v[94:95],v8 offset0:6 offset1:7
s_waitcnt lgkmcnt(0)
v_pk_add_f32 v[88:89],v[88:89],v[90:91]
v_pk_add_f32 v[92:93],v[92:93],v[94:95]
v_pk_add_f32 v[88:89],v[88:89],v[92:93]
v_cvt_pk_bf16_f32 v88,v88,v88
v_and_b32 v88,0xffff0000,v88
v_cvt_pk_bf16_f32 v89,v89,v89
v_and_b32 v89,0xffff0000,v89
v_mul_f32 v90,0xbfb8aa3b,v88
v_exp_f32 v90,v90
s_nop 0
v_add_f32 v90,1.0,v90
v_rcp_f32 v90,v90
s_nop 0
v_mul_f32 v88,v88,v90
v_cvt_pk_bf16_f32 v88,v88,v88
v_and_b32 v88,0xffff0000,v88
v_mul_f32 v88,v88,v89
v_cvt_pk_bf16_f32 v88,v88,v88
v_lshlrev_b32 v8,2,v1
v_add_u32 v8,s58,v8
ds_write_b32 v8,v88
v_lshlrev_b32 v8,6,v10
v_add_u32 v8,s58,v8
s_waitcnt lgkmcnt(0)
ds_read_b128 v[88:91],v8
ds_read_b128 v[92:95],v8 offset:16
ds_read_b128 v[108:111],v8 offset:32
ds_read_b128 v[112:115],v8 offset:48
s_waitcnt vmcnt(0) lgkmcnt(0)
v_and_b32 v124,v12,v88
v_and_b32 v125,v13,v88
v_and_b32 v126,v14,v88
v_and_b32 v127,v15,v88
s_nop 1
v_mfma_f32_16x16x32_bf16 v[116:119],v[124:127],v[24:27],0
v_and_b32 v124,v12,v89
v_and_b32 v125,v13,v89
v_and_b32 v126,v14,v89
v_and_b32 v127,v15,v89
s_nop 1
v_mfma_f32_16x16x32_bf16 v[116:119],v[124:127],v[28:31],v[116:119]
v_and_b32 v124,v12,v90
v_and_b32 v125,v13,v90
v_and_b32 v126,v14,v90
v_and_b32 v127,v15,v90
s_nop 1
v_mfma_f32_16x16x32_bf16 v[116:119],v[124:127],v[32:35],v[116:119]
v_and_b32 v124,v12,v91
v_and_b32 v125,v13,v91
v_and_b32 v126,v14,v91
v_and_b32 v127,v15,v91
s_nop 1
v_mfma_f32_16x16x32_bf16 v[116:119],v[124:127],v[36:39],v[116:119]
v_and_b32 v124,v12,v92
v_and_b32 v125,v13,v92
v_and_b32 v126,v14,v92
v_and_b32 v127,v15,v92
s_nop 1
v_mfma_f32_16x16x32_bf16 v[116:119],v[124:127],v[40:43],v[116:119]
v_and_b32 v124,v12,v93
v_and_b32 v125,v13,v93
v_and_b32 v126,v14,v93
v_and_b32 v127,v15,v93
s_nop 1
v_mfma_f32_16x16x32_bf16 v[116:119],v[124:127],v[44:47],v[116:119]
v_and_b32 v124,v12,v94
v_and_b32 v125,v13,v94
v_and_b32 v126,v14,v94
v_and_b32 v127,v15,v94
s_nop 1
v_mfma_f32_16x16x32_bf16 v[116:119],v[124:127],v[48:51],v[116:119]
v_and_b32 v124,v12,v95
v_and_b32 v125,v13,v95
v_and_b32 v126,v14,v95
v_and_b32 v127,v15,v95
s_nop 1
v_mfma_f32_16x16x32_bf16 v[116:119],v[124:127],v[52:55],v[116:119]
v_and_b32 v124,v12,v108
v_and_b32 v125,v13,v108
v_and_b32 v126,v14,v108
v_and_b32 v127,v15,v108
s_nop 1
v_mfma_f32_16x16x32_bf16 v[116:119],v[124:127],v[56:59],v[116:119]
v_and_b32 v124,v12,v109
v_and_b32 v125,v13,v109
v_and_b32 v126,v14,v109
v_and_b32 v127,v15,v109
s_nop 1
v_mfma_f32_16x16x32_bf16 v[116:119],v[124:127],v[60:63],v[116:119]
v_and_b32 v124,v12,v110
v_and_b32 v125,v13,v110
v_and_b32 v126,v14,v110
v_and_b32 v127,v15,v110
s_nop 1
v_mfma_f32_16x16x32_bf16 v[116:119],v[124:127],v[64:67],v[116:119]
v_and_b32 v124,v12,v111
v_and_b32 v125,v13,v111
v_and_b32 v126,v14,v111
v_and_b32 v127,v15,v111
s_nop 1
v_mfma_f32_16x16x32_bf16 v[116:119],v[124:127],v[68:71],v[116:119]
v_and_b32 v124,v12,v112
v_and_b32 v125,v13,v112
v_and_b32 v126,v14,v112
v_and_b32 v127,v15,v112
s_nop 1
v_mfma_f32_16x16x32_bf16 v[116:119],v[124:127],v[72:75],v[116:119]
v_and_b32 v124,v12,v113
v_and_b32 v125,v13,v113
v_and_b32 v126,v14,v113
v_and_b32 v127,v15,v113
s_nop 1
v_mfma_f32_16x16x32_bf16 v[116:119],v[124:127],v[76:79],v[116:119]
v_and_b32 v124,v12,v114
v_and_b32 v125,v13,v114
v_and_b32 v126,v14,v114
v_and_b32 v127,v15,v114
s_nop 1
v_mfma_f32_16x16x32_bf16 v[116:119],v[124:127],v[80:83],v[116:119]
v_and_b32 v124,v12,v115
v_and_b32 v125,v13,v115
v_and_b32 v126,v14,v115
v_and_b32 v127,v15,v115
s_nop 1
v_mfma_f32_16x16x32_bf16 v[116:119],v[124:127],v[84:87],v[116:119]
v_lshlrev_b32 v8,4,v9
v_and_b32 v124,1,v10
v_lshl_add_u32 v8,v124,3,v8
v_and_b32 v124,2,v10
v_lshl_add_u32 v8,v124,30,v8
s_lshl_b32 s65,s51,15
s_add_u32 s65,s65,92274688
s_lshl_b32 s59,s47,10
s_lshl_b32 s60,s46,8
s_add_u32 s59,s59,s60
s_add_u32 s59,s59,s65
v_cvt_pk_bf16_f32 v24,v116,v117
v_cvt_pk_bf16_f32 v25,v118,v119
buffer_store_dwordx2 v[24:25],v8,s[8:11],s59 offen
s_lshl_b32 s59,s51,13
s_lshl2_add_u32 s59,s47,s59
s_add_u32 s59,s59,10486912
s_waitcnt vmcnt(0)
s_barrier
s_or_b32 s59,s59,s52
buffer_store_dword v17,off,s[8:11],s59
s_lshl_b32 s59,s51,13
s_add_u32 s59,s59,10486912
v_and_b32 v124,31,v1
v_lshlrev_b32 v124,2,v124
L_fw_42:
buffer_load_dword v125,v124,s[8:11],s59 offen sc1
s_sub_u32 s49,s49,1
s_cbranch_scc1 L_abort
s_waitcnt vmcnt(0)
v_cmp_eq_u32 vcc,0,v125
s_cbranch_vccnz L_fw_42
s_add_u32 s63,s65,0
buffer_load_dwordx4 v[24:27],v22,s[8:11],s63 offen sc1
s_add_u32 s63,s65,4096
buffer_load_dwordx4 v[28:31],v22,s[8:11],s63 offen sc1
s_add_u32 s63,s65,8192
buffer_load_dwordx4 v[32:35],v22,s[8:11],s63 offen sc1
s_add_u32 s63,s65,12288
buffer_load_dwordx4 v[36:39],v22,s[8:11],s63 offen sc1
s_add_u32 s63,s65,16384
buffer_load_dwordx4 v[40:43],v22,s[8:11],s63 offen sc1
s_add_u32 s63,s65,20480
buffer_load_dwordx4 v[44:47],v22,s[8:11],s63 offen sc1
s_add_u32 s63,s65,24576
buffer_load_dwordx4 v[48:51],v22,s[8:11],s63 offen sc1
s_add_u32 s63,s65,28672
buffer_load_dwordx4 v[52:55],v22,s[8:11],s63 offen sc1
v_and_b32 v64,15,v1
v_and_b32 v65,1,v1
v_lshlrev_b32 v65,4,v65
v_mov_b32 v66,0x3f80
v_lshlrev_b32 v66,v65,v66
v_lshrrev_b32 v64,1,v64
v_cmp_eq_u32 vcc,0,v64
s_nop 1
v_cndmask_b32 v56,0,v66,vcc
v_cmp_eq_u32 vcc,1,v64
s_nop 1
v_cndmask_b32 v57,0,v66,vcc
v_cmp_eq_u32 vcc,2,v64
s_nop 1
v_cndmask_b32 v58,0,v66,vcc
v_cmp_eq_u32 vcc,3,v64
s_nop 1
v_cndmask_b32 v59,0,v66,vcc
s_waitcnt vmcnt(7)
s_nop 0
v_mfma_f32_16x16x32_bf16 v[60:63],v[56:59],v[24:27],0
s_waitcnt vmcnt(6)
v_mfma_f32_16x16x32_bf16 v[60:63],v[56:59],v[28:31],v[60:63]
s_waitcnt vmcnt(5)
v_mfma_f32_16x16x32_bf16 v[60:63],v[56:59],v[32:35],v[60:63]
s_waitcnt vmcnt(4)
v_mfma_f32_16x16x32_bf16 v[60:63],v[56:59],v[36:39],v[60:63]
s_waitcnt vmcnt(3)
v_mfma_f32_16x16x32_bf16 v[60:63],v[56:59],v[40:43],v[60:63]
s_waitcnt vmcnt(2)
v_mfma_f32_16x16x32_bf16 v[60:63],v[56:59],v[44:47],v[60:63]
s_waitcnt vmcnt(1)
v_mfma_f32_16x16x32_bf16 v[60:63],v[56:59],v[48:51],v[60:63]
s_waitcnt vmcnt(0)
v_mfma_f32_16x16x32_bf16 v[60:63],v[56:59],v[52:55],v[60:63]
s_nop 7
ds_write_b128 v21,v[60:63]
s_waitcnt lgkmcnt(0)
s_barrier
s_cmp_lg_u32 s46,0
s_cbranch_scc1 L_moed_41
v_lshlrev_b32 v56,5,v1
v_add_u32 v56,155648,v56
ds_read_b128 v[24:27],v56
ds_read_b128 v[28:31],v56 offset:16
s_and_b32 s59,s54,0xffff0000
s_xor_b32 s60,s59,0x80000000
s_xor_b32 s61,s59,0xffff0000
s_cmp_lt_i32 s59,0
s_cselect_b32 s59,s60,s61
v_mov_b32 v56,s59
v_mul_f32 v56,0xbfb8aa3b,v56
v_exp_f32 v56,v56
s_nop 0
v_add_f32 v56,1.0,v56
v_rcp_f32 v56,v56
s_nop 0
v_cvt_pk_bf16_f32 v56,v56,v56
v_and_b32 v56,0xffff0000,v56
v_lshlrev_b32 v48,16,v104
v_and_b32 v49,0xffff0000,v104
v_lshlrev_b32 v50,16,v105
v_and_b32 v51,0xffff0000,v105
v_lshlrev_b32 v52,16,v106
v_and_b32 v53,0xffff0000,v106
v_lshlrev_b32 v54,16,v107
v_and_b32 v55,0xffff0000,v107
s_waitcnt lgkmcnt(0)
v_cvt_pk_bf16_f32 v40,v24,v25
v_cvt_pk_bf16_f32 v41,v26,v27
v_cvt_pk_bf16_f32 v42,v28,v29
v_cvt_pk_bf16_f32 v43,v30,v31
v_lshlrev_b32 v24,16,v40
v_and_b32 v25,0xffff0000,v40
v_lshlrev_b32 v26,16,v41
v_and_b32 v27,0xffff0000,v41
v_lshlrev_b32 v28,16,v42
v_and_b32 v29,0xffff0000,v42
v_lshlrev_b32 v30,16,v43
v_and_b32 v31,0xffff0000,v43
v_mul_f32 v24,v24,v56
v_mul_f32 v25,v25,v56
v_mul_f32 v26,v26,v56
v_mul_f32 v27,v27,v56
v_mul_f32 v28,v28,v56
v_mul_f32 v29,v29,v56
v_mul_f32 v30,v30,v56
v_mul_f32 v31,v31,v56
v_cvt_pk_bf16_f32 v40,v24,v25
v_cvt_pk_bf16_f32 v41,v26,v27
v_cvt_pk_bf16_f32 v42,v28,v29
v_cvt_pk_bf16_f32 v43,v30,v31
v_lshlrev_b32 v24,16,v40
v_and_b32 v25,0xffff0000,v40
v_lshlrev_b32 v26,16,v41
v_and_b32 v27,0xffff0000,v41
v_lshlrev_b32 v28,16,v42
v_and_b32 v29,0xffff0000,v42
v_lshlrev_b32 v30,16,v43
v_and_b32 v31,0xffff0000,v43
v_add_f32 v24,v24,v48
v_add_f32 v25,v25,v49
v_add_f32 v26,v26,v50
v_add_f32 v27,v27,v51
v_add_f32 v28,v28,v52
v_add_f32 v29,v29,v53
v_add_f32 v30,v30,v54
v_add_f32 v31,v31,v55
v_cvt_pk_bf16_f32 v40,v24,v25
v_cvt_pk_bf16_f32 v41,v26,v27
v_cvt_pk_bf16_f32 v42,v28,v29
v_cvt_pk_bf16_f32 v43,v30,v31
v_lshlrev_b32 v24,16,v40
v_and_b32 v25,0xffff0000,v40
v_lshlrev_b32 v26,16,v41
v_and_b32 v27,0xffff0000,v41
v_lshlrev_b32 v28,16,v42
v_and_b32 v29,0xffff0000,v42
v_lshlrev_b32 v30,16,v43
v_and_b32 v31,0xffff0000,v43
v_add_f32 v96,v96,v24
v_add_f32 v97,v97,v25
v_add_f32 v98,v98,v26
v_add_f32 v99,v99,v27
v_add_f32 v100,v100,v28
v_add_f32 v101,v101,v29
v_add_f32 v102,v102,v30
v_add_f32 v103,v103,v31
v_cvt_pk_bf16_f32 v80,v96,v97
v_cvt_pk_bf16_f32 v81,v98,v99
v_cvt_pk_bf16_f32 v82,v100,v101
v_cvt_pk_bf16_f32 v83,v102,v103
v_lshlrev_b32 v96,16,v80
v_and_b32 v97,0xffff0000,v80
v_lshlrev_b32 v98,16,v81
v_and_b32 v99,0xffff0000,v81
v_lshlrev_b32 v100,16,v82
v_and_b32 v101,0xffff0000,v82
v_lshlrev_b32 v102,16,v83
v_and_b32 v103,0xffff0000,v83
v_readfirstlane_b32 s78,v96
s_nop 1
v_pk_add_f32 v[58:59],v[96:97],s[78:79] op_sel_hi:[1,0] neg_lo:[0,1] neg_hi:[0,1]
v_pk_add_f32 v[60:61],v[98:99],s[78:79] op_sel_hi:[1,0] neg_lo:[0,1] neg_hi:[0,1]
v_pk_add_f32 v[62:63],v[100:101],s[78:79] op_sel_hi:[1,0] neg_lo:[0,1] neg_hi:[0,1]
v_pk_add_f32 v[64:65],v[102:103],s[78:79] op_sel_hi:[1,0] neg_lo:[0,1] neg_hi:[0,1]
v_pk_add_f32 v[66:67],v[58:59],v[60:61]
v_pk_mul_f32 v[68:69],v[58:59],v[58:59]
v_pk_add_f32 v[70:71],v[62:63],v[64:65]
v_pk_fma_f32 v[68:69],v[60:61],v[60:61],v[68:69]
v_pk_add_f32 v[66:67],v[66:67],v[70:71]
v_pk_fma_f32 v[68:69],v[62:63],v[62:63],v[68:69]
v_add_f32 v66,v66,v67
v_pk_fma_f32 v[68:69],v[64:65],v[64:65],v[68:69]
v_add_f32 v68,v68,v69
s_nop 1
v_permlane32_swap_b32 v66,v68
v_add_f32 v66,v66,v68
s_nop 1
v_add_f32_dpp v66,v66,v66 row_ror:8 row_mask:0xf bank_mask:0xf
s_nop 1
v_add_f32_dpp v66,v66,v66 row_ror:4 row_mask:0xf bank_mask:0xf
s_nop 1
v_add_f32_dpp v66,v66,v66 row_ror:2 row_mask:0xf bank_mask:0xf
s_nop 1
v_add_f32_dpp v66,v66,v66 row_ror:1 row_mask:0xf bank_mask:0xf
v_mov_b32 v68,v66
s_nop 1
v_permlane16_swap_b32 v66,v68
v_add_f32 v66,v66,v68
v_mul_f32 v66,0x3b000000,v66
v_mov_b32 v68,v66
s_nop 1
v_permlane32_swap_b32 v66,v68
v_fma_f32 v68,-v66,v66,v68
v_add_f32 v66,s78,v66
v_max_f32 v68,0,v68
v_cvt_pk_bf16_f32 v68,v66,v68
v_lshlrev_b32 v66,16,v68
v_and_b32 v68,0xffff0000,v68
v_add_f32 v68,0x3727c5ac,v68
v_cvt_pk_bf16_f32 v68,v68,v68
v_and_b32 v68,0xffff0000,v68
v_sqrt_f32 v68,v68
v_pk_add_f32 v[58:59],v[96:97],v[66:67] op_sel_hi:[1,0] neg_lo:[0,1] neg_hi:[0,1]
v_pk_add_f32 v[60:61],v[98:99],v[66:67] op_sel_hi:[1,0] neg_lo:[0,1] neg_hi:[0,1]
v_pk_add_f32 v[62:63],v[100:101],v[66:67] op_sel_hi:[1,0] neg_lo:[0,1] neg_hi:[0,1]
v_pk_add_f32 v[64:65],v[102:103],v[66:67] op_sel_hi:[1,0] neg_lo:[0,1] neg_hi:[0,1]
v_cvt_pk_bf16_f32 v68,v68,v68
v_and_b32 v68,0xffff0000,v68
v_rcp_f32 v68,v68
v_cvt_pk_bf16_f32 v84,v58,v59
v_cvt_pk_bf16_f32 v85,v60,v61
v_cvt_pk_bf16_f32 v86,v62,v63
v_cvt_pk_bf16_f32 v87,v64,v65
v_lshlrev_b32 v58,16,v84
v_and_b32 v59,0xffff0000,v84
v_lshlrev_b32 v60,16,v85
v_and_b32 v61,0xffff0000,v85
v_lshlrev_b32 v62,16,v86
v_and_b32 v63,0xffff0000,v86
v_lshlrev_b32 v64,16,v87
v_and_b32 v65,0xffff0000,v87
v_pk_mul_f32 v[58:59],v[58:59],v[68:69] op_sel_hi:[1,0]
v_pk_mul_f32 v[60:61],v[60:61],v[68:69] op_sel_hi:[1,0]
v_pk_mul_f32 v[62:63],v[62:63],v[68:69] op_sel_hi:[1,0]
v_pk_mul_f32 v[64:65],v[64:65],v[68:69] op_sel_hi:[1,0]
v_cvt_pk_bf16_f32 v84,v58,v59
v_cvt_pk_bf16_f32 v85,v60,v61
v_cvt_pk_bf16_f32 v86,v62,v63
v_cvt_pk_bf16_f32 v87,v64,v65
s_lshl_b32 s58,s51,10
s_add_u32 s58,s58,11272192
s_add_u32 s59,s58,65536
s_cmp_eq_u32 s47,0
s_cselect_b32 s59,s59,0x80000000
s_add_u32 s57,s56,98566144
buffer_store_dwordx4 v[84:87],v0,s[8:11],s59 offen sc1
buffer_store_dwordx4 v[80:83],v0,s[8:11],s58 offen sc1
buffer_store_dwordx4 v[84:87],v0,s[8:11],s57 offen sc1
L_moed_41:
s_barrier
L_mo_28:
s_mov_b32 s77,-1
s_cmp_lt_u32 s31,64
s_cbranch_scc1 L_mo_24
s_cmp_eq_u32 s86,0
s_cbranch_scc1 L_mo_37
L_mo_30:
s_andn2_b32 s51,0x7ff,s54
s_lshr_b32 s51,s51,5
s_andn2_b32 s56,31,s54
v_lshrrev_b32 v2,10,v20
v_add_u32 v3,16,v2
v_add_u32 v8,96468992,v20
v_cmp_eq_u32 vcc,s56,v2
s_nop 1
v_cndmask_b32 v2,v20,v8,vcc
v_cmp_eq_u32 vcc,s56,v3
s_nop 1
v_cndmask_b32 v3,v20,v8,vcc
s_waitcnt vmcnt(0)
s_lshl_b32 s59,s51,13
s_add_u32 s59,s59,10487552
s_cmp_lg_u32 s46,0
s_cbranch_scc1 L_fd_46
v_and_b32 v124,31,v1
v_lshlrev_b32 v124,2,v124
s_branch L_ff_47
L_fw_45:
s_sleep 2
L_ff_47:
buffer_load_dword v125,v124,s[8:11],s59 offen sc1
s_sub_u32 s49,s49,1
s_cbranch_scc1 L_abort
s_waitcnt vmcnt(0)
v_cmp_eq_u32 vcc,0,v125
s_cbranch_vccnz L_fw_45
L_fd_46:
s_barrier
s_or_b32 s72,s72,s52
buffer_store_dword v17,off,s[8:11],s72 sc1
s_lshl_b32 s66,s51,15
s_add_u32 s66,s66,2097152
s_add_u32 s67,s66,16384
s_add_u32 m0,s50,131072
s_nop 0
buffer_load_dwordx4 v2,s[8:11],s66 offen offset:0 sc1 lds
s_add_u32 m0,s50,135168
s_nop 0
buffer_load_dwordx4 v3,s[8:11],s67 offen offset:0 sc1 lds
s_add_u32 m0,s50,139008
s_nop 0
buffer_load_dwordx4 v2,s[8:11],s66 offen offset:256 sc1 lds
s_add_u32 m0,s50,143104
s_nop 0
buffer_load_dwordx4 v3,s[8:11],s67 offen offset:256 sc1 lds
s_add_u32 m0,s50,146944
s_nop 0
buffer_load_dwordx4 v2,s[8:11],s66 offen offset:512 sc1 lds
s_add_u32 m0,s50,151040
s_nop 0
buffer_load_dwordx4 v3,s[8:11],s67 offen offset:512 sc1 lds
s_lshl_b32 s58,s51,5
s_add_u32 s58,s58,s47
s_mul_i32 s58,s58,24576
s_add_u32 s58,s58,201326592
s_add_u32 s61,s58,s50
s_add_u32 s62,s61,4096
s_add_u32 s63,s61,16384
s_add_u32 s64,s61,20480
s_add_u32 s65,s61,s50
s_add_u32 s65,s65,8192
s_waitcnt vmcnt(4)
s_barrier
ds_read_b128 v[104:107],v4 offset:0
ds_read_b128 v[108:111],v4 offset:4096
ds_read_b128 v[112:115],v5 offset:0
ds_read_b128 v[116:119],v5 offset:4096
s_add_u32 m0,s50,154880
s_nop 0
buffer_load_dwordx4 v2,s[8:11],s66 offen offset:768 sc1 lds
s_add_u32 m0,s50,158976
s_nop 0
buffer_load_dwordx4 v3,s[8:11],s67 offen offset:768 sc1 lds
s_waitcnt lgkmcnt(2)
v_mfma_f32_16x16x32_bf16 v[24:27],a[128:131],v[104:107],0
ds_read_b128 v[120:123],v6 offset:0
v_mfma_f32_16x16x32_bf16 v[40:43],v[104:107],v[128:131],0
v_mfma_f32_16x16x32_bf16 v[28:31],a[128:131],v[108:111],0
ds_read_b128 v[124:127],v6 offset:4096
v_mfma_f32_16x16x32_bf16 v[44:47],v[108:111],v[128:131],0
v_mfma_f32_16x16x32_bf16 v[32:35],a[136:139],v[104:107],0
v_mfma_f32_16x16x32_bf16 v[48:51],v[104:107],v[136:139],0
v_mfma_f32_16x16x32_bf16 v[36:39],a[136:139],v[108:111],0
v_mfma_f32_16x16x32_bf16 v[52:55],v[108:111],v[136:139],0
s_waitcnt lgkmcnt(2)
v_mfma_f32_16x16x32_bf16 v[24:27],a[132:135],v[112:115],v[24:27]
ds_read_b128 v[104:107],v7 offset:0
v_mfma_f32_16x16x32_bf16 v[40:43],v[112:115],v[132:135],v[40:43]
v_mfma_f32_16x16x32_bf16 v[28:31],a[132:135],v[116:119],v[28:31]
ds_read_b128 v[108:111],v7 offset:4096
v_mfma_f32_16x16x32_bf16 v[44:47],v[116:119],v[132:135],v[44:47]
v_mfma_f32_16x16x32_bf16 v[32:35],a[140:143],v[112:115],v[32:35]
v_mfma_f32_16x16x32_bf16 v[48:51],v[112:115],v[140:143],v[48:51]
v_mfma_f32_16x16x32_bf16 v[36:39],a[140:143],v[116:119],v[36:39]
v_mfma_f32_16x16x32_bf16 v[52:55],v[116:119],v[140:143],v[52:55]
s_waitcnt vmcnt(4)
s_barrier
s_waitcnt lgkmcnt(2)
v_mfma_f32_16x16x32_bf16 v[24:27],a[144:147],v[120:123],v[24:27]
ds_read_b128 v[112:115],v4 offset:8192
v_mfma_f32_16x16x32_bf16 v[40:43],v[120:123],v[144:147],v[40:43]
v_mfma_f32_16x16x32_bf16 v[28:31],a[144:147],v[124:127],v[28:31]
ds_read_b128 v[116:119],v4 offset:12288
v_mfma_f32_16x16x32_bf16 v[44:47],v[124:127],v[144:147],v[44:47]
v_mfma_f32_16x16x32_bf16 v[32:35],a[152:155],v[120:123],v[32:35]
v_mfma_f32_16x16x32_bf16 v[48:51],v[120:123],v[152:155],v[48:51]
v_mfma_f32_16x16x32_bf16 v[36:39],a[152:155],v[124:127],v[36:39]
v_mfma_f32_16x16x32_bf16 v[52:55],v[124:127],v[152:155],v[52:55]
s_waitcnt lgkmcnt(2)
v_mfma_f32_16x16x32_bf16 v[24:27],a[148:151],v[104:107],v[24:27]
ds_read_b128 v[120:123],v5 offset:8192
v_mfma_f32_16x16x32_bf16 v[40:43],v[104:107],v[148:151],v[40:43]
v_mfma_f32_16x16x32_bf16 v[28:31],a[148:151],v[108:111],v[28:31]
ds_read_b128 v[124:127],v5 offset:12288
v_mfma_f32_16x16x32_bf16 v[44:47],v[108:111],v[148:151],v[44:47]
v_mfma_f32_16x16x32_bf16 v[32:35],a[156:159],v[104:107],v[32:35]
v_mfma_f32_16x16x32_bf16 v[48:51],v[104:107],v[156:159],v[48:51]
v_mfma_f32_16x16x32_bf16 v[36:39],a[156:159],v[108:111],v[36:39]
v_mfma_f32_16x16x32_bf16 v[52:55],v[108:111],v[156:159],v[52:55]
s_waitcnt lgkmcnt(2)
v_mfma_f32_16x16x32_bf16 v[24:27],a[160:163],v[112:115],v[24:27]
ds_read_b128 v[104:107],v6 offset:8192
v_mfma_f32_16x16x32_bf16 v[40:43],v[112:115],v[160:163],v[40:43]
v_mfma_f32_16x16x32_bf16 v[28:31],a[160:163],v[116:119],v[28:31]
ds_read_b128 v[108:111],v6 offset:12288
v_mfma_f32_16x16x32_bf16 v[44:47],v[116:119],v[160:163],v[44:47]
v_mfma_f32_16x16x32_bf16 v[32:35],a[168:171],v[112:115],v[32:35]
v_mfma_f32_16x16x32_bf16 v[48:51],v[112:115],v[168:171],v[48:51]
v_mfma_f32_16x16x32_bf16 v[36:39],a[168:171],v[116:119],v[36:39]
v_mfma_f32_16x16x32_bf16 v[52:55],v[116:119],v[168:171],v[52:55]
s_waitcnt lgkmcnt(2)
v_mfma_f32_16x16x32_bf16 v[24:27],a[164:167],v[120:123],v[24:27]
ds_read_b128 v[112:115],v7 offset:8192
v_mfma_f32_16x16x32_bf16 v[40:43],v[120:123],v[164:167],v[40:43]
v_mfma_f32_16x16x32_bf16 v[28:31],a[164:167],v[124:127],v[28:31]
ds_read_b128 v[116:119],v7 offset:12288
v_mfma_f32_16x16x32_bf16 v[44:47],v[124:127],v[164:167],v[44:47]
v_mfma_f32_16x16x32_bf16 v[32:35],a[172:175],v[120:123],v[32:35]
v_mfma_f32_16x16x32_bf16 v[48:51],v[120:123],v[172:175],v[48:51]
v_mfma_f32_16x16x32_bf16 v[36:39],a[172:175],v[124:127],v[36:39]
v_mfma_f32_16x16x32_bf16 v[52:55],v[124:127],v[172:175],v[52:55]
s_waitcnt vmcnt(2)
s_barrier
s_waitcnt lgkmcnt(2)
v_mfma_f32_16x16x32_bf16 v[24:27],a[176:179],v[104:107],v[24:27]
ds_read_b128 v[120:123],v4 offset:16384
v_mfma_f32_16x16x32_bf16 v[40:43],v[104:107],v[176:179],v[40:43]
v_mfma_f32_16x16x32_bf16 v[28:31],a[176:179],v[108:111],v[28:31]
ds_read_b128 v[124:127],v4 offset:20480
v_mfma_f32_16x16x32_bf16 v[44:47],v[108:111],v[176:179],v[44:47]
v_mfma_f32_16x16x32_bf16 v[32:35],a[184:187],v[104:107],v[32:35]
v_mfma_f32_16x16x32_bf16 v[48:51],v[104:107],v[184:187],v[48:51]
v_mfma_f32_16x16x32_bf16 v[36:39],a[184:187],v[108:111],v[36:39]
v_mfma_f32_16x16x32_bf16 v[52:55],v[108:111],v[184:187],v[52:55]
s_waitcnt lgkmcnt(2)
v_mfma_f32_16x16x32_bf16 v[24:27],a[180:183],v[112:115],v[24:27]
ds_read_b128 v[104:107],v5 offset:16384
v_mfma_f32_16x16x32_bf16 v[40:43],v[112:115],v[180:183],v[40:43]
v_mfma_f32_16x16x32_bf16 v[28:31],a[180:183],v[116:119],v[28:31]
ds_read_b128 v[108:111],v5 offset:20480
v_mfma_f32_16x16x32_bf16 v[44:47],v[116:119],v[180:183],v[44:47]
v_mfma_f32_16x16x32_bf16 v[32:35],a[188:191],v[112:115],v[32:35]
v_mfma_f32_16x16x32_bf16 v[48:51],v[112:115],v[188:191],v[48:51]
v_mfma_f32_16x16x32_bf16 v[36:39],a[188:191],v[116:119],v[36:39]
v_mfma_f32_16x16x32_bf16 v[52:55],v[116:119],v[188:191],v[52:55]
s_waitcnt lgkmcnt(2)
v_mfma_f32_16x16x32_bf16 v[24:27],a[192:195],v[120:123],v[24:27]
ds_read_b128 v[112:115],v6 offset:16384
v_mfma_f32_16x16x32_bf16 v[40:43],v[120:123],v[192:195],v[40:43]
v_mfma_f32_16x16x32_bf16 v[28:31],a[192:195],v[124:127],v[28:31]
ds_read_b128 v[116:119],v6 offset:20480
v_mfma_f32_16x16x32_bf16 v[44:47],v[124:127],v[192:195],v[44:47]
v_mfma_f32_16x16x32_bf16 v[32:35],a[200:203],v[120:123],v[32:35]
v_mfma_f32_16x16x32_bf16 v[48:51],v[120:123],v[200:203],v[48:51]
v_mfma_f32_16x16x32_bf16 v[36:39],a[200:203],v[124:127],v[36:39]
v_mfma_f32_16x16x32_bf16 v[52:55],v[124:127],v[200:203],v[52:55]
s_waitcnt lgkmcnt(2)
v_mfma_f32_16x16x32_bf16 v[24:27],a[196:199],v[104:107],v[24:27]
ds_read_b128 v[120:123],v7 offset:16384
v_mfma_f32_16x16x32_bf16 v[40:43],v[104:107],v[196:199],v[40:43]
v_mfma_f32_16x16x32_bf16 v[28:31],a[196:199],v[108:111],v[28:31]
ds_read_b128 v[124:127],v7 offset:20480
v_mfma_f32_16x16x32_bf16 v[44:47],v[108:111],v[196:199],v[44:47]
v_mfma_f32_16x16x32_bf16 v[32:35],a[204:207],v[104:107],v[32:35]
v_mfma_f32_16x16x32_bf16 v[48:51],v[104:107],v[204:207],v[48:51]
v_mfma_f32_16x16x32_bf16 v[36:39],a[204:207],v[108:111],v[36:39]
v_mfma_f32_16x16x32_bf16 v[52:55],v[108:111],v[204:207],v[52:55]
s_waitcnt vmcnt(0)
s_barrier
s_waitcnt lgkmcnt(2)
v_mfma_f32_16x16x32_bf16 v[24:27],a[208:211],v[112:115],v[24:27]
ds_read_b128 v[104:107],v4 offset:24576
v_mfma_f32_16x16x32_bf16 v[40:43],v[112:115],v[208:211],v[40:43]
v_mfma_f32_16x16x32_bf16 v[28:31],a[208:211],v[116:119],v[28:31]
ds_read_b128 v[108:111],v4 offset:28672
v_mfma_f32_16x16x32_bf16 v[44:47],v[116:119],v[208:211],v[44:47]
v_mfma_f32_16x16x32_bf16 v[32:35],a[216:219],v[112:115],v[32:35]
v_mfma_f32_16x16x32_bf16 v[48:51],v[112:115],v[216:219],v[48:51]
v_mfma_f32_16x16x32_bf16 v[36:39],a[216:219],v[116:119],v[36:39]
v_mfma_f32_16x16x32_bf16 v[52:55],v[116:119],v[216:219],v[52:55]
s_waitcnt lgkmcnt(2)
v_mfma_f32_16x16x32_bf16 v[24:27],a[212:215],v[120:123],v[24:27]
ds_read_b128 v[112:115],v5 offset:24576
v_mfma_f32_16x16x32_bf16 v[40:43],v[120:123],v[212:215],v[40:43]
v_mfma_f32_16x16x32_bf16 v[28:31],a[212:215],v[124:127],v[28:31]
ds_read_b128 v[116:119],v5 offset:28672
v_mfma_f32_16x16x32_bf16 v[44:47],v[124:127],v[212:215],v[44:47]
v_mfma_f32_16x16x32_bf16 v[32:35],a[220:223],v[120:123],v[32:35]
v_mfma_f32_16x16x32_bf16 v[48:51],v[120:123],v[220:223],v[48:51]
v_mfma_f32_16x16x32_bf16 v[36:39],a[220:223],v[124:127],v[36:39]
v_mfma_f32_16x16x32_bf16 v[52:55],v[124:127],v[220:223],v[52:55]
s_waitcnt lgkmcnt(2)
v_mfma_f32_16x16x32_bf16 v[24:27],a[224:227],v[104:107],v[24:27]
ds_read_b128 v[120:123],v6 offset:24576
v_mfma_f32_16x16x32_bf16 v[40:43],v[104:107],v[224:227],v[40:43]
v_mfma_f32_16x16x32_bf16 v[28:31],a[224:227],v[108:111],v[28:31]
ds_read_b128 v[124:127],v6 offset:28672
v_mfma_f32_16x16x32_bf16 v[44:47],v[108:111],v[224:227],v[44:47]
v_mfma_f32_16x16x32_bf16 v[32:35],a[232:235],v[104:107],v[32:35]
v_mfma_f32_16x16x32_bf16 v[48:51],v[104:107],v[232:235],v[48:51]
v_mfma_f32_16x16x32_bf16 v[36:39],a[232:235],v[108:111],v[36:39]
v_mfma_f32_16x16x32_bf16 v[52:55],v[108:111],v[232:235],v[52:55]
s_waitcnt lgkmcnt(2)
v_mfma_f32_16x16x32_bf16 v[24:27],a[228:231],v[112:115],v[24:27]
ds_read_b128 v[104:107],v7 offset:24576
v_mfma_f32_16x16x32_bf16 v[40:43],v[112:115],v[228:231],v[40:43]
v_mfma_f32_16x16x32_bf16 v[28:31],a[228:231],v[116:119],v[28:31]
ds_read_b128 v[108:111],v7 offset:28672
v_mfma_f32_16x16x32_bf16 v[44:47],v[116:119],v[228:231],v[44:47]
v_mfma_f32_16x16x32_bf16 v[32:35],a[236:239],v[112:115],v[32:35]
v_mfma_f32_16x16x32_bf16 v[48:51],v[112:115],v[236:239],v[48:51]
v_mfma_f32_16x16x32_bf16 v[36:39],a[236:239],v[116:119],v[36:39]
v_mfma_f32_16x16x32_bf16 v[52:55],v[116:119],v[236:239],v[52:55]
s_waitcnt lgkmcnt(2)
v_mfma_f32_16x16x32_bf16 v[24:27],a[240:243],v[120:123],v[24:27]
ds_read_b128 v[112:115],v4 offset:0
v_mfma_f32_16x16x32_bf16 v[40:43],v[120:123],v[240:243],v[40:43]
v_mfma_f32_16x16x32_bf16 v[28:31],a[240:243],v[124:127],v[28:31]
ds_read_b128 v[116:119],v4 offset:4096
v_mfma_f32_16x16x32_bf16 v[44:47],v[124:127],v[240:243],v[44:47]
v_mfma_f32_16x16x32_bf16 v[32:35],a[248:251],v[120:123],v[32:35]
v_mfma_f32_16x16x32_bf16 v[48:51],v[120:123],v[248:251],v[48:51]
v_mfma_f32_16x16x32_bf16 v[36:39],a[248:251],v[124:127],v[36:39]
v_mfma_f32_16x16x32_bf16 v[52:55],v[124:127],v[248:251],v[52:55]
s_waitcnt lgkmcnt(2)
v_mfma_f32_16x16x32_bf16 v[24:27],a[244:247],v[104:107],v[24:27]
ds_read_b128 v[120:123],v5 offset:0
v_mfma_f32_16x16x32_bf16 v[40:43],v[104:107],v[244:247],v[40:43]
v_mfma_f32_16x16x32_bf16 v[28:31],a[244:247],v[108:111],v[28:31]
ds_read_b128 v[124:127],v5 offset:4096
v_mfma_f32_16x16x32_bf16 v[44:47],v[108:111],v[244:247],v[44:47]
v_mfma_f32_16x16x32_bf16 v[32:35],a[252:255],v[104:107],v[32:35]
v_mfma_f32_16x16x32_bf16 v[48:51],v[104:107],v[252:255],v[48:51]
v_mfma_f32_16x16x32_bf16 v[36:39],a[252:255],v[108:111],v[36:39]
v_mfma_f32_16x16x32_bf16 v[52:55],v[108:111],v[252:255],v[52:55]
s_waitcnt lgkmcnt(2)
v_mfma_f32_16x16x32_bf16 v[88:91],a[0:3],v[112:115],0
ds_read_b128 v[104:107],v6 offset:0
v_mfma_f32_16x16x32_bf16 v[92:95],a[0:3],v[116:119],0
v_mfma_f32_16x16x32_bf16 v[96:99],a[8:11],v[112:115],0
ds_read_b128 v[108:111],v6 offset:4096
v_mfma_f32_16x16x32_bf16 v[100:103],a[8:11],v[116:119],0
s_waitcnt lgkmcnt(2)
v_mfma_f32_16x16x32_bf16 v[88:91],a[4:7],v[120:123],v[88:91]
ds_read_b128 v[112:115],v7 offset:0
v_mfma_f32_16x16x32_bf16 v[92:95],a[4:7],v[124:127],v[92:95]
v_cvt_pk_bf16_f32 v56,v24,v32
v_cvt_pk_bf16_f32 v57,v25,v33
v_mfma_f32_16x16x32_bf16 v[96:99],a[12:15],v[120:123],v[96:99]
ds_read_b128 v[116:119],v7 offset:4096
v_mfma_f32_16x16x32_bf16 v[100:103],a[12:15],v[124:127],v[100:103]
v_cvt_pk_bf16_f32 v58,v26,v34
v_cvt_pk_bf16_f32 v59,v27,v35
s_waitcnt lgkmcnt(2)
v_mfma_f32_16x16x32_bf16 v[88:91],a[16:19],v[104:107],v[88:91]
ds_read_b128 v[120:123],v4 offset:8192
v_mfma_f32_16x16x32_bf16 v[92:95],a[16:19],v[108:111],v[92:95]
buffer_store_dwordx4 v[56:59],v0,s[8:11],s61 offen sc1
v_cvt_pk_bf16_f32 v60,v28,v36
v_mfma_f32_16x16x32_bf16 v[96:99],a[24:27],v[104:107],v[96:99]
ds_read_b128 v[124:127],v4 offset:12288
v_mfma_f32_16x16x32_bf16 v[100:103],a[24:27],v[108:111],v[100:103]
v_cvt_pk_bf16_f32 v61,v29,v37
v_cvt_pk_bf16_f32 v62,v30,v38
s_waitcnt lgkmcnt(2)
v_mfma_f32_16x16x32_bf16 v[88:91],a[20:23],v[112:115],v[88:91]
ds_read_b128 v[104:107],v5 offset:8192
v_mfma_f32_16x16x32_bf16 v[92:95],a[20:23],v[116:119],v[92:95]
v_cvt_pk_bf16_f32 v63,v31,v39
buffer_store_dwordx4 v[60:63],v0,s[8:11],s62 offen sc1
v_mfma_f32_16x16x32_bf16 v[96:99],a[28:31],v[112:115],v[96:99]
ds_read_b128 v[108:111],v5 offset:12288
v_mfma_f32_16x16x32_bf16 v[100:103],a[28:31],v[116:119],v[100:103]
v_cvt_pk_bf16_f32 v64,v40,v41
v_cvt_pk_bf16_f32 v65,v42,v43
s_waitcnt lgkmcnt(2)
v_mfma_f32_16x16x32_bf16 v[88:91],a[32:35],v[120:123],v[88:91]
ds_read_b128 v[112:115],v6 offset:8192
v_mfma_f32_16x16x32_bf16 v[92:95],a[32:35],v[124:127],v[92:95]
v_cvt_pk_bf16_f32 v66,v44,v45
v_cvt_pk_bf16_f32 v67,v46,v47
v_mfma_f32_16x16x32_bf16 v[96:99],a[40:43],v[120:123],v[96:99]
ds_read_b128 v[116:119],v6 offset:12288
v_mfma_f32_16x16x32_bf16 v[100:103],a[40:43],v[124:127],v[100:103]
buffer_store_dwordx4 v[64:67],v0,s[8:11],s65 offen offset:0 sc1
v_cvt_pk_bf16_f32 v68,v48,v49
s_waitcnt lgkmcnt(2)
v_mfma_f32_16x16x32_bf16 v[88:91],a[36:39],v[104:107],v[88:91]
ds_read_b128 v[120:123],v7 offset:8192
v_mfma_f32_16x16x32_bf16 v[92:95],a[36:39],v[108:111],v[92:95]
v_cvt_pk_bf16_f32 v69,v50,v51
v_cvt_pk_bf16_f32 v70,v52,v53
v_mfma_f32_16x16x32_bf16 v[96:99],a[44:47],v[104:107],v[96:99]
ds_read_b128 v[124:127],v7 offset:12288
v_mfma_f32_16x16x32_bf16 v[100:103],a[44:47],v[108:111],v[100:103]
v_cvt_pk_bf16_f32 v71,v54,v55
buffer_store_dwordx4 v[68:71],v0,s[8:11],s65 offen offset:1024 sc1
s_waitcnt lgkmcnt(2)
v_mfma_f32_16x16x32_bf16 v[88:91],a[48:51],v[112:115],v[88:91]
ds_read_b128 v[104:107],v4 offset:16384
v_mfma_f32_16x16x32_bf16 v[92:95],a[48:51],v[116:119],v[92:95]
v_mfma_f32_16x16x32_bf16 v[96:99],a[56:59],v[112:115],v[96:99]
ds_read_b128 v[108:111],v4 offset:20480
v_mfma_f32_16x16x32_bf16 v[100:103],a[56:59],v[116:119],v[100:103]
s_waitcnt lgkmcnt(2)
v_mfma_f32_16x16x32_bf16 v[88:91],a[52:55],v[120:123],v[88:91]
ds_read_b128 v[112:115],v5 offset:16384
v_mfma_f32_16x16x32_bf16 v[92:95],a[52:55],v[124:127],v[92:95]
v_mfma_f32_16x16x32_bf16 v[96:99],a[60:63],v[120:123],v[96:99]
ds_read_b128 v[116:119],v5 offset:20480
v_mfma_f32_16x16x32_bf16 v[100:103],a[60:63],v[124:127],v[100:103]
s_waitcnt lgkmcnt(2)
v_mfma_f32_16x16x32_bf16 v[88:91],a[64:67],v[104:107],v[88:91]
ds_read_b128 v[120:123],v6 offset:16384
v_mfma_f32_16x16x32_bf16 v[92:95],a[64:67],v[108:111],v[92:95]
v_mfma_f32_16x16x32_bf16 v[96:99],a[72:75],v[104:107],v[96:99]
ds_read_b128 v[124:127],v6 offset:20480
v_mfma_f32_16x16x32_bf16 v[100:103],a[72:75],v[108:111],v[100:103]
s_waitcnt lgkmcnt(2)
v_mfma_f32_16x16x32_bf16 v[88:91],a[68:71],v[112:115],v[88:91]
ds_read_b128 v[104:107],v7 offset:16384
v_mfma_f32_16x16x32_bf16 v[92:95],a[68:71],v[116:119],v[92:95]
v_mfma_f32_16x16x32_bf16 v[96:99],a[76:79],v[112:115],v[96:99]
ds_read_b128 v[108:111],v7 offset:20480
v_mfma_f32_16x16x32_bf16 v[100:103],a[76:79],v[116:119],v[100:103]
s_waitcnt lgkmcnt(2)
v_mfma_f32_16x16x32_bf16 v[88:91],a[80:83],v[120:123],v[88:91]
ds_read_b128 v[112:115],v4 offset:24576
v_mfma_f32_16x16x32_bf16 v[92:95],a[80:83],v[124:127],v[92:95]
v_mfma_f32_16x16x32_bf16 v[96:99],a[88:91],v[120:123],v[96:99]
ds_read_b128 v[116:119],v4 offset:28672
v_mfma_f32_16x16x32_bf16 v[100:103],a[88:91],v[124:127],v[100:103]
s_waitcnt lgkmcnt(2)
v_mfma_f32_16x16x32_bf16 v[88:91],a[84:87],v[104:107],v[88:91]
ds_read_b128 v[120:123],v5 offset:24576
v_mfma_f32_16x16x32_bf16 v[92:95],a[84:87],v[108:111],v[92:95]
v_mfma_f32_16x16x32_bf16 v[96:99],a[92:95],v[104:107],v[96:99]
ds_read_b128 v[124:127],v5 offset:28672
v_mfma_f32_16x16x32_bf16 v[100:103],a[92:95],v[108:111],v[100:103]
s_waitcnt lgkmcnt(2)
v_mfma_f32_16x16x32_bf16 v[88:91],a[96:99],v[112:115],v[88:91]
ds_read_b128 v[104:107],v6 offset:24576
v_mfma_f32_16x16x32_bf16 v[92:95],a[96:99],v[116:119],v[92:95]
v_mfma_f32_16x16x32_bf16 v[96:99],a[104:107],v[112:115],v[96:99]
ds_read_b128 v[108:111],v6 offset:28672
v_mfma_f32_16x16x32_bf16 v[100:103],a[104:107],v[116:119],v[100:103]
s_waitcnt lgkmcnt(2)
v_mfma_f32_16x16x32_bf16 v[88:91],a[100:103],v[120:123],v[88:91]
ds_read_b128 v[112:115],v7 offset:24576
v_mfma_f32_16x16x32_bf16 v[92:95],a[100:103],v[124:127],v[92:95]
v_mfma_f32_16x16x32_bf16 v[96:99],a[108:111],v[120:123],v[96:99]
ds_read_b128 v[116:119],v7 offset:28672
v_mfma_f32_16x16x32_bf16 v[100:103],a[108:111],v[124:127],v[100:103]
s_waitcnt lgkmcnt(2)
v_mfma_f32_16x16x32_bf16 v[88:91],a[112:115],v[104:107],v[88:91]
v_mfma_f32_16x16x32_bf16 v[92:95],a[112:115],v[108:111],v[92:95]
v_mfma_f32_16x16x32_bf16 v[96:99],a[120:123],v[104:107],v[96:99]
v_mfma_f32_16x16x32_bf16 v[100:103],a[120:123],v[108:111],v[100:103]
s_waitcnt lgkmcnt(0)
v_mfma_f32_16x16x32_bf16 v[88:91],a[116:119],v[112:115],v[88:91]
v_mfma_f32_16x16x32_bf16 v[92:95],a[116:119],v[116:119],v[92:95]
v_mfma_f32_16x16x32_bf16 v[96:99],a[124:127],v[112:115],v[96:99]
v_mfma_f32_16x16x32_bf16 v[100:103],a[124:127],v[116:119],v[100:103]
s_nop 3
v_cvt_pk_bf16_f32 v104,v88,v96
v_cvt_pk_bf16_f32 v105,v89,v97
v_cvt_pk_bf16_f32 v106,v90,v98
v_cvt_pk_bf16_f32 v107,v91,v99
v_cvt_pk_bf16_f32 v108,v92,v100
v_cvt_pk_bf16_f32 v109,v93,v101
v_cvt_pk_bf16_f32 v110,v94,v102
v_cvt_pk_bf16_f32 v111,v95,v103
buffer_store_dwordx4 v[104:107],v0,s[8:11],s63 offen sc1
buffer_store_dwordx4 v[108:111],v0,s[8:11],s64 offen sc1
s_waitcnt vmcnt(6)
s_barrier
s_add_u32 m0,s50,131072
s_nop 0
buffer_load_dwordx4 v20,s[8:11],s70 offen offset:0 sc1 lds
s_add_u32 m0,s50,135168
s_nop 0
buffer_load_dwordx4 v20,s[8:11],s71 offen offset:0 sc1 lds
s_add_u32 m0,s50,139008
s_nop 0
buffer_load_dwordx4 v20,s[8:11],s70 offen offset:256 sc1 lds
s_add_u32 m0,s50,143104
s_nop 0
buffer_load_dwordx4 v20,s[8:11],s71 offen offset:256 sc1 lds
s_add_u32 m0,s50,146944
s_nop 0
buffer_load_dwordx4 v20,s[8:11],s70 offen offset:512 sc1 lds
s_add_u32 m0,s50,151040
s_nop 0
buffer_load_dwordx4 v20,s[8:11],s71 offen offset:512 sc1 lds
s_lshl_b32 s59,s51,13
s_lshl2_add_u32 s59,s47,s59
s_add_u32 s59,s59,10487680
s_waitcnt vmcnt(0)
s_barrier
s_or_b32 s59,s59,s52
buffer_store_dword v17,off,s[8:11],s59 sc1
s_mov_b32 s72,0x80000000
s_mov_b32 s86,0
s_mov_b32 s19,1
s_mov_b32 s18,0
s_cmp_lt_u32 s31,64
s_cbranch_scc1 L_mo_24
L_mo_37:
s_mov_b32 s51,64
s_and_b32 s61,s54,0x7ff
s_sub_u32 s61,2047,s61
s_lshr_b32 s61,s61,5
s_cmp_lg_u32 s46,0
s_cbranch_scc1 L_mw_48
s_mov_b32 s59,11018240
v_lshlrev_b32 v2,2,v1
L_fp_49:
s_sleep 2
buffer_load_dword v3,v2,s[8:11],s59 offen sc1
s_sub_u32 s49,s49,1
s_cbranch_scc1 L_abort
s_waitcnt vmcnt(0)
v_cmp_eq_u32 vcc,0,v3
s_cbranch_vccnz L_fp_49
v_cmp_le_u32 vcc,s61,v1
s_nop 1
v_cndmask_b32 v2,1,2,vcc
v_cmp_ne_u32 s[84:85],v2,v3
s_lshl_b32 s56,s47,1
s_lshr_b64 s[20:21],s[84:85],s56
v_lshrrev_b32 v2,5,v1
v_lshrrev_b32 v3,v2,s20
v_and_b32 v3,1,v3
v_mul_u32_u24 v3,768,v3
v_lshlrev_b32 v2,13,v2
v_sub_u32 v2,v2,v3
v_and_b32 v3,31,v1
v_lshl_add_u32 v2,v3,2,v2
v_add_u32 v2,1536,v2
s_lshl_b32 s59,s47,14
s_add_u32 s59,s59,10485760
L_fp_50:
s_sleep 1
buffer_load_dword v3,v2,s[8:11],s59 offen sc1
s_sub_u32 s49,s49,1
s_cbranch_scc1 L_abort
s_waitcnt vmcnt(0)
v_cmp_eq_u32 vcc,0,v3
s_cbranch_vccnz L_fp_50
v_max_u32_dpp v3,v3,v3 row_ror:8 row_mask:0xf bank_mask:0xf
s_nop 1
v_max_u32_dpp v3,v3,v3 row_ror:4 row_mask:0xf bank_mask:0xf
s_nop 1
v_max_u32_dpp v3,v3,v3 row_ror:2 row_mask:0xf bank_mask:0xf
s_nop 1
v_max_u32_dpp v3,v3,v3 row_ror:1 row_mask:0xf bank_mask:0xf
v_mov_b32 v2,v3
s_nop 1
v_permlane16_swap_b32 v3,v2
v_max_u32 v3,v3,v2
v_mov_b32 v2,v3
s_nop 1
v_permlane32_swap_b32 v3,v2
v_max_u32 v3,v3,v2
s_lshl_b32 s59,s51,13
s_lshl2_add_u32 s59,s47,s59
s_add_u32 s59,s59,10487424
buffer_store_dword v3,off,s[8:11],s59
L_mw_48:
s_barrier
s_lshl_b32 s59,s51,13
s_add_u32 s59,s59,10487424
v_and_b32 v124,31,v1
v_lshlrev_b32 v124,2,v124
s_branch L_ff_53
L_fw_51:
s_sleep 1
L_ff_53:
buffer_load_dword v125,v124,s[8:11],s59 offen sc1
s_sub_u32 s49,s49,1
s_cbranch_scc1 L_abort
s_waitcnt vmcnt(0)
v_cmp_eq_u32 vcc,0,v125
s_cbranch_vccnz L_fw_51
v_max_u32_dpp v125,v125,v125 row_ror:8 row_mask:0xf bank_mask:0xf
s_nop 1
v_max_u32_dpp v125,v125,v125 row_ror:4 row_mask:0xf bank_mask:0xf
s_nop 1
v_max_u32_dpp v125,v125,v125 row_ror:2 row_mask:0xf bank_mask:0xf
s_nop 1
v_max_u32_dpp v125,v125,v125 row_ror:1 row_mask:0xf bank_mask:0xf
v_mov_b32 v124,v125
s_nop 1
v_permlane16_swap_b32 v125,v124
v_max_u32 v125,v125,v124
v_mov_b32 v124,v125
s_nop 1
v_permlane32_swap_b32 v125,v124
v_max_u32 v125,v125,v124
s_nop 0
v_readfirstlane_b32 s55,v125
s_and_b32 s64,s55,0x7ff
s_sub_u32 s64,2047,s64
s_lshl_b32 s56,s64,10
s_add_u32 s58,s56,6291456
buffer_load_dwordx4 v[88:91],v0,s[8:11],s58 offen sc1
s_mov_b32 s4,s38
s_mov_b32 s5,s39
s_mov_b32 s6,1835008
s_mov_b32 s7,0x20000
v_and_b32 v9,15,v1
v_lshrrev_b32 v10,4,v1
v_lshlrev_b32 v8,14,v10
v_lshl_add_u32 v8,v9,4,v8
s_lshl_b32 s59,s47,16
s_lshl_b32 s60,s46,8
s_add_u32 s59,s59,s60
buffer_load_dwordx4 v[24:27],v8,s[4:7],s59 offen offset:0
buffer_load_dwordx4 v[28:31],v8,s[4:7],s59 offen offset:1024
buffer_load_dwordx4 v[32:35],v8,s[4:7],s59 offen offset:2048
buffer_load_dwordx4 v[36:39],v8,s[4:7],s59 offen offset:3072
s_add_u32 s59,s59,4096
buffer_load_dwordx4 v[40:43],v8,s[4:7],s59 offen offset:0
buffer_load_dwordx4 v[44:47],v8,s[4:7],s59 offen offset:1024
buffer_load_dwordx4 v[48:51],v8,s[4:7],s59 offen offset:2048
buffer_load_dwordx4 v[52:55],v8,s[4:7],s59 offen offset:3072
s_add_u32 s59,s59,4096
buffer_load_dwordx4 v[56:59],v8,s[4:7],s59 offen offset:0
buffer_load_dwordx4 v[60:63],v8,s[4:7],s59 offen offset:1024
buffer_load_dwordx4 v[64:67],v8,s[4:7],s59 offen offset:2048
buffer_load_dwordx4 v[68:71],v8,s[4:7],s59 offen offset:3072
s_add_u32 s59,s59,4096
buffer_load_dwordx4 v[72:75],v8,s[4:7],s59 offen offset:0
buffer_load_dwordx4 v[76:79],v8,s[4:7],s59 offen offset:1024
buffer_load_dwordx4 v[80:83],v8,s[4:7],s59 offen offset:2048
buffer_load_dwordx4 v[84:87],v8,s[4:7],s59 offen offset:3072
v_and_b32 v124,1,v1
v_lshlrev_b32 v124,4,v124
v_mov_b32 v125,0xffff
v_lshlrev_b32 v125,v124,v125
v_lshrrev_b32 v124,1,v9
v_cmp_eq_u32 vcc,0,v124
s_nop 1
v_cndmask_b32 v12,0,v125,vcc
v_cmp_eq_u32 vcc,1,v124
s_nop 1
v_cndmask_b32 v13,0,v125,vcc
v_cmp_eq_u32 vcc,2,v124
s_nop 1
v_cndmask_b32 v14,0,v125,vcc
v_cmp_eq_u32 vcc,3,v124
s_nop 1
v_cndmask_b32 v15,0,v125,vcc
s_waitcnt vmcnt(16)
v_lshlrev_b32 v96,16,v88
v_and_b32 v97,0xffff0000,v88
v_lshlrev_b32 v98,16,v89
v_and_b32 v99,0xffff0000,v89
v_lshlrev_b32 v100,16,v90
v_and_b32 v101,0xffff0000,v90
v_lshlrev_b32 v102,16,v91
v_and_b32 v103,0xffff0000,v91
v_readfirstlane_b32 s78,v96
s_nop 1
v_pk_add_f32 v[108:109],v[96:97],s[78:79] op_sel_hi:[1,0] neg_lo:[0,1] neg_hi:[0,1]
v_pk_add_f32 v[110:111],v[98:99],s[78:79] op_sel_hi:[1,0] neg_lo:[0,1] neg_hi:[0,1]
v_pk_add_f32 v[112:113],v[100:101],s[78:79] op_sel_hi:[1,0] neg_lo:[0,1] neg_hi:[0,1]
v_pk_add_f32 v[114:115],v[102:103],s[78:79] op_sel_hi:[1,0] neg_lo:[0,1] neg_hi:[0,1]
v_pk_add_f32 v[116:117],v[108:109],v[110:111]
v_pk_mul_f32 v[118:119],v[108:109],v[108:109]
v_pk_add_f32 v[120:121],v[112:113],v[114:115]
v_pk_fma_f32 v[118:119],v[110:111],v[110:111],v[118:119]
v_pk_add_f32 v[116:117],v[116:117],v[120:121]
v_pk_fma_f32 v[118:119],v[112:113],v[112:113],v[118:119]
v_add_f32 v116,v116,v117
v_pk_fma_f32 v[118:119],v[114:115],v[114:115],v[118:119]
v_add_f32 v118,v118,v119
s_nop 1
v_permlane32_swap_b32 v116,v118
v_add_f32 v116,v116,v118
s_nop 1
v_add_f32_dpp v116,v116,v116 row_ror:8 row_mask:0xf bank_mask:0xf
s_nop 1
v_add_f32_dpp v116,v116,v116 row_ror:4 row_mask:0xf bank_mask:0xf
s_nop 1
v_add_f32_dpp v116,v116,v116 row_ror:2 row_mask:0xf bank_mask:0xf
s_nop 1
v_add_f32_dpp v116,v116,v116 row_ror:1 row_mask:0xf bank_mask:0xf
v_mov_b32 v118,v116
s_nop 1
v_permlane16_swap_b32 v116,v118
v_add_f32 v116,v116,v118
v_mul_f32 v116,0x3b000000,v116
v_mov_b32 v118,v116
s_nop 1
v_permlane32_swap_b32 v116,v118
v_fma_f32 v118,-v116,v116,v118
v_add_f32 v116,s78,v116
v_max_f32 v118,0,v118
v_cvt_pk_bf16_f32 v118,v116,v118
v_lshlrev_b32 v116,16,v118
v_and_b32 v118,0xffff0000,v118
v_add_f32 v118,0x3727c5ac,v118
v_cvt_pk_bf16_f32 v118,v118,v118
v_and_b32 v118,0xffff0000,v118
v_sqrt_f32 v118,v118
v_pk_add_f32 v[108:109],v[96:97],v[116:117] op_sel_hi:[1,0] neg_lo:[0,1] neg_hi:[0,1]
v_pk_add_f32 v[110:111],v[98:99],v[116:117] op_sel_hi:[1,0] neg_lo:[0,1] neg_hi:[0,1]
v_pk_add_f32 v[112:113],v[100:101],v[116:117] op_sel_hi:[1,0] neg_lo:[0,1] neg_hi:[0,1]
v_pk_add_f32 v[114:115],v[102:103],v[116:117] op_sel_hi:[1,0] neg_lo:[0,1] neg_hi:[0,1]
v_cvt_pk_bf16_f32 v118,v118,v118
v_and_b32 v118,0xffff0000,v118
v_rcp_f32 v118,v118
v_cvt_pk_bf16_f32 v104,v108,v109
v_cvt_pk_bf16_f32 v105,v110,v111
v_cvt_pk_bf16_f32 v106,v112,v113
v_cvt_pk_bf16_f32 v107,v114,v115
v_lshlrev_b32 v108,16,v104
v_and_b32 v109,0xffff0000,v104
v_lshlrev_b32 v110,16,v105
v_and_b32 v111,0xffff0000,v105
v_lshlrev_b32 v112,16,v106
v_and_b32 v113,0xffff0000,v106
v_lshlrev_b32 v114,16,v107
v_and_b32 v115,0xffff0000,v107
v_pk_mul_f32 v[108:109],v[108:109],v[118:119] op_sel_hi:[1,0]
v_pk_mul_f32 v[110:111],v[110:111],v[118:119] op_sel_hi:[1,0]
v_pk_mul_f32 v[112:113],v[112:113],v[118:119] op_sel_hi:[1,0]
v_pk_mul_f32 v[114:115],v[114:115],v[118:119] op_sel_hi:[1,0]
v_cvt_pk_bf16_f32 v104,v108,v109
v_cvt_pk_bf16_f32 v105,v110,v111
v_cvt_pk_bf16_f32 v106,v112,v113
v_cvt_pk_bf16_f32 v107,v114,v115
s_mov_b32 s58,0x01000100
s_mov_b32 s59,0x03020302
v_perm_b32 v88,v104,v104,s58
v_perm_b32 v89,v104,v104,s59
v_perm_b32 v90,v105,v105,s58
v_perm_b32 v91,v105,v105,s59
v_perm_b32 v92,v106,v106,s58
v_perm_b32 v93,v106,v106,s59
v_perm_b32 v94,v107,v107,s58
v_perm_b32 v95,v107,v107,s59
v_lshlrev_b32 v8,5,v1
s_lshl_b32 s58,s46,11
s_add_u32 s58,s58,139264
v_add_u32 v8,s58,v8
ds_write_b128 v8,v[88:91]
ds_write_b128 v8,v[92:95] offset:16
s_lshl_b32 s59,s46,9
s_add_u32 s59,s58,s59
v_lshlrev_b32 v8,7,v10
v_add_u32 v8,s59,v8
s_waitcnt lgkmcnt(0)
ds_read_b128 v[108:111],v18 offset:0
ds_read_b128 v[88:91],v8 offset:0
ds_read_b128 v[92:95],v8 offset:16
ds_read_b128 v[112:115],v18 offset:1024
s_waitcnt lgkmcnt(1)
v_and_b32 v124,v12,v88
v_and_b32 v125,v13,v88
v_and_b32 v126,v14,v88
v_and_b32 v127,v15,v88
s_nop 1
v_mfma_f32_16x16x32_bf16 v[116:119],v[124:127],v[108:111],0
ds_read_b128 v[108:111],v18 offset:2048
s_waitcnt lgkmcnt(1)
v_and_b32 v124,v12,v89
v_and_b32 v125,v13,v89
v_and_b32 v126,v14,v89
v_and_b32 v127,v15,v89
s_nop 1
v_mfma_f32_16x16x32_bf16 v[116:119],v[124:127],v[112:115],v[116:119]
ds_read_b128 v[112:115],v18 offset:3072
s_waitcnt lgkmcnt(1)
v_and_b32 v124,v12,v90
v_and_b32 v125,v13,v90
v_and_b32 v126,v14,v90
v_and_b32 v127,v15,v90
s_nop 1
v_mfma_f32_16x16x32_bf16 v[116:119],v[124:127],v[108:111],v[116:119]
ds_read_b128 v[108:111],v18 offset:4096
s_waitcnt lgkmcnt(1)
v_and_b32 v124,v12,v91
v_and_b32 v125,v13,v91
v_and_b32 v126,v14,v91
v_and_b32 v127,v15,v91
s_nop 1
v_mfma_f32_16x16x32_bf16 v[116:119],v[124:127],v[112:115],v[116:119]
ds_read_b128 v[112:115],v18 offset:5120
s_waitcnt lgkmcnt(1)
v_and_b32 v124,v12,v92
v_and_b32 v125,v13,v92
v_and_b32 v126,v14,v92
v_and_b32 v127,v15,v92
s_nop 1
v_mfma_f32_16x16x32_bf16 v[116:119],v[124:127],v[108:111],v[116:119]
ds_read_b128 v[108:111],v18 offset:6144
s_waitcnt lgkmcnt(1)
v_and_b32 v124,v12,v93
v_and_b32 v125,v13,v93
v_and_b32 v126,v14,v93
v_and_b32 v127,v15,v93
s_nop 1
v_mfma_f32_16x16x32_bf16 v[116:119],v[124:127],v[112:115],v[116:119]
ds_read_b128 v[112:115],v18 offset:7168
s_waitcnt lgkmcnt(1)
v_and_b32 v124,v12,v94
v_and_b32 v125,v13,v94
v_and_b32 v126,v14,v94
v_and_b32 v127,v15,v94
s_nop 1
v_mfma_f32_16x16x32_bf16 v[116:119],v[124:127],v[108:111],v[116:119]
ds_read_b128 v[108:111],v18 offset:8192
s_waitcnt lgkmcnt(1)
v_and_b32 v124,v12,v95
v_and_b32 v125,v13,v95
v_and_b32 v126,v14,v95
v_and_b32 v127,v15,v95
s_nop 1
v_mfma_f32_16x16x32_bf16 v[116:119],v[124:127],v[112:115],v[116:119]
ds_read_b128 v[88:91],v8 offset:32
ds_read_b128 v[92:95],v8 offset:48
ds_read_b128 v[112:115],v18 offset:9216
s_waitcnt lgkmcnt(1)
v_and_b32 v124,v12,v88
v_and_b32 v125,v13,v88
v_and_b32 v126,v14,v88
v_and_b32 v127,v15,v88
s_nop 1
v_mfma_f32_16x16x32_bf16 v[116:119],v[124:127],v[108:111],v[116:119]
ds_read_b128 v[108:111],v18 offset:10240
s_waitcnt lgkmcnt(1)
v_and_b32 v124,v12,v89
v_and_b32 v125,v13,v89
v_and_b32 v126,v14,v89
v_and_b32 v127,v15,v89
s_nop 1
v_mfma_f32_16x16x32_bf16 v[116:119],v[124:127],v[112:115],v[116:119]
ds_read_b128 v[112:115],v18 offset:11264
s_waitcnt lgkmcnt(1)
v_and_b32 v124,v12,v90
v_and_b32 v125,v13,v90
v_and_b32 v126,v14,v90
v_and_b32 v127,v15,v90
s_nop 1
v_mfma_f32_16x16x32_bf16 v[116:119],v[124:127],v[108:111],v[116:119]
ds_read_b128 v[108:111],v18 offset:12288
s_waitcnt lgkmcnt(1)
v_and_b32 v124,v12,v91
v_and_b32 v125,v13,v91
v_and_b32 v126,v14,v91
v_and_b32 v127,v15,v91
s_nop 1
v_mfma_f32_16x16x32_bf16 v[116:119],v[124:127],v[112:115],v[116:119]
ds_read_b128 v[112:115],v18 offset:13312
s_waitcnt lgkmcnt(1)
v_and_b32 v124,v12,v92
v_and_b32 v125,v13,v92
v_and_b32 v126,v14,v92
v_and_b32 v127,v15,v92
s_nop 1
v_mfma_f32_16x16x32_bf16 v[116:119],v[124:127],v[108:111],v[116:119]
ds_read_b128 v[108:111],v18 offset:14336
s_waitcnt lgkmcnt(1)
v_and_b32 v124,v12,v93
v_and_b32 v125,v13,v93
v_and_b32 v126,v14,v93
v_and_b32 v127,v15,v93
s_nop 1
v_mfma_f32_16x16x32_bf16 v[116:119],v[124:127],v[112:115],v[116:119]
ds_read_b128 v[112:115],v18 offset:15360
s_waitcnt lgkmcnt(1)
v_and_b32 v124,v12,v94
v_and_b32 v125,v13,v94
v_and_b32 v126,v14,v94
v_and_b32 v127,v15,v94
s_nop 1
v_mfma_f32_16x16x32_bf16 v[116:119],v[124:127],v[108:111],v[116:119]
ds_read_b128 v[108:111],v18 offset:16384
s_waitcnt lgkmcnt(1)
v_and_b32 v124,v12,v95
v_and_b32 v125,v13,v95
v_and_b32 v126,v14,v95
v_and_b32 v127,v15,v95
s_nop 1
v_mfma_f32_16x16x32_bf16 v[116:119],v[124:127],v[112:115],v[116:119]
ds_read_b128 v[88:91],v8 offset:64
ds_read_b128 v[92:95],v8 offset:80
ds_read_b128 v[112:115],v18 offset:17408
s_waitcnt lgkmcnt(1)
v_and_b32 v124,v12,v88
v_and_b32 v125,v13,v88
v_and_b32 v126,v14,v88
v_and_b32 v127,v15,v88
s_nop 1
v_mfma_f32_16x16x32_bf16 v[116:119],v[124:127],v[108:111],v[116:119]
ds_read_b128 v[108:111],v18 offset:18432
s_waitcnt lgkmcnt(1)
v_and_b32 v124,v12,v89
v_and_b32 v125,v13,v89
v_and_b32 v126,v14,v89
v_and_b32 v127,v15,v89
s_nop 1
v_mfma_f32_16x16x32_bf16 v[116:119],v[124:127],v[112:115],v[116:119]
ds_read_b128 v[112:115],v18 offset:19456
s_waitcnt lgkmcnt(1)
v_and_b32 v124,v12,v90
v_and_b32 v125,v13,v90
v_and_b32 v126,v14,v90
v_and_b32 v127,v15,v90
s_nop 1
v_mfma_f32_16x16x32_bf16 v[116:119],v[124:127],v[108:111],v[116:119]
ds_read_b128 v[108:111],v18 offset:20480
s_waitcnt lgkmcnt(1)
v_and_b32 v124,v12,v91
v_and_b32 v125,v13,v91
v_and_b32 v126,v14,v91
v_and_b32 v127,v15,v91
s_nop 1
v_mfma_f32_16x16x32_bf16 v[116:119],v[124:127],v[112:115],v[116:119]
ds_read_b128 v[112:115],v18 offset:21504
s_waitcnt lgkmcnt(1)
v_and_b32 v124,v12,v92
v_and_b32 v125,v13,v92
v_and_b32 v126,v14,v92
v_and_b32 v127,v15,v92
s_nop 1
v_mfma_f32_16x16x32_bf16 v[116:119],v[124:127],v[108:111],v[116:119]
ds_read_b128 v[108:111],v18 offset:22528
s_waitcnt lgkmcnt(1)
v_and_b32 v124,v12,v93
v_and_b32 v125,v13,v93
v_and_b32 v126,v14,v93
v_and_b32 v127,v15,v93
s_nop 1
v_mfma_f32_16x16x32_bf16 v[116:119],v[124:127],v[112:115],v[116:119]
ds_read_b128 v[112:115],v18 offset:23552
s_waitcnt lgkmcnt(1)
v_and_b32 v124,v12,v94
v_and_b32 v125,v13,v94
v_and_b32 v126,v14,v94
v_and_b32 v127,v15,v94
s_nop 1
v_mfma_f32_16x16x32_bf16 v[116:119],v[124:127],v[108:111],v[116:119]
ds_read_b128 v[108:111],v18 offset:24576
s_waitcnt lgkmcnt(1)
v_and_b32 v124,v12,v95
v_and_b32 v125,v13,v95
v_and_b32 v126,v14,v95
v_and_b32 v127,v15,v95
s_nop 1
v_mfma_f32_16x16x32_bf16 v[116:119],v[124:127],v[112:115],v[116:119]
ds_read_b128 v[88:91],v8 offset:96
ds_read_b128 v[92:95],v8 offset:112
ds_read_b128 v[112:115],v18 offset:25600
s_waitcnt lgkmcnt(1)
v_and_b32 v124,v12,v88
v_and_b32 v125,v13,v88
v_and_b32 v126,v14,v88
v_and_b32 v127,v15,v88
s_nop 1
v_mfma_f32_16x16x32_bf16 v[116:119],v[124:127],v[108:111],v[116:119]
ds_read_b128 v[108:111],v18 offset:26624
s_waitcnt lgkmcnt(1)
v_and_b32 v124,v12,v89
v_and_b32 v125,v13,v89
v_and_b32 v126,v14,v89
v_and_b32 v127,v15,v89
s_nop 1
v_mfma_f32_16x16x32_bf16 v[116:119],v[124:127],v[112:115],v[116:119]
ds_read_b128 v[112:115],v18 offset:27648
s_waitcnt lgkmcnt(1)
v_and_b32 v124,v12,v90
v_and_b32 v125,v13,v90
v_and_b32 v126,v14,v90
v_and_b32 v127,v15,v90
s_nop 1
v_mfma_f32_16x16x32_bf16 v[116:119],v[124:127],v[108:111],v[116:119]
ds_read_b128 v[108:111],v18 offset:28672
s_waitcnt lgkmcnt(1)
v_and_b32 v124,v12,v91
v_and_b32 v125,v13,v91
v_and_b32 v126,v14,v91
v_and_b32 v127,v15,v91
s_nop 1
v_mfma_f32_16x16x32_bf16 v[116:119],v[124:127],v[112:115],v[116:119]
ds_read_b128 v[112:115],v18 offset:29696
s_waitcnt lgkmcnt(1)
v_and_b32 v124,v12,v92
v_and_b32 v125,v13,v92
v_and_b32 v126,v14,v92
v_and_b32 v127,v15,v92
s_nop 1
v_mfma_f32_16x16x32_bf16 v[116:119],v[124:127],v[108:111],v[116:119]
ds_read_b128 v[108:111],v18 offset:30720
s_waitcnt lgkmcnt(1)
v_and_b32 v124,v12,v93
v_and_b32 v125,v13,v93
v_and_b32 v126,v14,v93
v_and_b32 v127,v15,v93
s_nop 1
v_mfma_f32_16x16x32_bf16 v[116:119],v[124:127],v[112:115],v[116:119]
ds_read_b128 v[112:115],v18 offset:31744
s_waitcnt lgkmcnt(1)
v_and_b32 v124,v12,v94
v_and_b32 v125,v13,v94
v_and_b32 v126,v14,v94
v_and_b32 v127,v15,v94
s_nop 1
v_mfma_f32_16x16x32_bf16 v[116:119],v[124:127],v[108:111],v[116:119]
s_waitcnt lgkmcnt(0)
v_and_b32 v124,v12,v95
v_and_b32 v125,v13,v95
v_and_b32 v126,v14,v95
v_and_b32 v127,v15,v95
s_nop 1
v_mfma_f32_16x16x32_bf16 v[116:119],v[124:127],v[112:115],v[116:119]
v_lshlrev_b32 v8,5,v9
v_and_b32 v124,1,v10
v_lshl_add_u32 v8,v124,4,v8
v_lshrrev_b32 v124,1,v10
v_lshl_add_u32 v8,v124,11,v8
s_lshl_b32 s60,s46,9
s_add_u32 s60,s60,147456
v_add_u32 v8,s60,v8
ds_write_b128 v8,v[116:119]
v_lshlrev_b32 v8,2,v1
v_add_u32 v8,147456,v8
s_waitcnt lgkmcnt(0)
s_barrier
ds_read2st64_b32 v[88:89],v8 offset0:0 offset1:1
ds_read2st64_b32 v[90:91],v8 offset0:2 offset1:3
ds_read2st64_b32 v[92:93],v8 offset0:4 offset1:5
ds_read2st64_b32 v[94:95],v8 offset0:6 offset1:7
s_waitcnt lgkmcnt(0)
v_pk_add_f32 v[88:89],v[88:89],v[90:91]
v_pk_add_f32 v[92:93],v[92:93],v[94:95]
v_pk_add_f32 v[88:89],v[88:89],v[92:93]
v_cvt_pk_bf16_f32 v88,v88,v88
v_and_b32 v88,0xffff0000,v88
v_cvt_pk_bf16_f32 v89,v89,v89
v_and_b32 v89,0xffff0000,v89
v_mul_f32 v90,0xbfb8aa3b,v88
v_exp_f32 v90,v90
s_nop 0
v_add_f32 v90,1.0,v90
v_rcp_f32 v90,v90
s_nop 0
v_mul_f32 v88,v88,v90
v_cvt_pk_bf16_f32 v88,v88,v88
v_and_b32 v88,0xffff0000,v88
v_mul_f32 v88,v88,v89
v_cvt_pk_bf16_f32 v88,v88,v88
v_lshlrev_b32 v8,2,v1
v_add_u32 v8,s58,v8
ds_write_b32 v8,v88
v_lshlrev_b32 v8,6,v10
v_add_u32 v8,s58,v8
s_waitcnt lgkmcnt(0)
ds_read_b128 v[88:91],v8
ds_read_b128 v[92:95],v8 offset:16
ds_read_b128 v[108:111],v8 offset:32
ds_read_b128 v[112:115],v8 offset:48
s_waitcnt vmcnt(0) lgkmcnt(0)
v_and_b32 v124,v12,v88
v_and_b32 v125,v13,v88
v_and_b32 v126,v14,v88
v_and_b32 v127,v15,v88
s_nop 1
v_mfma_f32_16x16x32_bf16 v[116:119],v[124:127],v[24:27],0
v_and_b32 v124,v12,v89
v_and_b32 v125,v13,v89
v_and_b32 v126,v14,v89
v_and_b32 v127,v15,v89
s_nop 1
v_mfma_f32_16x16x32_bf16 v[116:119],v[124:127],v[28:31],v[116:119]
v_and_b32 v124,v12,v90
v_and_b32 v125,v13,v90
v_and_b32 v126,v14,v90
v_and_b32 v127,v15,v90
s_nop 1
v_mfma_f32_16x16x32_bf16 v[116:119],v[124:127],v[32:35],v[116:119]
v_and_b32 v124,v12,v91
v_and_b32 v125,v13,v91
v_and_b32 v126,v14,v91
v_and_b32 v127,v15,v91
s_nop 1
v_mfma_f32_16x16x32_bf16 v[116:119],v[124:127],v[36:39],v[116:119]
v_and_b32 v124,v12,v92
v_and_b32 v125,v13,v92
v_and_b32 v126,v14,v92
v_and_b32 v127,v15,v92
s_nop 1
v_mfma_f32_16x16x32_bf16 v[116:119],v[124:127],v[40:43],v[116:119]
v_and_b32 v124,v12,v93
v_and_b32 v125,v13,v93
v_and_b32 v126,v14,v93
v_and_b32 v127,v15,v93
s_nop 1
v_mfma_f32_16x16x32_bf16 v[116:119],v[124:127],v[44:47],v[116:119]
v_and_b32 v124,v12,v94
v_and_b32 v125,v13,v94
v_and_b32 v126,v14,v94
v_and_b32 v127,v15,v94
s_nop 1
v_mfma_f32_16x16x32_bf16 v[116:119],v[124:127],v[48:51],v[116:119]
v_and_b32 v124,v12,v95
v_and_b32 v125,v13,v95
v_and_b32 v126,v14,v95
v_and_b32 v127,v15,v95
s_nop 1
v_mfma_f32_16x16x32_bf16 v[116:119],v[124:127],v[52:55],v[116:119]
v_and_b32 v124,v12,v108
v_and_b32 v125,v13,v108
v_and_b32 v126,v14,v108
v_and_b32 v127,v15,v108
s_nop 1
v_mfma_f32_16x16x32_bf16 v[116:119],v[124:127],v[56:59],v[116:119]
v_and_b32 v124,v12,v109
v_and_b32 v125,v13,v109
v_and_b32 v126,v14,v109
v_and_b32 v127,v15,v109
s_nop 1
v_mfma_f32_16x16x32_bf16 v[116:119],v[124:127],v[60:63],v[116:119]
v_and_b32 v124,v12,v110
v_and_b32 v125,v13,v110
v_and_b32 v126,v14,v110
v_and_b32 v127,v15,v110
s_nop 1
v_mfma_f32_16x16x32_bf16 v[116:119],v[124:127],v[64:67],v[116:119]
v_and_b32 v124,v12,v111
v_and_b32 v125,v13,v111
v_and_b32 v126,v14,v111
v_and_b32 v127,v15,v111
s_nop 1
v_mfma_f32_16x16x32_bf16 v[116:119],v[124:127],v[68:71],v[116:119]
v_and_b32 v124,v12,v112
v_and_b32 v125,v13,v112
v_and_b32 v126,v14,v112
v_and_b32 v127,v15,v112
s_nop 1
v_mfma_f32_16x16x32_bf16 v[116:119],v[124:127],v[72:75],v[116:119]
v_and_b32 v124,v12,v113
v_and_b32 v125,v13,v113
v_and_b32 v126,v14,v113
v_and_b32 v127,v15,v113
s_nop 1
v_mfma_f32_16x16x32_bf16 v[116:119],v[124:127],v[76:79],v[116:119]
v_and_b32 v124,v12,v114
v_and_b32 v125,v13,v114
v_and_b32 v126,v14,v114
v_and_b32 v127,v15,v114
s_nop 1
v_mfma_f32_16x16x32_bf16 v[116:119],v[124:127],v[80:83],v[116:119]
v_and_b32 v124,v12,v115
v_and_b32 v125,v13,v115
v_and_b32 v126,v14,v115
v_and_b32 v127,v15,v115
s_nop 1
v_mfma_f32_16x16x32_bf16 v[116:119],v[124:127],v[84:87],v[116:119]
v_lshlrev_b32 v8,4,v9
v_and_b32 v124,1,v10
v_lshl_add_u32 v8,v124,3,v8
v_and_b32 v124,2,v10
v_lshl_add_u32 v8,v124,30,v8
s_lshl_b32 s65,s51,15
s_add_u32 s65,s65,92274688
s_lshl_b32 s59,s47,10
s_lshl_b32 s60,s46,8
s_add_u32 s59,s59,s60
s_add_u32 s59,s59,s65
v_cvt_pk_bf16_f32 v24,v116,v117
v_cvt_pk_bf16_f32 v25,v118,v119
buffer_store_dwordx2 v[24:25],v8,s[8:11],s59 offen
s_lshl_b32 s59,s51,13
s_lshl2_add_u32 s59,s47,s59
s_add_u32 s59,s59,10486912
s_waitcnt vmcnt(0)
s_barrier
s_or_b32 s59,s59,s52
buffer_store_dword v17,off,s[8:11],s59
s_cmp_lg_u32 s47,0
s_cbranch_scc1 L_moed_54
s_lshl_b32 s59,s51,13
s_add_u32 s59,s59,10486912
v_and_b32 v124,31,v1
v_lshlrev_b32 v124,2,v124
L_fw_55:
buffer_load_dword v125,v124,s[8:11],s59 offen sc1
s_sub_u32 s49,s49,1
s_cbranch_scc1 L_abort
s_waitcnt vmcnt(0)
v_cmp_eq_u32 vcc,0,v125
s_cbranch_vccnz L_fw_55
s_add_u32 s63,s65,0
buffer_load_dwordx4 v[24:27],v22,s[8:11],s63 offen sc1
s_add_u32 s63,s65,4096
buffer_load_dwordx4 v[28:31],v22,s[8:11],s63 offen sc1
s_add_u32 s63,s65,8192
buffer_load_dwordx4 v[32:35],v22,s[8:11],s63 offen sc1
s_add_u32 s63,s65,12288
buffer_load_dwordx4 v[36:39],v22,s[8:11],s63 offen sc1
s_add_u32 s63,s65,16384
buffer_load_dwordx4 v[40:43],v22,s[8:11],s63 offen sc1
s_add_u32 s63,s65,20480
buffer_load_dwordx4 v[44:47],v22,s[8:11],s63 offen sc1
s_add_u32 s63,s65,24576
buffer_load_dwordx4 v[48:51],v22,s[8:11],s63 offen sc1
s_add_u32 s63,s65,28672
buffer_load_dwordx4 v[52:55],v22,s[8:11],s63 offen sc1
v_and_b32 v64,15,v1
v_and_b32 v65,1,v1
v_lshlrev_b32 v65,4,v65
v_mov_b32 v66,0x3f80
v_lshlrev_b32 v66,v65,v66
v_lshrrev_b32 v64,1,v64
v_cmp_eq_u32 vcc,0,v64
s_nop 1
v_cndmask_b32 v56,0,v66,vcc
v_cmp_eq_u32 vcc,1,v64
s_nop 1
v_cndmask_b32 v57,0,v66,vcc
v_cmp_eq_u32 vcc,2,v64
s_nop 1
v_cndmask_b32 v58,0,v66,vcc
v_cmp_eq_u32 vcc,3,v64
s_nop 1
v_cndmask_b32 v59,0,v66,vcc
s_waitcnt vmcnt(7)
s_nop 0
v_mfma_f32_16x16x32_bf16 v[60:63],v[56:59],v[24:27],0
s_waitcnt vmcnt(6)
v_mfma_f32_16x16x32_bf16 v[60:63],v[56:59],v[28:31],v[60:63]
s_waitcnt vmcnt(5)
v_mfma_f32_16x16x32_bf16 v[60:63],v[56:59],v[32:35],v[60:63]
s_waitcnt vmcnt(4)
v_mfma_f32_16x16x32_bf16 v[60:63],v[56:59],v[36:39],v[60:63]
s_waitcnt vmcnt(3)
v_mfma_f32_16x16x32_bf16 v[60:63],v[56:59],v[40:43],v[60:63]
s_waitcnt vmcnt(2)
v_mfma_f32_16x16x32_bf16 v[60:63],v[56:59],v[44:47],v[60:63]
s_waitcnt vmcnt(1)
v_mfma_f32_16x16x32_bf16 v[60:63],v[56:59],v[48:51],v[60:63]
s_waitcnt vmcnt(0)
v_mfma_f32_16x16x32_bf16 v[60:63],v[56:59],v[52:55],v[60:63]
s_nop 7
ds_write_b128 v21,v[60:63]
s_waitcnt lgkmcnt(0)
s_barrier
s_cmp_lg_u32 s46,0
s_cbranch_scc1 L_moed_54
v_lshlrev_b32 v56,5,v1
v_add_u32 v56,155648,v56
ds_read_b128 v[24:27],v56
ds_read_b128 v[28:31],v56 offset:16
s_and_b32 s59,s55,0xffff0000
s_xor_b32 s60,s59,0x80000000
s_xor_b32 s61,s59,0xffff0000
s_cmp_lt_i32 s59,0
s_cselect_b32 s59,s60,s61
v_mov_b32 v56,s59
v_mul_f32 v56,0xbfb8aa3b,v56
v_exp_f32 v56,v56
s_nop 0
v_add_f32 v56,1.0,v56
v_rcp_f32 v56,v56
s_nop 0
v_cvt_pk_bf16_f32 v56,v56,v56
v_and_b32 v56,0xffff0000,v56
v_lshlrev_b32 v48,16,v104
v_and_b32 v49,0xffff0000,v104
v_lshlrev_b32 v50,16,v105
v_and_b32 v51,0xffff0000,v105
v_lshlrev_b32 v52,16,v106
v_and_b32 v53,0xffff0000,v106
v_lshlrev_b32 v54,16,v107
v_and_b32 v55,0xffff0000,v107
s_waitcnt lgkmcnt(0)
v_cvt_pk_bf16_f32 v40,v24,v25
v_cvt_pk_bf16_f32 v41,v26,v27
v_cvt_pk_bf16_f32 v42,v28,v29
v_cvt_pk_bf16_f32 v43,v30,v31
v_lshlrev_b32 v24,16,v40
v_and_b32 v25,0xffff0000,v40
v_lshlrev_b32 v26,16,v41
v_and_b32 v27,0xffff0000,v41
v_lshlrev_b32 v28,16,v42
v_and_b32 v29,0xffff0000,v42
v_lshlrev_b32 v30,16,v43
v_and_b32 v31,0xffff0000,v43
v_mul_f32 v24,v24,v56
v_mul_f32 v25,v25,v56
v_mul_f32 v26,v26,v56
v_mul_f32 v27,v27,v56
v_mul_f32 v28,v28,v56
v_mul_f32 v29,v29,v56
v_mul_f32 v30,v30,v56
v_mul_f32 v31,v31,v56
v_cvt_pk_bf16_f32 v40,v24,v25
v_cvt_pk_bf16_f32 v41,v26,v27
v_cvt_pk_bf16_f32 v42,v28,v29
v_cvt_pk_bf16_f32 v43,v30,v31
v_lshlrev_b32 v24,16,v40
v_and_b32 v25,0xffff0000,v40
v_lshlrev_b32 v26,16,v41
v_and_b32 v27,0xffff0000,v41
v_lshlrev_b32 v28,16,v42
v_and_b32 v29,0xffff0000,v42
v_lshlrev_b32 v30,16,v43
v_and_b32 v31,0xffff0000,v43
v_add_f32 v24,v24,v48
v_add_f32 v25,v25,v49
v_add_f32 v26,v26,v50
v_add_f32 v27,v27,v51
v_add_f32 v28,v28,v52
v_add_f32 v29,v29,v53
v_add_f32 v30,v30,v54
v_add_f32 v31,v31,v55
v_cvt_pk_bf16_f32 v40,v24,v25
v_cvt_pk_bf16_f32 v41,v26,v27
v_cvt_pk_bf16_f32 v42,v28,v29
v_cvt_pk_bf16_f32 v43,v30,v31
v_lshlrev_b32 v24,16,v40
v_and_b32 v25,0xffff0000,v40
v_lshlrev_b32 v26,16,v41
v_and_b32 v27,0xffff0000,v41
v_lshlrev_b32 v28,16,v42
v_and_b32 v29,0xffff0000,v42
v_lshlrev_b32 v30,16,v43
v_and_b32 v31,0xffff0000,v43
v_add_f32 v96,v96,v24
v_add_f32 v97,v97,v25
v_add_f32 v98,v98,v26
v_add_f32 v99,v99,v27
v_add_f32 v100,v100,v28
v_add_f32 v101,v101,v29
v_add_f32 v102,v102,v30
v_add_f32 v103,v103,v31
v_cvt_pk_bf16_f32 v80,v96,v97
v_cvt_pk_bf16_f32 v81,v98,v99
v_cvt_pk_bf16_f32 v82,v100,v101
v_cvt_pk_bf16_f32 v83,v102,v103
s_mov_b32 s4,s40
s_mov_b32 s5,s41
s_mov_b32 s6,2097152
s_mov_b32 s7,0x20000
buffer_store_dwordx4 v[80:83],v0,s[4:7],s56 offen sc1
L_moed_54:
s_endpgm
L_abort:
s_endpgm
L_spread:
s_mov_b32 s3,-1
s_lshr_b32 s48,s2,5
s_and_b32 s47,s2,31
s_branch L_roles
L_ra_6:
s_and_b32 s56,s48,1
s_lshl_b32 s56,s56,12
s_add_u32 s56,s56,s50
s_and_b32 s57,s47,15
s_lshl_b32 s57,s57,13
s_add_u32 s56,s56,s57
s_mov_b32 s4,s22
s_mov_b32 s5,s23
s_mov_b32 s6,4194304
s_mov_b32 s7,0x20000
s_add_u32 s57,s56,0
buffer_load_dwordx4 v[24:27],v0,s[4:7],s57 offen
s_add_u32 s57,s56,131072
buffer_load_dwordx4 v[24:27],v0,s[4:7],s57 offen
s_add_u32 s57,s56,262144
buffer_load_dwordx4 v[24:27],v0,s[4:7],s57 offen
s_add_u32 s57,s56,393216
buffer_load_dwordx4 v[24:27],v0,s[4:7],s57 offen
s_add_u32 s57,s56,524288
buffer_load_dwordx4 v[24:27],v0,s[4:7],s57 offen
s_add_u32 s57,s56,655360
buffer_load_dwordx4 v[24:27],v0,s[4:7],s57 offen
s_add_u32 s57,s56,786432
buffer_load_dwordx4 v[24:27],v0,s[4:7],s57 offen
s_add_u32 s57,s56,917504
buffer_load_dwordx4 v[24:27],v0,s[4:7],s57 offen
s_add_u32 s57,s56,1048576
buffer_load_dwordx4 v[24:27],v0,s[4:7],s57 offen
s_add_u32 s57,s56,1179648
buffer_load_dwordx4 v[24:27],v0,s[4:7],s57 offen
s_waitcnt vmcnt(9)
s_add_u32 s57,s56,1310720
buffer_load_dwordx4 v[24:27],v0,s[4:7],s57 offen
s_barrier
s_cmp_lg_u32 s46,0
s_cbranch_scc1 L_ar_58
v_mov_b32 v8,128
v_mov_b32 v9,s53
s_mov_b64 exec,1
buffer_atomic_add v9,v8,s[12:15],0 offen
s_mov_b64 exec,-1
L_ar_58:
s_mov_b32 s53,0
s_waitcnt vmcnt(9)
s_add_u32 s57,s56,1441792
buffer_load_dwordx4 v[24:27],v0,s[4:7],s57 offen
s_waitcnt vmcnt(9)
s_add_u32 s57,s56,1572864
buffer_load_dwordx4 v[24:27],v0,s[4:7],s57 offen
s_waitcnt vmcnt(9)
s_add_u32 s57,s56,1703936
buffer_load_dwordx4 v[24:27],v0,s[4:7],s57 offen
s_waitcnt vmcnt(9)
s_add_u32 s57,s56,1835008
buffer_load_dwordx4 v[24:27],v0,s[4:7],s57 offen
s_waitcnt vmcnt(9)
s_add_u32 s57,s56,1966080
buffer_load_dwordx4 v[24:27],v0,s[4:7],s57 offen
s_waitcnt vmcnt(9)
s_add_u32 s57,s56,2097152
buffer_load_dwordx4 v[24:27],v0,s[4:7],s57 offen
s_waitcnt vmcnt(9)
s_add_u32 s57,s56,2228224
buffer_load_dwordx4 v[24:27],v0,s[4:7],s57 offen
s_waitcnt vmcnt(9)
s_add_u32 s57,s56,2359296
buffer_load_dwordx4 v[24:27],v0,s[4:7],s57 offen
s_waitcnt vmcnt(9)
s_add_u32 s57,s56,2490368
buffer_load_dwordx4 v[24:27],v0,s[4:7],s57 offen
s_waitcnt vmcnt(9)
s_add_u32 s57,s56,2621440
buffer_load_dwordx4 v[24:27],v0,s[4:7],s57 offen
s_waitcnt vmcnt(9)
s_add_u32 s57,s56,2752512
buffer_load_dwordx4 v[24:27],v0,s[4:7],s57 offen
s_waitcnt vmcnt(9)
s_add_u32 s57,s56,2883584
buffer_load_dwordx4 v[24:27],v0,s[4:7],s57 offen
s_waitcnt vmcnt(9)
s_add_u32 s57,s56,3014656
buffer_load_dwordx4 v[24:27],v0,s[4:7],s57 offen
s_waitcnt vmcnt(9)
s_add_u32 s57,s56,3145728
buffer_load_dwordx4 v[24:27],v0,s[4:7],s57 offen
s_waitcnt vmcnt(9)
s_add_u32 s57,s56,3276800
buffer_load_dwordx4 v[24:27],v0,s[4:7],s57 offen
s_waitcnt vmcnt(9)
s_add_u32 s57,s56,3407872
buffer_load_dwordx4 v[24:27],v0,s[4:7],s57 offen
s_waitcnt vmcnt(9)
s_add_u32 s57,s56,3538944
buffer_load_dwordx4 v[24:27],v0,s[4:7],s57 offen
s_waitcnt vmcnt(9)
s_add_u32 s57,s56,3670016
buffer_load_dwordx4 v[24:27],v0,s[4:7],s57 offen
s_waitcnt vmcnt(9)
s_add_u32 s57,s56,3801088
buffer_load_dwordx4 v[24:27],v0,s[4:7],s57 offen
s_waitcnt vmcnt(9)
s_add_u32 s57,s56,3932160
buffer_load_dwordx4 v[24:27],v0,s[4:7],s57 offen
s_waitcnt vmcnt(9)
s_add_u32 s57,s56,4063232
buffer_load_dwordx4 v[24:27],v0,s[4:7],s57 offen
s_mov_b32 s4,s24
s_mov_b32 s5,s25
s_mov_b32 s6,4194304
s_mov_b32 s7,0x20000
s_waitcnt vmcnt(9)
s_add_u32 s57,s56,0
buffer_load_dwordx4 v[24:27],v0,s[4:7],s57 offen
s_waitcnt vmcnt(9)
s_add_u32 s57,s56,131072
buffer_load_dwordx4 v[24:27],v0,s[4:7],s57 offen
s_waitcnt vmcnt(9)
s_add_u32 s57,s56,262144
buffer_load_dwordx4 v[24:27],v0,s[4:7],s57 offen
s_waitcnt vmcnt(9)
s_add_u32 s57,s56,393216
buffer_load_dwordx4 v[24:27],v0,s[4:7],s57 offen
s_waitcnt vmcnt(9)
s_add_u32 s57,s56,524288
buffer_load_dwordx4 v[24:27],v0,s[4:7],s57 offen
s_waitcnt vmcnt(9)
s_add_u32 s57,s56,655360
buffer_load_dwordx4 v[24:27],v0,s[4:7],s57 offen
s_waitcnt vmcnt(9)
s_add_u32 s57,s56,786432
buffer_load_dwordx4 v[24:27],v0,s[4:7],s57 offen
s_waitcnt vmcnt(9)
s_add_u32 s57,s56,917504
buffer_load_dwordx4 v[24:27],v0,s[4:7],s57 offen
s_waitcnt vmcnt(9)
s_add_u32 s57,s56,1048576
buffer_load_dwordx4 v[24:27],v0,s[4:7],s57 offen
s_waitcnt vmcnt(9)
s_add_u32 s57,s56,1179648
buffer_load_dwordx4 v[24:27],v0,s[4:7],s57 offen
s_waitcnt vmcnt(9)
s_add_u32 s57,s56,1310720
buffer_load_dwordx4 v[24:27],v0,s[4:7],s57 offen
s_waitcnt vmcnt(9)
s_add_u32 s57,s56,1441792
buffer_load_dwordx4 v[24:27],v0,s[4:7],s57 offen
s_waitcnt vmcnt(9)
s_add_u32 s57,s56,1572864
buffer_load_dwordx4 v[24:27],v0,s[4:7],s57 offen
s_waitcnt vmcnt(9)
s_add_u32 s57,s56,1703936
buffer_load_dwordx4 v[24:27],v0,s[4:7],s57 offen
s_waitcnt vmcnt(9)
s_add_u32 s57,s56,1835008
buffer_load_dwordx4 v[24:27],v0,s[4:7],s57 offen
s_waitcnt vmcnt(9)
s_add_u32 s57,s56,1966080
buffer_load_dwordx4 v[24:27],v0,s[4:7],s57 offen
s_waitcnt vmcnt(9)
s_add_u32 s57,s56,2097152
buffer_load_dwordx4 v[24:27],v0,s[4:7],s57 offen
s_waitcnt vmcnt(9)
s_add_u32 s57,s56,2228224
buffer_load_dwordx4 v[24:27],v0,s[4:7],s57 offen
s_waitcnt vmcnt(9)
s_add_u32 s57,s56,2359296
buffer_load_dwordx4 v[24:27],v0,s[4:7],s57 offen
s_waitcnt vmcnt(9)
s_add_u32 s57,s56,2490368
buffer_load_dwordx4 v[24:27],v0,s[4:7],s57 offen
s_waitcnt vmcnt(9)
s_add_u32 s57,s56,2621440
buffer_load_dwordx4 v[24:27],v0,s[4:7],s57 offen
s_waitcnt vmcnt(9)
s_add_u32 s57,s56,2752512
buffer_load_dwordx4 v[24:27],v0,s[4:7],s57 offen
s_waitcnt vmcnt(9)
s_add_u32 s57,s56,2883584
buffer_load_dwordx4 v[24:27],v0,s[4:7],s57 offen
s_waitcnt vmcnt(9)
s_add_u32 s57,s56,3014656
buffer_load_dwordx4 v[24:27],v0,s[4:7],s57 offen
s_waitcnt vmcnt(9)
s_add_u32 s57,s56,3145728
buffer_load_dwordx4 v[24:27],v0,s[4:7],s57 offen
s_waitcnt vmcnt(9)
s_add_u32 s57,s56,3276800
buffer_load_dwordx4 v[24:27],v0,s[4:7],s57 offen
s_waitcnt vmcnt(9)
s_add_u32 s57,s56,3407872
buffer_load_dwordx4 v[24:27],v0,s[4:7],s57 offen
s_waitcnt vmcnt(9)
s_add_u32 s57,s56,3538944
buffer_load_dwordx4 v[24:27],v0,s[4:7],s57 offen
s_waitcnt vmcnt(9)
s_add_u32 s57,s56,3670016
buffer_load_dwordx4 v[24:27],v0,s[4:7],s57 offen
s_waitcnt vmcnt(9)
s_add_u32 s57,s56,3801088
buffer_load_dwordx4 v[24:27],v0,s[4:7],s57 offen
s_waitcnt vmcnt(9)
s_add_u32 s57,s56,3932160
buffer_load_dwordx4 v[24:27],v0,s[4:7],s57 offen
s_waitcnt vmcnt(9)
s_add_u32 s57,s56,4063232
buffer_load_dwordx4 v[24:27],v0,s[4:7],s57 offen
s_mov_b32 s4,s20
s_mov_b32 s5,s21
s_mov_b32 s6,4194304
s_mov_b32 s7,0x20000
s_waitcnt vmcnt(9)
s_add_u32 s57,s56,0
buffer_load_dwordx4 v[24:27],v0,s[4:7],s57 offen
s_waitcnt vmcnt(9)
s_add_u32 s57,s56,131072
buffer_load_dwordx4 v[24:27],v0,s[4:7],s57 offen
s_waitcnt vmcnt(9)
s_add_u32 s57,s56,262144
buffer_load_dwordx4 v[24:27],v0,s[4:7],s57 offen
s_waitcnt vmcnt(9)
s_add_u32 s57,s56,393216
buffer_load_dwordx4 v[24:27],v0,s[4:7],s57 offen
s_waitcnt vmcnt(9)
s_add_u32 s57,s56,524288
buffer_load_dwordx4 v[24:27],v0,s[4:7],s57 offen
s_waitcnt vmcnt(9)
s_add_u32 s57,s56,655360
buffer_load_dwordx4 v[24:27],v0,s[4:7],s57 offen
s_waitcnt vmcnt(9)
s_add_u32 s57,s56,786432
buffer_load_dwordx4 v[24:27],v0,s[4:7],s57 offen
s_waitcnt vmcnt(9)
s_add_u32 s57,s56,917504
buffer_load_dwordx4 v[24:27],v0,s[4:7],s57 offen
s_waitcnt vmcnt(9)
s_add_u32 s57,s56,1048576
buffer_load_dwordx4 v[24:27],v0,s[4:7],s57 offen
s_waitcnt vmcnt(9)
s_add_u32 s57,s56,1179648
buffer_load_dwordx4 v[24:27],v0,s[4:7],s57 offen
s_waitcnt vmcnt(9)
s_add_u32 s57,s56,1310720
buffer_load_dwordx4 v[24:27],v0,s[4:7],s57 offen
s_waitcnt vmcnt(9)
s_add_u32 s57,s56,1441792
buffer_load_dwordx4 v[24:27],v0,s[4:7],s57 offen
s_waitcnt vmcnt(9)
s_add_u32 s57,s56,1572864
buffer_load_dwordx4 v[24:27],v0,s[4:7],s57 offen
s_waitcnt vmcnt(9)
s_add_u32 s57,s56,1703936
buffer_load_dwordx4 v[24:27],v0,s[4:7],s57 offen
s_waitcnt vmcnt(9)
s_add_u32 s57,s56,1835008
buffer_load_dwordx4 v[24:27],v0,s[4:7],s57 offen
s_waitcnt vmcnt(9)
s_add_u32 s57,s56,1966080
buffer_load_dwordx4 v[24:27],v0,s[4:7],s57 offen
s_waitcnt vmcnt(9)
s_add_u32 s57,s56,2097152
buffer_load_dwordx4 v[24:27],v0,s[4:7],s57 offen
s_waitcnt vmcnt(9)
s_add_u32 s57,s56,2228224
buffer_load_dwordx4 v[24:27],v0,s[4:7],s57 offen
s_waitcnt vmcnt(9)
s_add_u32 s57,s56,2359296
buffer_load_dwordx4 v[24:27],v0,s[4:7],s57 offen
s_waitcnt vmcnt(9)
s_add_u32 s57,s56,2490368
buffer_load_dwordx4 v[24:27],v0,s[4:7],s57 offen
s_waitcnt vmcnt(9)
s_add_u32 s57,s56,2621440
buffer_load_dwordx4 v[24:27],v0,s[4:7],s57 offen
s_waitcnt vmcnt(9)
s_add_u32 s57,s56,2752512
buffer_load_dwordx4 v[24:27],v0,s[4:7],s57 offen
s_waitcnt vmcnt(9)
s_add_u32 s57,s56,2883584
buffer_load_dwordx4 v[24:27],v0,s[4:7],s57 offen
s_waitcnt vmcnt(9)
s_add_u32 s57,s56,3014656
buffer_load_dwordx4 v[24:27],v0,s[4:7],s57 offen
s_waitcnt vmcnt(9)
s_add_u32 s57,s56,3145728
buffer_load_dwordx4 v[24:27],v0,s[4:7],s57 offen
s_waitcnt vmcnt(9)
s_add_u32 s57,s56,3276800
buffer_load_dwordx4 v[24:27],v0,s[4:7],s57 offen
s_waitcnt vmcnt(9)
s_add_u32 s57,s56,3407872
buffer_load_dwordx4 v[24:27],v0,s[4:7],s57 offen
s_waitcnt vmcnt(9)
s_add_u32 s57,s56,3538944
buffer_load_dwordx4 v[24:27],v0,s[4:7],s57 offen
s_waitcnt vmcnt(9)
s_add_u32 s57,s56,3670016
buffer_load_dwordx4 v[24:27],v0,s[4:7],s57 offen
s_waitcnt vmcnt(9)
s_add_u32 s57,s56,3801088
buffer_load_dwordx4 v[24:27],v0,s[4:7],s57 offen
s_waitcnt vmcnt(9)
s_add_u32 s57,s56,3932160
buffer_load_dwordx4 v[24:27],v0,s[4:7],s57 offen
s_waitcnt vmcnt(9)
s_add_u32 s57,s56,4063232
buffer_load_dwordx4 v[24:27],v0,s[4:7],s57 offen
L_rb_7:
s_mov_b32 s4,s26
s_mov_b32 s5,s27
s_mov_b32 s6,4194304
s_mov_b32 s7,0x20000
v_and_b32 v2,15,v1
v_lshlrev_b32 v2,4,v2
v_lshrrev_b32 v3,4,v1
v_lshl_add_u32 v2,v3,13,v2
s_and_b32 s56,s47,15
s_lshl_b32 s56,s56,18
s_lshl_b32 s57,s46,8
s_add_u32 s56,s56,s57
s_mov_b32 s61,0x05040100
s_mov_b32 s62,0x07060302
s_add_u32 s57,s56,0
buffer_load_dwordx4 v[24:27],v2,s[4:7],s57 offen offset:0
buffer_load_dwordx4 v[28:31],v2,s[4:7],s57 offen offset:1024
buffer_load_dwordx4 v[32:35],v2,s[4:7],s57 offen offset:2048
buffer_load_dwordx4 v[36:39],v2,s[4:7],s57 offen offset:3072
s_add_u32 s57,s56,4096
buffer_load_dwordx4 v[40:43],v2,s[4:7],s57 offen offset:0
buffer_load_dwordx4 v[44:47],v2,s[4:7],s57 offen offset:1024
buffer_load_dwordx4 v[48:51],v2,s[4:7],s57 offen offset:2048
buffer_load_dwordx4 v[52:55],v2,s[4:7],s57 offen offset:3072
s_add_u32 s57,s56,32768
buffer_load_dwordx4 v[56:59],v2,s[4:7],s57 offen offset:0
buffer_load_dwordx4 v[60:63],v2,s[4:7],s57 offen offset:1024
buffer_load_dwordx4 v[64:67],v2,s[4:7],s57 offen offset:2048
buffer_load_dwordx4 v[68:71],v2,s[4:7],s57 offen offset:3072
s_add_u32 s57,s56,36864
buffer_load_dwordx4 v[72:75],v2,s[4:7],s57 offen offset:0
buffer_load_dwordx4 v[76:79],v2,s[4:7],s57 offen offset:1024
buffer_load_dwordx4 v[80:83],v2,s[4:7],s57 offen offset:2048
buffer_load_dwordx4 v[84:87],v2,s[4:7],s57 offen offset:3072
s_add_u32 s57,s56,65536
buffer_load_dwordx4 v[88:91],v2,s[4:7],s57 offen offset:0
buffer_load_dwordx4 v[92:95],v2,s[4:7],s57 offen offset:1024
buffer_load_dwordx4 v[96:99],v2,s[4:7],s57 offen offset:2048
buffer_load_dwordx4 v[100:103],v2,s[4:7],s57 offen offset:3072
s_add_u32 s57,s56,69632
buffer_load_dwordx4 v[104:107],v2,s[4:7],s57 offen offset:0
buffer_load_dwordx4 v[108:111],v2,s[4:7],s57 offen offset:1024
buffer_load_dwordx4 v[112:115],v2,s[4:7],s57 offen offset:2048
buffer_load_dwordx4 v[116:119],v2,s[4:7],s57 offen offset:3072
s_add_u32 s57,s56,98304
buffer_load_dwordx4 v[120:123],v2,s[4:7],s57 offen offset:0
buffer_load_dwordx4 v[124:127],v2,s[4:7],s57 offen offset:1024
buffer_load_dwordx4 v[128:131],v2,s[4:7],s57 offen offset:2048
buffer_load_dwordx4 v[132:135],v2,s[4:7],s57 offen offset:3072
s_add_u32 s57,s56,102400
buffer_load_dwordx4 v[136:139],v2,s[4:7],s57 offen offset:0
buffer_load_dwordx4 v[140:143],v2,s[4:7],s57 offen offset:1024
buffer_load_dwordx4 v[144:147],v2,s[4:7],s57 offen offset:2048
buffer_load_dwordx4 v[148:151],v2,s[4:7],s57 offen offset:3072
s_add_u32 s57,s56,131072
buffer_load_dwordx4 v[152:155],v2,s[4:7],s57 offen offset:0
buffer_load_dwordx4 v[156:159],v2,s[4:7],s57 offen offset:1024
buffer_load_dwordx4 v[160:163],v2,s[4:7],s57 offen offset:2048
buffer_load_dwordx4 v[164:167],v2,s[4:7],s57 offen offset:3072
s_add_u32 s57,s56,135168
buffer_load_dwordx4 v[168:171],v2,s[4:7],s57 offen offset:0
buffer_load_dwordx4 v[172:175],v2,s[4:7],s57 offen offset:1024
buffer_load_dwordx4 v[176:179],v2,s[4:7],s57 offen offset:2048
buffer_load_dwordx4 v[180:183],v2,s[4:7],s57 offen offset:3072
s_add_u32 s57,s56,163840
buffer_load_dwordx4 v[184:187],v2,s[4:7],s57 offen offset:0
buffer_load_dwordx4 v[188:191],v2,s[4:7],s57 offen offset:1024
buffer_load_dwordx4 v[192:195],v2,s[4:7],s57 offen offset:2048
buffer_load_dwordx4 v[196:199],v2,s[4:7],s57 offen offset:3072
s_add_u32 s57,s56,167936
buffer_load_dwordx4 v[200:203],v2,s[4:7],s57 offen offset:0
buffer_load_dwordx4 v[204:207],v2,s[4:7],s57 offen offset:1024
buffer_load_dwordx4 v[208:211],v2,s[4:7],s57 offen offset:2048
buffer_load_dwordx4 v[212:215],v2,s[4:7],s57 offen offset:3072
s_waitcnt vmcnt(40)
v_perm_b32 v216,v28,v24,s61
v_perm_b32 v217,v36,v32,s61
v_perm_b32 v218,v44,v40,s61
v_perm_b32 v219,v52,v48,s61
v_accvgpr_write_b32 a0,v216
v_accvgpr_write_b32 a1,v217
v_accvgpr_write_b32 a2,v218
v_accvgpr_write_b32 a3,v219
v_perm_b32 v216,v28,v24,s62
v_perm_b32 v217,v36,v32,s62
v_perm_b32 v218,v44,v40,s62
v_perm_b32 v219,v52,v48,s62
v_accvgpr_write_b32 a4,v216
v_accvgpr_write_b32 a5,v217
v_accvgpr_write_b32 a6,v218
v_accvgpr_write_b32 a7,v219
v_perm_b32 v216,v29,v25,s61
v_perm_b32 v217,v37,v33,s61
v_perm_b32 v218,v45,v41,s61
v_perm_b32 v219,v53,v49,s61
v_accvgpr_write_b32 a8,v216
v_accvgpr_write_b32 a9,v217
v_accvgpr_write_b32 a10,v218
v_accvgpr_write_b32 a11,v219
v_perm_b32 v216,v29,v25,s62
v_perm_b32 v217,v37,v33,s62
v_perm_b32 v218,v45,v41,s62
v_perm_b32 v219,v53,v49,s62
v_accvgpr_write_b32 a12,v216
v_accvgpr_write_b32 a13,v217
v_accvgpr_write_b32 a14,v218
v_accvgpr_write_b32 a15,v219
v_perm_b32 v216,v30,v26,s61
v_perm_b32 v217,v38,v34,s61
v_perm_b32 v218,v46,v42,s61
v_perm_b32 v219,v54,v50,s61
v_accvgpr_write_b32 a16,v216
v_accvgpr_write_b32 a17,v217
v_accvgpr_write_b32 a18,v218
v_accvgpr_write_b32 a19,v219
v_perm_b32 v216,v30,v26,s62
v_perm_b32 v217,v38,v34,s62
v_perm_b32 v218,v46,v42,s62
v_perm_b32 v219,v54,v50,s62
v_accvgpr_write_b32 a20,v216
v_accvgpr_write_b32 a21,v217
v_accvgpr_write_b32 a22,v218
v_accvgpr_write_b32 a23,v219
v_perm_b32 v216,v31,v27,s61
v_perm_b32 v217,v39,v35,s61
v_perm_b32 v218,v47,v43,s61
v_perm_b32 v219,v55,v51,s61
v_accvgpr_write_b32 a24,v216
v_accvgpr_write_b32 a25,v217
v_accvgpr_write_b32 a26,v218
v_accvgpr_write_b32 a27,v219
v_perm_b32 v216,v31,v27,s62
v_perm_b32 v217,v39,v35,s62
v_perm_b32 v218,v47,v43,s62
v_perm_b32 v219,v55,v51,s62
v_accvgpr_write_b32 a28,v216
v_accvgpr_write_b32 a29,v217
v_accvgpr_write_b32 a30,v218
v_accvgpr_write_b32 a31,v219
s_add_u32 s57,s56,196608
buffer_load_dwordx4 v[24:27],v2,s[4:7],s57 offen offset:0
buffer_load_dwordx4 v[28:31],v2,s[4:7],s57 offen offset:1024
buffer_load_dwordx4 v[32:35],v2,s[4:7],s57 offen offset:2048
buffer_load_dwordx4 v[36:39],v2,s[4:7],s57 offen offset:3072
s_add_u32 s57,s56,200704
buffer_load_dwordx4 v[40:43],v2,s[4:7],s57 offen offset:0
buffer_load_dwordx4 v[44:47],v2,s[4:7],s57 offen offset:1024
buffer_load_dwordx4 v[48:51],v2,s[4:7],s57 offen offset:2048
buffer_load_dwordx4 v[52:55],v2,s[4:7],s57 offen offset:3072
s_barrier
s_cmp_lg_u32 s46,0
s_cbranch_scc1 L_ar_59
v_mov_b32 v8,128
v_mov_b32 v9,s53
s_mov_b64 exec,1
buffer_atomic_add v9,v8,s[12:15],0 offen
s_mov_b64 exec,-1
L_ar_59:
s_mov_b32 s53,0
s_waitcnt vmcnt(40)
v_perm_b32 v216,v60,v56,s61
v_perm_b32 v217,v68,v64,s61
v_perm_b32 v218,v76,v72,s61
v_perm_b32 v219,v84,v80,s61
v_accvgpr_write_b32 a32,v216
v_accvgpr_write_b32 a33,v217
v_accvgpr_write_b32 a34,v218
v_accvgpr_write_b32 a35,v219
v_perm_b32 v216,v60,v56,s62
v_perm_b32 v217,v68,v64,s62
v_perm_b32 v218,v76,v72,s62
v_perm_b32 v219,v84,v80,s62
v_accvgpr_write_b32 a36,v216
v_accvgpr_write_b32 a37,v217
v_accvgpr_write_b32 a38,v218
v_accvgpr_write_b32 a39,v219
v_perm_b32 v216,v61,v57,s61
v_perm_b32 v217,v69,v65,s61
v_perm_b32 v218,v77,v73,s61
v_perm_b32 v219,v85,v81,s61
v_accvgpr_write_b32 a40,v216
v_accvgpr_write_b32 a41,v217
v_accvgpr_write_b32 a42,v218
v_accvgpr_write_b32 a43,v219
v_perm_b32 v216,v61,v57,s62
v_perm_b32 v217,v69,v65,s62
v_perm_b32 v218,v77,v73,s62
v_perm_b32 v219,v85,v81,s62
v_accvgpr_write_b32 a44,v216
v_accvgpr_write_b32 a45,v217
v_accvgpr_write_b32 a46,v218
v_accvgpr_write_b32 a47,v219
v_perm_b32 v216,v62,v58,s61
v_perm_b32 v217,v70,v66,s61
v_perm_b32 v218,v78,v74,s61
v_perm_b32 v219,v86,v82,s61
v_accvgpr_write_b32 a48,v216
v_accvgpr_write_b32 a49,v217
v_accvgpr_write_b32 a50,v218
v_accvgpr_write_b32 a51,v219
v_perm_b32 v216,v62,v58,s62
v_perm_b32 v217,v70,v66,s62
v_perm_b32 v218,v78,v74,s62
v_perm_b32 v219,v86,v82,s62
v_accvgpr_write_b32 a52,v216
v_accvgpr_write_b32 a53,v217
v_accvgpr_write_b32 a54,v218
v_accvgpr_write_b32 a55,v219
v_perm_b32 v216,v63,v59,s61
v_perm_b32 v217,v71,v67,s61
v_perm_b32 v218,v79,v75,s61
v_perm_b32 v219,v87,v83,s61
v_accvgpr_write_b32 a56,v216
v_accvgpr_write_b32 a57,v217
v_accvgpr_write_b32 a58,v218
v_accvgpr_write_b32 a59,v219
v_perm_b32 v216,v63,v59,s62
v_perm_b32 v217,v71,v67,s62
v_perm_b32 v218,v79,v75,s62
v_perm_b32 v219,v87,v83,s62
v_accvgpr_write_b32 a60,v216
v_accvgpr_write_b32 a61,v217
v_accvgpr_write_b32 a62,v218
v_accvgpr_write_b32 a63,v219
s_add_u32 s57,s56,229376
buffer_load_dwordx4 v[56:59],v2,s[4:7],s57 offen offset:0
buffer_load_dwordx4 v[60:63],v2,s[4:7],s57 offen offset:1024
buffer_load_dwordx4 v[64:67],v2,s[4:7],s57 offen offset:2048
buffer_load_dwordx4 v[68:71],v2,s[4:7],s57 offen offset:3072
s_add_u32 s57,s56,233472
buffer_load_dwordx4 v[72:75],v2,s[4:7],s57 offen offset:0
buffer_load_dwordx4 v[76:79],v2,s[4:7],s57 offen offset:1024
buffer_load_dwordx4 v[80:83],v2,s[4:7],s57 offen offset:2048
buffer_load_dwordx4 v[84:87],v2,s[4:7],s57 offen offset:3072
s_waitcnt vmcnt(40)
v_perm_b32 v216,v92,v88,s61
v_perm_b32 v217,v100,v96,s61
v_perm_b32 v218,v108,v104,s61
v_perm_b32 v219,v116,v112,s61
v_accvgpr_write_b32 a64,v216
v_accvgpr_write_b32 a65,v217
v_accvgpr_write_b32 a66,v218
v_accvgpr_write_b32 a67,v219
v_perm_b32 v216,v92,v88,s62
v_perm_b32 v217,v100,v96,s62
v_perm_b32 v218,v108,v104,s62
v_perm_b32 v219,v116,v112,s62
v_accvgpr_write_b32 a68,v216
v_accvgpr_write_b32 a69,v217
v_accvgpr_write_b32 a70,v218
v_accvgpr_write_b32 a71,v219
v_perm_b32 v216,v93,v89,s61
v_perm_b32 v217,v101,v97,s61
v_perm_b32 v218,v109,v105,s61
v_perm_b32 v219,v117,v113,s61
v_accvgpr_write_b32 a72,v216
v_accvgpr_write_b32 a73,v217
v_accvgpr_write_b32 a74,v218
v_accvgpr_write_b32 a75,v219
v_perm_b32 v216,v93,v89,s62
v_perm_b32 v217,v101,v97,s62
v_perm_b32 v218,v109,v105,s62
v_perm_b32 v219,v117,v113,s62
v_accvgpr_write_b32 a76,v216
v_accvgpr_write_b32 a77,v217
v_accvgpr_write_b32 a78,v218
v_accvgpr_write_b32 a79,v219
v_perm_b32 v216,v94,v90,s61
v_perm_b32 v217,v102,v98,s61
v_perm_b32 v218,v110,v106,s61
v_perm_b32 v219,v118,v114,s61
v_accvgpr_write_b32 a80,v216
v_accvgpr_write_b32 a81,v217
v_accvgpr_write_b32 a82,v218
v_accvgpr_write_b32 a83,v219
v_perm_b32 v216,v94,v90,s62
v_perm_b32 v217,v102,v98,s62
v_perm_b32 v218,v110,v106,s62
v_perm_b32 v219,v118,v114,s62
v_accvgpr_write_b32 a84,v216
v_accvgpr_write_b32 a85,v217
v_accvgpr_write_b32 a86,v218
v_accvgpr_write_b32 a87,v219
v_perm_b32 v216,v95,v91,s61
v_perm_b32 v217,v103,v99,s61
v_perm_b32 v218,v111,v107,s61
v_perm_b32 v219,v119,v115,s61
v_accvgpr_write_b32 a88,v216
v_accvgpr_write_b32 a89,v217
v_accvgpr_write_b32 a90,v218
v_accvgpr_write_b32 a91,v219
v_perm_b32 v216,v95,v91,s62
v_perm_b32 v217,v103,v99,s62
v_perm_b32 v218,v111,v107,s62
v_perm_b32 v219,v119,v115,s62
v_accvgpr_write_b32 a92,v216
v_accvgpr_write_b32 a93,v217
v_accvgpr_write_b32 a94,v218
v_accvgpr_write_b32 a95,v219
s_waitcnt vmcnt(32)
v_perm_b32 v216,v124,v120,s61
v_perm_b32 v217,v132,v128,s61
v_perm_b32 v218,v140,v136,s61
v_perm_b32 v219,v148,v144,s61
v_accvgpr_write_b32 a96,v216
v_accvgpr_write_b32 a97,v217
v_accvgpr_write_b32 a98,v218
v_accvgpr_write_b32 a99,v219
v_perm_b32 v216,v124,v120,s62
v_perm_b32 v217,v132,v128,s62
v_perm_b32 v218,v140,v136,s62
v_perm_b32 v219,v148,v144,s62
v_accvgpr_write_b32 a100,v216
v_accvgpr_write_b32 a101,v217
v_accvgpr_write_b32 a102,v218
v_accvgpr_write_b32 a103,v219
v_perm_b32 v216,v125,v121,s61
v_perm_b32 v217,v133,v129,s61
v_perm_b32 v218,v141,v137,s61
v_perm_b32 v219,v149,v145,s61
v_accvgpr_write_b32 a104,v216
v_accvgpr_write_b32 a105,v217
v_accvgpr_write_b32 a106,v218
v_accvgpr_write_b32 a107,v219
v_perm_b32 v216,v125,v121,s62
v_perm_b32 v217,v133,v129,s62
v_perm_b32 v218,v141,v137,s62
v_perm_b32 v219,v149,v145,s62
v_accvgpr_write_b32 a108,v216
v_accvgpr_write_b32 a109,v217
v_accvgpr_write_b32 a110,v218
v_accvgpr_write_b32 a111,v219
v_perm_b32 v216,v126,v122,s61
v_perm_b32 v217,v134,v130,s61
v_perm_b32 v218,v142,v138,s61
v_perm_b32 v219,v150,v146,s61
v_accvgpr_write_b32 a112,v216
v_accvgpr_write_b32 a113,v217
v_accvgpr_write_b32 a114,v218
v_accvgpr_write_b32 a115,v219
v_perm_b32 v216,v126,v122,s62
v_perm_b32 v217,v134,v130,s62
v_perm_b32 v218,v142,v138,s62
v_perm_b32 v219,v150,v146,s62
v_accvgpr_write_b32 a116,v216
v_accvgpr_write_b32 a117,v217
v_accvgpr_write_b32 a118,v218
v_accvgpr_write_b32 a119,v219
v_perm_b32 v216,v127,v123,s61
v_perm_b32 v217,v135,v131,s61
v_perm_b32 v218,v143,v139,s61
v_perm_b32 v219,v151,v147,s61
v_accvgpr_write_b32 a120,v216
v_accvgpr_write_b32 a121,v217
v_accvgpr_write_b32 a122,v218
v_accvgpr_write_b32 a123,v219
v_perm_b32 v216,v127,v123,s62
v_perm_b32 v217,v135,v131,s62
v_perm_b32 v218,v143,v139,s62
v_perm_b32 v219,v151,v147,s62
v_accvgpr_write_b32 a124,v216
v_accvgpr_write_b32 a125,v217
v_accvgpr_write_b32 a126,v218
v_accvgpr_write_b32 a127,v219
s_waitcnt vmcnt(24)
v_perm_b32 v216,v156,v152,s61
v_perm_b32 v217,v164,v160,s61
v_perm_b32 v218,v172,v168,s61
v_perm_b32 v219,v180,v176,s61
v_accvgpr_write_b32 a128,v216
v_accvgpr_write_b32 a129,v217
v_accvgpr_write_b32 a130,v218
v_accvgpr_write_b32 a131,v219
v_perm_b32 v216,v156,v152,s62
v_perm_b32 v217,v164,v160,s62
v_perm_b32 v218,v172,v168,s62
v_perm_b32 v219,v180,v176,s62
v_accvgpr_write_b32 a132,v216
v_accvgpr_write_b32 a133,v217
v_accvgpr_write_b32 a134,v218
v_accvgpr_write_b32 a135,v219
v_perm_b32 v216,v157,v153,s61
v_perm_b32 v217,v165,v161,s61
v_perm_b32 v218,v173,v169,s61
v_perm_b32 v219,v181,v177,s61
v_accvgpr_write_b32 a136,v216
v_accvgpr_write_b32 a137,v217
v_accvgpr_write_b32 a138,v218
v_accvgpr_write_b32 a139,v219
v_perm_b32 v216,v157,v153,s62
v_perm_b32 v217,v165,v161,s62
v_perm_b32 v218,v173,v169,s62
v_perm_b32 v219,v181,v177,s62
v_accvgpr_write_b32 a140,v216
v_accvgpr_write_b32 a141,v217
v_accvgpr_write_b32 a142,v218
v_accvgpr_write_b32 a143,v219
v_perm_b32 v216,v158,v154,s61
v_perm_b32 v217,v166,v162,s61
v_perm_b32 v218,v174,v170,s61
v_perm_b32 v219,v182,v178,s61
v_accvgpr_write_b32 a144,v216
v_accvgpr_write_b32 a145,v217
v_accvgpr_write_b32 a146,v218
v_accvgpr_write_b32 a147,v219
v_perm_b32 v216,v158,v154,s62
v_perm_b32 v217,v166,v162,s62
v_perm_b32 v218,v174,v170,s62
v_perm_b32 v219,v182,v178,s62
v_accvgpr_write_b32 a148,v216
v_accvgpr_write_b32 a149,v217
v_accvgpr_write_b32 a150,v218
v_accvgpr_write_b32 a151,v219
v_perm_b32 v216,v159,v155,s61
v_perm_b32 v217,v167,v163,s61
v_perm_b32 v218,v175,v171,s61
v_perm_b32 v219,v183,v179,s61
v_accvgpr_write_b32 a152,v216
v_accvgpr_write_b32 a153,v217
v_accvgpr_write_b32 a154,v218
v_accvgpr_write_b32 a155,v219
v_perm_b32 v216,v159,v155,s62
v_perm_b32 v217,v167,v163,s62
v_perm_b32 v218,v175,v171,s62
v_perm_b32 v219,v183,v179,s62
v_accvgpr_write_b32 a156,v216
v_accvgpr_write_b32 a157,v217
v_accvgpr_write_b32 a158,v218
v_accvgpr_write_b32 a159,v219
s_waitcnt vmcnt(16)
v_perm_b32 v216,v188,v184,s61
v_perm_b32 v217,v196,v192,s61
v_perm_b32 v218,v204,v200,s61
v_perm_b32 v219,v212,v208,s61
v_accvgpr_write_b32 a160,v216
v_accvgpr_write_b32 a161,v217
v_accvgpr_write_b32 a162,v218
v_accvgpr_write_b32 a163,v219
v_perm_b32 v216,v188,v184,s62
v_perm_b32 v217,v196,v192,s62
v_perm_b32 v218,v204,v200,s62
v_perm_b32 v219,v212,v208,s62
v_accvgpr_write_b32 a164,v216
v_accvgpr_write_b32 a165,v217
v_accvgpr_write_b32 a166,v218
v_accvgpr_write_b32 a167,v219
v_perm_b32 v216,v189,v185,s61
v_perm_b32 v217,v197,v193,s61
v_perm_b32 v218,v205,v201,s61
v_perm_b32 v219,v213,v209,s61
v_accvgpr_write_b32 a168,v216
v_accvgpr_write_b32 a169,v217
v_accvgpr_write_b32 a170,v218
v_accvgpr_write_b32 a171,v219
v_perm_b32 v216,v189,v185,s62
v_perm_b32 v217,v197,v193,s62
v_perm_b32 v218,v205,v201,s62
v_perm_b32 v219,v213,v209,s62
v_accvgpr_write_b32 a172,v216
v_accvgpr_write_b32 a173,v217
v_accvgpr_write_b32 a174,v218
v_accvgpr_write_b32 a175,v219
v_perm_b32 v216,v190,v186,s61
v_perm_b32 v217,v198,v194,s61
v_perm_b32 v218,v206,v202,s61
v_perm_b32 v219,v214,v210,s61
v_accvgpr_write_b32 a176,v216
v_accvgpr_write_b32 a177,v217
v_accvgpr_write_b32 a178,v218
v_accvgpr_write_b32 a179,v219
v_perm_b32 v216,v190,v186,s62
v_perm_b32 v217,v198,v194,s62
v_perm_b32 v218,v206,v202,s62
v_perm_b32 v219,v214,v210,s62
v_accvgpr_write_b32 a180,v216
v_accvgpr_write_b32 a181,v217
v_accvgpr_write_b32 a182,v218
v_accvgpr_write_b32 a183,v219
v_perm_b32 v216,v191,v187,s61
v_perm_b32 v217,v199,v195,s61
v_perm_b32 v218,v207,v203,s61
v_perm_b32 v219,v215,v211,s61
v_accvgpr_write_b32 a184,v216
v_accvgpr_write_b32 a185,v217
v_accvgpr_write_b32 a186,v218
v_accvgpr_write_b32 a187,v219
v_perm_b32 v216,v191,v187,s62
v_perm_b32 v217,v199,v195,s62
v_perm_b32 v218,v207,v203,s62
v_perm_b32 v219,v215,v211,s62
v_accvgpr_write_b32 a188,v216
v_accvgpr_write_b32 a189,v217
v_accvgpr_write_b32 a190,v218
v_accvgpr_write_b32 a191,v219
s_waitcnt vmcnt(8)
v_perm_b32 v216,v28,v24,s61
v_perm_b32 v217,v36,v32,s61
v_perm_b32 v218,v44,v40,s61
v_perm_b32 v219,v52,v48,s61
v_accvgpr_write_b32 a192,v216
v_accvgpr_write_b32 a193,v217
v_accvgpr_write_b32 a194,v218
v_accvgpr_write_b32 a195,v219
v_perm_b32 v216,v28,v24,s62
v_perm_b32 v217,v36,v32,s62
v_perm_b32 v218,v44,v40,s62
v_perm_b32 v219,v52,v48,s62
v_accvgpr_write_b32 a196,v216
v_accvgpr_write_b32 a197,v217
v_accvgpr_write_b32 a198,v218
v_accvgpr_write_b32 a199,v219
v_perm_b32 v216,v29,v25,s61
v_perm_b32 v217,v37,v33,s61
v_perm_b32 v218,v45,v41,s61
v_perm_b32 v219,v53,v49,s61
v_accvgpr_write_b32 a200,v216
v_accvgpr_write_b32 a201,v217
v_accvgpr_write_b32 a202,v218
v_accvgpr_write_b32 a203,v219
v_perm_b32 v216,v29,v25,s62
v_perm_b32 v217,v37,v33,s62
v_perm_b32 v218,v45,v41,s62
v_perm_b32 v219,v53,v49,s62
v_accvgpr_write_b32 a204,v216
v_accvgpr_write_b32 a205,v217
v_accvgpr_write_b32 a206,v218
v_accvgpr_write_b32 a207,v219
v_perm_b32 v216,v30,v26,s61
v_perm_b32 v217,v38,v34,s61
v_perm_b32 v218,v46,v42,s61
v_perm_b32 v219,v54,v50,s61
v_accvgpr_write_b32 a208,v216
v_accvgpr_write_b32 a209,v217
v_accvgpr_write_b32 a210,v218
v_accvgpr_write_b32 a211,v219
v_perm_b32 v216,v30,v26,s62
v_perm_b32 v217,v38,v34,s62
v_perm_b32 v218,v46,v42,s62
v_perm_b32 v219,v54,v50,s62
v_accvgpr_write_b32 a212,v216
v_accvgpr_write_b32 a213,v217
v_accvgpr_write_b32 a214,v218
v_accvgpr_write_b32 a215,v219
v_perm_b32 v216,v31,v27,s61
v_perm_b32 v217,v39,v35,s61
v_perm_b32 v218,v47,v43,s61
v_perm_b32 v219,v55,v51,s61
v_accvgpr_write_b32 a216,v216
v_accvgpr_write_b32 a217,v217
v_accvgpr_write_b32 a218,v218
v_accvgpr_write_b32 a219,v219
v_perm_b32 v216,v31,v27,s62
v_perm_b32 v217,v39,v35,s62
v_perm_b32 v218,v47,v43,s62
v_perm_b32 v219,v55,v51,s62
v_accvgpr_write_b32 a220,v216
v_accvgpr_write_b32 a221,v217
v_accvgpr_write_b32 a222,v218
v_accvgpr_write_b32 a223,v219
s_waitcnt vmcnt(0)
v_perm_b32 v216,v60,v56,s61
v_perm_b32 v217,v68,v64,s61
v_perm_b32 v218,v76,v72,s61
v_perm_b32 v219,v84,v80,s61
v_accvgpr_write_b32 a224,v216
v_accvgpr_write_b32 a225,v217
v_accvgpr_write_b32 a226,v218
v_accvgpr_write_b32 a227,v219
v_perm_b32 v216,v60,v56,s62
v_perm_b32 v217,v68,v64,s62
v_perm_b32 v218,v76,v72,s62
v_perm_b32 v219,v84,v80,s62
v_accvgpr_write_b32 a228,v216
v_accvgpr_write_b32 a229,v217
v_accvgpr_write_b32 a230,v218
v_accvgpr_write_b32 a231,v219
v_perm_b32 v216,v61,v57,s61
v_perm_b32 v217,v69,v65,s61
v_perm_b32 v218,v77,v73,s61
v_perm_b32 v219,v85,v81,s61
v_accvgpr_write_b32 a232,v216
v_accvgpr_write_b32 a233,v217
v_accvgpr_write_b32 a234,v218
v_accvgpr_write_b32 a235,v219
v_perm_b32 v216,v61,v57,s62
v_perm_b32 v217,v69,v65,s62
v_perm_b32 v218,v77,v73,s62
v_perm_b32 v219,v85,v81,s62
v_accvgpr_write_b32 a236,v216
v_accvgpr_write_b32 a237,v217
v_accvgpr_write_b32 a238,v218
v_accvgpr_write_b32 a239,v219
v_perm_b32 v216,v62,v58,s61
v_perm_b32 v217,v70,v66,s61
v_perm_b32 v218,v78,v74,s61
v_perm_b32 v219,v86,v82,s61
v_accvgpr_write_b32 a240,v216
v_accvgpr_write_b32 a241,v217
v_accvgpr_write_b32 a242,v218
v_accvgpr_write_b32 a243,v219
v_perm_b32 v216,v62,v58,s62
v_perm_b32 v217,v70,v66,s62
v_perm_b32 v218,v78,v74,s62
v_perm_b32 v219,v86,v82,s62
v_accvgpr_write_b32 a244,v216
v_accvgpr_write_b32 a245,v217
v_accvgpr_write_b32 a246,v218
v_accvgpr_write_b32 a247,v219
v_perm_b32 v216,v63,v59,s61
v_perm_b32 v217,v71,v67,s61
v_perm_b32 v218,v79,v75,s61
v_perm_b32 v219,v87,v83,s61
v_accvgpr_write_b32 a248,v216
v_accvgpr_write_b32 a249,v217
v_accvgpr_write_b32 a250,v218
v_accvgpr_write_b32 a251,v219
v_perm_b32 v216,v63,v59,s62
v_perm_b32 v217,v71,v67,s62
v_perm_b32 v218,v79,v75,s62
v_perm_b32 v219,v87,v83,s62
v_accvgpr_write_b32 a252,v216
v_accvgpr_write_b32 a253,v217
v_accvgpr_write_b32 a254,v218
v_accvgpr_write_b32 a255,v219
v_mov_b32 v123,159744
s_cmp_lg_u32 s46,0
s_cbranch_scc1 L_gbd_61
v_mov_b32 v124,128
L_gb_60:
buffer_load_dword v125,v124,s[12:15],0 offen sc1
s_waitcnt vmcnt(0)
v_readfirstlane_b32 s56,v125
ds_write_b32 v123,v125
s_bitcmp1_b32 s56,8
s_cbranch_scc1 L_gbd_61
s_sleep 4
s_sub_u32 s49,s49,1
s_cmp_gt_i32 s49,0
s_cbranch_scc1 L_gb_60
s_branch L_abort
L_gbd_61:
s_waitcnt lgkmcnt(0)
s_barrier
ds_read_b32 v125,v123
s_waitcnt lgkmcnt(0)
v_readfirstlane_b32 s56,v125
s_barrier
s_lshr_b32 s56,s56,16
s_andn2_b32 s56,s56,s3
s_cbranch_scc1 L_spread
s_max_u32 s54,s48,5
s_sub_u32 s54,s54,5
s_lshl_b32 s54,s54,1
s_lshr_b32 s56,s47,4
s_add_u32 s54,s54,s56
s_cmp_lg_u32 s3,0
s_cbranch_scc1 L_wa
v_and_b32 v238,15,v1
v_and_b32 v239,1,v1
v_lshlrev_b32 v239,4,v239
v_mov_b32 v240,0x3f80
v_lshlrev_b32 v240,v239,v240
v_lshrrev_b32 v238,1,v238
v_cmp_eq_u32 vcc,0,v238
s_nop 1
v_cndmask_b32 v156,0,v240,vcc
v_cmp_eq_u32 vcc,1,v238
s_nop 1
v_cndmask_b32 v157,0,v240,vcc
v_cmp_eq_u32 vcc,2,v238
s_nop 1
v_cndmask_b32 v158,0,v240,vcc
v_cmp_eq_u32 vcc,3,v238
s_nop 1
v_cndmask_b32 v159,0,v240,vcc
s_mov_b32 s4,s32
s_mov_b32 s5,s33
s_mov_b32 s6,1024
s_mov_b32 s7,0x20000
buffer_load_dwordx4 v[224:227],v0,s[4:7],0 offen
v_and_b32 v238,15,v1
v_lshrrev_b32 v239,4,v1
v_lshlrev_b32 v240,2,v239
v_mov_b32 v241,0xf149f2ca
s_and_b32 s56,s46,1
s_lshl_b32 s56,s56,4
v_add_u32 v242,s56,v238
v_add_u32 v243,0,v240
v_cmp_gt_u32 vcc,v243,v242
s_nop 1
v_cndmask_b32 v8,0,v241,vcc
v_add_u32 v243,1,v240
v_cmp_gt_u32 vcc,v243,v242
s_nop 1
v_cndmask_b32 v9,0,v241,vcc
v_add_u32 v243,2,v240
v_cmp_gt_u32 vcc,v243,v242
s_nop 1
v_cndmask_b32 v10,0,v241,vcc
v_add_u32 v243,3,v240
v_cmp_gt_u32 vcc,v243,v242
s_nop 1
v_cndmask_b32 v11,0,v241,vcc
v_add_u32 v243,16,v240
v_cmp_gt_u32 vcc,v243,v242
s_nop 1
v_cndmask_b32 v12,0,v241,vcc
v_add_u32 v243,17,v240
v_cmp_gt_u32 vcc,v243,v242
s_nop 1
v_cndmask_b32 v13,0,v241,vcc
v_add_u32 v243,18,v240
v_cmp_gt_u32 vcc,v243,v242
s_nop 1
v_cndmask_b32 v14,0,v241,vcc
v_add_u32 v243,19,v240
v_cmp_gt_u32 vcc,v243,v242
s_nop 1
v_cndmask_b32 v15,0,v241,vcc
v_mov_b64 v[152:153],s[28:29]
v_mov_b64 v[154:155],s[28:29]
v_mov_b32 v145,0
v_mov_b32 v146,0
s_lshl_b32 s56,s46,12
s_add_u32 s56,s56,131072
v_add_u32 v3,s56,v0
v_add_u32 v4,131072,v0
s_lshl_b32 s56,s46,8
v_lshlrev_b32 v7,4,v238
v_add_u32 v7,s56,v7
v_lshl_add_u32 v5,v239,16,v7
v_lshlrev_b32 v6,1,v7
v_lshl_add_u32 v7,v239,10,v7
v_and_b32 v243,1,v239
v_lshl_add_u32 v6,v243,4,v6
v_lshrrev_b32 v243,1,v239
v_lshl_add_u32 v6,v243,12,v6
v_add_u32 v6,147456,v6
v_lshlrev_b32 v16,2,v238
v_lshlrev_b32 v21,3,v238
s_and_b32 s68,s47,15
s_lshl_b32 s56,s68,10
v_add_u32 v5,s56,v5
s_lshl_b32 s56,s68,15
v_add_u32 v7,s56,v7
s_lshl_b32 s69,s54,20
s_add_u32 s69,s69,20971520
s_lshl_b32 s87,s54,13
s_add_u32 s87,s87,10486656
s_lshl2_add_u32 s74,s68,s87
s_or_b32 s74,s74,s52
s_lshl_b32 s68,s68,1
s_lshr_b32 s56,s46,1
s_add_u32 s68,s68,s56
s_mov_b32 s66,0
s_mov_b32 s67,0
s_mov_b32 s73,0x80000000
s_mov_b32 s75,0
s_mov_b32 s37,0
s_mov_b64 s[38:39],0
s_sub_u32 s36,s54,13
s_and_b32 s36,s36,3
s_mov_b32 s12,s40
s_mov_b32 s13,s41
s_mov_b32 s14,2097152
s_mov_b32 s15,0x20000
v_add_u32 v21,10487168,v21
v_mov_b32 v244,v21
s_and_b32 s56,s50,2048
s_add_u32 s56,s56,147456
v_lshlrev_b32 v23,5,v1
v_add_u32 v23,s56,v23
v_and_b32 v253,32,v0
v_lshrrev_b32 v245,2,v253
v_add_u32 v253,v253,v245
v_sub_u32 v253,v0,v253
v_add_u32 v253,8,v253
v_mov_b32 v254,0x80000000
s_mov_b32 s56,1408
v_writelane_b32 v254,s56,0
s_mov_b32 s56,256
v_writelane_b32 v254,s56,1
s_mov_b32 s56,1280
v_writelane_b32 v254,s56,2
v_mov_b32 v245,155648
s_lshl_b32 s56,s46,2
v_add_u32 v247,s56,v245
s_waitcnt vmcnt(0)
v_lshlrev_b32 v228,16,v224
v_and_b32 v229,0xffff0000,v224
v_lshlrev_b32 v230,16,v225
v_and_b32 v231,0xffff0000,v225
v_lshlrev_b32 v232,16,v226
v_and_b32 v233,0xffff0000,v226
v_lshlrev_b32 v234,16,v227
v_and_b32 v235,0xffff0000,v227
v_mul_f32 v255,v228,v228
v_fma_f32 v255,v229,v229,v255
v_fma_f32 v255,v230,v230,v255
v_fma_f32 v255,v231,v231,v255
v_fma_f32 v255,v232,v232,v255
v_fma_f32 v255,v233,v233,v255
v_fma_f32 v255,v234,v234,v255
v_fma_f32 v255,v235,v235,v255
s_nop 1
v_add_f32_dpp v255,v255,v255 row_ror:8 row_mask:0xf bank_mask:0xf
s_nop 1
v_add_f32_dpp v255,v255,v255 row_ror:4 row_mask:0xf bank_mask:0xf
s_nop 1
v_add_f32_dpp v255,v255,v255 row_ror:2 row_mask:0xf bank_mask:0xf
s_nop 1
v_add_f32_dpp v255,v255,v255 row_ror:1 row_mask:0xf bank_mask:0xf
v_mov_b32 v238,v255
s_nop 1
v_permlane16_swap_b32 v255,v238
v_add_f32 v255,v255,v238
v_mov_b32 v238,v255
s_nop 1
v_permlane32_swap_b32 v255,v238
v_add_f32 v255,v255,v238
v_sqrt_f32 v255,v255
v_sub_u32 v238,68,v1
v_cvt_f32_u32 v238,v238
v_log_f32 v238,v238
v_mov_b32 v239,0x3ff9999a
v_fmac_f32 v239,0x3e632166,v238
v_mul_f32 v255,v255,v239
v_or_b32 v255,0x80000000,v255
s_xor_b32 s34,s69,524288
buffer_load_dwordx4 v[160:163],v7,s[8:11],s34 offen
s_add_u32 s34,s34,4096
buffer_load_dwordx4 v[164:167],v7,s[8:11],s34 offen
s_add_u32 s34,s34,4096
buffer_load_dwordx4 v[168:171],v7,s[8:11],s34 offen
s_add_u32 s34,s34,4096
buffer_load_dwordx4 v[172:175],v7,s[8:11],s34 offen
s_add_u32 s34,s34,4096
buffer_load_dwordx4 v[176:179],v7,s[8:11],s34 offen
s_add_u32 s34,s34,4096
buffer_load_dwordx4 v[180:183],v7,s[8:11],s34 offen
s_add_u32 s34,s34,4096
buffer_load_dwordx4 v[184:187],v7,s[8:11],s34 offen
s_add_u32 s34,s34,4096
buffer_load_dwordx4 v[188:191],v7,s[8:11],s34 offen
s_xor_b32 s69,s69,524288
s_xor_b32 s34,s69,524288
buffer_load_dwordx4 v[160:163],v7,s[8:11],s34 offen
s_add_u32 s34,s34,4096
buffer_load_dwordx4 v[164:167],v7,s[8:11],s34 offen
s_add_u32 s34,s34,4096
buffer_load_dwordx4 v[168:171],v7,s[8:11],s34 offen
s_add_u32 s34,s34,4096
buffer_load_dwordx4 v[172:175],v7,s[8:11],s34 offen
s_add_u32 s34,s34,4096
buffer_load_dwordx4 v[176:179],v7,s[8:11],s34 offen
s_add_u32 s34,s34,4096
buffer_load_dwordx4 v[180:183],v7,s[8:11],s34 offen
s_add_u32 s34,s34,4096
buffer_load_dwordx4 v[184:187],v7,s[8:11],s34 offen
s_add_u32 s34,s34,4096
buffer_load_dwordx4 v[188:191],v7,s[8:11],s34 offen
s_xor_b32 s69,s69,524288
s_cmp_lt_u32 s54,2
s_cbranch_scc1 L_aa_62
s_sub_u32 s77,s54,2
s_mov_b32 s30,0
s_mov_b32 s86,1536
s_lshl_b32 s56,s77,5
s_add_u32 s56,s56,s68
s_mul_i32 s70,s56,24576
s_lshl_b32 s71,s56,12
s_lshl_b32 s59,s77,13
s_lshl2_add_u32 s59,s68,s59
s_add_u32 s59,s59,10485760
s_buffer_load_dword s32,s[8:11],s59
s_mov_b32 s33,1
s_add_u32 s70,s70,100663296
s_add_u32 s71,s71,41943040
v_mov_b32 v19,s59
s_branch L_aa_70
L_aa_76:
s_bitcmp1_b32 s46,0
s_cbranch_scc1 L_av_77
ds_read_b128 v[24:27],v4 offset:0
ds_read_b128 v[28:31],v4 offset:1024
s_min_u32 s56,s32,s33
s_cmp_lt_u32 s77,64
s_cselect_b32 s56,s56,0
s_cmp_eq_u32 s56,0
s_cselect_b32 s72,0x80000000,0
v_mov_b32 v248,s72
s_or_b32 s64,s70,s72
s_or_b32 s65,s71,s72
s_and_b32 s57,s46,1
s_mul_i32 s58,s57,12288
s_add_u32 s64,s64,s58
s_lshl_b32 s57,s57,11
s_waitcnt lgkmcnt(1)
v_mfma_f32_16x16x32_bf16 v[160:163],v[24:27],a[0:3],0
ds_read_b128 v[32:35],v4 offset:2048
s_add_u32 s65,s65,s57
s_and_b32 s59,s50,2048
v_mfma_f32_16x16x32_bf16 v[164:167],v[24:27],a[4:7],0
ds_read_b128 v[36:39],v4 offset:3072
s_lshl_b32 s59,s59,4
s_xor_b32 s60,s67,65536
v_mfma_f32_16x16x32_bf16 v[168:171],v[24:27],a[8:11],0
ds_read_b128 v[40:43],v4 offset:8192
s_add_u32 s59,s59,s60
s_add_u32 s58,s58,s59
v_mfma_f32_16x16x32_bf16 v[172:175],v[24:27],a[12:15],0
ds_read_b128 v[44:47],v4 offset:9216
s_add_u32 s57,s57,s59
s_add_u32 m0,s58,0
v_mfma_f32_16x16x32_bf16 v[176:179],v[24:27],a[16:19],0
buffer_load_dwordx4 v0,s[8:11],s64 offen offset:0 sc1 lds
v_lshlrev_b32 v88,16,v224
v_and_b32 v89,0xffff0000,v224
v_mfma_f32_16x16x32_bf16 v[180:183],v[24:27],a[20:23],0
ds_read_b128 v[48:51],v4 offset:10240
v_lshlrev_b32 v90,16,v225
v_and_b32 v91,0xffff0000,v225
v_mfma_f32_16x16x32_bf16 v[184:187],v[24:27],a[24:27],0
ds_read_b128 v[52:55],v4 offset:11264
s_waitcnt vmcnt(8)
v_mfma_f32_16x16x32_bf16 v[128:131],v[156:159],v[192:195],0
ds_write_b32 v247,v248
v_lshlrev_b32 v92,16,v226
v_and_b32 v93,0xffff0000,v226
v_mfma_f32_16x16x32_bf16 v[188:191],v[24:27],a[28:31],0
ds_read_b128 v[56:59],v4 offset:4096
s_waitcnt vmcnt(7)
v_mfma_f32_16x16x32_bf16 v[128:131],v[156:159],v[196:199],v[128:131]
ds_read_b128 v[60:63],v4 offset:5120
v_lshlrev_b32 v94,16,v227
v_and_b32 v95,0xffff0000,v227
s_waitcnt lgkmcnt(9)
v_mfma_f32_16x16x32_bf16 v[160:163],v[28:31],a[32:35],v[160:163]
buffer_load_dwordx4 v0,s[8:11],s64 offen offset:1024 sc1 lds
s_waitcnt vmcnt(7)
v_mfma_f32_16x16x32_bf16 v[128:131],v[156:159],v[200:203],v[128:131]
ds_read_b128 v[64:67],v4 offset:6144
v_readfirstlane_b32 s22,v246
s_cmp_eq_u32 s22,0
s_cbranch_scc1 L_ag_78
L_agb_79:
v_mfma_f32_16x16x32_bf16 v[164:167],v[28:31],a[36:39],v[164:167]
ds_read_b128 v[68:71],v4 offset:7168
s_waitcnt vmcnt(6)
v_mfma_f32_16x16x32_bf16 v[128:131],v[156:159],v[204:207],v[128:131]
ds_read_b128 v[72:75],v4 offset:12288
s_lshl_b32 s18,s26,5
s_add_u32 s18,s18,s68
v_mfma_f32_16x16x32_bf16 v[168:171],v[28:31],a[40:43],v[168:171]
ds_read_b128 v[76:79],v4 offset:13312
s_waitcnt vmcnt(5)
v_mfma_f32_16x16x32_bf16 v[132:135],v[156:159],v[208:211],0
ds_read_b128 v[80:83],v4 offset:14336
s_lshl_b32 s19,s18,10
s_add_u32 s20,s19,6291456
v_mfma_f32_16x16x32_bf16 v[172:175],v[28:31],a[44:47],v[172:175]
ds_read_b128 v[84:87],v4 offset:15360
s_waitcnt vmcnt(4)
v_mfma_f32_16x16x32_bf16 v[132:135],v[156:159],v[212:215],v[132:135]
s_lshl_b32 s23,s51,5
s_add_u32 s23,s23,s68
s_lshl_b32 s24,s23,10
v_mfma_f32_16x16x32_bf16 v[176:179],v[28:31],a[48:51],v[176:179]
buffer_load_dwordx4 v0,s[8:11],s64 offen offset:2048 sc1 lds
s_waitcnt vmcnt(4)
v_mfma_f32_16x16x32_bf16 v[132:135],v[156:159],v[216:219],v[132:135]
s_lshl_b32 s25,s51,10
s_add_u32 s25,s25,2883584
s_cmp_eq_u32 s23,s55
s_cselect_b32 s25,s25,s24
v_mfma_f32_16x16x32_bf16 v[180:183],v[28:31],a[52:55],v[180:183]
ds_write_b128 v6,v[128:131]
s_waitcnt vmcnt(3)
v_mfma_f32_16x16x32_bf16 v[132:135],v[156:159],v[220:223],v[132:135]
s_add_u32 s25,s25,8388608
s_mov_b32 s6,268435456
s_cmp_eq_u32 s31,0
s_cselect_b32 s25,s24,s25
s_cselect_b64 s[4:5],s[16:17],s[44:45]
s_cmov_b32 s6,2097152
v_mfma_f32_16x16x32_bf16 v[184:187],v[28:31],a[56:59],v[184:187]
buffer_load_dwordx4 v[224:227],v0,s[4:7],s25 offen sc1
s_lshr_b32 s24,s55,5
s_cmp_lt_u32 s51,s24
s_cselect_b32 s24,1,2
v_mfma_f32_16x16x32_bf16 v[188:191],v[28:31],a[60:63],v[188:191]
v_mov_b32 v252,s24
s_lshl2_add_u32 s25,s51,11018240
s_waitcnt lgkmcnt(15)
v_mfma_f32_16x16x32_bf16 v[160:163],v[32:35],a[64:67],v[160:163]
ds_write_b128 v6,v[132:135] offset:2048
s_lshl_b32 s24,s68,16
s_add_u32 s24,s24,s31
v_mfma_f32_16x16x32_bf16 v[164:167],v[32:35],a[68:71],v[164:167]
buffer_load_dwordx4 v0,s[8:11],s64 offen offset:3072 sc1 lds
s_add_u32 s24,s24,s86
s_cmp_eq_u32 s24,1537
s_cselect_b32 s25,s25,0x80000000
v_mfma_f32_16x16x32_bf16 v[168:171],v[32:35],a[72:75],v[168:171]
buffer_store_dword v252,off,s[8:11],s25 sc1
s_bitcmp1_b64 s[38:39],s51
s_cselect_b32 s24,128,0
v_mfma_f32_16x16x32_bf16 v[172:175],v[32:35],a[76:79],v[172:175]
s_lshl_b32 s23,s51,13
s_lshl2_add_u32 s23,s68,s23
s_add_u32 s23,s23,10487168
v_mfma_f32_16x16x32_bf16 v[176:179],v[32:35],a[80:83],v[176:179]
s_waitcnt lgkmcnt(0)
s_barrier
s_add_u32 s23,s23,s24
v_mfma_f32_16x16x32_bf16 v[180:183],v[32:35],a[84:87],v[180:183]
ds_read_b128 v[96:99],v23
s_add_u32 m0,s58,4096
s_add_u32 s64,s64,4096
v_mfma_f32_16x16x32_bf16 v[184:187],v[32:35],a[88:91],v[184:187]
ds_read_b128 v[100:103],v23 offset:16
v_mfma_f32_16x16x32_bf16 v[188:191],v[32:35],a[92:95],v[188:191]
buffer_load_dwordx4 v0,s[8:11],s64 offen offset:0 sc1 lds
v_mfma_f32_16x16x32_bf16 v[160:163],v[36:39],a[96:99],v[160:163]
ds_read_b128 v[248:251],v245
v_mfma_f32_16x16x32_bf16 v[164:167],v[36:39],a[100:103],v[164:167]
buffer_load_dword v246,off,s[8:11],s23 sc1
v_lshrrev_b32 v244,4,v1
s_sub_u32 s23,s77,8
v_add_u32 v244,s23,v244
v_mfma_f32_16x16x32_bf16 v[168:171],v[36:39],a[104:107],v[168:171]
v_max_i32 v244,0,v244
v_lshl_add_u32 v244,v244,13,v21
v_mfma_f32_16x16x32_bf16 v[172:175],v[36:39],a[108:111],v[172:175]
buffer_load_dwordx4 v0,s[8:11],s64 offen offset:1024 sc1 lds
s_waitcnt lgkmcnt(1)
v_cvt_pk_bf16_f32 v104,v96,v97
v_cvt_pk_bf16_f32 v105,v98,v99
v_mfma_f32_16x16x32_bf16 v[176:179],v[36:39],a[112:115],v[176:179]
buffer_load_dwordx2 v[242:243],v244,s[8:11],0 offen sc1
v_cvt_pk_bf16_f32 v106,v100,v101
v_cvt_pk_bf16_f32 v107,v102,v103
v_lshlrev_b32 v96,16,v104
v_mfma_f32_16x16x32_bf16 v[180:183],v[36:39],a[116:119],v[180:183]
v_and_b32 v97,0xffff0000,v104
v_lshlrev_b32 v98,16,v105
v_mfma_f32_16x16x32_bf16 v[184:187],v[36:39],a[120:123],v[184:187]
s_waitcnt lgkmcnt(0)
v_or3_b32 v248,v248,v249,v250
v_or_b32 v248,v248,v251
v_mfma_f32_16x16x32_bf16 v[188:191],v[36:39],a[124:127],v[188:191]
buffer_load_dwordx4 v0,s[8:11],s64 offen offset:2048 sc1 lds
v_and_b32 v99,0xffff0000,v105
v_lshlrev_b32 v100,16,v106
v_mfma_f32_16x16x32_bf16 v[160:163],v[40:43],a[128:131],v[160:163]
v_readfirstlane_b32 s72,v248
v_and_b32 v101,0xffff0000,v106
v_mfma_f32_16x16x32_bf16 v[164:167],v[40:43],a[132:135],v[164:167]
v_lshlrev_b32 v102,16,v107
v_and_b32 v103,0xffff0000,v107
v_mfma_f32_16x16x32_bf16 v[168:171],v[40:43],a[136:139],v[168:171]
v_add_f32 v88,v88,v96
v_add_f32 v89,v89,v97
v_mfma_f32_16x16x32_bf16 v[172:175],v[40:43],a[140:143],v[172:175]
buffer_load_dwordx4 v0,s[8:11],s64 offen offset:3072 sc1 lds
v_add_f32 v90,v90,v98
v_add_f32 v91,v91,v99
v_mfma_f32_16x16x32_bf16 v[176:179],v[40:43],a[144:147],v[176:179]
v_add_f32 v92,v92,v100
v_add_f32 v93,v93,v101
v_mfma_f32_16x16x32_bf16 v[180:183],v[40:43],a[148:151],v[180:183]
v_add_f32 v94,v94,v102
v_add_f32 v95,v95,v103
v_mfma_f32_16x16x32_bf16 v[184:187],v[40:43],a[152:155],v[184:187]
v_cvt_pk_bf16_f32 v104,v88,v89
v_cvt_pk_bf16_f32 v105,v90,v91
v_mfma_f32_16x16x32_bf16 v[188:191],v[40:43],a[156:159],v[188:191]
s_add_u32 m0,s58,8192
s_add_u32 s64,s64,4096
v_cvt_pk_bf16_f32 v106,v92,v93
v_mfma_f32_16x16x32_bf16 v[160:163],v[44:47],a[160:163],v[160:163]
buffer_load_dwordx4 v0,s[8:11],s64 offen offset:0 sc1 lds
v_cvt_pk_bf16_f32 v107,v94,v95
v_mfma_f32_16x16x32_bf16 v[164:167],v[44:47],a[164:167],v[164:167]
buffer_store_dwordx4 v[104:107],v0,s[8:11],s20 offen sc1
v_lshlrev_b32 v88,16,v104
v_and_b32 v89,0xffff0000,v104
v_lshlrev_b32 v90,16,v105
v_mfma_f32_16x16x32_bf16 v[168:171],v[44:47],a[168:171],v[168:171]
v_and_b32 v91,0xffff0000,v105
v_lshlrev_b32 v92,16,v106
v_and_b32 v93,0xffff0000,v106
v_mfma_f32_16x16x32_bf16 v[172:175],v[44:47],a[172:175],v[172:175]
v_lshlrev_b32 v94,16,v107
v_and_b32 v95,0xffff0000,v107
v_mfma_f32_16x16x32_bf16 v[176:179],v[44:47],a[176:179],v[176:179]
buffer_load_dwordx4 v0,s[8:11],s64 offen offset:1024 sc1 lds
v_readfirstlane_b32 s78,v88
v_mfma_f32_16x16x32_bf16 v[180:183],v[44:47],a[180:183],v[180:183]
s_nop 0
v_add_f32 v120,v88,-s78
v_add_f32 v121,v89,-s78
v_add_f32 v122,v90,-s78
v_mfma_f32_16x16x32_bf16 v[184:187],v[44:47],a[184:187],v[184:187]
v_add_f32 v123,v91,-s78
v_add_f32 v124,v92,-s78
v_mfma_f32_16x16x32_bf16 v[188:191],v[44:47],a[188:191],v[188:191]
v_add_f32 v125,v93,-s78
v_add_f32 v126,v94,-s78
v_mfma_f32_16x16x32_bf16 v[160:163],v[48:51],a[192:195],v[160:163]
buffer_load_dwordx4 v0,s[8:11],s64 offen offset:2048 sc1 lds
v_add_f32 v127,v95,-s78
v_add_f32 v128,v120,v122
v_mfma_f32_16x16x32_bf16 v[164:167],v[48:51],a[196:199],v[164:167]
v_add_f32 v129,v121,v123
v_mul_f32 v130,v120,v120
v_mfma_f32_16x16x32_bf16 v[168:171],v[48:51],a[200:203],v[168:171]
v_mul_f32 v131,v121,v121
v_add_f32 v132,v124,v126
v_mfma_f32_16x16x32_bf16 v[172:175],v[48:51],a[204:207],v[172:175]
v_add_f32 v133,v125,v127
v_fma_f32 v130,v122,v122,v130
v_mfma_f32_16x16x32_bf16 v[176:179],v[48:51],a[208:211],v[176:179]
buffer_load_dwordx4 v0,s[8:11],s64 offen offset:3072 sc1 lds
v_fma_f32 v131,v123,v123,v131
v_add_f32 v128,v128,v132
v_mfma_f32_16x16x32_bf16 v[180:183],v[48:51],a[212:215],v[180:183]
v_add_f32 v129,v129,v133
v_fma_f32 v130,v124,v124,v130
v_mfma_f32_16x16x32_bf16 v[184:187],v[48:51],a[216:219],v[184:187]
v_fma_f32 v131,v125,v125,v131
v_add_f32 v128,v128,v129
v_mfma_f32_16x16x32_bf16 v[188:191],v[48:51],a[220:223],v[188:191]
v_fma_f32 v130,v126,v126,v130
v_fma_f32 v131,v127,v127,v131
v_mfma_f32_16x16x32_bf16 v[160:163],v[52:55],a[224:227],v[160:163]
s_add_u32 m0,s57,24576
v_add_f32 v130,v130,v131
v_mfma_f32_16x16x32_bf16 v[164:167],v[52:55],a[228:231],v[164:167]
buffer_load_dwordx4 v0,s[8:11],s65 offen offset:0 sc1 lds
v_permlane32_swap_b32 v128,v130
v_add_f32 v128,v128,v130
v_mfma_f32_16x16x32_bf16 v[168:171],v[52:55],a[232:235],v[168:171]
s_nop 0
v_add_f32_dpp v128,v128,v128 row_ror:8 row_mask:0xf bank_mask:0xf
v_mfma_f32_16x16x32_bf16 v[172:175],v[52:55],a[236:239],v[172:175]
s_nop 0
v_add_f32_dpp v128,v128,v128 row_ror:4 row_mask:0xf bank_mask:0xf
v_mfma_f32_16x16x32_bf16 v[176:179],v[52:55],a[240:243],v[176:179]
s_nop 0
v_add_f32_dpp v128,v128,v128 row_ror:2 row_mask:0xf bank_mask:0xf
v_mfma_f32_16x16x32_bf16 v[180:183],v[52:55],a[244:247],v[180:183]
buffer_load_dwordx4 v0,s[8:11],s65 offen offset:1024 sc1 lds
v_add_f32_dpp v128,v128,v128 row_ror:1 row_mask:0xf bank_mask:0xf
v_mov_b32 v130,v128
v_mfma_f32_16x16x32_bf16 v[184:187],v[52:55],a[248:251],v[184:187]
s_nop 0
v_permlane16_swap_b32 v128,v130
v_add_f32 v128,v128,v130
v_mul_f32 v128,0x3b000000,v128
v_mfma_f32_16x16x32_bf16 v[188:191],v[52:55],a[252:255],v[188:191]
v_mov_b32 v130,v128
v_mfma_f32_16x16x32_bf16 v[192:195],v[56:59],a[0:3],0
s_nop 0
v_permlane32_swap_b32 v128,v130
v_fma_f32 v130,-v128,v128,v130
v_add_f32 v128,s78,v128
v_mfma_f32_16x16x32_bf16 v[196:199],v[56:59],a[4:7],0
v_max_f32 v130,0,v130
v_cvt_pk_bf16_f32 v130,v128,v130
v_lshlrev_b32 v128,16,v130
v_mfma_f32_16x16x32_bf16 v[200:203],v[56:59],a[8:11],0
v_and_b32 v130,0xffff0000,v130
v_add_f32 v130,0x3727c5ac,v130
v_cvt_pk_bf16_f32 v130,v130,v130
v_mfma_f32_16x16x32_bf16 v[204:207],v[56:59],a[12:15],0
v_and_b32 v130,0xffff0000,v130
v_sqrt_f32 v130,v130
v_add_f32 v120,v88,-v128
v_mfma_f32_16x16x32_bf16 v[208:211],v[56:59],a[16:19],0
v_add_f32 v121,v89,-v128
v_add_f32 v122,v90,-v128
v_mfma_f32_16x16x32_bf16 v[212:215],v[56:59],a[20:23],0
v_add_f32 v123,v91,-v128
v_add_f32 v124,v92,-v128
v_mfma_f32_16x16x32_bf16 v[216:219],v[56:59],a[24:27],0
v_add_f32 v125,v93,-v128
v_add_f32 v126,v94,-v128
v_mfma_f32_16x16x32_bf16 v[220:223],v[56:59],a[28:31],0
v_add_f32 v127,v95,-v128
v_cvt_pk_bf16_f32 v130,v130,v130
v_mfma_f32_16x16x32_bf16 v[192:195],v[60:63],a[32:35],v[192:195]
v_and_b32 v130,0xffff0000,v130
v_rcp_f32 v130,v130
v_mfma_f32_16x16x32_bf16 v[196:199],v[60:63],a[36:39],v[196:199]
v_cvt_pk_bf16_f32 v108,v120,v121
v_cvt_pk_bf16_f32 v109,v122,v123
v_mfma_f32_16x16x32_bf16 v[200:203],v[60:63],a[40:43],v[200:203]
v_cvt_pk_bf16_f32 v110,v124,v125
v_cvt_pk_bf16_f32 v111,v126,v127
v_mfma_f32_16x16x32_bf16 v[204:207],v[60:63],a[44:47],v[204:207]
v_lshlrev_b32 v120,16,v108
v_and_b32 v121,0xffff0000,v108
v_mfma_f32_16x16x32_bf16 v[208:211],v[60:63],a[48:51],v[208:211]
v_lshlrev_b32 v122,16,v109
v_and_b32 v123,0xffff0000,v109
v_mfma_f32_16x16x32_bf16 v[212:215],v[60:63],a[52:55],v[212:215]
v_lshlrev_b32 v124,16,v110
v_and_b32 v125,0xffff0000,v110
v_mfma_f32_16x16x32_bf16 v[216:219],v[60:63],a[56:59],v[216:219]
v_lshlrev_b32 v126,16,v111
v_and_b32 v127,0xffff0000,v111
v_mfma_f32_16x16x32_bf16 v[220:223],v[60:63],a[60:63],v[220:223]
v_mul_f32 v120,v120,v130
v_mul_f32 v121,v121,v130
v_mfma_f32_16x16x32_bf16 v[192:195],v[64:67],a[64:67],v[192:195]
v_mul_f32 v122,v122,v130
v_mul_f32 v123,v123,v130
v_mfma_f32_16x16x32_bf16 v[196:199],v[64:67],a[68:71],v[196:199]
v_mul_f32 v124,v124,v130
v_mul_f32 v125,v125,v130
v_mfma_f32_16x16x32_bf16 v[200:203],v[64:67],a[72:75],v[200:203]
v_mul_f32 v126,v126,v130
v_mul_f32 v127,v127,v130
v_mfma_f32_16x16x32_bf16 v[204:207],v[64:67],a[76:79],v[204:207]
v_cvt_pk_bf16_f32 v108,v120,v121
v_cvt_pk_bf16_f32 v109,v122,v123
v_mfma_f32_16x16x32_bf16 v[208:211],v[64:67],a[80:83],v[208:211]
v_cvt_pk_bf16_f32 v24,v160,v164
v_cvt_pk_bf16_f32 v25,v168,v172
v_mfma_f32_16x16x32_bf16 v[212:215],v[64:67],a[84:87],v[212:215]
v_cvt_pk_bf16_f32 v26,v176,v180
v_cvt_pk_bf16_f32 v27,v184,v188
v_mfma_f32_16x16x32_bf16 v[216:219],v[64:67],a[88:91],v[216:219]
v_cvt_pk_bf16_f32 v28,v161,v165
v_cvt_pk_bf16_f32 v29,v169,v173
v_mfma_f32_16x16x32_bf16 v[220:223],v[64:67],a[92:95],v[220:223]
v_cvt_pk_bf16_f32 v30,v177,v181
v_cvt_pk_bf16_f32 v31,v185,v189
v_mfma_f32_16x16x32_bf16 v[192:195],v[68:71],a[96:99],v[192:195]
v_cvt_pk_bf16_f32 v32,v162,v166
v_cvt_pk_bf16_f32 v33,v170,v174
v_mfma_f32_16x16x32_bf16 v[196:199],v[68:71],a[100:103],v[196:199]
v_cvt_pk_bf16_f32 v34,v178,v182
v_cvt_pk_bf16_f32 v35,v186,v190
v_mfma_f32_16x16x32_bf16 v[200:203],v[68:71],a[104:107],v[200:203]
v_cvt_pk_bf16_f32 v36,v163,v167
v_cvt_pk_bf16_f32 v37,v171,v175
v_mfma_f32_16x16x32_bf16 v[204:207],v[68:71],a[108:111],v[204:207]
v_cvt_pk_bf16_f32 v38,v179,v183
v_cvt_pk_bf16_f32 v39,v187,v191
v_mfma_f32_16x16x32_bf16 v[208:211],v[68:71],a[112:115],v[208:211]
s_add_u32 s62,s69,0
v_cvt_pk_bf16_f32 v110,v124,v125
v_cvt_pk_bf16_f32 v111,v126,v127
v_mfma_f32_16x16x32_bf16 v[212:215],v[68:71],a[116:119],v[212:215]
buffer_store_dwordx4 v[24:27],v5,s[8:11],s62 offen
v_lshlrev_b32 v112,16,v108
v_and_b32 v113,0xffff0000,v108
v_mfma_f32_16x16x32_bf16 v[216:219],v[68:71],a[120:123],v[216:219]
v_lshlrev_b32 v114,16,v109
v_and_b32 v115,0xffff0000,v109
v_mfma_f32_16x16x32_bf16 v[220:223],v[68:71],a[124:127],v[220:223]
v_lshlrev_b32 v116,16,v110
v_and_b32 v117,0xffff0000,v110
v_mfma_f32_16x16x32_bf16 v[192:195],v[72:75],a[128:131],v[192:195]
s_add_u32 s62,s69,16384
v_lshlrev_b32 v118,16,v111
v_and_b32 v119,0xffff0000,v111
v_mfma_f32_16x16x32_bf16 v[196:199],v[72:75],a[132:135],v[196:199]
buffer_store_dwordx4 v[28:31],v5,s[8:11],s62 offen
v_add_f32 v88,v88,v112
v_add_f32 v89,v89,v113
v_mfma_f32_16x16x32_bf16 v[200:203],v[72:75],a[136:139],v[200:203]
v_add_f32 v90,v90,v114
v_add_f32 v91,v91,v115
v_mfma_f32_16x16x32_bf16 v[204:207],v[72:75],a[140:143],v[204:207]
v_add_f32 v92,v92,v116
v_add_f32 v93,v93,v117
v_mfma_f32_16x16x32_bf16 v[208:211],v[72:75],a[144:147],v[208:211]
s_add_u32 s62,s69,32768
v_add_f32 v94,v94,v118
v_add_f32 v95,v95,v119
v_mfma_f32_16x16x32_bf16 v[212:215],v[72:75],a[148:151],v[212:215]
buffer_store_dwordx4 v[32:35],v5,s[8:11],s62 offen
v_cvt_pk_bf16_f32 v96,v88,v89
v_cvt_pk_bf16_f32 v97,v90,v91
v_mfma_f32_16x16x32_bf16 v[216:219],v[72:75],a[152:155],v[216:219]
v_cvt_pk_bf16_f32 v98,v92,v93
v_cvt_pk_bf16_f32 v99,v94,v95
v_mfma_f32_16x16x32_bf16 v[220:223],v[72:75],a[156:159],v[220:223]
buffer_store_dwordx4 v[96:99],v0,s[12:15],s19 offen sc1
v_mul_f32 v236,v112,v228
v_mul_f32 v237,v113,v229
v_mfma_f32_16x16x32_bf16 v[192:195],v[76:79],a[160:163],v[192:195]
s_add_u32 s62,s69,49152
v_fma_f32 v236,v114,v230,v236
v_fma_f32 v237,v115,v231,v237
v_mfma_f32_16x16x32_bf16 v[196:199],v[76:79],a[164:167],v[196:199]
buffer_store_dwordx4 v[36:39],v5,s[8:11],s62 offen
v_fma_f32 v236,v116,v232,v236
v_fma_f32 v237,v117,v233,v237
v_mfma_f32_16x16x32_bf16 v[200:203],v[76:79],a[168:171],v[200:203]
v_fma_f32 v236,v118,v234,v236
v_fma_f32 v237,v119,v235,v237
v_mfma_f32_16x16x32_bf16 v[204:207],v[76:79],a[172:175],v[204:207]
v_add_f32 v236,v236,v237
v_mfma_f32_16x16x32_bf16 v[208:211],v[76:79],a[176:179],v[208:211]
s_nop 0
v_add_f32_dpp v236,v236,v236 row_ror:8 row_mask:0xf bank_mask:0xf
v_mfma_f32_16x16x32_bf16 v[212:215],v[76:79],a[180:183],v[212:215]
s_nop 0
v_add_f32_dpp v236,v236,v236 row_ror:4 row_mask:0xf bank_mask:0xf
v_mfma_f32_16x16x32_bf16 v[216:219],v[76:79],a[184:187],v[216:219]
s_nop 0
v_add_f32_dpp v236,v236,v236 row_ror:2 row_mask:0xf bank_mask:0xf
v_mfma_f32_16x16x32_bf16 v[220:223],v[76:79],a[188:191],v[220:223]
s_nop 0
v_add_f32_dpp v236,v236,v236 row_ror:1 row_mask:0xf bank_mask:0xf
v_mov_b32 v237,v236
v_mfma_f32_16x16x32_bf16 v[192:195],v[80:83],a[192:195],v[192:195]
s_nop 0
v_permlane16_swap_b32 v236,v237
v_add_f32 v236,v236,v237
v_mov_b32 v237,v236
v_mfma_f32_16x16x32_bf16 v[196:199],v[80:83],a[196:199],v[196:199]
s_nop 0
v_permlane32_swap_b32 v236,v237
v_add_f32 v236,v236,v237
v_cvt_pk_bf16_f32 v236,v236,v236
v_mfma_f32_16x16x32_bf16 v[200:203],v[80:83],a[200:203],v[200:203]
v_and_b32 v236,0xffff0000,v236
v_ashrrev_i32 v237,31,v236
v_or_b32 v237,0x80000000,v237
v_mfma_f32_16x16x32_bf16 v[204:207],v[80:83],a[204:207],v[204:207]
v_xor_b32 v236,v236,v237
v_and_b32 v236,0xffff0000,v236
s_sub_u32 s20,4095,s18
v_mfma_f32_16x16x32_bf16 v[208:211],v[80:83],a[208:211],v[208:211]
v_or_b32 v20,s20,v236
s_lshl_b32 s73,s26,13
s_lshl2_add_u32 s73,s68,s73
v_mfma_f32_16x16x32_bf16 v[212:215],v[80:83],a[212:215],v[212:215]
s_add_u32 s73,s73,10485760
s_add_u32 s73,s73,s86
v_mfma_f32_16x16x32_bf16 v[216:219],v[80:83],a[216:219],v[216:219]
v_mfma_f32_16x16x32_bf16 v[220:223],v[80:83],a[220:223],v[220:223]
v_mfma_f32_16x16x32_bf16 v[192:195],v[84:87],a[224:227],v[192:195]
v_mfma_f32_16x16x32_bf16 v[196:199],v[84:87],a[228:231],v[196:199]
v_mfma_f32_16x16x32_bf16 v[200:203],v[84:87],a[232:235],v[200:203]
v_mfma_f32_16x16x32_bf16 v[204:207],v[84:87],a[236:239],v[204:207]
v_mfma_f32_16x16x32_bf16 v[208:211],v[84:87],a[240:243],v[208:211]
v_mfma_f32_16x16x32_bf16 v[212:215],v[84:87],a[244:247],v[212:215]
v_mfma_f32_16x16x32_bf16 v[216:219],v[84:87],a[248:251],v[216:219]
v_mfma_f32_16x16x32_bf16 v[220:223],v[84:87],a[252:255],v[220:223]
v_cvt_pk_bf16_f32 v40,v192,v196
v_cvt_pk_bf16_f32 v41,v200,v204
v_cvt_pk_bf16_f32 v42,v208,v212
s_nop 4
v_cvt_pk_bf16_f32 v43,v216,v220
s_add_u32 s62,s69,262144
buffer_store_dwordx4 v[40:43],v5,s[8:11],s62 offen
v_cvt_pk_bf16_f32 v44,v193,v197
v_cvt_pk_bf16_f32 v45,v201,v205
v_cvt_pk_bf16_f32 v46,v209,v213
v_cvt_pk_bf16_f32 v47,v217,v221
s_add_u32 s62,s69,278528
buffer_store_dwordx4 v[44:47],v5,s[8:11],s62 offen
v_cvt_pk_bf16_f32 v48,v194,v198
v_cvt_pk_bf16_f32 v49,v202,v206
v_cvt_pk_bf16_f32 v50,v210,v214
v_cvt_pk_bf16_f32 v51,v218,v222
s_add_u32 s62,s69,294912
buffer_store_dwordx4 v[48:51],v5,s[8:11],s62 offen
v_cvt_pk_bf16_f32 v52,v195,v199
v_cvt_pk_bf16_f32 v53,v203,v207
v_cvt_pk_bf16_f32 v54,v211,v215
v_cvt_pk_bf16_f32 v55,v219,v223
s_add_u32 s62,s69,311296
buffer_store_dwordx4 v[52:55],v5,s[8:11],s62 offen
s_cmp_lg_u32 s72,0
s_cbranch_scc1 L_aa_65
s_waitcnt vmcnt(9)
s_branch L_aa_75
L_av_77:
ds_read_b128 v[24:27],v4 offset:0
ds_read_b128 v[28:31],v4 offset:1024
s_min_u32 s56,s32,s33
s_cmp_lt_u32 s77,64
s_cselect_b32 s56,s56,0
s_cmp_eq_u32 s56,0
s_cselect_b32 s72,0x80000000,0
v_mov_b32 v248,s72
s_or_b32 s64,s70,s72
s_or_b32 s65,s71,s72
s_and_b32 s57,s46,1
s_mul_i32 s58,s57,12288
s_add_u32 s64,s64,s58
s_lshl_b32 s57,s57,11
s_waitcnt lgkmcnt(1)
v_mfma_f32_16x16x32_bf16 v[160:163],v[24:27],a[0:3],0
ds_read_b128 v[32:35],v4 offset:2048
s_add_u32 s65,s65,s57
s_and_b32 s59,s50,2048
v_mfma_f32_16x16x32_bf16 v[164:167],v[24:27],a[4:7],0
ds_read_b128 v[36:39],v4 offset:3072
s_lshl_b32 s59,s59,4
s_xor_b32 s60,s67,65536
v_mfma_f32_16x16x32_bf16 v[168:171],v[24:27],a[8:11],0
ds_read_b128 v[40:43],v4 offset:8192
s_add_u32 s59,s59,s60
s_add_u32 s58,s58,s59
v_mfma_f32_16x16x32_bf16 v[172:175],v[24:27],a[12:15],0
ds_read_b128 v[44:47],v4 offset:9216
s_add_u32 s57,s57,s59
s_add_u32 m0,s58,0
v_mfma_f32_16x16x32_bf16 v[176:179],v[24:27],a[16:19],0
buffer_load_dwordx4 v0,s[8:11],s64 offen offset:0 sc1 lds
s_lshl_b32 s23,s51,5
s_add_u32 s23,s23,s68
v_mfma_f32_16x16x32_bf16 v[180:183],v[24:27],a[20:23],0
ds_read_b128 v[48:51],v4 offset:10240
s_lshl_b32 s24,s23,10
s_lshl_b32 s25,s51,10
v_mfma_f32_16x16x32_bf16 v[184:187],v[24:27],a[24:27],0
ds_read_b128 v[52:55],v4 offset:11264
s_waitcnt vmcnt(8)
v_mfma_f32_16x16x32_bf16 v[128:131],v[156:159],v[192:195],0
ds_write_b32 v247,v248
s_add_u32 s25,s25,2883584
s_cmp_eq_u32 s23,s55
s_cselect_b32 s25,s25,s24
v_mfma_f32_16x16x32_bf16 v[188:191],v[24:27],a[28:31],0
ds_read_b128 v[56:59],v4 offset:4096
s_waitcnt vmcnt(7)
v_mfma_f32_16x16x32_bf16 v[128:131],v[156:159],v[196:199],v[128:131]
ds_read_b128 v[60:63],v4 offset:5120
s_add_u32 s25,s25,8388608
s_mov_b32 s6,268435456
s_waitcnt lgkmcnt(9)
v_mfma_f32_16x16x32_bf16 v[160:163],v[28:31],a[32:35],v[160:163]
buffer_load_dwordx4 v0,s[8:11],s64 offen offset:1024 sc1 lds
s_waitcnt vmcnt(7)
v_mfma_f32_16x16x32_bf16 v[128:131],v[156:159],v[200:203],v[128:131]
ds_read_b128 v[64:67],v4 offset:6144
s_cmp_eq_u32 s31,0
s_cselect_b32 s25,s24,s25
s_cselect_b64 s[4:5],s[16:17],s[44:45]
s_cmov_b32 s6,2097152
v_mfma_f32_16x16x32_bf16 v[164:167],v[28:31],a[36:39],v[164:167]
ds_read_b128 v[68:71],v4 offset:7168
s_waitcnt vmcnt(6)
v_mfma_f32_16x16x32_bf16 v[128:131],v[156:159],v[204:207],v[128:131]
ds_read_b128 v[72:75],v4 offset:12288
v_mfma_f32_16x16x32_bf16 v[168:171],v[28:31],a[40:43],v[168:171]
ds_read_b128 v[76:79],v4 offset:13312
s_waitcnt vmcnt(5)
v_mfma_f32_16x16x32_bf16 v[132:135],v[156:159],v[208:211],0
ds_read_b128 v[80:83],v4 offset:14336
v_mfma_f32_16x16x32_bf16 v[172:175],v[28:31],a[44:47],v[172:175]
ds_read_b128 v[84:87],v4 offset:15360
s_waitcnt vmcnt(4)
v_mfma_f32_16x16x32_bf16 v[132:135],v[156:159],v[212:215],v[132:135]
buffer_load_dwordx4 v[224:227],v0,s[4:7],s25 offen sc1
s_lshr_b32 s24,s55,5
s_cmp_lt_u32 s51,s24
s_cselect_b32 s24,1,2
v_mfma_f32_16x16x32_bf16 v[176:179],v[28:31],a[48:51],v[176:179]
buffer_load_dwordx4 v0,s[8:11],s64 offen offset:2048 sc1 lds
s_waitcnt vmcnt(5)
v_mfma_f32_16x16x32_bf16 v[132:135],v[156:159],v[216:219],v[132:135]
v_mov_b32 v252,s24
s_lshl2_add_u32 s25,s51,11018240
v_mfma_f32_16x16x32_bf16 v[180:183],v[28:31],a[52:55],v[180:183]
ds_write_b128 v6,v[128:131]
s_waitcnt vmcnt(4)
v_mfma_f32_16x16x32_bf16 v[132:135],v[156:159],v[220:223],v[132:135]
s_lshl_b32 s24,s68,16
s_add_u32 s24,s24,s31
s_add_u32 s24,s24,s86
v_mfma_f32_16x16x32_bf16 v[184:187],v[28:31],a[56:59],v[184:187]
s_cmp_eq_u32 s24,1537
s_cselect_b32 s25,s25,0x80000000
v_mfma_f32_16x16x32_bf16 v[188:191],v[28:31],a[60:63],v[188:191]
buffer_store_dword v252,off,s[8:11],s25 sc1
s_bitcmp1_b64 s[38:39],s51
s_cselect_b32 s24,128,0
s_waitcnt lgkmcnt(15)
v_mfma_f32_16x16x32_bf16 v[160:163],v[32:35],a[64:67],v[160:163]
ds_write_b128 v6,v[132:135] offset:2048
s_lshl_b32 s23,s51,13
s_lshl2_add_u32 s23,s68,s23
v_mfma_f32_16x16x32_bf16 v[164:167],v[32:35],a[68:71],v[164:167]
buffer_load_dwordx4 v0,s[8:11],s64 offen offset:3072 sc1 lds
s_add_u32 s23,s23,10487168
s_add_u32 s23,s23,s24
v_mfma_f32_16x16x32_bf16 v[168:171],v[32:35],a[72:75],v[168:171]
buffer_load_dword v246,off,s[8:11],s23 sc1
v_lshrrev_b32 v244,4,v1
s_sub_u32 s23,s77,8
v_mfma_f32_16x16x32_bf16 v[172:175],v[32:35],a[76:79],v[172:175]
v_add_u32 v244,s23,v244
v_max_i32 v244,0,v244
v_mfma_f32_16x16x32_bf16 v[176:179],v[32:35],a[80:83],v[176:179]
s_waitcnt lgkmcnt(0)
s_barrier
v_lshl_add_u32 v244,v244,13,v21
v_mfma_f32_16x16x32_bf16 v[180:183],v[32:35],a[84:87],v[180:183]
ds_read_b128 v[248:251],v245
s_add_u32 m0,s58,4096
s_add_u32 s64,s64,4096
v_mfma_f32_16x16x32_bf16 v[184:187],v[32:35],a[88:91],v[184:187]
buffer_load_dwordx4 v0,s[8:11],s64 offen offset:0 sc1 lds
v_mfma_f32_16x16x32_bf16 v[188:191],v[32:35],a[92:95],v[188:191]
buffer_load_dwordx2 v[242:243],v244,s[8:11],0 offen sc1
v_mfma_f32_16x16x32_bf16 v[160:163],v[36:39],a[96:99],v[160:163]
v_mfma_f32_16x16x32_bf16 v[164:167],v[36:39],a[100:103],v[164:167]
v_mfma_f32_16x16x32_bf16 v[168:171],v[36:39],a[104:107],v[168:171]
buffer_load_dwordx4 v0,s[8:11],s64 offen offset:1024 sc1 lds
v_mfma_f32_16x16x32_bf16 v[172:175],v[36:39],a[108:111],v[172:175]
v_mfma_f32_16x16x32_bf16 v[176:179],v[36:39],a[112:115],v[176:179]
s_waitcnt lgkmcnt(0)
v_or3_b32 v248,v248,v249,v250
v_or_b32 v248,v248,v251
v_mfma_f32_16x16x32_bf16 v[180:183],v[36:39],a[116:119],v[180:183]
v_mfma_f32_16x16x32_bf16 v[184:187],v[36:39],a[120:123],v[184:187]
buffer_load_dwordx4 v0,s[8:11],s64 offen offset:2048 sc1 lds
v_readfirstlane_b32 s72,v248
v_mfma_f32_16x16x32_bf16 v[188:191],v[36:39],a[124:127],v[188:191]
v_mfma_f32_16x16x32_bf16 v[160:163],v[40:43],a[128:131],v[160:163]
v_mfma_f32_16x16x32_bf16 v[164:167],v[40:43],a[132:135],v[164:167]
v_mfma_f32_16x16x32_bf16 v[168:171],v[40:43],a[136:139],v[168:171]
buffer_load_dwordx4 v0,s[8:11],s64 offen offset:3072 sc1 lds
v_mfma_f32_16x16x32_bf16 v[172:175],v[40:43],a[140:143],v[172:175]
v_mfma_f32_16x16x32_bf16 v[176:179],v[40:43],a[144:147],v[176:179]
v_mfma_f32_16x16x32_bf16 v[180:183],v[40:43],a[148:151],v[180:183]
v_mfma_f32_16x16x32_bf16 v[184:187],v[40:43],a[152:155],v[184:187]
s_add_u32 m0,s58,8192
s_add_u32 s64,s64,4096
v_mfma_f32_16x16x32_bf16 v[188:191],v[40:43],a[156:159],v[188:191]
buffer_load_dwordx4 v0,s[8:11],s64 offen offset:0 sc1 lds
v_mfma_f32_16x16x32_bf16 v[160:163],v[44:47],a[160:163],v[160:163]
v_mfma_f32_16x16x32_bf16 v[164:167],v[44:47],a[164:167],v[164:167]
v_mfma_f32_16x16x32_bf16 v[168:171],v[44:47],a[168:171],v[168:171]
v_mfma_f32_16x16x32_bf16 v[172:175],v[44:47],a[172:175],v[172:175]
buffer_load_dwordx4 v0,s[8:11],s64 offen offset:1024 sc1 lds
v_mfma_f32_16x16x32_bf16 v[176:179],v[44:47],a[176:179],v[176:179]
v_mfma_f32_16x16x32_bf16 v[180:183],v[44:47],a[180:183],v[180:183]
v_mfma_f32_16x16x32_bf16 v[184:187],v[44:47],a[184:187],v[184:187]
v_mfma_f32_16x16x32_bf16 v[188:191],v[44:47],a[188:191],v[188:191]
buffer_load_dwordx4 v0,s[8:11],s64 offen offset:2048 sc1 lds
v_mfma_f32_16x16x32_bf16 v[160:163],v[48:51],a[192:195],v[160:163]
v_mfma_f32_16x16x32_bf16 v[164:167],v[48:51],a[196:199],v[164:167]
v_mfma_f32_16x16x32_bf16 v[168:171],v[48:51],a[200:203],v[168:171]
v_mfma_f32_16x16x32_bf16 v[172:175],v[48:51],a[204:207],v[172:175]
buffer_load_dwordx4 v0,s[8:11],s64 offen offset:3072 sc1 lds
v_mfma_f32_16x16x32_bf16 v[176:179],v[48:51],a[208:211],v[176:179]
v_mfma_f32_16x16x32_bf16 v[180:183],v[48:51],a[212:215],v[180:183]
v_mfma_f32_16x16x32_bf16 v[184:187],v[48:51],a[216:219],v[184:187]
v_mfma_f32_16x16x32_bf16 v[188:191],v[48:51],a[220:223],v[188:191]
s_add_u32 m0,s57,24576
v_mfma_f32_16x16x32_bf16 v[160:163],v[52:55],a[224:227],v[160:163]
buffer_load_dwordx4 v0,s[8:11],s65 offen offset:0 sc1 lds
v_mfma_f32_16x16x32_bf16 v[164:167],v[52:55],a[228:231],v[164:167]
v_mfma_f32_16x16x32_bf16 v[168:171],v[52:55],a[232:235],v[168:171]
v_mfma_f32_16x16x32_bf16 v[172:175],v[52:55],a[236:239],v[172:175]
v_mfma_f32_16x16x32_bf16 v[176:179],v[52:55],a[240:243],v[176:179]
buffer_load_dwordx4 v0,s[8:11],s65 offen offset:1024 sc1 lds
v_mfma_f32_16x16x32_bf16 v[180:183],v[52:55],a[244:247],v[180:183]
v_mfma_f32_16x16x32_bf16 v[184:187],v[52:55],a[248:251],v[184:187]
v_mfma_f32_16x16x32_bf16 v[188:191],v[52:55],a[252:255],v[188:191]
v_mfma_f32_16x16x32_bf16 v[192:195],v[56:59],a[0:3],0
v_mfma_f32_16x16x32_bf16 v[196:199],v[56:59],a[4:7],0
v_mfma_f32_16x16x32_bf16 v[200:203],v[56:59],a[8:11],0
v_cvt_pk_bf16_f32 v24,v160,v164
v_cvt_pk_bf16_f32 v25,v168,v172
v_mfma_f32_16x16x32_bf16 v[204:207],v[56:59],a[12:15],0
v_cvt_pk_bf16_f32 v26,v176,v180
v_cvt_pk_bf16_f32 v27,v184,v188
v_mfma_f32_16x16x32_bf16 v[208:211],v[56:59],a[16:19],0
v_cvt_pk_bf16_f32 v28,v161,v165
v_cvt_pk_bf16_f32 v29,v169,v173
v_mfma_f32_16x16x32_bf16 v[212:215],v[56:59],a[20:23],0
v_cvt_pk_bf16_f32 v30,v177,v181
v_cvt_pk_bf16_f32 v31,v185,v189
v_mfma_f32_16x16x32_bf16 v[216:219],v[56:59],a[24:27],0
v_cvt_pk_bf16_f32 v32,v162,v166
v_cvt_pk_bf16_f32 v33,v170,v174
v_mfma_f32_16x16x32_bf16 v[220:223],v[56:59],a[28:31],0
v_cvt_pk_bf16_f32 v34,v178,v182
v_cvt_pk_bf16_f32 v35,v186,v190
v_mfma_f32_16x16x32_bf16 v[192:195],v[60:63],a[32:35],v[192:195]
v_cvt_pk_bf16_f32 v36,v163,v167
v_cvt_pk_bf16_f32 v37,v171,v175
v_mfma_f32_16x16x32_bf16 v[196:199],v[60:63],a[36:39],v[196:199]
v_cvt_pk_bf16_f32 v38,v179,v183
v_cvt_pk_bf16_f32 v39,v187,v191
v_mfma_f32_16x16x32_bf16 v[200:203],v[60:63],a[40:43],v[200:203]
v_mfma_f32_16x16x32_bf16 v[204:207],v[60:63],a[44:47],v[204:207]
v_mfma_f32_16x16x32_bf16 v[208:211],v[60:63],a[48:51],v[208:211]
v_mfma_f32_16x16x32_bf16 v[212:215],v[60:63],a[52:55],v[212:215]
v_mfma_f32_16x16x32_bf16 v[216:219],v[60:63],a[56:59],v[216:219]
v_mfma_f32_16x16x32_bf16 v[220:223],v[60:63],a[60:63],v[220:223]
v_mfma_f32_16x16x32_bf16 v[192:195],v[64:67],a[64:67],v[192:195]
v_mfma_f32_16x16x32_bf16 v[196:199],v[64:67],a[68:71],v[196:199]
v_mfma_f32_16x16x32_bf16 v[200:203],v[64:67],a[72:75],v[200:203]
v_mfma_f32_16x16x32_bf16 v[204:207],v[64:67],a[76:79],v[204:207]
v_mfma_f32_16x16x32_bf16 v[208:211],v[64:67],a[80:83],v[208:211]
v_mfma_f32_16x16x32_bf16 v[212:215],v[64:67],a[84:87],v[212:215]
v_mfma_f32_16x16x32_bf16 v[216:219],v[64:67],a[88:91],v[216:219]
v_mfma_f32_16x16x32_bf16 v[220:223],v[64:67],a[92:95],v[220:223]
v_mfma_f32_16x16x32_bf16 v[192:195],v[68:71],a[96:99],v[192:195]
v_mfma_f32_16x16x32_bf16 v[196:199],v[68:71],a[100:103],v[196:199]
v_mfma_f32_16x16x32_bf16 v[200:203],v[68:71],a[104:107],v[200:203]
v_mfma_f32_16x16x32_bf16 v[204:207],v[68:71],a[108:111],v[204:207]
v_mfma_f32_16x16x32_bf16 v[208:211],v[68:71],a[112:115],v[208:211]
s_add_u32 s62,s69,0
v_mfma_f32_16x16x32_bf16 v[212:215],v[68:71],a[116:119],v[212:215]
buffer_store_dwordx4 v[24:27],v5,s[8:11],s62 offen
v_mfma_f32_16x16x32_bf16 v[216:219],v[68:71],a[120:123],v[216:219]
v_mfma_f32_16x16x32_bf16 v[220:223],v[68:71],a[124:127],v[220:223]
v_mfma_f32_16x16x32_bf16 v[192:195],v[72:75],a[128:131],v[192:195]
s_add_u32 s62,s69,16384
v_mfma_f32_16x16x32_bf16 v[196:199],v[72:75],a[132:135],v[196:199]
buffer_store_dwordx4 v[28:31],v5,s[8:11],s62 offen
v_mfma_f32_16x16x32_bf16 v[200:203],v[72:75],a[136:139],v[200:203]
v_mfma_f32_16x16x32_bf16 v[204:207],v[72:75],a[140:143],v[204:207]
v_mfma_f32_16x16x32_bf16 v[208:211],v[72:75],a[144:147],v[208:211]
s_add_u32 s62,s69,32768
v_mfma_f32_16x16x32_bf16 v[212:215],v[72:75],a[148:151],v[212:215]
buffer_store_dwordx4 v[32:35],v5,s[8:11],s62 offen
v_mfma_f32_16x16x32_bf16 v[216:219],v[72:75],a[152:155],v[216:219]
v_mfma_f32_16x16x32_bf16 v[220:223],v[72:75],a[156:159],v[220:223]
v_mfma_f32_16x16x32_bf16 v[192:195],v[76:79],a[160:163],v[192:195]
s_add_u32 s62,s69,49152
v_mfma_f32_16x16x32_bf16 v[196:199],v[76:79],a[164:167],v[196:199]
buffer_store_dwordx4 v[36:39],v5,s[8:11],s62 offen
v_mfma_f32_16x16x32_bf16 v[200:203],v[76:79],a[168:171],v[200:203]
v_mfma_f32_16x16x32_bf16 v[204:207],v[76:79],a[172:175],v[204:207]
v_mfma_f32_16x16x32_bf16 v[208:211],v[76:79],a[176:179],v[208:211]
v_mfma_f32_16x16x32_bf16 v[212:215],v[76:79],a[180:183],v[212:215]
v_mfma_f32_16x16x32_bf16 v[216:219],v[76:79],a[184:187],v[216:219]
v_mfma_f32_16x16x32_bf16 v[220:223],v[76:79],a[188:191],v[220:223]
v_mfma_f32_16x16x32_bf16 v[192:195],v[80:83],a[192:195],v[192:195]
v_mfma_f32_16x16x32_bf16 v[196:199],v[80:83],a[196:199],v[196:199]
v_mfma_f32_16x16x32_bf16 v[200:203],v[80:83],a[200:203],v[200:203]
v_mfma_f32_16x16x32_bf16 v[204:207],v[80:83],a[204:207],v[204:207]
v_mfma_f32_16x16x32_bf16 v[208:211],v[80:83],a[208:211],v[208:211]
v_mfma_f32_16x16x32_bf16 v[212:215],v[80:83],a[212:215],v[212:215]
v_mfma_f32_16x16x32_bf16 v[216:219],v[80:83],a[216:219],v[216:219]
v_mfma_f32_16x16x32_bf16 v[220:223],v[80:83],a[220:223],v[220:223]
v_mfma_f32_16x16x32_bf16 v[192:195],v[84:87],a[224:227],v[192:195]
v_mfma_f32_16x16x32_bf16 v[196:199],v[84:87],a[228:231],v[196:199]
v_mfma_f32_16x16x32_bf16 v[200:203],v[84:87],a[232:235],v[200:203]
v_mfma_f32_16x16x32_bf16 v[204:207],v[84:87],a[236:239],v[204:207]
v_mfma_f32_16x16x32_bf16 v[208:211],v[84:87],a[240:243],v[208:211]
v_mfma_f32_16x16x32_bf16 v[212:215],v[84:87],a[244:247],v[212:215]
v_mfma_f32_16x16x32_bf16 v[216:219],v[84:87],a[248:251],v[216:219]
v_mfma_f32_16x16x32_bf16 v[220:223],v[84:87],a[252:255],v[220:223]
v_cvt_pk_bf16_f32 v40,v192,v196
v_cvt_pk_bf16_f32 v41,v200,v204
v_cvt_pk_bf16_f32 v42,v208,v212
s_nop 4
v_cvt_pk_bf16_f32 v43,v216,v220
s_add_u32 s62,s69,262144
buffer_store_dwordx4 v[40:43],v5,s[8:11],s62 offen
v_cvt_pk_bf16_f32 v44,v193,v197
v_cvt_pk_bf16_f32 v45,v201,v205
v_cvt_pk_bf16_f32 v46,v209,v213
v_cvt_pk_bf16_f32 v47,v217,v221
s_add_u32 s62,s69,278528
buffer_store_dwordx4 v[44:47],v5,s[8:11],s62 offen
v_cvt_pk_bf16_f32 v48,v194,v198
v_cvt_pk_bf16_f32 v49,v202,v206
v_cvt_pk_bf16_f32 v50,v210,v214
v_cvt_pk_bf16_f32 v51,v218,v222
s_add_u32 s62,s69,294912
buffer_store_dwordx4 v[48:51],v5,s[8:11],s62 offen
v_cvt_pk_bf16_f32 v52,v195,v199
v_cvt_pk_bf16_f32 v53,v203,v207
v_cvt_pk_bf16_f32 v54,v211,v215
v_cvt_pk_bf16_f32 v55,v219,v223
s_add_u32 s62,s69,311296
buffer_store_dwordx4 v[52:55],v5,s[8:11],s62 offen
s_cmp_lg_u32 s72,0
s_cbranch_scc1 L_aa_65
s_waitcnt vmcnt(8)
s_branch L_aa_75
L_aa_63:
ds_read_b128 v[24:27],v4 offset:0
ds_read_b128 v[28:31],v4 offset:1024
s_min_u32 s56,s32,s33
s_cmp_lt_u32 s77,64
s_cselect_b32 s56,s56,0
s_cmp_eq_u32 s56,0
s_cselect_b32 s72,0x80000000,0
v_mov_b32 v248,s72
s_or_b32 s64,s70,s72
s_or_b32 s65,s71,s72
s_and_b32 s57,s46,1
s_mul_i32 s58,s57,12288
s_add_u32 s64,s64,s58
s_lshl_b32 s57,s57,11
s_waitcnt lgkmcnt(1)
v_mfma_f32_16x16x32_bf16 v[160:163],v[24:27],a[0:3],0
ds_read_b128 v[32:35],v4 offset:2048
s_add_u32 s65,s65,s57
s_and_b32 s59,s50,2048
v_mfma_f32_16x16x32_bf16 v[164:167],v[24:27],a[4:7],0
ds_read_b128 v[36:39],v4 offset:3072
s_lshl_b32 s59,s59,4
s_xor_b32 s60,s67,65536
v_mfma_f32_16x16x32_bf16 v[168:171],v[24:27],a[8:11],0
ds_read_b128 v[40:43],v4 offset:8192
s_add_u32 s59,s59,s60
s_add_u32 s58,s58,s59
v_mfma_f32_16x16x32_bf16 v[172:175],v[24:27],a[12:15],0
ds_read_b128 v[44:47],v4 offset:9216
s_add_u32 s57,s57,s59
s_add_u32 m0,s58,0
v_mfma_f32_16x16x32_bf16 v[176:179],v[24:27],a[16:19],0
buffer_load_dwordx4 v0,s[8:11],s64 offen offset:0 sc1 lds
s_lshl_b32 s23,s51,5
s_add_u32 s23,s23,s68
v_mfma_f32_16x16x32_bf16 v[180:183],v[24:27],a[20:23],0
ds_read_b128 v[48:51],v4 offset:10240
s_lshl_b32 s24,s23,10
s_lshl_b32 s25,s51,10
v_mfma_f32_16x16x32_bf16 v[184:187],v[24:27],a[24:27],0
ds_read_b128 v[52:55],v4 offset:11264
s_add_u32 s25,s25,2883584
s_cmp_eq_u32 s23,s55
s_cselect_b32 s25,s25,s24
v_mfma_f32_16x16x32_bf16 v[188:191],v[24:27],a[28:31],0
ds_write_b32 v247,v248
s_add_u32 s25,s25,8388608
s_mov_b32 s6,268435456
s_waitcnt lgkmcnt(7)
v_mfma_f32_16x16x32_bf16 v[160:163],v[28:31],a[32:35],v[160:163]
buffer_load_dwordx4 v0,s[8:11],s64 offen offset:1024 sc1 lds
s_cmp_eq_u32 s31,0
s_cselect_b32 s25,s24,s25
s_cselect_b64 s[4:5],s[16:17],s[44:45]
s_cmov_b32 s6,2097152
v_mfma_f32_16x16x32_bf16 v[164:167],v[28:31],a[36:39],v[164:167]
ds_read_b128 v[56:59],v4 offset:4096
v_mfma_f32_16x16x32_bf16 v[168:171],v[28:31],a[40:43],v[168:171]
ds_read_b128 v[60:63],v4 offset:5120
v_mfma_f32_16x16x32_bf16 v[172:175],v[28:31],a[44:47],v[172:175]
ds_read_b128 v[64:67],v4 offset:6144
v_mfma_f32_16x16x32_bf16 v[176:179],v[28:31],a[48:51],v[176:179]
buffer_load_dwordx4 v0,s[8:11],s64 offen offset:2048 sc1 lds
v_mfma_f32_16x16x32_bf16 v[180:183],v[28:31],a[52:55],v[180:183]
ds_read_b128 v[68:71],v4 offset:7168
v_mfma_f32_16x16x32_bf16 v[184:187],v[28:31],a[56:59],v[184:187]
ds_read_b128 v[72:75],v4 offset:12288
v_mfma_f32_16x16x32_bf16 v[188:191],v[28:31],a[60:63],v[188:191]
ds_read_b128 v[76:79],v4 offset:13312
s_waitcnt lgkmcnt(12)
v_mfma_f32_16x16x32_bf16 v[160:163],v[32:35],a[64:67],v[160:163]
buffer_load_dwordx4 v0,s[8:11],s64 offen offset:3072 sc1 lds
v_mfma_f32_16x16x32_bf16 v[164:167],v[32:35],a[68:71],v[164:167]
ds_read_b128 v[80:83],v4 offset:14336
v_mfma_f32_16x16x32_bf16 v[168:171],v[32:35],a[72:75],v[168:171]
ds_read_b128 v[84:87],v4 offset:15360
v_mfma_f32_16x16x32_bf16 v[172:175],v[32:35],a[76:79],v[172:175]
buffer_load_dwordx4 v[224:227],v0,s[4:7],s25 offen sc1
s_lshr_b32 s24,s55,5
s_cmp_lt_u32 s51,s24
s_cselect_b32 s24,1,2
v_mfma_f32_16x16x32_bf16 v[176:179],v[32:35],a[80:83],v[176:179]
s_add_u32 m0,s58,4096
s_add_u32 s64,s64,4096
v_mov_b32 v252,s24
v_mfma_f32_16x16x32_bf16 v[180:183],v[32:35],a[84:87],v[180:183]
buffer_load_dwordx4 v0,s[8:11],s64 offen offset:0 sc1 lds
s_lshl2_add_u32 s25,s51,11018240
s_lshl_b32 s24,s68,16
v_mfma_f32_16x16x32_bf16 v[184:187],v[32:35],a[88:91],v[184:187]
s_add_u32 s24,s24,s31
s_add_u32 s24,s24,s86
s_cmp_eq_u32 s24,1537
s_cselect_b32 s25,s25,0x80000000
v_mfma_f32_16x16x32_bf16 v[188:191],v[32:35],a[92:95],v[188:191]
buffer_store_dword v252,off,s[8:11],s25 sc1
s_waitcnt lgkmcnt(0)
s_barrier
s_waitcnt lgkmcnt(13)
v_mfma_f32_16x16x32_bf16 v[160:163],v[36:39],a[96:99],v[160:163]
ds_read_b128 v[248:251],v245
s_bitcmp1_b64 s[38:39],s51
s_cselect_b32 s24,128,0
v_mfma_f32_16x16x32_bf16 v[164:167],v[36:39],a[100:103],v[164:167]
buffer_load_dwordx4 v0,s[8:11],s64 offen offset:1024 sc1 lds
s_lshl_b32 s23,s51,13
s_lshl2_add_u32 s23,s68,s23
v_mfma_f32_16x16x32_bf16 v[168:171],v[36:39],a[104:107],v[168:171]
s_add_u32 s23,s23,10487168
s_add_u32 s23,s23,s24
v_mfma_f32_16x16x32_bf16 v[172:175],v[36:39],a[108:111],v[172:175]
buffer_load_dword v246,off,s[8:11],s23 sc1
v_lshrrev_b32 v244,4,v1
s_sub_u32 s23,s77,8
v_mfma_f32_16x16x32_bf16 v[176:179],v[36:39],a[112:115],v[176:179]
v_add_u32 v244,s23,v244
v_max_i32 v244,0,v244
v_mfma_f32_16x16x32_bf16 v[180:183],v[36:39],a[116:119],v[180:183]
buffer_load_dwordx4 v0,s[8:11],s64 offen offset:2048 sc1 lds
v_lshl_add_u32 v244,v244,13,v21
v_mfma_f32_16x16x32_bf16 v[184:187],v[36:39],a[120:123],v[184:187]
buffer_load_dwordx2 v[242:243],v244,s[8:11],0 offen sc1
s_waitcnt lgkmcnt(0)
v_or3_b32 v248,v248,v249,v250
v_mfma_f32_16x16x32_bf16 v[188:191],v[36:39],a[124:127],v[188:191]
v_or_b32 v248,v248,v251
v_mfma_f32_16x16x32_bf16 v[160:163],v[40:43],a[128:131],v[160:163]
v_readfirstlane_b32 s72,v248
v_mfma_f32_16x16x32_bf16 v[164:167],v[40:43],a[132:135],v[164:167]
buffer_load_dwordx4 v0,s[8:11],s64 offen offset:3072 sc1 lds
v_mfma_f32_16x16x32_bf16 v[168:171],v[40:43],a[136:139],v[168:171]
v_mfma_f32_16x16x32_bf16 v[172:175],v[40:43],a[140:143],v[172:175]
v_mfma_f32_16x16x32_bf16 v[176:179],v[40:43],a[144:147],v[176:179]
s_waitcnt vmcnt(12)
v_mfma_f32_16x16x32_bf16 v[180:183],v[40:43],a[148:151],v[180:183]
buffer_store_dword v20,off,s[8:11],s73 sc1
s_add_u32 m0,s58,8192
s_add_u32 s64,s64,4096
v_mfma_f32_16x16x32_bf16 v[184:187],v[40:43],a[152:155],v[184:187]
buffer_load_dwordx4 v0,s[8:11],s64 offen offset:0 sc1 lds
s_mov_b32 s73,0x80000000
v_mfma_f32_16x16x32_bf16 v[188:191],v[40:43],a[156:159],v[188:191]
v_mfma_f32_16x16x32_bf16 v[160:163],v[44:47],a[160:163],v[160:163]
v_mfma_f32_16x16x32_bf16 v[164:167],v[44:47],a[164:167],v[164:167]
v_mfma_f32_16x16x32_bf16 v[168:171],v[44:47],a[168:171],v[168:171]
buffer_load_dwordx4 v0,s[8:11],s64 offen offset:1024 sc1 lds
v_mfma_f32_16x16x32_bf16 v[172:175],v[44:47],a[172:175],v[172:175]
v_mfma_f32_16x16x32_bf16 v[176:179],v[44:47],a[176:179],v[176:179]
v_mfma_f32_16x16x32_bf16 v[180:183],v[44:47],a[180:183],v[180:183]
v_mfma_f32_16x16x32_bf16 v[184:187],v[44:47],a[184:187],v[184:187]
buffer_load_dwordx4 v0,s[8:11],s64 offen offset:2048 sc1 lds
v_mfma_f32_16x16x32_bf16 v[188:191],v[44:47],a[188:191],v[188:191]
v_mfma_f32_16x16x32_bf16 v[160:163],v[48:51],a[192:195],v[160:163]
v_mfma_f32_16x16x32_bf16 v[164:167],v[48:51],a[196:199],v[164:167]
v_mfma_f32_16x16x32_bf16 v[168:171],v[48:51],a[200:203],v[168:171]
buffer_load_dwordx4 v0,s[8:11],s64 offen offset:3072 sc1 lds
v_mfma_f32_16x16x32_bf16 v[172:175],v[48:51],a[204:207],v[172:175]
v_mfma_f32_16x16x32_bf16 v[176:179],v[48:51],a[208:211],v[176:179]
v_mfma_f32_16x16x32_bf16 v[180:183],v[48:51],a[212:215],v[180:183]
v_mfma_f32_16x16x32_bf16 v[184:187],v[48:51],a[216:219],v[184:187]
s_add_u32 m0,s57,24576
v_mfma_f32_16x16x32_bf16 v[188:191],v[48:51],a[220:223],v[188:191]
buffer_load_dwordx4 v0,s[8:11],s65 offen offset:0 sc1 lds
v_mfma_f32_16x16x32_bf16 v[160:163],v[52:55],a[224:227],v[160:163]
v_mfma_f32_16x16x32_bf16 v[164:167],v[52:55],a[228:231],v[164:167]
v_mfma_f32_16x16x32_bf16 v[168:171],v[52:55],a[232:235],v[168:171]
v_mfma_f32_16x16x32_bf16 v[172:175],v[52:55],a[236:239],v[172:175]
buffer_load_dwordx4 v0,s[8:11],s65 offen offset:1024 sc1 lds
v_mfma_f32_16x16x32_bf16 v[176:179],v[52:55],a[240:243],v[176:179]
v_mfma_f32_16x16x32_bf16 v[180:183],v[52:55],a[244:247],v[180:183]
v_mfma_f32_16x16x32_bf16 v[184:187],v[52:55],a[248:251],v[184:187]
v_mfma_f32_16x16x32_bf16 v[188:191],v[52:55],a[252:255],v[188:191]
v_mfma_f32_16x16x32_bf16 v[192:195],v[56:59],a[0:3],0
v_mfma_f32_16x16x32_bf16 v[196:199],v[56:59],a[4:7],0
v_mfma_f32_16x16x32_bf16 v[200:203],v[56:59],a[8:11],0
v_cvt_pk_bf16_f32 v24,v160,v164
v_cvt_pk_bf16_f32 v25,v168,v172
v_mfma_f32_16x16x32_bf16 v[204:207],v[56:59],a[12:15],0
v_cvt_pk_bf16_f32 v26,v176,v180
v_cvt_pk_bf16_f32 v27,v184,v188
v_mfma_f32_16x16x32_bf16 v[208:211],v[56:59],a[16:19],0
v_cvt_pk_bf16_f32 v28,v161,v165
v_cvt_pk_bf16_f32 v29,v169,v173
v_mfma_f32_16x16x32_bf16 v[212:215],v[56:59],a[20:23],0
v_cvt_pk_bf16_f32 v30,v177,v181
v_cvt_pk_bf16_f32 v31,v185,v189
v_mfma_f32_16x16x32_bf16 v[216:219],v[56:59],a[24:27],0
v_cvt_pk_bf16_f32 v32,v162,v166
v_cvt_pk_bf16_f32 v33,v170,v174
v_mfma_f32_16x16x32_bf16 v[220:223],v[56:59],a[28:31],0
v_cvt_pk_bf16_f32 v34,v178,v182
v_cvt_pk_bf16_f32 v35,v186,v190
v_mfma_f32_16x16x32_bf16 v[192:195],v[60:63],a[32:35],v[192:195]
v_cvt_pk_bf16_f32 v36,v163,v167
v_cvt_pk_bf16_f32 v37,v171,v175
v_mfma_f32_16x16x32_bf16 v[196:199],v[60:63],a[36:39],v[196:199]
v_cvt_pk_bf16_f32 v38,v179,v183
v_cvt_pk_bf16_f32 v39,v187,v191
v_mfma_f32_16x16x32_bf16 v[200:203],v[60:63],a[40:43],v[200:203]
v_mfma_f32_16x16x32_bf16 v[204:207],v[60:63],a[44:47],v[204:207]
v_mfma_f32_16x16x32_bf16 v[208:211],v[60:63],a[48:51],v[208:211]
v_mfma_f32_16x16x32_bf16 v[212:215],v[60:63],a[52:55],v[212:215]
v_mfma_f32_16x16x32_bf16 v[216:219],v[60:63],a[56:59],v[216:219]
v_mfma_f32_16x16x32_bf16 v[220:223],v[60:63],a[60:63],v[220:223]
v_mfma_f32_16x16x32_bf16 v[192:195],v[64:67],a[64:67],v[192:195]
v_mfma_f32_16x16x32_bf16 v[196:199],v[64:67],a[68:71],v[196:199]
v_mfma_f32_16x16x32_bf16 v[200:203],v[64:67],a[72:75],v[200:203]
v_mfma_f32_16x16x32_bf16 v[204:207],v[64:67],a[76:79],v[204:207]
v_mfma_f32_16x16x32_bf16 v[208:211],v[64:67],a[80:83],v[208:211]
v_mfma_f32_16x16x32_bf16 v[212:215],v[64:67],a[84:87],v[212:215]
v_mfma_f32_16x16x32_bf16 v[216:219],v[64:67],a[88:91],v[216:219]
v_mfma_f32_16x16x32_bf16 v[220:223],v[64:67],a[92:95],v[220:223]
v_mfma_f32_16x16x32_bf16 v[192:195],v[68:71],a[96:99],v[192:195]
v_mfma_f32_16x16x32_bf16 v[196:199],v[68:71],a[100:103],v[196:199]
v_mfma_f32_16x16x32_bf16 v[200:203],v[68:71],a[104:107],v[200:203]
v_mfma_f32_16x16x32_bf16 v[204:207],v[68:71],a[108:111],v[204:207]
v_mfma_f32_16x16x32_bf16 v[208:211],v[68:71],a[112:115],v[208:211]
s_add_u32 s62,s69,0
v_mfma_f32_16x16x32_bf16 v[212:215],v[68:71],a[116:119],v[212:215]
buffer_store_dwordx4 v[24:27],v5,s[8:11],s62 offen
v_mfma_f32_16x16x32_bf16 v[216:219],v[68:71],a[120:123],v[216:219]
v_mfma_f32_16x16x32_bf16 v[220:223],v[68:71],a[124:127],v[220:223]
v_mfma_f32_16x16x32_bf16 v[192:195],v[72:75],a[128:131],v[192:195]
s_add_u32 s62,s69,16384
v_mfma_f32_16x16x32_bf16 v[196:199],v[72:75],a[132:135],v[196:199]
buffer_store_dwordx4 v[28:31],v5,s[8:11],s62 offen
v_mfma_f32_16x16x32_bf16 v[200:203],v[72:75],a[136:139],v[200:203]
v_mfma_f32_16x16x32_bf16 v[204:207],v[72:75],a[140:143],v[204:207]
v_mfma_f32_16x16x32_bf16 v[208:211],v[72:75],a[144:147],v[208:211]
s_add_u32 s62,s69,32768
v_mfma_f32_16x16x32_bf16 v[212:215],v[72:75],a[148:151],v[212:215]
buffer_store_dwordx4 v[32:35],v5,s[8:11],s62 offen
v_mfma_f32_16x16x32_bf16 v[216:219],v[72:75],a[152:155],v[216:219]
v_mfma_f32_16x16x32_bf16 v[220:223],v[72:75],a[156:159],v[220:223]
v_mfma_f32_16x16x32_bf16 v[192:195],v[76:79],a[160:163],v[192:195]
s_add_u32 s62,s69,49152
v_mfma_f32_16x16x32_bf16 v[196:199],v[76:79],a[164:167],v[196:199]
buffer_store_dwordx4 v[36:39],v5,s[8:11],s62 offen
v_mfma_f32_16x16x32_bf16 v[200:203],v[76:79],a[168:171],v[200:203]
v_mfma_f32_16x16x32_bf16 v[204:207],v[76:79],a[172:175],v[204:207]
v_mfma_f32_16x16x32_bf16 v[208:211],v[76:79],a[176:179],v[208:211]
v_mfma_f32_16x16x32_bf16 v[212:215],v[76:79],a[180:183],v[212:215]
v_mfma_f32_16x16x32_bf16 v[216:219],v[76:79],a[184:187],v[216:219]
v_mfma_f32_16x16x32_bf16 v[220:223],v[76:79],a[188:191],v[220:223]
v_mfma_f32_16x16x32_bf16 v[192:195],v[80:83],a[192:195],v[192:195]
v_mfma_f32_16x16x32_bf16 v[196:199],v[80:83],a[196:199],v[196:199]
v_mfma_f32_16x16x32_bf16 v[200:203],v[80:83],a[200:203],v[200:203]
v_mfma_f32_16x16x32_bf16 v[204:207],v[80:83],a[204:207],v[204:207]
v_mfma_f32_16x16x32_bf16 v[208:211],v[80:83],a[208:211],v[208:211]
v_mfma_f32_16x16x32_bf16 v[212:215],v[80:83],a[212:215],v[212:215]
v_mfma_f32_16x16x32_bf16 v[216:219],v[80:83],a[216:219],v[216:219]
v_mfma_f32_16x16x32_bf16 v[220:223],v[80:83],a[220:223],v[220:223]
v_mfma_f32_16x16x32_bf16 v[192:195],v[84:87],a[224:227],v[192:195]
v_mfma_f32_16x16x32_bf16 v[196:199],v[84:87],a[228:231],v[196:199]
v_mfma_f32_16x16x32_bf16 v[200:203],v[84:87],a[232:235],v[200:203]
v_mfma_f32_16x16x32_bf16 v[204:207],v[84:87],a[236:239],v[204:207]
v_mfma_f32_16x16x32_bf16 v[208:211],v[84:87],a[240:243],v[208:211]
v_mfma_f32_16x16x32_bf16 v[212:215],v[84:87],a[244:247],v[212:215]
v_mfma_f32_16x16x32_bf16 v[216:219],v[84:87],a[248:251],v[216:219]
v_mfma_f32_16x16x32_bf16 v[220:223],v[84:87],a[252:255],v[220:223]
v_cvt_pk_bf16_f32 v40,v192,v196
v_cvt_pk_bf16_f32 v41,v200,v204
v_cvt_pk_bf16_f32 v42,v208,v212
s_nop 4
v_cvt_pk_bf16_f32 v43,v216,v220
s_add_u32 s62,s69,262144
buffer_store_dwordx4 v[40:43],v5,s[8:11],s62 offen
v_cvt_pk_bf16_f32 v44,v193,v197
v_cvt_pk_bf16_f32 v45,v201,v205
v_cvt_pk_bf16_f32 v46,v209,v213
v_cvt_pk_bf16_f32 v47,v217,v221
s_add_u32 s62,s69,278528
buffer_store_dwordx4 v[44:47],v5,s[8:11],s62 offen
v_cvt_pk_bf16_f32 v48,v194,v198
v_cvt_pk_bf16_f32 v49,v202,v206
v_cvt_pk_bf16_f32 v50,v210,v214
v_cvt_pk_bf16_f32 v51,v218,v222
s_add_u32 s62,s69,294912
buffer_store_dwordx4 v[48:51],v5,s[8:11],s62 offen
v_cvt_pk_bf16_f32 v52,v195,v199
v_cvt_pk_bf16_f32 v53,v203,v207
v_cvt_pk_bf16_f32 v54,v211,v215
v_cvt_pk_bf16_f32 v55,v219,v223
s_add_u32 s62,s69,311296
buffer_store_dwordx4 v[52:55],v5,s[8:11],s62 offen
s_cmp_lg_u32 s72,0
s_cbranch_scc1 L_aa_65
s_waitcnt vmcnt(8)
L_aa_75:
s_barrier
s_xor_b32 s67,s67,65536
s_and_b32 s56,s50,2048
s_lshl_b32 s56,s56,4
s_add_u32 s56,s56,s67
v_add_u32 v2,s56,v0
v_add_u32 v239,s56,v253
s_and_b32 s56,s50,1024
s_lshl_b32 s56,s56,2
v_add_u32 v238,s56,v2
s_mov_b32 s76,s71
s_mov_b32 s53,s77
ds_read_b128 v[24:27],v238 offset:16384
ds_read_b128 v[40:43],v2 offset:0
ds_read_b128 v[56:59],v2 offset:4096
ds_read_b128 v[28:31],v238 offset:17408
ds_read_b128 v[44:47],v2 offset:1024
ds_read_b128 v[60:63],v2 offset:5120
ds_read_b128 v[32:35],v238 offset:18432
ds_read_b128 v[48:51],v2 offset:2048
ds_read_b128 v[64:67],v2 offset:6144
ds_read_b128 v[36:39],v238 offset:19456
ds_read_b128 v[52:55],v2 offset:3072
ds_read_b128 v[68:71],v2 offset:7168
s_waitcnt lgkmcnt(9)
v_mfma_f32_16x16x32_bf16 v[128:131],v[40:43],v[24:27],v[8:11]
ds_read_b128 v[72:75],v2 offset:24576
v_mfma_f32_16x16x32_bf16 v[132:135],v[56:59],v[24:27],v[12:15]
ds_read_b128 v[76:79],v2 offset:25600
s_waitcnt lgkmcnt(8)
v_mfma_f32_16x16x32_bf16 v[128:131],v[44:47],v[28:31],v[128:131]
ds_read_b128 v[80:83],v2 offset:26624
v_mfma_f32_16x16x32_bf16 v[132:135],v[60:63],v[28:31],v[132:135]
ds_read_b128 v[84:87],v2 offset:27648
s_waitcnt lgkmcnt(7)
v_mfma_f32_16x16x32_bf16 v[128:131],v[48:51],v[32:35],v[128:131]
ds_read_b64 v[120:121],v239 offset:24576
v_mfma_f32_16x16x32_bf16 v[132:135],v[64:67],v[32:35],v[132:135]
ds_read_b64 v[122:123],v239 offset:25600
s_waitcnt lgkmcnt(6)
v_mfma_f32_16x16x32_bf16 v[128:131],v[52:55],v[36:39],v[128:131]
ds_read_b64 v[124:125],v239 offset:26624
v_mfma_f32_16x16x32_bf16 v[132:135],v[68:71],v[36:39],v[132:135]
ds_read_b64 v[126:127],v239 offset:27648
s_waitcnt lgkmcnt(4)
v_mfma_f32_16x16x32_bf16 v[136:139],v[72:75],v[24:27],0
ds_read_b128 v[88:91],v2 offset:8192
ds_read_b128 v[92:95],v2 offset:9216
v_mfma_f32_16x16x32_bf16 v[136:139],v[76:79],v[28:31],v[136:139]
ds_read_b128 v[96:99],v2 offset:10240
ds_read_b128 v[100:103],v2 offset:11264
v_mfma_f32_16x16x32_bf16 v[136:139],v[80:83],v[32:35],v[136:139]
ds_read_b128 v[104:107],v2 offset:12288
ds_read_b128 v[108:111],v2 offset:13312
v_mfma_f32_16x16x32_bf16 v[136:139],v[84:87],v[36:39],v[136:139]
ds_read_b128 v[112:115],v2 offset:14336
ds_read_b128 v[116:119],v2 offset:15360
s_cmp_eq_u32 s30,0
s_cbranch_scc1 L_aa_64
s_add_u32 s66,s66,4
s_bfe_u32 s56,s66,0x10002
s_bitset0_b32 s37,s56
s_or_b32 s56,s37,s66
v_mov_b32 v22,s56
s_xor_b32 s69,s69,524288
s_waitcnt vmcnt(0) lgkmcnt(0)
s_barrier
buffer_store_dword v22,off,s[8:11],s74
buffer_store_dword v20,off,s[8:11],s73 sc1
s_mov_b32 s73,0x80000000
s_cmp_lg_u32 s86,1536
s_cbranch_scc1 L_ae_82
s_mov_b32 s77,s35
s_mov_b32 s30,0
s_lshl_b32 s56,s77,5
s_add_u32 s56,s56,s68
s_mul_i32 s70,s56,24576
s_lshl_b32 s71,s56,12
s_lshl_b32 s59,s77,13
s_lshl2_add_u32 s59,s68,s59
s_add_u32 s59,s59,10485760
s_buffer_load_dword s32,s[8:11],s59
s_mov_b32 s33,1
s_add_u32 s70,s70,100663296
s_add_u32 s71,s71,41943040
v_mov_b32 v19,s59
s_branch L_af_83
L_ae_82:
s_ff1_i32_b64 s77,s[84:85]
s_bitset0_b64 s[84:85],s77
s_min_u32 s77,s77,64
s_lshr_b32 s61,s55,5
s_lshl_b32 s56,s77,5
s_add_u32 s56,s56,s68
s_mul_i32 s70,s56,24576
s_lshl_b32 s71,s56,12
s_lshl_b32 s59,s77,13
s_lshl2_add_u32 s59,s68,s59
s_add_u32 s59,s59,10486144
s_cmp_lt_u32 s77,s61
s_cselect_b32 s57,0,16777216
s_cselect_b32 s60,0,128
s_add_u32 s60,s60,s59
s_add_u32 s60,s60,128
s_buffer_load_dword s33,s[8:11],s60
s_add_u32 s71,s71,s57
s_add_u32 s71,s71,58720256
s_cmp_eq_u32 s77,s61
s_cselect_b32 s57,50331648,0
s_cselect_b32 s58,1536,0
s_add_u32 s59,s59,s58
s_buffer_load_dword s32,s[8:11],s59
s_add_u32 s70,s70,s57
s_add_u32 s70,s70,150994944
v_mov_b32 v19,s59
v_writelane_b32 v19,s60,1
L_af_83:
v_max3_f32 v238,v128,v129,v130
v_max3_f32 v239,v131,v132,v133
v_max3_f32 v238,v134,v135,v238
v_max3_f32 v239,v138,v139,v239
v_max_f32 v238,v238,v239
v_max_f32 v239,v238,v239
s_nop 1
v_permlane16_swap_b32 v238,v239
v_max_f32 v238,v238,v239
v_max_f32 v239,v238,v239
s_nop 1
v_permlane32_swap_b32 v238,v239
v_max_f32 v238,v238,v239
v_mul_f32 v238,s80,v238
v_fma_f32 v128,v128,s80,-v238
v_fma_f32 v129,v129,s80,-v238
v_exp_f32 v128,v128
v_fma_f32 v130,v130,s80,-v238
v_exp_f32 v129,v129
v_fma_f32 v131,v131,s80,-v238
v_exp_f32 v130,v130
v_fma_f32 v132,v132,s80,-v238
v_exp_f32 v131,v131
v_fma_f32 v133,v133,s80,-v238
v_exp_f32 v132,v132
v_fma_f32 v134,v134,s80,-v238
v_exp_f32 v133,v133
v_fma_f32 v135,v135,s80,-v238
v_exp_f32 v134,v134
v_fma_f32 v138,v138,s80,-v238
v_exp_f32 v135,v135
v_fma_f32 v139,v139,s80,-v238
v_exp_f32 v138,v138
v_exp_f32 v139,v139
v_cvt_pk_bf16_f32 v140,v128,v129
v_cvt_pk_bf16_f32 v141,v130,v131
v_cvt_pk_bf16_f32 v142,v132,v133
v_cvt_pk_bf16_f32 v143,v134,v135
v_cvt_pk_bf16_f32 v144,v138,v139
v_mov_b32 v147,v144
buffer_load_dword v17,v16,s[8:11],s87 offen sc1
v_mfma_f32_16x16x32_bf16 v[148:151],v[152:155],v[140:143],0
v_mfma_f32_16x16x32_bf16 v[24:27],v[88:91],v[140:143],0
v_mfma_f32_16x16x32_bf16 v[28:31],v[92:95],v[140:143],0
v_mfma_f32_16x16x16_bf16 v[148:151],v[152:153],v[144:145],v[148:151]
v_mfma_f32_16x16x32_bf16 v[32:35],v[96:99],v[140:143],0
v_mfma_f32_16x16x32_bf16 v[36:39],v[100:103],v[140:143],0
v_mfma_f32_16x16x32_bf16 v[40:43],v[104:107],v[140:143],0
v_mfma_f32_16x16x32_bf16 v[44:47],v[108:111],v[140:143],0
v_mfma_f32_16x16x32_bf16 v[48:51],v[112:115],v[140:143],0
v_mfma_f32_16x16x32_bf16 v[52:55],v[116:119],v[140:143],0
v_rcp_f32 v148,v148
v_mfma_f32_16x16x16_bf16 v[24:27],v[120:121],v[144:145],v[24:27]
v_mfma_f32_16x16x16_bf16 v[28:31],v[120:121],v[146:147],v[28:31]
v_mfma_f32_16x16x16_bf16 v[32:35],v[122:123],v[144:145],v[32:35]
v_mfma_f32_16x16x16_bf16 v[36:39],v[122:123],v[146:147],v[36:39]
v_mfma_f32_16x16x16_bf16 v[40:43],v[124:125],v[144:145],v[40:43]
v_pk_mul_f32 v[24:25],v[24:25],v[148:149] op_sel_hi:[1,0]
v_pk_mul_f32 v[26:27],v[26:27],v[148:149] op_sel_hi:[1,0]
v_mfma_f32_16x16x16_bf16 v[44:47],v[124:125],v[146:147],v[44:47]
v_pk_mul_f32 v[28:29],v[28:29],v[148:149] op_sel_hi:[1,0]
v_pk_mul_f32 v[30:31],v[30:31],v[148:149] op_sel_hi:[1,0]
v_mfma_f32_16x16x16_bf16 v[48:51],v[126:127],v[144:145],v[48:51]
v_cvt_pk_bf16_f32 v72,v24,v28
v_cvt_pk_bf16_f32 v73,v25,v29
v_mfma_f32_16x16x16_bf16 v[52:55],v[126:127],v[146:147],v[52:55]
v_cvt_pk_bf16_f32 v74,v26,v30
v_cvt_pk_bf16_f32 v75,v27,v31
ds_write_b128 v3,v[72:75] offset:0
v_pk_mul_f32 v[32:33],v[32:33],v[148:149] op_sel_hi:[1,0]
v_pk_mul_f32 v[34:35],v[34:35],v[148:149] op_sel_hi:[1,0]
v_pk_mul_f32 v[36:37],v[36:37],v[148:149] op_sel_hi:[1,0]
v_pk_mul_f32 v[38:39],v[38:39],v[148:149] op_sel_hi:[1,0]
v_cvt_pk_bf16_f32 v76,v32,v36
v_cvt_pk_bf16_f32 v77,v33,v37
v_cvt_pk_bf16_f32 v78,v34,v38
v_cvt_pk_bf16_f32 v79,v35,v39
ds_write_b128 v3,v[76:79] offset:1024
s_waitcnt vmcnt(0)
v_cmp_gt_u32 vcc,s66,v17
v_pk_mul_f32 v[40:41],v[40:41],v[148:149] op_sel_hi:[1,0]
v_pk_mul_f32 v[42:43],v[42:43],v[148:149] op_sel_hi:[1,0]
v_pk_mul_f32 v[44:45],v[44:45],v[148:149] op_sel_hi:[1,0]
v_pk_mul_f32 v[46:47],v[46:47],v[148:149] op_sel_hi:[1,0]
s_cbranch_vccnz L_ap_85
L_apb_86:
s_bfe_u32 s56,s66,0x10002
v_lshrrev_b32 v238,s56,v17
v_and_b32 v238,1,v238
v_cmp_ne_u32 vcc,0,v238
v_cvt_pk_bf16_f32 v80,v40,v44
v_cvt_pk_bf16_f32 v81,v41,v45
v_cvt_pk_bf16_f32 v82,v42,v46
s_cbranch_vccnz L_ak_81
s_add_u32 s36,s36,4
s_xor_b32 s34,s69,524288
buffer_load_dwordx4 v[192:195],v7,s[8:11],s34 offen sc1
v_cvt_pk_bf16_f32 v83,v43,v47
ds_write_b128 v3,v[80:83] offset:2048
s_add_u32 s34,s34,4096
buffer_load_dwordx4 v[196:199],v7,s[8:11],s34 offen sc1
v_pk_mul_f32 v[48:49],v[48:49],v[148:149] op_sel_hi:[1,0]
v_pk_mul_f32 v[50:51],v[50:51],v[148:149] op_sel_hi:[1,0]
s_add_u32 s34,s34,4096
buffer_load_dwordx4 v[200:203],v7,s[8:11],s34 offen sc1
v_pk_mul_f32 v[52:53],v[52:53],v[148:149] op_sel_hi:[1,0]
v_pk_mul_f32 v[54:55],v[54:55],v[148:149] op_sel_hi:[1,0]
s_add_u32 s34,s34,4096
buffer_load_dwordx4 v[204:207],v7,s[8:11],s34 offen sc1
v_cvt_pk_bf16_f32 v84,v48,v52
v_cvt_pk_bf16_f32 v85,v49,v53
s_add_u32 s34,s34,4096
buffer_load_dwordx4 v[208:211],v7,s[8:11],s34 offen sc1
v_cvt_pk_bf16_f32 v86,v50,v54
v_cvt_pk_bf16_f32 v87,v51,v55
s_add_u32 s34,s34,4096
buffer_load_dwordx4 v[212:215],v7,s[8:11],s34 offen sc1
ds_write_b128 v3,v[84:87] offset:3072
s_add_u32 s34,s34,4096
buffer_load_dwordx4 v[216:219],v7,s[8:11],s34 offen sc1
s_add_u32 s34,s34,4096
buffer_load_dwordx4 v[220:223],v7,s[8:11],s34 offen sc1
s_cmp_eq_u32 s31,0
s_cbranch_scc1 L_ah_84
s_waitcnt lgkmcnt(0)
s_barrier
s_mov_b32 s26,s51
s_mov_b32 s51,s53
s_branch L_aa_76
L_ah_84:
s_waitcnt vmcnt(7)
v_mfma_f32_16x16x32_bf16 v[160:163],v[156:159],v[192:195],0
s_waitcnt vmcnt(6)
v_mfma_f32_16x16x32_bf16 v[160:163],v[156:159],v[196:199],v[160:163]
s_waitcnt vmcnt(5)
v_mfma_f32_16x16x32_bf16 v[160:163],v[156:159],v[200:203],v[160:163]
s_waitcnt vmcnt(4)
v_mfma_f32_16x16x32_bf16 v[160:163],v[156:159],v[204:207],v[160:163]
s_waitcnt vmcnt(3)
v_mfma_f32_16x16x32_bf16 v[164:167],v[156:159],v[208:211],0
s_waitcnt vmcnt(2)
v_mfma_f32_16x16x32_bf16 v[164:167],v[156:159],v[212:215],v[164:167]
s_waitcnt vmcnt(1)
v_mfma_f32_16x16x32_bf16 v[164:167],v[156:159],v[216:219],v[164:167]
ds_write_b128 v6,v[160:163]
s_waitcnt vmcnt(0)
v_mfma_f32_16x16x32_bf16 v[164:167],v[156:159],v[220:223],v[164:167]
s_nop 7
ds_write_b128 v6,v[164:167] offset:2048
s_waitcnt lgkmcnt(0)
s_barrier
s_mov_b32 s27,1
s_branch L_aa_67
L_aa_64:
s_add_u32 s66,s66,4
s_bfe_u32 s56,s66,0x10002
s_bitset0_b32 s37,s56
s_or_b32 s56,s37,s66
v_mov_b32 v22,s56
s_xor_b32 s69,s69,524288
s_waitcnt vmcnt(0) lgkmcnt(0)
s_barrier
buffer_store_dword v22,off,s[8:11],s74
buffer_store_dword v20,off,s[8:11],s73 sc1
s_mov_b32 s73,0x80000000
s_cmp_eq_u32 s31,0
s_cbranch_scc1 L_aa_66
s_mov_b32 s26,s51
s_mov_b32 s27,3
s_branch L_aa_71
L_aa_66:
L_aq_87:
buffer_load_dword v17,v16,s[8:11],s87 offen sc1
s_sub_u32 s49,s49,1
s_cbranch_scc1 L_abort
s_waitcnt vmcnt(0)
v_cmp_gt_u32 vcc,s66,v17
s_cbranch_vccnz L_aq_87
s_xor_b32 s34,s69,524288
buffer_load_dwordx4 v[160:163],v7,s[8:11],s34 offen sc1
s_add_u32 s34,s34,4096
buffer_load_dwordx4 v[164:167],v7,s[8:11],s34 offen sc1
s_add_u32 s34,s34,4096
buffer_load_dwordx4 v[168:171],v7,s[8:11],s34 offen sc1
s_add_u32 s34,s34,4096
buffer_load_dwordx4 v[172:175],v7,s[8:11],s34 offen sc1
s_add_u32 s34,s34,4096
buffer_load_dwordx4 v[176:179],v7,s[8:11],s34 offen sc1
s_add_u32 s34,s34,4096
buffer_load_dwordx4 v[180:183],v7,s[8:11],s34 offen sc1
s_add_u32 s34,s34,4096
buffer_load_dwordx4 v[184:187],v7,s[8:11],s34 offen sc1
s_add_u32 s34,s34,4096
buffer_load_dwordx4 v[188:191],v7,s[8:11],s34 offen sc1
buffer_load_dwordx4 v[72:75],v0,s[8:11],s76 offen offset:0 sc1
buffer_load_dwordx4 v[76:79],v0,s[8:11],s76 offen offset:1024 sc1
buffer_load_dwordx4 v[80:83],v0,s[8:11],s76 offen offset:2048 sc1
buffer_load_dwordx4 v[84:87],v0,s[8:11],s76 offen offset:3072 sc1
buffer_load_dwordx2 v[120:121],v253,s[8:11],s76 offen offset:0 sc1
buffer_load_dwordx2 v[122:123],v253,s[8:11],s76 offen offset:1024 sc1
buffer_load_dwordx2 v[124:125],v253,s[8:11],s76 offen offset:2048 sc1
buffer_load_dwordx2 v[126:127],v253,s[8:11],s76 offen offset:3072 sc1
s_waitcnt vmcnt(15)
v_mfma_f32_16x16x32_bf16 v[192:195],v[156:159],v[160:163],0
s_waitcnt vmcnt(14)
v_mfma_f32_16x16x32_bf16 v[192:195],v[156:159],v[164:167],v[192:195]
s_waitcnt vmcnt(13)
v_mfma_f32_16x16x32_bf16 v[192:195],v[156:159],v[168:171],v[192:195]
s_waitcnt vmcnt(12)
v_mfma_f32_16x16x32_bf16 v[192:195],v[156:159],v[172:175],v[192:195]
s_waitcnt vmcnt(11)
v_mfma_f32_16x16x32_bf16 v[196:199],v[156:159],v[176:179],0
s_waitcnt vmcnt(10)
v_mfma_f32_16x16x32_bf16 v[196:199],v[156:159],v[180:183],v[196:199]
s_waitcnt vmcnt(9)
v_mfma_f32_16x16x32_bf16 v[196:199],v[156:159],v[184:187],v[196:199]
ds_write_b128 v6,v[192:195]
s_waitcnt vmcnt(8)
v_mfma_f32_16x16x32_bf16 v[196:199],v[156:159],v[188:191],v[196:199]
s_nop 7
ds_write_b128 v6,v[196:199] offset:2048
s_waitcnt lgkmcnt(0)
s_barrier
s_mov_b32 s27,0
s_branch L_aa_67
L_aa_65:
s_add_u32 s56,s30,s86
s_cmp_lg_u32 s56,1537
s_cbranch_scc1 L_al_80
s_add_u32 s66,s66,4
s_bfe_u32 s56,s66,0x10002
s_bitset1_b32 s37,s56
s_or_b32 s56,s37,s66
v_mov_b32 v22,s56
s_xor_b32 s69,s69,524288
s_waitcnt vmcnt(0) lgkmcnt(0)
s_barrier
buffer_store_dword v22,off,s[8:11],s74
buffer_store_dword v20,off,s[8:11],s73 sc1
s_mov_b32 s73,0x80000000
s_cmp_lg_u32 s86,1536
s_cbranch_scc1 L_ae_88
s_mov_b32 s77,s35
s_mov_b32 s30,0
s_lshl_b32 s56,s77,5
s_add_u32 s56,s56,s68
s_mul_i32 s70,s56,24576
s_lshl_b32 s71,s56,12
s_lshl_b32 s59,s77,13
s_lshl2_add_u32 s59,s68,s59
s_add_u32 s59,s59,10485760
s_buffer_load_dword s32,s[8:11],s59
s_mov_b32 s33,1
s_add_u32 s70,s70,100663296
s_add_u32 s71,s71,41943040
v_mov_b32 v19,s59
s_branch L_af_89
L_ae_88:
s_ff1_i32_b64 s77,s[84:85]
s_bitset0_b64 s[84:85],s77
s_min_u32 s77,s77,64
s_lshr_b32 s61,s55,5
s_lshl_b32 s56,s77,5
s_add_u32 s56,s56,s68
s_mul_i32 s70,s56,24576
s_lshl_b32 s71,s56,12
s_lshl_b32 s59,s77,13
s_lshl2_add_u32 s59,s68,s59
s_add_u32 s59,s59,10486144
s_cmp_lt_u32 s77,s61
s_cselect_b32 s57,0,16777216
s_cselect_b32 s60,0,128
s_add_u32 s60,s60,s59
s_add_u32 s60,s60,128
s_buffer_load_dword s33,s[8:11],s60
s_add_u32 s71,s71,s57
s_add_u32 s71,s71,58720256
s_cmp_eq_u32 s77,s61
s_cselect_b32 s57,50331648,0
s_cselect_b32 s58,1536,0
s_add_u32 s59,s59,s58
s_buffer_load_dword s32,s[8:11],s59
s_add_u32 s70,s70,s57
s_add_u32 s70,s70,150994944
v_mov_b32 v19,s59
v_writelane_b32 v19,s60,1
L_af_89:
s_branch L_ak_81
L_al_80:
s_add_u32 s66,s66,4
s_bfe_u32 s56,s66,0x10002
s_bitset0_b32 s37,s56
s_or_b32 s56,s37,s66
v_mov_b32 v22,s56
s_xor_b32 s69,s69,524288
s_waitcnt vmcnt(0) lgkmcnt(0)
s_barrier
buffer_store_dword v22,off,s[8:11],s74
buffer_store_dword v20,off,s[8:11],s73 sc1
s_mov_b32 s73,0x80000000
L_ak_81:
L_aq_90:
buffer_load_dword v17,v16,s[8:11],s87 offen sc1
s_sub_u32 s49,s49,1
s_cbranch_scc1 L_abort
s_waitcnt vmcnt(0)
v_cmp_gt_u32 vcc,s66,v17
s_cbranch_vccnz L_aq_90
s_xor_b32 s34,s69,524288
buffer_load_dwordx4 v[160:163],v7,s[8:11],s34 offen sc1
s_add_u32 s34,s34,4096
buffer_load_dwordx4 v[164:167],v7,s[8:11],s34 offen sc1
s_add_u32 s34,s34,4096
buffer_load_dwordx4 v[168:171],v7,s[8:11],s34 offen sc1
s_add_u32 s34,s34,4096
buffer_load_dwordx4 v[172:175],v7,s[8:11],s34 offen sc1
s_add_u32 s34,s34,4096
buffer_load_dwordx4 v[176:179],v7,s[8:11],s34 offen sc1
s_add_u32 s34,s34,4096
buffer_load_dwordx4 v[180:183],v7,s[8:11],s34 offen sc1
s_add_u32 s34,s34,4096
buffer_load_dwordx4 v[184:187],v7,s[8:11],s34 offen sc1
s_add_u32 s34,s34,4096
buffer_load_dwordx4 v[188:191],v7,s[8:11],s34 offen sc1
s_waitcnt vmcnt(7)
v_mfma_f32_16x16x32_bf16 v[192:195],v[156:159],v[160:163],0
s_waitcnt vmcnt(6)
v_mfma_f32_16x16x32_bf16 v[192:195],v[156:159],v[164:167],v[192:195]
s_waitcnt vmcnt(5)
v_mfma_f32_16x16x32_bf16 v[192:195],v[156:159],v[168:171],v[192:195]
s_waitcnt vmcnt(4)
v_mfma_f32_16x16x32_bf16 v[192:195],v[156:159],v[172:175],v[192:195]
s_waitcnt vmcnt(3)
v_mfma_f32_16x16x32_bf16 v[196:199],v[156:159],v[176:179],0
s_waitcnt vmcnt(2)
v_mfma_f32_16x16x32_bf16 v[196:199],v[156:159],v[180:183],v[196:199]
s_waitcnt vmcnt(1)
v_mfma_f32_16x16x32_bf16 v[196:199],v[156:159],v[184:187],v[196:199]
ds_write_b128 v6,v[192:195]
s_waitcnt vmcnt(0)
v_mfma_f32_16x16x32_bf16 v[196:199],v[156:159],v[188:191],v[196:199]
s_nop 7
ds_write_b128 v6,v[196:199] offset:2048
s_waitcnt lgkmcnt(0)
s_barrier
s_mov_b32 s27,2
L_aa_67:
s_cmp_lg_u32 s31,0
s_cbranch_scc1 L_ar_93
s_bitcmp1_b32 s46,0
s_cbranch_scc1 L_ar_92
L_ar_91:
ds_read_b128 v[160:163],v23
ds_read_b128 v[164:167],v23 offset:16
v_lshlrev_b32 v200,16,v224
v_and_b32 v201,0xffff0000,v224
v_lshlrev_b32 v202,16,v225
v_and_b32 v203,0xffff0000,v225
v_lshlrev_b32 v204,16,v226
v_and_b32 v205,0xffff0000,v226
v_lshlrev_b32 v206,16,v227
v_and_b32 v207,0xffff0000,v227
s_lshl_b32 s18,s51,5
s_add_u32 s18,s18,s68
s_lshl_b32 s19,s18,10
s_add_u32 s20,s19,8388608
s_waitcnt lgkmcnt(0)
v_cvt_pk_bf16_f32 v168,v160,v161
v_cvt_pk_bf16_f32 v169,v162,v163
v_cvt_pk_bf16_f32 v170,v164,v165
v_cvt_pk_bf16_f32 v171,v166,v167
v_lshlrev_b32 v160,16,v168
v_and_b32 v161,0xffff0000,v168
v_lshlrev_b32 v162,16,v169
v_and_b32 v163,0xffff0000,v169
v_lshlrev_b32 v164,16,v170
v_and_b32 v165,0xffff0000,v170
v_lshlrev_b32 v166,16,v171
v_and_b32 v167,0xffff0000,v171
v_pk_add_f32 v[200:201],v[200:201],v[160:161]
v_pk_add_f32 v[202:203],v[202:203],v[162:163]
v_pk_add_f32 v[204:205],v[204:205],v[164:165]
v_pk_add_f32 v[206:207],v[206:207],v[166:167]
v_cvt_pk_bf16_f32 v168,v200,v201
v_cvt_pk_bf16_f32 v169,v202,v203
v_cvt_pk_bf16_f32 v170,v204,v205
v_cvt_pk_bf16_f32 v171,v206,v207
v_lshlrev_b32 v200,16,v168
v_and_b32 v201,0xffff0000,v168
v_lshlrev_b32 v202,16,v169
v_and_b32 v203,0xffff0000,v169
v_lshlrev_b32 v204,16,v170
v_and_b32 v205,0xffff0000,v170
v_lshlrev_b32 v206,16,v171
v_and_b32 v207,0xffff0000,v171
v_readfirstlane_b32 s78,v200
s_nop 1
v_pk_add_f32 v[184:185],v[200:201],s[78:79] op_sel_hi:[1,0] neg_lo:[0,1] neg_hi:[0,1]
v_pk_add_f32 v[186:187],v[202:203],s[78:79] op_sel_hi:[1,0] neg_lo:[0,1] neg_hi:[0,1]
v_pk_add_f32 v[188:189],v[204:205],s[78:79] op_sel_hi:[1,0] neg_lo:[0,1] neg_hi:[0,1]
v_pk_add_f32 v[190:191],v[206:207],s[78:79] op_sel_hi:[1,0] neg_lo:[0,1] neg_hi:[0,1]
v_pk_add_f32 v[192:193],v[184:185],v[186:187]
v_pk_mul_f32 v[194:195],v[184:185],v[184:185]
v_pk_add_f32 v[196:197],v[188:189],v[190:191]
v_pk_fma_f32 v[194:195],v[186:187],v[186:187],v[194:195]
v_pk_add_f32 v[192:193],v[192:193],v[196:197]
v_pk_fma_f32 v[194:195],v[188:189],v[188:189],v[194:195]
v_add_f32 v192,v192,v193
v_pk_fma_f32 v[194:195],v[190:191],v[190:191],v[194:195]
v_add_f32 v194,v194,v195
s_nop 1
v_permlane32_swap_b32 v192,v194
v_add_f32 v192,v192,v194
s_nop 1
v_add_f32_dpp v192,v192,v192 row_ror:8 row_mask:0xf bank_mask:0xf
s_nop 1
v_add_f32_dpp v192,v192,v192 row_ror:4 row_mask:0xf bank_mask:0xf
s_nop 1
v_add_f32_dpp v192,v192,v192 row_ror:2 row_mask:0xf bank_mask:0xf
s_nop 1
v_add_f32_dpp v192,v192,v192 row_ror:1 row_mask:0xf bank_mask:0xf
v_mov_b32 v194,v192
s_nop 1
v_permlane16_swap_b32 v192,v194
v_add_f32 v192,v192,v194
v_mul_f32 v192,0x3b000000,v192
v_mov_b32 v194,v192
s_nop 1
v_permlane32_swap_b32 v192,v194
v_fma_f32 v194,-v192,v192,v194
v_add_f32 v192,s78,v192
v_max_f32 v194,0,v194
v_cvt_pk_bf16_f32 v194,v192,v194
v_lshlrev_b32 v192,16,v194
v_and_b32 v194,0xffff0000,v194
v_add_f32 v194,0x3727c5ac,v194
v_cvt_pk_bf16_f32 v194,v194,v194
v_and_b32 v194,0xffff0000,v194
v_sqrt_f32 v194,v194
v_pk_add_f32 v[184:185],v[200:201],v[192:193] op_sel_hi:[1,0] neg_lo:[0,1] neg_hi:[0,1]
v_pk_add_f32 v[186:187],v[202:203],v[192:193] op_sel_hi:[1,0] neg_lo:[0,1] neg_hi:[0,1]
v_pk_add_f32 v[188:189],v[204:205],v[192:193] op_sel_hi:[1,0] neg_lo:[0,1] neg_hi:[0,1]
v_pk_add_f32 v[190:191],v[206:207],v[192:193] op_sel_hi:[1,0] neg_lo:[0,1] neg_hi:[0,1]
v_cvt_pk_bf16_f32 v194,v194,v194
v_and_b32 v194,0xffff0000,v194
v_rcp_f32 v194,v194
v_cvt_pk_bf16_f32 v172,v184,v185
v_cvt_pk_bf16_f32 v173,v186,v187
v_cvt_pk_bf16_f32 v174,v188,v189
v_cvt_pk_bf16_f32 v175,v190,v191
v_lshlrev_b32 v184,16,v172
v_and_b32 v185,0xffff0000,v172
v_lshlrev_b32 v186,16,v173
v_and_b32 v187,0xffff0000,v173
v_lshlrev_b32 v188,16,v174
v_and_b32 v189,0xffff0000,v174
v_lshlrev_b32 v190,16,v175
v_and_b32 v191,0xffff0000,v175
v_pk_mul_f32 v[184:185],v[184:185],v[194:195] op_sel_hi:[1,0]
v_pk_mul_f32 v[186:187],v[186:187],v[194:195] op_sel_hi:[1,0]
v_pk_mul_f32 v[188:189],v[188:189],v[194:195] op_sel_hi:[1,0]
v_pk_mul_f32 v[190:191],v[190:191],v[194:195] op_sel_hi:[1,0]
v_cvt_pk_bf16_f32 v172,v184,v185
v_cvt_pk_bf16_f32 v173,v186,v187
v_cvt_pk_bf16_f32 v174,v188,v189
v_cvt_pk_bf16_f32 v175,v190,v191
v_lshlrev_b32 v176,16,v172
v_and_b32 v177,0xffff0000,v172
v_lshlrev_b32 v178,16,v173
v_and_b32 v179,0xffff0000,v173
v_lshlrev_b32 v180,16,v174
v_and_b32 v181,0xffff0000,v174
v_lshlrev_b32 v182,16,v175
v_and_b32 v183,0xffff0000,v175
v_pk_add_f32 v[200:201],v[200:201],v[176:177]
v_pk_add_f32 v[202:203],v[202:203],v[178:179]
v_pk_add_f32 v[204:205],v[204:205],v[180:181]
v_pk_add_f32 v[206:207],v[206:207],v[182:183]
v_cvt_pk_bf16_f32 v160,v200,v201
v_cvt_pk_bf16_f32 v161,v202,v203
v_cvt_pk_bf16_f32 v162,v204,v205
v_cvt_pk_bf16_f32 v163,v206,v207
buffer_store_dwordx4 v[160:163],v0,s[8:11],s20 offen sc1
v_lshlrev_b32 v200,16,v160
v_and_b32 v201,0xffff0000,v160
v_lshlrev_b32 v202,16,v161
v_and_b32 v203,0xffff0000,v161
v_lshlrev_b32 v204,16,v162
v_and_b32 v205,0xffff0000,v162
v_lshlrev_b32 v206,16,v163
v_and_b32 v207,0xffff0000,v163
v_readfirstlane_b32 s78,v200
s_nop 1
v_pk_add_f32 v[184:185],v[200:201],s[78:79] op_sel_hi:[1,0] neg_lo:[0,1] neg_hi:[0,1]
v_pk_add_f32 v[186:187],v[202:203],s[78:79] op_sel_hi:[1,0] neg_lo:[0,1] neg_hi:[0,1]
v_pk_add_f32 v[188:189],v[204:205],s[78:79] op_sel_hi:[1,0] neg_lo:[0,1] neg_hi:[0,1]
v_pk_add_f32 v[190:191],v[206:207],s[78:79] op_sel_hi:[1,0] neg_lo:[0,1] neg_hi:[0,1]
v_pk_add_f32 v[192:193],v[184:185],v[186:187]
v_pk_mul_f32 v[194:195],v[184:185],v[184:185]
v_pk_add_f32 v[196:197],v[188:189],v[190:191]
v_pk_fma_f32 v[194:195],v[186:187],v[186:187],v[194:195]
v_pk_add_f32 v[192:193],v[192:193],v[196:197]
v_pk_fma_f32 v[194:195],v[188:189],v[188:189],v[194:195]
v_add_f32 v192,v192,v193
v_pk_fma_f32 v[194:195],v[190:191],v[190:191],v[194:195]
v_add_f32 v194,v194,v195
s_nop 1
v_permlane32_swap_b32 v192,v194
v_add_f32 v192,v192,v194
s_nop 1
v_add_f32_dpp v192,v192,v192 row_ror:8 row_mask:0xf bank_mask:0xf
s_nop 1
v_add_f32_dpp v192,v192,v192 row_ror:4 row_mask:0xf bank_mask:0xf
s_nop 1
v_add_f32_dpp v192,v192,v192 row_ror:2 row_mask:0xf bank_mask:0xf
s_nop 1
v_add_f32_dpp v192,v192,v192 row_ror:1 row_mask:0xf bank_mask:0xf
v_mov_b32 v194,v192
s_nop 1
v_permlane16_swap_b32 v192,v194
v_add_f32 v192,v192,v194
v_mul_f32 v192,0x3b000000,v192
v_mov_b32 v194,v192
s_nop 1
v_permlane32_swap_b32 v192,v194
v_fma_f32 v194,-v192,v192,v194
v_add_f32 v192,s78,v192
v_max_f32 v194,0,v194
v_cvt_pk_bf16_f32 v194,v192,v194
v_lshlrev_b32 v192,16,v194
v_and_b32 v194,0xffff0000,v194
v_add_f32 v194,0x3727c5ac,v194
v_cvt_pk_bf16_f32 v194,v194,v194
v_and_b32 v194,0xffff0000,v194
v_sqrt_f32 v194,v194
v_pk_add_f32 v[184:185],v[200:201],v[192:193] op_sel_hi:[1,0] neg_lo:[0,1] neg_hi:[0,1]
v_pk_add_f32 v[186:187],v[202:203],v[192:193] op_sel_hi:[1,0] neg_lo:[0,1] neg_hi:[0,1]
v_pk_add_f32 v[188:189],v[204:205],v[192:193] op_sel_hi:[1,0] neg_lo:[0,1] neg_hi:[0,1]
v_pk_add_f32 v[190:191],v[206:207],v[192:193] op_sel_hi:[1,0] neg_lo:[0,1] neg_hi:[0,1]
v_cvt_pk_bf16_f32 v194,v194,v194
v_and_b32 v194,0xffff0000,v194
v_rcp_f32 v194,v194
v_cvt_pk_bf16_f32 v164,v184,v185
v_cvt_pk_bf16_f32 v165,v186,v187
v_cvt_pk_bf16_f32 v166,v188,v189
v_cvt_pk_bf16_f32 v167,v190,v191
v_lshlrev_b32 v184,16,v164
v_and_b32 v185,0xffff0000,v164
v_lshlrev_b32 v186,16,v165
v_and_b32 v187,0xffff0000,v165
v_lshlrev_b32 v188,16,v166
v_and_b32 v189,0xffff0000,v166
v_lshlrev_b32 v190,16,v167
v_and_b32 v191,0xffff0000,v167
v_pk_mul_f32 v[184:185],v[184:185],v[194:195] op_sel_hi:[1,0]
v_pk_mul_f32 v[186:187],v[186:187],v[194:195] op_sel_hi:[1,0]
v_pk_mul_f32 v[188:189],v[188:189],v[194:195] op_sel_hi:[1,0]
v_pk_mul_f32 v[190:191],v[190:191],v[194:195] op_sel_hi:[1,0]
v_cvt_pk_bf16_f32 v164,v184,v185
v_cvt_pk_bf16_f32 v165,v186,v187
v_cvt_pk_bf16_f32 v166,v188,v189
v_cvt_pk_bf16_f32 v167,v190,v191
s_add_u32 s20,s19,2097152
buffer_store_dwordx4 v[164:167],v0,s[8:11],s20 offen sc1
v_mov_b32 v20,1
s_lshl_b32 s73,s51,13
s_lshl2_add_u32 s73,s68,s73
s_add_u32 s73,s73,10487552
s_branch L_aa_68
L_ar_92:
ds_read_b128 v[160:163],v23
ds_read_b128 v[164:167],v23 offset:16
v_lshlrev_b32 v200,16,v224
v_and_b32 v201,0xffff0000,v224
v_lshlrev_b32 v202,16,v225
v_and_b32 v203,0xffff0000,v225
v_lshlrev_b32 v204,16,v226
v_and_b32 v205,0xffff0000,v226
v_lshlrev_b32 v206,16,v227
v_and_b32 v207,0xffff0000,v227
s_lshl_b32 s18,s51,5
s_add_u32 s18,s18,s68
s_lshl_b32 s19,s18,10
s_add_u32 s20,s19,4194304
s_waitcnt lgkmcnt(0)
v_cvt_pk_bf16_f32 v168,v160,v161
v_cvt_pk_bf16_f32 v169,v162,v163
v_cvt_pk_bf16_f32 v170,v164,v165
v_cvt_pk_bf16_f32 v171,v166,v167
v_lshlrev_b32 v160,16,v168
v_and_b32 v161,0xffff0000,v168
v_lshlrev_b32 v162,16,v169
v_and_b32 v163,0xffff0000,v169
v_lshlrev_b32 v164,16,v170
v_and_b32 v165,0xffff0000,v170
v_lshlrev_b32 v166,16,v171
v_and_b32 v167,0xffff0000,v171
v_pk_add_f32 v[200:201],v[200:201],v[160:161]
v_pk_add_f32 v[202:203],v[202:203],v[162:163]
v_pk_add_f32 v[204:205],v[204:205],v[164:165]
v_pk_add_f32 v[206:207],v[206:207],v[166:167]
v_cvt_pk_bf16_f32 v168,v200,v201
v_cvt_pk_bf16_f32 v169,v202,v203
v_cvt_pk_bf16_f32 v170,v204,v205
v_cvt_pk_bf16_f32 v171,v206,v207
buffer_store_dwordx4 v[168:171],v0,s[8:11],s20 offen sc1
v_lshlrev_b32 v200,16,v168
v_and_b32 v201,0xffff0000,v168
v_lshlrev_b32 v202,16,v169
v_and_b32 v203,0xffff0000,v169
v_lshlrev_b32 v204,16,v170
v_and_b32 v205,0xffff0000,v170
v_lshlrev_b32 v206,16,v171
v_and_b32 v207,0xffff0000,v171
v_readfirstlane_b32 s78,v200
s_nop 1
v_pk_add_f32 v[184:185],v[200:201],s[78:79] op_sel_hi:[1,0] neg_lo:[0,1] neg_hi:[0,1]
v_pk_add_f32 v[186:187],v[202:203],s[78:79] op_sel_hi:[1,0] neg_lo:[0,1] neg_hi:[0,1]
v_pk_add_f32 v[188:189],v[204:205],s[78:79] op_sel_hi:[1,0] neg_lo:[0,1] neg_hi:[0,1]
v_pk_add_f32 v[190:191],v[206:207],s[78:79] op_sel_hi:[1,0] neg_lo:[0,1] neg_hi:[0,1]
v_pk_add_f32 v[192:193],v[184:185],v[186:187]
v_pk_mul_f32 v[194:195],v[184:185],v[184:185]
v_pk_add_f32 v[196:197],v[188:189],v[190:191]
v_pk_fma_f32 v[194:195],v[186:187],v[186:187],v[194:195]
v_pk_add_f32 v[192:193],v[192:193],v[196:197]
v_pk_fma_f32 v[194:195],v[188:189],v[188:189],v[194:195]
v_add_f32 v192,v192,v193
v_pk_fma_f32 v[194:195],v[190:191],v[190:191],v[194:195]
v_add_f32 v194,v194,v195
s_nop 1
v_permlane32_swap_b32 v192,v194
v_add_f32 v192,v192,v194
s_nop 1
v_add_f32_dpp v192,v192,v192 row_ror:8 row_mask:0xf bank_mask:0xf
s_nop 1
v_add_f32_dpp v192,v192,v192 row_ror:4 row_mask:0xf bank_mask:0xf
s_nop 1
v_add_f32_dpp v192,v192,v192 row_ror:2 row_mask:0xf bank_mask:0xf
s_nop 1
v_add_f32_dpp v192,v192,v192 row_ror:1 row_mask:0xf bank_mask:0xf
v_mov_b32 v194,v192
s_nop 1
v_permlane16_swap_b32 v192,v194
v_add_f32 v192,v192,v194
v_mul_f32 v192,0x3b000000,v192
v_mov_b32 v194,v192
s_nop 1
v_permlane32_swap_b32 v192,v194
v_fma_f32 v194,-v192,v192,v194
v_add_f32 v192,s78,v192
v_max_f32 v194,0,v194
v_cvt_pk_bf16_f32 v194,v192,v194
v_lshlrev_b32 v192,16,v194
v_and_b32 v194,0xffff0000,v194
v_add_f32 v194,0x3727c5ac,v194
v_cvt_pk_bf16_f32 v194,v194,v194
v_and_b32 v194,0xffff0000,v194
v_sqrt_f32 v194,v194
v_pk_add_f32 v[184:185],v[200:201],v[192:193] op_sel_hi:[1,0] neg_lo:[0,1] neg_hi:[0,1]
v_pk_add_f32 v[186:187],v[202:203],v[192:193] op_sel_hi:[1,0] neg_lo:[0,1] neg_hi:[0,1]
v_pk_add_f32 v[188:189],v[204:205],v[192:193] op_sel_hi:[1,0] neg_lo:[0,1] neg_hi:[0,1]
v_pk_add_f32 v[190:191],v[206:207],v[192:193] op_sel_hi:[1,0] neg_lo:[0,1] neg_hi:[0,1]
v_cvt_pk_bf16_f32 v194,v194,v194
v_and_b32 v194,0xffff0000,v194
v_rcp_f32 v194,v194
v_cvt_pk_bf16_f32 v172,v184,v185
v_cvt_pk_bf16_f32 v173,v186,v187
v_cvt_pk_bf16_f32 v174,v188,v189
v_cvt_pk_bf16_f32 v175,v190,v191
v_lshlrev_b32 v184,16,v172
v_and_b32 v185,0xffff0000,v172
v_lshlrev_b32 v186,16,v173
v_and_b32 v187,0xffff0000,v173
v_lshlrev_b32 v188,16,v174
v_and_b32 v189,0xffff0000,v174
v_lshlrev_b32 v190,16,v175
v_and_b32 v191,0xffff0000,v175
v_pk_mul_f32 v[184:185],v[184:185],v[194:195] op_sel_hi:[1,0]
v_pk_mul_f32 v[186:187],v[186:187],v[194:195] op_sel_hi:[1,0]
v_pk_mul_f32 v[188:189],v[188:189],v[194:195] op_sel_hi:[1,0]
v_pk_mul_f32 v[190:191],v[190:191],v[194:195] op_sel_hi:[1,0]
v_cvt_pk_bf16_f32 v172,v184,v185
v_cvt_pk_bf16_f32 v173,v186,v187
v_cvt_pk_bf16_f32 v174,v188,v189
v_cvt_pk_bf16_f32 v175,v190,v191
v_lshlrev_b32 v176,16,v172
v_and_b32 v177,0xffff0000,v172
v_lshlrev_b32 v178,16,v173
v_and_b32 v179,0xffff0000,v173
v_lshlrev_b32 v180,16,v174
v_and_b32 v181,0xffff0000,v174
v_lshlrev_b32 v182,16,v175
v_and_b32 v183,0xffff0000,v175
v_pk_mul_f32 v[236:237],v[176:177],v[228:229]
v_pk_fma_f32 v[236:237],v[178:179],v[230:231],v[236:237]
v_pk_fma_f32 v[236:237],v[180:181],v[232:233],v[236:237]
v_pk_fma_f32 v[236:237],v[182:183],v[234:235],v[236:237]
v_add_f32 v236,v236,v237
s_nop 1
v_add_f32_dpp v236,v236,v236 row_ror:8 row_mask:0xf bank_mask:0xf
s_nop 1
v_add_f32_dpp v236,v236,v236 row_ror:4 row_mask:0xf bank_mask:0xf
s_nop 1
v_add_f32_dpp v236,v236,v236 row_ror:2 row_mask:0xf bank_mask:0xf
s_nop 1
v_add_f32_dpp v236,v236,v236 row_ror:1 row_mask:0xf bank_mask:0xf
v_mov_b32 v237,v236
s_nop 1
v_permlane16_swap_b32 v236,v237
v_add_f32 v236,v236,v237
v_mov_b32 v237,v236
s_nop 1
v_permlane32_swap_b32 v236,v237
v_add_f32 v236,v236,v237
v_cvt_pk_bf16_f32 v236,v236,v236
v_and_b32 v236,0xffff0000,v236
v_ashrrev_i32 v237,31,v236
v_or_b32 v237,0x80000000,v237
v_xor_b32 v236,v236,v237
v_and_b32 v236,0xffff0000,v236
s_sub_u32 s20,4095,s18
v_or_b32 v20,s20,v236
s_lshl_b32 s20,s51,13
s_lshl2_add_u32 s20,s68,s20
s_add_u32 s20,s20,10485760
buffer_store_dword v20,v254,s[8:11],s20 offen sc1
s_branch L_aa_68
L_ar_93:
s_bitcmp1_b32 s46,0
s_cbranch_scc1 L_aa_68
ds_read_b128 v[160:163],v23
ds_read_b128 v[164:167],v23 offset:16
v_lshlrev_b32 v200,16,v224
v_and_b32 v201,0xffff0000,v224
v_lshlrev_b32 v202,16,v225
v_and_b32 v203,0xffff0000,v225
v_lshlrev_b32 v204,16,v226
v_and_b32 v205,0xffff0000,v226
v_lshlrev_b32 v206,16,v227
v_and_b32 v207,0xffff0000,v227
v_readfirstlane_b32 s22,v246
s_cmp_eq_u32 s22,0
s_cbranch_scc1 L_ag_94
L_agb_95:
s_lshl_b32 s18,s51,5
s_add_u32 s18,s18,s68
s_lshl_b32 s19,s18,10
s_add_u32 s20,s19,6291456
s_waitcnt lgkmcnt(0)
v_cvt_pk_bf16_f32 v168,v160,v161
v_cvt_pk_bf16_f32 v169,v162,v163
v_cvt_pk_bf16_f32 v170,v164,v165
v_cvt_pk_bf16_f32 v171,v166,v167
v_lshlrev_b32 v160,16,v168
v_and_b32 v161,0xffff0000,v168
v_lshlrev_b32 v162,16,v169
v_and_b32 v163,0xffff0000,v169
v_lshlrev_b32 v164,16,v170
v_and_b32 v165,0xffff0000,v170
v_lshlrev_b32 v166,16,v171
v_and_b32 v167,0xffff0000,v171
v_pk_add_f32 v[200:201],v[200:201],v[160:161]
v_pk_add_f32 v[202:203],v[202:203],v[162:163]
v_pk_add_f32 v[204:205],v[204:205],v[164:165]
v_pk_add_f32 v[206:207],v[206:207],v[166:167]
v_cvt_pk_bf16_f32 v168,v200,v201
v_cvt_pk_bf16_f32 v169,v202,v203
v_cvt_pk_bf16_f32 v170,v204,v205
v_cvt_pk_bf16_f32 v171,v206,v207
buffer_store_dwordx4 v[168:171],v0,s[8:11],s20 offen sc1
v_lshlrev_b32 v200,16,v168
v_and_b32 v201,0xffff0000,v168
v_lshlrev_b32 v202,16,v169
v_and_b32 v203,0xffff0000,v169
v_lshlrev_b32 v204,16,v170
v_and_b32 v205,0xffff0000,v170
v_lshlrev_b32 v206,16,v171
v_and_b32 v207,0xffff0000,v171
v_readfirstlane_b32 s78,v200
s_nop 1
v_pk_add_f32 v[184:185],v[200:201],s[78:79] op_sel_hi:[1,0] neg_lo:[0,1] neg_hi:[0,1]
v_pk_add_f32 v[186:187],v[202:203],s[78:79] op_sel_hi:[1,0] neg_lo:[0,1] neg_hi:[0,1]
v_pk_add_f32 v[188:189],v[204:205],s[78:79] op_sel_hi:[1,0] neg_lo:[0,1] neg_hi:[0,1]
v_pk_add_f32 v[190:191],v[206:207],s[78:79] op_sel_hi:[1,0] neg_lo:[0,1] neg_hi:[0,1]
v_pk_add_f32 v[192:193],v[184:185],v[186:187]
v_pk_mul_f32 v[194:195],v[184:185],v[184:185]
v_pk_add_f32 v[196:197],v[188:189],v[190:191]
v_pk_fma_f32 v[194:195],v[186:187],v[186:187],v[194:195]
v_pk_add_f32 v[192:193],v[192:193],v[196:197]
v_pk_fma_f32 v[194:195],v[188:189],v[188:189],v[194:195]
v_add_f32 v192,v192,v193
v_pk_fma_f32 v[194:195],v[190:191],v[190:191],v[194:195]
v_add_f32 v194,v194,v195
s_nop 1
v_permlane32_swap_b32 v192,v194
v_add_f32 v192,v192,v194
s_nop 1
v_add_f32_dpp v192,v192,v192 row_ror:8 row_mask:0xf bank_mask:0xf
s_nop 1
v_add_f32_dpp v192,v192,v192 row_ror:4 row_mask:0xf bank_mask:0xf
s_nop 1
v_add_f32_dpp v192,v192,v192 row_ror:2 row_mask:0xf bank_mask:0xf
s_nop 1
v_add_f32_dpp v192,v192,v192 row_ror:1 row_mask:0xf bank_mask:0xf
v_mov_b32 v194,v192
s_nop 1
v_permlane16_swap_b32 v192,v194
v_add_f32 v192,v192,v194
v_mul_f32 v192,0x3b000000,v192
v_mov_b32 v194,v192
s_nop 1
v_permlane32_swap_b32 v192,v194
v_fma_f32 v194,-v192,v192,v194
v_add_f32 v192,s78,v192
v_max_f32 v194,0,v194
v_cvt_pk_bf16_f32 v194,v192,v194
v_lshlrev_b32 v192,16,v194
v_and_b32 v194,0xffff0000,v194
v_add_f32 v194,0x3727c5ac,v194
v_cvt_pk_bf16_f32 v194,v194,v194
v_and_b32 v194,0xffff0000,v194
v_sqrt_f32 v194,v194
v_pk_add_f32 v[184:185],v[200:201],v[192:193] op_sel_hi:[1,0] neg_lo:[0,1] neg_hi:[0,1]
v_pk_add_f32 v[186:187],v[202:203],v[192:193] op_sel_hi:[1,0] neg_lo:[0,1] neg_hi:[0,1]
v_pk_add_f32 v[188:189],v[204:205],v[192:193] op_sel_hi:[1,0] neg_lo:[0,1] neg_hi:[0,1]
v_pk_add_f32 v[190:191],v[206:207],v[192:193] op_sel_hi:[1,0] neg_lo:[0,1] neg_hi:[0,1]
v_cvt_pk_bf16_f32 v194,v194,v194
v_and_b32 v194,0xffff0000,v194
v_rcp_f32 v194,v194
v_cvt_pk_bf16_f32 v172,v184,v185
v_cvt_pk_bf16_f32 v173,v186,v187
v_cvt_pk_bf16_f32 v174,v188,v189
v_cvt_pk_bf16_f32 v175,v190,v191
v_lshlrev_b32 v184,16,v172
v_and_b32 v185,0xffff0000,v172
v_lshlrev_b32 v186,16,v173
v_and_b32 v187,0xffff0000,v173
v_lshlrev_b32 v188,16,v174
v_and_b32 v189,0xffff0000,v174
v_lshlrev_b32 v190,16,v175
v_and_b32 v191,0xffff0000,v175
v_pk_mul_f32 v[184:185],v[184:185],v[194:195] op_sel_hi:[1,0]
v_pk_mul_f32 v[186:187],v[186:187],v[194:195] op_sel_hi:[1,0]
v_pk_mul_f32 v[188:189],v[188:189],v[194:195] op_sel_hi:[1,0]
v_pk_mul_f32 v[190:191],v[190:191],v[194:195] op_sel_hi:[1,0]
v_cvt_pk_bf16_f32 v172,v184,v185
v_cvt_pk_bf16_f32 v173,v186,v187
v_cvt_pk_bf16_f32 v174,v188,v189
v_cvt_pk_bf16_f32 v175,v190,v191
v_lshlrev_b32 v176,16,v172
v_and_b32 v177,0xffff0000,v172
v_lshlrev_b32 v178,16,v173
v_and_b32 v179,0xffff0000,v173
v_lshlrev_b32 v180,16,v174
v_and_b32 v181,0xffff0000,v174
v_lshlrev_b32 v182,16,v175
v_and_b32 v183,0xffff0000,v175
v_pk_add_f32 v[200:201],v[200:201],v[176:177]
v_pk_add_f32 v[202:203],v[202:203],v[178:179]
v_pk_add_f32 v[204:205],v[204:205],v[180:181]
v_pk_add_f32 v[206:207],v[206:207],v[182:183]
v_cvt_pk_bf16_f32 v160,v200,v201
v_cvt_pk_bf16_f32 v161,v202,v203
v_cvt_pk_bf16_f32 v162,v204,v205
v_cvt_pk_bf16_f32 v163,v206,v207
buffer_store_dwordx4 v[160:163],v0,s[12:15],s19 offen sc1
v_pk_mul_f32 v[236:237],v[176:177],v[228:229]
v_pk_fma_f32 v[236:237],v[178:179],v[230:231],v[236:237]
v_pk_fma_f32 v[236:237],v[180:181],v[232:233],v[236:237]
v_pk_fma_f32 v[236:237],v[182:183],v[234:235],v[236:237]
v_add_f32 v236,v236,v237
s_nop 1
v_add_f32_dpp v236,v236,v236 row_ror:8 row_mask:0xf bank_mask:0xf
s_nop 1
v_add_f32_dpp v236,v236,v236 row_ror:4 row_mask:0xf bank_mask:0xf
s_nop 1
v_add_f32_dpp v236,v236,v236 row_ror:2 row_mask:0xf bank_mask:0xf
s_nop 1
v_add_f32_dpp v236,v236,v236 row_ror:1 row_mask:0xf bank_mask:0xf
v_mov_b32 v237,v236
s_nop 1
v_permlane16_swap_b32 v236,v237
v_add_f32 v236,v236,v237
v_mov_b32 v237,v236
s_nop 1
v_permlane32_swap_b32 v236,v237
v_add_f32 v236,v236,v237
v_cvt_pk_bf16_f32 v236,v236,v236
v_and_b32 v236,0xffff0000,v236
v_ashrrev_i32 v237,31,v236
v_or_b32 v237,0x80000000,v237
v_xor_b32 v236,v236,v237
v_and_b32 v236,0xffff0000,v236
s_sub_u32 s20,4095,s18
v_or_b32 v20,s20,v236
s_lshl_b32 s73,s51,13
s_lshl2_add_u32 s73,s68,s73
s_add_u32 s73,s73,10485760
s_add_u32 s73,s73,s86
L_aa_68:
s_cmp_eq_u32 s27,1
s_cbranch_scc1 L_ad_96
s_cmp_eq_u32 s27,0
s_cbranch_scc1 L_aa_69
s_cmp_ge_u32 s77,64
s_cbranch_scc1 L_aa_72
L_aa_70:
s_waitcnt vmcnt(0)
buffer_store_dword v20,off,s[8:11],s73 sc1
s_mov_b32 s73,0x80000000
v_mov_b32 v18,0
s_mov_b32 s27,0
L_aw_97:
v_cmp_eq_u32 vcc,0,v18
s_cbranch_vccz L_awd_98
buffer_load_dword v18,v19,s[8:11],0 offen sc1
s_sub_u32 s49,s49,1
s_cbranch_scc1 L_abort
s_waitcnt vmcnt(0)
s_branch L_aw_97
L_awd_98:
s_mov_b32 s64,s70
s_mov_b32 s65,s71
s_and_b32 s57,s46,1
s_mul_i32 s58,s57,12288
s_add_u32 s64,s64,s58
s_lshl_b32 s57,s57,11
s_add_u32 s65,s65,s57
s_and_b32 s59,s50,2048
s_lshl_b32 s59,s59,4
s_xor_b32 s60,s67,65536
s_add_u32 s59,s59,s60
s_add_u32 s58,s58,s59
s_add_u32 s57,s57,s59
s_add_u32 m0,s58,0
s_nop 0
buffer_load_dwordx4 v0,s[8:11],s64 offen offset:0 sc1 lds
buffer_load_dwordx4 v0,s[8:11],s64 offen offset:1024 sc1 lds
buffer_load_dwordx4 v0,s[8:11],s64 offen offset:2048 sc1 lds
buffer_load_dwordx4 v0,s[8:11],s64 offen offset:3072 sc1 lds
s_add_u32 m0,s58,4096
s_add_u32 s64,s64,4096
buffer_load_dwordx4 v0,s[8:11],s64 offen offset:0 sc1 lds
buffer_load_dwordx4 v0,s[8:11],s64 offen offset:1024 sc1 lds
buffer_load_dwordx4 v0,s[8:11],s64 offen offset:2048 sc1 lds
buffer_load_dwordx4 v0,s[8:11],s64 offen offset:3072 sc1 lds
s_add_u32 m0,s58,8192
s_add_u32 s64,s64,4096
buffer_load_dwordx4 v0,s[8:11],s64 offen offset:0 sc1 lds
buffer_load_dwordx4 v0,s[8:11],s64 offen offset:1024 sc1 lds
buffer_load_dwordx4 v0,s[8:11],s64 offen offset:2048 sc1 lds
buffer_load_dwordx4 v0,s[8:11],s64 offen offset:3072 sc1 lds
s_add_u32 m0,s57,24576
s_nop 0
buffer_load_dwordx4 v0,s[8:11],s65 offen offset:0 sc1 lds
buffer_load_dwordx4 v0,s[8:11],s65 offen offset:1024 sc1 lds
v_lshrrev_b32 v244,4,v1
s_sub_u32 s56,s77,8
v_add_u32 v244,s56,v244
v_max_i32 v244,0,v244
v_lshl_add_u32 v244,v244,13,v21
buffer_load_dwordx2 v[242:243],v244,s[8:11],0 offen sc1
s_waitcnt vmcnt(0) lgkmcnt(0)
s_barrier
s_xor_b32 s67,s67,65536
s_and_b32 s56,s50,2048
s_lshl_b32 s56,s56,4
s_add_u32 s56,s56,s67
v_add_u32 v2,s56,v0
v_add_u32 v239,s56,v253
s_and_b32 s56,s50,1024
s_lshl_b32 s56,s56,2
v_add_u32 v238,s56,v2
s_mov_b32 s76,s71
s_mov_b32 s53,s77
ds_read_b128 v[24:27],v238 offset:16384
ds_read_b128 v[40:43],v2 offset:0
ds_read_b128 v[56:59],v2 offset:4096
ds_read_b128 v[28:31],v238 offset:17408
ds_read_b128 v[44:47],v2 offset:1024
ds_read_b128 v[60:63],v2 offset:5120
ds_read_b128 v[32:35],v238 offset:18432
ds_read_b128 v[48:51],v2 offset:2048
ds_read_b128 v[64:67],v2 offset:6144
ds_read_b128 v[36:39],v238 offset:19456
ds_read_b128 v[52:55],v2 offset:3072
ds_read_b128 v[68:71],v2 offset:7168
s_waitcnt lgkmcnt(9)
v_mfma_f32_16x16x32_bf16 v[128:131],v[40:43],v[24:27],v[8:11]
ds_read_b128 v[72:75],v2 offset:24576
v_mfma_f32_16x16x32_bf16 v[132:135],v[56:59],v[24:27],v[12:15]
ds_read_b128 v[76:79],v2 offset:25600
s_waitcnt lgkmcnt(8)
v_mfma_f32_16x16x32_bf16 v[128:131],v[44:47],v[28:31],v[128:131]
ds_read_b128 v[80:83],v2 offset:26624
v_mfma_f32_16x16x32_bf16 v[132:135],v[60:63],v[28:31],v[132:135]
ds_read_b128 v[84:87],v2 offset:27648
s_waitcnt lgkmcnt(7)
v_mfma_f32_16x16x32_bf16 v[128:131],v[48:51],v[32:35],v[128:131]
ds_read_b64 v[120:121],v239 offset:24576
v_mfma_f32_16x16x32_bf16 v[132:135],v[64:67],v[32:35],v[132:135]
ds_read_b64 v[122:123],v239 offset:25600
s_waitcnt lgkmcnt(6)
v_mfma_f32_16x16x32_bf16 v[128:131],v[52:55],v[36:39],v[128:131]
ds_read_b64 v[124:125],v239 offset:26624
v_mfma_f32_16x16x32_bf16 v[132:135],v[68:71],v[36:39],v[132:135]
ds_read_b64 v[126:127],v239 offset:27648
s_waitcnt lgkmcnt(4)
v_mfma_f32_16x16x32_bf16 v[136:139],v[72:75],v[24:27],0
ds_read_b128 v[88:91],v2 offset:8192
ds_read_b128 v[92:95],v2 offset:9216
v_mfma_f32_16x16x32_bf16 v[136:139],v[76:79],v[28:31],v[136:139]
ds_read_b128 v[96:99],v2 offset:10240
ds_read_b128 v[100:103],v2 offset:11264
v_mfma_f32_16x16x32_bf16 v[136:139],v[80:83],v[32:35],v[136:139]
ds_read_b128 v[104:107],v2 offset:12288
ds_read_b128 v[108:111],v2 offset:13312
v_mfma_f32_16x16x32_bf16 v[136:139],v[84:87],v[36:39],v[136:139]
ds_read_b128 v[112:115],v2 offset:14336
ds_read_b128 v[116:119],v2 offset:15360
s_waitcnt lgkmcnt(0)
s_cmp_eq_u32 s30,0
s_cbranch_scc1 L_aa_71
s_cmp_lg_u32 s86,1536
s_cbranch_scc1 L_ae_99
s_mov_b32 s77,s35
s_mov_b32 s30,0
s_lshl_b32 s56,s77,5
s_add_u32 s56,s56,s68
s_mul_i32 s70,s56,24576
s_lshl_b32 s71,s56,12
s_lshl_b32 s59,s77,13
s_lshl2_add_u32 s59,s68,s59
s_add_u32 s59,s59,10485760
s_buffer_load_dword s32,s[8:11],s59
s_mov_b32 s33,1
s_add_u32 s70,s70,100663296
s_add_u32 s71,s71,41943040
v_mov_b32 v19,s59
s_branch L_af_100
L_ae_99:
s_ff1_i32_b64 s77,s[84:85]
s_bitset0_b64 s[84:85],s77
s_min_u32 s77,s77,64
s_lshr_b32 s61,s55,5
s_lshl_b32 s56,s77,5
s_add_u32 s56,s56,s68
s_mul_i32 s70,s56,24576
s_lshl_b32 s71,s56,12
s_lshl_b32 s59,s77,13
s_lshl2_add_u32 s59,s68,s59
s_add_u32 s59,s59,10486144
s_cmp_lt_u32 s77,s61
s_cselect_b32 s57,0,16777216
s_cselect_b32 s60,0,128
s_add_u32 s60,s60,s59
s_add_u32 s60,s60,128
s_buffer_load_dword s33,s[8:11],s60
s_add_u32 s71,s71,s57
s_add_u32 s71,s71,58720256
s_cmp_eq_u32 s77,s61
s_cselect_b32 s57,50331648,0
s_cselect_b32 s58,1536,0
s_add_u32 s59,s59,s58
s_buffer_load_dword s32,s[8:11],s59
s_add_u32 s70,s70,s57
s_add_u32 s70,s70,150994944
v_mov_b32 v19,s59
v_writelane_b32 v19,s60,1
L_af_100:
v_max3_f32 v238,v128,v129,v130
v_max3_f32 v239,v131,v132,v133
v_max3_f32 v238,v134,v135,v238
v_max3_f32 v239,v138,v139,v239
v_max_f32 v238,v238,v239
v_max_f32 v239,v238,v239
s_nop 1
v_permlane16_swap_b32 v238,v239
v_max_f32 v238,v238,v239
v_max_f32 v239,v238,v239
s_nop 1
v_permlane32_swap_b32 v238,v239
v_max_f32 v238,v238,v239
v_mul_f32 v238,s80,v238
v_fma_f32 v128,v128,s80,-v238
v_fma_f32 v129,v129,s80,-v238
v_exp_f32 v128,v128
v_fma_f32 v130,v130,s80,-v238
v_exp_f32 v129,v129
v_fma_f32 v131,v131,s80,-v238
v_exp_f32 v130,v130
v_fma_f32 v132,v132,s80,-v238
v_exp_f32 v131,v131
v_fma_f32 v133,v133,s80,-v238
v_exp_f32 v132,v132
v_fma_f32 v134,v134,s80,-v238
v_exp_f32 v133,v133
v_fma_f32 v135,v135,s80,-v238
v_exp_f32 v134,v134
v_fma_f32 v138,v138,s80,-v238
v_exp_f32 v135,v135
v_fma_f32 v139,v139,s80,-v238
v_exp_f32 v138,v138
v_exp_f32 v139,v139
v_cvt_pk_bf16_f32 v140,v128,v129
v_cvt_pk_bf16_f32 v141,v130,v131
v_cvt_pk_bf16_f32 v142,v132,v133
v_cvt_pk_bf16_f32 v143,v134,v135
v_cvt_pk_bf16_f32 v144,v138,v139
v_mov_b32 v147,v144
v_mfma_f32_16x16x32_bf16 v[148:151],v[152:155],v[140:143],0
v_mfma_f32_16x16x32_bf16 v[24:27],v[88:91],v[140:143],0
v_mfma_f32_16x16x32_bf16 v[28:31],v[92:95],v[140:143],0
v_mfma_f32_16x16x16_bf16 v[148:151],v[152:153],v[144:145],v[148:151]
v_mfma_f32_16x16x32_bf16 v[32:35],v[96:99],v[140:143],0
v_mfma_f32_16x16x32_bf16 v[36:39],v[100:103],v[140:143],0
v_mfma_f32_16x16x32_bf16 v[40:43],v[104:107],v[140:143],0
v_mfma_f32_16x16x32_bf16 v[44:47],v[108:111],v[140:143],0
v_mfma_f32_16x16x32_bf16 v[48:51],v[112:115],v[140:143],0
v_mfma_f32_16x16x32_bf16 v[52:55],v[116:119],v[140:143],0
v_rcp_f32 v148,v148
v_mfma_f32_16x16x16_bf16 v[24:27],v[120:121],v[144:145],v[24:27]
v_mfma_f32_16x16x16_bf16 v[28:31],v[120:121],v[146:147],v[28:31]
v_mfma_f32_16x16x16_bf16 v[32:35],v[122:123],v[144:145],v[32:35]
v_mfma_f32_16x16x16_bf16 v[36:39],v[122:123],v[146:147],v[36:39]
v_mfma_f32_16x16x16_bf16 v[40:43],v[124:125],v[144:145],v[40:43]
v_pk_mul_f32 v[24:25],v[24:25],v[148:149] op_sel_hi:[1,0]
v_pk_mul_f32 v[26:27],v[26:27],v[148:149] op_sel_hi:[1,0]
v_mfma_f32_16x16x16_bf16 v[44:47],v[124:125],v[146:147],v[44:47]
v_pk_mul_f32 v[28:29],v[28:29],v[148:149] op_sel_hi:[1,0]
v_pk_mul_f32 v[30:31],v[30:31],v[148:149] op_sel_hi:[1,0]
v_mfma_f32_16x16x16_bf16 v[48:51],v[126:127],v[144:145],v[48:51]
v_cvt_pk_bf16_f32 v72,v24,v28
v_cvt_pk_bf16_f32 v73,v25,v29
v_mfma_f32_16x16x16_bf16 v[52:55],v[126:127],v[146:147],v[52:55]
v_cvt_pk_bf16_f32 v74,v26,v30
v_cvt_pk_bf16_f32 v75,v27,v31
ds_write_b128 v3,v[72:75] offset:0
v_pk_mul_f32 v[32:33],v[32:33],v[148:149] op_sel_hi:[1,0]
v_pk_mul_f32 v[34:35],v[34:35],v[148:149] op_sel_hi:[1,0]
v_pk_mul_f32 v[36:37],v[36:37],v[148:149] op_sel_hi:[1,0]
v_pk_mul_f32 v[38:39],v[38:39],v[148:149] op_sel_hi:[1,0]
v_cvt_pk_bf16_f32 v76,v32,v36
v_cvt_pk_bf16_f32 v77,v33,v37
v_cvt_pk_bf16_f32 v78,v34,v38
v_cvt_pk_bf16_f32 v79,v35,v39
ds_write_b128 v3,v[76:79] offset:1024
v_pk_mul_f32 v[40:41],v[40:41],v[148:149] op_sel_hi:[1,0]
v_pk_mul_f32 v[42:43],v[42:43],v[148:149] op_sel_hi:[1,0]
v_pk_mul_f32 v[44:45],v[44:45],v[148:149] op_sel_hi:[1,0]
v_pk_mul_f32 v[46:47],v[46:47],v[148:149] op_sel_hi:[1,0]
v_cvt_pk_bf16_f32 v80,v40,v44
v_cvt_pk_bf16_f32 v81,v41,v45
v_cvt_pk_bf16_f32 v82,v42,v46
v_cvt_pk_bf16_f32 v83,v43,v47
ds_write_b128 v3,v[80:83] offset:2048
v_pk_mul_f32 v[48:49],v[48:49],v[148:149] op_sel_hi:[1,0]
v_pk_mul_f32 v[50:51],v[50:51],v[148:149] op_sel_hi:[1,0]
v_pk_mul_f32 v[52:53],v[52:53],v[148:149] op_sel_hi:[1,0]
v_pk_mul_f32 v[54:55],v[54:55],v[148:149] op_sel_hi:[1,0]
v_cvt_pk_bf16_f32 v84,v48,v52
v_cvt_pk_bf16_f32 v85,v49,v53
v_cvt_pk_bf16_f32 v86,v50,v54
v_cvt_pk_bf16_f32 v87,v51,v55
ds_write_b128 v3,v[84:87] offset:3072
s_waitcnt lgkmcnt(0)
s_barrier
L_ad_96:
s_mov_b32 s51,s53
s_mov_b32 s31,1
s_branch L_aa_63
L_aa_69:
s_waitcnt vmcnt(0)
buffer_store_dword v20,off,s[8:11],s73 sc1
s_mov_b32 s73,0x80000000
L_aa_71:
s_mov_b32 s51,s53
s_mov_b32 s31,0
s_add_u32 s35,s53,4
s_cmp_lt_u32 s53,5
s_cbranch_scc1 L_ab_101
s_cmp_ge_u32 s53,62
s_cbranch_scc1 L_am_103
L_aw_104:
v_min_u32 v239,v242,v243
v_cmp_eq_u32 vcc,0,v239
s_cbranch_vccz L_awd_105
s_sleep 4
buffer_load_dwordx2 v[242:243],v244,s[8:11],0 offen sc1
s_sub_u32 s49,s49,1
s_cbranch_scc1 L_abort
s_waitcnt vmcnt(0)
s_branch L_aw_104
L_awd_105:
v_max_u32 v242,v242,v243
s_nop 1
v_max_u32_dpp v242,v242,v242 row_ror:8 row_mask:0xf bank_mask:0xf
s_nop 1
v_max_u32_dpp v242,v242,v242 row_ror:4 row_mask:0xf bank_mask:0xf
s_nop 1
v_max_u32_dpp v242,v242,v242 row_ror:2 row_mask:0xf bank_mask:0xf
s_nop 1
v_max_u32_dpp v242,v242,v242 row_ror:1 row_mask:0xf bank_mask:0xf
v_mov_b32 v243,v242
s_nop 1
v_permlane16_swap_b32 v242,v243
v_max_u32 v242,v242,v243
v_mov_b32 v243,v242
s_nop 1
v_permlane32_swap_b32 v242,v243
v_max_u32 v242,v242,v243
s_nop 0
v_readfirstlane_b32 s56,v242
v_readlane_b32 s57,v255,s53
s_max_u32 s75,s75,s56
s_cmp_lt_u32 s53,11
s_cbranch_scc1 L_ab_101
s_mov_b32 s77,s36
s_and_b32 s55,s75,0x7ff
s_sub_u32 s55,2047,s55
s_cmp_lt_u32 s75,s57
s_cselect_b32 s55,4095,s55
s_lshr_b32 s61,s55,5
s_mov_b32 s30,1
s_lshl_b32 s56,s77,5
s_add_u32 s56,s56,s68
s_mul_i32 s70,s56,24576
s_lshl_b32 s71,s56,12
s_lshl_b32 s59,s77,13
s_lshl2_add_u32 s59,s68,s59
s_add_u32 s59,s59,10486144
s_cmp_lt_u32 s77,s61
s_cselect_b32 s57,0,16777216
s_cselect_b32 s60,0,128
s_add_u32 s60,s60,s59
s_add_u32 s60,s60,128
s_add_u32 s71,s71,s57
s_add_u32 s71,s71,58720256
s_cmp_eq_u32 s77,s61
s_cselect_b32 s57,50331648,0
s_cselect_b32 s58,1536,0
s_add_u32 s59,s59,s58
s_add_u32 s70,s70,s57
s_add_u32 s70,s70,150994944
v_mov_b32 v19,s59
v_writelane_b32 v19,s60,1
s_branch L_aj_102
L_ab_101:
s_mov_b32 s77,s35
s_mov_b32 s30,0
s_lshl_b32 s56,s77,5
s_add_u32 s56,s56,s68
s_mul_i32 s70,s56,24576
s_lshl_b32 s71,s56,12
s_lshl_b32 s59,s77,13
s_lshl2_add_u32 s59,s68,s59
s_add_u32 s59,s59,10485760
s_mov_b32 s33,1
s_add_u32 s70,s70,100663296
s_add_u32 s71,s71,41943040
v_mov_b32 v19,s59
L_aj_102:
buffer_load_dword v18,v19,s[8:11],0 offen sc1
v_mfma_f32_16x16x32_bf16 v[136:139],v[72:75],v[24:27],0
v_max3_u32 v238,v72,v73,v74
v_max3_u32 v238,v74,v75,v238
v_mfma_f32_16x16x32_bf16 v[136:139],v[76:79],v[28:31],v[136:139]
v_max3_u32 v238,v76,v77,v238
v_max3_u32 v238,v78,v79,v238
v_mfma_f32_16x16x32_bf16 v[136:139],v[80:83],v[32:35],v[136:139]
v_max3_u32 v238,v80,v81,v238
v_max3_u32 v238,v82,v83,v238
v_mfma_f32_16x16x32_bf16 v[136:139],v[84:87],v[36:39],v[136:139]
v_max3_u32 v238,v84,v85,v238
v_max3_u32 v238,v86,v87,v238
v_max3_u32 v238,v120,v121,v238
v_max3_u32 v238,v122,v123,v238
v_max3_u32 v238,v124,v125,v238
v_max3_u32 v238,v126,v127,v238
v_cmp_eq_u32 vcc,-1,v238
s_cbranch_vccz L_aa_74
L_aa_73:
buffer_load_dwordx4 v[72:75],v0,s[8:11],s76 offen offset:0 sc1
buffer_load_dwordx4 v[76:79],v0,s[8:11],s76 offen offset:1024 sc1
buffer_load_dwordx4 v[80:83],v0,s[8:11],s76 offen offset:2048 sc1
buffer_load_dwordx4 v[84:87],v0,s[8:11],s76 offen offset:3072 sc1
buffer_load_dwordx2 v[120:121],v253,s[8:11],s76 offen offset:0 sc1
buffer_load_dwordx2 v[122:123],v253,s[8:11],s76 offen offset:1024 sc1
buffer_load_dwordx2 v[124:125],v253,s[8:11],s76 offen offset:2048 sc1
buffer_load_dwordx2 v[126:127],v253,s[8:11],s76 offen offset:3072 sc1
buffer_load_dword v18,v19,s[8:11],0 offen sc1
s_sub_u32 s49,s49,1
s_cbranch_scc1 L_abort
s_waitcnt vmcnt(8)
v_mfma_f32_16x16x32_bf16 v[136:139],v[72:75],v[24:27],0
v_max3_u32 v238,v72,v73,v74
v_max3_u32 v238,v74,v75,v238
s_waitcnt vmcnt(7)
v_mfma_f32_16x16x32_bf16 v[136:139],v[76:79],v[28:31],v[136:139]
v_max3_u32 v238,v76,v77,v238
v_max3_u32 v238,v78,v79,v238
s_waitcnt vmcnt(6)
v_mfma_f32_16x16x32_bf16 v[136:139],v[80:83],v[32:35],v[136:139]
v_max3_u32 v238,v80,v81,v238
v_max3_u32 v238,v82,v83,v238
s_waitcnt vmcnt(5)
v_mfma_f32_16x16x32_bf16 v[136:139],v[84:87],v[36:39],v[136:139]
v_max3_u32 v238,v84,v85,v238
v_max3_u32 v238,v86,v87,v238
s_waitcnt vmcnt(1)
v_max3_u32 v238,v120,v121,v238
v_max3_u32 v238,v122,v123,v238
v_max3_u32 v238,v124,v125,v238
v_max3_u32 v238,v126,v127,v238
v_cmp_eq_u32 vcc,-1,v238
s_cbranch_vccnz L_aa_73
L_aa_74:
s_cmp_lg_u32 s27,3
s_cbranch_scc1 L_ai_106
v_max3_f32 v238,v128,v129,v130
v_max3_f32 v239,v131,v132,v133
v_max3_f32 v238,v134,v135,v238
v_max3_f32 v239,v138,v139,v239
v_max_f32 v238,v238,v239
v_max_f32 v239,v238,v239
s_nop 1
v_permlane16_swap_b32 v238,v239
v_max_f32 v238,v238,v239
v_max_f32 v239,v238,v239
s_nop 1
v_permlane32_swap_b32 v238,v239
v_max_f32 v238,v238,v239
v_mul_f32 v238,s80,v238
v_fma_f32 v128,v128,s80,-v238
v_fma_f32 v129,v129,s80,-v238
v_exp_f32 v128,v128
v_fma_f32 v130,v130,s80,-v238
v_exp_f32 v129,v129
v_fma_f32 v131,v131,s80,-v238
v_exp_f32 v130,v130
v_fma_f32 v132,v132,s80,-v238
v_exp_f32 v131,v131
v_fma_f32 v133,v133,s80,-v238
v_exp_f32 v132,v132
v_fma_f32 v134,v134,s80,-v238
v_exp_f32 v133,v133
v_fma_f32 v135,v135,s80,-v238
v_exp_f32 v134,v134
v_fma_f32 v138,v138,s80,-v238
v_exp_f32 v135,v135
v_fma_f32 v139,v139,s80,-v238
v_exp_f32 v138,v138
v_exp_f32 v139,v139
v_cvt_pk_bf16_f32 v140,v128,v129
v_cvt_pk_bf16_f32 v141,v130,v131
v_cvt_pk_bf16_f32 v142,v132,v133
v_cvt_pk_bf16_f32 v143,v134,v135
v_cvt_pk_bf16_f32 v144,v138,v139
v_mov_b32 v147,v144
buffer_load_dword v17,v16,s[8:11],s87 offen sc1
v_mfma_f32_16x16x32_bf16 v[148:151],v[152:155],v[140:143],0
v_mfma_f32_16x16x32_bf16 v[24:27],v[88:91],v[140:143],0
v_mfma_f32_16x16x32_bf16 v[28:31],v[92:95],v[140:143],0
v_mfma_f32_16x16x16_bf16 v[148:151],v[152:153],v[144:145],v[148:151]
v_mfma_f32_16x16x32_bf16 v[32:35],v[96:99],v[140:143],0
v_mfma_f32_16x16x32_bf16 v[36:39],v[100:103],v[140:143],0
v_mfma_f32_16x16x32_bf16 v[40:43],v[104:107],v[140:143],0
v_mfma_f32_16x16x32_bf16 v[44:47],v[108:111],v[140:143],0
v_mfma_f32_16x16x32_bf16 v[48:51],v[112:115],v[140:143],0
v_mfma_f32_16x16x32_bf16 v[52:55],v[116:119],v[140:143],0
v_rcp_f32 v148,v148
v_mfma_f32_16x16x16_bf16 v[24:27],v[120:121],v[144:145],v[24:27]
v_mfma_f32_16x16x16_bf16 v[28:31],v[120:121],v[146:147],v[28:31]
v_mfma_f32_16x16x16_bf16 v[32:35],v[122:123],v[144:145],v[32:35]
v_mfma_f32_16x16x16_bf16 v[36:39],v[122:123],v[146:147],v[36:39]
v_mfma_f32_16x16x16_bf16 v[40:43],v[124:125],v[144:145],v[40:43]
v_pk_mul_f32 v[24:25],v[24:25],v[148:149] op_sel_hi:[1,0]
v_pk_mul_f32 v[26:27],v[26:27],v[148:149] op_sel_hi:[1,0]
v_mfma_f32_16x16x16_bf16 v[44:47],v[124:125],v[146:147],v[44:47]
v_pk_mul_f32 v[28:29],v[28:29],v[148:149] op_sel_hi:[1,0]
v_pk_mul_f32 v[30:31],v[30:31],v[148:149] op_sel_hi:[1,0]
v_mfma_f32_16x16x16_bf16 v[48:51],v[126:127],v[144:145],v[48:51]
v_cvt_pk_bf16_f32 v72,v24,v28
v_cvt_pk_bf16_f32 v73,v25,v29
v_mfma_f32_16x16x16_bf16 v[52:55],v[126:127],v[146:147],v[52:55]
v_cvt_pk_bf16_f32 v74,v26,v30
v_cvt_pk_bf16_f32 v75,v27,v31
ds_write_b128 v3,v[72:75] offset:0
v_pk_mul_f32 v[32:33],v[32:33],v[148:149] op_sel_hi:[1,0]
v_pk_mul_f32 v[34:35],v[34:35],v[148:149] op_sel_hi:[1,0]
v_pk_mul_f32 v[36:37],v[36:37],v[148:149] op_sel_hi:[1,0]
v_pk_mul_f32 v[38:39],v[38:39],v[148:149] op_sel_hi:[1,0]
v_cvt_pk_bf16_f32 v76,v32,v36
v_cvt_pk_bf16_f32 v77,v33,v37
v_cvt_pk_bf16_f32 v78,v34,v38
v_cvt_pk_bf16_f32 v79,v35,v39
ds_write_b128 v3,v[76:79] offset:1024
s_waitcnt vmcnt(0)
v_cmp_gt_u32 vcc,s66,v17
v_pk_mul_f32 v[40:41],v[40:41],v[148:149] op_sel_hi:[1,0]
v_pk_mul_f32 v[42:43],v[42:43],v[148:149] op_sel_hi:[1,0]
v_pk_mul_f32 v[44:45],v[44:45],v[148:149] op_sel_hi:[1,0]
v_pk_mul_f32 v[46:47],v[46:47],v[148:149] op_sel_hi:[1,0]
s_cbranch_vccnz L_ap_107
L_apb_108:
s_xor_b32 s34,s69,524288
buffer_load_dwordx4 v[192:195],v7,s[8:11],s34 offen sc1
v_cvt_pk_bf16_f32 v80,v40,v44
v_cvt_pk_bf16_f32 v81,v41,v45
s_add_u32 s34,s34,4096
buffer_load_dwordx4 v[196:199],v7,s[8:11],s34 offen sc1
v_cvt_pk_bf16_f32 v82,v42,v46
v_cvt_pk_bf16_f32 v83,v43,v47
s_add_u32 s34,s34,4096
buffer_load_dwordx4 v[200:203],v7,s[8:11],s34 offen sc1
ds_write_b128 v3,v[80:83] offset:2048
v_pk_mul_f32 v[48:49],v[48:49],v[148:149] op_sel_hi:[1,0]
s_add_u32 s34,s34,4096
buffer_load_dwordx4 v[204:207],v7,s[8:11],s34 offen sc1
v_pk_mul_f32 v[50:51],v[50:51],v[148:149] op_sel_hi:[1,0]
v_pk_mul_f32 v[52:53],v[52:53],v[148:149] op_sel_hi:[1,0]
s_add_u32 s34,s34,4096
buffer_load_dwordx4 v[208:211],v7,s[8:11],s34 offen sc1
v_pk_mul_f32 v[54:55],v[54:55],v[148:149] op_sel_hi:[1,0]
v_cvt_pk_bf16_f32 v84,v48,v52
s_add_u32 s34,s34,4096
buffer_load_dwordx4 v[212:215],v7,s[8:11],s34 offen sc1
v_cvt_pk_bf16_f32 v85,v49,v53
v_cvt_pk_bf16_f32 v86,v50,v54
s_add_u32 s34,s34,4096
buffer_load_dwordx4 v[216:219],v7,s[8:11],s34 offen sc1
v_cvt_pk_bf16_f32 v87,v51,v55
ds_write_b128 v3,v[84:87] offset:3072
s_add_u32 s34,s34,4096
buffer_load_dwordx4 v[220:223],v7,s[8:11],s34 offen sc1
v_readlane_b32 s32,v18,0
v_readlane_b32 s33,v18,1
s_waitcnt lgkmcnt(0)
s_barrier
s_branch L_aa_76
L_ai_106:
v_max3_f32 v238,v128,v129,v130
v_max3_f32 v239,v131,v132,v133
v_max3_f32 v238,v134,v135,v238
v_max3_f32 v239,v138,v139,v239
v_max_f32 v238,v238,v239
v_max_f32 v239,v238,v239
s_nop 1
v_permlane16_swap_b32 v238,v239
v_max_f32 v238,v238,v239
v_max_f32 v239,v238,v239
s_nop 1
v_permlane32_swap_b32 v238,v239
v_max_f32 v238,v238,v239
v_mul_f32 v238,s80,v238
v_fma_f32 v128,v128,s80,-v238
v_fma_f32 v129,v129,s80,-v238
v_exp_f32 v128,v128
v_fma_f32 v130,v130,s80,-v238
v_exp_f32 v129,v129
v_fma_f32 v131,v131,s80,-v238
v_exp_f32 v130,v130
v_fma_f32 v132,v132,s80,-v238
v_exp_f32 v131,v131
v_fma_f32 v133,v133,s80,-v238
v_exp_f32 v132,v132
v_fma_f32 v134,v134,s80,-v238
v_exp_f32 v133,v133
v_fma_f32 v135,v135,s80,-v238
v_exp_f32 v134,v134
v_fma_f32 v138,v138,s80,-v238
v_exp_f32 v135,v135
v_fma_f32 v139,v139,s80,-v238
v_exp_f32 v138,v138
v_exp_f32 v139,v139
v_cvt_pk_bf16_f32 v140,v128,v129
v_cvt_pk_bf16_f32 v141,v130,v131
v_cvt_pk_bf16_f32 v142,v132,v133
v_cvt_pk_bf16_f32 v143,v134,v135
v_cvt_pk_bf16_f32 v144,v138,v139
v_mov_b32 v147,v144
v_mfma_f32_16x16x32_bf16 v[148:151],v[152:155],v[140:143],0
v_mfma_f32_16x16x32_bf16 v[24:27],v[88:91],v[140:143],0
v_mfma_f32_16x16x32_bf16 v[28:31],v[92:95],v[140:143],0
v_mfma_f32_16x16x16_bf16 v[148:151],v[152:153],v[144:145],v[148:151]
v_mfma_f32_16x16x32_bf16 v[32:35],v[96:99],v[140:143],0
v_mfma_f32_16x16x32_bf16 v[36:39],v[100:103],v[140:143],0
v_mfma_f32_16x16x32_bf16 v[40:43],v[104:107],v[140:143],0
v_mfma_f32_16x16x32_bf16 v[44:47],v[108:111],v[140:143],0
v_mfma_f32_16x16x32_bf16 v[48:51],v[112:115],v[140:143],0
v_mfma_f32_16x16x32_bf16 v[52:55],v[116:119],v[140:143],0
v_rcp_f32 v148,v148
v_mfma_f32_16x16x16_bf16 v[24:27],v[120:121],v[144:145],v[24:27]
v_mfma_f32_16x16x16_bf16 v[28:31],v[120:121],v[146:147],v[28:31]
v_mfma_f32_16x16x16_bf16 v[32:35],v[122:123],v[144:145],v[32:35]
v_mfma_f32_16x16x16_bf16 v[36:39],v[122:123],v[146:147],v[36:39]
v_mfma_f32_16x16x16_bf16 v[40:43],v[124:125],v[144:145],v[40:43]
v_pk_mul_f32 v[24:25],v[24:25],v[148:149] op_sel_hi:[1,0]
v_pk_mul_f32 v[26:27],v[26:27],v[148:149] op_sel_hi:[1,0]
v_mfma_f32_16x16x16_bf16 v[44:47],v[124:125],v[146:147],v[44:47]
v_pk_mul_f32 v[28:29],v[28:29],v[148:149] op_sel_hi:[1,0]
v_pk_mul_f32 v[30:31],v[30:31],v[148:149] op_sel_hi:[1,0]
v_mfma_f32_16x16x16_bf16 v[48:51],v[126:127],v[144:145],v[48:51]
v_cvt_pk_bf16_f32 v72,v24,v28
v_cvt_pk_bf16_f32 v73,v25,v29
v_mfma_f32_16x16x16_bf16 v[52:55],v[126:127],v[146:147],v[52:55]
v_cvt_pk_bf16_f32 v74,v26,v30
v_cvt_pk_bf16_f32 v75,v27,v31
ds_write_b128 v3,v[72:75] offset:0
v_pk_mul_f32 v[32:33],v[32:33],v[148:149] op_sel_hi:[1,0]
v_pk_mul_f32 v[34:35],v[34:35],v[148:149] op_sel_hi:[1,0]
v_pk_mul_f32 v[36:37],v[36:37],v[148:149] op_sel_hi:[1,0]
v_pk_mul_f32 v[38:39],v[38:39],v[148:149] op_sel_hi:[1,0]
v_cvt_pk_bf16_f32 v76,v32,v36
v_cvt_pk_bf16_f32 v77,v33,v37
v_cvt_pk_bf16_f32 v78,v34,v38
v_cvt_pk_bf16_f32 v79,v35,v39
ds_write_b128 v3,v[76:79] offset:1024
v_pk_mul_f32 v[40:41],v[40:41],v[148:149] op_sel_hi:[1,0]
v_pk_mul_f32 v[42:43],v[42:43],v[148:149] op_sel_hi:[1,0]
v_pk_mul_f32 v[44:45],v[44:45],v[148:149] op_sel_hi:[1,0]
v_pk_mul_f32 v[46:47],v[46:47],v[148:149] op_sel_hi:[1,0]
v_cvt_pk_bf16_f32 v80,v40,v44
v_cvt_pk_bf16_f32 v81,v41,v45
v_cvt_pk_bf16_f32 v82,v42,v46
v_cvt_pk_bf16_f32 v83,v43,v47
ds_write_b128 v3,v[80:83] offset:2048
v_pk_mul_f32 v[48:49],v[48:49],v[148:149] op_sel_hi:[1,0]
v_pk_mul_f32 v[50:51],v[50:51],v[148:149] op_sel_hi:[1,0]
v_pk_mul_f32 v[52:53],v[52:53],v[148:149] op_sel_hi:[1,0]
v_pk_mul_f32 v[54:55],v[54:55],v[148:149] op_sel_hi:[1,0]
v_cvt_pk_bf16_f32 v84,v48,v52
v_cvt_pk_bf16_f32 v85,v49,v53
v_cvt_pk_bf16_f32 v86,v50,v54
v_cvt_pk_bf16_f32 v87,v51,v55
ds_write_b128 v3,v[84:87] offset:3072
s_waitcnt vmcnt(0)
v_readlane_b32 s32,v18,0
v_readlane_b32 s33,v18,1
s_waitcnt lgkmcnt(0)
s_barrier
s_branch L_aa_63
L_aa_72:
s_cmp_lg_u32 s86,1536
s_cbranch_scc1 L_az_109
s_cmp_ge_u32 s35,66
s_cbranch_scc1 L_aa_62
v_subrev_u32 v248,s36,v1
v_and_b32 v248,0x80000003,v248
v_cmp_eq_u32 vcc,0,v248
v_lshlrev_b32 v248,2,v1
v_mov_b32 v249,0x40000000
v_cndmask_b32 v248,v249,v248,vcc
v_mov_b32 v249,3
s_or_b32 s59,s68,s46
s_mov_b32 s59,11018240
s_cmov_b32 s59,0x80000000
buffer_store_dword v249,v248,s[8:11],s59 offen sc1
L_aa_62:
s_waitcnt vmcnt(0)
buffer_store_dword v20,off,s[8:11],s73 sc1
s_mov_b32 s73,0x80000000
v_lshlrev_b32 v238,2,v1
v_add_u32 v248,155712,v238
s_cmp_lg_u32 s46,0
s_cbranch_scc1 L_an_110
s_lshl_b32 s59,s54,13
s_add_u32 s59,s59,11026432
L_fp_111:
s_sleep 1
buffer_load_dword v239,v238,s[8:11],s59 offen sc1
s_sub_u32 s49,s49,1
s_cbranch_scc1 L_abort
s_waitcnt vmcnt(0)
v_cmp_eq_u32 vcc,0,v239
s_cbranch_vccnz L_fp_111
ds_write_b32 v248,v239
s_waitcnt lgkmcnt(0)
L_an_110:
s_barrier
ds_read_b32 v239,v248
s_mov_b32 s86,768
s_mov_b32 s30,1
s_waitcnt lgkmcnt(0)
v_readfirstlane_b32 s55,v239
v_and_b32 v239,255,v239
s_lshr_b32 s55,s55,8
s_lshr_b32 s61,s55,5
v_cmp_ne_u32 s[38:39],3,v239
v_cmp_le_u32 vcc,s61,v1
s_nop 1
v_cndmask_b32 v238,1,2,vcc
v_cmp_ne_u32 s[84:85],v238,v239
s_bcnt1_i32_b64 s56,s[84:85]
s_nop 0
v_mbcnt_lo_u32_b32 v238,s84,0
v_mbcnt_hi_u32_b32 v238,s85,v238
s_mul_i32 s56,s56,14
s_add_u32 s56,s56,48
s_lshr_b32 s56,s56,7
s_lshl_b32 s56,s56,1
v_cmp_gt_u32 vcc,s56,v238
v_and_b32 v239,1,v238
v_and_b32 v238,3,v238
v_add_u32 v238,2,v238
v_cndmask_b32 v238,v238,v239,vcc
v_cmp_eq_u32 vcc,s54,v238
s_and_b64 s[84:85],s[84:85],vcc
s_ff1_i32_b64 s77,s[84:85]
s_bitset0_b64 s[84:85],s77
s_min_u32 s77,s77,64
s_lshl_b32 s56,s77,5
s_add_u32 s56,s56,s68
s_mul_i32 s70,s56,24576
s_lshl_b32 s71,s56,12
s_lshl_b32 s59,s77,13
s_lshl2_add_u32 s59,s68,s59
s_add_u32 s59,s59,10486144
s_cmp_lt_u32 s77,s61
s_cselect_b32 s57,0,16777216
s_cselect_b32 s60,0,128
s_add_u32 s60,s60,s59
s_add_u32 s60,s60,128
s_buffer_load_dword s33,s[8:11],s60
s_add_u32 s71,s71,s57
s_add_u32 s71,s71,58720256
s_cmp_eq_u32 s77,s61
s_cselect_b32 s57,50331648,0
s_cselect_b32 s58,1536,0
s_add_u32 s59,s59,s58
s_buffer_load_dword s32,s[8:11],s59
s_add_u32 s70,s70,s57
s_add_u32 s70,s70,150994944
v_mov_b32 v19,s59
v_writelane_b32 v19,s60,1
s_cmp_lt_u32 s77,64
s_cbranch_scc1 L_aa_70
L_az_109:
s_waitcnt vmcnt(0)
buffer_store_dword v20,off,s[8:11],s73 sc1
s_mov_b32 s73,0x80000000
s_endpgm
L_ag_78:
s_lshl_b32 s21,s26,13
s_lshl2_add_u32 s21,s68,s21
s_add_u32 s21,s21,10487296
L_ww_112:
buffer_load_dword v246,off,s[8:11],s21 sc1
s_sub_u32 s49,s49,1
s_cbranch_scc1 L_abort
s_waitcnt vmcnt(0)
v_readfirstlane_b32 s22,v246
s_cmp_eq_u32 s22,0
s_cbranch_scc1 L_ww_112
L_wwd_113:
s_branch L_agb_79
L_ap_85:
L_aw_114:
v_cmp_gt_u32 vcc,s66,v17
s_cbranch_vccz L_awd_115
buffer_load_dword v17,v16,s[8:11],s87 offen sc1
s_sub_u32 s49,s49,1
s_cbranch_scc1 L_abort
s_waitcnt vmcnt(0)
s_branch L_aw_114
L_awd_115:
s_branch L_apb_86
L_ag_94:
s_lshl_b32 s21,s51,13
s_lshl2_add_u32 s21,s68,s21
s_add_u32 s21,s21,10487296
L_ww_116:
buffer_load_dword v246,off,s[8:11],s21 sc1
s_sub_u32 s49,s49,1
s_cbranch_scc1 L_abort
s_waitcnt vmcnt(0)
v_readfirstlane_b32 s22,v246
s_cmp_eq_u32 s22,0
s_cbranch_scc1 L_ww_116
L_wwd_117:
s_branch L_agb_95
L_am_103:
v_subrev_u32 v248,s36,v1
v_and_b32 v248,0x80000003,v248
v_cmp_eq_u32 vcc,0,v248
v_lshlrev_b32 v248,2,v1
v_mov_b32 v249,0x40000000
v_cndmask_b32 v248,v249,v248,vcc
v_mov_b32 v249,3
s_or_b32 s59,s68,s46
s_mov_b32 s59,11018240
s_cmov_b32 s59,0x80000000
buffer_store_dword v249,v248,s[8:11],s59 offen sc1
s_branch L_ab_101
L_ap_107:
L_aw_118:
v_cmp_gt_u32 vcc,s66,v17
s_cbranch_vccz L_awd_119
buffer_load_dword v17,v16,s[8:11],s87 offen sc1
s_sub_u32 s49,s49,1
s_cbranch_scc1 L_abort
s_waitcnt vmcnt(0)
s_branch L_aw_118
L_awd_119:
s_branch L_apb_108
s_endpgm
L_rch_4:
v_and_b32 v2,15,v1
v_lshlrev_b32 v2,2,v2
v_lshrrev_b32 v3,4,v1
v_lshl_add_u32 v4,v3,16,v2
v_lshl_add_u32 v5,v3,12,v2
s_lshl_b32 s58,s47,8
s_lshl_b32 s57,s46,6
s_add_u32 s58,s58,s57
s_lshl_b32 s59,s47,17
s_add_u32 s59,s59,s57
s_lshl_b32 s60,s46,15
v_add_u32 v6,s60,v0
s_mov_b32 s61,0x05040100
s_mov_b32 s62,0x07060302
s_lshl_b32 s63,s46,19
s_cmp_lt_u32 s48,3
s_cselect_b32 s63,s63,0
s_mov_b32 s4,s26
s_mov_b32 s5,s27
s_mov_b32 s6,4194304
s_mov_b32 s7,0x20000
s_add_u32 s56,s59,0
buffer_load_dword v24,v5,s[4:7],s56 offen offset:0
buffer_load_dword v25,v5,s[4:7],s56 offen offset:1024
buffer_load_dword v26,v5,s[4:7],s56 offen offset:2048
buffer_load_dword v27,v5,s[4:7],s56 offen offset:3072
s_add_u32 s56,s59,16384
buffer_load_dword v28,v5,s[4:7],s56 offen offset:0
buffer_load_dword v29,v5,s[4:7],s56 offen offset:1024
buffer_load_dword v30,v5,s[4:7],s56 offen offset:2048
buffer_load_dword v31,v5,s[4:7],s56 offen offset:3072
s_add_u32 s56,s59,32768
buffer_load_dword v32,v5,s[4:7],s56 offen offset:0
buffer_load_dword v33,v5,s[4:7],s56 offen offset:1024
buffer_load_dword v34,v5,s[4:7],s56 offen offset:2048
buffer_load_dword v35,v5,s[4:7],s56 offen offset:3072
s_add_u32 s56,s59,49152
buffer_load_dword v36,v5,s[4:7],s56 offen offset:0
buffer_load_dword v37,v5,s[4:7],s56 offen offset:1024
buffer_load_dword v38,v5,s[4:7],s56 offen offset:2048
buffer_load_dword v39,v5,s[4:7],s56 offen offset:3072
s_add_u32 s56,s59,65536
buffer_load_dword v40,v5,s[4:7],s56 offen offset:0
buffer_load_dword v41,v5,s[4:7],s56 offen offset:1024
buffer_load_dword v42,v5,s[4:7],s56 offen offset:2048
buffer_load_dword v43,v5,s[4:7],s56 offen offset:3072
s_add_u32 s56,s59,81920
buffer_load_dword v44,v5,s[4:7],s56 offen offset:0
buffer_load_dword v45,v5,s[4:7],s56 offen offset:1024
buffer_load_dword v46,v5,s[4:7],s56 offen offset:2048
buffer_load_dword v47,v5,s[4:7],s56 offen offset:3072
s_add_u32 s56,s59,98304
buffer_load_dword v48,v5,s[4:7],s56 offen offset:0
buffer_load_dword v49,v5,s[4:7],s56 offen offset:1024
buffer_load_dword v50,v5,s[4:7],s56 offen offset:2048
buffer_load_dword v51,v5,s[4:7],s56 offen offset:3072
s_add_u32 s56,s59,114688
buffer_load_dword v52,v5,s[4:7],s56 offen offset:0
buffer_load_dword v53,v5,s[4:7],s56 offen offset:1024
buffer_load_dword v54,v5,s[4:7],s56 offen offset:2048
buffer_load_dword v55,v5,s[4:7],s56 offen offset:3072
s_add_u32 s56,s59,256
buffer_load_dword v56,v5,s[4:7],s56 offen offset:0
buffer_load_dword v57,v5,s[4:7],s56 offen offset:1024
buffer_load_dword v58,v5,s[4:7],s56 offen offset:2048
buffer_load_dword v59,v5,s[4:7],s56 offen offset:3072
s_add_u32 s56,s59,16640
buffer_load_dword v60,v5,s[4:7],s56 offen offset:0
buffer_load_dword v61,v5,s[4:7],s56 offen offset:1024
buffer_load_dword v62,v5,s[4:7],s56 offen offset:2048
buffer_load_dword v63,v5,s[4:7],s56 offen offset:3072
s_add_u32 s56,s59,33024
buffer_load_dword v64,v5,s[4:7],s56 offen offset:0
buffer_load_dword v65,v5,s[4:7],s56 offen offset:1024
buffer_load_dword v66,v5,s[4:7],s56 offen offset:2048
buffer_load_dword v67,v5,s[4:7],s56 offen offset:3072
s_add_u32 s56,s59,49408
buffer_load_dword v68,v5,s[4:7],s56 offen offset:0
buffer_load_dword v69,v5,s[4:7],s56 offen offset:1024
buffer_load_dword v70,v5,s[4:7],s56 offen offset:2048
buffer_load_dword v71,v5,s[4:7],s56 offen offset:3072
s_add_u32 s56,s59,65792
buffer_load_dword v72,v5,s[4:7],s56 offen offset:0
buffer_load_dword v73,v5,s[4:7],s56 offen offset:1024
buffer_load_dword v74,v5,s[4:7],s56 offen offset:2048
buffer_load_dword v75,v5,s[4:7],s56 offen offset:3072
s_add_u32 s56,s59,82176
buffer_load_dword v76,v5,s[4:7],s56 offen offset:0
buffer_load_dword v77,v5,s[4:7],s56 offen offset:1024
buffer_load_dword v78,v5,s[4:7],s56 offen offset:2048
buffer_load_dword v79,v5,s[4:7],s56 offen offset:3072
s_waitcnt vmcnt(48)
ds_write_b128 v6,v[24:27] offset:0
ds_write_b128 v6,v[28:31] offset:1024
s_waitcnt lgkmcnt(0)
s_add_u32 s56,s59,98560
buffer_load_dword v24,v5,s[4:7],s56 offen offset:0
buffer_load_dword v25,v5,s[4:7],s56 offen offset:1024
buffer_load_dword v26,v5,s[4:7],s56 offen offset:2048
buffer_load_dword v27,v5,s[4:7],s56 offen offset:3072
s_add_u32 s56,s59,114944
buffer_load_dword v28,v5,s[4:7],s56 offen offset:0
buffer_load_dword v29,v5,s[4:7],s56 offen offset:1024
buffer_load_dword v30,v5,s[4:7],s56 offen offset:2048
buffer_load_dword v31,v5,s[4:7],s56 offen offset:3072
s_waitcnt vmcnt(48)
ds_write_b128 v6,v[32:35] offset:2048
ds_write_b128 v6,v[36:39] offset:3072
s_waitcnt lgkmcnt(0)
s_add_u32 s56,s59,512
buffer_load_dword v32,v5,s[4:7],s56 offen offset:0
buffer_load_dword v33,v5,s[4:7],s56 offen offset:1024
buffer_load_dword v34,v5,s[4:7],s56 offen offset:2048
buffer_load_dword v35,v5,s[4:7],s56 offen offset:3072
s_add_u32 s56,s59,16896
buffer_load_dword v36,v5,s[4:7],s56 offen offset:0
buffer_load_dword v37,v5,s[4:7],s56 offen offset:1024
buffer_load_dword v38,v5,s[4:7],s56 offen offset:2048
buffer_load_dword v39,v5,s[4:7],s56 offen offset:3072
s_waitcnt vmcnt(48)
ds_write_b128 v6,v[40:43] offset:4096
ds_write_b128 v6,v[44:47] offset:5120
s_waitcnt lgkmcnt(0)
s_add_u32 s56,s59,33280
buffer_load_dword v40,v5,s[4:7],s56 offen offset:0
buffer_load_dword v41,v5,s[4:7],s56 offen offset:1024
buffer_load_dword v42,v5,s[4:7],s56 offen offset:2048
buffer_load_dword v43,v5,s[4:7],s56 offen offset:3072
s_add_u32 s56,s59,49664
buffer_load_dword v44,v5,s[4:7],s56 offen offset:0
buffer_load_dword v45,v5,s[4:7],s56 offen offset:1024
buffer_load_dword v46,v5,s[4:7],s56 offen offset:2048
buffer_load_dword v47,v5,s[4:7],s56 offen offset:3072
s_waitcnt vmcnt(48)
ds_write_b128 v6,v[48:51] offset:6144
ds_write_b128 v6,v[52:55] offset:7168
s_waitcnt lgkmcnt(0)
s_add_u32 s56,s59,66048
buffer_load_dword v48,v5,s[4:7],s56 offen offset:0
buffer_load_dword v49,v5,s[4:7],s56 offen offset:1024
buffer_load_dword v50,v5,s[4:7],s56 offen offset:2048
buffer_load_dword v51,v5,s[4:7],s56 offen offset:3072
s_add_u32 s56,s59,82432
buffer_load_dword v52,v5,s[4:7],s56 offen offset:0
buffer_load_dword v53,v5,s[4:7],s56 offen offset:1024
buffer_load_dword v54,v5,s[4:7],s56 offen offset:2048
buffer_load_dword v55,v5,s[4:7],s56 offen offset:3072
s_waitcnt vmcnt(48)
ds_write_b128 v6,v[56:59] offset:8192
ds_write_b128 v6,v[60:63] offset:9216
s_waitcnt lgkmcnt(0)
s_add_u32 s56,s59,98816
buffer_load_dword v56,v5,s[4:7],s56 offen offset:0
buffer_load_dword v57,v5,s[4:7],s56 offen offset:1024
buffer_load_dword v58,v5,s[4:7],s56 offen offset:2048
buffer_load_dword v59,v5,s[4:7],s56 offen offset:3072
s_add_u32 s56,s59,115200
buffer_load_dword v60,v5,s[4:7],s56 offen offset:0
buffer_load_dword v61,v5,s[4:7],s56 offen offset:1024
buffer_load_dword v62,v5,s[4:7],s56 offen offset:2048
buffer_load_dword v63,v5,s[4:7],s56 offen offset:3072
s_waitcnt vmcnt(48)
ds_write_b128 v6,v[64:67] offset:10240
ds_write_b128 v6,v[68:71] offset:11264
s_waitcnt lgkmcnt(0)
s_add_u32 s56,s59,768
buffer_load_dword v64,v5,s[4:7],s56 offen offset:0
buffer_load_dword v65,v5,s[4:7],s56 offen offset:1024
buffer_load_dword v66,v5,s[4:7],s56 offen offset:2048
buffer_load_dword v67,v5,s[4:7],s56 offen offset:3072
s_add_u32 s56,s59,17152
buffer_load_dword v68,v5,s[4:7],s56 offen offset:0
buffer_load_dword v69,v5,s[4:7],s56 offen offset:1024
buffer_load_dword v70,v5,s[4:7],s56 offen offset:2048
buffer_load_dword v71,v5,s[4:7],s56 offen offset:3072
s_waitcnt vmcnt(48)
ds_write_b128 v6,v[72:75] offset:12288
ds_write_b128 v6,v[76:79] offset:13312
s_waitcnt lgkmcnt(0)
s_add_u32 s56,s59,33536
buffer_load_dword v72,v5,s[4:7],s56 offen offset:0
buffer_load_dword v73,v5,s[4:7],s56 offen offset:1024
buffer_load_dword v74,v5,s[4:7],s56 offen offset:2048
buffer_load_dword v75,v5,s[4:7],s56 offen offset:3072
s_add_u32 s56,s59,49920
buffer_load_dword v76,v5,s[4:7],s56 offen offset:0
buffer_load_dword v77,v5,s[4:7],s56 offen offset:1024
buffer_load_dword v78,v5,s[4:7],s56 offen offset:2048
buffer_load_dword v79,v5,s[4:7],s56 offen offset:3072
s_waitcnt vmcnt(48)
ds_write_b128 v6,v[24:27] offset:14336
ds_write_b128 v6,v[28:31] offset:15360
s_waitcnt lgkmcnt(0)
s_add_u32 s56,s59,66304
buffer_load_dword v24,v5,s[4:7],s56 offen offset:0
buffer_load_dword v25,v5,s[4:7],s56 offen offset:1024
buffer_load_dword v26,v5,s[4:7],s56 offen offset:2048
buffer_load_dword v27,v5,s[4:7],s56 offen offset:3072
s_add_u32 s56,s59,82688
buffer_load_dword v28,v5,s[4:7],s56 offen offset:0
buffer_load_dword v29,v5,s[4:7],s56 offen offset:1024
buffer_load_dword v30,v5,s[4:7],s56 offen offset:2048
buffer_load_dword v31,v5,s[4:7],s56 offen offset:3072
s_waitcnt vmcnt(48)
ds_write_b128 v6,v[32:35] offset:16384
ds_write_b128 v6,v[36:39] offset:17408
s_waitcnt lgkmcnt(0)
s_add_u32 s56,s59,99072
buffer_load_dword v32,v5,s[4:7],s56 offen offset:0
buffer_load_dword v33,v5,s[4:7],s56 offen offset:1024
buffer_load_dword v34,v5,s[4:7],s56 offen offset:2048
buffer_load_dword v35,v5,s[4:7],s56 offen offset:3072
s_add_u32 s56,s59,115456
buffer_load_dword v36,v5,s[4:7],s56 offen offset:0
buffer_load_dword v37,v5,s[4:7],s56 offen offset:1024
buffer_load_dword v38,v5,s[4:7],s56 offen offset:2048
buffer_load_dword v39,v5,s[4:7],s56 offen offset:3072
s_waitcnt vmcnt(48)
ds_write_b128 v6,v[40:43] offset:18432
ds_write_b128 v6,v[44:47] offset:19456
s_waitcnt lgkmcnt(0)
s_waitcnt vmcnt(40)
ds_write_b128 v6,v[48:51] offset:20480
ds_write_b128 v6,v[52:55] offset:21504
s_waitcnt lgkmcnt(0)
s_waitcnt vmcnt(32)
ds_write_b128 v6,v[56:59] offset:22528
ds_write_b128 v6,v[60:63] offset:23552
s_waitcnt lgkmcnt(0)
s_waitcnt vmcnt(24)
ds_write_b128 v6,v[64:67] offset:24576
ds_write_b128 v6,v[68:71] offset:25600
s_waitcnt lgkmcnt(0)
s_waitcnt vmcnt(16)
ds_write_b128 v6,v[72:75] offset:26624
ds_write_b128 v6,v[76:79] offset:27648
s_waitcnt lgkmcnt(0)
s_waitcnt vmcnt(8)
ds_write_b128 v6,v[24:27] offset:28672
ds_write_b128 v6,v[28:31] offset:29696
s_waitcnt lgkmcnt(0)
s_waitcnt vmcnt(0)
ds_write_b128 v6,v[32:35] offset:30720
ds_write_b128 v6,v[36:39] offset:31744
s_waitcnt lgkmcnt(0)
v_mov_b32 v123,159744
s_cmp_lg_u32 s46,0
s_cbranch_scc1 L_gbd_121
v_mov_b32 v124,128
L_gb_120:
buffer_load_dword v125,v124,s[12:15],0 offen sc1
s_waitcnt vmcnt(0)
v_readfirstlane_b32 s56,v125
ds_write_b32 v123,v125
s_bitcmp1_b32 s56,8
s_cbranch_scc1 L_gbd_121
s_sleep 4
s_sub_u32 s49,s49,1
s_cmp_gt_i32 s49,0
s_cbranch_scc1 L_gb_120
s_branch L_abort
L_gbd_121:
s_waitcnt lgkmcnt(0)
s_barrier
ds_read_b32 v125,v123
s_waitcnt lgkmcnt(0)
v_readfirstlane_b32 s56,v125
s_barrier
s_lshr_b32 s56,s56,16
s_andn2_b32 s56,s56,s3
s_cbranch_scc1 L_spread
s_cmp_eq_u32 s48,0
s_cbranch_scc1 L_chd_122
v_and_b32 v120,15,v1
v_lshrrev_b32 v121,4,v1
v_mov_b32 v17,1
s_lshl_b32 s56,s46,2
v_add_u32 v125,s56,v121
v_xor_b32 v126,v125,v120
v_lshlrev_b32 v126,4,v126
v_lshl_add_u32 v20,v125,10,v126
s_lshl_b32 s56,s46,1
s_xor_b32 s56,s56,0
s_and_b32 s57,s56,3
s_lshl_b32 s57,s57,2
s_lshr_b32 s56,s56,2
s_lshl_b32 s56,s56,13
s_add_u32 s56,s56,131072
v_add_u32 v125,s57,v121
v_xor_b32 v125,v125,v120
v_lshlrev_b32 v125,4,v125
v_lshl_add_u32 v125,v120,8,v125
v_add_u32 v4,s56,v125
s_lshl_b32 s56,s46,1
s_xor_b32 s56,s56,1
s_and_b32 s57,s56,3
s_lshl_b32 s57,s57,2
s_lshr_b32 s56,s56,2
s_lshl_b32 s56,s56,13
s_add_u32 s56,s56,131072
v_add_u32 v125,s57,v121
v_xor_b32 v125,v125,v120
v_lshlrev_b32 v125,4,v125
v_lshl_add_u32 v125,v120,8,v125
v_add_u32 v5,s56,v125
s_lshl_b32 s56,s46,1
s_xor_b32 s56,s56,2
s_and_b32 s57,s56,3
s_lshl_b32 s57,s57,2
s_lshr_b32 s56,s56,2
s_lshl_b32 s56,s56,13
s_add_u32 s56,s56,131072
v_add_u32 v125,s57,v121
v_xor_b32 v125,v125,v120
v_lshlrev_b32 v125,4,v125
v_lshl_add_u32 v125,v120,8,v125
v_add_u32 v6,s56,v125
s_lshl_b32 s56,s46,1
s_xor_b32 s56,s56,3
s_and_b32 s57,s56,3
s_lshl_b32 s57,s57,2
s_lshr_b32 s56,s56,2
s_lshl_b32 s56,s56,13
s_add_u32 s56,s56,131072
v_add_u32 v125,s57,v121
v_xor_b32 v125,v125,v120
v_lshlrev_b32 v125,4,v125
v_lshl_add_u32 v125,v120,8,v125
v_add_u32 v7,s56,v125
s_lshl_b32 s56,s46,1
s_xor_b32 s56,s56,4
s_and_b32 s57,s56,3
s_lshl_b32 s57,s57,2
s_lshr_b32 s56,s56,2
s_lshl_b32 s56,s56,13
s_add_u32 s56,s56,131072
v_add_u32 v125,s57,v121
v_xor_b32 v125,v125,v120
v_lshlrev_b32 v125,4,v125
v_lshl_add_u32 v125,v120,8,v125
v_add_u32 v8,s56,v125
s_lshl_b32 s56,s46,1
s_xor_b32 s56,s56,5
s_and_b32 s57,s56,3
s_lshl_b32 s57,s57,2
s_lshr_b32 s56,s56,2
s_lshl_b32 s56,s56,13
s_add_u32 s56,s56,131072
v_add_u32 v125,s57,v121
v_xor_b32 v125,v125,v120
v_lshlrev_b32 v125,4,v125
v_lshl_add_u32 v125,v120,8,v125
v_add_u32 v9,s56,v125
s_lshl_b32 s56,s46,1
s_xor_b32 s56,s56,6
s_and_b32 s57,s56,3
s_lshl_b32 s57,s57,2
s_lshr_b32 s56,s56,2
s_lshl_b32 s56,s56,13
s_add_u32 s56,s56,131072
v_add_u32 v125,s57,v121
v_xor_b32 v125,v125,v120
v_lshlrev_b32 v125,4,v125
v_lshl_add_u32 v125,v120,8,v125
v_add_u32 v10,s56,v125
s_lshl_b32 s56,s46,1
s_xor_b32 s56,s56,7
s_and_b32 s57,s56,3
s_lshl_b32 s57,s57,2
s_lshr_b32 s56,s56,2
s_lshl_b32 s56,s56,13
s_add_u32 s56,s56,131072
v_add_u32 v125,s57,v121
v_xor_b32 v125,v125,v120
v_lshlrev_b32 v125,4,v125
v_lshl_add_u32 v125,v120,8,v125
v_add_u32 v11,s56,v125
s_cmp_eq_u32 s48,1
s_cselect_b32 s51,16,20
s_cselect_b32 s53,4,5
s_mov_b32 s72,0x80000000
s_lshl_b32 s70,s51,15
s_add_u32 s70,s70,0
s_add_u32 s71,s70,16384
s_add_u32 m0,s50,131072
s_nop 0
buffer_load_dwordx4 v20,s[8:11],s70 offen offset:0 sc1 lds
s_add_u32 m0,s50,135168
s_nop 0
buffer_load_dwordx4 v20,s[8:11],s71 offen offset:0 sc1 lds
s_add_u32 m0,s50,139008
s_nop 0
buffer_load_dwordx4 v20,s[8:11],s70 offen offset:256 sc1 lds
s_add_u32 m0,s50,143104
s_nop 0
buffer_load_dwordx4 v20,s[8:11],s71 offen offset:256 sc1 lds
s_waitcnt vmcnt(0)
L_chl_123:
s_mov_b64 s[68:69],s[70:71]
s_add_u32 s70,s70,32768
s_add_u32 s71,s71,32768
s_lshl_b32 s58,s51,5
s_add_u32 s58,s58,s47
s_mul_i32 s58,s58,24576
s_add_u32 s58,s58,100663296
s_add_u32 s61,s58,s50
s_add_u32 s62,s61,4096
s_add_u32 s63,s61,16384
s_add_u32 s64,s61,20480
s_add_u32 s65,s61,s50
s_add_u32 s65,s65,8192
s_waitcnt vmcnt(7)
s_barrier
ds_read_b128 v[72:75],v4 offset:0
ds_read_b128 v[76:79],v4 offset:4096
ds_read_b128 v[80:83],v5 offset:0
ds_read_b128 v[84:87],v5 offset:4096
s_add_u32 m0,s50,146944
s_nop 0
buffer_load_dwordx4 v20,s[8:11],s68 offen offset:512 sc1 lds
s_add_u32 m0,s50,151040
s_nop 0
buffer_load_dwordx4 v20,s[8:11],s69 offen offset:512 sc1 lds
s_add_u32 m0,s50,154880
s_nop 0
buffer_load_dwordx4 v20,s[8:11],s68 offen offset:768 sc1 lds
s_add_u32 m0,s50,158976
s_nop 0
buffer_load_dwordx4 v20,s[8:11],s69 offen offset:768 sc1 lds
s_waitcnt lgkmcnt(2)
v_mfma_f32_16x16x32_bf16 v[40:43],a[128:131],v[72:75],0
ds_read_b128 v[108:111],v6 offset:0
v_mfma_f32_16x16x32_bf16 v[56:59],v[72:75],v[128:131],0
v_mfma_f32_16x16x32_bf16 v[24:27],a[0:3],v[72:75],0
ds_read_b128 v[112:115],v6 offset:4096
v_mfma_f32_16x16x32_bf16 v[44:47],a[128:131],v[76:79],0
v_mfma_f32_16x16x32_bf16 v[60:63],v[76:79],v[128:131],0
v_mfma_f32_16x16x32_bf16 v[28:31],a[0:3],v[76:79],0
v_mfma_f32_16x16x32_bf16 v[48:51],a[136:139],v[72:75],0
v_mfma_f32_16x16x32_bf16 v[64:67],v[72:75],v[136:139],0
v_mfma_f32_16x16x32_bf16 v[32:35],a[8:11],v[72:75],0
v_mfma_f32_16x16x32_bf16 v[52:55],a[136:139],v[76:79],0
v_mfma_f32_16x16x32_bf16 v[68:71],v[76:79],v[136:139],0
v_mfma_f32_16x16x32_bf16 v[36:39],a[8:11],v[76:79],0
s_waitcnt lgkmcnt(2)
v_mfma_f32_16x16x32_bf16 v[40:43],a[132:135],v[80:83],v[40:43]
ds_read_b128 v[72:75],v7 offset:0
v_mfma_f32_16x16x32_bf16 v[56:59],v[80:83],v[132:135],v[56:59]
v_mfma_f32_16x16x32_bf16 v[24:27],a[4:7],v[80:83],v[24:27]
ds_read_b128 v[76:79],v7 offset:4096
v_mfma_f32_16x16x32_bf16 v[44:47],a[132:135],v[84:87],v[44:47]
v_mfma_f32_16x16x32_bf16 v[60:63],v[84:87],v[132:135],v[60:63]
v_mfma_f32_16x16x32_bf16 v[28:31],a[4:7],v[84:87],v[28:31]
v_mfma_f32_16x16x32_bf16 v[48:51],a[140:143],v[80:83],v[48:51]
v_mfma_f32_16x16x32_bf16 v[64:67],v[80:83],v[140:143],v[64:67]
v_mfma_f32_16x16x32_bf16 v[32:35],a[12:15],v[80:83],v[32:35]
v_mfma_f32_16x16x32_bf16 v[52:55],a[140:143],v[84:87],v[52:55]
v_mfma_f32_16x16x32_bf16 v[68:71],v[84:87],v[140:143],v[68:71]
v_mfma_f32_16x16x32_bf16 v[36:39],a[12:15],v[84:87],v[36:39]
s_waitcnt lgkmcnt(2)
v_mfma_f32_16x16x32_bf16 v[40:43],a[144:147],v[108:111],v[40:43]
ds_read_b128 v[80:83],v8 offset:0
v_mfma_f32_16x16x32_bf16 v[56:59],v[108:111],v[144:147],v[56:59]
v_mfma_f32_16x16x32_bf16 v[24:27],a[16:19],v[108:111],v[24:27]
ds_read_b128 v[84:87],v8 offset:4096
v_mfma_f32_16x16x32_bf16 v[44:47],a[144:147],v[112:115],v[44:47]
v_mfma_f32_16x16x32_bf16 v[60:63],v[112:115],v[144:147],v[60:63]
v_mfma_f32_16x16x32_bf16 v[28:31],a[16:19],v[112:115],v[28:31]
v_mfma_f32_16x16x32_bf16 v[48:51],a[152:155],v[108:111],v[48:51]
v_mfma_f32_16x16x32_bf16 v[64:67],v[108:111],v[152:155],v[64:67]
v_mfma_f32_16x16x32_bf16 v[32:35],a[24:27],v[108:111],v[32:35]
v_mfma_f32_16x16x32_bf16 v[52:55],a[152:155],v[112:115],v[52:55]
v_mfma_f32_16x16x32_bf16 v[68:71],v[112:115],v[152:155],v[68:71]
v_mfma_f32_16x16x32_bf16 v[36:39],a[24:27],v[112:115],v[36:39]
s_waitcnt lgkmcnt(2)
v_mfma_f32_16x16x32_bf16 v[40:43],a[148:151],v[72:75],v[40:43]
ds_read_b128 v[108:111],v9 offset:0
v_mfma_f32_16x16x32_bf16 v[56:59],v[72:75],v[148:151],v[56:59]
v_mfma_f32_16x16x32_bf16 v[24:27],a[20:23],v[72:75],v[24:27]
ds_read_b128 v[112:115],v9 offset:4096
v_mfma_f32_16x16x32_bf16 v[44:47],a[148:151],v[76:79],v[44:47]
v_mfma_f32_16x16x32_bf16 v[60:63],v[76:79],v[148:151],v[60:63]
v_mfma_f32_16x16x32_bf16 v[28:31],a[20:23],v[76:79],v[28:31]
v_mfma_f32_16x16x32_bf16 v[48:51],a[156:159],v[72:75],v[48:51]
v_mfma_f32_16x16x32_bf16 v[64:67],v[72:75],v[156:159],v[64:67]
v_mfma_f32_16x16x32_bf16 v[32:35],a[28:31],v[72:75],v[32:35]
v_mfma_f32_16x16x32_bf16 v[52:55],a[156:159],v[76:79],v[52:55]
v_mfma_f32_16x16x32_bf16 v[68:71],v[76:79],v[156:159],v[68:71]
v_mfma_f32_16x16x32_bf16 v[36:39],a[28:31],v[76:79],v[36:39]
s_waitcnt lgkmcnt(2)
v_mfma_f32_16x16x32_bf16 v[40:43],a[160:163],v[80:83],v[40:43]
ds_read_b128 v[72:75],v10 offset:0
v_mfma_f32_16x16x32_bf16 v[56:59],v[80:83],v[160:163],v[56:59]
v_mfma_f32_16x16x32_bf16 v[24:27],a[32:35],v[80:83],v[24:27]
ds_read_b128 v[76:79],v10 offset:4096
v_mfma_f32_16x16x32_bf16 v[44:47],a[160:163],v[84:87],v[44:47]
v_mfma_f32_16x16x32_bf16 v[60:63],v[84:87],v[160:163],v[60:63]
v_mfma_f32_16x16x32_bf16 v[28:31],a[32:35],v[84:87],v[28:31]
v_mfma_f32_16x16x32_bf16 v[48:51],a[168:171],v[80:83],v[48:51]
v_mfma_f32_16x16x32_bf16 v[64:67],v[80:83],v[168:171],v[64:67]
v_mfma_f32_16x16x32_bf16 v[32:35],a[40:43],v[80:83],v[32:35]
v_mfma_f32_16x16x32_bf16 v[52:55],a[168:171],v[84:87],v[52:55]
v_mfma_f32_16x16x32_bf16 v[68:71],v[84:87],v[168:171],v[68:71]
v_mfma_f32_16x16x32_bf16 v[36:39],a[40:43],v[84:87],v[36:39]
s_waitcnt lgkmcnt(2)
v_mfma_f32_16x16x32_bf16 v[40:43],a[164:167],v[108:111],v[40:43]
ds_read_b128 v[80:83],v11 offset:0
v_mfma_f32_16x16x32_bf16 v[56:59],v[108:111],v[164:167],v[56:59]
v_mfma_f32_16x16x32_bf16 v[24:27],a[36:39],v[108:111],v[24:27]
ds_read_b128 v[84:87],v11 offset:4096
v_mfma_f32_16x16x32_bf16 v[44:47],a[164:167],v[112:115],v[44:47]
v_mfma_f32_16x16x32_bf16 v[60:63],v[112:115],v[164:167],v[60:63]
v_mfma_f32_16x16x32_bf16 v[28:31],a[36:39],v[112:115],v[28:31]
v_mfma_f32_16x16x32_bf16 v[48:51],a[172:175],v[108:111],v[48:51]
v_mfma_f32_16x16x32_bf16 v[64:67],v[108:111],v[172:175],v[64:67]
v_mfma_f32_16x16x32_bf16 v[32:35],a[44:47],v[108:111],v[32:35]
v_mfma_f32_16x16x32_bf16 v[52:55],a[172:175],v[112:115],v[52:55]
v_mfma_f32_16x16x32_bf16 v[68:71],v[112:115],v[172:175],v[68:71]
v_mfma_f32_16x16x32_bf16 v[36:39],a[44:47],v[112:115],v[36:39]
s_waitcnt vmcnt(0)
s_barrier
s_or_b32 s72,s72,s52
buffer_store_dword v17,off,s[8:11],s72 sc1
s_waitcnt lgkmcnt(2)
v_mfma_f32_16x16x32_bf16 v[40:43],a[176:179],v[72:75],v[40:43]
ds_read_b128 v[108:111],v4 offset:16384
v_mfma_f32_16x16x32_bf16 v[56:59],v[72:75],v[176:179],v[56:59]
v_mfma_f32_16x16x32_bf16 v[24:27],a[48:51],v[72:75],v[24:27]
ds_read_b128 v[112:115],v4 offset:20480
v_mfma_f32_16x16x32_bf16 v[44:47],a[176:179],v[76:79],v[44:47]
v_mfma_f32_16x16x32_bf16 v[60:63],v[76:79],v[176:179],v[60:63]
v_mfma_f32_16x16x32_bf16 v[28:31],a[48:51],v[76:79],v[28:31]
v_mfma_f32_16x16x32_bf16 v[48:51],a[184:187],v[72:75],v[48:51]
v_mfma_f32_16x16x32_bf16 v[64:67],v[72:75],v[184:187],v[64:67]
v_mfma_f32_16x16x32_bf16 v[32:35],a[56:59],v[72:75],v[32:35]
v_mfma_f32_16x16x32_bf16 v[52:55],a[184:187],v[76:79],v[52:55]
v_mfma_f32_16x16x32_bf16 v[68:71],v[76:79],v[184:187],v[68:71]
v_mfma_f32_16x16x32_bf16 v[36:39],a[56:59],v[76:79],v[36:39]
s_waitcnt lgkmcnt(2)
v_mfma_f32_16x16x32_bf16 v[40:43],a[180:183],v[80:83],v[40:43]
ds_read_b128 v[72:75],v5 offset:16384
v_mfma_f32_16x16x32_bf16 v[56:59],v[80:83],v[180:183],v[56:59]
v_mfma_f32_16x16x32_bf16 v[24:27],a[52:55],v[80:83],v[24:27]
ds_read_b128 v[76:79],v5 offset:20480
v_mfma_f32_16x16x32_bf16 v[44:47],a[180:183],v[84:87],v[44:47]
v_mfma_f32_16x16x32_bf16 v[60:63],v[84:87],v[180:183],v[60:63]
v_mfma_f32_16x16x32_bf16 v[28:31],a[52:55],v[84:87],v[28:31]
v_mfma_f32_16x16x32_bf16 v[48:51],a[188:191],v[80:83],v[48:51]
v_mfma_f32_16x16x32_bf16 v[64:67],v[80:83],v[188:191],v[64:67]
v_mfma_f32_16x16x32_bf16 v[32:35],a[60:63],v[80:83],v[32:35]
v_mfma_f32_16x16x32_bf16 v[52:55],a[188:191],v[84:87],v[52:55]
v_mfma_f32_16x16x32_bf16 v[68:71],v[84:87],v[188:191],v[68:71]
v_mfma_f32_16x16x32_bf16 v[36:39],a[60:63],v[84:87],v[36:39]
s_waitcnt lgkmcnt(2)
v_mfma_f32_16x16x32_bf16 v[40:43],a[192:195],v[108:111],v[40:43]
ds_read_b128 v[80:83],v6 offset:16384
v_mfma_f32_16x16x32_bf16 v[56:59],v[108:111],v[192:195],v[56:59]
v_mfma_f32_16x16x32_bf16 v[24:27],a[64:67],v[108:111],v[24:27]
ds_read_b128 v[84:87],v6 offset:20480
v_mfma_f32_16x16x32_bf16 v[44:47],a[192:195],v[112:115],v[44:47]
v_mfma_f32_16x16x32_bf16 v[60:63],v[112:115],v[192:195],v[60:63]
v_mfma_f32_16x16x32_bf16 v[28:31],a[64:67],v[112:115],v[28:31]
v_mfma_f32_16x16x32_bf16 v[48:51],a[200:203],v[108:111],v[48:51]
v_mfma_f32_16x16x32_bf16 v[64:67],v[108:111],v[200:203],v[64:67]
v_mfma_f32_16x16x32_bf16 v[32:35],a[72:75],v[108:111],v[32:35]
v_mfma_f32_16x16x32_bf16 v[52:55],a[200:203],v[112:115],v[52:55]
v_mfma_f32_16x16x32_bf16 v[68:71],v[112:115],v[200:203],v[68:71]
v_mfma_f32_16x16x32_bf16 v[36:39],a[72:75],v[112:115],v[36:39]
s_waitcnt lgkmcnt(2)
v_mfma_f32_16x16x32_bf16 v[40:43],a[196:199],v[72:75],v[40:43]
ds_read_b128 v[108:111],v7 offset:16384
v_mfma_f32_16x16x32_bf16 v[56:59],v[72:75],v[196:199],v[56:59]
v_mfma_f32_16x16x32_bf16 v[24:27],a[68:71],v[72:75],v[24:27]
ds_read_b128 v[112:115],v7 offset:20480
v_mfma_f32_16x16x32_bf16 v[44:47],a[196:199],v[76:79],v[44:47]
v_mfma_f32_16x16x32_bf16 v[60:63],v[76:79],v[196:199],v[60:63]
v_mfma_f32_16x16x32_bf16 v[28:31],a[68:71],v[76:79],v[28:31]
v_mfma_f32_16x16x32_bf16 v[48:51],a[204:207],v[72:75],v[48:51]
v_mfma_f32_16x16x32_bf16 v[64:67],v[72:75],v[204:207],v[64:67]
v_mfma_f32_16x16x32_bf16 v[32:35],a[76:79],v[72:75],v[32:35]
v_mfma_f32_16x16x32_bf16 v[52:55],a[204:207],v[76:79],v[52:55]
v_mfma_f32_16x16x32_bf16 v[68:71],v[76:79],v[204:207],v[68:71]
v_mfma_f32_16x16x32_bf16 v[36:39],a[76:79],v[76:79],v[36:39]
s_waitcnt lgkmcnt(2)
v_mfma_f32_16x16x32_bf16 v[40:43],a[208:211],v[80:83],v[40:43]
ds_read_b128 v[72:75],v8 offset:16384
v_mfma_f32_16x16x32_bf16 v[56:59],v[80:83],v[208:211],v[56:59]
v_mfma_f32_16x16x32_bf16 v[24:27],a[80:83],v[80:83],v[24:27]
ds_read_b128 v[76:79],v8 offset:20480
v_mfma_f32_16x16x32_bf16 v[44:47],a[208:211],v[84:87],v[44:47]
v_mfma_f32_16x16x32_bf16 v[60:63],v[84:87],v[208:211],v[60:63]
v_mfma_f32_16x16x32_bf16 v[28:31],a[80:83],v[84:87],v[28:31]
v_mfma_f32_16x16x32_bf16 v[48:51],a[216:219],v[80:83],v[48:51]
v_mfma_f32_16x16x32_bf16 v[64:67],v[80:83],v[216:219],v[64:67]
v_mfma_f32_16x16x32_bf16 v[32:35],a[88:91],v[80:83],v[32:35]
v_mfma_f32_16x16x32_bf16 v[52:55],a[216:219],v[84:87],v[52:55]
v_mfma_f32_16x16x32_bf16 v[68:71],v[84:87],v[216:219],v[68:71]
v_mfma_f32_16x16x32_bf16 v[36:39],a[88:91],v[84:87],v[36:39]
s_waitcnt lgkmcnt(2)
v_mfma_f32_16x16x32_bf16 v[40:43],a[212:215],v[108:111],v[40:43]
ds_read_b128 v[80:83],v9 offset:16384
v_mfma_f32_16x16x32_bf16 v[56:59],v[108:111],v[212:215],v[56:59]
v_mfma_f32_16x16x32_bf16 v[24:27],a[84:87],v[108:111],v[24:27]
ds_read_b128 v[84:87],v9 offset:20480
v_mfma_f32_16x16x32_bf16 v[44:47],a[212:215],v[112:115],v[44:47]
v_mfma_f32_16x16x32_bf16 v[60:63],v[112:115],v[212:215],v[60:63]
v_mfma_f32_16x16x32_bf16 v[28:31],a[84:87],v[112:115],v[28:31]
v_mfma_f32_16x16x32_bf16 v[48:51],a[220:223],v[108:111],v[48:51]
v_mfma_f32_16x16x32_bf16 v[64:67],v[108:111],v[220:223],v[64:67]
v_mfma_f32_16x16x32_bf16 v[32:35],a[92:95],v[108:111],v[32:35]
v_mfma_f32_16x16x32_bf16 v[52:55],a[220:223],v[112:115],v[52:55]
v_mfma_f32_16x16x32_bf16 v[68:71],v[112:115],v[220:223],v[68:71]
v_mfma_f32_16x16x32_bf16 v[36:39],a[92:95],v[112:115],v[36:39]
s_barrier
s_waitcnt lgkmcnt(2)
v_mfma_f32_16x16x32_bf16 v[40:43],a[224:227],v[72:75],v[40:43]
ds_read_b128 v[108:111],v10 offset:16384
v_mfma_f32_16x16x32_bf16 v[56:59],v[72:75],v[224:227],v[56:59]
s_add_u32 m0,s50,131072
v_mfma_f32_16x16x32_bf16 v[24:27],a[96:99],v[72:75],v[24:27]
ds_read_b128 v[112:115],v10 offset:20480
v_mfma_f32_16x16x32_bf16 v[44:47],a[224:227],v[76:79],v[44:47]
buffer_load_dwordx4 v20,s[8:11],s70 offen offset:0 sc1 lds
v_mfma_f32_16x16x32_bf16 v[60:63],v[76:79],v[224:227],v[60:63]
s_add_u32 m0,s50,135168
v_mfma_f32_16x16x32_bf16 v[28:31],a[96:99],v[76:79],v[28:31]
buffer_load_dwordx4 v20,s[8:11],s71 offen offset:0 sc1 lds
v_mfma_f32_16x16x32_bf16 v[48:51],a[232:235],v[72:75],v[48:51]
s_add_u32 m0,s50,139008
v_mfma_f32_16x16x32_bf16 v[64:67],v[72:75],v[232:235],v[64:67]
buffer_load_dwordx4 v20,s[8:11],s70 offen offset:256 sc1 lds
v_mfma_f32_16x16x32_bf16 v[32:35],a[104:107],v[72:75],v[32:35]
s_add_u32 m0,s50,143104
v_mfma_f32_16x16x32_bf16 v[52:55],a[232:235],v[76:79],v[52:55]
buffer_load_dwordx4 v20,s[8:11],s71 offen offset:256 sc1 lds
v_mfma_f32_16x16x32_bf16 v[68:71],v[76:79],v[232:235],v[68:71]
v_mfma_f32_16x16x32_bf16 v[36:39],a[104:107],v[76:79],v[36:39]
s_waitcnt lgkmcnt(2)
v_mfma_f32_16x16x32_bf16 v[40:43],a[228:231],v[80:83],v[40:43]
ds_read_b128 v[72:75],v11 offset:16384
v_mfma_f32_16x16x32_bf16 v[56:59],v[80:83],v[228:231],v[56:59]
v_mfma_f32_16x16x32_bf16 v[24:27],a[100:103],v[80:83],v[24:27]
ds_read_b128 v[76:79],v11 offset:20480
v_mfma_f32_16x16x32_bf16 v[44:47],a[228:231],v[84:87],v[44:47]
v_mfma_f32_16x16x32_bf16 v[60:63],v[84:87],v[228:231],v[60:63]
v_mfma_f32_16x16x32_bf16 v[28:31],a[100:103],v[84:87],v[28:31]
v_mfma_f32_16x16x32_bf16 v[48:51],a[236:239],v[80:83],v[48:51]
v_mfma_f32_16x16x32_bf16 v[64:67],v[80:83],v[236:239],v[64:67]
v_mfma_f32_16x16x32_bf16 v[32:35],a[108:111],v[80:83],v[32:35]
v_mfma_f32_16x16x32_bf16 v[52:55],a[236:239],v[84:87],v[52:55]
v_mfma_f32_16x16x32_bf16 v[68:71],v[84:87],v[236:239],v[68:71]
v_mfma_f32_16x16x32_bf16 v[36:39],a[108:111],v[84:87],v[36:39]
s_waitcnt lgkmcnt(2)
v_mfma_f32_16x16x32_bf16 v[40:43],a[240:243],v[108:111],v[40:43]
v_mfma_f32_16x16x32_bf16 v[56:59],v[108:111],v[240:243],v[56:59]
v_mfma_f32_16x16x32_bf16 v[24:27],a[112:115],v[108:111],v[24:27]
v_mfma_f32_16x16x32_bf16 v[44:47],a[240:243],v[112:115],v[44:47]
v_mfma_f32_16x16x32_bf16 v[60:63],v[112:115],v[240:243],v[60:63]
v_mfma_f32_16x16x32_bf16 v[28:31],a[112:115],v[112:115],v[28:31]
v_mfma_f32_16x16x32_bf16 v[48:51],a[248:251],v[108:111],v[48:51]
v_mfma_f32_16x16x32_bf16 v[64:67],v[108:111],v[248:251],v[64:67]
v_mfma_f32_16x16x32_bf16 v[32:35],a[120:123],v[108:111],v[32:35]
v_mfma_f32_16x16x32_bf16 v[52:55],a[248:251],v[112:115],v[52:55]
v_mfma_f32_16x16x32_bf16 v[68:71],v[112:115],v[248:251],v[68:71]
v_mfma_f32_16x16x32_bf16 v[36:39],a[120:123],v[112:115],v[36:39]
s_waitcnt lgkmcnt(0)
v_mfma_f32_16x16x32_bf16 v[40:43],a[244:247],v[72:75],v[40:43]
v_mfma_f32_16x16x32_bf16 v[56:59],v[72:75],v[244:247],v[56:59]
v_mfma_f32_16x16x32_bf16 v[24:27],a[116:119],v[72:75],v[24:27]
v_mfma_f32_16x16x32_bf16 v[44:47],a[244:247],v[76:79],v[44:47]
v_mfma_f32_16x16x32_bf16 v[60:63],v[76:79],v[244:247],v[60:63]
v_mfma_f32_16x16x32_bf16 v[28:31],a[116:119],v[76:79],v[28:31]
v_mfma_f32_16x16x32_bf16 v[48:51],a[252:255],v[72:75],v[48:51]
v_mfma_f32_16x16x32_bf16 v[64:67],v[72:75],v[252:255],v[64:67]
v_mfma_f32_16x16x32_bf16 v[32:35],a[124:127],v[72:75],v[32:35]
v_mfma_f32_16x16x32_bf16 v[52:55],a[252:255],v[76:79],v[52:55]
v_mfma_f32_16x16x32_bf16 v[68:71],v[76:79],v[252:255],v[68:71]
v_mfma_f32_16x16x32_bf16 v[36:39],a[124:127],v[76:79],v[36:39]
s_lshl_b32 s56,s51,5
s_add_u32 s56,s56,s47
s_lshl_b32 s56,s56,12
s_add_u32 s56,s56,s50
s_add_u32 s56,s56,41943040
v_mov_b64 v[120:121],-1
v_mov_b64 v[122:123],-1
buffer_store_dwordx4 v[120:123],v0,s[8:11],s56 offen sc1
v_cvt_pk_bf16_f32 v72,v40,v48
v_cvt_pk_bf16_f32 v73,v41,v49
v_cvt_pk_bf16_f32 v74,v42,v50
v_cvt_pk_bf16_f32 v75,v43,v51
buffer_store_dwordx4 v[72:75],v0,s[8:11],s61 offen sc1
v_cvt_pk_bf16_f32 v76,v44,v52
v_cvt_pk_bf16_f32 v77,v45,v53
v_cvt_pk_bf16_f32 v78,v46,v54
v_cvt_pk_bf16_f32 v79,v47,v55
buffer_store_dwordx4 v[76:79],v0,s[8:11],s62 offen sc1
v_cvt_pk_bf16_f32 v80,v56,v57
v_cvt_pk_bf16_f32 v81,v58,v59
v_cvt_pk_bf16_f32 v82,v60,v61
v_cvt_pk_bf16_f32 v83,v62,v63
buffer_store_dwordx4 v[80:83],v0,s[8:11],s65 offen offset:0 sc1
v_cvt_pk_bf16_f32 v84,v64,v65
v_cvt_pk_bf16_f32 v85,v66,v67
v_cvt_pk_bf16_f32 v86,v68,v69
v_cvt_pk_bf16_f32 v87,v70,v71
buffer_store_dwordx4 v[84:87],v0,s[8:11],s65 offen offset:1024 sc1
v_cvt_pk_bf16_f32 v108,v24,v32
v_cvt_pk_bf16_f32 v109,v25,v33
v_cvt_pk_bf16_f32 v110,v26,v34
v_cvt_pk_bf16_f32 v111,v27,v35
buffer_store_dwordx4 v[108:111],v0,s[8:11],s63 offen sc1
v_cvt_pk_bf16_f32 v112,v28,v36
v_cvt_pk_bf16_f32 v113,v29,v37
v_cvt_pk_bf16_f32 v114,v30,v38
v_cvt_pk_bf16_f32 v115,v31,v39
buffer_store_dwordx4 v[112:115],v0,s[8:11],s64 offen sc1
s_lshl_b32 s72,s51,13
s_lshl2_add_u32 s72,s47,s72
s_add_u32 s72,s72,10485760
s_add_u32 s51,s51,1
s_sub_u32 s53,s53,1
s_cmp_gt_u32 s53,0
s_cbranch_scc1 L_chl_123
s_waitcnt vmcnt(0)
s_barrier
s_or_b32 s72,s72,s52
buffer_store_dword v17,off,s[8:11],s72 sc1
L_chd_122:
s_cmp_lg_u32 s3,0
s_cbranch_scc1 L_wc
s_cmp_eq_u32 s48,1
s_cbranch_scc1 L_rc1_124
s_cmp_eq_u32 s48,2
s_cbranch_scc1 L_rc2_125
v_and_b32 v120,15,v1
v_lshrrev_b32 v121,4,v1
v_and_b32 v122,2,v1
v_cmp_eq_u32 vcc,0,v122
v_mov_b32 v2,0xeeee
v_mov_b32 v123,0x4444
v_cndmask_b32 v2,v2,v123,vcc
v_and_b32 v122,1,v1
v_cmp_eq_u32 vcc,0,v122
v_mov_b32 v3,0xdddd
v_mov_b32 v123,0x8888
v_cndmask_b32 v3,v3,v123,vcc
v_lshrrev_b32 v122,1,v120
v_bfe_u32 v123,v120,2,1
v_xor_b32 v123,v123,v122
v_lshlrev_b32 v4,7,v123
v_and_b32 v123,1,v120
v_lshl_add_u32 v4,v123,6,v4
v_xor_b32 v123,v121,v122
v_and_b32 v123,3,v123
v_lshl_add_u32 v4,v123,4,v4
s_lshl_b32 s56,s46,10
s_add_u32 s56,s56,147456
v_add_u32 v4,s56,v4
v_lshlrev_b32 v122,1,v121
v_add_u32 v122,0,v122
v_and_b32 v123,1,v121
v_xor_b32 v123,v123,v122
v_lshlrev_b32 v5,7,v123
v_bfe_u32 v123,v120,3,1
v_lshl_add_u32 v5,v123,6,v5
v_xor_b32 v123,v120,v122
v_and_b32 v123,3,v123
v_lshl_add_u32 v5,v123,4,v5
v_bfe_u32 v123,v120,2,1
v_lshl_add_u32 v5,v123,3,v5
v_add_u32 v5,147456,v5
v_lshlrev_b32 v122,1,v121
v_add_u32 v122,1,v122
v_and_b32 v123,1,v121
v_xor_b32 v123,v123,v122
v_lshlrev_b32 v6,7,v123
v_bfe_u32 v123,v120,3,1
v_lshl_add_u32 v6,v123,6,v6
v_xor_b32 v123,v120,v122
v_and_b32 v123,3,v123
v_lshl_add_u32 v6,v123,4,v6
v_bfe_u32 v123,v120,2,1
v_lshl_add_u32 v6,v123,3,v6
v_add_u32 v6,147456,v6
v_lshlrev_b32 v7,7,v121
v_lshrrev_b32 v122,1,v120
v_lshl_add_u32 v8,v122,4,v7
v_add_u32 v8,151552,v8
v_lshrrev_b32 v122,2,v120
v_lshl_add_u32 v7,v122,5,v7
v_and_b32 v122,1,v120
v_lshl_add_u32 v7,v122,4,v7
v_and_b32 v122,2,v120
v_cmp_eq_u32 vcc,0,v122
s_lshl_b32 s56,s46,9
v_mov_b32 v122,2048
v_mov_b32 v123,s56
v_cndmask_b32 v122,v122,v123,vcc
v_add_u32 v7,v122,v7
v_add_u32 v7,151552,v7
v_lshrrev_b32 v122,3,v1
v_lshlrev_b32 v9,11,v122
v_and_b32 v122,7,v1
v_lshl_add_u32 v9,v122,3,v9
s_lshl_b32 s56,s46,14
s_lshl_b32 s57,s47,6
s_add_u32 s56,s56,s57
v_add_u32 v9,s56,v9
s_lshl_b32 s71,s47,2
s_add_u32 s71,s71,s46
s_bfe_u32 s56,s71,0x10003
s_lshl_b32 s56,s56,11
s_and_b32 s57,s71,1
s_lshl_b32 s57,s57,10
s_add_u32 s56,s56,s57
s_bfe_u32 s57,s71,0x10002
s_lshl_b32 s57,s57,9
s_add_u32 s56,s56,s57
s_bfe_u32 s57,s71,0x10001
s_lshl_b32 s57,s57,6
s_add_u32 s56,s56,s57
s_bfe_u32 s57,s71,0x10004
s_lshl_b32 s57,s57,8
s_add_u32 s56,s56,s57
s_bfe_u32 s57,s71,0x10005
s_lshl_b32 s57,s57,7
s_add_u32 s56,s56,s57
s_bfe_u32 s57,s71,0x10006
s_lshl_b32 s57,s57,12
s_add_u32 s56,s56,s57
v_and_b32 v122,3,v120
v_lshlrev_b32 v10,2,v122
v_bfe_u32 v122,v120,3,1
v_lshl_add_u32 v10,v122,4,v10
v_and_b32 v122,1,v121
v_lshl_add_u32 v10,v122,5,v10
v_add_u32 v10,s56,v10
v_and_b32 v123,36,v1
v_mov_b32 v122,0x80000000
v_cmp_eq_u32 vcc,0,v123
s_nop 1
v_cndmask_b32 v10,v122,v10,vcc
s_lshl_b32 s56,s46,15
v_add_u32 v11,s56,v0
s_lshl_b32 s71,s71,11
s_lshl_b32 s73,s46,11
s_mov_b32 s72,0xffc00000
s_mov_b32 s74,0
v_lshrrev_b32 v13,3,v1
v_lshlrev_b32 v13,9,v13
v_and_b32 v122,7,v1
v_lshl_add_u32 v13,v122,4,v13
v_and_b32 v122,15,v1
v_and_b32 v123,1,v1
v_lshlrev_b32 v123,4,v123
v_mov_b32 v124,0x3f80
v_lshlrev_b32 v124,v123,v124
v_lshrrev_b32 v122,1,v122
v_cmp_eq_u32 vcc,0,v122
s_nop 1
v_cndmask_b32 v18,0,v124,vcc
v_cmp_eq_u32 vcc,1,v122
s_nop 1
v_cndmask_b32 v19,0,v124,vcc
v_cmp_eq_u32 vcc,2,v122
s_nop 1
v_cndmask_b32 v20,0,v124,vcc
v_cmp_eq_u32 vcc,3,v122
s_nop 1
v_cndmask_b32 v21,0,v124,vcc
s_and_b32 s56,s46,1
s_lshl_b32 s56,s56,8
s_and_b32 s57,s46,2
s_lshl_b32 s57,s57,6
s_add_u32 s56,s56,s57
v_add_u32 v13,s56,v13
s_add_u32 s56,s50,155648
v_add_u32 v12,s56,v0
v_mov_b64 v[14:15],s[28:29]
v_mov_b64 v[16:17],s[28:29]
v_add_u32 v22,11550720,v10
s_lshl_b32 s18,s47,2
s_add_u32 s18,s18,10493952
v_mov_b32 v1,s80
s_mov_b32 s65,14680064
s_add_u32 s66,s71,14680064
s_add_u32 s69,s71,14942208
s_lshl_b32 s79,s47,2
s_add_u32 s79,s79,10485760
s_cmp_eq_u32 s46,0
s_cselect_b32 s79,s79,0x80000000
s_mov_b32 s30,0x40000000
s_mov_b32 s51,0
buffer_load_dwordx4 v[56:59],v0,s[8:11],s66 offen offset:0
buffer_load_dwordx4 v[60:63],v0,s[8:11],s66 offen offset:1024
buffer_load_dwordx4 v[64:67],v0,s[8:11],s69 offen offset:0
buffer_load_dwordx4 v[68:71],v0,s[8:11],s69 offen offset:1024
s_waitcnt vmcnt(0)
L_cst_129:
s_cmp_lg_u32 s46,0
s_cbranch_scc1 L_csw_134
s_lshl_b32 s59,s51,13
s_lshl2_add_u32 s59,s47,s59
s_add_u32 s59,s59,10485760
L_ww_135:
s_sleep 1
buffer_load_dword v122,off,s[8:11],s59 sc1
s_sub_u32 s49,s49,1
s_cbranch_scc1 L_abort
s_waitcnt vmcnt(0)
v_readfirstlane_b32 s61,v122
s_cmp_eq_u32 s61,0
s_cbranch_scc1 L_ww_135
L_wwd_136:
L_csw_134:
s_waitcnt lgkmcnt(0)
s_barrier
s_lshl_b32 s56,s51,5
s_add_u32 s56,s56,s47
s_mul_i32 s56,s56,24576
s_add_u32 s56,s56,100663296
s_add_u32 s67,s56,s73
s_add_u32 m0,s73,131072
s_add_u32 s57,s67,8192
buffer_load_dwordx4 v0,s[8:11],s67 offen sc1 lds
buffer_load_dwordx4 v0,s[8:11],s67 offen offset:1024 sc1 lds
s_add_u32 m0,s73,139264
s_add_u32 s67,s67,786432
buffer_load_dwordx4 v0,s[8:11],s57 offen sc1 lds
buffer_load_dwordx4 v0,s[8:11],s57 offen offset:1024 sc1 lds
s_lshl_b32 s75,s51,13
s_add_u32 s56,s75,11542528
buffer_load_dword v23,v10,s[8:11],s56 offen sc1
s_add_u32 s64,s75,11534336
s_add_u32 s70,s64,4096
s_lshl_b32 s68,s51,5
s_add_u32 s68,s68,s47
s_lshl_b32 s68,s68,12
s_lshl_b32 s56,s46,10
s_add_u32 s68,s68,s56
s_add_u32 s68,s68,41943040
s_mov_b32 s78,0x80000000
s_mov_b32 s55,0x80000000
s_mov_b32 s54,0x80000000
s_mov_b32 s77,0
s_mov_b32 s19,0
s_cmp_eq_u32 s51,63
s_cselect_b32 s76,1,s46
s_cmp_eq_u32 s76,0
s_cselect_b32 s76,1,0
v_mov_b64 v[96:97],0
v_mov_b64 v[98:99],0
v_mov_b64 v[100:101],0
v_mov_b64 v[102:103],0
v_mov_b64 v[104:105],0
v_mov_b64 v[106:107],0
v_mov_b64 v[108:109],0
v_mov_b64 v[110:111],0
v_mov_b64 v[112:113],0
v_mov_b64 v[114:115],0
v_mov_b64 v[116:117],0
v_mov_b64 v[118:119],0
s_waitcnt vmcnt(0) lgkmcnt(0)
s_barrier
v_add_u32 v55,131072,v0
ds_read_b128 v[56:59],v55 offset:0
ds_read_b128 v[60:63],v55 offset:4096
ds_read_b128 v[64:67],v55 offset:1024
ds_read_b128 v[68:71],v55 offset:5120
ds_read_b128 v[72:75],v55 offset:2048
ds_read_b128 v[76:79],v55 offset:6144
ds_read_b128 v[80:83],v55 offset:3072
ds_read_b128 v[84:87],v55 offset:7168
v_add_u32 v123,s73,v55
ds_read_b128 v[88:91],v123 offset:8192
ds_read_b128 v[92:95],v123 offset:9216
v_xor_b32 v120,1024,v12
v_xor_b32 v121,2048,v12
v_xor_b32 v122,3072,v12
buffer_load_dwordx4 v[24:27],v13,s[8:11],s64 offen sc1
buffer_load_dwordx4 v[40:43],v13,s[8:11],s70 offen sc1
L_chain_137:
L_cpa_138:
buffer_load_dwordx4 v[24:27],v13,s[8:11],s64 offen sc1
buffer_load_dwordx4 v[40:43],v13,s[8:11],s70 offen sc1
s_sub_u32 s49,s49,1
s_cbranch_scc1 L_abort
s_waitcnt vmcnt(2)
v_max3_u32 v123,v24,v25,v26
v_max3_u32 v123,v27,v40,v123
v_max3_u32 v123,v41,v42,v123
v_max_u32 v123,v43,v123
v_cmp_le_u32 vcc,s72,v123
s_cbranch_vccnz L_cpa_138
ds_write_b128 v12,v[24:27] offset:0
ds_write_b128 v12,v[40:43] offset:4096
v_smfmac_f32_16x16x64_bf16 v[96:99],v[24:27],a[0:7],v2
buffer_store_dwordx4 v[124:127],v0,s[8:11],s54 offen sc1
v_smfmac_f32_16x16x64_bf16 v[100:103],v[24:27],a[128:135],v2
s_add_u32 m0,s73,131072
s_add_u32 s57,s67,8192
v_smfmac_f32_16x16x64_bf16 v[104:107],v[24:27],a[8:15],v2
v_smfmac_f32_16x16x64_bf16 v[108:111],v[24:27],a[136:143],v2
s_waitcnt lgkmcnt(0)
s_cmp_lt_u32 s19,s76
s_cbranch_scc1 L_ckw_130
L_ckb_131:
s_barrier
ds_read_b128 v[28:31],v120 offset:0
ds_read_b128 v[32:35],v121 offset:0
v_smfmac_f32_16x16x64_bf16 v[96:99],v[40:43],a[64:71],v2
ds_read_b128 v[36:39],v122 offset:0
v_smfmac_f32_16x16x64_bf16 v[100:103],v[40:43],a[192:199],v2
ds_read_b128 v[44:47],v120 offset:4096
v_smfmac_f32_16x16x64_bf16 v[104:107],v[40:43],a[72:79],v2
ds_read_b128 v[48:51],v121 offset:4096
v_smfmac_f32_16x16x64_bf16 v[108:111],v[40:43],a[200:207],v2
ds_read_b128 v[52:55],v122 offset:4096
v_smfmac_f32_16x16x64_bf16 v[112:115],v[24:27],v[128:135],v2
buffer_load_dwordx4 v0,s[8:11],s67 offen sc1 lds
v_smfmac_f32_16x16x64_bf16 v[116:119],v[24:27],v[136:143],v2
v_smfmac_f32_16x16x64_bf16 v[112:115],v[40:43],v[192:199],v2
buffer_load_dwordx4 v0,s[8:11],s67 offen offset:1024 sc1 lds
v_smfmac_f32_16x16x64_bf16 v[116:119],v[40:43],v[200:207],v2
s_waitcnt lgkmcnt(5)
v_smfmac_f32_16x16x64_bf16 v[96:99],v[28:31],a[16:23],v2
s_add_u32 m0,s73,139264
v_smfmac_f32_16x16x64_bf16 v[100:103],v[28:31],a[144:151],v2
buffer_load_dwordx4 v0,s[8:11],s57 offen sc1 lds
v_smfmac_f32_16x16x64_bf16 v[104:107],v[28:31],a[24:31],v2
s_add_u32 s67,s67,786432
v_smfmac_f32_16x16x64_bf16 v[108:111],v[28:31],a[152:159],v2
s_waitcnt lgkmcnt(4)
v_smfmac_f32_16x16x64_bf16 v[96:99],v[32:35],a[32:39],v2
buffer_load_dwordx4 v0,s[8:11],s57 offen offset:1024 sc1 lds
v_smfmac_f32_16x16x64_bf16 v[100:103],v[32:35],a[160:167],v2
v_smfmac_f32_16x16x64_bf16 v[104:107],v[32:35],a[40:47],v2
v_smfmac_f32_16x16x64_bf16 v[108:111],v[32:35],a[168:175],v2
buffer_load_dword v23,v22,s[8:11],s75 offen sc1
s_waitcnt lgkmcnt(3)
v_smfmac_f32_16x16x64_bf16 v[96:99],v[36:39],a[48:55],v2
v_mov_b32 v125,0
v_smfmac_f32_16x16x64_bf16 v[100:103],v[36:39],a[176:183],v2
v_smfmac_f32_16x16x64_bf16 v[104:107],v[36:39],a[56:63],v2
v_smfmac_f32_16x16x64_bf16 v[108:111],v[36:39],a[184:191],v2
s_waitcnt lgkmcnt(0)
v_smfmac_f32_16x16x64_bf16 v[96:99],v[44:47],a[80:87],v2
v_smfmac_f32_16x16x64_bf16 v[100:103],v[44:47],a[208:215],v2
v_smfmac_f32_16x16x64_bf16 v[96:99],v[48:51],a[96:103],v2
v_smfmac_f32_16x16x64_bf16 v[100:103],v[48:51],a[224:231],v2
v_smfmac_f32_16x16x64_bf16 v[96:99],v[52:55],a[112:119],v2
v_smfmac_f32_16x16x64_bf16 v[100:103],v[52:55],a[240:247],v2
v_smfmac_f32_16x16x64_bf16 v[104:107],v[44:47],a[88:95],v2
v_smfmac_f32_16x16x64_bf16 v[108:111],v[44:47],a[216:223],v2
v_smfmac_f32_16x16x64_bf16 v[104:107],v[48:51],a[104:111],v2
v_add_f32 v96,v96,v98
v_smfmac_f32_16x16x64_bf16 v[108:111],v[48:51],a[232:239],v2
v_add_f32 v97,v97,v99
v_smfmac_f32_16x16x64_bf16 v[104:107],v[52:55],a[120:127],v2
v_cvt_pk_bf16_f32 v120,v96,v97
v_smfmac_f32_16x16x64_bf16 v[108:111],v[52:55],a[248:255],v2
v_add_f32 v100,v100,v102
v_smfmac_f32_16x16x64_bf16 v[112:115],v[28:31],v[144:151],v2
v_add_f32 v101,v101,v103
v_smfmac_f32_16x16x64_bf16 v[116:119],v[28:31],v[152:159],v2
v_cvt_pk_bf16_f32 v121,v100,v101
v_add_f32 v104,v104,v106
v_add_f32 v105,v105,v107
v_cvt_pk_bf16_f32 v122,v104,v105
v_add_f32 v108,v108,v110
v_add_f32 v109,v109,v111
v_cvt_pk_bf16_f32 v123,v108,v109
ds_write_b128 v4,v[120:123]
v_smfmac_f32_16x16x64_bf16 v[112:115],v[32:35],v[160:167],v2
v_smfmac_f32_16x16x64_bf16 v[116:119],v[32:35],v[168:175],v2
v_smfmac_f32_16x16x64_bf16 v[112:115],v[36:39],v[176:183],v2
v_smfmac_f32_16x16x64_bf16 v[116:119],v[36:39],v[184:191],v2
s_waitcnt vmcnt(6) lgkmcnt(0)
s_barrier
ds_read_b64_tr_b16 v[96:97],v5 offset:0
ds_read_b64_tr_b16 v[98:99],v6 offset:0
v_smfmac_f32_16x16x64_bf16 v[112:115],v[44:47],v[208:215],v2
ds_read_b64_tr_b16 v[100:101],v5 offset:1024
v_smfmac_f32_16x16x64_bf16 v[116:119],v[44:47],v[216:223],v2
ds_read_b64_tr_b16 v[102:103],v6 offset:1024
v_smfmac_f32_16x16x64_bf16 v[112:115],v[48:51],v[224:231],v2
ds_read_b64_tr_b16 v[104:105],v5 offset:2048
v_smfmac_f32_16x16x64_bf16 v[116:119],v[48:51],v[232:239],v2
ds_read_b64_tr_b16 v[106:107],v6 offset:2048
s_waitcnt lgkmcnt(4)
v_mfma_f32_16x16x32_bf16 v[24:27],v[56:59],v[96:99],0
ds_read_b64_tr_b16 v[108:109],v5 offset:3072
v_mfma_f32_16x16x32_bf16 v[28:31],v[60:63],v[96:99],0
ds_read_b64_tr_b16 v[110:111],v6 offset:3072
v_mfma_f32_16x16x32_bf16 v[32:35],v[96:99],v[96:99],0
ds_read_b128 v[40:43],v11 offset:12288
s_waitcnt lgkmcnt(5)
v_mfma_f32_16x16x32_bf16 v[24:27],v[64:67],v[100:103],v[24:27]
ds_read_b128 v[56:59],v11 offset:0
v_mfma_f32_16x16x32_bf16 v[28:31],v[68:71],v[100:103],v[28:31]
ds_read_b128 v[60:63],v11 offset:1024
v_mfma_f32_16x16x32_bf16 v[32:35],v[100:103],v[100:103],v[32:35]
ds_read_b128 v[96:99],v11 offset:8192
s_waitcnt lgkmcnt(6)
v_mfma_f32_16x16x32_bf16 v[24:27],v[72:75],v[104:107],v[24:27]
ds_read_b128 v[64:67],v11 offset:2048
v_mfma_f32_16x16x32_bf16 v[28:31],v[76:79],v[104:107],v[28:31]
ds_read_b128 v[68:71],v11 offset:3072
v_mfma_f32_16x16x32_bf16 v[32:35],v[104:107],v[104:107],v[32:35]
ds_read_b128 v[100:103],v11 offset:9216
s_waitcnt lgkmcnt(7)
v_mfma_f32_16x16x32_bf16 v[24:27],v[80:83],v[108:111],v[24:27]
ds_read_b128 v[72:75],v11 offset:4096
v_mfma_f32_16x16x32_bf16 v[28:31],v[84:87],v[108:111],v[28:31]
ds_read_b128 v[76:79],v11 offset:5120
v_mfma_f32_16x16x32_bf16 v[32:35],v[108:111],v[108:111],v[32:35]
ds_read_b128 v[104:107],v11 offset:10240
v_smfmac_f32_16x16x64_bf16 v[112:115],v[52:55],v[240:247],v2
ds_read_b128 v[80:83],v11 offset:6144
v_smfmac_f32_16x16x64_bf16 v[116:119],v[52:55],v[248:255],v2
ds_read_b128 v[84:87],v11 offset:7168
v_max3_f32 v126,v24,v25,v26
v_max3_f32 v127,v27,v28,v29
v_max3_f32 v126,v30,v31,v126
v_max3_f32 v127,v34,v35,v127
v_max_f32 v126,v126,v127
v_max_f32 v127,v126,v127
v_pk_mul_f32 v[34:35],v[34:35],v[0:1] op_sel:[0,1]
v_pk_mul_f32 v[24:25],v[24:25],v[0:1] op_sel:[0,1]
v_permlane16_swap_b32 v126,v127
v_max_f32 v126,v126,v127
v_max_f32 v127,v126,v127
v_pk_mul_f32 v[26:27],v[26:27],v[0:1] op_sel:[0,1]
v_pk_mul_f32 v[28:29],v[28:29],v[0:1] op_sel:[0,1]
v_permlane32_swap_b32 v126,v127
v_max_f32 v126,v126,v127
v_mul_f32 v126,v1,v126
v_pk_mul_f32 v[30:31],v[30:31],v[0:1] op_sel:[0,1]
v_pk_add_f32 v[34:35],v[34:35],v[126:127] op_sel_hi:[1,0] neg_lo:[0,1] neg_hi:[0,1]
v_pk_add_f32 v[112:113],v[112:113],v[114:115]
v_pk_add_f32 v[116:117],v[116:117],v[118:119]
v_pk_add_f32 v[24:25],v[24:25],v[126:127] op_sel_hi:[1,0] neg_lo:[0,1] neg_hi:[0,1]
v_pk_add_f32 v[26:27],v[26:27],v[126:127] op_sel_hi:[1,0] neg_lo:[0,1] neg_hi:[0,1]
v_pk_add_f32 v[28:29],v[28:29],v[126:127] op_sel_hi:[1,0] neg_lo:[0,1] neg_hi:[0,1]
v_pk_add_f32 v[30:31],v[30:31],v[126:127] op_sel_hi:[1,0] neg_lo:[0,1] neg_hi:[0,1]
v_exp_f32 v34,v34
v_exp_f32 v35,v35
v_cvt_pk_bf16_f32 v126,v112,v113
v_cvt_pk_bf16_f32 v124,v34,v35
v_cvt_pk_bf16_f32 v127,v116,v117
v_cvt_pk_bf16_f32 v36,v116,v117
v_mfma_f32_16x16x16_bf16 v[32:35],v[14:15],v[124:125],0
ds_read_b128 v[108:111],v11 offset:11264
v_exp_f32 v24,v24
v_mfma_f32_16x16x16_bf16 v[112:115],v[126:127],v[124:125],0
ds_read_b128 v[44:47],v11 offset:13312
v_exp_f32 v25,v25
v_mfma_f32_16x16x16_bf16 v[116:119],v[36:37],v[124:125],0
ds_read_b128 v[48:51],v11 offset:14336
v_exp_f32 v26,v26
v_exp_f32 v27,v27
v_cvt_pk_bf16_f32 v120,v24,v25
v_exp_f32 v28,v28
v_exp_f32 v29,v29
v_cvt_pk_bf16_f32 v121,v26,v27
v_exp_f32 v30,v30
v_exp_f32 v31,v31
v_cvt_pk_bf16_f32 v122,v28,v29
v_cvt_pk_bf16_f32 v123,v30,v31
s_mov_b32 s78,s55
s_add_u32 s55,s79,s75
v_mfma_f32_16x16x32_bf16 v[32:35],v[14:17],v[120:123],v[32:35]
ds_read_b128 v[52:55],v11 offset:15360
v_mfma_f32_16x16x32_bf16 v[112:115],v[88:91],v[120:123],v[112:115]
ds_read_b128 v[88:91],v11 offset:16384
v_mfma_f32_16x16x32_bf16 v[116:119],v[92:95],v[120:123],v[116:119]
ds_read_b128 v[92:95],v11 offset:17408
v_rcp_f32 v32,v32
v_mov_b64 v[24:25],-1
v_mov_b64 v[26:27],-1
s_mov_b32 s54,s68
s_add_u32 s75,s75,8192
v_pk_mul_f32 v[112:113],v[112:113],v[32:33] op_sel_hi:[1,0]
v_pk_mul_f32 v[114:115],v[114:115],v[32:33] op_sel_hi:[1,0]
v_pk_mul_f32 v[116:117],v[116:117],v[32:33] op_sel_hi:[1,0]
v_pk_mul_f32 v[118:119],v[118:119],v[32:33] op_sel_hi:[1,0]
v_cvt_pk_bf16_f32 v120,v112,v116
v_cvt_pk_bf16_f32 v121,v113,v117
v_cvt_pk_bf16_f32 v122,v114,v118
v_cvt_pk_bf16_f32 v123,v115,v119
ds_write_b128 v7,v[120:123]
buffer_store_dwordx4 v[24:27],v0,s[8:11],s69 offen
buffer_store_dwordx4 v[24:27],v0,s[8:11],s69 offen offset:1024
s_waitcnt lgkmcnt(0)
s_barrier
ds_read_b128 v[24:27],v8 offset:0
ds_read_b128 v[28:31],v8 offset:512
ds_read_b128 v[32:35],v8 offset:1024
ds_read_b128 v[36:39],v8 offset:1536
v_mov_b64 v[112:113],0
v_mov_b64 v[114:115],0
v_mov_b64 v[116:117],0
v_mov_b64 v[118:119],0
v_mov_b64 v[120:121],0
v_mov_b64 v[122:123],0
s_add_u32 s64,s75,11534336
s_add_u32 s70,s64,4096
s_add_u32 s68,s68,131072
s_add_u32 s51,s51,1
s_cmp_eq_u32 s51,64
s_cbranch_scc1 L_cend_140
s_waitcnt lgkmcnt(3)
v_smfmac_f32_16x16x64_bf16 v[112:115],v[24:27],v[56:63],v3
ds_read_b128 v[56:59],v11 offset:18432
s_add_u32 s57,s65,65536
s_waitcnt lgkmcnt(3)
v_smfmac_f32_16x16x64_bf16 v[112:115],v[28:31],v[64:71],v3
ds_read_b128 v[60:63],v11 offset:19456
s_add_u32 s58,s65,131072
s_waitcnt lgkmcnt(3)
v_smfmac_f32_16x16x64_bf16 v[112:115],v[32:35],v[72:79],v3
ds_read_b128 v[64:67],v11 offset:20480
s_add_u32 s59,s65,196608
s_waitcnt lgkmcnt(3)
v_smfmac_f32_16x16x64_bf16 v[112:115],v[36:39],v[80:87],v3
ds_read_b128 v[68:71],v11 offset:21504
v_smfmac_f32_16x16x64_bf16 v[116:119],v[24:27],v[96:103],v3
ds_read_b128 v[72:75],v11 offset:22528
v_smfmac_f32_16x16x64_bf16 v[116:119],v[28:31],v[104:111],v3
ds_read_b128 v[76:79],v11 offset:23552
v_cvt_pk_bf16_f32 v112,v112,v113
v_smfmac_f32_16x16x64_bf16 v[116:119],v[32:35],v[40:47],v3
ds_read_b128 v[80:83],v11 offset:24576
v_cvt_pk_bf16_f32 v113,v114,v115
buffer_store_dwordx2 v[112:113],v9,s[8:11],s65 offen
v_smfmac_f32_16x16x64_bf16 v[116:119],v[36:39],v[48:55],v3
ds_read_b128 v[84:87],v11 offset:25600
v_mov_b64 v[112:113],0
v_smfmac_f32_16x16x64_bf16 v[120:123],v[24:27],v[88:95],v3
ds_read_b128 v[96:99],v11 offset:26624
ds_read_b128 v[100:103],v11 offset:27648
v_mov_b64 v[114:115],0
s_waitcnt lgkmcnt(8)
v_smfmac_f32_16x16x64_bf16 v[120:123],v[28:31],v[56:63],v3
ds_read_b128 v[104:107],v11 offset:28672
v_cvt_pk_bf16_f32 v116,v116,v117
s_waitcnt lgkmcnt(7)
v_smfmac_f32_16x16x64_bf16 v[120:123],v[32:35],v[64:71],v3
ds_read_b128 v[108:111],v11 offset:29696
ds_read_b128 v[40:43],v11 offset:30720
v_cvt_pk_bf16_f32 v117,v118,v119
buffer_store_dwordx2 v[116:117],v9,s[8:11],s57 offen
s_waitcnt lgkmcnt(7)
v_smfmac_f32_16x16x64_bf16 v[120:123],v[36:39],v[72:79],v3
ds_read_b128 v[44:47],v11 offset:31744
s_waitcnt lgkmcnt(6)
v_smfmac_f32_16x16x64_bf16 v[112:115],v[24:27],v[80:87],v3
s_waitcnt lgkmcnt(4)
v_smfmac_f32_16x16x64_bf16 v[112:115],v[28:31],v[96:103],v3
v_cvt_pk_bf16_f32 v120,v120,v121
s_waitcnt lgkmcnt(2)
v_smfmac_f32_16x16x64_bf16 v[112:115],v[32:35],v[104:111],v3
v_cvt_pk_bf16_f32 v121,v122,v123
buffer_store_dwordx2 v[120:121],v9,s[8:11],s58 offen
s_waitcnt lgkmcnt(0)
v_smfmac_f32_16x16x64_bf16 v[112:115],v[36:39],v[40:47],v3
v_mov_b64 v[116:117],0
v_mov_b64 v[118:119],0
s_xor_b32 s65,s65,262144
v_add_u32 v52,s50,v5
v_add_u32 v54,s50,v6
v_mov_b32_dpp v124,v126 quad_perm:[2,3,2,3] row_mask:0xf bank_mask:0xf
v_mov_b32_dpp v125,v127 quad_perm:[2,3,2,3] row_mask:0xf bank_mask:0xf
s_nop 0
v_cvt_pk_bf16_f32 v112,v112,v113
v_cvt_pk_bf16_f32 v113,v114,v115
buffer_store_dwordx2 v[112:113],v9,s[8:11],s59 offen
ds_read_b64_tr_b16 v[52:53],v52
ds_read_b64_tr_b16 v[54:55],v54
s_mov_b32 vcc_lo,0xcccccccc
s_mov_b32 vcc_hi,0xcccccccc
v_mov_b64 v[96:97],0
v_mov_b64 v[98:99],0
v_mov_b64 v[100:101],0
v_mov_b64 v[102:103],0
v_mov_b64 v[104:105],0
v_mov_b64 v[106:107],0
v_mov_b64 v[108:109],0
v_mov_b64 v[110:111],0
v_mov_b64 v[112:113],0
v_mov_b64 v[114:115],0
s_waitcnt lgkmcnt(0)
v_cndmask_b32 v124,v124,v52,vcc
v_cndmask_b32 v125,v125,v53,vcc
v_cndmask_b32 v126,v126,v54,vcc
v_cndmask_b32 v127,v127,v55,vcc
s_add_u32 s56,s18,s75
s_buffer_load_dword s19,s[8:11],s56
v_add_u32 v55,131072,v0
v_add_u32 v123,s73,v55
v_xor_b32 v120,1024,v12
v_xor_b32 v121,2048,v12
v_xor_b32 v122,3072,v12
s_waitcnt vmcnt(0)
buffer_load_dwordx4 v[32:35],v0,s[8:11],s66 offen offset:0 sc1
buffer_load_dwordx4 v[36:39],v0,s[8:11],s66 offen offset:1024 sc1
s_cmp_ge_u32 s51,63
s_cselect_b32 s76,0,1
s_cmp_eq_u32 s46,0
s_cselect_b32 s76,s76,0
s_waitcnt vmcnt(1)
v_mfma_f32_16x16x32_bf16 v[28:31],v[18:21],v[32:35],0
s_waitcnt vmcnt(0)
v_mfma_f32_16x16x32_bf16 v[28:31],v[18:21],v[36:39],v[28:31]
s_nop 7
v_cmp_u_f32 vcc,v28,v28
v_add_f32_dpp v52,v28,v28 row_ror:8 row_mask:0xf bank_mask:0x3
v_add_f32_dpp v53,v29,v29 row_ror:8 row_mask:0xf bank_mask:0x3
v_add_f32_dpp v52,v30,v30 row_ror:8 row_mask:0xf bank_mask:0xc
v_add_f32_dpp v53,v31,v31 row_ror:8 row_mask:0xf bank_mask:0xc
s_nop 0
v_add_f32_dpp v52,v52,v52 row_shl:4 row_mask:0xf bank_mask:0x5
v_add_f32_dpp v53,v53,v53 row_shl:4 row_mask:0xf bank_mask:0x5
s_cbranch_vccnz L_crp_142
L_cok_147:
v_cvt_pk_bf16_f32 v54,v52,v53
buffer_store_dword v54,v10,s[8:11],s64 offen
s_mov_b32 s69,s66
s_xor_b32 s66,s66,262144
s_barrier
ds_read_b128 v[56:59],v55 offset:0
ds_read_b128 v[60:63],v55 offset:4096
buffer_load_dwordx4 v[24:27],v13,s[8:11],s64 offen sc1
buffer_load_dwordx4 v[40:43],v13,s[8:11],s70 offen sc1
ds_read_b128 v[64:67],v55 offset:1024
ds_read_b128 v[68:71],v55 offset:5120
ds_read_b128 v[72:75],v55 offset:2048
ds_read_b128 v[76:79],v55 offset:6144
ds_read_b128 v[80:83],v55 offset:3072
ds_read_b128 v[84:87],v55 offset:7168
ds_read_b128 v[88:91],v123 offset:8192
ds_read_b128 v[92:95],v123 offset:9216
s_branch L_chain_137
L_crp_142:
buffer_load_dwordx4 v[32:35],v0,s[8:11],s66 offen offset:0 sc1
buffer_load_dwordx4 v[36:39],v0,s[8:11],s66 offen offset:1024 sc1
s_sub_u32 s49,s49,1
s_cbranch_scc1 L_abort
s_waitcnt vmcnt(1)
v_mfma_f32_16x16x32_bf16 v[28:31],v[18:21],v[32:35],0
s_waitcnt vmcnt(0)
v_mfma_f32_16x16x32_bf16 v[28:31],v[18:21],v[36:39],v[28:31]
s_nop 7
v_cmp_u_f32 vcc,v28,v28
v_add_f32_dpp v52,v28,v28 row_ror:8 row_mask:0xf bank_mask:0x3
v_add_f32_dpp v53,v29,v29 row_ror:8 row_mask:0xf bank_mask:0x3
v_add_f32_dpp v52,v30,v30 row_ror:8 row_mask:0xf bank_mask:0xc
v_add_f32_dpp v53,v31,v31 row_ror:8 row_mask:0xf bank_mask:0xc
s_nop 0
v_add_f32_dpp v52,v52,v52 row_shl:4 row_mask:0xf bank_mask:0x5
v_add_f32_dpp v53,v53,v53 row_shl:4 row_mask:0xf bank_mask:0x5
s_cbranch_vccz L_cok_147
s_branch L_crp_142
L_ckw_130:
s_add_u32 s59,s18,s75
L_ww_148:
s_sleep 1
buffer_load_dword v23,off,s[8:11],s59 sc1
s_sub_u32 s49,s49,1
s_cbranch_scc1 L_abort
s_waitcnt vmcnt(0)
v_readfirstlane_b32 s76,v23
s_cmp_eq_u32 s76,0
s_cbranch_scc1 L_ww_148
L_wwd_149:
s_branch L_ckb_131
L_cend_140:
v_add_u32 v52,s50,v5
v_add_u32 v54,s50,v6
ds_read_b64_tr_b16 v[52:53],v52
ds_read_b64_tr_b16 v[54:55],v54
v_mov_b32_dpp v124,v126 quad_perm:[2,3,2,3] row_mask:0xf bank_mask:0xf
v_mov_b32_dpp v125,v127 quad_perm:[2,3,2,3] row_mask:0xf bank_mask:0xf
s_mov_b32 vcc_lo,0xcccccccc
s_mov_b32 vcc_hi,0xcccccccc
s_waitcnt lgkmcnt(0)
v_cndmask_b32 v124,v124,v52,vcc
v_cndmask_b32 v125,v125,v53,vcc
v_cndmask_b32 v126,v126,v54,vcc
v_cndmask_b32 v127,v127,v55,vcc
buffer_store_dwordx4 v[124:127],v0,s[8:11],s54 offen sc1
s_waitcnt vmcnt(0)
s_barrier
s_nop 11
v_lshrrev_b32 v1,4,v0
s_mov_b32 s53,0
s_branch L_rb_7
L_rc1_124:
v_and_b32 v120,15,v1
v_lshrrev_b32 v121,4,v1
v_and_b32 v122,2,v1
v_cmp_eq_u32 vcc,0,v122
v_mov_b32 v2,0xeeee
v_mov_b32 v123,0x4444
v_cndmask_b32 v2,v2,v123,vcc
v_and_b32 v122,1,v1
v_cmp_eq_u32 vcc,0,v122
v_mov_b32 v3,0xdddd
v_mov_b32 v123,0x8888
v_cndmask_b32 v3,v3,v123,vcc
v_lshrrev_b32 v122,1,v120
v_bfe_u32 v123,v120,2,1
v_xor_b32 v123,v123,v122
v_lshlrev_b32 v4,7,v123
v_and_b32 v123,1,v120
v_lshl_add_u32 v4,v123,6,v4
v_xor_b32 v123,v121,v122
v_and_b32 v123,3,v123
v_lshl_add_u32 v4,v123,4,v4
s_lshl_b32 s56,s46,10
s_add_u32 s56,s56,147456
v_add_u32 v4,s56,v4
v_lshlrev_b32 v122,1,v121
v_add_u32 v122,0,v122
v_and_b32 v123,1,v121
v_xor_b32 v123,v123,v122
v_lshlrev_b32 v5,7,v123
v_bfe_u32 v123,v120,3,1
v_lshl_add_u32 v5,v123,6,v5
v_xor_b32 v123,v120,v122
v_and_b32 v123,3,v123
v_lshl_add_u32 v5,v123,4,v5
v_bfe_u32 v123,v120,2,1
v_lshl_add_u32 v5,v123,3,v5
v_add_u32 v5,147456,v5
v_lshlrev_b32 v122,1,v121
v_add_u32 v122,1,v122
v_and_b32 v123,1,v121
v_xor_b32 v123,v123,v122
v_lshlrev_b32 v6,7,v123
v_bfe_u32 v123,v120,3,1
v_lshl_add_u32 v6,v123,6,v6
v_xor_b32 v123,v120,v122
v_and_b32 v123,3,v123
v_lshl_add_u32 v6,v123,4,v6
v_bfe_u32 v123,v120,2,1
v_lshl_add_u32 v6,v123,3,v6
v_add_u32 v6,147456,v6
v_lshlrev_b32 v7,7,v121
v_lshrrev_b32 v122,1,v120
v_lshl_add_u32 v8,v122,4,v7
v_add_u32 v8,151552,v8
v_lshrrev_b32 v122,2,v120
v_lshl_add_u32 v7,v122,5,v7
v_and_b32 v122,1,v120
v_lshl_add_u32 v7,v122,4,v7
v_and_b32 v122,2,v120
v_cmp_eq_u32 vcc,0,v122
s_lshl_b32 s56,s46,9
v_mov_b32 v122,2048
v_mov_b32 v123,s56
v_cndmask_b32 v122,v122,v123,vcc
v_add_u32 v7,v122,v7
v_add_u32 v7,151552,v7
v_lshrrev_b32 v122,3,v1
v_lshlrev_b32 v9,11,v122
v_and_b32 v122,7,v1
v_lshl_add_u32 v9,v122,3,v9
s_lshl_b32 s56,s46,14
s_lshl_b32 s57,s47,6
s_add_u32 s56,s56,s57
v_add_u32 v9,s56,v9
s_lshl_b32 s71,s47,2
s_add_u32 s71,s71,s46
s_bfe_u32 s56,s71,0x10003
s_lshl_b32 s56,s56,11
s_and_b32 s57,s71,1
s_lshl_b32 s57,s57,10
s_add_u32 s56,s56,s57
s_bfe_u32 s57,s71,0x10002
s_lshl_b32 s57,s57,9
s_add_u32 s56,s56,s57
s_bfe_u32 s57,s71,0x10001
s_lshl_b32 s57,s57,6
s_add_u32 s56,s56,s57
s_bfe_u32 s57,s71,0x10004
s_lshl_b32 s57,s57,8
s_add_u32 s56,s56,s57
s_bfe_u32 s57,s71,0x10005
s_lshl_b32 s57,s57,7
s_add_u32 s56,s56,s57
s_bfe_u32 s57,s71,0x10006
s_lshl_b32 s57,s57,12
s_add_u32 s56,s56,s57
v_and_b32 v122,3,v120
v_lshlrev_b32 v10,2,v122
v_bfe_u32 v122,v120,3,1
v_lshl_add_u32 v10,v122,4,v10
v_and_b32 v122,1,v121
v_lshl_add_u32 v10,v122,5,v10
v_add_u32 v10,s56,v10
v_and_b32 v123,36,v1
v_mov_b32 v122,0x80000000
v_cmp_eq_u32 vcc,0,v123
s_nop 1
v_cndmask_b32 v10,v122,v10,vcc
s_lshl_b32 s56,s46,15
v_add_u32 v11,s56,v0
s_lshl_b32 s71,s71,11
s_lshl_b32 s73,s46,11
s_mov_b32 s72,0xffc00000
s_mov_b32 s74,0
v_lshrrev_b32 v13,3,v1
v_lshlrev_b32 v13,9,v13
v_and_b32 v122,7,v1
v_lshl_add_u32 v13,v122,4,v13
v_and_b32 v122,15,v1
v_and_b32 v123,1,v1
v_lshlrev_b32 v123,4,v123
v_mov_b32 v124,0x3f80
v_lshlrev_b32 v124,v123,v124
v_lshrrev_b32 v122,1,v122
v_cmp_eq_u32 vcc,0,v122
s_nop 1
v_cndmask_b32 v18,0,v124,vcc
v_cmp_eq_u32 vcc,1,v122
s_nop 1
v_cndmask_b32 v19,0,v124,vcc
v_cmp_eq_u32 vcc,2,v122
s_nop 1
v_cndmask_b32 v20,0,v124,vcc
v_cmp_eq_u32 vcc,3,v122
s_nop 1
v_cndmask_b32 v21,0,v124,vcc
s_and_b32 s56,s46,1
s_lshl_b32 s56,s56,8
s_and_b32 s57,s46,2
s_lshl_b32 s57,s57,6
s_add_u32 s56,s56,s57
v_add_u32 v13,s56,v13
s_add_u32 s56,s50,155648
v_add_u32 v12,s56,v0
v_mov_b64 v[14:15],s[28:29]
v_mov_b64 v[16:17],s[28:29]
v_add_u32 v22,12599296,v10
s_lshl_b32 s18,s47,2
s_add_u32 s18,s18,10494080
v_mov_b32 v1,s80
s_mov_b32 s65,15728640
s_add_u32 s66,s71,15728640
s_add_u32 s69,s71,15990784
s_lshl_b32 s79,s47,2
s_add_u32 s79,s79,10486272
s_cmp_eq_u32 s46,0
s_cselect_b32 s79,s79,0x80000000
s_mov_b32 s30,0x40000000
s_mov_b32 s51,0
buffer_load_dwordx4 v[56:59],v0,s[8:11],s66 offen offset:0
buffer_load_dwordx4 v[60:63],v0,s[8:11],s66 offen offset:1024
buffer_load_dwordx4 v[64:67],v0,s[8:11],s69 offen offset:0
buffer_load_dwordx4 v[68:71],v0,s[8:11],s69 offen offset:1024
s_waitcnt vmcnt(0)
L_cst_153:
s_cmp_lg_u32 s46,0
s_cbranch_scc1 L_csw_158
s_lshl_b32 s59,s51,13
s_lshl2_add_u32 s59,s47,s59
s_add_u32 s59,s59,10485888
L_ww_159:
s_sleep 1
buffer_load_dword v122,off,s[8:11],s59 sc1
s_sub_u32 s49,s49,1
s_cbranch_scc1 L_abort
s_waitcnt vmcnt(0)
v_readfirstlane_b32 s61,v122
s_cmp_eq_u32 s61,0
s_cbranch_scc1 L_ww_159
L_wwd_160:
L_csw_158:
s_waitcnt lgkmcnt(0)
s_barrier
s_lshl_b32 s56,s51,5
s_add_u32 s56,s56,s47
s_mul_i32 s56,s56,24576
s_add_u32 s56,s56,150994944
s_add_u32 s67,s56,s73
s_add_u32 m0,s73,131072
s_add_u32 s57,s67,8192
buffer_load_dwordx4 v0,s[8:11],s67 offen sc1 lds
buffer_load_dwordx4 v0,s[8:11],s67 offen offset:1024 sc1 lds
s_add_u32 m0,s73,139264
s_add_u32 s67,s67,786432
buffer_load_dwordx4 v0,s[8:11],s57 offen sc1 lds
buffer_load_dwordx4 v0,s[8:11],s57 offen offset:1024 sc1 lds
s_lshl_b32 s75,s51,13
s_add_u32 s56,s75,12591104
buffer_load_dword v23,v10,s[8:11],s56 offen sc1
s_add_u32 s64,s75,12582912
s_add_u32 s70,s64,4096
s_lshl_b32 s68,s51,5
s_add_u32 s68,s68,s47
s_lshl_b32 s68,s68,12
s_lshl_b32 s56,s46,10
s_add_u32 s68,s68,s56
s_add_u32 s68,s68,58720256
s_mov_b32 s78,0x80000000
s_mov_b32 s55,0x80000000
s_mov_b32 s54,0x80000000
s_mov_b32 s77,0
s_mov_b32 s19,0
s_cmp_eq_u32 s51,63
s_cselect_b32 s76,1,s46
s_cmp_eq_u32 s76,0
s_cselect_b32 s76,1,0
v_mov_b64 v[96:97],0
v_mov_b64 v[98:99],0
v_mov_b64 v[100:101],0
v_mov_b64 v[102:103],0
v_mov_b64 v[104:105],0
v_mov_b64 v[106:107],0
v_mov_b64 v[108:109],0
v_mov_b64 v[110:111],0
v_mov_b64 v[112:113],0
v_mov_b64 v[114:115],0
v_mov_b64 v[116:117],0
v_mov_b64 v[118:119],0
s_waitcnt vmcnt(0) lgkmcnt(0)
s_barrier
v_add_u32 v55,131072,v0
ds_read_b128 v[56:59],v55 offset:0
ds_read_b128 v[60:63],v55 offset:4096
ds_read_b128 v[64:67],v55 offset:1024
ds_read_b128 v[68:71],v55 offset:5120
ds_read_b128 v[72:75],v55 offset:2048
ds_read_b128 v[76:79],v55 offset:6144
ds_read_b128 v[80:83],v55 offset:3072
ds_read_b128 v[84:87],v55 offset:7168
v_add_u32 v123,s73,v55
ds_read_b128 v[88:91],v123 offset:8192
ds_read_b128 v[92:95],v123 offset:9216
v_xor_b32 v120,1024,v12
v_xor_b32 v121,2048,v12
v_xor_b32 v122,3072,v12
buffer_load_dwordx4 v[24:27],v13,s[8:11],s64 offen sc1
buffer_load_dwordx4 v[40:43],v13,s[8:11],s70 offen sc1
L_chain_161:
L_cpa_162:
buffer_load_dwordx4 v[24:27],v13,s[8:11],s64 offen sc1
buffer_load_dwordx4 v[40:43],v13,s[8:11],s70 offen sc1
s_sub_u32 s49,s49,1
s_cbranch_scc1 L_abort
s_waitcnt vmcnt(2)
v_max3_u32 v123,v24,v25,v26
v_max3_u32 v123,v27,v40,v123
v_max3_u32 v123,v41,v42,v123
v_max_u32 v123,v43,v123
v_cmp_le_u32 vcc,s72,v123
s_cbranch_vccnz L_cpa_162
ds_write_b128 v12,v[24:27] offset:0
ds_write_b128 v12,v[40:43] offset:4096
v_smfmac_f32_16x16x64_bf16 v[96:99],v[24:27],a[0:7],v2
buffer_store_dwordx4 v[124:127],v0,s[8:11],s54 offen sc1
v_smfmac_f32_16x16x64_bf16 v[100:103],v[24:27],a[128:135],v2
buffer_store_dword v54,v10,s[8:11],s30 offen sc1
s_add_u32 m0,s73,131072
s_add_u32 s57,s67,8192
v_smfmac_f32_16x16x64_bf16 v[104:107],v[24:27],a[8:15],v2
v_smfmac_f32_16x16x64_bf16 v[108:111],v[24:27],a[136:143],v2
s_waitcnt lgkmcnt(0)
s_cmp_lt_u32 s19,s76
s_cbranch_scc1 L_ckw_154
L_ckb_155:
s_barrier
ds_read_b128 v[28:31],v120 offset:0
ds_read_b128 v[32:35],v121 offset:0
v_smfmac_f32_16x16x64_bf16 v[96:99],v[40:43],a[64:71],v2
ds_read_b128 v[36:39],v122 offset:0
v_smfmac_f32_16x16x64_bf16 v[100:103],v[40:43],a[192:199],v2
ds_read_b128 v[44:47],v120 offset:4096
v_smfmac_f32_16x16x64_bf16 v[104:107],v[40:43],a[72:79],v2
ds_read_b128 v[48:51],v121 offset:4096
v_smfmac_f32_16x16x64_bf16 v[108:111],v[40:43],a[200:207],v2
ds_read_b128 v[52:55],v122 offset:4096
v_smfmac_f32_16x16x64_bf16 v[112:115],v[24:27],v[128:135],v2
buffer_load_dwordx4 v0,s[8:11],s67 offen sc1 lds
v_smfmac_f32_16x16x64_bf16 v[116:119],v[24:27],v[136:143],v2
v_smfmac_f32_16x16x64_bf16 v[112:115],v[40:43],v[192:199],v2
buffer_load_dwordx4 v0,s[8:11],s67 offen offset:1024 sc1 lds
v_smfmac_f32_16x16x64_bf16 v[116:119],v[40:43],v[200:207],v2
s_waitcnt lgkmcnt(5)
v_smfmac_f32_16x16x64_bf16 v[96:99],v[28:31],a[16:23],v2
s_add_u32 m0,s73,139264
v_smfmac_f32_16x16x64_bf16 v[100:103],v[28:31],a[144:151],v2
buffer_load_dwordx4 v0,s[8:11],s57 offen sc1 lds
v_smfmac_f32_16x16x64_bf16 v[104:107],v[28:31],a[24:31],v2
s_add_u32 s67,s67,786432
v_smfmac_f32_16x16x64_bf16 v[108:111],v[28:31],a[152:159],v2
s_waitcnt lgkmcnt(4)
v_smfmac_f32_16x16x64_bf16 v[96:99],v[32:35],a[32:39],v2
buffer_load_dwordx4 v0,s[8:11],s57 offen offset:1024 sc1 lds
v_smfmac_f32_16x16x64_bf16 v[100:103],v[32:35],a[160:167],v2
v_smfmac_f32_16x16x64_bf16 v[104:107],v[32:35],a[40:47],v2
v_smfmac_f32_16x16x64_bf16 v[108:111],v[32:35],a[168:175],v2
buffer_load_dword v23,v22,s[8:11],s75 offen sc1
s_waitcnt lgkmcnt(3)
v_smfmac_f32_16x16x64_bf16 v[96:99],v[36:39],a[48:55],v2
v_mov_b32 v125,0
v_smfmac_f32_16x16x64_bf16 v[100:103],v[36:39],a[176:183],v2
v_smfmac_f32_16x16x64_bf16 v[104:107],v[36:39],a[56:63],v2
buffer_store_dword v2,off,s[8:11],s78 sc1
v_smfmac_f32_16x16x64_bf16 v[108:111],v[36:39],a[184:191],v2
s_waitcnt lgkmcnt(0)
v_smfmac_f32_16x16x64_bf16 v[96:99],v[44:47],a[80:87],v2
v_smfmac_f32_16x16x64_bf16 v[100:103],v[44:47],a[208:215],v2
v_smfmac_f32_16x16x64_bf16 v[96:99],v[48:51],a[96:103],v2
v_smfmac_f32_16x16x64_bf16 v[100:103],v[48:51],a[224:231],v2
v_smfmac_f32_16x16x64_bf16 v[96:99],v[52:55],a[112:119],v2
v_smfmac_f32_16x16x64_bf16 v[100:103],v[52:55],a[240:247],v2
v_smfmac_f32_16x16x64_bf16 v[104:107],v[44:47],a[88:95],v2
v_smfmac_f32_16x16x64_bf16 v[108:111],v[44:47],a[216:223],v2
v_smfmac_f32_16x16x64_bf16 v[104:107],v[48:51],a[104:111],v2
v_add_f32 v96,v96,v98
v_smfmac_f32_16x16x64_bf16 v[108:111],v[48:51],a[232:239],v2
v_add_f32 v97,v97,v99
v_smfmac_f32_16x16x64_bf16 v[104:107],v[52:55],a[120:127],v2
v_cvt_pk_bf16_f32 v120,v96,v97
v_smfmac_f32_16x16x64_bf16 v[108:111],v[52:55],a[248:255],v2
v_add_f32 v100,v100,v102
v_smfmac_f32_16x16x64_bf16 v[112:115],v[28:31],v[144:151],v2
v_add_f32 v101,v101,v103
v_smfmac_f32_16x16x64_bf16 v[116:119],v[28:31],v[152:159],v2
v_cvt_pk_bf16_f32 v121,v100,v101
v_add_f32 v104,v104,v106
v_add_f32 v105,v105,v107
v_cvt_pk_bf16_f32 v122,v104,v105
v_add_f32 v108,v108,v110
v_add_f32 v109,v109,v111
v_cvt_pk_bf16_f32 v123,v108,v109
ds_write_b128 v4,v[120:123]
v_smfmac_f32_16x16x64_bf16 v[112:115],v[32:35],v[160:167],v2
v_smfmac_f32_16x16x64_bf16 v[116:119],v[32:35],v[168:175],v2
v_smfmac_f32_16x16x64_bf16 v[112:115],v[36:39],v[176:183],v2
v_smfmac_f32_16x16x64_bf16 v[116:119],v[36:39],v[184:191],v2
s_waitcnt vmcnt(8) lgkmcnt(0)
s_barrier
ds_read_b64_tr_b16 v[96:97],v5 offset:0
ds_read_b64_tr_b16 v[98:99],v6 offset:0
v_smfmac_f32_16x16x64_bf16 v[112:115],v[44:47],v[208:215],v2
ds_read_b64_tr_b16 v[100:101],v5 offset:1024
v_smfmac_f32_16x16x64_bf16 v[116:119],v[44:47],v[216:223],v2
ds_read_b64_tr_b16 v[102:103],v6 offset:1024
v_smfmac_f32_16x16x64_bf16 v[112:115],v[48:51],v[224:231],v2
ds_read_b64_tr_b16 v[104:105],v5 offset:2048
v_smfmac_f32_16x16x64_bf16 v[116:119],v[48:51],v[232:239],v2
ds_read_b64_tr_b16 v[106:107],v6 offset:2048
s_waitcnt lgkmcnt(4)
v_mfma_f32_16x16x32_bf16 v[24:27],v[56:59],v[96:99],0
ds_read_b64_tr_b16 v[108:109],v5 offset:3072
v_mfma_f32_16x16x32_bf16 v[28:31],v[60:63],v[96:99],0
ds_read_b64_tr_b16 v[110:111],v6 offset:3072
v_mfma_f32_16x16x32_bf16 v[32:35],v[96:99],v[96:99],0
ds_read_b128 v[40:43],v11 offset:12288
s_waitcnt lgkmcnt(5)
v_mfma_f32_16x16x32_bf16 v[24:27],v[64:67],v[100:103],v[24:27]
ds_read_b128 v[56:59],v11 offset:0
v_mfma_f32_16x16x32_bf16 v[28:31],v[68:71],v[100:103],v[28:31]
ds_read_b128 v[60:63],v11 offset:1024
v_mfma_f32_16x16x32_bf16 v[32:35],v[100:103],v[100:103],v[32:35]
ds_read_b128 v[96:99],v11 offset:8192
s_waitcnt lgkmcnt(6)
v_mfma_f32_16x16x32_bf16 v[24:27],v[72:75],v[104:107],v[24:27]
ds_read_b128 v[64:67],v11 offset:2048
v_mfma_f32_16x16x32_bf16 v[28:31],v[76:79],v[104:107],v[28:31]
ds_read_b128 v[68:71],v11 offset:3072
v_mfma_f32_16x16x32_bf16 v[32:35],v[104:107],v[104:107],v[32:35]
ds_read_b128 v[100:103],v11 offset:9216
s_waitcnt lgkmcnt(7)
v_mfma_f32_16x16x32_bf16 v[24:27],v[80:83],v[108:111],v[24:27]
ds_read_b128 v[72:75],v11 offset:4096
v_mfma_f32_16x16x32_bf16 v[28:31],v[84:87],v[108:111],v[28:31]
ds_read_b128 v[76:79],v11 offset:5120
v_mfma_f32_16x16x32_bf16 v[32:35],v[108:111],v[108:111],v[32:35]
ds_read_b128 v[104:107],v11 offset:10240
v_smfmac_f32_16x16x64_bf16 v[112:115],v[52:55],v[240:247],v2
ds_read_b128 v[80:83],v11 offset:6144
v_smfmac_f32_16x16x64_bf16 v[116:119],v[52:55],v[248:255],v2
ds_read_b128 v[84:87],v11 offset:7168
v_max3_f32 v126,v24,v25,v26
v_max3_f32 v127,v27,v28,v29
v_max3_f32 v126,v30,v31,v126
v_max3_f32 v127,v34,v35,v127
v_max_f32 v126,v126,v127
v_max_f32 v127,v126,v127
v_pk_mul_f32 v[34:35],v[34:35],v[0:1] op_sel:[0,1]
v_pk_mul_f32 v[24:25],v[24:25],v[0:1] op_sel:[0,1]
v_permlane16_swap_b32 v126,v127
v_max_f32 v126,v126,v127
v_max_f32 v127,v126,v127
v_pk_mul_f32 v[26:27],v[26:27],v[0:1] op_sel:[0,1]
v_pk_mul_f32 v[28:29],v[28:29],v[0:1] op_sel:[0,1]
v_permlane32_swap_b32 v126,v127
v_max_f32 v126,v126,v127
v_mul_f32 v126,v1,v126
v_pk_mul_f32 v[30:31],v[30:31],v[0:1] op_sel:[0,1]
v_pk_add_f32 v[34:35],v[34:35],v[126:127] op_sel_hi:[1,0] neg_lo:[0,1] neg_hi:[0,1]
v_pk_add_f32 v[112:113],v[112:113],v[114:115]
v_pk_add_f32 v[116:117],v[116:117],v[118:119]
v_pk_add_f32 v[24:25],v[24:25],v[126:127] op_sel_hi:[1,0] neg_lo:[0,1] neg_hi:[0,1]
v_pk_add_f32 v[26:27],v[26:27],v[126:127] op_sel_hi:[1,0] neg_lo:[0,1] neg_hi:[0,1]
v_pk_add_f32 v[28:29],v[28:29],v[126:127] op_sel_hi:[1,0] neg_lo:[0,1] neg_hi:[0,1]
v_pk_add_f32 v[30:31],v[30:31],v[126:127] op_sel_hi:[1,0] neg_lo:[0,1] neg_hi:[0,1]
v_exp_f32 v34,v34
v_exp_f32 v35,v35
v_cvt_pk_bf16_f32 v126,v112,v113
v_cvt_pk_bf16_f32 v124,v34,v35
v_cvt_pk_bf16_f32 v127,v116,v117
v_cvt_pk_bf16_f32 v36,v116,v117
v_mfma_f32_16x16x16_bf16 v[32:35],v[14:15],v[124:125],0
ds_read_b128 v[108:111],v11 offset:11264
v_exp_f32 v24,v24
v_mfma_f32_16x16x16_bf16 v[112:115],v[126:127],v[124:125],0
ds_read_b128 v[44:47],v11 offset:13312
v_exp_f32 v25,v25
v_mfma_f32_16x16x16_bf16 v[116:119],v[36:37],v[124:125],0
ds_read_b128 v[48:51],v11 offset:14336
v_exp_f32 v26,v26
v_exp_f32 v27,v27
v_cvt_pk_bf16_f32 v120,v24,v25
v_exp_f32 v28,v28
v_exp_f32 v29,v29
v_cvt_pk_bf16_f32 v121,v26,v27
v_exp_f32 v30,v30
v_exp_f32 v31,v31
v_cvt_pk_bf16_f32 v122,v28,v29
v_cvt_pk_bf16_f32 v123,v30,v31
s_mov_b32 s78,s55
s_add_u32 s55,s79,s75
v_mfma_f32_16x16x32_bf16 v[32:35],v[14:17],v[120:123],v[32:35]
ds_read_b128 v[52:55],v11 offset:15360
v_mfma_f32_16x16x32_bf16 v[112:115],v[88:91],v[120:123],v[112:115]
ds_read_b128 v[88:91],v11 offset:16384
v_mfma_f32_16x16x32_bf16 v[116:119],v[92:95],v[120:123],v[116:119]
ds_read_b128 v[92:95],v11 offset:17408
v_rcp_f32 v32,v32
v_mov_b64 v[24:25],-1
v_mov_b64 v[26:27],-1
s_mov_b32 s54,s68
s_add_u32 s75,s75,8192
v_pk_mul_f32 v[112:113],v[112:113],v[32:33] op_sel_hi:[1,0]
v_pk_mul_f32 v[114:115],v[114:115],v[32:33] op_sel_hi:[1,0]
v_pk_mul_f32 v[116:117],v[116:117],v[32:33] op_sel_hi:[1,0]
v_pk_mul_f32 v[118:119],v[118:119],v[32:33] op_sel_hi:[1,0]
v_cvt_pk_bf16_f32 v120,v112,v116
v_cvt_pk_bf16_f32 v121,v113,v117
v_cvt_pk_bf16_f32 v122,v114,v118
v_cvt_pk_bf16_f32 v123,v115,v119
ds_write_b128 v7,v[120:123]
buffer_store_dwordx4 v[24:27],v0,s[8:11],s69 offen
buffer_store_dwordx4 v[24:27],v0,s[8:11],s69 offen offset:1024
s_waitcnt lgkmcnt(0)
s_barrier
ds_read_b128 v[24:27],v8 offset:0
ds_read_b128 v[28:31],v8 offset:512
ds_read_b128 v[32:35],v8 offset:1024
ds_read_b128 v[36:39],v8 offset:1536
v_mov_b64 v[112:113],0
v_mov_b64 v[114:115],0
v_mov_b64 v[116:117],0
v_mov_b64 v[118:119],0
v_mov_b64 v[120:121],0
v_mov_b64 v[122:123],0
s_add_u32 s30,s75,17825792
s_add_u32 s64,s75,12582912
s_add_u32 s70,s64,4096
s_add_u32 s68,s68,131072
s_add_u32 s51,s51,1
s_cmp_eq_u32 s51,64
s_cbranch_scc1 L_cend_164
s_waitcnt lgkmcnt(3)
v_smfmac_f32_16x16x64_bf16 v[112:115],v[24:27],v[56:63],v3
ds_read_b128 v[56:59],v11 offset:18432
s_add_u32 s57,s65,65536
s_waitcnt lgkmcnt(3)
v_smfmac_f32_16x16x64_bf16 v[112:115],v[28:31],v[64:71],v3
ds_read_b128 v[60:63],v11 offset:19456
s_add_u32 s58,s65,131072
s_waitcnt lgkmcnt(3)
v_smfmac_f32_16x16x64_bf16 v[112:115],v[32:35],v[72:79],v3
ds_read_b128 v[64:67],v11 offset:20480
s_add_u32 s59,s65,196608
s_waitcnt lgkmcnt(3)
v_smfmac_f32_16x16x64_bf16 v[112:115],v[36:39],v[80:87],v3
ds_read_b128 v[68:71],v11 offset:21504
v_smfmac_f32_16x16x64_bf16 v[116:119],v[24:27],v[96:103],v3
ds_read_b128 v[72:75],v11 offset:22528
v_smfmac_f32_16x16x64_bf16 v[116:119],v[28:31],v[104:111],v3
ds_read_b128 v[76:79],v11 offset:23552
v_cvt_pk_bf16_f32 v112,v112,v113
v_smfmac_f32_16x16x64_bf16 v[116:119],v[32:35],v[40:47],v3
ds_read_b128 v[80:83],v11 offset:24576
v_cvt_pk_bf16_f32 v113,v114,v115
buffer_store_dwordx2 v[112:113],v9,s[8:11],s65 offen
v_smfmac_f32_16x16x64_bf16 v[116:119],v[36:39],v[48:55],v3
ds_read_b128 v[84:87],v11 offset:25600
v_mov_b64 v[112:113],0
v_smfmac_f32_16x16x64_bf16 v[120:123],v[24:27],v[88:95],v3
ds_read_b128 v[96:99],v11 offset:26624
ds_read_b128 v[100:103],v11 offset:27648
v_mov_b64 v[114:115],0
s_waitcnt lgkmcnt(8)
v_smfmac_f32_16x16x64_bf16 v[120:123],v[28:31],v[56:63],v3
ds_read_b128 v[104:107],v11 offset:28672
v_cvt_pk_bf16_f32 v116,v116,v117
s_waitcnt lgkmcnt(7)
v_smfmac_f32_16x16x64_bf16 v[120:123],v[32:35],v[64:71],v3
ds_read_b128 v[108:111],v11 offset:29696
ds_read_b128 v[40:43],v11 offset:30720
v_cvt_pk_bf16_f32 v117,v118,v119
buffer_store_dwordx2 v[116:117],v9,s[8:11],s57 offen
s_waitcnt lgkmcnt(7)
v_smfmac_f32_16x16x64_bf16 v[120:123],v[36:39],v[72:79],v3
ds_read_b128 v[44:47],v11 offset:31744
s_waitcnt lgkmcnt(6)
v_smfmac_f32_16x16x64_bf16 v[112:115],v[24:27],v[80:87],v3
s_waitcnt lgkmcnt(4)
v_smfmac_f32_16x16x64_bf16 v[112:115],v[28:31],v[96:103],v3
v_cvt_pk_bf16_f32 v120,v120,v121
s_waitcnt lgkmcnt(2)
v_smfmac_f32_16x16x64_bf16 v[112:115],v[32:35],v[104:111],v3
v_cvt_pk_bf16_f32 v121,v122,v123
buffer_store_dwordx2 v[120:121],v9,s[8:11],s58 offen
s_waitcnt lgkmcnt(0)
v_smfmac_f32_16x16x64_bf16 v[112:115],v[36:39],v[40:47],v3
v_mov_b64 v[116:117],0
v_mov_b64 v[118:119],0
s_xor_b32 s65,s65,262144
v_add_u32 v52,s50,v5
v_add_u32 v54,s50,v6
v_mov_b32_dpp v124,v126 quad_perm:[2,3,2,3] row_mask:0xf bank_mask:0xf
v_mov_b32_dpp v125,v127 quad_perm:[2,3,2,3] row_mask:0xf bank_mask:0xf
s_nop 0
v_cvt_pk_bf16_f32 v112,v112,v113
v_cvt_pk_bf16_f32 v113,v114,v115
buffer_store_dwordx2 v[112:113],v9,s[8:11],s59 offen
ds_read_b64_tr_b16 v[52:53],v52
ds_read_b64_tr_b16 v[54:55],v54
s_mov_b32 vcc_lo,0xcccccccc
s_mov_b32 vcc_hi,0xcccccccc
v_mov_b64 v[96:97],0
v_mov_b64 v[98:99],0
v_mov_b64 v[100:101],0
v_mov_b64 v[102:103],0
v_mov_b64 v[104:105],0
v_mov_b64 v[106:107],0
v_mov_b64 v[108:109],0
v_mov_b64 v[110:111],0
v_mov_b64 v[112:113],0
v_mov_b64 v[114:115],0
s_waitcnt lgkmcnt(0)
v_cndmask_b32 v124,v124,v52,vcc
v_cndmask_b32 v125,v125,v53,vcc
v_cndmask_b32 v126,v126,v54,vcc
v_cndmask_b32 v127,v127,v55,vcc
s_add_u32 s56,s18,s75
s_buffer_load_dword s19,s[8:11],s56
v_add_u32 v55,131072,v0
v_add_u32 v123,s73,v55
v_xor_b32 v120,1024,v12
v_xor_b32 v121,2048,v12
v_xor_b32 v122,3072,v12
s_waitcnt vmcnt(0)
buffer_load_dwordx4 v[32:35],v0,s[8:11],s66 offen offset:0 sc1
buffer_load_dwordx4 v[36:39],v0,s[8:11],s66 offen offset:1024 sc1
s_cmp_ge_u32 s51,63
s_cselect_b32 s76,0,1
s_cmp_eq_u32 s46,0
s_cselect_b32 s76,s76,0
s_waitcnt vmcnt(1)
v_mfma_f32_16x16x32_bf16 v[28:31],v[18:21],v[32:35],0
s_waitcnt vmcnt(0)
v_mfma_f32_16x16x32_bf16 v[28:31],v[18:21],v[36:39],v[28:31]
s_nop 7
v_cmp_u_f32 vcc,v28,v28
v_add_f32_dpp v52,v28,v28 row_ror:8 row_mask:0xf bank_mask:0x3
v_add_f32_dpp v53,v29,v29 row_ror:8 row_mask:0xf bank_mask:0x3
v_add_f32_dpp v52,v30,v30 row_ror:8 row_mask:0xf bank_mask:0xc
v_add_f32_dpp v53,v31,v31 row_ror:8 row_mask:0xf bank_mask:0xc
s_nop 0
v_add_f32_dpp v52,v52,v52 row_shl:4 row_mask:0xf bank_mask:0x5
v_add_f32_dpp v53,v53,v53 row_shl:4 row_mask:0xf bank_mask:0x5
s_cbranch_vccnz L_crp_166
L_cok_171:
v_cvt_pk_bf16_f32 v54,v52,v53
buffer_store_dword v54,v10,s[8:11],s64 offen
s_mov_b32 s69,s66
s_xor_b32 s66,s66,262144
s_barrier
ds_read_b128 v[56:59],v55 offset:0
ds_read_b128 v[60:63],v55 offset:4096
buffer_load_dwordx4 v[24:27],v13,s[8:11],s64 offen sc1
buffer_load_dwordx4 v[40:43],v13,s[8:11],s70 offen sc1
ds_read_b128 v[64:67],v55 offset:1024
ds_read_b128 v[68:71],v55 offset:5120
ds_read_b128 v[72:75],v55 offset:2048
ds_read_b128 v[76:79],v55 offset:6144
ds_read_b128 v[80:83],v55 offset:3072
ds_read_b128 v[84:87],v55 offset:7168
ds_read_b128 v[88:91],v123 offset:8192
ds_read_b128 v[92:95],v123 offset:9216
s_branch L_chain_161
L_crp_166:
buffer_load_dwordx4 v[32:35],v0,s[8:11],s66 offen offset:0 sc1
buffer_load_dwordx4 v[36:39],v0,s[8:11],s66 offen offset:1024 sc1
s_sub_u32 s49,s49,1
s_cbranch_scc1 L_abort
s_waitcnt vmcnt(1)
v_mfma_f32_16x16x32_bf16 v[28:31],v[18:21],v[32:35],0
s_waitcnt vmcnt(0)
v_mfma_f32_16x16x32_bf16 v[28:31],v[18:21],v[36:39],v[28:31]
s_nop 7
v_cmp_u_f32 vcc,v28,v28
v_add_f32_dpp v52,v28,v28 row_ror:8 row_mask:0xf bank_mask:0x3
v_add_f32_dpp v53,v29,v29 row_ror:8 row_mask:0xf bank_mask:0x3
v_add_f32_dpp v52,v30,v30 row_ror:8 row_mask:0xf bank_mask:0xc
v_add_f32_dpp v53,v31,v31 row_ror:8 row_mask:0xf bank_mask:0xc
s_nop 0
v_add_f32_dpp v52,v52,v52 row_shl:4 row_mask:0xf bank_mask:0x5
v_add_f32_dpp v53,v53,v53 row_shl:4 row_mask:0xf bank_mask:0x5
s_cbranch_vccz L_cok_171
s_branch L_crp_166
L_ckw_154:
s_add_u32 s59,s18,s75
L_ww_172:
s_sleep 1
buffer_load_dword v23,off,s[8:11],s59 sc1
s_sub_u32 s49,s49,1
s_cbranch_scc1 L_abort
s_waitcnt vmcnt(0)
v_readfirstlane_b32 s76,v23
s_cmp_eq_u32 s76,0
s_cbranch_scc1 L_ww_172
L_wwd_173:
s_branch L_ckb_155
L_cend_164:
v_add_u32 v52,s50,v5
v_add_u32 v54,s50,v6
ds_read_b64_tr_b16 v[52:53],v52
ds_read_b64_tr_b16 v[54:55],v54
v_mov_b32_dpp v124,v126 quad_perm:[2,3,2,3] row_mask:0xf bank_mask:0xf
v_mov_b32_dpp v125,v127 quad_perm:[2,3,2,3] row_mask:0xf bank_mask:0xf
s_mov_b32 vcc_lo,0xcccccccc
s_mov_b32 vcc_hi,0xcccccccc
s_waitcnt lgkmcnt(0)
v_cndmask_b32 v124,v124,v52,vcc
v_cndmask_b32 v125,v125,v53,vcc
v_cndmask_b32 v126,v126,v54,vcc
v_cndmask_b32 v127,v127,v55,vcc
buffer_store_dwordx4 v[124:127],v0,s[8:11],s54 offen sc1
s_waitcnt vmcnt(0)
s_barrier
buffer_store_dword v2,off,s[8:11],s78 sc1
buffer_store_dword v2,off,s[8:11],s55 sc1
s_nop 11
v_lshrrev_b32 v1,4,v0
s_endpgm
L_rc2_125:
v_and_b32 v120,15,v1
v_lshrrev_b32 v121,4,v1
v_and_b32 v122,2,v1
v_cmp_eq_u32 vcc,0,v122
v_mov_b32 v2,0xeeee
v_mov_b32 v123,0x4444
v_cndmask_b32 v2,v2,v123,vcc
v_and_b32 v122,1,v1
v_cmp_eq_u32 vcc,0,v122
v_mov_b32 v3,0xdddd
v_mov_b32 v123,0x8888
v_cndmask_b32 v3,v3,v123,vcc
v_lshrrev_b32 v122,1,v120
v_bfe_u32 v123,v120,2,1
v_xor_b32 v123,v123,v122
v_lshlrev_b32 v4,7,v123
v_and_b32 v123,1,v120
v_lshl_add_u32 v4,v123,6,v4
v_xor_b32 v123,v121,v122
v_and_b32 v123,3,v123
v_lshl_add_u32 v4,v123,4,v4
s_lshl_b32 s56,s46,10
s_add_u32 s56,s56,147456
v_add_u32 v4,s56,v4
v_lshlrev_b32 v122,1,v121
v_add_u32 v122,0,v122
v_and_b32 v123,1,v121
v_xor_b32 v123,v123,v122
v_lshlrev_b32 v5,7,v123
v_bfe_u32 v123,v120,3,1
v_lshl_add_u32 v5,v123,6,v5
v_xor_b32 v123,v120,v122
v_and_b32 v123,3,v123
v_lshl_add_u32 v5,v123,4,v5
v_bfe_u32 v123,v120,2,1
v_lshl_add_u32 v5,v123,3,v5
v_add_u32 v5,147456,v5
v_lshlrev_b32 v122,1,v121
v_add_u32 v122,1,v122
v_and_b32 v123,1,v121
v_xor_b32 v123,v123,v122
v_lshlrev_b32 v6,7,v123
v_bfe_u32 v123,v120,3,1
v_lshl_add_u32 v6,v123,6,v6
v_xor_b32 v123,v120,v122
v_and_b32 v123,3,v123
v_lshl_add_u32 v6,v123,4,v6
v_bfe_u32 v123,v120,2,1
v_lshl_add_u32 v6,v123,3,v6
v_add_u32 v6,147456,v6
v_lshlrev_b32 v7,7,v121
v_lshrrev_b32 v122,1,v120
v_lshl_add_u32 v8,v122,4,v7
v_add_u32 v8,151552,v8
v_lshrrev_b32 v122,2,v120
v_lshl_add_u32 v7,v122,5,v7
v_and_b32 v122,1,v120
v_lshl_add_u32 v7,v122,4,v7
v_and_b32 v122,2,v120
v_cmp_eq_u32 vcc,0,v122
s_lshl_b32 s56,s46,9
v_mov_b32 v122,2048
v_mov_b32 v123,s56
v_cndmask_b32 v122,v122,v123,vcc
v_add_u32 v7,v122,v7
v_add_u32 v7,151552,v7
v_lshrrev_b32 v122,3,v1
v_lshlrev_b32 v9,11,v122
v_and_b32 v122,7,v1
v_lshl_add_u32 v9,v122,3,v9
s_lshl_b32 s56,s46,14
s_lshl_b32 s57,s47,6
s_add_u32 s56,s56,s57
v_add_u32 v9,s56,v9
s_lshl_b32 s71,s47,2
s_add_u32 s71,s71,s46
s_bfe_u32 s56,s71,0x10003
s_lshl_b32 s56,s56,11
s_and_b32 s57,s71,1
s_lshl_b32 s57,s57,10
s_add_u32 s56,s56,s57
s_bfe_u32 s57,s71,0x10002
s_lshl_b32 s57,s57,9
s_add_u32 s56,s56,s57
s_bfe_u32 s57,s71,0x10001
s_lshl_b32 s57,s57,6
s_add_u32 s56,s56,s57
s_bfe_u32 s57,s71,0x10004
s_lshl_b32 s57,s57,8
s_add_u32 s56,s56,s57
s_bfe_u32 s57,s71,0x10005
s_lshl_b32 s57,s57,7
s_add_u32 s56,s56,s57
s_bfe_u32 s57,s71,0x10006
s_lshl_b32 s57,s57,12
s_add_u32 s56,s56,s57
v_and_b32 v122,3,v120
v_lshlrev_b32 v10,2,v122
v_bfe_u32 v122,v120,3,1
v_lshl_add_u32 v10,v122,4,v10
v_and_b32 v122,1,v121
v_lshl_add_u32 v10,v122,5,v10
v_add_u32 v10,s56,v10
v_and_b32 v123,36,v1
v_mov_b32 v122,0x80000000
v_cmp_eq_u32 vcc,0,v123
s_nop 1
v_cndmask_b32 v10,v122,v10,vcc
s_lshl_b32 s56,s46,15
v_add_u32 v11,s56,v0
s_lshl_b32 s71,s71,11
s_lshl_b32 s73,s46,11
s_mov_b32 s72,0xffc00000
s_mov_b32 s74,0
v_lshrrev_b32 v13,3,v1
v_lshlrev_b32 v13,9,v13
v_and_b32 v122,7,v1
v_lshl_add_u32 v13,v122,4,v13
v_and_b32 v122,15,v1
v_and_b32 v123,1,v1
v_lshlrev_b32 v123,4,v123
v_mov_b32 v124,0x3f80
v_lshlrev_b32 v124,v123,v124
v_lshrrev_b32 v122,1,v122
v_cmp_eq_u32 vcc,0,v122
s_nop 1
v_cndmask_b32 v18,0,v124,vcc
v_cmp_eq_u32 vcc,1,v122
s_nop 1
v_cndmask_b32 v19,0,v124,vcc
v_cmp_eq_u32 vcc,2,v122
s_nop 1
v_cndmask_b32 v20,0,v124,vcc
v_cmp_eq_u32 vcc,3,v122
s_nop 1
v_cndmask_b32 v21,0,v124,vcc
s_and_b32 s56,s46,1
s_lshl_b32 s56,s56,8
s_and_b32 s57,s46,2
s_lshl_b32 s57,s57,6
s_add_u32 s56,s56,s57
v_add_u32 v13,s56,v13
s_add_u32 s56,s50,155648
v_add_u32 v12,s56,v0
v_mov_b64 v[14:15],s[28:29]
v_mov_b64 v[16:17],s[28:29]
v_add_u32 v22,13647872,v10
s_lshl_b32 s18,s47,2
s_add_u32 s18,s18,10494080
v_mov_b32 v1,s80
s_mov_b32 s65,16777216
s_add_u32 s66,s71,16777216
s_add_u32 s69,s71,17039360
s_lshl_b32 s79,s47,2
s_add_u32 s79,s79,10486400
s_cmp_eq_u32 s46,0
s_cselect_b32 s79,s79,0x80000000
s_mov_b32 s30,0x40000000
s_mov_b32 s51,0
v_lshrrev_b32 v120,2,v0
v_add_u32 v120,10510464,v120
v_or_b32 v120,s52,v120
s_mov_b64 vcc,-1
s_mov_b32 vcc_lo,0
v_cndmask_b32 v22,v22,v120,vcc
s_or_b32 s56,s52,10495616
v_writelane_b32 v22,s56,4
s_or_b32 s56,s47,s46
s_mov_b32 s56,10486784
s_cmov_b32 s56,0x80000000
v_writelane_b32 v22,s56,5
s_mov_b32 s30,0
s_mov_b32 s31,0
buffer_load_dwordx4 v[56:59],v0,s[8:11],s66 offen offset:0
buffer_load_dwordx4 v[60:63],v0,s[8:11],s66 offen offset:1024
buffer_load_dwordx4 v[64:67],v0,s[8:11],s69 offen offset:0
buffer_load_dwordx4 v[68:71],v0,s[8:11],s69 offen offset:1024
s_waitcnt vmcnt(0)
L_cst_177:
s_cmp_lg_u32 s46,0
s_cbranch_scc1 L_csw_182
s_lshl_b32 s59,s31,13
s_add_u32 s59,s59,10486016
v_lshrrev_b32 v121,2,v0
v_and_b32 v121,127,v121
L_ckk_183:
s_sleep 1
buffer_load_dword v120,v121,s[8:11],s59 offen sc1
s_sub_u32 s49,s49,1
s_cbranch_scc1 L_abort
s_waitcnt vmcnt(0)
v_cmp_eq_u32 vcc,0,v120
s_cbranch_vccnz L_ckk_183
v_max_u32_dpp v120,v120,v120 row_ror:8 row_mask:0xf bank_mask:0xf
s_nop 1
v_max_u32_dpp v120,v120,v120 row_ror:4 row_mask:0xf bank_mask:0xf
s_nop 1
v_max_u32_dpp v120,v120,v120 row_ror:2 row_mask:0xf bank_mask:0xf
s_nop 1
v_max_u32_dpp v120,v120,v120 row_ror:1 row_mask:0xf bank_mask:0xf
v_mov_b32 v121,v120
s_nop 1
v_permlane16_swap_b32 v120,v121
v_max_u32 v120,v120,v121
v_mov_b32 v121,v120
s_nop 1
v_permlane32_swap_b32 v120,v121
v_max_u32 v120,v120,v121
s_nop 0
v_readfirstlane_b32 s61,v120
s_max_u32 s30,s30,s61
s_add_u32 s31,s31,1
s_andn2_b32 s51,0x7ff,s30
s_lshr_b32 s51,s51,5
s_add_u32 s61,s51,2
s_min_u32 s61,s61,63
s_cmp_le_u32 s31,s61
s_cbranch_scc1 L_cst_177
v_mov_b32 v120,0
v_mov_b32 v121,s30
ds_write_b32 v8,v120 offset:2560
ds_write_b32 v8,v121 offset:3072
s_lshl_b32 s59,s51,13
s_lshl2_add_u32 s59,s47,s59
s_add_u32 s59,s59,10485888
L_ww_184:
s_sleep 1
buffer_load_dword v122,off,s[8:11],s59 sc1
s_sub_u32 s49,s49,1
s_cbranch_scc1 L_abort
s_waitcnt vmcnt(0)
v_readfirstlane_b32 s61,v122
s_cmp_eq_u32 s61,0
s_cbranch_scc1 L_ww_184
L_wwd_185:
L_csw_182:
s_waitcnt lgkmcnt(0)
s_barrier
ds_read_b32 v120,v8 offset:3072
s_waitcnt lgkmcnt(0)
v_readfirstlane_b32 s30,v120
s_andn2_b32 s51,0x7ff,s30
s_lshr_b32 s51,s51,5
s_lshl_b32 s56,s51,5
s_add_u32 s56,s56,s47
s_mul_i32 s56,s56,24576
s_add_u32 s56,s56,150994944
s_add_u32 s67,s56,s73
s_add_u32 m0,s73,131072
s_add_u32 s57,s67,8192
buffer_load_dwordx4 v0,s[8:11],s67 offen sc1 lds
buffer_load_dwordx4 v0,s[8:11],s67 offen offset:1024 sc1 lds
s_add_u32 m0,s73,139264
s_add_u32 s67,s67,786432
buffer_load_dwordx4 v0,s[8:11],s57 offen sc1 lds
buffer_load_dwordx4 v0,s[8:11],s57 offen offset:1024 sc1 lds
s_lshl_b32 s75,s51,13
s_add_u32 s56,s75,13639680
buffer_load_dword v23,v10,s[8:11],s56 offen sc1
s_add_u32 s64,s75,17825792
s_add_u32 s70,s64,4096
s_lshl_b32 s68,s51,5
s_add_u32 s68,s68,s47
s_lshl_b32 s68,s68,12
s_lshl_b32 s56,s46,10
s_add_u32 s68,s68,s56
s_add_u32 s68,s68,75497472
s_mov_b32 s78,0x80000000
s_mov_b32 s55,0x80000000
s_mov_b32 s54,0x80000000
s_mov_b32 s77,0
s_mov_b32 s19,0
s_cmp_eq_u32 s51,63
s_cselect_b32 s76,1,s46
s_cmp_eq_u32 s76,0
s_cselect_b32 s76,1,0
v_mov_b64 v[96:97],0
v_mov_b64 v[98:99],0
v_mov_b64 v[100:101],0
v_mov_b64 v[102:103],0
v_mov_b64 v[104:105],0
v_mov_b64 v[106:107],0
v_mov_b64 v[108:109],0
v_mov_b64 v[110:111],0
v_mov_b64 v[112:113],0
v_mov_b64 v[114:115],0
v_mov_b64 v[116:117],0
v_mov_b64 v[118:119],0
v_lshrrev_b32 v56,8,v0
v_lshlrev_b32 v56,5,v56
v_bfe_u32 v57,v0,5,1
v_lshl_add_u32 v56,v57,2,v56
s_lshl_b32 s56,s46,7
s_add_u32 s56,s56,155648
v_add_u32 v56,s56,v56
v_xor_b32 v57,128,v56
v_xor_b32 v58,256,v56
v_xor_b32 v59,384,v56
s_andn2_b32 s56,31,s30
s_lshr_b32 s57,s56,4
s_lshl_b32 s58,s57,12
s_and_b32 s59,s56,15
s_lshl4_add_u32 s58,s59,s58
s_add_u32 s58,s58,s50
s_add_u32 s58,s58,131072
v_bfe_u32 v60,v0,6,2
v_lshlrev_b32 v60,8,v60
v_bfe_u32 v61,v0,4,2
v_lshl_add_u32 v60,v61,2,v60
v_add_u32 v60,s58,v60
s_lshr_b32 s58,s59,2
s_lshl_b32 s58,s58,8
s_lshl3_add_u32 s58,s57,s58
s_and_b32 s59,s56,3
s_lshl1_add_u32 s58,s59,s58
s_add_u32 s58,s58,s73
s_add_u32 s58,s58,139264
v_and_b32 v61,255,v0
v_add_u32 v61,s58,v61
s_cmp_lg_u32 s46,0
s_cbranch_scc1 L_chd_187
s_lshl_b32 s59,s51,10
s_add_u32 s59,s59,11337728
L_chp_186:
buffer_load_dwordx4 v[120:123],v0,s[8:11],s59 offen sc1
s_sub_u32 s49,s49,1
s_cbranch_scc1 L_abort
s_waitcnt vmcnt(0)
v_max3_u32 v124,v120,v121,v122
v_max_u32 v124,v123,v124
v_cmp_eq_u32 vcc,-1,v124
s_cbranch_vccnz L_chp_186
ds_write_b128 v12,v[120:123]
L_chd_187:
s_waitcnt vmcnt(0) lgkmcnt(0)
s_barrier
ds_read2_b32 v[24:25],v56 offset0:0 offset1:2
ds_read2_b32 v[26:27],v56 offset0:4 offset1:6
ds_read2_b32 v[28:29],v57 offset0:0 offset1:2
ds_read2_b32 v[30:31],v57 offset0:4 offset1:6
ds_read2_b32 v[32:33],v58 offset0:0 offset1:2
ds_read2_b32 v[34:35],v58 offset0:4 offset1:6
ds_read2_b32 v[36:37],v59 offset0:0 offset1:2
ds_read2_b32 v[38:39],v59 offset0:4 offset1:6
s_waitcnt lgkmcnt(4)
ds_read2_b32 v[40:41],v56 offset0:128 offset1:130
ds_read2_b32 v[42:43],v56 offset0:132 offset1:134
ds_read2_b32 v[44:45],v57 offset0:128 offset1:130
ds_read2_b32 v[46:47],v57 offset0:132 offset1:134
ds_read2_b32 v[48:49],v58 offset0:128 offset1:130
ds_read2_b32 v[50:51],v58 offset0:132 offset1:134
ds_read2_b32 v[52:53],v59 offset0:128 offset1:130
ds_read2_b32 v[54:55],v59 offset0:132 offset1:134
s_waitcnt lgkmcnt(12)
v_smfmac_f32_16x16x64_bf16 v[100:103],v[24:27],a[128:135],v2
v_smfmac_f32_16x16x64_bf16 v[112:115],v[24:27],v[128:135],v2
v_smfmac_f32_16x16x64_bf16 v[108:111],v[24:27],a[136:143],v2
v_smfmac_f32_16x16x64_bf16 v[116:119],v[24:27],v[136:143],v2
s_waitcnt lgkmcnt(12)
v_smfmac_f32_16x16x64_bf16 v[100:103],v[28:31],a[144:151],v2
v_smfmac_f32_16x16x64_bf16 v[112:115],v[28:31],v[144:151],v2
v_smfmac_f32_16x16x64_bf16 v[108:111],v[28:31],a[152:159],v2
v_smfmac_f32_16x16x64_bf16 v[116:119],v[28:31],v[152:159],v2
s_waitcnt lgkmcnt(10)
v_smfmac_f32_16x16x64_bf16 v[100:103],v[32:35],a[160:167],v2
v_smfmac_f32_16x16x64_bf16 v[112:115],v[32:35],v[160:167],v2
v_smfmac_f32_16x16x64_bf16 v[108:111],v[32:35],a[168:175],v2
v_smfmac_f32_16x16x64_bf16 v[116:119],v[32:35],v[168:175],v2
s_waitcnt lgkmcnt(8)
v_smfmac_f32_16x16x64_bf16 v[100:103],v[36:39],a[176:183],v2
v_smfmac_f32_16x16x64_bf16 v[112:115],v[36:39],v[176:183],v2
v_smfmac_f32_16x16x64_bf16 v[108:111],v[36:39],a[184:191],v2
v_smfmac_f32_16x16x64_bf16 v[116:119],v[36:39],v[184:191],v2
s_waitcnt lgkmcnt(6)
v_smfmac_f32_16x16x64_bf16 v[100:103],v[40:43],a[192:199],v2
v_smfmac_f32_16x16x64_bf16 v[112:115],v[40:43],v[192:199],v2
v_smfmac_f32_16x16x64_bf16 v[108:111],v[40:43],a[200:207],v2
v_smfmac_f32_16x16x64_bf16 v[116:119],v[40:43],v[200:207],v2
s_waitcnt lgkmcnt(4)
v_smfmac_f32_16x16x64_bf16 v[100:103],v[44:47],a[208:215],v2
v_smfmac_f32_16x16x64_bf16 v[112:115],v[44:47],v[208:215],v2
v_smfmac_f32_16x16x64_bf16 v[108:111],v[44:47],a[216:223],v2
v_smfmac_f32_16x16x64_bf16 v[116:119],v[44:47],v[216:223],v2
s_waitcnt lgkmcnt(2)
v_smfmac_f32_16x16x64_bf16 v[100:103],v[48:51],a[224:231],v2
v_smfmac_f32_16x16x64_bf16 v[112:115],v[48:51],v[224:231],v2
v_smfmac_f32_16x16x64_bf16 v[108:111],v[48:51],a[232:239],v2
v_smfmac_f32_16x16x64_bf16 v[116:119],v[48:51],v[232:239],v2
s_waitcnt lgkmcnt(0)
v_smfmac_f32_16x16x64_bf16 v[100:103],v[52:55],a[240:247],v2
v_smfmac_f32_16x16x64_bf16 v[112:115],v[52:55],v[240:247],v2
v_smfmac_f32_16x16x64_bf16 v[108:111],v[52:55],a[248:255],v2
v_smfmac_f32_16x16x64_bf16 v[116:119],v[52:55],v[248:255],v2
v_add_f32 v100,v100,v102
v_add_f32 v112,v112,v114
s_nop 1
v_add_f32 v108,v108,v110
s_nop 2
v_add_f32 v116,v116,v118
v_cvt_pk_bf16_f32 v120,v100,v108
v_cvt_pk_bf16_f32 v121,v112,v116
ds_write_b32 v60,v120
ds_write_b16 v61,v121
ds_write_b16_d16_hi v61,v121 offset:1024
v_mov_b64 v[96:97],0
v_mov_b64 v[98:99],0
v_mov_b64 v[100:101],0
v_mov_b64 v[102:103],0
v_mov_b64 v[104:105],0
v_mov_b64 v[106:107],0
v_mov_b64 v[108:109],0
v_mov_b64 v[110:111],0
v_mov_b64 v[112:113],0
v_mov_b64 v[114:115],0
v_mov_b64 v[116:117],0
v_mov_b64 v[118:119],0
s_waitcnt vmcnt(0) lgkmcnt(0)
s_barrier
v_add_u32 v55,131072,v0
ds_read_b128 v[56:59],v55 offset:0
ds_read_b128 v[60:63],v55 offset:4096
ds_read_b128 v[64:67],v55 offset:1024
ds_read_b128 v[68:71],v55 offset:5120
ds_read_b128 v[72:75],v55 offset:2048
ds_read_b128 v[76:79],v55 offset:6144
ds_read_b128 v[80:83],v55 offset:3072
ds_read_b128 v[84:87],v55 offset:7168
v_add_u32 v123,s73,v55
ds_read_b128 v[88:91],v123 offset:8192
ds_read_b128 v[92:95],v123 offset:9216
v_xor_b32 v120,1024,v12
v_xor_b32 v121,2048,v12
v_xor_b32 v122,3072,v12
buffer_load_dwordx4 v[24:27],v13,s[8:11],s64 offen sc1
buffer_load_dwordx4 v[40:43],v13,s[8:11],s70 offen sc1
L_chain_188:
L_cpa_189:
buffer_load_dwordx4 v[24:27],v13,s[8:11],s64 offen sc1
buffer_load_dwordx4 v[40:43],v13,s[8:11],s70 offen sc1
s_sub_u32 s49,s49,1
s_cbranch_scc1 L_abort
s_waitcnt vmcnt(2)
v_max3_u32 v123,v24,v25,v26
v_max3_u32 v123,v27,v40,v123
v_max3_u32 v123,v41,v42,v123
v_max_u32 v123,v43,v123
v_cmp_le_u32 vcc,s72,v123
s_cbranch_vccnz L_cpa_189
ds_write_b128 v12,v[24:27] offset:0
ds_write_b128 v12,v[40:43] offset:4096
v_smfmac_f32_16x16x64_bf16 v[96:99],v[24:27],a[0:7],v2
buffer_store_dwordx4 v[124:127],v0,s[8:11],s54 offen sc1
v_smfmac_f32_16x16x64_bf16 v[100:103],v[24:27],a[128:135],v2
s_add_u32 m0,s73,131072
s_add_u32 s57,s67,8192
v_smfmac_f32_16x16x64_bf16 v[104:107],v[24:27],a[8:15],v2
v_smfmac_f32_16x16x64_bf16 v[108:111],v[24:27],a[136:143],v2
s_waitcnt lgkmcnt(0)
s_cmp_lt_u32 s19,s76
s_cbranch_scc1 L_ckw_178
L_ckb_179:
s_barrier
ds_read_b32 v123,v8 offset:2560
ds_read_b128 v[28:31],v120 offset:0
ds_read_b128 v[32:35],v121 offset:0
v_smfmac_f32_16x16x64_bf16 v[96:99],v[40:43],a[64:71],v2
ds_read_b128 v[36:39],v122 offset:0
v_smfmac_f32_16x16x64_bf16 v[100:103],v[40:43],a[192:199],v2
ds_read_b128 v[44:47],v120 offset:4096
v_smfmac_f32_16x16x64_bf16 v[104:107],v[40:43],a[72:79],v2
ds_read_b128 v[48:51],v121 offset:4096
v_smfmac_f32_16x16x64_bf16 v[108:111],v[40:43],a[200:207],v2
ds_read_b128 v[52:55],v122 offset:4096
v_smfmac_f32_16x16x64_bf16 v[112:115],v[24:27],v[128:135],v2
buffer_load_dwordx4 v0,s[8:11],s67 offen sc1 lds
v_smfmac_f32_16x16x64_bf16 v[116:119],v[24:27],v[136:143],v2
v_smfmac_f32_16x16x64_bf16 v[112:115],v[40:43],v[192:199],v2
buffer_load_dwordx4 v0,s[8:11],s67 offen offset:1024 sc1 lds
v_smfmac_f32_16x16x64_bf16 v[116:119],v[40:43],v[200:207],v2
s_waitcnt lgkmcnt(5)
v_smfmac_f32_16x16x64_bf16 v[96:99],v[28:31],a[16:23],v2
s_add_u32 m0,s73,139264
v_smfmac_f32_16x16x64_bf16 v[100:103],v[28:31],a[144:151],v2
buffer_load_dwordx4 v0,s[8:11],s57 offen sc1 lds
v_smfmac_f32_16x16x64_bf16 v[104:107],v[28:31],a[24:31],v2
s_add_u32 s67,s67,786432
v_smfmac_f32_16x16x64_bf16 v[108:111],v[28:31],a[152:159],v2
v_readfirstlane_b32 s58,v123
s_waitcnt lgkmcnt(4)
v_smfmac_f32_16x16x64_bf16 v[96:99],v[32:35],a[32:39],v2
buffer_load_dwordx4 v0,s[8:11],s57 offen offset:1024 sc1 lds
v_smfmac_f32_16x16x64_bf16 v[100:103],v[32:35],a[160:167],v2
s_cmp_lg_u32 s58,0
s_cbranch_scc1 L_cjump_181
v_smfmac_f32_16x16x64_bf16 v[104:107],v[32:35],a[40:47],v2
v_smfmac_f32_16x16x64_bf16 v[108:111],v[32:35],a[168:175],v2
buffer_load_dword v23,v22,s[8:11],s75 offen sc1
s_waitcnt lgkmcnt(3)
v_smfmac_f32_16x16x64_bf16 v[96:99],v[36:39],a[48:55],v2
v_mov_b32 v125,0
v_smfmac_f32_16x16x64_bf16 v[100:103],v[36:39],a[176:183],v2
v_smfmac_f32_16x16x64_bf16 v[104:107],v[36:39],a[56:63],v2
buffer_store_dword v2,off,s[8:11],s78 sc1
v_smfmac_f32_16x16x64_bf16 v[108:111],v[36:39],a[184:191],v2
s_waitcnt lgkmcnt(0)
v_smfmac_f32_16x16x64_bf16 v[96:99],v[44:47],a[80:87],v2
v_smfmac_f32_16x16x64_bf16 v[100:103],v[44:47],a[208:215],v2
v_smfmac_f32_16x16x64_bf16 v[96:99],v[48:51],a[96:103],v2
v_smfmac_f32_16x16x64_bf16 v[100:103],v[48:51],a[224:231],v2
v_smfmac_f32_16x16x64_bf16 v[96:99],v[52:55],a[112:119],v2
v_smfmac_f32_16x16x64_bf16 v[100:103],v[52:55],a[240:247],v2
v_smfmac_f32_16x16x64_bf16 v[104:107],v[44:47],a[88:95],v2
v_smfmac_f32_16x16x64_bf16 v[108:111],v[44:47],a[216:223],v2
v_smfmac_f32_16x16x64_bf16 v[104:107],v[48:51],a[104:111],v2
v_add_f32 v96,v96,v98
v_smfmac_f32_16x16x64_bf16 v[108:111],v[48:51],a[232:239],v2
v_add_f32 v97,v97,v99
v_smfmac_f32_16x16x64_bf16 v[104:107],v[52:55],a[120:127],v2
v_cvt_pk_bf16_f32 v120,v96,v97
v_smfmac_f32_16x16x64_bf16 v[108:111],v[52:55],a[248:255],v2
v_add_f32 v100,v100,v102
v_smfmac_f32_16x16x64_bf16 v[112:115],v[28:31],v[144:151],v2
v_add_f32 v101,v101,v103
v_smfmac_f32_16x16x64_bf16 v[116:119],v[28:31],v[152:159],v2
v_cvt_pk_bf16_f32 v121,v100,v101
v_add_f32 v104,v104,v106
v_add_f32 v105,v105,v107
v_cvt_pk_bf16_f32 v122,v104,v105
v_add_f32 v108,v108,v110
v_add_f32 v109,v109,v111
v_cvt_pk_bf16_f32 v123,v108,v109
ds_write_b128 v4,v[120:123]
v_smfmac_f32_16x16x64_bf16 v[112:115],v[32:35],v[160:167],v2
v_smfmac_f32_16x16x64_bf16 v[116:119],v[32:35],v[168:175],v2
v_smfmac_f32_16x16x64_bf16 v[112:115],v[36:39],v[176:183],v2
v_smfmac_f32_16x16x64_bf16 v[116:119],v[36:39],v[184:191],v2
s_waitcnt vmcnt(7) lgkmcnt(0)
s_barrier
ds_read_b64_tr_b16 v[96:97],v5 offset:0
ds_read_b64_tr_b16 v[98:99],v6 offset:0
v_smfmac_f32_16x16x64_bf16 v[112:115],v[44:47],v[208:215],v2
ds_read_b64_tr_b16 v[100:101],v5 offset:1024
v_smfmac_f32_16x16x64_bf16 v[116:119],v[44:47],v[216:223],v2
ds_read_b64_tr_b16 v[102:103],v6 offset:1024
v_smfmac_f32_16x16x64_bf16 v[112:115],v[48:51],v[224:231],v2
ds_read_b64_tr_b16 v[104:105],v5 offset:2048
v_smfmac_f32_16x16x64_bf16 v[116:119],v[48:51],v[232:239],v2
ds_read_b64_tr_b16 v[106:107],v6 offset:2048
s_waitcnt lgkmcnt(4)
v_mfma_f32_16x16x32_bf16 v[24:27],v[56:59],v[96:99],0
ds_read_b64_tr_b16 v[108:109],v5 offset:3072
v_mfma_f32_16x16x32_bf16 v[28:31],v[60:63],v[96:99],0
ds_read_b64_tr_b16 v[110:111],v6 offset:3072
v_mfma_f32_16x16x32_bf16 v[32:35],v[96:99],v[96:99],0
ds_read_b128 v[40:43],v11 offset:12288
s_waitcnt lgkmcnt(5)
v_mfma_f32_16x16x32_bf16 v[24:27],v[64:67],v[100:103],v[24:27]
ds_read_b128 v[56:59],v11 offset:0
v_mfma_f32_16x16x32_bf16 v[28:31],v[68:71],v[100:103],v[28:31]
ds_read_b128 v[60:63],v11 offset:1024
v_mfma_f32_16x16x32_bf16 v[32:35],v[100:103],v[100:103],v[32:35]
ds_read_b128 v[96:99],v11 offset:8192
s_waitcnt lgkmcnt(6)
v_mfma_f32_16x16x32_bf16 v[24:27],v[72:75],v[104:107],v[24:27]
ds_read_b128 v[64:67],v11 offset:2048
v_mfma_f32_16x16x32_bf16 v[28:31],v[76:79],v[104:107],v[28:31]
ds_read_b128 v[68:71],v11 offset:3072
v_mfma_f32_16x16x32_bf16 v[32:35],v[104:107],v[104:107],v[32:35]
ds_read_b128 v[100:103],v11 offset:9216
s_waitcnt lgkmcnt(7)
v_mfma_f32_16x16x32_bf16 v[24:27],v[80:83],v[108:111],v[24:27]
ds_read_b128 v[72:75],v11 offset:4096
v_mfma_f32_16x16x32_bf16 v[28:31],v[84:87],v[108:111],v[28:31]
ds_read_b128 v[76:79],v11 offset:5120
v_mfma_f32_16x16x32_bf16 v[32:35],v[108:111],v[108:111],v[32:35]
ds_read_b128 v[104:107],v11 offset:10240
v_smfmac_f32_16x16x64_bf16 v[112:115],v[52:55],v[240:247],v2
ds_read_b128 v[80:83],v11 offset:6144
v_smfmac_f32_16x16x64_bf16 v[116:119],v[52:55],v[248:255],v2
ds_read_b128 v[84:87],v11 offset:7168
v_max3_f32 v126,v24,v25,v26
v_max3_f32 v127,v27,v28,v29
v_max3_f32 v126,v30,v31,v126
v_max3_f32 v127,v34,v35,v127
v_max_f32 v126,v126,v127
v_max_f32 v127,v126,v127
v_pk_mul_f32 v[34:35],v[34:35],v[0:1] op_sel:[0,1]
v_pk_mul_f32 v[24:25],v[24:25],v[0:1] op_sel:[0,1]
v_permlane16_swap_b32 v126,v127
v_max_f32 v126,v126,v127
v_max_f32 v127,v126,v127
v_pk_mul_f32 v[26:27],v[26:27],v[0:1] op_sel:[0,1]
v_pk_mul_f32 v[28:29],v[28:29],v[0:1] op_sel:[0,1]
v_permlane32_swap_b32 v126,v127
v_max_f32 v126,v126,v127
v_mul_f32 v126,v1,v126
v_pk_mul_f32 v[30:31],v[30:31],v[0:1] op_sel:[0,1]
v_pk_add_f32 v[34:35],v[34:35],v[126:127] op_sel_hi:[1,0] neg_lo:[0,1] neg_hi:[0,1]
v_pk_add_f32 v[112:113],v[112:113],v[114:115]
v_pk_add_f32 v[116:117],v[116:117],v[118:119]
v_pk_add_f32 v[24:25],v[24:25],v[126:127] op_sel_hi:[1,0] neg_lo:[0,1] neg_hi:[0,1]
v_pk_add_f32 v[26:27],v[26:27],v[126:127] op_sel_hi:[1,0] neg_lo:[0,1] neg_hi:[0,1]
v_pk_add_f32 v[28:29],v[28:29],v[126:127] op_sel_hi:[1,0] neg_lo:[0,1] neg_hi:[0,1]
v_pk_add_f32 v[30:31],v[30:31],v[126:127] op_sel_hi:[1,0] neg_lo:[0,1] neg_hi:[0,1]
v_exp_f32 v34,v34
v_exp_f32 v35,v35
v_cvt_pk_bf16_f32 v126,v112,v113
v_cvt_pk_bf16_f32 v124,v34,v35
v_cvt_pk_bf16_f32 v127,v116,v117
v_cvt_pk_bf16_f32 v36,v116,v117
v_mfma_f32_16x16x16_bf16 v[32:35],v[14:15],v[124:125],0
ds_read_b128 v[108:111],v11 offset:11264
v_exp_f32 v24,v24
v_mfma_f32_16x16x16_bf16 v[112:115],v[126:127],v[124:125],0
ds_read_b128 v[44:47],v11 offset:13312
v_exp_f32 v25,v25
v_mfma_f32_16x16x16_bf16 v[116:119],v[36:37],v[124:125],0
ds_read_b128 v[48:51],v11 offset:14336
v_exp_f32 v26,v26
v_exp_f32 v27,v27
v_cvt_pk_bf16_f32 v120,v24,v25
v_exp_f32 v28,v28
v_exp_f32 v29,v29
v_cvt_pk_bf16_f32 v121,v26,v27
v_exp_f32 v30,v30
v_exp_f32 v31,v31
v_cvt_pk_bf16_f32 v122,v28,v29
v_cvt_pk_bf16_f32 v123,v30,v31
s_mov_b32 s78,s55
s_add_u32 s55,s79,s75
v_mfma_f32_16x16x32_bf16 v[32:35],v[14:17],v[120:123],v[32:35]
ds_read_b128 v[52:55],v11 offset:15360
v_mfma_f32_16x16x32_bf16 v[112:115],v[88:91],v[120:123],v[112:115]
ds_read_b128 v[88:91],v11 offset:16384
v_mfma_f32_16x16x32_bf16 v[116:119],v[92:95],v[120:123],v[116:119]
ds_read_b128 v[92:95],v11 offset:17408
v_rcp_f32 v32,v32
v_mov_b64 v[24:25],-1
v_mov_b64 v[26:27],-1
s_mov_b32 s54,s68
s_add_u32 s75,s75,8192
v_pk_mul_f32 v[112:113],v[112:113],v[32:33] op_sel_hi:[1,0]
v_pk_mul_f32 v[114:115],v[114:115],v[32:33] op_sel_hi:[1,0]
v_pk_mul_f32 v[116:117],v[116:117],v[32:33] op_sel_hi:[1,0]
v_pk_mul_f32 v[118:119],v[118:119],v[32:33] op_sel_hi:[1,0]
v_cvt_pk_bf16_f32 v120,v112,v116
v_cvt_pk_bf16_f32 v121,v113,v117
v_cvt_pk_bf16_f32 v122,v114,v118
v_cvt_pk_bf16_f32 v123,v115,v119
ds_write_b128 v7,v[120:123]
buffer_store_dwordx4 v[24:27],v0,s[8:11],s69 offen
buffer_store_dwordx4 v[24:27],v0,s[8:11],s69 offen offset:1024
s_waitcnt lgkmcnt(0)
s_barrier
ds_read_b128 v[24:27],v8 offset:0
ds_read_b128 v[28:31],v8 offset:512
ds_read_b128 v[32:35],v8 offset:1024
ds_read_b128 v[36:39],v8 offset:1536
v_mov_b64 v[112:113],0
v_mov_b64 v[114:115],0
v_mov_b64 v[116:117],0
v_mov_b64 v[118:119],0
v_mov_b64 v[120:121],0
v_mov_b64 v[122:123],0
s_add_u32 s64,s75,13631488
s_add_u32 s70,s64,4096
s_add_u32 s68,s68,131072
s_add_u32 s51,s51,1
s_cmp_eq_u32 s51,64
s_cbranch_scc1 L_cend_191
s_waitcnt lgkmcnt(3)
v_smfmac_f32_16x16x64_bf16 v[112:115],v[24:27],v[56:63],v3
ds_read_b128 v[56:59],v11 offset:18432
s_add_u32 s57,s65,65536
s_waitcnt lgkmcnt(3)
v_smfmac_f32_16x16x64_bf16 v[112:115],v[28:31],v[64:71],v3
ds_read_b128 v[60:63],v11 offset:19456
s_add_u32 s58,s65,131072
s_waitcnt lgkmcnt(3)
v_smfmac_f32_16x16x64_bf16 v[112:115],v[32:35],v[72:79],v3
ds_read_b128 v[64:67],v11 offset:20480
s_add_u32 s59,s65,196608
s_waitcnt lgkmcnt(3)
v_smfmac_f32_16x16x64_bf16 v[112:115],v[36:39],v[80:87],v3
ds_read_b128 v[68:71],v11 offset:21504
v_smfmac_f32_16x16x64_bf16 v[116:119],v[24:27],v[96:103],v3
ds_read_b128 v[72:75],v11 offset:22528
v_smfmac_f32_16x16x64_bf16 v[116:119],v[28:31],v[104:111],v3
ds_read_b128 v[76:79],v11 offset:23552
v_cvt_pk_bf16_f32 v112,v112,v113
v_smfmac_f32_16x16x64_bf16 v[116:119],v[32:35],v[40:47],v3
ds_read_b128 v[80:83],v11 offset:24576
v_cvt_pk_bf16_f32 v113,v114,v115
buffer_store_dwordx2 v[112:113],v9,s[8:11],s65 offen
v_smfmac_f32_16x16x64_bf16 v[116:119],v[36:39],v[48:55],v3
ds_read_b128 v[84:87],v11 offset:25600
v_mov_b64 v[112:113],0
v_smfmac_f32_16x16x64_bf16 v[120:123],v[24:27],v[88:95],v3
ds_read_b128 v[96:99],v11 offset:26624
ds_read_b128 v[100:103],v11 offset:27648
v_mov_b64 v[114:115],0
s_waitcnt lgkmcnt(8)
v_smfmac_f32_16x16x64_bf16 v[120:123],v[28:31],v[56:63],v3
ds_read_b128 v[104:107],v11 offset:28672
v_cvt_pk_bf16_f32 v116,v116,v117
s_waitcnt lgkmcnt(7)
v_smfmac_f32_16x16x64_bf16 v[120:123],v[32:35],v[64:71],v3
ds_read_b128 v[108:111],v11 offset:29696
ds_read_b128 v[40:43],v11 offset:30720
v_cvt_pk_bf16_f32 v117,v118,v119
buffer_store_dwordx2 v[116:117],v9,s[8:11],s57 offen
s_waitcnt lgkmcnt(7)
v_smfmac_f32_16x16x64_bf16 v[120:123],v[36:39],v[72:79],v3
ds_read_b128 v[44:47],v11 offset:31744
s_waitcnt lgkmcnt(6)
v_smfmac_f32_16x16x64_bf16 v[112:115],v[24:27],v[80:87],v3
s_waitcnt lgkmcnt(4)
v_smfmac_f32_16x16x64_bf16 v[112:115],v[28:31],v[96:103],v3
v_cvt_pk_bf16_f32 v120,v120,v121
s_waitcnt lgkmcnt(2)
v_smfmac_f32_16x16x64_bf16 v[112:115],v[32:35],v[104:111],v3
v_cvt_pk_bf16_f32 v121,v122,v123
buffer_store_dwordx2 v[120:121],v9,s[8:11],s58 offen
s_waitcnt lgkmcnt(0)
v_smfmac_f32_16x16x64_bf16 v[112:115],v[36:39],v[40:47],v3
v_mov_b64 v[116:117],0
v_mov_b64 v[118:119],0
s_xor_b32 s65,s65,262144
v_add_u32 v52,s50,v5
v_add_u32 v54,s50,v6
v_mov_b32_dpp v124,v126 quad_perm:[2,3,2,3] row_mask:0xf bank_mask:0xf
v_mov_b32_dpp v125,v127 quad_perm:[2,3,2,3] row_mask:0xf bank_mask:0xf
s_nop 0
v_cvt_pk_bf16_f32 v112,v112,v113
v_cvt_pk_bf16_f32 v113,v114,v115
buffer_store_dwordx2 v[112:113],v9,s[8:11],s59 offen
ds_read_b64_tr_b16 v[52:53],v52
ds_read_b64_tr_b16 v[54:55],v54
s_mov_b32 vcc_lo,0xcccccccc
s_mov_b32 vcc_hi,0xcccccccc
v_mov_b64 v[96:97],0
v_mov_b64 v[98:99],0
v_mov_b64 v[100:101],0
v_mov_b64 v[102:103],0
v_mov_b64 v[104:105],0
v_mov_b64 v[106:107],0
v_mov_b64 v[108:109],0
v_mov_b64 v[110:111],0
v_mov_b64 v[112:113],0
v_mov_b64 v[114:115],0
s_waitcnt lgkmcnt(0)
v_cndmask_b32 v124,v124,v52,vcc
v_cndmask_b32 v125,v125,v53,vcc
v_cndmask_b32 v126,v126,v54,vcc
v_cndmask_b32 v127,v127,v55,vcc
s_add_u32 s56,s18,s75
s_buffer_load_dword s19,s[8:11],s56
v_add_u32 v55,131072,v0
v_add_u32 v123,s73,v55
v_xor_b32 v120,1024,v12
v_xor_b32 v121,2048,v12
v_xor_b32 v122,3072,v12
s_waitcnt vmcnt(0)
buffer_load_dwordx4 v[32:35],v0,s[8:11],s66 offen offset:0 sc1
buffer_load_dwordx4 v[36:39],v0,s[8:11],s66 offen offset:1024 sc1
s_cmp_ge_u32 s51,63
s_cselect_b32 s76,0,1
v_readlane_b32 s56,v23,5
v_readlane_b32 s20,v23,4
v_add_u32 v23,-1,v23
v_cmp_le_u32 vcc,s30,v23
s_cmp_gt_u32 s51,61
s_cselect_b32 s77,0,vcc_hi
s_cmp_gt_u32 s20,s30
s_cselect_b32 s77,1,s77
s_cmp_lg_u32 s77,0
s_cselect_b32 s76,2,s76
s_cmp_gt_u32 s56,s30
s_cbranch_scc1 L_cld_174
L_clb_175:
s_cmp_eq_u32 s46,0
s_cselect_b32 s76,s76,0
s_waitcnt vmcnt(1)
v_mfma_f32_16x16x32_bf16 v[28:31],v[18:21],v[32:35],0
s_waitcnt vmcnt(0)
v_mfma_f32_16x16x32_bf16 v[28:31],v[18:21],v[36:39],v[28:31]
s_nop 7
v_cmp_u_f32 vcc,v28,v28
v_add_f32_dpp v52,v28,v28 row_ror:8 row_mask:0xf bank_mask:0x3
v_add_f32_dpp v53,v29,v29 row_ror:8 row_mask:0xf bank_mask:0x3
v_add_f32_dpp v52,v30,v30 row_ror:8 row_mask:0xf bank_mask:0xc
v_add_f32_dpp v53,v31,v31 row_ror:8 row_mask:0xf bank_mask:0xc
s_nop 0
v_add_f32_dpp v52,v52,v52 row_shl:4 row_mask:0xf bank_mask:0x5
v_add_f32_dpp v53,v53,v53 row_shl:4 row_mask:0xf bank_mask:0x5
s_cbranch_vccnz L_crp_193
L_cok_198:
v_cvt_pk_bf16_f32 v54,v52,v53
buffer_store_dword v54,v10,s[8:11],s64 offen
s_mov_b32 s69,s66
s_xor_b32 s66,s66,262144
s_barrier
ds_read_b128 v[56:59],v55 offset:0
ds_read_b128 v[60:63],v55 offset:4096
buffer_load_dwordx4 v[24:27],v13,s[8:11],s64 offen sc1
buffer_load_dwordx4 v[40:43],v13,s[8:11],s70 offen sc1
ds_read_b128 v[64:67],v55 offset:1024
ds_read_b128 v[68:71],v55 offset:5120
ds_read_b128 v[72:75],v55 offset:2048
ds_read_b128 v[76:79],v55 offset:6144
ds_read_b128 v[80:83],v55 offset:3072
ds_read_b128 v[84:87],v55 offset:7168
ds_read_b128 v[88:91],v123 offset:8192
ds_read_b128 v[92:95],v123 offset:9216
s_branch L_chain_188
L_crp_193:
buffer_load_dwordx4 v[32:35],v0,s[8:11],s66 offen offset:0 sc1
buffer_load_dwordx4 v[36:39],v0,s[8:11],s66 offen offset:1024 sc1
s_sub_u32 s49,s49,1
s_cbranch_scc1 L_abort
s_waitcnt vmcnt(1)
v_mfma_f32_16x16x32_bf16 v[28:31],v[18:21],v[32:35],0
s_waitcnt vmcnt(0)
v_mfma_f32_16x16x32_bf16 v[28:31],v[18:21],v[36:39],v[28:31]
s_nop 7
v_cmp_u_f32 vcc,v28,v28
v_add_f32_dpp v52,v28,v28 row_ror:8 row_mask:0xf bank_mask:0x3
v_add_f32_dpp v53,v29,v29 row_ror:8 row_mask:0xf bank_mask:0x3
v_add_f32_dpp v52,v30,v30 row_ror:8 row_mask:0xf bank_mask:0xc
v_add_f32_dpp v53,v31,v31 row_ror:8 row_mask:0xf bank_mask:0xc
s_nop 0
v_add_f32_dpp v52,v52,v52 row_shl:4 row_mask:0xf bank_mask:0x5
v_add_f32_dpp v53,v53,v53 row_shl:4 row_mask:0xf bank_mask:0x5
s_cbranch_vccz L_cok_198
s_branch L_crp_193
L_ckw_178:
s_cmp_eq_u32 s77,0
s_cbranch_scc1 L_cjw_180
s_andn2_b32 s31,0x7ff,s20
s_lshr_b32 s31,s31,5
s_cmp_gt_u32 s20,s30
s_cbranch_scc1 L_cjs_176
s_add_u32 s31,s51,2
s_lshl_b32 s59,s31,13
s_add_u32 s59,s59,10486016
v_lshrrev_b32 v29,2,v0
v_and_b32 v29,127,v29
L_ckk_199:
s_sleep 1
buffer_load_dword v28,v29,s[8:11],s59 offen sc1
s_sub_u32 s49,s49,1
s_cbranch_scc1 L_abort
s_waitcnt vmcnt(0)
v_cmp_eq_u32 vcc,0,v28
s_cbranch_vccnz L_ckk_199
v_cmp_lt_u32 vcc,s30,v28
s_cbranch_vccz L_cjw_180
L_cjs_176:
ds_write_b32 v8,v2 offset:2560
s_waitcnt lgkmcnt(0)
s_branch L_ckb_179
L_cld_174:
v_mov_b32 v23,s56
s_add_u32 s56,s75,10495616
buffer_store_dword v23,off,s[8:11],s56
s_waitcnt vmcnt(0)
s_branch L_clb_175
L_cjw_180:
s_cmp_lg_u32 s19,0
s_cbranch_scc1 L_ckb_179
s_add_u32 s59,s18,s75
L_ww_200:
s_sleep 1
buffer_load_dword v23,off,s[8:11],s59 sc1
s_sub_u32 s49,s49,1
s_cbranch_scc1 L_abort
s_waitcnt vmcnt(0)
v_readfirstlane_b32 s76,v23
s_cmp_eq_u32 s76,0
s_cbranch_scc1 L_ww_200
L_wwd_201:
s_branch L_ckb_179
L_cjump_181:
s_waitcnt vmcnt(0) lgkmcnt(0)
s_barrier
s_branch L_cst_177
L_cend_191:
v_add_u32 v52,s50,v5
v_add_u32 v54,s50,v6
ds_read_b64_tr_b16 v[52:53],v52
ds_read_b64_tr_b16 v[54:55],v54
v_mov_b32_dpp v124,v126 quad_perm:[2,3,2,3] row_mask:0xf bank_mask:0xf
v_mov_b32_dpp v125,v127 quad_perm:[2,3,2,3] row_mask:0xf bank_mask:0xf
s_mov_b32 vcc_lo,0xcccccccc
s_mov_b32 vcc_hi,0xcccccccc
s_waitcnt lgkmcnt(0)
v_cndmask_b32 v124,v124,v52,vcc
v_cndmask_b32 v125,v125,v53,vcc
v_cndmask_b32 v126,v126,v54,vcc
v_cndmask_b32 v127,v127,v55,vcc
buffer_store_dwordx4 v[124:127],v0,s[8:11],s54 offen sc1
s_waitcnt vmcnt(0)
s_barrier
buffer_store_dword v2,off,s[8:11],s78 sc1
buffer_store_dword v2,off,s[8:11],s55 sc1
s_nop 11
v_lshrrev_b32 v1,4,v0
s_endpgm
L_abort2:
s_endpgm
L_wc:
s_nop 11
s_cmp_eq_u32 s48,1
s_cbranch_scc1 L_rc1_202
s_cmp_eq_u32 s48,2
s_cbranch_scc1 L_rc2_203
v_and_b32 v120,15,v1
v_lshrrev_b32 v121,4,v1
v_and_b32 v122,2,v1
v_cmp_eq_u32 vcc,0,v122
v_mov_b32 v2,0xeeee
v_mov_b32 v123,0x4444
v_cndmask_b32 v2,v2,v123,vcc
v_and_b32 v122,1,v1
v_cmp_eq_u32 vcc,0,v122
v_mov_b32 v3,0xdddd
v_mov_b32 v123,0x8888
v_cndmask_b32 v3,v3,v123,vcc
v_lshrrev_b32 v122,1,v120
v_bfe_u32 v123,v120,2,1
v_xor_b32 v123,v123,v122
v_lshlrev_b32 v4,7,v123
v_and_b32 v123,1,v120
v_lshl_add_u32 v4,v123,6,v4
v_xor_b32 v123,v121,v122
v_and_b32 v123,3,v123
v_lshl_add_u32 v4,v123,4,v4
s_lshl_b32 s56,s46,10
s_add_u32 s56,s56,147456
v_add_u32 v4,s56,v4
v_lshlrev_b32 v122,1,v121
v_add_u32 v122,0,v122
v_and_b32 v123,1,v121
v_xor_b32 v123,v123,v122
v_lshlrev_b32 v5,7,v123
v_bfe_u32 v123,v120,3,1
v_lshl_add_u32 v5,v123,6,v5
v_xor_b32 v123,v120,v122
v_and_b32 v123,3,v123
v_lshl_add_u32 v5,v123,4,v5
v_bfe_u32 v123,v120,2,1
v_lshl_add_u32 v5,v123,3,v5
v_add_u32 v5,147456,v5
v_lshlrev_b32 v122,1,v121
v_add_u32 v122,1,v122
v_and_b32 v123,1,v121
v_xor_b32 v123,v123,v122
v_lshlrev_b32 v6,7,v123
v_bfe_u32 v123,v120,3,1
v_lshl_add_u32 v6,v123,6,v6
v_xor_b32 v123,v120,v122
v_and_b32 v123,3,v123
v_lshl_add_u32 v6,v123,4,v6
v_bfe_u32 v123,v120,2,1
v_lshl_add_u32 v6,v123,3,v6
v_add_u32 v6,147456,v6
v_lshlrev_b32 v7,7,v121
v_lshrrev_b32 v122,1,v120
v_lshl_add_u32 v8,v122,4,v7
v_add_u32 v8,151552,v8
v_lshrrev_b32 v122,2,v120
v_lshl_add_u32 v7,v122,5,v7
v_and_b32 v122,1,v120
v_lshl_add_u32 v7,v122,4,v7
v_and_b32 v122,2,v120
v_cmp_eq_u32 vcc,0,v122
s_lshl_b32 s56,s46,9
v_mov_b32 v122,2048
v_mov_b32 v123,s56
v_cndmask_b32 v122,v122,v123,vcc
v_add_u32 v7,v122,v7
v_add_u32 v7,151552,v7
v_lshrrev_b32 v122,3,v1
v_lshlrev_b32 v9,11,v122
v_and_b32 v122,7,v1
v_lshl_add_u32 v9,v122,3,v9
s_lshl_b32 s56,s46,14
s_lshl_b32 s57,s47,6
s_add_u32 s56,s56,s57
v_add_u32 v9,s56,v9
s_lshl_b32 s71,s47,2
s_add_u32 s71,s71,s46
s_bfe_u32 s56,s71,0x10003
s_lshl_b32 s56,s56,11
s_and_b32 s57,s71,1
s_lshl_b32 s57,s57,10
s_add_u32 s56,s56,s57
s_bfe_u32 s57,s71,0x10002
s_lshl_b32 s57,s57,9
s_add_u32 s56,s56,s57
s_bfe_u32 s57,s71,0x10001
s_lshl_b32 s57,s57,6
s_add_u32 s56,s56,s57
s_bfe_u32 s57,s71,0x10004
s_lshl_b32 s57,s57,8
s_add_u32 s56,s56,s57
s_bfe_u32 s57,s71,0x10005
s_lshl_b32 s57,s57,7
s_add_u32 s56,s56,s57
s_bfe_u32 s57,s71,0x10006
s_lshl_b32 s57,s57,12
s_add_u32 s56,s56,s57
v_and_b32 v122,3,v120
v_lshlrev_b32 v10,2,v122
v_bfe_u32 v122,v120,3,1
v_lshl_add_u32 v10,v122,4,v10
v_and_b32 v122,1,v121
v_lshl_add_u32 v10,v122,5,v10
v_add_u32 v10,s56,v10
v_and_b32 v123,36,v1
v_mov_b32 v122,0x80000000
v_cmp_eq_u32 vcc,0,v123
s_nop 1
v_cndmask_b32 v10,v122,v10,vcc
s_lshl_b32 s56,s46,15
v_add_u32 v11,s56,v0
s_lshl_b32 s71,s71,11
s_lshl_b32 s73,s46,11
s_mov_b32 s72,0xffc00000
s_mov_b32 s74,0
v_lshrrev_b32 v13,3,v1
v_lshlrev_b32 v13,9,v13
v_and_b32 v122,7,v1
v_lshl_add_u32 v13,v122,4,v13
v_and_b32 v122,15,v1
v_and_b32 v123,1,v1
v_lshlrev_b32 v123,4,v123
v_mov_b32 v124,0x3f80
v_lshlrev_b32 v124,v123,v124
v_lshrrev_b32 v122,1,v122
v_cmp_eq_u32 vcc,0,v122
s_nop 1
v_cndmask_b32 v18,0,v124,vcc
v_cmp_eq_u32 vcc,1,v122
s_nop 1
v_cndmask_b32 v19,0,v124,vcc
v_cmp_eq_u32 vcc,2,v122
s_nop 1
v_cndmask_b32 v20,0,v124,vcc
v_cmp_eq_u32 vcc,3,v122
s_nop 1
v_cndmask_b32 v21,0,v124,vcc
s_and_b32 s56,s46,1
s_lshl_b32 s56,s56,8
s_and_b32 s57,s46,2
s_lshl_b32 s57,s57,6
s_add_u32 s56,s56,s57
v_add_u32 v13,s56,v13
s_add_u32 s56,s50,155648
v_add_u32 v12,s56,v0
v_mov_b64 v[14:15],s[28:29]
v_mov_b64 v[16:17],s[28:29]
v_add_u32 v22,11550720,v10
s_lshl_b32 s18,s47,2
s_add_u32 s18,s18,10493952
v_mov_b32 v1,s80
s_mov_b32 s65,14680064
s_add_u32 s66,s71,14680064
s_add_u32 s69,s71,14942208
s_lshl_b32 s79,s47,2
s_add_u32 s79,s79,10485760
s_cmp_eq_u32 s46,0
s_cselect_b32 s79,s79,0x80000000
s_mov_b32 s30,0x40000000
s_mov_b32 s51,0
L_cst_207:
s_cmp_lg_u32 s46,0
s_cbranch_scc1 L_csw_212
s_lshl_b32 s59,s51,13
s_lshl2_add_u32 s59,s47,s59
s_add_u32 s59,s59,10485760
L_ww_213:
s_sleep 1
buffer_load_dword v122,off,s[8:11],s59 sc1
s_sub_u32 s49,s49,1
s_cbranch_scc1 L_abort2
s_waitcnt vmcnt(0)
v_readfirstlane_b32 s61,v122
s_cmp_eq_u32 s61,0
s_cbranch_scc1 L_ww_213
L_wwd_214:
L_csw_212:
s_waitcnt lgkmcnt(0)
s_barrier
s_lshl_b32 s56,s51,5
s_add_u32 s56,s56,s47
s_mul_i32 s56,s56,24576
s_add_u32 s56,s56,100663296
s_add_u32 s67,s56,s73
s_add_u32 m0,s73,131072
s_add_u32 s57,s67,8192
buffer_load_dwordx4 v0,s[8:11],s67 offen sc1 lds
buffer_load_dwordx4 v0,s[8:11],s67 offen offset:1024 sc1 lds
s_add_u32 m0,s73,139264
s_add_u32 s67,s67,786432
buffer_load_dwordx4 v0,s[8:11],s57 offen sc1 lds
buffer_load_dwordx4 v0,s[8:11],s57 offen offset:1024 sc1 lds
s_lshl_b32 s75,s51,13
s_add_u32 s56,s75,11542528
buffer_load_dword v23,v10,s[8:11],s56 offen sc1
s_add_u32 s64,s75,11534336
s_add_u32 s70,s64,4096
s_lshl_b32 s68,s51,5
s_add_u32 s68,s68,s47
s_lshl_b32 s68,s68,12
s_lshl_b32 s56,s46,10
s_add_u32 s68,s68,s56
s_add_u32 s68,s68,41943040
s_mov_b32 s78,0x80000000
s_mov_b32 s55,0x80000000
s_mov_b32 s54,0x80000000
s_mov_b32 s77,0
s_mov_b32 s19,0
s_cmp_eq_u32 s51,63
s_cselect_b32 s76,1,s46
s_cmp_eq_u32 s76,0
s_cselect_b32 s76,1,0
v_mov_b64 v[96:97],0
v_mov_b64 v[98:99],0
v_mov_b64 v[100:101],0
v_mov_b64 v[102:103],0
v_mov_b64 v[104:105],0
v_mov_b64 v[106:107],0
v_mov_b64 v[108:109],0
v_mov_b64 v[110:111],0
v_mov_b64 v[112:113],0
v_mov_b64 v[114:115],0
v_mov_b64 v[116:117],0
v_mov_b64 v[118:119],0
s_waitcnt vmcnt(0) lgkmcnt(0)
s_barrier
v_add_u32 v55,131072,v0
ds_read_b128 v[56:59],v55 offset:0
ds_read_b128 v[60:63],v55 offset:4096
ds_read_b128 v[64:67],v55 offset:1024
ds_read_b128 v[68:71],v55 offset:5120
ds_read_b128 v[72:75],v55 offset:2048
ds_read_b128 v[76:79],v55 offset:6144
ds_read_b128 v[80:83],v55 offset:3072
ds_read_b128 v[84:87],v55 offset:7168
v_add_u32 v123,s73,v55
ds_read_b128 v[88:91],v123 offset:8192
ds_read_b128 v[92:95],v123 offset:9216
v_xor_b32 v120,1024,v12
v_xor_b32 v121,2048,v12
v_xor_b32 v122,3072,v12
buffer_load_dwordx4 v[24:27],v13,s[8:11],s64 offen sc1
buffer_load_dwordx4 v[40:43],v13,s[8:11],s70 offen sc1
L_chain_215:
L_cpa_216:
buffer_load_dwordx4 v[24:27],v13,s[8:11],s64 offen sc1
buffer_load_dwordx4 v[40:43],v13,s[8:11],s70 offen sc1
s_sub_u32 s49,s49,1
s_cbranch_scc1 L_abort2
s_waitcnt vmcnt(2)
v_max3_u32 v123,v24,v25,v26
v_max3_u32 v123,v27,v40,v123
v_max3_u32 v123,v41,v42,v123
v_max_u32 v123,v43,v123
v_cmp_le_u32 vcc,s72,v123
s_cbranch_vccnz L_cpa_216
ds_write_b128 v12,v[24:27] offset:0
ds_write_b128 v12,v[40:43] offset:4096
v_smfmac_f32_16x16x64_bf16 v[96:99],v[24:27],a[0:7],v2
buffer_store_dwordx4 v[124:127],v0,s[8:11],s54 offen sc1
v_smfmac_f32_16x16x64_bf16 v[100:103],v[24:27],a[128:135],v2
s_add_u32 m0,s73,131072
s_add_u32 s57,s67,8192
v_smfmac_f32_16x16x64_bf16 v[104:107],v[24:27],a[8:15],v2
v_smfmac_f32_16x16x64_bf16 v[108:111],v[24:27],a[136:143],v2
s_waitcnt lgkmcnt(0)
s_cmp_lt_u32 s19,s76
s_cbranch_scc1 L_ckw_208
L_ckb_209:
s_barrier
ds_read_b128 v[28:31],v120 offset:0
ds_read_b128 v[32:35],v121 offset:0
v_smfmac_f32_16x16x64_bf16 v[96:99],v[40:43],a[64:71],v2
ds_read_b128 v[36:39],v122 offset:0
v_smfmac_f32_16x16x64_bf16 v[100:103],v[40:43],a[192:199],v2
ds_read_b128 v[44:47],v120 offset:4096
v_smfmac_f32_16x16x64_bf16 v[104:107],v[40:43],a[72:79],v2
ds_read_b128 v[48:51],v121 offset:4096
v_smfmac_f32_16x16x64_bf16 v[108:111],v[40:43],a[200:207],v2
ds_read_b128 v[52:55],v122 offset:4096
v_smfmac_f32_16x16x64_bf16 v[112:115],v[24:27],v[128:135],v2
buffer_load_dwordx4 v0,s[8:11],s67 offen sc1 lds
v_smfmac_f32_16x16x64_bf16 v[116:119],v[24:27],v[136:143],v2
v_smfmac_f32_16x16x64_bf16 v[112:115],v[40:43],v[192:199],v2
buffer_load_dwordx4 v0,s[8:11],s67 offen offset:1024 sc1 lds
v_smfmac_f32_16x16x64_bf16 v[116:119],v[40:43],v[200:207],v2
s_waitcnt lgkmcnt(5)
v_smfmac_f32_16x16x64_bf16 v[96:99],v[28:31],a[16:23],v2
s_add_u32 m0,s73,139264
v_smfmac_f32_16x16x64_bf16 v[100:103],v[28:31],a[144:151],v2
buffer_load_dwordx4 v0,s[8:11],s57 offen sc1 lds
v_smfmac_f32_16x16x64_bf16 v[104:107],v[28:31],a[24:31],v2
s_add_u32 s67,s67,786432
v_smfmac_f32_16x16x64_bf16 v[108:111],v[28:31],a[152:159],v2
s_waitcnt lgkmcnt(4)
v_smfmac_f32_16x16x64_bf16 v[96:99],v[32:35],a[32:39],v2
buffer_load_dwordx4 v0,s[8:11],s57 offen offset:1024 sc1 lds
v_smfmac_f32_16x16x64_bf16 v[100:103],v[32:35],a[160:167],v2
v_smfmac_f32_16x16x64_bf16 v[104:107],v[32:35],a[40:47],v2
v_smfmac_f32_16x16x64_bf16 v[108:111],v[32:35],a[168:175],v2
buffer_load_dword v23,v22,s[8:11],s75 offen sc1
s_waitcnt lgkmcnt(3)
v_smfmac_f32_16x16x64_bf16 v[96:99],v[36:39],a[48:55],v2
v_mov_b32 v125,0
v_smfmac_f32_16x16x64_bf16 v[100:103],v[36:39],a[176:183],v2
v_smfmac_f32_16x16x64_bf16 v[104:107],v[36:39],a[56:63],v2
v_smfmac_f32_16x16x64_bf16 v[108:111],v[36:39],a[184:191],v2
s_waitcnt lgkmcnt(0)
v_smfmac_f32_16x16x64_bf16 v[96:99],v[44:47],a[80:87],v2
v_smfmac_f32_16x16x64_bf16 v[100:103],v[44:47],a[208:215],v2
v_smfmac_f32_16x16x64_bf16 v[96:99],v[48:51],a[96:103],v2
v_smfmac_f32_16x16x64_bf16 v[100:103],v[48:51],a[224:231],v2
v_smfmac_f32_16x16x64_bf16 v[96:99],v[52:55],a[112:119],v2
v_smfmac_f32_16x16x64_bf16 v[100:103],v[52:55],a[240:247],v2
v_smfmac_f32_16x16x64_bf16 v[104:107],v[44:47],a[88:95],v2
v_smfmac_f32_16x16x64_bf16 v[108:111],v[44:47],a[216:223],v2
v_smfmac_f32_16x16x64_bf16 v[104:107],v[48:51],a[104:111],v2
v_add_f32 v96,v96,v98
v_smfmac_f32_16x16x64_bf16 v[108:111],v[48:51],a[232:239],v2
v_add_f32 v97,v97,v99
v_smfmac_f32_16x16x64_bf16 v[104:107],v[52:55],a[120:127],v2
v_cvt_pk_bf16_f32 v120,v96,v97
v_smfmac_f32_16x16x64_bf16 v[108:111],v[52:55],a[248:255],v2
v_add_f32 v100,v100,v102
v_smfmac_f32_16x16x64_bf16 v[112:115],v[28:31],v[144:151],v2
v_add_f32 v101,v101,v103
v_smfmac_f32_16x16x64_bf16 v[116:119],v[28:31],v[152:159],v2
v_cvt_pk_bf16_f32 v121,v100,v101
v_add_f32 v104,v104,v106
v_add_f32 v105,v105,v107
v_cvt_pk_bf16_f32 v122,v104,v105
v_add_f32 v108,v108,v110
v_add_f32 v109,v109,v111
v_cvt_pk_bf16_f32 v123,v108,v109
ds_write_b128 v4,v[120:123]
v_smfmac_f32_16x16x64_bf16 v[112:115],v[32:35],v[160:167],v2
v_smfmac_f32_16x16x64_bf16 v[116:119],v[32:35],v[168:175],v2
v_smfmac_f32_16x16x64_bf16 v[112:115],v[36:39],v[176:183],v2
v_smfmac_f32_16x16x64_bf16 v[116:119],v[36:39],v[184:191],v2
s_waitcnt vmcnt(6) lgkmcnt(0)
s_barrier
ds_read_b64_tr_b16 v[96:97],v5 offset:0
ds_read_b64_tr_b16 v[98:99],v6 offset:0
v_smfmac_f32_16x16x64_bf16 v[112:115],v[44:47],v[208:215],v2
ds_read_b64_tr_b16 v[100:101],v5 offset:1024
v_smfmac_f32_16x16x64_bf16 v[116:119],v[44:47],v[216:223],v2
ds_read_b64_tr_b16 v[102:103],v6 offset:1024
v_smfmac_f32_16x16x64_bf16 v[112:115],v[48:51],v[224:231],v2
ds_read_b64_tr_b16 v[104:105],v5 offset:2048
v_smfmac_f32_16x16x64_bf16 v[116:119],v[48:51],v[232:239],v2
ds_read_b64_tr_b16 v[106:107],v6 offset:2048
s_waitcnt lgkmcnt(4)
v_mfma_f32_16x16x32_bf16 v[24:27],v[56:59],v[96:99],0
ds_read_b64_tr_b16 v[108:109],v5 offset:3072
v_mfma_f32_16x16x32_bf16 v[28:31],v[60:63],v[96:99],0
ds_read_b64_tr_b16 v[110:111],v6 offset:3072
v_mfma_f32_16x16x32_bf16 v[32:35],v[96:99],v[96:99],0
ds_read_b128 v[40:43],v11 offset:12288
s_waitcnt lgkmcnt(5)
v_mfma_f32_16x16x32_bf16 v[24:27],v[64:67],v[100:103],v[24:27]
ds_read_b128 v[56:59],v11 offset:0
v_mfma_f32_16x16x32_bf16 v[28:31],v[68:71],v[100:103],v[28:31]
ds_read_b128 v[60:63],v11 offset:1024
v_mfma_f32_16x16x32_bf16 v[32:35],v[100:103],v[100:103],v[32:35]
ds_read_b128 v[96:99],v11 offset:8192
s_waitcnt lgkmcnt(6)
v_mfma_f32_16x16x32_bf16 v[24:27],v[72:75],v[104:107],v[24:27]
ds_read_b128 v[64:67],v11 offset:2048
v_mfma_f32_16x16x32_bf16 v[28:31],v[76:79],v[104:107],v[28:31]
ds_read_b128 v[68:71],v11 offset:3072
v_mfma_f32_16x16x32_bf16 v[32:35],v[104:107],v[104:107],v[32:35]
ds_read_b128 v[100:103],v11 offset:9216
s_waitcnt lgkmcnt(7)
v_mfma_f32_16x16x32_bf16 v[24:27],v[80:83],v[108:111],v[24:27]
ds_read_b128 v[72:75],v11 offset:4096
v_mfma_f32_16x16x32_bf16 v[28:31],v[84:87],v[108:111],v[28:31]
ds_read_b128 v[76:79],v11 offset:5120
v_mfma_f32_16x16x32_bf16 v[32:35],v[108:111],v[108:111],v[32:35]
ds_read_b128 v[104:107],v11 offset:10240
v_smfmac_f32_16x16x64_bf16 v[112:115],v[52:55],v[240:247],v2
ds_read_b128 v[80:83],v11 offset:6144
v_smfmac_f32_16x16x64_bf16 v[116:119],v[52:55],v[248:255],v2
ds_read_b128 v[84:87],v11 offset:7168
v_max3_f32 v126,v24,v25,v26
v_max3_f32 v127,v27,v28,v29
v_max3_f32 v126,v30,v31,v126
v_max3_f32 v127,v34,v35,v127
v_max_f32 v126,v126,v127
v_max_f32 v127,v126,v127
v_pk_mul_f32 v[34:35],v[34:35],v[0:1] op_sel:[0,1]
v_pk_mul_f32 v[24:25],v[24:25],v[0:1] op_sel:[0,1]
v_permlane16_swap_b32 v126,v127
v_max_f32 v126,v126,v127
v_max_f32 v127,v126,v127
v_pk_mul_f32 v[26:27],v[26:27],v[0:1] op_sel:[0,1]
v_pk_mul_f32 v[28:29],v[28:29],v[0:1] op_sel:[0,1]
v_permlane32_swap_b32 v126,v127
v_max_f32 v126,v126,v127
v_mul_f32 v126,v1,v126
v_pk_mul_f32 v[30:31],v[30:31],v[0:1] op_sel:[0,1]
v_pk_add_f32 v[34:35],v[34:35],v[126:127] op_sel_hi:[1,0] neg_lo:[0,1] neg_hi:[0,1]
v_pk_add_f32 v[112:113],v[112:113],v[114:115]
v_pk_add_f32 v[116:117],v[116:117],v[118:119]
v_pk_add_f32 v[24:25],v[24:25],v[126:127] op_sel_hi:[1,0] neg_lo:[0,1] neg_hi:[0,1]
v_pk_add_f32 v[26:27],v[26:27],v[126:127] op_sel_hi:[1,0] neg_lo:[0,1] neg_hi:[0,1]
v_pk_add_f32 v[28:29],v[28:29],v[126:127] op_sel_hi:[1,0] neg_lo:[0,1] neg_hi:[0,1]
v_pk_add_f32 v[30:31],v[30:31],v[126:127] op_sel_hi:[1,0] neg_lo:[0,1] neg_hi:[0,1]
v_exp_f32 v34,v34
v_exp_f32 v35,v35
v_cvt_pk_bf16_f32 v126,v112,v113
v_cvt_pk_bf16_f32 v124,v34,v35
v_cvt_pk_bf16_f32 v127,v116,v117
v_cvt_pk_bf16_f32 v36,v116,v117
v_mfma_f32_16x16x16_bf16 v[32:35],v[14:15],v[124:125],0
ds_read_b128 v[108:111],v11 offset:11264
v_exp_f32 v24,v24
v_mfma_f32_16x16x16_bf16 v[112:115],v[126:127],v[124:125],0
ds_read_b128 v[44:47],v11 offset:13312
v_exp_f32 v25,v25
v_mfma_f32_16x16x16_bf16 v[116:119],v[36:37],v[124:125],0
ds_read_b128 v[48:51],v11 offset:14336
v_exp_f32 v26,v26
v_exp_f32 v27,v27
v_cvt_pk_bf16_f32 v120,v24,v25
v_exp_f32 v28,v28
v_exp_f32 v29,v29
v_cvt_pk_bf16_f32 v121,v26,v27
v_exp_f32 v30,v30
v_exp_f32 v31,v31
v_cvt_pk_bf16_f32 v122,v28,v29
v_cvt_pk_bf16_f32 v123,v30,v31
s_mov_b32 s78,s55
s_add_u32 s55,s79,s75
v_mfma_f32_16x16x32_bf16 v[32:35],v[14:17],v[120:123],v[32:35]
ds_read_b128 v[52:55],v11 offset:15360
v_mfma_f32_16x16x32_bf16 v[112:115],v[88:91],v[120:123],v[112:115]
ds_read_b128 v[88:91],v11 offset:16384
v_mfma_f32_16x16x32_bf16 v[116:119],v[92:95],v[120:123],v[116:119]
ds_read_b128 v[92:95],v11 offset:17408
v_rcp_f32 v32,v32
v_mov_b64 v[24:25],-1
v_mov_b64 v[26:27],-1
s_mov_b32 s54,s68
s_add_u32 s75,s75,8192
v_pk_mul_f32 v[112:113],v[112:113],v[32:33] op_sel_hi:[1,0]
v_pk_mul_f32 v[114:115],v[114:115],v[32:33] op_sel_hi:[1,0]
v_pk_mul_f32 v[116:117],v[116:117],v[32:33] op_sel_hi:[1,0]
v_pk_mul_f32 v[118:119],v[118:119],v[32:33] op_sel_hi:[1,0]
v_cvt_pk_bf16_f32 v120,v112,v116
v_cvt_pk_bf16_f32 v121,v113,v117
v_cvt_pk_bf16_f32 v122,v114,v118
v_cvt_pk_bf16_f32 v123,v115,v119
ds_write_b128 v7,v[120:123]
buffer_store_dwordx4 v[24:27],v0,s[8:11],s69 offen sc1
buffer_store_dwordx4 v[24:27],v0,s[8:11],s69 offen offset:1024 sc1
s_waitcnt lgkmcnt(0)
s_barrier
ds_read_b128 v[24:27],v8 offset:0
ds_read_b128 v[28:31],v8 offset:512
ds_read_b128 v[32:35],v8 offset:1024
ds_read_b128 v[36:39],v8 offset:1536
v_mov_b64 v[112:113],0
v_mov_b64 v[114:115],0
v_mov_b64 v[116:117],0
v_mov_b64 v[118:119],0
v_mov_b64 v[120:121],0
v_mov_b64 v[122:123],0
s_add_u32 s64,s75,11534336
s_add_u32 s70,s64,4096
s_add_u32 s68,s68,131072
s_add_u32 s51,s51,1
s_cmp_eq_u32 s51,64
s_cbranch_scc1 L_cend_218
s_waitcnt lgkmcnt(3)
v_smfmac_f32_16x16x64_bf16 v[112:115],v[24:27],v[56:63],v3
ds_read_b128 v[56:59],v11 offset:18432
s_add_u32 s57,s65,65536
s_waitcnt lgkmcnt(3)
v_smfmac_f32_16x16x64_bf16 v[112:115],v[28:31],v[64:71],v3
ds_read_b128 v[60:63],v11 offset:19456
s_add_u32 s58,s65,131072
s_waitcnt lgkmcnt(3)
v_smfmac_f32_16x16x64_bf16 v[112:115],v[32:35],v[72:79],v3
ds_read_b128 v[64:67],v11 offset:20480
s_add_u32 s59,s65,196608
s_waitcnt lgkmcnt(3)
v_smfmac_f32_16x16x64_bf16 v[112:115],v[36:39],v[80:87],v3
ds_read_b128 v[68:71],v11 offset:21504
v_smfmac_f32_16x16x64_bf16 v[116:119],v[24:27],v[96:103],v3
ds_read_b128 v[72:75],v11 offset:22528
v_smfmac_f32_16x16x64_bf16 v[116:119],v[28:31],v[104:111],v3
ds_read_b128 v[76:79],v11 offset:23552
v_cvt_pk_bf16_f32 v112,v112,v113
v_smfmac_f32_16x16x64_bf16 v[116:119],v[32:35],v[40:47],v3
ds_read_b128 v[80:83],v11 offset:24576
v_cvt_pk_bf16_f32 v113,v114,v115
buffer_store_dwordx2 v[112:113],v9,s[8:11],s65 offen sc1
v_smfmac_f32_16x16x64_bf16 v[116:119],v[36:39],v[48:55],v3
ds_read_b128 v[84:87],v11 offset:25600
v_mov_b64 v[112:113],0
v_smfmac_f32_16x16x64_bf16 v[120:123],v[24:27],v[88:95],v3
ds_read_b128 v[96:99],v11 offset:26624
ds_read_b128 v[100:103],v11 offset:27648
v_mov_b64 v[114:115],0
s_waitcnt lgkmcnt(8)
v_smfmac_f32_16x16x64_bf16 v[120:123],v[28:31],v[56:63],v3
ds_read_b128 v[104:107],v11 offset:28672
v_cvt_pk_bf16_f32 v116,v116,v117
s_waitcnt lgkmcnt(7)
v_smfmac_f32_16x16x64_bf16 v[120:123],v[32:35],v[64:71],v3
ds_read_b128 v[108:111],v11 offset:29696
ds_read_b128 v[40:43],v11 offset:30720
v_cvt_pk_bf16_f32 v117,v118,v119
buffer_store_dwordx2 v[116:117],v9,s[8:11],s57 offen sc1
s_waitcnt lgkmcnt(7)
v_smfmac_f32_16x16x64_bf16 v[120:123],v[36:39],v[72:79],v3
ds_read_b128 v[44:47],v11 offset:31744
s_waitcnt lgkmcnt(6)
v_smfmac_f32_16x16x64_bf16 v[112:115],v[24:27],v[80:87],v3
s_waitcnt lgkmcnt(4)
v_smfmac_f32_16x16x64_bf16 v[112:115],v[28:31],v[96:103],v3
v_cvt_pk_bf16_f32 v120,v120,v121
s_waitcnt lgkmcnt(2)
v_smfmac_f32_16x16x64_bf16 v[112:115],v[32:35],v[104:111],v3
v_cvt_pk_bf16_f32 v121,v122,v123
buffer_store_dwordx2 v[120:121],v9,s[8:11],s58 offen sc1
s_waitcnt lgkmcnt(0)
v_smfmac_f32_16x16x64_bf16 v[112:115],v[36:39],v[40:47],v3
v_mov_b64 v[116:117],0
v_mov_b64 v[118:119],0
s_xor_b32 s65,s65,262144
v_add_u32 v52,s50,v5
v_add_u32 v54,s50,v6
v_mov_b32_dpp v124,v126 quad_perm:[2,3,2,3] row_mask:0xf bank_mask:0xf
v_mov_b32_dpp v125,v127 quad_perm:[2,3,2,3] row_mask:0xf bank_mask:0xf
s_nop 0
v_cvt_pk_bf16_f32 v112,v112,v113
v_cvt_pk_bf16_f32 v113,v114,v115
buffer_store_dwordx2 v[112:113],v9,s[8:11],s59 offen sc1
ds_read_b64_tr_b16 v[52:53],v52
ds_read_b64_tr_b16 v[54:55],v54
s_mov_b32 vcc_lo,0xcccccccc
s_mov_b32 vcc_hi,0xcccccccc
v_mov_b64 v[96:97],0
v_mov_b64 v[98:99],0
v_mov_b64 v[100:101],0
v_mov_b64 v[102:103],0
v_mov_b64 v[104:105],0
v_mov_b64 v[106:107],0
v_mov_b64 v[108:109],0
v_mov_b64 v[110:111],0
v_mov_b64 v[112:113],0
v_mov_b64 v[114:115],0
s_waitcnt lgkmcnt(0)
v_cndmask_b32 v124,v124,v52,vcc
v_cndmask_b32 v125,v125,v53,vcc
v_cndmask_b32 v126,v126,v54,vcc
v_cndmask_b32 v127,v127,v55,vcc
s_add_u32 s56,s18,s75
s_buffer_load_dword s19,s[8:11],s56
v_add_u32 v55,131072,v0
v_add_u32 v123,s73,v55
v_xor_b32 v120,1024,v12
v_xor_b32 v121,2048,v12
v_xor_b32 v122,3072,v12
s_waitcnt vmcnt(0)
buffer_load_dwordx4 v[32:35],v0,s[8:11],s66 offen offset:0 sc1
buffer_load_dwordx4 v[36:39],v0,s[8:11],s66 offen offset:1024 sc1
s_cmp_ge_u32 s51,63
s_cselect_b32 s76,0,1
s_cmp_eq_u32 s46,0
s_cselect_b32 s76,s76,0
s_waitcnt vmcnt(1)
v_mfma_f32_16x16x32_bf16 v[28:31],v[18:21],v[32:35],0
s_waitcnt vmcnt(0)
v_mfma_f32_16x16x32_bf16 v[28:31],v[18:21],v[36:39],v[28:31]
s_nop 7
v_cmp_u_f32 vcc,v28,v28
v_add_f32_dpp v52,v28,v28 row_ror:8 row_mask:0xf bank_mask:0x3
v_add_f32_dpp v53,v29,v29 row_ror:8 row_mask:0xf bank_mask:0x3
v_add_f32_dpp v52,v30,v30 row_ror:8 row_mask:0xf bank_mask:0xc
v_add_f32_dpp v53,v31,v31 row_ror:8 row_mask:0xf bank_mask:0xc
s_nop 0
v_add_f32_dpp v52,v52,v52 row_shl:4 row_mask:0xf bank_mask:0x5
v_add_f32_dpp v53,v53,v53 row_shl:4 row_mask:0xf bank_mask:0x5
s_cbranch_vccnz L_crp_220
L_cok_225:
v_cvt_pk_bf16_f32 v54,v52,v53
buffer_store_dword v54,v10,s[8:11],s64 offen sc1
s_mov_b32 s69,s66
s_xor_b32 s66,s66,262144
s_barrier
ds_read_b128 v[56:59],v55 offset:0
ds_read_b128 v[60:63],v55 offset:4096
buffer_load_dwordx4 v[24:27],v13,s[8:11],s64 offen sc1
buffer_load_dwordx4 v[40:43],v13,s[8:11],s70 offen sc1
ds_read_b128 v[64:67],v55 offset:1024
ds_read_b128 v[68:71],v55 offset:5120
ds_read_b128 v[72:75],v55 offset:2048
ds_read_b128 v[76:79],v55 offset:6144
ds_read_b128 v[80:83],v55 offset:3072
ds_read_b128 v[84:87],v55 offset:7168
ds_read_b128 v[88:91],v123 offset:8192
ds_read_b128 v[92:95],v123 offset:9216
s_branch L_chain_215
L_crp_220:
buffer_load_dwordx4 v[32:35],v0,s[8:11],s66 offen offset:0 sc1
buffer_load_dwordx4 v[36:39],v0,s[8:11],s66 offen offset:1024 sc1
s_sub_u32 s49,s49,1
s_cbranch_scc1 L_abort2
s_waitcnt vmcnt(1)
v_mfma_f32_16x16x32_bf16 v[28:31],v[18:21],v[32:35],0
s_waitcnt vmcnt(0)
v_mfma_f32_16x16x32_bf16 v[28:31],v[18:21],v[36:39],v[28:31]
s_nop 7
v_cmp_u_f32 vcc,v28,v28
v_add_f32_dpp v52,v28,v28 row_ror:8 row_mask:0xf bank_mask:0x3
v_add_f32_dpp v53,v29,v29 row_ror:8 row_mask:0xf bank_mask:0x3
v_add_f32_dpp v52,v30,v30 row_ror:8 row_mask:0xf bank_mask:0xc
v_add_f32_dpp v53,v31,v31 row_ror:8 row_mask:0xf bank_mask:0xc
s_nop 0
v_add_f32_dpp v52,v52,v52 row_shl:4 row_mask:0xf bank_mask:0x5
v_add_f32_dpp v53,v53,v53 row_shl:4 row_mask:0xf bank_mask:0x5
s_cbranch_vccz L_cok_225
s_branch L_crp_220
L_ckw_208:
s_add_u32 s59,s18,s75
L_ww_226:
s_sleep 1
buffer_load_dword v23,off,s[8:11],s59 sc1
s_sub_u32 s49,s49,1
s_cbranch_scc1 L_abort2
s_waitcnt vmcnt(0)
v_readfirstlane_b32 s76,v23
s_cmp_eq_u32 s76,0
s_cbranch_scc1 L_ww_226
L_wwd_227:
s_branch L_ckb_209
L_cend_218:
v_add_u32 v52,s50,v5
v_add_u32 v54,s50,v6
ds_read_b64_tr_b16 v[52:53],v52
ds_read_b64_tr_b16 v[54:55],v54
v_mov_b32_dpp v124,v126 quad_perm:[2,3,2,3] row_mask:0xf bank_mask:0xf
v_mov_b32_dpp v125,v127 quad_perm:[2,3,2,3] row_mask:0xf bank_mask:0xf
s_mov_b32 vcc_lo,0xcccccccc
s_mov_b32 vcc_hi,0xcccccccc
s_waitcnt lgkmcnt(0)
v_cndmask_b32 v124,v124,v52,vcc
v_cndmask_b32 v125,v125,v53,vcc
v_cndmask_b32 v126,v126,v54,vcc
v_cndmask_b32 v127,v127,v55,vcc
buffer_store_dwordx4 v[124:127],v0,s[8:11],s54 offen sc1
s_waitcnt vmcnt(0)
s_barrier
s_nop 11
v_lshrrev_b32 v1,4,v0
s_mov_b32 s53,0
s_branch L_rb_7
L_rc1_202:
v_and_b32 v120,15,v1
v_lshrrev_b32 v121,4,v1
v_and_b32 v122,2,v1
v_cmp_eq_u32 vcc,0,v122
v_mov_b32 v2,0xeeee
v_mov_b32 v123,0x4444
v_cndmask_b32 v2,v2,v123,vcc
v_and_b32 v122,1,v1
v_cmp_eq_u32 vcc,0,v122
v_mov_b32 v3,0xdddd
v_mov_b32 v123,0x8888
v_cndmask_b32 v3,v3,v123,vcc
v_lshrrev_b32 v122,1,v120
v_bfe_u32 v123,v120,2,1
v_xor_b32 v123,v123,v122
v_lshlrev_b32 v4,7,v123
v_and_b32 v123,1,v120
v_lshl_add_u32 v4,v123,6,v4
v_xor_b32 v123,v121,v122
v_and_b32 v123,3,v123
v_lshl_add_u32 v4,v123,4,v4
s_lshl_b32 s56,s46,10
s_add_u32 s56,s56,147456
v_add_u32 v4,s56,v4
v_lshlrev_b32 v122,1,v121
v_add_u32 v122,0,v122
v_and_b32 v123,1,v121
v_xor_b32 v123,v123,v122
v_lshlrev_b32 v5,7,v123
v_bfe_u32 v123,v120,3,1
v_lshl_add_u32 v5,v123,6,v5
v_xor_b32 v123,v120,v122
v_and_b32 v123,3,v123
v_lshl_add_u32 v5,v123,4,v5
v_bfe_u32 v123,v120,2,1
v_lshl_add_u32 v5,v123,3,v5
v_add_u32 v5,147456,v5
v_lshlrev_b32 v122,1,v121
v_add_u32 v122,1,v122
v_and_b32 v123,1,v121
v_xor_b32 v123,v123,v122
v_lshlrev_b32 v6,7,v123
v_bfe_u32 v123,v120,3,1
v_lshl_add_u32 v6,v123,6,v6
v_xor_b32 v123,v120,v122
v_and_b32 v123,3,v123
v_lshl_add_u32 v6,v123,4,v6
v_bfe_u32 v123,v120,2,1
v_lshl_add_u32 v6,v123,3,v6
v_add_u32 v6,147456,v6
v_lshlrev_b32 v7,7,v121
v_lshrrev_b32 v122,1,v120
v_lshl_add_u32 v8,v122,4,v7
v_add_u32 v8,151552,v8
v_lshrrev_b32 v122,2,v120
v_lshl_add_u32 v7,v122,5,v7
v_and_b32 v122,1,v120
v_lshl_add_u32 v7,v122,4,v7
v_and_b32 v122,2,v120
v_cmp_eq_u32 vcc,0,v122
s_lshl_b32 s56,s46,9
v_mov_b32 v122,2048
v_mov_b32 v123,s56
v_cndmask_b32 v122,v122,v123,vcc
v_add_u32 v7,v122,v7
v_add_u32 v7,151552,v7
v_lshrrev_b32 v122,3,v1
v_lshlrev_b32 v9,11,v122
v_and_b32 v122,7,v1
v_lshl_add_u32 v9,v122,3,v9
s_lshl_b32 s56,s46,14
s_lshl_b32 s57,s47,6
s_add_u32 s56,s56,s57
v_add_u32 v9,s56,v9
s_lshl_b32 s71,s47,2
s_add_u32 s71,s71,s46
s_bfe_u32 s56,s71,0x10003
s_lshl_b32 s56,s56,11
s_and_b32 s57,s71,1
s_lshl_b32 s57,s57,10
s_add_u32 s56,s56,s57
s_bfe_u32 s57,s71,0x10002
s_lshl_b32 s57,s57,9
s_add_u32 s56,s56,s57
s_bfe_u32 s57,s71,0x10001
s_lshl_b32 s57,s57,6
s_add_u32 s56,s56,s57
s_bfe_u32 s57,s71,0x10004
s_lshl_b32 s57,s57,8
s_add_u32 s56,s56,s57
s_bfe_u32 s57,s71,0x10005
s_lshl_b32 s57,s57,7
s_add_u32 s56,s56,s57
s_bfe_u32 s57,s71,0x10006
s_lshl_b32 s57,s57,12
s_add_u32 s56,s56,s57
v_and_b32 v122,3,v120
v_lshlrev_b32 v10,2,v122
v_bfe_u32 v122,v120,3,1
v_lshl_add_u32 v10,v122,4,v10
v_and_b32 v122,1,v121
v_lshl_add_u32 v10,v122,5,v10
v_add_u32 v10,s56,v10
v_and_b32 v123,36,v1
v_mov_b32 v122,0x80000000
v_cmp_eq_u32 vcc,0,v123
s_nop 1
v_cndmask_b32 v10,v122,v10,vcc
s_lshl_b32 s56,s46,15
v_add_u32 v11,s56,v0
s_lshl_b32 s71,s71,11
s_lshl_b32 s73,s46,11
s_mov_b32 s72,0xffc00000
s_mov_b32 s74,0
v_lshrrev_b32 v13,3,v1
v_lshlrev_b32 v13,9,v13
v_and_b32 v122,7,v1
v_lshl_add_u32 v13,v122,4,v13
v_and_b32 v122,15,v1
v_and_b32 v123,1,v1
v_lshlrev_b32 v123,4,v123
v_mov_b32 v124,0x3f80
v_lshlrev_b32 v124,v123,v124
v_lshrrev_b32 v122,1,v122
v_cmp_eq_u32 vcc,0,v122
s_nop 1
v_cndmask_b32 v18,0,v124,vcc
v_cmp_eq_u32 vcc,1,v122
s_nop 1
v_cndmask_b32 v19,0,v124,vcc
v_cmp_eq_u32 vcc,2,v122
s_nop 1
v_cndmask_b32 v20,0,v124,vcc
v_cmp_eq_u32 vcc,3,v122
s_nop 1
v_cndmask_b32 v21,0,v124,vcc
s_and_b32 s56,s46,1
s_lshl_b32 s56,s56,8
s_and_b32 s57,s46,2
s_lshl_b32 s57,s57,6
s_add_u32 s56,s56,s57
v_add_u32 v13,s56,v13
s_add_u32 s56,s50,155648
v_add_u32 v12,s56,v0
v_mov_b64 v[14:15],s[28:29]
v_mov_b64 v[16:17],s[28:29]
v_add_u32 v22,12599296,v10
s_lshl_b32 s18,s47,2
s_add_u32 s18,s18,10494080
v_mov_b32 v1,s80
s_mov_b32 s65,15728640
s_add_u32 s66,s71,15728640
s_add_u32 s69,s71,15990784
s_lshl_b32 s79,s47,2
s_add_u32 s79,s79,10486272
s_cmp_eq_u32 s46,0
s_cselect_b32 s79,s79,0x80000000
s_mov_b32 s30,0x40000000
s_mov_b32 s51,0
L_cst_231:
s_cmp_lg_u32 s46,0
s_cbranch_scc1 L_csw_236
s_lshl_b32 s59,s51,13
s_lshl2_add_u32 s59,s47,s59
s_add_u32 s59,s59,10485888
L_ww_237:
s_sleep 1
buffer_load_dword v122,off,s[8:11],s59 sc1
s_sub_u32 s49,s49,1
s_cbranch_scc1 L_abort2
s_waitcnt vmcnt(0)
v_readfirstlane_b32 s61,v122
s_cmp_eq_u32 s61,0
s_cbranch_scc1 L_ww_237
L_wwd_238:
L_csw_236:
s_waitcnt lgkmcnt(0)
s_barrier
s_lshl_b32 s56,s51,5
s_add_u32 s56,s56,s47
s_mul_i32 s56,s56,24576
s_add_u32 s56,s56,150994944
s_add_u32 s67,s56,s73
s_add_u32 m0,s73,131072
s_add_u32 s57,s67,8192
buffer_load_dwordx4 v0,s[8:11],s67 offen sc1 lds
buffer_load_dwordx4 v0,s[8:11],s67 offen offset:1024 sc1 lds
s_add_u32 m0,s73,139264
s_add_u32 s67,s67,786432
buffer_load_dwordx4 v0,s[8:11],s57 offen sc1 lds
buffer_load_dwordx4 v0,s[8:11],s57 offen offset:1024 sc1 lds
s_lshl_b32 s75,s51,13
s_add_u32 s56,s75,12591104
buffer_load_dword v23,v10,s[8:11],s56 offen sc1
s_add_u32 s64,s75,12582912
s_add_u32 s70,s64,4096
s_lshl_b32 s68,s51,5
s_add_u32 s68,s68,s47
s_lshl_b32 s68,s68,12
s_lshl_b32 s56,s46,10
s_add_u32 s68,s68,s56
s_add_u32 s68,s68,58720256
s_mov_b32 s78,0x80000000
s_mov_b32 s55,0x80000000
s_mov_b32 s54,0x80000000
s_mov_b32 s77,0
s_mov_b32 s19,0
s_cmp_eq_u32 s51,63
s_cselect_b32 s76,1,s46
s_cmp_eq_u32 s76,0
s_cselect_b32 s76,1,0
v_mov_b64 v[96:97],0
v_mov_b64 v[98:99],0
v_mov_b64 v[100:101],0
v_mov_b64 v[102:103],0
v_mov_b64 v[104:105],0
v_mov_b64 v[106:107],0
v_mov_b64 v[108:109],0
v_mov_b64 v[110:111],0
v_mov_b64 v[112:113],0
v_mov_b64 v[114:115],0
v_mov_b64 v[116:117],0
v_mov_b64 v[118:119],0
s_waitcnt vmcnt(0) lgkmcnt(0)
s_barrier
v_add_u32 v55,131072,v0
ds_read_b128 v[56:59],v55 offset:0
ds_read_b128 v[60:63],v55 offset:4096
ds_read_b128 v[64:67],v55 offset:1024
ds_read_b128 v[68:71],v55 offset:5120
ds_read_b128 v[72:75],v55 offset:2048
ds_read_b128 v[76:79],v55 offset:6144
ds_read_b128 v[80:83],v55 offset:3072
ds_read_b128 v[84:87],v55 offset:7168
v_add_u32 v123,s73,v55
ds_read_b128 v[88:91],v123 offset:8192
ds_read_b128 v[92:95],v123 offset:9216
v_xor_b32 v120,1024,v12
v_xor_b32 v121,2048,v12
v_xor_b32 v122,3072,v12
buffer_load_dwordx4 v[24:27],v13,s[8:11],s64 offen sc1
buffer_load_dwordx4 v[40:43],v13,s[8:11],s70 offen sc1
L_chain_239:
L_cpa_240:
buffer_load_dwordx4 v[24:27],v13,s[8:11],s64 offen sc1
buffer_load_dwordx4 v[40:43],v13,s[8:11],s70 offen sc1
s_sub_u32 s49,s49,1
s_cbranch_scc1 L_abort2
s_waitcnt vmcnt(2)
v_max3_u32 v123,v24,v25,v26
v_max3_u32 v123,v27,v40,v123
v_max3_u32 v123,v41,v42,v123
v_max_u32 v123,v43,v123
v_cmp_le_u32 vcc,s72,v123
s_cbranch_vccnz L_cpa_240
ds_write_b128 v12,v[24:27] offset:0
ds_write_b128 v12,v[40:43] offset:4096
v_smfmac_f32_16x16x64_bf16 v[96:99],v[24:27],a[0:7],v2
buffer_store_dwordx4 v[124:127],v0,s[8:11],s54 offen sc1
v_smfmac_f32_16x16x64_bf16 v[100:103],v[24:27],a[128:135],v2
buffer_store_dword v54,v10,s[8:11],s30 offen sc1
s_add_u32 m0,s73,131072
s_add_u32 s57,s67,8192
v_smfmac_f32_16x16x64_bf16 v[104:107],v[24:27],a[8:15],v2
v_smfmac_f32_16x16x64_bf16 v[108:111],v[24:27],a[136:143],v2
s_waitcnt lgkmcnt(0)
s_cmp_lt_u32 s19,s76
s_cbranch_scc1 L_ckw_232
L_ckb_233:
s_barrier
ds_read_b128 v[28:31],v120 offset:0
ds_read_b128 v[32:35],v121 offset:0
v_smfmac_f32_16x16x64_bf16 v[96:99],v[40:43],a[64:71],v2
ds_read_b128 v[36:39],v122 offset:0
v_smfmac_f32_16x16x64_bf16 v[100:103],v[40:43],a[192:199],v2
ds_read_b128 v[44:47],v120 offset:4096
v_smfmac_f32_16x16x64_bf16 v[104:107],v[40:43],a[72:79],v2
ds_read_b128 v[48:51],v121 offset:4096
v_smfmac_f32_16x16x64_bf16 v[108:111],v[40:43],a[200:207],v2
ds_read_b128 v[52:55],v122 offset:4096
v_smfmac_f32_16x16x64_bf16 v[112:115],v[24:27],v[128:135],v2
buffer_load_dwordx4 v0,s[8:11],s67 offen sc1 lds
v_smfmac_f32_16x16x64_bf16 v[116:119],v[24:27],v[136:143],v2
v_smfmac_f32_16x16x64_bf16 v[112:115],v[40:43],v[192:199],v2
buffer_load_dwordx4 v0,s[8:11],s67 offen offset:1024 sc1 lds
v_smfmac_f32_16x16x64_bf16 v[116:119],v[40:43],v[200:207],v2
s_waitcnt lgkmcnt(5)
v_smfmac_f32_16x16x64_bf16 v[96:99],v[28:31],a[16:23],v2
s_add_u32 m0,s73,139264
v_smfmac_f32_16x16x64_bf16 v[100:103],v[28:31],a[144:151],v2
buffer_load_dwordx4 v0,s[8:11],s57 offen sc1 lds
v_smfmac_f32_16x16x64_bf16 v[104:107],v[28:31],a[24:31],v2
s_add_u32 s67,s67,786432
v_smfmac_f32_16x16x64_bf16 v[108:111],v[28:31],a[152:159],v2
s_waitcnt lgkmcnt(4)
v_smfmac_f32_16x16x64_bf16 v[96:99],v[32:35],a[32:39],v2
buffer_load_dwordx4 v0,s[8:11],s57 offen offset:1024 sc1 lds
v_smfmac_f32_16x16x64_bf16 v[100:103],v[32:35],a[160:167],v2
v_smfmac_f32_16x16x64_bf16 v[104:107],v[32:35],a[40:47],v2
v_smfmac_f32_16x16x64_bf16 v[108:111],v[32:35],a[168:175],v2
buffer_load_dword v23,v22,s[8:11],s75 offen sc1
s_waitcnt lgkmcnt(3)
v_smfmac_f32_16x16x64_bf16 v[96:99],v[36:39],a[48:55],v2
v_mov_b32 v125,0
v_smfmac_f32_16x16x64_bf16 v[100:103],v[36:39],a[176:183],v2
v_smfmac_f32_16x16x64_bf16 v[104:107],v[36:39],a[56:63],v2
buffer_store_dword v2,off,s[8:11],s78 sc1
v_smfmac_f32_16x16x64_bf16 v[108:111],v[36:39],a[184:191],v2
s_waitcnt lgkmcnt(0)
v_smfmac_f32_16x16x64_bf16 v[96:99],v[44:47],a[80:87],v2
v_smfmac_f32_16x16x64_bf16 v[100:103],v[44:47],a[208:215],v2
v_smfmac_f32_16x16x64_bf16 v[96:99],v[48:51],a[96:103],v2
v_smfmac_f32_16x16x64_bf16 v[100:103],v[48:51],a[224:231],v2
v_smfmac_f32_16x16x64_bf16 v[96:99],v[52:55],a[112:119],v2
v_smfmac_f32_16x16x64_bf16 v[100:103],v[52:55],a[240:247],v2
v_smfmac_f32_16x16x64_bf16 v[104:107],v[44:47],a[88:95],v2
v_smfmac_f32_16x16x64_bf16 v[108:111],v[44:47],a[216:223],v2
v_smfmac_f32_16x16x64_bf16 v[104:107],v[48:51],a[104:111],v2
v_add_f32 v96,v96,v98
v_smfmac_f32_16x16x64_bf16 v[108:111],v[48:51],a[232:239],v2
v_add_f32 v97,v97,v99
v_smfmac_f32_16x16x64_bf16 v[104:107],v[52:55],a[120:127],v2
v_cvt_pk_bf16_f32 v120,v96,v97
v_smfmac_f32_16x16x64_bf16 v[108:111],v[52:55],a[248:255],v2
v_add_f32 v100,v100,v102
v_smfmac_f32_16x16x64_bf16 v[112:115],v[28:31],v[144:151],v2
v_add_f32 v101,v101,v103
v_smfmac_f32_16x16x64_bf16 v[116:119],v[28:31],v[152:159],v2
v_cvt_pk_bf16_f32 v121,v100,v101
v_add_f32 v104,v104,v106
v_add_f32 v105,v105,v107
v_cvt_pk_bf16_f32 v122,v104,v105
v_add_f32 v108,v108,v110
v_add_f32 v109,v109,v111
v_cvt_pk_bf16_f32 v123,v108,v109
ds_write_b128 v4,v[120:123]
v_smfmac_f32_16x16x64_bf16 v[112:115],v[32:35],v[160:167],v2
v_smfmac_f32_16x16x64_bf16 v[116:119],v[32:35],v[168:175],v2
v_smfmac_f32_16x16x64_bf16 v[112:115],v[36:39],v[176:183],v2
v_smfmac_f32_16x16x64_bf16 v[116:119],v[36:39],v[184:191],v2
s_waitcnt vmcnt(8) lgkmcnt(0)
s_barrier
ds_read_b64_tr_b16 v[96:97],v5 offset:0
ds_read_b64_tr_b16 v[98:99],v6 offset:0
v_smfmac_f32_16x16x64_bf16 v[112:115],v[44:47],v[208:215],v2
ds_read_b64_tr_b16 v[100:101],v5 offset:1024
v_smfmac_f32_16x16x64_bf16 v[116:119],v[44:47],v[216:223],v2
ds_read_b64_tr_b16 v[102:103],v6 offset:1024
v_smfmac_f32_16x16x64_bf16 v[112:115],v[48:51],v[224:231],v2
ds_read_b64_tr_b16 v[104:105],v5 offset:2048
v_smfmac_f32_16x16x64_bf16 v[116:119],v[48:51],v[232:239],v2
ds_read_b64_tr_b16 v[106:107],v6 offset:2048
s_waitcnt lgkmcnt(4)
v_mfma_f32_16x16x32_bf16 v[24:27],v[56:59],v[96:99],0
ds_read_b64_tr_b16 v[108:109],v5 offset:3072
v_mfma_f32_16x16x32_bf16 v[28:31],v[60:63],v[96:99],0
ds_read_b64_tr_b16 v[110:111],v6 offset:3072
v_mfma_f32_16x16x32_bf16 v[32:35],v[96:99],v[96:99],0
ds_read_b128 v[40:43],v11 offset:12288
s_waitcnt lgkmcnt(5)
v_mfma_f32_16x16x32_bf16 v[24:27],v[64:67],v[100:103],v[24:27]
ds_read_b128 v[56:59],v11 offset:0
v_mfma_f32_16x16x32_bf16 v[28:31],v[68:71],v[100:103],v[28:31]
ds_read_b128 v[60:63],v11 offset:1024
v_mfma_f32_16x16x32_bf16 v[32:35],v[100:103],v[100:103],v[32:35]
ds_read_b128 v[96:99],v11 offset:8192
s_waitcnt lgkmcnt(6)
v_mfma_f32_16x16x32_bf16 v[24:27],v[72:75],v[104:107],v[24:27]
ds_read_b128 v[64:67],v11 offset:2048
v_mfma_f32_16x16x32_bf16 v[28:31],v[76:79],v[104:107],v[28:31]
ds_read_b128 v[68:71],v11 offset:3072
v_mfma_f32_16x16x32_bf16 v[32:35],v[104:107],v[104:107],v[32:35]
ds_read_b128 v[100:103],v11 offset:9216
s_waitcnt lgkmcnt(7)
v_mfma_f32_16x16x32_bf16 v[24:27],v[80:83],v[108:111],v[24:27]
ds_read_b128 v[72:75],v11 offset:4096
v_mfma_f32_16x16x32_bf16 v[28:31],v[84:87],v[108:111],v[28:31]
ds_read_b128 v[76:79],v11 offset:5120
v_mfma_f32_16x16x32_bf16 v[32:35],v[108:111],v[108:111],v[32:35]
ds_read_b128 v[104:107],v11 offset:10240
v_smfmac_f32_16x16x64_bf16 v[112:115],v[52:55],v[240:247],v2
ds_read_b128 v[80:83],v11 offset:6144
v_smfmac_f32_16x16x64_bf16 v[116:119],v[52:55],v[248:255],v2
ds_read_b128 v[84:87],v11 offset:7168
v_max3_f32 v126,v24,v25,v26
v_max3_f32 v127,v27,v28,v29
v_max3_f32 v126,v30,v31,v126
v_max3_f32 v127,v34,v35,v127
v_max_f32 v126,v126,v127
v_max_f32 v127,v126,v127
v_pk_mul_f32 v[34:35],v[34:35],v[0:1] op_sel:[0,1]
v_pk_mul_f32 v[24:25],v[24:25],v[0:1] op_sel:[0,1]
v_permlane16_swap_b32 v126,v127
v_max_f32 v126,v126,v127
v_max_f32 v127,v126,v127
v_pk_mul_f32 v[26:27],v[26:27],v[0:1] op_sel:[0,1]
v_pk_mul_f32 v[28:29],v[28:29],v[0:1] op_sel:[0,1]
v_permlane32_swap_b32 v126,v127
v_max_f32 v126,v126,v127
v_mul_f32 v126,v1,v126
v_pk_mul_f32 v[30:31],v[30:31],v[0:1] op_sel:[0,1]
v_pk_add_f32 v[34:35],v[34:35],v[126:127] op_sel_hi:[1,0] neg_lo:[0,1] neg_hi:[0,1]
v_pk_add_f32 v[112:113],v[112:113],v[114:115]
v_pk_add_f32 v[116:117],v[116:117],v[118:119]
v_pk_add_f32 v[24:25],v[24:25],v[126:127] op_sel_hi:[1,0] neg_lo:[0,1] neg_hi:[0,1]
v_pk_add_f32 v[26:27],v[26:27],v[126:127] op_sel_hi:[1,0] neg_lo:[0,1] neg_hi:[0,1]
v_pk_add_f32 v[28:29],v[28:29],v[126:127] op_sel_hi:[1,0] neg_lo:[0,1] neg_hi:[0,1]
v_pk_add_f32 v[30:31],v[30:31],v[126:127] op_sel_hi:[1,0] neg_lo:[0,1] neg_hi:[0,1]
v_exp_f32 v34,v34
v_exp_f32 v35,v35
v_cvt_pk_bf16_f32 v126,v112,v113
v_cvt_pk_bf16_f32 v124,v34,v35
v_cvt_pk_bf16_f32 v127,v116,v117
v_cvt_pk_bf16_f32 v36,v116,v117
v_mfma_f32_16x16x16_bf16 v[32:35],v[14:15],v[124:125],0
ds_read_b128 v[108:111],v11 offset:11264
v_exp_f32 v24,v24
v_mfma_f32_16x16x16_bf16 v[112:115],v[126:127],v[124:125],0
ds_read_b128 v[44:47],v11 offset:13312
v_exp_f32 v25,v25
v_mfma_f32_16x16x16_bf16 v[116:119],v[36:37],v[124:125],0
ds_read_b128 v[48:51],v11 offset:14336
v_exp_f32 v26,v26
v_exp_f32 v27,v27
v_cvt_pk_bf16_f32 v120,v24,v25
v_exp_f32 v28,v28
v_exp_f32 v29,v29
v_cvt_pk_bf16_f32 v121,v26,v27
v_exp_f32 v30,v30
v_exp_f32 v31,v31
v_cvt_pk_bf16_f32 v122,v28,v29
v_cvt_pk_bf16_f32 v123,v30,v31
s_mov_b32 s78,s55
s_add_u32 s55,s79,s75
v_mfma_f32_16x16x32_bf16 v[32:35],v[14:17],v[120:123],v[32:35]
ds_read_b128 v[52:55],v11 offset:15360
v_mfma_f32_16x16x32_bf16 v[112:115],v[88:91],v[120:123],v[112:115]
ds_read_b128 v[88:91],v11 offset:16384
v_mfma_f32_16x16x32_bf16 v[116:119],v[92:95],v[120:123],v[116:119]
ds_read_b128 v[92:95],v11 offset:17408
v_rcp_f32 v32,v32
v_mov_b64 v[24:25],-1
v_mov_b64 v[26:27],-1
s_mov_b32 s54,s68
s_add_u32 s75,s75,8192
v_pk_mul_f32 v[112:113],v[112:113],v[32:33] op_sel_hi:[1,0]
v_pk_mul_f32 v[114:115],v[114:115],v[32:33] op_sel_hi:[1,0]
v_pk_mul_f32 v[116:117],v[116:117],v[32:33] op_sel_hi:[1,0]
v_pk_mul_f32 v[118:119],v[118:119],v[32:33] op_sel_hi:[1,0]
v_cvt_pk_bf16_f32 v120,v112,v116
v_cvt_pk_bf16_f32 v121,v113,v117
v_cvt_pk_bf16_f32 v122,v114,v118
v_cvt_pk_bf16_f32 v123,v115,v119
ds_write_b128 v7,v[120:123]
buffer_store_dwordx4 v[24:27],v0,s[8:11],s69 offen sc1
buffer_store_dwordx4 v[24:27],v0,s[8:11],s69 offen offset:1024 sc1
s_waitcnt lgkmcnt(0)
s_barrier
ds_read_b128 v[24:27],v8 offset:0
ds_read_b128 v[28:31],v8 offset:512
ds_read_b128 v[32:35],v8 offset:1024
ds_read_b128 v[36:39],v8 offset:1536
v_mov_b64 v[112:113],0
v_mov_b64 v[114:115],0
v_mov_b64 v[116:117],0
v_mov_b64 v[118:119],0
v_mov_b64 v[120:121],0
v_mov_b64 v[122:123],0
s_add_u32 s30,s75,17825792
s_add_u32 s64,s75,12582912
s_add_u32 s70,s64,4096
s_add_u32 s68,s68,131072
s_add_u32 s51,s51,1
s_cmp_eq_u32 s51,64
s_cbranch_scc1 L_cend_242
s_waitcnt lgkmcnt(3)
v_smfmac_f32_16x16x64_bf16 v[112:115],v[24:27],v[56:63],v3
ds_read_b128 v[56:59],v11 offset:18432
s_add_u32 s57,s65,65536
s_waitcnt lgkmcnt(3)
v_smfmac_f32_16x16x64_bf16 v[112:115],v[28:31],v[64:71],v3
ds_read_b128 v[60:63],v11 offset:19456
s_add_u32 s58,s65,131072
s_waitcnt lgkmcnt(3)
v_smfmac_f32_16x16x64_bf16 v[112:115],v[32:35],v[72:79],v3
ds_read_b128 v[64:67],v11 offset:20480
s_add_u32 s59,s65,196608
s_waitcnt lgkmcnt(3)
v_smfmac_f32_16x16x64_bf16 v[112:115],v[36:39],v[80:87],v3
ds_read_b128 v[68:71],v11 offset:21504
v_smfmac_f32_16x16x64_bf16 v[116:119],v[24:27],v[96:103],v3
ds_read_b128 v[72:75],v11 offset:22528
v_smfmac_f32_16x16x64_bf16 v[116:119],v[28:31],v[104:111],v3
ds_read_b128 v[76:79],v11 offset:23552
v_cvt_pk_bf16_f32 v112,v112,v113
v_smfmac_f32_16x16x64_bf16 v[116:119],v[32:35],v[40:47],v3
ds_read_b128 v[80:83],v11 offset:24576
v_cvt_pk_bf16_f32 v113,v114,v115
buffer_store_dwordx2 v[112:113],v9,s[8:11],s65 offen sc1
v_smfmac_f32_16x16x64_bf16 v[116:119],v[36:39],v[48:55],v3
ds_read_b128 v[84:87],v11 offset:25600
v_mov_b64 v[112:113],0
v_smfmac_f32_16x16x64_bf16 v[120:123],v[24:27],v[88:95],v3
ds_read_b128 v[96:99],v11 offset:26624
ds_read_b128 v[100:103],v11 offset:27648
v_mov_b64 v[114:115],0
s_waitcnt lgkmcnt(8)
v_smfmac_f32_16x16x64_bf16 v[120:123],v[28:31],v[56:63],v3
ds_read_b128 v[104:107],v11 offset:28672
v_cvt_pk_bf16_f32 v116,v116,v117
s_waitcnt lgkmcnt(7)
v_smfmac_f32_16x16x64_bf16 v[120:123],v[32:35],v[64:71],v3
ds_read_b128 v[108:111],v11 offset:29696
ds_read_b128 v[40:43],v11 offset:30720
v_cvt_pk_bf16_f32 v117,v118,v119
buffer_store_dwordx2 v[116:117],v9,s[8:11],s57 offen sc1
s_waitcnt lgkmcnt(7)
v_smfmac_f32_16x16x64_bf16 v[120:123],v[36:39],v[72:79],v3
ds_read_b128 v[44:47],v11 offset:31744
s_waitcnt lgkmcnt(6)
v_smfmac_f32_16x16x64_bf16 v[112:115],v[24:27],v[80:87],v3
s_waitcnt lgkmcnt(4)
v_smfmac_f32_16x16x64_bf16 v[112:115],v[28:31],v[96:103],v3
v_cvt_pk_bf16_f32 v120,v120,v121
s_waitcnt lgkmcnt(2)
v_smfmac_f32_16x16x64_bf16 v[112:115],v[32:35],v[104:111],v3
v_cvt_pk_bf16_f32 v121,v122,v123
buffer_store_dwordx2 v[120:121],v9,s[8:11],s58 offen sc1
s_waitcnt lgkmcnt(0)
v_smfmac_f32_16x16x64_bf16 v[112:115],v[36:39],v[40:47],v3
v_mov_b64 v[116:117],0
v_mov_b64 v[118:119],0
s_xor_b32 s65,s65,262144
v_add_u32 v52,s50,v5
v_add_u32 v54,s50,v6
v_mov_b32_dpp v124,v126 quad_perm:[2,3,2,3] row_mask:0xf bank_mask:0xf
v_mov_b32_dpp v125,v127 quad_perm:[2,3,2,3] row_mask:0xf bank_mask:0xf
s_nop 0
v_cvt_pk_bf16_f32 v112,v112,v113
v_cvt_pk_bf16_f32 v113,v114,v115
buffer_store_dwordx2 v[112:113],v9,s[8:11],s59 offen sc1
ds_read_b64_tr_b16 v[52:53],v52
ds_read_b64_tr_b16 v[54:55],v54
s_mov_b32 vcc_lo,0xcccccccc
s_mov_b32 vcc_hi,0xcccccccc
v_mov_b64 v[96:97],0
v_mov_b64 v[98:99],0
v_mov_b64 v[100:101],0
v_mov_b64 v[102:103],0
v_mov_b64 v[104:105],0
v_mov_b64 v[106:107],0
v_mov_b64 v[108:109],0
v_mov_b64 v[110:111],0
v_mov_b64 v[112:113],0
v_mov_b64 v[114:115],0
s_waitcnt lgkmcnt(0)
v_cndmask_b32 v124,v124,v52,vcc
v_cndmask_b32 v125,v125,v53,vcc
v_cndmask_b32 v126,v126,v54,vcc
v_cndmask_b32 v127,v127,v55,vcc
s_add_u32 s56,s18,s75
s_buffer_load_dword s19,s[8:11],s56
v_add_u32 v55,131072,v0
v_add_u32 v123,s73,v55
v_xor_b32 v120,1024,v12
v_xor_b32 v121,2048,v12
v_xor_b32 v122,3072,v12
s_waitcnt vmcnt(0)
buffer_load_dwordx4 v[32:35],v0,s[8:11],s66 offen offset:0 sc1
buffer_load_dwordx4 v[36:39],v0,s[8:11],s66 offen offset:1024 sc1
s_cmp_ge_u32 s51,63
s_cselect_b32 s76,0,1
s_cmp_eq_u32 s46,0
s_cselect_b32 s76,s76,0
s_waitcnt vmcnt(1)
v_mfma_f32_16x16x32_bf16 v[28:31],v[18:21],v[32:35],0
s_waitcnt vmcnt(0)
v_mfma_f32_16x16x32_bf16 v[28:31],v[18:21],v[36:39],v[28:31]
s_nop 7
v_cmp_u_f32 vcc,v28,v28
v_add_f32_dpp v52,v28,v28 row_ror:8 row_mask:0xf bank_mask:0x3
v_add_f32_dpp v53,v29,v29 row_ror:8 row_mask:0xf bank_mask:0x3
v_add_f32_dpp v52,v30,v30 row_ror:8 row_mask:0xf bank_mask:0xc
v_add_f32_dpp v53,v31,v31 row_ror:8 row_mask:0xf bank_mask:0xc
s_nop 0
v_add_f32_dpp v52,v52,v52 row_shl:4 row_mask:0xf bank_mask:0x5
v_add_f32_dpp v53,v53,v53 row_shl:4 row_mask:0xf bank_mask:0x5
s_cbranch_vccnz L_crp_244
L_cok_249:
v_cvt_pk_bf16_f32 v54,v52,v53
buffer_store_dword v54,v10,s[8:11],s64 offen sc1
s_mov_b32 s69,s66
s_xor_b32 s66,s66,262144
s_barrier
ds_read_b128 v[56:59],v55 offset:0
ds_read_b128 v[60:63],v55 offset:4096
buffer_load_dwordx4 v[24:27],v13,s[8:11],s64 offen sc1
buffer_load_dwordx4 v[40:43],v13,s[8:11],s70 offen sc1
ds_read_b128 v[64:67],v55 offset:1024
ds_read_b128 v[68:71],v55 offset:5120
ds_read_b128 v[72:75],v55 offset:2048
ds_read_b128 v[76:79],v55 offset:6144
ds_read_b128 v[80:83],v55 offset:3072
ds_read_b128 v[84:87],v55 offset:7168
ds_read_b128 v[88:91],v123 offset:8192
ds_read_b128 v[92:95],v123 offset:9216
s_branch L_chain_239
L_crp_244:
buffer_load_dwordx4 v[32:35],v0,s[8:11],s66 offen offset:0 sc1
buffer_load_dwordx4 v[36:39],v0,s[8:11],s66 offen offset:1024 sc1
s_sub_u32 s49,s49,1
s_cbranch_scc1 L_abort2
s_waitcnt vmcnt(1)
v_mfma_f32_16x16x32_bf16 v[28:31],v[18:21],v[32:35],0
s_waitcnt vmcnt(0)
v_mfma_f32_16x16x32_bf16 v[28:31],v[18:21],v[36:39],v[28:31]
s_nop 7
v_cmp_u_f32 vcc,v28,v28
v_add_f32_dpp v52,v28,v28 row_ror:8 row_mask:0xf bank_mask:0x3
v_add_f32_dpp v53,v29,v29 row_ror:8 row_mask:0xf bank_mask:0x3
v_add_f32_dpp v52,v30,v30 row_ror:8 row_mask:0xf bank_mask:0xc
v_add_f32_dpp v53,v31,v31 row_ror:8 row_mask:0xf bank_mask:0xc
s_nop 0
v_add_f32_dpp v52,v52,v52 row_shl:4 row_mask:0xf bank_mask:0x5
v_add_f32_dpp v53,v53,v53 row_shl:4 row_mask:0xf bank_mask:0x5
s_cbranch_vccz L_cok_249
s_branch L_crp_244
L_ckw_232:
s_add_u32 s59,s18,s75
L_ww_250:
s_sleep 1
buffer_load_dword v23,off,s[8:11],s59 sc1
s_sub_u32 s49,s49,1
s_cbranch_scc1 L_abort2
s_waitcnt vmcnt(0)
v_readfirstlane_b32 s76,v23
s_cmp_eq_u32 s76,0
s_cbranch_scc1 L_ww_250
L_wwd_251:
s_branch L_ckb_233
L_cend_242:
v_add_u32 v52,s50,v5
v_add_u32 v54,s50,v6
ds_read_b64_tr_b16 v[52:53],v52
ds_read_b64_tr_b16 v[54:55],v54
v_mov_b32_dpp v124,v126 quad_perm:[2,3,2,3] row_mask:0xf bank_mask:0xf
v_mov_b32_dpp v125,v127 quad_perm:[2,3,2,3] row_mask:0xf bank_mask:0xf
s_mov_b32 vcc_lo,0xcccccccc
s_mov_b32 vcc_hi,0xcccccccc
s_waitcnt lgkmcnt(0)
v_cndmask_b32 v124,v124,v52,vcc
v_cndmask_b32 v125,v125,v53,vcc
v_cndmask_b32 v126,v126,v54,vcc
v_cndmask_b32 v127,v127,v55,vcc
buffer_store_dwordx4 v[124:127],v0,s[8:11],s54 offen sc1
s_waitcnt vmcnt(0)
s_barrier
buffer_store_dword v2,off,s[8:11],s78 sc1
buffer_store_dword v2,off,s[8:11],s55 sc1
s_nop 11
v_lshrrev_b32 v1,4,v0
s_endpgm
L_rc2_203:
v_and_b32 v120,15,v1
v_lshrrev_b32 v121,4,v1
v_and_b32 v122,2,v1
v_cmp_eq_u32 vcc,0,v122
v_mov_b32 v2,0xeeee
v_mov_b32 v123,0x4444
v_cndmask_b32 v2,v2,v123,vcc
v_and_b32 v122,1,v1
v_cmp_eq_u32 vcc,0,v122
v_mov_b32 v3,0xdddd
v_mov_b32 v123,0x8888
v_cndmask_b32 v3,v3,v123,vcc
v_lshrrev_b32 v122,1,v120
v_bfe_u32 v123,v120,2,1
v_xor_b32 v123,v123,v122
v_lshlrev_b32 v4,7,v123
v_and_b32 v123,1,v120
v_lshl_add_u32 v4,v123,6,v4
v_xor_b32 v123,v121,v122
v_and_b32 v123,3,v123
v_lshl_add_u32 v4,v123,4,v4
s_lshl_b32 s56,s46,10
s_add_u32 s56,s56,147456
v_add_u32 v4,s56,v4
v_lshlrev_b32 v122,1,v121
v_add_u32 v122,0,v122
v_and_b32 v123,1,v121
v_xor_b32 v123,v123,v122
v_lshlrev_b32 v5,7,v123
v_bfe_u32 v123,v120,3,1
v_lshl_add_u32 v5,v123,6,v5
v_xor_b32 v123,v120,v122
v_and_b32 v123,3,v123
v_lshl_add_u32 v5,v123,4,v5
v_bfe_u32 v123,v120,2,1
v_lshl_add_u32 v5,v123,3,v5
v_add_u32 v5,147456,v5
v_lshlrev_b32 v122,1,v121
v_add_u32 v122,1,v122
v_and_b32 v123,1,v121
v_xor_b32 v123,v123,v122
v_lshlrev_b32 v6,7,v123
v_bfe_u32 v123,v120,3,1
v_lshl_add_u32 v6,v123,6,v6
v_xor_b32 v123,v120,v122
v_and_b32 v123,3,v123
v_lshl_add_u32 v6,v123,4,v6
v_bfe_u32 v123,v120,2,1
v_lshl_add_u32 v6,v123,3,v6
v_add_u32 v6,147456,v6
v_lshlrev_b32 v7,7,v121
v_lshrrev_b32 v122,1,v120
v_lshl_add_u32 v8,v122,4,v7
v_add_u32 v8,151552,v8
v_lshrrev_b32 v122,2,v120
v_lshl_add_u32 v7,v122,5,v7
v_and_b32 v122,1,v120
v_lshl_add_u32 v7,v122,4,v7
v_and_b32 v122,2,v120
v_cmp_eq_u32 vcc,0,v122
s_lshl_b32 s56,s46,9
v_mov_b32 v122,2048
v_mov_b32 v123,s56
v_cndmask_b32 v122,v122,v123,vcc
v_add_u32 v7,v122,v7
v_add_u32 v7,151552,v7
v_lshrrev_b32 v122,3,v1
v_lshlrev_b32 v9,11,v122
v_and_b32 v122,7,v1
v_lshl_add_u32 v9,v122,3,v9
s_lshl_b32 s56,s46,14
s_lshl_b32 s57,s47,6
s_add_u32 s56,s56,s57
v_add_u32 v9,s56,v9
s_lshl_b32 s71,s47,2
s_add_u32 s71,s71,s46
s_bfe_u32 s56,s71,0x10003
s_lshl_b32 s56,s56,11
s_and_b32 s57,s71,1
s_lshl_b32 s57,s57,10
s_add_u32 s56,s56,s57
s_bfe_u32 s57,s71,0x10002
s_lshl_b32 s57,s57,9
s_add_u32 s56,s56,s57
s_bfe_u32 s57,s71,0x10001
s_lshl_b32 s57,s57,6
s_add_u32 s56,s56,s57
s_bfe_u32 s57,s71,0x10004
s_lshl_b32 s57,s57,8
s_add_u32 s56,s56,s57
s_bfe_u32 s57,s71,0x10005
s_lshl_b32 s57,s57,7
s_add_u32 s56,s56,s57
s_bfe_u32 s57,s71,0x10006
s_lshl_b32 s57,s57,12
s_add_u32 s56,s56,s57
v_and_b32 v122,3,v120
v_lshlrev_b32 v10,2,v122
v_bfe_u32 v122,v120,3,1
v_lshl_add_u32 v10,v122,4,v10
v_and_b32 v122,1,v121
v_lshl_add_u32 v10,v122,5,v10
v_add_u32 v10,s56,v10
v_and_b32 v123,36,v1
v_mov_b32 v122,0x80000000
v_cmp_eq_u32 vcc,0,v123
s_nop 1
v_cndmask_b32 v10,v122,v10,vcc
s_lshl_b32 s56,s46,15
v_add_u32 v11,s56,v0
s_lshl_b32 s71,s71,11
s_lshl_b32 s73,s46,11
s_mov_b32 s72,0xffc00000
s_mov_b32 s74,0
v_lshrrev_b32 v13,3,v1
v_lshlrev_b32 v13,9,v13
v_and_b32 v122,7,v1
v_lshl_add_u32 v13,v122,4,v13
v_and_b32 v122,15,v1
v_and_b32 v123,1,v1
v_lshlrev_b32 v123,4,v123
v_mov_b32 v124,0x3f80
v_lshlrev_b32 v124,v123,v124
v_lshrrev_b32 v122,1,v122
v_cmp_eq_u32 vcc,0,v122
s_nop 1
v_cndmask_b32 v18,0,v124,vcc
v_cmp_eq_u32 vcc,1,v122
s_nop 1
v_cndmask_b32 v19,0,v124,vcc
v_cmp_eq_u32 vcc,2,v122
s_nop 1
v_cndmask_b32 v20,0,v124,vcc
v_cmp_eq_u32 vcc,3,v122
s_nop 1
v_cndmask_b32 v21,0,v124,vcc
s_and_b32 s56,s46,1
s_lshl_b32 s56,s56,8
s_and_b32 s57,s46,2
s_lshl_b32 s57,s57,6
s_add_u32 s56,s56,s57
v_add_u32 v13,s56,v13
s_add_u32 s56,s50,155648
v_add_u32 v12,s56,v0
v_mov_b64 v[14:15],s[28:29]
v_mov_b64 v[16:17],s[28:29]
v_add_u32 v22,13647872,v10
s_lshl_b32 s18,s47,2
s_add_u32 s18,s18,10494080
v_mov_b32 v1,s80
s_mov_b32 s65,16777216
s_add_u32 s66,s71,16777216
s_add_u32 s69,s71,17039360
s_lshl_b32 s79,s47,2
s_add_u32 s79,s79,10486400
s_cmp_eq_u32 s46,0
s_cselect_b32 s79,s79,0x80000000
s_mov_b32 s30,0x40000000
s_mov_b32 s51,0
v_lshrrev_b32 v120,2,v0
v_add_u32 v120,10510464,v120
v_or_b32 v120,s52,v120
s_mov_b64 vcc,-1
s_mov_b32 vcc_lo,0
v_cndmask_b32 v22,v22,v120,vcc
s_or_b32 s56,s52,10495616
v_writelane_b32 v22,s56,4
s_or_b32 s56,s47,s46
s_mov_b32 s56,10486784
s_cmov_b32 s56,0x80000000
v_writelane_b32 v22,s56,5
s_mov_b32 s30,0
s_mov_b32 s31,0
L_cst_255:
s_cmp_lg_u32 s46,0
s_cbranch_scc1 L_csw_260
s_lshl_b32 s59,s31,13
s_add_u32 s59,s59,10486016
v_lshrrev_b32 v121,2,v0
v_and_b32 v121,127,v121
L_ckk_261:
s_sleep 1
buffer_load_dword v120,v121,s[8:11],s59 offen sc1
s_sub_u32 s49,s49,1
s_cbranch_scc1 L_abort2
s_waitcnt vmcnt(0)
v_cmp_eq_u32 vcc,0,v120
s_cbranch_vccnz L_ckk_261
v_max_u32_dpp v120,v120,v120 row_ror:8 row_mask:0xf bank_mask:0xf
s_nop 1
v_max_u32_dpp v120,v120,v120 row_ror:4 row_mask:0xf bank_mask:0xf
s_nop 1
v_max_u32_dpp v120,v120,v120 row_ror:2 row_mask:0xf bank_mask:0xf
s_nop 1
v_max_u32_dpp v120,v120,v120 row_ror:1 row_mask:0xf bank_mask:0xf
v_mov_b32 v121,v120
s_nop 1
v_permlane16_swap_b32 v120,v121
v_max_u32 v120,v120,v121
v_mov_b32 v121,v120
s_nop 1
v_permlane32_swap_b32 v120,v121
v_max_u32 v120,v120,v121
s_nop 0
v_readfirstlane_b32 s61,v120
s_max_u32 s30,s30,s61
s_add_u32 s31,s31,1
s_andn2_b32 s51,0x7ff,s30
s_lshr_b32 s51,s51,5
s_add_u32 s61,s51,2
s_min_u32 s61,s61,63
s_cmp_le_u32 s31,s61
s_cbranch_scc1 L_cst_255
v_mov_b32 v120,0
v_mov_b32 v121,s30
ds_write_b32 v8,v120 offset:2560
ds_write_b32 v8,v121 offset:3072
s_lshl_b32 s59,s51,13
s_lshl2_add_u32 s59,s47,s59
s_add_u32 s59,s59,10485888
L_ww_262:
s_sleep 1
buffer_load_dword v122,off,s[8:11],s59 sc1
s_sub_u32 s49,s49,1
s_cbranch_scc1 L_abort2
s_waitcnt vmcnt(0)
v_readfirstlane_b32 s61,v122
s_cmp_eq_u32 s61,0
s_cbranch_scc1 L_ww_262
L_wwd_263:
L_csw_260:
s_waitcnt lgkmcnt(0)
s_barrier
ds_read_b32 v120,v8 offset:3072
s_waitcnt lgkmcnt(0)
v_readfirstlane_b32 s30,v120
s_andn2_b32 s51,0x7ff,s30
s_lshr_b32 s51,s51,5
s_lshl_b32 s56,s51,5
s_add_u32 s56,s56,s47
s_mul_i32 s56,s56,24576
s_add_u32 s56,s56,150994944
s_add_u32 s67,s56,s73
s_add_u32 m0,s73,131072
s_add_u32 s57,s67,8192
buffer_load_dwordx4 v0,s[8:11],s67 offen sc1 lds
buffer_load_dwordx4 v0,s[8:11],s67 offen offset:1024 sc1 lds
s_add_u32 m0,s73,139264
s_add_u32 s67,s67,786432
buffer_load_dwordx4 v0,s[8:11],s57 offen sc1 lds
buffer_load_dwordx4 v0,s[8:11],s57 offen offset:1024 sc1 lds
s_lshl_b32 s75,s51,13
s_add_u32 s56,s75,13639680
buffer_load_dword v23,v10,s[8:11],s56 offen sc1
s_add_u32 s64,s75,17825792
s_add_u32 s70,s64,4096
s_lshl_b32 s68,s51,5
s_add_u32 s68,s68,s47
s_lshl_b32 s68,s68,12
s_lshl_b32 s56,s46,10
s_add_u32 s68,s68,s56
s_add_u32 s68,s68,75497472
s_mov_b32 s78,0x80000000
s_mov_b32 s55,0x80000000
s_mov_b32 s54,0x80000000
s_mov_b32 s77,0
s_mov_b32 s19,0
s_cmp_eq_u32 s51,63
s_cselect_b32 s76,1,s46
s_cmp_eq_u32 s76,0
s_cselect_b32 s76,1,0
v_mov_b64 v[96:97],0
v_mov_b64 v[98:99],0
v_mov_b64 v[100:101],0
v_mov_b64 v[102:103],0
v_mov_b64 v[104:105],0
v_mov_b64 v[106:107],0
v_mov_b64 v[108:109],0
v_mov_b64 v[110:111],0
v_mov_b64 v[112:113],0
v_mov_b64 v[114:115],0
v_mov_b64 v[116:117],0
v_mov_b64 v[118:119],0
v_lshrrev_b32 v56,8,v0
v_lshlrev_b32 v56,5,v56
v_bfe_u32 v57,v0,5,1
v_lshl_add_u32 v56,v57,2,v56
s_lshl_b32 s56,s46,7
s_add_u32 s56,s56,155648
v_add_u32 v56,s56,v56
v_xor_b32 v57,128,v56
v_xor_b32 v58,256,v56
v_xor_b32 v59,384,v56
s_andn2_b32 s56,31,s30
s_lshr_b32 s57,s56,4
s_lshl_b32 s58,s57,12
s_and_b32 s59,s56,15
s_lshl4_add_u32 s58,s59,s58
s_add_u32 s58,s58,s50
s_add_u32 s58,s58,131072
v_bfe_u32 v60,v0,6,2
v_lshlrev_b32 v60,8,v60
v_bfe_u32 v61,v0,4,2
v_lshl_add_u32 v60,v61,2,v60
v_add_u32 v60,s58,v60
s_lshr_b32 s58,s59,2
s_lshl_b32 s58,s58,8
s_lshl3_add_u32 s58,s57,s58
s_and_b32 s59,s56,3
s_lshl1_add_u32 s58,s59,s58
s_add_u32 s58,s58,s73
s_add_u32 s58,s58,139264
v_and_b32 v61,255,v0
v_add_u32 v61,s58,v61
s_cmp_lg_u32 s46,0
s_cbranch_scc1 L_chd_265
s_lshl_b32 s59,s51,10
s_add_u32 s59,s59,11337728
L_chp_264:
buffer_load_dwordx4 v[120:123],v0,s[8:11],s59 offen sc1
s_sub_u32 s49,s49,1
s_cbranch_scc1 L_abort2
s_waitcnt vmcnt(0)
v_max3_u32 v124,v120,v121,v122
v_max_u32 v124,v123,v124
v_cmp_eq_u32 vcc,-1,v124
s_cbranch_vccnz L_chp_264
ds_write_b128 v12,v[120:123]
L_chd_265:
s_waitcnt vmcnt(0) lgkmcnt(0)
s_barrier
ds_read2_b32 v[24:25],v56 offset0:0 offset1:2
ds_read2_b32 v[26:27],v56 offset0:4 offset1:6
ds_read2_b32 v[28:29],v57 offset0:0 offset1:2
ds_read2_b32 v[30:31],v57 offset0:4 offset1:6
ds_read2_b32 v[32:33],v58 offset0:0 offset1:2
ds_read2_b32 v[34:35],v58 offset0:4 offset1:6
ds_read2_b32 v[36:37],v59 offset0:0 offset1:2
ds_read2_b32 v[38:39],v59 offset0:4 offset1:6
s_waitcnt lgkmcnt(4)
ds_read2_b32 v[40:41],v56 offset0:128 offset1:130
ds_read2_b32 v[42:43],v56 offset0:132 offset1:134
ds_read2_b32 v[44:45],v57 offset0:128 offset1:130
ds_read2_b32 v[46:47],v57 offset0:132 offset1:134
ds_read2_b32 v[48:49],v58 offset0:128 offset1:130
ds_read2_b32 v[50:51],v58 offset0:132 offset1:134
ds_read2_b32 v[52:53],v59 offset0:128 offset1:130
ds_read2_b32 v[54:55],v59 offset0:132 offset1:134
s_waitcnt lgkmcnt(12)
v_smfmac_f32_16x16x64_bf16 v[100:103],v[24:27],a[128:135],v2
v_smfmac_f32_16x16x64_bf16 v[112:115],v[24:27],v[128:135],v2
v_smfmac_f32_16x16x64_bf16 v[108:111],v[24:27],a[136:143],v2
v_smfmac_f32_16x16x64_bf16 v[116:119],v[24:27],v[136:143],v2
s_waitcnt lgkmcnt(12)
v_smfmac_f32_16x16x64_bf16 v[100:103],v[28:31],a[144:151],v2
v_smfmac_f32_16x16x64_bf16 v[112:115],v[28:31],v[144:151],v2
v_smfmac_f32_16x16x64_bf16 v[108:111],v[28:31],a[152:159],v2
v_smfmac_f32_16x16x64_bf16 v[116:119],v[28:31],v[152:159],v2
s_waitcnt lgkmcnt(10)
v_smfmac_f32_16x16x64_bf16 v[100:103],v[32:35],a[160:167],v2
v_smfmac_f32_16x16x64_bf16 v[112:115],v[32:35],v[160:167],v2
v_smfmac_f32_16x16x64_bf16 v[108:111],v[32:35],a[168:175],v2
v_smfmac_f32_16x16x64_bf16 v[116:119],v[32:35],v[168:175],v2
s_waitcnt lgkmcnt(8)
v_smfmac_f32_16x16x64_bf16 v[100:103],v[36:39],a[176:183],v2
v_smfmac_f32_16x16x64_bf16 v[112:115],v[36:39],v[176:183],v2
v_smfmac_f32_16x16x64_bf16 v[108:111],v[36:39],a[184:191],v2
v_smfmac_f32_16x16x64_bf16 v[116:119],v[36:39],v[184:191],v2
s_waitcnt lgkmcnt(6)
v_smfmac_f32_16x16x64_bf16 v[100:103],v[40:43],a[192:199],v2
v_smfmac_f32_16x16x64_bf16 v[112:115],v[40:43],v[192:199],v2
v_smfmac_f32_16x16x64_bf16 v[108:111],v[40:43],a[200:207],v2
v_smfmac_f32_16x16x64_bf16 v[116:119],v[40:43],v[200:207],v2
s_waitcnt lgkmcnt(4)
v_smfmac_f32_16x16x64_bf16 v[100:103],v[44:47],a[208:215],v2
v_smfmac_f32_16x16x64_bf16 v[112:115],v[44:47],v[208:215],v2
v_smfmac_f32_16x16x64_bf16 v[108:111],v[44:47],a[216:223],v2
v_smfmac_f32_16x16x64_bf16 v[116:119],v[44:47],v[216:223],v2
s_waitcnt lgkmcnt(2)
v_smfmac_f32_16x16x64_bf16 v[100:103],v[48:51],a[224:231],v2
v_smfmac_f32_16x16x64_bf16 v[112:115],v[48:51],v[224:231],v2
v_smfmac_f32_16x16x64_bf16 v[108:111],v[48:51],a[232:239],v2
v_smfmac_f32_16x16x64_bf16 v[116:119],v[48:51],v[232:239],v2
s_waitcnt lgkmcnt(0)
v_smfmac_f32_16x16x64_bf16 v[100:103],v[52:55],a[240:247],v2
v_smfmac_f32_16x16x64_bf16 v[112:115],v[52:55],v[240:247],v2
v_smfmac_f32_16x16x64_bf16 v[108:111],v[52:55],a[248:255],v2
v_smfmac_f32_16x16x64_bf16 v[116:119],v[52:55],v[248:255],v2
v_add_f32 v100,v100,v102
v_add_f32 v112,v112,v114
s_nop 1
v_add_f32 v108,v108,v110
s_nop 2
v_add_f32 v116,v116,v118
v_cvt_pk_bf16_f32 v120,v100,v108
v_cvt_pk_bf16_f32 v121,v112,v116
ds_write_b32 v60,v120
ds_write_b16 v61,v121
ds_write_b16_d16_hi v61,v121 offset:1024
v_mov_b64 v[96:97],0
v_mov_b64 v[98:99],0
v_mov_b64 v[100:101],0
v_mov_b64 v[102:103],0
v_mov_b64 v[104:105],0
v_mov_b64 v[106:107],0
v_mov_b64 v[108:109],0
v_mov_b64 v[110:111],0
v_mov_b64 v[112:113],0
v_mov_b64 v[114:115],0
v_mov_b64 v[116:117],0
v_mov_b64 v[118:119],0
s_waitcnt vmcnt(0) lgkmcnt(0)
s_barrier
v_add_u32 v55,131072,v0
ds_read_b128 v[56:59],v55 offset:0
ds_read_b128 v[60:63],v55 offset:4096
ds_read_b128 v[64:67],v55 offset:1024
ds_read_b128 v[68:71],v55 offset:5120
ds_read_b128 v[72:75],v55 offset:2048
ds_read_b128 v[76:79],v55 offset:6144
ds_read_b128 v[80:83],v55 offset:3072
ds_read_b128 v[84:87],v55 offset:7168
v_add_u32 v123,s73,v55
ds_read_b128 v[88:91],v123 offset:8192
ds_read_b128 v[92:95],v123 offset:9216
v_xor_b32 v120,1024,v12
v_xor_b32 v121,2048,v12
v_xor_b32 v122,3072,v12
buffer_load_dwordx4 v[24:27],v13,s[8:11],s64 offen sc1
buffer_load_dwordx4 v[40:43],v13,s[8:11],s70 offen sc1
L_chain_266:
L_cpa_267:
buffer_load_dwordx4 v[24:27],v13,s[8:11],s64 offen sc1
buffer_load_dwordx4 v[40:43],v13,s[8:11],s70 offen sc1
s_sub_u32 s49,s49,1
s_cbranch_scc1 L_abort2
s_waitcnt vmcnt(2)
v_max3_u32 v123,v24,v25,v26
v_max3_u32 v123,v27,v40,v123
v_max3_u32 v123,v41,v42,v123
v_max_u32 v123,v43,v123
v_cmp_le_u32 vcc,s72,v123
s_cbranch_vccnz L_cpa_267
ds_write_b128 v12,v[24:27] offset:0
ds_write_b128 v12,v[40:43] offset:4096
v_smfmac_f32_16x16x64_bf16 v[96:99],v[24:27],a[0:7],v2
buffer_store_dwordx4 v[124:127],v0,s[8:11],s54 offen sc1
v_smfmac_f32_16x16x64_bf16 v[100:103],v[24:27],a[128:135],v2
s_add_u32 m0,s73,131072
s_add_u32 s57,s67,8192
v_smfmac_f32_16x16x64_bf16 v[104:107],v[24:27],a[8:15],v2
v_smfmac_f32_16x16x64_bf16 v[108:111],v[24:27],a[136:143],v2
s_waitcnt lgkmcnt(0)
s_cmp_lt_u32 s19,s76
s_cbranch_scc1 L_ckw_256
L_ckb_257:
s_barrier
ds_read_b32 v123,v8 offset:2560
ds_read_b128 v[28:31],v120 offset:0
ds_read_b128 v[32:35],v121 offset:0
v_smfmac_f32_16x16x64_bf16 v[96:99],v[40:43],a[64:71],v2
ds_read_b128 v[36:39],v122 offset:0
v_smfmac_f32_16x16x64_bf16 v[100:103],v[40:43],a[192:199],v2
ds_read_b128 v[44:47],v120 offset:4096
v_smfmac_f32_16x16x64_bf16 v[104:107],v[40:43],a[72:79],v2
ds_read_b128 v[48:51],v121 offset:4096
v_smfmac_f32_16x16x64_bf16 v[108:111],v[40:43],a[200:207],v2
ds_read_b128 v[52:55],v122 offset:4096
v_smfmac_f32_16x16x64_bf16 v[112:115],v[24:27],v[128:135],v2
buffer_load_dwordx4 v0,s[8:11],s67 offen sc1 lds
v_smfmac_f32_16x16x64_bf16 v[116:119],v[24:27],v[136:143],v2
v_smfmac_f32_16x16x64_bf16 v[112:115],v[40:43],v[192:199],v2
buffer_load_dwordx4 v0,s[8:11],s67 offen offset:1024 sc1 lds
v_smfmac_f32_16x16x64_bf16 v[116:119],v[40:43],v[200:207],v2
s_waitcnt lgkmcnt(5)
v_smfmac_f32_16x16x64_bf16 v[96:99],v[28:31],a[16:23],v2
s_add_u32 m0,s73,139264
v_smfmac_f32_16x16x64_bf16 v[100:103],v[28:31],a[144:151],v2
buffer_load_dwordx4 v0,s[8:11],s57 offen sc1 lds
v_smfmac_f32_16x16x64_bf16 v[104:107],v[28:31],a[24:31],v2
s_add_u32 s67,s67,786432
v_smfmac_f32_16x16x64_bf16 v[108:111],v[28:31],a[152:159],v2
v_readfirstlane_b32 s58,v123
s_waitcnt lgkmcnt(4)
v_smfmac_f32_16x16x64_bf16 v[96:99],v[32:35],a[32:39],v2
buffer_load_dwordx4 v0,s[8:11],s57 offen offset:1024 sc1 lds
v_smfmac_f32_16x16x64_bf16 v[100:103],v[32:35],a[160:167],v2
s_cmp_lg_u32 s58,0
s_cbranch_scc1 L_cjump_259
v_smfmac_f32_16x16x64_bf16 v[104:107],v[32:35],a[40:47],v2
v_smfmac_f32_16x16x64_bf16 v[108:111],v[32:35],a[168:175],v2
buffer_load_dword v23,v22,s[8:11],s75 offen sc1
s_waitcnt lgkmcnt(3)
v_smfmac_f32_16x16x64_bf16 v[96:99],v[36:39],a[48:55],v2
v_mov_b32 v125,0
v_smfmac_f32_16x16x64_bf16 v[100:103],v[36:39],a[176:183],v2
v_smfmac_f32_16x16x64_bf16 v[104:107],v[36:39],a[56:63],v2
buffer_store_dword v2,off,s[8:11],s78 sc1
v_smfmac_f32_16x16x64_bf16 v[108:111],v[36:39],a[184:191],v2
s_waitcnt lgkmcnt(0)
v_smfmac_f32_16x16x64_bf16 v[96:99],v[44:47],a[80:87],v2
v_smfmac_f32_16x16x64_bf16 v[100:103],v[44:47],a[208:215],v2
v_smfmac_f32_16x16x64_bf16 v[96:99],v[48:51],a[96:103],v2
v_smfmac_f32_16x16x64_bf16 v[100:103],v[48:51],a[224:231],v2
v_smfmac_f32_16x16x64_bf16 v[96:99],v[52:55],a[112:119],v2
v_smfmac_f32_16x16x64_bf16 v[100:103],v[52:55],a[240:247],v2
v_smfmac_f32_16x16x64_bf16 v[104:107],v[44:47],a[88:95],v2
v_smfmac_f32_16x16x64_bf16 v[108:111],v[44:47],a[216:223],v2
v_smfmac_f32_16x16x64_bf16 v[104:107],v[48:51],a[104:111],v2
v_add_f32 v96,v96,v98
v_smfmac_f32_16x16x64_bf16 v[108:111],v[48:51],a[232:239],v2
v_add_f32 v97,v97,v99
v_smfmac_f32_16x16x64_bf16 v[104:107],v[52:55],a[120:127],v2
v_cvt_pk_bf16_f32 v120,v96,v97
v_smfmac_f32_16x16x64_bf16 v[108:111],v[52:55],a[248:255],v2
v_add_f32 v100,v100,v102
v_smfmac_f32_16x16x64_bf16 v[112:115],v[28:31],v[144:151],v2
v_add_f32 v101,v101,v103
v_smfmac_f32_16x16x64_bf16 v[116:119],v[28:31],v[152:159],v2
v_cvt_pk_bf16_f32 v121,v100,v101
v_add_f32 v104,v104,v106
v_add_f32 v105,v105,v107
v_cvt_pk_bf16_f32 v122,v104,v105
v_add_f32 v108,v108,v110
v_add_f32 v109,v109,v111
v_cvt_pk_bf16_f32 v123,v108,v109
ds_write_b128 v4,v[120:123]
v_smfmac_f32_16x16x64_bf16 v[112:115],v[32:35],v[160:167],v2
v_smfmac_f32_16x16x64_bf16 v[116:119],v[32:35],v[168:175],v2
v_smfmac_f32_16x16x64_bf16 v[112:115],v[36:39],v[176:183],v2
v_smfmac_f32_16x16x64_bf16 v[116:119],v[36:39],v[184:191],v2
s_waitcnt vmcnt(7) lgkmcnt(0)
s_barrier
ds_read_b64_tr_b16 v[96:97],v5 offset:0
ds_read_b64_tr_b16 v[98:99],v6 offset:0
v_smfmac_f32_16x16x64_bf16 v[112:115],v[44:47],v[208:215],v2
ds_read_b64_tr_b16 v[100:101],v5 offset:1024
v_smfmac_f32_16x16x64_bf16 v[116:119],v[44:47],v[216:223],v2
ds_read_b64_tr_b16 v[102:103],v6 offset:1024
v_smfmac_f32_16x16x64_bf16 v[112:115],v[48:51],v[224:231],v2
ds_read_b64_tr_b16 v[104:105],v5 offset:2048
v_smfmac_f32_16x16x64_bf16 v[116:119],v[48:51],v[232:239],v2
ds_read_b64_tr_b16 v[106:107],v6 offset:2048
s_waitcnt lgkmcnt(4)
v_mfma_f32_16x16x32_bf16 v[24:27],v[56:59],v[96:99],0
ds_read_b64_tr_b16 v[108:109],v5 offset:3072
v_mfma_f32_16x16x32_bf16 v[28:31],v[60:63],v[96:99],0
ds_read_b64_tr_b16 v[110:111],v6 offset:3072
v_mfma_f32_16x16x32_bf16 v[32:35],v[96:99],v[96:99],0
ds_read_b128 v[40:43],v11 offset:12288
s_waitcnt lgkmcnt(5)
v_mfma_f32_16x16x32_bf16 v[24:27],v[64:67],v[100:103],v[24:27]
ds_read_b128 v[56:59],v11 offset:0
v_mfma_f32_16x16x32_bf16 v[28:31],v[68:71],v[100:103],v[28:31]
ds_read_b128 v[60:63],v11 offset:1024
v_mfma_f32_16x16x32_bf16 v[32:35],v[100:103],v[100:103],v[32:35]
ds_read_b128 v[96:99],v11 offset:8192
s_waitcnt lgkmcnt(6)
v_mfma_f32_16x16x32_bf16 v[24:27],v[72:75],v[104:107],v[24:27]
ds_read_b128 v[64:67],v11 offset:2048
v_mfma_f32_16x16x32_bf16 v[28:31],v[76:79],v[104:107],v[28:31]
ds_read_b128 v[68:71],v11 offset:3072
v_mfma_f32_16x16x32_bf16 v[32:35],v[104:107],v[104:107],v[32:35]
ds_read_b128 v[100:103],v11 offset:9216
s_waitcnt lgkmcnt(7)
v_mfma_f32_16x16x32_bf16 v[24:27],v[80:83],v[108:111],v[24:27]
ds_read_b128 v[72:75],v11 offset:4096
v_mfma_f32_16x16x32_bf16 v[28:31],v[84:87],v[108:111],v[28:31]
ds_read_b128 v[76:79],v11 offset:5120
v_mfma_f32_16x16x32_bf16 v[32:35],v[108:111],v[108:111],v[32:35]
ds_read_b128 v[104:107],v11 offset:10240
v_smfmac_f32_16x16x64_bf16 v[112:115],v[52:55],v[240:247],v2
ds_read_b128 v[80:83],v11 offset:6144
v_smfmac_f32_16x16x64_bf16 v[116:119],v[52:55],v[248:255],v2
ds_read_b128 v[84:87],v11 offset:7168
v_max3_f32 v126,v24,v25,v26
v_max3_f32 v127,v27,v28,v29
v_max3_f32 v126,v30,v31,v126
v_max3_f32 v127,v34,v35,v127
v_max_f32 v126,v126,v127
v_max_f32 v127,v126,v127
v_pk_mul_f32 v[34:35],v[34:35],v[0:1] op_sel:[0,1]
v_pk_mul_f32 v[24:25],v[24:25],v[0:1] op_sel:[0,1]
v_permlane16_swap_b32 v126,v127
v_max_f32 v126,v126,v127
v_max_f32 v127,v126,v127
v_pk_mul_f32 v[26:27],v[26:27],v[0:1] op_sel:[0,1]
v_pk_mul_f32 v[28:29],v[28:29],v[0:1] op_sel:[0,1]
v_permlane32_swap_b32 v126,v127
v_max_f32 v126,v126,v127
v_mul_f32 v126,v1,v126
v_pk_mul_f32 v[30:31],v[30:31],v[0:1] op_sel:[0,1]
v_pk_add_f32 v[34:35],v[34:35],v[126:127] op_sel_hi:[1,0] neg_lo:[0,1] neg_hi:[0,1]
v_pk_add_f32 v[112:113],v[112:113],v[114:115]
v_pk_add_f32 v[116:117],v[116:117],v[118:119]
v_pk_add_f32 v[24:25],v[24:25],v[126:127] op_sel_hi:[1,0] neg_lo:[0,1] neg_hi:[0,1]
v_pk_add_f32 v[26:27],v[26:27],v[126:127] op_sel_hi:[1,0] neg_lo:[0,1] neg_hi:[0,1]
v_pk_add_f32 v[28:29],v[28:29],v[126:127] op_sel_hi:[1,0] neg_lo:[0,1] neg_hi:[0,1]
v_pk_add_f32 v[30:31],v[30:31],v[126:127] op_sel_hi:[1,0] neg_lo:[0,1] neg_hi:[0,1]
v_exp_f32 v34,v34
v_exp_f32 v35,v35
v_cvt_pk_bf16_f32 v126,v112,v113
v_cvt_pk_bf16_f32 v124,v34,v35
v_cvt_pk_bf16_f32 v127,v116,v117
v_cvt_pk_bf16_f32 v36,v116,v117
v_mfma_f32_16x16x16_bf16 v[32:35],v[14:15],v[124:125],0
ds_read_b128 v[108:111],v11 offset:11264
v_exp_f32 v24,v24
v_mfma_f32_16x16x16_bf16 v[112:115],v[126:127],v[124:125],0
ds_read_b128 v[44:47],v11 offset:13312
v_exp_f32 v25,v25
v_mfma_f32_16x16x16_bf16 v[116:119],v[36:37],v[124:125],0
ds_read_b128 v[48:51],v11 offset:14336
v_exp_f32 v26,v26
v_exp_f32 v27,v27
v_cvt_pk_bf16_f32 v120,v24,v25
v_exp_f32 v28,v28
v_exp_f32 v29,v29
v_cvt_pk_bf16_f32 v121,v26,v27
v_exp_f32 v30,v30
v_exp_f32 v31,v31
v_cvt_pk_bf16_f32 v122,v28,v29
v_cvt_pk_bf16_f32 v123,v30,v31
s_mov_b32 s78,s55
s_add_u32 s55,s79,s75
v_mfma_f32_16x16x32_bf16 v[32:35],v[14:17],v[120:123],v[32:35]
ds_read_b128 v[52:55],v11 offset:15360
v_mfma_f32_16x16x32_bf16 v[112:115],v[88:91],v[120:123],v[112:115]
ds_read_b128 v[88:91],v11 offset:16384
v_mfma_f32_16x16x32_bf16 v[116:119],v[92:95],v[120:123],v[116:119]
ds_read_b128 v[92:95],v11 offset:17408
v_rcp_f32 v32,v32
v_mov_b64 v[24:25],-1
v_mov_b64 v[26:27],-1
s_mov_b32 s54,s68
s_add_u32 s75,s75,8192
v_pk_mul_f32 v[112:113],v[112:113],v[32:33] op_sel_hi:[1,0]
v_pk_mul_f32 v[114:115],v[114:115],v[32:33] op_sel_hi:[1,0]
v_pk_mul_f32 v[116:117],v[116:117],v[32:33] op_sel_hi:[1,0]
v_pk_mul_f32 v[118:119],v[118:119],v[32:33] op_sel_hi:[1,0]
v_cvt_pk_bf16_f32 v120,v112,v116
v_cvt_pk_bf16_f32 v121,v113,v117
v_cvt_pk_bf16_f32 v122,v114,v118
v_cvt_pk_bf16_f32 v123,v115,v119
ds_write_b128 v7,v[120:123]
buffer_store_dwordx4 v[24:27],v0,s[8:11],s69 offen sc1
buffer_store_dwordx4 v[24:27],v0,s[8:11],s69 offen offset:1024 sc1
s_waitcnt lgkmcnt(0)
s_barrier
ds_read_b128 v[24:27],v8 offset:0
ds_read_b128 v[28:31],v8 offset:512
ds_read_b128 v[32:35],v8 offset:1024
ds_read_b128 v[36:39],v8 offset:1536
v_mov_b64 v[112:113],0
v_mov_b64 v[114:115],0
v_mov_b64 v[116:117],0
v_mov_b64 v[118:119],0
v_mov_b64 v[120:121],0
v_mov_b64 v[122:123],0
s_add_u32 s64,s75,13631488
s_add_u32 s70,s64,4096
s_add_u32 s68,s68,131072
s_add_u32 s51,s51,1
s_cmp_eq_u32 s51,64
s_cbranch_scc1 L_cend_269
s_waitcnt lgkmcnt(3)
v_smfmac_f32_16x16x64_bf16 v[112:115],v[24:27],v[56:63],v3
ds_read_b128 v[56:59],v11 offset:18432
s_add_u32 s57,s65,65536
s_waitcnt lgkmcnt(3)
v_smfmac_f32_16x16x64_bf16 v[112:115],v[28:31],v[64:71],v3
ds_read_b128 v[60:63],v11 offset:19456
s_add_u32 s58,s65,131072
s_waitcnt lgkmcnt(3)
v_smfmac_f32_16x16x64_bf16 v[112:115],v[32:35],v[72:79],v3
ds_read_b128 v[64:67],v11 offset:20480
s_add_u32 s59,s65,196608
s_waitcnt lgkmcnt(3)
v_smfmac_f32_16x16x64_bf16 v[112:115],v[36:39],v[80:87],v3
ds_read_b128 v[68:71],v11 offset:21504
v_smfmac_f32_16x16x64_bf16 v[116:119],v[24:27],v[96:103],v3
ds_read_b128 v[72:75],v11 offset:22528
v_smfmac_f32_16x16x64_bf16 v[116:119],v[28:31],v[104:111],v3
ds_read_b128 v[76:79],v11 offset:23552
v_cvt_pk_bf16_f32 v112,v112,v113
v_smfmac_f32_16x16x64_bf16 v[116:119],v[32:35],v[40:47],v3
ds_read_b128 v[80:83],v11 offset:24576
v_cvt_pk_bf16_f32 v113,v114,v115
buffer_store_dwordx2 v[112:113],v9,s[8:11],s65 offen sc1
v_smfmac_f32_16x16x64_bf16 v[116:119],v[36:39],v[48:55],v3
ds_read_b128 v[84:87],v11 offset:25600
v_mov_b64 v[112:113],0
v_smfmac_f32_16x16x64_bf16 v[120:123],v[24:27],v[88:95],v3
ds_read_b128 v[96:99],v11 offset:26624
ds_read_b128 v[100:103],v11 offset:27648
v_mov_b64 v[114:115],0
s_waitcnt lgkmcnt(8)
v_smfmac_f32_16x16x64_bf16 v[120:123],v[28:31],v[56:63],v3
ds_read_b128 v[104:107],v11 offset:28672
v_cvt_pk_bf16_f32 v116,v116,v117
s_waitcnt lgkmcnt(7)
v_smfmac_f32_16x16x64_bf16 v[120:123],v[32:35],v[64:71],v3
ds_read_b128 v[108:111],v11 offset:29696
ds_read_b128 v[40:43],v11 offset:30720
v_cvt_pk_bf16_f32 v117,v118,v119
buffer_store_dwordx2 v[116:117],v9,s[8:11],s57 offen sc1
s_waitcnt lgkmcnt(7)
v_smfmac_f32_16x16x64_bf16 v[120:123],v[36:39],v[72:79],v3
ds_read_b128 v[44:47],v11 offset:31744
s_waitcnt lgkmcnt(6)
v_smfmac_f32_16x16x64_bf16 v[112:115],v[24:27],v[80:87],v3
s_waitcnt lgkmcnt(4)
v_smfmac_f32_16x16x64_bf16 v[112:115],v[28:31],v[96:103],v3
v_cvt_pk_bf16_f32 v120,v120,v121
s_waitcnt lgkmcnt(2)
v_smfmac_f32_16x16x64_bf16 v[112:115],v[32:35],v[104:111],v3
v_cvt_pk_bf16_f32 v121,v122,v123
buffer_store_dwordx2 v[120:121],v9,s[8:11],s58 offen sc1
s_waitcnt lgkmcnt(0)
v_smfmac_f32_16x16x64_bf16 v[112:115],v[36:39],v[40:47],v3
v_mov_b64 v[116:117],0
v_mov_b64 v[118:119],0
s_xor_b32 s65,s65,262144
v_add_u32 v52,s50,v5
v_add_u32 v54,s50,v6
v_mov_b32_dpp v124,v126 quad_perm:[2,3,2,3] row_mask:0xf bank_mask:0xf
v_mov_b32_dpp v125,v127 quad_perm:[2,3,2,3] row_mask:0xf bank_mask:0xf
s_nop 0
v_cvt_pk_bf16_f32 v112,v112,v113
v_cvt_pk_bf16_f32 v113,v114,v115
buffer_store_dwordx2 v[112:113],v9,s[8:11],s59 offen sc1
ds_read_b64_tr_b16 v[52:53],v52
ds_read_b64_tr_b16 v[54:55],v54
s_mov_b32 vcc_lo,0xcccccccc
s_mov_b32 vcc_hi,0xcccccccc
v_mov_b64 v[96:97],0
v_mov_b64 v[98:99],0
v_mov_b64 v[100:101],0
v_mov_b64 v[102:103],0
v_mov_b64 v[104:105],0
v_mov_b64 v[106:107],0
v_mov_b64 v[108:109],0
v_mov_b64 v[110:111],0
v_mov_b64 v[112:113],0
v_mov_b64 v[114:115],0
s_waitcnt lgkmcnt(0)
v_cndmask_b32 v124,v124,v52,vcc
v_cndmask_b32 v125,v125,v53,vcc
v_cndmask_b32 v126,v126,v54,vcc
v_cndmask_b32 v127,v127,v55,vcc
s_add_u32 s56,s18,s75
s_buffer_load_dword s19,s[8:11],s56
v_add_u32 v55,131072,v0
v_add_u32 v123,s73,v55
v_xor_b32 v120,1024,v12
v_xor_b32 v121,2048,v12
v_xor_b32 v122,3072,v12
s_waitcnt vmcnt(0)
buffer_load_dwordx4 v[32:35],v0,s[8:11],s66 offen offset:0 sc1
buffer_load_dwordx4 v[36:39],v0,s[8:11],s66 offen offset:1024 sc1
s_cmp_ge_u32 s51,63
s_cselect_b32 s76,0,1
v_readlane_b32 s56,v23,5
v_readlane_b32 s20,v23,4
v_add_u32 v23,-1,v23
v_cmp_le_u32 vcc,s30,v23
s_cmp_gt_u32 s51,61
s_cselect_b32 s77,0,vcc_hi
s_cmp_gt_u32 s20,s30
s_cselect_b32 s77,1,s77
s_cmp_lg_u32 s77,0
s_cselect_b32 s76,2,s76
s_cmp_gt_u32 s56,s30
s_cbranch_scc1 L_cld_252
L_clb_253:
s_cmp_eq_u32 s46,0
s_cselect_b32 s76,s76,0
s_waitcnt vmcnt(1)
v_mfma_f32_16x16x32_bf16 v[28:31],v[18:21],v[32:35],0
s_waitcnt vmcnt(0)
v_mfma_f32_16x16x32_bf16 v[28:31],v[18:21],v[36:39],v[28:31]
s_nop 7
v_cmp_u_f32 vcc,v28,v28
v_add_f32_dpp v52,v28,v28 row_ror:8 row_mask:0xf bank_mask:0x3
v_add_f32_dpp v53,v29,v29 row_ror:8 row_mask:0xf bank_mask:0x3
v_add_f32_dpp v52,v30,v30 row_ror:8 row_mask:0xf bank_mask:0xc
v_add_f32_dpp v53,v31,v31 row_ror:8 row_mask:0xf bank_mask:0xc
s_nop 0
v_add_f32_dpp v52,v52,v52 row_shl:4 row_mask:0xf bank_mask:0x5
v_add_f32_dpp v53,v53,v53 row_shl:4 row_mask:0xf bank_mask:0x5
s_cbranch_vccnz L_crp_271
L_cok_276:
v_cvt_pk_bf16_f32 v54,v52,v53
buffer_store_dword v54,v10,s[8:11],s64 offen sc1
s_mov_b32 s69,s66
s_xor_b32 s66,s66,262144
s_barrier
ds_read_b128 v[56:59],v55 offset:0
ds_read_b128 v[60:63],v55 offset:4096
buffer_load_dwordx4 v[24:27],v13,s[8:11],s64 offen sc1
buffer_load_dwordx4 v[40:43],v13,s[8:11],s70 offen sc1
ds_read_b128 v[64:67],v55 offset:1024
ds_read_b128 v[68:71],v55 offset:5120
ds_read_b128 v[72:75],v55 offset:2048
ds_read_b128 v[76:79],v55 offset:6144
ds_read_b128 v[80:83],v55 offset:3072
ds_read_b128 v[84:87],v55 offset:7168
ds_read_b128 v[88:91],v123 offset:8192
ds_read_b128 v[92:95],v123 offset:9216
s_branch L_chain_266
L_crp_271:
buffer_load_dwordx4 v[32:35],v0,s[8:11],s66 offen offset:0 sc1
buffer_load_dwordx4 v[36:39],v0,s[8:11],s66 offen offset:1024 sc1
s_sub_u32 s49,s49,1
s_cbranch_scc1 L_abort2
s_waitcnt vmcnt(1)
v_mfma_f32_16x16x32_bf16 v[28:31],v[18:21],v[32:35],0
s_waitcnt vmcnt(0)
v_mfma_f32_16x16x32_bf16 v[28:31],v[18:21],v[36:39],v[28:31]
s_nop 7
v_cmp_u_f32 vcc,v28,v28
v_add_f32_dpp v52,v28,v28 row_ror:8 row_mask:0xf bank_mask:0x3
v_add_f32_dpp v53,v29,v29 row_ror:8 row_mask:0xf bank_mask:0x3
v_add_f32_dpp v52,v30,v30 row_ror:8 row_mask:0xf bank_mask:0xc
v_add_f32_dpp v53,v31,v31 row_ror:8 row_mask:0xf bank_mask:0xc
s_nop 0
v_add_f32_dpp v52,v52,v52 row_shl:4 row_mask:0xf bank_mask:0x5
v_add_f32_dpp v53,v53,v53 row_shl:4 row_mask:0xf bank_mask:0x5
s_cbranch_vccz L_cok_276
s_branch L_crp_271
L_ckw_256:
s_cmp_eq_u32 s77,0
s_cbranch_scc1 L_cjw_258
s_andn2_b32 s31,0x7ff,s20
s_lshr_b32 s31,s31,5
s_cmp_gt_u32 s20,s30
s_cbranch_scc1 L_cjs_254
s_add_u32 s31,s51,2
s_lshl_b32 s59,s31,13
s_add_u32 s59,s59,10486016
v_lshrrev_b32 v29,2,v0
v_and_b32 v29,127,v29
L_ckk_277:
s_sleep 1
buffer_load_dword v28,v29,s[8:11],s59 offen sc1
s_sub_u32 s49,s49,1
s_cbranch_scc1 L_abort2
s_waitcnt vmcnt(0)
v_cmp_eq_u32 vcc,0,v28
s_cbranch_vccnz L_ckk_277
v_cmp_lt_u32 vcc,s30,v28
s_cbranch_vccz L_cjw_258
L_cjs_254:
ds_write_b32 v8,v2 offset:2560
s_waitcnt lgkmcnt(0)
s_branch L_ckb_257
L_cld_252:
v_mov_b32 v23,s56
s_add_u32 s56,s75,10495616
buffer_store_dword v23,off,s[8:11],s56 sc1
s_waitcnt vmcnt(0)
s_branch L_clb_253
L_cjw_258:
s_cmp_lg_u32 s19,0
s_cbranch_scc1 L_ckb_257
s_add_u32 s59,s18,s75
L_ww_278:
s_sleep 1
buffer_load_dword v23,off,s[8:11],s59 sc1
s_sub_u32 s49,s49,1
s_cbranch_scc1 L_abort2
s_waitcnt vmcnt(0)
v_readfirstlane_b32 s76,v23
s_cmp_eq_u32 s76,0
s_cbranch_scc1 L_ww_278
L_wwd_279:
s_branch L_ckb_257
L_cjump_259:
s_waitcnt vmcnt(0) lgkmcnt(0)
s_barrier
s_branch L_cst_255
L_cend_269:
v_add_u32 v52,s50,v5
v_add_u32 v54,s50,v6
ds_read_b64_tr_b16 v[52:53],v52
ds_read_b64_tr_b16 v[54:55],v54
v_mov_b32_dpp v124,v126 quad_perm:[2,3,2,3] row_mask:0xf bank_mask:0xf
v_mov_b32_dpp v125,v127 quad_perm:[2,3,2,3] row_mask:0xf bank_mask:0xf
s_mov_b32 vcc_lo,0xcccccccc
s_mov_b32 vcc_hi,0xcccccccc
s_waitcnt lgkmcnt(0)
v_cndmask_b32 v124,v124,v52,vcc
v_cndmask_b32 v125,v125,v53,vcc
v_cndmask_b32 v126,v126,v54,vcc
v_cndmask_b32 v127,v127,v55,vcc
buffer_store_dwordx4 v[124:127],v0,s[8:11],s54 offen sc1
s_waitcnt vmcnt(0)
s_barrier
buffer_store_dword v2,off,s[8:11],s78 sc1
buffer_store_dword v2,off,s[8:11],s55 sc1
s_nop 11
v_lshrrev_b32 v1,4,v0
s_endpgm
L_wa:
s_nop 11
v_and_b32 v238,15,v1
v_and_b32 v239,1,v1
v_lshlrev_b32 v239,4,v239
v_mov_b32 v240,0x3f80
v_lshlrev_b32 v240,v239,v240
v_lshrrev_b32 v238,1,v238
v_cmp_eq_u32 vcc,0,v238
s_nop 1
v_cndmask_b32 v156,0,v240,vcc
v_cmp_eq_u32 vcc,1,v238
s_nop 1
v_cndmask_b32 v157,0,v240,vcc
v_cmp_eq_u32 vcc,2,v238
s_nop 1
v_cndmask_b32 v158,0,v240,vcc
v_cmp_eq_u32 vcc,3,v238
s_nop 1
v_cndmask_b32 v159,0,v240,vcc
s_mov_b32 s4,s32
s_mov_b32 s5,s33
s_mov_b32 s6,1024
s_mov_b32 s7,0x20000
buffer_load_dwordx4 v[224:227],v0,s[4:7],0 offen
v_and_b32 v238,15,v1
v_lshrrev_b32 v239,4,v1
v_lshlrev_b32 v240,2,v239
v_mov_b32 v241,0xf149f2ca
s_and_b32 s56,s46,1
s_lshl_b32 s56,s56,4
v_add_u32 v242,s56,v238
v_add_u32 v243,0,v240
v_cmp_gt_u32 vcc,v243,v242
s_nop 1
v_cndmask_b32 v8,0,v241,vcc
v_add_u32 v243,1,v240
v_cmp_gt_u32 vcc,v243,v242
s_nop 1
v_cndmask_b32 v9,0,v241,vcc
v_add_u32 v243,2,v240
v_cmp_gt_u32 vcc,v243,v242
s_nop 1
v_cndmask_b32 v10,0,v241,vcc
v_add_u32 v243,3,v240
v_cmp_gt_u32 vcc,v243,v242
s_nop 1
v_cndmask_b32 v11,0,v241,vcc
v_add_u32 v243,16,v240
v_cmp_gt_u32 vcc,v243,v242
s_nop 1
v_cndmask_b32 v12,0,v241,vcc
v_add_u32 v243,17,v240
v_cmp_gt_u32 vcc,v243,v242
s_nop 1
v_cndmask_b32 v13,0,v241,vcc
v_add_u32 v243,18,v240
v_cmp_gt_u32 vcc,v243,v242
s_nop 1
v_cndmask_b32 v14,0,v241,vcc
v_add_u32 v243,19,v240
v_cmp_gt_u32 vcc,v243,v242
s_nop 1
v_cndmask_b32 v15,0,v241,vcc
v_mov_b64 v[152:153],s[28:29]
v_mov_b64 v[154:155],s[28:29]
v_mov_b32 v145,0
v_mov_b32 v146,0
s_lshl_b32 s56,s46,12
s_add_u32 s56,s56,131072
v_add_u32 v3,s56,v0
v_add_u32 v4,131072,v0
s_lshl_b32 s56,s46,8
v_lshlrev_b32 v7,4,v238
v_add_u32 v7,s56,v7
v_lshl_add_u32 v5,v239,16,v7
v_lshlrev_b32 v6,1,v7
v_lshl_add_u32 v7,v239,10,v7
v_and_b32 v243,1,v239
v_lshl_add_u32 v6,v243,4,v6
v_lshrrev_b32 v243,1,v239
v_lshl_add_u32 v6,v243,12,v6
v_add_u32 v6,147456,v6
v_lshlrev_b32 v16,2,v238
v_lshlrev_b32 v21,3,v238
s_and_b32 s68,s47,15
s_lshl_b32 s56,s68,10
v_add_u32 v5,s56,v5
s_lshl_b32 s56,s68,15
v_add_u32 v7,s56,v7
s_lshl_b32 s69,s54,20
s_add_u32 s69,s69,20971520
s_lshl_b32 s87,s54,13
s_add_u32 s87,s87,10486656
s_lshl2_add_u32 s74,s68,s87
s_or_b32 s74,s74,s52
s_lshl_b32 s68,s68,1
s_lshr_b32 s56,s46,1
s_add_u32 s68,s68,s56
s_mov_b32 s66,0
s_mov_b32 s67,0
s_mov_b32 s73,0x80000000
s_mov_b32 s75,0
s_mov_b32 s37,0
s_mov_b64 s[38:39],0
s_sub_u32 s36,s54,13
s_and_b32 s36,s36,3
s_mov_b32 s12,s40
s_mov_b32 s13,s41
s_mov_b32 s14,2097152
s_mov_b32 s15,0x20000
v_add_u32 v21,10487168,v21
v_mov_b32 v244,v21
s_and_b32 s56,s50,2048
s_add_u32 s56,s56,147456
v_lshlrev_b32 v23,5,v1
v_add_u32 v23,s56,v23
v_and_b32 v253,32,v0
v_lshrrev_b32 v245,2,v253
v_add_u32 v253,v253,v245
v_sub_u32 v253,v0,v253
v_add_u32 v253,8,v253
v_mov_b32 v254,0x80000000
s_mov_b32 s56,1408
v_writelane_b32 v254,s56,0
s_mov_b32 s56,256
v_writelane_b32 v254,s56,1
s_mov_b32 s56,1280
v_writelane_b32 v254,s56,2
v_mov_b32 v245,155648
s_lshl_b32 s56,s46,2
v_add_u32 v247,s56,v245
s_waitcnt vmcnt(0)
v_lshlrev_b32 v228,16,v224
v_and_b32 v229,0xffff0000,v224
v_lshlrev_b32 v230,16,v225
v_and_b32 v231,0xffff0000,v225
v_lshlrev_b32 v232,16,v226
v_and_b32 v233,0xffff0000,v226
v_lshlrev_b32 v234,16,v227
v_and_b32 v235,0xffff0000,v227
v_mul_f32 v255,v228,v228
v_fma_f32 v255,v229,v229,v255
v_fma_f32 v255,v230,v230,v255
v_fma_f32 v255,v231,v231,v255
v_fma_f32 v255,v232,v232,v255
v_fma_f32 v255,v233,v233,v255
v_fma_f32 v255,v234,v234,v255
v_fma_f32 v255,v235,v235,v255
s_nop 1
v_add_f32_dpp v255,v255,v255 row_ror:8 row_mask:0xf bank_mask:0xf
s_nop 1
v_add_f32_dpp v255,v255,v255 row_ror:4 row_mask:0xf bank_mask:0xf
s_nop 1
v_add_f32_dpp v255,v255,v255 row_ror:2 row_mask:0xf bank_mask:0xf
s_nop 1
v_add_f32_dpp v255,v255,v255 row_ror:1 row_mask:0xf bank_mask:0xf
v_mov_b32 v238,v255
s_nop 1
v_permlane16_swap_b32 v255,v238
v_add_f32 v255,v255,v238
v_mov_b32 v238,v255
s_nop 1
v_permlane32_swap_b32 v255,v238
v_add_f32 v255,v255,v238
v_sqrt_f32 v255,v255
v_sub_u32 v238,68,v1
v_cvt_f32_u32 v238,v238
v_log_f32 v238,v238
v_mov_b32 v239,0x3ff9999a
v_fmac_f32 v239,0x3e632166,v238
v_mul_f32 v255,v255,v239
v_or_b32 v255,0x80000000,v255
s_cmp_lt_u32 s54,2
s_cbranch_scc1 L_aa_280
s_sub_u32 s77,s54,2
s_mov_b32 s30,0
s_mov_b32 s86,1536
s_lshl_b32 s56,s77,5
s_add_u32 s56,s56,s68
s_mul_i32 s70,s56,24576
s_lshl_b32 s71,s56,12
s_lshl_b32 s59,s77,13
s_lshl2_add_u32 s59,s68,s59
s_add_u32 s59,s59,10485760
s_buffer_load_dword s32,s[8:11],s59
s_mov_b32 s33,1
s_add_u32 s70,s70,100663296
s_add_u32 s71,s71,41943040
v_mov_b32 v19,s59
s_branch L_aa_288
L_aa_294:
s_bitcmp1_b32 s46,0
s_cbranch_scc1 L_av_295
ds_read_b128 v[24:27],v4 offset:0
ds_read_b128 v[28:31],v4 offset:1024
s_min_u32 s56,s32,s33
s_cmp_lt_u32 s77,64
s_cselect_b32 s56,s56,0
s_cmp_eq_u32 s56,0
s_cselect_b32 s72,0x80000000,0
v_mov_b32 v248,s72
s_or_b32 s64,s70,s72
s_or_b32 s65,s71,s72
s_and_b32 s57,s46,1
s_mul_i32 s58,s57,12288
s_add_u32 s64,s64,s58
s_lshl_b32 s57,s57,11
s_waitcnt lgkmcnt(1)
v_mfma_f32_16x16x32_bf16 v[160:163],v[24:27],a[0:3],0
ds_read_b128 v[32:35],v4 offset:2048
s_add_u32 s65,s65,s57
s_and_b32 s59,s50,2048
v_mfma_f32_16x16x32_bf16 v[164:167],v[24:27],a[4:7],0
ds_read_b128 v[36:39],v4 offset:3072
s_lshl_b32 s59,s59,4
s_xor_b32 s60,s67,65536
v_mfma_f32_16x16x32_bf16 v[168:171],v[24:27],a[8:11],0
ds_read_b128 v[40:43],v4 offset:8192
s_add_u32 s59,s59,s60
s_add_u32 s58,s58,s59
v_mfma_f32_16x16x32_bf16 v[172:175],v[24:27],a[12:15],0
ds_read_b128 v[44:47],v4 offset:9216
s_add_u32 s57,s57,s59
s_add_u32 m0,s58,0
v_mfma_f32_16x16x32_bf16 v[176:179],v[24:27],a[16:19],0
buffer_load_dwordx4 v0,s[8:11],s64 offen offset:0 sc1 lds
v_lshlrev_b32 v88,16,v224
v_and_b32 v89,0xffff0000,v224
v_mfma_f32_16x16x32_bf16 v[180:183],v[24:27],a[20:23],0
ds_read_b128 v[48:51],v4 offset:10240
v_lshlrev_b32 v90,16,v225
v_and_b32 v91,0xffff0000,v225
v_mfma_f32_16x16x32_bf16 v[184:187],v[24:27],a[24:27],0
ds_read_b128 v[52:55],v4 offset:11264
s_waitcnt vmcnt(8)
v_mfma_f32_16x16x32_bf16 v[128:131],v[156:159],v[192:195],0
ds_write_b32 v247,v248
v_lshlrev_b32 v92,16,v226
v_and_b32 v93,0xffff0000,v226
v_mfma_f32_16x16x32_bf16 v[188:191],v[24:27],a[28:31],0
ds_read_b128 v[56:59],v4 offset:4096
s_waitcnt vmcnt(7)
v_mfma_f32_16x16x32_bf16 v[128:131],v[156:159],v[196:199],v[128:131]
ds_read_b128 v[60:63],v4 offset:5120
v_lshlrev_b32 v94,16,v227
v_and_b32 v95,0xffff0000,v227
s_waitcnt lgkmcnt(9)
v_mfma_f32_16x16x32_bf16 v[160:163],v[28:31],a[32:35],v[160:163]
buffer_load_dwordx4 v0,s[8:11],s64 offen offset:1024 sc1 lds
s_waitcnt vmcnt(7)
v_mfma_f32_16x16x32_bf16 v[128:131],v[156:159],v[200:203],v[128:131]
ds_read_b128 v[64:67],v4 offset:6144
v_readfirstlane_b32 s22,v246
s_cmp_eq_u32 s22,0
s_cbranch_scc1 L_ag_296
L_agb_297:
v_mfma_f32_16x16x32_bf16 v[164:167],v[28:31],a[36:39],v[164:167]
ds_read_b128 v[68:71],v4 offset:7168
s_waitcnt vmcnt(6)
v_mfma_f32_16x16x32_bf16 v[128:131],v[156:159],v[204:207],v[128:131]
ds_read_b128 v[72:75],v4 offset:12288
s_lshl_b32 s18,s26,5
s_add_u32 s18,s18,s68
v_mfma_f32_16x16x32_bf16 v[168:171],v[28:31],a[40:43],v[168:171]
ds_read_b128 v[76:79],v4 offset:13312
s_waitcnt vmcnt(5)
v_mfma_f32_16x16x32_bf16 v[132:135],v[156:159],v[208:211],0
ds_read_b128 v[80:83],v4 offset:14336
s_lshl_b32 s19,s18,10
s_add_u32 s20,s19,6291456
v_mfma_f32_16x16x32_bf16 v[172:175],v[28:31],a[44:47],v[172:175]
ds_read_b128 v[84:87],v4 offset:15360
s_waitcnt vmcnt(4)
v_mfma_f32_16x16x32_bf16 v[132:135],v[156:159],v[212:215],v[132:135]
s_lshl_b32 s23,s51,5
s_add_u32 s23,s23,s68
s_lshl_b32 s24,s23,10
v_mfma_f32_16x16x32_bf16 v[176:179],v[28:31],a[48:51],v[176:179]
buffer_load_dwordx4 v0,s[8:11],s64 offen offset:2048 sc1 lds
s_waitcnt vmcnt(4)
v_mfma_f32_16x16x32_bf16 v[132:135],v[156:159],v[216:219],v[132:135]
s_lshl_b32 s25,s51,10
s_add_u32 s25,s25,2883584
s_cmp_eq_u32 s23,s55
s_cselect_b32 s25,s25,s24
v_mfma_f32_16x16x32_bf16 v[180:183],v[28:31],a[52:55],v[180:183]
ds_write_b128 v6,v[128:131]
s_waitcnt vmcnt(3)
v_mfma_f32_16x16x32_bf16 v[132:135],v[156:159],v[220:223],v[132:135]
s_add_u32 s25,s25,8388608
s_mov_b32 s6,268435456
s_cmp_eq_u32 s31,0
s_cselect_b32 s25,s24,s25
s_cselect_b64 s[4:5],s[16:17],s[44:45]
s_cmov_b32 s6,2097152
v_mfma_f32_16x16x32_bf16 v[184:187],v[28:31],a[56:59],v[184:187]
buffer_load_dwordx4 v[224:227],v0,s[4:7],s25 offen sc1
s_lshr_b32 s24,s55,5
s_cmp_lt_u32 s51,s24
s_cselect_b32 s24,1,2
v_mfma_f32_16x16x32_bf16 v[188:191],v[28:31],a[60:63],v[188:191]
v_mov_b32 v252,s24
s_lshl2_add_u32 s25,s51,11018240
s_waitcnt lgkmcnt(15)
v_mfma_f32_16x16x32_bf16 v[160:163],v[32:35],a[64:67],v[160:163]
ds_write_b128 v6,v[132:135] offset:2048
s_lshl_b32 s24,s68,16
s_add_u32 s24,s24,s31
v_mfma_f32_16x16x32_bf16 v[164:167],v[32:35],a[68:71],v[164:167]
buffer_load_dwordx4 v0,s[8:11],s64 offen offset:3072 sc1 lds
s_add_u32 s24,s24,s86
s_cmp_eq_u32 s24,1537
s_cselect_b32 s25,s25,0x80000000
v_mfma_f32_16x16x32_bf16 v[168:171],v[32:35],a[72:75],v[168:171]
buffer_store_dword v252,off,s[8:11],s25 sc1
s_bitcmp1_b64 s[38:39],s51
s_cselect_b32 s24,128,0
v_mfma_f32_16x16x32_bf16 v[172:175],v[32:35],a[76:79],v[172:175]
s_lshl_b32 s23,s51,13
s_lshl2_add_u32 s23,s68,s23
s_add_u32 s23,s23,10487168
v_mfma_f32_16x16x32_bf16 v[176:179],v[32:35],a[80:83],v[176:179]
s_waitcnt lgkmcnt(0)
s_barrier
s_add_u32 s23,s23,s24
v_mfma_f32_16x16x32_bf16 v[180:183],v[32:35],a[84:87],v[180:183]
ds_read_b128 v[96:99],v23
s_add_u32 m0,s58,4096
s_add_u32 s64,s64,4096
v_mfma_f32_16x16x32_bf16 v[184:187],v[32:35],a[88:91],v[184:187]
ds_read_b128 v[100:103],v23 offset:16
v_mfma_f32_16x16x32_bf16 v[188:191],v[32:35],a[92:95],v[188:191]
buffer_load_dwordx4 v0,s[8:11],s64 offen offset:0 sc1 lds
v_mfma_f32_16x16x32_bf16 v[160:163],v[36:39],a[96:99],v[160:163]
ds_read_b128 v[248:251],v245
v_mfma_f32_16x16x32_bf16 v[164:167],v[36:39],a[100:103],v[164:167]
buffer_load_dword v246,off,s[8:11],s23 sc1
v_lshrrev_b32 v244,4,v1
s_sub_u32 s23,s77,8
v_add_u32 v244,s23,v244
v_mfma_f32_16x16x32_bf16 v[168:171],v[36:39],a[104:107],v[168:171]
v_max_i32 v244,0,v244
v_lshl_add_u32 v244,v244,13,v21
v_mfma_f32_16x16x32_bf16 v[172:175],v[36:39],a[108:111],v[172:175]
buffer_load_dwordx4 v0,s[8:11],s64 offen offset:1024 sc1 lds
s_waitcnt lgkmcnt(1)
v_cvt_pk_bf16_f32 v104,v96,v97
v_cvt_pk_bf16_f32 v105,v98,v99
v_mfma_f32_16x16x32_bf16 v[176:179],v[36:39],a[112:115],v[176:179]
buffer_load_dwordx2 v[242:243],v244,s[8:11],0 offen sc1
v_cvt_pk_bf16_f32 v106,v100,v101
v_cvt_pk_bf16_f32 v107,v102,v103
v_lshlrev_b32 v96,16,v104
v_mfma_f32_16x16x32_bf16 v[180:183],v[36:39],a[116:119],v[180:183]
v_and_b32 v97,0xffff0000,v104
v_lshlrev_b32 v98,16,v105
v_mfma_f32_16x16x32_bf16 v[184:187],v[36:39],a[120:123],v[184:187]
s_waitcnt lgkmcnt(0)
v_or3_b32 v248,v248,v249,v250
v_or_b32 v248,v248,v251
v_mfma_f32_16x16x32_bf16 v[188:191],v[36:39],a[124:127],v[188:191]
buffer_load_dwordx4 v0,s[8:11],s64 offen offset:2048 sc1 lds
v_and_b32 v99,0xffff0000,v105
v_lshlrev_b32 v100,16,v106
v_mfma_f32_16x16x32_bf16 v[160:163],v[40:43],a[128:131],v[160:163]
v_readfirstlane_b32 s72,v248
v_and_b32 v101,0xffff0000,v106
v_mfma_f32_16x16x32_bf16 v[164:167],v[40:43],a[132:135],v[164:167]
v_lshlrev_b32 v102,16,v107
v_and_b32 v103,0xffff0000,v107
v_mfma_f32_16x16x32_bf16 v[168:171],v[40:43],a[136:139],v[168:171]
v_add_f32 v88,v88,v96
v_add_f32 v89,v89,v97
v_mfma_f32_16x16x32_bf16 v[172:175],v[40:43],a[140:143],v[172:175]
buffer_load_dwordx4 v0,s[8:11],s64 offen offset:3072 sc1 lds
v_add_f32 v90,v90,v98
v_add_f32 v91,v91,v99
v_mfma_f32_16x16x32_bf16 v[176:179],v[40:43],a[144:147],v[176:179]
v_add_f32 v92,v92,v100
v_add_f32 v93,v93,v101
v_mfma_f32_16x16x32_bf16 v[180:183],v[40:43],a[148:151],v[180:183]
v_add_f32 v94,v94,v102
v_add_f32 v95,v95,v103
v_mfma_f32_16x16x32_bf16 v[184:187],v[40:43],a[152:155],v[184:187]
v_cvt_pk_bf16_f32 v104,v88,v89
v_cvt_pk_bf16_f32 v105,v90,v91
v_mfma_f32_16x16x32_bf16 v[188:191],v[40:43],a[156:159],v[188:191]
s_add_u32 m0,s58,8192
s_add_u32 s64,s64,4096
v_cvt_pk_bf16_f32 v106,v92,v93
v_mfma_f32_16x16x32_bf16 v[160:163],v[44:47],a[160:163],v[160:163]
buffer_load_dwordx4 v0,s[8:11],s64 offen offset:0 sc1 lds
v_cvt_pk_bf16_f32 v107,v94,v95
v_mfma_f32_16x16x32_bf16 v[164:167],v[44:47],a[164:167],v[164:167]
buffer_store_dwordx4 v[104:107],v0,s[8:11],s20 offen sc1
v_lshlrev_b32 v88,16,v104
v_and_b32 v89,0xffff0000,v104
v_lshlrev_b32 v90,16,v105
v_mfma_f32_16x16x32_bf16 v[168:171],v[44:47],a[168:171],v[168:171]
v_and_b32 v91,0xffff0000,v105
v_lshlrev_b32 v92,16,v106
v_and_b32 v93,0xffff0000,v106
v_mfma_f32_16x16x32_bf16 v[172:175],v[44:47],a[172:175],v[172:175]
v_lshlrev_b32 v94,16,v107
v_and_b32 v95,0xffff0000,v107
v_mfma_f32_16x16x32_bf16 v[176:179],v[44:47],a[176:179],v[176:179]
buffer_load_dwordx4 v0,s[8:11],s64 offen offset:1024 sc1 lds
v_readfirstlane_b32 s78,v88
v_mfma_f32_16x16x32_bf16 v[180:183],v[44:47],a[180:183],v[180:183]
s_nop 0
v_add_f32 v120,v88,-s78
v_add_f32 v121,v89,-s78
v_add_f32 v122,v90,-s78
v_mfma_f32_16x16x32_bf16 v[184:187],v[44:47],a[184:187],v[184:187]
v_add_f32 v123,v91,-s78
v_add_f32 v124,v92,-s78
v_mfma_f32_16x16x32_bf16 v[188:191],v[44:47],a[188:191],v[188:191]
v_add_f32 v125,v93,-s78
v_add_f32 v126,v94,-s78
v_mfma_f32_16x16x32_bf16 v[160:163],v[48:51],a[192:195],v[160:163]
buffer_load_dwordx4 v0,s[8:11],s64 offen offset:2048 sc1 lds
v_add_f32 v127,v95,-s78
v_add_f32 v128,v120,v122
v_mfma_f32_16x16x32_bf16 v[164:167],v[48:51],a[196:199],v[164:167]
v_add_f32 v129,v121,v123
v_mul_f32 v130,v120,v120
v_mfma_f32_16x16x32_bf16 v[168:171],v[48:51],a[200:203],v[168:171]
v_mul_f32 v131,v121,v121
v_add_f32 v132,v124,v126
v_mfma_f32_16x16x32_bf16 v[172:175],v[48:51],a[204:207],v[172:175]
v_add_f32 v133,v125,v127
v_fma_f32 v130,v122,v122,v130
v_mfma_f32_16x16x32_bf16 v[176:179],v[48:51],a[208:211],v[176:179]
buffer_load_dwordx4 v0,s[8:11],s64 offen offset:3072 sc1 lds
v_fma_f32 v131,v123,v123,v131
v_add_f32 v128,v128,v132
v_mfma_f32_16x16x32_bf16 v[180:183],v[48:51],a[212:215],v[180:183]
v_add_f32 v129,v129,v133
v_fma_f32 v130,v124,v124,v130
v_mfma_f32_16x16x32_bf16 v[184:187],v[48:51],a[216:219],v[184:187]
v_fma_f32 v131,v125,v125,v131
v_add_f32 v128,v128,v129
v_mfma_f32_16x16x32_bf16 v[188:191],v[48:51],a[220:223],v[188:191]
v_fma_f32 v130,v126,v126,v130
v_fma_f32 v131,v127,v127,v131
v_mfma_f32_16x16x32_bf16 v[160:163],v[52:55],a[224:227],v[160:163]
s_add_u32 m0,s57,24576
v_add_f32 v130,v130,v131
v_mfma_f32_16x16x32_bf16 v[164:167],v[52:55],a[228:231],v[164:167]
buffer_load_dwordx4 v0,s[8:11],s65 offen offset:0 sc1 lds
v_permlane32_swap_b32 v128,v130
v_add_f32 v128,v128,v130
v_mfma_f32_16x16x32_bf16 v[168:171],v[52:55],a[232:235],v[168:171]
s_nop 0
v_add_f32_dpp v128,v128,v128 row_ror:8 row_mask:0xf bank_mask:0xf
v_mfma_f32_16x16x32_bf16 v[172:175],v[52:55],a[236:239],v[172:175]
s_nop 0
v_add_f32_dpp v128,v128,v128 row_ror:4 row_mask:0xf bank_mask:0xf
v_mfma_f32_16x16x32_bf16 v[176:179],v[52:55],a[240:243],v[176:179]
s_nop 0
v_add_f32_dpp v128,v128,v128 row_ror:2 row_mask:0xf bank_mask:0xf
v_mfma_f32_16x16x32_bf16 v[180:183],v[52:55],a[244:247],v[180:183]
buffer_load_dwordx4 v0,s[8:11],s65 offen offset:1024 sc1 lds
v_add_f32_dpp v128,v128,v128 row_ror:1 row_mask:0xf bank_mask:0xf
v_mov_b32 v130,v128
v_mfma_f32_16x16x32_bf16 v[184:187],v[52:55],a[248:251],v[184:187]
s_nop 0
v_permlane16_swap_b32 v128,v130
v_add_f32 v128,v128,v130
v_mul_f32 v128,0x3b000000,v128
v_mfma_f32_16x16x32_bf16 v[188:191],v[52:55],a[252:255],v[188:191]
v_mov_b32 v130,v128
v_mfma_f32_16x16x32_bf16 v[192:195],v[56:59],a[0:3],0
s_nop 0
v_permlane32_swap_b32 v128,v130
v_fma_f32 v130,-v128,v128,v130
v_add_f32 v128,s78,v128
v_mfma_f32_16x16x32_bf16 v[196:199],v[56:59],a[4:7],0
v_max_f32 v130,0,v130
v_cvt_pk_bf16_f32 v130,v128,v130
v_lshlrev_b32 v128,16,v130
v_mfma_f32_16x16x32_bf16 v[200:203],v[56:59],a[8:11],0
v_and_b32 v130,0xffff0000,v130
v_add_f32 v130,0x3727c5ac,v130
v_cvt_pk_bf16_f32 v130,v130,v130
v_mfma_f32_16x16x32_bf16 v[204:207],v[56:59],a[12:15],0
v_and_b32 v130,0xffff0000,v130
v_sqrt_f32 v130,v130
v_add_f32 v120,v88,-v128
v_mfma_f32_16x16x32_bf16 v[208:211],v[56:59],a[16:19],0
v_add_f32 v121,v89,-v128
v_add_f32 v122,v90,-v128
v_mfma_f32_16x16x32_bf16 v[212:215],v[56:59],a[20:23],0
v_add_f32 v123,v91,-v128
v_add_f32 v124,v92,-v128
v_mfma_f32_16x16x32_bf16 v[216:219],v[56:59],a[24:27],0
v_add_f32 v125,v93,-v128
v_add_f32 v126,v94,-v128
v_mfma_f32_16x16x32_bf16 v[220:223],v[56:59],a[28:31],0
v_add_f32 v127,v95,-v128
v_cvt_pk_bf16_f32 v130,v130,v130
v_mfma_f32_16x16x32_bf16 v[192:195],v[60:63],a[32:35],v[192:195]
v_and_b32 v130,0xffff0000,v130
v_rcp_f32 v130,v130
v_mfma_f32_16x16x32_bf16 v[196:199],v[60:63],a[36:39],v[196:199]
v_cvt_pk_bf16_f32 v108,v120,v121
v_cvt_pk_bf16_f32 v109,v122,v123
v_mfma_f32_16x16x32_bf16 v[200:203],v[60:63],a[40:43],v[200:203]
v_cvt_pk_bf16_f32 v110,v124,v125
v_cvt_pk_bf16_f32 v111,v126,v127
v_mfma_f32_16x16x32_bf16 v[204:207],v[60:63],a[44:47],v[204:207]
v_lshlrev_b32 v120,16,v108
v_and_b32 v121,0xffff0000,v108
v_mfma_f32_16x16x32_bf16 v[208:211],v[60:63],a[48:51],v[208:211]
v_lshlrev_b32 v122,16,v109
v_and_b32 v123,0xffff0000,v109
v_mfma_f32_16x16x32_bf16 v[212:215],v[60:63],a[52:55],v[212:215]
v_lshlrev_b32 v124,16,v110
v_and_b32 v125,0xffff0000,v110
v_mfma_f32_16x16x32_bf16 v[216:219],v[60:63],a[56:59],v[216:219]
v_lshlrev_b32 v126,16,v111
v_and_b32 v127,0xffff0000,v111
v_mfma_f32_16x16x32_bf16 v[220:223],v[60:63],a[60:63],v[220:223]
v_mul_f32 v120,v120,v130
v_mul_f32 v121,v121,v130
v_mfma_f32_16x16x32_bf16 v[192:195],v[64:67],a[64:67],v[192:195]
v_mul_f32 v122,v122,v130
v_mul_f32 v123,v123,v130
v_mfma_f32_16x16x32_bf16 v[196:199],v[64:67],a[68:71],v[196:199]
v_mul_f32 v124,v124,v130
v_mul_f32 v125,v125,v130
v_mfma_f32_16x16x32_bf16 v[200:203],v[64:67],a[72:75],v[200:203]
v_mul_f32 v126,v126,v130
v_mul_f32 v127,v127,v130
v_mfma_f32_16x16x32_bf16 v[204:207],v[64:67],a[76:79],v[204:207]
v_cvt_pk_bf16_f32 v108,v120,v121
v_cvt_pk_bf16_f32 v109,v122,v123
v_mfma_f32_16x16x32_bf16 v[208:211],v[64:67],a[80:83],v[208:211]
v_cvt_pk_bf16_f32 v24,v160,v164
v_cvt_pk_bf16_f32 v25,v168,v172
v_mfma_f32_16x16x32_bf16 v[212:215],v[64:67],a[84:87],v[212:215]
v_cvt_pk_bf16_f32 v26,v176,v180
v_cvt_pk_bf16_f32 v27,v184,v188
v_mfma_f32_16x16x32_bf16 v[216:219],v[64:67],a[88:91],v[216:219]
v_cvt_pk_bf16_f32 v28,v161,v165
v_cvt_pk_bf16_f32 v29,v169,v173
v_mfma_f32_16x16x32_bf16 v[220:223],v[64:67],a[92:95],v[220:223]
v_cvt_pk_bf16_f32 v30,v177,v181
v_cvt_pk_bf16_f32 v31,v185,v189
v_mfma_f32_16x16x32_bf16 v[192:195],v[68:71],a[96:99],v[192:195]
v_cvt_pk_bf16_f32 v32,v162,v166
v_cvt_pk_bf16_f32 v33,v170,v174
v_mfma_f32_16x16x32_bf16 v[196:199],v[68:71],a[100:103],v[196:199]
v_cvt_pk_bf16_f32 v34,v178,v182
v_cvt_pk_bf16_f32 v35,v186,v190
v_mfma_f32_16x16x32_bf16 v[200:203],v[68:71],a[104:107],v[200:203]
v_cvt_pk_bf16_f32 v36,v163,v167
v_cvt_pk_bf16_f32 v37,v171,v175
v_mfma_f32_16x16x32_bf16 v[204:207],v[68:71],a[108:111],v[204:207]
v_cvt_pk_bf16_f32 v38,v179,v183
v_cvt_pk_bf16_f32 v39,v187,v191
v_mfma_f32_16x16x32_bf16 v[208:211],v[68:71],a[112:115],v[208:211]
s_add_u32 s62,s69,0
v_cvt_pk_bf16_f32 v110,v124,v125
v_cvt_pk_bf16_f32 v111,v126,v127
v_mfma_f32_16x16x32_bf16 v[212:215],v[68:71],a[116:119],v[212:215]
buffer_store_dwordx4 v[24:27],v5,s[8:11],s62 offen sc1
v_lshlrev_b32 v112,16,v108
v_and_b32 v113,0xffff0000,v108
v_mfma_f32_16x16x32_bf16 v[216:219],v[68:71],a[120:123],v[216:219]
v_lshlrev_b32 v114,16,v109
v_and_b32 v115,0xffff0000,v109
v_mfma_f32_16x16x32_bf16 v[220:223],v[68:71],a[124:127],v[220:223]
v_lshlrev_b32 v116,16,v110
v_and_b32 v117,0xffff0000,v110
v_mfma_f32_16x16x32_bf16 v[192:195],v[72:75],a[128:131],v[192:195]
s_add_u32 s62,s69,16384
v_lshlrev_b32 v118,16,v111
v_and_b32 v119,0xffff0000,v111
v_mfma_f32_16x16x32_bf16 v[196:199],v[72:75],a[132:135],v[196:199]
buffer_store_dwordx4 v[28:31],v5,s[8:11],s62 offen sc1
v_add_f32 v88,v88,v112
v_add_f32 v89,v89,v113
v_mfma_f32_16x16x32_bf16 v[200:203],v[72:75],a[136:139],v[200:203]
v_add_f32 v90,v90,v114
v_add_f32 v91,v91,v115
v_mfma_f32_16x16x32_bf16 v[204:207],v[72:75],a[140:143],v[204:207]
v_add_f32 v92,v92,v116
v_add_f32 v93,v93,v117
v_mfma_f32_16x16x32_bf16 v[208:211],v[72:75],a[144:147],v[208:211]
s_add_u32 s62,s69,32768
v_add_f32 v94,v94,v118
v_add_f32 v95,v95,v119
v_mfma_f32_16x16x32_bf16 v[212:215],v[72:75],a[148:151],v[212:215]
buffer_store_dwordx4 v[32:35],v5,s[8:11],s62 offen sc1
v_cvt_pk_bf16_f32 v96,v88,v89
v_cvt_pk_bf16_f32 v97,v90,v91
v_mfma_f32_16x16x32_bf16 v[216:219],v[72:75],a[152:155],v[216:219]
v_cvt_pk_bf16_f32 v98,v92,v93
v_cvt_pk_bf16_f32 v99,v94,v95
v_mfma_f32_16x16x32_bf16 v[220:223],v[72:75],a[156:159],v[220:223]
buffer_store_dwordx4 v[96:99],v0,s[12:15],s19 offen sc1
v_mul_f32 v236,v112,v228
v_mul_f32 v237,v113,v229
v_mfma_f32_16x16x32_bf16 v[192:195],v[76:79],a[160:163],v[192:195]
s_add_u32 s62,s69,49152
v_fma_f32 v236,v114,v230,v236
v_fma_f32 v237,v115,v231,v237
v_mfma_f32_16x16x32_bf16 v[196:199],v[76:79],a[164:167],v[196:199]
buffer_store_dwordx4 v[36:39],v5,s[8:11],s62 offen sc1
v_fma_f32 v236,v116,v232,v236
v_fma_f32 v237,v117,v233,v237
v_mfma_f32_16x16x32_bf16 v[200:203],v[76:79],a[168:171],v[200:203]
v_fma_f32 v236,v118,v234,v236
v_fma_f32 v237,v119,v235,v237
v_mfma_f32_16x16x32_bf16 v[204:207],v[76:79],a[172:175],v[204:207]
v_add_f32 v236,v236,v237
v_mfma_f32_16x16x32_bf16 v[208:211],v[76:79],a[176:179],v[208:211]
s_nop 0
v_add_f32_dpp v236,v236,v236 row_ror:8 row_mask:0xf bank_mask:0xf
v_mfma_f32_16x16x32_bf16 v[212:215],v[76:79],a[180:183],v[212:215]
s_nop 0
v_add_f32_dpp v236,v236,v236 row_ror:4 row_mask:0xf bank_mask:0xf
v_mfma_f32_16x16x32_bf16 v[216:219],v[76:79],a[184:187],v[216:219]
s_nop 0
v_add_f32_dpp v236,v236,v236 row_ror:2 row_mask:0xf bank_mask:0xf
v_mfma_f32_16x16x32_bf16 v[220:223],v[76:79],a[188:191],v[220:223]
s_nop 0
v_add_f32_dpp v236,v236,v236 row_ror:1 row_mask:0xf bank_mask:0xf
v_mov_b32 v237,v236
v_mfma_f32_16x16x32_bf16 v[192:195],v[80:83],a[192:195],v[192:195]
s_nop 0
v_permlane16_swap_b32 v236,v237
v_add_f32 v236,v236,v237
v_mov_b32 v237,v236
v_mfma_f32_16x16x32_bf16 v[196:199],v[80:83],a[196:199],v[196:199]
s_nop 0
v_permlane32_swap_b32 v236,v237
v_add_f32 v236,v236,v237
v_cvt_pk_bf16_f32 v236,v236,v236
v_mfma_f32_16x16x32_bf16 v[200:203],v[80:83],a[200:203],v[200:203]
v_and_b32 v236,0xffff0000,v236
v_ashrrev_i32 v237,31,v236
v_or_b32 v237,0x80000000,v237
v_mfma_f32_16x16x32_bf16 v[204:207],v[80:83],a[204:207],v[204:207]
v_xor_b32 v236,v236,v237
v_and_b32 v236,0xffff0000,v236
s_sub_u32 s20,4095,s18
v_mfma_f32_16x16x32_bf16 v[208:211],v[80:83],a[208:211],v[208:211]
v_or_b32 v20,s20,v236
s_lshl_b32 s73,s26,13
s_lshl2_add_u32 s73,s68,s73
v_mfma_f32_16x16x32_bf16 v[212:215],v[80:83],a[212:215],v[212:215]
s_add_u32 s73,s73,10485760
s_add_u32 s73,s73,s86
v_mfma_f32_16x16x32_bf16 v[216:219],v[80:83],a[216:219],v[216:219]
v_mfma_f32_16x16x32_bf16 v[220:223],v[80:83],a[220:223],v[220:223]
v_mfma_f32_16x16x32_bf16 v[192:195],v[84:87],a[224:227],v[192:195]
v_mfma_f32_16x16x32_bf16 v[196:199],v[84:87],a[228:231],v[196:199]
v_mfma_f32_16x16x32_bf16 v[200:203],v[84:87],a[232:235],v[200:203]
v_mfma_f32_16x16x32_bf16 v[204:207],v[84:87],a[236:239],v[204:207]
v_mfma_f32_16x16x32_bf16 v[208:211],v[84:87],a[240:243],v[208:211]
v_mfma_f32_16x16x32_bf16 v[212:215],v[84:87],a[244:247],v[212:215]
v_mfma_f32_16x16x32_bf16 v[216:219],v[84:87],a[248:251],v[216:219]
v_mfma_f32_16x16x32_bf16 v[220:223],v[84:87],a[252:255],v[220:223]
v_cvt_pk_bf16_f32 v40,v192,v196
v_cvt_pk_bf16_f32 v41,v200,v204
v_cvt_pk_bf16_f32 v42,v208,v212
s_nop 4
v_cvt_pk_bf16_f32 v43,v216,v220
s_add_u32 s62,s69,262144
buffer_store_dwordx4 v[40:43],v5,s[8:11],s62 offen sc1
v_cvt_pk_bf16_f32 v44,v193,v197
v_cvt_pk_bf16_f32 v45,v201,v205
v_cvt_pk_bf16_f32 v46,v209,v213
v_cvt_pk_bf16_f32 v47,v217,v221
s_add_u32 s62,s69,278528
buffer_store_dwordx4 v[44:47],v5,s[8:11],s62 offen sc1
v_cvt_pk_bf16_f32 v48,v194,v198
v_cvt_pk_bf16_f32 v49,v202,v206
v_cvt_pk_bf16_f32 v50,v210,v214
v_cvt_pk_bf16_f32 v51,v218,v222
s_add_u32 s62,s69,294912
buffer_store_dwordx4 v[48:51],v5,s[8:11],s62 offen sc1
v_cvt_pk_bf16_f32 v52,v195,v199
v_cvt_pk_bf16_f32 v53,v203,v207
v_cvt_pk_bf16_f32 v54,v211,v215
v_cvt_pk_bf16_f32 v55,v219,v223
s_add_u32 s62,s69,311296
buffer_store_dwordx4 v[52:55],v5,s[8:11],s62 offen sc1
s_cmp_lg_u32 s72,0
s_cbranch_scc1 L_aa_283
s_waitcnt vmcnt(9)
s_branch L_aa_293
L_av_295:
ds_read_b128 v[24:27],v4 offset:0
ds_read_b128 v[28:31],v4 offset:1024
s_min_u32 s56,s32,s33
s_cmp_lt_u32 s77,64
s_cselect_b32 s56,s56,0
s_cmp_eq_u32 s56,0
s_cselect_b32 s72,0x80000000,0
v_mov_b32 v248,s72
s_or_b32 s64,s70,s72
s_or_b32 s65,s71,s72
s_and_b32 s57,s46,1
s_mul_i32 s58,s57,12288
s_add_u32 s64,s64,s58
s_lshl_b32 s57,s57,11
s_waitcnt lgkmcnt(1)
v_mfma_f32_16x16x32_bf16 v[160:163],v[24:27],a[0:3],0
ds_read_b128 v[32:35],v4 offset:2048
s_add_u32 s65,s65,s57
s_and_b32 s59,s50,2048
v_mfma_f32_16x16x32_bf16 v[164:167],v[24:27],a[4:7],0
ds_read_b128 v[36:39],v4 offset:3072
s_lshl_b32 s59,s59,4
s_xor_b32 s60,s67,65536
v_mfma_f32_16x16x32_bf16 v[168:171],v[24:27],a[8:11],0
ds_read_b128 v[40:43],v4 offset:8192
s_add_u32 s59,s59,s60
s_add_u32 s58,s58,s59
v_mfma_f32_16x16x32_bf16 v[172:175],v[24:27],a[12:15],0
ds_read_b128 v[44:47],v4 offset:9216
s_add_u32 s57,s57,s59
s_add_u32 m0,s58,0
v_mfma_f32_16x16x32_bf16 v[176:179],v[24:27],a[16:19],0
buffer_load_dwordx4 v0,s[8:11],s64 offen offset:0 sc1 lds
s_lshl_b32 s23,s51,5
s_add_u32 s23,s23,s68
v_mfma_f32_16x16x32_bf16 v[180:183],v[24:27],a[20:23],0
ds_read_b128 v[48:51],v4 offset:10240
s_lshl_b32 s24,s23,10
s_lshl_b32 s25,s51,10
v_mfma_f32_16x16x32_bf16 v[184:187],v[24:27],a[24:27],0
ds_read_b128 v[52:55],v4 offset:11264
s_waitcnt vmcnt(8)
v_mfma_f32_16x16x32_bf16 v[128:131],v[156:159],v[192:195],0
ds_write_b32 v247,v248
s_add_u32 s25,s25,2883584
s_cmp_eq_u32 s23,s55
s_cselect_b32 s25,s25,s24
v_mfma_f32_16x16x32_bf16 v[188:191],v[24:27],a[28:31],0
ds_read_b128 v[56:59],v4 offset:4096
s_waitcnt vmcnt(7)
v_mfma_f32_16x16x32_bf16 v[128:131],v[156:159],v[196:199],v[128:131]
ds_read_b128 v[60:63],v4 offset:5120
s_add_u32 s25,s25,8388608
s_mov_b32 s6,268435456
s_waitcnt lgkmcnt(9)
v_mfma_f32_16x16x32_bf16 v[160:163],v[28:31],a[32:35],v[160:163]
buffer_load_dwordx4 v0,s[8:11],s64 offen offset:1024 sc1 lds
s_waitcnt vmcnt(7)
v_mfma_f32_16x16x32_bf16 v[128:131],v[156:159],v[200:203],v[128:131]
ds_read_b128 v[64:67],v4 offset:6144
s_cmp_eq_u32 s31,0
s_cselect_b32 s25,s24,s25
s_cselect_b64 s[4:5],s[16:17],s[44:45]
s_cmov_b32 s6,2097152
v_mfma_f32_16x16x32_bf16 v[164:167],v[28:31],a[36:39],v[164:167]
ds_read_b128 v[68:71],v4 offset:7168
s_waitcnt vmcnt(6)
v_mfma_f32_16x16x32_bf16 v[128:131],v[156:159],v[204:207],v[128:131]
ds_read_b128 v[72:75],v4 offset:12288
v_mfma_f32_16x16x32_bf16 v[168:171],v[28:31],a[40:43],v[168:171]
ds_read_b128 v[76:79],v4 offset:13312
s_waitcnt vmcnt(5)
v_mfma_f32_16x16x32_bf16 v[132:135],v[156:159],v[208:211],0
ds_read_b128 v[80:83],v4 offset:14336
v_mfma_f32_16x16x32_bf16 v[172:175],v[28:31],a[44:47],v[172:175]
ds_read_b128 v[84:87],v4 offset:15360
s_waitcnt vmcnt(4)
v_mfma_f32_16x16x32_bf16 v[132:135],v[156:159],v[212:215],v[132:135]
buffer_load_dwordx4 v[224:227],v0,s[4:7],s25 offen sc1
s_lshr_b32 s24,s55,5
s_cmp_lt_u32 s51,s24
s_cselect_b32 s24,1,2
v_mfma_f32_16x16x32_bf16 v[176:179],v[28:31],a[48:51],v[176:179]
buffer_load_dwordx4 v0,s[8:11],s64 offen offset:2048 sc1 lds
s_waitcnt vmcnt(5)
v_mfma_f32_16x16x32_bf16 v[132:135],v[156:159],v[216:219],v[132:135]
v_mov_b32 v252,s24
s_lshl2_add_u32 s25,s51,11018240
v_mfma_f32_16x16x32_bf16 v[180:183],v[28:31],a[52:55],v[180:183]
ds_write_b128 v6,v[128:131]
s_waitcnt vmcnt(4)
v_mfma_f32_16x16x32_bf16 v[132:135],v[156:159],v[220:223],v[132:135]
s_lshl_b32 s24,s68,16
s_add_u32 s24,s24,s31
s_add_u32 s24,s24,s86
v_mfma_f32_16x16x32_bf16 v[184:187],v[28:31],a[56:59],v[184:187]
s_cmp_eq_u32 s24,1537
s_cselect_b32 s25,s25,0x80000000
v_mfma_f32_16x16x32_bf16 v[188:191],v[28:31],a[60:63],v[188:191]
buffer_store_dword v252,off,s[8:11],s25 sc1
s_bitcmp1_b64 s[38:39],s51
s_cselect_b32 s24,128,0
s_waitcnt lgkmcnt(15)
v_mfma_f32_16x16x32_bf16 v[160:163],v[32:35],a[64:67],v[160:163]
ds_write_b128 v6,v[132:135] offset:2048
s_lshl_b32 s23,s51,13
s_lshl2_add_u32 s23,s68,s23
v_mfma_f32_16x16x32_bf16 v[164:167],v[32:35],a[68:71],v[164:167]
buffer_load_dwordx4 v0,s[8:11],s64 offen offset:3072 sc1 lds
s_add_u32 s23,s23,10487168
s_add_u32 s23,s23,s24
v_mfma_f32_16x16x32_bf16 v[168:171],v[32:35],a[72:75],v[168:171]
buffer_load_dword v246,off,s[8:11],s23 sc1
v_lshrrev_b32 v244,4,v1
s_sub_u32 s23,s77,8
v_mfma_f32_16x16x32_bf16 v[172:175],v[32:35],a[76:79],v[172:175]
v_add_u32 v244,s23,v244
v_max_i32 v244,0,v244
v_mfma_f32_16x16x32_bf16 v[176:179],v[32:35],a[80:83],v[176:179]
s_waitcnt lgkmcnt(0)
s_barrier
v_lshl_add_u32 v244,v244,13,v21
v_mfma_f32_16x16x32_bf16 v[180:183],v[32:35],a[84:87],v[180:183]
ds_read_b128 v[248:251],v245
s_add_u32 m0,s58,4096
s_add_u32 s64,s64,4096
v_mfma_f32_16x16x32_bf16 v[184:187],v[32:35],a[88:91],v[184:187]
buffer_load_dwordx4 v0,s[8:11],s64 offen offset:0 sc1 lds
v_mfma_f32_16x16x32_bf16 v[188:191],v[32:35],a[92:95],v[188:191]
buffer_load_dwordx2 v[242:243],v244,s[8:11],0 offen sc1
v_mfma_f32_16x16x32_bf16 v[160:163],v[36:39],a[96:99],v[160:163]
v_mfma_f32_16x16x32_bf16 v[164:167],v[36:39],a[100:103],v[164:167]
v_mfma_f32_16x16x32_bf16 v[168:171],v[36:39],a[104:107],v[168:171]
buffer_load_dwordx4 v0,s[8:11],s64 offen offset:1024 sc1 lds
v_mfma_f32_16x16x32_bf16 v[172:175],v[36:39],a[108:111],v[172:175]
v_mfma_f32_16x16x32_bf16 v[176:179],v[36:39],a[112:115],v[176:179]
s_waitcnt lgkmcnt(0)
v_or3_b32 v248,v248,v249,v250
v_or_b32 v248,v248,v251
v_mfma_f32_16x16x32_bf16 v[180:183],v[36:39],a[116:119],v[180:183]
v_mfma_f32_16x16x32_bf16 v[184:187],v[36:39],a[120:123],v[184:187]
buffer_load_dwordx4 v0,s[8:11],s64 offen offset:2048 sc1 lds
v_readfirstlane_b32 s72,v248
v_mfma_f32_16x16x32_bf16 v[188:191],v[36:39],a[124:127],v[188:191]
v_mfma_f32_16x16x32_bf16 v[160:163],v[40:43],a[128:131],v[160:163]
v_mfma_f32_16x16x32_bf16 v[164:167],v[40:43],a[132:135],v[164:167]
v_mfma_f32_16x16x32_bf16 v[168:171],v[40:43],a[136:139],v[168:171]
buffer_load_dwordx4 v0,s[8:11],s64 offen offset:3072 sc1 lds
v_mfma_f32_16x16x32_bf16 v[172:175],v[40:43],a[140:143],v[172:175]
v_mfma_f32_16x16x32_bf16 v[176:179],v[40:43],a[144:147],v[176:179]
v_mfma_f32_16x16x32_bf16 v[180:183],v[40:43],a[148:151],v[180:183]
v_mfma_f32_16x16x32_bf16 v[184:187],v[40:43],a[152:155],v[184:187]
s_add_u32 m0,s58,8192
s_add_u32 s64,s64,4096
v_mfma_f32_16x16x32_bf16 v[188:191],v[40:43],a[156:159],v[188:191]
buffer_load_dwordx4 v0,s[8:11],s64 offen offset:0 sc1 lds
v_mfma_f32_16x16x32_bf16 v[160:163],v[44:47],a[160:163],v[160:163]
v_mfma_f32_16x16x32_bf16 v[164:167],v[44:47],a[164:167],v[164:167]
v_mfma_f32_16x16x32_bf16 v[168:171],v[44:47],a[168:171],v[168:171]
v_mfma_f32_16x16x32_bf16 v[172:175],v[44:47],a[172:175],v[172:175]
buffer_load_dwordx4 v0,s[8:11],s64 offen offset:1024 sc1 lds
v_mfma_f32_16x16x32_bf16 v[176:179],v[44:47],a[176:179],v[176:179]
v_mfma_f32_16x16x32_bf16 v[180:183],v[44:47],a[180:183],v[180:183]
v_mfma_f32_16x16x32_bf16 v[184:187],v[44:47],a[184:187],v[184:187]
v_mfma_f32_16x16x32_bf16 v[188:191],v[44:47],a[188:191],v[188:191]
buffer_load_dwordx4 v0,s[8:11],s64 offen offset:2048 sc1 lds
v_mfma_f32_16x16x32_bf16 v[160:163],v[48:51],a[192:195],v[160:163]
v_mfma_f32_16x16x32_bf16 v[164:167],v[48:51],a[196:199],v[164:167]
v_mfma_f32_16x16x32_bf16 v[168:171],v[48:51],a[200:203],v[168:171]
v_mfma_f32_16x16x32_bf16 v[172:175],v[48:51],a[204:207],v[172:175]
buffer_load_dwordx4 v0,s[8:11],s64 offen offset:3072 sc1 lds
v_mfma_f32_16x16x32_bf16 v[176:179],v[48:51],a[208:211],v[176:179]
v_mfma_f32_16x16x32_bf16 v[180:183],v[48:51],a[212:215],v[180:183]
v_mfma_f32_16x16x32_bf16 v[184:187],v[48:51],a[216:219],v[184:187]
v_mfma_f32_16x16x32_bf16 v[188:191],v[48:51],a[220:223],v[188:191]
s_add_u32 m0,s57,24576
v_mfma_f32_16x16x32_bf16 v[160:163],v[52:55],a[224:227],v[160:163]
buffer_load_dwordx4 v0,s[8:11],s65 offen offset:0 sc1 lds
v_mfma_f32_16x16x32_bf16 v[164:167],v[52:55],a[228:231],v[164:167]
v_mfma_f32_16x16x32_bf16 v[168:171],v[52:55],a[232:235],v[168:171]
v_mfma_f32_16x16x32_bf16 v[172:175],v[52:55],a[236:239],v[172:175]
v_mfma_f32_16x16x32_bf16 v[176:179],v[52:55],a[240:243],v[176:179]
buffer_load_dwordx4 v0,s[8:11],s65 offen offset:1024 sc1 lds
v_mfma_f32_16x16x32_bf16 v[180:183],v[52:55],a[244:247],v[180:183]
v_mfma_f32_16x16x32_bf16 v[184:187],v[52:55],a[248:251],v[184:187]
v_mfma_f32_16x16x32_bf16 v[188:191],v[52:55],a[252:255],v[188:191]
v_mfma_f32_16x16x32_bf16 v[192:195],v[56:59],a[0:3],0
v_mfma_f32_16x16x32_bf16 v[196:199],v[56:59],a[4:7],0
v_mfma_f32_16x16x32_bf16 v[200:203],v[56:59],a[8:11],0
v_cvt_pk_bf16_f32 v24,v160,v164
v_cvt_pk_bf16_f32 v25,v168,v172
v_mfma_f32_16x16x32_bf16 v[204:207],v[56:59],a[12:15],0
v_cvt_pk_bf16_f32 v26,v176,v180
v_cvt_pk_bf16_f32 v27,v184,v188
v_mfma_f32_16x16x32_bf16 v[208:211],v[56:59],a[16:19],0
v_cvt_pk_bf16_f32 v28,v161,v165
v_cvt_pk_bf16_f32 v29,v169,v173
v_mfma_f32_16x16x32_bf16 v[212:215],v[56:59],a[20:23],0
v_cvt_pk_bf16_f32 v30,v177,v181
v_cvt_pk_bf16_f32 v31,v185,v189
v_mfma_f32_16x16x32_bf16 v[216:219],v[56:59],a[24:27],0
v_cvt_pk_bf16_f32 v32,v162,v166
v_cvt_pk_bf16_f32 v33,v170,v174
v_mfma_f32_16x16x32_bf16 v[220:223],v[56:59],a[28:31],0
v_cvt_pk_bf16_f32 v34,v178,v182
v_cvt_pk_bf16_f32 v35,v186,v190
v_mfma_f32_16x16x32_bf16 v[192:195],v[60:63],a[32:35],v[192:195]
v_cvt_pk_bf16_f32 v36,v163,v167
v_cvt_pk_bf16_f32 v37,v171,v175
v_mfma_f32_16x16x32_bf16 v[196:199],v[60:63],a[36:39],v[196:199]
v_cvt_pk_bf16_f32 v38,v179,v183
v_cvt_pk_bf16_f32 v39,v187,v191
v_mfma_f32_16x16x32_bf16 v[200:203],v[60:63],a[40:43],v[200:203]
v_mfma_f32_16x16x32_bf16 v[204:207],v[60:63],a[44:47],v[204:207]
v_mfma_f32_16x16x32_bf16 v[208:211],v[60:63],a[48:51],v[208:211]
v_mfma_f32_16x16x32_bf16 v[212:215],v[60:63],a[52:55],v[212:215]
v_mfma_f32_16x16x32_bf16 v[216:219],v[60:63],a[56:59],v[216:219]
v_mfma_f32_16x16x32_bf16 v[220:223],v[60:63],a[60:63],v[220:223]
v_mfma_f32_16x16x32_bf16 v[192:195],v[64:67],a[64:67],v[192:195]
v_mfma_f32_16x16x32_bf16 v[196:199],v[64:67],a[68:71],v[196:199]
v_mfma_f32_16x16x32_bf16 v[200:203],v[64:67],a[72:75],v[200:203]
v_mfma_f32_16x16x32_bf16 v[204:207],v[64:67],a[76:79],v[204:207]
v_mfma_f32_16x16x32_bf16 v[208:211],v[64:67],a[80:83],v[208:211]
v_mfma_f32_16x16x32_bf16 v[212:215],v[64:67],a[84:87],v[212:215]
v_mfma_f32_16x16x32_bf16 v[216:219],v[64:67],a[88:91],v[216:219]
v_mfma_f32_16x16x32_bf16 v[220:223],v[64:67],a[92:95],v[220:223]
v_mfma_f32_16x16x32_bf16 v[192:195],v[68:71],a[96:99],v[192:195]
v_mfma_f32_16x16x32_bf16 v[196:199],v[68:71],a[100:103],v[196:199]
v_mfma_f32_16x16x32_bf16 v[200:203],v[68:71],a[104:107],v[200:203]
v_mfma_f32_16x16x32_bf16 v[204:207],v[68:71],a[108:111],v[204:207]
v_mfma_f32_16x16x32_bf16 v[208:211],v[68:71],a[112:115],v[208:211]
s_add_u32 s62,s69,0
v_mfma_f32_16x16x32_bf16 v[212:215],v[68:71],a[116:119],v[212:215]
buffer_store_dwordx4 v[24:27],v5,s[8:11],s62 offen sc1
v_mfma_f32_16x16x32_bf16 v[216:219],v[68:71],a[120:123],v[216:219]
v_mfma_f32_16x16x32_bf16 v[220:223],v[68:71],a[124:127],v[220:223]
v_mfma_f32_16x16x32_bf16 v[192:195],v[72:75],a[128:131],v[192:195]
s_add_u32 s62,s69,16384
v_mfma_f32_16x16x32_bf16 v[196:199],v[72:75],a[132:135],v[196:199]
buffer_store_dwordx4 v[28:31],v5,s[8:11],s62 offen sc1
v_mfma_f32_16x16x32_bf16 v[200:203],v[72:75],a[136:139],v[200:203]
v_mfma_f32_16x16x32_bf16 v[204:207],v[72:75],a[140:143],v[204:207]
v_mfma_f32_16x16x32_bf16 v[208:211],v[72:75],a[144:147],v[208:211]
s_add_u32 s62,s69,32768
v_mfma_f32_16x16x32_bf16 v[212:215],v[72:75],a[148:151],v[212:215]
buffer_store_dwordx4 v[32:35],v5,s[8:11],s62 offen sc1
v_mfma_f32_16x16x32_bf16 v[216:219],v[72:75],a[152:155],v[216:219]
v_mfma_f32_16x16x32_bf16 v[220:223],v[72:75],a[156:159],v[220:223]
v_mfma_f32_16x16x32_bf16 v[192:195],v[76:79],a[160:163],v[192:195]
s_add_u32 s62,s69,49152
v_mfma_f32_16x16x32_bf16 v[196:199],v[76:79],a[164:167],v[196:199]
buffer_store_dwordx4 v[36:39],v5,s[8:11],s62 offen sc1
v_mfma_f32_16x16x32_bf16 v[200:203],v[76:79],a[168:171],v[200:203]
v_mfma_f32_16x16x32_bf16 v[204:207],v[76:79],a[172:175],v[204:207]
v_mfma_f32_16x16x32_bf16 v[208:211],v[76:79],a[176:179],v[208:211]
v_mfma_f32_16x16x32_bf16 v[212:215],v[76:79],a[180:183],v[212:215]
v_mfma_f32_16x16x32_bf16 v[216:219],v[76:79],a[184:187],v[216:219]
v_mfma_f32_16x16x32_bf16 v[220:223],v[76:79],a[188:191],v[220:223]
v_mfma_f32_16x16x32_bf16 v[192:195],v[80:83],a[192:195],v[192:195]
v_mfma_f32_16x16x32_bf16 v[196:199],v[80:83],a[196:199],v[196:199]
v_mfma_f32_16x16x32_bf16 v[200:203],v[80:83],a[200:203],v[200:203]
v_mfma_f32_16x16x32_bf16 v[204:207],v[80:83],a[204:207],v[204:207]
v_mfma_f32_16x16x32_bf16 v[208:211],v[80:83],a[208:211],v[208:211]
v_mfma_f32_16x16x32_bf16 v[212:215],v[80:83],a[212:215],v[212:215]
v_mfma_f32_16x16x32_bf16 v[216:219],v[80:83],a[216:219],v[216:219]
v_mfma_f32_16x16x32_bf16 v[220:223],v[80:83],a[220:223],v[220:223]
v_mfma_f32_16x16x32_bf16 v[192:195],v[84:87],a[224:227],v[192:195]
v_mfma_f32_16x16x32_bf16 v[196:199],v[84:87],a[228:231],v[196:199]
v_mfma_f32_16x16x32_bf16 v[200:203],v[84:87],a[232:235],v[200:203]
v_mfma_f32_16x16x32_bf16 v[204:207],v[84:87],a[236:239],v[204:207]
v_mfma_f32_16x16x32_bf16 v[208:211],v[84:87],a[240:243],v[208:211]
v_mfma_f32_16x16x32_bf16 v[212:215],v[84:87],a[244:247],v[212:215]
v_mfma_f32_16x16x32_bf16 v[216:219],v[84:87],a[248:251],v[216:219]
v_mfma_f32_16x16x32_bf16 v[220:223],v[84:87],a[252:255],v[220:223]
v_cvt_pk_bf16_f32 v40,v192,v196
v_cvt_pk_bf16_f32 v41,v200,v204
v_cvt_pk_bf16_f32 v42,v208,v212
s_nop 4
v_cvt_pk_bf16_f32 v43,v216,v220
s_add_u32 s62,s69,262144
buffer_store_dwordx4 v[40:43],v5,s[8:11],s62 offen sc1
v_cvt_pk_bf16_f32 v44,v193,v197
v_cvt_pk_bf16_f32 v45,v201,v205
v_cvt_pk_bf16_f32 v46,v209,v213
v_cvt_pk_bf16_f32 v47,v217,v221
s_add_u32 s62,s69,278528
buffer_store_dwordx4 v[44:47],v5,s[8:11],s62 offen sc1
v_cvt_pk_bf16_f32 v48,v194,v198
v_cvt_pk_bf16_f32 v49,v202,v206
v_cvt_pk_bf16_f32 v50,v210,v214
v_cvt_pk_bf16_f32 v51,v218,v222
s_add_u32 s62,s69,294912
buffer_store_dwordx4 v[48:51],v5,s[8:11],s62 offen sc1
v_cvt_pk_bf16_f32 v52,v195,v199
v_cvt_pk_bf16_f32 v53,v203,v207
v_cvt_pk_bf16_f32 v54,v211,v215
v_cvt_pk_bf16_f32 v55,v219,v223
s_add_u32 s62,s69,311296
buffer_store_dwordx4 v[52:55],v5,s[8:11],s62 offen sc1
s_cmp_lg_u32 s72,0
s_cbranch_scc1 L_aa_283
s_waitcnt vmcnt(8)
s_branch L_aa_293
L_aa_281:
ds_read_b128 v[24:27],v4 offset:0
ds_read_b128 v[28:31],v4 offset:1024
s_min_u32 s56,s32,s33
s_cmp_lt_u32 s77,64
s_cselect_b32 s56,s56,0
s_cmp_eq_u32 s56,0
s_cselect_b32 s72,0x80000000,0
v_mov_b32 v248,s72
s_or_b32 s64,s70,s72
s_or_b32 s65,s71,s72
s_and_b32 s57,s46,1
s_mul_i32 s58,s57,12288
s_add_u32 s64,s64,s58
s_lshl_b32 s57,s57,11
s_waitcnt lgkmcnt(1)
v_mfma_f32_16x16x32_bf16 v[160:163],v[24:27],a[0:3],0
ds_read_b128 v[32:35],v4 offset:2048
s_add_u32 s65,s65,s57
s_and_b32 s59,s50,2048
v_mfma_f32_16x16x32_bf16 v[164:167],v[24:27],a[4:7],0
ds_read_b128 v[36:39],v4 offset:3072
s_lshl_b32 s59,s59,4
s_xor_b32 s60,s67,65536
v_mfma_f32_16x16x32_bf16 v[168:171],v[24:27],a[8:11],0
ds_read_b128 v[40:43],v4 offset:8192
s_add_u32 s59,s59,s60
s_add_u32 s58,s58,s59
v_mfma_f32_16x16x32_bf16 v[172:175],v[24:27],a[12:15],0
ds_read_b128 v[44:47],v4 offset:9216
s_add_u32 s57,s57,s59
s_add_u32 m0,s58,0
v_mfma_f32_16x16x32_bf16 v[176:179],v[24:27],a[16:19],0
buffer_load_dwordx4 v0,s[8:11],s64 offen offset:0 sc1 lds
s_lshl_b32 s23,s51,5
s_add_u32 s23,s23,s68
v_mfma_f32_16x16x32_bf16 v[180:183],v[24:27],a[20:23],0
ds_read_b128 v[48:51],v4 offset:10240
s_lshl_b32 s24,s23,10
s_lshl_b32 s25,s51,10
v_mfma_f32_16x16x32_bf16 v[184:187],v[24:27],a[24:27],0
ds_read_b128 v[52:55],v4 offset:11264
s_add_u32 s25,s25,2883584
s_cmp_eq_u32 s23,s55
s_cselect_b32 s25,s25,s24
v_mfma_f32_16x16x32_bf16 v[188:191],v[24:27],a[28:31],0
ds_write_b32 v247,v248
s_add_u32 s25,s25,8388608
s_mov_b32 s6,268435456
s_waitcnt lgkmcnt(7)
v_mfma_f32_16x16x32_bf16 v[160:163],v[28:31],a[32:35],v[160:163]
buffer_load_dwordx4 v0,s[8:11],s64 offen offset:1024 sc1 lds
s_cmp_eq_u32 s31,0
s_cselect_b32 s25,s24,s25
s_cselect_b64 s[4:5],s[16:17],s[44:45]
s_cmov_b32 s6,2097152
v_mfma_f32_16x16x32_bf16 v[164:167],v[28:31],a[36:39],v[164:167]
ds_read_b128 v[56:59],v4 offset:4096
v_mfma_f32_16x16x32_bf16 v[168:171],v[28:31],a[40:43],v[168:171]
ds_read_b128 v[60:63],v4 offset:5120
v_mfma_f32_16x16x32_bf16 v[172:175],v[28:31],a[44:47],v[172:175]
ds_read_b128 v[64:67],v4 offset:6144
v_mfma_f32_16x16x32_bf16 v[176:179],v[28:31],a[48:51],v[176:179]
buffer_load_dwordx4 v0,s[8:11],s64 offen offset:2048 sc1 lds
v_mfma_f32_16x16x32_bf16 v[180:183],v[28:31],a[52:55],v[180:183]
ds_read_b128 v[68:71],v4 offset:7168
v_mfma_f32_16x16x32_bf16 v[184:187],v[28:31],a[56:59],v[184:187]
ds_read_b128 v[72:75],v4 offset:12288
v_mfma_f32_16x16x32_bf16 v[188:191],v[28:31],a[60:63],v[188:191]
ds_read_b128 v[76:79],v4 offset:13312
s_waitcnt lgkmcnt(12)
v_mfma_f32_16x16x32_bf16 v[160:163],v[32:35],a[64:67],v[160:163]
buffer_load_dwordx4 v0,s[8:11],s64 offen offset:3072 sc1 lds
v_mfma_f32_16x16x32_bf16 v[164:167],v[32:35],a[68:71],v[164:167]
ds_read_b128 v[80:83],v4 offset:14336
v_mfma_f32_16x16x32_bf16 v[168:171],v[32:35],a[72:75],v[168:171]
ds_read_b128 v[84:87],v4 offset:15360
v_mfma_f32_16x16x32_bf16 v[172:175],v[32:35],a[76:79],v[172:175]
buffer_load_dwordx4 v[224:227],v0,s[4:7],s25 offen sc1
s_lshr_b32 s24,s55,5
s_cmp_lt_u32 s51,s24
s_cselect_b32 s24,1,2
v_mfma_f32_16x16x32_bf16 v[176:179],v[32:35],a[80:83],v[176:179]
s_add_u32 m0,s58,4096
s_add_u32 s64,s64,4096
v_mov_b32 v252,s24
v_mfma_f32_16x16x32_bf16 v[180:183],v[32:35],a[84:87],v[180:183]
buffer_load_dwordx4 v0,s[8:11],s64 offen offset:0 sc1 lds
s_lshl2_add_u32 s25,s51,11018240
s_lshl_b32 s24,s68,16
v_mfma_f32_16x16x32_bf16 v[184:187],v[32:35],a[88:91],v[184:187]
s_add_u32 s24,s24,s31
s_add_u32 s24,s24,s86
s_cmp_eq_u32 s24,1537
s_cselect_b32 s25,s25,0x80000000
v_mfma_f32_16x16x32_bf16 v[188:191],v[32:35],a[92:95],v[188:191]
buffer_store_dword v252,off,s[8:11],s25 sc1
s_waitcnt lgkmcnt(0)
s_barrier
s_waitcnt lgkmcnt(13)
v_mfma_f32_16x16x32_bf16 v[160:163],v[36:39],a[96:99],v[160:163]
ds_read_b128 v[248:251],v245
s_bitcmp1_b64 s[38:39],s51
s_cselect_b32 s24,128,0
v_mfma_f32_16x16x32_bf16 v[164:167],v[36:39],a[100:103],v[164:167]
buffer_load_dwordx4 v0,s[8:11],s64 offen offset:1024 sc1 lds
s_lshl_b32 s23,s51,13
s_lshl2_add_u32 s23,s68,s23
v_mfma_f32_16x16x32_bf16 v[168:171],v[36:39],a[104:107],v[168:171]
s_add_u32 s23,s23,10487168
s_add_u32 s23,s23,s24
v_mfma_f32_16x16x32_bf16 v[172:175],v[36:39],a[108:111],v[172:175]
buffer_load_dword v246,off,s[8:11],s23 sc1
v_lshrrev_b32 v244,4,v1
s_sub_u32 s23,s77,8
v_mfma_f32_16x16x32_bf16 v[176:179],v[36:39],a[112:115],v[176:179]
v_add_u32 v244,s23,v244
v_max_i32 v244,0,v244
v_mfma_f32_16x16x32_bf16 v[180:183],v[36:39],a[116:119],v[180:183]
buffer_load_dwordx4 v0,s[8:11],s64 offen offset:2048 sc1 lds
v_lshl_add_u32 v244,v244,13,v21
v_mfma_f32_16x16x32_bf16 v[184:187],v[36:39],a[120:123],v[184:187]
buffer_load_dwordx2 v[242:243],v244,s[8:11],0 offen sc1
s_waitcnt lgkmcnt(0)
v_or3_b32 v248,v248,v249,v250
v_mfma_f32_16x16x32_bf16 v[188:191],v[36:39],a[124:127],v[188:191]
v_or_b32 v248,v248,v251
v_mfma_f32_16x16x32_bf16 v[160:163],v[40:43],a[128:131],v[160:163]
v_readfirstlane_b32 s72,v248
v_mfma_f32_16x16x32_bf16 v[164:167],v[40:43],a[132:135],v[164:167]
buffer_load_dwordx4 v0,s[8:11],s64 offen offset:3072 sc1 lds
v_mfma_f32_16x16x32_bf16 v[168:171],v[40:43],a[136:139],v[168:171]
v_mfma_f32_16x16x32_bf16 v[172:175],v[40:43],a[140:143],v[172:175]
v_mfma_f32_16x16x32_bf16 v[176:179],v[40:43],a[144:147],v[176:179]
s_waitcnt vmcnt(12)
v_mfma_f32_16x16x32_bf16 v[180:183],v[40:43],a[148:151],v[180:183]
buffer_store_dword v20,off,s[8:11],s73 sc1
s_add_u32 m0,s58,8192
s_add_u32 s64,s64,4096
v_mfma_f32_16x16x32_bf16 v[184:187],v[40:43],a[152:155],v[184:187]
buffer_load_dwordx4 v0,s[8:11],s64 offen offset:0 sc1 lds
s_mov_b32 s73,0x80000000
v_mfma_f32_16x16x32_bf16 v[188:191],v[40:43],a[156:159],v[188:191]
v_mfma_f32_16x16x32_bf16 v[160:163],v[44:47],a[160:163],v[160:163]
v_mfma_f32_16x16x32_bf16 v[164:167],v[44:47],a[164:167],v[164:167]
v_mfma_f32_16x16x32_bf16 v[168:171],v[44:47],a[168:171],v[168:171]
buffer_load_dwordx4 v0,s[8:11],s64 offen offset:1024 sc1 lds
v_mfma_f32_16x16x32_bf16 v[172:175],v[44:47],a[172:175],v[172:175]
v_mfma_f32_16x16x32_bf16 v[176:179],v[44:47],a[176:179],v[176:179]
v_mfma_f32_16x16x32_bf16 v[180:183],v[44:47],a[180:183],v[180:183]
v_mfma_f32_16x16x32_bf16 v[184:187],v[44:47],a[184:187],v[184:187]
buffer_load_dwordx4 v0,s[8:11],s64 offen offset:2048 sc1 lds
v_mfma_f32_16x16x32_bf16 v[188:191],v[44:47],a[188:191],v[188:191]
v_mfma_f32_16x16x32_bf16 v[160:163],v[48:51],a[192:195],v[160:163]
v_mfma_f32_16x16x32_bf16 v[164:167],v[48:51],a[196:199],v[164:167]
v_mfma_f32_16x16x32_bf16 v[168:171],v[48:51],a[200:203],v[168:171]
buffer_load_dwordx4 v0,s[8:11],s64 offen offset:3072 sc1 lds
v_mfma_f32_16x16x32_bf16 v[172:175],v[48:51],a[204:207],v[172:175]
v_mfma_f32_16x16x32_bf16 v[176:179],v[48:51],a[208:211],v[176:179]
v_mfma_f32_16x16x32_bf16 v[180:183],v[48:51],a[212:215],v[180:183]
v_mfma_f32_16x16x32_bf16 v[184:187],v[48:51],a[216:219],v[184:187]
s_add_u32 m0,s57,24576
v_mfma_f32_16x16x32_bf16 v[188:191],v[48:51],a[220:223],v[188:191]
buffer_load_dwordx4 v0,s[8:11],s65 offen offset:0 sc1 lds
v_mfma_f32_16x16x32_bf16 v[160:163],v[52:55],a[224:227],v[160:163]
v_mfma_f32_16x16x32_bf16 v[164:167],v[52:55],a[228:231],v[164:167]
v_mfma_f32_16x16x32_bf16 v[168:171],v[52:55],a[232:235],v[168:171]
v_mfma_f32_16x16x32_bf16 v[172:175],v[52:55],a[236:239],v[172:175]
buffer_load_dwordx4 v0,s[8:11],s65 offen offset:1024 sc1 lds
v_mfma_f32_16x16x32_bf16 v[176:179],v[52:55],a[240:243],v[176:179]
v_mfma_f32_16x16x32_bf16 v[180:183],v[52:55],a[244:247],v[180:183]
v_mfma_f32_16x16x32_bf16 v[184:187],v[52:55],a[248:251],v[184:187]
v_mfma_f32_16x16x32_bf16 v[188:191],v[52:55],a[252:255],v[188:191]
v_mfma_f32_16x16x32_bf16 v[192:195],v[56:59],a[0:3],0
v_mfma_f32_16x16x32_bf16 v[196:199],v[56:59],a[4:7],0
v_mfma_f32_16x16x32_bf16 v[200:203],v[56:59],a[8:11],0
v_cvt_pk_bf16_f32 v24,v160,v164
v_cvt_pk_bf16_f32 v25,v168,v172
v_mfma_f32_16x16x32_bf16 v[204:207],v[56:59],a[12:15],0
v_cvt_pk_bf16_f32 v26,v176,v180
v_cvt_pk_bf16_f32 v27,v184,v188
v_mfma_f32_16x16x32_bf16 v[208:211],v[56:59],a[16:19],0
v_cvt_pk_bf16_f32 v28,v161,v165
v_cvt_pk_bf16_f32 v29,v169,v173
v_mfma_f32_16x16x32_bf16 v[212:215],v[56:59],a[20:23],0
v_cvt_pk_bf16_f32 v30,v177,v181
v_cvt_pk_bf16_f32 v31,v185,v189
v_mfma_f32_16x16x32_bf16 v[216:219],v[56:59],a[24:27],0
v_cvt_pk_bf16_f32 v32,v162,v166
v_cvt_pk_bf16_f32 v33,v170,v174
v_mfma_f32_16x16x32_bf16 v[220:223],v[56:59],a[28:31],0
v_cvt_pk_bf16_f32 v34,v178,v182
v_cvt_pk_bf16_f32 v35,v186,v190
v_mfma_f32_16x16x32_bf16 v[192:195],v[60:63],a[32:35],v[192:195]
v_cvt_pk_bf16_f32 v36,v163,v167
v_cvt_pk_bf16_f32 v37,v171,v175
v_mfma_f32_16x16x32_bf16 v[196:199],v[60:63],a[36:39],v[196:199]
v_cvt_pk_bf16_f32 v38,v179,v183
v_cvt_pk_bf16_f32 v39,v187,v191
v_mfma_f32_16x16x32_bf16 v[200:203],v[60:63],a[40:43],v[200:203]
v_mfma_f32_16x16x32_bf16 v[204:207],v[60:63],a[44:47],v[204:207]
v_mfma_f32_16x16x32_bf16 v[208:211],v[60:63],a[48:51],v[208:211]
v_mfma_f32_16x16x32_bf16 v[212:215],v[60:63],a[52:55],v[212:215]
v_mfma_f32_16x16x32_bf16 v[216:219],v[60:63],a[56:59],v[216:219]
v_mfma_f32_16x16x32_bf16 v[220:223],v[60:63],a[60:63],v[220:223]
v_mfma_f32_16x16x32_bf16 v[192:195],v[64:67],a[64:67],v[192:195]
v_mfma_f32_16x16x32_bf16 v[196:199],v[64:67],a[68:71],v[196:199]
v_mfma_f32_16x16x32_bf16 v[200:203],v[64:67],a[72:75],v[200:203]
v_mfma_f32_16x16x32_bf16 v[204:207],v[64:67],a[76:79],v[204:207]
v_mfma_f32_16x16x32_bf16 v[208:211],v[64:67],a[80:83],v[208:211]
v_mfma_f32_16x16x32_bf16 v[212:215],v[64:67],a[84:87],v[212:215]
v_mfma_f32_16x16x32_bf16 v[216:219],v[64:67],a[88:91],v[216:219]
v_mfma_f32_16x16x32_bf16 v[220:223],v[64:67],a[92:95],v[220:223]
v_mfma_f32_16x16x32_bf16 v[192:195],v[68:71],a[96:99],v[192:195]
v_mfma_f32_16x16x32_bf16 v[196:199],v[68:71],a[100:103],v[196:199]
v_mfma_f32_16x16x32_bf16 v[200:203],v[68:71],a[104:107],v[200:203]
v_mfma_f32_16x16x32_bf16 v[204:207],v[68:71],a[108:111],v[204:207]
v_mfma_f32_16x16x32_bf16 v[208:211],v[68:71],a[112:115],v[208:211]
s_add_u32 s62,s69,0
v_mfma_f32_16x16x32_bf16 v[212:215],v[68:71],a[116:119],v[212:215]
buffer_store_dwordx4 v[24:27],v5,s[8:11],s62 offen sc1
v_mfma_f32_16x16x32_bf16 v[216:219],v[68:71],a[120:123],v[216:219]
v_mfma_f32_16x16x32_bf16 v[220:223],v[68:71],a[124:127],v[220:223]
v_mfma_f32_16x16x32_bf16 v[192:195],v[72:75],a[128:131],v[192:195]
s_add_u32 s62,s69,16384
v_mfma_f32_16x16x32_bf16 v[196:199],v[72:75],a[132:135],v[196:199]
buffer_store_dwordx4 v[28:31],v5,s[8:11],s62 offen sc1
v_mfma_f32_16x16x32_bf16 v[200:203],v[72:75],a[136:139],v[200:203]
v_mfma_f32_16x16x32_bf16 v[204:207],v[72:75],a[140:143],v[204:207]
v_mfma_f32_16x16x32_bf16 v[208:211],v[72:75],a[144:147],v[208:211]
s_add_u32 s62,s69,32768
v_mfma_f32_16x16x32_bf16 v[212:215],v[72:75],a[148:151],v[212:215]
buffer_store_dwordx4 v[32:35],v5,s[8:11],s62 offen sc1
v_mfma_f32_16x16x32_bf16 v[216:219],v[72:75],a[152:155],v[216:219]
v_mfma_f32_16x16x32_bf16 v[220:223],v[72:75],a[156:159],v[220:223]
v_mfma_f32_16x16x32_bf16 v[192:195],v[76:79],a[160:163],v[192:195]
s_add_u32 s62,s69,49152
v_mfma_f32_16x16x32_bf16 v[196:199],v[76:79],a[164:167],v[196:199]
buffer_store_dwordx4 v[36:39],v5,s[8:11],s62 offen sc1
v_mfma_f32_16x16x32_bf16 v[200:203],v[76:79],a[168:171],v[200:203]
v_mfma_f32_16x16x32_bf16 v[204:207],v[76:79],a[172:175],v[204:207]
v_mfma_f32_16x16x32_bf16 v[208:211],v[76:79],a[176:179],v[208:211]
v_mfma_f32_16x16x32_bf16 v[212:215],v[76:79],a[180:183],v[212:215]
v_mfma_f32_16x16x32_bf16 v[216:219],v[76:79],a[184:187],v[216:219]
v_mfma_f32_16x16x32_bf16 v[220:223],v[76:79],a[188:191],v[220:223]
v_mfma_f32_16x16x32_bf16 v[192:195],v[80:83],a[192:195],v[192:195]
v_mfma_f32_16x16x32_bf16 v[196:199],v[80:83],a[196:199],v[196:199]
v_mfma_f32_16x16x32_bf16 v[200:203],v[80:83],a[200:203],v[200:203]
v_mfma_f32_16x16x32_bf16 v[204:207],v[80:83],a[204:207],v[204:207]
v_mfma_f32_16x16x32_bf16 v[208:211],v[80:83],a[208:211],v[208:211]
v_mfma_f32_16x16x32_bf16 v[212:215],v[80:83],a[212:215],v[212:215]
v_mfma_f32_16x16x32_bf16 v[216:219],v[80:83],a[216:219],v[216:219]
v_mfma_f32_16x16x32_bf16 v[220:223],v[80:83],a[220:223],v[220:223]
v_mfma_f32_16x16x32_bf16 v[192:195],v[84:87],a[224:227],v[192:195]
v_mfma_f32_16x16x32_bf16 v[196:199],v[84:87],a[228:231],v[196:199]
v_mfma_f32_16x16x32_bf16 v[200:203],v[84:87],a[232:235],v[200:203]
v_mfma_f32_16x16x32_bf16 v[204:207],v[84:87],a[236:239],v[204:207]
v_mfma_f32_16x16x32_bf16 v[208:211],v[84:87],a[240:243],v[208:211]
v_mfma_f32_16x16x32_bf16 v[212:215],v[84:87],a[244:247],v[212:215]
v_mfma_f32_16x16x32_bf16 v[216:219],v[84:87],a[248:251],v[216:219]
v_mfma_f32_16x16x32_bf16 v[220:223],v[84:87],a[252:255],v[220:223]
v_cvt_pk_bf16_f32 v40,v192,v196
v_cvt_pk_bf16_f32 v41,v200,v204
v_cvt_pk_bf16_f32 v42,v208,v212
s_nop 4
v_cvt_pk_bf16_f32 v43,v216,v220
s_add_u32 s62,s69,262144
buffer_store_dwordx4 v[40:43],v5,s[8:11],s62 offen sc1
v_cvt_pk_bf16_f32 v44,v193,v197
v_cvt_pk_bf16_f32 v45,v201,v205
v_cvt_pk_bf16_f32 v46,v209,v213
v_cvt_pk_bf16_f32 v47,v217,v221
s_add_u32 s62,s69,278528
buffer_store_dwordx4 v[44:47],v5,s[8:11],s62 offen sc1
v_cvt_pk_bf16_f32 v48,v194,v198
v_cvt_pk_bf16_f32 v49,v202,v206
v_cvt_pk_bf16_f32 v50,v210,v214
v_cvt_pk_bf16_f32 v51,v218,v222
s_add_u32 s62,s69,294912
buffer_store_dwordx4 v[48:51],v5,s[8:11],s62 offen sc1
v_cvt_pk_bf16_f32 v52,v195,v199
v_cvt_pk_bf16_f32 v53,v203,v207
v_cvt_pk_bf16_f32 v54,v211,v215
v_cvt_pk_bf16_f32 v55,v219,v223
s_add_u32 s62,s69,311296
buffer_store_dwordx4 v[52:55],v5,s[8:11],s62 offen sc1
s_cmp_lg_u32 s72,0
s_cbranch_scc1 L_aa_283
s_waitcnt vmcnt(8)
L_aa_293:
s_barrier
s_xor_b32 s67,s67,65536
s_and_b32 s56,s50,2048
s_lshl_b32 s56,s56,4
s_add_u32 s56,s56,s67
v_add_u32 v2,s56,v0
v_add_u32 v239,s56,v253
s_and_b32 s56,s50,1024
s_lshl_b32 s56,s56,2
v_add_u32 v238,s56,v2
s_mov_b32 s76,s71
s_mov_b32 s53,s77
ds_read_b128 v[24:27],v238 offset:16384
ds_read_b128 v[40:43],v2 offset:0
ds_read_b128 v[56:59],v2 offset:4096
ds_read_b128 v[28:31],v238 offset:17408
ds_read_b128 v[44:47],v2 offset:1024
ds_read_b128 v[60:63],v2 offset:5120
ds_read_b128 v[32:35],v238 offset:18432
ds_read_b128 v[48:51],v2 offset:2048
ds_read_b128 v[64:67],v2 offset:6144
ds_read_b128 v[36:39],v238 offset:19456
ds_read_b128 v[52:55],v2 offset:3072
ds_read_b128 v[68:71],v2 offset:7168
s_waitcnt lgkmcnt(9)
v_mfma_f32_16x16x32_bf16 v[128:131],v[40:43],v[24:27],v[8:11]
ds_read_b128 v[72:75],v2 offset:24576
v_mfma_f32_16x16x32_bf16 v[132:135],v[56:59],v[24:27],v[12:15]
ds_read_b128 v[76:79],v2 offset:25600
s_waitcnt lgkmcnt(8)
v_mfma_f32_16x16x32_bf16 v[128:131],v[44:47],v[28:31],v[128:131]
ds_read_b128 v[80:83],v2 offset:26624
v_mfma_f32_16x16x32_bf16 v[132:135],v[60:63],v[28:31],v[132:135]
ds_read_b128 v[84:87],v2 offset:27648
s_waitcnt lgkmcnt(7)
v_mfma_f32_16x16x32_bf16 v[128:131],v[48:51],v[32:35],v[128:131]
ds_read_b64 v[120:121],v239 offset:24576
v_mfma_f32_16x16x32_bf16 v[132:135],v[64:67],v[32:35],v[132:135]
ds_read_b64 v[122:123],v239 offset:25600
s_waitcnt lgkmcnt(6)
v_mfma_f32_16x16x32_bf16 v[128:131],v[52:55],v[36:39],v[128:131]
ds_read_b64 v[124:125],v239 offset:26624
v_mfma_f32_16x16x32_bf16 v[132:135],v[68:71],v[36:39],v[132:135]
ds_read_b64 v[126:127],v239 offset:27648
s_waitcnt lgkmcnt(4)
v_mfma_f32_16x16x32_bf16 v[136:139],v[72:75],v[24:27],0
ds_read_b128 v[88:91],v2 offset:8192
ds_read_b128 v[92:95],v2 offset:9216
v_mfma_f32_16x16x32_bf16 v[136:139],v[76:79],v[28:31],v[136:139]
ds_read_b128 v[96:99],v2 offset:10240
ds_read_b128 v[100:103],v2 offset:11264
v_mfma_f32_16x16x32_bf16 v[136:139],v[80:83],v[32:35],v[136:139]
ds_read_b128 v[104:107],v2 offset:12288
ds_read_b128 v[108:111],v2 offset:13312
v_mfma_f32_16x16x32_bf16 v[136:139],v[84:87],v[36:39],v[136:139]
ds_read_b128 v[112:115],v2 offset:14336
ds_read_b128 v[116:119],v2 offset:15360
s_cmp_eq_u32 s30,0
s_cbranch_scc1 L_aa_282
s_add_u32 s66,s66,4
s_bfe_u32 s56,s66,0x10002
s_bitset0_b32 s37,s56
s_or_b32 s56,s37,s66
v_mov_b32 v22,s56
s_xor_b32 s69,s69,524288
s_waitcnt vmcnt(0) lgkmcnt(0)
s_barrier
buffer_store_dword v22,off,s[8:11],s74 sc1
buffer_store_dword v20,off,s[8:11],s73 sc1
s_mov_b32 s73,0x80000000
s_cmp_lg_u32 s86,1536
s_cbranch_scc1 L_ae_300
s_mov_b32 s77,s35
s_mov_b32 s30,0
s_lshl_b32 s56,s77,5
s_add_u32 s56,s56,s68
s_mul_i32 s70,s56,24576
s_lshl_b32 s71,s56,12
s_lshl_b32 s59,s77,13
s_lshl2_add_u32 s59,s68,s59
s_add_u32 s59,s59,10485760
s_buffer_load_dword s32,s[8:11],s59
s_mov_b32 s33,1
s_add_u32 s70,s70,100663296
s_add_u32 s71,s71,41943040
v_mov_b32 v19,s59
s_branch L_af_301
L_ae_300:
s_ff1_i32_b64 s77,s[84:85]
s_bitset0_b64 s[84:85],s77
s_min_u32 s77,s77,64
s_lshr_b32 s61,s55,5
s_lshl_b32 s56,s77,5
s_add_u32 s56,s56,s68
s_mul_i32 s70,s56,24576
s_lshl_b32 s71,s56,12
s_lshl_b32 s59,s77,13
s_lshl2_add_u32 s59,s68,s59
s_add_u32 s59,s59,10486144
s_cmp_lt_u32 s77,s61
s_cselect_b32 s57,0,16777216
s_cselect_b32 s60,0,128
s_add_u32 s60,s60,s59
s_add_u32 s60,s60,128
s_buffer_load_dword s33,s[8:11],s60
s_add_u32 s71,s71,s57
s_add_u32 s71,s71,58720256
s_cmp_eq_u32 s77,s61
s_cselect_b32 s57,50331648,0
s_cselect_b32 s58,1536,0
s_add_u32 s59,s59,s58
s_buffer_load_dword s32,s[8:11],s59
s_add_u32 s70,s70,s57
s_add_u32 s70,s70,150994944
v_mov_b32 v19,s59
v_writelane_b32 v19,s60,1
L_af_301:
v_max3_f32 v238,v128,v129,v130
v_max3_f32 v239,v131,v132,v133
v_max3_f32 v238,v134,v135,v238
v_max3_f32 v239,v138,v139,v239
v_max_f32 v238,v238,v239
v_max_f32 v239,v238,v239
s_nop 1
v_permlane16_swap_b32 v238,v239
v_max_f32 v238,v238,v239
v_max_f32 v239,v238,v239
s_nop 1
v_permlane32_swap_b32 v238,v239
v_max_f32 v238,v238,v239
v_mul_f32 v238,s80,v238
v_fma_f32 v128,v128,s80,-v238
v_fma_f32 v129,v129,s80,-v238
v_exp_f32 v128,v128
v_fma_f32 v130,v130,s80,-v238
v_exp_f32 v129,v129
v_fma_f32 v131,v131,s80,-v238
v_exp_f32 v130,v130
v_fma_f32 v132,v132,s80,-v238
v_exp_f32 v131,v131
v_fma_f32 v133,v133,s80,-v238
v_exp_f32 v132,v132
v_fma_f32 v134,v134,s80,-v238
v_exp_f32 v133,v133
v_fma_f32 v135,v135,s80,-v238
v_exp_f32 v134,v134
v_fma_f32 v138,v138,s80,-v238
v_exp_f32 v135,v135
v_fma_f32 v139,v139,s80,-v238
v_exp_f32 v138,v138
v_exp_f32 v139,v139
v_cvt_pk_bf16_f32 v140,v128,v129
v_cvt_pk_bf16_f32 v141,v130,v131
v_cvt_pk_bf16_f32 v142,v132,v133
v_cvt_pk_bf16_f32 v143,v134,v135
v_cvt_pk_bf16_f32 v144,v138,v139
v_mov_b32 v147,v144
buffer_load_dword v17,v16,s[8:11],s87 offen sc1
v_mfma_f32_16x16x32_bf16 v[148:151],v[152:155],v[140:143],0
v_mfma_f32_16x16x32_bf16 v[24:27],v[88:91],v[140:143],0
v_mfma_f32_16x16x32_bf16 v[28:31],v[92:95],v[140:143],0
v_mfma_f32_16x16x16_bf16 v[148:151],v[152:153],v[144:145],v[148:151]
v_mfma_f32_16x16x32_bf16 v[32:35],v[96:99],v[140:143],0
v_mfma_f32_16x16x32_bf16 v[36:39],v[100:103],v[140:143],0
v_mfma_f32_16x16x32_bf16 v[40:43],v[104:107],v[140:143],0
v_mfma_f32_16x16x32_bf16 v[44:47],v[108:111],v[140:143],0
v_mfma_f32_16x16x32_bf16 v[48:51],v[112:115],v[140:143],0
v_mfma_f32_16x16x32_bf16 v[52:55],v[116:119],v[140:143],0
v_rcp_f32 v148,v148
v_mfma_f32_16x16x16_bf16 v[24:27],v[120:121],v[144:145],v[24:27]
v_mfma_f32_16x16x16_bf16 v[28:31],v[120:121],v[146:147],v[28:31]
v_mfma_f32_16x16x16_bf16 v[32:35],v[122:123],v[144:145],v[32:35]
v_mfma_f32_16x16x16_bf16 v[36:39],v[122:123],v[146:147],v[36:39]
v_mfma_f32_16x16x16_bf16 v[40:43],v[124:125],v[144:145],v[40:43]
v_pk_mul_f32 v[24:25],v[24:25],v[148:149] op_sel_hi:[1,0]
v_pk_mul_f32 v[26:27],v[26:27],v[148:149] op_sel_hi:[1,0]
v_mfma_f32_16x16x16_bf16 v[44:47],v[124:125],v[146:147],v[44:47]
v_pk_mul_f32 v[28:29],v[28:29],v[148:149] op_sel_hi:[1,0]
v_pk_mul_f32 v[30:31],v[30:31],v[148:149] op_sel_hi:[1,0]
v_mfma_f32_16x16x16_bf16 v[48:51],v[126:127],v[144:145],v[48:51]
v_cvt_pk_bf16_f32 v72,v24,v28
v_cvt_pk_bf16_f32 v73,v25,v29
v_mfma_f32_16x16x16_bf16 v[52:55],v[126:127],v[146:147],v[52:55]
v_cvt_pk_bf16_f32 v74,v26,v30
v_cvt_pk_bf16_f32 v75,v27,v31
ds_write_b128 v3,v[72:75] offset:0
v_pk_mul_f32 v[32:33],v[32:33],v[148:149] op_sel_hi:[1,0]
v_pk_mul_f32 v[34:35],v[34:35],v[148:149] op_sel_hi:[1,0]
v_pk_mul_f32 v[36:37],v[36:37],v[148:149] op_sel_hi:[1,0]
v_pk_mul_f32 v[38:39],v[38:39],v[148:149] op_sel_hi:[1,0]
v_cvt_pk_bf16_f32 v76,v32,v36
v_cvt_pk_bf16_f32 v77,v33,v37
v_cvt_pk_bf16_f32 v78,v34,v38
v_cvt_pk_bf16_f32 v79,v35,v39
ds_write_b128 v3,v[76:79] offset:1024
s_waitcnt vmcnt(0)
v_cmp_gt_u32 vcc,s66,v17
v_pk_mul_f32 v[40:41],v[40:41],v[148:149] op_sel_hi:[1,0]
v_pk_mul_f32 v[42:43],v[42:43],v[148:149] op_sel_hi:[1,0]
v_pk_mul_f32 v[44:45],v[44:45],v[148:149] op_sel_hi:[1,0]
v_pk_mul_f32 v[46:47],v[46:47],v[148:149] op_sel_hi:[1,0]
s_cbranch_vccnz L_ap_303
L_apb_304:
s_bfe_u32 s56,s66,0x10002
v_lshrrev_b32 v238,s56,v17
v_and_b32 v238,1,v238
v_cmp_ne_u32 vcc,0,v238
v_cvt_pk_bf16_f32 v80,v40,v44
v_cvt_pk_bf16_f32 v81,v41,v45
v_cvt_pk_bf16_f32 v82,v42,v46
s_cbranch_vccnz L_ak_299
s_add_u32 s36,s36,4
s_xor_b32 s34,s69,524288
buffer_load_dwordx4 v[192:195],v7,s[8:11],s34 offen sc1
v_cvt_pk_bf16_f32 v83,v43,v47
ds_write_b128 v3,v[80:83] offset:2048
s_add_u32 s34,s34,4096
buffer_load_dwordx4 v[196:199],v7,s[8:11],s34 offen sc1
v_pk_mul_f32 v[48:49],v[48:49],v[148:149] op_sel_hi:[1,0]
v_pk_mul_f32 v[50:51],v[50:51],v[148:149] op_sel_hi:[1,0]
s_add_u32 s34,s34,4096
buffer_load_dwordx4 v[200:203],v7,s[8:11],s34 offen sc1
v_pk_mul_f32 v[52:53],v[52:53],v[148:149] op_sel_hi:[1,0]
v_pk_mul_f32 v[54:55],v[54:55],v[148:149] op_sel_hi:[1,0]
s_add_u32 s34,s34,4096
buffer_load_dwordx4 v[204:207],v7,s[8:11],s34 offen sc1
v_cvt_pk_bf16_f32 v84,v48,v52
v_cvt_pk_bf16_f32 v85,v49,v53
s_add_u32 s34,s34,4096
buffer_load_dwordx4 v[208:211],v7,s[8:11],s34 offen sc1
v_cvt_pk_bf16_f32 v86,v50,v54
v_cvt_pk_bf16_f32 v87,v51,v55
s_add_u32 s34,s34,4096
buffer_load_dwordx4 v[212:215],v7,s[8:11],s34 offen sc1
ds_write_b128 v3,v[84:87] offset:3072
s_add_u32 s34,s34,4096
buffer_load_dwordx4 v[216:219],v7,s[8:11],s34 offen sc1
s_add_u32 s34,s34,4096
buffer_load_dwordx4 v[220:223],v7,s[8:11],s34 offen sc1
s_cmp_eq_u32 s31,0
s_cbranch_scc1 L_ah_302
s_waitcnt lgkmcnt(0)
s_barrier
s_mov_b32 s26,s51
s_mov_b32 s51,s53
s_branch L_aa_294
L_ah_302:
s_waitcnt vmcnt(7)
v_mfma_f32_16x16x32_bf16 v[160:163],v[156:159],v[192:195],0
s_waitcnt vmcnt(6)
v_mfma_f32_16x16x32_bf16 v[160:163],v[156:159],v[196:199],v[160:163]
s_waitcnt vmcnt(5)
v_mfma_f32_16x16x32_bf16 v[160:163],v[156:159],v[200:203],v[160:163]
s_waitcnt vmcnt(4)
v_mfma_f32_16x16x32_bf16 v[160:163],v[156:159],v[204:207],v[160:163]
s_waitcnt vmcnt(3)
v_mfma_f32_16x16x32_bf16 v[164:167],v[156:159],v[208:211],0
s_waitcnt vmcnt(2)
v_mfma_f32_16x16x32_bf16 v[164:167],v[156:159],v[212:215],v[164:167]
s_waitcnt vmcnt(1)
v_mfma_f32_16x16x32_bf16 v[164:167],v[156:159],v[216:219],v[164:167]
ds_write_b128 v6,v[160:163]
s_waitcnt vmcnt(0)
v_mfma_f32_16x16x32_bf16 v[164:167],v[156:159],v[220:223],v[164:167]
s_nop 7
ds_write_b128 v6,v[164:167] offset:2048
s_waitcnt lgkmcnt(0)
s_barrier
s_mov_b32 s27,1
s_branch L_aa_285
L_aa_282:
s_add_u32 s66,s66,4
s_bfe_u32 s56,s66,0x10002
s_bitset0_b32 s37,s56
s_or_b32 s56,s37,s66
v_mov_b32 v22,s56
s_xor_b32 s69,s69,524288
s_waitcnt vmcnt(0) lgkmcnt(0)
s_barrier
buffer_store_dword v22,off,s[8:11],s74 sc1
buffer_store_dword v20,off,s[8:11],s73 sc1
s_mov_b32 s73,0x80000000
s_cmp_eq_u32 s31,0
s_cbranch_scc1 L_aa_284
s_mov_b32 s26,s51
s_mov_b32 s27,3
s_branch L_aa_289
L_aa_284:
L_aq_305:
buffer_load_dword v17,v16,s[8:11],s87 offen sc1
s_sub_u32 s49,s49,1
s_cbranch_scc1 L_abort2
s_waitcnt vmcnt(0)
v_cmp_gt_u32 vcc,s66,v17
s_cbranch_vccnz L_aq_305
s_xor_b32 s34,s69,524288
buffer_load_dwordx4 v[160:163],v7,s[8:11],s34 offen sc1
s_add_u32 s34,s34,4096
buffer_load_dwordx4 v[164:167],v7,s[8:11],s34 offen sc1
s_add_u32 s34,s34,4096
buffer_load_dwordx4 v[168:171],v7,s[8:11],s34 offen sc1
s_add_u32 s34,s34,4096
buffer_load_dwordx4 v[172:175],v7,s[8:11],s34 offen sc1
s_add_u32 s34,s34,4096
buffer_load_dwordx4 v[176:179],v7,s[8:11],s34 offen sc1
s_add_u32 s34,s34,4096
buffer_load_dwordx4 v[180:183],v7,s[8:11],s34 offen sc1
s_add_u32 s34,s34,4096
buffer_load_dwordx4 v[184:187],v7,s[8:11],s34 offen sc1
s_add_u32 s34,s34,4096
buffer_load_dwordx4 v[188:191],v7,s[8:11],s34 offen sc1
buffer_load_dwordx4 v[72:75],v0,s[8:11],s76 offen offset:0 sc1
buffer_load_dwordx4 v[76:79],v0,s[8:11],s76 offen offset:1024 sc1
buffer_load_dwordx4 v[80:83],v0,s[8:11],s76 offen offset:2048 sc1
buffer_load_dwordx4 v[84:87],v0,s[8:11],s76 offen offset:3072 sc1
buffer_load_dwordx2 v[120:121],v253,s[8:11],s76 offen offset:0 sc1
buffer_load_dwordx2 v[122:123],v253,s[8:11],s76 offen offset:1024 sc1
buffer_load_dwordx2 v[124:125],v253,s[8:11],s76 offen offset:2048 sc1
buffer_load_dwordx2 v[126:127],v253,s[8:11],s76 offen offset:3072 sc1
s_waitcnt vmcnt(15)
v_mfma_f32_16x16x32_bf16 v[192:195],v[156:159],v[160:163],0
s_waitcnt vmcnt(14)
v_mfma_f32_16x16x32_bf16 v[192:195],v[156:159],v[164:167],v[192:195]
s_waitcnt vmcnt(13)
v_mfma_f32_16x16x32_bf16 v[192:195],v[156:159],v[168:171],v[192:195]
s_waitcnt vmcnt(12)
v_mfma_f32_16x16x32_bf16 v[192:195],v[156:159],v[172:175],v[192:195]
s_waitcnt vmcnt(11)
v_mfma_f32_16x16x32_bf16 v[196:199],v[156:159],v[176:179],0
s_waitcnt vmcnt(10)
v_mfma_f32_16x16x32_bf16 v[196:199],v[156:159],v[180:183],v[196:199]
s_waitcnt vmcnt(9)
v_mfma_f32_16x16x32_bf16 v[196:199],v[156:159],v[184:187],v[196:199]
ds_write_b128 v6,v[192:195]
s_waitcnt vmcnt(8)
v_mfma_f32_16x16x32_bf16 v[196:199],v[156:159],v[188:191],v[196:199]
s_nop 7
ds_write_b128 v6,v[196:199] offset:2048
s_waitcnt lgkmcnt(0)
s_barrier
s_mov_b32 s27,0
s_branch L_aa_285
L_aa_283:
s_add_u32 s56,s30,s86
s_cmp_lg_u32 s56,1537
s_cbranch_scc1 L_al_298
s_add_u32 s66,s66,4
s_bfe_u32 s56,s66,0x10002
s_bitset1_b32 s37,s56
s_or_b32 s56,s37,s66
v_mov_b32 v22,s56
s_xor_b32 s69,s69,524288
s_waitcnt vmcnt(0) lgkmcnt(0)
s_barrier
buffer_store_dword v22,off,s[8:11],s74 sc1
buffer_store_dword v20,off,s[8:11],s73 sc1
s_mov_b32 s73,0x80000000
s_cmp_lg_u32 s86,1536
s_cbranch_scc1 L_ae_306
s_mov_b32 s77,s35
s_mov_b32 s30,0
s_lshl_b32 s56,s77,5
s_add_u32 s56,s56,s68
s_mul_i32 s70,s56,24576
s_lshl_b32 s71,s56,12
s_lshl_b32 s59,s77,13
s_lshl2_add_u32 s59,s68,s59
s_add_u32 s59,s59,10485760
s_buffer_load_dword s32,s[8:11],s59
s_mov_b32 s33,1
s_add_u32 s70,s70,100663296
s_add_u32 s71,s71,41943040
v_mov_b32 v19,s59
s_branch L_af_307
L_ae_306:
s_ff1_i32_b64 s77,s[84:85]
s_bitset0_b64 s[84:85],s77
s_min_u32 s77,s77,64
s_lshr_b32 s61,s55,5
s_lshl_b32 s56,s77,5
s_add_u32 s56,s56,s68
s_mul_i32 s70,s56,24576
s_lshl_b32 s71,s56,12
s_lshl_b32 s59,s77,13
s_lshl2_add_u32 s59,s68,s59
s_add_u32 s59,s59,10486144
s_cmp_lt_u32 s77,s61
s_cselect_b32 s57,0,16777216
s_cselect_b32 s60,0,128
s_add_u32 s60,s60,s59
s_add_u32 s60,s60,128
s_buffer_load_dword s33,s[8:11],s60
s_add_u32 s71,s71,s57
s_add_u32 s71,s71,58720256
s_cmp_eq_u32 s77,s61
s_cselect_b32 s57,50331648,0
s_cselect_b32 s58,1536,0
s_add_u32 s59,s59,s58
s_buffer_load_dword s32,s[8:11],s59
s_add_u32 s70,s70,s57
s_add_u32 s70,s70,150994944
v_mov_b32 v19,s59
v_writelane_b32 v19,s60,1
L_af_307:
s_branch L_ak_299
L_al_298:
s_add_u32 s66,s66,4
s_bfe_u32 s56,s66,0x10002
s_bitset0_b32 s37,s56
s_or_b32 s56,s37,s66
v_mov_b32 v22,s56
s_xor_b32 s69,s69,524288
s_waitcnt vmcnt(0) lgkmcnt(0)
s_barrier
buffer_store_dword v22,off,s[8:11],s74 sc1
buffer_store_dword v20,off,s[8:11],s73 sc1
s_mov_b32 s73,0x80000000
L_ak_299:
L_aq_308:
buffer_load_dword v17,v16,s[8:11],s87 offen sc1
s_sub_u32 s49,s49,1
s_cbranch_scc1 L_abort2
s_waitcnt vmcnt(0)
v_cmp_gt_u32 vcc,s66,v17
s_cbranch_vccnz L_aq_308
s_xor_b32 s34,s69,524288
buffer_load_dwordx4 v[160:163],v7,s[8:11],s34 offen sc1
s_add_u32 s34,s34,4096
buffer_load_dwordx4 v[164:167],v7,s[8:11],s34 offen sc1
s_add_u32 s34,s34,4096
buffer_load_dwordx4 v[168:171],v7,s[8:11],s34 offen sc1
s_add_u32 s34,s34,4096
buffer_load_dwordx4 v[172:175],v7,s[8:11],s34 offen sc1
s_add_u32 s34,s34,4096
buffer_load_dwordx4 v[176:179],v7,s[8:11],s34 offen sc1
s_add_u32 s34,s34,4096
buffer_load_dwordx4 v[180:183],v7,s[8:11],s34 offen sc1
s_add_u32 s34,s34,4096
buffer_load_dwordx4 v[184:187],v7,s[8:11],s34 offen sc1
s_add_u32 s34,s34,4096
buffer_load_dwordx4 v[188:191],v7,s[8:11],s34 offen sc1
s_waitcnt vmcnt(7)
v_mfma_f32_16x16x32_bf16 v[192:195],v[156:159],v[160:163],0
s_waitcnt vmcnt(6)
v_mfma_f32_16x16x32_bf16 v[192:195],v[156:159],v[164:167],v[192:195]
s_waitcnt vmcnt(5)
v_mfma_f32_16x16x32_bf16 v[192:195],v[156:159],v[168:171],v[192:195]
s_waitcnt vmcnt(4)
v_mfma_f32_16x16x32_bf16 v[192:195],v[156:159],v[172:175],v[192:195]
s_waitcnt vmcnt(3)
v_mfma_f32_16x16x32_bf16 v[196:199],v[156:159],v[176:179],0
s_waitcnt vmcnt(2)
v_mfma_f32_16x16x32_bf16 v[196:199],v[156:159],v[180:183],v[196:199]
s_waitcnt vmcnt(1)
v_mfma_f32_16x16x32_bf16 v[196:199],v[156:159],v[184:187],v[196:199]
ds_write_b128 v6,v[192:195]
s_waitcnt vmcnt(0)
v_mfma_f32_16x16x32_bf16 v[196:199],v[156:159],v[188:191],v[196:199]
s_nop 7
ds_write_b128 v6,v[196:199] offset:2048
s_waitcnt lgkmcnt(0)
s_barrier
s_mov_b32 s27,2
L_aa_285:
s_cmp_lg_u32 s31,0
s_cbranch_scc1 L_ar_311
s_bitcmp1_b32 s46,0
s_cbranch_scc1 L_ar_310
L_ar_309:
ds_read_b128 v[160:163],v23
ds_read_b128 v[164:167],v23 offset:16
v_lshlrev_b32 v200,16,v224
v_and_b32 v201,0xffff0000,v224
v_lshlrev_b32 v202,16,v225
v_and_b32 v203,0xffff0000,v225
v_lshlrev_b32 v204,16,v226
v_and_b32 v205,0xffff0000,v226
v_lshlrev_b32 v206,16,v227
v_and_b32 v207,0xffff0000,v227
s_lshl_b32 s18,s51,5
s_add_u32 s18,s18,s68
s_lshl_b32 s19,s18,10
s_add_u32 s20,s19,8388608
s_waitcnt lgkmcnt(0)
v_cvt_pk_bf16_f32 v168,v160,v161
v_cvt_pk_bf16_f32 v169,v162,v163
v_cvt_pk_bf16_f32 v170,v164,v165
v_cvt_pk_bf16_f32 v171,v166,v167
v_lshlrev_b32 v160,16,v168
v_and_b32 v161,0xffff0000,v168
v_lshlrev_b32 v162,16,v169
v_and_b32 v163,0xffff0000,v169
v_lshlrev_b32 v164,16,v170
v_and_b32 v165,0xffff0000,v170
v_lshlrev_b32 v166,16,v171
v_and_b32 v167,0xffff0000,v171
v_pk_add_f32 v[200:201],v[200:201],v[160:161]
v_pk_add_f32 v[202:203],v[202:203],v[162:163]
v_pk_add_f32 v[204:205],v[204:205],v[164:165]
v_pk_add_f32 v[206:207],v[206:207],v[166:167]
v_cvt_pk_bf16_f32 v168,v200,v201
v_cvt_pk_bf16_f32 v169,v202,v203
v_cvt_pk_bf16_f32 v170,v204,v205
v_cvt_pk_bf16_f32 v171,v206,v207
v_lshlrev_b32 v200,16,v168
v_and_b32 v201,0xffff0000,v168
v_lshlrev_b32 v202,16,v169
v_and_b32 v203,0xffff0000,v169
v_lshlrev_b32 v204,16,v170
v_and_b32 v205,0xffff0000,v170
v_lshlrev_b32 v206,16,v171
v_and_b32 v207,0xffff0000,v171
v_readfirstlane_b32 s78,v200
s_nop 1
v_pk_add_f32 v[184:185],v[200:201],s[78:79] op_sel_hi:[1,0] neg_lo:[0,1] neg_hi:[0,1]
v_pk_add_f32 v[186:187],v[202:203],s[78:79] op_sel_hi:[1,0] neg_lo:[0,1] neg_hi:[0,1]
v_pk_add_f32 v[188:189],v[204:205],s[78:79] op_sel_hi:[1,0] neg_lo:[0,1] neg_hi:[0,1]
v_pk_add_f32 v[190:191],v[206:207],s[78:79] op_sel_hi:[1,0] neg_lo:[0,1] neg_hi:[0,1]
v_pk_add_f32 v[192:193],v[184:185],v[186:187]
v_pk_mul_f32 v[194:195],v[184:185],v[184:185]
v_pk_add_f32 v[196:197],v[188:189],v[190:191]
v_pk_fma_f32 v[194:195],v[186:187],v[186:187],v[194:195]
v_pk_add_f32 v[192:193],v[192:193],v[196:197]
v_pk_fma_f32 v[194:195],v[188:189],v[188:189],v[194:195]
v_add_f32 v192,v192,v193
v_pk_fma_f32 v[194:195],v[190:191],v[190:191],v[194:195]
v_add_f32 v194,v194,v195
s_nop 1
v_permlane32_swap_b32 v192,v194
v_add_f32 v192,v192,v194
s_nop 1
v_add_f32_dpp v192,v192,v192 row_ror:8 row_mask:0xf bank_mask:0xf
s_nop 1
v_add_f32_dpp v192,v192,v192 row_ror:4 row_mask:0xf bank_mask:0xf
s_nop 1
v_add_f32_dpp v192,v192,v192 row_ror:2 row_mask:0xf bank_mask:0xf
s_nop 1
v_add_f32_dpp v192,v192,v192 row_ror:1 row_mask:0xf bank_mask:0xf
v_mov_b32 v194,v192
s_nop 1
v_permlane16_swap_b32 v192,v194
v_add_f32 v192,v192,v194
v_mul_f32 v192,0x3b000000,v192
v_mov_b32 v194,v192
s_nop 1
v_permlane32_swap_b32 v192,v194
v_fma_f32 v194,-v192,v192,v194
v_add_f32 v192,s78,v192
v_max_f32 v194,0,v194
v_cvt_pk_bf16_f32 v194,v192,v194
v_lshlrev_b32 v192,16,v194
v_and_b32 v194,0xffff0000,v194
v_add_f32 v194,0x3727c5ac,v194
v_cvt_pk_bf16_f32 v194,v194,v194
v_and_b32 v194,0xffff0000,v194
v_sqrt_f32 v194,v194
v_pk_add_f32 v[184:185],v[200:201],v[192:193] op_sel_hi:[1,0] neg_lo:[0,1] neg_hi:[0,1]
v_pk_add_f32 v[186:187],v[202:203],v[192:193] op_sel_hi:[1,0] neg_lo:[0,1] neg_hi:[0,1]
v_pk_add_f32 v[188:189],v[204:205],v[192:193] op_sel_hi:[1,0] neg_lo:[0,1] neg_hi:[0,1]
v_pk_add_f32 v[190:191],v[206:207],v[192:193] op_sel_hi:[1,0] neg_lo:[0,1] neg_hi:[0,1]
v_cvt_pk_bf16_f32 v194,v194,v194
v_and_b32 v194,0xffff0000,v194
v_rcp_f32 v194,v194
v_cvt_pk_bf16_f32 v172,v184,v185
v_cvt_pk_bf16_f32 v173,v186,v187
v_cvt_pk_bf16_f32 v174,v188,v189
v_cvt_pk_bf16_f32 v175,v190,v191
v_lshlrev_b32 v184,16,v172
v_and_b32 v185,0xffff0000,v172
v_lshlrev_b32 v186,16,v173
v_and_b32 v187,0xffff0000,v173
v_lshlrev_b32 v188,16,v174
v_and_b32 v189,0xffff0000,v174
v_lshlrev_b32 v190,16,v175
v_and_b32 v191,0xffff0000,v175
v_pk_mul_f32 v[184:185],v[184:185],v[194:195] op_sel_hi:[1,0]
v_pk_mul_f32 v[186:187],v[186:187],v[194:195] op_sel_hi:[1,0]
v_pk_mul_f32 v[188:189],v[188:189],v[194:195] op_sel_hi:[1,0]
v_pk_mul_f32 v[190:191],v[190:191],v[194:195] op_sel_hi:[1,0]
v_cvt_pk_bf16_f32 v172,v184,v185
v_cvt_pk_bf16_f32 v173,v186,v187
v_cvt_pk_bf16_f32 v174,v188,v189
v_cvt_pk_bf16_f32 v175,v190,v191
v_lshlrev_b32 v176,16,v172
v_and_b32 v177,0xffff0000,v172
v_lshlrev_b32 v178,16,v173
v_and_b32 v179,0xffff0000,v173
v_lshlrev_b32 v180,16,v174
v_and_b32 v181,0xffff0000,v174
v_lshlrev_b32 v182,16,v175
v_and_b32 v183,0xffff0000,v175
v_pk_add_f32 v[200:201],v[200:201],v[176:177]
v_pk_add_f32 v[202:203],v[202:203],v[178:179]
v_pk_add_f32 v[204:205],v[204:205],v[180:181]
v_pk_add_f32 v[206:207],v[206:207],v[182:183]
v_cvt_pk_bf16_f32 v160,v200,v201
v_cvt_pk_bf16_f32 v161,v202,v203
v_cvt_pk_bf16_f32 v162,v204,v205
v_cvt_pk_bf16_f32 v163,v206,v207
buffer_store_dwordx4 v[160:163],v0,s[8:11],s20 offen sc1
v_lshlrev_b32 v200,16,v160
v_and_b32 v201,0xffff0000,v160
v_lshlrev_b32 v202,16,v161
v_and_b32 v203,0xffff0000,v161
v_lshlrev_b32 v204,16,v162
v_and_b32 v205,0xffff0000,v162
v_lshlrev_b32 v206,16,v163
v_and_b32 v207,0xffff0000,v163
v_readfirstlane_b32 s78,v200
s_nop 1
v_pk_add_f32 v[184:185],v[200:201],s[78:79] op_sel_hi:[1,0] neg_lo:[0,1] neg_hi:[0,1]
v_pk_add_f32 v[186:187],v[202:203],s[78:79] op_sel_hi:[1,0] neg_lo:[0,1] neg_hi:[0,1]
v_pk_add_f32 v[188:189],v[204:205],s[78:79] op_sel_hi:[1,0] neg_lo:[0,1] neg_hi:[0,1]
v_pk_add_f32 v[190:191],v[206:207],s[78:79] op_sel_hi:[1,0] neg_lo:[0,1] neg_hi:[0,1]
v_pk_add_f32 v[192:193],v[184:185],v[186:187]
v_pk_mul_f32 v[194:195],v[184:185],v[184:185]
v_pk_add_f32 v[196:197],v[188:189],v[190:191]
v_pk_fma_f32 v[194:195],v[186:187],v[186:187],v[194:195]
v_pk_add_f32 v[192:193],v[192:193],v[196:197]
v_pk_fma_f32 v[194:195],v[188:189],v[188:189],v[194:195]
v_add_f32 v192,v192,v193
v_pk_fma_f32 v[194:195],v[190:191],v[190:191],v[194:195]
v_add_f32 v194,v194,v195
s_nop 1
v_permlane32_swap_b32 v192,v194
v_add_f32 v192,v192,v194
s_nop 1
v_add_f32_dpp v192,v192,v192 row_ror:8 row_mask:0xf bank_mask:0xf
s_nop 1
v_add_f32_dpp v192,v192,v192 row_ror:4 row_mask:0xf bank_mask:0xf
s_nop 1
v_add_f32_dpp v192,v192,v192 row_ror:2 row_mask:0xf bank_mask:0xf
s_nop 1
v_add_f32_dpp v192,v192,v192 row_ror:1 row_mask:0xf bank_mask:0xf
v_mov_b32 v194,v192
s_nop 1
v_permlane16_swap_b32 v192,v194
v_add_f32 v192,v192,v194
v_mul_f32 v192,0x3b000000,v192
v_mov_b32 v194,v192
s_nop 1
v_permlane32_swap_b32 v192,v194
v_fma_f32 v194,-v192,v192,v194
v_add_f32 v192,s78,v192
v_max_f32 v194,0,v194
v_cvt_pk_bf16_f32 v194,v192,v194
v_lshlrev_b32 v192,16,v194
v_and_b32 v194,0xffff0000,v194
v_add_f32 v194,0x3727c5ac,v194
v_cvt_pk_bf16_f32 v194,v194,v194
v_and_b32 v194,0xffff0000,v194
v_sqrt_f32 v194,v194
v_pk_add_f32 v[184:185],v[200:201],v[192:193] op_sel_hi:[1,0] neg_lo:[0,1] neg_hi:[0,1]
v_pk_add_f32 v[186:187],v[202:203],v[192:193] op_sel_hi:[1,0] neg_lo:[0,1] neg_hi:[0,1]
v_pk_add_f32 v[188:189],v[204:205],v[192:193] op_sel_hi:[1,0] neg_lo:[0,1] neg_hi:[0,1]
v_pk_add_f32 v[190:191],v[206:207],v[192:193] op_sel_hi:[1,0] neg_lo:[0,1] neg_hi:[0,1]
v_cvt_pk_bf16_f32 v194,v194,v194
v_and_b32 v194,0xffff0000,v194
v_rcp_f32 v194,v194
v_cvt_pk_bf16_f32 v164,v184,v185
v_cvt_pk_bf16_f32 v165,v186,v187
v_cvt_pk_bf16_f32 v166,v188,v189
v_cvt_pk_bf16_f32 v167,v190,v191
v_lshlrev_b32 v184,16,v164
v_and_b32 v185,0xffff0000,v164
v_lshlrev_b32 v186,16,v165
v_and_b32 v187,0xffff0000,v165
v_lshlrev_b32 v188,16,v166
v_and_b32 v189,0xffff0000,v166
v_lshlrev_b32 v190,16,v167
v_and_b32 v191,0xffff0000,v167
v_pk_mul_f32 v[184:185],v[184:185],v[194:195] op_sel_hi:[1,0]
v_pk_mul_f32 v[186:187],v[186:187],v[194:195] op_sel_hi:[1,0]
v_pk_mul_f32 v[188:189],v[188:189],v[194:195] op_sel_hi:[1,0]
v_pk_mul_f32 v[190:191],v[190:191],v[194:195] op_sel_hi:[1,0]
v_cvt_pk_bf16_f32 v164,v184,v185
v_cvt_pk_bf16_f32 v165,v186,v187
v_cvt_pk_bf16_f32 v166,v188,v189
v_cvt_pk_bf16_f32 v167,v190,v191
s_add_u32 s20,s19,2097152
buffer_store_dwordx4 v[164:167],v0,s[8:11],s20 offen sc1
v_mov_b32 v20,1
s_lshl_b32 s73,s51,13
s_lshl2_add_u32 s73,s68,s73
s_add_u32 s73,s73,10487552
s_branch L_aa_286
L_ar_310:
ds_read_b128 v[160:163],v23
ds_read_b128 v[164:167],v23 offset:16
v_lshlrev_b32 v200,16,v224
v_and_b32 v201,0xffff0000,v224
v_lshlrev_b32 v202,16,v225
v_and_b32 v203,0xffff0000,v225
v_lshlrev_b32 v204,16,v226
v_and_b32 v205,0xffff0000,v226
v_lshlrev_b32 v206,16,v227
v_and_b32 v207,0xffff0000,v227
s_lshl_b32 s18,s51,5
s_add_u32 s18,s18,s68
s_lshl_b32 s19,s18,10
s_add_u32 s20,s19,4194304
s_waitcnt lgkmcnt(0)
v_cvt_pk_bf16_f32 v168,v160,v161
v_cvt_pk_bf16_f32 v169,v162,v163
v_cvt_pk_bf16_f32 v170,v164,v165
v_cvt_pk_bf16_f32 v171,v166,v167
v_lshlrev_b32 v160,16,v168
v_and_b32 v161,0xffff0000,v168
v_lshlrev_b32 v162,16,v169
v_and_b32 v163,0xffff0000,v169
v_lshlrev_b32 v164,16,v170
v_and_b32 v165,0xffff0000,v170
v_lshlrev_b32 v166,16,v171
v_and_b32 v167,0xffff0000,v171
v_pk_add_f32 v[200:201],v[200:201],v[160:161]
v_pk_add_f32 v[202:203],v[202:203],v[162:163]
v_pk_add_f32 v[204:205],v[204:205],v[164:165]
v_pk_add_f32 v[206:207],v[206:207],v[166:167]
v_cvt_pk_bf16_f32 v168,v200,v201
v_cvt_pk_bf16_f32 v169,v202,v203
v_cvt_pk_bf16_f32 v170,v204,v205
v_cvt_pk_bf16_f32 v171,v206,v207
buffer_store_dwordx4 v[168:171],v0,s[8:11],s20 offen sc1
v_lshlrev_b32 v200,16,v168
v_and_b32 v201,0xffff0000,v168
v_lshlrev_b32 v202,16,v169
v_and_b32 v203,0xffff0000,v169
v_lshlrev_b32 v204,16,v170
v_and_b32 v205,0xffff0000,v170
v_lshlrev_b32 v206,16,v171
v_and_b32 v207,0xffff0000,v171
v_readfirstlane_b32 s78,v200
s_nop 1
v_pk_add_f32 v[184:185],v[200:201],s[78:79] op_sel_hi:[1,0] neg_lo:[0,1] neg_hi:[0,1]
v_pk_add_f32 v[186:187],v[202:203],s[78:79] op_sel_hi:[1,0] neg_lo:[0,1] neg_hi:[0,1]
v_pk_add_f32 v[188:189],v[204:205],s[78:79] op_sel_hi:[1,0] neg_lo:[0,1] neg_hi:[0,1]
v_pk_add_f32 v[190:191],v[206:207],s[78:79] op_sel_hi:[1,0] neg_lo:[0,1] neg_hi:[0,1]
v_pk_add_f32 v[192:193],v[184:185],v[186:187]
v_pk_mul_f32 v[194:195],v[184:185],v[184:185]
v_pk_add_f32 v[196:197],v[188:189],v[190:191]
v_pk_fma_f32 v[194:195],v[186:187],v[186:187],v[194:195]
v_pk_add_f32 v[192:193],v[192:193],v[196:197]
v_pk_fma_f32 v[194:195],v[188:189],v[188:189],v[194:195]
v_add_f32 v192,v192,v193
v_pk_fma_f32 v[194:195],v[190:191],v[190:191],v[194:195]
v_add_f32 v194,v194,v195
s_nop 1
v_permlane32_swap_b32 v192,v194
v_add_f32 v192,v192,v194
s_nop 1
v_add_f32_dpp v192,v192,v192 row_ror:8 row_mask:0xf bank_mask:0xf
s_nop 1
v_add_f32_dpp v192,v192,v192 row_ror:4 row_mask:0xf bank_mask:0xf
s_nop 1
v_add_f32_dpp v192,v192,v192 row_ror:2 row_mask:0xf bank_mask:0xf
s_nop 1
v_add_f32_dpp v192,v192,v192 row_ror:1 row_mask:0xf bank_mask:0xf
v_mov_b32 v194,v192
s_nop 1
v_permlane16_swap_b32 v192,v194
v_add_f32 v192,v192,v194
v_mul_f32 v192,0x3b000000,v192
v_mov_b32 v194,v192
s_nop 1
v_permlane32_swap_b32 v192,v194
v_fma_f32 v194,-v192,v192,v194
v_add_f32 v192,s78,v192
v_max_f32 v194,0,v194
v_cvt_pk_bf16_f32 v194,v192,v194
v_lshlrev_b32 v192,16,v194
v_and_b32 v194,0xffff0000,v194
v_add_f32 v194,0x3727c5ac,v194
v_cvt_pk_bf16_f32 v194,v194,v194
v_and_b32 v194,0xffff0000,v194
v_sqrt_f32 v194,v194
v_pk_add_f32 v[184:185],v[200:201],v[192:193] op_sel_hi:[1,0] neg_lo:[0,1] neg_hi:[0,1]
v_pk_add_f32 v[186:187],v[202:203],v[192:193] op_sel_hi:[1,0] neg_lo:[0,1] neg_hi:[0,1]
v_pk_add_f32 v[188:189],v[204:205],v[192:193] op_sel_hi:[1,0] neg_lo:[0,1] neg_hi:[0,1]
v_pk_add_f32 v[190:191],v[206:207],v[192:193] op_sel_hi:[1,0] neg_lo:[0,1] neg_hi:[0,1]
v_cvt_pk_bf16_f32 v194,v194,v194
v_and_b32 v194,0xffff0000,v194
v_rcp_f32 v194,v194
v_cvt_pk_bf16_f32 v172,v184,v185
v_cvt_pk_bf16_f32 v173,v186,v187
v_cvt_pk_bf16_f32 v174,v188,v189
v_cvt_pk_bf16_f32 v175,v190,v191
v_lshlrev_b32 v184,16,v172
v_and_b32 v185,0xffff0000,v172
v_lshlrev_b32 v186,16,v173
v_and_b32 v187,0xffff0000,v173
v_lshlrev_b32 v188,16,v174
v_and_b32 v189,0xffff0000,v174
v_lshlrev_b32 v190,16,v175
v_and_b32 v191,0xffff0000,v175
v_pk_mul_f32 v[184:185],v[184:185],v[194:195] op_sel_hi:[1,0]
v_pk_mul_f32 v[186:187],v[186:187],v[194:195] op_sel_hi:[1,0]
v_pk_mul_f32 v[188:189],v[188:189],v[194:195] op_sel_hi:[1,0]
v_pk_mul_f32 v[190:191],v[190:191],v[194:195] op_sel_hi:[1,0]
v_cvt_pk_bf16_f32 v172,v184,v185
v_cvt_pk_bf16_f32 v173,v186,v187
v_cvt_pk_bf16_f32 v174,v188,v189
v_cvt_pk_bf16_f32 v175,v190,v191
v_lshlrev_b32 v176,16,v172
v_and_b32 v177,0xffff0000,v172
v_lshlrev_b32 v178,16,v173
v_and_b32 v179,0xffff0000,v173
v_lshlrev_b32 v180,16,v174
v_and_b32 v181,0xffff0000,v174
v_lshlrev_b32 v182,16,v175
v_and_b32 v183,0xffff0000,v175
v_pk_mul_f32 v[236:237],v[176:177],v[228:229]
v_pk_fma_f32 v[236:237],v[178:179],v[230:231],v[236:237]
v_pk_fma_f32 v[236:237],v[180:181],v[232:233],v[236:237]
v_pk_fma_f32 v[236:237],v[182:183],v[234:235],v[236:237]
v_add_f32 v236,v236,v237
s_nop 1
v_add_f32_dpp v236,v236,v236 row_ror:8 row_mask:0xf bank_mask:0xf
s_nop 1
v_add_f32_dpp v236,v236,v236 row_ror:4 row_mask:0xf bank_mask:0xf
s_nop 1
v_add_f32_dpp v236,v236,v236 row_ror:2 row_mask:0xf bank_mask:0xf
s_nop 1
v_add_f32_dpp v236,v236,v236 row_ror:1 row_mask:0xf bank_mask:0xf
v_mov_b32 v237,v236
s_nop 1
v_permlane16_swap_b32 v236,v237
v_add_f32 v236,v236,v237
v_mov_b32 v237,v236
s_nop 1
v_permlane32_swap_b32 v236,v237
v_add_f32 v236,v236,v237
v_cvt_pk_bf16_f32 v236,v236,v236
v_and_b32 v236,0xffff0000,v236
v_ashrrev_i32 v237,31,v236
v_or_b32 v237,0x80000000,v237
v_xor_b32 v236,v236,v237
v_and_b32 v236,0xffff0000,v236
s_sub_u32 s20,4095,s18
v_or_b32 v20,s20,v236
s_lshl_b32 s20,s51,13
s_lshl2_add_u32 s20,s68,s20
s_add_u32 s20,s20,10485760
buffer_store_dword v20,v254,s[8:11],s20 offen sc1
s_branch L_aa_286
L_ar_311:
s_bitcmp1_b32 s46,0
s_cbranch_scc1 L_aa_286
ds_read_b128 v[160:163],v23
ds_read_b128 v[164:167],v23 offset:16
v_lshlrev_b32 v200,16,v224
v_and_b32 v201,0xffff0000,v224
v_lshlrev_b32 v202,16,v225
v_and_b32 v203,0xffff0000,v225
v_lshlrev_b32 v204,16,v226
v_and_b32 v205,0xffff0000,v226
v_lshlrev_b32 v206,16,v227
v_and_b32 v207,0xffff0000,v227
v_readfirstlane_b32 s22,v246
s_cmp_eq_u32 s22,0
s_cbranch_scc1 L_ag_312
L_agb_313:
s_lshl_b32 s18,s51,5
s_add_u32 s18,s18,s68
s_lshl_b32 s19,s18,10
s_add_u32 s20,s19,6291456
s_waitcnt lgkmcnt(0)
v_cvt_pk_bf16_f32 v168,v160,v161
v_cvt_pk_bf16_f32 v169,v162,v163
v_cvt_pk_bf16_f32 v170,v164,v165
v_cvt_pk_bf16_f32 v171,v166,v167
v_lshlrev_b32 v160,16,v168
v_and_b32 v161,0xffff0000,v168
v_lshlrev_b32 v162,16,v169
v_and_b32 v163,0xffff0000,v169
v_lshlrev_b32 v164,16,v170
v_and_b32 v165,0xffff0000,v170
v_lshlrev_b32 v166,16,v171
v_and_b32 v167,0xffff0000,v171
v_pk_add_f32 v[200:201],v[200:201],v[160:161]
v_pk_add_f32 v[202:203],v[202:203],v[162:163]
v_pk_add_f32 v[204:205],v[204:205],v[164:165]
v_pk_add_f32 v[206:207],v[206:207],v[166:167]
v_cvt_pk_bf16_f32 v168,v200,v201
v_cvt_pk_bf16_f32 v169,v202,v203
v_cvt_pk_bf16_f32 v170,v204,v205
v_cvt_pk_bf16_f32 v171,v206,v207
buffer_store_dwordx4 v[168:171],v0,s[8:11],s20 offen sc1
v_lshlrev_b32 v200,16,v168
v_and_b32 v201,0xffff0000,v168
v_lshlrev_b32 v202,16,v169
v_and_b32 v203,0xffff0000,v169
v_lshlrev_b32 v204,16,v170
v_and_b32 v205,0xffff0000,v170
v_lshlrev_b32 v206,16,v171
v_and_b32 v207,0xffff0000,v171
v_readfirstlane_b32 s78,v200
s_nop 1
v_pk_add_f32 v[184:185],v[200:201],s[78:79] op_sel_hi:[1,0] neg_lo:[0,1] neg_hi:[0,1]
v_pk_add_f32 v[186:187],v[202:203],s[78:79] op_sel_hi:[1,0] neg_lo:[0,1] neg_hi:[0,1]
v_pk_add_f32 v[188:189],v[204:205],s[78:79] op_sel_hi:[1,0] neg_lo:[0,1] neg_hi:[0,1]
v_pk_add_f32 v[190:191],v[206:207],s[78:79] op_sel_hi:[1,0] neg_lo:[0,1] neg_hi:[0,1]
v_pk_add_f32 v[192:193],v[184:185],v[186:187]
v_pk_mul_f32 v[194:195],v[184:185],v[184:185]
v_pk_add_f32 v[196:197],v[188:189],v[190:191]
v_pk_fma_f32 v[194:195],v[186:187],v[186:187],v[194:195]
v_pk_add_f32 v[192:193],v[192:193],v[196:197]
v_pk_fma_f32 v[194:195],v[188:189],v[188:189],v[194:195]
v_add_f32 v192,v192,v193
v_pk_fma_f32 v[194:195],v[190:191],v[190:191],v[194:195]
v_add_f32 v194,v194,v195
s_nop 1
v_permlane32_swap_b32 v192,v194
v_add_f32 v192,v192,v194
s_nop 1
v_add_f32_dpp v192,v192,v192 row_ror:8 row_mask:0xf bank_mask:0xf
s_nop 1
v_add_f32_dpp v192,v192,v192 row_ror:4 row_mask:0xf bank_mask:0xf
s_nop 1
v_add_f32_dpp v192,v192,v192 row_ror:2 row_mask:0xf bank_mask:0xf
s_nop 1
v_add_f32_dpp v192,v192,v192 row_ror:1 row_mask:0xf bank_mask:0xf
v_mov_b32 v194,v192
s_nop 1
v_permlane16_swap_b32 v192,v194
v_add_f32 v192,v192,v194
v_mul_f32 v192,0x3b000000,v192
v_mov_b32 v194,v192
s_nop 1
v_permlane32_swap_b32 v192,v194
v_fma_f32 v194,-v192,v192,v194
v_add_f32 v192,s78,v192
v_max_f32 v194,0,v194
v_cvt_pk_bf16_f32 v194,v192,v194
v_lshlrev_b32 v192,16,v194
v_and_b32 v194,0xffff0000,v194
v_add_f32 v194,0x3727c5ac,v194
v_cvt_pk_bf16_f32 v194,v194,v194
v_and_b32 v194,0xffff0000,v194
v_sqrt_f32 v194,v194
v_pk_add_f32 v[184:185],v[200:201],v[192:193] op_sel_hi:[1,0] neg_lo:[0,1] neg_hi:[0,1]
v_pk_add_f32 v[186:187],v[202:203],v[192:193] op_sel_hi:[1,0] neg_lo:[0,1] neg_hi:[0,1]
v_pk_add_f32 v[188:189],v[204:205],v[192:193] op_sel_hi:[1,0] neg_lo:[0,1] neg_hi:[0,1]
v_pk_add_f32 v[190:191],v[206:207],v[192:193] op_sel_hi:[1,0] neg_lo:[0,1] neg_hi:[0,1]
v_cvt_pk_bf16_f32 v194,v194,v194
v_and_b32 v194,0xffff0000,v194
v_rcp_f32 v194,v194
v_cvt_pk_bf16_f32 v172,v184,v185
v_cvt_pk_bf16_f32 v173,v186,v187
v_cvt_pk_bf16_f32 v174,v188,v189
v_cvt_pk_bf16_f32 v175,v190,v191
v_lshlrev_b32 v184,16,v172
v_and_b32 v185,0xffff0000,v172
v_lshlrev_b32 v186,16,v173
v_and_b32 v187,0xffff0000,v173
v_lshlrev_b32 v188,16,v174
v_and_b32 v189,0xffff0000,v174
v_lshlrev_b32 v190,16,v175
v_and_b32 v191,0xffff0000,v175
v_pk_mul_f32 v[184:185],v[184:185],v[194:195] op_sel_hi:[1,0]
v_pk_mul_f32 v[186:187],v[186:187],v[194:195] op_sel_hi:[1,0]
v_pk_mul_f32 v[188:189],v[188:189],v[194:195] op_sel_hi:[1,0]
v_pk_mul_f32 v[190:191],v[190:191],v[194:195] op_sel_hi:[1,0]
v_cvt_pk_bf16_f32 v172,v184,v185
v_cvt_pk_bf16_f32 v173,v186,v187
v_cvt_pk_bf16_f32 v174,v188,v189
v_cvt_pk_bf16_f32 v175,v190,v191
v_lshlrev_b32 v176,16,v172
v_and_b32 v177,0xffff0000,v172
v_lshlrev_b32 v178,16,v173
v_and_b32 v179,0xffff0000,v173
v_lshlrev_b32 v180,16,v174
v_and_b32 v181,0xffff0000,v174
v_lshlrev_b32 v182,16,v175
v_and_b32 v183,0xffff0000,v175
v_pk_add_f32 v[200:201],v[200:201],v[176:177]
v_pk_add_f32 v[202:203],v[202:203],v[178:179]
v_pk_add_f32 v[204:205],v[204:205],v[180:181]
v_pk_add_f32 v[206:207],v[206:207],v[182:183]
v_cvt_pk_bf16_f32 v160,v200,v201
v_cvt_pk_bf16_f32 v161,v202,v203
v_cvt_pk_bf16_f32 v162,v204,v205
v_cvt_pk_bf16_f32 v163,v206,v207
buffer_store_dwordx4 v[160:163],v0,s[12:15],s19 offen sc1
v_pk_mul_f32 v[236:237],v[176:177],v[228:229]
v_pk_fma_f32 v[236:237],v[178:179],v[230:231],v[236:237]
v_pk_fma_f32 v[236:237],v[180:181],v[232:233],v[236:237]
v_pk_fma_f32 v[236:237],v[182:183],v[234:235],v[236:237]
v_add_f32 v236,v236,v237
s_nop 1
v_add_f32_dpp v236,v236,v236 row_ror:8 row_mask:0xf bank_mask:0xf
s_nop 1
v_add_f32_dpp v236,v236,v236 row_ror:4 row_mask:0xf bank_mask:0xf
s_nop 1
v_add_f32_dpp v236,v236,v236 row_ror:2 row_mask:0xf bank_mask:0xf
s_nop 1
v_add_f32_dpp v236,v236,v236 row_ror:1 row_mask:0xf bank_mask:0xf
v_mov_b32 v237,v236
s_nop 1
v_permlane16_swap_b32 v236,v237
v_add_f32 v236,v236,v237
v_mov_b32 v237,v236
s_nop 1
v_permlane32_swap_b32 v236,v237
v_add_f32 v236,v236,v237
v_cvt_pk_bf16_f32 v236,v236,v236
v_and_b32 v236,0xffff0000,v236
v_ashrrev_i32 v237,31,v236
v_or_b32 v237,0x80000000,v237
v_xor_b32 v236,v236,v237
v_and_b32 v236,0xffff0000,v236
s_sub_u32 s20,4095,s18
v_or_b32 v20,s20,v236
s_lshl_b32 s73,s51,13
s_lshl2_add_u32 s73,s68,s73
s_add_u32 s73,s73,10485760
s_add_u32 s73,s73,s86
L_aa_286:
s_cmp_eq_u32 s27,1
s_cbranch_scc1 L_ad_314
s_cmp_eq_u32 s27,0
s_cbranch_scc1 L_aa_287
s_cmp_ge_u32 s77,64
s_cbranch_scc1 L_aa_290
L_aa_288:
s_waitcnt vmcnt(0)
buffer_store_dword v20,off,s[8:11],s73 sc1
s_mov_b32 s73,0x80000000
v_mov_b32 v18,0
s_mov_b32 s27,0
L_aw_315:
v_cmp_eq_u32 vcc,0,v18
s_cbranch_vccz L_awd_316
buffer_load_dword v18,v19,s[8:11],0 offen sc1
s_sub_u32 s49,s49,1
s_cbranch_scc1 L_abort2
s_waitcnt vmcnt(0)
s_branch L_aw_315
L_awd_316:
s_mov_b32 s64,s70
s_mov_b32 s65,s71
s_and_b32 s57,s46,1
s_mul_i32 s58,s57,12288
s_add_u32 s64,s64,s58
s_lshl_b32 s57,s57,11
s_add_u32 s65,s65,s57
s_and_b32 s59,s50,2048
s_lshl_b32 s59,s59,4
s_xor_b32 s60,s67,65536
s_add_u32 s59,s59,s60
s_add_u32 s58,s58,s59
s_add_u32 s57,s57,s59
s_add_u32 m0,s58,0
s_nop 0
buffer_load_dwordx4 v0,s[8:11],s64 offen offset:0 sc1 lds
buffer_load_dwordx4 v0,s[8:11],s64 offen offset:1024 sc1 lds
buffer_load_dwordx4 v0,s[8:11],s64 offen offset:2048 sc1 lds
buffer_load_dwordx4 v0,s[8:11],s64 offen offset:3072 sc1 lds
s_add_u32 m0,s58,4096
s_add_u32 s64,s64,4096
buffer_load_dwordx4 v0,s[8:11],s64 offen offset:0 sc1 lds
buffer_load_dwordx4 v0,s[8:11],s64 offen offset:1024 sc1 lds
buffer_load_dwordx4 v0,s[8:11],s64 offen offset:2048 sc1 lds
buffer_load_dwordx4 v0,s[8:11],s64 offen offset:3072 sc1 lds
s_add_u32 m0,s58,8192
s_add_u32 s64,s64,4096
buffer_load_dwordx4 v0,s[8:11],s64 offen offset:0 sc1 lds
buffer_load_dwordx4 v0,s[8:11],s64 offen offset:1024 sc1 lds
buffer_load_dwordx4 v0,s[8:11],s64 offen offset:2048 sc1 lds
buffer_load_dwordx4 v0,s[8:11],s64 offen offset:3072 sc1 lds
s_add_u32 m0,s57,24576
s_nop 0
buffer_load_dwordx4 v0,s[8:11],s65 offen offset:0 sc1 lds
buffer_load_dwordx4 v0,s[8:11],s65 offen offset:1024 sc1 lds
v_lshrrev_b32 v244,4,v1
s_sub_u32 s56,s77,8
v_add_u32 v244,s56,v244
v_max_i32 v244,0,v244
v_lshl_add_u32 v244,v244,13,v21
buffer_load_dwordx2 v[242:243],v244,s[8:11],0 offen sc1
s_waitcnt vmcnt(0) lgkmcnt(0)
s_barrier
s_xor_b32 s67,s67,65536
s_and_b32 s56,s50,2048
s_lshl_b32 s56,s56,4
s_add_u32 s56,s56,s67
v_add_u32 v2,s56,v0
v_add_u32 v239,s56,v253
s_and_b32 s56,s50,1024
s_lshl_b32 s56,s56,2
v_add_u32 v238,s56,v2
s_mov_b32 s76,s71
s_mov_b32 s53,s77
ds_read_b128 v[24:27],v238 offset:16384
ds_read_b128 v[40:43],v2 offset:0
ds_read_b128 v[56:59],v2 offset:4096
ds_read_b128 v[28:31],v238 offset:17408
ds_read_b128 v[44:47],v2 offset:1024
ds_read_b128 v[60:63],v2 offset:5120
ds_read_b128 v[32:35],v238 offset:18432
ds_read_b128 v[48:51],v2 offset:2048
ds_read_b128 v[64:67],v2 offset:6144
ds_read_b128 v[36:39],v238 offset:19456
ds_read_b128 v[52:55],v2 offset:3072
ds_read_b128 v[68:71],v2 offset:7168
s_waitcnt lgkmcnt(9)
v_mfma_f32_16x16x32_bf16 v[128:131],v[40:43],v[24:27],v[8:11]
ds_read_b128 v[72:75],v2 offset:24576
v_mfma_f32_16x16x32_bf16 v[132:135],v[56:59],v[24:27],v[12:15]
ds_read_b128 v[76:79],v2 offset:25600
s_waitcnt lgkmcnt(8)
v_mfma_f32_16x16x32_bf16 v[128:131],v[44:47],v[28:31],v[128:131]
ds_read_b128 v[80:83],v2 offset:26624
v_mfma_f32_16x16x32_bf16 v[132:135],v[60:63],v[28:31],v[132:135]
ds_read_b128 v[84:87],v2 offset:27648
s_waitcnt lgkmcnt(7)
v_mfma_f32_16x16x32_bf16 v[128:131],v[48:51],v[32:35],v[128:131]
ds_read_b64 v[120:121],v239 offset:24576
v_mfma_f32_16x16x32_bf16 v[132:135],v[64:67],v[32:35],v[132:135]
ds_read_b64 v[122:123],v239 offset:25600
s_waitcnt lgkmcnt(6)
v_mfma_f32_16x16x32_bf16 v[128:131],v[52:55],v[36:39],v[128:131]
ds_read_b64 v[124:125],v239 offset:26624
v_mfma_f32_16x16x32_bf16 v[132:135],v[68:71],v[36:39],v[132:135]
ds_read_b64 v[126:127],v239 offset:27648
s_waitcnt lgkmcnt(4)
v_mfma_f32_16x16x32_bf16 v[136:139],v[72:75],v[24:27],0
ds_read_b128 v[88:91],v2 offset:8192
ds_read_b128 v[92:95],v2 offset:9216
v_mfma_f32_16x16x32_bf16 v[136:139],v[76:79],v[28:31],v[136:139]
ds_read_b128 v[96:99],v2 offset:10240
ds_read_b128 v[100:103],v2 offset:11264
v_mfma_f32_16x16x32_bf16 v[136:139],v[80:83],v[32:35],v[136:139]
ds_read_b128 v[104:107],v2 offset:12288
ds_read_b128 v[108:111],v2 offset:13312
v_mfma_f32_16x16x32_bf16 v[136:139],v[84:87],v[36:39],v[136:139]
ds_read_b128 v[112:115],v2 offset:14336
ds_read_b128 v[116:119],v2 offset:15360
s_waitcnt lgkmcnt(0)
s_cmp_eq_u32 s30,0
s_cbranch_scc1 L_aa_289
s_cmp_lg_u32 s86,1536
s_cbranch_scc1 L_ae_317
s_mov_b32 s77,s35
s_mov_b32 s30,0
s_lshl_b32 s56,s77,5
s_add_u32 s56,s56,s68
s_mul_i32 s70,s56,24576
s_lshl_b32 s71,s56,12
s_lshl_b32 s59,s77,13
s_lshl2_add_u32 s59,s68,s59
s_add_u32 s59,s59,10485760
s_buffer_load_dword s32,s[8:11],s59
s_mov_b32 s33,1
s_add_u32 s70,s70,100663296
s_add_u32 s71,s71,41943040
v_mov_b32 v19,s59
s_branch L_af_318
L_ae_317:
s_ff1_i32_b64 s77,s[84:85]
s_bitset0_b64 s[84:85],s77
s_min_u32 s77,s77,64
s_lshr_b32 s61,s55,5
s_lshl_b32 s56,s77,5
s_add_u32 s56,s56,s68
s_mul_i32 s70,s56,24576
s_lshl_b32 s71,s56,12
s_lshl_b32 s59,s77,13
s_lshl2_add_u32 s59,s68,s59
s_add_u32 s59,s59,10486144
s_cmp_lt_u32 s77,s61
s_cselect_b32 s57,0,16777216
s_cselect_b32 s60,0,128
s_add_u32 s60,s60,s59
s_add_u32 s60,s60,128
s_buffer_load_dword s33,s[8:11],s60
s_add_u32 s71,s71,s57
s_add_u32 s71,s71,58720256
s_cmp_eq_u32 s77,s61
s_cselect_b32 s57,50331648,0
s_cselect_b32 s58,1536,0
s_add_u32 s59,s59,s58
s_buffer_load_dword s32,s[8:11],s59
s_add_u32 s70,s70,s57
s_add_u32 s70,s70,150994944
v_mov_b32 v19,s59
v_writelane_b32 v19,s60,1
L_af_318:
v_max3_f32 v238,v128,v129,v130
v_max3_f32 v239,v131,v132,v133
v_max3_f32 v238,v134,v135,v238
v_max3_f32 v239,v138,v139,v239
v_max_f32 v238,v238,v239
v_max_f32 v239,v238,v239
s_nop 1
v_permlane16_swap_b32 v238,v239
v_max_f32 v238,v238,v239
v_max_f32 v239,v238,v239
s_nop 1
v_permlane32_swap_b32 v238,v239
v_max_f32 v238,v238,v239
v_mul_f32 v238,s80,v238
v_fma_f32 v128,v128,s80,-v238
v_fma_f32 v129,v129,s80,-v238
v_exp_f32 v128,v128
v_fma_f32 v130,v130,s80,-v238
v_exp_f32 v129,v129
v_fma_f32 v131,v131,s80,-v238
v_exp_f32 v130,v130
v_fma_f32 v132,v132,s80,-v238
v_exp_f32 v131,v131
v_fma_f32 v133,v133,s80,-v238
v_exp_f32 v132,v132
v_fma_f32 v134,v134,s80,-v238
v_exp_f32 v133,v133
v_fma_f32 v135,v135,s80,-v238
v_exp_f32 v134,v134
v_fma_f32 v138,v138,s80,-v238
v_exp_f32 v135,v135
v_fma_f32 v139,v139,s80,-v238
v_exp_f32 v138,v138
v_exp_f32 v139,v139
v_cvt_pk_bf16_f32 v140,v128,v129
v_cvt_pk_bf16_f32 v141,v130,v131
v_cvt_pk_bf16_f32 v142,v132,v133
v_cvt_pk_bf16_f32 v143,v134,v135
v_cvt_pk_bf16_f32 v144,v138,v139
v_mov_b32 v147,v144
v_mfma_f32_16x16x32_bf16 v[148:151],v[152:155],v[140:143],0
v_mfma_f32_16x16x32_bf16 v[24:27],v[88:91],v[140:143],0
v_mfma_f32_16x16x32_bf16 v[28:31],v[92:95],v[140:143],0
v_mfma_f32_16x16x16_bf16 v[148:151],v[152:153],v[144:145],v[148:151]
v_mfma_f32_16x16x32_bf16 v[32:35],v[96:99],v[140:143],0
v_mfma_f32_16x16x32_bf16 v[36:39],v[100:103],v[140:143],0
v_mfma_f32_16x16x32_bf16 v[40:43],v[104:107],v[140:143],0
v_mfma_f32_16x16x32_bf16 v[44:47],v[108:111],v[140:143],0
v_mfma_f32_16x16x32_bf16 v[48:51],v[112:115],v[140:143],0
v_mfma_f32_16x16x32_bf16 v[52:55],v[116:119],v[140:143],0
v_rcp_f32 v148,v148
v_mfma_f32_16x16x16_bf16 v[24:27],v[120:121],v[144:145],v[24:27]
v_mfma_f32_16x16x16_bf16 v[28:31],v[120:121],v[146:147],v[28:31]
v_mfma_f32_16x16x16_bf16 v[32:35],v[122:123],v[144:145],v[32:35]
v_mfma_f32_16x16x16_bf16 v[36:39],v[122:123],v[146:147],v[36:39]
v_mfma_f32_16x16x16_bf16 v[40:43],v[124:125],v[144:145],v[40:43]
v_pk_mul_f32 v[24:25],v[24:25],v[148:149] op_sel_hi:[1,0]
v_pk_mul_f32 v[26:27],v[26:27],v[148:149] op_sel_hi:[1,0]
v_mfma_f32_16x16x16_bf16 v[44:47],v[124:125],v[146:147],v[44:47]
v_pk_mul_f32 v[28:29],v[28:29],v[148:149] op_sel_hi:[1,0]
v_pk_mul_f32 v[30:31],v[30:31],v[148:149] op_sel_hi:[1,0]
v_mfma_f32_16x16x16_bf16 v[48:51],v[126:127],v[144:145],v[48:51]
v_cvt_pk_bf16_f32 v72,v24,v28
v_cvt_pk_bf16_f32 v73,v25,v29
v_mfma_f32_16x16x16_bf16 v[52:55],v[126:127],v[146:147],v[52:55]
v_cvt_pk_bf16_f32 v74,v26,v30
v_cvt_pk_bf16_f32 v75,v27,v31
ds_write_b128 v3,v[72:75] offset:0
v_pk_mul_f32 v[32:33],v[32:33],v[148:149] op_sel_hi:[1,0]
v_pk_mul_f32 v[34:35],v[34:35],v[148:149] op_sel_hi:[1,0]
v_pk_mul_f32 v[36:37],v[36:37],v[148:149] op_sel_hi:[1,0]
v_pk_mul_f32 v[38:39],v[38:39],v[148:149] op_sel_hi:[1,0]
v_cvt_pk_bf16_f32 v76,v32,v36
v_cvt_pk_bf16_f32 v77,v33,v37
v_cvt_pk_bf16_f32 v78,v34,v38
v_cvt_pk_bf16_f32 v79,v35,v39
ds_write_b128 v3,v[76:79] offset:1024
v_pk_mul_f32 v[40:41],v[40:41],v[148:149] op_sel_hi:[1,0]
v_pk_mul_f32 v[42:43],v[42:43],v[148:149] op_sel_hi:[1,0]
v_pk_mul_f32 v[44:45],v[44:45],v[148:149] op_sel_hi:[1,0]
v_pk_mul_f32 v[46:47],v[46:47],v[148:149] op_sel_hi:[1,0]
v_cvt_pk_bf16_f32 v80,v40,v44
v_cvt_pk_bf16_f32 v81,v41,v45
v_cvt_pk_bf16_f32 v82,v42,v46
v_cvt_pk_bf16_f32 v83,v43,v47
ds_write_b128 v3,v[80:83] offset:2048
v_pk_mul_f32 v[48:49],v[48:49],v[148:149] op_sel_hi:[1,0]
v_pk_mul_f32 v[50:51],v[50:51],v[148:149] op_sel_hi:[1,0]
v_pk_mul_f32 v[52:53],v[52:53],v[148:149] op_sel_hi:[1,0]
v_pk_mul_f32 v[54:55],v[54:55],v[148:149] op_sel_hi:[1,0]
v_cvt_pk_bf16_f32 v84,v48,v52
v_cvt_pk_bf16_f32 v85,v49,v53
v_cvt_pk_bf16_f32 v86,v50,v54
v_cvt_pk_bf16_f32 v87,v51,v55
ds_write_b128 v3,v[84:87] offset:3072
s_waitcnt lgkmcnt(0)
s_barrier
L_ad_314:
s_mov_b32 s51,s53
s_mov_b32 s31,1
s_branch L_aa_281
L_aa_287:
s_waitcnt vmcnt(0)
buffer_store_dword v20,off,s[8:11],s73 sc1
s_mov_b32 s73,0x80000000
L_aa_289:
s_mov_b32 s51,s53
s_mov_b32 s31,0
s_add_u32 s35,s53,4
s_cmp_lt_u32 s53,5
s_cbranch_scc1 L_ab_319
s_cmp_ge_u32 s53,62
s_cbranch_scc1 L_am_321
L_aw_322:
v_min_u32 v239,v242,v243
v_cmp_eq_u32 vcc,0,v239
s_cbranch_vccz L_awd_323
s_sleep 4
buffer_load_dwordx2 v[242:243],v244,s[8:11],0 offen sc1
s_sub_u32 s49,s49,1
s_cbranch_scc1 L_abort2
s_waitcnt vmcnt(0)
s_branch L_aw_322
L_awd_323:
v_max_u32 v242,v242,v243
s_nop 1
v_max_u32_dpp v242,v242,v242 row_ror:8 row_mask:0xf bank_mask:0xf
s_nop 1
v_max_u32_dpp v242,v242,v242 row_ror:4 row_mask:0xf bank_mask:0xf
s_nop 1
v_max_u32_dpp v242,v242,v242 row_ror:2 row_mask:0xf bank_mask:0xf
s_nop 1
v_max_u32_dpp v242,v242,v242 row_ror:1 row_mask:0xf bank_mask:0xf
v_mov_b32 v243,v242
s_nop 1
v_permlane16_swap_b32 v242,v243
v_max_u32 v242,v242,v243
v_mov_b32 v243,v242
s_nop 1
v_permlane32_swap_b32 v242,v243
v_max_u32 v242,v242,v243
s_nop 0
v_readfirstlane_b32 s56,v242
v_readlane_b32 s57,v255,s53
s_max_u32 s75,s75,s56
s_cmp_lt_u32 s53,11
s_cbranch_scc1 L_ab_319
s_mov_b32 s77,s36
s_and_b32 s55,s75,0x7ff
s_sub_u32 s55,2047,s55
s_cmp_lt_u32 s75,s57
s_cselect_b32 s55,4095,s55
s_lshr_b32 s61,s55,5
s_mov_b32 s30,1
s_lshl_b32 s56,s77,5
s_add_u32 s56,s56,s68
s_mul_i32 s70,s56,24576
s_lshl_b32 s71,s56,12
s_lshl_b32 s59,s77,13
s_lshl2_add_u32 s59,s68,s59
s_add_u32 s59,s59,10486144
s_cmp_lt_u32 s77,s61
s_cselect_b32 s57,0,16777216
s_cselect_b32 s60,0,128
s_add_u32 s60,s60,s59
s_add_u32 s60,s60,128
s_add_u32 s71,s71,s57
s_add_u32 s71,s71,58720256
s_cmp_eq_u32 s77,s61
s_cselect_b32 s57,50331648,0
s_cselect_b32 s58,1536,0
s_add_u32 s59,s59,s58
s_add_u32 s70,s70,s57
s_add_u32 s70,s70,150994944
v_mov_b32 v19,s59
v_writelane_b32 v19,s60,1
s_branch L_aj_320
L_ab_319:
s_mov_b32 s77,s35
s_mov_b32 s30,0
s_lshl_b32 s56,s77,5
s_add_u32 s56,s56,s68
s_mul_i32 s70,s56,24576
s_lshl_b32 s71,s56,12
s_lshl_b32 s59,s77,13
s_lshl2_add_u32 s59,s68,s59
s_add_u32 s59,s59,10485760
s_mov_b32 s33,1
s_add_u32 s70,s70,100663296
s_add_u32 s71,s71,41943040
v_mov_b32 v19,s59
L_aj_320:
buffer_load_dword v18,v19,s[8:11],0 offen sc1
v_mfma_f32_16x16x32_bf16 v[136:139],v[72:75],v[24:27],0
v_max3_u32 v238,v72,v73,v74
v_max3_u32 v238,v74,v75,v238
v_mfma_f32_16x16x32_bf16 v[136:139],v[76:79],v[28:31],v[136:139]
v_max3_u32 v238,v76,v77,v238
v_max3_u32 v238,v78,v79,v238
v_mfma_f32_16x16x32_bf16 v[136:139],v[80:83],v[32:35],v[136:139]
v_max3_u32 v238,v80,v81,v238
v_max3_u32 v238,v82,v83,v238
v_mfma_f32_16x16x32_bf16 v[136:139],v[84:87],v[36:39],v[136:139]
v_max3_u32 v238,v84,v85,v238
v_max3_u32 v238,v86,v87,v238
v_max3_u32 v238,v120,v121,v238
v_max3_u32 v238,v122,v123,v238
v_max3_u32 v238,v124,v125,v238
v_max3_u32 v238,v126,v127,v238
v_cmp_eq_u32 vcc,-1,v238
s_cbranch_vccz L_aa_292
L_aa_291:
buffer_load_dwordx4 v[72:75],v0,s[8:11],s76 offen offset:0 sc1
buffer_load_dwordx4 v[76:79],v0,s[8:11],s76 offen offset:1024 sc1
buffer_load_dwordx4 v[80:83],v0,s[8:11],s76 offen offset:2048 sc1
buffer_load_dwordx4 v[84:87],v0,s[8:11],s76 offen offset:3072 sc1
buffer_load_dwordx2 v[120:121],v253,s[8:11],s76 offen offset:0 sc1
buffer_load_dwordx2 v[122:123],v253,s[8:11],s76 offen offset:1024 sc1
buffer_load_dwordx2 v[124:125],v253,s[8:11],s76 offen offset:2048 sc1
buffer_load_dwordx2 v[126:127],v253,s[8:11],s76 offen offset:3072 sc1
buffer_load_dword v18,v19,s[8:11],0 offen sc1
s_sub_u32 s49,s49,1
s_cbranch_scc1 L_abort2
s_waitcnt vmcnt(8)
v_mfma_f32_16x16x32_bf16 v[136:139],v[72:75],v[24:27],0
v_max3_u32 v238,v72,v73,v74
v_max3_u32 v238,v74,v75,v238
s_waitcnt vmcnt(7)
v_mfma_f32_16x16x32_bf16 v[136:139],v[76:79],v[28:31],v[136:139]
v_max3_u32 v238,v76,v77,v238
v_max3_u32 v238,v78,v79,v238
s_waitcnt vmcnt(6)
v_mfma_f32_16x16x32_bf16 v[136:139],v[80:83],v[32:35],v[136:139]
v_max3_u32 v238,v80,v81,v238
v_max3_u32 v238,v82,v83,v238
s_waitcnt vmcnt(5)
v_mfma_f32_16x16x32_bf16 v[136:139],v[84:87],v[36:39],v[136:139]
v_max3_u32 v238,v84,v85,v238
v_max3_u32 v238,v86,v87,v238
s_waitcnt vmcnt(1)
v_max3_u32 v238,v120,v121,v238
v_max3_u32 v238,v122,v123,v238
v_max3_u32 v238,v124,v125,v238
v_max3_u32 v238,v126,v127,v238
v_cmp_eq_u32 vcc,-1,v238
s_cbranch_vccnz L_aa_291
L_aa_292:
s_cmp_lg_u32 s27,3
s_cbranch_scc1 L_ai_324
v_max3_f32 v238,v128,v129,v130
v_max3_f32 v239,v131,v132,v133
v_max3_f32 v238,v134,v135,v238
v_max3_f32 v239,v138,v139,v239
v_max_f32 v238,v238,v239
v_max_f32 v239,v238,v239
s_nop 1
v_permlane16_swap_b32 v238,v239
v_max_f32 v238,v238,v239
v_max_f32 v239,v238,v239
s_nop 1
v_permlane32_swap_b32 v238,v239
v_max_f32 v238,v238,v239
v_mul_f32 v238,s80,v238
v_fma_f32 v128,v128,s80,-v238
v_fma_f32 v129,v129,s80,-v238
v_exp_f32 v128,v128
v_fma_f32 v130,v130,s80,-v238
v_exp_f32 v129,v129
v_fma_f32 v131,v131,s80,-v238
v_exp_f32 v130,v130
v_fma_f32 v132,v132,s80,-v238
v_exp_f32 v131,v131
v_fma_f32 v133,v133,s80,-v238
v_exp_f32 v132,v132
v_fma_f32 v134,v134,s80,-v238
v_exp_f32 v133,v133
v_fma_f32 v135,v135,s80,-v238
v_exp_f32 v134,v134
v_fma_f32 v138,v138,s80,-v238
v_exp_f32 v135,v135
v_fma_f32 v139,v139,s80,-v238
v_exp_f32 v138,v138
v_exp_f32 v139,v139
v_cvt_pk_bf16_f32 v140,v128,v129
v_cvt_pk_bf16_f32 v141,v130,v131
v_cvt_pk_bf16_f32 v142,v132,v133
v_cvt_pk_bf16_f32 v143,v134,v135
v_cvt_pk_bf16_f32 v144,v138,v139
v_mov_b32 v147,v144
buffer_load_dword v17,v16,s[8:11],s87 offen sc1
v_mfma_f32_16x16x32_bf16 v[148:151],v[152:155],v[140:143],0
v_mfma_f32_16x16x32_bf16 v[24:27],v[88:91],v[140:143],0
v_mfma_f32_16x16x32_bf16 v[28:31],v[92:95],v[140:143],0
v_mfma_f32_16x16x16_bf16 v[148:151],v[152:153],v[144:145],v[148:151]
v_mfma_f32_16x16x32_bf16 v[32:35],v[96:99],v[140:143],0
v_mfma_f32_16x16x32_bf16 v[36:39],v[100:103],v[140:143],0
v_mfma_f32_16x16x32_bf16 v[40:43],v[104:107],v[140:143],0
v_mfma_f32_16x16x32_bf16 v[44:47],v[108:111],v[140:143],0
v_mfma_f32_16x16x32_bf16 v[48:51],v[112:115],v[140:143],0
v_mfma_f32_16x16x32_bf16 v[52:55],v[116:119],v[140:143],0
v_rcp_f32 v148,v148
v_mfma_f32_16x16x16_bf16 v[24:27],v[120:121],v[144:145],v[24:27]
v_mfma_f32_16x16x16_bf16 v[28:31],v[120:121],v[146:147],v[28:31]
v_mfma_f32_16x16x16_bf16 v[32:35],v[122:123],v[144:145],v[32:35]
v_mfma_f32_16x16x16_bf16 v[36:39],v[122:123],v[146:147],v[36:39]
v_mfma_f32_16x16x16_bf16 v[40:43],v[124:125],v[144:145],v[40:43]
v_pk_mul_f32 v[24:25],v[24:25],v[148:149] op_sel_hi:[1,0]
v_pk_mul_f32 v[26:27],v[26:27],v[148:149] op_sel_hi:[1,0]
v_mfma_f32_16x16x16_bf16 v[44:47],v[124:125],v[146:147],v[44:47]
v_pk_mul_f32 v[28:29],v[28:29],v[148:149] op_sel_hi:[1,0]
v_pk_mul_f32 v[30:31],v[30:31],v[148:149] op_sel_hi:[1,0]
v_mfma_f32_16x16x16_bf16 v[48:51],v[126:127],v[144:145],v[48:51]
v_cvt_pk_bf16_f32 v72,v24,v28
v_cvt_pk_bf16_f32 v73,v25,v29
v_mfma_f32_16x16x16_bf16 v[52:55],v[126:127],v[146:147],v[52:55]
v_cvt_pk_bf16_f32 v74,v26,v30
v_cvt_pk_bf16_f32 v75,v27,v31
ds_write_b128 v3,v[72:75] offset:0
v_pk_mul_f32 v[32:33],v[32:33],v[148:149] op_sel_hi:[1,0]
v_pk_mul_f32 v[34:35],v[34:35],v[148:149] op_sel_hi:[1,0]
v_pk_mul_f32 v[36:37],v[36:37],v[148:149] op_sel_hi:[1,0]
v_pk_mul_f32 v[38:39],v[38:39],v[148:149] op_sel_hi:[1,0]
v_cvt_pk_bf16_f32 v76,v32,v36
v_cvt_pk_bf16_f32 v77,v33,v37
v_cvt_pk_bf16_f32 v78,v34,v38
v_cvt_pk_bf16_f32 v79,v35,v39
ds_write_b128 v3,v[76:79] offset:1024
s_waitcnt vmcnt(0)
v_cmp_gt_u32 vcc,s66,v17
v_pk_mul_f32 v[40:41],v[40:41],v[148:149] op_sel_hi:[1,0]
v_pk_mul_f32 v[42:43],v[42:43],v[148:149] op_sel_hi:[1,0]
v_pk_mul_f32 v[44:45],v[44:45],v[148:149] op_sel_hi:[1,0]
v_pk_mul_f32 v[46:47],v[46:47],v[148:149] op_sel_hi:[1,0]
s_cbranch_vccnz L_ap_325
L_apb_326:
s_xor_b32 s34,s69,524288
buffer_load_dwordx4 v[192:195],v7,s[8:11],s34 offen sc1
v_cvt_pk_bf16_f32 v80,v40,v44
v_cvt_pk_bf16_f32 v81,v41,v45
s_add_u32 s34,s34,4096
buffer_load_dwordx4 v[196:199],v7,s[8:11],s34 offen sc1
v_cvt_pk_bf16_f32 v82,v42,v46
v_cvt_pk_bf16_f32 v83,v43,v47
s_add_u32 s34,s34,4096
buffer_load_dwordx4 v[200:203],v7,s[8:11],s34 offen sc1
ds_write_b128 v3,v[80:83] offset:2048
v_pk_mul_f32 v[48:49],v[48:49],v[148:149] op_sel_hi:[1,0]
s_add_u32 s34,s34,4096
buffer_load_dwordx4 v[204:207],v7,s[8:11],s34 offen sc1
v_pk_mul_f32 v[50:51],v[50:51],v[148:149] op_sel_hi:[1,0]
v_pk_mul_f32 v[52:53],v[52:53],v[148:149] op_sel_hi:[1,0]
s_add_u32 s34,s34,4096
buffer_load_dwordx4 v[208:211],v7,s[8:11],s34 offen sc1
v_pk_mul_f32 v[54:55],v[54:55],v[148:149] op_sel_hi:[1,0]
v_cvt_pk_bf16_f32 v84,v48,v52
s_add_u32 s34,s34,4096
buffer_load_dwordx4 v[212:215],v7,s[8:11],s34 offen sc1
v_cvt_pk_bf16_f32 v85,v49,v53
v_cvt_pk_bf16_f32 v86,v50,v54
s_add_u32 s34,s34,4096
buffer_load_dwordx4 v[216:219],v7,s[8:11],s34 offen sc1
v_cvt_pk_bf16_f32 v87,v51,v55
ds_write_b128 v3,v[84:87] offset:3072
s_add_u32 s34,s34,4096
buffer_load_dwordx4 v[220:223],v7,s[8:11],s34 offen sc1
v_readlane_b32 s32,v18,0
v_readlane_b32 s33,v18,1
s_waitcnt lgkmcnt(0)
s_barrier
s_branch L_aa_294
L_ai_324:
v_max3_f32 v238,v128,v129,v130
v_max3_f32 v239,v131,v132,v133
v_max3_f32 v238,v134,v135,v238
v_max3_f32 v239,v138,v139,v239
v_max_f32 v238,v238,v239
v_max_f32 v239,v238,v239
s_nop 1
v_permlane16_swap_b32 v238,v239
v_max_f32 v238,v238,v239
v_max_f32 v239,v238,v239
s_nop 1
v_permlane32_swap_b32 v238,v239
v_max_f32 v238,v238,v239
v_mul_f32 v238,s80,v238
v_fma_f32 v128,v128,s80,-v238
v_fma_f32 v129,v129,s80,-v238
v_exp_f32 v128,v128
v_fma_f32 v130,v130,s80,-v238
v_exp_f32 v129,v129
v_fma_f32 v131,v131,s80,-v238
v_exp_f32 v130,v130
v_fma_f32 v132,v132,s80,-v238
v_exp_f32 v131,v131
v_fma_f32 v133,v133,s80,-v238
v_exp_f32 v132,v132
v_fma_f32 v134,v134,s80,-v238
v_exp_f32 v133,v133
v_fma_f32 v135,v135,s80,-v238
v_exp_f32 v134,v134
v_fma_f32 v138,v138,s80,-v238
v_exp_f32 v135,v135
v_fma_f32 v139,v139,s80,-v238
v_exp_f32 v138,v138
v_exp_f32 v139,v139
v_cvt_pk_bf16_f32 v140,v128,v129
v_cvt_pk_bf16_f32 v141,v130,v131
v_cvt_pk_bf16_f32 v142,v132,v133
v_cvt_pk_bf16_f32 v143,v134,v135
v_cvt_pk_bf16_f32 v144,v138,v139
v_mov_b32 v147,v144
v_mfma_f32_16x16x32_bf16 v[148:151],v[152:155],v[140:143],0
v_mfma_f32_16x16x32_bf16 v[24:27],v[88:91],v[140:143],0
v_mfma_f32_16x16x32_bf16 v[28:31],v[92:95],v[140:143],0
v_mfma_f32_16x16x16_bf16 v[148:151],v[152:153],v[144:145],v[148:151]
v_mfma_f32_16x16x32_bf16 v[32:35],v[96:99],v[140:143],0
v_mfma_f32_16x16x32_bf16 v[36:39],v[100:103],v[140:143],0
v_mfma_f32_16x16x32_bf16 v[40:43],v[104:107],v[140:143],0
v_mfma_f32_16x16x32_bf16 v[44:47],v[108:111],v[140:143],0
v_mfma_f32_16x16x32_bf16 v[48:51],v[112:115],v[140:143],0
v_mfma_f32_16x16x32_bf16 v[52:55],v[116:119],v[140:143],0
v_rcp_f32 v148,v148
v_mfma_f32_16x16x16_bf16 v[24:27],v[120:121],v[144:145],v[24:27]
v_mfma_f32_16x16x16_bf16 v[28:31],v[120:121],v[146:147],v[28:31]
v_mfma_f32_16x16x16_bf16 v[32:35],v[122:123],v[144:145],v[32:35]
v_mfma_f32_16x16x16_bf16 v[36:39],v[122:123],v[146:147],v[36:39]
v_mfma_f32_16x16x16_bf16 v[40:43],v[124:125],v[144:145],v[40:43]
v_pk_mul_f32 v[24:25],v[24:25],v[148:149] op_sel_hi:[1,0]
v_pk_mul_f32 v[26:27],v[26:27],v[148:149] op_sel_hi:[1,0]
v_mfma_f32_16x16x16_bf16 v[44:47],v[124:125],v[146:147],v[44:47]
v_pk_mul_f32 v[28:29],v[28:29],v[148:149] op_sel_hi:[1,0]
v_pk_mul_f32 v[30:31],v[30:31],v[148:149] op_sel_hi:[1,0]
v_mfma_f32_16x16x16_bf16 v[48:51],v[126:127],v[144:145],v[48:51]
v_cvt_pk_bf16_f32 v72,v24,v28
v_cvt_pk_bf16_f32 v73,v25,v29
v_mfma_f32_16x16x16_bf16 v[52:55],v[126:127],v[146:147],v[52:55]
v_cvt_pk_bf16_f32 v74,v26,v30
v_cvt_pk_bf16_f32 v75,v27,v31
ds_write_b128 v3,v[72:75] offset:0
v_pk_mul_f32 v[32:33],v[32:33],v[148:149] op_sel_hi:[1,0]
v_pk_mul_f32 v[34:35],v[34:35],v[148:149] op_sel_hi:[1,0]
v_pk_mul_f32 v[36:37],v[36:37],v[148:149] op_sel_hi:[1,0]
v_pk_mul_f32 v[38:39],v[38:39],v[148:149] op_sel_hi:[1,0]
v_cvt_pk_bf16_f32 v76,v32,v36
v_cvt_pk_bf16_f32 v77,v33,v37
v_cvt_pk_bf16_f32 v78,v34,v38
v_cvt_pk_bf16_f32 v79,v35,v39
ds_write_b128 v3,v[76:79] offset:1024
v_pk_mul_f32 v[40:41],v[40:41],v[148:149] op_sel_hi:[1,0]
v_pk_mul_f32 v[42:43],v[42:43],v[148:149] op_sel_hi:[1,0]
v_pk_mul_f32 v[44:45],v[44:45],v[148:149] op_sel_hi:[1,0]
v_pk_mul_f32 v[46:47],v[46:47],v[148:149] op_sel_hi:[1,0]
v_cvt_pk_bf16_f32 v80,v40,v44
v_cvt_pk_bf16_f32 v81,v41,v45
v_cvt_pk_bf16_f32 v82,v42,v46
v_cvt_pk_bf16_f32 v83,v43,v47
ds_write_b128 v3,v[80:83] offset:2048
v_pk_mul_f32 v[48:49],v[48:49],v[148:149] op_sel_hi:[1,0]
v_pk_mul_f32 v[50:51],v[50:51],v[148:149] op_sel_hi:[1,0]
v_pk_mul_f32 v[52:53],v[52:53],v[148:149] op_sel_hi:[1,0]
v_pk_mul_f32 v[54:55],v[54:55],v[148:149] op_sel_hi:[1,0]
v_cvt_pk_bf16_f32 v84,v48,v52
v_cvt_pk_bf16_f32 v85,v49,v53
v_cvt_pk_bf16_f32 v86,v50,v54
v_cvt_pk_bf16_f32 v87,v51,v55
ds_write_b128 v3,v[84:87] offset:3072
s_waitcnt vmcnt(0)
v_readlane_b32 s32,v18,0
v_readlane_b32 s33,v18,1
s_waitcnt lgkmcnt(0)
s_barrier
s_branch L_aa_281
L_aa_290:
s_cmp_lg_u32 s86,1536
s_cbranch_scc1 L_az_327
s_cmp_ge_u32 s35,66
s_cbranch_scc1 L_aa_280
v_subrev_u32 v248,s36,v1
v_and_b32 v248,0x80000003,v248
v_cmp_eq_u32 vcc,0,v248
v_lshlrev_b32 v248,2,v1
v_mov_b32 v249,0x40000000
v_cndmask_b32 v248,v249,v248,vcc
v_mov_b32 v249,3
s_or_b32 s59,s68,s46
s_mov_b32 s59,11018240
s_cmov_b32 s59,0x80000000
buffer_store_dword v249,v248,s[8:11],s59 offen sc1
L_aa_280:
s_waitcnt vmcnt(0)
buffer_store_dword v20,off,s[8:11],s73 sc1
s_mov_b32 s73,0x80000000
v_lshlrev_b32 v238,2,v1
v_add_u32 v248,155712,v238
s_cmp_lg_u32 s46,0
s_cbranch_scc1 L_an_328
s_lshl_b32 s59,s54,13
s_add_u32 s59,s59,11026432
L_fp_329:
s_sleep 1
buffer_load_dword v239,v238,s[8:11],s59 offen sc1
s_sub_u32 s49,s49,1
s_cbranch_scc1 L_abort2
s_waitcnt vmcnt(0)
v_cmp_eq_u32 vcc,0,v239
s_cbranch_vccnz L_fp_329
ds_write_b32 v248,v239
s_waitcnt lgkmcnt(0)
L_an_328:
s_barrier
ds_read_b32 v239,v248
s_mov_b32 s86,768
s_mov_b32 s30,1
s_waitcnt lgkmcnt(0)
v_readfirstlane_b32 s55,v239
v_and_b32 v239,255,v239
s_lshr_b32 s55,s55,8
s_lshr_b32 s61,s55,5
v_cmp_ne_u32 s[38:39],3,v239
v_cmp_le_u32 vcc,s61,v1
s_nop 1
v_cndmask_b32 v238,1,2,vcc
v_cmp_ne_u32 s[84:85],v238,v239
s_bcnt1_i32_b64 s56,s[84:85]
s_nop 0
v_mbcnt_lo_u32_b32 v238,s84,0
v_mbcnt_hi_u32_b32 v238,s85,v238
s_mul_i32 s56,s56,14
s_add_u32 s56,s56,48
s_lshr_b32 s56,s56,7
s_lshl_b32 s56,s56,1
v_cmp_gt_u32 vcc,s56,v238
v_and_b32 v239,1,v238
v_and_b32 v238,3,v238
v_add_u32 v238,2,v238
v_cndmask_b32 v238,v238,v239,vcc
v_cmp_eq_u32 vcc,s54,v238
s_and_b64 s[84:85],s[84:85],vcc
s_ff1_i32_b64 s77,s[84:85]
s_bitset0_b64 s[84:85],s77
s_min_u32 s77,s77,64
s_lshl_b32 s56,s77,5
s_add_u32 s56,s56,s68
s_mul_i32 s70,s56,24576
s_lshl_b32 s71,s56,12
s_lshl_b32 s59,s77,13
s_lshl2_add_u32 s59,s68,s59
s_add_u32 s59,s59,10486144
s_cmp_lt_u32 s77,s61
s_cselect_b32 s57,0,16777216
s_cselect_b32 s60,0,128
s_add_u32 s60,s60,s59
s_add_u32 s60,s60,128
s_buffer_load_dword s33,s[8:11],s60
s_add_u32 s71,s71,s57
s_add_u32 s71,s71,58720256
s_cmp_eq_u32 s77,s61
s_cselect_b32 s57,50331648,0
s_cselect_b32 s58,1536,0
s_add_u32 s59,s59,s58
s_buffer_load_dword s32,s[8:11],s59
s_add_u32 s70,s70,s57
s_add_u32 s70,s70,150994944
v_mov_b32 v19,s59
v_writelane_b32 v19,s60,1
s_cmp_lt_u32 s77,64
s_cbranch_scc1 L_aa_288
L_az_327:
s_waitcnt vmcnt(0)
buffer_store_dword v20,off,s[8:11],s73 sc1
s_mov_b32 s73,0x80000000
s_endpgm
L_ag_296:
s_lshl_b32 s21,s26,13
s_lshl2_add_u32 s21,s68,s21
s_add_u32 s21,s21,10487296
L_ww_330:
buffer_load_dword v246,off,s[8:11],s21 sc1
s_sub_u32 s49,s49,1
s_cbranch_scc1 L_abort2
s_waitcnt vmcnt(0)
v_readfirstlane_b32 s22,v246
s_cmp_eq_u32 s22,0
s_cbranch_scc1 L_ww_330
L_wwd_331:
s_branch L_agb_297
L_ap_303:
L_aw_332:
v_cmp_gt_u32 vcc,s66,v17
s_cbranch_vccz L_awd_333
buffer_load_dword v17,v16,s[8:11],s87 offen sc1
s_sub_u32 s49,s49,1
s_cbranch_scc1 L_abort2
s_waitcnt vmcnt(0)
s_branch L_aw_332
L_awd_333:
s_branch L_apb_304
L_ag_312:
s_lshl_b32 s21,s51,13
s_lshl2_add_u32 s21,s68,s21
s_add_u32 s21,s21,10487296
L_ww_334:
buffer_load_dword v246,off,s[8:11],s21 sc1
s_sub_u32 s49,s49,1
s_cbranch_scc1 L_abort2
s_waitcnt vmcnt(0)
v_readfirstlane_b32 s22,v246
s_cmp_eq_u32 s22,0
s_cbranch_scc1 L_ww_334
L_wwd_335:
s_branch L_agb_313
L_am_321:
v_subrev_u32 v248,s36,v1
v_and_b32 v248,0x80000003,v248
v_cmp_eq_u32 vcc,0,v248
v_lshlrev_b32 v248,2,v1
v_mov_b32 v249,0x40000000
v_cndmask_b32 v248,v249,v248,vcc
v_mov_b32 v249,3
s_or_b32 s59,s68,s46
s_mov_b32 s59,11018240
s_cmov_b32 s59,0x80000000
buffer_store_dword v249,v248,s[8:11],s59 offen sc1
s_branch L_ab_319
L_ap_325:
L_aw_336:
v_cmp_gt_u32 vcc,s66,v17
s_cbranch_vccz L_awd_337
buffer_load_dword v17,v16,s[8:11],s87 offen sc1
s_sub_u32 s49,s49,1
s_cbranch_scc1 L_abort2
s_waitcnt vmcnt(0)
s_branch L_aw_336
L_awd_337:
s_branch L_apb_326
s_endpgm
L_wm:
s_nop 11
v_and_b32 v120,15,v1
v_lshrrev_b32 v121,4,v1
v_mov_b32 v17,1
s_lshl_b32 s56,s46,15
v_add_u32 v18,s56,v0
s_lshl_b32 s56,s46,2
v_add_u32 v125,s56,v121
v_xor_b32 v126,v125,v120
v_lshlrev_b32 v126,4,v126
v_lshl_add_u32 v20,v125,10,v126
v_add_u32 v125,0,v121
v_xor_b32 v125,v125,v120
v_lshlrev_b32 v125,4,v125
v_lshl_add_u32 v125,v120,8,v125
v_add_u32 v4,131072,v125
v_add_u32 v125,4,v121
v_xor_b32 v125,v125,v120
v_lshlrev_b32 v125,4,v125
v_lshl_add_u32 v125,v120,8,v125
v_add_u32 v5,131072,v125
v_add_u32 v125,8,v121
v_xor_b32 v125,v125,v120
v_lshlrev_b32 v125,4,v125
v_lshl_add_u32 v125,v120,8,v125
v_add_u32 v6,131072,v125
v_add_u32 v125,12,v121
v_xor_b32 v125,v125,v120
v_lshlrev_b32 v125,4,v125
v_lshl_add_u32 v125,v120,8,v125
v_add_u32 v7,131072,v125
v_lshlrev_b32 v21,5,v120
v_and_b32 v125,1,v121
v_lshl_add_u32 v21,v125,4,v21
s_lshl_b32 s56,s46,9
v_lshrrev_b32 v125,1,v121
v_lshl_add_u32 v21,v125,11,v21
s_add_u32 s56,s56,155648
v_add_u32 v21,s56,v21
v_lshlrev_b32 v22,4,v120
v_lshl_add_u32 v22,v121,10,v22
s_lshl_b32 s56,s46,8
v_add_u32 v22,s56,v22
s_mov_b32 s54,0
s_mov_b32 s31,0
s_mov_b32 s53,3
s_mov_b32 s72,0x80000000
s_mov_b32 s73,0
s_mov_b32 s77,-1
s_mov_b32 s86,0
s_mov_b32 s19,0
s_mov_b32 s74,1308622848
s_mov_b32 s75,2454267026
v_and_b32 v23,15,v1
v_lshlrev_b32 v23,3,v23
v_lshrrev_b32 v16,4,v1
v_lshl_add_u32 v23,v16,13,v23
v_mov_b32 v19,159744
v_lshl_add_u32 v16,v16,2,v19
s_ff1_i32_b64 s30,s[74:75]
s_bitset0_b64 s[74:75],s30
s_min_u32 s30,s30,127
s_lshl_b32 s70,s30,15
s_add_u32 s70,s70,0
s_add_u32 s71,s70,16384
L_mo_341:
s_cmp_lg_u32 s19,0
s_cbranch_scc1 L_mo_342
s_add_u32 m0,s50,131072
s_nop 0
buffer_load_dwordx4 v20,s[8:11],s70 offen offset:0 sc1 lds
s_add_u32 m0,s50,135168
s_nop 0
buffer_load_dwordx4 v20,s[8:11],s71 offen offset:0 sc1 lds
s_add_u32 m0,s50,139008
s_nop 0
buffer_load_dwordx4 v20,s[8:11],s70 offen offset:256 sc1 lds
s_add_u32 m0,s50,143104
s_nop 0
buffer_load_dwordx4 v20,s[8:11],s71 offen offset:256 sc1 lds
s_add_u32 m0,s50,146944
s_nop 0
buffer_load_dwordx4 v20,s[8:11],s70 offen offset:512 sc1 lds
s_add_u32 m0,s50,151040
s_nop 0
buffer_load_dwordx4 v20,s[8:11],s71 offen offset:512 sc1 lds
s_mov_b32 s19,1
s_waitcnt vmcnt(0)
L_mo_342:
s_mov_b32 s51,s30
s_mov_b64 s[68:69],s[70:71]
s_ff1_i32_b64 s30,s[74:75]
s_bitset0_b64 s[74:75],s30
s_min_u32 s30,s30,127
s_lshl_b32 s70,s30,15
s_add_u32 s70,s70,0
s_add_u32 s71,s70,16384
s_lshl_b32 s76,s31,13
s_add_u32 s76,s76,10487040
s_lshl_b32 s58,s51,5
s_add_u32 s58,s58,s47
s_mul_i32 s58,s58,24576
s_add_u32 s58,s58,100663296
s_add_u32 s61,s58,s50
s_add_u32 s62,s61,4096
s_add_u32 s63,s61,16384
s_add_u32 s64,s61,20480
s_add_u32 s65,s61,s50
s_add_u32 s65,s65,8192
s_waitcnt vmcnt(12)
s_barrier
ds_read_b128 v[72:75],v4 offset:0
ds_read_b128 v[76:79],v4 offset:4096
ds_read_b128 v[80:83],v5 offset:0
ds_read_b128 v[84:87],v5 offset:4096
s_add_u32 m0,s50,154880
s_nop 0
buffer_load_dwordx4 v20,s[8:11],s68 offen offset:768 sc1 lds
s_add_u32 m0,s50,158976
s_nop 0
buffer_load_dwordx4 v20,s[8:11],s69 offen offset:768 sc1 lds
s_waitcnt lgkmcnt(2)
v_mfma_f32_16x16x32_bf16 v[40:43],a[128:131],v[72:75],0
ds_read_b128 v[108:111],v6 offset:0
v_mfma_f32_16x16x32_bf16 v[56:59],v[72:75],v[128:131],0
v_mfma_f32_16x16x32_bf16 v[24:27],a[0:3],v[72:75],0
ds_read_b128 v[112:115],v6 offset:4096
v_mfma_f32_16x16x32_bf16 v[44:47],a[128:131],v[76:79],0
v_mfma_f32_16x16x32_bf16 v[60:63],v[76:79],v[128:131],0
v_mfma_f32_16x16x32_bf16 v[28:31],a[0:3],v[76:79],0
v_mfma_f32_16x16x32_bf16 v[48:51],a[136:139],v[72:75],0
v_mfma_f32_16x16x32_bf16 v[64:67],v[72:75],v[136:139],0
v_mfma_f32_16x16x32_bf16 v[32:35],a[8:11],v[72:75],0
v_mfma_f32_16x16x32_bf16 v[52:55],a[136:139],v[76:79],0
v_mfma_f32_16x16x32_bf16 v[68:71],v[76:79],v[136:139],0
v_mfma_f32_16x16x32_bf16 v[36:39],a[8:11],v[76:79],0
s_waitcnt lgkmcnt(2)
v_mfma_f32_16x16x32_bf16 v[40:43],a[132:135],v[80:83],v[40:43]
ds_read_b128 v[72:75],v7 offset:0
v_mfma_f32_16x16x32_bf16 v[56:59],v[80:83],v[132:135],v[56:59]
v_mfma_f32_16x16x32_bf16 v[24:27],a[4:7],v[80:83],v[24:27]
ds_read_b128 v[76:79],v7 offset:4096
v_mfma_f32_16x16x32_bf16 v[44:47],a[132:135],v[84:87],v[44:47]
v_mfma_f32_16x16x32_bf16 v[60:63],v[84:87],v[132:135],v[60:63]
v_mfma_f32_16x16x32_bf16 v[28:31],a[4:7],v[84:87],v[28:31]
v_mfma_f32_16x16x32_bf16 v[48:51],a[140:143],v[80:83],v[48:51]
v_mfma_f32_16x16x32_bf16 v[64:67],v[80:83],v[140:143],v[64:67]
v_mfma_f32_16x16x32_bf16 v[32:35],a[12:15],v[80:83],v[32:35]
v_mfma_f32_16x16x32_bf16 v[52:55],a[140:143],v[84:87],v[52:55]
v_mfma_f32_16x16x32_bf16 v[68:71],v[84:87],v[140:143],v[68:71]
v_mfma_f32_16x16x32_bf16 v[36:39],a[12:15],v[84:87],v[36:39]
s_waitcnt vmcnt(12)
s_barrier
s_waitcnt lgkmcnt(2)
v_mfma_f32_16x16x32_bf16 v[40:43],a[144:147],v[108:111],v[40:43]
ds_read_b128 v[80:83],v4 offset:8192
v_mfma_f32_16x16x32_bf16 v[56:59],v[108:111],v[144:147],v[56:59]
v_mfma_f32_16x16x32_bf16 v[24:27],a[16:19],v[108:111],v[24:27]
ds_read_b128 v[84:87],v4 offset:12288
v_mfma_f32_16x16x32_bf16 v[44:47],a[144:147],v[112:115],v[44:47]
v_mfma_f32_16x16x32_bf16 v[60:63],v[112:115],v[144:147],v[60:63]
v_mfma_f32_16x16x32_bf16 v[28:31],a[16:19],v[112:115],v[28:31]
v_mfma_f32_16x16x32_bf16 v[48:51],a[152:155],v[108:111],v[48:51]
v_mfma_f32_16x16x32_bf16 v[64:67],v[108:111],v[152:155],v[64:67]
v_mfma_f32_16x16x32_bf16 v[32:35],a[24:27],v[108:111],v[32:35]
v_mfma_f32_16x16x32_bf16 v[52:55],a[152:155],v[112:115],v[52:55]
v_mfma_f32_16x16x32_bf16 v[68:71],v[112:115],v[152:155],v[68:71]
v_mfma_f32_16x16x32_bf16 v[36:39],a[24:27],v[112:115],v[36:39]
s_waitcnt lgkmcnt(2)
v_mfma_f32_16x16x32_bf16 v[40:43],a[148:151],v[72:75],v[40:43]
ds_read_b128 v[108:111],v5 offset:8192
v_mfma_f32_16x16x32_bf16 v[56:59],v[72:75],v[148:151],v[56:59]
v_mfma_f32_16x16x32_bf16 v[24:27],a[20:23],v[72:75],v[24:27]
ds_read_b128 v[112:115],v5 offset:12288
v_mfma_f32_16x16x32_bf16 v[44:47],a[148:151],v[76:79],v[44:47]
v_mfma_f32_16x16x32_bf16 v[60:63],v[76:79],v[148:151],v[60:63]
v_mfma_f32_16x16x32_bf16 v[28:31],a[20:23],v[76:79],v[28:31]
v_mfma_f32_16x16x32_bf16 v[48:51],a[156:159],v[72:75],v[48:51]
v_mfma_f32_16x16x32_bf16 v[64:67],v[72:75],v[156:159],v[64:67]
v_mfma_f32_16x16x32_bf16 v[32:35],a[28:31],v[72:75],v[32:35]
v_mfma_f32_16x16x32_bf16 v[52:55],a[156:159],v[76:79],v[52:55]
v_mfma_f32_16x16x32_bf16 v[68:71],v[76:79],v[156:159],v[68:71]
v_mfma_f32_16x16x32_bf16 v[36:39],a[28:31],v[76:79],v[36:39]
s_waitcnt lgkmcnt(2)
v_mfma_f32_16x16x32_bf16 v[40:43],a[160:163],v[80:83],v[40:43]
ds_read_b128 v[72:75],v6 offset:8192
v_mfma_f32_16x16x32_bf16 v[56:59],v[80:83],v[160:163],v[56:59]
v_mfma_f32_16x16x32_bf16 v[24:27],a[32:35],v[80:83],v[24:27]
ds_read_b128 v[76:79],v6 offset:12288
v_mfma_f32_16x16x32_bf16 v[44:47],a[160:163],v[84:87],v[44:47]
v_mfma_f32_16x16x32_bf16 v[60:63],v[84:87],v[160:163],v[60:63]
v_mfma_f32_16x16x32_bf16 v[28:31],a[32:35],v[84:87],v[28:31]
v_mfma_f32_16x16x32_bf16 v[48:51],a[168:171],v[80:83],v[48:51]
v_mfma_f32_16x16x32_bf16 v[64:67],v[80:83],v[168:171],v[64:67]
v_mfma_f32_16x16x32_bf16 v[32:35],a[40:43],v[80:83],v[32:35]
v_mfma_f32_16x16x32_bf16 v[52:55],a[168:171],v[84:87],v[52:55]
v_mfma_f32_16x16x32_bf16 v[68:71],v[84:87],v[168:171],v[68:71]
v_mfma_f32_16x16x32_bf16 v[36:39],a[40:43],v[84:87],v[36:39]
s_waitcnt lgkmcnt(2)
v_mfma_f32_16x16x32_bf16 v[40:43],a[164:167],v[108:111],v[40:43]
ds_read_b128 v[80:83],v7 offset:8192
v_mfma_f32_16x16x32_bf16 v[56:59],v[108:111],v[164:167],v[56:59]
v_mfma_f32_16x16x32_bf16 v[24:27],a[36:39],v[108:111],v[24:27]
ds_read_b128 v[84:87],v7 offset:12288
v_mfma_f32_16x16x32_bf16 v[44:47],a[164:167],v[112:115],v[44:47]
v_mfma_f32_16x16x32_bf16 v[60:63],v[112:115],v[164:167],v[60:63]
v_mfma_f32_16x16x32_bf16 v[28:31],a[36:39],v[112:115],v[28:31]
v_mfma_f32_16x16x32_bf16 v[48:51],a[172:175],v[108:111],v[48:51]
v_mfma_f32_16x16x32_bf16 v[64:67],v[108:111],v[172:175],v[64:67]
v_mfma_f32_16x16x32_bf16 v[32:35],a[44:47],v[108:111],v[32:35]
v_mfma_f32_16x16x32_bf16 v[52:55],a[172:175],v[112:115],v[52:55]
v_mfma_f32_16x16x32_bf16 v[68:71],v[112:115],v[172:175],v[68:71]
v_mfma_f32_16x16x32_bf16 v[36:39],a[44:47],v[112:115],v[36:39]
s_waitcnt vmcnt(10)
s_barrier
s_waitcnt lgkmcnt(2)
v_mfma_f32_16x16x32_bf16 v[40:43],a[176:179],v[72:75],v[40:43]
ds_read_b128 v[108:111],v4 offset:16384
v_mfma_f32_16x16x32_bf16 v[56:59],v[72:75],v[176:179],v[56:59]
v_mfma_f32_16x16x32_bf16 v[24:27],a[48:51],v[72:75],v[24:27]
ds_read_b128 v[112:115],v4 offset:20480
v_mfma_f32_16x16x32_bf16 v[44:47],a[176:179],v[76:79],v[44:47]
v_mfma_f32_16x16x32_bf16 v[60:63],v[76:79],v[176:179],v[60:63]
v_mfma_f32_16x16x32_bf16 v[28:31],a[48:51],v[76:79],v[28:31]
v_mfma_f32_16x16x32_bf16 v[48:51],a[184:187],v[72:75],v[48:51]
v_mfma_f32_16x16x32_bf16 v[64:67],v[72:75],v[184:187],v[64:67]
v_mfma_f32_16x16x32_bf16 v[32:35],a[56:59],v[72:75],v[32:35]
v_mfma_f32_16x16x32_bf16 v[52:55],a[184:187],v[76:79],v[52:55]
v_mfma_f32_16x16x32_bf16 v[68:71],v[76:79],v[184:187],v[68:71]
v_mfma_f32_16x16x32_bf16 v[36:39],a[56:59],v[76:79],v[36:39]
s_waitcnt vmcnt(2)
s_barrier
s_or_b32 s72,s72,s52
buffer_store_dword v17,off,s[8:11],s72 sc1
s_waitcnt lgkmcnt(2)
v_mfma_f32_16x16x32_bf16 v[40:43],a[180:183],v[80:83],v[40:43]
ds_read_b128 v[72:75],v5 offset:16384
v_mfma_f32_16x16x32_bf16 v[56:59],v[80:83],v[180:183],v[56:59]
v_mfma_f32_16x16x32_bf16 v[24:27],a[52:55],v[80:83],v[24:27]
ds_read_b128 v[76:79],v5 offset:20480
v_mfma_f32_16x16x32_bf16 v[44:47],a[180:183],v[84:87],v[44:47]
v_mfma_f32_16x16x32_bf16 v[60:63],v[84:87],v[180:183],v[60:63]
v_mfma_f32_16x16x32_bf16 v[28:31],a[52:55],v[84:87],v[28:31]
v_mfma_f32_16x16x32_bf16 v[48:51],a[188:191],v[80:83],v[48:51]
v_mfma_f32_16x16x32_bf16 v[64:67],v[80:83],v[188:191],v[64:67]
v_mfma_f32_16x16x32_bf16 v[32:35],a[60:63],v[80:83],v[32:35]
v_mfma_f32_16x16x32_bf16 v[52:55],a[188:191],v[84:87],v[52:55]
v_mfma_f32_16x16x32_bf16 v[68:71],v[84:87],v[188:191],v[68:71]
v_mfma_f32_16x16x32_bf16 v[36:39],a[60:63],v[84:87],v[36:39]
s_waitcnt lgkmcnt(2)
v_mfma_f32_16x16x32_bf16 v[40:43],a[192:195],v[108:111],v[40:43]
ds_read_b128 v[80:83],v6 offset:16384
v_mfma_f32_16x16x32_bf16 v[56:59],v[108:111],v[192:195],v[56:59]
v_mfma_f32_16x16x32_bf16 v[24:27],a[64:67],v[108:111],v[24:27]
ds_read_b128 v[84:87],v6 offset:20480
v_mfma_f32_16x16x32_bf16 v[44:47],a[192:195],v[112:115],v[44:47]
v_mfma_f32_16x16x32_bf16 v[60:63],v[112:115],v[192:195],v[60:63]
v_mfma_f32_16x16x32_bf16 v[28:31],a[64:67],v[112:115],v[28:31]
v_mfma_f32_16x16x32_bf16 v[48:51],a[200:203],v[108:111],v[48:51]
v_mfma_f32_16x16x32_bf16 v[64:67],v[108:111],v[200:203],v[64:67]
v_mfma_f32_16x16x32_bf16 v[32:35],a[72:75],v[108:111],v[32:35]
v_mfma_f32_16x16x32_bf16 v[52:55],a[200:203],v[112:115],v[52:55]
v_mfma_f32_16x16x32_bf16 v[68:71],v[112:115],v[200:203],v[68:71]
v_mfma_f32_16x16x32_bf16 v[36:39],a[72:75],v[112:115],v[36:39]
s_waitcnt lgkmcnt(2)
v_mfma_f32_16x16x32_bf16 v[40:43],a[196:199],v[72:75],v[40:43]
ds_read_b128 v[108:111],v7 offset:16384
v_mfma_f32_16x16x32_bf16 v[56:59],v[72:75],v[196:199],v[56:59]
v_mfma_f32_16x16x32_bf16 v[24:27],a[68:71],v[72:75],v[24:27]
ds_read_b128 v[112:115],v7 offset:20480
v_mfma_f32_16x16x32_bf16 v[44:47],a[196:199],v[76:79],v[44:47]
v_mfma_f32_16x16x32_bf16 v[60:63],v[76:79],v[196:199],v[60:63]
v_mfma_f32_16x16x32_bf16 v[28:31],a[68:71],v[76:79],v[28:31]
v_mfma_f32_16x16x32_bf16 v[48:51],a[204:207],v[72:75],v[48:51]
v_mfma_f32_16x16x32_bf16 v[64:67],v[72:75],v[204:207],v[64:67]
v_mfma_f32_16x16x32_bf16 v[32:35],a[76:79],v[72:75],v[32:35]
v_mfma_f32_16x16x32_bf16 v[52:55],a[204:207],v[76:79],v[52:55]
v_mfma_f32_16x16x32_bf16 v[68:71],v[76:79],v[204:207],v[68:71]
v_mfma_f32_16x16x32_bf16 v[36:39],a[76:79],v[76:79],v[36:39]
s_waitcnt vmcnt(1)
s_barrier
s_waitcnt lgkmcnt(2)
v_mfma_f32_16x16x32_bf16 v[40:43],a[208:211],v[80:83],v[40:43]
ds_read_b128 v[72:75],v4 offset:24576
v_mfma_f32_16x16x32_bf16 v[56:59],v[80:83],v[208:211],v[56:59]
v_mfma_f32_16x16x32_bf16 v[24:27],a[80:83],v[80:83],v[24:27]
ds_read_b128 v[76:79],v4 offset:28672
v_mfma_f32_16x16x32_bf16 v[44:47],a[208:211],v[84:87],v[44:47]
v_mfma_f32_16x16x32_bf16 v[60:63],v[84:87],v[208:211],v[60:63]
v_mfma_f32_16x16x32_bf16 v[28:31],a[80:83],v[84:87],v[28:31]
v_mfma_f32_16x16x32_bf16 v[48:51],a[216:219],v[80:83],v[48:51]
v_mfma_f32_16x16x32_bf16 v[64:67],v[80:83],v[216:219],v[64:67]
v_mfma_f32_16x16x32_bf16 v[32:35],a[88:91],v[80:83],v[32:35]
v_mfma_f32_16x16x32_bf16 v[52:55],a[216:219],v[84:87],v[52:55]
v_mfma_f32_16x16x32_bf16 v[68:71],v[84:87],v[216:219],v[68:71]
v_mfma_f32_16x16x32_bf16 v[36:39],a[88:91],v[84:87],v[36:39]
s_waitcnt lgkmcnt(2)
v_mfma_f32_16x16x32_bf16 v[40:43],a[212:215],v[108:111],v[40:43]
ds_read_b128 v[80:83],v5 offset:24576
v_mfma_f32_16x16x32_bf16 v[56:59],v[108:111],v[212:215],v[56:59]
v_mfma_f32_16x16x32_bf16 v[24:27],a[84:87],v[108:111],v[24:27]
ds_read_b128 v[84:87],v5 offset:28672
v_mfma_f32_16x16x32_bf16 v[44:47],a[212:215],v[112:115],v[44:47]
v_mfma_f32_16x16x32_bf16 v[60:63],v[112:115],v[212:215],v[60:63]
v_mfma_f32_16x16x32_bf16 v[28:31],a[84:87],v[112:115],v[28:31]
v_mfma_f32_16x16x32_bf16 v[48:51],a[220:223],v[108:111],v[48:51]
v_mfma_f32_16x16x32_bf16 v[64:67],v[108:111],v[220:223],v[64:67]
v_mfma_f32_16x16x32_bf16 v[32:35],a[92:95],v[108:111],v[32:35]
v_mfma_f32_16x16x32_bf16 v[52:55],a[220:223],v[112:115],v[52:55]
v_mfma_f32_16x16x32_bf16 v[68:71],v[112:115],v[220:223],v[68:71]
v_mfma_f32_16x16x32_bf16 v[36:39],a[92:95],v[112:115],v[36:39]
s_barrier
s_waitcnt lgkmcnt(2)
v_mfma_f32_16x16x32_bf16 v[40:43],a[224:227],v[72:75],v[40:43]
ds_read_b128 v[108:111],v6 offset:24576
v_mfma_f32_16x16x32_bf16 v[56:59],v[72:75],v[224:227],v[56:59]
s_add_u32 m0,s50,131072
v_mfma_f32_16x16x32_bf16 v[24:27],a[96:99],v[72:75],v[24:27]
ds_read_b128 v[112:115],v6 offset:28672
v_mfma_f32_16x16x32_bf16 v[44:47],a[224:227],v[76:79],v[44:47]
buffer_load_dwordx4 v20,s[8:11],s70 offen offset:0 sc1 lds
v_mfma_f32_16x16x32_bf16 v[60:63],v[76:79],v[224:227],v[60:63]
s_add_u32 m0,s50,135168
v_mfma_f32_16x16x32_bf16 v[28:31],a[96:99],v[76:79],v[28:31]
buffer_load_dwordx4 v20,s[8:11],s71 offen offset:0 sc1 lds
v_mfma_f32_16x16x32_bf16 v[48:51],a[232:235],v[72:75],v[48:51]
s_add_u32 m0,s50,139008
v_mfma_f32_16x16x32_bf16 v[64:67],v[72:75],v[232:235],v[64:67]
buffer_load_dwordx4 v20,s[8:11],s70 offen offset:256 sc1 lds
v_mfma_f32_16x16x32_bf16 v[32:35],a[104:107],v[72:75],v[32:35]
s_add_u32 m0,s50,143104
v_mfma_f32_16x16x32_bf16 v[52:55],a[232:235],v[76:79],v[52:55]
buffer_load_dwordx4 v20,s[8:11],s71 offen offset:256 sc1 lds
v_mfma_f32_16x16x32_bf16 v[68:71],v[76:79],v[232:235],v[68:71]
s_add_u32 m0,s50,146944
v_mfma_f32_16x16x32_bf16 v[36:39],a[104:107],v[76:79],v[36:39]
buffer_load_dwordx4 v20,s[8:11],s70 offen offset:512 sc1 lds
s_waitcnt lgkmcnt(2)
v_mfma_f32_16x16x32_bf16 v[40:43],a[228:231],v[80:83],v[40:43]
ds_read_b128 v[72:75],v7 offset:24576
v_mfma_f32_16x16x32_bf16 v[56:59],v[80:83],v[228:231],v[56:59]
s_add_u32 m0,s50,151040
v_mfma_f32_16x16x32_bf16 v[24:27],a[100:103],v[80:83],v[24:27]
ds_read_b128 v[76:79],v7 offset:28672
v_mfma_f32_16x16x32_bf16 v[44:47],a[228:231],v[84:87],v[44:47]
buffer_load_dwordx4 v20,s[8:11],s71 offen offset:512 sc1 lds
v_mfma_f32_16x16x32_bf16 v[60:63],v[84:87],v[228:231],v[60:63]
buffer_load_dwordx2 v[124:125],v23,s[8:11],s76 offen sc1
v_mfma_f32_16x16x32_bf16 v[28:31],a[100:103],v[84:87],v[28:31]
v_mfma_f32_16x16x32_bf16 v[48:51],a[236:239],v[80:83],v[48:51]
v_mfma_f32_16x16x32_bf16 v[64:67],v[80:83],v[236:239],v[64:67]
v_mfma_f32_16x16x32_bf16 v[32:35],a[108:111],v[80:83],v[32:35]
v_mfma_f32_16x16x32_bf16 v[52:55],a[236:239],v[84:87],v[52:55]
v_mfma_f32_16x16x32_bf16 v[68:71],v[84:87],v[236:239],v[68:71]
v_mfma_f32_16x16x32_bf16 v[36:39],a[108:111],v[84:87],v[36:39]
s_waitcnt lgkmcnt(2)
v_mfma_f32_16x16x32_bf16 v[40:43],a[240:243],v[108:111],v[40:43]
v_mfma_f32_16x16x32_bf16 v[56:59],v[108:111],v[240:243],v[56:59]
v_mfma_f32_16x16x32_bf16 v[24:27],a[112:115],v[108:111],v[24:27]
v_mfma_f32_16x16x32_bf16 v[44:47],a[240:243],v[112:115],v[44:47]
v_mfma_f32_16x16x32_bf16 v[60:63],v[112:115],v[240:243],v[60:63]
v_mfma_f32_16x16x32_bf16 v[28:31],a[112:115],v[112:115],v[28:31]
v_mfma_f32_16x16x32_bf16 v[48:51],a[248:251],v[108:111],v[48:51]
v_mfma_f32_16x16x32_bf16 v[64:67],v[108:111],v[248:251],v[64:67]
v_mfma_f32_16x16x32_bf16 v[32:35],a[120:123],v[108:111],v[32:35]
v_mfma_f32_16x16x32_bf16 v[52:55],a[248:251],v[112:115],v[52:55]
v_mfma_f32_16x16x32_bf16 v[68:71],v[112:115],v[248:251],v[68:71]
v_mfma_f32_16x16x32_bf16 v[36:39],a[120:123],v[112:115],v[36:39]
s_waitcnt lgkmcnt(0)
v_mfma_f32_16x16x32_bf16 v[40:43],a[244:247],v[72:75],v[40:43]
v_mfma_f32_16x16x32_bf16 v[56:59],v[72:75],v[244:247],v[56:59]
v_mfma_f32_16x16x32_bf16 v[24:27],a[116:119],v[72:75],v[24:27]
v_mfma_f32_16x16x32_bf16 v[44:47],a[244:247],v[76:79],v[44:47]
v_mfma_f32_16x16x32_bf16 v[60:63],v[76:79],v[244:247],v[60:63]
v_mfma_f32_16x16x32_bf16 v[28:31],a[116:119],v[76:79],v[28:31]
v_mfma_f32_16x16x32_bf16 v[48:51],a[252:255],v[72:75],v[48:51]
v_mfma_f32_16x16x32_bf16 v[64:67],v[72:75],v[252:255],v[64:67]
v_mfma_f32_16x16x32_bf16 v[32:35],a[124:127],v[72:75],v[32:35]
v_mfma_f32_16x16x32_bf16 v[52:55],a[252:255],v[76:79],v[52:55]
v_mfma_f32_16x16x32_bf16 v[68:71],v[76:79],v[252:255],v[68:71]
v_mfma_f32_16x16x32_bf16 v[36:39],a[124:127],v[76:79],v[36:39]
s_lshl_b32 s56,s51,5
s_add_u32 s56,s56,s47
s_lshl_b32 s56,s56,12
s_add_u32 s56,s56,s50
s_add_u32 s56,s56,41943040
v_mov_b64 v[120:121],-1
v_mov_b64 v[122:123],-1
buffer_store_dwordx4 v[120:123],v0,s[8:11],s56 offen sc1
v_cvt_pk_bf16_f32 v72,v40,v48
v_cvt_pk_bf16_f32 v73,v41,v49
v_cvt_pk_bf16_f32 v74,v42,v50
v_cvt_pk_bf16_f32 v75,v43,v51
buffer_store_dwordx4 v[72:75],v0,s[8:11],s61 offen sc1
v_cvt_pk_bf16_f32 v76,v44,v52
v_cvt_pk_bf16_f32 v77,v45,v53
v_cvt_pk_bf16_f32 v78,v46,v54
v_cvt_pk_bf16_f32 v79,v47,v55
buffer_store_dwordx4 v[76:79],v0,s[8:11],s62 offen sc1
v_cvt_pk_bf16_f32 v80,v56,v57
v_cvt_pk_bf16_f32 v81,v58,v59
v_cvt_pk_bf16_f32 v82,v60,v61
v_cvt_pk_bf16_f32 v83,v62,v63
buffer_store_dwordx4 v[80:83],v0,s[8:11],s65 offen offset:0 sc1
v_cvt_pk_bf16_f32 v84,v64,v65
v_cvt_pk_bf16_f32 v85,v66,v67
v_cvt_pk_bf16_f32 v86,v68,v69
v_cvt_pk_bf16_f32 v87,v70,v71
buffer_store_dwordx4 v[84:87],v0,s[8:11],s65 offen offset:1024 sc1
v_cvt_pk_bf16_f32 v108,v24,v32
v_cvt_pk_bf16_f32 v109,v25,v33
v_cvt_pk_bf16_f32 v110,v26,v34
v_cvt_pk_bf16_f32 v111,v27,v35
buffer_store_dwordx4 v[108:111],v0,s[8:11],s63 offen sc1
v_cvt_pk_bf16_f32 v112,v28,v36
v_cvt_pk_bf16_f32 v113,v29,v37
v_cvt_pk_bf16_f32 v114,v30,v38
v_cvt_pk_bf16_f32 v115,v31,v39
buffer_store_dwordx4 v[112:115],v0,s[8:11],s64 offen sc1
s_lshl_b32 s72,s51,13
s_lshl2_add_u32 s72,s47,s72
s_add_u32 s72,s72,10485760
s_sub_u32 s53,s53,1
s_cmp_gt_i32 s53,0
s_cbranch_scc1 L_mo_342
s_mov_b32 s87,3
s_mov_b32 s18,0
s_waitcnt vmcnt(7)
s_branch L_mo_347
L_mo_340:
s_mov_b32 s55,s22
s_mov_b32 s22,s23
s_mov_b32 s23,s24
s_mov_b32 s24,-1
s_cmp_lg_u32 s55,-1
s_cbranch_scc1 L_mp_338
s_sub_u32 s56,s30,s31
s_cmp_gt_i32 s77,0
s_cselect_b32 s57,6,12
s_cmp_lt_i32 s56,s57
s_cbranch_scc1 L_mo_341
s_cmp_lt_i32 s56,26
s_cselect_b32 s87,s18,0
s_cmp_ge_u32 s31,56
s_cselect_b32 s56,1,s18
s_and_b32 s56,s56,s86
s_cselect_b32 s87,2,s87
s_mul_i32 s56,s87,s18
s_cmp_lg_u32 s56,0
s_cbranch_scc1 L_mo_345
s_mov_b32 s18,0
s_lshr_b32 s56,s72,31
s_or_b32 s56,s56,s87
s_cbranch_scc1 L_mo_351
s_waitcnt vmcnt(0)
s_barrier
s_or_b32 s72,s72,s52
buffer_store_dword v17,off,s[8:11],s72 sc1
s_mov_b32 s72,0x80000000
L_mo_351:
s_cmp_lg_u32 s46,0
s_cbranch_scc1 L_mo_349
s_lshl_b32 s76,s31,13
s_add_u32 s76,s76,10487040
L_mo_348:
buffer_load_dwordx2 v[124:125],v23,s[8:11],s76 offen sc1
s_sub_u32 s49,s49,1
s_cbranch_scc1 L_abort2
s_waitcnt vmcnt(0)
L_mo_347:
v_min_u32 v123,v124,v125
v_max_u32 v125,v124,v125
v_cmp_eq_u32 vcc,0,v123
s_nop 1
v_cndmask_b32 v125,v125,-1,vcc
s_and_b32 s56,vcc_lo,0xffff
s_cbranch_scc0 L_mo_352
s_cmp_lg_u32 s87,0
s_cbranch_scc1 L_mo_352
s_mov_b32 s18,1
s_sleep 2
s_branch L_mo_348
L_mo_352:
v_max_u32_dpp v125,v125,v125 row_ror:8 row_mask:0xf bank_mask:0xf
s_nop 1
v_max_u32_dpp v125,v125,v125 row_ror:4 row_mask:0xf bank_mask:0xf
s_nop 1
v_max_u32_dpp v125,v125,v125 row_ror:2 row_mask:0xf bank_mask:0xf
s_nop 1
v_max_u32_dpp v125,v125,v125 row_ror:1 row_mask:0xf bank_mask:0xf
L_mo_349:
s_sub_u32 s49,s49,1
s_cbranch_scc1 L_abort2
v_mov_b32 v124,s18
s_barrier
s_cmp_lg_u32 s46,0
s_cbranch_scc1 L_mo_350
ds_write_b32 v16,v125
ds_write_b32 v19,v124 offset:16
s_waitcnt lgkmcnt(0)
L_mo_350:
s_barrier
ds_read_b128 v[120:123],v19
ds_read_b32 v124,v19 offset:16
s_waitcnt lgkmcnt(0)
v_readfirstlane_b32 s55,v120
v_readfirstlane_b32 s22,v121
v_readfirstlane_b32 s23,v122
v_readfirstlane_b32 s24,v123
v_readfirstlane_b32 s18,v124
s_cmp_lg_u32 s55,-1
s_cbranch_scc1 L_mp_338
L_mo_345:
s_mov_b32 s22,-1
s_cmp_eq_u32 s87,1
s_cbranch_scc1 L_mo_341
s_cmp_eq_u32 s87,2
s_cbranch_scc1 L_mo_346
s_branch L_mo_340
L_mp_338:
s_sub_u32 s73,s73,1
s_max_i32 s73,s73,0
s_sub_u32 s77,s77,1
s_min_u32 s61,s73,2
s_cmp_lt_u32 s31,5
s_cselect_b32 s61,2,s61
s_cmp_le_u32 s55,s54
s_cbranch_scc1 L_mr_339
s_mov_b32 s77,s61
s_mov_b32 s54,s55
s_mov_b32 s86,0
s_or_b32 s61,s47,s46
s_cbranch_scc1 L_mr_339
v_mov_b32 v120,s54
v_lshlrev_b32 v121,13,v1
s_mov_b32 s61,10486784
buffer_store_dword v120,v121,s[8:11],s61 offen sc1
L_mr_339:
s_cmp_lg_u32 s31,63
s_cbranch_scc1 L_mo_343
s_min_i32 s77,s77,0
s_or_b32 s61,s47,s46
s_cbranch_scc1 L_mo_343
s_mov_b32 s59,11018240
v_lshlrev_b32 v120,2,v1
L_fp_354:
s_sleep 0
buffer_load_dword v121,v120,s[8:11],s59 offen sc1
s_sub_u32 s49,s49,1
s_cbranch_scc1 L_abort2
s_waitcnt vmcnt(0)
v_cmp_eq_u32 vcc,0,v121
s_cbranch_vccnz L_fp_354
s_andn2_b32 s62,0x7ff,s54
v_lshl_or_b32 v121,s62,8,v121
s_add_u32 s59,s59,8192
buffer_store_dword v121,v120,s[8:11],s59 offen sc1
s_add_u32 s59,s59,8192
buffer_store_dword v121,v120,s[8:11],s59 offen sc1
s_add_u32 s59,s59,8192
buffer_store_dword v121,v120,s[8:11],s59 offen sc1
s_add_u32 s59,s59,8192
buffer_store_dword v121,v120,s[8:11],s59 offen sc1
s_add_u32 s59,s59,8192
buffer_store_dword v121,v120,s[8:11],s59 offen sc1
s_add_u32 s59,s59,8192
buffer_store_dword v121,v120,s[8:11],s59 offen sc1
L_mo_343:
s_add_u32 s31,s31,1
s_cmp_gt_i32 s77,0
s_cmov_b32 s18,0
s_cbranch_scc1 L_mo_340
s_cmp_lg_u32 s77,0
s_cbranch_scc1 L_mo_344
s_andn2_b32 s51,0x7ff,s54
s_lshr_b32 s51,s51,5
s_add_u32 s73,s73,2
s_mov_b32 s86,1
s_mov_b32 s19,0
s_mov_b32 s18,0
s_waitcnt vmcnt(8)
s_barrier
s_and_b32 s64,s54,0x7ff
s_sub_u32 s64,2047,s64
s_lshl_b32 s56,s64,10
s_add_u32 s58,s56,4194304
buffer_load_dwordx4 v[88:91],v0,s[8:11],s58 offen sc1
s_mov_b32 s4,s38
s_mov_b32 s5,s39
s_mov_b32 s6,1835008
s_mov_b32 s7,0x20000
v_and_b32 v9,15,v1
v_lshrrev_b32 v10,4,v1
v_lshlrev_b32 v8,14,v10
v_lshl_add_u32 v8,v9,4,v8
s_lshl_b32 s59,s47,16
s_lshl_b32 s60,s46,8
s_add_u32 s59,s59,s60
buffer_load_dwordx4 v[24:27],v8,s[4:7],s59 offen offset:0
buffer_load_dwordx4 v[28:31],v8,s[4:7],s59 offen offset:1024
buffer_load_dwordx4 v[32:35],v8,s[4:7],s59 offen offset:2048
buffer_load_dwordx4 v[36:39],v8,s[4:7],s59 offen offset:3072
s_add_u32 s59,s59,4096
buffer_load_dwordx4 v[40:43],v8,s[4:7],s59 offen offset:0
buffer_load_dwordx4 v[44:47],v8,s[4:7],s59 offen offset:1024
buffer_load_dwordx4 v[48:51],v8,s[4:7],s59 offen offset:2048
buffer_load_dwordx4 v[52:55],v8,s[4:7],s59 offen offset:3072
s_add_u32 s59,s59,4096
buffer_load_dwordx4 v[56:59],v8,s[4:7],s59 offen offset:0
buffer_load_dwordx4 v[60:63],v8,s[4:7],s59 offen offset:1024
buffer_load_dwordx4 v[64:67],v8,s[4:7],s59 offen offset:2048
buffer_load_dwordx4 v[68:71],v8,s[4:7],s59 offen offset:3072
s_add_u32 s59,s59,4096
buffer_load_dwordx4 v[72:75],v8,s[4:7],s59 offen offset:0
buffer_load_dwordx4 v[76:79],v8,s[4:7],s59 offen offset:1024
buffer_load_dwordx4 v[80:83],v8,s[4:7],s59 offen offset:2048
buffer_load_dwordx4 v[84:87],v8,s[4:7],s59 offen offset:3072
v_and_b32 v124,1,v1
v_lshlrev_b32 v124,4,v124
v_mov_b32 v125,0xffff
v_lshlrev_b32 v125,v124,v125
v_lshrrev_b32 v124,1,v9
v_cmp_eq_u32 vcc,0,v124
s_nop 1
v_cndmask_b32 v12,0,v125,vcc
v_cmp_eq_u32 vcc,1,v124
s_nop 1
v_cndmask_b32 v13,0,v125,vcc
v_cmp_eq_u32 vcc,2,v124
s_nop 1
v_cndmask_b32 v14,0,v125,vcc
v_cmp_eq_u32 vcc,3,v124
s_nop 1
v_cndmask_b32 v15,0,v125,vcc
s_waitcnt vmcnt(16)
L_mx_355:
v_max3_u32 v124,v88,v89,v90
v_max_u32 v124,v91,v124
v_cmp_eq_u32 vcc,-1,v124
s_cbranch_vccz L_mxd_356
buffer_load_dwordx4 v[88:91],v0,s[8:11],s58 offen sc1
s_sub_u32 s49,s49,1
s_cbranch_scc1 L_abort2
s_waitcnt vmcnt(0)
s_branch L_mx_355
L_mxd_356:
v_lshlrev_b32 v96,16,v88
v_and_b32 v97,0xffff0000,v88
v_lshlrev_b32 v98,16,v89
v_and_b32 v99,0xffff0000,v89
v_lshlrev_b32 v100,16,v90
v_and_b32 v101,0xffff0000,v90
v_lshlrev_b32 v102,16,v91
v_and_b32 v103,0xffff0000,v91
v_readfirstlane_b32 s78,v96
s_nop 1
v_pk_add_f32 v[108:109],v[96:97],s[78:79] op_sel_hi:[1,0] neg_lo:[0,1] neg_hi:[0,1]
v_pk_add_f32 v[110:111],v[98:99],s[78:79] op_sel_hi:[1,0] neg_lo:[0,1] neg_hi:[0,1]
v_pk_add_f32 v[112:113],v[100:101],s[78:79] op_sel_hi:[1,0] neg_lo:[0,1] neg_hi:[0,1]
v_pk_add_f32 v[114:115],v[102:103],s[78:79] op_sel_hi:[1,0] neg_lo:[0,1] neg_hi:[0,1]
v_pk_add_f32 v[116:117],v[108:109],v[110:111]
v_pk_mul_f32 v[118:119],v[108:109],v[108:109]
v_pk_add_f32 v[120:121],v[112:113],v[114:115]
v_pk_fma_f32 v[118:119],v[110:111],v[110:111],v[118:119]
v_pk_add_f32 v[116:117],v[116:117],v[120:121]
v_pk_fma_f32 v[118:119],v[112:113],v[112:113],v[118:119]
v_add_f32 v116,v116,v117
v_pk_fma_f32 v[118:119],v[114:115],v[114:115],v[118:119]
v_add_f32 v118,v118,v119
s_nop 1
v_permlane32_swap_b32 v116,v118
v_add_f32 v116,v116,v118
s_nop 1
v_add_f32_dpp v116,v116,v116 row_ror:8 row_mask:0xf bank_mask:0xf
s_nop 1
v_add_f32_dpp v116,v116,v116 row_ror:4 row_mask:0xf bank_mask:0xf
s_nop 1
v_add_f32_dpp v116,v116,v116 row_ror:2 row_mask:0xf bank_mask:0xf
s_nop 1
v_add_f32_dpp v116,v116,v116 row_ror:1 row_mask:0xf bank_mask:0xf
v_mov_b32 v118,v116
s_nop 1
v_permlane16_swap_b32 v116,v118
v_add_f32 v116,v116,v118
v_mul_f32 v116,0x3b000000,v116
v_mov_b32 v118,v116
s_nop 1
v_permlane32_swap_b32 v116,v118
v_fma_f32 v118,-v116,v116,v118
v_add_f32 v116,s78,v116
v_max_f32 v118,0,v118
v_cvt_pk_bf16_f32 v118,v116,v118
v_lshlrev_b32 v116,16,v118
v_and_b32 v118,0xffff0000,v118
v_add_f32 v118,0x3727c5ac,v118
v_cvt_pk_bf16_f32 v118,v118,v118
v_and_b32 v118,0xffff0000,v118
v_sqrt_f32 v118,v118
v_pk_add_f32 v[108:109],v[96:97],v[116:117] op_sel_hi:[1,0] neg_lo:[0,1] neg_hi:[0,1]
v_pk_add_f32 v[110:111],v[98:99],v[116:117] op_sel_hi:[1,0] neg_lo:[0,1] neg_hi:[0,1]
v_pk_add_f32 v[112:113],v[100:101],v[116:117] op_sel_hi:[1,0] neg_lo:[0,1] neg_hi:[0,1]
v_pk_add_f32 v[114:115],v[102:103],v[116:117] op_sel_hi:[1,0] neg_lo:[0,1] neg_hi:[0,1]
v_cvt_pk_bf16_f32 v118,v118,v118
v_and_b32 v118,0xffff0000,v118
v_rcp_f32 v118,v118
v_cvt_pk_bf16_f32 v104,v108,v109
v_cvt_pk_bf16_f32 v105,v110,v111
v_cvt_pk_bf16_f32 v106,v112,v113
v_cvt_pk_bf16_f32 v107,v114,v115
v_lshlrev_b32 v108,16,v104
v_and_b32 v109,0xffff0000,v104
v_lshlrev_b32 v110,16,v105
v_and_b32 v111,0xffff0000,v105
v_lshlrev_b32 v112,16,v106
v_and_b32 v113,0xffff0000,v106
v_lshlrev_b32 v114,16,v107
v_and_b32 v115,0xffff0000,v107
v_pk_mul_f32 v[108:109],v[108:109],v[118:119] op_sel_hi:[1,0]
v_pk_mul_f32 v[110:111],v[110:111],v[118:119] op_sel_hi:[1,0]
v_pk_mul_f32 v[112:113],v[112:113],v[118:119] op_sel_hi:[1,0]
v_pk_mul_f32 v[114:115],v[114:115],v[118:119] op_sel_hi:[1,0]
v_cvt_pk_bf16_f32 v104,v108,v109
v_cvt_pk_bf16_f32 v105,v110,v111
v_cvt_pk_bf16_f32 v106,v112,v113
v_cvt_pk_bf16_f32 v107,v114,v115
s_mov_b32 s58,0x01000100
s_mov_b32 s59,0x03020302
v_perm_b32 v88,v104,v104,s58
v_perm_b32 v89,v104,v104,s59
v_perm_b32 v90,v105,v105,s58
v_perm_b32 v91,v105,v105,s59
v_perm_b32 v92,v106,v106,s58
v_perm_b32 v93,v106,v106,s59
v_perm_b32 v94,v107,v107,s58
v_perm_b32 v95,v107,v107,s59
v_lshlrev_b32 v8,5,v1
s_lshl_b32 s58,s46,11
s_add_u32 s58,s58,139264
v_add_u32 v8,s58,v8
ds_write_b128 v8,v[88:91]
ds_write_b128 v8,v[92:95] offset:16
s_lshl_b32 s59,s46,9
s_add_u32 s59,s58,s59
v_lshlrev_b32 v8,7,v10
v_add_u32 v8,s59,v8
s_waitcnt lgkmcnt(0)
ds_read_b128 v[108:111],v18 offset:0
ds_read_b128 v[88:91],v8 offset:0
ds_read_b128 v[92:95],v8 offset:16
ds_read_b128 v[112:115],v18 offset:1024
s_waitcnt lgkmcnt(1)
v_and_b32 v124,v12,v88
v_and_b32 v125,v13,v88
v_and_b32 v126,v14,v88
v_and_b32 v127,v15,v88
s_nop 1
v_mfma_f32_16x16x32_bf16 v[116:119],v[124:127],v[108:111],0
ds_read_b128 v[108:111],v18 offset:2048
s_waitcnt lgkmcnt(1)
v_and_b32 v124,v12,v89
v_and_b32 v125,v13,v89
v_and_b32 v126,v14,v89
v_and_b32 v127,v15,v89
s_nop 1
v_mfma_f32_16x16x32_bf16 v[116:119],v[124:127],v[112:115],v[116:119]
ds_read_b128 v[112:115],v18 offset:3072
s_waitcnt lgkmcnt(1)
v_and_b32 v124,v12,v90
v_and_b32 v125,v13,v90
v_and_b32 v126,v14,v90
v_and_b32 v127,v15,v90
s_nop 1
v_mfma_f32_16x16x32_bf16 v[116:119],v[124:127],v[108:111],v[116:119]
ds_read_b128 v[108:111],v18 offset:4096
s_waitcnt lgkmcnt(1)
v_and_b32 v124,v12,v91
v_and_b32 v125,v13,v91
v_and_b32 v126,v14,v91
v_and_b32 v127,v15,v91
s_nop 1
v_mfma_f32_16x16x32_bf16 v[116:119],v[124:127],v[112:115],v[116:119]
ds_read_b128 v[112:115],v18 offset:5120
s_waitcnt lgkmcnt(1)
v_and_b32 v124,v12,v92
v_and_b32 v125,v13,v92
v_and_b32 v126,v14,v92
v_and_b32 v127,v15,v92
s_nop 1
v_mfma_f32_16x16x32_bf16 v[116:119],v[124:127],v[108:111],v[116:119]
ds_read_b128 v[108:111],v18 offset:6144
s_waitcnt lgkmcnt(1)
v_and_b32 v124,v12,v93
v_and_b32 v125,v13,v93
v_and_b32 v126,v14,v93
v_and_b32 v127,v15,v93
s_nop 1
v_mfma_f32_16x16x32_bf16 v[116:119],v[124:127],v[112:115],v[116:119]
ds_read_b128 v[112:115],v18 offset:7168
s_waitcnt lgkmcnt(1)
v_and_b32 v124,v12,v94
v_and_b32 v125,v13,v94
v_and_b32 v126,v14,v94
v_and_b32 v127,v15,v94
s_nop 1
v_mfma_f32_16x16x32_bf16 v[116:119],v[124:127],v[108:111],v[116:119]
ds_read_b128 v[108:111],v18 offset:8192
s_waitcnt lgkmcnt(1)
v_and_b32 v124,v12,v95
v_and_b32 v125,v13,v95
v_and_b32 v126,v14,v95
v_and_b32 v127,v15,v95
s_nop 1
v_mfma_f32_16x16x32_bf16 v[116:119],v[124:127],v[112:115],v[116:119]
ds_read_b128 v[88:91],v8 offset:32
ds_read_b128 v[92:95],v8 offset:48
ds_read_b128 v[112:115],v18 offset:9216
s_waitcnt lgkmcnt(1)
v_and_b32 v124,v12,v88
v_and_b32 v125,v13,v88
v_and_b32 v126,v14,v88
v_and_b32 v127,v15,v88
s_nop 1
v_mfma_f32_16x16x32_bf16 v[116:119],v[124:127],v[108:111],v[116:119]
ds_read_b128 v[108:111],v18 offset:10240
s_waitcnt lgkmcnt(1)
v_and_b32 v124,v12,v89
v_and_b32 v125,v13,v89
v_and_b32 v126,v14,v89
v_and_b32 v127,v15,v89
s_nop 1
v_mfma_f32_16x16x32_bf16 v[116:119],v[124:127],v[112:115],v[116:119]
ds_read_b128 v[112:115],v18 offset:11264
s_waitcnt lgkmcnt(1)
v_and_b32 v124,v12,v90
v_and_b32 v125,v13,v90
v_and_b32 v126,v14,v90
v_and_b32 v127,v15,v90
s_nop 1
v_mfma_f32_16x16x32_bf16 v[116:119],v[124:127],v[108:111],v[116:119]
ds_read_b128 v[108:111],v18 offset:12288
s_waitcnt lgkmcnt(1)
v_and_b32 v124,v12,v91
v_and_b32 v125,v13,v91
v_and_b32 v126,v14,v91
v_and_b32 v127,v15,v91
s_nop 1
v_mfma_f32_16x16x32_bf16 v[116:119],v[124:127],v[112:115],v[116:119]
ds_read_b128 v[112:115],v18 offset:13312
s_waitcnt lgkmcnt(1)
v_and_b32 v124,v12,v92
v_and_b32 v125,v13,v92
v_and_b32 v126,v14,v92
v_and_b32 v127,v15,v92
s_nop 1
v_mfma_f32_16x16x32_bf16 v[116:119],v[124:127],v[108:111],v[116:119]
ds_read_b128 v[108:111],v18 offset:14336
s_waitcnt lgkmcnt(1)
v_and_b32 v124,v12,v93
v_and_b32 v125,v13,v93
v_and_b32 v126,v14,v93
v_and_b32 v127,v15,v93
s_nop 1
v_mfma_f32_16x16x32_bf16 v[116:119],v[124:127],v[112:115],v[116:119]
ds_read_b128 v[112:115],v18 offset:15360
s_waitcnt lgkmcnt(1)
v_and_b32 v124,v12,v94
v_and_b32 v125,v13,v94
v_and_b32 v126,v14,v94
v_and_b32 v127,v15,v94
s_nop 1
v_mfma_f32_16x16x32_bf16 v[116:119],v[124:127],v[108:111],v[116:119]
ds_read_b128 v[108:111],v18 offset:16384
s_waitcnt lgkmcnt(1)
v_and_b32 v124,v12,v95
v_and_b32 v125,v13,v95
v_and_b32 v126,v14,v95
v_and_b32 v127,v15,v95
s_nop 1
v_mfma_f32_16x16x32_bf16 v[116:119],v[124:127],v[112:115],v[116:119]
ds_read_b128 v[88:91],v8 offset:64
ds_read_b128 v[92:95],v8 offset:80
ds_read_b128 v[112:115],v18 offset:17408
s_waitcnt lgkmcnt(1)
v_and_b32 v124,v12,v88
v_and_b32 v125,v13,v88
v_and_b32 v126,v14,v88
v_and_b32 v127,v15,v88
s_nop 1
v_mfma_f32_16x16x32_bf16 v[116:119],v[124:127],v[108:111],v[116:119]
ds_read_b128 v[108:111],v18 offset:18432
s_waitcnt lgkmcnt(1)
v_and_b32 v124,v12,v89
v_and_b32 v125,v13,v89
v_and_b32 v126,v14,v89
v_and_b32 v127,v15,v89
s_nop 1
v_mfma_f32_16x16x32_bf16 v[116:119],v[124:127],v[112:115],v[116:119]
ds_read_b128 v[112:115],v18 offset:19456
s_waitcnt lgkmcnt(1)
v_and_b32 v124,v12,v90
v_and_b32 v125,v13,v90
v_and_b32 v126,v14,v90
v_and_b32 v127,v15,v90
s_nop 1
v_mfma_f32_16x16x32_bf16 v[116:119],v[124:127],v[108:111],v[116:119]
ds_read_b128 v[108:111],v18 offset:20480
s_waitcnt lgkmcnt(1)
v_and_b32 v124,v12,v91
v_and_b32 v125,v13,v91
v_and_b32 v126,v14,v91
v_and_b32 v127,v15,v91
s_nop 1
v_mfma_f32_16x16x32_bf16 v[116:119],v[124:127],v[112:115],v[116:119]
ds_read_b128 v[112:115],v18 offset:21504
s_waitcnt lgkmcnt(1)
v_and_b32 v124,v12,v92
v_and_b32 v125,v13,v92
v_and_b32 v126,v14,v92
v_and_b32 v127,v15,v92
s_nop 1
v_mfma_f32_16x16x32_bf16 v[116:119],v[124:127],v[108:111],v[116:119]
ds_read_b128 v[108:111],v18 offset:22528
s_waitcnt lgkmcnt(1)
v_and_b32 v124,v12,v93
v_and_b32 v125,v13,v93
v_and_b32 v126,v14,v93
v_and_b32 v127,v15,v93
s_nop 1
v_mfma_f32_16x16x32_bf16 v[116:119],v[124:127],v[112:115],v[116:119]
ds_read_b128 v[112:115],v18 offset:23552
s_waitcnt lgkmcnt(1)
v_and_b32 v124,v12,v94
v_and_b32 v125,v13,v94
v_and_b32 v126,v14,v94
v_and_b32 v127,v15,v94
s_nop 1
v_mfma_f32_16x16x32_bf16 v[116:119],v[124:127],v[108:111],v[116:119]
ds_read_b128 v[108:111],v18 offset:24576
s_waitcnt lgkmcnt(1)
v_and_b32 v124,v12,v95
v_and_b32 v125,v13,v95
v_and_b32 v126,v14,v95
v_and_b32 v127,v15,v95
s_nop 1
v_mfma_f32_16x16x32_bf16 v[116:119],v[124:127],v[112:115],v[116:119]
ds_read_b128 v[88:91],v8 offset:96
ds_read_b128 v[92:95],v8 offset:112
ds_read_b128 v[112:115],v18 offset:25600
s_waitcnt lgkmcnt(1)
v_and_b32 v124,v12,v88
v_and_b32 v125,v13,v88
v_and_b32 v126,v14,v88
v_and_b32 v127,v15,v88
s_nop 1
v_mfma_f32_16x16x32_bf16 v[116:119],v[124:127],v[108:111],v[116:119]
ds_read_b128 v[108:111],v18 offset:26624
s_waitcnt lgkmcnt(1)
v_and_b32 v124,v12,v89
v_and_b32 v125,v13,v89
v_and_b32 v126,v14,v89
v_and_b32 v127,v15,v89
s_nop 1
v_mfma_f32_16x16x32_bf16 v[116:119],v[124:127],v[112:115],v[116:119]
ds_read_b128 v[112:115],v18 offset:27648
s_waitcnt lgkmcnt(1)
v_and_b32 v124,v12,v90
v_and_b32 v125,v13,v90
v_and_b32 v126,v14,v90
v_and_b32 v127,v15,v90
s_nop 1
v_mfma_f32_16x16x32_bf16 v[116:119],v[124:127],v[108:111],v[116:119]
ds_read_b128 v[108:111],v18 offset:28672
s_waitcnt lgkmcnt(1)
v_and_b32 v124,v12,v91
v_and_b32 v125,v13,v91
v_and_b32 v126,v14,v91
v_and_b32 v127,v15,v91
s_nop 1
v_mfma_f32_16x16x32_bf16 v[116:119],v[124:127],v[112:115],v[116:119]
ds_read_b128 v[112:115],v18 offset:29696
s_waitcnt lgkmcnt(1)
v_and_b32 v124,v12,v92
v_and_b32 v125,v13,v92
v_and_b32 v126,v14,v92
v_and_b32 v127,v15,v92
s_nop 1
v_mfma_f32_16x16x32_bf16 v[116:119],v[124:127],v[108:111],v[116:119]
ds_read_b128 v[108:111],v18 offset:30720
s_waitcnt lgkmcnt(1)
v_and_b32 v124,v12,v93
v_and_b32 v125,v13,v93
v_and_b32 v126,v14,v93
v_and_b32 v127,v15,v93
s_nop 1
v_mfma_f32_16x16x32_bf16 v[116:119],v[124:127],v[112:115],v[116:119]
ds_read_b128 v[112:115],v18 offset:31744
s_waitcnt lgkmcnt(1)
v_and_b32 v124,v12,v94
v_and_b32 v125,v13,v94
v_and_b32 v126,v14,v94
v_and_b32 v127,v15,v94
s_nop 1
v_mfma_f32_16x16x32_bf16 v[116:119],v[124:127],v[108:111],v[116:119]
s_waitcnt lgkmcnt(0)
v_and_b32 v124,v12,v95
v_and_b32 v125,v13,v95
v_and_b32 v126,v14,v95
v_and_b32 v127,v15,v95
s_nop 1
v_mfma_f32_16x16x32_bf16 v[116:119],v[124:127],v[112:115],v[116:119]
v_lshlrev_b32 v8,5,v9
v_and_b32 v124,1,v10
v_lshl_add_u32 v8,v124,4,v8
v_lshrrev_b32 v124,1,v10
v_lshl_add_u32 v8,v124,11,v8
s_lshl_b32 s60,s46,9
s_add_u32 s60,s60,147456
v_add_u32 v8,s60,v8
ds_write_b128 v8,v[116:119]
v_lshlrev_b32 v8,2,v1
v_add_u32 v8,147456,v8
s_waitcnt lgkmcnt(0)
s_barrier
ds_read2st64_b32 v[88:89],v8 offset0:0 offset1:1
ds_read2st64_b32 v[90:91],v8 offset0:2 offset1:3
ds_read2st64_b32 v[92:93],v8 offset0:4 offset1:5
ds_read2st64_b32 v[94:95],v8 offset0:6 offset1:7
s_waitcnt lgkmcnt(0)
v_pk_add_f32 v[88:89],v[88:89],v[90:91]
v_pk_add_f32 v[92:93],v[92:93],v[94:95]
v_pk_add_f32 v[88:89],v[88:89],v[92:93]
v_cvt_pk_bf16_f32 v88,v88,v88
v_and_b32 v88,0xffff0000,v88
v_cvt_pk_bf16_f32 v89,v89,v89
v_and_b32 v89,0xffff0000,v89
v_mul_f32 v90,0xbfb8aa3b,v88
v_exp_f32 v90,v90
s_nop 0
v_add_f32 v90,1.0,v90
v_rcp_f32 v90,v90
s_nop 0
v_mul_f32 v88,v88,v90
v_cvt_pk_bf16_f32 v88,v88,v88
v_and_b32 v88,0xffff0000,v88
v_mul_f32 v88,v88,v89
v_cvt_pk_bf16_f32 v88,v88,v88
v_lshlrev_b32 v8,2,v1
v_add_u32 v8,s58,v8
ds_write_b32 v8,v88
v_lshlrev_b32 v8,6,v10
v_add_u32 v8,s58,v8
s_waitcnt lgkmcnt(0)
ds_read_b128 v[88:91],v8
ds_read_b128 v[92:95],v8 offset:16
ds_read_b128 v[108:111],v8 offset:32
ds_read_b128 v[112:115],v8 offset:48
s_waitcnt vmcnt(0) lgkmcnt(0)
v_and_b32 v124,v12,v88
v_and_b32 v125,v13,v88
v_and_b32 v126,v14,v88
v_and_b32 v127,v15,v88
s_nop 1
v_mfma_f32_16x16x32_bf16 v[116:119],v[124:127],v[24:27],0
v_and_b32 v124,v12,v89
v_and_b32 v125,v13,v89
v_and_b32 v126,v14,v89
v_and_b32 v127,v15,v89
s_nop 1
v_mfma_f32_16x16x32_bf16 v[116:119],v[124:127],v[28:31],v[116:119]
v_and_b32 v124,v12,v90
v_and_b32 v125,v13,v90
v_and_b32 v126,v14,v90
v_and_b32 v127,v15,v90
s_nop 1
v_mfma_f32_16x16x32_bf16 v[116:119],v[124:127],v[32:35],v[116:119]
v_and_b32 v124,v12,v91
v_and_b32 v125,v13,v91
v_and_b32 v126,v14,v91
v_and_b32 v127,v15,v91
s_nop 1
v_mfma_f32_16x16x32_bf16 v[116:119],v[124:127],v[36:39],v[116:119]
v_and_b32 v124,v12,v92
v_and_b32 v125,v13,v92
v_and_b32 v126,v14,v92
v_and_b32 v127,v15,v92
s_nop 1
v_mfma_f32_16x16x32_bf16 v[116:119],v[124:127],v[40:43],v[116:119]
v_and_b32 v124,v12,v93
v_and_b32 v125,v13,v93
v_and_b32 v126,v14,v93
v_and_b32 v127,v15,v93
s_nop 1
v_mfma_f32_16x16x32_bf16 v[116:119],v[124:127],v[44:47],v[116:119]
v_and_b32 v124,v12,v94
v_and_b32 v125,v13,v94
v_and_b32 v126,v14,v94
v_and_b32 v127,v15,v94
s_nop 1
v_mfma_f32_16x16x32_bf16 v[116:119],v[124:127],v[48:51],v[116:119]
v_and_b32 v124,v12,v95
v_and_b32 v125,v13,v95
v_and_b32 v126,v14,v95
v_and_b32 v127,v15,v95
s_nop 1
v_mfma_f32_16x16x32_bf16 v[116:119],v[124:127],v[52:55],v[116:119]
v_and_b32 v124,v12,v108
v_and_b32 v125,v13,v108
v_and_b32 v126,v14,v108
v_and_b32 v127,v15,v108
s_nop 1
v_mfma_f32_16x16x32_bf16 v[116:119],v[124:127],v[56:59],v[116:119]
v_and_b32 v124,v12,v109
v_and_b32 v125,v13,v109
v_and_b32 v126,v14,v109
v_and_b32 v127,v15,v109
s_nop 1
v_mfma_f32_16x16x32_bf16 v[116:119],v[124:127],v[60:63],v[116:119]
v_and_b32 v124,v12,v110
v_and_b32 v125,v13,v110
v_and_b32 v126,v14,v110
v_and_b32 v127,v15,v110
s_nop 1
v_mfma_f32_16x16x32_bf16 v[116:119],v[124:127],v[64:67],v[116:119]
v_and_b32 v124,v12,v111
v_and_b32 v125,v13,v111
v_and_b32 v126,v14,v111
v_and_b32 v127,v15,v111
s_nop 1
v_mfma_f32_16x16x32_bf16 v[116:119],v[124:127],v[68:71],v[116:119]
v_and_b32 v124,v12,v112
v_and_b32 v125,v13,v112
v_and_b32 v126,v14,v112
v_and_b32 v127,v15,v112
s_nop 1
v_mfma_f32_16x16x32_bf16 v[116:119],v[124:127],v[72:75],v[116:119]
v_and_b32 v124,v12,v113
v_and_b32 v125,v13,v113
v_and_b32 v126,v14,v113
v_and_b32 v127,v15,v113
s_nop 1
v_mfma_f32_16x16x32_bf16 v[116:119],v[124:127],v[76:79],v[116:119]
v_and_b32 v124,v12,v114
v_and_b32 v125,v13,v114
v_and_b32 v126,v14,v114
v_and_b32 v127,v15,v114
s_nop 1
v_mfma_f32_16x16x32_bf16 v[116:119],v[124:127],v[80:83],v[116:119]
v_and_b32 v124,v12,v115
v_and_b32 v125,v13,v115
v_and_b32 v126,v14,v115
v_and_b32 v127,v15,v115
s_nop 1
v_mfma_f32_16x16x32_bf16 v[116:119],v[124:127],v[84:87],v[116:119]
v_lshlrev_b32 v8,4,v9
v_and_b32 v124,1,v10
v_lshl_add_u32 v8,v124,3,v8
v_and_b32 v124,2,v10
v_lshl_add_u32 v8,v124,30,v8
s_lshl_b32 s65,s51,15
s_add_u32 s65,s65,92274688
s_lshl_b32 s59,s47,10
s_lshl_b32 s60,s46,8
s_add_u32 s59,s59,s60
s_add_u32 s59,s59,s65
v_cvt_pk_bf16_f32 v24,v116,v117
v_cvt_pk_bf16_f32 v25,v118,v119
buffer_store_dwordx2 v[24:25],v8,s[8:11],s59 offen sc1
s_lshl_b32 s59,s51,13
s_lshl2_add_u32 s59,s47,s59
s_add_u32 s59,s59,10486912
s_waitcnt vmcnt(0)
s_barrier
s_or_b32 s59,s59,s52
buffer_store_dword v17,off,s[8:11],s59 sc1
s_lshl_b32 s59,s51,13
s_add_u32 s59,s59,10486912
v_and_b32 v124,31,v1
v_lshlrev_b32 v124,2,v124
L_fw_358:
buffer_load_dword v125,v124,s[8:11],s59 offen sc1
s_sub_u32 s49,s49,1
s_cbranch_scc1 L_abort2
s_waitcnt vmcnt(0)
v_cmp_eq_u32 vcc,0,v125
s_cbranch_vccnz L_fw_358
s_add_u32 s63,s65,0
buffer_load_dwordx4 v[24:27],v22,s[8:11],s63 offen sc1
s_add_u32 s63,s65,4096
buffer_load_dwordx4 v[28:31],v22,s[8:11],s63 offen sc1
s_add_u32 s63,s65,8192
buffer_load_dwordx4 v[32:35],v22,s[8:11],s63 offen sc1
s_add_u32 s63,s65,12288
buffer_load_dwordx4 v[36:39],v22,s[8:11],s63 offen sc1
s_add_u32 s63,s65,16384
buffer_load_dwordx4 v[40:43],v22,s[8:11],s63 offen sc1
s_add_u32 s63,s65,20480
buffer_load_dwordx4 v[44:47],v22,s[8:11],s63 offen sc1
s_add_u32 s63,s65,24576
buffer_load_dwordx4 v[48:51],v22,s[8:11],s63 offen sc1
s_add_u32 s63,s65,28672
buffer_load_dwordx4 v[52:55],v22,s[8:11],s63 offen sc1
v_and_b32 v64,15,v1
v_and_b32 v65,1,v1
v_lshlrev_b32 v65,4,v65
v_mov_b32 v66,0x3f80
v_lshlrev_b32 v66,v65,v66
v_lshrrev_b32 v64,1,v64
v_cmp_eq_u32 vcc,0,v64
s_nop 1
v_cndmask_b32 v56,0,v66,vcc
v_cmp_eq_u32 vcc,1,v64
s_nop 1
v_cndmask_b32 v57,0,v66,vcc
v_cmp_eq_u32 vcc,2,v64
s_nop 1
v_cndmask_b32 v58,0,v66,vcc
v_cmp_eq_u32 vcc,3,v64
s_nop 1
v_cndmask_b32 v59,0,v66,vcc
s_waitcnt vmcnt(7)
s_nop 0
v_mfma_f32_16x16x32_bf16 v[60:63],v[56:59],v[24:27],0
s_waitcnt vmcnt(6)
v_mfma_f32_16x16x32_bf16 v[60:63],v[56:59],v[28:31],v[60:63]
s_waitcnt vmcnt(5)
v_mfma_f32_16x16x32_bf16 v[60:63],v[56:59],v[32:35],v[60:63]
s_waitcnt vmcnt(4)
v_mfma_f32_16x16x32_bf16 v[60:63],v[56:59],v[36:39],v[60:63]
s_waitcnt vmcnt(3)
v_mfma_f32_16x16x32_bf16 v[60:63],v[56:59],v[40:43],v[60:63]
s_waitcnt vmcnt(2)
v_mfma_f32_16x16x32_bf16 v[60:63],v[56:59],v[44:47],v[60:63]
s_waitcnt vmcnt(1)
v_mfma_f32_16x16x32_bf16 v[60:63],v[56:59],v[48:51],v[60:63]
s_waitcnt vmcnt(0)
v_mfma_f32_16x16x32_bf16 v[60:63],v[56:59],v[52:55],v[60:63]
s_nop 7
ds_write_b128 v21,v[60:63]
s_waitcnt lgkmcnt(0)
s_barrier
s_cmp_lg_u32 s46,0
s_cbranch_scc1 L_moed_357
v_lshlrev_b32 v56,5,v1
v_add_u32 v56,155648,v56
ds_read_b128 v[24:27],v56
ds_read_b128 v[28:31],v56 offset:16
s_and_b32 s59,s54,0xffff0000
s_xor_b32 s60,s59,0x80000000
s_xor_b32 s61,s59,0xffff0000
s_cmp_lt_i32 s59,0
s_cselect_b32 s59,s60,s61
v_mov_b32 v56,s59
v_mul_f32 v56,0xbfb8aa3b,v56
v_exp_f32 v56,v56
s_nop 0
v_add_f32 v56,1.0,v56
v_rcp_f32 v56,v56
s_nop 0
v_cvt_pk_bf16_f32 v56,v56,v56
v_and_b32 v56,0xffff0000,v56
v_lshlrev_b32 v48,16,v104
v_and_b32 v49,0xffff0000,v104
v_lshlrev_b32 v50,16,v105
v_and_b32 v51,0xffff0000,v105
v_lshlrev_b32 v52,16,v106
v_and_b32 v53,0xffff0000,v106
v_lshlrev_b32 v54,16,v107
v_and_b32 v55,0xffff0000,v107
s_waitcnt lgkmcnt(0)
v_cvt_pk_bf16_f32 v40,v24,v25
v_cvt_pk_bf16_f32 v41,v26,v27
v_cvt_pk_bf16_f32 v42,v28,v29
v_cvt_pk_bf16_f32 v43,v30,v31
v_lshlrev_b32 v24,16,v40
v_and_b32 v25,0xffff0000,v40
v_lshlrev_b32 v26,16,v41
v_and_b32 v27,0xffff0000,v41
v_lshlrev_b32 v28,16,v42
v_and_b32 v29,0xffff0000,v42
v_lshlrev_b32 v30,16,v43
v_and_b32 v31,0xffff0000,v43
v_mul_f32 v24,v24,v56
v_mul_f32 v25,v25,v56
v_mul_f32 v26,v26,v56
v_mul_f32 v27,v27,v56
v_mul_f32 v28,v28,v56
v_mul_f32 v29,v29,v56
v_mul_f32 v30,v30,v56
v_mul_f32 v31,v31,v56
v_cvt_pk_bf16_f32 v40,v24,v25
v_cvt_pk_bf16_f32 v41,v26,v27
v_cvt_pk_bf16_f32 v42,v28,v29
v_cvt_pk_bf16_f32 v43,v30,v31
v_lshlrev_b32 v24,16,v40
v_and_b32 v25,0xffff0000,v40
v_lshlrev_b32 v26,16,v41
v_and_b32 v27,0xffff0000,v41
v_lshlrev_b32 v28,16,v42
v_and_b32 v29,0xffff0000,v42
v_lshlrev_b32 v30,16,v43
v_and_b32 v31,0xffff0000,v43
v_add_f32 v24,v24,v48
v_add_f32 v25,v25,v49
v_add_f32 v26,v26,v50
v_add_f32 v27,v27,v51
v_add_f32 v28,v28,v52
v_add_f32 v29,v29,v53
v_add_f32 v30,v30,v54
v_add_f32 v31,v31,v55
v_cvt_pk_bf16_f32 v40,v24,v25
v_cvt_pk_bf16_f32 v41,v26,v27
v_cvt_pk_bf16_f32 v42,v28,v29
v_cvt_pk_bf16_f32 v43,v30,v31
v_lshlrev_b32 v24,16,v40
v_and_b32 v25,0xffff0000,v40
v_lshlrev_b32 v26,16,v41
v_and_b32 v27,0xffff0000,v41
v_lshlrev_b32 v28,16,v42
v_and_b32 v29,0xffff0000,v42
v_lshlrev_b32 v30,16,v43
v_and_b32 v31,0xffff0000,v43
v_add_f32 v96,v96,v24
v_add_f32 v97,v97,v25
v_add_f32 v98,v98,v26
v_add_f32 v99,v99,v27
v_add_f32 v100,v100,v28
v_add_f32 v101,v101,v29
v_add_f32 v102,v102,v30
v_add_f32 v103,v103,v31
v_cvt_pk_bf16_f32 v80,v96,v97
v_cvt_pk_bf16_f32 v81,v98,v99
v_cvt_pk_bf16_f32 v82,v100,v101
v_cvt_pk_bf16_f32 v83,v102,v103
v_lshlrev_b32 v96,16,v80
v_and_b32 v97,0xffff0000,v80
v_lshlrev_b32 v98,16,v81
v_and_b32 v99,0xffff0000,v81
v_lshlrev_b32 v100,16,v82
v_and_b32 v101,0xffff0000,v82
v_lshlrev_b32 v102,16,v83
v_and_b32 v103,0xffff0000,v83
v_readfirstlane_b32 s78,v96
s_nop 1
v_pk_add_f32 v[58:59],v[96:97],s[78:79] op_sel_hi:[1,0] neg_lo:[0,1] neg_hi:[0,1]
v_pk_add_f32 v[60:61],v[98:99],s[78:79] op_sel_hi:[1,0] neg_lo:[0,1] neg_hi:[0,1]
v_pk_add_f32 v[62:63],v[100:101],s[78:79] op_sel_hi:[1,0] neg_lo:[0,1] neg_hi:[0,1]
v_pk_add_f32 v[64:65],v[102:103],s[78:79] op_sel_hi:[1,0] neg_lo:[0,1] neg_hi:[0,1]
v_pk_add_f32 v[66:67],v[58:59],v[60:61]
v_pk_mul_f32 v[68:69],v[58:59],v[58:59]
v_pk_add_f32 v[70:71],v[62:63],v[64:65]
v_pk_fma_f32 v[68:69],v[60:61],v[60:61],v[68:69]
v_pk_add_f32 v[66:67],v[66:67],v[70:71]
v_pk_fma_f32 v[68:69],v[62:63],v[62:63],v[68:69]
v_add_f32 v66,v66,v67
v_pk_fma_f32 v[68:69],v[64:65],v[64:65],v[68:69]
v_add_f32 v68,v68,v69
s_nop 1
v_permlane32_swap_b32 v66,v68
v_add_f32 v66,v66,v68
s_nop 1
v_add_f32_dpp v66,v66,v66 row_ror:8 row_mask:0xf bank_mask:0xf
s_nop 1
v_add_f32_dpp v66,v66,v66 row_ror:4 row_mask:0xf bank_mask:0xf
s_nop 1
v_add_f32_dpp v66,v66,v66 row_ror:2 row_mask:0xf bank_mask:0xf
s_nop 1
v_add_f32_dpp v66,v66,v66 row_ror:1 row_mask:0xf bank_mask:0xf
v_mov_b32 v68,v66
s_nop 1
v_permlane16_swap_b32 v66,v68
v_add_f32 v66,v66,v68
v_mul_f32 v66,0x3b000000,v66
v_mov_b32 v68,v66
s_nop 1
v_permlane32_swap_b32 v66,v68
v_fma_f32 v68,-v66,v66,v68
v_add_f32 v66,s78,v66
v_max_f32 v68,0,v68
v_cvt_pk_bf16_f32 v68,v66,v68
v_lshlrev_b32 v66,16,v68
v_and_b32 v68,0xffff0000,v68
v_add_f32 v68,0x3727c5ac,v68
v_cvt_pk_bf16_f32 v68,v68,v68
v_and_b32 v68,0xffff0000,v68
v_sqrt_f32 v68,v68
v_pk_add_f32 v[58:59],v[96:97],v[66:67] op_sel_hi:[1,0] neg_lo:[0,1] neg_hi:[0,1]
v_pk_add_f32 v[60:61],v[98:99],v[66:67] op_sel_hi:[1,0] neg_lo:[0,1] neg_hi:[0,1]
v_pk_add_f32 v[62:63],v[100:101],v[66:67] op_sel_hi:[1,0] neg_lo:[0,1] neg_hi:[0,1]
v_pk_add_f32 v[64:65],v[102:103],v[66:67] op_sel_hi:[1,0] neg_lo:[0,1] neg_hi:[0,1]
v_cvt_pk_bf16_f32 v68,v68,v68
v_and_b32 v68,0xffff0000,v68
v_rcp_f32 v68,v68
v_cvt_pk_bf16_f32 v84,v58,v59
v_cvt_pk_bf16_f32 v85,v60,v61
v_cvt_pk_bf16_f32 v86,v62,v63
v_cvt_pk_bf16_f32 v87,v64,v65
v_lshlrev_b32 v58,16,v84
v_and_b32 v59,0xffff0000,v84
v_lshlrev_b32 v60,16,v85
v_and_b32 v61,0xffff0000,v85
v_lshlrev_b32 v62,16,v86
v_and_b32 v63,0xffff0000,v86
v_lshlrev_b32 v64,16,v87
v_and_b32 v65,0xffff0000,v87
v_pk_mul_f32 v[58:59],v[58:59],v[68:69] op_sel_hi:[1,0]
v_pk_mul_f32 v[60:61],v[60:61],v[68:69] op_sel_hi:[1,0]
v_pk_mul_f32 v[62:63],v[62:63],v[68:69] op_sel_hi:[1,0]
v_pk_mul_f32 v[64:65],v[64:65],v[68:69] op_sel_hi:[1,0]
v_cvt_pk_bf16_f32 v84,v58,v59
v_cvt_pk_bf16_f32 v85,v60,v61
v_cvt_pk_bf16_f32 v86,v62,v63
v_cvt_pk_bf16_f32 v87,v64,v65
s_lshl_b32 s58,s51,10
s_add_u32 s58,s58,11272192
s_add_u32 s59,s58,65536
s_cmp_eq_u32 s47,0
s_cselect_b32 s59,s59,0x80000000
s_add_u32 s57,s56,98566144
buffer_store_dwordx4 v[84:87],v0,s[8:11],s59 offen sc1
buffer_store_dwordx4 v[80:83],v0,s[8:11],s58 offen sc1
buffer_store_dwordx4 v[84:87],v0,s[8:11],s57 offen sc1
L_moed_357:
s_barrier
L_mo_344:
s_mov_b32 s77,-1
s_cmp_lt_u32 s31,64
s_cbranch_scc1 L_mo_340
s_cmp_eq_u32 s86,0
s_cbranch_scc1 L_mo_353
L_mo_346:
s_andn2_b32 s51,0x7ff,s54
s_lshr_b32 s51,s51,5
s_andn2_b32 s56,31,s54
v_lshrrev_b32 v2,10,v20
v_add_u32 v3,16,v2
v_add_u32 v8,96468992,v20
v_cmp_eq_u32 vcc,s56,v2
s_nop 1
v_cndmask_b32 v2,v20,v8,vcc
v_cmp_eq_u32 vcc,s56,v3
s_nop 1
v_cndmask_b32 v3,v20,v8,vcc
s_waitcnt vmcnt(0)
s_lshl_b32 s59,s51,13
s_add_u32 s59,s59,10487552
s_cmp_lg_u32 s46,0
s_cbranch_scc1 L_fd_362
v_and_b32 v124,31,v1
v_lshlrev_b32 v124,2,v124
s_branch L_ff_363
L_fw_361:
s_sleep 2
L_ff_363:
buffer_load_dword v125,v124,s[8:11],s59 offen sc1
s_sub_u32 s49,s49,1
s_cbranch_scc1 L_abort2
s_waitcnt vmcnt(0)
v_cmp_eq_u32 vcc,0,v125
s_cbranch_vccnz L_fw_361
L_fd_362:
s_barrier
s_or_b32 s72,s72,s52
buffer_store_dword v17,off,s[8:11],s72 sc1
s_lshl_b32 s66,s51,15
s_add_u32 s66,s66,2097152
s_add_u32 s67,s66,16384
s_add_u32 m0,s50,131072
s_nop 0
buffer_load_dwordx4 v2,s[8:11],s66 offen offset:0 sc1 lds
s_add_u32 m0,s50,135168
s_nop 0
buffer_load_dwordx4 v3,s[8:11],s67 offen offset:0 sc1 lds
s_add_u32 m0,s50,139008
s_nop 0
buffer_load_dwordx4 v2,s[8:11],s66 offen offset:256 sc1 lds
s_add_u32 m0,s50,143104
s_nop 0
buffer_load_dwordx4 v3,s[8:11],s67 offen offset:256 sc1 lds
s_add_u32 m0,s50,146944
s_nop 0
buffer_load_dwordx4 v2,s[8:11],s66 offen offset:512 sc1 lds
s_add_u32 m0,s50,151040
s_nop 0
buffer_load_dwordx4 v3,s[8:11],s67 offen offset:512 sc1 lds
s_lshl_b32 s58,s51,5
s_add_u32 s58,s58,s47
s_mul_i32 s58,s58,24576
s_add_u32 s58,s58,201326592
s_add_u32 s61,s58,s50
s_add_u32 s62,s61,4096
s_add_u32 s63,s61,16384
s_add_u32 s64,s61,20480
s_add_u32 s65,s61,s50
s_add_u32 s65,s65,8192
s_waitcnt vmcnt(4)
s_barrier
ds_read_b128 v[104:107],v4 offset:0
ds_read_b128 v[108:111],v4 offset:4096
ds_read_b128 v[112:115],v5 offset:0
ds_read_b128 v[116:119],v5 offset:4096
s_add_u32 m0,s50,154880
s_nop 0
buffer_load_dwordx4 v2,s[8:11],s66 offen offset:768 sc1 lds
s_add_u32 m0,s50,158976
s_nop 0
buffer_load_dwordx4 v3,s[8:11],s67 offen offset:768 sc1 lds
s_waitcnt lgkmcnt(2)
v_mfma_f32_16x16x32_bf16 v[24:27],a[128:131],v[104:107],0
ds_read_b128 v[120:123],v6 offset:0
v_mfma_f32_16x16x32_bf16 v[40:43],v[104:107],v[128:131],0
v_mfma_f32_16x16x32_bf16 v[28:31],a[128:131],v[108:111],0
ds_read_b128 v[124:127],v6 offset:4096
v_mfma_f32_16x16x32_bf16 v[44:47],v[108:111],v[128:131],0
v_mfma_f32_16x16x32_bf16 v[32:35],a[136:139],v[104:107],0
v_mfma_f32_16x16x32_bf16 v[48:51],v[104:107],v[136:139],0
v_mfma_f32_16x16x32_bf16 v[36:39],a[136:139],v[108:111],0
v_mfma_f32_16x16x32_bf16 v[52:55],v[108:111],v[136:139],0
s_waitcnt lgkmcnt(2)
v_mfma_f32_16x16x32_bf16 v[24:27],a[132:135],v[112:115],v[24:27]
ds_read_b128 v[104:107],v7 offset:0
v_mfma_f32_16x16x32_bf16 v[40:43],v[112:115],v[132:135],v[40:43]
v_mfma_f32_16x16x32_bf16 v[28:31],a[132:135],v[116:119],v[28:31]
ds_read_b128 v[108:111],v7 offset:4096
v_mfma_f32_16x16x32_bf16 v[44:47],v[116:119],v[132:135],v[44:47]
v_mfma_f32_16x16x32_bf16 v[32:35],a[140:143],v[112:115],v[32:35]
v_mfma_f32_16x16x32_bf16 v[48:51],v[112:115],v[140:143],v[48:51]
v_mfma_f32_16x16x32_bf16 v[36:39],a[140:143],v[116:119],v[36:39]
v_mfma_f32_16x16x32_bf16 v[52:55],v[116:119],v[140:143],v[52:55]
s_waitcnt vmcnt(4)
s_barrier
s_waitcnt lgkmcnt(2)
v_mfma_f32_16x16x32_bf16 v[24:27],a[144:147],v[120:123],v[24:27]
ds_read_b128 v[112:115],v4 offset:8192
v_mfma_f32_16x16x32_bf16 v[40:43],v[120:123],v[144:147],v[40:43]
v_mfma_f32_16x16x32_bf16 v[28:31],a[144:147],v[124:127],v[28:31]
ds_read_b128 v[116:119],v4 offset:12288
v_mfma_f32_16x16x32_bf16 v[44:47],v[124:127],v[144:147],v[44:47]
v_mfma_f32_16x16x32_bf16 v[32:35],a[152:155],v[120:123],v[32:35]
v_mfma_f32_16x16x32_bf16 v[48:51],v[120:123],v[152:155],v[48:51]
v_mfma_f32_16x16x32_bf16 v[36:39],a[152:155],v[124:127],v[36:39]
v_mfma_f32_16x16x32_bf16 v[52:55],v[124:127],v[152:155],v[52:55]
s_waitcnt lgkmcnt(2)
v_mfma_f32_16x16x32_bf16 v[24:27],a[148:151],v[104:107],v[24:27]
ds_read_b128 v[120:123],v5 offset:8192
v_mfma_f32_16x16x32_bf16 v[40:43],v[104:107],v[148:151],v[40:43]
v_mfma_f32_16x16x32_bf16 v[28:31],a[148:151],v[108:111],v[28:31]
ds_read_b128 v[124:127],v5 offset:12288
v_mfma_f32_16x16x32_bf16 v[44:47],v[108:111],v[148:151],v[44:47]
v_mfma_f32_16x16x32_bf16 v[32:35],a[156:159],v[104:107],v[32:35]
v_mfma_f32_16x16x32_bf16 v[48:51],v[104:107],v[156:159],v[48:51]
v_mfma_f32_16x16x32_bf16 v[36:39],a[156:159],v[108:111],v[36:39]
v_mfma_f32_16x16x32_bf16 v[52:55],v[108:111],v[156:159],v[52:55]
s_waitcnt lgkmcnt(2)
v_mfma_f32_16x16x32_bf16 v[24:27],a[160:163],v[112:115],v[24:27]
ds_read_b128 v[104:107],v6 offset:8192
v_mfma_f32_16x16x32_bf16 v[40:43],v[112:115],v[160:163],v[40:43]
v_mfma_f32_16x16x32_bf16 v[28:31],a[160:163],v[116:119],v[28:31]
ds_read_b128 v[108:111],v6 offset:12288
v_mfma_f32_16x16x32_bf16 v[44:47],v[116:119],v[160:163],v[44:47]
v_mfma_f32_16x16x32_bf16 v[32:35],a[168:171],v[112:115],v[32:35]
v_mfma_f32_16x16x32_bf16 v[48:51],v[112:115],v[168:171],v[48:51]
v_mfma_f32_16x16x32_bf16 v[36:39],a[168:171],v[116:119],v[36:39]
v_mfma_f32_16x16x32_bf16 v[52:55],v[116:119],v[168:171],v[52:55]
s_waitcnt lgkmcnt(2)
v_mfma_f32_16x16x32_bf16 v[24:27],a[164:167],v[120:123],v[24:27]
ds_read_b128 v[112:115],v7 offset:8192
v_mfma_f32_16x16x32_bf16 v[40:43],v[120:123],v[164:167],v[40:43]
v_mfma_f32_16x16x32_bf16 v[28:31],a[164:167],v[124:127],v[28:31]
ds_read_b128 v[116:119],v7 offset:12288
v_mfma_f32_16x16x32_bf16 v[44:47],v[124:127],v[164:167],v[44:47]
v_mfma_f32_16x16x32_bf16 v[32:35],a[172:175],v[120:123],v[32:35]
v_mfma_f32_16x16x32_bf16 v[48:51],v[120:123],v[172:175],v[48:51]
v_mfma_f32_16x16x32_bf16 v[36:39],a[172:175],v[124:127],v[36:39]
v_mfma_f32_16x16x32_bf16 v[52:55],v[124:127],v[172:175],v[52:55]
s_waitcnt vmcnt(2)
s_barrier
s_waitcnt lgkmcnt(2)
v_mfma_f32_16x16x32_bf16 v[24:27],a[176:179],v[104:107],v[24:27]
ds_read_b128 v[120:123],v4 offset:16384
v_mfma_f32_16x16x32_bf16 v[40:43],v[104:107],v[176:179],v[40:43]
v_mfma_f32_16x16x32_bf16 v[28:31],a[176:179],v[108:111],v[28:31]
ds_read_b128 v[124:127],v4 offset:20480
v_mfma_f32_16x16x32_bf16 v[44:47],v[108:111],v[176:179],v[44:47]
v_mfma_f32_16x16x32_bf16 v[32:35],a[184:187],v[104:107],v[32:35]
v_mfma_f32_16x16x32_bf16 v[48:51],v[104:107],v[184:187],v[48:51]
v_mfma_f32_16x16x32_bf16 v[36:39],a[184:187],v[108:111],v[36:39]
v_mfma_f32_16x16x32_bf16 v[52:55],v[108:111],v[184:187],v[52:55]
s_waitcnt lgkmcnt(2)
v_mfma_f32_16x16x32_bf16 v[24:27],a[180:183],v[112:115],v[24:27]
ds_read_b128 v[104:107],v5 offset:16384
v_mfma_f32_16x16x32_bf16 v[40:43],v[112:115],v[180:183],v[40:43]
v_mfma_f32_16x16x32_bf16 v[28:31],a[180:183],v[116:119],v[28:31]
ds_read_b128 v[108:111],v5 offset:20480
v_mfma_f32_16x16x32_bf16 v[44:47],v[116:119],v[180:183],v[44:47]
v_mfma_f32_16x16x32_bf16 v[32:35],a[188:191],v[112:115],v[32:35]
v_mfma_f32_16x16x32_bf16 v[48:51],v[112:115],v[188:191],v[48:51]
v_mfma_f32_16x16x32_bf16 v[36:39],a[188:191],v[116:119],v[36:39]
v_mfma_f32_16x16x32_bf16 v[52:55],v[116:119],v[188:191],v[52:55]
s_waitcnt lgkmcnt(2)
v_mfma_f32_16x16x32_bf16 v[24:27],a[192:195],v[120:123],v[24:27]
ds_read_b128 v[112:115],v6 offset:16384
v_mfma_f32_16x16x32_bf16 v[40:43],v[120:123],v[192:195],v[40:43]
v_mfma_f32_16x16x32_bf16 v[28:31],a[192:195],v[124:127],v[28:31]
ds_read_b128 v[116:119],v6 offset:20480
v_mfma_f32_16x16x32_bf16 v[44:47],v[124:127],v[192:195],v[44:47]
v_mfma_f32_16x16x32_bf16 v[32:35],a[200:203],v[120:123],v[32:35]
v_mfma_f32_16x16x32_bf16 v[48:51],v[120:123],v[200:203],v[48:51]
v_mfma_f32_16x16x32_bf16 v[36:39],a[200:203],v[124:127],v[36:39]
v_mfma_f32_16x16x32_bf16 v[52:55],v[124:127],v[200:203],v[52:55]
s_waitcnt lgkmcnt(2)
v_mfma_f32_16x16x32_bf16 v[24:27],a[196:199],v[104:107],v[24:27]
ds_read_b128 v[120:123],v7 offset:16384
v_mfma_f32_16x16x32_bf16 v[40:43],v[104:107],v[196:199],v[40:43]
v_mfma_f32_16x16x32_bf16 v[28:31],a[196:199],v[108:111],v[28:31]
ds_read_b128 v[124:127],v7 offset:20480
v_mfma_f32_16x16x32_bf16 v[44:47],v[108:111],v[196:199],v[44:47]
v_mfma_f32_16x16x32_bf16 v[32:35],a[204:207],v[104:107],v[32:35]
v_mfma_f32_16x16x32_bf16 v[48:51],v[104:107],v[204:207],v[48:51]
v_mfma_f32_16x16x32_bf16 v[36:39],a[204:207],v[108:111],v[36:39]
v_mfma_f32_16x16x32_bf16 v[52:55],v[108:111],v[204:207],v[52:55]
s_waitcnt vmcnt(0)
s_barrier
s_waitcnt lgkmcnt(2)
v_mfma_f32_16x16x32_bf16 v[24:27],a[208:211],v[112:115],v[24:27]
ds_read_b128 v[104:107],v4 offset:24576
v_mfma_f32_16x16x32_bf16 v[40:43],v[112:115],v[208:211],v[40:43]
v_mfma_f32_16x16x32_bf16 v[28:31],a[208:211],v[116:119],v[28:31]
ds_read_b128 v[108:111],v4 offset:28672
v_mfma_f32_16x16x32_bf16 v[44:47],v[116:119],v[208:211],v[44:47]
v_mfma_f32_16x16x32_bf16 v[32:35],a[216:219],v[112:115],v[32:35]
v_mfma_f32_16x16x32_bf16 v[48:51],v[112:115],v[216:219],v[48:51]
v_mfma_f32_16x16x32_bf16 v[36:39],a[216:219],v[116:119],v[36:39]
v_mfma_f32_16x16x32_bf16 v[52:55],v[116:119],v[216:219],v[52:55]
s_waitcnt lgkmcnt(2)
v_mfma_f32_16x16x32_bf16 v[24:27],a[212:215],v[120:123],v[24:27]
ds_read_b128 v[112:115],v5 offset:24576
v_mfma_f32_16x16x32_bf16 v[40:43],v[120:123],v[212:215],v[40:43]
v_mfma_f32_16x16x32_bf16 v[28:31],a[212:215],v[124:127],v[28:31]
ds_read_b128 v[116:119],v5 offset:28672
v_mfma_f32_16x16x32_bf16 v[44:47],v[124:127],v[212:215],v[44:47]
v_mfma_f32_16x16x32_bf16 v[32:35],a[220:223],v[120:123],v[32:35]
v_mfma_f32_16x16x32_bf16 v[48:51],v[120:123],v[220:223],v[48:51]
v_mfma_f32_16x16x32_bf16 v[36:39],a[220:223],v[124:127],v[36:39]
v_mfma_f32_16x16x32_bf16 v[52:55],v[124:127],v[220:223],v[52:55]
s_waitcnt lgkmcnt(2)
v_mfma_f32_16x16x32_bf16 v[24:27],a[224:227],v[104:107],v[24:27]
ds_read_b128 v[120:123],v6 offset:24576
v_mfma_f32_16x16x32_bf16 v[40:43],v[104:107],v[224:227],v[40:43]
v_mfma_f32_16x16x32_bf16 v[28:31],a[224:227],v[108:111],v[28:31]
ds_read_b128 v[124:127],v6 offset:28672
v_mfma_f32_16x16x32_bf16 v[44:47],v[108:111],v[224:227],v[44:47]
v_mfma_f32_16x16x32_bf16 v[32:35],a[232:235],v[104:107],v[32:35]
v_mfma_f32_16x16x32_bf16 v[48:51],v[104:107],v[232:235],v[48:51]
v_mfma_f32_16x16x32_bf16 v[36:39],a[232:235],v[108:111],v[36:39]
v_mfma_f32_16x16x32_bf16 v[52:55],v[108:111],v[232:235],v[52:55]
s_waitcnt lgkmcnt(2)
v_mfma_f32_16x16x32_bf16 v[24:27],a[228:231],v[112:115],v[24:27]
ds_read_b128 v[104:107],v7 offset:24576
v_mfma_f32_16x16x32_bf16 v[40:43],v[112:115],v[228:231],v[40:43]
v_mfma_f32_16x16x32_bf16 v[28:31],a[228:231],v[116:119],v[28:31]
ds_read_b128 v[108:111],v7 offset:28672
v_mfma_f32_16x16x32_bf16 v[44:47],v[116:119],v[228:231],v[44:47]
v_mfma_f32_16x16x32_bf16 v[32:35],a[236:239],v[112:115],v[32:35]
v_mfma_f32_16x16x32_bf16 v[48:51],v[112:115],v[236:239],v[48:51]
v_mfma_f32_16x16x32_bf16 v[36:39],a[236:239],v[116:119],v[36:39]
v_mfma_f32_16x16x32_bf16 v[52:55],v[116:119],v[236:239],v[52:55]
s_waitcnt lgkmcnt(2)
v_mfma_f32_16x16x32_bf16 v[24:27],a[240:243],v[120:123],v[24:27]
ds_read_b128 v[112:115],v4 offset:0
v_mfma_f32_16x16x32_bf16 v[40:43],v[120:123],v[240:243],v[40:43]
v_mfma_f32_16x16x32_bf16 v[28:31],a[240:243],v[124:127],v[28:31]
ds_read_b128 v[116:119],v4 offset:4096
v_mfma_f32_16x16x32_bf16 v[44:47],v[124:127],v[240:243],v[44:47]
v_mfma_f32_16x16x32_bf16 v[32:35],a[248:251],v[120:123],v[32:35]
v_mfma_f32_16x16x32_bf16 v[48:51],v[120:123],v[248:251],v[48:51]
v_mfma_f32_16x16x32_bf16 v[36:39],a[248:251],v[124:127],v[36:39]
v_mfma_f32_16x16x32_bf16 v[52:55],v[124:127],v[248:251],v[52:55]
s_waitcnt lgkmcnt(2)
v_mfma_f32_16x16x32_bf16 v[24:27],a[244:247],v[104:107],v[24:27]
ds_read_b128 v[120:123],v5 offset:0
v_mfma_f32_16x16x32_bf16 v[40:43],v[104:107],v[244:247],v[40:43]
v_mfma_f32_16x16x32_bf16 v[28:31],a[244:247],v[108:111],v[28:31]
ds_read_b128 v[124:127],v5 offset:4096
v_mfma_f32_16x16x32_bf16 v[44:47],v[108:111],v[244:247],v[44:47]
v_mfma_f32_16x16x32_bf16 v[32:35],a[252:255],v[104:107],v[32:35]
v_mfma_f32_16x16x32_bf16 v[48:51],v[104:107],v[252:255],v[48:51]
v_mfma_f32_16x16x32_bf16 v[36:39],a[252:255],v[108:111],v[36:39]
v_mfma_f32_16x16x32_bf16 v[52:55],v[108:111],v[252:255],v[52:55]
s_waitcnt lgkmcnt(2)
v_mfma_f32_16x16x32_bf16 v[88:91],a[0:3],v[112:115],0
ds_read_b128 v[104:107],v6 offset:0
v_mfma_f32_16x16x32_bf16 v[92:95],a[0:3],v[116:119],0
v_mfma_f32_16x16x32_bf16 v[96:99],a[8:11],v[112:115],0
ds_read_b128 v[108:111],v6 offset:4096
v_mfma_f32_16x16x32_bf16 v[100:103],a[8:11],v[116:119],0
s_waitcnt lgkmcnt(2)
v_mfma_f32_16x16x32_bf16 v[88:91],a[4:7],v[120:123],v[88:91]
ds_read_b128 v[112:115],v7 offset:0
v_mfma_f32_16x16x32_bf16 v[92:95],a[4:7],v[124:127],v[92:95]
v_cvt_pk_bf16_f32 v56,v24,v32
v_cvt_pk_bf16_f32 v57,v25,v33
v_mfma_f32_16x16x32_bf16 v[96:99],a[12:15],v[120:123],v[96:99]
ds_read_b128 v[116:119],v7 offset:4096
v_mfma_f32_16x16x32_bf16 v[100:103],a[12:15],v[124:127],v[100:103]
v_cvt_pk_bf16_f32 v58,v26,v34
v_cvt_pk_bf16_f32 v59,v27,v35
s_waitcnt lgkmcnt(2)
v_mfma_f32_16x16x32_bf16 v[88:91],a[16:19],v[104:107],v[88:91]
ds_read_b128 v[120:123],v4 offset:8192
v_mfma_f32_16x16x32_bf16 v[92:95],a[16:19],v[108:111],v[92:95]
buffer_store_dwordx4 v[56:59],v0,s[8:11],s61 offen sc1
v_cvt_pk_bf16_f32 v60,v28,v36
v_mfma_f32_16x16x32_bf16 v[96:99],a[24:27],v[104:107],v[96:99]
ds_read_b128 v[124:127],v4 offset:12288
v_mfma_f32_16x16x32_bf16 v[100:103],a[24:27],v[108:111],v[100:103]
v_cvt_pk_bf16_f32 v61,v29,v37
v_cvt_pk_bf16_f32 v62,v30,v38
s_waitcnt lgkmcnt(2)
v_mfma_f32_16x16x32_bf16 v[88:91],a[20:23],v[112:115],v[88:91]
ds_read_b128 v[104:107],v5 offset:8192
v_mfma_f32_16x16x32_bf16 v[92:95],a[20:23],v[116:119],v[92:95]
v_cvt_pk_bf16_f32 v63,v31,v39
buffer_store_dwordx4 v[60:63],v0,s[8:11],s62 offen sc1
v_mfma_f32_16x16x32_bf16 v[96:99],a[28:31],v[112:115],v[96:99]
ds_read_b128 v[108:111],v5 offset:12288
v_mfma_f32_16x16x32_bf16 v[100:103],a[28:31],v[116:119],v[100:103]
v_cvt_pk_bf16_f32 v64,v40,v41
v_cvt_pk_bf16_f32 v65,v42,v43
s_waitcnt lgkmcnt(2)
v_mfma_f32_16x16x32_bf16 v[88:91],a[32:35],v[120:123],v[88:91]
ds_read_b128 v[112:115],v6 offset:8192
v_mfma_f32_16x16x32_bf16 v[92:95],a[32:35],v[124:127],v[92:95]
v_cvt_pk_bf16_f32 v66,v44,v45
v_cvt_pk_bf16_f32 v67,v46,v47
v_mfma_f32_16x16x32_bf16 v[96:99],a[40:43],v[120:123],v[96:99]
ds_read_b128 v[116:119],v6 offset:12288
v_mfma_f32_16x16x32_bf16 v[100:103],a[40:43],v[124:127],v[100:103]
buffer_store_dwordx4 v[64:67],v0,s[8:11],s65 offen offset:0 sc1
v_cvt_pk_bf16_f32 v68,v48,v49
s_waitcnt lgkmcnt(2)
v_mfma_f32_16x16x32_bf16 v[88:91],a[36:39],v[104:107],v[88:91]
ds_read_b128 v[120:123],v7 offset:8192
v_mfma_f32_16x16x32_bf16 v[92:95],a[36:39],v[108:111],v[92:95]
v_cvt_pk_bf16_f32 v69,v50,v51
v_cvt_pk_bf16_f32 v70,v52,v53
v_mfma_f32_16x16x32_bf16 v[96:99],a[44:47],v[104:107],v[96:99]
ds_read_b128 v[124:127],v7 offset:12288
v_mfma_f32_16x16x32_bf16 v[100:103],a[44:47],v[108:111],v[100:103]
v_cvt_pk_bf16_f32 v71,v54,v55
buffer_store_dwordx4 v[68:71],v0,s[8:11],s65 offen offset:1024 sc1
s_waitcnt lgkmcnt(2)
v_mfma_f32_16x16x32_bf16 v[88:91],a[48:51],v[112:115],v[88:91]
ds_read_b128 v[104:107],v4 offset:16384
v_mfma_f32_16x16x32_bf16 v[92:95],a[48:51],v[116:119],v[92:95]
v_mfma_f32_16x16x32_bf16 v[96:99],a[56:59],v[112:115],v[96:99]
ds_read_b128 v[108:111],v4 offset:20480
v_mfma_f32_16x16x32_bf16 v[100:103],a[56:59],v[116:119],v[100:103]
s_waitcnt lgkmcnt(2)
v_mfma_f32_16x16x32_bf16 v[88:91],a[52:55],v[120:123],v[88:91]
ds_read_b128 v[112:115],v5 offset:16384
v_mfma_f32_16x16x32_bf16 v[92:95],a[52:55],v[124:127],v[92:95]
v_mfma_f32_16x16x32_bf16 v[96:99],a[60:63],v[120:123],v[96:99]
ds_read_b128 v[116:119],v5 offset:20480
v_mfma_f32_16x16x32_bf16 v[100:103],a[60:63],v[124:127],v[100:103]
s_waitcnt lgkmcnt(2)
v_mfma_f32_16x16x32_bf16 v[88:91],a[64:67],v[104:107],v[88:91]
ds_read_b128 v[120:123],v6 offset:16384
v_mfma_f32_16x16x32_bf16 v[92:95],a[64:67],v[108:111],v[92:95]
v_mfma_f32_16x16x32_bf16 v[96:99],a[72:75],v[104:107],v[96:99]
ds_read_b128 v[124:127],v6 offset:20480
v_mfma_f32_16x16x32_bf16 v[100:103],a[72:75],v[108:111],v[100:103]
s_waitcnt lgkmcnt(2)
v_mfma_f32_16x16x32_bf16 v[88:91],a[68:71],v[112:115],v[88:91]
ds_read_b128 v[104:107],v7 offset:16384
v_mfma_f32_16x16x32_bf16 v[92:95],a[68:71],v[116:119],v[92:95]
v_mfma_f32_16x16x32_bf16 v[96:99],a[76:79],v[112:115],v[96:99]
ds_read_b128 v[108:111],v7 offset:20480
v_mfma_f32_16x16x32_bf16 v[100:103],a[76:79],v[116:119],v[100:103]
s_waitcnt lgkmcnt(2)
v_mfma_f32_16x16x32_bf16 v[88:91],a[80:83],v[120:123],v[88:91]
ds_read_b128 v[112:115],v4 offset:24576
v_mfma_f32_16x16x32_bf16 v[92:95],a[80:83],v[124:127],v[92:95]
v_mfma_f32_16x16x32_bf16 v[96:99],a[88:91],v[120:123],v[96:99]
ds_read_b128 v[116:119],v4 offset:28672
v_mfma_f32_16x16x32_bf16 v[100:103],a[88:91],v[124:127],v[100:103]
s_waitcnt lgkmcnt(2)
v_mfma_f32_16x16x32_bf16 v[88:91],a[84:87],v[104:107],v[88:91]
ds_read_b128 v[120:123],v5 offset:24576
v_mfma_f32_16x16x32_bf16 v[92:95],a[84:87],v[108:111],v[92:95]
v_mfma_f32_16x16x32_bf16 v[96:99],a[92:95],v[104:107],v[96:99]
ds_read_b128 v[124:127],v5 offset:28672
v_mfma_f32_16x16x32_bf16 v[100:103],a[92:95],v[108:111],v[100:103]
s_waitcnt lgkmcnt(2)
v_mfma_f32_16x16x32_bf16 v[88:91],a[96:99],v[112:115],v[88:91]
ds_read_b128 v[104:107],v6 offset:24576
v_mfma_f32_16x16x32_bf16 v[92:95],a[96:99],v[116:119],v[92:95]
v_mfma_f32_16x16x32_bf16 v[96:99],a[104:107],v[112:115],v[96:99]
ds_read_b128 v[108:111],v6 offset:28672
v_mfma_f32_16x16x32_bf16 v[100:103],a[104:107],v[116:119],v[100:103]
s_waitcnt lgkmcnt(2)
v_mfma_f32_16x16x32_bf16 v[88:91],a[100:103],v[120:123],v[88:91]
ds_read_b128 v[112:115],v7 offset:24576
v_mfma_f32_16x16x32_bf16 v[92:95],a[100:103],v[124:127],v[92:95]
v_mfma_f32_16x16x32_bf16 v[96:99],a[108:111],v[120:123],v[96:99]
ds_read_b128 v[116:119],v7 offset:28672
v_mfma_f32_16x16x32_bf16 v[100:103],a[108:111],v[124:127],v[100:103]
s_waitcnt lgkmcnt(2)
v_mfma_f32_16x16x32_bf16 v[88:91],a[112:115],v[104:107],v[88:91]
v_mfma_f32_16x16x32_bf16 v[92:95],a[112:115],v[108:111],v[92:95]
v_mfma_f32_16x16x32_bf16 v[96:99],a[120:123],v[104:107],v[96:99]
v_mfma_f32_16x16x32_bf16 v[100:103],a[120:123],v[108:111],v[100:103]
s_waitcnt lgkmcnt(0)
v_mfma_f32_16x16x32_bf16 v[88:91],a[116:119],v[112:115],v[88:91]
v_mfma_f32_16x16x32_bf16 v[92:95],a[116:119],v[116:119],v[92:95]
v_mfma_f32_16x16x32_bf16 v[96:99],a[124:127],v[112:115],v[96:99]
v_mfma_f32_16x16x32_bf16 v[100:103],a[124:127],v[116:119],v[100:103]
s_nop 3
v_cvt_pk_bf16_f32 v104,v88,v96
v_cvt_pk_bf16_f32 v105,v89,v97
v_cvt_pk_bf16_f32 v106,v90,v98
v_cvt_pk_bf16_f32 v107,v91,v99
v_cvt_pk_bf16_f32 v108,v92,v100
v_cvt_pk_bf16_f32 v109,v93,v101
v_cvt_pk_bf16_f32 v110,v94,v102
v_cvt_pk_bf16_f32 v111,v95,v103
buffer_store_dwordx4 v[104:107],v0,s[8:11],s63 offen sc1
buffer_store_dwordx4 v[108:111],v0,s[8:11],s64 offen sc1
s_waitcnt vmcnt(6)
s_barrier
s_add_u32 m0,s50,131072
s_nop 0
buffer_load_dwordx4 v20,s[8:11],s70 offen offset:0 sc1 lds
s_add_u32 m0,s50,135168
s_nop 0
buffer_load_dwordx4 v20,s[8:11],s71 offen offset:0 sc1 lds
s_add_u32 m0,s50,139008
s_nop 0
buffer_load_dwordx4 v20,s[8:11],s70 offen offset:256 sc1 lds
s_add_u32 m0,s50,143104
s_nop 0
buffer_load_dwordx4 v20,s[8:11],s71 offen offset:256 sc1 lds
s_add_u32 m0,s50,146944
s_nop 0
buffer_load_dwordx4 v20,s[8:11],s70 offen offset:512 sc1 lds
s_add_u32 m0,s50,151040
s_nop 0
buffer_load_dwordx4 v20,s[8:11],s71 offen offset:512 sc1 lds
s_lshl_b32 s59,s51,13
s_lshl2_add_u32 s59,s47,s59
s_add_u32 s59,s59,10487680
s_waitcnt vmcnt(0)
s_barrier
s_or_b32 s59,s59,s52
buffer_store_dword v17,off,s[8:11],s59 sc1
s_mov_b32 s72,0x80000000
s_mov_b32 s86,0
s_mov_b32 s19,1
s_mov_b32 s18,0
s_cmp_lt_u32 s31,64
s_cbranch_scc1 L_mo_340
L_mo_353:
s_mov_b32 s51,64
s_and_b32 s61,s54,0x7ff
s_sub_u32 s61,2047,s61
s_lshr_b32 s61,s61,5
s_cmp_lg_u32 s46,0
s_cbranch_scc1 L_mw_364
s_mov_b32 s59,11018240
v_lshlrev_b32 v2,2,v1
L_fp_365:
s_sleep 2
buffer_load_dword v3,v2,s[8:11],s59 offen sc1
s_sub_u32 s49,s49,1
s_cbranch_scc1 L_abort2
s_waitcnt vmcnt(0)
v_cmp_eq_u32 vcc,0,v3
s_cbranch_vccnz L_fp_365
v_cmp_le_u32 vcc,s61,v1
s_nop 1
v_cndmask_b32 v2,1,2,vcc
v_cmp_ne_u32 s[84:85],v2,v3
s_lshl_b32 s56,s47,1
s_lshr_b64 s[20:21],s[84:85],s56
v_lshrrev_b32 v2,5,v1
v_lshrrev_b32 v3,v2,s20
v_and_b32 v3,1,v3
v_mul_u32_u24 v3,768,v3
v_lshlrev_b32 v2,13,v2
v_sub_u32 v2,v2,v3
v_and_b32 v3,31,v1
v_lshl_add_u32 v2,v3,2,v2
v_add_u32 v2,1536,v2
s_lshl_b32 s59,s47,14
s_add_u32 s59,s59,10485760
L_fp_366:
s_sleep 1
buffer_load_dword v3,v2,s[8:11],s59 offen sc1
s_sub_u32 s49,s49,1
s_cbranch_scc1 L_abort2
s_waitcnt vmcnt(0)
v_cmp_eq_u32 vcc,0,v3
s_cbranch_vccnz L_fp_366
v_max_u32_dpp v3,v3,v3 row_ror:8 row_mask:0xf bank_mask:0xf
s_nop 1
v_max_u32_dpp v3,v3,v3 row_ror:4 row_mask:0xf bank_mask:0xf
s_nop 1
v_max_u32_dpp v3,v3,v3 row_ror:2 row_mask:0xf bank_mask:0xf
s_nop 1
v_max_u32_dpp v3,v3,v3 row_ror:1 row_mask:0xf bank_mask:0xf
v_mov_b32 v2,v3
s_nop 1
v_permlane16_swap_b32 v3,v2
v_max_u32 v3,v3,v2
v_mov_b32 v2,v3
s_nop 1
v_permlane32_swap_b32 v3,v2
v_max_u32 v3,v3,v2
s_lshl_b32 s59,s51,13
s_lshl2_add_u32 s59,s47,s59
s_add_u32 s59,s59,10487424
buffer_store_dword v3,off,s[8:11],s59 sc1
L_mw_364:
s_barrier
s_lshl_b32 s59,s51,13
s_add_u32 s59,s59,10487424
v_and_b32 v124,31,v1
v_lshlrev_b32 v124,2,v124
s_branch L_ff_369
L_fw_367:
s_sleep 1
L_ff_369:
buffer_load_dword v125,v124,s[8:11],s59 offen sc1
s_sub_u32 s49,s49,1
s_cbranch_scc1 L_abort2
s_waitcnt vmcnt(0)
v_cmp_eq_u32 vcc,0,v125
s_cbranch_vccnz L_fw_367
v_max_u32_dpp v125,v125,v125 row_ror:8 row_mask:0xf bank_mask:0xf
s_nop 1
v_max_u32_dpp v125,v125,v125 row_ror:4 row_mask:0xf bank_mask:0xf
s_nop 1
v_max_u32_dpp v125,v125,v125 row_ror:2 row_mask:0xf bank_mask:0xf
s_nop 1
v_max_u32_dpp v125,v125,v125 row_ror:1 row_mask:0xf bank_mask:0xf
v_mov_b32 v124,v125
s_nop 1
v_permlane16_swap_b32 v125,v124
v_max_u32 v125,v125,v124
v_mov_b32 v124,v125
s_nop 1
v_permlane32_swap_b32 v125,v124
v_max_u32 v125,v125,v124
s_nop 0
v_readfirstlane_b32 s55,v125
s_and_b32 s64,s55,0x7ff
s_sub_u32 s64,2047,s64
s_lshl_b32 s56,s64,10
s_add_u32 s58,s56,6291456
buffer_load_dwordx4 v[88:91],v0,s[8:11],s58 offen sc1
s_mov_b32 s4,s38
s_mov_b32 s5,s39
s_mov_b32 s6,1835008
s_mov_b32 s7,0x20000
v_and_b32 v9,15,v1
v_lshrrev_b32 v10,4,v1
v_lshlrev_b32 v8,14,v10
v_lshl_add_u32 v8,v9,4,v8
s_lshl_b32 s59,s47,16
s_lshl_b32 s60,s46,8
s_add_u32 s59,s59,s60
buffer_load_dwordx4 v[24:27],v8,s[4:7],s59 offen offset:0
buffer_load_dwordx4 v[28:31],v8,s[4:7],s59 offen offset:1024
buffer_load_dwordx4 v[32:35],v8,s[4:7],s59 offen offset:2048
buffer_load_dwordx4 v[36:39],v8,s[4:7],s59 offen offset:3072
s_add_u32 s59,s59,4096
buffer_load_dwordx4 v[40:43],v8,s[4:7],s59 offen offset:0
buffer_load_dwordx4 v[44:47],v8,s[4:7],s59 offen offset:1024
buffer_load_dwordx4 v[48:51],v8,s[4:7],s59 offen offset:2048
buffer_load_dwordx4 v[52:55],v8,s[4:7],s59 offen offset:3072
s_add_u32 s59,s59,4096
buffer_load_dwordx4 v[56:59],v8,s[4:7],s59 offen offset:0
buffer_load_dwordx4 v[60:63],v8,s[4:7],s59 offen offset:1024
buffer_load_dwordx4 v[64:67],v8,s[4:7],s59 offen offset:2048
buffer_load_dwordx4 v[68:71],v8,s[4:7],s59 offen offset:3072
s_add_u32 s59,s59,4096
buffer_load_dwordx4 v[72:75],v8,s[4:7],s59 offen offset:0
buffer_load_dwordx4 v[76:79],v8,s[4:7],s59 offen offset:1024
buffer_load_dwordx4 v[80:83],v8,s[4:7],s59 offen offset:2048
buffer_load_dwordx4 v[84:87],v8,s[4:7],s59 offen offset:3072
v_and_b32 v124,1,v1
v_lshlrev_b32 v124,4,v124
v_mov_b32 v125,0xffff
v_lshlrev_b32 v125,v124,v125
v_lshrrev_b32 v124,1,v9
v_cmp_eq_u32 vcc,0,v124
s_nop 1
v_cndmask_b32 v12,0,v125,vcc
v_cmp_eq_u32 vcc,1,v124
s_nop 1
v_cndmask_b32 v13,0,v125,vcc
v_cmp_eq_u32 vcc,2,v124
s_nop 1
v_cndmask_b32 v14,0,v125,vcc
v_cmp_eq_u32 vcc,3,v124
s_nop 1
v_cndmask_b32 v15,0,v125,vcc
s_waitcnt vmcnt(16)
v_lshlrev_b32 v96,16,v88
v_and_b32 v97,0xffff0000,v88
v_lshlrev_b32 v98,16,v89
v_and_b32 v99,0xffff0000,v89
v_lshlrev_b32 v100,16,v90
v_and_b32 v101,0xffff0000,v90
v_lshlrev_b32 v102,16,v91
v_and_b32 v103,0xffff0000,v91
v_readfirstlane_b32 s78,v96
s_nop 1
v_pk_add_f32 v[108:109],v[96:97],s[78:79] op_sel_hi:[1,0] neg_lo:[0,1] neg_hi:[0,1]
v_pk_add_f32 v[110:111],v[98:99],s[78:79] op_sel_hi:[1,0] neg_lo:[0,1] neg_hi:[0,1]
v_pk_add_f32 v[112:113],v[100:101],s[78:79] op_sel_hi:[1,0] neg_lo:[0,1] neg_hi:[0,1]
v_pk_add_f32 v[114:115],v[102:103],s[78:79] op_sel_hi:[1,0] neg_lo:[0,1] neg_hi:[0,1]
v_pk_add_f32 v[116:117],v[108:109],v[110:111]
v_pk_mul_f32 v[118:119],v[108:109],v[108:109]
v_pk_add_f32 v[120:121],v[112:113],v[114:115]
v_pk_fma_f32 v[118:119],v[110:111],v[110:111],v[118:119]
v_pk_add_f32 v[116:117],v[116:117],v[120:121]
v_pk_fma_f32 v[118:119],v[112:113],v[112:113],v[118:119]
v_add_f32 v116,v116,v117
v_pk_fma_f32 v[118:119],v[114:115],v[114:115],v[118:119]
v_add_f32 v118,v118,v119
s_nop 1
v_permlane32_swap_b32 v116,v118
v_add_f32 v116,v116,v118
s_nop 1
v_add_f32_dpp v116,v116,v116 row_ror:8 row_mask:0xf bank_mask:0xf
s_nop 1
v_add_f32_dpp v116,v116,v116 row_ror:4 row_mask:0xf bank_mask:0xf
s_nop 1
v_add_f32_dpp v116,v116,v116 row_ror:2 row_mask:0xf bank_mask:0xf
s_nop 1
v_add_f32_dpp v116,v116,v116 row_ror:1 row_mask:0xf bank_mask:0xf
v_mov_b32 v118,v116
s_nop 1
v_permlane16_swap_b32 v116,v118
v_add_f32 v116,v116,v118
v_mul_f32 v116,0x3b000000,v116
v_mov_b32 v118,v116
s_nop 1
v_permlane32_swap_b32 v116,v118
v_fma_f32 v118,-v116,v116,v118
v_add_f32 v116,s78,v116
v_max_f32 v118,0,v118
v_cvt_pk_bf16_f32 v118,v116,v118
v_lshlrev_b32 v116,16,v118
v_and_b32 v118,0xffff0000,v118
v_add_f32 v118,0x3727c5ac,v118
v_cvt_pk_bf16_f32 v118,v118,v118
v_and_b32 v118,0xffff0000,v118
v_sqrt_f32 v118,v118
v_pk_add_f32 v[108:109],v[96:97],v[116:117] op_sel_hi:[1,0] neg_lo:[0,1] neg_hi:[0,1]
v_pk_add_f32 v[110:111],v[98:99],v[116:117] op_sel_hi:[1,0] neg_lo:[0,1] neg_hi:[0,1]
v_pk_add_f32 v[112:113],v[100:101],v[116:117] op_sel_hi:[1,0] neg_lo:[0,1] neg_hi:[0,1]
v_pk_add_f32 v[114:115],v[102:103],v[116:117] op_sel_hi:[1,0] neg_lo:[0,1] neg_hi:[0,1]
v_cvt_pk_bf16_f32 v118,v118,v118
v_and_b32 v118,0xffff0000,v118
v_rcp_f32 v118,v118
v_cvt_pk_bf16_f32 v104,v108,v109
v_cvt_pk_bf16_f32 v105,v110,v111
v_cvt_pk_bf16_f32 v106,v112,v113
v_cvt_pk_bf16_f32 v107,v114,v115
v_lshlrev_b32 v108,16,v104
v_and_b32 v109,0xffff0000,v104
v_lshlrev_b32 v110,16,v105
v_and_b32 v111,0xffff0000,v105
v_lshlrev_b32 v112,16,v106
v_and_b32 v113,0xffff0000,v106
v_lshlrev_b32 v114,16,v107
v_and_b32 v115,0xffff0000,v107
v_pk_mul_f32 v[108:109],v[108:109],v[118:119] op_sel_hi:[1,0]
v_pk_mul_f32 v[110:111],v[110:111],v[118:119] op_sel_hi:[1,0]
v_pk_mul_f32 v[112:113],v[112:113],v[118:119] op_sel_hi:[1,0]
v_pk_mul_f32 v[114:115],v[114:115],v[118:119] op_sel_hi:[1,0]
v_cvt_pk_bf16_f32 v104,v108,v109
v_cvt_pk_bf16_f32 v105,v110,v111
v_cvt_pk_bf16_f32 v106,v112,v113
v_cvt_pk_bf16_f32 v107,v114,v115
s_mov_b32 s58,0x01000100
s_mov_b32 s59,0x03020302
v_perm_b32 v88,v104,v104,s58
v_perm_b32 v89,v104,v104,s59
v_perm_b32 v90,v105,v105,s58
v_perm_b32 v91,v105,v105,s59
v_perm_b32 v92,v106,v106,s58
v_perm_b32 v93,v106,v106,s59
v_perm_b32 v94,v107,v107,s58
v_perm_b32 v95,v107,v107,s59
v_lshlrev_b32 v8,5,v1
s_lshl_b32 s58,s46,11
s_add_u32 s58,s58,139264
v_add_u32 v8,s58,v8
ds_write_b128 v8,v[88:91]
ds_write_b128 v8,v[92:95] offset:16
s_lshl_b32 s59,s46,9
s_add_u32 s59,s58,s59
v_lshlrev_b32 v8,7,v10
v_add_u32 v8,s59,v8
s_waitcnt lgkmcnt(0)
ds_read_b128 v[108:111],v18 offset:0
ds_read_b128 v[88:91],v8 offset:0
ds_read_b128 v[92:95],v8 offset:16
ds_read_b128 v[112:115],v18 offset:1024
s_waitcnt lgkmcnt(1)
v_and_b32 v124,v12,v88
v_and_b32 v125,v13,v88
v_and_b32 v126,v14,v88
v_and_b32 v127,v15,v88
s_nop 1
v_mfma_f32_16x16x32_bf16 v[116:119],v[124:127],v[108:111],0
ds_read_b128 v[108:111],v18 offset:2048
s_waitcnt lgkmcnt(1)
v_and_b32 v124,v12,v89
v_and_b32 v125,v13,v89
v_and_b32 v126,v14,v89
v_and_b32 v127,v15,v89
s_nop 1
v_mfma_f32_16x16x32_bf16 v[116:119],v[124:127],v[112:115],v[116:119]
ds_read_b128 v[112:115],v18 offset:3072
s_waitcnt lgkmcnt(1)
v_and_b32 v124,v12,v90
v_and_b32 v125,v13,v90
v_and_b32 v126,v14,v90
v_and_b32 v127,v15,v90
s_nop 1
v_mfma_f32_16x16x32_bf16 v[116:119],v[124:127],v[108:111],v[116:119]
ds_read_b128 v[108:111],v18 offset:4096
s_waitcnt lgkmcnt(1)
v_and_b32 v124,v12,v91
v_and_b32 v125,v13,v91
v_and_b32 v126,v14,v91
v_and_b32 v127,v15,v91
s_nop 1
v_mfma_f32_16x16x32_bf16 v[116:119],v[124:127],v[112:115],v[116:119]
ds_read_b128 v[112:115],v18 offset:5120
s_waitcnt lgkmcnt(1)
v_and_b32 v124,v12,v92
v_and_b32 v125,v13,v92
v_and_b32 v126,v14,v92
v_and_b32 v127,v15,v92
s_nop 1
v_mfma_f32_16x16x32_bf16 v[116:119],v[124:127],v[108:111],v[116:119]
ds_read_b128 v[108:111],v18 offset:6144
s_waitcnt lgkmcnt(1)
v_and_b32 v124,v12,v93
v_and_b32 v125,v13,v93
v_and_b32 v126,v14,v93
v_and_b32 v127,v15,v93
s_nop 1
v_mfma_f32_16x16x32_bf16 v[116:119],v[124:127],v[112:115],v[116:119]
ds_read_b128 v[112:115],v18 offset:7168
s_waitcnt lgkmcnt(1)
v_and_b32 v124,v12,v94
v_and_b32 v125,v13,v94
v_and_b32 v126,v14,v94
v_and_b32 v127,v15,v94
s_nop 1
v_mfma_f32_16x16x32_bf16 v[116:119],v[124:127],v[108:111],v[116:119]
ds_read_b128 v[108:111],v18 offset:8192
s_waitcnt lgkmcnt(1)
v_and_b32 v124,v12,v95
v_and_b32 v125,v13,v95
v_and_b32 v126,v14,v95
v_and_b32 v127,v15,v95
s_nop 1
v_mfma_f32_16x16x32_bf16 v[116:119],v[124:127],v[112:115],v[116:119]
ds_read_b128 v[88:91],v8 offset:32
ds_read_b128 v[92:95],v8 offset:48
ds_read_b128 v[112:115],v18 offset:9216
s_waitcnt lgkmcnt(1)
v_and_b32 v124,v12,v88
v_and_b32 v125,v13,v88
v_and_b32 v126,v14,v88
v_and_b32 v127,v15,v88
s_nop 1
v_mfma_f32_16x16x32_bf16 v[116:119],v[124:127],v[108:111],v[116:119]
ds_read_b128 v[108:111],v18 offset:10240
s_waitcnt lgkmcnt(1)
v_and_b32 v124,v12,v89
v_and_b32 v125,v13,v89
v_and_b32 v126,v14,v89
v_and_b32 v127,v15,v89
s_nop 1
v_mfma_f32_16x16x32_bf16 v[116:119],v[124:127],v[112:115],v[116:119]
ds_read_b128 v[112:115],v18 offset:11264
s_waitcnt lgkmcnt(1)
v_and_b32 v124,v12,v90
v_and_b32 v125,v13,v90
v_and_b32 v126,v14,v90
v_and_b32 v127,v15,v90
s_nop 1
v_mfma_f32_16x16x32_bf16 v[116:119],v[124:127],v[108:111],v[116:119]
ds_read_b128 v[108:111],v18 offset:12288
s_waitcnt lgkmcnt(1)
v_and_b32 v124,v12,v91
v_and_b32 v125,v13,v91
v_and_b32 v126,v14,v91
v_and_b32 v127,v15,v91
s_nop 1
v_mfma_f32_16x16x32_bf16 v[116:119],v[124:127],v[112:115],v[116:119]
ds_read_b128 v[112:115],v18 offset:13312
s_waitcnt lgkmcnt(1)
v_and_b32 v124,v12,v92
v_and_b32 v125,v13,v92
v_and_b32 v126,v14,v92
v_and_b32 v127,v15,v92
s_nop 1
v_mfma_f32_16x16x32_bf16 v[116:119],v[124:127],v[108:111],v[116:119]
ds_read_b128 v[108:111],v18 offset:14336
s_waitcnt lgkmcnt(1)
v_and_b32 v124,v12,v93
v_and_b32 v125,v13,v93
v_and_b32 v126,v14,v93
v_and_b32 v127,v15,v93
s_nop 1
v_mfma_f32_16x16x32_bf16 v[116:119],v[124:127],v[112:115],v[116:119]
ds_read_b128 v[112:115],v18 offset:15360
s_waitcnt lgkmcnt(1)
v_and_b32 v124,v12,v94
v_and_b32 v125,v13,v94
v_and_b32 v126,v14,v94
v_and_b32 v127,v15,v94
s_nop 1
v_mfma_f32_16x16x32_bf16 v[116:119],v[124:127],v[108:111],v[116:119]
ds_read_b128 v[108:111],v18 offset:16384
s_waitcnt lgkmcnt(1)
v_and_b32 v124,v12,v95
v_and_b32 v125,v13,v95
v_and_b32 v126,v14,v95
v_and_b32 v127,v15,v95
s_nop 1
v_mfma_f32_16x16x32_bf16 v[116:119],v[124:127],v[112:115],v[116:119]
ds_read_b128 v[88:91],v8 offset:64
ds_read_b128 v[92:95],v8 offset:80
ds_read_b128 v[112:115],v18 offset:17408
s_waitcnt lgkmcnt(1)
v_and_b32 v124,v12,v88
v_and_b32 v125,v13,v88
v_and_b32 v126,v14,v88
v_and_b32 v127,v15,v88
s_nop 1
v_mfma_f32_16x16x32_bf16 v[116:119],v[124:127],v[108:111],v[116:119]
ds_read_b128 v[108:111],v18 offset:18432
s_waitcnt lgkmcnt(1)
v_and_b32 v124,v12,v89
v_and_b32 v125,v13,v89
v_and_b32 v126,v14,v89
v_and_b32 v127,v15,v89
s_nop 1
v_mfma_f32_16x16x32_bf16 v[116:119],v[124:127],v[112:115],v[116:119]
ds_read_b128 v[112:115],v18 offset:19456
s_waitcnt lgkmcnt(1)
v_and_b32 v124,v12,v90
v_and_b32 v125,v13,v90
v_and_b32 v126,v14,v90
v_and_b32 v127,v15,v90
s_nop 1
v_mfma_f32_16x16x32_bf16 v[116:119],v[124:127],v[108:111],v[116:119]
ds_read_b128 v[108:111],v18 offset:20480
s_waitcnt lgkmcnt(1)
v_and_b32 v124,v12,v91
v_and_b32 v125,v13,v91
v_and_b32 v126,v14,v91
v_and_b32 v127,v15,v91
s_nop 1
v_mfma_f32_16x16x32_bf16 v[116:119],v[124:127],v[112:115],v[116:119]
ds_read_b128 v[112:115],v18 offset:21504
s_waitcnt lgkmcnt(1)
v_and_b32 v124,v12,v92
v_and_b32 v125,v13,v92
v_and_b32 v126,v14,v92
v_and_b32 v127,v15,v92
s_nop 1
v_mfma_f32_16x16x32_bf16 v[116:119],v[124:127],v[108:111],v[116:119]
ds_read_b128 v[108:111],v18 offset:22528
s_waitcnt lgkmcnt(1)
v_and_b32 v124,v12,v93
v_and_b32 v125,v13,v93
v_and_b32 v126,v14,v93
v_and_b32 v127,v15,v93
s_nop 1
v_mfma_f32_16x16x32_bf16 v[116:119],v[124:127],v[112:115],v[116:119]
ds_read_b128 v[112:115],v18 offset:23552
s_waitcnt lgkmcnt(1)
v_and_b32 v124,v12,v94
v_and_b32 v125,v13,v94
v_and_b32 v126,v14,v94
v_and_b32 v127,v15,v94
s_nop 1
v_mfma_f32_16x16x32_bf16 v[116:119],v[124:127],v[108:111],v[116:119]
ds_read_b128 v[108:111],v18 offset:24576
s_waitcnt lgkmcnt(1)
v_and_b32 v124,v12,v95
v_and_b32 v125,v13,v95
v_and_b32 v126,v14,v95
v_and_b32 v127,v15,v95
s_nop 1
v_mfma_f32_16x16x32_bf16 v[116:119],v[124:127],v[112:115],v[116:119]
ds_read_b128 v[88:91],v8 offset:96
ds_read_b128 v[92:95],v8 offset:112
ds_read_b128 v[112:115],v18 offset:25600
s_waitcnt lgkmcnt(1)
v_and_b32 v124,v12,v88
v_and_b32 v125,v13,v88
v_and_b32 v126,v14,v88
v_and_b32 v127,v15,v88
s_nop 1
v_mfma_f32_16x16x32_bf16 v[116:119],v[124:127],v[108:111],v[116:119]
ds_read_b128 v[108:111],v18 offset:26624
s_waitcnt lgkmcnt(1)
v_and_b32 v124,v12,v89
v_and_b32 v125,v13,v89
v_and_b32 v126,v14,v89
v_and_b32 v127,v15,v89
s_nop 1
v_mfma_f32_16x16x32_bf16 v[116:119],v[124:127],v[112:115],v[116:119]
ds_read_b128 v[112:115],v18 offset:27648
s_waitcnt lgkmcnt(1)
v_and_b32 v124,v12,v90
v_and_b32 v125,v13,v90
v_and_b32 v126,v14,v90
v_and_b32 v127,v15,v90
s_nop 1
v_mfma_f32_16x16x32_bf16 v[116:119],v[124:127],v[108:111],v[116:119]
ds_read_b128 v[108:111],v18 offset:28672
s_waitcnt lgkmcnt(1)
v_and_b32 v124,v12,v91
v_and_b32 v125,v13,v91
v_and_b32 v126,v14,v91
v_and_b32 v127,v15,v91
s_nop 1
v_mfma_f32_16x16x32_bf16 v[116:119],v[124:127],v[112:115],v[116:119]
ds_read_b128 v[112:115],v18 offset:29696
s_waitcnt lgkmcnt(1)
v_and_b32 v124,v12,v92
v_and_b32 v125,v13,v92
v_and_b32 v126,v14,v92
v_and_b32 v127,v15,v92
s_nop 1
v_mfma_f32_16x16x32_bf16 v[116:119],v[124:127],v[108:111],v[116:119]
ds_read_b128 v[108:111],v18 offset:30720
s_waitcnt lgkmcnt(1)
v_and_b32 v124,v12,v93
v_and_b32 v125,v13,v93
v_and_b32 v126,v14,v93
v_and_b32 v127,v15,v93
s_nop 1
v_mfma_f32_16x16x32_bf16 v[116:119],v[124:127],v[112:115],v[116:119]
ds_read_b128 v[112:115],v18 offset:31744
s_waitcnt lgkmcnt(1)
v_and_b32 v124,v12,v94
v_and_b32 v125,v13,v94
v_and_b32 v126,v14,v94
v_and_b32 v127,v15,v94
s_nop 1
v_mfma_f32_16x16x32_bf16 v[116:119],v[124:127],v[108:111],v[116:119]
s_waitcnt lgkmcnt(0)
v_and_b32 v124,v12,v95
v_and_b32 v125,v13,v95
v_and_b32 v126,v14,v95
v_and_b32 v127,v15,v95
s_nop 1
v_mfma_f32_16x16x32_bf16 v[116:119],v[124:127],v[112:115],v[116:119]
v_lshlrev_b32 v8,5,v9
v_and_b32 v124,1,v10
v_lshl_add_u32 v8,v124,4,v8
v_lshrrev_b32 v124,1,v10
v_lshl_add_u32 v8,v124,11,v8
s_lshl_b32 s60,s46,9
s_add_u32 s60,s60,147456
v_add_u32 v8,s60,v8
ds_write_b128 v8,v[116:119]
v_lshlrev_b32 v8,2,v1
v_add_u32 v8,147456,v8
s_waitcnt lgkmcnt(0)
s_barrier
ds_read2st64_b32 v[88:89],v8 offset0:0 offset1:1
ds_read2st64_b32 v[90:91],v8 offset0:2 offset1:3
ds_read2st64_b32 v[92:93],v8 offset0:4 offset1:5
ds_read2st64_b32 v[94:95],v8 offset0:6 offset1:7
s_waitcnt lgkmcnt(0)
v_pk_add_f32 v[88:89],v[88:89],v[90:91]
v_pk_add_f32 v[92:93],v[92:93],v[94:95]
v_pk_add_f32 v[88:89],v[88:89],v[92:93]
v_cvt_pk_bf16_f32 v88,v88,v88
v_and_b32 v88,0xffff0000,v88
v_cvt_pk_bf16_f32 v89,v89,v89
v_and_b32 v89,0xffff0000,v89
v_mul_f32 v90,0xbfb8aa3b,v88
v_exp_f32 v90,v90
s_nop 0
v_add_f32 v90,1.0,v90
v_rcp_f32 v90,v90
s_nop 0
v_mul_f32 v88,v88,v90
v_cvt_pk_bf16_f32 v88,v88,v88
v_and_b32 v88,0xffff0000,v88
v_mul_f32 v88,v88,v89
v_cvt_pk_bf16_f32 v88,v88,v88
v_lshlrev_b32 v8,2,v1
v_add_u32 v8,s58,v8
ds_write_b32 v8,v88
v_lshlrev_b32 v8,6,v10
v_add_u32 v8,s58,v8
s_waitcnt lgkmcnt(0)
ds_read_b128 v[88:91],v8
ds_read_b128 v[92:95],v8 offset:16
ds_read_b128 v[108:111],v8 offset:32
ds_read_b128 v[112:115],v8 offset:48
s_waitcnt vmcnt(0) lgkmcnt(0)
v_and_b32 v124,v12,v88
v_and_b32 v125,v13,v88
v_and_b32 v126,v14,v88
v_and_b32 v127,v15,v88
s_nop 1
v_mfma_f32_16x16x32_bf16 v[116:119],v[124:127],v[24:27],0
v_and_b32 v124,v12,v89
v_and_b32 v125,v13,v89
v_and_b32 v126,v14,v89
v_and_b32 v127,v15,v89
s_nop 1
v_mfma_f32_16x16x32_bf16 v[116:119],v[124:127],v[28:31],v[116:119]
v_and_b32 v124,v12,v90
v_and_b32 v125,v13,v90
v_and_b32 v126,v14,v90
v_and_b32 v127,v15,v90
s_nop 1
v_mfma_f32_16x16x32_bf16 v[116:119],v[124:127],v[32:35],v[116:119]
v_and_b32 v124,v12,v91
v_and_b32 v125,v13,v91
v_and_b32 v126,v14,v91
v_and_b32 v127,v15,v91
s_nop 1
v_mfma_f32_16x16x32_bf16 v[116:119],v[124:127],v[36:39],v[116:119]
v_and_b32 v124,v12,v92
v_and_b32 v125,v13,v92
v_and_b32 v126,v14,v92
v_and_b32 v127,v15,v92
s_nop 1
v_mfma_f32_16x16x32_bf16 v[116:119],v[124:127],v[40:43],v[116:119]
v_and_b32 v124,v12,v93
v_and_b32 v125,v13,v93
v_and_b32 v126,v14,v93
v_and_b32 v127,v15,v93
s_nop 1
v_mfma_f32_16x16x32_bf16 v[116:119],v[124:127],v[44:47],v[116:119]
v_and_b32 v124,v12,v94
v_and_b32 v125,v13,v94
v_and_b32 v126,v14,v94
v_and_b32 v127,v15,v94
s_nop 1
v_mfma_f32_16x16x32_bf16 v[116:119],v[124:127],v[48:51],v[116:119]
v_and_b32 v124,v12,v95
v_and_b32 v125,v13,v95
v_and_b32 v126,v14,v95
v_and_b32 v127,v15,v95
s_nop 1
v_mfma_f32_16x16x32_bf16 v[116:119],v[124:127],v[52:55],v[116:119]
v_and_b32 v124,v12,v108
v_and_b32 v125,v13,v108
v_and_b32 v126,v14,v108
v_and_b32 v127,v15,v108
s_nop 1
v_mfma_f32_16x16x32_bf16 v[116:119],v[124:127],v[56:59],v[116:119]
v_and_b32 v124,v12,v109
v_and_b32 v125,v13,v109
v_and_b32 v126,v14,v109
v_and_b32 v127,v15,v109
s_nop 1
v_mfma_f32_16x16x32_bf16 v[116:119],v[124:127],v[60:63],v[116:119]
v_and_b32 v124,v12,v110
v_and_b32 v125,v13,v110
v_and_b32 v126,v14,v110
v_and_b32 v127,v15,v110
s_nop 1
v_mfma_f32_16x16x32_bf16 v[116:119],v[124:127],v[64:67],v[116:119]
v_and_b32 v124,v12,v111
v_and_b32 v125,v13,v111
v_and_b32 v126,v14,v111
v_and_b32 v127,v15,v111
s_nop 1
v_mfma_f32_16x16x32_bf16 v[116:119],v[124:127],v[68:71],v[116:119]
v_and_b32 v124,v12,v112
v_and_b32 v125,v13,v112
v_and_b32 v126,v14,v112
v_and_b32 v127,v15,v112
s_nop 1
v_mfma_f32_16x16x32_bf16 v[116:119],v[124:127],v[72:75],v[116:119]
v_and_b32 v124,v12,v113
v_and_b32 v125,v13,v113
v_and_b32 v126,v14,v113
v_and_b32 v127,v15,v113
s_nop 1
v_mfma_f32_16x16x32_bf16 v[116:119],v[124:127],v[76:79],v[116:119]
v_and_b32 v124,v12,v114
v_and_b32 v125,v13,v114
v_and_b32 v126,v14,v114
v_and_b32 v127,v15,v114
s_nop 1
v_mfma_f32_16x16x32_bf16 v[116:119],v[124:127],v[80:83],v[116:119]
v_and_b32 v124,v12,v115
v_and_b32 v125,v13,v115
v_and_b32 v126,v14,v115
v_and_b32 v127,v15,v115
s_nop 1
v_mfma_f32_16x16x32_bf16 v[116:119],v[124:127],v[84:87],v[116:119]
v_lshlrev_b32 v8,4,v9
v_and_b32 v124,1,v10
v_lshl_add_u32 v8,v124,3,v8
v_and_b32 v124,2,v10
v_lshl_add_u32 v8,v124,30,v8
s_lshl_b32 s65,s51,15
s_add_u32 s65,s65,92274688
s_lshl_b32 s59,s47,10
s_lshl_b32 s60,s46,8
s_add_u32 s59,s59,s60
s_add_u32 s59,s59,s65
v_cvt_pk_bf16_f32 v24,v116,v117
v_cvt_pk_bf16_f32 v25,v118,v119
buffer_store_dwordx2 v[24:25],v8,s[8:11],s59 offen sc1
s_lshl_b32 s59,s51,13
s_lshl2_add_u32 s59,s47,s59
s_add_u32 s59,s59,10486912
s_waitcnt vmcnt(0)
s_barrier
s_or_b32 s59,s59,s52
buffer_store_dword v17,off,s[8:11],s59 sc1
s_cmp_lg_u32 s47,0
s_cbranch_scc1 L_moed_370
s_lshl_b32 s59,s51,13
s_add_u32 s59,s59,10486912
v_and_b32 v124,31,v1
v_lshlrev_b32 v124,2,v124
L_fw_371:
buffer_load_dword v125,v124,s[8:11],s59 offen sc1
s_sub_u32 s49,s49,1
s_cbranch_scc1 L_abort2
s_waitcnt vmcnt(0)
v_cmp_eq_u32 vcc,0,v125
s_cbranch_vccnz L_fw_371
s_add_u32 s63,s65,0
buffer_load_dwordx4 v[24:27],v22,s[8:11],s63 offen sc1
s_add_u32 s63,s65,4096
buffer_load_dwordx4 v[28:31],v22,s[8:11],s63 offen sc1
s_add_u32 s63,s65,8192
buffer_load_dwordx4 v[32:35],v22,s[8:11],s63 offen sc1
s_add_u32 s63,s65,12288
buffer_load_dwordx4 v[36:39],v22,s[8:11],s63 offen sc1
s_add_u32 s63,s65,16384
buffer_load_dwordx4 v[40:43],v22,s[8:11],s63 offen sc1
s_add_u32 s63,s65,20480
buffer_load_dwordx4 v[44:47],v22,s[8:11],s63 offen sc1
s_add_u32 s63,s65,24576
buffer_load_dwordx4 v[48:51],v22,s[8:11],s63 offen sc1
s_add_u32 s63,s65,28672
buffer_load_dwordx4 v[52:55],v22,s[8:11],s63 offen sc1
v_and_b32 v64,15,v1
v_and_b32 v65,1,v1
v_lshlrev_b32 v65,4,v65
v_mov_b32 v66,0x3f80
v_lshlrev_b32 v66,v65,v66
v_lshrrev_b32 v64,1,v64
v_cmp_eq_u32 vcc,0,v64
s_nop 1
v_cndmask_b32 v56,0,v66,vcc
v_cmp_eq_u32 vcc,1,v64
s_nop 1
v_cndmask_b32 v57,0,v66,vcc
v_cmp_eq_u32 vcc,2,v64
s_nop 1
v_cndmask_b32 v58,0,v66,vcc
v_cmp_eq_u32 vcc,3,v64
s_nop 1
v_cndmask_b32 v59,0,v66,vcc
s_waitcnt vmcnt(7)
s_nop 0
v_mfma_f32_16x16x32_bf16 v[60:63],v[56:59],v[24:27],0
s_waitcnt vmcnt(6)
v_mfma_f32_16x16x32_bf16 v[60:63],v[56:59],v[28:31],v[60:63]
s_waitcnt vmcnt(5)
v_mfma_f32_16x16x32_bf16 v[60:63],v[56:59],v[32:35],v[60:63]
s_waitcnt vmcnt(4)
v_mfma_f32_16x16x32_bf16 v[60:63],v[56:59],v[36:39],v[60:63]
s_waitcnt vmcnt(3)
v_mfma_f32_16x16x32_bf16 v[60:63],v[56:59],v[40:43],v[60:63]
s_waitcnt vmcnt(2)
v_mfma_f32_16x16x32_bf16 v[60:63],v[56:59],v[44:47],v[60:63]
s_waitcnt vmcnt(1)
v_mfma_f32_16x16x32_bf16 v[60:63],v[56:59],v[48:51],v[60:63]
s_waitcnt vmcnt(0)
v_mfma_f32_16x16x32_bf16 v[60:63],v[56:59],v[52:55],v[60:63]
s_nop 7
ds_write_b128 v21,v[60:63]
s_waitcnt lgkmcnt(0)
s_barrier
s_cmp_lg_u32 s46,0
s_cbranch_scc1 L_moed_370
v_lshlrev_b32 v56,5,v1
v_add_u32 v56,155648,v56
ds_read_b128 v[24:27],v56
ds_read_b128 v[28:31],v56 offset:16
s_and_b32 s59,s55,0xffff0000
s_xor_b32 s60,s59,0x80000000
s_xor_b32 s61,s59,0xffff0000
s_cmp_lt_i32 s59,0
s_cselect_b32 s59,s60,s61
v_mov_b32 v56,s59
v_mul_f32 v56,0xbfb8aa3b,v56
v_exp_f32 v56,v56
s_nop 0
v_add_f32 v56,1.0,v56
v_rcp_f32 v56,v56
s_nop 0
v_cvt_pk_bf16_f32 v56,v56,v56
v_and_b32 v56,0xffff0000,v56
v_lshlrev_b32 v48,16,v104
v_and_b32 v49,0xffff0000,v104
v_lshlrev_b32 v50,16,v105
v_and_b32 v51,0xffff0000,v105
v_lshlrev_b32 v52,16,v106
v_and_b32 v53,0xffff0000,v106
v_lshlrev_b32 v54,16,v107
v_and_b32 v55,0xffff0000,v107
s_waitcnt lgkmcnt(0)
v_cvt_pk_bf16_f32 v40,v24,v25
v_cvt_pk_bf16_f32 v41,v26,v27
v_cvt_pk_bf16_f32 v42,v28,v29
v_cvt_pk_bf16_f32 v43,v30,v31
v_lshlrev_b32 v24,16,v40
v_and_b32 v25,0xffff0000,v40
v_lshlrev_b32 v26,16,v41
v_and_b32 v27,0xffff0000,v41
v_lshlrev_b32 v28,16,v42
v_and_b32 v29,0xffff0000,v42
v_lshlrev_b32 v30,16,v43
v_and_b32 v31,0xffff0000,v43
v_mul_f32 v24,v24,v56
v_mul_f32 v25,v25,v56
v_mul_f32 v26,v26,v56
v_mul_f32 v27,v27,v56
v_mul_f32 v28,v28,v56
v_mul_f32 v29,v29,v56
v_mul_f32 v30,v30,v56
v_mul_f32 v31,v31,v56
v_cvt_pk_bf16_f32 v40,v24,v25
v_cvt_pk_bf16_f32 v41,v26,v27
v_cvt_pk_bf16_f32 v42,v28,v29
v_cvt_pk_bf16_f32 v43,v30,v31
v_lshlrev_b32 v24,16,v40
v_and_b32 v25,0xffff0000,v40
v_lshlrev_b32 v26,16,v41
v_and_b32 v27,0xffff0000,v41
v_lshlrev_b32 v28,16,v42
v_and_b32 v29,0xffff0000,v42
v_lshlrev_b32 v30,16,v43
v_and_b32 v31,0xffff0000,v43
v_add_f32 v24,v24,v48
v_add_f32 v25,v25,v49
v_add_f32 v26,v26,v50
v_add_f32 v27,v27,v51
v_add_f32 v28,v28,v52
v_add_f32 v29,v29,v53
v_add_f32 v30,v30,v54
v_add_f32 v31,v31,v55
v_cvt_pk_bf16_f32 v40,v24,v25
v_cvt_pk_bf16_f32 v41,v26,v27
v_cvt_pk_bf16_f32 v42,v28,v29
v_cvt_pk_bf16_f32 v43,v30,v31
v_lshlrev_b32 v24,16,v40
v_and_b32 v25,0xffff0000,v40
v_lshlrev_b32 v26,16,v41
v_and_b32 v27,0xffff0000,v41
v_lshlrev_b32 v28,16,v42
v_and_b32 v29,0xffff0000,v42
v_lshlrev_b32 v30,16,v43
v_and_b32 v31,0xffff0000,v43
v_add_f32 v96,v96,v24
v_add_f32 v97,v97,v25
v_add_f32 v98,v98,v26
v_add_f32 v99,v99,v27
v_add_f32 v100,v100,v28
v_add_f32 v101,v101,v29
v_add_f32 v102,v102,v30
v_add_f32 v103,v103,v31
v_cvt_pk_bf16_f32 v80,v96,v97
v_cvt_pk_bf16_f32 v81,v98,v99
v_cvt_pk_bf16_f32 v82,v100,v101
v_cvt_pk_bf16_f32 v83,v102,v103
s_mov_b32 s4,s40
s_mov_b32 s5,s41
s_mov_b32 s6,2097152
s_mov_b32 s7,0x20000
buffer_store_dwordx4 v[80:83],v0,s[4:7],s56 offen sc1
L_moed_370:
s_endpgm
.section .rodata,"a"
.p2align 6
.amdhsa_kernel interleave_layers__memory_aug_recurrent_mem_tr__moe_arch_mod__prompt_kernel
  .amdhsa_next_free_vgpr 512
  .amdhsa_next_free_sgpr 102
  .amdhsa_accum_offset 256
  .amdhsa_group_segment_fixed_size 0
  .amdhsa_kernarg_size 120
  .amdhsa_user_sgpr_count 2
  .amdhsa_user_sgpr_kernarg_segment_ptr 1
  .amdhsa_system_sgpr_workgroup_id_x 1
  .amdhsa_float_denorm_mode_32 3
.end_amdhsa_kernel
```

```asm
; @launch grid=(256,1,1) block=(256,1,1) lds=163840
.amdgcn_target "amdgcn-amd-amdhsa--gfx950"
.text
.globl interleave_layers__memory_aug_recurrent_mem_tr__moe_arch_mod__prompt_kernel
.p2align 8
.type interleave_layers__memory_aug_recurrent_mem_tr__moe_arch_mod__prompt_kernel,@function
interleave_layers__memory_aug_recurrent_mem_tr__moe_arch_mod__prompt_kernel:
s_cmp_ge_u32 s2,256
s_cbranch_scc1 L_abort
s_load_dwordx16 s[16:31],s[0:1],0
s_load_dwordx8 s[32:39],s[0:1],64
s_load_dwordx4 s[40:43],s[0:1],96
s_load_dwordx2 s[44:45],s[0:1],112
v_lshrrev_b32 v2,6,v0
v_and_b32 v1,63,v0
v_readfirstlane_b32 s46,v2
v_lshlrev_b32 v0,4,v1
s_getreg_b32 s48,hwreg(HW_REG_XCC_ID)
s_and_b32 s48,s48,7
s_lshl_b32 s48,s48,2
s_lshr_b32 s48,1399931488,s48
s_and_b32 s48,s48,7
s_mov_b32 s49,100000
s_mov_b32 s80,0x3e0293ee
s_waitcnt lgkmcnt(0)
s_mov_b32 s8,s44
s_mov_b32 s9,s45
s_mov_b32 s10,268435456
s_mov_b32 s11,0x20000
s_mov_b32 s12,s42
s_mov_b32 s13,s43
s_mov_b32 s14,256
s_mov_b32 s15,0x20000
s_cmp_lg_u32 s46,0
s_cbranch_scc1 L_tk_1
s_lshl_b32 s56,s48,2
v_mov_b32 v14,s56
v_mov_b32 v15,1
s_mov_b64 exec,1
buffer_atomic_add v15,v14,s[12:15],0 offen sc0
s_mov_b64 exec,-1
L_tk_1:
s_mov_b32 s4,s16
s_mov_b32 s5,s17
s_mov_b32 s6,2097152
s_mov_b32 s7,0x20000
s_lshl_b32 s56,s2,3
s_lshl_b32 s59,s46,1
s_add_u32 s56,s56,s59
s_lshl_b32 s59,s56,10
buffer_load_dwordx4 v[24:27],v0,s[4:7],s59 offen
buffer_load_dwordx4 v[28:31],v0,s[4:7],s59 offen offset:1024
s_lshl_b32 s56,s2,12
s_lshl_b32 s57,s46,10
s_add_u32 s56,s56,s57
v_add_u32 v2,s56,v0
v_mov_b32 v4,-1
v_mov_b32 v5,-1
v_mov_b32 v6,-1
v_mov_b32 v7,-1
v_mov_b32 v8,0
v_mov_b32 v9,0
v_mov_b32 v10,0
v_mov_b32 v11,0
v_cmp_gt_u32 vcc,524288,v2
v_mov_b32 v3,14155776
v_mov_b32 v12,11542528
v_cndmask_b32 v3,v3,v12,vcc
v_add_u32 v3,v3,v2
s_mov_b32 s56,0
buffer_store_dwordx4 v[4:7],v3,s[8:11],s56 offen sc1
s_mov_b32 s56,1048576
buffer_store_dwordx4 v[4:7],v3,s[8:11],s56 offen sc1
s_mov_b32 s56,2097152
buffer_store_dwordx4 v[4:7],v3,s[8:11],s56 offen sc1
s_mov_b32 s56,4194304
buffer_store_dwordx4 v[4:7],v2,s[8:11],s56 offen sc1
s_mov_b32 s56,5242880
buffer_store_dwordx4 v[4:7],v2,s[8:11],s56 offen sc1
v_add_u32 v3,17309696,v2
v_mov_b32 v12,0x80000000
v_cndmask_b32 v3,v3,v12,vcc
buffer_store_dwordx4 v[4:7],v3,s[8:11],0 offen sc1
v_cmp_gt_u32 vcc,147456,v2
v_lshrrev_b32 v3,11,v2
v_lshlrev_b32 v3,13,v3
v_and_b32 v13,0x7ff,v2
v_add_u32 v3,v3,v13
v_add_u32 v3,10485760,v3
v_cndmask_b32 v3,v12,v3,vcc
buffer_store_dwordx4 v[8:11],v3,s[8:11],0 offen sc1
v_add_u32 v3,11075584,v2
v_lshrrev_b32 v13,16,v2
v_cmp_eq_u32 vcc,4,v13
s_nop 1
v_cndmask_b32 v3,v12,v3,vcc
buffer_store_dwordx4 v[4:7],v3,s[8:11],0 offen sc1
s_waitcnt vmcnt(8)
v_lshlrev_b32 v32,16,v24
v_and_b32 v33,0xffff0000,v24
v_lshlrev_b32 v34,16,v25
v_and_b32 v35,0xffff0000,v25
v_lshlrev_b32 v36,16,v26
v_and_b32 v37,0xffff0000,v26
v_lshlrev_b32 v38,16,v27
v_and_b32 v39,0xffff0000,v27
v_readfirstlane_b32 s78,v32
s_nop 1
v_pk_add_f32 v[48:49],v[32:33],s[78:79] op_sel_hi:[1,0] neg_lo:[0,1] neg_hi:[0,1]
v_pk_add_f32 v[50:51],v[34:35],s[78:79] op_sel_hi:[1,0] neg_lo:[0,1] neg_hi:[0,1]
v_pk_add_f32 v[52:53],v[36:37],s[78:79] op_sel_hi:[1,0] neg_lo:[0,1] neg_hi:[0,1]
v_pk_add_f32 v[54:55],v[38:39],s[78:79] op_sel_hi:[1,0] neg_lo:[0,1] neg_hi:[0,1]
v_pk_add_f32 v[56:57],v[48:49],v[50:51]
v_pk_mul_f32 v[58:59],v[48:49],v[48:49]
v_pk_add_f32 v[60:61],v[52:53],v[54:55]
v_pk_fma_f32 v[58:59],v[50:51],v[50:51],v[58:59]
v_pk_add_f32 v[56:57],v[56:57],v[60:61]
v_pk_fma_f32 v[58:59],v[52:53],v[52:53],v[58:59]
v_add_f32 v56,v56,v57
v_pk_fma_f32 v[58:59],v[54:55],v[54:55],v[58:59]
v_add_f32 v58,v58,v59
s_nop 1
v_permlane32_swap_b32 v56,v58
v_add_f32 v56,v56,v58
s_nop 1
v_add_f32_dpp v56,v56,v56 row_ror:8 row_mask:0xf bank_mask:0xf
s_nop 1
v_add_f32_dpp v56,v56,v56 row_ror:4 row_mask:0xf bank_mask:0xf
s_nop 1
v_add_f32_dpp v56,v56,v56 row_ror:2 row_mask:0xf bank_mask:0xf
s_nop 1
v_add_f32_dpp v56,v56,v56 row_ror:1 row_mask:0xf bank_mask:0xf
v_mov_b32 v58,v56
s_nop 1
v_permlane16_swap_b32 v56,v58
v_add_f32 v56,v56,v58
v_mul_f32 v56,0x3b000000,v56
v_mov_b32 v58,v56
s_nop 1
v_permlane32_swap_b32 v56,v58
v_fma_f32 v58,-v56,v56,v58
v_add_f32 v56,s78,v56
v_max_f32 v58,0,v58
v_cvt_pk_bf16_f32 v58,v56,v58
v_lshlrev_b32 v56,16,v58
v_and_b32 v58,0xffff0000,v58
v_add_f32 v58,0x3727c5ac,v58
v_cvt_pk_bf16_f32 v58,v58,v58
v_and_b32 v58,0xffff0000,v58
v_sqrt_f32 v58,v58
v_pk_add_f32 v[48:49],v[32:33],v[56:57] op_sel_hi:[1,0] neg_lo:[0,1] neg_hi:[0,1]
v_pk_add_f32 v[50:51],v[34:35],v[56:57] op_sel_hi:[1,0] neg_lo:[0,1] neg_hi:[0,1]
v_pk_add_f32 v[52:53],v[36:37],v[56:57] op_sel_hi:[1,0] neg_lo:[0,1] neg_hi:[0,1]
v_pk_add_f32 v[54:55],v[38:39],v[56:57] op_sel_hi:[1,0] neg_lo:[0,1] neg_hi:[0,1]
v_cvt_pk_bf16_f32 v58,v58,v58
v_and_b32 v58,0xffff0000,v58
v_rcp_f32 v58,v58
v_cvt_pk_bf16_f32 v40,v48,v49
v_cvt_pk_bf16_f32 v41,v50,v51
v_cvt_pk_bf16_f32 v42,v52,v53
v_cvt_pk_bf16_f32 v43,v54,v55
v_lshlrev_b32 v48,16,v40
v_and_b32 v49,0xffff0000,v40
v_lshlrev_b32 v50,16,v41
v_and_b32 v51,0xffff0000,v41
v_lshlrev_b32 v52,16,v42
v_and_b32 v53,0xffff0000,v42
v_lshlrev_b32 v54,16,v43
v_and_b32 v55,0xffff0000,v43
v_pk_mul_f32 v[48:49],v[48:49],v[58:59] op_sel_hi:[1,0]
v_pk_mul_f32 v[50:51],v[50:51],v[58:59] op_sel_hi:[1,0]
v_pk_mul_f32 v[52:53],v[52:53],v[58:59] op_sel_hi:[1,0]
v_pk_mul_f32 v[54:55],v[54:55],v[58:59] op_sel_hi:[1,0]
v_cvt_pk_bf16_f32 v40,v48,v49
v_cvt_pk_bf16_f32 v41,v50,v51
v_cvt_pk_bf16_f32 v42,v52,v53
v_cvt_pk_bf16_f32 v43,v54,v55
buffer_store_dwordx4 v[40:43],v0,s[8:11],s59 offen offset:0 sc1
v_lshlrev_b32 v32,16,v28
v_and_b32 v33,0xffff0000,v28
v_lshlrev_b32 v34,16,v29
v_and_b32 v35,0xffff0000,v29
v_lshlrev_b32 v36,16,v30
v_and_b32 v37,0xffff0000,v30
v_lshlrev_b32 v38,16,v31
v_and_b32 v39,0xffff0000,v31
v_readfirstlane_b32 s78,v32
s_nop 1
v_pk_add_f32 v[48:49],v[32:33],s[78:79] op_sel_hi:[1,0] neg_lo:[0,1] neg_hi:[0,1]
v_pk_add_f32 v[50:51],v[34:35],s[78:79] op_sel_hi:[1,0] neg_lo:[0,1] neg_hi:[0,1]
v_pk_add_f32 v[52:53],v[36:37],s[78:79] op_sel_hi:[1,0] neg_lo:[0,1] neg_hi:[0,1]
v_pk_add_f32 v[54:55],v[38:39],s[78:79] op_sel_hi:[1,0] neg_lo:[0,1] neg_hi:[0,1]
v_pk_add_f32 v[56:57],v[48:49],v[50:51]
v_pk_mul_f32 v[58:59],v[48:49],v[48:49]
v_pk_add_f32 v[60:61],v[52:53],v[54:55]
v_pk_fma_f32 v[58:59],v[50:51],v[50:51],v[58:59]
v_pk_add_f32 v[56:57],v[56:57],v[60:61]
v_pk_fma_f32 v[58:59],v[52:53],v[52:53],v[58:59]
v_add_f32 v56,v56,v57
v_pk_fma_f32 v[58:59],v[54:55],v[54:55],v[58:59]
v_add_f32 v58,v58,v59
s_nop 1
v_permlane32_swap_b32 v56,v58
v_add_f32 v56,v56,v58
s_nop 1
v_add_f32_dpp v56,v56,v56 row_ror:8 row_mask:0xf bank_mask:0xf
s_nop 1
v_add_f32_dpp v56,v56,v56 row_ror:4 row_mask:0xf bank_mask:0xf
s_nop 1
v_add_f32_dpp v56,v56,v56 row_ror:2 row_mask:0xf bank_mask:0xf
s_nop 1
v_add_f32_dpp v56,v56,v56 row_ror:1 row_mask:0xf bank_mask:0xf
v_mov_b32 v58,v56
s_nop 1
v_permlane16_swap_b32 v56,v58
v_add_f32 v56,v56,v58
v_mul_f32 v56,0x3b000000,v56
v_mov_b32 v58,v56
s_nop 1
v_permlane32_swap_b32 v56,v58
v_fma_f32 v58,-v56,v56,v58
v_add_f32 v56,s78,v56
v_max_f32 v58,0,v58
v_cvt_pk_bf16_f32 v58,v56,v58
v_lshlrev_b32 v56,16,v58
v_and_b32 v58,0xffff0000,v58
v_add_f32 v58,0x3727c5ac,v58
v_cvt_pk_bf16_f32 v58,v58,v58
v_and_b32 v58,0xffff0000,v58
v_sqrt_f32 v58,v58
v_pk_add_f32 v[48:49],v[32:33],v[56:57] op_sel_hi:[1,0] neg_lo:[0,1] neg_hi:[0,1]
v_pk_add_f32 v[50:51],v[34:35],v[56:57] op_sel_hi:[1,0] neg_lo:[0,1] neg_hi:[0,1]
v_pk_add_f32 v[52:53],v[36:37],v[56:57] op_sel_hi:[1,0] neg_lo:[0,1] neg_hi:[0,1]
v_pk_add_f32 v[54:55],v[38:39],v[56:57] op_sel_hi:[1,0] neg_lo:[0,1] neg_hi:[0,1]
v_cvt_pk_bf16_f32 v58,v58,v58
v_and_b32 v58,0xffff0000,v58
v_rcp_f32 v58,v58
v_cvt_pk_bf16_f32 v44,v48,v49
v_cvt_pk_bf16_f32 v45,v50,v51
v_cvt_pk_bf16_f32 v46,v52,v53
v_cvt_pk_bf16_f32 v47,v54,v55
v_lshlrev_b32 v48,16,v44
v_and_b32 v49,0xffff0000,v44
v_lshlrev_b32 v50,16,v45
v_and_b32 v51,0xffff0000,v45
v_lshlrev_b32 v52,16,v46
v_and_b32 v53,0xffff0000,v46
v_lshlrev_b32 v54,16,v47
v_and_b32 v55,0xffff0000,v47
v_pk_mul_f32 v[48:49],v[48:49],v[58:59] op_sel_hi:[1,0]
v_pk_mul_f32 v[50:51],v[50:51],v[58:59] op_sel_hi:[1,0]
v_pk_mul_f32 v[52:53],v[52:53],v[58:59] op_sel_hi:[1,0]
v_pk_mul_f32 v[54:55],v[54:55],v[58:59] op_sel_hi:[1,0]
v_cvt_pk_bf16_f32 v44,v48,v49
v_cvt_pk_bf16_f32 v45,v50,v51
v_cvt_pk_bf16_f32 v46,v52,v53
v_cvt_pk_bf16_f32 v47,v54,v55
buffer_store_dwordx4 v[44:47],v0,s[8:11],s59 offen offset:1024 sc1
s_mov_b32 s4,s18
s_mov_b32 s5,s19
s_mov_b32 s6,8192
s_mov_b32 s7,0x20000
s_cmp_ge_u32 s2,2
s_cbranch_scc1 L_m0_2
s_lshl_b32 s56,s2,2
s_add_u32 s56,s56,s46
v_bfe_u32 v2,v1,2,2
v_and_b32 v3,1,v1
v_lshl_add_u32 v2,v2,1,v3
v_lshlrev_b32 v2,10,v2
v_lshrrev_b32 v3,4,v1
v_lshl_add_u32 v2,v3,5,v2
v_and_b32 v3,2,v1
v_lshl_add_u32 v2,v3,1,v2
s_lshl_b32 s57,s56,7
buffer_load_dword v32,v2,s[4:7],s57 offen offset:0
buffer_load_dword v33,v2,s[4:7],s57 offen offset:8
buffer_load_dword v34,v2,s[4:7],s57 offen offset:16
buffer_load_dword v35,v2,s[4:7],s57 offen offset:24
v_lshrrev_b32 v2,3,v1
v_lshlrev_b32 v2,9,v2
v_and_b32 v3,7,v1
v_lshl_add_u32 v2,v3,4,v2
s_and_b32 s57,s56,1
s_lshl_b32 s57,s57,8
s_and_b32 s58,s56,2
s_lshl_b32 s58,s58,6
s_add_u32 s57,s57,s58
s_and_b32 s58,s56,4
s_lshl_b32 s58,s58,10
s_add_u32 s57,s57,s58
s_waitcnt vmcnt(0)
s_add_u32 s58,s57,11534336
buffer_store_dwordx4 v[32:35],v2,s[8:11],s58 offen sc1
s_add_u32 s58,s57,12582912
buffer_store_dwordx4 v[32:35],v2,s[8:11],s58 offen sc1
s_add_u32 s58,s57,17825792
buffer_store_dwordx4 v[32:35],v2,s[8:11],s58 offen sc1
L_m0_2:
s_cmp_lg_u32 s46,0
s_cbranch_scc1 L_tk_3
s_mov_b64 exec,1
v_mov_b32 v4,159744
ds_write_b32 v4,v15
s_mov_b64 exec,-1
s_waitcnt lgkmcnt(0)
L_tk_3:
s_barrier
v_mov_b32 v4,159744
ds_read_b32 v3,v4
s_waitcnt lgkmcnt(0)
v_readfirstlane_b32 s47,v3
s_mov_b32 s3,0
s_cmp_ge_u32 s47,32
s_cselect_b32 s53,0x10001,1
s_and_b32 s47,s47,31
s_lshl_b32 s50,s46,10
s_cmp_eq_u32 s46,0
s_cselect_b32 s52,0,0x80000000
s_mov_b32 s28,0x3f803f80
s_mov_b32 s29,0x3f803f80
s_mov_b32 s51,0
s_bfe_u32 s56,s48,0x10001
s_and_b32 s57,s48,1
s_add_u32 s58,s56,6
s_sub_u32 s59,5,s57
s_cmp_ge_u32 s47,16
s_cselect_b32 s58,s58,s59
s_cselect_b32 s57,s57,s56
s_and_b32 s59,s47,15
s_lshl4_add_u32 s57,s57,s59
s_cmp_ge_u32 s48,4
s_cselect_b32 s48,s58,s48
s_cselect_b32 s47,s57,s47
L_roles:
s_cmp_ge_u32 s48,6
s_cbranch_scc1 L_ra_6
v_and_b32 v2,15,v1
v_lshlrev_b32 v2,2,v2
v_lshrrev_b32 v3,4,v1
v_lshl_add_u32 v4,v3,16,v2
v_lshl_add_u32 v5,v3,13,v2
s_lshl_b32 s58,s47,8
s_lshl_b32 s57,s46,6
s_add_u32 s58,s58,s57
s_lshl_b32 s59,s47,17
s_add_u32 s59,s59,s57
s_lshl_b32 s60,s46,15
v_add_u32 v6,s60,v0
s_mov_b32 s61,0x05040100
s_mov_b32 s62,0x07060302
s_lshl_b32 s63,s46,19
s_cmp_lt_u32 s48,3
s_cselect_b32 s63,s63,0
s_mov_b32 s4,s22
s_mov_b32 s5,s23
s_mov_b32 s6,4194304
s_mov_b32 s7,0x20000
s_xor_b32 s56,s63,0
s_add_u32 s56,s56,s58
buffer_load_dword v24,v4,s[4:7],s56 offen
s_add_u32 s56,s56,8192
buffer_load_dword v25,v4,s[4:7],s56 offen
s_add_u32 s56,s56,8192
buffer_load_dword v26,v4,s[4:7],s56 offen
s_add_u32 s56,s56,8192
buffer_load_dword v27,v4,s[4:7],s56 offen
s_add_u32 s56,s56,8192
buffer_load_dword v28,v4,s[4:7],s56 offen
s_add_u32 s56,s56,8192
buffer_load_dword v29,v4,s[4:7],s56 offen
s_add_u32 s56,s56,8192
buffer_load_dword v30,v4,s[4:7],s56 offen
s_add_u32 s56,s56,8192
buffer_load_dword v31,v4,s[4:7],s56 offen
s_xor_b32 s56,s63,262144
s_add_u32 s56,s56,s58
buffer_load_dword v32,v4,s[4:7],s56 offen
s_add_u32 s56,s56,8192
buffer_load_dword v33,v4,s[4:7],s56 offen
s_add_u32 s56,s56,8192
buffer_load_dword v34,v4,s[4:7],s56 offen
s_add_u32 s56,s56,8192
buffer_load_dword v35,v4,s[4:7],s56 offen
s_add_u32 s56,s56,8192
buffer_load_dword v36,v4,s[4:7],s56 offen
s_add_u32 s56,s56,8192
buffer_load_dword v37,v4,s[4:7],s56 offen
s_add_u32 s56,s56,8192
buffer_load_dword v38,v4,s[4:7],s56 offen
s_add_u32 s56,s56,8192
buffer_load_dword v39,v4,s[4:7],s56 offen
s_xor_b32 s56,s63,524288
s_add_u32 s56,s56,s58
buffer_load_dword v40,v4,s[4:7],s56 offen
s_add_u32 s56,s56,8192
buffer_load_dword v41,v4,s[4:7],s56 offen
s_add_u32 s56,s56,8192
buffer_load_dword v42,v4,s[4:7],s56 offen
s_add_u32 s56,s56,8192
buffer_load_dword v43,v4,s[4:7],s56 offen
s_add_u32 s56,s56,8192
buffer_load_dword v44,v4,s[4:7],s56 offen
s_add_u32 s56,s56,8192
buffer_load_dword v45,v4,s[4:7],s56 offen
s_add_u32 s56,s56,8192
buffer_load_dword v46,v4,s[4:7],s56 offen
s_add_u32 s56,s56,8192
buffer_load_dword v47,v4,s[4:7],s56 offen
s_xor_b32 s56,s63,786432
s_add_u32 s56,s56,s58
buffer_load_dword v48,v4,s[4:7],s56 offen
s_add_u32 s56,s56,8192
buffer_load_dword v49,v4,s[4:7],s56 offen
s_add_u32 s56,s56,8192
buffer_load_dword v50,v4,s[4:7],s56 offen
s_add_u32 s56,s56,8192
buffer_load_dword v51,v4,s[4:7],s56 offen
s_add_u32 s56,s56,8192
buffer_load_dword v52,v4,s[4:7],s56 offen
s_add_u32 s56,s56,8192
buffer_load_dword v53,v4,s[4:7],s56 offen
s_add_u32 s56,s56,8192
buffer_load_dword v54,v4,s[4:7],s56 offen
s_add_u32 s56,s56,8192
buffer_load_dword v55,v4,s[4:7],s56 offen
s_xor_b32 s56,s63,1048576
s_add_u32 s56,s56,s58
buffer_load_dword v56,v4,s[4:7],s56 offen
s_add_u32 s56,s56,8192
buffer_load_dword v57,v4,s[4:7],s56 offen
s_add_u32 s56,s56,8192
buffer_load_dword v58,v4,s[4:7],s56 offen
s_add_u32 s56,s56,8192
buffer_load_dword v59,v4,s[4:7],s56 offen
s_add_u32 s56,s56,8192
buffer_load_dword v60,v4,s[4:7],s56 offen
s_add_u32 s56,s56,8192
buffer_load_dword v61,v4,s[4:7],s56 offen
s_add_u32 s56,s56,8192
buffer_load_dword v62,v4,s[4:7],s56 offen
s_add_u32 s56,s56,8192
buffer_load_dword v63,v4,s[4:7],s56 offen
s_xor_b32 s56,s63,1310720
s_add_u32 s56,s56,s58
buffer_load_dword v64,v4,s[4:7],s56 offen
s_add_u32 s56,s56,8192
buffer_load_dword v65,v4,s[4:7],s56 offen
s_add_u32 s56,s56,8192
buffer_load_dword v66,v4,s[4:7],s56 offen
s_add_u32 s56,s56,8192
buffer_load_dword v67,v4,s[4:7],s56 offen
s_add_u32 s56,s56,8192
buffer_load_dword v68,v4,s[4:7],s56 offen
s_add_u32 s56,s56,8192
buffer_load_dword v69,v4,s[4:7],s56 offen
s_add_u32 s56,s56,8192
buffer_load_dword v70,v4,s[4:7],s56 offen
s_add_u32 s56,s56,8192
buffer_load_dword v71,v4,s[4:7],s56 offen
s_xor_b32 s56,s63,1572864
s_add_u32 s56,s56,s58
buffer_load_dword v72,v4,s[4:7],s56 offen
s_add_u32 s56,s56,8192
buffer_load_dword v73,v4,s[4:7],s56 offen
s_add_u32 s56,s56,8192
buffer_load_dword v74,v4,s[4:7],s56 offen
s_add_u32 s56,s56,8192
buffer_load_dword v75,v4,s[4:7],s56 offen
s_add_u32 s56,s56,8192
buffer_load_dword v76,v4,s[4:7],s56 offen
s_add_u32 s56,s56,8192
buffer_load_dword v77,v4,s[4:7],s56 offen
s_add_u32 s56,s56,8192
buffer_load_dword v78,v4,s[4:7],s56 offen
s_add_u32 s56,s56,8192
buffer_load_dword v79,v4,s[4:7],s56 offen
s_waitcnt vmcnt(48)
v_perm_b32 v80,v25,v24,s61
v_perm_b32 v81,v27,v26,s61
v_perm_b32 v82,v29,v28,s61
v_perm_b32 v83,v31,v30,s61
v_perm_b32 v84,v25,v24,s62
v_perm_b32 v85,v27,v26,s62
v_perm_b32 v86,v29,v28,s62
v_perm_b32 v87,v31,v30,s62
v_accvgpr_write_b32 a128,v80
v_accvgpr_write_b32 a129,v81
v_accvgpr_write_b32 a130,v82
v_accvgpr_write_b32 a131,v83
v_accvgpr_write_b32 a136,v84
v_accvgpr_write_b32 a137,v85
v_accvgpr_write_b32 a138,v86
v_accvgpr_write_b32 a139,v87
s_xor_b32 s56,s63,1835008
s_add_u32 s56,s56,s58
buffer_load_dword v24,v4,s[4:7],s56 offen
s_add_u32 s56,s56,8192
buffer_load_dword v25,v4,s[4:7],s56 offen
s_add_u32 s56,s56,8192
buffer_load_dword v26,v4,s[4:7],s56 offen
s_add_u32 s56,s56,8192
buffer_load_dword v27,v4,s[4:7],s56 offen
s_add_u32 s56,s56,8192
buffer_load_dword v28,v4,s[4:7],s56 offen
s_add_u32 s56,s56,8192
buffer_load_dword v29,v4,s[4:7],s56 offen
s_add_u32 s56,s56,8192
buffer_load_dword v30,v4,s[4:7],s56 offen
s_add_u32 s56,s56,8192
buffer_load_dword v31,v4,s[4:7],s56 offen
s_barrier
s_cmp_lg_u32 s46,0
s_cbranch_scc1 L_ar_10
v_mov_b32 v8,128
v_mov_b32 v9,s53
s_mov_b64 exec,1
buffer_atomic_add v9,v8,s[12:15],0 offen
s_mov_b64 exec,-1
L_ar_10:
s_mov_b32 s53,0
s_waitcnt vmcnt(48)
v_perm_b32 v80,v33,v32,s61
v_perm_b32 v81,v35,v34,s61
v_perm_b32 v82,v37,v36,s61
v_perm_b32 v83,v39,v38,s61
v_perm_b32 v84,v33,v32,s62
v_perm_b32 v85,v35,v34,s62
v_perm_b32 v86,v37,v36,s62
v_perm_b32 v87,v39,v38,s62
v_accvgpr_write_b32 a132,v80
v_accvgpr_write_b32 a133,v81
v_accvgpr_write_b32 a134,v82
v_accvgpr_write_b32 a135,v83
v_accvgpr_write_b32 a140,v84
v_accvgpr_write_b32 a141,v85
v_accvgpr_write_b32 a142,v86
v_accvgpr_write_b32 a143,v87
s_xor_b32 s56,s63,2097152
s_add_u32 s56,s56,s58
buffer_load_dword v32,v4,s[4:7],s56 offen
s_add_u32 s56,s56,8192
buffer_load_dword v33,v4,s[4:7],s56 offen
s_add_u32 s56,s56,8192
buffer_load_dword v34,v4,s[4:7],s56 offen
s_add_u32 s56,s56,8192
buffer_load_dword v35,v4,s[4:7],s56 offen
s_add_u32 s56,s56,8192
buffer_load_dword v36,v4,s[4:7],s56 offen
s_add_u32 s56,s56,8192
buffer_load_dword v37,v4,s[4:7],s56 offen
s_add_u32 s56,s56,8192
buffer_load_dword v38,v4,s[4:7],s56 offen
s_add_u32 s56,s56,8192
buffer_load_dword v39,v4,s[4:7],s56 offen
s_waitcnt vmcnt(48)
v_perm_b32 v80,v41,v40,s61
v_perm_b32 v81,v43,v42,s61
v_perm_b32 v82,v45,v44,s61
v_perm_b32 v83,v47,v46,s61
v_perm_b32 v84,v41,v40,s62
v_perm_b32 v85,v43,v42,s62
v_perm_b32 v86,v45,v44,s62
v_perm_b32 v87,v47,v46,s62
v_accvgpr_write_b32 a144,v80
v_accvgpr_write_b32 a145,v81
v_accvgpr_write_b32 a146,v82
v_accvgpr_write_b32 a147,v83
v_accvgpr_write_b32 a152,v84
v_accvgpr_write_b32 a153,v85
v_accvgpr_write_b32 a154,v86
v_accvgpr_write_b32 a155,v87
s_xor_b32 s56,s63,2359296
s_add_u32 s56,s56,s58
buffer_load_dword v40,v4,s[4:7],s56 offen
s_add_u32 s56,s56,8192
buffer_load_dword v41,v4,s[4:7],s56 offen
s_add_u32 s56,s56,8192
buffer_load_dword v42,v4,s[4:7],s56 offen
s_add_u32 s56,s56,8192
buffer_load_dword v43,v4,s[4:7],s56 offen
s_add_u32 s56,s56,8192
buffer_load_dword v44,v4,s[4:7],s56 offen
s_add_u32 s56,s56,8192
buffer_load_dword v45,v4,s[4:7],s56 offen
s_add_u32 s56,s56,8192
buffer_load_dword v46,v4,s[4:7],s56 offen
s_add_u32 s56,s56,8192
buffer_load_dword v47,v4,s[4:7],s56 offen
s_waitcnt vmcnt(48)
v_perm_b32 v80,v49,v48,s61
v_perm_b32 v81,v51,v50,s61
v_perm_b32 v82,v53,v52,s61
v_perm_b32 v83,v55,v54,s61
v_perm_b32 v84,v49,v48,s62
v_perm_b32 v85,v51,v50,s62
v_perm_b32 v86,v53,v52,s62
v_perm_b32 v87,v55,v54,s62
v_accvgpr_write_b32 a148,v80
v_accvgpr_write_b32 a149,v81
v_accvgpr_write_b32 a150,v82
v_accvgpr_write_b32 a151,v83
v_accvgpr_write_b32 a156,v84
v_accvgpr_write_b32 a157,v85
v_accvgpr_write_b32 a158,v86
v_accvgpr_write_b32 a159,v87
s_xor_b32 s56,s63,2621440
s_add_u32 s56,s56,s58
buffer_load_dword v48,v4,s[4:7],s56 offen
s_add_u32 s56,s56,8192
buffer_load_dword v49,v4,s[4:7],s56 offen
s_add_u32 s56,s56,8192
buffer_load_dword v50,v4,s[4:7],s56 offen
s_add_u32 s56,s56,8192
buffer_load_dword v51,v4,s[4:7],s56 offen
s_add_u32 s56,s56,8192
buffer_load_dword v52,v4,s[4:7],s56 offen
s_add_u32 s56,s56,8192
buffer_load_dword v53,v4,s[4:7],s56 offen
s_add_u32 s56,s56,8192
buffer_load_dword v54,v4,s[4:7],s56 offen
s_add_u32 s56,s56,8192
buffer_load_dword v55,v4,s[4:7],s56 offen
s_waitcnt vmcnt(48)
v_perm_b32 v80,v57,v56,s61
v_perm_b32 v81,v59,v58,s61
v_perm_b32 v82,v61,v60,s61
v_perm_b32 v83,v63,v62,s61
v_perm_b32 v84,v57,v56,s62
v_perm_b32 v85,v59,v58,s62
v_perm_b32 v86,v61,v60,s62
v_perm_b32 v87,v63,v62,s62
v_accvgpr_write_b32 a160,v80
v_accvgpr_write_b32 a161,v81
v_accvgpr_write_b32 a162,v82
v_accvgpr_write_b32 a163,v83
v_accvgpr_write_b32 a168,v84
v_accvgpr_write_b32 a169,v85
v_accvgpr_write_b32 a170,v86
v_accvgpr_write_b32 a171,v87
s_xor_b32 s56,s63,2883584
s_add_u32 s56,s56,s58
buffer_load_dword v56,v4,s[4:7],s56 offen
s_add_u32 s56,s56,8192
buffer_load_dword v57,v4,s[4:7],s56 offen
s_add_u32 s56,s56,8192
buffer_load_dword v58,v4,s[4:7],s56 offen
s_add_u32 s56,s56,8192
buffer_load_dword v59,v4,s[4:7],s56 offen
s_add_u32 s56,s56,8192
buffer_load_dword v60,v4,s[4:7],s56 offen
s_add_u32 s56,s56,8192
buffer_load_dword v61,v4,s[4:7],s56 offen
s_add_u32 s56,s56,8192
buffer_load_dword v62,v4,s[4:7],s56 offen
s_add_u32 s56,s56,8192
buffer_load_dword v63,v4,s[4:7],s56 offen
s_waitcnt vmcnt(48)
v_perm_b32 v80,v65,v64,s61
v_perm_b32 v81,v67,v66,s61
v_perm_b32 v82,v69,v68,s61
v_perm_b32 v83,v71,v70,s61
v_perm_b32 v84,v65,v64,s62
v_perm_b32 v85,v67,v66,s62
v_perm_b32 v86,v69,v68,s62
v_perm_b32 v87,v71,v70,s62
v_accvgpr_write_b32 a164,v80
v_accvgpr_write_b32 a165,v81
v_accvgpr_write_b32 a166,v82
v_accvgpr_write_b32 a167,v83
v_accvgpr_write_b32 a172,v84
v_accvgpr_write_b32 a173,v85
v_accvgpr_write_b32 a174,v86
v_accvgpr_write_b32 a175,v87
s_xor_b32 s56,s63,3145728
s_add_u32 s56,s56,s58
buffer_load_dword v64,v4,s[4:7],s56 offen
s_add_u32 s56,s56,8192
buffer_load_dword v65,v4,s[4:7],s56 offen
s_add_u32 s56,s56,8192
buffer_load_dword v66,v4,s[4:7],s56 offen
s_add_u32 s56,s56,8192
buffer_load_dword v67,v4,s[4:7],s56 offen
s_add_u32 s56,s56,8192
buffer_load_dword v68,v4,s[4:7],s56 offen
s_add_u32 s56,s56,8192
buffer_load_dword v69,v4,s[4:7],s56 offen
s_add_u32 s56,s56,8192
buffer_load_dword v70,v4,s[4:7],s56 offen
s_add_u32 s56,s56,8192
buffer_load_dword v71,v4,s[4:7],s56 offen
s_waitcnt vmcnt(48)
v_perm_b32 v80,v73,v72,s61
v_perm_b32 v81,v75,v74,s61
v_perm_b32 v82,v77,v76,s61
v_perm_b32 v83,v79,v78,s61
v_perm_b32 v84,v73,v72,s62
v_perm_b32 v85,v75,v74,s62
v_perm_b32 v86,v77,v76,s62
v_perm_b32 v87,v79,v78,s62
v_accvgpr_write_b32 a176,v80
v_accvgpr_write_b32 a177,v81
v_accvgpr_write_b32 a178,v82
v_accvgpr_write_b32 a179,v83
v_accvgpr_write_b32 a184,v84
v_accvgpr_write_b32 a185,v85
v_accvgpr_write_b32 a186,v86
v_accvgpr_write_b32 a187,v87
s_xor_b32 s56,s63,3407872
s_add_u32 s56,s56,s58
buffer_load_dword v72,v4,s[4:7],s56 offen
s_add_u32 s56,s56,8192
buffer_load_dword v73,v4,s[4:7],s56 offen
s_add_u32 s56,s56,8192
buffer_load_dword v74,v4,s[4:7],s56 offen
s_add_u32 s56,s56,8192
buffer_load_dword v75,v4,s[4:7],s56 offen
s_add_u32 s56,s56,8192
buffer_load_dword v76,v4,s[4:7],s56 offen
s_add_u32 s56,s56,8192
buffer_load_dword v77,v4,s[4:7],s56 offen
s_add_u32 s56,s56,8192
buffer_load_dword v78,v4,s[4:7],s56 offen
s_add_u32 s56,s56,8192
buffer_load_dword v79,v4,s[4:7],s56 offen
s_waitcnt vmcnt(48)
v_perm_b32 v80,v25,v24,s61
v_perm_b32 v81,v27,v26,s61
v_perm_b32 v82,v29,v28,s61
v_perm_b32 v83,v31,v30,s61
v_perm_b32 v84,v25,v24,s62
v_perm_b32 v85,v27,v26,s62
v_perm_b32 v86,v29,v28,s62
v_perm_b32 v87,v31,v30,s62
v_accvgpr_write_b32 a180,v80
v_accvgpr_write_b32 a181,v81
v_accvgpr_write_b32 a182,v82
v_accvgpr_write_b32 a183,v83
v_accvgpr_write_b32 a188,v84
v_accvgpr_write_b32 a189,v85
v_accvgpr_write_b32 a190,v86
v_accvgpr_write_b32 a191,v87
s_xor_b32 s56,s63,3670016
s_add_u32 s56,s56,s58
buffer_load_dword v24,v4,s[4:7],s56 offen
s_add_u32 s56,s56,8192
buffer_load_dword v25,v4,s[4:7],s56 offen
s_add_u32 s56,s56,8192
buffer_load_dword v26,v4,s[4:7],s56 offen
s_add_u32 s56,s56,8192
buffer_load_dword v27,v4,s[4:7],s56 offen
s_add_u32 s56,s56,8192
buffer_load_dword v28,v4,s[4:7],s56 offen
s_add_u32 s56,s56,8192
buffer_load_dword v29,v4,s[4:7],s56 offen
s_add_u32 s56,s56,8192
buffer_load_dword v30,v4,s[4:7],s56 offen
s_add_u32 s56,s56,8192
buffer_load_dword v31,v4,s[4:7],s56 offen
s_waitcnt vmcnt(48)
v_perm_b32 v80,v33,v32,s61
v_perm_b32 v81,v35,v34,s61
v_perm_b32 v82,v37,v36,s61
v_perm_b32 v83,v39,v38,s61
v_perm_b32 v84,v33,v32,s62
v_perm_b32 v85,v35,v34,s62
v_perm_b32 v86,v37,v36,s62
v_perm_b32 v87,v39,v38,s62
v_accvgpr_write_b32 a192,v80
v_accvgpr_write_b32 a193,v81
v_accvgpr_write_b32 a194,v82
v_accvgpr_write_b32 a195,v83
v_accvgpr_write_b32 a200,v84
v_accvgpr_write_b32 a201,v85
v_accvgpr_write_b32 a202,v86
v_accvgpr_write_b32 a203,v87
s_xor_b32 s56,s63,3932160
s_add_u32 s56,s56,s58
buffer_load_dword v32,v4,s[4:7],s56 offen
s_add_u32 s56,s56,8192
buffer_load_dword v33,v4,s[4:7],s56 offen
s_add_u32 s56,s56,8192
buffer_load_dword v34,v4,s[4:7],s56 offen
s_add_u32 s56,s56,8192
buffer_load_dword v35,v4,s[4:7],s56 offen
s_add_u32 s56,s56,8192
buffer_load_dword v36,v4,s[4:7],s56 offen
s_add_u32 s56,s56,8192
buffer_load_dword v37,v4,s[4:7],s56 offen
s_add_u32 s56,s56,8192
buffer_load_dword v38,v4,s[4:7],s56 offen
s_add_u32 s56,s56,8192
buffer_load_dword v39,v4,s[4:7],s56 offen
s_waitcnt vmcnt(48)
v_perm_b32 v80,v41,v40,s61
v_perm_b32 v81,v43,v42,s61
v_perm_b32 v82,v45,v44,s61
v_perm_b32 v83,v47,v46,s61
v_perm_b32 v84,v41,v40,s62
v_perm_b32 v85,v43,v42,s62
v_perm_b32 v86,v45,v44,s62
v_perm_b32 v87,v47,v46,s62
v_accvgpr_write_b32 a196,v80
v_accvgpr_write_b32 a197,v81
v_accvgpr_write_b32 a198,v82
v_accvgpr_write_b32 a199,v83
v_accvgpr_write_b32 a204,v84
v_accvgpr_write_b32 a205,v85
v_accvgpr_write_b32 a206,v86
v_accvgpr_write_b32 a207,v87
s_mov_b32 s4,s24
s_mov_b32 s5,s25
s_mov_b32 s6,4194304
s_mov_b32 s7,0x20000
s_xor_b32 s56,s63,0
s_add_u32 s56,s56,s58
buffer_load_dword v40,v4,s[4:7],s56 offen
s_add_u32 s56,s56,8192
buffer_load_dword v41,v4,s[4:7],s56 offen
s_add_u32 s56,s56,8192
buffer_load_dword v42,v4,s[4:7],s56 offen
s_add_u32 s56,s56,8192
buffer_load_dword v43,v4,s[4:7],s56 offen
s_add_u32 s56,s56,8192
buffer_load_dword v44,v4,s[4:7],s56 offen
s_add_u32 s56,s56,8192
buffer_load_dword v45,v4,s[4:7],s56 offen
s_add_u32 s56,s56,8192
buffer_load_dword v46,v4,s[4:7],s56 offen
s_add_u32 s56,s56,8192
buffer_load_dword v47,v4,s[4:7],s56 offen
s_waitcnt vmcnt(48)
v_perm_b32 v80,v49,v48,s61
v_perm_b32 v81,v51,v50,s61
v_perm_b32 v82,v53,v52,s61
v_perm_b32 v83,v55,v54,s61
v_perm_b32 v84,v49,v48,s62
v_perm_b32 v85,v51,v50,s62
v_perm_b32 v86,v53,v52,s62
v_perm_b32 v87,v55,v54,s62
v_accvgpr_write_b32 a208,v80
v_accvgpr_write_b32 a209,v81
v_accvgpr_write_b32 a210,v82
v_accvgpr_write_b32 a211,v83
v_accvgpr_write_b32 a216,v84
v_accvgpr_write_b32 a217,v85
v_accvgpr_write_b32 a218,v86
v_accvgpr_write_b32 a219,v87
s_xor_b32 s56,s63,262144
s_add_u32 s56,s56,s58
buffer_load_dword v48,v4,s[4:7],s56 offen
s_add_u32 s56,s56,8192
buffer_load_dword v49,v4,s[4:7],s56 offen
s_add_u32 s56,s56,8192
buffer_load_dword v50,v4,s[4:7],s56 offen
s_add_u32 s56,s56,8192
buffer_load_dword v51,v4,s[4:7],s56 offen
s_add_u32 s56,s56,8192
buffer_load_dword v52,v4,s[4:7],s56 offen
s_add_u32 s56,s56,8192
buffer_load_dword v53,v4,s[4:7],s56 offen
s_add_u32 s56,s56,8192
buffer_load_dword v54,v4,s[4:7],s56 offen
s_add_u32 s56,s56,8192
buffer_load_dword v55,v4,s[4:7],s56 offen
s_waitcnt vmcnt(48)
v_perm_b32 v80,v57,v56,s61
v_perm_b32 v81,v59,v58,s61
v_perm_b32 v82,v61,v60,s61
v_perm_b32 v83,v63,v62,s61
v_perm_b32 v84,v57,v56,s62
v_perm_b32 v85,v59,v58,s62
v_perm_b32 v86,v61,v60,s62
v_perm_b32 v87,v63,v62,s62
v_accvgpr_write_b32 a212,v80
v_accvgpr_write_b32 a213,v81
v_accvgpr_write_b32 a214,v82
v_accvgpr_write_b32 a215,v83
v_accvgpr_write_b32 a220,v84
v_accvgpr_write_b32 a221,v85
v_accvgpr_write_b32 a222,v86
v_accvgpr_write_b32 a223,v87
s_xor_b32 s56,s63,524288
s_add_u32 s56,s56,s58
buffer_load_dword v56,v4,s[4:7],s56 offen
s_add_u32 s56,s56,8192
buffer_load_dword v57,v4,s[4:7],s56 offen
s_add_u32 s56,s56,8192
buffer_load_dword v58,v4,s[4:7],s56 offen
s_add_u32 s56,s56,8192
buffer_load_dword v59,v4,s[4:7],s56 offen
s_add_u32 s56,s56,8192
buffer_load_dword v60,v4,s[4:7],s56 offen
s_add_u32 s56,s56,8192
buffer_load_dword v61,v4,s[4:7],s56 offen
s_add_u32 s56,s56,8192
buffer_load_dword v62,v4,s[4:7],s56 offen
s_add_u32 s56,s56,8192
buffer_load_dword v63,v4,s[4:7],s56 offen
s_waitcnt vmcnt(48)
v_perm_b32 v80,v65,v64,s61
v_perm_b32 v81,v67,v66,s61
v_perm_b32 v82,v69,v68,s61
v_perm_b32 v83,v71,v70,s61
v_perm_b32 v84,v65,v64,s62
v_perm_b32 v85,v67,v66,s62
v_perm_b32 v86,v69,v68,s62
v_perm_b32 v87,v71,v70,s62
v_accvgpr_write_b32 a224,v80
v_accvgpr_write_b32 a225,v81
v_accvgpr_write_b32 a226,v82
v_accvgpr_write_b32 a227,v83
v_accvgpr_write_b32 a232,v84
v_accvgpr_write_b32 a233,v85
v_accvgpr_write_b32 a234,v86
v_accvgpr_write_b32 a235,v87
s_xor_b32 s56,s63,786432
s_add_u32 s56,s56,s58
buffer_load_dword v64,v4,s[4:7],s56 offen
s_add_u32 s56,s56,8192
buffer_load_dword v65,v4,s[4:7],s56 offen
s_add_u32 s56,s56,8192
buffer_load_dword v66,v4,s[4:7],s56 offen
s_add_u32 s56,s56,8192
buffer_load_dword v67,v4,s[4:7],s56 offen
s_add_u32 s56,s56,8192
buffer_load_dword v68,v4,s[4:7],s56 offen
s_add_u32 s56,s56,8192
buffer_load_dword v69,v4,s[4:7],s56 offen
s_add_u32 s56,s56,8192
buffer_load_dword v70,v4,s[4:7],s56 offen
s_add_u32 s56,s56,8192
buffer_load_dword v71,v4,s[4:7],s56 offen
s_waitcnt vmcnt(48)
v_perm_b32 v80,v73,v72,s61
v_perm_b32 v81,v75,v74,s61
v_perm_b32 v82,v77,v76,s61
v_perm_b32 v83,v79,v78,s61
v_perm_b32 v84,v73,v72,s62
v_perm_b32 v85,v75,v74,s62
v_perm_b32 v86,v77,v76,s62
v_perm_b32 v87,v79,v78,s62
v_accvgpr_write_b32 a228,v80
v_accvgpr_write_b32 a229,v81
v_accvgpr_write_b32 a230,v82
v_accvgpr_write_b32 a231,v83
v_accvgpr_write_b32 a236,v84
v_accvgpr_write_b32 a237,v85
v_accvgpr_write_b32 a238,v86
v_accvgpr_write_b32 a239,v87
s_xor_b32 s56,s63,1048576
s_add_u32 s56,s56,s58
buffer_load_dword v72,v4,s[4:7],s56 offen
s_add_u32 s56,s56,8192
buffer_load_dword v73,v4,s[4:7],s56 offen
s_add_u32 s56,s56,8192
buffer_load_dword v74,v4,s[4:7],s56 offen
s_add_u32 s56,s56,8192
buffer_load_dword v75,v4,s[4:7],s56 offen
s_add_u32 s56,s56,8192
buffer_load_dword v76,v4,s[4:7],s56 offen
s_add_u32 s56,s56,8192
buffer_load_dword v77,v4,s[4:7],s56 offen
s_add_u32 s56,s56,8192
buffer_load_dword v78,v4,s[4:7],s56 offen
s_add_u32 s56,s56,8192
buffer_load_dword v79,v4,s[4:7],s56 offen
s_waitcnt vmcnt(48)
v_perm_b32 v80,v25,v24,s61
v_perm_b32 v81,v27,v26,s61
v_perm_b32 v82,v29,v28,s61
v_perm_b32 v83,v31,v30,s61
v_perm_b32 v84,v25,v24,s62
v_perm_b32 v85,v27,v26,s62
v_perm_b32 v86,v29,v28,s62
v_perm_b32 v87,v31,v30,s62
v_accvgpr_write_b32 a240,v80
v_accvgpr_write_b32 a241,v81
v_accvgpr_write_b32 a242,v82
v_accvgpr_write_b32 a243,v83
v_accvgpr_write_b32 a248,v84
v_accvgpr_write_b32 a249,v85
v_accvgpr_write_b32 a250,v86
v_accvgpr_write_b32 a251,v87
s_xor_b32 s56,s63,1310720
s_add_u32 s56,s56,s58
buffer_load_dword v24,v4,s[4:7],s56 offen
s_add_u32 s56,s56,8192
buffer_load_dword v25,v4,s[4:7],s56 offen
s_add_u32 s56,s56,8192
buffer_load_dword v26,v4,s[4:7],s56 offen
s_add_u32 s56,s56,8192
buffer_load_dword v27,v4,s[4:7],s56 offen
s_add_u32 s56,s56,8192
buffer_load_dword v28,v4,s[4:7],s56 offen
s_add_u32 s56,s56,8192
buffer_load_dword v29,v4,s[4:7],s56 offen
s_add_u32 s56,s56,8192
buffer_load_dword v30,v4,s[4:7],s56 offen
s_add_u32 s56,s56,8192
buffer_load_dword v31,v4,s[4:7],s56 offen
s_waitcnt vmcnt(48)
v_perm_b32 v80,v33,v32,s61
v_perm_b32 v81,v35,v34,s61
v_perm_b32 v82,v37,v36,s61
v_perm_b32 v83,v39,v38,s61
v_perm_b32 v84,v33,v32,s62
v_perm_b32 v85,v35,v34,s62
v_perm_b32 v86,v37,v36,s62
v_perm_b32 v87,v39,v38,s62
v_accvgpr_write_b32 a244,v80
v_accvgpr_write_b32 a245,v81
v_accvgpr_write_b32 a246,v82
v_accvgpr_write_b32 a247,v83
v_accvgpr_write_b32 a252,v84
v_accvgpr_write_b32 a253,v85
v_accvgpr_write_b32 a254,v86
v_accvgpr_write_b32 a255,v87
s_xor_b32 s56,s63,1572864
s_add_u32 s56,s56,s58
buffer_load_dword v32,v4,s[4:7],s56 offen
s_add_u32 s56,s56,8192
buffer_load_dword v33,v4,s[4:7],s56 offen
s_add_u32 s56,s56,8192
buffer_load_dword v34,v4,s[4:7],s56 offen
s_add_u32 s56,s56,8192
buffer_load_dword v35,v4,s[4:7],s56 offen
s_add_u32 s56,s56,8192
buffer_load_dword v36,v4,s[4:7],s56 offen
s_add_u32 s56,s56,8192
buffer_load_dword v37,v4,s[4:7],s56 offen
s_add_u32 s56,s56,8192
buffer_load_dword v38,v4,s[4:7],s56 offen
s_add_u32 s56,s56,8192
buffer_load_dword v39,v4,s[4:7],s56 offen
s_waitcnt vmcnt(48)
v_perm_b32 v128,v41,v40,s61
v_perm_b32 v129,v43,v42,s61
v_perm_b32 v130,v45,v44,s61
v_perm_b32 v131,v47,v46,s61
v_perm_b32 v136,v41,v40,s62
v_perm_b32 v137,v43,v42,s62
v_perm_b32 v138,v45,v44,s62
v_perm_b32 v139,v47,v46,s62
s_xor_b32 s56,s63,1835008
s_add_u32 s56,s56,s58
buffer_load_dword v40,v4,s[4:7],s56 offen
s_add_u32 s56,s56,8192
buffer_load_dword v41,v4,s[4:7],s56 offen
s_add_u32 s56,s56,8192
buffer_load_dword v42,v4,s[4:7],s56 offen
s_add_u32 s56,s56,8192
buffer_load_dword v43,v4,s[4:7],s56 offen
s_add_u32 s56,s56,8192
buffer_load_dword v44,v4,s[4:7],s56 offen
s_add_u32 s56,s56,8192
buffer_load_dword v45,v4,s[4:7],s56 offen
s_add_u32 s56,s56,8192
buffer_load_dword v46,v4,s[4:7],s56 offen
s_add_u32 s56,s56,8192
buffer_load_dword v47,v4,s[4:7],s56 offen
s_waitcnt vmcnt(48)
v_perm_b32 v132,v49,v48,s61
v_perm_b32 v133,v51,v50,s61
v_perm_b32 v134,v53,v52,s61
v_perm_b32 v135,v55,v54,s61
v_perm_b32 v140,v49,v48,s62
v_perm_b32 v141,v51,v50,s62
v_perm_b32 v142,v53,v52,s62
v_perm_b32 v143,v55,v54,s62
s_xor_b32 s56,s63,2097152
s_add_u32 s56,s56,s58
buffer_load_dword v48,v4,s[4:7],s56 offen
s_add_u32 s56,s56,8192
buffer_load_dword v49,v4,s[4:7],s56 offen
s_add_u32 s56,s56,8192
buffer_load_dword v50,v4,s[4:7],s56 offen
s_add_u32 s56,s56,8192
buffer_load_dword v51,v4,s[4:7],s56 offen
s_add_u32 s56,s56,8192
buffer_load_dword v52,v4,s[4:7],s56 offen
s_add_u32 s56,s56,8192
buffer_load_dword v53,v4,s[4:7],s56 offen
s_add_u32 s56,s56,8192
buffer_load_dword v54,v4,s[4:7],s56 offen
s_add_u32 s56,s56,8192
buffer_load_dword v55,v4,s[4:7],s56 offen
s_waitcnt vmcnt(48)
v_perm_b32 v144,v57,v56,s61
v_perm_b32 v145,v59,v58,s61
v_perm_b32 v146,v61,v60,s61
v_perm_b32 v147,v63,v62,s61
v_perm_b32 v152,v57,v56,s62
v_perm_b32 v153,v59,v58,s62
v_perm_b32 v154,v61,v60,s62
v_perm_b32 v155,v63,v62,s62
s_xor_b32 s56,s63,2359296
s_add_u32 s56,s56,s58
buffer_load_dword v56,v4,s[4:7],s56 offen
s_add_u32 s56,s56,8192
buffer_load_dword v57,v4,s[4:7],s56 offen
s_add_u32 s56,s56,8192
buffer_load_dword v58,v4,s[4:7],s56 offen
s_add_u32 s56,s56,8192
buffer_load_dword v59,v4,s[4:7],s56 offen
s_add_u32 s56,s56,8192
buffer_load_dword v60,v4,s[4:7],s56 offen
s_add_u32 s56,s56,8192
buffer_load_dword v61,v4,s[4:7],s56 offen
s_add_u32 s56,s56,8192
buffer_load_dword v62,v4,s[4:7],s56 offen
s_add_u32 s56,s56,8192
buffer_load_dword v63,v4,s[4:7],s56 offen
s_waitcnt vmcnt(48)
v_perm_b32 v148,v65,v64,s61
v_perm_b32 v149,v67,v66,s61
v_perm_b32 v150,v69,v68,s61
v_perm_b32 v151,v71,v70,s61
v_perm_b32 v156,v65,v64,s62
v_perm_b32 v157,v67,v66,s62
v_perm_b32 v158,v69,v68,s62
v_perm_b32 v159,v71,v70,s62
s_xor_b32 s56,s63,2621440
s_add_u32 s56,s56,s58
buffer_load_dword v64,v4,s[4:7],s56 offen
s_add_u32 s56,s56,8192
buffer_load_dword v65,v4,s[4:7],s56 offen
s_add_u32 s56,s56,8192
buffer_load_dword v66,v4,s[4:7],s56 offen
s_add_u32 s56,s56,8192
buffer_load_dword v67,v4,s[4:7],s56 offen
s_add_u32 s56,s56,8192
buffer_load_dword v68,v4,s[4:7],s56 offen
s_add_u32 s56,s56,8192
buffer_load_dword v69,v4,s[4:7],s56 offen
s_add_u32 s56,s56,8192
buffer_load_dword v70,v4,s[4:7],s56 offen
s_add_u32 s56,s56,8192
buffer_load_dword v71,v4,s[4:7],s56 offen
s_waitcnt vmcnt(48)
v_perm_b32 v160,v73,v72,s61
v_perm_b32 v161,v75,v74,s61
v_perm_b32 v162,v77,v76,s61
v_perm_b32 v163,v79,v78,s61
v_perm_b32 v168,v73,v72,s62
v_perm_b32 v169,v75,v74,s62
v_perm_b32 v170,v77,v76,s62
v_perm_b32 v171,v79,v78,s62
s_xor_b32 s56,s63,2883584
s_add_u32 s56,s56,s58
buffer_load_dword v72,v4,s[4:7],s56 offen
s_add_u32 s56,s56,8192
buffer_load_dword v73,v4,s[4:7],s56 offen
s_add_u32 s56,s56,8192
buffer_load_dword v74,v4,s[4:7],s56 offen
s_add_u32 s56,s56,8192
buffer_load_dword v75,v4,s[4:7],s56 offen
s_add_u32 s56,s56,8192
buffer_load_dword v76,v4,s[4:7],s56 offen
s_add_u32 s56,s56,8192
buffer_load_dword v77,v4,s[4:7],s56 offen
s_add_u32 s56,s56,8192
buffer_load_dword v78,v4,s[4:7],s56 offen
s_add_u32 s56,s56,8192
buffer_load_dword v79,v4,s[4:7],s56 offen
s_waitcnt vmcnt(48)
v_perm_b32 v164,v25,v24,s61
v_perm_b32 v165,v27,v26,s61
v_perm_b32 v166,v29,v28,s61
v_perm_b32 v167,v31,v30,s61
v_perm_b32 v172,v25,v24,s62
v_perm_b32 v173,v27,v26,s62
v_perm_b32 v174,v29,v28,s62
v_perm_b32 v175,v31,v30,s62
s_xor_b32 s56,s63,3145728
s_add_u32 s56,s56,s58
buffer_load_dword v24,v4,s[4:7],s56 offen
s_add_u32 s56,s56,8192
buffer_load_dword v25,v4,s[4:7],s56 offen
s_add_u32 s56,s56,8192
buffer_load_dword v26,v4,s[4:7],s56 offen
s_add_u32 s56,s56,8192
buffer_load_dword v27,v4,s[4:7],s56 offen
s_add_u32 s56,s56,8192
buffer_load_dword v28,v4,s[4:7],s56 offen
s_add_u32 s56,s56,8192
buffer_load_dword v29,v4,s[4:7],s56 offen
s_add_u32 s56,s56,8192
buffer_load_dword v30,v4,s[4:7],s56 offen
s_add_u32 s56,s56,8192
buffer_load_dword v31,v4,s[4:7],s56 offen
s_waitcnt vmcnt(48)
v_perm_b32 v176,v33,v32,s61
v_perm_b32 v177,v35,v34,s61
v_perm_b32 v178,v37,v36,s61
v_perm_b32 v179,v39,v38,s61
v_perm_b32 v184,v33,v32,s62
v_perm_b32 v185,v35,v34,s62
v_perm_b32 v186,v37,v36,s62
v_perm_b32 v187,v39,v38,s62
s_xor_b32 s56,s63,3407872
s_add_u32 s56,s56,s58
buffer_load_dword v32,v4,s[4:7],s56 offen
s_add_u32 s56,s56,8192
buffer_load_dword v33,v4,s[4:7],s56 offen
s_add_u32 s56,s56,8192
buffer_load_dword v34,v4,s[4:7],s56 offen
s_add_u32 s56,s56,8192
buffer_load_dword v35,v4,s[4:7],s56 offen
s_add_u32 s56,s56,8192
buffer_load_dword v36,v4,s[4:7],s56 offen
s_add_u32 s56,s56,8192
buffer_load_dword v37,v4,s[4:7],s56 offen
s_add_u32 s56,s56,8192
buffer_load_dword v38,v4,s[4:7],s56 offen
s_add_u32 s56,s56,8192
buffer_load_dword v39,v4,s[4:7],s56 offen
s_waitcnt vmcnt(48)
v_perm_b32 v180,v41,v40,s61
v_perm_b32 v181,v43,v42,s61
v_perm_b32 v182,v45,v44,s61
v_perm_b32 v183,v47,v46,s61
v_perm_b32 v188,v41,v40,s62
v_perm_b32 v189,v43,v42,s62
v_perm_b32 v190,v45,v44,s62
v_perm_b32 v191,v47,v46,s62
s_xor_b32 s56,s63,3670016
s_add_u32 s56,s56,s58
buffer_load_dword v40,v4,s[4:7],s56 offen
s_add_u32 s56,s56,8192
buffer_load_dword v41,v4,s[4:7],s56 offen
s_add_u32 s56,s56,8192
buffer_load_dword v42,v4,s[4:7],s56 offen
s_add_u32 s56,s56,8192
buffer_load_dword v43,v4,s[4:7],s56 offen
s_add_u32 s56,s56,8192
buffer_load_dword v44,v4,s[4:7],s56 offen
s_add_u32 s56,s56,8192
buffer_load_dword v45,v4,s[4:7],s56 offen
s_add_u32 s56,s56,8192
buffer_load_dword v46,v4,s[4:7],s56 offen
s_add_u32 s56,s56,8192
buffer_load_dword v47,v4,s[4:7],s56 offen
s_waitcnt vmcnt(48)
v_perm_b32 v192,v49,v48,s61
v_perm_b32 v193,v51,v50,s61
v_perm_b32 v194,v53,v52,s61
v_perm_b32 v195,v55,v54,s61
v_perm_b32 v200,v49,v48,s62
v_perm_b32 v201,v51,v50,s62
v_perm_b32 v202,v53,v52,s62
v_perm_b32 v203,v55,v54,s62
s_xor_b32 s56,s63,3932160
s_add_u32 s56,s56,s58
buffer_load_dword v48,v4,s[4:7],s56 offen
s_add_u32 s56,s56,8192
buffer_load_dword v49,v4,s[4:7],s56 offen
s_add_u32 s56,s56,8192
buffer_load_dword v50,v4,s[4:7],s56 offen
s_add_u32 s56,s56,8192
buffer_load_dword v51,v4,s[4:7],s56 offen
s_add_u32 s56,s56,8192
buffer_load_dword v52,v4,s[4:7],s56 offen
s_add_u32 s56,s56,8192
buffer_load_dword v53,v4,s[4:7],s56 offen
s_add_u32 s56,s56,8192
buffer_load_dword v54,v4,s[4:7],s56 offen
s_add_u32 s56,s56,8192
buffer_load_dword v55,v4,s[4:7],s56 offen
s_waitcnt vmcnt(48)
v_perm_b32 v196,v57,v56,s61
v_perm_b32 v197,v59,v58,s61
v_perm_b32 v198,v61,v60,s61
v_perm_b32 v199,v63,v62,s61
v_perm_b32 v204,v57,v56,s62
v_perm_b32 v205,v59,v58,s62
v_perm_b32 v206,v61,v60,s62
v_perm_b32 v207,v63,v62,s62
s_mov_b32 s4,s20
s_mov_b32 s5,s21
s_mov_b32 s6,4194304
s_mov_b32 s7,0x20000
s_xor_b32 s56,s63,0
s_add_u32 s56,s56,s58
buffer_load_dword v56,v4,s[4:7],s56 offen
s_add_u32 s56,s56,8192
buffer_load_dword v57,v4,s[4:7],s56 offen
s_add_u32 s56,s56,8192
buffer_load_dword v58,v4,s[4:7],s56 offen
s_add_u32 s56,s56,8192
buffer_load_dword v59,v4,s[4:7],s56 offen
s_add_u32 s56,s56,8192
buffer_load_dword v60,v4,s[4:7],s56 offen
s_add_u32 s56,s56,8192
buffer_load_dword v61,v4,s[4:7],s56 offen
s_add_u32 s56,s56,8192
buffer_load_dword v62,v4,s[4:7],s56 offen
s_add_u32 s56,s56,8192
buffer_load_dword v63,v4,s[4:7],s56 offen
s_waitcnt vmcnt(48)
v_perm_b32 v208,v65,v64,s61
v_perm_b32 v209,v67,v66,s61
v_perm_b32 v210,v69,v68,s61
v_perm_b32 v211,v71,v70,s61
v_perm_b32 v216,v65,v64,s62
v_perm_b32 v217,v67,v66,s62
v_perm_b32 v218,v69,v68,s62
v_perm_b32 v219,v71,v70,s62
s_xor_b32 s56,s63,262144
s_add_u32 s56,s56,s58
buffer_load_dword v64,v4,s[4:7],s56 offen
s_add_u32 s56,s56,8192
buffer_load_dword v65,v4,s[4:7],s56 offen
s_add_u32 s56,s56,8192
buffer_load_dword v66,v4,s[4:7],s56 offen
s_add_u32 s56,s56,8192
buffer_load_dword v67,v4,s[4:7],s56 offen
s_add_u32 s56,s56,8192
buffer_load_dword v68,v4,s[4:7],s56 offen
s_add_u32 s56,s56,8192
buffer_load_dword v69,v4,s[4:7],s56 offen
s_add_u32 s56,s56,8192
buffer_load_dword v70,v4,s[4:7],s56 offen
s_add_u32 s56,s56,8192
buffer_load_dword v71,v4,s[4:7],s56 offen
s_waitcnt vmcnt(48)
v_perm_b32 v212,v73,v72,s61
v_perm_b32 v213,v75,v74,s61
v_perm_b32 v214,v77,v76,s61
v_perm_b32 v215,v79,v78,s61
v_perm_b32 v220,v73,v72,s62
v_perm_b32 v221,v75,v74,s62
v_perm_b32 v222,v77,v76,s62
v_perm_b32 v223,v79,v78,s62
s_xor_b32 s56,s63,524288
s_add_u32 s56,s56,s58
buffer_load_dword v72,v4,s[4:7],s56 offen
s_add_u32 s56,s56,8192
buffer_load_dword v73,v4,s[4:7],s56 offen
s_add_u32 s56,s56,8192
buffer_load_dword v74,v4,s[4:7],s56 offen
s_add_u32 s56,s56,8192
buffer_load_dword v75,v4,s[4:7],s56 offen
s_add_u32 s56,s56,8192
buffer_load_dword v76,v4,s[4:7],s56 offen
s_add_u32 s56,s56,8192
buffer_load_dword v77,v4,s[4:7],s56 offen
s_add_u32 s56,s56,8192
buffer_load_dword v78,v4,s[4:7],s56 offen
s_add_u32 s56,s56,8192
buffer_load_dword v79,v4,s[4:7],s56 offen
s_waitcnt vmcnt(48)
v_perm_b32 v224,v25,v24,s61
v_perm_b32 v225,v27,v26,s61
v_perm_b32 v226,v29,v28,s61
v_perm_b32 v227,v31,v30,s61
v_perm_b32 v232,v25,v24,s62
v_perm_b32 v233,v27,v26,s62
v_perm_b32 v234,v29,v28,s62
v_perm_b32 v235,v31,v30,s62
s_xor_b32 s56,s63,786432
s_add_u32 s56,s56,s58
buffer_load_dword v24,v4,s[4:7],s56 offen
s_add_u32 s56,s56,8192
buffer_load_dword v25,v4,s[4:7],s56 offen
s_add_u32 s56,s56,8192
buffer_load_dword v26,v4,s[4:7],s56 offen
s_add_u32 s56,s56,8192
buffer_load_dword v27,v4,s[4:7],s56 offen
s_add_u32 s56,s56,8192
buffer_load_dword v28,v4,s[4:7],s56 offen
s_add_u32 s56,s56,8192
buffer_load_dword v29,v4,s[4:7],s56 offen
s_add_u32 s56,s56,8192
buffer_load_dword v30,v4,s[4:7],s56 offen
s_add_u32 s56,s56,8192
buffer_load_dword v31,v4,s[4:7],s56 offen
s_waitcnt vmcnt(48)
v_perm_b32 v228,v33,v32,s61
v_perm_b32 v229,v35,v34,s61
v_perm_b32 v230,v37,v36,s61
v_perm_b32 v231,v39,v38,s61
v_perm_b32 v236,v33,v32,s62
v_perm_b32 v237,v35,v34,s62
v_perm_b32 v238,v37,v36,s62
v_perm_b32 v239,v39,v38,s62
s_xor_b32 s56,s63,1048576
s_add_u32 s56,s56,s58
buffer_load_dword v32,v4,s[4:7],s56 offen
s_add_u32 s56,s56,8192
buffer_load_dword v33,v4,s[4:7],s56 offen
s_add_u32 s56,s56,8192
buffer_load_dword v34,v4,s[4:7],s56 offen
s_add_u32 s56,s56,8192
buffer_load_dword v35,v4,s[4:7],s56 offen
s_add_u32 s56,s56,8192
buffer_load_dword v36,v4,s[4:7],s56 offen
s_add_u32 s56,s56,8192
buffer_load_dword v37,v4,s[4:7],s56 offen
s_add_u32 s56,s56,8192
buffer_load_dword v38,v4,s[4:7],s56 offen
s_add_u32 s56,s56,8192
buffer_load_dword v39,v4,s[4:7],s56 offen
s_waitcnt vmcnt(48)
v_perm_b32 v240,v41,v40,s61
v_perm_b32 v241,v43,v42,s61
v_perm_b32 v242,v45,v44,s61
v_perm_b32 v243,v47,v46,s61
v_perm_b32 v248,v41,v40,s62
v_perm_b32 v249,v43,v42,s62
v_perm_b32 v250,v45,v44,s62
v_perm_b32 v251,v47,v46,s62
s_xor_b32 s56,s63,1310720
s_add_u32 s56,s56,s58
buffer_load_dword v40,v4,s[4:7],s56 offen
s_add_u32 s56,s56,8192
buffer_load_dword v41,v4,s[4:7],s56 offen
s_add_u32 s56,s56,8192
buffer_load_dword v42,v4,s[4:7],s56 offen
s_add_u32 s56,s56,8192
buffer_load_dword v43,v4,s[4:7],s56 offen
s_add_u32 s56,s56,8192
buffer_load_dword v44,v4,s[4:7],s56 offen
s_add_u32 s56,s56,8192
buffer_load_dword v45,v4,s[4:7],s56 offen
s_add_u32 s56,s56,8192
buffer_load_dword v46,v4,s[4:7],s56 offen
s_add_u32 s56,s56,8192
buffer_load_dword v47,v4,s[4:7],s56 offen
s_waitcnt vmcnt(48)
v_perm_b32 v244,v49,v48,s61
v_perm_b32 v245,v51,v50,s61
v_perm_b32 v246,v53,v52,s61
v_perm_b32 v247,v55,v54,s61
v_perm_b32 v252,v49,v48,s62
v_perm_b32 v253,v51,v50,s62
v_perm_b32 v254,v53,v52,s62
v_perm_b32 v255,v55,v54,s62
s_xor_b32 s56,s63,1572864
s_add_u32 s56,s56,s58
buffer_load_dword v48,v4,s[4:7],s56 offen
s_add_u32 s56,s56,8192
buffer_load_dword v49,v4,s[4:7],s56 offen
s_add_u32 s56,s56,8192
buffer_load_dword v50,v4,s[4:7],s56 offen
s_add_u32 s56,s56,8192
buffer_load_dword v51,v4,s[4:7],s56 offen
s_add_u32 s56,s56,8192
buffer_load_dword v52,v4,s[4:7],s56 offen
s_add_u32 s56,s56,8192
buffer_load_dword v53,v4,s[4:7],s56 offen
s_add_u32 s56,s56,8192
buffer_load_dword v54,v4,s[4:7],s56 offen
s_add_u32 s56,s56,8192
buffer_load_dword v55,v4,s[4:7],s56 offen
s_waitcnt vmcnt(48)
v_perm_b32 v80,v57,v56,s61
v_perm_b32 v81,v59,v58,s61
v_perm_b32 v82,v61,v60,s61
v_perm_b32 v83,v63,v62,s61
v_perm_b32 v84,v57,v56,s62
v_perm_b32 v85,v59,v58,s62
v_perm_b32 v86,v61,v60,s62
v_perm_b32 v87,v63,v62,s62
v_accvgpr_write_b32 a0,v80
v_accvgpr_write_b32 a1,v81
v_accvgpr_write_b32 a2,v82
v_accvgpr_write_b32 a3,v83
v_accvgpr_write_b32 a8,v84
v_accvgpr_write_b32 a9,v85
v_accvgpr_write_b32 a10,v86
v_accvgpr_write_b32 a11,v87
s_xor_b32 s56,s63,1835008
s_add_u32 s56,s56,s58
buffer_load_dword v56,v4,s[4:7],s56 offen
s_add_u32 s56,s56,8192
buffer_load_dword v57,v4,s[4:7],s56 offen
s_add_u32 s56,s56,8192
buffer_load_dword v58,v4,s[4:7],s56 offen
s_add_u32 s56,s56,8192
buffer_load_dword v59,v4,s[4:7],s56 offen
s_add_u32 s56,s56,8192
buffer_load_dword v60,v4,s[4:7],s56 offen
s_add_u32 s56,s56,8192
buffer_load_dword v61,v4,s[4:7],s56 offen
s_add_u32 s56,s56,8192
buffer_load_dword v62,v4,s[4:7],s56 offen
s_add_u32 s56,s56,8192
buffer_load_dword v63,v4,s[4:7],s56 offen
s_waitcnt vmcnt(48)
v_perm_b32 v80,v65,v64,s61
v_perm_b32 v81,v67,v66,s61
v_perm_b32 v82,v69,v68,s61
v_perm_b32 v83,v71,v70,s61
v_perm_b32 v84,v65,v64,s62
v_perm_b32 v85,v67,v66,s62
v_perm_b32 v86,v69,v68,s62
v_perm_b32 v87,v71,v70,s62
v_accvgpr_write_b32 a4,v80
v_accvgpr_write_b32 a5,v81
v_accvgpr_write_b32 a6,v82
v_accvgpr_write_b32 a7,v83
v_accvgpr_write_b32 a12,v84
v_accvgpr_write_b32 a13,v85
v_accvgpr_write_b32 a14,v86
v_accvgpr_write_b32 a15,v87
s_xor_b32 s56,s63,2097152
s_add_u32 s56,s56,s58
buffer_load_dword v64,v4,s[4:7],s56 offen
s_add_u32 s56,s56,8192
buffer_load_dword v65,v4,s[4:7],s56 offen
s_add_u32 s56,s56,8192
buffer_load_dword v66,v4,s[4:7],s56 offen
s_add_u32 s56,s56,8192
buffer_load_dword v67,v4,s[4:7],s56 offen
s_add_u32 s56,s56,8192
buffer_load_dword v68,v4,s[4:7],s56 offen
s_add_u32 s56,s56,8192
buffer_load_dword v69,v4,s[4:7],s56 offen
s_add_u32 s56,s56,8192
buffer_load_dword v70,v4,s[4:7],s56 offen
s_add_u32 s56,s56,8192
buffer_load_dword v71,v4,s[4:7],s56 offen
s_waitcnt vmcnt(48)
v_perm_b32 v80,v73,v72,s61
v_perm_b32 v81,v75,v74,s61
v_perm_b32 v82,v77,v76,s61
v_perm_b32 v83,v79,v78,s61
v_perm_b32 v84,v73,v72,s62
v_perm_b32 v85,v75,v74,s62
v_perm_b32 v86,v77,v76,s62
v_perm_b32 v87,v79,v78,s62
v_accvgpr_write_b32 a16,v80
v_accvgpr_write_b32 a17,v81
v_accvgpr_write_b32 a18,v82
v_accvgpr_write_b32 a19,v83
v_accvgpr_write_b32 a24,v84
v_accvgpr_write_b32 a25,v85
v_accvgpr_write_b32 a26,v86
v_accvgpr_write_b32 a27,v87
s_xor_b32 s56,s63,2359296
s_add_u32 s56,s56,s58
buffer_load_dword v72,v4,s[4:7],s56 offen
s_add_u32 s56,s56,8192
buffer_load_dword v73,v4,s[4:7],s56 offen
s_add_u32 s56,s56,8192
buffer_load_dword v74,v4,s[4:7],s56 offen
s_add_u32 s56,s56,8192
buffer_load_dword v75,v4,s[4:7],s56 offen
s_add_u32 s56,s56,8192
buffer_load_dword v76,v4,s[4:7],s56 offen
s_add_u32 s56,s56,8192
buffer_load_dword v77,v4,s[4:7],s56 offen
s_add_u32 s56,s56,8192
buffer_load_dword v78,v4,s[4:7],s56 offen
s_add_u32 s56,s56,8192
buffer_load_dword v79,v4,s[4:7],s56 offen
s_waitcnt vmcnt(48)
v_perm_b32 v80,v25,v24,s61
v_perm_b32 v81,v27,v26,s61
v_perm_b32 v82,v29,v28,s61
v_perm_b32 v83,v31,v30,s61
v_perm_b32 v84,v25,v24,s62
v_perm_b32 v85,v27,v26,s62
v_perm_b32 v86,v29,v28,s62
v_perm_b32 v87,v31,v30,s62
v_accvgpr_write_b32 a20,v80
v_accvgpr_write_b32 a21,v81
v_accvgpr_write_b32 a22,v82
v_accvgpr_write_b32 a23,v83
v_accvgpr_write_b32 a28,v84
v_accvgpr_write_b32 a29,v85
v_accvgpr_write_b32 a30,v86
v_accvgpr_write_b32 a31,v87
s_xor_b32 s56,s63,2621440
s_add_u32 s56,s56,s58
buffer_load_dword v24,v4,s[4:7],s56 offen
s_add_u32 s56,s56,8192
buffer_load_dword v25,v4,s[4:7],s56 offen
s_add_u32 s56,s56,8192
buffer_load_dword v26,v4,s[4:7],s56 offen
s_add_u32 s56,s56,8192
buffer_load_dword v27,v4,s[4:7],s56 offen
s_add_u32 s56,s56,8192
buffer_load_dword v28,v4,s[4:7],s56 offen
s_add_u32 s56,s56,8192
buffer_load_dword v29,v4,s[4:7],s56 offen
s_add_u32 s56,s56,8192
buffer_load_dword v30,v4,s[4:7],s56 offen
s_add_u32 s56,s56,8192
buffer_load_dword v31,v4,s[4:7],s56 offen
s_waitcnt vmcnt(48)
v_perm_b32 v80,v33,v32,s61
v_perm_b32 v81,v35,v34,s61
v_perm_b32 v82,v37,v36,s61
v_perm_b32 v83,v39,v38,s61
v_perm_b32 v84,v33,v32,s62
v_perm_b32 v85,v35,v34,s62
v_perm_b32 v86,v37,v36,s62
v_perm_b32 v87,v39,v38,s62
v_accvgpr_write_b32 a32,v80
v_accvgpr_write_b32 a33,v81
v_accvgpr_write_b32 a34,v82
v_accvgpr_write_b32 a35,v83
v_accvgpr_write_b32 a40,v84
v_accvgpr_write_b32 a41,v85
v_accvgpr_write_b32 a42,v86
v_accvgpr_write_b32 a43,v87
s_xor_b32 s56,s63,2883584
s_add_u32 s56,s56,s58
buffer_load_dword v32,v4,s[4:7],s56 offen
s_add_u32 s56,s56,8192
buffer_load_dword v33,v4,s[4:7],s56 offen
s_add_u32 s56,s56,8192
buffer_load_dword v34,v4,s[4:7],s56 offen
s_add_u32 s56,s56,8192
buffer_load_dword v35,v4,s[4:7],s56 offen
s_add_u32 s56,s56,8192
buffer_load_dword v36,v4,s[4:7],s56 offen
s_add_u32 s56,s56,8192
buffer_load_dword v37,v4,s[4:7],s56 offen
s_add_u32 s56,s56,8192
buffer_load_dword v38,v4,s[4:7],s56 offen
s_add_u32 s56,s56,8192
buffer_load_dword v39,v4,s[4:7],s56 offen
s_waitcnt vmcnt(48)
v_perm_b32 v80,v41,v40,s61
v_perm_b32 v81,v43,v42,s61
v_perm_b32 v82,v45,v44,s61
v_perm_b32 v83,v47,v46,s61
v_perm_b32 v84,v41,v40,s62
v_perm_b32 v85,v43,v42,s62
v_perm_b32 v86,v45,v44,s62
v_perm_b32 v87,v47,v46,s62
v_accvgpr_write_b32 a36,v80
v_accvgpr_write_b32 a37,v81
v_accvgpr_write_b32 a38,v82
v_accvgpr_write_b32 a39,v83
v_accvgpr_write_b32 a44,v84
v_accvgpr_write_b32 a45,v85
v_accvgpr_write_b32 a46,v86
v_accvgpr_write_b32 a47,v87
s_xor_b32 s56,s63,3145728
s_add_u32 s56,s56,s58
buffer_load_dword v40,v4,s[4:7],s56 offen
s_add_u32 s56,s56,8192
buffer_load_dword v41,v4,s[4:7],s56 offen
s_add_u32 s56,s56,8192
buffer_load_dword v42,v4,s[4:7],s56 offen
s_add_u32 s56,s56,8192
buffer_load_dword v43,v4,s[4:7],s56 offen
s_add_u32 s56,s56,8192
buffer_load_dword v44,v4,s[4:7],s56 offen
s_add_u32 s56,s56,8192
buffer_load_dword v45,v4,s[4:7],s56 offen
s_add_u32 s56,s56,8192
buffer_load_dword v46,v4,s[4:7],s56 offen
s_add_u32 s56,s56,8192
buffer_load_dword v47,v4,s[4:7],s56 offen
s_waitcnt vmcnt(48)
v_perm_b32 v80,v49,v48,s61
v_perm_b32 v81,v51,v50,s61
v_perm_b32 v82,v53,v52,s61
v_perm_b32 v83,v55,v54,s61
v_perm_b32 v84,v49,v48,s62
v_perm_b32 v85,v51,v50,s62
v_perm_b32 v86,v53,v52,s62
v_perm_b32 v87,v55,v54,s62
v_accvgpr_write_b32 a48,v80
v_accvgpr_write_b32 a49,v81
v_accvgpr_write_b32 a50,v82
v_accvgpr_write_b32 a51,v83
v_accvgpr_write_b32 a56,v84
v_accvgpr_write_b32 a57,v85
v_accvgpr_write_b32 a58,v86
v_accvgpr_write_b32 a59,v87
s_xor_b32 s56,s63,3407872
s_add_u32 s56,s56,s58
buffer_load_dword v48,v4,s[4:7],s56 offen
s_add_u32 s56,s56,8192
buffer_load_dword v49,v4,s[4:7],s56 offen
s_add_u32 s56,s56,8192
buffer_load_dword v50,v4,s[4:7],s56 offen
s_add_u32 s56,s56,8192
buffer_load_dword v51,v4,s[4:7],s56 offen
s_add_u32 s56,s56,8192
buffer_load_dword v52,v4,s[4:7],s56 offen
s_add_u32 s56,s56,8192
buffer_load_dword v53,v4,s[4:7],s56 offen
s_add_u32 s56,s56,8192
buffer_load_dword v54,v4,s[4:7],s56 offen
s_add_u32 s56,s56,8192
buffer_load_dword v55,v4,s[4:7],s56 offen
s_waitcnt vmcnt(48)
v_perm_b32 v80,v57,v56,s61
v_perm_b32 v81,v59,v58,s61
v_perm_b32 v82,v61,v60,s61
v_perm_b32 v83,v63,v62,s61
v_perm_b32 v84,v57,v56,s62
v_perm_b32 v85,v59,v58,s62
v_perm_b32 v86,v61,v60,s62
v_perm_b32 v87,v63,v62,s62
v_accvgpr_write_b32 a52,v80
v_accvgpr_write_b32 a53,v81
v_accvgpr_write_b32 a54,v82
v_accvgpr_write_b32 a55,v83
v_accvgpr_write_b32 a60,v84
v_accvgpr_write_b32 a61,v85
v_accvgpr_write_b32 a62,v86
v_accvgpr_write_b32 a63,v87
s_xor_b32 s56,s63,3670016
s_add_u32 s56,s56,s58
buffer_load_dword v56,v4,s[4:7],s56 offen
s_add_u32 s56,s56,8192
buffer_load_dword v57,v4,s[4:7],s56 offen
s_add_u32 s56,s56,8192
buffer_load_dword v58,v4,s[4:7],s56 offen
s_add_u32 s56,s56,8192
buffer_load_dword v59,v4,s[4:7],s56 offen
s_add_u32 s56,s56,8192
buffer_load_dword v60,v4,s[4:7],s56 offen
s_add_u32 s56,s56,8192
buffer_load_dword v61,v4,s[4:7],s56 offen
s_add_u32 s56,s56,8192
buffer_load_dword v62,v4,s[4:7],s56 offen
s_add_u32 s56,s56,8192
buffer_load_dword v63,v4,s[4:7],s56 offen
s_waitcnt vmcnt(48)
v_perm_b32 v80,v65,v64,s61
v_perm_b32 v81,v67,v66,s61
v_perm_b32 v82,v69,v68,s61
v_perm_b32 v83,v71,v70,s61
v_perm_b32 v84,v65,v64,s62
v_perm_b32 v85,v67,v66,s62
v_perm_b32 v86,v69,v68,s62
v_perm_b32 v87,v71,v70,s62
v_accvgpr_write_b32 a64,v80
v_accvgpr_write_b32 a65,v81
v_accvgpr_write_b32 a66,v82
v_accvgpr_write_b32 a67,v83
v_accvgpr_write_b32 a72,v84
v_accvgpr_write_b32 a73,v85
v_accvgpr_write_b32 a74,v86
v_accvgpr_write_b32 a75,v87
s_xor_b32 s56,s63,3932160
s_add_u32 s56,s56,s58
buffer_load_dword v64,v4,s[4:7],s56 offen
s_add_u32 s56,s56,8192
buffer_load_dword v65,v4,s[4:7],s56 offen
s_add_u32 s56,s56,8192
buffer_load_dword v66,v4,s[4:7],s56 offen
s_add_u32 s56,s56,8192
buffer_load_dword v67,v4,s[4:7],s56 offen
s_add_u32 s56,s56,8192
buffer_load_dword v68,v4,s[4:7],s56 offen
s_add_u32 s56,s56,8192
buffer_load_dword v69,v4,s[4:7],s56 offen
s_add_u32 s56,s56,8192
buffer_load_dword v70,v4,s[4:7],s56 offen
s_add_u32 s56,s56,8192
buffer_load_dword v71,v4,s[4:7],s56 offen
s_waitcnt vmcnt(48)
v_perm_b32 v80,v73,v72,s61
v_perm_b32 v81,v75,v74,s61
v_perm_b32 v82,v77,v76,s61
v_perm_b32 v83,v79,v78,s61
v_perm_b32 v84,v73,v72,s62
v_perm_b32 v85,v75,v74,s62
v_perm_b32 v86,v77,v76,s62
v_perm_b32 v87,v79,v78,s62
v_accvgpr_write_b32 a68,v80
v_accvgpr_write_b32 a69,v81
v_accvgpr_write_b32 a70,v82
v_accvgpr_write_b32 a71,v83
v_accvgpr_write_b32 a76,v84
v_accvgpr_write_b32 a77,v85
v_accvgpr_write_b32 a78,v86
v_accvgpr_write_b32 a79,v87
s_waitcnt vmcnt(40)
v_perm_b32 v80,v25,v24,s61
v_perm_b32 v81,v27,v26,s61
v_perm_b32 v82,v29,v28,s61
v_perm_b32 v83,v31,v30,s61
v_perm_b32 v84,v25,v24,s62
v_perm_b32 v85,v27,v26,s62
v_perm_b32 v86,v29,v28,s62
v_perm_b32 v87,v31,v30,s62
v_accvgpr_write_b32 a80,v80
v_accvgpr_write_b32 a81,v81
v_accvgpr_write_b32 a82,v82
v_accvgpr_write_b32 a83,v83
v_accvgpr_write_b32 a88,v84
v_accvgpr_write_b32 a89,v85
v_accvgpr_write_b32 a90,v86
v_accvgpr_write_b32 a91,v87
s_waitcnt vmcnt(32)
v_perm_b32 v80,v33,v32,s61
v_perm_b32 v81,v35,v34,s61
v_perm_b32 v82,v37,v36,s61
v_perm_b32 v83,v39,v38,s61
v_perm_b32 v84,v33,v32,s62
v_perm_b32 v85,v35,v34,s62
v_perm_b32 v86,v37,v36,s62
v_perm_b32 v87,v39,v38,s62
v_accvgpr_write_b32 a84,v80
v_accvgpr_write_b32 a85,v81
v_accvgpr_write_b32 a86,v82
v_accvgpr_write_b32 a87,v83
v_accvgpr_write_b32 a92,v84
v_accvgpr_write_b32 a93,v85
v_accvgpr_write_b32 a94,v86
v_accvgpr_write_b32 a95,v87
s_waitcnt vmcnt(24)
v_perm_b32 v80,v41,v40,s61
v_perm_b32 v81,v43,v42,s61
v_perm_b32 v82,v45,v44,s61
v_perm_b32 v83,v47,v46,s61
v_perm_b32 v84,v41,v40,s62
v_perm_b32 v85,v43,v42,s62
v_perm_b32 v86,v45,v44,s62
v_perm_b32 v87,v47,v46,s62
v_accvgpr_write_b32 a96,v80
v_accvgpr_write_b32 a97,v81
v_accvgpr_write_b32 a98,v82
v_accvgpr_write_b32 a99,v83
v_accvgpr_write_b32 a104,v84
v_accvgpr_write_b32 a105,v85
v_accvgpr_write_b32 a106,v86
v_accvgpr_write_b32 a107,v87
s_waitcnt vmcnt(16)
v_perm_b32 v80,v49,v48,s61
v_perm_b32 v81,v51,v50,s61
v_perm_b32 v82,v53,v52,s61
v_perm_b32 v83,v55,v54,s61
v_perm_b32 v84,v49,v48,s62
v_perm_b32 v85,v51,v50,s62
v_perm_b32 v86,v53,v52,s62
v_perm_b32 v87,v55,v54,s62
v_accvgpr_write_b32 a100,v80
v_accvgpr_write_b32 a101,v81
v_accvgpr_write_b32 a102,v82
v_accvgpr_write_b32 a103,v83
v_accvgpr_write_b32 a108,v84
v_accvgpr_write_b32 a109,v85
v_accvgpr_write_b32 a110,v86
v_accvgpr_write_b32 a111,v87
s_waitcnt vmcnt(8)
v_perm_b32 v80,v57,v56,s61
v_perm_b32 v81,v59,v58,s61
v_perm_b32 v82,v61,v60,s61
v_perm_b32 v83,v63,v62,s61
v_perm_b32 v84,v57,v56,s62
v_perm_b32 v85,v59,v58,s62
v_perm_b32 v86,v61,v60,s62
v_perm_b32 v87,v63,v62,s62
v_accvgpr_write_b32 a112,v80
v_accvgpr_write_b32 a113,v81
v_accvgpr_write_b32 a114,v82
v_accvgpr_write_b32 a115,v83
v_accvgpr_write_b32 a120,v84
v_accvgpr_write_b32 a121,v85
v_accvgpr_write_b32 a122,v86
v_accvgpr_write_b32 a123,v87
s_waitcnt vmcnt(0)
v_perm_b32 v80,v65,v64,s61
v_perm_b32 v81,v67,v66,s61
v_perm_b32 v82,v69,v68,s61
v_perm_b32 v83,v71,v70,s61
v_perm_b32 v84,v65,v64,s62
v_perm_b32 v85,v67,v66,s62
v_perm_b32 v86,v69,v68,s62
v_perm_b32 v87,v71,v70,s62
v_accvgpr_write_b32 a116,v80
v_accvgpr_write_b32 a117,v81
v_accvgpr_write_b32 a118,v82
v_accvgpr_write_b32 a119,v83
v_accvgpr_write_b32 a124,v84
v_accvgpr_write_b32 a125,v85
v_accvgpr_write_b32 a126,v86
v_accvgpr_write_b32 a127,v87
s_cmp_lt_u32 s48,3
s_cbranch_scc1 L_rch_4
s_cmp_eq_u32 s48,3
s_cbranch_scc1 L_rm_5
v_mov_b32 v123,159744
s_cmp_lg_u32 s46,0
s_cbranch_scc1 L_gbd_12
v_mov_b32 v124,128
L_gb_11:
buffer_load_dword v125,v124,s[12:15],0 offen sc1
s_waitcnt vmcnt(0)
v_readfirstlane_b32 s56,v125
ds_write_b32 v123,v125
s_bitcmp1_b32 s56,8
s_cbranch_scc1 L_gbd_12
s_sleep 4
s_sub_u32 s49,s49,1
s_cmp_gt_i32 s49,0
s_cbranch_scc1 L_gb_11
s_branch L_abort
L_gbd_12:
s_waitcnt lgkmcnt(0)
s_barrier
ds_read_b32 v125,v123
s_waitcnt lgkmcnt(0)
v_readfirstlane_b32 s56,v125
s_barrier
s_lshr_b32 s56,s56,16
s_andn2_b32 s56,s56,s3
s_cbranch_scc1 L_spread
v_and_b32 v120,15,v1
v_lshrrev_b32 v121,4,v1
v_mov_b32 v17,1
s_lshl_b32 s56,s46,15
v_add_u32 v18,s56,v0
s_lshl_b32 s56,s46,2
v_add_u32 v125,s56,v121
v_xor_b32 v126,v125,v120
v_lshlrev_b32 v126,4,v126
v_lshl_add_u32 v20,v125,10,v126
v_add_u32 v125,0,v121
v_xor_b32 v125,v125,v120
v_lshlrev_b32 v125,4,v125
v_lshl_add_u32 v125,v120,8,v125
v_add_u32 v4,65536,v125
v_add_u32 v125,4,v121
v_xor_b32 v125,v125,v120
v_lshlrev_b32 v125,4,v125
v_lshl_add_u32 v125,v120,8,v125
v_add_u32 v5,65536,v125
v_add_u32 v125,8,v121
v_xor_b32 v125,v125,v120
v_lshlrev_b32 v125,4,v125
v_lshl_add_u32 v125,v120,8,v125
v_add_u32 v6,65536,v125
v_add_u32 v125,12,v121
v_xor_b32 v125,v125,v120
v_lshlrev_b32 v125,4,v125
v_lshl_add_u32 v125,v120,8,v125
v_add_u32 v7,65536,v125
v_lshlrev_b32 v21,5,v120
v_and_b32 v125,1,v121
v_lshl_add_u32 v21,v125,4,v21
s_lshl_b32 s56,s46,9
v_lshrrev_b32 v125,1,v121
v_lshl_add_u32 v21,v125,11,v21
s_add_u32 s56,s56,155648
v_add_u32 v21,s56,v21
v_lshlrev_b32 v22,4,v120
v_lshl_add_u32 v22,v121,10,v22
s_lshl_b32 s56,s46,8
v_add_u32 v22,s56,v22
s_sub_u32 s54,s48,4
s_cmp_eq_u32 s54,0
s_mov_b32 s72,2147494570
s_mov_b32 s73,613566756
s_cmov_b32 s72,1073747285
s_cmov_b32 s73,2454267026
s_mov_b32 s70,0x80000000
s_mov_b32 s53,7
s_mov_b32 s74,s50
s_xor_b32 s75,s74,32768
v_and_b32 v23,31,v1
v_lshlrev_b32 v23,2,v23
v_mov_b32 v19,s50
v_mov_b32 v16,0
s_ff1_i32_b64 s55,s[72:73]
s_bitset0_b64 s[72:73],s55
s_min_u32 s55,s55,127
s_lshl_b32 s68,s55,15
s_add_u32 s68,s68,0
s_add_u32 s69,s68,16384
s_add_u32 m0,s75,65536
s_nop 0
buffer_load_dwordx4 v20,s[8:11],s68 offen offset:0 sc1 lds
s_add_u32 m0,s75,69632
s_nop 0
buffer_load_dwordx4 v20,s[8:11],s69 offen offset:0 sc1 lds
s_add_u32 m0,s75,73472
s_nop 0
buffer_load_dwordx4 v20,s[8:11],s68 offen offset:256 sc1 lds
s_add_u32 m0,s75,77568
s_nop 0
buffer_load_dwordx4 v20,s[8:11],s69 offen offset:256 sc1 lds
s_add_u32 m0,s75,81408
s_nop 0
buffer_load_dwordx4 v20,s[8:11],s68 offen offset:512 sc1 lds
s_add_u32 m0,s75,85504
s_nop 0
buffer_load_dwordx4 v20,s[8:11],s69 offen offset:512 sc1 lds
s_add_u32 m0,s75,89344
s_nop 0
buffer_load_dwordx4 v20,s[8:11],s68 offen offset:768 sc1 lds
s_add_u32 m0,s75,93440
s_nop 0
buffer_load_dwordx4 v20,s[8:11],s69 offen offset:768 sc1 lds
s_waitcnt vmcnt(0)
s_barrier
L_p_13:
s_mov_b32 s75,s74
s_xor_b32 s74,s74,32768
v_xor_b32 v4,32768,v4
v_xor_b32 v5,32768,v5
v_xor_b32 v6,32768,v6
v_xor_b32 v7,32768,v7
ds_read_b128 v[104:107],v4 offset:0
ds_read_b128 v[108:111],v4 offset:4096
ds_read_b128 v[112:115],v5 offset:0
ds_read_b128 v[116:119],v5 offset:4096
s_waitcnt lgkmcnt(2)
v_mfma_f32_16x16x32_bf16 v[24:27],a[128:131],v[104:107],0
ds_read_b128 v[120:123],v6 offset:0
v_mfma_f32_16x16x32_bf16 v[40:43],v[104:107],v[128:131],0
s_mov_b32 s51,s55
v_mfma_f32_16x16x32_bf16 v[28:31],a[128:131],v[108:111],0
ds_read_b128 v[124:127],v6 offset:4096
v_mfma_f32_16x16x32_bf16 v[44:47],v[108:111],v[128:131],0
s_mov_b32 s77,0
v_mfma_f32_16x16x32_bf16 v[32:35],a[136:139],v[104:107],0
s_sub_u32 s53,s53,1
v_mfma_f32_16x16x32_bf16 v[48:51],v[104:107],v[136:139],0
s_ff1_i32_b64 s55,s[72:73]
v_mfma_f32_16x16x32_bf16 v[36:39],a[136:139],v[108:111],0
s_bitset0_b64 s[72:73],s55
v_mfma_f32_16x16x32_bf16 v[52:55],v[108:111],v[136:139],0
s_min_u32 s55,s55,127
s_waitcnt lgkmcnt(2)
v_mfma_f32_16x16x32_bf16 v[24:27],a[132:135],v[112:115],v[24:27]
ds_read_b128 v[104:107],v7 offset:0
v_mfma_f32_16x16x32_bf16 v[40:43],v[112:115],v[132:135],v[40:43]
s_lshl_b32 s58,s51,5
v_mfma_f32_16x16x32_bf16 v[28:31],a[132:135],v[116:119],v[28:31]
ds_read_b128 v[108:111],v7 offset:4096
v_mfma_f32_16x16x32_bf16 v[44:47],v[116:119],v[132:135],v[44:47]
s_add_u32 s58,s58,s47
v_mfma_f32_16x16x32_bf16 v[32:35],a[140:143],v[112:115],v[32:35]
s_mul_i32 s58,s58,24576
v_mfma_f32_16x16x32_bf16 v[48:51],v[112:115],v[140:143],v[48:51]
s_add_u32 s58,s58,100663296
v_mfma_f32_16x16x32_bf16 v[36:39],a[140:143],v[116:119],v[36:39]
s_add_u32 s61,s58,s50
v_mfma_f32_16x16x32_bf16 v[52:55],v[116:119],v[140:143],v[52:55]
s_add_u32 s62,s61,4096
s_waitcnt lgkmcnt(2)
v_mfma_f32_16x16x32_bf16 v[24:27],a[144:147],v[120:123],v[24:27]
ds_read_b128 v[112:115],v4 offset:8192
v_mfma_f32_16x16x32_bf16 v[40:43],v[120:123],v[144:147],v[40:43]
s_add_u32 s63,s61,16384
v_mfma_f32_16x16x32_bf16 v[28:31],a[144:147],v[124:127],v[28:31]
ds_read_b128 v[116:119],v4 offset:12288
v_mfma_f32_16x16x32_bf16 v[44:47],v[124:127],v[144:147],v[44:47]
s_add_u32 s64,s61,20480
v_mfma_f32_16x16x32_bf16 v[32:35],a[152:155],v[120:123],v[32:35]
s_add_u32 s65,s61,s50
v_mfma_f32_16x16x32_bf16 v[48:51],v[120:123],v[152:155],v[48:51]
s_add_u32 s65,s65,8192
v_mfma_f32_16x16x32_bf16 v[36:39],a[152:155],v[124:127],v[36:39]
v_mfma_f32_16x16x32_bf16 v[52:55],v[124:127],v[152:155],v[52:55]
s_waitcnt lgkmcnt(2)
v_mfma_f32_16x16x32_bf16 v[24:27],a[148:151],v[104:107],v[24:27]
ds_read_b128 v[120:123],v5 offset:8192
v_mfma_f32_16x16x32_bf16 v[40:43],v[104:107],v[148:151],v[40:43]
v_mfma_f32_16x16x32_bf16 v[28:31],a[148:151],v[108:111],v[28:31]
ds_read_b128 v[124:127],v5 offset:12288
v_mfma_f32_16x16x32_bf16 v[44:47],v[108:111],v[148:151],v[44:47]
v_mfma_f32_16x16x32_bf16 v[32:35],a[156:159],v[104:107],v[32:35]
v_mfma_f32_16x16x32_bf16 v[48:51],v[104:107],v[156:159],v[48:51]
v_mfma_f32_16x16x32_bf16 v[36:39],a[156:159],v[108:111],v[36:39]
v_mfma_f32_16x16x32_bf16 v[52:55],v[108:111],v[156:159],v[52:55]
s_waitcnt lgkmcnt(2)
v_mfma_f32_16x16x32_bf16 v[24:27],a[160:163],v[112:115],v[24:27]
ds_read_b128 v[104:107],v6 offset:8192
v_mfma_f32_16x16x32_bf16 v[40:43],v[112:115],v[160:163],v[40:43]
v_mfma_f32_16x16x32_bf16 v[28:31],a[160:163],v[116:119],v[28:31]
ds_read_b128 v[108:111],v6 offset:12288
v_mfma_f32_16x16x32_bf16 v[44:47],v[116:119],v[160:163],v[44:47]
v_mfma_f32_16x16x32_bf16 v[32:35],a[168:171],v[112:115],v[32:35]
v_mfma_f32_16x16x32_bf16 v[48:51],v[112:115],v[168:171],v[48:51]
v_mfma_f32_16x16x32_bf16 v[36:39],a[168:171],v[116:119],v[36:39]
v_mfma_f32_16x16x32_bf16 v[52:55],v[116:119],v[168:171],v[52:55]
s_waitcnt lgkmcnt(2)
v_mfma_f32_16x16x32_bf16 v[24:27],a[164:167],v[120:123],v[24:27]
ds_read_b128 v[112:115],v7 offset:8192
v_mfma_f32_16x16x32_bf16 v[40:43],v[120:123],v[164:167],v[40:43]
s_lshl_b32 s56,s54,13
v_mfma_f32_16x16x32_bf16 v[28:31],a[164:167],v[124:127],v[28:31]
ds_read_b128 v[116:119],v7 offset:12288
v_mfma_f32_16x16x32_bf16 v[44:47],v[124:127],v[164:167],v[44:47]
s_add_u32 s56,s56,10487552
v_mfma_f32_16x16x32_bf16 v[32:35],a[172:175],v[120:123],v[32:35]
s_or_b32 s56,s56,s52
v_mfma_f32_16x16x32_bf16 v[48:51],v[120:123],v[172:175],v[48:51]
buffer_load_dword v76,v23,s[8:11],s56 offen sc1
v_mfma_f32_16x16x32_bf16 v[36:39],a[172:175],v[124:127],v[36:39]
v_mfma_f32_16x16x32_bf16 v[52:55],v[124:127],v[172:175],v[52:55]
s_waitcnt lgkmcnt(2)
v_mfma_f32_16x16x32_bf16 v[24:27],a[176:179],v[104:107],v[24:27]
ds_read_b128 v[120:123],v4 offset:16384
v_mfma_f32_16x16x32_bf16 v[40:43],v[104:107],v[176:179],v[40:43]
v_mfma_f32_16x16x32_bf16 v[28:31],a[176:179],v[108:111],v[28:31]
ds_read_b128 v[124:127],v4 offset:20480
v_mfma_f32_16x16x32_bf16 v[44:47],v[108:111],v[176:179],v[44:47]
v_mfma_f32_16x16x32_bf16 v[32:35],a[184:187],v[104:107],v[32:35]
v_mfma_f32_16x16x32_bf16 v[48:51],v[104:107],v[184:187],v[48:51]
v_mfma_f32_16x16x32_bf16 v[36:39],a[184:187],v[108:111],v[36:39]
v_mfma_f32_16x16x32_bf16 v[52:55],v[108:111],v[184:187],v[52:55]
s_waitcnt lgkmcnt(2)
v_mfma_f32_16x16x32_bf16 v[24:27],a[180:183],v[112:115],v[24:27]
ds_read_b128 v[104:107],v5 offset:16384
v_mfma_f32_16x16x32_bf16 v[40:43],v[112:115],v[180:183],v[40:43]
v_mfma_f32_16x16x32_bf16 v[28:31],a[180:183],v[116:119],v[28:31]
ds_read_b128 v[108:111],v5 offset:20480
v_mfma_f32_16x16x32_bf16 v[44:47],v[116:119],v[180:183],v[44:47]
v_mfma_f32_16x16x32_bf16 v[32:35],a[188:191],v[112:115],v[32:35]
v_mfma_f32_16x16x32_bf16 v[48:51],v[112:115],v[188:191],v[48:51]
v_mfma_f32_16x16x32_bf16 v[36:39],a[188:191],v[116:119],v[36:39]
v_mfma_f32_16x16x32_bf16 v[52:55],v[116:119],v[188:191],v[52:55]
s_waitcnt lgkmcnt(2)
v_mfma_f32_16x16x32_bf16 v[24:27],a[192:195],v[120:123],v[24:27]
ds_read_b128 v[112:115],v6 offset:16384
v_mfma_f32_16x16x32_bf16 v[40:43],v[120:123],v[192:195],v[40:43]
v_mfma_f32_16x16x32_bf16 v[28:31],a[192:195],v[124:127],v[28:31]
ds_read_b128 v[116:119],v6 offset:20480
v_mfma_f32_16x16x32_bf16 v[44:47],v[124:127],v[192:195],v[44:47]
v_mfma_f32_16x16x32_bf16 v[32:35],a[200:203],v[120:123],v[32:35]
v_mfma_f32_16x16x32_bf16 v[48:51],v[120:123],v[200:203],v[48:51]
v_mfma_f32_16x16x32_bf16 v[36:39],a[200:203],v[124:127],v[36:39]
v_mfma_f32_16x16x32_bf16 v[52:55],v[124:127],v[200:203],v[52:55]
s_waitcnt lgkmcnt(2)
v_mfma_f32_16x16x32_bf16 v[24:27],a[196:199],v[104:107],v[24:27]
ds_read_b128 v[120:123],v7 offset:16384
v_mfma_f32_16x16x32_bf16 v[40:43],v[104:107],v[196:199],v[40:43]
s_waitcnt vmcnt(0)
v_mfma_f32_16x16x32_bf16 v[28:31],a[196:199],v[108:111],v[28:31]
ds_read_b128 v[124:127],v7 offset:20480
v_mfma_f32_16x16x32_bf16 v[44:47],v[108:111],v[196:199],v[44:47]
v_cmp_eq_u32 vcc,0,v76
v_mfma_f32_16x16x32_bf16 v[32:35],a[204:207],v[104:107],v[32:35]
s_nop 0
v_mov_b32 v76,vcc_lo
v_mfma_f32_16x16x32_bf16 v[48:51],v[104:107],v[204:207],v[48:51]
ds_write_b32 v19,v76
v_mfma_f32_16x16x32_bf16 v[36:39],a[204:207],v[108:111],v[36:39]
v_mfma_f32_16x16x32_bf16 v[52:55],v[108:111],v[204:207],v[52:55]
s_waitcnt vmcnt(0) lgkmcnt(0)
s_barrier
s_or_b32 s70,s70,s52
buffer_store_dword v17,off,s[8:11],s70 sc1
ds_read_b32 v76,v16
v_mfma_f32_16x16x32_bf16 v[24:27],a[208:211],v[112:115],v[24:27]
ds_read_b128 v[104:107],v4 offset:24576
v_mfma_f32_16x16x32_bf16 v[40:43],v[112:115],v[208:211],v[40:43]
s_lshl_b32 s56,s51,5
s_add_u32 s56,s56,s47
s_lshl_b32 s56,s56,12
v_mfma_f32_16x16x32_bf16 v[28:31],a[208:211],v[116:119],v[28:31]
ds_read_b128 v[108:111],v4 offset:28672
v_mfma_f32_16x16x32_bf16 v[44:47],v[116:119],v[208:211],v[44:47]
s_add_u32 s56,s56,s50
s_add_u32 s56,s56,41943040
v_mfma_f32_16x16x32_bf16 v[32:35],a[216:219],v[112:115],v[32:35]
v_mov_b64 v[72:73],-1
v_mov_b64 v[74:75],-1
v_mfma_f32_16x16x32_bf16 v[48:51],v[112:115],v[216:219],v[48:51]
buffer_store_dwordx4 v[72:75],v0,s[8:11],s56 offen sc1
v_mfma_f32_16x16x32_bf16 v[36:39],a[216:219],v[116:119],v[36:39]
v_mfma_f32_16x16x32_bf16 v[52:55],v[116:119],v[216:219],v[52:55]
s_waitcnt lgkmcnt(2)
v_mfma_f32_16x16x32_bf16 v[24:27],a[212:215],v[120:123],v[24:27]
ds_read_b128 v[112:115],v5 offset:24576
v_mfma_f32_16x16x32_bf16 v[40:43],v[120:123],v[212:215],v[40:43]
v_readfirstlane_b32 s57,v76
v_mfma_f32_16x16x32_bf16 v[28:31],a[212:215],v[124:127],v[28:31]
ds_read_b128 v[116:119],v5 offset:28672
v_mfma_f32_16x16x32_bf16 v[44:47],v[124:127],v[212:215],v[44:47]
s_sub_u32 s59,s55,s54
s_cmp_lt_i32 s59,44
s_cselect_b32 s76,2,0
v_mfma_f32_16x16x32_bf16 v[32:35],a[220:223],v[120:123],v[32:35]
s_cmp_gt_i32 s53,0
s_cselect_b32 s76,s76,0
v_mfma_f32_16x16x32_bf16 v[48:51],v[120:123],v[220:223],v[48:51]
s_cmp_eq_u32 s57,0
s_cselect_b32 s76,1,s76
v_mfma_f32_16x16x32_bf16 v[36:39],a[220:223],v[124:127],v[36:39]
s_cmp_lt_i32 s59,12
s_cselect_b32 s76,2,s76
s_add_u32 s57,s54,64
v_mfma_f32_16x16x32_bf16 v[52:55],v[124:127],v[220:223],v[52:55]
s_cmp_eq_u32 s76,1
s_cselect_b32 s68,s57,s55
s_lshl_b32 s68,s68,15
s_waitcnt lgkmcnt(2)
v_mfma_f32_16x16x32_bf16 v[24:27],a[224:227],v[104:107],v[24:27]
ds_read_b128 v[120:123],v6 offset:24576
v_mfma_f32_16x16x32_bf16 v[40:43],v[104:107],v[224:227],v[40:43]
s_cmp_eq_u32 s76,0
s_cselect_b32 s68,0x80000000,s68
s_add_u32 s69,s68,16384
v_mfma_f32_16x16x32_bf16 v[28:31],a[224:227],v[108:111],v[28:31]
ds_read_b128 v[124:127],v6 offset:28672
v_mfma_f32_16x16x32_bf16 v[44:47],v[108:111],v[224:227],v[44:47]
s_add_u32 m0,s75,65536
v_mfma_f32_16x16x32_bf16 v[32:35],a[232:235],v[104:107],v[32:35]
buffer_load_dwordx4 v20,s[8:11],s68 offen offset:0 sc1 lds
v_mfma_f32_16x16x32_bf16 v[48:51],v[104:107],v[232:235],v[48:51]
s_add_u32 m0,s75,69632
v_mfma_f32_16x16x32_bf16 v[36:39],a[232:235],v[108:111],v[36:39]
buffer_load_dwordx4 v20,s[8:11],s69 offen offset:0 sc1 lds
v_mfma_f32_16x16x32_bf16 v[52:55],v[108:111],v[232:235],v[52:55]
s_add_u32 m0,s75,73472
s_waitcnt lgkmcnt(2)
v_mfma_f32_16x16x32_bf16 v[24:27],a[228:231],v[112:115],v[24:27]
ds_read_b128 v[104:107],v7 offset:24576
v_mfma_f32_16x16x32_bf16 v[40:43],v[112:115],v[228:231],v[40:43]
buffer_load_dwordx4 v20,s[8:11],s68 offen offset:256 sc1 lds
v_mfma_f32_16x16x32_bf16 v[28:31],a[228:231],v[116:119],v[28:31]
ds_read_b128 v[108:111],v7 offset:28672
v_mfma_f32_16x16x32_bf16 v[44:47],v[116:119],v[228:231],v[44:47]
s_add_u32 m0,s75,77568
v_mfma_f32_16x16x32_bf16 v[32:35],a[236:239],v[112:115],v[32:35]
buffer_load_dwordx4 v20,s[8:11],s69 offen offset:256 sc1 lds
v_mfma_f32_16x16x32_bf16 v[48:51],v[112:115],v[236:239],v[48:51]
s_add_u32 m0,s75,81408
v_mfma_f32_16x16x32_bf16 v[36:39],a[236:239],v[116:119],v[36:39]
buffer_load_dwordx4 v20,s[8:11],s68 offen offset:512 sc1 lds
v_mfma_f32_16x16x32_bf16 v[52:55],v[116:119],v[236:239],v[52:55]
s_add_u32 m0,s75,85504
s_waitcnt lgkmcnt(2)
v_mfma_f32_16x16x32_bf16 v[24:27],a[240:243],v[120:123],v[24:27]
ds_read_b128 v[112:115],v4 offset:0
v_mfma_f32_16x16x32_bf16 v[40:43],v[120:123],v[240:243],v[40:43]
buffer_load_dwordx4 v20,s[8:11],s69 offen offset:512 sc1 lds
v_mfma_f32_16x16x32_bf16 v[28:31],a[240:243],v[124:127],v[28:31]
ds_read_b128 v[116:119],v4 offset:4096
v_mfma_f32_16x16x32_bf16 v[44:47],v[124:127],v[240:243],v[44:47]
s_add_u32 m0,s75,89344
v_mfma_f32_16x16x32_bf16 v[32:35],a[248:251],v[120:123],v[32:35]
buffer_load_dwordx4 v20,s[8:11],s68 offen offset:768 sc1 lds
v_mfma_f32_16x16x32_bf16 v[48:51],v[120:123],v[248:251],v[48:51]
s_add_u32 m0,s75,93440
v_mfma_f32_16x16x32_bf16 v[36:39],a[248:251],v[124:127],v[36:39]
buffer_load_dwordx4 v20,s[8:11],s69 offen offset:768 sc1 lds
v_mfma_f32_16x16x32_bf16 v[52:55],v[124:127],v[248:251],v[52:55]
s_waitcnt lgkmcnt(2)
v_mfma_f32_16x16x32_bf16 v[24:27],a[244:247],v[104:107],v[24:27]
ds_read_b128 v[120:123],v5 offset:0
v_mfma_f32_16x16x32_bf16 v[40:43],v[104:107],v[244:247],v[40:43]
v_mfma_f32_16x16x32_bf16 v[28:31],a[244:247],v[108:111],v[28:31]
ds_read_b128 v[124:127],v5 offset:4096
v_mfma_f32_16x16x32_bf16 v[44:47],v[108:111],v[244:247],v[44:47]
v_mfma_f32_16x16x32_bf16 v[32:35],a[252:255],v[104:107],v[32:35]
v_mfma_f32_16x16x32_bf16 v[48:51],v[104:107],v[252:255],v[48:51]
v_mfma_f32_16x16x32_bf16 v[36:39],a[252:255],v[108:111],v[36:39]
v_mfma_f32_16x16x32_bf16 v[52:55],v[108:111],v[252:255],v[52:55]
s_waitcnt lgkmcnt(2)
v_mfma_f32_16x16x32_bf16 v[88:91],a[0:3],v[112:115],0
ds_read_b128 v[104:107],v6 offset:0
v_mfma_f32_16x16x32_bf16 v[92:95],a[0:3],v[116:119],0
v_mfma_f32_16x16x32_bf16 v[96:99],a[8:11],v[112:115],0
ds_read_b128 v[108:111],v6 offset:4096
v_cvt_pk_bf16_f32 v56,v24,v32
v_cvt_pk_bf16_f32 v57,v25,v33
v_mfma_f32_16x16x32_bf16 v[100:103],a[8:11],v[116:119],0
v_cvt_pk_bf16_f32 v58,v26,v34
v_cvt_pk_bf16_f32 v59,v27,v35
s_waitcnt lgkmcnt(2)
v_mfma_f32_16x16x32_bf16 v[88:91],a[4:7],v[120:123],v[88:91]
ds_read_b128 v[112:115],v7 offset:0
v_mfma_f32_16x16x32_bf16 v[92:95],a[4:7],v[124:127],v[92:95]
buffer_store_dwordx4 v[56:59],v0,s[8:11],s61 offen sc1
v_cvt_pk_bf16_f32 v60,v28,v36
v_cvt_pk_bf16_f32 v61,v29,v37
v_mfma_f32_16x16x32_bf16 v[96:99],a[12:15],v[120:123],v[96:99]
ds_read_b128 v[116:119],v7 offset:4096
v_cvt_pk_bf16_f32 v62,v30,v38
v_cvt_pk_bf16_f32 v63,v31,v39
v_mfma_f32_16x16x32_bf16 v[100:103],a[12:15],v[124:127],v[100:103]
buffer_store_dwordx4 v[60:63],v0,s[8:11],s62 offen sc1
v_cvt_pk_bf16_f32 v64,v40,v41
v_cvt_pk_bf16_f32 v65,v42,v43
s_waitcnt lgkmcnt(2)
v_mfma_f32_16x16x32_bf16 v[88:91],a[16:19],v[104:107],v[88:91]
ds_read_b128 v[120:123],v4 offset:8192
v_cvt_pk_bf16_f32 v66,v44,v45
v_cvt_pk_bf16_f32 v67,v46,v47
v_mfma_f32_16x16x32_bf16 v[92:95],a[16:19],v[108:111],v[92:95]
buffer_store_dwordx4 v[64:67],v0,s[8:11],s65 offen offset:0 sc1
v_cvt_pk_bf16_f32 v68,v48,v49
v_cvt_pk_bf16_f32 v69,v50,v51
v_mfma_f32_16x16x32_bf16 v[96:99],a[24:27],v[104:107],v[96:99]
ds_read_b128 v[124:127],v4 offset:12288
v_cvt_pk_bf16_f32 v70,v52,v53
v_cvt_pk_bf16_f32 v71,v54,v55
v_mfma_f32_16x16x32_bf16 v[100:103],a[24:27],v[108:111],v[100:103]
buffer_store_dwordx4 v[68:71],v0,s[8:11],s65 offen offset:1024 sc1
s_waitcnt lgkmcnt(2)
v_mfma_f32_16x16x32_bf16 v[88:91],a[20:23],v[112:115],v[88:91]
ds_read_b128 v[104:107],v5 offset:8192
v_mfma_f32_16x16x32_bf16 v[92:95],a[20:23],v[116:119],v[92:95]
v_mfma_f32_16x16x32_bf16 v[96:99],a[28:31],v[112:115],v[96:99]
ds_read_b128 v[108:111],v5 offset:12288
v_mfma_f32_16x16x32_bf16 v[100:103],a[28:31],v[116:119],v[100:103]
s_waitcnt lgkmcnt(2)
v_mfma_f32_16x16x32_bf16 v[88:91],a[32:35],v[120:123],v[88:91]
ds_read_b128 v[112:115],v6 offset:8192
v_mfma_f32_16x16x32_bf16 v[92:95],a[32:35],v[124:127],v[92:95]
v_mfma_f32_16x16x32_bf16 v[96:99],a[40:43],v[120:123],v[96:99]
ds_read_b128 v[116:119],v6 offset:12288
v_mfma_f32_16x16x32_bf16 v[100:103],a[40:43],v[124:127],v[100:103]
s_waitcnt lgkmcnt(2)
v_mfma_f32_16x16x32_bf16 v[88:91],a[36:39],v[104:107],v[88:91]
ds_read_b128 v[120:123],v7 offset:8192
v_mfma_f32_16x16x32_bf16 v[92:95],a[36:39],v[108:111],v[92:95]
s_lshl_b32 s56,s54,13
v_mfma_f32_16x16x32_bf16 v[96:99],a[44:47],v[104:107],v[96:99]
ds_read_b128 v[124:127],v7 offset:12288
v_mfma_f32_16x16x32_bf16 v[100:103],a[44:47],v[108:111],v[100:103]
s_add_u32 s56,s56,10487552
s_waitcnt lgkmcnt(2)
v_mfma_f32_16x16x32_bf16 v[88:91],a[48:51],v[112:115],v[88:91]
ds_read_b128 v[104:107],v4 offset:16384
v_mfma_f32_16x16x32_bf16 v[92:95],a[48:51],v[116:119],v[92:95]
s_or_b32 s56,s56,s52
v_mfma_f32_16x16x32_bf16 v[96:99],a[56:59],v[112:115],v[96:99]
ds_read_b128 v[108:111],v4 offset:20480
v_mfma_f32_16x16x32_bf16 v[100:103],a[56:59],v[116:119],v[100:103]
buffer_load_dword v76,v23,s[8:11],s56 offen sc1
s_waitcnt lgkmcnt(2)
v_mfma_f32_16x16x32_bf16 v[88:91],a[52:55],v[120:123],v[88:91]
ds_read_b128 v[112:115],v5 offset:16384
v_mfma_f32_16x16x32_bf16 v[92:95],a[52:55],v[124:127],v[92:95]
v_mfma_f32_16x16x32_bf16 v[96:99],a[60:63],v[120:123],v[96:99]
ds_read_b128 v[116:119],v5 offset:20480
v_mfma_f32_16x16x32_bf16 v[100:103],a[60:63],v[124:127],v[100:103]
s_waitcnt lgkmcnt(2)
v_mfma_f32_16x16x32_bf16 v[88:91],a[64:67],v[104:107],v[88:91]
ds_read_b128 v[120:123],v6 offset:16384
v_mfma_f32_16x16x32_bf16 v[92:95],a[64:67],v[108:111],v[92:95]
v_mfma_f32_16x16x32_bf16 v[96:99],a[72:75],v[104:107],v[96:99]
ds_read_b128 v[124:127],v6 offset:20480
v_mfma_f32_16x16x32_bf16 v[100:103],a[72:75],v[108:111],v[100:103]
s_waitcnt lgkmcnt(2)
v_mfma_f32_16x16x32_bf16 v[88:91],a[68:71],v[112:115],v[88:91]
ds_read_b128 v[104:107],v7 offset:16384
v_mfma_f32_16x16x32_bf16 v[92:95],a[68:71],v[116:119],v[92:95]
v_mfma_f32_16x16x32_bf16 v[96:99],a[76:79],v[112:115],v[96:99]
ds_read_b128 v[108:111],v7 offset:20480
v_mfma_f32_16x16x32_bf16 v[100:103],a[76:79],v[116:119],v[100:103]
s_waitcnt lgkmcnt(2)
v_mfma_f32_16x16x32_bf16 v[88:91],a[80:83],v[120:123],v[88:91]
ds_read_b128 v[112:115],v4 offset:24576
v_mfma_f32_16x16x32_bf16 v[92:95],a[80:83],v[124:127],v[92:95]
v_mfma_f32_16x16x32_bf16 v[96:99],a[88:91],v[120:123],v[96:99]
ds_read_b128 v[116:119],v4 offset:28672
v_mfma_f32_16x16x32_bf16 v[100:103],a[88:91],v[124:127],v[100:103]
s_waitcnt lgkmcnt(2)
v_mfma_f32_16x16x32_bf16 v[88:91],a[84:87],v[104:107],v[88:91]
ds_read_b128 v[120:123],v5 offset:24576
v_mfma_f32_16x16x32_bf16 v[92:95],a[84:87],v[108:111],v[92:95]
v_mfma_f32_16x16x32_bf16 v[96:99],a[92:95],v[104:107],v[96:99]
ds_read_b128 v[124:127],v5 offset:28672
v_mfma_f32_16x16x32_bf16 v[100:103],a[92:95],v[108:111],v[100:103]
s_waitcnt lgkmcnt(2)
v_mfma_f32_16x16x32_bf16 v[88:91],a[96:99],v[112:115],v[88:91]
ds_read_b128 v[104:107],v6 offset:24576
v_mfma_f32_16x16x32_bf16 v[92:95],a[96:99],v[116:119],v[92:95]
v_mfma_f32_16x16x32_bf16 v[96:99],a[104:107],v[112:115],v[96:99]
ds_read_b128 v[108:111],v6 offset:28672
v_mfma_f32_16x16x32_bf16 v[100:103],a[104:107],v[116:119],v[100:103]
s_waitcnt lgkmcnt(2)
v_mfma_f32_16x16x32_bf16 v[88:91],a[100:103],v[120:123],v[88:91]
ds_read_b128 v[112:115],v7 offset:24576
v_mfma_f32_16x16x32_bf16 v[92:95],a[100:103],v[124:127],v[92:95]
v_mfma_f32_16x16x32_bf16 v[96:99],a[108:111],v[120:123],v[96:99]
ds_read_b128 v[116:119],v7 offset:28672
v_mfma_f32_16x16x32_bf16 v[100:103],a[108:111],v[124:127],v[100:103]
s_waitcnt lgkmcnt(2)
v_mfma_f32_16x16x32_bf16 v[88:91],a[112:115],v[104:107],v[88:91]
v_mfma_f32_16x16x32_bf16 v[92:95],a[112:115],v[108:111],v[92:95]
v_mfma_f32_16x16x32_bf16 v[96:99],a[120:123],v[104:107],v[96:99]
v_mfma_f32_16x16x32_bf16 v[100:103],a[120:123],v[108:111],v[100:103]
s_waitcnt lgkmcnt(0)
v_mfma_f32_16x16x32_bf16 v[88:91],a[116:119],v[112:115],v[88:91]
v_mfma_f32_16x16x32_bf16 v[92:95],a[116:119],v[116:119],v[92:95]
v_mfma_f32_16x16x32_bf16 v[96:99],a[124:127],v[112:115],v[96:99]
v_mfma_f32_16x16x32_bf16 v[100:103],a[124:127],v[116:119],v[100:103]
s_nop 3
v_cvt_pk_bf16_f32 v104,v88,v96
v_cvt_pk_bf16_f32 v105,v89,v97
v_cvt_pk_bf16_f32 v106,v90,v98
v_cvt_pk_bf16_f32 v107,v91,v99
v_cvt_pk_bf16_f32 v108,v92,v100
v_cvt_pk_bf16_f32 v109,v93,v101
v_cvt_pk_bf16_f32 v110,v94,v102
v_cvt_pk_bf16_f32 v111,v95,v103
buffer_store_dwordx4 v[104:107],v0,s[8:11],s63 offen sc1
buffer_store_dwordx4 v[108:111],v0,s[8:11],s64 offen sc1
s_waitcnt vmcnt(7)
s_barrier
s_lshl_b32 s70,s51,13
s_lshl2_add_u32 s70,s47,s70
s_add_u32 s70,s70,10485760
s_cmp_ge_u32 s51,2
s_cbranch_scc1 L_p_15
s_waitcnt vmcnt(0)
s_barrier
s_or_b32 s70,s70,s52
buffer_store_dword v17,off,s[8:11],s70 sc1
L_p_15:
s_cmp_eq_u32 s76,2
s_cbranch_scc1 L_p_13
s_mov_b32 s53,0
s_mov_b32 s51,s54
s_add_u32 s54,s54,2
s_cmp_eq_u32 s76,1
s_cbranch_scc1 L_p_14
s_cmp_lg_u32 s77,0
s_waitcnt vmcnt(3)
s_cbranch_scc1 L_p_17
s_waitcnt vmcnt(2)
L_p_17:
v_cmp_eq_u32 vcc,0,v76
s_nop 1
v_mov_b32 v76,vcc_lo
ds_write_b32 v19,v76
s_lshl_b32 s66,s51,15
s_add_u32 s66,s66,2097152
s_add_u32 s67,s66,16384
s_waitcnt lgkmcnt(0)
s_barrier
ds_read_b32 v76,v16
s_waitcnt lgkmcnt(0)
v_cmp_eq_u32 vcc,0,v76
s_cbranch_vccnz L_p_18
s_waitcnt vmcnt(0)
s_barrier
s_or_b32 s70,s70,s52
buffer_store_dword v17,off,s[8:11],s70 sc1
s_mov_b32 s70,0x80000000
s_mov_b32 s53,1
s_cmp_ge_u32 s51,64
s_cbranch_scc1 L_p_16
s_lshl_b32 s59,s51,13
s_add_u32 s59,s59,10487552
s_cmp_lg_u32 s46,0
s_cbranch_scc1 L_fd_20
v_and_b32 v124,31,v1
v_lshlrev_b32 v124,2,v124
s_branch L_ff_21
L_fw_19:
s_sleep 2
L_ff_21:
buffer_load_dword v125,v124,s[8:11],s59 offen sc1
s_sub_u32 s49,s49,1
s_cbranch_scc1 L_abort
s_waitcnt vmcnt(0)
v_cmp_eq_u32 vcc,0,v125
s_cbranch_vccnz L_fw_19
L_fd_20:
s_barrier
L_p_18:
s_add_u32 m0,s74,65536
s_nop 0
buffer_load_dwordx4 v20,s[8:11],s66 offen offset:0 sc1 lds
s_add_u32 m0,s74,69632
s_nop 0
buffer_load_dwordx4 v20,s[8:11],s67 offen offset:0 sc1 lds
s_add_u32 m0,s74,73472
s_nop 0
buffer_load_dwordx4 v20,s[8:11],s66 offen offset:256 sc1 lds
s_add_u32 m0,s74,77568
s_nop 0
buffer_load_dwordx4 v20,s[8:11],s67 offen offset:256 sc1 lds
s_add_u32 m0,s74,81408
s_nop 0
buffer_load_dwordx4 v20,s[8:11],s66 offen offset:512 sc1 lds
s_add_u32 m0,s74,85504
s_nop 0
buffer_load_dwordx4 v20,s[8:11],s67 offen offset:512 sc1 lds
s_add_u32 m0,s74,89344
s_nop 0
buffer_load_dwordx4 v20,s[8:11],s66 offen offset:768 sc1 lds
s_add_u32 m0,s74,93440
s_nop 0
buffer_load_dwordx4 v20,s[8:11],s67 offen offset:768 sc1 lds
s_lshl_b32 s56,s54,13
s_add_u32 s56,s56,10487552
s_or_b32 s56,s56,s52
buffer_load_dword v76,v23,s[8:11],s56 offen sc1
s_waitcnt vmcnt(7)
s_barrier
ds_read_b128 v[104:107],v4 offset:0
ds_read_b128 v[108:111],v4 offset:4096
ds_read_b128 v[112:115],v5 offset:0
ds_read_b128 v[116:119],v5 offset:4096
s_waitcnt lgkmcnt(2)
v_mfma_f32_16x16x32_bf16 v[24:27],a[128:131],v[104:107],0
ds_read_b128 v[120:123],v6 offset:0
v_mfma_f32_16x16x32_bf16 v[40:43],v[104:107],v[128:131],0
s_lshl_b32 s58,s51,5
v_mfma_f32_16x16x32_bf16 v[28:31],a[128:131],v[108:111],0
ds_read_b128 v[124:127],v6 offset:4096
v_mfma_f32_16x16x32_bf16 v[44:47],v[108:111],v[128:131],0
s_add_u32 s58,s58,s47
v_mfma_f32_16x16x32_bf16 v[32:35],a[136:139],v[104:107],0
s_mul_i32 s58,s58,24576
v_mfma_f32_16x16x32_bf16 v[48:51],v[104:107],v[136:139],0
s_add_u32 s58,s58,150994944
v_mfma_f32_16x16x32_bf16 v[36:39],a[136:139],v[108:111],0
s_add_u32 s61,s58,s50
v_mfma_f32_16x16x32_bf16 v[52:55],v[108:111],v[136:139],0
s_add_u32 s62,s61,4096
s_waitcnt lgkmcnt(2)
v_mfma_f32_16x16x32_bf16 v[24:27],a[132:135],v[112:115],v[24:27]
ds_read_b128 v[104:107],v7 offset:0
v_mfma_f32_16x16x32_bf16 v[40:43],v[112:115],v[132:135],v[40:43]
s_add_u32 s63,s61,16384
v_mfma_f32_16x16x32_bf16 v[28:31],a[132:135],v[116:119],v[28:31]
ds_read_b128 v[108:111],v7 offset:4096
v_mfma_f32_16x16x32_bf16 v[44:47],v[116:119],v[132:135],v[44:47]
s_add_u32 s64,s61,20480
v_mfma_f32_16x16x32_bf16 v[32:35],a[140:143],v[112:115],v[32:35]
s_add_u32 s65,s61,s50
v_mfma_f32_16x16x32_bf16 v[48:51],v[112:115],v[140:143],v[48:51]
s_add_u32 s65,s65,8192
v_mfma_f32_16x16x32_bf16 v[36:39],a[140:143],v[116:119],v[36:39]
v_mfma_f32_16x16x32_bf16 v[52:55],v[116:119],v[140:143],v[52:55]
s_waitcnt vmcnt(5)
s_barrier
s_waitcnt lgkmcnt(2)
v_mfma_f32_16x16x32_bf16 v[24:27],a[144:147],v[120:123],v[24:27]
ds_read_b128 v[112:115],v4 offset:8192
v_mfma_f32_16x16x32_bf16 v[40:43],v[120:123],v[144:147],v[40:43]
v_mfma_f32_16x16x32_bf16 v[28:31],a[144:147],v[124:127],v[28:31]
ds_read_b128 v[116:119],v4 offset:12288
v_mfma_f32_16x16x32_bf16 v[44:47],v[124:127],v[144:147],v[44:47]
v_mfma_f32_16x16x32_bf16 v[32:35],a[152:155],v[120:123],v[32:35]
v_mfma_f32_16x16x32_bf16 v[48:51],v[120:123],v[152:155],v[48:51]
v_mfma_f32_16x16x32_bf16 v[36:39],a[152:155],v[124:127],v[36:39]
v_mfma_f32_16x16x32_bf16 v[52:55],v[124:127],v[152:155],v[52:55]
s_waitcnt lgkmcnt(2)
v_mfma_f32_16x16x32_bf16 v[24:27],a[148:151],v[104:107],v[24:27]
ds_read_b128 v[120:123],v5 offset:8192
v_mfma_f32_16x16x32_bf16 v[40:43],v[104:107],v[148:151],v[40:43]
v_mfma_f32_16x16x32_bf16 v[28:31],a[148:151],v[108:111],v[28:31]
ds_read_b128 v[124:127],v5 offset:12288
v_mfma_f32_16x16x32_bf16 v[44:47],v[108:111],v[148:151],v[44:47]
v_mfma_f32_16x16x32_bf16 v[32:35],a[156:159],v[104:107],v[32:35]
v_mfma_f32_16x16x32_bf16 v[48:51],v[104:107],v[156:159],v[48:51]
v_mfma_f32_16x16x32_bf16 v[36:39],a[156:159],v[108:111],v[36:39]
v_mfma_f32_16x16x32_bf16 v[52:55],v[108:111],v[156:159],v[52:55]
s_waitcnt lgkmcnt(2)
v_mfma_f32_16x16x32_bf16 v[24:27],a[160:163],v[112:115],v[24:27]
ds_read_b128 v[104:107],v6 offset:8192
v_mfma_f32_16x16x32_bf16 v[40:43],v[112:115],v[160:163],v[40:43]
v_mfma_f32_16x16x32_bf16 v[28:31],a[160:163],v[116:119],v[28:31]
ds_read_b128 v[108:111],v6 offset:12288
v_mfma_f32_16x16x32_bf16 v[44:47],v[116:119],v[160:163],v[44:47]
v_mfma_f32_16x16x32_bf16 v[32:35],a[168:171],v[112:115],v[32:35]
v_mfma_f32_16x16x32_bf16 v[48:51],v[112:115],v[168:171],v[48:51]
v_mfma_f32_16x16x32_bf16 v[36:39],a[168:171],v[116:119],v[36:39]
v_mfma_f32_16x16x32_bf16 v[52:55],v[116:119],v[168:171],v[52:55]
s_waitcnt lgkmcnt(2)
v_mfma_f32_16x16x32_bf16 v[24:27],a[164:167],v[120:123],v[24:27]
ds_read_b128 v[112:115],v7 offset:8192
v_mfma_f32_16x16x32_bf16 v[40:43],v[120:123],v[164:167],v[40:43]
v_mfma_f32_16x16x32_bf16 v[28:31],a[164:167],v[124:127],v[28:31]
ds_read_b128 v[116:119],v7 offset:12288
v_mfma_f32_16x16x32_bf16 v[44:47],v[124:127],v[164:167],v[44:47]
v_mfma_f32_16x16x32_bf16 v[32:35],a[172:175],v[120:123],v[32:35]
v_mfma_f32_16x16x32_bf16 v[48:51],v[120:123],v[172:175],v[48:51]
v_mfma_f32_16x16x32_bf16 v[36:39],a[172:175],v[124:127],v[36:39]
v_mfma_f32_16x16x32_bf16 v[52:55],v[124:127],v[172:175],v[52:55]
s_waitcnt vmcnt(3)
s_barrier
s_waitcnt lgkmcnt(2)
v_mfma_f32_16x16x32_bf16 v[24:27],a[176:179],v[104:107],v[24:27]
ds_read_b128 v[120:123],v4 offset:16384
v_mfma_f32_16x16x32_bf16 v[40:43],v[104:107],v[176:179],v[40:43]
v_mfma_f32_16x16x32_bf16 v[28:31],a[176:179],v[108:111],v[28:31]
ds_read_b128 v[124:127],v4 offset:20480
v_mfma_f32_16x16x32_bf16 v[44:47],v[108:111],v[176:179],v[44:47]
v_mfma_f32_16x16x32_bf16 v[32:35],a[184:187],v[104:107],v[32:35]
v_mfma_f32_16x16x32_bf16 v[48:51],v[104:107],v[184:187],v[48:51]
v_mfma_f32_16x16x32_bf16 v[36:39],a[184:187],v[108:111],v[36:39]
v_mfma_f32_16x16x32_bf16 v[52:55],v[108:111],v[184:187],v[52:55]
s_waitcnt lgkmcnt(2)
v_mfma_f32_16x16x32_bf16 v[24:27],a[180:183],v[112:115],v[24:27]
ds_read_b128 v[104:107],v5 offset:16384
v_mfma_f32_16x16x32_bf16 v[40:43],v[112:115],v[180:183],v[40:43]
v_mfma_f32_16x16x32_bf16 v[28:31],a[180:183],v[116:119],v[28:31]
ds_read_b128 v[108:111],v5 offset:20480
v_mfma_f32_16x16x32_bf16 v[44:47],v[116:119],v[180:183],v[44:47]
v_mfma_f32_16x16x32_bf16 v[32:35],a[188:191],v[112:115],v[32:35]
v_mfma_f32_16x16x32_bf16 v[48:51],v[112:115],v[188:191],v[48:51]
v_mfma_f32_16x16x32_bf16 v[36:39],a[188:191],v[116:119],v[36:39]
v_mfma_f32_16x16x32_bf16 v[52:55],v[116:119],v[188:191],v[52:55]
s_waitcnt lgkmcnt(2)
v_mfma_f32_16x16x32_bf16 v[24:27],a[192:195],v[120:123],v[24:27]
ds_read_b128 v[112:115],v6 offset:16384
v_mfma_f32_16x16x32_bf16 v[40:43],v[120:123],v[192:195],v[40:43]
v_mfma_f32_16x16x32_bf16 v[28:31],a[192:195],v[124:127],v[28:31]
ds_read_b128 v[116:119],v6 offset:20480
v_mfma_f32_16x16x32_bf16 v[44:47],v[124:127],v[192:195],v[44:47]
v_mfma_f32_16x16x32_bf16 v[32:35],a[200:203],v[120:123],v[32:35]
v_mfma_f32_16x16x32_bf16 v[48:51],v[120:123],v[200:203],v[48:51]
v_mfma_f32_16x16x32_bf16 v[36:39],a[200:203],v[124:127],v[36:39]
v_mfma_f32_16x16x32_bf16 v[52:55],v[124:127],v[200:203],v[52:55]
s_waitcnt lgkmcnt(2)
v_mfma_f32_16x16x32_bf16 v[24:27],a[196:199],v[104:107],v[24:27]
ds_read_b128 v[120:123],v7 offset:16384
v_mfma_f32_16x16x32_bf16 v[40:43],v[104:107],v[196:199],v[40:43]
s_waitcnt vmcnt(0)
v_mfma_f32_16x16x32_bf16 v[28:31],a[196:199],v[108:111],v[28:31]
ds_read_b128 v[124:127],v7 offset:20480
v_mfma_f32_16x16x32_bf16 v[44:47],v[108:111],v[196:199],v[44:47]
v_cmp_eq_u32 vcc,0,v76
v_mfma_f32_16x16x32_bf16 v[32:35],a[204:207],v[104:107],v[32:35]
s_nop 0
v_mov_b32 v76,vcc_lo
v_mfma_f32_16x16x32_bf16 v[48:51],v[104:107],v[204:207],v[48:51]
ds_write_b32 v19,v76
v_mfma_f32_16x16x32_bf16 v[36:39],a[204:207],v[108:111],v[36:39]
v_mfma_f32_16x16x32_bf16 v[52:55],v[108:111],v[204:207],v[52:55]
s_waitcnt vmcnt(0) lgkmcnt(0)
s_barrier
s_or_b32 s70,s70,s52
buffer_store_dword v17,off,s[8:11],s70 sc1
ds_read_b32 v76,v16
v_mfma_f32_16x16x32_bf16 v[24:27],a[208:211],v[112:115],v[24:27]
ds_read_b128 v[104:107],v4 offset:24576
v_mfma_f32_16x16x32_bf16 v[40:43],v[112:115],v[208:211],v[40:43]
s_lshl_b32 s56,s51,5
s_add_u32 s56,s56,s47
s_lshl_b32 s56,s56,12
v_mfma_f32_16x16x32_bf16 v[28:31],a[208:211],v[116:119],v[28:31]
ds_read_b128 v[108:111],v4 offset:28672
v_mfma_f32_16x16x32_bf16 v[44:47],v[116:119],v[208:211],v[44:47]
s_add_u32 s56,s56,s50
s_add_u32 s56,s56,58720256
v_mfma_f32_16x16x32_bf16 v[32:35],a[216:219],v[112:115],v[32:35]
v_mov_b64 v[72:73],-1
v_mov_b64 v[74:75],-1
v_mfma_f32_16x16x32_bf16 v[48:51],v[112:115],v[216:219],v[48:51]
buffer_store_dwordx4 v[72:75],v0,s[8:11],s56 offen sc1
v_mfma_f32_16x16x32_bf16 v[36:39],a[216:219],v[116:119],v[36:39]
s_add_u32 s56,s56,16777216
v_mfma_f32_16x16x32_bf16 v[52:55],v[116:119],v[216:219],v[52:55]
buffer_store_dwordx4 v[72:75],v0,s[8:11],s56 offen sc1
s_waitcnt lgkmcnt(2)
v_mfma_f32_16x16x32_bf16 v[24:27],a[212:215],v[120:123],v[24:27]
ds_read_b128 v[112:115],v5 offset:24576
v_mfma_f32_16x16x32_bf16 v[40:43],v[120:123],v[212:215],v[40:43]
v_readfirstlane_b32 s57,v76
v_mfma_f32_16x16x32_bf16 v[28:31],a[212:215],v[124:127],v[28:31]
ds_read_b128 v[116:119],v5 offset:28672
v_mfma_f32_16x16x32_bf16 v[44:47],v[124:127],v[212:215],v[44:47]
s_sub_u32 s59,s55,s54
s_cmp_lt_i32 s59,44
s_cselect_b32 s76,2,0
v_mfma_f32_16x16x32_bf16 v[32:35],a[220:223],v[120:123],v[32:35]
s_cmp_gt_i32 s53,0
s_cselect_b32 s76,s76,0
v_mfma_f32_16x16x32_bf16 v[48:51],v[120:123],v[220:223],v[48:51]
s_cmp_eq_u32 s57,0
s_cselect_b32 s76,1,s76
v_mfma_f32_16x16x32_bf16 v[36:39],a[220:223],v[124:127],v[36:39]
s_cmp_lt_i32 s59,12
s_cselect_b32 s76,2,s76
s_add_u32 s57,s54,64
v_mfma_f32_16x16x32_bf16 v[52:55],v[124:127],v[220:223],v[52:55]
s_cmp_eq_u32 s76,1
s_cselect_b32 s68,s57,s55
s_lshl_b32 s68,s68,15
s_waitcnt lgkmcnt(2)
v_mfma_f32_16x16x32_bf16 v[24:27],a[224:227],v[104:107],v[24:27]
ds_read_b128 v[120:123],v6 offset:24576
v_mfma_f32_16x16x32_bf16 v[40:43],v[104:107],v[224:227],v[40:43]
s_cmp_eq_u32 s76,0
s_cselect_b32 s68,0x80000000,s68
s_add_u32 s69,s68,16384
v_mfma_f32_16x16x32_bf16 v[28:31],a[224:227],v[108:111],v[28:31]
ds_read_b128 v[124:127],v6 offset:28672
v_mfma_f32_16x16x32_bf16 v[44:47],v[108:111],v[224:227],v[44:47]
s_add_u32 m0,s75,65536
v_mfma_f32_16x16x32_bf16 v[32:35],a[232:235],v[104:107],v[32:35]
buffer_load_dwordx4 v20,s[8:11],s68 offen offset:0 sc1 lds
v_mfma_f32_16x16x32_bf16 v[48:51],v[104:107],v[232:235],v[48:51]
s_add_u32 m0,s75,69632
v_mfma_f32_16x16x32_bf16 v[36:39],a[232:235],v[108:111],v[36:39]
buffer_load_dwordx4 v20,s[8:11],s69 offen offset:0 sc1 lds
v_mfma_f32_16x16x32_bf16 v[52:55],v[108:111],v[232:235],v[52:55]
s_add_u32 m0,s75,73472
s_waitcnt lgkmcnt(2)
v_mfma_f32_16x16x32_bf16 v[24:27],a[228:231],v[112:115],v[24:27]
ds_read_b128 v[104:107],v7 offset:24576
v_mfma_f32_16x16x32_bf16 v[40:43],v[112:115],v[228:231],v[40:43]
buffer_load_dwordx4 v20,s[8:11],s68 offen offset:256 sc1 lds
v_mfma_f32_16x16x32_bf16 v[28:31],a[228:231],v[116:119],v[28:31]
ds_read_b128 v[108:111],v7 offset:28672
v_mfma_f32_16x16x32_bf16 v[44:47],v[116:119],v[228:231],v[44:47]
s_add_u32 m0,s75,77568
v_mfma_f32_16x16x32_bf16 v[32:35],a[236:239],v[112:115],v[32:35]
buffer_load_dwordx4 v20,s[8:11],s69 offen offset:256 sc1 lds
v_mfma_f32_16x16x32_bf16 v[48:51],v[112:115],v[236:239],v[48:51]
s_add_u32 m0,s75,81408
v_mfma_f32_16x16x32_bf16 v[36:39],a[236:239],v[116:119],v[36:39]
buffer_load_dwordx4 v20,s[8:11],s68 offen offset:512 sc1 lds
v_mfma_f32_16x16x32_bf16 v[52:55],v[116:119],v[236:239],v[52:55]
s_add_u32 m0,s75,85504
s_waitcnt lgkmcnt(2)
v_mfma_f32_16x16x32_bf16 v[24:27],a[240:243],v[120:123],v[24:27]
ds_read_b128 v[112:115],v4 offset:0
v_mfma_f32_16x16x32_bf16 v[40:43],v[120:123],v[240:243],v[40:43]
buffer_load_dwordx4 v20,s[8:11],s69 offen offset:512 sc1 lds
v_mfma_f32_16x16x32_bf16 v[28:31],a[240:243],v[124:127],v[28:31]
ds_read_b128 v[116:119],v4 offset:4096
v_mfma_f32_16x16x32_bf16 v[44:47],v[124:127],v[240:243],v[44:47]
s_add_u32 m0,s75,89344
v_mfma_f32_16x16x32_bf16 v[32:35],a[248:251],v[120:123],v[32:35]
buffer_load_dwordx4 v20,s[8:11],s68 offen offset:768 sc1 lds
v_mfma_f32_16x16x32_bf16 v[48:51],v[120:123],v[248:251],v[48:51]
s_add_u32 m0,s75,93440
v_mfma_f32_16x16x32_bf16 v[36:39],a[248:251],v[124:127],v[36:39]
buffer_load_dwordx4 v20,s[8:11],s69 offen offset:768 sc1 lds
v_mfma_f32_16x16x32_bf16 v[52:55],v[124:127],v[248:251],v[52:55]
s_waitcnt lgkmcnt(2)
v_mfma_f32_16x16x32_bf16 v[24:27],a[244:247],v[104:107],v[24:27]
ds_read_b128 v[120:123],v5 offset:0
v_mfma_f32_16x16x32_bf16 v[40:43],v[104:107],v[244:247],v[40:43]
v_mfma_f32_16x16x32_bf16 v[28:31],a[244:247],v[108:111],v[28:31]
ds_read_b128 v[124:127],v5 offset:4096
v_mfma_f32_16x16x32_bf16 v[44:47],v[108:111],v[244:247],v[44:47]
v_mfma_f32_16x16x32_bf16 v[32:35],a[252:255],v[104:107],v[32:35]
v_mfma_f32_16x16x32_bf16 v[48:51],v[104:107],v[252:255],v[48:51]
v_mfma_f32_16x16x32_bf16 v[36:39],a[252:255],v[108:111],v[36:39]
v_mfma_f32_16x16x32_bf16 v[52:55],v[108:111],v[252:255],v[52:55]
s_waitcnt lgkmcnt(2)
v_mfma_f32_16x16x32_bf16 v[88:91],a[0:3],v[112:115],0
ds_read_b128 v[104:107],v6 offset:0
v_mfma_f32_16x16x32_bf16 v[92:95],a[0:3],v[116:119],0
v_mfma_f32_16x16x32_bf16 v[96:99],a[8:11],v[112:115],0
ds_read_b128 v[108:111],v6 offset:4096
v_cvt_pk_bf16_f32 v56,v24,v32
v_cvt_pk_bf16_f32 v57,v25,v33
v_mfma_f32_16x16x32_bf16 v[100:103],a[8:11],v[116:119],0
v_cvt_pk_bf16_f32 v58,v26,v34
v_cvt_pk_bf16_f32 v59,v27,v35
s_waitcnt lgkmcnt(2)
v_mfma_f32_16x16x32_bf16 v[88:91],a[4:7],v[120:123],v[88:91]
ds_read_b128 v[112:115],v7 offset:0
v_mfma_f32_16x16x32_bf16 v[92:95],a[4:7],v[124:127],v[92:95]
buffer_store_dwordx4 v[56:59],v0,s[8:11],s61 offen sc1
v_cvt_pk_bf16_f32 v60,v28,v36
v_cvt_pk_bf16_f32 v61,v29,v37
v_mfma_f32_16x16x32_bf16 v[96:99],a[12:15],v[120:123],v[96:99]
ds_read_b128 v[116:119],v7 offset:4096
v_cvt_pk_bf16_f32 v62,v30,v38
v_cvt_pk_bf16_f32 v63,v31,v39
v_mfma_f32_16x16x32_bf16 v[100:103],a[12:15],v[124:127],v[100:103]
buffer_store_dwordx4 v[60:63],v0,s[8:11],s62 offen sc1
v_cvt_pk_bf16_f32 v64,v40,v41
v_cvt_pk_bf16_f32 v65,v42,v43
s_waitcnt lgkmcnt(2)
v_mfma_f32_16x16x32_bf16 v[88:91],a[16:19],v[104:107],v[88:91]
ds_read_b128 v[120:123],v4 offset:8192
v_cvt_pk_bf16_f32 v66,v44,v45
v_cvt_pk_bf16_f32 v67,v46,v47
v_mfma_f32_16x16x32_bf16 v[92:95],a[16:19],v[108:111],v[92:95]
buffer_store_dwordx4 v[64:67],v0,s[8:11],s65 offen offset:0 sc1
v_cvt_pk_bf16_f32 v68,v48,v49
v_cvt_pk_bf16_f32 v69,v50,v51
v_mfma_f32_16x16x32_bf16 v[96:99],a[24:27],v[104:107],v[96:99]
ds_read_b128 v[124:127],v4 offset:12288
v_cvt_pk_bf16_f32 v70,v52,v53
v_cvt_pk_bf16_f32 v71,v54,v55
v_mfma_f32_16x16x32_bf16 v[100:103],a[24:27],v[108:111],v[100:103]
buffer_store_dwordx4 v[68:71],v0,s[8:11],s65 offen offset:1024 sc1
s_waitcnt lgkmcnt(2)
v_mfma_f32_16x16x32_bf16 v[88:91],a[20:23],v[112:115],v[88:91]
ds_read_b128 v[104:107],v5 offset:8192
v_mfma_f32_16x16x32_bf16 v[92:95],a[20:23],v[116:119],v[92:95]
v_mfma_f32_16x16x32_bf16 v[96:99],a[28:31],v[112:115],v[96:99]
ds_read_b128 v[108:111],v5 offset:12288
v_mfma_f32_16x16x32_bf16 v[100:103],a[28:31],v[116:119],v[100:103]
s_waitcnt lgkmcnt(2)
v_mfma_f32_16x16x32_bf16 v[88:91],a[32:35],v[120:123],v[88:91]
ds_read_b128 v[112:115],v6 offset:8192
v_mfma_f32_16x16x32_bf16 v[92:95],a[32:35],v[124:127],v[92:95]
v_mfma_f32_16x16x32_bf16 v[96:99],a[40:43],v[120:123],v[96:99]
ds_read_b128 v[116:119],v6 offset:12288
v_mfma_f32_16x16x32_bf16 v[100:103],a[40:43],v[124:127],v[100:103]
s_waitcnt lgkmcnt(2)
v_mfma_f32_16x16x32_bf16 v[88:91],a[36:39],v[104:107],v[88:91]
ds_read_b128 v[120:123],v7 offset:8192
v_mfma_f32_16x16x32_bf16 v[92:95],a[36:39],v[108:111],v[92:95]
s_lshl_b32 s56,s54,13
v_mfma_f32_16x16x32_bf16 v[96:99],a[44:47],v[104:107],v[96:99]
ds_read_b128 v[124:127],v7 offset:12288
v_mfma_f32_16x16x32_bf16 v[100:103],a[44:47],v[108:111],v[100:103]
s_add_u32 s56,s56,10487552
s_waitcnt lgkmcnt(2)
v_mfma_f32_16x16x32_bf16 v[88:91],a[48:51],v[112:115],v[88:91]
ds_read_b128 v[104:107],v4 offset:16384
v_mfma_f32_16x16x32_bf16 v[92:95],a[48:51],v[116:119],v[92:95]
s_or_b32 s56,s56,s52
v_mfma_f32_16x16x32_bf16 v[96:99],a[56:59],v[112:115],v[96:99]
ds_read_b128 v[108:111],v4 offset:20480
v_mfma_f32_16x16x32_bf16 v[100:103],a[56:59],v[116:119],v[100:103]
buffer_load_dword v76,v23,s[8:11],s56 offen sc1
s_waitcnt lgkmcnt(2)
v_mfma_f32_16x16x32_bf16 v[88:91],a[52:55],v[120:123],v[88:91]
ds_read_b128 v[112:115],v5 offset:16384
v_mfma_f32_16x16x32_bf16 v[92:95],a[52:55],v[124:127],v[92:95]
v_mfma_f32_16x16x32_bf16 v[96:99],a[60:63],v[120:123],v[96:99]
ds_read_b128 v[116:119],v5 offset:20480
v_mfma_f32_16x16x32_bf16 v[100:103],a[60:63],v[124:127],v[100:103]
s_waitcnt lgkmcnt(2)
v_mfma_f32_16x16x32_bf16 v[88:91],a[64:67],v[104:107],v[88:91]
ds_read_b128 v[120:123],v6 offset:16384
v_mfma_f32_16x16x32_bf16 v[92:95],a[64:67],v[108:111],v[92:95]
v_mfma_f32_16x16x32_bf16 v[96:99],a[72:75],v[104:107],v[96:99]
ds_read_b128 v[124:127],v6 offset:20480
v_mfma_f32_16x16x32_bf16 v[100:103],a[72:75],v[108:111],v[100:103]
s_waitcnt lgkmcnt(2)
v_mfma_f32_16x16x32_bf16 v[88:91],a[68:71],v[112:115],v[88:91]
ds_read_b128 v[104:107],v7 offset:16384
v_mfma_f32_16x16x32_bf16 v[92:95],a[68:71],v[116:119],v[92:95]
v_mfma_f32_16x16x32_bf16 v[96:99],a[76:79],v[112:115],v[96:99]
ds_read_b128 v[108:111],v7 offset:20480
v_mfma_f32_16x16x32_bf16 v[100:103],a[76:79],v[116:119],v[100:103]
s_waitcnt lgkmcnt(2)
v_mfma_f32_16x16x32_bf16 v[88:91],a[80:83],v[120:123],v[88:91]
ds_read_b128 v[112:115],v4 offset:24576
v_mfma_f32_16x16x32_bf16 v[92:95],a[80:83],v[124:127],v[92:95]
v_mfma_f32_16x16x32_bf16 v[96:99],a[88:91],v[120:123],v[96:99]
ds_read_b128 v[116:119],v4 offset:28672
v_mfma_f32_16x16x32_bf16 v[100:103],a[88:91],v[124:127],v[100:103]
s_waitcnt lgkmcnt(2)
v_mfma_f32_16x16x32_bf16 v[88:91],a[84:87],v[104:107],v[88:91]
ds_read_b128 v[120:123],v5 offset:24576
v_mfma_f32_16x16x32_bf16 v[92:95],a[84:87],v[108:111],v[92:95]
v_mfma_f32_16x16x32_bf16 v[96:99],a[92:95],v[104:107],v[96:99]
ds_read_b128 v[124:127],v5 offset:28672
v_mfma_f32_16x16x32_bf16 v[100:103],a[92:95],v[108:111],v[100:103]
s_waitcnt lgkmcnt(2)
v_mfma_f32_16x16x32_bf16 v[88:91],a[96:99],v[112:115],v[88:91]
ds_read_b128 v[104:107],v6 offset:24576
v_mfma_f32_16x16x32_bf16 v[92:95],a[96:99],v[116:119],v[92:95]
v_mfma_f32_16x16x32_bf16 v[96:99],a[104:107],v[112:115],v[96:99]
ds_read_b128 v[108:111],v6 offset:28672
v_mfma_f32_16x16x32_bf16 v[100:103],a[104:107],v[116:119],v[100:103]
s_waitcnt lgkmcnt(2)
v_mfma_f32_16x16x32_bf16 v[88:91],a[100:103],v[120:123],v[88:91]
ds_read_b128 v[112:115],v7 offset:24576
v_mfma_f32_16x16x32_bf16 v[92:95],a[100:103],v[124:127],v[92:95]
v_mfma_f32_16x16x32_bf16 v[96:99],a[108:111],v[120:123],v[96:99]
ds_read_b128 v[116:119],v7 offset:28672
v_mfma_f32_16x16x32_bf16 v[100:103],a[108:111],v[124:127],v[100:103]
s_waitcnt lgkmcnt(2)
v_mfma_f32_16x16x32_bf16 v[88:91],a[112:115],v[104:107],v[88:91]
v_mfma_f32_16x16x32_bf16 v[92:95],a[112:115],v[108:111],v[92:95]
v_mfma_f32_16x16x32_bf16 v[96:99],a[120:123],v[104:107],v[96:99]
v_mfma_f32_16x16x32_bf16 v[100:103],a[120:123],v[108:111],v[100:103]
s_waitcnt lgkmcnt(0)
v_mfma_f32_16x16x32_bf16 v[88:91],a[116:119],v[112:115],v[88:91]
v_mfma_f32_16x16x32_bf16 v[92:95],a[116:119],v[116:119],v[92:95]
v_mfma_f32_16x16x32_bf16 v[96:99],a[124:127],v[112:115],v[96:99]
v_mfma_f32_16x16x32_bf16 v[100:103],a[124:127],v[116:119],v[100:103]
s_nop 3
v_cvt_pk_bf16_f32 v104,v88,v96
v_cvt_pk_bf16_f32 v105,v89,v97
v_cvt_pk_bf16_f32 v106,v90,v98
v_cvt_pk_bf16_f32 v107,v91,v99
v_cvt_pk_bf16_f32 v108,v92,v100
v_cvt_pk_bf16_f32 v109,v93,v101
v_cvt_pk_bf16_f32 v110,v94,v102
v_cvt_pk_bf16_f32 v111,v95,v103
buffer_store_dwordx4 v[104:107],v0,s[8:11],s63 offen sc1
buffer_store_dwordx4 v[108:111],v0,s[8:11],s64 offen sc1
s_lshl_b32 s59,s51,13
s_lshl2_add_u32 s59,s47,s59
s_add_u32 s59,s59,10485888
s_waitcnt vmcnt(3)
s_barrier
s_or_b32 s59,s59,s52
buffer_store_dword v17,off,s[8:11],s59 sc1
s_mov_b32 s77,1
s_lshl_b32 s70,s51,13
s_lshl2_add_u32 s70,s47,s70
s_add_u32 s70,s70,10486144
s_branch L_p_15
L_p_14:
s_mov_b32 s75,s74
s_xor_b32 s74,s74,32768
v_xor_b32 v4,32768,v4
v_xor_b32 v5,32768,v5
v_xor_b32 v6,32768,v6
v_xor_b32 v7,32768,v7
ds_read_b128 v[104:107],v4 offset:0
ds_read_b128 v[108:111],v4 offset:4096
ds_read_b128 v[112:115],v5 offset:0
ds_read_b128 v[116:119],v5 offset:4096
s_waitcnt lgkmcnt(2)
v_mfma_f32_16x16x32_bf16 v[24:27],a[128:131],v[104:107],0
ds_read_b128 v[120:123],v6 offset:0
v_mfma_f32_16x16x32_bf16 v[40:43],v[104:107],v[128:131],0
s_lshl_b32 s58,s51,5
v_mfma_f32_16x16x32_bf16 v[28:31],a[128:131],v[108:111],0
ds_read_b128 v[124:127],v6 offset:4096
v_mfma_f32_16x16x32_bf16 v[44:47],v[108:111],v[128:131],0
s_add_u32 s58,s58,s47
v_mfma_f32_16x16x32_bf16 v[32:35],a[136:139],v[104:107],0
s_mul_i32 s58,s58,24576
v_mfma_f32_16x16x32_bf16 v[48:51],v[104:107],v[136:139],0
s_add_u32 s58,s58,150994944
v_mfma_f32_16x16x32_bf16 v[36:39],a[136:139],v[108:111],0
s_add_u32 s61,s58,s50
v_mfma_f32_16x16x32_bf16 v[52:55],v[108:111],v[136:139],0
s_add_u32 s62,s61,4096
s_waitcnt lgkmcnt(2)
v_mfma_f32_16x16x32_bf16 v[24:27],a[132:135],v[112:115],v[24:27]
ds_read_b128 v[104:107],v7 offset:0
v_mfma_f32_16x16x32_bf16 v[40:43],v[112:115],v[132:135],v[40:43]
s_add_u32 s63,s61,16384
v_mfma_f32_16x16x32_bf16 v[28:31],a[132:135],v[116:119],v[28:31]
ds_read_b128 v[108:111],v7 offset:4096
v_mfma_f32_16x16x32_bf16 v[44:47],v[116:119],v[132:135],v[44:47]
s_add_u32 s64,s61,20480
v_mfma_f32_16x16x32_bf16 v[32:35],a[140:143],v[112:115],v[32:35]
s_add_u32 s65,s61,s50
v_mfma_f32_16x16x32_bf16 v[48:51],v[112:115],v[140:143],v[48:51]
s_add_u32 s65,s65,8192
v_mfma_f32_16x16x32_bf16 v[36:39],a[140:143],v[116:119],v[36:39]
v_mfma_f32_16x16x32_bf16 v[52:55],v[116:119],v[140:143],v[52:55]
s_waitcnt lgkmcnt(2)
v_mfma_f32_16x16x32_bf16 v[24:27],a[144:147],v[120:123],v[24:27]
ds_read_b128 v[112:115],v4 offset:8192
v_mfma_f32_16x16x32_bf16 v[40:43],v[120:123],v[144:147],v[40:43]
v_mfma_f32_16x16x32_bf16 v[28:31],a[144:147],v[124:127],v[28:31]
ds_read_b128 v[116:119],v4 offset:12288
v_mfma_f32_16x16x32_bf16 v[44:47],v[124:127],v[144:147],v[44:47]
v_mfma_f32_16x16x32_bf16 v[32:35],a[152:155],v[120:123],v[32:35]
v_mfma_f32_16x16x32_bf16 v[48:51],v[120:123],v[152:155],v[48:51]
v_mfma_f32_16x16x32_bf16 v[36:39],a[152:155],v[124:127],v[36:39]
v_mfma_f32_16x16x32_bf16 v[52:55],v[124:127],v[152:155],v[52:55]
s_waitcnt lgkmcnt(2)
v_mfma_f32_16x16x32_bf16 v[24:27],a[148:151],v[104:107],v[24:27]
ds_read_b128 v[120:123],v5 offset:8192
v_mfma_f32_16x16x32_bf16 v[40:43],v[104:107],v[148:151],v[40:43]
v_mfma_f32_16x16x32_bf16 v[28:31],a[148:151],v[108:111],v[28:31]
ds_read_b128 v[124:127],v5 offset:12288
v_mfma_f32_16x16x32_bf16 v[44:47],v[108:111],v[148:151],v[44:47]
v_mfma_f32_16x16x32_bf16 v[32:35],a[156:159],v[104:107],v[32:35]
v_mfma_f32_16x16x32_bf16 v[48:51],v[104:107],v[156:159],v[48:51]
v_mfma_f32_16x16x32_bf16 v[36:39],a[156:159],v[108:111],v[36:39]
v_mfma_f32_16x16x32_bf16 v[52:55],v[108:111],v[156:159],v[52:55]
s_waitcnt lgkmcnt(2)
v_mfma_f32_16x16x32_bf16 v[24:27],a[160:163],v[112:115],v[24:27]
ds_read_b128 v[104:107],v6 offset:8192
v_mfma_f32_16x16x32_bf16 v[40:43],v[112:115],v[160:163],v[40:43]
v_mfma_f32_16x16x32_bf16 v[28:31],a[160:163],v[116:119],v[28:31]
ds_read_b128 v[108:111],v6 offset:12288
v_mfma_f32_16x16x32_bf16 v[44:47],v[116:119],v[160:163],v[44:47]
v_mfma_f32_16x16x32_bf16 v[32:35],a[168:171],v[112:115],v[32:35]
v_mfma_f32_16x16x32_bf16 v[48:51],v[112:115],v[168:171],v[48:51]
v_mfma_f32_16x16x32_bf16 v[36:39],a[168:171],v[116:119],v[36:39]
v_mfma_f32_16x16x32_bf16 v[52:55],v[116:119],v[168:171],v[52:55]
s_waitcnt lgkmcnt(2)
v_mfma_f32_16x16x32_bf16 v[24:27],a[164:167],v[120:123],v[24:27]
ds_read_b128 v[112:115],v7 offset:8192
v_mfma_f32_16x16x32_bf16 v[40:43],v[120:123],v[164:167],v[40:43]
s_lshl_b32 s56,s54,13
v_mfma_f32_16x16x32_bf16 v[28:31],a[164:167],v[124:127],v[28:31]
ds_read_b128 v[116:119],v7 offset:12288
v_mfma_f32_16x16x32_bf16 v[44:47],v[124:127],v[164:167],v[44:47]
s_add_u32 s56,s56,10487552
v_mfma_f32_16x16x32_bf16 v[32:35],a[172:175],v[120:123],v[32:35]
s_or_b32 s56,s56,s52
v_mfma_f32_16x16x32_bf16 v[48:51],v[120:123],v[172:175],v[48:51]
buffer_load_dword v76,v23,s[8:11],s56 offen sc1
v_mfma_f32_16x16x32_bf16 v[36:39],a[172:175],v[124:127],v[36:39]
v_mfma_f32_16x16x32_bf16 v[52:55],v[124:127],v[172:175],v[52:55]
s_waitcnt lgkmcnt(2)
v_mfma_f32_16x16x32_bf16 v[24:27],a[176:179],v[104:107],v[24:27]
ds_read_b128 v[120:123],v4 offset:16384
v_mfma_f32_16x16x32_bf16 v[40:43],v[104:107],v[176:179],v[40:43]
v_mfma_f32_16x16x32_bf16 v[28:31],a[176:179],v[108:111],v[28:31]
ds_read_b128 v[124:127],v4 offset:20480
v_mfma_f32_16x16x32_bf16 v[44:47],v[108:111],v[176:179],v[44:47]
v_mfma_f32_16x16x32_bf16 v[32:35],a[184:187],v[104:107],v[32:35]
v_mfma_f32_16x16x32_bf16 v[48:51],v[104:107],v[184:187],v[48:51]
v_mfma_f32_16x16x32_bf16 v[36:39],a[184:187],v[108:111],v[36:39]
v_mfma_f32_16x16x32_bf16 v[52:55],v[108:111],v[184:187],v[52:55]
s_waitcnt lgkmcnt(2)
v_mfma_f32_16x16x32_bf16 v[24:27],a[180:183],v[112:115],v[24:27]
ds_read_b128 v[104:107],v5 offset:16384
v_mfma_f32_16x16x32_bf16 v[40:43],v[112:115],v[180:183],v[40:43]
v_mfma_f32_16x16x32_bf16 v[28:31],a[180:183],v[116:119],v[28:31]
ds_read_b128 v[108:111],v5 offset:20480
v_mfma_f32_16x16x32_bf16 v[44:47],v[116:119],v[180:183],v[44:47]
v_mfma_f32_16x16x32_bf16 v[32:35],a[188:191],v[112:115],v[32:35]
v_mfma_f32_16x16x32_bf16 v[48:51],v[112:115],v[188:191],v[48:51]
v_mfma_f32_16x16x32_bf16 v[36:39],a[188:191],v[116:119],v[36:39]
v_mfma_f32_16x16x32_bf16 v[52:55],v[116:119],v[188:191],v[52:55]
s_waitcnt lgkmcnt(2)
v_mfma_f32_16x16x32_bf16 v[24:27],a[192:195],v[120:123],v[24:27]
ds_read_b128 v[112:115],v6 offset:16384
v_mfma_f32_16x16x32_bf16 v[40:43],v[120:123],v[192:195],v[40:43]
v_mfma_f32_16x16x32_bf16 v[28:31],a[192:195],v[124:127],v[28:31]
ds_read_b128 v[116:119],v6 offset:20480
v_mfma_f32_16x16x32_bf16 v[44:47],v[124:127],v[192:195],v[44:47]
v_mfma_f32_16x16x32_bf16 v[32:35],a[200:203],v[120:123],v[32:35]
v_mfma_f32_16x16x32_bf16 v[48:51],v[120:123],v[200:203],v[48:51]
v_mfma_f32_16x16x32_bf16 v[36:39],a[200:203],v[124:127],v[36:39]
v_mfma_f32_16x16x32_bf16 v[52:55],v[124:127],v[200:203],v[52:55]
s_waitcnt lgkmcnt(2)
v_mfma_f32_16x16x32_bf16 v[24:27],a[196:199],v[104:107],v[24:27]
ds_read_b128 v[120:123],v7 offset:16384
v_mfma_f32_16x16x32_bf16 v[40:43],v[104:107],v[196:199],v[40:43]
s_waitcnt vmcnt(0)
v_mfma_f32_16x16x32_bf16 v[28:31],a[196:199],v[108:111],v[28:31]
ds_read_b128 v[124:127],v7 offset:20480
v_mfma_f32_16x16x32_bf16 v[44:47],v[108:111],v[196:199],v[44:47]
v_cmp_eq_u32 vcc,0,v76
v_mfma_f32_16x16x32_bf16 v[32:35],a[204:207],v[104:107],v[32:35]
s_nop 0
v_mov_b32 v76,vcc_lo
v_mfma_f32_16x16x32_bf16 v[48:51],v[104:107],v[204:207],v[48:51]
ds_write_b32 v19,v76
v_mfma_f32_16x16x32_bf16 v[36:39],a[204:207],v[108:111],v[36:39]
v_mfma_f32_16x16x32_bf16 v[52:55],v[108:111],v[204:207],v[52:55]
s_waitcnt vmcnt(0) lgkmcnt(0)
s_barrier
s_or_b32 s70,s70,s52
buffer_store_dword v17,off,s[8:11],s70 sc1
ds_read_b32 v76,v16
v_mfma_f32_16x16x32_bf16 v[24:27],a[208:211],v[112:115],v[24:27]
ds_read_b128 v[104:107],v4 offset:24576
v_mfma_f32_16x16x32_bf16 v[40:43],v[112:115],v[208:211],v[40:43]
s_lshl_b32 s56,s51,5
s_add_u32 s56,s56,s47
s_lshl_b32 s56,s56,12
v_mfma_f32_16x16x32_bf16 v[28:31],a[208:211],v[116:119],v[28:31]
ds_read_b128 v[108:111],v4 offset:28672
v_mfma_f32_16x16x32_bf16 v[44:47],v[116:119],v[208:211],v[44:47]
s_add_u32 s56,s56,s50
s_add_u32 s56,s56,58720256
v_mfma_f32_16x16x32_bf16 v[32:35],a[216:219],v[112:115],v[32:35]
v_mov_b64 v[72:73],-1
v_mov_b64 v[74:75],-1
v_mfma_f32_16x16x32_bf16 v[48:51],v[112:115],v[216:219],v[48:51]
buffer_store_dwordx4 v[72:75],v0,s[8:11],s56 offen sc1
v_mfma_f32_16x16x32_bf16 v[36:39],a[216:219],v[116:119],v[36:39]
s_add_u32 s56,s56,16777216
v_mfma_f32_16x16x32_bf16 v[52:55],v[116:119],v[216:219],v[52:55]
buffer_store_dwordx4 v[72:75],v0,s[8:11],s56 offen sc1
s_waitcnt lgkmcnt(2)
v_mfma_f32_16x16x32_bf16 v[24:27],a[212:215],v[120:123],v[24:27]
ds_read_b128 v[112:115],v5 offset:24576
v_mfma_f32_16x16x32_bf16 v[40:43],v[120:123],v[212:215],v[40:43]
v_readfirstlane_b32 s57,v76
v_mfma_f32_16x16x32_bf16 v[28:31],a[212:215],v[124:127],v[28:31]
ds_read_b128 v[116:119],v5 offset:28672
v_mfma_f32_16x16x32_bf16 v[44:47],v[124:127],v[212:215],v[44:47]
s_sub_u32 s59,s55,s54
s_cmp_lt_i32 s59,44
s_cselect_b32 s76,2,0
v_mfma_f32_16x16x32_bf16 v[32:35],a[220:223],v[120:123],v[32:35]
s_cmp_gt_i32 s53,0
s_cselect_b32 s76,s76,0
v_mfma_f32_16x16x32_bf16 v[48:51],v[120:123],v[220:223],v[48:51]
s_cmp_eq_u32 s57,0
s_cselect_b32 s76,1,s76
v_mfma_f32_16x16x32_bf16 v[36:39],a[220:223],v[124:127],v[36:39]
s_cmp_lt_i32 s59,12
s_cselect_b32 s76,2,s76
s_add_u32 s57,s54,64
v_mfma_f32_16x16x32_bf16 v[52:55],v[124:127],v[220:223],v[52:55]
s_cmp_eq_u32 s76,1
s_cselect_b32 s68,s57,s55
s_lshl_b32 s68,s68,15
s_waitcnt lgkmcnt(2)
v_mfma_f32_16x16x32_bf16 v[24:27],a[224:227],v[104:107],v[24:27]
ds_read_b128 v[120:123],v6 offset:24576
v_mfma_f32_16x16x32_bf16 v[40:43],v[104:107],v[224:227],v[40:43]
s_cmp_eq_u32 s76,0
s_cselect_b32 s68,0x80000000,s68
s_add_u32 s69,s68,16384
v_mfma_f32_16x16x32_bf16 v[28:31],a[224:227],v[108:111],v[28:31]
ds_read_b128 v[124:127],v6 offset:28672
v_mfma_f32_16x16x32_bf16 v[44:47],v[108:111],v[224:227],v[44:47]
s_add_u32 m0,s75,65536
v_mfma_f32_16x16x32_bf16 v[32:35],a[232:235],v[104:107],v[32:35]
buffer_load_dwordx4 v20,s[8:11],s68 offen offset:0 sc1 lds
v_mfma_f32_16x16x32_bf16 v[48:51],v[104:107],v[232:235],v[48:51]
s_add_u32 m0,s75,69632
v_mfma_f32_16x16x32_bf16 v[36:39],a[232:235],v[108:111],v[36:39]
buffer_load_dwordx4 v20,s[8:11],s69 offen offset:0 sc1 lds
v_mfma_f32_16x16x32_bf16 v[52:55],v[108:111],v[232:235],v[52:55]
s_add_u32 m0,s75,73472
s_waitcnt lgkmcnt(2)
v_mfma_f32_16x16x32_bf16 v[24:27],a[228:231],v[112:115],v[24:27]
ds_read_b128 v[104:107],v7 offset:24576
v_mfma_f32_16x16x32_bf16 v[40:43],v[112:115],v[228:231],v[40:43]
buffer_load_dwordx4 v20,s[8:11],s68 offen offset:256 sc1 lds
v_mfma_f32_16x16x32_bf16 v[28:31],a[228:231],v[116:119],v[28:31]
ds_read_b128 v[108:111],v7 offset:28672
v_mfma_f32_16x16x32_bf16 v[44:47],v[116:119],v[228:231],v[44:47]
s_add_u32 m0,s75,77568
v_mfma_f32_16x16x32_bf16 v[32:35],a[236:239],v[112:115],v[32:35]
buffer_load_dwordx4 v20,s[8:11],s69 offen offset:256 sc1 lds
v_mfma_f32_16x16x32_bf16 v[48:51],v[112:115],v[236:239],v[48:51]
s_add_u32 m0,s75,81408
v_mfma_f32_16x16x32_bf16 v[36:39],a[236:239],v[116:119],v[36:39]
buffer_load_dwordx4 v20,s[8:11],s68 offen offset:512 sc1 lds
v_mfma_f32_16x16x32_bf16 v[52:55],v[116:119],v[236:239],v[52:55]
s_add_u32 m0,s75,85504
s_waitcnt lgkmcnt(2)
v_mfma_f32_16x16x32_bf16 v[24:27],a[240:243],v[120:123],v[24:27]
ds_read_b128 v[112:115],v4 offset:0
v_mfma_f32_16x16x32_bf16 v[40:43],v[120:123],v[240:243],v[40:43]
buffer_load_dwordx4 v20,s[8:11],s69 offen offset:512 sc1 lds
v_mfma_f32_16x16x32_bf16 v[28:31],a[240:243],v[124:127],v[28:31]
ds_read_b128 v[116:119],v4 offset:4096
v_mfma_f32_16x16x32_bf16 v[44:47],v[124:127],v[240:243],v[44:47]
s_add_u32 m0,s75,89344
v_mfma_f32_16x16x32_bf16 v[32:35],a[248:251],v[120:123],v[32:35]
buffer_load_dwordx4 v20,s[8:11],s68 offen offset:768 sc1 lds
v_mfma_f32_16x16x32_bf16 v[48:51],v[120:123],v[248:251],v[48:51]
s_add_u32 m0,s75,93440
v_mfma_f32_16x16x32_bf16 v[36:39],a[248:251],v[124:127],v[36:39]
buffer_load_dwordx4 v20,s[8:11],s69 offen offset:768 sc1 lds
v_mfma_f32_16x16x32_bf16 v[52:55],v[124:127],v[248:251],v[52:55]
s_waitcnt lgkmcnt(2)
v_mfma_f32_16x16x32_bf16 v[24:27],a[244:247],v[104:107],v[24:27]
ds_read_b128 v[120:123],v5 offset:0
v_mfma_f32_16x16x32_bf16 v[40:43],v[104:107],v[244:247],v[40:43]
v_mfma_f32_16x16x32_bf16 v[28:31],a[244:247],v[108:111],v[28:31]
ds_read_b128 v[124:127],v5 offset:4096
v_mfma_f32_16x16x32_bf16 v[44:47],v[108:111],v[244:247],v[44:47]
v_mfma_f32_16x16x32_bf16 v[32:35],a[252:255],v[104:107],v[32:35]
v_mfma_f32_16x16x32_bf16 v[48:51],v[104:107],v[252:255],v[48:51]
v_mfma_f32_16x16x32_bf16 v[36:39],a[252:255],v[108:111],v[36:39]
v_mfma_f32_16x16x32_bf16 v[52:55],v[108:111],v[252:255],v[52:55]
s_waitcnt lgkmcnt(2)
v_mfma_f32_16x16x32_bf16 v[88:91],a[0:3],v[112:115],0
ds_read_b128 v[104:107],v6 offset:0
v_mfma_f32_16x16x32_bf16 v[92:95],a[0:3],v[116:119],0
v_mfma_f32_16x16x32_bf16 v[96:99],a[8:11],v[112:115],0
ds_read_b128 v[108:111],v6 offset:4096
v_cvt_pk_bf16_f32 v56,v24,v32
v_cvt_pk_bf16_f32 v57,v25,v33
v_mfma_f32_16x16x32_bf16 v[100:103],a[8:11],v[116:119],0
v_cvt_pk_bf16_f32 v58,v26,v34
v_cvt_pk_bf16_f32 v59,v27,v35
s_waitcnt lgkmcnt(2)
v_mfma_f32_16x16x32_bf16 v[88:91],a[4:7],v[120:123],v[88:91]
ds_read_b128 v[112:115],v7 offset:0
v_mfma_f32_16x16x32_bf16 v[92:95],a[4:7],v[124:127],v[92:95]
buffer_store_dwordx4 v[56:59],v0,s[8:11],s61 offen sc1
v_cvt_pk_bf16_f32 v60,v28,v36
v_cvt_pk_bf16_f32 v61,v29,v37
v_mfma_f32_16x16x32_bf16 v[96:99],a[12:15],v[120:123],v[96:99]
ds_read_b128 v[116:119],v7 offset:4096
v_cvt_pk_bf16_f32 v62,v30,v38
v_cvt_pk_bf16_f32 v63,v31,v39
v_mfma_f32_16x16x32_bf16 v[100:103],a[12:15],v[124:127],v[100:103]
buffer_store_dwordx4 v[60:63],v0,s[8:11],s62 offen sc1
v_cvt_pk_bf16_f32 v64,v40,v41
v_cvt_pk_bf16_f32 v65,v42,v43
s_waitcnt lgkmcnt(2)
v_mfma_f32_16x16x32_bf16 v[88:91],a[16:19],v[104:107],v[88:91]
ds_read_b128 v[120:123],v4 offset:8192
v_cvt_pk_bf16_f32 v66,v44,v45
v_cvt_pk_bf16_f32 v67,v46,v47
v_mfma_f32_16x16x32_bf16 v[92:95],a[16:19],v[108:111],v[92:95]
buffer_store_dwordx4 v[64:67],v0,s[8:11],s65 offen offset:0 sc1
v_cvt_pk_bf16_f32 v68,v48,v49
v_cvt_pk_bf16_f32 v69,v50,v51
v_mfma_f32_16x16x32_bf16 v[96:99],a[24:27],v[104:107],v[96:99]
ds_read_b128 v[124:127],v4 offset:12288
v_cvt_pk_bf16_f32 v70,v52,v53
v_cvt_pk_bf16_f32 v71,v54,v55
v_mfma_f32_16x16x32_bf16 v[100:103],a[24:27],v[108:111],v[100:103]
buffer_store_dwordx4 v[68:71],v0,s[8:11],s65 offen offset:1024 sc1
s_waitcnt lgkmcnt(2)
v_mfma_f32_16x16x32_bf16 v[88:91],a[20:23],v[112:115],v[88:91]
ds_read_b128 v[104:107],v5 offset:8192
v_mfma_f32_16x16x32_bf16 v[92:95],a[20:23],v[116:119],v[92:95]
v_mfma_f32_16x16x32_bf16 v[96:99],a[28:31],v[112:115],v[96:99]
ds_read_b128 v[108:111],v5 offset:12288
v_mfma_f32_16x16x32_bf16 v[100:103],a[28:31],v[116:119],v[100:103]
s_waitcnt lgkmcnt(2)
v_mfma_f32_16x16x32_bf16 v[88:91],a[32:35],v[120:123],v[88:91]
ds_read_b128 v[112:115],v6 offset:8192
v_mfma_f32_16x16x32_bf16 v[92:95],a[32:35],v[124:127],v[92:95]
v_mfma_f32_16x16x32_bf16 v[96:99],a[40:43],v[120:123],v[96:99]
ds_read_b128 v[116:119],v6 offset:12288
v_mfma_f32_16x16x32_bf16 v[100:103],a[40:43],v[124:127],v[100:103]
s_waitcnt lgkmcnt(2)
v_mfma_f32_16x16x32_bf16 v[88:91],a[36:39],v[104:107],v[88:91]
ds_read_b128 v[120:123],v7 offset:8192
v_mfma_f32_16x16x32_bf16 v[92:95],a[36:39],v[108:111],v[92:95]
s_lshl_b32 s56,s54,13
v_mfma_f32_16x16x32_bf16 v[96:99],a[44:47],v[104:107],v[96:99]
ds_read_b128 v[124:127],v7 offset:12288
v_mfma_f32_16x16x32_bf16 v[100:103],a[44:47],v[108:111],v[100:103]
s_add_u32 s56,s56,10487552
s_waitcnt lgkmcnt(2)
v_mfma_f32_16x16x32_bf16 v[88:91],a[48:51],v[112:115],v[88:91]
ds_read_b128 v[104:107],v4 offset:16384
v_mfma_f32_16x16x32_bf16 v[92:95],a[48:51],v[116:119],v[92:95]
s_or_b32 s56,s56,s52
v_mfma_f32_16x16x32_bf16 v[96:99],a[56:59],v[112:115],v[96:99]
ds_read_b128 v[108:111],v4 offset:20480
v_mfma_f32_16x16x32_bf16 v[100:103],a[56:59],v[116:119],v[100:103]
buffer_load_dword v76,v23,s[8:11],s56 offen sc1
s_waitcnt lgkmcnt(2)
v_mfma_f32_16x16x32_bf16 v[88:91],a[52:55],v[120:123],v[88:91]
ds_read_b128 v[112:115],v5 offset:16384
v_mfma_f32_16x16x32_bf16 v[92:95],a[52:55],v[124:127],v[92:95]
v_mfma_f32_16x16x32_bf16 v[96:99],a[60:63],v[120:123],v[96:99]
ds_read_b128 v[116:119],v5 offset:20480
v_mfma_f32_16x16x32_bf16 v[100:103],a[60:63],v[124:127],v[100:103]
s_waitcnt lgkmcnt(2)
v_mfma_f32_16x16x32_bf16 v[88:91],a[64:67],v[104:107],v[88:91]
ds_read_b128 v[120:123],v6 offset:16384
v_mfma_f32_16x16x32_bf16 v[92:95],a[64:67],v[108:111],v[92:95]
v_mfma_f32_16x16x32_bf16 v[96:99],a[72:75],v[104:107],v[96:99]
ds_read_b128 v[124:127],v6 offset:20480
v_mfma_f32_16x16x32_bf16 v[100:103],a[72:75],v[108:111],v[100:103]
s_waitcnt lgkmcnt(2)
v_mfma_f32_16x16x32_bf16 v[88:91],a[68:71],v[112:115],v[88:91]
ds_read_b128 v[104:107],v7 offset:16384
v_mfma_f32_16x16x32_bf16 v[92:95],a[68:71],v[116:119],v[92:95]
v_mfma_f32_16x16x32_bf16 v[96:99],a[76:79],v[112:115],v[96:99]
ds_read_b128 v[108:111],v7 offset:20480
v_mfma_f32_16x16x32_bf16 v[100:103],a[76:79],v[116:119],v[100:103]
s_waitcnt lgkmcnt(2)
v_mfma_f32_16x16x32_bf16 v[88:91],a[80:83],v[120:123],v[88:91]
ds_read_b128 v[112:115],v4 offset:24576
v_mfma_f32_16x16x32_bf16 v[92:95],a[80:83],v[124:127],v[92:95]
v_mfma_f32_16x16x32_bf16 v[96:99],a[88:91],v[120:123],v[96:99]
ds_read_b128 v[116:119],v4 offset:28672
v_mfma_f32_16x16x32_bf16 v[100:103],a[88:91],v[124:127],v[100:103]
s_waitcnt lgkmcnt(2)
v_mfma_f32_16x16x32_bf16 v[88:91],a[84:87],v[104:107],v[88:91]
ds_read_b128 v[120:123],v5 offset:24576
v_mfma_f32_16x16x32_bf16 v[92:95],a[84:87],v[108:111],v[92:95]
v_mfma_f32_16x16x32_bf16 v[96:99],a[92:95],v[104:107],v[96:99]
ds_read_b128 v[124:127],v5 offset:28672
v_mfma_f32_16x16x32_bf16 v[100:103],a[92:95],v[108:111],v[100:103]
s_waitcnt lgkmcnt(2)
v_mfma_f32_16x16x32_bf16 v[88:91],a[96:99],v[112:115],v[88:91]
ds_read_b128 v[104:107],v6 offset:24576
v_mfma_f32_16x16x32_bf16 v[92:95],a[96:99],v[116:119],v[92:95]
v_mfma_f32_16x16x32_bf16 v[96:99],a[104:107],v[112:115],v[96:99]
ds_read_b128 v[108:111],v6 offset:28672
v_mfma_f32_16x16x32_bf16 v[100:103],a[104:107],v[116:119],v[100:103]
s_waitcnt lgkmcnt(2)
v_mfma_f32_16x16x32_bf16 v[88:91],a[100:103],v[120:123],v[88:91]
ds_read_b128 v[112:115],v7 offset:24576
v_mfma_f32_16x16x32_bf16 v[92:95],a[100:103],v[124:127],v[92:95]
v_mfma_f32_16x16x32_bf16 v[96:99],a[108:111],v[120:123],v[96:99]
ds_read_b128 v[116:119],v7 offset:28672
v_mfma_f32_16x16x32_bf16 v[100:103],a[108:111],v[124:127],v[100:103]
s_waitcnt lgkmcnt(2)
v_mfma_f32_16x16x32_bf16 v[88:91],a[112:115],v[104:107],v[88:91]
v_mfma_f32_16x16x32_bf16 v[92:95],a[112:115],v[108:111],v[92:95]
v_mfma_f32_16x16x32_bf16 v[96:99],a[120:123],v[104:107],v[96:99]
v_mfma_f32_16x16x32_bf16 v[100:103],a[120:123],v[108:111],v[100:103]
s_waitcnt lgkmcnt(0)
v_mfma_f32_16x16x32_bf16 v[88:91],a[116:119],v[112:115],v[88:91]
v_mfma_f32_16x16x32_bf16 v[92:95],a[116:119],v[116:119],v[92:95]
v_mfma_f32_16x16x32_bf16 v[96:99],a[124:127],v[112:115],v[96:99]
v_mfma_f32_16x16x32_bf16 v[100:103],a[124:127],v[116:119],v[100:103]
s_nop 3
v_cvt_pk_bf16_f32 v104,v88,v96
v_cvt_pk_bf16_f32 v105,v89,v97
v_cvt_pk_bf16_f32 v106,v90,v98
v_cvt_pk_bf16_f32 v107,v91,v99
v_cvt_pk_bf16_f32 v108,v92,v100
v_cvt_pk_bf16_f32 v109,v93,v101
v_cvt_pk_bf16_f32 v110,v94,v102
v_cvt_pk_bf16_f32 v111,v95,v103
buffer_store_dwordx4 v[104:107],v0,s[8:11],s63 offen sc1
buffer_store_dwordx4 v[108:111],v0,s[8:11],s64 offen sc1
s_lshl_b32 s59,s51,13
s_lshl2_add_u32 s59,s47,s59
s_add_u32 s59,s59,10485888
s_waitcnt vmcnt(3)
s_barrier
s_or_b32 s59,s59,s52
buffer_store_dword v17,off,s[8:11],s59 sc1
s_mov_b32 s77,1
s_lshl_b32 s70,s51,13
s_lshl2_add_u32 s70,s47,s70
s_add_u32 s70,s70,10486144
s_branch L_p_15
L_p_16:
s_endpgm
L_rm_5:
v_and_b32 v33,15,v1
v_lshrrev_b32 v34,4,v1
s_min_u32 s60,s47,27
s_lshl_b32 s60,s60,7
s_mul_i32 s59,s46,458752
s_add_u32 s60,s60,s59
v_mul_u32_u24 v36,114688,v34
v_and_b32 v35,7,v33
v_lshl_add_u32 v36,v35,4,v36
v_add_u32 v36,s60,v36
v_cmp_gt_u32 vcc,8,v33
v_mov_b32 v38,s36
v_mov_b32 v39,s37
v_mov_b32 v40,s34
v_mov_b32 v41,s35
v_cndmask_b32 v38,v38,v40,vcc
v_cndmask_b32 v39,v39,v41,vcc
v_add_co_u32 v38,vcc,v38,v36
s_nop 1
v_addc_co_u32 v39,vcc,0,v39,vcc
s_lshl_b32 s56,s46,15
v_add_u32 v37,s56,v0
global_load_dwordx4 v[44:47],v[38:39],off
v_add_co_u32 v38,vcc,3584,v38
s_nop 1
v_addc_co_u32 v39,vcc,0,v39,vcc
global_load_dwordx4 v[48:51],v[38:39],off
v_add_co_u32 v38,vcc,3584,v38
s_nop 1
v_addc_co_u32 v39,vcc,0,v39,vcc
global_load_dwordx4 v[52:55],v[38:39],off
v_add_co_u32 v38,vcc,3584,v38
s_nop 1
v_addc_co_u32 v39,vcc,0,v39,vcc
global_load_dwordx4 v[56:59],v[38:39],off
v_add_co_u32 v38,vcc,3584,v38
s_nop 1
v_addc_co_u32 v39,vcc,0,v39,vcc
global_load_dwordx4 v[60:63],v[38:39],off
v_add_co_u32 v38,vcc,3584,v38
s_nop 1
v_addc_co_u32 v39,vcc,0,v39,vcc
global_load_dwordx4 v[64:67],v[38:39],off
v_add_co_u32 v38,vcc,3584,v38
s_nop 1
v_addc_co_u32 v39,vcc,0,v39,vcc
global_load_dwordx4 v[68:71],v[38:39],off
v_add_co_u32 v38,vcc,3584,v38
s_nop 1
v_addc_co_u32 v39,vcc,0,v39,vcc
global_load_dwordx4 v[72:75],v[38:39],off
v_add_co_u32 v38,vcc,3584,v38
s_nop 1
v_addc_co_u32 v39,vcc,0,v39,vcc
global_load_dwordx4 v[76:79],v[38:39],off
v_add_co_u32 v38,vcc,3584,v38
s_nop 1
v_addc_co_u32 v39,vcc,0,v39,vcc
global_load_dwordx4 v[80:83],v[38:39],off
v_add_co_u32 v38,vcc,3584,v38
s_nop 1
v_addc_co_u32 v39,vcc,0,v39,vcc
global_load_dwordx4 v[84:87],v[38:39],off
v_add_co_u32 v38,vcc,3584,v38
s_nop 1
v_addc_co_u32 v39,vcc,0,v39,vcc
global_load_dwordx4 v[88:91],v[38:39],off
v_add_co_u32 v38,vcc,3584,v38
s_nop 1
v_addc_co_u32 v39,vcc,0,v39,vcc
global_load_dwordx4 v[92:95],v[38:39],off
v_add_co_u32 v38,vcc,3584,v38
s_nop 1
v_addc_co_u32 v39,vcc,0,v39,vcc
global_load_dwordx4 v[96:99],v[38:39],off
v_add_co_u32 v38,vcc,3584,v38
s_nop 1
v_addc_co_u32 v39,vcc,0,v39,vcc
global_load_dwordx4 v[100:103],v[38:39],off
v_add_co_u32 v38,vcc,3584,v38
s_nop 1
v_addc_co_u32 v39,vcc,0,v39,vcc
global_load_dwordx4 v[104:107],v[38:39],off
v_add_co_u32 v38,vcc,3584,v38
s_nop 1
v_addc_co_u32 v39,vcc,0,v39,vcc
s_waitcnt vmcnt(15)
ds_write_b128 v37,v[44:47] offset:0
s_waitcnt vmcnt(14)
ds_write_b128 v37,v[48:51] offset:1024
s_waitcnt vmcnt(13)
ds_write_b128 v37,v[52:55] offset:2048
s_waitcnt vmcnt(12)
ds_write_b128 v37,v[56:59] offset:3072
s_waitcnt vmcnt(11)
ds_write_b128 v37,v[60:63] offset:4096
s_waitcnt vmcnt(10)
ds_write_b128 v37,v[64:67] offset:5120
s_waitcnt vmcnt(9)
ds_write_b128 v37,v[68:71] offset:6144
s_waitcnt vmcnt(8)
ds_write_b128 v37,v[72:75] offset:7168
s_waitcnt lgkmcnt(0)
s_waitcnt vmcnt(7)
ds_write_b128 v37,v[76:79] offset:8192
s_waitcnt vmcnt(6)
ds_write_b128 v37,v[80:83] offset:9216
s_waitcnt vmcnt(5)
ds_write_b128 v37,v[84:87] offset:10240
s_waitcnt vmcnt(4)
ds_write_b128 v37,v[88:91] offset:11264
s_waitcnt vmcnt(3)
ds_write_b128 v37,v[92:95] offset:12288
s_waitcnt vmcnt(2)
ds_write_b128 v37,v[96:99] offset:13312
s_waitcnt vmcnt(1)
ds_write_b128 v37,v[100:103] offset:14336
s_waitcnt vmcnt(0)
ds_write_b128 v37,v[104:107] offset:15360
s_waitcnt lgkmcnt(0)
global_load_dwordx4 v[44:47],v[38:39],off
v_add_co_u32 v38,vcc,3584,v38
s_nop 1
v_addc_co_u32 v39,vcc,0,v39,vcc
global_load_dwordx4 v[48:51],v[38:39],off
v_add_co_u32 v38,vcc,3584,v38
s_nop 1
v_addc_co_u32 v39,vcc,0,v39,vcc
global_load_dwordx4 v[52:55],v[38:39],off
v_add_co_u32 v38,vcc,3584,v38
s_nop 1
v_addc_co_u32 v39,vcc,0,v39,vcc
global_load_dwordx4 v[56:59],v[38:39],off
v_add_co_u32 v38,vcc,3584,v38
s_nop 1
v_addc_co_u32 v39,vcc,0,v39,vcc
global_load_dwordx4 v[60:63],v[38:39],off
v_add_co_u32 v38,vcc,3584,v38
s_nop 1
v_addc_co_u32 v39,vcc,0,v39,vcc
global_load_dwordx4 v[64:67],v[38:39],off
v_add_co_u32 v38,vcc,3584,v38
s_nop 1
v_addc_co_u32 v39,vcc,0,v39,vcc
global_load_dwordx4 v[68:71],v[38:39],off
v_add_co_u32 v38,vcc,3584,v38
s_nop 1
v_addc_co_u32 v39,vcc,0,v39,vcc
global_load_dwordx4 v[72:75],v[38:39],off
v_add_co_u32 v38,vcc,3584,v38
s_nop 1
v_addc_co_u32 v39,vcc,0,v39,vcc
global_load_dwordx4 v[76:79],v[38:39],off
v_add_co_u32 v38,vcc,3584,v38
s_nop 1
v_addc_co_u32 v39,vcc,0,v39,vcc
global_load_dwordx4 v[80:83],v[38:39],off
v_add_co_u32 v38,vcc,3584,v38
s_nop 1
v_addc_co_u32 v39,vcc,0,v39,vcc
global_load_dwordx4 v[84:87],v[38:39],off
v_add_co_u32 v38,vcc,3584,v38
s_nop 1
v_addc_co_u32 v39,vcc,0,v39,vcc
global_load_dwordx4 v[88:91],v[38:39],off
v_add_co_u32 v38,vcc,3584,v38
s_nop 1
v_addc_co_u32 v39,vcc,0,v39,vcc
global_load_dwordx4 v[92:95],v[38:39],off
v_add_co_u32 v38,vcc,3584,v38
s_nop 1
v_addc_co_u32 v39,vcc,0,v39,vcc
global_load_dwordx4 v[96:99],v[38:39],off
v_add_co_u32 v38,vcc,3584,v38
s_nop 1
v_addc_co_u32 v39,vcc,0,v39,vcc
global_load_dwordx4 v[100:103],v[38:39],off
v_add_co_u32 v38,vcc,3584,v38
s_nop 1
v_addc_co_u32 v39,vcc,0,v39,vcc
global_load_dwordx4 v[104:107],v[38:39],off
v_add_co_u32 v38,vcc,3584,v38
s_nop 1
v_addc_co_u32 v39,vcc,0,v39,vcc
s_waitcnt vmcnt(15)
ds_write_b128 v37,v[44:47] offset:16384
s_waitcnt vmcnt(14)
ds_write_b128 v37,v[48:51] offset:17408
s_waitcnt vmcnt(13)
ds_write_b128 v37,v[52:55] offset:18432
s_waitcnt vmcnt(12)
ds_write_b128 v37,v[56:59] offset:19456
s_waitcnt vmcnt(11)
ds_write_b128 v37,v[60:63] offset:20480
s_waitcnt vmcnt(10)
ds_write_b128 v37,v[64:67] offset:21504
s_waitcnt vmcnt(9)
ds_write_b128 v37,v[68:71] offset:22528
s_waitcnt vmcnt(8)
ds_write_b128 v37,v[72:75] offset:23552
s_waitcnt lgkmcnt(0)
s_waitcnt vmcnt(7)
ds_write_b128 v37,v[76:79] offset:24576
s_waitcnt vmcnt(6)
ds_write_b128 v37,v[80:83] offset:25600
s_waitcnt vmcnt(5)
ds_write_b128 v37,v[84:87] offset:26624
s_waitcnt vmcnt(4)
ds_write_b128 v37,v[88:91] offset:27648
s_waitcnt vmcnt(3)
ds_write_b128 v37,v[92:95] offset:28672
s_waitcnt vmcnt(2)
ds_write_b128 v37,v[96:99] offset:29696
s_waitcnt vmcnt(1)
ds_write_b128 v37,v[100:103] offset:30720
s_waitcnt vmcnt(0)
ds_write_b128 v37,v[104:107] offset:31744
s_waitcnt lgkmcnt(0)
v_mov_b32 v123,159744
s_cmp_lg_u32 s46,0
s_cbranch_scc1 L_gbd_23
v_mov_b32 v124,128
L_gb_22:
buffer_load_dword v125,v124,s[12:15],0 offen sc1
s_waitcnt vmcnt(0)
v_readfirstlane_b32 s56,v125
ds_write_b32 v123,v125
s_bitcmp1_b32 s56,8
s_cbranch_scc1 L_gbd_23
s_sleep 4
s_sub_u32 s49,s49,1
s_cmp_gt_i32 s49,0
s_cbranch_scc1 L_gb_22
s_branch L_abort
L_gbd_23:
s_waitcnt lgkmcnt(0)
s_barrier
ds_read_b32 v125,v123
s_waitcnt lgkmcnt(0)
v_readfirstlane_b32 s56,v125
s_barrier
s_lshr_b32 s56,s56,16
s_andn2_b32 s56,s56,s3
s_cbranch_scc1 L_spread
s_cmp_lg_u32 s3,0
s_cbranch_scc1 L_wm
v_and_b32 v120,15,v1
v_lshrrev_b32 v121,4,v1
v_mov_b32 v17,1
s_lshl_b32 s56,s46,15
v_add_u32 v18,s56,v0
s_lshl_b32 s56,s46,2
v_add_u32 v125,s56,v121
v_xor_b32 v126,v125,v120
v_lshlrev_b32 v126,4,v126
v_lshl_add_u32 v20,v125,10,v126
v_add_u32 v125,0,v121
v_xor_b32 v125,v125,v120
v_lshlrev_b32 v125,4,v125
v_lshl_add_u32 v125,v120,8,v125
v_add_u32 v4,131072,v125
v_add_u32 v125,4,v121
v_xor_b32 v125,v125,v120
v_lshlrev_b32 v125,4,v125
v_lshl_add_u32 v125,v120,8,v125
v_add_u32 v5,131072,v125
v_add_u32 v125,8,v121
v_xor_b32 v125,v125,v120
v_lshlrev_b32 v125,4,v125
v_lshl_add_u32 v125,v120,8,v125
v_add_u32 v6,131072,v125
v_add_u32 v125,12,v121
v_xor_b32 v125,v125,v120
v_lshlrev_b32 v125,4,v125
v_lshl_add_u32 v125,v120,8,v125
v_add_u32 v7,131072,v125
v_lshlrev_b32 v21,5,v120
v_and_b32 v125,1,v121
v_lshl_add_u32 v21,v125,4,v21
s_lshl_b32 s56,s46,9
v_lshrrev_b32 v125,1,v121
v_lshl_add_u32 v21,v125,11,v21
s_add_u32 s56,s56,155648
v_add_u32 v21,s56,v21
v_lshlrev_b32 v22,4,v120
v_lshl_add_u32 v22,v121,10,v22
s_lshl_b32 s56,s46,8
v_add_u32 v22,s56,v22
s_mov_b32 s54,0
s_mov_b32 s31,0
s_mov_b32 s53,6
s_mov_b32 s72,0x80000000
s_mov_b32 s73,0
s_mov_b32 s77,-1
s_mov_b32 s86,0
s_mov_b32 s19,0
s_mov_b32 s74,1056964608
s_mov_b32 s75,1227133513
v_and_b32 v23,15,v1
v_lshlrev_b32 v23,3,v23
v_lshrrev_b32 v16,4,v1
v_lshl_add_u32 v23,v16,13,v23
v_mov_b32 v19,159744
v_lshl_add_u32 v16,v16,2,v19
s_ff1_i32_b64 s30,s[74:75]
s_bitset0_b64 s[74:75],s30
s_min_u32 s30,s30,127
s_lshl_b32 s70,s30,15
s_add_u32 s70,s70,0
s_add_u32 s71,s70,16384
L_mo_27:
s_cmp_lg_u32 s19,0
s_cbranch_scc1 L_mo_28
s_add_u32 m0,s50,131072
s_nop 0
buffer_load_dwordx4 v20,s[8:11],s70 offen offset:0 sc1 lds
s_add_u32 m0,s50,135168
s_nop 0
buffer_load_dwordx4 v20,s[8:11],s71 offen offset:0 sc1 lds
s_add_u32 m0,s50,139008
s_nop 0
buffer_load_dwordx4 v20,s[8:11],s70 offen offset:256 sc1 lds
s_add_u32 m0,s50,143104
s_nop 0
buffer_load_dwordx4 v20,s[8:11],s71 offen offset:256 sc1 lds
s_add_u32 m0,s50,146944
s_nop 0
buffer_load_dwordx4 v20,s[8:11],s70 offen offset:512 sc1 lds
s_add_u32 m0,s50,151040
s_nop 0
buffer_load_dwordx4 v20,s[8:11],s71 offen offset:512 sc1 lds
s_mov_b32 s19,1
s_waitcnt vmcnt(0)
L_mo_28:
s_mov_b32 s51,s30
s_mov_b64 s[68:69],s[70:71]
s_ff1_i32_b64 s30,s[74:75]
s_bitset0_b64 s[74:75],s30
s_min_u32 s30,s30,127
s_lshl_b32 s70,s30,15
s_add_u32 s70,s70,0
s_add_u32 s71,s70,16384
s_lshl_b32 s76,s31,13
s_add_u32 s76,s76,10487040
s_lshl_b32 s58,s51,5
s_add_u32 s58,s58,s47
s_mul_i32 s58,s58,24576
s_add_u32 s58,s58,100663296
s_add_u32 s61,s58,s50
s_add_u32 s62,s61,4096
s_add_u32 s63,s61,16384
s_add_u32 s64,s61,20480
s_add_u32 s65,s61,s50
s_add_u32 s65,s65,8192
s_waitcnt vmcnt(12)
s_barrier
ds_read_b128 v[72:75],v4 offset:0
ds_read_b128 v[76:79],v4 offset:4096
ds_read_b128 v[80:83],v5 offset:0
ds_read_b128 v[84:87],v5 offset:4096
s_add_u32 m0,s50,154880
s_nop 0
buffer_load_dwordx4 v20,s[8:11],s68 offen offset:768 sc1 lds
s_add_u32 m0,s50,158976
s_nop 0
buffer_load_dwordx4 v20,s[8:11],s69 offen offset:768 sc1 lds
s_waitcnt lgkmcnt(2)
v_mfma_f32_16x16x32_bf16 v[40:43],a[128:131],v[72:75],0
ds_read_b128 v[108:111],v6 offset:0
v_mfma_f32_16x16x32_bf16 v[56:59],v[72:75],v[128:131],0
v_mfma_f32_16x16x32_bf16 v[24:27],a[0:3],v[72:75],0
ds_read_b128 v[112:115],v6 offset:4096
v_mfma_f32_16x16x32_bf16 v[44:47],a[128:131],v[76:79],0
v_mfma_f32_16x16x32_bf16 v[60:63],v[76:79],v[128:131],0
v_mfma_f32_16x16x32_bf16 v[28:31],a[0:3],v[76:79],0
v_mfma_f32_16x16x32_bf16 v[48:51],a[136:139],v[72:75],0
v_mfma_f32_16x16x32_bf16 v[64:67],v[72:75],v[136:139],0
v_mfma_f32_16x16x32_bf16 v[32:35],a[8:11],v[72:75],0
v_mfma_f32_16x16x32_bf16 v[52:55],a[136:139],v[76:79],0
v_mfma_f32_16x16x32_bf16 v[68:71],v[76:79],v[136:139],0
v_mfma_f32_16x16x32_bf16 v[36:39],a[8:11],v[76:79],0
s_waitcnt lgkmcnt(2)
v_mfma_f32_16x16x32_bf16 v[40:43],a[132:135],v[80:83],v[40:43]
ds_read_b128 v[72:75],v7 offset:0
v_mfma_f32_16x16x32_bf16 v[56:59],v[80:83],v[132:135],v[56:59]
v_mfma_f32_16x16x32_bf16 v[24:27],a[4:7],v[80:83],v[24:27]
ds_read_b128 v[76:79],v7 offset:4096
v_mfma_f32_16x16x32_bf16 v[44:47],a[132:135],v[84:87],v[44:47]
v_mfma_f32_16x16x32_bf16 v[60:63],v[84:87],v[132:135],v[60:63]
v_mfma_f32_16x16x32_bf16 v[28:31],a[4:7],v[84:87],v[28:31]
v_mfma_f32_16x16x32_bf16 v[48:51],a[140:143],v[80:83],v[48:51]
v_mfma_f32_16x16x32_bf16 v[64:67],v[80:83],v[140:143],v[64:67]
v_mfma_f32_16x16x32_bf16 v[32:35],a[12:15],v[80:83],v[32:35]
v_mfma_f32_16x16x32_bf16 v[52:55],a[140:143],v[84:87],v[52:55]
v_mfma_f32_16x16x32_bf16 v[68:71],v[84:87],v[140:143],v[68:71]
v_mfma_f32_16x16x32_bf16 v[36:39],a[12:15],v[84:87],v[36:39]
s_waitcnt vmcnt(12)
s_barrier
s_waitcnt lgkmcnt(2)
v_mfma_f32_16x16x32_bf16 v[40:43],a[144:147],v[108:111],v[40:43]
ds_read_b128 v[80:83],v4 offset:8192
v_mfma_f32_16x16x32_bf16 v[56:59],v[108:111],v[144:147],v[56:59]
v_mfma_f32_16x16x32_bf16 v[24:27],a[16:19],v[108:111],v[24:27]
ds_read_b128 v[84:87],v4 offset:12288
v_mfma_f32_16x16x32_bf16 v[44:47],a[144:147],v[112:115],v[44:47]
v_mfma_f32_16x16x32_bf16 v[60:63],v[112:115],v[144:147],v[60:63]
v_mfma_f32_16x16x32_bf16 v[28:31],a[16:19],v[112:115],v[28:31]
v_mfma_f32_16x16x32_bf16 v[48:51],a[152:155],v[108:111],v[48:51]
v_mfma_f32_16x16x32_bf16 v[64:67],v[108:111],v[152:155],v[64:67]
v_mfma_f32_16x16x32_bf16 v[32:35],a[24:27],v[108:111],v[32:35]
v_mfma_f32_16x16x32_bf16 v[52:55],a[152:155],v[112:115],v[52:55]
v_mfma_f32_16x16x32_bf16 v[68:71],v[112:115],v[152:155],v[68:71]
v_mfma_f32_16x16x32_bf16 v[36:39],a[24:27],v[112:115],v[36:39]
s_waitcnt lgkmcnt(2)
v_mfma_f32_16x16x32_bf16 v[40:43],a[148:151],v[72:75],v[40:43]
ds_read_b128 v[108:111],v5 offset:8192
v_mfma_f32_16x16x32_bf16 v[56:59],v[72:75],v[148:151],v[56:59]
v_mfma_f32_16x16x32_bf16 v[24:27],a[20:23],v[72:75],v[24:27]
ds_read_b128 v[112:115],v5 offset:12288
v_mfma_f32_16x16x32_bf16 v[44:47],a[148:151],v[76:79],v[44:47]
v_mfma_f32_16x16x32_bf16 v[60:63],v[76:79],v[148:151],v[60:63]
v_mfma_f32_16x16x32_bf16 v[28:31],a[20:23],v[76:79],v[28:31]
v_mfma_f32_16x16x32_bf16 v[48:51],a[156:159],v[72:75],v[48:51]
v_mfma_f32_16x16x32_bf16 v[64:67],v[72:75],v[156:159],v[64:67]
v_mfma_f32_16x16x32_bf16 v[32:35],a[28:31],v[72:75],v[32:35]
v_mfma_f32_16x16x32_bf16 v[52:55],a[156:159],v[76:79],v[52:55]
v_mfma_f32_16x16x32_bf16 v[68:71],v[76:79],v[156:159],v[68:71]
v_mfma_f32_16x16x32_bf16 v[36:39],a[28:31],v[76:79],v[36:39]
s_waitcnt lgkmcnt(2)
v_mfma_f32_16x16x32_bf16 v[40:43],a[160:163],v[80:83],v[40:43]
ds_read_b128 v[72:75],v6 offset:8192
v_mfma_f32_16x16x32_bf16 v[56:59],v[80:83],v[160:163],v[56:59]
v_mfma_f32_16x16x32_bf16 v[24:27],a[32:35],v[80:83],v[24:27]
ds_read_b128 v[76:79],v6 offset:12288
v_mfma_f32_16x16x32_bf16 v[44:47],a[160:163],v[84:87],v[44:47]
v_mfma_f32_16x16x32_bf16 v[60:63],v[84:87],v[160:163],v[60:63]
v_mfma_f32_16x16x32_bf16 v[28:31],a[32:35],v[84:87],v[28:31]
v_mfma_f32_16x16x32_bf16 v[48:51],a[168:171],v[80:83],v[48:51]
v_mfma_f32_16x16x32_bf16 v[64:67],v[80:83],v[168:171],v[64:67]
v_mfma_f32_16x16x32_bf16 v[32:35],a[40:43],v[80:83],v[32:35]
v_mfma_f32_16x16x32_bf16 v[52:55],a[168:171],v[84:87],v[52:55]
v_mfma_f32_16x16x32_bf16 v[68:71],v[84:87],v[168:171],v[68:71]
v_mfma_f32_16x16x32_bf16 v[36:39],a[40:43],v[84:87],v[36:39]
s_waitcnt lgkmcnt(2)
v_mfma_f32_16x16x32_bf16 v[40:43],a[164:167],v[108:111],v[40:43]
ds_read_b128 v[80:83],v7 offset:8192
v_mfma_f32_16x16x32_bf16 v[56:59],v[108:111],v[164:167],v[56:59]
v_mfma_f32_16x16x32_bf16 v[24:27],a[36:39],v[108:111],v[24:27]
ds_read_b128 v[84:87],v7 offset:12288
v_mfma_f32_16x16x32_bf16 v[44:47],a[164:167],v[112:115],v[44:47]
v_mfma_f32_16x16x32_bf16 v[60:63],v[112:115],v[164:167],v[60:63]
v_mfma_f32_16x16x32_bf16 v[28:31],a[36:39],v[112:115],v[28:31]
v_mfma_f32_16x16x32_bf16 v[48:51],a[172:175],v[108:111],v[48:51]
v_mfma_f32_16x16x32_bf16 v[64:67],v[108:111],v[172:175],v[64:67]
v_mfma_f32_16x16x32_bf16 v[32:35],a[44:47],v[108:111],v[32:35]
v_mfma_f32_16x16x32_bf16 v[52:55],a[172:175],v[112:115],v[52:55]
v_mfma_f32_16x16x32_bf16 v[68:71],v[112:115],v[172:175],v[68:71]
v_mfma_f32_16x16x32_bf16 v[36:39],a[44:47],v[112:115],v[36:39]
s_waitcnt vmcnt(10)
s_barrier
s_waitcnt lgkmcnt(2)
v_mfma_f32_16x16x32_bf16 v[40:43],a[176:179],v[72:75],v[40:43]
ds_read_b128 v[108:111],v4 offset:16384
v_mfma_f32_16x16x32_bf16 v[56:59],v[72:75],v[176:179],v[56:59]
v_mfma_f32_16x16x32_bf16 v[24:27],a[48:51],v[72:75],v[24:27]
ds_read_b128 v[112:115],v4 offset:20480
v_mfma_f32_16x16x32_bf16 v[44:47],a[176:179],v[76:79],v[44:47]
v_mfma_f32_16x16x32_bf16 v[60:63],v[76:79],v[176:179],v[60:63]
v_mfma_f32_16x16x32_bf16 v[28:31],a[48:51],v[76:79],v[28:31]
v_mfma_f32_16x16x32_bf16 v[48:51],a[184:187],v[72:75],v[48:51]
v_mfma_f32_16x16x32_bf16 v[64:67],v[72:75],v[184:187],v[64:67]
v_mfma_f32_16x16x32_bf16 v[32:35],a[56:59],v[72:75],v[32:35]
v_mfma_f32_16x16x32_bf16 v[52:55],a[184:187],v[76:79],v[52:55]
v_mfma_f32_16x16x32_bf16 v[68:71],v[76:79],v[184:187],v[68:71]
v_mfma_f32_16x16x32_bf16 v[36:39],a[56:59],v[76:79],v[36:39]
s_waitcnt vmcnt(2)
s_barrier
s_or_b32 s72,s72,s52
buffer_store_dword v17,off,s[8:11],s72 sc1
s_waitcnt lgkmcnt(2)
v_mfma_f32_16x16x32_bf16 v[40:43],a[180:183],v[80:83],v[40:43]
ds_read_b128 v[72:75],v5 offset:16384
v_mfma_f32_16x16x32_bf16 v[56:59],v[80:83],v[180:183],v[56:59]
v_mfma_f32_16x16x32_bf16 v[24:27],a[52:55],v[80:83],v[24:27]
ds_read_b128 v[76:79],v5 offset:20480
v_mfma_f32_16x16x32_bf16 v[44:47],a[180:183],v[84:87],v[44:47]
v_mfma_f32_16x16x32_bf16 v[60:63],v[84:87],v[180:183],v[60:63]
v_mfma_f32_16x16x32_bf16 v[28:31],a[52:55],v[84:87],v[28:31]
v_mfma_f32_16x16x32_bf16 v[48:51],a[188:191],v[80:83],v[48:51]
v_mfma_f32_16x16x32_bf16 v[64:67],v[80:83],v[188:191],v[64:67]
v_mfma_f32_16x16x32_bf16 v[32:35],a[60:63],v[80:83],v[32:35]
v_mfma_f32_16x16x32_bf16 v[52:55],a[188:191],v[84:87],v[52:55]
v_mfma_f32_16x16x32_bf16 v[68:71],v[84:87],v[188:191],v[68:71]
v_mfma_f32_16x16x32_bf16 v[36:39],a[60:63],v[84:87],v[36:39]
s_waitcnt lgkmcnt(2)
v_mfma_f32_16x16x32_bf16 v[40:43],a[192:195],v[108:111],v[40:43]
ds_read_b128 v[80:83],v6 offset:16384
v_mfma_f32_16x16x32_bf16 v[56:59],v[108:111],v[192:195],v[56:59]
v_mfma_f32_16x16x32_bf16 v[24:27],a[64:67],v[108:111],v[24:27]
ds_read_b128 v[84:87],v6 offset:20480
v_mfma_f32_16x16x32_bf16 v[44:47],a[192:195],v[112:115],v[44:47]
v_mfma_f32_16x16x32_bf16 v[60:63],v[112:115],v[192:195],v[60:63]
v_mfma_f32_16x16x32_bf16 v[28:31],a[64:67],v[112:115],v[28:31]
v_mfma_f32_16x16x32_bf16 v[48:51],a[200:203],v[108:111],v[48:51]
v_mfma_f32_16x16x32_bf16 v[64:67],v[108:111],v[200:203],v[64:67]
v_mfma_f32_16x16x32_bf16 v[32:35],a[72:75],v[108:111],v[32:35]
v_mfma_f32_16x16x32_bf16 v[52:55],a[200:203],v[112:115],v[52:55]
v_mfma_f32_16x16x32_bf16 v[68:71],v[112:115],v[200:203],v[68:71]
v_mfma_f32_16x16x32_bf16 v[36:39],a[72:75],v[112:115],v[36:39]
s_waitcnt lgkmcnt(2)
v_mfma_f32_16x16x32_bf16 v[40:43],a[196:199],v[72:75],v[40:43]
ds_read_b128 v[108:111],v7 offset:16384
v_mfma_f32_16x16x32_bf16 v[56:59],v[72:75],v[196:199],v[56:59]
v_mfma_f32_16x16x32_bf16 v[24:27],a[68:71],v[72:75],v[24:27]
ds_read_b128 v[112:115],v7 offset:20480
v_mfma_f32_16x16x32_bf16 v[44:47],a[196:199],v[76:79],v[44:47]
v_mfma_f32_16x16x32_bf16 v[60:63],v[76:79],v[196:199],v[60:63]
v_mfma_f32_16x16x32_bf16 v[28:31],a[68:71],v[76:79],v[28:31]
v_mfma_f32_16x16x32_bf16 v[48:51],a[204:207],v[72:75],v[48:51]
v_mfma_f32_16x16x32_bf16 v[64:67],v[72:75],v[204:207],v[64:67]
v_mfma_f32_16x16x32_bf16 v[32:35],a[76:79],v[72:75],v[32:35]
v_mfma_f32_16x16x32_bf16 v[52:55],a[204:207],v[76:79],v[52:55]
v_mfma_f32_16x16x32_bf16 v[68:71],v[76:79],v[204:207],v[68:71]
v_mfma_f32_16x16x32_bf16 v[36:39],a[76:79],v[76:79],v[36:39]
s_waitcnt vmcnt(1)
s_barrier
s_waitcnt lgkmcnt(2)
v_mfma_f32_16x16x32_bf16 v[40:43],a[208:211],v[80:83],v[40:43]
ds_read_b128 v[72:75],v4 offset:24576
v_mfma_f32_16x16x32_bf16 v[56:59],v[80:83],v[208:211],v[56:59]
v_mfma_f32_16x16x32_bf16 v[24:27],a[80:83],v[80:83],v[24:27]
ds_read_b128 v[76:79],v4 offset:28672
v_mfma_f32_16x16x32_bf16 v[44:47],a[208:211],v[84:87],v[44:47]
v_mfma_f32_16x16x32_bf16 v[60:63],v[84:87],v[208:211],v[60:63]
v_mfma_f32_16x16x32_bf16 v[28:31],a[80:83],v[84:87],v[28:31]
v_mfma_f32_16x16x32_bf16 v[48:51],a[216:219],v[80:83],v[48:51]
v_mfma_f32_16x16x32_bf16 v[64:67],v[80:83],v[216:219],v[64:67]
v_mfma_f32_16x16x32_bf16 v[32:35],a[88:91],v[80:83],v[32:35]
v_mfma_f32_16x16x32_bf16 v[52:55],a[216:219],v[84:87],v[52:55]
v_mfma_f32_16x16x32_bf16 v[68:71],v[84:87],v[216:219],v[68:71]
v_mfma_f32_16x16x32_bf16 v[36:39],a[88:91],v[84:87],v[36:39]
s_waitcnt lgkmcnt(2)
v_mfma_f32_16x16x32_bf16 v[40:43],a[212:215],v[108:111],v[40:43]
ds_read_b128 v[80:83],v5 offset:24576
v_mfma_f32_16x16x32_bf16 v[56:59],v[108:111],v[212:215],v[56:59]
v_mfma_f32_16x16x32_bf16 v[24:27],a[84:87],v[108:111],v[24:27]
ds_read_b128 v[84:87],v5 offset:28672
v_mfma_f32_16x16x32_bf16 v[44:47],a[212:215],v[112:115],v[44:47]
v_mfma_f32_16x16x32_bf16 v[60:63],v[112:115],v[212:215],v[60:63]
v_mfma_f32_16x16x32_bf16 v[28:31],a[84:87],v[112:115],v[28:31]
v_mfma_f32_16x16x32_bf16 v[48:51],a[220:223],v[108:111],v[48:51]
v_mfma_f32_16x16x32_bf16 v[64:67],v[108:111],v[220:223],v[64:67]
v_mfma_f32_16x16x32_bf16 v[32:35],a[92:95],v[108:111],v[32:35]
v_mfma_f32_16x16x32_bf16 v[52:55],a[220:223],v[112:115],v[52:55]
v_mfma_f32_16x16x32_bf16 v[68:71],v[112:115],v[220:223],v[68:71]
v_mfma_f32_16x16x32_bf16 v[36:39],a[92:95],v[112:115],v[36:39]
s_barrier
s_waitcnt lgkmcnt(2)
v_mfma_f32_16x16x32_bf16 v[40:43],a[224:227],v[72:75],v[40:43]
ds_read_b128 v[108:111],v6 offset:24576
v_mfma_f32_16x16x32_bf16 v[56:59],v[72:75],v[224:227],v[56:59]
s_add_u32 m0,s50,131072
v_mfma_f32_16x16x32_bf16 v[24:27],a[96:99],v[72:75],v[24:27]
ds_read_b128 v[112:115],v6 offset:28672
v_mfma_f32_16x16x32_bf16 v[44:47],a[224:227],v[76:79],v[44:47]
buffer_load_dwordx4 v20,s[8:11],s70 offen offset:0 sc1 lds
v_mfma_f32_16x16x32_bf16 v[60:63],v[76:79],v[224:227],v[60:63]
s_add_u32 m0,s50,135168
v_mfma_f32_16x16x32_bf16 v[28:31],a[96:99],v[76:79],v[28:31]
buffer_load_dwordx4 v20,s[8:11],s71 offen offset:0 sc1 lds
v_mfma_f32_16x16x32_bf16 v[48:51],a[232:235],v[72:75],v[48:51]
s_add_u32 m0,s50,139008
v_mfma_f32_16x16x32_bf16 v[64:67],v[72:75],v[232:235],v[64:67]
buffer_load_dwordx4 v20,s[8:11],s70 offen offset:256 sc1 lds
v_mfma_f32_16x16x32_bf16 v[32:35],a[104:107],v[72:75],v[32:35]
s_add_u32 m0,s50,143104
v_mfma_f32_16x16x32_bf16 v[52:55],a[232:235],v[76:79],v[52:55]
buffer_load_dwordx4 v20,s[8:11],s71 offen offset:256 sc1 lds
v_mfma_f32_16x16x32_bf16 v[68:71],v[76:79],v[232:235],v[68:71]
s_add_u32 m0,s50,146944
v_mfma_f32_16x16x32_bf16 v[36:39],a[104:107],v[76:79],v[36:39]
buffer_load_dwordx4 v20,s[8:11],s70 offen offset:512 sc1 lds
s_waitcnt lgkmcnt(2)
v_mfma_f32_16x16x32_bf16 v[40:43],a[228:231],v[80:83],v[40:43]
ds_read_b128 v[72:75],v7 offset:24576
v_mfma_f32_16x16x32_bf16 v[56:59],v[80:83],v[228:231],v[56:59]
s_add_u32 m0,s50,151040
v_mfma_f32_16x16x32_bf16 v[24:27],a[100:103],v[80:83],v[24:27]
ds_read_b128 v[76:79],v7 offset:28672
v_mfma_f32_16x16x32_bf16 v[44:47],a[228:231],v[84:87],v[44:47]
buffer_load_dwordx4 v20,s[8:11],s71 offen offset:512 sc1 lds
v_mfma_f32_16x16x32_bf16 v[60:63],v[84:87],v[228:231],v[60:63]
buffer_load_dwordx2 v[124:125],v23,s[8:11],s76 offen sc1
v_mfma_f32_16x16x32_bf16 v[28:31],a[100:103],v[84:87],v[28:31]
v_mfma_f32_16x16x32_bf16 v[48:51],a[236:239],v[80:83],v[48:51]
v_mfma_f32_16x16x32_bf16 v[64:67],v[80:83],v[236:239],v[64:67]
v_mfma_f32_16x16x32_bf16 v[32:35],a[108:111],v[80:83],v[32:35]
v_mfma_f32_16x16x32_bf16 v[52:55],a[236:239],v[84:87],v[52:55]
v_mfma_f32_16x16x32_bf16 v[68:71],v[84:87],v[236:239],v[68:71]
v_mfma_f32_16x16x32_bf16 v[36:39],a[108:111],v[84:87],v[36:39]
s_waitcnt lgkmcnt(2)
v_mfma_f32_16x16x32_bf16 v[40:43],a[240:243],v[108:111],v[40:43]
v_mfma_f32_16x16x32_bf16 v[56:59],v[108:111],v[240:243],v[56:59]
v_mfma_f32_16x16x32_bf16 v[24:27],a[112:115],v[108:111],v[24:27]
v_mfma_f32_16x16x32_bf16 v[44:47],a[240:243],v[112:115],v[44:47]
v_mfma_f32_16x16x32_bf16 v[60:63],v[112:115],v[240:243],v[60:63]
v_mfma_f32_16x16x32_bf16 v[28:31],a[112:115],v[112:115],v[28:31]
v_mfma_f32_16x16x32_bf16 v[48:51],a[248:251],v[108:111],v[48:51]
v_mfma_f32_16x16x32_bf16 v[64:67],v[108:111],v[248:251],v[64:67]
v_mfma_f32_16x16x32_bf16 v[32:35],a[120:123],v[108:111],v[32:35]
v_mfma_f32_16x16x32_bf16 v[52:55],a[248:251],v[112:115],v[52:55]
v_mfma_f32_16x16x32_bf16 v[68:71],v[112:115],v[248:251],v[68:71]
v_mfma_f32_16x16x32_bf16 v[36:39],a[120:123],v[112:115],v[36:39]
s_waitcnt lgkmcnt(0)
v_mfma_f32_16x16x32_bf16 v[40:43],a[244:247],v[72:75],v[40:43]
v_mfma_f32_16x16x32_bf16 v[56:59],v[72:75],v[244:247],v[56:59]
v_mfma_f32_16x16x32_bf16 v[24:27],a[116:119],v[72:75],v[24:27]
v_mfma_f32_16x16x32_bf16 v[44:47],a[244:247],v[76:79],v[44:47]
v_mfma_f32_16x16x32_bf16 v[60:63],v[76:79],v[244:247],v[60:63]
v_mfma_f32_16x16x32_bf16 v[28:31],a[116:119],v[76:79],v[28:31]
v_mfma_f32_16x16x32_bf16 v[48:51],a[252:255],v[72:75],v[48:51]
v_mfma_f32_16x16x32_bf16 v[64:67],v[72:75],v[252:255],v[64:67]
v_mfma_f32_16x16x32_bf16 v[32:35],a[124:127],v[72:75],v[32:35]
v_mfma_f32_16x16x32_bf16 v[52:55],a[252:255],v[76:79],v[52:55]
v_mfma_f32_16x16x32_bf16 v[68:71],v[76:79],v[252:255],v[68:71]
v_mfma_f32_16x16x32_bf16 v[36:39],a[124:127],v[76:79],v[36:39]
s_lshl_b32 s56,s51,5
s_add_u32 s56,s56,s47
s_lshl_b32 s56,s56,12
s_add_u32 s56,s56,s50
s_add_u32 s56,s56,41943040
v_mov_b64 v[120:121],-1
v_mov_b64 v[122:123],-1
buffer_store_dwordx4 v[120:123],v0,s[8:11],s56 offen sc1
v_cvt_pk_bf16_f32 v72,v40,v48
v_cvt_pk_bf16_f32 v73,v41,v49
v_cvt_pk_bf16_f32 v74,v42,v50
v_cvt_pk_bf16_f32 v75,v43,v51
buffer_store_dwordx4 v[72:75],v0,s[8:11],s61 offen sc1
v_cvt_pk_bf16_f32 v76,v44,v52
v_cvt_pk_bf16_f32 v77,v45,v53
v_cvt_pk_bf16_f32 v78,v46,v54
v_cvt_pk_bf16_f32 v79,v47,v55
buffer_store_dwordx4 v[76:79],v0,s[8:11],s62 offen sc1
v_cvt_pk_bf16_f32 v80,v56,v57
v_cvt_pk_bf16_f32 v81,v58,v59
v_cvt_pk_bf16_f32 v82,v60,v61
v_cvt_pk_bf16_f32 v83,v62,v63
buffer_store_dwordx4 v[80:83],v0,s[8:11],s65 offen offset:0 sc1
v_cvt_pk_bf16_f32 v84,v64,v65
v_cvt_pk_bf16_f32 v85,v66,v67
v_cvt_pk_bf16_f32 v86,v68,v69
v_cvt_pk_bf16_f32 v87,v70,v71
buffer_store_dwordx4 v[84:87],v0,s[8:11],s65 offen offset:1024 sc1
v_cvt_pk_bf16_f32 v108,v24,v32
v_cvt_pk_bf16_f32 v109,v25,v33
v_cvt_pk_bf16_f32 v110,v26,v34
v_cvt_pk_bf16_f32 v111,v27,v35
buffer_store_dwordx4 v[108:111],v0,s[8:11],s63 offen sc1
v_cvt_pk_bf16_f32 v112,v28,v36
v_cvt_pk_bf16_f32 v113,v29,v37
v_cvt_pk_bf16_f32 v114,v30,v38
v_cvt_pk_bf16_f32 v115,v31,v39
buffer_store_dwordx4 v[112:115],v0,s[8:11],s64 offen sc1
s_lshl_b32 s72,s51,13
s_lshl2_add_u32 s72,s47,s72
s_add_u32 s72,s72,10485760
s_sub_u32 s53,s53,1
s_cmp_gt_i32 s53,0
s_cbranch_scc1 L_mo_28
s_mov_b32 s87,3
s_mov_b32 s18,0
s_waitcnt vmcnt(7)
s_branch L_mo_33
L_mo_26:
s_mov_b32 s55,s22
s_mov_b32 s22,s23
s_mov_b32 s23,s24
s_mov_b32 s24,-1
s_cmp_lg_u32 s55,-1
s_cbranch_scc1 L_mp_24
s_sub_u32 s56,s30,s31
s_cmp_gt_i32 s77,0
s_cselect_b32 s57,6,15
s_cmp_lg_u32 s86,0
s_cselect_b32 s57,9,s57
s_cmp_lt_i32 s56,s57
s_cbranch_scc1 L_mo_27
s_cmp_lt_i32 s56,30
s_cselect_b32 s87,s18,0
s_cmp_ge_u32 s31,8
s_cselect_b32 s56,1,s18
s_and_b32 s56,s56,s86
s_cselect_b32 s87,2,s87
s_mul_i32 s56,s87,s18
s_cmp_lg_u32 s56,0
s_cbranch_scc1 L_mo_31
s_mov_b32 s18,0
s_lshr_b32 s56,s72,31
s_or_b32 s56,s56,s87
s_cbranch_scc1 L_mo_37
s_waitcnt vmcnt(0)
s_barrier
s_or_b32 s72,s72,s52
buffer_store_dword v17,off,s[8:11],s72 sc1
s_mov_b32 s72,0x80000000
L_mo_37:
s_cmp_lg_u32 s46,0
s_cbranch_scc1 L_mo_35
s_lshl_b32 s76,s31,13
s_add_u32 s76,s76,10487040
L_mo_34:
buffer_load_dwordx2 v[124:125],v23,s[8:11],s76 offen sc1
s_sub_u32 s49,s49,1
s_cbranch_scc1 L_abort
s_waitcnt vmcnt(0)
L_mo_33:
v_min_u32 v123,v124,v125
v_max_u32 v125,v124,v125
v_cmp_eq_u32 vcc,0,v123
s_nop 1
v_cndmask_b32 v125,v125,-1,vcc
s_and_b32 s56,vcc_lo,0xffff
s_cbranch_scc0 L_mo_38
s_cmp_lg_u32 s87,0
s_cbranch_scc1 L_mo_38
s_mov_b32 s18,1
s_sleep 2
s_branch L_mo_34
L_mo_38:
v_max_u32_dpp v125,v125,v125 row_ror:8 row_mask:0xf bank_mask:0xf
s_nop 1
v_max_u32_dpp v125,v125,v125 row_ror:4 row_mask:0xf bank_mask:0xf
s_nop 1
v_max_u32_dpp v125,v125,v125 row_ror:2 row_mask:0xf bank_mask:0xf
s_nop 1
v_max_u32_dpp v125,v125,v125 row_ror:1 row_mask:0xf bank_mask:0xf
L_mo_35:
s_sub_u32 s49,s49,1
s_cbranch_scc1 L_abort
v_mov_b32 v124,s18
s_barrier
s_cmp_lg_u32 s46,0
s_cbranch_scc1 L_mo_36
ds_write_b32 v16,v125
ds_write_b32 v19,v124 offset:16
s_waitcnt lgkmcnt(0)
L_mo_36:
s_barrier
ds_read_b128 v[120:123],v19
ds_read_b32 v124,v19 offset:16
s_waitcnt lgkmcnt(0)
v_readfirstlane_b32 s55,v120
v_readfirstlane_b32 s22,v121
v_readfirstlane_b32 s23,v122
v_readfirstlane_b32 s24,v123
v_readfirstlane_b32 s18,v124
s_cmp_lg_u32 s55,-1
s_cbranch_scc1 L_mp_24
L_mo_31:
s_mov_b32 s22,-1
s_cmp_eq_u32 s87,1
s_cbranch_scc1 L_mo_27
s_cmp_eq_u32 s87,2
s_cbranch_scc1 L_mo_32
s_branch L_mo_26
L_mp_24:
s_sub_u32 s73,s73,1
s_max_i32 s73,s73,0
s_sub_u32 s77,s77,1
s_min_u32 s61,s73,2
s_cmp_lt_u32 s31,5
s_cselect_b32 s61,2,s61
s_cmp_le_u32 s55,s54
s_cbranch_scc1 L_mr_25
s_mov_b32 s77,s61
s_mov_b32 s54,s55
s_mov_b32 s86,0
s_or_b32 s61,s47,s46
s_cbranch_scc1 L_mr_25
v_mov_b32 v120,s54
v_lshlrev_b32 v121,13,v1
s_mov_b32 s61,10486784
buffer_store_dword v120,v121,s[8:11],s61 offen sc1
L_mr_25:
s_cmp_lg_u32 s31,63
s_cbranch_scc1 L_mo_29
s_min_i32 s77,s77,0
s_or_b32 s61,s47,s46
s_cbranch_scc1 L_mo_29
s_mov_b32 s59,11018240
v_lshlrev_b32 v120,2,v1
L_fp_40:
s_sleep 0
buffer_load_dword v121,v120,s[8:11],s59 offen sc1
s_sub_u32 s49,s49,1
s_cbranch_scc1 L_abort
s_waitcnt vmcnt(0)
v_cmp_eq_u32 vcc,0,v121
s_cbranch_vccnz L_fp_40
s_andn2_b32 s62,0x7ff,s54
v_lshl_or_b32 v121,s62,8,v121
s_add_u32 s59,s59,8192
buffer_store_dword v121,v120,s[8:11],s59 offen sc1
s_add_u32 s59,s59,8192
buffer_store_dword v121,v120,s[8:11],s59 offen sc1
s_add_u32 s59,s59,8192
buffer_store_dword v121,v120,s[8:11],s59 offen sc1
s_add_u32 s59,s59,8192
buffer_store_dword v121,v120,s[8:11],s59 offen sc1
s_add_u32 s59,s59,8192
buffer_store_dword v121,v120,s[8:11],s59 offen sc1
s_add_u32 s59,s59,8192
buffer_store_dword v121,v120,s[8:11],s59 offen sc1
L_mo_29:
s_add_u32 s31,s31,1
s_cmp_gt_i32 s77,0
s_cmov_b32 s18,0
s_cbranch_scc1 L_mo_26
s_cmp_lg_u32 s77,0
s_cbranch_scc1 L_mo_30
s_andn2_b32 s51,0x7ff,s54
s_lshr_b32 s51,s51,5
s_add_u32 s73,s73,2
s_mov_b32 s86,1
s_mov_b32 s19,0
s_mov_b32 s18,0
s_waitcnt vmcnt(8)
s_barrier
s_and_b32 s64,s54,0x7ff
s_sub_u32 s64,2047,s64
s_lshl_b32 s56,s64,10
s_add_u32 s58,s56,4194304
buffer_load_dwordx4 v[88:91],v0,s[8:11],s58 offen sc1
s_mov_b32 s4,s38
s_mov_b32 s5,s39
s_mov_b32 s6,1835008
s_mov_b32 s7,0x20000
v_and_b32 v9,15,v1
v_lshrrev_b32 v10,4,v1
v_lshlrev_b32 v8,14,v10
v_lshl_add_u32 v8,v9,4,v8
s_lshl_b32 s59,s47,16
s_lshl_b32 s60,s46,8
s_add_u32 s59,s59,s60
buffer_load_dwordx4 v[24:27],v8,s[4:7],s59 offen offset:0
buffer_load_dwordx4 v[28:31],v8,s[4:7],s59 offen offset:1024
buffer_load_dwordx4 v[32:35],v8,s[4:7],s59 offen offset:2048
buffer_load_dwordx4 v[36:39],v8,s[4:7],s59 offen offset:3072
s_add_u32 s59,s59,4096
buffer_load_dwordx4 v[40:43],v8,s[4:7],s59 offen offset:0
buffer_load_dwordx4 v[44:47],v8,s[4:7],s59 offen offset:1024
buffer_load_dwordx4 v[48:51],v8,s[4:7],s59 offen offset:2048
buffer_load_dwordx4 v[52:55],v8,s[4:7],s59 offen offset:3072
s_add_u32 s59,s59,4096
buffer_load_dwordx4 v[56:59],v8,s[4:7],s59 offen offset:0
buffer_load_dwordx4 v[60:63],v8,s[4:7],s59 offen offset:1024
buffer_load_dwordx4 v[64:67],v8,s[4:7],s59 offen offset:2048
buffer_load_dwordx4 v[68:71],v8,s[4:7],s59 offen offset:3072
s_add_u32 s59,s59,4096
buffer_load_dwordx4 v[72:75],v8,s[4:7],s59 offen offset:0
buffer_load_dwordx4 v[76:79],v8,s[4:7],s59 offen offset:1024
buffer_load_dwordx4 v[80:83],v8,s[4:7],s59 offen offset:2048
buffer_load_dwordx4 v[84:87],v8,s[4:7],s59 offen offset:3072
v_and_b32 v124,1,v1
v_lshlrev_b32 v124,4,v124
v_mov_b32 v125,0xffff
v_lshlrev_b32 v125,v124,v125
v_lshrrev_b32 v124,1,v9
v_cmp_eq_u32 vcc,0,v124
s_nop 1
v_cndmask_b32 v12,0,v125,vcc
v_cmp_eq_u32 vcc,1,v124
s_nop 1
v_cndmask_b32 v13,0,v125,vcc
v_cmp_eq_u32 vcc,2,v124
s_nop 1
v_cndmask_b32 v14,0,v125,vcc
v_cmp_eq_u32 vcc,3,v124
s_nop 1
v_cndmask_b32 v15,0,v125,vcc
s_waitcnt vmcnt(16)
L_mx_41:
v_max3_u32 v124,v88,v89,v90
v_max_u32 v124,v91,v124
v_cmp_eq_u32 vcc,-1,v124
s_cbranch_vccz L_mxd_42
buffer_load_dwordx4 v[88:91],v0,s[8:11],s58 offen sc1
s_sub_u32 s49,s49,1
s_cbranch_scc1 L_abort
s_waitcnt vmcnt(0)
s_branch L_mx_41
L_mxd_42:
v_lshlrev_b32 v96,16,v88
v_and_b32 v97,0xffff0000,v88
v_lshlrev_b32 v98,16,v89
v_and_b32 v99,0xffff0000,v89
v_lshlrev_b32 v100,16,v90
v_and_b32 v101,0xffff0000,v90
v_lshlrev_b32 v102,16,v91
v_and_b32 v103,0xffff0000,v91
v_readfirstlane_b32 s78,v96
s_nop 1
v_pk_add_f32 v[108:109],v[96:97],s[78:79] op_sel_hi:[1,0] neg_lo:[0,1] neg_hi:[0,1]
v_pk_add_f32 v[110:111],v[98:99],s[78:79] op_sel_hi:[1,0] neg_lo:[0,1] neg_hi:[0,1]
v_pk_add_f32 v[112:113],v[100:101],s[78:79] op_sel_hi:[1,0] neg_lo:[0,1] neg_hi:[0,1]
v_pk_add_f32 v[114:115],v[102:103],s[78:79] op_sel_hi:[1,0] neg_lo:[0,1] neg_hi:[0,1]
v_pk_add_f32 v[116:117],v[108:109],v[110:111]
v_pk_mul_f32 v[118:119],v[108:109],v[108:109]
v_pk_add_f32 v[120:121],v[112:113],v[114:115]
v_pk_fma_f32 v[118:119],v[110:111],v[110:111],v[118:119]
v_pk_add_f32 v[116:117],v[116:117],v[120:121]
v_pk_fma_f32 v[118:119],v[112:113],v[112:113],v[118:119]
v_add_f32 v116,v116,v117
v_pk_fma_f32 v[118:119],v[114:115],v[114:115],v[118:119]
v_add_f32 v118,v118,v119
s_nop 1
v_permlane32_swap_b32 v116,v118
v_add_f32 v116,v116,v118
s_nop 1
v_add_f32_dpp v116,v116,v116 row_ror:8 row_mask:0xf bank_mask:0xf
s_nop 1
v_add_f32_dpp v116,v116,v116 row_ror:4 row_mask:0xf bank_mask:0xf
s_nop 1
v_add_f32_dpp v116,v116,v116 row_ror:2 row_mask:0xf bank_mask:0xf
s_nop 1
v_add_f32_dpp v116,v116,v116 row_ror:1 row_mask:0xf bank_mask:0xf
v_mov_b32 v118,v116
s_nop 1
v_permlane16_swap_b32 v116,v118
v_add_f32 v116,v116,v118
v_mul_f32 v116,0x3b000000,v116
v_mov_b32 v118,v116
s_nop 1
v_permlane32_swap_b32 v116,v118
v_fma_f32 v118,-v116,v116,v118
v_add_f32 v116,s78,v116
v_max_f32 v118,0,v118
v_cvt_pk_bf16_f32 v118,v116,v118
v_lshlrev_b32 v116,16,v118
v_and_b32 v118,0xffff0000,v118
v_add_f32 v118,0x3727c5ac,v118
v_cvt_pk_bf16_f32 v118,v118,v118
v_and_b32 v118,0xffff0000,v118
v_sqrt_f32 v118,v118
v_pk_add_f32 v[108:109],v[96:97],v[116:117] op_sel_hi:[1,0] neg_lo:[0,1] neg_hi:[0,1]
v_pk_add_f32 v[110:111],v[98:99],v[116:117] op_sel_hi:[1,0] neg_lo:[0,1] neg_hi:[0,1]
v_pk_add_f32 v[112:113],v[100:101],v[116:117] op_sel_hi:[1,0] neg_lo:[0,1] neg_hi:[0,1]
v_pk_add_f32 v[114:115],v[102:103],v[116:117] op_sel_hi:[1,0] neg_lo:[0,1] neg_hi:[0,1]
v_cvt_pk_bf16_f32 v118,v118,v118
v_and_b32 v118,0xffff0000,v118
v_rcp_f32 v118,v118
v_cvt_pk_bf16_f32 v104,v108,v109
v_cvt_pk_bf16_f32 v105,v110,v111
v_cvt_pk_bf16_f32 v106,v112,v113
v_cvt_pk_bf16_f32 v107,v114,v115
v_lshlrev_b32 v108,16,v104
v_and_b32 v109,0xffff0000,v104
v_lshlrev_b32 v110,16,v105
v_and_b32 v111,0xffff0000,v105
v_lshlrev_b32 v112,16,v106
v_and_b32 v113,0xffff0000,v106
v_lshlrev_b32 v114,16,v107
v_and_b32 v115,0xffff0000,v107
v_pk_mul_f32 v[108:109],v[108:109],v[118:119] op_sel_hi:[1,0]
v_pk_mul_f32 v[110:111],v[110:111],v[118:119] op_sel_hi:[1,0]
v_pk_mul_f32 v[112:113],v[112:113],v[118:119] op_sel_hi:[1,0]
v_pk_mul_f32 v[114:115],v[114:115],v[118:119] op_sel_hi:[1,0]
v_cvt_pk_bf16_f32 v104,v108,v109
v_cvt_pk_bf16_f32 v105,v110,v111
v_cvt_pk_bf16_f32 v106,v112,v113
v_cvt_pk_bf16_f32 v107,v114,v115
s_mov_b32 s58,0x01000100
s_mov_b32 s59,0x03020302
v_perm_b32 v88,v104,v104,s58
v_perm_b32 v89,v104,v104,s59
v_perm_b32 v90,v105,v105,s58
v_perm_b32 v91,v105,v105,s59
v_perm_b32 v92,v106,v106,s58
v_perm_b32 v93,v106,v106,s59
v_perm_b32 v94,v107,v107,s58
v_perm_b32 v95,v107,v107,s59
v_lshlrev_b32 v8,5,v1
s_lshl_b32 s58,s46,11
s_add_u32 s58,s58,139264
v_add_u32 v8,s58,v8
ds_write_b128 v8,v[88:91]
ds_write_b128 v8,v[92:95] offset:16
s_lshl_b32 s59,s46,9
s_add_u32 s59,s58,s59
v_lshlrev_b32 v8,7,v10
v_add_u32 v8,s59,v8
s_waitcnt lgkmcnt(0)
ds_read_b128 v[108:111],v18 offset:0
ds_read_b128 v[88:91],v8 offset:0
ds_read_b128 v[92:95],v8 offset:16
ds_read_b128 v[112:115],v18 offset:1024
s_waitcnt lgkmcnt(1)
v_and_b32 v124,v12,v88
v_and_b32 v125,v13,v88
v_and_b32 v126,v14,v88
v_and_b32 v127,v15,v88
s_nop 1
v_mfma_f32_16x16x32_bf16 v[116:119],v[124:127],v[108:111],0
ds_read_b128 v[108:111],v18 offset:2048
s_waitcnt lgkmcnt(1)
v_and_b32 v124,v12,v89
v_and_b32 v125,v13,v89
v_and_b32 v126,v14,v89
v_and_b32 v127,v15,v89
s_nop 1
v_mfma_f32_16x16x32_bf16 v[116:119],v[124:127],v[112:115],v[116:119]
ds_read_b128 v[112:115],v18 offset:3072
s_waitcnt lgkmcnt(1)
v_and_b32 v124,v12,v90
v_and_b32 v125,v13,v90
v_and_b32 v126,v14,v90
v_and_b32 v127,v15,v90
s_nop 1
v_mfma_f32_16x16x32_bf16 v[116:119],v[124:127],v[108:111],v[116:119]
ds_read_b128 v[108:111],v18 offset:4096
s_waitcnt lgkmcnt(1)
v_and_b32 v124,v12,v91
v_and_b32 v125,v13,v91
v_and_b32 v126,v14,v91
v_and_b32 v127,v15,v91
s_nop 1
v_mfma_f32_16x16x32_bf16 v[116:119],v[124:127],v[112:115],v[116:119]
ds_read_b128 v[112:115],v18 offset:5120
s_waitcnt lgkmcnt(1)
v_and_b32 v124,v12,v92
v_and_b32 v125,v13,v92
v_and_b32 v126,v14,v92
v_and_b32 v127,v15,v92
s_nop 1
v_mfma_f32_16x16x32_bf16 v[116:119],v[124:127],v[108:111],v[116:119]
ds_read_b128 v[108:111],v18 offset:6144
s_waitcnt lgkmcnt(1)
v_and_b32 v124,v12,v93
v_and_b32 v125,v13,v93
v_and_b32 v126,v14,v93
v_and_b32 v127,v15,v93
s_nop 1
v_mfma_f32_16x16x32_bf16 v[116:119],v[124:127],v[112:115],v[116:119]
ds_read_b128 v[112:115],v18 offset:7168
s_waitcnt lgkmcnt(1)
v_and_b32 v124,v12,v94
v_and_b32 v125,v13,v94
v_and_b32 v126,v14,v94
v_and_b32 v127,v15,v94
s_nop 1
v_mfma_f32_16x16x32_bf16 v[116:119],v[124:127],v[108:111],v[116:119]
ds_read_b128 v[108:111],v18 offset:8192
s_waitcnt lgkmcnt(1)
v_and_b32 v124,v12,v95
v_and_b32 v125,v13,v95
v_and_b32 v126,v14,v95
v_and_b32 v127,v15,v95
s_nop 1
v_mfma_f32_16x16x32_bf16 v[116:119],v[124:127],v[112:115],v[116:119]
ds_read_b128 v[88:91],v8 offset:32
ds_read_b128 v[92:95],v8 offset:48
ds_read_b128 v[112:115],v18 offset:9216
s_waitcnt lgkmcnt(1)
v_and_b32 v124,v12,v88
v_and_b32 v125,v13,v88
v_and_b32 v126,v14,v88
v_and_b32 v127,v15,v88
s_nop 1
v_mfma_f32_16x16x32_bf16 v[116:119],v[124:127],v[108:111],v[116:119]
ds_read_b128 v[108:111],v18 offset:10240
s_waitcnt lgkmcnt(1)
v_and_b32 v124,v12,v89
v_and_b32 v125,v13,v89
v_and_b32 v126,v14,v89
v_and_b32 v127,v15,v89
s_nop 1
v_mfma_f32_16x16x32_bf16 v[116:119],v[124:127],v[112:115],v[116:119]
ds_read_b128 v[112:115],v18 offset:11264
s_waitcnt lgkmcnt(1)
v_and_b32 v124,v12,v90
v_and_b32 v125,v13,v90
v_and_b32 v126,v14,v90
v_and_b32 v127,v15,v90
s_nop 1
v_mfma_f32_16x16x32_bf16 v[116:119],v[124:127],v[108:111],v[116:119]
ds_read_b128 v[108:111],v18 offset:12288
s_waitcnt lgkmcnt(1)
v_and_b32 v124,v12,v91
v_and_b32 v125,v13,v91
v_and_b32 v126,v14,v91
v_and_b32 v127,v15,v91
s_nop 1
v_mfma_f32_16x16x32_bf16 v[116:119],v[124:127],v[112:115],v[116:119]
ds_read_b128 v[112:115],v18 offset:13312
s_waitcnt lgkmcnt(1)
v_and_b32 v124,v12,v92
v_and_b32 v125,v13,v92
v_and_b32 v126,v14,v92
v_and_b32 v127,v15,v92
s_nop 1
v_mfma_f32_16x16x32_bf16 v[116:119],v[124:127],v[108:111],v[116:119]
ds_read_b128 v[108:111],v18 offset:14336
s_waitcnt lgkmcnt(1)
v_and_b32 v124,v12,v93
v_and_b32 v125,v13,v93
v_and_b32 v126,v14,v93
v_and_b32 v127,v15,v93
s_nop 1
v_mfma_f32_16x16x32_bf16 v[116:119],v[124:127],v[112:115],v[116:119]
ds_read_b128 v[112:115],v18 offset:15360
s_waitcnt lgkmcnt(1)
v_and_b32 v124,v12,v94
v_and_b32 v125,v13,v94
v_and_b32 v126,v14,v94
v_and_b32 v127,v15,v94
s_nop 1
v_mfma_f32_16x16x32_bf16 v[116:119],v[124:127],v[108:111],v[116:119]
ds_read_b128 v[108:111],v18 offset:16384
s_waitcnt lgkmcnt(1)
v_and_b32 v124,v12,v95
v_and_b32 v125,v13,v95
v_and_b32 v126,v14,v95
v_and_b32 v127,v15,v95
s_nop 1
v_mfma_f32_16x16x32_bf16 v[116:119],v[124:127],v[112:115],v[116:119]
ds_read_b128 v[88:91],v8 offset:64
ds_read_b128 v[92:95],v8 offset:80
ds_read_b128 v[112:115],v18 offset:17408
s_waitcnt lgkmcnt(1)
v_and_b32 v124,v12,v88
v_and_b32 v125,v13,v88
v_and_b32 v126,v14,v88
v_and_b32 v127,v15,v88
s_nop 1
v_mfma_f32_16x16x32_bf16 v[116:119],v[124:127],v[108:111],v[116:119]
ds_read_b128 v[108:111],v18 offset:18432
s_waitcnt lgkmcnt(1)
v_and_b32 v124,v12,v89
v_and_b32 v125,v13,v89
v_and_b32 v126,v14,v89
v_and_b32 v127,v15,v89
s_nop 1
v_mfma_f32_16x16x32_bf16 v[116:119],v[124:127],v[112:115],v[116:119]
ds_read_b128 v[112:115],v18 offset:19456
s_waitcnt lgkmcnt(1)
v_and_b32 v124,v12,v90
v_and_b32 v125,v13,v90
v_and_b32 v126,v14,v90
v_and_b32 v127,v15,v90
s_nop 1
v_mfma_f32_16x16x32_bf16 v[116:119],v[124:127],v[108:111],v[116:119]
ds_read_b128 v[108:111],v18 offset:20480
s_waitcnt lgkmcnt(1)
v_and_b32 v124,v12,v91
v_and_b32 v125,v13,v91
v_and_b32 v126,v14,v91
v_and_b32 v127,v15,v91
s_nop 1
v_mfma_f32_16x16x32_bf16 v[116:119],v[124:127],v[112:115],v[116:119]
ds_read_b128 v[112:115],v18 offset:21504
s_waitcnt lgkmcnt(1)
v_and_b32 v124,v12,v92
v_and_b32 v125,v13,v92
v_and_b32 v126,v14,v92
v_and_b32 v127,v15,v92
s_nop 1
v_mfma_f32_16x16x32_bf16 v[116:119],v[124:127],v[108:111],v[116:119]
ds_read_b128 v[108:111],v18 offset:22528
s_waitcnt lgkmcnt(1)
v_and_b32 v124,v12,v93
v_and_b32 v125,v13,v93
v_and_b32 v126,v14,v93
v_and_b32 v127,v15,v93
s_nop 1
v_mfma_f32_16x16x32_bf16 v[116:119],v[124:127],v[112:115],v[116:119]
ds_read_b128 v[112:115],v18 offset:23552
s_waitcnt lgkmcnt(1)
v_and_b32 v124,v12,v94
v_and_b32 v125,v13,v94
v_and_b32 v126,v14,v94
v_and_b32 v127,v15,v94
s_nop 1
v_mfma_f32_16x16x32_bf16 v[116:119],v[124:127],v[108:111],v[116:119]
ds_read_b128 v[108:111],v18 offset:24576
s_waitcnt lgkmcnt(1)
v_and_b32 v124,v12,v95
v_and_b32 v125,v13,v95
v_and_b32 v126,v14,v95
v_and_b32 v127,v15,v95
s_nop 1
v_mfma_f32_16x16x32_bf16 v[116:119],v[124:127],v[112:115],v[116:119]
ds_read_b128 v[88:91],v8 offset:96
ds_read_b128 v[92:95],v8 offset:112
ds_read_b128 v[112:115],v18 offset:25600
s_waitcnt lgkmcnt(1)
v_and_b32 v124,v12,v88
v_and_b32 v125,v13,v88
v_and_b32 v126,v14,v88
v_and_b32 v127,v15,v88
s_nop 1
v_mfma_f32_16x16x32_bf16 v[116:119],v[124:127],v[108:111],v[116:119]
ds_read_b128 v[108:111],v18 offset:26624
s_waitcnt lgkmcnt(1)
v_and_b32 v124,v12,v89
v_and_b32 v125,v13,v89
v_and_b32 v126,v14,v89
v_and_b32 v127,v15,v89
s_nop 1
v_mfma_f32_16x16x32_bf16 v[116:119],v[124:127],v[112:115],v[116:119]
ds_read_b128 v[112:115],v18 offset:27648
s_waitcnt lgkmcnt(1)
v_and_b32 v124,v12,v90
v_and_b32 v125,v13,v90
v_and_b32 v126,v14,v90
v_and_b32 v127,v15,v90
s_nop 1
v_mfma_f32_16x16x32_bf16 v[116:119],v[124:127],v[108:111],v[116:119]
ds_read_b128 v[108:111],v18 offset:28672
s_waitcnt lgkmcnt(1)
v_and_b32 v124,v12,v91
v_and_b32 v125,v13,v91
v_and_b32 v126,v14,v91
v_and_b32 v127,v15,v91
s_nop 1
v_mfma_f32_16x16x32_bf16 v[116:119],v[124:127],v[112:115],v[116:119]
ds_read_b128 v[112:115],v18 offset:29696
s_waitcnt lgkmcnt(1)
v_and_b32 v124,v12,v92
v_and_b32 v125,v13,v92
v_and_b32 v126,v14,v92
v_and_b32 v127,v15,v92
s_nop 1
v_mfma_f32_16x16x32_bf16 v[116:119],v[124:127],v[108:111],v[116:119]
ds_read_b128 v[108:111],v18 offset:30720
s_waitcnt lgkmcnt(1)
v_and_b32 v124,v12,v93
v_and_b32 v125,v13,v93
v_and_b32 v126,v14,v93
v_and_b32 v127,v15,v93
s_nop 1
v_mfma_f32_16x16x32_bf16 v[116:119],v[124:127],v[112:115],v[116:119]
ds_read_b128 v[112:115],v18 offset:31744
s_waitcnt lgkmcnt(1)
v_and_b32 v124,v12,v94
v_and_b32 v125,v13,v94
v_and_b32 v126,v14,v94
v_and_b32 v127,v15,v94
s_nop 1
v_mfma_f32_16x16x32_bf16 v[116:119],v[124:127],v[108:111],v[116:119]
s_waitcnt lgkmcnt(0)
v_and_b32 v124,v12,v95
v_and_b32 v125,v13,v95
v_and_b32 v126,v14,v95
v_and_b32 v127,v15,v95
s_nop 1
v_mfma_f32_16x16x32_bf16 v[116:119],v[124:127],v[112:115],v[116:119]
v_lshlrev_b32 v8,5,v9
v_and_b32 v124,1,v10
v_lshl_add_u32 v8,v124,4,v8
v_lshrrev_b32 v124,1,v10
v_lshl_add_u32 v8,v124,11,v8
s_lshl_b32 s60,s46,9
s_add_u32 s60,s60,147456
v_add_u32 v8,s60,v8
ds_write_b128 v8,v[116:119]
v_lshlrev_b32 v8,2,v1
v_add_u32 v8,147456,v8
s_waitcnt lgkmcnt(0)
s_barrier
ds_read2st64_b32 v[88:89],v8 offset0:0 offset1:1
ds_read2st64_b32 v[90:91],v8 offset0:2 offset1:3
ds_read2st64_b32 v[92:93],v8 offset0:4 offset1:5
ds_read2st64_b32 v[94:95],v8 offset0:6 offset1:7
s_waitcnt lgkmcnt(0)
v_pk_add_f32 v[88:89],v[88:89],v[90:91]
v_pk_add_f32 v[92:93],v[92:93],v[94:95]
v_pk_add_f32 v[88:89],v[88:89],v[92:93]
v_cvt_pk_bf16_f32 v88,v88,v88
v_and_b32 v88,0xffff0000,v88
v_cvt_pk_bf16_f32 v89,v89,v89
v_and_b32 v89,0xffff0000,v89
v_mul_f32 v90,0xbfb8aa3b,v88
v_exp_f32 v90,v90
s_nop 0
v_add_f32 v90,1.0,v90
v_rcp_f32 v90,v90
s_nop 0
v_mul_f32 v88,v88,v90
v_cvt_pk_bf16_f32 v88,v88,v88
v_and_b32 v88,0xffff0000,v88
v_mul_f32 v88,v88,v89
v_cvt_pk_bf16_f32 v88,v88,v88
v_lshlrev_b32 v8,2,v1
v_add_u32 v8,s58,v8
ds_write_b32 v8,v88
v_lshlrev_b32 v8,6,v10
v_add_u32 v8,s58,v8
s_waitcnt lgkmcnt(0)
ds_read_b128 v[88:91],v8
ds_read_b128 v[92:95],v8 offset:16
ds_read_b128 v[108:111],v8 offset:32
ds_read_b128 v[112:115],v8 offset:48
s_waitcnt vmcnt(0) lgkmcnt(0)
v_and_b32 v124,v12,v88
v_and_b32 v125,v13,v88
v_and_b32 v126,v14,v88
v_and_b32 v127,v15,v88
s_nop 1
v_mfma_f32_16x16x32_bf16 v[116:119],v[124:127],v[24:27],0
v_and_b32 v124,v12,v89
v_and_b32 v125,v13,v89
v_and_b32 v126,v14,v89
v_and_b32 v127,v15,v89
s_nop 1
v_mfma_f32_16x16x32_bf16 v[116:119],v[124:127],v[28:31],v[116:119]
v_and_b32 v124,v12,v90
v_and_b32 v125,v13,v90
v_and_b32 v126,v14,v90
v_and_b32 v127,v15,v90
s_nop 1
v_mfma_f32_16x16x32_bf16 v[116:119],v[124:127],v[32:35],v[116:119]
v_and_b32 v124,v12,v91
v_and_b32 v125,v13,v91
v_and_b32 v126,v14,v91
v_and_b32 v127,v15,v91
s_nop 1
v_mfma_f32_16x16x32_bf16 v[116:119],v[124:127],v[36:39],v[116:119]
v_and_b32 v124,v12,v92
v_and_b32 v125,v13,v92
v_and_b32 v126,v14,v92
v_and_b32 v127,v15,v92
s_nop 1
v_mfma_f32_16x16x32_bf16 v[116:119],v[124:127],v[40:43],v[116:119]
v_and_b32 v124,v12,v93
v_and_b32 v125,v13,v93
v_and_b32 v126,v14,v93
v_and_b32 v127,v15,v93
s_nop 1
v_mfma_f32_16x16x32_bf16 v[116:119],v[124:127],v[44:47],v[116:119]
v_and_b32 v124,v12,v94
v_and_b32 v125,v13,v94
v_and_b32 v126,v14,v94
v_and_b32 v127,v15,v94
s_nop 1
v_mfma_f32_16x16x32_bf16 v[116:119],v[124:127],v[48:51],v[116:119]
v_and_b32 v124,v12,v95
v_and_b32 v125,v13,v95
v_and_b32 v126,v14,v95
v_and_b32 v127,v15,v95
s_nop 1
v_mfma_f32_16x16x32_bf16 v[116:119],v[124:127],v[52:55],v[116:119]
v_and_b32 v124,v12,v108
v_and_b32 v125,v13,v108
v_and_b32 v126,v14,v108
v_and_b32 v127,v15,v108
s_nop 1
v_mfma_f32_16x16x32_bf16 v[116:119],v[124:127],v[56:59],v[116:119]
v_and_b32 v124,v12,v109
v_and_b32 v125,v13,v109
v_and_b32 v126,v14,v109
v_and_b32 v127,v15,v109
s_nop 1
v_mfma_f32_16x16x32_bf16 v[116:119],v[124:127],v[60:63],v[116:119]
v_and_b32 v124,v12,v110
v_and_b32 v125,v13,v110
v_and_b32 v126,v14,v110
v_and_b32 v127,v15,v110
s_nop 1
v_mfma_f32_16x16x32_bf16 v[116:119],v[124:127],v[64:67],v[116:119]
v_and_b32 v124,v12,v111
v_and_b32 v125,v13,v111
v_and_b32 v126,v14,v111
v_and_b32 v127,v15,v111
s_nop 1
v_mfma_f32_16x16x32_bf16 v[116:119],v[124:127],v[68:71],v[116:119]
v_and_b32 v124,v12,v112
v_and_b32 v125,v13,v112
v_and_b32 v126,v14,v112
v_and_b32 v127,v15,v112
s_nop 1
v_mfma_f32_16x16x32_bf16 v[116:119],v[124:127],v[72:75],v[116:119]
v_and_b32 v124,v12,v113
v_and_b32 v125,v13,v113
v_and_b32 v126,v14,v113
v_and_b32 v127,v15,v113
s_nop 1
v_mfma_f32_16x16x32_bf16 v[116:119],v[124:127],v[76:79],v[116:119]
v_and_b32 v124,v12,v114
v_and_b32 v125,v13,v114
v_and_b32 v126,v14,v114
v_and_b32 v127,v15,v114
s_nop 1
v_mfma_f32_16x16x32_bf16 v[116:119],v[124:127],v[80:83],v[116:119]
v_and_b32 v124,v12,v115
v_and_b32 v125,v13,v115
v_and_b32 v126,v14,v115
v_and_b32 v127,v15,v115
s_nop 1
v_mfma_f32_16x16x32_bf16 v[116:119],v[124:127],v[84:87],v[116:119]
v_lshlrev_b32 v8,4,v9
v_and_b32 v124,1,v10
v_lshl_add_u32 v8,v124,3,v8
v_and_b32 v124,2,v10
v_lshl_add_u32 v8,v124,30,v8
s_lshl_b32 s65,s51,15
s_add_u32 s65,s65,92274688
s_lshl_b32 s59,s47,10
s_lshl_b32 s60,s46,8
s_add_u32 s59,s59,s60
s_add_u32 s59,s59,s65
v_cvt_pk_bf16_f32 v24,v116,v117
v_cvt_pk_bf16_f32 v25,v118,v119
buffer_store_dwordx2 v[24:25],v8,s[8:11],s59 offen
s_lshl_b32 s59,s51,13
s_lshl2_add_u32 s59,s47,s59
s_add_u32 s59,s59,10486912
s_waitcnt vmcnt(0)
s_barrier
s_or_b32 s59,s59,s52
buffer_store_dword v17,off,s[8:11],s59
s_lshl_b32 s59,s51,13
s_add_u32 s59,s59,10486912
v_and_b32 v124,31,v1
v_lshlrev_b32 v124,2,v124
L_fw_44:
buffer_load_dword v125,v124,s[8:11],s59 offen sc1
s_sub_u32 s49,s49,1
s_cbranch_scc1 L_abort
s_waitcnt vmcnt(0)
v_cmp_eq_u32 vcc,0,v125
s_cbranch_vccnz L_fw_44
s_add_u32 s63,s65,0
buffer_load_dwordx4 v[24:27],v22,s[8:11],s63 offen sc1
s_add_u32 s63,s65,4096
buffer_load_dwordx4 v[28:31],v22,s[8:11],s63 offen sc1
s_add_u32 s63,s65,8192
buffer_load_dwordx4 v[32:35],v22,s[8:11],s63 offen sc1
s_add_u32 s63,s65,12288
buffer_load_dwordx4 v[36:39],v22,s[8:11],s63 offen sc1
s_add_u32 s63,s65,16384
buffer_load_dwordx4 v[40:43],v22,s[8:11],s63 offen sc1
s_add_u32 s63,s65,20480
buffer_load_dwordx4 v[44:47],v22,s[8:11],s63 offen sc1
s_add_u32 s63,s65,24576
buffer_load_dwordx4 v[48:51],v22,s[8:11],s63 offen sc1
s_add_u32 s63,s65,28672
buffer_load_dwordx4 v[52:55],v22,s[8:11],s63 offen sc1
v_and_b32 v64,15,v1
v_and_b32 v65,1,v1
v_lshlrev_b32 v65,4,v65
v_mov_b32 v66,0x3f80
v_lshlrev_b32 v66,v65,v66
v_lshrrev_b32 v64,1,v64
v_cmp_eq_u32 vcc,0,v64
s_nop 1
v_cndmask_b32 v56,0,v66,vcc
v_cmp_eq_u32 vcc,1,v64
s_nop 1
v_cndmask_b32 v57,0,v66,vcc
v_cmp_eq_u32 vcc,2,v64
s_nop 1
v_cndmask_b32 v58,0,v66,vcc
v_cmp_eq_u32 vcc,3,v64
s_nop 1
v_cndmask_b32 v59,0,v66,vcc
s_waitcnt vmcnt(7)
s_nop 0
v_mfma_f32_16x16x32_bf16 v[60:63],v[56:59],v[24:27],0
s_waitcnt vmcnt(6)
v_mfma_f32_16x16x32_bf16 v[60:63],v[56:59],v[28:31],v[60:63]
s_waitcnt vmcnt(5)
v_mfma_f32_16x16x32_bf16 v[60:63],v[56:59],v[32:35],v[60:63]
s_waitcnt vmcnt(4)
v_mfma_f32_16x16x32_bf16 v[60:63],v[56:59],v[36:39],v[60:63]
s_waitcnt vmcnt(3)
v_mfma_f32_16x16x32_bf16 v[60:63],v[56:59],v[40:43],v[60:63]
s_waitcnt vmcnt(2)
v_mfma_f32_16x16x32_bf16 v[60:63],v[56:59],v[44:47],v[60:63]
s_waitcnt vmcnt(1)
v_mfma_f32_16x16x32_bf16 v[60:63],v[56:59],v[48:51],v[60:63]
s_waitcnt vmcnt(0)
v_mfma_f32_16x16x32_bf16 v[60:63],v[56:59],v[52:55],v[60:63]
s_nop 7
ds_write_b128 v21,v[60:63]
s_waitcnt lgkmcnt(0)
s_barrier
s_cmp_lg_u32 s46,0
s_cbranch_scc1 L_moed_43
v_lshlrev_b32 v56,5,v1
v_add_u32 v56,155648,v56
ds_read_b128 v[24:27],v56
ds_read_b128 v[28:31],v56 offset:16
s_and_b32 s59,s54,0xffff0000
s_xor_b32 s60,s59,0x80000000
s_xor_b32 s61,s59,0xffff0000
s_cmp_lt_i32 s59,0
s_cselect_b32 s59,s60,s61
v_mov_b32 v56,s59
v_mul_f32 v56,0xbfb8aa3b,v56
v_exp_f32 v56,v56
s_nop 0
v_add_f32 v56,1.0,v56
v_rcp_f32 v56,v56
s_nop 0
v_cvt_pk_bf16_f32 v56,v56,v56
v_and_b32 v56,0xffff0000,v56
v_lshlrev_b32 v48,16,v104
v_and_b32 v49,0xffff0000,v104
v_lshlrev_b32 v50,16,v105
v_and_b32 v51,0xffff0000,v105
v_lshlrev_b32 v52,16,v106
v_and_b32 v53,0xffff0000,v106
v_lshlrev_b32 v54,16,v107
v_and_b32 v55,0xffff0000,v107
s_waitcnt lgkmcnt(0)
v_cvt_pk_bf16_f32 v40,v24,v25
v_cvt_pk_bf16_f32 v41,v26,v27
v_cvt_pk_bf16_f32 v42,v28,v29
v_cvt_pk_bf16_f32 v43,v30,v31
v_lshlrev_b32 v24,16,v40
v_and_b32 v25,0xffff0000,v40
v_lshlrev_b32 v26,16,v41
v_and_b32 v27,0xffff0000,v41
v_lshlrev_b32 v28,16,v42
v_and_b32 v29,0xffff0000,v42
v_lshlrev_b32 v30,16,v43
v_and_b32 v31,0xffff0000,v43
v_mul_f32 v24,v24,v56
v_mul_f32 v25,v25,v56
v_mul_f32 v26,v26,v56
v_mul_f32 v27,v27,v56
v_mul_f32 v28,v28,v56
v_mul_f32 v29,v29,v56
v_mul_f32 v30,v30,v56
v_mul_f32 v31,v31,v56
v_cvt_pk_bf16_f32 v40,v24,v25
v_cvt_pk_bf16_f32 v41,v26,v27
v_cvt_pk_bf16_f32 v42,v28,v29
v_cvt_pk_bf16_f32 v43,v30,v31
v_lshlrev_b32 v24,16,v40
v_and_b32 v25,0xffff0000,v40
v_lshlrev_b32 v26,16,v41
v_and_b32 v27,0xffff0000,v41
v_lshlrev_b32 v28,16,v42
v_and_b32 v29,0xffff0000,v42
v_lshlrev_b32 v30,16,v43
v_and_b32 v31,0xffff0000,v43
v_add_f32 v24,v24,v48
v_add_f32 v25,v25,v49
v_add_f32 v26,v26,v50
v_add_f32 v27,v27,v51
v_add_f32 v28,v28,v52
v_add_f32 v29,v29,v53
v_add_f32 v30,v30,v54
v_add_f32 v31,v31,v55
v_cvt_pk_bf16_f32 v40,v24,v25
v_cvt_pk_bf16_f32 v41,v26,v27
v_cvt_pk_bf16_f32 v42,v28,v29
v_cvt_pk_bf16_f32 v43,v30,v31
v_lshlrev_b32 v24,16,v40
v_and_b32 v25,0xffff0000,v40
v_lshlrev_b32 v26,16,v41
v_and_b32 v27,0xffff0000,v41
v_lshlrev_b32 v28,16,v42
v_and_b32 v29,0xffff0000,v42
v_lshlrev_b32 v30,16,v43
v_and_b32 v31,0xffff0000,v43
v_add_f32 v96,v96,v24
v_add_f32 v97,v97,v25
v_add_f32 v98,v98,v26
v_add_f32 v99,v99,v27
v_add_f32 v100,v100,v28
v_add_f32 v101,v101,v29
v_add_f32 v102,v102,v30
v_add_f32 v103,v103,v31
v_cvt_pk_bf16_f32 v80,v96,v97
v_cvt_pk_bf16_f32 v81,v98,v99
v_cvt_pk_bf16_f32 v82,v100,v101
v_cvt_pk_bf16_f32 v83,v102,v103
v_lshlrev_b32 v96,16,v80
v_and_b32 v97,0xffff0000,v80
v_lshlrev_b32 v98,16,v81
v_and_b32 v99,0xffff0000,v81
v_lshlrev_b32 v100,16,v82
v_and_b32 v101,0xffff0000,v82
v_lshlrev_b32 v102,16,v83
v_and_b32 v103,0xffff0000,v83
v_readfirstlane_b32 s78,v96
s_nop 1
v_pk_add_f32 v[58:59],v[96:97],s[78:79] op_sel_hi:[1,0] neg_lo:[0,1] neg_hi:[0,1]
v_pk_add_f32 v[60:61],v[98:99],s[78:79] op_sel_hi:[1,0] neg_lo:[0,1] neg_hi:[0,1]
v_pk_add_f32 v[62:63],v[100:101],s[78:79] op_sel_hi:[1,0] neg_lo:[0,1] neg_hi:[0,1]
v_pk_add_f32 v[64:65],v[102:103],s[78:79] op_sel_hi:[1,0] neg_lo:[0,1] neg_hi:[0,1]
v_pk_add_f32 v[66:67],v[58:59],v[60:61]
v_pk_mul_f32 v[68:69],v[58:59],v[58:59]
v_pk_add_f32 v[70:71],v[62:63],v[64:65]
v_pk_fma_f32 v[68:69],v[60:61],v[60:61],v[68:69]
v_pk_add_f32 v[66:67],v[66:67],v[70:71]
v_pk_fma_f32 v[68:69],v[62:63],v[62:63],v[68:69]
v_add_f32 v66,v66,v67
v_pk_fma_f32 v[68:69],v[64:65],v[64:65],v[68:69]
v_add_f32 v68,v68,v69
s_nop 1
v_permlane32_swap_b32 v66,v68
v_add_f32 v66,v66,v68
s_nop 1
v_add_f32_dpp v66,v66,v66 row_ror:8 row_mask:0xf bank_mask:0xf
s_nop 1
v_add_f32_dpp v66,v66,v66 row_ror:4 row_mask:0xf bank_mask:0xf
s_nop 1
v_add_f32_dpp v66,v66,v66 row_ror:2 row_mask:0xf bank_mask:0xf
s_nop 1
v_add_f32_dpp v66,v66,v66 row_ror:1 row_mask:0xf bank_mask:0xf
v_mov_b32 v68,v66
s_nop 1
v_permlane16_swap_b32 v66,v68
v_add_f32 v66,v66,v68
v_mul_f32 v66,0x3b000000,v66
v_mov_b32 v68,v66
s_nop 1
v_permlane32_swap_b32 v66,v68
v_fma_f32 v68,-v66,v66,v68
v_add_f32 v66,s78,v66
v_max_f32 v68,0,v68
v_cvt_pk_bf16_f32 v68,v66,v68
v_lshlrev_b32 v66,16,v68
v_and_b32 v68,0xffff0000,v68
v_add_f32 v68,0x3727c5ac,v68
v_cvt_pk_bf16_f32 v68,v68,v68
v_and_b32 v68,0xffff0000,v68
v_sqrt_f32 v68,v68
v_pk_add_f32 v[58:59],v[96:97],v[66:67] op_sel_hi:[1,0] neg_lo:[0,1] neg_hi:[0,1]
v_pk_add_f32 v[60:61],v[98:99],v[66:67] op_sel_hi:[1,0] neg_lo:[0,1] neg_hi:[0,1]
v_pk_add_f32 v[62:63],v[100:101],v[66:67] op_sel_hi:[1,0] neg_lo:[0,1] neg_hi:[0,1]
v_pk_add_f32 v[64:65],v[102:103],v[66:67] op_sel_hi:[1,0] neg_lo:[0,1] neg_hi:[0,1]
v_cvt_pk_bf16_f32 v68,v68,v68
v_and_b32 v68,0xffff0000,v68
v_rcp_f32 v68,v68
v_cvt_pk_bf16_f32 v84,v58,v59
v_cvt_pk_bf16_f32 v85,v60,v61
v_cvt_pk_bf16_f32 v86,v62,v63
v_cvt_pk_bf16_f32 v87,v64,v65
v_lshlrev_b32 v58,16,v84
v_and_b32 v59,0xffff0000,v84
v_lshlrev_b32 v60,16,v85
v_and_b32 v61,0xffff0000,v85
v_lshlrev_b32 v62,16,v86
v_and_b32 v63,0xffff0000,v86
v_lshlrev_b32 v64,16,v87
v_and_b32 v65,0xffff0000,v87
v_pk_mul_f32 v[58:59],v[58:59],v[68:69] op_sel_hi:[1,0]
v_pk_mul_f32 v[60:61],v[60:61],v[68:69] op_sel_hi:[1,0]
v_pk_mul_f32 v[62:63],v[62:63],v[68:69] op_sel_hi:[1,0]
v_pk_mul_f32 v[64:65],v[64:65],v[68:69] op_sel_hi:[1,0]
v_cvt_pk_bf16_f32 v84,v58,v59
v_cvt_pk_bf16_f32 v85,v60,v61
v_cvt_pk_bf16_f32 v86,v62,v63
v_cvt_pk_bf16_f32 v87,v64,v65
s_lshl_b32 s58,s51,10
s_add_u32 s58,s58,11272192
s_add_u32 s59,s58,65536
s_cmp_eq_u32 s47,0
s_cselect_b32 s59,s59,0x80000000
s_add_u32 s57,s56,98566144
buffer_store_dwordx4 v[84:87],v0,s[8:11],s59 offen sc1
buffer_store_dwordx4 v[80:83],v0,s[8:11],s58 offen sc1
buffer_store_dwordx4 v[84:87],v0,s[8:11],s57 offen sc1
L_moed_43:
s_barrier
L_mo_30:
s_mov_b32 s77,-1
s_cmp_lt_u32 s31,64
s_cbranch_scc1 L_mo_26
s_cmp_eq_u32 s86,0
s_cbranch_scc1 L_mo_39
L_mo_32:
s_andn2_b32 s51,0x7ff,s54
s_lshr_b32 s51,s51,5
s_andn2_b32 s56,31,s54
v_lshrrev_b32 v2,10,v20
v_add_u32 v3,16,v2
v_add_u32 v8,96468992,v20
v_cmp_eq_u32 vcc,s56,v2
s_nop 1
v_cndmask_b32 v2,v20,v8,vcc
v_cmp_eq_u32 vcc,s56,v3
s_nop 1
v_cndmask_b32 v3,v20,v8,vcc
s_waitcnt vmcnt(0)
s_lshl_b32 s59,s51,13
s_add_u32 s59,s59,10487552
s_cmp_lg_u32 s46,0
s_cbranch_scc1 L_fd_48
v_and_b32 v124,31,v1
v_lshlrev_b32 v124,2,v124
s_branch L_ff_49
L_fw_47:
s_sleep 2
L_ff_49:
buffer_load_dword v125,v124,s[8:11],s59 offen sc1
s_sub_u32 s49,s49,1
s_cbranch_scc1 L_abort
s_waitcnt vmcnt(0)
v_cmp_eq_u32 vcc,0,v125
s_cbranch_vccnz L_fw_47
L_fd_48:
s_barrier
s_or_b32 s72,s72,s52
buffer_store_dword v17,off,s[8:11],s72 sc1
s_lshl_b32 s66,s51,15
s_add_u32 s66,s66,2097152
s_add_u32 s67,s66,16384
s_add_u32 m0,s50,131072
s_nop 0
buffer_load_dwordx4 v2,s[8:11],s66 offen offset:0 sc1 lds
s_add_u32 m0,s50,135168
s_nop 0
buffer_load_dwordx4 v3,s[8:11],s67 offen offset:0 sc1 lds
s_add_u32 m0,s50,139008
s_nop 0
buffer_load_dwordx4 v2,s[8:11],s66 offen offset:256 sc1 lds
s_add_u32 m0,s50,143104
s_nop 0
buffer_load_dwordx4 v3,s[8:11],s67 offen offset:256 sc1 lds
s_add_u32 m0,s50,146944
s_nop 0
buffer_load_dwordx4 v2,s[8:11],s66 offen offset:512 sc1 lds
s_add_u32 m0,s50,151040
s_nop 0
buffer_load_dwordx4 v3,s[8:11],s67 offen offset:512 sc1 lds
s_waitcnt vmcnt(4)
s_barrier
ds_read_b128 v[104:107],v4 offset:0
ds_read_b128 v[108:111],v4 offset:4096
ds_read_b128 v[112:115],v5 offset:0
ds_read_b128 v[116:119],v5 offset:4096
s_add_u32 m0,s50,154880
s_nop 0
buffer_load_dwordx4 v2,s[8:11],s66 offen offset:768 sc1 lds
s_add_u32 m0,s50,158976
s_nop 0
buffer_load_dwordx4 v3,s[8:11],s67 offen offset:768 sc1 lds
s_waitcnt lgkmcnt(2)
v_mfma_f32_16x16x32_bf16 v[24:27],a[128:131],v[104:107],0
ds_read_b128 v[120:123],v6 offset:0
v_mfma_f32_16x16x32_bf16 v[40:43],v[104:107],v[128:131],0
s_lshl_b32 s58,s51,5
v_mfma_f32_16x16x32_bf16 v[28:31],a[128:131],v[108:111],0
ds_read_b128 v[124:127],v6 offset:4096
v_mfma_f32_16x16x32_bf16 v[44:47],v[108:111],v[128:131],0
s_add_u32 s58,s58,s47
v_mfma_f32_16x16x32_bf16 v[32:35],a[136:139],v[104:107],0
s_mul_i32 s58,s58,24576
v_mfma_f32_16x16x32_bf16 v[48:51],v[104:107],v[136:139],0
s_add_u32 s58,s58,201326592
v_mfma_f32_16x16x32_bf16 v[36:39],a[136:139],v[108:111],0
s_add_u32 s61,s58,s50
v_mfma_f32_16x16x32_bf16 v[52:55],v[108:111],v[136:139],0
s_add_u32 s62,s61,4096
s_waitcnt lgkmcnt(2)
v_mfma_f32_16x16x32_bf16 v[24:27],a[132:135],v[112:115],v[24:27]
ds_read_b128 v[104:107],v7 offset:0
v_mfma_f32_16x16x32_bf16 v[40:43],v[112:115],v[132:135],v[40:43]
s_add_u32 s63,s61,16384
v_mfma_f32_16x16x32_bf16 v[28:31],a[132:135],v[116:119],v[28:31]
ds_read_b128 v[108:111],v7 offset:4096
v_mfma_f32_16x16x32_bf16 v[44:47],v[116:119],v[132:135],v[44:47]
s_add_u32 s64,s61,20480
v_mfma_f32_16x16x32_bf16 v[32:35],a[140:143],v[112:115],v[32:35]
s_add_u32 s65,s61,s50
v_mfma_f32_16x16x32_bf16 v[48:51],v[112:115],v[140:143],v[48:51]
s_add_u32 s65,s65,8192
v_mfma_f32_16x16x32_bf16 v[36:39],a[140:143],v[116:119],v[36:39]
v_mfma_f32_16x16x32_bf16 v[52:55],v[116:119],v[140:143],v[52:55]
s_waitcnt vmcnt(4)
s_barrier
s_waitcnt lgkmcnt(2)
v_mfma_f32_16x16x32_bf16 v[24:27],a[144:147],v[120:123],v[24:27]
ds_read_b128 v[112:115],v4 offset:8192
v_mfma_f32_16x16x32_bf16 v[40:43],v[120:123],v[144:147],v[40:43]
v_mfma_f32_16x16x32_bf16 v[28:31],a[144:147],v[124:127],v[28:31]
ds_read_b128 v[116:119],v4 offset:12288
v_mfma_f32_16x16x32_bf16 v[44:47],v[124:127],v[144:147],v[44:47]
v_mfma_f32_16x16x32_bf16 v[32:35],a[152:155],v[120:123],v[32:35]
v_mfma_f32_16x16x32_bf16 v[48:51],v[120:123],v[152:155],v[48:51]
v_mfma_f32_16x16x32_bf16 v[36:39],a[152:155],v[124:127],v[36:39]
v_mfma_f32_16x16x32_bf16 v[52:55],v[124:127],v[152:155],v[52:55]
s_waitcnt lgkmcnt(2)
v_mfma_f32_16x16x32_bf16 v[24:27],a[148:151],v[104:107],v[24:27]
ds_read_b128 v[120:123],v5 offset:8192
v_mfma_f32_16x16x32_bf16 v[40:43],v[104:107],v[148:151],v[40:43]
v_mfma_f32_16x16x32_bf16 v[28:31],a[148:151],v[108:111],v[28:31]
ds_read_b128 v[124:127],v5 offset:12288
v_mfma_f32_16x16x32_bf16 v[44:47],v[108:111],v[148:151],v[44:47]
v_mfma_f32_16x16x32_bf16 v[32:35],a[156:159],v[104:107],v[32:35]
v_mfma_f32_16x16x32_bf16 v[48:51],v[104:107],v[156:159],v[48:51]
v_mfma_f32_16x16x32_bf16 v[36:39],a[156:159],v[108:111],v[36:39]
v_mfma_f32_16x16x32_bf16 v[52:55],v[108:111],v[156:159],v[52:55]
s_waitcnt lgkmcnt(2)
v_mfma_f32_16x16x32_bf16 v[24:27],a[160:163],v[112:115],v[24:27]
ds_read_b128 v[104:107],v6 offset:8192
v_mfma_f32_16x16x32_bf16 v[40:43],v[112:115],v[160:163],v[40:43]
v_mfma_f32_16x16x32_bf16 v[28:31],a[160:163],v[116:119],v[28:31]
ds_read_b128 v[108:111],v6 offset:12288
v_mfma_f32_16x16x32_bf16 v[44:47],v[116:119],v[160:163],v[44:47]
v_mfma_f32_16x16x32_bf16 v[32:35],a[168:171],v[112:115],v[32:35]
v_mfma_f32_16x16x32_bf16 v[48:51],v[112:115],v[168:171],v[48:51]
v_mfma_f32_16x16x32_bf16 v[36:39],a[168:171],v[116:119],v[36:39]
v_mfma_f32_16x16x32_bf16 v[52:55],v[116:119],v[168:171],v[52:55]
s_waitcnt lgkmcnt(2)
v_mfma_f32_16x16x32_bf16 v[24:27],a[164:167],v[120:123],v[24:27]
ds_read_b128 v[112:115],v7 offset:8192
v_mfma_f32_16x16x32_bf16 v[40:43],v[120:123],v[164:167],v[40:43]
v_mfma_f32_16x16x32_bf16 v[28:31],a[164:167],v[124:127],v[28:31]
ds_read_b128 v[116:119],v7 offset:12288
v_mfma_f32_16x16x32_bf16 v[44:47],v[124:127],v[164:167],v[44:47]
v_mfma_f32_16x16x32_bf16 v[32:35],a[172:175],v[120:123],v[32:35]
v_mfma_f32_16x16x32_bf16 v[48:51],v[120:123],v[172:175],v[48:51]
v_mfma_f32_16x16x32_bf16 v[36:39],a[172:175],v[124:127],v[36:39]
v_mfma_f32_16x16x32_bf16 v[52:55],v[124:127],v[172:175],v[52:55]
s_waitcnt vmcnt(2)
s_barrier
s_waitcnt lgkmcnt(2)
v_mfma_f32_16x16x32_bf16 v[24:27],a[176:179],v[104:107],v[24:27]
ds_read_b128 v[120:123],v4 offset:16384
v_mfma_f32_16x16x32_bf16 v[40:43],v[104:107],v[176:179],v[40:43]
v_mfma_f32_16x16x32_bf16 v[28:31],a[176:179],v[108:111],v[28:31]
ds_read_b128 v[124:127],v4 offset:20480
v_mfma_f32_16x16x32_bf16 v[44:47],v[108:111],v[176:179],v[44:47]
v_mfma_f32_16x16x32_bf16 v[32:35],a[184:187],v[104:107],v[32:35]
v_mfma_f32_16x16x32_bf16 v[48:51],v[104:107],v[184:187],v[48:51]
v_mfma_f32_16x16x32_bf16 v[36:39],a[184:187],v[108:111],v[36:39]
v_mfma_f32_16x16x32_bf16 v[52:55],v[108:111],v[184:187],v[52:55]
s_waitcnt lgkmcnt(2)
v_mfma_f32_16x16x32_bf16 v[24:27],a[180:183],v[112:115],v[24:27]
ds_read_b128 v[104:107],v5 offset:16384
v_mfma_f32_16x16x32_bf16 v[40:43],v[112:115],v[180:183],v[40:43]
v_mfma_f32_16x16x32_bf16 v[28:31],a[180:183],v[116:119],v[28:31]
ds_read_b128 v[108:111],v5 offset:20480
v_mfma_f32_16x16x32_bf16 v[44:47],v[116:119],v[180:183],v[44:47]
v_mfma_f32_16x16x32_bf16 v[32:35],a[188:191],v[112:115],v[32:35]
v_mfma_f32_16x16x32_bf16 v[48:51],v[112:115],v[188:191],v[48:51]
v_mfma_f32_16x16x32_bf16 v[36:39],a[188:191],v[116:119],v[36:39]
v_mfma_f32_16x16x32_bf16 v[52:55],v[116:119],v[188:191],v[52:55]
s_waitcnt lgkmcnt(2)
v_mfma_f32_16x16x32_bf16 v[24:27],a[192:195],v[120:123],v[24:27]
ds_read_b128 v[112:115],v6 offset:16384
v_mfma_f32_16x16x32_bf16 v[40:43],v[120:123],v[192:195],v[40:43]
v_mfma_f32_16x16x32_bf16 v[28:31],a[192:195],v[124:127],v[28:31]
ds_read_b128 v[116:119],v6 offset:20480
v_mfma_f32_16x16x32_bf16 v[44:47],v[124:127],v[192:195],v[44:47]
v_mfma_f32_16x16x32_bf16 v[32:35],a[200:203],v[120:123],v[32:35]
v_mfma_f32_16x16x32_bf16 v[48:51],v[120:123],v[200:203],v[48:51]
v_mfma_f32_16x16x32_bf16 v[36:39],a[200:203],v[124:127],v[36:39]
v_mfma_f32_16x16x32_bf16 v[52:55],v[124:127],v[200:203],v[52:55]
s_waitcnt lgkmcnt(2)
v_mfma_f32_16x16x32_bf16 v[24:27],a[196:199],v[104:107],v[24:27]
ds_read_b128 v[120:123],v7 offset:16384
v_mfma_f32_16x16x32_bf16 v[40:43],v[104:107],v[196:199],v[40:43]
v_mfma_f32_16x16x32_bf16 v[28:31],a[196:199],v[108:111],v[28:31]
ds_read_b128 v[124:127],v7 offset:20480
v_mfma_f32_16x16x32_bf16 v[44:47],v[108:111],v[196:199],v[44:47]
v_mfma_f32_16x16x32_bf16 v[32:35],a[204:207],v[104:107],v[32:35]
v_mfma_f32_16x16x32_bf16 v[48:51],v[104:107],v[204:207],v[48:51]
v_mfma_f32_16x16x32_bf16 v[36:39],a[204:207],v[108:111],v[36:39]
v_mfma_f32_16x16x32_bf16 v[52:55],v[108:111],v[204:207],v[52:55]
s_waitcnt vmcnt(0)
s_barrier
s_waitcnt lgkmcnt(2)
v_mfma_f32_16x16x32_bf16 v[24:27],a[208:211],v[112:115],v[24:27]
ds_read_b128 v[104:107],v4 offset:24576
v_mfma_f32_16x16x32_bf16 v[40:43],v[112:115],v[208:211],v[40:43]
v_mfma_f32_16x16x32_bf16 v[28:31],a[208:211],v[116:119],v[28:31]
ds_read_b128 v[108:111],v4 offset:28672
v_mfma_f32_16x16x32_bf16 v[44:47],v[116:119],v[208:211],v[44:47]
v_mfma_f32_16x16x32_bf16 v[32:35],a[216:219],v[112:115],v[32:35]
v_mfma_f32_16x16x32_bf16 v[48:51],v[112:115],v[216:219],v[48:51]
v_mfma_f32_16x16x32_bf16 v[36:39],a[216:219],v[116:119],v[36:39]
v_mfma_f32_16x16x32_bf16 v[52:55],v[116:119],v[216:219],v[52:55]
s_waitcnt lgkmcnt(2)
v_mfma_f32_16x16x32_bf16 v[24:27],a[212:215],v[120:123],v[24:27]
ds_read_b128 v[112:115],v5 offset:24576
v_mfma_f32_16x16x32_bf16 v[40:43],v[120:123],v[212:215],v[40:43]
v_mfma_f32_16x16x32_bf16 v[28:31],a[212:215],v[124:127],v[28:31]
ds_read_b128 v[116:119],v5 offset:28672
v_mfma_f32_16x16x32_bf16 v[44:47],v[124:127],v[212:215],v[44:47]
v_mfma_f32_16x16x32_bf16 v[32:35],a[220:223],v[120:123],v[32:35]
v_mfma_f32_16x16x32_bf16 v[48:51],v[120:123],v[220:223],v[48:51]
v_mfma_f32_16x16x32_bf16 v[36:39],a[220:223],v[124:127],v[36:39]
v_mfma_f32_16x16x32_bf16 v[52:55],v[124:127],v[220:223],v[52:55]
s_waitcnt lgkmcnt(2)
v_mfma_f32_16x16x32_bf16 v[24:27],a[224:227],v[104:107],v[24:27]
ds_read_b128 v[120:123],v6 offset:24576
v_mfma_f32_16x16x32_bf16 v[40:43],v[104:107],v[224:227],v[40:43]
v_mfma_f32_16x16x32_bf16 v[28:31],a[224:227],v[108:111],v[28:31]
ds_read_b128 v[124:127],v6 offset:28672
v_mfma_f32_16x16x32_bf16 v[44:47],v[108:111],v[224:227],v[44:47]
v_mfma_f32_16x16x32_bf16 v[32:35],a[232:235],v[104:107],v[32:35]
v_mfma_f32_16x16x32_bf16 v[48:51],v[104:107],v[232:235],v[48:51]
v_mfma_f32_16x16x32_bf16 v[36:39],a[232:235],v[108:111],v[36:39]
v_mfma_f32_16x16x32_bf16 v[52:55],v[108:111],v[232:235],v[52:55]
s_waitcnt lgkmcnt(2)
v_mfma_f32_16x16x32_bf16 v[24:27],a[228:231],v[112:115],v[24:27]
ds_read_b128 v[104:107],v7 offset:24576
v_mfma_f32_16x16x32_bf16 v[40:43],v[112:115],v[228:231],v[40:43]
v_mfma_f32_16x16x32_bf16 v[28:31],a[228:231],v[116:119],v[28:31]
ds_read_b128 v[108:111],v7 offset:28672
v_mfma_f32_16x16x32_bf16 v[44:47],v[116:119],v[228:231],v[44:47]
v_mfma_f32_16x16x32_bf16 v[32:35],a[236:239],v[112:115],v[32:35]
v_mfma_f32_16x16x32_bf16 v[48:51],v[112:115],v[236:239],v[48:51]
v_mfma_f32_16x16x32_bf16 v[36:39],a[236:239],v[116:119],v[36:39]
v_mfma_f32_16x16x32_bf16 v[52:55],v[116:119],v[236:239],v[52:55]
s_waitcnt lgkmcnt(2)
v_mfma_f32_16x16x32_bf16 v[24:27],a[240:243],v[120:123],v[24:27]
ds_read_b128 v[112:115],v4 offset:0
v_mfma_f32_16x16x32_bf16 v[40:43],v[120:123],v[240:243],v[40:43]
v_mfma_f32_16x16x32_bf16 v[28:31],a[240:243],v[124:127],v[28:31]
ds_read_b128 v[116:119],v4 offset:4096
v_mfma_f32_16x16x32_bf16 v[44:47],v[124:127],v[240:243],v[44:47]
v_mfma_f32_16x16x32_bf16 v[32:35],a[248:251],v[120:123],v[32:35]
v_mfma_f32_16x16x32_bf16 v[48:51],v[120:123],v[248:251],v[48:51]
v_mfma_f32_16x16x32_bf16 v[36:39],a[248:251],v[124:127],v[36:39]
v_mfma_f32_16x16x32_bf16 v[52:55],v[124:127],v[248:251],v[52:55]
s_waitcnt lgkmcnt(2)
v_mfma_f32_16x16x32_bf16 v[24:27],a[244:247],v[104:107],v[24:27]
ds_read_b128 v[120:123],v5 offset:0
v_mfma_f32_16x16x32_bf16 v[40:43],v[104:107],v[244:247],v[40:43]
v_mfma_f32_16x16x32_bf16 v[28:31],a[244:247],v[108:111],v[28:31]
ds_read_b128 v[124:127],v5 offset:4096
v_mfma_f32_16x16x32_bf16 v[44:47],v[108:111],v[244:247],v[44:47]
v_mfma_f32_16x16x32_bf16 v[32:35],a[252:255],v[104:107],v[32:35]
v_mfma_f32_16x16x32_bf16 v[48:51],v[104:107],v[252:255],v[48:51]
v_mfma_f32_16x16x32_bf16 v[36:39],a[252:255],v[108:111],v[36:39]
v_mfma_f32_16x16x32_bf16 v[52:55],v[108:111],v[252:255],v[52:55]
s_waitcnt lgkmcnt(2)
v_mfma_f32_16x16x32_bf16 v[88:91],a[0:3],v[112:115],0
ds_read_b128 v[104:107],v6 offset:0
v_mfma_f32_16x16x32_bf16 v[92:95],a[0:3],v[116:119],0
v_mfma_f32_16x16x32_bf16 v[96:99],a[8:11],v[112:115],0
ds_read_b128 v[108:111],v6 offset:4096
v_cvt_pk_bf16_f32 v56,v24,v32
v_cvt_pk_bf16_f32 v57,v25,v33
v_mfma_f32_16x16x32_bf16 v[100:103],a[8:11],v[116:119],0
v_cvt_pk_bf16_f32 v58,v26,v34
v_cvt_pk_bf16_f32 v59,v27,v35
s_waitcnt lgkmcnt(2)
v_mfma_f32_16x16x32_bf16 v[88:91],a[4:7],v[120:123],v[88:91]
ds_read_b128 v[112:115],v7 offset:0
v_mfma_f32_16x16x32_bf16 v[92:95],a[4:7],v[124:127],v[92:95]
buffer_store_dwordx4 v[56:59],v0,s[8:11],s61 offen sc1
v_cvt_pk_bf16_f32 v60,v28,v36
v_cvt_pk_bf16_f32 v61,v29,v37
v_mfma_f32_16x16x32_bf16 v[96:99],a[12:15],v[120:123],v[96:99]
ds_read_b128 v[116:119],v7 offset:4096
v_cvt_pk_bf16_f32 v62,v30,v38
v_cvt_pk_bf16_f32 v63,v31,v39
v_mfma_f32_16x16x32_bf16 v[100:103],a[12:15],v[124:127],v[100:103]
buffer_store_dwordx4 v[60:63],v0,s[8:11],s62 offen sc1
v_cvt_pk_bf16_f32 v64,v40,v41
v_cvt_pk_bf16_f32 v65,v42,v43
s_waitcnt lgkmcnt(2)
v_mfma_f32_16x16x32_bf16 v[88:91],a[16:19],v[104:107],v[88:91]
ds_read_b128 v[120:123],v4 offset:8192
v_cvt_pk_bf16_f32 v66,v44,v45
v_cvt_pk_bf16_f32 v67,v46,v47
v_mfma_f32_16x16x32_bf16 v[92:95],a[16:19],v[108:111],v[92:95]
buffer_store_dwordx4 v[64:67],v0,s[8:11],s65 offen offset:0 sc1
v_cvt_pk_bf16_f32 v68,v48,v49
v_cvt_pk_bf16_f32 v69,v50,v51
v_mfma_f32_16x16x32_bf16 v[96:99],a[24:27],v[104:107],v[96:99]
ds_read_b128 v[124:127],v4 offset:12288
v_cvt_pk_bf16_f32 v70,v52,v53
v_cvt_pk_bf16_f32 v71,v54,v55
v_mfma_f32_16x16x32_bf16 v[100:103],a[24:27],v[108:111],v[100:103]
buffer_store_dwordx4 v[68:71],v0,s[8:11],s65 offen offset:1024 sc1
s_waitcnt lgkmcnt(2)
v_mfma_f32_16x16x32_bf16 v[88:91],a[20:23],v[112:115],v[88:91]
ds_read_b128 v[104:107],v5 offset:8192
v_mfma_f32_16x16x32_bf16 v[92:95],a[20:23],v[116:119],v[92:95]
v_mfma_f32_16x16x32_bf16 v[96:99],a[28:31],v[112:115],v[96:99]
ds_read_b128 v[108:111],v5 offset:12288
v_mfma_f32_16x16x32_bf16 v[100:103],a[28:31],v[116:119],v[100:103]
s_waitcnt lgkmcnt(2)
v_mfma_f32_16x16x32_bf16 v[88:91],a[32:35],v[120:123],v[88:91]
ds_read_b128 v[112:115],v6 offset:8192
v_mfma_f32_16x16x32_bf16 v[92:95],a[32:35],v[124:127],v[92:95]
v_mfma_f32_16x16x32_bf16 v[96:99],a[40:43],v[120:123],v[96:99]
ds_read_b128 v[116:119],v6 offset:12288
v_mfma_f32_16x16x32_bf16 v[100:103],a[40:43],v[124:127],v[100:103]
s_waitcnt lgkmcnt(2)
v_mfma_f32_16x16x32_bf16 v[88:91],a[36:39],v[104:107],v[88:91]
ds_read_b128 v[120:123],v7 offset:8192
v_mfma_f32_16x16x32_bf16 v[92:95],a[36:39],v[108:111],v[92:95]
v_mfma_f32_16x16x32_bf16 v[96:99],a[44:47],v[104:107],v[96:99]
ds_read_b128 v[124:127],v7 offset:12288
v_mfma_f32_16x16x32_bf16 v[100:103],a[44:47],v[108:111],v[100:103]
s_waitcnt lgkmcnt(2)
v_mfma_f32_16x16x32_bf16 v[88:91],a[48:51],v[112:115],v[88:91]
ds_read_b128 v[104:107],v4 offset:16384
v_mfma_f32_16x16x32_bf16 v[92:95],a[48:51],v[116:119],v[92:95]
v_mfma_f32_16x16x32_bf16 v[96:99],a[56:59],v[112:115],v[96:99]
ds_read_b128 v[108:111],v4 offset:20480
v_mfma_f32_16x16x32_bf16 v[100:103],a[56:59],v[116:119],v[100:103]
s_waitcnt lgkmcnt(2)
v_mfma_f32_16x16x32_bf16 v[88:91],a[52:55],v[120:123],v[88:91]
ds_read_b128 v[112:115],v5 offset:16384
v_mfma_f32_16x16x32_bf16 v[92:95],a[52:55],v[124:127],v[92:95]
v_mfma_f32_16x16x32_bf16 v[96:99],a[60:63],v[120:123],v[96:99]
ds_read_b128 v[116:119],v5 offset:20480
v_mfma_f32_16x16x32_bf16 v[100:103],a[60:63],v[124:127],v[100:103]
s_waitcnt lgkmcnt(2)
v_mfma_f32_16x16x32_bf16 v[88:91],a[64:67],v[104:107],v[88:91]
ds_read_b128 v[120:123],v6 offset:16384
v_mfma_f32_16x16x32_bf16 v[92:95],a[64:67],v[108:111],v[92:95]
v_mfma_f32_16x16x32_bf16 v[96:99],a[72:75],v[104:107],v[96:99]
ds_read_b128 v[124:127],v6 offset:20480
v_mfma_f32_16x16x32_bf16 v[100:103],a[72:75],v[108:111],v[100:103]
s_waitcnt lgkmcnt(2)
v_mfma_f32_16x16x32_bf16 v[88:91],a[68:71],v[112:115],v[88:91]
ds_read_b128 v[104:107],v7 offset:16384
v_mfma_f32_16x16x32_bf16 v[92:95],a[68:71],v[116:119],v[92:95]
v_mfma_f32_16x16x32_bf16 v[96:99],a[76:79],v[112:115],v[96:99]
ds_read_b128 v[108:111],v7 offset:20480
v_mfma_f32_16x16x32_bf16 v[100:103],a[76:79],v[116:119],v[100:103]
s_waitcnt lgkmcnt(2)
v_mfma_f32_16x16x32_bf16 v[88:91],a[80:83],v[120:123],v[88:91]
ds_read_b128 v[112:115],v4 offset:24576
v_mfma_f32_16x16x32_bf16 v[92:95],a[80:83],v[124:127],v[92:95]
v_mfma_f32_16x16x32_bf16 v[96:99],a[88:91],v[120:123],v[96:99]
ds_read_b128 v[116:119],v4 offset:28672
v_mfma_f32_16x16x32_bf16 v[100:103],a[88:91],v[124:127],v[100:103]
s_waitcnt lgkmcnt(2)
v_mfma_f32_16x16x32_bf16 v[88:91],a[84:87],v[104:107],v[88:91]
ds_read_b128 v[120:123],v5 offset:24576
v_mfma_f32_16x16x32_bf16 v[92:95],a[84:87],v[108:111],v[92:95]
v_mfma_f32_16x16x32_bf16 v[96:99],a[92:95],v[104:107],v[96:99]
ds_read_b128 v[124:127],v5 offset:28672
v_mfma_f32_16x16x32_bf16 v[100:103],a[92:95],v[108:111],v[100:103]
s_waitcnt lgkmcnt(2)
v_mfma_f32_16x16x32_bf16 v[88:91],a[96:99],v[112:115],v[88:91]
ds_read_b128 v[104:107],v6 offset:24576
v_mfma_f32_16x16x32_bf16 v[92:95],a[96:99],v[116:119],v[92:95]
v_mfma_f32_16x16x32_bf16 v[96:99],a[104:107],v[112:115],v[96:99]
ds_read_b128 v[108:111],v6 offset:28672
v_mfma_f32_16x16x32_bf16 v[100:103],a[104:107],v[116:119],v[100:103]
s_waitcnt lgkmcnt(2)
v_mfma_f32_16x16x32_bf16 v[88:91],a[100:103],v[120:123],v[88:91]
ds_read_b128 v[112:115],v7 offset:24576
v_mfma_f32_16x16x32_bf16 v[92:95],a[100:103],v[124:127],v[92:95]
v_mfma_f32_16x16x32_bf16 v[96:99],a[108:111],v[120:123],v[96:99]
ds_read_b128 v[116:119],v7 offset:28672
v_mfma_f32_16x16x32_bf16 v[100:103],a[108:111],v[124:127],v[100:103]
s_waitcnt lgkmcnt(2)
v_mfma_f32_16x16x32_bf16 v[88:91],a[112:115],v[104:107],v[88:91]
v_mfma_f32_16x16x32_bf16 v[92:95],a[112:115],v[108:111],v[92:95]
v_mfma_f32_16x16x32_bf16 v[96:99],a[120:123],v[104:107],v[96:99]
v_mfma_f32_16x16x32_bf16 v[100:103],a[120:123],v[108:111],v[100:103]
s_waitcnt lgkmcnt(0)
v_mfma_f32_16x16x32_bf16 v[88:91],a[116:119],v[112:115],v[88:91]
v_mfma_f32_16x16x32_bf16 v[92:95],a[116:119],v[116:119],v[92:95]
v_mfma_f32_16x16x32_bf16 v[96:99],a[124:127],v[112:115],v[96:99]
v_mfma_f32_16x16x32_bf16 v[100:103],a[124:127],v[116:119],v[100:103]
s_nop 3
v_cvt_pk_bf16_f32 v104,v88,v96
v_cvt_pk_bf16_f32 v105,v89,v97
v_cvt_pk_bf16_f32 v106,v90,v98
v_cvt_pk_bf16_f32 v107,v91,v99
v_cvt_pk_bf16_f32 v108,v92,v100
v_cvt_pk_bf16_f32 v109,v93,v101
v_cvt_pk_bf16_f32 v110,v94,v102
v_cvt_pk_bf16_f32 v111,v95,v103
buffer_store_dwordx4 v[104:107],v0,s[8:11],s63 offen sc1
buffer_store_dwordx4 v[108:111],v0,s[8:11],s64 offen sc1
s_waitcnt vmcnt(6)
s_barrier
s_add_u32 m0,s50,131072
s_nop 0
buffer_load_dwordx4 v20,s[8:11],s70 offen offset:0 sc1 lds
s_add_u32 m0,s50,135168
s_nop 0
buffer_load_dwordx4 v20,s[8:11],s71 offen offset:0 sc1 lds
s_add_u32 m0,s50,139008
s_nop 0
buffer_load_dwordx4 v20,s[8:11],s70 offen offset:256 sc1 lds
s_add_u32 m0,s50,143104
s_nop 0
buffer_load_dwordx4 v20,s[8:11],s71 offen offset:256 sc1 lds
s_add_u32 m0,s50,146944
s_nop 0
buffer_load_dwordx4 v20,s[8:11],s70 offen offset:512 sc1 lds
s_add_u32 m0,s50,151040
s_nop 0
buffer_load_dwordx4 v20,s[8:11],s71 offen offset:512 sc1 lds
s_lshl_b32 s59,s51,13
s_lshl2_add_u32 s59,s47,s59
s_add_u32 s59,s59,10487680
s_waitcnt vmcnt(0)
s_barrier
s_or_b32 s59,s59,s52
buffer_store_dword v17,off,s[8:11],s59 sc1
s_mov_b32 s72,0x80000000
s_mov_b32 s86,0
s_mov_b32 s19,1
s_mov_b32 s18,0
s_cmp_lt_u32 s31,64
s_cbranch_scc1 L_mo_26
L_mo_39:
s_mov_b32 s51,64
s_and_b32 s61,s54,0x7ff
s_sub_u32 s61,2047,s61
s_lshr_b32 s61,s61,5
s_cmp_lg_u32 s46,0
s_cbranch_scc1 L_mw_50
s_mov_b32 s59,11018240
v_lshlrev_b32 v2,2,v1
L_fp_51:
s_sleep 2
buffer_load_dword v3,v2,s[8:11],s59 offen sc1
s_sub_u32 s49,s49,1
s_cbranch_scc1 L_abort
s_waitcnt vmcnt(0)
v_cmp_eq_u32 vcc,0,v3
s_cbranch_vccnz L_fp_51
v_cmp_le_u32 vcc,s61,v1
s_nop 1
v_cndmask_b32 v2,1,2,vcc
v_cmp_ne_u32 s[84:85],v2,v3
s_lshl_b32 s56,s47,1
s_lshr_b64 s[20:21],s[84:85],s56
v_lshrrev_b32 v2,5,v1
v_lshrrev_b32 v3,v2,s20
v_and_b32 v3,1,v3
v_mul_u32_u24 v3,768,v3
v_lshlrev_b32 v2,13,v2
v_sub_u32 v2,v2,v3
v_and_b32 v3,31,v1
v_lshl_add_u32 v2,v3,2,v2
v_add_u32 v2,1536,v2
s_lshl_b32 s59,s47,14
s_add_u32 s59,s59,10485760
L_fp_52:
s_sleep 1
buffer_load_dword v3,v2,s[8:11],s59 offen sc1
s_sub_u32 s49,s49,1
s_cbranch_scc1 L_abort
s_waitcnt vmcnt(0)
v_cmp_eq_u32 vcc,0,v3
s_cbranch_vccnz L_fp_52
v_max_u32_dpp v3,v3,v3 row_ror:8 row_mask:0xf bank_mask:0xf
s_nop 1
v_max_u32_dpp v3,v3,v3 row_ror:4 row_mask:0xf bank_mask:0xf
s_nop 1
v_max_u32_dpp v3,v3,v3 row_ror:2 row_mask:0xf bank_mask:0xf
s_nop 1
v_max_u32_dpp v3,v3,v3 row_ror:1 row_mask:0xf bank_mask:0xf
v_mov_b32 v2,v3
s_nop 1
v_permlane16_swap_b32 v3,v2
v_max_u32 v3,v3,v2
v_mov_b32 v2,v3
s_nop 1
v_permlane32_swap_b32 v3,v2
v_max_u32 v3,v3,v2
s_lshl_b32 s59,s51,13
s_lshl2_add_u32 s59,s47,s59
s_add_u32 s59,s59,10487424
buffer_store_dword v3,off,s[8:11],s59
L_mw_50:
s_barrier
s_lshl_b32 s59,s51,13
s_add_u32 s59,s59,10487424
v_and_b32 v124,31,v1
v_lshlrev_b32 v124,2,v124
s_branch L_ff_55
L_fw_53:
s_sleep 1
L_ff_55:
buffer_load_dword v125,v124,s[8:11],s59 offen sc1
s_sub_u32 s49,s49,1
s_cbranch_scc1 L_abort
s_waitcnt vmcnt(0)
v_cmp_eq_u32 vcc,0,v125
s_cbranch_vccnz L_fw_53
v_max_u32_dpp v125,v125,v125 row_ror:8 row_mask:0xf bank_mask:0xf
s_nop 1
v_max_u32_dpp v125,v125,v125 row_ror:4 row_mask:0xf bank_mask:0xf
s_nop 1
v_max_u32_dpp v125,v125,v125 row_ror:2 row_mask:0xf bank_mask:0xf
s_nop 1
v_max_u32_dpp v125,v125,v125 row_ror:1 row_mask:0xf bank_mask:0xf
v_mov_b32 v124,v125
s_nop 1
v_permlane16_swap_b32 v125,v124
v_max_u32 v125,v125,v124
v_mov_b32 v124,v125
s_nop 1
v_permlane32_swap_b32 v125,v124
v_max_u32 v125,v125,v124
s_nop 0
v_readfirstlane_b32 s55,v125
s_and_b32 s64,s55,0x7ff
s_sub_u32 s64,2047,s64
s_lshl_b32 s56,s64,10
s_add_u32 s58,s56,6291456
buffer_load_dwordx4 v[88:91],v0,s[8:11],s58 offen sc1
s_mov_b32 s4,s38
s_mov_b32 s5,s39
s_mov_b32 s6,1835008
s_mov_b32 s7,0x20000
v_and_b32 v9,15,v1
v_lshrrev_b32 v10,4,v1
v_lshlrev_b32 v8,14,v10
v_lshl_add_u32 v8,v9,4,v8
s_lshl_b32 s59,s47,16
s_lshl_b32 s60,s46,8
s_add_u32 s59,s59,s60
buffer_load_dwordx4 v[24:27],v8,s[4:7],s59 offen offset:0
buffer_load_dwordx4 v[28:31],v8,s[4:7],s59 offen offset:1024
buffer_load_dwordx4 v[32:35],v8,s[4:7],s59 offen offset:2048
buffer_load_dwordx4 v[36:39],v8,s[4:7],s59 offen offset:3072
s_add_u32 s59,s59,4096
buffer_load_dwordx4 v[40:43],v8,s[4:7],s59 offen offset:0
buffer_load_dwordx4 v[44:47],v8,s[4:7],s59 offen offset:1024
buffer_load_dwordx4 v[48:51],v8,s[4:7],s59 offen offset:2048
buffer_load_dwordx4 v[52:55],v8,s[4:7],s59 offen offset:3072
s_add_u32 s59,s59,4096
buffer_load_dwordx4 v[56:59],v8,s[4:7],s59 offen offset:0
buffer_load_dwordx4 v[60:63],v8,s[4:7],s59 offen offset:1024
buffer_load_dwordx4 v[64:67],v8,s[4:7],s59 offen offset:2048
buffer_load_dwordx4 v[68:71],v8,s[4:7],s59 offen offset:3072
s_add_u32 s59,s59,4096
buffer_load_dwordx4 v[72:75],v8,s[4:7],s59 offen offset:0
buffer_load_dwordx4 v[76:79],v8,s[4:7],s59 offen offset:1024
buffer_load_dwordx4 v[80:83],v8,s[4:7],s59 offen offset:2048
buffer_load_dwordx4 v[84:87],v8,s[4:7],s59 offen offset:3072
v_and_b32 v124,1,v1
v_lshlrev_b32 v124,4,v124
v_mov_b32 v125,0xffff
v_lshlrev_b32 v125,v124,v125
v_lshrrev_b32 v124,1,v9
v_cmp_eq_u32 vcc,0,v124
s_nop 1
v_cndmask_b32 v12,0,v125,vcc
v_cmp_eq_u32 vcc,1,v124
s_nop 1
v_cndmask_b32 v13,0,v125,vcc
v_cmp_eq_u32 vcc,2,v124
s_nop 1
v_cndmask_b32 v14,0,v125,vcc
v_cmp_eq_u32 vcc,3,v124
s_nop 1
v_cndmask_b32 v15,0,v125,vcc
s_waitcnt vmcnt(16)
v_lshlrev_b32 v96,16,v88
v_and_b32 v97,0xffff0000,v88
v_lshlrev_b32 v98,16,v89
v_and_b32 v99,0xffff0000,v89
v_lshlrev_b32 v100,16,v90
v_and_b32 v101,0xffff0000,v90
v_lshlrev_b32 v102,16,v91
v_and_b32 v103,0xffff0000,v91
v_readfirstlane_b32 s78,v96
s_nop 1
v_pk_add_f32 v[108:109],v[96:97],s[78:79] op_sel_hi:[1,0] neg_lo:[0,1] neg_hi:[0,1]
v_pk_add_f32 v[110:111],v[98:99],s[78:79] op_sel_hi:[1,0] neg_lo:[0,1] neg_hi:[0,1]
v_pk_add_f32 v[112:113],v[100:101],s[78:79] op_sel_hi:[1,0] neg_lo:[0,1] neg_hi:[0,1]
v_pk_add_f32 v[114:115],v[102:103],s[78:79] op_sel_hi:[1,0] neg_lo:[0,1] neg_hi:[0,1]
v_pk_add_f32 v[116:117],v[108:109],v[110:111]
v_pk_mul_f32 v[118:119],v[108:109],v[108:109]
v_pk_add_f32 v[120:121],v[112:113],v[114:115]
v_pk_fma_f32 v[118:119],v[110:111],v[110:111],v[118:119]
v_pk_add_f32 v[116:117],v[116:117],v[120:121]
v_pk_fma_f32 v[118:119],v[112:113],v[112:113],v[118:119]
v_add_f32 v116,v116,v117
v_pk_fma_f32 v[118:119],v[114:115],v[114:115],v[118:119]
v_add_f32 v118,v118,v119
s_nop 1
v_permlane32_swap_b32 v116,v118
v_add_f32 v116,v116,v118
s_nop 1
v_add_f32_dpp v116,v116,v116 row_ror:8 row_mask:0xf bank_mask:0xf
s_nop 1
v_add_f32_dpp v116,v116,v116 row_ror:4 row_mask:0xf bank_mask:0xf
s_nop 1
v_add_f32_dpp v116,v116,v116 row_ror:2 row_mask:0xf bank_mask:0xf
s_nop 1
v_add_f32_dpp v116,v116,v116 row_ror:1 row_mask:0xf bank_mask:0xf
v_mov_b32 v118,v116
s_nop 1
v_permlane16_swap_b32 v116,v118
v_add_f32 v116,v116,v118
v_mul_f32 v116,0x3b000000,v116
v_mov_b32 v118,v116
s_nop 1
v_permlane32_swap_b32 v116,v118
v_fma_f32 v118,-v116,v116,v118
v_add_f32 v116,s78,v116
v_max_f32 v118,0,v118
v_cvt_pk_bf16_f32 v118,v116,v118
v_lshlrev_b32 v116,16,v118
v_and_b32 v118,0xffff0000,v118
v_add_f32 v118,0x3727c5ac,v118
v_cvt_pk_bf16_f32 v118,v118,v118
v_and_b32 v118,0xffff0000,v118
v_sqrt_f32 v118,v118
v_pk_add_f32 v[108:109],v[96:97],v[116:117] op_sel_hi:[1,0] neg_lo:[0,1] neg_hi:[0,1]
v_pk_add_f32 v[110:111],v[98:99],v[116:117] op_sel_hi:[1,0] neg_lo:[0,1] neg_hi:[0,1]
v_pk_add_f32 v[112:113],v[100:101],v[116:117] op_sel_hi:[1,0] neg_lo:[0,1] neg_hi:[0,1]
v_pk_add_f32 v[114:115],v[102:103],v[116:117] op_sel_hi:[1,0] neg_lo:[0,1] neg_hi:[0,1]
v_cvt_pk_bf16_f32 v118,v118,v118
v_and_b32 v118,0xffff0000,v118
v_rcp_f32 v118,v118
v_cvt_pk_bf16_f32 v104,v108,v109
v_cvt_pk_bf16_f32 v105,v110,v111
v_cvt_pk_bf16_f32 v106,v112,v113
v_cvt_pk_bf16_f32 v107,v114,v115
v_lshlrev_b32 v108,16,v104
v_and_b32 v109,0xffff0000,v104
v_lshlrev_b32 v110,16,v105
v_and_b32 v111,0xffff0000,v105
v_lshlrev_b32 v112,16,v106
v_and_b32 v113,0xffff0000,v106
v_lshlrev_b32 v114,16,v107
v_and_b32 v115,0xffff0000,v107
v_pk_mul_f32 v[108:109],v[108:109],v[118:119] op_sel_hi:[1,0]
v_pk_mul_f32 v[110:111],v[110:111],v[118:119] op_sel_hi:[1,0]
v_pk_mul_f32 v[112:113],v[112:113],v[118:119] op_sel_hi:[1,0]
v_pk_mul_f32 v[114:115],v[114:115],v[118:119] op_sel_hi:[1,0]
v_cvt_pk_bf16_f32 v104,v108,v109
v_cvt_pk_bf16_f32 v105,v110,v111
v_cvt_pk_bf16_f32 v106,v112,v113
v_cvt_pk_bf16_f32 v107,v114,v115
s_mov_b32 s58,0x01000100
s_mov_b32 s59,0x03020302
v_perm_b32 v88,v104,v104,s58
v_perm_b32 v89,v104,v104,s59
v_perm_b32 v90,v105,v105,s58
v_perm_b32 v91,v105,v105,s59
v_perm_b32 v92,v106,v106,s58
v_perm_b32 v93,v106,v106,s59
v_perm_b32 v94,v107,v107,s58
v_perm_b32 v95,v107,v107,s59
v_lshlrev_b32 v8,5,v1
s_lshl_b32 s58,s46,11
s_add_u32 s58,s58,139264
v_add_u32 v8,s58,v8
ds_write_b128 v8,v[88:91]
ds_write_b128 v8,v[92:95] offset:16
s_lshl_b32 s59,s46,9
s_add_u32 s59,s58,s59
v_lshlrev_b32 v8,7,v10
v_add_u32 v8,s59,v8
s_waitcnt lgkmcnt(0)
ds_read_b128 v[108:111],v18 offset:0
ds_read_b128 v[88:91],v8 offset:0
ds_read_b128 v[92:95],v8 offset:16
ds_read_b128 v[112:115],v18 offset:1024
s_waitcnt lgkmcnt(1)
v_and_b32 v124,v12,v88
v_and_b32 v125,v13,v88
v_and_b32 v126,v14,v88
v_and_b32 v127,v15,v88
s_nop 1
v_mfma_f32_16x16x32_bf16 v[116:119],v[124:127],v[108:111],0
ds_read_b128 v[108:111],v18 offset:2048
s_waitcnt lgkmcnt(1)
v_and_b32 v124,v12,v89
v_and_b32 v125,v13,v89
v_and_b32 v126,v14,v89
v_and_b32 v127,v15,v89
s_nop 1
v_mfma_f32_16x16x32_bf16 v[116:119],v[124:127],v[112:115],v[116:119]
ds_read_b128 v[112:115],v18 offset:3072
s_waitcnt lgkmcnt(1)
v_and_b32 v124,v12,v90
v_and_b32 v125,v13,v90
v_and_b32 v126,v14,v90
v_and_b32 v127,v15,v90
s_nop 1
v_mfma_f32_16x16x32_bf16 v[116:119],v[124:127],v[108:111],v[116:119]
ds_read_b128 v[108:111],v18 offset:4096
s_waitcnt lgkmcnt(1)
v_and_b32 v124,v12,v91
v_and_b32 v125,v13,v91
v_and_b32 v126,v14,v91
v_and_b32 v127,v15,v91
s_nop 1
v_mfma_f32_16x16x32_bf16 v[116:119],v[124:127],v[112:115],v[116:119]
ds_read_b128 v[112:115],v18 offset:5120
s_waitcnt lgkmcnt(1)
v_and_b32 v124,v12,v92
v_and_b32 v125,v13,v92
v_and_b32 v126,v14,v92
v_and_b32 v127,v15,v92
s_nop 1
v_mfma_f32_16x16x32_bf16 v[116:119],v[124:127],v[108:111],v[116:119]
ds_read_b128 v[108:111],v18 offset:6144
s_waitcnt lgkmcnt(1)
v_and_b32 v124,v12,v93
v_and_b32 v125,v13,v93
v_and_b32 v126,v14,v93
v_and_b32 v127,v15,v93
s_nop 1
v_mfma_f32_16x16x32_bf16 v[116:119],v[124:127],v[112:115],v[116:119]
ds_read_b128 v[112:115],v18 offset:7168
s_waitcnt lgkmcnt(1)
v_and_b32 v124,v12,v94
v_and_b32 v125,v13,v94
v_and_b32 v126,v14,v94
v_and_b32 v127,v15,v94
s_nop 1
v_mfma_f32_16x16x32_bf16 v[116:119],v[124:127],v[108:111],v[116:119]
ds_read_b128 v[108:111],v18 offset:8192
s_waitcnt lgkmcnt(1)
v_and_b32 v124,v12,v95
v_and_b32 v125,v13,v95
v_and_b32 v126,v14,v95
v_and_b32 v127,v15,v95
s_nop 1
v_mfma_f32_16x16x32_bf16 v[116:119],v[124:127],v[112:115],v[116:119]
ds_read_b128 v[88:91],v8 offset:32
ds_read_b128 v[92:95],v8 offset:48
ds_read_b128 v[112:115],v18 offset:9216
s_waitcnt lgkmcnt(1)
v_and_b32 v124,v12,v88
v_and_b32 v125,v13,v88
v_and_b32 v126,v14,v88
v_and_b32 v127,v15,v88
s_nop 1
v_mfma_f32_16x16x32_bf16 v[116:119],v[124:127],v[108:111],v[116:119]
ds_read_b128 v[108:111],v18 offset:10240
s_waitcnt lgkmcnt(1)
v_and_b32 v124,v12,v89
v_and_b32 v125,v13,v89
v_and_b32 v126,v14,v89
v_and_b32 v127,v15,v89
s_nop 1
v_mfma_f32_16x16x32_bf16 v[116:119],v[124:127],v[112:115],v[116:119]
ds_read_b128 v[112:115],v18 offset:11264
s_waitcnt lgkmcnt(1)
v_and_b32 v124,v12,v90
v_and_b32 v125,v13,v90
v_and_b32 v126,v14,v90
v_and_b32 v127,v15,v90
s_nop 1
v_mfma_f32_16x16x32_bf16 v[116:119],v[124:127],v[108:111],v[116:119]
ds_read_b128 v[108:111],v18 offset:12288
s_waitcnt lgkmcnt(1)
v_and_b32 v124,v12,v91
v_and_b32 v125,v13,v91
v_and_b32 v126,v14,v91
v_and_b32 v127,v15,v91
s_nop 1
v_mfma_f32_16x16x32_bf16 v[116:119],v[124:127],v[112:115],v[116:119]
ds_read_b128 v[112:115],v18 offset:13312
s_waitcnt lgkmcnt(1)
v_and_b32 v124,v12,v92
v_and_b32 v125,v13,v92
v_and_b32 v126,v14,v92
v_and_b32 v127,v15,v92
s_nop 1
v_mfma_f32_16x16x32_bf16 v[116:119],v[124:127],v[108:111],v[116:119]
ds_read_b128 v[108:111],v18 offset:14336
s_waitcnt lgkmcnt(1)
v_and_b32 v124,v12,v93
v_and_b32 v125,v13,v93
v_and_b32 v126,v14,v93
v_and_b32 v127,v15,v93
s_nop 1
v_mfma_f32_16x16x32_bf16 v[116:119],v[124:127],v[112:115],v[116:119]
ds_read_b128 v[112:115],v18 offset:15360
s_waitcnt lgkmcnt(1)
v_and_b32 v124,v12,v94
v_and_b32 v125,v13,v94
v_and_b32 v126,v14,v94
v_and_b32 v127,v15,v94
s_nop 1
v_mfma_f32_16x16x32_bf16 v[116:119],v[124:127],v[108:111],v[116:119]
ds_read_b128 v[108:111],v18 offset:16384
s_waitcnt lgkmcnt(1)
v_and_b32 v124,v12,v95
v_and_b32 v125,v13,v95
v_and_b32 v126,v14,v95
v_and_b32 v127,v15,v95
s_nop 1
v_mfma_f32_16x16x32_bf16 v[116:119],v[124:127],v[112:115],v[116:119]
ds_read_b128 v[88:91],v8 offset:64
ds_read_b128 v[92:95],v8 offset:80
ds_read_b128 v[112:115],v18 offset:17408
s_waitcnt lgkmcnt(1)
v_and_b32 v124,v12,v88
v_and_b32 v125,v13,v88
v_and_b32 v126,v14,v88
v_and_b32 v127,v15,v88
s_nop 1
v_mfma_f32_16x16x32_bf16 v[116:119],v[124:127],v[108:111],v[116:119]
ds_read_b128 v[108:111],v18 offset:18432
s_waitcnt lgkmcnt(1)
v_and_b32 v124,v12,v89
v_and_b32 v125,v13,v89
v_and_b32 v126,v14,v89
v_and_b32 v127,v15,v89
s_nop 1
v_mfma_f32_16x16x32_bf16 v[116:119],v[124:127],v[112:115],v[116:119]
ds_read_b128 v[112:115],v18 offset:19456
s_waitcnt lgkmcnt(1)
v_and_b32 v124,v12,v90
v_and_b32 v125,v13,v90
v_and_b32 v126,v14,v90
v_and_b32 v127,v15,v90
s_nop 1
v_mfma_f32_16x16x32_bf16 v[116:119],v[124:127],v[108:111],v[116:119]
ds_read_b128 v[108:111],v18 offset:20480
s_waitcnt lgkmcnt(1)
v_and_b32 v124,v12,v91
v_and_b32 v125,v13,v91
v_and_b32 v126,v14,v91
v_and_b32 v127,v15,v91
s_nop 1
v_mfma_f32_16x16x32_bf16 v[116:119],v[124:127],v[112:115],v[116:119]
ds_read_b128 v[112:115],v18 offset:21504
s_waitcnt lgkmcnt(1)
v_and_b32 v124,v12,v92
v_and_b32 v125,v13,v92
v_and_b32 v126,v14,v92
v_and_b32 v127,v15,v92
s_nop 1
v_mfma_f32_16x16x32_bf16 v[116:119],v[124:127],v[108:111],v[116:119]
ds_read_b128 v[108:111],v18 offset:22528
s_waitcnt lgkmcnt(1)
v_and_b32 v124,v12,v93
v_and_b32 v125,v13,v93
v_and_b32 v126,v14,v93
v_and_b32 v127,v15,v93
s_nop 1
v_mfma_f32_16x16x32_bf16 v[116:119],v[124:127],v[112:115],v[116:119]
ds_read_b128 v[112:115],v18 offset:23552
s_waitcnt lgkmcnt(1)
v_and_b32 v124,v12,v94
v_and_b32 v125,v13,v94
v_and_b32 v126,v14,v94
v_and_b32 v127,v15,v94
s_nop 1
v_mfma_f32_16x16x32_bf16 v[116:119],v[124:127],v[108:111],v[116:119]
ds_read_b128 v[108:111],v18 offset:24576
s_waitcnt lgkmcnt(1)
v_and_b32 v124,v12,v95
v_and_b32 v125,v13,v95
v_and_b32 v126,v14,v95
v_and_b32 v127,v15,v95
s_nop 1
v_mfma_f32_16x16x32_bf16 v[116:119],v[124:127],v[112:115],v[116:119]
ds_read_b128 v[88:91],v8 offset:96
ds_read_b128 v[92:95],v8 offset:112
ds_read_b128 v[112:115],v18 offset:25600
s_waitcnt lgkmcnt(1)
v_and_b32 v124,v12,v88
v_and_b32 v125,v13,v88
v_and_b32 v126,v14,v88
v_and_b32 v127,v15,v88
s_nop 1
v_mfma_f32_16x16x32_bf16 v[116:119],v[124:127],v[108:111],v[116:119]
ds_read_b128 v[108:111],v18 offset:26624
s_waitcnt lgkmcnt(1)
v_and_b32 v124,v12,v89
v_and_b32 v125,v13,v89
v_and_b32 v126,v14,v89
v_and_b32 v127,v15,v89
s_nop 1
v_mfma_f32_16x16x32_bf16 v[116:119],v[124:127],v[112:115],v[116:119]
ds_read_b128 v[112:115],v18 offset:27648
s_waitcnt lgkmcnt(1)
v_and_b32 v124,v12,v90
v_and_b32 v125,v13,v90
v_and_b32 v126,v14,v90
v_and_b32 v127,v15,v90
s_nop 1
v_mfma_f32_16x16x32_bf16 v[116:119],v[124:127],v[108:111],v[116:119]
ds_read_b128 v[108:111],v18 offset:28672
s_waitcnt lgkmcnt(1)
v_and_b32 v124,v12,v91
v_and_b32 v125,v13,v91
v_and_b32 v126,v14,v91
v_and_b32 v127,v15,v91
s_nop 1
v_mfma_f32_16x16x32_bf16 v[116:119],v[124:127],v[112:115],v[116:119]
ds_read_b128 v[112:115],v18 offset:29696
s_waitcnt lgkmcnt(1)
v_and_b32 v124,v12,v92
v_and_b32 v125,v13,v92
v_and_b32 v126,v14,v92
v_and_b32 v127,v15,v92
s_nop 1
v_mfma_f32_16x16x32_bf16 v[116:119],v[124:127],v[108:111],v[116:119]
ds_read_b128 v[108:111],v18 offset:30720
s_waitcnt lgkmcnt(1)
v_and_b32 v124,v12,v93
v_and_b32 v125,v13,v93
v_and_b32 v126,v14,v93
v_and_b32 v127,v15,v93
s_nop 1
v_mfma_f32_16x16x32_bf16 v[116:119],v[124:127],v[112:115],v[116:119]
ds_read_b128 v[112:115],v18 offset:31744
s_waitcnt lgkmcnt(1)
v_and_b32 v124,v12,v94
v_and_b32 v125,v13,v94
v_and_b32 v126,v14,v94
v_and_b32 v127,v15,v94
s_nop 1
v_mfma_f32_16x16x32_bf16 v[116:119],v[124:127],v[108:111],v[116:119]
s_waitcnt lgkmcnt(0)
v_and_b32 v124,v12,v95
v_and_b32 v125,v13,v95
v_and_b32 v126,v14,v95
v_and_b32 v127,v15,v95
s_nop 1
v_mfma_f32_16x16x32_bf16 v[116:119],v[124:127],v[112:115],v[116:119]
v_lshlrev_b32 v8,5,v9
v_and_b32 v124,1,v10
v_lshl_add_u32 v8,v124,4,v8
v_lshrrev_b32 v124,1,v10
v_lshl_add_u32 v8,v124,11,v8
s_lshl_b32 s60,s46,9
s_add_u32 s60,s60,147456
v_add_u32 v8,s60,v8
ds_write_b128 v8,v[116:119]
v_lshlrev_b32 v8,2,v1
v_add_u32 v8,147456,v8
s_waitcnt lgkmcnt(0)
s_barrier
ds_read2st64_b32 v[88:89],v8 offset0:0 offset1:1
ds_read2st64_b32 v[90:91],v8 offset0:2 offset1:3
ds_read2st64_b32 v[92:93],v8 offset0:4 offset1:5
ds_read2st64_b32 v[94:95],v8 offset0:6 offset1:7
s_waitcnt lgkmcnt(0)
v_pk_add_f32 v[88:89],v[88:89],v[90:91]
v_pk_add_f32 v[92:93],v[92:93],v[94:95]
v_pk_add_f32 v[88:89],v[88:89],v[92:93]
v_cvt_pk_bf16_f32 v88,v88,v88
v_and_b32 v88,0xffff0000,v88
v_cvt_pk_bf16_f32 v89,v89,v89
v_and_b32 v89,0xffff0000,v89
v_mul_f32 v90,0xbfb8aa3b,v88
v_exp_f32 v90,v90
s_nop 0
v_add_f32 v90,1.0,v90
v_rcp_f32 v90,v90
s_nop 0
v_mul_f32 v88,v88,v90
v_cvt_pk_bf16_f32 v88,v88,v88
v_and_b32 v88,0xffff0000,v88
v_mul_f32 v88,v88,v89
v_cvt_pk_bf16_f32 v88,v88,v88
v_lshlrev_b32 v8,2,v1
v_add_u32 v8,s58,v8
ds_write_b32 v8,v88
v_lshlrev_b32 v8,6,v10
v_add_u32 v8,s58,v8
s_waitcnt lgkmcnt(0)
ds_read_b128 v[88:91],v8
ds_read_b128 v[92:95],v8 offset:16
ds_read_b128 v[108:111],v8 offset:32
ds_read_b128 v[112:115],v8 offset:48
s_waitcnt vmcnt(0) lgkmcnt(0)
v_and_b32 v124,v12,v88
v_and_b32 v125,v13,v88
v_and_b32 v126,v14,v88
v_and_b32 v127,v15,v88
s_nop 1
v_mfma_f32_16x16x32_bf16 v[116:119],v[124:127],v[24:27],0
v_and_b32 v124,v12,v89
v_and_b32 v125,v13,v89
v_and_b32 v126,v14,v89
v_and_b32 v127,v15,v89
s_nop 1
v_mfma_f32_16x16x32_bf16 v[116:119],v[124:127],v[28:31],v[116:119]
v_and_b32 v124,v12,v90
v_and_b32 v125,v13,v90
v_and_b32 v126,v14,v90
v_and_b32 v127,v15,v90
s_nop 1
v_mfma_f32_16x16x32_bf16 v[116:119],v[124:127],v[32:35],v[116:119]
v_and_b32 v124,v12,v91
v_and_b32 v125,v13,v91
v_and_b32 v126,v14,v91
v_and_b32 v127,v15,v91
s_nop 1
v_mfma_f32_16x16x32_bf16 v[116:119],v[124:127],v[36:39],v[116:119]
v_and_b32 v124,v12,v92
v_and_b32 v125,v13,v92
v_and_b32 v126,v14,v92
v_and_b32 v127,v15,v92
s_nop 1
v_mfma_f32_16x16x32_bf16 v[116:119],v[124:127],v[40:43],v[116:119]
v_and_b32 v124,v12,v93
v_and_b32 v125,v13,v93
v_and_b32 v126,v14,v93
v_and_b32 v127,v15,v93
s_nop 1
v_mfma_f32_16x16x32_bf16 v[116:119],v[124:127],v[44:47],v[116:119]
v_and_b32 v124,v12,v94
v_and_b32 v125,v13,v94
v_and_b32 v126,v14,v94
v_and_b32 v127,v15,v94
s_nop 1
v_mfma_f32_16x16x32_bf16 v[116:119],v[124:127],v[48:51],v[116:119]
v_and_b32 v124,v12,v95
v_and_b32 v125,v13,v95
v_and_b32 v126,v14,v95
v_and_b32 v127,v15,v95
s_nop 1
v_mfma_f32_16x16x32_bf16 v[116:119],v[124:127],v[52:55],v[116:119]
v_and_b32 v124,v12,v108
v_and_b32 v125,v13,v108
v_and_b32 v126,v14,v108
v_and_b32 v127,v15,v108
s_nop 1
v_mfma_f32_16x16x32_bf16 v[116:119],v[124:127],v[56:59],v[116:119]
v_and_b32 v124,v12,v109
v_and_b32 v125,v13,v109
v_and_b32 v126,v14,v109
v_and_b32 v127,v15,v109
s_nop 1
v_mfma_f32_16x16x32_bf16 v[116:119],v[124:127],v[60:63],v[116:119]
v_and_b32 v124,v12,v110
v_and_b32 v125,v13,v110
v_and_b32 v126,v14,v110
v_and_b32 v127,v15,v110
s_nop 1
v_mfma_f32_16x16x32_bf16 v[116:119],v[124:127],v[64:67],v[116:119]
v_and_b32 v124,v12,v111
v_and_b32 v125,v13,v111
v_and_b32 v126,v14,v111
v_and_b32 v127,v15,v111
s_nop 1
v_mfma_f32_16x16x32_bf16 v[116:119],v[124:127],v[68:71],v[116:119]
v_and_b32 v124,v12,v112
v_and_b32 v125,v13,v112
v_and_b32 v126,v14,v112
v_and_b32 v127,v15,v112
s_nop 1
v_mfma_f32_16x16x32_bf16 v[116:119],v[124:127],v[72:75],v[116:119]
v_and_b32 v124,v12,v113
v_and_b32 v125,v13,v113
v_and_b32 v126,v14,v113
v_and_b32 v127,v15,v113
s_nop 1
v_mfma_f32_16x16x32_bf16 v[116:119],v[124:127],v[76:79],v[116:119]
v_and_b32 v124,v12,v114
v_and_b32 v125,v13,v114
v_and_b32 v126,v14,v114
v_and_b32 v127,v15,v114
s_nop 1
v_mfma_f32_16x16x32_bf16 v[116:119],v[124:127],v[80:83],v[116:119]
v_and_b32 v124,v12,v115
v_and_b32 v125,v13,v115
v_and_b32 v126,v14,v115
v_and_b32 v127,v15,v115
s_nop 1
v_mfma_f32_16x16x32_bf16 v[116:119],v[124:127],v[84:87],v[116:119]
v_lshlrev_b32 v8,4,v9
v_and_b32 v124,1,v10
v_lshl_add_u32 v8,v124,3,v8
v_and_b32 v124,2,v10
v_lshl_add_u32 v8,v124,30,v8
s_lshl_b32 s65,s51,15
s_add_u32 s65,s65,92274688
s_lshl_b32 s59,s47,10
s_lshl_b32 s60,s46,8
s_add_u32 s59,s59,s60
s_add_u32 s59,s59,s65
v_cvt_pk_bf16_f32 v24,v116,v117
v_cvt_pk_bf16_f32 v25,v118,v119
buffer_store_dwordx2 v[24:25],v8,s[8:11],s59 offen
s_lshl_b32 s59,s51,13
s_lshl2_add_u32 s59,s47,s59
s_add_u32 s59,s59,10486912
s_waitcnt vmcnt(0)
s_barrier
s_or_b32 s59,s59,s52
buffer_store_dword v17,off,s[8:11],s59
s_cmp_lg_u32 s47,0
s_cbranch_scc1 L_moed_56
s_lshl_b32 s59,s51,13
s_add_u32 s59,s59,10486912
v_and_b32 v124,31,v1
v_lshlrev_b32 v124,2,v124
L_fw_57:
buffer_load_dword v125,v124,s[8:11],s59 offen sc1
s_sub_u32 s49,s49,1
s_cbranch_scc1 L_abort
s_waitcnt vmcnt(0)
v_cmp_eq_u32 vcc,0,v125
s_cbranch_vccnz L_fw_57
s_add_u32 s63,s65,0
buffer_load_dwordx4 v[24:27],v22,s[8:11],s63 offen sc1
s_add_u32 s63,s65,4096
buffer_load_dwordx4 v[28:31],v22,s[8:11],s63 offen sc1
s_add_u32 s63,s65,8192
buffer_load_dwordx4 v[32:35],v22,s[8:11],s63 offen sc1
s_add_u32 s63,s65,12288
buffer_load_dwordx4 v[36:39],v22,s[8:11],s63 offen sc1
s_add_u32 s63,s65,16384
buffer_load_dwordx4 v[40:43],v22,s[8:11],s63 offen sc1
s_add_u32 s63,s65,20480
buffer_load_dwordx4 v[44:47],v22,s[8:11],s63 offen sc1
s_add_u32 s63,s65,24576
buffer_load_dwordx4 v[48:51],v22,s[8:11],s63 offen sc1
s_add_u32 s63,s65,28672
buffer_load_dwordx4 v[52:55],v22,s[8:11],s63 offen sc1
v_and_b32 v64,15,v1
v_and_b32 v65,1,v1
v_lshlrev_b32 v65,4,v65
v_mov_b32 v66,0x3f80
v_lshlrev_b32 v66,v65,v66
v_lshrrev_b32 v64,1,v64
v_cmp_eq_u32 vcc,0,v64
s_nop 1
v_cndmask_b32 v56,0,v66,vcc
v_cmp_eq_u32 vcc,1,v64
s_nop 1
v_cndmask_b32 v57,0,v66,vcc
v_cmp_eq_u32 vcc,2,v64
s_nop 1
v_cndmask_b32 v58,0,v66,vcc
v_cmp_eq_u32 vcc,3,v64
s_nop 1
v_cndmask_b32 v59,0,v66,vcc
s_waitcnt vmcnt(7)
s_nop 0
v_mfma_f32_16x16x32_bf16 v[60:63],v[56:59],v[24:27],0
s_waitcnt vmcnt(6)
v_mfma_f32_16x16x32_bf16 v[60:63],v[56:59],v[28:31],v[60:63]
s_waitcnt vmcnt(5)
v_mfma_f32_16x16x32_bf16 v[60:63],v[56:59],v[32:35],v[60:63]
s_waitcnt vmcnt(4)
v_mfma_f32_16x16x32_bf16 v[60:63],v[56:59],v[36:39],v[60:63]
s_waitcnt vmcnt(3)
v_mfma_f32_16x16x32_bf16 v[60:63],v[56:59],v[40:43],v[60:63]
s_waitcnt vmcnt(2)
v_mfma_f32_16x16x32_bf16 v[60:63],v[56:59],v[44:47],v[60:63]
s_waitcnt vmcnt(1)
v_mfma_f32_16x16x32_bf16 v[60:63],v[56:59],v[48:51],v[60:63]
s_waitcnt vmcnt(0)
v_mfma_f32_16x16x32_bf16 v[60:63],v[56:59],v[52:55],v[60:63]
s_nop 7
ds_write_b128 v21,v[60:63]
s_waitcnt lgkmcnt(0)
s_barrier
s_cmp_lg_u32 s46,0
s_cbranch_scc1 L_moed_56
v_lshlrev_b32 v56,5,v1
v_add_u32 v56,155648,v56
ds_read_b128 v[24:27],v56
ds_read_b128 v[28:31],v56 offset:16
s_and_b32 s59,s55,0xffff0000
s_xor_b32 s60,s59,0x80000000
s_xor_b32 s61,s59,0xffff0000
s_cmp_lt_i32 s59,0
s_cselect_b32 s59,s60,s61
v_mov_b32 v56,s59
v_mul_f32 v56,0xbfb8aa3b,v56
v_exp_f32 v56,v56
s_nop 0
v_add_f32 v56,1.0,v56
v_rcp_f32 v56,v56
s_nop 0
v_cvt_pk_bf16_f32 v56,v56,v56
v_and_b32 v56,0xffff0000,v56
v_lshlrev_b32 v48,16,v104
v_and_b32 v49,0xffff0000,v104
v_lshlrev_b32 v50,16,v105
v_and_b32 v51,0xffff0000,v105
v_lshlrev_b32 v52,16,v106
v_and_b32 v53,0xffff0000,v106
v_lshlrev_b32 v54,16,v107
v_and_b32 v55,0xffff0000,v107
s_waitcnt lgkmcnt(0)
v_cvt_pk_bf16_f32 v40,v24,v25
v_cvt_pk_bf16_f32 v41,v26,v27
v_cvt_pk_bf16_f32 v42,v28,v29
v_cvt_pk_bf16_f32 v43,v30,v31
v_lshlrev_b32 v24,16,v40
v_and_b32 v25,0xffff0000,v40
v_lshlrev_b32 v26,16,v41
v_and_b32 v27,0xffff0000,v41
v_lshlrev_b32 v28,16,v42
v_and_b32 v29,0xffff0000,v42
v_lshlrev_b32 v30,16,v43
v_and_b32 v31,0xffff0000,v43
v_mul_f32 v24,v24,v56
v_mul_f32 v25,v25,v56
v_mul_f32 v26,v26,v56
v_mul_f32 v27,v27,v56
v_mul_f32 v28,v28,v56
v_mul_f32 v29,v29,v56
v_mul_f32 v30,v30,v56
v_mul_f32 v31,v31,v56
v_cvt_pk_bf16_f32 v40,v24,v25
v_cvt_pk_bf16_f32 v41,v26,v27
v_cvt_pk_bf16_f32 v42,v28,v29
v_cvt_pk_bf16_f32 v43,v30,v31
v_lshlrev_b32 v24,16,v40
v_and_b32 v25,0xffff0000,v40
v_lshlrev_b32 v26,16,v41
v_and_b32 v27,0xffff0000,v41
v_lshlrev_b32 v28,16,v42
v_and_b32 v29,0xffff0000,v42
v_lshlrev_b32 v30,16,v43
v_and_b32 v31,0xffff0000,v43
v_add_f32 v24,v24,v48
v_add_f32 v25,v25,v49
v_add_f32 v26,v26,v50
v_add_f32 v27,v27,v51
v_add_f32 v28,v28,v52
v_add_f32 v29,v29,v53
v_add_f32 v30,v30,v54
v_add_f32 v31,v31,v55
v_cvt_pk_bf16_f32 v40,v24,v25
v_cvt_pk_bf16_f32 v41,v26,v27
v_cvt_pk_bf16_f32 v42,v28,v29
v_cvt_pk_bf16_f32 v43,v30,v31
v_lshlrev_b32 v24,16,v40
v_and_b32 v25,0xffff0000,v40
v_lshlrev_b32 v26,16,v41
v_and_b32 v27,0xffff0000,v41
v_lshlrev_b32 v28,16,v42
v_and_b32 v29,0xffff0000,v42
v_lshlrev_b32 v30,16,v43
v_and_b32 v31,0xffff0000,v43
v_add_f32 v96,v96,v24
v_add_f32 v97,v97,v25
v_add_f32 v98,v98,v26
v_add_f32 v99,v99,v27
v_add_f32 v100,v100,v28
v_add_f32 v101,v101,v29
v_add_f32 v102,v102,v30
v_add_f32 v103,v103,v31
v_cvt_pk_bf16_f32 v80,v96,v97
v_cvt_pk_bf16_f32 v81,v98,v99
v_cvt_pk_bf16_f32 v82,v100,v101
v_cvt_pk_bf16_f32 v83,v102,v103
s_mov_b32 s4,s40
s_mov_b32 s5,s41
s_mov_b32 s6,2097152
s_mov_b32 s7,0x20000
buffer_store_dwordx4 v[80:83],v0,s[4:7],s56 offen sc1
L_moed_56:
s_endpgm
L_abort:
s_endpgm
L_spread:
s_mov_b32 s3,-1
s_lshr_b32 s48,s2,5
s_and_b32 s47,s2,31
s_branch L_roles
L_ra_6:
s_and_b32 s56,s48,1
s_lshl_b32 s56,s56,12
s_add_u32 s56,s56,s50
s_and_b32 s57,s47,15
s_lshl_b32 s57,s57,13
s_add_u32 s56,s56,s57
s_mov_b32 s4,s22
s_mov_b32 s5,s23
s_mov_b32 s6,4194304
s_mov_b32 s7,0x20000
s_add_u32 s57,s56,0
buffer_load_dwordx4 v[24:27],v0,s[4:7],s57 offen
s_add_u32 s57,s56,131072
buffer_load_dwordx4 v[24:27],v0,s[4:7],s57 offen
s_add_u32 s57,s56,262144
buffer_load_dwordx4 v[24:27],v0,s[4:7],s57 offen
s_add_u32 s57,s56,393216
buffer_load_dwordx4 v[24:27],v0,s[4:7],s57 offen
s_add_u32 s57,s56,524288
buffer_load_dwordx4 v[24:27],v0,s[4:7],s57 offen
s_add_u32 s57,s56,655360
buffer_load_dwordx4 v[24:27],v0,s[4:7],s57 offen
s_add_u32 s57,s56,786432
buffer_load_dwordx4 v[24:27],v0,s[4:7],s57 offen
s_add_u32 s57,s56,917504
buffer_load_dwordx4 v[24:27],v0,s[4:7],s57 offen
s_add_u32 s57,s56,1048576
buffer_load_dwordx4 v[24:27],v0,s[4:7],s57 offen
s_add_u32 s57,s56,1179648
buffer_load_dwordx4 v[24:27],v0,s[4:7],s57 offen
s_waitcnt vmcnt(9)
s_add_u32 s57,s56,1310720
buffer_load_dwordx4 v[24:27],v0,s[4:7],s57 offen
s_barrier
s_cmp_lg_u32 s46,0
s_cbranch_scc1 L_ar_60
v_mov_b32 v8,128
v_mov_b32 v9,s53
s_mov_b64 exec,1
buffer_atomic_add v9,v8,s[12:15],0 offen
s_mov_b64 exec,-1
L_ar_60:
s_mov_b32 s53,0
s_waitcnt vmcnt(9)
s_add_u32 s57,s56,1441792
buffer_load_dwordx4 v[24:27],v0,s[4:7],s57 offen
s_waitcnt vmcnt(9)
s_add_u32 s57,s56,1572864
buffer_load_dwordx4 v[24:27],v0,s[4:7],s57 offen
s_waitcnt vmcnt(9)
s_add_u32 s57,s56,1703936
buffer_load_dwordx4 v[24:27],v0,s[4:7],s57 offen
s_waitcnt vmcnt(9)
s_add_u32 s57,s56,1835008
buffer_load_dwordx4 v[24:27],v0,s[4:7],s57 offen
s_waitcnt vmcnt(9)
s_add_u32 s57,s56,1966080
buffer_load_dwordx4 v[24:27],v0,s[4:7],s57 offen
s_waitcnt vmcnt(9)
s_add_u32 s57,s56,2097152
buffer_load_dwordx4 v[24:27],v0,s[4:7],s57 offen
s_waitcnt vmcnt(9)
s_add_u32 s57,s56,2228224
buffer_load_dwordx4 v[24:27],v0,s[4:7],s57 offen
s_waitcnt vmcnt(9)
s_add_u32 s57,s56,2359296
buffer_load_dwordx4 v[24:27],v0,s[4:7],s57 offen
s_waitcnt vmcnt(9)
s_add_u32 s57,s56,2490368
buffer_load_dwordx4 v[24:27],v0,s[4:7],s57 offen
s_waitcnt vmcnt(9)
s_add_u32 s57,s56,2621440
buffer_load_dwordx4 v[24:27],v0,s[4:7],s57 offen
s_waitcnt vmcnt(9)
s_add_u32 s57,s56,2752512
buffer_load_dwordx4 v[24:27],v0,s[4:7],s57 offen
s_waitcnt vmcnt(9)
s_add_u32 s57,s56,2883584
buffer_load_dwordx4 v[24:27],v0,s[4:7],s57 offen
s_waitcnt vmcnt(9)
s_add_u32 s57,s56,3014656
buffer_load_dwordx4 v[24:27],v0,s[4:7],s57 offen
s_waitcnt vmcnt(9)
s_add_u32 s57,s56,3145728
buffer_load_dwordx4 v[24:27],v0,s[4:7],s57 offen
s_waitcnt vmcnt(9)
s_add_u32 s57,s56,3276800
buffer_load_dwordx4 v[24:27],v0,s[4:7],s57 offen
s_waitcnt vmcnt(9)
s_add_u32 s57,s56,3407872
buffer_load_dwordx4 v[24:27],v0,s[4:7],s57 offen
s_waitcnt vmcnt(9)
s_add_u32 s57,s56,3538944
buffer_load_dwordx4 v[24:27],v0,s[4:7],s57 offen
s_waitcnt vmcnt(9)
s_add_u32 s57,s56,3670016
buffer_load_dwordx4 v[24:27],v0,s[4:7],s57 offen
s_waitcnt vmcnt(9)
s_add_u32 s57,s56,3801088
buffer_load_dwordx4 v[24:27],v0,s[4:7],s57 offen
s_waitcnt vmcnt(9)
s_add_u32 s57,s56,3932160
buffer_load_dwordx4 v[24:27],v0,s[4:7],s57 offen
s_waitcnt vmcnt(9)
s_add_u32 s57,s56,4063232
buffer_load_dwordx4 v[24:27],v0,s[4:7],s57 offen
s_mov_b32 s4,s24
s_mov_b32 s5,s25
s_mov_b32 s6,4194304
s_mov_b32 s7,0x20000
s_waitcnt vmcnt(9)
s_add_u32 s57,s56,0
buffer_load_dwordx4 v[24:27],v0,s[4:7],s57 offen
s_waitcnt vmcnt(9)
s_add_u32 s57,s56,131072
buffer_load_dwordx4 v[24:27],v0,s[4:7],s57 offen
s_waitcnt vmcnt(9)
s_add_u32 s57,s56,262144
buffer_load_dwordx4 v[24:27],v0,s[4:7],s57 offen
s_waitcnt vmcnt(9)
s_add_u32 s57,s56,393216
buffer_load_dwordx4 v[24:27],v0,s[4:7],s57 offen
s_waitcnt vmcnt(9)
s_add_u32 s57,s56,524288
buffer_load_dwordx4 v[24:27],v0,s[4:7],s57 offen
s_waitcnt vmcnt(9)
s_add_u32 s57,s56,655360
buffer_load_dwordx4 v[24:27],v0,s[4:7],s57 offen
s_waitcnt vmcnt(9)
s_add_u32 s57,s56,786432
buffer_load_dwordx4 v[24:27],v0,s[4:7],s57 offen
s_waitcnt vmcnt(9)
s_add_u32 s57,s56,917504
buffer_load_dwordx4 v[24:27],v0,s[4:7],s57 offen
s_waitcnt vmcnt(9)
s_add_u32 s57,s56,1048576
buffer_load_dwordx4 v[24:27],v0,s[4:7],s57 offen
s_waitcnt vmcnt(9)
s_add_u32 s57,s56,1179648
buffer_load_dwordx4 v[24:27],v0,s[4:7],s57 offen
s_waitcnt vmcnt(9)
s_add_u32 s57,s56,1310720
buffer_load_dwordx4 v[24:27],v0,s[4:7],s57 offen
s_waitcnt vmcnt(9)
s_add_u32 s57,s56,1441792
buffer_load_dwordx4 v[24:27],v0,s[4:7],s57 offen
s_waitcnt vmcnt(9)
s_add_u32 s57,s56,1572864
buffer_load_dwordx4 v[24:27],v0,s[4:7],s57 offen
s_waitcnt vmcnt(9)
s_add_u32 s57,s56,1703936
buffer_load_dwordx4 v[24:27],v0,s[4:7],s57 offen
s_waitcnt vmcnt(9)
s_add_u32 s57,s56,1835008
buffer_load_dwordx4 v[24:27],v0,s[4:7],s57 offen
s_waitcnt vmcnt(9)
s_add_u32 s57,s56,1966080
buffer_load_dwordx4 v[24:27],v0,s[4:7],s57 offen
s_waitcnt vmcnt(9)
s_add_u32 s57,s56,2097152
buffer_load_dwordx4 v[24:27],v0,s[4:7],s57 offen
s_waitcnt vmcnt(9)
s_add_u32 s57,s56,2228224
buffer_load_dwordx4 v[24:27],v0,s[4:7],s57 offen
s_waitcnt vmcnt(9)
s_add_u32 s57,s56,2359296
buffer_load_dwordx4 v[24:27],v0,s[4:7],s57 offen
s_waitcnt vmcnt(9)
s_add_u32 s57,s56,2490368
buffer_load_dwordx4 v[24:27],v0,s[4:7],s57 offen
s_waitcnt vmcnt(9)
s_add_u32 s57,s56,2621440
buffer_load_dwordx4 v[24:27],v0,s[4:7],s57 offen
s_waitcnt vmcnt(9)
s_add_u32 s57,s56,2752512
buffer_load_dwordx4 v[24:27],v0,s[4:7],s57 offen
s_waitcnt vmcnt(9)
s_add_u32 s57,s56,2883584
buffer_load_dwordx4 v[24:27],v0,s[4:7],s57 offen
s_waitcnt vmcnt(9)
s_add_u32 s57,s56,3014656
buffer_load_dwordx4 v[24:27],v0,s[4:7],s57 offen
s_waitcnt vmcnt(9)
s_add_u32 s57,s56,3145728
buffer_load_dwordx4 v[24:27],v0,s[4:7],s57 offen
s_waitcnt vmcnt(9)
s_add_u32 s57,s56,3276800
buffer_load_dwordx4 v[24:27],v0,s[4:7],s57 offen
s_waitcnt vmcnt(9)
s_add_u32 s57,s56,3407872
buffer_load_dwordx4 v[24:27],v0,s[4:7],s57 offen
s_waitcnt vmcnt(9)
s_add_u32 s57,s56,3538944
buffer_load_dwordx4 v[24:27],v0,s[4:7],s57 offen
s_waitcnt vmcnt(9)
s_add_u32 s57,s56,3670016
buffer_load_dwordx4 v[24:27],v0,s[4:7],s57 offen
s_waitcnt vmcnt(9)
s_add_u32 s57,s56,3801088
buffer_load_dwordx4 v[24:27],v0,s[4:7],s57 offen
s_waitcnt vmcnt(9)
s_add_u32 s57,s56,3932160
buffer_load_dwordx4 v[24:27],v0,s[4:7],s57 offen
s_waitcnt vmcnt(9)
s_add_u32 s57,s56,4063232
buffer_load_dwordx4 v[24:27],v0,s[4:7],s57 offen
s_mov_b32 s4,s20
s_mov_b32 s5,s21
s_mov_b32 s6,4194304
s_mov_b32 s7,0x20000
s_waitcnt vmcnt(9)
s_add_u32 s57,s56,0
buffer_load_dwordx4 v[24:27],v0,s[4:7],s57 offen
s_waitcnt vmcnt(9)
s_add_u32 s57,s56,131072
buffer_load_dwordx4 v[24:27],v0,s[4:7],s57 offen
s_waitcnt vmcnt(9)
s_add_u32 s57,s56,262144
buffer_load_dwordx4 v[24:27],v0,s[4:7],s57 offen
s_waitcnt vmcnt(9)
s_add_u32 s57,s56,393216
buffer_load_dwordx4 v[24:27],v0,s[4:7],s57 offen
s_waitcnt vmcnt(9)
s_add_u32 s57,s56,524288
buffer_load_dwordx4 v[24:27],v0,s[4:7],s57 offen
s_waitcnt vmcnt(9)
s_add_u32 s57,s56,655360
buffer_load_dwordx4 v[24:27],v0,s[4:7],s57 offen
s_waitcnt vmcnt(9)
s_add_u32 s57,s56,786432
buffer_load_dwordx4 v[24:27],v0,s[4:7],s57 offen
s_waitcnt vmcnt(9)
s_add_u32 s57,s56,917504
buffer_load_dwordx4 v[24:27],v0,s[4:7],s57 offen
s_waitcnt vmcnt(9)
s_add_u32 s57,s56,1048576
buffer_load_dwordx4 v[24:27],v0,s[4:7],s57 offen
s_waitcnt vmcnt(9)
s_add_u32 s57,s56,1179648
buffer_load_dwordx4 v[24:27],v0,s[4:7],s57 offen
s_waitcnt vmcnt(9)
s_add_u32 s57,s56,1310720
buffer_load_dwordx4 v[24:27],v0,s[4:7],s57 offen
s_waitcnt vmcnt(9)
s_add_u32 s57,s56,1441792
buffer_load_dwordx4 v[24:27],v0,s[4:7],s57 offen
s_waitcnt vmcnt(9)
s_add_u32 s57,s56,1572864
buffer_load_dwordx4 v[24:27],v0,s[4:7],s57 offen
s_waitcnt vmcnt(9)
s_add_u32 s57,s56,1703936
buffer_load_dwordx4 v[24:27],v0,s[4:7],s57 offen
s_waitcnt vmcnt(9)
s_add_u32 s57,s56,1835008
buffer_load_dwordx4 v[24:27],v0,s[4:7],s57 offen
s_waitcnt vmcnt(9)
s_add_u32 s57,s56,1966080
buffer_load_dwordx4 v[24:27],v0,s[4:7],s57 offen
s_waitcnt vmcnt(9)
s_add_u32 s57,s56,2097152
buffer_load_dwordx4 v[24:27],v0,s[4:7],s57 offen
s_waitcnt vmcnt(9)
s_add_u32 s57,s56,2228224
buffer_load_dwordx4 v[24:27],v0,s[4:7],s57 offen
s_waitcnt vmcnt(9)
s_add_u32 s57,s56,2359296
buffer_load_dwordx4 v[24:27],v0,s[4:7],s57 offen
s_waitcnt vmcnt(9)
s_add_u32 s57,s56,2490368
buffer_load_dwordx4 v[24:27],v0,s[4:7],s57 offen
s_waitcnt vmcnt(9)
s_add_u32 s57,s56,2621440
buffer_load_dwordx4 v[24:27],v0,s[4:7],s57 offen
s_waitcnt vmcnt(9)
s_add_u32 s57,s56,2752512
buffer_load_dwordx4 v[24:27],v0,s[4:7],s57 offen
s_waitcnt vmcnt(9)
s_add_u32 s57,s56,2883584
buffer_load_dwordx4 v[24:27],v0,s[4:7],s57 offen
s_waitcnt vmcnt(9)
s_add_u32 s57,s56,3014656
buffer_load_dwordx4 v[24:27],v0,s[4:7],s57 offen
s_waitcnt vmcnt(9)
s_add_u32 s57,s56,3145728
buffer_load_dwordx4 v[24:27],v0,s[4:7],s57 offen
s_waitcnt vmcnt(9)
s_add_u32 s57,s56,3276800
buffer_load_dwordx4 v[24:27],v0,s[4:7],s57 offen
s_waitcnt vmcnt(9)
s_add_u32 s57,s56,3407872
buffer_load_dwordx4 v[24:27],v0,s[4:7],s57 offen
s_waitcnt vmcnt(9)
s_add_u32 s57,s56,3538944
buffer_load_dwordx4 v[24:27],v0,s[4:7],s57 offen
s_waitcnt vmcnt(9)
s_add_u32 s57,s56,3670016
buffer_load_dwordx4 v[24:27],v0,s[4:7],s57 offen
s_waitcnt vmcnt(9)
s_add_u32 s57,s56,3801088
buffer_load_dwordx4 v[24:27],v0,s[4:7],s57 offen
s_waitcnt vmcnt(9)
s_add_u32 s57,s56,3932160
buffer_load_dwordx4 v[24:27],v0,s[4:7],s57 offen
s_waitcnt vmcnt(9)
s_add_u32 s57,s56,4063232
buffer_load_dwordx4 v[24:27],v0,s[4:7],s57 offen
L_rb_7:
s_mov_b32 s4,s26
s_mov_b32 s5,s27
s_mov_b32 s6,4194304
s_mov_b32 s7,0x20000
v_and_b32 v2,15,v1
v_lshlrev_b32 v2,4,v2
v_lshrrev_b32 v3,4,v1
v_lshl_add_u32 v2,v3,13,v2
s_and_b32 s56,s47,15
s_lshl_b32 s56,s56,18
s_lshl_b32 s57,s46,8
s_add_u32 s56,s56,s57
s_mov_b32 s61,0x05040100
s_mov_b32 s62,0x07060302
s_add_u32 s57,s56,0
buffer_load_dwordx4 v[24:27],v2,s[4:7],s57 offen offset:0
buffer_load_dwordx4 v[28:31],v2,s[4:7],s57 offen offset:1024
buffer_load_dwordx4 v[32:35],v2,s[4:7],s57 offen offset:2048
buffer_load_dwordx4 v[36:39],v2,s[4:7],s57 offen offset:3072
s_add_u32 s57,s56,4096
buffer_load_dwordx4 v[40:43],v2,s[4:7],s57 offen offset:0
buffer_load_dwordx4 v[44:47],v2,s[4:7],s57 offen offset:1024
buffer_load_dwordx4 v[48:51],v2,s[4:7],s57 offen offset:2048
buffer_load_dwordx4 v[52:55],v2,s[4:7],s57 offen offset:3072
s_add_u32 s57,s56,32768
buffer_load_dwordx4 v[56:59],v2,s[4:7],s57 offen offset:0
buffer_load_dwordx4 v[60:63],v2,s[4:7],s57 offen offset:1024
buffer_load_dwordx4 v[64:67],v2,s[4:7],s57 offen offset:2048
buffer_load_dwordx4 v[68:71],v2,s[4:7],s57 offen offset:3072
s_add_u32 s57,s56,36864
buffer_load_dwordx4 v[72:75],v2,s[4:7],s57 offen offset:0
buffer_load_dwordx4 v[76:79],v2,s[4:7],s57 offen offset:1024
buffer_load_dwordx4 v[80:83],v2,s[4:7],s57 offen offset:2048
buffer_load_dwordx4 v[84:87],v2,s[4:7],s57 offen offset:3072
s_add_u32 s57,s56,65536
buffer_load_dwordx4 v[88:91],v2,s[4:7],s57 offen offset:0
buffer_load_dwordx4 v[92:95],v2,s[4:7],s57 offen offset:1024
buffer_load_dwordx4 v[96:99],v2,s[4:7],s57 offen offset:2048
buffer_load_dwordx4 v[100:103],v2,s[4:7],s57 offen offset:3072
s_add_u32 s57,s56,69632
buffer_load_dwordx4 v[104:107],v2,s[4:7],s57 offen offset:0
buffer_load_dwordx4 v[108:111],v2,s[4:7],s57 offen offset:1024
buffer_load_dwordx4 v[112:115],v2,s[4:7],s57 offen offset:2048
buffer_load_dwordx4 v[116:119],v2,s[4:7],s57 offen offset:3072
s_add_u32 s57,s56,98304
buffer_load_dwordx4 v[120:123],v2,s[4:7],s57 offen offset:0
buffer_load_dwordx4 v[124:127],v2,s[4:7],s57 offen offset:1024
buffer_load_dwordx4 v[128:131],v2,s[4:7],s57 offen offset:2048
buffer_load_dwordx4 v[132:135],v2,s[4:7],s57 offen offset:3072
s_add_u32 s57,s56,102400
buffer_load_dwordx4 v[136:139],v2,s[4:7],s57 offen offset:0
buffer_load_dwordx4 v[140:143],v2,s[4:7],s57 offen offset:1024
buffer_load_dwordx4 v[144:147],v2,s[4:7],s57 offen offset:2048
buffer_load_dwordx4 v[148:151],v2,s[4:7],s57 offen offset:3072
s_add_u32 s57,s56,131072
buffer_load_dwordx4 v[152:155],v2,s[4:7],s57 offen offset:0
buffer_load_dwordx4 v[156:159],v2,s[4:7],s57 offen offset:1024
buffer_load_dwordx4 v[160:163],v2,s[4:7],s57 offen offset:2048
buffer_load_dwordx4 v[164:167],v2,s[4:7],s57 offen offset:3072
s_add_u32 s57,s56,135168
buffer_load_dwordx4 v[168:171],v2,s[4:7],s57 offen offset:0
buffer_load_dwordx4 v[172:175],v2,s[4:7],s57 offen offset:1024
buffer_load_dwordx4 v[176:179],v2,s[4:7],s57 offen offset:2048
buffer_load_dwordx4 v[180:183],v2,s[4:7],s57 offen offset:3072
s_add_u32 s57,s56,163840
buffer_load_dwordx4 v[184:187],v2,s[4:7],s57 offen offset:0
buffer_load_dwordx4 v[188:191],v2,s[4:7],s57 offen offset:1024
buffer_load_dwordx4 v[192:195],v2,s[4:7],s57 offen offset:2048
buffer_load_dwordx4 v[196:199],v2,s[4:7],s57 offen offset:3072
s_add_u32 s57,s56,167936
buffer_load_dwordx4 v[200:203],v2,s[4:7],s57 offen offset:0
buffer_load_dwordx4 v[204:207],v2,s[4:7],s57 offen offset:1024
buffer_load_dwordx4 v[208:211],v2,s[4:7],s57 offen offset:2048
buffer_load_dwordx4 v[212:215],v2,s[4:7],s57 offen offset:3072
s_waitcnt vmcnt(40)
v_perm_b32 v216,v28,v24,s61
v_perm_b32 v217,v36,v32,s61
v_perm_b32 v218,v44,v40,s61
v_perm_b32 v219,v52,v48,s61
v_accvgpr_write_b32 a0,v216
v_accvgpr_write_b32 a1,v217
v_accvgpr_write_b32 a2,v218
v_accvgpr_write_b32 a3,v219
v_perm_b32 v216,v28,v24,s62
v_perm_b32 v217,v36,v32,s62
v_perm_b32 v218,v44,v40,s62
v_perm_b32 v219,v52,v48,s62
v_accvgpr_write_b32 a4,v216
v_accvgpr_write_b32 a5,v217
v_accvgpr_write_b32 a6,v218
v_accvgpr_write_b32 a7,v219
v_perm_b32 v216,v29,v25,s61
v_perm_b32 v217,v37,v33,s61
v_perm_b32 v218,v45,v41,s61
v_perm_b32 v219,v53,v49,s61
v_accvgpr_write_b32 a8,v216
v_accvgpr_write_b32 a9,v217
v_accvgpr_write_b32 a10,v218
v_accvgpr_write_b32 a11,v219
v_perm_b32 v216,v29,v25,s62
v_perm_b32 v217,v37,v33,s62
v_perm_b32 v218,v45,v41,s62
v_perm_b32 v219,v53,v49,s62
v_accvgpr_write_b32 a12,v216
v_accvgpr_write_b32 a13,v217
v_accvgpr_write_b32 a14,v218
v_accvgpr_write_b32 a15,v219
v_perm_b32 v216,v30,v26,s61
v_perm_b32 v217,v38,v34,s61
v_perm_b32 v218,v46,v42,s61
v_perm_b32 v219,v54,v50,s61
v_accvgpr_write_b32 a16,v216
v_accvgpr_write_b32 a17,v217
v_accvgpr_write_b32 a18,v218
v_accvgpr_write_b32 a19,v219
v_perm_b32 v216,v30,v26,s62
v_perm_b32 v217,v38,v34,s62
v_perm_b32 v218,v46,v42,s62
v_perm_b32 v219,v54,v50,s62
v_accvgpr_write_b32 a20,v216
v_accvgpr_write_b32 a21,v217
v_accvgpr_write_b32 a22,v218
v_accvgpr_write_b32 a23,v219
v_perm_b32 v216,v31,v27,s61
v_perm_b32 v217,v39,v35,s61
v_perm_b32 v218,v47,v43,s61
v_perm_b32 v219,v55,v51,s61
v_accvgpr_write_b32 a24,v216
v_accvgpr_write_b32 a25,v217
v_accvgpr_write_b32 a26,v218
v_accvgpr_write_b32 a27,v219
v_perm_b32 v216,v31,v27,s62
v_perm_b32 v217,v39,v35,s62
v_perm_b32 v218,v47,v43,s62
v_perm_b32 v219,v55,v51,s62
v_accvgpr_write_b32 a28,v216
v_accvgpr_write_b32 a29,v217
v_accvgpr_write_b32 a30,v218
v_accvgpr_write_b32 a31,v219
s_add_u32 s57,s56,196608
buffer_load_dwordx4 v[24:27],v2,s[4:7],s57 offen offset:0
buffer_load_dwordx4 v[28:31],v2,s[4:7],s57 offen offset:1024
buffer_load_dwordx4 v[32:35],v2,s[4:7],s57 offen offset:2048
buffer_load_dwordx4 v[36:39],v2,s[4:7],s57 offen offset:3072
s_add_u32 s57,s56,200704
buffer_load_dwordx4 v[40:43],v2,s[4:7],s57 offen offset:0
buffer_load_dwordx4 v[44:47],v2,s[4:7],s57 offen offset:1024
buffer_load_dwordx4 v[48:51],v2,s[4:7],s57 offen offset:2048
buffer_load_dwordx4 v[52:55],v2,s[4:7],s57 offen offset:3072
s_barrier
s_cmp_lg_u32 s46,0
s_cbranch_scc1 L_ar_61
v_mov_b32 v8,128
v_mov_b32 v9,s53
s_mov_b64 exec,1
buffer_atomic_add v9,v8,s[12:15],0 offen
s_mov_b64 exec,-1
L_ar_61:
s_mov_b32 s53,0
s_waitcnt vmcnt(40)
v_perm_b32 v216,v60,v56,s61
v_perm_b32 v217,v68,v64,s61
v_perm_b32 v218,v76,v72,s61
v_perm_b32 v219,v84,v80,s61
v_accvgpr_write_b32 a32,v216
v_accvgpr_write_b32 a33,v217
v_accvgpr_write_b32 a34,v218
v_accvgpr_write_b32 a35,v219
v_perm_b32 v216,v60,v56,s62
v_perm_b32 v217,v68,v64,s62
v_perm_b32 v218,v76,v72,s62
v_perm_b32 v219,v84,v80,s62
v_accvgpr_write_b32 a36,v216
v_accvgpr_write_b32 a37,v217
v_accvgpr_write_b32 a38,v218
v_accvgpr_write_b32 a39,v219
v_perm_b32 v216,v61,v57,s61
v_perm_b32 v217,v69,v65,s61
v_perm_b32 v218,v77,v73,s61
v_perm_b32 v219,v85,v81,s61
v_accvgpr_write_b32 a40,v216
v_accvgpr_write_b32 a41,v217
v_accvgpr_write_b32 a42,v218
v_accvgpr_write_b32 a43,v219
v_perm_b32 v216,v61,v57,s62
v_perm_b32 v217,v69,v65,s62
v_perm_b32 v218,v77,v73,s62
v_perm_b32 v219,v85,v81,s62
v_accvgpr_write_b32 a44,v216
v_accvgpr_write_b32 a45,v217
v_accvgpr_write_b32 a46,v218
v_accvgpr_write_b32 a47,v219
v_perm_b32 v216,v62,v58,s61
v_perm_b32 v217,v70,v66,s61
v_perm_b32 v218,v78,v74,s61
v_perm_b32 v219,v86,v82,s61
v_accvgpr_write_b32 a48,v216
v_accvgpr_write_b32 a49,v217
v_accvgpr_write_b32 a50,v218
v_accvgpr_write_b32 a51,v219
v_perm_b32 v216,v62,v58,s62
v_perm_b32 v217,v70,v66,s62
v_perm_b32 v218,v78,v74,s62
v_perm_b32 v219,v86,v82,s62
v_accvgpr_write_b32 a52,v216
v_accvgpr_write_b32 a53,v217
v_accvgpr_write_b32 a54,v218
v_accvgpr_write_b32 a55,v219
v_perm_b32 v216,v63,v59,s61
v_perm_b32 v217,v71,v67,s61
v_perm_b32 v218,v79,v75,s61
v_perm_b32 v219,v87,v83,s61
v_accvgpr_write_b32 a56,v216
v_accvgpr_write_b32 a57,v217
v_accvgpr_write_b32 a58,v218
v_accvgpr_write_b32 a59,v219
v_perm_b32 v216,v63,v59,s62
v_perm_b32 v217,v71,v67,s62
v_perm_b32 v218,v79,v75,s62
v_perm_b32 v219,v87,v83,s62
v_accvgpr_write_b32 a60,v216
v_accvgpr_write_b32 a61,v217
v_accvgpr_write_b32 a62,v218
v_accvgpr_write_b32 a63,v219
s_add_u32 s57,s56,229376
buffer_load_dwordx4 v[56:59],v2,s[4:7],s57 offen offset:0
buffer_load_dwordx4 v[60:63],v2,s[4:7],s57 offen offset:1024
buffer_load_dwordx4 v[64:67],v2,s[4:7],s57 offen offset:2048
buffer_load_dwordx4 v[68:71],v2,s[4:7],s57 offen offset:3072
s_add_u32 s57,s56,233472
buffer_load_dwordx4 v[72:75],v2,s[4:7],s57 offen offset:0
buffer_load_dwordx4 v[76:79],v2,s[4:7],s57 offen offset:1024
buffer_load_dwordx4 v[80:83],v2,s[4:7],s57 offen offset:2048
buffer_load_dwordx4 v[84:87],v2,s[4:7],s57 offen offset:3072
s_waitcnt vmcnt(40)
v_perm_b32 v216,v92,v88,s61
v_perm_b32 v217,v100,v96,s61
v_perm_b32 v218,v108,v104,s61
v_perm_b32 v219,v116,v112,s61
v_accvgpr_write_b32 a64,v216
v_accvgpr_write_b32 a65,v217
v_accvgpr_write_b32 a66,v218
v_accvgpr_write_b32 a67,v219
v_perm_b32 v216,v92,v88,s62
v_perm_b32 v217,v100,v96,s62
v_perm_b32 v218,v108,v104,s62
v_perm_b32 v219,v116,v112,s62
v_accvgpr_write_b32 a68,v216
v_accvgpr_write_b32 a69,v217
v_accvgpr_write_b32 a70,v218
v_accvgpr_write_b32 a71,v219
v_perm_b32 v216,v93,v89,s61
v_perm_b32 v217,v101,v97,s61
v_perm_b32 v218,v109,v105,s61
v_perm_b32 v219,v117,v113,s61
v_accvgpr_write_b32 a72,v216
v_accvgpr_write_b32 a73,v217
v_accvgpr_write_b32 a74,v218
v_accvgpr_write_b32 a75,v219
v_perm_b32 v216,v93,v89,s62
v_perm_b32 v217,v101,v97,s62
v_perm_b32 v218,v109,v105,s62
v_perm_b32 v219,v117,v113,s62
v_accvgpr_write_b32 a76,v216
v_accvgpr_write_b32 a77,v217
v_accvgpr_write_b32 a78,v218
v_accvgpr_write_b32 a79,v219
v_perm_b32 v216,v94,v90,s61
v_perm_b32 v217,v102,v98,s61
v_perm_b32 v218,v110,v106,s61
v_perm_b32 v219,v118,v114,s61
v_accvgpr_write_b32 a80,v216
v_accvgpr_write_b32 a81,v217
v_accvgpr_write_b32 a82,v218
v_accvgpr_write_b32 a83,v219
v_perm_b32 v216,v94,v90,s62
v_perm_b32 v217,v102,v98,s62
v_perm_b32 v218,v110,v106,s62
v_perm_b32 v219,v118,v114,s62
v_accvgpr_write_b32 a84,v216
v_accvgpr_write_b32 a85,v217
v_accvgpr_write_b32 a86,v218
v_accvgpr_write_b32 a87,v219
v_perm_b32 v216,v95,v91,s61
v_perm_b32 v217,v103,v99,s61
v_perm_b32 v218,v111,v107,s61
v_perm_b32 v219,v119,v115,s61
v_accvgpr_write_b32 a88,v216
v_accvgpr_write_b32 a89,v217
v_accvgpr_write_b32 a90,v218
v_accvgpr_write_b32 a91,v219
v_perm_b32 v216,v95,v91,s62
v_perm_b32 v217,v103,v99,s62
v_perm_b32 v218,v111,v107,s62
v_perm_b32 v219,v119,v115,s62
v_accvgpr_write_b32 a92,v216
v_accvgpr_write_b32 a93,v217
v_accvgpr_write_b32 a94,v218
v_accvgpr_write_b32 a95,v219
s_waitcnt vmcnt(32)
v_perm_b32 v216,v124,v120,s61
v_perm_b32 v217,v132,v128,s61
v_perm_b32 v218,v140,v136,s61
v_perm_b32 v219,v148,v144,s61
v_accvgpr_write_b32 a96,v216
v_accvgpr_write_b32 a97,v217
v_accvgpr_write_b32 a98,v218
v_accvgpr_write_b32 a99,v219
v_perm_b32 v216,v124,v120,s62
v_perm_b32 v217,v132,v128,s62
v_perm_b32 v218,v140,v136,s62
v_perm_b32 v219,v148,v144,s62
v_accvgpr_write_b32 a100,v216
v_accvgpr_write_b32 a101,v217
v_accvgpr_write_b32 a102,v218
v_accvgpr_write_b32 a103,v219
v_perm_b32 v216,v125,v121,s61
v_perm_b32 v217,v133,v129,s61
v_perm_b32 v218,v141,v137,s61
v_perm_b32 v219,v149,v145,s61
v_accvgpr_write_b32 a104,v216
v_accvgpr_write_b32 a105,v217
v_accvgpr_write_b32 a106,v218
v_accvgpr_write_b32 a107,v219
v_perm_b32 v216,v125,v121,s62
v_perm_b32 v217,v133,v129,s62
v_perm_b32 v218,v141,v137,s62
v_perm_b32 v219,v149,v145,s62
v_accvgpr_write_b32 a108,v216
v_accvgpr_write_b32 a109,v217
v_accvgpr_write_b32 a110,v218
v_accvgpr_write_b32 a111,v219
v_perm_b32 v216,v126,v122,s61
v_perm_b32 v217,v134,v130,s61
v_perm_b32 v218,v142,v138,s61
v_perm_b32 v219,v150,v146,s61
v_accvgpr_write_b32 a112,v216
v_accvgpr_write_b32 a113,v217
v_accvgpr_write_b32 a114,v218
v_accvgpr_write_b32 a115,v219
v_perm_b32 v216,v126,v122,s62
v_perm_b32 v217,v134,v130,s62
v_perm_b32 v218,v142,v138,s62
v_perm_b32 v219,v150,v146,s62
v_accvgpr_write_b32 a116,v216
v_accvgpr_write_b32 a117,v217
v_accvgpr_write_b32 a118,v218
v_accvgpr_write_b32 a119,v219
v_perm_b32 v216,v127,v123,s61
v_perm_b32 v217,v135,v131,s61
v_perm_b32 v218,v143,v139,s61
v_perm_b32 v219,v151,v147,s61
v_accvgpr_write_b32 a120,v216
v_accvgpr_write_b32 a121,v217
v_accvgpr_write_b32 a122,v218
v_accvgpr_write_b32 a123,v219
v_perm_b32 v216,v127,v123,s62
v_perm_b32 v217,v135,v131,s62
v_perm_b32 v218,v143,v139,s62
v_perm_b32 v219,v151,v147,s62
v_accvgpr_write_b32 a124,v216
v_accvgpr_write_b32 a125,v217
v_accvgpr_write_b32 a126,v218
v_accvgpr_write_b32 a127,v219
s_waitcnt vmcnt(24)
v_perm_b32 v216,v156,v152,s61
v_perm_b32 v217,v164,v160,s61
v_perm_b32 v218,v172,v168,s61
v_perm_b32 v219,v180,v176,s61
v_accvgpr_write_b32 a128,v216
v_accvgpr_write_b32 a129,v217
v_accvgpr_write_b32 a130,v218
v_accvgpr_write_b32 a131,v219
v_perm_b32 v216,v156,v152,s62
v_perm_b32 v217,v164,v160,s62
v_perm_b32 v218,v172,v168,s62
v_perm_b32 v219,v180,v176,s62
v_accvgpr_write_b32 a132,v216
v_accvgpr_write_b32 a133,v217
v_accvgpr_write_b32 a134,v218
v_accvgpr_write_b32 a135,v219
v_perm_b32 v216,v157,v153,s61
v_perm_b32 v217,v165,v161,s61
v_perm_b32 v218,v173,v169,s61
v_perm_b32 v219,v181,v177,s61
v_accvgpr_write_b32 a136,v216
v_accvgpr_write_b32 a137,v217
v_accvgpr_write_b32 a138,v218
v_accvgpr_write_b32 a139,v219
v_perm_b32 v216,v157,v153,s62
v_perm_b32 v217,v165,v161,s62
v_perm_b32 v218,v173,v169,s62
v_perm_b32 v219,v181,v177,s62
v_accvgpr_write_b32 a140,v216
v_accvgpr_write_b32 a141,v217
v_accvgpr_write_b32 a142,v218
v_accvgpr_write_b32 a143,v219
v_perm_b32 v216,v158,v154,s61
v_perm_b32 v217,v166,v162,s61
v_perm_b32 v218,v174,v170,s61
v_perm_b32 v219,v182,v178,s61
v_accvgpr_write_b32 a144,v216
v_accvgpr_write_b32 a145,v217
v_accvgpr_write_b32 a146,v218
v_accvgpr_write_b32 a147,v219
v_perm_b32 v216,v158,v154,s62
v_perm_b32 v217,v166,v162,s62
v_perm_b32 v218,v174,v170,s62
v_perm_b32 v219,v182,v178,s62
v_accvgpr_write_b32 a148,v216
v_accvgpr_write_b32 a149,v217
v_accvgpr_write_b32 a150,v218
v_accvgpr_write_b32 a151,v219
v_perm_b32 v216,v159,v155,s61
v_perm_b32 v217,v167,v163,s61
v_perm_b32 v218,v175,v171,s61
v_perm_b32 v219,v183,v179,s61
v_accvgpr_write_b32 a152,v216
v_accvgpr_write_b32 a153,v217
v_accvgpr_write_b32 a154,v218
v_accvgpr_write_b32 a155,v219
v_perm_b32 v216,v159,v155,s62
v_perm_b32 v217,v167,v163,s62
v_perm_b32 v218,v175,v171,s62
v_perm_b32 v219,v183,v179,s62
v_accvgpr_write_b32 a156,v216
v_accvgpr_write_b32 a157,v217
v_accvgpr_write_b32 a158,v218
v_accvgpr_write_b32 a159,v219
s_waitcnt vmcnt(16)
v_perm_b32 v216,v188,v184,s61
v_perm_b32 v217,v196,v192,s61
v_perm_b32 v218,v204,v200,s61
v_perm_b32 v219,v212,v208,s61
v_accvgpr_write_b32 a160,v216
v_accvgpr_write_b32 a161,v217
v_accvgpr_write_b32 a162,v218
v_accvgpr_write_b32 a163,v219
v_perm_b32 v216,v188,v184,s62
v_perm_b32 v217,v196,v192,s62
v_perm_b32 v218,v204,v200,s62
v_perm_b32 v219,v212,v208,s62
v_accvgpr_write_b32 a164,v216
v_accvgpr_write_b32 a165,v217
v_accvgpr_write_b32 a166,v218
v_accvgpr_write_b32 a167,v219
v_perm_b32 v216,v189,v185,s61
v_perm_b32 v217,v197,v193,s61
v_perm_b32 v218,v205,v201,s61
v_perm_b32 v219,v213,v209,s61
v_accvgpr_write_b32 a168,v216
v_accvgpr_write_b32 a169,v217
v_accvgpr_write_b32 a170,v218
v_accvgpr_write_b32 a171,v219
v_perm_b32 v216,v189,v185,s62
v_perm_b32 v217,v197,v193,s62
v_perm_b32 v218,v205,v201,s62
v_perm_b32 v219,v213,v209,s62
v_accvgpr_write_b32 a172,v216
v_accvgpr_write_b32 a173,v217
v_accvgpr_write_b32 a174,v218
v_accvgpr_write_b32 a175,v219
v_perm_b32 v216,v190,v186,s61
v_perm_b32 v217,v198,v194,s61
v_perm_b32 v218,v206,v202,s61
v_perm_b32 v219,v214,v210,s61
v_accvgpr_write_b32 a176,v216
v_accvgpr_write_b32 a177,v217
v_accvgpr_write_b32 a178,v218
v_accvgpr_write_b32 a179,v219
v_perm_b32 v216,v190,v186,s62
v_perm_b32 v217,v198,v194,s62
v_perm_b32 v218,v206,v202,s62
v_perm_b32 v219,v214,v210,s62
v_accvgpr_write_b32 a180,v216
v_accvgpr_write_b32 a181,v217
v_accvgpr_write_b32 a182,v218
v_accvgpr_write_b32 a183,v219
v_perm_b32 v216,v191,v187,s61
v_perm_b32 v217,v199,v195,s61
v_perm_b32 v218,v207,v203,s61
v_perm_b32 v219,v215,v211,s61
v_accvgpr_write_b32 a184,v216
v_accvgpr_write_b32 a185,v217
v_accvgpr_write_b32 a186,v218
v_accvgpr_write_b32 a187,v219
v_perm_b32 v216,v191,v187,s62
v_perm_b32 v217,v199,v195,s62
v_perm_b32 v218,v207,v203,s62
v_perm_b32 v219,v215,v211,s62
v_accvgpr_write_b32 a188,v216
v_accvgpr_write_b32 a189,v217
v_accvgpr_write_b32 a190,v218
v_accvgpr_write_b32 a191,v219
s_waitcnt vmcnt(8)
v_perm_b32 v216,v28,v24,s61
v_perm_b32 v217,v36,v32,s61
v_perm_b32 v218,v44,v40,s61
v_perm_b32 v219,v52,v48,s61
v_accvgpr_write_b32 a192,v216
v_accvgpr_write_b32 a193,v217
v_accvgpr_write_b32 a194,v218
v_accvgpr_write_b32 a195,v219
v_perm_b32 v216,v28,v24,s62
v_perm_b32 v217,v36,v32,s62
v_perm_b32 v218,v44,v40,s62
v_perm_b32 v219,v52,v48,s62
v_accvgpr_write_b32 a196,v216
v_accvgpr_write_b32 a197,v217
v_accvgpr_write_b32 a198,v218
v_accvgpr_write_b32 a199,v219
v_perm_b32 v216,v29,v25,s61
v_perm_b32 v217,v37,v33,s61
v_perm_b32 v218,v45,v41,s61
v_perm_b32 v219,v53,v49,s61
v_accvgpr_write_b32 a200,v216
v_accvgpr_write_b32 a201,v217
v_accvgpr_write_b32 a202,v218
v_accvgpr_write_b32 a203,v219
v_perm_b32 v216,v29,v25,s62
v_perm_b32 v217,v37,v33,s62
v_perm_b32 v218,v45,v41,s62
v_perm_b32 v219,v53,v49,s62
v_accvgpr_write_b32 a204,v216
v_accvgpr_write_b32 a205,v217
v_accvgpr_write_b32 a206,v218
v_accvgpr_write_b32 a207,v219
v_perm_b32 v216,v30,v26,s61
v_perm_b32 v217,v38,v34,s61
v_perm_b32 v218,v46,v42,s61
v_perm_b32 v219,v54,v50,s61
v_accvgpr_write_b32 a208,v216
v_accvgpr_write_b32 a209,v217
v_accvgpr_write_b32 a210,v218
v_accvgpr_write_b32 a211,v219
v_perm_b32 v216,v30,v26,s62
v_perm_b32 v217,v38,v34,s62
v_perm_b32 v218,v46,v42,s62
v_perm_b32 v219,v54,v50,s62
v_accvgpr_write_b32 a212,v216
v_accvgpr_write_b32 a213,v217
v_accvgpr_write_b32 a214,v218
v_accvgpr_write_b32 a215,v219
v_perm_b32 v216,v31,v27,s61
v_perm_b32 v217,v39,v35,s61
v_perm_b32 v218,v47,v43,s61
v_perm_b32 v219,v55,v51,s61
v_accvgpr_write_b32 a216,v216
v_accvgpr_write_b32 a217,v217
v_accvgpr_write_b32 a218,v218
v_accvgpr_write_b32 a219,v219
v_perm_b32 v216,v31,v27,s62
v_perm_b32 v217,v39,v35,s62
v_perm_b32 v218,v47,v43,s62
v_perm_b32 v219,v55,v51,s62
v_accvgpr_write_b32 a220,v216
v_accvgpr_write_b32 a221,v217
v_accvgpr_write_b32 a222,v218
v_accvgpr_write_b32 a223,v219
s_waitcnt vmcnt(0)
v_perm_b32 v216,v60,v56,s61
v_perm_b32 v217,v68,v64,s61
v_perm_b32 v218,v76,v72,s61
v_perm_b32 v219,v84,v80,s61
v_accvgpr_write_b32 a224,v216
v_accvgpr_write_b32 a225,v217
v_accvgpr_write_b32 a226,v218
v_accvgpr_write_b32 a227,v219
v_perm_b32 v216,v60,v56,s62
v_perm_b32 v217,v68,v64,s62
v_perm_b32 v218,v76,v72,s62
v_perm_b32 v219,v84,v80,s62
v_accvgpr_write_b32 a228,v216
v_accvgpr_write_b32 a229,v217
v_accvgpr_write_b32 a230,v218
v_accvgpr_write_b32 a231,v219
v_perm_b32 v216,v61,v57,s61
v_perm_b32 v217,v69,v65,s61
v_perm_b32 v218,v77,v73,s61
v_perm_b32 v219,v85,v81,s61
v_accvgpr_write_b32 a232,v216
v_accvgpr_write_b32 a233,v217
v_accvgpr_write_b32 a234,v218
v_accvgpr_write_b32 a235,v219
v_perm_b32 v216,v61,v57,s62
v_perm_b32 v217,v69,v65,s62
v_perm_b32 v218,v77,v73,s62
v_perm_b32 v219,v85,v81,s62
v_accvgpr_write_b32 a236,v216
v_accvgpr_write_b32 a237,v217
v_accvgpr_write_b32 a238,v218
v_accvgpr_write_b32 a239,v219
v_perm_b32 v216,v62,v58,s61
v_perm_b32 v217,v70,v66,s61
v_perm_b32 v218,v78,v74,s61
v_perm_b32 v219,v86,v82,s61
v_accvgpr_write_b32 a240,v216
v_accvgpr_write_b32 a241,v217
v_accvgpr_write_b32 a242,v218
v_accvgpr_write_b32 a243,v219
v_perm_b32 v216,v62,v58,s62
v_perm_b32 v217,v70,v66,s62
v_perm_b32 v218,v78,v74,s62
v_perm_b32 v219,v86,v82,s62
v_accvgpr_write_b32 a244,v216
v_accvgpr_write_b32 a245,v217
v_accvgpr_write_b32 a246,v218
v_accvgpr_write_b32 a247,v219
v_perm_b32 v216,v63,v59,s61
v_perm_b32 v217,v71,v67,s61
v_perm_b32 v218,v79,v75,s61
v_perm_b32 v219,v87,v83,s61
v_accvgpr_write_b32 a248,v216
v_accvgpr_write_b32 a249,v217
v_accvgpr_write_b32 a250,v218
v_accvgpr_write_b32 a251,v219
v_perm_b32 v216,v63,v59,s62
v_perm_b32 v217,v71,v67,s62
v_perm_b32 v218,v79,v75,s62
v_perm_b32 v219,v87,v83,s62
v_accvgpr_write_b32 a252,v216
v_accvgpr_write_b32 a253,v217
v_accvgpr_write_b32 a254,v218
v_accvgpr_write_b32 a255,v219
v_mov_b32 v123,159744
s_cmp_lg_u32 s46,0
s_cbranch_scc1 L_gbd_63
v_mov_b32 v124,128
L_gb_62:
buffer_load_dword v125,v124,s[12:15],0 offen sc1
s_waitcnt vmcnt(0)
v_readfirstlane_b32 s56,v125
ds_write_b32 v123,v125
s_bitcmp1_b32 s56,8
s_cbranch_scc1 L_gbd_63
s_sleep 4
s_sub_u32 s49,s49,1
s_cmp_gt_i32 s49,0
s_cbranch_scc1 L_gb_62
s_branch L_abort
L_gbd_63:
s_waitcnt lgkmcnt(0)
s_barrier
ds_read_b32 v125,v123
s_waitcnt lgkmcnt(0)
v_readfirstlane_b32 s56,v125
s_barrier
s_lshr_b32 s56,s56,16
s_andn2_b32 s56,s56,s3
s_cbranch_scc1 L_spread
s_max_u32 s54,s48,5
s_sub_u32 s54,s54,5
s_lshl_b32 s54,s54,1
s_lshr_b32 s56,s47,4
s_add_u32 s54,s54,s56
s_cmp_lg_u32 s3,0
s_cbranch_scc1 L_wa
v_and_b32 v238,15,v1
v_and_b32 v239,1,v1
v_lshlrev_b32 v239,4,v239
v_mov_b32 v240,0x3f80
v_lshlrev_b32 v240,v239,v240
v_lshrrev_b32 v238,1,v238
v_cmp_eq_u32 vcc,0,v238
s_nop 1
v_cndmask_b32 v156,0,v240,vcc
v_cmp_eq_u32 vcc,1,v238
s_nop 1
v_cndmask_b32 v157,0,v240,vcc
v_cmp_eq_u32 vcc,2,v238
s_nop 1
v_cndmask_b32 v158,0,v240,vcc
v_cmp_eq_u32 vcc,3,v238
s_nop 1
v_cndmask_b32 v159,0,v240,vcc
s_mov_b32 s4,s32
s_mov_b32 s5,s33
s_mov_b32 s6,1024
s_mov_b32 s7,0x20000
buffer_load_dwordx4 v[224:227],v0,s[4:7],0 offen
v_and_b32 v238,15,v1
v_lshrrev_b32 v239,4,v1
v_lshlrev_b32 v240,2,v239
v_mov_b32 v241,0xf149f2ca
s_and_b32 s56,s46,1
s_lshl_b32 s56,s56,4
v_add_u32 v242,s56,v238
v_add_u32 v243,0,v240
v_cmp_gt_u32 vcc,v243,v242
s_nop 1
v_cndmask_b32 v8,0,v241,vcc
v_add_u32 v243,1,v240
v_cmp_gt_u32 vcc,v243,v242
s_nop 1
v_cndmask_b32 v9,0,v241,vcc
v_add_u32 v243,2,v240
v_cmp_gt_u32 vcc,v243,v242
s_nop 1
v_cndmask_b32 v10,0,v241,vcc
v_add_u32 v243,3,v240
v_cmp_gt_u32 vcc,v243,v242
s_nop 1
v_cndmask_b32 v11,0,v241,vcc
v_add_u32 v243,16,v240
v_cmp_gt_u32 vcc,v243,v242
s_nop 1
v_cndmask_b32 v12,0,v241,vcc
v_add_u32 v243,17,v240
v_cmp_gt_u32 vcc,v243,v242
s_nop 1
v_cndmask_b32 v13,0,v241,vcc
v_add_u32 v243,18,v240
v_cmp_gt_u32 vcc,v243,v242
s_nop 1
v_cndmask_b32 v14,0,v241,vcc
v_add_u32 v243,19,v240
v_cmp_gt_u32 vcc,v243,v242
s_nop 1
v_cndmask_b32 v15,0,v241,vcc
v_mov_b32 v152,s80
v_mov_b32 v145,0
v_mov_b32 v146,0
s_lshl_b32 s56,s46,12
s_add_u32 s56,s56,131072
v_add_u32 v3,s56,v0
v_add_u32 v4,131072,v0
s_lshl_b32 s56,s46,8
v_lshlrev_b32 v7,4,v238
v_add_u32 v7,s56,v7
v_lshl_add_u32 v5,v239,16,v7
v_lshlrev_b32 v6,1,v7
v_lshl_add_u32 v7,v239,10,v7
v_and_b32 v243,1,v239
v_lshl_add_u32 v6,v243,4,v6
v_lshrrev_b32 v243,1,v239
v_lshl_add_u32 v6,v243,12,v6
v_add_u32 v6,147456,v6
v_lshlrev_b32 v16,2,v1
v_lshlrev_b32 v21,3,v238
s_and_b32 s68,s47,15
s_lshl_b32 s56,s68,10
v_add_u32 v5,s56,v5
s_lshl_b32 s56,s68,15
v_add_u32 v7,s56,v7
s_lshl_b32 s69,s54,20
s_add_u32 s69,s69,20971520
s_lshl_b32 s87,s54,13
s_add_u32 s87,s87,10486272
s_lshl4_add_u32 s74,s68,s87
s_lshl2_add_u32 s74,s46,s74
s_lshl_b32 s68,s68,1
s_lshr_b32 s56,s46,1
s_add_u32 s68,s68,s56
s_mov_b32 s66,0
s_mov_b32 s67,0
s_mov_b32 s73,0x80000000
s_mov_b32 s75,0
s_mov_b32 s37,0
s_mov_b64 s[38:39],0
s_sub_u32 s36,s54,12
s_and_b32 s36,s36,3
s_mov_b32 s12,s40
s_mov_b32 s13,s41
s_mov_b32 s14,2097152
s_mov_b32 s15,0x20000
v_add_u32 v21,10487168,v21
v_mov_b32 v244,v21
s_and_b32 s56,s50,2048
s_add_u32 s56,s56,147456
v_lshlrev_b32 v23,5,v1
v_add_u32 v23,s56,v23
v_and_b32 v253,32,v0
v_lshrrev_b32 v245,2,v253
v_add_u32 v253,v253,v245
v_sub_u32 v253,v0,v253
v_add_u32 v253,8,v253
v_mov_b32 v254,0x80000000
s_mov_b32 s56,1408
v_writelane_b32 v254,s56,0
s_mov_b32 s56,256
v_writelane_b32 v254,s56,1
s_mov_b32 s56,1280
v_writelane_b32 v254,s56,2
v_mov_b32 v245,155648
s_lshl_b32 s56,s46,2
v_add_u32 v247,s56,v245
s_waitcnt vmcnt(0)
v_lshlrev_b32 v228,16,v224
v_and_b32 v229,0xffff0000,v224
v_lshlrev_b32 v230,16,v225
v_and_b32 v231,0xffff0000,v225
v_lshlrev_b32 v232,16,v226
v_and_b32 v233,0xffff0000,v226
v_lshlrev_b32 v234,16,v227
v_and_b32 v235,0xffff0000,v227
v_mul_f32 v255,v228,v228
v_fma_f32 v255,v229,v229,v255
v_fma_f32 v255,v230,v230,v255
v_fma_f32 v255,v231,v231,v255
v_fma_f32 v255,v232,v232,v255
v_fma_f32 v255,v233,v233,v255
v_fma_f32 v255,v234,v234,v255
v_fma_f32 v255,v235,v235,v255
s_nop 1
v_add_f32_dpp v255,v255,v255 row_ror:8 row_mask:0xf bank_mask:0xf
s_nop 1
v_add_f32_dpp v255,v255,v255 row_ror:4 row_mask:0xf bank_mask:0xf
s_nop 1
v_add_f32_dpp v255,v255,v255 row_ror:2 row_mask:0xf bank_mask:0xf
s_nop 1
v_add_f32_dpp v255,v255,v255 row_ror:1 row_mask:0xf bank_mask:0xf
v_mov_b32 v238,v255
s_nop 1
v_permlane16_swap_b32 v255,v238
v_add_f32 v255,v255,v238
v_mov_b32 v238,v255
s_nop 1
v_permlane32_swap_b32 v255,v238
v_add_f32 v255,v255,v238
v_sqrt_f32 v255,v255
v_sub_u32 v238,68,v1
v_cvt_f32_u32 v238,v238
v_log_f32 v238,v238
v_mov_b32 v239,0x3ff9999a
v_fmac_f32 v239,0x3e632166,v238
v_mul_f32 v255,v255,v239
v_or_b32 v255,0x80000000,v255
s_xor_b32 s34,s69,524288
buffer_load_dwordx4 v[160:163],v7,s[8:11],s34 offen
s_add_u32 s34,s34,4096
buffer_load_dwordx4 v[164:167],v7,s[8:11],s34 offen
s_add_u32 s34,s34,4096
buffer_load_dwordx4 v[168:171],v7,s[8:11],s34 offen
s_add_u32 s34,s34,4096
buffer_load_dwordx4 v[172:175],v7,s[8:11],s34 offen
s_add_u32 s34,s34,4096
buffer_load_dwordx4 v[176:179],v7,s[8:11],s34 offen
s_add_u32 s34,s34,4096
buffer_load_dwordx4 v[180:183],v7,s[8:11],s34 offen
s_add_u32 s34,s34,4096
buffer_load_dwordx4 v[184:187],v7,s[8:11],s34 offen
s_add_u32 s34,s34,4096
buffer_load_dwordx4 v[188:191],v7,s[8:11],s34 offen
s_xor_b32 s69,s69,524288
s_xor_b32 s34,s69,524288
buffer_load_dwordx4 v[160:163],v7,s[8:11],s34 offen
s_add_u32 s34,s34,4096
buffer_load_dwordx4 v[164:167],v7,s[8:11],s34 offen
s_add_u32 s34,s34,4096
buffer_load_dwordx4 v[168:171],v7,s[8:11],s34 offen
s_add_u32 s34,s34,4096
buffer_load_dwordx4 v[172:175],v7,s[8:11],s34 offen
s_add_u32 s34,s34,4096
buffer_load_dwordx4 v[176:179],v7,s[8:11],s34 offen
s_add_u32 s34,s34,4096
buffer_load_dwordx4 v[180:183],v7,s[8:11],s34 offen
s_add_u32 s34,s34,4096
buffer_load_dwordx4 v[184:187],v7,s[8:11],s34 offen
s_add_u32 s34,s34,4096
buffer_load_dwordx4 v[188:191],v7,s[8:11],s34 offen
s_xor_b32 s69,s69,524288
s_cmp_lt_u32 s54,2
s_cbranch_scc1 L_aa_64
s_sub_u32 s77,s54,2
s_mov_b32 s30,0
s_mov_b32 s86,1536
s_lshl_b32 s56,s77,5
s_add_u32 s56,s56,s68
s_mul_i32 s70,s56,24576
s_lshl_b32 s71,s56,12
s_lshl_b32 s59,s77,13
s_lshl2_add_u32 s59,s68,s59
s_add_u32 s59,s59,10485760
s_buffer_load_dword s32,s[8:11],s59
s_mov_b32 s33,1
s_add_u32 s70,s70,100663296
s_add_u32 s71,s71,41943040
v_mov_b32 v19,s59
s_branch L_aa_72
L_aa_78:
s_bitcmp1_b32 s46,0
s_cbranch_scc1 L_av_79
ds_read_b128 v[24:27],v4 offset:0
ds_read_b128 v[28:31],v4 offset:1024
s_min_u32 s56,s32,s33
s_cmp_lt_u32 s77,64
s_cselect_b32 s56,s56,0
s_cmp_eq_u32 s56,0
s_cselect_b32 s72,0x80000000,0
v_mov_b32 v248,s72
s_or_b32 s64,s70,s72
s_or_b32 s65,s71,s72
s_cmp_lt_u32 s30,s31
s_cselect_b32 s65,0x80000000,s65
s_and_b32 s57,s46,1
s_mul_i32 s58,s57,12288
s_add_u32 s64,s64,s58
s_lshl_b32 s57,s57,11
s_waitcnt lgkmcnt(1)
v_mfma_f32_16x16x32_bf16 v[160:163],v[24:27],a[0:3],0
ds_read_b128 v[32:35],v4 offset:2048
s_add_u32 s65,s65,s57
s_and_b32 s59,s50,2048
v_mfma_f32_16x16x32_bf16 v[164:167],v[24:27],a[4:7],0
ds_read_b128 v[36:39],v4 offset:3072
s_lshl_b32 s59,s59,4
s_xor_b32 s60,s67,65536
v_mfma_f32_16x16x32_bf16 v[168:171],v[24:27],a[8:11],0
ds_read_b128 v[40:43],v4 offset:8192
s_add_u32 s59,s59,s60
s_add_u32 s58,s58,s59
v_mfma_f32_16x16x32_bf16 v[172:175],v[24:27],a[12:15],0
ds_read_b128 v[44:47],v4 offset:9216
s_add_u32 s57,s57,s59
s_add_u32 m0,s58,0
v_mfma_f32_16x16x32_bf16 v[176:179],v[24:27],a[16:19],0
buffer_load_dwordx4 v0,s[8:11],s64 offen offset:0 sc1 lds
v_lshlrev_b32 v88,16,v224
v_and_b32 v89,0xffff0000,v224
v_mfma_f32_16x16x32_bf16 v[180:183],v[24:27],a[20:23],0
ds_read_b128 v[48:51],v4 offset:10240
v_lshlrev_b32 v90,16,v225
v_and_b32 v91,0xffff0000,v225
v_mfma_f32_16x16x32_bf16 v[184:187],v[24:27],a[24:27],0
ds_read_b128 v[52:55],v4 offset:11264
s_waitcnt vmcnt(8)
v_mfma_f32_16x16x32_bf16 v[128:131],v[156:159],v[192:195],0
ds_write_b32 v247,v248
v_lshlrev_b32 v92,16,v226
v_and_b32 v93,0xffff0000,v226
v_mfma_f32_16x16x32_bf16 v[188:191],v[24:27],a[28:31],0
ds_read_b128 v[56:59],v4 offset:4096
s_waitcnt vmcnt(7)
v_mfma_f32_16x16x32_bf16 v[128:131],v[156:159],v[196:199],v[128:131]
ds_read_b128 v[60:63],v4 offset:5120
v_lshlrev_b32 v94,16,v227
v_and_b32 v95,0xffff0000,v227
s_waitcnt lgkmcnt(9)
v_mfma_f32_16x16x32_bf16 v[160:163],v[28:31],a[32:35],v[160:163]
buffer_load_dwordx4 v0,s[8:11],s64 offen offset:1024 sc1 lds
s_waitcnt vmcnt(7)
v_mfma_f32_16x16x32_bf16 v[128:131],v[156:159],v[200:203],v[128:131]
ds_read_b128 v[64:67],v4 offset:6144
v_readfirstlane_b32 s22,v246
s_cmp_eq_u32 s22,0
s_cbranch_scc1 L_ag_80
L_agb_81:
v_mfma_f32_16x16x32_bf16 v[164:167],v[28:31],a[36:39],v[164:167]
ds_read_b128 v[68:71],v4 offset:7168
s_waitcnt vmcnt(6)
v_mfma_f32_16x16x32_bf16 v[128:131],v[156:159],v[204:207],v[128:131]
ds_read_b128 v[72:75],v4 offset:12288
s_lshl_b32 s18,s26,5
s_add_u32 s18,s18,s68
v_mfma_f32_16x16x32_bf16 v[168:171],v[28:31],a[40:43],v[168:171]
ds_read_b128 v[76:79],v4 offset:13312
s_waitcnt vmcnt(5)
v_mfma_f32_16x16x32_bf16 v[132:135],v[156:159],v[208:211],0
ds_read_b128 v[80:83],v4 offset:14336
s_lshl_b32 s19,s18,10
s_add_u32 s20,s19,6291456
v_mfma_f32_16x16x32_bf16 v[172:175],v[28:31],a[44:47],v[172:175]
ds_read_b128 v[84:87],v4 offset:15360
s_waitcnt vmcnt(4)
v_mfma_f32_16x16x32_bf16 v[132:135],v[156:159],v[212:215],v[132:135]
s_lshl_b32 s23,s51,5
s_add_u32 s23,s23,s68
s_lshl_b32 s24,s23,10
v_mfma_f32_16x16x32_bf16 v[176:179],v[28:31],a[48:51],v[176:179]
buffer_load_dwordx4 v0,s[8:11],s64 offen offset:2048 sc1 lds
s_waitcnt vmcnt(4)
v_mfma_f32_16x16x32_bf16 v[132:135],v[156:159],v[216:219],v[132:135]
s_lshl_b32 s25,s51,10
s_add_u32 s25,s25,2883584
s_cmp_eq_u32 s23,s55
s_cselect_b32 s25,s25,s24
v_mfma_f32_16x16x32_bf16 v[180:183],v[28:31],a[52:55],v[180:183]
ds_write_b128 v6,v[128:131]
s_waitcnt vmcnt(3)
v_mfma_f32_16x16x32_bf16 v[132:135],v[156:159],v[220:223],v[132:135]
s_add_u32 s25,s25,8388608
s_mov_b32 s6,268435456
s_cmp_eq_u32 s31,0
s_cselect_b32 s25,s24,s25
s_cselect_b64 s[4:5],s[16:17],s[44:45]
s_cmov_b32 s6,2097152
v_mfma_f32_16x16x32_bf16 v[184:187],v[28:31],a[56:59],v[184:187]
buffer_load_dwordx4 v[224:227],v0,s[4:7],s25 offen sc1
s_lshr_b32 s24,s55,5
s_cmp_lt_u32 s51,s24
s_cselect_b32 s24,1,2
v_mfma_f32_16x16x32_bf16 v[188:191],v[28:31],a[60:63],v[188:191]
v_mov_b32 v252,s24
s_lshl2_add_u32 s25,s51,11018240
s_waitcnt lgkmcnt(15)
v_mfma_f32_16x16x32_bf16 v[160:163],v[32:35],a[64:67],v[160:163]
ds_write_b128 v6,v[132:135] offset:2048
s_lshl_b32 s24,s68,16
s_add_u32 s24,s24,s31
v_mfma_f32_16x16x32_bf16 v[164:167],v[32:35],a[68:71],v[164:167]
buffer_load_dwordx4 v0,s[8:11],s64 offen offset:3072 sc1 lds
s_add_u32 s24,s24,s86
s_cmp_eq_u32 s24,1537
s_cselect_b32 s25,s25,0x80000000
v_mfma_f32_16x16x32_bf16 v[168:171],v[32:35],a[72:75],v[168:171]
buffer_store_dword v252,off,s[8:11],s25 sc1
s_bitcmp1_b64 s[38:39],s51
s_cselect_b32 s24,128,0
v_mfma_f32_16x16x32_bf16 v[172:175],v[32:35],a[76:79],v[172:175]
s_lshl_b32 s23,s51,13
s_lshl2_add_u32 s23,s68,s23
s_add_u32 s23,s23,10487168
v_mfma_f32_16x16x32_bf16 v[176:179],v[32:35],a[80:83],v[176:179]
s_waitcnt lgkmcnt(0)
s_barrier
s_add_u32 s23,s23,s24
v_mfma_f32_16x16x32_bf16 v[180:183],v[32:35],a[84:87],v[180:183]
ds_read_b128 v[96:99],v23
s_add_u32 m0,s58,4096
s_add_u32 s64,s64,4096
v_mfma_f32_16x16x32_bf16 v[184:187],v[32:35],a[88:91],v[184:187]
ds_read_b128 v[100:103],v23 offset:16
v_mfma_f32_16x16x32_bf16 v[188:191],v[32:35],a[92:95],v[188:191]
buffer_load_dwordx4 v0,s[8:11],s64 offen offset:0 sc1 lds
v_mfma_f32_16x16x32_bf16 v[160:163],v[36:39],a[96:99],v[160:163]
ds_read_b128 v[248:251],v245
v_mfma_f32_16x16x32_bf16 v[164:167],v[36:39],a[100:103],v[164:167]
buffer_load_dword v246,off,s[8:11],s23 sc1
v_lshrrev_b32 v244,4,v1
s_sub_u32 s23,s77,8
v_add_u32 v244,s23,v244
v_mfma_f32_16x16x32_bf16 v[168:171],v[36:39],a[104:107],v[168:171]
buffer_store_dword v20,off,s[8:11],s73 sc1
v_max_i32 v244,0,v244
v_lshl_add_u32 v244,v244,13,v21
s_mov_b32 s73,0x80000000
v_mfma_f32_16x16x32_bf16 v[172:175],v[36:39],a[108:111],v[172:175]
buffer_load_dwordx4 v0,s[8:11],s64 offen offset:1024 sc1 lds
v_mfma_f32_16x16x32_bf16 v[176:179],v[36:39],a[112:115],v[176:179]
buffer_load_dwordx2 v[242:243],v244,s[8:11],0 offen sc1
v_mfma_f32_16x16x32_bf16 v[180:183],v[36:39],a[116:119],v[180:183]
v_mfma_f32_16x16x32_bf16 v[184:187],v[36:39],a[120:123],v[184:187]
s_waitcnt lgkmcnt(0)
v_or3_b32 v248,v248,v249,v250
v_or_b32 v248,v248,v251
v_mfma_f32_16x16x32_bf16 v[188:191],v[36:39],a[124:127],v[188:191]
buffer_load_dwordx4 v0,s[8:11],s64 offen offset:2048 sc1 lds
v_readfirstlane_b32 s72,v248
s_waitcnt lgkmcnt(1)
v_cvt_pk_bf16_f32 v104,v96,v97
v_mfma_f32_16x16x32_bf16 v[160:163],v[40:43],a[128:131],v[160:163]
v_cvt_pk_bf16_f32 v105,v98,v99
v_cvt_pk_bf16_f32 v106,v100,v101
v_cvt_pk_bf16_f32 v107,v102,v103
v_mfma_f32_16x16x32_bf16 v[164:167],v[40:43],a[132:135],v[164:167]
v_lshlrev_b32 v96,16,v104
v_and_b32 v97,0xffff0000,v104
v_lshlrev_b32 v98,16,v105
v_mfma_f32_16x16x32_bf16 v[168:171],v[40:43],a[136:139],v[168:171]
v_and_b32 v99,0xffff0000,v105
v_lshlrev_b32 v100,16,v106
v_and_b32 v101,0xffff0000,v106
v_mfma_f32_16x16x32_bf16 v[172:175],v[40:43],a[140:143],v[172:175]
buffer_load_dwordx4 v0,s[8:11],s64 offen offset:3072 sc1 lds
v_lshlrev_b32 v102,16,v107
v_and_b32 v103,0xffff0000,v107
v_add_f32 v88,v88,v96
v_mfma_f32_16x16x32_bf16 v[176:179],v[40:43],a[144:147],v[176:179]
v_add_f32 v89,v89,v97
v_add_f32 v90,v90,v98
v_add_f32 v91,v91,v99
v_mfma_f32_16x16x32_bf16 v[180:183],v[40:43],a[148:151],v[180:183]
v_add_f32 v92,v92,v100
v_add_f32 v93,v93,v101
v_add_f32 v94,v94,v102
v_mfma_f32_16x16x32_bf16 v[184:187],v[40:43],a[152:155],v[184:187]
v_add_f32 v95,v95,v103
v_cvt_pk_bf16_f32 v104,v88,v89
v_cvt_pk_bf16_f32 v105,v90,v91
v_mfma_f32_16x16x32_bf16 v[188:191],v[40:43],a[156:159],v[188:191]
s_add_u32 m0,s58,8192
s_add_u32 s64,s64,4096
v_cvt_pk_bf16_f32 v106,v92,v93
v_mfma_f32_16x16x32_bf16 v[160:163],v[44:47],a[160:163],v[160:163]
buffer_load_dwordx4 v0,s[8:11],s64 offen offset:0 sc1 lds
v_cvt_pk_bf16_f32 v107,v94,v95
v_mfma_f32_16x16x32_bf16 v[164:167],v[44:47],a[164:167],v[164:167]
buffer_store_dwordx4 v[104:107],v0,s[8:11],s20 offen sc1
v_lshlrev_b32 v88,16,v104
v_and_b32 v89,0xffff0000,v104
v_lshlrev_b32 v90,16,v105
v_mfma_f32_16x16x32_bf16 v[168:171],v[44:47],a[168:171],v[168:171]
v_and_b32 v91,0xffff0000,v105
v_lshlrev_b32 v92,16,v106
v_and_b32 v93,0xffff0000,v106
v_mfma_f32_16x16x32_bf16 v[172:175],v[44:47],a[172:175],v[172:175]
v_lshlrev_b32 v94,16,v107
v_and_b32 v95,0xffff0000,v107
v_mfma_f32_16x16x32_bf16 v[176:179],v[44:47],a[176:179],v[176:179]
buffer_load_dwordx4 v0,s[8:11],s64 offen offset:1024 sc1 lds
v_readfirstlane_b32 s78,v88
v_mfma_f32_16x16x32_bf16 v[180:183],v[44:47],a[180:183],v[180:183]
s_nop 0
v_add_f32 v120,v88,-s78
v_add_f32 v121,v89,-s78
v_add_f32 v122,v90,-s78
v_mfma_f32_16x16x32_bf16 v[184:187],v[44:47],a[184:187],v[184:187]
v_add_f32 v123,v91,-s78
v_add_f32 v124,v92,-s78
v_mfma_f32_16x16x32_bf16 v[188:191],v[44:47],a[188:191],v[188:191]
v_add_f32 v125,v93,-s78
v_add_f32 v126,v94,-s78
v_mfma_f32_16x16x32_bf16 v[160:163],v[48:51],a[192:195],v[160:163]
buffer_load_dwordx4 v0,s[8:11],s64 offen offset:2048 sc1 lds
v_add_f32 v127,v95,-s78
v_add_f32 v128,v120,v122
v_mfma_f32_16x16x32_bf16 v[164:167],v[48:51],a[196:199],v[164:167]
v_add_f32 v129,v121,v123
v_mul_f32 v130,v120,v120
v_mfma_f32_16x16x32_bf16 v[168:171],v[48:51],a[200:203],v[168:171]
v_mul_f32 v131,v121,v121
v_add_f32 v132,v124,v126
v_mfma_f32_16x16x32_bf16 v[172:175],v[48:51],a[204:207],v[172:175]
v_add_f32 v133,v125,v127
v_fma_f32 v130,v122,v122,v130
v_mfma_f32_16x16x32_bf16 v[176:179],v[48:51],a[208:211],v[176:179]
buffer_load_dwordx4 v0,s[8:11],s64 offen offset:3072 sc1 lds
v_fma_f32 v131,v123,v123,v131
v_add_f32 v128,v128,v132
v_mfma_f32_16x16x32_bf16 v[180:183],v[48:51],a[212:215],v[180:183]
v_add_f32 v129,v129,v133
v_fma_f32 v130,v124,v124,v130
v_mfma_f32_16x16x32_bf16 v[184:187],v[48:51],a[216:219],v[184:187]
v_fma_f32 v131,v125,v125,v131
v_add_f32 v128,v128,v129
v_mfma_f32_16x16x32_bf16 v[188:191],v[48:51],a[220:223],v[188:191]
v_fma_f32 v130,v126,v126,v130
v_fma_f32 v131,v127,v127,v131
v_mfma_f32_16x16x32_bf16 v[160:163],v[52:55],a[224:227],v[160:163]
s_add_u32 m0,s57,24576
v_add_f32 v130,v130,v131
v_mfma_f32_16x16x32_bf16 v[164:167],v[52:55],a[228:231],v[164:167]
buffer_load_dwordx4 v0,s[8:11],s65 offen offset:0 sc1 lds
v_permlane32_swap_b32 v128,v130
v_add_f32 v128,v128,v130
v_mfma_f32_16x16x32_bf16 v[168:171],v[52:55],a[232:235],v[168:171]
s_nop 0
v_add_f32_dpp v128,v128,v128 row_ror:8 row_mask:0xf bank_mask:0xf
v_mfma_f32_16x16x32_bf16 v[172:175],v[52:55],a[236:239],v[172:175]
s_nop 0
v_add_f32_dpp v128,v128,v128 row_ror:4 row_mask:0xf bank_mask:0xf
v_mfma_f32_16x16x32_bf16 v[176:179],v[52:55],a[240:243],v[176:179]
s_nop 0
v_add_f32_dpp v128,v128,v128 row_ror:2 row_mask:0xf bank_mask:0xf
v_mfma_f32_16x16x32_bf16 v[180:183],v[52:55],a[244:247],v[180:183]
buffer_load_dwordx4 v0,s[8:11],s65 offen offset:1024 sc1 lds
v_add_f32_dpp v128,v128,v128 row_ror:1 row_mask:0xf bank_mask:0xf
v_mov_b32 v130,v128
v_mfma_f32_16x16x32_bf16 v[184:187],v[52:55],a[248:251],v[184:187]
s_nop 0
v_permlane16_swap_b32 v128,v130
v_add_f32 v128,v128,v130
v_mul_f32 v128,0x3b000000,v128
v_mfma_f32_16x16x32_bf16 v[188:191],v[52:55],a[252:255],v[188:191]
v_mov_b32 v130,v128
v_mfma_f32_16x16x32_bf16 v[192:195],v[56:59],a[0:3],0
s_nop 0
v_permlane32_swap_b32 v128,v130
v_fma_f32 v130,-v128,v128,v130
v_add_f32 v128,s78,v128
v_mfma_f32_16x16x32_bf16 v[196:199],v[56:59],a[4:7],0
v_max_f32 v130,0,v130
v_cvt_pk_bf16_f32 v130,v128,v130
v_lshlrev_b32 v128,16,v130
v_mfma_f32_16x16x32_bf16 v[200:203],v[56:59],a[8:11],0
v_and_b32 v130,0xffff0000,v130
v_add_f32 v130,0x3727c5ac,v130
v_cvt_pk_bf16_f32 v130,v130,v130
v_mfma_f32_16x16x32_bf16 v[204:207],v[56:59],a[12:15],0
v_and_b32 v130,0xffff0000,v130
v_sqrt_f32 v130,v130
v_add_f32 v120,v88,-v128
v_mfma_f32_16x16x32_bf16 v[208:211],v[56:59],a[16:19],0
v_add_f32 v121,v89,-v128
v_add_f32 v122,v90,-v128
v_mfma_f32_16x16x32_bf16 v[212:215],v[56:59],a[20:23],0
v_add_f32 v123,v91,-v128
v_add_f32 v124,v92,-v128
v_mfma_f32_16x16x32_bf16 v[216:219],v[56:59],a[24:27],0
v_add_f32 v125,v93,-v128
v_add_f32 v126,v94,-v128
v_mfma_f32_16x16x32_bf16 v[220:223],v[56:59],a[28:31],0
v_add_f32 v127,v95,-v128
v_cvt_pk_bf16_f32 v130,v130,v130
v_mfma_f32_16x16x32_bf16 v[192:195],v[60:63],a[32:35],v[192:195]
v_and_b32 v130,0xffff0000,v130
v_rcp_f32 v130,v130
v_mfma_f32_16x16x32_bf16 v[196:199],v[60:63],a[36:39],v[196:199]
v_cvt_pk_bf16_f32 v108,v120,v121
v_cvt_pk_bf16_f32 v109,v122,v123
v_mfma_f32_16x16x32_bf16 v[200:203],v[60:63],a[40:43],v[200:203]
v_cvt_pk_bf16_f32 v110,v124,v125
v_cvt_pk_bf16_f32 v111,v126,v127
v_mfma_f32_16x16x32_bf16 v[204:207],v[60:63],a[44:47],v[204:207]
v_lshlrev_b32 v120,16,v108
v_and_b32 v121,0xffff0000,v108
v_mfma_f32_16x16x32_bf16 v[208:211],v[60:63],a[48:51],v[208:211]
v_lshlrev_b32 v122,16,v109
v_and_b32 v123,0xffff0000,v109
v_mfma_f32_16x16x32_bf16 v[212:215],v[60:63],a[52:55],v[212:215]
v_lshlrev_b32 v124,16,v110
v_and_b32 v125,0xffff0000,v110
v_mfma_f32_16x16x32_bf16 v[216:219],v[60:63],a[56:59],v[216:219]
v_lshlrev_b32 v126,16,v111
v_and_b32 v127,0xffff0000,v111
v_mfma_f32_16x16x32_bf16 v[220:223],v[60:63],a[60:63],v[220:223]
v_mul_f32 v120,v120,v130
v_mul_f32 v121,v121,v130
v_mfma_f32_16x16x32_bf16 v[192:195],v[64:67],a[64:67],v[192:195]
v_mul_f32 v122,v122,v130
v_mul_f32 v123,v123,v130
v_mfma_f32_16x16x32_bf16 v[196:199],v[64:67],a[68:71],v[196:199]
v_mul_f32 v124,v124,v130
v_mul_f32 v125,v125,v130
v_mfma_f32_16x16x32_bf16 v[200:203],v[64:67],a[72:75],v[200:203]
v_mul_f32 v126,v126,v130
v_mul_f32 v127,v127,v130
v_mfma_f32_16x16x32_bf16 v[204:207],v[64:67],a[76:79],v[204:207]
v_cvt_pk_bf16_f32 v108,v120,v121
v_cvt_pk_bf16_f32 v109,v122,v123
v_mfma_f32_16x16x32_bf16 v[208:211],v[64:67],a[80:83],v[208:211]
v_cvt_pk_bf16_f32 v24,v160,v164
v_cvt_pk_bf16_f32 v25,v168,v172
v_mfma_f32_16x16x32_bf16 v[212:215],v[64:67],a[84:87],v[212:215]
v_cvt_pk_bf16_f32 v26,v176,v180
v_cvt_pk_bf16_f32 v27,v184,v188
v_mfma_f32_16x16x32_bf16 v[216:219],v[64:67],a[88:91],v[216:219]
v_cvt_pk_bf16_f32 v28,v161,v165
v_cvt_pk_bf16_f32 v29,v169,v173
v_mfma_f32_16x16x32_bf16 v[220:223],v[64:67],a[92:95],v[220:223]
v_cvt_pk_bf16_f32 v30,v177,v181
v_cvt_pk_bf16_f32 v31,v185,v189
v_mfma_f32_16x16x32_bf16 v[192:195],v[68:71],a[96:99],v[192:195]
v_cvt_pk_bf16_f32 v32,v162,v166
v_cvt_pk_bf16_f32 v33,v170,v174
v_mfma_f32_16x16x32_bf16 v[196:199],v[68:71],a[100:103],v[196:199]
v_cvt_pk_bf16_f32 v34,v178,v182
v_cvt_pk_bf16_f32 v35,v186,v190
v_mfma_f32_16x16x32_bf16 v[200:203],v[68:71],a[104:107],v[200:203]
v_cvt_pk_bf16_f32 v36,v163,v167
v_cvt_pk_bf16_f32 v37,v171,v175
v_mfma_f32_16x16x32_bf16 v[204:207],v[68:71],a[108:111],v[204:207]
v_cvt_pk_bf16_f32 v38,v179,v183
v_cvt_pk_bf16_f32 v39,v187,v191
v_mfma_f32_16x16x32_bf16 v[208:211],v[68:71],a[112:115],v[208:211]
s_add_u32 s62,s69,0
v_cvt_pk_bf16_f32 v110,v124,v125
v_cvt_pk_bf16_f32 v111,v126,v127
v_mfma_f32_16x16x32_bf16 v[212:215],v[68:71],a[116:119],v[212:215]
buffer_store_dwordx4 v[24:27],v5,s[8:11],s62 offen
v_lshlrev_b32 v112,16,v108
v_and_b32 v113,0xffff0000,v108
v_mfma_f32_16x16x32_bf16 v[216:219],v[68:71],a[120:123],v[216:219]
v_lshlrev_b32 v114,16,v109
v_and_b32 v115,0xffff0000,v109
v_mfma_f32_16x16x32_bf16 v[220:223],v[68:71],a[124:127],v[220:223]
v_lshlrev_b32 v116,16,v110
v_and_b32 v117,0xffff0000,v110
v_mfma_f32_16x16x32_bf16 v[192:195],v[72:75],a[128:131],v[192:195]
s_add_u32 s62,s69,16384
v_lshlrev_b32 v118,16,v111
v_and_b32 v119,0xffff0000,v111
v_mfma_f32_16x16x32_bf16 v[196:199],v[72:75],a[132:135],v[196:199]
buffer_store_dwordx4 v[28:31],v5,s[8:11],s62 offen
v_add_f32 v88,v88,v112
v_add_f32 v89,v89,v113
v_mfma_f32_16x16x32_bf16 v[200:203],v[72:75],a[136:139],v[200:203]
v_add_f32 v90,v90,v114
v_add_f32 v91,v91,v115
v_mfma_f32_16x16x32_bf16 v[204:207],v[72:75],a[140:143],v[204:207]
v_add_f32 v92,v92,v116
v_add_f32 v93,v93,v117
v_mfma_f32_16x16x32_bf16 v[208:211],v[72:75],a[144:147],v[208:211]
s_add_u32 s62,s69,32768
v_add_f32 v94,v94,v118
v_add_f32 v95,v95,v119
v_mfma_f32_16x16x32_bf16 v[212:215],v[72:75],a[148:151],v[212:215]
buffer_store_dwordx4 v[32:35],v5,s[8:11],s62 offen
v_cvt_pk_bf16_f32 v96,v88,v89
v_cvt_pk_bf16_f32 v97,v90,v91
v_mfma_f32_16x16x32_bf16 v[216:219],v[72:75],a[152:155],v[216:219]
v_cvt_pk_bf16_f32 v98,v92,v93
v_cvt_pk_bf16_f32 v99,v94,v95
v_mfma_f32_16x16x32_bf16 v[220:223],v[72:75],a[156:159],v[220:223]
buffer_store_dwordx4 v[96:99],v0,s[12:15],s19 offen sc1
v_mul_f32 v236,v112,v228
v_mul_f32 v237,v113,v229
v_mfma_f32_16x16x32_bf16 v[192:195],v[76:79],a[160:163],v[192:195]
s_add_u32 s62,s69,49152
v_fma_f32 v236,v114,v230,v236
v_fma_f32 v237,v115,v231,v237
v_mfma_f32_16x16x32_bf16 v[196:199],v[76:79],a[164:167],v[196:199]
buffer_store_dwordx4 v[36:39],v5,s[8:11],s62 offen
v_fma_f32 v236,v116,v232,v236
v_fma_f32 v237,v117,v233,v237
v_mfma_f32_16x16x32_bf16 v[200:203],v[76:79],a[168:171],v[200:203]
v_fma_f32 v236,v118,v234,v236
v_fma_f32 v237,v119,v235,v237
v_mfma_f32_16x16x32_bf16 v[204:207],v[76:79],a[172:175],v[204:207]
v_add_f32 v236,v236,v237
v_mfma_f32_16x16x32_bf16 v[208:211],v[76:79],a[176:179],v[208:211]
s_nop 0
v_add_f32_dpp v236,v236,v236 row_ror:8 row_mask:0xf bank_mask:0xf
v_mfma_f32_16x16x32_bf16 v[212:215],v[76:79],a[180:183],v[212:215]
s_nop 0
v_add_f32_dpp v236,v236,v236 row_ror:4 row_mask:0xf bank_mask:0xf
v_mfma_f32_16x16x32_bf16 v[216:219],v[76:79],a[184:187],v[216:219]
s_nop 0
v_add_f32_dpp v236,v236,v236 row_ror:2 row_mask:0xf bank_mask:0xf
v_mfma_f32_16x16x32_bf16 v[220:223],v[76:79],a[188:191],v[220:223]
s_nop 0
v_add_f32_dpp v236,v236,v236 row_ror:1 row_mask:0xf bank_mask:0xf
v_mov_b32 v237,v236
v_mfma_f32_16x16x32_bf16 v[192:195],v[80:83],a[192:195],v[192:195]
s_nop 0
v_permlane16_swap_b32 v236,v237
v_add_f32 v236,v236,v237
v_mov_b32 v237,v236
v_mfma_f32_16x16x32_bf16 v[196:199],v[80:83],a[196:199],v[196:199]
s_nop 0
v_permlane32_swap_b32 v236,v237
v_add_f32 v236,v236,v237
v_cvt_pk_bf16_f32 v236,v236,v236
v_mfma_f32_16x16x32_bf16 v[200:203],v[80:83],a[200:203],v[200:203]
v_and_b32 v236,0xffff0000,v236
v_ashrrev_i32 v237,31,v236
v_or_b32 v237,0x80000000,v237
v_mfma_f32_16x16x32_bf16 v[204:207],v[80:83],a[204:207],v[204:207]
v_xor_b32 v236,v236,v237
v_and_b32 v236,0xffff0000,v236
s_sub_u32 s20,4095,s18
v_mfma_f32_16x16x32_bf16 v[208:211],v[80:83],a[208:211],v[208:211]
v_or_b32 v20,s20,v236
s_lshl_b32 s73,s26,13
s_lshl2_add_u32 s73,s68,s73
v_mfma_f32_16x16x32_bf16 v[212:215],v[80:83],a[212:215],v[212:215]
s_add_u32 s73,s73,10485760
s_add_u32 s73,s73,s86
v_mfma_f32_16x16x32_bf16 v[216:219],v[80:83],a[216:219],v[216:219]
v_mfma_f32_16x16x32_bf16 v[220:223],v[80:83],a[220:223],v[220:223]
v_mfma_f32_16x16x32_bf16 v[192:195],v[84:87],a[224:227],v[192:195]
v_mfma_f32_16x16x32_bf16 v[196:199],v[84:87],a[228:231],v[196:199]
v_mfma_f32_16x16x32_bf16 v[200:203],v[84:87],a[232:235],v[200:203]
v_mfma_f32_16x16x32_bf16 v[204:207],v[84:87],a[236:239],v[204:207]
v_mfma_f32_16x16x32_bf16 v[208:211],v[84:87],a[240:243],v[208:211]
v_mfma_f32_16x16x32_bf16 v[212:215],v[84:87],a[244:247],v[212:215]
v_mfma_f32_16x16x32_bf16 v[216:219],v[84:87],a[248:251],v[216:219]
v_mfma_f32_16x16x32_bf16 v[220:223],v[84:87],a[252:255],v[220:223]
v_cvt_pk_bf16_f32 v40,v192,v196
v_cvt_pk_bf16_f32 v41,v200,v204
v_cvt_pk_bf16_f32 v42,v208,v212
s_nop 4
v_cvt_pk_bf16_f32 v43,v216,v220
s_add_u32 s62,s69,262144
buffer_store_dwordx4 v[40:43],v5,s[8:11],s62 offen
v_cvt_pk_bf16_f32 v44,v193,v197
v_cvt_pk_bf16_f32 v45,v201,v205
v_cvt_pk_bf16_f32 v46,v209,v213
v_cvt_pk_bf16_f32 v47,v217,v221
s_add_u32 s62,s69,278528
buffer_store_dwordx4 v[44:47],v5,s[8:11],s62 offen
v_cvt_pk_bf16_f32 v48,v194,v198
v_cvt_pk_bf16_f32 v49,v202,v206
v_cvt_pk_bf16_f32 v50,v210,v214
v_cvt_pk_bf16_f32 v51,v218,v222
s_add_u32 s62,s69,294912
buffer_store_dwordx4 v[48:51],v5,s[8:11],s62 offen
v_cvt_pk_bf16_f32 v52,v195,v199
v_cvt_pk_bf16_f32 v53,v203,v207
v_cvt_pk_bf16_f32 v54,v211,v215
v_cvt_pk_bf16_f32 v55,v219,v223
s_add_u32 s62,s69,311296
buffer_store_dwordx4 v[52:55],v5,s[8:11],s62 offen
s_cmp_lg_u32 s72,0
s_cbranch_scc1 L_aa_67
s_waitcnt vmcnt(9)
s_branch L_aa_77
L_av_79:
ds_read_b128 v[24:27],v4 offset:0
ds_read_b128 v[28:31],v4 offset:1024
s_min_u32 s56,s32,s33
s_cmp_lt_u32 s77,64
s_cselect_b32 s56,s56,0
s_cmp_eq_u32 s56,0
s_cselect_b32 s72,0x80000000,0
v_mov_b32 v248,s72
s_or_b32 s64,s70,s72
s_or_b32 s65,s71,s72
s_cmp_lt_u32 s30,s31
s_cselect_b32 s65,0x80000000,s65
s_and_b32 s57,s46,1
s_mul_i32 s58,s57,12288
s_add_u32 s64,s64,s58
s_lshl_b32 s57,s57,11
s_waitcnt lgkmcnt(1)
v_mfma_f32_16x16x32_bf16 v[160:163],v[24:27],a[0:3],0
ds_read_b128 v[32:35],v4 offset:2048
s_add_u32 s65,s65,s57
s_and_b32 s59,s50,2048
v_mfma_f32_16x16x32_bf16 v[164:167],v[24:27],a[4:7],0
ds_read_b128 v[36:39],v4 offset:3072
s_lshl_b32 s59,s59,4
s_xor_b32 s60,s67,65536
v_mfma_f32_16x16x32_bf16 v[168:171],v[24:27],a[8:11],0
ds_read_b128 v[40:43],v4 offset:8192
s_add_u32 s59,s59,s60
s_add_u32 s58,s58,s59
v_mfma_f32_16x16x32_bf16 v[172:175],v[24:27],a[12:15],0
ds_read_b128 v[44:47],v4 offset:9216
s_add_u32 s57,s57,s59
s_add_u32 m0,s58,0
v_mfma_f32_16x16x32_bf16 v[176:179],v[24:27],a[16:19],0
buffer_load_dwordx4 v0,s[8:11],s64 offen offset:0 sc1 lds
s_lshl_b32 s23,s51,5
s_add_u32 s23,s23,s68
v_mfma_f32_16x16x32_bf16 v[180:183],v[24:27],a[20:23],0
ds_read_b128 v[48:51],v4 offset:10240
s_lshl_b32 s24,s23,10
s_lshl_b32 s25,s51,10
v_mfma_f32_16x16x32_bf16 v[184:187],v[24:27],a[24:27],0
ds_read_b128 v[52:55],v4 offset:11264
s_waitcnt vmcnt(8)
v_mfma_f32_16x16x32_bf16 v[128:131],v[156:159],v[192:195],0
ds_write_b32 v247,v248
s_add_u32 s25,s25,2883584
s_cmp_eq_u32 s23,s55
s_cselect_b32 s25,s25,s24
v_mfma_f32_16x16x32_bf16 v[188:191],v[24:27],a[28:31],0
ds_read_b128 v[56:59],v4 offset:4096
s_waitcnt vmcnt(7)
v_mfma_f32_16x16x32_bf16 v[128:131],v[156:159],v[196:199],v[128:131]
ds_read_b128 v[60:63],v4 offset:5120
s_add_u32 s25,s25,8388608
s_mov_b32 s6,268435456
s_waitcnt lgkmcnt(9)
v_mfma_f32_16x16x32_bf16 v[160:163],v[28:31],a[32:35],v[160:163]
buffer_load_dwordx4 v0,s[8:11],s64 offen offset:1024 sc1 lds
s_waitcnt vmcnt(7)
v_mfma_f32_16x16x32_bf16 v[128:131],v[156:159],v[200:203],v[128:131]
ds_read_b128 v[64:67],v4 offset:6144
s_cmp_eq_u32 s31,0
s_cselect_b32 s25,s24,s25
s_cselect_b64 s[4:5],s[16:17],s[44:45]
s_cmov_b32 s6,2097152
v_mfma_f32_16x16x32_bf16 v[164:167],v[28:31],a[36:39],v[164:167]
ds_read_b128 v[68:71],v4 offset:7168
s_waitcnt vmcnt(6)
v_mfma_f32_16x16x32_bf16 v[128:131],v[156:159],v[204:207],v[128:131]
ds_read_b128 v[72:75],v4 offset:12288
v_mfma_f32_16x16x32_bf16 v[168:171],v[28:31],a[40:43],v[168:171]
ds_read_b128 v[76:79],v4 offset:13312
s_waitcnt vmcnt(5)
v_mfma_f32_16x16x32_bf16 v[132:135],v[156:159],v[208:211],0
ds_read_b128 v[80:83],v4 offset:14336
v_mfma_f32_16x16x32_bf16 v[172:175],v[28:31],a[44:47],v[172:175]
ds_read_b128 v[84:87],v4 offset:15360
s_waitcnt vmcnt(4)
v_mfma_f32_16x16x32_bf16 v[132:135],v[156:159],v[212:215],v[132:135]
buffer_load_dwordx4 v[224:227],v0,s[4:7],s25 offen sc1
s_lshr_b32 s24,s55,5
s_cmp_lt_u32 s51,s24
s_cselect_b32 s24,1,2
v_mfma_f32_16x16x32_bf16 v[176:179],v[28:31],a[48:51],v[176:179]
buffer_load_dwordx4 v0,s[8:11],s64 offen offset:2048 sc1 lds
s_waitcnt vmcnt(5)
v_mfma_f32_16x16x32_bf16 v[132:135],v[156:159],v[216:219],v[132:135]
v_mov_b32 v252,s24
s_lshl2_add_u32 s25,s51,11018240
v_mfma_f32_16x16x32_bf16 v[180:183],v[28:31],a[52:55],v[180:183]
ds_write_b128 v6,v[128:131]
s_waitcnt vmcnt(4)
v_mfma_f32_16x16x32_bf16 v[132:135],v[156:159],v[220:223],v[132:135]
s_lshl_b32 s24,s68,16
s_add_u32 s24,s24,s31
s_add_u32 s24,s24,s86
v_mfma_f32_16x16x32_bf16 v[184:187],v[28:31],a[56:59],v[184:187]
s_cmp_eq_u32 s24,1537
s_cselect_b32 s25,s25,0x80000000
v_mfma_f32_16x16x32_bf16 v[188:191],v[28:31],a[60:63],v[188:191]
buffer_store_dword v252,off,s[8:11],s25 sc1
s_bitcmp1_b64 s[38:39],s51
s_cselect_b32 s24,128,0
s_waitcnt lgkmcnt(15)
v_mfma_f32_16x16x32_bf16 v[160:163],v[32:35],a[64:67],v[160:163]
ds_write_b128 v6,v[132:135] offset:2048
s_lshl_b32 s23,s51,13
s_lshl2_add_u32 s23,s68,s23
v_mfma_f32_16x16x32_bf16 v[164:167],v[32:35],a[68:71],v[164:167]
buffer_load_dwordx4 v0,s[8:11],s64 offen offset:3072 sc1 lds
s_add_u32 s23,s23,10487168
s_add_u32 s23,s23,s24
v_mfma_f32_16x16x32_bf16 v[168:171],v[32:35],a[72:75],v[168:171]
buffer_load_dword v246,off,s[8:11],s23 sc1
v_lshrrev_b32 v244,4,v1
s_sub_u32 s23,s77,8
v_mfma_f32_16x16x32_bf16 v[172:175],v[32:35],a[76:79],v[172:175]
v_add_u32 v244,s23,v244
v_max_i32 v244,0,v244
v_mfma_f32_16x16x32_bf16 v[176:179],v[32:35],a[80:83],v[176:179]
s_waitcnt lgkmcnt(0)
s_barrier
v_lshl_add_u32 v244,v244,13,v21
v_mfma_f32_16x16x32_bf16 v[180:183],v[32:35],a[84:87],v[180:183]
ds_read_b128 v[248:251],v245
s_add_u32 m0,s58,4096
s_add_u32 s64,s64,4096
v_mfma_f32_16x16x32_bf16 v[184:187],v[32:35],a[88:91],v[184:187]
buffer_load_dwordx4 v0,s[8:11],s64 offen offset:0 sc1 lds
v_mfma_f32_16x16x32_bf16 v[188:191],v[32:35],a[92:95],v[188:191]
buffer_load_dwordx2 v[242:243],v244,s[8:11],0 offen sc1
v_mfma_f32_16x16x32_bf16 v[160:163],v[36:39],a[96:99],v[160:163]
buffer_store_dword v20,off,s[8:11],s73 sc1
s_mov_b32 s73,0x80000000
v_mfma_f32_16x16x32_bf16 v[164:167],v[36:39],a[100:103],v[164:167]
v_mfma_f32_16x16x32_bf16 v[168:171],v[36:39],a[104:107],v[168:171]
buffer_load_dwordx4 v0,s[8:11],s64 offen offset:1024 sc1 lds
v_mfma_f32_16x16x32_bf16 v[172:175],v[36:39],a[108:111],v[172:175]
v_mfma_f32_16x16x32_bf16 v[176:179],v[36:39],a[112:115],v[176:179]
s_waitcnt lgkmcnt(0)
v_or3_b32 v248,v248,v249,v250
v_or_b32 v248,v248,v251
v_mfma_f32_16x16x32_bf16 v[180:183],v[36:39],a[116:119],v[180:183]
v_mfma_f32_16x16x32_bf16 v[184:187],v[36:39],a[120:123],v[184:187]
buffer_load_dwordx4 v0,s[8:11],s64 offen offset:2048 sc1 lds
v_readfirstlane_b32 s72,v248
v_mfma_f32_16x16x32_bf16 v[188:191],v[36:39],a[124:127],v[188:191]
v_mfma_f32_16x16x32_bf16 v[160:163],v[40:43],a[128:131],v[160:163]
v_mfma_f32_16x16x32_bf16 v[164:167],v[40:43],a[132:135],v[164:167]
v_mfma_f32_16x16x32_bf16 v[168:171],v[40:43],a[136:139],v[168:171]
buffer_load_dwordx4 v0,s[8:11],s64 offen offset:3072 sc1 lds
v_mfma_f32_16x16x32_bf16 v[172:175],v[40:43],a[140:143],v[172:175]
v_mfma_f32_16x16x32_bf16 v[176:179],v[40:43],a[144:147],v[176:179]
v_mfma_f32_16x16x32_bf16 v[180:183],v[40:43],a[148:151],v[180:183]
v_mfma_f32_16x16x32_bf16 v[184:187],v[40:43],a[152:155],v[184:187]
s_add_u32 m0,s58,8192
s_add_u32 s64,s64,4096
v_mfma_f32_16x16x32_bf16 v[188:191],v[40:43],a[156:159],v[188:191]
buffer_load_dwordx4 v0,s[8:11],s64 offen offset:0 sc1 lds
v_mfma_f32_16x16x32_bf16 v[160:163],v[44:47],a[160:163],v[160:163]
v_mfma_f32_16x16x32_bf16 v[164:167],v[44:47],a[164:167],v[164:167]
v_mfma_f32_16x16x32_bf16 v[168:171],v[44:47],a[168:171],v[168:171]
v_mfma_f32_16x16x32_bf16 v[172:175],v[44:47],a[172:175],v[172:175]
buffer_load_dwordx4 v0,s[8:11],s64 offen offset:1024 sc1 lds
v_mfma_f32_16x16x32_bf16 v[176:179],v[44:47],a[176:179],v[176:179]
v_mfma_f32_16x16x32_bf16 v[180:183],v[44:47],a[180:183],v[180:183]
v_mfma_f32_16x16x32_bf16 v[184:187],v[44:47],a[184:187],v[184:187]
v_mfma_f32_16x16x32_bf16 v[188:191],v[44:47],a[188:191],v[188:191]
buffer_load_dwordx4 v0,s[8:11],s64 offen offset:2048 sc1 lds
v_mfma_f32_16x16x32_bf16 v[160:163],v[48:51],a[192:195],v[160:163]
v_mfma_f32_16x16x32_bf16 v[164:167],v[48:51],a[196:199],v[164:167]
v_mfma_f32_16x16x32_bf16 v[168:171],v[48:51],a[200:203],v[168:171]
v_mfma_f32_16x16x32_bf16 v[172:175],v[48:51],a[204:207],v[172:175]
buffer_load_dwordx4 v0,s[8:11],s64 offen offset:3072 sc1 lds
v_mfma_f32_16x16x32_bf16 v[176:179],v[48:51],a[208:211],v[176:179]
v_mfma_f32_16x16x32_bf16 v[180:183],v[48:51],a[212:215],v[180:183]
v_mfma_f32_16x16x32_bf16 v[184:187],v[48:51],a[216:219],v[184:187]
v_mfma_f32_16x16x32_bf16 v[188:191],v[48:51],a[220:223],v[188:191]
s_add_u32 m0,s57,24576
v_mfma_f32_16x16x32_bf16 v[160:163],v[52:55],a[224:227],v[160:163]
buffer_load_dwordx4 v0,s[8:11],s65 offen offset:0 sc1 lds
v_mfma_f32_16x16x32_bf16 v[164:167],v[52:55],a[228:231],v[164:167]
v_mfma_f32_16x16x32_bf16 v[168:171],v[52:55],a[232:235],v[168:171]
v_mfma_f32_16x16x32_bf16 v[172:175],v[52:55],a[236:239],v[172:175]
v_mfma_f32_16x16x32_bf16 v[176:179],v[52:55],a[240:243],v[176:179]
buffer_load_dwordx4 v0,s[8:11],s65 offen offset:1024 sc1 lds
v_mfma_f32_16x16x32_bf16 v[180:183],v[52:55],a[244:247],v[180:183]
v_mfma_f32_16x16x32_bf16 v[184:187],v[52:55],a[248:251],v[184:187]
v_mfma_f32_16x16x32_bf16 v[188:191],v[52:55],a[252:255],v[188:191]
v_mfma_f32_16x16x32_bf16 v[192:195],v[56:59],a[0:3],0
v_mfma_f32_16x16x32_bf16 v[196:199],v[56:59],a[4:7],0
v_mfma_f32_16x16x32_bf16 v[200:203],v[56:59],a[8:11],0
v_cvt_pk_bf16_f32 v24,v160,v164
v_cvt_pk_bf16_f32 v25,v168,v172
v_mfma_f32_16x16x32_bf16 v[204:207],v[56:59],a[12:15],0
v_cvt_pk_bf16_f32 v26,v176,v180
v_cvt_pk_bf16_f32 v27,v184,v188
v_mfma_f32_16x16x32_bf16 v[208:211],v[56:59],a[16:19],0
v_cvt_pk_bf16_f32 v28,v161,v165
v_cvt_pk_bf16_f32 v29,v169,v173
v_mfma_f32_16x16x32_bf16 v[212:215],v[56:59],a[20:23],0
v_cvt_pk_bf16_f32 v30,v177,v181
v_cvt_pk_bf16_f32 v31,v185,v189
v_mfma_f32_16x16x32_bf16 v[216:219],v[56:59],a[24:27],0
v_cvt_pk_bf16_f32 v32,v162,v166
v_cvt_pk_bf16_f32 v33,v170,v174
v_mfma_f32_16x16x32_bf16 v[220:223],v[56:59],a[28:31],0
v_cvt_pk_bf16_f32 v34,v178,v182
v_cvt_pk_bf16_f32 v35,v186,v190
v_mfma_f32_16x16x32_bf16 v[192:195],v[60:63],a[32:35],v[192:195]
v_cvt_pk_bf16_f32 v36,v163,v167
v_cvt_pk_bf16_f32 v37,v171,v175
v_mfma_f32_16x16x32_bf16 v[196:199],v[60:63],a[36:39],v[196:199]
v_cvt_pk_bf16_f32 v38,v179,v183
v_cvt_pk_bf16_f32 v39,v187,v191
v_mfma_f32_16x16x32_bf16 v[200:203],v[60:63],a[40:43],v[200:203]
v_mfma_f32_16x16x32_bf16 v[204:207],v[60:63],a[44:47],v[204:207]
v_mfma_f32_16x16x32_bf16 v[208:211],v[60:63],a[48:51],v[208:211]
v_mfma_f32_16x16x32_bf16 v[212:215],v[60:63],a[52:55],v[212:215]
v_mfma_f32_16x16x32_bf16 v[216:219],v[60:63],a[56:59],v[216:219]
v_mfma_f32_16x16x32_bf16 v[220:223],v[60:63],a[60:63],v[220:223]
v_mfma_f32_16x16x32_bf16 v[192:195],v[64:67],a[64:67],v[192:195]
v_mfma_f32_16x16x32_bf16 v[196:199],v[64:67],a[68:71],v[196:199]
v_mfma_f32_16x16x32_bf16 v[200:203],v[64:67],a[72:75],v[200:203]
v_mfma_f32_16x16x32_bf16 v[204:207],v[64:67],a[76:79],v[204:207]
v_mfma_f32_16x16x32_bf16 v[208:211],v[64:67],a[80:83],v[208:211]
v_mfma_f32_16x16x32_bf16 v[212:215],v[64:67],a[84:87],v[212:215]
v_mfma_f32_16x16x32_bf16 v[216:219],v[64:67],a[88:91],v[216:219]
v_mfma_f32_16x16x32_bf16 v[220:223],v[64:67],a[92:95],v[220:223]
v_mfma_f32_16x16x32_bf16 v[192:195],v[68:71],a[96:99],v[192:195]
v_mfma_f32_16x16x32_bf16 v[196:199],v[68:71],a[100:103],v[196:199]
v_mfma_f32_16x16x32_bf16 v[200:203],v[68:71],a[104:107],v[200:203]
v_mfma_f32_16x16x32_bf16 v[204:207],v[68:71],a[108:111],v[204:207]
v_mfma_f32_16x16x32_bf16 v[208:211],v[68:71],a[112:115],v[208:211]
s_add_u32 s62,s69,0
v_mfma_f32_16x16x32_bf16 v[212:215],v[68:71],a[116:119],v[212:215]
buffer_store_dwordx4 v[24:27],v5,s[8:11],s62 offen
v_mfma_f32_16x16x32_bf16 v[216:219],v[68:71],a[120:123],v[216:219]
v_mfma_f32_16x16x32_bf16 v[220:223],v[68:71],a[124:127],v[220:223]
v_mfma_f32_16x16x32_bf16 v[192:195],v[72:75],a[128:131],v[192:195]
s_add_u32 s62,s69,16384
v_mfma_f32_16x16x32_bf16 v[196:199],v[72:75],a[132:135],v[196:199]
buffer_store_dwordx4 v[28:31],v5,s[8:11],s62 offen
v_mfma_f32_16x16x32_bf16 v[200:203],v[72:75],a[136:139],v[200:203]
v_mfma_f32_16x16x32_bf16 v[204:207],v[72:75],a[140:143],v[204:207]
v_mfma_f32_16x16x32_bf16 v[208:211],v[72:75],a[144:147],v[208:211]
s_add_u32 s62,s69,32768
v_mfma_f32_16x16x32_bf16 v[212:215],v[72:75],a[148:151],v[212:215]
buffer_store_dwordx4 v[32:35],v5,s[8:11],s62 offen
v_mfma_f32_16x16x32_bf16 v[216:219],v[72:75],a[152:155],v[216:219]
v_mfma_f32_16x16x32_bf16 v[220:223],v[72:75],a[156:159],v[220:223]
v_mfma_f32_16x16x32_bf16 v[192:195],v[76:79],a[160:163],v[192:195]
s_add_u32 s62,s69,49152
v_mfma_f32_16x16x32_bf16 v[196:199],v[76:79],a[164:167],v[196:199]
buffer_store_dwordx4 v[36:39],v5,s[8:11],s62 offen
v_mfma_f32_16x16x32_bf16 v[200:203],v[76:79],a[168:171],v[200:203]
v_mfma_f32_16x16x32_bf16 v[204:207],v[76:79],a[172:175],v[204:207]
v_mfma_f32_16x16x32_bf16 v[208:211],v[76:79],a[176:179],v[208:211]
v_mfma_f32_16x16x32_bf16 v[212:215],v[76:79],a[180:183],v[212:215]
v_mfma_f32_16x16x32_bf16 v[216:219],v[76:79],a[184:187],v[216:219]
v_mfma_f32_16x16x32_bf16 v[220:223],v[76:79],a[188:191],v[220:223]
v_mfma_f32_16x16x32_bf16 v[192:195],v[80:83],a[192:195],v[192:195]
v_mfma_f32_16x16x32_bf16 v[196:199],v[80:83],a[196:199],v[196:199]
v_mfma_f32_16x16x32_bf16 v[200:203],v[80:83],a[200:203],v[200:203]
v_mfma_f32_16x16x32_bf16 v[204:207],v[80:83],a[204:207],v[204:207]
v_mfma_f32_16x16x32_bf16 v[208:211],v[80:83],a[208:211],v[208:211]
v_mfma_f32_16x16x32_bf16 v[212:215],v[80:83],a[212:215],v[212:215]
v_mfma_f32_16x16x32_bf16 v[216:219],v[80:83],a[216:219],v[216:219]
v_mfma_f32_16x16x32_bf16 v[220:223],v[80:83],a[220:223],v[220:223]
v_mfma_f32_16x16x32_bf16 v[192:195],v[84:87],a[224:227],v[192:195]
v_mfma_f32_16x16x32_bf16 v[196:199],v[84:87],a[228:231],v[196:199]
v_mfma_f32_16x16x32_bf16 v[200:203],v[84:87],a[232:235],v[200:203]
v_mfma_f32_16x16x32_bf16 v[204:207],v[84:87],a[236:239],v[204:207]
v_mfma_f32_16x16x32_bf16 v[208:211],v[84:87],a[240:243],v[208:211]
v_mfma_f32_16x16x32_bf16 v[212:215],v[84:87],a[244:247],v[212:215]
v_mfma_f32_16x16x32_bf16 v[216:219],v[84:87],a[248:251],v[216:219]
v_mfma_f32_16x16x32_bf16 v[220:223],v[84:87],a[252:255],v[220:223]
v_cvt_pk_bf16_f32 v40,v192,v196
v_cvt_pk_bf16_f32 v41,v200,v204
v_cvt_pk_bf16_f32 v42,v208,v212
s_nop 4
v_cvt_pk_bf16_f32 v43,v216,v220
s_add_u32 s62,s69,262144
buffer_store_dwordx4 v[40:43],v5,s[8:11],s62 offen
v_cvt_pk_bf16_f32 v44,v193,v197
v_cvt_pk_bf16_f32 v45,v201,v205
v_cvt_pk_bf16_f32 v46,v209,v213
v_cvt_pk_bf16_f32 v47,v217,v221
s_add_u32 s62,s69,278528
buffer_store_dwordx4 v[44:47],v5,s[8:11],s62 offen
v_cvt_pk_bf16_f32 v48,v194,v198
v_cvt_pk_bf16_f32 v49,v202,v206
v_cvt_pk_bf16_f32 v50,v210,v214
v_cvt_pk_bf16_f32 v51,v218,v222
s_add_u32 s62,s69,294912
buffer_store_dwordx4 v[48:51],v5,s[8:11],s62 offen
v_cvt_pk_bf16_f32 v52,v195,v199
v_cvt_pk_bf16_f32 v53,v203,v207
v_cvt_pk_bf16_f32 v54,v211,v215
v_cvt_pk_bf16_f32 v55,v219,v223
s_add_u32 s62,s69,311296
buffer_store_dwordx4 v[52:55],v5,s[8:11],s62 offen
s_cmp_lg_u32 s72,0
s_cbranch_scc1 L_aa_67
s_waitcnt vmcnt(8)
s_branch L_aa_77
L_aa_65:
ds_read_b128 v[24:27],v4 offset:0
ds_read_b128 v[28:31],v4 offset:1024
s_min_u32 s56,s32,s33
s_cmp_lt_u32 s77,64
s_cselect_b32 s56,s56,0
s_cmp_eq_u32 s56,0
s_cselect_b32 s72,0x80000000,0
v_mov_b32 v248,s72
s_or_b32 s64,s70,s72
s_or_b32 s65,s71,s72
s_cmp_lt_u32 s30,s31
s_cselect_b32 s65,0x80000000,s65
s_and_b32 s57,s46,1
s_mul_i32 s58,s57,12288
s_add_u32 s64,s64,s58
s_lshl_b32 s57,s57,11
s_waitcnt lgkmcnt(1)
v_mfma_f32_16x16x32_bf16 v[160:163],v[24:27],a[0:3],0
ds_read_b128 v[32:35],v4 offset:2048
s_add_u32 s65,s65,s57
s_and_b32 s59,s50,2048
v_mfma_f32_16x16x32_bf16 v[164:167],v[24:27],a[4:7],0
ds_read_b128 v[36:39],v4 offset:3072
s_lshl_b32 s59,s59,4
s_xor_b32 s60,s67,65536
v_mfma_f32_16x16x32_bf16 v[168:171],v[24:27],a[8:11],0
ds_read_b128 v[40:43],v4 offset:8192
s_add_u32 s59,s59,s60
s_add_u32 s58,s58,s59
v_mfma_f32_16x16x32_bf16 v[172:175],v[24:27],a[12:15],0
ds_read_b128 v[44:47],v4 offset:9216
s_add_u32 s57,s57,s59
s_add_u32 m0,s58,0
v_mfma_f32_16x16x32_bf16 v[176:179],v[24:27],a[16:19],0
buffer_load_dwordx4 v0,s[8:11],s64 offen offset:0 sc1 lds
s_lshl_b32 s23,s51,5
s_add_u32 s23,s23,s68
v_mfma_f32_16x16x32_bf16 v[180:183],v[24:27],a[20:23],0
ds_read_b128 v[48:51],v4 offset:10240
s_lshl_b32 s24,s23,10
s_lshl_b32 s25,s51,10
v_mfma_f32_16x16x32_bf16 v[184:187],v[24:27],a[24:27],0
ds_read_b128 v[52:55],v4 offset:11264
s_add_u32 s25,s25,2883584
s_cmp_eq_u32 s23,s55
s_cselect_b32 s25,s25,s24
v_mfma_f32_16x16x32_bf16 v[188:191],v[24:27],a[28:31],0
ds_write_b32 v247,v248
s_add_u32 s25,s25,8388608
s_mov_b32 s6,268435456
s_waitcnt lgkmcnt(7)
v_mfma_f32_16x16x32_bf16 v[160:163],v[28:31],a[32:35],v[160:163]
buffer_load_dwordx4 v0,s[8:11],s64 offen offset:1024 sc1 lds
s_cmp_eq_u32 s31,0
s_cselect_b32 s25,s24,s25
s_cselect_b64 s[4:5],s[16:17],s[44:45]
s_cmov_b32 s6,2097152
v_mfma_f32_16x16x32_bf16 v[164:167],v[28:31],a[36:39],v[164:167]
ds_read_b128 v[56:59],v4 offset:4096
v_mfma_f32_16x16x32_bf16 v[168:171],v[28:31],a[40:43],v[168:171]
ds_read_b128 v[60:63],v4 offset:5120
v_mfma_f32_16x16x32_bf16 v[172:175],v[28:31],a[44:47],v[172:175]
ds_read_b128 v[64:67],v4 offset:6144
v_mfma_f32_16x16x32_bf16 v[176:179],v[28:31],a[48:51],v[176:179]
buffer_load_dwordx4 v0,s[8:11],s64 offen offset:2048 sc1 lds
v_mfma_f32_16x16x32_bf16 v[180:183],v[28:31],a[52:55],v[180:183]
ds_read_b128 v[68:71],v4 offset:7168
v_mfma_f32_16x16x32_bf16 v[184:187],v[28:31],a[56:59],v[184:187]
ds_read_b128 v[72:75],v4 offset:12288
v_mfma_f32_16x16x32_bf16 v[188:191],v[28:31],a[60:63],v[188:191]
ds_read_b128 v[76:79],v4 offset:13312
s_waitcnt lgkmcnt(12)
v_mfma_f32_16x16x32_bf16 v[160:163],v[32:35],a[64:67],v[160:163]
buffer_load_dwordx4 v0,s[8:11],s64 offen offset:3072 sc1 lds
v_mfma_f32_16x16x32_bf16 v[164:167],v[32:35],a[68:71],v[164:167]
ds_read_b128 v[80:83],v4 offset:14336
v_mfma_f32_16x16x32_bf16 v[168:171],v[32:35],a[72:75],v[168:171]
ds_read_b128 v[84:87],v4 offset:15360
v_mfma_f32_16x16x32_bf16 v[172:175],v[32:35],a[76:79],v[172:175]
buffer_load_dwordx4 v[224:227],v0,s[4:7],s25 offen sc1
s_lshr_b32 s24,s55,5
s_cmp_lt_u32 s51,s24
s_cselect_b32 s24,1,2
v_mfma_f32_16x16x32_bf16 v[176:179],v[32:35],a[80:83],v[176:179]
s_add_u32 m0,s58,4096
s_add_u32 s64,s64,4096
v_mov_b32 v252,s24
v_mfma_f32_16x16x32_bf16 v[180:183],v[32:35],a[84:87],v[180:183]
buffer_load_dwordx4 v0,s[8:11],s64 offen offset:0 sc1 lds
s_lshl2_add_u32 s25,s51,11018240
s_lshl_b32 s24,s68,16
v_mfma_f32_16x16x32_bf16 v[184:187],v[32:35],a[88:91],v[184:187]
s_add_u32 s24,s24,s31
s_add_u32 s24,s24,s86
s_cmp_eq_u32 s24,1537
s_cselect_b32 s25,s25,0x80000000
v_mfma_f32_16x16x32_bf16 v[188:191],v[32:35],a[92:95],v[188:191]
buffer_store_dword v252,off,s[8:11],s25 sc1
s_waitcnt lgkmcnt(0)
s_barrier
s_waitcnt lgkmcnt(13)
v_mfma_f32_16x16x32_bf16 v[160:163],v[36:39],a[96:99],v[160:163]
ds_read_b128 v[248:251],v245
s_bitcmp1_b64 s[38:39],s51
s_cselect_b32 s24,128,0
v_mfma_f32_16x16x32_bf16 v[164:167],v[36:39],a[100:103],v[164:167]
buffer_load_dwordx4 v0,s[8:11],s64 offen offset:1024 sc1 lds
s_lshl_b32 s23,s51,13
s_lshl2_add_u32 s23,s68,s23
v_mfma_f32_16x16x32_bf16 v[168:171],v[36:39],a[104:107],v[168:171]
s_add_u32 s23,s23,10487168
s_add_u32 s23,s23,s24
v_mfma_f32_16x16x32_bf16 v[172:175],v[36:39],a[108:111],v[172:175]
buffer_load_dword v246,off,s[8:11],s23 sc1
v_lshrrev_b32 v244,4,v1
s_sub_u32 s23,s77,8
v_mfma_f32_16x16x32_bf16 v[176:179],v[36:39],a[112:115],v[176:179]
v_add_u32 v244,s23,v244
v_max_i32 v244,0,v244
v_mfma_f32_16x16x32_bf16 v[180:183],v[36:39],a[116:119],v[180:183]
buffer_load_dwordx4 v0,s[8:11],s64 offen offset:2048 sc1 lds
v_lshl_add_u32 v244,v244,13,v21
v_mfma_f32_16x16x32_bf16 v[184:187],v[36:39],a[120:123],v[184:187]
buffer_load_dwordx2 v[242:243],v244,s[8:11],0 offen sc1
s_waitcnt lgkmcnt(0)
v_or3_b32 v248,v248,v249,v250
v_mfma_f32_16x16x32_bf16 v[188:191],v[36:39],a[124:127],v[188:191]
v_or_b32 v248,v248,v251
v_mfma_f32_16x16x32_bf16 v[160:163],v[40:43],a[128:131],v[160:163]
v_readfirstlane_b32 s72,v248
v_mfma_f32_16x16x32_bf16 v[164:167],v[40:43],a[132:135],v[164:167]
buffer_load_dwordx4 v0,s[8:11],s64 offen offset:3072 sc1 lds
v_mfma_f32_16x16x32_bf16 v[168:171],v[40:43],a[136:139],v[168:171]
v_mfma_f32_16x16x32_bf16 v[172:175],v[40:43],a[140:143],v[172:175]
v_mfma_f32_16x16x32_bf16 v[176:179],v[40:43],a[144:147],v[176:179]
s_waitcnt vmcnt(12)
v_mfma_f32_16x16x32_bf16 v[180:183],v[40:43],a[148:151],v[180:183]
buffer_store_dword v20,off,s[8:11],s73 sc1
s_add_u32 m0,s58,8192
s_add_u32 s64,s64,4096
v_mfma_f32_16x16x32_bf16 v[184:187],v[40:43],a[152:155],v[184:187]
buffer_load_dwordx4 v0,s[8:11],s64 offen offset:0 sc1 lds
s_mov_b32 s73,0x80000000
v_mfma_f32_16x16x32_bf16 v[188:191],v[40:43],a[156:159],v[188:191]
v_mfma_f32_16x16x32_bf16 v[160:163],v[44:47],a[160:163],v[160:163]
v_mfma_f32_16x16x32_bf16 v[164:167],v[44:47],a[164:167],v[164:167]
v_mfma_f32_16x16x32_bf16 v[168:171],v[44:47],a[168:171],v[168:171]
buffer_load_dwordx4 v0,s[8:11],s64 offen offset:1024 sc1 lds
v_mfma_f32_16x16x32_bf16 v[172:175],v[44:47],a[172:175],v[172:175]
v_mfma_f32_16x16x32_bf16 v[176:179],v[44:47],a[176:179],v[176:179]
v_mfma_f32_16x16x32_bf16 v[180:183],v[44:47],a[180:183],v[180:183]
v_mfma_f32_16x16x32_bf16 v[184:187],v[44:47],a[184:187],v[184:187]
buffer_load_dwordx4 v0,s[8:11],s64 offen offset:2048 sc1 lds
v_mfma_f32_16x16x32_bf16 v[188:191],v[44:47],a[188:191],v[188:191]
v_mfma_f32_16x16x32_bf16 v[160:163],v[48:51],a[192:195],v[160:163]
v_mfma_f32_16x16x32_bf16 v[164:167],v[48:51],a[196:199],v[164:167]
v_mfma_f32_16x16x32_bf16 v[168:171],v[48:51],a[200:203],v[168:171]
buffer_load_dwordx4 v0,s[8:11],s64 offen offset:3072 sc1 lds
v_mfma_f32_16x16x32_bf16 v[172:175],v[48:51],a[204:207],v[172:175]
v_mfma_f32_16x16x32_bf16 v[176:179],v[48:51],a[208:211],v[176:179]
v_mfma_f32_16x16x32_bf16 v[180:183],v[48:51],a[212:215],v[180:183]
v_mfma_f32_16x16x32_bf16 v[184:187],v[48:51],a[216:219],v[184:187]
s_add_u32 m0,s57,24576
v_mfma_f32_16x16x32_bf16 v[188:191],v[48:51],a[220:223],v[188:191]
buffer_load_dwordx4 v0,s[8:11],s65 offen offset:0 sc1 lds
v_mfma_f32_16x16x32_bf16 v[160:163],v[52:55],a[224:227],v[160:163]
v_mfma_f32_16x16x32_bf16 v[164:167],v[52:55],a[228:231],v[164:167]
v_mfma_f32_16x16x32_bf16 v[168:171],v[52:55],a[232:235],v[168:171]
v_mfma_f32_16x16x32_bf16 v[172:175],v[52:55],a[236:239],v[172:175]
buffer_load_dwordx4 v0,s[8:11],s65 offen offset:1024 sc1 lds
v_mfma_f32_16x16x32_bf16 v[176:179],v[52:55],a[240:243],v[176:179]
v_mfma_f32_16x16x32_bf16 v[180:183],v[52:55],a[244:247],v[180:183]
v_mfma_f32_16x16x32_bf16 v[184:187],v[52:55],a[248:251],v[184:187]
v_mfma_f32_16x16x32_bf16 v[188:191],v[52:55],a[252:255],v[188:191]
v_mfma_f32_16x16x32_bf16 v[192:195],v[56:59],a[0:3],0
v_mfma_f32_16x16x32_bf16 v[196:199],v[56:59],a[4:7],0
v_mfma_f32_16x16x32_bf16 v[200:203],v[56:59],a[8:11],0
v_cvt_pk_bf16_f32 v24,v160,v164
v_cvt_pk_bf16_f32 v25,v168,v172
v_mfma_f32_16x16x32_bf16 v[204:207],v[56:59],a[12:15],0
v_cvt_pk_bf16_f32 v26,v176,v180
v_cvt_pk_bf16_f32 v27,v184,v188
v_mfma_f32_16x16x32_bf16 v[208:211],v[56:59],a[16:19],0
v_cvt_pk_bf16_f32 v28,v161,v165
v_cvt_pk_bf16_f32 v29,v169,v173
v_mfma_f32_16x16x32_bf16 v[212:215],v[56:59],a[20:23],0
v_cvt_pk_bf16_f32 v30,v177,v181
v_cvt_pk_bf16_f32 v31,v185,v189
v_mfma_f32_16x16x32_bf16 v[216:219],v[56:59],a[24:27],0
v_cvt_pk_bf16_f32 v32,v162,v166
v_cvt_pk_bf16_f32 v33,v170,v174
v_mfma_f32_16x16x32_bf16 v[220:223],v[56:59],a[28:31],0
v_cvt_pk_bf16_f32 v34,v178,v182
v_cvt_pk_bf16_f32 v35,v186,v190
v_mfma_f32_16x16x32_bf16 v[192:195],v[60:63],a[32:35],v[192:195]
v_cvt_pk_bf16_f32 v36,v163,v167
v_cvt_pk_bf16_f32 v37,v171,v175
v_mfma_f32_16x16x32_bf16 v[196:199],v[60:63],a[36:39],v[196:199]
v_cvt_pk_bf16_f32 v38,v179,v183
v_cvt_pk_bf16_f32 v39,v187,v191
v_mfma_f32_16x16x32_bf16 v[200:203],v[60:63],a[40:43],v[200:203]
v_mfma_f32_16x16x32_bf16 v[204:207],v[60:63],a[44:47],v[204:207]
v_mfma_f32_16x16x32_bf16 v[208:211],v[60:63],a[48:51],v[208:211]
v_mfma_f32_16x16x32_bf16 v[212:215],v[60:63],a[52:55],v[212:215]
v_mfma_f32_16x16x32_bf16 v[216:219],v[60:63],a[56:59],v[216:219]
v_mfma_f32_16x16x32_bf16 v[220:223],v[60:63],a[60:63],v[220:223]
v_mfma_f32_16x16x32_bf16 v[192:195],v[64:67],a[64:67],v[192:195]
v_mfma_f32_16x16x32_bf16 v[196:199],v[64:67],a[68:71],v[196:199]
v_mfma_f32_16x16x32_bf16 v[200:203],v[64:67],a[72:75],v[200:203]
v_mfma_f32_16x16x32_bf16 v[204:207],v[64:67],a[76:79],v[204:207]
v_mfma_f32_16x16x32_bf16 v[208:211],v[64:67],a[80:83],v[208:211]
v_mfma_f32_16x16x32_bf16 v[212:215],v[64:67],a[84:87],v[212:215]
v_mfma_f32_16x16x32_bf16 v[216:219],v[64:67],a[88:91],v[216:219]
v_mfma_f32_16x16x32_bf16 v[220:223],v[64:67],a[92:95],v[220:223]
v_mfma_f32_16x16x32_bf16 v[192:195],v[68:71],a[96:99],v[192:195]
v_mfma_f32_16x16x32_bf16 v[196:199],v[68:71],a[100:103],v[196:199]
v_mfma_f32_16x16x32_bf16 v[200:203],v[68:71],a[104:107],v[200:203]
v_mfma_f32_16x16x32_bf16 v[204:207],v[68:71],a[108:111],v[204:207]
v_mfma_f32_16x16x32_bf16 v[208:211],v[68:71],a[112:115],v[208:211]
s_add_u32 s62,s69,0
v_mfma_f32_16x16x32_bf16 v[212:215],v[68:71],a[116:119],v[212:215]
buffer_store_dwordx4 v[24:27],v5,s[8:11],s62 offen
v_mfma_f32_16x16x32_bf16 v[216:219],v[68:71],a[120:123],v[216:219]
v_mfma_f32_16x16x32_bf16 v[220:223],v[68:71],a[124:127],v[220:223]
v_mfma_f32_16x16x32_bf16 v[192:195],v[72:75],a[128:131],v[192:195]
s_add_u32 s62,s69,16384
v_mfma_f32_16x16x32_bf16 v[196:199],v[72:75],a[132:135],v[196:199]
buffer_store_dwordx4 v[28:31],v5,s[8:11],s62 offen
v_mfma_f32_16x16x32_bf16 v[200:203],v[72:75],a[136:139],v[200:203]
v_mfma_f32_16x16x32_bf16 v[204:207],v[72:75],a[140:143],v[204:207]
v_mfma_f32_16x16x32_bf16 v[208:211],v[72:75],a[144:147],v[208:211]
s_add_u32 s62,s69,32768
v_mfma_f32_16x16x32_bf16 v[212:215],v[72:75],a[148:151],v[212:215]
buffer_store_dwordx4 v[32:35],v5,s[8:11],s62 offen
v_mfma_f32_16x16x32_bf16 v[216:219],v[72:75],a[152:155],v[216:219]
v_mfma_f32_16x16x32_bf16 v[220:223],v[72:75],a[156:159],v[220:223]
v_mfma_f32_16x16x32_bf16 v[192:195],v[76:79],a[160:163],v[192:195]
s_add_u32 s62,s69,49152
v_mfma_f32_16x16x32_bf16 v[196:199],v[76:79],a[164:167],v[196:199]
buffer_store_dwordx4 v[36:39],v5,s[8:11],s62 offen
v_mfma_f32_16x16x32_bf16 v[200:203],v[76:79],a[168:171],v[200:203]
v_mfma_f32_16x16x32_bf16 v[204:207],v[76:79],a[172:175],v[204:207]
v_mfma_f32_16x16x32_bf16 v[208:211],v[76:79],a[176:179],v[208:211]
v_mfma_f32_16x16x32_bf16 v[212:215],v[76:79],a[180:183],v[212:215]
v_mfma_f32_16x16x32_bf16 v[216:219],v[76:79],a[184:187],v[216:219]
v_mfma_f32_16x16x32_bf16 v[220:223],v[76:79],a[188:191],v[220:223]
v_mfma_f32_16x16x32_bf16 v[192:195],v[80:83],a[192:195],v[192:195]
v_mfma_f32_16x16x32_bf16 v[196:199],v[80:83],a[196:199],v[196:199]
v_mfma_f32_16x16x32_bf16 v[200:203],v[80:83],a[200:203],v[200:203]
v_mfma_f32_16x16x32_bf16 v[204:207],v[80:83],a[204:207],v[204:207]
v_mfma_f32_16x16x32_bf16 v[208:211],v[80:83],a[208:211],v[208:211]
v_mfma_f32_16x16x32_bf16 v[212:215],v[80:83],a[212:215],v[212:215]
v_mfma_f32_16x16x32_bf16 v[216:219],v[80:83],a[216:219],v[216:219]
v_mfma_f32_16x16x32_bf16 v[220:223],v[80:83],a[220:223],v[220:223]
v_mfma_f32_16x16x32_bf16 v[192:195],v[84:87],a[224:227],v[192:195]
v_mfma_f32_16x16x32_bf16 v[196:199],v[84:87],a[228:231],v[196:199]
v_mfma_f32_16x16x32_bf16 v[200:203],v[84:87],a[232:235],v[200:203]
v_mfma_f32_16x16x32_bf16 v[204:207],v[84:87],a[236:239],v[204:207]
v_mfma_f32_16x16x32_bf16 v[208:211],v[84:87],a[240:243],v[208:211]
v_mfma_f32_16x16x32_bf16 v[212:215],v[84:87],a[244:247],v[212:215]
v_mfma_f32_16x16x32_bf16 v[216:219],v[84:87],a[248:251],v[216:219]
v_mfma_f32_16x16x32_bf16 v[220:223],v[84:87],a[252:255],v[220:223]
v_cvt_pk_bf16_f32 v40,v192,v196
v_cvt_pk_bf16_f32 v41,v200,v204
v_cvt_pk_bf16_f32 v42,v208,v212
s_nop 4
v_cvt_pk_bf16_f32 v43,v216,v220
s_add_u32 s62,s69,262144
buffer_store_dwordx4 v[40:43],v5,s[8:11],s62 offen
v_cvt_pk_bf16_f32 v44,v193,v197
v_cvt_pk_bf16_f32 v45,v201,v205
v_cvt_pk_bf16_f32 v46,v209,v213
v_cvt_pk_bf16_f32 v47,v217,v221
s_add_u32 s62,s69,278528
buffer_store_dwordx4 v[44:47],v5,s[8:11],s62 offen
v_cvt_pk_bf16_f32 v48,v194,v198
v_cvt_pk_bf16_f32 v49,v202,v206
v_cvt_pk_bf16_f32 v50,v210,v214
v_cvt_pk_bf16_f32 v51,v218,v222
s_add_u32 s62,s69,294912
buffer_store_dwordx4 v[48:51],v5,s[8:11],s62 offen
v_cvt_pk_bf16_f32 v52,v195,v199
v_cvt_pk_bf16_f32 v53,v203,v207
v_cvt_pk_bf16_f32 v54,v211,v215
v_cvt_pk_bf16_f32 v55,v219,v223
s_add_u32 s62,s69,311296
buffer_store_dwordx4 v[52:55],v5,s[8:11],s62 offen
s_cmp_lg_u32 s72,0
s_cbranch_scc1 L_aa_67
s_waitcnt vmcnt(8)
L_aa_77:
s_barrier
s_cmp_lt_u32 s30,s31
s_cbranch_scc1 L_ao_82
s_xor_b32 s67,s67,65536
s_and_b32 s56,s50,2048
s_lshl_b32 s56,s56,4
s_add_u32 s56,s56,s67
v_add_u32 v2,s56,v0
v_add_u32 v239,s56,v253
s_and_b32 s56,s50,1024
s_lshl_b32 s56,s56,2
v_add_u32 v238,s56,v2
s_mov_b32 s76,s71
s_mov_b32 s53,s77
ds_read_b128 v[24:27],v238 offset:16384
ds_read_b128 v[40:43],v2 offset:0
ds_read_b128 v[56:59],v2 offset:4096
ds_read_b128 v[28:31],v238 offset:17408
ds_read_b128 v[44:47],v2 offset:1024
ds_read_b128 v[60:63],v2 offset:5120
ds_read_b128 v[32:35],v238 offset:18432
ds_read_b128 v[48:51],v2 offset:2048
ds_read_b128 v[64:67],v2 offset:6144
ds_read_b128 v[36:39],v238 offset:19456
ds_read_b128 v[52:55],v2 offset:3072
ds_read_b128 v[68:71],v2 offset:7168
s_waitcnt lgkmcnt(9)
v_mfma_f32_16x16x32_bf16 v[128:131],v[40:43],v[24:27],v[8:11]
ds_read_b128 v[72:75],v2 offset:24576
v_mfma_f32_16x16x32_bf16 v[132:135],v[56:59],v[24:27],v[12:15]
ds_read_b128 v[76:79],v2 offset:25600
s_waitcnt lgkmcnt(8)
v_mfma_f32_16x16x32_bf16 v[128:131],v[44:47],v[28:31],v[128:131]
ds_read_b128 v[80:83],v2 offset:26624
v_mfma_f32_16x16x32_bf16 v[132:135],v[60:63],v[28:31],v[132:135]
ds_read_b128 v[84:87],v2 offset:27648
s_waitcnt lgkmcnt(7)
v_mfma_f32_16x16x32_bf16 v[128:131],v[48:51],v[32:35],v[128:131]
ds_read_b64 v[120:121],v239 offset:24576
v_mfma_f32_16x16x32_bf16 v[132:135],v[64:67],v[32:35],v[132:135]
ds_read_b64 v[122:123],v239 offset:25600
s_waitcnt lgkmcnt(6)
v_mfma_f32_16x16x32_bf16 v[128:131],v[52:55],v[36:39],v[128:131]
ds_read_b64 v[124:125],v239 offset:26624
v_mfma_f32_16x16x32_bf16 v[132:135],v[68:71],v[36:39],v[132:135]
ds_read_b64 v[126:127],v239 offset:27648
s_waitcnt lgkmcnt(4)
v_mfma_f32_16x16x32_bf16 v[136:139],v[72:75],v[24:27],0
ds_read_b128 v[88:91],v2 offset:8192
ds_read_b128 v[92:95],v2 offset:9216
v_mfma_f32_16x16x32_bf16 v[136:139],v[76:79],v[28:31],v[136:139]
ds_read_b128 v[96:99],v2 offset:10240
ds_read_b128 v[100:103],v2 offset:11264
v_mfma_f32_16x16x32_bf16 v[136:139],v[80:83],v[32:35],v[136:139]
ds_read_b128 v[104:107],v2 offset:12288
ds_read_b128 v[108:111],v2 offset:13312
v_mfma_f32_16x16x32_bf16 v[136:139],v[84:87],v[36:39],v[136:139]
ds_read_b128 v[112:115],v2 offset:14336
ds_read_b128 v[116:119],v2 offset:15360
s_cmp_eq_u32 s30,0
s_cbranch_scc1 L_aa_66
v_max3_u32 v238,v72,v73,v74
v_max3_u32 v238,v74,v75,v238
v_max3_u32 v238,v76,v77,v238
v_max3_u32 v238,v78,v79,v238
v_max3_u32 v238,v80,v81,v238
v_max3_u32 v238,v82,v83,v238
v_max3_u32 v238,v84,v85,v238
v_max3_u32 v238,v86,v87,v238
s_waitcnt lgkmcnt(8)
v_max3_u32 v238,v120,v121,v238
v_max3_u32 v238,v122,v123,v238
v_max3_u32 v238,v124,v125,v238
v_max3_u32 v238,v126,v127,v238
v_cmp_eq_u32 vcc,-1,v238
s_cmp_lg_u64 vcc,0
s_cselect_b32 s27,1,0
s_andn2_b32 s57,s27,s31
s_add_u32 s66,s66,4
s_bfe_u32 s56,s66,0x10002
s_bitset0_b32 s37,s56
s_lshl_b32 s56,s57,s56
s_or_b32 s37,s37,s56
s_or_b32 s56,s37,s66
v_mov_b32 v22,s56
s_xor_b32 s69,s69,524288
s_waitcnt vmcnt(0) lgkmcnt(0)
buffer_store_dword v22,off,s[8:11],s74
s_cmp_lg_u32 s86,1536
s_cbranch_scc1 L_ae_85
s_mov_b32 s77,s35
s_mov_b32 s30,0
s_lshl_b32 s56,s77,5
s_add_u32 s56,s56,s68
s_mul_i32 s70,s56,24576
s_lshl_b32 s71,s56,12
s_lshl_b32 s59,s77,13
s_lshl2_add_u32 s59,s68,s59
s_add_u32 s59,s59,10485760
s_buffer_load_dword s32,s[8:11],s59
s_mov_b32 s33,1
s_add_u32 s70,s70,100663296
s_add_u32 s71,s71,41943040
v_mov_b32 v19,s59
s_branch L_af_86
L_ae_85:
s_ff1_i32_b64 s77,s[84:85]
s_bitset0_b64 s[84:85],s77
s_min_u32 s77,s77,64
s_lshr_b32 s61,s55,5
s_lshl_b32 s56,s77,5
s_add_u32 s56,s56,s68
s_mul_i32 s70,s56,24576
s_lshl_b32 s71,s56,12
s_lshl_b32 s59,s77,13
s_lshl2_add_u32 s59,s68,s59
s_add_u32 s59,s59,10486144
s_cmp_lt_u32 s77,s61
s_cselect_b32 s57,0,16777216
s_mov_b32 s60,s59
s_buffer_load_dword s33,s[8:11],s60
s_add_u32 s71,s71,s57
s_add_u32 s71,s71,58720256
s_cmp_eq_u32 s77,s61
s_cselect_b32 s57,50331648,0
s_cselect_b32 s58,1536,0
s_add_u32 s59,s59,s58
s_buffer_load_dword s32,s[8:11],s59
s_add_u32 s70,s70,s57
s_add_u32 s70,s70,150994944
v_mov_b32 v19,s59
v_writelane_b32 v19,s60,1
L_af_86:
s_and_b32 s27,s27,s31
s_cbranch_scc1 L_ac_87
L_acb_88:
v_max3_f32 v238,v128,v129,v130
v_max3_f32 v239,v131,v132,v133
v_max3_f32 v238,v134,v135,v238
v_max3_f32 v239,v138,v139,v239
v_max_f32 v238,v238,v239
v_max_f32 v239,v238,v239
v_pk_mul_f32 v[128:129],v[128:129],v[152:153] op_sel_hi:[1,0]
v_pk_mul_f32 v[130:131],v[130:131],v[152:153] op_sel_hi:[1,0]
v_permlane16_swap_b32 v238,v239
v_max_f32 v238,v238,v239
v_max_f32 v239,v238,v239
v_pk_mul_f32 v[132:133],v[132:133],v[152:153] op_sel_hi:[1,0]
v_pk_mul_f32 v[134:135],v[134:135],v[152:153] op_sel_hi:[1,0]
v_permlane32_swap_b32 v238,v239
v_max_f32 v238,v238,v239
v_mul_f32 v238,v152,v238
v_pk_mul_f32 v[138:139],v[138:139],v[152:153] op_sel_hi:[1,0]
buffer_load_dword v17,v16,s[8:11],s87 offen sc1
v_pk_add_f32 v[128:129],v[128:129],v[238:239] op_sel_hi:[1,0] neg_lo:[0,1] neg_hi:[0,1]
v_pk_add_f32 v[130:131],v[130:131],v[238:239] op_sel_hi:[1,0] neg_lo:[0,1] neg_hi:[0,1]
v_pk_add_f32 v[132:133],v[132:133],v[238:239] op_sel_hi:[1,0] neg_lo:[0,1] neg_hi:[0,1]
v_pk_add_f32 v[134:135],v[134:135],v[238:239] op_sel_hi:[1,0] neg_lo:[0,1] neg_hi:[0,1]
v_pk_add_f32 v[138:139],v[138:139],v[238:239] op_sel_hi:[1,0] neg_lo:[0,1] neg_hi:[0,1]
v_exp_f32 v128,v128
v_exp_f32 v129,v129
v_exp_f32 v130,v130
v_exp_f32 v131,v131
v_exp_f32 v132,v132
v_exp_f32 v133,v133
v_exp_f32 v134,v134
v_exp_f32 v135,v135
v_exp_f32 v138,v138
v_exp_f32 v139,v139
v_pk_add_f32 v[148:149],v[128:129],v[130:131]
v_pk_add_f32 v[150:151],v[132:133],v[134:135]
v_pk_add_f32 v[148:149],v[148:149],v[138:139]
v_pk_add_f32 v[148:149],v[148:149],v[150:151]
v_add_f32 v150,v148,v149
v_add_f32 v151,v148,v149
s_nop 1
v_permlane16_swap_b32 v150,v151
v_add_f32 v148,v150,v151
v_add_f32 v149,v150,v151
s_nop 1
v_permlane32_swap_b32 v148,v149
v_add_f32 v148,v148,v149
v_rcp_f32 v148,v148
s_waitcnt vmcnt(0)
v_cmp_gt_u32 vcc,s66,v17
v_pk_mul_f32 v[138:139],v[138:139],v[148:149] op_sel_hi:[1,0]
v_pk_mul_f32 v[128:129],v[128:129],v[148:149] op_sel_hi:[1,0]
v_pk_mul_f32 v[130:131],v[130:131],v[148:149] op_sel_hi:[1,0]
v_pk_mul_f32 v[132:133],v[132:133],v[148:149] op_sel_hi:[1,0]
v_pk_mul_f32 v[134:135],v[134:135],v[148:149] op_sel_hi:[1,0]
s_cbranch_vccnz L_ap_90
L_apb_91:
s_xor_b32 s34,s69,524288
buffer_load_dwordx4 v[192:195],v7,s[8:11],s34 offen sc1
s_bfe_u32 s56,s66,0x10002
v_lshrrev_b32 v238,s56,v17
v_and_b32 v238,1,v238
v_cmp_ne_u32 vcc,0,v238
v_cvt_pk_bf16_f32 v144,v138,v139
v_cvt_pk_bf16_f32 v147,v138,v139
v_cvt_pk_bf16_f32 v140,v128,v129
v_cvt_pk_bf16_f32 v141,v130,v131
v_cvt_pk_bf16_f32 v142,v132,v133
v_cvt_pk_bf16_f32 v143,v134,v135
s_cbranch_vccnz L_ak_84
s_add_u32 s36,s36,4
v_mfma_f32_16x16x16_bf16 v[24:27],v[120:121],v[144:145],0
s_add_u32 s34,s34,4096
v_mfma_f32_16x16x16_bf16 v[28:31],v[120:121],v[146:147],0
buffer_load_dwordx4 v[196:199],v7,s[8:11],s34 offen sc1
v_mfma_f32_16x16x16_bf16 v[32:35],v[122:123],v[144:145],0
s_add_u32 s34,s34,4096
v_mfma_f32_16x16x16_bf16 v[36:39],v[122:123],v[146:147],0
buffer_load_dwordx4 v[200:203],v7,s[8:11],s34 offen sc1
v_mfma_f32_16x16x16_bf16 v[40:43],v[124:125],v[144:145],0
s_add_u32 s34,s34,4096
v_mfma_f32_16x16x16_bf16 v[44:47],v[124:125],v[146:147],0
buffer_load_dwordx4 v[204:207],v7,s[8:11],s34 offen sc1
v_mfma_f32_16x16x16_bf16 v[48:51],v[126:127],v[144:145],0
s_add_u32 s34,s34,4096
v_mfma_f32_16x16x16_bf16 v[52:55],v[126:127],v[146:147],0
buffer_load_dwordx4 v[208:211],v7,s[8:11],s34 offen sc1
v_mfma_f32_16x16x32_bf16 v[24:27],v[88:91],v[140:143],v[24:27]
s_add_u32 s34,s34,4096
v_mfma_f32_16x16x32_bf16 v[28:31],v[92:95],v[140:143],v[28:31]
buffer_load_dwordx4 v[212:215],v7,s[8:11],s34 offen sc1
v_mfma_f32_16x16x32_bf16 v[32:35],v[96:99],v[140:143],v[32:35]
s_add_u32 s34,s34,4096
v_mfma_f32_16x16x32_bf16 v[36:39],v[100:103],v[140:143],v[36:39]
buffer_load_dwordx4 v[216:219],v7,s[8:11],s34 offen sc1
v_cvt_pk_bf16_f32 v72,v24,v28
v_cvt_pk_bf16_f32 v73,v25,v29
v_mfma_f32_16x16x32_bf16 v[40:43],v[104:107],v[140:143],v[40:43]
s_add_u32 s34,s34,4096
v_cvt_pk_bf16_f32 v74,v26,v30
v_cvt_pk_bf16_f32 v75,v27,v31
v_mfma_f32_16x16x32_bf16 v[44:47],v[108:111],v[140:143],v[44:47]
ds_write_b128 v3,v[72:75] offset:0
v_cvt_pk_bf16_f32 v76,v32,v36
v_cvt_pk_bf16_f32 v77,v33,v37
v_mfma_f32_16x16x32_bf16 v[48:51],v[112:115],v[140:143],v[48:51]
buffer_load_dwordx4 v[220:223],v7,s[8:11],s34 offen sc1
v_cvt_pk_bf16_f32 v78,v34,v38
v_cvt_pk_bf16_f32 v79,v35,v39
v_mfma_f32_16x16x32_bf16 v[52:55],v[116:119],v[140:143],v[52:55]
ds_write_b128 v3,v[76:79] offset:1024
v_cvt_pk_bf16_f32 v80,v40,v44
v_cvt_pk_bf16_f32 v81,v41,v45
v_cvt_pk_bf16_f32 v82,v42,v46
v_cvt_pk_bf16_f32 v83,v43,v47
ds_write_b128 v3,v[80:83] offset:2048
s_nop 1
v_cvt_pk_bf16_f32 v84,v48,v52
v_cvt_pk_bf16_f32 v85,v49,v53
v_cvt_pk_bf16_f32 v86,v50,v54
v_cvt_pk_bf16_f32 v87,v51,v55
ds_write_b128 v3,v[84:87] offset:3072
s_cmp_eq_u32 s31,0
s_cbranch_scc1 L_ah_89
s_waitcnt lgkmcnt(0)
s_barrier
s_mov_b32 s26,s51
s_mov_b32 s51,s53
s_branch L_aa_78
L_ah_89:
s_waitcnt vmcnt(7)
v_mfma_f32_16x16x32_bf16 v[160:163],v[156:159],v[192:195],0
s_waitcnt vmcnt(6)
v_mfma_f32_16x16x32_bf16 v[160:163],v[156:159],v[196:199],v[160:163]
s_waitcnt vmcnt(5)
v_mfma_f32_16x16x32_bf16 v[160:163],v[156:159],v[200:203],v[160:163]
s_waitcnt vmcnt(4)
v_mfma_f32_16x16x32_bf16 v[160:163],v[156:159],v[204:207],v[160:163]
s_waitcnt vmcnt(3)
v_mfma_f32_16x16x32_bf16 v[164:167],v[156:159],v[208:211],0
s_waitcnt vmcnt(2)
v_mfma_f32_16x16x32_bf16 v[164:167],v[156:159],v[212:215],v[164:167]
s_waitcnt vmcnt(1)
v_mfma_f32_16x16x32_bf16 v[164:167],v[156:159],v[216:219],v[164:167]
ds_write_b128 v6,v[160:163]
s_waitcnt vmcnt(0)
v_mfma_f32_16x16x32_bf16 v[164:167],v[156:159],v[220:223],v[164:167]
s_nop 7
ds_write_b128 v6,v[164:167] offset:2048
s_waitcnt lgkmcnt(0)
s_barrier
buffer_store_dword v20,off,s[8:11],s73 sc1
s_mov_b32 s73,0x80000000
s_mov_b32 s27,1
s_branch L_aa_69
L_ao_82:
s_xor_b32 s67,s67,65536
s_and_b32 s56,s50,2048
s_lshl_b32 s56,s56,4
s_add_u32 s56,s56,s67
v_add_u32 v2,s56,v0
v_add_u32 v239,s56,v253
s_and_b32 s56,s50,1024
s_lshl_b32 s56,s56,2
v_add_u32 v238,s56,v2
s_mov_b32 s76,s71
s_mov_b32 s53,s77
ds_read_b128 v[24:27],v238 offset:16384
ds_read_b128 v[40:43],v2 offset:0
ds_read_b128 v[56:59],v2 offset:4096
ds_read_b128 v[28:31],v238 offset:17408
ds_read_b128 v[44:47],v2 offset:1024
ds_read_b128 v[60:63],v2 offset:5120
ds_read_b128 v[32:35],v238 offset:18432
ds_read_b128 v[48:51],v2 offset:2048
ds_read_b128 v[64:67],v2 offset:6144
ds_read_b128 v[36:39],v238 offset:19456
ds_read_b128 v[52:55],v2 offset:3072
ds_read_b128 v[68:71],v2 offset:7168
buffer_load_dwordx4 v[72:75],v0,s[8:11],s76 offen offset:0 sc1
buffer_load_dwordx4 v[76:79],v0,s[8:11],s76 offen offset:1024 sc1
buffer_load_dwordx4 v[80:83],v0,s[8:11],s76 offen offset:2048 sc1
buffer_load_dwordx4 v[84:87],v0,s[8:11],s76 offen offset:3072 sc1
buffer_load_dwordx2 v[120:121],v253,s[8:11],s76 offen offset:0 sc1
buffer_load_dwordx2 v[122:123],v253,s[8:11],s76 offen offset:1024 sc1
buffer_load_dwordx2 v[124:125],v253,s[8:11],s76 offen offset:2048 sc1
buffer_load_dwordx2 v[126:127],v253,s[8:11],s76 offen offset:3072 sc1
s_waitcnt lgkmcnt(9)
v_mfma_f32_16x16x32_bf16 v[128:131],v[40:43],v[24:27],v[8:11]
ds_read_b128 v[88:91],v2 offset:8192
v_mfma_f32_16x16x32_bf16 v[132:135],v[56:59],v[24:27],v[12:15]
ds_read_b128 v[92:95],v2 offset:9216
s_waitcnt lgkmcnt(8)
v_mfma_f32_16x16x32_bf16 v[128:131],v[44:47],v[28:31],v[128:131]
ds_read_b128 v[96:99],v2 offset:10240
v_mfma_f32_16x16x32_bf16 v[132:135],v[60:63],v[28:31],v[132:135]
ds_read_b128 v[100:103],v2 offset:11264
s_waitcnt lgkmcnt(7)
v_mfma_f32_16x16x32_bf16 v[128:131],v[48:51],v[32:35],v[128:131]
ds_read_b128 v[104:107],v2 offset:12288
v_mfma_f32_16x16x32_bf16 v[132:135],v[64:67],v[32:35],v[132:135]
ds_read_b128 v[108:111],v2 offset:13312
s_waitcnt lgkmcnt(6)
v_mfma_f32_16x16x32_bf16 v[128:131],v[52:55],v[36:39],v[128:131]
ds_read_b128 v[112:115],v2 offset:14336
v_mfma_f32_16x16x32_bf16 v[132:135],v[68:71],v[36:39],v[132:135]
ds_read_b128 v[116:119],v2 offset:15360
s_add_u32 s66,s66,4
s_bfe_u32 s56,s66,0x10002
s_bitset0_b32 s37,s56
s_lshl_b32 s56,0,s56
s_or_b32 s37,s37,s56
s_or_b32 s56,s37,s66
v_mov_b32 v22,s56
s_xor_b32 s69,s69,524288
s_waitcnt vmcnt(8) lgkmcnt(0)
buffer_store_dword v22,off,s[8:11],s74
s_mov_b32 s26,s51
s_mov_b32 s27,3
s_branch L_aa_73
L_aa_66:
s_add_u32 s66,s66,4
s_bfe_u32 s56,s66,0x10002
s_bitset0_b32 s37,s56
s_lshl_b32 s56,0,s56
s_or_b32 s37,s37,s56
s_or_b32 s56,s37,s66
v_mov_b32 v22,s56
s_xor_b32 s69,s69,524288
s_waitcnt vmcnt(0) lgkmcnt(0)
buffer_store_dword v22,off,s[8:11],s74
L_aq_92:
buffer_load_dword v17,v16,s[8:11],s87 offen sc1
s_sub_u32 s49,s49,1
s_cbranch_scc1 L_abort
s_waitcnt vmcnt(0)
v_cmp_gt_u32 vcc,s66,v17
s_cbranch_vccnz L_aq_92
s_xor_b32 s34,s69,524288
buffer_load_dwordx4 v[160:163],v7,s[8:11],s34 offen sc1
s_add_u32 s34,s34,4096
buffer_load_dwordx4 v[164:167],v7,s[8:11],s34 offen sc1
s_add_u32 s34,s34,4096
buffer_load_dwordx4 v[168:171],v7,s[8:11],s34 offen sc1
s_add_u32 s34,s34,4096
buffer_load_dwordx4 v[172:175],v7,s[8:11],s34 offen sc1
s_add_u32 s34,s34,4096
buffer_load_dwordx4 v[176:179],v7,s[8:11],s34 offen sc1
s_add_u32 s34,s34,4096
buffer_load_dwordx4 v[180:183],v7,s[8:11],s34 offen sc1
s_add_u32 s34,s34,4096
buffer_load_dwordx4 v[184:187],v7,s[8:11],s34 offen sc1
s_add_u32 s34,s34,4096
buffer_load_dwordx4 v[188:191],v7,s[8:11],s34 offen sc1
buffer_load_dwordx4 v[72:75],v0,s[8:11],s76 offen offset:0 sc1
buffer_load_dwordx4 v[76:79],v0,s[8:11],s76 offen offset:1024 sc1
buffer_load_dwordx4 v[80:83],v0,s[8:11],s76 offen offset:2048 sc1
buffer_load_dwordx4 v[84:87],v0,s[8:11],s76 offen offset:3072 sc1
buffer_load_dwordx2 v[120:121],v253,s[8:11],s76 offen offset:0 sc1
buffer_load_dwordx2 v[122:123],v253,s[8:11],s76 offen offset:1024 sc1
buffer_load_dwordx2 v[124:125],v253,s[8:11],s76 offen offset:2048 sc1
buffer_load_dwordx2 v[126:127],v253,s[8:11],s76 offen offset:3072 sc1
s_waitcnt vmcnt(15)
v_mfma_f32_16x16x32_bf16 v[192:195],v[156:159],v[160:163],0
s_waitcnt vmcnt(14)
v_mfma_f32_16x16x32_bf16 v[192:195],v[156:159],v[164:167],v[192:195]
s_waitcnt vmcnt(13)
v_mfma_f32_16x16x32_bf16 v[192:195],v[156:159],v[168:171],v[192:195]
s_waitcnt vmcnt(12)
v_mfma_f32_16x16x32_bf16 v[192:195],v[156:159],v[172:175],v[192:195]
s_waitcnt vmcnt(11)
v_mfma_f32_16x16x32_bf16 v[196:199],v[156:159],v[176:179],0
s_waitcnt vmcnt(10)
v_mfma_f32_16x16x32_bf16 v[196:199],v[156:159],v[180:183],v[196:199]
s_waitcnt vmcnt(9)
v_mfma_f32_16x16x32_bf16 v[196:199],v[156:159],v[184:187],v[196:199]
ds_write_b128 v6,v[192:195]
s_waitcnt vmcnt(8)
v_mfma_f32_16x16x32_bf16 v[196:199],v[156:159],v[188:191],v[196:199]
s_nop 7
ds_write_b128 v6,v[196:199] offset:2048
s_waitcnt lgkmcnt(0)
s_barrier
buffer_store_dword v20,off,s[8:11],s73 sc1
s_mov_b32 s73,0x80000000
s_mov_b32 s27,0
s_branch L_aa_69
L_aa_67:
s_add_u32 s56,s30,s86
s_cmp_lg_u32 s56,1537
s_cbranch_scc1 L_al_83
s_add_u32 s66,s66,4
s_bfe_u32 s56,s66,0x10002
s_bitset0_b32 s37,s56
s_lshl_b32 s56,1,s56
s_or_b32 s37,s37,s56
s_or_b32 s56,s37,s66
v_mov_b32 v22,s56
s_xor_b32 s69,s69,524288
s_waitcnt vmcnt(0) lgkmcnt(0)
buffer_store_dword v22,off,s[8:11],s74
s_cmp_lg_u32 s86,1536
s_cbranch_scc1 L_ae_93
s_mov_b32 s77,s35
s_mov_b32 s30,0
s_lshl_b32 s56,s77,5
s_add_u32 s56,s56,s68
s_mul_i32 s70,s56,24576
s_lshl_b32 s71,s56,12
s_lshl_b32 s59,s77,13
s_lshl2_add_u32 s59,s68,s59
s_add_u32 s59,s59,10485760
s_buffer_load_dword s32,s[8:11],s59
s_mov_b32 s33,1
s_add_u32 s70,s70,100663296
s_add_u32 s71,s71,41943040
v_mov_b32 v19,s59
s_branch L_af_94
L_ae_93:
s_ff1_i32_b64 s77,s[84:85]
s_bitset0_b64 s[84:85],s77
s_min_u32 s77,s77,64
s_lshr_b32 s61,s55,5
s_lshl_b32 s56,s77,5
s_add_u32 s56,s56,s68
s_mul_i32 s70,s56,24576
s_lshl_b32 s71,s56,12
s_lshl_b32 s59,s77,13
s_lshl2_add_u32 s59,s68,s59
s_add_u32 s59,s59,10486144
s_cmp_lt_u32 s77,s61
s_cselect_b32 s57,0,16777216
s_mov_b32 s60,s59
s_buffer_load_dword s33,s[8:11],s60
s_add_u32 s71,s71,s57
s_add_u32 s71,s71,58720256
s_cmp_eq_u32 s77,s61
s_cselect_b32 s57,50331648,0
s_cselect_b32 s58,1536,0
s_add_u32 s59,s59,s58
s_buffer_load_dword s32,s[8:11],s59
s_add_u32 s70,s70,s57
s_add_u32 s70,s70,150994944
v_mov_b32 v19,s59
v_writelane_b32 v19,s60,1
L_af_94:
s_branch L_ak_84
L_al_83:
s_add_u32 s66,s66,4
s_bfe_u32 s56,s66,0x10002
s_bitset0_b32 s37,s56
s_lshl_b32 s56,0,s56
s_or_b32 s37,s37,s56
s_or_b32 s56,s37,s66
v_mov_b32 v22,s56
s_xor_b32 s69,s69,524288
s_waitcnt vmcnt(0) lgkmcnt(0)
buffer_store_dword v22,off,s[8:11],s74
L_ak_84:
L_aq_95:
buffer_load_dword v17,v16,s[8:11],s87 offen sc1
s_sub_u32 s49,s49,1
s_cbranch_scc1 L_abort
s_waitcnt vmcnt(0)
v_cmp_gt_u32 vcc,s66,v17
s_cbranch_vccnz L_aq_95
s_xor_b32 s34,s69,524288
buffer_load_dwordx4 v[160:163],v7,s[8:11],s34 offen sc1
s_add_u32 s34,s34,4096
buffer_load_dwordx4 v[164:167],v7,s[8:11],s34 offen sc1
s_add_u32 s34,s34,4096
buffer_load_dwordx4 v[168:171],v7,s[8:11],s34 offen sc1
s_add_u32 s34,s34,4096
buffer_load_dwordx4 v[172:175],v7,s[8:11],s34 offen sc1
s_add_u32 s34,s34,4096
buffer_load_dwordx4 v[176:179],v7,s[8:11],s34 offen sc1
s_add_u32 s34,s34,4096
buffer_load_dwordx4 v[180:183],v7,s[8:11],s34 offen sc1
s_add_u32 s34,s34,4096
buffer_load_dwordx4 v[184:187],v7,s[8:11],s34 offen sc1
s_add_u32 s34,s34,4096
buffer_load_dwordx4 v[188:191],v7,s[8:11],s34 offen sc1
s_waitcnt vmcnt(7)
v_mfma_f32_16x16x32_bf16 v[192:195],v[156:159],v[160:163],0
s_waitcnt vmcnt(6)
v_mfma_f32_16x16x32_bf16 v[192:195],v[156:159],v[164:167],v[192:195]
s_waitcnt vmcnt(5)
v_mfma_f32_16x16x32_bf16 v[192:195],v[156:159],v[168:171],v[192:195]
s_waitcnt vmcnt(4)
v_mfma_f32_16x16x32_bf16 v[192:195],v[156:159],v[172:175],v[192:195]
s_waitcnt vmcnt(3)
v_mfma_f32_16x16x32_bf16 v[196:199],v[156:159],v[176:179],0
s_waitcnt vmcnt(2)
v_mfma_f32_16x16x32_bf16 v[196:199],v[156:159],v[180:183],v[196:199]
s_waitcnt vmcnt(1)
v_mfma_f32_16x16x32_bf16 v[196:199],v[156:159],v[184:187],v[196:199]
ds_write_b128 v6,v[192:195]
s_waitcnt vmcnt(0)
v_mfma_f32_16x16x32_bf16 v[196:199],v[156:159],v[188:191],v[196:199]
s_nop 7
ds_write_b128 v6,v[196:199] offset:2048
s_waitcnt lgkmcnt(0)
s_barrier
buffer_store_dword v20,off,s[8:11],s73 sc1
s_mov_b32 s73,0x80000000
s_mov_b32 s27,2
L_aa_69:
s_cmp_lg_u32 s31,0
s_cbranch_scc1 L_ar_98
s_bitcmp1_b32 s46,0
s_cbranch_scc1 L_ar_97
L_ar_96:
ds_read_b128 v[160:163],v23
ds_read_b128 v[164:167],v23 offset:16
v_lshlrev_b32 v200,16,v224
v_and_b32 v201,0xffff0000,v224
v_lshlrev_b32 v202,16,v225
v_and_b32 v203,0xffff0000,v225
v_lshlrev_b32 v204,16,v226
v_and_b32 v205,0xffff0000,v226
v_lshlrev_b32 v206,16,v227
v_and_b32 v207,0xffff0000,v227
s_lshl_b32 s18,s51,5
s_add_u32 s18,s18,s68
s_lshl_b32 s19,s18,10
s_add_u32 s20,s19,8388608
s_waitcnt lgkmcnt(0)
v_cvt_pk_bf16_f32 v168,v160,v161
v_cvt_pk_bf16_f32 v169,v162,v163
v_cvt_pk_bf16_f32 v170,v164,v165
v_cvt_pk_bf16_f32 v171,v166,v167
v_lshlrev_b32 v160,16,v168
v_and_b32 v161,0xffff0000,v168
v_lshlrev_b32 v162,16,v169
v_and_b32 v163,0xffff0000,v169
v_lshlrev_b32 v164,16,v170
v_and_b32 v165,0xffff0000,v170
v_lshlrev_b32 v166,16,v171
v_and_b32 v167,0xffff0000,v171
v_pk_add_f32 v[200:201],v[200:201],v[160:161]
v_pk_add_f32 v[202:203],v[202:203],v[162:163]
v_pk_add_f32 v[204:205],v[204:205],v[164:165]
v_pk_add_f32 v[206:207],v[206:207],v[166:167]
v_cvt_pk_bf16_f32 v168,v200,v201
v_cvt_pk_bf16_f32 v169,v202,v203
v_cvt_pk_bf16_f32 v170,v204,v205
v_cvt_pk_bf16_f32 v171,v206,v207
v_lshlrev_b32 v200,16,v168
v_and_b32 v201,0xffff0000,v168
v_lshlrev_b32 v202,16,v169
v_and_b32 v203,0xffff0000,v169
v_lshlrev_b32 v204,16,v170
v_and_b32 v205,0xffff0000,v170
v_lshlrev_b32 v206,16,v171
v_and_b32 v207,0xffff0000,v171
v_readfirstlane_b32 s78,v200
s_nop 1
v_pk_add_f32 v[184:185],v[200:201],s[78:79] op_sel_hi:[1,0] neg_lo:[0,1] neg_hi:[0,1]
v_pk_add_f32 v[186:187],v[202:203],s[78:79] op_sel_hi:[1,0] neg_lo:[0,1] neg_hi:[0,1]
v_pk_add_f32 v[188:189],v[204:205],s[78:79] op_sel_hi:[1,0] neg_lo:[0,1] neg_hi:[0,1]
v_pk_add_f32 v[190:191],v[206:207],s[78:79] op_sel_hi:[1,0] neg_lo:[0,1] neg_hi:[0,1]
v_pk_add_f32 v[192:193],v[184:185],v[186:187]
v_pk_mul_f32 v[194:195],v[184:185],v[184:185]
v_pk_add_f32 v[196:197],v[188:189],v[190:191]
v_pk_fma_f32 v[194:195],v[186:187],v[186:187],v[194:195]
v_pk_add_f32 v[192:193],v[192:193],v[196:197]
v_pk_fma_f32 v[194:195],v[188:189],v[188:189],v[194:195]
v_add_f32 v192,v192,v193
v_pk_fma_f32 v[194:195],v[190:191],v[190:191],v[194:195]
v_add_f32 v194,v194,v195
s_nop 1
v_permlane32_swap_b32 v192,v194
v_add_f32 v192,v192,v194
s_nop 1
v_add_f32_dpp v192,v192,v192 row_ror:8 row_mask:0xf bank_mask:0xf
s_nop 1
v_add_f32_dpp v192,v192,v192 row_ror:4 row_mask:0xf bank_mask:0xf
s_nop 1
v_add_f32_dpp v192,v192,v192 row_ror:2 row_mask:0xf bank_mask:0xf
s_nop 1
v_add_f32_dpp v192,v192,v192 row_ror:1 row_mask:0xf bank_mask:0xf
v_mov_b32 v194,v192
s_nop 1
v_permlane16_swap_b32 v192,v194
v_add_f32 v192,v192,v194
v_mul_f32 v192,0x3b000000,v192
v_mov_b32 v194,v192
s_nop 1
v_permlane32_swap_b32 v192,v194
v_fma_f32 v194,-v192,v192,v194
v_add_f32 v192,s78,v192
v_max_f32 v194,0,v194
v_cvt_pk_bf16_f32 v194,v192,v194
v_lshlrev_b32 v192,16,v194
v_and_b32 v194,0xffff0000,v194
v_add_f32 v194,0x3727c5ac,v194
v_cvt_pk_bf16_f32 v194,v194,v194
v_and_b32 v194,0xffff0000,v194
v_sqrt_f32 v194,v194
v_pk_add_f32 v[184:185],v[200:201],v[192:193] op_sel_hi:[1,0] neg_lo:[0,1] neg_hi:[0,1]
v_pk_add_f32 v[186:187],v[202:203],v[192:193] op_sel_hi:[1,0] neg_lo:[0,1] neg_hi:[0,1]
v_pk_add_f32 v[188:189],v[204:205],v[192:193] op_sel_hi:[1,0] neg_lo:[0,1] neg_hi:[0,1]
v_pk_add_f32 v[190:191],v[206:207],v[192:193] op_sel_hi:[1,0] neg_lo:[0,1] neg_hi:[0,1]
v_cvt_pk_bf16_f32 v194,v194,v194
v_and_b32 v194,0xffff0000,v194
v_rcp_f32 v194,v194
v_cvt_pk_bf16_f32 v172,v184,v185
v_cvt_pk_bf16_f32 v173,v186,v187
v_cvt_pk_bf16_f32 v174,v188,v189
v_cvt_pk_bf16_f32 v175,v190,v191
v_lshlrev_b32 v184,16,v172
v_and_b32 v185,0xffff0000,v172
v_lshlrev_b32 v186,16,v173
v_and_b32 v187,0xffff0000,v173
v_lshlrev_b32 v188,16,v174
v_and_b32 v189,0xffff0000,v174
v_lshlrev_b32 v190,16,v175
v_and_b32 v191,0xffff0000,v175
v_pk_mul_f32 v[184:185],v[184:185],v[194:195] op_sel_hi:[1,0]
v_pk_mul_f32 v[186:187],v[186:187],v[194:195] op_sel_hi:[1,0]
v_pk_mul_f32 v[188:189],v[188:189],v[194:195] op_sel_hi:[1,0]
v_pk_mul_f32 v[190:191],v[190:191],v[194:195] op_sel_hi:[1,0]
v_cvt_pk_bf16_f32 v172,v184,v185
v_cvt_pk_bf16_f32 v173,v186,v187
v_cvt_pk_bf16_f32 v174,v188,v189
v_cvt_pk_bf16_f32 v175,v190,v191
v_lshlrev_b32 v176,16,v172
v_and_b32 v177,0xffff0000,v172
v_lshlrev_b32 v178,16,v173
v_and_b32 v179,0xffff0000,v173
v_lshlrev_b32 v180,16,v174
v_and_b32 v181,0xffff0000,v174
v_lshlrev_b32 v182,16,v175
v_and_b32 v183,0xffff0000,v175
v_pk_add_f32 v[200:201],v[200:201],v[176:177]
v_pk_add_f32 v[202:203],v[202:203],v[178:179]
v_pk_add_f32 v[204:205],v[204:205],v[180:181]
v_pk_add_f32 v[206:207],v[206:207],v[182:183]
v_cvt_pk_bf16_f32 v160,v200,v201
v_cvt_pk_bf16_f32 v161,v202,v203
v_cvt_pk_bf16_f32 v162,v204,v205
v_cvt_pk_bf16_f32 v163,v206,v207
buffer_store_dwordx4 v[160:163],v0,s[8:11],s20 offen sc1
v_lshlrev_b32 v200,16,v160
v_and_b32 v201,0xffff0000,v160
v_lshlrev_b32 v202,16,v161
v_and_b32 v203,0xffff0000,v161
v_lshlrev_b32 v204,16,v162
v_and_b32 v205,0xffff0000,v162
v_lshlrev_b32 v206,16,v163
v_and_b32 v207,0xffff0000,v163
v_readfirstlane_b32 s78,v200
s_nop 1
v_pk_add_f32 v[184:185],v[200:201],s[78:79] op_sel_hi:[1,0] neg_lo:[0,1] neg_hi:[0,1]
v_pk_add_f32 v[186:187],v[202:203],s[78:79] op_sel_hi:[1,0] neg_lo:[0,1] neg_hi:[0,1]
v_pk_add_f32 v[188:189],v[204:205],s[78:79] op_sel_hi:[1,0] neg_lo:[0,1] neg_hi:[0,1]
v_pk_add_f32 v[190:191],v[206:207],s[78:79] op_sel_hi:[1,0] neg_lo:[0,1] neg_hi:[0,1]
v_pk_add_f32 v[192:193],v[184:185],v[186:187]
v_pk_mul_f32 v[194:195],v[184:185],v[184:185]
v_pk_add_f32 v[196:197],v[188:189],v[190:191]
v_pk_fma_f32 v[194:195],v[186:187],v[186:187],v[194:195]
v_pk_add_f32 v[192:193],v[192:193],v[196:197]
v_pk_fma_f32 v[194:195],v[188:189],v[188:189],v[194:195]
v_add_f32 v192,v192,v193
v_pk_fma_f32 v[194:195],v[190:191],v[190:191],v[194:195]
v_add_f32 v194,v194,v195
s_nop 1
v_permlane32_swap_b32 v192,v194
v_add_f32 v192,v192,v194
s_nop 1
v_add_f32_dpp v192,v192,v192 row_ror:8 row_mask:0xf bank_mask:0xf
s_nop 1
v_add_f32_dpp v192,v192,v192 row_ror:4 row_mask:0xf bank_mask:0xf
s_nop 1
v_add_f32_dpp v192,v192,v192 row_ror:2 row_mask:0xf bank_mask:0xf
s_nop 1
v_add_f32_dpp v192,v192,v192 row_ror:1 row_mask:0xf bank_mask:0xf
v_mov_b32 v194,v192
s_nop 1
v_permlane16_swap_b32 v192,v194
v_add_f32 v192,v192,v194
v_mul_f32 v192,0x3b000000,v192
v_mov_b32 v194,v192
s_nop 1
v_permlane32_swap_b32 v192,v194
v_fma_f32 v194,-v192,v192,v194
v_add_f32 v192,s78,v192
v_max_f32 v194,0,v194
v_cvt_pk_bf16_f32 v194,v192,v194
v_lshlrev_b32 v192,16,v194
v_and_b32 v194,0xffff0000,v194
v_add_f32 v194,0x3727c5ac,v194
v_cvt_pk_bf16_f32 v194,v194,v194
v_and_b32 v194,0xffff0000,v194
v_sqrt_f32 v194,v194
v_pk_add_f32 v[184:185],v[200:201],v[192:193] op_sel_hi:[1,0] neg_lo:[0,1] neg_hi:[0,1]
v_pk_add_f32 v[186:187],v[202:203],v[192:193] op_sel_hi:[1,0] neg_lo:[0,1] neg_hi:[0,1]
v_pk_add_f32 v[188:189],v[204:205],v[192:193] op_sel_hi:[1,0] neg_lo:[0,1] neg_hi:[0,1]
v_pk_add_f32 v[190:191],v[206:207],v[192:193] op_sel_hi:[1,0] neg_lo:[0,1] neg_hi:[0,1]
v_cvt_pk_bf16_f32 v194,v194,v194
v_and_b32 v194,0xffff0000,v194
v_rcp_f32 v194,v194
v_cvt_pk_bf16_f32 v164,v184,v185
v_cvt_pk_bf16_f32 v165,v186,v187
v_cvt_pk_bf16_f32 v166,v188,v189
v_cvt_pk_bf16_f32 v167,v190,v191
v_lshlrev_b32 v184,16,v164
v_and_b32 v185,0xffff0000,v164
v_lshlrev_b32 v186,16,v165
v_and_b32 v187,0xffff0000,v165
v_lshlrev_b32 v188,16,v166
v_and_b32 v189,0xffff0000,v166
v_lshlrev_b32 v190,16,v167
v_and_b32 v191,0xffff0000,v167
v_pk_mul_f32 v[184:185],v[184:185],v[194:195] op_sel_hi:[1,0]
v_pk_mul_f32 v[186:187],v[186:187],v[194:195] op_sel_hi:[1,0]
v_pk_mul_f32 v[188:189],v[188:189],v[194:195] op_sel_hi:[1,0]
v_pk_mul_f32 v[190:191],v[190:191],v[194:195] op_sel_hi:[1,0]
v_cvt_pk_bf16_f32 v164,v184,v185
v_cvt_pk_bf16_f32 v165,v186,v187
v_cvt_pk_bf16_f32 v166,v188,v189
v_cvt_pk_bf16_f32 v167,v190,v191
s_add_u32 s20,s19,2097152
buffer_store_dwordx4 v[164:167],v0,s[8:11],s20 offen sc1
v_mov_b32 v20,1
s_lshl_b32 s73,s51,13
s_lshl2_add_u32 s73,s68,s73
s_add_u32 s73,s73,10487552
s_branch L_aa_70
L_ar_97:
ds_read_b128 v[160:163],v23
ds_read_b128 v[164:167],v23 offset:16
v_lshlrev_b32 v200,16,v224
v_and_b32 v201,0xffff0000,v224
v_lshlrev_b32 v202,16,v225
v_and_b32 v203,0xffff0000,v225
v_lshlrev_b32 v204,16,v226
v_and_b32 v205,0xffff0000,v226
v_lshlrev_b32 v206,16,v227
v_and_b32 v207,0xffff0000,v227
s_lshl_b32 s18,s51,5
s_add_u32 s18,s18,s68
s_lshl_b32 s19,s18,10
s_add_u32 s20,s19,4194304
s_waitcnt lgkmcnt(0)
v_cvt_pk_bf16_f32 v168,v160,v161
v_cvt_pk_bf16_f32 v169,v162,v163
v_cvt_pk_bf16_f32 v170,v164,v165
v_cvt_pk_bf16_f32 v171,v166,v167
v_lshlrev_b32 v160,16,v168
v_and_b32 v161,0xffff0000,v168
v_lshlrev_b32 v162,16,v169
v_and_b32 v163,0xffff0000,v169
v_lshlrev_b32 v164,16,v170
v_and_b32 v165,0xffff0000,v170
v_lshlrev_b32 v166,16,v171
v_and_b32 v167,0xffff0000,v171
v_pk_add_f32 v[200:201],v[200:201],v[160:161]
v_pk_add_f32 v[202:203],v[202:203],v[162:163]
v_pk_add_f32 v[204:205],v[204:205],v[164:165]
v_pk_add_f32 v[206:207],v[206:207],v[166:167]
v_cvt_pk_bf16_f32 v168,v200,v201
v_cvt_pk_bf16_f32 v169,v202,v203
v_cvt_pk_bf16_f32 v170,v204,v205
v_cvt_pk_bf16_f32 v171,v206,v207
buffer_store_dwordx4 v[168:171],v0,s[8:11],s20 offen sc1
v_lshlrev_b32 v200,16,v168
v_and_b32 v201,0xffff0000,v168
v_lshlrev_b32 v202,16,v169
v_and_b32 v203,0xffff0000,v169
v_lshlrev_b32 v204,16,v170
v_and_b32 v205,0xffff0000,v170
v_lshlrev_b32 v206,16,v171
v_and_b32 v207,0xffff0000,v171
v_readfirstlane_b32 s78,v200
s_nop 1
v_pk_add_f32 v[184:185],v[200:201],s[78:79] op_sel_hi:[1,0] neg_lo:[0,1] neg_hi:[0,1]
v_pk_add_f32 v[186:187],v[202:203],s[78:79] op_sel_hi:[1,0] neg_lo:[0,1] neg_hi:[0,1]
v_pk_add_f32 v[188:189],v[204:205],s[78:79] op_sel_hi:[1,0] neg_lo:[0,1] neg_hi:[0,1]
v_pk_add_f32 v[190:191],v[206:207],s[78:79] op_sel_hi:[1,0] neg_lo:[0,1] neg_hi:[0,1]
v_pk_add_f32 v[192:193],v[184:185],v[186:187]
v_pk_mul_f32 v[194:195],v[184:185],v[184:185]
v_pk_add_f32 v[196:197],v[188:189],v[190:191]
v_pk_fma_f32 v[194:195],v[186:187],v[186:187],v[194:195]
v_pk_add_f32 v[192:193],v[192:193],v[196:197]
v_pk_fma_f32 v[194:195],v[188:189],v[188:189],v[194:195]
v_add_f32 v192,v192,v193
v_pk_fma_f32 v[194:195],v[190:191],v[190:191],v[194:195]
v_add_f32 v194,v194,v195
s_nop 1
v_permlane32_swap_b32 v192,v194
v_add_f32 v192,v192,v194
s_nop 1
v_add_f32_dpp v192,v192,v192 row_ror:8 row_mask:0xf bank_mask:0xf
s_nop 1
v_add_f32_dpp v192,v192,v192 row_ror:4 row_mask:0xf bank_mask:0xf
s_nop 1
v_add_f32_dpp v192,v192,v192 row_ror:2 row_mask:0xf bank_mask:0xf
s_nop 1
v_add_f32_dpp v192,v192,v192 row_ror:1 row_mask:0xf bank_mask:0xf
v_mov_b32 v194,v192
s_nop 1
v_permlane16_swap_b32 v192,v194
v_add_f32 v192,v192,v194
v_mul_f32 v192,0x3b000000,v192
v_mov_b32 v194,v192
s_nop 1
v_permlane32_swap_b32 v192,v194
v_fma_f32 v194,-v192,v192,v194
v_add_f32 v192,s78,v192
v_max_f32 v194,0,v194
v_cvt_pk_bf16_f32 v194,v192,v194
v_lshlrev_b32 v192,16,v194
v_and_b32 v194,0xffff0000,v194
v_add_f32 v194,0x3727c5ac,v194
v_cvt_pk_bf16_f32 v194,v194,v194
v_and_b32 v194,0xffff0000,v194
v_sqrt_f32 v194,v194
v_pk_add_f32 v[184:185],v[200:201],v[192:193] op_sel_hi:[1,0] neg_lo:[0,1] neg_hi:[0,1]
v_pk_add_f32 v[186:187],v[202:203],v[192:193] op_sel_hi:[1,0] neg_lo:[0,1] neg_hi:[0,1]
v_pk_add_f32 v[188:189],v[204:205],v[192:193] op_sel_hi:[1,0] neg_lo:[0,1] neg_hi:[0,1]
v_pk_add_f32 v[190:191],v[206:207],v[192:193] op_sel_hi:[1,0] neg_lo:[0,1] neg_hi:[0,1]
v_cvt_pk_bf16_f32 v194,v194,v194
v_and_b32 v194,0xffff0000,v194
v_rcp_f32 v194,v194
v_cvt_pk_bf16_f32 v172,v184,v185
v_cvt_pk_bf16_f32 v173,v186,v187
v_cvt_pk_bf16_f32 v174,v188,v189
v_cvt_pk_bf16_f32 v175,v190,v191
v_lshlrev_b32 v184,16,v172
v_and_b32 v185,0xffff0000,v172
v_lshlrev_b32 v186,16,v173
v_and_b32 v187,0xffff0000,v173
v_lshlrev_b32 v188,16,v174
v_and_b32 v189,0xffff0000,v174
v_lshlrev_b32 v190,16,v175
v_and_b32 v191,0xffff0000,v175
v_pk_mul_f32 v[184:185],v[184:185],v[194:195] op_sel_hi:[1,0]
v_pk_mul_f32 v[186:187],v[186:187],v[194:195] op_sel_hi:[1,0]
v_pk_mul_f32 v[188:189],v[188:189],v[194:195] op_sel_hi:[1,0]
v_pk_mul_f32 v[190:191],v[190:191],v[194:195] op_sel_hi:[1,0]
v_cvt_pk_bf16_f32 v172,v184,v185
v_cvt_pk_bf16_f32 v173,v186,v187
v_cvt_pk_bf16_f32 v174,v188,v189
v_cvt_pk_bf16_f32 v175,v190,v191
v_lshlrev_b32 v176,16,v172
v_and_b32 v177,0xffff0000,v172
v_lshlrev_b32 v178,16,v173
v_and_b32 v179,0xffff0000,v173
v_lshlrev_b32 v180,16,v174
v_and_b32 v181,0xffff0000,v174
v_lshlrev_b32 v182,16,v175
v_and_b32 v183,0xffff0000,v175
v_pk_mul_f32 v[236:237],v[176:177],v[228:229]
v_pk_fma_f32 v[236:237],v[178:179],v[230:231],v[236:237]
v_pk_fma_f32 v[236:237],v[180:181],v[232:233],v[236:237]
v_pk_fma_f32 v[236:237],v[182:183],v[234:235],v[236:237]
v_add_f32 v236,v236,v237
s_nop 1
v_add_f32_dpp v236,v236,v236 row_ror:8 row_mask:0xf bank_mask:0xf
s_nop 1
v_add_f32_dpp v236,v236,v236 row_ror:4 row_mask:0xf bank_mask:0xf
s_nop 1
v_add_f32_dpp v236,v236,v236 row_ror:2 row_mask:0xf bank_mask:0xf
s_nop 1
v_add_f32_dpp v236,v236,v236 row_ror:1 row_mask:0xf bank_mask:0xf
v_mov_b32 v237,v236
s_nop 1
v_permlane16_swap_b32 v236,v237
v_add_f32 v236,v236,v237
v_mov_b32 v237,v236
s_nop 1
v_permlane32_swap_b32 v236,v237
v_add_f32 v236,v236,v237
v_cvt_pk_bf16_f32 v236,v236,v236
v_and_b32 v236,0xffff0000,v236
v_ashrrev_i32 v237,31,v236
v_or_b32 v237,0x80000000,v237
v_xor_b32 v236,v236,v237
v_and_b32 v236,0xffff0000,v236
s_sub_u32 s20,4095,s18
v_or_b32 v20,s20,v236
s_lshl_b32 s20,s51,13
s_lshl2_add_u32 s20,s68,s20
s_add_u32 s20,s20,10485760
buffer_store_dword v20,v254,s[8:11],s20 offen sc1
s_branch L_aa_70
L_ar_98:
s_bitcmp1_b32 s46,0
s_cbranch_scc1 L_aa_70
ds_read_b128 v[160:163],v23
ds_read_b128 v[164:167],v23 offset:16
v_lshlrev_b32 v200,16,v224
v_and_b32 v201,0xffff0000,v224
v_lshlrev_b32 v202,16,v225
v_and_b32 v203,0xffff0000,v225
v_lshlrev_b32 v204,16,v226
v_and_b32 v205,0xffff0000,v226
v_lshlrev_b32 v206,16,v227
v_and_b32 v207,0xffff0000,v227
v_readfirstlane_b32 s22,v246
s_cmp_eq_u32 s22,0
s_cbranch_scc1 L_ag_99
L_agb_100:
s_lshl_b32 s18,s51,5
s_add_u32 s18,s18,s68
s_lshl_b32 s19,s18,10
s_add_u32 s20,s19,6291456
s_waitcnt lgkmcnt(0)
v_cvt_pk_bf16_f32 v168,v160,v161
v_cvt_pk_bf16_f32 v169,v162,v163
v_cvt_pk_bf16_f32 v170,v164,v165
v_cvt_pk_bf16_f32 v171,v166,v167
v_lshlrev_b32 v160,16,v168
v_and_b32 v161,0xffff0000,v168
v_lshlrev_b32 v162,16,v169
v_and_b32 v163,0xffff0000,v169
v_lshlrev_b32 v164,16,v170
v_and_b32 v165,0xffff0000,v170
v_lshlrev_b32 v166,16,v171
v_and_b32 v167,0xffff0000,v171
v_pk_add_f32 v[200:201],v[200:201],v[160:161]
v_pk_add_f32 v[202:203],v[202:203],v[162:163]
v_pk_add_f32 v[204:205],v[204:205],v[164:165]
v_pk_add_f32 v[206:207],v[206:207],v[166:167]
v_cvt_pk_bf16_f32 v168,v200,v201
v_cvt_pk_bf16_f32 v169,v202,v203
v_cvt_pk_bf16_f32 v170,v204,v205
v_cvt_pk_bf16_f32 v171,v206,v207
buffer_store_dwordx4 v[168:171],v0,s[8:11],s20 offen sc1
v_lshlrev_b32 v200,16,v168
v_and_b32 v201,0xffff0000,v168
v_lshlrev_b32 v202,16,v169
v_and_b32 v203,0xffff0000,v169
v_lshlrev_b32 v204,16,v170
v_and_b32 v205,0xffff0000,v170
v_lshlrev_b32 v206,16,v171
v_and_b32 v207,0xffff0000,v171
v_readfirstlane_b32 s78,v200
s_nop 1
v_pk_add_f32 v[184:185],v[200:201],s[78:79] op_sel_hi:[1,0] neg_lo:[0,1] neg_hi:[0,1]
v_pk_add_f32 v[186:187],v[202:203],s[78:79] op_sel_hi:[1,0] neg_lo:[0,1] neg_hi:[0,1]
v_pk_add_f32 v[188:189],v[204:205],s[78:79] op_sel_hi:[1,0] neg_lo:[0,1] neg_hi:[0,1]
v_pk_add_f32 v[190:191],v[206:207],s[78:79] op_sel_hi:[1,0] neg_lo:[0,1] neg_hi:[0,1]
v_pk_add_f32 v[192:193],v[184:185],v[186:187]
v_pk_mul_f32 v[194:195],v[184:185],v[184:185]
v_pk_add_f32 v[196:197],v[188:189],v[190:191]
v_pk_fma_f32 v[194:195],v[186:187],v[186:187],v[194:195]
v_pk_add_f32 v[192:193],v[192:193],v[196:197]
v_pk_fma_f32 v[194:195],v[188:189],v[188:189],v[194:195]
v_add_f32 v192,v192,v193
v_pk_fma_f32 v[194:195],v[190:191],v[190:191],v[194:195]
v_add_f32 v194,v194,v195
s_nop 1
v_permlane32_swap_b32 v192,v194
v_add_f32 v192,v192,v194
s_nop 1
v_add_f32_dpp v192,v192,v192 row_ror:8 row_mask:0xf bank_mask:0xf
s_nop 1
v_add_f32_dpp v192,v192,v192 row_ror:4 row_mask:0xf bank_mask:0xf
s_nop 1
v_add_f32_dpp v192,v192,v192 row_ror:2 row_mask:0xf bank_mask:0xf
s_nop 1
v_add_f32_dpp v192,v192,v192 row_ror:1 row_mask:0xf bank_mask:0xf
v_mov_b32 v194,v192
s_nop 1
v_permlane16_swap_b32 v192,v194
v_add_f32 v192,v192,v194
v_mul_f32 v192,0x3b000000,v192
v_mov_b32 v194,v192
s_nop 1
v_permlane32_swap_b32 v192,v194
v_fma_f32 v194,-v192,v192,v194
v_add_f32 v192,s78,v192
v_max_f32 v194,0,v194
v_cvt_pk_bf16_f32 v194,v192,v194
v_lshlrev_b32 v192,16,v194
v_and_b32 v194,0xffff0000,v194
v_add_f32 v194,0x3727c5ac,v194
v_cvt_pk_bf16_f32 v194,v194,v194
v_and_b32 v194,0xffff0000,v194
v_sqrt_f32 v194,v194
v_pk_add_f32 v[184:185],v[200:201],v[192:193] op_sel_hi:[1,0] neg_lo:[0,1] neg_hi:[0,1]
v_pk_add_f32 v[186:187],v[202:203],v[192:193] op_sel_hi:[1,0] neg_lo:[0,1] neg_hi:[0,1]
v_pk_add_f32 v[188:189],v[204:205],v[192:193] op_sel_hi:[1,0] neg_lo:[0,1] neg_hi:[0,1]
v_pk_add_f32 v[190:191],v[206:207],v[192:193] op_sel_hi:[1,0] neg_lo:[0,1] neg_hi:[0,1]
v_cvt_pk_bf16_f32 v194,v194,v194
v_and_b32 v194,0xffff0000,v194
v_rcp_f32 v194,v194
v_cvt_pk_bf16_f32 v172,v184,v185
v_cvt_pk_bf16_f32 v173,v186,v187
v_cvt_pk_bf16_f32 v174,v188,v189
v_cvt_pk_bf16_f32 v175,v190,v191
v_lshlrev_b32 v184,16,v172
v_and_b32 v185,0xffff0000,v172
v_lshlrev_b32 v186,16,v173
v_and_b32 v187,0xffff0000,v173
v_lshlrev_b32 v188,16,v174
v_and_b32 v189,0xffff0000,v174
v_lshlrev_b32 v190,16,v175
v_and_b32 v191,0xffff0000,v175
v_pk_mul_f32 v[184:185],v[184:185],v[194:195] op_sel_hi:[1,0]
v_pk_mul_f32 v[186:187],v[186:187],v[194:195] op_sel_hi:[1,0]
v_pk_mul_f32 v[188:189],v[188:189],v[194:195] op_sel_hi:[1,0]
v_pk_mul_f32 v[190:191],v[190:191],v[194:195] op_sel_hi:[1,0]
v_cvt_pk_bf16_f32 v172,v184,v185
v_cvt_pk_bf16_f32 v173,v186,v187
v_cvt_pk_bf16_f32 v174,v188,v189
v_cvt_pk_bf16_f32 v175,v190,v191
v_lshlrev_b32 v176,16,v172
v_and_b32 v177,0xffff0000,v172
v_lshlrev_b32 v178,16,v173
v_and_b32 v179,0xffff0000,v173
v_lshlrev_b32 v180,16,v174
v_and_b32 v181,0xffff0000,v174
v_lshlrev_b32 v182,16,v175
v_and_b32 v183,0xffff0000,v175
v_pk_add_f32 v[200:201],v[200:201],v[176:177]
v_pk_add_f32 v[202:203],v[202:203],v[178:179]
v_pk_add_f32 v[204:205],v[204:205],v[180:181]
v_pk_add_f32 v[206:207],v[206:207],v[182:183]
v_cvt_pk_bf16_f32 v160,v200,v201
v_cvt_pk_bf16_f32 v161,v202,v203
v_cvt_pk_bf16_f32 v162,v204,v205
v_cvt_pk_bf16_f32 v163,v206,v207
buffer_store_dwordx4 v[160:163],v0,s[12:15],s19 offen sc1
v_pk_mul_f32 v[236:237],v[176:177],v[228:229]
v_pk_fma_f32 v[236:237],v[178:179],v[230:231],v[236:237]
v_pk_fma_f32 v[236:237],v[180:181],v[232:233],v[236:237]
v_pk_fma_f32 v[236:237],v[182:183],v[234:235],v[236:237]
v_add_f32 v236,v236,v237
s_nop 1
v_add_f32_dpp v236,v236,v236 row_ror:8 row_mask:0xf bank_mask:0xf
s_nop 1
v_add_f32_dpp v236,v236,v236 row_ror:4 row_mask:0xf bank_mask:0xf
s_nop 1
v_add_f32_dpp v236,v236,v236 row_ror:2 row_mask:0xf bank_mask:0xf
s_nop 1
v_add_f32_dpp v236,v236,v236 row_ror:1 row_mask:0xf bank_mask:0xf
v_mov_b32 v237,v236
s_nop 1
v_permlane16_swap_b32 v236,v237
v_add_f32 v236,v236,v237
v_mov_b32 v237,v236
s_nop 1
v_permlane32_swap_b32 v236,v237
v_add_f32 v236,v236,v237
v_cvt_pk_bf16_f32 v236,v236,v236
v_and_b32 v236,0xffff0000,v236
v_ashrrev_i32 v237,31,v236
v_or_b32 v237,0x80000000,v237
v_xor_b32 v236,v236,v237
v_and_b32 v236,0xffff0000,v236
s_sub_u32 s20,4095,s18
v_or_b32 v20,s20,v236
s_lshl_b32 s73,s51,13
s_lshl2_add_u32 s73,s68,s73
s_add_u32 s73,s73,10485760
s_add_u32 s73,s73,s86
L_aa_70:
s_cmp_eq_u32 s27,1
s_cbranch_scc1 L_ad_101
s_cmp_eq_u32 s27,0
s_cbranch_scc1 L_aa_71
s_cmp_ge_u32 s77,64
s_cbranch_scc1 L_aa_74
L_aa_72:
s_waitcnt vmcnt(0)
buffer_store_dword v20,off,s[8:11],s73 sc1
s_mov_b32 s73,0x80000000
v_mov_b32 v18,0
s_mov_b32 s27,0
L_aw_102:
v_cmp_eq_u32 vcc,0,v18
s_cbranch_vccz L_awd_103
buffer_load_dword v18,v19,s[8:11],0 offen sc1
s_sub_u32 s49,s49,1
s_cbranch_scc1 L_abort
s_waitcnt vmcnt(0)
s_branch L_aw_102
L_awd_103:
s_mov_b32 s64,s70
s_mov_b32 s65,s71
s_and_b32 s57,s46,1
s_mul_i32 s58,s57,12288
s_add_u32 s64,s64,s58
s_lshl_b32 s57,s57,11
s_add_u32 s65,s65,s57
s_and_b32 s59,s50,2048
s_lshl_b32 s59,s59,4
s_xor_b32 s60,s67,65536
s_add_u32 s59,s59,s60
s_add_u32 s58,s58,s59
s_add_u32 s57,s57,s59
s_add_u32 m0,s58,0
s_nop 0
buffer_load_dwordx4 v0,s[8:11],s64 offen offset:0 sc1 lds
buffer_load_dwordx4 v0,s[8:11],s64 offen offset:1024 sc1 lds
buffer_load_dwordx4 v0,s[8:11],s64 offen offset:2048 sc1 lds
buffer_load_dwordx4 v0,s[8:11],s64 offen offset:3072 sc1 lds
s_add_u32 m0,s58,4096
s_add_u32 s64,s64,4096
buffer_load_dwordx4 v0,s[8:11],s64 offen offset:0 sc1 lds
buffer_load_dwordx4 v0,s[8:11],s64 offen offset:1024 sc1 lds
buffer_load_dwordx4 v0,s[8:11],s64 offen offset:2048 sc1 lds
buffer_load_dwordx4 v0,s[8:11],s64 offen offset:3072 sc1 lds
s_add_u32 m0,s58,8192
s_add_u32 s64,s64,4096
buffer_load_dwordx4 v0,s[8:11],s64 offen offset:0 sc1 lds
buffer_load_dwordx4 v0,s[8:11],s64 offen offset:1024 sc1 lds
buffer_load_dwordx4 v0,s[8:11],s64 offen offset:2048 sc1 lds
buffer_load_dwordx4 v0,s[8:11],s64 offen offset:3072 sc1 lds
s_add_u32 m0,s57,24576
s_nop 0
buffer_load_dwordx4 v0,s[8:11],s65 offen offset:0 sc1 lds
buffer_load_dwordx4 v0,s[8:11],s65 offen offset:1024 sc1 lds
v_lshrrev_b32 v244,4,v1
s_sub_u32 s56,s77,8
v_add_u32 v244,s56,v244
v_max_i32 v244,0,v244
v_lshl_add_u32 v244,v244,13,v21
buffer_load_dwordx2 v[242:243],v244,s[8:11],0 offen sc1
s_waitcnt vmcnt(0) lgkmcnt(0)
s_barrier
s_xor_b32 s67,s67,65536
s_and_b32 s56,s50,2048
s_lshl_b32 s56,s56,4
s_add_u32 s56,s56,s67
v_add_u32 v2,s56,v0
v_add_u32 v239,s56,v253
s_and_b32 s56,s50,1024
s_lshl_b32 s56,s56,2
v_add_u32 v238,s56,v2
s_mov_b32 s76,s71
s_mov_b32 s53,s77
ds_read_b128 v[24:27],v238 offset:16384
ds_read_b128 v[40:43],v2 offset:0
ds_read_b128 v[56:59],v2 offset:4096
ds_read_b128 v[28:31],v238 offset:17408
ds_read_b128 v[44:47],v2 offset:1024
ds_read_b128 v[60:63],v2 offset:5120
ds_read_b128 v[32:35],v238 offset:18432
ds_read_b128 v[48:51],v2 offset:2048
ds_read_b128 v[64:67],v2 offset:6144
ds_read_b128 v[36:39],v238 offset:19456
ds_read_b128 v[52:55],v2 offset:3072
ds_read_b128 v[68:71],v2 offset:7168
s_waitcnt lgkmcnt(9)
v_mfma_f32_16x16x32_bf16 v[128:131],v[40:43],v[24:27],v[8:11]
ds_read_b128 v[72:75],v2 offset:24576
v_mfma_f32_16x16x32_bf16 v[132:135],v[56:59],v[24:27],v[12:15]
ds_read_b128 v[76:79],v2 offset:25600
s_waitcnt lgkmcnt(8)
v_mfma_f32_16x16x32_bf16 v[128:131],v[44:47],v[28:31],v[128:131]
ds_read_b128 v[80:83],v2 offset:26624
v_mfma_f32_16x16x32_bf16 v[132:135],v[60:63],v[28:31],v[132:135]
ds_read_b128 v[84:87],v2 offset:27648
s_waitcnt lgkmcnt(7)
v_mfma_f32_16x16x32_bf16 v[128:131],v[48:51],v[32:35],v[128:131]
ds_read_b64 v[120:121],v239 offset:24576
v_mfma_f32_16x16x32_bf16 v[132:135],v[64:67],v[32:35],v[132:135]
ds_read_b64 v[122:123],v239 offset:25600
s_waitcnt lgkmcnt(6)
v_mfma_f32_16x16x32_bf16 v[128:131],v[52:55],v[36:39],v[128:131]
ds_read_b64 v[124:125],v239 offset:26624
v_mfma_f32_16x16x32_bf16 v[132:135],v[68:71],v[36:39],v[132:135]
ds_read_b64 v[126:127],v239 offset:27648
s_waitcnt lgkmcnt(4)
v_mfma_f32_16x16x32_bf16 v[136:139],v[72:75],v[24:27],0
ds_read_b128 v[88:91],v2 offset:8192
ds_read_b128 v[92:95],v2 offset:9216
v_mfma_f32_16x16x32_bf16 v[136:139],v[76:79],v[28:31],v[136:139]
ds_read_b128 v[96:99],v2 offset:10240
ds_read_b128 v[100:103],v2 offset:11264
v_mfma_f32_16x16x32_bf16 v[136:139],v[80:83],v[32:35],v[136:139]
ds_read_b128 v[104:107],v2 offset:12288
ds_read_b128 v[108:111],v2 offset:13312
v_mfma_f32_16x16x32_bf16 v[136:139],v[84:87],v[36:39],v[136:139]
ds_read_b128 v[112:115],v2 offset:14336
ds_read_b128 v[116:119],v2 offset:15360
s_waitcnt lgkmcnt(0)
s_cmp_eq_u32 s30,0
s_cbranch_scc1 L_aa_73
s_cmp_lg_u32 s86,1536
s_cbranch_scc1 L_ae_104
s_mov_b32 s77,s35
s_mov_b32 s30,0
s_lshl_b32 s56,s77,5
s_add_u32 s56,s56,s68
s_mul_i32 s70,s56,24576
s_lshl_b32 s71,s56,12
s_lshl_b32 s59,s77,13
s_lshl2_add_u32 s59,s68,s59
s_add_u32 s59,s59,10485760
s_buffer_load_dword s32,s[8:11],s59
s_mov_b32 s33,1
s_add_u32 s70,s70,100663296
s_add_u32 s71,s71,41943040
v_mov_b32 v19,s59
s_branch L_af_105
L_ae_104:
s_ff1_i32_b64 s77,s[84:85]
s_bitset0_b64 s[84:85],s77
s_min_u32 s77,s77,64
s_lshr_b32 s61,s55,5
s_lshl_b32 s56,s77,5
s_add_u32 s56,s56,s68
s_mul_i32 s70,s56,24576
s_lshl_b32 s71,s56,12
s_lshl_b32 s59,s77,13
s_lshl2_add_u32 s59,s68,s59
s_add_u32 s59,s59,10486144
s_cmp_lt_u32 s77,s61
s_cselect_b32 s57,0,16777216
s_mov_b32 s60,s59
s_buffer_load_dword s33,s[8:11],s60
s_add_u32 s71,s71,s57
s_add_u32 s71,s71,58720256
s_cmp_eq_u32 s77,s61
s_cselect_b32 s57,50331648,0
s_cselect_b32 s58,1536,0
s_add_u32 s59,s59,s58
s_buffer_load_dword s32,s[8:11],s59
s_add_u32 s70,s70,s57
s_add_u32 s70,s70,150994944
v_mov_b32 v19,s59
v_writelane_b32 v19,s60,1
L_af_105:
v_max3_u32 v238,v72,v73,v74
v_max3_u32 v238,v74,v75,v238
v_max3_u32 v238,v76,v77,v238
v_max3_u32 v238,v78,v79,v238
v_max3_u32 v238,v80,v81,v238
v_max3_u32 v238,v82,v83,v238
v_max3_u32 v238,v84,v85,v238
v_max3_u32 v238,v86,v87,v238
v_max3_u32 v238,v120,v121,v238
v_max3_u32 v238,v122,v123,v238
v_max3_u32 v238,v124,v125,v238
v_max3_u32 v238,v126,v127,v238
v_cmp_eq_u32 vcc,-1,v238
s_cbranch_vccnz L_ac_106
L_acb_107:
v_max3_f32 v238,v128,v129,v130
v_max3_f32 v239,v131,v132,v133
v_max3_f32 v238,v134,v135,v238
v_max3_f32 v239,v138,v139,v239
v_max_f32 v238,v238,v239
v_max_f32 v239,v238,v239
v_pk_mul_f32 v[128:129],v[128:129],v[152:153] op_sel_hi:[1,0]
v_pk_mul_f32 v[130:131],v[130:131],v[152:153] op_sel_hi:[1,0]
v_permlane16_swap_b32 v238,v239
v_max_f32 v238,v238,v239
v_max_f32 v239,v238,v239
v_pk_mul_f32 v[132:133],v[132:133],v[152:153] op_sel_hi:[1,0]
v_pk_mul_f32 v[134:135],v[134:135],v[152:153] op_sel_hi:[1,0]
v_permlane32_swap_b32 v238,v239
v_max_f32 v238,v238,v239
v_mul_f32 v238,v152,v238
v_pk_mul_f32 v[138:139],v[138:139],v[152:153] op_sel_hi:[1,0]
v_pk_add_f32 v[128:129],v[128:129],v[238:239] op_sel_hi:[1,0] neg_lo:[0,1] neg_hi:[0,1]
v_pk_add_f32 v[130:131],v[130:131],v[238:239] op_sel_hi:[1,0] neg_lo:[0,1] neg_hi:[0,1]
v_pk_add_f32 v[132:133],v[132:133],v[238:239] op_sel_hi:[1,0] neg_lo:[0,1] neg_hi:[0,1]
v_pk_add_f32 v[134:135],v[134:135],v[238:239] op_sel_hi:[1,0] neg_lo:[0,1] neg_hi:[0,1]
v_pk_add_f32 v[138:139],v[138:139],v[238:239] op_sel_hi:[1,0] neg_lo:[0,1] neg_hi:[0,1]
v_exp_f32 v128,v128
v_exp_f32 v129,v129
v_exp_f32 v130,v130
v_exp_f32 v131,v131
v_exp_f32 v132,v132
v_exp_f32 v133,v133
v_exp_f32 v134,v134
v_exp_f32 v135,v135
v_exp_f32 v138,v138
v_exp_f32 v139,v139
v_pk_add_f32 v[148:149],v[128:129],v[130:131]
v_pk_add_f32 v[150:151],v[132:133],v[134:135]
v_pk_add_f32 v[148:149],v[148:149],v[138:139]
v_pk_add_f32 v[148:149],v[148:149],v[150:151]
v_add_f32 v150,v148,v149
v_add_f32 v151,v148,v149
s_nop 1
v_permlane16_swap_b32 v150,v151
v_add_f32 v148,v150,v151
v_add_f32 v149,v150,v151
s_nop 1
v_permlane32_swap_b32 v148,v149
v_add_f32 v148,v148,v149
v_rcp_f32 v148,v148
s_nop 0
v_pk_mul_f32 v[138:139],v[138:139],v[148:149] op_sel_hi:[1,0]
v_pk_mul_f32 v[128:129],v[128:129],v[148:149] op_sel_hi:[1,0]
v_pk_mul_f32 v[130:131],v[130:131],v[148:149] op_sel_hi:[1,0]
v_pk_mul_f32 v[132:133],v[132:133],v[148:149] op_sel_hi:[1,0]
v_pk_mul_f32 v[134:135],v[134:135],v[148:149] op_sel_hi:[1,0]
v_cvt_pk_bf16_f32 v144,v138,v139
v_cvt_pk_bf16_f32 v147,v138,v139
s_nop 0
v_mfma_f32_16x16x16_bf16 v[24:27],v[120:121],v[144:145],0
v_cvt_pk_bf16_f32 v140,v128,v129
v_mfma_f32_16x16x16_bf16 v[28:31],v[120:121],v[146:147],0
v_cvt_pk_bf16_f32 v141,v130,v131
v_mfma_f32_16x16x16_bf16 v[32:35],v[122:123],v[144:145],0
v_cvt_pk_bf16_f32 v142,v132,v133
v_mfma_f32_16x16x16_bf16 v[36:39],v[122:123],v[146:147],0
v_cvt_pk_bf16_f32 v143,v134,v135
v_mfma_f32_16x16x16_bf16 v[40:43],v[124:125],v[144:145],0
v_mfma_f32_16x16x16_bf16 v[44:47],v[124:125],v[146:147],0
v_mfma_f32_16x16x16_bf16 v[48:51],v[126:127],v[144:145],0
v_mfma_f32_16x16x16_bf16 v[52:55],v[126:127],v[146:147],0
v_mfma_f32_16x16x32_bf16 v[24:27],v[88:91],v[140:143],v[24:27]
v_mfma_f32_16x16x32_bf16 v[28:31],v[92:95],v[140:143],v[28:31]
v_mfma_f32_16x16x32_bf16 v[32:35],v[96:99],v[140:143],v[32:35]
v_mfma_f32_16x16x32_bf16 v[36:39],v[100:103],v[140:143],v[36:39]
v_cvt_pk_bf16_f32 v72,v24,v28
v_cvt_pk_bf16_f32 v73,v25,v29
v_mfma_f32_16x16x32_bf16 v[40:43],v[104:107],v[140:143],v[40:43]
v_cvt_pk_bf16_f32 v74,v26,v30
v_cvt_pk_bf16_f32 v75,v27,v31
v_mfma_f32_16x16x32_bf16 v[44:47],v[108:111],v[140:143],v[44:47]
ds_write_b128 v3,v[72:75] offset:0
v_cvt_pk_bf16_f32 v76,v32,v36
v_cvt_pk_bf16_f32 v77,v33,v37
v_mfma_f32_16x16x32_bf16 v[48:51],v[112:115],v[140:143],v[48:51]
v_cvt_pk_bf16_f32 v78,v34,v38
v_cvt_pk_bf16_f32 v79,v35,v39
v_mfma_f32_16x16x32_bf16 v[52:55],v[116:119],v[140:143],v[52:55]
ds_write_b128 v3,v[76:79] offset:1024
v_cvt_pk_bf16_f32 v80,v40,v44
v_cvt_pk_bf16_f32 v81,v41,v45
v_cvt_pk_bf16_f32 v82,v42,v46
v_cvt_pk_bf16_f32 v83,v43,v47
ds_write_b128 v3,v[80:83] offset:2048
s_nop 1
v_cvt_pk_bf16_f32 v84,v48,v52
v_cvt_pk_bf16_f32 v85,v49,v53
v_cvt_pk_bf16_f32 v86,v50,v54
v_cvt_pk_bf16_f32 v87,v51,v55
ds_write_b128 v3,v[84:87] offset:3072
s_waitcnt lgkmcnt(0)
s_barrier
L_ad_101:
s_mov_b32 s51,s53
s_mov_b32 s31,1
s_branch L_aa_65
L_aa_71:
s_waitcnt vmcnt(0)
buffer_store_dword v20,off,s[8:11],s73 sc1
s_mov_b32 s73,0x80000000
L_aa_73:
s_mov_b32 s51,s53
s_mov_b32 s31,0
s_add_u32 s35,s53,4
s_cmp_lt_u32 s53,5
s_cbranch_scc1 L_ab_108
s_cmp_ge_u32 s53,62
s_cbranch_scc1 L_am_110
L_aw_111:
v_min_u32 v239,v242,v243
v_cmp_eq_u32 vcc,0,v239
s_cbranch_vccz L_awd_112
s_sleep 4
buffer_load_dwordx2 v[242:243],v244,s[8:11],0 offen sc1
s_sub_u32 s49,s49,1
s_cbranch_scc1 L_abort
s_waitcnt vmcnt(0)
s_branch L_aw_111
L_awd_112:
v_max_u32 v242,v242,v243
s_nop 1
v_max_u32_dpp v242,v242,v242 row_ror:8 row_mask:0xf bank_mask:0xf
s_nop 1
v_max_u32_dpp v242,v242,v242 row_ror:4 row_mask:0xf bank_mask:0xf
s_nop 1
v_max_u32_dpp v242,v242,v242 row_ror:2 row_mask:0xf bank_mask:0xf
s_nop 1
v_max_u32_dpp v242,v242,v242 row_ror:1 row_mask:0xf bank_mask:0xf
v_mov_b32 v243,v242
s_nop 1
v_permlane16_swap_b32 v242,v243
v_max_u32 v242,v242,v243
v_mov_b32 v243,v242
s_nop 1
v_permlane32_swap_b32 v242,v243
v_max_u32 v242,v242,v243
s_nop 0
v_readfirstlane_b32 s56,v242
v_readlane_b32 s57,v255,s53
s_max_u32 s75,s75,s56
s_cmp_lt_u32 s53,10
s_cbranch_scc1 L_ab_108
s_mov_b32 s77,s36
s_and_b32 s55,s75,0x7ff
s_sub_u32 s55,2047,s55
s_cmp_lt_u32 s75,s57
s_cselect_b32 s55,4095,s55
s_lshr_b32 s61,s55,5
s_mov_b32 s30,1
s_lshl_b32 s56,s77,5
s_add_u32 s56,s56,s68
s_mul_i32 s70,s56,24576
s_lshl_b32 s71,s56,12
s_lshl_b32 s59,s77,13
s_lshl2_add_u32 s59,s68,s59
s_add_u32 s59,s59,10486144
s_cmp_lt_u32 s77,s61
s_cselect_b32 s57,0,16777216
s_mov_b32 s60,s59
s_add_u32 s71,s71,s57
s_add_u32 s71,s71,58720256
s_cmp_eq_u32 s77,s61
s_cselect_b32 s57,50331648,0
s_cselect_b32 s58,1536,0
s_add_u32 s59,s59,s58
s_add_u32 s70,s70,s57
s_add_u32 s70,s70,150994944
v_mov_b32 v19,s59
v_writelane_b32 v19,s60,1
s_branch L_aj_109
L_ab_108:
s_mov_b32 s77,s35
s_mov_b32 s30,0
s_lshl_b32 s56,s77,5
s_add_u32 s56,s56,s68
s_mul_i32 s70,s56,24576
s_lshl_b32 s71,s56,12
s_lshl_b32 s59,s77,13
s_lshl2_add_u32 s59,s68,s59
s_add_u32 s59,s59,10485760
s_mov_b32 s33,1
s_add_u32 s70,s70,100663296
s_add_u32 s71,s71,41943040
v_mov_b32 v19,s59
L_aj_109:
buffer_load_dword v18,v19,s[8:11],0 offen sc1
s_waitcnt vmcnt(2)
v_mfma_f32_16x16x32_bf16 v[136:139],v[72:75],v[24:27],0
v_max3_u32 v238,v72,v73,v74
v_max3_u32 v238,v74,v75,v238
v_mfma_f32_16x16x32_bf16 v[136:139],v[76:79],v[28:31],v[136:139]
v_max3_u32 v238,v76,v77,v238
v_max3_u32 v238,v78,v79,v238
v_mfma_f32_16x16x32_bf16 v[136:139],v[80:83],v[32:35],v[136:139]
v_max3_u32 v238,v80,v81,v238
v_max3_u32 v238,v82,v83,v238
v_mfma_f32_16x16x32_bf16 v[136:139],v[84:87],v[36:39],v[136:139]
v_max3_u32 v238,v84,v85,v238
v_max3_u32 v238,v86,v87,v238
v_max3_u32 v238,v120,v121,v238
v_max3_u32 v238,v122,v123,v238
v_max3_u32 v238,v124,v125,v238
v_max3_u32 v238,v126,v127,v238
v_cmp_eq_u32 vcc,-1,v238
s_cbranch_vccz L_aa_76
L_aa_75:
buffer_load_dwordx4 v[72:75],v0,s[8:11],s76 offen offset:0 sc1
buffer_load_dwordx4 v[76:79],v0,s[8:11],s76 offen offset:1024 sc1
buffer_load_dwordx4 v[80:83],v0,s[8:11],s76 offen offset:2048 sc1
buffer_load_dwordx4 v[84:87],v0,s[8:11],s76 offen offset:3072 sc1
buffer_load_dwordx2 v[120:121],v253,s[8:11],s76 offen offset:0 sc1
buffer_load_dwordx2 v[122:123],v253,s[8:11],s76 offen offset:1024 sc1
buffer_load_dwordx2 v[124:125],v253,s[8:11],s76 offen offset:2048 sc1
buffer_load_dwordx2 v[126:127],v253,s[8:11],s76 offen offset:3072 sc1
buffer_load_dword v18,v19,s[8:11],0 offen sc1
s_sub_u32 s49,s49,1
s_cbranch_scc1 L_abort
s_waitcnt vmcnt(8)
v_mfma_f32_16x16x32_bf16 v[136:139],v[72:75],v[24:27],0
v_max3_u32 v238,v72,v73,v74
v_max3_u32 v238,v74,v75,v238
s_waitcnt vmcnt(7)
v_mfma_f32_16x16x32_bf16 v[136:139],v[76:79],v[28:31],v[136:139]
v_max3_u32 v238,v76,v77,v238
v_max3_u32 v238,v78,v79,v238
s_waitcnt vmcnt(6)
v_mfma_f32_16x16x32_bf16 v[136:139],v[80:83],v[32:35],v[136:139]
v_max3_u32 v238,v80,v81,v238
v_max3_u32 v238,v82,v83,v238
s_waitcnt vmcnt(5)
v_mfma_f32_16x16x32_bf16 v[136:139],v[84:87],v[36:39],v[136:139]
v_max3_u32 v238,v84,v85,v238
v_max3_u32 v238,v86,v87,v238
s_waitcnt vmcnt(1)
v_max3_u32 v238,v120,v121,v238
v_max3_u32 v238,v122,v123,v238
v_max3_u32 v238,v124,v125,v238
v_max3_u32 v238,v126,v127,v238
v_cmp_eq_u32 vcc,-1,v238
s_cbranch_vccnz L_aa_75
L_aa_76:
s_cmp_lg_u32 s27,3
s_cbranch_scc1 L_ai_113
v_max3_f32 v238,v128,v129,v130
v_max3_f32 v239,v131,v132,v133
v_max3_f32 v238,v134,v135,v238
v_max3_f32 v239,v138,v139,v239
v_max_f32 v238,v238,v239
v_max_f32 v239,v238,v239
v_pk_mul_f32 v[128:129],v[128:129],v[152:153] op_sel_hi:[1,0]
v_pk_mul_f32 v[130:131],v[130:131],v[152:153] op_sel_hi:[1,0]
v_permlane16_swap_b32 v238,v239
v_max_f32 v238,v238,v239
v_max_f32 v239,v238,v239
v_pk_mul_f32 v[132:133],v[132:133],v[152:153] op_sel_hi:[1,0]
v_pk_mul_f32 v[134:135],v[134:135],v[152:153] op_sel_hi:[1,0]
v_permlane32_swap_b32 v238,v239
v_max_f32 v238,v238,v239
v_mul_f32 v238,v152,v238
v_pk_mul_f32 v[138:139],v[138:139],v[152:153] op_sel_hi:[1,0]
buffer_load_dword v17,v16,s[8:11],s87 offen sc1
v_pk_add_f32 v[128:129],v[128:129],v[238:239] op_sel_hi:[1,0] neg_lo:[0,1] neg_hi:[0,1]
v_pk_add_f32 v[130:131],v[130:131],v[238:239] op_sel_hi:[1,0] neg_lo:[0,1] neg_hi:[0,1]
v_pk_add_f32 v[132:133],v[132:133],v[238:239] op_sel_hi:[1,0] neg_lo:[0,1] neg_hi:[0,1]
v_pk_add_f32 v[134:135],v[134:135],v[238:239] op_sel_hi:[1,0] neg_lo:[0,1] neg_hi:[0,1]
v_pk_add_f32 v[138:139],v[138:139],v[238:239] op_sel_hi:[1,0] neg_lo:[0,1] neg_hi:[0,1]
v_exp_f32 v128,v128
v_exp_f32 v129,v129
v_exp_f32 v130,v130
v_exp_f32 v131,v131
v_exp_f32 v132,v132
v_exp_f32 v133,v133
v_exp_f32 v134,v134
v_exp_f32 v135,v135
v_exp_f32 v138,v138
v_exp_f32 v139,v139
v_pk_add_f32 v[148:149],v[128:129],v[130:131]
v_pk_add_f32 v[150:151],v[132:133],v[134:135]
v_pk_add_f32 v[148:149],v[148:149],v[138:139]
v_pk_add_f32 v[148:149],v[148:149],v[150:151]
v_add_f32 v150,v148,v149
v_add_f32 v151,v148,v149
s_nop 1
v_permlane16_swap_b32 v150,v151
v_add_f32 v148,v150,v151
v_add_f32 v149,v150,v151
s_nop 1
v_permlane32_swap_b32 v148,v149
v_add_f32 v148,v148,v149
v_rcp_f32 v148,v148
s_waitcnt vmcnt(0)
v_cmp_gt_u32 vcc,s66,v17
v_pk_mul_f32 v[138:139],v[138:139],v[148:149] op_sel_hi:[1,0]
v_pk_mul_f32 v[128:129],v[128:129],v[148:149] op_sel_hi:[1,0]
v_pk_mul_f32 v[130:131],v[130:131],v[148:149] op_sel_hi:[1,0]
v_pk_mul_f32 v[132:133],v[132:133],v[148:149] op_sel_hi:[1,0]
v_pk_mul_f32 v[134:135],v[134:135],v[148:149] op_sel_hi:[1,0]
s_cbranch_vccnz L_ap_114
L_apb_115:
s_xor_b32 s34,s69,524288
buffer_load_dwordx4 v[192:195],v7,s[8:11],s34 offen sc1
v_cvt_pk_bf16_f32 v144,v138,v139
v_cvt_pk_bf16_f32 v147,v138,v139
s_nop 0
v_mfma_f32_16x16x16_bf16 v[24:27],v[120:121],v[144:145],0
s_add_u32 s34,s34,4096
v_cvt_pk_bf16_f32 v140,v128,v129
v_mfma_f32_16x16x16_bf16 v[28:31],v[120:121],v[146:147],0
buffer_load_dwordx4 v[196:199],v7,s[8:11],s34 offen sc1
v_cvt_pk_bf16_f32 v141,v130,v131
v_mfma_f32_16x16x16_bf16 v[32:35],v[122:123],v[144:145],0
s_add_u32 s34,s34,4096
v_cvt_pk_bf16_f32 v142,v132,v133
v_mfma_f32_16x16x16_bf16 v[36:39],v[122:123],v[146:147],0
buffer_load_dwordx4 v[200:203],v7,s[8:11],s34 offen sc1
v_cvt_pk_bf16_f32 v143,v134,v135
v_mfma_f32_16x16x16_bf16 v[40:43],v[124:125],v[144:145],0
s_add_u32 s34,s34,4096
v_mfma_f32_16x16x16_bf16 v[44:47],v[124:125],v[146:147],0
buffer_load_dwordx4 v[204:207],v7,s[8:11],s34 offen sc1
v_mfma_f32_16x16x16_bf16 v[48:51],v[126:127],v[144:145],0
s_add_u32 s34,s34,4096
v_mfma_f32_16x16x16_bf16 v[52:55],v[126:127],v[146:147],0
buffer_load_dwordx4 v[208:211],v7,s[8:11],s34 offen sc1
v_mfma_f32_16x16x32_bf16 v[24:27],v[88:91],v[140:143],v[24:27]
s_add_u32 s34,s34,4096
v_mfma_f32_16x16x32_bf16 v[28:31],v[92:95],v[140:143],v[28:31]
buffer_load_dwordx4 v[212:215],v7,s[8:11],s34 offen sc1
v_mfma_f32_16x16x32_bf16 v[32:35],v[96:99],v[140:143],v[32:35]
s_add_u32 s34,s34,4096
v_mfma_f32_16x16x32_bf16 v[36:39],v[100:103],v[140:143],v[36:39]
buffer_load_dwordx4 v[216:219],v7,s[8:11],s34 offen sc1
v_cvt_pk_bf16_f32 v72,v24,v28
v_cvt_pk_bf16_f32 v73,v25,v29
v_mfma_f32_16x16x32_bf16 v[40:43],v[104:107],v[140:143],v[40:43]
s_add_u32 s34,s34,4096
v_cvt_pk_bf16_f32 v74,v26,v30
v_cvt_pk_bf16_f32 v75,v27,v31
v_mfma_f32_16x16x32_bf16 v[44:47],v[108:111],v[140:143],v[44:47]
ds_write_b128 v3,v[72:75] offset:0
v_cvt_pk_bf16_f32 v76,v32,v36
v_cvt_pk_bf16_f32 v77,v33,v37
v_mfma_f32_16x16x32_bf16 v[48:51],v[112:115],v[140:143],v[48:51]
buffer_load_dwordx4 v[220:223],v7,s[8:11],s34 offen sc1
v_cvt_pk_bf16_f32 v78,v34,v38
v_cvt_pk_bf16_f32 v79,v35,v39
v_mfma_f32_16x16x32_bf16 v[52:55],v[116:119],v[140:143],v[52:55]
ds_write_b128 v3,v[76:79] offset:1024
v_cvt_pk_bf16_f32 v80,v40,v44
v_cvt_pk_bf16_f32 v81,v41,v45
v_cvt_pk_bf16_f32 v82,v42,v46
v_cvt_pk_bf16_f32 v83,v43,v47
ds_write_b128 v3,v[80:83] offset:2048
s_nop 1
v_cvt_pk_bf16_f32 v84,v48,v52
v_cvt_pk_bf16_f32 v85,v49,v53
v_cvt_pk_bf16_f32 v86,v50,v54
v_cvt_pk_bf16_f32 v87,v51,v55
ds_write_b128 v3,v[84:87] offset:3072
v_readlane_b32 s32,v18,0
v_readlane_b32 s33,v18,1
s_waitcnt lgkmcnt(0)
s_barrier
s_branch L_aa_78
L_ai_113:
v_max3_f32 v238,v128,v129,v130
v_max3_f32 v239,v131,v132,v133
v_max3_f32 v238,v134,v135,v238
v_max3_f32 v239,v138,v139,v239
v_max_f32 v238,v238,v239
v_max_f32 v239,v238,v239
v_pk_mul_f32 v[128:129],v[128:129],v[152:153] op_sel_hi:[1,0]
v_pk_mul_f32 v[130:131],v[130:131],v[152:153] op_sel_hi:[1,0]
v_permlane16_swap_b32 v238,v239
v_max_f32 v238,v238,v239
v_max_f32 v239,v238,v239
v_pk_mul_f32 v[132:133],v[132:133],v[152:153] op_sel_hi:[1,0]
v_pk_mul_f32 v[134:135],v[134:135],v[152:153] op_sel_hi:[1,0]
v_permlane32_swap_b32 v238,v239
v_max_f32 v238,v238,v239
v_mul_f32 v238,v152,v238
v_pk_mul_f32 v[138:139],v[138:139],v[152:153] op_sel_hi:[1,0]
v_pk_add_f32 v[128:129],v[128:129],v[238:239] op_sel_hi:[1,0] neg_lo:[0,1] neg_hi:[0,1]
v_pk_add_f32 v[130:131],v[130:131],v[238:239] op_sel_hi:[1,0] neg_lo:[0,1] neg_hi:[0,1]
v_pk_add_f32 v[132:133],v[132:133],v[238:239] op_sel_hi:[1,0] neg_lo:[0,1] neg_hi:[0,1]
v_pk_add_f32 v[134:135],v[134:135],v[238:239] op_sel_hi:[1,0] neg_lo:[0,1] neg_hi:[0,1]
v_pk_add_f32 v[138:139],v[138:139],v[238:239] op_sel_hi:[1,0] neg_lo:[0,1] neg_hi:[0,1]
v_exp_f32 v128,v128
v_exp_f32 v129,v129
v_exp_f32 v130,v130
v_exp_f32 v131,v131
v_exp_f32 v132,v132
v_exp_f32 v133,v133
v_exp_f32 v134,v134
v_exp_f32 v135,v135
v_exp_f32 v138,v138
v_exp_f32 v139,v139
v_pk_add_f32 v[148:149],v[128:129],v[130:131]
v_pk_add_f32 v[150:151],v[132:133],v[134:135]
v_pk_add_f32 v[148:149],v[148:149],v[138:139]
v_pk_add_f32 v[148:149],v[148:149],v[150:151]
v_add_f32 v150,v148,v149
v_add_f32 v151,v148,v149
s_nop 1
v_permlane16_swap_b32 v150,v151
v_add_f32 v148,v150,v151
v_add_f32 v149,v150,v151
s_nop 1
v_permlane32_swap_b32 v148,v149
v_add_f32 v148,v148,v149
v_rcp_f32 v148,v148
s_nop 0
v_pk_mul_f32 v[138:139],v[138:139],v[148:149] op_sel_hi:[1,0]
v_pk_mul_f32 v[128:129],v[128:129],v[148:149] op_sel_hi:[1,0]
v_pk_mul_f32 v[130:131],v[130:131],v[148:149] op_sel_hi:[1,0]
v_pk_mul_f32 v[132:133],v[132:133],v[148:149] op_sel_hi:[1,0]
v_pk_mul_f32 v[134:135],v[134:135],v[148:149] op_sel_hi:[1,0]
v_cvt_pk_bf16_f32 v144,v138,v139
v_cvt_pk_bf16_f32 v147,v138,v139
s_nop 0
v_mfma_f32_16x16x16_bf16 v[24:27],v[120:121],v[144:145],0
v_cvt_pk_bf16_f32 v140,v128,v129
v_mfma_f32_16x16x16_bf16 v[28:31],v[120:121],v[146:147],0
v_cvt_pk_bf16_f32 v141,v130,v131
v_mfma_f32_16x16x16_bf16 v[32:35],v[122:123],v[144:145],0
v_cvt_pk_bf16_f32 v142,v132,v133
v_mfma_f32_16x16x16_bf16 v[36:39],v[122:123],v[146:147],0
v_cvt_pk_bf16_f32 v143,v134,v135
v_mfma_f32_16x16x16_bf16 v[40:43],v[124:125],v[144:145],0
v_mfma_f32_16x16x16_bf16 v[44:47],v[124:125],v[146:147],0
v_mfma_f32_16x16x16_bf16 v[48:51],v[126:127],v[144:145],0
v_mfma_f32_16x16x16_bf16 v[52:55],v[126:127],v[146:147],0
v_mfma_f32_16x16x32_bf16 v[24:27],v[88:91],v[140:143],v[24:27]
v_mfma_f32_16x16x32_bf16 v[28:31],v[92:95],v[140:143],v[28:31]
v_mfma_f32_16x16x32_bf16 v[32:35],v[96:99],v[140:143],v[32:35]
v_mfma_f32_16x16x32_bf16 v[36:39],v[100:103],v[140:143],v[36:39]
v_cvt_pk_bf16_f32 v72,v24,v28
v_cvt_pk_bf16_f32 v73,v25,v29
v_mfma_f32_16x16x32_bf16 v[40:43],v[104:107],v[140:143],v[40:43]
v_cvt_pk_bf16_f32 v74,v26,v30
v_cvt_pk_bf16_f32 v75,v27,v31
v_mfma_f32_16x16x32_bf16 v[44:47],v[108:111],v[140:143],v[44:47]
ds_write_b128 v3,v[72:75] offset:0
v_cvt_pk_bf16_f32 v76,v32,v36
v_cvt_pk_bf16_f32 v77,v33,v37
v_mfma_f32_16x16x32_bf16 v[48:51],v[112:115],v[140:143],v[48:51]
v_cvt_pk_bf16_f32 v78,v34,v38
v_cvt_pk_bf16_f32 v79,v35,v39
v_mfma_f32_16x16x32_bf16 v[52:55],v[116:119],v[140:143],v[52:55]
ds_write_b128 v3,v[76:79] offset:1024
v_cvt_pk_bf16_f32 v80,v40,v44
v_cvt_pk_bf16_f32 v81,v41,v45
v_cvt_pk_bf16_f32 v82,v42,v46
v_cvt_pk_bf16_f32 v83,v43,v47
ds_write_b128 v3,v[80:83] offset:2048
s_nop 1
v_cvt_pk_bf16_f32 v84,v48,v52
v_cvt_pk_bf16_f32 v85,v49,v53
v_cvt_pk_bf16_f32 v86,v50,v54
v_cvt_pk_bf16_f32 v87,v51,v55
ds_write_b128 v3,v[84:87] offset:3072
s_waitcnt vmcnt(0)
v_readlane_b32 s32,v18,0
v_readlane_b32 s33,v18,1
s_waitcnt lgkmcnt(0)
s_barrier
s_branch L_aa_65
L_aa_74:
s_cmp_lg_u32 s86,1536
s_cbranch_scc1 L_az_116
s_cmp_ge_u32 s35,66
s_cbranch_scc1 L_aa_64
v_subrev_u32 v248,s36,v1
v_and_b32 v248,0x80000003,v248
v_cmp_eq_u32 vcc,0,v248
v_lshlrev_b32 v248,2,v1
v_mov_b32 v249,0x40000000
v_cndmask_b32 v248,v249,v248,vcc
v_mov_b32 v249,3
s_or_b32 s59,s68,s46
s_mov_b32 s59,11018240
s_cmov_b32 s59,0x80000000
buffer_store_dword v249,v248,s[8:11],s59 offen sc1
L_aa_64:
s_waitcnt vmcnt(0)
buffer_store_dword v20,off,s[8:11],s73 sc1
s_mov_b32 s73,0x80000000
v_lshlrev_b32 v238,2,v1
v_add_u32 v248,155712,v238
s_cmp_lg_u32 s46,0
s_cbranch_scc1 L_an_117
s_lshl_b32 s59,s54,13
s_add_u32 s59,s59,11026432
L_fp_118:
s_sleep 1
buffer_load_dword v239,v238,s[8:11],s59 offen sc1
s_sub_u32 s49,s49,1
s_cbranch_scc1 L_abort
s_waitcnt vmcnt(0)
v_cmp_eq_u32 vcc,0,v239
s_cbranch_vccnz L_fp_118
ds_write_b32 v248,v239
s_waitcnt lgkmcnt(0)
L_an_117:
s_barrier
ds_read_b32 v239,v248
s_mov_b32 s86,768
s_mov_b32 s30,1
s_waitcnt lgkmcnt(0)
v_readfirstlane_b32 s55,v239
v_and_b32 v239,255,v239
s_lshr_b32 s55,s55,8
s_lshr_b32 s61,s55,5
v_cmp_ne_u32 s[38:39],3,v239
v_cmp_le_u32 vcc,s61,v1
s_nop 1
v_cndmask_b32 v238,1,2,vcc
v_cmp_ne_u32 s[84:85],v238,v239
s_bcnt1_i32_b64 s56,s[84:85]
s_nop 0
v_mbcnt_lo_u32_b32 v238,s84,0
v_mbcnt_hi_u32_b32 v238,s85,v238
s_mul_i32 s56,s56,14
s_add_u32 s56,s56,48
s_lshr_b32 s56,s56,7
s_lshl_b32 s56,s56,1
v_cmp_gt_u32 vcc,s56,v238
v_and_b32 v239,1,v238
v_and_b32 v238,3,v238
v_add_u32 v238,2,v238
v_cndmask_b32 v238,v238,v239,vcc
v_cmp_eq_u32 vcc,s54,v238
s_and_b64 s[84:85],s[84:85],vcc
s_ff1_i32_b64 s77,s[84:85]
s_bitset0_b64 s[84:85],s77
s_min_u32 s77,s77,64
s_lshl_b32 s56,s77,5
s_add_u32 s56,s56,s68
s_mul_i32 s70,s56,24576
s_lshl_b32 s71,s56,12
s_lshl_b32 s59,s77,13
s_lshl2_add_u32 s59,s68,s59
s_add_u32 s59,s59,10486144
s_cmp_lt_u32 s77,s61
s_cselect_b32 s57,0,16777216
s_mov_b32 s60,s59
s_buffer_load_dword s33,s[8:11],s60
s_add_u32 s71,s71,s57
s_add_u32 s71,s71,58720256
s_cmp_eq_u32 s77,s61
s_cselect_b32 s57,50331648,0
s_cselect_b32 s58,1536,0
s_add_u32 s59,s59,s58
s_buffer_load_dword s32,s[8:11],s59
s_add_u32 s70,s70,s57
s_add_u32 s70,s70,150994944
v_mov_b32 v19,s59
v_writelane_b32 v19,s60,1
s_cmp_lt_u32 s77,64
s_cbranch_scc1 L_aa_72
L_az_116:
s_waitcnt vmcnt(0)
buffer_store_dword v20,off,s[8:11],s73 sc1
s_mov_b32 s73,0x80000000
s_endpgm
L_ag_80:
s_lshl_b32 s21,s26,13
s_lshl2_add_u32 s21,s68,s21
s_add_u32 s21,s21,10487296
L_ww_119:
buffer_load_dword v246,off,s[8:11],s21 sc1
s_sub_u32 s49,s49,1
s_cbranch_scc1 L_abort
s_waitcnt vmcnt(0)
v_readfirstlane_b32 s22,v246
s_cmp_eq_u32 s22,0
s_cbranch_scc1 L_ww_119
L_wwd_120:
s_branch L_agb_81
L_ac_87:
buffer_load_dwordx4 v[72:75],v0,s[8:11],s76 offen offset:0 sc1
buffer_load_dwordx4 v[76:79],v0,s[8:11],s76 offen offset:1024 sc1
buffer_load_dwordx4 v[80:83],v0,s[8:11],s76 offen offset:2048 sc1
buffer_load_dwordx4 v[84:87],v0,s[8:11],s76 offen offset:3072 sc1
buffer_load_dwordx2 v[120:121],v253,s[8:11],s76 offen offset:0 sc1
buffer_load_dwordx2 v[122:123],v253,s[8:11],s76 offen offset:1024 sc1
buffer_load_dwordx2 v[124:125],v253,s[8:11],s76 offen offset:2048 sc1
buffer_load_dwordx2 v[126:127],v253,s[8:11],s76 offen offset:3072 sc1
s_sub_u32 s49,s49,1
s_cbranch_scc1 L_abort
s_waitcnt vmcnt(7)
v_mfma_f32_16x16x32_bf16 v[136:139],v[72:75],v[24:27],0
v_max3_u32 v238,v72,v73,v74
v_max3_u32 v238,v74,v75,v238
s_waitcnt vmcnt(6)
v_mfma_f32_16x16x32_bf16 v[136:139],v[76:79],v[28:31],v[136:139]
v_max3_u32 v238,v76,v77,v238
v_max3_u32 v238,v78,v79,v238
s_waitcnt vmcnt(5)
v_mfma_f32_16x16x32_bf16 v[136:139],v[80:83],v[32:35],v[136:139]
v_max3_u32 v238,v80,v81,v238
v_max3_u32 v238,v82,v83,v238
s_waitcnt vmcnt(4)
v_mfma_f32_16x16x32_bf16 v[136:139],v[84:87],v[36:39],v[136:139]
v_max3_u32 v238,v84,v85,v238
v_max3_u32 v238,v86,v87,v238
s_waitcnt vmcnt(0)
v_max3_u32 v238,v120,v121,v238
v_max3_u32 v238,v122,v123,v238
v_max3_u32 v238,v124,v125,v238
v_max3_u32 v238,v126,v127,v238
v_cmp_eq_u32 vcc,-1,v238
s_cbranch_vccnz L_ac_87
s_branch L_acb_88
L_ap_90:
L_aw_121:
v_cmp_gt_u32 vcc,s66,v17
s_cbranch_vccz L_awd_122
buffer_load_dword v17,v16,s[8:11],s87 offen sc1
s_sub_u32 s49,s49,1
s_cbranch_scc1 L_abort
s_waitcnt vmcnt(0)
s_branch L_aw_121
L_awd_122:
s_branch L_apb_91
L_ag_99:
s_lshl_b32 s21,s51,13
s_lshl2_add_u32 s21,s68,s21
s_add_u32 s21,s21,10487296
L_ww_123:
buffer_load_dword v246,off,s[8:11],s21 sc1
s_sub_u32 s49,s49,1
s_cbranch_scc1 L_abort
s_waitcnt vmcnt(0)
v_readfirstlane_b32 s22,v246
s_cmp_eq_u32 s22,0
s_cbranch_scc1 L_ww_123
L_wwd_124:
s_branch L_agb_100
L_ac_106:
buffer_load_dwordx4 v[72:75],v0,s[8:11],s76 offen offset:0 sc1
buffer_load_dwordx4 v[76:79],v0,s[8:11],s76 offen offset:1024 sc1
buffer_load_dwordx4 v[80:83],v0,s[8:11],s76 offen offset:2048 sc1
buffer_load_dwordx4 v[84:87],v0,s[8:11],s76 offen offset:3072 sc1
buffer_load_dwordx2 v[120:121],v253,s[8:11],s76 offen offset:0 sc1
buffer_load_dwordx2 v[122:123],v253,s[8:11],s76 offen offset:1024 sc1
buffer_load_dwordx2 v[124:125],v253,s[8:11],s76 offen offset:2048 sc1
buffer_load_dwordx2 v[126:127],v253,s[8:11],s76 offen offset:3072 sc1
s_sub_u32 s49,s49,1
s_cbranch_scc1 L_abort
s_waitcnt vmcnt(7)
v_mfma_f32_16x16x32_bf16 v[136:139],v[72:75],v[24:27],0
v_max3_u32 v238,v72,v73,v74
v_max3_u32 v238,v74,v75,v238
s_waitcnt vmcnt(6)
v_mfma_f32_16x16x32_bf16 v[136:139],v[76:79],v[28:31],v[136:139]
v_max3_u32 v238,v76,v77,v238
v_max3_u32 v238,v78,v79,v238
s_waitcnt vmcnt(5)
v_mfma_f32_16x16x32_bf16 v[136:139],v[80:83],v[32:35],v[136:139]
v_max3_u32 v238,v80,v81,v238
v_max3_u32 v238,v82,v83,v238
s_waitcnt vmcnt(4)
v_mfma_f32_16x16x32_bf16 v[136:139],v[84:87],v[36:39],v[136:139]
v_max3_u32 v238,v84,v85,v238
v_max3_u32 v238,v86,v87,v238
s_waitcnt vmcnt(0)
v_max3_u32 v238,v120,v121,v238
v_max3_u32 v238,v122,v123,v238
v_max3_u32 v238,v124,v125,v238
v_max3_u32 v238,v126,v127,v238
v_cmp_eq_u32 vcc,-1,v238
s_cbranch_vccnz L_ac_106
s_branch L_acb_107
L_am_110:
v_subrev_u32 v248,s36,v1
v_and_b32 v248,0x80000003,v248
v_cmp_eq_u32 vcc,0,v248
v_lshlrev_b32 v248,2,v1
v_mov_b32 v249,0x40000000
v_cndmask_b32 v248,v249,v248,vcc
v_mov_b32 v249,3
s_or_b32 s59,s68,s46
s_mov_b32 s59,11018240
s_cmov_b32 s59,0x80000000
buffer_store_dword v249,v248,s[8:11],s59 offen sc1
s_branch L_ab_108
L_ap_114:
L_aw_125:
v_cmp_gt_u32 vcc,s66,v17
s_cbranch_vccz L_awd_126
buffer_load_dword v17,v16,s[8:11],s87 offen sc1
s_sub_u32 s49,s49,1
s_cbranch_scc1 L_abort
s_waitcnt vmcnt(0)
s_branch L_aw_125
L_awd_126:
s_branch L_apb_115
s_endpgm
L_rch_4:
v_and_b32 v2,15,v1
v_lshlrev_b32 v2,2,v2
v_lshrrev_b32 v3,4,v1
v_lshl_add_u32 v4,v3,16,v2
v_lshl_add_u32 v5,v3,12,v2
s_lshl_b32 s58,s47,8
s_lshl_b32 s57,s46,6
s_add_u32 s58,s58,s57
s_lshl_b32 s59,s47,17
s_add_u32 s59,s59,s57
s_lshl_b32 s60,s46,15
v_add_u32 v6,s60,v0
s_mov_b32 s61,0x05040100
s_mov_b32 s62,0x07060302
s_lshl_b32 s63,s46,19
s_cmp_lt_u32 s48,3
s_cselect_b32 s63,s63,0
s_mov_b32 s4,s26
s_mov_b32 s5,s27
s_mov_b32 s6,4194304
s_mov_b32 s7,0x20000
s_add_u32 s56,s59,0
buffer_load_dword v24,v5,s[4:7],s56 offen offset:0
buffer_load_dword v25,v5,s[4:7],s56 offen offset:1024
buffer_load_dword v26,v5,s[4:7],s56 offen offset:2048
buffer_load_dword v27,v5,s[4:7],s56 offen offset:3072
s_add_u32 s56,s59,16384
buffer_load_dword v28,v5,s[4:7],s56 offen offset:0
buffer_load_dword v29,v5,s[4:7],s56 offen offset:1024
buffer_load_dword v30,v5,s[4:7],s56 offen offset:2048
buffer_load_dword v31,v5,s[4:7],s56 offen offset:3072
s_add_u32 s56,s59,32768
buffer_load_dword v32,v5,s[4:7],s56 offen offset:0
buffer_load_dword v33,v5,s[4:7],s56 offen offset:1024
buffer_load_dword v34,v5,s[4:7],s56 offen offset:2048
buffer_load_dword v35,v5,s[4:7],s56 offen offset:3072
s_add_u32 s56,s59,49152
buffer_load_dword v36,v5,s[4:7],s56 offen offset:0
buffer_load_dword v37,v5,s[4:7],s56 offen offset:1024
buffer_load_dword v38,v5,s[4:7],s56 offen offset:2048
buffer_load_dword v39,v5,s[4:7],s56 offen offset:3072
s_add_u32 s56,s59,65536
buffer_load_dword v40,v5,s[4:7],s56 offen offset:0
buffer_load_dword v41,v5,s[4:7],s56 offen offset:1024
buffer_load_dword v42,v5,s[4:7],s56 offen offset:2048
buffer_load_dword v43,v5,s[4:7],s56 offen offset:3072
s_add_u32 s56,s59,81920
buffer_load_dword v44,v5,s[4:7],s56 offen offset:0
buffer_load_dword v45,v5,s[4:7],s56 offen offset:1024
buffer_load_dword v46,v5,s[4:7],s56 offen offset:2048
buffer_load_dword v47,v5,s[4:7],s56 offen offset:3072
s_add_u32 s56,s59,98304
buffer_load_dword v48,v5,s[4:7],s56 offen offset:0
buffer_load_dword v49,v5,s[4:7],s56 offen offset:1024
buffer_load_dword v50,v5,s[4:7],s56 offen offset:2048
buffer_load_dword v51,v5,s[4:7],s56 offen offset:3072
s_add_u32 s56,s59,114688
buffer_load_dword v52,v5,s[4:7],s56 offen offset:0
buffer_load_dword v53,v5,s[4:7],s56 offen offset:1024
buffer_load_dword v54,v5,s[4:7],s56 offen offset:2048
buffer_load_dword v55,v5,s[4:7],s56 offen offset:3072
s_add_u32 s56,s59,256
buffer_load_dword v56,v5,s[4:7],s56 offen offset:0
buffer_load_dword v57,v5,s[4:7],s56 offen offset:1024
buffer_load_dword v58,v5,s[4:7],s56 offen offset:2048
buffer_load_dword v59,v5,s[4:7],s56 offen offset:3072
s_add_u32 s56,s59,16640
buffer_load_dword v60,v5,s[4:7],s56 offen offset:0
buffer_load_dword v61,v5,s[4:7],s56 offen offset:1024
buffer_load_dword v62,v5,s[4:7],s56 offen offset:2048
buffer_load_dword v63,v5,s[4:7],s56 offen offset:3072
s_add_u32 s56,s59,33024
buffer_load_dword v64,v5,s[4:7],s56 offen offset:0
buffer_load_dword v65,v5,s[4:7],s56 offen offset:1024
buffer_load_dword v66,v5,s[4:7],s56 offen offset:2048
buffer_load_dword v67,v5,s[4:7],s56 offen offset:3072
s_add_u32 s56,s59,49408
buffer_load_dword v68,v5,s[4:7],s56 offen offset:0
buffer_load_dword v69,v5,s[4:7],s56 offen offset:1024
buffer_load_dword v70,v5,s[4:7],s56 offen offset:2048
buffer_load_dword v71,v5,s[4:7],s56 offen offset:3072
s_add_u32 s56,s59,65792
buffer_load_dword v72,v5,s[4:7],s56 offen offset:0
buffer_load_dword v73,v5,s[4:7],s56 offen offset:1024
buffer_load_dword v74,v5,s[4:7],s56 offen offset:2048
buffer_load_dword v75,v5,s[4:7],s56 offen offset:3072
s_add_u32 s56,s59,82176
buffer_load_dword v76,v5,s[4:7],s56 offen offset:0
buffer_load_dword v77,v5,s[4:7],s56 offen offset:1024
buffer_load_dword v78,v5,s[4:7],s56 offen offset:2048
buffer_load_dword v79,v5,s[4:7],s56 offen offset:3072
s_waitcnt vmcnt(48)
ds_write_b128 v6,v[24:27] offset:0
ds_write_b128 v6,v[28:31] offset:1024
s_waitcnt lgkmcnt(0)
s_add_u32 s56,s59,98560
buffer_load_dword v24,v5,s[4:7],s56 offen offset:0
buffer_load_dword v25,v5,s[4:7],s56 offen offset:1024
buffer_load_dword v26,v5,s[4:7],s56 offen offset:2048
buffer_load_dword v27,v5,s[4:7],s56 offen offset:3072
s_add_u32 s56,s59,114944
buffer_load_dword v28,v5,s[4:7],s56 offen offset:0
buffer_load_dword v29,v5,s[4:7],s56 offen offset:1024
buffer_load_dword v30,v5,s[4:7],s56 offen offset:2048
buffer_load_dword v31,v5,s[4:7],s56 offen offset:3072
s_waitcnt vmcnt(48)
ds_write_b128 v6,v[32:35] offset:2048
ds_write_b128 v6,v[36:39] offset:3072
s_waitcnt lgkmcnt(0)
s_add_u32 s56,s59,512
buffer_load_dword v32,v5,s[4:7],s56 offen offset:0
buffer_load_dword v33,v5,s[4:7],s56 offen offset:1024
buffer_load_dword v34,v5,s[4:7],s56 offen offset:2048
buffer_load_dword v35,v5,s[4:7],s56 offen offset:3072
s_add_u32 s56,s59,16896
buffer_load_dword v36,v5,s[4:7],s56 offen offset:0
buffer_load_dword v37,v5,s[4:7],s56 offen offset:1024
buffer_load_dword v38,v5,s[4:7],s56 offen offset:2048
buffer_load_dword v39,v5,s[4:7],s56 offen offset:3072
s_waitcnt vmcnt(48)
ds_write_b128 v6,v[40:43] offset:4096
ds_write_b128 v6,v[44:47] offset:5120
s_waitcnt lgkmcnt(0)
s_add_u32 s56,s59,33280
buffer_load_dword v40,v5,s[4:7],s56 offen offset:0
buffer_load_dword v41,v5,s[4:7],s56 offen offset:1024
buffer_load_dword v42,v5,s[4:7],s56 offen offset:2048
buffer_load_dword v43,v5,s[4:7],s56 offen offset:3072
s_add_u32 s56,s59,49664
buffer_load_dword v44,v5,s[4:7],s56 offen offset:0
buffer_load_dword v45,v5,s[4:7],s56 offen offset:1024
buffer_load_dword v46,v5,s[4:7],s56 offen offset:2048
buffer_load_dword v47,v5,s[4:7],s56 offen offset:3072
s_waitcnt vmcnt(48)
ds_write_b128 v6,v[48:51] offset:6144
ds_write_b128 v6,v[52:55] offset:7168
s_waitcnt lgkmcnt(0)
s_add_u32 s56,s59,66048
buffer_load_dword v48,v5,s[4:7],s56 offen offset:0
buffer_load_dword v49,v5,s[4:7],s56 offen offset:1024
buffer_load_dword v50,v5,s[4:7],s56 offen offset:2048
buffer_load_dword v51,v5,s[4:7],s56 offen offset:3072
s_add_u32 s56,s59,82432
buffer_load_dword v52,v5,s[4:7],s56 offen offset:0
buffer_load_dword v53,v5,s[4:7],s56 offen offset:1024
buffer_load_dword v54,v5,s[4:7],s56 offen offset:2048
buffer_load_dword v55,v5,s[4:7],s56 offen offset:3072
s_waitcnt vmcnt(48)
ds_write_b128 v6,v[56:59] offset:8192
ds_write_b128 v6,v[60:63] offset:9216
s_waitcnt lgkmcnt(0)
s_add_u32 s56,s59,98816
buffer_load_dword v56,v5,s[4:7],s56 offen offset:0
buffer_load_dword v57,v5,s[4:7],s56 offen offset:1024
buffer_load_dword v58,v5,s[4:7],s56 offen offset:2048
buffer_load_dword v59,v5,s[4:7],s56 offen offset:3072
s_add_u32 s56,s59,115200
buffer_load_dword v60,v5,s[4:7],s56 offen offset:0
buffer_load_dword v61,v5,s[4:7],s56 offen offset:1024
buffer_load_dword v62,v5,s[4:7],s56 offen offset:2048
buffer_load_dword v63,v5,s[4:7],s56 offen offset:3072
s_waitcnt vmcnt(48)
ds_write_b128 v6,v[64:67] offset:10240
ds_write_b128 v6,v[68:71] offset:11264
s_waitcnt lgkmcnt(0)
s_add_u32 s56,s59,768
buffer_load_dword v64,v5,s[4:7],s56 offen offset:0
buffer_load_dword v65,v5,s[4:7],s56 offen offset:1024
buffer_load_dword v66,v5,s[4:7],s56 offen offset:2048
buffer_load_dword v67,v5,s[4:7],s56 offen offset:3072
s_add_u32 s56,s59,17152
buffer_load_dword v68,v5,s[4:7],s56 offen offset:0
buffer_load_dword v69,v5,s[4:7],s56 offen offset:1024
buffer_load_dword v70,v5,s[4:7],s56 offen offset:2048
buffer_load_dword v71,v5,s[4:7],s56 offen offset:3072
s_waitcnt vmcnt(48)
ds_write_b128 v6,v[72:75] offset:12288
ds_write_b128 v6,v[76:79] offset:13312
s_waitcnt lgkmcnt(0)
s_add_u32 s56,s59,33536
buffer_load_dword v72,v5,s[4:7],s56 offen offset:0
buffer_load_dword v73,v5,s[4:7],s56 offen offset:1024
buffer_load_dword v74,v5,s[4:7],s56 offen offset:2048
buffer_load_dword v75,v5,s[4:7],s56 offen offset:3072
s_add_u32 s56,s59,49920
buffer_load_dword v76,v5,s[4:7],s56 offen offset:0
buffer_load_dword v77,v5,s[4:7],s56 offen offset:1024
buffer_load_dword v78,v5,s[4:7],s56 offen offset:2048
buffer_load_dword v79,v5,s[4:7],s56 offen offset:3072
s_waitcnt vmcnt(48)
ds_write_b128 v6,v[24:27] offset:14336
ds_write_b128 v6,v[28:31] offset:15360
s_waitcnt lgkmcnt(0)
s_add_u32 s56,s59,66304
buffer_load_dword v24,v5,s[4:7],s56 offen offset:0
buffer_load_dword v25,v5,s[4:7],s56 offen offset:1024
buffer_load_dword v26,v5,s[4:7],s56 offen offset:2048
buffer_load_dword v27,v5,s[4:7],s56 offen offset:3072
s_add_u32 s56,s59,82688
buffer_load_dword v28,v5,s[4:7],s56 offen offset:0
buffer_load_dword v29,v5,s[4:7],s56 offen offset:1024
buffer_load_dword v30,v5,s[4:7],s56 offen offset:2048
buffer_load_dword v31,v5,s[4:7],s56 offen offset:3072
s_waitcnt vmcnt(48)
ds_write_b128 v6,v[32:35] offset:16384
ds_write_b128 v6,v[36:39] offset:17408
s_waitcnt lgkmcnt(0)
s_add_u32 s56,s59,99072
buffer_load_dword v32,v5,s[4:7],s56 offen offset:0
buffer_load_dword v33,v5,s[4:7],s56 offen offset:1024
buffer_load_dword v34,v5,s[4:7],s56 offen offset:2048
buffer_load_dword v35,v5,s[4:7],s56 offen offset:3072
s_add_u32 s56,s59,115456
buffer_load_dword v36,v5,s[4:7],s56 offen offset:0
buffer_load_dword v37,v5,s[4:7],s56 offen offset:1024
buffer_load_dword v38,v5,s[4:7],s56 offen offset:2048
buffer_load_dword v39,v5,s[4:7],s56 offen offset:3072
s_waitcnt vmcnt(48)
ds_write_b128 v6,v[40:43] offset:18432
ds_write_b128 v6,v[44:47] offset:19456
s_waitcnt lgkmcnt(0)
s_waitcnt vmcnt(40)
ds_write_b128 v6,v[48:51] offset:20480
ds_write_b128 v6,v[52:55] offset:21504
s_waitcnt lgkmcnt(0)
s_waitcnt vmcnt(32)
ds_write_b128 v6,v[56:59] offset:22528
ds_write_b128 v6,v[60:63] offset:23552
s_waitcnt lgkmcnt(0)
s_waitcnt vmcnt(24)
ds_write_b128 v6,v[64:67] offset:24576
ds_write_b128 v6,v[68:71] offset:25600
s_waitcnt lgkmcnt(0)
s_waitcnt vmcnt(16)
ds_write_b128 v6,v[72:75] offset:26624
ds_write_b128 v6,v[76:79] offset:27648
s_waitcnt lgkmcnt(0)
s_waitcnt vmcnt(8)
ds_write_b128 v6,v[24:27] offset:28672
ds_write_b128 v6,v[28:31] offset:29696
s_waitcnt lgkmcnt(0)
s_waitcnt vmcnt(0)
ds_write_b128 v6,v[32:35] offset:30720
ds_write_b128 v6,v[36:39] offset:31744
s_waitcnt lgkmcnt(0)
v_mov_b32 v123,159744
s_cmp_lg_u32 s46,0
s_cbranch_scc1 L_gbd_128
v_mov_b32 v124,128
L_gb_127:
buffer_load_dword v125,v124,s[12:15],0 offen sc1
s_waitcnt vmcnt(0)
v_readfirstlane_b32 s56,v125
ds_write_b32 v123,v125
s_bitcmp1_b32 s56,8
s_cbranch_scc1 L_gbd_128
s_sleep 4
s_sub_u32 s49,s49,1
s_cmp_gt_i32 s49,0
s_cbranch_scc1 L_gb_127
s_branch L_abort
L_gbd_128:
s_waitcnt lgkmcnt(0)
s_barrier
ds_read_b32 v125,v123
s_waitcnt lgkmcnt(0)
v_readfirstlane_b32 s56,v125
s_barrier
s_lshr_b32 s56,s56,16
s_andn2_b32 s56,s56,s3
s_cbranch_scc1 L_spread
s_cmp_eq_u32 s48,0
s_cbranch_scc1 L_chd_129
v_and_b32 v120,15,v1
v_lshrrev_b32 v121,4,v1
v_mov_b32 v17,1
s_lshl_b32 s56,s46,2
v_add_u32 v125,s56,v121
v_xor_b32 v126,v125,v120
v_lshlrev_b32 v126,4,v126
v_lshl_add_u32 v20,v125,10,v126
s_lshl_b32 s56,s46,1
s_xor_b32 s56,s56,0
s_and_b32 s57,s56,3
s_lshl_b32 s57,s57,2
s_lshr_b32 s56,s56,2
s_lshl_b32 s56,s56,13
s_add_u32 s56,s56,131072
v_add_u32 v125,s57,v121
v_xor_b32 v125,v125,v120
v_lshlrev_b32 v125,4,v125
v_lshl_add_u32 v125,v120,8,v125
v_add_u32 v4,s56,v125
s_lshl_b32 s56,s46,1
s_xor_b32 s56,s56,1
s_and_b32 s57,s56,3
s_lshl_b32 s57,s57,2
s_lshr_b32 s56,s56,2
s_lshl_b32 s56,s56,13
s_add_u32 s56,s56,131072
v_add_u32 v125,s57,v121
v_xor_b32 v125,v125,v120
v_lshlrev_b32 v125,4,v125
v_lshl_add_u32 v125,v120,8,v125
v_add_u32 v5,s56,v125
s_lshl_b32 s56,s46,1
s_xor_b32 s56,s56,2
s_and_b32 s57,s56,3
s_lshl_b32 s57,s57,2
s_lshr_b32 s56,s56,2
s_lshl_b32 s56,s56,13
s_add_u32 s56,s56,131072
v_add_u32 v125,s57,v121
v_xor_b32 v125,v125,v120
v_lshlrev_b32 v125,4,v125
v_lshl_add_u32 v125,v120,8,v125
v_add_u32 v6,s56,v125
s_lshl_b32 s56,s46,1
s_xor_b32 s56,s56,3
s_and_b32 s57,s56,3
s_lshl_b32 s57,s57,2
s_lshr_b32 s56,s56,2
s_lshl_b32 s56,s56,13
s_add_u32 s56,s56,131072
v_add_u32 v125,s57,v121
v_xor_b32 v125,v125,v120
v_lshlrev_b32 v125,4,v125
v_lshl_add_u32 v125,v120,8,v125
v_add_u32 v7,s56,v125
s_lshl_b32 s56,s46,1
s_xor_b32 s56,s56,4
s_and_b32 s57,s56,3
s_lshl_b32 s57,s57,2
s_lshr_b32 s56,s56,2
s_lshl_b32 s56,s56,13
s_add_u32 s56,s56,131072
v_add_u32 v125,s57,v121
v_xor_b32 v125,v125,v120
v_lshlrev_b32 v125,4,v125
v_lshl_add_u32 v125,v120,8,v125
v_add_u32 v8,s56,v125
s_lshl_b32 s56,s46,1
s_xor_b32 s56,s56,5
s_and_b32 s57,s56,3
s_lshl_b32 s57,s57,2
s_lshr_b32 s56,s56,2
s_lshl_b32 s56,s56,13
s_add_u32 s56,s56,131072
v_add_u32 v125,s57,v121
v_xor_b32 v125,v125,v120
v_lshlrev_b32 v125,4,v125
v_lshl_add_u32 v125,v120,8,v125
v_add_u32 v9,s56,v125
s_lshl_b32 s56,s46,1
s_xor_b32 s56,s56,6
s_and_b32 s57,s56,3
s_lshl_b32 s57,s57,2
s_lshr_b32 s56,s56,2
s_lshl_b32 s56,s56,13
s_add_u32 s56,s56,131072
v_add_u32 v125,s57,v121
v_xor_b32 v125,v125,v120
v_lshlrev_b32 v125,4,v125
v_lshl_add_u32 v125,v120,8,v125
v_add_u32 v10,s56,v125
s_lshl_b32 s56,s46,1
s_xor_b32 s56,s56,7
s_and_b32 s57,s56,3
s_lshl_b32 s57,s57,2
s_lshr_b32 s56,s56,2
s_lshl_b32 s56,s56,13
s_add_u32 s56,s56,131072
v_add_u32 v125,s57,v121
v_xor_b32 v125,v125,v120
v_lshlrev_b32 v125,4,v125
v_lshl_add_u32 v125,v120,8,v125
v_add_u32 v11,s56,v125
s_cmp_eq_u32 s48,1
s_cselect_b32 s51,14,18
s_cselect_b32 s53,4,6
s_mov_b32 s72,0x80000000
s_lshl_b32 s70,s51,15
s_add_u32 s70,s70,0
s_add_u32 s71,s70,16384
s_add_u32 m0,s50,131072
s_nop 0
buffer_load_dwordx4 v20,s[8:11],s70 offen offset:0 sc1 lds
s_add_u32 m0,s50,135168
s_nop 0
buffer_load_dwordx4 v20,s[8:11],s71 offen offset:0 sc1 lds
s_add_u32 m0,s50,139008
s_nop 0
buffer_load_dwordx4 v20,s[8:11],s70 offen offset:256 sc1 lds
s_add_u32 m0,s50,143104
s_nop 0
buffer_load_dwordx4 v20,s[8:11],s71 offen offset:256 sc1 lds
s_waitcnt vmcnt(0)
L_chl_130:
s_mov_b64 s[68:69],s[70:71]
s_add_u32 s70,s70,32768
s_add_u32 s71,s71,32768
s_lshl_b32 s58,s51,5
s_add_u32 s58,s58,s47
s_mul_i32 s58,s58,24576
s_add_u32 s58,s58,100663296
s_add_u32 s61,s58,s50
s_add_u32 s62,s61,4096
s_add_u32 s63,s61,16384
s_add_u32 s64,s61,20480
s_add_u32 s65,s61,s50
s_add_u32 s65,s65,8192
s_waitcnt vmcnt(7)
s_barrier
ds_read_b128 v[72:75],v4 offset:0
ds_read_b128 v[76:79],v4 offset:4096
ds_read_b128 v[80:83],v5 offset:0
ds_read_b128 v[84:87],v5 offset:4096
s_add_u32 m0,s50,146944
s_nop 0
buffer_load_dwordx4 v20,s[8:11],s68 offen offset:512 sc1 lds
s_add_u32 m0,s50,151040
s_nop 0
buffer_load_dwordx4 v20,s[8:11],s69 offen offset:512 sc1 lds
s_add_u32 m0,s50,154880
s_nop 0
buffer_load_dwordx4 v20,s[8:11],s68 offen offset:768 sc1 lds
s_add_u32 m0,s50,158976
s_nop 0
buffer_load_dwordx4 v20,s[8:11],s69 offen offset:768 sc1 lds
s_waitcnt lgkmcnt(2)
v_mfma_f32_16x16x32_bf16 v[40:43],a[128:131],v[72:75],0
ds_read_b128 v[108:111],v6 offset:0
v_mfma_f32_16x16x32_bf16 v[56:59],v[72:75],v[128:131],0
v_mfma_f32_16x16x32_bf16 v[24:27],a[0:3],v[72:75],0
ds_read_b128 v[112:115],v6 offset:4096
v_mfma_f32_16x16x32_bf16 v[44:47],a[128:131],v[76:79],0
v_mfma_f32_16x16x32_bf16 v[60:63],v[76:79],v[128:131],0
v_mfma_f32_16x16x32_bf16 v[28:31],a[0:3],v[76:79],0
v_mfma_f32_16x16x32_bf16 v[48:51],a[136:139],v[72:75],0
v_mfma_f32_16x16x32_bf16 v[64:67],v[72:75],v[136:139],0
v_mfma_f32_16x16x32_bf16 v[32:35],a[8:11],v[72:75],0
v_mfma_f32_16x16x32_bf16 v[52:55],a[136:139],v[76:79],0
v_mfma_f32_16x16x32_bf16 v[68:71],v[76:79],v[136:139],0
v_mfma_f32_16x16x32_bf16 v[36:39],a[8:11],v[76:79],0
s_waitcnt lgkmcnt(2)
v_mfma_f32_16x16x32_bf16 v[40:43],a[132:135],v[80:83],v[40:43]
ds_read_b128 v[72:75],v7 offset:0
v_mfma_f32_16x16x32_bf16 v[56:59],v[80:83],v[132:135],v[56:59]
v_mfma_f32_16x16x32_bf16 v[24:27],a[4:7],v[80:83],v[24:27]
ds_read_b128 v[76:79],v7 offset:4096
v_mfma_f32_16x16x32_bf16 v[44:47],a[132:135],v[84:87],v[44:47]
v_mfma_f32_16x16x32_bf16 v[60:63],v[84:87],v[132:135],v[60:63]
v_mfma_f32_16x16x32_bf16 v[28:31],a[4:7],v[84:87],v[28:31]
v_mfma_f32_16x16x32_bf16 v[48:51],a[140:143],v[80:83],v[48:51]
v_mfma_f32_16x16x32_bf16 v[64:67],v[80:83],v[140:143],v[64:67]
v_mfma_f32_16x16x32_bf16 v[32:35],a[12:15],v[80:83],v[32:35]
v_mfma_f32_16x16x32_bf16 v[52:55],a[140:143],v[84:87],v[52:55]
v_mfma_f32_16x16x32_bf16 v[68:71],v[84:87],v[140:143],v[68:71]
v_mfma_f32_16x16x32_bf16 v[36:39],a[12:15],v[84:87],v[36:39]
s_waitcnt lgkmcnt(2)
v_mfma_f32_16x16x32_bf16 v[40:43],a[144:147],v[108:111],v[40:43]
ds_read_b128 v[80:83],v8 offset:0
v_mfma_f32_16x16x32_bf16 v[56:59],v[108:111],v[144:147],v[56:59]
v_mfma_f32_16x16x32_bf16 v[24:27],a[16:19],v[108:111],v[24:27]
ds_read_b128 v[84:87],v8 offset:4096
v_mfma_f32_16x16x32_bf16 v[44:47],a[144:147],v[112:115],v[44:47]
v_mfma_f32_16x16x32_bf16 v[60:63],v[112:115],v[144:147],v[60:63]
v_mfma_f32_16x16x32_bf16 v[28:31],a[16:19],v[112:115],v[28:31]
v_mfma_f32_16x16x32_bf16 v[48:51],a[152:155],v[108:111],v[48:51]
v_mfma_f32_16x16x32_bf16 v[64:67],v[108:111],v[152:155],v[64:67]
v_mfma_f32_16x16x32_bf16 v[32:35],a[24:27],v[108:111],v[32:35]
v_mfma_f32_16x16x32_bf16 v[52:55],a[152:155],v[112:115],v[52:55]
v_mfma_f32_16x16x32_bf16 v[68:71],v[112:115],v[152:155],v[68:71]
v_mfma_f32_16x16x32_bf16 v[36:39],a[24:27],v[112:115],v[36:39]
s_waitcnt lgkmcnt(2)
v_mfma_f32_16x16x32_bf16 v[40:43],a[148:151],v[72:75],v[40:43]
ds_read_b128 v[108:111],v9 offset:0
v_mfma_f32_16x16x32_bf16 v[56:59],v[72:75],v[148:151],v[56:59]
v_mfma_f32_16x16x32_bf16 v[24:27],a[20:23],v[72:75],v[24:27]
ds_read_b128 v[112:115],v9 offset:4096
v_mfma_f32_16x16x32_bf16 v[44:47],a[148:151],v[76:79],v[44:47]
v_mfma_f32_16x16x32_bf16 v[60:63],v[76:79],v[148:151],v[60:63]
v_mfma_f32_16x16x32_bf16 v[28:31],a[20:23],v[76:79],v[28:31]
v_mfma_f32_16x16x32_bf16 v[48:51],a[156:159],v[72:75],v[48:51]
v_mfma_f32_16x16x32_bf16 v[64:67],v[72:75],v[156:159],v[64:67]
v_mfma_f32_16x16x32_bf16 v[32:35],a[28:31],v[72:75],v[32:35]
v_mfma_f32_16x16x32_bf16 v[52:55],a[156:159],v[76:79],v[52:55]
v_mfma_f32_16x16x32_bf16 v[68:71],v[76:79],v[156:159],v[68:71]
v_mfma_f32_16x16x32_bf16 v[36:39],a[28:31],v[76:79],v[36:39]
s_waitcnt lgkmcnt(2)
v_mfma_f32_16x16x32_bf16 v[40:43],a[160:163],v[80:83],v[40:43]
ds_read_b128 v[72:75],v10 offset:0
v_mfma_f32_16x16x32_bf16 v[56:59],v[80:83],v[160:163],v[56:59]
v_mfma_f32_16x16x32_bf16 v[24:27],a[32:35],v[80:83],v[24:27]
ds_read_b128 v[76:79],v10 offset:4096
v_mfma_f32_16x16x32_bf16 v[44:47],a[160:163],v[84:87],v[44:47]
v_mfma_f32_16x16x32_bf16 v[60:63],v[84:87],v[160:163],v[60:63]
v_mfma_f32_16x16x32_bf16 v[28:31],a[32:35],v[84:87],v[28:31]
v_mfma_f32_16x16x32_bf16 v[48:51],a[168:171],v[80:83],v[48:51]
v_mfma_f32_16x16x32_bf16 v[64:67],v[80:83],v[168:171],v[64:67]
v_mfma_f32_16x16x32_bf16 v[32:35],a[40:43],v[80:83],v[32:35]
v_mfma_f32_16x16x32_bf16 v[52:55],a[168:171],v[84:87],v[52:55]
v_mfma_f32_16x16x32_bf16 v[68:71],v[84:87],v[168:171],v[68:71]
v_mfma_f32_16x16x32_bf16 v[36:39],a[40:43],v[84:87],v[36:39]
s_waitcnt lgkmcnt(2)
v_mfma_f32_16x16x32_bf16 v[40:43],a[164:167],v[108:111],v[40:43]
ds_read_b128 v[80:83],v11 offset:0
v_mfma_f32_16x16x32_bf16 v[56:59],v[108:111],v[164:167],v[56:59]
v_mfma_f32_16x16x32_bf16 v[24:27],a[36:39],v[108:111],v[24:27]
ds_read_b128 v[84:87],v11 offset:4096
v_mfma_f32_16x16x32_bf16 v[44:47],a[164:167],v[112:115],v[44:47]
v_mfma_f32_16x16x32_bf16 v[60:63],v[112:115],v[164:167],v[60:63]
v_mfma_f32_16x16x32_bf16 v[28:31],a[36:39],v[112:115],v[28:31]
v_mfma_f32_16x16x32_bf16 v[48:51],a[172:175],v[108:111],v[48:51]
v_mfma_f32_16x16x32_bf16 v[64:67],v[108:111],v[172:175],v[64:67]
v_mfma_f32_16x16x32_bf16 v[32:35],a[44:47],v[108:111],v[32:35]
v_mfma_f32_16x16x32_bf16 v[52:55],a[172:175],v[112:115],v[52:55]
v_mfma_f32_16x16x32_bf16 v[68:71],v[112:115],v[172:175],v[68:71]
v_mfma_f32_16x16x32_bf16 v[36:39],a[44:47],v[112:115],v[36:39]
s_waitcnt vmcnt(0)
s_barrier
s_or_b32 s72,s72,s52
buffer_store_dword v17,off,s[8:11],s72 sc1
s_waitcnt lgkmcnt(2)
v_mfma_f32_16x16x32_bf16 v[40:43],a[176:179],v[72:75],v[40:43]
ds_read_b128 v[108:111],v4 offset:16384
v_mfma_f32_16x16x32_bf16 v[56:59],v[72:75],v[176:179],v[56:59]
v_mfma_f32_16x16x32_bf16 v[24:27],a[48:51],v[72:75],v[24:27]
ds_read_b128 v[112:115],v4 offset:20480
v_mfma_f32_16x16x32_bf16 v[44:47],a[176:179],v[76:79],v[44:47]
v_mfma_f32_16x16x32_bf16 v[60:63],v[76:79],v[176:179],v[60:63]
v_mfma_f32_16x16x32_bf16 v[28:31],a[48:51],v[76:79],v[28:31]
v_mfma_f32_16x16x32_bf16 v[48:51],a[184:187],v[72:75],v[48:51]
v_mfma_f32_16x16x32_bf16 v[64:67],v[72:75],v[184:187],v[64:67]
v_mfma_f32_16x16x32_bf16 v[32:35],a[56:59],v[72:75],v[32:35]
v_mfma_f32_16x16x32_bf16 v[52:55],a[184:187],v[76:79],v[52:55]
v_mfma_f32_16x16x32_bf16 v[68:71],v[76:79],v[184:187],v[68:71]
v_mfma_f32_16x16x32_bf16 v[36:39],a[56:59],v[76:79],v[36:39]
s_waitcnt lgkmcnt(2)
v_mfma_f32_16x16x32_bf16 v[40:43],a[180:183],v[80:83],v[40:43]
ds_read_b128 v[72:75],v5 offset:16384
v_mfma_f32_16x16x32_bf16 v[56:59],v[80:83],v[180:183],v[56:59]
v_mfma_f32_16x16x32_bf16 v[24:27],a[52:55],v[80:83],v[24:27]
ds_read_b128 v[76:79],v5 offset:20480
v_mfma_f32_16x16x32_bf16 v[44:47],a[180:183],v[84:87],v[44:47]
v_mfma_f32_16x16x32_bf16 v[60:63],v[84:87],v[180:183],v[60:63]
v_mfma_f32_16x16x32_bf16 v[28:31],a[52:55],v[84:87],v[28:31]
v_mfma_f32_16x16x32_bf16 v[48:51],a[188:191],v[80:83],v[48:51]
v_mfma_f32_16x16x32_bf16 v[64:67],v[80:83],v[188:191],v[64:67]
v_mfma_f32_16x16x32_bf16 v[32:35],a[60:63],v[80:83],v[32:35]
v_mfma_f32_16x16x32_bf16 v[52:55],a[188:191],v[84:87],v[52:55]
v_mfma_f32_16x16x32_bf16 v[68:71],v[84:87],v[188:191],v[68:71]
v_mfma_f32_16x16x32_bf16 v[36:39],a[60:63],v[84:87],v[36:39]
s_waitcnt lgkmcnt(2)
v_mfma_f32_16x16x32_bf16 v[40:43],a[192:195],v[108:111],v[40:43]
ds_read_b128 v[80:83],v6 offset:16384
v_mfma_f32_16x16x32_bf16 v[56:59],v[108:111],v[192:195],v[56:59]
v_mfma_f32_16x16x32_bf16 v[24:27],a[64:67],v[108:111],v[24:27]
ds_read_b128 v[84:87],v6 offset:20480
v_mfma_f32_16x16x32_bf16 v[44:47],a[192:195],v[112:115],v[44:47]
v_mfma_f32_16x16x32_bf16 v[60:63],v[112:115],v[192:195],v[60:63]
v_mfma_f32_16x16x32_bf16 v[28:31],a[64:67],v[112:115],v[28:31]
v_mfma_f32_16x16x32_bf16 v[48:51],a[200:203],v[108:111],v[48:51]
v_mfma_f32_16x16x32_bf16 v[64:67],v[108:111],v[200:203],v[64:67]
v_mfma_f32_16x16x32_bf16 v[32:35],a[72:75],v[108:111],v[32:35]
v_mfma_f32_16x16x32_bf16 v[52:55],a[200:203],v[112:115],v[52:55]
v_mfma_f32_16x16x32_bf16 v[68:71],v[112:115],v[200:203],v[68:71]
v_mfma_f32_16x16x32_bf16 v[36:39],a[72:75],v[112:115],v[36:39]
s_waitcnt lgkmcnt(2)
v_mfma_f32_16x16x32_bf16 v[40:43],a[196:199],v[72:75],v[40:43]
ds_read_b128 v[108:111],v7 offset:16384
v_mfma_f32_16x16x32_bf16 v[56:59],v[72:75],v[196:199],v[56:59]
v_mfma_f32_16x16x32_bf16 v[24:27],a[68:71],v[72:75],v[24:27]
ds_read_b128 v[112:115],v7 offset:20480
v_mfma_f32_16x16x32_bf16 v[44:47],a[196:199],v[76:79],v[44:47]
v_mfma_f32_16x16x32_bf16 v[60:63],v[76:79],v[196:199],v[60:63]
v_mfma_f32_16x16x32_bf16 v[28:31],a[68:71],v[76:79],v[28:31]
v_mfma_f32_16x16x32_bf16 v[48:51],a[204:207],v[72:75],v[48:51]
v_mfma_f32_16x16x32_bf16 v[64:67],v[72:75],v[204:207],v[64:67]
v_mfma_f32_16x16x32_bf16 v[32:35],a[76:79],v[72:75],v[32:35]
v_mfma_f32_16x16x32_bf16 v[52:55],a[204:207],v[76:79],v[52:55]
v_mfma_f32_16x16x32_bf16 v[68:71],v[76:79],v[204:207],v[68:71]
v_mfma_f32_16x16x32_bf16 v[36:39],a[76:79],v[76:79],v[36:39]
s_waitcnt lgkmcnt(2)
v_mfma_f32_16x16x32_bf16 v[40:43],a[208:211],v[80:83],v[40:43]
ds_read_b128 v[72:75],v8 offset:16384
v_mfma_f32_16x16x32_bf16 v[56:59],v[80:83],v[208:211],v[56:59]
v_mfma_f32_16x16x32_bf16 v[24:27],a[80:83],v[80:83],v[24:27]
ds_read_b128 v[76:79],v8 offset:20480
v_mfma_f32_16x16x32_bf16 v[44:47],a[208:211],v[84:87],v[44:47]
v_mfma_f32_16x16x32_bf16 v[60:63],v[84:87],v[208:211],v[60:63]
v_mfma_f32_16x16x32_bf16 v[28:31],a[80:83],v[84:87],v[28:31]
v_mfma_f32_16x16x32_bf16 v[48:51],a[216:219],v[80:83],v[48:51]
v_mfma_f32_16x16x32_bf16 v[64:67],v[80:83],v[216:219],v[64:67]
v_mfma_f32_16x16x32_bf16 v[32:35],a[88:91],v[80:83],v[32:35]
v_mfma_f32_16x16x32_bf16 v[52:55],a[216:219],v[84:87],v[52:55]
v_mfma_f32_16x16x32_bf16 v[68:71],v[84:87],v[216:219],v[68:71]
v_mfma_f32_16x16x32_bf16 v[36:39],a[88:91],v[84:87],v[36:39]
s_waitcnt lgkmcnt(2)
v_mfma_f32_16x16x32_bf16 v[40:43],a[212:215],v[108:111],v[40:43]
ds_read_b128 v[80:83],v9 offset:16384
v_mfma_f32_16x16x32_bf16 v[56:59],v[108:111],v[212:215],v[56:59]
v_mfma_f32_16x16x32_bf16 v[24:27],a[84:87],v[108:111],v[24:27]
ds_read_b128 v[84:87],v9 offset:20480
v_mfma_f32_16x16x32_bf16 v[44:47],a[212:215],v[112:115],v[44:47]
v_mfma_f32_16x16x32_bf16 v[60:63],v[112:115],v[212:215],v[60:63]
v_mfma_f32_16x16x32_bf16 v[28:31],a[84:87],v[112:115],v[28:31]
v_mfma_f32_16x16x32_bf16 v[48:51],a[220:223],v[108:111],v[48:51]
v_mfma_f32_16x16x32_bf16 v[64:67],v[108:111],v[220:223],v[64:67]
v_mfma_f32_16x16x32_bf16 v[32:35],a[92:95],v[108:111],v[32:35]
v_mfma_f32_16x16x32_bf16 v[52:55],a[220:223],v[112:115],v[52:55]
v_mfma_f32_16x16x32_bf16 v[68:71],v[112:115],v[220:223],v[68:71]
v_mfma_f32_16x16x32_bf16 v[36:39],a[92:95],v[112:115],v[36:39]
s_barrier
s_waitcnt lgkmcnt(2)
v_mfma_f32_16x16x32_bf16 v[40:43],a[224:227],v[72:75],v[40:43]
ds_read_b128 v[108:111],v10 offset:16384
v_mfma_f32_16x16x32_bf16 v[56:59],v[72:75],v[224:227],v[56:59]
s_add_u32 m0,s50,131072
v_mfma_f32_16x16x32_bf16 v[24:27],a[96:99],v[72:75],v[24:27]
ds_read_b128 v[112:115],v10 offset:20480
v_mfma_f32_16x16x32_bf16 v[44:47],a[224:227],v[76:79],v[44:47]
buffer_load_dwordx4 v20,s[8:11],s70 offen offset:0 sc1 lds
v_mfma_f32_16x16x32_bf16 v[60:63],v[76:79],v[224:227],v[60:63]
s_add_u32 m0,s50,135168
v_mfma_f32_16x16x32_bf16 v[28:31],a[96:99],v[76:79],v[28:31]
buffer_load_dwordx4 v20,s[8:11],s71 offen offset:0 sc1 lds
v_mfma_f32_16x16x32_bf16 v[48:51],a[232:235],v[72:75],v[48:51]
s_add_u32 m0,s50,139008
v_mfma_f32_16x16x32_bf16 v[64:67],v[72:75],v[232:235],v[64:67]
buffer_load_dwordx4 v20,s[8:11],s70 offen offset:256 sc1 lds
v_mfma_f32_16x16x32_bf16 v[32:35],a[104:107],v[72:75],v[32:35]
s_add_u32 m0,s50,143104
v_mfma_f32_16x16x32_bf16 v[52:55],a[232:235],v[76:79],v[52:55]
buffer_load_dwordx4 v20,s[8:11],s71 offen offset:256 sc1 lds
v_mfma_f32_16x16x32_bf16 v[68:71],v[76:79],v[232:235],v[68:71]
v_mfma_f32_16x16x32_bf16 v[36:39],a[104:107],v[76:79],v[36:39]
s_waitcnt lgkmcnt(2)
v_mfma_f32_16x16x32_bf16 v[40:43],a[228:231],v[80:83],v[40:43]
ds_read_b128 v[72:75],v11 offset:16384
v_mfma_f32_16x16x32_bf16 v[56:59],v[80:83],v[228:231],v[56:59]
v_mfma_f32_16x16x32_bf16 v[24:27],a[100:103],v[80:83],v[24:27]
ds_read_b128 v[76:79],v11 offset:20480
v_mfma_f32_16x16x32_bf16 v[44:47],a[228:231],v[84:87],v[44:47]
v_mfma_f32_16x16x32_bf16 v[60:63],v[84:87],v[228:231],v[60:63]
v_mfma_f32_16x16x32_bf16 v[28:31],a[100:103],v[84:87],v[28:31]
v_mfma_f32_16x16x32_bf16 v[48:51],a[236:239],v[80:83],v[48:51]
v_mfma_f32_16x16x32_bf16 v[64:67],v[80:83],v[236:239],v[64:67]
v_mfma_f32_16x16x32_bf16 v[32:35],a[108:111],v[80:83],v[32:35]
v_mfma_f32_16x16x32_bf16 v[52:55],a[236:239],v[84:87],v[52:55]
v_mfma_f32_16x16x32_bf16 v[68:71],v[84:87],v[236:239],v[68:71]
v_mfma_f32_16x16x32_bf16 v[36:39],a[108:111],v[84:87],v[36:39]
s_waitcnt lgkmcnt(2)
v_mfma_f32_16x16x32_bf16 v[40:43],a[240:243],v[108:111],v[40:43]
v_mfma_f32_16x16x32_bf16 v[56:59],v[108:111],v[240:243],v[56:59]
v_mfma_f32_16x16x32_bf16 v[24:27],a[112:115],v[108:111],v[24:27]
v_mfma_f32_16x16x32_bf16 v[44:47],a[240:243],v[112:115],v[44:47]
v_mfma_f32_16x16x32_bf16 v[60:63],v[112:115],v[240:243],v[60:63]
v_mfma_f32_16x16x32_bf16 v[28:31],a[112:115],v[112:115],v[28:31]
v_mfma_f32_16x16x32_bf16 v[48:51],a[248:251],v[108:111],v[48:51]
v_mfma_f32_16x16x32_bf16 v[64:67],v[108:111],v[248:251],v[64:67]
v_mfma_f32_16x16x32_bf16 v[32:35],a[120:123],v[108:111],v[32:35]
v_mfma_f32_16x16x32_bf16 v[52:55],a[248:251],v[112:115],v[52:55]
v_mfma_f32_16x16x32_bf16 v[68:71],v[112:115],v[248:251],v[68:71]
v_mfma_f32_16x16x32_bf16 v[36:39],a[120:123],v[112:115],v[36:39]
s_waitcnt lgkmcnt(0)
v_mfma_f32_16x16x32_bf16 v[40:43],a[244:247],v[72:75],v[40:43]
v_mfma_f32_16x16x32_bf16 v[56:59],v[72:75],v[244:247],v[56:59]
v_mfma_f32_16x16x32_bf16 v[24:27],a[116:119],v[72:75],v[24:27]
v_mfma_f32_16x16x32_bf16 v[44:47],a[244:247],v[76:79],v[44:47]
v_mfma_f32_16x16x32_bf16 v[60:63],v[76:79],v[244:247],v[60:63]
v_mfma_f32_16x16x32_bf16 v[28:31],a[116:119],v[76:79],v[28:31]
v_mfma_f32_16x16x32_bf16 v[48:51],a[252:255],v[72:75],v[48:51]
v_mfma_f32_16x16x32_bf16 v[64:67],v[72:75],v[252:255],v[64:67]
v_mfma_f32_16x16x32_bf16 v[32:35],a[124:127],v[72:75],v[32:35]
v_mfma_f32_16x16x32_bf16 v[52:55],a[252:255],v[76:79],v[52:55]
v_mfma_f32_16x16x32_bf16 v[68:71],v[76:79],v[252:255],v[68:71]
v_mfma_f32_16x16x32_bf16 v[36:39],a[124:127],v[76:79],v[36:39]
s_lshl_b32 s56,s51,5
s_add_u32 s56,s56,s47
s_lshl_b32 s56,s56,12
s_add_u32 s56,s56,s50
s_add_u32 s56,s56,41943040
v_mov_b64 v[120:121],-1
v_mov_b64 v[122:123],-1
buffer_store_dwordx4 v[120:123],v0,s[8:11],s56 offen sc1
v_cvt_pk_bf16_f32 v72,v40,v48
v_cvt_pk_bf16_f32 v73,v41,v49
v_cvt_pk_bf16_f32 v74,v42,v50
v_cvt_pk_bf16_f32 v75,v43,v51
buffer_store_dwordx4 v[72:75],v0,s[8:11],s61 offen sc1
v_cvt_pk_bf16_f32 v76,v44,v52
v_cvt_pk_bf16_f32 v77,v45,v53
v_cvt_pk_bf16_f32 v78,v46,v54
v_cvt_pk_bf16_f32 v79,v47,v55
buffer_store_dwordx4 v[76:79],v0,s[8:11],s62 offen sc1
v_cvt_pk_bf16_f32 v80,v56,v57
v_cvt_pk_bf16_f32 v81,v58,v59
v_cvt_pk_bf16_f32 v82,v60,v61
v_cvt_pk_bf16_f32 v83,v62,v63
buffer_store_dwordx4 v[80:83],v0,s[8:11],s65 offen offset:0 sc1
v_cvt_pk_bf16_f32 v84,v64,v65
v_cvt_pk_bf16_f32 v85,v66,v67
v_cvt_pk_bf16_f32 v86,v68,v69
v_cvt_pk_bf16_f32 v87,v70,v71
buffer_store_dwordx4 v[84:87],v0,s[8:11],s65 offen offset:1024 sc1
v_cvt_pk_bf16_f32 v108,v24,v32
v_cvt_pk_bf16_f32 v109,v25,v33
v_cvt_pk_bf16_f32 v110,v26,v34
v_cvt_pk_bf16_f32 v111,v27,v35
buffer_store_dwordx4 v[108:111],v0,s[8:11],s63 offen sc1
v_cvt_pk_bf16_f32 v112,v28,v36
v_cvt_pk_bf16_f32 v113,v29,v37
v_cvt_pk_bf16_f32 v114,v30,v38
v_cvt_pk_bf16_f32 v115,v31,v39
buffer_store_dwordx4 v[112:115],v0,s[8:11],s64 offen sc1
s_lshl_b32 s72,s51,13
s_lshl2_add_u32 s72,s47,s72
s_add_u32 s72,s72,10485760
s_add_u32 s51,s51,1
s_sub_u32 s53,s53,1
s_cmp_gt_u32 s53,0
s_cbranch_scc1 L_chl_130
s_waitcnt vmcnt(0)
s_barrier
s_or_b32 s72,s72,s52
buffer_store_dword v17,off,s[8:11],s72 sc1
L_chd_129:
s_cmp_lg_u32 s3,0
s_cbranch_scc1 L_wc
s_cmp_eq_u32 s48,1
s_cbranch_scc1 L_rc1_131
s_cmp_eq_u32 s48,2
s_cbranch_scc1 L_rc2_132
v_and_b32 v120,15,v1
v_lshrrev_b32 v121,4,v1
v_and_b32 v122,2,v1
v_cmp_eq_u32 vcc,0,v122
v_mov_b32 v2,0xeeee
v_mov_b32 v123,0x4444
v_cndmask_b32 v2,v2,v123,vcc
v_and_b32 v122,1,v1
v_cmp_eq_u32 vcc,0,v122
v_mov_b32 v3,0xdddd
v_mov_b32 v123,0x8888
v_cndmask_b32 v3,v3,v123,vcc
v_lshrrev_b32 v122,1,v120
v_bfe_u32 v123,v120,2,1
v_xor_b32 v123,v123,v122
v_lshlrev_b32 v4,7,v123
v_and_b32 v123,1,v120
v_lshl_add_u32 v4,v123,6,v4
v_xor_b32 v123,v121,v122
v_and_b32 v123,3,v123
v_lshl_add_u32 v4,v123,4,v4
s_lshl_b32 s56,s46,10
s_add_u32 s56,s56,147456
v_add_u32 v4,s56,v4
v_lshlrev_b32 v122,1,v121
v_add_u32 v122,0,v122
v_and_b32 v123,1,v121
v_xor_b32 v123,v123,v122
v_lshlrev_b32 v5,7,v123
v_bfe_u32 v123,v120,3,1
v_lshl_add_u32 v5,v123,6,v5
v_xor_b32 v123,v120,v122
v_and_b32 v123,3,v123
v_lshl_add_u32 v5,v123,4,v5
v_bfe_u32 v123,v120,2,1
v_lshl_add_u32 v5,v123,3,v5
v_add_u32 v5,147456,v5
v_lshlrev_b32 v122,1,v121
v_add_u32 v122,1,v122
v_and_b32 v123,1,v121
v_xor_b32 v123,v123,v122
v_lshlrev_b32 v6,7,v123
v_bfe_u32 v123,v120,3,1
v_lshl_add_u32 v6,v123,6,v6
v_xor_b32 v123,v120,v122
v_and_b32 v123,3,v123
v_lshl_add_u32 v6,v123,4,v6
v_bfe_u32 v123,v120,2,1
v_lshl_add_u32 v6,v123,3,v6
v_add_u32 v6,147456,v6
v_lshlrev_b32 v7,7,v121
v_lshrrev_b32 v122,1,v120
v_lshl_add_u32 v8,v122,4,v7
v_add_u32 v8,151552,v8
v_lshrrev_b32 v122,2,v120
v_lshl_add_u32 v7,v122,5,v7
v_and_b32 v122,1,v120
v_lshl_add_u32 v7,v122,4,v7
v_and_b32 v122,2,v120
v_cmp_eq_u32 vcc,0,v122
s_lshl_b32 s56,s46,9
v_mov_b32 v122,2048
v_mov_b32 v123,s56
v_cndmask_b32 v122,v122,v123,vcc
v_add_u32 v7,v122,v7
v_add_u32 v7,151552,v7
v_lshrrev_b32 v122,3,v1
v_lshlrev_b32 v9,11,v122
v_and_b32 v122,7,v1
v_lshl_add_u32 v9,v122,3,v9
s_lshl_b32 s56,s46,14
s_lshl_b32 s57,s47,6
s_add_u32 s56,s56,s57
v_add_u32 v9,s56,v9
s_lshl_b32 s71,s46,5
s_add_u32 s71,s71,s47
s_bfe_u32 s56,s71,0x10003
s_lshl_b32 s56,s56,11
s_and_b32 s57,s71,1
s_lshl_b32 s57,s57,10
s_add_u32 s56,s56,s57
s_bfe_u32 s57,s71,0x10002
s_lshl_b32 s57,s57,9
s_add_u32 s56,s56,s57
s_bfe_u32 s57,s71,0x10001
s_lshl_b32 s57,s57,6
s_add_u32 s56,s56,s57
s_bfe_u32 s57,s71,0x10004
s_lshl_b32 s57,s57,8
s_add_u32 s56,s56,s57
s_bfe_u32 s57,s71,0x10005
s_lshl_b32 s57,s57,7
s_add_u32 s56,s56,s57
s_bfe_u32 s57,s71,0x10006
s_lshl_b32 s57,s57,12
s_add_u32 s56,s56,s57
v_and_b32 v122,3,v120
v_lshlrev_b32 v10,2,v122
v_bfe_u32 v122,v120,3,1
v_lshl_add_u32 v10,v122,4,v10
v_and_b32 v122,1,v121
v_lshl_add_u32 v10,v122,5,v10
v_add_u32 v10,s56,v10
v_and_b32 v123,36,v1
v_mov_b32 v122,0x80000000
v_cmp_eq_u32 vcc,0,v123
s_nop 1
v_cndmask_b32 v10,v122,v10,vcc
s_lshl_b32 s56,s46,15
v_add_u32 v11,s56,v0
s_lshl_b32 s71,s71,11
s_lshl_b32 s73,s46,11
s_mov_b32 s72,0xffc00000
s_mov_b32 s74,0
v_lshrrev_b32 v13,3,v1
v_lshlrev_b32 v13,9,v13
v_and_b32 v122,7,v1
v_lshl_add_u32 v13,v122,4,v13
v_and_b32 v122,15,v1
v_and_b32 v123,1,v1
v_lshlrev_b32 v123,4,v123
v_mov_b32 v124,0x3f80
v_lshlrev_b32 v124,v123,v124
v_lshrrev_b32 v122,1,v122
v_cmp_eq_u32 vcc,0,v122
s_nop 1
v_cndmask_b32 v18,0,v124,vcc
v_cmp_eq_u32 vcc,1,v122
s_nop 1
v_cndmask_b32 v19,0,v124,vcc
v_cmp_eq_u32 vcc,2,v122
s_nop 1
v_cndmask_b32 v20,0,v124,vcc
v_cmp_eq_u32 vcc,3,v122
s_nop 1
v_cndmask_b32 v21,0,v124,vcc
s_and_b32 s56,s46,1
s_lshl_b32 s56,s56,8
s_and_b32 s57,s46,2
s_lshl_b32 s57,s57,6
s_add_u32 s56,s56,s57
v_add_u32 v13,s56,v13
s_add_u32 s56,s50,155648
v_add_u32 v12,s56,v0
v_mov_b64 v[14:15],s[28:29]
v_mov_b64 v[16:17],s[28:29]
v_add_u32 v22,11550720,v10
s_lshl_b32 s18,s47,2
s_add_u32 s18,s18,10493952
v_mov_b32 v1,s80
s_mov_b32 s65,14680064
s_add_u32 s66,s71,14680064
s_add_u32 s69,s71,14942208
s_mov_b32 s30,0x40000000
s_mov_b32 s51,0
buffer_load_dwordx4 v[56:59],v0,s[8:11],s66 offen offset:0
buffer_load_dwordx4 v[60:63],v0,s[8:11],s66 offen offset:1024
buffer_load_dwordx4 v[64:67],v0,s[8:11],s69 offen offset:0
buffer_load_dwordx4 v[68:71],v0,s[8:11],s69 offen offset:1024
s_waitcnt vmcnt(0)
L_cst_136:
s_cmp_lg_u32 s46,0
s_cbranch_scc1 L_csw_141
s_lshl_b32 s59,s51,13
s_lshl2_add_u32 s59,s47,s59
s_add_u32 s59,s59,10485760
L_ww_142:
s_sleep 1
buffer_load_dword v122,off,s[8:11],s59 sc1
s_sub_u32 s49,s49,1
s_cbranch_scc1 L_abort
s_waitcnt vmcnt(0)
v_readfirstlane_b32 s61,v122
s_cmp_eq_u32 s61,0
s_cbranch_scc1 L_ww_142
L_wwd_143:
L_csw_141:
s_waitcnt lgkmcnt(0)
s_barrier
s_lshl_b32 s56,s51,5
s_add_u32 s56,s56,s47
s_mul_i32 s56,s56,24576
s_add_u32 s56,s56,100663296
s_add_u32 s67,s56,s73
s_add_u32 m0,s73,131072
s_add_u32 s57,s67,8192
buffer_load_dwordx4 v0,s[8:11],s67 offen sc1 lds
buffer_load_dwordx4 v0,s[8:11],s67 offen offset:1024 sc1 lds
s_add_u32 m0,s73,139264
s_add_u32 s67,s67,786432
buffer_load_dwordx4 v0,s[8:11],s57 offen sc1 lds
buffer_load_dwordx4 v0,s[8:11],s57 offen offset:1024 sc1 lds
s_lshl_b32 s75,s51,13
s_add_u32 s56,s75,11542528
buffer_load_dword v23,v10,s[8:11],s56 offen sc1
s_add_u32 s64,s75,11534336
s_add_u32 s70,s64,4096
s_lshl_b32 s68,s51,5
s_add_u32 s68,s68,s47
s_lshl_b32 s68,s68,12
s_lshl_b32 s56,s46,10
s_add_u32 s68,s68,s56
s_add_u32 s68,s68,41943040
s_mov_b32 s54,0x80000000
s_mov_b32 s77,0
s_mov_b32 s19,0
s_cmp_eq_u32 s51,63
s_cselect_b32 s76,1,s46
s_cmp_eq_u32 s76,0
s_cselect_b32 s76,1,0
v_mov_b64 v[96:97],0
v_mov_b64 v[98:99],0
v_mov_b64 v[100:101],0
v_mov_b64 v[102:103],0
v_mov_b64 v[104:105],0
v_mov_b64 v[106:107],0
v_mov_b64 v[108:109],0
v_mov_b64 v[110:111],0
v_mov_b64 v[112:113],0
v_mov_b64 v[114:115],0
v_mov_b64 v[116:117],0
v_mov_b64 v[118:119],0
s_waitcnt vmcnt(0) lgkmcnt(0)
s_barrier
v_add_u32 v55,131072,v0
ds_read_b128 v[56:59],v55 offset:0
ds_read_b128 v[60:63],v55 offset:4096
ds_read_b128 v[64:67],v55 offset:1024
ds_read_b128 v[68:71],v55 offset:5120
ds_read_b128 v[72:75],v55 offset:2048
ds_read_b128 v[76:79],v55 offset:6144
ds_read_b128 v[80:83],v55 offset:3072
ds_read_b128 v[84:87],v55 offset:7168
v_add_u32 v123,s73,v55
ds_read_b128 v[88:91],v123 offset:8192
ds_read_b128 v[92:95],v123 offset:9216
v_xor_b32 v120,1024,v12
v_xor_b32 v121,2048,v12
v_xor_b32 v122,3072,v12
buffer_load_dwordx4 v[24:27],v13,s[8:11],s64 offen sc1
buffer_load_dwordx4 v[24:27],v13,s[8:11],s64 offen sc1
L_chain_144:
L_cpa_145:
buffer_load_dwordx4 v[24:27],v13,s[8:11],s64 offen sc1
s_sub_u32 s49,s49,1
s_cbranch_scc1 L_abort
s_waitcnt vmcnt(2)
v_max3_u32 v123,v24,v25,v26
v_max_u32 v123,v27,v123
v_cmp_le_u32 vcc,s72,v123
s_cbranch_vccnz L_cpa_145
L_cgo_148:
ds_write_b128 v12,v[24:27] offset:0
v_smfmac_f32_16x16x64_bf16 v[96:99],v[24:27],a[0:7],v2
buffer_load_dwordx4 v[40:43],v13,s[8:11],s70 offen sc1
v_smfmac_f32_16x16x64_bf16 v[100:103],v[24:27],a[128:135],v2
v_smfmac_f32_16x16x64_bf16 v[104:107],v[24:27],a[8:15],v2
v_smfmac_f32_16x16x64_bf16 v[108:111],v[24:27],a[136:143],v2
s_waitcnt lgkmcnt(0)
s_barrier
ds_read_b128 v[28:31],v120 offset:0
v_smfmac_f32_16x16x64_bf16 v[112:115],v[24:27],v[128:135],v2
ds_read_b128 v[32:35],v121 offset:0
v_smfmac_f32_16x16x64_bf16 v[116:119],v[24:27],v[136:143],v2
ds_read_b128 v[36:39],v122 offset:0
s_waitcnt lgkmcnt(2)
v_smfmac_f32_16x16x64_bf16 v[96:99],v[28:31],a[16:23],v2
s_add_u32 m0,s73,131072
v_smfmac_f32_16x16x64_bf16 v[100:103],v[28:31],a[144:151],v2
s_add_u32 s57,s67,8192
v_smfmac_f32_16x16x64_bf16 v[104:107],v[28:31],a[24:31],v2
s_cmp_lt_u32 s19,s76
s_cbranch_scc1 L_ckw_137
L_ckb_138:
v_smfmac_f32_16x16x64_bf16 v[108:111],v[28:31],a[152:159],v2
s_waitcnt vmcnt(0) lgkmcnt(1)
v_smfmac_f32_16x16x64_bf16 v[96:99],v[32:35],a[32:39],v2
ds_write_b128 v12,v[40:43] offset:4096
v_max3_u32 v123,v40,v41,v42
v_smfmac_f32_16x16x64_bf16 v[100:103],v[32:35],a[160:167],v2
v_max_u32 v123,v43,v123
v_smfmac_f32_16x16x64_bf16 v[104:107],v[32:35],a[40:47],v2
v_cmp_le_u32 vcc,s72,v123
v_smfmac_f32_16x16x64_bf16 v[108:111],v[32:35],a[168:175],v2
v_smfmac_f32_16x16x64_bf16 v[112:115],v[28:31],v[144:151],v2
s_cbranch_vccnz L_cpb_151
L_cback_153:
s_waitcnt lgkmcnt(0)
s_barrier
v_smfmac_f32_16x16x64_bf16 v[96:99],v[36:39],a[48:55],v2
buffer_store_dwordx4 v[124:127],v0,s[8:11],s54 offen sc1
v_smfmac_f32_16x16x64_bf16 v[100:103],v[36:39],a[176:183],v2
ds_read_b128 v[44:47],v120 offset:4096
v_smfmac_f32_16x16x64_bf16 v[104:107],v[36:39],a[56:63],v2
buffer_load_dwordx4 v0,s[8:11],s67 offen sc1 lds
v_smfmac_f32_16x16x64_bf16 v[108:111],v[36:39],a[184:191],v2
ds_read_b128 v[48:51],v121 offset:4096
v_smfmac_f32_16x16x64_bf16 v[96:99],v[40:43],a[64:71],v2
buffer_load_dwordx4 v0,s[8:11],s67 offen offset:1024 sc1 lds
s_add_u32 m0,s73,139264
v_smfmac_f32_16x16x64_bf16 v[100:103],v[40:43],a[192:199],v2
ds_read_b128 v[52:55],v122 offset:4096
v_smfmac_f32_16x16x64_bf16 v[104:107],v[40:43],a[72:79],v2
buffer_load_dwordx4 v0,s[8:11],s57 offen sc1 lds
s_add_u32 s67,s67,786432
v_smfmac_f32_16x16x64_bf16 v[108:111],v[40:43],a[200:207],v2
s_waitcnt lgkmcnt(2)
v_smfmac_f32_16x16x64_bf16 v[96:99],v[44:47],a[80:87],v2
buffer_load_dwordx4 v0,s[8:11],s57 offen offset:1024 sc1 lds
v_smfmac_f32_16x16x64_bf16 v[100:103],v[44:47],a[208:215],v2
s_waitcnt lgkmcnt(1)
v_smfmac_f32_16x16x64_bf16 v[96:99],v[48:51],a[96:103],v2
buffer_load_dword v23,v22,s[8:11],s75 offen sc1
v_smfmac_f32_16x16x64_bf16 v[100:103],v[48:51],a[224:231],v2
s_waitcnt lgkmcnt(0)
v_smfmac_f32_16x16x64_bf16 v[96:99],v[52:55],a[112:119],v2
v_smfmac_f32_16x16x64_bf16 v[100:103],v[52:55],a[240:247],v2
v_smfmac_f32_16x16x64_bf16 v[104:107],v[44:47],a[88:95],v2
v_smfmac_f32_16x16x64_bf16 v[108:111],v[44:47],a[216:223],v2
v_smfmac_f32_16x16x64_bf16 v[104:107],v[48:51],a[104:111],v2
v_add_f32 v96,v96,v98
v_smfmac_f32_16x16x64_bf16 v[108:111],v[48:51],a[232:239],v2
v_add_f32 v97,v97,v99
v_smfmac_f32_16x16x64_bf16 v[104:107],v[52:55],a[120:127],v2
v_cvt_pk_bf16_f32 v120,v96,v97
v_smfmac_f32_16x16x64_bf16 v[108:111],v[52:55],a[248:255],v2
v_add_f32 v100,v100,v102
v_smfmac_f32_16x16x64_bf16 v[116:119],v[28:31],v[152:159],v2
v_add_f32 v101,v101,v103
v_smfmac_f32_16x16x64_bf16 v[112:115],v[32:35],v[160:167],v2
v_cvt_pk_bf16_f32 v121,v100,v101
v_add_f32 v104,v104,v106
v_add_f32 v105,v105,v107
v_cvt_pk_bf16_f32 v122,v104,v105
v_add_f32 v108,v108,v110
v_add_f32 v109,v109,v111
v_cvt_pk_bf16_f32 v123,v108,v109
ds_write_b128 v4,v[120:123]
v_smfmac_f32_16x16x64_bf16 v[116:119],v[32:35],v[168:175],v2
s_mov_b32 s54,s68
s_add_u32 s68,s68,131072
v_mov_b32 v125,0
v_smfmac_f32_16x16x64_bf16 v[112:115],v[36:39],v[176:183],v2
s_cmp_eq_u32 s51,63
s_cbranch_scc1 L_cend_147
v_smfmac_f32_16x16x64_bf16 v[116:119],v[36:39],v[184:191],v2
v_smfmac_f32_16x16x64_bf16 v[112:115],v[40:43],v[192:199],v2
s_waitcnt lgkmcnt(0)
s_barrier
ds_read_b64_tr_b16 v[96:97],v5 offset:0
ds_read_b64_tr_b16 v[98:99],v6 offset:0
v_smfmac_f32_16x16x64_bf16 v[116:119],v[40:43],v[200:207],v2
ds_read_b64_tr_b16 v[100:101],v5 offset:1024
v_smfmac_f32_16x16x64_bf16 v[112:115],v[44:47],v[208:215],v2
ds_read_b64_tr_b16 v[102:103],v6 offset:1024
v_smfmac_f32_16x16x64_bf16 v[116:119],v[44:47],v[216:223],v2
ds_read_b64_tr_b16 v[104:105],v5 offset:2048
v_smfmac_f32_16x16x64_bf16 v[112:115],v[48:51],v[224:231],v2
ds_read_b64_tr_b16 v[106:107],v6 offset:2048
s_waitcnt lgkmcnt(4)
v_mfma_f32_16x16x32_bf16 v[24:27],v[56:59],v[96:99],0
ds_read_b64_tr_b16 v[108:109],v5 offset:3072
v_mfma_f32_16x16x32_bf16 v[28:31],v[60:63],v[96:99],0
ds_read_b64_tr_b16 v[110:111],v6 offset:3072
v_mfma_f32_16x16x32_bf16 v[32:35],v[96:99],v[96:99],0
ds_read_b128 v[40:43],v11 offset:12288
s_waitcnt lgkmcnt(5)
v_mfma_f32_16x16x32_bf16 v[24:27],v[64:67],v[100:103],v[24:27]
ds_read_b128 v[56:59],v11 offset:0
v_mfma_f32_16x16x32_bf16 v[28:31],v[68:71],v[100:103],v[28:31]
ds_read_b128 v[60:63],v11 offset:1024
v_mfma_f32_16x16x32_bf16 v[32:35],v[100:103],v[100:103],v[32:35]
ds_read_b128 v[96:99],v11 offset:8192
s_waitcnt lgkmcnt(6)
v_mfma_f32_16x16x32_bf16 v[24:27],v[72:75],v[104:107],v[24:27]
ds_read_b128 v[64:67],v11 offset:2048
v_mfma_f32_16x16x32_bf16 v[28:31],v[76:79],v[104:107],v[28:31]
ds_read_b128 v[68:71],v11 offset:3072
v_mfma_f32_16x16x32_bf16 v[32:35],v[104:107],v[104:107],v[32:35]
ds_read_b128 v[100:103],v11 offset:9216
s_waitcnt lgkmcnt(7)
v_mfma_f32_16x16x32_bf16 v[24:27],v[80:83],v[108:111],v[24:27]
ds_read_b128 v[72:75],v11 offset:4096
v_mfma_f32_16x16x32_bf16 v[28:31],v[84:87],v[108:111],v[28:31]
ds_read_b128 v[76:79],v11 offset:5120
v_mfma_f32_16x16x32_bf16 v[32:35],v[108:111],v[108:111],v[32:35]
ds_read_b128 v[104:107],v11 offset:10240
v_smfmac_f32_16x16x64_bf16 v[116:119],v[48:51],v[232:239],v2
ds_read_b128 v[80:83],v11 offset:6144
v_smfmac_f32_16x16x64_bf16 v[112:115],v[52:55],v[240:247],v2
ds_read_b128 v[84:87],v11 offset:7168
v_smfmac_f32_16x16x64_bf16 v[116:119],v[52:55],v[248:255],v2
ds_read_b128 v[108:111],v11 offset:11264
v_max3_f32 v126,v24,v25,v26
v_max3_f32 v127,v27,v28,v29
v_max3_f32 v126,v30,v31,v126
v_max3_f32 v127,v34,v35,v127
v_max_f32 v126,v126,v127
v_max_f32 v127,v126,v127
v_pk_mul_f32 v[34:35],v[34:35],v[0:1] op_sel:[0,1]
v_pk_mul_f32 v[24:25],v[24:25],v[0:1] op_sel:[0,1]
v_permlane16_swap_b32 v126,v127
v_max_f32 v126,v126,v127
v_max_f32 v127,v126,v127
v_pk_mul_f32 v[26:27],v[26:27],v[0:1] op_sel:[0,1]
v_pk_mul_f32 v[28:29],v[28:29],v[0:1] op_sel:[0,1]
v_permlane32_swap_b32 v126,v127
v_max_f32 v126,v126,v127
v_mul_f32 v126,v1,v126
v_pk_mul_f32 v[30:31],v[30:31],v[0:1] op_sel:[0,1]
v_pk_add_f32 v[34:35],v[34:35],v[126:127] op_sel_hi:[1,0] neg_lo:[0,1] neg_hi:[0,1]
v_pk_add_f32 v[112:113],v[112:113],v[114:115]
v_pk_add_f32 v[116:117],v[116:117],v[118:119]
v_pk_add_f32 v[24:25],v[24:25],v[126:127] op_sel_hi:[1,0] neg_lo:[0,1] neg_hi:[0,1]
v_pk_add_f32 v[26:27],v[26:27],v[126:127] op_sel_hi:[1,0] neg_lo:[0,1] neg_hi:[0,1]
v_pk_add_f32 v[28:29],v[28:29],v[126:127] op_sel_hi:[1,0] neg_lo:[0,1] neg_hi:[0,1]
v_pk_add_f32 v[30:31],v[30:31],v[126:127] op_sel_hi:[1,0] neg_lo:[0,1] neg_hi:[0,1]
v_exp_f32 v34,v34
v_exp_f32 v35,v35
v_cvt_pk_bf16_f32 v126,v112,v113
v_cvt_pk_bf16_f32 v124,v34,v35
v_cvt_pk_bf16_f32 v127,v116,v117
v_cvt_pk_bf16_f32 v36,v116,v117
v_mfma_f32_16x16x16_bf16 v[32:35],v[14:15],v[124:125],0
ds_read_b128 v[44:47],v11 offset:13312
v_exp_f32 v24,v24
v_mfma_f32_16x16x16_bf16 v[112:115],v[126:127],v[124:125],0
ds_read_b128 v[48:51],v11 offset:14336
v_exp_f32 v25,v25
v_mfma_f32_16x16x16_bf16 v[116:119],v[36:37],v[124:125],0
ds_read_b128 v[52:55],v11 offset:15360
v_exp_f32 v26,v26
v_exp_f32 v27,v27
v_cvt_pk_bf16_f32 v120,v24,v25
v_exp_f32 v28,v28
v_exp_f32 v29,v29
v_cvt_pk_bf16_f32 v121,v26,v27
v_exp_f32 v30,v30
v_exp_f32 v31,v31
v_cvt_pk_bf16_f32 v122,v28,v29
v_cvt_pk_bf16_f32 v123,v30,v31
s_add_u32 s75,s75,8192
s_add_u32 s51,s51,1
v_mfma_f32_16x16x32_bf16 v[32:35],v[14:17],v[120:123],v[32:35]
v_mfma_f32_16x16x32_bf16 v[112:115],v[88:91],v[120:123],v[112:115]
ds_read_b128 v[88:91],v11 offset:16384
v_mfma_f32_16x16x32_bf16 v[116:119],v[92:95],v[120:123],v[116:119]
ds_read_b128 v[92:95],v11 offset:17408
v_rcp_f32 v32,v32
v_mov_b64 v[24:25],-1
v_mov_b64 v[26:27],-1
s_add_u32 s64,s75,11534336
s_add_u32 s70,s64,4096
v_pk_mul_f32 v[112:113],v[112:113],v[32:33] op_sel_hi:[1,0]
v_pk_mul_f32 v[114:115],v[114:115],v[32:33] op_sel_hi:[1,0]
v_pk_mul_f32 v[116:117],v[116:117],v[32:33] op_sel_hi:[1,0]
v_pk_mul_f32 v[118:119],v[118:119],v[32:33] op_sel_hi:[1,0]
v_cvt_pk_bf16_f32 v120,v112,v116
v_cvt_pk_bf16_f32 v121,v113,v117
v_cvt_pk_bf16_f32 v122,v114,v118
v_cvt_pk_bf16_f32 v123,v115,v119
ds_write_b128 v7,v[120:123]
buffer_store_dwordx4 v[24:27],v0,s[8:11],s69 offen
buffer_store_dwordx4 v[24:27],v0,s[8:11],s69 offen offset:1024
v_mov_b64 v[112:113],0
v_mov_b64 v[114:115],0
v_mov_b64 v[116:117],0
v_mov_b64 v[118:119],0
s_waitcnt lgkmcnt(0)
s_barrier
ds_read_b128 v[24:27],v8 offset:0
ds_read_b128 v[28:31],v8 offset:512
ds_read_b128 v[32:35],v8 offset:1024
ds_read_b128 v[36:39],v8 offset:1536
v_mov_b64 v[120:121],0
v_mov_b64 v[122:123],0
s_waitcnt lgkmcnt(3)
v_smfmac_f32_16x16x64_bf16 v[112:115],v[24:27],v[56:63],v3
ds_read_b128 v[56:59],v11 offset:18432
s_add_u32 s57,s65,65536
s_waitcnt lgkmcnt(3)
v_smfmac_f32_16x16x64_bf16 v[112:115],v[28:31],v[64:71],v3
ds_read_b128 v[60:63],v11 offset:19456
s_add_u32 s58,s65,131072
s_waitcnt lgkmcnt(3)
v_smfmac_f32_16x16x64_bf16 v[112:115],v[32:35],v[72:79],v3
ds_read_b128 v[64:67],v11 offset:20480
s_add_u32 s59,s65,196608
s_waitcnt lgkmcnt(3)
v_smfmac_f32_16x16x64_bf16 v[112:115],v[36:39],v[80:87],v3
ds_read_b128 v[68:71],v11 offset:21504
v_smfmac_f32_16x16x64_bf16 v[116:119],v[24:27],v[96:103],v3
ds_read_b128 v[72:75],v11 offset:22528
v_smfmac_f32_16x16x64_bf16 v[116:119],v[28:31],v[104:111],v3
ds_read_b128 v[76:79],v11 offset:23552
v_cvt_pk_bf16_f32 v112,v112,v113
v_smfmac_f32_16x16x64_bf16 v[116:119],v[32:35],v[40:47],v3
ds_read_b128 v[80:83],v11 offset:24576
v_cvt_pk_bf16_f32 v113,v114,v115
buffer_store_dwordx2 v[112:113],v9,s[8:11],s65 offen
v_smfmac_f32_16x16x64_bf16 v[116:119],v[36:39],v[48:55],v3
ds_read_b128 v[84:87],v11 offset:25600
v_mov_b64 v[112:113],0
v_smfmac_f32_16x16x64_bf16 v[120:123],v[24:27],v[88:95],v3
ds_read_b128 v[96:99],v11 offset:26624
ds_read_b128 v[100:103],v11 offset:27648
v_mov_b64 v[114:115],0
s_waitcnt lgkmcnt(8)
v_smfmac_f32_16x16x64_bf16 v[120:123],v[28:31],v[56:63],v3
ds_read_b128 v[104:107],v11 offset:28672
v_cvt_pk_bf16_f32 v116,v116,v117
s_waitcnt lgkmcnt(7)
v_smfmac_f32_16x16x64_bf16 v[120:123],v[32:35],v[64:71],v3
ds_read_b128 v[108:111],v11 offset:29696
ds_read_b128 v[40:43],v11 offset:30720
v_cvt_pk_bf16_f32 v117,v118,v119
buffer_store_dwordx2 v[116:117],v9,s[8:11],s57 offen
s_waitcnt lgkmcnt(7)
v_smfmac_f32_16x16x64_bf16 v[120:123],v[36:39],v[72:79],v3
ds_read_b128 v[44:47],v11 offset:31744
v_add_u32 v52,s50,v5
s_waitcnt lgkmcnt(6)
v_smfmac_f32_16x16x64_bf16 v[112:115],v[24:27],v[80:87],v3
v_add_u32 v54,s50,v6
s_waitcnt lgkmcnt(4)
v_smfmac_f32_16x16x64_bf16 v[112:115],v[28:31],v[96:103],v3
ds_read_b64_tr_b16 v[52:53],v52
v_cvt_pk_bf16_f32 v120,v120,v121
s_waitcnt lgkmcnt(3)
v_smfmac_f32_16x16x64_bf16 v[112:115],v[32:35],v[104:111],v3
ds_read_b64_tr_b16 v[54:55],v54
v_cvt_pk_bf16_f32 v121,v122,v123
buffer_store_dwordx2 v[120:121],v9,s[8:11],s58 offen
s_waitcnt lgkmcnt(2)
s_add_u32 s56,s18,s75
v_smfmac_f32_16x16x64_bf16 v[112:115],v[36:39],v[40:47],v3
v_mov_b64 v[116:117],0
v_mov_b64 v[118:119],0
s_xor_b32 s65,s65,262144
v_mov_b32_dpp v124,v126 quad_perm:[2,3,2,3] row_mask:0xf bank_mask:0xf
v_mov_b32_dpp v125,v127 quad_perm:[2,3,2,3] row_mask:0xf bank_mask:0xf
s_mov_b32 vcc_lo,0xcccccccc
s_mov_b32 vcc_hi,0xcccccccc
s_nop 0
v_cvt_pk_bf16_f32 v112,v112,v113
v_cvt_pk_bf16_f32 v113,v114,v115
buffer_store_dwordx2 v[112:113],v9,s[8:11],s59 offen
s_waitcnt lgkmcnt(0)
s_buffer_load_dword s19,s[8:11],s56
v_cndmask_b32 v124,v124,v52,vcc
v_cndmask_b32 v125,v125,v53,vcc
v_cndmask_b32 v126,v126,v54,vcc
v_cndmask_b32 v127,v127,v55,vcc
v_mov_b64 v[96:97],0
v_mov_b64 v[98:99],0
v_mov_b64 v[100:101],0
v_mov_b64 v[102:103],0
v_mov_b64 v[104:105],0
v_mov_b64 v[106:107],0
v_mov_b64 v[108:109],0
v_mov_b64 v[110:111],0
v_mov_b64 v[112:113],0
v_mov_b64 v[114:115],0
v_add_u32 v55,131072,v0
v_add_u32 v123,s73,v55
v_xor_b32 v120,1024,v12
v_xor_b32 v121,2048,v12
v_xor_b32 v122,3072,v12
s_cmp_lt_u32 s46,2
s_waitcnt vmcnt(2)
s_cbranch_scc1 L_crg_154
s_cmp_eq_u32 s46,2
s_waitcnt vmcnt(1)
s_cbranch_scc1 L_crg_154
s_waitcnt vmcnt(0)
L_crg_154:
buffer_load_dwordx4 v[32:35],v0,s[8:11],s66 offen offset:0 sc1
buffer_load_dwordx4 v[36:39],v0,s[8:11],s66 offen offset:1024 sc1
s_cmp_ge_u32 s51,63
s_cselect_b32 s76,0,1
s_cmp_eq_u32 s46,0
s_cselect_b32 s76,s76,0
s_waitcnt vmcnt(1)
v_mfma_f32_16x16x32_bf16 v[28:31],v[18:21],v[32:35],0
s_waitcnt vmcnt(0)
v_mfma_f32_16x16x32_bf16 v[28:31],v[18:21],v[36:39],v[28:31]
s_nop 7
v_cmp_u_f32 vcc,v28,v28
v_add_f32_dpp v52,v28,v28 row_ror:8 row_mask:0xf bank_mask:0x3
v_add_f32_dpp v53,v29,v29 row_ror:8 row_mask:0xf bank_mask:0x3
v_add_f32_dpp v52,v30,v30 row_ror:8 row_mask:0xf bank_mask:0xc
v_add_f32_dpp v53,v31,v31 row_ror:8 row_mask:0xf bank_mask:0xc
s_nop 0
v_add_f32_dpp v52,v52,v52 row_shl:4 row_mask:0xf bank_mask:0x5
v_add_f32_dpp v53,v53,v53 row_shl:4 row_mask:0xf bank_mask:0x5
s_cbranch_vccnz L_crp_149
L_cok_155:
v_cvt_pk_bf16_f32 v54,v52,v53
buffer_store_dword v54,v10,s[8:11],s64 offen
s_mov_b32 s69,s66
s_xor_b32 s66,s66,262144
s_barrier
ds_read_b128 v[56:59],v55 offset:0
ds_read_b128 v[60:63],v55 offset:4096
ds_read_b128 v[64:67],v55 offset:1024
buffer_load_dwordx4 v[24:27],v13,s[8:11],s64 offen sc1
ds_read_b128 v[68:71],v55 offset:5120
ds_read_b128 v[72:75],v55 offset:2048
ds_read_b128 v[76:79],v55 offset:6144
ds_read_b128 v[80:83],v55 offset:3072
buffer_load_dwordx4 v[24:27],v13,s[8:11],s64 offen sc1
ds_read_b128 v[84:87],v55 offset:7168
ds_read_b128 v[88:91],v123 offset:8192
ds_read_b128 v[92:95],v123 offset:9216
s_branch L_chain_144
L_cpb_151:
buffer_load_dwordx4 v[40:43],v13,s[8:11],s70 offen sc1
s_sub_u32 s49,s49,1
s_cbranch_scc1 L_abort
s_waitcnt vmcnt(0)
v_max3_u32 v123,v40,v41,v42
v_max_u32 v123,v43,v123
v_cmp_le_u32 vcc,s72,v123
s_cbranch_vccnz L_cpb_151
ds_write_b128 v12,v[40:43] offset:4096
s_branch L_cback_153
L_crp_149:
buffer_load_dwordx4 v[32:35],v0,s[8:11],s66 offen offset:0 sc1
buffer_load_dwordx4 v[36:39],v0,s[8:11],s66 offen offset:1024 sc1
s_sub_u32 s49,s49,1
s_cbranch_scc1 L_abort
s_waitcnt vmcnt(1)
v_mfma_f32_16x16x32_bf16 v[28:31],v[18:21],v[32:35],0
s_waitcnt vmcnt(0)
v_mfma_f32_16x16x32_bf16 v[28:31],v[18:21],v[36:39],v[28:31]
s_nop 7
v_cmp_u_f32 vcc,v28,v28
v_add_f32_dpp v52,v28,v28 row_ror:8 row_mask:0xf bank_mask:0x3
v_add_f32_dpp v53,v29,v29 row_ror:8 row_mask:0xf bank_mask:0x3
v_add_f32_dpp v52,v30,v30 row_ror:8 row_mask:0xf bank_mask:0xc
v_add_f32_dpp v53,v31,v31 row_ror:8 row_mask:0xf bank_mask:0xc
s_nop 0
v_add_f32_dpp v52,v52,v52 row_shl:4 row_mask:0xf bank_mask:0x5
v_add_f32_dpp v53,v53,v53 row_shl:4 row_mask:0xf bank_mask:0x5
s_cbranch_vccz L_cok_155
s_branch L_crp_149
L_ckw_137:
s_add_u32 s59,s18,s75
L_ww_156:
s_sleep 1
buffer_load_dword v23,off,s[8:11],s59 sc1
s_sub_u32 s49,s49,1
s_cbranch_scc1 L_abort
s_waitcnt vmcnt(0)
v_readfirstlane_b32 s76,v23
s_cmp_eq_u32 s76,0
s_cbranch_scc1 L_ww_156
L_wwd_157:
s_branch L_ckb_138
L_cend_147:
v_smfmac_f32_16x16x64_bf16 v[116:119],v[36:39],v[184:191],v2
v_smfmac_f32_16x16x64_bf16 v[112:115],v[40:43],v[192:199],v2
v_smfmac_f32_16x16x64_bf16 v[116:119],v[40:43],v[200:207],v2
v_smfmac_f32_16x16x64_bf16 v[112:115],v[44:47],v[208:215],v2
v_smfmac_f32_16x16x64_bf16 v[116:119],v[44:47],v[216:223],v2
v_smfmac_f32_16x16x64_bf16 v[112:115],v[48:51],v[224:231],v2
v_smfmac_f32_16x16x64_bf16 v[116:119],v[48:51],v[232:239],v2
v_smfmac_f32_16x16x64_bf16 v[112:115],v[52:55],v[240:247],v2
v_smfmac_f32_16x16x64_bf16 v[116:119],v[52:55],v[248:255],v2
s_waitcnt lgkmcnt(0)
s_nop 2
v_pk_add_f32 v[112:113],v[112:113],v[114:115]
s_nop 2
v_pk_add_f32 v[116:117],v[116:117],v[118:119]
v_cvt_pk_bf16_f32 v126,v112,v113
v_cvt_pk_bf16_f32 v127,v116,v117
v_add_u32 v52,s50,v5
v_add_u32 v54,s50,v6
ds_read_b64_tr_b16 v[52:53],v52
ds_read_b64_tr_b16 v[54:55],v54
v_mov_b32_dpp v124,v126 quad_perm:[2,3,2,3] row_mask:0xf bank_mask:0xf
v_mov_b32_dpp v125,v127 quad_perm:[2,3,2,3] row_mask:0xf bank_mask:0xf
s_mov_b32 vcc_lo,0xcccccccc
s_mov_b32 vcc_hi,0xcccccccc
s_waitcnt lgkmcnt(0)
v_cndmask_b32 v124,v124,v52,vcc
v_cndmask_b32 v125,v125,v53,vcc
v_cndmask_b32 v126,v126,v54,vcc
v_cndmask_b32 v127,v127,v55,vcc
buffer_store_dwordx4 v[124:127],v0,s[8:11],s54 offen sc1
s_mov_b32 s51,64
s_waitcnt vmcnt(0)
s_barrier
s_nop 11
v_lshrrev_b32 v1,4,v0
s_mov_b32 s53,0
s_branch L_rb_7
L_rc1_131:
v_and_b32 v120,15,v1
v_lshrrev_b32 v121,4,v1
v_and_b32 v122,2,v1
v_cmp_eq_u32 vcc,0,v122
v_mov_b32 v2,0xeeee
v_mov_b32 v123,0x4444
v_cndmask_b32 v2,v2,v123,vcc
v_and_b32 v122,1,v1
v_cmp_eq_u32 vcc,0,v122
v_mov_b32 v3,0xdddd
v_mov_b32 v123,0x8888
v_cndmask_b32 v3,v3,v123,vcc
v_lshrrev_b32 v122,1,v120
v_bfe_u32 v123,v120,2,1
v_xor_b32 v123,v123,v122
v_lshlrev_b32 v4,7,v123
v_and_b32 v123,1,v120
v_lshl_add_u32 v4,v123,6,v4
v_xor_b32 v123,v121,v122
v_and_b32 v123,3,v123
v_lshl_add_u32 v4,v123,4,v4
s_lshl_b32 s56,s46,10
s_add_u32 s56,s56,147456
v_add_u32 v4,s56,v4
v_lshlrev_b32 v122,1,v121
v_add_u32 v122,0,v122
v_and_b32 v123,1,v121
v_xor_b32 v123,v123,v122
v_lshlrev_b32 v5,7,v123
v_bfe_u32 v123,v120,3,1
v_lshl_add_u32 v5,v123,6,v5
v_xor_b32 v123,v120,v122
v_and_b32 v123,3,v123
v_lshl_add_u32 v5,v123,4,v5
v_bfe_u32 v123,v120,2,1
v_lshl_add_u32 v5,v123,3,v5
v_add_u32 v5,147456,v5
v_lshlrev_b32 v122,1,v121
v_add_u32 v122,1,v122
v_and_b32 v123,1,v121
v_xor_b32 v123,v123,v122
v_lshlrev_b32 v6,7,v123
v_bfe_u32 v123,v120,3,1
v_lshl_add_u32 v6,v123,6,v6
v_xor_b32 v123,v120,v122
v_and_b32 v123,3,v123
v_lshl_add_u32 v6,v123,4,v6
v_bfe_u32 v123,v120,2,1
v_lshl_add_u32 v6,v123,3,v6
v_add_u32 v6,147456,v6
v_lshlrev_b32 v7,7,v121
v_lshrrev_b32 v122,1,v120
v_lshl_add_u32 v8,v122,4,v7
v_add_u32 v8,151552,v8
v_lshrrev_b32 v122,2,v120
v_lshl_add_u32 v7,v122,5,v7
v_and_b32 v122,1,v120
v_lshl_add_u32 v7,v122,4,v7
v_and_b32 v122,2,v120
v_cmp_eq_u32 vcc,0,v122
s_lshl_b32 s56,s46,9
v_mov_b32 v122,2048
v_mov_b32 v123,s56
v_cndmask_b32 v122,v122,v123,vcc
v_add_u32 v7,v122,v7
v_add_u32 v7,151552,v7
v_lshrrev_b32 v122,3,v1
v_lshlrev_b32 v9,11,v122
v_and_b32 v122,7,v1
v_lshl_add_u32 v9,v122,3,v9
s_lshl_b32 s56,s46,14
s_lshl_b32 s57,s47,6
s_add_u32 s56,s56,s57
v_add_u32 v9,s56,v9
s_lshl_b32 s71,s46,5
s_add_u32 s71,s71,s47
s_bfe_u32 s56,s71,0x10003
s_lshl_b32 s56,s56,11
s_and_b32 s57,s71,1
s_lshl_b32 s57,s57,10
s_add_u32 s56,s56,s57
s_bfe_u32 s57,s71,0x10002
s_lshl_b32 s57,s57,9
s_add_u32 s56,s56,s57
s_bfe_u32 s57,s71,0x10001
s_lshl_b32 s57,s57,6
s_add_u32 s56,s56,s57
s_bfe_u32 s57,s71,0x10004
s_lshl_b32 s57,s57,8
s_add_u32 s56,s56,s57
s_bfe_u32 s57,s71,0x10005
s_lshl_b32 s57,s57,7
s_add_u32 s56,s56,s57
s_bfe_u32 s57,s71,0x10006
s_lshl_b32 s57,s57,12
s_add_u32 s56,s56,s57
v_and_b32 v122,3,v120
v_lshlrev_b32 v10,2,v122
v_bfe_u32 v122,v120,3,1
v_lshl_add_u32 v10,v122,4,v10
v_and_b32 v122,1,v121
v_lshl_add_u32 v10,v122,5,v10
v_add_u32 v10,s56,v10
v_and_b32 v123,36,v1
v_mov_b32 v122,0x80000000
v_cmp_eq_u32 vcc,0,v123
s_nop 1
v_cndmask_b32 v10,v122,v10,vcc
s_lshl_b32 s56,s46,15
v_add_u32 v11,s56,v0
s_lshl_b32 s71,s71,11
s_lshl_b32 s73,s46,11
s_mov_b32 s72,0xffc00000
s_mov_b32 s74,0
v_lshrrev_b32 v13,3,v1
v_lshlrev_b32 v13,9,v13
v_and_b32 v122,7,v1
v_lshl_add_u32 v13,v122,4,v13
v_and_b32 v122,15,v1
v_and_b32 v123,1,v1
v_lshlrev_b32 v123,4,v123
v_mov_b32 v124,0x3f80
v_lshlrev_b32 v124,v123,v124
v_lshrrev_b32 v122,1,v122
v_cmp_eq_u32 vcc,0,v122
s_nop 1
v_cndmask_b32 v18,0,v124,vcc
v_cmp_eq_u32 vcc,1,v122
s_nop 1
v_cndmask_b32 v19,0,v124,vcc
v_cmp_eq_u32 vcc,2,v122
s_nop 1
v_cndmask_b32 v20,0,v124,vcc
v_cmp_eq_u32 vcc,3,v122
s_nop 1
v_cndmask_b32 v21,0,v124,vcc
s_and_b32 s56,s46,1
s_lshl_b32 s56,s56,8
s_and_b32 s57,s46,2
s_lshl_b32 s57,s57,6
s_add_u32 s56,s56,s57
v_add_u32 v13,s56,v13
s_add_u32 s56,s50,155648
v_add_u32 v12,s56,v0
v_mov_b64 v[14:15],s[28:29]
v_mov_b64 v[16:17],s[28:29]
v_add_u32 v22,12599296,v10
s_lshl_b32 s18,s47,2
s_add_u32 s18,s18,10494080
v_mov_b32 v1,s80
s_mov_b32 s65,15728640
s_add_u32 s66,s71,15728640
s_add_u32 s69,s71,15990784
s_mov_b32 s30,0x40000000
s_mov_b32 s51,0
buffer_load_dwordx4 v[56:59],v0,s[8:11],s66 offen offset:0
buffer_load_dwordx4 v[60:63],v0,s[8:11],s66 offen offset:1024
buffer_load_dwordx4 v[64:67],v0,s[8:11],s69 offen offset:0
buffer_load_dwordx4 v[68:71],v0,s[8:11],s69 offen offset:1024
s_waitcnt vmcnt(0)
L_cst_161:
s_cmp_lg_u32 s46,0
s_cbranch_scc1 L_csw_166
s_lshl_b32 s59,s51,13
s_lshl2_add_u32 s59,s47,s59
s_add_u32 s59,s59,10485888
L_ww_167:
s_sleep 1
buffer_load_dword v122,off,s[8:11],s59 sc1
s_sub_u32 s49,s49,1
s_cbranch_scc1 L_abort
s_waitcnt vmcnt(0)
v_readfirstlane_b32 s61,v122
s_cmp_eq_u32 s61,0
s_cbranch_scc1 L_ww_167
L_wwd_168:
L_csw_166:
s_waitcnt lgkmcnt(0)
s_barrier
s_lshl_b32 s56,s51,5
s_add_u32 s56,s56,s47
s_mul_i32 s56,s56,24576
s_add_u32 s56,s56,150994944
s_add_u32 s67,s56,s73
s_add_u32 m0,s73,131072
s_add_u32 s57,s67,8192
buffer_load_dwordx4 v0,s[8:11],s67 offen sc1 lds
buffer_load_dwordx4 v0,s[8:11],s67 offen offset:1024 sc1 lds
s_add_u32 m0,s73,139264
s_add_u32 s67,s67,786432
buffer_load_dwordx4 v0,s[8:11],s57 offen sc1 lds
buffer_load_dwordx4 v0,s[8:11],s57 offen offset:1024 sc1 lds
s_lshl_b32 s75,s51,13
s_add_u32 s56,s75,12591104
buffer_load_dword v23,v10,s[8:11],s56 offen sc1
s_add_u32 s64,s75,12582912
s_add_u32 s70,s64,4096
s_lshl_b32 s68,s51,5
s_add_u32 s68,s68,s47
s_lshl_b32 s68,s68,12
s_lshl_b32 s56,s46,10
s_add_u32 s68,s68,s56
s_add_u32 s68,s68,58720256
s_mov_b32 s54,0x80000000
s_mov_b32 s77,0
s_mov_b32 s19,0
s_cmp_eq_u32 s51,63
s_cselect_b32 s76,1,s46
s_cmp_eq_u32 s76,0
s_cselect_b32 s76,1,0
v_mov_b64 v[96:97],0
v_mov_b64 v[98:99],0
v_mov_b64 v[100:101],0
v_mov_b64 v[102:103],0
v_mov_b64 v[104:105],0
v_mov_b64 v[106:107],0
v_mov_b64 v[108:109],0
v_mov_b64 v[110:111],0
v_mov_b64 v[112:113],0
v_mov_b64 v[114:115],0
v_mov_b64 v[116:117],0
v_mov_b64 v[118:119],0
s_waitcnt vmcnt(0) lgkmcnt(0)
s_barrier
v_add_u32 v55,131072,v0
ds_read_b128 v[56:59],v55 offset:0
ds_read_b128 v[60:63],v55 offset:4096
ds_read_b128 v[64:67],v55 offset:1024
ds_read_b128 v[68:71],v55 offset:5120
ds_read_b128 v[72:75],v55 offset:2048
ds_read_b128 v[76:79],v55 offset:6144
ds_read_b128 v[80:83],v55 offset:3072
ds_read_b128 v[84:87],v55 offset:7168
v_add_u32 v123,s73,v55
ds_read_b128 v[88:91],v123 offset:8192
ds_read_b128 v[92:95],v123 offset:9216
v_xor_b32 v120,1024,v12
v_xor_b32 v121,2048,v12
v_xor_b32 v122,3072,v12
buffer_load_dwordx4 v[24:27],v13,s[8:11],s64 offen sc1
buffer_load_dwordx4 v[24:27],v13,s[8:11],s64 offen sc1
L_chain_169:
L_cpa_170:
buffer_load_dwordx4 v[24:27],v13,s[8:11],s64 offen sc1
s_sub_u32 s49,s49,1
s_cbranch_scc1 L_abort
s_waitcnt vmcnt(2)
v_max3_u32 v123,v24,v25,v26
v_max_u32 v123,v27,v123
v_cmp_le_u32 vcc,s72,v123
s_cbranch_vccnz L_cpa_170
L_cgo_173:
ds_write_b128 v12,v[24:27] offset:0
v_smfmac_f32_16x16x64_bf16 v[96:99],v[24:27],a[0:7],v2
buffer_load_dwordx4 v[40:43],v13,s[8:11],s70 offen sc1
v_smfmac_f32_16x16x64_bf16 v[100:103],v[24:27],a[128:135],v2
v_smfmac_f32_16x16x64_bf16 v[104:107],v[24:27],a[8:15],v2
v_smfmac_f32_16x16x64_bf16 v[108:111],v[24:27],a[136:143],v2
s_waitcnt lgkmcnt(0)
s_barrier
ds_read_b128 v[28:31],v120 offset:0
v_smfmac_f32_16x16x64_bf16 v[112:115],v[24:27],v[128:135],v2
ds_read_b128 v[32:35],v121 offset:0
v_smfmac_f32_16x16x64_bf16 v[116:119],v[24:27],v[136:143],v2
ds_read_b128 v[36:39],v122 offset:0
s_waitcnt lgkmcnt(2)
v_smfmac_f32_16x16x64_bf16 v[96:99],v[28:31],a[16:23],v2
s_add_u32 m0,s73,131072
v_smfmac_f32_16x16x64_bf16 v[100:103],v[28:31],a[144:151],v2
s_add_u32 s57,s67,8192
v_smfmac_f32_16x16x64_bf16 v[104:107],v[28:31],a[24:31],v2
s_cmp_lt_u32 s19,s76
s_cbranch_scc1 L_ckw_162
L_ckb_163:
v_smfmac_f32_16x16x64_bf16 v[108:111],v[28:31],a[152:159],v2
s_waitcnt vmcnt(0) lgkmcnt(1)
v_smfmac_f32_16x16x64_bf16 v[96:99],v[32:35],a[32:39],v2
ds_write_b128 v12,v[40:43] offset:4096
v_max3_u32 v123,v40,v41,v42
v_smfmac_f32_16x16x64_bf16 v[100:103],v[32:35],a[160:167],v2
v_max_u32 v123,v43,v123
v_smfmac_f32_16x16x64_bf16 v[104:107],v[32:35],a[40:47],v2
v_cmp_le_u32 vcc,s72,v123
v_smfmac_f32_16x16x64_bf16 v[108:111],v[32:35],a[168:175],v2
v_smfmac_f32_16x16x64_bf16 v[112:115],v[28:31],v[144:151],v2
s_cbranch_vccnz L_cpb_176
L_cback_178:
s_waitcnt lgkmcnt(0)
s_barrier
buffer_store_dword v54,v10,s[8:11],s30 offen sc1
v_smfmac_f32_16x16x64_bf16 v[96:99],v[36:39],a[48:55],v2
buffer_store_dwordx4 v[124:127],v0,s[8:11],s54 offen sc1
v_smfmac_f32_16x16x64_bf16 v[100:103],v[36:39],a[176:183],v2
ds_read_b128 v[44:47],v120 offset:4096
v_smfmac_f32_16x16x64_bf16 v[104:107],v[36:39],a[56:63],v2
buffer_load_dwordx4 v0,s[8:11],s67 offen sc1 lds
v_smfmac_f32_16x16x64_bf16 v[108:111],v[36:39],a[184:191],v2
ds_read_b128 v[48:51],v121 offset:4096
v_smfmac_f32_16x16x64_bf16 v[96:99],v[40:43],a[64:71],v2
buffer_load_dwordx4 v0,s[8:11],s67 offen offset:1024 sc1 lds
s_add_u32 m0,s73,139264
v_smfmac_f32_16x16x64_bf16 v[100:103],v[40:43],a[192:199],v2
ds_read_b128 v[52:55],v122 offset:4096
v_smfmac_f32_16x16x64_bf16 v[104:107],v[40:43],a[72:79],v2
buffer_load_dwordx4 v0,s[8:11],s57 offen sc1 lds
s_add_u32 s67,s67,786432
v_smfmac_f32_16x16x64_bf16 v[108:111],v[40:43],a[200:207],v2
s_waitcnt lgkmcnt(2)
v_smfmac_f32_16x16x64_bf16 v[96:99],v[44:47],a[80:87],v2
buffer_load_dwordx4 v0,s[8:11],s57 offen offset:1024 sc1 lds
v_smfmac_f32_16x16x64_bf16 v[100:103],v[44:47],a[208:215],v2
s_waitcnt lgkmcnt(1)
v_smfmac_f32_16x16x64_bf16 v[96:99],v[48:51],a[96:103],v2
buffer_load_dword v23,v22,s[8:11],s75 offen sc1
v_smfmac_f32_16x16x64_bf16 v[100:103],v[48:51],a[224:231],v2
s_waitcnt lgkmcnt(0)
v_smfmac_f32_16x16x64_bf16 v[96:99],v[52:55],a[112:119],v2
v_smfmac_f32_16x16x64_bf16 v[100:103],v[52:55],a[240:247],v2
v_smfmac_f32_16x16x64_bf16 v[104:107],v[44:47],a[88:95],v2
v_smfmac_f32_16x16x64_bf16 v[108:111],v[44:47],a[216:223],v2
v_smfmac_f32_16x16x64_bf16 v[104:107],v[48:51],a[104:111],v2
v_add_f32 v96,v96,v98
v_smfmac_f32_16x16x64_bf16 v[108:111],v[48:51],a[232:239],v2
v_add_f32 v97,v97,v99
v_smfmac_f32_16x16x64_bf16 v[104:107],v[52:55],a[120:127],v2
v_cvt_pk_bf16_f32 v120,v96,v97
v_smfmac_f32_16x16x64_bf16 v[108:111],v[52:55],a[248:255],v2
v_add_f32 v100,v100,v102
v_smfmac_f32_16x16x64_bf16 v[116:119],v[28:31],v[152:159],v2
v_add_f32 v101,v101,v103
v_smfmac_f32_16x16x64_bf16 v[112:115],v[32:35],v[160:167],v2
v_cvt_pk_bf16_f32 v121,v100,v101
v_add_f32 v104,v104,v106
v_add_f32 v105,v105,v107
v_cvt_pk_bf16_f32 v122,v104,v105
v_add_f32 v108,v108,v110
v_add_f32 v109,v109,v111
v_cvt_pk_bf16_f32 v123,v108,v109
ds_write_b128 v4,v[120:123]
v_smfmac_f32_16x16x64_bf16 v[116:119],v[32:35],v[168:175],v2
s_mov_b32 s54,s68
s_add_u32 s68,s68,131072
v_mov_b32 v125,0
v_smfmac_f32_16x16x64_bf16 v[112:115],v[36:39],v[176:183],v2
s_cmp_eq_u32 s51,63
s_cbranch_scc1 L_cend_172
v_smfmac_f32_16x16x64_bf16 v[116:119],v[36:39],v[184:191],v2
v_smfmac_f32_16x16x64_bf16 v[112:115],v[40:43],v[192:199],v2
s_waitcnt lgkmcnt(0)
s_barrier
ds_read_b64_tr_b16 v[96:97],v5 offset:0
ds_read_b64_tr_b16 v[98:99],v6 offset:0
v_smfmac_f32_16x16x64_bf16 v[116:119],v[40:43],v[200:207],v2
ds_read_b64_tr_b16 v[100:101],v5 offset:1024
v_smfmac_f32_16x16x64_bf16 v[112:115],v[44:47],v[208:215],v2
ds_read_b64_tr_b16 v[102:103],v6 offset:1024
v_smfmac_f32_16x16x64_bf16 v[116:119],v[44:47],v[216:223],v2
ds_read_b64_tr_b16 v[104:105],v5 offset:2048
v_smfmac_f32_16x16x64_bf16 v[112:115],v[48:51],v[224:231],v2
ds_read_b64_tr_b16 v[106:107],v6 offset:2048
s_waitcnt lgkmcnt(4)
v_mfma_f32_16x16x32_bf16 v[24:27],v[56:59],v[96:99],0
ds_read_b64_tr_b16 v[108:109],v5 offset:3072
v_mfma_f32_16x16x32_bf16 v[28:31],v[60:63],v[96:99],0
ds_read_b64_tr_b16 v[110:111],v6 offset:3072
v_mfma_f32_16x16x32_bf16 v[32:35],v[96:99],v[96:99],0
ds_read_b128 v[40:43],v11 offset:12288
s_waitcnt lgkmcnt(5)
v_mfma_f32_16x16x32_bf16 v[24:27],v[64:67],v[100:103],v[24:27]
ds_read_b128 v[56:59],v11 offset:0
v_mfma_f32_16x16x32_bf16 v[28:31],v[68:71],v[100:103],v[28:31]
ds_read_b128 v[60:63],v11 offset:1024
v_mfma_f32_16x16x32_bf16 v[32:35],v[100:103],v[100:103],v[32:35]
ds_read_b128 v[96:99],v11 offset:8192
s_waitcnt lgkmcnt(6)
v_mfma_f32_16x16x32_bf16 v[24:27],v[72:75],v[104:107],v[24:27]
ds_read_b128 v[64:67],v11 offset:2048
v_mfma_f32_16x16x32_bf16 v[28:31],v[76:79],v[104:107],v[28:31]
ds_read_b128 v[68:71],v11 offset:3072
v_mfma_f32_16x16x32_bf16 v[32:35],v[104:107],v[104:107],v[32:35]
ds_read_b128 v[100:103],v11 offset:9216
s_waitcnt lgkmcnt(7)
v_mfma_f32_16x16x32_bf16 v[24:27],v[80:83],v[108:111],v[24:27]
ds_read_b128 v[72:75],v11 offset:4096
v_mfma_f32_16x16x32_bf16 v[28:31],v[84:87],v[108:111],v[28:31]
ds_read_b128 v[76:79],v11 offset:5120
v_mfma_f32_16x16x32_bf16 v[32:35],v[108:111],v[108:111],v[32:35]
ds_read_b128 v[104:107],v11 offset:10240
v_smfmac_f32_16x16x64_bf16 v[116:119],v[48:51],v[232:239],v2
ds_read_b128 v[80:83],v11 offset:6144
v_smfmac_f32_16x16x64_bf16 v[112:115],v[52:55],v[240:247],v2
ds_read_b128 v[84:87],v11 offset:7168
v_smfmac_f32_16x16x64_bf16 v[116:119],v[52:55],v[248:255],v2
ds_read_b128 v[108:111],v11 offset:11264
v_max3_f32 v126,v24,v25,v26
v_max3_f32 v127,v27,v28,v29
v_max3_f32 v126,v30,v31,v126
v_max3_f32 v127,v34,v35,v127
v_max_f32 v126,v126,v127
v_max_f32 v127,v126,v127
v_pk_mul_f32 v[34:35],v[34:35],v[0:1] op_sel:[0,1]
v_pk_mul_f32 v[24:25],v[24:25],v[0:1] op_sel:[0,1]
v_permlane16_swap_b32 v126,v127
v_max_f32 v126,v126,v127
v_max_f32 v127,v126,v127
v_pk_mul_f32 v[26:27],v[26:27],v[0:1] op_sel:[0,1]
v_pk_mul_f32 v[28:29],v[28:29],v[0:1] op_sel:[0,1]
v_permlane32_swap_b32 v126,v127
v_max_f32 v126,v126,v127
v_mul_f32 v126,v1,v126
v_pk_mul_f32 v[30:31],v[30:31],v[0:1] op_sel:[0,1]
v_pk_add_f32 v[34:35],v[34:35],v[126:127] op_sel_hi:[1,0] neg_lo:[0,1] neg_hi:[0,1]
v_pk_add_f32 v[112:113],v[112:113],v[114:115]
v_pk_add_f32 v[116:117],v[116:117],v[118:119]
v_pk_add_f32 v[24:25],v[24:25],v[126:127] op_sel_hi:[1,0] neg_lo:[0,1] neg_hi:[0,1]
v_pk_add_f32 v[26:27],v[26:27],v[126:127] op_sel_hi:[1,0] neg_lo:[0,1] neg_hi:[0,1]
v_pk_add_f32 v[28:29],v[28:29],v[126:127] op_sel_hi:[1,0] neg_lo:[0,1] neg_hi:[0,1]
v_pk_add_f32 v[30:31],v[30:31],v[126:127] op_sel_hi:[1,0] neg_lo:[0,1] neg_hi:[0,1]
v_exp_f32 v34,v34
v_exp_f32 v35,v35
v_cvt_pk_bf16_f32 v126,v112,v113
v_cvt_pk_bf16_f32 v124,v34,v35
v_cvt_pk_bf16_f32 v127,v116,v117
v_cvt_pk_bf16_f32 v36,v116,v117
v_mfma_f32_16x16x16_bf16 v[32:35],v[14:15],v[124:125],0
ds_read_b128 v[44:47],v11 offset:13312
v_exp_f32 v24,v24
v_mfma_f32_16x16x16_bf16 v[112:115],v[126:127],v[124:125],0
ds_read_b128 v[48:51],v11 offset:14336
v_exp_f32 v25,v25
v_mfma_f32_16x16x16_bf16 v[116:119],v[36:37],v[124:125],0
ds_read_b128 v[52:55],v11 offset:15360
v_exp_f32 v26,v26
v_exp_f32 v27,v27
v_cvt_pk_bf16_f32 v120,v24,v25
v_exp_f32 v28,v28
v_exp_f32 v29,v29
v_cvt_pk_bf16_f32 v121,v26,v27
v_exp_f32 v30,v30
v_exp_f32 v31,v31
v_cvt_pk_bf16_f32 v122,v28,v29
v_cvt_pk_bf16_f32 v123,v30,v31
s_add_u32 s75,s75,8192
s_add_u32 s51,s51,1
v_mfma_f32_16x16x32_bf16 v[32:35],v[14:17],v[120:123],v[32:35]
v_mfma_f32_16x16x32_bf16 v[112:115],v[88:91],v[120:123],v[112:115]
ds_read_b128 v[88:91],v11 offset:16384
v_mfma_f32_16x16x32_bf16 v[116:119],v[92:95],v[120:123],v[116:119]
ds_read_b128 v[92:95],v11 offset:17408
v_rcp_f32 v32,v32
v_mov_b64 v[24:25],-1
v_mov_b64 v[26:27],-1
s_add_u32 s64,s75,12582912
s_add_u32 s70,s64,4096
v_pk_mul_f32 v[112:113],v[112:113],v[32:33] op_sel_hi:[1,0]
v_pk_mul_f32 v[114:115],v[114:115],v[32:33] op_sel_hi:[1,0]
v_pk_mul_f32 v[116:117],v[116:117],v[32:33] op_sel_hi:[1,0]
v_pk_mul_f32 v[118:119],v[118:119],v[32:33] op_sel_hi:[1,0]
v_cvt_pk_bf16_f32 v120,v112,v116
v_cvt_pk_bf16_f32 v121,v113,v117
v_cvt_pk_bf16_f32 v122,v114,v118
v_cvt_pk_bf16_f32 v123,v115,v119
ds_write_b128 v7,v[120:123]
buffer_store_dwordx4 v[24:27],v0,s[8:11],s69 offen
buffer_store_dwordx4 v[24:27],v0,s[8:11],s69 offen offset:1024
v_mov_b64 v[112:113],0
v_mov_b64 v[114:115],0
v_mov_b64 v[116:117],0
v_mov_b64 v[118:119],0
s_waitcnt lgkmcnt(0)
s_barrier
ds_read_b128 v[24:27],v8 offset:0
ds_read_b128 v[28:31],v8 offset:512
ds_read_b128 v[32:35],v8 offset:1024
ds_read_b128 v[36:39],v8 offset:1536
v_mov_b64 v[120:121],0
v_mov_b64 v[122:123],0
s_waitcnt lgkmcnt(3)
v_smfmac_f32_16x16x64_bf16 v[112:115],v[24:27],v[56:63],v3
ds_read_b128 v[56:59],v11 offset:18432
s_add_u32 s57,s65,65536
s_waitcnt lgkmcnt(3)
v_smfmac_f32_16x16x64_bf16 v[112:115],v[28:31],v[64:71],v3
ds_read_b128 v[60:63],v11 offset:19456
s_add_u32 s58,s65,131072
s_waitcnt lgkmcnt(3)
v_smfmac_f32_16x16x64_bf16 v[112:115],v[32:35],v[72:79],v3
ds_read_b128 v[64:67],v11 offset:20480
s_add_u32 s59,s65,196608
s_waitcnt lgkmcnt(3)
v_smfmac_f32_16x16x64_bf16 v[112:115],v[36:39],v[80:87],v3
ds_read_b128 v[68:71],v11 offset:21504
s_add_u32 s30,s75,17825792
v_smfmac_f32_16x16x64_bf16 v[116:119],v[24:27],v[96:103],v3
ds_read_b128 v[72:75],v11 offset:22528
v_smfmac_f32_16x16x64_bf16 v[116:119],v[28:31],v[104:111],v3
ds_read_b128 v[76:79],v11 offset:23552
v_cvt_pk_bf16_f32 v112,v112,v113
v_smfmac_f32_16x16x64_bf16 v[116:119],v[32:35],v[40:47],v3
ds_read_b128 v[80:83],v11 offset:24576
v_cvt_pk_bf16_f32 v113,v114,v115
buffer_store_dwordx2 v[112:113],v9,s[8:11],s65 offen
v_smfmac_f32_16x16x64_bf16 v[116:119],v[36:39],v[48:55],v3
ds_read_b128 v[84:87],v11 offset:25600
v_mov_b64 v[112:113],0
v_smfmac_f32_16x16x64_bf16 v[120:123],v[24:27],v[88:95],v3
ds_read_b128 v[96:99],v11 offset:26624
ds_read_b128 v[100:103],v11 offset:27648
v_mov_b64 v[114:115],0
s_waitcnt lgkmcnt(8)
v_smfmac_f32_16x16x64_bf16 v[120:123],v[28:31],v[56:63],v3
ds_read_b128 v[104:107],v11 offset:28672
v_cvt_pk_bf16_f32 v116,v116,v117
s_waitcnt lgkmcnt(7)
v_smfmac_f32_16x16x64_bf16 v[120:123],v[32:35],v[64:71],v3
ds_read_b128 v[108:111],v11 offset:29696
ds_read_b128 v[40:43],v11 offset:30720
v_cvt_pk_bf16_f32 v117,v118,v119
buffer_store_dwordx2 v[116:117],v9,s[8:11],s57 offen
s_waitcnt lgkmcnt(7)
v_smfmac_f32_16x16x64_bf16 v[120:123],v[36:39],v[72:79],v3
ds_read_b128 v[44:47],v11 offset:31744
v_add_u32 v52,s50,v5
s_waitcnt lgkmcnt(6)
v_smfmac_f32_16x16x64_bf16 v[112:115],v[24:27],v[80:87],v3
v_add_u32 v54,s50,v6
s_waitcnt lgkmcnt(4)
v_smfmac_f32_16x16x64_bf16 v[112:115],v[28:31],v[96:103],v3
ds_read_b64_tr_b16 v[52:53],v52
v_cvt_pk_bf16_f32 v120,v120,v121
s_waitcnt lgkmcnt(3)
v_smfmac_f32_16x16x64_bf16 v[112:115],v[32:35],v[104:111],v3
ds_read_b64_tr_b16 v[54:55],v54
v_cvt_pk_bf16_f32 v121,v122,v123
buffer_store_dwordx2 v[120:121],v9,s[8:11],s58 offen
s_waitcnt lgkmcnt(2)
s_add_u32 s56,s18,s75
v_smfmac_f32_16x16x64_bf16 v[112:115],v[36:39],v[40:47],v3
v_mov_b64 v[116:117],0
v_mov_b64 v[118:119],0
s_xor_b32 s65,s65,262144
v_mov_b32_dpp v124,v126 quad_perm:[2,3,2,3] row_mask:0xf bank_mask:0xf
v_mov_b32_dpp v125,v127 quad_perm:[2,3,2,3] row_mask:0xf bank_mask:0xf
s_mov_b32 vcc_lo,0xcccccccc
s_mov_b32 vcc_hi,0xcccccccc
s_nop 0
v_cvt_pk_bf16_f32 v112,v112,v113
v_cvt_pk_bf16_f32 v113,v114,v115
buffer_store_dwordx2 v[112:113],v9,s[8:11],s59 offen
s_waitcnt lgkmcnt(0)
s_buffer_load_dword s19,s[8:11],s56
v_cndmask_b32 v124,v124,v52,vcc
v_cndmask_b32 v125,v125,v53,vcc
v_cndmask_b32 v126,v126,v54,vcc
v_cndmask_b32 v127,v127,v55,vcc
v_mov_b64 v[96:97],0
v_mov_b64 v[98:99],0
v_mov_b64 v[100:101],0
v_mov_b64 v[102:103],0
v_mov_b64 v[104:105],0
v_mov_b64 v[106:107],0
v_mov_b64 v[108:109],0
v_mov_b64 v[110:111],0
v_mov_b64 v[112:113],0
v_mov_b64 v[114:115],0
v_add_u32 v55,131072,v0
v_add_u32 v123,s73,v55
v_xor_b32 v120,1024,v12
v_xor_b32 v121,2048,v12
v_xor_b32 v122,3072,v12
s_cmp_lt_u32 s46,2
s_waitcnt vmcnt(2)
s_cbranch_scc1 L_crg_179
s_cmp_eq_u32 s46,2
s_waitcnt vmcnt(1)
s_cbranch_scc1 L_crg_179
s_waitcnt vmcnt(0)
L_crg_179:
buffer_load_dwordx4 v[32:35],v0,s[8:11],s66 offen offset:0 sc1
buffer_load_dwordx4 v[36:39],v0,s[8:11],s66 offen offset:1024 sc1
s_cmp_ge_u32 s51,63
s_cselect_b32 s76,0,1
s_cmp_eq_u32 s46,0
s_cselect_b32 s76,s76,0
s_waitcnt vmcnt(1)
v_mfma_f32_16x16x32_bf16 v[28:31],v[18:21],v[32:35],0
s_waitcnt vmcnt(0)
v_mfma_f32_16x16x32_bf16 v[28:31],v[18:21],v[36:39],v[28:31]
s_nop 7
v_cmp_u_f32 vcc,v28,v28
v_add_f32_dpp v52,v28,v28 row_ror:8 row_mask:0xf bank_mask:0x3
v_add_f32_dpp v53,v29,v29 row_ror:8 row_mask:0xf bank_mask:0x3
v_add_f32_dpp v52,v30,v30 row_ror:8 row_mask:0xf bank_mask:0xc
v_add_f32_dpp v53,v31,v31 row_ror:8 row_mask:0xf bank_mask:0xc
s_nop 0
v_add_f32_dpp v52,v52,v52 row_shl:4 row_mask:0xf bank_mask:0x5
v_add_f32_dpp v53,v53,v53 row_shl:4 row_mask:0xf bank_mask:0x5
s_cbranch_vccnz L_crp_174
L_cok_180:
v_cvt_pk_bf16_f32 v54,v52,v53
buffer_store_dword v54,v10,s[8:11],s64 offen
s_mov_b32 s69,s66
s_xor_b32 s66,s66,262144
s_barrier
ds_read_b128 v[56:59],v55 offset:0
ds_read_b128 v[60:63],v55 offset:4096
ds_read_b128 v[64:67],v55 offset:1024
buffer_load_dwordx4 v[24:27],v13,s[8:11],s64 offen sc1
ds_read_b128 v[68:71],v55 offset:5120
ds_read_b128 v[72:75],v55 offset:2048
ds_read_b128 v[76:79],v55 offset:6144
ds_read_b128 v[80:83],v55 offset:3072
buffer_load_dwordx4 v[24:27],v13,s[8:11],s64 offen sc1
ds_read_b128 v[84:87],v55 offset:7168
ds_read_b128 v[88:91],v123 offset:8192
ds_read_b128 v[92:95],v123 offset:9216
s_branch L_chain_169
L_cpb_176:
buffer_load_dwordx4 v[40:43],v13,s[8:11],s70 offen sc1
s_sub_u32 s49,s49,1
s_cbranch_scc1 L_abort
s_waitcnt vmcnt(0)
v_max3_u32 v123,v40,v41,v42
v_max_u32 v123,v43,v123
v_cmp_le_u32 vcc,s72,v123
s_cbranch_vccnz L_cpb_176
ds_write_b128 v12,v[40:43] offset:4096
s_branch L_cback_178
L_crp_174:
buffer_load_dwordx4 v[32:35],v0,s[8:11],s66 offen offset:0 sc1
buffer_load_dwordx4 v[36:39],v0,s[8:11],s66 offen offset:1024 sc1
s_sub_u32 s49,s49,1
s_cbranch_scc1 L_abort
s_waitcnt vmcnt(1)
v_mfma_f32_16x16x32_bf16 v[28:31],v[18:21],v[32:35],0
s_waitcnt vmcnt(0)
v_mfma_f32_16x16x32_bf16 v[28:31],v[18:21],v[36:39],v[28:31]
s_nop 7
v_cmp_u_f32 vcc,v28,v28
v_add_f32_dpp v52,v28,v28 row_ror:8 row_mask:0xf bank_mask:0x3
v_add_f32_dpp v53,v29,v29 row_ror:8 row_mask:0xf bank_mask:0x3
v_add_f32_dpp v52,v30,v30 row_ror:8 row_mask:0xf bank_mask:0xc
v_add_f32_dpp v53,v31,v31 row_ror:8 row_mask:0xf bank_mask:0xc
s_nop 0
v_add_f32_dpp v52,v52,v52 row_shl:4 row_mask:0xf bank_mask:0x5
v_add_f32_dpp v53,v53,v53 row_shl:4 row_mask:0xf bank_mask:0x5
s_cbranch_vccz L_cok_180
s_branch L_crp_174
L_ckw_162:
s_add_u32 s59,s18,s75
L_ww_181:
s_sleep 1
buffer_load_dword v23,off,s[8:11],s59 sc1
s_sub_u32 s49,s49,1
s_cbranch_scc1 L_abort
s_waitcnt vmcnt(0)
v_readfirstlane_b32 s76,v23
s_cmp_eq_u32 s76,0
s_cbranch_scc1 L_ww_181
L_wwd_182:
s_branch L_ckb_163
L_cend_172:
v_smfmac_f32_16x16x64_bf16 v[116:119],v[36:39],v[184:191],v2
v_smfmac_f32_16x16x64_bf16 v[112:115],v[40:43],v[192:199],v2
v_smfmac_f32_16x16x64_bf16 v[116:119],v[40:43],v[200:207],v2
v_smfmac_f32_16x16x64_bf16 v[112:115],v[44:47],v[208:215],v2
v_smfmac_f32_16x16x64_bf16 v[116:119],v[44:47],v[216:223],v2
v_smfmac_f32_16x16x64_bf16 v[112:115],v[48:51],v[224:231],v2
v_smfmac_f32_16x16x64_bf16 v[116:119],v[48:51],v[232:239],v2
v_smfmac_f32_16x16x64_bf16 v[112:115],v[52:55],v[240:247],v2
v_smfmac_f32_16x16x64_bf16 v[116:119],v[52:55],v[248:255],v2
s_waitcnt lgkmcnt(0)
s_nop 2
v_pk_add_f32 v[112:113],v[112:113],v[114:115]
s_nop 2
v_pk_add_f32 v[116:117],v[116:117],v[118:119]
v_cvt_pk_bf16_f32 v126,v112,v113
v_cvt_pk_bf16_f32 v127,v116,v117
v_add_u32 v52,s50,v5
v_add_u32 v54,s50,v6
ds_read_b64_tr_b16 v[52:53],v52
ds_read_b64_tr_b16 v[54:55],v54
v_mov_b32_dpp v124,v126 quad_perm:[2,3,2,3] row_mask:0xf bank_mask:0xf
v_mov_b32_dpp v125,v127 quad_perm:[2,3,2,3] row_mask:0xf bank_mask:0xf
s_mov_b32 vcc_lo,0xcccccccc
s_mov_b32 vcc_hi,0xcccccccc
s_waitcnt lgkmcnt(0)
v_cndmask_b32 v124,v124,v52,vcc
v_cndmask_b32 v125,v125,v53,vcc
v_cndmask_b32 v126,v126,v54,vcc
v_cndmask_b32 v127,v127,v55,vcc
buffer_store_dwordx4 v[124:127],v0,s[8:11],s54 offen sc1
s_mov_b32 s51,64
s_waitcnt vmcnt(0)
s_barrier
s_nop 11
v_lshrrev_b32 v1,4,v0
s_endpgm
L_rc2_132:
v_and_b32 v120,15,v1
v_lshrrev_b32 v121,4,v1
v_and_b32 v122,2,v1
v_cmp_eq_u32 vcc,0,v122
v_mov_b32 v2,0xeeee
v_mov_b32 v123,0x4444
v_cndmask_b32 v2,v2,v123,vcc
v_and_b32 v122,1,v1
v_cmp_eq_u32 vcc,0,v122
v_mov_b32 v3,0xdddd
v_mov_b32 v123,0x8888
v_cndmask_b32 v3,v3,v123,vcc
v_lshrrev_b32 v122,1,v120
v_bfe_u32 v123,v120,2,1
v_xor_b32 v123,v123,v122
v_lshlrev_b32 v4,7,v123
v_and_b32 v123,1,v120
v_lshl_add_u32 v4,v123,6,v4
v_xor_b32 v123,v121,v122
v_and_b32 v123,3,v123
v_lshl_add_u32 v4,v123,4,v4
s_lshl_b32 s56,s46,10
s_add_u32 s56,s56,147456
v_add_u32 v4,s56,v4
v_lshlrev_b32 v122,1,v121
v_add_u32 v122,0,v122
v_and_b32 v123,1,v121
v_xor_b32 v123,v123,v122
v_lshlrev_b32 v5,7,v123
v_bfe_u32 v123,v120,3,1
v_lshl_add_u32 v5,v123,6,v5
v_xor_b32 v123,v120,v122
v_and_b32 v123,3,v123
v_lshl_add_u32 v5,v123,4,v5
v_bfe_u32 v123,v120,2,1
v_lshl_add_u32 v5,v123,3,v5
v_add_u32 v5,147456,v5
v_lshlrev_b32 v122,1,v121
v_add_u32 v122,1,v122
v_and_b32 v123,1,v121
v_xor_b32 v123,v123,v122
v_lshlrev_b32 v6,7,v123
v_bfe_u32 v123,v120,3,1
v_lshl_add_u32 v6,v123,6,v6
v_xor_b32 v123,v120,v122
v_and_b32 v123,3,v123
v_lshl_add_u32 v6,v123,4,v6
v_bfe_u32 v123,v120,2,1
v_lshl_add_u32 v6,v123,3,v6
v_add_u32 v6,147456,v6
v_lshlrev_b32 v7,7,v121
v_lshrrev_b32 v122,1,v120
v_lshl_add_u32 v8,v122,4,v7
v_add_u32 v8,151552,v8
v_lshrrev_b32 v122,2,v120
v_lshl_add_u32 v7,v122,5,v7
v_and_b32 v122,1,v120
v_lshl_add_u32 v7,v122,4,v7
v_and_b32 v122,2,v120
v_cmp_eq_u32 vcc,0,v122
s_lshl_b32 s56,s46,9
v_mov_b32 v122,2048
v_mov_b32 v123,s56
v_cndmask_b32 v122,v122,v123,vcc
v_add_u32 v7,v122,v7
v_add_u32 v7,151552,v7
v_lshrrev_b32 v122,3,v1
v_lshlrev_b32 v9,11,v122
v_and_b32 v122,7,v1
v_lshl_add_u32 v9,v122,3,v9
s_lshl_b32 s56,s46,14
s_lshl_b32 s57,s47,6
s_add_u32 s56,s56,s57
v_add_u32 v9,s56,v9
s_lshl_b32 s71,s46,5
s_add_u32 s71,s71,s47
s_bfe_u32 s56,s71,0x10003
s_lshl_b32 s56,s56,11
s_and_b32 s57,s71,1
s_lshl_b32 s57,s57,10
s_add_u32 s56,s56,s57
s_bfe_u32 s57,s71,0x10002
s_lshl_b32 s57,s57,9
s_add_u32 s56,s56,s57
s_bfe_u32 s57,s71,0x10001
s_lshl_b32 s57,s57,6
s_add_u32 s56,s56,s57
s_bfe_u32 s57,s71,0x10004
s_lshl_b32 s57,s57,8
s_add_u32 s56,s56,s57
s_bfe_u32 s57,s71,0x10005
s_lshl_b32 s57,s57,7
s_add_u32 s56,s56,s57
s_bfe_u32 s57,s71,0x10006
s_lshl_b32 s57,s57,12
s_add_u32 s56,s56,s57
v_and_b32 v122,3,v120
v_lshlrev_b32 v10,2,v122
v_bfe_u32 v122,v120,3,1
v_lshl_add_u32 v10,v122,4,v10
v_and_b32 v122,1,v121
v_lshl_add_u32 v10,v122,5,v10
v_add_u32 v10,s56,v10
v_and_b32 v123,36,v1
v_mov_b32 v122,0x80000000
v_cmp_eq_u32 vcc,0,v123
s_nop 1
v_cndmask_b32 v10,v122,v10,vcc
s_lshl_b32 s56,s46,15
v_add_u32 v11,s56,v0
s_lshl_b32 s71,s71,11
s_lshl_b32 s73,s46,11
s_mov_b32 s72,0xffc00000
s_mov_b32 s74,0
v_lshrrev_b32 v13,3,v1
v_lshlrev_b32 v13,9,v13
v_and_b32 v122,7,v1
v_lshl_add_u32 v13,v122,4,v13
v_and_b32 v122,15,v1
v_and_b32 v123,1,v1
v_lshlrev_b32 v123,4,v123
v_mov_b32 v124,0x3f80
v_lshlrev_b32 v124,v123,v124
v_lshrrev_b32 v122,1,v122
v_cmp_eq_u32 vcc,0,v122
s_nop 1
v_cndmask_b32 v18,0,v124,vcc
v_cmp_eq_u32 vcc,1,v122
s_nop 1
v_cndmask_b32 v19,0,v124,vcc
v_cmp_eq_u32 vcc,2,v122
s_nop 1
v_cndmask_b32 v20,0,v124,vcc
v_cmp_eq_u32 vcc,3,v122
s_nop 1
v_cndmask_b32 v21,0,v124,vcc
s_and_b32 s56,s46,1
s_lshl_b32 s56,s56,8
s_and_b32 s57,s46,2
s_lshl_b32 s57,s57,6
s_add_u32 s56,s56,s57
v_add_u32 v13,s56,v13
s_add_u32 s56,s50,155648
v_add_u32 v12,s56,v0
v_mov_b64 v[14:15],s[28:29]
v_mov_b64 v[16:17],s[28:29]
v_add_u32 v22,13647872,v10
s_lshl_b32 s18,s47,2
s_add_u32 s18,s18,10494080
v_mov_b32 v1,s80
s_mov_b32 s65,16777216
s_add_u32 s66,s71,16777216
s_add_u32 s69,s71,17039360
s_mov_b32 s30,0x40000000
s_mov_b32 s51,0
v_lshrrev_b32 v120,2,v0
v_add_u32 v120,10510464,v120
v_or_b32 v120,s52,v120
s_mov_b64 vcc,-1
s_mov_b32 vcc_lo,0
v_cndmask_b32 v22,v22,v120,vcc
s_or_b32 s56,s52,10495616
v_writelane_b32 v22,s56,4
s_or_b32 s56,s47,s46
s_mov_b32 s56,10486784
s_cmov_b32 s56,0x80000000
v_writelane_b32 v22,s56,5
s_mov_b32 s30,0
s_mov_b32 s31,0
buffer_load_dwordx4 v[56:59],v0,s[8:11],s66 offen offset:0
buffer_load_dwordx4 v[60:63],v0,s[8:11],s66 offen offset:1024
buffer_load_dwordx4 v[64:67],v0,s[8:11],s69 offen offset:0
buffer_load_dwordx4 v[68:71],v0,s[8:11],s69 offen offset:1024
s_waitcnt vmcnt(0)
L_cst_186:
s_cmp_lg_u32 s46,0
s_cbranch_scc1 L_csw_191
s_lshl_b32 s59,s31,13
s_add_u32 s59,s59,10486016
v_lshrrev_b32 v121,2,v0
v_and_b32 v121,127,v121
L_ckk_192:
s_sleep 1
buffer_load_dword v120,v121,s[8:11],s59 offen sc1
s_sub_u32 s49,s49,1
s_cbranch_scc1 L_abort
s_waitcnt vmcnt(0)
v_cmp_eq_u32 vcc,0,v120
s_cbranch_vccnz L_ckk_192
v_max_u32_dpp v120,v120,v120 row_ror:8 row_mask:0xf bank_mask:0xf
s_nop 1
v_max_u32_dpp v120,v120,v120 row_ror:4 row_mask:0xf bank_mask:0xf
s_nop 1
v_max_u32_dpp v120,v120,v120 row_ror:2 row_mask:0xf bank_mask:0xf
s_nop 1
v_max_u32_dpp v120,v120,v120 row_ror:1 row_mask:0xf bank_mask:0xf
v_mov_b32 v121,v120
s_nop 1
v_permlane16_swap_b32 v120,v121
v_max_u32 v120,v120,v121
v_mov_b32 v121,v120
s_nop 1
v_permlane32_swap_b32 v120,v121
v_max_u32 v120,v120,v121
s_nop 0
v_readfirstlane_b32 s61,v120
s_max_u32 s30,s30,s61
s_add_u32 s31,s31,1
s_andn2_b32 s51,0x7ff,s30
s_lshr_b32 s51,s51,5
s_add_u32 s61,s51,2
s_min_u32 s61,s61,63
s_cmp_le_u32 s31,s61
s_cbranch_scc1 L_cst_186
v_mov_b32 v120,0
v_mov_b32 v121,s30
ds_write_b32 v8,v120 offset:2560
ds_write_b32 v8,v121 offset:3072
s_lshl_b32 s59,s51,13
s_lshl2_add_u32 s59,s47,s59
s_add_u32 s59,s59,10485888
L_ww_193:
s_sleep 1
buffer_load_dword v122,off,s[8:11],s59 sc1
s_sub_u32 s49,s49,1
s_cbranch_scc1 L_abort
s_waitcnt vmcnt(0)
v_readfirstlane_b32 s61,v122
s_cmp_eq_u32 s61,0
s_cbranch_scc1 L_ww_193
L_wwd_194:
L_csw_191:
s_waitcnt lgkmcnt(0)
s_barrier
ds_read_b32 v120,v8 offset:3072
s_waitcnt lgkmcnt(0)
v_readfirstlane_b32 s30,v120
s_andn2_b32 s51,0x7ff,s30
s_lshr_b32 s51,s51,5
s_lshl_b32 s56,s51,5
s_add_u32 s56,s56,s47
s_mul_i32 s56,s56,24576
s_add_u32 s56,s56,150994944
s_add_u32 s67,s56,s73
s_add_u32 m0,s73,131072
s_add_u32 s57,s67,8192
buffer_load_dwordx4 v0,s[8:11],s67 offen sc1 lds
buffer_load_dwordx4 v0,s[8:11],s67 offen offset:1024 sc1 lds
s_add_u32 m0,s73,139264
s_add_u32 s67,s67,786432
buffer_load_dwordx4 v0,s[8:11],s57 offen sc1 lds
buffer_load_dwordx4 v0,s[8:11],s57 offen offset:1024 sc1 lds
s_lshl_b32 s75,s51,13
s_add_u32 s56,s75,13639680
buffer_load_dword v23,v10,s[8:11],s56 offen sc1
s_add_u32 s64,s75,17825792
s_add_u32 s70,s64,4096
s_lshl_b32 s68,s51,5
s_add_u32 s68,s68,s47
s_lshl_b32 s68,s68,12
s_lshl_b32 s56,s46,10
s_add_u32 s68,s68,s56
s_add_u32 s68,s68,75497472
s_mov_b32 s54,0x80000000
s_mov_b32 s77,0
s_mov_b32 s19,0
s_cmp_eq_u32 s51,63
s_cselect_b32 s76,1,s46
s_cmp_eq_u32 s76,0
s_cselect_b32 s76,1,0
v_mov_b64 v[96:97],0
v_mov_b64 v[98:99],0
v_mov_b64 v[100:101],0
v_mov_b64 v[102:103],0
v_mov_b64 v[104:105],0
v_mov_b64 v[106:107],0
v_mov_b64 v[108:109],0
v_mov_b64 v[110:111],0
v_mov_b64 v[112:113],0
v_mov_b64 v[114:115],0
v_mov_b64 v[116:117],0
v_mov_b64 v[118:119],0
v_lshrrev_b32 v56,8,v0
v_lshlrev_b32 v56,5,v56
v_bfe_u32 v57,v0,5,1
v_lshl_add_u32 v56,v57,2,v56
s_lshl_b32 s56,s46,7
s_add_u32 s56,s56,155648
v_add_u32 v56,s56,v56
v_xor_b32 v57,128,v56
v_xor_b32 v58,256,v56
v_xor_b32 v59,384,v56
s_andn2_b32 s56,31,s30
s_lshr_b32 s57,s56,4
s_lshl_b32 s58,s57,12
s_and_b32 s59,s56,15
s_lshl4_add_u32 s58,s59,s58
s_add_u32 s58,s58,s50
s_add_u32 s58,s58,131072
v_bfe_u32 v60,v0,6,2
v_lshlrev_b32 v60,8,v60
v_bfe_u32 v61,v0,4,2
v_lshl_add_u32 v60,v61,2,v60
v_add_u32 v60,s58,v60
s_lshr_b32 s58,s59,2
s_lshl_b32 s58,s58,8
s_lshl3_add_u32 s58,s57,s58
s_and_b32 s59,s56,3
s_lshl1_add_u32 s58,s59,s58
s_add_u32 s58,s58,s73
s_add_u32 s58,s58,139264
v_and_b32 v61,255,v0
v_add_u32 v61,s58,v61
s_cmp_lg_u32 s46,0
s_cbranch_scc1 L_chd_196
s_lshl_b32 s59,s51,10
s_add_u32 s59,s59,11337728
L_chp_195:
buffer_load_dwordx4 v[120:123],v0,s[8:11],s59 offen sc1
s_sub_u32 s49,s49,1
s_cbranch_scc1 L_abort
s_waitcnt vmcnt(0)
v_max3_u32 v124,v120,v121,v122
v_max_u32 v124,v123,v124
v_cmp_eq_u32 vcc,-1,v124
s_cbranch_vccnz L_chp_195
ds_write_b128 v12,v[120:123]
L_chd_196:
s_waitcnt vmcnt(0) lgkmcnt(0)
s_barrier
ds_read2_b32 v[24:25],v56 offset0:0 offset1:2
ds_read2_b32 v[26:27],v56 offset0:4 offset1:6
ds_read2_b32 v[28:29],v57 offset0:0 offset1:2
ds_read2_b32 v[30:31],v57 offset0:4 offset1:6
ds_read2_b32 v[32:33],v58 offset0:0 offset1:2
ds_read2_b32 v[34:35],v58 offset0:4 offset1:6
ds_read2_b32 v[36:37],v59 offset0:0 offset1:2
ds_read2_b32 v[38:39],v59 offset0:4 offset1:6
s_waitcnt lgkmcnt(4)
ds_read2_b32 v[40:41],v56 offset0:128 offset1:130
ds_read2_b32 v[42:43],v56 offset0:132 offset1:134
ds_read2_b32 v[44:45],v57 offset0:128 offset1:130
ds_read2_b32 v[46:47],v57 offset0:132 offset1:134
ds_read2_b32 v[48:49],v58 offset0:128 offset1:130
ds_read2_b32 v[50:51],v58 offset0:132 offset1:134
ds_read2_b32 v[52:53],v59 offset0:128 offset1:130
ds_read2_b32 v[54:55],v59 offset0:132 offset1:134
s_waitcnt lgkmcnt(12)
v_smfmac_f32_16x16x64_bf16 v[100:103],v[24:27],a[128:135],v2
v_smfmac_f32_16x16x64_bf16 v[112:115],v[24:27],v[128:135],v2
v_smfmac_f32_16x16x64_bf16 v[108:111],v[24:27],a[136:143],v2
v_smfmac_f32_16x16x64_bf16 v[116:119],v[24:27],v[136:143],v2
s_waitcnt lgkmcnt(12)
v_smfmac_f32_16x16x64_bf16 v[100:103],v[28:31],a[144:151],v2
v_smfmac_f32_16x16x64_bf16 v[112:115],v[28:31],v[144:151],v2
v_smfmac_f32_16x16x64_bf16 v[108:111],v[28:31],a[152:159],v2
v_smfmac_f32_16x16x64_bf16 v[116:119],v[28:31],v[152:159],v2
s_waitcnt lgkmcnt(10)
v_smfmac_f32_16x16x64_bf16 v[100:103],v[32:35],a[160:167],v2
v_smfmac_f32_16x16x64_bf16 v[112:115],v[32:35],v[160:167],v2
v_smfmac_f32_16x16x64_bf16 v[108:111],v[32:35],a[168:175],v2
v_smfmac_f32_16x16x64_bf16 v[116:119],v[32:35],v[168:175],v2
s_waitcnt lgkmcnt(8)
v_smfmac_f32_16x16x64_bf16 v[100:103],v[36:39],a[176:183],v2
v_smfmac_f32_16x16x64_bf16 v[112:115],v[36:39],v[176:183],v2
v_smfmac_f32_16x16x64_bf16 v[108:111],v[36:39],a[184:191],v2
v_smfmac_f32_16x16x64_bf16 v[116:119],v[36:39],v[184:191],v2
s_waitcnt lgkmcnt(6)
v_smfmac_f32_16x16x64_bf16 v[100:103],v[40:43],a[192:199],v2
v_smfmac_f32_16x16x64_bf16 v[112:115],v[40:43],v[192:199],v2
v_smfmac_f32_16x16x64_bf16 v[108:111],v[40:43],a[200:207],v2
v_smfmac_f32_16x16x64_bf16 v[116:119],v[40:43],v[200:207],v2
s_waitcnt lgkmcnt(4)
v_smfmac_f32_16x16x64_bf16 v[100:103],v[44:47],a[208:215],v2
v_smfmac_f32_16x16x64_bf16 v[112:115],v[44:47],v[208:215],v2
v_smfmac_f32_16x16x64_bf16 v[108:111],v[44:47],a[216:223],v2
v_smfmac_f32_16x16x64_bf16 v[116:119],v[44:47],v[216:223],v2
s_waitcnt lgkmcnt(2)
v_smfmac_f32_16x16x64_bf16 v[100:103],v[48:51],a[224:231],v2
v_smfmac_f32_16x16x64_bf16 v[112:115],v[48:51],v[224:231],v2
v_smfmac_f32_16x16x64_bf16 v[108:111],v[48:51],a[232:239],v2
v_smfmac_f32_16x16x64_bf16 v[116:119],v[48:51],v[232:239],v2
s_waitcnt lgkmcnt(0)
v_smfmac_f32_16x16x64_bf16 v[100:103],v[52:55],a[240:247],v2
v_smfmac_f32_16x16x64_bf16 v[112:115],v[52:55],v[240:247],v2
v_smfmac_f32_16x16x64_bf16 v[108:111],v[52:55],a[248:255],v2
v_smfmac_f32_16x16x64_bf16 v[116:119],v[52:55],v[248:255],v2
v_add_f32 v100,v100,v102
v_add_f32 v112,v112,v114
s_nop 1
v_add_f32 v108,v108,v110
s_nop 2
v_add_f32 v116,v116,v118
v_cvt_pk_bf16_f32 v120,v100,v108
v_cvt_pk_bf16_f32 v121,v112,v116
ds_write_b32 v60,v120
ds_write_b16 v61,v121
ds_write_b16_d16_hi v61,v121 offset:1024
v_mov_b64 v[96:97],0
v_mov_b64 v[98:99],0
v_mov_b64 v[100:101],0
v_mov_b64 v[102:103],0
v_mov_b64 v[104:105],0
v_mov_b64 v[106:107],0
v_mov_b64 v[108:109],0
v_mov_b64 v[110:111],0
v_mov_b64 v[112:113],0
v_mov_b64 v[114:115],0
v_mov_b64 v[116:117],0
v_mov_b64 v[118:119],0
s_waitcnt vmcnt(0) lgkmcnt(0)
s_barrier
v_add_u32 v55,131072,v0
ds_read_b128 v[56:59],v55 offset:0
ds_read_b128 v[60:63],v55 offset:4096
ds_read_b128 v[64:67],v55 offset:1024
ds_read_b128 v[68:71],v55 offset:5120
ds_read_b128 v[72:75],v55 offset:2048
ds_read_b128 v[76:79],v55 offset:6144
ds_read_b128 v[80:83],v55 offset:3072
ds_read_b128 v[84:87],v55 offset:7168
v_add_u32 v123,s73,v55
ds_read_b128 v[88:91],v123 offset:8192
ds_read_b128 v[92:95],v123 offset:9216
v_xor_b32 v120,1024,v12
v_xor_b32 v121,2048,v12
v_xor_b32 v122,3072,v12
buffer_load_dwordx4 v[24:27],v13,s[8:11],s64 offen sc1
buffer_load_dwordx4 v[24:27],v13,s[8:11],s64 offen sc1
L_chain_197:
L_cpa_198:
buffer_load_dwordx4 v[24:27],v13,s[8:11],s64 offen sc1
s_sub_u32 s49,s49,1
s_cbranch_scc1 L_abort
s_waitcnt vmcnt(2)
v_max3_u32 v123,v24,v25,v26
v_max_u32 v123,v27,v123
v_cmp_le_u32 vcc,s72,v123
s_cbranch_vccnz L_cpa_198
L_cgo_201:
ds_write_b128 v12,v[24:27] offset:0
v_smfmac_f32_16x16x64_bf16 v[96:99],v[24:27],a[0:7],v2
buffer_load_dwordx4 v[40:43],v13,s[8:11],s70 offen sc1
v_smfmac_f32_16x16x64_bf16 v[100:103],v[24:27],a[128:135],v2
v_smfmac_f32_16x16x64_bf16 v[104:107],v[24:27],a[8:15],v2
v_smfmac_f32_16x16x64_bf16 v[108:111],v[24:27],a[136:143],v2
s_waitcnt lgkmcnt(0)
s_barrier
ds_read_b128 v[28:31],v120 offset:0
v_smfmac_f32_16x16x64_bf16 v[112:115],v[24:27],v[128:135],v2
ds_read_b128 v[32:35],v121 offset:0
v_smfmac_f32_16x16x64_bf16 v[116:119],v[24:27],v[136:143],v2
ds_read_b128 v[36:39],v122 offset:0
s_waitcnt lgkmcnt(2)
v_smfmac_f32_16x16x64_bf16 v[96:99],v[28:31],a[16:23],v2
s_add_u32 m0,s73,131072
v_smfmac_f32_16x16x64_bf16 v[100:103],v[28:31],a[144:151],v2
s_add_u32 s57,s67,8192
v_smfmac_f32_16x16x64_bf16 v[104:107],v[28:31],a[24:31],v2
s_cmp_lt_u32 s19,s76
s_cbranch_scc1 L_ckw_187
L_ckb_188:
v_smfmac_f32_16x16x64_bf16 v[108:111],v[28:31],a[152:159],v2
s_waitcnt vmcnt(0) lgkmcnt(1)
v_smfmac_f32_16x16x64_bf16 v[96:99],v[32:35],a[32:39],v2
ds_write_b128 v12,v[40:43] offset:4096
v_max3_u32 v123,v40,v41,v42
v_smfmac_f32_16x16x64_bf16 v[100:103],v[32:35],a[160:167],v2
v_max_u32 v123,v43,v123
v_smfmac_f32_16x16x64_bf16 v[104:107],v[32:35],a[40:47],v2
v_cmp_le_u32 vcc,s72,v123
v_smfmac_f32_16x16x64_bf16 v[108:111],v[32:35],a[168:175],v2
v_smfmac_f32_16x16x64_bf16 v[112:115],v[28:31],v[144:151],v2
s_cbranch_vccnz L_cpb_204
L_cback_206:
s_waitcnt lgkmcnt(0)
s_barrier
ds_read_b32 v123,v8 offset:2560
v_smfmac_f32_16x16x64_bf16 v[96:99],v[36:39],a[48:55],v2
buffer_store_dwordx4 v[124:127],v0,s[8:11],s54 offen sc1
v_smfmac_f32_16x16x64_bf16 v[100:103],v[36:39],a[176:183],v2
ds_read_b128 v[44:47],v120 offset:4096
v_smfmac_f32_16x16x64_bf16 v[104:107],v[36:39],a[56:63],v2
buffer_load_dwordx4 v0,s[8:11],s67 offen sc1 lds
v_smfmac_f32_16x16x64_bf16 v[108:111],v[36:39],a[184:191],v2
ds_read_b128 v[48:51],v121 offset:4096
v_smfmac_f32_16x16x64_bf16 v[96:99],v[40:43],a[64:71],v2
buffer_load_dwordx4 v0,s[8:11],s67 offen offset:1024 sc1 lds
s_add_u32 m0,s73,139264
v_smfmac_f32_16x16x64_bf16 v[100:103],v[40:43],a[192:199],v2
ds_read_b128 v[52:55],v122 offset:4096
v_smfmac_f32_16x16x64_bf16 v[104:107],v[40:43],a[72:79],v2
buffer_load_dwordx4 v0,s[8:11],s57 offen sc1 lds
s_add_u32 s67,s67,786432
v_smfmac_f32_16x16x64_bf16 v[108:111],v[40:43],a[200:207],v2
s_waitcnt lgkmcnt(2)
v_smfmac_f32_16x16x64_bf16 v[96:99],v[44:47],a[80:87],v2
buffer_load_dwordx4 v0,s[8:11],s57 offen offset:1024 sc1 lds
v_smfmac_f32_16x16x64_bf16 v[100:103],v[44:47],a[208:215],v2
v_readfirstlane_b32 s58,v123
s_waitcnt lgkmcnt(1)
v_smfmac_f32_16x16x64_bf16 v[96:99],v[48:51],a[96:103],v2
buffer_load_dword v23,v22,s[8:11],s75 offen sc1
v_smfmac_f32_16x16x64_bf16 v[100:103],v[48:51],a[224:231],v2
s_cmp_lg_u32 s58,0
s_cbranch_scc1 L_cjump_190
s_waitcnt lgkmcnt(0)
v_smfmac_f32_16x16x64_bf16 v[96:99],v[52:55],a[112:119],v2
v_smfmac_f32_16x16x64_bf16 v[100:103],v[52:55],a[240:247],v2
v_smfmac_f32_16x16x64_bf16 v[104:107],v[44:47],a[88:95],v2
v_smfmac_f32_16x16x64_bf16 v[108:111],v[44:47],a[216:223],v2
v_smfmac_f32_16x16x64_bf16 v[104:107],v[48:51],a[104:111],v2
v_add_f32 v96,v96,v98
v_smfmac_f32_16x16x64_bf16 v[108:111],v[48:51],a[232:239],v2
v_add_f32 v97,v97,v99
v_smfmac_f32_16x16x64_bf16 v[104:107],v[52:55],a[120:127],v2
v_cvt_pk_bf16_f32 v120,v96,v97
v_smfmac_f32_16x16x64_bf16 v[108:111],v[52:55],a[248:255],v2
v_add_f32 v100,v100,v102
v_smfmac_f32_16x16x64_bf16 v[116:119],v[28:31],v[152:159],v2
v_add_f32 v101,v101,v103
v_smfmac_f32_16x16x64_bf16 v[112:115],v[32:35],v[160:167],v2
v_cvt_pk_bf16_f32 v121,v100,v101
v_add_f32 v104,v104,v106
v_add_f32 v105,v105,v107
v_cvt_pk_bf16_f32 v122,v104,v105
v_add_f32 v108,v108,v110
v_add_f32 v109,v109,v111
v_cvt_pk_bf16_f32 v123,v108,v109
ds_write_b128 v4,v[120:123]
v_smfmac_f32_16x16x64_bf16 v[116:119],v[32:35],v[168:175],v2
s_mov_b32 s54,s68
s_add_u32 s68,s68,131072
v_mov_b32 v125,0
v_smfmac_f32_16x16x64_bf16 v[112:115],v[36:39],v[176:183],v2
s_cmp_eq_u32 s51,63
s_cbranch_scc1 L_cend_200
v_smfmac_f32_16x16x64_bf16 v[116:119],v[36:39],v[184:191],v2
v_smfmac_f32_16x16x64_bf16 v[112:115],v[40:43],v[192:199],v2
s_waitcnt lgkmcnt(0)
s_barrier
ds_read_b64_tr_b16 v[96:97],v5 offset:0
ds_read_b64_tr_b16 v[98:99],v6 offset:0
v_smfmac_f32_16x16x64_bf16 v[116:119],v[40:43],v[200:207],v2
ds_read_b64_tr_b16 v[100:101],v5 offset:1024
v_smfmac_f32_16x16x64_bf16 v[112:115],v[44:47],v[208:215],v2
ds_read_b64_tr_b16 v[102:103],v6 offset:1024
v_smfmac_f32_16x16x64_bf16 v[116:119],v[44:47],v[216:223],v2
ds_read_b64_tr_b16 v[104:105],v5 offset:2048
v_smfmac_f32_16x16x64_bf16 v[112:115],v[48:51],v[224:231],v2
ds_read_b64_tr_b16 v[106:107],v6 offset:2048
s_waitcnt lgkmcnt(4)
v_mfma_f32_16x16x32_bf16 v[24:27],v[56:59],v[96:99],0
ds_read_b64_tr_b16 v[108:109],v5 offset:3072
v_mfma_f32_16x16x32_bf16 v[28:31],v[60:63],v[96:99],0
ds_read_b64_tr_b16 v[110:111],v6 offset:3072
v_mfma_f32_16x16x32_bf16 v[32:35],v[96:99],v[96:99],0
ds_read_b128 v[40:43],v11 offset:12288
s_waitcnt lgkmcnt(5)
v_mfma_f32_16x16x32_bf16 v[24:27],v[64:67],v[100:103],v[24:27]
ds_read_b128 v[56:59],v11 offset:0
v_mfma_f32_16x16x32_bf16 v[28:31],v[68:71],v[100:103],v[28:31]
ds_read_b128 v[60:63],v11 offset:1024
v_mfma_f32_16x16x32_bf16 v[32:35],v[100:103],v[100:103],v[32:35]
ds_read_b128 v[96:99],v11 offset:8192
s_waitcnt lgkmcnt(6)
v_mfma_f32_16x16x32_bf16 v[24:27],v[72:75],v[104:107],v[24:27]
ds_read_b128 v[64:67],v11 offset:2048
v_mfma_f32_16x16x32_bf16 v[28:31],v[76:79],v[104:107],v[28:31]
ds_read_b128 v[68:71],v11 offset:3072
v_mfma_f32_16x16x32_bf16 v[32:35],v[104:107],v[104:107],v[32:35]
ds_read_b128 v[100:103],v11 offset:9216
s_waitcnt lgkmcnt(7)
v_mfma_f32_16x16x32_bf16 v[24:27],v[80:83],v[108:111],v[24:27]
ds_read_b128 v[72:75],v11 offset:4096
v_mfma_f32_16x16x32_bf16 v[28:31],v[84:87],v[108:111],v[28:31]
ds_read_b128 v[76:79],v11 offset:5120
v_mfma_f32_16x16x32_bf16 v[32:35],v[108:111],v[108:111],v[32:35]
ds_read_b128 v[104:107],v11 offset:10240
v_smfmac_f32_16x16x64_bf16 v[116:119],v[48:51],v[232:239],v2
ds_read_b128 v[80:83],v11 offset:6144
v_smfmac_f32_16x16x64_bf16 v[112:115],v[52:55],v[240:247],v2
ds_read_b128 v[84:87],v11 offset:7168
v_smfmac_f32_16x16x64_bf16 v[116:119],v[52:55],v[248:255],v2
ds_read_b128 v[108:111],v11 offset:11264
v_max3_f32 v126,v24,v25,v26
v_max3_f32 v127,v27,v28,v29
v_max3_f32 v126,v30,v31,v126
v_max3_f32 v127,v34,v35,v127
v_max_f32 v126,v126,v127
v_max_f32 v127,v126,v127
v_pk_mul_f32 v[34:35],v[34:35],v[0:1] op_sel:[0,1]
v_pk_mul_f32 v[24:25],v[24:25],v[0:1] op_sel:[0,1]
v_permlane16_swap_b32 v126,v127
v_max_f32 v126,v126,v127
v_max_f32 v127,v126,v127
v_pk_mul_f32 v[26:27],v[26:27],v[0:1] op_sel:[0,1]
v_pk_mul_f32 v[28:29],v[28:29],v[0:1] op_sel:[0,1]
v_permlane32_swap_b32 v126,v127
v_max_f32 v126,v126,v127
v_mul_f32 v126,v1,v126
v_pk_mul_f32 v[30:31],v[30:31],v[0:1] op_sel:[0,1]
v_pk_add_f32 v[34:35],v[34:35],v[126:127] op_sel_hi:[1,0] neg_lo:[0,1] neg_hi:[0,1]
v_pk_add_f32 v[112:113],v[112:113],v[114:115]
v_pk_add_f32 v[116:117],v[116:117],v[118:119]
v_pk_add_f32 v[24:25],v[24:25],v[126:127] op_sel_hi:[1,0] neg_lo:[0,1] neg_hi:[0,1]
v_pk_add_f32 v[26:27],v[26:27],v[126:127] op_sel_hi:[1,0] neg_lo:[0,1] neg_hi:[0,1]
v_pk_add_f32 v[28:29],v[28:29],v[126:127] op_sel_hi:[1,0] neg_lo:[0,1] neg_hi:[0,1]
v_pk_add_f32 v[30:31],v[30:31],v[126:127] op_sel_hi:[1,0] neg_lo:[0,1] neg_hi:[0,1]
v_exp_f32 v34,v34
v_exp_f32 v35,v35
v_cvt_pk_bf16_f32 v126,v112,v113
v_cvt_pk_bf16_f32 v124,v34,v35
v_cvt_pk_bf16_f32 v127,v116,v117
v_cvt_pk_bf16_f32 v36,v116,v117
v_mfma_f32_16x16x16_bf16 v[32:35],v[14:15],v[124:125],0
ds_read_b128 v[44:47],v11 offset:13312
v_exp_f32 v24,v24
v_mfma_f32_16x16x16_bf16 v[112:115],v[126:127],v[124:125],0
ds_read_b128 v[48:51],v11 offset:14336
v_exp_f32 v25,v25
v_mfma_f32_16x16x16_bf16 v[116:119],v[36:37],v[124:125],0
ds_read_b128 v[52:55],v11 offset:15360
v_exp_f32 v26,v26
v_exp_f32 v27,v27
v_cvt_pk_bf16_f32 v120,v24,v25
v_exp_f32 v28,v28
v_exp_f32 v29,v29
v_cvt_pk_bf16_f32 v121,v26,v27
v_exp_f32 v30,v30
v_exp_f32 v31,v31
v_cvt_pk_bf16_f32 v122,v28,v29
v_cvt_pk_bf16_f32 v123,v30,v31
s_add_u32 s75,s75,8192
s_add_u32 s51,s51,1
v_mfma_f32_16x16x32_bf16 v[32:35],v[14:17],v[120:123],v[32:35]
v_mfma_f32_16x16x32_bf16 v[112:115],v[88:91],v[120:123],v[112:115]
ds_read_b128 v[88:91],v11 offset:16384
v_mfma_f32_16x16x32_bf16 v[116:119],v[92:95],v[120:123],v[116:119]
ds_read_b128 v[92:95],v11 offset:17408
v_rcp_f32 v32,v32
v_mov_b64 v[24:25],-1
v_mov_b64 v[26:27],-1
s_add_u32 s64,s75,13631488
s_add_u32 s70,s64,4096
v_pk_mul_f32 v[112:113],v[112:113],v[32:33] op_sel_hi:[1,0]
v_pk_mul_f32 v[114:115],v[114:115],v[32:33] op_sel_hi:[1,0]
v_pk_mul_f32 v[116:117],v[116:117],v[32:33] op_sel_hi:[1,0]
v_pk_mul_f32 v[118:119],v[118:119],v[32:33] op_sel_hi:[1,0]
v_cvt_pk_bf16_f32 v120,v112,v116
v_cvt_pk_bf16_f32 v121,v113,v117
v_cvt_pk_bf16_f32 v122,v114,v118
v_cvt_pk_bf16_f32 v123,v115,v119
ds_write_b128 v7,v[120:123]
buffer_store_dwordx4 v[24:27],v0,s[8:11],s69 offen
buffer_store_dwordx4 v[24:27],v0,s[8:11],s69 offen offset:1024
v_mov_b64 v[112:113],0
v_mov_b64 v[114:115],0
v_mov_b64 v[116:117],0
v_mov_b64 v[118:119],0
s_waitcnt lgkmcnt(0)
s_barrier
ds_read_b128 v[24:27],v8 offset:0
ds_read_b128 v[28:31],v8 offset:512
ds_read_b128 v[32:35],v8 offset:1024
ds_read_b128 v[36:39],v8 offset:1536
v_mov_b64 v[120:121],0
v_mov_b64 v[122:123],0
s_waitcnt lgkmcnt(3)
v_smfmac_f32_16x16x64_bf16 v[112:115],v[24:27],v[56:63],v3
ds_read_b128 v[56:59],v11 offset:18432
s_add_u32 s57,s65,65536
s_waitcnt lgkmcnt(3)
v_smfmac_f32_16x16x64_bf16 v[112:115],v[28:31],v[64:71],v3
ds_read_b128 v[60:63],v11 offset:19456
s_add_u32 s58,s65,131072
s_waitcnt lgkmcnt(3)
v_smfmac_f32_16x16x64_bf16 v[112:115],v[32:35],v[72:79],v3
ds_read_b128 v[64:67],v11 offset:20480
s_add_u32 s59,s65,196608
s_waitcnt lgkmcnt(3)
v_smfmac_f32_16x16x64_bf16 v[112:115],v[36:39],v[80:87],v3
ds_read_b128 v[68:71],v11 offset:21504
v_smfmac_f32_16x16x64_bf16 v[116:119],v[24:27],v[96:103],v3
ds_read_b128 v[72:75],v11 offset:22528
v_smfmac_f32_16x16x64_bf16 v[116:119],v[28:31],v[104:111],v3
ds_read_b128 v[76:79],v11 offset:23552
v_cvt_pk_bf16_f32 v112,v112,v113
v_smfmac_f32_16x16x64_bf16 v[116:119],v[32:35],v[40:47],v3
ds_read_b128 v[80:83],v11 offset:24576
v_cvt_pk_bf16_f32 v113,v114,v115
buffer_store_dwordx2 v[112:113],v9,s[8:11],s65 offen
v_smfmac_f32_16x16x64_bf16 v[116:119],v[36:39],v[48:55],v3
ds_read_b128 v[84:87],v11 offset:25600
v_mov_b64 v[112:113],0
v_smfmac_f32_16x16x64_bf16 v[120:123],v[24:27],v[88:95],v3
ds_read_b128 v[96:99],v11 offset:26624
ds_read_b128 v[100:103],v11 offset:27648
v_mov_b64 v[114:115],0
s_waitcnt lgkmcnt(8)
v_smfmac_f32_16x16x64_bf16 v[120:123],v[28:31],v[56:63],v3
ds_read_b128 v[104:107],v11 offset:28672
v_cvt_pk_bf16_f32 v116,v116,v117
s_waitcnt lgkmcnt(7)
v_smfmac_f32_16x16x64_bf16 v[120:123],v[32:35],v[64:71],v3
ds_read_b128 v[108:111],v11 offset:29696
ds_read_b128 v[40:43],v11 offset:30720
v_cvt_pk_bf16_f32 v117,v118,v119
buffer_store_dwordx2 v[116:117],v9,s[8:11],s57 offen
s_waitcnt lgkmcnt(7)
v_smfmac_f32_16x16x64_bf16 v[120:123],v[36:39],v[72:79],v3
ds_read_b128 v[44:47],v11 offset:31744
v_add_u32 v52,s50,v5
s_waitcnt lgkmcnt(6)
v_smfmac_f32_16x16x64_bf16 v[112:115],v[24:27],v[80:87],v3
v_add_u32 v54,s50,v6
s_waitcnt lgkmcnt(4)
v_smfmac_f32_16x16x64_bf16 v[112:115],v[28:31],v[96:103],v3
ds_read_b64_tr_b16 v[52:53],v52
v_cvt_pk_bf16_f32 v120,v120,v121
s_waitcnt lgkmcnt(3)
v_smfmac_f32_16x16x64_bf16 v[112:115],v[32:35],v[104:111],v3
ds_read_b64_tr_b16 v[54:55],v54
v_cvt_pk_bf16_f32 v121,v122,v123
buffer_store_dwordx2 v[120:121],v9,s[8:11],s58 offen
s_waitcnt lgkmcnt(2)
s_add_u32 s56,s18,s75
v_smfmac_f32_16x16x64_bf16 v[112:115],v[36:39],v[40:47],v3
v_mov_b64 v[116:117],0
v_mov_b64 v[118:119],0
s_xor_b32 s65,s65,262144
v_mov_b32_dpp v124,v126 quad_perm:[2,3,2,3] row_mask:0xf bank_mask:0xf
v_mov_b32_dpp v125,v127 quad_perm:[2,3,2,3] row_mask:0xf bank_mask:0xf
s_mov_b32 vcc_lo,0xcccccccc
s_mov_b32 vcc_hi,0xcccccccc
s_nop 0
v_cvt_pk_bf16_f32 v112,v112,v113
v_cvt_pk_bf16_f32 v113,v114,v115
buffer_store_dwordx2 v[112:113],v9,s[8:11],s59 offen
s_waitcnt lgkmcnt(0)
s_buffer_load_dword s19,s[8:11],s56
v_cndmask_b32 v124,v124,v52,vcc
v_cndmask_b32 v125,v125,v53,vcc
v_cndmask_b32 v126,v126,v54,vcc
v_cndmask_b32 v127,v127,v55,vcc
v_mov_b64 v[96:97],0
v_mov_b64 v[98:99],0
v_mov_b64 v[100:101],0
v_mov_b64 v[102:103],0
v_mov_b64 v[104:105],0
v_mov_b64 v[106:107],0
v_mov_b64 v[108:109],0
v_mov_b64 v[110:111],0
v_mov_b64 v[112:113],0
v_mov_b64 v[114:115],0
v_add_u32 v55,131072,v0
v_add_u32 v123,s73,v55
v_xor_b32 v120,1024,v12
v_xor_b32 v121,2048,v12
v_xor_b32 v122,3072,v12
s_cmp_lt_u32 s46,2
s_waitcnt vmcnt(2)
s_cbranch_scc1 L_crg_207
s_cmp_eq_u32 s46,2
s_waitcnt vmcnt(1)
s_cbranch_scc1 L_crg_207
s_waitcnt vmcnt(0)
L_crg_207:
buffer_load_dwordx4 v[32:35],v0,s[8:11],s66 offen offset:0 sc1
buffer_load_dwordx4 v[36:39],v0,s[8:11],s66 offen offset:1024 sc1
s_cmp_ge_u32 s51,63
s_cselect_b32 s76,0,1
v_readlane_b32 s56,v23,5
v_readlane_b32 s20,v23,4
v_add_u32 v23,-1,v23
v_cmp_le_u32 vcc,s30,v23
s_cmp_gt_u32 s51,61
s_cselect_b32 s77,0,vcc_hi
s_cmp_gt_u32 s20,s30
s_cselect_b32 s77,1,s77
s_cmp_lg_u32 s77,0
s_cselect_b32 s76,2,s76
s_cmp_gt_u32 s56,s30
s_cbranch_scc1 L_cld_183
L_clb_184:
s_cmp_eq_u32 s46,0
s_cselect_b32 s76,s76,0
s_waitcnt vmcnt(1)
v_mfma_f32_16x16x32_bf16 v[28:31],v[18:21],v[32:35],0
s_waitcnt vmcnt(0)
v_mfma_f32_16x16x32_bf16 v[28:31],v[18:21],v[36:39],v[28:31]
s_nop 7
v_cmp_u_f32 vcc,v28,v28
v_add_f32_dpp v52,v28,v28 row_ror:8 row_mask:0xf bank_mask:0x3
v_add_f32_dpp v53,v29,v29 row_ror:8 row_mask:0xf bank_mask:0x3
v_add_f32_dpp v52,v30,v30 row_ror:8 row_mask:0xf bank_mask:0xc
v_add_f32_dpp v53,v31,v31 row_ror:8 row_mask:0xf bank_mask:0xc
s_nop 0
v_add_f32_dpp v52,v52,v52 row_shl:4 row_mask:0xf bank_mask:0x5
v_add_f32_dpp v53,v53,v53 row_shl:4 row_mask:0xf bank_mask:0x5
s_cbranch_vccnz L_crp_202
L_cok_208:
v_cvt_pk_bf16_f32 v54,v52,v53
buffer_store_dword v54,v10,s[8:11],s64 offen
s_mov_b32 s69,s66
s_xor_b32 s66,s66,262144
s_barrier
ds_read_b128 v[56:59],v55 offset:0
ds_read_b128 v[60:63],v55 offset:4096
ds_read_b128 v[64:67],v55 offset:1024
buffer_load_dwordx4 v[24:27],v13,s[8:11],s64 offen sc1
ds_read_b128 v[68:71],v55 offset:5120
ds_read_b128 v[72:75],v55 offset:2048
ds_read_b128 v[76:79],v55 offset:6144
ds_read_b128 v[80:83],v55 offset:3072
buffer_load_dwordx4 v[24:27],v13,s[8:11],s64 offen sc1
ds_read_b128 v[84:87],v55 offset:7168
ds_read_b128 v[88:91],v123 offset:8192
ds_read_b128 v[92:95],v123 offset:9216
s_branch L_chain_197
L_cpb_204:
buffer_load_dwordx4 v[40:43],v13,s[8:11],s70 offen sc1
s_sub_u32 s49,s49,1
s_cbranch_scc1 L_abort
s_waitcnt vmcnt(0)
v_max3_u32 v123,v40,v41,v42
v_max_u32 v123,v43,v123
v_cmp_le_u32 vcc,s72,v123
s_cbranch_vccnz L_cpb_204
ds_write_b128 v12,v[40:43] offset:4096
s_branch L_cback_206
L_crp_202:
buffer_load_dwordx4 v[32:35],v0,s[8:11],s66 offen offset:0 sc1
buffer_load_dwordx4 v[36:39],v0,s[8:11],s66 offen offset:1024 sc1
s_sub_u32 s49,s49,1
s_cbranch_scc1 L_abort
s_waitcnt vmcnt(1)
v_mfma_f32_16x16x32_bf16 v[28:31],v[18:21],v[32:35],0
s_waitcnt vmcnt(0)
v_mfma_f32_16x16x32_bf16 v[28:31],v[18:21],v[36:39],v[28:31]
s_nop 7
v_cmp_u_f32 vcc,v28,v28
v_add_f32_dpp v52,v28,v28 row_ror:8 row_mask:0xf bank_mask:0x3
v_add_f32_dpp v53,v29,v29 row_ror:8 row_mask:0xf bank_mask:0x3
v_add_f32_dpp v52,v30,v30 row_ror:8 row_mask:0xf bank_mask:0xc
v_add_f32_dpp v53,v31,v31 row_ror:8 row_mask:0xf bank_mask:0xc
s_nop 0
v_add_f32_dpp v52,v52,v52 row_shl:4 row_mask:0xf bank_mask:0x5
v_add_f32_dpp v53,v53,v53 row_shl:4 row_mask:0xf bank_mask:0x5
s_cbranch_vccz L_cok_208
s_branch L_crp_202
L_ckw_187:
s_cmp_eq_u32 s77,0
s_cbranch_scc1 L_cjw_189
s_andn2_b32 s31,0x7ff,s20
s_lshr_b32 s31,s31,5
s_cmp_gt_u32 s20,s30
s_cbranch_scc1 L_cjs_185
s_add_u32 s31,s51,2
s_lshl_b32 s59,s31,13
s_add_u32 s59,s59,10486016
v_lshrrev_b32 v45,2,v0
v_and_b32 v45,127,v45
L_ckk_209:
s_sleep 1
buffer_load_dword v44,v45,s[8:11],s59 offen sc1
s_sub_u32 s49,s49,1
s_cbranch_scc1 L_abort
s_waitcnt vmcnt(0)
v_cmp_eq_u32 vcc,0,v44
s_cbranch_vccnz L_ckk_209
v_cmp_lt_u32 vcc,s30,v44
s_cbranch_vccz L_cjw_189
L_cjs_185:
ds_write_b32 v8,v2 offset:2560
s_waitcnt lgkmcnt(0)
s_branch L_ckb_188
L_cld_183:
v_mov_b32 v23,s56
s_add_u32 s56,s75,10495616
buffer_store_dword v23,off,s[8:11],s56
s_waitcnt vmcnt(0)
s_branch L_clb_184
L_cjw_189:
s_cmp_lg_u32 s19,0
s_cbranch_scc1 L_ckb_188
s_add_u32 s59,s18,s75
L_ww_210:
s_sleep 1
buffer_load_dword v23,off,s[8:11],s59 sc1
s_sub_u32 s49,s49,1
s_cbranch_scc1 L_abort
s_waitcnt vmcnt(0)
v_readfirstlane_b32 s76,v23
s_cmp_eq_u32 s76,0
s_cbranch_scc1 L_ww_210
L_wwd_211:
s_branch L_ckb_188
L_cjump_190:
s_waitcnt vmcnt(0) lgkmcnt(0)
s_barrier
s_branch L_cst_186
L_cend_200:
v_smfmac_f32_16x16x64_bf16 v[116:119],v[36:39],v[184:191],v2
v_smfmac_f32_16x16x64_bf16 v[112:115],v[40:43],v[192:199],v2
v_smfmac_f32_16x16x64_bf16 v[116:119],v[40:43],v[200:207],v2
v_smfmac_f32_16x16x64_bf16 v[112:115],v[44:47],v[208:215],v2
v_smfmac_f32_16x16x64_bf16 v[116:119],v[44:47],v[216:223],v2
v_smfmac_f32_16x16x64_bf16 v[112:115],v[48:51],v[224:231],v2
v_smfmac_f32_16x16x64_bf16 v[116:119],v[48:51],v[232:239],v2
v_smfmac_f32_16x16x64_bf16 v[112:115],v[52:55],v[240:247],v2
v_smfmac_f32_16x16x64_bf16 v[116:119],v[52:55],v[248:255],v2
s_waitcnt lgkmcnt(0)
s_nop 2
v_pk_add_f32 v[112:113],v[112:113],v[114:115]
s_nop 2
v_pk_add_f32 v[116:117],v[116:117],v[118:119]
v_cvt_pk_bf16_f32 v126,v112,v113
v_cvt_pk_bf16_f32 v127,v116,v117
v_add_u32 v52,s50,v5
v_add_u32 v54,s50,v6
ds_read_b64_tr_b16 v[52:53],v52
ds_read_b64_tr_b16 v[54:55],v54
v_mov_b32_dpp v124,v126 quad_perm:[2,3,2,3] row_mask:0xf bank_mask:0xf
v_mov_b32_dpp v125,v127 quad_perm:[2,3,2,3] row_mask:0xf bank_mask:0xf
s_mov_b32 vcc_lo,0xcccccccc
s_mov_b32 vcc_hi,0xcccccccc
s_waitcnt lgkmcnt(0)
v_cndmask_b32 v124,v124,v52,vcc
v_cndmask_b32 v125,v125,v53,vcc
v_cndmask_b32 v126,v126,v54,vcc
v_cndmask_b32 v127,v127,v55,vcc
buffer_store_dwordx4 v[124:127],v0,s[8:11],s54 offen sc1
s_mov_b32 s51,64
s_waitcnt vmcnt(0)
s_barrier
s_nop 11
v_lshrrev_b32 v1,4,v0
s_endpgm
L_abort2:
s_endpgm
L_wc:
s_nop 11
s_cmp_eq_u32 s48,1
s_cbranch_scc1 L_rc1_212
s_cmp_eq_u32 s48,2
s_cbranch_scc1 L_rc2_213
v_and_b32 v120,15,v1
v_lshrrev_b32 v121,4,v1
v_and_b32 v122,2,v1
v_cmp_eq_u32 vcc,0,v122
v_mov_b32 v2,0xeeee
v_mov_b32 v123,0x4444
v_cndmask_b32 v2,v2,v123,vcc
v_and_b32 v122,1,v1
v_cmp_eq_u32 vcc,0,v122
v_mov_b32 v3,0xdddd
v_mov_b32 v123,0x8888
v_cndmask_b32 v3,v3,v123,vcc
v_lshrrev_b32 v122,1,v120
v_bfe_u32 v123,v120,2,1
v_xor_b32 v123,v123,v122
v_lshlrev_b32 v4,7,v123
v_and_b32 v123,1,v120
v_lshl_add_u32 v4,v123,6,v4
v_xor_b32 v123,v121,v122
v_and_b32 v123,3,v123
v_lshl_add_u32 v4,v123,4,v4
s_lshl_b32 s56,s46,10
s_add_u32 s56,s56,147456
v_add_u32 v4,s56,v4
v_lshlrev_b32 v122,1,v121
v_add_u32 v122,0,v122
v_and_b32 v123,1,v121
v_xor_b32 v123,v123,v122
v_lshlrev_b32 v5,7,v123
v_bfe_u32 v123,v120,3,1
v_lshl_add_u32 v5,v123,6,v5
v_xor_b32 v123,v120,v122
v_and_b32 v123,3,v123
v_lshl_add_u32 v5,v123,4,v5
v_bfe_u32 v123,v120,2,1
v_lshl_add_u32 v5,v123,3,v5
v_add_u32 v5,147456,v5
v_lshlrev_b32 v122,1,v121
v_add_u32 v122,1,v122
v_and_b32 v123,1,v121
v_xor_b32 v123,v123,v122
v_lshlrev_b32 v6,7,v123
v_bfe_u32 v123,v120,3,1
v_lshl_add_u32 v6,v123,6,v6
v_xor_b32 v123,v120,v122
v_and_b32 v123,3,v123
v_lshl_add_u32 v6,v123,4,v6
v_bfe_u32 v123,v120,2,1
v_lshl_add_u32 v6,v123,3,v6
v_add_u32 v6,147456,v6
v_lshlrev_b32 v7,7,v121
v_lshrrev_b32 v122,1,v120
v_lshl_add_u32 v8,v122,4,v7
v_add_u32 v8,151552,v8
v_lshrrev_b32 v122,2,v120
v_lshl_add_u32 v7,v122,5,v7
v_and_b32 v122,1,v120
v_lshl_add_u32 v7,v122,4,v7
v_and_b32 v122,2,v120
v_cmp_eq_u32 vcc,0,v122
s_lshl_b32 s56,s46,9
v_mov_b32 v122,2048
v_mov_b32 v123,s56
v_cndmask_b32 v122,v122,v123,vcc
v_add_u32 v7,v122,v7
v_add_u32 v7,151552,v7
v_lshrrev_b32 v122,3,v1
v_lshlrev_b32 v9,11,v122
v_and_b32 v122,7,v1
v_lshl_add_u32 v9,v122,3,v9
s_lshl_b32 s56,s46,14
s_lshl_b32 s57,s47,6
s_add_u32 s56,s56,s57
v_add_u32 v9,s56,v9
s_lshl_b32 s71,s46,5
s_add_u32 s71,s71,s47
s_bfe_u32 s56,s71,0x10003
s_lshl_b32 s56,s56,11
s_and_b32 s57,s71,1
s_lshl_b32 s57,s57,10
s_add_u32 s56,s56,s57
s_bfe_u32 s57,s71,0x10002
s_lshl_b32 s57,s57,9
s_add_u32 s56,s56,s57
s_bfe_u32 s57,s71,0x10001
s_lshl_b32 s57,s57,6
s_add_u32 s56,s56,s57
s_bfe_u32 s57,s71,0x10004
s_lshl_b32 s57,s57,8
s_add_u32 s56,s56,s57
s_bfe_u32 s57,s71,0x10005
s_lshl_b32 s57,s57,7
s_add_u32 s56,s56,s57
s_bfe_u32 s57,s71,0x10006
s_lshl_b32 s57,s57,12
s_add_u32 s56,s56,s57
v_and_b32 v122,3,v120
v_lshlrev_b32 v10,2,v122
v_bfe_u32 v122,v120,3,1
v_lshl_add_u32 v10,v122,4,v10
v_and_b32 v122,1,v121
v_lshl_add_u32 v10,v122,5,v10
v_add_u32 v10,s56,v10
v_and_b32 v123,36,v1
v_mov_b32 v122,0x80000000
v_cmp_eq_u32 vcc,0,v123
s_nop 1
v_cndmask_b32 v10,v122,v10,vcc
s_lshl_b32 s56,s46,15
v_add_u32 v11,s56,v0
s_lshl_b32 s71,s71,11
s_lshl_b32 s73,s46,11
s_mov_b32 s72,0xffc00000
s_mov_b32 s74,0
v_lshrrev_b32 v13,3,v1
v_lshlrev_b32 v13,9,v13
v_and_b32 v122,7,v1
v_lshl_add_u32 v13,v122,4,v13
v_and_b32 v122,15,v1
v_and_b32 v123,1,v1
v_lshlrev_b32 v123,4,v123
v_mov_b32 v124,0x3f80
v_lshlrev_b32 v124,v123,v124
v_lshrrev_b32 v122,1,v122
v_cmp_eq_u32 vcc,0,v122
s_nop 1
v_cndmask_b32 v18,0,v124,vcc
v_cmp_eq_u32 vcc,1,v122
s_nop 1
v_cndmask_b32 v19,0,v124,vcc
v_cmp_eq_u32 vcc,2,v122
s_nop 1
v_cndmask_b32 v20,0,v124,vcc
v_cmp_eq_u32 vcc,3,v122
s_nop 1
v_cndmask_b32 v21,0,v124,vcc
s_and_b32 s56,s46,1
s_lshl_b32 s56,s56,8
s_and_b32 s57,s46,2
s_lshl_b32 s57,s57,6
s_add_u32 s56,s56,s57
v_add_u32 v13,s56,v13
s_add_u32 s56,s50,155648
v_add_u32 v12,s56,v0
v_mov_b64 v[14:15],s[28:29]
v_mov_b64 v[16:17],s[28:29]
v_add_u32 v22,11550720,v10
s_lshl_b32 s18,s47,2
s_add_u32 s18,s18,10493952
v_mov_b32 v1,s80
s_mov_b32 s65,14680064
s_add_u32 s66,s71,14680064
s_add_u32 s69,s71,14942208
s_mov_b32 s30,0x40000000
s_mov_b32 s51,0
L_cst_217:
s_cmp_lg_u32 s46,0
s_cbranch_scc1 L_csw_222
s_lshl_b32 s59,s51,13
s_lshl2_add_u32 s59,s47,s59
s_add_u32 s59,s59,10485760
L_ww_223:
s_sleep 1
buffer_load_dword v122,off,s[8:11],s59 sc1
s_sub_u32 s49,s49,1
s_cbranch_scc1 L_abort2
s_waitcnt vmcnt(0)
v_readfirstlane_b32 s61,v122
s_cmp_eq_u32 s61,0
s_cbranch_scc1 L_ww_223
L_wwd_224:
L_csw_222:
s_waitcnt lgkmcnt(0)
s_barrier
s_lshl_b32 s56,s51,5
s_add_u32 s56,s56,s47
s_mul_i32 s56,s56,24576
s_add_u32 s56,s56,100663296
s_add_u32 s67,s56,s73
s_add_u32 m0,s73,131072
s_add_u32 s57,s67,8192
buffer_load_dwordx4 v0,s[8:11],s67 offen sc1 lds
buffer_load_dwordx4 v0,s[8:11],s67 offen offset:1024 sc1 lds
s_add_u32 m0,s73,139264
s_add_u32 s67,s67,786432
buffer_load_dwordx4 v0,s[8:11],s57 offen sc1 lds
buffer_load_dwordx4 v0,s[8:11],s57 offen offset:1024 sc1 lds
s_lshl_b32 s75,s51,13
s_add_u32 s56,s75,11542528
buffer_load_dword v23,v10,s[8:11],s56 offen sc1
s_add_u32 s64,s75,11534336
s_add_u32 s70,s64,4096
s_lshl_b32 s68,s51,5
s_add_u32 s68,s68,s47
s_lshl_b32 s68,s68,12
s_lshl_b32 s56,s46,10
s_add_u32 s68,s68,s56
s_add_u32 s68,s68,41943040
s_mov_b32 s54,0x80000000
s_mov_b32 s77,0
s_mov_b32 s19,0
s_cmp_eq_u32 s51,63
s_cselect_b32 s76,1,s46
s_cmp_eq_u32 s76,0
s_cselect_b32 s76,1,0
v_mov_b64 v[96:97],0
v_mov_b64 v[98:99],0
v_mov_b64 v[100:101],0
v_mov_b64 v[102:103],0
v_mov_b64 v[104:105],0
v_mov_b64 v[106:107],0
v_mov_b64 v[108:109],0
v_mov_b64 v[110:111],0
v_mov_b64 v[112:113],0
v_mov_b64 v[114:115],0
v_mov_b64 v[116:117],0
v_mov_b64 v[118:119],0
s_waitcnt vmcnt(0) lgkmcnt(0)
s_barrier
v_add_u32 v55,131072,v0
ds_read_b128 v[56:59],v55 offset:0
ds_read_b128 v[60:63],v55 offset:4096
ds_read_b128 v[64:67],v55 offset:1024
ds_read_b128 v[68:71],v55 offset:5120
ds_read_b128 v[72:75],v55 offset:2048
ds_read_b128 v[76:79],v55 offset:6144
ds_read_b128 v[80:83],v55 offset:3072
ds_read_b128 v[84:87],v55 offset:7168
v_add_u32 v123,s73,v55
ds_read_b128 v[88:91],v123 offset:8192
ds_read_b128 v[92:95],v123 offset:9216
v_xor_b32 v120,1024,v12
v_xor_b32 v121,2048,v12
v_xor_b32 v122,3072,v12
buffer_load_dwordx4 v[24:27],v13,s[8:11],s64 offen sc1
buffer_load_dwordx4 v[24:27],v13,s[8:11],s64 offen sc1
L_chain_225:
L_cpa_226:
buffer_load_dwordx4 v[24:27],v13,s[8:11],s64 offen sc1
s_sub_u32 s49,s49,1
s_cbranch_scc1 L_abort2
s_waitcnt vmcnt(2)
v_max3_u32 v123,v24,v25,v26
v_max_u32 v123,v27,v123
v_cmp_le_u32 vcc,s72,v123
s_cbranch_vccnz L_cpa_226
L_cgo_229:
ds_write_b128 v12,v[24:27] offset:0
v_smfmac_f32_16x16x64_bf16 v[96:99],v[24:27],a[0:7],v2
buffer_load_dwordx4 v[40:43],v13,s[8:11],s70 offen sc1
v_smfmac_f32_16x16x64_bf16 v[100:103],v[24:27],a[128:135],v2
v_smfmac_f32_16x16x64_bf16 v[104:107],v[24:27],a[8:15],v2
v_smfmac_f32_16x16x64_bf16 v[108:111],v[24:27],a[136:143],v2
s_waitcnt lgkmcnt(0)
s_barrier
ds_read_b128 v[28:31],v120 offset:0
v_smfmac_f32_16x16x64_bf16 v[112:115],v[24:27],v[128:135],v2
ds_read_b128 v[32:35],v121 offset:0
v_smfmac_f32_16x16x64_bf16 v[116:119],v[24:27],v[136:143],v2
ds_read_b128 v[36:39],v122 offset:0
s_waitcnt lgkmcnt(2)
v_smfmac_f32_16x16x64_bf16 v[96:99],v[28:31],a[16:23],v2
s_add_u32 m0,s73,131072
v_smfmac_f32_16x16x64_bf16 v[100:103],v[28:31],a[144:151],v2
s_add_u32 s57,s67,8192
v_smfmac_f32_16x16x64_bf16 v[104:107],v[28:31],a[24:31],v2
s_cmp_lt_u32 s19,s76
s_cbranch_scc1 L_ckw_218
L_ckb_219:
v_smfmac_f32_16x16x64_bf16 v[108:111],v[28:31],a[152:159],v2
s_waitcnt vmcnt(0) lgkmcnt(1)
v_smfmac_f32_16x16x64_bf16 v[96:99],v[32:35],a[32:39],v2
ds_write_b128 v12,v[40:43] offset:4096
v_max3_u32 v123,v40,v41,v42
v_smfmac_f32_16x16x64_bf16 v[100:103],v[32:35],a[160:167],v2
v_max_u32 v123,v43,v123
v_smfmac_f32_16x16x64_bf16 v[104:107],v[32:35],a[40:47],v2
v_cmp_le_u32 vcc,s72,v123
v_smfmac_f32_16x16x64_bf16 v[108:111],v[32:35],a[168:175],v2
v_smfmac_f32_16x16x64_bf16 v[112:115],v[28:31],v[144:151],v2
s_cbranch_vccnz L_cpb_232
L_cback_234:
s_waitcnt lgkmcnt(0)
s_barrier
v_smfmac_f32_16x16x64_bf16 v[96:99],v[36:39],a[48:55],v2
buffer_store_dwordx4 v[124:127],v0,s[8:11],s54 offen sc1
v_smfmac_f32_16x16x64_bf16 v[100:103],v[36:39],a[176:183],v2
ds_read_b128 v[44:47],v120 offset:4096
v_smfmac_f32_16x16x64_bf16 v[104:107],v[36:39],a[56:63],v2
buffer_load_dwordx4 v0,s[8:11],s67 offen sc1 lds
v_smfmac_f32_16x16x64_bf16 v[108:111],v[36:39],a[184:191],v2
ds_read_b128 v[48:51],v121 offset:4096
v_smfmac_f32_16x16x64_bf16 v[96:99],v[40:43],a[64:71],v2
buffer_load_dwordx4 v0,s[8:11],s67 offen offset:1024 sc1 lds
s_add_u32 m0,s73,139264
v_smfmac_f32_16x16x64_bf16 v[100:103],v[40:43],a[192:199],v2
ds_read_b128 v[52:55],v122 offset:4096
v_smfmac_f32_16x16x64_bf16 v[104:107],v[40:43],a[72:79],v2
buffer_load_dwordx4 v0,s[8:11],s57 offen sc1 lds
s_add_u32 s67,s67,786432
v_smfmac_f32_16x16x64_bf16 v[108:111],v[40:43],a[200:207],v2
s_waitcnt lgkmcnt(2)
v_smfmac_f32_16x16x64_bf16 v[96:99],v[44:47],a[80:87],v2
buffer_load_dwordx4 v0,s[8:11],s57 offen offset:1024 sc1 lds
v_smfmac_f32_16x16x64_bf16 v[100:103],v[44:47],a[208:215],v2
s_waitcnt lgkmcnt(1)
v_smfmac_f32_16x16x64_bf16 v[96:99],v[48:51],a[96:103],v2
buffer_load_dword v23,v22,s[8:11],s75 offen sc1
v_smfmac_f32_16x16x64_bf16 v[100:103],v[48:51],a[224:231],v2
s_waitcnt lgkmcnt(0)
v_smfmac_f32_16x16x64_bf16 v[96:99],v[52:55],a[112:119],v2
v_smfmac_f32_16x16x64_bf16 v[100:103],v[52:55],a[240:247],v2
v_smfmac_f32_16x16x64_bf16 v[104:107],v[44:47],a[88:95],v2
v_smfmac_f32_16x16x64_bf16 v[108:111],v[44:47],a[216:223],v2
v_smfmac_f32_16x16x64_bf16 v[104:107],v[48:51],a[104:111],v2
v_add_f32 v96,v96,v98
v_smfmac_f32_16x16x64_bf16 v[108:111],v[48:51],a[232:239],v2
v_add_f32 v97,v97,v99
v_smfmac_f32_16x16x64_bf16 v[104:107],v[52:55],a[120:127],v2
v_cvt_pk_bf16_f32 v120,v96,v97
v_smfmac_f32_16x16x64_bf16 v[108:111],v[52:55],a[248:255],v2
v_add_f32 v100,v100,v102
v_smfmac_f32_16x16x64_bf16 v[116:119],v[28:31],v[152:159],v2
v_add_f32 v101,v101,v103
v_smfmac_f32_16x16x64_bf16 v[112:115],v[32:35],v[160:167],v2
v_cvt_pk_bf16_f32 v121,v100,v101
v_add_f32 v104,v104,v106
v_add_f32 v105,v105,v107
v_cvt_pk_bf16_f32 v122,v104,v105
v_add_f32 v108,v108,v110
v_add_f32 v109,v109,v111
v_cvt_pk_bf16_f32 v123,v108,v109
ds_write_b128 v4,v[120:123]
v_smfmac_f32_16x16x64_bf16 v[116:119],v[32:35],v[168:175],v2
s_mov_b32 s54,s68
s_add_u32 s68,s68,131072
v_mov_b32 v125,0
v_smfmac_f32_16x16x64_bf16 v[112:115],v[36:39],v[176:183],v2
s_cmp_eq_u32 s51,63
s_cbranch_scc1 L_cend_228
v_smfmac_f32_16x16x64_bf16 v[116:119],v[36:39],v[184:191],v2
v_smfmac_f32_16x16x64_bf16 v[112:115],v[40:43],v[192:199],v2
s_waitcnt lgkmcnt(0)
s_barrier
ds_read_b64_tr_b16 v[96:97],v5 offset:0
ds_read_b64_tr_b16 v[98:99],v6 offset:0
v_smfmac_f32_16x16x64_bf16 v[116:119],v[40:43],v[200:207],v2
ds_read_b64_tr_b16 v[100:101],v5 offset:1024
v_smfmac_f32_16x16x64_bf16 v[112:115],v[44:47],v[208:215],v2
ds_read_b64_tr_b16 v[102:103],v6 offset:1024
v_smfmac_f32_16x16x64_bf16 v[116:119],v[44:47],v[216:223],v2
ds_read_b64_tr_b16 v[104:105],v5 offset:2048
v_smfmac_f32_16x16x64_bf16 v[112:115],v[48:51],v[224:231],v2
ds_read_b64_tr_b16 v[106:107],v6 offset:2048
s_waitcnt lgkmcnt(4)
v_mfma_f32_16x16x32_bf16 v[24:27],v[56:59],v[96:99],0
ds_read_b64_tr_b16 v[108:109],v5 offset:3072
v_mfma_f32_16x16x32_bf16 v[28:31],v[60:63],v[96:99],0
ds_read_b64_tr_b16 v[110:111],v6 offset:3072
v_mfma_f32_16x16x32_bf16 v[32:35],v[96:99],v[96:99],0
ds_read_b128 v[40:43],v11 offset:12288
s_waitcnt lgkmcnt(5)
v_mfma_f32_16x16x32_bf16 v[24:27],v[64:67],v[100:103],v[24:27]
ds_read_b128 v[56:59],v11 offset:0
v_mfma_f32_16x16x32_bf16 v[28:31],v[68:71],v[100:103],v[28:31]
ds_read_b128 v[60:63],v11 offset:1024
v_mfma_f32_16x16x32_bf16 v[32:35],v[100:103],v[100:103],v[32:35]
ds_read_b128 v[96:99],v11 offset:8192
s_waitcnt lgkmcnt(6)
v_mfma_f32_16x16x32_bf16 v[24:27],v[72:75],v[104:107],v[24:27]
ds_read_b128 v[64:67],v11 offset:2048
v_mfma_f32_16x16x32_bf16 v[28:31],v[76:79],v[104:107],v[28:31]
ds_read_b128 v[68:71],v11 offset:3072
v_mfma_f32_16x16x32_bf16 v[32:35],v[104:107],v[104:107],v[32:35]
ds_read_b128 v[100:103],v11 offset:9216
s_waitcnt lgkmcnt(7)
v_mfma_f32_16x16x32_bf16 v[24:27],v[80:83],v[108:111],v[24:27]
ds_read_b128 v[72:75],v11 offset:4096
v_mfma_f32_16x16x32_bf16 v[28:31],v[84:87],v[108:111],v[28:31]
ds_read_b128 v[76:79],v11 offset:5120
v_mfma_f32_16x16x32_bf16 v[32:35],v[108:111],v[108:111],v[32:35]
ds_read_b128 v[104:107],v11 offset:10240
v_smfmac_f32_16x16x64_bf16 v[116:119],v[48:51],v[232:239],v2
ds_read_b128 v[80:83],v11 offset:6144
v_smfmac_f32_16x16x64_bf16 v[112:115],v[52:55],v[240:247],v2
ds_read_b128 v[84:87],v11 offset:7168
v_smfmac_f32_16x16x64_bf16 v[116:119],v[52:55],v[248:255],v2
ds_read_b128 v[108:111],v11 offset:11264
v_max3_f32 v126,v24,v25,v26
v_max3_f32 v127,v27,v28,v29
v_max3_f32 v126,v30,v31,v126
v_max3_f32 v127,v34,v35,v127
v_max_f32 v126,v126,v127
v_max_f32 v127,v126,v127
v_pk_mul_f32 v[34:35],v[34:35],v[0:1] op_sel:[0,1]
v_pk_mul_f32 v[24:25],v[24:25],v[0:1] op_sel:[0,1]
v_permlane16_swap_b32 v126,v127
v_max_f32 v126,v126,v127
v_max_f32 v127,v126,v127
v_pk_mul_f32 v[26:27],v[26:27],v[0:1] op_sel:[0,1]
v_pk_mul_f32 v[28:29],v[28:29],v[0:1] op_sel:[0,1]
v_permlane32_swap_b32 v126,v127
v_max_f32 v126,v126,v127
v_mul_f32 v126,v1,v126
v_pk_mul_f32 v[30:31],v[30:31],v[0:1] op_sel:[0,1]
v_pk_add_f32 v[34:35],v[34:35],v[126:127] op_sel_hi:[1,0] neg_lo:[0,1] neg_hi:[0,1]
v_pk_add_f32 v[112:113],v[112:113],v[114:115]
v_pk_add_f32 v[116:117],v[116:117],v[118:119]
v_pk_add_f32 v[24:25],v[24:25],v[126:127] op_sel_hi:[1,0] neg_lo:[0,1] neg_hi:[0,1]
v_pk_add_f32 v[26:27],v[26:27],v[126:127] op_sel_hi:[1,0] neg_lo:[0,1] neg_hi:[0,1]
v_pk_add_f32 v[28:29],v[28:29],v[126:127] op_sel_hi:[1,0] neg_lo:[0,1] neg_hi:[0,1]
v_pk_add_f32 v[30:31],v[30:31],v[126:127] op_sel_hi:[1,0] neg_lo:[0,1] neg_hi:[0,1]
v_exp_f32 v34,v34
v_exp_f32 v35,v35
v_cvt_pk_bf16_f32 v126,v112,v113
v_cvt_pk_bf16_f32 v124,v34,v35
v_cvt_pk_bf16_f32 v127,v116,v117
v_cvt_pk_bf16_f32 v36,v116,v117
v_mfma_f32_16x16x16_bf16 v[32:35],v[14:15],v[124:125],0
ds_read_b128 v[44:47],v11 offset:13312
v_exp_f32 v24,v24
v_mfma_f32_16x16x16_bf16 v[112:115],v[126:127],v[124:125],0
ds_read_b128 v[48:51],v11 offset:14336
v_exp_f32 v25,v25
v_mfma_f32_16x16x16_bf16 v[116:119],v[36:37],v[124:125],0
ds_read_b128 v[52:55],v11 offset:15360
v_exp_f32 v26,v26
v_exp_f32 v27,v27
v_cvt_pk_bf16_f32 v120,v24,v25
v_exp_f32 v28,v28
v_exp_f32 v29,v29
v_cvt_pk_bf16_f32 v121,v26,v27
v_exp_f32 v30,v30
v_exp_f32 v31,v31
v_cvt_pk_bf16_f32 v122,v28,v29
v_cvt_pk_bf16_f32 v123,v30,v31
s_add_u32 s75,s75,8192
s_add_u32 s51,s51,1
v_mfma_f32_16x16x32_bf16 v[32:35],v[14:17],v[120:123],v[32:35]
v_mfma_f32_16x16x32_bf16 v[112:115],v[88:91],v[120:123],v[112:115]
ds_read_b128 v[88:91],v11 offset:16384
v_mfma_f32_16x16x32_bf16 v[116:119],v[92:95],v[120:123],v[116:119]
ds_read_b128 v[92:95],v11 offset:17408
v_rcp_f32 v32,v32
v_mov_b64 v[24:25],-1
v_mov_b64 v[26:27],-1
s_add_u32 s64,s75,11534336
s_add_u32 s70,s64,4096
v_pk_mul_f32 v[112:113],v[112:113],v[32:33] op_sel_hi:[1,0]
v_pk_mul_f32 v[114:115],v[114:115],v[32:33] op_sel_hi:[1,0]
v_pk_mul_f32 v[116:117],v[116:117],v[32:33] op_sel_hi:[1,0]
v_pk_mul_f32 v[118:119],v[118:119],v[32:33] op_sel_hi:[1,0]
v_cvt_pk_bf16_f32 v120,v112,v116
v_cvt_pk_bf16_f32 v121,v113,v117
v_cvt_pk_bf16_f32 v122,v114,v118
v_cvt_pk_bf16_f32 v123,v115,v119
ds_write_b128 v7,v[120:123]
buffer_store_dwordx4 v[24:27],v0,s[8:11],s69 offen sc1
buffer_store_dwordx4 v[24:27],v0,s[8:11],s69 offen offset:1024 sc1
v_mov_b64 v[112:113],0
v_mov_b64 v[114:115],0
v_mov_b64 v[116:117],0
v_mov_b64 v[118:119],0
s_waitcnt lgkmcnt(0)
s_barrier
ds_read_b128 v[24:27],v8 offset:0
ds_read_b128 v[28:31],v8 offset:512
ds_read_b128 v[32:35],v8 offset:1024
ds_read_b128 v[36:39],v8 offset:1536
v_mov_b64 v[120:121],0
v_mov_b64 v[122:123],0
s_waitcnt lgkmcnt(3)
v_smfmac_f32_16x16x64_bf16 v[112:115],v[24:27],v[56:63],v3
ds_read_b128 v[56:59],v11 offset:18432
s_add_u32 s57,s65,65536
s_waitcnt lgkmcnt(3)
v_smfmac_f32_16x16x64_bf16 v[112:115],v[28:31],v[64:71],v3
ds_read_b128 v[60:63],v11 offset:19456
s_add_u32 s58,s65,131072
s_waitcnt lgkmcnt(3)
v_smfmac_f32_16x16x64_bf16 v[112:115],v[32:35],v[72:79],v3
ds_read_b128 v[64:67],v11 offset:20480
s_add_u32 s59,s65,196608
s_waitcnt lgkmcnt(3)
v_smfmac_f32_16x16x64_bf16 v[112:115],v[36:39],v[80:87],v3
ds_read_b128 v[68:71],v11 offset:21504
v_smfmac_f32_16x16x64_bf16 v[116:119],v[24:27],v[96:103],v3
ds_read_b128 v[72:75],v11 offset:22528
v_smfmac_f32_16x16x64_bf16 v[116:119],v[28:31],v[104:111],v3
ds_read_b128 v[76:79],v11 offset:23552
v_cvt_pk_bf16_f32 v112,v112,v113
v_smfmac_f32_16x16x64_bf16 v[116:119],v[32:35],v[40:47],v3
ds_read_b128 v[80:83],v11 offset:24576
v_cvt_pk_bf16_f32 v113,v114,v115
buffer_store_dwordx2 v[112:113],v9,s[8:11],s65 offen sc1
v_smfmac_f32_16x16x64_bf16 v[116:119],v[36:39],v[48:55],v3
ds_read_b128 v[84:87],v11 offset:25600
v_mov_b64 v[112:113],0
v_smfmac_f32_16x16x64_bf16 v[120:123],v[24:27],v[88:95],v3
ds_read_b128 v[96:99],v11 offset:26624
ds_read_b128 v[100:103],v11 offset:27648
v_mov_b64 v[114:115],0
s_waitcnt lgkmcnt(8)
v_smfmac_f32_16x16x64_bf16 v[120:123],v[28:31],v[56:63],v3
ds_read_b128 v[104:107],v11 offset:28672
v_cvt_pk_bf16_f32 v116,v116,v117
s_waitcnt lgkmcnt(7)
v_smfmac_f32_16x16x64_bf16 v[120:123],v[32:35],v[64:71],v3
ds_read_b128 v[108:111],v11 offset:29696
ds_read_b128 v[40:43],v11 offset:30720
v_cvt_pk_bf16_f32 v117,v118,v119
buffer_store_dwordx2 v[116:117],v9,s[8:11],s57 offen sc1
s_waitcnt lgkmcnt(7)
v_smfmac_f32_16x16x64_bf16 v[120:123],v[36:39],v[72:79],v3
ds_read_b128 v[44:47],v11 offset:31744
v_add_u32 v52,s50,v5
s_waitcnt lgkmcnt(6)
v_smfmac_f32_16x16x64_bf16 v[112:115],v[24:27],v[80:87],v3
v_add_u32 v54,s50,v6
s_waitcnt lgkmcnt(4)
v_smfmac_f32_16x16x64_bf16 v[112:115],v[28:31],v[96:103],v3
ds_read_b64_tr_b16 v[52:53],v52
v_cvt_pk_bf16_f32 v120,v120,v121
s_waitcnt lgkmcnt(3)
v_smfmac_f32_16x16x64_bf16 v[112:115],v[32:35],v[104:111],v3
ds_read_b64_tr_b16 v[54:55],v54
v_cvt_pk_bf16_f32 v121,v122,v123
buffer_store_dwordx2 v[120:121],v9,s[8:11],s58 offen sc1
s_waitcnt lgkmcnt(2)
s_add_u32 s56,s18,s75
v_smfmac_f32_16x16x64_bf16 v[112:115],v[36:39],v[40:47],v3
v_mov_b64 v[116:117],0
v_mov_b64 v[118:119],0
s_xor_b32 s65,s65,262144
v_mov_b32_dpp v124,v126 quad_perm:[2,3,2,3] row_mask:0xf bank_mask:0xf
v_mov_b32_dpp v125,v127 quad_perm:[2,3,2,3] row_mask:0xf bank_mask:0xf
s_mov_b32 vcc_lo,0xcccccccc
s_mov_b32 vcc_hi,0xcccccccc
s_nop 0
v_cvt_pk_bf16_f32 v112,v112,v113
v_cvt_pk_bf16_f32 v113,v114,v115
buffer_store_dwordx2 v[112:113],v9,s[8:11],s59 offen sc1
s_waitcnt lgkmcnt(0)
s_buffer_load_dword s19,s[8:11],s56
v_cndmask_b32 v124,v124,v52,vcc
v_cndmask_b32 v125,v125,v53,vcc
v_cndmask_b32 v126,v126,v54,vcc
v_cndmask_b32 v127,v127,v55,vcc
v_mov_b64 v[96:97],0
v_mov_b64 v[98:99],0
v_mov_b64 v[100:101],0
v_mov_b64 v[102:103],0
v_mov_b64 v[104:105],0
v_mov_b64 v[106:107],0
v_mov_b64 v[108:109],0
v_mov_b64 v[110:111],0
v_mov_b64 v[112:113],0
v_mov_b64 v[114:115],0
v_add_u32 v55,131072,v0
v_add_u32 v123,s73,v55
v_xor_b32 v120,1024,v12
v_xor_b32 v121,2048,v12
v_xor_b32 v122,3072,v12
s_cmp_lt_u32 s46,2
s_waitcnt vmcnt(2)
s_cbranch_scc1 L_crg_235
s_cmp_eq_u32 s46,2
s_waitcnt vmcnt(1)
s_cbranch_scc1 L_crg_235
s_waitcnt vmcnt(0)
L_crg_235:
buffer_load_dwordx4 v[32:35],v0,s[8:11],s66 offen offset:0 sc1
buffer_load_dwordx4 v[36:39],v0,s[8:11],s66 offen offset:1024 sc1
s_cmp_ge_u32 s51,63
s_cselect_b32 s76,0,1
s_cmp_eq_u32 s46,0
s_cselect_b32 s76,s76,0
s_waitcnt vmcnt(1)
v_mfma_f32_16x16x32_bf16 v[28:31],v[18:21],v[32:35],0
s_waitcnt vmcnt(0)
v_mfma_f32_16x16x32_bf16 v[28:31],v[18:21],v[36:39],v[28:31]
s_nop 7
v_cmp_u_f32 vcc,v28,v28
v_add_f32_dpp v52,v28,v28 row_ror:8 row_mask:0xf bank_mask:0x3
v_add_f32_dpp v53,v29,v29 row_ror:8 row_mask:0xf bank_mask:0x3
v_add_f32_dpp v52,v30,v30 row_ror:8 row_mask:0xf bank_mask:0xc
v_add_f32_dpp v53,v31,v31 row_ror:8 row_mask:0xf bank_mask:0xc
s_nop 0
v_add_f32_dpp v52,v52,v52 row_shl:4 row_mask:0xf bank_mask:0x5
v_add_f32_dpp v53,v53,v53 row_shl:4 row_mask:0xf bank_mask:0x5
s_cbranch_vccnz L_crp_230
L_cok_236:
v_cvt_pk_bf16_f32 v54,v52,v53
buffer_store_dword v54,v10,s[8:11],s64 offen sc1
s_mov_b32 s69,s66
s_xor_b32 s66,s66,262144
s_barrier
ds_read_b128 v[56:59],v55 offset:0
ds_read_b128 v[60:63],v55 offset:4096
ds_read_b128 v[64:67],v55 offset:1024
buffer_load_dwordx4 v[24:27],v13,s[8:11],s64 offen sc1
ds_read_b128 v[68:71],v55 offset:5120
ds_read_b128 v[72:75],v55 offset:2048
ds_read_b128 v[76:79],v55 offset:6144
ds_read_b128 v[80:83],v55 offset:3072
buffer_load_dwordx4 v[24:27],v13,s[8:11],s64 offen sc1
ds_read_b128 v[84:87],v55 offset:7168
ds_read_b128 v[88:91],v123 offset:8192
ds_read_b128 v[92:95],v123 offset:9216
s_branch L_chain_225
L_cpb_232:
buffer_load_dwordx4 v[40:43],v13,s[8:11],s70 offen sc1
s_sub_u32 s49,s49,1
s_cbranch_scc1 L_abort2
s_waitcnt vmcnt(0)
v_max3_u32 v123,v40,v41,v42
v_max_u32 v123,v43,v123
v_cmp_le_u32 vcc,s72,v123
s_cbranch_vccnz L_cpb_232
ds_write_b128 v12,v[40:43] offset:4096
s_branch L_cback_234
L_crp_230:
buffer_load_dwordx4 v[32:35],v0,s[8:11],s66 offen offset:0 sc1
buffer_load_dwordx4 v[36:39],v0,s[8:11],s66 offen offset:1024 sc1
s_sub_u32 s49,s49,1
s_cbranch_scc1 L_abort2
s_waitcnt vmcnt(1)
v_mfma_f32_16x16x32_bf16 v[28:31],v[18:21],v[32:35],0
s_waitcnt vmcnt(0)
v_mfma_f32_16x16x32_bf16 v[28:31],v[18:21],v[36:39],v[28:31]
s_nop 7
v_cmp_u_f32 vcc,v28,v28
v_add_f32_dpp v52,v28,v28 row_ror:8 row_mask:0xf bank_mask:0x3
v_add_f32_dpp v53,v29,v29 row_ror:8 row_mask:0xf bank_mask:0x3
v_add_f32_dpp v52,v30,v30 row_ror:8 row_mask:0xf bank_mask:0xc
v_add_f32_dpp v53,v31,v31 row_ror:8 row_mask:0xf bank_mask:0xc
s_nop 0
v_add_f32_dpp v52,v52,v52 row_shl:4 row_mask:0xf bank_mask:0x5
v_add_f32_dpp v53,v53,v53 row_shl:4 row_mask:0xf bank_mask:0x5
s_cbranch_vccz L_cok_236
s_branch L_crp_230
L_ckw_218:
s_add_u32 s59,s18,s75
L_ww_237:
s_sleep 1
buffer_load_dword v23,off,s[8:11],s59 sc1
s_sub_u32 s49,s49,1
s_cbranch_scc1 L_abort2
s_waitcnt vmcnt(0)
v_readfirstlane_b32 s76,v23
s_cmp_eq_u32 s76,0
s_cbranch_scc1 L_ww_237
L_wwd_238:
s_branch L_ckb_219
L_cend_228:
v_smfmac_f32_16x16x64_bf16 v[116:119],v[36:39],v[184:191],v2
v_smfmac_f32_16x16x64_bf16 v[112:115],v[40:43],v[192:199],v2
v_smfmac_f32_16x16x64_bf16 v[116:119],v[40:43],v[200:207],v2
v_smfmac_f32_16x16x64_bf16 v[112:115],v[44:47],v[208:215],v2
v_smfmac_f32_16x16x64_bf16 v[116:119],v[44:47],v[216:223],v2
v_smfmac_f32_16x16x64_bf16 v[112:115],v[48:51],v[224:231],v2
v_smfmac_f32_16x16x64_bf16 v[116:119],v[48:51],v[232:239],v2
v_smfmac_f32_16x16x64_bf16 v[112:115],v[52:55],v[240:247],v2
v_smfmac_f32_16x16x64_bf16 v[116:119],v[52:55],v[248:255],v2
s_waitcnt lgkmcnt(0)
s_nop 2
v_pk_add_f32 v[112:113],v[112:113],v[114:115]
s_nop 2
v_pk_add_f32 v[116:117],v[116:117],v[118:119]
v_cvt_pk_bf16_f32 v126,v112,v113
v_cvt_pk_bf16_f32 v127,v116,v117
v_add_u32 v52,s50,v5
v_add_u32 v54,s50,v6
ds_read_b64_tr_b16 v[52:53],v52
ds_read_b64_tr_b16 v[54:55],v54
v_mov_b32_dpp v124,v126 quad_perm:[2,3,2,3] row_mask:0xf bank_mask:0xf
v_mov_b32_dpp v125,v127 quad_perm:[2,3,2,3] row_mask:0xf bank_mask:0xf
s_mov_b32 vcc_lo,0xcccccccc
s_mov_b32 vcc_hi,0xcccccccc
s_waitcnt lgkmcnt(0)
v_cndmask_b32 v124,v124,v52,vcc
v_cndmask_b32 v125,v125,v53,vcc
v_cndmask_b32 v126,v126,v54,vcc
v_cndmask_b32 v127,v127,v55,vcc
buffer_store_dwordx4 v[124:127],v0,s[8:11],s54 offen sc1
s_mov_b32 s51,64
s_waitcnt vmcnt(0)
s_barrier
s_nop 11
v_lshrrev_b32 v1,4,v0
s_mov_b32 s53,0
s_branch L_rb_7
L_rc1_212:
v_and_b32 v120,15,v1
v_lshrrev_b32 v121,4,v1
v_and_b32 v122,2,v1
v_cmp_eq_u32 vcc,0,v122
v_mov_b32 v2,0xeeee
v_mov_b32 v123,0x4444
v_cndmask_b32 v2,v2,v123,vcc
v_and_b32 v122,1,v1
v_cmp_eq_u32 vcc,0,v122
v_mov_b32 v3,0xdddd
v_mov_b32 v123,0x8888
v_cndmask_b32 v3,v3,v123,vcc
v_lshrrev_b32 v122,1,v120
v_bfe_u32 v123,v120,2,1
v_xor_b32 v123,v123,v122
v_lshlrev_b32 v4,7,v123
v_and_b32 v123,1,v120
v_lshl_add_u32 v4,v123,6,v4
v_xor_b32 v123,v121,v122
v_and_b32 v123,3,v123
v_lshl_add_u32 v4,v123,4,v4
s_lshl_b32 s56,s46,10
s_add_u32 s56,s56,147456
v_add_u32 v4,s56,v4
v_lshlrev_b32 v122,1,v121
v_add_u32 v122,0,v122
v_and_b32 v123,1,v121
v_xor_b32 v123,v123,v122
v_lshlrev_b32 v5,7,v123
v_bfe_u32 v123,v120,3,1
v_lshl_add_u32 v5,v123,6,v5
v_xor_b32 v123,v120,v122
v_and_b32 v123,3,v123
v_lshl_add_u32 v5,v123,4,v5
v_bfe_u32 v123,v120,2,1
v_lshl_add_u32 v5,v123,3,v5
v_add_u32 v5,147456,v5
v_lshlrev_b32 v122,1,v121
v_add_u32 v122,1,v122
v_and_b32 v123,1,v121
v_xor_b32 v123,v123,v122
v_lshlrev_b32 v6,7,v123
v_bfe_u32 v123,v120,3,1
v_lshl_add_u32 v6,v123,6,v6
v_xor_b32 v123,v120,v122
v_and_b32 v123,3,v123
v_lshl_add_u32 v6,v123,4,v6
v_bfe_u32 v123,v120,2,1
v_lshl_add_u32 v6,v123,3,v6
v_add_u32 v6,147456,v6
v_lshlrev_b32 v7,7,v121
v_lshrrev_b32 v122,1,v120
v_lshl_add_u32 v8,v122,4,v7
v_add_u32 v8,151552,v8
v_lshrrev_b32 v122,2,v120
v_lshl_add_u32 v7,v122,5,v7
v_and_b32 v122,1,v120
v_lshl_add_u32 v7,v122,4,v7
v_and_b32 v122,2,v120
v_cmp_eq_u32 vcc,0,v122
s_lshl_b32 s56,s46,9
v_mov_b32 v122,2048
v_mov_b32 v123,s56
v_cndmask_b32 v122,v122,v123,vcc
v_add_u32 v7,v122,v7
v_add_u32 v7,151552,v7
v_lshrrev_b32 v122,3,v1
v_lshlrev_b32 v9,11,v122
v_and_b32 v122,7,v1
v_lshl_add_u32 v9,v122,3,v9
s_lshl_b32 s56,s46,14
s_lshl_b32 s57,s47,6
s_add_u32 s56,s56,s57
v_add_u32 v9,s56,v9
s_lshl_b32 s71,s46,5
s_add_u32 s71,s71,s47
s_bfe_u32 s56,s71,0x10003
s_lshl_b32 s56,s56,11
s_and_b32 s57,s71,1
s_lshl_b32 s57,s57,10
s_add_u32 s56,s56,s57
s_bfe_u32 s57,s71,0x10002
s_lshl_b32 s57,s57,9
s_add_u32 s56,s56,s57
s_bfe_u32 s57,s71,0x10001
s_lshl_b32 s57,s57,6
s_add_u32 s56,s56,s57
s_bfe_u32 s57,s71,0x10004
s_lshl_b32 s57,s57,8
s_add_u32 s56,s56,s57
s_bfe_u32 s57,s71,0x10005
s_lshl_b32 s57,s57,7
s_add_u32 s56,s56,s57
s_bfe_u32 s57,s71,0x10006
s_lshl_b32 s57,s57,12
s_add_u32 s56,s56,s57
v_and_b32 v122,3,v120
v_lshlrev_b32 v10,2,v122
v_bfe_u32 v122,v120,3,1
v_lshl_add_u32 v10,v122,4,v10
v_and_b32 v122,1,v121
v_lshl_add_u32 v10,v122,5,v10
v_add_u32 v10,s56,v10
v_and_b32 v123,36,v1
v_mov_b32 v122,0x80000000
v_cmp_eq_u32 vcc,0,v123
s_nop 1
v_cndmask_b32 v10,v122,v10,vcc
s_lshl_b32 s56,s46,15
v_add_u32 v11,s56,v0
s_lshl_b32 s71,s71,11
s_lshl_b32 s73,s46,11
s_mov_b32 s72,0xffc00000
s_mov_b32 s74,0
v_lshrrev_b32 v13,3,v1
v_lshlrev_b32 v13,9,v13
v_and_b32 v122,7,v1
v_lshl_add_u32 v13,v122,4,v13
v_and_b32 v122,15,v1
v_and_b32 v123,1,v1
v_lshlrev_b32 v123,4,v123
v_mov_b32 v124,0x3f80
v_lshlrev_b32 v124,v123,v124
v_lshrrev_b32 v122,1,v122
v_cmp_eq_u32 vcc,0,v122
s_nop 1
v_cndmask_b32 v18,0,v124,vcc
v_cmp_eq_u32 vcc,1,v122
s_nop 1
v_cndmask_b32 v19,0,v124,vcc
v_cmp_eq_u32 vcc,2,v122
s_nop 1
v_cndmask_b32 v20,0,v124,vcc
v_cmp_eq_u32 vcc,3,v122
s_nop 1
v_cndmask_b32 v21,0,v124,vcc
s_and_b32 s56,s46,1
s_lshl_b32 s56,s56,8
s_and_b32 s57,s46,2
s_lshl_b32 s57,s57,6
s_add_u32 s56,s56,s57
v_add_u32 v13,s56,v13
s_add_u32 s56,s50,155648
v_add_u32 v12,s56,v0
v_mov_b64 v[14:15],s[28:29]
v_mov_b64 v[16:17],s[28:29]
v_add_u32 v22,12599296,v10
s_lshl_b32 s18,s47,2
s_add_u32 s18,s18,10494080
v_mov_b32 v1,s80
s_mov_b32 s65,15728640
s_add_u32 s66,s71,15728640
s_add_u32 s69,s71,15990784
s_mov_b32 s30,0x40000000
s_mov_b32 s51,0
L_cst_242:
s_cmp_lg_u32 s46,0
s_cbranch_scc1 L_csw_247
s_lshl_b32 s59,s51,13
s_lshl2_add_u32 s59,s47,s59
s_add_u32 s59,s59,10485888
L_ww_248:
s_sleep 1
buffer_load_dword v122,off,s[8:11],s59 sc1
s_sub_u32 s49,s49,1
s_cbranch_scc1 L_abort2
s_waitcnt vmcnt(0)
v_readfirstlane_b32 s61,v122
s_cmp_eq_u32 s61,0
s_cbranch_scc1 L_ww_248
L_wwd_249:
L_csw_247:
s_waitcnt lgkmcnt(0)
s_barrier
s_lshl_b32 s56,s51,5
s_add_u32 s56,s56,s47
s_mul_i32 s56,s56,24576
s_add_u32 s56,s56,150994944
s_add_u32 s67,s56,s73
s_add_u32 m0,s73,131072
s_add_u32 s57,s67,8192
buffer_load_dwordx4 v0,s[8:11],s67 offen sc1 lds
buffer_load_dwordx4 v0,s[8:11],s67 offen offset:1024 sc1 lds
s_add_u32 m0,s73,139264
s_add_u32 s67,s67,786432
buffer_load_dwordx4 v0,s[8:11],s57 offen sc1 lds
buffer_load_dwordx4 v0,s[8:11],s57 offen offset:1024 sc1 lds
s_lshl_b32 s75,s51,13
s_add_u32 s56,s75,12591104
buffer_load_dword v23,v10,s[8:11],s56 offen sc1
s_add_u32 s64,s75,12582912
s_add_u32 s70,s64,4096
s_lshl_b32 s68,s51,5
s_add_u32 s68,s68,s47
s_lshl_b32 s68,s68,12
s_lshl_b32 s56,s46,10
s_add_u32 s68,s68,s56
s_add_u32 s68,s68,58720256
s_mov_b32 s54,0x80000000
s_mov_b32 s77,0
s_mov_b32 s19,0
s_cmp_eq_u32 s51,63
s_cselect_b32 s76,1,s46
s_cmp_eq_u32 s76,0
s_cselect_b32 s76,1,0
v_mov_b64 v[96:97],0
v_mov_b64 v[98:99],0
v_mov_b64 v[100:101],0
v_mov_b64 v[102:103],0
v_mov_b64 v[104:105],0
v_mov_b64 v[106:107],0
v_mov_b64 v[108:109],0
v_mov_b64 v[110:111],0
v_mov_b64 v[112:113],0
v_mov_b64 v[114:115],0
v_mov_b64 v[116:117],0
v_mov_b64 v[118:119],0
s_waitcnt vmcnt(0) lgkmcnt(0)
s_barrier
v_add_u32 v55,131072,v0
ds_read_b128 v[56:59],v55 offset:0
ds_read_b128 v[60:63],v55 offset:4096
ds_read_b128 v[64:67],v55 offset:1024
ds_read_b128 v[68:71],v55 offset:5120
ds_read_b128 v[72:75],v55 offset:2048
ds_read_b128 v[76:79],v55 offset:6144
ds_read_b128 v[80:83],v55 offset:3072
ds_read_b128 v[84:87],v55 offset:7168
v_add_u32 v123,s73,v55
ds_read_b128 v[88:91],v123 offset:8192
ds_read_b128 v[92:95],v123 offset:9216
v_xor_b32 v120,1024,v12
v_xor_b32 v121,2048,v12
v_xor_b32 v122,3072,v12
buffer_load_dwordx4 v[24:27],v13,s[8:11],s64 offen sc1
buffer_load_dwordx4 v[24:27],v13,s[8:11],s64 offen sc1
L_chain_250:
L_cpa_251:
buffer_load_dwordx4 v[24:27],v13,s[8:11],s64 offen sc1
s_sub_u32 s49,s49,1
s_cbranch_scc1 L_abort2
s_waitcnt vmcnt(2)
v_max3_u32 v123,v24,v25,v26
v_max_u32 v123,v27,v123
v_cmp_le_u32 vcc,s72,v123
s_cbranch_vccnz L_cpa_251
L_cgo_254:
ds_write_b128 v12,v[24:27] offset:0
v_smfmac_f32_16x16x64_bf16 v[96:99],v[24:27],a[0:7],v2
buffer_load_dwordx4 v[40:43],v13,s[8:11],s70 offen sc1
v_smfmac_f32_16x16x64_bf16 v[100:103],v[24:27],a[128:135],v2
v_smfmac_f32_16x16x64_bf16 v[104:107],v[24:27],a[8:15],v2
v_smfmac_f32_16x16x64_bf16 v[108:111],v[24:27],a[136:143],v2
s_waitcnt lgkmcnt(0)
s_barrier
ds_read_b128 v[28:31],v120 offset:0
v_smfmac_f32_16x16x64_bf16 v[112:115],v[24:27],v[128:135],v2
ds_read_b128 v[32:35],v121 offset:0
v_smfmac_f32_16x16x64_bf16 v[116:119],v[24:27],v[136:143],v2
ds_read_b128 v[36:39],v122 offset:0
s_waitcnt lgkmcnt(2)
v_smfmac_f32_16x16x64_bf16 v[96:99],v[28:31],a[16:23],v2
s_add_u32 m0,s73,131072
v_smfmac_f32_16x16x64_bf16 v[100:103],v[28:31],a[144:151],v2
s_add_u32 s57,s67,8192
v_smfmac_f32_16x16x64_bf16 v[104:107],v[28:31],a[24:31],v2
s_cmp_lt_u32 s19,s76
s_cbranch_scc1 L_ckw_243
L_ckb_244:
v_smfmac_f32_16x16x64_bf16 v[108:111],v[28:31],a[152:159],v2
s_waitcnt vmcnt(0) lgkmcnt(1)
v_smfmac_f32_16x16x64_bf16 v[96:99],v[32:35],a[32:39],v2
ds_write_b128 v12,v[40:43] offset:4096
v_max3_u32 v123,v40,v41,v42
v_smfmac_f32_16x16x64_bf16 v[100:103],v[32:35],a[160:167],v2
v_max_u32 v123,v43,v123
v_smfmac_f32_16x16x64_bf16 v[104:107],v[32:35],a[40:47],v2
v_cmp_le_u32 vcc,s72,v123
v_smfmac_f32_16x16x64_bf16 v[108:111],v[32:35],a[168:175],v2
v_smfmac_f32_16x16x64_bf16 v[112:115],v[28:31],v[144:151],v2
s_cbranch_vccnz L_cpb_257
L_cback_259:
s_waitcnt lgkmcnt(0)
s_barrier
buffer_store_dword v54,v10,s[8:11],s30 offen sc1
v_smfmac_f32_16x16x64_bf16 v[96:99],v[36:39],a[48:55],v2
buffer_store_dwordx4 v[124:127],v0,s[8:11],s54 offen sc1
v_smfmac_f32_16x16x64_bf16 v[100:103],v[36:39],a[176:183],v2
ds_read_b128 v[44:47],v120 offset:4096
v_smfmac_f32_16x16x64_bf16 v[104:107],v[36:39],a[56:63],v2
buffer_load_dwordx4 v0,s[8:11],s67 offen sc1 lds
v_smfmac_f32_16x16x64_bf16 v[108:111],v[36:39],a[184:191],v2
ds_read_b128 v[48:51],v121 offset:4096
v_smfmac_f32_16x16x64_bf16 v[96:99],v[40:43],a[64:71],v2
buffer_load_dwordx4 v0,s[8:11],s67 offen offset:1024 sc1 lds
s_add_u32 m0,s73,139264
v_smfmac_f32_16x16x64_bf16 v[100:103],v[40:43],a[192:199],v2
ds_read_b128 v[52:55],v122 offset:4096
v_smfmac_f32_16x16x64_bf16 v[104:107],v[40:43],a[72:79],v2
buffer_load_dwordx4 v0,s[8:11],s57 offen sc1 lds
s_add_u32 s67,s67,786432
v_smfmac_f32_16x16x64_bf16 v[108:111],v[40:43],a[200:207],v2
s_waitcnt lgkmcnt(2)
v_smfmac_f32_16x16x64_bf16 v[96:99],v[44:47],a[80:87],v2
buffer_load_dwordx4 v0,s[8:11],s57 offen offset:1024 sc1 lds
v_smfmac_f32_16x16x64_bf16 v[100:103],v[44:47],a[208:215],v2
s_waitcnt lgkmcnt(1)
v_smfmac_f32_16x16x64_bf16 v[96:99],v[48:51],a[96:103],v2
buffer_load_dword v23,v22,s[8:11],s75 offen sc1
v_smfmac_f32_16x16x64_bf16 v[100:103],v[48:51],a[224:231],v2
s_waitcnt lgkmcnt(0)
v_smfmac_f32_16x16x64_bf16 v[96:99],v[52:55],a[112:119],v2
v_smfmac_f32_16x16x64_bf16 v[100:103],v[52:55],a[240:247],v2
v_smfmac_f32_16x16x64_bf16 v[104:107],v[44:47],a[88:95],v2
v_smfmac_f32_16x16x64_bf16 v[108:111],v[44:47],a[216:223],v2
v_smfmac_f32_16x16x64_bf16 v[104:107],v[48:51],a[104:111],v2
v_add_f32 v96,v96,v98
v_smfmac_f32_16x16x64_bf16 v[108:111],v[48:51],a[232:239],v2
v_add_f32 v97,v97,v99
v_smfmac_f32_16x16x64_bf16 v[104:107],v[52:55],a[120:127],v2
v_cvt_pk_bf16_f32 v120,v96,v97
v_smfmac_f32_16x16x64_bf16 v[108:111],v[52:55],a[248:255],v2
v_add_f32 v100,v100,v102
v_smfmac_f32_16x16x64_bf16 v[116:119],v[28:31],v[152:159],v2
v_add_f32 v101,v101,v103
v_smfmac_f32_16x16x64_bf16 v[112:115],v[32:35],v[160:167],v2
v_cvt_pk_bf16_f32 v121,v100,v101
v_add_f32 v104,v104,v106
v_add_f32 v105,v105,v107
v_cvt_pk_bf16_f32 v122,v104,v105
v_add_f32 v108,v108,v110
v_add_f32 v109,v109,v111
v_cvt_pk_bf16_f32 v123,v108,v109
ds_write_b128 v4,v[120:123]
v_smfmac_f32_16x16x64_bf16 v[116:119],v[32:35],v[168:175],v2
s_mov_b32 s54,s68
s_add_u32 s68,s68,131072
v_mov_b32 v125,0
v_smfmac_f32_16x16x64_bf16 v[112:115],v[36:39],v[176:183],v2
s_cmp_eq_u32 s51,63
s_cbranch_scc1 L_cend_253
v_smfmac_f32_16x16x64_bf16 v[116:119],v[36:39],v[184:191],v2
v_smfmac_f32_16x16x64_bf16 v[112:115],v[40:43],v[192:199],v2
s_waitcnt lgkmcnt(0)
s_barrier
ds_read_b64_tr_b16 v[96:97],v5 offset:0
ds_read_b64_tr_b16 v[98:99],v6 offset:0
v_smfmac_f32_16x16x64_bf16 v[116:119],v[40:43],v[200:207],v2
ds_read_b64_tr_b16 v[100:101],v5 offset:1024
v_smfmac_f32_16x16x64_bf16 v[112:115],v[44:47],v[208:215],v2
ds_read_b64_tr_b16 v[102:103],v6 offset:1024
v_smfmac_f32_16x16x64_bf16 v[116:119],v[44:47],v[216:223],v2
ds_read_b64_tr_b16 v[104:105],v5 offset:2048
v_smfmac_f32_16x16x64_bf16 v[112:115],v[48:51],v[224:231],v2
ds_read_b64_tr_b16 v[106:107],v6 offset:2048
s_waitcnt lgkmcnt(4)
v_mfma_f32_16x16x32_bf16 v[24:27],v[56:59],v[96:99],0
ds_read_b64_tr_b16 v[108:109],v5 offset:3072
v_mfma_f32_16x16x32_bf16 v[28:31],v[60:63],v[96:99],0
ds_read_b64_tr_b16 v[110:111],v6 offset:3072
v_mfma_f32_16x16x32_bf16 v[32:35],v[96:99],v[96:99],0
ds_read_b128 v[40:43],v11 offset:12288
s_waitcnt lgkmcnt(5)
v_mfma_f32_16x16x32_bf16 v[24:27],v[64:67],v[100:103],v[24:27]
ds_read_b128 v[56:59],v11 offset:0
v_mfma_f32_16x16x32_bf16 v[28:31],v[68:71],v[100:103],v[28:31]
ds_read_b128 v[60:63],v11 offset:1024
v_mfma_f32_16x16x32_bf16 v[32:35],v[100:103],v[100:103],v[32:35]
ds_read_b128 v[96:99],v11 offset:8192
s_waitcnt lgkmcnt(6)
v_mfma_f32_16x16x32_bf16 v[24:27],v[72:75],v[104:107],v[24:27]
ds_read_b128 v[64:67],v11 offset:2048
v_mfma_f32_16x16x32_bf16 v[28:31],v[76:79],v[104:107],v[28:31]
ds_read_b128 v[68:71],v11 offset:3072
v_mfma_f32_16x16x32_bf16 v[32:35],v[104:107],v[104:107],v[32:35]
ds_read_b128 v[100:103],v11 offset:9216
s_waitcnt lgkmcnt(7)
v_mfma_f32_16x16x32_bf16 v[24:27],v[80:83],v[108:111],v[24:27]
ds_read_b128 v[72:75],v11 offset:4096
v_mfma_f32_16x16x32_bf16 v[28:31],v[84:87],v[108:111],v[28:31]
ds_read_b128 v[76:79],v11 offset:5120
v_mfma_f32_16x16x32_bf16 v[32:35],v[108:111],v[108:111],v[32:35]
ds_read_b128 v[104:107],v11 offset:10240
v_smfmac_f32_16x16x64_bf16 v[116:119],v[48:51],v[232:239],v2
ds_read_b128 v[80:83],v11 offset:6144
v_smfmac_f32_16x16x64_bf16 v[112:115],v[52:55],v[240:247],v2
ds_read_b128 v[84:87],v11 offset:7168
v_smfmac_f32_16x16x64_bf16 v[116:119],v[52:55],v[248:255],v2
ds_read_b128 v[108:111],v11 offset:11264
v_max3_f32 v126,v24,v25,v26
v_max3_f32 v127,v27,v28,v29
v_max3_f32 v126,v30,v31,v126
v_max3_f32 v127,v34,v35,v127
v_max_f32 v126,v126,v127
v_max_f32 v127,v126,v127
v_pk_mul_f32 v[34:35],v[34:35],v[0:1] op_sel:[0,1]
v_pk_mul_f32 v[24:25],v[24:25],v[0:1] op_sel:[0,1]
v_permlane16_swap_b32 v126,v127
v_max_f32 v126,v126,v127
v_max_f32 v127,v126,v127
v_pk_mul_f32 v[26:27],v[26:27],v[0:1] op_sel:[0,1]
v_pk_mul_f32 v[28:29],v[28:29],v[0:1] op_sel:[0,1]
v_permlane32_swap_b32 v126,v127
v_max_f32 v126,v126,v127
v_mul_f32 v126,v1,v126
v_pk_mul_f32 v[30:31],v[30:31],v[0:1] op_sel:[0,1]
v_pk_add_f32 v[34:35],v[34:35],v[126:127] op_sel_hi:[1,0] neg_lo:[0,1] neg_hi:[0,1]
v_pk_add_f32 v[112:113],v[112:113],v[114:115]
v_pk_add_f32 v[116:117],v[116:117],v[118:119]
v_pk_add_f32 v[24:25],v[24:25],v[126:127] op_sel_hi:[1,0] neg_lo:[0,1] neg_hi:[0,1]
v_pk_add_f32 v[26:27],v[26:27],v[126:127] op_sel_hi:[1,0] neg_lo:[0,1] neg_hi:[0,1]
v_pk_add_f32 v[28:29],v[28:29],v[126:127] op_sel_hi:[1,0] neg_lo:[0,1] neg_hi:[0,1]
v_pk_add_f32 v[30:31],v[30:31],v[126:127] op_sel_hi:[1,0] neg_lo:[0,1] neg_hi:[0,1]
v_exp_f32 v34,v34
v_exp_f32 v35,v35
v_cvt_pk_bf16_f32 v126,v112,v113
v_cvt_pk_bf16_f32 v124,v34,v35
v_cvt_pk_bf16_f32 v127,v116,v117
v_cvt_pk_bf16_f32 v36,v116,v117
v_mfma_f32_16x16x16_bf16 v[32:35],v[14:15],v[124:125],0
ds_read_b128 v[44:47],v11 offset:13312
v_exp_f32 v24,v24
v_mfma_f32_16x16x16_bf16 v[112:115],v[126:127],v[124:125],0
ds_read_b128 v[48:51],v11 offset:14336
v_exp_f32 v25,v25
v_mfma_f32_16x16x16_bf16 v[116:119],v[36:37],v[124:125],0
ds_read_b128 v[52:55],v11 offset:15360
v_exp_f32 v26,v26
v_exp_f32 v27,v27
v_cvt_pk_bf16_f32 v120,v24,v25
v_exp_f32 v28,v28
v_exp_f32 v29,v29
v_cvt_pk_bf16_f32 v121,v26,v27
v_exp_f32 v30,v30
v_exp_f32 v31,v31
v_cvt_pk_bf16_f32 v122,v28,v29
v_cvt_pk_bf16_f32 v123,v30,v31
s_add_u32 s75,s75,8192
s_add_u32 s51,s51,1
v_mfma_f32_16x16x32_bf16 v[32:35],v[14:17],v[120:123],v[32:35]
v_mfma_f32_16x16x32_bf16 v[112:115],v[88:91],v[120:123],v[112:115]
ds_read_b128 v[88:91],v11 offset:16384
v_mfma_f32_16x16x32_bf16 v[116:119],v[92:95],v[120:123],v[116:119]
ds_read_b128 v[92:95],v11 offset:17408
v_rcp_f32 v32,v32
v_mov_b64 v[24:25],-1
v_mov_b64 v[26:27],-1
s_add_u32 s64,s75,12582912
s_add_u32 s70,s64,4096
v_pk_mul_f32 v[112:113],v[112:113],v[32:33] op_sel_hi:[1,0]
v_pk_mul_f32 v[114:115],v[114:115],v[32:33] op_sel_hi:[1,0]
v_pk_mul_f32 v[116:117],v[116:117],v[32:33] op_sel_hi:[1,0]
v_pk_mul_f32 v[118:119],v[118:119],v[32:33] op_sel_hi:[1,0]
v_cvt_pk_bf16_f32 v120,v112,v116
v_cvt_pk_bf16_f32 v121,v113,v117
v_cvt_pk_bf16_f32 v122,v114,v118
v_cvt_pk_bf16_f32 v123,v115,v119
ds_write_b128 v7,v[120:123]
buffer_store_dwordx4 v[24:27],v0,s[8:11],s69 offen sc1
buffer_store_dwordx4 v[24:27],v0,s[8:11],s69 offen offset:1024 sc1
v_mov_b64 v[112:113],0
v_mov_b64 v[114:115],0
v_mov_b64 v[116:117],0
v_mov_b64 v[118:119],0
s_waitcnt lgkmcnt(0)
s_barrier
ds_read_b128 v[24:27],v8 offset:0
ds_read_b128 v[28:31],v8 offset:512
ds_read_b128 v[32:35],v8 offset:1024
ds_read_b128 v[36:39],v8 offset:1536
v_mov_b64 v[120:121],0
v_mov_b64 v[122:123],0
s_waitcnt lgkmcnt(3)
v_smfmac_f32_16x16x64_bf16 v[112:115],v[24:27],v[56:63],v3
ds_read_b128 v[56:59],v11 offset:18432
s_add_u32 s57,s65,65536
s_waitcnt lgkmcnt(3)
v_smfmac_f32_16x16x64_bf16 v[112:115],v[28:31],v[64:71],v3
ds_read_b128 v[60:63],v11 offset:19456
s_add_u32 s58,s65,131072
s_waitcnt lgkmcnt(3)
v_smfmac_f32_16x16x64_bf16 v[112:115],v[32:35],v[72:79],v3
ds_read_b128 v[64:67],v11 offset:20480
s_add_u32 s59,s65,196608
s_waitcnt lgkmcnt(3)
v_smfmac_f32_16x16x64_bf16 v[112:115],v[36:39],v[80:87],v3
ds_read_b128 v[68:71],v11 offset:21504
s_add_u32 s30,s75,17825792
v_smfmac_f32_16x16x64_bf16 v[116:119],v[24:27],v[96:103],v3
ds_read_b128 v[72:75],v11 offset:22528
v_smfmac_f32_16x16x64_bf16 v[116:119],v[28:31],v[104:111],v3
ds_read_b128 v[76:79],v11 offset:23552
v_cvt_pk_bf16_f32 v112,v112,v113
v_smfmac_f32_16x16x64_bf16 v[116:119],v[32:35],v[40:47],v3
ds_read_b128 v[80:83],v11 offset:24576
v_cvt_pk_bf16_f32 v113,v114,v115
buffer_store_dwordx2 v[112:113],v9,s[8:11],s65 offen sc1
v_smfmac_f32_16x16x64_bf16 v[116:119],v[36:39],v[48:55],v3
ds_read_b128 v[84:87],v11 offset:25600
v_mov_b64 v[112:113],0
v_smfmac_f32_16x16x64_bf16 v[120:123],v[24:27],v[88:95],v3
ds_read_b128 v[96:99],v11 offset:26624
ds_read_b128 v[100:103],v11 offset:27648
v_mov_b64 v[114:115],0
s_waitcnt lgkmcnt(8)
v_smfmac_f32_16x16x64_bf16 v[120:123],v[28:31],v[56:63],v3
ds_read_b128 v[104:107],v11 offset:28672
v_cvt_pk_bf16_f32 v116,v116,v117
s_waitcnt lgkmcnt(7)
v_smfmac_f32_16x16x64_bf16 v[120:123],v[32:35],v[64:71],v3
ds_read_b128 v[108:111],v11 offset:29696
ds_read_b128 v[40:43],v11 offset:30720
v_cvt_pk_bf16_f32 v117,v118,v119
buffer_store_dwordx2 v[116:117],v9,s[8:11],s57 offen sc1
s_waitcnt lgkmcnt(7)
v_smfmac_f32_16x16x64_bf16 v[120:123],v[36:39],v[72:79],v3
ds_read_b128 v[44:47],v11 offset:31744
v_add_u32 v52,s50,v5
s_waitcnt lgkmcnt(6)
v_smfmac_f32_16x16x64_bf16 v[112:115],v[24:27],v[80:87],v3
v_add_u32 v54,s50,v6
s_waitcnt lgkmcnt(4)
v_smfmac_f32_16x16x64_bf16 v[112:115],v[28:31],v[96:103],v3
ds_read_b64_tr_b16 v[52:53],v52
v_cvt_pk_bf16_f32 v120,v120,v121
s_waitcnt lgkmcnt(3)
v_smfmac_f32_16x16x64_bf16 v[112:115],v[32:35],v[104:111],v3
ds_read_b64_tr_b16 v[54:55],v54
v_cvt_pk_bf16_f32 v121,v122,v123
buffer_store_dwordx2 v[120:121],v9,s[8:11],s58 offen sc1
s_waitcnt lgkmcnt(2)
s_add_u32 s56,s18,s75
v_smfmac_f32_16x16x64_bf16 v[112:115],v[36:39],v[40:47],v3
v_mov_b64 v[116:117],0
v_mov_b64 v[118:119],0
s_xor_b32 s65,s65,262144
v_mov_b32_dpp v124,v126 quad_perm:[2,3,2,3] row_mask:0xf bank_mask:0xf
v_mov_b32_dpp v125,v127 quad_perm:[2,3,2,3] row_mask:0xf bank_mask:0xf
s_mov_b32 vcc_lo,0xcccccccc
s_mov_b32 vcc_hi,0xcccccccc
s_nop 0
v_cvt_pk_bf16_f32 v112,v112,v113
v_cvt_pk_bf16_f32 v113,v114,v115
buffer_store_dwordx2 v[112:113],v9,s[8:11],s59 offen sc1
s_waitcnt lgkmcnt(0)
s_buffer_load_dword s19,s[8:11],s56
v_cndmask_b32 v124,v124,v52,vcc
v_cndmask_b32 v125,v125,v53,vcc
v_cndmask_b32 v126,v126,v54,vcc
v_cndmask_b32 v127,v127,v55,vcc
v_mov_b64 v[96:97],0
v_mov_b64 v[98:99],0
v_mov_b64 v[100:101],0
v_mov_b64 v[102:103],0
v_mov_b64 v[104:105],0
v_mov_b64 v[106:107],0
v_mov_b64 v[108:109],0
v_mov_b64 v[110:111],0
v_mov_b64 v[112:113],0
v_mov_b64 v[114:115],0
v_add_u32 v55,131072,v0
v_add_u32 v123,s73,v55
v_xor_b32 v120,1024,v12
v_xor_b32 v121,2048,v12
v_xor_b32 v122,3072,v12
s_cmp_lt_u32 s46,2
s_waitcnt vmcnt(2)
s_cbranch_scc1 L_crg_260
s_cmp_eq_u32 s46,2
s_waitcnt vmcnt(1)
s_cbranch_scc1 L_crg_260
s_waitcnt vmcnt(0)
L_crg_260:
buffer_load_dwordx4 v[32:35],v0,s[8:11],s66 offen offset:0 sc1
buffer_load_dwordx4 v[36:39],v0,s[8:11],s66 offen offset:1024 sc1
s_cmp_ge_u32 s51,63
s_cselect_b32 s76,0,1
s_cmp_eq_u32 s46,0
s_cselect_b32 s76,s76,0
s_waitcnt vmcnt(1)
v_mfma_f32_16x16x32_bf16 v[28:31],v[18:21],v[32:35],0
s_waitcnt vmcnt(0)
v_mfma_f32_16x16x32_bf16 v[28:31],v[18:21],v[36:39],v[28:31]
s_nop 7
v_cmp_u_f32 vcc,v28,v28
v_add_f32_dpp v52,v28,v28 row_ror:8 row_mask:0xf bank_mask:0x3
v_add_f32_dpp v53,v29,v29 row_ror:8 row_mask:0xf bank_mask:0x3
v_add_f32_dpp v52,v30,v30 row_ror:8 row_mask:0xf bank_mask:0xc
v_add_f32_dpp v53,v31,v31 row_ror:8 row_mask:0xf bank_mask:0xc
s_nop 0
v_add_f32_dpp v52,v52,v52 row_shl:4 row_mask:0xf bank_mask:0x5
v_add_f32_dpp v53,v53,v53 row_shl:4 row_mask:0xf bank_mask:0x5
s_cbranch_vccnz L_crp_255
L_cok_261:
v_cvt_pk_bf16_f32 v54,v52,v53
buffer_store_dword v54,v10,s[8:11],s64 offen sc1
s_mov_b32 s69,s66
s_xor_b32 s66,s66,262144
s_barrier
ds_read_b128 v[56:59],v55 offset:0
ds_read_b128 v[60:63],v55 offset:4096
ds_read_b128 v[64:67],v55 offset:1024
buffer_load_dwordx4 v[24:27],v13,s[8:11],s64 offen sc1
ds_read_b128 v[68:71],v55 offset:5120
ds_read_b128 v[72:75],v55 offset:2048
ds_read_b128 v[76:79],v55 offset:6144
ds_read_b128 v[80:83],v55 offset:3072
buffer_load_dwordx4 v[24:27],v13,s[8:11],s64 offen sc1
ds_read_b128 v[84:87],v55 offset:7168
ds_read_b128 v[88:91],v123 offset:8192
ds_read_b128 v[92:95],v123 offset:9216
s_branch L_chain_250
L_cpb_257:
buffer_load_dwordx4 v[40:43],v13,s[8:11],s70 offen sc1
s_sub_u32 s49,s49,1
s_cbranch_scc1 L_abort2
s_waitcnt vmcnt(0)
v_max3_u32 v123,v40,v41,v42
v_max_u32 v123,v43,v123
v_cmp_le_u32 vcc,s72,v123
s_cbranch_vccnz L_cpb_257
ds_write_b128 v12,v[40:43] offset:4096
s_branch L_cback_259
L_crp_255:
buffer_load_dwordx4 v[32:35],v0,s[8:11],s66 offen offset:0 sc1
buffer_load_dwordx4 v[36:39],v0,s[8:11],s66 offen offset:1024 sc1
s_sub_u32 s49,s49,1
s_cbranch_scc1 L_abort2
s_waitcnt vmcnt(1)
v_mfma_f32_16x16x32_bf16 v[28:31],v[18:21],v[32:35],0
s_waitcnt vmcnt(0)
v_mfma_f32_16x16x32_bf16 v[28:31],v[18:21],v[36:39],v[28:31]
s_nop 7
v_cmp_u_f32 vcc,v28,v28
v_add_f32_dpp v52,v28,v28 row_ror:8 row_mask:0xf bank_mask:0x3
v_add_f32_dpp v53,v29,v29 row_ror:8 row_mask:0xf bank_mask:0x3
v_add_f32_dpp v52,v30,v30 row_ror:8 row_mask:0xf bank_mask:0xc
v_add_f32_dpp v53,v31,v31 row_ror:8 row_mask:0xf bank_mask:0xc
s_nop 0
v_add_f32_dpp v52,v52,v52 row_shl:4 row_mask:0xf bank_mask:0x5
v_add_f32_dpp v53,v53,v53 row_shl:4 row_mask:0xf bank_mask:0x5
s_cbranch_vccz L_cok_261
s_branch L_crp_255
L_ckw_243:
s_add_u32 s59,s18,s75
L_ww_262:
s_sleep 1
buffer_load_dword v23,off,s[8:11],s59 sc1
s_sub_u32 s49,s49,1
s_cbranch_scc1 L_abort2
s_waitcnt vmcnt(0)
v_readfirstlane_b32 s76,v23
s_cmp_eq_u32 s76,0
s_cbranch_scc1 L_ww_262
L_wwd_263:
s_branch L_ckb_244
L_cend_253:
v_smfmac_f32_16x16x64_bf16 v[116:119],v[36:39],v[184:191],v2
v_smfmac_f32_16x16x64_bf16 v[112:115],v[40:43],v[192:199],v2
v_smfmac_f32_16x16x64_bf16 v[116:119],v[40:43],v[200:207],v2
v_smfmac_f32_16x16x64_bf16 v[112:115],v[44:47],v[208:215],v2
v_smfmac_f32_16x16x64_bf16 v[116:119],v[44:47],v[216:223],v2
v_smfmac_f32_16x16x64_bf16 v[112:115],v[48:51],v[224:231],v2
v_smfmac_f32_16x16x64_bf16 v[116:119],v[48:51],v[232:239],v2
v_smfmac_f32_16x16x64_bf16 v[112:115],v[52:55],v[240:247],v2
v_smfmac_f32_16x16x64_bf16 v[116:119],v[52:55],v[248:255],v2
s_waitcnt lgkmcnt(0)
s_nop 2
v_pk_add_f32 v[112:113],v[112:113],v[114:115]
s_nop 2
v_pk_add_f32 v[116:117],v[116:117],v[118:119]
v_cvt_pk_bf16_f32 v126,v112,v113
v_cvt_pk_bf16_f32 v127,v116,v117
v_add_u32 v52,s50,v5
v_add_u32 v54,s50,v6
ds_read_b64_tr_b16 v[52:53],v52
ds_read_b64_tr_b16 v[54:55],v54
v_mov_b32_dpp v124,v126 quad_perm:[2,3,2,3] row_mask:0xf bank_mask:0xf
v_mov_b32_dpp v125,v127 quad_perm:[2,3,2,3] row_mask:0xf bank_mask:0xf
s_mov_b32 vcc_lo,0xcccccccc
s_mov_b32 vcc_hi,0xcccccccc
s_waitcnt lgkmcnt(0)
v_cndmask_b32 v124,v124,v52,vcc
v_cndmask_b32 v125,v125,v53,vcc
v_cndmask_b32 v126,v126,v54,vcc
v_cndmask_b32 v127,v127,v55,vcc
buffer_store_dwordx4 v[124:127],v0,s[8:11],s54 offen sc1
s_mov_b32 s51,64
s_waitcnt vmcnt(0)
s_barrier
s_nop 11
v_lshrrev_b32 v1,4,v0
s_endpgm
L_rc2_213:
v_and_b32 v120,15,v1
v_lshrrev_b32 v121,4,v1
v_and_b32 v122,2,v1
v_cmp_eq_u32 vcc,0,v122
v_mov_b32 v2,0xeeee
v_mov_b32 v123,0x4444
v_cndmask_b32 v2,v2,v123,vcc
v_and_b32 v122,1,v1
v_cmp_eq_u32 vcc,0,v122
v_mov_b32 v3,0xdddd
v_mov_b32 v123,0x8888
v_cndmask_b32 v3,v3,v123,vcc
v_lshrrev_b32 v122,1,v120
v_bfe_u32 v123,v120,2,1
v_xor_b32 v123,v123,v122
v_lshlrev_b32 v4,7,v123
v_and_b32 v123,1,v120
v_lshl_add_u32 v4,v123,6,v4
v_xor_b32 v123,v121,v122
v_and_b32 v123,3,v123
v_lshl_add_u32 v4,v123,4,v4
s_lshl_b32 s56,s46,10
s_add_u32 s56,s56,147456
v_add_u32 v4,s56,v4
v_lshlrev_b32 v122,1,v121
v_add_u32 v122,0,v122
v_and_b32 v123,1,v121
v_xor_b32 v123,v123,v122
v_lshlrev_b32 v5,7,v123
v_bfe_u32 v123,v120,3,1
v_lshl_add_u32 v5,v123,6,v5
v_xor_b32 v123,v120,v122
v_and_b32 v123,3,v123
v_lshl_add_u32 v5,v123,4,v5
v_bfe_u32 v123,v120,2,1
v_lshl_add_u32 v5,v123,3,v5
v_add_u32 v5,147456,v5
v_lshlrev_b32 v122,1,v121
v_add_u32 v122,1,v122
v_and_b32 v123,1,v121
v_xor_b32 v123,v123,v122
v_lshlrev_b32 v6,7,v123
v_bfe_u32 v123,v120,3,1
v_lshl_add_u32 v6,v123,6,v6
v_xor_b32 v123,v120,v122
v_and_b32 v123,3,v123
v_lshl_add_u32 v6,v123,4,v6
v_bfe_u32 v123,v120,2,1
v_lshl_add_u32 v6,v123,3,v6
v_add_u32 v6,147456,v6
v_lshlrev_b32 v7,7,v121
v_lshrrev_b32 v122,1,v120
v_lshl_add_u32 v8,v122,4,v7
v_add_u32 v8,151552,v8
v_lshrrev_b32 v122,2,v120
v_lshl_add_u32 v7,v122,5,v7
v_and_b32 v122,1,v120
v_lshl_add_u32 v7,v122,4,v7
v_and_b32 v122,2,v120
v_cmp_eq_u32 vcc,0,v122
s_lshl_b32 s56,s46,9
v_mov_b32 v122,2048
v_mov_b32 v123,s56
v_cndmask_b32 v122,v122,v123,vcc
v_add_u32 v7,v122,v7
v_add_u32 v7,151552,v7
v_lshrrev_b32 v122,3,v1
v_lshlrev_b32 v9,11,v122
v_and_b32 v122,7,v1
v_lshl_add_u32 v9,v122,3,v9
s_lshl_b32 s56,s46,14
s_lshl_b32 s57,s47,6
s_add_u32 s56,s56,s57
v_add_u32 v9,s56,v9
s_lshl_b32 s71,s46,5
s_add_u32 s71,s71,s47
s_bfe_u32 s56,s71,0x10003
s_lshl_b32 s56,s56,11
s_and_b32 s57,s71,1
s_lshl_b32 s57,s57,10
s_add_u32 s56,s56,s57
s_bfe_u32 s57,s71,0x10002
s_lshl_b32 s57,s57,9
s_add_u32 s56,s56,s57
s_bfe_u32 s57,s71,0x10001
s_lshl_b32 s57,s57,6
s_add_u32 s56,s56,s57
s_bfe_u32 s57,s71,0x10004
s_lshl_b32 s57,s57,8
s_add_u32 s56,s56,s57
s_bfe_u32 s57,s71,0x10005
s_lshl_b32 s57,s57,7
s_add_u32 s56,s56,s57
s_bfe_u32 s57,s71,0x10006
s_lshl_b32 s57,s57,12
s_add_u32 s56,s56,s57
v_and_b32 v122,3,v120
v_lshlrev_b32 v10,2,v122
v_bfe_u32 v122,v120,3,1
v_lshl_add_u32 v10,v122,4,v10
v_and_b32 v122,1,v121
v_lshl_add_u32 v10,v122,5,v10
v_add_u32 v10,s56,v10
v_and_b32 v123,36,v1
v_mov_b32 v122,0x80000000
v_cmp_eq_u32 vcc,0,v123
s_nop 1
v_cndmask_b32 v10,v122,v10,vcc
s_lshl_b32 s56,s46,15
v_add_u32 v11,s56,v0
s_lshl_b32 s71,s71,11
s_lshl_b32 s73,s46,11
s_mov_b32 s72,0xffc00000
s_mov_b32 s74,0
v_lshrrev_b32 v13,3,v1
v_lshlrev_b32 v13,9,v13
v_and_b32 v122,7,v1
v_lshl_add_u32 v13,v122,4,v13
v_and_b32 v122,15,v1
v_and_b32 v123,1,v1
v_lshlrev_b32 v123,4,v123
v_mov_b32 v124,0x3f80
v_lshlrev_b32 v124,v123,v124
v_lshrrev_b32 v122,1,v122
v_cmp_eq_u32 vcc,0,v122
s_nop 1
v_cndmask_b32 v18,0,v124,vcc
v_cmp_eq_u32 vcc,1,v122
s_nop 1
v_cndmask_b32 v19,0,v124,vcc
v_cmp_eq_u32 vcc,2,v122
s_nop 1
v_cndmask_b32 v20,0,v124,vcc
v_cmp_eq_u32 vcc,3,v122
s_nop 1
v_cndmask_b32 v21,0,v124,vcc
s_and_b32 s56,s46,1
s_lshl_b32 s56,s56,8
s_and_b32 s57,s46,2
s_lshl_b32 s57,s57,6
s_add_u32 s56,s56,s57
v_add_u32 v13,s56,v13
s_add_u32 s56,s50,155648
v_add_u32 v12,s56,v0
v_mov_b64 v[14:15],s[28:29]
v_mov_b64 v[16:17],s[28:29]
v_add_u32 v22,13647872,v10
s_lshl_b32 s18,s47,2
s_add_u32 s18,s18,10494080
v_mov_b32 v1,s80
s_mov_b32 s65,16777216
s_add_u32 s66,s71,16777216
s_add_u32 s69,s71,17039360
s_mov_b32 s30,0x40000000
s_mov_b32 s51,0
v_lshrrev_b32 v120,2,v0
v_add_u32 v120,10510464,v120
v_or_b32 v120,s52,v120
s_mov_b64 vcc,-1
s_mov_b32 vcc_lo,0
v_cndmask_b32 v22,v22,v120,vcc
s_or_b32 s56,s52,10495616
v_writelane_b32 v22,s56,4
s_or_b32 s56,s47,s46
s_mov_b32 s56,10486784
s_cmov_b32 s56,0x80000000
v_writelane_b32 v22,s56,5
s_mov_b32 s30,0
s_mov_b32 s31,0
L_cst_267:
s_cmp_lg_u32 s46,0
s_cbranch_scc1 L_csw_272
s_lshl_b32 s59,s31,13
s_add_u32 s59,s59,10486016
v_lshrrev_b32 v121,2,v0
v_and_b32 v121,127,v121
L_ckk_273:
s_sleep 1
buffer_load_dword v120,v121,s[8:11],s59 offen sc1
s_sub_u32 s49,s49,1
s_cbranch_scc1 L_abort2
s_waitcnt vmcnt(0)
v_cmp_eq_u32 vcc,0,v120
s_cbranch_vccnz L_ckk_273
v_max_u32_dpp v120,v120,v120 row_ror:8 row_mask:0xf bank_mask:0xf
s_nop 1
v_max_u32_dpp v120,v120,v120 row_ror:4 row_mask:0xf bank_mask:0xf
s_nop 1
v_max_u32_dpp v120,v120,v120 row_ror:2 row_mask:0xf bank_mask:0xf
s_nop 1
v_max_u32_dpp v120,v120,v120 row_ror:1 row_mask:0xf bank_mask:0xf
v_mov_b32 v121,v120
s_nop 1
v_permlane16_swap_b32 v120,v121
v_max_u32 v120,v120,v121
v_mov_b32 v121,v120
s_nop 1
v_permlane32_swap_b32 v120,v121
v_max_u32 v120,v120,v121
s_nop 0
v_readfirstlane_b32 s61,v120
s_max_u32 s30,s30,s61
s_add_u32 s31,s31,1
s_andn2_b32 s51,0x7ff,s30
s_lshr_b32 s51,s51,5
s_add_u32 s61,s51,2
s_min_u32 s61,s61,63
s_cmp_le_u32 s31,s61
s_cbranch_scc1 L_cst_267
v_mov_b32 v120,0
v_mov_b32 v121,s30
ds_write_b32 v8,v120 offset:2560
ds_write_b32 v8,v121 offset:3072
s_lshl_b32 s59,s51,13
s_lshl2_add_u32 s59,s47,s59
s_add_u32 s59,s59,10485888
L_ww_274:
s_sleep 1
buffer_load_dword v122,off,s[8:11],s59 sc1
s_sub_u32 s49,s49,1
s_cbranch_scc1 L_abort2
s_waitcnt vmcnt(0)
v_readfirstlane_b32 s61,v122
s_cmp_eq_u32 s61,0
s_cbranch_scc1 L_ww_274
L_wwd_275:
L_csw_272:
s_waitcnt lgkmcnt(0)
s_barrier
ds_read_b32 v120,v8 offset:3072
s_waitcnt lgkmcnt(0)
v_readfirstlane_b32 s30,v120
s_andn2_b32 s51,0x7ff,s30
s_lshr_b32 s51,s51,5
s_lshl_b32 s56,s51,5
s_add_u32 s56,s56,s47
s_mul_i32 s56,s56,24576
s_add_u32 s56,s56,150994944
s_add_u32 s67,s56,s73
s_add_u32 m0,s73,131072
s_add_u32 s57,s67,8192
buffer_load_dwordx4 v0,s[8:11],s67 offen sc1 lds
buffer_load_dwordx4 v0,s[8:11],s67 offen offset:1024 sc1 lds
s_add_u32 m0,s73,139264
s_add_u32 s67,s67,786432
buffer_load_dwordx4 v0,s[8:11],s57 offen sc1 lds
buffer_load_dwordx4 v0,s[8:11],s57 offen offset:1024 sc1 lds
s_lshl_b32 s75,s51,13
s_add_u32 s56,s75,13639680
buffer_load_dword v23,v10,s[8:11],s56 offen sc1
s_add_u32 s64,s75,17825792
s_add_u32 s70,s64,4096
s_lshl_b32 s68,s51,5
s_add_u32 s68,s68,s47
s_lshl_b32 s68,s68,12
s_lshl_b32 s56,s46,10
s_add_u32 s68,s68,s56
s_add_u32 s68,s68,75497472
s_mov_b32 s54,0x80000000
s_mov_b32 s77,0
s_mov_b32 s19,0
s_cmp_eq_u32 s51,63
s_cselect_b32 s76,1,s46
s_cmp_eq_u32 s76,0
s_cselect_b32 s76,1,0
v_mov_b64 v[96:97],0
v_mov_b64 v[98:99],0
v_mov_b64 v[100:101],0
v_mov_b64 v[102:103],0
v_mov_b64 v[104:105],0
v_mov_b64 v[106:107],0
v_mov_b64 v[108:109],0
v_mov_b64 v[110:111],0
v_mov_b64 v[112:113],0
v_mov_b64 v[114:115],0
v_mov_b64 v[116:117],0
v_mov_b64 v[118:119],0
v_lshrrev_b32 v56,8,v0
v_lshlrev_b32 v56,5,v56
v_bfe_u32 v57,v0,5,1
v_lshl_add_u32 v56,v57,2,v56
s_lshl_b32 s56,s46,7
s_add_u32 s56,s56,155648
v_add_u32 v56,s56,v56
v_xor_b32 v57,128,v56
v_xor_b32 v58,256,v56
v_xor_b32 v59,384,v56
s_andn2_b32 s56,31,s30
s_lshr_b32 s57,s56,4
s_lshl_b32 s58,s57,12
s_and_b32 s59,s56,15
s_lshl4_add_u32 s58,s59,s58
s_add_u32 s58,s58,s50
s_add_u32 s58,s58,131072
v_bfe_u32 v60,v0,6,2
v_lshlrev_b32 v60,8,v60
v_bfe_u32 v61,v0,4,2
v_lshl_add_u32 v60,v61,2,v60
v_add_u32 v60,s58,v60
s_lshr_b32 s58,s59,2
s_lshl_b32 s58,s58,8
s_lshl3_add_u32 s58,s57,s58
s_and_b32 s59,s56,3
s_lshl1_add_u32 s58,s59,s58
s_add_u32 s58,s58,s73
s_add_u32 s58,s58,139264
v_and_b32 v61,255,v0
v_add_u32 v61,s58,v61
s_cmp_lg_u32 s46,0
s_cbranch_scc1 L_chd_277
s_lshl_b32 s59,s51,10
s_add_u32 s59,s59,11337728
L_chp_276:
buffer_load_dwordx4 v[120:123],v0,s[8:11],s59 offen sc1
s_sub_u32 s49,s49,1
s_cbranch_scc1 L_abort2
s_waitcnt vmcnt(0)
v_max3_u32 v124,v120,v121,v122
v_max_u32 v124,v123,v124
v_cmp_eq_u32 vcc,-1,v124
s_cbranch_vccnz L_chp_276
ds_write_b128 v12,v[120:123]
L_chd_277:
s_waitcnt vmcnt(0) lgkmcnt(0)
s_barrier
ds_read2_b32 v[24:25],v56 offset0:0 offset1:2
ds_read2_b32 v[26:27],v56 offset0:4 offset1:6
ds_read2_b32 v[28:29],v57 offset0:0 offset1:2
ds_read2_b32 v[30:31],v57 offset0:4 offset1:6
ds_read2_b32 v[32:33],v58 offset0:0 offset1:2
ds_read2_b32 v[34:35],v58 offset0:4 offset1:6
ds_read2_b32 v[36:37],v59 offset0:0 offset1:2
ds_read2_b32 v[38:39],v59 offset0:4 offset1:6
s_waitcnt lgkmcnt(4)
ds_read2_b32 v[40:41],v56 offset0:128 offset1:130
ds_read2_b32 v[42:43],v56 offset0:132 offset1:134
ds_read2_b32 v[44:45],v57 offset0:128 offset1:130
ds_read2_b32 v[46:47],v57 offset0:132 offset1:134
ds_read2_b32 v[48:49],v58 offset0:128 offset1:130
ds_read2_b32 v[50:51],v58 offset0:132 offset1:134
ds_read2_b32 v[52:53],v59 offset0:128 offset1:130
ds_read2_b32 v[54:55],v59 offset0:132 offset1:134
s_waitcnt lgkmcnt(12)
v_smfmac_f32_16x16x64_bf16 v[100:103],v[24:27],a[128:135],v2
v_smfmac_f32_16x16x64_bf16 v[112:115],v[24:27],v[128:135],v2
v_smfmac_f32_16x16x64_bf16 v[108:111],v[24:27],a[136:143],v2
v_smfmac_f32_16x16x64_bf16 v[116:119],v[24:27],v[136:143],v2
s_waitcnt lgkmcnt(12)
v_smfmac_f32_16x16x64_bf16 v[100:103],v[28:31],a[144:151],v2
v_smfmac_f32_16x16x64_bf16 v[112:115],v[28:31],v[144:151],v2
v_smfmac_f32_16x16x64_bf16 v[108:111],v[28:31],a[152:159],v2
v_smfmac_f32_16x16x64_bf16 v[116:119],v[28:31],v[152:159],v2
s_waitcnt lgkmcnt(10)
v_smfmac_f32_16x16x64_bf16 v[100:103],v[32:35],a[160:167],v2
v_smfmac_f32_16x16x64_bf16 v[112:115],v[32:35],v[160:167],v2
v_smfmac_f32_16x16x64_bf16 v[108:111],v[32:35],a[168:175],v2
v_smfmac_f32_16x16x64_bf16 v[116:119],v[32:35],v[168:175],v2
s_waitcnt lgkmcnt(8)
v_smfmac_f32_16x16x64_bf16 v[100:103],v[36:39],a[176:183],v2
v_smfmac_f32_16x16x64_bf16 v[112:115],v[36:39],v[176:183],v2
v_smfmac_f32_16x16x64_bf16 v[108:111],v[36:39],a[184:191],v2
v_smfmac_f32_16x16x64_bf16 v[116:119],v[36:39],v[184:191],v2
s_waitcnt lgkmcnt(6)
v_smfmac_f32_16x16x64_bf16 v[100:103],v[40:43],a[192:199],v2
v_smfmac_f32_16x16x64_bf16 v[112:115],v[40:43],v[192:199],v2
v_smfmac_f32_16x16x64_bf16 v[108:111],v[40:43],a[200:207],v2
v_smfmac_f32_16x16x64_bf16 v[116:119],v[40:43],v[200:207],v2
s_waitcnt lgkmcnt(4)
v_smfmac_f32_16x16x64_bf16 v[100:103],v[44:47],a[208:215],v2
v_smfmac_f32_16x16x64_bf16 v[112:115],v[44:47],v[208:215],v2
v_smfmac_f32_16x16x64_bf16 v[108:111],v[44:47],a[216:223],v2
v_smfmac_f32_16x16x64_bf16 v[116:119],v[44:47],v[216:223],v2
s_waitcnt lgkmcnt(2)
v_smfmac_f32_16x16x64_bf16 v[100:103],v[48:51],a[224:231],v2
v_smfmac_f32_16x16x64_bf16 v[112:115],v[48:51],v[224:231],v2
v_smfmac_f32_16x16x64_bf16 v[108:111],v[48:51],a[232:239],v2
v_smfmac_f32_16x16x64_bf16 v[116:119],v[48:51],v[232:239],v2
s_waitcnt lgkmcnt(0)
v_smfmac_f32_16x16x64_bf16 v[100:103],v[52:55],a[240:247],v2
v_smfmac_f32_16x16x64_bf16 v[112:115],v[52:55],v[240:247],v2
v_smfmac_f32_16x16x64_bf16 v[108:111],v[52:55],a[248:255],v2
v_smfmac_f32_16x16x64_bf16 v[116:119],v[52:55],v[248:255],v2
v_add_f32 v100,v100,v102
v_add_f32 v112,v112,v114
s_nop 1
v_add_f32 v108,v108,v110
s_nop 2
v_add_f32 v116,v116,v118
v_cvt_pk_bf16_f32 v120,v100,v108
v_cvt_pk_bf16_f32 v121,v112,v116
ds_write_b32 v60,v120
ds_write_b16 v61,v121
ds_write_b16_d16_hi v61,v121 offset:1024
v_mov_b64 v[96:97],0
v_mov_b64 v[98:99],0
v_mov_b64 v[100:101],0
v_mov_b64 v[102:103],0
v_mov_b64 v[104:105],0
v_mov_b64 v[106:107],0
v_mov_b64 v[108:109],0
v_mov_b64 v[110:111],0
v_mov_b64 v[112:113],0
v_mov_b64 v[114:115],0
v_mov_b64 v[116:117],0
v_mov_b64 v[118:119],0
s_waitcnt vmcnt(0) lgkmcnt(0)
s_barrier
v_add_u32 v55,131072,v0
ds_read_b128 v[56:59],v55 offset:0
ds_read_b128 v[60:63],v55 offset:4096
ds_read_b128 v[64:67],v55 offset:1024
ds_read_b128 v[68:71],v55 offset:5120
ds_read_b128 v[72:75],v55 offset:2048
ds_read_b128 v[76:79],v55 offset:6144
ds_read_b128 v[80:83],v55 offset:3072
ds_read_b128 v[84:87],v55 offset:7168
v_add_u32 v123,s73,v55
ds_read_b128 v[88:91],v123 offset:8192
ds_read_b128 v[92:95],v123 offset:9216
v_xor_b32 v120,1024,v12
v_xor_b32 v121,2048,v12
v_xor_b32 v122,3072,v12
buffer_load_dwordx4 v[24:27],v13,s[8:11],s64 offen sc1
buffer_load_dwordx4 v[24:27],v13,s[8:11],s64 offen sc1
L_chain_278:
L_cpa_279:
buffer_load_dwordx4 v[24:27],v13,s[8:11],s64 offen sc1
s_sub_u32 s49,s49,1
s_cbranch_scc1 L_abort2
s_waitcnt vmcnt(2)
v_max3_u32 v123,v24,v25,v26
v_max_u32 v123,v27,v123
v_cmp_le_u32 vcc,s72,v123
s_cbranch_vccnz L_cpa_279
L_cgo_282:
ds_write_b128 v12,v[24:27] offset:0
v_smfmac_f32_16x16x64_bf16 v[96:99],v[24:27],a[0:7],v2
buffer_load_dwordx4 v[40:43],v13,s[8:11],s70 offen sc1
v_smfmac_f32_16x16x64_bf16 v[100:103],v[24:27],a[128:135],v2
v_smfmac_f32_16x16x64_bf16 v[104:107],v[24:27],a[8:15],v2
v_smfmac_f32_16x16x64_bf16 v[108:111],v[24:27],a[136:143],v2
s_waitcnt lgkmcnt(0)
s_barrier
ds_read_b128 v[28:31],v120 offset:0
v_smfmac_f32_16x16x64_bf16 v[112:115],v[24:27],v[128:135],v2
ds_read_b128 v[32:35],v121 offset:0
v_smfmac_f32_16x16x64_bf16 v[116:119],v[24:27],v[136:143],v2
ds_read_b128 v[36:39],v122 offset:0
s_waitcnt lgkmcnt(2)
v_smfmac_f32_16x16x64_bf16 v[96:99],v[28:31],a[16:23],v2
s_add_u32 m0,s73,131072
v_smfmac_f32_16x16x64_bf16 v[100:103],v[28:31],a[144:151],v2
s_add_u32 s57,s67,8192
v_smfmac_f32_16x16x64_bf16 v[104:107],v[28:31],a[24:31],v2
s_cmp_lt_u32 s19,s76
s_cbranch_scc1 L_ckw_268
L_ckb_269:
v_smfmac_f32_16x16x64_bf16 v[108:111],v[28:31],a[152:159],v2
s_waitcnt vmcnt(0) lgkmcnt(1)
v_smfmac_f32_16x16x64_bf16 v[96:99],v[32:35],a[32:39],v2
ds_write_b128 v12,v[40:43] offset:4096
v_max3_u32 v123,v40,v41,v42
v_smfmac_f32_16x16x64_bf16 v[100:103],v[32:35],a[160:167],v2
v_max_u32 v123,v43,v123
v_smfmac_f32_16x16x64_bf16 v[104:107],v[32:35],a[40:47],v2
v_cmp_le_u32 vcc,s72,v123
v_smfmac_f32_16x16x64_bf16 v[108:111],v[32:35],a[168:175],v2
v_smfmac_f32_16x16x64_bf16 v[112:115],v[28:31],v[144:151],v2
s_cbranch_vccnz L_cpb_285
L_cback_287:
s_waitcnt lgkmcnt(0)
s_barrier
ds_read_b32 v123,v8 offset:2560
v_smfmac_f32_16x16x64_bf16 v[96:99],v[36:39],a[48:55],v2
buffer_store_dwordx4 v[124:127],v0,s[8:11],s54 offen sc1
v_smfmac_f32_16x16x64_bf16 v[100:103],v[36:39],a[176:183],v2
ds_read_b128 v[44:47],v120 offset:4096
v_smfmac_f32_16x16x64_bf16 v[104:107],v[36:39],a[56:63],v2
buffer_load_dwordx4 v0,s[8:11],s67 offen sc1 lds
v_smfmac_f32_16x16x64_bf16 v[108:111],v[36:39],a[184:191],v2
ds_read_b128 v[48:51],v121 offset:4096
v_smfmac_f32_16x16x64_bf16 v[96:99],v[40:43],a[64:71],v2
buffer_load_dwordx4 v0,s[8:11],s67 offen offset:1024 sc1 lds
s_add_u32 m0,s73,139264
v_smfmac_f32_16x16x64_bf16 v[100:103],v[40:43],a[192:199],v2
ds_read_b128 v[52:55],v122 offset:4096
v_smfmac_f32_16x16x64_bf16 v[104:107],v[40:43],a[72:79],v2
buffer_load_dwordx4 v0,s[8:11],s57 offen sc1 lds
s_add_u32 s67,s67,786432
v_smfmac_f32_16x16x64_bf16 v[108:111],v[40:43],a[200:207],v2
s_waitcnt lgkmcnt(2)
v_smfmac_f32_16x16x64_bf16 v[96:99],v[44:47],a[80:87],v2
buffer_load_dwordx4 v0,s[8:11],s57 offen offset:1024 sc1 lds
v_smfmac_f32_16x16x64_bf16 v[100:103],v[44:47],a[208:215],v2
v_readfirstlane_b32 s58,v123
s_waitcnt lgkmcnt(1)
v_smfmac_f32_16x16x64_bf16 v[96:99],v[48:51],a[96:103],v2
buffer_load_dword v23,v22,s[8:11],s75 offen sc1
v_smfmac_f32_16x16x64_bf16 v[100:103],v[48:51],a[224:231],v2
s_cmp_lg_u32 s58,0
s_cbranch_scc1 L_cjump_271
s_waitcnt lgkmcnt(0)
v_smfmac_f32_16x16x64_bf16 v[96:99],v[52:55],a[112:119],v2
v_smfmac_f32_16x16x64_bf16 v[100:103],v[52:55],a[240:247],v2
v_smfmac_f32_16x16x64_bf16 v[104:107],v[44:47],a[88:95],v2
v_smfmac_f32_16x16x64_bf16 v[108:111],v[44:47],a[216:223],v2
v_smfmac_f32_16x16x64_bf16 v[104:107],v[48:51],a[104:111],v2
v_add_f32 v96,v96,v98
v_smfmac_f32_16x16x64_bf16 v[108:111],v[48:51],a[232:239],v2
v_add_f32 v97,v97,v99
v_smfmac_f32_16x16x64_bf16 v[104:107],v[52:55],a[120:127],v2
v_cvt_pk_bf16_f32 v120,v96,v97
v_smfmac_f32_16x16x64_bf16 v[108:111],v[52:55],a[248:255],v2
v_add_f32 v100,v100,v102
v_smfmac_f32_16x16x64_bf16 v[116:119],v[28:31],v[152:159],v2
v_add_f32 v101,v101,v103
v_smfmac_f32_16x16x64_bf16 v[112:115],v[32:35],v[160:167],v2
v_cvt_pk_bf16_f32 v121,v100,v101
v_add_f32 v104,v104,v106
v_add_f32 v105,v105,v107
v_cvt_pk_bf16_f32 v122,v104,v105
v_add_f32 v108,v108,v110
v_add_f32 v109,v109,v111
v_cvt_pk_bf16_f32 v123,v108,v109
ds_write_b128 v4,v[120:123]
v_smfmac_f32_16x16x64_bf16 v[116:119],v[32:35],v[168:175],v2
s_mov_b32 s54,s68
s_add_u32 s68,s68,131072
v_mov_b32 v125,0
v_smfmac_f32_16x16x64_bf16 v[112:115],v[36:39],v[176:183],v2
s_cmp_eq_u32 s51,63
s_cbranch_scc1 L_cend_281
v_smfmac_f32_16x16x64_bf16 v[116:119],v[36:39],v[184:191],v2
v_smfmac_f32_16x16x64_bf16 v[112:115],v[40:43],v[192:199],v2
s_waitcnt lgkmcnt(0)
s_barrier
ds_read_b64_tr_b16 v[96:97],v5 offset:0
ds_read_b64_tr_b16 v[98:99],v6 offset:0
v_smfmac_f32_16x16x64_bf16 v[116:119],v[40:43],v[200:207],v2
ds_read_b64_tr_b16 v[100:101],v5 offset:1024
v_smfmac_f32_16x16x64_bf16 v[112:115],v[44:47],v[208:215],v2
ds_read_b64_tr_b16 v[102:103],v6 offset:1024
v_smfmac_f32_16x16x64_bf16 v[116:119],v[44:47],v[216:223],v2
ds_read_b64_tr_b16 v[104:105],v5 offset:2048
v_smfmac_f32_16x16x64_bf16 v[112:115],v[48:51],v[224:231],v2
ds_read_b64_tr_b16 v[106:107],v6 offset:2048
s_waitcnt lgkmcnt(4)
v_mfma_f32_16x16x32_bf16 v[24:27],v[56:59],v[96:99],0
ds_read_b64_tr_b16 v[108:109],v5 offset:3072
v_mfma_f32_16x16x32_bf16 v[28:31],v[60:63],v[96:99],0
ds_read_b64_tr_b16 v[110:111],v6 offset:3072
v_mfma_f32_16x16x32_bf16 v[32:35],v[96:99],v[96:99],0
ds_read_b128 v[40:43],v11 offset:12288
s_waitcnt lgkmcnt(5)
v_mfma_f32_16x16x32_bf16 v[24:27],v[64:67],v[100:103],v[24:27]
ds_read_b128 v[56:59],v11 offset:0
v_mfma_f32_16x16x32_bf16 v[28:31],v[68:71],v[100:103],v[28:31]
ds_read_b128 v[60:63],v11 offset:1024
v_mfma_f32_16x16x32_bf16 v[32:35],v[100:103],v[100:103],v[32:35]
ds_read_b128 v[96:99],v11 offset:8192
s_waitcnt lgkmcnt(6)
v_mfma_f32_16x16x32_bf16 v[24:27],v[72:75],v[104:107],v[24:27]
ds_read_b128 v[64:67],v11 offset:2048
v_mfma_f32_16x16x32_bf16 v[28:31],v[76:79],v[104:107],v[28:31]
ds_read_b128 v[68:71],v11 offset:3072
v_mfma_f32_16x16x32_bf16 v[32:35],v[104:107],v[104:107],v[32:35]
ds_read_b128 v[100:103],v11 offset:9216
s_waitcnt lgkmcnt(7)
v_mfma_f32_16x16x32_bf16 v[24:27],v[80:83],v[108:111],v[24:27]
ds_read_b128 v[72:75],v11 offset:4096
v_mfma_f32_16x16x32_bf16 v[28:31],v[84:87],v[108:111],v[28:31]
ds_read_b128 v[76:79],v11 offset:5120
v_mfma_f32_16x16x32_bf16 v[32:35],v[108:111],v[108:111],v[32:35]
ds_read_b128 v[104:107],v11 offset:10240
v_smfmac_f32_16x16x64_bf16 v[116:119],v[48:51],v[232:239],v2
ds_read_b128 v[80:83],v11 offset:6144
v_smfmac_f32_16x16x64_bf16 v[112:115],v[52:55],v[240:247],v2
ds_read_b128 v[84:87],v11 offset:7168
v_smfmac_f32_16x16x64_bf16 v[116:119],v[52:55],v[248:255],v2
ds_read_b128 v[108:111],v11 offset:11264
v_max3_f32 v126,v24,v25,v26
v_max3_f32 v127,v27,v28,v29
v_max3_f32 v126,v30,v31,v126
v_max3_f32 v127,v34,v35,v127
v_max_f32 v126,v126,v127
v_max_f32 v127,v126,v127
v_pk_mul_f32 v[34:35],v[34:35],v[0:1] op_sel:[0,1]
v_pk_mul_f32 v[24:25],v[24:25],v[0:1] op_sel:[0,1]
v_permlane16_swap_b32 v126,v127
v_max_f32 v126,v126,v127
v_max_f32 v127,v126,v127
v_pk_mul_f32 v[26:27],v[26:27],v[0:1] op_sel:[0,1]
v_pk_mul_f32 v[28:29],v[28:29],v[0:1] op_sel:[0,1]
v_permlane32_swap_b32 v126,v127
v_max_f32 v126,v126,v127
v_mul_f32 v126,v1,v126
v_pk_mul_f32 v[30:31],v[30:31],v[0:1] op_sel:[0,1]
v_pk_add_f32 v[34:35],v[34:35],v[126:127] op_sel_hi:[1,0] neg_lo:[0,1] neg_hi:[0,1]
v_pk_add_f32 v[112:113],v[112:113],v[114:115]
v_pk_add_f32 v[116:117],v[116:117],v[118:119]
v_pk_add_f32 v[24:25],v[24:25],v[126:127] op_sel_hi:[1,0] neg_lo:[0,1] neg_hi:[0,1]
v_pk_add_f32 v[26:27],v[26:27],v[126:127] op_sel_hi:[1,0] neg_lo:[0,1] neg_hi:[0,1]
v_pk_add_f32 v[28:29],v[28:29],v[126:127] op_sel_hi:[1,0] neg_lo:[0,1] neg_hi:[0,1]
v_pk_add_f32 v[30:31],v[30:31],v[126:127] op_sel_hi:[1,0] neg_lo:[0,1] neg_hi:[0,1]
v_exp_f32 v34,v34
v_exp_f32 v35,v35
v_cvt_pk_bf16_f32 v126,v112,v113
v_cvt_pk_bf16_f32 v124,v34,v35
v_cvt_pk_bf16_f32 v127,v116,v117
v_cvt_pk_bf16_f32 v36,v116,v117
v_mfma_f32_16x16x16_bf16 v[32:35],v[14:15],v[124:125],0
ds_read_b128 v[44:47],v11 offset:13312
v_exp_f32 v24,v24
v_mfma_f32_16x16x16_bf16 v[112:115],v[126:127],v[124:125],0
ds_read_b128 v[48:51],v11 offset:14336
v_exp_f32 v25,v25
v_mfma_f32_16x16x16_bf16 v[116:119],v[36:37],v[124:125],0
ds_read_b128 v[52:55],v11 offset:15360
v_exp_f32 v26,v26
v_exp_f32 v27,v27
v_cvt_pk_bf16_f32 v120,v24,v25
v_exp_f32 v28,v28
v_exp_f32 v29,v29
v_cvt_pk_bf16_f32 v121,v26,v27
v_exp_f32 v30,v30
v_exp_f32 v31,v31
v_cvt_pk_bf16_f32 v122,v28,v29
v_cvt_pk_bf16_f32 v123,v30,v31
s_add_u32 s75,s75,8192
s_add_u32 s51,s51,1
v_mfma_f32_16x16x32_bf16 v[32:35],v[14:17],v[120:123],v[32:35]
v_mfma_f32_16x16x32_bf16 v[112:115],v[88:91],v[120:123],v[112:115]
ds_read_b128 v[88:91],v11 offset:16384
v_mfma_f32_16x16x32_bf16 v[116:119],v[92:95],v[120:123],v[116:119]
ds_read_b128 v[92:95],v11 offset:17408
v_rcp_f32 v32,v32
v_mov_b64 v[24:25],-1
v_mov_b64 v[26:27],-1
s_add_u32 s64,s75,13631488
s_add_u32 s70,s64,4096
v_pk_mul_f32 v[112:113],v[112:113],v[32:33] op_sel_hi:[1,0]
v_pk_mul_f32 v[114:115],v[114:115],v[32:33] op_sel_hi:[1,0]
v_pk_mul_f32 v[116:117],v[116:117],v[32:33] op_sel_hi:[1,0]
v_pk_mul_f32 v[118:119],v[118:119],v[32:33] op_sel_hi:[1,0]
v_cvt_pk_bf16_f32 v120,v112,v116
v_cvt_pk_bf16_f32 v121,v113,v117
v_cvt_pk_bf16_f32 v122,v114,v118
v_cvt_pk_bf16_f32 v123,v115,v119
ds_write_b128 v7,v[120:123]
buffer_store_dwordx4 v[24:27],v0,s[8:11],s69 offen sc1
buffer_store_dwordx4 v[24:27],v0,s[8:11],s69 offen offset:1024 sc1
v_mov_b64 v[112:113],0
v_mov_b64 v[114:115],0
v_mov_b64 v[116:117],0
v_mov_b64 v[118:119],0
s_waitcnt lgkmcnt(0)
s_barrier
ds_read_b128 v[24:27],v8 offset:0
ds_read_b128 v[28:31],v8 offset:512
ds_read_b128 v[32:35],v8 offset:1024
ds_read_b128 v[36:39],v8 offset:1536
v_mov_b64 v[120:121],0
v_mov_b64 v[122:123],0
s_waitcnt lgkmcnt(3)
v_smfmac_f32_16x16x64_bf16 v[112:115],v[24:27],v[56:63],v3
ds_read_b128 v[56:59],v11 offset:18432
s_add_u32 s57,s65,65536
s_waitcnt lgkmcnt(3)
v_smfmac_f32_16x16x64_bf16 v[112:115],v[28:31],v[64:71],v3
ds_read_b128 v[60:63],v11 offset:19456
s_add_u32 s58,s65,131072
s_waitcnt lgkmcnt(3)
v_smfmac_f32_16x16x64_bf16 v[112:115],v[32:35],v[72:79],v3
ds_read_b128 v[64:67],v11 offset:20480
s_add_u32 s59,s65,196608
s_waitcnt lgkmcnt(3)
v_smfmac_f32_16x16x64_bf16 v[112:115],v[36:39],v[80:87],v3
ds_read_b128 v[68:71],v11 offset:21504
v_smfmac_f32_16x16x64_bf16 v[116:119],v[24:27],v[96:103],v3
ds_read_b128 v[72:75],v11 offset:22528
v_smfmac_f32_16x16x64_bf16 v[116:119],v[28:31],v[104:111],v3
ds_read_b128 v[76:79],v11 offset:23552
v_cvt_pk_bf16_f32 v112,v112,v113
v_smfmac_f32_16x16x64_bf16 v[116:119],v[32:35],v[40:47],v3
ds_read_b128 v[80:83],v11 offset:24576
v_cvt_pk_bf16_f32 v113,v114,v115
buffer_store_dwordx2 v[112:113],v9,s[8:11],s65 offen sc1
v_smfmac_f32_16x16x64_bf16 v[116:119],v[36:39],v[48:55],v3
ds_read_b128 v[84:87],v11 offset:25600
v_mov_b64 v[112:113],0
v_smfmac_f32_16x16x64_bf16 v[120:123],v[24:27],v[88:95],v3
ds_read_b128 v[96:99],v11 offset:26624
ds_read_b128 v[100:103],v11 offset:27648
v_mov_b64 v[114:115],0
s_waitcnt lgkmcnt(8)
v_smfmac_f32_16x16x64_bf16 v[120:123],v[28:31],v[56:63],v3
ds_read_b128 v[104:107],v11 offset:28672
v_cvt_pk_bf16_f32 v116,v116,v117
s_waitcnt lgkmcnt(7)
v_smfmac_f32_16x16x64_bf16 v[120:123],v[32:35],v[64:71],v3
ds_read_b128 v[108:111],v11 offset:29696
ds_read_b128 v[40:43],v11 offset:30720
v_cvt_pk_bf16_f32 v117,v118,v119
buffer_store_dwordx2 v[116:117],v9,s[8:11],s57 offen sc1
s_waitcnt lgkmcnt(7)
v_smfmac_f32_16x16x64_bf16 v[120:123],v[36:39],v[72:79],v3
ds_read_b128 v[44:47],v11 offset:31744
v_add_u32 v52,s50,v5
s_waitcnt lgkmcnt(6)
v_smfmac_f32_16x16x64_bf16 v[112:115],v[24:27],v[80:87],v3
v_add_u32 v54,s50,v6
s_waitcnt lgkmcnt(4)
v_smfmac_f32_16x16x64_bf16 v[112:115],v[28:31],v[96:103],v3
ds_read_b64_tr_b16 v[52:53],v52
v_cvt_pk_bf16_f32 v120,v120,v121
s_waitcnt lgkmcnt(3)
v_smfmac_f32_16x16x64_bf16 v[112:115],v[32:35],v[104:111],v3
ds_read_b64_tr_b16 v[54:55],v54
v_cvt_pk_bf16_f32 v121,v122,v123
buffer_store_dwordx2 v[120:121],v9,s[8:11],s58 offen sc1
s_waitcnt lgkmcnt(2)
s_add_u32 s56,s18,s75
v_smfmac_f32_16x16x64_bf16 v[112:115],v[36:39],v[40:47],v3
v_mov_b64 v[116:117],0
v_mov_b64 v[118:119],0
s_xor_b32 s65,s65,262144
v_mov_b32_dpp v124,v126 quad_perm:[2,3,2,3] row_mask:0xf bank_mask:0xf
v_mov_b32_dpp v125,v127 quad_perm:[2,3,2,3] row_mask:0xf bank_mask:0xf
s_mov_b32 vcc_lo,0xcccccccc
s_mov_b32 vcc_hi,0xcccccccc
s_nop 0
v_cvt_pk_bf16_f32 v112,v112,v113
v_cvt_pk_bf16_f32 v113,v114,v115
buffer_store_dwordx2 v[112:113],v9,s[8:11],s59 offen sc1
s_waitcnt lgkmcnt(0)
s_buffer_load_dword s19,s[8:11],s56
v_cndmask_b32 v124,v124,v52,vcc
v_cndmask_b32 v125,v125,v53,vcc
v_cndmask_b32 v126,v126,v54,vcc
v_cndmask_b32 v127,v127,v55,vcc
v_mov_b64 v[96:97],0
v_mov_b64 v[98:99],0
v_mov_b64 v[100:101],0
v_mov_b64 v[102:103],0
v_mov_b64 v[104:105],0
v_mov_b64 v[106:107],0
v_mov_b64 v[108:109],0
v_mov_b64 v[110:111],0
v_mov_b64 v[112:113],0
v_mov_b64 v[114:115],0
v_add_u32 v55,131072,v0
v_add_u32 v123,s73,v55
v_xor_b32 v120,1024,v12
v_xor_b32 v121,2048,v12
v_xor_b32 v122,3072,v12
s_cmp_lt_u32 s46,2
s_waitcnt vmcnt(2)
s_cbranch_scc1 L_crg_288
s_cmp_eq_u32 s46,2
s_waitcnt vmcnt(1)
s_cbranch_scc1 L_crg_288
s_waitcnt vmcnt(0)
L_crg_288:
buffer_load_dwordx4 v[32:35],v0,s[8:11],s66 offen offset:0 sc1
buffer_load_dwordx4 v[36:39],v0,s[8:11],s66 offen offset:1024 sc1
s_cmp_ge_u32 s51,63
s_cselect_b32 s76,0,1
v_readlane_b32 s56,v23,5
v_readlane_b32 s20,v23,4
v_add_u32 v23,-1,v23
v_cmp_le_u32 vcc,s30,v23
s_cmp_gt_u32 s51,61
s_cselect_b32 s77,0,vcc_hi
s_cmp_gt_u32 s20,s30
s_cselect_b32 s77,1,s77
s_cmp_lg_u32 s77,0
s_cselect_b32 s76,2,s76
s_cmp_gt_u32 s56,s30
s_cbranch_scc1 L_cld_264
L_clb_265:
s_cmp_eq_u32 s46,0
s_cselect_b32 s76,s76,0
s_waitcnt vmcnt(1)
v_mfma_f32_16x16x32_bf16 v[28:31],v[18:21],v[32:35],0
s_waitcnt vmcnt(0)
v_mfma_f32_16x16x32_bf16 v[28:31],v[18:21],v[36:39],v[28:31]
s_nop 7
v_cmp_u_f32 vcc,v28,v28
v_add_f32_dpp v52,v28,v28 row_ror:8 row_mask:0xf bank_mask:0x3
v_add_f32_dpp v53,v29,v29 row_ror:8 row_mask:0xf bank_mask:0x3
v_add_f32_dpp v52,v30,v30 row_ror:8 row_mask:0xf bank_mask:0xc
v_add_f32_dpp v53,v31,v31 row_ror:8 row_mask:0xf bank_mask:0xc
s_nop 0
v_add_f32_dpp v52,v52,v52 row_shl:4 row_mask:0xf bank_mask:0x5
v_add_f32_dpp v53,v53,v53 row_shl:4 row_mask:0xf bank_mask:0x5
s_cbranch_vccnz L_crp_283
L_cok_289:
v_cvt_pk_bf16_f32 v54,v52,v53
buffer_store_dword v54,v10,s[8:11],s64 offen sc1
s_mov_b32 s69,s66
s_xor_b32 s66,s66,262144
s_barrier
ds_read_b128 v[56:59],v55 offset:0
ds_read_b128 v[60:63],v55 offset:4096
ds_read_b128 v[64:67],v55 offset:1024
buffer_load_dwordx4 v[24:27],v13,s[8:11],s64 offen sc1
ds_read_b128 v[68:71],v55 offset:5120
ds_read_b128 v[72:75],v55 offset:2048
ds_read_b128 v[76:79],v55 offset:6144
ds_read_b128 v[80:83],v55 offset:3072
buffer_load_dwordx4 v[24:27],v13,s[8:11],s64 offen sc1
ds_read_b128 v[84:87],v55 offset:7168
ds_read_b128 v[88:91],v123 offset:8192
ds_read_b128 v[92:95],v123 offset:9216
s_branch L_chain_278
L_cpb_285:
buffer_load_dwordx4 v[40:43],v13,s[8:11],s70 offen sc1
s_sub_u32 s49,s49,1
s_cbranch_scc1 L_abort2
s_waitcnt vmcnt(0)
v_max3_u32 v123,v40,v41,v42
v_max_u32 v123,v43,v123
v_cmp_le_u32 vcc,s72,v123
s_cbranch_vccnz L_cpb_285
ds_write_b128 v12,v[40:43] offset:4096
s_branch L_cback_287
L_crp_283:
buffer_load_dwordx4 v[32:35],v0,s[8:11],s66 offen offset:0 sc1
buffer_load_dwordx4 v[36:39],v0,s[8:11],s66 offen offset:1024 sc1
s_sub_u32 s49,s49,1
s_cbranch_scc1 L_abort2
s_waitcnt vmcnt(1)
v_mfma_f32_16x16x32_bf16 v[28:31],v[18:21],v[32:35],0
s_waitcnt vmcnt(0)
v_mfma_f32_16x16x32_bf16 v[28:31],v[18:21],v[36:39],v[28:31]
s_nop 7
v_cmp_u_f32 vcc,v28,v28
v_add_f32_dpp v52,v28,v28 row_ror:8 row_mask:0xf bank_mask:0x3
v_add_f32_dpp v53,v29,v29 row_ror:8 row_mask:0xf bank_mask:0x3
v_add_f32_dpp v52,v30,v30 row_ror:8 row_mask:0xf bank_mask:0xc
v_add_f32_dpp v53,v31,v31 row_ror:8 row_mask:0xf bank_mask:0xc
s_nop 0
v_add_f32_dpp v52,v52,v52 row_shl:4 row_mask:0xf bank_mask:0x5
v_add_f32_dpp v53,v53,v53 row_shl:4 row_mask:0xf bank_mask:0x5
s_cbranch_vccz L_cok_289
s_branch L_crp_283
L_ckw_268:
s_cmp_eq_u32 s77,0
s_cbranch_scc1 L_cjw_270
s_andn2_b32 s31,0x7ff,s20
s_lshr_b32 s31,s31,5
s_cmp_gt_u32 s20,s30
s_cbranch_scc1 L_cjs_266
s_add_u32 s31,s51,2
s_lshl_b32 s59,s31,13
s_add_u32 s59,s59,10486016
v_lshrrev_b32 v45,2,v0
v_and_b32 v45,127,v45
L_ckk_290:
s_sleep 1
buffer_load_dword v44,v45,s[8:11],s59 offen sc1
s_sub_u32 s49,s49,1
s_cbranch_scc1 L_abort2
s_waitcnt vmcnt(0)
v_cmp_eq_u32 vcc,0,v44
s_cbranch_vccnz L_ckk_290
v_cmp_lt_u32 vcc,s30,v44
s_cbranch_vccz L_cjw_270
L_cjs_266:
ds_write_b32 v8,v2 offset:2560
s_waitcnt lgkmcnt(0)
s_branch L_ckb_269
L_cld_264:
v_mov_b32 v23,s56
s_add_u32 s56,s75,10495616
buffer_store_dword v23,off,s[8:11],s56 sc1
s_waitcnt vmcnt(0)
s_branch L_clb_265
L_cjw_270:
s_cmp_lg_u32 s19,0
s_cbranch_scc1 L_ckb_269
s_add_u32 s59,s18,s75
L_ww_291:
s_sleep 1
buffer_load_dword v23,off,s[8:11],s59 sc1
s_sub_u32 s49,s49,1
s_cbranch_scc1 L_abort2
s_waitcnt vmcnt(0)
v_readfirstlane_b32 s76,v23
s_cmp_eq_u32 s76,0
s_cbranch_scc1 L_ww_291
L_wwd_292:
s_branch L_ckb_269
L_cjump_271:
s_waitcnt vmcnt(0) lgkmcnt(0)
s_barrier
s_branch L_cst_267
L_cend_281:
v_smfmac_f32_16x16x64_bf16 v[116:119],v[36:39],v[184:191],v2
v_smfmac_f32_16x16x64_bf16 v[112:115],v[40:43],v[192:199],v2
v_smfmac_f32_16x16x64_bf16 v[116:119],v[40:43],v[200:207],v2
v_smfmac_f32_16x16x64_bf16 v[112:115],v[44:47],v[208:215],v2
v_smfmac_f32_16x16x64_bf16 v[116:119],v[44:47],v[216:223],v2
v_smfmac_f32_16x16x64_bf16 v[112:115],v[48:51],v[224:231],v2
v_smfmac_f32_16x16x64_bf16 v[116:119],v[48:51],v[232:239],v2
v_smfmac_f32_16x16x64_bf16 v[112:115],v[52:55],v[240:247],v2
v_smfmac_f32_16x16x64_bf16 v[116:119],v[52:55],v[248:255],v2
s_waitcnt lgkmcnt(0)
s_nop 2
v_pk_add_f32 v[112:113],v[112:113],v[114:115]
s_nop 2
v_pk_add_f32 v[116:117],v[116:117],v[118:119]
v_cvt_pk_bf16_f32 v126,v112,v113
v_cvt_pk_bf16_f32 v127,v116,v117
v_add_u32 v52,s50,v5
v_add_u32 v54,s50,v6
ds_read_b64_tr_b16 v[52:53],v52
ds_read_b64_tr_b16 v[54:55],v54
v_mov_b32_dpp v124,v126 quad_perm:[2,3,2,3] row_mask:0xf bank_mask:0xf
v_mov_b32_dpp v125,v127 quad_perm:[2,3,2,3] row_mask:0xf bank_mask:0xf
s_mov_b32 vcc_lo,0xcccccccc
s_mov_b32 vcc_hi,0xcccccccc
s_waitcnt lgkmcnt(0)
v_cndmask_b32 v124,v124,v52,vcc
v_cndmask_b32 v125,v125,v53,vcc
v_cndmask_b32 v126,v126,v54,vcc
v_cndmask_b32 v127,v127,v55,vcc
buffer_store_dwordx4 v[124:127],v0,s[8:11],s54 offen sc1
s_mov_b32 s51,64
s_waitcnt vmcnt(0)
s_barrier
s_nop 11
v_lshrrev_b32 v1,4,v0
s_endpgm
L_wa:
s_nop 11
v_and_b32 v238,15,v1
v_and_b32 v239,1,v1
v_lshlrev_b32 v239,4,v239
v_mov_b32 v240,0x3f80
v_lshlrev_b32 v240,v239,v240
v_lshrrev_b32 v238,1,v238
v_cmp_eq_u32 vcc,0,v238
s_nop 1
v_cndmask_b32 v156,0,v240,vcc
v_cmp_eq_u32 vcc,1,v238
s_nop 1
v_cndmask_b32 v157,0,v240,vcc
v_cmp_eq_u32 vcc,2,v238
s_nop 1
v_cndmask_b32 v158,0,v240,vcc
v_cmp_eq_u32 vcc,3,v238
s_nop 1
v_cndmask_b32 v159,0,v240,vcc
s_mov_b32 s4,s32
s_mov_b32 s5,s33
s_mov_b32 s6,1024
s_mov_b32 s7,0x20000
buffer_load_dwordx4 v[224:227],v0,s[4:7],0 offen
v_and_b32 v238,15,v1
v_lshrrev_b32 v239,4,v1
v_lshlrev_b32 v240,2,v239
v_mov_b32 v241,0xf149f2ca
s_and_b32 s56,s46,1
s_lshl_b32 s56,s56,4
v_add_u32 v242,s56,v238
v_add_u32 v243,0,v240
v_cmp_gt_u32 vcc,v243,v242
s_nop 1
v_cndmask_b32 v8,0,v241,vcc
v_add_u32 v243,1,v240
v_cmp_gt_u32 vcc,v243,v242
s_nop 1
v_cndmask_b32 v9,0,v241,vcc
v_add_u32 v243,2,v240
v_cmp_gt_u32 vcc,v243,v242
s_nop 1
v_cndmask_b32 v10,0,v241,vcc
v_add_u32 v243,3,v240
v_cmp_gt_u32 vcc,v243,v242
s_nop 1
v_cndmask_b32 v11,0,v241,vcc
v_add_u32 v243,16,v240
v_cmp_gt_u32 vcc,v243,v242
s_nop 1
v_cndmask_b32 v12,0,v241,vcc
v_add_u32 v243,17,v240
v_cmp_gt_u32 vcc,v243,v242
s_nop 1
v_cndmask_b32 v13,0,v241,vcc
v_add_u32 v243,18,v240
v_cmp_gt_u32 vcc,v243,v242
s_nop 1
v_cndmask_b32 v14,0,v241,vcc
v_add_u32 v243,19,v240
v_cmp_gt_u32 vcc,v243,v242
s_nop 1
v_cndmask_b32 v15,0,v241,vcc
v_mov_b32 v152,s80
v_mov_b32 v145,0
v_mov_b32 v146,0
s_lshl_b32 s56,s46,12
s_add_u32 s56,s56,131072
v_add_u32 v3,s56,v0
v_add_u32 v4,131072,v0
s_lshl_b32 s56,s46,8
v_lshlrev_b32 v7,4,v238
v_add_u32 v7,s56,v7
v_lshl_add_u32 v5,v239,16,v7
v_lshlrev_b32 v6,1,v7
v_lshl_add_u32 v7,v239,10,v7
v_and_b32 v243,1,v239
v_lshl_add_u32 v6,v243,4,v6
v_lshrrev_b32 v243,1,v239
v_lshl_add_u32 v6,v243,12,v6
v_add_u32 v6,147456,v6
v_lshlrev_b32 v16,2,v1
v_lshlrev_b32 v21,3,v238
s_and_b32 s68,s47,15
s_lshl_b32 s56,s68,10
v_add_u32 v5,s56,v5
s_lshl_b32 s56,s68,15
v_add_u32 v7,s56,v7
s_lshl_b32 s69,s54,20
s_add_u32 s69,s69,20971520
s_lshl_b32 s87,s54,13
s_add_u32 s87,s87,10486272
s_lshl4_add_u32 s74,s68,s87
s_lshl2_add_u32 s74,s46,s74
s_lshl_b32 s68,s68,1
s_lshr_b32 s56,s46,1
s_add_u32 s68,s68,s56
s_mov_b32 s66,0
s_mov_b32 s67,0
s_mov_b32 s73,0x80000000
s_mov_b32 s75,0
s_mov_b32 s37,0
s_mov_b64 s[38:39],0
s_sub_u32 s36,s54,12
s_and_b32 s36,s36,3
s_mov_b32 s12,s40
s_mov_b32 s13,s41
s_mov_b32 s14,2097152
s_mov_b32 s15,0x20000
v_add_u32 v21,10487168,v21
v_mov_b32 v244,v21
s_and_b32 s56,s50,2048
s_add_u32 s56,s56,147456
v_lshlrev_b32 v23,5,v1
v_add_u32 v23,s56,v23
v_and_b32 v253,32,v0
v_lshrrev_b32 v245,2,v253
v_add_u32 v253,v253,v245
v_sub_u32 v253,v0,v253
v_add_u32 v253,8,v253
v_mov_b32 v254,0x80000000
s_mov_b32 s56,1408
v_writelane_b32 v254,s56,0
s_mov_b32 s56,256
v_writelane_b32 v254,s56,1
s_mov_b32 s56,1280
v_writelane_b32 v254,s56,2
v_mov_b32 v245,155648
s_lshl_b32 s56,s46,2
v_add_u32 v247,s56,v245
s_waitcnt vmcnt(0)
v_lshlrev_b32 v228,16,v224
v_and_b32 v229,0xffff0000,v224
v_lshlrev_b32 v230,16,v225
v_and_b32 v231,0xffff0000,v225
v_lshlrev_b32 v232,16,v226
v_and_b32 v233,0xffff0000,v226
v_lshlrev_b32 v234,16,v227
v_and_b32 v235,0xffff0000,v227
v_mul_f32 v255,v228,v228
v_fma_f32 v255,v229,v229,v255
v_fma_f32 v255,v230,v230,v255
v_fma_f32 v255,v231,v231,v255
v_fma_f32 v255,v232,v232,v255
v_fma_f32 v255,v233,v233,v255
v_fma_f32 v255,v234,v234,v255
v_fma_f32 v255,v235,v235,v255
s_nop 1
v_add_f32_dpp v255,v255,v255 row_ror:8 row_mask:0xf bank_mask:0xf
s_nop 1
v_add_f32_dpp v255,v255,v255 row_ror:4 row_mask:0xf bank_mask:0xf
s_nop 1
v_add_f32_dpp v255,v255,v255 row_ror:2 row_mask:0xf bank_mask:0xf
s_nop 1
v_add_f32_dpp v255,v255,v255 row_ror:1 row_mask:0xf bank_mask:0xf
v_mov_b32 v238,v255
s_nop 1
v_permlane16_swap_b32 v255,v238
v_add_f32 v255,v255,v238
v_mov_b32 v238,v255
s_nop 1
v_permlane32_swap_b32 v255,v238
v_add_f32 v255,v255,v238
v_sqrt_f32 v255,v255
v_sub_u32 v238,68,v1
v_cvt_f32_u32 v238,v238
v_log_f32 v238,v238
v_mov_b32 v239,0x3ff9999a
v_fmac_f32 v239,0x3e632166,v238
v_mul_f32 v255,v255,v239
v_or_b32 v255,0x80000000,v255
s_cmp_lt_u32 s54,2
s_cbranch_scc1 L_aa_293
s_sub_u32 s77,s54,2
s_mov_b32 s30,0
s_mov_b32 s86,1536
s_lshl_b32 s56,s77,5
s_add_u32 s56,s56,s68
s_mul_i32 s70,s56,24576
s_lshl_b32 s71,s56,12
s_lshl_b32 s59,s77,13
s_lshl2_add_u32 s59,s68,s59
s_add_u32 s59,s59,10485760
s_buffer_load_dword s32,s[8:11],s59
s_mov_b32 s33,1
s_add_u32 s70,s70,100663296
s_add_u32 s71,s71,41943040
v_mov_b32 v19,s59
s_branch L_aa_301
L_aa_307:
s_bitcmp1_b32 s46,0
s_cbranch_scc1 L_av_308
ds_read_b128 v[24:27],v4 offset:0
ds_read_b128 v[28:31],v4 offset:1024
s_min_u32 s56,s32,s33
s_cmp_lt_u32 s77,64
s_cselect_b32 s56,s56,0
s_cmp_eq_u32 s56,0
s_cselect_b32 s72,0x80000000,0
v_mov_b32 v248,s72
s_or_b32 s64,s70,s72
s_or_b32 s65,s71,s72
s_cmp_lt_u32 s30,s31
s_cselect_b32 s65,0x80000000,s65
s_and_b32 s57,s46,1
s_mul_i32 s58,s57,12288
s_add_u32 s64,s64,s58
s_lshl_b32 s57,s57,11
s_waitcnt lgkmcnt(1)
v_mfma_f32_16x16x32_bf16 v[160:163],v[24:27],a[0:3],0
ds_read_b128 v[32:35],v4 offset:2048
s_add_u32 s65,s65,s57
s_and_b32 s59,s50,2048
v_mfma_f32_16x16x32_bf16 v[164:167],v[24:27],a[4:7],0
ds_read_b128 v[36:39],v4 offset:3072
s_lshl_b32 s59,s59,4
s_xor_b32 s60,s67,65536
v_mfma_f32_16x16x32_bf16 v[168:171],v[24:27],a[8:11],0
ds_read_b128 v[40:43],v4 offset:8192
s_add_u32 s59,s59,s60
s_add_u32 s58,s58,s59
v_mfma_f32_16x16x32_bf16 v[172:175],v[24:27],a[12:15],0
ds_read_b128 v[44:47],v4 offset:9216
s_add_u32 s57,s57,s59
s_add_u32 m0,s58,0
v_mfma_f32_16x16x32_bf16 v[176:179],v[24:27],a[16:19],0
buffer_load_dwordx4 v0,s[8:11],s64 offen offset:0 sc1 lds
v_lshlrev_b32 v88,16,v224
v_and_b32 v89,0xffff0000,v224
v_mfma_f32_16x16x32_bf16 v[180:183],v[24:27],a[20:23],0
ds_read_b128 v[48:51],v4 offset:10240
v_lshlrev_b32 v90,16,v225
v_and_b32 v91,0xffff0000,v225
v_mfma_f32_16x16x32_bf16 v[184:187],v[24:27],a[24:27],0
ds_read_b128 v[52:55],v4 offset:11264
s_waitcnt vmcnt(8)
v_mfma_f32_16x16x32_bf16 v[128:131],v[156:159],v[192:195],0
ds_write_b32 v247,v248
v_lshlrev_b32 v92,16,v226
v_and_b32 v93,0xffff0000,v226
v_mfma_f32_16x16x32_bf16 v[188:191],v[24:27],a[28:31],0
ds_read_b128 v[56:59],v4 offset:4096
s_waitcnt vmcnt(7)
v_mfma_f32_16x16x32_bf16 v[128:131],v[156:159],v[196:199],v[128:131]
ds_read_b128 v[60:63],v4 offset:5120
v_lshlrev_b32 v94,16,v227
v_and_b32 v95,0xffff0000,v227
s_waitcnt lgkmcnt(9)
v_mfma_f32_16x16x32_bf16 v[160:163],v[28:31],a[32:35],v[160:163]
buffer_load_dwordx4 v0,s[8:11],s64 offen offset:1024 sc1 lds
s_waitcnt vmcnt(7)
v_mfma_f32_16x16x32_bf16 v[128:131],v[156:159],v[200:203],v[128:131]
ds_read_b128 v[64:67],v4 offset:6144
v_readfirstlane_b32 s22,v246
s_cmp_eq_u32 s22,0
s_cbranch_scc1 L_ag_309
L_agb_310:
v_mfma_f32_16x16x32_bf16 v[164:167],v[28:31],a[36:39],v[164:167]
ds_read_b128 v[68:71],v4 offset:7168
s_waitcnt vmcnt(6)
v_mfma_f32_16x16x32_bf16 v[128:131],v[156:159],v[204:207],v[128:131]
ds_read_b128 v[72:75],v4 offset:12288
s_lshl_b32 s18,s26,5
s_add_u32 s18,s18,s68
v_mfma_f32_16x16x32_bf16 v[168:171],v[28:31],a[40:43],v[168:171]
ds_read_b128 v[76:79],v4 offset:13312
s_waitcnt vmcnt(5)
v_mfma_f32_16x16x32_bf16 v[132:135],v[156:159],v[208:211],0
ds_read_b128 v[80:83],v4 offset:14336
s_lshl_b32 s19,s18,10
s_add_u32 s20,s19,6291456
v_mfma_f32_16x16x32_bf16 v[172:175],v[28:31],a[44:47],v[172:175]
ds_read_b128 v[84:87],v4 offset:15360
s_waitcnt vmcnt(4)
v_mfma_f32_16x16x32_bf16 v[132:135],v[156:159],v[212:215],v[132:135]
s_lshl_b32 s23,s51,5
s_add_u32 s23,s23,s68
s_lshl_b32 s24,s23,10
v_mfma_f32_16x16x32_bf16 v[176:179],v[28:31],a[48:51],v[176:179]
buffer_load_dwordx4 v0,s[8:11],s64 offen offset:2048 sc1 lds
s_waitcnt vmcnt(4)
v_mfma_f32_16x16x32_bf16 v[132:135],v[156:159],v[216:219],v[132:135]
s_lshl_b32 s25,s51,10
s_add_u32 s25,s25,2883584
s_cmp_eq_u32 s23,s55
s_cselect_b32 s25,s25,s24
v_mfma_f32_16x16x32_bf16 v[180:183],v[28:31],a[52:55],v[180:183]
ds_write_b128 v6,v[128:131]
s_waitcnt vmcnt(3)
v_mfma_f32_16x16x32_bf16 v[132:135],v[156:159],v[220:223],v[132:135]
s_add_u32 s25,s25,8388608
s_mov_b32 s6,268435456
s_cmp_eq_u32 s31,0
s_cselect_b32 s25,s24,s25
s_cselect_b64 s[4:5],s[16:17],s[44:45]
s_cmov_b32 s6,2097152
v_mfma_f32_16x16x32_bf16 v[184:187],v[28:31],a[56:59],v[184:187]
buffer_load_dwordx4 v[224:227],v0,s[4:7],s25 offen sc1
s_lshr_b32 s24,s55,5
s_cmp_lt_u32 s51,s24
s_cselect_b32 s24,1,2
v_mfma_f32_16x16x32_bf16 v[188:191],v[28:31],a[60:63],v[188:191]
v_mov_b32 v252,s24
s_lshl2_add_u32 s25,s51,11018240
s_waitcnt lgkmcnt(15)
v_mfma_f32_16x16x32_bf16 v[160:163],v[32:35],a[64:67],v[160:163]
ds_write_b128 v6,v[132:135] offset:2048
s_lshl_b32 s24,s68,16
s_add_u32 s24,s24,s31
v_mfma_f32_16x16x32_bf16 v[164:167],v[32:35],a[68:71],v[164:167]
buffer_load_dwordx4 v0,s[8:11],s64 offen offset:3072 sc1 lds
s_add_u32 s24,s24,s86
s_cmp_eq_u32 s24,1537
s_cselect_b32 s25,s25,0x80000000
v_mfma_f32_16x16x32_bf16 v[168:171],v[32:35],a[72:75],v[168:171]
buffer_store_dword v252,off,s[8:11],s25 sc1
s_bitcmp1_b64 s[38:39],s51
s_cselect_b32 s24,128,0
v_mfma_f32_16x16x32_bf16 v[172:175],v[32:35],a[76:79],v[172:175]
s_lshl_b32 s23,s51,13
s_lshl2_add_u32 s23,s68,s23
s_add_u32 s23,s23,10487168
v_mfma_f32_16x16x32_bf16 v[176:179],v[32:35],a[80:83],v[176:179]
s_waitcnt lgkmcnt(0)
s_barrier
s_add_u32 s23,s23,s24
v_mfma_f32_16x16x32_bf16 v[180:183],v[32:35],a[84:87],v[180:183]
ds_read_b128 v[96:99],v23
s_add_u32 m0,s58,4096
s_add_u32 s64,s64,4096
v_mfma_f32_16x16x32_bf16 v[184:187],v[32:35],a[88:91],v[184:187]
ds_read_b128 v[100:103],v23 offset:16
v_mfma_f32_16x16x32_bf16 v[188:191],v[32:35],a[92:95],v[188:191]
buffer_load_dwordx4 v0,s[8:11],s64 offen offset:0 sc1 lds
v_mfma_f32_16x16x32_bf16 v[160:163],v[36:39],a[96:99],v[160:163]
ds_read_b128 v[248:251],v245
v_mfma_f32_16x16x32_bf16 v[164:167],v[36:39],a[100:103],v[164:167]
buffer_load_dword v246,off,s[8:11],s23 sc1
v_lshrrev_b32 v244,4,v1
s_sub_u32 s23,s77,8
v_add_u32 v244,s23,v244
v_mfma_f32_16x16x32_bf16 v[168:171],v[36:39],a[104:107],v[168:171]
buffer_store_dword v20,off,s[8:11],s73 sc1
v_max_i32 v244,0,v244
v_lshl_add_u32 v244,v244,13,v21
s_mov_b32 s73,0x80000000
v_mfma_f32_16x16x32_bf16 v[172:175],v[36:39],a[108:111],v[172:175]
buffer_load_dwordx4 v0,s[8:11],s64 offen offset:1024 sc1 lds
v_mfma_f32_16x16x32_bf16 v[176:179],v[36:39],a[112:115],v[176:179]
buffer_load_dwordx2 v[242:243],v244,s[8:11],0 offen sc1
v_mfma_f32_16x16x32_bf16 v[180:183],v[36:39],a[116:119],v[180:183]
v_mfma_f32_16x16x32_bf16 v[184:187],v[36:39],a[120:123],v[184:187]
s_waitcnt lgkmcnt(0)
v_or3_b32 v248,v248,v249,v250
v_or_b32 v248,v248,v251
v_mfma_f32_16x16x32_bf16 v[188:191],v[36:39],a[124:127],v[188:191]
buffer_load_dwordx4 v0,s[8:11],s64 offen offset:2048 sc1 lds
v_readfirstlane_b32 s72,v248
s_waitcnt lgkmcnt(1)
v_cvt_pk_bf16_f32 v104,v96,v97
v_mfma_f32_16x16x32_bf16 v[160:163],v[40:43],a[128:131],v[160:163]
v_cvt_pk_bf16_f32 v105,v98,v99
v_cvt_pk_bf16_f32 v106,v100,v101
v_cvt_pk_bf16_f32 v107,v102,v103
v_mfma_f32_16x16x32_bf16 v[164:167],v[40:43],a[132:135],v[164:167]
v_lshlrev_b32 v96,16,v104
v_and_b32 v97,0xffff0000,v104
v_lshlrev_b32 v98,16,v105
v_mfma_f32_16x16x32_bf16 v[168:171],v[40:43],a[136:139],v[168:171]
v_and_b32 v99,0xffff0000,v105
v_lshlrev_b32 v100,16,v106
v_and_b32 v101,0xffff0000,v106
v_mfma_f32_16x16x32_bf16 v[172:175],v[40:43],a[140:143],v[172:175]
buffer_load_dwordx4 v0,s[8:11],s64 offen offset:3072 sc1 lds
v_lshlrev_b32 v102,16,v107
v_and_b32 v103,0xffff0000,v107
v_add_f32 v88,v88,v96
v_mfma_f32_16x16x32_bf16 v[176:179],v[40:43],a[144:147],v[176:179]
v_add_f32 v89,v89,v97
v_add_f32 v90,v90,v98
v_add_f32 v91,v91,v99
v_mfma_f32_16x16x32_bf16 v[180:183],v[40:43],a[148:151],v[180:183]
v_add_f32 v92,v92,v100
v_add_f32 v93,v93,v101
v_add_f32 v94,v94,v102
v_mfma_f32_16x16x32_bf16 v[184:187],v[40:43],a[152:155],v[184:187]
v_add_f32 v95,v95,v103
v_cvt_pk_bf16_f32 v104,v88,v89
v_cvt_pk_bf16_f32 v105,v90,v91
v_mfma_f32_16x16x32_bf16 v[188:191],v[40:43],a[156:159],v[188:191]
s_add_u32 m0,s58,8192
s_add_u32 s64,s64,4096
v_cvt_pk_bf16_f32 v106,v92,v93
v_mfma_f32_16x16x32_bf16 v[160:163],v[44:47],a[160:163],v[160:163]
buffer_load_dwordx4 v0,s[8:11],s64 offen offset:0 sc1 lds
v_cvt_pk_bf16_f32 v107,v94,v95
v_mfma_f32_16x16x32_bf16 v[164:167],v[44:47],a[164:167],v[164:167]
buffer_store_dwordx4 v[104:107],v0,s[8:11],s20 offen sc1
v_lshlrev_b32 v88,16,v104
v_and_b32 v89,0xffff0000,v104
v_lshlrev_b32 v90,16,v105
v_mfma_f32_16x16x32_bf16 v[168:171],v[44:47],a[168:171],v[168:171]
v_and_b32 v91,0xffff0000,v105
v_lshlrev_b32 v92,16,v106
v_and_b32 v93,0xffff0000,v106
v_mfma_f32_16x16x32_bf16 v[172:175],v[44:47],a[172:175],v[172:175]
v_lshlrev_b32 v94,16,v107
v_and_b32 v95,0xffff0000,v107
v_mfma_f32_16x16x32_bf16 v[176:179],v[44:47],a[176:179],v[176:179]
buffer_load_dwordx4 v0,s[8:11],s64 offen offset:1024 sc1 lds
v_readfirstlane_b32 s78,v88
v_mfma_f32_16x16x32_bf16 v[180:183],v[44:47],a[180:183],v[180:183]
s_nop 0
v_add_f32 v120,v88,-s78
v_add_f32 v121,v89,-s78
v_add_f32 v122,v90,-s78
v_mfma_f32_16x16x32_bf16 v[184:187],v[44:47],a[184:187],v[184:187]
v_add_f32 v123,v91,-s78
v_add_f32 v124,v92,-s78
v_mfma_f32_16x16x32_bf16 v[188:191],v[44:47],a[188:191],v[188:191]
v_add_f32 v125,v93,-s78
v_add_f32 v126,v94,-s78
v_mfma_f32_16x16x32_bf16 v[160:163],v[48:51],a[192:195],v[160:163]
buffer_load_dwordx4 v0,s[8:11],s64 offen offset:2048 sc1 lds
v_add_f32 v127,v95,-s78
v_add_f32 v128,v120,v122
v_mfma_f32_16x16x32_bf16 v[164:167],v[48:51],a[196:199],v[164:167]
v_add_f32 v129,v121,v123
v_mul_f32 v130,v120,v120
v_mfma_f32_16x16x32_bf16 v[168:171],v[48:51],a[200:203],v[168:171]
v_mul_f32 v131,v121,v121
v_add_f32 v132,v124,v126
v_mfma_f32_16x16x32_bf16 v[172:175],v[48:51],a[204:207],v[172:175]
v_add_f32 v133,v125,v127
v_fma_f32 v130,v122,v122,v130
v_mfma_f32_16x16x32_bf16 v[176:179],v[48:51],a[208:211],v[176:179]
buffer_load_dwordx4 v0,s[8:11],s64 offen offset:3072 sc1 lds
v_fma_f32 v131,v123,v123,v131
v_add_f32 v128,v128,v132
v_mfma_f32_16x16x32_bf16 v[180:183],v[48:51],a[212:215],v[180:183]
v_add_f32 v129,v129,v133
v_fma_f32 v130,v124,v124,v130
v_mfma_f32_16x16x32_bf16 v[184:187],v[48:51],a[216:219],v[184:187]
v_fma_f32 v131,v125,v125,v131
v_add_f32 v128,v128,v129
v_mfma_f32_16x16x32_bf16 v[188:191],v[48:51],a[220:223],v[188:191]
v_fma_f32 v130,v126,v126,v130
v_fma_f32 v131,v127,v127,v131
v_mfma_f32_16x16x32_bf16 v[160:163],v[52:55],a[224:227],v[160:163]
s_add_u32 m0,s57,24576
v_add_f32 v130,v130,v131
v_mfma_f32_16x16x32_bf16 v[164:167],v[52:55],a[228:231],v[164:167]
buffer_load_dwordx4 v0,s[8:11],s65 offen offset:0 sc1 lds
v_permlane32_swap_b32 v128,v130
v_add_f32 v128,v128,v130
v_mfma_f32_16x16x32_bf16 v[168:171],v[52:55],a[232:235],v[168:171]
s_nop 0
v_add_f32_dpp v128,v128,v128 row_ror:8 row_mask:0xf bank_mask:0xf
v_mfma_f32_16x16x32_bf16 v[172:175],v[52:55],a[236:239],v[172:175]
s_nop 0
v_add_f32_dpp v128,v128,v128 row_ror:4 row_mask:0xf bank_mask:0xf
v_mfma_f32_16x16x32_bf16 v[176:179],v[52:55],a[240:243],v[176:179]
s_nop 0
v_add_f32_dpp v128,v128,v128 row_ror:2 row_mask:0xf bank_mask:0xf
v_mfma_f32_16x16x32_bf16 v[180:183],v[52:55],a[244:247],v[180:183]
buffer_load_dwordx4 v0,s[8:11],s65 offen offset:1024 sc1 lds
v_add_f32_dpp v128,v128,v128 row_ror:1 row_mask:0xf bank_mask:0xf
v_mov_b32 v130,v128
v_mfma_f32_16x16x32_bf16 v[184:187],v[52:55],a[248:251],v[184:187]
s_nop 0
v_permlane16_swap_b32 v128,v130
v_add_f32 v128,v128,v130
v_mul_f32 v128,0x3b000000,v128
v_mfma_f32_16x16x32_bf16 v[188:191],v[52:55],a[252:255],v[188:191]
v_mov_b32 v130,v128
v_mfma_f32_16x16x32_bf16 v[192:195],v[56:59],a[0:3],0
s_nop 0
v_permlane32_swap_b32 v128,v130
v_fma_f32 v130,-v128,v128,v130
v_add_f32 v128,s78,v128
v_mfma_f32_16x16x32_bf16 v[196:199],v[56:59],a[4:7],0
v_max_f32 v130,0,v130
v_cvt_pk_bf16_f32 v130,v128,v130
v_lshlrev_b32 v128,16,v130
v_mfma_f32_16x16x32_bf16 v[200:203],v[56:59],a[8:11],0
v_and_b32 v130,0xffff0000,v130
v_add_f32 v130,0x3727c5ac,v130
v_cvt_pk_bf16_f32 v130,v130,v130
v_mfma_f32_16x16x32_bf16 v[204:207],v[56:59],a[12:15],0
v_and_b32 v130,0xffff0000,v130
v_sqrt_f32 v130,v130
v_add_f32 v120,v88,-v128
v_mfma_f32_16x16x32_bf16 v[208:211],v[56:59],a[16:19],0
v_add_f32 v121,v89,-v128
v_add_f32 v122,v90,-v128
v_mfma_f32_16x16x32_bf16 v[212:215],v[56:59],a[20:23],0
v_add_f32 v123,v91,-v128
v_add_f32 v124,v92,-v128
v_mfma_f32_16x16x32_bf16 v[216:219],v[56:59],a[24:27],0
v_add_f32 v125,v93,-v128
v_add_f32 v126,v94,-v128
v_mfma_f32_16x16x32_bf16 v[220:223],v[56:59],a[28:31],0
v_add_f32 v127,v95,-v128
v_cvt_pk_bf16_f32 v130,v130,v130
v_mfma_f32_16x16x32_bf16 v[192:195],v[60:63],a[32:35],v[192:195]
v_and_b32 v130,0xffff0000,v130
v_rcp_f32 v130,v130
v_mfma_f32_16x16x32_bf16 v[196:199],v[60:63],a[36:39],v[196:199]
v_cvt_pk_bf16_f32 v108,v120,v121
v_cvt_pk_bf16_f32 v109,v122,v123
v_mfma_f32_16x16x32_bf16 v[200:203],v[60:63],a[40:43],v[200:203]
v_cvt_pk_bf16_f32 v110,v124,v125
v_cvt_pk_bf16_f32 v111,v126,v127
v_mfma_f32_16x16x32_bf16 v[204:207],v[60:63],a[44:47],v[204:207]
v_lshlrev_b32 v120,16,v108
v_and_b32 v121,0xffff0000,v108
v_mfma_f32_16x16x32_bf16 v[208:211],v[60:63],a[48:51],v[208:211]
v_lshlrev_b32 v122,16,v109
v_and_b32 v123,0xffff0000,v109
v_mfma_f32_16x16x32_bf16 v[212:215],v[60:63],a[52:55],v[212:215]
v_lshlrev_b32 v124,16,v110
v_and_b32 v125,0xffff0000,v110
v_mfma_f32_16x16x32_bf16 v[216:219],v[60:63],a[56:59],v[216:219]
v_lshlrev_b32 v126,16,v111
v_and_b32 v127,0xffff0000,v111
v_mfma_f32_16x16x32_bf16 v[220:223],v[60:63],a[60:63],v[220:223]
v_mul_f32 v120,v120,v130
v_mul_f32 v121,v121,v130
v_mfma_f32_16x16x32_bf16 v[192:195],v[64:67],a[64:67],v[192:195]
v_mul_f32 v122,v122,v130
v_mul_f32 v123,v123,v130
v_mfma_f32_16x16x32_bf16 v[196:199],v[64:67],a[68:71],v[196:199]
v_mul_f32 v124,v124,v130
v_mul_f32 v125,v125,v130
v_mfma_f32_16x16x32_bf16 v[200:203],v[64:67],a[72:75],v[200:203]
v_mul_f32 v126,v126,v130
v_mul_f32 v127,v127,v130
v_mfma_f32_16x16x32_bf16 v[204:207],v[64:67],a[76:79],v[204:207]
v_cvt_pk_bf16_f32 v108,v120,v121
v_cvt_pk_bf16_f32 v109,v122,v123
v_mfma_f32_16x16x32_bf16 v[208:211],v[64:67],a[80:83],v[208:211]
v_cvt_pk_bf16_f32 v24,v160,v164
v_cvt_pk_bf16_f32 v25,v168,v172
v_mfma_f32_16x16x32_bf16 v[212:215],v[64:67],a[84:87],v[212:215]
v_cvt_pk_bf16_f32 v26,v176,v180
v_cvt_pk_bf16_f32 v27,v184,v188
v_mfma_f32_16x16x32_bf16 v[216:219],v[64:67],a[88:91],v[216:219]
v_cvt_pk_bf16_f32 v28,v161,v165
v_cvt_pk_bf16_f32 v29,v169,v173
v_mfma_f32_16x16x32_bf16 v[220:223],v[64:67],a[92:95],v[220:223]
v_cvt_pk_bf16_f32 v30,v177,v181
v_cvt_pk_bf16_f32 v31,v185,v189
v_mfma_f32_16x16x32_bf16 v[192:195],v[68:71],a[96:99],v[192:195]
v_cvt_pk_bf16_f32 v32,v162,v166
v_cvt_pk_bf16_f32 v33,v170,v174
v_mfma_f32_16x16x32_bf16 v[196:199],v[68:71],a[100:103],v[196:199]
v_cvt_pk_bf16_f32 v34,v178,v182
v_cvt_pk_bf16_f32 v35,v186,v190
v_mfma_f32_16x16x32_bf16 v[200:203],v[68:71],a[104:107],v[200:203]
v_cvt_pk_bf16_f32 v36,v163,v167
v_cvt_pk_bf16_f32 v37,v171,v175
v_mfma_f32_16x16x32_bf16 v[204:207],v[68:71],a[108:111],v[204:207]
v_cvt_pk_bf16_f32 v38,v179,v183
v_cvt_pk_bf16_f32 v39,v187,v191
v_mfma_f32_16x16x32_bf16 v[208:211],v[68:71],a[112:115],v[208:211]
s_add_u32 s62,s69,0
v_cvt_pk_bf16_f32 v110,v124,v125
v_cvt_pk_bf16_f32 v111,v126,v127
v_mfma_f32_16x16x32_bf16 v[212:215],v[68:71],a[116:119],v[212:215]
buffer_store_dwordx4 v[24:27],v5,s[8:11],s62 offen sc1
v_lshlrev_b32 v112,16,v108
v_and_b32 v113,0xffff0000,v108
v_mfma_f32_16x16x32_bf16 v[216:219],v[68:71],a[120:123],v[216:219]
v_lshlrev_b32 v114,16,v109
v_and_b32 v115,0xffff0000,v109
v_mfma_f32_16x16x32_bf16 v[220:223],v[68:71],a[124:127],v[220:223]
v_lshlrev_b32 v116,16,v110
v_and_b32 v117,0xffff0000,v110
v_mfma_f32_16x16x32_bf16 v[192:195],v[72:75],a[128:131],v[192:195]
s_add_u32 s62,s69,16384
v_lshlrev_b32 v118,16,v111
v_and_b32 v119,0xffff0000,v111
v_mfma_f32_16x16x32_bf16 v[196:199],v[72:75],a[132:135],v[196:199]
buffer_store_dwordx4 v[28:31],v5,s[8:11],s62 offen sc1
v_add_f32 v88,v88,v112
v_add_f32 v89,v89,v113
v_mfma_f32_16x16x32_bf16 v[200:203],v[72:75],a[136:139],v[200:203]
v_add_f32 v90,v90,v114
v_add_f32 v91,v91,v115
v_mfma_f32_16x16x32_bf16 v[204:207],v[72:75],a[140:143],v[204:207]
v_add_f32 v92,v92,v116
v_add_f32 v93,v93,v117
v_mfma_f32_16x16x32_bf16 v[208:211],v[72:75],a[144:147],v[208:211]
s_add_u32 s62,s69,32768
v_add_f32 v94,v94,v118
v_add_f32 v95,v95,v119
v_mfma_f32_16x16x32_bf16 v[212:215],v[72:75],a[148:151],v[212:215]
buffer_store_dwordx4 v[32:35],v5,s[8:11],s62 offen sc1
v_cvt_pk_bf16_f32 v96,v88,v89
v_cvt_pk_bf16_f32 v97,v90,v91
v_mfma_f32_16x16x32_bf16 v[216:219],v[72:75],a[152:155],v[216:219]
v_cvt_pk_bf16_f32 v98,v92,v93
v_cvt_pk_bf16_f32 v99,v94,v95
v_mfma_f32_16x16x32_bf16 v[220:223],v[72:75],a[156:159],v[220:223]
buffer_store_dwordx4 v[96:99],v0,s[12:15],s19 offen sc1
v_mul_f32 v236,v112,v228
v_mul_f32 v237,v113,v229
v_mfma_f32_16x16x32_bf16 v[192:195],v[76:79],a[160:163],v[192:195]
s_add_u32 s62,s69,49152
v_fma_f32 v236,v114,v230,v236
v_fma_f32 v237,v115,v231,v237
v_mfma_f32_16x16x32_bf16 v[196:199],v[76:79],a[164:167],v[196:199]
buffer_store_dwordx4 v[36:39],v5,s[8:11],s62 offen sc1
v_fma_f32 v236,v116,v232,v236
v_fma_f32 v237,v117,v233,v237
v_mfma_f32_16x16x32_bf16 v[200:203],v[76:79],a[168:171],v[200:203]
v_fma_f32 v236,v118,v234,v236
v_fma_f32 v237,v119,v235,v237
v_mfma_f32_16x16x32_bf16 v[204:207],v[76:79],a[172:175],v[204:207]
v_add_f32 v236,v236,v237
v_mfma_f32_16x16x32_bf16 v[208:211],v[76:79],a[176:179],v[208:211]
s_nop 0
v_add_f32_dpp v236,v236,v236 row_ror:8 row_mask:0xf bank_mask:0xf
v_mfma_f32_16x16x32_bf16 v[212:215],v[76:79],a[180:183],v[212:215]
s_nop 0
v_add_f32_dpp v236,v236,v236 row_ror:4 row_mask:0xf bank_mask:0xf
v_mfma_f32_16x16x32_bf16 v[216:219],v[76:79],a[184:187],v[216:219]
s_nop 0
v_add_f32_dpp v236,v236,v236 row_ror:2 row_mask:0xf bank_mask:0xf
v_mfma_f32_16x16x32_bf16 v[220:223],v[76:79],a[188:191],v[220:223]
s_nop 0
v_add_f32_dpp v236,v236,v236 row_ror:1 row_mask:0xf bank_mask:0xf
v_mov_b32 v237,v236
v_mfma_f32_16x16x32_bf16 v[192:195],v[80:83],a[192:195],v[192:195]
s_nop 0
v_permlane16_swap_b32 v236,v237
v_add_f32 v236,v236,v237
v_mov_b32 v237,v236
v_mfma_f32_16x16x32_bf16 v[196:199],v[80:83],a[196:199],v[196:199]
s_nop 0
v_permlane32_swap_b32 v236,v237
v_add_f32 v236,v236,v237
v_cvt_pk_bf16_f32 v236,v236,v236
v_mfma_f32_16x16x32_bf16 v[200:203],v[80:83],a[200:203],v[200:203]
v_and_b32 v236,0xffff0000,v236
v_ashrrev_i32 v237,31,v236
v_or_b32 v237,0x80000000,v237
v_mfma_f32_16x16x32_bf16 v[204:207],v[80:83],a[204:207],v[204:207]
v_xor_b32 v236,v236,v237
v_and_b32 v236,0xffff0000,v236
s_sub_u32 s20,4095,s18
v_mfma_f32_16x16x32_bf16 v[208:211],v[80:83],a[208:211],v[208:211]
v_or_b32 v20,s20,v236
s_lshl_b32 s73,s26,13
s_lshl2_add_u32 s73,s68,s73
v_mfma_f32_16x16x32_bf16 v[212:215],v[80:83],a[212:215],v[212:215]
s_add_u32 s73,s73,10485760
s_add_u32 s73,s73,s86
v_mfma_f32_16x16x32_bf16 v[216:219],v[80:83],a[216:219],v[216:219]
v_mfma_f32_16x16x32_bf16 v[220:223],v[80:83],a[220:223],v[220:223]
v_mfma_f32_16x16x32_bf16 v[192:195],v[84:87],a[224:227],v[192:195]
v_mfma_f32_16x16x32_bf16 v[196:199],v[84:87],a[228:231],v[196:199]
v_mfma_f32_16x16x32_bf16 v[200:203],v[84:87],a[232:235],v[200:203]
v_mfma_f32_16x16x32_bf16 v[204:207],v[84:87],a[236:239],v[204:207]
v_mfma_f32_16x16x32_bf16 v[208:211],v[84:87],a[240:243],v[208:211]
v_mfma_f32_16x16x32_bf16 v[212:215],v[84:87],a[244:247],v[212:215]
v_mfma_f32_16x16x32_bf16 v[216:219],v[84:87],a[248:251],v[216:219]
v_mfma_f32_16x16x32_bf16 v[220:223],v[84:87],a[252:255],v[220:223]
v_cvt_pk_bf16_f32 v40,v192,v196
v_cvt_pk_bf16_f32 v41,v200,v204
v_cvt_pk_bf16_f32 v42,v208,v212
s_nop 4
v_cvt_pk_bf16_f32 v43,v216,v220
s_add_u32 s62,s69,262144
buffer_store_dwordx4 v[40:43],v5,s[8:11],s62 offen sc1
v_cvt_pk_bf16_f32 v44,v193,v197
v_cvt_pk_bf16_f32 v45,v201,v205
v_cvt_pk_bf16_f32 v46,v209,v213
v_cvt_pk_bf16_f32 v47,v217,v221
s_add_u32 s62,s69,278528
buffer_store_dwordx4 v[44:47],v5,s[8:11],s62 offen sc1
v_cvt_pk_bf16_f32 v48,v194,v198
v_cvt_pk_bf16_f32 v49,v202,v206
v_cvt_pk_bf16_f32 v50,v210,v214
v_cvt_pk_bf16_f32 v51,v218,v222
s_add_u32 s62,s69,294912
buffer_store_dwordx4 v[48:51],v5,s[8:11],s62 offen sc1
v_cvt_pk_bf16_f32 v52,v195,v199
v_cvt_pk_bf16_f32 v53,v203,v207
v_cvt_pk_bf16_f32 v54,v211,v215
v_cvt_pk_bf16_f32 v55,v219,v223
s_add_u32 s62,s69,311296
buffer_store_dwordx4 v[52:55],v5,s[8:11],s62 offen sc1
s_cmp_lg_u32 s72,0
s_cbranch_scc1 L_aa_296
s_waitcnt vmcnt(9)
s_branch L_aa_306
L_av_308:
ds_read_b128 v[24:27],v4 offset:0
ds_read_b128 v[28:31],v4 offset:1024
s_min_u32 s56,s32,s33
s_cmp_lt_u32 s77,64
s_cselect_b32 s56,s56,0
s_cmp_eq_u32 s56,0
s_cselect_b32 s72,0x80000000,0
v_mov_b32 v248,s72
s_or_b32 s64,s70,s72
s_or_b32 s65,s71,s72
s_cmp_lt_u32 s30,s31
s_cselect_b32 s65,0x80000000,s65
s_and_b32 s57,s46,1
s_mul_i32 s58,s57,12288
s_add_u32 s64,s64,s58
s_lshl_b32 s57,s57,11
s_waitcnt lgkmcnt(1)
v_mfma_f32_16x16x32_bf16 v[160:163],v[24:27],a[0:3],0
ds_read_b128 v[32:35],v4 offset:2048
s_add_u32 s65,s65,s57
s_and_b32 s59,s50,2048
v_mfma_f32_16x16x32_bf16 v[164:167],v[24:27],a[4:7],0
ds_read_b128 v[36:39],v4 offset:3072
s_lshl_b32 s59,s59,4
s_xor_b32 s60,s67,65536
v_mfma_f32_16x16x32_bf16 v[168:171],v[24:27],a[8:11],0
ds_read_b128 v[40:43],v4 offset:8192
s_add_u32 s59,s59,s60
s_add_u32 s58,s58,s59
v_mfma_f32_16x16x32_bf16 v[172:175],v[24:27],a[12:15],0
ds_read_b128 v[44:47],v4 offset:9216
s_add_u32 s57,s57,s59
s_add_u32 m0,s58,0
v_mfma_f32_16x16x32_bf16 v[176:179],v[24:27],a[16:19],0
buffer_load_dwordx4 v0,s[8:11],s64 offen offset:0 sc1 lds
s_lshl_b32 s23,s51,5
s_add_u32 s23,s23,s68
v_mfma_f32_16x16x32_bf16 v[180:183],v[24:27],a[20:23],0
ds_read_b128 v[48:51],v4 offset:10240
s_lshl_b32 s24,s23,10
s_lshl_b32 s25,s51,10
v_mfma_f32_16x16x32_bf16 v[184:187],v[24:27],a[24:27],0
ds_read_b128 v[52:55],v4 offset:11264
s_waitcnt vmcnt(8)
v_mfma_f32_16x16x32_bf16 v[128:131],v[156:159],v[192:195],0
ds_write_b32 v247,v248
s_add_u32 s25,s25,2883584
s_cmp_eq_u32 s23,s55
s_cselect_b32 s25,s25,s24
v_mfma_f32_16x16x32_bf16 v[188:191],v[24:27],a[28:31],0
ds_read_b128 v[56:59],v4 offset:4096
s_waitcnt vmcnt(7)
v_mfma_f32_16x16x32_bf16 v[128:131],v[156:159],v[196:199],v[128:131]
ds_read_b128 v[60:63],v4 offset:5120
s_add_u32 s25,s25,8388608
s_mov_b32 s6,268435456
s_waitcnt lgkmcnt(9)
v_mfma_f32_16x16x32_bf16 v[160:163],v[28:31],a[32:35],v[160:163]
buffer_load_dwordx4 v0,s[8:11],s64 offen offset:1024 sc1 lds
s_waitcnt vmcnt(7)
v_mfma_f32_16x16x32_bf16 v[128:131],v[156:159],v[200:203],v[128:131]
ds_read_b128 v[64:67],v4 offset:6144
s_cmp_eq_u32 s31,0
s_cselect_b32 s25,s24,s25
s_cselect_b64 s[4:5],s[16:17],s[44:45]
s_cmov_b32 s6,2097152
v_mfma_f32_16x16x32_bf16 v[164:167],v[28:31],a[36:39],v[164:167]
ds_read_b128 v[68:71],v4 offset:7168
s_waitcnt vmcnt(6)
v_mfma_f32_16x16x32_bf16 v[128:131],v[156:159],v[204:207],v[128:131]
ds_read_b128 v[72:75],v4 offset:12288
v_mfma_f32_16x16x32_bf16 v[168:171],v[28:31],a[40:43],v[168:171]
ds_read_b128 v[76:79],v4 offset:13312
s_waitcnt vmcnt(5)
v_mfma_f32_16x16x32_bf16 v[132:135],v[156:159],v[208:211],0
ds_read_b128 v[80:83],v4 offset:14336
v_mfma_f32_16x16x32_bf16 v[172:175],v[28:31],a[44:47],v[172:175]
ds_read_b128 v[84:87],v4 offset:15360
s_waitcnt vmcnt(4)
v_mfma_f32_16x16x32_bf16 v[132:135],v[156:159],v[212:215],v[132:135]
buffer_load_dwordx4 v[224:227],v0,s[4:7],s25 offen sc1
s_lshr_b32 s24,s55,5
s_cmp_lt_u32 s51,s24
s_cselect_b32 s24,1,2
v_mfma_f32_16x16x32_bf16 v[176:179],v[28:31],a[48:51],v[176:179]
buffer_load_dwordx4 v0,s[8:11],s64 offen offset:2048 sc1 lds
s_waitcnt vmcnt(5)
v_mfma_f32_16x16x32_bf16 v[132:135],v[156:159],v[216:219],v[132:135]
v_mov_b32 v252,s24
s_lshl2_add_u32 s25,s51,11018240
v_mfma_f32_16x16x32_bf16 v[180:183],v[28:31],a[52:55],v[180:183]
ds_write_b128 v6,v[128:131]
s_waitcnt vmcnt(4)
v_mfma_f32_16x16x32_bf16 v[132:135],v[156:159],v[220:223],v[132:135]
s_lshl_b32 s24,s68,16
s_add_u32 s24,s24,s31
s_add_u32 s24,s24,s86
v_mfma_f32_16x16x32_bf16 v[184:187],v[28:31],a[56:59],v[184:187]
s_cmp_eq_u32 s24,1537
s_cselect_b32 s25,s25,0x80000000
v_mfma_f32_16x16x32_bf16 v[188:191],v[28:31],a[60:63],v[188:191]
buffer_store_dword v252,off,s[8:11],s25 sc1
s_bitcmp1_b64 s[38:39],s51
s_cselect_b32 s24,128,0
s_waitcnt lgkmcnt(15)
v_mfma_f32_16x16x32_bf16 v[160:163],v[32:35],a[64:67],v[160:163]
ds_write_b128 v6,v[132:135] offset:2048
s_lshl_b32 s23,s51,13
s_lshl2_add_u32 s23,s68,s23
v_mfma_f32_16x16x32_bf16 v[164:167],v[32:35],a[68:71],v[164:167]
buffer_load_dwordx4 v0,s[8:11],s64 offen offset:3072 sc1 lds
s_add_u32 s23,s23,10487168
s_add_u32 s23,s23,s24
v_mfma_f32_16x16x32_bf16 v[168:171],v[32:35],a[72:75],v[168:171]
buffer_load_dword v246,off,s[8:11],s23 sc1
v_lshrrev_b32 v244,4,v1
s_sub_u32 s23,s77,8
v_mfma_f32_16x16x32_bf16 v[172:175],v[32:35],a[76:79],v[172:175]
v_add_u32 v244,s23,v244
v_max_i32 v244,0,v244
v_mfma_f32_16x16x32_bf16 v[176:179],v[32:35],a[80:83],v[176:179]
s_waitcnt lgkmcnt(0)
s_barrier
v_lshl_add_u32 v244,v244,13,v21
v_mfma_f32_16x16x32_bf16 v[180:183],v[32:35],a[84:87],v[180:183]
ds_read_b128 v[248:251],v245
s_add_u32 m0,s58,4096
s_add_u32 s64,s64,4096
v_mfma_f32_16x16x32_bf16 v[184:187],v[32:35],a[88:91],v[184:187]
buffer_load_dwordx4 v0,s[8:11],s64 offen offset:0 sc1 lds
v_mfma_f32_16x16x32_bf16 v[188:191],v[32:35],a[92:95],v[188:191]
buffer_load_dwordx2 v[242:243],v244,s[8:11],0 offen sc1
v_mfma_f32_16x16x32_bf16 v[160:163],v[36:39],a[96:99],v[160:163]
buffer_store_dword v20,off,s[8:11],s73 sc1
s_mov_b32 s73,0x80000000
v_mfma_f32_16x16x32_bf16 v[164:167],v[36:39],a[100:103],v[164:167]
v_mfma_f32_16x16x32_bf16 v[168:171],v[36:39],a[104:107],v[168:171]
buffer_load_dwordx4 v0,s[8:11],s64 offen offset:1024 sc1 lds
v_mfma_f32_16x16x32_bf16 v[172:175],v[36:39],a[108:111],v[172:175]
v_mfma_f32_16x16x32_bf16 v[176:179],v[36:39],a[112:115],v[176:179]
s_waitcnt lgkmcnt(0)
v_or3_b32 v248,v248,v249,v250
v_or_b32 v248,v248,v251
v_mfma_f32_16x16x32_bf16 v[180:183],v[36:39],a[116:119],v[180:183]
v_mfma_f32_16x16x32_bf16 v[184:187],v[36:39],a[120:123],v[184:187]
buffer_load_dwordx4 v0,s[8:11],s64 offen offset:2048 sc1 lds
v_readfirstlane_b32 s72,v248
v_mfma_f32_16x16x32_bf16 v[188:191],v[36:39],a[124:127],v[188:191]
v_mfma_f32_16x16x32_bf16 v[160:163],v[40:43],a[128:131],v[160:163]
v_mfma_f32_16x16x32_bf16 v[164:167],v[40:43],a[132:135],v[164:167]
v_mfma_f32_16x16x32_bf16 v[168:171],v[40:43],a[136:139],v[168:171]
buffer_load_dwordx4 v0,s[8:11],s64 offen offset:3072 sc1 lds
v_mfma_f32_16x16x32_bf16 v[172:175],v[40:43],a[140:143],v[172:175]
v_mfma_f32_16x16x32_bf16 v[176:179],v[40:43],a[144:147],v[176:179]
v_mfma_f32_16x16x32_bf16 v[180:183],v[40:43],a[148:151],v[180:183]
v_mfma_f32_16x16x32_bf16 v[184:187],v[40:43],a[152:155],v[184:187]
s_add_u32 m0,s58,8192
s_add_u32 s64,s64,4096
v_mfma_f32_16x16x32_bf16 v[188:191],v[40:43],a[156:159],v[188:191]
buffer_load_dwordx4 v0,s[8:11],s64 offen offset:0 sc1 lds
v_mfma_f32_16x16x32_bf16 v[160:163],v[44:47],a[160:163],v[160:163]
v_mfma_f32_16x16x32_bf16 v[164:167],v[44:47],a[164:167],v[164:167]
v_mfma_f32_16x16x32_bf16 v[168:171],v[44:47],a[168:171],v[168:171]
v_mfma_f32_16x16x32_bf16 v[172:175],v[44:47],a[172:175],v[172:175]
buffer_load_dwordx4 v0,s[8:11],s64 offen offset:1024 sc1 lds
v_mfma_f32_16x16x32_bf16 v[176:179],v[44:47],a[176:179],v[176:179]
v_mfma_f32_16x16x32_bf16 v[180:183],v[44:47],a[180:183],v[180:183]
v_mfma_f32_16x16x32_bf16 v[184:187],v[44:47],a[184:187],v[184:187]
v_mfma_f32_16x16x32_bf16 v[188:191],v[44:47],a[188:191],v[188:191]
buffer_load_dwordx4 v0,s[8:11],s64 offen offset:2048 sc1 lds
v_mfma_f32_16x16x32_bf16 v[160:163],v[48:51],a[192:195],v[160:163]
v_mfma_f32_16x16x32_bf16 v[164:167],v[48:51],a[196:199],v[164:167]
v_mfma_f32_16x16x32_bf16 v[168:171],v[48:51],a[200:203],v[168:171]
v_mfma_f32_16x16x32_bf16 v[172:175],v[48:51],a[204:207],v[172:175]
buffer_load_dwordx4 v0,s[8:11],s64 offen offset:3072 sc1 lds
v_mfma_f32_16x16x32_bf16 v[176:179],v[48:51],a[208:211],v[176:179]
v_mfma_f32_16x16x32_bf16 v[180:183],v[48:51],a[212:215],v[180:183]
v_mfma_f32_16x16x32_bf16 v[184:187],v[48:51],a[216:219],v[184:187]
v_mfma_f32_16x16x32_bf16 v[188:191],v[48:51],a[220:223],v[188:191]
s_add_u32 m0,s57,24576
v_mfma_f32_16x16x32_bf16 v[160:163],v[52:55],a[224:227],v[160:163]
buffer_load_dwordx4 v0,s[8:11],s65 offen offset:0 sc1 lds
v_mfma_f32_16x16x32_bf16 v[164:167],v[52:55],a[228:231],v[164:167]
v_mfma_f32_16x16x32_bf16 v[168:171],v[52:55],a[232:235],v[168:171]
v_mfma_f32_16x16x32_bf16 v[172:175],v[52:55],a[236:239],v[172:175]
v_mfma_f32_16x16x32_bf16 v[176:179],v[52:55],a[240:243],v[176:179]
buffer_load_dwordx4 v0,s[8:11],s65 offen offset:1024 sc1 lds
v_mfma_f32_16x16x32_bf16 v[180:183],v[52:55],a[244:247],v[180:183]
v_mfma_f32_16x16x32_bf16 v[184:187],v[52:55],a[248:251],v[184:187]
v_mfma_f32_16x16x32_bf16 v[188:191],v[52:55],a[252:255],v[188:191]
v_mfma_f32_16x16x32_bf16 v[192:195],v[56:59],a[0:3],0
v_mfma_f32_16x16x32_bf16 v[196:199],v[56:59],a[4:7],0
v_mfma_f32_16x16x32_bf16 v[200:203],v[56:59],a[8:11],0
v_cvt_pk_bf16_f32 v24,v160,v164
v_cvt_pk_bf16_f32 v25,v168,v172
v_mfma_f32_16x16x32_bf16 v[204:207],v[56:59],a[12:15],0
v_cvt_pk_bf16_f32 v26,v176,v180
v_cvt_pk_bf16_f32 v27,v184,v188
v_mfma_f32_16x16x32_bf16 v[208:211],v[56:59],a[16:19],0
v_cvt_pk_bf16_f32 v28,v161,v165
v_cvt_pk_bf16_f32 v29,v169,v173
v_mfma_f32_16x16x32_bf16 v[212:215],v[56:59],a[20:23],0
v_cvt_pk_bf16_f32 v30,v177,v181
v_cvt_pk_bf16_f32 v31,v185,v189
v_mfma_f32_16x16x32_bf16 v[216:219],v[56:59],a[24:27],0
v_cvt_pk_bf16_f32 v32,v162,v166
v_cvt_pk_bf16_f32 v33,v170,v174
v_mfma_f32_16x16x32_bf16 v[220:223],v[56:59],a[28:31],0
v_cvt_pk_bf16_f32 v34,v178,v182
v_cvt_pk_bf16_f32 v35,v186,v190
v_mfma_f32_16x16x32_bf16 v[192:195],v[60:63],a[32:35],v[192:195]
v_cvt_pk_bf16_f32 v36,v163,v167
v_cvt_pk_bf16_f32 v37,v171,v175
v_mfma_f32_16x16x32_bf16 v[196:199],v[60:63],a[36:39],v[196:199]
v_cvt_pk_bf16_f32 v38,v179,v183
v_cvt_pk_bf16_f32 v39,v187,v191
v_mfma_f32_16x16x32_bf16 v[200:203],v[60:63],a[40:43],v[200:203]
v_mfma_f32_16x16x32_bf16 v[204:207],v[60:63],a[44:47],v[204:207]
v_mfma_f32_16x16x32_bf16 v[208:211],v[60:63],a[48:51],v[208:211]
v_mfma_f32_16x16x32_bf16 v[212:215],v[60:63],a[52:55],v[212:215]
v_mfma_f32_16x16x32_bf16 v[216:219],v[60:63],a[56:59],v[216:219]
v_mfma_f32_16x16x32_bf16 v[220:223],v[60:63],a[60:63],v[220:223]
v_mfma_f32_16x16x32_bf16 v[192:195],v[64:67],a[64:67],v[192:195]
v_mfma_f32_16x16x32_bf16 v[196:199],v[64:67],a[68:71],v[196:199]
v_mfma_f32_16x16x32_bf16 v[200:203],v[64:67],a[72:75],v[200:203]
v_mfma_f32_16x16x32_bf16 v[204:207],v[64:67],a[76:79],v[204:207]
v_mfma_f32_16x16x32_bf16 v[208:211],v[64:67],a[80:83],v[208:211]
v_mfma_f32_16x16x32_bf16 v[212:215],v[64:67],a[84:87],v[212:215]
v_mfma_f32_16x16x32_bf16 v[216:219],v[64:67],a[88:91],v[216:219]
v_mfma_f32_16x16x32_bf16 v[220:223],v[64:67],a[92:95],v[220:223]
v_mfma_f32_16x16x32_bf16 v[192:195],v[68:71],a[96:99],v[192:195]
v_mfma_f32_16x16x32_bf16 v[196:199],v[68:71],a[100:103],v[196:199]
v_mfma_f32_16x16x32_bf16 v[200:203],v[68:71],a[104:107],v[200:203]
v_mfma_f32_16x16x32_bf16 v[204:207],v[68:71],a[108:111],v[204:207]
v_mfma_f32_16x16x32_bf16 v[208:211],v[68:71],a[112:115],v[208:211]
s_add_u32 s62,s69,0
v_mfma_f32_16x16x32_bf16 v[212:215],v[68:71],a[116:119],v[212:215]
buffer_store_dwordx4 v[24:27],v5,s[8:11],s62 offen sc1
v_mfma_f32_16x16x32_bf16 v[216:219],v[68:71],a[120:123],v[216:219]
v_mfma_f32_16x16x32_bf16 v[220:223],v[68:71],a[124:127],v[220:223]
v_mfma_f32_16x16x32_bf16 v[192:195],v[72:75],a[128:131],v[192:195]
s_add_u32 s62,s69,16384
v_mfma_f32_16x16x32_bf16 v[196:199],v[72:75],a[132:135],v[196:199]
buffer_store_dwordx4 v[28:31],v5,s[8:11],s62 offen sc1
v_mfma_f32_16x16x32_bf16 v[200:203],v[72:75],a[136:139],v[200:203]
v_mfma_f32_16x16x32_bf16 v[204:207],v[72:75],a[140:143],v[204:207]
v_mfma_f32_16x16x32_bf16 v[208:211],v[72:75],a[144:147],v[208:211]
s_add_u32 s62,s69,32768
v_mfma_f32_16x16x32_bf16 v[212:215],v[72:75],a[148:151],v[212:215]
buffer_store_dwordx4 v[32:35],v5,s[8:11],s62 offen sc1
v_mfma_f32_16x16x32_bf16 v[216:219],v[72:75],a[152:155],v[216:219]
v_mfma_f32_16x16x32_bf16 v[220:223],v[72:75],a[156:159],v[220:223]
v_mfma_f32_16x16x32_bf16 v[192:195],v[76:79],a[160:163],v[192:195]
s_add_u32 s62,s69,49152
v_mfma_f32_16x16x32_bf16 v[196:199],v[76:79],a[164:167],v[196:199]
buffer_store_dwordx4 v[36:39],v5,s[8:11],s62 offen sc1
v_mfma_f32_16x16x32_bf16 v[200:203],v[76:79],a[168:171],v[200:203]
v_mfma_f32_16x16x32_bf16 v[204:207],v[76:79],a[172:175],v[204:207]
v_mfma_f32_16x16x32_bf16 v[208:211],v[76:79],a[176:179],v[208:211]
v_mfma_f32_16x16x32_bf16 v[212:215],v[76:79],a[180:183],v[212:215]
v_mfma_f32_16x16x32_bf16 v[216:219],v[76:79],a[184:187],v[216:219]
v_mfma_f32_16x16x32_bf16 v[220:223],v[76:79],a[188:191],v[220:223]
v_mfma_f32_16x16x32_bf16 v[192:195],v[80:83],a[192:195],v[192:195]
v_mfma_f32_16x16x32_bf16 v[196:199],v[80:83],a[196:199],v[196:199]
v_mfma_f32_16x16x32_bf16 v[200:203],v[80:83],a[200:203],v[200:203]
v_mfma_f32_16x16x32_bf16 v[204:207],v[80:83],a[204:207],v[204:207]
v_mfma_f32_16x16x32_bf16 v[208:211],v[80:83],a[208:211],v[208:211]
v_mfma_f32_16x16x32_bf16 v[212:215],v[80:83],a[212:215],v[212:215]
v_mfma_f32_16x16x32_bf16 v[216:219],v[80:83],a[216:219],v[216:219]
v_mfma_f32_16x16x32_bf16 v[220:223],v[80:83],a[220:223],v[220:223]
v_mfma_f32_16x16x32_bf16 v[192:195],v[84:87],a[224:227],v[192:195]
v_mfma_f32_16x16x32_bf16 v[196:199],v[84:87],a[228:231],v[196:199]
v_mfma_f32_16x16x32_bf16 v[200:203],v[84:87],a[232:235],v[200:203]
v_mfma_f32_16x16x32_bf16 v[204:207],v[84:87],a[236:239],v[204:207]
v_mfma_f32_16x16x32_bf16 v[208:211],v[84:87],a[240:243],v[208:211]
v_mfma_f32_16x16x32_bf16 v[212:215],v[84:87],a[244:247],v[212:215]
v_mfma_f32_16x16x32_bf16 v[216:219],v[84:87],a[248:251],v[216:219]
v_mfma_f32_16x16x32_bf16 v[220:223],v[84:87],a[252:255],v[220:223]
v_cvt_pk_bf16_f32 v40,v192,v196
v_cvt_pk_bf16_f32 v41,v200,v204
v_cvt_pk_bf16_f32 v42,v208,v212
s_nop 4
v_cvt_pk_bf16_f32 v43,v216,v220
s_add_u32 s62,s69,262144
buffer_store_dwordx4 v[40:43],v5,s[8:11],s62 offen sc1
v_cvt_pk_bf16_f32 v44,v193,v197
v_cvt_pk_bf16_f32 v45,v201,v205
v_cvt_pk_bf16_f32 v46,v209,v213
v_cvt_pk_bf16_f32 v47,v217,v221
s_add_u32 s62,s69,278528
buffer_store_dwordx4 v[44:47],v5,s[8:11],s62 offen sc1
v_cvt_pk_bf16_f32 v48,v194,v198
v_cvt_pk_bf16_f32 v49,v202,v206
v_cvt_pk_bf16_f32 v50,v210,v214
v_cvt_pk_bf16_f32 v51,v218,v222
s_add_u32 s62,s69,294912
buffer_store_dwordx4 v[48:51],v5,s[8:11],s62 offen sc1
v_cvt_pk_bf16_f32 v52,v195,v199
v_cvt_pk_bf16_f32 v53,v203,v207
v_cvt_pk_bf16_f32 v54,v211,v215
v_cvt_pk_bf16_f32 v55,v219,v223
s_add_u32 s62,s69,311296
buffer_store_dwordx4 v[52:55],v5,s[8:11],s62 offen sc1
s_cmp_lg_u32 s72,0
s_cbranch_scc1 L_aa_296
s_waitcnt vmcnt(8)
s_branch L_aa_306
L_aa_294:
ds_read_b128 v[24:27],v4 offset:0
ds_read_b128 v[28:31],v4 offset:1024
s_min_u32 s56,s32,s33
s_cmp_lt_u32 s77,64
s_cselect_b32 s56,s56,0
s_cmp_eq_u32 s56,0
s_cselect_b32 s72,0x80000000,0
v_mov_b32 v248,s72
s_or_b32 s64,s70,s72
s_or_b32 s65,s71,s72
s_cmp_lt_u32 s30,s31
s_cselect_b32 s65,0x80000000,s65
s_and_b32 s57,s46,1
s_mul_i32 s58,s57,12288
s_add_u32 s64,s64,s58
s_lshl_b32 s57,s57,11
s_waitcnt lgkmcnt(1)
v_mfma_f32_16x16x32_bf16 v[160:163],v[24:27],a[0:3],0
ds_read_b128 v[32:35],v4 offset:2048
s_add_u32 s65,s65,s57
s_and_b32 s59,s50,2048
v_mfma_f32_16x16x32_bf16 v[164:167],v[24:27],a[4:7],0
ds_read_b128 v[36:39],v4 offset:3072
s_lshl_b32 s59,s59,4
s_xor_b32 s60,s67,65536
v_mfma_f32_16x16x32_bf16 v[168:171],v[24:27],a[8:11],0
ds_read_b128 v[40:43],v4 offset:8192
s_add_u32 s59,s59,s60
s_add_u32 s58,s58,s59
v_mfma_f32_16x16x32_bf16 v[172:175],v[24:27],a[12:15],0
ds_read_b128 v[44:47],v4 offset:9216
s_add_u32 s57,s57,s59
s_add_u32 m0,s58,0
v_mfma_f32_16x16x32_bf16 v[176:179],v[24:27],a[16:19],0
buffer_load_dwordx4 v0,s[8:11],s64 offen offset:0 sc1 lds
s_lshl_b32 s23,s51,5
s_add_u32 s23,s23,s68
v_mfma_f32_16x16x32_bf16 v[180:183],v[24:27],a[20:23],0
ds_read_b128 v[48:51],v4 offset:10240
s_lshl_b32 s24,s23,10
s_lshl_b32 s25,s51,10
v_mfma_f32_16x16x32_bf16 v[184:187],v[24:27],a[24:27],0
ds_read_b128 v[52:55],v4 offset:11264
s_add_u32 s25,s25,2883584
s_cmp_eq_u32 s23,s55
s_cselect_b32 s25,s25,s24
v_mfma_f32_16x16x32_bf16 v[188:191],v[24:27],a[28:31],0
ds_write_b32 v247,v248
s_add_u32 s25,s25,8388608
s_mov_b32 s6,268435456
s_waitcnt lgkmcnt(7)
v_mfma_f32_16x16x32_bf16 v[160:163],v[28:31],a[32:35],v[160:163]
buffer_load_dwordx4 v0,s[8:11],s64 offen offset:1024 sc1 lds
s_cmp_eq_u32 s31,0
s_cselect_b32 s25,s24,s25
s_cselect_b64 s[4:5],s[16:17],s[44:45]
s_cmov_b32 s6,2097152
v_mfma_f32_16x16x32_bf16 v[164:167],v[28:31],a[36:39],v[164:167]
ds_read_b128 v[56:59],v4 offset:4096
v_mfma_f32_16x16x32_bf16 v[168:171],v[28:31],a[40:43],v[168:171]
ds_read_b128 v[60:63],v4 offset:5120
v_mfma_f32_16x16x32_bf16 v[172:175],v[28:31],a[44:47],v[172:175]
ds_read_b128 v[64:67],v4 offset:6144
v_mfma_f32_16x16x32_bf16 v[176:179],v[28:31],a[48:51],v[176:179]
buffer_load_dwordx4 v0,s[8:11],s64 offen offset:2048 sc1 lds
v_mfma_f32_16x16x32_bf16 v[180:183],v[28:31],a[52:55],v[180:183]
ds_read_b128 v[68:71],v4 offset:7168
v_mfma_f32_16x16x32_bf16 v[184:187],v[28:31],a[56:59],v[184:187]
ds_read_b128 v[72:75],v4 offset:12288
v_mfma_f32_16x16x32_bf16 v[188:191],v[28:31],a[60:63],v[188:191]
ds_read_b128 v[76:79],v4 offset:13312
s_waitcnt lgkmcnt(12)
v_mfma_f32_16x16x32_bf16 v[160:163],v[32:35],a[64:67],v[160:163]
buffer_load_dwordx4 v0,s[8:11],s64 offen offset:3072 sc1 lds
v_mfma_f32_16x16x32_bf16 v[164:167],v[32:35],a[68:71],v[164:167]
ds_read_b128 v[80:83],v4 offset:14336
v_mfma_f32_16x16x32_bf16 v[168:171],v[32:35],a[72:75],v[168:171]
ds_read_b128 v[84:87],v4 offset:15360
v_mfma_f32_16x16x32_bf16 v[172:175],v[32:35],a[76:79],v[172:175]
buffer_load_dwordx4 v[224:227],v0,s[4:7],s25 offen sc1
s_lshr_b32 s24,s55,5
s_cmp_lt_u32 s51,s24
s_cselect_b32 s24,1,2
v_mfma_f32_16x16x32_bf16 v[176:179],v[32:35],a[80:83],v[176:179]
s_add_u32 m0,s58,4096
s_add_u32 s64,s64,4096
v_mov_b32 v252,s24
v_mfma_f32_16x16x32_bf16 v[180:183],v[32:35],a[84:87],v[180:183]
buffer_load_dwordx4 v0,s[8:11],s64 offen offset:0 sc1 lds
s_lshl2_add_u32 s25,s51,11018240
s_lshl_b32 s24,s68,16
v_mfma_f32_16x16x32_bf16 v[184:187],v[32:35],a[88:91],v[184:187]
s_add_u32 s24,s24,s31
s_add_u32 s24,s24,s86
s_cmp_eq_u32 s24,1537
s_cselect_b32 s25,s25,0x80000000
v_mfma_f32_16x16x32_bf16 v[188:191],v[32:35],a[92:95],v[188:191]
buffer_store_dword v252,off,s[8:11],s25 sc1
s_waitcnt lgkmcnt(0)
s_barrier
s_waitcnt lgkmcnt(13)
v_mfma_f32_16x16x32_bf16 v[160:163],v[36:39],a[96:99],v[160:163]
ds_read_b128 v[248:251],v245
s_bitcmp1_b64 s[38:39],s51
s_cselect_b32 s24,128,0
v_mfma_f32_16x16x32_bf16 v[164:167],v[36:39],a[100:103],v[164:167]
buffer_load_dwordx4 v0,s[8:11],s64 offen offset:1024 sc1 lds
s_lshl_b32 s23,s51,13
s_lshl2_add_u32 s23,s68,s23
v_mfma_f32_16x16x32_bf16 v[168:171],v[36:39],a[104:107],v[168:171]
s_add_u32 s23,s23,10487168
s_add_u32 s23,s23,s24
v_mfma_f32_16x16x32_bf16 v[172:175],v[36:39],a[108:111],v[172:175]
buffer_load_dword v246,off,s[8:11],s23 sc1
v_lshrrev_b32 v244,4,v1
s_sub_u32 s23,s77,8
v_mfma_f32_16x16x32_bf16 v[176:179],v[36:39],a[112:115],v[176:179]
v_add_u32 v244,s23,v244
v_max_i32 v244,0,v244
v_mfma_f32_16x16x32_bf16 v[180:183],v[36:39],a[116:119],v[180:183]
buffer_load_dwordx4 v0,s[8:11],s64 offen offset:2048 sc1 lds
v_lshl_add_u32 v244,v244,13,v21
v_mfma_f32_16x16x32_bf16 v[184:187],v[36:39],a[120:123],v[184:187]
buffer_load_dwordx2 v[242:243],v244,s[8:11],0 offen sc1
s_waitcnt lgkmcnt(0)
v_or3_b32 v248,v248,v249,v250
v_mfma_f32_16x16x32_bf16 v[188:191],v[36:39],a[124:127],v[188:191]
v_or_b32 v248,v248,v251
v_mfma_f32_16x16x32_bf16 v[160:163],v[40:43],a[128:131],v[160:163]
v_readfirstlane_b32 s72,v248
v_mfma_f32_16x16x32_bf16 v[164:167],v[40:43],a[132:135],v[164:167]
buffer_load_dwordx4 v0,s[8:11],s64 offen offset:3072 sc1 lds
v_mfma_f32_16x16x32_bf16 v[168:171],v[40:43],a[136:139],v[168:171]
v_mfma_f32_16x16x32_bf16 v[172:175],v[40:43],a[140:143],v[172:175]
v_mfma_f32_16x16x32_bf16 v[176:179],v[40:43],a[144:147],v[176:179]
s_waitcnt vmcnt(12)
v_mfma_f32_16x16x32_bf16 v[180:183],v[40:43],a[148:151],v[180:183]
buffer_store_dword v20,off,s[8:11],s73 sc1
s_add_u32 m0,s58,8192
s_add_u32 s64,s64,4096
v_mfma_f32_16x16x32_bf16 v[184:187],v[40:43],a[152:155],v[184:187]
buffer_load_dwordx4 v0,s[8:11],s64 offen offset:0 sc1 lds
s_mov_b32 s73,0x80000000
v_mfma_f32_16x16x32_bf16 v[188:191],v[40:43],a[156:159],v[188:191]
v_mfma_f32_16x16x32_bf16 v[160:163],v[44:47],a[160:163],v[160:163]
v_mfma_f32_16x16x32_bf16 v[164:167],v[44:47],a[164:167],v[164:167]
v_mfma_f32_16x16x32_bf16 v[168:171],v[44:47],a[168:171],v[168:171]
buffer_load_dwordx4 v0,s[8:11],s64 offen offset:1024 sc1 lds
v_mfma_f32_16x16x32_bf16 v[172:175],v[44:47],a[172:175],v[172:175]
v_mfma_f32_16x16x32_bf16 v[176:179],v[44:47],a[176:179],v[176:179]
v_mfma_f32_16x16x32_bf16 v[180:183],v[44:47],a[180:183],v[180:183]
v_mfma_f32_16x16x32_bf16 v[184:187],v[44:47],a[184:187],v[184:187]
buffer_load_dwordx4 v0,s[8:11],s64 offen offset:2048 sc1 lds
v_mfma_f32_16x16x32_bf16 v[188:191],v[44:47],a[188:191],v[188:191]
v_mfma_f32_16x16x32_bf16 v[160:163],v[48:51],a[192:195],v[160:163]
v_mfma_f32_16x16x32_bf16 v[164:167],v[48:51],a[196:199],v[164:167]
v_mfma_f32_16x16x32_bf16 v[168:171],v[48:51],a[200:203],v[168:171]
buffer_load_dwordx4 v0,s[8:11],s64 offen offset:3072 sc1 lds
v_mfma_f32_16x16x32_bf16 v[172:175],v[48:51],a[204:207],v[172:175]
v_mfma_f32_16x16x32_bf16 v[176:179],v[48:51],a[208:211],v[176:179]
v_mfma_f32_16x16x32_bf16 v[180:183],v[48:51],a[212:215],v[180:183]
v_mfma_f32_16x16x32_bf16 v[184:187],v[48:51],a[216:219],v[184:187]
s_add_u32 m0,s57,24576
v_mfma_f32_16x16x32_bf16 v[188:191],v[48:51],a[220:223],v[188:191]
buffer_load_dwordx4 v0,s[8:11],s65 offen offset:0 sc1 lds
v_mfma_f32_16x16x32_bf16 v[160:163],v[52:55],a[224:227],v[160:163]
v_mfma_f32_16x16x32_bf16 v[164:167],v[52:55],a[228:231],v[164:167]
v_mfma_f32_16x16x32_bf16 v[168:171],v[52:55],a[232:235],v[168:171]
v_mfma_f32_16x16x32_bf16 v[172:175],v[52:55],a[236:239],v[172:175]
buffer_load_dwordx4 v0,s[8:11],s65 offen offset:1024 sc1 lds
v_mfma_f32_16x16x32_bf16 v[176:179],v[52:55],a[240:243],v[176:179]
v_mfma_f32_16x16x32_bf16 v[180:183],v[52:55],a[244:247],v[180:183]
v_mfma_f32_16x16x32_bf16 v[184:187],v[52:55],a[248:251],v[184:187]
v_mfma_f32_16x16x32_bf16 v[188:191],v[52:55],a[252:255],v[188:191]
v_mfma_f32_16x16x32_bf16 v[192:195],v[56:59],a[0:3],0
v_mfma_f32_16x16x32_bf16 v[196:199],v[56:59],a[4:7],0
v_mfma_f32_16x16x32_bf16 v[200:203],v[56:59],a[8:11],0
v_cvt_pk_bf16_f32 v24,v160,v164
v_cvt_pk_bf16_f32 v25,v168,v172
v_mfma_f32_16x16x32_bf16 v[204:207],v[56:59],a[12:15],0
v_cvt_pk_bf16_f32 v26,v176,v180
v_cvt_pk_bf16_f32 v27,v184,v188
v_mfma_f32_16x16x32_bf16 v[208:211],v[56:59],a[16:19],0
v_cvt_pk_bf16_f32 v28,v161,v165
v_cvt_pk_bf16_f32 v29,v169,v173
v_mfma_f32_16x16x32_bf16 v[212:215],v[56:59],a[20:23],0
v_cvt_pk_bf16_f32 v30,v177,v181
v_cvt_pk_bf16_f32 v31,v185,v189
v_mfma_f32_16x16x32_bf16 v[216:219],v[56:59],a[24:27],0
v_cvt_pk_bf16_f32 v32,v162,v166
v_cvt_pk_bf16_f32 v33,v170,v174
v_mfma_f32_16x16x32_bf16 v[220:223],v[56:59],a[28:31],0
v_cvt_pk_bf16_f32 v34,v178,v182
v_cvt_pk_bf16_f32 v35,v186,v190
v_mfma_f32_16x16x32_bf16 v[192:195],v[60:63],a[32:35],v[192:195]
v_cvt_pk_bf16_f32 v36,v163,v167
v_cvt_pk_bf16_f32 v37,v171,v175
v_mfma_f32_16x16x32_bf16 v[196:199],v[60:63],a[36:39],v[196:199]
v_cvt_pk_bf16_f32 v38,v179,v183
v_cvt_pk_bf16_f32 v39,v187,v191
v_mfma_f32_16x16x32_bf16 v[200:203],v[60:63],a[40:43],v[200:203]
v_mfma_f32_16x16x32_bf16 v[204:207],v[60:63],a[44:47],v[204:207]
v_mfma_f32_16x16x32_bf16 v[208:211],v[60:63],a[48:51],v[208:211]
v_mfma_f32_16x16x32_bf16 v[212:215],v[60:63],a[52:55],v[212:215]
v_mfma_f32_16x16x32_bf16 v[216:219],v[60:63],a[56:59],v[216:219]
v_mfma_f32_16x16x32_bf16 v[220:223],v[60:63],a[60:63],v[220:223]
v_mfma_f32_16x16x32_bf16 v[192:195],v[64:67],a[64:67],v[192:195]
v_mfma_f32_16x16x32_bf16 v[196:199],v[64:67],a[68:71],v[196:199]
v_mfma_f32_16x16x32_bf16 v[200:203],v[64:67],a[72:75],v[200:203]
v_mfma_f32_16x16x32_bf16 v[204:207],v[64:67],a[76:79],v[204:207]
v_mfma_f32_16x16x32_bf16 v[208:211],v[64:67],a[80:83],v[208:211]
v_mfma_f32_16x16x32_bf16 v[212:215],v[64:67],a[84:87],v[212:215]
v_mfma_f32_16x16x32_bf16 v[216:219],v[64:67],a[88:91],v[216:219]
v_mfma_f32_16x16x32_bf16 v[220:223],v[64:67],a[92:95],v[220:223]
v_mfma_f32_16x16x32_bf16 v[192:195],v[68:71],a[96:99],v[192:195]
v_mfma_f32_16x16x32_bf16 v[196:199],v[68:71],a[100:103],v[196:199]
v_mfma_f32_16x16x32_bf16 v[200:203],v[68:71],a[104:107],v[200:203]
v_mfma_f32_16x16x32_bf16 v[204:207],v[68:71],a[108:111],v[204:207]
v_mfma_f32_16x16x32_bf16 v[208:211],v[68:71],a[112:115],v[208:211]
s_add_u32 s62,s69,0
v_mfma_f32_16x16x32_bf16 v[212:215],v[68:71],a[116:119],v[212:215]
buffer_store_dwordx4 v[24:27],v5,s[8:11],s62 offen sc1
v_mfma_f32_16x16x32_bf16 v[216:219],v[68:71],a[120:123],v[216:219]
v_mfma_f32_16x16x32_bf16 v[220:223],v[68:71],a[124:127],v[220:223]
v_mfma_f32_16x16x32_bf16 v[192:195],v[72:75],a[128:131],v[192:195]
s_add_u32 s62,s69,16384
v_mfma_f32_16x16x32_bf16 v[196:199],v[72:75],a[132:135],v[196:199]
buffer_store_dwordx4 v[28:31],v5,s[8:11],s62 offen sc1
v_mfma_f32_16x16x32_bf16 v[200:203],v[72:75],a[136:139],v[200:203]
v_mfma_f32_16x16x32_bf16 v[204:207],v[72:75],a[140:143],v[204:207]
v_mfma_f32_16x16x32_bf16 v[208:211],v[72:75],a[144:147],v[208:211]
s_add_u32 s62,s69,32768
v_mfma_f32_16x16x32_bf16 v[212:215],v[72:75],a[148:151],v[212:215]
buffer_store_dwordx4 v[32:35],v5,s[8:11],s62 offen sc1
v_mfma_f32_16x16x32_bf16 v[216:219],v[72:75],a[152:155],v[216:219]
v_mfma_f32_16x16x32_bf16 v[220:223],v[72:75],a[156:159],v[220:223]
v_mfma_f32_16x16x32_bf16 v[192:195],v[76:79],a[160:163],v[192:195]
s_add_u32 s62,s69,49152
v_mfma_f32_16x16x32_bf16 v[196:199],v[76:79],a[164:167],v[196:199]
buffer_store_dwordx4 v[36:39],v5,s[8:11],s62 offen sc1
v_mfma_f32_16x16x32_bf16 v[200:203],v[76:79],a[168:171],v[200:203]
v_mfma_f32_16x16x32_bf16 v[204:207],v[76:79],a[172:175],v[204:207]
v_mfma_f32_16x16x32_bf16 v[208:211],v[76:79],a[176:179],v[208:211]
v_mfma_f32_16x16x32_bf16 v[212:215],v[76:79],a[180:183],v[212:215]
v_mfma_f32_16x16x32_bf16 v[216:219],v[76:79],a[184:187],v[216:219]
v_mfma_f32_16x16x32_bf16 v[220:223],v[76:79],a[188:191],v[220:223]
v_mfma_f32_16x16x32_bf16 v[192:195],v[80:83],a[192:195],v[192:195]
v_mfma_f32_16x16x32_bf16 v[196:199],v[80:83],a[196:199],v[196:199]
v_mfma_f32_16x16x32_bf16 v[200:203],v[80:83],a[200:203],v[200:203]
v_mfma_f32_16x16x32_bf16 v[204:207],v[80:83],a[204:207],v[204:207]
v_mfma_f32_16x16x32_bf16 v[208:211],v[80:83],a[208:211],v[208:211]
v_mfma_f32_16x16x32_bf16 v[212:215],v[80:83],a[212:215],v[212:215]
v_mfma_f32_16x16x32_bf16 v[216:219],v[80:83],a[216:219],v[216:219]
v_mfma_f32_16x16x32_bf16 v[220:223],v[80:83],a[220:223],v[220:223]
v_mfma_f32_16x16x32_bf16 v[192:195],v[84:87],a[224:227],v[192:195]
v_mfma_f32_16x16x32_bf16 v[196:199],v[84:87],a[228:231],v[196:199]
v_mfma_f32_16x16x32_bf16 v[200:203],v[84:87],a[232:235],v[200:203]
v_mfma_f32_16x16x32_bf16 v[204:207],v[84:87],a[236:239],v[204:207]
v_mfma_f32_16x16x32_bf16 v[208:211],v[84:87],a[240:243],v[208:211]
v_mfma_f32_16x16x32_bf16 v[212:215],v[84:87],a[244:247],v[212:215]
v_mfma_f32_16x16x32_bf16 v[216:219],v[84:87],a[248:251],v[216:219]
v_mfma_f32_16x16x32_bf16 v[220:223],v[84:87],a[252:255],v[220:223]
v_cvt_pk_bf16_f32 v40,v192,v196
v_cvt_pk_bf16_f32 v41,v200,v204
v_cvt_pk_bf16_f32 v42,v208,v212
s_nop 4
v_cvt_pk_bf16_f32 v43,v216,v220
s_add_u32 s62,s69,262144
buffer_store_dwordx4 v[40:43],v5,s[8:11],s62 offen sc1
v_cvt_pk_bf16_f32 v44,v193,v197
v_cvt_pk_bf16_f32 v45,v201,v205
v_cvt_pk_bf16_f32 v46,v209,v213
v_cvt_pk_bf16_f32 v47,v217,v221
s_add_u32 s62,s69,278528
buffer_store_dwordx4 v[44:47],v5,s[8:11],s62 offen sc1
v_cvt_pk_bf16_f32 v48,v194,v198
v_cvt_pk_bf16_f32 v49,v202,v206
v_cvt_pk_bf16_f32 v50,v210,v214
v_cvt_pk_bf16_f32 v51,v218,v222
s_add_u32 s62,s69,294912
buffer_store_dwordx4 v[48:51],v5,s[8:11],s62 offen sc1
v_cvt_pk_bf16_f32 v52,v195,v199
v_cvt_pk_bf16_f32 v53,v203,v207
v_cvt_pk_bf16_f32 v54,v211,v215
v_cvt_pk_bf16_f32 v55,v219,v223
s_add_u32 s62,s69,311296
buffer_store_dwordx4 v[52:55],v5,s[8:11],s62 offen sc1
s_cmp_lg_u32 s72,0
s_cbranch_scc1 L_aa_296
s_waitcnt vmcnt(8)
L_aa_306:
s_barrier
s_cmp_lt_u32 s30,s31
s_cbranch_scc1 L_ao_311
s_xor_b32 s67,s67,65536
s_and_b32 s56,s50,2048
s_lshl_b32 s56,s56,4
s_add_u32 s56,s56,s67
v_add_u32 v2,s56,v0
v_add_u32 v239,s56,v253
s_and_b32 s56,s50,1024
s_lshl_b32 s56,s56,2
v_add_u32 v238,s56,v2
s_mov_b32 s76,s71
s_mov_b32 s53,s77
ds_read_b128 v[24:27],v238 offset:16384
ds_read_b128 v[40:43],v2 offset:0
ds_read_b128 v[56:59],v2 offset:4096
ds_read_b128 v[28:31],v238 offset:17408
ds_read_b128 v[44:47],v2 offset:1024
ds_read_b128 v[60:63],v2 offset:5120
ds_read_b128 v[32:35],v238 offset:18432
ds_read_b128 v[48:51],v2 offset:2048
ds_read_b128 v[64:67],v2 offset:6144
ds_read_b128 v[36:39],v238 offset:19456
ds_read_b128 v[52:55],v2 offset:3072
ds_read_b128 v[68:71],v2 offset:7168
s_waitcnt lgkmcnt(9)
v_mfma_f32_16x16x32_bf16 v[128:131],v[40:43],v[24:27],v[8:11]
ds_read_b128 v[72:75],v2 offset:24576
v_mfma_f32_16x16x32_bf16 v[132:135],v[56:59],v[24:27],v[12:15]
ds_read_b128 v[76:79],v2 offset:25600
s_waitcnt lgkmcnt(8)
v_mfma_f32_16x16x32_bf16 v[128:131],v[44:47],v[28:31],v[128:131]
ds_read_b128 v[80:83],v2 offset:26624
v_mfma_f32_16x16x32_bf16 v[132:135],v[60:63],v[28:31],v[132:135]
ds_read_b128 v[84:87],v2 offset:27648
s_waitcnt lgkmcnt(7)
v_mfma_f32_16x16x32_bf16 v[128:131],v[48:51],v[32:35],v[128:131]
ds_read_b64 v[120:121],v239 offset:24576
v_mfma_f32_16x16x32_bf16 v[132:135],v[64:67],v[32:35],v[132:135]
ds_read_b64 v[122:123],v239 offset:25600
s_waitcnt lgkmcnt(6)
v_mfma_f32_16x16x32_bf16 v[128:131],v[52:55],v[36:39],v[128:131]
ds_read_b64 v[124:125],v239 offset:26624
v_mfma_f32_16x16x32_bf16 v[132:135],v[68:71],v[36:39],v[132:135]
ds_read_b64 v[126:127],v239 offset:27648
s_waitcnt lgkmcnt(4)
v_mfma_f32_16x16x32_bf16 v[136:139],v[72:75],v[24:27],0
ds_read_b128 v[88:91],v2 offset:8192
ds_read_b128 v[92:95],v2 offset:9216
v_mfma_f32_16x16x32_bf16 v[136:139],v[76:79],v[28:31],v[136:139]
ds_read_b128 v[96:99],v2 offset:10240
ds_read_b128 v[100:103],v2 offset:11264
v_mfma_f32_16x16x32_bf16 v[136:139],v[80:83],v[32:35],v[136:139]
ds_read_b128 v[104:107],v2 offset:12288
ds_read_b128 v[108:111],v2 offset:13312
v_mfma_f32_16x16x32_bf16 v[136:139],v[84:87],v[36:39],v[136:139]
ds_read_b128 v[112:115],v2 offset:14336
ds_read_b128 v[116:119],v2 offset:15360
s_cmp_eq_u32 s30,0
s_cbranch_scc1 L_aa_295
v_max3_u32 v238,v72,v73,v74
v_max3_u32 v238,v74,v75,v238
v_max3_u32 v238,v76,v77,v238
v_max3_u32 v238,v78,v79,v238
v_max3_u32 v238,v80,v81,v238
v_max3_u32 v238,v82,v83,v238
v_max3_u32 v238,v84,v85,v238
v_max3_u32 v238,v86,v87,v238
s_waitcnt lgkmcnt(8)
v_max3_u32 v238,v120,v121,v238
v_max3_u32 v238,v122,v123,v238
v_max3_u32 v238,v124,v125,v238
v_max3_u32 v238,v126,v127,v238
v_cmp_eq_u32 vcc,-1,v238
s_cmp_lg_u64 vcc,0
s_cselect_b32 s27,1,0
s_andn2_b32 s57,s27,s31
s_add_u32 s66,s66,4
s_bfe_u32 s56,s66,0x10002
s_bitset0_b32 s37,s56
s_lshl_b32 s56,s57,s56
s_or_b32 s37,s37,s56
s_or_b32 s56,s37,s66
v_mov_b32 v22,s56
s_xor_b32 s69,s69,524288
s_waitcnt vmcnt(0) lgkmcnt(0)
buffer_store_dword v22,off,s[8:11],s74 sc1
s_cmp_lg_u32 s86,1536
s_cbranch_scc1 L_ae_314
s_mov_b32 s77,s35
s_mov_b32 s30,0
s_lshl_b32 s56,s77,5
s_add_u32 s56,s56,s68
s_mul_i32 s70,s56,24576
s_lshl_b32 s71,s56,12
s_lshl_b32 s59,s77,13
s_lshl2_add_u32 s59,s68,s59
s_add_u32 s59,s59,10485760
s_buffer_load_dword s32,s[8:11],s59
s_mov_b32 s33,1
s_add_u32 s70,s70,100663296
s_add_u32 s71,s71,41943040
v_mov_b32 v19,s59
s_branch L_af_315
L_ae_314:
s_ff1_i32_b64 s77,s[84:85]
s_bitset0_b64 s[84:85],s77
s_min_u32 s77,s77,64
s_lshr_b32 s61,s55,5
s_lshl_b32 s56,s77,5
s_add_u32 s56,s56,s68
s_mul_i32 s70,s56,24576
s_lshl_b32 s71,s56,12
s_lshl_b32 s59,s77,13
s_lshl2_add_u32 s59,s68,s59
s_add_u32 s59,s59,10486144
s_cmp_lt_u32 s77,s61
s_cselect_b32 s57,0,16777216
s_mov_b32 s60,s59
s_buffer_load_dword s33,s[8:11],s60
s_add_u32 s71,s71,s57
s_add_u32 s71,s71,58720256
s_cmp_eq_u32 s77,s61
s_cselect_b32 s57,50331648,0
s_cselect_b32 s58,1536,0
s_add_u32 s59,s59,s58
s_buffer_load_dword s32,s[8:11],s59
s_add_u32 s70,s70,s57
s_add_u32 s70,s70,150994944
v_mov_b32 v19,s59
v_writelane_b32 v19,s60,1
L_af_315:
s_and_b32 s27,s27,s31
s_cbranch_scc1 L_ac_316
L_acb_317:
v_max3_f32 v238,v128,v129,v130
v_max3_f32 v239,v131,v132,v133
v_max3_f32 v238,v134,v135,v238
v_max3_f32 v239,v138,v139,v239
v_max_f32 v238,v238,v239
v_max_f32 v239,v238,v239
v_pk_mul_f32 v[128:129],v[128:129],v[152:153] op_sel_hi:[1,0]
v_pk_mul_f32 v[130:131],v[130:131],v[152:153] op_sel_hi:[1,0]
v_permlane16_swap_b32 v238,v239
v_max_f32 v238,v238,v239
v_max_f32 v239,v238,v239
v_pk_mul_f32 v[132:133],v[132:133],v[152:153] op_sel_hi:[1,0]
v_pk_mul_f32 v[134:135],v[134:135],v[152:153] op_sel_hi:[1,0]
v_permlane32_swap_b32 v238,v239
v_max_f32 v238,v238,v239
v_mul_f32 v238,v152,v238
v_pk_mul_f32 v[138:139],v[138:139],v[152:153] op_sel_hi:[1,0]
buffer_load_dword v17,v16,s[8:11],s87 offen sc1
v_pk_add_f32 v[128:129],v[128:129],v[238:239] op_sel_hi:[1,0] neg_lo:[0,1] neg_hi:[0,1]
v_pk_add_f32 v[130:131],v[130:131],v[238:239] op_sel_hi:[1,0] neg_lo:[0,1] neg_hi:[0,1]
v_pk_add_f32 v[132:133],v[132:133],v[238:239] op_sel_hi:[1,0] neg_lo:[0,1] neg_hi:[0,1]
v_pk_add_f32 v[134:135],v[134:135],v[238:239] op_sel_hi:[1,0] neg_lo:[0,1] neg_hi:[0,1]
v_pk_add_f32 v[138:139],v[138:139],v[238:239] op_sel_hi:[1,0] neg_lo:[0,1] neg_hi:[0,1]
v_exp_f32 v128,v128
v_exp_f32 v129,v129
v_exp_f32 v130,v130
v_exp_f32 v131,v131
v_exp_f32 v132,v132
v_exp_f32 v133,v133
v_exp_f32 v134,v134
v_exp_f32 v135,v135
v_exp_f32 v138,v138
v_exp_f32 v139,v139
v_pk_add_f32 v[148:149],v[128:129],v[130:131]
v_pk_add_f32 v[150:151],v[132:133],v[134:135]
v_pk_add_f32 v[148:149],v[148:149],v[138:139]
v_pk_add_f32 v[148:149],v[148:149],v[150:151]
v_add_f32 v150,v148,v149
v_add_f32 v151,v148,v149
s_nop 1
v_permlane16_swap_b32 v150,v151
v_add_f32 v148,v150,v151
v_add_f32 v149,v150,v151
s_nop 1
v_permlane32_swap_b32 v148,v149
v_add_f32 v148,v148,v149
v_rcp_f32 v148,v148
s_waitcnt vmcnt(0)
v_cmp_gt_u32 vcc,s66,v17
v_pk_mul_f32 v[138:139],v[138:139],v[148:149] op_sel_hi:[1,0]
v_pk_mul_f32 v[128:129],v[128:129],v[148:149] op_sel_hi:[1,0]
v_pk_mul_f32 v[130:131],v[130:131],v[148:149] op_sel_hi:[1,0]
v_pk_mul_f32 v[132:133],v[132:133],v[148:149] op_sel_hi:[1,0]
v_pk_mul_f32 v[134:135],v[134:135],v[148:149] op_sel_hi:[1,0]
s_cbranch_vccnz L_ap_319
L_apb_320:
s_xor_b32 s34,s69,524288
buffer_load_dwordx4 v[192:195],v7,s[8:11],s34 offen sc1
s_bfe_u32 s56,s66,0x10002
v_lshrrev_b32 v238,s56,v17
v_and_b32 v238,1,v238
v_cmp_ne_u32 vcc,0,v238
v_cvt_pk_bf16_f32 v144,v138,v139
v_cvt_pk_bf16_f32 v147,v138,v139
v_cvt_pk_bf16_f32 v140,v128,v129
v_cvt_pk_bf16_f32 v141,v130,v131
v_cvt_pk_bf16_f32 v142,v132,v133
v_cvt_pk_bf16_f32 v143,v134,v135
s_cbranch_vccnz L_ak_313
s_add_u32 s36,s36,4
v_mfma_f32_16x16x16_bf16 v[24:27],v[120:121],v[144:145],0
s_add_u32 s34,s34,4096
v_mfma_f32_16x16x16_bf16 v[28:31],v[120:121],v[146:147],0
buffer_load_dwordx4 v[196:199],v7,s[8:11],s34 offen sc1
v_mfma_f32_16x16x16_bf16 v[32:35],v[122:123],v[144:145],0
s_add_u32 s34,s34,4096
v_mfma_f32_16x16x16_bf16 v[36:39],v[122:123],v[146:147],0
buffer_load_dwordx4 v[200:203],v7,s[8:11],s34 offen sc1
v_mfma_f32_16x16x16_bf16 v[40:43],v[124:125],v[144:145],0
s_add_u32 s34,s34,4096
v_mfma_f32_16x16x16_bf16 v[44:47],v[124:125],v[146:147],0
buffer_load_dwordx4 v[204:207],v7,s[8:11],s34 offen sc1
v_mfma_f32_16x16x16_bf16 v[48:51],v[126:127],v[144:145],0
s_add_u32 s34,s34,4096
v_mfma_f32_16x16x16_bf16 v[52:55],v[126:127],v[146:147],0
buffer_load_dwordx4 v[208:211],v7,s[8:11],s34 offen sc1
v_mfma_f32_16x16x32_bf16 v[24:27],v[88:91],v[140:143],v[24:27]
s_add_u32 s34,s34,4096
v_mfma_f32_16x16x32_bf16 v[28:31],v[92:95],v[140:143],v[28:31]
buffer_load_dwordx4 v[212:215],v7,s[8:11],s34 offen sc1
v_mfma_f32_16x16x32_bf16 v[32:35],v[96:99],v[140:143],v[32:35]
s_add_u32 s34,s34,4096
v_mfma_f32_16x16x32_bf16 v[36:39],v[100:103],v[140:143],v[36:39]
buffer_load_dwordx4 v[216:219],v7,s[8:11],s34 offen sc1
v_cvt_pk_bf16_f32 v72,v24,v28
v_cvt_pk_bf16_f32 v73,v25,v29
v_mfma_f32_16x16x32_bf16 v[40:43],v[104:107],v[140:143],v[40:43]
s_add_u32 s34,s34,4096
v_cvt_pk_bf16_f32 v74,v26,v30
v_cvt_pk_bf16_f32 v75,v27,v31
v_mfma_f32_16x16x32_bf16 v[44:47],v[108:111],v[140:143],v[44:47]
ds_write_b128 v3,v[72:75] offset:0
v_cvt_pk_bf16_f32 v76,v32,v36
v_cvt_pk_bf16_f32 v77,v33,v37
v_mfma_f32_16x16x32_bf16 v[48:51],v[112:115],v[140:143],v[48:51]
buffer_load_dwordx4 v[220:223],v7,s[8:11],s34 offen sc1
v_cvt_pk_bf16_f32 v78,v34,v38
v_cvt_pk_bf16_f32 v79,v35,v39
v_mfma_f32_16x16x32_bf16 v[52:55],v[116:119],v[140:143],v[52:55]
ds_write_b128 v3,v[76:79] offset:1024
v_cvt_pk_bf16_f32 v80,v40,v44
v_cvt_pk_bf16_f32 v81,v41,v45
v_cvt_pk_bf16_f32 v82,v42,v46
v_cvt_pk_bf16_f32 v83,v43,v47
ds_write_b128 v3,v[80:83] offset:2048
s_nop 1
v_cvt_pk_bf16_f32 v84,v48,v52
v_cvt_pk_bf16_f32 v85,v49,v53
v_cvt_pk_bf16_f32 v86,v50,v54
v_cvt_pk_bf16_f32 v87,v51,v55
ds_write_b128 v3,v[84:87] offset:3072
s_cmp_eq_u32 s31,0
s_cbranch_scc1 L_ah_318
s_waitcnt lgkmcnt(0)
s_barrier
s_mov_b32 s26,s51
s_mov_b32 s51,s53
s_branch L_aa_307
L_ah_318:
s_waitcnt vmcnt(7)
v_mfma_f32_16x16x32_bf16 v[160:163],v[156:159],v[192:195],0
s_waitcnt vmcnt(6)
v_mfma_f32_16x16x32_bf16 v[160:163],v[156:159],v[196:199],v[160:163]
s_waitcnt vmcnt(5)
v_mfma_f32_16x16x32_bf16 v[160:163],v[156:159],v[200:203],v[160:163]
s_waitcnt vmcnt(4)
v_mfma_f32_16x16x32_bf16 v[160:163],v[156:159],v[204:207],v[160:163]
s_waitcnt vmcnt(3)
v_mfma_f32_16x16x32_bf16 v[164:167],v[156:159],v[208:211],0
s_waitcnt vmcnt(2)
v_mfma_f32_16x16x32_bf16 v[164:167],v[156:159],v[212:215],v[164:167]
s_waitcnt vmcnt(1)
v_mfma_f32_16x16x32_bf16 v[164:167],v[156:159],v[216:219],v[164:167]
ds_write_b128 v6,v[160:163]
s_waitcnt vmcnt(0)
v_mfma_f32_16x16x32_bf16 v[164:167],v[156:159],v[220:223],v[164:167]
s_nop 7
ds_write_b128 v6,v[164:167] offset:2048
s_waitcnt lgkmcnt(0)
s_barrier
buffer_store_dword v20,off,s[8:11],s73 sc1
s_mov_b32 s73,0x80000000
s_mov_b32 s27,1
s_branch L_aa_298
L_ao_311:
s_xor_b32 s67,s67,65536
s_and_b32 s56,s50,2048
s_lshl_b32 s56,s56,4
s_add_u32 s56,s56,s67
v_add_u32 v2,s56,v0
v_add_u32 v239,s56,v253
s_and_b32 s56,s50,1024
s_lshl_b32 s56,s56,2
v_add_u32 v238,s56,v2
s_mov_b32 s76,s71
s_mov_b32 s53,s77
ds_read_b128 v[24:27],v238 offset:16384
ds_read_b128 v[40:43],v2 offset:0
ds_read_b128 v[56:59],v2 offset:4096
ds_read_b128 v[28:31],v238 offset:17408
ds_read_b128 v[44:47],v2 offset:1024
ds_read_b128 v[60:63],v2 offset:5120
ds_read_b128 v[32:35],v238 offset:18432
ds_read_b128 v[48:51],v2 offset:2048
ds_read_b128 v[64:67],v2 offset:6144
ds_read_b128 v[36:39],v238 offset:19456
ds_read_b128 v[52:55],v2 offset:3072
ds_read_b128 v[68:71],v2 offset:7168
buffer_load_dwordx4 v[72:75],v0,s[8:11],s76 offen offset:0 sc1
buffer_load_dwordx4 v[76:79],v0,s[8:11],s76 offen offset:1024 sc1
buffer_load_dwordx4 v[80:83],v0,s[8:11],s76 offen offset:2048 sc1
buffer_load_dwordx4 v[84:87],v0,s[8:11],s76 offen offset:3072 sc1
buffer_load_dwordx2 v[120:121],v253,s[8:11],s76 offen offset:0 sc1
buffer_load_dwordx2 v[122:123],v253,s[8:11],s76 offen offset:1024 sc1
buffer_load_dwordx2 v[124:125],v253,s[8:11],s76 offen offset:2048 sc1
buffer_load_dwordx2 v[126:127],v253,s[8:11],s76 offen offset:3072 sc1
s_waitcnt lgkmcnt(9)
v_mfma_f32_16x16x32_bf16 v[128:131],v[40:43],v[24:27],v[8:11]
ds_read_b128 v[88:91],v2 offset:8192
v_mfma_f32_16x16x32_bf16 v[132:135],v[56:59],v[24:27],v[12:15]
ds_read_b128 v[92:95],v2 offset:9216
s_waitcnt lgkmcnt(8)
v_mfma_f32_16x16x32_bf16 v[128:131],v[44:47],v[28:31],v[128:131]
ds_read_b128 v[96:99],v2 offset:10240
v_mfma_f32_16x16x32_bf16 v[132:135],v[60:63],v[28:31],v[132:135]
ds_read_b128 v[100:103],v2 offset:11264
s_waitcnt lgkmcnt(7)
v_mfma_f32_16x16x32_bf16 v[128:131],v[48:51],v[32:35],v[128:131]
ds_read_b128 v[104:107],v2 offset:12288
v_mfma_f32_16x16x32_bf16 v[132:135],v[64:67],v[32:35],v[132:135]
ds_read_b128 v[108:111],v2 offset:13312
s_waitcnt lgkmcnt(6)
v_mfma_f32_16x16x32_bf16 v[128:131],v[52:55],v[36:39],v[128:131]
ds_read_b128 v[112:115],v2 offset:14336
v_mfma_f32_16x16x32_bf16 v[132:135],v[68:71],v[36:39],v[132:135]
ds_read_b128 v[116:119],v2 offset:15360
s_add_u32 s66,s66,4
s_bfe_u32 s56,s66,0x10002
s_bitset0_b32 s37,s56
s_lshl_b32 s56,0,s56
s_or_b32 s37,s37,s56
s_or_b32 s56,s37,s66
v_mov_b32 v22,s56
s_xor_b32 s69,s69,524288
s_waitcnt vmcnt(8) lgkmcnt(0)
buffer_store_dword v22,off,s[8:11],s74 sc1
s_mov_b32 s26,s51
s_mov_b32 s27,3
s_branch L_aa_302
L_aa_295:
s_add_u32 s66,s66,4
s_bfe_u32 s56,s66,0x10002
s_bitset0_b32 s37,s56
s_lshl_b32 s56,0,s56
s_or_b32 s37,s37,s56
s_or_b32 s56,s37,s66
v_mov_b32 v22,s56
s_xor_b32 s69,s69,524288
s_waitcnt vmcnt(0) lgkmcnt(0)
buffer_store_dword v22,off,s[8:11],s74 sc1
L_aq_321:
buffer_load_dword v17,v16,s[8:11],s87 offen sc1
s_sub_u32 s49,s49,1
s_cbranch_scc1 L_abort2
s_waitcnt vmcnt(0)
v_cmp_gt_u32 vcc,s66,v17
s_cbranch_vccnz L_aq_321
s_xor_b32 s34,s69,524288
buffer_load_dwordx4 v[160:163],v7,s[8:11],s34 offen sc1
s_add_u32 s34,s34,4096
buffer_load_dwordx4 v[164:167],v7,s[8:11],s34 offen sc1
s_add_u32 s34,s34,4096
buffer_load_dwordx4 v[168:171],v7,s[8:11],s34 offen sc1
s_add_u32 s34,s34,4096
buffer_load_dwordx4 v[172:175],v7,s[8:11],s34 offen sc1
s_add_u32 s34,s34,4096
buffer_load_dwordx4 v[176:179],v7,s[8:11],s34 offen sc1
s_add_u32 s34,s34,4096
buffer_load_dwordx4 v[180:183],v7,s[8:11],s34 offen sc1
s_add_u32 s34,s34,4096
buffer_load_dwordx4 v[184:187],v7,s[8:11],s34 offen sc1
s_add_u32 s34,s34,4096
buffer_load_dwordx4 v[188:191],v7,s[8:11],s34 offen sc1
buffer_load_dwordx4 v[72:75],v0,s[8:11],s76 offen offset:0 sc1
buffer_load_dwordx4 v[76:79],v0,s[8:11],s76 offen offset:1024 sc1
buffer_load_dwordx4 v[80:83],v0,s[8:11],s76 offen offset:2048 sc1
buffer_load_dwordx4 v[84:87],v0,s[8:11],s76 offen offset:3072 sc1
buffer_load_dwordx2 v[120:121],v253,s[8:11],s76 offen offset:0 sc1
buffer_load_dwordx2 v[122:123],v253,s[8:11],s76 offen offset:1024 sc1
buffer_load_dwordx2 v[124:125],v253,s[8:11],s76 offen offset:2048 sc1
buffer_load_dwordx2 v[126:127],v253,s[8:11],s76 offen offset:3072 sc1
s_waitcnt vmcnt(15)
v_mfma_f32_16x16x32_bf16 v[192:195],v[156:159],v[160:163],0
s_waitcnt vmcnt(14)
v_mfma_f32_16x16x32_bf16 v[192:195],v[156:159],v[164:167],v[192:195]
s_waitcnt vmcnt(13)
v_mfma_f32_16x16x32_bf16 v[192:195],v[156:159],v[168:171],v[192:195]
s_waitcnt vmcnt(12)
v_mfma_f32_16x16x32_bf16 v[192:195],v[156:159],v[172:175],v[192:195]
s_waitcnt vmcnt(11)
v_mfma_f32_16x16x32_bf16 v[196:199],v[156:159],v[176:179],0
s_waitcnt vmcnt(10)
v_mfma_f32_16x16x32_bf16 v[196:199],v[156:159],v[180:183],v[196:199]
s_waitcnt vmcnt(9)
v_mfma_f32_16x16x32_bf16 v[196:199],v[156:159],v[184:187],v[196:199]
ds_write_b128 v6,v[192:195]
s_waitcnt vmcnt(8)
v_mfma_f32_16x16x32_bf16 v[196:199],v[156:159],v[188:191],v[196:199]
s_nop 7
ds_write_b128 v6,v[196:199] offset:2048
s_waitcnt lgkmcnt(0)
s_barrier
buffer_store_dword v20,off,s[8:11],s73 sc1
s_mov_b32 s73,0x80000000
s_mov_b32 s27,0
s_branch L_aa_298
L_aa_296:
s_add_u32 s56,s30,s86
s_cmp_lg_u32 s56,1537
s_cbranch_scc1 L_al_312
s_add_u32 s66,s66,4
s_bfe_u32 s56,s66,0x10002
s_bitset0_b32 s37,s56
s_lshl_b32 s56,1,s56
s_or_b32 s37,s37,s56
s_or_b32 s56,s37,s66
v_mov_b32 v22,s56
s_xor_b32 s69,s69,524288
s_waitcnt vmcnt(0) lgkmcnt(0)
buffer_store_dword v22,off,s[8:11],s74 sc1
s_cmp_lg_u32 s86,1536
s_cbranch_scc1 L_ae_322
s_mov_b32 s77,s35
s_mov_b32 s30,0
s_lshl_b32 s56,s77,5
s_add_u32 s56,s56,s68
s_mul_i32 s70,s56,24576
s_lshl_b32 s71,s56,12
s_lshl_b32 s59,s77,13
s_lshl2_add_u32 s59,s68,s59
s_add_u32 s59,s59,10485760
s_buffer_load_dword s32,s[8:11],s59
s_mov_b32 s33,1
s_add_u32 s70,s70,100663296
s_add_u32 s71,s71,41943040
v_mov_b32 v19,s59
s_branch L_af_323
L_ae_322:
s_ff1_i32_b64 s77,s[84:85]
s_bitset0_b64 s[84:85],s77
s_min_u32 s77,s77,64
s_lshr_b32 s61,s55,5
s_lshl_b32 s56,s77,5
s_add_u32 s56,s56,s68
s_mul_i32 s70,s56,24576
s_lshl_b32 s71,s56,12
s_lshl_b32 s59,s77,13
s_lshl2_add_u32 s59,s68,s59
s_add_u32 s59,s59,10486144
s_cmp_lt_u32 s77,s61
s_cselect_b32 s57,0,16777216
s_mov_b32 s60,s59
s_buffer_load_dword s33,s[8:11],s60
s_add_u32 s71,s71,s57
s_add_u32 s71,s71,58720256
s_cmp_eq_u32 s77,s61
s_cselect_b32 s57,50331648,0
s_cselect_b32 s58,1536,0
s_add_u32 s59,s59,s58
s_buffer_load_dword s32,s[8:11],s59
s_add_u32 s70,s70,s57
s_add_u32 s70,s70,150994944
v_mov_b32 v19,s59
v_writelane_b32 v19,s60,1
L_af_323:
s_branch L_ak_313
L_al_312:
s_add_u32 s66,s66,4
s_bfe_u32 s56,s66,0x10002
s_bitset0_b32 s37,s56
s_lshl_b32 s56,0,s56
s_or_b32 s37,s37,s56
s_or_b32 s56,s37,s66
v_mov_b32 v22,s56
s_xor_b32 s69,s69,524288
s_waitcnt vmcnt(0) lgkmcnt(0)
buffer_store_dword v22,off,s[8:11],s74 sc1
L_ak_313:
L_aq_324:
buffer_load_dword v17,v16,s[8:11],s87 offen sc1
s_sub_u32 s49,s49,1
s_cbranch_scc1 L_abort2
s_waitcnt vmcnt(0)
v_cmp_gt_u32 vcc,s66,v17
s_cbranch_vccnz L_aq_324
s_xor_b32 s34,s69,524288
buffer_load_dwordx4 v[160:163],v7,s[8:11],s34 offen sc1
s_add_u32 s34,s34,4096
buffer_load_dwordx4 v[164:167],v7,s[8:11],s34 offen sc1
s_add_u32 s34,s34,4096
buffer_load_dwordx4 v[168:171],v7,s[8:11],s34 offen sc1
s_add_u32 s34,s34,4096
buffer_load_dwordx4 v[172:175],v7,s[8:11],s34 offen sc1
s_add_u32 s34,s34,4096
buffer_load_dwordx4 v[176:179],v7,s[8:11],s34 offen sc1
s_add_u32 s34,s34,4096
buffer_load_dwordx4 v[180:183],v7,s[8:11],s34 offen sc1
s_add_u32 s34,s34,4096
buffer_load_dwordx4 v[184:187],v7,s[8:11],s34 offen sc1
s_add_u32 s34,s34,4096
buffer_load_dwordx4 v[188:191],v7,s[8:11],s34 offen sc1
s_waitcnt vmcnt(7)
v_mfma_f32_16x16x32_bf16 v[192:195],v[156:159],v[160:163],0
s_waitcnt vmcnt(6)
v_mfma_f32_16x16x32_bf16 v[192:195],v[156:159],v[164:167],v[192:195]
s_waitcnt vmcnt(5)
v_mfma_f32_16x16x32_bf16 v[192:195],v[156:159],v[168:171],v[192:195]
s_waitcnt vmcnt(4)
v_mfma_f32_16x16x32_bf16 v[192:195],v[156:159],v[172:175],v[192:195]
s_waitcnt vmcnt(3)
v_mfma_f32_16x16x32_bf16 v[196:199],v[156:159],v[176:179],0
s_waitcnt vmcnt(2)
v_mfma_f32_16x16x32_bf16 v[196:199],v[156:159],v[180:183],v[196:199]
s_waitcnt vmcnt(1)
v_mfma_f32_16x16x32_bf16 v[196:199],v[156:159],v[184:187],v[196:199]
ds_write_b128 v6,v[192:195]
s_waitcnt vmcnt(0)
v_mfma_f32_16x16x32_bf16 v[196:199],v[156:159],v[188:191],v[196:199]
s_nop 7
ds_write_b128 v6,v[196:199] offset:2048
s_waitcnt lgkmcnt(0)
s_barrier
buffer_store_dword v20,off,s[8:11],s73 sc1
s_mov_b32 s73,0x80000000
s_mov_b32 s27,2
L_aa_298:
s_cmp_lg_u32 s31,0
s_cbranch_scc1 L_ar_327
s_bitcmp1_b32 s46,0
s_cbranch_scc1 L_ar_326
L_ar_325:
ds_read_b128 v[160:163],v23
ds_read_b128 v[164:167],v23 offset:16
v_lshlrev_b32 v200,16,v224
v_and_b32 v201,0xffff0000,v224
v_lshlrev_b32 v202,16,v225
v_and_b32 v203,0xffff0000,v225
v_lshlrev_b32 v204,16,v226
v_and_b32 v205,0xffff0000,v226
v_lshlrev_b32 v206,16,v227
v_and_b32 v207,0xffff0000,v227
s_lshl_b32 s18,s51,5
s_add_u32 s18,s18,s68
s_lshl_b32 s19,s18,10
s_add_u32 s20,s19,8388608
s_waitcnt lgkmcnt(0)
v_cvt_pk_bf16_f32 v168,v160,v161
v_cvt_pk_bf16_f32 v169,v162,v163
v_cvt_pk_bf16_f32 v170,v164,v165
v_cvt_pk_bf16_f32 v171,v166,v167
v_lshlrev_b32 v160,16,v168
v_and_b32 v161,0xffff0000,v168
v_lshlrev_b32 v162,16,v169
v_and_b32 v163,0xffff0000,v169
v_lshlrev_b32 v164,16,v170
v_and_b32 v165,0xffff0000,v170
v_lshlrev_b32 v166,16,v171
v_and_b32 v167,0xffff0000,v171
v_pk_add_f32 v[200:201],v[200:201],v[160:161]
v_pk_add_f32 v[202:203],v[202:203],v[162:163]
v_pk_add_f32 v[204:205],v[204:205],v[164:165]
v_pk_add_f32 v[206:207],v[206:207],v[166:167]
v_cvt_pk_bf16_f32 v168,v200,v201
v_cvt_pk_bf16_f32 v169,v202,v203
v_cvt_pk_bf16_f32 v170,v204,v205
v_cvt_pk_bf16_f32 v171,v206,v207
v_lshlrev_b32 v200,16,v168
v_and_b32 v201,0xffff0000,v168
v_lshlrev_b32 v202,16,v169
v_and_b32 v203,0xffff0000,v169
v_lshlrev_b32 v204,16,v170
v_and_b32 v205,0xffff0000,v170
v_lshlrev_b32 v206,16,v171
v_and_b32 v207,0xffff0000,v171
v_readfirstlane_b32 s78,v200
s_nop 1
v_pk_add_f32 v[184:185],v[200:201],s[78:79] op_sel_hi:[1,0] neg_lo:[0,1] neg_hi:[0,1]
v_pk_add_f32 v[186:187],v[202:203],s[78:79] op_sel_hi:[1,0] neg_lo:[0,1] neg_hi:[0,1]
v_pk_add_f32 v[188:189],v[204:205],s[78:79] op_sel_hi:[1,0] neg_lo:[0,1] neg_hi:[0,1]
v_pk_add_f32 v[190:191],v[206:207],s[78:79] op_sel_hi:[1,0] neg_lo:[0,1] neg_hi:[0,1]
v_pk_add_f32 v[192:193],v[184:185],v[186:187]
v_pk_mul_f32 v[194:195],v[184:185],v[184:185]
v_pk_add_f32 v[196:197],v[188:189],v[190:191]
v_pk_fma_f32 v[194:195],v[186:187],v[186:187],v[194:195]
v_pk_add_f32 v[192:193],v[192:193],v[196:197]
v_pk_fma_f32 v[194:195],v[188:189],v[188:189],v[194:195]
v_add_f32 v192,v192,v193
v_pk_fma_f32 v[194:195],v[190:191],v[190:191],v[194:195]
v_add_f32 v194,v194,v195
s_nop 1
v_permlane32_swap_b32 v192,v194
v_add_f32 v192,v192,v194
s_nop 1
v_add_f32_dpp v192,v192,v192 row_ror:8 row_mask:0xf bank_mask:0xf
s_nop 1
v_add_f32_dpp v192,v192,v192 row_ror:4 row_mask:0xf bank_mask:0xf
s_nop 1
v_add_f32_dpp v192,v192,v192 row_ror:2 row_mask:0xf bank_mask:0xf
s_nop 1
v_add_f32_dpp v192,v192,v192 row_ror:1 row_mask:0xf bank_mask:0xf
v_mov_b32 v194,v192
s_nop 1
v_permlane16_swap_b32 v192,v194
v_add_f32 v192,v192,v194
v_mul_f32 v192,0x3b000000,v192
v_mov_b32 v194,v192
s_nop 1
v_permlane32_swap_b32 v192,v194
v_fma_f32 v194,-v192,v192,v194
v_add_f32 v192,s78,v192
v_max_f32 v194,0,v194
v_cvt_pk_bf16_f32 v194,v192,v194
v_lshlrev_b32 v192,16,v194
v_and_b32 v194,0xffff0000,v194
v_add_f32 v194,0x3727c5ac,v194
v_cvt_pk_bf16_f32 v194,v194,v194
v_and_b32 v194,0xffff0000,v194
v_sqrt_f32 v194,v194
v_pk_add_f32 v[184:185],v[200:201],v[192:193] op_sel_hi:[1,0] neg_lo:[0,1] neg_hi:[0,1]
v_pk_add_f32 v[186:187],v[202:203],v[192:193] op_sel_hi:[1,0] neg_lo:[0,1] neg_hi:[0,1]
v_pk_add_f32 v[188:189],v[204:205],v[192:193] op_sel_hi:[1,0] neg_lo:[0,1] neg_hi:[0,1]
v_pk_add_f32 v[190:191],v[206:207],v[192:193] op_sel_hi:[1,0] neg_lo:[0,1] neg_hi:[0,1]
v_cvt_pk_bf16_f32 v194,v194,v194
v_and_b32 v194,0xffff0000,v194
v_rcp_f32 v194,v194
v_cvt_pk_bf16_f32 v172,v184,v185
v_cvt_pk_bf16_f32 v173,v186,v187
v_cvt_pk_bf16_f32 v174,v188,v189
v_cvt_pk_bf16_f32 v175,v190,v191
v_lshlrev_b32 v184,16,v172
v_and_b32 v185,0xffff0000,v172
v_lshlrev_b32 v186,16,v173
v_and_b32 v187,0xffff0000,v173
v_lshlrev_b32 v188,16,v174
v_and_b32 v189,0xffff0000,v174
v_lshlrev_b32 v190,16,v175
v_and_b32 v191,0xffff0000,v175
v_pk_mul_f32 v[184:185],v[184:185],v[194:195] op_sel_hi:[1,0]
v_pk_mul_f32 v[186:187],v[186:187],v[194:195] op_sel_hi:[1,0]
v_pk_mul_f32 v[188:189],v[188:189],v[194:195] op_sel_hi:[1,0]
v_pk_mul_f32 v[190:191],v[190:191],v[194:195] op_sel_hi:[1,0]
v_cvt_pk_bf16_f32 v172,v184,v185
v_cvt_pk_bf16_f32 v173,v186,v187
v_cvt_pk_bf16_f32 v174,v188,v189
v_cvt_pk_bf16_f32 v175,v190,v191
v_lshlrev_b32 v176,16,v172
v_and_b32 v177,0xffff0000,v172
v_lshlrev_b32 v178,16,v173
v_and_b32 v179,0xffff0000,v173
v_lshlrev_b32 v180,16,v174
v_and_b32 v181,0xffff0000,v174
v_lshlrev_b32 v182,16,v175
v_and_b32 v183,0xffff0000,v175
v_pk_add_f32 v[200:201],v[200:201],v[176:177]
v_pk_add_f32 v[202:203],v[202:203],v[178:179]
v_pk_add_f32 v[204:205],v[204:205],v[180:181]
v_pk_add_f32 v[206:207],v[206:207],v[182:183]
v_cvt_pk_bf16_f32 v160,v200,v201
v_cvt_pk_bf16_f32 v161,v202,v203
v_cvt_pk_bf16_f32 v162,v204,v205
v_cvt_pk_bf16_f32 v163,v206,v207
buffer_store_dwordx4 v[160:163],v0,s[8:11],s20 offen sc1
v_lshlrev_b32 v200,16,v160
v_and_b32 v201,0xffff0000,v160
v_lshlrev_b32 v202,16,v161
v_and_b32 v203,0xffff0000,v161
v_lshlrev_b32 v204,16,v162
v_and_b32 v205,0xffff0000,v162
v_lshlrev_b32 v206,16,v163
v_and_b32 v207,0xffff0000,v163
v_readfirstlane_b32 s78,v200
s_nop 1
v_pk_add_f32 v[184:185],v[200:201],s[78:79] op_sel_hi:[1,0] neg_lo:[0,1] neg_hi:[0,1]
v_pk_add_f32 v[186:187],v[202:203],s[78:79] op_sel_hi:[1,0] neg_lo:[0,1] neg_hi:[0,1]
v_pk_add_f32 v[188:189],v[204:205],s[78:79] op_sel_hi:[1,0] neg_lo:[0,1] neg_hi:[0,1]
v_pk_add_f32 v[190:191],v[206:207],s[78:79] op_sel_hi:[1,0] neg_lo:[0,1] neg_hi:[0,1]
v_pk_add_f32 v[192:193],v[184:185],v[186:187]
v_pk_mul_f32 v[194:195],v[184:185],v[184:185]
v_pk_add_f32 v[196:197],v[188:189],v[190:191]
v_pk_fma_f32 v[194:195],v[186:187],v[186:187],v[194:195]
v_pk_add_f32 v[192:193],v[192:193],v[196:197]
v_pk_fma_f32 v[194:195],v[188:189],v[188:189],v[194:195]
v_add_f32 v192,v192,v193
v_pk_fma_f32 v[194:195],v[190:191],v[190:191],v[194:195]
v_add_f32 v194,v194,v195
s_nop 1
v_permlane32_swap_b32 v192,v194
v_add_f32 v192,v192,v194
s_nop 1
v_add_f32_dpp v192,v192,v192 row_ror:8 row_mask:0xf bank_mask:0xf
s_nop 1
v_add_f32_dpp v192,v192,v192 row_ror:4 row_mask:0xf bank_mask:0xf
s_nop 1
v_add_f32_dpp v192,v192,v192 row_ror:2 row_mask:0xf bank_mask:0xf
s_nop 1
v_add_f32_dpp v192,v192,v192 row_ror:1 row_mask:0xf bank_mask:0xf
v_mov_b32 v194,v192
s_nop 1
v_permlane16_swap_b32 v192,v194
v_add_f32 v192,v192,v194
v_mul_f32 v192,0x3b000000,v192
v_mov_b32 v194,v192
s_nop 1
v_permlane32_swap_b32 v192,v194
v_fma_f32 v194,-v192,v192,v194
v_add_f32 v192,s78,v192
v_max_f32 v194,0,v194
v_cvt_pk_bf16_f32 v194,v192,v194
v_lshlrev_b32 v192,16,v194
v_and_b32 v194,0xffff0000,v194
v_add_f32 v194,0x3727c5ac,v194
v_cvt_pk_bf16_f32 v194,v194,v194
v_and_b32 v194,0xffff0000,v194
v_sqrt_f32 v194,v194
v_pk_add_f32 v[184:185],v[200:201],v[192:193] op_sel_hi:[1,0] neg_lo:[0,1] neg_hi:[0,1]
v_pk_add_f32 v[186:187],v[202:203],v[192:193] op_sel_hi:[1,0] neg_lo:[0,1] neg_hi:[0,1]
v_pk_add_f32 v[188:189],v[204:205],v[192:193] op_sel_hi:[1,0] neg_lo:[0,1] neg_hi:[0,1]
v_pk_add_f32 v[190:191],v[206:207],v[192:193] op_sel_hi:[1,0] neg_lo:[0,1] neg_hi:[0,1]
v_cvt_pk_bf16_f32 v194,v194,v194
v_and_b32 v194,0xffff0000,v194
v_rcp_f32 v194,v194
v_cvt_pk_bf16_f32 v164,v184,v185
v_cvt_pk_bf16_f32 v165,v186,v187
v_cvt_pk_bf16_f32 v166,v188,v189
v_cvt_pk_bf16_f32 v167,v190,v191
v_lshlrev_b32 v184,16,v164
v_and_b32 v185,0xffff0000,v164
v_lshlrev_b32 v186,16,v165
v_and_b32 v187,0xffff0000,v165
v_lshlrev_b32 v188,16,v166
v_and_b32 v189,0xffff0000,v166
v_lshlrev_b32 v190,16,v167
v_and_b32 v191,0xffff0000,v167
v_pk_mul_f32 v[184:185],v[184:185],v[194:195] op_sel_hi:[1,0]
v_pk_mul_f32 v[186:187],v[186:187],v[194:195] op_sel_hi:[1,0]
v_pk_mul_f32 v[188:189],v[188:189],v[194:195] op_sel_hi:[1,0]
v_pk_mul_f32 v[190:191],v[190:191],v[194:195] op_sel_hi:[1,0]
v_cvt_pk_bf16_f32 v164,v184,v185
v_cvt_pk_bf16_f32 v165,v186,v187
v_cvt_pk_bf16_f32 v166,v188,v189
v_cvt_pk_bf16_f32 v167,v190,v191
s_add_u32 s20,s19,2097152
buffer_store_dwordx4 v[164:167],v0,s[8:11],s20 offen sc1
v_mov_b32 v20,1
s_lshl_b32 s73,s51,13
s_lshl2_add_u32 s73,s68,s73
s_add_u32 s73,s73,10487552
s_branch L_aa_299
L_ar_326:
ds_read_b128 v[160:163],v23
ds_read_b128 v[164:167],v23 offset:16
v_lshlrev_b32 v200,16,v224
v_and_b32 v201,0xffff0000,v224
v_lshlrev_b32 v202,16,v225
v_and_b32 v203,0xffff0000,v225
v_lshlrev_b32 v204,16,v226
v_and_b32 v205,0xffff0000,v226
v_lshlrev_b32 v206,16,v227
v_and_b32 v207,0xffff0000,v227
s_lshl_b32 s18,s51,5
s_add_u32 s18,s18,s68
s_lshl_b32 s19,s18,10
s_add_u32 s20,s19,4194304
s_waitcnt lgkmcnt(0)
v_cvt_pk_bf16_f32 v168,v160,v161
v_cvt_pk_bf16_f32 v169,v162,v163
v_cvt_pk_bf16_f32 v170,v164,v165
v_cvt_pk_bf16_f32 v171,v166,v167
v_lshlrev_b32 v160,16,v168
v_and_b32 v161,0xffff0000,v168
v_lshlrev_b32 v162,16,v169
v_and_b32 v163,0xffff0000,v169
v_lshlrev_b32 v164,16,v170
v_and_b32 v165,0xffff0000,v170
v_lshlrev_b32 v166,16,v171
v_and_b32 v167,0xffff0000,v171
v_pk_add_f32 v[200:201],v[200:201],v[160:161]
v_pk_add_f32 v[202:203],v[202:203],v[162:163]
v_pk_add_f32 v[204:205],v[204:205],v[164:165]
v_pk_add_f32 v[206:207],v[206:207],v[166:167]
v_cvt_pk_bf16_f32 v168,v200,v201
v_cvt_pk_bf16_f32 v169,v202,v203
v_cvt_pk_bf16_f32 v170,v204,v205
v_cvt_pk_bf16_f32 v171,v206,v207
buffer_store_dwordx4 v[168:171],v0,s[8:11],s20 offen sc1
v_lshlrev_b32 v200,16,v168
v_and_b32 v201,0xffff0000,v168
v_lshlrev_b32 v202,16,v169
v_and_b32 v203,0xffff0000,v169
v_lshlrev_b32 v204,16,v170
v_and_b32 v205,0xffff0000,v170
v_lshlrev_b32 v206,16,v171
v_and_b32 v207,0xffff0000,v171
v_readfirstlane_b32 s78,v200
s_nop 1
v_pk_add_f32 v[184:185],v[200:201],s[78:79] op_sel_hi:[1,0] neg_lo:[0,1] neg_hi:[0,1]
v_pk_add_f32 v[186:187],v[202:203],s[78:79] op_sel_hi:[1,0] neg_lo:[0,1] neg_hi:[0,1]
v_pk_add_f32 v[188:189],v[204:205],s[78:79] op_sel_hi:[1,0] neg_lo:[0,1] neg_hi:[0,1]
v_pk_add_f32 v[190:191],v[206:207],s[78:79] op_sel_hi:[1,0] neg_lo:[0,1] neg_hi:[0,1]
v_pk_add_f32 v[192:193],v[184:185],v[186:187]
v_pk_mul_f32 v[194:195],v[184:185],v[184:185]
v_pk_add_f32 v[196:197],v[188:189],v[190:191]
v_pk_fma_f32 v[194:195],v[186:187],v[186:187],v[194:195]
v_pk_add_f32 v[192:193],v[192:193],v[196:197]
v_pk_fma_f32 v[194:195],v[188:189],v[188:189],v[194:195]
v_add_f32 v192,v192,v193
v_pk_fma_f32 v[194:195],v[190:191],v[190:191],v[194:195]
v_add_f32 v194,v194,v195
s_nop 1
v_permlane32_swap_b32 v192,v194
v_add_f32 v192,v192,v194
s_nop 1
v_add_f32_dpp v192,v192,v192 row_ror:8 row_mask:0xf bank_mask:0xf
s_nop 1
v_add_f32_dpp v192,v192,v192 row_ror:4 row_mask:0xf bank_mask:0xf
s_nop 1
v_add_f32_dpp v192,v192,v192 row_ror:2 row_mask:0xf bank_mask:0xf
s_nop 1
v_add_f32_dpp v192,v192,v192 row_ror:1 row_mask:0xf bank_mask:0xf
v_mov_b32 v194,v192
s_nop 1
v_permlane16_swap_b32 v192,v194
v_add_f32 v192,v192,v194
v_mul_f32 v192,0x3b000000,v192
v_mov_b32 v194,v192
s_nop 1
v_permlane32_swap_b32 v192,v194
v_fma_f32 v194,-v192,v192,v194
v_add_f32 v192,s78,v192
v_max_f32 v194,0,v194
v_cvt_pk_bf16_f32 v194,v192,v194
v_lshlrev_b32 v192,16,v194
v_and_b32 v194,0xffff0000,v194
v_add_f32 v194,0x3727c5ac,v194
v_cvt_pk_bf16_f32 v194,v194,v194
v_and_b32 v194,0xffff0000,v194
v_sqrt_f32 v194,v194
v_pk_add_f32 v[184:185],v[200:201],v[192:193] op_sel_hi:[1,0] neg_lo:[0,1] neg_hi:[0,1]
v_pk_add_f32 v[186:187],v[202:203],v[192:193] op_sel_hi:[1,0] neg_lo:[0,1] neg_hi:[0,1]
v_pk_add_f32 v[188:189],v[204:205],v[192:193] op_sel_hi:[1,0] neg_lo:[0,1] neg_hi:[0,1]
v_pk_add_f32 v[190:191],v[206:207],v[192:193] op_sel_hi:[1,0] neg_lo:[0,1] neg_hi:[0,1]
v_cvt_pk_bf16_f32 v194,v194,v194
v_and_b32 v194,0xffff0000,v194
v_rcp_f32 v194,v194
v_cvt_pk_bf16_f32 v172,v184,v185
v_cvt_pk_bf16_f32 v173,v186,v187
v_cvt_pk_bf16_f32 v174,v188,v189
v_cvt_pk_bf16_f32 v175,v190,v191
v_lshlrev_b32 v184,16,v172
v_and_b32 v185,0xffff0000,v172
v_lshlrev_b32 v186,16,v173
v_and_b32 v187,0xffff0000,v173
v_lshlrev_b32 v188,16,v174
v_and_b32 v189,0xffff0000,v174
v_lshlrev_b32 v190,16,v175
v_and_b32 v191,0xffff0000,v175
v_pk_mul_f32 v[184:185],v[184:185],v[194:195] op_sel_hi:[1,0]
v_pk_mul_f32 v[186:187],v[186:187],v[194:195] op_sel_hi:[1,0]
v_pk_mul_f32 v[188:189],v[188:189],v[194:195] op_sel_hi:[1,0]
v_pk_mul_f32 v[190:191],v[190:191],v[194:195] op_sel_hi:[1,0]
v_cvt_pk_bf16_f32 v172,v184,v185
v_cvt_pk_bf16_f32 v173,v186,v187
v_cvt_pk_bf16_f32 v174,v188,v189
v_cvt_pk_bf16_f32 v175,v190,v191
v_lshlrev_b32 v176,16,v172
v_and_b32 v177,0xffff0000,v172
v_lshlrev_b32 v178,16,v173
v_and_b32 v179,0xffff0000,v173
v_lshlrev_b32 v180,16,v174
v_and_b32 v181,0xffff0000,v174
v_lshlrev_b32 v182,16,v175
v_and_b32 v183,0xffff0000,v175
v_pk_mul_f32 v[236:237],v[176:177],v[228:229]
v_pk_fma_f32 v[236:237],v[178:179],v[230:231],v[236:237]
v_pk_fma_f32 v[236:237],v[180:181],v[232:233],v[236:237]
v_pk_fma_f32 v[236:237],v[182:183],v[234:235],v[236:237]
v_add_f32 v236,v236,v237
s_nop 1
v_add_f32_dpp v236,v236,v236 row_ror:8 row_mask:0xf bank_mask:0xf
s_nop 1
v_add_f32_dpp v236,v236,v236 row_ror:4 row_mask:0xf bank_mask:0xf
s_nop 1
v_add_f32_dpp v236,v236,v236 row_ror:2 row_mask:0xf bank_mask:0xf
s_nop 1
v_add_f32_dpp v236,v236,v236 row_ror:1 row_mask:0xf bank_mask:0xf
v_mov_b32 v237,v236
s_nop 1
v_permlane16_swap_b32 v236,v237
v_add_f32 v236,v236,v237
v_mov_b32 v237,v236
s_nop 1
v_permlane32_swap_b32 v236,v237
v_add_f32 v236,v236,v237
v_cvt_pk_bf16_f32 v236,v236,v236
v_and_b32 v236,0xffff0000,v236
v_ashrrev_i32 v237,31,v236
v_or_b32 v237,0x80000000,v237
v_xor_b32 v236,v236,v237
v_and_b32 v236,0xffff0000,v236
s_sub_u32 s20,4095,s18
v_or_b32 v20,s20,v236
s_lshl_b32 s20,s51,13
s_lshl2_add_u32 s20,s68,s20
s_add_u32 s20,s20,10485760
buffer_store_dword v20,v254,s[8:11],s20 offen sc1
s_branch L_aa_299
L_ar_327:
s_bitcmp1_b32 s46,0
s_cbranch_scc1 L_aa_299
ds_read_b128 v[160:163],v23
ds_read_b128 v[164:167],v23 offset:16
v_lshlrev_b32 v200,16,v224
v_and_b32 v201,0xffff0000,v224
v_lshlrev_b32 v202,16,v225
v_and_b32 v203,0xffff0000,v225
v_lshlrev_b32 v204,16,v226
v_and_b32 v205,0xffff0000,v226
v_lshlrev_b32 v206,16,v227
v_and_b32 v207,0xffff0000,v227
v_readfirstlane_b32 s22,v246
s_cmp_eq_u32 s22,0
s_cbranch_scc1 L_ag_328
L_agb_329:
s_lshl_b32 s18,s51,5
s_add_u32 s18,s18,s68
s_lshl_b32 s19,s18,10
s_add_u32 s20,s19,6291456
s_waitcnt lgkmcnt(0)
v_cvt_pk_bf16_f32 v168,v160,v161
v_cvt_pk_bf16_f32 v169,v162,v163
v_cvt_pk_bf16_f32 v170,v164,v165
v_cvt_pk_bf16_f32 v171,v166,v167
v_lshlrev_b32 v160,16,v168
v_and_b32 v161,0xffff0000,v168
v_lshlrev_b32 v162,16,v169
v_and_b32 v163,0xffff0000,v169
v_lshlrev_b32 v164,16,v170
v_and_b32 v165,0xffff0000,v170
v_lshlrev_b32 v166,16,v171
v_and_b32 v167,0xffff0000,v171
v_pk_add_f32 v[200:201],v[200:201],v[160:161]
v_pk_add_f32 v[202:203],v[202:203],v[162:163]
v_pk_add_f32 v[204:205],v[204:205],v[164:165]
v_pk_add_f32 v[206:207],v[206:207],v[166:167]
v_cvt_pk_bf16_f32 v168,v200,v201
v_cvt_pk_bf16_f32 v169,v202,v203
v_cvt_pk_bf16_f32 v170,v204,v205
v_cvt_pk_bf16_f32 v171,v206,v207
buffer_store_dwordx4 v[168:171],v0,s[8:11],s20 offen sc1
v_lshlrev_b32 v200,16,v168
v_and_b32 v201,0xffff0000,v168
v_lshlrev_b32 v202,16,v169
v_and_b32 v203,0xffff0000,v169
v_lshlrev_b32 v204,16,v170
v_and_b32 v205,0xffff0000,v170
v_lshlrev_b32 v206,16,v171
v_and_b32 v207,0xffff0000,v171
v_readfirstlane_b32 s78,v200
s_nop 1
v_pk_add_f32 v[184:185],v[200:201],s[78:79] op_sel_hi:[1,0] neg_lo:[0,1] neg_hi:[0,1]
v_pk_add_f32 v[186:187],v[202:203],s[78:79] op_sel_hi:[1,0] neg_lo:[0,1] neg_hi:[0,1]
v_pk_add_f32 v[188:189],v[204:205],s[78:79] op_sel_hi:[1,0] neg_lo:[0,1] neg_hi:[0,1]
v_pk_add_f32 v[190:191],v[206:207],s[78:79] op_sel_hi:[1,0] neg_lo:[0,1] neg_hi:[0,1]
v_pk_add_f32 v[192:193],v[184:185],v[186:187]
v_pk_mul_f32 v[194:195],v[184:185],v[184:185]
v_pk_add_f32 v[196:197],v[188:189],v[190:191]
v_pk_fma_f32 v[194:195],v[186:187],v[186:187],v[194:195]
v_pk_add_f32 v[192:193],v[192:193],v[196:197]
v_pk_fma_f32 v[194:195],v[188:189],v[188:189],v[194:195]
v_add_f32 v192,v192,v193
v_pk_fma_f32 v[194:195],v[190:191],v[190:191],v[194:195]
v_add_f32 v194,v194,v195
s_nop 1
v_permlane32_swap_b32 v192,v194
v_add_f32 v192,v192,v194
s_nop 1
v_add_f32_dpp v192,v192,v192 row_ror:8 row_mask:0xf bank_mask:0xf
s_nop 1
v_add_f32_dpp v192,v192,v192 row_ror:4 row_mask:0xf bank_mask:0xf
s_nop 1
v_add_f32_dpp v192,v192,v192 row_ror:2 row_mask:0xf bank_mask:0xf
s_nop 1
v_add_f32_dpp v192,v192,v192 row_ror:1 row_mask:0xf bank_mask:0xf
v_mov_b32 v194,v192
s_nop 1
v_permlane16_swap_b32 v192,v194
v_add_f32 v192,v192,v194
v_mul_f32 v192,0x3b000000,v192
v_mov_b32 v194,v192
s_nop 1
v_permlane32_swap_b32 v192,v194
v_fma_f32 v194,-v192,v192,v194
v_add_f32 v192,s78,v192
v_max_f32 v194,0,v194
v_cvt_pk_bf16_f32 v194,v192,v194
v_lshlrev_b32 v192,16,v194
v_and_b32 v194,0xffff0000,v194
v_add_f32 v194,0x3727c5ac,v194
v_cvt_pk_bf16_f32 v194,v194,v194
v_and_b32 v194,0xffff0000,v194
v_sqrt_f32 v194,v194
v_pk_add_f32 v[184:185],v[200:201],v[192:193] op_sel_hi:[1,0] neg_lo:[0,1] neg_hi:[0,1]
v_pk_add_f32 v[186:187],v[202:203],v[192:193] op_sel_hi:[1,0] neg_lo:[0,1] neg_hi:[0,1]
v_pk_add_f32 v[188:189],v[204:205],v[192:193] op_sel_hi:[1,0] neg_lo:[0,1] neg_hi:[0,1]
v_pk_add_f32 v[190:191],v[206:207],v[192:193] op_sel_hi:[1,0] neg_lo:[0,1] neg_hi:[0,1]
v_cvt_pk_bf16_f32 v194,v194,v194
v_and_b32 v194,0xffff0000,v194
v_rcp_f32 v194,v194
v_cvt_pk_bf16_f32 v172,v184,v185
v_cvt_pk_bf16_f32 v173,v186,v187
v_cvt_pk_bf16_f32 v174,v188,v189
v_cvt_pk_bf16_f32 v175,v190,v191
v_lshlrev_b32 v184,16,v172
v_and_b32 v185,0xffff0000,v172
v_lshlrev_b32 v186,16,v173
v_and_b32 v187,0xffff0000,v173
v_lshlrev_b32 v188,16,v174
v_and_b32 v189,0xffff0000,v174
v_lshlrev_b32 v190,16,v175
v_and_b32 v191,0xffff0000,v175
v_pk_mul_f32 v[184:185],v[184:185],v[194:195] op_sel_hi:[1,0]
v_pk_mul_f32 v[186:187],v[186:187],v[194:195] op_sel_hi:[1,0]
v_pk_mul_f32 v[188:189],v[188:189],v[194:195] op_sel_hi:[1,0]
v_pk_mul_f32 v[190:191],v[190:191],v[194:195] op_sel_hi:[1,0]
v_cvt_pk_bf16_f32 v172,v184,v185
v_cvt_pk_bf16_f32 v173,v186,v187
v_cvt_pk_bf16_f32 v174,v188,v189
v_cvt_pk_bf16_f32 v175,v190,v191
v_lshlrev_b32 v176,16,v172
v_and_b32 v177,0xffff0000,v172
v_lshlrev_b32 v178,16,v173
v_and_b32 v179,0xffff0000,v173
v_lshlrev_b32 v180,16,v174
v_and_b32 v181,0xffff0000,v174
v_lshlrev_b32 v182,16,v175
v_and_b32 v183,0xffff0000,v175
v_pk_add_f32 v[200:201],v[200:201],v[176:177]
v_pk_add_f32 v[202:203],v[202:203],v[178:179]
v_pk_add_f32 v[204:205],v[204:205],v[180:181]
v_pk_add_f32 v[206:207],v[206:207],v[182:183]
v_cvt_pk_bf16_f32 v160,v200,v201
v_cvt_pk_bf16_f32 v161,v202,v203
v_cvt_pk_bf16_f32 v162,v204,v205
v_cvt_pk_bf16_f32 v163,v206,v207
buffer_store_dwordx4 v[160:163],v0,s[12:15],s19 offen sc1
v_pk_mul_f32 v[236:237],v[176:177],v[228:229]
v_pk_fma_f32 v[236:237],v[178:179],v[230:231],v[236:237]
v_pk_fma_f32 v[236:237],v[180:181],v[232:233],v[236:237]
v_pk_fma_f32 v[236:237],v[182:183],v[234:235],v[236:237]
v_add_f32 v236,v236,v237
s_nop 1
v_add_f32_dpp v236,v236,v236 row_ror:8 row_mask:0xf bank_mask:0xf
s_nop 1
v_add_f32_dpp v236,v236,v236 row_ror:4 row_mask:0xf bank_mask:0xf
s_nop 1
v_add_f32_dpp v236,v236,v236 row_ror:2 row_mask:0xf bank_mask:0xf
s_nop 1
v_add_f32_dpp v236,v236,v236 row_ror:1 row_mask:0xf bank_mask:0xf
v_mov_b32 v237,v236
s_nop 1
v_permlane16_swap_b32 v236,v237
v_add_f32 v236,v236,v237
v_mov_b32 v237,v236
s_nop 1
v_permlane32_swap_b32 v236,v237
v_add_f32 v236,v236,v237
v_cvt_pk_bf16_f32 v236,v236,v236
v_and_b32 v236,0xffff0000,v236
v_ashrrev_i32 v237,31,v236
v_or_b32 v237,0x80000000,v237
v_xor_b32 v236,v236,v237
v_and_b32 v236,0xffff0000,v236
s_sub_u32 s20,4095,s18
v_or_b32 v20,s20,v236
s_lshl_b32 s73,s51,13
s_lshl2_add_u32 s73,s68,s73
s_add_u32 s73,s73,10485760
s_add_u32 s73,s73,s86
L_aa_299:
s_cmp_eq_u32 s27,1
s_cbranch_scc1 L_ad_330
s_cmp_eq_u32 s27,0
s_cbranch_scc1 L_aa_300
s_cmp_ge_u32 s77,64
s_cbranch_scc1 L_aa_303
L_aa_301:
s_waitcnt vmcnt(0)
buffer_store_dword v20,off,s[8:11],s73 sc1
s_mov_b32 s73,0x80000000
v_mov_b32 v18,0
s_mov_b32 s27,0
L_aw_331:
v_cmp_eq_u32 vcc,0,v18
s_cbranch_vccz L_awd_332
buffer_load_dword v18,v19,s[8:11],0 offen sc1
s_sub_u32 s49,s49,1
s_cbranch_scc1 L_abort2
s_waitcnt vmcnt(0)
s_branch L_aw_331
L_awd_332:
s_mov_b32 s64,s70
s_mov_b32 s65,s71
s_and_b32 s57,s46,1
s_mul_i32 s58,s57,12288
s_add_u32 s64,s64,s58
s_lshl_b32 s57,s57,11
s_add_u32 s65,s65,s57
s_and_b32 s59,s50,2048
s_lshl_b32 s59,s59,4
s_xor_b32 s60,s67,65536
s_add_u32 s59,s59,s60
s_add_u32 s58,s58,s59
s_add_u32 s57,s57,s59
s_add_u32 m0,s58,0
s_nop 0
buffer_load_dwordx4 v0,s[8:11],s64 offen offset:0 sc1 lds
buffer_load_dwordx4 v0,s[8:11],s64 offen offset:1024 sc1 lds
buffer_load_dwordx4 v0,s[8:11],s64 offen offset:2048 sc1 lds
buffer_load_dwordx4 v0,s[8:11],s64 offen offset:3072 sc1 lds
s_add_u32 m0,s58,4096
s_add_u32 s64,s64,4096
buffer_load_dwordx4 v0,s[8:11],s64 offen offset:0 sc1 lds
buffer_load_dwordx4 v0,s[8:11],s64 offen offset:1024 sc1 lds
buffer_load_dwordx4 v0,s[8:11],s64 offen offset:2048 sc1 lds
buffer_load_dwordx4 v0,s[8:11],s64 offen offset:3072 sc1 lds
s_add_u32 m0,s58,8192
s_add_u32 s64,s64,4096
buffer_load_dwordx4 v0,s[8:11],s64 offen offset:0 sc1 lds
buffer_load_dwordx4 v0,s[8:11],s64 offen offset:1024 sc1 lds
buffer_load_dwordx4 v0,s[8:11],s64 offen offset:2048 sc1 lds
buffer_load_dwordx4 v0,s[8:11],s64 offen offset:3072 sc1 lds
s_add_u32 m0,s57,24576
s_nop 0
buffer_load_dwordx4 v0,s[8:11],s65 offen offset:0 sc1 lds
buffer_load_dwordx4 v0,s[8:11],s65 offen offset:1024 sc1 lds
v_lshrrev_b32 v244,4,v1
s_sub_u32 s56,s77,8
v_add_u32 v244,s56,v244
v_max_i32 v244,0,v244
v_lshl_add_u32 v244,v244,13,v21
buffer_load_dwordx2 v[242:243],v244,s[8:11],0 offen sc1
s_waitcnt vmcnt(0) lgkmcnt(0)
s_barrier
s_xor_b32 s67,s67,65536
s_and_b32 s56,s50,2048
s_lshl_b32 s56,s56,4
s_add_u32 s56,s56,s67
v_add_u32 v2,s56,v0
v_add_u32 v239,s56,v253
s_and_b32 s56,s50,1024
s_lshl_b32 s56,s56,2
v_add_u32 v238,s56,v2
s_mov_b32 s76,s71
s_mov_b32 s53,s77
ds_read_b128 v[24:27],v238 offset:16384
ds_read_b128 v[40:43],v2 offset:0
ds_read_b128 v[56:59],v2 offset:4096
ds_read_b128 v[28:31],v238 offset:17408
ds_read_b128 v[44:47],v2 offset:1024
ds_read_b128 v[60:63],v2 offset:5120
ds_read_b128 v[32:35],v238 offset:18432
ds_read_b128 v[48:51],v2 offset:2048
ds_read_b128 v[64:67],v2 offset:6144
ds_read_b128 v[36:39],v238 offset:19456
ds_read_b128 v[52:55],v2 offset:3072
ds_read_b128 v[68:71],v2 offset:7168
s_waitcnt lgkmcnt(9)
v_mfma_f32_16x16x32_bf16 v[128:131],v[40:43],v[24:27],v[8:11]
ds_read_b128 v[72:75],v2 offset:24576
v_mfma_f32_16x16x32_bf16 v[132:135],v[56:59],v[24:27],v[12:15]
ds_read_b128 v[76:79],v2 offset:25600
s_waitcnt lgkmcnt(8)
v_mfma_f32_16x16x32_bf16 v[128:131],v[44:47],v[28:31],v[128:131]
ds_read_b128 v[80:83],v2 offset:26624
v_mfma_f32_16x16x32_bf16 v[132:135],v[60:63],v[28:31],v[132:135]
ds_read_b128 v[84:87],v2 offset:27648
s_waitcnt lgkmcnt(7)
v_mfma_f32_16x16x32_bf16 v[128:131],v[48:51],v[32:35],v[128:131]
ds_read_b64 v[120:121],v239 offset:24576
v_mfma_f32_16x16x32_bf16 v[132:135],v[64:67],v[32:35],v[132:135]
ds_read_b64 v[122:123],v239 offset:25600
s_waitcnt lgkmcnt(6)
v_mfma_f32_16x16x32_bf16 v[128:131],v[52:55],v[36:39],v[128:131]
ds_read_b64 v[124:125],v239 offset:26624
v_mfma_f32_16x16x32_bf16 v[132:135],v[68:71],v[36:39],v[132:135]
ds_read_b64 v[126:127],v239 offset:27648
s_waitcnt lgkmcnt(4)
v_mfma_f32_16x16x32_bf16 v[136:139],v[72:75],v[24:27],0
ds_read_b128 v[88:91],v2 offset:8192
ds_read_b128 v[92:95],v2 offset:9216
v_mfma_f32_16x16x32_bf16 v[136:139],v[76:79],v[28:31],v[136:139]
ds_read_b128 v[96:99],v2 offset:10240
ds_read_b128 v[100:103],v2 offset:11264
v_mfma_f32_16x16x32_bf16 v[136:139],v[80:83],v[32:35],v[136:139]
ds_read_b128 v[104:107],v2 offset:12288
ds_read_b128 v[108:111],v2 offset:13312
v_mfma_f32_16x16x32_bf16 v[136:139],v[84:87],v[36:39],v[136:139]
ds_read_b128 v[112:115],v2 offset:14336
ds_read_b128 v[116:119],v2 offset:15360
s_waitcnt lgkmcnt(0)
s_cmp_eq_u32 s30,0
s_cbranch_scc1 L_aa_302
s_cmp_lg_u32 s86,1536
s_cbranch_scc1 L_ae_333
s_mov_b32 s77,s35
s_mov_b32 s30,0
s_lshl_b32 s56,s77,5
s_add_u32 s56,s56,s68
s_mul_i32 s70,s56,24576
s_lshl_b32 s71,s56,12
s_lshl_b32 s59,s77,13
s_lshl2_add_u32 s59,s68,s59
s_add_u32 s59,s59,10485760
s_buffer_load_dword s32,s[8:11],s59
s_mov_b32 s33,1
s_add_u32 s70,s70,100663296
s_add_u32 s71,s71,41943040
v_mov_b32 v19,s59
s_branch L_af_334
L_ae_333:
s_ff1_i32_b64 s77,s[84:85]
s_bitset0_b64 s[84:85],s77
s_min_u32 s77,s77,64
s_lshr_b32 s61,s55,5
s_lshl_b32 s56,s77,5
s_add_u32 s56,s56,s68
s_mul_i32 s70,s56,24576
s_lshl_b32 s71,s56,12
s_lshl_b32 s59,s77,13
s_lshl2_add_u32 s59,s68,s59
s_add_u32 s59,s59,10486144
s_cmp_lt_u32 s77,s61
s_cselect_b32 s57,0,16777216
s_mov_b32 s60,s59
s_buffer_load_dword s33,s[8:11],s60
s_add_u32 s71,s71,s57
s_add_u32 s71,s71,58720256
s_cmp_eq_u32 s77,s61
s_cselect_b32 s57,50331648,0
s_cselect_b32 s58,1536,0
s_add_u32 s59,s59,s58
s_buffer_load_dword s32,s[8:11],s59
s_add_u32 s70,s70,s57
s_add_u32 s70,s70,150994944
v_mov_b32 v19,s59
v_writelane_b32 v19,s60,1
L_af_334:
v_max3_u32 v238,v72,v73,v74
v_max3_u32 v238,v74,v75,v238
v_max3_u32 v238,v76,v77,v238
v_max3_u32 v238,v78,v79,v238
v_max3_u32 v238,v80,v81,v238
v_max3_u32 v238,v82,v83,v238
v_max3_u32 v238,v84,v85,v238
v_max3_u32 v238,v86,v87,v238
v_max3_u32 v238,v120,v121,v238
v_max3_u32 v238,v122,v123,v238
v_max3_u32 v238,v124,v125,v238
v_max3_u32 v238,v126,v127,v238
v_cmp_eq_u32 vcc,-1,v238
s_cbranch_vccnz L_ac_335
L_acb_336:
v_max3_f32 v238,v128,v129,v130
v_max3_f32 v239,v131,v132,v133
v_max3_f32 v238,v134,v135,v238
v_max3_f32 v239,v138,v139,v239
v_max_f32 v238,v238,v239
v_max_f32 v239,v238,v239
v_pk_mul_f32 v[128:129],v[128:129],v[152:153] op_sel_hi:[1,0]
v_pk_mul_f32 v[130:131],v[130:131],v[152:153] op_sel_hi:[1,0]
v_permlane16_swap_b32 v238,v239
v_max_f32 v238,v238,v239
v_max_f32 v239,v238,v239
v_pk_mul_f32 v[132:133],v[132:133],v[152:153] op_sel_hi:[1,0]
v_pk_mul_f32 v[134:135],v[134:135],v[152:153] op_sel_hi:[1,0]
v_permlane32_swap_b32 v238,v239
v_max_f32 v238,v238,v239
v_mul_f32 v238,v152,v238
v_pk_mul_f32 v[138:139],v[138:139],v[152:153] op_sel_hi:[1,0]
v_pk_add_f32 v[128:129],v[128:129],v[238:239] op_sel_hi:[1,0] neg_lo:[0,1] neg_hi:[0,1]
v_pk_add_f32 v[130:131],v[130:131],v[238:239] op_sel_hi:[1,0] neg_lo:[0,1] neg_hi:[0,1]
v_pk_add_f32 v[132:133],v[132:133],v[238:239] op_sel_hi:[1,0] neg_lo:[0,1] neg_hi:[0,1]
v_pk_add_f32 v[134:135],v[134:135],v[238:239] op_sel_hi:[1,0] neg_lo:[0,1] neg_hi:[0,1]
v_pk_add_f32 v[138:139],v[138:139],v[238:239] op_sel_hi:[1,0] neg_lo:[0,1] neg_hi:[0,1]
v_exp_f32 v128,v128
v_exp_f32 v129,v129
v_exp_f32 v130,v130
v_exp_f32 v131,v131
v_exp_f32 v132,v132
v_exp_f32 v133,v133
v_exp_f32 v134,v134
v_exp_f32 v135,v135
v_exp_f32 v138,v138
v_exp_f32 v139,v139
v_pk_add_f32 v[148:149],v[128:129],v[130:131]
v_pk_add_f32 v[150:151],v[132:133],v[134:135]
v_pk_add_f32 v[148:149],v[148:149],v[138:139]
v_pk_add_f32 v[148:149],v[148:149],v[150:151]
v_add_f32 v150,v148,v149
v_add_f32 v151,v148,v149
s_nop 1
v_permlane16_swap_b32 v150,v151
v_add_f32 v148,v150,v151
v_add_f32 v149,v150,v151
s_nop 1
v_permlane32_swap_b32 v148,v149
v_add_f32 v148,v148,v149
v_rcp_f32 v148,v148
s_nop 0
v_pk_mul_f32 v[138:139],v[138:139],v[148:149] op_sel_hi:[1,0]
v_pk_mul_f32 v[128:129],v[128:129],v[148:149] op_sel_hi:[1,0]
v_pk_mul_f32 v[130:131],v[130:131],v[148:149] op_sel_hi:[1,0]
v_pk_mul_f32 v[132:133],v[132:133],v[148:149] op_sel_hi:[1,0]
v_pk_mul_f32 v[134:135],v[134:135],v[148:149] op_sel_hi:[1,0]
v_cvt_pk_bf16_f32 v144,v138,v139
v_cvt_pk_bf16_f32 v147,v138,v139
s_nop 0
v_mfma_f32_16x16x16_bf16 v[24:27],v[120:121],v[144:145],0
v_cvt_pk_bf16_f32 v140,v128,v129
v_mfma_f32_16x16x16_bf16 v[28:31],v[120:121],v[146:147],0
v_cvt_pk_bf16_f32 v141,v130,v131
v_mfma_f32_16x16x16_bf16 v[32:35],v[122:123],v[144:145],0
v_cvt_pk_bf16_f32 v142,v132,v133
v_mfma_f32_16x16x16_bf16 v[36:39],v[122:123],v[146:147],0
v_cvt_pk_bf16_f32 v143,v134,v135
v_mfma_f32_16x16x16_bf16 v[40:43],v[124:125],v[144:145],0
v_mfma_f32_16x16x16_bf16 v[44:47],v[124:125],v[146:147],0
v_mfma_f32_16x16x16_bf16 v[48:51],v[126:127],v[144:145],0
v_mfma_f32_16x16x16_bf16 v[52:55],v[126:127],v[146:147],0
v_mfma_f32_16x16x32_bf16 v[24:27],v[88:91],v[140:143],v[24:27]
v_mfma_f32_16x16x32_bf16 v[28:31],v[92:95],v[140:143],v[28:31]
v_mfma_f32_16x16x32_bf16 v[32:35],v[96:99],v[140:143],v[32:35]
v_mfma_f32_16x16x32_bf16 v[36:39],v[100:103],v[140:143],v[36:39]
v_cvt_pk_bf16_f32 v72,v24,v28
v_cvt_pk_bf16_f32 v73,v25,v29
v_mfma_f32_16x16x32_bf16 v[40:43],v[104:107],v[140:143],v[40:43]
v_cvt_pk_bf16_f32 v74,v26,v30
v_cvt_pk_bf16_f32 v75,v27,v31
v_mfma_f32_16x16x32_bf16 v[44:47],v[108:111],v[140:143],v[44:47]
ds_write_b128 v3,v[72:75] offset:0
v_cvt_pk_bf16_f32 v76,v32,v36
v_cvt_pk_bf16_f32 v77,v33,v37
v_mfma_f32_16x16x32_bf16 v[48:51],v[112:115],v[140:143],v[48:51]
v_cvt_pk_bf16_f32 v78,v34,v38
v_cvt_pk_bf16_f32 v79,v35,v39
v_mfma_f32_16x16x32_bf16 v[52:55],v[116:119],v[140:143],v[52:55]
ds_write_b128 v3,v[76:79] offset:1024
v_cvt_pk_bf16_f32 v80,v40,v44
v_cvt_pk_bf16_f32 v81,v41,v45
v_cvt_pk_bf16_f32 v82,v42,v46
v_cvt_pk_bf16_f32 v83,v43,v47
ds_write_b128 v3,v[80:83] offset:2048
s_nop 1
v_cvt_pk_bf16_f32 v84,v48,v52
v_cvt_pk_bf16_f32 v85,v49,v53
v_cvt_pk_bf16_f32 v86,v50,v54
v_cvt_pk_bf16_f32 v87,v51,v55
ds_write_b128 v3,v[84:87] offset:3072
s_waitcnt lgkmcnt(0)
s_barrier
L_ad_330:
s_mov_b32 s51,s53
s_mov_b32 s31,1
s_branch L_aa_294
L_aa_300:
s_waitcnt vmcnt(0)
buffer_store_dword v20,off,s[8:11],s73 sc1
s_mov_b32 s73,0x80000000
L_aa_302:
s_mov_b32 s51,s53
s_mov_b32 s31,0
s_add_u32 s35,s53,4
s_cmp_lt_u32 s53,5
s_cbranch_scc1 L_ab_337
s_cmp_ge_u32 s53,62
s_cbranch_scc1 L_am_339
L_aw_340:
v_min_u32 v239,v242,v243
v_cmp_eq_u32 vcc,0,v239
s_cbranch_vccz L_awd_341
s_sleep 4
buffer_load_dwordx2 v[242:243],v244,s[8:11],0 offen sc1
s_sub_u32 s49,s49,1
s_cbranch_scc1 L_abort2
s_waitcnt vmcnt(0)
s_branch L_aw_340
L_awd_341:
v_max_u32 v242,v242,v243
s_nop 1
v_max_u32_dpp v242,v242,v242 row_ror:8 row_mask:0xf bank_mask:0xf
s_nop 1
v_max_u32_dpp v242,v242,v242 row_ror:4 row_mask:0xf bank_mask:0xf
s_nop 1
v_max_u32_dpp v242,v242,v242 row_ror:2 row_mask:0xf bank_mask:0xf
s_nop 1
v_max_u32_dpp v242,v242,v242 row_ror:1 row_mask:0xf bank_mask:0xf
v_mov_b32 v243,v242
s_nop 1
v_permlane16_swap_b32 v242,v243
v_max_u32 v242,v242,v243
v_mov_b32 v243,v242
s_nop 1
v_permlane32_swap_b32 v242,v243
v_max_u32 v242,v242,v243
s_nop 0
v_readfirstlane_b32 s56,v242
v_readlane_b32 s57,v255,s53
s_max_u32 s75,s75,s56
s_cmp_lt_u32 s53,10
s_cbranch_scc1 L_ab_337
s_mov_b32 s77,s36
s_and_b32 s55,s75,0x7ff
s_sub_u32 s55,2047,s55
s_cmp_lt_u32 s75,s57
s_cselect_b32 s55,4095,s55
s_lshr_b32 s61,s55,5
s_mov_b32 s30,1
s_lshl_b32 s56,s77,5
s_add_u32 s56,s56,s68
s_mul_i32 s70,s56,24576
s_lshl_b32 s71,s56,12
s_lshl_b32 s59,s77,13
s_lshl2_add_u32 s59,s68,s59
s_add_u32 s59,s59,10486144
s_cmp_lt_u32 s77,s61
s_cselect_b32 s57,0,16777216
s_mov_b32 s60,s59
s_add_u32 s71,s71,s57
s_add_u32 s71,s71,58720256
s_cmp_eq_u32 s77,s61
s_cselect_b32 s57,50331648,0
s_cselect_b32 s58,1536,0
s_add_u32 s59,s59,s58
s_add_u32 s70,s70,s57
s_add_u32 s70,s70,150994944
v_mov_b32 v19,s59
v_writelane_b32 v19,s60,1
s_branch L_aj_338
L_ab_337:
s_mov_b32 s77,s35
s_mov_b32 s30,0
s_lshl_b32 s56,s77,5
s_add_u32 s56,s56,s68
s_mul_i32 s70,s56,24576
s_lshl_b32 s71,s56,12
s_lshl_b32 s59,s77,13
s_lshl2_add_u32 s59,s68,s59
s_add_u32 s59,s59,10485760
s_mov_b32 s33,1
s_add_u32 s70,s70,100663296
s_add_u32 s71,s71,41943040
v_mov_b32 v19,s59
L_aj_338:
buffer_load_dword v18,v19,s[8:11],0 offen sc1
s_waitcnt vmcnt(2)
v_mfma_f32_16x16x32_bf16 v[136:139],v[72:75],v[24:27],0
v_max3_u32 v238,v72,v73,v74
v_max3_u32 v238,v74,v75,v238
v_mfma_f32_16x16x32_bf16 v[136:139],v[76:79],v[28:31],v[136:139]
v_max3_u32 v238,v76,v77,v238
v_max3_u32 v238,v78,v79,v238
v_mfma_f32_16x16x32_bf16 v[136:139],v[80:83],v[32:35],v[136:139]
v_max3_u32 v238,v80,v81,v238
v_max3_u32 v238,v82,v83,v238
v_mfma_f32_16x16x32_bf16 v[136:139],v[84:87],v[36:39],v[136:139]
v_max3_u32 v238,v84,v85,v238
v_max3_u32 v238,v86,v87,v238
v_max3_u32 v238,v120,v121,v238
v_max3_u32 v238,v122,v123,v238
v_max3_u32 v238,v124,v125,v238
v_max3_u32 v238,v126,v127,v238
v_cmp_eq_u32 vcc,-1,v238
s_cbranch_vccz L_aa_305
L_aa_304:
buffer_load_dwordx4 v[72:75],v0,s[8:11],s76 offen offset:0 sc1
buffer_load_dwordx4 v[76:79],v0,s[8:11],s76 offen offset:1024 sc1
buffer_load_dwordx4 v[80:83],v0,s[8:11],s76 offen offset:2048 sc1
buffer_load_dwordx4 v[84:87],v0,s[8:11],s76 offen offset:3072 sc1
buffer_load_dwordx2 v[120:121],v253,s[8:11],s76 offen offset:0 sc1
buffer_load_dwordx2 v[122:123],v253,s[8:11],s76 offen offset:1024 sc1
buffer_load_dwordx2 v[124:125],v253,s[8:11],s76 offen offset:2048 sc1
buffer_load_dwordx2 v[126:127],v253,s[8:11],s76 offen offset:3072 sc1
buffer_load_dword v18,v19,s[8:11],0 offen sc1
s_sub_u32 s49,s49,1
s_cbranch_scc1 L_abort2
s_waitcnt vmcnt(8)
v_mfma_f32_16x16x32_bf16 v[136:139],v[72:75],v[24:27],0
v_max3_u32 v238,v72,v73,v74
v_max3_u32 v238,v74,v75,v238
s_waitcnt vmcnt(7)
v_mfma_f32_16x16x32_bf16 v[136:139],v[76:79],v[28:31],v[136:139]
v_max3_u32 v238,v76,v77,v238
v_max3_u32 v238,v78,v79,v238
s_waitcnt vmcnt(6)
v_mfma_f32_16x16x32_bf16 v[136:139],v[80:83],v[32:35],v[136:139]
v_max3_u32 v238,v80,v81,v238
v_max3_u32 v238,v82,v83,v238
s_waitcnt vmcnt(5)
v_mfma_f32_16x16x32_bf16 v[136:139],v[84:87],v[36:39],v[136:139]
v_max3_u32 v238,v84,v85,v238
v_max3_u32 v238,v86,v87,v238
s_waitcnt vmcnt(1)
v_max3_u32 v238,v120,v121,v238
v_max3_u32 v238,v122,v123,v238
v_max3_u32 v238,v124,v125,v238
v_max3_u32 v238,v126,v127,v238
v_cmp_eq_u32 vcc,-1,v238
s_cbranch_vccnz L_aa_304
L_aa_305:
s_cmp_lg_u32 s27,3
s_cbranch_scc1 L_ai_342
v_max3_f32 v238,v128,v129,v130
v_max3_f32 v239,v131,v132,v133
v_max3_f32 v238,v134,v135,v238
v_max3_f32 v239,v138,v139,v239
v_max_f32 v238,v238,v239
v_max_f32 v239,v238,v239
v_pk_mul_f32 v[128:129],v[128:129],v[152:153] op_sel_hi:[1,0]
v_pk_mul_f32 v[130:131],v[130:131],v[152:153] op_sel_hi:[1,0]
v_permlane16_swap_b32 v238,v239
v_max_f32 v238,v238,v239
v_max_f32 v239,v238,v239
v_pk_mul_f32 v[132:133],v[132:133],v[152:153] op_sel_hi:[1,0]
v_pk_mul_f32 v[134:135],v[134:135],v[152:153] op_sel_hi:[1,0]
v_permlane32_swap_b32 v238,v239
v_max_f32 v238,v238,v239
v_mul_f32 v238,v152,v238
v_pk_mul_f32 v[138:139],v[138:139],v[152:153] op_sel_hi:[1,0]
buffer_load_dword v17,v16,s[8:11],s87 offen sc1
v_pk_add_f32 v[128:129],v[128:129],v[238:239] op_sel_hi:[1,0] neg_lo:[0,1] neg_hi:[0,1]
v_pk_add_f32 v[130:131],v[130:131],v[238:239] op_sel_hi:[1,0] neg_lo:[0,1] neg_hi:[0,1]
v_pk_add_f32 v[132:133],v[132:133],v[238:239] op_sel_hi:[1,0] neg_lo:[0,1] neg_hi:[0,1]
v_pk_add_f32 v[134:135],v[134:135],v[238:239] op_sel_hi:[1,0] neg_lo:[0,1] neg_hi:[0,1]
v_pk_add_f32 v[138:139],v[138:139],v[238:239] op_sel_hi:[1,0] neg_lo:[0,1] neg_hi:[0,1]
v_exp_f32 v128,v128
v_exp_f32 v129,v129
v_exp_f32 v130,v130
v_exp_f32 v131,v131
v_exp_f32 v132,v132
v_exp_f32 v133,v133
v_exp_f32 v134,v134
v_exp_f32 v135,v135
v_exp_f32 v138,v138
v_exp_f32 v139,v139
v_pk_add_f32 v[148:149],v[128:129],v[130:131]
v_pk_add_f32 v[150:151],v[132:133],v[134:135]
v_pk_add_f32 v[148:149],v[148:149],v[138:139]
v_pk_add_f32 v[148:149],v[148:149],v[150:151]
v_add_f32 v150,v148,v149
v_add_f32 v151,v148,v149
s_nop 1
v_permlane16_swap_b32 v150,v151
v_add_f32 v148,v150,v151
v_add_f32 v149,v150,v151
s_nop 1
v_permlane32_swap_b32 v148,v149
v_add_f32 v148,v148,v149
v_rcp_f32 v148,v148
s_waitcnt vmcnt(0)
v_cmp_gt_u32 vcc,s66,v17
v_pk_mul_f32 v[138:139],v[138:139],v[148:149] op_sel_hi:[1,0]
v_pk_mul_f32 v[128:129],v[128:129],v[148:149] op_sel_hi:[1,0]
v_pk_mul_f32 v[130:131],v[130:131],v[148:149] op_sel_hi:[1,0]
v_pk_mul_f32 v[132:133],v[132:133],v[148:149] op_sel_hi:[1,0]
v_pk_mul_f32 v[134:135],v[134:135],v[148:149] op_sel_hi:[1,0]
s_cbranch_vccnz L_ap_343
L_apb_344:
s_xor_b32 s34,s69,524288
buffer_load_dwordx4 v[192:195],v7,s[8:11],s34 offen sc1
v_cvt_pk_bf16_f32 v144,v138,v139
v_cvt_pk_bf16_f32 v147,v138,v139
s_nop 0
v_mfma_f32_16x16x16_bf16 v[24:27],v[120:121],v[144:145],0
s_add_u32 s34,s34,4096
v_cvt_pk_bf16_f32 v140,v128,v129
v_mfma_f32_16x16x16_bf16 v[28:31],v[120:121],v[146:147],0
buffer_load_dwordx4 v[196:199],v7,s[8:11],s34 offen sc1
v_cvt_pk_bf16_f32 v141,v130,v131
v_mfma_f32_16x16x16_bf16 v[32:35],v[122:123],v[144:145],0
s_add_u32 s34,s34,4096
v_cvt_pk_bf16_f32 v142,v132,v133
v_mfma_f32_16x16x16_bf16 v[36:39],v[122:123],v[146:147],0
buffer_load_dwordx4 v[200:203],v7,s[8:11],s34 offen sc1
v_cvt_pk_bf16_f32 v143,v134,v135
v_mfma_f32_16x16x16_bf16 v[40:43],v[124:125],v[144:145],0
s_add_u32 s34,s34,4096
v_mfma_f32_16x16x16_bf16 v[44:47],v[124:125],v[146:147],0
buffer_load_dwordx4 v[204:207],v7,s[8:11],s34 offen sc1
v_mfma_f32_16x16x16_bf16 v[48:51],v[126:127],v[144:145],0
s_add_u32 s34,s34,4096
v_mfma_f32_16x16x16_bf16 v[52:55],v[126:127],v[146:147],0
buffer_load_dwordx4 v[208:211],v7,s[8:11],s34 offen sc1
v_mfma_f32_16x16x32_bf16 v[24:27],v[88:91],v[140:143],v[24:27]
s_add_u32 s34,s34,4096
v_mfma_f32_16x16x32_bf16 v[28:31],v[92:95],v[140:143],v[28:31]
buffer_load_dwordx4 v[212:215],v7,s[8:11],s34 offen sc1
v_mfma_f32_16x16x32_bf16 v[32:35],v[96:99],v[140:143],v[32:35]
s_add_u32 s34,s34,4096
v_mfma_f32_16x16x32_bf16 v[36:39],v[100:103],v[140:143],v[36:39]
buffer_load_dwordx4 v[216:219],v7,s[8:11],s34 offen sc1
v_cvt_pk_bf16_f32 v72,v24,v28
v_cvt_pk_bf16_f32 v73,v25,v29
v_mfma_f32_16x16x32_bf16 v[40:43],v[104:107],v[140:143],v[40:43]
s_add_u32 s34,s34,4096
v_cvt_pk_bf16_f32 v74,v26,v30
v_cvt_pk_bf16_f32 v75,v27,v31
v_mfma_f32_16x16x32_bf16 v[44:47],v[108:111],v[140:143],v[44:47]
ds_write_b128 v3,v[72:75] offset:0
v_cvt_pk_bf16_f32 v76,v32,v36
v_cvt_pk_bf16_f32 v77,v33,v37
v_mfma_f32_16x16x32_bf16 v[48:51],v[112:115],v[140:143],v[48:51]
buffer_load_dwordx4 v[220:223],v7,s[8:11],s34 offen sc1
v_cvt_pk_bf16_f32 v78,v34,v38
v_cvt_pk_bf16_f32 v79,v35,v39
v_mfma_f32_16x16x32_bf16 v[52:55],v[116:119],v[140:143],v[52:55]
ds_write_b128 v3,v[76:79] offset:1024
v_cvt_pk_bf16_f32 v80,v40,v44
v_cvt_pk_bf16_f32 v81,v41,v45
v_cvt_pk_bf16_f32 v82,v42,v46
v_cvt_pk_bf16_f32 v83,v43,v47
ds_write_b128 v3,v[80:83] offset:2048
s_nop 1
v_cvt_pk_bf16_f32 v84,v48,v52
v_cvt_pk_bf16_f32 v85,v49,v53
v_cvt_pk_bf16_f32 v86,v50,v54
v_cvt_pk_bf16_f32 v87,v51,v55
ds_write_b128 v3,v[84:87] offset:3072
v_readlane_b32 s32,v18,0
v_readlane_b32 s33,v18,1
s_waitcnt lgkmcnt(0)
s_barrier
s_branch L_aa_307
L_ai_342:
v_max3_f32 v238,v128,v129,v130
v_max3_f32 v239,v131,v132,v133
v_max3_f32 v238,v134,v135,v238
v_max3_f32 v239,v138,v139,v239
v_max_f32 v238,v238,v239
v_max_f32 v239,v238,v239
v_pk_mul_f32 v[128:129],v[128:129],v[152:153] op_sel_hi:[1,0]
v_pk_mul_f32 v[130:131],v[130:131],v[152:153] op_sel_hi:[1,0]
v_permlane16_swap_b32 v238,v239
v_max_f32 v238,v238,v239
v_max_f32 v239,v238,v239
v_pk_mul_f32 v[132:133],v[132:133],v[152:153] op_sel_hi:[1,0]
v_pk_mul_f32 v[134:135],v[134:135],v[152:153] op_sel_hi:[1,0]
v_permlane32_swap_b32 v238,v239
v_max_f32 v238,v238,v239
v_mul_f32 v238,v152,v238
v_pk_mul_f32 v[138:139],v[138:139],v[152:153] op_sel_hi:[1,0]
v_pk_add_f32 v[128:129],v[128:129],v[238:239] op_sel_hi:[1,0] neg_lo:[0,1] neg_hi:[0,1]
v_pk_add_f32 v[130:131],v[130:131],v[238:239] op_sel_hi:[1,0] neg_lo:[0,1] neg_hi:[0,1]
v_pk_add_f32 v[132:133],v[132:133],v[238:239] op_sel_hi:[1,0] neg_lo:[0,1] neg_hi:[0,1]
v_pk_add_f32 v[134:135],v[134:135],v[238:239] op_sel_hi:[1,0] neg_lo:[0,1] neg_hi:[0,1]
v_pk_add_f32 v[138:139],v[138:139],v[238:239] op_sel_hi:[1,0] neg_lo:[0,1] neg_hi:[0,1]
v_exp_f32 v128,v128
v_exp_f32 v129,v129
v_exp_f32 v130,v130
v_exp_f32 v131,v131
v_exp_f32 v132,v132
v_exp_f32 v133,v133
v_exp_f32 v134,v134
v_exp_f32 v135,v135
v_exp_f32 v138,v138
v_exp_f32 v139,v139
v_pk_add_f32 v[148:149],v[128:129],v[130:131]
v_pk_add_f32 v[150:151],v[132:133],v[134:135]
v_pk_add_f32 v[148:149],v[148:149],v[138:139]
v_pk_add_f32 v[148:149],v[148:149],v[150:151]
v_add_f32 v150,v148,v149
v_add_f32 v151,v148,v149
s_nop 1
v_permlane16_swap_b32 v150,v151
v_add_f32 v148,v150,v151
v_add_f32 v149,v150,v151
s_nop 1
v_permlane32_swap_b32 v148,v149
v_add_f32 v148,v148,v149
v_rcp_f32 v148,v148
s_nop 0
v_pk_mul_f32 v[138:139],v[138:139],v[148:149] op_sel_hi:[1,0]
v_pk_mul_f32 v[128:129],v[128:129],v[148:149] op_sel_hi:[1,0]
v_pk_mul_f32 v[130:131],v[130:131],v[148:149] op_sel_hi:[1,0]
v_pk_mul_f32 v[132:133],v[132:133],v[148:149] op_sel_hi:[1,0]
v_pk_mul_f32 v[134:135],v[134:135],v[148:149] op_sel_hi:[1,0]
v_cvt_pk_bf16_f32 v144,v138,v139
v_cvt_pk_bf16_f32 v147,v138,v139
s_nop 0
v_mfma_f32_16x16x16_bf16 v[24:27],v[120:121],v[144:145],0
v_cvt_pk_bf16_f32 v140,v128,v129
v_mfma_f32_16x16x16_bf16 v[28:31],v[120:121],v[146:147],0
v_cvt_pk_bf16_f32 v141,v130,v131
v_mfma_f32_16x16x16_bf16 v[32:35],v[122:123],v[144:145],0
v_cvt_pk_bf16_f32 v142,v132,v133
v_mfma_f32_16x16x16_bf16 v[36:39],v[122:123],v[146:147],0
v_cvt_pk_bf16_f32 v143,v134,v135
v_mfma_f32_16x16x16_bf16 v[40:43],v[124:125],v[144:145],0
v_mfma_f32_16x16x16_bf16 v[44:47],v[124:125],v[146:147],0
v_mfma_f32_16x16x16_bf16 v[48:51],v[126:127],v[144:145],0
v_mfma_f32_16x16x16_bf16 v[52:55],v[126:127],v[146:147],0
v_mfma_f32_16x16x32_bf16 v[24:27],v[88:91],v[140:143],v[24:27]
v_mfma_f32_16x16x32_bf16 v[28:31],v[92:95],v[140:143],v[28:31]
v_mfma_f32_16x16x32_bf16 v[32:35],v[96:99],v[140:143],v[32:35]
v_mfma_f32_16x16x32_bf16 v[36:39],v[100:103],v[140:143],v[36:39]
v_cvt_pk_bf16_f32 v72,v24,v28
v_cvt_pk_bf16_f32 v73,v25,v29
v_mfma_f32_16x16x32_bf16 v[40:43],v[104:107],v[140:143],v[40:43]
v_cvt_pk_bf16_f32 v74,v26,v30
v_cvt_pk_bf16_f32 v75,v27,v31
v_mfma_f32_16x16x32_bf16 v[44:47],v[108:111],v[140:143],v[44:47]
ds_write_b128 v3,v[72:75] offset:0
v_cvt_pk_bf16_f32 v76,v32,v36
v_cvt_pk_bf16_f32 v77,v33,v37
v_mfma_f32_16x16x32_bf16 v[48:51],v[112:115],v[140:143],v[48:51]
v_cvt_pk_bf16_f32 v78,v34,v38
v_cvt_pk_bf16_f32 v79,v35,v39
v_mfma_f32_16x16x32_bf16 v[52:55],v[116:119],v[140:143],v[52:55]
ds_write_b128 v3,v[76:79] offset:1024
v_cvt_pk_bf16_f32 v80,v40,v44
v_cvt_pk_bf16_f32 v81,v41,v45
v_cvt_pk_bf16_f32 v82,v42,v46
v_cvt_pk_bf16_f32 v83,v43,v47
ds_write_b128 v3,v[80:83] offset:2048
s_nop 1
v_cvt_pk_bf16_f32 v84,v48,v52
v_cvt_pk_bf16_f32 v85,v49,v53
v_cvt_pk_bf16_f32 v86,v50,v54
v_cvt_pk_bf16_f32 v87,v51,v55
ds_write_b128 v3,v[84:87] offset:3072
s_waitcnt vmcnt(0)
v_readlane_b32 s32,v18,0
v_readlane_b32 s33,v18,1
s_waitcnt lgkmcnt(0)
s_barrier
s_branch L_aa_294
L_aa_303:
s_cmp_lg_u32 s86,1536
s_cbranch_scc1 L_az_345
s_cmp_ge_u32 s35,66
s_cbranch_scc1 L_aa_293
v_subrev_u32 v248,s36,v1
v_and_b32 v248,0x80000003,v248
v_cmp_eq_u32 vcc,0,v248
v_lshlrev_b32 v248,2,v1
v_mov_b32 v249,0x40000000
v_cndmask_b32 v248,v249,v248,vcc
v_mov_b32 v249,3
s_or_b32 s59,s68,s46
s_mov_b32 s59,11018240
s_cmov_b32 s59,0x80000000
buffer_store_dword v249,v248,s[8:11],s59 offen sc1
L_aa_293:
s_waitcnt vmcnt(0)
buffer_store_dword v20,off,s[8:11],s73 sc1
s_mov_b32 s73,0x80000000
v_lshlrev_b32 v238,2,v1
v_add_u32 v248,155712,v238
s_cmp_lg_u32 s46,0
s_cbranch_scc1 L_an_346
s_lshl_b32 s59,s54,13
s_add_u32 s59,s59,11026432
L_fp_347:
s_sleep 1
buffer_load_dword v239,v238,s[8:11],s59 offen sc1
s_sub_u32 s49,s49,1
s_cbranch_scc1 L_abort2
s_waitcnt vmcnt(0)
v_cmp_eq_u32 vcc,0,v239
s_cbranch_vccnz L_fp_347
ds_write_b32 v248,v239
s_waitcnt lgkmcnt(0)
L_an_346:
s_barrier
ds_read_b32 v239,v248
s_mov_b32 s86,768
s_mov_b32 s30,1
s_waitcnt lgkmcnt(0)
v_readfirstlane_b32 s55,v239
v_and_b32 v239,255,v239
s_lshr_b32 s55,s55,8
s_lshr_b32 s61,s55,5
v_cmp_ne_u32 s[38:39],3,v239
v_cmp_le_u32 vcc,s61,v1
s_nop 1
v_cndmask_b32 v238,1,2,vcc
v_cmp_ne_u32 s[84:85],v238,v239
s_bcnt1_i32_b64 s56,s[84:85]
s_nop 0
v_mbcnt_lo_u32_b32 v238,s84,0
v_mbcnt_hi_u32_b32 v238,s85,v238
s_mul_i32 s56,s56,14
s_add_u32 s56,s56,48
s_lshr_b32 s56,s56,7
s_lshl_b32 s56,s56,1
v_cmp_gt_u32 vcc,s56,v238
v_and_b32 v239,1,v238
v_and_b32 v238,3,v238
v_add_u32 v238,2,v238
v_cndmask_b32 v238,v238,v239,vcc
v_cmp_eq_u32 vcc,s54,v238
s_and_b64 s[84:85],s[84:85],vcc
s_ff1_i32_b64 s77,s[84:85]
s_bitset0_b64 s[84:85],s77
s_min_u32 s77,s77,64
s_lshl_b32 s56,s77,5
s_add_u32 s56,s56,s68
s_mul_i32 s70,s56,24576
s_lshl_b32 s71,s56,12
s_lshl_b32 s59,s77,13
s_lshl2_add_u32 s59,s68,s59
s_add_u32 s59,s59,10486144
s_cmp_lt_u32 s77,s61
s_cselect_b32 s57,0,16777216
s_mov_b32 s60,s59
s_buffer_load_dword s33,s[8:11],s60
s_add_u32 s71,s71,s57
s_add_u32 s71,s71,58720256
s_cmp_eq_u32 s77,s61
s_cselect_b32 s57,50331648,0
s_cselect_b32 s58,1536,0
s_add_u32 s59,s59,s58
s_buffer_load_dword s32,s[8:11],s59
s_add_u32 s70,s70,s57
s_add_u32 s70,s70,150994944
v_mov_b32 v19,s59
v_writelane_b32 v19,s60,1
s_cmp_lt_u32 s77,64
s_cbranch_scc1 L_aa_301
L_az_345:
s_waitcnt vmcnt(0)
buffer_store_dword v20,off,s[8:11],s73 sc1
s_mov_b32 s73,0x80000000
s_endpgm
L_ag_309:
s_lshl_b32 s21,s26,13
s_lshl2_add_u32 s21,s68,s21
s_add_u32 s21,s21,10487296
L_ww_348:
buffer_load_dword v246,off,s[8:11],s21 sc1
s_sub_u32 s49,s49,1
s_cbranch_scc1 L_abort2
s_waitcnt vmcnt(0)
v_readfirstlane_b32 s22,v246
s_cmp_eq_u32 s22,0
s_cbranch_scc1 L_ww_348
L_wwd_349:
s_branch L_agb_310
L_ac_316:
buffer_load_dwordx4 v[72:75],v0,s[8:11],s76 offen offset:0 sc1
buffer_load_dwordx4 v[76:79],v0,s[8:11],s76 offen offset:1024 sc1
buffer_load_dwordx4 v[80:83],v0,s[8:11],s76 offen offset:2048 sc1
buffer_load_dwordx4 v[84:87],v0,s[8:11],s76 offen offset:3072 sc1
buffer_load_dwordx2 v[120:121],v253,s[8:11],s76 offen offset:0 sc1
buffer_load_dwordx2 v[122:123],v253,s[8:11],s76 offen offset:1024 sc1
buffer_load_dwordx2 v[124:125],v253,s[8:11],s76 offen offset:2048 sc1
buffer_load_dwordx2 v[126:127],v253,s[8:11],s76 offen offset:3072 sc1
s_sub_u32 s49,s49,1
s_cbranch_scc1 L_abort2
s_waitcnt vmcnt(7)
v_mfma_f32_16x16x32_bf16 v[136:139],v[72:75],v[24:27],0
v_max3_u32 v238,v72,v73,v74
v_max3_u32 v238,v74,v75,v238
s_waitcnt vmcnt(6)
v_mfma_f32_16x16x32_bf16 v[136:139],v[76:79],v[28:31],v[136:139]
v_max3_u32 v238,v76,v77,v238
v_max3_u32 v238,v78,v79,v238
s_waitcnt vmcnt(5)
v_mfma_f32_16x16x32_bf16 v[136:139],v[80:83],v[32:35],v[136:139]
v_max3_u32 v238,v80,v81,v238
v_max3_u32 v238,v82,v83,v238
s_waitcnt vmcnt(4)
v_mfma_f32_16x16x32_bf16 v[136:139],v[84:87],v[36:39],v[136:139]
v_max3_u32 v238,v84,v85,v238
v_max3_u32 v238,v86,v87,v238
s_waitcnt vmcnt(0)
v_max3_u32 v238,v120,v121,v238
v_max3_u32 v238,v122,v123,v238
v_max3_u32 v238,v124,v125,v238
v_max3_u32 v238,v126,v127,v238
v_cmp_eq_u32 vcc,-1,v238
s_cbranch_vccnz L_ac_316
s_branch L_acb_317
L_ap_319:
L_aw_350:
v_cmp_gt_u32 vcc,s66,v17
s_cbranch_vccz L_awd_351
buffer_load_dword v17,v16,s[8:11],s87 offen sc1
s_sub_u32 s49,s49,1
s_cbranch_scc1 L_abort2
s_waitcnt vmcnt(0)
s_branch L_aw_350
L_awd_351:
s_branch L_apb_320
L_ag_328:
s_lshl_b32 s21,s51,13
s_lshl2_add_u32 s21,s68,s21
s_add_u32 s21,s21,10487296
L_ww_352:
buffer_load_dword v246,off,s[8:11],s21 sc1
s_sub_u32 s49,s49,1
s_cbranch_scc1 L_abort2
s_waitcnt vmcnt(0)
v_readfirstlane_b32 s22,v246
s_cmp_eq_u32 s22,0
s_cbranch_scc1 L_ww_352
L_wwd_353:
s_branch L_agb_329
L_ac_335:
buffer_load_dwordx4 v[72:75],v0,s[8:11],s76 offen offset:0 sc1
buffer_load_dwordx4 v[76:79],v0,s[8:11],s76 offen offset:1024 sc1
buffer_load_dwordx4 v[80:83],v0,s[8:11],s76 offen offset:2048 sc1
buffer_load_dwordx4 v[84:87],v0,s[8:11],s76 offen offset:3072 sc1
buffer_load_dwordx2 v[120:121],v253,s[8:11],s76 offen offset:0 sc1
buffer_load_dwordx2 v[122:123],v253,s[8:11],s76 offen offset:1024 sc1
buffer_load_dwordx2 v[124:125],v253,s[8:11],s76 offen offset:2048 sc1
buffer_load_dwordx2 v[126:127],v253,s[8:11],s76 offen offset:3072 sc1
s_sub_u32 s49,s49,1
s_cbranch_scc1 L_abort2
s_waitcnt vmcnt(7)
v_mfma_f32_16x16x32_bf16 v[136:139],v[72:75],v[24:27],0
v_max3_u32 v238,v72,v73,v74
v_max3_u32 v238,v74,v75,v238
s_waitcnt vmcnt(6)
v_mfma_f32_16x16x32_bf16 v[136:139],v[76:79],v[28:31],v[136:139]
v_max3_u32 v238,v76,v77,v238
v_max3_u32 v238,v78,v79,v238
s_waitcnt vmcnt(5)
v_mfma_f32_16x16x32_bf16 v[136:139],v[80:83],v[32:35],v[136:139]
v_max3_u32 v238,v80,v81,v238
v_max3_u32 v238,v82,v83,v238
s_waitcnt vmcnt(4)
v_mfma_f32_16x16x32_bf16 v[136:139],v[84:87],v[36:39],v[136:139]
v_max3_u32 v238,v84,v85,v238
v_max3_u32 v238,v86,v87,v238
s_waitcnt vmcnt(0)
v_max3_u32 v238,v120,v121,v238
v_max3_u32 v238,v122,v123,v238
v_max3_u32 v238,v124,v125,v238
v_max3_u32 v238,v126,v127,v238
v_cmp_eq_u32 vcc,-1,v238
s_cbranch_vccnz L_ac_335
s_branch L_acb_336
L_am_339:
v_subrev_u32 v248,s36,v1
v_and_b32 v248,0x80000003,v248
v_cmp_eq_u32 vcc,0,v248
v_lshlrev_b32 v248,2,v1
v_mov_b32 v249,0x40000000
v_cndmask_b32 v248,v249,v248,vcc
v_mov_b32 v249,3
s_or_b32 s59,s68,s46
s_mov_b32 s59,11018240
s_cmov_b32 s59,0x80000000
buffer_store_dword v249,v248,s[8:11],s59 offen sc1
s_branch L_ab_337
L_ap_343:
L_aw_354:
v_cmp_gt_u32 vcc,s66,v17
s_cbranch_vccz L_awd_355
buffer_load_dword v17,v16,s[8:11],s87 offen sc1
s_sub_u32 s49,s49,1
s_cbranch_scc1 L_abort2
s_waitcnt vmcnt(0)
s_branch L_aw_354
L_awd_355:
s_branch L_apb_344
s_endpgm
L_wm:
s_nop 11
v_and_b32 v120,15,v1
v_lshrrev_b32 v121,4,v1
v_mov_b32 v17,1
s_lshl_b32 s56,s46,15
v_add_u32 v18,s56,v0
s_lshl_b32 s56,s46,2
v_add_u32 v125,s56,v121
v_xor_b32 v126,v125,v120
v_lshlrev_b32 v126,4,v126
v_lshl_add_u32 v20,v125,10,v126
v_add_u32 v125,0,v121
v_xor_b32 v125,v125,v120
v_lshlrev_b32 v125,4,v125
v_lshl_add_u32 v125,v120,8,v125
v_add_u32 v4,131072,v125
v_add_u32 v125,4,v121
v_xor_b32 v125,v125,v120
v_lshlrev_b32 v125,4,v125
v_lshl_add_u32 v125,v120,8,v125
v_add_u32 v5,131072,v125
v_add_u32 v125,8,v121
v_xor_b32 v125,v125,v120
v_lshlrev_b32 v125,4,v125
v_lshl_add_u32 v125,v120,8,v125
v_add_u32 v6,131072,v125
v_add_u32 v125,12,v121
v_xor_b32 v125,v125,v120
v_lshlrev_b32 v125,4,v125
v_lshl_add_u32 v125,v120,8,v125
v_add_u32 v7,131072,v125
v_lshlrev_b32 v21,5,v120
v_and_b32 v125,1,v121
v_lshl_add_u32 v21,v125,4,v21
s_lshl_b32 s56,s46,9
v_lshrrev_b32 v125,1,v121
v_lshl_add_u32 v21,v125,11,v21
s_add_u32 s56,s56,155648
v_add_u32 v21,s56,v21
v_lshlrev_b32 v22,4,v120
v_lshl_add_u32 v22,v121,10,v22
s_lshl_b32 s56,s46,8
v_add_u32 v22,s56,v22
s_mov_b32 s54,0
s_mov_b32 s31,0
s_mov_b32 s53,6
s_mov_b32 s72,0x80000000
s_mov_b32 s73,0
s_mov_b32 s77,-1
s_mov_b32 s86,0
s_mov_b32 s19,0
s_mov_b32 s74,1056964608
s_mov_b32 s75,1227133513
v_and_b32 v23,15,v1
v_lshlrev_b32 v23,3,v23
v_lshrrev_b32 v16,4,v1
v_lshl_add_u32 v23,v16,13,v23
v_mov_b32 v19,159744
v_lshl_add_u32 v16,v16,2,v19
s_ff1_i32_b64 s30,s[74:75]
s_bitset0_b64 s[74:75],s30
s_min_u32 s30,s30,127
s_lshl_b32 s70,s30,15
s_add_u32 s70,s70,0
s_add_u32 s71,s70,16384
L_mo_359:
s_cmp_lg_u32 s19,0
s_cbranch_scc1 L_mo_360
s_add_u32 m0,s50,131072
s_nop 0
buffer_load_dwordx4 v20,s[8:11],s70 offen offset:0 sc1 lds
s_add_u32 m0,s50,135168
s_nop 0
buffer_load_dwordx4 v20,s[8:11],s71 offen offset:0 sc1 lds
s_add_u32 m0,s50,139008
s_nop 0
buffer_load_dwordx4 v20,s[8:11],s70 offen offset:256 sc1 lds
s_add_u32 m0,s50,143104
s_nop 0
buffer_load_dwordx4 v20,s[8:11],s71 offen offset:256 sc1 lds
s_add_u32 m0,s50,146944
s_nop 0
buffer_load_dwordx4 v20,s[8:11],s70 offen offset:512 sc1 lds
s_add_u32 m0,s50,151040
s_nop 0
buffer_load_dwordx4 v20,s[8:11],s71 offen offset:512 sc1 lds
s_mov_b32 s19,1
s_waitcnt vmcnt(0)
L_mo_360:
s_mov_b32 s51,s30
s_mov_b64 s[68:69],s[70:71]
s_ff1_i32_b64 s30,s[74:75]
s_bitset0_b64 s[74:75],s30
s_min_u32 s30,s30,127
s_lshl_b32 s70,s30,15
s_add_u32 s70,s70,0
s_add_u32 s71,s70,16384
s_lshl_b32 s76,s31,13
s_add_u32 s76,s76,10487040
s_lshl_b32 s58,s51,5
s_add_u32 s58,s58,s47
s_mul_i32 s58,s58,24576
s_add_u32 s58,s58,100663296
s_add_u32 s61,s58,s50
s_add_u32 s62,s61,4096
s_add_u32 s63,s61,16384
s_add_u32 s64,s61,20480
s_add_u32 s65,s61,s50
s_add_u32 s65,s65,8192
s_waitcnt vmcnt(12)
s_barrier
ds_read_b128 v[72:75],v4 offset:0
ds_read_b128 v[76:79],v4 offset:4096
ds_read_b128 v[80:83],v5 offset:0
ds_read_b128 v[84:87],v5 offset:4096
s_add_u32 m0,s50,154880
s_nop 0
buffer_load_dwordx4 v20,s[8:11],s68 offen offset:768 sc1 lds
s_add_u32 m0,s50,158976
s_nop 0
buffer_load_dwordx4 v20,s[8:11],s69 offen offset:768 sc1 lds
s_waitcnt lgkmcnt(2)
v_mfma_f32_16x16x32_bf16 v[40:43],a[128:131],v[72:75],0
ds_read_b128 v[108:111],v6 offset:0
v_mfma_f32_16x16x32_bf16 v[56:59],v[72:75],v[128:131],0
v_mfma_f32_16x16x32_bf16 v[24:27],a[0:3],v[72:75],0
ds_read_b128 v[112:115],v6 offset:4096
v_mfma_f32_16x16x32_bf16 v[44:47],a[128:131],v[76:79],0
v_mfma_f32_16x16x32_bf16 v[60:63],v[76:79],v[128:131],0
v_mfma_f32_16x16x32_bf16 v[28:31],a[0:3],v[76:79],0
v_mfma_f32_16x16x32_bf16 v[48:51],a[136:139],v[72:75],0
v_mfma_f32_16x16x32_bf16 v[64:67],v[72:75],v[136:139],0
v_mfma_f32_16x16x32_bf16 v[32:35],a[8:11],v[72:75],0
v_mfma_f32_16x16x32_bf16 v[52:55],a[136:139],v[76:79],0
v_mfma_f32_16x16x32_bf16 v[68:71],v[76:79],v[136:139],0
v_mfma_f32_16x16x32_bf16 v[36:39],a[8:11],v[76:79],0
s_waitcnt lgkmcnt(2)
v_mfma_f32_16x16x32_bf16 v[40:43],a[132:135],v[80:83],v[40:43]
ds_read_b128 v[72:75],v7 offset:0
v_mfma_f32_16x16x32_bf16 v[56:59],v[80:83],v[132:135],v[56:59]
v_mfma_f32_16x16x32_bf16 v[24:27],a[4:7],v[80:83],v[24:27]
ds_read_b128 v[76:79],v7 offset:4096
v_mfma_f32_16x16x32_bf16 v[44:47],a[132:135],v[84:87],v[44:47]
v_mfma_f32_16x16x32_bf16 v[60:63],v[84:87],v[132:135],v[60:63]
v_mfma_f32_16x16x32_bf16 v[28:31],a[4:7],v[84:87],v[28:31]
v_mfma_f32_16x16x32_bf16 v[48:51],a[140:143],v[80:83],v[48:51]
v_mfma_f32_16x16x32_bf16 v[64:67],v[80:83],v[140:143],v[64:67]
v_mfma_f32_16x16x32_bf16 v[32:35],a[12:15],v[80:83],v[32:35]
v_mfma_f32_16x16x32_bf16 v[52:55],a[140:143],v[84:87],v[52:55]
v_mfma_f32_16x16x32_bf16 v[68:71],v[84:87],v[140:143],v[68:71]
v_mfma_f32_16x16x32_bf16 v[36:39],a[12:15],v[84:87],v[36:39]
s_waitcnt vmcnt(12)
s_barrier
s_waitcnt lgkmcnt(2)
v_mfma_f32_16x16x32_bf16 v[40:43],a[144:147],v[108:111],v[40:43]
ds_read_b128 v[80:83],v4 offset:8192
v_mfma_f32_16x16x32_bf16 v[56:59],v[108:111],v[144:147],v[56:59]
v_mfma_f32_16x16x32_bf16 v[24:27],a[16:19],v[108:111],v[24:27]
ds_read_b128 v[84:87],v4 offset:12288
v_mfma_f32_16x16x32_bf16 v[44:47],a[144:147],v[112:115],v[44:47]
v_mfma_f32_16x16x32_bf16 v[60:63],v[112:115],v[144:147],v[60:63]
v_mfma_f32_16x16x32_bf16 v[28:31],a[16:19],v[112:115],v[28:31]
v_mfma_f32_16x16x32_bf16 v[48:51],a[152:155],v[108:111],v[48:51]
v_mfma_f32_16x16x32_bf16 v[64:67],v[108:111],v[152:155],v[64:67]
v_mfma_f32_16x16x32_bf16 v[32:35],a[24:27],v[108:111],v[32:35]
v_mfma_f32_16x16x32_bf16 v[52:55],a[152:155],v[112:115],v[52:55]
v_mfma_f32_16x16x32_bf16 v[68:71],v[112:115],v[152:155],v[68:71]
v_mfma_f32_16x16x32_bf16 v[36:39],a[24:27],v[112:115],v[36:39]
s_waitcnt lgkmcnt(2)
v_mfma_f32_16x16x32_bf16 v[40:43],a[148:151],v[72:75],v[40:43]
ds_read_b128 v[108:111],v5 offset:8192
v_mfma_f32_16x16x32_bf16 v[56:59],v[72:75],v[148:151],v[56:59]
v_mfma_f32_16x16x32_bf16 v[24:27],a[20:23],v[72:75],v[24:27]
ds_read_b128 v[112:115],v5 offset:12288
v_mfma_f32_16x16x32_bf16 v[44:47],a[148:151],v[76:79],v[44:47]
v_mfma_f32_16x16x32_bf16 v[60:63],v[76:79],v[148:151],v[60:63]
v_mfma_f32_16x16x32_bf16 v[28:31],a[20:23],v[76:79],v[28:31]
v_mfma_f32_16x16x32_bf16 v[48:51],a[156:159],v[72:75],v[48:51]
v_mfma_f32_16x16x32_bf16 v[64:67],v[72:75],v[156:159],v[64:67]
v_mfma_f32_16x16x32_bf16 v[32:35],a[28:31],v[72:75],v[32:35]
v_mfma_f32_16x16x32_bf16 v[52:55],a[156:159],v[76:79],v[52:55]
v_mfma_f32_16x16x32_bf16 v[68:71],v[76:79],v[156:159],v[68:71]
v_mfma_f32_16x16x32_bf16 v[36:39],a[28:31],v[76:79],v[36:39]
s_waitcnt lgkmcnt(2)
v_mfma_f32_16x16x32_bf16 v[40:43],a[160:163],v[80:83],v[40:43]
ds_read_b128 v[72:75],v6 offset:8192
v_mfma_f32_16x16x32_bf16 v[56:59],v[80:83],v[160:163],v[56:59]
v_mfma_f32_16x16x32_bf16 v[24:27],a[32:35],v[80:83],v[24:27]
ds_read_b128 v[76:79],v6 offset:12288
v_mfma_f32_16x16x32_bf16 v[44:47],a[160:163],v[84:87],v[44:47]
v_mfma_f32_16x16x32_bf16 v[60:63],v[84:87],v[160:163],v[60:63]
v_mfma_f32_16x16x32_bf16 v[28:31],a[32:35],v[84:87],v[28:31]
v_mfma_f32_16x16x32_bf16 v[48:51],a[168:171],v[80:83],v[48:51]
v_mfma_f32_16x16x32_bf16 v[64:67],v[80:83],v[168:171],v[64:67]
v_mfma_f32_16x16x32_bf16 v[32:35],a[40:43],v[80:83],v[32:35]
v_mfma_f32_16x16x32_bf16 v[52:55],a[168:171],v[84:87],v[52:55]
v_mfma_f32_16x16x32_bf16 v[68:71],v[84:87],v[168:171],v[68:71]
v_mfma_f32_16x16x32_bf16 v[36:39],a[40:43],v[84:87],v[36:39]
s_waitcnt lgkmcnt(2)
v_mfma_f32_16x16x32_bf16 v[40:43],a[164:167],v[108:111],v[40:43]
ds_read_b128 v[80:83],v7 offset:8192
v_mfma_f32_16x16x32_bf16 v[56:59],v[108:111],v[164:167],v[56:59]
v_mfma_f32_16x16x32_bf16 v[24:27],a[36:39],v[108:111],v[24:27]
ds_read_b128 v[84:87],v7 offset:12288
v_mfma_f32_16x16x32_bf16 v[44:47],a[164:167],v[112:115],v[44:47]
v_mfma_f32_16x16x32_bf16 v[60:63],v[112:115],v[164:167],v[60:63]
v_mfma_f32_16x16x32_bf16 v[28:31],a[36:39],v[112:115],v[28:31]
v_mfma_f32_16x16x32_bf16 v[48:51],a[172:175],v[108:111],v[48:51]
v_mfma_f32_16x16x32_bf16 v[64:67],v[108:111],v[172:175],v[64:67]
v_mfma_f32_16x16x32_bf16 v[32:35],a[44:47],v[108:111],v[32:35]
v_mfma_f32_16x16x32_bf16 v[52:55],a[172:175],v[112:115],v[52:55]
v_mfma_f32_16x16x32_bf16 v[68:71],v[112:115],v[172:175],v[68:71]
v_mfma_f32_16x16x32_bf16 v[36:39],a[44:47],v[112:115],v[36:39]
s_waitcnt vmcnt(10)
s_barrier
s_waitcnt lgkmcnt(2)
v_mfma_f32_16x16x32_bf16 v[40:43],a[176:179],v[72:75],v[40:43]
ds_read_b128 v[108:111],v4 offset:16384
v_mfma_f32_16x16x32_bf16 v[56:59],v[72:75],v[176:179],v[56:59]
v_mfma_f32_16x16x32_bf16 v[24:27],a[48:51],v[72:75],v[24:27]
ds_read_b128 v[112:115],v4 offset:20480
v_mfma_f32_16x16x32_bf16 v[44:47],a[176:179],v[76:79],v[44:47]
v_mfma_f32_16x16x32_bf16 v[60:63],v[76:79],v[176:179],v[60:63]
v_mfma_f32_16x16x32_bf16 v[28:31],a[48:51],v[76:79],v[28:31]
v_mfma_f32_16x16x32_bf16 v[48:51],a[184:187],v[72:75],v[48:51]
v_mfma_f32_16x16x32_bf16 v[64:67],v[72:75],v[184:187],v[64:67]
v_mfma_f32_16x16x32_bf16 v[32:35],a[56:59],v[72:75],v[32:35]
v_mfma_f32_16x16x32_bf16 v[52:55],a[184:187],v[76:79],v[52:55]
v_mfma_f32_16x16x32_bf16 v[68:71],v[76:79],v[184:187],v[68:71]
v_mfma_f32_16x16x32_bf16 v[36:39],a[56:59],v[76:79],v[36:39]
s_waitcnt vmcnt(2)
s_barrier
s_or_b32 s72,s72,s52
buffer_store_dword v17,off,s[8:11],s72 sc1
s_waitcnt lgkmcnt(2)
v_mfma_f32_16x16x32_bf16 v[40:43],a[180:183],v[80:83],v[40:43]
ds_read_b128 v[72:75],v5 offset:16384
v_mfma_f32_16x16x32_bf16 v[56:59],v[80:83],v[180:183],v[56:59]
v_mfma_f32_16x16x32_bf16 v[24:27],a[52:55],v[80:83],v[24:27]
ds_read_b128 v[76:79],v5 offset:20480
v_mfma_f32_16x16x32_bf16 v[44:47],a[180:183],v[84:87],v[44:47]
v_mfma_f32_16x16x32_bf16 v[60:63],v[84:87],v[180:183],v[60:63]
v_mfma_f32_16x16x32_bf16 v[28:31],a[52:55],v[84:87],v[28:31]
v_mfma_f32_16x16x32_bf16 v[48:51],a[188:191],v[80:83],v[48:51]
v_mfma_f32_16x16x32_bf16 v[64:67],v[80:83],v[188:191],v[64:67]
v_mfma_f32_16x16x32_bf16 v[32:35],a[60:63],v[80:83],v[32:35]
v_mfma_f32_16x16x32_bf16 v[52:55],a[188:191],v[84:87],v[52:55]
v_mfma_f32_16x16x32_bf16 v[68:71],v[84:87],v[188:191],v[68:71]
v_mfma_f32_16x16x32_bf16 v[36:39],a[60:63],v[84:87],v[36:39]
s_waitcnt lgkmcnt(2)
v_mfma_f32_16x16x32_bf16 v[40:43],a[192:195],v[108:111],v[40:43]
ds_read_b128 v[80:83],v6 offset:16384
v_mfma_f32_16x16x32_bf16 v[56:59],v[108:111],v[192:195],v[56:59]
v_mfma_f32_16x16x32_bf16 v[24:27],a[64:67],v[108:111],v[24:27]
ds_read_b128 v[84:87],v6 offset:20480
v_mfma_f32_16x16x32_bf16 v[44:47],a[192:195],v[112:115],v[44:47]
v_mfma_f32_16x16x32_bf16 v[60:63],v[112:115],v[192:195],v[60:63]
v_mfma_f32_16x16x32_bf16 v[28:31],a[64:67],v[112:115],v[28:31]
v_mfma_f32_16x16x32_bf16 v[48:51],a[200:203],v[108:111],v[48:51]
v_mfma_f32_16x16x32_bf16 v[64:67],v[108:111],v[200:203],v[64:67]
v_mfma_f32_16x16x32_bf16 v[32:35],a[72:75],v[108:111],v[32:35]
v_mfma_f32_16x16x32_bf16 v[52:55],a[200:203],v[112:115],v[52:55]
v_mfma_f32_16x16x32_bf16 v[68:71],v[112:115],v[200:203],v[68:71]
v_mfma_f32_16x16x32_bf16 v[36:39],a[72:75],v[112:115],v[36:39]
s_waitcnt lgkmcnt(2)
v_mfma_f32_16x16x32_bf16 v[40:43],a[196:199],v[72:75],v[40:43]
ds_read_b128 v[108:111],v7 offset:16384
v_mfma_f32_16x16x32_bf16 v[56:59],v[72:75],v[196:199],v[56:59]
v_mfma_f32_16x16x32_bf16 v[24:27],a[68:71],v[72:75],v[24:27]
ds_read_b128 v[112:115],v7 offset:20480
v_mfma_f32_16x16x32_bf16 v[44:47],a[196:199],v[76:79],v[44:47]
v_mfma_f32_16x16x32_bf16 v[60:63],v[76:79],v[196:199],v[60:63]
v_mfma_f32_16x16x32_bf16 v[28:31],a[68:71],v[76:79],v[28:31]
v_mfma_f32_16x16x32_bf16 v[48:51],a[204:207],v[72:75],v[48:51]
v_mfma_f32_16x16x32_bf16 v[64:67],v[72:75],v[204:207],v[64:67]
v_mfma_f32_16x16x32_bf16 v[32:35],a[76:79],v[72:75],v[32:35]
v_mfma_f32_16x16x32_bf16 v[52:55],a[204:207],v[76:79],v[52:55]
v_mfma_f32_16x16x32_bf16 v[68:71],v[76:79],v[204:207],v[68:71]
v_mfma_f32_16x16x32_bf16 v[36:39],a[76:79],v[76:79],v[36:39]
s_waitcnt vmcnt(1)
s_barrier
s_waitcnt lgkmcnt(2)
v_mfma_f32_16x16x32_bf16 v[40:43],a[208:211],v[80:83],v[40:43]
ds_read_b128 v[72:75],v4 offset:24576
v_mfma_f32_16x16x32_bf16 v[56:59],v[80:83],v[208:211],v[56:59]
v_mfma_f32_16x16x32_bf16 v[24:27],a[80:83],v[80:83],v[24:27]
ds_read_b128 v[76:79],v4 offset:28672
v_mfma_f32_16x16x32_bf16 v[44:47],a[208:211],v[84:87],v[44:47]
v_mfma_f32_16x16x32_bf16 v[60:63],v[84:87],v[208:211],v[60:63]
v_mfma_f32_16x16x32_bf16 v[28:31],a[80:83],v[84:87],v[28:31]
v_mfma_f32_16x16x32_bf16 v[48:51],a[216:219],v[80:83],v[48:51]
v_mfma_f32_16x16x32_bf16 v[64:67],v[80:83],v[216:219],v[64:67]
v_mfma_f32_16x16x32_bf16 v[32:35],a[88:91],v[80:83],v[32:35]
v_mfma_f32_16x16x32_bf16 v[52:55],a[216:219],v[84:87],v[52:55]
v_mfma_f32_16x16x32_bf16 v[68:71],v[84:87],v[216:219],v[68:71]
v_mfma_f32_16x16x32_bf16 v[36:39],a[88:91],v[84:87],v[36:39]
s_waitcnt lgkmcnt(2)
v_mfma_f32_16x16x32_bf16 v[40:43],a[212:215],v[108:111],v[40:43]
ds_read_b128 v[80:83],v5 offset:24576
v_mfma_f32_16x16x32_bf16 v[56:59],v[108:111],v[212:215],v[56:59]
v_mfma_f32_16x16x32_bf16 v[24:27],a[84:87],v[108:111],v[24:27]
ds_read_b128 v[84:87],v5 offset:28672
v_mfma_f32_16x16x32_bf16 v[44:47],a[212:215],v[112:115],v[44:47]
v_mfma_f32_16x16x32_bf16 v[60:63],v[112:115],v[212:215],v[60:63]
v_mfma_f32_16x16x32_bf16 v[28:31],a[84:87],v[112:115],v[28:31]
v_mfma_f32_16x16x32_bf16 v[48:51],a[220:223],v[108:111],v[48:51]
v_mfma_f32_16x16x32_bf16 v[64:67],v[108:111],v[220:223],v[64:67]
v_mfma_f32_16x16x32_bf16 v[32:35],a[92:95],v[108:111],v[32:35]
v_mfma_f32_16x16x32_bf16 v[52:55],a[220:223],v[112:115],v[52:55]
v_mfma_f32_16x16x32_bf16 v[68:71],v[112:115],v[220:223],v[68:71]
v_mfma_f32_16x16x32_bf16 v[36:39],a[92:95],v[112:115],v[36:39]
s_barrier
s_waitcnt lgkmcnt(2)
v_mfma_f32_16x16x32_bf16 v[40:43],a[224:227],v[72:75],v[40:43]
ds_read_b128 v[108:111],v6 offset:24576
v_mfma_f32_16x16x32_bf16 v[56:59],v[72:75],v[224:227],v[56:59]
s_add_u32 m0,s50,131072
v_mfma_f32_16x16x32_bf16 v[24:27],a[96:99],v[72:75],v[24:27]
ds_read_b128 v[112:115],v6 offset:28672
v_mfma_f32_16x16x32_bf16 v[44:47],a[224:227],v[76:79],v[44:47]
buffer_load_dwordx4 v20,s[8:11],s70 offen offset:0 sc1 lds
v_mfma_f32_16x16x32_bf16 v[60:63],v[76:79],v[224:227],v[60:63]
s_add_u32 m0,s50,135168
v_mfma_f32_16x16x32_bf16 v[28:31],a[96:99],v[76:79],v[28:31]
buffer_load_dwordx4 v20,s[8:11],s71 offen offset:0 sc1 lds
v_mfma_f32_16x16x32_bf16 v[48:51],a[232:235],v[72:75],v[48:51]
s_add_u32 m0,s50,139008
v_mfma_f32_16x16x32_bf16 v[64:67],v[72:75],v[232:235],v[64:67]
buffer_load_dwordx4 v20,s[8:11],s70 offen offset:256 sc1 lds
v_mfma_f32_16x16x32_bf16 v[32:35],a[104:107],v[72:75],v[32:35]
s_add_u32 m0,s50,143104
v_mfma_f32_16x16x32_bf16 v[52:55],a[232:235],v[76:79],v[52:55]
buffer_load_dwordx4 v20,s[8:11],s71 offen offset:256 sc1 lds
v_mfma_f32_16x16x32_bf16 v[68:71],v[76:79],v[232:235],v[68:71]
s_add_u32 m0,s50,146944
v_mfma_f32_16x16x32_bf16 v[36:39],a[104:107],v[76:79],v[36:39]
buffer_load_dwordx4 v20,s[8:11],s70 offen offset:512 sc1 lds
s_waitcnt lgkmcnt(2)
v_mfma_f32_16x16x32_bf16 v[40:43],a[228:231],v[80:83],v[40:43]
ds_read_b128 v[72:75],v7 offset:24576
v_mfma_f32_16x16x32_bf16 v[56:59],v[80:83],v[228:231],v[56:59]
s_add_u32 m0,s50,151040
v_mfma_f32_16x16x32_bf16 v[24:27],a[100:103],v[80:83],v[24:27]
ds_read_b128 v[76:79],v7 offset:28672
v_mfma_f32_16x16x32_bf16 v[44:47],a[228:231],v[84:87],v[44:47]
buffer_load_dwordx4 v20,s[8:11],s71 offen offset:512 sc1 lds
v_mfma_f32_16x16x32_bf16 v[60:63],v[84:87],v[228:231],v[60:63]
buffer_load_dwordx2 v[124:125],v23,s[8:11],s76 offen sc1
v_mfma_f32_16x16x32_bf16 v[28:31],a[100:103],v[84:87],v[28:31]
v_mfma_f32_16x16x32_bf16 v[48:51],a[236:239],v[80:83],v[48:51]
v_mfma_f32_16x16x32_bf16 v[64:67],v[80:83],v[236:239],v[64:67]
v_mfma_f32_16x16x32_bf16 v[32:35],a[108:111],v[80:83],v[32:35]
v_mfma_f32_16x16x32_bf16 v[52:55],a[236:239],v[84:87],v[52:55]
v_mfma_f32_16x16x32_bf16 v[68:71],v[84:87],v[236:239],v[68:71]
v_mfma_f32_16x16x32_bf16 v[36:39],a[108:111],v[84:87],v[36:39]
s_waitcnt lgkmcnt(2)
v_mfma_f32_16x16x32_bf16 v[40:43],a[240:243],v[108:111],v[40:43]
v_mfma_f32_16x16x32_bf16 v[56:59],v[108:111],v[240:243],v[56:59]
v_mfma_f32_16x16x32_bf16 v[24:27],a[112:115],v[108:111],v[24:27]
v_mfma_f32_16x16x32_bf16 v[44:47],a[240:243],v[112:115],v[44:47]
v_mfma_f32_16x16x32_bf16 v[60:63],v[112:115],v[240:243],v[60:63]
v_mfma_f32_16x16x32_bf16 v[28:31],a[112:115],v[112:115],v[28:31]
v_mfma_f32_16x16x32_bf16 v[48:51],a[248:251],v[108:111],v[48:51]
v_mfma_f32_16x16x32_bf16 v[64:67],v[108:111],v[248:251],v[64:67]
v_mfma_f32_16x16x32_bf16 v[32:35],a[120:123],v[108:111],v[32:35]
v_mfma_f32_16x16x32_bf16 v[52:55],a[248:251],v[112:115],v[52:55]
v_mfma_f32_16x16x32_bf16 v[68:71],v[112:115],v[248:251],v[68:71]
v_mfma_f32_16x16x32_bf16 v[36:39],a[120:123],v[112:115],v[36:39]
s_waitcnt lgkmcnt(0)
v_mfma_f32_16x16x32_bf16 v[40:43],a[244:247],v[72:75],v[40:43]
v_mfma_f32_16x16x32_bf16 v[56:59],v[72:75],v[244:247],v[56:59]
v_mfma_f32_16x16x32_bf16 v[24:27],a[116:119],v[72:75],v[24:27]
v_mfma_f32_16x16x32_bf16 v[44:47],a[244:247],v[76:79],v[44:47]
v_mfma_f32_16x16x32_bf16 v[60:63],v[76:79],v[244:247],v[60:63]
v_mfma_f32_16x16x32_bf16 v[28:31],a[116:119],v[76:79],v[28:31]
v_mfma_f32_16x16x32_bf16 v[48:51],a[252:255],v[72:75],v[48:51]
v_mfma_f32_16x16x32_bf16 v[64:67],v[72:75],v[252:255],v[64:67]
v_mfma_f32_16x16x32_bf16 v[32:35],a[124:127],v[72:75],v[32:35]
v_mfma_f32_16x16x32_bf16 v[52:55],a[252:255],v[76:79],v[52:55]
v_mfma_f32_16x16x32_bf16 v[68:71],v[76:79],v[252:255],v[68:71]
v_mfma_f32_16x16x32_bf16 v[36:39],a[124:127],v[76:79],v[36:39]
s_lshl_b32 s56,s51,5
s_add_u32 s56,s56,s47
s_lshl_b32 s56,s56,12
s_add_u32 s56,s56,s50
s_add_u32 s56,s56,41943040
v_mov_b64 v[120:121],-1
v_mov_b64 v[122:123],-1
buffer_store_dwordx4 v[120:123],v0,s[8:11],s56 offen sc1
v_cvt_pk_bf16_f32 v72,v40,v48
v_cvt_pk_bf16_f32 v73,v41,v49
v_cvt_pk_bf16_f32 v74,v42,v50
v_cvt_pk_bf16_f32 v75,v43,v51
buffer_store_dwordx4 v[72:75],v0,s[8:11],s61 offen sc1
v_cvt_pk_bf16_f32 v76,v44,v52
v_cvt_pk_bf16_f32 v77,v45,v53
v_cvt_pk_bf16_f32 v78,v46,v54
v_cvt_pk_bf16_f32 v79,v47,v55
buffer_store_dwordx4 v[76:79],v0,s[8:11],s62 offen sc1
v_cvt_pk_bf16_f32 v80,v56,v57
v_cvt_pk_bf16_f32 v81,v58,v59
v_cvt_pk_bf16_f32 v82,v60,v61
v_cvt_pk_bf16_f32 v83,v62,v63
buffer_store_dwordx4 v[80:83],v0,s[8:11],s65 offen offset:0 sc1
v_cvt_pk_bf16_f32 v84,v64,v65
v_cvt_pk_bf16_f32 v85,v66,v67
v_cvt_pk_bf16_f32 v86,v68,v69
v_cvt_pk_bf16_f32 v87,v70,v71
buffer_store_dwordx4 v[84:87],v0,s[8:11],s65 offen offset:1024 sc1
v_cvt_pk_bf16_f32 v108,v24,v32
v_cvt_pk_bf16_f32 v109,v25,v33
v_cvt_pk_bf16_f32 v110,v26,v34
v_cvt_pk_bf16_f32 v111,v27,v35
buffer_store_dwordx4 v[108:111],v0,s[8:11],s63 offen sc1
v_cvt_pk_bf16_f32 v112,v28,v36
v_cvt_pk_bf16_f32 v113,v29,v37
v_cvt_pk_bf16_f32 v114,v30,v38
v_cvt_pk_bf16_f32 v115,v31,v39
buffer_store_dwordx4 v[112:115],v0,s[8:11],s64 offen sc1
s_lshl_b32 s72,s51,13
s_lshl2_add_u32 s72,s47,s72
s_add_u32 s72,s72,10485760
s_sub_u32 s53,s53,1
s_cmp_gt_i32 s53,0
s_cbranch_scc1 L_mo_360
s_mov_b32 s87,3
s_mov_b32 s18,0
s_waitcnt vmcnt(7)
s_branch L_mo_365
L_mo_358:
s_mov_b32 s55,s22
s_mov_b32 s22,s23
s_mov_b32 s23,s24
s_mov_b32 s24,-1
s_cmp_lg_u32 s55,-1
s_cbranch_scc1 L_mp_356
s_sub_u32 s56,s30,s31
s_cmp_gt_i32 s77,0
s_cselect_b32 s57,6,15
s_cmp_lg_u32 s86,0
s_cselect_b32 s57,9,s57
s_cmp_lt_i32 s56,s57
s_cbranch_scc1 L_mo_359
s_cmp_lt_i32 s56,30
s_cselect_b32 s87,s18,0
s_cmp_ge_u32 s31,8
s_cselect_b32 s56,1,s18
s_and_b32 s56,s56,s86
s_cselect_b32 s87,2,s87
s_mul_i32 s56,s87,s18
s_cmp_lg_u32 s56,0
s_cbranch_scc1 L_mo_363
s_mov_b32 s18,0
s_lshr_b32 s56,s72,31
s_or_b32 s56,s56,s87
s_cbranch_scc1 L_mo_369
s_waitcnt vmcnt(0)
s_barrier
s_or_b32 s72,s72,s52
buffer_store_dword v17,off,s[8:11],s72 sc1
s_mov_b32 s72,0x80000000
L_mo_369:
s_cmp_lg_u32 s46,0
s_cbranch_scc1 L_mo_367
s_lshl_b32 s76,s31,13
s_add_u32 s76,s76,10487040
L_mo_366:
buffer_load_dwordx2 v[124:125],v23,s[8:11],s76 offen sc1
s_sub_u32 s49,s49,1
s_cbranch_scc1 L_abort2
s_waitcnt vmcnt(0)
L_mo_365:
v_min_u32 v123,v124,v125
v_max_u32 v125,v124,v125
v_cmp_eq_u32 vcc,0,v123
s_nop 1
v_cndmask_b32 v125,v125,-1,vcc
s_and_b32 s56,vcc_lo,0xffff
s_cbranch_scc0 L_mo_370
s_cmp_lg_u32 s87,0
s_cbranch_scc1 L_mo_370
s_mov_b32 s18,1
s_sleep 2
s_branch L_mo_366
L_mo_370:
v_max_u32_dpp v125,v125,v125 row_ror:8 row_mask:0xf bank_mask:0xf
s_nop 1
v_max_u32_dpp v125,v125,v125 row_ror:4 row_mask:0xf bank_mask:0xf
s_nop 1
v_max_u32_dpp v125,v125,v125 row_ror:2 row_mask:0xf bank_mask:0xf
s_nop 1
v_max_u32_dpp v125,v125,v125 row_ror:1 row_mask:0xf bank_mask:0xf
L_mo_367:
s_sub_u32 s49,s49,1
s_cbranch_scc1 L_abort2
v_mov_b32 v124,s18
s_barrier
s_cmp_lg_u32 s46,0
s_cbranch_scc1 L_mo_368
ds_write_b32 v16,v125
ds_write_b32 v19,v124 offset:16
s_waitcnt lgkmcnt(0)
L_mo_368:
s_barrier
ds_read_b128 v[120:123],v19
ds_read_b32 v124,v19 offset:16
s_waitcnt lgkmcnt(0)
v_readfirstlane_b32 s55,v120
v_readfirstlane_b32 s22,v121
v_readfirstlane_b32 s23,v122
v_readfirstlane_b32 s24,v123
v_readfirstlane_b32 s18,v124
s_cmp_lg_u32 s55,-1
s_cbranch_scc1 L_mp_356
L_mo_363:
s_mov_b32 s22,-1
s_cmp_eq_u32 s87,1
s_cbranch_scc1 L_mo_359
s_cmp_eq_u32 s87,2
s_cbranch_scc1 L_mo_364
s_branch L_mo_358
L_mp_356:
s_sub_u32 s73,s73,1
s_max_i32 s73,s73,0
s_sub_u32 s77,s77,1
s_min_u32 s61,s73,2
s_cmp_lt_u32 s31,5
s_cselect_b32 s61,2,s61
s_cmp_le_u32 s55,s54
s_cbranch_scc1 L_mr_357
s_mov_b32 s77,s61
s_mov_b32 s54,s55
s_mov_b32 s86,0
s_or_b32 s61,s47,s46
s_cbranch_scc1 L_mr_357
v_mov_b32 v120,s54
v_lshlrev_b32 v121,13,v1
s_mov_b32 s61,10486784
buffer_store_dword v120,v121,s[8:11],s61 offen sc1
L_mr_357:
s_cmp_lg_u32 s31,63
s_cbranch_scc1 L_mo_361
s_min_i32 s77,s77,0
s_or_b32 s61,s47,s46
s_cbranch_scc1 L_mo_361
s_mov_b32 s59,11018240
v_lshlrev_b32 v120,2,v1
L_fp_372:
s_sleep 0
buffer_load_dword v121,v120,s[8:11],s59 offen sc1
s_sub_u32 s49,s49,1
s_cbranch_scc1 L_abort2
s_waitcnt vmcnt(0)
v_cmp_eq_u32 vcc,0,v121
s_cbranch_vccnz L_fp_372
s_andn2_b32 s62,0x7ff,s54
v_lshl_or_b32 v121,s62,8,v121
s_add_u32 s59,s59,8192
buffer_store_dword v121,v120,s[8:11],s59 offen sc1
s_add_u32 s59,s59,8192
buffer_store_dword v121,v120,s[8:11],s59 offen sc1
s_add_u32 s59,s59,8192
buffer_store_dword v121,v120,s[8:11],s59 offen sc1
s_add_u32 s59,s59,8192
buffer_store_dword v121,v120,s[8:11],s59 offen sc1
s_add_u32 s59,s59,8192
buffer_store_dword v121,v120,s[8:11],s59 offen sc1
s_add_u32 s59,s59,8192
buffer_store_dword v121,v120,s[8:11],s59 offen sc1
L_mo_361:
s_add_u32 s31,s31,1
s_cmp_gt_i32 s77,0
s_cmov_b32 s18,0
s_cbranch_scc1 L_mo_358
s_cmp_lg_u32 s77,0
s_cbranch_scc1 L_mo_362
s_andn2_b32 s51,0x7ff,s54
s_lshr_b32 s51,s51,5
s_add_u32 s73,s73,2
s_mov_b32 s86,1
s_mov_b32 s19,0
s_mov_b32 s18,0
s_waitcnt vmcnt(8)
s_barrier
s_and_b32 s64,s54,0x7ff
s_sub_u32 s64,2047,s64
s_lshl_b32 s56,s64,10
s_add_u32 s58,s56,4194304
buffer_load_dwordx4 v[88:91],v0,s[8:11],s58 offen sc1
s_mov_b32 s4,s38
s_mov_b32 s5,s39
s_mov_b32 s6,1835008
s_mov_b32 s7,0x20000
v_and_b32 v9,15,v1
v_lshrrev_b32 v10,4,v1
v_lshlrev_b32 v8,14,v10
v_lshl_add_u32 v8,v9,4,v8
s_lshl_b32 s59,s47,16
s_lshl_b32 s60,s46,8
s_add_u32 s59,s59,s60
buffer_load_dwordx4 v[24:27],v8,s[4:7],s59 offen offset:0
buffer_load_dwordx4 v[28:31],v8,s[4:7],s59 offen offset:1024
buffer_load_dwordx4 v[32:35],v8,s[4:7],s59 offen offset:2048
buffer_load_dwordx4 v[36:39],v8,s[4:7],s59 offen offset:3072
s_add_u32 s59,s59,4096
buffer_load_dwordx4 v[40:43],v8,s[4:7],s59 offen offset:0
buffer_load_dwordx4 v[44:47],v8,s[4:7],s59 offen offset:1024
buffer_load_dwordx4 v[48:51],v8,s[4:7],s59 offen offset:2048
buffer_load_dwordx4 v[52:55],v8,s[4:7],s59 offen offset:3072
s_add_u32 s59,s59,4096
buffer_load_dwordx4 v[56:59],v8,s[4:7],s59 offen offset:0
buffer_load_dwordx4 v[60:63],v8,s[4:7],s59 offen offset:1024
buffer_load_dwordx4 v[64:67],v8,s[4:7],s59 offen offset:2048
buffer_load_dwordx4 v[68:71],v8,s[4:7],s59 offen offset:3072
s_add_u32 s59,s59,4096
buffer_load_dwordx4 v[72:75],v8,s[4:7],s59 offen offset:0
buffer_load_dwordx4 v[76:79],v8,s[4:7],s59 offen offset:1024
buffer_load_dwordx4 v[80:83],v8,s[4:7],s59 offen offset:2048
buffer_load_dwordx4 v[84:87],v8,s[4:7],s59 offen offset:3072
v_and_b32 v124,1,v1
v_lshlrev_b32 v124,4,v124
v_mov_b32 v125,0xffff
v_lshlrev_b32 v125,v124,v125
v_lshrrev_b32 v124,1,v9
v_cmp_eq_u32 vcc,0,v124
s_nop 1
v_cndmask_b32 v12,0,v125,vcc
v_cmp_eq_u32 vcc,1,v124
s_nop 1
v_cndmask_b32 v13,0,v125,vcc
v_cmp_eq_u32 vcc,2,v124
s_nop 1
v_cndmask_b32 v14,0,v125,vcc
v_cmp_eq_u32 vcc,3,v124
s_nop 1
v_cndmask_b32 v15,0,v125,vcc
s_waitcnt vmcnt(16)
L_mx_373:
v_max3_u32 v124,v88,v89,v90
v_max_u32 v124,v91,v124
v_cmp_eq_u32 vcc,-1,v124
s_cbranch_vccz L_mxd_374
buffer_load_dwordx4 v[88:91],v0,s[8:11],s58 offen sc1
s_sub_u32 s49,s49,1
s_cbranch_scc1 L_abort2
s_waitcnt vmcnt(0)
s_branch L_mx_373
L_mxd_374:
v_lshlrev_b32 v96,16,v88
v_and_b32 v97,0xffff0000,v88
v_lshlrev_b32 v98,16,v89
v_and_b32 v99,0xffff0000,v89
v_lshlrev_b32 v100,16,v90
v_and_b32 v101,0xffff0000,v90
v_lshlrev_b32 v102,16,v91
v_and_b32 v103,0xffff0000,v91
v_readfirstlane_b32 s78,v96
s_nop 1
v_pk_add_f32 v[108:109],v[96:97],s[78:79] op_sel_hi:[1,0] neg_lo:[0,1] neg_hi:[0,1]
v_pk_add_f32 v[110:111],v[98:99],s[78:79] op_sel_hi:[1,0] neg_lo:[0,1] neg_hi:[0,1]
v_pk_add_f32 v[112:113],v[100:101],s[78:79] op_sel_hi:[1,0] neg_lo:[0,1] neg_hi:[0,1]
v_pk_add_f32 v[114:115],v[102:103],s[78:79] op_sel_hi:[1,0] neg_lo:[0,1] neg_hi:[0,1]
v_pk_add_f32 v[116:117],v[108:109],v[110:111]
v_pk_mul_f32 v[118:119],v[108:109],v[108:109]
v_pk_add_f32 v[120:121],v[112:113],v[114:115]
v_pk_fma_f32 v[118:119],v[110:111],v[110:111],v[118:119]
v_pk_add_f32 v[116:117],v[116:117],v[120:121]
v_pk_fma_f32 v[118:119],v[112:113],v[112:113],v[118:119]
v_add_f32 v116,v116,v117
v_pk_fma_f32 v[118:119],v[114:115],v[114:115],v[118:119]
v_add_f32 v118,v118,v119
s_nop 1
v_permlane32_swap_b32 v116,v118
v_add_f32 v116,v116,v118
s_nop 1
v_add_f32_dpp v116,v116,v116 row_ror:8 row_mask:0xf bank_mask:0xf
s_nop 1
v_add_f32_dpp v116,v116,v116 row_ror:4 row_mask:0xf bank_mask:0xf
s_nop 1
v_add_f32_dpp v116,v116,v116 row_ror:2 row_mask:0xf bank_mask:0xf
s_nop 1
v_add_f32_dpp v116,v116,v116 row_ror:1 row_mask:0xf bank_mask:0xf
v_mov_b32 v118,v116
s_nop 1
v_permlane16_swap_b32 v116,v118
v_add_f32 v116,v116,v118
v_mul_f32 v116,0x3b000000,v116
v_mov_b32 v118,v116
s_nop 1
v_permlane32_swap_b32 v116,v118
v_fma_f32 v118,-v116,v116,v118
v_add_f32 v116,s78,v116
v_max_f32 v118,0,v118
v_cvt_pk_bf16_f32 v118,v116,v118
v_lshlrev_b32 v116,16,v118
v_and_b32 v118,0xffff0000,v118
v_add_f32 v118,0x3727c5ac,v118
v_cvt_pk_bf16_f32 v118,v118,v118
v_and_b32 v118,0xffff0000,v118
v_sqrt_f32 v118,v118
v_pk_add_f32 v[108:109],v[96:97],v[116:117] op_sel_hi:[1,0] neg_lo:[0,1] neg_hi:[0,1]
v_pk_add_f32 v[110:111],v[98:99],v[116:117] op_sel_hi:[1,0] neg_lo:[0,1] neg_hi:[0,1]
v_pk_add_f32 v[112:113],v[100:101],v[116:117] op_sel_hi:[1,0] neg_lo:[0,1] neg_hi:[0,1]
v_pk_add_f32 v[114:115],v[102:103],v[116:117] op_sel_hi:[1,0] neg_lo:[0,1] neg_hi:[0,1]
v_cvt_pk_bf16_f32 v118,v118,v118
v_and_b32 v118,0xffff0000,v118
v_rcp_f32 v118,v118
v_cvt_pk_bf16_f32 v104,v108,v109
v_cvt_pk_bf16_f32 v105,v110,v111
v_cvt_pk_bf16_f32 v106,v112,v113
v_cvt_pk_bf16_f32 v107,v114,v115
v_lshlrev_b32 v108,16,v104
v_and_b32 v109,0xffff0000,v104
v_lshlrev_b32 v110,16,v105
v_and_b32 v111,0xffff0000,v105
v_lshlrev_b32 v112,16,v106
v_and_b32 v113,0xffff0000,v106
v_lshlrev_b32 v114,16,v107
v_and_b32 v115,0xffff0000,v107
v_pk_mul_f32 v[108:109],v[108:109],v[118:119] op_sel_hi:[1,0]
v_pk_mul_f32 v[110:111],v[110:111],v[118:119] op_sel_hi:[1,0]
v_pk_mul_f32 v[112:113],v[112:113],v[118:119] op_sel_hi:[1,0]
v_pk_mul_f32 v[114:115],v[114:115],v[118:119] op_sel_hi:[1,0]
v_cvt_pk_bf16_f32 v104,v108,v109
v_cvt_pk_bf16_f32 v105,v110,v111
v_cvt_pk_bf16_f32 v106,v112,v113
v_cvt_pk_bf16_f32 v107,v114,v115
s_mov_b32 s58,0x01000100
s_mov_b32 s59,0x03020302
v_perm_b32 v88,v104,v104,s58
v_perm_b32 v89,v104,v104,s59
v_perm_b32 v90,v105,v105,s58
v_perm_b32 v91,v105,v105,s59
v_perm_b32 v92,v106,v106,s58
v_perm_b32 v93,v106,v106,s59
v_perm_b32 v94,v107,v107,s58
v_perm_b32 v95,v107,v107,s59
v_lshlrev_b32 v8,5,v1
s_lshl_b32 s58,s46,11
s_add_u32 s58,s58,139264
v_add_u32 v8,s58,v8
ds_write_b128 v8,v[88:91]
ds_write_b128 v8,v[92:95] offset:16
s_lshl_b32 s59,s46,9
s_add_u32 s59,s58,s59
v_lshlrev_b32 v8,7,v10
v_add_u32 v8,s59,v8
s_waitcnt lgkmcnt(0)
ds_read_b128 v[108:111],v18 offset:0
ds_read_b128 v[88:91],v8 offset:0
ds_read_b128 v[92:95],v8 offset:16
ds_read_b128 v[112:115],v18 offset:1024
s_waitcnt lgkmcnt(1)
v_and_b32 v124,v12,v88
v_and_b32 v125,v13,v88
v_and_b32 v126,v14,v88
v_and_b32 v127,v15,v88
s_nop 1
v_mfma_f32_16x16x32_bf16 v[116:119],v[124:127],v[108:111],0
ds_read_b128 v[108:111],v18 offset:2048
s_waitcnt lgkmcnt(1)
v_and_b32 v124,v12,v89
v_and_b32 v125,v13,v89
v_and_b32 v126,v14,v89
v_and_b32 v127,v15,v89
s_nop 1
v_mfma_f32_16x16x32_bf16 v[116:119],v[124:127],v[112:115],v[116:119]
ds_read_b128 v[112:115],v18 offset:3072
s_waitcnt lgkmcnt(1)
v_and_b32 v124,v12,v90
v_and_b32 v125,v13,v90
v_and_b32 v126,v14,v90
v_and_b32 v127,v15,v90
s_nop 1
v_mfma_f32_16x16x32_bf16 v[116:119],v[124:127],v[108:111],v[116:119]
ds_read_b128 v[108:111],v18 offset:4096
s_waitcnt lgkmcnt(1)
v_and_b32 v124,v12,v91
v_and_b32 v125,v13,v91
v_and_b32 v126,v14,v91
v_and_b32 v127,v15,v91
s_nop 1
v_mfma_f32_16x16x32_bf16 v[116:119],v[124:127],v[112:115],v[116:119]
ds_read_b128 v[112:115],v18 offset:5120
s_waitcnt lgkmcnt(1)
v_and_b32 v124,v12,v92
v_and_b32 v125,v13,v92
v_and_b32 v126,v14,v92
v_and_b32 v127,v15,v92
s_nop 1
v_mfma_f32_16x16x32_bf16 v[116:119],v[124:127],v[108:111],v[116:119]
ds_read_b128 v[108:111],v18 offset:6144
s_waitcnt lgkmcnt(1)
v_and_b32 v124,v12,v93
v_and_b32 v125,v13,v93
v_and_b32 v126,v14,v93
v_and_b32 v127,v15,v93
s_nop 1
v_mfma_f32_16x16x32_bf16 v[116:119],v[124:127],v[112:115],v[116:119]
ds_read_b128 v[112:115],v18 offset:7168
s_waitcnt lgkmcnt(1)
v_and_b32 v124,v12,v94
v_and_b32 v125,v13,v94
v_and_b32 v126,v14,v94
v_and_b32 v127,v15,v94
s_nop 1
v_mfma_f32_16x16x32_bf16 v[116:119],v[124:127],v[108:111],v[116:119]
ds_read_b128 v[108:111],v18 offset:8192
s_waitcnt lgkmcnt(1)
v_and_b32 v124,v12,v95
v_and_b32 v125,v13,v95
v_and_b32 v126,v14,v95
v_and_b32 v127,v15,v95
s_nop 1
v_mfma_f32_16x16x32_bf16 v[116:119],v[124:127],v[112:115],v[116:119]
ds_read_b128 v[88:91],v8 offset:32
ds_read_b128 v[92:95],v8 offset:48
ds_read_b128 v[112:115],v18 offset:9216
s_waitcnt lgkmcnt(1)
v_and_b32 v124,v12,v88
v_and_b32 v125,v13,v88
v_and_b32 v126,v14,v88
v_and_b32 v127,v15,v88
s_nop 1
v_mfma_f32_16x16x32_bf16 v[116:119],v[124:127],v[108:111],v[116:119]
ds_read_b128 v[108:111],v18 offset:10240
s_waitcnt lgkmcnt(1)
v_and_b32 v124,v12,v89
v_and_b32 v125,v13,v89
v_and_b32 v126,v14,v89
v_and_b32 v127,v15,v89
s_nop 1
v_mfma_f32_16x16x32_bf16 v[116:119],v[124:127],v[112:115],v[116:119]
ds_read_b128 v[112:115],v18 offset:11264
s_waitcnt lgkmcnt(1)
v_and_b32 v124,v12,v90
v_and_b32 v125,v13,v90
v_and_b32 v126,v14,v90
v_and_b32 v127,v15,v90
s_nop 1
v_mfma_f32_16x16x32_bf16 v[116:119],v[124:127],v[108:111],v[116:119]
ds_read_b128 v[108:111],v18 offset:12288
s_waitcnt lgkmcnt(1)
v_and_b32 v124,v12,v91
v_and_b32 v125,v13,v91
v_and_b32 v126,v14,v91
v_and_b32 v127,v15,v91
s_nop 1
v_mfma_f32_16x16x32_bf16 v[116:119],v[124:127],v[112:115],v[116:119]
ds_read_b128 v[112:115],v18 offset:13312
s_waitcnt lgkmcnt(1)
v_and_b32 v124,v12,v92
v_and_b32 v125,v13,v92
v_and_b32 v126,v14,v92
v_and_b32 v127,v15,v92
s_nop 1
v_mfma_f32_16x16x32_bf16 v[116:119],v[124:127],v[108:111],v[116:119]
ds_read_b128 v[108:111],v18 offset:14336
s_waitcnt lgkmcnt(1)
v_and_b32 v124,v12,v93
v_and_b32 v125,v13,v93
v_and_b32 v126,v14,v93
v_and_b32 v127,v15,v93
s_nop 1
v_mfma_f32_16x16x32_bf16 v[116:119],v[124:127],v[112:115],v[116:119]
ds_read_b128 v[112:115],v18 offset:15360
s_waitcnt lgkmcnt(1)
v_and_b32 v124,v12,v94
v_and_b32 v125,v13,v94
v_and_b32 v126,v14,v94
v_and_b32 v127,v15,v94
s_nop 1
v_mfma_f32_16x16x32_bf16 v[116:119],v[124:127],v[108:111],v[116:119]
ds_read_b128 v[108:111],v18 offset:16384
s_waitcnt lgkmcnt(1)
v_and_b32 v124,v12,v95
v_and_b32 v125,v13,v95
v_and_b32 v126,v14,v95
v_and_b32 v127,v15,v95
s_nop 1
v_mfma_f32_16x16x32_bf16 v[116:119],v[124:127],v[112:115],v[116:119]
ds_read_b128 v[88:91],v8 offset:64
ds_read_b128 v[92:95],v8 offset:80
ds_read_b128 v[112:115],v18 offset:17408
s_waitcnt lgkmcnt(1)
v_and_b32 v124,v12,v88
v_and_b32 v125,v13,v88
v_and_b32 v126,v14,v88
v_and_b32 v127,v15,v88
s_nop 1
v_mfma_f32_16x16x32_bf16 v[116:119],v[124:127],v[108:111],v[116:119]
ds_read_b128 v[108:111],v18 offset:18432
s_waitcnt lgkmcnt(1)
v_and_b32 v124,v12,v89
v_and_b32 v125,v13,v89
v_and_b32 v126,v14,v89
v_and_b32 v127,v15,v89
s_nop 1
v_mfma_f32_16x16x32_bf16 v[116:119],v[124:127],v[112:115],v[116:119]
ds_read_b128 v[112:115],v18 offset:19456
s_waitcnt lgkmcnt(1)
v_and_b32 v124,v12,v90
v_and_b32 v125,v13,v90
v_and_b32 v126,v14,v90
v_and_b32 v127,v15,v90
s_nop 1
v_mfma_f32_16x16x32_bf16 v[116:119],v[124:127],v[108:111],v[116:119]
ds_read_b128 v[108:111],v18 offset:20480
s_waitcnt lgkmcnt(1)
v_and_b32 v124,v12,v91
v_and_b32 v125,v13,v91
v_and_b32 v126,v14,v91
v_and_b32 v127,v15,v91
s_nop 1
v_mfma_f32_16x16x32_bf16 v[116:119],v[124:127],v[112:115],v[116:119]
ds_read_b128 v[112:115],v18 offset:21504
s_waitcnt lgkmcnt(1)
v_and_b32 v124,v12,v92
v_and_b32 v125,v13,v92
v_and_b32 v126,v14,v92
v_and_b32 v127,v15,v92
s_nop 1
v_mfma_f32_16x16x32_bf16 v[116:119],v[124:127],v[108:111],v[116:119]
ds_read_b128 v[108:111],v18 offset:22528
s_waitcnt lgkmcnt(1)
v_and_b32 v124,v12,v93
v_and_b32 v125,v13,v93
v_and_b32 v126,v14,v93
v_and_b32 v127,v15,v93
s_nop 1
v_mfma_f32_16x16x32_bf16 v[116:119],v[124:127],v[112:115],v[116:119]
ds_read_b128 v[112:115],v18 offset:23552
s_waitcnt lgkmcnt(1)
v_and_b32 v124,v12,v94
v_and_b32 v125,v13,v94
v_and_b32 v126,v14,v94
v_and_b32 v127,v15,v94
s_nop 1
v_mfma_f32_16x16x32_bf16 v[116:119],v[124:127],v[108:111],v[116:119]
ds_read_b128 v[108:111],v18 offset:24576
s_waitcnt lgkmcnt(1)
v_and_b32 v124,v12,v95
v_and_b32 v125,v13,v95
v_and_b32 v126,v14,v95
v_and_b32 v127,v15,v95
s_nop 1
v_mfma_f32_16x16x32_bf16 v[116:119],v[124:127],v[112:115],v[116:119]
ds_read_b128 v[88:91],v8 offset:96
ds_read_b128 v[92:95],v8 offset:112
ds_read_b128 v[112:115],v18 offset:25600
s_waitcnt lgkmcnt(1)
v_and_b32 v124,v12,v88
v_and_b32 v125,v13,v88
v_and_b32 v126,v14,v88
v_and_b32 v127,v15,v88
s_nop 1
v_mfma_f32_16x16x32_bf16 v[116:119],v[124:127],v[108:111],v[116:119]
ds_read_b128 v[108:111],v18 offset:26624
s_waitcnt lgkmcnt(1)
v_and_b32 v124,v12,v89
v_and_b32 v125,v13,v89
v_and_b32 v126,v14,v89
v_and_b32 v127,v15,v89
s_nop 1
v_mfma_f32_16x16x32_bf16 v[116:119],v[124:127],v[112:115],v[116:119]
ds_read_b128 v[112:115],v18 offset:27648
s_waitcnt lgkmcnt(1)
v_and_b32 v124,v12,v90
v_and_b32 v125,v13,v90
v_and_b32 v126,v14,v90
v_and_b32 v127,v15,v90
s_nop 1
v_mfma_f32_16x16x32_bf16 v[116:119],v[124:127],v[108:111],v[116:119]
ds_read_b128 v[108:111],v18 offset:28672
s_waitcnt lgkmcnt(1)
v_and_b32 v124,v12,v91
v_and_b32 v125,v13,v91
v_and_b32 v126,v14,v91
v_and_b32 v127,v15,v91
s_nop 1
v_mfma_f32_16x16x32_bf16 v[116:119],v[124:127],v[112:115],v[116:119]
ds_read_b128 v[112:115],v18 offset:29696
s_waitcnt lgkmcnt(1)
v_and_b32 v124,v12,v92
v_and_b32 v125,v13,v92
v_and_b32 v126,v14,v92
v_and_b32 v127,v15,v92
s_nop 1
v_mfma_f32_16x16x32_bf16 v[116:119],v[124:127],v[108:111],v[116:119]
ds_read_b128 v[108:111],v18 offset:30720
s_waitcnt lgkmcnt(1)
v_and_b32 v124,v12,v93
v_and_b32 v125,v13,v93
v_and_b32 v126,v14,v93
v_and_b32 v127,v15,v93
s_nop 1
v_mfma_f32_16x16x32_bf16 v[116:119],v[124:127],v[112:115],v[116:119]
ds_read_b128 v[112:115],v18 offset:31744
s_waitcnt lgkmcnt(1)
v_and_b32 v124,v12,v94
v_and_b32 v125,v13,v94
v_and_b32 v126,v14,v94
v_and_b32 v127,v15,v94
s_nop 1
v_mfma_f32_16x16x32_bf16 v[116:119],v[124:127],v[108:111],v[116:119]
s_waitcnt lgkmcnt(0)
v_and_b32 v124,v12,v95
v_and_b32 v125,v13,v95
v_and_b32 v126,v14,v95
v_and_b32 v127,v15,v95
s_nop 1
v_mfma_f32_16x16x32_bf16 v[116:119],v[124:127],v[112:115],v[116:119]
v_lshlrev_b32 v8,5,v9
v_and_b32 v124,1,v10
v_lshl_add_u32 v8,v124,4,v8
v_lshrrev_b32 v124,1,v10
v_lshl_add_u32 v8,v124,11,v8
s_lshl_b32 s60,s46,9
s_add_u32 s60,s60,147456
v_add_u32 v8,s60,v8
ds_write_b128 v8,v[116:119]
v_lshlrev_b32 v8,2,v1
v_add_u32 v8,147456,v8
s_waitcnt lgkmcnt(0)
s_barrier
ds_read2st64_b32 v[88:89],v8 offset0:0 offset1:1
ds_read2st64_b32 v[90:91],v8 offset0:2 offset1:3
ds_read2st64_b32 v[92:93],v8 offset0:4 offset1:5
ds_read2st64_b32 v[94:95],v8 offset0:6 offset1:7
s_waitcnt lgkmcnt(0)
v_pk_add_f32 v[88:89],v[88:89],v[90:91]
v_pk_add_f32 v[92:93],v[92:93],v[94:95]
v_pk_add_f32 v[88:89],v[88:89],v[92:93]
v_cvt_pk_bf16_f32 v88,v88,v88
v_and_b32 v88,0xffff0000,v88
v_cvt_pk_bf16_f32 v89,v89,v89
v_and_b32 v89,0xffff0000,v89
v_mul_f32 v90,0xbfb8aa3b,v88
v_exp_f32 v90,v90
s_nop 0
v_add_f32 v90,1.0,v90
v_rcp_f32 v90,v90
s_nop 0
v_mul_f32 v88,v88,v90
v_cvt_pk_bf16_f32 v88,v88,v88
v_and_b32 v88,0xffff0000,v88
v_mul_f32 v88,v88,v89
v_cvt_pk_bf16_f32 v88,v88,v88
v_lshlrev_b32 v8,2,v1
v_add_u32 v8,s58,v8
ds_write_b32 v8,v88
v_lshlrev_b32 v8,6,v10
v_add_u32 v8,s58,v8
s_waitcnt lgkmcnt(0)
ds_read_b128 v[88:91],v8
ds_read_b128 v[92:95],v8 offset:16
ds_read_b128 v[108:111],v8 offset:32
ds_read_b128 v[112:115],v8 offset:48
s_waitcnt vmcnt(0) lgkmcnt(0)
v_and_b32 v124,v12,v88
v_and_b32 v125,v13,v88
v_and_b32 v126,v14,v88
v_and_b32 v127,v15,v88
s_nop 1
v_mfma_f32_16x16x32_bf16 v[116:119],v[124:127],v[24:27],0
v_and_b32 v124,v12,v89
v_and_b32 v125,v13,v89
v_and_b32 v126,v14,v89
v_and_b32 v127,v15,v89
s_nop 1
v_mfma_f32_16x16x32_bf16 v[116:119],v[124:127],v[28:31],v[116:119]
v_and_b32 v124,v12,v90
v_and_b32 v125,v13,v90
v_and_b32 v126,v14,v90
v_and_b32 v127,v15,v90
s_nop 1
v_mfma_f32_16x16x32_bf16 v[116:119],v[124:127],v[32:35],v[116:119]
v_and_b32 v124,v12,v91
v_and_b32 v125,v13,v91
v_and_b32 v126,v14,v91
v_and_b32 v127,v15,v91
s_nop 1
v_mfma_f32_16x16x32_bf16 v[116:119],v[124:127],v[36:39],v[116:119]
v_and_b32 v124,v12,v92
v_and_b32 v125,v13,v92
v_and_b32 v126,v14,v92
v_and_b32 v127,v15,v92
s_nop 1
v_mfma_f32_16x16x32_bf16 v[116:119],v[124:127],v[40:43],v[116:119]
v_and_b32 v124,v12,v93
v_and_b32 v125,v13,v93
v_and_b32 v126,v14,v93
v_and_b32 v127,v15,v93
s_nop 1
v_mfma_f32_16x16x32_bf16 v[116:119],v[124:127],v[44:47],v[116:119]
v_and_b32 v124,v12,v94
v_and_b32 v125,v13,v94
v_and_b32 v126,v14,v94
v_and_b32 v127,v15,v94
s_nop 1
v_mfma_f32_16x16x32_bf16 v[116:119],v[124:127],v[48:51],v[116:119]
v_and_b32 v124,v12,v95
v_and_b32 v125,v13,v95
v_and_b32 v126,v14,v95
v_and_b32 v127,v15,v95
s_nop 1
v_mfma_f32_16x16x32_bf16 v[116:119],v[124:127],v[52:55],v[116:119]
v_and_b32 v124,v12,v108
v_and_b32 v125,v13,v108
v_and_b32 v126,v14,v108
v_and_b32 v127,v15,v108
s_nop 1
v_mfma_f32_16x16x32_bf16 v[116:119],v[124:127],v[56:59],v[116:119]
v_and_b32 v124,v12,v109
v_and_b32 v125,v13,v109
v_and_b32 v126,v14,v109
v_and_b32 v127,v15,v109
s_nop 1
v_mfma_f32_16x16x32_bf16 v[116:119],v[124:127],v[60:63],v[116:119]
v_and_b32 v124,v12,v110
v_and_b32 v125,v13,v110
v_and_b32 v126,v14,v110
v_and_b32 v127,v15,v110
s_nop 1
v_mfma_f32_16x16x32_bf16 v[116:119],v[124:127],v[64:67],v[116:119]
v_and_b32 v124,v12,v111
v_and_b32 v125,v13,v111
v_and_b32 v126,v14,v111
v_and_b32 v127,v15,v111
s_nop 1
v_mfma_f32_16x16x32_bf16 v[116:119],v[124:127],v[68:71],v[116:119]
v_and_b32 v124,v12,v112
v_and_b32 v125,v13,v112
v_and_b32 v126,v14,v112
v_and_b32 v127,v15,v112
s_nop 1
v_mfma_f32_16x16x32_bf16 v[116:119],v[124:127],v[72:75],v[116:119]
v_and_b32 v124,v12,v113
v_and_b32 v125,v13,v113
v_and_b32 v126,v14,v113
v_and_b32 v127,v15,v113
s_nop 1
v_mfma_f32_16x16x32_bf16 v[116:119],v[124:127],v[76:79],v[116:119]
v_and_b32 v124,v12,v114
v_and_b32 v125,v13,v114
v_and_b32 v126,v14,v114
v_and_b32 v127,v15,v114
s_nop 1
v_mfma_f32_16x16x32_bf16 v[116:119],v[124:127],v[80:83],v[116:119]
v_and_b32 v124,v12,v115
v_and_b32 v125,v13,v115
v_and_b32 v126,v14,v115
v_and_b32 v127,v15,v115
s_nop 1
v_mfma_f32_16x16x32_bf16 v[116:119],v[124:127],v[84:87],v[116:119]
v_lshlrev_b32 v8,4,v9
v_and_b32 v124,1,v10
v_lshl_add_u32 v8,v124,3,v8
v_and_b32 v124,2,v10
v_lshl_add_u32 v8,v124,30,v8
s_lshl_b32 s65,s51,15
s_add_u32 s65,s65,92274688
s_lshl_b32 s59,s47,10
s_lshl_b32 s60,s46,8
s_add_u32 s59,s59,s60
s_add_u32 s59,s59,s65
v_cvt_pk_bf16_f32 v24,v116,v117
v_cvt_pk_bf16_f32 v25,v118,v119
buffer_store_dwordx2 v[24:25],v8,s[8:11],s59 offen sc1
s_lshl_b32 s59,s51,13
s_lshl2_add_u32 s59,s47,s59
s_add_u32 s59,s59,10486912
s_waitcnt vmcnt(0)
s_barrier
s_or_b32 s59,s59,s52
buffer_store_dword v17,off,s[8:11],s59 sc1
s_lshl_b32 s59,s51,13
s_add_u32 s59,s59,10486912
v_and_b32 v124,31,v1
v_lshlrev_b32 v124,2,v124
L_fw_376:
buffer_load_dword v125,v124,s[8:11],s59 offen sc1
s_sub_u32 s49,s49,1
s_cbranch_scc1 L_abort2
s_waitcnt vmcnt(0)
v_cmp_eq_u32 vcc,0,v125
s_cbranch_vccnz L_fw_376
s_add_u32 s63,s65,0
buffer_load_dwordx4 v[24:27],v22,s[8:11],s63 offen sc1
s_add_u32 s63,s65,4096
buffer_load_dwordx4 v[28:31],v22,s[8:11],s63 offen sc1
s_add_u32 s63,s65,8192
buffer_load_dwordx4 v[32:35],v22,s[8:11],s63 offen sc1
s_add_u32 s63,s65,12288
buffer_load_dwordx4 v[36:39],v22,s[8:11],s63 offen sc1
s_add_u32 s63,s65,16384
buffer_load_dwordx4 v[40:43],v22,s[8:11],s63 offen sc1
s_add_u32 s63,s65,20480
buffer_load_dwordx4 v[44:47],v22,s[8:11],s63 offen sc1
s_add_u32 s63,s65,24576
buffer_load_dwordx4 v[48:51],v22,s[8:11],s63 offen sc1
s_add_u32 s63,s65,28672
buffer_load_dwordx4 v[52:55],v22,s[8:11],s63 offen sc1
v_and_b32 v64,15,v1
v_and_b32 v65,1,v1
v_lshlrev_b32 v65,4,v65
v_mov_b32 v66,0x3f80
v_lshlrev_b32 v66,v65,v66
v_lshrrev_b32 v64,1,v64
v_cmp_eq_u32 vcc,0,v64
s_nop 1
v_cndmask_b32 v56,0,v66,vcc
v_cmp_eq_u32 vcc,1,v64
s_nop 1
v_cndmask_b32 v57,0,v66,vcc
v_cmp_eq_u32 vcc,2,v64
s_nop 1
v_cndmask_b32 v58,0,v66,vcc
v_cmp_eq_u32 vcc,3,v64
s_nop 1
v_cndmask_b32 v59,0,v66,vcc
s_waitcnt vmcnt(7)
s_nop 0
v_mfma_f32_16x16x32_bf16 v[60:63],v[56:59],v[24:27],0
s_waitcnt vmcnt(6)
v_mfma_f32_16x16x32_bf16 v[60:63],v[56:59],v[28:31],v[60:63]
s_waitcnt vmcnt(5)
v_mfma_f32_16x16x32_bf16 v[60:63],v[56:59],v[32:35],v[60:63]
s_waitcnt vmcnt(4)
v_mfma_f32_16x16x32_bf16 v[60:63],v[56:59],v[36:39],v[60:63]
s_waitcnt vmcnt(3)
v_mfma_f32_16x16x32_bf16 v[60:63],v[56:59],v[40:43],v[60:63]
s_waitcnt vmcnt(2)
v_mfma_f32_16x16x32_bf16 v[60:63],v[56:59],v[44:47],v[60:63]
s_waitcnt vmcnt(1)
v_mfma_f32_16x16x32_bf16 v[60:63],v[56:59],v[48:51],v[60:63]
s_waitcnt vmcnt(0)
v_mfma_f32_16x16x32_bf16 v[60:63],v[56:59],v[52:55],v[60:63]
s_nop 7
ds_write_b128 v21,v[60:63]
s_waitcnt lgkmcnt(0)
s_barrier
s_cmp_lg_u32 s46,0
s_cbranch_scc1 L_moed_375
v_lshlrev_b32 v56,5,v1
v_add_u32 v56,155648,v56
ds_read_b128 v[24:27],v56
ds_read_b128 v[28:31],v56 offset:16
s_and_b32 s59,s54,0xffff0000
s_xor_b32 s60,s59,0x80000000
s_xor_b32 s61,s59,0xffff0000
s_cmp_lt_i32 s59,0
s_cselect_b32 s59,s60,s61
v_mov_b32 v56,s59
v_mul_f32 v56,0xbfb8aa3b,v56
v_exp_f32 v56,v56
s_nop 0
v_add_f32 v56,1.0,v56
v_rcp_f32 v56,v56
s_nop 0
v_cvt_pk_bf16_f32 v56,v56,v56
v_and_b32 v56,0xffff0000,v56
v_lshlrev_b32 v48,16,v104
v_and_b32 v49,0xffff0000,v104
v_lshlrev_b32 v50,16,v105
v_and_b32 v51,0xffff0000,v105
v_lshlrev_b32 v52,16,v106
v_and_b32 v53,0xffff0000,v106
v_lshlrev_b32 v54,16,v107
v_and_b32 v55,0xffff0000,v107
s_waitcnt lgkmcnt(0)
v_cvt_pk_bf16_f32 v40,v24,v25
v_cvt_pk_bf16_f32 v41,v26,v27
v_cvt_pk_bf16_f32 v42,v28,v29
v_cvt_pk_bf16_f32 v43,v30,v31
v_lshlrev_b32 v24,16,v40
v_and_b32 v25,0xffff0000,v40
v_lshlrev_b32 v26,16,v41
v_and_b32 v27,0xffff0000,v41
v_lshlrev_b32 v28,16,v42
v_and_b32 v29,0xffff0000,v42
v_lshlrev_b32 v30,16,v43
v_and_b32 v31,0xffff0000,v43
v_mul_f32 v24,v24,v56
v_mul_f32 v25,v25,v56
v_mul_f32 v26,v26,v56
v_mul_f32 v27,v27,v56
v_mul_f32 v28,v28,v56
v_mul_f32 v29,v29,v56
v_mul_f32 v30,v30,v56
v_mul_f32 v31,v31,v56
v_cvt_pk_bf16_f32 v40,v24,v25
v_cvt_pk_bf16_f32 v41,v26,v27
v_cvt_pk_bf16_f32 v42,v28,v29
v_cvt_pk_bf16_f32 v43,v30,v31
v_lshlrev_b32 v24,16,v40
v_and_b32 v25,0xffff0000,v40
v_lshlrev_b32 v26,16,v41
v_and_b32 v27,0xffff0000,v41
v_lshlrev_b32 v28,16,v42
v_and_b32 v29,0xffff0000,v42
v_lshlrev_b32 v30,16,v43
v_and_b32 v31,0xffff0000,v43
v_add_f32 v24,v24,v48
v_add_f32 v25,v25,v49
v_add_f32 v26,v26,v50
v_add_f32 v27,v27,v51
v_add_f32 v28,v28,v52
v_add_f32 v29,v29,v53
v_add_f32 v30,v30,v54
v_add_f32 v31,v31,v55
v_cvt_pk_bf16_f32 v40,v24,v25
v_cvt_pk_bf16_f32 v41,v26,v27
v_cvt_pk_bf16_f32 v42,v28,v29
v_cvt_pk_bf16_f32 v43,v30,v31
v_lshlrev_b32 v24,16,v40
v_and_b32 v25,0xffff0000,v40
v_lshlrev_b32 v26,16,v41
v_and_b32 v27,0xffff0000,v41
v_lshlrev_b32 v28,16,v42
v_and_b32 v29,0xffff0000,v42
v_lshlrev_b32 v30,16,v43
v_and_b32 v31,0xffff0000,v43
v_add_f32 v96,v96,v24
v_add_f32 v97,v97,v25
v_add_f32 v98,v98,v26
v_add_f32 v99,v99,v27
v_add_f32 v100,v100,v28
v_add_f32 v101,v101,v29
v_add_f32 v102,v102,v30
v_add_f32 v103,v103,v31
v_cvt_pk_bf16_f32 v80,v96,v97
v_cvt_pk_bf16_f32 v81,v98,v99
v_cvt_pk_bf16_f32 v82,v100,v101
v_cvt_pk_bf16_f32 v83,v102,v103
v_lshlrev_b32 v96,16,v80
v_and_b32 v97,0xffff0000,v80
v_lshlrev_b32 v98,16,v81
v_and_b32 v99,0xffff0000,v81
v_lshlrev_b32 v100,16,v82
v_and_b32 v101,0xffff0000,v82
v_lshlrev_b32 v102,16,v83
v_and_b32 v103,0xffff0000,v83
v_readfirstlane_b32 s78,v96
s_nop 1
v_pk_add_f32 v[58:59],v[96:97],s[78:79] op_sel_hi:[1,0] neg_lo:[0,1] neg_hi:[0,1]
v_pk_add_f32 v[60:61],v[98:99],s[78:79] op_sel_hi:[1,0] neg_lo:[0,1] neg_hi:[0,1]
v_pk_add_f32 v[62:63],v[100:101],s[78:79] op_sel_hi:[1,0] neg_lo:[0,1] neg_hi:[0,1]
v_pk_add_f32 v[64:65],v[102:103],s[78:79] op_sel_hi:[1,0] neg_lo:[0,1] neg_hi:[0,1]
v_pk_add_f32 v[66:67],v[58:59],v[60:61]
v_pk_mul_f32 v[68:69],v[58:59],v[58:59]
v_pk_add_f32 v[70:71],v[62:63],v[64:65]
v_pk_fma_f32 v[68:69],v[60:61],v[60:61],v[68:69]
v_pk_add_f32 v[66:67],v[66:67],v[70:71]
v_pk_fma_f32 v[68:69],v[62:63],v[62:63],v[68:69]
v_add_f32 v66,v66,v67
v_pk_fma_f32 v[68:69],v[64:65],v[64:65],v[68:69]
v_add_f32 v68,v68,v69
s_nop 1
v_permlane32_swap_b32 v66,v68
v_add_f32 v66,v66,v68
s_nop 1
v_add_f32_dpp v66,v66,v66 row_ror:8 row_mask:0xf bank_mask:0xf
s_nop 1
v_add_f32_dpp v66,v66,v66 row_ror:4 row_mask:0xf bank_mask:0xf
s_nop 1
v_add_f32_dpp v66,v66,v66 row_ror:2 row_mask:0xf bank_mask:0xf
s_nop 1
v_add_f32_dpp v66,v66,v66 row_ror:1 row_mask:0xf bank_mask:0xf
v_mov_b32 v68,v66
s_nop 1
v_permlane16_swap_b32 v66,v68
v_add_f32 v66,v66,v68
v_mul_f32 v66,0x3b000000,v66
v_mov_b32 v68,v66
s_nop 1
v_permlane32_swap_b32 v66,v68
v_fma_f32 v68,-v66,v66,v68
v_add_f32 v66,s78,v66
v_max_f32 v68,0,v68
v_cvt_pk_bf16_f32 v68,v66,v68
v_lshlrev_b32 v66,16,v68
v_and_b32 v68,0xffff0000,v68
v_add_f32 v68,0x3727c5ac,v68
v_cvt_pk_bf16_f32 v68,v68,v68
v_and_b32 v68,0xffff0000,v68
v_sqrt_f32 v68,v68
v_pk_add_f32 v[58:59],v[96:97],v[66:67] op_sel_hi:[1,0] neg_lo:[0,1] neg_hi:[0,1]
v_pk_add_f32 v[60:61],v[98:99],v[66:67] op_sel_hi:[1,0] neg_lo:[0,1] neg_hi:[0,1]
v_pk_add_f32 v[62:63],v[100:101],v[66:67] op_sel_hi:[1,0] neg_lo:[0,1] neg_hi:[0,1]
v_pk_add_f32 v[64:65],v[102:103],v[66:67] op_sel_hi:[1,0] neg_lo:[0,1] neg_hi:[0,1]
v_cvt_pk_bf16_f32 v68,v68,v68
v_and_b32 v68,0xffff0000,v68
v_rcp_f32 v68,v68
v_cvt_pk_bf16_f32 v84,v58,v59
v_cvt_pk_bf16_f32 v85,v60,v61
v_cvt_pk_bf16_f32 v86,v62,v63
v_cvt_pk_bf16_f32 v87,v64,v65
v_lshlrev_b32 v58,16,v84
v_and_b32 v59,0xffff0000,v84
v_lshlrev_b32 v60,16,v85
v_and_b32 v61,0xffff0000,v85
v_lshlrev_b32 v62,16,v86
v_and_b32 v63,0xffff0000,v86
v_lshlrev_b32 v64,16,v87
v_and_b32 v65,0xffff0000,v87
v_pk_mul_f32 v[58:59],v[58:59],v[68:69] op_sel_hi:[1,0]
v_pk_mul_f32 v[60:61],v[60:61],v[68:69] op_sel_hi:[1,0]
v_pk_mul_f32 v[62:63],v[62:63],v[68:69] op_sel_hi:[1,0]
v_pk_mul_f32 v[64:65],v[64:65],v[68:69] op_sel_hi:[1,0]
v_cvt_pk_bf16_f32 v84,v58,v59
v_cvt_pk_bf16_f32 v85,v60,v61
v_cvt_pk_bf16_f32 v86,v62,v63
v_cvt_pk_bf16_f32 v87,v64,v65
s_lshl_b32 s58,s51,10
s_add_u32 s58,s58,11272192
s_add_u32 s59,s58,65536
s_cmp_eq_u32 s47,0
s_cselect_b32 s59,s59,0x80000000
s_add_u32 s57,s56,98566144
buffer_store_dwordx4 v[84:87],v0,s[8:11],s59 offen sc1
buffer_store_dwordx4 v[80:83],v0,s[8:11],s58 offen sc1
buffer_store_dwordx4 v[84:87],v0,s[8:11],s57 offen sc1
L_moed_375:
s_barrier
L_mo_362:
s_mov_b32 s77,-1
s_cmp_lt_u32 s31,64
s_cbranch_scc1 L_mo_358
s_cmp_eq_u32 s86,0
s_cbranch_scc1 L_mo_371
L_mo_364:
s_andn2_b32 s51,0x7ff,s54
s_lshr_b32 s51,s51,5
s_andn2_b32 s56,31,s54
v_lshrrev_b32 v2,10,v20
v_add_u32 v3,16,v2
v_add_u32 v8,96468992,v20
v_cmp_eq_u32 vcc,s56,v2
s_nop 1
v_cndmask_b32 v2,v20,v8,vcc
v_cmp_eq_u32 vcc,s56,v3
s_nop 1
v_cndmask_b32 v3,v20,v8,vcc
s_waitcnt vmcnt(0)
s_lshl_b32 s59,s51,13
s_add_u32 s59,s59,10487552
s_cmp_lg_u32 s46,0
s_cbranch_scc1 L_fd_380
v_and_b32 v124,31,v1
v_lshlrev_b32 v124,2,v124
s_branch L_ff_381
L_fw_379:
s_sleep 2
L_ff_381:
buffer_load_dword v125,v124,s[8:11],s59 offen sc1
s_sub_u32 s49,s49,1
s_cbranch_scc1 L_abort2
s_waitcnt vmcnt(0)
v_cmp_eq_u32 vcc,0,v125
s_cbranch_vccnz L_fw_379
L_fd_380:
s_barrier
s_or_b32 s72,s72,s52
buffer_store_dword v17,off,s[8:11],s72 sc1
s_lshl_b32 s66,s51,15
s_add_u32 s66,s66,2097152
s_add_u32 s67,s66,16384
s_add_u32 m0,s50,131072
s_nop 0
buffer_load_dwordx4 v2,s[8:11],s66 offen offset:0 sc1 lds
s_add_u32 m0,s50,135168
s_nop 0
buffer_load_dwordx4 v3,s[8:11],s67 offen offset:0 sc1 lds
s_add_u32 m0,s50,139008
s_nop 0
buffer_load_dwordx4 v2,s[8:11],s66 offen offset:256 sc1 lds
s_add_u32 m0,s50,143104
s_nop 0
buffer_load_dwordx4 v3,s[8:11],s67 offen offset:256 sc1 lds
s_add_u32 m0,s50,146944
s_nop 0
buffer_load_dwordx4 v2,s[8:11],s66 offen offset:512 sc1 lds
s_add_u32 m0,s50,151040
s_nop 0
buffer_load_dwordx4 v3,s[8:11],s67 offen offset:512 sc1 lds
s_waitcnt vmcnt(4)
s_barrier
ds_read_b128 v[104:107],v4 offset:0
ds_read_b128 v[108:111],v4 offset:4096
ds_read_b128 v[112:115],v5 offset:0
ds_read_b128 v[116:119],v5 offset:4096
s_add_u32 m0,s50,154880
s_nop 0
buffer_load_dwordx4 v2,s[8:11],s66 offen offset:768 sc1 lds
s_add_u32 m0,s50,158976
s_nop 0
buffer_load_dwordx4 v3,s[8:11],s67 offen offset:768 sc1 lds
s_waitcnt lgkmcnt(2)
v_mfma_f32_16x16x32_bf16 v[24:27],a[128:131],v[104:107],0
ds_read_b128 v[120:123],v6 offset:0
v_mfma_f32_16x16x32_bf16 v[40:43],v[104:107],v[128:131],0
s_lshl_b32 s58,s51,5
v_mfma_f32_16x16x32_bf16 v[28:31],a[128:131],v[108:111],0
ds_read_b128 v[124:127],v6 offset:4096
v_mfma_f32_16x16x32_bf16 v[44:47],v[108:111],v[128:131],0
s_add_u32 s58,s58,s47
v_mfma_f32_16x16x32_bf16 v[32:35],a[136:139],v[104:107],0
s_mul_i32 s58,s58,24576
v_mfma_f32_16x16x32_bf16 v[48:51],v[104:107],v[136:139],0
s_add_u32 s58,s58,201326592
v_mfma_f32_16x16x32_bf16 v[36:39],a[136:139],v[108:111],0
s_add_u32 s61,s58,s50
v_mfma_f32_16x16x32_bf16 v[52:55],v[108:111],v[136:139],0
s_add_u32 s62,s61,4096
s_waitcnt lgkmcnt(2)
v_mfma_f32_16x16x32_bf16 v[24:27],a[132:135],v[112:115],v[24:27]
ds_read_b128 v[104:107],v7 offset:0
v_mfma_f32_16x16x32_bf16 v[40:43],v[112:115],v[132:135],v[40:43]
s_add_u32 s63,s61,16384
v_mfma_f32_16x16x32_bf16 v[28:31],a[132:135],v[116:119],v[28:31]
ds_read_b128 v[108:111],v7 offset:4096
v_mfma_f32_16x16x32_bf16 v[44:47],v[116:119],v[132:135],v[44:47]
s_add_u32 s64,s61,20480
v_mfma_f32_16x16x32_bf16 v[32:35],a[140:143],v[112:115],v[32:35]
s_add_u32 s65,s61,s50
v_mfma_f32_16x16x32_bf16 v[48:51],v[112:115],v[140:143],v[48:51]
s_add_u32 s65,s65,8192
v_mfma_f32_16x16x32_bf16 v[36:39],a[140:143],v[116:119],v[36:39]
v_mfma_f32_16x16x32_bf16 v[52:55],v[116:119],v[140:143],v[52:55]
s_waitcnt vmcnt(4)
s_barrier
s_waitcnt lgkmcnt(2)
v_mfma_f32_16x16x32_bf16 v[24:27],a[144:147],v[120:123],v[24:27]
ds_read_b128 v[112:115],v4 offset:8192
v_mfma_f32_16x16x32_bf16 v[40:43],v[120:123],v[144:147],v[40:43]
v_mfma_f32_16x16x32_bf16 v[28:31],a[144:147],v[124:127],v[28:31]
ds_read_b128 v[116:119],v4 offset:12288
v_mfma_f32_16x16x32_bf16 v[44:47],v[124:127],v[144:147],v[44:47]
v_mfma_f32_16x16x32_bf16 v[32:35],a[152:155],v[120:123],v[32:35]
v_mfma_f32_16x16x32_bf16 v[48:51],v[120:123],v[152:155],v[48:51]
v_mfma_f32_16x16x32_bf16 v[36:39],a[152:155],v[124:127],v[36:39]
v_mfma_f32_16x16x32_bf16 v[52:55],v[124:127],v[152:155],v[52:55]
s_waitcnt lgkmcnt(2)
v_mfma_f32_16x16x32_bf16 v[24:27],a[148:151],v[104:107],v[24:27]
ds_read_b128 v[120:123],v5 offset:8192
v_mfma_f32_16x16x32_bf16 v[40:43],v[104:107],v[148:151],v[40:43]
v_mfma_f32_16x16x32_bf16 v[28:31],a[148:151],v[108:111],v[28:31]
ds_read_b128 v[124:127],v5 offset:12288
v_mfma_f32_16x16x32_bf16 v[44:47],v[108:111],v[148:151],v[44:47]
v_mfma_f32_16x16x32_bf16 v[32:35],a[156:159],v[104:107],v[32:35]
v_mfma_f32_16x16x32_bf16 v[48:51],v[104:107],v[156:159],v[48:51]
v_mfma_f32_16x16x32_bf16 v[36:39],a[156:159],v[108:111],v[36:39]
v_mfma_f32_16x16x32_bf16 v[52:55],v[108:111],v[156:159],v[52:55]
s_waitcnt lgkmcnt(2)
v_mfma_f32_16x16x32_bf16 v[24:27],a[160:163],v[112:115],v[24:27]
ds_read_b128 v[104:107],v6 offset:8192
v_mfma_f32_16x16x32_bf16 v[40:43],v[112:115],v[160:163],v[40:43]
v_mfma_f32_16x16x32_bf16 v[28:31],a[160:163],v[116:119],v[28:31]
ds_read_b128 v[108:111],v6 offset:12288
v_mfma_f32_16x16x32_bf16 v[44:47],v[116:119],v[160:163],v[44:47]
v_mfma_f32_16x16x32_bf16 v[32:35],a[168:171],v[112:115],v[32:35]
v_mfma_f32_16x16x32_bf16 v[48:51],v[112:115],v[168:171],v[48:51]
v_mfma_f32_16x16x32_bf16 v[36:39],a[168:171],v[116:119],v[36:39]
v_mfma_f32_16x16x32_bf16 v[52:55],v[116:119],v[168:171],v[52:55]
s_waitcnt lgkmcnt(2)
v_mfma_f32_16x16x32_bf16 v[24:27],a[164:167],v[120:123],v[24:27]
ds_read_b128 v[112:115],v7 offset:8192
v_mfma_f32_16x16x32_bf16 v[40:43],v[120:123],v[164:167],v[40:43]
v_mfma_f32_16x16x32_bf16 v[28:31],a[164:167],v[124:127],v[28:31]
ds_read_b128 v[116:119],v7 offset:12288
v_mfma_f32_16x16x32_bf16 v[44:47],v[124:127],v[164:167],v[44:47]
v_mfma_f32_16x16x32_bf16 v[32:35],a[172:175],v[120:123],v[32:35]
v_mfma_f32_16x16x32_bf16 v[48:51],v[120:123],v[172:175],v[48:51]
v_mfma_f32_16x16x32_bf16 v[36:39],a[172:175],v[124:127],v[36:39]
v_mfma_f32_16x16x32_bf16 v[52:55],v[124:127],v[172:175],v[52:55]
s_waitcnt vmcnt(2)
s_barrier
s_waitcnt lgkmcnt(2)
v_mfma_f32_16x16x32_bf16 v[24:27],a[176:179],v[104:107],v[24:27]
ds_read_b128 v[120:123],v4 offset:16384
v_mfma_f32_16x16x32_bf16 v[40:43],v[104:107],v[176:179],v[40:43]
v_mfma_f32_16x16x32_bf16 v[28:31],a[176:179],v[108:111],v[28:31]
ds_read_b128 v[124:127],v4 offset:20480
v_mfma_f32_16x16x32_bf16 v[44:47],v[108:111],v[176:179],v[44:47]
v_mfma_f32_16x16x32_bf16 v[32:35],a[184:187],v[104:107],v[32:35]
v_mfma_f32_16x16x32_bf16 v[48:51],v[104:107],v[184:187],v[48:51]
v_mfma_f32_16x16x32_bf16 v[36:39],a[184:187],v[108:111],v[36:39]
v_mfma_f32_16x16x32_bf16 v[52:55],v[108:111],v[184:187],v[52:55]
s_waitcnt lgkmcnt(2)
v_mfma_f32_16x16x32_bf16 v[24:27],a[180:183],v[112:115],v[24:27]
ds_read_b128 v[104:107],v5 offset:16384
v_mfma_f32_16x16x32_bf16 v[40:43],v[112:115],v[180:183],v[40:43]
v_mfma_f32_16x16x32_bf16 v[28:31],a[180:183],v[116:119],v[28:31]
ds_read_b128 v[108:111],v5 offset:20480
v_mfma_f32_16x16x32_bf16 v[44:47],v[116:119],v[180:183],v[44:47]
v_mfma_f32_16x16x32_bf16 v[32:35],a[188:191],v[112:115],v[32:35]
v_mfma_f32_16x16x32_bf16 v[48:51],v[112:115],v[188:191],v[48:51]
v_mfma_f32_16x16x32_bf16 v[36:39],a[188:191],v[116:119],v[36:39]
v_mfma_f32_16x16x32_bf16 v[52:55],v[116:119],v[188:191],v[52:55]
s_waitcnt lgkmcnt(2)
v_mfma_f32_16x16x32_bf16 v[24:27],a[192:195],v[120:123],v[24:27]
ds_read_b128 v[112:115],v6 offset:16384
v_mfma_f32_16x16x32_bf16 v[40:43],v[120:123],v[192:195],v[40:43]
v_mfma_f32_16x16x32_bf16 v[28:31],a[192:195],v[124:127],v[28:31]
ds_read_b128 v[116:119],v6 offset:20480
v_mfma_f32_16x16x32_bf16 v[44:47],v[124:127],v[192:195],v[44:47]
v_mfma_f32_16x16x32_bf16 v[32:35],a[200:203],v[120:123],v[32:35]
v_mfma_f32_16x16x32_bf16 v[48:51],v[120:123],v[200:203],v[48:51]
v_mfma_f32_16x16x32_bf16 v[36:39],a[200:203],v[124:127],v[36:39]
v_mfma_f32_16x16x32_bf16 v[52:55],v[124:127],v[200:203],v[52:55]
s_waitcnt lgkmcnt(2)
v_mfma_f32_16x16x32_bf16 v[24:27],a[196:199],v[104:107],v[24:27]
ds_read_b128 v[120:123],v7 offset:16384
v_mfma_f32_16x16x32_bf16 v[40:43],v[104:107],v[196:199],v[40:43]
v_mfma_f32_16x16x32_bf16 v[28:31],a[196:199],v[108:111],v[28:31]
ds_read_b128 v[124:127],v7 offset:20480
v_mfma_f32_16x16x32_bf16 v[44:47],v[108:111],v[196:199],v[44:47]
v_mfma_f32_16x16x32_bf16 v[32:35],a[204:207],v[104:107],v[32:35]
v_mfma_f32_16x16x32_bf16 v[48:51],v[104:107],v[204:207],v[48:51]
v_mfma_f32_16x16x32_bf16 v[36:39],a[204:207],v[108:111],v[36:39]
v_mfma_f32_16x16x32_bf16 v[52:55],v[108:111],v[204:207],v[52:55]
s_waitcnt vmcnt(0)
s_barrier
s_waitcnt lgkmcnt(2)
v_mfma_f32_16x16x32_bf16 v[24:27],a[208:211],v[112:115],v[24:27]
ds_read_b128 v[104:107],v4 offset:24576
v_mfma_f32_16x16x32_bf16 v[40:43],v[112:115],v[208:211],v[40:43]
v_mfma_f32_16x16x32_bf16 v[28:31],a[208:211],v[116:119],v[28:31]
ds_read_b128 v[108:111],v4 offset:28672
v_mfma_f32_16x16x32_bf16 v[44:47],v[116:119],v[208:211],v[44:47]
v_mfma_f32_16x16x32_bf16 v[32:35],a[216:219],v[112:115],v[32:35]
v_mfma_f32_16x16x32_bf16 v[48:51],v[112:115],v[216:219],v[48:51]
v_mfma_f32_16x16x32_bf16 v[36:39],a[216:219],v[116:119],v[36:39]
v_mfma_f32_16x16x32_bf16 v[52:55],v[116:119],v[216:219],v[52:55]
s_waitcnt lgkmcnt(2)
v_mfma_f32_16x16x32_bf16 v[24:27],a[212:215],v[120:123],v[24:27]
ds_read_b128 v[112:115],v5 offset:24576
v_mfma_f32_16x16x32_bf16 v[40:43],v[120:123],v[212:215],v[40:43]
v_mfma_f32_16x16x32_bf16 v[28:31],a[212:215],v[124:127],v[28:31]
ds_read_b128 v[116:119],v5 offset:28672
v_mfma_f32_16x16x32_bf16 v[44:47],v[124:127],v[212:215],v[44:47]
v_mfma_f32_16x16x32_bf16 v[32:35],a[220:223],v[120:123],v[32:35]
v_mfma_f32_16x16x32_bf16 v[48:51],v[120:123],v[220:223],v[48:51]
v_mfma_f32_16x16x32_bf16 v[36:39],a[220:223],v[124:127],v[36:39]
v_mfma_f32_16x16x32_bf16 v[52:55],v[124:127],v[220:223],v[52:55]
s_waitcnt lgkmcnt(2)
v_mfma_f32_16x16x32_bf16 v[24:27],a[224:227],v[104:107],v[24:27]
ds_read_b128 v[120:123],v6 offset:24576
v_mfma_f32_16x16x32_bf16 v[40:43],v[104:107],v[224:227],v[40:43]
v_mfma_f32_16x16x32_bf16 v[28:31],a[224:227],v[108:111],v[28:31]
ds_read_b128 v[124:127],v6 offset:28672
v_mfma_f32_16x16x32_bf16 v[44:47],v[108:111],v[224:227],v[44:47]
v_mfma_f32_16x16x32_bf16 v[32:35],a[232:235],v[104:107],v[32:35]
v_mfma_f32_16x16x32_bf16 v[48:51],v[104:107],v[232:235],v[48:51]
v_mfma_f32_16x16x32_bf16 v[36:39],a[232:235],v[108:111],v[36:39]
v_mfma_f32_16x16x32_bf16 v[52:55],v[108:111],v[232:235],v[52:55]
s_waitcnt lgkmcnt(2)
v_mfma_f32_16x16x32_bf16 v[24:27],a[228:231],v[112:115],v[24:27]
ds_read_b128 v[104:107],v7 offset:24576
v_mfma_f32_16x16x32_bf16 v[40:43],v[112:115],v[228:231],v[40:43]
v_mfma_f32_16x16x32_bf16 v[28:31],a[228:231],v[116:119],v[28:31]
ds_read_b128 v[108:111],v7 offset:28672
v_mfma_f32_16x16x32_bf16 v[44:47],v[116:119],v[228:231],v[44:47]
v_mfma_f32_16x16x32_bf16 v[32:35],a[236:239],v[112:115],v[32:35]
v_mfma_f32_16x16x32_bf16 v[48:51],v[112:115],v[236:239],v[48:51]
v_mfma_f32_16x16x32_bf16 v[36:39],a[236:239],v[116:119],v[36:39]
v_mfma_f32_16x16x32_bf16 v[52:55],v[116:119],v[236:239],v[52:55]
s_waitcnt lgkmcnt(2)
v_mfma_f32_16x16x32_bf16 v[24:27],a[240:243],v[120:123],v[24:27]
ds_read_b128 v[112:115],v4 offset:0
v_mfma_f32_16x16x32_bf16 v[40:43],v[120:123],v[240:243],v[40:43]
v_mfma_f32_16x16x32_bf16 v[28:31],a[240:243],v[124:127],v[28:31]
ds_read_b128 v[116:119],v4 offset:4096
v_mfma_f32_16x16x32_bf16 v[44:47],v[124:127],v[240:243],v[44:47]
v_mfma_f32_16x16x32_bf16 v[32:35],a[248:251],v[120:123],v[32:35]
v_mfma_f32_16x16x32_bf16 v[48:51],v[120:123],v[248:251],v[48:51]
v_mfma_f32_16x16x32_bf16 v[36:39],a[248:251],v[124:127],v[36:39]
v_mfma_f32_16x16x32_bf16 v[52:55],v[124:127],v[248:251],v[52:55]
s_waitcnt lgkmcnt(2)
v_mfma_f32_16x16x32_bf16 v[24:27],a[244:247],v[104:107],v[24:27]
ds_read_b128 v[120:123],v5 offset:0
v_mfma_f32_16x16x32_bf16 v[40:43],v[104:107],v[244:247],v[40:43]
v_mfma_f32_16x16x32_bf16 v[28:31],a[244:247],v[108:111],v[28:31]
ds_read_b128 v[124:127],v5 offset:4096
v_mfma_f32_16x16x32_bf16 v[44:47],v[108:111],v[244:247],v[44:47]
v_mfma_f32_16x16x32_bf16 v[32:35],a[252:255],v[104:107],v[32:35]
v_mfma_f32_16x16x32_bf16 v[48:51],v[104:107],v[252:255],v[48:51]
v_mfma_f32_16x16x32_bf16 v[36:39],a[252:255],v[108:111],v[36:39]
v_mfma_f32_16x16x32_bf16 v[52:55],v[108:111],v[252:255],v[52:55]
s_waitcnt lgkmcnt(2)
v_mfma_f32_16x16x32_bf16 v[88:91],a[0:3],v[112:115],0
ds_read_b128 v[104:107],v6 offset:0
v_mfma_f32_16x16x32_bf16 v[92:95],a[0:3],v[116:119],0
v_mfma_f32_16x16x32_bf16 v[96:99],a[8:11],v[112:115],0
ds_read_b128 v[108:111],v6 offset:4096
v_cvt_pk_bf16_f32 v56,v24,v32
v_cvt_pk_bf16_f32 v57,v25,v33
v_mfma_f32_16x16x32_bf16 v[100:103],a[8:11],v[116:119],0
v_cvt_pk_bf16_f32 v58,v26,v34
v_cvt_pk_bf16_f32 v59,v27,v35
s_waitcnt lgkmcnt(2)
v_mfma_f32_16x16x32_bf16 v[88:91],a[4:7],v[120:123],v[88:91]
ds_read_b128 v[112:115],v7 offset:0
v_mfma_f32_16x16x32_bf16 v[92:95],a[4:7],v[124:127],v[92:95]
buffer_store_dwordx4 v[56:59],v0,s[8:11],s61 offen sc1
v_cvt_pk_bf16_f32 v60,v28,v36
v_cvt_pk_bf16_f32 v61,v29,v37
v_mfma_f32_16x16x32_bf16 v[96:99],a[12:15],v[120:123],v[96:99]
ds_read_b128 v[116:119],v7 offset:4096
v_cvt_pk_bf16_f32 v62,v30,v38
v_cvt_pk_bf16_f32 v63,v31,v39
v_mfma_f32_16x16x32_bf16 v[100:103],a[12:15],v[124:127],v[100:103]
buffer_store_dwordx4 v[60:63],v0,s[8:11],s62 offen sc1
v_cvt_pk_bf16_f32 v64,v40,v41
v_cvt_pk_bf16_f32 v65,v42,v43
s_waitcnt lgkmcnt(2)
v_mfma_f32_16x16x32_bf16 v[88:91],a[16:19],v[104:107],v[88:91]
ds_read_b128 v[120:123],v4 offset:8192
v_cvt_pk_bf16_f32 v66,v44,v45
v_cvt_pk_bf16_f32 v67,v46,v47
v_mfma_f32_16x16x32_bf16 v[92:95],a[16:19],v[108:111],v[92:95]
buffer_store_dwordx4 v[64:67],v0,s[8:11],s65 offen offset:0 sc1
v_cvt_pk_bf16_f32 v68,v48,v49
v_cvt_pk_bf16_f32 v69,v50,v51
v_mfma_f32_16x16x32_bf16 v[96:99],a[24:27],v[104:107],v[96:99]
ds_read_b128 v[124:127],v4 offset:12288
v_cvt_pk_bf16_f32 v70,v52,v53
v_cvt_pk_bf16_f32 v71,v54,v55
v_mfma_f32_16x16x32_bf16 v[100:103],a[24:27],v[108:111],v[100:103]
buffer_store_dwordx4 v[68:71],v0,s[8:11],s65 offen offset:1024 sc1
s_waitcnt lgkmcnt(2)
v_mfma_f32_16x16x32_bf16 v[88:91],a[20:23],v[112:115],v[88:91]
ds_read_b128 v[104:107],v5 offset:8192
v_mfma_f32_16x16x32_bf16 v[92:95],a[20:23],v[116:119],v[92:95]
v_mfma_f32_16x16x32_bf16 v[96:99],a[28:31],v[112:115],v[96:99]
ds_read_b128 v[108:111],v5 offset:12288
v_mfma_f32_16x16x32_bf16 v[100:103],a[28:31],v[116:119],v[100:103]
s_waitcnt lgkmcnt(2)
v_mfma_f32_16x16x32_bf16 v[88:91],a[32:35],v[120:123],v[88:91]
ds_read_b128 v[112:115],v6 offset:8192
v_mfma_f32_16x16x32_bf16 v[92:95],a[32:35],v[124:127],v[92:95]
v_mfma_f32_16x16x32_bf16 v[96:99],a[40:43],v[120:123],v[96:99]
ds_read_b128 v[116:119],v6 offset:12288
v_mfma_f32_16x16x32_bf16 v[100:103],a[40:43],v[124:127],v[100:103]
s_waitcnt lgkmcnt(2)
v_mfma_f32_16x16x32_bf16 v[88:91],a[36:39],v[104:107],v[88:91]
ds_read_b128 v[120:123],v7 offset:8192
v_mfma_f32_16x16x32_bf16 v[92:95],a[36:39],v[108:111],v[92:95]
v_mfma_f32_16x16x32_bf16 v[96:99],a[44:47],v[104:107],v[96:99]
ds_read_b128 v[124:127],v7 offset:12288
v_mfma_f32_16x16x32_bf16 v[100:103],a[44:47],v[108:111],v[100:103]
s_waitcnt lgkmcnt(2)
v_mfma_f32_16x16x32_bf16 v[88:91],a[48:51],v[112:115],v[88:91]
ds_read_b128 v[104:107],v4 offset:16384
v_mfma_f32_16x16x32_bf16 v[92:95],a[48:51],v[116:119],v[92:95]
v_mfma_f32_16x16x32_bf16 v[96:99],a[56:59],v[112:115],v[96:99]
ds_read_b128 v[108:111],v4 offset:20480
v_mfma_f32_16x16x32_bf16 v[100:103],a[56:59],v[116:119],v[100:103]
s_waitcnt lgkmcnt(2)
v_mfma_f32_16x16x32_bf16 v[88:91],a[52:55],v[120:123],v[88:91]
ds_read_b128 v[112:115],v5 offset:16384
v_mfma_f32_16x16x32_bf16 v[92:95],a[52:55],v[124:127],v[92:95]
v_mfma_f32_16x16x32_bf16 v[96:99],a[60:63],v[120:123],v[96:99]
ds_read_b128 v[116:119],v5 offset:20480
v_mfma_f32_16x16x32_bf16 v[100:103],a[60:63],v[124:127],v[100:103]
s_waitcnt lgkmcnt(2)
v_mfma_f32_16x16x32_bf16 v[88:91],a[64:67],v[104:107],v[88:91]
ds_read_b128 v[120:123],v6 offset:16384
v_mfma_f32_16x16x32_bf16 v[92:95],a[64:67],v[108:111],v[92:95]
v_mfma_f32_16x16x32_bf16 v[96:99],a[72:75],v[104:107],v[96:99]
ds_read_b128 v[124:127],v6 offset:20480
v_mfma_f32_16x16x32_bf16 v[100:103],a[72:75],v[108:111],v[100:103]
s_waitcnt lgkmcnt(2)
v_mfma_f32_16x16x32_bf16 v[88:91],a[68:71],v[112:115],v[88:91]
ds_read_b128 v[104:107],v7 offset:16384
v_mfma_f32_16x16x32_bf16 v[92:95],a[68:71],v[116:119],v[92:95]
v_mfma_f32_16x16x32_bf16 v[96:99],a[76:79],v[112:115],v[96:99]
ds_read_b128 v[108:111],v7 offset:20480
v_mfma_f32_16x16x32_bf16 v[100:103],a[76:79],v[116:119],v[100:103]
s_waitcnt lgkmcnt(2)
v_mfma_f32_16x16x32_bf16 v[88:91],a[80:83],v[120:123],v[88:91]
ds_read_b128 v[112:115],v4 offset:24576
v_mfma_f32_16x16x32_bf16 v[92:95],a[80:83],v[124:127],v[92:95]
v_mfma_f32_16x16x32_bf16 v[96:99],a[88:91],v[120:123],v[96:99]
ds_read_b128 v[116:119],v4 offset:28672
v_mfma_f32_16x16x32_bf16 v[100:103],a[88:91],v[124:127],v[100:103]
s_waitcnt lgkmcnt(2)
v_mfma_f32_16x16x32_bf16 v[88:91],a[84:87],v[104:107],v[88:91]
ds_read_b128 v[120:123],v5 offset:24576
v_mfma_f32_16x16x32_bf16 v[92:95],a[84:87],v[108:111],v[92:95]
v_mfma_f32_16x16x32_bf16 v[96:99],a[92:95],v[104:107],v[96:99]
ds_read_b128 v[124:127],v5 offset:28672
v_mfma_f32_16x16x32_bf16 v[100:103],a[92:95],v[108:111],v[100:103]
s_waitcnt lgkmcnt(2)
v_mfma_f32_16x16x32_bf16 v[88:91],a[96:99],v[112:115],v[88:91]
ds_read_b128 v[104:107],v6 offset:24576
v_mfma_f32_16x16x32_bf16 v[92:95],a[96:99],v[116:119],v[92:95]
v_mfma_f32_16x16x32_bf16 v[96:99],a[104:107],v[112:115],v[96:99]
ds_read_b128 v[108:111],v6 offset:28672
v_mfma_f32_16x16x32_bf16 v[100:103],a[104:107],v[116:119],v[100:103]
s_waitcnt lgkmcnt(2)
v_mfma_f32_16x16x32_bf16 v[88:91],a[100:103],v[120:123],v[88:91]
ds_read_b128 v[112:115],v7 offset:24576
v_mfma_f32_16x16x32_bf16 v[92:95],a[100:103],v[124:127],v[92:95]
v_mfma_f32_16x16x32_bf16 v[96:99],a[108:111],v[120:123],v[96:99]
ds_read_b128 v[116:119],v7 offset:28672
v_mfma_f32_16x16x32_bf16 v[100:103],a[108:111],v[124:127],v[100:103]
s_waitcnt lgkmcnt(2)
v_mfma_f32_16x16x32_bf16 v[88:91],a[112:115],v[104:107],v[88:91]
v_mfma_f32_16x16x32_bf16 v[92:95],a[112:115],v[108:111],v[92:95]
v_mfma_f32_16x16x32_bf16 v[96:99],a[120:123],v[104:107],v[96:99]
v_mfma_f32_16x16x32_bf16 v[100:103],a[120:123],v[108:111],v[100:103]
s_waitcnt lgkmcnt(0)
v_mfma_f32_16x16x32_bf16 v[88:91],a[116:119],v[112:115],v[88:91]
v_mfma_f32_16x16x32_bf16 v[92:95],a[116:119],v[116:119],v[92:95]
v_mfma_f32_16x16x32_bf16 v[96:99],a[124:127],v[112:115],v[96:99]
v_mfma_f32_16x16x32_bf16 v[100:103],a[124:127],v[116:119],v[100:103]
s_nop 3
v_cvt_pk_bf16_f32 v104,v88,v96
v_cvt_pk_bf16_f32 v105,v89,v97
v_cvt_pk_bf16_f32 v106,v90,v98
v_cvt_pk_bf16_f32 v107,v91,v99
v_cvt_pk_bf16_f32 v108,v92,v100
v_cvt_pk_bf16_f32 v109,v93,v101
v_cvt_pk_bf16_f32 v110,v94,v102
v_cvt_pk_bf16_f32 v111,v95,v103
buffer_store_dwordx4 v[104:107],v0,s[8:11],s63 offen sc1
buffer_store_dwordx4 v[108:111],v0,s[8:11],s64 offen sc1
s_waitcnt vmcnt(6)
s_barrier
s_add_u32 m0,s50,131072
s_nop 0
buffer_load_dwordx4 v20,s[8:11],s70 offen offset:0 sc1 lds
s_add_u32 m0,s50,135168
s_nop 0
buffer_load_dwordx4 v20,s[8:11],s71 offen offset:0 sc1 lds
s_add_u32 m0,s50,139008
s_nop 0
buffer_load_dwordx4 v20,s[8:11],s70 offen offset:256 sc1 lds
s_add_u32 m0,s50,143104
s_nop 0
buffer_load_dwordx4 v20,s[8:11],s71 offen offset:256 sc1 lds
s_add_u32 m0,s50,146944
s_nop 0
buffer_load_dwordx4 v20,s[8:11],s70 offen offset:512 sc1 lds
s_add_u32 m0,s50,151040
s_nop 0
buffer_load_dwordx4 v20,s[8:11],s71 offen offset:512 sc1 lds
s_lshl_b32 s59,s51,13
s_lshl2_add_u32 s59,s47,s59
s_add_u32 s59,s59,10487680
s_waitcnt vmcnt(0)
s_barrier
s_or_b32 s59,s59,s52
buffer_store_dword v17,off,s[8:11],s59 sc1
s_mov_b32 s72,0x80000000
s_mov_b32 s86,0
s_mov_b32 s19,1
s_mov_b32 s18,0
s_cmp_lt_u32 s31,64
s_cbranch_scc1 L_mo_358
L_mo_371:
s_mov_b32 s51,64
s_and_b32 s61,s54,0x7ff
s_sub_u32 s61,2047,s61
s_lshr_b32 s61,s61,5
s_cmp_lg_u32 s46,0
s_cbranch_scc1 L_mw_382
s_mov_b32 s59,11018240
v_lshlrev_b32 v2,2,v1
L_fp_383:
s_sleep 2
buffer_load_dword v3,v2,s[8:11],s59 offen sc1
s_sub_u32 s49,s49,1
s_cbranch_scc1 L_abort2
s_waitcnt vmcnt(0)
v_cmp_eq_u32 vcc,0,v3
s_cbranch_vccnz L_fp_383
v_cmp_le_u32 vcc,s61,v1
s_nop 1
v_cndmask_b32 v2,1,2,vcc
v_cmp_ne_u32 s[84:85],v2,v3
s_lshl_b32 s56,s47,1
s_lshr_b64 s[20:21],s[84:85],s56
v_lshrrev_b32 v2,5,v1
v_lshrrev_b32 v3,v2,s20
v_and_b32 v3,1,v3
v_mul_u32_u24 v3,768,v3
v_lshlrev_b32 v2,13,v2
v_sub_u32 v2,v2,v3
v_and_b32 v3,31,v1
v_lshl_add_u32 v2,v3,2,v2
v_add_u32 v2,1536,v2
s_lshl_b32 s59,s47,14
s_add_u32 s59,s59,10485760
L_fp_384:
s_sleep 1
buffer_load_dword v3,v2,s[8:11],s59 offen sc1
s_sub_u32 s49,s49,1
s_cbranch_scc1 L_abort2
s_waitcnt vmcnt(0)
v_cmp_eq_u32 vcc,0,v3
s_cbranch_vccnz L_fp_384
v_max_u32_dpp v3,v3,v3 row_ror:8 row_mask:0xf bank_mask:0xf
s_nop 1
v_max_u32_dpp v3,v3,v3 row_ror:4 row_mask:0xf bank_mask:0xf
s_nop 1
v_max_u32_dpp v3,v3,v3 row_ror:2 row_mask:0xf bank_mask:0xf
s_nop 1
v_max_u32_dpp v3,v3,v3 row_ror:1 row_mask:0xf bank_mask:0xf
v_mov_b32 v2,v3
s_nop 1
v_permlane16_swap_b32 v3,v2
v_max_u32 v3,v3,v2
v_mov_b32 v2,v3
s_nop 1
v_permlane32_swap_b32 v3,v2
v_max_u32 v3,v3,v2
s_lshl_b32 s59,s51,13
s_lshl2_add_u32 s59,s47,s59
s_add_u32 s59,s59,10487424
buffer_store_dword v3,off,s[8:11],s59 sc1
L_mw_382:
s_barrier
s_lshl_b32 s59,s51,13
s_add_u32 s59,s59,10487424
v_and_b32 v124,31,v1
v_lshlrev_b32 v124,2,v124
s_branch L_ff_387
L_fw_385:
s_sleep 1
L_ff_387:
buffer_load_dword v125,v124,s[8:11],s59 offen sc1
s_sub_u32 s49,s49,1
s_cbranch_scc1 L_abort2
s_waitcnt vmcnt(0)
v_cmp_eq_u32 vcc,0,v125
s_cbranch_vccnz L_fw_385
v_max_u32_dpp v125,v125,v125 row_ror:8 row_mask:0xf bank_mask:0xf
s_nop 1
v_max_u32_dpp v125,v125,v125 row_ror:4 row_mask:0xf bank_mask:0xf
s_nop 1
v_max_u32_dpp v125,v125,v125 row_ror:2 row_mask:0xf bank_mask:0xf
s_nop 1
v_max_u32_dpp v125,v125,v125 row_ror:1 row_mask:0xf bank_mask:0xf
v_mov_b32 v124,v125
s_nop 1
v_permlane16_swap_b32 v125,v124
v_max_u32 v125,v125,v124
v_mov_b32 v124,v125
s_nop 1
v_permlane32_swap_b32 v125,v124
v_max_u32 v125,v125,v124
s_nop 0
v_readfirstlane_b32 s55,v125
s_and_b32 s64,s55,0x7ff
s_sub_u32 s64,2047,s64
s_lshl_b32 s56,s64,10
s_add_u32 s58,s56,6291456
buffer_load_dwordx4 v[88:91],v0,s[8:11],s58 offen sc1
s_mov_b32 s4,s38
s_mov_b32 s5,s39
s_mov_b32 s6,1835008
s_mov_b32 s7,0x20000
v_and_b32 v9,15,v1
v_lshrrev_b32 v10,4,v1
v_lshlrev_b32 v8,14,v10
v_lshl_add_u32 v8,v9,4,v8
s_lshl_b32 s59,s47,16
s_lshl_b32 s60,s46,8
s_add_u32 s59,s59,s60
buffer_load_dwordx4 v[24:27],v8,s[4:7],s59 offen offset:0
buffer_load_dwordx4 v[28:31],v8,s[4:7],s59 offen offset:1024
buffer_load_dwordx4 v[32:35],v8,s[4:7],s59 offen offset:2048
buffer_load_dwordx4 v[36:39],v8,s[4:7],s59 offen offset:3072
s_add_u32 s59,s59,4096
buffer_load_dwordx4 v[40:43],v8,s[4:7],s59 offen offset:0
buffer_load_dwordx4 v[44:47],v8,s[4:7],s59 offen offset:1024
buffer_load_dwordx4 v[48:51],v8,s[4:7],s59 offen offset:2048
buffer_load_dwordx4 v[52:55],v8,s[4:7],s59 offen offset:3072
s_add_u32 s59,s59,4096
buffer_load_dwordx4 v[56:59],v8,s[4:7],s59 offen offset:0
buffer_load_dwordx4 v[60:63],v8,s[4:7],s59 offen offset:1024
buffer_load_dwordx4 v[64:67],v8,s[4:7],s59 offen offset:2048
buffer_load_dwordx4 v[68:71],v8,s[4:7],s59 offen offset:3072
s_add_u32 s59,s59,4096
buffer_load_dwordx4 v[72:75],v8,s[4:7],s59 offen offset:0
buffer_load_dwordx4 v[76:79],v8,s[4:7],s59 offen offset:1024
buffer_load_dwordx4 v[80:83],v8,s[4:7],s59 offen offset:2048
buffer_load_dwordx4 v[84:87],v8,s[4:7],s59 offen offset:3072
v_and_b32 v124,1,v1
v_lshlrev_b32 v124,4,v124
v_mov_b32 v125,0xffff
v_lshlrev_b32 v125,v124,v125
v_lshrrev_b32 v124,1,v9
v_cmp_eq_u32 vcc,0,v124
s_nop 1
v_cndmask_b32 v12,0,v125,vcc
v_cmp_eq_u32 vcc,1,v124
s_nop 1
v_cndmask_b32 v13,0,v125,vcc
v_cmp_eq_u32 vcc,2,v124
s_nop 1
v_cndmask_b32 v14,0,v125,vcc
v_cmp_eq_u32 vcc,3,v124
s_nop 1
v_cndmask_b32 v15,0,v125,vcc
s_waitcnt vmcnt(16)
v_lshlrev_b32 v96,16,v88
v_and_b32 v97,0xffff0000,v88
v_lshlrev_b32 v98,16,v89
v_and_b32 v99,0xffff0000,v89
v_lshlrev_b32 v100,16,v90
v_and_b32 v101,0xffff0000,v90
v_lshlrev_b32 v102,16,v91
v_and_b32 v103,0xffff0000,v91
v_readfirstlane_b32 s78,v96
s_nop 1
v_pk_add_f32 v[108:109],v[96:97],s[78:79] op_sel_hi:[1,0] neg_lo:[0,1] neg_hi:[0,1]
v_pk_add_f32 v[110:111],v[98:99],s[78:79] op_sel_hi:[1,0] neg_lo:[0,1] neg_hi:[0,1]
v_pk_add_f32 v[112:113],v[100:101],s[78:79] op_sel_hi:[1,0] neg_lo:[0,1] neg_hi:[0,1]
v_pk_add_f32 v[114:115],v[102:103],s[78:79] op_sel_hi:[1,0] neg_lo:[0,1] neg_hi:[0,1]
v_pk_add_f32 v[116:117],v[108:109],v[110:111]
v_pk_mul_f32 v[118:119],v[108:109],v[108:109]
v_pk_add_f32 v[120:121],v[112:113],v[114:115]
v_pk_fma_f32 v[118:119],v[110:111],v[110:111],v[118:119]
v_pk_add_f32 v[116:117],v[116:117],v[120:121]
v_pk_fma_f32 v[118:119],v[112:113],v[112:113],v[118:119]
v_add_f32 v116,v116,v117
v_pk_fma_f32 v[118:119],v[114:115],v[114:115],v[118:119]
v_add_f32 v118,v118,v119
s_nop 1
v_permlane32_swap_b32 v116,v118
v_add_f32 v116,v116,v118
s_nop 1
v_add_f32_dpp v116,v116,v116 row_ror:8 row_mask:0xf bank_mask:0xf
s_nop 1
v_add_f32_dpp v116,v116,v116 row_ror:4 row_mask:0xf bank_mask:0xf
s_nop 1
v_add_f32_dpp v116,v116,v116 row_ror:2 row_mask:0xf bank_mask:0xf
s_nop 1
v_add_f32_dpp v116,v116,v116 row_ror:1 row_mask:0xf bank_mask:0xf
v_mov_b32 v118,v116
s_nop 1
v_permlane16_swap_b32 v116,v118
v_add_f32 v116,v116,v118
v_mul_f32 v116,0x3b000000,v116
v_mov_b32 v118,v116
s_nop 1
v_permlane32_swap_b32 v116,v118
v_fma_f32 v118,-v116,v116,v118
v_add_f32 v116,s78,v116
v_max_f32 v118,0,v118
v_cvt_pk_bf16_f32 v118,v116,v118
v_lshlrev_b32 v116,16,v118
v_and_b32 v118,0xffff0000,v118
v_add_f32 v118,0x3727c5ac,v118
v_cvt_pk_bf16_f32 v118,v118,v118
v_and_b32 v118,0xffff0000,v118
v_sqrt_f32 v118,v118
v_pk_add_f32 v[108:109],v[96:97],v[116:117] op_sel_hi:[1,0] neg_lo:[0,1] neg_hi:[0,1]
v_pk_add_f32 v[110:111],v[98:99],v[116:117] op_sel_hi:[1,0] neg_lo:[0,1] neg_hi:[0,1]
v_pk_add_f32 v[112:113],v[100:101],v[116:117] op_sel_hi:[1,0] neg_lo:[0,1] neg_hi:[0,1]
v_pk_add_f32 v[114:115],v[102:103],v[116:117] op_sel_hi:[1,0] neg_lo:[0,1] neg_hi:[0,1]
v_cvt_pk_bf16_f32 v118,v118,v118
v_and_b32 v118,0xffff0000,v118
v_rcp_f32 v118,v118
v_cvt_pk_bf16_f32 v104,v108,v109
v_cvt_pk_bf16_f32 v105,v110,v111
v_cvt_pk_bf16_f32 v106,v112,v113
v_cvt_pk_bf16_f32 v107,v114,v115
v_lshlrev_b32 v108,16,v104
v_and_b32 v109,0xffff0000,v104
v_lshlrev_b32 v110,16,v105
v_and_b32 v111,0xffff0000,v105
v_lshlrev_b32 v112,16,v106
v_and_b32 v113,0xffff0000,v106
v_lshlrev_b32 v114,16,v107
v_and_b32 v115,0xffff0000,v107
v_pk_mul_f32 v[108:109],v[108:109],v[118:119] op_sel_hi:[1,0]
v_pk_mul_f32 v[110:111],v[110:111],v[118:119] op_sel_hi:[1,0]
v_pk_mul_f32 v[112:113],v[112:113],v[118:119] op_sel_hi:[1,0]
v_pk_mul_f32 v[114:115],v[114:115],v[118:119] op_sel_hi:[1,0]
v_cvt_pk_bf16_f32 v104,v108,v109
v_cvt_pk_bf16_f32 v105,v110,v111
v_cvt_pk_bf16_f32 v106,v112,v113
v_cvt_pk_bf16_f32 v107,v114,v115
s_mov_b32 s58,0x01000100
s_mov_b32 s59,0x03020302
v_perm_b32 v88,v104,v104,s58
v_perm_b32 v89,v104,v104,s59
v_perm_b32 v90,v105,v105,s58
v_perm_b32 v91,v105,v105,s59
v_perm_b32 v92,v106,v106,s58
v_perm_b32 v93,v106,v106,s59
v_perm_b32 v94,v107,v107,s58
v_perm_b32 v95,v107,v107,s59
v_lshlrev_b32 v8,5,v1
s_lshl_b32 s58,s46,11
s_add_u32 s58,s58,139264
v_add_u32 v8,s58,v8
ds_write_b128 v8,v[88:91]
ds_write_b128 v8,v[92:95] offset:16
s_lshl_b32 s59,s46,9
s_add_u32 s59,s58,s59
v_lshlrev_b32 v8,7,v10
v_add_u32 v8,s59,v8
s_waitcnt lgkmcnt(0)
ds_read_b128 v[108:111],v18 offset:0
ds_read_b128 v[88:91],v8 offset:0
ds_read_b128 v[92:95],v8 offset:16
ds_read_b128 v[112:115],v18 offset:1024
s_waitcnt lgkmcnt(1)
v_and_b32 v124,v12,v88
v_and_b32 v125,v13,v88
v_and_b32 v126,v14,v88
v_and_b32 v127,v15,v88
s_nop 1
v_mfma_f32_16x16x32_bf16 v[116:119],v[124:127],v[108:111],0
ds_read_b128 v[108:111],v18 offset:2048
s_waitcnt lgkmcnt(1)
v_and_b32 v124,v12,v89
v_and_b32 v125,v13,v89
v_and_b32 v126,v14,v89
v_and_b32 v127,v15,v89
s_nop 1
v_mfma_f32_16x16x32_bf16 v[116:119],v[124:127],v[112:115],v[116:119]
ds_read_b128 v[112:115],v18 offset:3072
s_waitcnt lgkmcnt(1)
v_and_b32 v124,v12,v90
v_and_b32 v125,v13,v90
v_and_b32 v126,v14,v90
v_and_b32 v127,v15,v90
s_nop 1
v_mfma_f32_16x16x32_bf16 v[116:119],v[124:127],v[108:111],v[116:119]
ds_read_b128 v[108:111],v18 offset:4096
s_waitcnt lgkmcnt(1)
v_and_b32 v124,v12,v91
v_and_b32 v125,v13,v91
v_and_b32 v126,v14,v91
v_and_b32 v127,v15,v91
s_nop 1
v_mfma_f32_16x16x32_bf16 v[116:119],v[124:127],v[112:115],v[116:119]
ds_read_b128 v[112:115],v18 offset:5120
s_waitcnt lgkmcnt(1)
v_and_b32 v124,v12,v92
v_and_b32 v125,v13,v92
v_and_b32 v126,v14,v92
v_and_b32 v127,v15,v92
s_nop 1
v_mfma_f32_16x16x32_bf16 v[116:119],v[124:127],v[108:111],v[116:119]
ds_read_b128 v[108:111],v18 offset:6144
s_waitcnt lgkmcnt(1)
v_and_b32 v124,v12,v93
v_and_b32 v125,v13,v93
v_and_b32 v126,v14,v93
v_and_b32 v127,v15,v93
s_nop 1
v_mfma_f32_16x16x32_bf16 v[116:119],v[124:127],v[112:115],v[116:119]
ds_read_b128 v[112:115],v18 offset:7168
s_waitcnt lgkmcnt(1)
v_and_b32 v124,v12,v94
v_and_b32 v125,v13,v94
v_and_b32 v126,v14,v94
v_and_b32 v127,v15,v94
s_nop 1
v_mfma_f32_16x16x32_bf16 v[116:119],v[124:127],v[108:111],v[116:119]
ds_read_b128 v[108:111],v18 offset:8192
s_waitcnt lgkmcnt(1)
v_and_b32 v124,v12,v95
v_and_b32 v125,v13,v95
v_and_b32 v126,v14,v95
v_and_b32 v127,v15,v95
s_nop 1
v_mfma_f32_16x16x32_bf16 v[116:119],v[124:127],v[112:115],v[116:119]
ds_read_b128 v[88:91],v8 offset:32
ds_read_b128 v[92:95],v8 offset:48
ds_read_b128 v[112:115],v18 offset:9216
s_waitcnt lgkmcnt(1)
v_and_b32 v124,v12,v88
v_and_b32 v125,v13,v88
v_and_b32 v126,v14,v88
v_and_b32 v127,v15,v88
s_nop 1
v_mfma_f32_16x16x32_bf16 v[116:119],v[124:127],v[108:111],v[116:119]
ds_read_b128 v[108:111],v18 offset:10240
s_waitcnt lgkmcnt(1)
v_and_b32 v124,v12,v89
v_and_b32 v125,v13,v89
v_and_b32 v126,v14,v89
v_and_b32 v127,v15,v89
s_nop 1
v_mfma_f32_16x16x32_bf16 v[116:119],v[124:127],v[112:115],v[116:119]
ds_read_b128 v[112:115],v18 offset:11264
s_waitcnt lgkmcnt(1)
v_and_b32 v124,v12,v90
v_and_b32 v125,v13,v90
v_and_b32 v126,v14,v90
v_and_b32 v127,v15,v90
s_nop 1
v_mfma_f32_16x16x32_bf16 v[116:119],v[124:127],v[108:111],v[116:119]
ds_read_b128 v[108:111],v18 offset:12288
s_waitcnt lgkmcnt(1)
v_and_b32 v124,v12,v91
v_and_b32 v125,v13,v91
v_and_b32 v126,v14,v91
v_and_b32 v127,v15,v91
s_nop 1
v_mfma_f32_16x16x32_bf16 v[116:119],v[124:127],v[112:115],v[116:119]
ds_read_b128 v[112:115],v18 offset:13312
s_waitcnt lgkmcnt(1)
v_and_b32 v124,v12,v92
v_and_b32 v125,v13,v92
v_and_b32 v126,v14,v92
v_and_b32 v127,v15,v92
s_nop 1
v_mfma_f32_16x16x32_bf16 v[116:119],v[124:127],v[108:111],v[116:119]
ds_read_b128 v[108:111],v18 offset:14336
s_waitcnt lgkmcnt(1)
v_and_b32 v124,v12,v93
v_and_b32 v125,v13,v93
v_and_b32 v126,v14,v93
v_and_b32 v127,v15,v93
s_nop 1
v_mfma_f32_16x16x32_bf16 v[116:119],v[124:127],v[112:115],v[116:119]
ds_read_b128 v[112:115],v18 offset:15360
s_waitcnt lgkmcnt(1)
v_and_b32 v124,v12,v94
v_and_b32 v125,v13,v94
v_and_b32 v126,v14,v94
v_and_b32 v127,v15,v94
s_nop 1
v_mfma_f32_16x16x32_bf16 v[116:119],v[124:127],v[108:111],v[116:119]
ds_read_b128 v[108:111],v18 offset:16384
s_waitcnt lgkmcnt(1)
v_and_b32 v124,v12,v95
v_and_b32 v125,v13,v95
v_and_b32 v126,v14,v95
v_and_b32 v127,v15,v95
s_nop 1
v_mfma_f32_16x16x32_bf16 v[116:119],v[124:127],v[112:115],v[116:119]
ds_read_b128 v[88:91],v8 offset:64
ds_read_b128 v[92:95],v8 offset:80
ds_read_b128 v[112:115],v18 offset:17408
s_waitcnt lgkmcnt(1)
v_and_b32 v124,v12,v88
v_and_b32 v125,v13,v88
v_and_b32 v126,v14,v88
v_and_b32 v127,v15,v88
s_nop 1
v_mfma_f32_16x16x32_bf16 v[116:119],v[124:127],v[108:111],v[116:119]
ds_read_b128 v[108:111],v18 offset:18432
s_waitcnt lgkmcnt(1)
v_and_b32 v124,v12,v89
v_and_b32 v125,v13,v89
v_and_b32 v126,v14,v89
v_and_b32 v127,v15,v89
s_nop 1
v_mfma_f32_16x16x32_bf16 v[116:119],v[124:127],v[112:115],v[116:119]
ds_read_b128 v[112:115],v18 offset:19456
s_waitcnt lgkmcnt(1)
v_and_b32 v124,v12,v90
v_and_b32 v125,v13,v90
v_and_b32 v126,v14,v90
v_and_b32 v127,v15,v90
s_nop 1
v_mfma_f32_16x16x32_bf16 v[116:119],v[124:127],v[108:111],v[116:119]
ds_read_b128 v[108:111],v18 offset:20480
s_waitcnt lgkmcnt(1)
v_and_b32 v124,v12,v91
v_and_b32 v125,v13,v91
v_and_b32 v126,v14,v91
v_and_b32 v127,v15,v91
s_nop 1
v_mfma_f32_16x16x32_bf16 v[116:119],v[124:127],v[112:115],v[116:119]
ds_read_b128 v[112:115],v18 offset:21504
s_waitcnt lgkmcnt(1)
v_and_b32 v124,v12,v92
v_and_b32 v125,v13,v92
v_and_b32 v126,v14,v92
v_and_b32 v127,v15,v92
s_nop 1
v_mfma_f32_16x16x32_bf16 v[116:119],v[124:127],v[108:111],v[116:119]
ds_read_b128 v[108:111],v18 offset:22528
s_waitcnt lgkmcnt(1)
v_and_b32 v124,v12,v93
v_and_b32 v125,v13,v93
v_and_b32 v126,v14,v93
v_and_b32 v127,v15,v93
s_nop 1
v_mfma_f32_16x16x32_bf16 v[116:119],v[124:127],v[112:115],v[116:119]
ds_read_b128 v[112:115],v18 offset:23552
s_waitcnt lgkmcnt(1)
v_and_b32 v124,v12,v94
v_and_b32 v125,v13,v94
v_and_b32 v126,v14,v94
v_and_b32 v127,v15,v94
s_nop 1
v_mfma_f32_16x16x32_bf16 v[116:119],v[124:127],v[108:111],v[116:119]
ds_read_b128 v[108:111],v18 offset:24576
s_waitcnt lgkmcnt(1)
v_and_b32 v124,v12,v95
v_and_b32 v125,v13,v95
v_and_b32 v126,v14,v95
v_and_b32 v127,v15,v95
s_nop 1
v_mfma_f32_16x16x32_bf16 v[116:119],v[124:127],v[112:115],v[116:119]
ds_read_b128 v[88:91],v8 offset:96
ds_read_b128 v[92:95],v8 offset:112
ds_read_b128 v[112:115],v18 offset:25600
s_waitcnt lgkmcnt(1)
v_and_b32 v124,v12,v88
v_and_b32 v125,v13,v88
v_and_b32 v126,v14,v88
v_and_b32 v127,v15,v88
s_nop 1
v_mfma_f32_16x16x32_bf16 v[116:119],v[124:127],v[108:111],v[116:119]
ds_read_b128 v[108:111],v18 offset:26624
s_waitcnt lgkmcnt(1)
v_and_b32 v124,v12,v89
v_and_b32 v125,v13,v89
v_and_b32 v126,v14,v89
v_and_b32 v127,v15,v89
s_nop 1
v_mfma_f32_16x16x32_bf16 v[116:119],v[124:127],v[112:115],v[116:119]
ds_read_b128 v[112:115],v18 offset:27648
s_waitcnt lgkmcnt(1)
v_and_b32 v124,v12,v90
v_and_b32 v125,v13,v90
v_and_b32 v126,v14,v90
v_and_b32 v127,v15,v90
s_nop 1
v_mfma_f32_16x16x32_bf16 v[116:119],v[124:127],v[108:111],v[116:119]
ds_read_b128 v[108:111],v18 offset:28672
s_waitcnt lgkmcnt(1)
v_and_b32 v124,v12,v91
v_and_b32 v125,v13,v91
v_and_b32 v126,v14,v91
v_and_b32 v127,v15,v91
s_nop 1
v_mfma_f32_16x16x32_bf16 v[116:119],v[124:127],v[112:115],v[116:119]
ds_read_b128 v[112:115],v18 offset:29696
s_waitcnt lgkmcnt(1)
v_and_b32 v124,v12,v92
v_and_b32 v125,v13,v92
v_and_b32 v126,v14,v92
v_and_b32 v127,v15,v92
s_nop 1
v_mfma_f32_16x16x32_bf16 v[116:119],v[124:127],v[108:111],v[116:119]
ds_read_b128 v[108:111],v18 offset:30720
s_waitcnt lgkmcnt(1)
v_and_b32 v124,v12,v93
v_and_b32 v125,v13,v93
v_and_b32 v126,v14,v93
v_and_b32 v127,v15,v93
s_nop 1
v_mfma_f32_16x16x32_bf16 v[116:119],v[124:127],v[112:115],v[116:119]
ds_read_b128 v[112:115],v18 offset:31744
s_waitcnt lgkmcnt(1)
v_and_b32 v124,v12,v94
v_and_b32 v125,v13,v94
v_and_b32 v126,v14,v94
v_and_b32 v127,v15,v94
s_nop 1
v_mfma_f32_16x16x32_bf16 v[116:119],v[124:127],v[108:111],v[116:119]
s_waitcnt lgkmcnt(0)
v_and_b32 v124,v12,v95
v_and_b32 v125,v13,v95
v_and_b32 v126,v14,v95
v_and_b32 v127,v15,v95
s_nop 1
v_mfma_f32_16x16x32_bf16 v[116:119],v[124:127],v[112:115],v[116:119]
v_lshlrev_b32 v8,5,v9
v_and_b32 v124,1,v10
v_lshl_add_u32 v8,v124,4,v8
v_lshrrev_b32 v124,1,v10
v_lshl_add_u32 v8,v124,11,v8
s_lshl_b32 s60,s46,9
s_add_u32 s60,s60,147456
v_add_u32 v8,s60,v8
ds_write_b128 v8,v[116:119]
v_lshlrev_b32 v8,2,v1
v_add_u32 v8,147456,v8
s_waitcnt lgkmcnt(0)
s_barrier
ds_read2st64_b32 v[88:89],v8 offset0:0 offset1:1
ds_read2st64_b32 v[90:91],v8 offset0:2 offset1:3
ds_read2st64_b32 v[92:93],v8 offset0:4 offset1:5
ds_read2st64_b32 v[94:95],v8 offset0:6 offset1:7
s_waitcnt lgkmcnt(0)
v_pk_add_f32 v[88:89],v[88:89],v[90:91]
v_pk_add_f32 v[92:93],v[92:93],v[94:95]
v_pk_add_f32 v[88:89],v[88:89],v[92:93]
v_cvt_pk_bf16_f32 v88,v88,v88
v_and_b32 v88,0xffff0000,v88
v_cvt_pk_bf16_f32 v89,v89,v89
v_and_b32 v89,0xffff0000,v89
v_mul_f32 v90,0xbfb8aa3b,v88
v_exp_f32 v90,v90
s_nop 0
v_add_f32 v90,1.0,v90
v_rcp_f32 v90,v90
s_nop 0
v_mul_f32 v88,v88,v90
v_cvt_pk_bf16_f32 v88,v88,v88
v_and_b32 v88,0xffff0000,v88
v_mul_f32 v88,v88,v89
v_cvt_pk_bf16_f32 v88,v88,v88
v_lshlrev_b32 v8,2,v1
v_add_u32 v8,s58,v8
ds_write_b32 v8,v88
v_lshlrev_b32 v8,6,v10
v_add_u32 v8,s58,v8
s_waitcnt lgkmcnt(0)
ds_read_b128 v[88:91],v8
ds_read_b128 v[92:95],v8 offset:16
ds_read_b128 v[108:111],v8 offset:32
ds_read_b128 v[112:115],v8 offset:48
s_waitcnt vmcnt(0) lgkmcnt(0)
v_and_b32 v124,v12,v88
v_and_b32 v125,v13,v88
v_and_b32 v126,v14,v88
v_and_b32 v127,v15,v88
s_nop 1
v_mfma_f32_16x16x32_bf16 v[116:119],v[124:127],v[24:27],0
v_and_b32 v124,v12,v89
v_and_b32 v125,v13,v89
v_and_b32 v126,v14,v89
v_and_b32 v127,v15,v89
s_nop 1
v_mfma_f32_16x16x32_bf16 v[116:119],v[124:127],v[28:31],v[116:119]
v_and_b32 v124,v12,v90
v_and_b32 v125,v13,v90
v_and_b32 v126,v14,v90
v_and_b32 v127,v15,v90
s_nop 1
v_mfma_f32_16x16x32_bf16 v[116:119],v[124:127],v[32:35],v[116:119]
v_and_b32 v124,v12,v91
v_and_b32 v125,v13,v91
v_and_b32 v126,v14,v91
v_and_b32 v127,v15,v91
s_nop 1
v_mfma_f32_16x16x32_bf16 v[116:119],v[124:127],v[36:39],v[116:119]
v_and_b32 v124,v12,v92
v_and_b32 v125,v13,v92
v_and_b32 v126,v14,v92
v_and_b32 v127,v15,v92
s_nop 1
v_mfma_f32_16x16x32_bf16 v[116:119],v[124:127],v[40:43],v[116:119]
v_and_b32 v124,v12,v93
v_and_b32 v125,v13,v93
v_and_b32 v126,v14,v93
v_and_b32 v127,v15,v93
s_nop 1
v_mfma_f32_16x16x32_bf16 v[116:119],v[124:127],v[44:47],v[116:119]
v_and_b32 v124,v12,v94
v_and_b32 v125,v13,v94
v_and_b32 v126,v14,v94
v_and_b32 v127,v15,v94
s_nop 1
v_mfma_f32_16x16x32_bf16 v[116:119],v[124:127],v[48:51],v[116:119]
v_and_b32 v124,v12,v95
v_and_b32 v125,v13,v95
v_and_b32 v126,v14,v95
v_and_b32 v127,v15,v95
s_nop 1
v_mfma_f32_16x16x32_bf16 v[116:119],v[124:127],v[52:55],v[116:119]
v_and_b32 v124,v12,v108
v_and_b32 v125,v13,v108
v_and_b32 v126,v14,v108
v_and_b32 v127,v15,v108
s_nop 1
v_mfma_f32_16x16x32_bf16 v[116:119],v[124:127],v[56:59],v[116:119]
v_and_b32 v124,v12,v109
v_and_b32 v125,v13,v109
v_and_b32 v126,v14,v109
v_and_b32 v127,v15,v109
s_nop 1
v_mfma_f32_16x16x32_bf16 v[116:119],v[124:127],v[60:63],v[116:119]
v_and_b32 v124,v12,v110
v_and_b32 v125,v13,v110
v_and_b32 v126,v14,v110
v_and_b32 v127,v15,v110
s_nop 1
v_mfma_f32_16x16x32_bf16 v[116:119],v[124:127],v[64:67],v[116:119]
v_and_b32 v124,v12,v111
v_and_b32 v125,v13,v111
v_and_b32 v126,v14,v111
v_and_b32 v127,v15,v111
s_nop 1
v_mfma_f32_16x16x32_bf16 v[116:119],v[124:127],v[68:71],v[116:119]
v_and_b32 v124,v12,v112
v_and_b32 v125,v13,v112
v_and_b32 v126,v14,v112
v_and_b32 v127,v15,v112
s_nop 1
v_mfma_f32_16x16x32_bf16 v[116:119],v[124:127],v[72:75],v[116:119]
v_and_b32 v124,v12,v113
v_and_b32 v125,v13,v113
v_and_b32 v126,v14,v113
v_and_b32 v127,v15,v113
s_nop 1
v_mfma_f32_16x16x32_bf16 v[116:119],v[124:127],v[76:79],v[116:119]
v_and_b32 v124,v12,v114
v_and_b32 v125,v13,v114
v_and_b32 v126,v14,v114
v_and_b32 v127,v15,v114
s_nop 1
v_mfma_f32_16x16x32_bf16 v[116:119],v[124:127],v[80:83],v[116:119]
v_and_b32 v124,v12,v115
v_and_b32 v125,v13,v115
v_and_b32 v126,v14,v115
v_and_b32 v127,v15,v115
s_nop 1
v_mfma_f32_16x16x32_bf16 v[116:119],v[124:127],v[84:87],v[116:119]
v_lshlrev_b32 v8,4,v9
v_and_b32 v124,1,v10
v_lshl_add_u32 v8,v124,3,v8
v_and_b32 v124,2,v10
v_lshl_add_u32 v8,v124,30,v8
s_lshl_b32 s65,s51,15
s_add_u32 s65,s65,92274688
s_lshl_b32 s59,s47,10
s_lshl_b32 s60,s46,8
s_add_u32 s59,s59,s60
s_add_u32 s59,s59,s65
v_cvt_pk_bf16_f32 v24,v116,v117
v_cvt_pk_bf16_f32 v25,v118,v119
buffer_store_dwordx2 v[24:25],v8,s[8:11],s59 offen sc1
s_lshl_b32 s59,s51,13
s_lshl2_add_u32 s59,s47,s59
s_add_u32 s59,s59,10486912
s_waitcnt vmcnt(0)
s_barrier
s_or_b32 s59,s59,s52
buffer_store_dword v17,off,s[8:11],s59 sc1
s_cmp_lg_u32 s47,0
s_cbranch_scc1 L_moed_388
s_lshl_b32 s59,s51,13
s_add_u32 s59,s59,10486912
v_and_b32 v124,31,v1
v_lshlrev_b32 v124,2,v124
L_fw_389:
buffer_load_dword v125,v124,s[8:11],s59 offen sc1
s_sub_u32 s49,s49,1
s_cbranch_scc1 L_abort2
s_waitcnt vmcnt(0)
v_cmp_eq_u32 vcc,0,v125
s_cbranch_vccnz L_fw_389
s_add_u32 s63,s65,0
buffer_load_dwordx4 v[24:27],v22,s[8:11],s63 offen sc1
s_add_u32 s63,s65,4096
buffer_load_dwordx4 v[28:31],v22,s[8:11],s63 offen sc1
s_add_u32 s63,s65,8192
buffer_load_dwordx4 v[32:35],v22,s[8:11],s63 offen sc1
s_add_u32 s63,s65,12288
buffer_load_dwordx4 v[36:39],v22,s[8:11],s63 offen sc1
s_add_u32 s63,s65,16384
buffer_load_dwordx4 v[40:43],v22,s[8:11],s63 offen sc1
s_add_u32 s63,s65,20480
buffer_load_dwordx4 v[44:47],v22,s[8:11],s63 offen sc1
s_add_u32 s63,s65,24576
buffer_load_dwordx4 v[48:51],v22,s[8:11],s63 offen sc1
s_add_u32 s63,s65,28672
buffer_load_dwordx4 v[52:55],v22,s[8:11],s63 offen sc1
v_and_b32 v64,15,v1
v_and_b32 v65,1,v1
v_lshlrev_b32 v65,4,v65
v_mov_b32 v66,0x3f80
v_lshlrev_b32 v66,v65,v66
v_lshrrev_b32 v64,1,v64
v_cmp_eq_u32 vcc,0,v64
s_nop 1
v_cndmask_b32 v56,0,v66,vcc
v_cmp_eq_u32 vcc,1,v64
s_nop 1
v_cndmask_b32 v57,0,v66,vcc
v_cmp_eq_u32 vcc,2,v64
s_nop 1
v_cndmask_b32 v58,0,v66,vcc
v_cmp_eq_u32 vcc,3,v64
s_nop 1
v_cndmask_b32 v59,0,v66,vcc
s_waitcnt vmcnt(7)
s_nop 0
v_mfma_f32_16x16x32_bf16 v[60:63],v[56:59],v[24:27],0
s_waitcnt vmcnt(6)
v_mfma_f32_16x16x32_bf16 v[60:63],v[56:59],v[28:31],v[60:63]
s_waitcnt vmcnt(5)
v_mfma_f32_16x16x32_bf16 v[60:63],v[56:59],v[32:35],v[60:63]
s_waitcnt vmcnt(4)
v_mfma_f32_16x16x32_bf16 v[60:63],v[56:59],v[36:39],v[60:63]
s_waitcnt vmcnt(3)
v_mfma_f32_16x16x32_bf16 v[60:63],v[56:59],v[40:43],v[60:63]
s_waitcnt vmcnt(2)
v_mfma_f32_16x16x32_bf16 v[60:63],v[56:59],v[44:47],v[60:63]
s_waitcnt vmcnt(1)
v_mfma_f32_16x16x32_bf16 v[60:63],v[56:59],v[48:51],v[60:63]
s_waitcnt vmcnt(0)
v_mfma_f32_16x16x32_bf16 v[60:63],v[56:59],v[52:55],v[60:63]
s_nop 7
ds_write_b128 v21,v[60:63]
s_waitcnt lgkmcnt(0)
s_barrier
s_cmp_lg_u32 s46,0
s_cbranch_scc1 L_moed_388
v_lshlrev_b32 v56,5,v1
v_add_u32 v56,155648,v56
ds_read_b128 v[24:27],v56
ds_read_b128 v[28:31],v56 offset:16
s_and_b32 s59,s55,0xffff0000
s_xor_b32 s60,s59,0x80000000
s_xor_b32 s61,s59,0xffff0000
s_cmp_lt_i32 s59,0
s_cselect_b32 s59,s60,s61
v_mov_b32 v56,s59
v_mul_f32 v56,0xbfb8aa3b,v56
v_exp_f32 v56,v56
s_nop 0
v_add_f32 v56,1.0,v56
v_rcp_f32 v56,v56
s_nop 0
v_cvt_pk_bf16_f32 v56,v56,v56
v_and_b32 v56,0xffff0000,v56
v_lshlrev_b32 v48,16,v104
v_and_b32 v49,0xffff0000,v104
v_lshlrev_b32 v50,16,v105
v_and_b32 v51,0xffff0000,v105
v_lshlrev_b32 v52,16,v106
v_and_b32 v53,0xffff0000,v106
v_lshlrev_b32 v54,16,v107
v_and_b32 v55,0xffff0000,v107
s_waitcnt lgkmcnt(0)
v_cvt_pk_bf16_f32 v40,v24,v25
v_cvt_pk_bf16_f32 v41,v26,v27
v_cvt_pk_bf16_f32 v42,v28,v29
v_cvt_pk_bf16_f32 v43,v30,v31
v_lshlrev_b32 v24,16,v40
v_and_b32 v25,0xffff0000,v40
v_lshlrev_b32 v26,16,v41
v_and_b32 v27,0xffff0000,v41
v_lshlrev_b32 v28,16,v42
v_and_b32 v29,0xffff0000,v42
v_lshlrev_b32 v30,16,v43
v_and_b32 v31,0xffff0000,v43
v_mul_f32 v24,v24,v56
v_mul_f32 v25,v25,v56
v_mul_f32 v26,v26,v56
v_mul_f32 v27,v27,v56
v_mul_f32 v28,v28,v56
v_mul_f32 v29,v29,v56
v_mul_f32 v30,v30,v56
v_mul_f32 v31,v31,v56
v_cvt_pk_bf16_f32 v40,v24,v25
v_cvt_pk_bf16_f32 v41,v26,v27
v_cvt_pk_bf16_f32 v42,v28,v29
v_cvt_pk_bf16_f32 v43,v30,v31
v_lshlrev_b32 v24,16,v40
v_and_b32 v25,0xffff0000,v40
v_lshlrev_b32 v26,16,v41
v_and_b32 v27,0xffff0000,v41
v_lshlrev_b32 v28,16,v42
v_and_b32 v29,0xffff0000,v42
v_lshlrev_b32 v30,16,v43
v_and_b32 v31,0xffff0000,v43
v_add_f32 v24,v24,v48
v_add_f32 v25,v25,v49
v_add_f32 v26,v26,v50
v_add_f32 v27,v27,v51
v_add_f32 v28,v28,v52
v_add_f32 v29,v29,v53
v_add_f32 v30,v30,v54
v_add_f32 v31,v31,v55
v_cvt_pk_bf16_f32 v40,v24,v25
v_cvt_pk_bf16_f32 v41,v26,v27
v_cvt_pk_bf16_f32 v42,v28,v29
v_cvt_pk_bf16_f32 v43,v30,v31
v_lshlrev_b32 v24,16,v40
v_and_b32 v25,0xffff0000,v40
v_lshlrev_b32 v26,16,v41
v_and_b32 v27,0xffff0000,v41
v_lshlrev_b32 v28,16,v42
v_and_b32 v29,0xffff0000,v42
v_lshlrev_b32 v30,16,v43
v_and_b32 v31,0xffff0000,v43
v_add_f32 v96,v96,v24
v_add_f32 v97,v97,v25
v_add_f32 v98,v98,v26
v_add_f32 v99,v99,v27
v_add_f32 v100,v100,v28
v_add_f32 v101,v101,v29
v_add_f32 v102,v102,v30
v_add_f32 v103,v103,v31
v_cvt_pk_bf16_f32 v80,v96,v97
v_cvt_pk_bf16_f32 v81,v98,v99
v_cvt_pk_bf16_f32 v82,v100,v101
v_cvt_pk_bf16_f32 v83,v102,v103
s_mov_b32 s4,s40
s_mov_b32 s5,s41
s_mov_b32 s6,2097152
s_mov_b32 s7,0x20000
buffer_store_dwordx4 v[80:83],v0,s[4:7],s56 offen sc1
L_moed_388:
s_endpgm
.section .rodata,"a"
.p2align 6
.amdhsa_kernel interleave_layers__memory_aug_recurrent_mem_tr__moe_arch_mod__prompt_kernel
  .amdhsa_next_free_vgpr 512
  .amdhsa_next_free_sgpr 102
  .amdhsa_accum_offset 256
  .amdhsa_group_segment_fixed_size 0
  .amdhsa_kernarg_size 120
  .amdhsa_user_sgpr_count 2
  .amdhsa_user_sgpr_kernarg_segment_ptr 1
  .amdhsa_system_sgpr_workgroup_id_x 1
  .amdhsa_float_denorm_mode_32 3
.end_amdhsa_kernel
```

```asm
; @launch grid=(256,1,1) block=(256,1,1) lds=163840
.amdgcn_target "amdgcn-amd-amdhsa--gfx950"
.text
.globl interleave_layers__memory_aug_recurrent_mem_tr__moe_arch_mod__prompt_kernel
.p2align 8
.type interleave_layers__memory_aug_recurrent_mem_tr__moe_arch_mod__prompt_kernel,@function
interleave_layers__memory_aug_recurrent_mem_tr__moe_arch_mod__prompt_kernel:
s_cmp_ge_u32 s2,256
s_cbranch_scc1 L_abort
s_load_dwordx16 s[16:31],s[0:1],0
s_load_dwordx8 s[32:39],s[0:1],64
s_load_dwordx4 s[40:43],s[0:1],96
s_load_dwordx2 s[44:45],s[0:1],112
v_lshrrev_b32 v2,6,v0
v_and_b32 v1,63,v0
v_readfirstlane_b32 s46,v2
v_lshlrev_b32 v0,4,v1
s_getreg_b32 s48,hwreg(HW_REG_XCC_ID)
s_and_b32 s48,s48,7
s_lshl_b32 s48,s48,2
s_lshr_b32 s48,1399931488,s48
s_and_b32 s48,s48,7
s_mov_b32 s49,100000
s_mov_b32 s80,0x3e0293ee
s_waitcnt lgkmcnt(0)
s_mov_b32 s8,s44
s_mov_b32 s9,s45
s_mov_b32 s10,268435456
s_mov_b32 s11,0x20000
s_mov_b32 s12,s42
s_mov_b32 s13,s43
s_mov_b32 s14,256
s_mov_b32 s15,0x20000
s_cmp_lg_u32 s46,0
s_cbranch_scc1 L_tk_1
s_lshl_b32 s56,s48,2
v_mov_b32 v14,s56
v_mov_b32 v15,1
s_mov_b64 exec,1
buffer_atomic_add v15,v14,s[12:15],0 offen sc0
s_mov_b64 exec,-1
L_tk_1:
s_mov_b32 s4,s16
s_mov_b32 s5,s17
s_mov_b32 s6,2097152
s_mov_b32 s7,0x20000
s_lshl_b32 s56,s2,3
s_lshl_b32 s59,s46,1
s_add_u32 s56,s56,s59
s_lshl_b32 s59,s56,10
buffer_load_dwordx4 v[24:27],v0,s[4:7],s59 offen
buffer_load_dwordx4 v[28:31],v0,s[4:7],s59 offen offset:1024
s_lshl_b32 s56,s2,12
s_lshl_b32 s57,s46,10
s_add_u32 s56,s56,s57
v_add_u32 v2,s56,v0
v_mov_b32 v4,-1
v_mov_b32 v5,-1
v_mov_b32 v6,-1
v_mov_b32 v7,-1
v_mov_b32 v8,0
v_mov_b32 v9,0
v_mov_b32 v10,0
v_mov_b32 v11,0
v_cmp_gt_u32 vcc,524288,v2
v_mov_b32 v3,14155776
v_mov_b32 v12,11542528
v_cndmask_b32 v3,v3,v12,vcc
v_add_u32 v3,v3,v2
s_mov_b32 s56,0
buffer_store_dwordx4 v[4:7],v3,s[8:11],s56 offen sc1
s_mov_b32 s56,1048576
buffer_store_dwordx4 v[4:7],v3,s[8:11],s56 offen sc1
s_mov_b32 s56,2097152
buffer_store_dwordx4 v[4:7],v3,s[8:11],s56 offen sc1
s_mov_b32 s56,4194304
buffer_store_dwordx4 v[4:7],v2,s[8:11],s56 offen sc1
s_mov_b32 s56,5242880
buffer_store_dwordx4 v[4:7],v2,s[8:11],s56 offen sc1
v_add_u32 v3,17309696,v2
v_mov_b32 v12,0x80000000
v_cndmask_b32 v3,v3,v12,vcc
buffer_store_dwordx4 v[4:7],v3,s[8:11],0 offen sc1
v_cmp_gt_u32 vcc,147456,v2
v_lshrrev_b32 v3,11,v2
v_lshlrev_b32 v3,13,v3
v_and_b32 v13,0x7ff,v2
v_add_u32 v3,v3,v13
v_add_u32 v3,10485760,v3
v_cndmask_b32 v3,v12,v3,vcc
buffer_store_dwordx4 v[8:11],v3,s[8:11],0 offen sc1
v_add_u32 v3,11075584,v2
v_lshrrev_b32 v13,16,v2
v_cmp_eq_u32 vcc,4,v13
s_nop 1
v_cndmask_b32 v3,v12,v3,vcc
buffer_store_dwordx4 v[4:7],v3,s[8:11],0 offen sc1
s_waitcnt vmcnt(8)
v_lshlrev_b32 v32,16,v24
v_and_b32 v33,0xffff0000,v24
v_lshlrev_b32 v34,16,v25
v_and_b32 v35,0xffff0000,v25
v_lshlrev_b32 v36,16,v26
v_and_b32 v37,0xffff0000,v26
v_lshlrev_b32 v38,16,v27
v_and_b32 v39,0xffff0000,v27
v_readfirstlane_b32 s78,v32
s_nop 1
v_pk_add_f32 v[48:49],v[32:33],s[78:79] op_sel_hi:[1,0] neg_lo:[0,1] neg_hi:[0,1]
v_pk_add_f32 v[50:51],v[34:35],s[78:79] op_sel_hi:[1,0] neg_lo:[0,1] neg_hi:[0,1]
v_pk_add_f32 v[52:53],v[36:37],s[78:79] op_sel_hi:[1,0] neg_lo:[0,1] neg_hi:[0,1]
v_pk_add_f32 v[54:55],v[38:39],s[78:79] op_sel_hi:[1,0] neg_lo:[0,1] neg_hi:[0,1]
v_pk_add_f32 v[56:57],v[48:49],v[50:51]
v_pk_mul_f32 v[58:59],v[48:49],v[48:49]
v_pk_add_f32 v[60:61],v[52:53],v[54:55]
v_pk_fma_f32 v[58:59],v[50:51],v[50:51],v[58:59]
v_pk_add_f32 v[56:57],v[56:57],v[60:61]
v_pk_fma_f32 v[58:59],v[52:53],v[52:53],v[58:59]
v_add_f32 v56,v56,v57
v_pk_fma_f32 v[58:59],v[54:55],v[54:55],v[58:59]
v_add_f32 v58,v58,v59
s_nop 1
v_permlane32_swap_b32 v56,v58
v_add_f32 v56,v56,v58
s_nop 1
v_add_f32_dpp v56,v56,v56 row_ror:8 row_mask:0xf bank_mask:0xf
s_nop 1
v_add_f32_dpp v56,v56,v56 row_ror:4 row_mask:0xf bank_mask:0xf
s_nop 1
v_add_f32_dpp v56,v56,v56 row_ror:2 row_mask:0xf bank_mask:0xf
s_nop 1
v_add_f32_dpp v56,v56,v56 row_ror:1 row_mask:0xf bank_mask:0xf
v_mov_b32 v58,v56
s_nop 1
v_permlane16_swap_b32 v56,v58
v_add_f32 v56,v56,v58
v_mul_f32 v56,0x3b000000,v56
v_mov_b32 v58,v56
s_nop 1
v_permlane32_swap_b32 v56,v58
v_fma_f32 v58,-v56,v56,v58
v_add_f32 v56,s78,v56
v_max_f32 v58,0,v58
v_cvt_pk_bf16_f32 v58,v56,v58
v_lshlrev_b32 v56,16,v58
v_and_b32 v58,0xffff0000,v58
v_add_f32 v58,0x3727c5ac,v58
v_cvt_pk_bf16_f32 v58,v58,v58
v_and_b32 v58,0xffff0000,v58
v_sqrt_f32 v58,v58
v_pk_add_f32 v[48:49],v[32:33],v[56:57] op_sel_hi:[1,0] neg_lo:[0,1] neg_hi:[0,1]
v_pk_add_f32 v[50:51],v[34:35],v[56:57] op_sel_hi:[1,0] neg_lo:[0,1] neg_hi:[0,1]
v_pk_add_f32 v[52:53],v[36:37],v[56:57] op_sel_hi:[1,0] neg_lo:[0,1] neg_hi:[0,1]
v_pk_add_f32 v[54:55],v[38:39],v[56:57] op_sel_hi:[1,0] neg_lo:[0,1] neg_hi:[0,1]
v_cvt_pk_bf16_f32 v58,v58,v58
v_and_b32 v58,0xffff0000,v58
v_rcp_f32 v58,v58
v_cvt_pk_bf16_f32 v40,v48,v49
v_cvt_pk_bf16_f32 v41,v50,v51
v_cvt_pk_bf16_f32 v42,v52,v53
v_cvt_pk_bf16_f32 v43,v54,v55
v_lshlrev_b32 v48,16,v40
v_and_b32 v49,0xffff0000,v40
v_lshlrev_b32 v50,16,v41
v_and_b32 v51,0xffff0000,v41
v_lshlrev_b32 v52,16,v42
v_and_b32 v53,0xffff0000,v42
v_lshlrev_b32 v54,16,v43
v_and_b32 v55,0xffff0000,v43
v_pk_mul_f32 v[48:49],v[48:49],v[58:59] op_sel_hi:[1,0]
v_pk_mul_f32 v[50:51],v[50:51],v[58:59] op_sel_hi:[1,0]
v_pk_mul_f32 v[52:53],v[52:53],v[58:59] op_sel_hi:[1,0]
v_pk_mul_f32 v[54:55],v[54:55],v[58:59] op_sel_hi:[1,0]
v_cvt_pk_bf16_f32 v40,v48,v49
v_cvt_pk_bf16_f32 v41,v50,v51
v_cvt_pk_bf16_f32 v42,v52,v53
v_cvt_pk_bf16_f32 v43,v54,v55
buffer_store_dwordx4 v[40:43],v0,s[8:11],s59 offen offset:0 sc1
v_lshlrev_b32 v32,16,v28
v_and_b32 v33,0xffff0000,v28
v_lshlrev_b32 v34,16,v29
v_and_b32 v35,0xffff0000,v29
v_lshlrev_b32 v36,16,v30
v_and_b32 v37,0xffff0000,v30
v_lshlrev_b32 v38,16,v31
v_and_b32 v39,0xffff0000,v31
v_readfirstlane_b32 s78,v32
s_nop 1
v_pk_add_f32 v[48:49],v[32:33],s[78:79] op_sel_hi:[1,0] neg_lo:[0,1] neg_hi:[0,1]
v_pk_add_f32 v[50:51],v[34:35],s[78:79] op_sel_hi:[1,0] neg_lo:[0,1] neg_hi:[0,1]
v_pk_add_f32 v[52:53],v[36:37],s[78:79] op_sel_hi:[1,0] neg_lo:[0,1] neg_hi:[0,1]
v_pk_add_f32 v[54:55],v[38:39],s[78:79] op_sel_hi:[1,0] neg_lo:[0,1] neg_hi:[0,1]
v_pk_add_f32 v[56:57],v[48:49],v[50:51]
v_pk_mul_f32 v[58:59],v[48:49],v[48:49]
v_pk_add_f32 v[60:61],v[52:53],v[54:55]
v_pk_fma_f32 v[58:59],v[50:51],v[50:51],v[58:59]
v_pk_add_f32 v[56:57],v[56:57],v[60:61]
v_pk_fma_f32 v[58:59],v[52:53],v[52:53],v[58:59]
v_add_f32 v56,v56,v57
v_pk_fma_f32 v[58:59],v[54:55],v[54:55],v[58:59]
v_add_f32 v58,v58,v59
s_nop 1
v_permlane32_swap_b32 v56,v58
v_add_f32 v56,v56,v58
s_nop 1
v_add_f32_dpp v56,v56,v56 row_ror:8 row_mask:0xf bank_mask:0xf
s_nop 1
v_add_f32_dpp v56,v56,v56 row_ror:4 row_mask:0xf bank_mask:0xf
s_nop 1
v_add_f32_dpp v56,v56,v56 row_ror:2 row_mask:0xf bank_mask:0xf
s_nop 1
v_add_f32_dpp v56,v56,v56 row_ror:1 row_mask:0xf bank_mask:0xf
v_mov_b32 v58,v56
s_nop 1
v_permlane16_swap_b32 v56,v58
v_add_f32 v56,v56,v58
v_mul_f32 v56,0x3b000000,v56
v_mov_b32 v58,v56
s_nop 1
v_permlane32_swap_b32 v56,v58
v_fma_f32 v58,-v56,v56,v58
v_add_f32 v56,s78,v56
v_max_f32 v58,0,v58
v_cvt_pk_bf16_f32 v58,v56,v58
v_lshlrev_b32 v56,16,v58
v_and_b32 v58,0xffff0000,v58
v_add_f32 v58,0x3727c5ac,v58
v_cvt_pk_bf16_f32 v58,v58,v58
v_and_b32 v58,0xffff0000,v58
v_sqrt_f32 v58,v58
v_pk_add_f32 v[48:49],v[32:33],v[56:57] op_sel_hi:[1,0] neg_lo:[0,1] neg_hi:[0,1]
v_pk_add_f32 v[50:51],v[34:35],v[56:57] op_sel_hi:[1,0] neg_lo:[0,1] neg_hi:[0,1]
v_pk_add_f32 v[52:53],v[36:37],v[56:57] op_sel_hi:[1,0] neg_lo:[0,1] neg_hi:[0,1]
v_pk_add_f32 v[54:55],v[38:39],v[56:57] op_sel_hi:[1,0] neg_lo:[0,1] neg_hi:[0,1]
v_cvt_pk_bf16_f32 v58,v58,v58
v_and_b32 v58,0xffff0000,v58
v_rcp_f32 v58,v58
v_cvt_pk_bf16_f32 v44,v48,v49
v_cvt_pk_bf16_f32 v45,v50,v51
v_cvt_pk_bf16_f32 v46,v52,v53
v_cvt_pk_bf16_f32 v47,v54,v55
v_lshlrev_b32 v48,16,v44
v_and_b32 v49,0xffff0000,v44
v_lshlrev_b32 v50,16,v45
v_and_b32 v51,0xffff0000,v45
v_lshlrev_b32 v52,16,v46
v_and_b32 v53,0xffff0000,v46
v_lshlrev_b32 v54,16,v47
v_and_b32 v55,0xffff0000,v47
v_pk_mul_f32 v[48:49],v[48:49],v[58:59] op_sel_hi:[1,0]
v_pk_mul_f32 v[50:51],v[50:51],v[58:59] op_sel_hi:[1,0]
v_pk_mul_f32 v[52:53],v[52:53],v[58:59] op_sel_hi:[1,0]
v_pk_mul_f32 v[54:55],v[54:55],v[58:59] op_sel_hi:[1,0]
v_cvt_pk_bf16_f32 v44,v48,v49
v_cvt_pk_bf16_f32 v45,v50,v51
v_cvt_pk_bf16_f32 v46,v52,v53
v_cvt_pk_bf16_f32 v47,v54,v55
buffer_store_dwordx4 v[44:47],v0,s[8:11],s59 offen offset:1024 sc1
s_mov_b32 s4,s18
s_mov_b32 s5,s19
s_mov_b32 s6,8192
s_mov_b32 s7,0x20000
s_cmp_ge_u32 s2,2
s_cbranch_scc1 L_m0_2
s_lshl_b32 s56,s2,2
s_add_u32 s56,s56,s46
v_bfe_u32 v2,v1,2,2
v_and_b32 v3,1,v1
v_lshl_add_u32 v2,v2,1,v3
v_lshlrev_b32 v2,10,v2
v_lshrrev_b32 v3,4,v1
v_lshl_add_u32 v2,v3,5,v2
v_and_b32 v3,2,v1
v_lshl_add_u32 v2,v3,1,v2
s_lshl_b32 s57,s56,7
buffer_load_dword v32,v2,s[4:7],s57 offen offset:0
buffer_load_dword v33,v2,s[4:7],s57 offen offset:8
buffer_load_dword v34,v2,s[4:7],s57 offen offset:16
buffer_load_dword v35,v2,s[4:7],s57 offen offset:24
v_lshrrev_b32 v2,3,v1
v_lshlrev_b32 v2,9,v2
v_and_b32 v3,7,v1
v_lshl_add_u32 v2,v3,4,v2
s_and_b32 s57,s56,1
s_lshl_b32 s57,s57,8
s_and_b32 s58,s56,2
s_lshl_b32 s58,s58,6
s_add_u32 s57,s57,s58
s_and_b32 s58,s56,4
s_lshl_b32 s58,s58,10
s_add_u32 s57,s57,s58
s_waitcnt vmcnt(0)
s_add_u32 s58,s57,11534336
buffer_store_dwordx4 v[32:35],v2,s[8:11],s58 offen sc1
s_add_u32 s58,s57,12582912
buffer_store_dwordx4 v[32:35],v2,s[8:11],s58 offen sc1
s_add_u32 s58,s57,17825792
buffer_store_dwordx4 v[32:35],v2,s[8:11],s58 offen sc1
L_m0_2:
s_cmp_lg_u32 s46,0
s_cbranch_scc1 L_tk_3
s_mov_b64 exec,1
v_mov_b32 v4,159744
ds_write_b32 v4,v15
s_mov_b64 exec,-1
s_waitcnt lgkmcnt(0)
L_tk_3:
s_barrier
v_mov_b32 v4,159744
ds_read_b32 v3,v4
s_waitcnt lgkmcnt(0)
v_readfirstlane_b32 s47,v3
s_mov_b32 s3,0
s_cmp_ge_u32 s47,32
s_cselect_b32 s53,0x10001,1
s_and_b32 s47,s47,31
s_lshl_b32 s50,s46,10
s_cmp_eq_u32 s46,0
s_cselect_b32 s52,0,0x80000000
s_mov_b32 s28,0x3f803f80
s_mov_b32 s29,0x3f803f80
s_mov_b32 s51,0
s_bfe_u32 s56,s48,0x10001
s_and_b32 s57,s48,1
s_add_u32 s58,s56,6
s_sub_u32 s59,5,s57
s_cmp_ge_u32 s47,16
s_cselect_b32 s58,s58,s59
s_cselect_b32 s57,s57,s56
s_and_b32 s59,s47,15
s_lshl4_add_u32 s57,s57,s59
s_cmp_ge_u32 s48,4
s_cselect_b32 s48,s58,s48
s_cselect_b32 s47,s57,s47
L_roles:
s_cmp_ge_u32 s48,6
s_cbranch_scc1 L_ra_6
v_and_b32 v2,15,v1
v_lshlrev_b32 v2,2,v2
v_lshrrev_b32 v3,4,v1
v_lshl_add_u32 v4,v3,16,v2
v_lshl_add_u32 v5,v3,13,v2
s_lshl_b32 s58,s47,8
s_lshl_b32 s57,s46,6
s_add_u32 s58,s58,s57
s_lshl_b32 s59,s47,17
s_add_u32 s59,s59,s57
s_lshl_b32 s60,s46,15
v_add_u32 v6,s60,v0
s_mov_b32 s61,0x05040100
s_mov_b32 s62,0x07060302
s_lshl_b32 s63,s46,19
s_cmp_lt_u32 s48,3
s_cselect_b32 s63,s63,0
s_mov_b32 s4,s22
s_mov_b32 s5,s23
s_mov_b32 s6,4194304
s_mov_b32 s7,0x20000
s_xor_b32 s56,s63,0
s_add_u32 s56,s56,s58
buffer_load_dword v24,v4,s[4:7],s56 offen
s_add_u32 s56,s56,8192
buffer_load_dword v25,v4,s[4:7],s56 offen
s_add_u32 s56,s56,8192
buffer_load_dword v26,v4,s[4:7],s56 offen
s_add_u32 s56,s56,8192
buffer_load_dword v27,v4,s[4:7],s56 offen
s_add_u32 s56,s56,8192
buffer_load_dword v28,v4,s[4:7],s56 offen
s_add_u32 s56,s56,8192
buffer_load_dword v29,v4,s[4:7],s56 offen
s_add_u32 s56,s56,8192
buffer_load_dword v30,v4,s[4:7],s56 offen
s_add_u32 s56,s56,8192
buffer_load_dword v31,v4,s[4:7],s56 offen
s_xor_b32 s56,s63,262144
s_add_u32 s56,s56,s58
buffer_load_dword v32,v4,s[4:7],s56 offen
s_add_u32 s56,s56,8192
buffer_load_dword v33,v4,s[4:7],s56 offen
s_add_u32 s56,s56,8192
buffer_load_dword v34,v4,s[4:7],s56 offen
s_add_u32 s56,s56,8192
buffer_load_dword v35,v4,s[4:7],s56 offen
s_add_u32 s56,s56,8192
buffer_load_dword v36,v4,s[4:7],s56 offen
s_add_u32 s56,s56,8192
buffer_load_dword v37,v4,s[4:7],s56 offen
s_add_u32 s56,s56,8192
buffer_load_dword v38,v4,s[4:7],s56 offen
s_add_u32 s56,s56,8192
buffer_load_dword v39,v4,s[4:7],s56 offen
s_xor_b32 s56,s63,524288
s_add_u32 s56,s56,s58
buffer_load_dword v40,v4,s[4:7],s56 offen
s_add_u32 s56,s56,8192
buffer_load_dword v41,v4,s[4:7],s56 offen
s_add_u32 s56,s56,8192
buffer_load_dword v42,v4,s[4:7],s56 offen
s_add_u32 s56,s56,8192
buffer_load_dword v43,v4,s[4:7],s56 offen
s_add_u32 s56,s56,8192
buffer_load_dword v44,v4,s[4:7],s56 offen
s_add_u32 s56,s56,8192
buffer_load_dword v45,v4,s[4:7],s56 offen
s_add_u32 s56,s56,8192
buffer_load_dword v46,v4,s[4:7],s56 offen
s_add_u32 s56,s56,8192
buffer_load_dword v47,v4,s[4:7],s56 offen
s_xor_b32 s56,s63,786432
s_add_u32 s56,s56,s58
buffer_load_dword v48,v4,s[4:7],s56 offen
s_add_u32 s56,s56,8192
buffer_load_dword v49,v4,s[4:7],s56 offen
s_add_u32 s56,s56,8192
buffer_load_dword v50,v4,s[4:7],s56 offen
s_add_u32 s56,s56,8192
buffer_load_dword v51,v4,s[4:7],s56 offen
s_add_u32 s56,s56,8192
buffer_load_dword v52,v4,s[4:7],s56 offen
s_add_u32 s56,s56,8192
buffer_load_dword v53,v4,s[4:7],s56 offen
s_add_u32 s56,s56,8192
buffer_load_dword v54,v4,s[4:7],s56 offen
s_add_u32 s56,s56,8192
buffer_load_dword v55,v4,s[4:7],s56 offen
s_xor_b32 s56,s63,1048576
s_add_u32 s56,s56,s58
buffer_load_dword v56,v4,s[4:7],s56 offen
s_add_u32 s56,s56,8192
buffer_load_dword v57,v4,s[4:7],s56 offen
s_add_u32 s56,s56,8192
buffer_load_dword v58,v4,s[4:7],s56 offen
s_add_u32 s56,s56,8192
buffer_load_dword v59,v4,s[4:7],s56 offen
s_add_u32 s56,s56,8192
buffer_load_dword v60,v4,s[4:7],s56 offen
s_add_u32 s56,s56,8192
buffer_load_dword v61,v4,s[4:7],s56 offen
s_add_u32 s56,s56,8192
buffer_load_dword v62,v4,s[4:7],s56 offen
s_add_u32 s56,s56,8192
buffer_load_dword v63,v4,s[4:7],s56 offen
s_xor_b32 s56,s63,1310720
s_add_u32 s56,s56,s58
buffer_load_dword v64,v4,s[4:7],s56 offen
s_add_u32 s56,s56,8192
buffer_load_dword v65,v4,s[4:7],s56 offen
s_add_u32 s56,s56,8192
buffer_load_dword v66,v4,s[4:7],s56 offen
s_add_u32 s56,s56,8192
buffer_load_dword v67,v4,s[4:7],s56 offen
s_add_u32 s56,s56,8192
buffer_load_dword v68,v4,s[4:7],s56 offen
s_add_u32 s56,s56,8192
buffer_load_dword v69,v4,s[4:7],s56 offen
s_add_u32 s56,s56,8192
buffer_load_dword v70,v4,s[4:7],s56 offen
s_add_u32 s56,s56,8192
buffer_load_dword v71,v4,s[4:7],s56 offen
s_xor_b32 s56,s63,1572864
s_add_u32 s56,s56,s58
buffer_load_dword v72,v4,s[4:7],s56 offen
s_add_u32 s56,s56,8192
buffer_load_dword v73,v4,s[4:7],s56 offen
s_add_u32 s56,s56,8192
buffer_load_dword v74,v4,s[4:7],s56 offen
s_add_u32 s56,s56,8192
buffer_load_dword v75,v4,s[4:7],s56 offen
s_add_u32 s56,s56,8192
buffer_load_dword v76,v4,s[4:7],s56 offen
s_add_u32 s56,s56,8192
buffer_load_dword v77,v4,s[4:7],s56 offen
s_add_u32 s56,s56,8192
buffer_load_dword v78,v4,s[4:7],s56 offen
s_add_u32 s56,s56,8192
buffer_load_dword v79,v4,s[4:7],s56 offen
s_waitcnt vmcnt(48)
v_perm_b32 v80,v25,v24,s61
v_perm_b32 v81,v27,v26,s61
v_perm_b32 v82,v29,v28,s61
v_perm_b32 v83,v31,v30,s61
v_perm_b32 v84,v25,v24,s62
v_perm_b32 v85,v27,v26,s62
v_perm_b32 v86,v29,v28,s62
v_perm_b32 v87,v31,v30,s62
v_accvgpr_write_b32 a128,v80
v_accvgpr_write_b32 a129,v81
v_accvgpr_write_b32 a130,v82
v_accvgpr_write_b32 a131,v83
v_accvgpr_write_b32 a136,v84
v_accvgpr_write_b32 a137,v85
v_accvgpr_write_b32 a138,v86
v_accvgpr_write_b32 a139,v87
s_xor_b32 s56,s63,1835008
s_add_u32 s56,s56,s58
buffer_load_dword v24,v4,s[4:7],s56 offen
s_add_u32 s56,s56,8192
buffer_load_dword v25,v4,s[4:7],s56 offen
s_add_u32 s56,s56,8192
buffer_load_dword v26,v4,s[4:7],s56 offen
s_add_u32 s56,s56,8192
buffer_load_dword v27,v4,s[4:7],s56 offen
s_add_u32 s56,s56,8192
buffer_load_dword v28,v4,s[4:7],s56 offen
s_add_u32 s56,s56,8192
buffer_load_dword v29,v4,s[4:7],s56 offen
s_add_u32 s56,s56,8192
buffer_load_dword v30,v4,s[4:7],s56 offen
s_add_u32 s56,s56,8192
buffer_load_dword v31,v4,s[4:7],s56 offen
s_barrier
s_cmp_lg_u32 s46,0
s_cbranch_scc1 L_ar_10
v_mov_b32 v8,128
v_mov_b32 v9,s53
s_mov_b64 exec,1
buffer_atomic_add v9,v8,s[12:15],0 offen
s_mov_b64 exec,-1
L_ar_10:
s_mov_b32 s53,0
s_waitcnt vmcnt(48)
v_perm_b32 v80,v33,v32,s61
v_perm_b32 v81,v35,v34,s61
v_perm_b32 v82,v37,v36,s61
v_perm_b32 v83,v39,v38,s61
v_perm_b32 v84,v33,v32,s62
v_perm_b32 v85,v35,v34,s62
v_perm_b32 v86,v37,v36,s62
v_perm_b32 v87,v39,v38,s62
v_accvgpr_write_b32 a132,v80
v_accvgpr_write_b32 a133,v81
v_accvgpr_write_b32 a134,v82
v_accvgpr_write_b32 a135,v83
v_accvgpr_write_b32 a140,v84
v_accvgpr_write_b32 a141,v85
v_accvgpr_write_b32 a142,v86
v_accvgpr_write_b32 a143,v87
s_xor_b32 s56,s63,2097152
s_add_u32 s56,s56,s58
buffer_load_dword v32,v4,s[4:7],s56 offen
s_add_u32 s56,s56,8192
buffer_load_dword v33,v4,s[4:7],s56 offen
s_add_u32 s56,s56,8192
buffer_load_dword v34,v4,s[4:7],s56 offen
s_add_u32 s56,s56,8192
buffer_load_dword v35,v4,s[4:7],s56 offen
s_add_u32 s56,s56,8192
buffer_load_dword v36,v4,s[4:7],s56 offen
s_add_u32 s56,s56,8192
buffer_load_dword v37,v4,s[4:7],s56 offen
s_add_u32 s56,s56,8192
buffer_load_dword v38,v4,s[4:7],s56 offen
s_add_u32 s56,s56,8192
buffer_load_dword v39,v4,s[4:7],s56 offen
s_waitcnt vmcnt(48)
v_perm_b32 v80,v41,v40,s61
v_perm_b32 v81,v43,v42,s61
v_perm_b32 v82,v45,v44,s61
v_perm_b32 v83,v47,v46,s61
v_perm_b32 v84,v41,v40,s62
v_perm_b32 v85,v43,v42,s62
v_perm_b32 v86,v45,v44,s62
v_perm_b32 v87,v47,v46,s62
v_accvgpr_write_b32 a144,v80
v_accvgpr_write_b32 a145,v81
v_accvgpr_write_b32 a146,v82
v_accvgpr_write_b32 a147,v83
v_accvgpr_write_b32 a152,v84
v_accvgpr_write_b32 a153,v85
v_accvgpr_write_b32 a154,v86
v_accvgpr_write_b32 a155,v87
s_xor_b32 s56,s63,2359296
s_add_u32 s56,s56,s58
buffer_load_dword v40,v4,s[4:7],s56 offen
s_add_u32 s56,s56,8192
buffer_load_dword v41,v4,s[4:7],s56 offen
s_add_u32 s56,s56,8192
buffer_load_dword v42,v4,s[4:7],s56 offen
s_add_u32 s56,s56,8192
buffer_load_dword v43,v4,s[4:7],s56 offen
s_add_u32 s56,s56,8192
buffer_load_dword v44,v4,s[4:7],s56 offen
s_add_u32 s56,s56,8192
buffer_load_dword v45,v4,s[4:7],s56 offen
s_add_u32 s56,s56,8192
buffer_load_dword v46,v4,s[4:7],s56 offen
s_add_u32 s56,s56,8192
buffer_load_dword v47,v4,s[4:7],s56 offen
s_waitcnt vmcnt(48)
v_perm_b32 v80,v49,v48,s61
v_perm_b32 v81,v51,v50,s61
v_perm_b32 v82,v53,v52,s61
v_perm_b32 v83,v55,v54,s61
v_perm_b32 v84,v49,v48,s62
v_perm_b32 v85,v51,v50,s62
v_perm_b32 v86,v53,v52,s62
v_perm_b32 v87,v55,v54,s62
v_accvgpr_write_b32 a148,v80
v_accvgpr_write_b32 a149,v81
v_accvgpr_write_b32 a150,v82
v_accvgpr_write_b32 a151,v83
v_accvgpr_write_b32 a156,v84
v_accvgpr_write_b32 a157,v85
v_accvgpr_write_b32 a158,v86
v_accvgpr_write_b32 a159,v87
s_xor_b32 s56,s63,2621440
s_add_u32 s56,s56,s58
buffer_load_dword v48,v4,s[4:7],s56 offen
s_add_u32 s56,s56,8192
buffer_load_dword v49,v4,s[4:7],s56 offen
s_add_u32 s56,s56,8192
buffer_load_dword v50,v4,s[4:7],s56 offen
s_add_u32 s56,s56,8192
buffer_load_dword v51,v4,s[4:7],s56 offen
s_add_u32 s56,s56,8192
buffer_load_dword v52,v4,s[4:7],s56 offen
s_add_u32 s56,s56,8192
buffer_load_dword v53,v4,s[4:7],s56 offen
s_add_u32 s56,s56,8192
buffer_load_dword v54,v4,s[4:7],s56 offen
s_add_u32 s56,s56,8192
buffer_load_dword v55,v4,s[4:7],s56 offen
s_waitcnt vmcnt(48)
v_perm_b32 v80,v57,v56,s61
v_perm_b32 v81,v59,v58,s61
v_perm_b32 v82,v61,v60,s61
v_perm_b32 v83,v63,v62,s61
v_perm_b32 v84,v57,v56,s62
v_perm_b32 v85,v59,v58,s62
v_perm_b32 v86,v61,v60,s62
v_perm_b32 v87,v63,v62,s62
v_accvgpr_write_b32 a160,v80
v_accvgpr_write_b32 a161,v81
v_accvgpr_write_b32 a162,v82
v_accvgpr_write_b32 a163,v83
v_accvgpr_write_b32 a168,v84
v_accvgpr_write_b32 a169,v85
v_accvgpr_write_b32 a170,v86
v_accvgpr_write_b32 a171,v87
s_xor_b32 s56,s63,2883584
s_add_u32 s56,s56,s58
buffer_load_dword v56,v4,s[4:7],s56 offen
s_add_u32 s56,s56,8192
buffer_load_dword v57,v4,s[4:7],s56 offen
s_add_u32 s56,s56,8192
buffer_load_dword v58,v4,s[4:7],s56 offen
s_add_u32 s56,s56,8192
buffer_load_dword v59,v4,s[4:7],s56 offen
s_add_u32 s56,s56,8192
buffer_load_dword v60,v4,s[4:7],s56 offen
s_add_u32 s56,s56,8192
buffer_load_dword v61,v4,s[4:7],s56 offen
s_add_u32 s56,s56,8192
buffer_load_dword v62,v4,s[4:7],s56 offen
s_add_u32 s56,s56,8192
buffer_load_dword v63,v4,s[4:7],s56 offen
s_waitcnt vmcnt(48)
v_perm_b32 v80,v65,v64,s61
v_perm_b32 v81,v67,v66,s61
v_perm_b32 v82,v69,v68,s61
v_perm_b32 v83,v71,v70,s61
v_perm_b32 v84,v65,v64,s62
v_perm_b32 v85,v67,v66,s62
v_perm_b32 v86,v69,v68,s62
v_perm_b32 v87,v71,v70,s62
v_accvgpr_write_b32 a164,v80
v_accvgpr_write_b32 a165,v81
v_accvgpr_write_b32 a166,v82
v_accvgpr_write_b32 a167,v83
v_accvgpr_write_b32 a172,v84
v_accvgpr_write_b32 a173,v85
v_accvgpr_write_b32 a174,v86
v_accvgpr_write_b32 a175,v87
s_xor_b32 s56,s63,3145728
s_add_u32 s56,s56,s58
buffer_load_dword v64,v4,s[4:7],s56 offen
s_add_u32 s56,s56,8192
buffer_load_dword v65,v4,s[4:7],s56 offen
s_add_u32 s56,s56,8192
buffer_load_dword v66,v4,s[4:7],s56 offen
s_add_u32 s56,s56,8192
buffer_load_dword v67,v4,s[4:7],s56 offen
s_add_u32 s56,s56,8192
buffer_load_dword v68,v4,s[4:7],s56 offen
s_add_u32 s56,s56,8192
buffer_load_dword v69,v4,s[4:7],s56 offen
s_add_u32 s56,s56,8192
buffer_load_dword v70,v4,s[4:7],s56 offen
s_add_u32 s56,s56,8192
buffer_load_dword v71,v4,s[4:7],s56 offen
s_waitcnt vmcnt(48)
v_perm_b32 v80,v73,v72,s61
v_perm_b32 v81,v75,v74,s61
v_perm_b32 v82,v77,v76,s61
v_perm_b32 v83,v79,v78,s61
v_perm_b32 v84,v73,v72,s62
v_perm_b32 v85,v75,v74,s62
v_perm_b32 v86,v77,v76,s62
v_perm_b32 v87,v79,v78,s62
v_accvgpr_write_b32 a176,v80
v_accvgpr_write_b32 a177,v81
v_accvgpr_write_b32 a178,v82
v_accvgpr_write_b32 a179,v83
v_accvgpr_write_b32 a184,v84
v_accvgpr_write_b32 a185,v85
v_accvgpr_write_b32 a186,v86
v_accvgpr_write_b32 a187,v87
s_xor_b32 s56,s63,3407872
s_add_u32 s56,s56,s58
buffer_load_dword v72,v4,s[4:7],s56 offen
s_add_u32 s56,s56,8192
buffer_load_dword v73,v4,s[4:7],s56 offen
s_add_u32 s56,s56,8192
buffer_load_dword v74,v4,s[4:7],s56 offen
s_add_u32 s56,s56,8192
buffer_load_dword v75,v4,s[4:7],s56 offen
s_add_u32 s56,s56,8192
buffer_load_dword v76,v4,s[4:7],s56 offen
s_add_u32 s56,s56,8192
buffer_load_dword v77,v4,s[4:7],s56 offen
s_add_u32 s56,s56,8192
buffer_load_dword v78,v4,s[4:7],s56 offen
s_add_u32 s56,s56,8192
buffer_load_dword v79,v4,s[4:7],s56 offen
s_waitcnt vmcnt(48)
v_perm_b32 v80,v25,v24,s61
v_perm_b32 v81,v27,v26,s61
v_perm_b32 v82,v29,v28,s61
v_perm_b32 v83,v31,v30,s61
v_perm_b32 v84,v25,v24,s62
v_perm_b32 v85,v27,v26,s62
v_perm_b32 v86,v29,v28,s62
v_perm_b32 v87,v31,v30,s62
v_accvgpr_write_b32 a180,v80
v_accvgpr_write_b32 a181,v81
v_accvgpr_write_b32 a182,v82
v_accvgpr_write_b32 a183,v83
v_accvgpr_write_b32 a188,v84
v_accvgpr_write_b32 a189,v85
v_accvgpr_write_b32 a190,v86
v_accvgpr_write_b32 a191,v87
s_xor_b32 s56,s63,3670016
s_add_u32 s56,s56,s58
buffer_load_dword v24,v4,s[4:7],s56 offen
s_add_u32 s56,s56,8192
buffer_load_dword v25,v4,s[4:7],s56 offen
s_add_u32 s56,s56,8192
buffer_load_dword v26,v4,s[4:7],s56 offen
s_add_u32 s56,s56,8192
buffer_load_dword v27,v4,s[4:7],s56 offen
s_add_u32 s56,s56,8192
buffer_load_dword v28,v4,s[4:7],s56 offen
s_add_u32 s56,s56,8192
buffer_load_dword v29,v4,s[4:7],s56 offen
s_add_u32 s56,s56,8192
buffer_load_dword v30,v4,s[4:7],s56 offen
s_add_u32 s56,s56,8192
buffer_load_dword v31,v4,s[4:7],s56 offen
s_waitcnt vmcnt(48)
v_perm_b32 v80,v33,v32,s61
v_perm_b32 v81,v35,v34,s61
v_perm_b32 v82,v37,v36,s61
v_perm_b32 v83,v39,v38,s61
v_perm_b32 v84,v33,v32,s62
v_perm_b32 v85,v35,v34,s62
v_perm_b32 v86,v37,v36,s62
v_perm_b32 v87,v39,v38,s62
v_accvgpr_write_b32 a192,v80
v_accvgpr_write_b32 a193,v81
v_accvgpr_write_b32 a194,v82
v_accvgpr_write_b32 a195,v83
v_accvgpr_write_b32 a200,v84
v_accvgpr_write_b32 a201,v85
v_accvgpr_write_b32 a202,v86
v_accvgpr_write_b32 a203,v87
s_xor_b32 s56,s63,3932160
s_add_u32 s56,s56,s58
buffer_load_dword v32,v4,s[4:7],s56 offen
s_add_u32 s56,s56,8192
buffer_load_dword v33,v4,s[4:7],s56 offen
s_add_u32 s56,s56,8192
buffer_load_dword v34,v4,s[4:7],s56 offen
s_add_u32 s56,s56,8192
buffer_load_dword v35,v4,s[4:7],s56 offen
s_add_u32 s56,s56,8192
buffer_load_dword v36,v4,s[4:7],s56 offen
s_add_u32 s56,s56,8192
buffer_load_dword v37,v4,s[4:7],s56 offen
s_add_u32 s56,s56,8192
buffer_load_dword v38,v4,s[4:7],s56 offen
s_add_u32 s56,s56,8192
buffer_load_dword v39,v4,s[4:7],s56 offen
s_waitcnt vmcnt(48)
v_perm_b32 v80,v41,v40,s61
v_perm_b32 v81,v43,v42,s61
v_perm_b32 v82,v45,v44,s61
v_perm_b32 v83,v47,v46,s61
v_perm_b32 v84,v41,v40,s62
v_perm_b32 v85,v43,v42,s62
v_perm_b32 v86,v45,v44,s62
v_perm_b32 v87,v47,v46,s62
v_accvgpr_write_b32 a196,v80
v_accvgpr_write_b32 a197,v81
v_accvgpr_write_b32 a198,v82
v_accvgpr_write_b32 a199,v83
v_accvgpr_write_b32 a204,v84
v_accvgpr_write_b32 a205,v85
v_accvgpr_write_b32 a206,v86
v_accvgpr_write_b32 a207,v87
s_mov_b32 s4,s24
s_mov_b32 s5,s25
s_mov_b32 s6,4194304
s_mov_b32 s7,0x20000
s_xor_b32 s56,s63,0
s_add_u32 s56,s56,s58
buffer_load_dword v40,v4,s[4:7],s56 offen
s_add_u32 s56,s56,8192
buffer_load_dword v41,v4,s[4:7],s56 offen
s_add_u32 s56,s56,8192
buffer_load_dword v42,v4,s[4:7],s56 offen
s_add_u32 s56,s56,8192
buffer_load_dword v43,v4,s[4:7],s56 offen
s_add_u32 s56,s56,8192
buffer_load_dword v44,v4,s[4:7],s56 offen
s_add_u32 s56,s56,8192
buffer_load_dword v45,v4,s[4:7],s56 offen
s_add_u32 s56,s56,8192
buffer_load_dword v46,v4,s[4:7],s56 offen
s_add_u32 s56,s56,8192
buffer_load_dword v47,v4,s[4:7],s56 offen
s_waitcnt vmcnt(48)
v_perm_b32 v80,v49,v48,s61
v_perm_b32 v81,v51,v50,s61
v_perm_b32 v82,v53,v52,s61
v_perm_b32 v83,v55,v54,s61
v_perm_b32 v84,v49,v48,s62
v_perm_b32 v85,v51,v50,s62
v_perm_b32 v86,v53,v52,s62
v_perm_b32 v87,v55,v54,s62
v_accvgpr_write_b32 a208,v80
v_accvgpr_write_b32 a209,v81
v_accvgpr_write_b32 a210,v82
v_accvgpr_write_b32 a211,v83
v_accvgpr_write_b32 a216,v84
v_accvgpr_write_b32 a217,v85
v_accvgpr_write_b32 a218,v86
v_accvgpr_write_b32 a219,v87
s_xor_b32 s56,s63,262144
s_add_u32 s56,s56,s58
buffer_load_dword v48,v4,s[4:7],s56 offen
s_add_u32 s56,s56,8192
buffer_load_dword v49,v4,s[4:7],s56 offen
s_add_u32 s56,s56,8192
buffer_load_dword v50,v4,s[4:7],s56 offen
s_add_u32 s56,s56,8192
buffer_load_dword v51,v4,s[4:7],s56 offen
s_add_u32 s56,s56,8192
buffer_load_dword v52,v4,s[4:7],s56 offen
s_add_u32 s56,s56,8192
buffer_load_dword v53,v4,s[4:7],s56 offen
s_add_u32 s56,s56,8192
buffer_load_dword v54,v4,s[4:7],s56 offen
s_add_u32 s56,s56,8192
buffer_load_dword v55,v4,s[4:7],s56 offen
s_waitcnt vmcnt(48)
v_perm_b32 v80,v57,v56,s61
v_perm_b32 v81,v59,v58,s61
v_perm_b32 v82,v61,v60,s61
v_perm_b32 v83,v63,v62,s61
v_perm_b32 v84,v57,v56,s62
v_perm_b32 v85,v59,v58,s62
v_perm_b32 v86,v61,v60,s62
v_perm_b32 v87,v63,v62,s62
v_accvgpr_write_b32 a212,v80
v_accvgpr_write_b32 a213,v81
v_accvgpr_write_b32 a214,v82
v_accvgpr_write_b32 a215,v83
v_accvgpr_write_b32 a220,v84
v_accvgpr_write_b32 a221,v85
v_accvgpr_write_b32 a222,v86
v_accvgpr_write_b32 a223,v87
s_xor_b32 s56,s63,524288
s_add_u32 s56,s56,s58
buffer_load_dword v56,v4,s[4:7],s56 offen
s_add_u32 s56,s56,8192
buffer_load_dword v57,v4,s[4:7],s56 offen
s_add_u32 s56,s56,8192
buffer_load_dword v58,v4,s[4:7],s56 offen
s_add_u32 s56,s56,8192
buffer_load_dword v59,v4,s[4:7],s56 offen
s_add_u32 s56,s56,8192
buffer_load_dword v60,v4,s[4:7],s56 offen
s_add_u32 s56,s56,8192
buffer_load_dword v61,v4,s[4:7],s56 offen
s_add_u32 s56,s56,8192
buffer_load_dword v62,v4,s[4:7],s56 offen
s_add_u32 s56,s56,8192
buffer_load_dword v63,v4,s[4:7],s56 offen
s_waitcnt vmcnt(48)
v_perm_b32 v80,v65,v64,s61
v_perm_b32 v81,v67,v66,s61
v_perm_b32 v82,v69,v68,s61
v_perm_b32 v83,v71,v70,s61
v_perm_b32 v84,v65,v64,s62
v_perm_b32 v85,v67,v66,s62
v_perm_b32 v86,v69,v68,s62
v_perm_b32 v87,v71,v70,s62
v_accvgpr_write_b32 a224,v80
v_accvgpr_write_b32 a225,v81
v_accvgpr_write_b32 a226,v82
v_accvgpr_write_b32 a227,v83
v_accvgpr_write_b32 a232,v84
v_accvgpr_write_b32 a233,v85
v_accvgpr_write_b32 a234,v86
v_accvgpr_write_b32 a235,v87
s_xor_b32 s56,s63,786432
s_add_u32 s56,s56,s58
buffer_load_dword v64,v4,s[4:7],s56 offen
s_add_u32 s56,s56,8192
buffer_load_dword v65,v4,s[4:7],s56 offen
s_add_u32 s56,s56,8192
buffer_load_dword v66,v4,s[4:7],s56 offen
s_add_u32 s56,s56,8192
buffer_load_dword v67,v4,s[4:7],s56 offen
s_add_u32 s56,s56,8192
buffer_load_dword v68,v4,s[4:7],s56 offen
s_add_u32 s56,s56,8192
buffer_load_dword v69,v4,s[4:7],s56 offen
s_add_u32 s56,s56,8192
buffer_load_dword v70,v4,s[4:7],s56 offen
s_add_u32 s56,s56,8192
buffer_load_dword v71,v4,s[4:7],s56 offen
s_waitcnt vmcnt(48)
v_perm_b32 v80,v73,v72,s61
v_perm_b32 v81,v75,v74,s61
v_perm_b32 v82,v77,v76,s61
v_perm_b32 v83,v79,v78,s61
v_perm_b32 v84,v73,v72,s62
v_perm_b32 v85,v75,v74,s62
v_perm_b32 v86,v77,v76,s62
v_perm_b32 v87,v79,v78,s62
v_accvgpr_write_b32 a228,v80
v_accvgpr_write_b32 a229,v81
v_accvgpr_write_b32 a230,v82
v_accvgpr_write_b32 a231,v83
v_accvgpr_write_b32 a236,v84
v_accvgpr_write_b32 a237,v85
v_accvgpr_write_b32 a238,v86
v_accvgpr_write_b32 a239,v87
s_xor_b32 s56,s63,1048576
s_add_u32 s56,s56,s58
buffer_load_dword v72,v4,s[4:7],s56 offen
s_add_u32 s56,s56,8192
buffer_load_dword v73,v4,s[4:7],s56 offen
s_add_u32 s56,s56,8192
buffer_load_dword v74,v4,s[4:7],s56 offen
s_add_u32 s56,s56,8192
buffer_load_dword v75,v4,s[4:7],s56 offen
s_add_u32 s56,s56,8192
buffer_load_dword v76,v4,s[4:7],s56 offen
s_add_u32 s56,s56,8192
buffer_load_dword v77,v4,s[4:7],s56 offen
s_add_u32 s56,s56,8192
buffer_load_dword v78,v4,s[4:7],s56 offen
s_add_u32 s56,s56,8192
buffer_load_dword v79,v4,s[4:7],s56 offen
s_waitcnt vmcnt(48)
v_perm_b32 v80,v25,v24,s61
v_perm_b32 v81,v27,v26,s61
v_perm_b32 v82,v29,v28,s61
v_perm_b32 v83,v31,v30,s61
v_perm_b32 v84,v25,v24,s62
v_perm_b32 v85,v27,v26,s62
v_perm_b32 v86,v29,v28,s62
v_perm_b32 v87,v31,v30,s62
v_accvgpr_write_b32 a240,v80
v_accvgpr_write_b32 a241,v81
v_accvgpr_write_b32 a242,v82
v_accvgpr_write_b32 a243,v83
v_accvgpr_write_b32 a248,v84
v_accvgpr_write_b32 a249,v85
v_accvgpr_write_b32 a250,v86
v_accvgpr_write_b32 a251,v87
s_xor_b32 s56,s63,1310720
s_add_u32 s56,s56,s58
buffer_load_dword v24,v4,s[4:7],s56 offen
s_add_u32 s56,s56,8192
buffer_load_dword v25,v4,s[4:7],s56 offen
s_add_u32 s56,s56,8192
buffer_load_dword v26,v4,s[4:7],s56 offen
s_add_u32 s56,s56,8192
buffer_load_dword v27,v4,s[4:7],s56 offen
s_add_u32 s56,s56,8192
buffer_load_dword v28,v4,s[4:7],s56 offen
s_add_u32 s56,s56,8192
buffer_load_dword v29,v4,s[4:7],s56 offen
s_add_u32 s56,s56,8192
buffer_load_dword v30,v4,s[4:7],s56 offen
s_add_u32 s56,s56,8192
buffer_load_dword v31,v4,s[4:7],s56 offen
s_waitcnt vmcnt(48)
v_perm_b32 v80,v33,v32,s61
v_perm_b32 v81,v35,v34,s61
v_perm_b32 v82,v37,v36,s61
v_perm_b32 v83,v39,v38,s61
v_perm_b32 v84,v33,v32,s62
v_perm_b32 v85,v35,v34,s62
v_perm_b32 v86,v37,v36,s62
v_perm_b32 v87,v39,v38,s62
v_accvgpr_write_b32 a244,v80
v_accvgpr_write_b32 a245,v81
v_accvgpr_write_b32 a246,v82
v_accvgpr_write_b32 a247,v83
v_accvgpr_write_b32 a252,v84
v_accvgpr_write_b32 a253,v85
v_accvgpr_write_b32 a254,v86
v_accvgpr_write_b32 a255,v87
s_xor_b32 s56,s63,1572864
s_add_u32 s56,s56,s58
buffer_load_dword v32,v4,s[4:7],s56 offen
s_add_u32 s56,s56,8192
buffer_load_dword v33,v4,s[4:7],s56 offen
s_add_u32 s56,s56,8192
buffer_load_dword v34,v4,s[4:7],s56 offen
s_add_u32 s56,s56,8192
buffer_load_dword v35,v4,s[4:7],s56 offen
s_add_u32 s56,s56,8192
buffer_load_dword v36,v4,s[4:7],s56 offen
s_add_u32 s56,s56,8192
buffer_load_dword v37,v4,s[4:7],s56 offen
s_add_u32 s56,s56,8192
buffer_load_dword v38,v4,s[4:7],s56 offen
s_add_u32 s56,s56,8192
buffer_load_dword v39,v4,s[4:7],s56 offen
s_waitcnt vmcnt(48)
v_perm_b32 v128,v41,v40,s61
v_perm_b32 v129,v43,v42,s61
v_perm_b32 v130,v45,v44,s61
v_perm_b32 v131,v47,v46,s61
v_perm_b32 v136,v41,v40,s62
v_perm_b32 v137,v43,v42,s62
v_perm_b32 v138,v45,v44,s62
v_perm_b32 v139,v47,v46,s62
s_xor_b32 s56,s63,1835008
s_add_u32 s56,s56,s58
buffer_load_dword v40,v4,s[4:7],s56 offen
s_add_u32 s56,s56,8192
buffer_load_dword v41,v4,s[4:7],s56 offen
s_add_u32 s56,s56,8192
buffer_load_dword v42,v4,s[4:7],s56 offen
s_add_u32 s56,s56,8192
buffer_load_dword v43,v4,s[4:7],s56 offen
s_add_u32 s56,s56,8192
buffer_load_dword v44,v4,s[4:7],s56 offen
s_add_u32 s56,s56,8192
buffer_load_dword v45,v4,s[4:7],s56 offen
s_add_u32 s56,s56,8192
buffer_load_dword v46,v4,s[4:7],s56 offen
s_add_u32 s56,s56,8192
buffer_load_dword v47,v4,s[4:7],s56 offen
s_waitcnt vmcnt(48)
v_perm_b32 v132,v49,v48,s61
v_perm_b32 v133,v51,v50,s61
v_perm_b32 v134,v53,v52,s61
v_perm_b32 v135,v55,v54,s61
v_perm_b32 v140,v49,v48,s62
v_perm_b32 v141,v51,v50,s62
v_perm_b32 v142,v53,v52,s62
v_perm_b32 v143,v55,v54,s62
s_xor_b32 s56,s63,2097152
s_add_u32 s56,s56,s58
buffer_load_dword v48,v4,s[4:7],s56 offen
s_add_u32 s56,s56,8192
buffer_load_dword v49,v4,s[4:7],s56 offen
s_add_u32 s56,s56,8192
buffer_load_dword v50,v4,s[4:7],s56 offen
s_add_u32 s56,s56,8192
buffer_load_dword v51,v4,s[4:7],s56 offen
s_add_u32 s56,s56,8192
buffer_load_dword v52,v4,s[4:7],s56 offen
s_add_u32 s56,s56,8192
buffer_load_dword v53,v4,s[4:7],s56 offen
s_add_u32 s56,s56,8192
buffer_load_dword v54,v4,s[4:7],s56 offen
s_add_u32 s56,s56,8192
buffer_load_dword v55,v4,s[4:7],s56 offen
s_waitcnt vmcnt(48)
v_perm_b32 v144,v57,v56,s61
v_perm_b32 v145,v59,v58,s61
v_perm_b32 v146,v61,v60,s61
v_perm_b32 v147,v63,v62,s61
v_perm_b32 v152,v57,v56,s62
v_perm_b32 v153,v59,v58,s62
v_perm_b32 v154,v61,v60,s62
v_perm_b32 v155,v63,v62,s62
s_xor_b32 s56,s63,2359296
s_add_u32 s56,s56,s58
buffer_load_dword v56,v4,s[4:7],s56 offen
s_add_u32 s56,s56,8192
buffer_load_dword v57,v4,s[4:7],s56 offen
s_add_u32 s56,s56,8192
buffer_load_dword v58,v4,s[4:7],s56 offen
s_add_u32 s56,s56,8192
buffer_load_dword v59,v4,s[4:7],s56 offen
s_add_u32 s56,s56,8192
buffer_load_dword v60,v4,s[4:7],s56 offen
s_add_u32 s56,s56,8192
buffer_load_dword v61,v4,s[4:7],s56 offen
s_add_u32 s56,s56,8192
buffer_load_dword v62,v4,s[4:7],s56 offen
s_add_u32 s56,s56,8192
buffer_load_dword v63,v4,s[4:7],s56 offen
s_waitcnt vmcnt(48)
v_perm_b32 v148,v65,v64,s61
v_perm_b32 v149,v67,v66,s61
v_perm_b32 v150,v69,v68,s61
v_perm_b32 v151,v71,v70,s61
v_perm_b32 v156,v65,v64,s62
v_perm_b32 v157,v67,v66,s62
v_perm_b32 v158,v69,v68,s62
v_perm_b32 v159,v71,v70,s62
s_xor_b32 s56,s63,2621440
s_add_u32 s56,s56,s58
buffer_load_dword v64,v4,s[4:7],s56 offen
s_add_u32 s56,s56,8192
buffer_load_dword v65,v4,s[4:7],s56 offen
s_add_u32 s56,s56,8192
buffer_load_dword v66,v4,s[4:7],s56 offen
s_add_u32 s56,s56,8192
buffer_load_dword v67,v4,s[4:7],s56 offen
s_add_u32 s56,s56,8192
buffer_load_dword v68,v4,s[4:7],s56 offen
s_add_u32 s56,s56,8192
buffer_load_dword v69,v4,s[4:7],s56 offen
s_add_u32 s56,s56,8192
buffer_load_dword v70,v4,s[4:7],s56 offen
s_add_u32 s56,s56,8192
buffer_load_dword v71,v4,s[4:7],s56 offen
s_waitcnt vmcnt(48)
v_perm_b32 v160,v73,v72,s61
v_perm_b32 v161,v75,v74,s61
v_perm_b32 v162,v77,v76,s61
v_perm_b32 v163,v79,v78,s61
v_perm_b32 v168,v73,v72,s62
v_perm_b32 v169,v75,v74,s62
v_perm_b32 v170,v77,v76,s62
v_perm_b32 v171,v79,v78,s62
s_xor_b32 s56,s63,2883584
s_add_u32 s56,s56,s58
buffer_load_dword v72,v4,s[4:7],s56 offen
s_add_u32 s56,s56,8192
buffer_load_dword v73,v4,s[4:7],s56 offen
s_add_u32 s56,s56,8192
buffer_load_dword v74,v4,s[4:7],s56 offen
s_add_u32 s56,s56,8192
buffer_load_dword v75,v4,s[4:7],s56 offen
s_add_u32 s56,s56,8192
buffer_load_dword v76,v4,s[4:7],s56 offen
s_add_u32 s56,s56,8192
buffer_load_dword v77,v4,s[4:7],s56 offen
s_add_u32 s56,s56,8192
buffer_load_dword v78,v4,s[4:7],s56 offen
s_add_u32 s56,s56,8192
buffer_load_dword v79,v4,s[4:7],s56 offen
s_waitcnt vmcnt(48)
v_perm_b32 v164,v25,v24,s61
v_perm_b32 v165,v27,v26,s61
v_perm_b32 v166,v29,v28,s61
v_perm_b32 v167,v31,v30,s61
v_perm_b32 v172,v25,v24,s62
v_perm_b32 v173,v27,v26,s62
v_perm_b32 v174,v29,v28,s62
v_perm_b32 v175,v31,v30,s62
s_xor_b32 s56,s63,3145728
s_add_u32 s56,s56,s58
buffer_load_dword v24,v4,s[4:7],s56 offen
s_add_u32 s56,s56,8192
buffer_load_dword v25,v4,s[4:7],s56 offen
s_add_u32 s56,s56,8192
buffer_load_dword v26,v4,s[4:7],s56 offen
s_add_u32 s56,s56,8192
buffer_load_dword v27,v4,s[4:7],s56 offen
s_add_u32 s56,s56,8192
buffer_load_dword v28,v4,s[4:7],s56 offen
s_add_u32 s56,s56,8192
buffer_load_dword v29,v4,s[4:7],s56 offen
s_add_u32 s56,s56,8192
buffer_load_dword v30,v4,s[4:7],s56 offen
s_add_u32 s56,s56,8192
buffer_load_dword v31,v4,s[4:7],s56 offen
s_waitcnt vmcnt(48)
v_perm_b32 v176,v33,v32,s61
v_perm_b32 v177,v35,v34,s61
v_perm_b32 v178,v37,v36,s61
v_perm_b32 v179,v39,v38,s61
v_perm_b32 v184,v33,v32,s62
v_perm_b32 v185,v35,v34,s62
v_perm_b32 v186,v37,v36,s62
v_perm_b32 v187,v39,v38,s62
s_xor_b32 s56,s63,3407872
s_add_u32 s56,s56,s58
buffer_load_dword v32,v4,s[4:7],s56 offen
s_add_u32 s56,s56,8192
buffer_load_dword v33,v4,s[4:7],s56 offen
s_add_u32 s56,s56,8192
buffer_load_dword v34,v4,s[4:7],s56 offen
s_add_u32 s56,s56,8192
buffer_load_dword v35,v4,s[4:7],s56 offen
s_add_u32 s56,s56,8192
buffer_load_dword v36,v4,s[4:7],s56 offen
s_add_u32 s56,s56,8192
buffer_load_dword v37,v4,s[4:7],s56 offen
s_add_u32 s56,s56,8192
buffer_load_dword v38,v4,s[4:7],s56 offen
s_add_u32 s56,s56,8192
buffer_load_dword v39,v4,s[4:7],s56 offen
s_waitcnt vmcnt(48)
v_perm_b32 v180,v41,v40,s61
v_perm_b32 v181,v43,v42,s61
v_perm_b32 v182,v45,v44,s61
v_perm_b32 v183,v47,v46,s61
v_perm_b32 v188,v41,v40,s62
v_perm_b32 v189,v43,v42,s62
v_perm_b32 v190,v45,v44,s62
v_perm_b32 v191,v47,v46,s62
s_xor_b32 s56,s63,3670016
s_add_u32 s56,s56,s58
buffer_load_dword v40,v4,s[4:7],s56 offen
s_add_u32 s56,s56,8192
buffer_load_dword v41,v4,s[4:7],s56 offen
s_add_u32 s56,s56,8192
buffer_load_dword v42,v4,s[4:7],s56 offen
s_add_u32 s56,s56,8192
buffer_load_dword v43,v4,s[4:7],s56 offen
s_add_u32 s56,s56,8192
buffer_load_dword v44,v4,s[4:7],s56 offen
s_add_u32 s56,s56,8192
buffer_load_dword v45,v4,s[4:7],s56 offen
s_add_u32 s56,s56,8192
buffer_load_dword v46,v4,s[4:7],s56 offen
s_add_u32 s56,s56,8192
buffer_load_dword v47,v4,s[4:7],s56 offen
s_waitcnt vmcnt(48)
v_perm_b32 v192,v49,v48,s61
v_perm_b32 v193,v51,v50,s61
v_perm_b32 v194,v53,v52,s61
v_perm_b32 v195,v55,v54,s61
v_perm_b32 v200,v49,v48,s62
v_perm_b32 v201,v51,v50,s62
v_perm_b32 v202,v53,v52,s62
v_perm_b32 v203,v55,v54,s62
s_xor_b32 s56,s63,3932160
s_add_u32 s56,s56,s58
buffer_load_dword v48,v4,s[4:7],s56 offen
s_add_u32 s56,s56,8192
buffer_load_dword v49,v4,s[4:7],s56 offen
s_add_u32 s56,s56,8192
buffer_load_dword v50,v4,s[4:7],s56 offen
s_add_u32 s56,s56,8192
buffer_load_dword v51,v4,s[4:7],s56 offen
s_add_u32 s56,s56,8192
buffer_load_dword v52,v4,s[4:7],s56 offen
s_add_u32 s56,s56,8192
buffer_load_dword v53,v4,s[4:7],s56 offen
s_add_u32 s56,s56,8192
buffer_load_dword v54,v4,s[4:7],s56 offen
s_add_u32 s56,s56,8192
buffer_load_dword v55,v4,s[4:7],s56 offen
s_waitcnt vmcnt(48)
v_perm_b32 v196,v57,v56,s61
v_perm_b32 v197,v59,v58,s61
v_perm_b32 v198,v61,v60,s61
v_perm_b32 v199,v63,v62,s61
v_perm_b32 v204,v57,v56,s62
v_perm_b32 v205,v59,v58,s62
v_perm_b32 v206,v61,v60,s62
v_perm_b32 v207,v63,v62,s62
s_mov_b32 s4,s20
s_mov_b32 s5,s21
s_mov_b32 s6,4194304
s_mov_b32 s7,0x20000
s_xor_b32 s56,s63,0
s_add_u32 s56,s56,s58
buffer_load_dword v56,v4,s[4:7],s56 offen
s_add_u32 s56,s56,8192
buffer_load_dword v57,v4,s[4:7],s56 offen
s_add_u32 s56,s56,8192
buffer_load_dword v58,v4,s[4:7],s56 offen
s_add_u32 s56,s56,8192
buffer_load_dword v59,v4,s[4:7],s56 offen
s_add_u32 s56,s56,8192
buffer_load_dword v60,v4,s[4:7],s56 offen
s_add_u32 s56,s56,8192
buffer_load_dword v61,v4,s[4:7],s56 offen
s_add_u32 s56,s56,8192
buffer_load_dword v62,v4,s[4:7],s56 offen
s_add_u32 s56,s56,8192
buffer_load_dword v63,v4,s[4:7],s56 offen
s_waitcnt vmcnt(48)
v_perm_b32 v208,v65,v64,s61
v_perm_b32 v209,v67,v66,s61
v_perm_b32 v210,v69,v68,s61
v_perm_b32 v211,v71,v70,s61
v_perm_b32 v216,v65,v64,s62
v_perm_b32 v217,v67,v66,s62
v_perm_b32 v218,v69,v68,s62
v_perm_b32 v219,v71,v70,s62
s_xor_b32 s56,s63,262144
s_add_u32 s56,s56,s58
buffer_load_dword v64,v4,s[4:7],s56 offen
s_add_u32 s56,s56,8192
buffer_load_dword v65,v4,s[4:7],s56 offen
s_add_u32 s56,s56,8192
buffer_load_dword v66,v4,s[4:7],s56 offen
s_add_u32 s56,s56,8192
buffer_load_dword v67,v4,s[4:7],s56 offen
s_add_u32 s56,s56,8192
buffer_load_dword v68,v4,s[4:7],s56 offen
s_add_u32 s56,s56,8192
buffer_load_dword v69,v4,s[4:7],s56 offen
s_add_u32 s56,s56,8192
buffer_load_dword v70,v4,s[4:7],s56 offen
s_add_u32 s56,s56,8192
buffer_load_dword v71,v4,s[4:7],s56 offen
s_waitcnt vmcnt(48)
v_perm_b32 v212,v73,v72,s61
v_perm_b32 v213,v75,v74,s61
v_perm_b32 v214,v77,v76,s61
v_perm_b32 v215,v79,v78,s61
v_perm_b32 v220,v73,v72,s62
v_perm_b32 v221,v75,v74,s62
v_perm_b32 v222,v77,v76,s62
v_perm_b32 v223,v79,v78,s62
s_xor_b32 s56,s63,524288
s_add_u32 s56,s56,s58
buffer_load_dword v72,v4,s[4:7],s56 offen
s_add_u32 s56,s56,8192
buffer_load_dword v73,v4,s[4:7],s56 offen
s_add_u32 s56,s56,8192
buffer_load_dword v74,v4,s[4:7],s56 offen
s_add_u32 s56,s56,8192
buffer_load_dword v75,v4,s[4:7],s56 offen
s_add_u32 s56,s56,8192
buffer_load_dword v76,v4,s[4:7],s56 offen
s_add_u32 s56,s56,8192
buffer_load_dword v77,v4,s[4:7],s56 offen
s_add_u32 s56,s56,8192
buffer_load_dword v78,v4,s[4:7],s56 offen
s_add_u32 s56,s56,8192
buffer_load_dword v79,v4,s[4:7],s56 offen
s_waitcnt vmcnt(48)
v_perm_b32 v224,v25,v24,s61
v_perm_b32 v225,v27,v26,s61
v_perm_b32 v226,v29,v28,s61
v_perm_b32 v227,v31,v30,s61
v_perm_b32 v232,v25,v24,s62
v_perm_b32 v233,v27,v26,s62
v_perm_b32 v234,v29,v28,s62
v_perm_b32 v235,v31,v30,s62
s_xor_b32 s56,s63,786432
s_add_u32 s56,s56,s58
buffer_load_dword v24,v4,s[4:7],s56 offen
s_add_u32 s56,s56,8192
buffer_load_dword v25,v4,s[4:7],s56 offen
s_add_u32 s56,s56,8192
buffer_load_dword v26,v4,s[4:7],s56 offen
s_add_u32 s56,s56,8192
buffer_load_dword v27,v4,s[4:7],s56 offen
s_add_u32 s56,s56,8192
buffer_load_dword v28,v4,s[4:7],s56 offen
s_add_u32 s56,s56,8192
buffer_load_dword v29,v4,s[4:7],s56 offen
s_add_u32 s56,s56,8192
buffer_load_dword v30,v4,s[4:7],s56 offen
s_add_u32 s56,s56,8192
buffer_load_dword v31,v4,s[4:7],s56 offen
s_waitcnt vmcnt(48)
v_perm_b32 v228,v33,v32,s61
v_perm_b32 v229,v35,v34,s61
v_perm_b32 v230,v37,v36,s61
v_perm_b32 v231,v39,v38,s61
v_perm_b32 v236,v33,v32,s62
v_perm_b32 v237,v35,v34,s62
v_perm_b32 v238,v37,v36,s62
v_perm_b32 v239,v39,v38,s62
s_xor_b32 s56,s63,1048576
s_add_u32 s56,s56,s58
buffer_load_dword v32,v4,s[4:7],s56 offen
s_add_u32 s56,s56,8192
buffer_load_dword v33,v4,s[4:7],s56 offen
s_add_u32 s56,s56,8192
buffer_load_dword v34,v4,s[4:7],s56 offen
s_add_u32 s56,s56,8192
buffer_load_dword v35,v4,s[4:7],s56 offen
s_add_u32 s56,s56,8192
buffer_load_dword v36,v4,s[4:7],s56 offen
s_add_u32 s56,s56,8192
buffer_load_dword v37,v4,s[4:7],s56 offen
s_add_u32 s56,s56,8192
buffer_load_dword v38,v4,s[4:7],s56 offen
s_add_u32 s56,s56,8192
buffer_load_dword v39,v4,s[4:7],s56 offen
s_waitcnt vmcnt(48)
v_perm_b32 v240,v41,v40,s61
v_perm_b32 v241,v43,v42,s61
v_perm_b32 v242,v45,v44,s61
v_perm_b32 v243,v47,v46,s61
v_perm_b32 v248,v41,v40,s62
v_perm_b32 v249,v43,v42,s62
v_perm_b32 v250,v45,v44,s62
v_perm_b32 v251,v47,v46,s62
s_xor_b32 s56,s63,1310720
s_add_u32 s56,s56,s58
buffer_load_dword v40,v4,s[4:7],s56 offen
s_add_u32 s56,s56,8192
buffer_load_dword v41,v4,s[4:7],s56 offen
s_add_u32 s56,s56,8192
buffer_load_dword v42,v4,s[4:7],s56 offen
s_add_u32 s56,s56,8192
buffer_load_dword v43,v4,s[4:7],s56 offen
s_add_u32 s56,s56,8192
buffer_load_dword v44,v4,s[4:7],s56 offen
s_add_u32 s56,s56,8192
buffer_load_dword v45,v4,s[4:7],s56 offen
s_add_u32 s56,s56,8192
buffer_load_dword v46,v4,s[4:7],s56 offen
s_add_u32 s56,s56,8192
buffer_load_dword v47,v4,s[4:7],s56 offen
s_waitcnt vmcnt(48)
v_perm_b32 v244,v49,v48,s61
v_perm_b32 v245,v51,v50,s61
v_perm_b32 v246,v53,v52,s61
v_perm_b32 v247,v55,v54,s61
v_perm_b32 v252,v49,v48,s62
v_perm_b32 v253,v51,v50,s62
v_perm_b32 v254,v53,v52,s62
v_perm_b32 v255,v55,v54,s62
s_xor_b32 s56,s63,1572864
s_add_u32 s56,s56,s58
buffer_load_dword v48,v4,s[4:7],s56 offen
s_add_u32 s56,s56,8192
buffer_load_dword v49,v4,s[4:7],s56 offen
s_add_u32 s56,s56,8192
buffer_load_dword v50,v4,s[4:7],s56 offen
s_add_u32 s56,s56,8192
buffer_load_dword v51,v4,s[4:7],s56 offen
s_add_u32 s56,s56,8192
buffer_load_dword v52,v4,s[4:7],s56 offen
s_add_u32 s56,s56,8192
buffer_load_dword v53,v4,s[4:7],s56 offen
s_add_u32 s56,s56,8192
buffer_load_dword v54,v4,s[4:7],s56 offen
s_add_u32 s56,s56,8192
buffer_load_dword v55,v4,s[4:7],s56 offen
s_waitcnt vmcnt(48)
v_perm_b32 v80,v57,v56,s61
v_perm_b32 v81,v59,v58,s61
v_perm_b32 v82,v61,v60,s61
v_perm_b32 v83,v63,v62,s61
v_perm_b32 v84,v57,v56,s62
v_perm_b32 v85,v59,v58,s62
v_perm_b32 v86,v61,v60,s62
v_perm_b32 v87,v63,v62,s62
v_accvgpr_write_b32 a0,v80
v_accvgpr_write_b32 a1,v81
v_accvgpr_write_b32 a2,v82
v_accvgpr_write_b32 a3,v83
v_accvgpr_write_b32 a8,v84
v_accvgpr_write_b32 a9,v85
v_accvgpr_write_b32 a10,v86
v_accvgpr_write_b32 a11,v87
s_xor_b32 s56,s63,1835008
s_add_u32 s56,s56,s58
buffer_load_dword v56,v4,s[4:7],s56 offen
s_add_u32 s56,s56,8192
buffer_load_dword v57,v4,s[4:7],s56 offen
s_add_u32 s56,s56,8192
buffer_load_dword v58,v4,s[4:7],s56 offen
s_add_u32 s56,s56,8192
buffer_load_dword v59,v4,s[4:7],s56 offen
s_add_u32 s56,s56,8192
buffer_load_dword v60,v4,s[4:7],s56 offen
s_add_u32 s56,s56,8192
buffer_load_dword v61,v4,s[4:7],s56 offen
s_add_u32 s56,s56,8192
buffer_load_dword v62,v4,s[4:7],s56 offen
s_add_u32 s56,s56,8192
buffer_load_dword v63,v4,s[4:7],s56 offen
s_waitcnt vmcnt(48)
v_perm_b32 v80,v65,v64,s61
v_perm_b32 v81,v67,v66,s61
v_perm_b32 v82,v69,v68,s61
v_perm_b32 v83,v71,v70,s61
v_perm_b32 v84,v65,v64,s62
v_perm_b32 v85,v67,v66,s62
v_perm_b32 v86,v69,v68,s62
v_perm_b32 v87,v71,v70,s62
v_accvgpr_write_b32 a4,v80
v_accvgpr_write_b32 a5,v81
v_accvgpr_write_b32 a6,v82
v_accvgpr_write_b32 a7,v83
v_accvgpr_write_b32 a12,v84
v_accvgpr_write_b32 a13,v85
v_accvgpr_write_b32 a14,v86
v_accvgpr_write_b32 a15,v87
s_xor_b32 s56,s63,2097152
s_add_u32 s56,s56,s58
buffer_load_dword v64,v4,s[4:7],s56 offen
s_add_u32 s56,s56,8192
buffer_load_dword v65,v4,s[4:7],s56 offen
s_add_u32 s56,s56,8192
buffer_load_dword v66,v4,s[4:7],s56 offen
s_add_u32 s56,s56,8192
buffer_load_dword v67,v4,s[4:7],s56 offen
s_add_u32 s56,s56,8192
buffer_load_dword v68,v4,s[4:7],s56 offen
s_add_u32 s56,s56,8192
buffer_load_dword v69,v4,s[4:7],s56 offen
s_add_u32 s56,s56,8192
buffer_load_dword v70,v4,s[4:7],s56 offen
s_add_u32 s56,s56,8192
buffer_load_dword v71,v4,s[4:7],s56 offen
s_waitcnt vmcnt(48)
v_perm_b32 v80,v73,v72,s61
v_perm_b32 v81,v75,v74,s61
v_perm_b32 v82,v77,v76,s61
v_perm_b32 v83,v79,v78,s61
v_perm_b32 v84,v73,v72,s62
v_perm_b32 v85,v75,v74,s62
v_perm_b32 v86,v77,v76,s62
v_perm_b32 v87,v79,v78,s62
v_accvgpr_write_b32 a16,v80
v_accvgpr_write_b32 a17,v81
v_accvgpr_write_b32 a18,v82
v_accvgpr_write_b32 a19,v83
v_accvgpr_write_b32 a24,v84
v_accvgpr_write_b32 a25,v85
v_accvgpr_write_b32 a26,v86
v_accvgpr_write_b32 a27,v87
s_xor_b32 s56,s63,2359296
s_add_u32 s56,s56,s58
buffer_load_dword v72,v4,s[4:7],s56 offen
s_add_u32 s56,s56,8192
buffer_load_dword v73,v4,s[4:7],s56 offen
s_add_u32 s56,s56,8192
buffer_load_dword v74,v4,s[4:7],s56 offen
s_add_u32 s56,s56,8192
buffer_load_dword v75,v4,s[4:7],s56 offen
s_add_u32 s56,s56,8192
buffer_load_dword v76,v4,s[4:7],s56 offen
s_add_u32 s56,s56,8192
buffer_load_dword v77,v4,s[4:7],s56 offen
s_add_u32 s56,s56,8192
buffer_load_dword v78,v4,s[4:7],s56 offen
s_add_u32 s56,s56,8192
buffer_load_dword v79,v4,s[4:7],s56 offen
s_waitcnt vmcnt(48)
v_perm_b32 v80,v25,v24,s61
v_perm_b32 v81,v27,v26,s61
v_perm_b32 v82,v29,v28,s61
v_perm_b32 v83,v31,v30,s61
v_perm_b32 v84,v25,v24,s62
v_perm_b32 v85,v27,v26,s62
v_perm_b32 v86,v29,v28,s62
v_perm_b32 v87,v31,v30,s62
v_accvgpr_write_b32 a20,v80
v_accvgpr_write_b32 a21,v81
v_accvgpr_write_b32 a22,v82
v_accvgpr_write_b32 a23,v83
v_accvgpr_write_b32 a28,v84
v_accvgpr_write_b32 a29,v85
v_accvgpr_write_b32 a30,v86
v_accvgpr_write_b32 a31,v87
s_xor_b32 s56,s63,2621440
s_add_u32 s56,s56,s58
buffer_load_dword v24,v4,s[4:7],s56 offen
s_add_u32 s56,s56,8192
buffer_load_dword v25,v4,s[4:7],s56 offen
s_add_u32 s56,s56,8192
buffer_load_dword v26,v4,s[4:7],s56 offen
s_add_u32 s56,s56,8192
buffer_load_dword v27,v4,s[4:7],s56 offen
s_add_u32 s56,s56,8192
buffer_load_dword v28,v4,s[4:7],s56 offen
s_add_u32 s56,s56,8192
buffer_load_dword v29,v4,s[4:7],s56 offen
s_add_u32 s56,s56,8192
buffer_load_dword v30,v4,s[4:7],s56 offen
s_add_u32 s56,s56,8192
buffer_load_dword v31,v4,s[4:7],s56 offen
s_waitcnt vmcnt(48)
v_perm_b32 v80,v33,v32,s61
v_perm_b32 v81,v35,v34,s61
v_perm_b32 v82,v37,v36,s61
v_perm_b32 v83,v39,v38,s61
v_perm_b32 v84,v33,v32,s62
v_perm_b32 v85,v35,v34,s62
v_perm_b32 v86,v37,v36,s62
v_perm_b32 v87,v39,v38,s62
v_accvgpr_write_b32 a32,v80
v_accvgpr_write_b32 a33,v81
v_accvgpr_write_b32 a34,v82
v_accvgpr_write_b32 a35,v83
v_accvgpr_write_b32 a40,v84
v_accvgpr_write_b32 a41,v85
v_accvgpr_write_b32 a42,v86
v_accvgpr_write_b32 a43,v87
s_xor_b32 s56,s63,2883584
s_add_u32 s56,s56,s58
buffer_load_dword v32,v4,s[4:7],s56 offen
s_add_u32 s56,s56,8192
buffer_load_dword v33,v4,s[4:7],s56 offen
s_add_u32 s56,s56,8192
buffer_load_dword v34,v4,s[4:7],s56 offen
s_add_u32 s56,s56,8192
buffer_load_dword v35,v4,s[4:7],s56 offen
s_add_u32 s56,s56,8192
buffer_load_dword v36,v4,s[4:7],s56 offen
s_add_u32 s56,s56,8192
buffer_load_dword v37,v4,s[4:7],s56 offen
s_add_u32 s56,s56,8192
buffer_load_dword v38,v4,s[4:7],s56 offen
s_add_u32 s56,s56,8192
buffer_load_dword v39,v4,s[4:7],s56 offen
s_waitcnt vmcnt(48)
v_perm_b32 v80,v41,v40,s61
v_perm_b32 v81,v43,v42,s61
v_perm_b32 v82,v45,v44,s61
v_perm_b32 v83,v47,v46,s61
v_perm_b32 v84,v41,v40,s62
v_perm_b32 v85,v43,v42,s62
v_perm_b32 v86,v45,v44,s62
v_perm_b32 v87,v47,v46,s62
v_accvgpr_write_b32 a36,v80
v_accvgpr_write_b32 a37,v81
v_accvgpr_write_b32 a38,v82
v_accvgpr_write_b32 a39,v83
v_accvgpr_write_b32 a44,v84
v_accvgpr_write_b32 a45,v85
v_accvgpr_write_b32 a46,v86
v_accvgpr_write_b32 a47,v87
s_xor_b32 s56,s63,3145728
s_add_u32 s56,s56,s58
buffer_load_dword v40,v4,s[4:7],s56 offen
s_add_u32 s56,s56,8192
buffer_load_dword v41,v4,s[4:7],s56 offen
s_add_u32 s56,s56,8192
buffer_load_dword v42,v4,s[4:7],s56 offen
s_add_u32 s56,s56,8192
buffer_load_dword v43,v4,s[4:7],s56 offen
s_add_u32 s56,s56,8192
buffer_load_dword v44,v4,s[4:7],s56 offen
s_add_u32 s56,s56,8192
buffer_load_dword v45,v4,s[4:7],s56 offen
s_add_u32 s56,s56,8192
buffer_load_dword v46,v4,s[4:7],s56 offen
s_add_u32 s56,s56,8192
buffer_load_dword v47,v4,s[4:7],s56 offen
s_waitcnt vmcnt(48)
v_perm_b32 v80,v49,v48,s61
v_perm_b32 v81,v51,v50,s61
v_perm_b32 v82,v53,v52,s61
v_perm_b32 v83,v55,v54,s61
v_perm_b32 v84,v49,v48,s62
v_perm_b32 v85,v51,v50,s62
v_perm_b32 v86,v53,v52,s62
v_perm_b32 v87,v55,v54,s62
v_accvgpr_write_b32 a48,v80
v_accvgpr_write_b32 a49,v81
v_accvgpr_write_b32 a50,v82
v_accvgpr_write_b32 a51,v83
v_accvgpr_write_b32 a56,v84
v_accvgpr_write_b32 a57,v85
v_accvgpr_write_b32 a58,v86
v_accvgpr_write_b32 a59,v87
s_xor_b32 s56,s63,3407872
s_add_u32 s56,s56,s58
buffer_load_dword v48,v4,s[4:7],s56 offen
s_add_u32 s56,s56,8192
buffer_load_dword v49,v4,s[4:7],s56 offen
s_add_u32 s56,s56,8192
buffer_load_dword v50,v4,s[4:7],s56 offen
s_add_u32 s56,s56,8192
buffer_load_dword v51,v4,s[4:7],s56 offen
s_add_u32 s56,s56,8192
buffer_load_dword v52,v4,s[4:7],s56 offen
s_add_u32 s56,s56,8192
buffer_load_dword v53,v4,s[4:7],s56 offen
s_add_u32 s56,s56,8192
buffer_load_dword v54,v4,s[4:7],s56 offen
s_add_u32 s56,s56,8192
buffer_load_dword v55,v4,s[4:7],s56 offen
s_waitcnt vmcnt(48)
v_perm_b32 v80,v57,v56,s61
v_perm_b32 v81,v59,v58,s61
v_perm_b32 v82,v61,v60,s61
v_perm_b32 v83,v63,v62,s61
v_perm_b32 v84,v57,v56,s62
v_perm_b32 v85,v59,v58,s62
v_perm_b32 v86,v61,v60,s62
v_perm_b32 v87,v63,v62,s62
v_accvgpr_write_b32 a52,v80
v_accvgpr_write_b32 a53,v81
v_accvgpr_write_b32 a54,v82
v_accvgpr_write_b32 a55,v83
v_accvgpr_write_b32 a60,v84
v_accvgpr_write_b32 a61,v85
v_accvgpr_write_b32 a62,v86
v_accvgpr_write_b32 a63,v87
s_xor_b32 s56,s63,3670016
s_add_u32 s56,s56,s58
buffer_load_dword v56,v4,s[4:7],s56 offen
s_add_u32 s56,s56,8192
buffer_load_dword v57,v4,s[4:7],s56 offen
s_add_u32 s56,s56,8192
buffer_load_dword v58,v4,s[4:7],s56 offen
s_add_u32 s56,s56,8192
buffer_load_dword v59,v4,s[4:7],s56 offen
s_add_u32 s56,s56,8192
buffer_load_dword v60,v4,s[4:7],s56 offen
s_add_u32 s56,s56,8192
buffer_load_dword v61,v4,s[4:7],s56 offen
s_add_u32 s56,s56,8192
buffer_load_dword v62,v4,s[4:7],s56 offen
s_add_u32 s56,s56,8192
buffer_load_dword v63,v4,s[4:7],s56 offen
s_waitcnt vmcnt(48)
v_perm_b32 v80,v65,v64,s61
v_perm_b32 v81,v67,v66,s61
v_perm_b32 v82,v69,v68,s61
v_perm_b32 v83,v71,v70,s61
v_perm_b32 v84,v65,v64,s62
v_perm_b32 v85,v67,v66,s62
v_perm_b32 v86,v69,v68,s62
v_perm_b32 v87,v71,v70,s62
v_accvgpr_write_b32 a64,v80
v_accvgpr_write_b32 a65,v81
v_accvgpr_write_b32 a66,v82
v_accvgpr_write_b32 a67,v83
v_accvgpr_write_b32 a72,v84
v_accvgpr_write_b32 a73,v85
v_accvgpr_write_b32 a74,v86
v_accvgpr_write_b32 a75,v87
s_xor_b32 s56,s63,3932160
s_add_u32 s56,s56,s58
buffer_load_dword v64,v4,s[4:7],s56 offen
s_add_u32 s56,s56,8192
buffer_load_dword v65,v4,s[4:7],s56 offen
s_add_u32 s56,s56,8192
buffer_load_dword v66,v4,s[4:7],s56 offen
s_add_u32 s56,s56,8192
buffer_load_dword v67,v4,s[4:7],s56 offen
s_add_u32 s56,s56,8192
buffer_load_dword v68,v4,s[4:7],s56 offen
s_add_u32 s56,s56,8192
buffer_load_dword v69,v4,s[4:7],s56 offen
s_add_u32 s56,s56,8192
buffer_load_dword v70,v4,s[4:7],s56 offen
s_add_u32 s56,s56,8192
buffer_load_dword v71,v4,s[4:7],s56 offen
s_waitcnt vmcnt(48)
v_perm_b32 v80,v73,v72,s61
v_perm_b32 v81,v75,v74,s61
v_perm_b32 v82,v77,v76,s61
v_perm_b32 v83,v79,v78,s61
v_perm_b32 v84,v73,v72,s62
v_perm_b32 v85,v75,v74,s62
v_perm_b32 v86,v77,v76,s62
v_perm_b32 v87,v79,v78,s62
v_accvgpr_write_b32 a68,v80
v_accvgpr_write_b32 a69,v81
v_accvgpr_write_b32 a70,v82
v_accvgpr_write_b32 a71,v83
v_accvgpr_write_b32 a76,v84
v_accvgpr_write_b32 a77,v85
v_accvgpr_write_b32 a78,v86
v_accvgpr_write_b32 a79,v87
s_waitcnt vmcnt(40)
v_perm_b32 v80,v25,v24,s61
v_perm_b32 v81,v27,v26,s61
v_perm_b32 v82,v29,v28,s61
v_perm_b32 v83,v31,v30,s61
v_perm_b32 v84,v25,v24,s62
v_perm_b32 v85,v27,v26,s62
v_perm_b32 v86,v29,v28,s62
v_perm_b32 v87,v31,v30,s62
v_accvgpr_write_b32 a80,v80
v_accvgpr_write_b32 a81,v81
v_accvgpr_write_b32 a82,v82
v_accvgpr_write_b32 a83,v83
v_accvgpr_write_b32 a88,v84
v_accvgpr_write_b32 a89,v85
v_accvgpr_write_b32 a90,v86
v_accvgpr_write_b32 a91,v87
s_waitcnt vmcnt(32)
v_perm_b32 v80,v33,v32,s61
v_perm_b32 v81,v35,v34,s61
v_perm_b32 v82,v37,v36,s61
v_perm_b32 v83,v39,v38,s61
v_perm_b32 v84,v33,v32,s62
v_perm_b32 v85,v35,v34,s62
v_perm_b32 v86,v37,v36,s62
v_perm_b32 v87,v39,v38,s62
v_accvgpr_write_b32 a84,v80
v_accvgpr_write_b32 a85,v81
v_accvgpr_write_b32 a86,v82
v_accvgpr_write_b32 a87,v83
v_accvgpr_write_b32 a92,v84
v_accvgpr_write_b32 a93,v85
v_accvgpr_write_b32 a94,v86
v_accvgpr_write_b32 a95,v87
s_waitcnt vmcnt(24)
v_perm_b32 v80,v41,v40,s61
v_perm_b32 v81,v43,v42,s61
v_perm_b32 v82,v45,v44,s61
v_perm_b32 v83,v47,v46,s61
v_perm_b32 v84,v41,v40,s62
v_perm_b32 v85,v43,v42,s62
v_perm_b32 v86,v45,v44,s62
v_perm_b32 v87,v47,v46,s62
v_accvgpr_write_b32 a96,v80
v_accvgpr_write_b32 a97,v81
v_accvgpr_write_b32 a98,v82
v_accvgpr_write_b32 a99,v83
v_accvgpr_write_b32 a104,v84
v_accvgpr_write_b32 a105,v85
v_accvgpr_write_b32 a106,v86
v_accvgpr_write_b32 a107,v87
s_waitcnt vmcnt(16)
v_perm_b32 v80,v49,v48,s61
v_perm_b32 v81,v51,v50,s61
v_perm_b32 v82,v53,v52,s61
v_perm_b32 v83,v55,v54,s61
v_perm_b32 v84,v49,v48,s62
v_perm_b32 v85,v51,v50,s62
v_perm_b32 v86,v53,v52,s62
v_perm_b32 v87,v55,v54,s62
v_accvgpr_write_b32 a100,v80
v_accvgpr_write_b32 a101,v81
v_accvgpr_write_b32 a102,v82
v_accvgpr_write_b32 a103,v83
v_accvgpr_write_b32 a108,v84
v_accvgpr_write_b32 a109,v85
v_accvgpr_write_b32 a110,v86
v_accvgpr_write_b32 a111,v87
s_waitcnt vmcnt(8)
v_perm_b32 v80,v57,v56,s61
v_perm_b32 v81,v59,v58,s61
v_perm_b32 v82,v61,v60,s61
v_perm_b32 v83,v63,v62,s61
v_perm_b32 v84,v57,v56,s62
v_perm_b32 v85,v59,v58,s62
v_perm_b32 v86,v61,v60,s62
v_perm_b32 v87,v63,v62,s62
v_accvgpr_write_b32 a112,v80
v_accvgpr_write_b32 a113,v81
v_accvgpr_write_b32 a114,v82
v_accvgpr_write_b32 a115,v83
v_accvgpr_write_b32 a120,v84
v_accvgpr_write_b32 a121,v85
v_accvgpr_write_b32 a122,v86
v_accvgpr_write_b32 a123,v87
s_waitcnt vmcnt(0)
v_perm_b32 v80,v65,v64,s61
v_perm_b32 v81,v67,v66,s61
v_perm_b32 v82,v69,v68,s61
v_perm_b32 v83,v71,v70,s61
v_perm_b32 v84,v65,v64,s62
v_perm_b32 v85,v67,v66,s62
v_perm_b32 v86,v69,v68,s62
v_perm_b32 v87,v71,v70,s62
v_accvgpr_write_b32 a116,v80
v_accvgpr_write_b32 a117,v81
v_accvgpr_write_b32 a118,v82
v_accvgpr_write_b32 a119,v83
v_accvgpr_write_b32 a124,v84
v_accvgpr_write_b32 a125,v85
v_accvgpr_write_b32 a126,v86
v_accvgpr_write_b32 a127,v87
s_cmp_lt_u32 s48,3
s_cbranch_scc1 L_rch_4
s_cmp_eq_u32 s48,3
s_cbranch_scc1 L_rm_5
v_mov_b32 v123,159744
s_cmp_lg_u32 s46,0
s_cbranch_scc1 L_gbd_12
v_mov_b32 v124,128
L_gb_11:
buffer_load_dword v125,v124,s[12:15],0 offen sc1
s_waitcnt vmcnt(0)
v_readfirstlane_b32 s56,v125
ds_write_b32 v123,v125
s_bitcmp1_b32 s56,8
s_cbranch_scc1 L_gbd_12
s_sleep 4
s_sub_u32 s49,s49,1
s_cmp_gt_i32 s49,0
s_cbranch_scc1 L_gb_11
s_branch L_abort
L_gbd_12:
s_waitcnt lgkmcnt(0)
s_barrier
ds_read_b32 v125,v123
s_waitcnt lgkmcnt(0)
v_readfirstlane_b32 s56,v125
s_barrier
s_lshr_b32 s56,s56,16
s_andn2_b32 s56,s56,s3
s_cbranch_scc1 L_spread
v_and_b32 v120,15,v1
v_lshrrev_b32 v121,4,v1
v_mov_b32 v17,1
s_lshl_b32 s56,s46,15
v_add_u32 v18,s56,v0
s_lshl_b32 s56,s46,2
v_add_u32 v125,s56,v121
v_xor_b32 v126,v125,v120
v_lshlrev_b32 v126,4,v126
v_lshl_add_u32 v20,v125,10,v126
v_add_u32 v125,0,v121
v_xor_b32 v125,v125,v120
v_lshlrev_b32 v125,4,v125
v_lshl_add_u32 v125,v120,8,v125
v_add_u32 v4,65536,v125
v_add_u32 v125,4,v121
v_xor_b32 v125,v125,v120
v_lshlrev_b32 v125,4,v125
v_lshl_add_u32 v125,v120,8,v125
v_add_u32 v5,65536,v125
v_add_u32 v125,8,v121
v_xor_b32 v125,v125,v120
v_lshlrev_b32 v125,4,v125
v_lshl_add_u32 v125,v120,8,v125
v_add_u32 v6,65536,v125
v_add_u32 v125,12,v121
v_xor_b32 v125,v125,v120
v_lshlrev_b32 v125,4,v125
v_lshl_add_u32 v125,v120,8,v125
v_add_u32 v7,65536,v125
v_lshlrev_b32 v21,5,v120
v_and_b32 v125,1,v121
v_lshl_add_u32 v21,v125,4,v21
s_lshl_b32 s56,s46,9
v_lshrrev_b32 v125,1,v121
v_lshl_add_u32 v21,v125,11,v21
s_add_u32 s56,s56,155648
v_add_u32 v21,s56,v21
v_lshlrev_b32 v22,4,v120
v_lshl_add_u32 v22,v121,10,v22
s_lshl_b32 s56,s46,8
v_add_u32 v22,s56,v22
s_sub_u32 s54,s48,4
s_cmp_eq_u32 s54,0
s_mov_b32 s72,1073752746
s_mov_b32 s73,2454267026
s_cmov_b32 s72,536876373
s_cmov_b32 s73,1227133513
s_mov_b32 s70,0x80000000
s_mov_b32 s53,7
s_mov_b32 s74,s50
s_xor_b32 s75,s74,32768
v_and_b32 v23,31,v1
v_lshlrev_b32 v23,2,v23
v_mov_b32 v19,s50
v_mov_b32 v16,0
s_ff1_i32_b64 s55,s[72:73]
s_bitset0_b64 s[72:73],s55
s_min_u32 s55,s55,127
s_lshl_b32 s68,s55,15
s_add_u32 s68,s68,0
s_add_u32 s69,s68,16384
s_add_u32 m0,s75,65536
s_nop 0
buffer_load_dwordx4 v20,s[8:11],s68 offen offset:0 sc1 lds
s_add_u32 m0,s75,69632
s_nop 0
buffer_load_dwordx4 v20,s[8:11],s69 offen offset:0 sc1 lds
s_add_u32 m0,s75,73472
s_nop 0
buffer_load_dwordx4 v20,s[8:11],s68 offen offset:256 sc1 lds
s_add_u32 m0,s75,77568
s_nop 0
buffer_load_dwordx4 v20,s[8:11],s69 offen offset:256 sc1 lds
s_add_u32 m0,s75,81408
s_nop 0
buffer_load_dwordx4 v20,s[8:11],s68 offen offset:512 sc1 lds
s_add_u32 m0,s75,85504
s_nop 0
buffer_load_dwordx4 v20,s[8:11],s69 offen offset:512 sc1 lds
s_add_u32 m0,s75,89344
s_nop 0
buffer_load_dwordx4 v20,s[8:11],s68 offen offset:768 sc1 lds
s_add_u32 m0,s75,93440
s_nop 0
buffer_load_dwordx4 v20,s[8:11],s69 offen offset:768 sc1 lds
s_waitcnt vmcnt(0)
s_barrier
L_p_13:
s_mov_b32 s75,s74
s_xor_b32 s74,s74,32768
v_xor_b32 v4,32768,v4
v_xor_b32 v5,32768,v5
v_xor_b32 v6,32768,v6
v_xor_b32 v7,32768,v7
ds_read_b128 v[104:107],v4 offset:0
ds_read_b128 v[108:111],v4 offset:4096
ds_read_b128 v[112:115],v5 offset:0
ds_read_b128 v[116:119],v5 offset:4096
s_waitcnt lgkmcnt(2)
v_mfma_f32_16x16x32_bf16 v[24:27],a[128:131],v[104:107],0
ds_read_b128 v[120:123],v6 offset:0
v_mfma_f32_16x16x32_bf16 v[40:43],v[104:107],v[128:131],0
s_mov_b32 s51,s55
v_mfma_f32_16x16x32_bf16 v[28:31],a[128:131],v[108:111],0
ds_read_b128 v[124:127],v6 offset:4096
v_mfma_f32_16x16x32_bf16 v[44:47],v[108:111],v[128:131],0
s_mov_b32 s77,0
v_mfma_f32_16x16x32_bf16 v[32:35],a[136:139],v[104:107],0
s_sub_u32 s53,s53,1
v_mfma_f32_16x16x32_bf16 v[48:51],v[104:107],v[136:139],0
s_ff1_i32_b64 s55,s[72:73]
v_mfma_f32_16x16x32_bf16 v[36:39],a[136:139],v[108:111],0
s_bitset0_b64 s[72:73],s55
v_mfma_f32_16x16x32_bf16 v[52:55],v[108:111],v[136:139],0
s_min_u32 s55,s55,127
s_waitcnt lgkmcnt(2)
v_mfma_f32_16x16x32_bf16 v[24:27],a[132:135],v[112:115],v[24:27]
ds_read_b128 v[104:107],v7 offset:0
v_mfma_f32_16x16x32_bf16 v[40:43],v[112:115],v[132:135],v[40:43]
s_lshl_b32 s58,s51,5
v_mfma_f32_16x16x32_bf16 v[28:31],a[132:135],v[116:119],v[28:31]
ds_read_b128 v[108:111],v7 offset:4096
v_mfma_f32_16x16x32_bf16 v[44:47],v[116:119],v[132:135],v[44:47]
s_add_u32 s58,s58,s47
v_mfma_f32_16x16x32_bf16 v[32:35],a[140:143],v[112:115],v[32:35]
s_mul_i32 s58,s58,24576
v_mfma_f32_16x16x32_bf16 v[48:51],v[112:115],v[140:143],v[48:51]
s_add_u32 s58,s58,100663296
v_mfma_f32_16x16x32_bf16 v[36:39],a[140:143],v[116:119],v[36:39]
s_add_u32 s61,s58,s50
v_mfma_f32_16x16x32_bf16 v[52:55],v[116:119],v[140:143],v[52:55]
s_add_u32 s62,s61,4096
s_waitcnt lgkmcnt(2)
v_mfma_f32_16x16x32_bf16 v[24:27],a[144:147],v[120:123],v[24:27]
ds_read_b128 v[112:115],v4 offset:8192
v_mfma_f32_16x16x32_bf16 v[40:43],v[120:123],v[144:147],v[40:43]
s_add_u32 s63,s61,16384
v_mfma_f32_16x16x32_bf16 v[28:31],a[144:147],v[124:127],v[28:31]
ds_read_b128 v[116:119],v4 offset:12288
v_mfma_f32_16x16x32_bf16 v[44:47],v[124:127],v[144:147],v[44:47]
s_add_u32 s64,s61,20480
v_mfma_f32_16x16x32_bf16 v[32:35],a[152:155],v[120:123],v[32:35]
s_add_u32 s65,s61,s50
v_mfma_f32_16x16x32_bf16 v[48:51],v[120:123],v[152:155],v[48:51]
s_add_u32 s65,s65,8192
v_mfma_f32_16x16x32_bf16 v[36:39],a[152:155],v[124:127],v[36:39]
v_mfma_f32_16x16x32_bf16 v[52:55],v[124:127],v[152:155],v[52:55]
s_waitcnt lgkmcnt(2)
v_mfma_f32_16x16x32_bf16 v[24:27],a[148:151],v[104:107],v[24:27]
ds_read_b128 v[120:123],v5 offset:8192
v_mfma_f32_16x16x32_bf16 v[40:43],v[104:107],v[148:151],v[40:43]
v_mfma_f32_16x16x32_bf16 v[28:31],a[148:151],v[108:111],v[28:31]
ds_read_b128 v[124:127],v5 offset:12288
v_mfma_f32_16x16x32_bf16 v[44:47],v[108:111],v[148:151],v[44:47]
v_mfma_f32_16x16x32_bf16 v[32:35],a[156:159],v[104:107],v[32:35]
v_mfma_f32_16x16x32_bf16 v[48:51],v[104:107],v[156:159],v[48:51]
v_mfma_f32_16x16x32_bf16 v[36:39],a[156:159],v[108:111],v[36:39]
v_mfma_f32_16x16x32_bf16 v[52:55],v[108:111],v[156:159],v[52:55]
s_waitcnt lgkmcnt(2)
v_mfma_f32_16x16x32_bf16 v[24:27],a[160:163],v[112:115],v[24:27]
ds_read_b128 v[104:107],v6 offset:8192
v_mfma_f32_16x16x32_bf16 v[40:43],v[112:115],v[160:163],v[40:43]
v_mfma_f32_16x16x32_bf16 v[28:31],a[160:163],v[116:119],v[28:31]
ds_read_b128 v[108:111],v6 offset:12288
v_mfma_f32_16x16x32_bf16 v[44:47],v[116:119],v[160:163],v[44:47]
v_mfma_f32_16x16x32_bf16 v[32:35],a[168:171],v[112:115],v[32:35]
v_mfma_f32_16x16x32_bf16 v[48:51],v[112:115],v[168:171],v[48:51]
v_mfma_f32_16x16x32_bf16 v[36:39],a[168:171],v[116:119],v[36:39]
v_mfma_f32_16x16x32_bf16 v[52:55],v[116:119],v[168:171],v[52:55]
s_waitcnt lgkmcnt(2)
v_mfma_f32_16x16x32_bf16 v[24:27],a[164:167],v[120:123],v[24:27]
ds_read_b128 v[112:115],v7 offset:8192
v_mfma_f32_16x16x32_bf16 v[40:43],v[120:123],v[164:167],v[40:43]
s_lshl_b32 s56,s54,13
v_mfma_f32_16x16x32_bf16 v[28:31],a[164:167],v[124:127],v[28:31]
ds_read_b128 v[116:119],v7 offset:12288
v_mfma_f32_16x16x32_bf16 v[44:47],v[124:127],v[164:167],v[44:47]
s_add_u32 s56,s56,10487552
v_mfma_f32_16x16x32_bf16 v[32:35],a[172:175],v[120:123],v[32:35]
s_or_b32 s56,s56,s52
v_mfma_f32_16x16x32_bf16 v[48:51],v[120:123],v[172:175],v[48:51]
buffer_load_dword v76,v23,s[8:11],s56 offen sc1
v_mfma_f32_16x16x32_bf16 v[36:39],a[172:175],v[124:127],v[36:39]
v_mfma_f32_16x16x32_bf16 v[52:55],v[124:127],v[172:175],v[52:55]
s_waitcnt lgkmcnt(2)
v_mfma_f32_16x16x32_bf16 v[24:27],a[176:179],v[104:107],v[24:27]
ds_read_b128 v[120:123],v4 offset:16384
v_mfma_f32_16x16x32_bf16 v[40:43],v[104:107],v[176:179],v[40:43]
v_mfma_f32_16x16x32_bf16 v[28:31],a[176:179],v[108:111],v[28:31]
ds_read_b128 v[124:127],v4 offset:20480
v_mfma_f32_16x16x32_bf16 v[44:47],v[108:111],v[176:179],v[44:47]
v_mfma_f32_16x16x32_bf16 v[32:35],a[184:187],v[104:107],v[32:35]
v_mfma_f32_16x16x32_bf16 v[48:51],v[104:107],v[184:187],v[48:51]
v_mfma_f32_16x16x32_bf16 v[36:39],a[184:187],v[108:111],v[36:39]
v_mfma_f32_16x16x32_bf16 v[52:55],v[108:111],v[184:187],v[52:55]
s_waitcnt lgkmcnt(2)
v_mfma_f32_16x16x32_bf16 v[24:27],a[180:183],v[112:115],v[24:27]
ds_read_b128 v[104:107],v5 offset:16384
v_mfma_f32_16x16x32_bf16 v[40:43],v[112:115],v[180:183],v[40:43]
v_mfma_f32_16x16x32_bf16 v[28:31],a[180:183],v[116:119],v[28:31]
ds_read_b128 v[108:111],v5 offset:20480
v_mfma_f32_16x16x32_bf16 v[44:47],v[116:119],v[180:183],v[44:47]
v_mfma_f32_16x16x32_bf16 v[32:35],a[188:191],v[112:115],v[32:35]
v_mfma_f32_16x16x32_bf16 v[48:51],v[112:115],v[188:191],v[48:51]
v_mfma_f32_16x16x32_bf16 v[36:39],a[188:191],v[116:119],v[36:39]
v_mfma_f32_16x16x32_bf16 v[52:55],v[116:119],v[188:191],v[52:55]
s_waitcnt lgkmcnt(2)
v_mfma_f32_16x16x32_bf16 v[24:27],a[192:195],v[120:123],v[24:27]
ds_read_b128 v[112:115],v6 offset:16384
v_mfma_f32_16x16x32_bf16 v[40:43],v[120:123],v[192:195],v[40:43]
v_mfma_f32_16x16x32_bf16 v[28:31],a[192:195],v[124:127],v[28:31]
ds_read_b128 v[116:119],v6 offset:20480
v_mfma_f32_16x16x32_bf16 v[44:47],v[124:127],v[192:195],v[44:47]
v_mfma_f32_16x16x32_bf16 v[32:35],a[200:203],v[120:123],v[32:35]
v_mfma_f32_16x16x32_bf16 v[48:51],v[120:123],v[200:203],v[48:51]
v_mfma_f32_16x16x32_bf16 v[36:39],a[200:203],v[124:127],v[36:39]
v_mfma_f32_16x16x32_bf16 v[52:55],v[124:127],v[200:203],v[52:55]
s_waitcnt lgkmcnt(2)
v_mfma_f32_16x16x32_bf16 v[24:27],a[196:199],v[104:107],v[24:27]
ds_read_b128 v[120:123],v7 offset:16384
v_mfma_f32_16x16x32_bf16 v[40:43],v[104:107],v[196:199],v[40:43]
s_waitcnt vmcnt(0)
v_mfma_f32_16x16x32_bf16 v[28:31],a[196:199],v[108:111],v[28:31]
ds_read_b128 v[124:127],v7 offset:20480
v_mfma_f32_16x16x32_bf16 v[44:47],v[108:111],v[196:199],v[44:47]
v_cmp_eq_u32 vcc,0,v76
v_mfma_f32_16x16x32_bf16 v[32:35],a[204:207],v[104:107],v[32:35]
s_nop 0
v_mov_b32 v76,vcc_lo
v_mfma_f32_16x16x32_bf16 v[48:51],v[104:107],v[204:207],v[48:51]
ds_write_b32 v19,v76
v_mfma_f32_16x16x32_bf16 v[36:39],a[204:207],v[108:111],v[36:39]
v_mfma_f32_16x16x32_bf16 v[52:55],v[108:111],v[204:207],v[52:55]
s_waitcnt vmcnt(0) lgkmcnt(0)
s_barrier
s_or_b32 s70,s70,s52
buffer_store_dword v17,off,s[8:11],s70 sc1
ds_read_b32 v76,v16
v_mfma_f32_16x16x32_bf16 v[24:27],a[208:211],v[112:115],v[24:27]
ds_read_b128 v[104:107],v4 offset:24576
v_mfma_f32_16x16x32_bf16 v[40:43],v[112:115],v[208:211],v[40:43]
s_lshl_b32 s56,s51,5
s_add_u32 s56,s56,s47
s_lshl_b32 s56,s56,12
v_mfma_f32_16x16x32_bf16 v[28:31],a[208:211],v[116:119],v[28:31]
ds_read_b128 v[108:111],v4 offset:28672
v_mfma_f32_16x16x32_bf16 v[44:47],v[116:119],v[208:211],v[44:47]
s_add_u32 s56,s56,s50
s_add_u32 s56,s56,41943040
v_mfma_f32_16x16x32_bf16 v[32:35],a[216:219],v[112:115],v[32:35]
v_mov_b64 v[72:73],-1
v_mov_b64 v[74:75],-1
v_mfma_f32_16x16x32_bf16 v[48:51],v[112:115],v[216:219],v[48:51]
buffer_store_dwordx4 v[72:75],v0,s[8:11],s56 offen sc1
v_mfma_f32_16x16x32_bf16 v[36:39],a[216:219],v[116:119],v[36:39]
v_mfma_f32_16x16x32_bf16 v[52:55],v[116:119],v[216:219],v[52:55]
s_waitcnt lgkmcnt(2)
v_mfma_f32_16x16x32_bf16 v[24:27],a[212:215],v[120:123],v[24:27]
ds_read_b128 v[112:115],v5 offset:24576
v_mfma_f32_16x16x32_bf16 v[40:43],v[120:123],v[212:215],v[40:43]
v_readfirstlane_b32 s57,v76
v_mfma_f32_16x16x32_bf16 v[28:31],a[212:215],v[124:127],v[28:31]
ds_read_b128 v[116:119],v5 offset:28672
v_mfma_f32_16x16x32_bf16 v[44:47],v[124:127],v[212:215],v[44:47]
s_sub_u32 s59,s55,s54
s_cmp_lt_i32 s59,44
s_cselect_b32 s76,2,0
v_mfma_f32_16x16x32_bf16 v[32:35],a[220:223],v[120:123],v[32:35]
s_cmp_gt_i32 s53,0
s_cselect_b32 s76,s76,0
v_mfma_f32_16x16x32_bf16 v[48:51],v[120:123],v[220:223],v[48:51]
s_cmp_eq_u32 s57,0
s_cselect_b32 s76,1,s76
v_mfma_f32_16x16x32_bf16 v[36:39],a[220:223],v[124:127],v[36:39]
s_cmp_lt_i32 s59,12
s_cselect_b32 s76,2,s76
s_add_u32 s57,s54,64
v_mfma_f32_16x16x32_bf16 v[52:55],v[124:127],v[220:223],v[52:55]
s_cmp_eq_u32 s76,1
s_cselect_b32 s68,s57,s55
s_lshl_b32 s68,s68,15
s_waitcnt lgkmcnt(2)
v_mfma_f32_16x16x32_bf16 v[24:27],a[224:227],v[104:107],v[24:27]
ds_read_b128 v[120:123],v6 offset:24576
v_mfma_f32_16x16x32_bf16 v[40:43],v[104:107],v[224:227],v[40:43]
s_cmp_eq_u32 s76,0
s_cselect_b32 s68,0x80000000,s68
s_add_u32 s69,s68,16384
v_mfma_f32_16x16x32_bf16 v[28:31],a[224:227],v[108:111],v[28:31]
ds_read_b128 v[124:127],v6 offset:28672
v_mfma_f32_16x16x32_bf16 v[44:47],v[108:111],v[224:227],v[44:47]
s_add_u32 m0,s75,65536
v_mfma_f32_16x16x32_bf16 v[32:35],a[232:235],v[104:107],v[32:35]
buffer_load_dwordx4 v20,s[8:11],s68 offen offset:0 sc1 lds
v_mfma_f32_16x16x32_bf16 v[48:51],v[104:107],v[232:235],v[48:51]
s_add_u32 m0,s75,69632
v_mfma_f32_16x16x32_bf16 v[36:39],a[232:235],v[108:111],v[36:39]
buffer_load_dwordx4 v20,s[8:11],s69 offen offset:0 sc1 lds
v_mfma_f32_16x16x32_bf16 v[52:55],v[108:111],v[232:235],v[52:55]
s_add_u32 m0,s75,73472
s_waitcnt lgkmcnt(2)
v_mfma_f32_16x16x32_bf16 v[24:27],a[228:231],v[112:115],v[24:27]
ds_read_b128 v[104:107],v7 offset:24576
v_mfma_f32_16x16x32_bf16 v[40:43],v[112:115],v[228:231],v[40:43]
buffer_load_dwordx4 v20,s[8:11],s68 offen offset:256 sc1 lds
v_mfma_f32_16x16x32_bf16 v[28:31],a[228:231],v[116:119],v[28:31]
ds_read_b128 v[108:111],v7 offset:28672
v_mfma_f32_16x16x32_bf16 v[44:47],v[116:119],v[228:231],v[44:47]
s_add_u32 m0,s75,77568
v_mfma_f32_16x16x32_bf16 v[32:35],a[236:239],v[112:115],v[32:35]
buffer_load_dwordx4 v20,s[8:11],s69 offen offset:256 sc1 lds
v_mfma_f32_16x16x32_bf16 v[48:51],v[112:115],v[236:239],v[48:51]
s_add_u32 m0,s75,81408
v_mfma_f32_16x16x32_bf16 v[36:39],a[236:239],v[116:119],v[36:39]
buffer_load_dwordx4 v20,s[8:11],s68 offen offset:512 sc1 lds
v_mfma_f32_16x16x32_bf16 v[52:55],v[116:119],v[236:239],v[52:55]
s_add_u32 m0,s75,85504
s_waitcnt lgkmcnt(2)
v_mfma_f32_16x16x32_bf16 v[24:27],a[240:243],v[120:123],v[24:27]
ds_read_b128 v[112:115],v4 offset:0
v_mfma_f32_16x16x32_bf16 v[40:43],v[120:123],v[240:243],v[40:43]
buffer_load_dwordx4 v20,s[8:11],s69 offen offset:512 sc1 lds
v_mfma_f32_16x16x32_bf16 v[28:31],a[240:243],v[124:127],v[28:31]
ds_read_b128 v[116:119],v4 offset:4096
v_mfma_f32_16x16x32_bf16 v[44:47],v[124:127],v[240:243],v[44:47]
s_add_u32 m0,s75,89344
v_mfma_f32_16x16x32_bf16 v[32:35],a[248:251],v[120:123],v[32:35]
buffer_load_dwordx4 v20,s[8:11],s68 offen offset:768 sc1 lds
v_mfma_f32_16x16x32_bf16 v[48:51],v[120:123],v[248:251],v[48:51]
s_add_u32 m0,s75,93440
v_mfma_f32_16x16x32_bf16 v[36:39],a[248:251],v[124:127],v[36:39]
buffer_load_dwordx4 v20,s[8:11],s69 offen offset:768 sc1 lds
v_mfma_f32_16x16x32_bf16 v[52:55],v[124:127],v[248:251],v[52:55]
s_waitcnt lgkmcnt(2)
v_mfma_f32_16x16x32_bf16 v[24:27],a[244:247],v[104:107],v[24:27]
ds_read_b128 v[120:123],v5 offset:0
v_mfma_f32_16x16x32_bf16 v[40:43],v[104:107],v[244:247],v[40:43]
v_mfma_f32_16x16x32_bf16 v[28:31],a[244:247],v[108:111],v[28:31]
ds_read_b128 v[124:127],v5 offset:4096
v_mfma_f32_16x16x32_bf16 v[44:47],v[108:111],v[244:247],v[44:47]
v_mfma_f32_16x16x32_bf16 v[32:35],a[252:255],v[104:107],v[32:35]
v_mfma_f32_16x16x32_bf16 v[48:51],v[104:107],v[252:255],v[48:51]
v_mfma_f32_16x16x32_bf16 v[36:39],a[252:255],v[108:111],v[36:39]
v_mfma_f32_16x16x32_bf16 v[52:55],v[108:111],v[252:255],v[52:55]
s_waitcnt lgkmcnt(2)
v_mfma_f32_16x16x32_bf16 v[88:91],a[0:3],v[112:115],0
ds_read_b128 v[104:107],v6 offset:0
v_mfma_f32_16x16x32_bf16 v[92:95],a[0:3],v[116:119],0
v_mfma_f32_16x16x32_bf16 v[96:99],a[8:11],v[112:115],0
ds_read_b128 v[108:111],v6 offset:4096
v_cvt_pk_bf16_f32 v56,v24,v32
v_cvt_pk_bf16_f32 v57,v25,v33
v_mfma_f32_16x16x32_bf16 v[100:103],a[8:11],v[116:119],0
v_cvt_pk_bf16_f32 v58,v26,v34
v_cvt_pk_bf16_f32 v59,v27,v35
s_waitcnt lgkmcnt(2)
v_mfma_f32_16x16x32_bf16 v[88:91],a[4:7],v[120:123],v[88:91]
ds_read_b128 v[112:115],v7 offset:0
v_mfma_f32_16x16x32_bf16 v[92:95],a[4:7],v[124:127],v[92:95]
buffer_store_dwordx4 v[56:59],v0,s[8:11],s61 offen sc1
v_cvt_pk_bf16_f32 v60,v28,v36
v_cvt_pk_bf16_f32 v61,v29,v37
v_mfma_f32_16x16x32_bf16 v[96:99],a[12:15],v[120:123],v[96:99]
ds_read_b128 v[116:119],v7 offset:4096
v_cvt_pk_bf16_f32 v62,v30,v38
v_cvt_pk_bf16_f32 v63,v31,v39
v_mfma_f32_16x16x32_bf16 v[100:103],a[12:15],v[124:127],v[100:103]
buffer_store_dwordx4 v[60:63],v0,s[8:11],s62 offen sc1
v_cvt_pk_bf16_f32 v64,v40,v41
v_cvt_pk_bf16_f32 v65,v42,v43
s_waitcnt lgkmcnt(2)
v_mfma_f32_16x16x32_bf16 v[88:91],a[16:19],v[104:107],v[88:91]
ds_read_b128 v[120:123],v4 offset:8192
v_cvt_pk_bf16_f32 v66,v44,v45
v_cvt_pk_bf16_f32 v67,v46,v47
v_mfma_f32_16x16x32_bf16 v[92:95],a[16:19],v[108:111],v[92:95]
buffer_store_dwordx4 v[64:67],v0,s[8:11],s65 offen offset:0 sc1
v_cvt_pk_bf16_f32 v68,v48,v49
v_cvt_pk_bf16_f32 v69,v50,v51
v_mfma_f32_16x16x32_bf16 v[96:99],a[24:27],v[104:107],v[96:99]
ds_read_b128 v[124:127],v4 offset:12288
v_cvt_pk_bf16_f32 v70,v52,v53
v_cvt_pk_bf16_f32 v71,v54,v55
v_mfma_f32_16x16x32_bf16 v[100:103],a[24:27],v[108:111],v[100:103]
buffer_store_dwordx4 v[68:71],v0,s[8:11],s65 offen offset:1024 sc1
s_waitcnt lgkmcnt(2)
v_mfma_f32_16x16x32_bf16 v[88:91],a[20:23],v[112:115],v[88:91]
ds_read_b128 v[104:107],v5 offset:8192
v_mfma_f32_16x16x32_bf16 v[92:95],a[20:23],v[116:119],v[92:95]
v_mfma_f32_16x16x32_bf16 v[96:99],a[28:31],v[112:115],v[96:99]
ds_read_b128 v[108:111],v5 offset:12288
v_mfma_f32_16x16x32_bf16 v[100:103],a[28:31],v[116:119],v[100:103]
s_waitcnt lgkmcnt(2)
v_mfma_f32_16x16x32_bf16 v[88:91],a[32:35],v[120:123],v[88:91]
ds_read_b128 v[112:115],v6 offset:8192
v_mfma_f32_16x16x32_bf16 v[92:95],a[32:35],v[124:127],v[92:95]
v_mfma_f32_16x16x32_bf16 v[96:99],a[40:43],v[120:123],v[96:99]
ds_read_b128 v[116:119],v6 offset:12288
v_mfma_f32_16x16x32_bf16 v[100:103],a[40:43],v[124:127],v[100:103]
s_waitcnt lgkmcnt(2)
v_mfma_f32_16x16x32_bf16 v[88:91],a[36:39],v[104:107],v[88:91]
ds_read_b128 v[120:123],v7 offset:8192
v_mfma_f32_16x16x32_bf16 v[92:95],a[36:39],v[108:111],v[92:95]
s_lshl_b32 s56,s54,13
v_mfma_f32_16x16x32_bf16 v[96:99],a[44:47],v[104:107],v[96:99]
ds_read_b128 v[124:127],v7 offset:12288
v_mfma_f32_16x16x32_bf16 v[100:103],a[44:47],v[108:111],v[100:103]
s_add_u32 s56,s56,10487552
s_waitcnt lgkmcnt(2)
v_mfma_f32_16x16x32_bf16 v[88:91],a[48:51],v[112:115],v[88:91]
ds_read_b128 v[104:107],v4 offset:16384
v_mfma_f32_16x16x32_bf16 v[92:95],a[48:51],v[116:119],v[92:95]
s_or_b32 s56,s56,s52
v_mfma_f32_16x16x32_bf16 v[96:99],a[56:59],v[112:115],v[96:99]
ds_read_b128 v[108:111],v4 offset:20480
v_mfma_f32_16x16x32_bf16 v[100:103],a[56:59],v[116:119],v[100:103]
buffer_load_dword v76,v23,s[8:11],s56 offen sc1
s_waitcnt lgkmcnt(2)
v_mfma_f32_16x16x32_bf16 v[88:91],a[52:55],v[120:123],v[88:91]
ds_read_b128 v[112:115],v5 offset:16384
v_mfma_f32_16x16x32_bf16 v[92:95],a[52:55],v[124:127],v[92:95]
v_mfma_f32_16x16x32_bf16 v[96:99],a[60:63],v[120:123],v[96:99]
ds_read_b128 v[116:119],v5 offset:20480
v_mfma_f32_16x16x32_bf16 v[100:103],a[60:63],v[124:127],v[100:103]
s_waitcnt lgkmcnt(2)
v_mfma_f32_16x16x32_bf16 v[88:91],a[64:67],v[104:107],v[88:91]
ds_read_b128 v[120:123],v6 offset:16384
v_mfma_f32_16x16x32_bf16 v[92:95],a[64:67],v[108:111],v[92:95]
v_mfma_f32_16x16x32_bf16 v[96:99],a[72:75],v[104:107],v[96:99]
ds_read_b128 v[124:127],v6 offset:20480
v_mfma_f32_16x16x32_bf16 v[100:103],a[72:75],v[108:111],v[100:103]
s_waitcnt lgkmcnt(2)
v_mfma_f32_16x16x32_bf16 v[88:91],a[68:71],v[112:115],v[88:91]
ds_read_b128 v[104:107],v7 offset:16384
v_mfma_f32_16x16x32_bf16 v[92:95],a[68:71],v[116:119],v[92:95]
v_mfma_f32_16x16x32_bf16 v[96:99],a[76:79],v[112:115],v[96:99]
ds_read_b128 v[108:111],v7 offset:20480
v_mfma_f32_16x16x32_bf16 v[100:103],a[76:79],v[116:119],v[100:103]
s_waitcnt lgkmcnt(2)
v_mfma_f32_16x16x32_bf16 v[88:91],a[80:83],v[120:123],v[88:91]
ds_read_b128 v[112:115],v4 offset:24576
v_mfma_f32_16x16x32_bf16 v[92:95],a[80:83],v[124:127],v[92:95]
v_mfma_f32_16x16x32_bf16 v[96:99],a[88:91],v[120:123],v[96:99]
ds_read_b128 v[116:119],v4 offset:28672
v_mfma_f32_16x16x32_bf16 v[100:103],a[88:91],v[124:127],v[100:103]
s_waitcnt lgkmcnt(2)
v_mfma_f32_16x16x32_bf16 v[88:91],a[84:87],v[104:107],v[88:91]
ds_read_b128 v[120:123],v5 offset:24576
v_mfma_f32_16x16x32_bf16 v[92:95],a[84:87],v[108:111],v[92:95]
v_mfma_f32_16x16x32_bf16 v[96:99],a[92:95],v[104:107],v[96:99]
ds_read_b128 v[124:127],v5 offset:28672
v_mfma_f32_16x16x32_bf16 v[100:103],a[92:95],v[108:111],v[100:103]
s_waitcnt lgkmcnt(2)
v_mfma_f32_16x16x32_bf16 v[88:91],a[96:99],v[112:115],v[88:91]
ds_read_b128 v[104:107],v6 offset:24576
v_mfma_f32_16x16x32_bf16 v[92:95],a[96:99],v[116:119],v[92:95]
v_mfma_f32_16x16x32_bf16 v[96:99],a[104:107],v[112:115],v[96:99]
ds_read_b128 v[108:111],v6 offset:28672
v_mfma_f32_16x16x32_bf16 v[100:103],a[104:107],v[116:119],v[100:103]
s_waitcnt lgkmcnt(2)
v_mfma_f32_16x16x32_bf16 v[88:91],a[100:103],v[120:123],v[88:91]
ds_read_b128 v[112:115],v7 offset:24576
v_mfma_f32_16x16x32_bf16 v[92:95],a[100:103],v[124:127],v[92:95]
v_mfma_f32_16x16x32_bf16 v[96:99],a[108:111],v[120:123],v[96:99]
ds_read_b128 v[116:119],v7 offset:28672
v_mfma_f32_16x16x32_bf16 v[100:103],a[108:111],v[124:127],v[100:103]
s_waitcnt lgkmcnt(2)
v_mfma_f32_16x16x32_bf16 v[88:91],a[112:115],v[104:107],v[88:91]
v_mfma_f32_16x16x32_bf16 v[92:95],a[112:115],v[108:111],v[92:95]
v_mfma_f32_16x16x32_bf16 v[96:99],a[120:123],v[104:107],v[96:99]
v_mfma_f32_16x16x32_bf16 v[100:103],a[120:123],v[108:111],v[100:103]
s_waitcnt lgkmcnt(0)
v_mfma_f32_16x16x32_bf16 v[88:91],a[116:119],v[112:115],v[88:91]
v_mfma_f32_16x16x32_bf16 v[92:95],a[116:119],v[116:119],v[92:95]
v_mfma_f32_16x16x32_bf16 v[96:99],a[124:127],v[112:115],v[96:99]
v_mfma_f32_16x16x32_bf16 v[100:103],a[124:127],v[116:119],v[100:103]
s_nop 3
v_cvt_pk_bf16_f32 v104,v88,v96
v_cvt_pk_bf16_f32 v105,v89,v97
v_cvt_pk_bf16_f32 v106,v90,v98
v_cvt_pk_bf16_f32 v107,v91,v99
v_cvt_pk_bf16_f32 v108,v92,v100
v_cvt_pk_bf16_f32 v109,v93,v101
v_cvt_pk_bf16_f32 v110,v94,v102
v_cvt_pk_bf16_f32 v111,v95,v103
buffer_store_dwordx4 v[104:107],v0,s[8:11],s63 offen sc1
buffer_store_dwordx4 v[108:111],v0,s[8:11],s64 offen sc1
s_waitcnt vmcnt(7)
s_barrier
s_lshl_b32 s70,s51,13
s_lshl2_add_u32 s70,s47,s70
s_add_u32 s70,s70,10485760
s_cmp_ge_u32 s51,2
s_cbranch_scc1 L_p_15
s_waitcnt vmcnt(0)
s_barrier
s_or_b32 s70,s70,s52
buffer_store_dword v17,off,s[8:11],s70 sc1
L_p_15:
s_cmp_eq_u32 s76,2
s_cbranch_scc1 L_p_13
s_mov_b32 s53,0
s_mov_b32 s51,s54
s_add_u32 s54,s54,2
s_cmp_eq_u32 s76,1
s_cbranch_scc1 L_p_14
s_cmp_lg_u32 s77,0
s_waitcnt vmcnt(3)
s_cbranch_scc1 L_p_17
s_waitcnt vmcnt(2)
L_p_17:
v_cmp_eq_u32 vcc,0,v76
s_nop 1
v_mov_b32 v76,vcc_lo
ds_write_b32 v19,v76
s_lshl_b32 s66,s51,15
s_add_u32 s66,s66,2097152
s_add_u32 s67,s66,16384
s_waitcnt lgkmcnt(0)
s_barrier
ds_read_b32 v76,v16
s_waitcnt lgkmcnt(0)
v_cmp_eq_u32 vcc,0,v76
s_cbranch_vccnz L_p_18
s_waitcnt vmcnt(0)
s_barrier
s_or_b32 s70,s70,s52
buffer_store_dword v17,off,s[8:11],s70 sc1
s_mov_b32 s70,0x80000000
s_mov_b32 s53,1
s_cmp_ge_u32 s51,64
s_cbranch_scc1 L_p_16
s_lshl_b32 s59,s51,13
s_add_u32 s59,s59,10487552
s_cmp_lg_u32 s46,0
s_cbranch_scc1 L_fd_20
v_and_b32 v124,31,v1
v_lshlrev_b32 v124,2,v124
s_branch L_ff_21
L_fw_19:
s_sleep 2
L_ff_21:
buffer_load_dword v125,v124,s[8:11],s59 offen sc1
s_sub_u32 s49,s49,1
s_cbranch_scc1 L_abort
s_waitcnt vmcnt(0)
v_cmp_eq_u32 vcc,0,v125
s_cbranch_vccnz L_fw_19
L_fd_20:
s_barrier
L_p_18:
s_add_u32 m0,s74,65536
s_nop 0
buffer_load_dwordx4 v20,s[8:11],s66 offen offset:0 sc1 lds
s_add_u32 m0,s74,69632
s_nop 0
buffer_load_dwordx4 v20,s[8:11],s67 offen offset:0 sc1 lds
s_add_u32 m0,s74,73472
s_nop 0
buffer_load_dwordx4 v20,s[8:11],s66 offen offset:256 sc1 lds
s_add_u32 m0,s74,77568
s_nop 0
buffer_load_dwordx4 v20,s[8:11],s67 offen offset:256 sc1 lds
s_add_u32 m0,s74,81408
s_nop 0
buffer_load_dwordx4 v20,s[8:11],s66 offen offset:512 sc1 lds
s_add_u32 m0,s74,85504
s_nop 0
buffer_load_dwordx4 v20,s[8:11],s67 offen offset:512 sc1 lds
s_add_u32 m0,s74,89344
s_nop 0
buffer_load_dwordx4 v20,s[8:11],s66 offen offset:768 sc1 lds
s_add_u32 m0,s74,93440
s_nop 0
buffer_load_dwordx4 v20,s[8:11],s67 offen offset:768 sc1 lds
s_lshl_b32 s56,s54,13
s_add_u32 s56,s56,10487552
s_or_b32 s56,s56,s52
buffer_load_dword v76,v23,s[8:11],s56 offen sc1
s_waitcnt vmcnt(7)
s_barrier
ds_read_b128 v[104:107],v4 offset:0
ds_read_b128 v[108:111],v4 offset:4096
ds_read_b128 v[112:115],v5 offset:0
ds_read_b128 v[116:119],v5 offset:4096
s_waitcnt lgkmcnt(2)
v_mfma_f32_16x16x32_bf16 v[24:27],a[128:131],v[104:107],0
ds_read_b128 v[120:123],v6 offset:0
v_mfma_f32_16x16x32_bf16 v[40:43],v[104:107],v[128:131],0
s_lshl_b32 s58,s51,5
v_mfma_f32_16x16x32_bf16 v[28:31],a[128:131],v[108:111],0
ds_read_b128 v[124:127],v6 offset:4096
v_mfma_f32_16x16x32_bf16 v[44:47],v[108:111],v[128:131],0
s_add_u32 s58,s58,s47
v_mfma_f32_16x16x32_bf16 v[32:35],a[136:139],v[104:107],0
s_mul_i32 s58,s58,24576
v_mfma_f32_16x16x32_bf16 v[48:51],v[104:107],v[136:139],0
s_add_u32 s58,s58,150994944
v_mfma_f32_16x16x32_bf16 v[36:39],a[136:139],v[108:111],0
s_add_u32 s61,s58,s50
v_mfma_f32_16x16x32_bf16 v[52:55],v[108:111],v[136:139],0
s_add_u32 s62,s61,4096
s_waitcnt lgkmcnt(2)
v_mfma_f32_16x16x32_bf16 v[24:27],a[132:135],v[112:115],v[24:27]
ds_read_b128 v[104:107],v7 offset:0
v_mfma_f32_16x16x32_bf16 v[40:43],v[112:115],v[132:135],v[40:43]
s_add_u32 s63,s61,16384
v_mfma_f32_16x16x32_bf16 v[28:31],a[132:135],v[116:119],v[28:31]
ds_read_b128 v[108:111],v7 offset:4096
v_mfma_f32_16x16x32_bf16 v[44:47],v[116:119],v[132:135],v[44:47]
s_add_u32 s64,s61,20480
v_mfma_f32_16x16x32_bf16 v[32:35],a[140:143],v[112:115],v[32:35]
s_add_u32 s65,s61,s50
v_mfma_f32_16x16x32_bf16 v[48:51],v[112:115],v[140:143],v[48:51]
s_add_u32 s65,s65,8192
v_mfma_f32_16x16x32_bf16 v[36:39],a[140:143],v[116:119],v[36:39]
v_mfma_f32_16x16x32_bf16 v[52:55],v[116:119],v[140:143],v[52:55]
s_waitcnt vmcnt(5)
s_barrier
s_waitcnt lgkmcnt(2)
v_mfma_f32_16x16x32_bf16 v[24:27],a[144:147],v[120:123],v[24:27]
ds_read_b128 v[112:115],v4 offset:8192
v_mfma_f32_16x16x32_bf16 v[40:43],v[120:123],v[144:147],v[40:43]
v_mfma_f32_16x16x32_bf16 v[28:31],a[144:147],v[124:127],v[28:31]
ds_read_b128 v[116:119],v4 offset:12288
v_mfma_f32_16x16x32_bf16 v[44:47],v[124:127],v[144:147],v[44:47]
v_mfma_f32_16x16x32_bf16 v[32:35],a[152:155],v[120:123],v[32:35]
v_mfma_f32_16x16x32_bf16 v[48:51],v[120:123],v[152:155],v[48:51]
v_mfma_f32_16x16x32_bf16 v[36:39],a[152:155],v[124:127],v[36:39]
v_mfma_f32_16x16x32_bf16 v[52:55],v[124:127],v[152:155],v[52:55]
s_waitcnt lgkmcnt(2)
v_mfma_f32_16x16x32_bf16 v[24:27],a[148:151],v[104:107],v[24:27]
ds_read_b128 v[120:123],v5 offset:8192
v_mfma_f32_16x16x32_bf16 v[40:43],v[104:107],v[148:151],v[40:43]
v_mfma_f32_16x16x32_bf16 v[28:31],a[148:151],v[108:111],v[28:31]
ds_read_b128 v[124:127],v5 offset:12288
v_mfma_f32_16x16x32_bf16 v[44:47],v[108:111],v[148:151],v[44:47]
v_mfma_f32_16x16x32_bf16 v[32:35],a[156:159],v[104:107],v[32:35]
v_mfma_f32_16x16x32_bf16 v[48:51],v[104:107],v[156:159],v[48:51]
v_mfma_f32_16x16x32_bf16 v[36:39],a[156:159],v[108:111],v[36:39]
v_mfma_f32_16x16x32_bf16 v[52:55],v[108:111],v[156:159],v[52:55]
s_waitcnt lgkmcnt(2)
v_mfma_f32_16x16x32_bf16 v[24:27],a[160:163],v[112:115],v[24:27]
ds_read_b128 v[104:107],v6 offset:8192
v_mfma_f32_16x16x32_bf16 v[40:43],v[112:115],v[160:163],v[40:43]
v_mfma_f32_16x16x32_bf16 v[28:31],a[160:163],v[116:119],v[28:31]
ds_read_b128 v[108:111],v6 offset:12288
v_mfma_f32_16x16x32_bf16 v[44:47],v[116:119],v[160:163],v[44:47]
v_mfma_f32_16x16x32_bf16 v[32:35],a[168:171],v[112:115],v[32:35]
v_mfma_f32_16x16x32_bf16 v[48:51],v[112:115],v[168:171],v[48:51]
v_mfma_f32_16x16x32_bf16 v[36:39],a[168:171],v[116:119],v[36:39]
v_mfma_f32_16x16x32_bf16 v[52:55],v[116:119],v[168:171],v[52:55]
s_waitcnt lgkmcnt(2)
v_mfma_f32_16x16x32_bf16 v[24:27],a[164:167],v[120:123],v[24:27]
ds_read_b128 v[112:115],v7 offset:8192
v_mfma_f32_16x16x32_bf16 v[40:43],v[120:123],v[164:167],v[40:43]
v_mfma_f32_16x16x32_bf16 v[28:31],a[164:167],v[124:127],v[28:31]
ds_read_b128 v[116:119],v7 offset:12288
v_mfma_f32_16x16x32_bf16 v[44:47],v[124:127],v[164:167],v[44:47]
v_mfma_f32_16x16x32_bf16 v[32:35],a[172:175],v[120:123],v[32:35]
v_mfma_f32_16x16x32_bf16 v[48:51],v[120:123],v[172:175],v[48:51]
v_mfma_f32_16x16x32_bf16 v[36:39],a[172:175],v[124:127],v[36:39]
v_mfma_f32_16x16x32_bf16 v[52:55],v[124:127],v[172:175],v[52:55]
s_waitcnt vmcnt(3)
s_barrier
s_waitcnt lgkmcnt(2)
v_mfma_f32_16x16x32_bf16 v[24:27],a[176:179],v[104:107],v[24:27]
ds_read_b128 v[120:123],v4 offset:16384
v_mfma_f32_16x16x32_bf16 v[40:43],v[104:107],v[176:179],v[40:43]
v_mfma_f32_16x16x32_bf16 v[28:31],a[176:179],v[108:111],v[28:31]
ds_read_b128 v[124:127],v4 offset:20480
v_mfma_f32_16x16x32_bf16 v[44:47],v[108:111],v[176:179],v[44:47]
v_mfma_f32_16x16x32_bf16 v[32:35],a[184:187],v[104:107],v[32:35]
v_mfma_f32_16x16x32_bf16 v[48:51],v[104:107],v[184:187],v[48:51]
v_mfma_f32_16x16x32_bf16 v[36:39],a[184:187],v[108:111],v[36:39]
v_mfma_f32_16x16x32_bf16 v[52:55],v[108:111],v[184:187],v[52:55]
s_waitcnt lgkmcnt(2)
v_mfma_f32_16x16x32_bf16 v[24:27],a[180:183],v[112:115],v[24:27]
ds_read_b128 v[104:107],v5 offset:16384
v_mfma_f32_16x16x32_bf16 v[40:43],v[112:115],v[180:183],v[40:43]
v_mfma_f32_16x16x32_bf16 v[28:31],a[180:183],v[116:119],v[28:31]
ds_read_b128 v[108:111],v5 offset:20480
v_mfma_f32_16x16x32_bf16 v[44:47],v[116:119],v[180:183],v[44:47]
v_mfma_f32_16x16x32_bf16 v[32:35],a[188:191],v[112:115],v[32:35]
v_mfma_f32_16x16x32_bf16 v[48:51],v[112:115],v[188:191],v[48:51]
v_mfma_f32_16x16x32_bf16 v[36:39],a[188:191],v[116:119],v[36:39]
v_mfma_f32_16x16x32_bf16 v[52:55],v[116:119],v[188:191],v[52:55]
s_waitcnt lgkmcnt(2)
v_mfma_f32_16x16x32_bf16 v[24:27],a[192:195],v[120:123],v[24:27]
ds_read_b128 v[112:115],v6 offset:16384
v_mfma_f32_16x16x32_bf16 v[40:43],v[120:123],v[192:195],v[40:43]
v_mfma_f32_16x16x32_bf16 v[28:31],a[192:195],v[124:127],v[28:31]
ds_read_b128 v[116:119],v6 offset:20480
v_mfma_f32_16x16x32_bf16 v[44:47],v[124:127],v[192:195],v[44:47]
v_mfma_f32_16x16x32_bf16 v[32:35],a[200:203],v[120:123],v[32:35]
v_mfma_f32_16x16x32_bf16 v[48:51],v[120:123],v[200:203],v[48:51]
v_mfma_f32_16x16x32_bf16 v[36:39],a[200:203],v[124:127],v[36:39]
v_mfma_f32_16x16x32_bf16 v[52:55],v[124:127],v[200:203],v[52:55]
s_waitcnt lgkmcnt(2)
v_mfma_f32_16x16x32_bf16 v[24:27],a[196:199],v[104:107],v[24:27]
ds_read_b128 v[120:123],v7 offset:16384
v_mfma_f32_16x16x32_bf16 v[40:43],v[104:107],v[196:199],v[40:43]
s_waitcnt vmcnt(0)
v_mfma_f32_16x16x32_bf16 v[28:31],a[196:199],v[108:111],v[28:31]
ds_read_b128 v[124:127],v7 offset:20480
v_mfma_f32_16x16x32_bf16 v[44:47],v[108:111],v[196:199],v[44:47]
v_cmp_eq_u32 vcc,0,v76
v_mfma_f32_16x16x32_bf16 v[32:35],a[204:207],v[104:107],v[32:35]
s_nop 0
v_mov_b32 v76,vcc_lo
v_mfma_f32_16x16x32_bf16 v[48:51],v[104:107],v[204:207],v[48:51]
ds_write_b32 v19,v76
v_mfma_f32_16x16x32_bf16 v[36:39],a[204:207],v[108:111],v[36:39]
v_mfma_f32_16x16x32_bf16 v[52:55],v[108:111],v[204:207],v[52:55]
s_waitcnt vmcnt(0) lgkmcnt(0)
s_barrier
s_or_b32 s70,s70,s52
buffer_store_dword v17,off,s[8:11],s70 sc1
ds_read_b32 v76,v16
v_mfma_f32_16x16x32_bf16 v[24:27],a[208:211],v[112:115],v[24:27]
ds_read_b128 v[104:107],v4 offset:24576
v_mfma_f32_16x16x32_bf16 v[40:43],v[112:115],v[208:211],v[40:43]
s_lshl_b32 s56,s51,5
s_add_u32 s56,s56,s47
s_lshl_b32 s56,s56,12
v_mfma_f32_16x16x32_bf16 v[28:31],a[208:211],v[116:119],v[28:31]
ds_read_b128 v[108:111],v4 offset:28672
v_mfma_f32_16x16x32_bf16 v[44:47],v[116:119],v[208:211],v[44:47]
s_add_u32 s56,s56,s50
s_add_u32 s56,s56,58720256
v_mfma_f32_16x16x32_bf16 v[32:35],a[216:219],v[112:115],v[32:35]
v_mov_b64 v[72:73],-1
v_mov_b64 v[74:75],-1
v_mfma_f32_16x16x32_bf16 v[48:51],v[112:115],v[216:219],v[48:51]
buffer_store_dwordx4 v[72:75],v0,s[8:11],s56 offen sc1
v_mfma_f32_16x16x32_bf16 v[36:39],a[216:219],v[116:119],v[36:39]
s_add_u32 s56,s56,16777216
v_mfma_f32_16x16x32_bf16 v[52:55],v[116:119],v[216:219],v[52:55]
buffer_store_dwordx4 v[72:75],v0,s[8:11],s56 offen sc1
s_waitcnt lgkmcnt(2)
v_mfma_f32_16x16x32_bf16 v[24:27],a[212:215],v[120:123],v[24:27]
ds_read_b128 v[112:115],v5 offset:24576
v_mfma_f32_16x16x32_bf16 v[40:43],v[120:123],v[212:215],v[40:43]
v_readfirstlane_b32 s57,v76
v_mfma_f32_16x16x32_bf16 v[28:31],a[212:215],v[124:127],v[28:31]
ds_read_b128 v[116:119],v5 offset:28672
v_mfma_f32_16x16x32_bf16 v[44:47],v[124:127],v[212:215],v[44:47]
s_sub_u32 s59,s55,s54
s_cmp_lt_i32 s59,44
s_cselect_b32 s76,2,0
v_mfma_f32_16x16x32_bf16 v[32:35],a[220:223],v[120:123],v[32:35]
s_cmp_gt_i32 s53,0
s_cselect_b32 s76,s76,0
v_mfma_f32_16x16x32_bf16 v[48:51],v[120:123],v[220:223],v[48:51]
s_cmp_eq_u32 s57,0
s_cselect_b32 s76,1,s76
v_mfma_f32_16x16x32_bf16 v[36:39],a[220:223],v[124:127],v[36:39]
s_cmp_lt_i32 s59,12
s_cselect_b32 s76,2,s76
s_add_u32 s57,s54,64
v_mfma_f32_16x16x32_bf16 v[52:55],v[124:127],v[220:223],v[52:55]
s_cmp_eq_u32 s76,1
s_cselect_b32 s68,s57,s55
s_lshl_b32 s68,s68,15
s_waitcnt lgkmcnt(2)
v_mfma_f32_16x16x32_bf16 v[24:27],a[224:227],v[104:107],v[24:27]
ds_read_b128 v[120:123],v6 offset:24576
v_mfma_f32_16x16x32_bf16 v[40:43],v[104:107],v[224:227],v[40:43]
s_cmp_eq_u32 s76,0
s_cselect_b32 s68,0x80000000,s68
s_add_u32 s69,s68,16384
v_mfma_f32_16x16x32_bf16 v[28:31],a[224:227],v[108:111],v[28:31]
ds_read_b128 v[124:127],v6 offset:28672
v_mfma_f32_16x16x32_bf16 v[44:47],v[108:111],v[224:227],v[44:47]
s_add_u32 m0,s75,65536
v_mfma_f32_16x16x32_bf16 v[32:35],a[232:235],v[104:107],v[32:35]
buffer_load_dwordx4 v20,s[8:11],s68 offen offset:0 sc1 lds
v_mfma_f32_16x16x32_bf16 v[48:51],v[104:107],v[232:235],v[48:51]
s_add_u32 m0,s75,69632
v_mfma_f32_16x16x32_bf16 v[36:39],a[232:235],v[108:111],v[36:39]
buffer_load_dwordx4 v20,s[8:11],s69 offen offset:0 sc1 lds
v_mfma_f32_16x16x32_bf16 v[52:55],v[108:111],v[232:235],v[52:55]
s_add_u32 m0,s75,73472
s_waitcnt lgkmcnt(2)
v_mfma_f32_16x16x32_bf16 v[24:27],a[228:231],v[112:115],v[24:27]
ds_read_b128 v[104:107],v7 offset:24576
v_mfma_f32_16x16x32_bf16 v[40:43],v[112:115],v[228:231],v[40:43]
buffer_load_dwordx4 v20,s[8:11],s68 offen offset:256 sc1 lds
v_mfma_f32_16x16x32_bf16 v[28:31],a[228:231],v[116:119],v[28:31]
ds_read_b128 v[108:111],v7 offset:28672
v_mfma_f32_16x16x32_bf16 v[44:47],v[116:119],v[228:231],v[44:47]
s_add_u32 m0,s75,77568
v_mfma_f32_16x16x32_bf16 v[32:35],a[236:239],v[112:115],v[32:35]
buffer_load_dwordx4 v20,s[8:11],s69 offen offset:256 sc1 lds
v_mfma_f32_16x16x32_bf16 v[48:51],v[112:115],v[236:239],v[48:51]
s_add_u32 m0,s75,81408
v_mfma_f32_16x16x32_bf16 v[36:39],a[236:239],v[116:119],v[36:39]
buffer_load_dwordx4 v20,s[8:11],s68 offen offset:512 sc1 lds
v_mfma_f32_16x16x32_bf16 v[52:55],v[116:119],v[236:239],v[52:55]
s_add_u32 m0,s75,85504
s_waitcnt lgkmcnt(2)
v_mfma_f32_16x16x32_bf16 v[24:27],a[240:243],v[120:123],v[24:27]
ds_read_b128 v[112:115],v4 offset:0
v_mfma_f32_16x16x32_bf16 v[40:43],v[120:123],v[240:243],v[40:43]
buffer_load_dwordx4 v20,s[8:11],s69 offen offset:512 sc1 lds
v_mfma_f32_16x16x32_bf16 v[28:31],a[240:243],v[124:127],v[28:31]
ds_read_b128 v[116:119],v4 offset:4096
v_mfma_f32_16x16x32_bf16 v[44:47],v[124:127],v[240:243],v[44:47]
s_add_u32 m0,s75,89344
v_mfma_f32_16x16x32_bf16 v[32:35],a[248:251],v[120:123],v[32:35]
buffer_load_dwordx4 v20,s[8:11],s68 offen offset:768 sc1 lds
v_mfma_f32_16x16x32_bf16 v[48:51],v[120:123],v[248:251],v[48:51]
s_add_u32 m0,s75,93440
v_mfma_f32_16x16x32_bf16 v[36:39],a[248:251],v[124:127],v[36:39]
buffer_load_dwordx4 v20,s[8:11],s69 offen offset:768 sc1 lds
v_mfma_f32_16x16x32_bf16 v[52:55],v[124:127],v[248:251],v[52:55]
s_waitcnt lgkmcnt(2)
v_mfma_f32_16x16x32_bf16 v[24:27],a[244:247],v[104:107],v[24:27]
ds_read_b128 v[120:123],v5 offset:0
v_mfma_f32_16x16x32_bf16 v[40:43],v[104:107],v[244:247],v[40:43]
v_mfma_f32_16x16x32_bf16 v[28:31],a[244:247],v[108:111],v[28:31]
ds_read_b128 v[124:127],v5 offset:4096
v_mfma_f32_16x16x32_bf16 v[44:47],v[108:111],v[244:247],v[44:47]
v_mfma_f32_16x16x32_bf16 v[32:35],a[252:255],v[104:107],v[32:35]
v_mfma_f32_16x16x32_bf16 v[48:51],v[104:107],v[252:255],v[48:51]
v_mfma_f32_16x16x32_bf16 v[36:39],a[252:255],v[108:111],v[36:39]
v_mfma_f32_16x16x32_bf16 v[52:55],v[108:111],v[252:255],v[52:55]
s_waitcnt lgkmcnt(2)
v_mfma_f32_16x16x32_bf16 v[88:91],a[0:3],v[112:115],0
ds_read_b128 v[104:107],v6 offset:0
v_mfma_f32_16x16x32_bf16 v[92:95],a[0:3],v[116:119],0
v_mfma_f32_16x16x32_bf16 v[96:99],a[8:11],v[112:115],0
ds_read_b128 v[108:111],v6 offset:4096
v_cvt_pk_bf16_f32 v56,v24,v32
v_cvt_pk_bf16_f32 v57,v25,v33
v_mfma_f32_16x16x32_bf16 v[100:103],a[8:11],v[116:119],0
v_cvt_pk_bf16_f32 v58,v26,v34
v_cvt_pk_bf16_f32 v59,v27,v35
s_waitcnt lgkmcnt(2)
v_mfma_f32_16x16x32_bf16 v[88:91],a[4:7],v[120:123],v[88:91]
ds_read_b128 v[112:115],v7 offset:0
v_mfma_f32_16x16x32_bf16 v[92:95],a[4:7],v[124:127],v[92:95]
buffer_store_dwordx4 v[56:59],v0,s[8:11],s61 offen sc1
v_cvt_pk_bf16_f32 v60,v28,v36
v_cvt_pk_bf16_f32 v61,v29,v37
v_mfma_f32_16x16x32_bf16 v[96:99],a[12:15],v[120:123],v[96:99]
ds_read_b128 v[116:119],v7 offset:4096
v_cvt_pk_bf16_f32 v62,v30,v38
v_cvt_pk_bf16_f32 v63,v31,v39
v_mfma_f32_16x16x32_bf16 v[100:103],a[12:15],v[124:127],v[100:103]
buffer_store_dwordx4 v[60:63],v0,s[8:11],s62 offen sc1
v_cvt_pk_bf16_f32 v64,v40,v41
v_cvt_pk_bf16_f32 v65,v42,v43
s_waitcnt lgkmcnt(2)
v_mfma_f32_16x16x32_bf16 v[88:91],a[16:19],v[104:107],v[88:91]
ds_read_b128 v[120:123],v4 offset:8192
v_cvt_pk_bf16_f32 v66,v44,v45
v_cvt_pk_bf16_f32 v67,v46,v47
v_mfma_f32_16x16x32_bf16 v[92:95],a[16:19],v[108:111],v[92:95]
buffer_store_dwordx4 v[64:67],v0,s[8:11],s65 offen offset:0 sc1
v_cvt_pk_bf16_f32 v68,v48,v49
v_cvt_pk_bf16_f32 v69,v50,v51
v_mfma_f32_16x16x32_bf16 v[96:99],a[24:27],v[104:107],v[96:99]
ds_read_b128 v[124:127],v4 offset:12288
v_cvt_pk_bf16_f32 v70,v52,v53
v_cvt_pk_bf16_f32 v71,v54,v55
v_mfma_f32_16x16x32_bf16 v[100:103],a[24:27],v[108:111],v[100:103]
buffer_store_dwordx4 v[68:71],v0,s[8:11],s65 offen offset:1024 sc1
s_waitcnt lgkmcnt(2)
v_mfma_f32_16x16x32_bf16 v[88:91],a[20:23],v[112:115],v[88:91]
ds_read_b128 v[104:107],v5 offset:8192
v_mfma_f32_16x16x32_bf16 v[92:95],a[20:23],v[116:119],v[92:95]
v_mfma_f32_16x16x32_bf16 v[96:99],a[28:31],v[112:115],v[96:99]
ds_read_b128 v[108:111],v5 offset:12288
v_mfma_f32_16x16x32_bf16 v[100:103],a[28:31],v[116:119],v[100:103]
s_waitcnt lgkmcnt(2)
v_mfma_f32_16x16x32_bf16 v[88:91],a[32:35],v[120:123],v[88:91]
ds_read_b128 v[112:115],v6 offset:8192
v_mfma_f32_16x16x32_bf16 v[92:95],a[32:35],v[124:127],v[92:95]
v_mfma_f32_16x16x32_bf16 v[96:99],a[40:43],v[120:123],v[96:99]
ds_read_b128 v[116:119],v6 offset:12288
v_mfma_f32_16x16x32_bf16 v[100:103],a[40:43],v[124:127],v[100:103]
s_waitcnt lgkmcnt(2)
v_mfma_f32_16x16x32_bf16 v[88:91],a[36:39],v[104:107],v[88:91]
ds_read_b128 v[120:123],v7 offset:8192
v_mfma_f32_16x16x32_bf16 v[92:95],a[36:39],v[108:111],v[92:95]
s_lshl_b32 s56,s54,13
v_mfma_f32_16x16x32_bf16 v[96:99],a[44:47],v[104:107],v[96:99]
ds_read_b128 v[124:127],v7 offset:12288
v_mfma_f32_16x16x32_bf16 v[100:103],a[44:47],v[108:111],v[100:103]
s_add_u32 s56,s56,10487552
s_waitcnt lgkmcnt(2)
v_mfma_f32_16x16x32_bf16 v[88:91],a[48:51],v[112:115],v[88:91]
ds_read_b128 v[104:107],v4 offset:16384
v_mfma_f32_16x16x32_bf16 v[92:95],a[48:51],v[116:119],v[92:95]
s_or_b32 s56,s56,s52
v_mfma_f32_16x16x32_bf16 v[96:99],a[56:59],v[112:115],v[96:99]
ds_read_b128 v[108:111],v4 offset:20480
v_mfma_f32_16x16x32_bf16 v[100:103],a[56:59],v[116:119],v[100:103]
buffer_load_dword v76,v23,s[8:11],s56 offen sc1
s_waitcnt lgkmcnt(2)
v_mfma_f32_16x16x32_bf16 v[88:91],a[52:55],v[120:123],v[88:91]
ds_read_b128 v[112:115],v5 offset:16384
v_mfma_f32_16x16x32_bf16 v[92:95],a[52:55],v[124:127],v[92:95]
v_mfma_f32_16x16x32_bf16 v[96:99],a[60:63],v[120:123],v[96:99]
ds_read_b128 v[116:119],v5 offset:20480
v_mfma_f32_16x16x32_bf16 v[100:103],a[60:63],v[124:127],v[100:103]
s_waitcnt lgkmcnt(2)
v_mfma_f32_16x16x32_bf16 v[88:91],a[64:67],v[104:107],v[88:91]
ds_read_b128 v[120:123],v6 offset:16384
v_mfma_f32_16x16x32_bf16 v[92:95],a[64:67],v[108:111],v[92:95]
v_mfma_f32_16x16x32_bf16 v[96:99],a[72:75],v[104:107],v[96:99]
ds_read_b128 v[124:127],v6 offset:20480
v_mfma_f32_16x16x32_bf16 v[100:103],a[72:75],v[108:111],v[100:103]
s_waitcnt lgkmcnt(2)
v_mfma_f32_16x16x32_bf16 v[88:91],a[68:71],v[112:115],v[88:91]
ds_read_b128 v[104:107],v7 offset:16384
v_mfma_f32_16x16x32_bf16 v[92:95],a[68:71],v[116:119],v[92:95]
v_mfma_f32_16x16x32_bf16 v[96:99],a[76:79],v[112:115],v[96:99]
ds_read_b128 v[108:111],v7 offset:20480
v_mfma_f32_16x16x32_bf16 v[100:103],a[76:79],v[116:119],v[100:103]
s_waitcnt lgkmcnt(2)
v_mfma_f32_16x16x32_bf16 v[88:91],a[80:83],v[120:123],v[88:91]
ds_read_b128 v[112:115],v4 offset:24576
v_mfma_f32_16x16x32_bf16 v[92:95],a[80:83],v[124:127],v[92:95]
v_mfma_f32_16x16x32_bf16 v[96:99],a[88:91],v[120:123],v[96:99]
ds_read_b128 v[116:119],v4 offset:28672
v_mfma_f32_16x16x32_bf16 v[100:103],a[88:91],v[124:127],v[100:103]
s_waitcnt lgkmcnt(2)
v_mfma_f32_16x16x32_bf16 v[88:91],a[84:87],v[104:107],v[88:91]
ds_read_b128 v[120:123],v5 offset:24576
v_mfma_f32_16x16x32_bf16 v[92:95],a[84:87],v[108:111],v[92:95]
v_mfma_f32_16x16x32_bf16 v[96:99],a[92:95],v[104:107],v[96:99]
ds_read_b128 v[124:127],v5 offset:28672
v_mfma_f32_16x16x32_bf16 v[100:103],a[92:95],v[108:111],v[100:103]
s_waitcnt lgkmcnt(2)
v_mfma_f32_16x16x32_bf16 v[88:91],a[96:99],v[112:115],v[88:91]
ds_read_b128 v[104:107],v6 offset:24576
v_mfma_f32_16x16x32_bf16 v[92:95],a[96:99],v[116:119],v[92:95]
v_mfma_f32_16x16x32_bf16 v[96:99],a[104:107],v[112:115],v[96:99]
ds_read_b128 v[108:111],v6 offset:28672
v_mfma_f32_16x16x32_bf16 v[100:103],a[104:107],v[116:119],v[100:103]
s_waitcnt lgkmcnt(2)
v_mfma_f32_16x16x32_bf16 v[88:91],a[100:103],v[120:123],v[88:91]
ds_read_b128 v[112:115],v7 offset:24576
v_mfma_f32_16x16x32_bf16 v[92:95],a[100:103],v[124:127],v[92:95]
v_mfma_f32_16x16x32_bf16 v[96:99],a[108:111],v[120:123],v[96:99]
ds_read_b128 v[116:119],v7 offset:28672
v_mfma_f32_16x16x32_bf16 v[100:103],a[108:111],v[124:127],v[100:103]
s_waitcnt lgkmcnt(2)
v_mfma_f32_16x16x32_bf16 v[88:91],a[112:115],v[104:107],v[88:91]
v_mfma_f32_16x16x32_bf16 v[92:95],a[112:115],v[108:111],v[92:95]
v_mfma_f32_16x16x32_bf16 v[96:99],a[120:123],v[104:107],v[96:99]
v_mfma_f32_16x16x32_bf16 v[100:103],a[120:123],v[108:111],v[100:103]
s_waitcnt lgkmcnt(0)
v_mfma_f32_16x16x32_bf16 v[88:91],a[116:119],v[112:115],v[88:91]
v_mfma_f32_16x16x32_bf16 v[92:95],a[116:119],v[116:119],v[92:95]
v_mfma_f32_16x16x32_bf16 v[96:99],a[124:127],v[112:115],v[96:99]
v_mfma_f32_16x16x32_bf16 v[100:103],a[124:127],v[116:119],v[100:103]
s_nop 3
v_cvt_pk_bf16_f32 v104,v88,v96
v_cvt_pk_bf16_f32 v105,v89,v97
v_cvt_pk_bf16_f32 v106,v90,v98
v_cvt_pk_bf16_f32 v107,v91,v99
v_cvt_pk_bf16_f32 v108,v92,v100
v_cvt_pk_bf16_f32 v109,v93,v101
v_cvt_pk_bf16_f32 v110,v94,v102
v_cvt_pk_bf16_f32 v111,v95,v103
buffer_store_dwordx4 v[104:107],v0,s[8:11],s63 offen sc1
buffer_store_dwordx4 v[108:111],v0,s[8:11],s64 offen sc1
s_lshl_b32 s59,s51,13
s_lshl2_add_u32 s59,s47,s59
s_add_u32 s59,s59,10485888
s_waitcnt vmcnt(3)
s_barrier
s_or_b32 s59,s59,s52
buffer_store_dword v17,off,s[8:11],s59 sc1
s_mov_b32 s77,1
s_lshl_b32 s70,s51,13
s_lshl2_add_u32 s70,s47,s70
s_add_u32 s70,s70,10486144
s_branch L_p_15
L_p_14:
s_mov_b32 s75,s74
s_xor_b32 s74,s74,32768
v_xor_b32 v4,32768,v4
v_xor_b32 v5,32768,v5
v_xor_b32 v6,32768,v6
v_xor_b32 v7,32768,v7
ds_read_b128 v[104:107],v4 offset:0
ds_read_b128 v[108:111],v4 offset:4096
ds_read_b128 v[112:115],v5 offset:0
ds_read_b128 v[116:119],v5 offset:4096
s_waitcnt lgkmcnt(2)
v_mfma_f32_16x16x32_bf16 v[24:27],a[128:131],v[104:107],0
ds_read_b128 v[120:123],v6 offset:0
v_mfma_f32_16x16x32_bf16 v[40:43],v[104:107],v[128:131],0
s_lshl_b32 s58,s51,5
v_mfma_f32_16x16x32_bf16 v[28:31],a[128:131],v[108:111],0
ds_read_b128 v[124:127],v6 offset:4096
v_mfma_f32_16x16x32_bf16 v[44:47],v[108:111],v[128:131],0
s_add_u32 s58,s58,s47
v_mfma_f32_16x16x32_bf16 v[32:35],a[136:139],v[104:107],0
s_mul_i32 s58,s58,24576
v_mfma_f32_16x16x32_bf16 v[48:51],v[104:107],v[136:139],0
s_add_u32 s58,s58,150994944
v_mfma_f32_16x16x32_bf16 v[36:39],a[136:139],v[108:111],0
s_add_u32 s61,s58,s50
v_mfma_f32_16x16x32_bf16 v[52:55],v[108:111],v[136:139],0
s_add_u32 s62,s61,4096
s_waitcnt lgkmcnt(2)
v_mfma_f32_16x16x32_bf16 v[24:27],a[132:135],v[112:115],v[24:27]
ds_read_b128 v[104:107],v7 offset:0
v_mfma_f32_16x16x32_bf16 v[40:43],v[112:115],v[132:135],v[40:43]
s_add_u32 s63,s61,16384
v_mfma_f32_16x16x32_bf16 v[28:31],a[132:135],v[116:119],v[28:31]
ds_read_b128 v[108:111],v7 offset:4096
v_mfma_f32_16x16x32_bf16 v[44:47],v[116:119],v[132:135],v[44:47]
s_add_u32 s64,s61,20480
v_mfma_f32_16x16x32_bf16 v[32:35],a[140:143],v[112:115],v[32:35]
s_add_u32 s65,s61,s50
v_mfma_f32_16x16x32_bf16 v[48:51],v[112:115],v[140:143],v[48:51]
s_add_u32 s65,s65,8192
v_mfma_f32_16x16x32_bf16 v[36:39],a[140:143],v[116:119],v[36:39]
v_mfma_f32_16x16x32_bf16 v[52:55],v[116:119],v[140:143],v[52:55]
s_waitcnt lgkmcnt(2)
v_mfma_f32_16x16x32_bf16 v[24:27],a[144:147],v[120:123],v[24:27]
ds_read_b128 v[112:115],v4 offset:8192
v_mfma_f32_16x16x32_bf16 v[40:43],v[120:123],v[144:147],v[40:43]
v_mfma_f32_16x16x32_bf16 v[28:31],a[144:147],v[124:127],v[28:31]
ds_read_b128 v[116:119],v4 offset:12288
v_mfma_f32_16x16x32_bf16 v[44:47],v[124:127],v[144:147],v[44:47]
v_mfma_f32_16x16x32_bf16 v[32:35],a[152:155],v[120:123],v[32:35]
v_mfma_f32_16x16x32_bf16 v[48:51],v[120:123],v[152:155],v[48:51]
v_mfma_f32_16x16x32_bf16 v[36:39],a[152:155],v[124:127],v[36:39]
v_mfma_f32_16x16x32_bf16 v[52:55],v[124:127],v[152:155],v[52:55]
s_waitcnt lgkmcnt(2)
v_mfma_f32_16x16x32_bf16 v[24:27],a[148:151],v[104:107],v[24:27]
ds_read_b128 v[120:123],v5 offset:8192
v_mfma_f32_16x16x32_bf16 v[40:43],v[104:107],v[148:151],v[40:43]
v_mfma_f32_16x16x32_bf16 v[28:31],a[148:151],v[108:111],v[28:31]
ds_read_b128 v[124:127],v5 offset:12288
v_mfma_f32_16x16x32_bf16 v[44:47],v[108:111],v[148:151],v[44:47]
v_mfma_f32_16x16x32_bf16 v[32:35],a[156:159],v[104:107],v[32:35]
v_mfma_f32_16x16x32_bf16 v[48:51],v[104:107],v[156:159],v[48:51]
v_mfma_f32_16x16x32_bf16 v[36:39],a[156:159],v[108:111],v[36:39]
v_mfma_f32_16x16x32_bf16 v[52:55],v[108:111],v[156:159],v[52:55]
s_waitcnt lgkmcnt(2)
v_mfma_f32_16x16x32_bf16 v[24:27],a[160:163],v[112:115],v[24:27]
ds_read_b128 v[104:107],v6 offset:8192
v_mfma_f32_16x16x32_bf16 v[40:43],v[112:115],v[160:163],v[40:43]
v_mfma_f32_16x16x32_bf16 v[28:31],a[160:163],v[116:119],v[28:31]
ds_read_b128 v[108:111],v6 offset:12288
v_mfma_f32_16x16x32_bf16 v[44:47],v[116:119],v[160:163],v[44:47]
v_mfma_f32_16x16x32_bf16 v[32:35],a[168:171],v[112:115],v[32:35]
v_mfma_f32_16x16x32_bf16 v[48:51],v[112:115],v[168:171],v[48:51]
v_mfma_f32_16x16x32_bf16 v[36:39],a[168:171],v[116:119],v[36:39]
v_mfma_f32_16x16x32_bf16 v[52:55],v[116:119],v[168:171],v[52:55]
s_waitcnt lgkmcnt(2)
v_mfma_f32_16x16x32_bf16 v[24:27],a[164:167],v[120:123],v[24:27]
ds_read_b128 v[112:115],v7 offset:8192
v_mfma_f32_16x16x32_bf16 v[40:43],v[120:123],v[164:167],v[40:43]
s_lshl_b32 s56,s54,13
v_mfma_f32_16x16x32_bf16 v[28:31],a[164:167],v[124:127],v[28:31]
ds_read_b128 v[116:119],v7 offset:12288
v_mfma_f32_16x16x32_bf16 v[44:47],v[124:127],v[164:167],v[44:47]
s_add_u32 s56,s56,10487552
v_mfma_f32_16x16x32_bf16 v[32:35],a[172:175],v[120:123],v[32:35]
s_or_b32 s56,s56,s52
v_mfma_f32_16x16x32_bf16 v[48:51],v[120:123],v[172:175],v[48:51]
buffer_load_dword v76,v23,s[8:11],s56 offen sc1
v_mfma_f32_16x16x32_bf16 v[36:39],a[172:175],v[124:127],v[36:39]
v_mfma_f32_16x16x32_bf16 v[52:55],v[124:127],v[172:175],v[52:55]
s_waitcnt lgkmcnt(2)
v_mfma_f32_16x16x32_bf16 v[24:27],a[176:179],v[104:107],v[24:27]
ds_read_b128 v[120:123],v4 offset:16384
v_mfma_f32_16x16x32_bf16 v[40:43],v[104:107],v[176:179],v[40:43]
v_mfma_f32_16x16x32_bf16 v[28:31],a[176:179],v[108:111],v[28:31]
ds_read_b128 v[124:127],v4 offset:20480
v_mfma_f32_16x16x32_bf16 v[44:47],v[108:111],v[176:179],v[44:47]
v_mfma_f32_16x16x32_bf16 v[32:35],a[184:187],v[104:107],v[32:35]
v_mfma_f32_16x16x32_bf16 v[48:51],v[104:107],v[184:187],v[48:51]
v_mfma_f32_16x16x32_bf16 v[36:39],a[184:187],v[108:111],v[36:39]
v_mfma_f32_16x16x32_bf16 v[52:55],v[108:111],v[184:187],v[52:55]
s_waitcnt lgkmcnt(2)
v_mfma_f32_16x16x32_bf16 v[24:27],a[180:183],v[112:115],v[24:27]
ds_read_b128 v[104:107],v5 offset:16384
v_mfma_f32_16x16x32_bf16 v[40:43],v[112:115],v[180:183],v[40:43]
v_mfma_f32_16x16x32_bf16 v[28:31],a[180:183],v[116:119],v[28:31]
ds_read_b128 v[108:111],v5 offset:20480
v_mfma_f32_16x16x32_bf16 v[44:47],v[116:119],v[180:183],v[44:47]
v_mfma_f32_16x16x32_bf16 v[32:35],a[188:191],v[112:115],v[32:35]
v_mfma_f32_16x16x32_bf16 v[48:51],v[112:115],v[188:191],v[48:51]
v_mfma_f32_16x16x32_bf16 v[36:39],a[188:191],v[116:119],v[36:39]
v_mfma_f32_16x16x32_bf16 v[52:55],v[116:119],v[188:191],v[52:55]
s_waitcnt lgkmcnt(2)
v_mfma_f32_16x16x32_bf16 v[24:27],a[192:195],v[120:123],v[24:27]
ds_read_b128 v[112:115],v6 offset:16384
v_mfma_f32_16x16x32_bf16 v[40:43],v[120:123],v[192:195],v[40:43]
v_mfma_f32_16x16x32_bf16 v[28:31],a[192:195],v[124:127],v[28:31]
ds_read_b128 v[116:119],v6 offset:20480
v_mfma_f32_16x16x32_bf16 v[44:47],v[124:127],v[192:195],v[44:47]
v_mfma_f32_16x16x32_bf16 v[32:35],a[200:203],v[120:123],v[32:35]
v_mfma_f32_16x16x32_bf16 v[48:51],v[120:123],v[200:203],v[48:51]
v_mfma_f32_16x16x32_bf16 v[36:39],a[200:203],v[124:127],v[36:39]
v_mfma_f32_16x16x32_bf16 v[52:55],v[124:127],v[200:203],v[52:55]
s_waitcnt lgkmcnt(2)
v_mfma_f32_16x16x32_bf16 v[24:27],a[196:199],v[104:107],v[24:27]
ds_read_b128 v[120:123],v7 offset:16384
v_mfma_f32_16x16x32_bf16 v[40:43],v[104:107],v[196:199],v[40:43]
s_waitcnt vmcnt(0)
v_mfma_f32_16x16x32_bf16 v[28:31],a[196:199],v[108:111],v[28:31]
ds_read_b128 v[124:127],v7 offset:20480
v_mfma_f32_16x16x32_bf16 v[44:47],v[108:111],v[196:199],v[44:47]
v_cmp_eq_u32 vcc,0,v76
v_mfma_f32_16x16x32_bf16 v[32:35],a[204:207],v[104:107],v[32:35]
s_nop 0
v_mov_b32 v76,vcc_lo
v_mfma_f32_16x16x32_bf16 v[48:51],v[104:107],v[204:207],v[48:51]
ds_write_b32 v19,v76
v_mfma_f32_16x16x32_bf16 v[36:39],a[204:207],v[108:111],v[36:39]
v_mfma_f32_16x16x32_bf16 v[52:55],v[108:111],v[204:207],v[52:55]
s_waitcnt vmcnt(0) lgkmcnt(0)
s_barrier
s_or_b32 s70,s70,s52
buffer_store_dword v17,off,s[8:11],s70 sc1
ds_read_b32 v76,v16
v_mfma_f32_16x16x32_bf16 v[24:27],a[208:211],v[112:115],v[24:27]
ds_read_b128 v[104:107],v4 offset:24576
v_mfma_f32_16x16x32_bf16 v[40:43],v[112:115],v[208:211],v[40:43]
s_lshl_b32 s56,s51,5
s_add_u32 s56,s56,s47
s_lshl_b32 s56,s56,12
v_mfma_f32_16x16x32_bf16 v[28:31],a[208:211],v[116:119],v[28:31]
ds_read_b128 v[108:111],v4 offset:28672
v_mfma_f32_16x16x32_bf16 v[44:47],v[116:119],v[208:211],v[44:47]
s_add_u32 s56,s56,s50
s_add_u32 s56,s56,58720256
v_mfma_f32_16x16x32_bf16 v[32:35],a[216:219],v[112:115],v[32:35]
v_mov_b64 v[72:73],-1
v_mov_b64 v[74:75],-1
v_mfma_f32_16x16x32_bf16 v[48:51],v[112:115],v[216:219],v[48:51]
buffer_store_dwordx4 v[72:75],v0,s[8:11],s56 offen sc1
v_mfma_f32_16x16x32_bf16 v[36:39],a[216:219],v[116:119],v[36:39]
s_add_u32 s56,s56,16777216
v_mfma_f32_16x16x32_bf16 v[52:55],v[116:119],v[216:219],v[52:55]
buffer_store_dwordx4 v[72:75],v0,s[8:11],s56 offen sc1
s_waitcnt lgkmcnt(2)
v_mfma_f32_16x16x32_bf16 v[24:27],a[212:215],v[120:123],v[24:27]
ds_read_b128 v[112:115],v5 offset:24576
v_mfma_f32_16x16x32_bf16 v[40:43],v[120:123],v[212:215],v[40:43]
v_readfirstlane_b32 s57,v76
v_mfma_f32_16x16x32_bf16 v[28:31],a[212:215],v[124:127],v[28:31]
ds_read_b128 v[116:119],v5 offset:28672
v_mfma_f32_16x16x32_bf16 v[44:47],v[124:127],v[212:215],v[44:47]
s_sub_u32 s59,s55,s54
s_cmp_lt_i32 s59,44
s_cselect_b32 s76,2,0
v_mfma_f32_16x16x32_bf16 v[32:35],a[220:223],v[120:123],v[32:35]
s_cmp_gt_i32 s53,0
s_cselect_b32 s76,s76,0
v_mfma_f32_16x16x32_bf16 v[48:51],v[120:123],v[220:223],v[48:51]
s_cmp_eq_u32 s57,0
s_cselect_b32 s76,1,s76
v_mfma_f32_16x16x32_bf16 v[36:39],a[220:223],v[124:127],v[36:39]
s_cmp_lt_i32 s59,12
s_cselect_b32 s76,2,s76
s_add_u32 s57,s54,64
v_mfma_f32_16x16x32_bf16 v[52:55],v[124:127],v[220:223],v[52:55]
s_cmp_eq_u32 s76,1
s_cselect_b32 s68,s57,s55
s_lshl_b32 s68,s68,15
s_waitcnt lgkmcnt(2)
v_mfma_f32_16x16x32_bf16 v[24:27],a[224:227],v[104:107],v[24:27]
ds_read_b128 v[120:123],v6 offset:24576
v_mfma_f32_16x16x32_bf16 v[40:43],v[104:107],v[224:227],v[40:43]
s_cmp_eq_u32 s76,0
s_cselect_b32 s68,0x80000000,s68
s_add_u32 s69,s68,16384
v_mfma_f32_16x16x32_bf16 v[28:31],a[224:227],v[108:111],v[28:31]
ds_read_b128 v[124:127],v6 offset:28672
v_mfma_f32_16x16x32_bf16 v[44:47],v[108:111],v[224:227],v[44:47]
s_add_u32 m0,s75,65536
v_mfma_f32_16x16x32_bf16 v[32:35],a[232:235],v[104:107],v[32:35]
buffer_load_dwordx4 v20,s[8:11],s68 offen offset:0 sc1 lds
v_mfma_f32_16x16x32_bf16 v[48:51],v[104:107],v[232:235],v[48:51]
s_add_u32 m0,s75,69632
v_mfma_f32_16x16x32_bf16 v[36:39],a[232:235],v[108:111],v[36:39]
buffer_load_dwordx4 v20,s[8:11],s69 offen offset:0 sc1 lds
v_mfma_f32_16x16x32_bf16 v[52:55],v[108:111],v[232:235],v[52:55]
s_add_u32 m0,s75,73472
s_waitcnt lgkmcnt(2)
v_mfma_f32_16x16x32_bf16 v[24:27],a[228:231],v[112:115],v[24:27]
ds_read_b128 v[104:107],v7 offset:24576
v_mfma_f32_16x16x32_bf16 v[40:43],v[112:115],v[228:231],v[40:43]
buffer_load_dwordx4 v20,s[8:11],s68 offen offset:256 sc1 lds
v_mfma_f32_16x16x32_bf16 v[28:31],a[228:231],v[116:119],v[28:31]
ds_read_b128 v[108:111],v7 offset:28672
v_mfma_f32_16x16x32_bf16 v[44:47],v[116:119],v[228:231],v[44:47]
s_add_u32 m0,s75,77568
v_mfma_f32_16x16x32_bf16 v[32:35],a[236:239],v[112:115],v[32:35]
buffer_load_dwordx4 v20,s[8:11],s69 offen offset:256 sc1 lds
v_mfma_f32_16x16x32_bf16 v[48:51],v[112:115],v[236:239],v[48:51]
s_add_u32 m0,s75,81408
v_mfma_f32_16x16x32_bf16 v[36:39],a[236:239],v[116:119],v[36:39]
buffer_load_dwordx4 v20,s[8:11],s68 offen offset:512 sc1 lds
v_mfma_f32_16x16x32_bf16 v[52:55],v[116:119],v[236:239],v[52:55]
s_add_u32 m0,s75,85504
s_waitcnt lgkmcnt(2)
v_mfma_f32_16x16x32_bf16 v[24:27],a[240:243],v[120:123],v[24:27]
ds_read_b128 v[112:115],v4 offset:0
v_mfma_f32_16x16x32_bf16 v[40:43],v[120:123],v[240:243],v[40:43]
buffer_load_dwordx4 v20,s[8:11],s69 offen offset:512 sc1 lds
v_mfma_f32_16x16x32_bf16 v[28:31],a[240:243],v[124:127],v[28:31]
ds_read_b128 v[116:119],v4 offset:4096
v_mfma_f32_16x16x32_bf16 v[44:47],v[124:127],v[240:243],v[44:47]
s_add_u32 m0,s75,89344
v_mfma_f32_16x16x32_bf16 v[32:35],a[248:251],v[120:123],v[32:35]
buffer_load_dwordx4 v20,s[8:11],s68 offen offset:768 sc1 lds
v_mfma_f32_16x16x32_bf16 v[48:51],v[120:123],v[248:251],v[48:51]
s_add_u32 m0,s75,93440
v_mfma_f32_16x16x32_bf16 v[36:39],a[248:251],v[124:127],v[36:39]
buffer_load_dwordx4 v20,s[8:11],s69 offen offset:768 sc1 lds
v_mfma_f32_16x16x32_bf16 v[52:55],v[124:127],v[248:251],v[52:55]
s_waitcnt lgkmcnt(2)
v_mfma_f32_16x16x32_bf16 v[24:27],a[244:247],v[104:107],v[24:27]
ds_read_b128 v[120:123],v5 offset:0
v_mfma_f32_16x16x32_bf16 v[40:43],v[104:107],v[244:247],v[40:43]
v_mfma_f32_16x16x32_bf16 v[28:31],a[244:247],v[108:111],v[28:31]
ds_read_b128 v[124:127],v5 offset:4096
v_mfma_f32_16x16x32_bf16 v[44:47],v[108:111],v[244:247],v[44:47]
v_mfma_f32_16x16x32_bf16 v[32:35],a[252:255],v[104:107],v[32:35]
v_mfma_f32_16x16x32_bf16 v[48:51],v[104:107],v[252:255],v[48:51]
v_mfma_f32_16x16x32_bf16 v[36:39],a[252:255],v[108:111],v[36:39]
v_mfma_f32_16x16x32_bf16 v[52:55],v[108:111],v[252:255],v[52:55]
s_waitcnt lgkmcnt(2)
v_mfma_f32_16x16x32_bf16 v[88:91],a[0:3],v[112:115],0
ds_read_b128 v[104:107],v6 offset:0
v_mfma_f32_16x16x32_bf16 v[92:95],a[0:3],v[116:119],0
v_mfma_f32_16x16x32_bf16 v[96:99],a[8:11],v[112:115],0
ds_read_b128 v[108:111],v6 offset:4096
v_cvt_pk_bf16_f32 v56,v24,v32
v_cvt_pk_bf16_f32 v57,v25,v33
v_mfma_f32_16x16x32_bf16 v[100:103],a[8:11],v[116:119],0
v_cvt_pk_bf16_f32 v58,v26,v34
v_cvt_pk_bf16_f32 v59,v27,v35
s_waitcnt lgkmcnt(2)
v_mfma_f32_16x16x32_bf16 v[88:91],a[4:7],v[120:123],v[88:91]
ds_read_b128 v[112:115],v7 offset:0
v_mfma_f32_16x16x32_bf16 v[92:95],a[4:7],v[124:127],v[92:95]
buffer_store_dwordx4 v[56:59],v0,s[8:11],s61 offen sc1
v_cvt_pk_bf16_f32 v60,v28,v36
v_cvt_pk_bf16_f32 v61,v29,v37
v_mfma_f32_16x16x32_bf16 v[96:99],a[12:15],v[120:123],v[96:99]
ds_read_b128 v[116:119],v7 offset:4096
v_cvt_pk_bf16_f32 v62,v30,v38
v_cvt_pk_bf16_f32 v63,v31,v39
v_mfma_f32_16x16x32_bf16 v[100:103],a[12:15],v[124:127],v[100:103]
buffer_store_dwordx4 v[60:63],v0,s[8:11],s62 offen sc1
v_cvt_pk_bf16_f32 v64,v40,v41
v_cvt_pk_bf16_f32 v65,v42,v43
s_waitcnt lgkmcnt(2)
v_mfma_f32_16x16x32_bf16 v[88:91],a[16:19],v[104:107],v[88:91]
ds_read_b128 v[120:123],v4 offset:8192
v_cvt_pk_bf16_f32 v66,v44,v45
v_cvt_pk_bf16_f32 v67,v46,v47
v_mfma_f32_16x16x32_bf16 v[92:95],a[16:19],v[108:111],v[92:95]
buffer_store_dwordx4 v[64:67],v0,s[8:11],s65 offen offset:0 sc1
v_cvt_pk_bf16_f32 v68,v48,v49
v_cvt_pk_bf16_f32 v69,v50,v51
v_mfma_f32_16x16x32_bf16 v[96:99],a[24:27],v[104:107],v[96:99]
ds_read_b128 v[124:127],v4 offset:12288
v_cvt_pk_bf16_f32 v70,v52,v53
v_cvt_pk_bf16_f32 v71,v54,v55
v_mfma_f32_16x16x32_bf16 v[100:103],a[24:27],v[108:111],v[100:103]
buffer_store_dwordx4 v[68:71],v0,s[8:11],s65 offen offset:1024 sc1
s_waitcnt lgkmcnt(2)
v_mfma_f32_16x16x32_bf16 v[88:91],a[20:23],v[112:115],v[88:91]
ds_read_b128 v[104:107],v5 offset:8192
v_mfma_f32_16x16x32_bf16 v[92:95],a[20:23],v[116:119],v[92:95]
v_mfma_f32_16x16x32_bf16 v[96:99],a[28:31],v[112:115],v[96:99]
ds_read_b128 v[108:111],v5 offset:12288
v_mfma_f32_16x16x32_bf16 v[100:103],a[28:31],v[116:119],v[100:103]
s_waitcnt lgkmcnt(2)
v_mfma_f32_16x16x32_bf16 v[88:91],a[32:35],v[120:123],v[88:91]
ds_read_b128 v[112:115],v6 offset:8192
v_mfma_f32_16x16x32_bf16 v[92:95],a[32:35],v[124:127],v[92:95]
v_mfma_f32_16x16x32_bf16 v[96:99],a[40:43],v[120:123],v[96:99]
ds_read_b128 v[116:119],v6 offset:12288
v_mfma_f32_16x16x32_bf16 v[100:103],a[40:43],v[124:127],v[100:103]
s_waitcnt lgkmcnt(2)
v_mfma_f32_16x16x32_bf16 v[88:91],a[36:39],v[104:107],v[88:91]
ds_read_b128 v[120:123],v7 offset:8192
v_mfma_f32_16x16x32_bf16 v[92:95],a[36:39],v[108:111],v[92:95]
s_lshl_b32 s56,s54,13
v_mfma_f32_16x16x32_bf16 v[96:99],a[44:47],v[104:107],v[96:99]
ds_read_b128 v[124:127],v7 offset:12288
v_mfma_f32_16x16x32_bf16 v[100:103],a[44:47],v[108:111],v[100:103]
s_add_u32 s56,s56,10487552
s_waitcnt lgkmcnt(2)
v_mfma_f32_16x16x32_bf16 v[88:91],a[48:51],v[112:115],v[88:91]
ds_read_b128 v[104:107],v4 offset:16384
v_mfma_f32_16x16x32_bf16 v[92:95],a[48:51],v[116:119],v[92:95]
s_or_b32 s56,s56,s52
v_mfma_f32_16x16x32_bf16 v[96:99],a[56:59],v[112:115],v[96:99]
ds_read_b128 v[108:111],v4 offset:20480
v_mfma_f32_16x16x32_bf16 v[100:103],a[56:59],v[116:119],v[100:103]
buffer_load_dword v76,v23,s[8:11],s56 offen sc1
s_waitcnt lgkmcnt(2)
v_mfma_f32_16x16x32_bf16 v[88:91],a[52:55],v[120:123],v[88:91]
ds_read_b128 v[112:115],v5 offset:16384
v_mfma_f32_16x16x32_bf16 v[92:95],a[52:55],v[124:127],v[92:95]
v_mfma_f32_16x16x32_bf16 v[96:99],a[60:63],v[120:123],v[96:99]
ds_read_b128 v[116:119],v5 offset:20480
v_mfma_f32_16x16x32_bf16 v[100:103],a[60:63],v[124:127],v[100:103]
s_waitcnt lgkmcnt(2)
v_mfma_f32_16x16x32_bf16 v[88:91],a[64:67],v[104:107],v[88:91]
ds_read_b128 v[120:123],v6 offset:16384
v_mfma_f32_16x16x32_bf16 v[92:95],a[64:67],v[108:111],v[92:95]
v_mfma_f32_16x16x32_bf16 v[96:99],a[72:75],v[104:107],v[96:99]
ds_read_b128 v[124:127],v6 offset:20480
v_mfma_f32_16x16x32_bf16 v[100:103],a[72:75],v[108:111],v[100:103]
s_waitcnt lgkmcnt(2)
v_mfma_f32_16x16x32_bf16 v[88:91],a[68:71],v[112:115],v[88:91]
ds_read_b128 v[104:107],v7 offset:16384
v_mfma_f32_16x16x32_bf16 v[92:95],a[68:71],v[116:119],v[92:95]
v_mfma_f32_16x16x32_bf16 v[96:99],a[76:79],v[112:115],v[96:99]
ds_read_b128 v[108:111],v7 offset:20480
v_mfma_f32_16x16x32_bf16 v[100:103],a[76:79],v[116:119],v[100:103]
s_waitcnt lgkmcnt(2)
v_mfma_f32_16x16x32_bf16 v[88:91],a[80:83],v[120:123],v[88:91]
ds_read_b128 v[112:115],v4 offset:24576
v_mfma_f32_16x16x32_bf16 v[92:95],a[80:83],v[124:127],v[92:95]
v_mfma_f32_16x16x32_bf16 v[96:99],a[88:91],v[120:123],v[96:99]
ds_read_b128 v[116:119],v4 offset:28672
v_mfma_f32_16x16x32_bf16 v[100:103],a[88:91],v[124:127],v[100:103]
s_waitcnt lgkmcnt(2)
v_mfma_f32_16x16x32_bf16 v[88:91],a[84:87],v[104:107],v[88:91]
ds_read_b128 v[120:123],v5 offset:24576
v_mfma_f32_16x16x32_bf16 v[92:95],a[84:87],v[108:111],v[92:95]
v_mfma_f32_16x16x32_bf16 v[96:99],a[92:95],v[104:107],v[96:99]
ds_read_b128 v[124:127],v5 offset:28672
v_mfma_f32_16x16x32_bf16 v[100:103],a[92:95],v[108:111],v[100:103]
s_waitcnt lgkmcnt(2)
v_mfma_f32_16x16x32_bf16 v[88:91],a[96:99],v[112:115],v[88:91]
ds_read_b128 v[104:107],v6 offset:24576
v_mfma_f32_16x16x32_bf16 v[92:95],a[96:99],v[116:119],v[92:95]
v_mfma_f32_16x16x32_bf16 v[96:99],a[104:107],v[112:115],v[96:99]
ds_read_b128 v[108:111],v6 offset:28672
v_mfma_f32_16x16x32_bf16 v[100:103],a[104:107],v[116:119],v[100:103]
s_waitcnt lgkmcnt(2)
v_mfma_f32_16x16x32_bf16 v[88:91],a[100:103],v[120:123],v[88:91]
ds_read_b128 v[112:115],v7 offset:24576
v_mfma_f32_16x16x32_bf16 v[92:95],a[100:103],v[124:127],v[92:95]
v_mfma_f32_16x16x32_bf16 v[96:99],a[108:111],v[120:123],v[96:99]
ds_read_b128 v[116:119],v7 offset:28672
v_mfma_f32_16x16x32_bf16 v[100:103],a[108:111],v[124:127],v[100:103]
s_waitcnt lgkmcnt(2)
v_mfma_f32_16x16x32_bf16 v[88:91],a[112:115],v[104:107],v[88:91]
v_mfma_f32_16x16x32_bf16 v[92:95],a[112:115],v[108:111],v[92:95]
v_mfma_f32_16x16x32_bf16 v[96:99],a[120:123],v[104:107],v[96:99]
v_mfma_f32_16x16x32_bf16 v[100:103],a[120:123],v[108:111],v[100:103]
s_waitcnt lgkmcnt(0)
v_mfma_f32_16x16x32_bf16 v[88:91],a[116:119],v[112:115],v[88:91]
v_mfma_f32_16x16x32_bf16 v[92:95],a[116:119],v[116:119],v[92:95]
v_mfma_f32_16x16x32_bf16 v[96:99],a[124:127],v[112:115],v[96:99]
v_mfma_f32_16x16x32_bf16 v[100:103],a[124:127],v[116:119],v[100:103]
s_nop 3
v_cvt_pk_bf16_f32 v104,v88,v96
v_cvt_pk_bf16_f32 v105,v89,v97
v_cvt_pk_bf16_f32 v106,v90,v98
v_cvt_pk_bf16_f32 v107,v91,v99
v_cvt_pk_bf16_f32 v108,v92,v100
v_cvt_pk_bf16_f32 v109,v93,v101
v_cvt_pk_bf16_f32 v110,v94,v102
v_cvt_pk_bf16_f32 v111,v95,v103
buffer_store_dwordx4 v[104:107],v0,s[8:11],s63 offen sc1
buffer_store_dwordx4 v[108:111],v0,s[8:11],s64 offen sc1
s_lshl_b32 s59,s51,13
s_lshl2_add_u32 s59,s47,s59
s_add_u32 s59,s59,10485888
s_waitcnt vmcnt(3)
s_barrier
s_or_b32 s59,s59,s52
buffer_store_dword v17,off,s[8:11],s59 sc1
s_mov_b32 s77,1
s_lshl_b32 s70,s51,13
s_lshl2_add_u32 s70,s47,s70
s_add_u32 s70,s70,10486144
s_branch L_p_15
L_p_16:
s_endpgm
L_rm_5:
v_and_b32 v33,15,v1
v_lshrrev_b32 v34,4,v1
s_min_u32 s60,s47,27
s_lshl_b32 s60,s60,7
s_mul_i32 s59,s46,458752
s_add_u32 s60,s60,s59
v_mul_u32_u24 v36,114688,v34
v_and_b32 v35,7,v33
v_lshl_add_u32 v36,v35,4,v36
v_add_u32 v36,s60,v36
v_cmp_gt_u32 vcc,8,v33
v_mov_b32 v38,s36
v_mov_b32 v39,s37
v_mov_b32 v40,s34
v_mov_b32 v41,s35
v_cndmask_b32 v38,v38,v40,vcc
v_cndmask_b32 v39,v39,v41,vcc
v_add_co_u32 v38,vcc,v38,v36
s_nop 1
v_addc_co_u32 v39,vcc,0,v39,vcc
s_lshl_b32 s56,s46,15
v_add_u32 v37,s56,v0
global_load_dwordx4 v[44:47],v[38:39],off
v_add_co_u32 v38,vcc,3584,v38
s_nop 1
v_addc_co_u32 v39,vcc,0,v39,vcc
global_load_dwordx4 v[48:51],v[38:39],off
v_add_co_u32 v38,vcc,3584,v38
s_nop 1
v_addc_co_u32 v39,vcc,0,v39,vcc
global_load_dwordx4 v[52:55],v[38:39],off
v_add_co_u32 v38,vcc,3584,v38
s_nop 1
v_addc_co_u32 v39,vcc,0,v39,vcc
global_load_dwordx4 v[56:59],v[38:39],off
v_add_co_u32 v38,vcc,3584,v38
s_nop 1
v_addc_co_u32 v39,vcc,0,v39,vcc
global_load_dwordx4 v[60:63],v[38:39],off
v_add_co_u32 v38,vcc,3584,v38
s_nop 1
v_addc_co_u32 v39,vcc,0,v39,vcc
global_load_dwordx4 v[64:67],v[38:39],off
v_add_co_u32 v38,vcc,3584,v38
s_nop 1
v_addc_co_u32 v39,vcc,0,v39,vcc
global_load_dwordx4 v[68:71],v[38:39],off
v_add_co_u32 v38,vcc,3584,v38
s_nop 1
v_addc_co_u32 v39,vcc,0,v39,vcc
global_load_dwordx4 v[72:75],v[38:39],off
v_add_co_u32 v38,vcc,3584,v38
s_nop 1
v_addc_co_u32 v39,vcc,0,v39,vcc
global_load_dwordx4 v[76:79],v[38:39],off
v_add_co_u32 v38,vcc,3584,v38
s_nop 1
v_addc_co_u32 v39,vcc,0,v39,vcc
global_load_dwordx4 v[80:83],v[38:39],off
v_add_co_u32 v38,vcc,3584,v38
s_nop 1
v_addc_co_u32 v39,vcc,0,v39,vcc
global_load_dwordx4 v[84:87],v[38:39],off
v_add_co_u32 v38,vcc,3584,v38
s_nop 1
v_addc_co_u32 v39,vcc,0,v39,vcc
global_load_dwordx4 v[88:91],v[38:39],off
v_add_co_u32 v38,vcc,3584,v38
s_nop 1
v_addc_co_u32 v39,vcc,0,v39,vcc
global_load_dwordx4 v[92:95],v[38:39],off
v_add_co_u32 v38,vcc,3584,v38
s_nop 1
v_addc_co_u32 v39,vcc,0,v39,vcc
global_load_dwordx4 v[96:99],v[38:39],off
v_add_co_u32 v38,vcc,3584,v38
s_nop 1
v_addc_co_u32 v39,vcc,0,v39,vcc
global_load_dwordx4 v[100:103],v[38:39],off
v_add_co_u32 v38,vcc,3584,v38
s_nop 1
v_addc_co_u32 v39,vcc,0,v39,vcc
global_load_dwordx4 v[104:107],v[38:39],off
v_add_co_u32 v38,vcc,3584,v38
s_nop 1
v_addc_co_u32 v39,vcc,0,v39,vcc
s_waitcnt vmcnt(15)
ds_write_b128 v37,v[44:47] offset:0
s_waitcnt vmcnt(14)
ds_write_b128 v37,v[48:51] offset:1024
s_waitcnt vmcnt(13)
ds_write_b128 v37,v[52:55] offset:2048
s_waitcnt vmcnt(12)
ds_write_b128 v37,v[56:59] offset:3072
s_waitcnt vmcnt(11)
ds_write_b128 v37,v[60:63] offset:4096
s_waitcnt vmcnt(10)
ds_write_b128 v37,v[64:67] offset:5120
s_waitcnt vmcnt(9)
ds_write_b128 v37,v[68:71] offset:6144
s_waitcnt vmcnt(8)
ds_write_b128 v37,v[72:75] offset:7168
s_waitcnt lgkmcnt(0)
s_waitcnt vmcnt(7)
ds_write_b128 v37,v[76:79] offset:8192
s_waitcnt vmcnt(6)
ds_write_b128 v37,v[80:83] offset:9216
s_waitcnt vmcnt(5)
ds_write_b128 v37,v[84:87] offset:10240
s_waitcnt vmcnt(4)
ds_write_b128 v37,v[88:91] offset:11264
s_waitcnt vmcnt(3)
ds_write_b128 v37,v[92:95] offset:12288
s_waitcnt vmcnt(2)
ds_write_b128 v37,v[96:99] offset:13312
s_waitcnt vmcnt(1)
ds_write_b128 v37,v[100:103] offset:14336
s_waitcnt vmcnt(0)
ds_write_b128 v37,v[104:107] offset:15360
s_waitcnt lgkmcnt(0)
global_load_dwordx4 v[44:47],v[38:39],off
v_add_co_u32 v38,vcc,3584,v38
s_nop 1
v_addc_co_u32 v39,vcc,0,v39,vcc
global_load_dwordx4 v[48:51],v[38:39],off
v_add_co_u32 v38,vcc,3584,v38
s_nop 1
v_addc_co_u32 v39,vcc,0,v39,vcc
global_load_dwordx4 v[52:55],v[38:39],off
v_add_co_u32 v38,vcc,3584,v38
s_nop 1
v_addc_co_u32 v39,vcc,0,v39,vcc
global_load_dwordx4 v[56:59],v[38:39],off
v_add_co_u32 v38,vcc,3584,v38
s_nop 1
v_addc_co_u32 v39,vcc,0,v39,vcc
global_load_dwordx4 v[60:63],v[38:39],off
v_add_co_u32 v38,vcc,3584,v38
s_nop 1
v_addc_co_u32 v39,vcc,0,v39,vcc
global_load_dwordx4 v[64:67],v[38:39],off
v_add_co_u32 v38,vcc,3584,v38
s_nop 1
v_addc_co_u32 v39,vcc,0,v39,vcc
global_load_dwordx4 v[68:71],v[38:39],off
v_add_co_u32 v38,vcc,3584,v38
s_nop 1
v_addc_co_u32 v39,vcc,0,v39,vcc
global_load_dwordx4 v[72:75],v[38:39],off
v_add_co_u32 v38,vcc,3584,v38
s_nop 1
v_addc_co_u32 v39,vcc,0,v39,vcc
global_load_dwordx4 v[76:79],v[38:39],off
v_add_co_u32 v38,vcc,3584,v38
s_nop 1
v_addc_co_u32 v39,vcc,0,v39,vcc
global_load_dwordx4 v[80:83],v[38:39],off
v_add_co_u32 v38,vcc,3584,v38
s_nop 1
v_addc_co_u32 v39,vcc,0,v39,vcc
global_load_dwordx4 v[84:87],v[38:39],off
v_add_co_u32 v38,vcc,3584,v38
s_nop 1
v_addc_co_u32 v39,vcc,0,v39,vcc
global_load_dwordx4 v[88:91],v[38:39],off
v_add_co_u32 v38,vcc,3584,v38
s_nop 1
v_addc_co_u32 v39,vcc,0,v39,vcc
global_load_dwordx4 v[92:95],v[38:39],off
v_add_co_u32 v38,vcc,3584,v38
s_nop 1
v_addc_co_u32 v39,vcc,0,v39,vcc
global_load_dwordx4 v[96:99],v[38:39],off
v_add_co_u32 v38,vcc,3584,v38
s_nop 1
v_addc_co_u32 v39,vcc,0,v39,vcc
global_load_dwordx4 v[100:103],v[38:39],off
v_add_co_u32 v38,vcc,3584,v38
s_nop 1
v_addc_co_u32 v39,vcc,0,v39,vcc
global_load_dwordx4 v[104:107],v[38:39],off
v_add_co_u32 v38,vcc,3584,v38
s_nop 1
v_addc_co_u32 v39,vcc,0,v39,vcc
s_waitcnt vmcnt(15)
ds_write_b128 v37,v[44:47] offset:16384
s_waitcnt vmcnt(14)
ds_write_b128 v37,v[48:51] offset:17408
s_waitcnt vmcnt(13)
ds_write_b128 v37,v[52:55] offset:18432
s_waitcnt vmcnt(12)
ds_write_b128 v37,v[56:59] offset:19456
s_waitcnt vmcnt(11)
ds_write_b128 v37,v[60:63] offset:20480
s_waitcnt vmcnt(10)
ds_write_b128 v37,v[64:67] offset:21504
s_waitcnt vmcnt(9)
ds_write_b128 v37,v[68:71] offset:22528
s_waitcnt vmcnt(8)
ds_write_b128 v37,v[72:75] offset:23552
s_waitcnt lgkmcnt(0)
s_waitcnt vmcnt(7)
ds_write_b128 v37,v[76:79] offset:24576
s_waitcnt vmcnt(6)
ds_write_b128 v37,v[80:83] offset:25600
s_waitcnt vmcnt(5)
ds_write_b128 v37,v[84:87] offset:26624
s_waitcnt vmcnt(4)
ds_write_b128 v37,v[88:91] offset:27648
s_waitcnt vmcnt(3)
ds_write_b128 v37,v[92:95] offset:28672
s_waitcnt vmcnt(2)
ds_write_b128 v37,v[96:99] offset:29696
s_waitcnt vmcnt(1)
ds_write_b128 v37,v[100:103] offset:30720
s_waitcnt vmcnt(0)
ds_write_b128 v37,v[104:107] offset:31744
s_waitcnt lgkmcnt(0)
v_mov_b32 v123,159744
s_cmp_lg_u32 s46,0
s_cbranch_scc1 L_gbd_23
v_mov_b32 v124,128
L_gb_22:
buffer_load_dword v125,v124,s[12:15],0 offen sc1
s_waitcnt vmcnt(0)
v_readfirstlane_b32 s56,v125
ds_write_b32 v123,v125
s_bitcmp1_b32 s56,8
s_cbranch_scc1 L_gbd_23
s_sleep 4
s_sub_u32 s49,s49,1
s_cmp_gt_i32 s49,0
s_cbranch_scc1 L_gb_22
s_branch L_abort
L_gbd_23:
s_waitcnt lgkmcnt(0)
s_barrier
ds_read_b32 v125,v123
s_waitcnt lgkmcnt(0)
v_readfirstlane_b32 s56,v125
s_barrier
s_lshr_b32 s56,s56,16
s_andn2_b32 s56,s56,s3
s_cbranch_scc1 L_spread
s_cmp_lg_u32 s3,0
s_cbranch_scc1 L_wm
v_and_b32 v120,15,v1
v_lshrrev_b32 v121,4,v1
v_mov_b32 v17,1
s_lshl_b32 s56,s46,15
v_add_u32 v18,s56,v0
s_lshl_b32 s56,s46,2
v_add_u32 v125,s56,v121
v_xor_b32 v126,v125,v120
v_lshlrev_b32 v126,4,v126
v_lshl_add_u32 v20,v125,10,v126
v_add_u32 v125,0,v121
v_xor_b32 v125,v125,v120
v_lshlrev_b32 v125,4,v125
v_lshl_add_u32 v125,v120,8,v125
v_add_u32 v4,131072,v125
v_add_u32 v125,4,v121
v_xor_b32 v125,v125,v120
v_lshlrev_b32 v125,4,v125
v_lshl_add_u32 v125,v120,8,v125
v_add_u32 v5,131072,v125
v_add_u32 v125,8,v121
v_xor_b32 v125,v125,v120
v_lshlrev_b32 v125,4,v125
v_lshl_add_u32 v125,v120,8,v125
v_add_u32 v6,131072,v125
v_add_u32 v125,12,v121
v_xor_b32 v125,v125,v120
v_lshlrev_b32 v125,4,v125
v_lshl_add_u32 v125,v120,8,v125
v_add_u32 v7,131072,v125
v_lshlrev_b32 v21,5,v120
v_and_b32 v125,1,v121
v_lshl_add_u32 v21,v125,4,v21
s_lshl_b32 s56,s46,9
v_lshrrev_b32 v125,1,v121
v_lshl_add_u32 v21,v125,11,v21
s_add_u32 s56,s56,155648
v_add_u32 v21,s56,v21
v_lshlrev_b32 v22,4,v120
v_lshl_add_u32 v22,v121,10,v22
s_lshl_b32 s56,s46,8
v_add_u32 v22,s56,v22
s_mov_b32 s54,0
s_mov_b32 s31,0
s_mov_b32 s53,6
s_mov_b32 s72,0x80000000
s_mov_b32 s73,0
s_mov_b32 s77,-1
s_mov_b32 s86,0
s_mov_b32 s19,0
s_mov_b32 s74,2675965952
s_mov_b32 s75,613566756
v_and_b32 v23,15,v1
v_lshlrev_b32 v23,3,v23
v_lshrrev_b32 v16,4,v1
v_lshl_add_u32 v23,v16,13,v23
v_mov_b32 v19,159744
v_lshl_add_u32 v16,v16,2,v19
v_and_b32 v9,15,v1
v_lshrrev_b32 v10,4,v1
v_and_b32 v124,1,v1
v_lshlrev_b32 v124,4,v124
v_mov_b32 v125,0xffff
v_lshlrev_b32 v125,v124,v125
v_lshrrev_b32 v124,2,v9
v_cmp_eq_u32 vcc,0,v124
s_nop 1
v_cndmask_b32 v12,0,v125,vcc
v_cmp_eq_u32 vcc,1,v124
s_nop 1
v_cndmask_b32 v13,0,v125,vcc
v_and_b32 v124,2,v1
v_cmp_eq_u32 vcc,0,v124
v_mov_b32 v14,0xeeee
v_mov_b32 v124,0x4444
v_cndmask_b32 v14,v14,v124,vcc
v_lshlrev_b32 v11,14,v10
v_lshl_add_u32 v11,v9,4,v11
s_lshl_b32 s65,s51,15
s_add_u32 s65,s65,92274688
s_lshl_b32 s62,s47,10
s_add_u32 s62,s62,s65
s_lshl_b32 s63,s47,16
s_lshl_b32 s60,s46,8
s_add_u32 s63,s63,s60
s_mov_b32 s4,s38
s_mov_b32 s5,s39
s_mov_b32 s6,1835008
s_mov_b32 s7,0x20000
buffer_load_dwordx4 v[24:27],v11,s[4:7],s63 offen offset:0
buffer_load_dwordx4 v[28:31],v11,s[4:7],s63 offen offset:1024
buffer_load_dwordx4 v[32:35],v11,s[4:7],s63 offen offset:2048
buffer_load_dwordx4 v[36:39],v11,s[4:7],s63 offen offset:3072
s_add_u32 s63,s63,4096
buffer_load_dwordx4 v[40:43],v11,s[4:7],s63 offen offset:0
buffer_load_dwordx4 v[44:47],v11,s[4:7],s63 offen offset:1024
buffer_load_dwordx4 v[48:51],v11,s[4:7],s63 offen offset:2048
buffer_load_dwordx4 v[52:55],v11,s[4:7],s63 offen offset:3072
s_add_u32 s63,s63,4096
buffer_load_dwordx4 v[56:59],v11,s[4:7],s63 offen offset:0
buffer_load_dwordx4 v[60:63],v11,s[4:7],s63 offen offset:1024
buffer_load_dwordx4 v[64:67],v11,s[4:7],s63 offen offset:2048
buffer_load_dwordx4 v[68:71],v11,s[4:7],s63 offen offset:3072
s_add_u32 s63,s63,4096
buffer_load_dwordx4 v[72:75],v11,s[4:7],s63 offen offset:0
buffer_load_dwordx4 v[76:79],v11,s[4:7],s63 offen offset:1024
buffer_load_dwordx4 v[80:83],v11,s[4:7],s63 offen offset:2048
buffer_load_dwordx4 v[84:87],v11,s[4:7],s63 offen offset:3072
s_mov_b32 s4,s32
s_mov_b32 s5,s33
s_mov_b32 s6,1024
s_mov_b32 s7,0x20000
buffer_load_dwordx4 v[88:91],v0,s[4:7],0 offen
s_waitcnt vmcnt(0)
v_lshlrev_b32 v96,16,v88
v_and_b32 v97,0xffff0000,v88
v_lshlrev_b32 v98,16,v89
v_and_b32 v99,0xffff0000,v89
v_lshlrev_b32 v100,16,v90
v_and_b32 v101,0xffff0000,v90
v_lshlrev_b32 v102,16,v91
v_and_b32 v103,0xffff0000,v91
v_mul_f32 v88,v96,v96
v_fma_f32 v88,v97,v97,v88
v_fma_f32 v88,v98,v98,v88
v_fma_f32 v88,v99,v99,v88
v_fma_f32 v88,v100,v100,v88
v_fma_f32 v88,v101,v101,v88
v_fma_f32 v88,v102,v102,v88
v_fma_f32 v88,v103,v103,v88
s_nop 1
v_add_f32_dpp v88,v88,v88 row_ror:8 row_mask:0xf bank_mask:0xf
s_nop 1
v_add_f32_dpp v88,v88,v88 row_ror:4 row_mask:0xf bank_mask:0xf
s_nop 1
v_add_f32_dpp v88,v88,v88 row_ror:2 row_mask:0xf bank_mask:0xf
s_nop 1
v_add_f32_dpp v88,v88,v88 row_ror:1 row_mask:0xf bank_mask:0xf
v_mov_b32 v89,v88
s_nop 1
v_permlane16_swap_b32 v88,v89
v_add_f32 v88,v88,v89
v_mov_b32 v89,v88
s_nop 1
v_permlane32_swap_b32 v88,v89
v_add_f32 v88,v88,v89
v_sqrt_f32 v88,v88
s_nop 0
v_mul_f32 v88,0x40333333,v88
s_nop 0
v_readfirstlane_b32 s25,v88
s_bitset1_b32 s25,31
s_ff1_i32_b64 s30,s[74:75]
s_bitset0_b64 s[74:75],s30
s_min_u32 s30,s30,127
s_lshl_b32 s70,s30,15
s_add_u32 s70,s70,0
s_add_u32 s71,s70,16384
L_mo_27:
s_cmp_lg_u32 s19,0
s_cbranch_scc1 L_mo_28
s_add_u32 m0,s50,131072
s_nop 0
buffer_load_dwordx4 v20,s[8:11],s70 offen offset:0 sc1 lds
s_add_u32 m0,s50,135168
s_nop 0
buffer_load_dwordx4 v20,s[8:11],s71 offen offset:0 sc1 lds
s_add_u32 m0,s50,139008
s_nop 0
buffer_load_dwordx4 v20,s[8:11],s70 offen offset:256 sc1 lds
s_add_u32 m0,s50,143104
s_nop 0
buffer_load_dwordx4 v20,s[8:11],s71 offen offset:256 sc1 lds
s_add_u32 m0,s50,146944
s_nop 0
buffer_load_dwordx4 v20,s[8:11],s70 offen offset:512 sc1 lds
s_add_u32 m0,s50,151040
s_nop 0
buffer_load_dwordx4 v20,s[8:11],s71 offen offset:512 sc1 lds
s_mov_b32 s19,1
s_waitcnt vmcnt(0)
L_mo_28:
s_mov_b32 s51,s30
s_mov_b64 s[68:69],s[70:71]
s_ff1_i32_b64 s30,s[74:75]
s_bitset0_b64 s[74:75],s30
s_min_u32 s30,s30,127
s_lshl_b32 s70,s30,15
s_add_u32 s70,s70,0
s_add_u32 s71,s70,16384
s_lshl_b32 s76,s31,13
s_add_u32 s76,s76,10487040
s_lshl_b32 s58,s51,5
s_add_u32 s58,s58,s47
s_mul_i32 s58,s58,24576
s_add_u32 s58,s58,100663296
s_add_u32 s61,s58,s50
s_add_u32 s62,s61,4096
s_add_u32 s63,s61,16384
s_add_u32 s64,s61,20480
s_add_u32 s65,s61,s50
s_add_u32 s65,s65,8192
s_waitcnt vmcnt(12)
s_barrier
ds_read_b128 v[72:75],v4 offset:0
ds_read_b128 v[76:79],v4 offset:4096
ds_read_b128 v[80:83],v5 offset:0
ds_read_b128 v[84:87],v5 offset:4096
s_add_u32 m0,s50,154880
s_nop 0
buffer_load_dwordx4 v20,s[8:11],s68 offen offset:768 sc1 lds
s_add_u32 m0,s50,158976
s_nop 0
buffer_load_dwordx4 v20,s[8:11],s69 offen offset:768 sc1 lds
s_waitcnt lgkmcnt(2)
v_mfma_f32_16x16x32_bf16 v[40:43],a[128:131],v[72:75],0
ds_read_b128 v[108:111],v6 offset:0
v_mfma_f32_16x16x32_bf16 v[56:59],v[72:75],v[128:131],0
v_mfma_f32_16x16x32_bf16 v[24:27],a[0:3],v[72:75],0
ds_read_b128 v[112:115],v6 offset:4096
v_mfma_f32_16x16x32_bf16 v[44:47],a[128:131],v[76:79],0
v_mfma_f32_16x16x32_bf16 v[60:63],v[76:79],v[128:131],0
v_mfma_f32_16x16x32_bf16 v[28:31],a[0:3],v[76:79],0
v_mfma_f32_16x16x32_bf16 v[48:51],a[136:139],v[72:75],0
v_mfma_f32_16x16x32_bf16 v[64:67],v[72:75],v[136:139],0
v_mfma_f32_16x16x32_bf16 v[32:35],a[8:11],v[72:75],0
v_mfma_f32_16x16x32_bf16 v[52:55],a[136:139],v[76:79],0
v_mfma_f32_16x16x32_bf16 v[68:71],v[76:79],v[136:139],0
v_mfma_f32_16x16x32_bf16 v[36:39],a[8:11],v[76:79],0
s_waitcnt lgkmcnt(2)
v_mfma_f32_16x16x32_bf16 v[40:43],a[132:135],v[80:83],v[40:43]
ds_read_b128 v[72:75],v7 offset:0
v_mfma_f32_16x16x32_bf16 v[56:59],v[80:83],v[132:135],v[56:59]
v_mfma_f32_16x16x32_bf16 v[24:27],a[4:7],v[80:83],v[24:27]
ds_read_b128 v[76:79],v7 offset:4096
v_mfma_f32_16x16x32_bf16 v[44:47],a[132:135],v[84:87],v[44:47]
v_mfma_f32_16x16x32_bf16 v[60:63],v[84:87],v[132:135],v[60:63]
v_mfma_f32_16x16x32_bf16 v[28:31],a[4:7],v[84:87],v[28:31]
v_mfma_f32_16x16x32_bf16 v[48:51],a[140:143],v[80:83],v[48:51]
v_mfma_f32_16x16x32_bf16 v[64:67],v[80:83],v[140:143],v[64:67]
v_mfma_f32_16x16x32_bf16 v[32:35],a[12:15],v[80:83],v[32:35]
v_mfma_f32_16x16x32_bf16 v[52:55],a[140:143],v[84:87],v[52:55]
v_mfma_f32_16x16x32_bf16 v[68:71],v[84:87],v[140:143],v[68:71]
v_mfma_f32_16x16x32_bf16 v[36:39],a[12:15],v[84:87],v[36:39]
s_waitcnt vmcnt(12)
s_barrier
s_waitcnt lgkmcnt(2)
v_mfma_f32_16x16x32_bf16 v[40:43],a[144:147],v[108:111],v[40:43]
ds_read_b128 v[80:83],v4 offset:8192
v_mfma_f32_16x16x32_bf16 v[56:59],v[108:111],v[144:147],v[56:59]
v_mfma_f32_16x16x32_bf16 v[24:27],a[16:19],v[108:111],v[24:27]
ds_read_b128 v[84:87],v4 offset:12288
v_mfma_f32_16x16x32_bf16 v[44:47],a[144:147],v[112:115],v[44:47]
v_mfma_f32_16x16x32_bf16 v[60:63],v[112:115],v[144:147],v[60:63]
v_mfma_f32_16x16x32_bf16 v[28:31],a[16:19],v[112:115],v[28:31]
v_mfma_f32_16x16x32_bf16 v[48:51],a[152:155],v[108:111],v[48:51]
v_mfma_f32_16x16x32_bf16 v[64:67],v[108:111],v[152:155],v[64:67]
v_mfma_f32_16x16x32_bf16 v[32:35],a[24:27],v[108:111],v[32:35]
v_mfma_f32_16x16x32_bf16 v[52:55],a[152:155],v[112:115],v[52:55]
v_mfma_f32_16x16x32_bf16 v[68:71],v[112:115],v[152:155],v[68:71]
v_mfma_f32_16x16x32_bf16 v[36:39],a[24:27],v[112:115],v[36:39]
s_waitcnt lgkmcnt(2)
v_mfma_f32_16x16x32_bf16 v[40:43],a[148:151],v[72:75],v[40:43]
ds_read_b128 v[108:111],v5 offset:8192
v_mfma_f32_16x16x32_bf16 v[56:59],v[72:75],v[148:151],v[56:59]
v_mfma_f32_16x16x32_bf16 v[24:27],a[20:23],v[72:75],v[24:27]
ds_read_b128 v[112:115],v5 offset:12288
v_mfma_f32_16x16x32_bf16 v[44:47],a[148:151],v[76:79],v[44:47]
v_mfma_f32_16x16x32_bf16 v[60:63],v[76:79],v[148:151],v[60:63]
v_mfma_f32_16x16x32_bf16 v[28:31],a[20:23],v[76:79],v[28:31]
v_mfma_f32_16x16x32_bf16 v[48:51],a[156:159],v[72:75],v[48:51]
v_mfma_f32_16x16x32_bf16 v[64:67],v[72:75],v[156:159],v[64:67]
v_mfma_f32_16x16x32_bf16 v[32:35],a[28:31],v[72:75],v[32:35]
v_mfma_f32_16x16x32_bf16 v[52:55],a[156:159],v[76:79],v[52:55]
v_mfma_f32_16x16x32_bf16 v[68:71],v[76:79],v[156:159],v[68:71]
v_mfma_f32_16x16x32_bf16 v[36:39],a[28:31],v[76:79],v[36:39]
s_waitcnt lgkmcnt(2)
v_mfma_f32_16x16x32_bf16 v[40:43],a[160:163],v[80:83],v[40:43]
ds_read_b128 v[72:75],v6 offset:8192
v_mfma_f32_16x16x32_bf16 v[56:59],v[80:83],v[160:163],v[56:59]
v_mfma_f32_16x16x32_bf16 v[24:27],a[32:35],v[80:83],v[24:27]
ds_read_b128 v[76:79],v6 offset:12288
v_mfma_f32_16x16x32_bf16 v[44:47],a[160:163],v[84:87],v[44:47]
v_mfma_f32_16x16x32_bf16 v[60:63],v[84:87],v[160:163],v[60:63]
v_mfma_f32_16x16x32_bf16 v[28:31],a[32:35],v[84:87],v[28:31]
v_mfma_f32_16x16x32_bf16 v[48:51],a[168:171],v[80:83],v[48:51]
v_mfma_f32_16x16x32_bf16 v[64:67],v[80:83],v[168:171],v[64:67]
v_mfma_f32_16x16x32_bf16 v[32:35],a[40:43],v[80:83],v[32:35]
v_mfma_f32_16x16x32_bf16 v[52:55],a[168:171],v[84:87],v[52:55]
v_mfma_f32_16x16x32_bf16 v[68:71],v[84:87],v[168:171],v[68:71]
v_mfma_f32_16x16x32_bf16 v[36:39],a[40:43],v[84:87],v[36:39]
s_waitcnt lgkmcnt(2)
v_mfma_f32_16x16x32_bf16 v[40:43],a[164:167],v[108:111],v[40:43]
ds_read_b128 v[80:83],v7 offset:8192
v_mfma_f32_16x16x32_bf16 v[56:59],v[108:111],v[164:167],v[56:59]
v_mfma_f32_16x16x32_bf16 v[24:27],a[36:39],v[108:111],v[24:27]
ds_read_b128 v[84:87],v7 offset:12288
v_mfma_f32_16x16x32_bf16 v[44:47],a[164:167],v[112:115],v[44:47]
v_mfma_f32_16x16x32_bf16 v[60:63],v[112:115],v[164:167],v[60:63]
v_mfma_f32_16x16x32_bf16 v[28:31],a[36:39],v[112:115],v[28:31]
v_mfma_f32_16x16x32_bf16 v[48:51],a[172:175],v[108:111],v[48:51]
v_mfma_f32_16x16x32_bf16 v[64:67],v[108:111],v[172:175],v[64:67]
v_mfma_f32_16x16x32_bf16 v[32:35],a[44:47],v[108:111],v[32:35]
v_mfma_f32_16x16x32_bf16 v[52:55],a[172:175],v[112:115],v[52:55]
v_mfma_f32_16x16x32_bf16 v[68:71],v[112:115],v[172:175],v[68:71]
v_mfma_f32_16x16x32_bf16 v[36:39],a[44:47],v[112:115],v[36:39]
s_waitcnt vmcnt(10)
s_barrier
s_waitcnt lgkmcnt(2)
v_mfma_f32_16x16x32_bf16 v[40:43],a[176:179],v[72:75],v[40:43]
ds_read_b128 v[108:111],v4 offset:16384
v_mfma_f32_16x16x32_bf16 v[56:59],v[72:75],v[176:179],v[56:59]
v_mfma_f32_16x16x32_bf16 v[24:27],a[48:51],v[72:75],v[24:27]
ds_read_b128 v[112:115],v4 offset:20480
v_mfma_f32_16x16x32_bf16 v[44:47],a[176:179],v[76:79],v[44:47]
v_mfma_f32_16x16x32_bf16 v[60:63],v[76:79],v[176:179],v[60:63]
v_mfma_f32_16x16x32_bf16 v[28:31],a[48:51],v[76:79],v[28:31]
v_mfma_f32_16x16x32_bf16 v[48:51],a[184:187],v[72:75],v[48:51]
v_mfma_f32_16x16x32_bf16 v[64:67],v[72:75],v[184:187],v[64:67]
v_mfma_f32_16x16x32_bf16 v[32:35],a[56:59],v[72:75],v[32:35]
v_mfma_f32_16x16x32_bf16 v[52:55],a[184:187],v[76:79],v[52:55]
v_mfma_f32_16x16x32_bf16 v[68:71],v[76:79],v[184:187],v[68:71]
v_mfma_f32_16x16x32_bf16 v[36:39],a[56:59],v[76:79],v[36:39]
s_waitcnt vmcnt(2)
s_barrier
s_or_b32 s72,s72,s52
buffer_store_dword v17,off,s[8:11],s72 sc1
s_waitcnt lgkmcnt(2)
v_mfma_f32_16x16x32_bf16 v[40:43],a[180:183],v[80:83],v[40:43]
ds_read_b128 v[72:75],v5 offset:16384
v_mfma_f32_16x16x32_bf16 v[56:59],v[80:83],v[180:183],v[56:59]
v_mfma_f32_16x16x32_bf16 v[24:27],a[52:55],v[80:83],v[24:27]
ds_read_b128 v[76:79],v5 offset:20480
v_mfma_f32_16x16x32_bf16 v[44:47],a[180:183],v[84:87],v[44:47]
v_mfma_f32_16x16x32_bf16 v[60:63],v[84:87],v[180:183],v[60:63]
v_mfma_f32_16x16x32_bf16 v[28:31],a[52:55],v[84:87],v[28:31]
v_mfma_f32_16x16x32_bf16 v[48:51],a[188:191],v[80:83],v[48:51]
v_mfma_f32_16x16x32_bf16 v[64:67],v[80:83],v[188:191],v[64:67]
v_mfma_f32_16x16x32_bf16 v[32:35],a[60:63],v[80:83],v[32:35]
v_mfma_f32_16x16x32_bf16 v[52:55],a[188:191],v[84:87],v[52:55]
v_mfma_f32_16x16x32_bf16 v[68:71],v[84:87],v[188:191],v[68:71]
v_mfma_f32_16x16x32_bf16 v[36:39],a[60:63],v[84:87],v[36:39]
s_waitcnt lgkmcnt(2)
v_mfma_f32_16x16x32_bf16 v[40:43],a[192:195],v[108:111],v[40:43]
ds_read_b128 v[80:83],v6 offset:16384
v_mfma_f32_16x16x32_bf16 v[56:59],v[108:111],v[192:195],v[56:59]
v_mfma_f32_16x16x32_bf16 v[24:27],a[64:67],v[108:111],v[24:27]
ds_read_b128 v[84:87],v6 offset:20480
v_mfma_f32_16x16x32_bf16 v[44:47],a[192:195],v[112:115],v[44:47]
v_mfma_f32_16x16x32_bf16 v[60:63],v[112:115],v[192:195],v[60:63]
v_mfma_f32_16x16x32_bf16 v[28:31],a[64:67],v[112:115],v[28:31]
v_mfma_f32_16x16x32_bf16 v[48:51],a[200:203],v[108:111],v[48:51]
v_mfma_f32_16x16x32_bf16 v[64:67],v[108:111],v[200:203],v[64:67]
v_mfma_f32_16x16x32_bf16 v[32:35],a[72:75],v[108:111],v[32:35]
v_mfma_f32_16x16x32_bf16 v[52:55],a[200:203],v[112:115],v[52:55]
v_mfma_f32_16x16x32_bf16 v[68:71],v[112:115],v[200:203],v[68:71]
v_mfma_f32_16x16x32_bf16 v[36:39],a[72:75],v[112:115],v[36:39]
s_waitcnt lgkmcnt(2)
v_mfma_f32_16x16x32_bf16 v[40:43],a[196:199],v[72:75],v[40:43]
ds_read_b128 v[108:111],v7 offset:16384
v_mfma_f32_16x16x32_bf16 v[56:59],v[72:75],v[196:199],v[56:59]
v_mfma_f32_16x16x32_bf16 v[24:27],a[68:71],v[72:75],v[24:27]
ds_read_b128 v[112:115],v7 offset:20480
v_mfma_f32_16x16x32_bf16 v[44:47],a[196:199],v[76:79],v[44:47]
v_mfma_f32_16x16x32_bf16 v[60:63],v[76:79],v[196:199],v[60:63]
v_mfma_f32_16x16x32_bf16 v[28:31],a[68:71],v[76:79],v[28:31]
v_mfma_f32_16x16x32_bf16 v[48:51],a[204:207],v[72:75],v[48:51]
v_mfma_f32_16x16x32_bf16 v[64:67],v[72:75],v[204:207],v[64:67]
v_mfma_f32_16x16x32_bf16 v[32:35],a[76:79],v[72:75],v[32:35]
v_mfma_f32_16x16x32_bf16 v[52:55],a[204:207],v[76:79],v[52:55]
v_mfma_f32_16x16x32_bf16 v[68:71],v[76:79],v[204:207],v[68:71]
v_mfma_f32_16x16x32_bf16 v[36:39],a[76:79],v[76:79],v[36:39]
s_waitcnt vmcnt(1)
s_barrier
s_waitcnt lgkmcnt(2)
v_mfma_f32_16x16x32_bf16 v[40:43],a[208:211],v[80:83],v[40:43]
ds_read_b128 v[72:75],v4 offset:24576
v_mfma_f32_16x16x32_bf16 v[56:59],v[80:83],v[208:211],v[56:59]
v_mfma_f32_16x16x32_bf16 v[24:27],a[80:83],v[80:83],v[24:27]
ds_read_b128 v[76:79],v4 offset:28672
v_mfma_f32_16x16x32_bf16 v[44:47],a[208:211],v[84:87],v[44:47]
v_mfma_f32_16x16x32_bf16 v[60:63],v[84:87],v[208:211],v[60:63]
v_mfma_f32_16x16x32_bf16 v[28:31],a[80:83],v[84:87],v[28:31]
v_mfma_f32_16x16x32_bf16 v[48:51],a[216:219],v[80:83],v[48:51]
v_mfma_f32_16x16x32_bf16 v[64:67],v[80:83],v[216:219],v[64:67]
v_mfma_f32_16x16x32_bf16 v[32:35],a[88:91],v[80:83],v[32:35]
v_mfma_f32_16x16x32_bf16 v[52:55],a[216:219],v[84:87],v[52:55]
v_mfma_f32_16x16x32_bf16 v[68:71],v[84:87],v[216:219],v[68:71]
v_mfma_f32_16x16x32_bf16 v[36:39],a[88:91],v[84:87],v[36:39]
s_waitcnt lgkmcnt(2)
v_mfma_f32_16x16x32_bf16 v[40:43],a[212:215],v[108:111],v[40:43]
ds_read_b128 v[80:83],v5 offset:24576
v_mfma_f32_16x16x32_bf16 v[56:59],v[108:111],v[212:215],v[56:59]
v_mfma_f32_16x16x32_bf16 v[24:27],a[84:87],v[108:111],v[24:27]
ds_read_b128 v[84:87],v5 offset:28672
v_mfma_f32_16x16x32_bf16 v[44:47],a[212:215],v[112:115],v[44:47]
v_mfma_f32_16x16x32_bf16 v[60:63],v[112:115],v[212:215],v[60:63]
v_mfma_f32_16x16x32_bf16 v[28:31],a[84:87],v[112:115],v[28:31]
v_mfma_f32_16x16x32_bf16 v[48:51],a[220:223],v[108:111],v[48:51]
v_mfma_f32_16x16x32_bf16 v[64:67],v[108:111],v[220:223],v[64:67]
v_mfma_f32_16x16x32_bf16 v[32:35],a[92:95],v[108:111],v[32:35]
v_mfma_f32_16x16x32_bf16 v[52:55],a[220:223],v[112:115],v[52:55]
v_mfma_f32_16x16x32_bf16 v[68:71],v[112:115],v[220:223],v[68:71]
v_mfma_f32_16x16x32_bf16 v[36:39],a[92:95],v[112:115],v[36:39]
s_barrier
s_waitcnt lgkmcnt(2)
v_mfma_f32_16x16x32_bf16 v[40:43],a[224:227],v[72:75],v[40:43]
ds_read_b128 v[108:111],v6 offset:24576
v_mfma_f32_16x16x32_bf16 v[56:59],v[72:75],v[224:227],v[56:59]
s_add_u32 m0,s50,131072
v_mfma_f32_16x16x32_bf16 v[24:27],a[96:99],v[72:75],v[24:27]
ds_read_b128 v[112:115],v6 offset:28672
v_mfma_f32_16x16x32_bf16 v[44:47],a[224:227],v[76:79],v[44:47]
buffer_load_dwordx4 v20,s[8:11],s70 offen offset:0 sc1 lds
v_mfma_f32_16x16x32_bf16 v[60:63],v[76:79],v[224:227],v[60:63]
s_add_u32 m0,s50,135168
v_mfma_f32_16x16x32_bf16 v[28:31],a[96:99],v[76:79],v[28:31]
buffer_load_dwordx4 v20,s[8:11],s71 offen offset:0 sc1 lds
v_mfma_f32_16x16x32_bf16 v[48:51],a[232:235],v[72:75],v[48:51]
s_add_u32 m0,s50,139008
v_mfma_f32_16x16x32_bf16 v[64:67],v[72:75],v[232:235],v[64:67]
buffer_load_dwordx4 v20,s[8:11],s70 offen offset:256 sc1 lds
v_mfma_f32_16x16x32_bf16 v[32:35],a[104:107],v[72:75],v[32:35]
s_add_u32 m0,s50,143104
v_mfma_f32_16x16x32_bf16 v[52:55],a[232:235],v[76:79],v[52:55]
buffer_load_dwordx4 v20,s[8:11],s71 offen offset:256 sc1 lds
v_mfma_f32_16x16x32_bf16 v[68:71],v[76:79],v[232:235],v[68:71]
s_add_u32 m0,s50,146944
v_mfma_f32_16x16x32_bf16 v[36:39],a[104:107],v[76:79],v[36:39]
buffer_load_dwordx4 v20,s[8:11],s70 offen offset:512 sc1 lds
s_waitcnt lgkmcnt(2)
v_mfma_f32_16x16x32_bf16 v[40:43],a[228:231],v[80:83],v[40:43]
ds_read_b128 v[72:75],v7 offset:24576
v_mfma_f32_16x16x32_bf16 v[56:59],v[80:83],v[228:231],v[56:59]
s_add_u32 m0,s50,151040
v_mfma_f32_16x16x32_bf16 v[24:27],a[100:103],v[80:83],v[24:27]
ds_read_b128 v[76:79],v7 offset:28672
v_mfma_f32_16x16x32_bf16 v[44:47],a[228:231],v[84:87],v[44:47]
buffer_load_dwordx4 v20,s[8:11],s71 offen offset:512 sc1 lds
v_mfma_f32_16x16x32_bf16 v[60:63],v[84:87],v[228:231],v[60:63]
buffer_load_dwordx2 v[124:125],v23,s[8:11],s76 offen sc1
v_mfma_f32_16x16x32_bf16 v[28:31],a[100:103],v[84:87],v[28:31]
v_mfma_f32_16x16x32_bf16 v[48:51],a[236:239],v[80:83],v[48:51]
v_mfma_f32_16x16x32_bf16 v[64:67],v[80:83],v[236:239],v[64:67]
v_mfma_f32_16x16x32_bf16 v[32:35],a[108:111],v[80:83],v[32:35]
v_mfma_f32_16x16x32_bf16 v[52:55],a[236:239],v[84:87],v[52:55]
v_mfma_f32_16x16x32_bf16 v[68:71],v[84:87],v[236:239],v[68:71]
v_mfma_f32_16x16x32_bf16 v[36:39],a[108:111],v[84:87],v[36:39]
s_waitcnt lgkmcnt(2)
v_mfma_f32_16x16x32_bf16 v[40:43],a[240:243],v[108:111],v[40:43]
v_mfma_f32_16x16x32_bf16 v[56:59],v[108:111],v[240:243],v[56:59]
v_mfma_f32_16x16x32_bf16 v[24:27],a[112:115],v[108:111],v[24:27]
v_mfma_f32_16x16x32_bf16 v[44:47],a[240:243],v[112:115],v[44:47]
v_mfma_f32_16x16x32_bf16 v[60:63],v[112:115],v[240:243],v[60:63]
v_mfma_f32_16x16x32_bf16 v[28:31],a[112:115],v[112:115],v[28:31]
v_mfma_f32_16x16x32_bf16 v[48:51],a[248:251],v[108:111],v[48:51]
v_mfma_f32_16x16x32_bf16 v[64:67],v[108:111],v[248:251],v[64:67]
v_mfma_f32_16x16x32_bf16 v[32:35],a[120:123],v[108:111],v[32:35]
v_mfma_f32_16x16x32_bf16 v[52:55],a[248:251],v[112:115],v[52:55]
v_mfma_f32_16x16x32_bf16 v[68:71],v[112:115],v[248:251],v[68:71]
v_mfma_f32_16x16x32_bf16 v[36:39],a[120:123],v[112:115],v[36:39]
s_waitcnt lgkmcnt(0)
v_mfma_f32_16x16x32_bf16 v[40:43],a[244:247],v[72:75],v[40:43]
v_mfma_f32_16x16x32_bf16 v[56:59],v[72:75],v[244:247],v[56:59]
v_mfma_f32_16x16x32_bf16 v[24:27],a[116:119],v[72:75],v[24:27]
v_mfma_f32_16x16x32_bf16 v[44:47],a[244:247],v[76:79],v[44:47]
v_mfma_f32_16x16x32_bf16 v[60:63],v[76:79],v[244:247],v[60:63]
v_mfma_f32_16x16x32_bf16 v[28:31],a[116:119],v[76:79],v[28:31]
v_mfma_f32_16x16x32_bf16 v[48:51],a[252:255],v[72:75],v[48:51]
v_mfma_f32_16x16x32_bf16 v[64:67],v[72:75],v[252:255],v[64:67]
v_mfma_f32_16x16x32_bf16 v[32:35],a[124:127],v[72:75],v[32:35]
v_mfma_f32_16x16x32_bf16 v[52:55],a[252:255],v[76:79],v[52:55]
v_mfma_f32_16x16x32_bf16 v[68:71],v[76:79],v[252:255],v[68:71]
v_mfma_f32_16x16x32_bf16 v[36:39],a[124:127],v[76:79],v[36:39]
s_lshl_b32 s56,s51,5
s_add_u32 s56,s56,s47
s_lshl_b32 s56,s56,12
s_add_u32 s56,s56,s50
s_add_u32 s56,s56,41943040
v_mov_b64 v[120:121],-1
v_mov_b64 v[122:123],-1
buffer_store_dwordx4 v[120:123],v0,s[8:11],s56 offen sc1
v_cvt_pk_bf16_f32 v72,v40,v48
v_cvt_pk_bf16_f32 v73,v41,v49
v_cvt_pk_bf16_f32 v74,v42,v50
v_cvt_pk_bf16_f32 v75,v43,v51
buffer_store_dwordx4 v[72:75],v0,s[8:11],s61 offen sc1
v_cvt_pk_bf16_f32 v76,v44,v52
v_cvt_pk_bf16_f32 v77,v45,v53
v_cvt_pk_bf16_f32 v78,v46,v54
v_cvt_pk_bf16_f32 v79,v47,v55
buffer_store_dwordx4 v[76:79],v0,s[8:11],s62 offen sc1
v_cvt_pk_bf16_f32 v80,v56,v57
v_cvt_pk_bf16_f32 v81,v58,v59
v_cvt_pk_bf16_f32 v82,v60,v61
v_cvt_pk_bf16_f32 v83,v62,v63
buffer_store_dwordx4 v[80:83],v0,s[8:11],s65 offen offset:0 sc1
v_cvt_pk_bf16_f32 v84,v64,v65
v_cvt_pk_bf16_f32 v85,v66,v67
v_cvt_pk_bf16_f32 v86,v68,v69
v_cvt_pk_bf16_f32 v87,v70,v71
buffer_store_dwordx4 v[84:87],v0,s[8:11],s65 offen offset:1024 sc1
v_cvt_pk_bf16_f32 v108,v24,v32
v_cvt_pk_bf16_f32 v109,v25,v33
v_cvt_pk_bf16_f32 v110,v26,v34
v_cvt_pk_bf16_f32 v111,v27,v35
buffer_store_dwordx4 v[108:111],v0,s[8:11],s63 offen sc1
v_cvt_pk_bf16_f32 v112,v28,v36
v_cvt_pk_bf16_f32 v113,v29,v37
v_cvt_pk_bf16_f32 v114,v30,v38
v_cvt_pk_bf16_f32 v115,v31,v39
buffer_store_dwordx4 v[112:115],v0,s[8:11],s64 offen sc1
s_lshl_b32 s72,s51,13
s_lshl2_add_u32 s72,s47,s72
s_add_u32 s72,s72,10485760
s_sub_u32 s53,s53,1
s_cmp_gt_i32 s53,3
s_cbranch_scc1 L_mo_28
s_cmp_gt_i32 s53,0
s_cselect_b32 s87,1,3
s_mov_b32 s18,0
s_waitcnt vmcnt(7)
s_branch L_mo_33
L_mo_26:
s_mov_b32 s55,s22
s_mov_b32 s22,s23
s_mov_b32 s23,s24
s_mov_b32 s24,-1
s_cmp_lg_u32 s55,-1
s_cbranch_scc1 L_mp_24
s_sub_u32 s56,s30,s31
s_cmp_gt_i32 s77,0
s_cselect_b32 s57,6,15
s_cmp_lg_u32 s86,0
s_cselect_b32 s57,9,s57
s_cmp_lt_i32 s56,s57
s_cbranch_scc1 L_mo_27
s_cmp_lt_i32 s56,30
s_cselect_b32 s87,s18,0
s_cmp_ge_u32 s31,8
s_cselect_b32 s56,1,s18
s_and_b32 s56,s56,s86
s_cselect_b32 s87,2,s87
s_mul_i32 s56,s87,s18
s_cmp_lg_u32 s56,0
s_cbranch_scc1 L_mo_31
s_mov_b32 s18,0
s_lshr_b32 s56,s72,31
s_or_b32 s56,s56,s87
s_cbranch_scc1 L_mo_37
s_waitcnt vmcnt(0)
s_barrier
s_or_b32 s72,s72,s52
buffer_store_dword v17,off,s[8:11],s72 sc1
s_mov_b32 s72,0x80000000
L_mo_37:
s_cmp_lg_u32 s46,0
s_cbranch_scc1 L_mo_35
s_lshl_b32 s76,s31,13
s_add_u32 s76,s76,10487040
L_mo_34:
buffer_load_dwordx2 v[124:125],v23,s[8:11],s76 offen sc1
s_sub_u32 s49,s49,1
s_cbranch_scc1 L_abort
s_waitcnt vmcnt(0)
L_mo_33:
v_min_u32 v123,v124,v125
v_max_u32 v125,v124,v125
v_cmp_eq_u32 vcc,0,v123
s_nop 1
v_cndmask_b32 v125,v125,-1,vcc
s_and_b32 s56,vcc_lo,0xffff
s_cbranch_scc0 L_mo_38
s_cmp_lg_u32 s87,0
s_cbranch_scc1 L_mo_38
s_mov_b32 s18,1
s_sleep 2
s_branch L_mo_34
L_mo_38:
v_max_u32_dpp v125,v125,v125 row_ror:8 row_mask:0xf bank_mask:0xf
s_nop 1
v_max_u32_dpp v125,v125,v125 row_ror:4 row_mask:0xf bank_mask:0xf
s_nop 1
v_max_u32_dpp v125,v125,v125 row_ror:2 row_mask:0xf bank_mask:0xf
s_nop 1
v_max_u32_dpp v125,v125,v125 row_ror:1 row_mask:0xf bank_mask:0xf
L_mo_35:
s_sub_u32 s49,s49,1
s_cbranch_scc1 L_abort
v_mov_b32 v124,s18
s_barrier
s_cmp_lg_u32 s46,0
s_cbranch_scc1 L_mo_36
ds_write_b32 v16,v125
ds_write_b32 v19,v124 offset:16
s_waitcnt lgkmcnt(0)
L_mo_36:
s_barrier
ds_read_b128 v[120:123],v19
ds_read_b32 v124,v19 offset:16
s_waitcnt lgkmcnt(0)
v_readfirstlane_b32 s55,v120
v_readfirstlane_b32 s22,v121
v_readfirstlane_b32 s23,v122
v_readfirstlane_b32 s24,v123
v_readfirstlane_b32 s18,v124
s_cmp_lg_u32 s55,-1
s_cbranch_scc1 L_mp_24
L_mo_31:
s_mov_b32 s22,-1
s_cmp_eq_u32 s87,1
s_cbranch_scc1 L_mo_27
s_cmp_eq_u32 s87,2
s_cbranch_scc1 L_mo_32
s_branch L_mo_26
L_mp_24:
s_mov_b32 s53,0
s_sub_u32 s73,s73,1
s_max_i32 s73,s73,0
s_sub_u32 s77,s77,1
s_min_u32 s61,s73,2
s_cmp_lt_u32 s31,5
s_cselect_b32 s60,s25,0
s_cmp_lt_u32 s55,s60
s_cselect_b32 s61,2,s61
s_cmp_le_u32 s55,s54
s_cbranch_scc1 L_mr_25
s_mov_b32 s77,s61
s_mov_b32 s54,s55
s_mov_b32 s86,0
s_or_b32 s61,s47,s46
s_cbranch_scc1 L_mr_25
v_mov_b32 v120,s54
v_lshlrev_b32 v121,13,v1
s_mov_b32 s61,10486784
buffer_store_dword v120,v121,s[8:11],s61 offen sc1
L_mr_25:
s_cmp_lg_u32 s31,63
s_cbranch_scc1 L_mo_29
s_min_i32 s77,s77,0
s_or_b32 s61,s47,s46
s_cbranch_scc1 L_mo_29
s_mov_b32 s59,11018240
v_lshlrev_b32 v120,2,v1
L_fp_40:
s_sleep 0
buffer_load_dword v121,v120,s[8:11],s59 offen sc1
s_sub_u32 s49,s49,1
s_cbranch_scc1 L_abort
s_waitcnt vmcnt(0)
v_cmp_eq_u32 vcc,0,v121
s_cbranch_vccnz L_fp_40
s_andn2_b32 s62,0x7ff,s54
v_lshl_or_b32 v121,s62,8,v121
s_add_u32 s59,s59,8192
buffer_store_dword v121,v120,s[8:11],s59 offen sc1
s_add_u32 s59,s59,8192
buffer_store_dword v121,v120,s[8:11],s59 offen sc1
s_add_u32 s59,s59,8192
buffer_store_dword v121,v120,s[8:11],s59 offen sc1
s_add_u32 s59,s59,8192
buffer_store_dword v121,v120,s[8:11],s59 offen sc1
s_add_u32 s59,s59,8192
buffer_store_dword v121,v120,s[8:11],s59 offen sc1
s_add_u32 s59,s59,8192
buffer_store_dword v121,v120,s[8:11],s59 offen sc1
L_mo_29:
s_add_u32 s31,s31,1
s_cmp_gt_i32 s77,0
s_cmov_b32 s18,0
s_cbranch_scc1 L_mo_26
s_cmp_lg_u32 s77,0
s_cbranch_scc1 L_mo_30
s_andn2_b32 s51,0x7ff,s54
s_lshr_b32 s51,s51,5
s_add_u32 s73,s73,2
s_mov_b32 s86,1
s_mov_b32 s19,0
s_mov_b32 s18,0
s_waitcnt vmcnt(8)
s_barrier
s_andn2_b32 s64,0x7ff,s54
s_lshl_b32 s56,s64,10
s_add_u32 s58,s56,4194304
buffer_load_dwordx4 v[88:91],v0,s[8:11],s58 offen sc1
v_and_b32 v9,15,v1
v_lshrrev_b32 v10,4,v1
v_and_b32 v124,1,v1
v_lshlrev_b32 v124,4,v124
v_mov_b32 v125,0xffff
v_lshlrev_b32 v125,v124,v125
v_lshrrev_b32 v124,2,v9
v_cmp_eq_u32 vcc,0,v124
s_nop 1
v_cndmask_b32 v12,0,v125,vcc
v_cmp_eq_u32 vcc,1,v124
s_nop 1
v_cndmask_b32 v13,0,v125,vcc
v_and_b32 v124,2,v1
v_cmp_eq_u32 vcc,0,v124
v_mov_b32 v14,0xeeee
v_mov_b32 v124,0x4444
v_cndmask_b32 v14,v14,v124,vcc
v_lshlrev_b32 v11,14,v10
v_lshl_add_u32 v11,v9,4,v11
s_lshl_b32 s65,s51,15
s_add_u32 s65,s65,92274688
s_lshl_b32 s62,s47,10
s_add_u32 s62,s62,s65
s_lshl_b32 s63,s47,16
s_lshl_b32 s60,s46,8
s_add_u32 s63,s63,s60
s_mov_b32 s4,s38
s_mov_b32 s5,s39
s_mov_b32 s6,1835008
s_mov_b32 s7,0x20000
s_lshl_b32 s57,s46,11
s_add_u32 s57,s57,139264
v_add_u32 v8,s57,v0
v_and_b32 v2,1,v10
v_lshrrev_b32 v3,1,v10
v_lshlrev_b32 v2,7,v2
v_lshl_add_u32 v2,v3,10,v2
s_lshl_b32 s59,s46,8
s_add_u32 s59,s57,s59
v_add_u32 v2,s59,v2
s_mov_b32 s60,0x01000100
s_mov_b32 s61,0x03020302
s_waitcnt vmcnt(0)
L_mx_41:
v_max3_u32 v124,v88,v89,v90
v_max_u32 v124,v91,v124
v_cmp_eq_u32 vcc,-1,v124
s_cbranch_vccz L_mxd_42
buffer_load_dwordx4 v[88:91],v0,s[8:11],s58 offen sc1
s_sub_u32 s49,s49,1
s_cbranch_scc1 L_abort
s_waitcnt vmcnt(0)
s_branch L_mx_41
L_mxd_42:
buffer_load_dwordx4 v[24:27],v11,s[4:7],s63 offen offset:0
buffer_load_dwordx4 v[28:31],v11,s[4:7],s63 offen offset:1024
buffer_load_dwordx4 v[32:35],v11,s[4:7],s63 offen offset:2048
buffer_load_dwordx4 v[36:39],v11,s[4:7],s63 offen offset:3072
v_lshlrev_b32 v96,16,v88
v_and_b32 v97,0xffff0000,v88
v_lshlrev_b32 v98,16,v89
v_and_b32 v99,0xffff0000,v89
v_lshlrev_b32 v100,16,v90
v_and_b32 v101,0xffff0000,v90
v_lshlrev_b32 v102,16,v91
v_and_b32 v103,0xffff0000,v91
v_readfirstlane_b32 s78,v96
s_nop 1
v_pk_add_f32 v[108:109],v[96:97],s[78:79] op_sel_hi:[1,0] neg_lo:[0,1] neg_hi:[0,1]
v_pk_add_f32 v[110:111],v[98:99],s[78:79] op_sel_hi:[1,0] neg_lo:[0,1] neg_hi:[0,1]
v_pk_add_f32 v[112:113],v[100:101],s[78:79] op_sel_hi:[1,0] neg_lo:[0,1] neg_hi:[0,1]
v_pk_add_f32 v[114:115],v[102:103],s[78:79] op_sel_hi:[1,0] neg_lo:[0,1] neg_hi:[0,1]
v_pk_add_f32 v[116:117],v[108:109],v[110:111]
v_pk_mul_f32 v[118:119],v[108:109],v[108:109]
v_pk_add_f32 v[120:121],v[112:113],v[114:115]
v_pk_fma_f32 v[118:119],v[110:111],v[110:111],v[118:119]
v_pk_add_f32 v[116:117],v[116:117],v[120:121]
v_pk_fma_f32 v[118:119],v[112:113],v[112:113],v[118:119]
v_add_f32 v116,v116,v117
v_pk_fma_f32 v[118:119],v[114:115],v[114:115],v[118:119]
v_add_f32 v118,v118,v119
s_nop 1
v_permlane32_swap_b32 v116,v118
v_add_f32 v116,v116,v118
s_nop 1
v_add_f32_dpp v116,v116,v116 row_ror:8 row_mask:0xf bank_mask:0xf
s_nop 1
v_add_f32_dpp v116,v116,v116 row_ror:4 row_mask:0xf bank_mask:0xf
s_nop 1
v_add_f32_dpp v116,v116,v116 row_ror:2 row_mask:0xf bank_mask:0xf
s_nop 1
v_add_f32_dpp v116,v116,v116 row_ror:1 row_mask:0xf bank_mask:0xf
v_mov_b32 v118,v116
s_nop 1
v_permlane16_swap_b32 v116,v118
v_add_f32 v116,v116,v118
v_mul_f32 v116,0x3b000000,v116
v_mov_b32 v118,v116
s_nop 1
v_permlane32_swap_b32 v116,v118
v_fma_f32 v118,-v116,v116,v118
v_add_f32 v116,s78,v116
v_max_f32 v118,0,v118
v_cvt_pk_bf16_f32 v118,v116,v118
v_lshlrev_b32 v116,16,v118
v_and_b32 v118,0xffff0000,v118
v_add_f32 v118,0x3727c5ac,v118
v_cvt_pk_bf16_f32 v118,v118,v118
v_and_b32 v118,0xffff0000,v118
v_sqrt_f32 v118,v118
v_pk_add_f32 v[108:109],v[96:97],v[116:117] op_sel_hi:[1,0] neg_lo:[0,1] neg_hi:[0,1]
v_pk_add_f32 v[110:111],v[98:99],v[116:117] op_sel_hi:[1,0] neg_lo:[0,1] neg_hi:[0,1]
v_pk_add_f32 v[112:113],v[100:101],v[116:117] op_sel_hi:[1,0] neg_lo:[0,1] neg_hi:[0,1]
v_pk_add_f32 v[114:115],v[102:103],v[116:117] op_sel_hi:[1,0] neg_lo:[0,1] neg_hi:[0,1]
v_cvt_pk_bf16_f32 v118,v118,v118
v_and_b32 v118,0xffff0000,v118
v_rcp_f32 v118,v118
v_cvt_pk_bf16_f32 v104,v108,v109
v_cvt_pk_bf16_f32 v105,v110,v111
v_cvt_pk_bf16_f32 v106,v112,v113
v_cvt_pk_bf16_f32 v107,v114,v115
v_lshlrev_b32 v108,16,v104
v_and_b32 v109,0xffff0000,v104
v_lshlrev_b32 v110,16,v105
v_and_b32 v111,0xffff0000,v105
v_lshlrev_b32 v112,16,v106
v_and_b32 v113,0xffff0000,v106
v_lshlrev_b32 v114,16,v107
v_and_b32 v115,0xffff0000,v107
v_pk_mul_f32 v[108:109],v[108:109],v[118:119] op_sel_hi:[1,0]
v_pk_mul_f32 v[110:111],v[110:111],v[118:119] op_sel_hi:[1,0]
v_pk_mul_f32 v[112:113],v[112:113],v[118:119] op_sel_hi:[1,0]
v_pk_mul_f32 v[114:115],v[114:115],v[118:119] op_sel_hi:[1,0]
v_cvt_pk_bf16_f32 v104,v108,v109
v_cvt_pk_bf16_f32 v105,v110,v111
v_cvt_pk_bf16_f32 v106,v112,v113
v_cvt_pk_bf16_f32 v107,v114,v115
v_perm_b32 v88,v104,v104,s60
v_perm_b32 v89,v105,v105,s60
v_perm_b32 v90,v106,v106,s60
v_perm_b32 v91,v107,v107,s60
ds_write_b128 v8,v[88:91]
v_perm_b32 v92,v104,v104,s61
v_perm_b32 v93,v105,v105,s61
v_perm_b32 v94,v106,v106,s61
v_perm_b32 v95,v107,v107,s61
ds_write_b128 v8,v[92:95] offset:1024
s_mov_b32 s58,s57
ds_read_b128 v[88:91],v2 offset:0
ds_read_b128 v[92:95],v2 offset:64
ds_read_b128 v[108:111],v18 offset:0
ds_read_b128 v[112:115],v18 offset:1024
ds_read_b128 v[64:67],v18 offset:2048
ds_read_b128 v[68:71],v18 offset:3072
ds_read_b128 v[72:75],v18 offset:4096
ds_read_b128 v[76:79],v18 offset:5120
ds_read_b128 v[80:83],v18 offset:6144
ds_read_b128 v[84:87],v18 offset:7168
v_mov_b64 v[116:117],0
v_mov_b64 v[118:119],0
s_waitcnt lgkmcnt(8)
v_and_b32 v120,v12,v88
v_and_b32 v121,v13,v88
v_and_b32 v122,v12,v92
v_and_b32 v123,v13,v92
s_waitcnt lgkmcnt(6)
s_nop 0
v_smfmac_f32_16x16x64_bf16 v[116:119],v[120:123],v[108:115],v14
ds_read_b128 v[108:111],v18 offset:8192
ds_read_b128 v[112:115],v18 offset:9216
s_add_u32 s63,s63,4096
buffer_load_dwordx4 v[40:43],v11,s[4:7],s63 offen offset:0
v_and_b32 v124,v12,v89
v_and_b32 v125,v13,v89
v_and_b32 v126,v12,v93
v_and_b32 v127,v13,v93
s_waitcnt lgkmcnt(6)
s_nop 0
v_smfmac_f32_16x16x64_bf16 v[116:119],v[124:127],v[64:71],v14
ds_read_b128 v[64:67],v18 offset:10240
ds_read_b128 v[68:71],v18 offset:11264
buffer_load_dwordx4 v[44:47],v11,s[4:7],s63 offen offset:1024
v_and_b32 v120,v12,v90
v_and_b32 v121,v13,v90
v_and_b32 v122,v12,v94
v_and_b32 v123,v13,v94
s_waitcnt lgkmcnt(6)
s_nop 0
v_smfmac_f32_16x16x64_bf16 v[116:119],v[120:123],v[72:79],v14
ds_read_b128 v[72:75],v18 offset:12288
ds_read_b128 v[76:79],v18 offset:13312
buffer_load_dwordx4 v[48:51],v11,s[4:7],s63 offen offset:2048
v_and_b32 v124,v12,v91
v_and_b32 v125,v13,v91
v_and_b32 v126,v12,v95
v_and_b32 v127,v13,v95
ds_read_b128 v[88:91],v2 offset:16
ds_read_b128 v[92:95],v2 offset:80
s_waitcnt lgkmcnt(8)
v_smfmac_f32_16x16x64_bf16 v[116:119],v[124:127],v[80:87],v14
ds_read_b128 v[80:83],v18 offset:14336
ds_read_b128 v[84:87],v18 offset:15360
buffer_load_dwordx4 v[52:55],v11,s[4:7],s63 offen offset:3072
s_waitcnt lgkmcnt(2)
v_and_b32 v120,v12,v88
v_and_b32 v121,v13,v88
v_and_b32 v122,v12,v92
v_and_b32 v123,v13,v92
s_waitcnt lgkmcnt(8)
s_nop 0
v_smfmac_f32_16x16x64_bf16 v[116:119],v[120:123],v[108:115],v14
ds_read_b128 v[108:111],v18 offset:16384
ds_read_b128 v[112:115],v18 offset:17408
s_add_u32 s63,s63,4096
buffer_load_dwordx4 v[56:59],v11,s[4:7],s63 offen offset:0
v_and_b32 v124,v12,v89
v_and_b32 v125,v13,v89
v_and_b32 v126,v12,v93
v_and_b32 v127,v13,v93
s_waitcnt lgkmcnt(8)
s_nop 0
v_smfmac_f32_16x16x64_bf16 v[116:119],v[124:127],v[64:71],v14
ds_read_b128 v[64:67],v18 offset:18432
ds_read_b128 v[68:71],v18 offset:19456
buffer_load_dwordx4 v[60:63],v11,s[4:7],s63 offen offset:1024
v_and_b32 v120,v12,v90
v_and_b32 v121,v13,v90
v_and_b32 v122,v12,v94
v_and_b32 v123,v13,v94
s_waitcnt lgkmcnt(8)
s_nop 0
v_smfmac_f32_16x16x64_bf16 v[116:119],v[120:123],v[72:79],v14
ds_read_b128 v[72:75],v18 offset:20480
ds_read_b128 v[76:79],v18 offset:21504
buffer_load_dword v15,v0,s[8:11],s62 offen
v_and_b32 v124,v12,v91
v_and_b32 v125,v13,v91
v_and_b32 v126,v12,v95
v_and_b32 v127,v13,v95
ds_read_b128 v[88:91],v2 offset:32
ds_read_b128 v[92:95],v2 offset:96
s_waitcnt lgkmcnt(8)
v_smfmac_f32_16x16x64_bf16 v[116:119],v[124:127],v[80:87],v14
ds_read_b128 v[80:83],v18 offset:22528
ds_read_b128 v[84:87],v18 offset:23552
s_waitcnt lgkmcnt(2)
v_and_b32 v120,v12,v88
v_and_b32 v121,v13,v88
v_and_b32 v122,v12,v92
v_and_b32 v123,v13,v92
s_waitcnt lgkmcnt(8)
s_nop 0
v_smfmac_f32_16x16x64_bf16 v[116:119],v[120:123],v[108:115],v14
ds_read_b128 v[108:111],v18 offset:24576
ds_read_b128 v[112:115],v18 offset:25600
v_and_b32 v124,v12,v89
v_and_b32 v125,v13,v89
v_and_b32 v126,v12,v93
v_and_b32 v127,v13,v93
s_waitcnt lgkmcnt(8)
s_nop 0
v_smfmac_f32_16x16x64_bf16 v[116:119],v[124:127],v[64:71],v14
ds_read_b128 v[64:67],v18 offset:26624
ds_read_b128 v[68:71],v18 offset:27648
v_and_b32 v120,v12,v90
v_and_b32 v121,v13,v90
v_and_b32 v122,v12,v94
v_and_b32 v123,v13,v94
s_waitcnt lgkmcnt(8)
s_nop 0
v_smfmac_f32_16x16x64_bf16 v[116:119],v[120:123],v[72:79],v14
ds_read_b128 v[72:75],v18 offset:28672
ds_read_b128 v[76:79],v18 offset:29696
v_and_b32 v124,v12,v91
v_and_b32 v125,v13,v91
v_and_b32 v126,v12,v95
v_and_b32 v127,v13,v95
ds_read_b128 v[88:91],v2 offset:48
ds_read_b128 v[92:95],v2 offset:112
s_waitcnt lgkmcnt(8)
v_smfmac_f32_16x16x64_bf16 v[116:119],v[124:127],v[80:87],v14
ds_read_b128 v[80:83],v18 offset:30720
ds_read_b128 v[84:87],v18 offset:31744
s_waitcnt lgkmcnt(2)
v_and_b32 v120,v12,v88
v_and_b32 v121,v13,v88
v_and_b32 v122,v12,v92
v_and_b32 v123,v13,v92
s_waitcnt lgkmcnt(8)
s_nop 0
v_smfmac_f32_16x16x64_bf16 v[116:119],v[120:123],v[108:115],v14
v_and_b32 v124,v12,v89
v_and_b32 v125,v13,v89
v_and_b32 v126,v12,v93
v_and_b32 v127,v13,v93
s_waitcnt lgkmcnt(6)
s_nop 0
v_smfmac_f32_16x16x64_bf16 v[116:119],v[124:127],v[64:71],v14
buffer_load_dwordx4 v[64:67],v11,s[4:7],s63 offen offset:2048
buffer_load_dwordx4 v[68:71],v11,s[4:7],s63 offen offset:3072
v_and_b32 v120,v12,v90
v_and_b32 v121,v13,v90
v_and_b32 v122,v12,v94
v_and_b32 v123,v13,v94
s_waitcnt lgkmcnt(4)
s_nop 0
v_smfmac_f32_16x16x64_bf16 v[116:119],v[120:123],v[72:79],v14
s_add_u32 s63,s63,4096
buffer_load_dwordx4 v[72:75],v11,s[4:7],s63 offen offset:0
buffer_load_dwordx4 v[76:79],v11,s[4:7],s63 offen offset:1024
v_and_b32 v124,v12,v91
v_and_b32 v125,v13,v91
v_and_b32 v126,v12,v95
v_and_b32 v127,v13,v95
s_waitcnt lgkmcnt(0)
s_nop 0
v_smfmac_f32_16x16x64_bf16 v[116:119],v[124:127],v[80:87],v14
buffer_load_dwordx4 v[80:83],v11,s[4:7],s63 offen offset:2048
buffer_load_dwordx4 v[84:87],v11,s[4:7],s63 offen offset:3072
v_lshlrev_b32 v8,5,v9
v_and_b32 v124,1,v10
v_lshl_add_u32 v8,v124,4,v8
v_lshrrev_b32 v124,1,v10
v_lshl_add_u32 v8,v124,11,v8
s_lshl_b32 s60,s46,9
s_add_u32 s60,s60,147456
v_add_u32 v8,s60,v8
ds_write_b128 v8,v[116:119]
v_lshlrev_b32 v8,2,v1
v_add_u32 v8,147456,v8
v_and_b32 v2,1,v1
v_lshrrev_b32 v3,1,v1
v_lshlrev_b32 v3,2,v3
v_lshl_add_u32 v2,v2,7,v3
v_add_u32 v2,s58,v2
v_lshlrev_b32 v3,6,v10
v_add_u32 v3,s58,v3
s_waitcnt lgkmcnt(0)
s_barrier
ds_read2st64_b32 v[88:89],v8 offset0:0 offset1:1
ds_read2st64_b32 v[90:91],v8 offset0:2 offset1:3
ds_read2st64_b32 v[92:93],v8 offset0:4 offset1:5
ds_read2st64_b32 v[94:95],v8 offset0:6 offset1:7
s_waitcnt lgkmcnt(0)
v_pk_add_f32 v[88:89],v[88:89],v[90:91]
v_pk_add_f32 v[92:93],v[92:93],v[94:95]
v_pk_add_f32 v[88:89],v[88:89],v[92:93]
v_cvt_pk_bf16_f32 v88,v88,v88
v_and_b32 v88,0xffff0000,v88
v_cvt_pk_bf16_f32 v89,v89,v89
v_and_b32 v89,0xffff0000,v89
v_mul_f32 v90,0xbfb8aa3b,v88
v_exp_f32 v90,v90
s_nop 0
v_add_f32 v90,1.0,v90
v_rcp_f32 v90,v90
s_nop 0
v_mul_f32 v88,v88,v90
v_cvt_pk_bf16_f32 v88,v88,v88
v_and_b32 v88,0xffff0000,v88
v_mul_f32 v88,v88,v89
v_cvt_pk_bf16_f32 v88,v88,v88
ds_write_b32 v2,v88
ds_read_b128 v[88:91],v3
ds_read_b128 v[108:111],v3 offset:32
ds_read_b128 v[92:95],v3 offset:16
ds_read_b128 v[112:115],v3 offset:48
v_mov_b64 v[116:117],0
v_mov_b64 v[118:119],0
s_waitcnt vmcnt(0) lgkmcnt(0)
v_and_b32 v120,v12,v88
v_and_b32 v121,v13,v88
v_and_b32 v122,v12,v108
v_and_b32 v123,v13,v108
v_and_b32 v124,v12,v89
v_and_b32 v125,v13,v89
v_smfmac_f32_16x16x64_bf16 v[116:119],v[120:123],v[24:31],v14
v_and_b32 v126,v12,v109
v_and_b32 v127,v13,v109
v_and_b32 v120,v12,v90
v_and_b32 v121,v13,v90
v_smfmac_f32_16x16x64_bf16 v[116:119],v[124:127],v[32:39],v14
v_and_b32 v122,v12,v110
v_and_b32 v123,v13,v110
v_and_b32 v124,v12,v91
v_and_b32 v125,v13,v91
v_smfmac_f32_16x16x64_bf16 v[116:119],v[120:123],v[40:47],v14
v_and_b32 v126,v12,v111
v_and_b32 v127,v13,v111
v_and_b32 v120,v12,v92
v_and_b32 v121,v13,v92
v_smfmac_f32_16x16x64_bf16 v[116:119],v[124:127],v[48:55],v14
v_and_b32 v122,v12,v112
v_and_b32 v123,v13,v112
v_and_b32 v124,v12,v93
v_and_b32 v125,v13,v93
v_smfmac_f32_16x16x64_bf16 v[116:119],v[120:123],v[56:63],v14
v_and_b32 v126,v12,v113
v_and_b32 v127,v13,v113
v_and_b32 v120,v12,v94
v_and_b32 v121,v13,v94
v_smfmac_f32_16x16x64_bf16 v[116:119],v[124:127],v[64:71],v14
v_and_b32 v122,v12,v114
v_and_b32 v123,v13,v114
v_and_b32 v124,v12,v95
v_and_b32 v125,v13,v95
v_smfmac_f32_16x16x64_bf16 v[116:119],v[120:123],v[72:79],v14
v_and_b32 v126,v12,v115
v_and_b32 v127,v13,v115
s_nop 1
v_smfmac_f32_16x16x64_bf16 v[116:119],v[124:127],v[80:87],v14
v_lshlrev_b32 v8,4,v9
v_and_b32 v124,1,v10
v_lshl_add_u32 v8,v124,3,v8
v_and_b32 v124,2,v10
v_lshl_add_u32 v8,v124,30,v8
s_lshl_b32 s60,s46,8
s_add_u32 s59,s62,s60
s_nop 0
v_cvt_pk_bf16_f32 v24,v116,v117
v_cvt_pk_bf16_f32 v25,v118,v119
buffer_store_dwordx2 v[24:25],v8,s[8:11],s59 offen
s_lshl_b32 s59,s51,13
s_lshl2_add_u32 s59,s47,s59
s_add_u32 s59,s59,10486912
s_waitcnt vmcnt(0)
s_barrier
s_or_b32 s59,s59,s52
buffer_store_dword v17,off,s[8:11],s59
s_lshl_b32 s59,s51,13
s_add_u32 s59,s59,10486912
v_and_b32 v124,31,v1
v_lshlrev_b32 v124,2,v124
L_fw_44:
buffer_load_dword v125,v124,s[8:11],s59 offen sc1
s_sub_u32 s49,s49,1
s_cbranch_scc1 L_abort
s_waitcnt vmcnt(0)
v_cmp_eq_u32 vcc,0,v125
s_cbranch_vccnz L_fw_44
s_add_u32 s63,s65,0
buffer_load_dwordx4 v[24:27],v22,s[8:11],s63 offen sc1
s_add_u32 s63,s65,4096
buffer_load_dwordx4 v[28:31],v22,s[8:11],s63 offen sc1
s_add_u32 s63,s65,8192
buffer_load_dwordx4 v[32:35],v22,s[8:11],s63 offen sc1
s_add_u32 s63,s65,12288
buffer_load_dwordx4 v[36:39],v22,s[8:11],s63 offen sc1
s_add_u32 s63,s65,16384
buffer_load_dwordx4 v[40:43],v22,s[8:11],s63 offen sc1
s_add_u32 s63,s65,20480
buffer_load_dwordx4 v[44:47],v22,s[8:11],s63 offen sc1
s_add_u32 s63,s65,24576
buffer_load_dwordx4 v[48:51],v22,s[8:11],s63 offen sc1
s_add_u32 s63,s65,28672
buffer_load_dwordx4 v[52:55],v22,s[8:11],s63 offen sc1
v_and_b32 v64,15,v1
v_and_b32 v65,1,v1
v_lshlrev_b32 v65,4,v65
v_mov_b32 v66,0x3f80
v_lshlrev_b32 v66,v65,v66
v_lshrrev_b32 v64,1,v64
v_cmp_eq_u32 vcc,0,v64
s_nop 1
v_cndmask_b32 v56,0,v66,vcc
v_cmp_eq_u32 vcc,1,v64
s_nop 1
v_cndmask_b32 v57,0,v66,vcc
v_cmp_eq_u32 vcc,2,v64
s_nop 1
v_cndmask_b32 v58,0,v66,vcc
v_cmp_eq_u32 vcc,3,v64
s_nop 1
v_cndmask_b32 v59,0,v66,vcc
s_waitcnt vmcnt(7)
s_nop 0
v_mfma_f32_16x16x32_bf16 v[60:63],v[56:59],v[24:27],0
s_waitcnt vmcnt(6)
v_mfma_f32_16x16x32_bf16 v[60:63],v[56:59],v[28:31],v[60:63]
s_waitcnt vmcnt(5)
v_mfma_f32_16x16x32_bf16 v[60:63],v[56:59],v[32:35],v[60:63]
s_waitcnt vmcnt(4)
v_mfma_f32_16x16x32_bf16 v[60:63],v[56:59],v[36:39],v[60:63]
s_waitcnt vmcnt(3)
v_mfma_f32_16x16x32_bf16 v[60:63],v[56:59],v[40:43],v[60:63]
s_waitcnt vmcnt(2)
v_mfma_f32_16x16x32_bf16 v[60:63],v[56:59],v[44:47],v[60:63]
s_waitcnt vmcnt(1)
v_mfma_f32_16x16x32_bf16 v[60:63],v[56:59],v[48:51],v[60:63]
s_waitcnt vmcnt(0)
v_mfma_f32_16x16x32_bf16 v[60:63],v[56:59],v[52:55],v[60:63]
s_nop 7
ds_write_b128 v21,v[60:63]
s_waitcnt lgkmcnt(0)
s_barrier
s_cmp_lg_u32 s46,0
s_cbranch_scc1 L_moed_43
v_lshlrev_b32 v56,5,v1
v_add_u32 v56,155648,v56
ds_read_b128 v[24:27],v56
ds_read_b128 v[28:31],v56 offset:16
s_and_b32 s59,s54,0xffff0000
s_xor_b32 s60,s59,0x80000000
s_xor_b32 s61,s59,0xffff0000
s_cmp_lt_i32 s59,0
s_cselect_b32 s59,s60,s61
v_mov_b32 v56,s59
v_mul_f32 v56,0xbfb8aa3b,v56
v_exp_f32 v56,v56
s_nop 0
v_add_f32 v56,1.0,v56
v_rcp_f32 v56,v56
s_nop 0
v_cvt_pk_bf16_f32 v56,v56,v56
v_and_b32 v56,0xffff0000,v56
v_lshlrev_b32 v48,16,v104
v_and_b32 v49,0xffff0000,v104
v_lshlrev_b32 v50,16,v105
v_and_b32 v51,0xffff0000,v105
v_lshlrev_b32 v52,16,v106
v_and_b32 v53,0xffff0000,v106
v_lshlrev_b32 v54,16,v107
v_and_b32 v55,0xffff0000,v107
s_waitcnt lgkmcnt(0)
v_cvt_pk_bf16_f32 v40,v24,v25
v_cvt_pk_bf16_f32 v41,v26,v27
v_cvt_pk_bf16_f32 v42,v28,v29
v_cvt_pk_bf16_f32 v43,v30,v31
v_lshlrev_b32 v24,16,v40
v_and_b32 v25,0xffff0000,v40
v_lshlrev_b32 v26,16,v41
v_and_b32 v27,0xffff0000,v41
v_lshlrev_b32 v28,16,v42
v_and_b32 v29,0xffff0000,v42
v_lshlrev_b32 v30,16,v43
v_and_b32 v31,0xffff0000,v43
v_pk_mul_f32 v[24:25],v[24:25],v[56:57] op_sel_hi:[1,0]
v_pk_mul_f32 v[26:27],v[26:27],v[56:57] op_sel_hi:[1,0]
v_pk_mul_f32 v[28:29],v[28:29],v[56:57] op_sel_hi:[1,0]
v_pk_mul_f32 v[30:31],v[30:31],v[56:57] op_sel_hi:[1,0]
v_cvt_pk_bf16_f32 v40,v24,v25
v_cvt_pk_bf16_f32 v41,v26,v27
v_cvt_pk_bf16_f32 v42,v28,v29
v_cvt_pk_bf16_f32 v43,v30,v31
v_lshlrev_b32 v24,16,v40
v_and_b32 v25,0xffff0000,v40
v_lshlrev_b32 v26,16,v41
v_and_b32 v27,0xffff0000,v41
v_lshlrev_b32 v28,16,v42
v_and_b32 v29,0xffff0000,v42
v_lshlrev_b32 v30,16,v43
v_and_b32 v31,0xffff0000,v43
v_pk_add_f32 v[24:25],v[24:25],v[48:49]
v_pk_add_f32 v[26:27],v[26:27],v[50:51]
v_pk_add_f32 v[28:29],v[28:29],v[52:53]
v_pk_add_f32 v[30:31],v[30:31],v[54:55]
v_cvt_pk_bf16_f32 v40,v24,v25
v_cvt_pk_bf16_f32 v41,v26,v27
v_cvt_pk_bf16_f32 v42,v28,v29
v_cvt_pk_bf16_f32 v43,v30,v31
v_lshlrev_b32 v24,16,v40
v_and_b32 v25,0xffff0000,v40
v_lshlrev_b32 v26,16,v41
v_and_b32 v27,0xffff0000,v41
v_lshlrev_b32 v28,16,v42
v_and_b32 v29,0xffff0000,v42
v_lshlrev_b32 v30,16,v43
v_and_b32 v31,0xffff0000,v43
v_pk_add_f32 v[96:97],v[96:97],v[24:25]
v_pk_add_f32 v[98:99],v[98:99],v[26:27]
v_pk_add_f32 v[100:101],v[100:101],v[28:29]
v_pk_add_f32 v[102:103],v[102:103],v[30:31]
v_cvt_pk_bf16_f32 v80,v96,v97
v_cvt_pk_bf16_f32 v81,v98,v99
v_cvt_pk_bf16_f32 v82,v100,v101
v_cvt_pk_bf16_f32 v83,v102,v103
v_lshlrev_b32 v96,16,v80
v_and_b32 v97,0xffff0000,v80
v_lshlrev_b32 v98,16,v81
v_and_b32 v99,0xffff0000,v81
v_lshlrev_b32 v100,16,v82
v_and_b32 v101,0xffff0000,v82
v_lshlrev_b32 v102,16,v83
v_and_b32 v103,0xffff0000,v83
v_readfirstlane_b32 s78,v96
s_nop 1
v_pk_add_f32 v[58:59],v[96:97],s[78:79] op_sel_hi:[1,0] neg_lo:[0,1] neg_hi:[0,1]
v_pk_add_f32 v[60:61],v[98:99],s[78:79] op_sel_hi:[1,0] neg_lo:[0,1] neg_hi:[0,1]
v_pk_add_f32 v[62:63],v[100:101],s[78:79] op_sel_hi:[1,0] neg_lo:[0,1] neg_hi:[0,1]
v_pk_add_f32 v[64:65],v[102:103],s[78:79] op_sel_hi:[1,0] neg_lo:[0,1] neg_hi:[0,1]
v_pk_add_f32 v[66:67],v[58:59],v[60:61]
v_pk_mul_f32 v[68:69],v[58:59],v[58:59]
v_pk_add_f32 v[70:71],v[62:63],v[64:65]
v_pk_fma_f32 v[68:69],v[60:61],v[60:61],v[68:69]
v_pk_add_f32 v[66:67],v[66:67],v[70:71]
v_pk_fma_f32 v[68:69],v[62:63],v[62:63],v[68:69]
v_add_f32 v66,v66,v67
v_pk_fma_f32 v[68:69],v[64:65],v[64:65],v[68:69]
v_add_f32 v68,v68,v69
s_nop 1
v_permlane32_swap_b32 v66,v68
v_add_f32 v66,v66,v68
s_nop 1
v_add_f32_dpp v66,v66,v66 row_ror:8 row_mask:0xf bank_mask:0xf
s_nop 1
v_add_f32_dpp v66,v66,v66 row_ror:4 row_mask:0xf bank_mask:0xf
s_nop 1
v_add_f32_dpp v66,v66,v66 row_ror:2 row_mask:0xf bank_mask:0xf
s_nop 1
v_add_f32_dpp v66,v66,v66 row_ror:1 row_mask:0xf bank_mask:0xf
v_mov_b32 v68,v66
s_nop 1
v_permlane16_swap_b32 v66,v68
v_add_f32 v66,v66,v68
v_mul_f32 v66,0x3b000000,v66
v_mov_b32 v68,v66
s_nop 1
v_permlane32_swap_b32 v66,v68
v_fma_f32 v68,-v66,v66,v68
v_add_f32 v66,s78,v66
v_max_f32 v68,0,v68
v_cvt_pk_bf16_f32 v68,v66,v68
v_lshlrev_b32 v66,16,v68
v_and_b32 v68,0xffff0000,v68
v_add_f32 v68,0x3727c5ac,v68
v_cvt_pk_bf16_f32 v68,v68,v68
v_and_b32 v68,0xffff0000,v68
v_sqrt_f32 v68,v68
v_pk_add_f32 v[58:59],v[96:97],v[66:67] op_sel_hi:[1,0] neg_lo:[0,1] neg_hi:[0,1]
v_pk_add_f32 v[60:61],v[98:99],v[66:67] op_sel_hi:[1,0] neg_lo:[0,1] neg_hi:[0,1]
v_pk_add_f32 v[62:63],v[100:101],v[66:67] op_sel_hi:[1,0] neg_lo:[0,1] neg_hi:[0,1]
v_pk_add_f32 v[64:65],v[102:103],v[66:67] op_sel_hi:[1,0] neg_lo:[0,1] neg_hi:[0,1]
v_cvt_pk_bf16_f32 v68,v68,v68
v_and_b32 v68,0xffff0000,v68
v_rcp_f32 v68,v68
v_cvt_pk_bf16_f32 v84,v58,v59
v_cvt_pk_bf16_f32 v85,v60,v61
v_cvt_pk_bf16_f32 v86,v62,v63
v_cvt_pk_bf16_f32 v87,v64,v65
v_lshlrev_b32 v58,16,v84
v_and_b32 v59,0xffff0000,v84
v_lshlrev_b32 v60,16,v85
v_and_b32 v61,0xffff0000,v85
v_lshlrev_b32 v62,16,v86
v_and_b32 v63,0xffff0000,v86
v_lshlrev_b32 v64,16,v87
v_and_b32 v65,0xffff0000,v87
v_pk_mul_f32 v[58:59],v[58:59],v[68:69] op_sel_hi:[1,0]
v_pk_mul_f32 v[60:61],v[60:61],v[68:69] op_sel_hi:[1,0]
v_pk_mul_f32 v[62:63],v[62:63],v[68:69] op_sel_hi:[1,0]
v_pk_mul_f32 v[64:65],v[64:65],v[68:69] op_sel_hi:[1,0]
v_cvt_pk_bf16_f32 v84,v58,v59
v_cvt_pk_bf16_f32 v85,v60,v61
v_cvt_pk_bf16_f32 v86,v62,v63
v_cvt_pk_bf16_f32 v87,v64,v65
s_lshl_b32 s58,s51,10
s_add_u32 s58,s58,11272192
s_add_u32 s59,s58,65536
s_cmp_eq_u32 s47,0
s_cselect_b32 s59,s59,0x80000000
s_add_u32 s57,s56,98566144
buffer_store_dwordx4 v[84:87],v0,s[8:11],s59 offen sc1
buffer_store_dwordx4 v[80:83],v0,s[8:11],s58 offen sc1
buffer_store_dwordx4 v[84:87],v0,s[8:11],s57 offen sc1
L_moed_43:
s_barrier
L_mo_30:
s_mov_b32 s77,-1
s_cmp_lt_u32 s31,64
s_cbranch_scc1 L_mo_26
s_cmp_eq_u32 s86,0
s_cbranch_scc1 L_mo_39
L_mo_32:
s_andn2_b32 s51,0x7ff,s54
s_lshr_b32 s51,s51,5
s_andn2_b32 s56,31,s54
v_lshrrev_b32 v2,10,v20
v_add_u32 v3,16,v2
v_add_u32 v8,96468992,v20
v_cmp_eq_u32 vcc,s56,v2
s_nop 1
v_cndmask_b32 v2,v20,v8,vcc
v_cmp_eq_u32 vcc,s56,v3
s_nop 1
v_cndmask_b32 v3,v20,v8,vcc
s_waitcnt vmcnt(0)
s_lshl_b32 s59,s51,13
s_add_u32 s59,s59,10487552
s_cmp_lg_u32 s46,0
s_cbranch_scc1 L_fd_48
v_and_b32 v124,31,v1
v_lshlrev_b32 v124,2,v124
s_branch L_ff_49
L_fw_47:
s_sleep 2
L_ff_49:
buffer_load_dword v125,v124,s[8:11],s59 offen sc1
s_sub_u32 s49,s49,1
s_cbranch_scc1 L_abort
s_waitcnt vmcnt(0)
v_cmp_eq_u32 vcc,0,v125
s_cbranch_vccnz L_fw_47
L_fd_48:
s_barrier
s_or_b32 s72,s72,s52
buffer_store_dword v17,off,s[8:11],s72 sc1
s_lshl_b32 s66,s51,15
s_add_u32 s66,s66,2097152
s_add_u32 s67,s66,16384
s_add_u32 m0,s50,131072
s_nop 0
buffer_load_dwordx4 v2,s[8:11],s66 offen offset:0 sc1 lds
s_add_u32 m0,s50,135168
s_nop 0
buffer_load_dwordx4 v3,s[8:11],s67 offen offset:0 sc1 lds
s_add_u32 m0,s50,139008
s_nop 0
buffer_load_dwordx4 v2,s[8:11],s66 offen offset:256 sc1 lds
s_add_u32 m0,s50,143104
s_nop 0
buffer_load_dwordx4 v3,s[8:11],s67 offen offset:256 sc1 lds
s_add_u32 m0,s50,146944
s_nop 0
buffer_load_dwordx4 v2,s[8:11],s66 offen offset:512 sc1 lds
s_add_u32 m0,s50,151040
s_nop 0
buffer_load_dwordx4 v3,s[8:11],s67 offen offset:512 sc1 lds
s_waitcnt vmcnt(4)
s_barrier
ds_read_b128 v[104:107],v4 offset:0
ds_read_b128 v[108:111],v4 offset:4096
ds_read_b128 v[112:115],v5 offset:0
ds_read_b128 v[116:119],v5 offset:4096
s_add_u32 m0,s50,154880
s_nop 0
buffer_load_dwordx4 v2,s[8:11],s66 offen offset:768 sc1 lds
s_add_u32 m0,s50,158976
s_nop 0
buffer_load_dwordx4 v3,s[8:11],s67 offen offset:768 sc1 lds
s_waitcnt lgkmcnt(2)
v_mfma_f32_16x16x32_bf16 v[24:27],a[128:131],v[104:107],0
ds_read_b128 v[120:123],v6 offset:0
v_mfma_f32_16x16x32_bf16 v[40:43],v[104:107],v[128:131],0
s_lshl_b32 s58,s51,5
v_mfma_f32_16x16x32_bf16 v[28:31],a[128:131],v[108:111],0
ds_read_b128 v[124:127],v6 offset:4096
v_mfma_f32_16x16x32_bf16 v[44:47],v[108:111],v[128:131],0
s_add_u32 s58,s58,s47
v_mfma_f32_16x16x32_bf16 v[32:35],a[136:139],v[104:107],0
s_mul_i32 s58,s58,24576
v_mfma_f32_16x16x32_bf16 v[48:51],v[104:107],v[136:139],0
s_add_u32 s58,s58,201326592
v_mfma_f32_16x16x32_bf16 v[36:39],a[136:139],v[108:111],0
s_add_u32 s61,s58,s50
v_mfma_f32_16x16x32_bf16 v[52:55],v[108:111],v[136:139],0
s_add_u32 s62,s61,4096
s_waitcnt lgkmcnt(2)
v_mfma_f32_16x16x32_bf16 v[24:27],a[132:135],v[112:115],v[24:27]
ds_read_b128 v[104:107],v7 offset:0
v_mfma_f32_16x16x32_bf16 v[40:43],v[112:115],v[132:135],v[40:43]
s_add_u32 s63,s61,16384
v_mfma_f32_16x16x32_bf16 v[28:31],a[132:135],v[116:119],v[28:31]
ds_read_b128 v[108:111],v7 offset:4096
v_mfma_f32_16x16x32_bf16 v[44:47],v[116:119],v[132:135],v[44:47]
s_add_u32 s64,s61,20480
v_mfma_f32_16x16x32_bf16 v[32:35],a[140:143],v[112:115],v[32:35]
s_add_u32 s65,s61,s50
v_mfma_f32_16x16x32_bf16 v[48:51],v[112:115],v[140:143],v[48:51]
s_add_u32 s65,s65,8192
v_mfma_f32_16x16x32_bf16 v[36:39],a[140:143],v[116:119],v[36:39]
v_mfma_f32_16x16x32_bf16 v[52:55],v[116:119],v[140:143],v[52:55]
s_waitcnt vmcnt(4)
s_barrier
s_waitcnt lgkmcnt(2)
v_mfma_f32_16x16x32_bf16 v[24:27],a[144:147],v[120:123],v[24:27]
ds_read_b128 v[112:115],v4 offset:8192
v_mfma_f32_16x16x32_bf16 v[40:43],v[120:123],v[144:147],v[40:43]
v_mfma_f32_16x16x32_bf16 v[28:31],a[144:147],v[124:127],v[28:31]
ds_read_b128 v[116:119],v4 offset:12288
v_mfma_f32_16x16x32_bf16 v[44:47],v[124:127],v[144:147],v[44:47]
v_mfma_f32_16x16x32_bf16 v[32:35],a[152:155],v[120:123],v[32:35]
v_mfma_f32_16x16x32_bf16 v[48:51],v[120:123],v[152:155],v[48:51]
v_mfma_f32_16x16x32_bf16 v[36:39],a[152:155],v[124:127],v[36:39]
v_mfma_f32_16x16x32_bf16 v[52:55],v[124:127],v[152:155],v[52:55]
s_waitcnt lgkmcnt(2)
v_mfma_f32_16x16x32_bf16 v[24:27],a[148:151],v[104:107],v[24:27]
ds_read_b128 v[120:123],v5 offset:8192
v_mfma_f32_16x16x32_bf16 v[40:43],v[104:107],v[148:151],v[40:43]
v_mfma_f32_16x16x32_bf16 v[28:31],a[148:151],v[108:111],v[28:31]
ds_read_b128 v[124:127],v5 offset:12288
v_mfma_f32_16x16x32_bf16 v[44:47],v[108:111],v[148:151],v[44:47]
v_mfma_f32_16x16x32_bf16 v[32:35],a[156:159],v[104:107],v[32:35]
v_mfma_f32_16x16x32_bf16 v[48:51],v[104:107],v[156:159],v[48:51]
v_mfma_f32_16x16x32_bf16 v[36:39],a[156:159],v[108:111],v[36:39]
v_mfma_f32_16x16x32_bf16 v[52:55],v[108:111],v[156:159],v[52:55]
s_waitcnt lgkmcnt(2)
v_mfma_f32_16x16x32_bf16 v[24:27],a[160:163],v[112:115],v[24:27]
ds_read_b128 v[104:107],v6 offset:8192
v_mfma_f32_16x16x32_bf16 v[40:43],v[112:115],v[160:163],v[40:43]
v_mfma_f32_16x16x32_bf16 v[28:31],a[160:163],v[116:119],v[28:31]
ds_read_b128 v[108:111],v6 offset:12288
v_mfma_f32_16x16x32_bf16 v[44:47],v[116:119],v[160:163],v[44:47]
v_mfma_f32_16x16x32_bf16 v[32:35],a[168:171],v[112:115],v[32:35]
v_mfma_f32_16x16x32_bf16 v[48:51],v[112:115],v[168:171],v[48:51]
v_mfma_f32_16x16x32_bf16 v[36:39],a[168:171],v[116:119],v[36:39]
v_mfma_f32_16x16x32_bf16 v[52:55],v[116:119],v[168:171],v[52:55]
s_waitcnt lgkmcnt(2)
v_mfma_f32_16x16x32_bf16 v[24:27],a[164:167],v[120:123],v[24:27]
ds_read_b128 v[112:115],v7 offset:8192
v_mfma_f32_16x16x32_bf16 v[40:43],v[120:123],v[164:167],v[40:43]
v_mfma_f32_16x16x32_bf16 v[28:31],a[164:167],v[124:127],v[28:31]
ds_read_b128 v[116:119],v7 offset:12288
v_mfma_f32_16x16x32_bf16 v[44:47],v[124:127],v[164:167],v[44:47]
v_mfma_f32_16x16x32_bf16 v[32:35],a[172:175],v[120:123],v[32:35]
v_mfma_f32_16x16x32_bf16 v[48:51],v[120:123],v[172:175],v[48:51]
v_mfma_f32_16x16x32_bf16 v[36:39],a[172:175],v[124:127],v[36:39]
v_mfma_f32_16x16x32_bf16 v[52:55],v[124:127],v[172:175],v[52:55]
s_waitcnt vmcnt(2)
s_barrier
s_waitcnt lgkmcnt(2)
v_mfma_f32_16x16x32_bf16 v[24:27],a[176:179],v[104:107],v[24:27]
ds_read_b128 v[120:123],v4 offset:16384
v_mfma_f32_16x16x32_bf16 v[40:43],v[104:107],v[176:179],v[40:43]
v_mfma_f32_16x16x32_bf16 v[28:31],a[176:179],v[108:111],v[28:31]
ds_read_b128 v[124:127],v4 offset:20480
v_mfma_f32_16x16x32_bf16 v[44:47],v[108:111],v[176:179],v[44:47]
v_mfma_f32_16x16x32_bf16 v[32:35],a[184:187],v[104:107],v[32:35]
v_mfma_f32_16x16x32_bf16 v[48:51],v[104:107],v[184:187],v[48:51]
v_mfma_f32_16x16x32_bf16 v[36:39],a[184:187],v[108:111],v[36:39]
v_mfma_f32_16x16x32_bf16 v[52:55],v[108:111],v[184:187],v[52:55]
s_waitcnt lgkmcnt(2)
v_mfma_f32_16x16x32_bf16 v[24:27],a[180:183],v[112:115],v[24:27]
ds_read_b128 v[104:107],v5 offset:16384
v_mfma_f32_16x16x32_bf16 v[40:43],v[112:115],v[180:183],v[40:43]
v_mfma_f32_16x16x32_bf16 v[28:31],a[180:183],v[116:119],v[28:31]
ds_read_b128 v[108:111],v5 offset:20480
v_mfma_f32_16x16x32_bf16 v[44:47],v[116:119],v[180:183],v[44:47]
v_mfma_f32_16x16x32_bf16 v[32:35],a[188:191],v[112:115],v[32:35]
v_mfma_f32_16x16x32_bf16 v[48:51],v[112:115],v[188:191],v[48:51]
v_mfma_f32_16x16x32_bf16 v[36:39],a[188:191],v[116:119],v[36:39]
v_mfma_f32_16x16x32_bf16 v[52:55],v[116:119],v[188:191],v[52:55]
s_waitcnt lgkmcnt(2)
v_mfma_f32_16x16x32_bf16 v[24:27],a[192:195],v[120:123],v[24:27]
ds_read_b128 v[112:115],v6 offset:16384
v_mfma_f32_16x16x32_bf16 v[40:43],v[120:123],v[192:195],v[40:43]
v_mfma_f32_16x16x32_bf16 v[28:31],a[192:195],v[124:127],v[28:31]
ds_read_b128 v[116:119],v6 offset:20480
v_mfma_f32_16x16x32_bf16 v[44:47],v[124:127],v[192:195],v[44:47]
v_mfma_f32_16x16x32_bf16 v[32:35],a[200:203],v[120:123],v[32:35]
v_mfma_f32_16x16x32_bf16 v[48:51],v[120:123],v[200:203],v[48:51]
v_mfma_f32_16x16x32_bf16 v[36:39],a[200:203],v[124:127],v[36:39]
v_mfma_f32_16x16x32_bf16 v[52:55],v[124:127],v[200:203],v[52:55]
s_waitcnt lgkmcnt(2)
v_mfma_f32_16x16x32_bf16 v[24:27],a[196:199],v[104:107],v[24:27]
ds_read_b128 v[120:123],v7 offset:16384
v_mfma_f32_16x16x32_bf16 v[40:43],v[104:107],v[196:199],v[40:43]
v_mfma_f32_16x16x32_bf16 v[28:31],a[196:199],v[108:111],v[28:31]
ds_read_b128 v[124:127],v7 offset:20480
v_mfma_f32_16x16x32_bf16 v[44:47],v[108:111],v[196:199],v[44:47]
v_mfma_f32_16x16x32_bf16 v[32:35],a[204:207],v[104:107],v[32:35]
v_mfma_f32_16x16x32_bf16 v[48:51],v[104:107],v[204:207],v[48:51]
v_mfma_f32_16x16x32_bf16 v[36:39],a[204:207],v[108:111],v[36:39]
v_mfma_f32_16x16x32_bf16 v[52:55],v[108:111],v[204:207],v[52:55]
s_waitcnt vmcnt(0)
s_barrier
s_waitcnt lgkmcnt(2)
v_mfma_f32_16x16x32_bf16 v[24:27],a[208:211],v[112:115],v[24:27]
ds_read_b128 v[104:107],v4 offset:24576
v_mfma_f32_16x16x32_bf16 v[40:43],v[112:115],v[208:211],v[40:43]
v_mfma_f32_16x16x32_bf16 v[28:31],a[208:211],v[116:119],v[28:31]
ds_read_b128 v[108:111],v4 offset:28672
v_mfma_f32_16x16x32_bf16 v[44:47],v[116:119],v[208:211],v[44:47]
v_mfma_f32_16x16x32_bf16 v[32:35],a[216:219],v[112:115],v[32:35]
v_mfma_f32_16x16x32_bf16 v[48:51],v[112:115],v[216:219],v[48:51]
v_mfma_f32_16x16x32_bf16 v[36:39],a[216:219],v[116:119],v[36:39]
v_mfma_f32_16x16x32_bf16 v[52:55],v[116:119],v[216:219],v[52:55]
s_waitcnt lgkmcnt(2)
v_mfma_f32_16x16x32_bf16 v[24:27],a[212:215],v[120:123],v[24:27]
ds_read_b128 v[112:115],v5 offset:24576
v_mfma_f32_16x16x32_bf16 v[40:43],v[120:123],v[212:215],v[40:43]
v_mfma_f32_16x16x32_bf16 v[28:31],a[212:215],v[124:127],v[28:31]
ds_read_b128 v[116:119],v5 offset:28672
v_mfma_f32_16x16x32_bf16 v[44:47],v[124:127],v[212:215],v[44:47]
v_mfma_f32_16x16x32_bf16 v[32:35],a[220:223],v[120:123],v[32:35]
v_mfma_f32_16x16x32_bf16 v[48:51],v[120:123],v[220:223],v[48:51]
v_mfma_f32_16x16x32_bf16 v[36:39],a[220:223],v[124:127],v[36:39]
v_mfma_f32_16x16x32_bf16 v[52:55],v[124:127],v[220:223],v[52:55]
s_waitcnt lgkmcnt(2)
v_mfma_f32_16x16x32_bf16 v[24:27],a[224:227],v[104:107],v[24:27]
ds_read_b128 v[120:123],v6 offset:24576
v_mfma_f32_16x16x32_bf16 v[40:43],v[104:107],v[224:227],v[40:43]
v_mfma_f32_16x16x32_bf16 v[28:31],a[224:227],v[108:111],v[28:31]
ds_read_b128 v[124:127],v6 offset:28672
v_mfma_f32_16x16x32_bf16 v[44:47],v[108:111],v[224:227],v[44:47]
v_mfma_f32_16x16x32_bf16 v[32:35],a[232:235],v[104:107],v[32:35]
v_mfma_f32_16x16x32_bf16 v[48:51],v[104:107],v[232:235],v[48:51]
v_mfma_f32_16x16x32_bf16 v[36:39],a[232:235],v[108:111],v[36:39]
v_mfma_f32_16x16x32_bf16 v[52:55],v[108:111],v[232:235],v[52:55]
s_waitcnt lgkmcnt(2)
v_mfma_f32_16x16x32_bf16 v[24:27],a[228:231],v[112:115],v[24:27]
ds_read_b128 v[104:107],v7 offset:24576
v_mfma_f32_16x16x32_bf16 v[40:43],v[112:115],v[228:231],v[40:43]
v_mfma_f32_16x16x32_bf16 v[28:31],a[228:231],v[116:119],v[28:31]
ds_read_b128 v[108:111],v7 offset:28672
v_mfma_f32_16x16x32_bf16 v[44:47],v[116:119],v[228:231],v[44:47]
v_mfma_f32_16x16x32_bf16 v[32:35],a[236:239],v[112:115],v[32:35]
v_mfma_f32_16x16x32_bf16 v[48:51],v[112:115],v[236:239],v[48:51]
v_mfma_f32_16x16x32_bf16 v[36:39],a[236:239],v[116:119],v[36:39]
v_mfma_f32_16x16x32_bf16 v[52:55],v[116:119],v[236:239],v[52:55]
s_waitcnt lgkmcnt(2)
v_mfma_f32_16x16x32_bf16 v[24:27],a[240:243],v[120:123],v[24:27]
ds_read_b128 v[112:115],v4 offset:0
v_mfma_f32_16x16x32_bf16 v[40:43],v[120:123],v[240:243],v[40:43]
v_mfma_f32_16x16x32_bf16 v[28:31],a[240:243],v[124:127],v[28:31]
ds_read_b128 v[116:119],v4 offset:4096
v_mfma_f32_16x16x32_bf16 v[44:47],v[124:127],v[240:243],v[44:47]
v_mfma_f32_16x16x32_bf16 v[32:35],a[248:251],v[120:123],v[32:35]
v_mfma_f32_16x16x32_bf16 v[48:51],v[120:123],v[248:251],v[48:51]
v_mfma_f32_16x16x32_bf16 v[36:39],a[248:251],v[124:127],v[36:39]
v_mfma_f32_16x16x32_bf16 v[52:55],v[124:127],v[248:251],v[52:55]
s_waitcnt lgkmcnt(2)
v_mfma_f32_16x16x32_bf16 v[24:27],a[244:247],v[104:107],v[24:27]
ds_read_b128 v[120:123],v5 offset:0
v_mfma_f32_16x16x32_bf16 v[40:43],v[104:107],v[244:247],v[40:43]
v_mfma_f32_16x16x32_bf16 v[28:31],a[244:247],v[108:111],v[28:31]
ds_read_b128 v[124:127],v5 offset:4096
v_mfma_f32_16x16x32_bf16 v[44:47],v[108:111],v[244:247],v[44:47]
v_mfma_f32_16x16x32_bf16 v[32:35],a[252:255],v[104:107],v[32:35]
v_mfma_f32_16x16x32_bf16 v[48:51],v[104:107],v[252:255],v[48:51]
v_mfma_f32_16x16x32_bf16 v[36:39],a[252:255],v[108:111],v[36:39]
v_mfma_f32_16x16x32_bf16 v[52:55],v[108:111],v[252:255],v[52:55]
s_waitcnt lgkmcnt(2)
v_mfma_f32_16x16x32_bf16 v[88:91],a[0:3],v[112:115],0
ds_read_b128 v[104:107],v6 offset:0
v_mfma_f32_16x16x32_bf16 v[92:95],a[0:3],v[116:119],0
v_mfma_f32_16x16x32_bf16 v[96:99],a[8:11],v[112:115],0
ds_read_b128 v[108:111],v6 offset:4096
v_cvt_pk_bf16_f32 v56,v24,v32
v_cvt_pk_bf16_f32 v57,v25,v33
v_mfma_f32_16x16x32_bf16 v[100:103],a[8:11],v[116:119],0
v_cvt_pk_bf16_f32 v58,v26,v34
v_cvt_pk_bf16_f32 v59,v27,v35
s_waitcnt lgkmcnt(2)
v_mfma_f32_16x16x32_bf16 v[88:91],a[4:7],v[120:123],v[88:91]
ds_read_b128 v[112:115],v7 offset:0
v_mfma_f32_16x16x32_bf16 v[92:95],a[4:7],v[124:127],v[92:95]
buffer_store_dwordx4 v[56:59],v0,s[8:11],s61 offen sc1
v_cvt_pk_bf16_f32 v60,v28,v36
v_cvt_pk_bf16_f32 v61,v29,v37
v_mfma_f32_16x16x32_bf16 v[96:99],a[12:15],v[120:123],v[96:99]
ds_read_b128 v[116:119],v7 offset:4096
v_cvt_pk_bf16_f32 v62,v30,v38
v_cvt_pk_bf16_f32 v63,v31,v39
v_mfma_f32_16x16x32_bf16 v[100:103],a[12:15],v[124:127],v[100:103]
buffer_store_dwordx4 v[60:63],v0,s[8:11],s62 offen sc1
v_cvt_pk_bf16_f32 v64,v40,v41
v_cvt_pk_bf16_f32 v65,v42,v43
s_waitcnt lgkmcnt(2)
v_mfma_f32_16x16x32_bf16 v[88:91],a[16:19],v[104:107],v[88:91]
ds_read_b128 v[120:123],v4 offset:8192
v_cvt_pk_bf16_f32 v66,v44,v45
v_cvt_pk_bf16_f32 v67,v46,v47
v_mfma_f32_16x16x32_bf16 v[92:95],a[16:19],v[108:111],v[92:95]
buffer_store_dwordx4 v[64:67],v0,s[8:11],s65 offen offset:0 sc1
v_cvt_pk_bf16_f32 v68,v48,v49
v_cvt_pk_bf16_f32 v69,v50,v51
v_mfma_f32_16x16x32_bf16 v[96:99],a[24:27],v[104:107],v[96:99]
ds_read_b128 v[124:127],v4 offset:12288
v_cvt_pk_bf16_f32 v70,v52,v53
v_cvt_pk_bf16_f32 v71,v54,v55
v_mfma_f32_16x16x32_bf16 v[100:103],a[24:27],v[108:111],v[100:103]
buffer_store_dwordx4 v[68:71],v0,s[8:11],s65 offen offset:1024 sc1
s_waitcnt lgkmcnt(2)
v_mfma_f32_16x16x32_bf16 v[88:91],a[20:23],v[112:115],v[88:91]
ds_read_b128 v[104:107],v5 offset:8192
v_mfma_f32_16x16x32_bf16 v[92:95],a[20:23],v[116:119],v[92:95]
v_mfma_f32_16x16x32_bf16 v[96:99],a[28:31],v[112:115],v[96:99]
ds_read_b128 v[108:111],v5 offset:12288
v_mfma_f32_16x16x32_bf16 v[100:103],a[28:31],v[116:119],v[100:103]
s_waitcnt lgkmcnt(2)
v_mfma_f32_16x16x32_bf16 v[88:91],a[32:35],v[120:123],v[88:91]
ds_read_b128 v[112:115],v6 offset:8192
v_mfma_f32_16x16x32_bf16 v[92:95],a[32:35],v[124:127],v[92:95]
v_mfma_f32_16x16x32_bf16 v[96:99],a[40:43],v[120:123],v[96:99]
ds_read_b128 v[116:119],v6 offset:12288
v_mfma_f32_16x16x32_bf16 v[100:103],a[40:43],v[124:127],v[100:103]
s_waitcnt lgkmcnt(2)
v_mfma_f32_16x16x32_bf16 v[88:91],a[36:39],v[104:107],v[88:91]
ds_read_b128 v[120:123],v7 offset:8192
v_mfma_f32_16x16x32_bf16 v[92:95],a[36:39],v[108:111],v[92:95]
v_mfma_f32_16x16x32_bf16 v[96:99],a[44:47],v[104:107],v[96:99]
ds_read_b128 v[124:127],v7 offset:12288
v_mfma_f32_16x16x32_bf16 v[100:103],a[44:47],v[108:111],v[100:103]
s_waitcnt lgkmcnt(2)
v_mfma_f32_16x16x32_bf16 v[88:91],a[48:51],v[112:115],v[88:91]
ds_read_b128 v[104:107],v4 offset:16384
v_mfma_f32_16x16x32_bf16 v[92:95],a[48:51],v[116:119],v[92:95]
v_mfma_f32_16x16x32_bf16 v[96:99],a[56:59],v[112:115],v[96:99]
ds_read_b128 v[108:111],v4 offset:20480
v_mfma_f32_16x16x32_bf16 v[100:103],a[56:59],v[116:119],v[100:103]
s_waitcnt lgkmcnt(2)
v_mfma_f32_16x16x32_bf16 v[88:91],a[52:55],v[120:123],v[88:91]
ds_read_b128 v[112:115],v5 offset:16384
v_mfma_f32_16x16x32_bf16 v[92:95],a[52:55],v[124:127],v[92:95]
v_mfma_f32_16x16x32_bf16 v[96:99],a[60:63],v[120:123],v[96:99]
ds_read_b128 v[116:119],v5 offset:20480
v_mfma_f32_16x16x32_bf16 v[100:103],a[60:63],v[124:127],v[100:103]
s_waitcnt lgkmcnt(2)
v_mfma_f32_16x16x32_bf16 v[88:91],a[64:67],v[104:107],v[88:91]
ds_read_b128 v[120:123],v6 offset:16384
v_mfma_f32_16x16x32_bf16 v[92:95],a[64:67],v[108:111],v[92:95]
v_mfma_f32_16x16x32_bf16 v[96:99],a[72:75],v[104:107],v[96:99]
ds_read_b128 v[124:127],v6 offset:20480
v_mfma_f32_16x16x32_bf16 v[100:103],a[72:75],v[108:111],v[100:103]
s_waitcnt lgkmcnt(2)
v_mfma_f32_16x16x32_bf16 v[88:91],a[68:71],v[112:115],v[88:91]
ds_read_b128 v[104:107],v7 offset:16384
v_mfma_f32_16x16x32_bf16 v[92:95],a[68:71],v[116:119],v[92:95]
v_mfma_f32_16x16x32_bf16 v[96:99],a[76:79],v[112:115],v[96:99]
ds_read_b128 v[108:111],v7 offset:20480
v_mfma_f32_16x16x32_bf16 v[100:103],a[76:79],v[116:119],v[100:103]
s_waitcnt lgkmcnt(2)
v_mfma_f32_16x16x32_bf16 v[88:91],a[80:83],v[120:123],v[88:91]
ds_read_b128 v[112:115],v4 offset:24576
v_mfma_f32_16x16x32_bf16 v[92:95],a[80:83],v[124:127],v[92:95]
v_mfma_f32_16x16x32_bf16 v[96:99],a[88:91],v[120:123],v[96:99]
ds_read_b128 v[116:119],v4 offset:28672
v_mfma_f32_16x16x32_bf16 v[100:103],a[88:91],v[124:127],v[100:103]
s_waitcnt lgkmcnt(2)
v_mfma_f32_16x16x32_bf16 v[88:91],a[84:87],v[104:107],v[88:91]
ds_read_b128 v[120:123],v5 offset:24576
v_mfma_f32_16x16x32_bf16 v[92:95],a[84:87],v[108:111],v[92:95]
v_mfma_f32_16x16x32_bf16 v[96:99],a[92:95],v[104:107],v[96:99]
ds_read_b128 v[124:127],v5 offset:28672
v_mfma_f32_16x16x32_bf16 v[100:103],a[92:95],v[108:111],v[100:103]
s_waitcnt lgkmcnt(2)
v_mfma_f32_16x16x32_bf16 v[88:91],a[96:99],v[112:115],v[88:91]
ds_read_b128 v[104:107],v6 offset:24576
v_mfma_f32_16x16x32_bf16 v[92:95],a[96:99],v[116:119],v[92:95]
v_mfma_f32_16x16x32_bf16 v[96:99],a[104:107],v[112:115],v[96:99]
ds_read_b128 v[108:111],v6 offset:28672
v_mfma_f32_16x16x32_bf16 v[100:103],a[104:107],v[116:119],v[100:103]
s_waitcnt lgkmcnt(2)
v_mfma_f32_16x16x32_bf16 v[88:91],a[100:103],v[120:123],v[88:91]
ds_read_b128 v[112:115],v7 offset:24576
v_mfma_f32_16x16x32_bf16 v[92:95],a[100:103],v[124:127],v[92:95]
v_mfma_f32_16x16x32_bf16 v[96:99],a[108:111],v[120:123],v[96:99]
ds_read_b128 v[116:119],v7 offset:28672
v_mfma_f32_16x16x32_bf16 v[100:103],a[108:111],v[124:127],v[100:103]
s_waitcnt lgkmcnt(2)
v_mfma_f32_16x16x32_bf16 v[88:91],a[112:115],v[104:107],v[88:91]
v_mfma_f32_16x16x32_bf16 v[92:95],a[112:115],v[108:111],v[92:95]
v_mfma_f32_16x16x32_bf16 v[96:99],a[120:123],v[104:107],v[96:99]
v_mfma_f32_16x16x32_bf16 v[100:103],a[120:123],v[108:111],v[100:103]
s_waitcnt lgkmcnt(0)
v_mfma_f32_16x16x32_bf16 v[88:91],a[116:119],v[112:115],v[88:91]
v_mfma_f32_16x16x32_bf16 v[92:95],a[116:119],v[116:119],v[92:95]
v_mfma_f32_16x16x32_bf16 v[96:99],a[124:127],v[112:115],v[96:99]
v_mfma_f32_16x16x32_bf16 v[100:103],a[124:127],v[116:119],v[100:103]
s_nop 3
v_cvt_pk_bf16_f32 v104,v88,v96
v_cvt_pk_bf16_f32 v105,v89,v97
v_cvt_pk_bf16_f32 v106,v90,v98
v_cvt_pk_bf16_f32 v107,v91,v99
v_cvt_pk_bf16_f32 v108,v92,v100
v_cvt_pk_bf16_f32 v109,v93,v101
v_cvt_pk_bf16_f32 v110,v94,v102
v_cvt_pk_bf16_f32 v111,v95,v103
buffer_store_dwordx4 v[104:107],v0,s[8:11],s63 offen sc1
buffer_store_dwordx4 v[108:111],v0,s[8:11],s64 offen sc1
s_waitcnt vmcnt(6)
s_barrier
s_add_u32 m0,s50,131072
s_nop 0
buffer_load_dwordx4 v20,s[8:11],s70 offen offset:0 sc1 lds
s_add_u32 m0,s50,135168
s_nop 0
buffer_load_dwordx4 v20,s[8:11],s71 offen offset:0 sc1 lds
s_add_u32 m0,s50,139008
s_nop 0
buffer_load_dwordx4 v20,s[8:11],s70 offen offset:256 sc1 lds
s_add_u32 m0,s50,143104
s_nop 0
buffer_load_dwordx4 v20,s[8:11],s71 offen offset:256 sc1 lds
s_add_u32 m0,s50,146944
s_nop 0
buffer_load_dwordx4 v20,s[8:11],s70 offen offset:512 sc1 lds
s_add_u32 m0,s50,151040
s_nop 0
buffer_load_dwordx4 v20,s[8:11],s71 offen offset:512 sc1 lds
s_lshl_b32 s59,s51,13
s_lshl2_add_u32 s59,s47,s59
s_add_u32 s59,s59,10487680
s_waitcnt vmcnt(0)
s_barrier
s_or_b32 s59,s59,s52
buffer_store_dword v17,off,s[8:11],s59 sc1
s_mov_b32 s72,0x80000000
s_mov_b32 s86,0
s_mov_b32 s19,1
s_mov_b32 s18,0
s_cmp_lt_u32 s31,64
s_cbranch_scc1 L_mo_26
L_mo_39:
s_mov_b32 s51,64
v_and_b32 v9,15,v1
v_lshrrev_b32 v10,4,v1
v_and_b32 v124,1,v1
v_lshlrev_b32 v124,4,v124
v_mov_b32 v125,0xffff
v_lshlrev_b32 v125,v124,v125
v_lshrrev_b32 v124,2,v9
v_cmp_eq_u32 vcc,0,v124
s_nop 1
v_cndmask_b32 v12,0,v125,vcc
v_cmp_eq_u32 vcc,1,v124
s_nop 1
v_cndmask_b32 v13,0,v125,vcc
v_and_b32 v124,2,v1
v_cmp_eq_u32 vcc,0,v124
v_mov_b32 v14,0xeeee
v_mov_b32 v124,0x4444
v_cndmask_b32 v14,v14,v124,vcc
v_lshlrev_b32 v11,14,v10
v_lshl_add_u32 v11,v9,4,v11
s_lshl_b32 s65,s51,15
s_add_u32 s65,s65,92274688
s_lshl_b32 s62,s47,10
s_add_u32 s62,s62,s65
s_lshl_b32 s63,s47,16
s_lshl_b32 s60,s46,8
s_add_u32 s63,s63,s60
s_mov_b32 s4,s38
s_mov_b32 s5,s39
s_mov_b32 s6,1835008
s_mov_b32 s7,0x20000
buffer_load_dwordx4 v[24:27],v11,s[4:7],s63 offen offset:0
buffer_load_dwordx4 v[28:31],v11,s[4:7],s63 offen offset:1024
buffer_load_dwordx4 v[32:35],v11,s[4:7],s63 offen offset:2048
buffer_load_dwordx4 v[36:39],v11,s[4:7],s63 offen offset:3072
s_add_u32 s63,s63,4096
buffer_load_dwordx4 v[40:43],v11,s[4:7],s63 offen offset:0
buffer_load_dwordx4 v[44:47],v11,s[4:7],s63 offen offset:1024
buffer_load_dwordx4 v[48:51],v11,s[4:7],s63 offen offset:2048
buffer_load_dwordx4 v[52:55],v11,s[4:7],s63 offen offset:3072
s_add_u32 s63,s63,4096
buffer_load_dwordx4 v[56:59],v11,s[4:7],s63 offen offset:0
buffer_load_dwordx4 v[60:63],v11,s[4:7],s63 offen offset:1024
buffer_load_dwordx4 v[64:67],v11,s[4:7],s63 offen offset:2048
buffer_load_dwordx4 v[68:71],v11,s[4:7],s63 offen offset:3072
s_add_u32 s63,s63,4096
buffer_load_dwordx4 v[72:75],v11,s[4:7],s63 offen offset:0
buffer_load_dwordx4 v[76:79],v11,s[4:7],s63 offen offset:1024
buffer_load_dwordx4 v[80:83],v11,s[4:7],s63 offen offset:2048
buffer_load_dwordx4 v[84:87],v11,s[4:7],s63 offen offset:3072
buffer_load_dword v15,v0,s[8:11],s62 offen
ds_read_b128 a[0:3],v18 offset:0
ds_read_b128 a[4:7],v18 offset:1024
ds_read_b128 a[8:11],v18 offset:2048
ds_read_b128 a[12:15],v18 offset:3072
ds_read_b128 a[16:19],v18 offset:4096
ds_read_b128 a[20:23],v18 offset:5120
ds_read_b128 a[24:27],v18 offset:6144
ds_read_b128 a[28:31],v18 offset:7168
ds_read_b128 a[32:35],v18 offset:8192
ds_read_b128 a[36:39],v18 offset:9216
ds_read_b128 a[40:43],v18 offset:10240
ds_read_b128 a[44:47],v18 offset:11264
ds_read_b128 a[48:51],v18 offset:12288
ds_read_b128 a[52:55],v18 offset:13312
ds_read_b128 a[56:59],v18 offset:14336
ds_read_b128 a[60:63],v18 offset:15360
ds_read_b128 a[64:67],v18 offset:16384
ds_read_b128 a[68:71],v18 offset:17408
ds_read_b128 a[72:75],v18 offset:18432
ds_read_b128 a[76:79],v18 offset:19456
ds_read_b128 a[80:83],v18 offset:20480
ds_read_b128 a[84:87],v18 offset:21504
ds_read_b128 a[88:91],v18 offset:22528
ds_read_b128 a[92:95],v18 offset:23552
ds_read_b128 a[96:99],v18 offset:24576
ds_read_b128 a[100:103],v18 offset:25600
ds_read_b128 a[104:107],v18 offset:26624
ds_read_b128 a[108:111],v18 offset:27648
ds_read_b128 a[112:115],v18 offset:28672
ds_read_b128 a[116:119],v18 offset:29696
ds_read_b128 a[120:123],v18 offset:30720
ds_read_b128 a[124:127],v18 offset:31744
s_and_b32 s61,s54,0x7ff
s_sub_u32 s61,2047,s61
s_lshr_b32 s61,s61,5
s_cmp_lg_u32 s46,0
s_cbranch_scc1 L_mw_50
s_mov_b32 s59,11018240
v_lshlrev_b32 v2,2,v1
L_fp_51:
s_sleep 2
buffer_load_dword v3,v2,s[8:11],s59 offen sc1
s_sub_u32 s49,s49,1
s_cbranch_scc1 L_abort
s_waitcnt vmcnt(0)
v_cmp_eq_u32 vcc,0,v3
s_cbranch_vccnz L_fp_51
v_cmp_le_u32 vcc,s61,v1
s_nop 1
v_cndmask_b32 v2,1,2,vcc
v_cmp_ne_u32 s[84:85],v2,v3
s_lshl_b32 s56,s47,1
s_lshr_b64 s[20:21],s[84:85],s56
v_lshrrev_b32 v2,5,v1
v_lshrrev_b32 v3,v2,s20
v_and_b32 v3,1,v3
v_mul_u32_u24 v3,768,v3
v_lshlrev_b32 v2,13,v2
v_sub_u32 v2,v2,v3
v_and_b32 v3,31,v1
v_lshl_add_u32 v2,v3,2,v2
v_add_u32 v2,1536,v2
s_lshl_b32 s59,s47,14
s_add_u32 s59,s59,10485760
v_mov_b32 v3,1
s_cmp_ge_u32 s47,28
s_cbranch_scc1 L_mf_52
L_fp_58:
s_sleep 1
buffer_load_dword v3,v2,s[8:11],s59 offen sc1
s_sub_u32 s49,s49,1
s_cbranch_scc1 L_abort
s_waitcnt vmcnt(0)
v_cmp_eq_u32 vcc,0,v3
s_cbranch_vccnz L_fp_58
v_max_u32_dpp v3,v3,v3 row_ror:8 row_mask:0xf bank_mask:0xf
s_nop 1
v_max_u32_dpp v3,v3,v3 row_ror:4 row_mask:0xf bank_mask:0xf
s_nop 1
v_max_u32_dpp v3,v3,v3 row_ror:2 row_mask:0xf bank_mask:0xf
s_nop 1
v_max_u32_dpp v3,v3,v3 row_ror:1 row_mask:0xf bank_mask:0xf
v_mov_b32 v2,v3
s_nop 1
v_permlane16_swap_b32 v3,v2
v_max_u32 v3,v3,v2
v_mov_b32 v2,v3
s_nop 1
v_permlane32_swap_b32 v3,v2
v_max_u32 v3,v3,v2
L_mf_52:
s_lshl_b32 s59,s51,13
s_lshl2_add_u32 s59,s47,s59
s_add_u32 s59,s59,10487424
buffer_store_dword v3,off,s[8:11],s59
L_mw_50:
s_barrier
s_lshl_b32 s59,s51,13
s_add_u32 s59,s59,10487424
v_and_b32 v124,31,v1
v_lshlrev_b32 v124,2,v124
s_branch L_ff_61
L_fw_59:
s_sleep 1
L_ff_61:
buffer_load_dword v125,v124,s[8:11],s59 offen sc1
s_sub_u32 s49,s49,1
s_cbranch_scc1 L_abort
s_waitcnt vmcnt(0)
v_cmp_eq_u32 vcc,0,v125
s_cbranch_vccnz L_fw_59
v_max_u32_dpp v125,v125,v125 row_ror:8 row_mask:0xf bank_mask:0xf
s_nop 1
v_max_u32_dpp v125,v125,v125 row_ror:4 row_mask:0xf bank_mask:0xf
s_nop 1
v_max_u32_dpp v125,v125,v125 row_ror:2 row_mask:0xf bank_mask:0xf
s_nop 1
v_max_u32_dpp v125,v125,v125 row_ror:1 row_mask:0xf bank_mask:0xf
v_mov_b32 v124,v125
s_nop 1
v_permlane16_swap_b32 v125,v124
v_max_u32 v125,v125,v124
v_mov_b32 v124,v125
s_nop 1
v_permlane32_swap_b32 v125,v124
v_max_u32 v125,v125,v124
s_nop 0
v_readfirstlane_b32 s55,v125
L_mf_53:
s_andn2_b32 s64,0x7ff,s55
s_lshl_b32 s56,s64,10
s_add_u32 s58,s56,6291456
buffer_load_dwordx4 v[88:91],v0,s[8:11],s58 offen sc1
s_lshl_b32 s57,s46,11
s_add_u32 s57,s57,139264
v_add_u32 v8,s57,v0
v_and_b32 v2,1,v10
v_lshrrev_b32 v3,1,v10
v_lshlrev_b32 v2,7,v2
v_lshl_add_u32 v2,v3,10,v2
s_lshl_b32 s59,s46,8
s_add_u32 s59,s57,s59
v_add_u32 v2,s59,v2
s_mov_b32 s60,0x01000100
s_mov_b32 s61,0x03020302
s_waitcnt vmcnt(0)
v_lshlrev_b32 v96,16,v88
v_and_b32 v97,0xffff0000,v88
v_lshlrev_b32 v98,16,v89
v_and_b32 v99,0xffff0000,v89
v_lshlrev_b32 v100,16,v90
v_and_b32 v101,0xffff0000,v90
v_lshlrev_b32 v102,16,v91
v_and_b32 v103,0xffff0000,v91
v_readfirstlane_b32 s78,v96
s_nop 1
v_pk_add_f32 v[108:109],v[96:97],s[78:79] op_sel_hi:[1,0] neg_lo:[0,1] neg_hi:[0,1]
v_pk_add_f32 v[110:111],v[98:99],s[78:79] op_sel_hi:[1,0] neg_lo:[0,1] neg_hi:[0,1]
v_pk_add_f32 v[112:113],v[100:101],s[78:79] op_sel_hi:[1,0] neg_lo:[0,1] neg_hi:[0,1]
v_pk_add_f32 v[114:115],v[102:103],s[78:79] op_sel_hi:[1,0] neg_lo:[0,1] neg_hi:[0,1]
v_pk_add_f32 v[116:117],v[108:109],v[110:111]
v_pk_mul_f32 v[118:119],v[108:109],v[108:109]
v_pk_add_f32 v[120:121],v[112:113],v[114:115]
v_pk_fma_f32 v[118:119],v[110:111],v[110:111],v[118:119]
v_pk_add_f32 v[116:117],v[116:117],v[120:121]
v_pk_fma_f32 v[118:119],v[112:113],v[112:113],v[118:119]
v_add_f32 v116,v116,v117
v_pk_fma_f32 v[118:119],v[114:115],v[114:115],v[118:119]
v_add_f32 v118,v118,v119
s_nop 1
v_permlane32_swap_b32 v116,v118
v_add_f32 v116,v116,v118
s_nop 1
v_add_f32_dpp v116,v116,v116 row_ror:8 row_mask:0xf bank_mask:0xf
s_nop 1
v_add_f32_dpp v116,v116,v116 row_ror:4 row_mask:0xf bank_mask:0xf
s_nop 1
v_add_f32_dpp v116,v116,v116 row_ror:2 row_mask:0xf bank_mask:0xf
s_nop 1
v_add_f32_dpp v116,v116,v116 row_ror:1 row_mask:0xf bank_mask:0xf
v_mov_b32 v118,v116
s_nop 1
v_permlane16_swap_b32 v116,v118
v_add_f32 v116,v116,v118
v_mul_f32 v116,0x3b000000,v116
v_mov_b32 v118,v116
s_nop 1
v_permlane32_swap_b32 v116,v118
v_fma_f32 v118,-v116,v116,v118
v_add_f32 v116,s78,v116
v_max_f32 v118,0,v118
v_cvt_pk_bf16_f32 v118,v116,v118
v_lshlrev_b32 v116,16,v118
v_and_b32 v118,0xffff0000,v118
v_add_f32 v118,0x3727c5ac,v118
v_cvt_pk_bf16_f32 v118,v118,v118
v_and_b32 v118,0xffff0000,v118
v_sqrt_f32 v118,v118
v_pk_add_f32 v[108:109],v[96:97],v[116:117] op_sel_hi:[1,0] neg_lo:[0,1] neg_hi:[0,1]
v_pk_add_f32 v[110:111],v[98:99],v[116:117] op_sel_hi:[1,0] neg_lo:[0,1] neg_hi:[0,1]
v_pk_add_f32 v[112:113],v[100:101],v[116:117] op_sel_hi:[1,0] neg_lo:[0,1] neg_hi:[0,1]
v_pk_add_f32 v[114:115],v[102:103],v[116:117] op_sel_hi:[1,0] neg_lo:[0,1] neg_hi:[0,1]
v_cvt_pk_bf16_f32 v118,v118,v118
v_and_b32 v118,0xffff0000,v118
v_rcp_f32 v118,v118
v_cvt_pk_bf16_f32 v104,v108,v109
v_cvt_pk_bf16_f32 v105,v110,v111
v_cvt_pk_bf16_f32 v106,v112,v113
v_cvt_pk_bf16_f32 v107,v114,v115
v_lshlrev_b32 v108,16,v104
v_and_b32 v109,0xffff0000,v104
v_lshlrev_b32 v110,16,v105
v_and_b32 v111,0xffff0000,v105
v_lshlrev_b32 v112,16,v106
v_and_b32 v113,0xffff0000,v106
v_lshlrev_b32 v114,16,v107
v_and_b32 v115,0xffff0000,v107
v_pk_mul_f32 v[108:109],v[108:109],v[118:119] op_sel_hi:[1,0]
v_pk_mul_f32 v[110:111],v[110:111],v[118:119] op_sel_hi:[1,0]
v_pk_mul_f32 v[112:113],v[112:113],v[118:119] op_sel_hi:[1,0]
v_pk_mul_f32 v[114:115],v[114:115],v[118:119] op_sel_hi:[1,0]
v_cvt_pk_bf16_f32 v104,v108,v109
v_cvt_pk_bf16_f32 v105,v110,v111
v_cvt_pk_bf16_f32 v106,v112,v113
v_cvt_pk_bf16_f32 v107,v114,v115
v_perm_b32 v88,v104,v104,s60
v_perm_b32 v89,v105,v105,s60
v_perm_b32 v90,v106,v106,s60
v_perm_b32 v91,v107,v107,s60
ds_write_b128 v8,v[88:91]
v_perm_b32 v92,v104,v104,s61
v_perm_b32 v93,v105,v105,s61
v_perm_b32 v94,v106,v106,s61
v_perm_b32 v95,v107,v107,s61
ds_write_b128 v8,v[92:95] offset:1024
s_mov_b32 s58,s57
ds_read_b128 v[128:131],v2 offset:0
ds_read_b128 v[144:147],v2 offset:64
ds_read_b128 v[132:135],v2 offset:16
ds_read_b128 v[148:151],v2 offset:80
ds_read_b128 v[136:139],v2 offset:32
ds_read_b128 v[152:155],v2 offset:96
ds_read_b128 v[140:143],v2 offset:48
ds_read_b128 v[156:159],v2 offset:112
v_mov_b64 v[116:117],0
v_mov_b64 v[118:119],0
s_waitcnt lgkmcnt(6)
v_and_b32 v120,v12,v128
v_and_b32 v121,v13,v128
v_and_b32 v122,v12,v144
v_and_b32 v123,v13,v144
v_and_b32 v124,v12,v129
v_and_b32 v125,v13,v129
v_smfmac_f32_16x16x64_bf16 v[116:119],v[120:123],a[0:7],v14
v_and_b32 v126,v12,v145
v_and_b32 v127,v13,v145
v_and_b32 v120,v12,v130
v_and_b32 v121,v13,v130
v_smfmac_f32_16x16x64_bf16 v[116:119],v[124:127],a[8:15],v14
v_and_b32 v122,v12,v146
v_and_b32 v123,v13,v146
v_and_b32 v124,v12,v131
v_and_b32 v125,v13,v131
v_smfmac_f32_16x16x64_bf16 v[116:119],v[120:123],a[16:23],v14
v_and_b32 v126,v12,v147
v_and_b32 v127,v13,v147
s_waitcnt lgkmcnt(4)
v_and_b32 v120,v12,v132
v_and_b32 v121,v13,v132
v_smfmac_f32_16x16x64_bf16 v[116:119],v[124:127],a[24:31],v14
v_and_b32 v122,v12,v148
v_and_b32 v123,v13,v148
v_and_b32 v124,v12,v133
v_and_b32 v125,v13,v133
v_smfmac_f32_16x16x64_bf16 v[116:119],v[120:123],a[32:39],v14
v_and_b32 v126,v12,v149
v_and_b32 v127,v13,v149
v_and_b32 v120,v12,v134
v_and_b32 v121,v13,v134
v_smfmac_f32_16x16x64_bf16 v[116:119],v[124:127],a[40:47],v14
v_and_b32 v122,v12,v150
v_and_b32 v123,v13,v150
v_and_b32 v124,v12,v135
v_and_b32 v125,v13,v135
v_smfmac_f32_16x16x64_bf16 v[116:119],v[120:123],a[48:55],v14
v_and_b32 v126,v12,v151
v_and_b32 v127,v13,v151
s_waitcnt lgkmcnt(2)
v_and_b32 v120,v12,v136
v_and_b32 v121,v13,v136
v_smfmac_f32_16x16x64_bf16 v[116:119],v[124:127],a[56:63],v14
v_and_b32 v122,v12,v152
v_and_b32 v123,v13,v152
v_and_b32 v124,v12,v137
v_and_b32 v125,v13,v137
v_smfmac_f32_16x16x64_bf16 v[116:119],v[120:123],a[64:71],v14
v_and_b32 v126,v12,v153
v_and_b32 v127,v13,v153
v_and_b32 v120,v12,v138
v_and_b32 v121,v13,v138
v_smfmac_f32_16x16x64_bf16 v[116:119],v[124:127],a[72:79],v14
v_and_b32 v122,v12,v154
v_and_b32 v123,v13,v154
v_and_b32 v124,v12,v139
v_and_b32 v125,v13,v139
v_smfmac_f32_16x16x64_bf16 v[116:119],v[120:123],a[80:87],v14
v_and_b32 v126,v12,v155
v_and_b32 v127,v13,v155
s_waitcnt lgkmcnt(0)
v_and_b32 v120,v12,v140
v_and_b32 v121,v13,v140
v_smfmac_f32_16x16x64_bf16 v[116:119],v[124:127],a[88:95],v14
v_and_b32 v122,v12,v156
v_and_b32 v123,v13,v156
v_and_b32 v124,v12,v141
v_and_b32 v125,v13,v141
v_smfmac_f32_16x16x64_bf16 v[116:119],v[120:123],a[96:103],v14
v_and_b32 v126,v12,v157
v_and_b32 v127,v13,v157
v_and_b32 v120,v12,v142
v_and_b32 v121,v13,v142
v_smfmac_f32_16x16x64_bf16 v[116:119],v[124:127],a[104:111],v14
v_and_b32 v122,v12,v158
v_and_b32 v123,v13,v158
v_and_b32 v124,v12,v143
v_and_b32 v125,v13,v143
v_smfmac_f32_16x16x64_bf16 v[116:119],v[120:123],a[112:119],v14
v_and_b32 v126,v12,v159
v_and_b32 v127,v13,v159
s_nop 1
v_smfmac_f32_16x16x64_bf16 v[116:119],v[124:127],a[120:127],v14
v_lshlrev_b32 v8,5,v9
v_and_b32 v124,1,v10
v_lshl_add_u32 v8,v124,4,v8
v_lshrrev_b32 v124,1,v10
v_lshl_add_u32 v8,v124,11,v8
s_lshl_b32 s60,s46,9
s_add_u32 s60,s60,147456
v_add_u32 v8,s60,v8
ds_write_b128 v8,v[116:119]
v_lshlrev_b32 v8,2,v1
v_add_u32 v8,147456,v8
v_and_b32 v2,1,v1
v_lshrrev_b32 v3,1,v1
v_lshlrev_b32 v3,2,v3
v_lshl_add_u32 v2,v2,7,v3
v_add_u32 v2,s58,v2
v_lshlrev_b32 v3,6,v10
v_add_u32 v3,s58,v3
s_waitcnt lgkmcnt(0)
s_barrier
ds_read2st64_b32 v[88:89],v8 offset0:0 offset1:1
ds_read2st64_b32 v[90:91],v8 offset0:2 offset1:3
ds_read2st64_b32 v[92:93],v8 offset0:4 offset1:5
ds_read2st64_b32 v[94:95],v8 offset0:6 offset1:7
s_waitcnt lgkmcnt(0)
v_pk_add_f32 v[88:89],v[88:89],v[90:91]
v_pk_add_f32 v[92:93],v[92:93],v[94:95]
v_pk_add_f32 v[88:89],v[88:89],v[92:93]
v_cvt_pk_bf16_f32 v88,v88,v88
v_and_b32 v88,0xffff0000,v88
v_cvt_pk_bf16_f32 v89,v89,v89
v_and_b32 v89,0xffff0000,v89
v_mul_f32 v90,0xbfb8aa3b,v88
v_exp_f32 v90,v90
s_nop 0
v_add_f32 v90,1.0,v90
v_rcp_f32 v90,v90
s_nop 0
v_mul_f32 v88,v88,v90
v_cvt_pk_bf16_f32 v88,v88,v88
v_and_b32 v88,0xffff0000,v88
v_mul_f32 v88,v88,v89
v_cvt_pk_bf16_f32 v88,v88,v88
ds_write_b32 v2,v88
ds_read_b128 v[88:91],v3
ds_read_b128 v[108:111],v3 offset:32
ds_read_b128 v[92:95],v3 offset:16
ds_read_b128 v[112:115],v3 offset:48
v_mov_b64 v[116:117],0
v_mov_b64 v[118:119],0
s_waitcnt vmcnt(0) lgkmcnt(0)
v_and_b32 v120,v12,v88
v_and_b32 v121,v13,v88
v_and_b32 v122,v12,v108
v_and_b32 v123,v13,v108
v_and_b32 v124,v12,v89
v_and_b32 v125,v13,v89
v_smfmac_f32_16x16x64_bf16 v[116:119],v[120:123],v[24:31],v14
v_and_b32 v126,v12,v109
v_and_b32 v127,v13,v109
v_and_b32 v120,v12,v90
v_and_b32 v121,v13,v90
v_smfmac_f32_16x16x64_bf16 v[116:119],v[124:127],v[32:39],v14
v_and_b32 v122,v12,v110
v_and_b32 v123,v13,v110
v_and_b32 v124,v12,v91
v_and_b32 v125,v13,v91
v_smfmac_f32_16x16x64_bf16 v[116:119],v[120:123],v[40:47],v14
v_and_b32 v126,v12,v111
v_and_b32 v127,v13,v111
v_and_b32 v120,v12,v92
v_and_b32 v121,v13,v92
v_smfmac_f32_16x16x64_bf16 v[116:119],v[124:127],v[48:55],v14
v_and_b32 v122,v12,v112
v_and_b32 v123,v13,v112
v_and_b32 v124,v12,v93
v_and_b32 v125,v13,v93
v_smfmac_f32_16x16x64_bf16 v[116:119],v[120:123],v[56:63],v14
v_and_b32 v126,v12,v113
v_and_b32 v127,v13,v113
v_and_b32 v120,v12,v94
v_and_b32 v121,v13,v94
v_smfmac_f32_16x16x64_bf16 v[116:119],v[124:127],v[64:71],v14
v_and_b32 v122,v12,v114
v_and_b32 v123,v13,v114
v_and_b32 v124,v12,v95
v_and_b32 v125,v13,v95
v_smfmac_f32_16x16x64_bf16 v[116:119],v[120:123],v[72:79],v14
v_and_b32 v126,v12,v115
v_and_b32 v127,v13,v115
s_nop 1
v_smfmac_f32_16x16x64_bf16 v[116:119],v[124:127],v[80:87],v14
v_lshlrev_b32 v8,4,v9
v_and_b32 v124,1,v10
v_lshl_add_u32 v8,v124,3,v8
v_and_b32 v124,2,v10
v_lshl_add_u32 v8,v124,30,v8
s_lshl_b32 s60,s46,8
s_add_u32 s59,s62,s60
s_nop 0
v_cvt_pk_bf16_f32 v24,v116,v117
v_cvt_pk_bf16_f32 v25,v118,v119
buffer_store_dwordx2 v[24:25],v8,s[8:11],s59 offen
s_lshl_b32 s59,s51,13
s_lshl2_add_u32 s59,s47,s59
s_add_u32 s59,s59,10486912
s_waitcnt vmcnt(0)
s_barrier
s_or_b32 s59,s59,s52
buffer_store_dword v17,off,s[8:11],s59
s_cmp_lg_u32 s47,0
s_cbranch_scc1 L_moed_62
s_lshl_b32 s59,s51,13
s_add_u32 s59,s59,10486912
v_and_b32 v124,31,v1
v_lshlrev_b32 v124,2,v124
L_fw_63:
buffer_load_dword v125,v124,s[8:11],s59 offen sc1
s_sub_u32 s49,s49,1
s_cbranch_scc1 L_abort
s_waitcnt vmcnt(0)
v_cmp_eq_u32 vcc,0,v125
s_cbranch_vccnz L_fw_63
s_add_u32 s63,s65,0
buffer_load_dwordx4 v[24:27],v22,s[8:11],s63 offen sc1
s_add_u32 s63,s65,4096
buffer_load_dwordx4 v[28:31],v22,s[8:11],s63 offen sc1
s_add_u32 s63,s65,8192
buffer_load_dwordx4 v[32:35],v22,s[8:11],s63 offen sc1
s_add_u32 s63,s65,12288
buffer_load_dwordx4 v[36:39],v22,s[8:11],s63 offen sc1
s_add_u32 s63,s65,16384
buffer_load_dwordx4 v[40:43],v22,s[8:11],s63 offen sc1
s_add_u32 s63,s65,20480
buffer_load_dwordx4 v[44:47],v22,s[8:11],s63 offen sc1
s_add_u32 s63,s65,24576
buffer_load_dwordx4 v[48:51],v22,s[8:11],s63 offen sc1
s_add_u32 s63,s65,28672
buffer_load_dwordx4 v[52:55],v22,s[8:11],s63 offen sc1
v_and_b32 v64,15,v1
v_and_b32 v65,1,v1
v_lshlrev_b32 v65,4,v65
v_mov_b32 v66,0x3f80
v_lshlrev_b32 v66,v65,v66
v_lshrrev_b32 v64,1,v64
v_cmp_eq_u32 vcc,0,v64
s_nop 1
v_cndmask_b32 v56,0,v66,vcc
v_cmp_eq_u32 vcc,1,v64
s_nop 1
v_cndmask_b32 v57,0,v66,vcc
v_cmp_eq_u32 vcc,2,v64
s_nop 1
v_cndmask_b32 v58,0,v66,vcc
v_cmp_eq_u32 vcc,3,v64
s_nop 1
v_cndmask_b32 v59,0,v66,vcc
s_waitcnt vmcnt(7)
s_nop 0
v_mfma_f32_16x16x32_bf16 v[60:63],v[56:59],v[24:27],0
s_waitcnt vmcnt(6)
v_mfma_f32_16x16x32_bf16 v[60:63],v[56:59],v[28:31],v[60:63]
s_waitcnt vmcnt(5)
v_mfma_f32_16x16x32_bf16 v[60:63],v[56:59],v[32:35],v[60:63]
s_waitcnt vmcnt(4)
v_mfma_f32_16x16x32_bf16 v[60:63],v[56:59],v[36:39],v[60:63]
s_waitcnt vmcnt(3)
v_mfma_f32_16x16x32_bf16 v[60:63],v[56:59],v[40:43],v[60:63]
s_waitcnt vmcnt(2)
v_mfma_f32_16x16x32_bf16 v[60:63],v[56:59],v[44:47],v[60:63]
s_waitcnt vmcnt(1)
v_mfma_f32_16x16x32_bf16 v[60:63],v[56:59],v[48:51],v[60:63]
s_waitcnt vmcnt(0)
v_mfma_f32_16x16x32_bf16 v[60:63],v[56:59],v[52:55],v[60:63]
s_nop 7
ds_write_b128 v21,v[60:63]
s_waitcnt lgkmcnt(0)
s_barrier
s_cmp_lg_u32 s46,0
s_cbranch_scc1 L_moed_62
v_lshlrev_b32 v56,5,v1
v_add_u32 v56,155648,v56
ds_read_b128 v[24:27],v56
ds_read_b128 v[28:31],v56 offset:16
s_and_b32 s59,s55,0xffff0000
s_xor_b32 s60,s59,0x80000000
s_xor_b32 s61,s59,0xffff0000
s_cmp_lt_i32 s59,0
s_cselect_b32 s59,s60,s61
v_mov_b32 v56,s59
v_mul_f32 v56,0xbfb8aa3b,v56
v_exp_f32 v56,v56
s_nop 0
v_add_f32 v56,1.0,v56
v_rcp_f32 v56,v56
s_nop 0
v_cvt_pk_bf16_f32 v56,v56,v56
v_and_b32 v56,0xffff0000,v56
v_lshlrev_b32 v48,16,v104
v_and_b32 v49,0xffff0000,v104
v_lshlrev_b32 v50,16,v105
v_and_b32 v51,0xffff0000,v105
v_lshlrev_b32 v52,16,v106
v_and_b32 v53,0xffff0000,v106
v_lshlrev_b32 v54,16,v107
v_and_b32 v55,0xffff0000,v107
s_waitcnt lgkmcnt(0)
v_cvt_pk_bf16_f32 v40,v24,v25
v_cvt_pk_bf16_f32 v41,v26,v27
v_cvt_pk_bf16_f32 v42,v28,v29
v_cvt_pk_bf16_f32 v43,v30,v31
v_lshlrev_b32 v24,16,v40
v_and_b32 v25,0xffff0000,v40
v_lshlrev_b32 v26,16,v41
v_and_b32 v27,0xffff0000,v41
v_lshlrev_b32 v28,16,v42
v_and_b32 v29,0xffff0000,v42
v_lshlrev_b32 v30,16,v43
v_and_b32 v31,0xffff0000,v43
v_pk_mul_f32 v[24:25],v[24:25],v[56:57] op_sel_hi:[1,0]
v_pk_mul_f32 v[26:27],v[26:27],v[56:57] op_sel_hi:[1,0]
v_pk_mul_f32 v[28:29],v[28:29],v[56:57] op_sel_hi:[1,0]
v_pk_mul_f32 v[30:31],v[30:31],v[56:57] op_sel_hi:[1,0]
v_cvt_pk_bf16_f32 v40,v24,v25
v_cvt_pk_bf16_f32 v41,v26,v27
v_cvt_pk_bf16_f32 v42,v28,v29
v_cvt_pk_bf16_f32 v43,v30,v31
v_lshlrev_b32 v24,16,v40
v_and_b32 v25,0xffff0000,v40
v_lshlrev_b32 v26,16,v41
v_and_b32 v27,0xffff0000,v41
v_lshlrev_b32 v28,16,v42
v_and_b32 v29,0xffff0000,v42
v_lshlrev_b32 v30,16,v43
v_and_b32 v31,0xffff0000,v43
v_pk_add_f32 v[24:25],v[24:25],v[48:49]
v_pk_add_f32 v[26:27],v[26:27],v[50:51]
v_pk_add_f32 v[28:29],v[28:29],v[52:53]
v_pk_add_f32 v[30:31],v[30:31],v[54:55]
v_cvt_pk_bf16_f32 v40,v24,v25
v_cvt_pk_bf16_f32 v41,v26,v27
v_cvt_pk_bf16_f32 v42,v28,v29
v_cvt_pk_bf16_f32 v43,v30,v31
v_lshlrev_b32 v24,16,v40
v_and_b32 v25,0xffff0000,v40
v_lshlrev_b32 v26,16,v41
v_and_b32 v27,0xffff0000,v41
v_lshlrev_b32 v28,16,v42
v_and_b32 v29,0xffff0000,v42
v_lshlrev_b32 v30,16,v43
v_and_b32 v31,0xffff0000,v43
v_pk_add_f32 v[96:97],v[96:97],v[24:25]
v_pk_add_f32 v[98:99],v[98:99],v[26:27]
v_pk_add_f32 v[100:101],v[100:101],v[28:29]
v_pk_add_f32 v[102:103],v[102:103],v[30:31]
v_cvt_pk_bf16_f32 v160,v96,v97
v_cvt_pk_bf16_f32 v161,v98,v99
v_cvt_pk_bf16_f32 v162,v100,v101
v_cvt_pk_bf16_f32 v163,v102,v103
L_moed_62:
s_or_b32 s61,s47,s46
s_cselect_b32 s61,1,0
s_add_u32 s51,s51,1
s_lshl1_add_u32 s61,s51,s61
s_cmp_gt_u32 s61,132
s_cbranch_scc1 L_mf_57
s_cmp_eq_u32 s61,132
s_cbranch_scc1 L_mf_55
v_and_b32 v9,15,v1
v_lshrrev_b32 v10,4,v1
v_and_b32 v124,1,v1
v_lshlrev_b32 v124,4,v124
v_mov_b32 v125,0xffff
v_lshlrev_b32 v125,v124,v125
v_lshrrev_b32 v124,2,v9
v_cmp_eq_u32 vcc,0,v124
s_nop 1
v_cndmask_b32 v12,0,v125,vcc
v_cmp_eq_u32 vcc,1,v124
s_nop 1
v_cndmask_b32 v13,0,v125,vcc
v_and_b32 v124,2,v1
v_cmp_eq_u32 vcc,0,v124
v_mov_b32 v14,0xeeee
v_mov_b32 v124,0x4444
v_cndmask_b32 v14,v14,v124,vcc
v_lshlrev_b32 v11,14,v10
v_lshl_add_u32 v11,v9,4,v11
s_lshl_b32 s65,s51,15
s_add_u32 s65,s65,92274688
s_lshl_b32 s62,s47,10
s_add_u32 s62,s62,s65
s_lshl_b32 s63,s47,16
s_lshl_b32 s60,s46,8
s_add_u32 s63,s63,s60
s_mov_b32 s4,s38
s_mov_b32 s5,s39
s_mov_b32 s6,1835008
s_mov_b32 s7,0x20000
buffer_load_dwordx4 v[24:27],v11,s[4:7],s63 offen offset:0
buffer_load_dwordx4 v[28:31],v11,s[4:7],s63 offen offset:1024
buffer_load_dwordx4 v[32:35],v11,s[4:7],s63 offen offset:2048
buffer_load_dwordx4 v[36:39],v11,s[4:7],s63 offen offset:3072
s_add_u32 s63,s63,4096
buffer_load_dwordx4 v[40:43],v11,s[4:7],s63 offen offset:0
buffer_load_dwordx4 v[44:47],v11,s[4:7],s63 offen offset:1024
buffer_load_dwordx4 v[48:51],v11,s[4:7],s63 offen offset:2048
buffer_load_dwordx4 v[52:55],v11,s[4:7],s63 offen offset:3072
s_add_u32 s63,s63,4096
buffer_load_dwordx4 v[56:59],v11,s[4:7],s63 offen offset:0
buffer_load_dwordx4 v[60:63],v11,s[4:7],s63 offen offset:1024
buffer_load_dwordx4 v[64:67],v11,s[4:7],s63 offen offset:2048
buffer_load_dwordx4 v[68:71],v11,s[4:7],s63 offen offset:3072
s_add_u32 s63,s63,4096
buffer_load_dwordx4 v[72:75],v11,s[4:7],s63 offen offset:0
buffer_load_dwordx4 v[76:79],v11,s[4:7],s63 offen offset:1024
buffer_load_dwordx4 v[80:83],v11,s[4:7],s63 offen offset:2048
buffer_load_dwordx4 v[84:87],v11,s[4:7],s63 offen offset:3072
buffer_load_dword v15,v0,s[8:11],s62 offen
s_cmp_eq_u32 s61,131
s_cbranch_scc1 L_mf_56
v_lshrrev_b32 v2,3,v1
s_lshr_b32 s20,s85,24
v_lshrrev_b32 v3,v2,s20
v_and_b32 v3,1,v3
v_mul_u32_u24 v3,768,v3
v_lshlrev_b32 v2,13,v2
v_sub_u32 v2,v2,v3
v_and_b32 v3,0x70,v0
v_add_u32 v2,v2,v3
v_add_u32 v2,1536,v2
s_mov_b32 s59,10944512
L_mf_54:
buffer_load_dwordx4 v[164:167],v2,s[8:11],s59 offen sc1
s_sub_u32 s49,s49,1
s_cbranch_scc1 L_abort
s_waitcnt vmcnt(0)
v_min3_u32 v168,v164,v165,v166
v_min_u32 v168,v167,v168
v_cmp_eq_u32 vcc,0,v168
s_cbranch_vccnz L_mf_54
v_max3_u32 v168,v164,v165,v166
v_max3_u32 v168,v167,v168,s55
v_cmp_lt_u32 vcc,s55,v168
s_mov_b32 s59,11019904
s_cbranch_vccz L_mf_55
v_max_u32_dpp v168,v168,v168 row_ror:8 row_mask:0xf bank_mask:0xf
s_nop 1
v_max_u32_dpp v168,v168,v168 row_ror:4 row_mask:0xf bank_mask:0xf
s_nop 1
v_max_u32_dpp v168,v168,v168 row_ror:2 row_mask:0xf bank_mask:0xf
s_nop 1
v_max_u32_dpp v168,v168,v168 row_ror:1 row_mask:0xf bank_mask:0xf
v_mov_b32 v169,v168
s_nop 1
v_permlane16_swap_b32 v168,v169
v_max_u32 v168,v168,v169
v_mov_b32 v169,v168
s_nop 1
v_permlane32_swap_b32 v168,v169
v_max_u32 v168,v168,v169
buffer_store_dword v168,off,s[8:11],s59
s_branch L_mf_56
L_mf_55:
s_mov_b32 s4,s40
s_mov_b32 s5,s41
s_mov_b32 s6,2097152
s_mov_b32 s7,0x20000
buffer_store_dwordx4 v[160:163],v0,s[4:7],s56 offen sc1
v_mov_b32 v168,s55
s_mov_b32 s59,11019904
buffer_store_dword v168,off,s[8:11],s59
s_endpgm
L_mf_56:
s_mov_b32 s59,11019904
L_ww_66:
s_sleep 1
buffer_load_dword v2,off,s[8:11],s59 sc1
s_sub_u32 s49,s49,1
s_cbranch_scc1 L_abort
s_waitcnt vmcnt(0)
v_readfirstlane_b32 s61,v2
s_cmp_eq_u32 s61,0
s_cbranch_scc1 L_ww_66
L_wwd_67:
s_cmp_eq_u32 s61,s55
s_cbranch_scc1 L_mf_57
s_mov_b32 s55,s61
s_barrier
s_branch L_mf_53
L_mf_57:
s_waitcnt vmcnt(0)
s_endpgm
L_abort:
s_endpgm
L_spread:
s_mov_b32 s3,-1
s_lshr_b32 s48,s2,5
s_and_b32 s47,s2,31
s_branch L_roles
L_ra_6:
s_and_b32 s56,s48,1
s_lshl_b32 s56,s56,12
s_add_u32 s56,s56,s50
s_and_b32 s57,s47,15
s_lshl_b32 s57,s57,13
s_add_u32 s56,s56,s57
s_mov_b32 s4,s22
s_mov_b32 s5,s23
s_mov_b32 s6,4194304
s_mov_b32 s7,0x20000
s_add_u32 s57,s56,0
buffer_load_dwordx4 v[24:27],v0,s[4:7],s57 offen
s_add_u32 s57,s56,131072
buffer_load_dwordx4 v[24:27],v0,s[4:7],s57 offen
s_add_u32 s57,s56,262144
buffer_load_dwordx4 v[24:27],v0,s[4:7],s57 offen
s_add_u32 s57,s56,393216
buffer_load_dwordx4 v[24:27],v0,s[4:7],s57 offen
s_add_u32 s57,s56,524288
buffer_load_dwordx4 v[24:27],v0,s[4:7],s57 offen
s_add_u32 s57,s56,655360
buffer_load_dwordx4 v[24:27],v0,s[4:7],s57 offen
s_add_u32 s57,s56,786432
buffer_load_dwordx4 v[24:27],v0,s[4:7],s57 offen
s_add_u32 s57,s56,917504
buffer_load_dwordx4 v[24:27],v0,s[4:7],s57 offen
s_add_u32 s57,s56,1048576
buffer_load_dwordx4 v[24:27],v0,s[4:7],s57 offen
s_add_u32 s57,s56,1179648
buffer_load_dwordx4 v[24:27],v0,s[4:7],s57 offen
s_waitcnt vmcnt(9)
s_add_u32 s57,s56,1310720
buffer_load_dwordx4 v[24:27],v0,s[4:7],s57 offen
s_barrier
s_cmp_lg_u32 s46,0
s_cbranch_scc1 L_ar_68
v_mov_b32 v8,128
v_mov_b32 v9,s53
s_mov_b64 exec,1
buffer_atomic_add v9,v8,s[12:15],0 offen
s_mov_b64 exec,-1
L_ar_68:
s_mov_b32 s53,0
s_waitcnt vmcnt(9)
s_add_u32 s57,s56,1441792
buffer_load_dwordx4 v[24:27],v0,s[4:7],s57 offen
s_waitcnt vmcnt(9)
s_add_u32 s57,s56,1572864
buffer_load_dwordx4 v[24:27],v0,s[4:7],s57 offen
s_waitcnt vmcnt(9)
s_add_u32 s57,s56,1703936
buffer_load_dwordx4 v[24:27],v0,s[4:7],s57 offen
s_waitcnt vmcnt(9)
s_add_u32 s57,s56,1835008
buffer_load_dwordx4 v[24:27],v0,s[4:7],s57 offen
s_waitcnt vmcnt(9)
s_add_u32 s57,s56,1966080
buffer_load_dwordx4 v[24:27],v0,s[4:7],s57 offen
s_waitcnt vmcnt(9)
s_add_u32 s57,s56,2097152
buffer_load_dwordx4 v[24:27],v0,s[4:7],s57 offen
s_waitcnt vmcnt(9)
s_add_u32 s57,s56,2228224
buffer_load_dwordx4 v[24:27],v0,s[4:7],s57 offen
s_waitcnt vmcnt(9)
s_add_u32 s57,s56,2359296
buffer_load_dwordx4 v[24:27],v0,s[4:7],s57 offen
s_waitcnt vmcnt(9)
s_add_u32 s57,s56,2490368
buffer_load_dwordx4 v[24:27],v0,s[4:7],s57 offen
s_waitcnt vmcnt(9)
s_add_u32 s57,s56,2621440
buffer_load_dwordx4 v[24:27],v0,s[4:7],s57 offen
s_waitcnt vmcnt(9)
s_add_u32 s57,s56,2752512
buffer_load_dwordx4 v[24:27],v0,s[4:7],s57 offen
s_waitcnt vmcnt(9)
s_add_u32 s57,s56,2883584
buffer_load_dwordx4 v[24:27],v0,s[4:7],s57 offen
s_waitcnt vmcnt(9)
s_add_u32 s57,s56,3014656
buffer_load_dwordx4 v[24:27],v0,s[4:7],s57 offen
s_waitcnt vmcnt(9)
s_add_u32 s57,s56,3145728
buffer_load_dwordx4 v[24:27],v0,s[4:7],s57 offen
s_waitcnt vmcnt(9)
s_add_u32 s57,s56,3276800
buffer_load_dwordx4 v[24:27],v0,s[4:7],s57 offen
s_waitcnt vmcnt(9)
s_add_u32 s57,s56,3407872
buffer_load_dwordx4 v[24:27],v0,s[4:7],s57 offen
s_waitcnt vmcnt(9)
s_add_u32 s57,s56,3538944
buffer_load_dwordx4 v[24:27],v0,s[4:7],s57 offen
s_waitcnt vmcnt(9)
s_add_u32 s57,s56,3670016
buffer_load_dwordx4 v[24:27],v0,s[4:7],s57 offen
s_waitcnt vmcnt(9)
s_add_u32 s57,s56,3801088
buffer_load_dwordx4 v[24:27],v0,s[4:7],s57 offen
s_waitcnt vmcnt(9)
s_add_u32 s57,s56,3932160
buffer_load_dwordx4 v[24:27],v0,s[4:7],s57 offen
s_waitcnt vmcnt(9)
s_add_u32 s57,s56,4063232
buffer_load_dwordx4 v[24:27],v0,s[4:7],s57 offen
s_mov_b32 s4,s24
s_mov_b32 s5,s25
s_mov_b32 s6,4194304
s_mov_b32 s7,0x20000
s_waitcnt vmcnt(9)
s_add_u32 s57,s56,0
buffer_load_dwordx4 v[24:27],v0,s[4:7],s57 offen
s_waitcnt vmcnt(9)
s_add_u32 s57,s56,131072
buffer_load_dwordx4 v[24:27],v0,s[4:7],s57 offen
s_waitcnt vmcnt(9)
s_add_u32 s57,s56,262144
buffer_load_dwordx4 v[24:27],v0,s[4:7],s57 offen
s_waitcnt vmcnt(9)
s_add_u32 s57,s56,393216
buffer_load_dwordx4 v[24:27],v0,s[4:7],s57 offen
s_waitcnt vmcnt(9)
s_add_u32 s57,s56,524288
buffer_load_dwordx4 v[24:27],v0,s[4:7],s57 offen
s_waitcnt vmcnt(9)
s_add_u32 s57,s56,655360
buffer_load_dwordx4 v[24:27],v0,s[4:7],s57 offen
s_waitcnt vmcnt(9)
s_add_u32 s57,s56,786432
buffer_load_dwordx4 v[24:27],v0,s[4:7],s57 offen
s_waitcnt vmcnt(9)
s_add_u32 s57,s56,917504
buffer_load_dwordx4 v[24:27],v0,s[4:7],s57 offen
s_waitcnt vmcnt(9)
s_add_u32 s57,s56,1048576
buffer_load_dwordx4 v[24:27],v0,s[4:7],s57 offen
s_waitcnt vmcnt(9)
s_add_u32 s57,s56,1179648
buffer_load_dwordx4 v[24:27],v0,s[4:7],s57 offen
s_waitcnt vmcnt(9)
s_add_u32 s57,s56,1310720
buffer_load_dwordx4 v[24:27],v0,s[4:7],s57 offen
s_waitcnt vmcnt(9)
s_add_u32 s57,s56,1441792
buffer_load_dwordx4 v[24:27],v0,s[4:7],s57 offen
s_waitcnt vmcnt(9)
s_add_u32 s57,s56,1572864
buffer_load_dwordx4 v[24:27],v0,s[4:7],s57 offen
s_waitcnt vmcnt(9)
s_add_u32 s57,s56,1703936
buffer_load_dwordx4 v[24:27],v0,s[4:7],s57 offen
s_waitcnt vmcnt(9)
s_add_u32 s57,s56,1835008
buffer_load_dwordx4 v[24:27],v0,s[4:7],s57 offen
s_waitcnt vmcnt(9)
s_add_u32 s57,s56,1966080
buffer_load_dwordx4 v[24:27],v0,s[4:7],s57 offen
s_waitcnt vmcnt(9)
s_add_u32 s57,s56,2097152
buffer_load_dwordx4 v[24:27],v0,s[4:7],s57 offen
s_waitcnt vmcnt(9)
s_add_u32 s57,s56,2228224
buffer_load_dwordx4 v[24:27],v0,s[4:7],s57 offen
s_waitcnt vmcnt(9)
s_add_u32 s57,s56,2359296
buffer_load_dwordx4 v[24:27],v0,s[4:7],s57 offen
s_waitcnt vmcnt(9)
s_add_u32 s57,s56,2490368
buffer_load_dwordx4 v[24:27],v0,s[4:7],s57 offen
s_waitcnt vmcnt(9)
s_add_u32 s57,s56,2621440
buffer_load_dwordx4 v[24:27],v0,s[4:7],s57 offen
s_waitcnt vmcnt(9)
s_add_u32 s57,s56,2752512
buffer_load_dwordx4 v[24:27],v0,s[4:7],s57 offen
s_waitcnt vmcnt(9)
s_add_u32 s57,s56,2883584
buffer_load_dwordx4 v[24:27],v0,s[4:7],s57 offen
s_waitcnt vmcnt(9)
s_add_u32 s57,s56,3014656
buffer_load_dwordx4 v[24:27],v0,s[4:7],s57 offen
s_waitcnt vmcnt(9)
s_add_u32 s57,s56,3145728
buffer_load_dwordx4 v[24:27],v0,s[4:7],s57 offen
s_waitcnt vmcnt(9)
s_add_u32 s57,s56,3276800
buffer_load_dwordx4 v[24:27],v0,s[4:7],s57 offen
s_waitcnt vmcnt(9)
s_add_u32 s57,s56,3407872
buffer_load_dwordx4 v[24:27],v0,s[4:7],s57 offen
s_waitcnt vmcnt(9)
s_add_u32 s57,s56,3538944
buffer_load_dwordx4 v[24:27],v0,s[4:7],s57 offen
s_waitcnt vmcnt(9)
s_add_u32 s57,s56,3670016
buffer_load_dwordx4 v[24:27],v0,s[4:7],s57 offen
s_waitcnt vmcnt(9)
s_add_u32 s57,s56,3801088
buffer_load_dwordx4 v[24:27],v0,s[4:7],s57 offen
s_waitcnt vmcnt(9)
s_add_u32 s57,s56,3932160
buffer_load_dwordx4 v[24:27],v0,s[4:7],s57 offen
s_waitcnt vmcnt(9)
s_add_u32 s57,s56,4063232
buffer_load_dwordx4 v[24:27],v0,s[4:7],s57 offen
s_mov_b32 s4,s20
s_mov_b32 s5,s21
s_mov_b32 s6,4194304
s_mov_b32 s7,0x20000
s_waitcnt vmcnt(9)
s_add_u32 s57,s56,0
buffer_load_dwordx4 v[24:27],v0,s[4:7],s57 offen
s_waitcnt vmcnt(9)
s_add_u32 s57,s56,131072
buffer_load_dwordx4 v[24:27],v0,s[4:7],s57 offen
s_waitcnt vmcnt(9)
s_add_u32 s57,s56,262144
buffer_load_dwordx4 v[24:27],v0,s[4:7],s57 offen
s_waitcnt vmcnt(9)
s_add_u32 s57,s56,393216
buffer_load_dwordx4 v[24:27],v0,s[4:7],s57 offen
s_waitcnt vmcnt(9)
s_add_u32 s57,s56,524288
buffer_load_dwordx4 v[24:27],v0,s[4:7],s57 offen
s_waitcnt vmcnt(9)
s_add_u32 s57,s56,655360
buffer_load_dwordx4 v[24:27],v0,s[4:7],s57 offen
s_waitcnt vmcnt(9)
s_add_u32 s57,s56,786432
buffer_load_dwordx4 v[24:27],v0,s[4:7],s57 offen
s_waitcnt vmcnt(9)
s_add_u32 s57,s56,917504
buffer_load_dwordx4 v[24:27],v0,s[4:7],s57 offen
s_waitcnt vmcnt(9)
s_add_u32 s57,s56,1048576
buffer_load_dwordx4 v[24:27],v0,s[4:7],s57 offen
s_waitcnt vmcnt(9)
s_add_u32 s57,s56,1179648
buffer_load_dwordx4 v[24:27],v0,s[4:7],s57 offen
s_waitcnt vmcnt(9)
s_add_u32 s57,s56,1310720
buffer_load_dwordx4 v[24:27],v0,s[4:7],s57 offen
s_waitcnt vmcnt(9)
s_add_u32 s57,s56,1441792
buffer_load_dwordx4 v[24:27],v0,s[4:7],s57 offen
s_waitcnt vmcnt(9)
s_add_u32 s57,s56,1572864
buffer_load_dwordx4 v[24:27],v0,s[4:7],s57 offen
s_waitcnt vmcnt(9)
s_add_u32 s57,s56,1703936
buffer_load_dwordx4 v[24:27],v0,s[4:7],s57 offen
s_waitcnt vmcnt(9)
s_add_u32 s57,s56,1835008
buffer_load_dwordx4 v[24:27],v0,s[4:7],s57 offen
s_waitcnt vmcnt(9)
s_add_u32 s57,s56,1966080
buffer_load_dwordx4 v[24:27],v0,s[4:7],s57 offen
s_waitcnt vmcnt(9)
s_add_u32 s57,s56,2097152
buffer_load_dwordx4 v[24:27],v0,s[4:7],s57 offen
s_waitcnt vmcnt(9)
s_add_u32 s57,s56,2228224
buffer_load_dwordx4 v[24:27],v0,s[4:7],s57 offen
s_waitcnt vmcnt(9)
s_add_u32 s57,s56,2359296
buffer_load_dwordx4 v[24:27],v0,s[4:7],s57 offen
s_waitcnt vmcnt(9)
s_add_u32 s57,s56,2490368
buffer_load_dwordx4 v[24:27],v0,s[4:7],s57 offen
s_waitcnt vmcnt(9)
s_add_u32 s57,s56,2621440
buffer_load_dwordx4 v[24:27],v0,s[4:7],s57 offen
s_waitcnt vmcnt(9)
s_add_u32 s57,s56,2752512
buffer_load_dwordx4 v[24:27],v0,s[4:7],s57 offen
s_waitcnt vmcnt(9)
s_add_u32 s57,s56,2883584
buffer_load_dwordx4 v[24:27],v0,s[4:7],s57 offen
s_waitcnt vmcnt(9)
s_add_u32 s57,s56,3014656
buffer_load_dwordx4 v[24:27],v0,s[4:7],s57 offen
s_waitcnt vmcnt(9)
s_add_u32 s57,s56,3145728
buffer_load_dwordx4 v[24:27],v0,s[4:7],s57 offen
s_waitcnt vmcnt(9)
s_add_u32 s57,s56,3276800
buffer_load_dwordx4 v[24:27],v0,s[4:7],s57 offen
s_waitcnt vmcnt(9)
s_add_u32 s57,s56,3407872
buffer_load_dwordx4 v[24:27],v0,s[4:7],s57 offen
s_waitcnt vmcnt(9)
s_add_u32 s57,s56,3538944
buffer_load_dwordx4 v[24:27],v0,s[4:7],s57 offen
s_waitcnt vmcnt(9)
s_add_u32 s57,s56,3670016
buffer_load_dwordx4 v[24:27],v0,s[4:7],s57 offen
s_waitcnt vmcnt(9)
s_add_u32 s57,s56,3801088
buffer_load_dwordx4 v[24:27],v0,s[4:7],s57 offen
s_waitcnt vmcnt(9)
s_add_u32 s57,s56,3932160
buffer_load_dwordx4 v[24:27],v0,s[4:7],s57 offen
s_waitcnt vmcnt(9)
s_add_u32 s57,s56,4063232
buffer_load_dwordx4 v[24:27],v0,s[4:7],s57 offen
L_rb_7:
s_mov_b32 s4,s26
s_mov_b32 s5,s27
s_mov_b32 s6,4194304
s_mov_b32 s7,0x20000
v_and_b32 v2,15,v1
v_lshlrev_b32 v2,4,v2
v_lshrrev_b32 v3,4,v1
v_lshl_add_u32 v2,v3,13,v2
s_and_b32 s56,s47,15
s_lshl_b32 s56,s56,18
s_lshl_b32 s57,s46,8
s_add_u32 s56,s56,s57
s_mov_b32 s61,0x05040100
s_mov_b32 s62,0x07060302
s_add_u32 s57,s56,0
buffer_load_dwordx4 v[24:27],v2,s[4:7],s57 offen offset:0
buffer_load_dwordx4 v[28:31],v2,s[4:7],s57 offen offset:1024
buffer_load_dwordx4 v[32:35],v2,s[4:7],s57 offen offset:2048
buffer_load_dwordx4 v[36:39],v2,s[4:7],s57 offen offset:3072
s_add_u32 s57,s56,4096
buffer_load_dwordx4 v[40:43],v2,s[4:7],s57 offen offset:0
buffer_load_dwordx4 v[44:47],v2,s[4:7],s57 offen offset:1024
buffer_load_dwordx4 v[48:51],v2,s[4:7],s57 offen offset:2048
buffer_load_dwordx4 v[52:55],v2,s[4:7],s57 offen offset:3072
s_add_u32 s57,s56,32768
buffer_load_dwordx4 v[56:59],v2,s[4:7],s57 offen offset:0
buffer_load_dwordx4 v[60:63],v2,s[4:7],s57 offen offset:1024
buffer_load_dwordx4 v[64:67],v2,s[4:7],s57 offen offset:2048
buffer_load_dwordx4 v[68:71],v2,s[4:7],s57 offen offset:3072
s_add_u32 s57,s56,36864
buffer_load_dwordx4 v[72:75],v2,s[4:7],s57 offen offset:0
buffer_load_dwordx4 v[76:79],v2,s[4:7],s57 offen offset:1024
buffer_load_dwordx4 v[80:83],v2,s[4:7],s57 offen offset:2048
buffer_load_dwordx4 v[84:87],v2,s[4:7],s57 offen offset:3072
s_add_u32 s57,s56,65536
buffer_load_dwordx4 v[88:91],v2,s[4:7],s57 offen offset:0
buffer_load_dwordx4 v[92:95],v2,s[4:7],s57 offen offset:1024
buffer_load_dwordx4 v[96:99],v2,s[4:7],s57 offen offset:2048
buffer_load_dwordx4 v[100:103],v2,s[4:7],s57 offen offset:3072
s_add_u32 s57,s56,69632
buffer_load_dwordx4 v[104:107],v2,s[4:7],s57 offen offset:0
buffer_load_dwordx4 v[108:111],v2,s[4:7],s57 offen offset:1024
buffer_load_dwordx4 v[112:115],v2,s[4:7],s57 offen offset:2048
buffer_load_dwordx4 v[116:119],v2,s[4:7],s57 offen offset:3072
s_add_u32 s57,s56,98304
buffer_load_dwordx4 v[120:123],v2,s[4:7],s57 offen offset:0
buffer_load_dwordx4 v[124:127],v2,s[4:7],s57 offen offset:1024
buffer_load_dwordx4 v[128:131],v2,s[4:7],s57 offen offset:2048
buffer_load_dwordx4 v[132:135],v2,s[4:7],s57 offen offset:3072
s_add_u32 s57,s56,102400
buffer_load_dwordx4 v[136:139],v2,s[4:7],s57 offen offset:0
buffer_load_dwordx4 v[140:143],v2,s[4:7],s57 offen offset:1024
buffer_load_dwordx4 v[144:147],v2,s[4:7],s57 offen offset:2048
buffer_load_dwordx4 v[148:151],v2,s[4:7],s57 offen offset:3072
s_add_u32 s57,s56,131072
buffer_load_dwordx4 v[152:155],v2,s[4:7],s57 offen offset:0
buffer_load_dwordx4 v[156:159],v2,s[4:7],s57 offen offset:1024
buffer_load_dwordx4 v[160:163],v2,s[4:7],s57 offen offset:2048
buffer_load_dwordx4 v[164:167],v2,s[4:7],s57 offen offset:3072
s_add_u32 s57,s56,135168
buffer_load_dwordx4 v[168:171],v2,s[4:7],s57 offen offset:0
buffer_load_dwordx4 v[172:175],v2,s[4:7],s57 offen offset:1024
buffer_load_dwordx4 v[176:179],v2,s[4:7],s57 offen offset:2048
buffer_load_dwordx4 v[180:183],v2,s[4:7],s57 offen offset:3072
s_add_u32 s57,s56,163840
buffer_load_dwordx4 v[184:187],v2,s[4:7],s57 offen offset:0
buffer_load_dwordx4 v[188:191],v2,s[4:7],s57 offen offset:1024
buffer_load_dwordx4 v[192:195],v2,s[4:7],s57 offen offset:2048
buffer_load_dwordx4 v[196:199],v2,s[4:7],s57 offen offset:3072
s_add_u32 s57,s56,167936
buffer_load_dwordx4 v[200:203],v2,s[4:7],s57 offen offset:0
buffer_load_dwordx4 v[204:207],v2,s[4:7],s57 offen offset:1024
buffer_load_dwordx4 v[208:211],v2,s[4:7],s57 offen offset:2048
buffer_load_dwordx4 v[212:215],v2,s[4:7],s57 offen offset:3072
s_waitcnt vmcnt(40)
v_perm_b32 v216,v28,v24,s61
v_perm_b32 v217,v36,v32,s61
v_perm_b32 v218,v44,v40,s61
v_perm_b32 v219,v52,v48,s61
v_accvgpr_write_b32 a0,v216
v_accvgpr_write_b32 a1,v217
v_accvgpr_write_b32 a2,v218
v_accvgpr_write_b32 a3,v219
v_perm_b32 v216,v28,v24,s62
v_perm_b32 v217,v36,v32,s62
v_perm_b32 v218,v44,v40,s62
v_perm_b32 v219,v52,v48,s62
v_accvgpr_write_b32 a4,v216
v_accvgpr_write_b32 a5,v217
v_accvgpr_write_b32 a6,v218
v_accvgpr_write_b32 a7,v219
v_perm_b32 v216,v29,v25,s61
v_perm_b32 v217,v37,v33,s61
v_perm_b32 v218,v45,v41,s61
v_perm_b32 v219,v53,v49,s61
v_accvgpr_write_b32 a8,v216
v_accvgpr_write_b32 a9,v217
v_accvgpr_write_b32 a10,v218
v_accvgpr_write_b32 a11,v219
v_perm_b32 v216,v29,v25,s62
v_perm_b32 v217,v37,v33,s62
v_perm_b32 v218,v45,v41,s62
v_perm_b32 v219,v53,v49,s62
v_accvgpr_write_b32 a12,v216
v_accvgpr_write_b32 a13,v217
v_accvgpr_write_b32 a14,v218
v_accvgpr_write_b32 a15,v219
v_perm_b32 v216,v30,v26,s61
v_perm_b32 v217,v38,v34,s61
v_perm_b32 v218,v46,v42,s61
v_perm_b32 v219,v54,v50,s61
v_accvgpr_write_b32 a16,v216
v_accvgpr_write_b32 a17,v217
v_accvgpr_write_b32 a18,v218
v_accvgpr_write_b32 a19,v219
v_perm_b32 v216,v30,v26,s62
v_perm_b32 v217,v38,v34,s62
v_perm_b32 v218,v46,v42,s62
v_perm_b32 v219,v54,v50,s62
v_accvgpr_write_b32 a20,v216
v_accvgpr_write_b32 a21,v217
v_accvgpr_write_b32 a22,v218
v_accvgpr_write_b32 a23,v219
v_perm_b32 v216,v31,v27,s61
v_perm_b32 v217,v39,v35,s61
v_perm_b32 v218,v47,v43,s61
v_perm_b32 v219,v55,v51,s61
v_accvgpr_write_b32 a24,v216
v_accvgpr_write_b32 a25,v217
v_accvgpr_write_b32 a26,v218
v_accvgpr_write_b32 a27,v219
v_perm_b32 v216,v31,v27,s62
v_perm_b32 v217,v39,v35,s62
v_perm_b32 v218,v47,v43,s62
v_perm_b32 v219,v55,v51,s62
v_accvgpr_write_b32 a28,v216
v_accvgpr_write_b32 a29,v217
v_accvgpr_write_b32 a30,v218
v_accvgpr_write_b32 a31,v219
s_add_u32 s57,s56,196608
buffer_load_dwordx4 v[24:27],v2,s[4:7],s57 offen offset:0
buffer_load_dwordx4 v[28:31],v2,s[4:7],s57 offen offset:1024
buffer_load_dwordx4 v[32:35],v2,s[4:7],s57 offen offset:2048
buffer_load_dwordx4 v[36:39],v2,s[4:7],s57 offen offset:3072
s_add_u32 s57,s56,200704
buffer_load_dwordx4 v[40:43],v2,s[4:7],s57 offen offset:0
buffer_load_dwordx4 v[44:47],v2,s[4:7],s57 offen offset:1024
buffer_load_dwordx4 v[48:51],v2,s[4:7],s57 offen offset:2048
buffer_load_dwordx4 v[52:55],v2,s[4:7],s57 offen offset:3072
s_barrier
s_cmp_lg_u32 s46,0
s_cbranch_scc1 L_ar_69
v_mov_b32 v8,128
v_mov_b32 v9,s53
s_mov_b64 exec,1
buffer_atomic_add v9,v8,s[12:15],0 offen
s_mov_b64 exec,-1
L_ar_69:
s_mov_b32 s53,0
s_waitcnt vmcnt(40)
v_perm_b32 v216,v60,v56,s61
v_perm_b32 v217,v68,v64,s61
v_perm_b32 v218,v76,v72,s61
v_perm_b32 v219,v84,v80,s61
v_accvgpr_write_b32 a32,v216
v_accvgpr_write_b32 a33,v217
v_accvgpr_write_b32 a34,v218
v_accvgpr_write_b32 a35,v219
v_perm_b32 v216,v60,v56,s62
v_perm_b32 v217,v68,v64,s62
v_perm_b32 v218,v76,v72,s62
v_perm_b32 v219,v84,v80,s62
v_accvgpr_write_b32 a36,v216
v_accvgpr_write_b32 a37,v217
v_accvgpr_write_b32 a38,v218
v_accvgpr_write_b32 a39,v219
v_perm_b32 v216,v61,v57,s61
v_perm_b32 v217,v69,v65,s61
v_perm_b32 v218,v77,v73,s61
v_perm_b32 v219,v85,v81,s61
v_accvgpr_write_b32 a40,v216
v_accvgpr_write_b32 a41,v217
v_accvgpr_write_b32 a42,v218
v_accvgpr_write_b32 a43,v219
v_perm_b32 v216,v61,v57,s62
v_perm_b32 v217,v69,v65,s62
v_perm_b32 v218,v77,v73,s62
v_perm_b32 v219,v85,v81,s62
v_accvgpr_write_b32 a44,v216
v_accvgpr_write_b32 a45,v217
v_accvgpr_write_b32 a46,v218
v_accvgpr_write_b32 a47,v219
v_perm_b32 v216,v62,v58,s61
v_perm_b32 v217,v70,v66,s61
v_perm_b32 v218,v78,v74,s61
v_perm_b32 v219,v86,v82,s61
v_accvgpr_write_b32 a48,v216
v_accvgpr_write_b32 a49,v217
v_accvgpr_write_b32 a50,v218
v_accvgpr_write_b32 a51,v219
v_perm_b32 v216,v62,v58,s62
v_perm_b32 v217,v70,v66,s62
v_perm_b32 v218,v78,v74,s62
v_perm_b32 v219,v86,v82,s62
v_accvgpr_write_b32 a52,v216
v_accvgpr_write_b32 a53,v217
v_accvgpr_write_b32 a54,v218
v_accvgpr_write_b32 a55,v219
v_perm_b32 v216,v63,v59,s61
v_perm_b32 v217,v71,v67,s61
v_perm_b32 v218,v79,v75,s61
v_perm_b32 v219,v87,v83,s61
v_accvgpr_write_b32 a56,v216
v_accvgpr_write_b32 a57,v217
v_accvgpr_write_b32 a58,v218
v_accvgpr_write_b32 a59,v219
v_perm_b32 v216,v63,v59,s62
v_perm_b32 v217,v71,v67,s62
v_perm_b32 v218,v79,v75,s62
v_perm_b32 v219,v87,v83,s62
v_accvgpr_write_b32 a60,v216
v_accvgpr_write_b32 a61,v217
v_accvgpr_write_b32 a62,v218
v_accvgpr_write_b32 a63,v219
s_add_u32 s57,s56,229376
buffer_load_dwordx4 v[56:59],v2,s[4:7],s57 offen offset:0
buffer_load_dwordx4 v[60:63],v2,s[4:7],s57 offen offset:1024
buffer_load_dwordx4 v[64:67],v2,s[4:7],s57 offen offset:2048
buffer_load_dwordx4 v[68:71],v2,s[4:7],s57 offen offset:3072
s_add_u32 s57,s56,233472
buffer_load_dwordx4 v[72:75],v2,s[4:7],s57 offen offset:0
buffer_load_dwordx4 v[76:79],v2,s[4:7],s57 offen offset:1024
buffer_load_dwordx4 v[80:83],v2,s[4:7],s57 offen offset:2048
buffer_load_dwordx4 v[84:87],v2,s[4:7],s57 offen offset:3072
s_waitcnt vmcnt(40)
v_perm_b32 v216,v92,v88,s61
v_perm_b32 v217,v100,v96,s61
v_perm_b32 v218,v108,v104,s61
v_perm_b32 v219,v116,v112,s61
v_accvgpr_write_b32 a64,v216
v_accvgpr_write_b32 a65,v217
v_accvgpr_write_b32 a66,v218
v_accvgpr_write_b32 a67,v219
v_perm_b32 v216,v92,v88,s62
v_perm_b32 v217,v100,v96,s62
v_perm_b32 v218,v108,v104,s62
v_perm_b32 v219,v116,v112,s62
v_accvgpr_write_b32 a68,v216
v_accvgpr_write_b32 a69,v217
v_accvgpr_write_b32 a70,v218
v_accvgpr_write_b32 a71,v219
v_perm_b32 v216,v93,v89,s61
v_perm_b32 v217,v101,v97,s61
v_perm_b32 v218,v109,v105,s61
v_perm_b32 v219,v117,v113,s61
v_accvgpr_write_b32 a72,v216
v_accvgpr_write_b32 a73,v217
v_accvgpr_write_b32 a74,v218
v_accvgpr_write_b32 a75,v219
v_perm_b32 v216,v93,v89,s62
v_perm_b32 v217,v101,v97,s62
v_perm_b32 v218,v109,v105,s62
v_perm_b32 v219,v117,v113,s62
v_accvgpr_write_b32 a76,v216
v_accvgpr_write_b32 a77,v217
v_accvgpr_write_b32 a78,v218
v_accvgpr_write_b32 a79,v219
v_perm_b32 v216,v94,v90,s61
v_perm_b32 v217,v102,v98,s61
v_perm_b32 v218,v110,v106,s61
v_perm_b32 v219,v118,v114,s61
v_accvgpr_write_b32 a80,v216
v_accvgpr_write_b32 a81,v217
v_accvgpr_write_b32 a82,v218
v_accvgpr_write_b32 a83,v219
v_perm_b32 v216,v94,v90,s62
v_perm_b32 v217,v102,v98,s62
v_perm_b32 v218,v110,v106,s62
v_perm_b32 v219,v118,v114,s62
v_accvgpr_write_b32 a84,v216
v_accvgpr_write_b32 a85,v217
v_accvgpr_write_b32 a86,v218
v_accvgpr_write_b32 a87,v219
v_perm_b32 v216,v95,v91,s61
v_perm_b32 v217,v103,v99,s61
v_perm_b32 v218,v111,v107,s61
v_perm_b32 v219,v119,v115,s61
v_accvgpr_write_b32 a88,v216
v_accvgpr_write_b32 a89,v217
v_accvgpr_write_b32 a90,v218
v_accvgpr_write_b32 a91,v219
v_perm_b32 v216,v95,v91,s62
v_perm_b32 v217,v103,v99,s62
v_perm_b32 v218,v111,v107,s62
v_perm_b32 v219,v119,v115,s62
v_accvgpr_write_b32 a92,v216
v_accvgpr_write_b32 a93,v217
v_accvgpr_write_b32 a94,v218
v_accvgpr_write_b32 a95,v219
s_waitcnt vmcnt(32)
v_perm_b32 v216,v124,v120,s61
v_perm_b32 v217,v132,v128,s61
v_perm_b32 v218,v140,v136,s61
v_perm_b32 v219,v148,v144,s61
v_accvgpr_write_b32 a96,v216
v_accvgpr_write_b32 a97,v217
v_accvgpr_write_b32 a98,v218
v_accvgpr_write_b32 a99,v219
v_perm_b32 v216,v124,v120,s62
v_perm_b32 v217,v132,v128,s62
v_perm_b32 v218,v140,v136,s62
v_perm_b32 v219,v148,v144,s62
v_accvgpr_write_b32 a100,v216
v_accvgpr_write_b32 a101,v217
v_accvgpr_write_b32 a102,v218
v_accvgpr_write_b32 a103,v219
v_perm_b32 v216,v125,v121,s61
v_perm_b32 v217,v133,v129,s61
v_perm_b32 v218,v141,v137,s61
v_perm_b32 v219,v149,v145,s61
v_accvgpr_write_b32 a104,v216
v_accvgpr_write_b32 a105,v217
v_accvgpr_write_b32 a106,v218
v_accvgpr_write_b32 a107,v219
v_perm_b32 v216,v125,v121,s62
v_perm_b32 v217,v133,v129,s62
v_perm_b32 v218,v141,v137,s62
v_perm_b32 v219,v149,v145,s62
v_accvgpr_write_b32 a108,v216
v_accvgpr_write_b32 a109,v217
v_accvgpr_write_b32 a110,v218
v_accvgpr_write_b32 a111,v219
v_perm_b32 v216,v126,v122,s61
v_perm_b32 v217,v134,v130,s61
v_perm_b32 v218,v142,v138,s61
v_perm_b32 v219,v150,v146,s61
v_accvgpr_write_b32 a112,v216
v_accvgpr_write_b32 a113,v217
v_accvgpr_write_b32 a114,v218
v_accvgpr_write_b32 a115,v219
v_perm_b32 v216,v126,v122,s62
v_perm_b32 v217,v134,v130,s62
v_perm_b32 v218,v142,v138,s62
v_perm_b32 v219,v150,v146,s62
v_accvgpr_write_b32 a116,v216
v_accvgpr_write_b32 a117,v217
v_accvgpr_write_b32 a118,v218
v_accvgpr_write_b32 a119,v219
v_perm_b32 v216,v127,v123,s61
v_perm_b32 v217,v135,v131,s61
v_perm_b32 v218,v143,v139,s61
v_perm_b32 v219,v151,v147,s61
v_accvgpr_write_b32 a120,v216
v_accvgpr_write_b32 a121,v217
v_accvgpr_write_b32 a122,v218
v_accvgpr_write_b32 a123,v219
v_perm_b32 v216,v127,v123,s62
v_perm_b32 v217,v135,v131,s62
v_perm_b32 v218,v143,v139,s62
v_perm_b32 v219,v151,v147,s62
v_accvgpr_write_b32 a124,v216
v_accvgpr_write_b32 a125,v217
v_accvgpr_write_b32 a126,v218
v_accvgpr_write_b32 a127,v219
s_waitcnt vmcnt(24)
v_perm_b32 v216,v156,v152,s61
v_perm_b32 v217,v164,v160,s61
v_perm_b32 v218,v172,v168,s61
v_perm_b32 v219,v180,v176,s61
v_accvgpr_write_b32 a128,v216
v_accvgpr_write_b32 a129,v217
v_accvgpr_write_b32 a130,v218
v_accvgpr_write_b32 a131,v219
v_perm_b32 v216,v156,v152,s62
v_perm_b32 v217,v164,v160,s62
v_perm_b32 v218,v172,v168,s62
v_perm_b32 v219,v180,v176,s62
v_accvgpr_write_b32 a132,v216
v_accvgpr_write_b32 a133,v217
v_accvgpr_write_b32 a134,v218
v_accvgpr_write_b32 a135,v219
v_perm_b32 v216,v157,v153,s61
v_perm_b32 v217,v165,v161,s61
v_perm_b32 v218,v173,v169,s61
v_perm_b32 v219,v181,v177,s61
v_accvgpr_write_b32 a136,v216
v_accvgpr_write_b32 a137,v217
v_accvgpr_write_b32 a138,v218
v_accvgpr_write_b32 a139,v219
v_perm_b32 v216,v157,v153,s62
v_perm_b32 v217,v165,v161,s62
v_perm_b32 v218,v173,v169,s62
v_perm_b32 v219,v181,v177,s62
v_accvgpr_write_b32 a140,v216
v_accvgpr_write_b32 a141,v217
v_accvgpr_write_b32 a142,v218
v_accvgpr_write_b32 a143,v219
v_perm_b32 v216,v158,v154,s61
v_perm_b32 v217,v166,v162,s61
v_perm_b32 v218,v174,v170,s61
v_perm_b32 v219,v182,v178,s61
v_accvgpr_write_b32 a144,v216
v_accvgpr_write_b32 a145,v217
v_accvgpr_write_b32 a146,v218
v_accvgpr_write_b32 a147,v219
v_perm_b32 v216,v158,v154,s62
v_perm_b32 v217,v166,v162,s62
v_perm_b32 v218,v174,v170,s62
v_perm_b32 v219,v182,v178,s62
v_accvgpr_write_b32 a148,v216
v_accvgpr_write_b32 a149,v217
v_accvgpr_write_b32 a150,v218
v_accvgpr_write_b32 a151,v219
v_perm_b32 v216,v159,v155,s61
v_perm_b32 v217,v167,v163,s61
v_perm_b32 v218,v175,v171,s61
v_perm_b32 v219,v183,v179,s61
v_accvgpr_write_b32 a152,v216
v_accvgpr_write_b32 a153,v217
v_accvgpr_write_b32 a154,v218
v_accvgpr_write_b32 a155,v219
v_perm_b32 v216,v159,v155,s62
v_perm_b32 v217,v167,v163,s62
v_perm_b32 v218,v175,v171,s62
v_perm_b32 v219,v183,v179,s62
v_accvgpr_write_b32 a156,v216
v_accvgpr_write_b32 a157,v217
v_accvgpr_write_b32 a158,v218
v_accvgpr_write_b32 a159,v219
s_waitcnt vmcnt(16)
v_perm_b32 v216,v188,v184,s61
v_perm_b32 v217,v196,v192,s61
v_perm_b32 v218,v204,v200,s61
v_perm_b32 v219,v212,v208,s61
v_accvgpr_write_b32 a160,v216
v_accvgpr_write_b32 a161,v217
v_accvgpr_write_b32 a162,v218
v_accvgpr_write_b32 a163,v219
v_perm_b32 v216,v188,v184,s62
v_perm_b32 v217,v196,v192,s62
v_perm_b32 v218,v204,v200,s62
v_perm_b32 v219,v212,v208,s62
v_accvgpr_write_b32 a164,v216
v_accvgpr_write_b32 a165,v217
v_accvgpr_write_b32 a166,v218
v_accvgpr_write_b32 a167,v219
v_perm_b32 v216,v189,v185,s61
v_perm_b32 v217,v197,v193,s61
v_perm_b32 v218,v205,v201,s61
v_perm_b32 v219,v213,v209,s61
v_accvgpr_write_b32 a168,v216
v_accvgpr_write_b32 a169,v217
v_accvgpr_write_b32 a170,v218
v_accvgpr_write_b32 a171,v219
v_perm_b32 v216,v189,v185,s62
v_perm_b32 v217,v197,v193,s62
v_perm_b32 v218,v205,v201,s62
v_perm_b32 v219,v213,v209,s62
v_accvgpr_write_b32 a172,v216
v_accvgpr_write_b32 a173,v217
v_accvgpr_write_b32 a174,v218
v_accvgpr_write_b32 a175,v219
v_perm_b32 v216,v190,v186,s61
v_perm_b32 v217,v198,v194,s61
v_perm_b32 v218,v206,v202,s61
v_perm_b32 v219,v214,v210,s61
v_accvgpr_write_b32 a176,v216
v_accvgpr_write_b32 a177,v217
v_accvgpr_write_b32 a178,v218
v_accvgpr_write_b32 a179,v219
v_perm_b32 v216,v190,v186,s62
v_perm_b32 v217,v198,v194,s62
v_perm_b32 v218,v206,v202,s62
v_perm_b32 v219,v214,v210,s62
v_accvgpr_write_b32 a180,v216
v_accvgpr_write_b32 a181,v217
v_accvgpr_write_b32 a182,v218
v_accvgpr_write_b32 a183,v219
v_perm_b32 v216,v191,v187,s61
v_perm_b32 v217,v199,v195,s61
v_perm_b32 v218,v207,v203,s61
v_perm_b32 v219,v215,v211,s61
v_accvgpr_write_b32 a184,v216
v_accvgpr_write_b32 a185,v217
v_accvgpr_write_b32 a186,v218
v_accvgpr_write_b32 a187,v219
v_perm_b32 v216,v191,v187,s62
v_perm_b32 v217,v199,v195,s62
v_perm_b32 v218,v207,v203,s62
v_perm_b32 v219,v215,v211,s62
v_accvgpr_write_b32 a188,v216
v_accvgpr_write_b32 a189,v217
v_accvgpr_write_b32 a190,v218
v_accvgpr_write_b32 a191,v219
s_waitcnt vmcnt(8)
v_perm_b32 v216,v28,v24,s61
v_perm_b32 v217,v36,v32,s61
v_perm_b32 v218,v44,v40,s61
v_perm_b32 v219,v52,v48,s61
v_accvgpr_write_b32 a192,v216
v_accvgpr_write_b32 a193,v217
v_accvgpr_write_b32 a194,v218
v_accvgpr_write_b32 a195,v219
v_perm_b32 v216,v28,v24,s62
v_perm_b32 v217,v36,v32,s62
v_perm_b32 v218,v44,v40,s62
v_perm_b32 v219,v52,v48,s62
v_accvgpr_write_b32 a196,v216
v_accvgpr_write_b32 a197,v217
v_accvgpr_write_b32 a198,v218
v_accvgpr_write_b32 a199,v219
v_perm_b32 v216,v29,v25,s61
v_perm_b32 v217,v37,v33,s61
v_perm_b32 v218,v45,v41,s61
v_perm_b32 v219,v53,v49,s61
v_accvgpr_write_b32 a200,v216
v_accvgpr_write_b32 a201,v217
v_accvgpr_write_b32 a202,v218
v_accvgpr_write_b32 a203,v219
v_perm_b32 v216,v29,v25,s62
v_perm_b32 v217,v37,v33,s62
v_perm_b32 v218,v45,v41,s62
v_perm_b32 v219,v53,v49,s62
v_accvgpr_write_b32 a204,v216
v_accvgpr_write_b32 a205,v217
v_accvgpr_write_b32 a206,v218
v_accvgpr_write_b32 a207,v219
v_perm_b32 v216,v30,v26,s61
v_perm_b32 v217,v38,v34,s61
v_perm_b32 v218,v46,v42,s61
v_perm_b32 v219,v54,v50,s61
v_accvgpr_write_b32 a208,v216
v_accvgpr_write_b32 a209,v217
v_accvgpr_write_b32 a210,v218
v_accvgpr_write_b32 a211,v219
v_perm_b32 v216,v30,v26,s62
v_perm_b32 v217,v38,v34,s62
v_perm_b32 v218,v46,v42,s62
v_perm_b32 v219,v54,v50,s62
v_accvgpr_write_b32 a212,v216
v_accvgpr_write_b32 a213,v217
v_accvgpr_write_b32 a214,v218
v_accvgpr_write_b32 a215,v219
v_perm_b32 v216,v31,v27,s61
v_perm_b32 v217,v39,v35,s61
v_perm_b32 v218,v47,v43,s61
v_perm_b32 v219,v55,v51,s61
v_accvgpr_write_b32 a216,v216
v_accvgpr_write_b32 a217,v217
v_accvgpr_write_b32 a218,v218
v_accvgpr_write_b32 a219,v219
v_perm_b32 v216,v31,v27,s62
v_perm_b32 v217,v39,v35,s62
v_perm_b32 v218,v47,v43,s62
v_perm_b32 v219,v55,v51,s62
v_accvgpr_write_b32 a220,v216
v_accvgpr_write_b32 a221,v217
v_accvgpr_write_b32 a222,v218
v_accvgpr_write_b32 a223,v219
s_waitcnt vmcnt(0)
v_perm_b32 v216,v60,v56,s61
v_perm_b32 v217,v68,v64,s61
v_perm_b32 v218,v76,v72,s61
v_perm_b32 v219,v84,v80,s61
v_accvgpr_write_b32 a224,v216
v_accvgpr_write_b32 a225,v217
v_accvgpr_write_b32 a226,v218
v_accvgpr_write_b32 a227,v219
v_perm_b32 v216,v60,v56,s62
v_perm_b32 v217,v68,v64,s62
v_perm_b32 v218,v76,v72,s62
v_perm_b32 v219,v84,v80,s62
v_accvgpr_write_b32 a228,v216
v_accvgpr_write_b32 a229,v217
v_accvgpr_write_b32 a230,v218
v_accvgpr_write_b32 a231,v219
v_perm_b32 v216,v61,v57,s61
v_perm_b32 v217,v69,v65,s61
v_perm_b32 v218,v77,v73,s61
v_perm_b32 v219,v85,v81,s61
v_accvgpr_write_b32 a232,v216
v_accvgpr_write_b32 a233,v217
v_accvgpr_write_b32 a234,v218
v_accvgpr_write_b32 a235,v219
v_perm_b32 v216,v61,v57,s62
v_perm_b32 v217,v69,v65,s62
v_perm_b32 v218,v77,v73,s62
v_perm_b32 v219,v85,v81,s62
v_accvgpr_write_b32 a236,v216
v_accvgpr_write_b32 a237,v217
v_accvgpr_write_b32 a238,v218
v_accvgpr_write_b32 a239,v219
v_perm_b32 v216,v62,v58,s61
v_perm_b32 v217,v70,v66,s61
v_perm_b32 v218,v78,v74,s61
v_perm_b32 v219,v86,v82,s61
v_accvgpr_write_b32 a240,v216
v_accvgpr_write_b32 a241,v217
v_accvgpr_write_b32 a242,v218
v_accvgpr_write_b32 a243,v219
v_perm_b32 v216,v62,v58,s62
v_perm_b32 v217,v70,v66,s62
v_perm_b32 v218,v78,v74,s62
v_perm_b32 v219,v86,v82,s62
v_accvgpr_write_b32 a244,v216
v_accvgpr_write_b32 a245,v217
v_accvgpr_write_b32 a246,v218
v_accvgpr_write_b32 a247,v219
v_perm_b32 v216,v63,v59,s61
v_perm_b32 v217,v71,v67,s61
v_perm_b32 v218,v79,v75,s61
v_perm_b32 v219,v87,v83,s61
v_accvgpr_write_b32 a248,v216
v_accvgpr_write_b32 a249,v217
v_accvgpr_write_b32 a250,v218
v_accvgpr_write_b32 a251,v219
v_perm_b32 v216,v63,v59,s62
v_perm_b32 v217,v71,v67,s62
v_perm_b32 v218,v79,v75,s62
v_perm_b32 v219,v87,v83,s62
v_accvgpr_write_b32 a252,v216
v_accvgpr_write_b32 a253,v217
v_accvgpr_write_b32 a254,v218
v_accvgpr_write_b32 a255,v219
v_mov_b32 v123,159744
s_cmp_lg_u32 s46,0
s_cbranch_scc1 L_gbd_71
v_mov_b32 v124,128
L_gb_70:
buffer_load_dword v125,v124,s[12:15],0 offen sc1
s_waitcnt vmcnt(0)
v_readfirstlane_b32 s56,v125
ds_write_b32 v123,v125
s_bitcmp1_b32 s56,8
s_cbranch_scc1 L_gbd_71
s_sleep 4
s_sub_u32 s49,s49,1
s_cmp_gt_i32 s49,0
s_cbranch_scc1 L_gb_70
s_branch L_abort
L_gbd_71:
s_waitcnt lgkmcnt(0)
s_barrier
ds_read_b32 v125,v123
s_waitcnt lgkmcnt(0)
v_readfirstlane_b32 s56,v125
s_barrier
s_lshr_b32 s56,s56,16
s_andn2_b32 s56,s56,s3
s_cbranch_scc1 L_spread
s_max_u32 s54,s48,5
s_sub_u32 s54,s54,5
s_lshl_b32 s54,s54,1
s_lshr_b32 s56,s47,4
s_add_u32 s54,s54,s56
s_cmp_lg_u32 s3,0
s_cbranch_scc1 L_wa
v_and_b32 v238,15,v1
v_and_b32 v239,1,v1
v_lshlrev_b32 v239,4,v239
v_mov_b32 v240,0x3f80
v_lshlrev_b32 v240,v239,v240
v_lshrrev_b32 v238,1,v238
v_cmp_eq_u32 vcc,0,v238
s_nop 1
v_cndmask_b32 v156,0,v240,vcc
v_cmp_eq_u32 vcc,1,v238
s_nop 1
v_cndmask_b32 v157,0,v240,vcc
v_cmp_eq_u32 vcc,2,v238
s_nop 1
v_cndmask_b32 v158,0,v240,vcc
v_cmp_eq_u32 vcc,3,v238
s_nop 1
v_cndmask_b32 v159,0,v240,vcc
s_mov_b32 s4,s32
s_mov_b32 s5,s33
s_mov_b32 s6,1024
s_mov_b32 s7,0x20000
buffer_load_dwordx4 v[224:227],v0,s[4:7],0 offen
v_and_b32 v238,15,v1
v_lshrrev_b32 v239,4,v1
v_lshlrev_b32 v240,2,v239
v_mov_b32 v241,0xf149f2ca
s_and_b32 s56,s46,1
s_lshl_b32 s56,s56,4
v_add_u32 v242,s56,v238
v_add_u32 v243,0,v240
v_cmp_gt_u32 vcc,v243,v242
s_nop 1
v_cndmask_b32 v8,0,v241,vcc
v_add_u32 v243,1,v240
v_cmp_gt_u32 vcc,v243,v242
s_nop 1
v_cndmask_b32 v9,0,v241,vcc
v_add_u32 v243,2,v240
v_cmp_gt_u32 vcc,v243,v242
s_nop 1
v_cndmask_b32 v10,0,v241,vcc
v_add_u32 v243,3,v240
v_cmp_gt_u32 vcc,v243,v242
s_nop 1
v_cndmask_b32 v11,0,v241,vcc
v_add_u32 v243,16,v240
v_cmp_gt_u32 vcc,v243,v242
s_nop 1
v_cndmask_b32 v12,0,v241,vcc
v_add_u32 v243,17,v240
v_cmp_gt_u32 vcc,v243,v242
s_nop 1
v_cndmask_b32 v13,0,v241,vcc
v_add_u32 v243,18,v240
v_cmp_gt_u32 vcc,v243,v242
s_nop 1
v_cndmask_b32 v14,0,v241,vcc
v_add_u32 v243,19,v240
v_cmp_gt_u32 vcc,v243,v242
s_nop 1
v_cndmask_b32 v15,0,v241,vcc
v_mov_b32 v152,s80
v_mov_b32 v145,0
v_mov_b32 v146,0
s_lshl_b32 s56,s46,12
s_add_u32 s56,s56,131072
v_add_u32 v3,s56,v0
v_add_u32 v4,131072,v0
s_lshl_b32 s56,s46,8
v_lshlrev_b32 v7,4,v238
v_add_u32 v7,s56,v7
v_lshl_add_u32 v5,v239,16,v7
v_lshlrev_b32 v6,1,v7
v_lshl_add_u32 v7,v239,10,v7
v_and_b32 v243,1,v239
v_lshl_add_u32 v6,v243,4,v6
v_lshrrev_b32 v243,1,v239
v_lshl_add_u32 v6,v243,12,v6
v_add_u32 v6,147456,v6
v_lshlrev_b32 v16,2,v1
v_lshlrev_b32 v21,3,v238
s_and_b32 s68,s47,15
s_lshl_b32 s56,s68,10
v_add_u32 v5,s56,v5
s_lshl_b32 s56,s68,15
v_add_u32 v7,s56,v7
s_lshl_b32 s69,s54,20
s_add_u32 s69,s69,20971520
s_lshl_b32 s87,s54,13
s_add_u32 s87,s87,10486272
s_lshl4_add_u32 s74,s68,s87
s_lshl2_add_u32 s74,s46,s74
s_lshl_b32 s68,s68,1
s_lshr_b32 s56,s46,1
s_add_u32 s68,s68,s56
s_mov_b32 s66,0
s_mov_b32 s67,0
s_mov_b32 s73,0x80000000
s_mov_b32 s75,0
s_mov_b32 s37,0
s_mov_b32 s42,4294966272
s_mov_b32 s43,4294967295
s_mov_b64 s[38:39],0
s_sub_u32 s36,s54,12
s_and_b32 s36,s36,3
s_mov_b32 s12,s40
s_mov_b32 s13,s41
s_mov_b32 s14,2097152
s_mov_b32 s15,0x20000
v_add_u32 v21,10487168,v21
v_mov_b32 v244,v21
s_and_b32 s56,s50,2048
s_add_u32 s56,s56,147456
v_lshlrev_b32 v23,5,v1
v_add_u32 v23,s56,v23
v_and_b32 v253,32,v0
v_lshrrev_b32 v245,2,v253
v_add_u32 v253,v253,v245
v_sub_u32 v253,v0,v253
v_add_u32 v253,8,v253
v_mov_b32 v254,0x80000000
s_mov_b32 s56,1408
v_writelane_b32 v254,s56,0
s_mov_b32 s56,256
v_writelane_b32 v254,s56,1
s_mov_b32 s56,1280
v_writelane_b32 v254,s56,2
v_mov_b32 v245,155648
s_lshl_b32 s56,s46,2
v_add_u32 v247,s56,v245
s_waitcnt vmcnt(0)
v_lshlrev_b32 v228,16,v224
v_and_b32 v229,0xffff0000,v224
v_lshlrev_b32 v230,16,v225
v_and_b32 v231,0xffff0000,v225
v_lshlrev_b32 v232,16,v226
v_and_b32 v233,0xffff0000,v226
v_lshlrev_b32 v234,16,v227
v_and_b32 v235,0xffff0000,v227
v_mul_f32 v255,v228,v228
v_fma_f32 v255,v229,v229,v255
v_fma_f32 v255,v230,v230,v255
v_fma_f32 v255,v231,v231,v255
v_fma_f32 v255,v232,v232,v255
v_fma_f32 v255,v233,v233,v255
v_fma_f32 v255,v234,v234,v255
v_fma_f32 v255,v235,v235,v255
s_nop 1
v_add_f32_dpp v255,v255,v255 row_ror:8 row_mask:0xf bank_mask:0xf
s_nop 1
v_add_f32_dpp v255,v255,v255 row_ror:4 row_mask:0xf bank_mask:0xf
s_nop 1
v_add_f32_dpp v255,v255,v255 row_ror:2 row_mask:0xf bank_mask:0xf
s_nop 1
v_add_f32_dpp v255,v255,v255 row_ror:1 row_mask:0xf bank_mask:0xf
v_mov_b32 v238,v255
s_nop 1
v_permlane16_swap_b32 v255,v238
v_add_f32 v255,v255,v238
v_mov_b32 v238,v255
s_nop 1
v_permlane32_swap_b32 v255,v238
v_add_f32 v255,v255,v238
v_sqrt_f32 v255,v255
v_sub_u32 v238,68,v1
v_cvt_f32_u32 v238,v238
v_log_f32 v238,v238
v_mov_b32 v239,0x3ff9999a
v_fmac_f32 v239,0x3e632166,v238
v_mul_f32 v255,v255,v239
v_or_b32 v255,0x80000000,v255
s_xor_b32 s34,s69,524288
buffer_load_dwordx4 v[160:163],v7,s[8:11],s34 offen
s_add_u32 s34,s34,4096
buffer_load_dwordx4 v[164:167],v7,s[8:11],s34 offen
s_add_u32 s34,s34,4096
buffer_load_dwordx4 v[168:171],v7,s[8:11],s34 offen
s_add_u32 s34,s34,4096
buffer_load_dwordx4 v[172:175],v7,s[8:11],s34 offen
s_add_u32 s34,s34,4096
buffer_load_dwordx4 v[176:179],v7,s[8:11],s34 offen
s_add_u32 s34,s34,4096
buffer_load_dwordx4 v[180:183],v7,s[8:11],s34 offen
s_add_u32 s34,s34,4096
buffer_load_dwordx4 v[184:187],v7,s[8:11],s34 offen
s_add_u32 s34,s34,4096
buffer_load_dwordx4 v[188:191],v7,s[8:11],s34 offen
s_xor_b32 s69,s69,524288
s_xor_b32 s34,s69,524288
buffer_load_dwordx4 v[160:163],v7,s[8:11],s34 offen
s_add_u32 s34,s34,4096
buffer_load_dwordx4 v[164:167],v7,s[8:11],s34 offen
s_add_u32 s34,s34,4096
buffer_load_dwordx4 v[168:171],v7,s[8:11],s34 offen
s_add_u32 s34,s34,4096
buffer_load_dwordx4 v[172:175],v7,s[8:11],s34 offen
s_add_u32 s34,s34,4096
buffer_load_dwordx4 v[176:179],v7,s[8:11],s34 offen
s_add_u32 s34,s34,4096
buffer_load_dwordx4 v[180:183],v7,s[8:11],s34 offen
s_add_u32 s34,s34,4096
buffer_load_dwordx4 v[184:187],v7,s[8:11],s34 offen
s_add_u32 s34,s34,4096
buffer_load_dwordx4 v[188:191],v7,s[8:11],s34 offen
s_xor_b32 s69,s69,524288
s_cmp_lt_u32 s54,2
s_cbranch_scc1 L_aa_72
s_sub_u32 s77,s54,2
s_mov_b32 s30,0
s_mov_b32 s86,1536
s_lshl_b32 s56,s77,5
s_add_u32 s56,s56,s68
s_mul_i32 s70,s56,24576
s_lshl_b32 s71,s56,12
s_lshl_b32 s59,s77,13
s_lshl2_add_u32 s59,s68,s59
s_add_u32 s59,s59,10485760
s_buffer_load_dword s32,s[8:11],s59
s_mov_b32 s33,1
s_add_u32 s70,s70,100663296
s_add_u32 s71,s71,41943040
v_mov_b32 v19,s59
s_branch L_aa_80
L_aa_86:
s_bitcmp1_b32 s46,0
s_cbranch_scc1 L_av_87
ds_read_b128 v[24:27],v4 offset:0
ds_read_b128 v[28:31],v4 offset:1024
s_min_u32 s56,s32,s33
s_cmp_lt_u32 s77,64
s_cselect_b32 s56,s56,0
s_cmp_eq_u32 s56,0
s_cselect_b32 s72,0x80000000,0
v_mov_b32 v248,s72
s_or_b32 s64,s70,s72
s_or_b32 s65,s71,s72
s_cmp_lt_u32 s30,s31
s_cselect_b32 s65,0x80000000,s65
s_and_b32 s57,s46,1
s_mul_i32 s58,s57,12288
s_add_u32 s64,s64,s58
s_lshl_b32 s57,s57,11
s_waitcnt lgkmcnt(1)
v_mfma_f32_16x16x32_bf16 v[160:163],v[24:27],a[0:3],0
ds_read_b128 v[32:35],v4 offset:2048
s_add_u32 s65,s65,s57
s_and_b32 s59,s50,2048
v_mfma_f32_16x16x32_bf16 v[164:167],v[24:27],a[4:7],0
ds_read_b128 v[36:39],v4 offset:3072
s_lshl_b32 s59,s59,4
s_xor_b32 s60,s67,65536
v_mfma_f32_16x16x32_bf16 v[168:171],v[24:27],a[8:11],0
ds_read_b128 v[40:43],v4 offset:8192
s_add_u32 s59,s59,s60
s_add_u32 s58,s58,s59
v_mfma_f32_16x16x32_bf16 v[172:175],v[24:27],a[12:15],0
ds_read_b128 v[44:47],v4 offset:9216
s_add_u32 s57,s57,s59
s_add_u32 m0,s58,0
v_mfma_f32_16x16x32_bf16 v[176:179],v[24:27],a[16:19],0
buffer_load_dwordx4 v0,s[8:11],s64 offen offset:0 sc1 lds
v_lshlrev_b32 v88,16,v224
v_and_b32 v89,0xffff0000,v224
v_mfma_f32_16x16x32_bf16 v[180:183],v[24:27],a[20:23],0
ds_read_b128 v[48:51],v4 offset:10240
v_lshlrev_b32 v90,16,v225
v_and_b32 v91,0xffff0000,v225
v_mfma_f32_16x16x32_bf16 v[184:187],v[24:27],a[24:27],0
ds_read_b128 v[52:55],v4 offset:11264
s_waitcnt vmcnt(8)
v_mfma_f32_16x16x32_bf16 v[128:131],v[156:159],v[192:195],0
ds_write_b32 v247,v248
v_lshlrev_b32 v92,16,v226
v_and_b32 v93,0xffff0000,v226
v_mfma_f32_16x16x32_bf16 v[188:191],v[24:27],a[28:31],0
ds_read_b128 v[56:59],v4 offset:4096
s_waitcnt vmcnt(7)
v_mfma_f32_16x16x32_bf16 v[128:131],v[156:159],v[196:199],v[128:131]
ds_read_b128 v[60:63],v4 offset:5120
v_lshlrev_b32 v94,16,v227
v_and_b32 v95,0xffff0000,v227
s_waitcnt lgkmcnt(9)
v_mfma_f32_16x16x32_bf16 v[160:163],v[28:31],a[32:35],v[160:163]
buffer_load_dwordx4 v0,s[8:11],s64 offen offset:1024 sc1 lds
s_waitcnt vmcnt(7)
v_mfma_f32_16x16x32_bf16 v[128:131],v[156:159],v[200:203],v[128:131]
ds_read_b128 v[64:67],v4 offset:6144
v_readfirstlane_b32 s22,v246
s_cmp_eq_u32 s22,0
s_cbranch_scc1 L_ag_88
L_agb_89:
v_mfma_f32_16x16x32_bf16 v[164:167],v[28:31],a[36:39],v[164:167]
ds_read_b128 v[68:71],v4 offset:7168
s_waitcnt vmcnt(6)
v_mfma_f32_16x16x32_bf16 v[128:131],v[156:159],v[204:207],v[128:131]
ds_read_b128 v[72:75],v4 offset:12288
s_lshl_b32 s18,s26,5
s_add_u32 s18,s18,s68
v_mfma_f32_16x16x32_bf16 v[168:171],v[28:31],a[40:43],v[168:171]
ds_read_b128 v[76:79],v4 offset:13312
s_waitcnt vmcnt(5)
v_mfma_f32_16x16x32_bf16 v[132:135],v[156:159],v[208:211],0
ds_read_b128 v[80:83],v4 offset:14336
s_lshl_b32 s19,s18,10
s_add_u32 s20,s19,6291456
v_mfma_f32_16x16x32_bf16 v[172:175],v[28:31],a[44:47],v[172:175]
ds_read_b128 v[84:87],v4 offset:15360
s_waitcnt vmcnt(4)
v_mfma_f32_16x16x32_bf16 v[132:135],v[156:159],v[212:215],v[132:135]
s_lshl_b32 s23,s51,5
s_add_u32 s23,s23,s68
s_lshl_b32 s24,s23,10
v_mfma_f32_16x16x32_bf16 v[176:179],v[28:31],a[48:51],v[176:179]
buffer_load_dwordx4 v0,s[8:11],s64 offen offset:2048 sc1 lds
s_waitcnt vmcnt(4)
v_mfma_f32_16x16x32_bf16 v[132:135],v[156:159],v[216:219],v[132:135]
s_lshl_b32 s25,s51,10
s_add_u32 s25,s25,2883584
s_cmp_eq_u32 s23,s55
s_cselect_b32 s25,s25,s24
v_mfma_f32_16x16x32_bf16 v[180:183],v[28:31],a[52:55],v[180:183]
ds_write_b128 v6,v[128:131]
s_waitcnt vmcnt(3)
v_mfma_f32_16x16x32_bf16 v[132:135],v[156:159],v[220:223],v[132:135]
s_add_u32 s25,s25,8388608
s_mov_b32 s6,268435456
s_cmp_eq_u32 s31,0
s_cselect_b32 s25,s24,s25
s_cselect_b64 s[4:5],s[16:17],s[44:45]
s_cmov_b32 s6,2097152
v_mfma_f32_16x16x32_bf16 v[184:187],v[28:31],a[56:59],v[184:187]
buffer_load_dwordx4 v[224:227],v0,s[4:7],s25 offen sc1
s_lshr_b32 s24,s55,5
s_cmp_lt_u32 s51,s24
s_cselect_b32 s24,1,2
v_mfma_f32_16x16x32_bf16 v[188:191],v[28:31],a[60:63],v[188:191]
v_mov_b32 v252,s24
s_lshl2_add_u32 s25,s51,11018240
s_waitcnt lgkmcnt(15)
v_mfma_f32_16x16x32_bf16 v[160:163],v[32:35],a[64:67],v[160:163]
ds_write_b128 v6,v[132:135] offset:2048
s_lshl_b32 s24,s68,16
s_add_u32 s24,s24,s31
v_mfma_f32_16x16x32_bf16 v[164:167],v[32:35],a[68:71],v[164:167]
buffer_load_dwordx4 v0,s[8:11],s64 offen offset:3072 sc1 lds
s_add_u32 s24,s24,s86
s_cmp_eq_u32 s24,1537
s_cselect_b32 s25,s25,0x80000000
v_mfma_f32_16x16x32_bf16 v[168:171],v[32:35],a[72:75],v[168:171]
buffer_store_dword v252,off,s[8:11],s25 sc1
s_bitcmp1_b64 s[38:39],s51
s_cselect_b32 s24,128,0
v_mfma_f32_16x16x32_bf16 v[172:175],v[32:35],a[76:79],v[172:175]
s_lshl_b32 s23,s51,13
s_lshl2_add_u32 s23,s68,s23
s_add_u32 s23,s23,10487168
v_mfma_f32_16x16x32_bf16 v[176:179],v[32:35],a[80:83],v[176:179]
s_waitcnt lgkmcnt(0)
s_barrier
s_add_u32 s23,s23,s24
v_mfma_f32_16x16x32_bf16 v[180:183],v[32:35],a[84:87],v[180:183]
ds_read_b128 v[96:99],v23
s_add_u32 m0,s58,4096
s_add_u32 s64,s64,4096
v_mfma_f32_16x16x32_bf16 v[184:187],v[32:35],a[88:91],v[184:187]
ds_read_b128 v[100:103],v23 offset:16
v_mfma_f32_16x16x32_bf16 v[188:191],v[32:35],a[92:95],v[188:191]
buffer_load_dwordx4 v0,s[8:11],s64 offen offset:0 sc1 lds
v_mfma_f32_16x16x32_bf16 v[160:163],v[36:39],a[96:99],v[160:163]
ds_read_b128 v[248:251],v245
v_mfma_f32_16x16x32_bf16 v[164:167],v[36:39],a[100:103],v[164:167]
buffer_load_dword v246,off,s[8:11],s23 sc1
v_lshrrev_b32 v244,4,v1
s_sub_u32 s23,s77,8
v_add_u32 v244,s23,v244
v_mfma_f32_16x16x32_bf16 v[168:171],v[36:39],a[104:107],v[168:171]
buffer_store_dword v20,off,s[8:11],s73 sc1
v_max_i32 v244,0,v244
v_lshl_add_u32 v244,v244,13,v21
s_mov_b32 s73,0x80000000
v_mfma_f32_16x16x32_bf16 v[172:175],v[36:39],a[108:111],v[172:175]
buffer_load_dwordx4 v0,s[8:11],s64 offen offset:1024 sc1 lds
v_mfma_f32_16x16x32_bf16 v[176:179],v[36:39],a[112:115],v[176:179]
buffer_load_dwordx2 v[242:243],v244,s[8:11],0 offen sc1
v_mfma_f32_16x16x32_bf16 v[180:183],v[36:39],a[116:119],v[180:183]
v_mfma_f32_16x16x32_bf16 v[184:187],v[36:39],a[120:123],v[184:187]
s_waitcnt lgkmcnt(0)
v_or3_b32 v248,v248,v249,v250
v_or_b32 v248,v248,v251
v_mfma_f32_16x16x32_bf16 v[188:191],v[36:39],a[124:127],v[188:191]
buffer_load_dwordx4 v0,s[8:11],s64 offen offset:2048 sc1 lds
v_readfirstlane_b32 s72,v248
s_waitcnt lgkmcnt(1)
v_cvt_pk_bf16_f32 v104,v96,v97
v_mfma_f32_16x16x32_bf16 v[160:163],v[40:43],a[128:131],v[160:163]
v_cvt_pk_bf16_f32 v105,v98,v99
v_cvt_pk_bf16_f32 v106,v100,v101
v_cvt_pk_bf16_f32 v107,v102,v103
v_mfma_f32_16x16x32_bf16 v[164:167],v[40:43],a[132:135],v[164:167]
v_lshlrev_b32 v96,16,v104
v_and_b32 v97,0xffff0000,v104
v_lshlrev_b32 v98,16,v105
v_mfma_f32_16x16x32_bf16 v[168:171],v[40:43],a[136:139],v[168:171]
v_and_b32 v99,0xffff0000,v105
v_lshlrev_b32 v100,16,v106
v_and_b32 v101,0xffff0000,v106
v_mfma_f32_16x16x32_bf16 v[172:175],v[40:43],a[140:143],v[172:175]
buffer_load_dwordx4 v0,s[8:11],s64 offen offset:3072 sc1 lds
v_lshlrev_b32 v102,16,v107
v_and_b32 v103,0xffff0000,v107
v_add_f32 v88,v88,v96
v_mfma_f32_16x16x32_bf16 v[176:179],v[40:43],a[144:147],v[176:179]
v_add_f32 v89,v89,v97
v_add_f32 v90,v90,v98
v_add_f32 v91,v91,v99
v_mfma_f32_16x16x32_bf16 v[180:183],v[40:43],a[148:151],v[180:183]
v_add_f32 v92,v92,v100
v_add_f32 v93,v93,v101
v_add_f32 v94,v94,v102
v_mfma_f32_16x16x32_bf16 v[184:187],v[40:43],a[152:155],v[184:187]
v_add_f32 v95,v95,v103
v_cvt_pk_bf16_f32 v104,v88,v89
v_cvt_pk_bf16_f32 v105,v90,v91
v_mfma_f32_16x16x32_bf16 v[188:191],v[40:43],a[156:159],v[188:191]
s_add_u32 m0,s58,8192
s_add_u32 s64,s64,4096
v_cvt_pk_bf16_f32 v106,v92,v93
v_cvt_pk_bf16_f32 v107,v94,v95
v_mfma_f32_16x16x32_bf16 v[160:163],v[44:47],a[160:163],v[160:163]
buffer_load_dwordx4 v0,s[8:11],s64 offen offset:0 sc1 lds
v_mfma_f32_16x16x32_bf16 v[164:167],v[44:47],a[164:167],v[164:167]
buffer_store_dwordx4 v[104:107],v0,s[8:11],s20 offen sc1
v_lshlrev_b32 v88,16,v104
v_and_b32 v89,0xffff0000,v104
v_lshlrev_b32 v90,16,v105
v_mfma_f32_16x16x32_bf16 v[168:171],v[44:47],a[168:171],v[168:171]
v_and_b32 v91,0xffff0000,v105
v_lshlrev_b32 v92,16,v106
v_and_b32 v93,0xffff0000,v106
v_mfma_f32_16x16x32_bf16 v[172:175],v[44:47],a[172:175],v[172:175]
v_lshlrev_b32 v94,16,v107
v_and_b32 v95,0xffff0000,v107
v_readfirstlane_b32 s78,v88
v_mfma_f32_16x16x32_bf16 v[176:179],v[44:47],a[176:179],v[176:179]
buffer_load_dwordx4 v0,s[8:11],s64 offen offset:1024 sc1 lds
v_add_f32 v120,v88,-s78
v_add_f32 v121,v89,-s78
v_add_f32 v122,v90,-s78
v_mfma_f32_16x16x32_bf16 v[180:183],v[44:47],a[180:183],v[180:183]
v_add_f32 v123,v91,-s78
v_add_f32 v124,v92,-s78
v_add_f32 v125,v93,-s78
v_mfma_f32_16x16x32_bf16 v[184:187],v[44:47],a[184:187],v[184:187]
v_add_f32 v126,v94,-s78
v_add_f32 v127,v95,-s78
v_add_f32 v128,v120,v122
v_mfma_f32_16x16x32_bf16 v[188:191],v[44:47],a[188:191],v[188:191]
v_add_f32 v129,v121,v123
v_mul_f32 v130,v120,v120
v_mul_f32 v131,v121,v121
v_mfma_f32_16x16x32_bf16 v[160:163],v[48:51],a[192:195],v[160:163]
buffer_load_dwordx4 v0,s[8:11],s64 offen offset:2048 sc1 lds
v_add_f32 v132,v124,v126
v_add_f32 v133,v125,v127
v_fma_f32 v130,v122,v122,v130
v_mfma_f32_16x16x32_bf16 v[164:167],v[48:51],a[196:199],v[164:167]
v_fma_f32 v131,v123,v123,v131
v_add_f32 v128,v128,v132
v_add_f32 v129,v129,v133
v_mfma_f32_16x16x32_bf16 v[168:171],v[48:51],a[200:203],v[168:171]
v_fma_f32 v130,v124,v124,v130
v_fma_f32 v131,v125,v125,v131
v_add_f32 v128,v128,v129
v_mfma_f32_16x16x32_bf16 v[172:175],v[48:51],a[204:207],v[172:175]
v_fma_f32 v130,v126,v126,v130
v_fma_f32 v131,v127,v127,v131
v_add_f32 v130,v130,v131
v_mfma_f32_16x16x32_bf16 v[176:179],v[48:51],a[208:211],v[176:179]
buffer_load_dwordx4 v0,s[8:11],s64 offen offset:3072 sc1 lds
v_permlane32_swap_b32 v128,v130
v_add_f32 v128,v128,v130
v_mfma_f32_16x16x32_bf16 v[180:183],v[48:51],a[212:215],v[180:183]
s_nop 0
v_add_f32_dpp v128,v128,v128 row_ror:8 row_mask:0xf bank_mask:0xf
v_mfma_f32_16x16x32_bf16 v[184:187],v[48:51],a[216:219],v[184:187]
s_nop 0
v_add_f32_dpp v128,v128,v128 row_ror:4 row_mask:0xf bank_mask:0xf
v_mfma_f32_16x16x32_bf16 v[188:191],v[48:51],a[220:223],v[188:191]
s_nop 0
v_add_f32_dpp v128,v128,v128 row_ror:2 row_mask:0xf bank_mask:0xf
v_mfma_f32_16x16x32_bf16 v[160:163],v[52:55],a[224:227],v[160:163]
s_add_u32 m0,s57,24576
v_add_f32_dpp v128,v128,v128 row_ror:1 row_mask:0xf bank_mask:0xf
v_mov_b32 v130,v128
v_mfma_f32_16x16x32_bf16 v[164:167],v[52:55],a[228:231],v[164:167]
buffer_load_dwordx4 v0,s[8:11],s65 offen offset:0 sc1 lds
v_permlane16_swap_b32 v128,v130
v_add_f32 v128,v128,v130
v_mul_f32 v128,0x3b000000,v128
v_mfma_f32_16x16x32_bf16 v[168:171],v[52:55],a[232:235],v[168:171]
v_mov_b32 v130,v128
v_mfma_f32_16x16x32_bf16 v[172:175],v[52:55],a[236:239],v[172:175]
s_nop 0
v_permlane32_swap_b32 v128,v130
v_fma_f32 v130,-v128,v128,v130
v_add_f32 v128,s78,v128
v_mfma_f32_16x16x32_bf16 v[176:179],v[52:55],a[240:243],v[176:179]
v_max_f32 v130,0,v130
v_cvt_pk_bf16_f32 v130,v128,v130
v_lshlrev_b32 v128,16,v130
v_mfma_f32_16x16x32_bf16 v[180:183],v[52:55],a[244:247],v[180:183]
buffer_load_dwordx4 v0,s[8:11],s65 offen offset:1024 sc1 lds
v_and_b32 v130,0xffff0000,v130
v_add_f32 v130,0x3727c5ac,v130
v_cvt_pk_bf16_f32 v130,v130,v130
v_mfma_f32_16x16x32_bf16 v[184:187],v[52:55],a[248:251],v[184:187]
v_and_b32 v130,0xffff0000,v130
v_sqrt_f32 v130,v130
v_add_f32 v120,v88,-v128
v_mfma_f32_16x16x32_bf16 v[188:191],v[52:55],a[252:255],v[188:191]
v_add_f32 v121,v89,-v128
v_add_f32 v122,v90,-v128
v_add_f32 v123,v91,-v128
v_mfma_f32_16x16x32_bf16 v[192:195],v[56:59],a[0:3],0
v_add_f32 v124,v92,-v128
v_add_f32 v125,v93,-v128
v_add_f32 v126,v94,-v128
v_mfma_f32_16x16x32_bf16 v[196:199],v[56:59],a[4:7],0
v_add_f32 v127,v95,-v128
v_cvt_pk_bf16_f32 v130,v130,v130
v_mfma_f32_16x16x32_bf16 v[200:203],v[56:59],a[8:11],0
v_and_b32 v130,0xffff0000,v130
v_rcp_f32 v130,v130
v_mfma_f32_16x16x32_bf16 v[204:207],v[56:59],a[12:15],0
v_cvt_pk_bf16_f32 v108,v120,v121
v_cvt_pk_bf16_f32 v109,v122,v123
v_mfma_f32_16x16x32_bf16 v[208:211],v[56:59],a[16:19],0
v_cvt_pk_bf16_f32 v110,v124,v125
v_cvt_pk_bf16_f32 v111,v126,v127
v_mfma_f32_16x16x32_bf16 v[212:215],v[56:59],a[20:23],0
v_lshlrev_b32 v120,16,v108
v_and_b32 v121,0xffff0000,v108
v_mfma_f32_16x16x32_bf16 v[216:219],v[56:59],a[24:27],0
v_lshlrev_b32 v122,16,v109
v_and_b32 v123,0xffff0000,v109
v_mfma_f32_16x16x32_bf16 v[220:223],v[56:59],a[28:31],0
v_lshlrev_b32 v124,16,v110
v_and_b32 v125,0xffff0000,v110
v_mfma_f32_16x16x32_bf16 v[192:195],v[60:63],a[32:35],v[192:195]
v_lshlrev_b32 v126,16,v111
v_and_b32 v127,0xffff0000,v111
v_mfma_f32_16x16x32_bf16 v[196:199],v[60:63],a[36:39],v[196:199]
v_mul_f32 v120,v120,v130
v_mul_f32 v121,v121,v130
v_mfma_f32_16x16x32_bf16 v[200:203],v[60:63],a[40:43],v[200:203]
v_mul_f32 v122,v122,v130
v_mul_f32 v123,v123,v130
v_mfma_f32_16x16x32_bf16 v[204:207],v[60:63],a[44:47],v[204:207]
v_mul_f32 v124,v124,v130
v_mul_f32 v125,v125,v130
v_mfma_f32_16x16x32_bf16 v[208:211],v[60:63],a[48:51],v[208:211]
v_mul_f32 v126,v126,v130
v_mul_f32 v127,v127,v130
v_mfma_f32_16x16x32_bf16 v[212:215],v[60:63],a[52:55],v[212:215]
v_cvt_pk_bf16_f32 v108,v120,v121
v_cvt_pk_bf16_f32 v109,v122,v123
v_mfma_f32_16x16x32_bf16 v[216:219],v[60:63],a[56:59],v[216:219]
v_cvt_pk_bf16_f32 v110,v124,v125
v_cvt_pk_bf16_f32 v111,v126,v127
v_mfma_f32_16x16x32_bf16 v[220:223],v[60:63],a[60:63],v[220:223]
v_lshlrev_b32 v112,16,v108
v_and_b32 v113,0xffff0000,v108
v_mfma_f32_16x16x32_bf16 v[192:195],v[64:67],a[64:67],v[192:195]
v_lshlrev_b32 v114,16,v109
v_and_b32 v115,0xffff0000,v109
v_mfma_f32_16x16x32_bf16 v[196:199],v[64:67],a[68:71],v[196:199]
v_lshlrev_b32 v116,16,v110
v_and_b32 v117,0xffff0000,v110
v_mfma_f32_16x16x32_bf16 v[200:203],v[64:67],a[72:75],v[200:203]
v_lshlrev_b32 v118,16,v111
v_and_b32 v119,0xffff0000,v111
v_mfma_f32_16x16x32_bf16 v[204:207],v[64:67],a[76:79],v[204:207]
v_add_f32 v88,v88,v112
v_add_f32 v89,v89,v113
v_mfma_f32_16x16x32_bf16 v[208:211],v[64:67],a[80:83],v[208:211]
v_cvt_pk_bf16_f32 v24,v160,v164
v_cvt_pk_bf16_f32 v25,v168,v172
v_mfma_f32_16x16x32_bf16 v[212:215],v[64:67],a[84:87],v[212:215]
v_cvt_pk_bf16_f32 v26,v176,v180
v_cvt_pk_bf16_f32 v27,v184,v188
v_mfma_f32_16x16x32_bf16 v[216:219],v[64:67],a[88:91],v[216:219]
v_cvt_pk_bf16_f32 v28,v161,v165
v_cvt_pk_bf16_f32 v29,v169,v173
v_mfma_f32_16x16x32_bf16 v[220:223],v[64:67],a[92:95],v[220:223]
v_cvt_pk_bf16_f32 v30,v177,v181
v_cvt_pk_bf16_f32 v31,v185,v189
v_mfma_f32_16x16x32_bf16 v[192:195],v[68:71],a[96:99],v[192:195]
v_cvt_pk_bf16_f32 v32,v162,v166
v_cvt_pk_bf16_f32 v33,v170,v174
v_mfma_f32_16x16x32_bf16 v[196:199],v[68:71],a[100:103],v[196:199]
v_cvt_pk_bf16_f32 v34,v178,v182
v_cvt_pk_bf16_f32 v35,v186,v190
v_mfma_f32_16x16x32_bf16 v[200:203],v[68:71],a[104:107],v[200:203]
v_cvt_pk_bf16_f32 v36,v163,v167
v_cvt_pk_bf16_f32 v37,v171,v175
v_mfma_f32_16x16x32_bf16 v[204:207],v[68:71],a[108:111],v[204:207]
v_cvt_pk_bf16_f32 v38,v179,v183
v_cvt_pk_bf16_f32 v39,v187,v191
v_mfma_f32_16x16x32_bf16 v[208:211],v[68:71],a[112:115],v[208:211]
s_add_u32 s62,s69,0
v_add_f32 v90,v90,v114
v_add_f32 v91,v91,v115
v_mfma_f32_16x16x32_bf16 v[212:215],v[68:71],a[116:119],v[212:215]
buffer_store_dwordx4 v[24:27],v5,s[8:11],s62 offen
v_add_f32 v92,v92,v116
v_add_f32 v93,v93,v117
v_mfma_f32_16x16x32_bf16 v[216:219],v[68:71],a[120:123],v[216:219]
v_add_f32 v94,v94,v118
v_add_f32 v95,v95,v119
v_mfma_f32_16x16x32_bf16 v[220:223],v[68:71],a[124:127],v[220:223]
v_cvt_pk_bf16_f32 v96,v88,v89
v_cvt_pk_bf16_f32 v97,v90,v91
v_mfma_f32_16x16x32_bf16 v[192:195],v[72:75],a[128:131],v[192:195]
s_add_u32 s62,s69,16384
v_cvt_pk_bf16_f32 v98,v92,v93
v_cvt_pk_bf16_f32 v99,v94,v95
v_mfma_f32_16x16x32_bf16 v[196:199],v[72:75],a[132:135],v[196:199]
buffer_store_dwordx4 v[28:31],v5,s[8:11],s62 offen
v_mfma_f32_16x16x32_bf16 v[200:203],v[72:75],a[136:139],v[200:203]
buffer_store_dwordx4 v[96:99],v0,s[12:15],s19 offen sc1
v_mul_f32 v236,v112,v228
v_mul_f32 v237,v113,v229
v_fma_f32 v236,v114,v230,v236
v_mfma_f32_16x16x32_bf16 v[204:207],v[72:75],a[140:143],v[204:207]
v_fma_f32 v237,v115,v231,v237
v_fma_f32 v236,v116,v232,v236
v_fma_f32 v237,v117,v233,v237
v_mfma_f32_16x16x32_bf16 v[208:211],v[72:75],a[144:147],v[208:211]
s_add_u32 s62,s69,32768
v_fma_f32 v236,v118,v234,v236
v_fma_f32 v237,v119,v235,v237
v_mfma_f32_16x16x32_bf16 v[212:215],v[72:75],a[148:151],v[212:215]
buffer_store_dwordx4 v[32:35],v5,s[8:11],s62 offen
v_add_f32 v236,v236,v237
v_mfma_f32_16x16x32_bf16 v[216:219],v[72:75],a[152:155],v[216:219]
s_nop 0
v_add_f32_dpp v236,v236,v236 row_ror:8 row_mask:0xf bank_mask:0xf
v_mfma_f32_16x16x32_bf16 v[220:223],v[72:75],a[156:159],v[220:223]
s_nop 0
v_add_f32_dpp v236,v236,v236 row_ror:4 row_mask:0xf bank_mask:0xf
v_mfma_f32_16x16x32_bf16 v[192:195],v[76:79],a[160:163],v[192:195]
s_add_u32 s62,s69,49152
v_add_f32_dpp v236,v236,v236 row_ror:2 row_mask:0xf bank_mask:0xf
v_mfma_f32_16x16x32_bf16 v[196:199],v[76:79],a[164:167],v[196:199]
buffer_store_dwordx4 v[36:39],v5,s[8:11],s62 offen
v_add_f32_dpp v236,v236,v236 row_ror:1 row_mask:0xf bank_mask:0xf
v_mov_b32 v237,v236
v_mfma_f32_16x16x32_bf16 v[200:203],v[76:79],a[168:171],v[200:203]
s_nop 0
v_permlane16_swap_b32 v236,v237
v_add_f32 v236,v236,v237
v_mov_b32 v237,v236
v_mfma_f32_16x16x32_bf16 v[204:207],v[76:79],a[172:175],v[204:207]
s_nop 0
v_permlane32_swap_b32 v236,v237
v_add_f32 v236,v236,v237
v_cvt_pk_bf16_f32 v236,v236,v236
v_mfma_f32_16x16x32_bf16 v[208:211],v[76:79],a[176:179],v[208:211]
v_and_b32 v236,0xffff0000,v236
v_ashrrev_i32 v237,31,v236
v_or_b32 v237,0x80000000,v237
v_mfma_f32_16x16x32_bf16 v[212:215],v[76:79],a[180:183],v[212:215]
v_xor_b32 v236,v236,v237
v_and_b32 v236,0xffff0000,v236
s_sub_u32 s20,4095,s18
v_mfma_f32_16x16x32_bf16 v[216:219],v[76:79],a[184:187],v[216:219]
v_or_b32 v20,s20,v236
s_lshl_b32 s73,s26,13
s_lshl2_add_u32 s73,s68,s73
v_mfma_f32_16x16x32_bf16 v[220:223],v[76:79],a[188:191],v[220:223]
s_add_u32 s73,s73,10485760
s_add_u32 s73,s73,s86
v_mfma_f32_16x16x32_bf16 v[192:195],v[80:83],a[192:195],v[192:195]
v_mfma_f32_16x16x32_bf16 v[196:199],v[80:83],a[196:199],v[196:199]
v_mfma_f32_16x16x32_bf16 v[192:195],v[84:87],a[224:227],v[192:195]
v_mfma_f32_16x16x32_bf16 v[196:199],v[84:87],a[228:231],v[196:199]
v_mfma_f32_16x16x32_bf16 v[200:203],v[80:83],a[200:203],v[200:203]
v_mfma_f32_16x16x32_bf16 v[204:207],v[80:83],a[204:207],v[204:207]
v_mfma_f32_16x16x32_bf16 v[200:203],v[84:87],a[232:235],v[200:203]
v_mfma_f32_16x16x32_bf16 v[204:207],v[84:87],a[236:239],v[204:207]
v_cvt_pk_bf16_f32 v40,v192,v196
v_cvt_pk_bf16_f32 v44,v193,v197
v_cvt_pk_bf16_f32 v48,v194,v198
v_mfma_f32_16x16x32_bf16 v[208:211],v[80:83],a[208:211],v[208:211]
v_cvt_pk_bf16_f32 v52,v195,v199
v_mfma_f32_16x16x32_bf16 v[212:215],v[80:83],a[212:215],v[212:215]
v_cvt_pk_bf16_f32 v41,v200,v204
v_cvt_pk_bf16_f32 v45,v201,v205
v_cvt_pk_bf16_f32 v49,v202,v206
v_mfma_f32_16x16x32_bf16 v[208:211],v[84:87],a[240:243],v[208:211]
v_cvt_pk_bf16_f32 v53,v203,v207
v_mfma_f32_16x16x32_bf16 v[212:215],v[84:87],a[244:247],v[212:215]
v_mfma_f32_16x16x32_bf16 v[216:219],v[80:83],a[216:219],v[216:219]
v_mfma_f32_16x16x32_bf16 v[220:223],v[80:83],a[220:223],v[220:223]
v_mfma_f32_16x16x32_bf16 v[216:219],v[84:87],a[248:251],v[216:219]
v_mfma_f32_16x16x32_bf16 v[220:223],v[84:87],a[252:255],v[220:223]
v_cvt_pk_bf16_f32 v42,v208,v212
v_cvt_pk_bf16_f32 v46,v209,v213
v_cvt_pk_bf16_f32 v50,v210,v214
v_cvt_pk_bf16_f32 v54,v211,v215
s_nop 3
v_cvt_pk_bf16_f32 v43,v216,v220
s_add_u32 s62,s69,262144
buffer_store_dwordx4 v[40:43],v5,s[8:11],s62 offen
v_cvt_pk_bf16_f32 v47,v217,v221
s_add_u32 s62,s69,278528
buffer_store_dwordx4 v[44:47],v5,s[8:11],s62 offen
v_cvt_pk_bf16_f32 v51,v218,v222
s_add_u32 s62,s69,294912
buffer_store_dwordx4 v[48:51],v5,s[8:11],s62 offen
v_cvt_pk_bf16_f32 v55,v219,v223
s_add_u32 s62,s69,311296
buffer_store_dwordx4 v[52:55],v5,s[8:11],s62 offen
s_cmp_lg_u32 s72,0
s_cbranch_scc1 L_aa_75
s_waitcnt vmcnt(9)
s_branch L_aa_85
L_av_87:
ds_read_b128 v[24:27],v4 offset:0
ds_read_b128 v[28:31],v4 offset:1024
s_min_u32 s56,s32,s33
s_cmp_lt_u32 s77,64
s_cselect_b32 s56,s56,0
s_cmp_eq_u32 s56,0
s_cselect_b32 s72,0x80000000,0
v_mov_b32 v248,s72
s_or_b32 s64,s70,s72
s_or_b32 s65,s71,s72
s_cmp_lt_u32 s30,s31
s_cselect_b32 s65,0x80000000,s65
s_and_b32 s57,s46,1
s_mul_i32 s58,s57,12288
s_add_u32 s64,s64,s58
s_lshl_b32 s57,s57,11
s_waitcnt lgkmcnt(1)
v_mfma_f32_16x16x32_bf16 v[160:163],v[24:27],a[0:3],0
ds_read_b128 v[32:35],v4 offset:2048
s_add_u32 s65,s65,s57
s_and_b32 s59,s50,2048
v_mfma_f32_16x16x32_bf16 v[164:167],v[24:27],a[4:7],0
ds_read_b128 v[36:39],v4 offset:3072
s_lshl_b32 s59,s59,4
s_xor_b32 s60,s67,65536
v_mfma_f32_16x16x32_bf16 v[168:171],v[24:27],a[8:11],0
ds_read_b128 v[40:43],v4 offset:8192
s_add_u32 s59,s59,s60
s_add_u32 s58,s58,s59
v_mfma_f32_16x16x32_bf16 v[172:175],v[24:27],a[12:15],0
ds_read_b128 v[44:47],v4 offset:9216
s_add_u32 s57,s57,s59
s_add_u32 m0,s58,0
v_mfma_f32_16x16x32_bf16 v[176:179],v[24:27],a[16:19],0
buffer_load_dwordx4 v0,s[8:11],s64 offen offset:0 sc1 lds
s_lshl_b32 s23,s51,5
s_add_u32 s23,s23,s68
v_mfma_f32_16x16x32_bf16 v[180:183],v[24:27],a[20:23],0
ds_read_b128 v[48:51],v4 offset:10240
s_lshl_b32 s24,s23,10
s_lshl_b32 s25,s51,10
v_mfma_f32_16x16x32_bf16 v[184:187],v[24:27],a[24:27],0
ds_read_b128 v[52:55],v4 offset:11264
s_waitcnt vmcnt(8)
v_mfma_f32_16x16x32_bf16 v[128:131],v[156:159],v[192:195],0
ds_write_b32 v247,v248
s_add_u32 s25,s25,2883584
s_cmp_eq_u32 s23,s55
s_cselect_b32 s25,s25,s24
v_mfma_f32_16x16x32_bf16 v[188:191],v[24:27],a[28:31],0
ds_read_b128 v[56:59],v4 offset:4096
s_waitcnt vmcnt(7)
v_mfma_f32_16x16x32_bf16 v[128:131],v[156:159],v[196:199],v[128:131]
ds_read_b128 v[60:63],v4 offset:5120
s_add_u32 s25,s25,8388608
s_mov_b32 s6,268435456
s_waitcnt lgkmcnt(9)
v_mfma_f32_16x16x32_bf16 v[160:163],v[28:31],a[32:35],v[160:163]
buffer_load_dwordx4 v0,s[8:11],s64 offen offset:1024 sc1 lds
s_waitcnt vmcnt(7)
v_mfma_f32_16x16x32_bf16 v[128:131],v[156:159],v[200:203],v[128:131]
ds_read_b128 v[64:67],v4 offset:6144
s_cmp_eq_u32 s31,0
s_cselect_b32 s25,s24,s25
s_cselect_b64 s[4:5],s[16:17],s[44:45]
s_cmov_b32 s6,2097152
v_mfma_f32_16x16x32_bf16 v[164:167],v[28:31],a[36:39],v[164:167]
ds_read_b128 v[68:71],v4 offset:7168
s_waitcnt vmcnt(6)
v_mfma_f32_16x16x32_bf16 v[128:131],v[156:159],v[204:207],v[128:131]
ds_read_b128 v[72:75],v4 offset:12288
v_mfma_f32_16x16x32_bf16 v[168:171],v[28:31],a[40:43],v[168:171]
ds_read_b128 v[76:79],v4 offset:13312
s_waitcnt vmcnt(5)
v_mfma_f32_16x16x32_bf16 v[132:135],v[156:159],v[208:211],0
ds_read_b128 v[80:83],v4 offset:14336
v_mfma_f32_16x16x32_bf16 v[172:175],v[28:31],a[44:47],v[172:175]
ds_read_b128 v[84:87],v4 offset:15360
s_waitcnt vmcnt(4)
v_mfma_f32_16x16x32_bf16 v[132:135],v[156:159],v[212:215],v[132:135]
buffer_load_dwordx4 v[224:227],v0,s[4:7],s25 offen sc1
s_lshr_b32 s24,s55,5
s_cmp_lt_u32 s51,s24
s_cselect_b32 s24,1,2
v_mfma_f32_16x16x32_bf16 v[176:179],v[28:31],a[48:51],v[176:179]
buffer_load_dwordx4 v0,s[8:11],s64 offen offset:2048 sc1 lds
s_waitcnt vmcnt(5)
v_mfma_f32_16x16x32_bf16 v[132:135],v[156:159],v[216:219],v[132:135]
v_mov_b32 v252,s24
s_lshl2_add_u32 s25,s51,11018240
v_mfma_f32_16x16x32_bf16 v[180:183],v[28:31],a[52:55],v[180:183]
ds_write_b128 v6,v[128:131]
s_waitcnt vmcnt(4)
v_mfma_f32_16x16x32_bf16 v[132:135],v[156:159],v[220:223],v[132:135]
s_lshl_b32 s24,s68,16
s_add_u32 s24,s24,s31
s_add_u32 s24,s24,s86
v_mfma_f32_16x16x32_bf16 v[184:187],v[28:31],a[56:59],v[184:187]
s_cmp_eq_u32 s24,1537
s_cselect_b32 s25,s25,0x80000000
v_mfma_f32_16x16x32_bf16 v[188:191],v[28:31],a[60:63],v[188:191]
buffer_store_dword v252,off,s[8:11],s25 sc1
s_bitcmp1_b64 s[38:39],s51
s_cselect_b32 s24,128,0
s_waitcnt lgkmcnt(15)
v_mfma_f32_16x16x32_bf16 v[160:163],v[32:35],a[64:67],v[160:163]
ds_write_b128 v6,v[132:135] offset:2048
s_lshl_b32 s23,s51,13
s_lshl2_add_u32 s23,s68,s23
v_mfma_f32_16x16x32_bf16 v[164:167],v[32:35],a[68:71],v[164:167]
buffer_load_dwordx4 v0,s[8:11],s64 offen offset:3072 sc1 lds
s_add_u32 s23,s23,10487168
s_add_u32 s23,s23,s24
v_mfma_f32_16x16x32_bf16 v[168:171],v[32:35],a[72:75],v[168:171]
buffer_load_dword v246,off,s[8:11],s23 sc1
v_lshrrev_b32 v244,4,v1
s_sub_u32 s23,s77,8
v_mfma_f32_16x16x32_bf16 v[172:175],v[32:35],a[76:79],v[172:175]
v_add_u32 v244,s23,v244
v_max_i32 v244,0,v244
v_mfma_f32_16x16x32_bf16 v[176:179],v[32:35],a[80:83],v[176:179]
s_waitcnt lgkmcnt(0)
s_barrier
v_lshl_add_u32 v244,v244,13,v21
v_mfma_f32_16x16x32_bf16 v[180:183],v[32:35],a[84:87],v[180:183]
ds_read_b128 v[248:251],v245
s_add_u32 m0,s58,4096
s_add_u32 s64,s64,4096
v_mfma_f32_16x16x32_bf16 v[184:187],v[32:35],a[88:91],v[184:187]
buffer_load_dwordx4 v0,s[8:11],s64 offen offset:0 sc1 lds
v_mfma_f32_16x16x32_bf16 v[188:191],v[32:35],a[92:95],v[188:191]
buffer_load_dwordx2 v[242:243],v244,s[8:11],0 offen sc1
v_mfma_f32_16x16x32_bf16 v[160:163],v[36:39],a[96:99],v[160:163]
buffer_store_dword v20,off,s[8:11],s73 sc1
s_mov_b32 s73,0x80000000
v_mfma_f32_16x16x32_bf16 v[164:167],v[36:39],a[100:103],v[164:167]
v_mfma_f32_16x16x32_bf16 v[168:171],v[36:39],a[104:107],v[168:171]
buffer_load_dwordx4 v0,s[8:11],s64 offen offset:1024 sc1 lds
v_mfma_f32_16x16x32_bf16 v[172:175],v[36:39],a[108:111],v[172:175]
v_mfma_f32_16x16x32_bf16 v[176:179],v[36:39],a[112:115],v[176:179]
s_waitcnt lgkmcnt(0)
v_or3_b32 v248,v248,v249,v250
v_or_b32 v248,v248,v251
v_mfma_f32_16x16x32_bf16 v[180:183],v[36:39],a[116:119],v[180:183]
v_mfma_f32_16x16x32_bf16 v[184:187],v[36:39],a[120:123],v[184:187]
buffer_load_dwordx4 v0,s[8:11],s64 offen offset:2048 sc1 lds
v_readfirstlane_b32 s72,v248
v_mfma_f32_16x16x32_bf16 v[188:191],v[36:39],a[124:127],v[188:191]
v_mfma_f32_16x16x32_bf16 v[160:163],v[40:43],a[128:131],v[160:163]
v_mfma_f32_16x16x32_bf16 v[164:167],v[40:43],a[132:135],v[164:167]
v_mfma_f32_16x16x32_bf16 v[168:171],v[40:43],a[136:139],v[168:171]
buffer_load_dwordx4 v0,s[8:11],s64 offen offset:3072 sc1 lds
v_mfma_f32_16x16x32_bf16 v[172:175],v[40:43],a[140:143],v[172:175]
v_mfma_f32_16x16x32_bf16 v[176:179],v[40:43],a[144:147],v[176:179]
v_mfma_f32_16x16x32_bf16 v[180:183],v[40:43],a[148:151],v[180:183]
v_mfma_f32_16x16x32_bf16 v[184:187],v[40:43],a[152:155],v[184:187]
s_add_u32 m0,s58,8192
s_add_u32 s64,s64,4096
v_mfma_f32_16x16x32_bf16 v[188:191],v[40:43],a[156:159],v[188:191]
buffer_load_dwordx4 v0,s[8:11],s64 offen offset:0 sc1 lds
v_mfma_f32_16x16x32_bf16 v[160:163],v[44:47],a[160:163],v[160:163]
v_mfma_f32_16x16x32_bf16 v[164:167],v[44:47],a[164:167],v[164:167]
v_mfma_f32_16x16x32_bf16 v[168:171],v[44:47],a[168:171],v[168:171]
v_mfma_f32_16x16x32_bf16 v[172:175],v[44:47],a[172:175],v[172:175]
buffer_load_dwordx4 v0,s[8:11],s64 offen offset:1024 sc1 lds
v_mfma_f32_16x16x32_bf16 v[176:179],v[44:47],a[176:179],v[176:179]
v_mfma_f32_16x16x32_bf16 v[180:183],v[44:47],a[180:183],v[180:183]
v_mfma_f32_16x16x32_bf16 v[184:187],v[44:47],a[184:187],v[184:187]
v_mfma_f32_16x16x32_bf16 v[188:191],v[44:47],a[188:191],v[188:191]
buffer_load_dwordx4 v0,s[8:11],s64 offen offset:2048 sc1 lds
v_mfma_f32_16x16x32_bf16 v[160:163],v[48:51],a[192:195],v[160:163]
v_mfma_f32_16x16x32_bf16 v[164:167],v[48:51],a[196:199],v[164:167]
v_mfma_f32_16x16x32_bf16 v[168:171],v[48:51],a[200:203],v[168:171]
v_mfma_f32_16x16x32_bf16 v[172:175],v[48:51],a[204:207],v[172:175]
buffer_load_dwordx4 v0,s[8:11],s64 offen offset:3072 sc1 lds
v_mfma_f32_16x16x32_bf16 v[176:179],v[48:51],a[208:211],v[176:179]
v_mfma_f32_16x16x32_bf16 v[180:183],v[48:51],a[212:215],v[180:183]
v_mfma_f32_16x16x32_bf16 v[184:187],v[48:51],a[216:219],v[184:187]
v_mfma_f32_16x16x32_bf16 v[188:191],v[48:51],a[220:223],v[188:191]
s_add_u32 m0,s57,24576
v_mfma_f32_16x16x32_bf16 v[160:163],v[52:55],a[224:227],v[160:163]
buffer_load_dwordx4 v0,s[8:11],s65 offen offset:0 sc1 lds
v_mfma_f32_16x16x32_bf16 v[164:167],v[52:55],a[228:231],v[164:167]
v_mfma_f32_16x16x32_bf16 v[168:171],v[52:55],a[232:235],v[168:171]
v_mfma_f32_16x16x32_bf16 v[172:175],v[52:55],a[236:239],v[172:175]
v_mfma_f32_16x16x32_bf16 v[176:179],v[52:55],a[240:243],v[176:179]
buffer_load_dwordx4 v0,s[8:11],s65 offen offset:1024 sc1 lds
v_mfma_f32_16x16x32_bf16 v[180:183],v[52:55],a[244:247],v[180:183]
v_mfma_f32_16x16x32_bf16 v[184:187],v[52:55],a[248:251],v[184:187]
v_mfma_f32_16x16x32_bf16 v[188:191],v[52:55],a[252:255],v[188:191]
v_mfma_f32_16x16x32_bf16 v[192:195],v[56:59],a[0:3],0
v_mfma_f32_16x16x32_bf16 v[196:199],v[56:59],a[4:7],0
v_mfma_f32_16x16x32_bf16 v[200:203],v[56:59],a[8:11],0
v_cvt_pk_bf16_f32 v24,v160,v164
v_cvt_pk_bf16_f32 v25,v168,v172
v_mfma_f32_16x16x32_bf16 v[204:207],v[56:59],a[12:15],0
v_cvt_pk_bf16_f32 v26,v176,v180
v_cvt_pk_bf16_f32 v27,v184,v188
v_mfma_f32_16x16x32_bf16 v[208:211],v[56:59],a[16:19],0
v_cvt_pk_bf16_f32 v28,v161,v165
v_cvt_pk_bf16_f32 v29,v169,v173
v_mfma_f32_16x16x32_bf16 v[212:215],v[56:59],a[20:23],0
v_cvt_pk_bf16_f32 v30,v177,v181
v_cvt_pk_bf16_f32 v31,v185,v189
v_mfma_f32_16x16x32_bf16 v[216:219],v[56:59],a[24:27],0
v_cvt_pk_bf16_f32 v32,v162,v166
v_cvt_pk_bf16_f32 v33,v170,v174
v_mfma_f32_16x16x32_bf16 v[220:223],v[56:59],a[28:31],0
v_cvt_pk_bf16_f32 v34,v178,v182
v_cvt_pk_bf16_f32 v35,v186,v190
v_mfma_f32_16x16x32_bf16 v[192:195],v[60:63],a[32:35],v[192:195]
v_cvt_pk_bf16_f32 v36,v163,v167
v_cvt_pk_bf16_f32 v37,v171,v175
v_mfma_f32_16x16x32_bf16 v[196:199],v[60:63],a[36:39],v[196:199]
v_cvt_pk_bf16_f32 v38,v179,v183
v_cvt_pk_bf16_f32 v39,v187,v191
v_mfma_f32_16x16x32_bf16 v[200:203],v[60:63],a[40:43],v[200:203]
v_mfma_f32_16x16x32_bf16 v[204:207],v[60:63],a[44:47],v[204:207]
v_mfma_f32_16x16x32_bf16 v[208:211],v[60:63],a[48:51],v[208:211]
v_mfma_f32_16x16x32_bf16 v[212:215],v[60:63],a[52:55],v[212:215]
v_mfma_f32_16x16x32_bf16 v[216:219],v[60:63],a[56:59],v[216:219]
v_mfma_f32_16x16x32_bf16 v[220:223],v[60:63],a[60:63],v[220:223]
v_mfma_f32_16x16x32_bf16 v[192:195],v[64:67],a[64:67],v[192:195]
v_mfma_f32_16x16x32_bf16 v[196:199],v[64:67],a[68:71],v[196:199]
v_mfma_f32_16x16x32_bf16 v[200:203],v[64:67],a[72:75],v[200:203]
v_mfma_f32_16x16x32_bf16 v[204:207],v[64:67],a[76:79],v[204:207]
v_mfma_f32_16x16x32_bf16 v[208:211],v[64:67],a[80:83],v[208:211]
v_mfma_f32_16x16x32_bf16 v[212:215],v[64:67],a[84:87],v[212:215]
v_mfma_f32_16x16x32_bf16 v[216:219],v[64:67],a[88:91],v[216:219]
v_mfma_f32_16x16x32_bf16 v[220:223],v[64:67],a[92:95],v[220:223]
v_mfma_f32_16x16x32_bf16 v[192:195],v[68:71],a[96:99],v[192:195]
v_mfma_f32_16x16x32_bf16 v[196:199],v[68:71],a[100:103],v[196:199]
v_mfma_f32_16x16x32_bf16 v[200:203],v[68:71],a[104:107],v[200:203]
v_mfma_f32_16x16x32_bf16 v[204:207],v[68:71],a[108:111],v[204:207]
v_mfma_f32_16x16x32_bf16 v[208:211],v[68:71],a[112:115],v[208:211]
s_add_u32 s62,s69,0
v_mfma_f32_16x16x32_bf16 v[212:215],v[68:71],a[116:119],v[212:215]
buffer_store_dwordx4 v[24:27],v5,s[8:11],s62 offen
v_mfma_f32_16x16x32_bf16 v[216:219],v[68:71],a[120:123],v[216:219]
v_mfma_f32_16x16x32_bf16 v[220:223],v[68:71],a[124:127],v[220:223]
v_mfma_f32_16x16x32_bf16 v[192:195],v[72:75],a[128:131],v[192:195]
s_add_u32 s62,s69,16384
v_mfma_f32_16x16x32_bf16 v[196:199],v[72:75],a[132:135],v[196:199]
buffer_store_dwordx4 v[28:31],v5,s[8:11],s62 offen
v_mfma_f32_16x16x32_bf16 v[200:203],v[72:75],a[136:139],v[200:203]
v_mfma_f32_16x16x32_bf16 v[204:207],v[72:75],a[140:143],v[204:207]
v_mfma_f32_16x16x32_bf16 v[208:211],v[72:75],a[144:147],v[208:211]
s_add_u32 s62,s69,32768
v_mfma_f32_16x16x32_bf16 v[212:215],v[72:75],a[148:151],v[212:215]
buffer_store_dwordx4 v[32:35],v5,s[8:11],s62 offen
v_mfma_f32_16x16x32_bf16 v[216:219],v[72:75],a[152:155],v[216:219]
v_mfma_f32_16x16x32_bf16 v[220:223],v[72:75],a[156:159],v[220:223]
v_mfma_f32_16x16x32_bf16 v[192:195],v[76:79],a[160:163],v[192:195]
s_add_u32 s62,s69,49152
v_mfma_f32_16x16x32_bf16 v[196:199],v[76:79],a[164:167],v[196:199]
buffer_store_dwordx4 v[36:39],v5,s[8:11],s62 offen
v_mfma_f32_16x16x32_bf16 v[200:203],v[76:79],a[168:171],v[200:203]
v_mfma_f32_16x16x32_bf16 v[204:207],v[76:79],a[172:175],v[204:207]
v_mfma_f32_16x16x32_bf16 v[208:211],v[76:79],a[176:179],v[208:211]
v_mfma_f32_16x16x32_bf16 v[212:215],v[76:79],a[180:183],v[212:215]
v_mfma_f32_16x16x32_bf16 v[216:219],v[76:79],a[184:187],v[216:219]
v_mfma_f32_16x16x32_bf16 v[220:223],v[76:79],a[188:191],v[220:223]
v_mfma_f32_16x16x32_bf16 v[192:195],v[80:83],a[192:195],v[192:195]
v_mfma_f32_16x16x32_bf16 v[196:199],v[80:83],a[196:199],v[196:199]
v_mfma_f32_16x16x32_bf16 v[192:195],v[84:87],a[224:227],v[192:195]
v_mfma_f32_16x16x32_bf16 v[196:199],v[84:87],a[228:231],v[196:199]
v_mfma_f32_16x16x32_bf16 v[200:203],v[80:83],a[200:203],v[200:203]
v_mfma_f32_16x16x32_bf16 v[204:207],v[80:83],a[204:207],v[204:207]
v_mfma_f32_16x16x32_bf16 v[200:203],v[84:87],a[232:235],v[200:203]
v_mfma_f32_16x16x32_bf16 v[204:207],v[84:87],a[236:239],v[204:207]
v_cvt_pk_bf16_f32 v40,v192,v196
v_cvt_pk_bf16_f32 v44,v193,v197
v_cvt_pk_bf16_f32 v48,v194,v198
v_mfma_f32_16x16x32_bf16 v[208:211],v[80:83],a[208:211],v[208:211]
v_cvt_pk_bf16_f32 v52,v195,v199
v_mfma_f32_16x16x32_bf16 v[212:215],v[80:83],a[212:215],v[212:215]
v_cvt_pk_bf16_f32 v41,v200,v204
v_cvt_pk_bf16_f32 v45,v201,v205
v_cvt_pk_bf16_f32 v49,v202,v206
v_mfma_f32_16x16x32_bf16 v[208:211],v[84:87],a[240:243],v[208:211]
v_cvt_pk_bf16_f32 v53,v203,v207
v_mfma_f32_16x16x32_bf16 v[212:215],v[84:87],a[244:247],v[212:215]
v_mfma_f32_16x16x32_bf16 v[216:219],v[80:83],a[216:219],v[216:219]
v_mfma_f32_16x16x32_bf16 v[220:223],v[80:83],a[220:223],v[220:223]
v_mfma_f32_16x16x32_bf16 v[216:219],v[84:87],a[248:251],v[216:219]
v_mfma_f32_16x16x32_bf16 v[220:223],v[84:87],a[252:255],v[220:223]
v_cvt_pk_bf16_f32 v42,v208,v212
v_cvt_pk_bf16_f32 v46,v209,v213
v_cvt_pk_bf16_f32 v50,v210,v214
v_cvt_pk_bf16_f32 v54,v211,v215
s_nop 3
v_cvt_pk_bf16_f32 v43,v216,v220
s_add_u32 s62,s69,262144
buffer_store_dwordx4 v[40:43],v5,s[8:11],s62 offen
v_cvt_pk_bf16_f32 v47,v217,v221
s_add_u32 s62,s69,278528
buffer_store_dwordx4 v[44:47],v5,s[8:11],s62 offen
v_cvt_pk_bf16_f32 v51,v218,v222
s_add_u32 s62,s69,294912
buffer_store_dwordx4 v[48:51],v5,s[8:11],s62 offen
v_cvt_pk_bf16_f32 v55,v219,v223
s_add_u32 s62,s69,311296
buffer_store_dwordx4 v[52:55],v5,s[8:11],s62 offen
s_cmp_lg_u32 s72,0
s_cbranch_scc1 L_aa_75
s_waitcnt vmcnt(8)
s_branch L_aa_85
L_aa_73:
ds_read_b128 v[24:27],v4 offset:0
ds_read_b128 v[28:31],v4 offset:1024
s_min_u32 s56,s32,s33
s_cmp_lt_u32 s77,64
s_cselect_b32 s56,s56,0
s_cmp_eq_u32 s56,0
s_cselect_b32 s72,0x80000000,0
v_mov_b32 v248,s72
s_or_b32 s64,s70,s72
s_or_b32 s65,s71,s72
s_cmp_lt_u32 s30,s31
s_cselect_b32 s65,0x80000000,s65
s_and_b32 s57,s46,1
s_mul_i32 s58,s57,12288
s_add_u32 s64,s64,s58
s_lshl_b32 s57,s57,11
s_waitcnt lgkmcnt(1)
v_mfma_f32_16x16x32_bf16 v[160:163],v[24:27],a[0:3],0
ds_read_b128 v[32:35],v4 offset:2048
s_add_u32 s65,s65,s57
s_and_b32 s59,s50,2048
v_mfma_f32_16x16x32_bf16 v[164:167],v[24:27],a[4:7],0
ds_read_b128 v[36:39],v4 offset:3072
s_lshl_b32 s59,s59,4
s_xor_b32 s60,s67,65536
v_mfma_f32_16x16x32_bf16 v[168:171],v[24:27],a[8:11],0
ds_read_b128 v[40:43],v4 offset:8192
s_add_u32 s59,s59,s60
s_add_u32 s58,s58,s59
v_mfma_f32_16x16x32_bf16 v[172:175],v[24:27],a[12:15],0
ds_read_b128 v[44:47],v4 offset:9216
s_add_u32 s57,s57,s59
s_add_u32 m0,s58,0
v_mfma_f32_16x16x32_bf16 v[176:179],v[24:27],a[16:19],0
buffer_load_dwordx4 v0,s[8:11],s64 offen offset:0 sc1 lds
s_lshl_b32 s23,s51,5
s_add_u32 s23,s23,s68
v_mfma_f32_16x16x32_bf16 v[180:183],v[24:27],a[20:23],0
ds_read_b128 v[48:51],v4 offset:10240
s_lshl_b32 s24,s23,10
s_lshl_b32 s25,s51,10
v_mfma_f32_16x16x32_bf16 v[184:187],v[24:27],a[24:27],0
ds_read_b128 v[52:55],v4 offset:11264
s_add_u32 s25,s25,2883584
s_cmp_eq_u32 s23,s55
s_cselect_b32 s25,s25,s24
v_mfma_f32_16x16x32_bf16 v[188:191],v[24:27],a[28:31],0
ds_write_b32 v247,v248
s_add_u32 s25,s25,8388608
s_mov_b32 s6,268435456
s_waitcnt lgkmcnt(7)
v_mfma_f32_16x16x32_bf16 v[160:163],v[28:31],a[32:35],v[160:163]
buffer_load_dwordx4 v0,s[8:11],s64 offen offset:1024 sc1 lds
s_cmp_eq_u32 s31,0
s_cselect_b32 s25,s24,s25
s_cselect_b64 s[4:5],s[16:17],s[44:45]
s_cmov_b32 s6,2097152
v_mfma_f32_16x16x32_bf16 v[164:167],v[28:31],a[36:39],v[164:167]
ds_read_b128 v[56:59],v4 offset:4096
v_mfma_f32_16x16x32_bf16 v[168:171],v[28:31],a[40:43],v[168:171]
ds_read_b128 v[60:63],v4 offset:5120
v_mfma_f32_16x16x32_bf16 v[172:175],v[28:31],a[44:47],v[172:175]
ds_read_b128 v[64:67],v4 offset:6144
v_mfma_f32_16x16x32_bf16 v[176:179],v[28:31],a[48:51],v[176:179]
buffer_load_dwordx4 v0,s[8:11],s64 offen offset:2048 sc1 lds
v_mfma_f32_16x16x32_bf16 v[180:183],v[28:31],a[52:55],v[180:183]
ds_read_b128 v[68:71],v4 offset:7168
v_mfma_f32_16x16x32_bf16 v[184:187],v[28:31],a[56:59],v[184:187]
ds_read_b128 v[72:75],v4 offset:12288
v_mfma_f32_16x16x32_bf16 v[188:191],v[28:31],a[60:63],v[188:191]
ds_read_b128 v[76:79],v4 offset:13312
s_waitcnt lgkmcnt(12)
v_mfma_f32_16x16x32_bf16 v[160:163],v[32:35],a[64:67],v[160:163]
buffer_load_dwordx4 v0,s[8:11],s64 offen offset:3072 sc1 lds
v_mfma_f32_16x16x32_bf16 v[164:167],v[32:35],a[68:71],v[164:167]
ds_read_b128 v[80:83],v4 offset:14336
v_mfma_f32_16x16x32_bf16 v[168:171],v[32:35],a[72:75],v[168:171]
ds_read_b128 v[84:87],v4 offset:15360
v_mfma_f32_16x16x32_bf16 v[172:175],v[32:35],a[76:79],v[172:175]
buffer_load_dwordx4 v[224:227],v0,s[4:7],s25 offen sc1
s_lshr_b32 s24,s55,5
s_cmp_lt_u32 s51,s24
s_cselect_b32 s24,1,2
v_mfma_f32_16x16x32_bf16 v[176:179],v[32:35],a[80:83],v[176:179]
s_add_u32 m0,s58,4096
s_add_u32 s64,s64,4096
v_mov_b32 v252,s24
v_mfma_f32_16x16x32_bf16 v[180:183],v[32:35],a[84:87],v[180:183]
buffer_load_dwordx4 v0,s[8:11],s64 offen offset:0 sc1 lds
s_lshl2_add_u32 s25,s51,11018240
s_lshl_b32 s24,s68,16
v_mfma_f32_16x16x32_bf16 v[184:187],v[32:35],a[88:91],v[184:187]
s_add_u32 s24,s24,s31
s_add_u32 s24,s24,s86
s_cmp_eq_u32 s24,1537
s_cselect_b32 s25,s25,0x80000000
v_mfma_f32_16x16x32_bf16 v[188:191],v[32:35],a[92:95],v[188:191]
buffer_store_dword v252,off,s[8:11],s25 sc1
s_waitcnt lgkmcnt(0)
s_barrier
s_waitcnt lgkmcnt(13)
v_mfma_f32_16x16x32_bf16 v[160:163],v[36:39],a[96:99],v[160:163]
ds_read_b128 v[248:251],v245
s_bitcmp1_b64 s[38:39],s51
s_cselect_b32 s24,128,0
v_mfma_f32_16x16x32_bf16 v[164:167],v[36:39],a[100:103],v[164:167]
buffer_load_dwordx4 v0,s[8:11],s64 offen offset:1024 sc1 lds
s_lshl_b32 s23,s51,13
s_lshl2_add_u32 s23,s68,s23
v_mfma_f32_16x16x32_bf16 v[168:171],v[36:39],a[104:107],v[168:171]
s_add_u32 s23,s23,10487168
s_add_u32 s23,s23,s24
v_mfma_f32_16x16x32_bf16 v[172:175],v[36:39],a[108:111],v[172:175]
buffer_load_dword v246,off,s[8:11],s23 sc1
v_lshrrev_b32 v244,4,v1
s_sub_u32 s23,s77,8
v_mfma_f32_16x16x32_bf16 v[176:179],v[36:39],a[112:115],v[176:179]
v_add_u32 v244,s23,v244
v_max_i32 v244,0,v244
v_mfma_f32_16x16x32_bf16 v[180:183],v[36:39],a[116:119],v[180:183]
buffer_load_dwordx4 v0,s[8:11],s64 offen offset:2048 sc1 lds
v_lshl_add_u32 v244,v244,13,v21
v_mfma_f32_16x16x32_bf16 v[184:187],v[36:39],a[120:123],v[184:187]
buffer_load_dwordx2 v[242:243],v244,s[8:11],0 offen sc1
s_waitcnt lgkmcnt(0)
v_or3_b32 v248,v248,v249,v250
v_mfma_f32_16x16x32_bf16 v[188:191],v[36:39],a[124:127],v[188:191]
v_or_b32 v248,v248,v251
v_mfma_f32_16x16x32_bf16 v[160:163],v[40:43],a[128:131],v[160:163]
v_readfirstlane_b32 s72,v248
v_mfma_f32_16x16x32_bf16 v[164:167],v[40:43],a[132:135],v[164:167]
buffer_load_dwordx4 v0,s[8:11],s64 offen offset:3072 sc1 lds
v_mfma_f32_16x16x32_bf16 v[168:171],v[40:43],a[136:139],v[168:171]
v_mfma_f32_16x16x32_bf16 v[172:175],v[40:43],a[140:143],v[172:175]
v_mfma_f32_16x16x32_bf16 v[176:179],v[40:43],a[144:147],v[176:179]
s_waitcnt vmcnt(12)
v_mfma_f32_16x16x32_bf16 v[180:183],v[40:43],a[148:151],v[180:183]
buffer_store_dword v20,off,s[8:11],s73 sc1
s_add_u32 m0,s58,8192
s_add_u32 s64,s64,4096
v_mfma_f32_16x16x32_bf16 v[184:187],v[40:43],a[152:155],v[184:187]
buffer_load_dwordx4 v0,s[8:11],s64 offen offset:0 sc1 lds
s_mov_b32 s73,0x80000000
v_mfma_f32_16x16x32_bf16 v[188:191],v[40:43],a[156:159],v[188:191]
v_mfma_f32_16x16x32_bf16 v[160:163],v[44:47],a[160:163],v[160:163]
v_mfma_f32_16x16x32_bf16 v[164:167],v[44:47],a[164:167],v[164:167]
v_mfma_f32_16x16x32_bf16 v[168:171],v[44:47],a[168:171],v[168:171]
buffer_load_dwordx4 v0,s[8:11],s64 offen offset:1024 sc1 lds
v_mfma_f32_16x16x32_bf16 v[172:175],v[44:47],a[172:175],v[172:175]
v_mfma_f32_16x16x32_bf16 v[176:179],v[44:47],a[176:179],v[176:179]
v_mfma_f32_16x16x32_bf16 v[180:183],v[44:47],a[180:183],v[180:183]
v_mfma_f32_16x16x32_bf16 v[184:187],v[44:47],a[184:187],v[184:187]
buffer_load_dwordx4 v0,s[8:11],s64 offen offset:2048 sc1 lds
v_mfma_f32_16x16x32_bf16 v[188:191],v[44:47],a[188:191],v[188:191]
v_mfma_f32_16x16x32_bf16 v[160:163],v[48:51],a[192:195],v[160:163]
v_mfma_f32_16x16x32_bf16 v[164:167],v[48:51],a[196:199],v[164:167]
v_mfma_f32_16x16x32_bf16 v[168:171],v[48:51],a[200:203],v[168:171]
buffer_load_dwordx4 v0,s[8:11],s64 offen offset:3072 sc1 lds
v_mfma_f32_16x16x32_bf16 v[172:175],v[48:51],a[204:207],v[172:175]
v_mfma_f32_16x16x32_bf16 v[176:179],v[48:51],a[208:211],v[176:179]
v_mfma_f32_16x16x32_bf16 v[180:183],v[48:51],a[212:215],v[180:183]
v_mfma_f32_16x16x32_bf16 v[184:187],v[48:51],a[216:219],v[184:187]
s_add_u32 m0,s57,24576
v_mfma_f32_16x16x32_bf16 v[188:191],v[48:51],a[220:223],v[188:191]
buffer_load_dwordx4 v0,s[8:11],s65 offen offset:0 sc1 lds
v_mfma_f32_16x16x32_bf16 v[160:163],v[52:55],a[224:227],v[160:163]
v_mfma_f32_16x16x32_bf16 v[164:167],v[52:55],a[228:231],v[164:167]
v_mfma_f32_16x16x32_bf16 v[168:171],v[52:55],a[232:235],v[168:171]
v_mfma_f32_16x16x32_bf16 v[172:175],v[52:55],a[236:239],v[172:175]
buffer_load_dwordx4 v0,s[8:11],s65 offen offset:1024 sc1 lds
v_mfma_f32_16x16x32_bf16 v[176:179],v[52:55],a[240:243],v[176:179]
v_mfma_f32_16x16x32_bf16 v[180:183],v[52:55],a[244:247],v[180:183]
v_mfma_f32_16x16x32_bf16 v[184:187],v[52:55],a[248:251],v[184:187]
v_mfma_f32_16x16x32_bf16 v[188:191],v[52:55],a[252:255],v[188:191]
v_mfma_f32_16x16x32_bf16 v[192:195],v[56:59],a[0:3],0
v_mfma_f32_16x16x32_bf16 v[196:199],v[56:59],a[4:7],0
v_mfma_f32_16x16x32_bf16 v[200:203],v[56:59],a[8:11],0
v_cvt_pk_bf16_f32 v24,v160,v164
v_cvt_pk_bf16_f32 v25,v168,v172
v_mfma_f32_16x16x32_bf16 v[204:207],v[56:59],a[12:15],0
v_cvt_pk_bf16_f32 v26,v176,v180
v_cvt_pk_bf16_f32 v27,v184,v188
v_mfma_f32_16x16x32_bf16 v[208:211],v[56:59],a[16:19],0
v_cvt_pk_bf16_f32 v28,v161,v165
v_cvt_pk_bf16_f32 v29,v169,v173
v_mfma_f32_16x16x32_bf16 v[212:215],v[56:59],a[20:23],0
v_cvt_pk_bf16_f32 v30,v177,v181
v_cvt_pk_bf16_f32 v31,v185,v189
v_mfma_f32_16x16x32_bf16 v[216:219],v[56:59],a[24:27],0
v_cvt_pk_bf16_f32 v32,v162,v166
v_cvt_pk_bf16_f32 v33,v170,v174
v_mfma_f32_16x16x32_bf16 v[220:223],v[56:59],a[28:31],0
v_cvt_pk_bf16_f32 v34,v178,v182
v_cvt_pk_bf16_f32 v35,v186,v190
v_mfma_f32_16x16x32_bf16 v[192:195],v[60:63],a[32:35],v[192:195]
v_cvt_pk_bf16_f32 v36,v163,v167
v_cvt_pk_bf16_f32 v37,v171,v175
v_mfma_f32_16x16x32_bf16 v[196:199],v[60:63],a[36:39],v[196:199]
v_cvt_pk_bf16_f32 v38,v179,v183
v_cvt_pk_bf16_f32 v39,v187,v191
v_mfma_f32_16x16x32_bf16 v[200:203],v[60:63],a[40:43],v[200:203]
v_mfma_f32_16x16x32_bf16 v[204:207],v[60:63],a[44:47],v[204:207]
v_mfma_f32_16x16x32_bf16 v[208:211],v[60:63],a[48:51],v[208:211]
v_mfma_f32_16x16x32_bf16 v[212:215],v[60:63],a[52:55],v[212:215]
v_mfma_f32_16x16x32_bf16 v[216:219],v[60:63],a[56:59],v[216:219]
v_mfma_f32_16x16x32_bf16 v[220:223],v[60:63],a[60:63],v[220:223]
v_mfma_f32_16x16x32_bf16 v[192:195],v[64:67],a[64:67],v[192:195]
v_mfma_f32_16x16x32_bf16 v[196:199],v[64:67],a[68:71],v[196:199]
v_mfma_f32_16x16x32_bf16 v[200:203],v[64:67],a[72:75],v[200:203]
v_mfma_f32_16x16x32_bf16 v[204:207],v[64:67],a[76:79],v[204:207]
v_mfma_f32_16x16x32_bf16 v[208:211],v[64:67],a[80:83],v[208:211]
v_mfma_f32_16x16x32_bf16 v[212:215],v[64:67],a[84:87],v[212:215]
v_mfma_f32_16x16x32_bf16 v[216:219],v[64:67],a[88:91],v[216:219]
v_mfma_f32_16x16x32_bf16 v[220:223],v[64:67],a[92:95],v[220:223]
v_mfma_f32_16x16x32_bf16 v[192:195],v[68:71],a[96:99],v[192:195]
v_mfma_f32_16x16x32_bf16 v[196:199],v[68:71],a[100:103],v[196:199]
v_mfma_f32_16x16x32_bf16 v[200:203],v[68:71],a[104:107],v[200:203]
v_mfma_f32_16x16x32_bf16 v[204:207],v[68:71],a[108:111],v[204:207]
v_mfma_f32_16x16x32_bf16 v[208:211],v[68:71],a[112:115],v[208:211]
s_add_u32 s62,s69,0
v_mfma_f32_16x16x32_bf16 v[212:215],v[68:71],a[116:119],v[212:215]
buffer_store_dwordx4 v[24:27],v5,s[8:11],s62 offen
v_mfma_f32_16x16x32_bf16 v[216:219],v[68:71],a[120:123],v[216:219]
v_mfma_f32_16x16x32_bf16 v[220:223],v[68:71],a[124:127],v[220:223]
v_mfma_f32_16x16x32_bf16 v[192:195],v[72:75],a[128:131],v[192:195]
s_add_u32 s62,s69,16384
v_mfma_f32_16x16x32_bf16 v[196:199],v[72:75],a[132:135],v[196:199]
buffer_store_dwordx4 v[28:31],v5,s[8:11],s62 offen
v_mfma_f32_16x16x32_bf16 v[200:203],v[72:75],a[136:139],v[200:203]
v_mfma_f32_16x16x32_bf16 v[204:207],v[72:75],a[140:143],v[204:207]
v_mfma_f32_16x16x32_bf16 v[208:211],v[72:75],a[144:147],v[208:211]
s_add_u32 s62,s69,32768
v_mfma_f32_16x16x32_bf16 v[212:215],v[72:75],a[148:151],v[212:215]
buffer_store_dwordx4 v[32:35],v5,s[8:11],s62 offen
v_mfma_f32_16x16x32_bf16 v[216:219],v[72:75],a[152:155],v[216:219]
v_mfma_f32_16x16x32_bf16 v[220:223],v[72:75],a[156:159],v[220:223]
v_mfma_f32_16x16x32_bf16 v[192:195],v[76:79],a[160:163],v[192:195]
s_add_u32 s62,s69,49152
v_mfma_f32_16x16x32_bf16 v[196:199],v[76:79],a[164:167],v[196:199]
buffer_store_dwordx4 v[36:39],v5,s[8:11],s62 offen
v_mfma_f32_16x16x32_bf16 v[200:203],v[76:79],a[168:171],v[200:203]
v_mfma_f32_16x16x32_bf16 v[204:207],v[76:79],a[172:175],v[204:207]
v_mfma_f32_16x16x32_bf16 v[208:211],v[76:79],a[176:179],v[208:211]
v_mfma_f32_16x16x32_bf16 v[212:215],v[76:79],a[180:183],v[212:215]
v_mfma_f32_16x16x32_bf16 v[216:219],v[76:79],a[184:187],v[216:219]
v_mfma_f32_16x16x32_bf16 v[220:223],v[76:79],a[188:191],v[220:223]
v_mfma_f32_16x16x32_bf16 v[192:195],v[80:83],a[192:195],v[192:195]
v_mfma_f32_16x16x32_bf16 v[196:199],v[80:83],a[196:199],v[196:199]
v_mfma_f32_16x16x32_bf16 v[192:195],v[84:87],a[224:227],v[192:195]
v_mfma_f32_16x16x32_bf16 v[196:199],v[84:87],a[228:231],v[196:199]
v_mfma_f32_16x16x32_bf16 v[200:203],v[80:83],a[200:203],v[200:203]
v_mfma_f32_16x16x32_bf16 v[204:207],v[80:83],a[204:207],v[204:207]
v_mfma_f32_16x16x32_bf16 v[200:203],v[84:87],a[232:235],v[200:203]
v_mfma_f32_16x16x32_bf16 v[204:207],v[84:87],a[236:239],v[204:207]
v_cvt_pk_bf16_f32 v40,v192,v196
v_cvt_pk_bf16_f32 v44,v193,v197
v_cvt_pk_bf16_f32 v48,v194,v198
v_mfma_f32_16x16x32_bf16 v[208:211],v[80:83],a[208:211],v[208:211]
v_cvt_pk_bf16_f32 v52,v195,v199
v_mfma_f32_16x16x32_bf16 v[212:215],v[80:83],a[212:215],v[212:215]
v_cvt_pk_bf16_f32 v41,v200,v204
v_cvt_pk_bf16_f32 v45,v201,v205
v_cvt_pk_bf16_f32 v49,v202,v206
v_mfma_f32_16x16x32_bf16 v[208:211],v[84:87],a[240:243],v[208:211]
v_cvt_pk_bf16_f32 v53,v203,v207
v_mfma_f32_16x16x32_bf16 v[212:215],v[84:87],a[244:247],v[212:215]
v_mfma_f32_16x16x32_bf16 v[216:219],v[80:83],a[216:219],v[216:219]
v_mfma_f32_16x16x32_bf16 v[220:223],v[80:83],a[220:223],v[220:223]
v_mfma_f32_16x16x32_bf16 v[216:219],v[84:87],a[248:251],v[216:219]
v_mfma_f32_16x16x32_bf16 v[220:223],v[84:87],a[252:255],v[220:223]
v_cvt_pk_bf16_f32 v42,v208,v212
v_cvt_pk_bf16_f32 v46,v209,v213
v_cvt_pk_bf16_f32 v50,v210,v214
v_cvt_pk_bf16_f32 v54,v211,v215
s_nop 3
v_cvt_pk_bf16_f32 v43,v216,v220
s_add_u32 s62,s69,262144
buffer_store_dwordx4 v[40:43],v5,s[8:11],s62 offen
v_cvt_pk_bf16_f32 v47,v217,v221
s_add_u32 s62,s69,278528
buffer_store_dwordx4 v[44:47],v5,s[8:11],s62 offen
v_cvt_pk_bf16_f32 v51,v218,v222
s_add_u32 s62,s69,294912
buffer_store_dwordx4 v[48:51],v5,s[8:11],s62 offen
v_cvt_pk_bf16_f32 v55,v219,v223
s_add_u32 s62,s69,311296
buffer_store_dwordx4 v[52:55],v5,s[8:11],s62 offen
s_cmp_lg_u32 s72,0
s_cbranch_scc1 L_aa_75
s_waitcnt vmcnt(8)
L_aa_85:
s_barrier
s_cmp_lt_u32 s30,s31
s_cbranch_scc1 L_ao_92
s_xor_b32 s67,s67,65536
s_and_b32 s56,s50,2048
s_lshl_b32 s56,s56,4
s_add_u32 s56,s56,s67
v_add_u32 v2,s56,v0
v_add_u32 v239,s56,v253
s_and_b32 s56,s50,1024
s_lshl_b32 s56,s56,2
v_add_u32 v238,s56,v2
s_mov_b32 s76,s71
s_mov_b32 s53,s77
ds_read_b128 v[24:27],v238 offset:16384
ds_read_b128 v[40:43],v2 offset:0
ds_read_b128 v[56:59],v2 offset:4096
ds_read_b128 v[28:31],v238 offset:17408
ds_read_b128 v[44:47],v2 offset:1024
ds_read_b128 v[60:63],v2 offset:5120
ds_read_b128 v[32:35],v238 offset:18432
ds_read_b128 v[48:51],v2 offset:2048
ds_read_b128 v[64:67],v2 offset:6144
ds_read_b128 v[36:39],v238 offset:19456
ds_read_b128 v[52:55],v2 offset:3072
ds_read_b128 v[68:71],v2 offset:7168
s_waitcnt lgkmcnt(9)
v_mfma_f32_16x16x32_bf16 v[128:131],v[40:43],v[24:27],v[8:11]
ds_read_b128 v[72:75],v2 offset:24576
v_mfma_f32_16x16x32_bf16 v[132:135],v[56:59],v[24:27],v[12:15]
ds_read_b128 v[76:79],v2 offset:25600
s_waitcnt lgkmcnt(8)
v_mfma_f32_16x16x32_bf16 v[128:131],v[44:47],v[28:31],v[128:131]
ds_read_b128 v[80:83],v2 offset:26624
v_mfma_f32_16x16x32_bf16 v[132:135],v[60:63],v[28:31],v[132:135]
ds_read_b128 v[84:87],v2 offset:27648
s_waitcnt lgkmcnt(7)
v_mfma_f32_16x16x32_bf16 v[128:131],v[48:51],v[32:35],v[128:131]
ds_read_b64 v[120:121],v239 offset:24576
v_mfma_f32_16x16x32_bf16 v[132:135],v[64:67],v[32:35],v[132:135]
ds_read_b64 v[122:123],v239 offset:25600
s_waitcnt lgkmcnt(6)
v_mfma_f32_16x16x32_bf16 v[128:131],v[52:55],v[36:39],v[128:131]
ds_read_b64 v[124:125],v239 offset:26624
v_mfma_f32_16x16x32_bf16 v[132:135],v[68:71],v[36:39],v[132:135]
ds_read_b64 v[126:127],v239 offset:27648
s_waitcnt lgkmcnt(4)
v_mfma_f32_16x16x32_bf16 v[136:139],v[72:75],v[24:27],0
ds_read_b128 v[88:91],v2 offset:8192
ds_read_b128 v[92:95],v2 offset:9216
v_mfma_f32_16x16x32_bf16 v[136:139],v[76:79],v[28:31],v[136:139]
ds_read_b128 v[96:99],v2 offset:10240
ds_read_b128 v[100:103],v2 offset:11264
v_mfma_f32_16x16x32_bf16 v[136:139],v[80:83],v[32:35],v[136:139]
ds_read_b128 v[104:107],v2 offset:12288
ds_read_b128 v[108:111],v2 offset:13312
v_mfma_f32_16x16x32_bf16 v[136:139],v[84:87],v[36:39],v[136:139]
ds_read_b128 v[112:115],v2 offset:14336
ds_read_b128 v[116:119],v2 offset:15360
s_cmp_eq_u32 s30,0
s_cbranch_scc1 L_aa_74
v_max3_u32 v238,v72,v73,v74
v_max3_u32 v238,v74,v75,v238
v_max3_u32 v238,v76,v77,v238
v_max3_u32 v238,v78,v79,v238
v_max3_u32 v238,v80,v81,v238
v_max3_u32 v238,v82,v83,v238
v_max3_u32 v238,v84,v85,v238
v_max3_u32 v238,v86,v87,v238
s_waitcnt lgkmcnt(8)
v_max3_u32 v238,v120,v121,v238
v_max3_u32 v238,v122,v123,v238
v_max3_u32 v238,v124,v125,v238
v_max3_u32 v238,v126,v127,v238
v_cmp_eq_u32 vcc,-1,v238
s_cmp_lg_u64 vcc,0
s_cselect_b32 s27,1,0
s_andn2_b32 s57,s27,s31
s_add_u32 s66,s66,4
s_bfe_u32 s56,s66,0x10002
s_bitset0_b32 s37,s56
s_lshl_b32 s56,s57,s56
s_or_b32 s37,s37,s56
s_or_b32 s56,s37,s66
v_mov_b32 v22,s56
s_xor_b32 s69,s69,524288
s_waitcnt vmcnt(0) lgkmcnt(0)
buffer_store_dword v22,off,s[8:11],s74
s_cmp_lg_u32 s86,1536
s_cbranch_scc1 L_ae_95
s_mov_b32 s77,s35
s_mov_b32 s30,0
s_lshl_b32 s56,s77,5
s_add_u32 s56,s56,s68
s_mul_i32 s70,s56,24576
s_lshl_b32 s71,s56,12
s_lshl_b32 s59,s77,13
s_lshl2_add_u32 s59,s68,s59
s_add_u32 s59,s59,10485760
s_buffer_load_dword s32,s[8:11],s59
s_mov_b32 s33,1
s_add_u32 s70,s70,100663296
s_add_u32 s71,s71,41943040
v_mov_b32 v19,s59
s_branch L_af_96
L_ae_95:
s_ff1_i32_b64 s77,s[84:85]
s_bitset0_b64 s[84:85],s77
s_min_u32 s77,s77,64
s_lshr_b32 s61,s55,5
s_lshl_b32 s56,s77,5
s_add_u32 s56,s56,s68
s_mul_i32 s70,s56,24576
s_lshl_b32 s71,s56,12
s_lshl_b32 s59,s77,13
s_lshl2_add_u32 s59,s68,s59
s_add_u32 s59,s59,10486144
s_cmp_lt_u32 s77,s61
s_cselect_b32 s57,0,16777216
s_mov_b32 s60,s59
s_buffer_load_dword s33,s[8:11],s60
s_add_u32 s71,s71,s57
s_add_u32 s71,s71,58720256
s_cmp_eq_u32 s77,s61
s_cselect_b32 s57,50331648,0
s_cselect_b32 s58,1536,0
s_add_u32 s59,s59,s58
s_buffer_load_dword s32,s[8:11],s59
s_add_u32 s70,s70,s57
s_add_u32 s70,s70,150994944
v_mov_b32 v19,s59
v_writelane_b32 v19,s60,1
L_af_96:
s_and_b32 s27,s27,s31
s_cbranch_scc1 L_ac_97
L_acb_98:
v_max3_f32 v238,v128,v129,v130
v_max3_f32 v239,v131,v132,v133
v_max3_f32 v238,v134,v135,v238
v_max3_f32 v239,v138,v139,v239
v_max_f32 v238,v238,v239
v_max_f32 v239,v238,v239
v_pk_mul_f32 v[128:129],v[128:129],v[152:153] op_sel_hi:[1,0]
v_pk_mul_f32 v[130:131],v[130:131],v[152:153] op_sel_hi:[1,0]
v_permlane16_swap_b32 v238,v239
v_max_f32 v238,v238,v239
v_max_f32 v239,v238,v239
v_pk_mul_f32 v[132:133],v[132:133],v[152:153] op_sel_hi:[1,0]
v_pk_mul_f32 v[134:135],v[134:135],v[152:153] op_sel_hi:[1,0]
v_permlane32_swap_b32 v238,v239
v_max_f32 v238,v238,v239
v_mul_f32 v238,v152,v238
v_pk_mul_f32 v[138:139],v[138:139],v[152:153] op_sel_hi:[1,0]
buffer_load_dword v17,v16,s[8:11],s87 offen sc1
v_pk_add_f32 v[128:129],v[128:129],v[238:239] op_sel_hi:[1,0] neg_lo:[0,1] neg_hi:[0,1]
v_pk_add_f32 v[130:131],v[130:131],v[238:239] op_sel_hi:[1,0] neg_lo:[0,1] neg_hi:[0,1]
v_pk_add_f32 v[132:133],v[132:133],v[238:239] op_sel_hi:[1,0] neg_lo:[0,1] neg_hi:[0,1]
v_pk_add_f32 v[134:135],v[134:135],v[238:239] op_sel_hi:[1,0] neg_lo:[0,1] neg_hi:[0,1]
v_pk_add_f32 v[138:139],v[138:139],v[238:239] op_sel_hi:[1,0] neg_lo:[0,1] neg_hi:[0,1]
v_exp_f32 v128,v128
v_exp_f32 v129,v129
v_exp_f32 v130,v130
v_exp_f32 v131,v131
v_exp_f32 v132,v132
v_exp_f32 v133,v133
v_exp_f32 v134,v134
v_exp_f32 v135,v135
v_exp_f32 v138,v138
v_exp_f32 v139,v139
v_pk_add_f32 v[148:149],v[128:129],v[130:131]
v_pk_add_f32 v[150:151],v[132:133],v[134:135]
v_pk_add_f32 v[148:149],v[148:149],v[138:139]
v_pk_add_f32 v[148:149],v[148:149],v[150:151]
v_add_f32 v150,v148,v149
v_add_f32 v151,v148,v149
s_nop 1
v_permlane16_swap_b32 v150,v151
v_add_f32 v148,v150,v151
v_add_f32 v149,v150,v151
s_nop 1
v_permlane32_swap_b32 v148,v149
v_add_f32 v148,v148,v149
v_rcp_f32 v148,v148
s_waitcnt vmcnt(0)
v_cmp_gt_u32 vcc,s66,v17
v_pk_mul_f32 v[138:139],v[138:139],v[148:149] op_sel_hi:[1,0]
v_pk_mul_f32 v[128:129],v[128:129],v[148:149] op_sel_hi:[1,0]
v_pk_mul_f32 v[130:131],v[130:131],v[148:149] op_sel_hi:[1,0]
v_pk_mul_f32 v[132:133],v[132:133],v[148:149] op_sel_hi:[1,0]
v_pk_mul_f32 v[134:135],v[134:135],v[148:149] op_sel_hi:[1,0]
s_cbranch_vccnz L_ap_100
L_apb_101:
s_xor_b32 s34,s69,524288
buffer_load_dwordx4 v[192:195],v7,s[8:11],s34 offen sc1
s_bfe_u32 s56,s66,0x10002
v_lshrrev_b32 v238,s56,v17
v_and_b32 v238,1,v238
v_cmp_ne_u32 vcc,0,v238
v_cvt_pk_bf16_f32 v144,v138,v139
v_cvt_pk_bf16_f32 v147,v138,v139
v_cvt_pk_bf16_f32 v140,v128,v129
v_cvt_pk_bf16_f32 v141,v130,v131
v_cvt_pk_bf16_f32 v142,v132,v133
v_cvt_pk_bf16_f32 v143,v134,v135
s_cbranch_vccnz L_ak_94
s_add_u32 s36,s36,4
v_mfma_f32_16x16x16_bf16 v[24:27],v[120:121],v[144:145],0
s_add_u32 s34,s34,4096
v_mfma_f32_16x16x16_bf16 v[28:31],v[120:121],v[146:147],0
buffer_load_dwordx4 v[196:199],v7,s[8:11],s34 offen sc1
v_mfma_f32_16x16x16_bf16 v[32:35],v[122:123],v[144:145],0
s_add_u32 s34,s34,4096
v_mfma_f32_16x16x16_bf16 v[36:39],v[122:123],v[146:147],0
buffer_load_dwordx4 v[200:203],v7,s[8:11],s34 offen sc1
v_mfma_f32_16x16x16_bf16 v[40:43],v[124:125],v[144:145],0
s_add_u32 s34,s34,4096
v_mfma_f32_16x16x16_bf16 v[44:47],v[124:125],v[146:147],0
buffer_load_dwordx4 v[204:207],v7,s[8:11],s34 offen sc1
v_mfma_f32_16x16x16_bf16 v[48:51],v[126:127],v[144:145],0
s_add_u32 s34,s34,4096
v_mfma_f32_16x16x16_bf16 v[52:55],v[126:127],v[146:147],0
buffer_load_dwordx4 v[208:211],v7,s[8:11],s34 offen sc1
v_mfma_f32_16x16x32_bf16 v[24:27],v[88:91],v[140:143],v[24:27]
s_add_u32 s34,s34,4096
v_mfma_f32_16x16x32_bf16 v[28:31],v[92:95],v[140:143],v[28:31]
buffer_load_dwordx4 v[212:215],v7,s[8:11],s34 offen sc1
v_mfma_f32_16x16x32_bf16 v[32:35],v[96:99],v[140:143],v[32:35]
s_add_u32 s34,s34,4096
v_mfma_f32_16x16x32_bf16 v[36:39],v[100:103],v[140:143],v[36:39]
buffer_load_dwordx4 v[216:219],v7,s[8:11],s34 offen sc1
v_cvt_pk_bf16_f32 v72,v24,v28
v_cvt_pk_bf16_f32 v73,v25,v29
v_mfma_f32_16x16x32_bf16 v[40:43],v[104:107],v[140:143],v[40:43]
s_add_u32 s34,s34,4096
v_cvt_pk_bf16_f32 v74,v26,v30
v_cvt_pk_bf16_f32 v75,v27,v31
v_mfma_f32_16x16x32_bf16 v[44:47],v[108:111],v[140:143],v[44:47]
ds_write_b128 v3,v[72:75] offset:0
v_cvt_pk_bf16_f32 v76,v32,v36
v_cvt_pk_bf16_f32 v77,v33,v37
v_mfma_f32_16x16x32_bf16 v[48:51],v[112:115],v[140:143],v[48:51]
buffer_load_dwordx4 v[220:223],v7,s[8:11],s34 offen sc1
v_cvt_pk_bf16_f32 v78,v34,v38
v_cvt_pk_bf16_f32 v79,v35,v39
v_mfma_f32_16x16x32_bf16 v[52:55],v[116:119],v[140:143],v[52:55]
ds_write_b128 v3,v[76:79] offset:1024
v_cvt_pk_bf16_f32 v80,v40,v44
v_cvt_pk_bf16_f32 v81,v41,v45
v_cvt_pk_bf16_f32 v82,v42,v46
v_cvt_pk_bf16_f32 v83,v43,v47
ds_write_b128 v3,v[80:83] offset:2048
s_nop 1
v_cvt_pk_bf16_f32 v84,v48,v52
v_cvt_pk_bf16_f32 v85,v49,v53
v_cvt_pk_bf16_f32 v86,v50,v54
v_cvt_pk_bf16_f32 v87,v51,v55
ds_write_b128 v3,v[84:87] offset:3072
s_cmp_eq_u32 s31,0
s_cbranch_scc1 L_ah_99
s_waitcnt lgkmcnt(0)
s_barrier
s_mov_b32 s26,s51
s_mov_b32 s51,s53
s_branch L_aa_86
L_ah_99:
s_waitcnt vmcnt(7)
v_mfma_f32_16x16x32_bf16 v[160:163],v[156:159],v[192:195],0
s_waitcnt vmcnt(6)
v_mfma_f32_16x16x32_bf16 v[160:163],v[156:159],v[196:199],v[160:163]
s_waitcnt vmcnt(5)
v_mfma_f32_16x16x32_bf16 v[160:163],v[156:159],v[200:203],v[160:163]
s_waitcnt vmcnt(4)
v_mfma_f32_16x16x32_bf16 v[160:163],v[156:159],v[204:207],v[160:163]
s_waitcnt vmcnt(3)
v_mfma_f32_16x16x32_bf16 v[164:167],v[156:159],v[208:211],0
s_waitcnt vmcnt(2)
v_mfma_f32_16x16x32_bf16 v[164:167],v[156:159],v[212:215],v[164:167]
s_waitcnt vmcnt(1)
v_mfma_f32_16x16x32_bf16 v[164:167],v[156:159],v[216:219],v[164:167]
ds_write_b128 v6,v[160:163]
s_waitcnt vmcnt(0)
v_mfma_f32_16x16x32_bf16 v[164:167],v[156:159],v[220:223],v[164:167]
s_nop 7
ds_write_b128 v6,v[164:167] offset:2048
s_waitcnt lgkmcnt(0)
s_barrier
buffer_store_dword v20,off,s[8:11],s73 sc1
s_mov_b32 s73,0x80000000
s_mov_b32 s27,1
s_branch L_aa_77
L_ao_92:
s_xor_b32 s67,s67,65536
s_and_b32 s56,s50,2048
s_lshl_b32 s56,s56,4
s_add_u32 s56,s56,s67
v_add_u32 v2,s56,v0
v_add_u32 v239,s56,v253
s_and_b32 s56,s50,1024
s_lshl_b32 s56,s56,2
v_add_u32 v238,s56,v2
s_mov_b32 s76,s71
s_mov_b32 s53,s77
ds_read_b128 v[24:27],v238 offset:16384
ds_read_b128 v[40:43],v2 offset:0
ds_read_b128 v[56:59],v2 offset:4096
ds_read_b128 v[28:31],v238 offset:17408
ds_read_b128 v[44:47],v2 offset:1024
ds_read_b128 v[60:63],v2 offset:5120
ds_read_b128 v[32:35],v238 offset:18432
ds_read_b128 v[48:51],v2 offset:2048
ds_read_b128 v[64:67],v2 offset:6144
ds_read_b128 v[36:39],v238 offset:19456
ds_read_b128 v[52:55],v2 offset:3072
ds_read_b128 v[68:71],v2 offset:7168
buffer_load_dwordx4 v[72:75],v0,s[8:11],s76 offen offset:0 sc1
buffer_load_dwordx4 v[76:79],v0,s[8:11],s76 offen offset:1024 sc1
buffer_load_dwordx4 v[80:83],v0,s[8:11],s76 offen offset:2048 sc1
buffer_load_dwordx4 v[84:87],v0,s[8:11],s76 offen offset:3072 sc1
buffer_load_dwordx2 v[120:121],v253,s[8:11],s76 offen offset:0 sc1
buffer_load_dwordx2 v[122:123],v253,s[8:11],s76 offen offset:1024 sc1
buffer_load_dwordx2 v[124:125],v253,s[8:11],s76 offen offset:2048 sc1
buffer_load_dwordx2 v[126:127],v253,s[8:11],s76 offen offset:3072 sc1
s_waitcnt lgkmcnt(9)
v_mfma_f32_16x16x32_bf16 v[128:131],v[40:43],v[24:27],v[8:11]
ds_read_b128 v[88:91],v2 offset:8192
v_mfma_f32_16x16x32_bf16 v[132:135],v[56:59],v[24:27],v[12:15]
ds_read_b128 v[92:95],v2 offset:9216
s_waitcnt lgkmcnt(8)
v_mfma_f32_16x16x32_bf16 v[128:131],v[44:47],v[28:31],v[128:131]
ds_read_b128 v[96:99],v2 offset:10240
v_mfma_f32_16x16x32_bf16 v[132:135],v[60:63],v[28:31],v[132:135]
ds_read_b128 v[100:103],v2 offset:11264
s_waitcnt lgkmcnt(7)
v_mfma_f32_16x16x32_bf16 v[128:131],v[48:51],v[32:35],v[128:131]
ds_read_b128 v[104:107],v2 offset:12288
v_mfma_f32_16x16x32_bf16 v[132:135],v[64:67],v[32:35],v[132:135]
ds_read_b128 v[108:111],v2 offset:13312
s_waitcnt lgkmcnt(6)
v_mfma_f32_16x16x32_bf16 v[128:131],v[52:55],v[36:39],v[128:131]
ds_read_b128 v[112:115],v2 offset:14336
v_mfma_f32_16x16x32_bf16 v[132:135],v[68:71],v[36:39],v[132:135]
ds_read_b128 v[116:119],v2 offset:15360
s_add_u32 s66,s66,4
s_bfe_u32 s56,s66,0x10002
s_bitset0_b32 s37,s56
s_lshl_b32 s56,0,s56
s_or_b32 s37,s37,s56
s_or_b32 s56,s37,s66
v_mov_b32 v22,s56
s_xor_b32 s69,s69,524288
s_waitcnt vmcnt(8) lgkmcnt(0)
buffer_store_dword v22,off,s[8:11],s74
s_mov_b32 s26,s51
s_mov_b32 s27,3
s_branch L_aa_81
L_aa_74:
s_add_u32 s66,s66,4
s_bfe_u32 s56,s66,0x10002
s_bitset0_b32 s37,s56
s_lshl_b32 s56,0,s56
s_or_b32 s37,s37,s56
s_or_b32 s56,s37,s66
v_mov_b32 v22,s56
s_xor_b32 s69,s69,524288
s_waitcnt vmcnt(0) lgkmcnt(0)
buffer_store_dword v22,off,s[8:11],s74
L_aq_102:
buffer_load_dword v17,v16,s[8:11],s87 offen sc1
s_sub_u32 s49,s49,1
s_cbranch_scc1 L_abort
s_waitcnt vmcnt(0)
v_cmp_gt_u32 vcc,s66,v17
s_cbranch_vccnz L_aq_102
s_xor_b32 s34,s69,524288
buffer_load_dwordx4 v[160:163],v7,s[8:11],s34 offen sc1
s_add_u32 s34,s34,4096
buffer_load_dwordx4 v[164:167],v7,s[8:11],s34 offen sc1
s_add_u32 s34,s34,4096
buffer_load_dwordx4 v[168:171],v7,s[8:11],s34 offen sc1
s_add_u32 s34,s34,4096
buffer_load_dwordx4 v[172:175],v7,s[8:11],s34 offen sc1
s_add_u32 s34,s34,4096
buffer_load_dwordx4 v[176:179],v7,s[8:11],s34 offen sc1
s_add_u32 s34,s34,4096
buffer_load_dwordx4 v[180:183],v7,s[8:11],s34 offen sc1
s_add_u32 s34,s34,4096
buffer_load_dwordx4 v[184:187],v7,s[8:11],s34 offen sc1
s_add_u32 s34,s34,4096
buffer_load_dwordx4 v[188:191],v7,s[8:11],s34 offen sc1
buffer_load_dwordx4 v[72:75],v0,s[8:11],s76 offen offset:0 sc1
buffer_load_dwordx4 v[76:79],v0,s[8:11],s76 offen offset:1024 sc1
buffer_load_dwordx4 v[80:83],v0,s[8:11],s76 offen offset:2048 sc1
buffer_load_dwordx4 v[84:87],v0,s[8:11],s76 offen offset:3072 sc1
buffer_load_dwordx2 v[120:121],v253,s[8:11],s76 offen offset:0 sc1
buffer_load_dwordx2 v[122:123],v253,s[8:11],s76 offen offset:1024 sc1
buffer_load_dwordx2 v[124:125],v253,s[8:11],s76 offen offset:2048 sc1
buffer_load_dwordx2 v[126:127],v253,s[8:11],s76 offen offset:3072 sc1
s_waitcnt vmcnt(15)
v_mfma_f32_16x16x32_bf16 v[192:195],v[156:159],v[160:163],0
s_waitcnt vmcnt(14)
v_mfma_f32_16x16x32_bf16 v[192:195],v[156:159],v[164:167],v[192:195]
s_waitcnt vmcnt(13)
v_mfma_f32_16x16x32_bf16 v[192:195],v[156:159],v[168:171],v[192:195]
s_waitcnt vmcnt(12)
v_mfma_f32_16x16x32_bf16 v[192:195],v[156:159],v[172:175],v[192:195]
s_waitcnt vmcnt(11)
v_mfma_f32_16x16x32_bf16 v[196:199],v[156:159],v[176:179],0
s_waitcnt vmcnt(10)
v_mfma_f32_16x16x32_bf16 v[196:199],v[156:159],v[180:183],v[196:199]
s_waitcnt vmcnt(9)
v_mfma_f32_16x16x32_bf16 v[196:199],v[156:159],v[184:187],v[196:199]
ds_write_b128 v6,v[192:195]
s_waitcnt vmcnt(8)
v_mfma_f32_16x16x32_bf16 v[196:199],v[156:159],v[188:191],v[196:199]
s_nop 7
ds_write_b128 v6,v[196:199] offset:2048
s_waitcnt lgkmcnt(0)
s_barrier
buffer_store_dword v20,off,s[8:11],s73 sc1
s_mov_b32 s73,0x80000000
s_mov_b32 s27,0
s_branch L_aa_77
L_aa_75:
s_add_u32 s56,s30,s86
s_cmp_lg_u32 s56,1537
s_cbranch_scc1 L_al_93
s_add_u32 s66,s66,4
s_bfe_u32 s56,s66,0x10002
s_bitset0_b32 s37,s56
s_lshl_b32 s56,1,s56
s_or_b32 s37,s37,s56
s_or_b32 s56,s37,s66
v_mov_b32 v22,s56
s_xor_b32 s69,s69,524288
s_waitcnt vmcnt(0) lgkmcnt(0)
buffer_store_dword v22,off,s[8:11],s74
s_cmp_lg_u32 s86,1536
s_cbranch_scc1 L_ae_103
s_mov_b32 s77,s35
s_mov_b32 s30,0
s_lshl_b32 s56,s77,5
s_add_u32 s56,s56,s68
s_mul_i32 s70,s56,24576
s_lshl_b32 s71,s56,12
s_lshl_b32 s59,s77,13
s_lshl2_add_u32 s59,s68,s59
s_add_u32 s59,s59,10485760
s_buffer_load_dword s32,s[8:11],s59
s_mov_b32 s33,1
s_add_u32 s70,s70,100663296
s_add_u32 s71,s71,41943040
v_mov_b32 v19,s59
s_branch L_af_104
L_ae_103:
s_ff1_i32_b64 s77,s[84:85]
s_bitset0_b64 s[84:85],s77
s_min_u32 s77,s77,64
s_lshr_b32 s61,s55,5
s_lshl_b32 s56,s77,5
s_add_u32 s56,s56,s68
s_mul_i32 s70,s56,24576
s_lshl_b32 s71,s56,12
s_lshl_b32 s59,s77,13
s_lshl2_add_u32 s59,s68,s59
s_add_u32 s59,s59,10486144
s_cmp_lt_u32 s77,s61
s_cselect_b32 s57,0,16777216
s_mov_b32 s60,s59
s_buffer_load_dword s33,s[8:11],s60
s_add_u32 s71,s71,s57
s_add_u32 s71,s71,58720256
s_cmp_eq_u32 s77,s61
s_cselect_b32 s57,50331648,0
s_cselect_b32 s58,1536,0
s_add_u32 s59,s59,s58
s_buffer_load_dword s32,s[8:11],s59
s_add_u32 s70,s70,s57
s_add_u32 s70,s70,150994944
v_mov_b32 v19,s59
v_writelane_b32 v19,s60,1
L_af_104:
s_branch L_ak_94
L_al_93:
s_add_u32 s66,s66,4
s_bfe_u32 s56,s66,0x10002
s_bitset0_b32 s37,s56
s_lshl_b32 s56,0,s56
s_or_b32 s37,s37,s56
s_or_b32 s56,s37,s66
v_mov_b32 v22,s56
s_xor_b32 s69,s69,524288
s_waitcnt vmcnt(0) lgkmcnt(0)
buffer_store_dword v22,off,s[8:11],s74
L_ak_94:
L_aq_105:
buffer_load_dword v17,v16,s[8:11],s87 offen sc1
s_sub_u32 s49,s49,1
s_cbranch_scc1 L_abort
s_waitcnt vmcnt(0)
v_cmp_gt_u32 vcc,s66,v17
s_cbranch_vccnz L_aq_105
s_xor_b32 s34,s69,524288
buffer_load_dwordx4 v[160:163],v7,s[8:11],s34 offen sc1
s_add_u32 s34,s34,4096
buffer_load_dwordx4 v[164:167],v7,s[8:11],s34 offen sc1
s_add_u32 s34,s34,4096
buffer_load_dwordx4 v[168:171],v7,s[8:11],s34 offen sc1
s_add_u32 s34,s34,4096
buffer_load_dwordx4 v[172:175],v7,s[8:11],s34 offen sc1
s_add_u32 s34,s34,4096
buffer_load_dwordx4 v[176:179],v7,s[8:11],s34 offen sc1
s_add_u32 s34,s34,4096
buffer_load_dwordx4 v[180:183],v7,s[8:11],s34 offen sc1
s_add_u32 s34,s34,4096
buffer_load_dwordx4 v[184:187],v7,s[8:11],s34 offen sc1
s_add_u32 s34,s34,4096
buffer_load_dwordx4 v[188:191],v7,s[8:11],s34 offen sc1
s_waitcnt vmcnt(7)
v_mfma_f32_16x16x32_bf16 v[192:195],v[156:159],v[160:163],0
s_waitcnt vmcnt(6)
v_mfma_f32_16x16x32_bf16 v[192:195],v[156:159],v[164:167],v[192:195]
s_waitcnt vmcnt(5)
v_mfma_f32_16x16x32_bf16 v[192:195],v[156:159],v[168:171],v[192:195]
s_waitcnt vmcnt(4)
v_mfma_f32_16x16x32_bf16 v[192:195],v[156:159],v[172:175],v[192:195]
s_waitcnt vmcnt(3)
v_mfma_f32_16x16x32_bf16 v[196:199],v[156:159],v[176:179],0
s_waitcnt vmcnt(2)
v_mfma_f32_16x16x32_bf16 v[196:199],v[156:159],v[180:183],v[196:199]
s_waitcnt vmcnt(1)
v_mfma_f32_16x16x32_bf16 v[196:199],v[156:159],v[184:187],v[196:199]
ds_write_b128 v6,v[192:195]
s_waitcnt vmcnt(0)
v_mfma_f32_16x16x32_bf16 v[196:199],v[156:159],v[188:191],v[196:199]
s_nop 7
ds_write_b128 v6,v[196:199] offset:2048
s_waitcnt lgkmcnt(0)
s_barrier
buffer_store_dword v20,off,s[8:11],s73 sc1
s_mov_b32 s73,0x80000000
s_mov_b32 s27,2
L_aa_77:
s_cmp_lg_u32 s31,0
s_cbranch_scc1 L_ar_108
s_bitcmp1_b32 s46,0
s_cbranch_scc1 L_ar_107
L_ar_106:
ds_read_b128 v[160:163],v23
ds_read_b128 v[164:167],v23 offset:16
v_lshlrev_b32 v200,16,v224
v_and_b32 v201,0xffff0000,v224
v_lshlrev_b32 v202,16,v225
v_and_b32 v203,0xffff0000,v225
v_lshlrev_b32 v204,16,v226
v_and_b32 v205,0xffff0000,v226
v_lshlrev_b32 v206,16,v227
v_and_b32 v207,0xffff0000,v227
s_lshl_b32 s18,s51,5
s_add_u32 s18,s18,s68
s_lshl_b32 s19,s18,10
s_add_u32 s20,s19,8388608
s_waitcnt lgkmcnt(0)
v_cvt_pk_bf16_f32 v168,v160,v161
v_cvt_pk_bf16_f32 v169,v162,v163
v_cvt_pk_bf16_f32 v170,v164,v165
v_cvt_pk_bf16_f32 v171,v166,v167
v_lshlrev_b32 v160,16,v168
v_and_b32 v161,0xffff0000,v168
v_lshlrev_b32 v162,16,v169
v_and_b32 v163,0xffff0000,v169
v_lshlrev_b32 v164,16,v170
v_and_b32 v165,0xffff0000,v170
v_lshlrev_b32 v166,16,v171
v_and_b32 v167,0xffff0000,v171
v_pk_add_f32 v[200:201],v[200:201],v[160:161]
v_pk_add_f32 v[202:203],v[202:203],v[162:163]
v_pk_add_f32 v[204:205],v[204:205],v[164:165]
v_pk_add_f32 v[206:207],v[206:207],v[166:167]
v_cvt_pk_bf16_f32 v168,v200,v201
v_cvt_pk_bf16_f32 v169,v202,v203
v_cvt_pk_bf16_f32 v170,v204,v205
v_cvt_pk_bf16_f32 v171,v206,v207
v_lshlrev_b32 v200,16,v168
v_and_b32 v201,0xffff0000,v168
v_lshlrev_b32 v202,16,v169
v_and_b32 v203,0xffff0000,v169
v_lshlrev_b32 v204,16,v170
v_and_b32 v205,0xffff0000,v170
v_lshlrev_b32 v206,16,v171
v_and_b32 v207,0xffff0000,v171
v_readfirstlane_b32 s78,v200
s_nop 1
v_pk_add_f32 v[184:185],v[200:201],s[78:79] op_sel_hi:[1,0] neg_lo:[0,1] neg_hi:[0,1]
v_pk_add_f32 v[186:187],v[202:203],s[78:79] op_sel_hi:[1,0] neg_lo:[0,1] neg_hi:[0,1]
v_pk_add_f32 v[188:189],v[204:205],s[78:79] op_sel_hi:[1,0] neg_lo:[0,1] neg_hi:[0,1]
v_pk_add_f32 v[190:191],v[206:207],s[78:79] op_sel_hi:[1,0] neg_lo:[0,1] neg_hi:[0,1]
v_pk_add_f32 v[192:193],v[184:185],v[186:187]
v_pk_mul_f32 v[194:195],v[184:185],v[184:185]
v_pk_add_f32 v[196:197],v[188:189],v[190:191]
v_pk_fma_f32 v[194:195],v[186:187],v[186:187],v[194:195]
v_pk_add_f32 v[192:193],v[192:193],v[196:197]
v_pk_fma_f32 v[194:195],v[188:189],v[188:189],v[194:195]
v_add_f32 v192,v192,v193
v_pk_fma_f32 v[194:195],v[190:191],v[190:191],v[194:195]
v_add_f32 v194,v194,v195
s_nop 1
v_permlane32_swap_b32 v192,v194
v_add_f32 v192,v192,v194
s_nop 1
v_add_f32_dpp v192,v192,v192 row_ror:8 row_mask:0xf bank_mask:0xf
s_nop 1
v_add_f32_dpp v192,v192,v192 row_ror:4 row_mask:0xf bank_mask:0xf
s_nop 1
v_add_f32_dpp v192,v192,v192 row_ror:2 row_mask:0xf bank_mask:0xf
s_nop 1
v_add_f32_dpp v192,v192,v192 row_ror:1 row_mask:0xf bank_mask:0xf
v_mov_b32 v194,v192
s_nop 1
v_permlane16_swap_b32 v192,v194
v_add_f32 v192,v192,v194
v_mul_f32 v192,0x3b000000,v192
v_mov_b32 v194,v192
s_nop 1
v_permlane32_swap_b32 v192,v194
v_fma_f32 v194,-v192,v192,v194
v_add_f32 v192,s78,v192
v_max_f32 v194,0,v194
v_cvt_pk_bf16_f32 v194,v192,v194
v_lshlrev_b32 v192,16,v194
v_and_b32 v194,0xffff0000,v194
v_add_f32 v194,0x3727c5ac,v194
v_cvt_pk_bf16_f32 v194,v194,v194
v_and_b32 v194,0xffff0000,v194
v_sqrt_f32 v194,v194
v_pk_add_f32 v[184:185],v[200:201],v[192:193] op_sel_hi:[1,0] neg_lo:[0,1] neg_hi:[0,1]
v_pk_add_f32 v[186:187],v[202:203],v[192:193] op_sel_hi:[1,0] neg_lo:[0,1] neg_hi:[0,1]
v_pk_add_f32 v[188:189],v[204:205],v[192:193] op_sel_hi:[1,0] neg_lo:[0,1] neg_hi:[0,1]
v_pk_add_f32 v[190:191],v[206:207],v[192:193] op_sel_hi:[1,0] neg_lo:[0,1] neg_hi:[0,1]
v_cvt_pk_bf16_f32 v194,v194,v194
v_and_b32 v194,0xffff0000,v194
v_rcp_f32 v194,v194
v_cvt_pk_bf16_f32 v172,v184,v185
v_cvt_pk_bf16_f32 v173,v186,v187
v_cvt_pk_bf16_f32 v174,v188,v189
v_cvt_pk_bf16_f32 v175,v190,v191
v_lshlrev_b32 v184,16,v172
v_and_b32 v185,0xffff0000,v172
v_lshlrev_b32 v186,16,v173
v_and_b32 v187,0xffff0000,v173
v_lshlrev_b32 v188,16,v174
v_and_b32 v189,0xffff0000,v174
v_lshlrev_b32 v190,16,v175
v_and_b32 v191,0xffff0000,v175
v_pk_mul_f32 v[184:185],v[184:185],v[194:195] op_sel_hi:[1,0]
v_pk_mul_f32 v[186:187],v[186:187],v[194:195] op_sel_hi:[1,0]
v_pk_mul_f32 v[188:189],v[188:189],v[194:195] op_sel_hi:[1,0]
v_pk_mul_f32 v[190:191],v[190:191],v[194:195] op_sel_hi:[1,0]
v_cvt_pk_bf16_f32 v172,v184,v185
v_cvt_pk_bf16_f32 v173,v186,v187
v_cvt_pk_bf16_f32 v174,v188,v189
v_cvt_pk_bf16_f32 v175,v190,v191
v_lshlrev_b32 v176,16,v172
v_and_b32 v177,0xffff0000,v172
v_lshlrev_b32 v178,16,v173
v_and_b32 v179,0xffff0000,v173
v_lshlrev_b32 v180,16,v174
v_and_b32 v181,0xffff0000,v174
v_lshlrev_b32 v182,16,v175
v_and_b32 v183,0xffff0000,v175
v_pk_add_f32 v[200:201],v[200:201],v[176:177]
v_pk_add_f32 v[202:203],v[202:203],v[178:179]
v_pk_add_f32 v[204:205],v[204:205],v[180:181]
v_pk_add_f32 v[206:207],v[206:207],v[182:183]
v_cvt_pk_bf16_f32 v160,v200,v201
v_cvt_pk_bf16_f32 v161,v202,v203
v_cvt_pk_bf16_f32 v162,v204,v205
v_cvt_pk_bf16_f32 v163,v206,v207
buffer_store_dwordx4 v[160:163],v0,s[8:11],s20 offen sc1
v_lshlrev_b32 v200,16,v160
v_and_b32 v201,0xffff0000,v160
v_lshlrev_b32 v202,16,v161
v_and_b32 v203,0xffff0000,v161
v_lshlrev_b32 v204,16,v162
v_and_b32 v205,0xffff0000,v162
v_lshlrev_b32 v206,16,v163
v_and_b32 v207,0xffff0000,v163
v_readfirstlane_b32 s78,v200
s_nop 1
v_pk_add_f32 v[184:185],v[200:201],s[78:79] op_sel_hi:[1,0] neg_lo:[0,1] neg_hi:[0,1]
v_pk_add_f32 v[186:187],v[202:203],s[78:79] op_sel_hi:[1,0] neg_lo:[0,1] neg_hi:[0,1]
v_pk_add_f32 v[188:189],v[204:205],s[78:79] op_sel_hi:[1,0] neg_lo:[0,1] neg_hi:[0,1]
v_pk_add_f32 v[190:191],v[206:207],s[78:79] op_sel_hi:[1,0] neg_lo:[0,1] neg_hi:[0,1]
v_pk_add_f32 v[192:193],v[184:185],v[186:187]
v_pk_mul_f32 v[194:195],v[184:185],v[184:185]
v_pk_add_f32 v[196:197],v[188:189],v[190:191]
v_pk_fma_f32 v[194:195],v[186:187],v[186:187],v[194:195]
v_pk_add_f32 v[192:193],v[192:193],v[196:197]
v_pk_fma_f32 v[194:195],v[188:189],v[188:189],v[194:195]
v_add_f32 v192,v192,v193
v_pk_fma_f32 v[194:195],v[190:191],v[190:191],v[194:195]
v_add_f32 v194,v194,v195
s_nop 1
v_permlane32_swap_b32 v192,v194
v_add_f32 v192,v192,v194
s_nop 1
v_add_f32_dpp v192,v192,v192 row_ror:8 row_mask:0xf bank_mask:0xf
s_nop 1
v_add_f32_dpp v192,v192,v192 row_ror:4 row_mask:0xf bank_mask:0xf
s_nop 1
v_add_f32_dpp v192,v192,v192 row_ror:2 row_mask:0xf bank_mask:0xf
s_nop 1
v_add_f32_dpp v192,v192,v192 row_ror:1 row_mask:0xf bank_mask:0xf
v_mov_b32 v194,v192
s_nop 1
v_permlane16_swap_b32 v192,v194
v_add_f32 v192,v192,v194
v_mul_f32 v192,0x3b000000,v192
v_mov_b32 v194,v192
s_nop 1
v_permlane32_swap_b32 v192,v194
v_fma_f32 v194,-v192,v192,v194
v_add_f32 v192,s78,v192
v_max_f32 v194,0,v194
v_cvt_pk_bf16_f32 v194,v192,v194
v_lshlrev_b32 v192,16,v194
v_and_b32 v194,0xffff0000,v194
v_add_f32 v194,0x3727c5ac,v194
v_cvt_pk_bf16_f32 v194,v194,v194
v_and_b32 v194,0xffff0000,v194
v_sqrt_f32 v194,v194
v_pk_add_f32 v[184:185],v[200:201],v[192:193] op_sel_hi:[1,0] neg_lo:[0,1] neg_hi:[0,1]
v_pk_add_f32 v[186:187],v[202:203],v[192:193] op_sel_hi:[1,0] neg_lo:[0,1] neg_hi:[0,1]
v_pk_add_f32 v[188:189],v[204:205],v[192:193] op_sel_hi:[1,0] neg_lo:[0,1] neg_hi:[0,1]
v_pk_add_f32 v[190:191],v[206:207],v[192:193] op_sel_hi:[1,0] neg_lo:[0,1] neg_hi:[0,1]
v_cvt_pk_bf16_f32 v194,v194,v194
v_and_b32 v194,0xffff0000,v194
v_rcp_f32 v194,v194
v_cvt_pk_bf16_f32 v164,v184,v185
v_cvt_pk_bf16_f32 v165,v186,v187
v_cvt_pk_bf16_f32 v166,v188,v189
v_cvt_pk_bf16_f32 v167,v190,v191
v_lshlrev_b32 v184,16,v164
v_and_b32 v185,0xffff0000,v164
v_lshlrev_b32 v186,16,v165
v_and_b32 v187,0xffff0000,v165
v_lshlrev_b32 v188,16,v166
v_and_b32 v189,0xffff0000,v166
v_lshlrev_b32 v190,16,v167
v_and_b32 v191,0xffff0000,v167
v_pk_mul_f32 v[184:185],v[184:185],v[194:195] op_sel_hi:[1,0]
v_pk_mul_f32 v[186:187],v[186:187],v[194:195] op_sel_hi:[1,0]
v_pk_mul_f32 v[188:189],v[188:189],v[194:195] op_sel_hi:[1,0]
v_pk_mul_f32 v[190:191],v[190:191],v[194:195] op_sel_hi:[1,0]
v_cvt_pk_bf16_f32 v164,v184,v185
v_cvt_pk_bf16_f32 v165,v186,v187
v_cvt_pk_bf16_f32 v166,v188,v189
v_cvt_pk_bf16_f32 v167,v190,v191
s_add_u32 s20,s19,2097152
buffer_store_dwordx4 v[164:167],v0,s[8:11],s20 offen sc1
v_mov_b32 v20,1
s_lshl_b32 s73,s51,13
s_lshl2_add_u32 s73,s68,s73
s_add_u32 s73,s73,10487552
s_branch L_aa_78
L_ar_107:
ds_read_b128 v[160:163],v23
ds_read_b128 v[164:167],v23 offset:16
v_lshlrev_b32 v200,16,v224
v_and_b32 v201,0xffff0000,v224
v_lshlrev_b32 v202,16,v225
v_and_b32 v203,0xffff0000,v225
v_lshlrev_b32 v204,16,v226
v_and_b32 v205,0xffff0000,v226
v_lshlrev_b32 v206,16,v227
v_and_b32 v207,0xffff0000,v227
s_lshl_b32 s18,s51,5
s_add_u32 s18,s18,s68
s_lshl_b32 s19,s18,10
s_add_u32 s20,s19,4194304
s_waitcnt lgkmcnt(0)
v_cvt_pk_bf16_f32 v168,v160,v161
v_cvt_pk_bf16_f32 v169,v162,v163
v_cvt_pk_bf16_f32 v170,v164,v165
v_cvt_pk_bf16_f32 v171,v166,v167
v_lshlrev_b32 v160,16,v168
v_and_b32 v161,0xffff0000,v168
v_lshlrev_b32 v162,16,v169
v_and_b32 v163,0xffff0000,v169
v_lshlrev_b32 v164,16,v170
v_and_b32 v165,0xffff0000,v170
v_lshlrev_b32 v166,16,v171
v_and_b32 v167,0xffff0000,v171
v_pk_add_f32 v[200:201],v[200:201],v[160:161]
v_pk_add_f32 v[202:203],v[202:203],v[162:163]
v_pk_add_f32 v[204:205],v[204:205],v[164:165]
v_pk_add_f32 v[206:207],v[206:207],v[166:167]
v_cvt_pk_bf16_f32 v168,v200,v201
v_cvt_pk_bf16_f32 v169,v202,v203
v_cvt_pk_bf16_f32 v170,v204,v205
v_cvt_pk_bf16_f32 v171,v206,v207
buffer_store_dwordx4 v[168:171],v0,s[8:11],s20 offen sc1
v_lshlrev_b32 v200,16,v168
v_and_b32 v201,0xffff0000,v168
v_lshlrev_b32 v202,16,v169
v_and_b32 v203,0xffff0000,v169
v_lshlrev_b32 v204,16,v170
v_and_b32 v205,0xffff0000,v170
v_lshlrev_b32 v206,16,v171
v_and_b32 v207,0xffff0000,v171
v_readfirstlane_b32 s78,v200
s_nop 1
v_pk_add_f32 v[184:185],v[200:201],s[78:79] op_sel_hi:[1,0] neg_lo:[0,1] neg_hi:[0,1]
v_pk_add_f32 v[186:187],v[202:203],s[78:79] op_sel_hi:[1,0] neg_lo:[0,1] neg_hi:[0,1]
v_pk_add_f32 v[188:189],v[204:205],s[78:79] op_sel_hi:[1,0] neg_lo:[0,1] neg_hi:[0,1]
v_pk_add_f32 v[190:191],v[206:207],s[78:79] op_sel_hi:[1,0] neg_lo:[0,1] neg_hi:[0,1]
v_pk_add_f32 v[192:193],v[184:185],v[186:187]
v_pk_mul_f32 v[194:195],v[184:185],v[184:185]
v_pk_add_f32 v[196:197],v[188:189],v[190:191]
v_pk_fma_f32 v[194:195],v[186:187],v[186:187],v[194:195]
v_pk_add_f32 v[192:193],v[192:193],v[196:197]
v_pk_fma_f32 v[194:195],v[188:189],v[188:189],v[194:195]
v_add_f32 v192,v192,v193
v_pk_fma_f32 v[194:195],v[190:191],v[190:191],v[194:195]
v_add_f32 v194,v194,v195
s_nop 1
v_permlane32_swap_b32 v192,v194
v_add_f32 v192,v192,v194
s_nop 1
v_add_f32_dpp v192,v192,v192 row_ror:8 row_mask:0xf bank_mask:0xf
s_nop 1
v_add_f32_dpp v192,v192,v192 row_ror:4 row_mask:0xf bank_mask:0xf
s_nop 1
v_add_f32_dpp v192,v192,v192 row_ror:2 row_mask:0xf bank_mask:0xf
s_nop 1
v_add_f32_dpp v192,v192,v192 row_ror:1 row_mask:0xf bank_mask:0xf
v_mov_b32 v194,v192
s_nop 1
v_permlane16_swap_b32 v192,v194
v_add_f32 v192,v192,v194
v_mul_f32 v192,0x3b000000,v192
v_mov_b32 v194,v192
s_nop 1
v_permlane32_swap_b32 v192,v194
v_fma_f32 v194,-v192,v192,v194
v_add_f32 v192,s78,v192
v_max_f32 v194,0,v194
v_cvt_pk_bf16_f32 v194,v192,v194
v_lshlrev_b32 v192,16,v194
v_and_b32 v194,0xffff0000,v194
v_add_f32 v194,0x3727c5ac,v194
v_cvt_pk_bf16_f32 v194,v194,v194
v_and_b32 v194,0xffff0000,v194
v_sqrt_f32 v194,v194
v_pk_add_f32 v[184:185],v[200:201],v[192:193] op_sel_hi:[1,0] neg_lo:[0,1] neg_hi:[0,1]
v_pk_add_f32 v[186:187],v[202:203],v[192:193] op_sel_hi:[1,0] neg_lo:[0,1] neg_hi:[0,1]
v_pk_add_f32 v[188:189],v[204:205],v[192:193] op_sel_hi:[1,0] neg_lo:[0,1] neg_hi:[0,1]
v_pk_add_f32 v[190:191],v[206:207],v[192:193] op_sel_hi:[1,0] neg_lo:[0,1] neg_hi:[0,1]
v_cvt_pk_bf16_f32 v194,v194,v194
v_and_b32 v194,0xffff0000,v194
v_rcp_f32 v194,v194
v_cvt_pk_bf16_f32 v172,v184,v185
v_cvt_pk_bf16_f32 v173,v186,v187
v_cvt_pk_bf16_f32 v174,v188,v189
v_cvt_pk_bf16_f32 v175,v190,v191
v_lshlrev_b32 v184,16,v172
v_and_b32 v185,0xffff0000,v172
v_lshlrev_b32 v186,16,v173
v_and_b32 v187,0xffff0000,v173
v_lshlrev_b32 v188,16,v174
v_and_b32 v189,0xffff0000,v174
v_lshlrev_b32 v190,16,v175
v_and_b32 v191,0xffff0000,v175
v_pk_mul_f32 v[184:185],v[184:185],v[194:195] op_sel_hi:[1,0]
v_pk_mul_f32 v[186:187],v[186:187],v[194:195] op_sel_hi:[1,0]
v_pk_mul_f32 v[188:189],v[188:189],v[194:195] op_sel_hi:[1,0]
v_pk_mul_f32 v[190:191],v[190:191],v[194:195] op_sel_hi:[1,0]
v_cvt_pk_bf16_f32 v172,v184,v185
v_cvt_pk_bf16_f32 v173,v186,v187
v_cvt_pk_bf16_f32 v174,v188,v189
v_cvt_pk_bf16_f32 v175,v190,v191
v_lshlrev_b32 v176,16,v172
v_and_b32 v177,0xffff0000,v172
v_lshlrev_b32 v178,16,v173
v_and_b32 v179,0xffff0000,v173
v_lshlrev_b32 v180,16,v174
v_and_b32 v181,0xffff0000,v174
v_lshlrev_b32 v182,16,v175
v_and_b32 v183,0xffff0000,v175
v_pk_mul_f32 v[236:237],v[176:177],v[228:229]
v_pk_fma_f32 v[236:237],v[178:179],v[230:231],v[236:237]
v_pk_fma_f32 v[236:237],v[180:181],v[232:233],v[236:237]
v_pk_fma_f32 v[236:237],v[182:183],v[234:235],v[236:237]
v_add_f32 v236,v236,v237
s_nop 1
v_add_f32_dpp v236,v236,v236 row_ror:8 row_mask:0xf bank_mask:0xf
s_nop 1
v_add_f32_dpp v236,v236,v236 row_ror:4 row_mask:0xf bank_mask:0xf
s_nop 1
v_add_f32_dpp v236,v236,v236 row_ror:2 row_mask:0xf bank_mask:0xf
s_nop 1
v_add_f32_dpp v236,v236,v236 row_ror:1 row_mask:0xf bank_mask:0xf
v_mov_b32 v237,v236
s_nop 1
v_permlane16_swap_b32 v236,v237
v_add_f32 v236,v236,v237
v_mov_b32 v237,v236
s_nop 1
v_permlane32_swap_b32 v236,v237
v_add_f32 v236,v236,v237
v_cvt_pk_bf16_f32 v236,v236,v236
v_and_b32 v236,0xffff0000,v236
v_ashrrev_i32 v237,31,v236
v_or_b32 v237,0x80000000,v237
v_xor_b32 v236,v236,v237
v_and_b32 v236,0xffff0000,v236
s_sub_u32 s20,4095,s18
v_or_b32 v20,s20,v236
s_lshl_b32 s20,s51,13
s_lshl2_add_u32 s20,s68,s20
s_add_u32 s20,s20,10485760
buffer_store_dword v20,v254,s[8:11],s20 offen sc1
s_branch L_aa_78
L_ar_108:
s_bitcmp1_b32 s46,0
s_cbranch_scc1 L_aa_78
ds_read_b128 v[160:163],v23
ds_read_b128 v[164:167],v23 offset:16
v_lshlrev_b32 v200,16,v224
v_and_b32 v201,0xffff0000,v224
v_lshlrev_b32 v202,16,v225
v_and_b32 v203,0xffff0000,v225
v_lshlrev_b32 v204,16,v226
v_and_b32 v205,0xffff0000,v226
v_lshlrev_b32 v206,16,v227
v_and_b32 v207,0xffff0000,v227
v_readfirstlane_b32 s22,v246
s_cmp_eq_u32 s22,0
s_cbranch_scc1 L_ag_109
L_agb_110:
s_lshl_b32 s18,s51,5
s_add_u32 s18,s18,s68
s_lshl_b32 s19,s18,10
s_add_u32 s20,s19,6291456
s_waitcnt lgkmcnt(0)
v_cvt_pk_bf16_f32 v168,v160,v161
v_cvt_pk_bf16_f32 v169,v162,v163
v_cvt_pk_bf16_f32 v170,v164,v165
v_cvt_pk_bf16_f32 v171,v166,v167
v_lshlrev_b32 v160,16,v168
v_and_b32 v161,0xffff0000,v168
v_lshlrev_b32 v162,16,v169
v_and_b32 v163,0xffff0000,v169
v_lshlrev_b32 v164,16,v170
v_and_b32 v165,0xffff0000,v170
v_lshlrev_b32 v166,16,v171
v_and_b32 v167,0xffff0000,v171
v_pk_add_f32 v[200:201],v[200:201],v[160:161]
v_pk_add_f32 v[202:203],v[202:203],v[162:163]
v_pk_add_f32 v[204:205],v[204:205],v[164:165]
v_pk_add_f32 v[206:207],v[206:207],v[166:167]
v_cvt_pk_bf16_f32 v168,v200,v201
v_cvt_pk_bf16_f32 v169,v202,v203
v_cvt_pk_bf16_f32 v170,v204,v205
v_cvt_pk_bf16_f32 v171,v206,v207
buffer_store_dwordx4 v[168:171],v0,s[8:11],s20 offen sc1
v_lshlrev_b32 v200,16,v168
v_and_b32 v201,0xffff0000,v168
v_lshlrev_b32 v202,16,v169
v_and_b32 v203,0xffff0000,v169
v_lshlrev_b32 v204,16,v170
v_and_b32 v205,0xffff0000,v170
v_lshlrev_b32 v206,16,v171
v_and_b32 v207,0xffff0000,v171
v_readfirstlane_b32 s78,v200
s_nop 1
v_pk_add_f32 v[184:185],v[200:201],s[78:79] op_sel_hi:[1,0] neg_lo:[0,1] neg_hi:[0,1]
v_pk_add_f32 v[186:187],v[202:203],s[78:79] op_sel_hi:[1,0] neg_lo:[0,1] neg_hi:[0,1]
v_pk_add_f32 v[188:189],v[204:205],s[78:79] op_sel_hi:[1,0] neg_lo:[0,1] neg_hi:[0,1]
v_pk_add_f32 v[190:191],v[206:207],s[78:79] op_sel_hi:[1,0] neg_lo:[0,1] neg_hi:[0,1]
v_pk_add_f32 v[192:193],v[184:185],v[186:187]
v_pk_mul_f32 v[194:195],v[184:185],v[184:185]
v_pk_add_f32 v[196:197],v[188:189],v[190:191]
v_pk_fma_f32 v[194:195],v[186:187],v[186:187],v[194:195]
v_pk_add_f32 v[192:193],v[192:193],v[196:197]
v_pk_fma_f32 v[194:195],v[188:189],v[188:189],v[194:195]
v_add_f32 v192,v192,v193
v_pk_fma_f32 v[194:195],v[190:191],v[190:191],v[194:195]
v_add_f32 v194,v194,v195
s_nop 1
v_permlane32_swap_b32 v192,v194
v_add_f32 v192,v192,v194
s_nop 1
v_add_f32_dpp v192,v192,v192 row_ror:8 row_mask:0xf bank_mask:0xf
s_nop 1
v_add_f32_dpp v192,v192,v192 row_ror:4 row_mask:0xf bank_mask:0xf
s_nop 1
v_add_f32_dpp v192,v192,v192 row_ror:2 row_mask:0xf bank_mask:0xf
s_nop 1
v_add_f32_dpp v192,v192,v192 row_ror:1 row_mask:0xf bank_mask:0xf
v_mov_b32 v194,v192
s_nop 1
v_permlane16_swap_b32 v192,v194
v_add_f32 v192,v192,v194
v_mul_f32 v192,0x3b000000,v192
v_mov_b32 v194,v192
s_nop 1
v_permlane32_swap_b32 v192,v194
v_fma_f32 v194,-v192,v192,v194
v_add_f32 v192,s78,v192
v_max_f32 v194,0,v194
v_cvt_pk_bf16_f32 v194,v192,v194
v_lshlrev_b32 v192,16,v194
v_and_b32 v194,0xffff0000,v194
v_add_f32 v194,0x3727c5ac,v194
v_cvt_pk_bf16_f32 v194,v194,v194
v_and_b32 v194,0xffff0000,v194
v_sqrt_f32 v194,v194
v_pk_add_f32 v[184:185],v[200:201],v[192:193] op_sel_hi:[1,0] neg_lo:[0,1] neg_hi:[0,1]
v_pk_add_f32 v[186:187],v[202:203],v[192:193] op_sel_hi:[1,0] neg_lo:[0,1] neg_hi:[0,1]
v_pk_add_f32 v[188:189],v[204:205],v[192:193] op_sel_hi:[1,0] neg_lo:[0,1] neg_hi:[0,1]
v_pk_add_f32 v[190:191],v[206:207],v[192:193] op_sel_hi:[1,0] neg_lo:[0,1] neg_hi:[0,1]
v_cvt_pk_bf16_f32 v194,v194,v194
v_and_b32 v194,0xffff0000,v194
v_rcp_f32 v194,v194
v_cvt_pk_bf16_f32 v172,v184,v185
v_cvt_pk_bf16_f32 v173,v186,v187
v_cvt_pk_bf16_f32 v174,v188,v189
v_cvt_pk_bf16_f32 v175,v190,v191
v_lshlrev_b32 v184,16,v172
v_and_b32 v185,0xffff0000,v172
v_lshlrev_b32 v186,16,v173
v_and_b32 v187,0xffff0000,v173
v_lshlrev_b32 v188,16,v174
v_and_b32 v189,0xffff0000,v174
v_lshlrev_b32 v190,16,v175
v_and_b32 v191,0xffff0000,v175
v_pk_mul_f32 v[184:185],v[184:185],v[194:195] op_sel_hi:[1,0]
v_pk_mul_f32 v[186:187],v[186:187],v[194:195] op_sel_hi:[1,0]
v_pk_mul_f32 v[188:189],v[188:189],v[194:195] op_sel_hi:[1,0]
v_pk_mul_f32 v[190:191],v[190:191],v[194:195] op_sel_hi:[1,0]
v_cvt_pk_bf16_f32 v172,v184,v185
v_cvt_pk_bf16_f32 v173,v186,v187
v_cvt_pk_bf16_f32 v174,v188,v189
v_cvt_pk_bf16_f32 v175,v190,v191
v_lshlrev_b32 v176,16,v172
v_and_b32 v177,0xffff0000,v172
v_lshlrev_b32 v178,16,v173
v_and_b32 v179,0xffff0000,v173
v_lshlrev_b32 v180,16,v174
v_and_b32 v181,0xffff0000,v174
v_lshlrev_b32 v182,16,v175
v_and_b32 v183,0xffff0000,v175
v_pk_add_f32 v[200:201],v[200:201],v[176:177]
v_pk_add_f32 v[202:203],v[202:203],v[178:179]
v_pk_add_f32 v[204:205],v[204:205],v[180:181]
v_pk_add_f32 v[206:207],v[206:207],v[182:183]
v_cvt_pk_bf16_f32 v160,v200,v201
v_cvt_pk_bf16_f32 v161,v202,v203
v_cvt_pk_bf16_f32 v162,v204,v205
v_cvt_pk_bf16_f32 v163,v206,v207
buffer_store_dwordx4 v[160:163],v0,s[12:15],s19 offen sc1
v_pk_mul_f32 v[236:237],v[176:177],v[228:229]
v_pk_fma_f32 v[236:237],v[178:179],v[230:231],v[236:237]
v_pk_fma_f32 v[236:237],v[180:181],v[232:233],v[236:237]
v_pk_fma_f32 v[236:237],v[182:183],v[234:235],v[236:237]
v_add_f32 v236,v236,v237
s_nop 1
v_add_f32_dpp v236,v236,v236 row_ror:8 row_mask:0xf bank_mask:0xf
s_nop 1
v_add_f32_dpp v236,v236,v236 row_ror:4 row_mask:0xf bank_mask:0xf
s_nop 1
v_add_f32_dpp v236,v236,v236 row_ror:2 row_mask:0xf bank_mask:0xf
s_nop 1
v_add_f32_dpp v236,v236,v236 row_ror:1 row_mask:0xf bank_mask:0xf
v_mov_b32 v237,v236
s_nop 1
v_permlane16_swap_b32 v236,v237
v_add_f32 v236,v236,v237
v_mov_b32 v237,v236
s_nop 1
v_permlane32_swap_b32 v236,v237
v_add_f32 v236,v236,v237
v_cvt_pk_bf16_f32 v236,v236,v236
v_and_b32 v236,0xffff0000,v236
v_ashrrev_i32 v237,31,v236
v_or_b32 v237,0x80000000,v237
v_xor_b32 v236,v236,v237
v_and_b32 v236,0xffff0000,v236
s_sub_u32 s20,4095,s18
v_or_b32 v20,s20,v236
s_lshl_b32 s73,s51,13
s_lshl2_add_u32 s73,s68,s73
s_add_u32 s73,s73,10485760
s_add_u32 s73,s73,s86
L_aa_78:
s_cmp_eq_u32 s27,1
s_cbranch_scc1 L_ad_111
s_cmp_eq_u32 s27,0
s_cbranch_scc1 L_aa_79
s_cmp_ge_u32 s77,64
s_cbranch_scc1 L_aa_82
L_aa_80:
s_waitcnt vmcnt(0)
buffer_store_dword v20,off,s[8:11],s73 sc1
s_mov_b32 s73,0x80000000
v_mov_b32 v18,0
s_mov_b32 s27,0
L_aw_112:
v_cmp_eq_u32 vcc,0,v18
s_cbranch_vccz L_awd_113
buffer_load_dword v18,v19,s[8:11],0 offen sc1
s_sub_u32 s49,s49,1
s_cbranch_scc1 L_abort
s_waitcnt vmcnt(0)
s_branch L_aw_112
L_awd_113:
s_mov_b32 s64,s70
s_mov_b32 s65,s71
s_and_b32 s57,s46,1
s_mul_i32 s58,s57,12288
s_add_u32 s64,s64,s58
s_lshl_b32 s57,s57,11
s_add_u32 s65,s65,s57
s_and_b32 s59,s50,2048
s_lshl_b32 s59,s59,4
s_xor_b32 s60,s67,65536
s_add_u32 s59,s59,s60
s_add_u32 s58,s58,s59
s_add_u32 s57,s57,s59
s_add_u32 m0,s58,0
s_nop 0
buffer_load_dwordx4 v0,s[8:11],s64 offen offset:0 sc1 lds
buffer_load_dwordx4 v0,s[8:11],s64 offen offset:1024 sc1 lds
buffer_load_dwordx4 v0,s[8:11],s64 offen offset:2048 sc1 lds
buffer_load_dwordx4 v0,s[8:11],s64 offen offset:3072 sc1 lds
s_add_u32 m0,s58,4096
s_add_u32 s64,s64,4096
buffer_load_dwordx4 v0,s[8:11],s64 offen offset:0 sc1 lds
buffer_load_dwordx4 v0,s[8:11],s64 offen offset:1024 sc1 lds
buffer_load_dwordx4 v0,s[8:11],s64 offen offset:2048 sc1 lds
buffer_load_dwordx4 v0,s[8:11],s64 offen offset:3072 sc1 lds
s_add_u32 m0,s58,8192
s_add_u32 s64,s64,4096
buffer_load_dwordx4 v0,s[8:11],s64 offen offset:0 sc1 lds
buffer_load_dwordx4 v0,s[8:11],s64 offen offset:1024 sc1 lds
buffer_load_dwordx4 v0,s[8:11],s64 offen offset:2048 sc1 lds
buffer_load_dwordx4 v0,s[8:11],s64 offen offset:3072 sc1 lds
s_add_u32 m0,s57,24576
s_nop 0
buffer_load_dwordx4 v0,s[8:11],s65 offen offset:0 sc1 lds
buffer_load_dwordx4 v0,s[8:11],s65 offen offset:1024 sc1 lds
v_lshrrev_b32 v244,4,v1
s_sub_u32 s56,s77,8
v_add_u32 v244,s56,v244
v_max_i32 v244,0,v244
v_lshl_add_u32 v244,v244,13,v21
buffer_load_dwordx2 v[242:243],v244,s[8:11],0 offen sc1
s_waitcnt vmcnt(0) lgkmcnt(0)
s_barrier
s_xor_b32 s67,s67,65536
s_and_b32 s56,s50,2048
s_lshl_b32 s56,s56,4
s_add_u32 s56,s56,s67
v_add_u32 v2,s56,v0
v_add_u32 v239,s56,v253
s_and_b32 s56,s50,1024
s_lshl_b32 s56,s56,2
v_add_u32 v238,s56,v2
s_mov_b32 s76,s71
s_mov_b32 s53,s77
ds_read_b128 v[24:27],v238 offset:16384
ds_read_b128 v[40:43],v2 offset:0
ds_read_b128 v[56:59],v2 offset:4096
ds_read_b128 v[28:31],v238 offset:17408
ds_read_b128 v[44:47],v2 offset:1024
ds_read_b128 v[60:63],v2 offset:5120
ds_read_b128 v[32:35],v238 offset:18432
ds_read_b128 v[48:51],v2 offset:2048
ds_read_b128 v[64:67],v2 offset:6144
ds_read_b128 v[36:39],v238 offset:19456
ds_read_b128 v[52:55],v2 offset:3072
ds_read_b128 v[68:71],v2 offset:7168
s_waitcnt lgkmcnt(9)
v_mfma_f32_16x16x32_bf16 v[128:131],v[40:43],v[24:27],v[8:11]
ds_read_b128 v[72:75],v2 offset:24576
v_mfma_f32_16x16x32_bf16 v[132:135],v[56:59],v[24:27],v[12:15]
ds_read_b128 v[76:79],v2 offset:25600
s_waitcnt lgkmcnt(8)
v_mfma_f32_16x16x32_bf16 v[128:131],v[44:47],v[28:31],v[128:131]
ds_read_b128 v[80:83],v2 offset:26624
v_mfma_f32_16x16x32_bf16 v[132:135],v[60:63],v[28:31],v[132:135]
ds_read_b128 v[84:87],v2 offset:27648
s_waitcnt lgkmcnt(7)
v_mfma_f32_16x16x32_bf16 v[128:131],v[48:51],v[32:35],v[128:131]
ds_read_b64 v[120:121],v239 offset:24576
v_mfma_f32_16x16x32_bf16 v[132:135],v[64:67],v[32:35],v[132:135]
ds_read_b64 v[122:123],v239 offset:25600
s_waitcnt lgkmcnt(6)
v_mfma_f32_16x16x32_bf16 v[128:131],v[52:55],v[36:39],v[128:131]
ds_read_b64 v[124:125],v239 offset:26624
v_mfma_f32_16x16x32_bf16 v[132:135],v[68:71],v[36:39],v[132:135]
ds_read_b64 v[126:127],v239 offset:27648
s_waitcnt lgkmcnt(4)
v_mfma_f32_16x16x32_bf16 v[136:139],v[72:75],v[24:27],0
ds_read_b128 v[88:91],v2 offset:8192
ds_read_b128 v[92:95],v2 offset:9216
v_mfma_f32_16x16x32_bf16 v[136:139],v[76:79],v[28:31],v[136:139]
ds_read_b128 v[96:99],v2 offset:10240
ds_read_b128 v[100:103],v2 offset:11264
v_mfma_f32_16x16x32_bf16 v[136:139],v[80:83],v[32:35],v[136:139]
ds_read_b128 v[104:107],v2 offset:12288
ds_read_b128 v[108:111],v2 offset:13312
v_mfma_f32_16x16x32_bf16 v[136:139],v[84:87],v[36:39],v[136:139]
ds_read_b128 v[112:115],v2 offset:14336
ds_read_b128 v[116:119],v2 offset:15360
s_waitcnt lgkmcnt(0)
s_cmp_eq_u32 s30,0
s_cbranch_scc1 L_aa_81
s_cmp_lg_u32 s86,1536
s_cbranch_scc1 L_ae_114
s_mov_b32 s77,s35
s_mov_b32 s30,0
s_lshl_b32 s56,s77,5
s_add_u32 s56,s56,s68
s_mul_i32 s70,s56,24576
s_lshl_b32 s71,s56,12
s_lshl_b32 s59,s77,13
s_lshl2_add_u32 s59,s68,s59
s_add_u32 s59,s59,10485760
s_buffer_load_dword s32,s[8:11],s59
s_mov_b32 s33,1
s_add_u32 s70,s70,100663296
s_add_u32 s71,s71,41943040
v_mov_b32 v19,s59
s_branch L_af_115
L_ae_114:
s_ff1_i32_b64 s77,s[84:85]
s_bitset0_b64 s[84:85],s77
s_min_u32 s77,s77,64
s_lshr_b32 s61,s55,5
s_lshl_b32 s56,s77,5
s_add_u32 s56,s56,s68
s_mul_i32 s70,s56,24576
s_lshl_b32 s71,s56,12
s_lshl_b32 s59,s77,13
s_lshl2_add_u32 s59,s68,s59
s_add_u32 s59,s59,10486144
s_cmp_lt_u32 s77,s61
s_cselect_b32 s57,0,16777216
s_mov_b32 s60,s59
s_buffer_load_dword s33,s[8:11],s60
s_add_u32 s71,s71,s57
s_add_u32 s71,s71,58720256
s_cmp_eq_u32 s77,s61
s_cselect_b32 s57,50331648,0
s_cselect_b32 s58,1536,0
s_add_u32 s59,s59,s58
s_buffer_load_dword s32,s[8:11],s59
s_add_u32 s70,s70,s57
s_add_u32 s70,s70,150994944
v_mov_b32 v19,s59
v_writelane_b32 v19,s60,1
L_af_115:
v_max3_u32 v238,v72,v73,v74
v_max3_u32 v238,v74,v75,v238
v_max3_u32 v238,v76,v77,v238
v_max3_u32 v238,v78,v79,v238
v_max3_u32 v238,v80,v81,v238
v_max3_u32 v238,v82,v83,v238
v_max3_u32 v238,v84,v85,v238
v_max3_u32 v238,v86,v87,v238
v_max3_u32 v238,v120,v121,v238
v_max3_u32 v238,v122,v123,v238
v_max3_u32 v238,v124,v125,v238
v_max3_u32 v238,v126,v127,v238
v_cmp_eq_u32 vcc,-1,v238
s_cbranch_vccnz L_ac_116
L_acb_117:
v_max3_f32 v238,v128,v129,v130
v_max3_f32 v239,v131,v132,v133
v_max3_f32 v238,v134,v135,v238
v_max3_f32 v239,v138,v139,v239
v_max_f32 v238,v238,v239
v_max_f32 v239,v238,v239
v_pk_mul_f32 v[128:129],v[128:129],v[152:153] op_sel_hi:[1,0]
v_pk_mul_f32 v[130:131],v[130:131],v[152:153] op_sel_hi:[1,0]
v_permlane16_swap_b32 v238,v239
v_max_f32 v238,v238,v239
v_max_f32 v239,v238,v239
v_pk_mul_f32 v[132:133],v[132:133],v[152:153] op_sel_hi:[1,0]
v_pk_mul_f32 v[134:135],v[134:135],v[152:153] op_sel_hi:[1,0]
v_permlane32_swap_b32 v238,v239
v_max_f32 v238,v238,v239
v_mul_f32 v238,v152,v238
v_pk_mul_f32 v[138:139],v[138:139],v[152:153] op_sel_hi:[1,0]
v_pk_add_f32 v[128:129],v[128:129],v[238:239] op_sel_hi:[1,0] neg_lo:[0,1] neg_hi:[0,1]
v_pk_add_f32 v[130:131],v[130:131],v[238:239] op_sel_hi:[1,0] neg_lo:[0,1] neg_hi:[0,1]
v_pk_add_f32 v[132:133],v[132:133],v[238:239] op_sel_hi:[1,0] neg_lo:[0,1] neg_hi:[0,1]
v_pk_add_f32 v[134:135],v[134:135],v[238:239] op_sel_hi:[1,0] neg_lo:[0,1] neg_hi:[0,1]
v_pk_add_f32 v[138:139],v[138:139],v[238:239] op_sel_hi:[1,0] neg_lo:[0,1] neg_hi:[0,1]
v_exp_f32 v128,v128
v_exp_f32 v129,v129
v_exp_f32 v130,v130
v_exp_f32 v131,v131
v_exp_f32 v132,v132
v_exp_f32 v133,v133
v_exp_f32 v134,v134
v_exp_f32 v135,v135
v_exp_f32 v138,v138
v_exp_f32 v139,v139
v_pk_add_f32 v[148:149],v[128:129],v[130:131]
v_pk_add_f32 v[150:151],v[132:133],v[134:135]
v_pk_add_f32 v[148:149],v[148:149],v[138:139]
v_pk_add_f32 v[148:149],v[148:149],v[150:151]
v_add_f32 v150,v148,v149
v_add_f32 v151,v148,v149
s_nop 1
v_permlane16_swap_b32 v150,v151
v_add_f32 v148,v150,v151
v_add_f32 v149,v150,v151
s_nop 1
v_permlane32_swap_b32 v148,v149
v_add_f32 v148,v148,v149
v_rcp_f32 v148,v148
s_nop 0
v_pk_mul_f32 v[138:139],v[138:139],v[148:149] op_sel_hi:[1,0]
v_pk_mul_f32 v[128:129],v[128:129],v[148:149] op_sel_hi:[1,0]
v_pk_mul_f32 v[130:131],v[130:131],v[148:149] op_sel_hi:[1,0]
v_pk_mul_f32 v[132:133],v[132:133],v[148:149] op_sel_hi:[1,0]
v_pk_mul_f32 v[134:135],v[134:135],v[148:149] op_sel_hi:[1,0]
v_cvt_pk_bf16_f32 v144,v138,v139
v_cvt_pk_bf16_f32 v147,v138,v139
s_nop 0
v_mfma_f32_16x16x16_bf16 v[24:27],v[120:121],v[144:145],0
v_cvt_pk_bf16_f32 v140,v128,v129
v_mfma_f32_16x16x16_bf16 v[28:31],v[120:121],v[146:147],0
v_cvt_pk_bf16_f32 v141,v130,v131
v_mfma_f32_16x16x16_bf16 v[32:35],v[122:123],v[144:145],0
v_cvt_pk_bf16_f32 v142,v132,v133
v_mfma_f32_16x16x16_bf16 v[36:39],v[122:123],v[146:147],0
v_cvt_pk_bf16_f32 v143,v134,v135
v_mfma_f32_16x16x16_bf16 v[40:43],v[124:125],v[144:145],0
v_mfma_f32_16x16x16_bf16 v[44:47],v[124:125],v[146:147],0
v_mfma_f32_16x16x16_bf16 v[48:51],v[126:127],v[144:145],0
v_mfma_f32_16x16x16_bf16 v[52:55],v[126:127],v[146:147],0
v_mfma_f32_16x16x32_bf16 v[24:27],v[88:91],v[140:143],v[24:27]
v_mfma_f32_16x16x32_bf16 v[28:31],v[92:95],v[140:143],v[28:31]
v_mfma_f32_16x16x32_bf16 v[32:35],v[96:99],v[140:143],v[32:35]
v_mfma_f32_16x16x32_bf16 v[36:39],v[100:103],v[140:143],v[36:39]
v_cvt_pk_bf16_f32 v72,v24,v28
v_cvt_pk_bf16_f32 v73,v25,v29
v_mfma_f32_16x16x32_bf16 v[40:43],v[104:107],v[140:143],v[40:43]
v_cvt_pk_bf16_f32 v74,v26,v30
v_cvt_pk_bf16_f32 v75,v27,v31
v_mfma_f32_16x16x32_bf16 v[44:47],v[108:111],v[140:143],v[44:47]
ds_write_b128 v3,v[72:75] offset:0
v_cvt_pk_bf16_f32 v76,v32,v36
v_cvt_pk_bf16_f32 v77,v33,v37
v_mfma_f32_16x16x32_bf16 v[48:51],v[112:115],v[140:143],v[48:51]
v_cvt_pk_bf16_f32 v78,v34,v38
v_cvt_pk_bf16_f32 v79,v35,v39
v_mfma_f32_16x16x32_bf16 v[52:55],v[116:119],v[140:143],v[52:55]
ds_write_b128 v3,v[76:79] offset:1024
v_cvt_pk_bf16_f32 v80,v40,v44
v_cvt_pk_bf16_f32 v81,v41,v45
v_cvt_pk_bf16_f32 v82,v42,v46
v_cvt_pk_bf16_f32 v83,v43,v47
ds_write_b128 v3,v[80:83] offset:2048
s_nop 1
v_cvt_pk_bf16_f32 v84,v48,v52
v_cvt_pk_bf16_f32 v85,v49,v53
v_cvt_pk_bf16_f32 v86,v50,v54
v_cvt_pk_bf16_f32 v87,v51,v55
ds_write_b128 v3,v[84:87] offset:3072
s_waitcnt lgkmcnt(0)
s_barrier
L_ad_111:
s_mov_b32 s51,s53
s_mov_b32 s31,1
s_branch L_aa_73
L_aa_79:
s_waitcnt vmcnt(0)
buffer_store_dword v20,off,s[8:11],s73 sc1
s_mov_b32 s73,0x80000000
L_aa_81:
s_mov_b32 s51,s53
s_mov_b32 s31,0
s_add_u32 s35,s53,4
s_cmp_lt_u32 s53,5
s_cbranch_scc1 L_ab_118
s_cmp_ge_u32 s53,62
s_cbranch_scc1 L_am_120
L_aw_121:
v_min_u32 v239,v242,v243
v_cmp_eq_u32 vcc,0,v239
s_cbranch_vccz L_awd_122
s_sleep 4
buffer_load_dwordx2 v[242:243],v244,s[8:11],0 offen sc1
s_sub_u32 s49,s49,1
s_cbranch_scc1 L_abort
s_waitcnt vmcnt(0)
s_branch L_aw_121
L_awd_122:
v_max_u32 v242,v242,v243
s_nop 1
v_max_u32_dpp v242,v242,v242 row_ror:8 row_mask:0xf bank_mask:0xf
s_nop 1
v_max_u32_dpp v242,v242,v242 row_ror:4 row_mask:0xf bank_mask:0xf
s_nop 1
v_max_u32_dpp v242,v242,v242 row_ror:2 row_mask:0xf bank_mask:0xf
s_nop 1
v_max_u32_dpp v242,v242,v242 row_ror:1 row_mask:0xf bank_mask:0xf
v_mov_b32 v243,v242
s_nop 1
v_permlane16_swap_b32 v242,v243
v_max_u32 v242,v242,v243
v_mov_b32 v243,v242
s_nop 1
v_permlane32_swap_b32 v242,v243
v_max_u32 v242,v242,v243
s_nop 0
v_readfirstlane_b32 s56,v242
v_readlane_b32 s57,v255,s53
s_max_u32 s75,s75,s56
s_bitcmp0_b64 s[42:43],s53
s_cbranch_scc1 L_ab_118
s_mov_b32 s77,s36
s_and_b32 s55,s75,0x7ff
s_sub_u32 s55,2047,s55
s_cmp_lt_u32 s75,s57
s_cselect_b32 s55,4095,s55
s_lshr_b32 s61,s55,5
s_mov_b32 s30,1
s_lshl_b32 s56,s77,5
s_add_u32 s56,s56,s68
s_mul_i32 s70,s56,24576
s_lshl_b32 s71,s56,12
s_lshl_b32 s59,s77,13
s_lshl2_add_u32 s59,s68,s59
s_add_u32 s59,s59,10486144
s_cmp_lt_u32 s77,s61
s_cselect_b32 s57,0,16777216
s_mov_b32 s60,s59
s_add_u32 s71,s71,s57
s_add_u32 s71,s71,58720256
s_cmp_eq_u32 s77,s61
s_cselect_b32 s57,50331648,0
s_cselect_b32 s58,1536,0
s_add_u32 s59,s59,s58
s_add_u32 s70,s70,s57
s_add_u32 s70,s70,150994944
v_mov_b32 v19,s59
v_writelane_b32 v19,s60,1
s_branch L_aj_119
L_ab_118:
s_mov_b32 s77,s35
s_mov_b32 s30,0
s_lshl_b32 s56,s77,5
s_add_u32 s56,s56,s68
s_mul_i32 s70,s56,24576
s_lshl_b32 s71,s56,12
s_lshl_b32 s59,s77,13
s_lshl2_add_u32 s59,s68,s59
s_add_u32 s59,s59,10485760
s_mov_b32 s33,1
s_add_u32 s70,s70,100663296
s_add_u32 s71,s71,41943040
v_mov_b32 v19,s59
L_aj_119:
buffer_load_dword v18,v19,s[8:11],0 offen sc1
s_waitcnt vmcnt(2)
v_mfma_f32_16x16x32_bf16 v[136:139],v[72:75],v[24:27],0
v_max3_u32 v238,v72,v73,v74
v_max3_u32 v238,v74,v75,v238
v_mfma_f32_16x16x32_bf16 v[136:139],v[76:79],v[28:31],v[136:139]
v_max3_u32 v238,v76,v77,v238
v_max3_u32 v238,v78,v79,v238
v_mfma_f32_16x16x32_bf16 v[136:139],v[80:83],v[32:35],v[136:139]
v_max3_u32 v238,v80,v81,v238
v_max3_u32 v238,v82,v83,v238
v_mfma_f32_16x16x32_bf16 v[136:139],v[84:87],v[36:39],v[136:139]
v_max3_u32 v238,v84,v85,v238
v_max3_u32 v238,v86,v87,v238
v_max3_u32 v238,v120,v121,v238
v_max3_u32 v238,v122,v123,v238
v_max3_u32 v238,v124,v125,v238
v_max3_u32 v238,v126,v127,v238
v_cmp_eq_u32 vcc,-1,v238
s_cbranch_vccz L_aa_84
L_aa_83:
buffer_load_dwordx4 v[72:75],v0,s[8:11],s76 offen offset:0 sc1
buffer_load_dwordx4 v[76:79],v0,s[8:11],s76 offen offset:1024 sc1
buffer_load_dwordx4 v[80:83],v0,s[8:11],s76 offen offset:2048 sc1
buffer_load_dwordx4 v[84:87],v0,s[8:11],s76 offen offset:3072 sc1
buffer_load_dwordx2 v[120:121],v253,s[8:11],s76 offen offset:0 sc1
buffer_load_dwordx2 v[122:123],v253,s[8:11],s76 offen offset:1024 sc1
buffer_load_dwordx2 v[124:125],v253,s[8:11],s76 offen offset:2048 sc1
buffer_load_dwordx2 v[126:127],v253,s[8:11],s76 offen offset:3072 sc1
buffer_load_dword v18,v19,s[8:11],0 offen sc1
s_sub_u32 s49,s49,1
s_cbranch_scc1 L_abort
s_waitcnt vmcnt(8)
v_mfma_f32_16x16x32_bf16 v[136:139],v[72:75],v[24:27],0
v_max3_u32 v238,v72,v73,v74
v_max3_u32 v238,v74,v75,v238
s_waitcnt vmcnt(7)
v_mfma_f32_16x16x32_bf16 v[136:139],v[76:79],v[28:31],v[136:139]
v_max3_u32 v238,v76,v77,v238
v_max3_u32 v238,v78,v79,v238
s_waitcnt vmcnt(6)
v_mfma_f32_16x16x32_bf16 v[136:139],v[80:83],v[32:35],v[136:139]
v_max3_u32 v238,v80,v81,v238
v_max3_u32 v238,v82,v83,v238
s_waitcnt vmcnt(5)
v_mfma_f32_16x16x32_bf16 v[136:139],v[84:87],v[36:39],v[136:139]
v_max3_u32 v238,v84,v85,v238
v_max3_u32 v238,v86,v87,v238
s_waitcnt vmcnt(1)
v_max3_u32 v238,v120,v121,v238
v_max3_u32 v238,v122,v123,v238
v_max3_u32 v238,v124,v125,v238
v_max3_u32 v238,v126,v127,v238
v_cmp_eq_u32 vcc,-1,v238
s_cbranch_vccnz L_aa_83
L_aa_84:
s_cmp_lg_u32 s27,3
s_cbranch_scc1 L_ai_123
v_max3_f32 v238,v128,v129,v130
v_max3_f32 v239,v131,v132,v133
v_max3_f32 v238,v134,v135,v238
v_max3_f32 v239,v138,v139,v239
v_max_f32 v238,v238,v239
v_max_f32 v239,v238,v239
v_pk_mul_f32 v[128:129],v[128:129],v[152:153] op_sel_hi:[1,0]
v_pk_mul_f32 v[130:131],v[130:131],v[152:153] op_sel_hi:[1,0]
v_permlane16_swap_b32 v238,v239
v_max_f32 v238,v238,v239
v_max_f32 v239,v238,v239
v_pk_mul_f32 v[132:133],v[132:133],v[152:153] op_sel_hi:[1,0]
v_pk_mul_f32 v[134:135],v[134:135],v[152:153] op_sel_hi:[1,0]
v_permlane32_swap_b32 v238,v239
v_max_f32 v238,v238,v239
v_mul_f32 v238,v152,v238
v_pk_mul_f32 v[138:139],v[138:139],v[152:153] op_sel_hi:[1,0]
buffer_load_dword v17,v16,s[8:11],s87 offen sc1
v_pk_add_f32 v[128:129],v[128:129],v[238:239] op_sel_hi:[1,0] neg_lo:[0,1] neg_hi:[0,1]
v_pk_add_f32 v[130:131],v[130:131],v[238:239] op_sel_hi:[1,0] neg_lo:[0,1] neg_hi:[0,1]
v_pk_add_f32 v[132:133],v[132:133],v[238:239] op_sel_hi:[1,0] neg_lo:[0,1] neg_hi:[0,1]
v_pk_add_f32 v[134:135],v[134:135],v[238:239] op_sel_hi:[1,0] neg_lo:[0,1] neg_hi:[0,1]
v_pk_add_f32 v[138:139],v[138:139],v[238:239] op_sel_hi:[1,0] neg_lo:[0,1] neg_hi:[0,1]
v_exp_f32 v128,v128
v_exp_f32 v129,v129
v_exp_f32 v130,v130
v_exp_f32 v131,v131
v_exp_f32 v132,v132
v_exp_f32 v133,v133
v_exp_f32 v134,v134
v_exp_f32 v135,v135
v_exp_f32 v138,v138
v_exp_f32 v139,v139
v_pk_add_f32 v[148:149],v[128:129],v[130:131]
v_pk_add_f32 v[150:151],v[132:133],v[134:135]
v_pk_add_f32 v[148:149],v[148:149],v[138:139]
v_pk_add_f32 v[148:149],v[148:149],v[150:151]
v_add_f32 v150,v148,v149
v_add_f32 v151,v148,v149
s_nop 1
v_permlane16_swap_b32 v150,v151
v_add_f32 v148,v150,v151
v_add_f32 v149,v150,v151
s_nop 1
v_permlane32_swap_b32 v148,v149
v_add_f32 v148,v148,v149
v_rcp_f32 v148,v148
s_waitcnt vmcnt(0)
v_cmp_gt_u32 vcc,s66,v17
v_pk_mul_f32 v[138:139],v[138:139],v[148:149] op_sel_hi:[1,0]
v_pk_mul_f32 v[128:129],v[128:129],v[148:149] op_sel_hi:[1,0]
v_pk_mul_f32 v[130:131],v[130:131],v[148:149] op_sel_hi:[1,0]
v_pk_mul_f32 v[132:133],v[132:133],v[148:149] op_sel_hi:[1,0]
v_pk_mul_f32 v[134:135],v[134:135],v[148:149] op_sel_hi:[1,0]
s_cbranch_vccnz L_ap_124
L_apb_125:
s_xor_b32 s34,s69,524288
buffer_load_dwordx4 v[192:195],v7,s[8:11],s34 offen sc1
v_cvt_pk_bf16_f32 v144,v138,v139
v_cvt_pk_bf16_f32 v147,v138,v139
s_nop 0
v_mfma_f32_16x16x16_bf16 v[24:27],v[120:121],v[144:145],0
s_add_u32 s34,s34,4096
v_cvt_pk_bf16_f32 v140,v128,v129
v_mfma_f32_16x16x16_bf16 v[28:31],v[120:121],v[146:147],0
buffer_load_dwordx4 v[196:199],v7,s[8:11],s34 offen sc1
v_cvt_pk_bf16_f32 v141,v130,v131
v_mfma_f32_16x16x16_bf16 v[32:35],v[122:123],v[144:145],0
s_add_u32 s34,s34,4096
v_cvt_pk_bf16_f32 v142,v132,v133
v_mfma_f32_16x16x16_bf16 v[36:39],v[122:123],v[146:147],0
buffer_load_dwordx4 v[200:203],v7,s[8:11],s34 offen sc1
v_cvt_pk_bf16_f32 v143,v134,v135
v_mfma_f32_16x16x16_bf16 v[40:43],v[124:125],v[144:145],0
s_add_u32 s34,s34,4096
v_mfma_f32_16x16x16_bf16 v[44:47],v[124:125],v[146:147],0
buffer_load_dwordx4 v[204:207],v7,s[8:11],s34 offen sc1
v_mfma_f32_16x16x16_bf16 v[48:51],v[126:127],v[144:145],0
s_add_u32 s34,s34,4096
v_mfma_f32_16x16x16_bf16 v[52:55],v[126:127],v[146:147],0
buffer_load_dwordx4 v[208:211],v7,s[8:11],s34 offen sc1
v_mfma_f32_16x16x32_bf16 v[24:27],v[88:91],v[140:143],v[24:27]
s_add_u32 s34,s34,4096
v_mfma_f32_16x16x32_bf16 v[28:31],v[92:95],v[140:143],v[28:31]
buffer_load_dwordx4 v[212:215],v7,s[8:11],s34 offen sc1
v_mfma_f32_16x16x32_bf16 v[32:35],v[96:99],v[140:143],v[32:35]
s_add_u32 s34,s34,4096
v_mfma_f32_16x16x32_bf16 v[36:39],v[100:103],v[140:143],v[36:39]
buffer_load_dwordx4 v[216:219],v7,s[8:11],s34 offen sc1
v_cvt_pk_bf16_f32 v72,v24,v28
v_cvt_pk_bf16_f32 v73,v25,v29
v_mfma_f32_16x16x32_bf16 v[40:43],v[104:107],v[140:143],v[40:43]
s_add_u32 s34,s34,4096
v_cvt_pk_bf16_f32 v74,v26,v30
v_cvt_pk_bf16_f32 v75,v27,v31
v_mfma_f32_16x16x32_bf16 v[44:47],v[108:111],v[140:143],v[44:47]
ds_write_b128 v3,v[72:75] offset:0
v_cvt_pk_bf16_f32 v76,v32,v36
v_cvt_pk_bf16_f32 v77,v33,v37
v_mfma_f32_16x16x32_bf16 v[48:51],v[112:115],v[140:143],v[48:51]
buffer_load_dwordx4 v[220:223],v7,s[8:11],s34 offen sc1
v_cvt_pk_bf16_f32 v78,v34,v38
v_cvt_pk_bf16_f32 v79,v35,v39
v_mfma_f32_16x16x32_bf16 v[52:55],v[116:119],v[140:143],v[52:55]
ds_write_b128 v3,v[76:79] offset:1024
v_cvt_pk_bf16_f32 v80,v40,v44
v_cvt_pk_bf16_f32 v81,v41,v45
v_cvt_pk_bf16_f32 v82,v42,v46
v_cvt_pk_bf16_f32 v83,v43,v47
ds_write_b128 v3,v[80:83] offset:2048
s_nop 1
v_cvt_pk_bf16_f32 v84,v48,v52
v_cvt_pk_bf16_f32 v85,v49,v53
v_cvt_pk_bf16_f32 v86,v50,v54
v_cvt_pk_bf16_f32 v87,v51,v55
ds_write_b128 v3,v[84:87] offset:3072
v_readlane_b32 s32,v18,0
v_readlane_b32 s33,v18,1
s_waitcnt lgkmcnt(0)
s_barrier
s_branch L_aa_86
L_ai_123:
v_max3_f32 v238,v128,v129,v130
v_max3_f32 v239,v131,v132,v133
v_max3_f32 v238,v134,v135,v238
v_max3_f32 v239,v138,v139,v239
v_max_f32 v238,v238,v239
v_max_f32 v239,v238,v239
v_pk_mul_f32 v[128:129],v[128:129],v[152:153] op_sel_hi:[1,0]
v_pk_mul_f32 v[130:131],v[130:131],v[152:153] op_sel_hi:[1,0]
v_permlane16_swap_b32 v238,v239
v_max_f32 v238,v238,v239
v_max_f32 v239,v238,v239
v_pk_mul_f32 v[132:133],v[132:133],v[152:153] op_sel_hi:[1,0]
v_pk_mul_f32 v[134:135],v[134:135],v[152:153] op_sel_hi:[1,0]
v_permlane32_swap_b32 v238,v239
v_max_f32 v238,v238,v239
v_mul_f32 v238,v152,v238
v_pk_mul_f32 v[138:139],v[138:139],v[152:153] op_sel_hi:[1,0]
v_pk_add_f32 v[128:129],v[128:129],v[238:239] op_sel_hi:[1,0] neg_lo:[0,1] neg_hi:[0,1]
v_pk_add_f32 v[130:131],v[130:131],v[238:239] op_sel_hi:[1,0] neg_lo:[0,1] neg_hi:[0,1]
v_pk_add_f32 v[132:133],v[132:133],v[238:239] op_sel_hi:[1,0] neg_lo:[0,1] neg_hi:[0,1]
v_pk_add_f32 v[134:135],v[134:135],v[238:239] op_sel_hi:[1,0] neg_lo:[0,1] neg_hi:[0,1]
v_pk_add_f32 v[138:139],v[138:139],v[238:239] op_sel_hi:[1,0] neg_lo:[0,1] neg_hi:[0,1]
v_exp_f32 v128,v128
v_exp_f32 v129,v129
v_exp_f32 v130,v130
v_exp_f32 v131,v131
v_exp_f32 v132,v132
v_exp_f32 v133,v133
v_exp_f32 v134,v134
v_exp_f32 v135,v135
v_exp_f32 v138,v138
v_exp_f32 v139,v139
v_pk_add_f32 v[148:149],v[128:129],v[130:131]
v_pk_add_f32 v[150:151],v[132:133],v[134:135]
v_pk_add_f32 v[148:149],v[148:149],v[138:139]
v_pk_add_f32 v[148:149],v[148:149],v[150:151]
v_add_f32 v150,v148,v149
v_add_f32 v151,v148,v149
s_nop 1
v_permlane16_swap_b32 v150,v151
v_add_f32 v148,v150,v151
v_add_f32 v149,v150,v151
s_nop 1
v_permlane32_swap_b32 v148,v149
v_add_f32 v148,v148,v149
v_rcp_f32 v148,v148
s_nop 0
v_pk_mul_f32 v[138:139],v[138:139],v[148:149] op_sel_hi:[1,0]
v_pk_mul_f32 v[128:129],v[128:129],v[148:149] op_sel_hi:[1,0]
v_pk_mul_f32 v[130:131],v[130:131],v[148:149] op_sel_hi:[1,0]
v_pk_mul_f32 v[132:133],v[132:133],v[148:149] op_sel_hi:[1,0]
v_pk_mul_f32 v[134:135],v[134:135],v[148:149] op_sel_hi:[1,0]
v_cvt_pk_bf16_f32 v144,v138,v139
v_cvt_pk_bf16_f32 v147,v138,v139
s_nop 0
v_mfma_f32_16x16x16_bf16 v[24:27],v[120:121],v[144:145],0
v_cvt_pk_bf16_f32 v140,v128,v129
v_mfma_f32_16x16x16_bf16 v[28:31],v[120:121],v[146:147],0
v_cvt_pk_bf16_f32 v141,v130,v131
v_mfma_f32_16x16x16_bf16 v[32:35],v[122:123],v[144:145],0
v_cvt_pk_bf16_f32 v142,v132,v133
v_mfma_f32_16x16x16_bf16 v[36:39],v[122:123],v[146:147],0
v_cvt_pk_bf16_f32 v143,v134,v135
v_mfma_f32_16x16x16_bf16 v[40:43],v[124:125],v[144:145],0
v_mfma_f32_16x16x16_bf16 v[44:47],v[124:125],v[146:147],0
v_mfma_f32_16x16x16_bf16 v[48:51],v[126:127],v[144:145],0
v_mfma_f32_16x16x16_bf16 v[52:55],v[126:127],v[146:147],0
v_mfma_f32_16x16x32_bf16 v[24:27],v[88:91],v[140:143],v[24:27]
v_mfma_f32_16x16x32_bf16 v[28:31],v[92:95],v[140:143],v[28:31]
v_mfma_f32_16x16x32_bf16 v[32:35],v[96:99],v[140:143],v[32:35]
v_mfma_f32_16x16x32_bf16 v[36:39],v[100:103],v[140:143],v[36:39]
v_cvt_pk_bf16_f32 v72,v24,v28
v_cvt_pk_bf16_f32 v73,v25,v29
v_mfma_f32_16x16x32_bf16 v[40:43],v[104:107],v[140:143],v[40:43]
v_cvt_pk_bf16_f32 v74,v26,v30
v_cvt_pk_bf16_f32 v75,v27,v31
v_mfma_f32_16x16x32_bf16 v[44:47],v[108:111],v[140:143],v[44:47]
ds_write_b128 v3,v[72:75] offset:0
v_cvt_pk_bf16_f32 v76,v32,v36
v_cvt_pk_bf16_f32 v77,v33,v37
v_mfma_f32_16x16x32_bf16 v[48:51],v[112:115],v[140:143],v[48:51]
v_cvt_pk_bf16_f32 v78,v34,v38
v_cvt_pk_bf16_f32 v79,v35,v39
v_mfma_f32_16x16x32_bf16 v[52:55],v[116:119],v[140:143],v[52:55]
ds_write_b128 v3,v[76:79] offset:1024
v_cvt_pk_bf16_f32 v80,v40,v44
v_cvt_pk_bf16_f32 v81,v41,v45
v_cvt_pk_bf16_f32 v82,v42,v46
v_cvt_pk_bf16_f32 v83,v43,v47
ds_write_b128 v3,v[80:83] offset:2048
s_nop 1
v_cvt_pk_bf16_f32 v84,v48,v52
v_cvt_pk_bf16_f32 v85,v49,v53
v_cvt_pk_bf16_f32 v86,v50,v54
v_cvt_pk_bf16_f32 v87,v51,v55
ds_write_b128 v3,v[84:87] offset:3072
s_waitcnt vmcnt(0)
v_readlane_b32 s32,v18,0
v_readlane_b32 s33,v18,1
s_waitcnt lgkmcnt(0)
s_barrier
s_branch L_aa_73
L_aa_82:
s_cmp_lg_u32 s86,1536
s_cbranch_scc1 L_az_126
s_cmp_ge_u32 s35,66
s_cbranch_scc1 L_aa_72
v_subrev_u32 v248,s36,v1
v_and_b32 v248,0x80000003,v248
v_cmp_eq_u32 vcc,0,v248
v_lshlrev_b32 v248,2,v1
v_mov_b32 v249,0x40000000
v_cndmask_b32 v248,v249,v248,vcc
v_mov_b32 v249,3
s_or_b32 s59,s68,s46
s_mov_b32 s59,11018240
s_cmov_b32 s59,0x80000000
buffer_store_dword v249,v248,s[8:11],s59 offen sc1
L_aa_72:
s_waitcnt vmcnt(0)
buffer_store_dword v20,off,s[8:11],s73 sc1
s_mov_b32 s73,0x80000000
v_lshlrev_b32 v238,2,v1
v_add_u32 v248,155712,v238
s_cmp_lg_u32 s46,0
s_cbranch_scc1 L_an_127
s_lshl_b32 s59,s54,13
s_add_u32 s59,s59,11026432
L_fp_128:
s_sleep 1
buffer_load_dword v239,v238,s[8:11],s59 offen sc1
s_sub_u32 s49,s49,1
s_cbranch_scc1 L_abort
s_waitcnt vmcnt(0)
v_cmp_eq_u32 vcc,0,v239
s_cbranch_vccnz L_fp_128
ds_write_b32 v248,v239
s_waitcnt lgkmcnt(0)
L_an_127:
s_barrier
ds_read_b32 v239,v248
s_mov_b32 s86,768
s_mov_b32 s30,1
s_waitcnt lgkmcnt(0)
v_readfirstlane_b32 s55,v239
v_and_b32 v239,255,v239
s_lshr_b32 s55,s55,8
s_lshr_b32 s61,s55,5
v_cmp_ne_u32 s[38:39],3,v239
v_cmp_le_u32 vcc,s61,v1
s_nop 1
v_cndmask_b32 v238,1,2,vcc
v_cmp_ne_u32 s[84:85],v238,v239
s_bcnt1_i32_b64 s56,s[84:85]
s_nop 0
v_mbcnt_lo_u32_b32 v238,s84,0
v_mbcnt_hi_u32_b32 v238,s85,v238
s_mul_i32 s56,s56,14
s_add_u32 s56,s56,48
s_lshr_b32 s56,s56,7
s_lshl_b32 s56,s56,1
v_cmp_gt_u32 vcc,s56,v238
v_and_b32 v239,1,v238
v_and_b32 v238,3,v238
v_add_u32 v238,2,v238
v_cndmask_b32 v238,v238,v239,vcc
v_cmp_eq_u32 vcc,s54,v238
s_and_b64 s[84:85],s[84:85],vcc
s_ff1_i32_b64 s77,s[84:85]
s_bitset0_b64 s[84:85],s77
s_min_u32 s77,s77,64
s_lshl_b32 s56,s77,5
s_add_u32 s56,s56,s68
s_mul_i32 s70,s56,24576
s_lshl_b32 s71,s56,12
s_lshl_b32 s59,s77,13
s_lshl2_add_u32 s59,s68,s59
s_add_u32 s59,s59,10486144
s_cmp_lt_u32 s77,s61
s_cselect_b32 s57,0,16777216
s_mov_b32 s60,s59
s_buffer_load_dword s33,s[8:11],s60
s_add_u32 s71,s71,s57
s_add_u32 s71,s71,58720256
s_cmp_eq_u32 s77,s61
s_cselect_b32 s57,50331648,0
s_cselect_b32 s58,1536,0
s_add_u32 s59,s59,s58
s_buffer_load_dword s32,s[8:11],s59
s_add_u32 s70,s70,s57
s_add_u32 s70,s70,150994944
v_mov_b32 v19,s59
v_writelane_b32 v19,s60,1
s_cmp_lt_u32 s77,64
s_cbranch_scc1 L_aa_80
L_az_126:
s_waitcnt vmcnt(0)
buffer_store_dword v20,off,s[8:11],s73 sc1
s_mov_b32 s73,0x80000000
s_endpgm
L_ag_88:
s_lshl_b32 s21,s26,13
s_lshl2_add_u32 s21,s68,s21
s_add_u32 s21,s21,10487296
L_ww_129:
buffer_load_dword v246,off,s[8:11],s21 sc1
s_sub_u32 s49,s49,1
s_cbranch_scc1 L_abort
s_waitcnt vmcnt(0)
v_readfirstlane_b32 s22,v246
s_cmp_eq_u32 s22,0
s_cbranch_scc1 L_ww_129
L_wwd_130:
s_branch L_agb_89
L_ac_97:
buffer_store_dword v20,off,s[8:11],s73 sc1
s_mov_b32 s73,0x80000000
buffer_load_dwordx4 v[72:75],v0,s[8:11],s76 offen offset:0 sc1
buffer_load_dwordx4 v[76:79],v0,s[8:11],s76 offen offset:1024 sc1
buffer_load_dwordx4 v[80:83],v0,s[8:11],s76 offen offset:2048 sc1
buffer_load_dwordx4 v[84:87],v0,s[8:11],s76 offen offset:3072 sc1
buffer_load_dwordx2 v[120:121],v253,s[8:11],s76 offen offset:0 sc1
buffer_load_dwordx2 v[122:123],v253,s[8:11],s76 offen offset:1024 sc1
buffer_load_dwordx2 v[124:125],v253,s[8:11],s76 offen offset:2048 sc1
buffer_load_dwordx2 v[126:127],v253,s[8:11],s76 offen offset:3072 sc1
s_sub_u32 s49,s49,1
s_cbranch_scc1 L_abort
s_waitcnt vmcnt(7)
v_mfma_f32_16x16x32_bf16 v[136:139],v[72:75],v[24:27],0
v_max3_u32 v238,v72,v73,v74
v_max3_u32 v238,v74,v75,v238
s_waitcnt vmcnt(6)
v_mfma_f32_16x16x32_bf16 v[136:139],v[76:79],v[28:31],v[136:139]
v_max3_u32 v238,v76,v77,v238
v_max3_u32 v238,v78,v79,v238
s_waitcnt vmcnt(5)
v_mfma_f32_16x16x32_bf16 v[136:139],v[80:83],v[32:35],v[136:139]
v_max3_u32 v238,v80,v81,v238
v_max3_u32 v238,v82,v83,v238
s_waitcnt vmcnt(4)
v_mfma_f32_16x16x32_bf16 v[136:139],v[84:87],v[36:39],v[136:139]
v_max3_u32 v238,v84,v85,v238
v_max3_u32 v238,v86,v87,v238
s_waitcnt vmcnt(0)
v_max3_u32 v238,v120,v121,v238
v_max3_u32 v238,v122,v123,v238
v_max3_u32 v238,v124,v125,v238
v_max3_u32 v238,v126,v127,v238
v_cmp_eq_u32 vcc,-1,v238
s_cbranch_vccnz L_ac_97
s_branch L_acb_98
L_ap_100:
L_aw_131:
v_cmp_gt_u32 vcc,s66,v17
s_cbranch_vccz L_awd_132
buffer_load_dword v17,v16,s[8:11],s87 offen sc1
s_sub_u32 s49,s49,1
s_cbranch_scc1 L_abort
s_waitcnt vmcnt(0)
s_branch L_aw_131
L_awd_132:
s_branch L_apb_101
L_ag_109:
s_lshl_b32 s21,s51,13
s_lshl2_add_u32 s21,s68,s21
s_add_u32 s21,s21,10487296
L_ww_133:
buffer_load_dword v246,off,s[8:11],s21 sc1
s_sub_u32 s49,s49,1
s_cbranch_scc1 L_abort
s_waitcnt vmcnt(0)
v_readfirstlane_b32 s22,v246
s_cmp_eq_u32 s22,0
s_cbranch_scc1 L_ww_133
L_wwd_134:
s_branch L_agb_110
L_ac_116:
buffer_store_dword v20,off,s[8:11],s73 sc1
s_mov_b32 s73,0x80000000
buffer_load_dwordx4 v[72:75],v0,s[8:11],s76 offen offset:0 sc1
buffer_load_dwordx4 v[76:79],v0,s[8:11],s76 offen offset:1024 sc1
buffer_load_dwordx4 v[80:83],v0,s[8:11],s76 offen offset:2048 sc1
buffer_load_dwordx4 v[84:87],v0,s[8:11],s76 offen offset:3072 sc1
buffer_load_dwordx2 v[120:121],v253,s[8:11],s76 offen offset:0 sc1
buffer_load_dwordx2 v[122:123],v253,s[8:11],s76 offen offset:1024 sc1
buffer_load_dwordx2 v[124:125],v253,s[8:11],s76 offen offset:2048 sc1
buffer_load_dwordx2 v[126:127],v253,s[8:11],s76 offen offset:3072 sc1
s_sub_u32 s49,s49,1
s_cbranch_scc1 L_abort
s_waitcnt vmcnt(7)
v_mfma_f32_16x16x32_bf16 v[136:139],v[72:75],v[24:27],0
v_max3_u32 v238,v72,v73,v74
v_max3_u32 v238,v74,v75,v238
s_waitcnt vmcnt(6)
v_mfma_f32_16x16x32_bf16 v[136:139],v[76:79],v[28:31],v[136:139]
v_max3_u32 v238,v76,v77,v238
v_max3_u32 v238,v78,v79,v238
s_waitcnt vmcnt(5)
v_mfma_f32_16x16x32_bf16 v[136:139],v[80:83],v[32:35],v[136:139]
v_max3_u32 v238,v80,v81,v238
v_max3_u32 v238,v82,v83,v238
s_waitcnt vmcnt(4)
v_mfma_f32_16x16x32_bf16 v[136:139],v[84:87],v[36:39],v[136:139]
v_max3_u32 v238,v84,v85,v238
v_max3_u32 v238,v86,v87,v238
s_waitcnt vmcnt(0)
v_max3_u32 v238,v120,v121,v238
v_max3_u32 v238,v122,v123,v238
v_max3_u32 v238,v124,v125,v238
v_max3_u32 v238,v126,v127,v238
v_cmp_eq_u32 vcc,-1,v238
s_cbranch_vccnz L_ac_116
s_branch L_acb_117
L_am_120:
v_subrev_u32 v248,s36,v1
v_and_b32 v248,0x80000003,v248
v_cmp_eq_u32 vcc,0,v248
v_lshlrev_b32 v248,2,v1
v_mov_b32 v249,0x40000000
v_cndmask_b32 v248,v249,v248,vcc
v_mov_b32 v249,3
s_or_b32 s59,s68,s46
s_mov_b32 s59,11018240
s_cmov_b32 s59,0x80000000
buffer_store_dword v249,v248,s[8:11],s59 offen sc1
s_branch L_ab_118
L_ap_124:
L_aw_135:
v_cmp_gt_u32 vcc,s66,v17
s_cbranch_vccz L_awd_136
buffer_load_dword v17,v16,s[8:11],s87 offen sc1
s_sub_u32 s49,s49,1
s_cbranch_scc1 L_abort
s_waitcnt vmcnt(0)
s_branch L_aw_135
L_awd_136:
s_branch L_apb_125
s_endpgm
L_rch_4:
v_and_b32 v2,15,v1
v_lshlrev_b32 v2,2,v2
v_lshrrev_b32 v3,4,v1
v_lshl_add_u32 v4,v3,16,v2
v_lshl_add_u32 v5,v3,12,v2
s_lshl_b32 s58,s47,8
s_lshl_b32 s57,s46,6
s_add_u32 s58,s58,s57
s_lshl_b32 s59,s47,17
s_add_u32 s59,s59,s57
s_lshl_b32 s60,s46,15
v_add_u32 v6,s60,v0
s_mov_b32 s61,0x05040100
s_mov_b32 s62,0x07060302
s_lshl_b32 s63,s46,19
s_cmp_lt_u32 s48,3
s_cselect_b32 s63,s63,0
s_mov_b32 s4,s26
s_mov_b32 s5,s27
s_mov_b32 s6,4194304
s_mov_b32 s7,0x20000
s_add_u32 s56,s59,0
buffer_load_dword v24,v5,s[4:7],s56 offen offset:0
buffer_load_dword v25,v5,s[4:7],s56 offen offset:1024
buffer_load_dword v26,v5,s[4:7],s56 offen offset:2048
buffer_load_dword v27,v5,s[4:7],s56 offen offset:3072
s_add_u32 s56,s59,16384
buffer_load_dword v28,v5,s[4:7],s56 offen offset:0
buffer_load_dword v29,v5,s[4:7],s56 offen offset:1024
buffer_load_dword v30,v5,s[4:7],s56 offen offset:2048
buffer_load_dword v31,v5,s[4:7],s56 offen offset:3072
s_add_u32 s56,s59,32768
buffer_load_dword v32,v5,s[4:7],s56 offen offset:0
buffer_load_dword v33,v5,s[4:7],s56 offen offset:1024
buffer_load_dword v34,v5,s[4:7],s56 offen offset:2048
buffer_load_dword v35,v5,s[4:7],s56 offen offset:3072
s_add_u32 s56,s59,49152
buffer_load_dword v36,v5,s[4:7],s56 offen offset:0
buffer_load_dword v37,v5,s[4:7],s56 offen offset:1024
buffer_load_dword v38,v5,s[4:7],s56 offen offset:2048
buffer_load_dword v39,v5,s[4:7],s56 offen offset:3072
s_add_u32 s56,s59,65536
buffer_load_dword v40,v5,s[4:7],s56 offen offset:0
buffer_load_dword v41,v5,s[4:7],s56 offen offset:1024
buffer_load_dword v42,v5,s[4:7],s56 offen offset:2048
buffer_load_dword v43,v5,s[4:7],s56 offen offset:3072
s_add_u32 s56,s59,81920
buffer_load_dword v44,v5,s[4:7],s56 offen offset:0
buffer_load_dword v45,v5,s[4:7],s56 offen offset:1024
buffer_load_dword v46,v5,s[4:7],s56 offen offset:2048
buffer_load_dword v47,v5,s[4:7],s56 offen offset:3072
s_add_u32 s56,s59,98304
buffer_load_dword v48,v5,s[4:7],s56 offen offset:0
buffer_load_dword v49,v5,s[4:7],s56 offen offset:1024
buffer_load_dword v50,v5,s[4:7],s56 offen offset:2048
buffer_load_dword v51,v5,s[4:7],s56 offen offset:3072
s_add_u32 s56,s59,114688
buffer_load_dword v52,v5,s[4:7],s56 offen offset:0
buffer_load_dword v53,v5,s[4:7],s56 offen offset:1024
buffer_load_dword v54,v5,s[4:7],s56 offen offset:2048
buffer_load_dword v55,v5,s[4:7],s56 offen offset:3072
s_add_u32 s56,s59,256
buffer_load_dword v56,v5,s[4:7],s56 offen offset:0
buffer_load_dword v57,v5,s[4:7],s56 offen offset:1024
buffer_load_dword v58,v5,s[4:7],s56 offen offset:2048
buffer_load_dword v59,v5,s[4:7],s56 offen offset:3072
s_add_u32 s56,s59,16640
buffer_load_dword v60,v5,s[4:7],s56 offen offset:0
buffer_load_dword v61,v5,s[4:7],s56 offen offset:1024
buffer_load_dword v62,v5,s[4:7],s56 offen offset:2048
buffer_load_dword v63,v5,s[4:7],s56 offen offset:3072
s_add_u32 s56,s59,33024
buffer_load_dword v64,v5,s[4:7],s56 offen offset:0
buffer_load_dword v65,v5,s[4:7],s56 offen offset:1024
buffer_load_dword v66,v5,s[4:7],s56 offen offset:2048
buffer_load_dword v67,v5,s[4:7],s56 offen offset:3072
s_add_u32 s56,s59,49408
buffer_load_dword v68,v5,s[4:7],s56 offen offset:0
buffer_load_dword v69,v5,s[4:7],s56 offen offset:1024
buffer_load_dword v70,v5,s[4:7],s56 offen offset:2048
buffer_load_dword v71,v5,s[4:7],s56 offen offset:3072
s_add_u32 s56,s59,65792
buffer_load_dword v72,v5,s[4:7],s56 offen offset:0
buffer_load_dword v73,v5,s[4:7],s56 offen offset:1024
buffer_load_dword v74,v5,s[4:7],s56 offen offset:2048
buffer_load_dword v75,v5,s[4:7],s56 offen offset:3072
s_add_u32 s56,s59,82176
buffer_load_dword v76,v5,s[4:7],s56 offen offset:0
buffer_load_dword v77,v5,s[4:7],s56 offen offset:1024
buffer_load_dword v78,v5,s[4:7],s56 offen offset:2048
buffer_load_dword v79,v5,s[4:7],s56 offen offset:3072
s_waitcnt vmcnt(48)
ds_write_b128 v6,v[24:27] offset:0
ds_write_b128 v6,v[28:31] offset:1024
s_waitcnt lgkmcnt(0)
s_add_u32 s56,s59,98560
buffer_load_dword v24,v5,s[4:7],s56 offen offset:0
buffer_load_dword v25,v5,s[4:7],s56 offen offset:1024
buffer_load_dword v26,v5,s[4:7],s56 offen offset:2048
buffer_load_dword v27,v5,s[4:7],s56 offen offset:3072
s_add_u32 s56,s59,114944
buffer_load_dword v28,v5,s[4:7],s56 offen offset:0
buffer_load_dword v29,v5,s[4:7],s56 offen offset:1024
buffer_load_dword v30,v5,s[4:7],s56 offen offset:2048
buffer_load_dword v31,v5,s[4:7],s56 offen offset:3072
s_waitcnt vmcnt(48)
ds_write_b128 v6,v[32:35] offset:2048
ds_write_b128 v6,v[36:39] offset:3072
s_waitcnt lgkmcnt(0)
s_add_u32 s56,s59,512
buffer_load_dword v32,v5,s[4:7],s56 offen offset:0
buffer_load_dword v33,v5,s[4:7],s56 offen offset:1024
buffer_load_dword v34,v5,s[4:7],s56 offen offset:2048
buffer_load_dword v35,v5,s[4:7],s56 offen offset:3072
s_add_u32 s56,s59,16896
buffer_load_dword v36,v5,s[4:7],s56 offen offset:0
buffer_load_dword v37,v5,s[4:7],s56 offen offset:1024
buffer_load_dword v38,v5,s[4:7],s56 offen offset:2048
buffer_load_dword v39,v5,s[4:7],s56 offen offset:3072
s_waitcnt vmcnt(48)
ds_write_b128 v6,v[40:43] offset:4096
ds_write_b128 v6,v[44:47] offset:5120
s_waitcnt lgkmcnt(0)
s_add_u32 s56,s59,33280
buffer_load_dword v40,v5,s[4:7],s56 offen offset:0
buffer_load_dword v41,v5,s[4:7],s56 offen offset:1024
buffer_load_dword v42,v5,s[4:7],s56 offen offset:2048
buffer_load_dword v43,v5,s[4:7],s56 offen offset:3072
s_add_u32 s56,s59,49664
buffer_load_dword v44,v5,s[4:7],s56 offen offset:0
buffer_load_dword v45,v5,s[4:7],s56 offen offset:1024
buffer_load_dword v46,v5,s[4:7],s56 offen offset:2048
buffer_load_dword v47,v5,s[4:7],s56 offen offset:3072
s_waitcnt vmcnt(48)
ds_write_b128 v6,v[48:51] offset:6144
ds_write_b128 v6,v[52:55] offset:7168
s_waitcnt lgkmcnt(0)
s_add_u32 s56,s59,66048
buffer_load_dword v48,v5,s[4:7],s56 offen offset:0
buffer_load_dword v49,v5,s[4:7],s56 offen offset:1024
buffer_load_dword v50,v5,s[4:7],s56 offen offset:2048
buffer_load_dword v51,v5,s[4:7],s56 offen offset:3072
s_add_u32 s56,s59,82432
buffer_load_dword v52,v5,s[4:7],s56 offen offset:0
buffer_load_dword v53,v5,s[4:7],s56 offen offset:1024
buffer_load_dword v54,v5,s[4:7],s56 offen offset:2048
buffer_load_dword v55,v5,s[4:7],s56 offen offset:3072
s_waitcnt vmcnt(48)
ds_write_b128 v6,v[56:59] offset:8192
ds_write_b128 v6,v[60:63] offset:9216
s_waitcnt lgkmcnt(0)
s_add_u32 s56,s59,98816
buffer_load_dword v56,v5,s[4:7],s56 offen offset:0
buffer_load_dword v57,v5,s[4:7],s56 offen offset:1024
buffer_load_dword v58,v5,s[4:7],s56 offen offset:2048
buffer_load_dword v59,v5,s[4:7],s56 offen offset:3072
s_add_u32 s56,s59,115200
buffer_load_dword v60,v5,s[4:7],s56 offen offset:0
buffer_load_dword v61,v5,s[4:7],s56 offen offset:1024
buffer_load_dword v62,v5,s[4:7],s56 offen offset:2048
buffer_load_dword v63,v5,s[4:7],s56 offen offset:3072
s_waitcnt vmcnt(48)
ds_write_b128 v6,v[64:67] offset:10240
ds_write_b128 v6,v[68:71] offset:11264
s_waitcnt lgkmcnt(0)
s_add_u32 s56,s59,768
buffer_load_dword v64,v5,s[4:7],s56 offen offset:0
buffer_load_dword v65,v5,s[4:7],s56 offen offset:1024
buffer_load_dword v66,v5,s[4:7],s56 offen offset:2048
buffer_load_dword v67,v5,s[4:7],s56 offen offset:3072
s_add_u32 s56,s59,17152
buffer_load_dword v68,v5,s[4:7],s56 offen offset:0
buffer_load_dword v69,v5,s[4:7],s56 offen offset:1024
buffer_load_dword v70,v5,s[4:7],s56 offen offset:2048
buffer_load_dword v71,v5,s[4:7],s56 offen offset:3072
s_waitcnt vmcnt(48)
ds_write_b128 v6,v[72:75] offset:12288
ds_write_b128 v6,v[76:79] offset:13312
s_waitcnt lgkmcnt(0)
s_add_u32 s56,s59,33536
buffer_load_dword v72,v5,s[4:7],s56 offen offset:0
buffer_load_dword v73,v5,s[4:7],s56 offen offset:1024
buffer_load_dword v74,v5,s[4:7],s56 offen offset:2048
buffer_load_dword v75,v5,s[4:7],s56 offen offset:3072
s_add_u32 s56,s59,49920
buffer_load_dword v76,v5,s[4:7],s56 offen offset:0
buffer_load_dword v77,v5,s[4:7],s56 offen offset:1024
buffer_load_dword v78,v5,s[4:7],s56 offen offset:2048
buffer_load_dword v79,v5,s[4:7],s56 offen offset:3072
s_waitcnt vmcnt(48)
ds_write_b128 v6,v[24:27] offset:14336
ds_write_b128 v6,v[28:31] offset:15360
s_waitcnt lgkmcnt(0)
s_add_u32 s56,s59,66304
buffer_load_dword v24,v5,s[4:7],s56 offen offset:0
buffer_load_dword v25,v5,s[4:7],s56 offen offset:1024
buffer_load_dword v26,v5,s[4:7],s56 offen offset:2048
buffer_load_dword v27,v5,s[4:7],s56 offen offset:3072
s_add_u32 s56,s59,82688
buffer_load_dword v28,v5,s[4:7],s56 offen offset:0
buffer_load_dword v29,v5,s[4:7],s56 offen offset:1024
buffer_load_dword v30,v5,s[4:7],s56 offen offset:2048
buffer_load_dword v31,v5,s[4:7],s56 offen offset:3072
s_waitcnt vmcnt(48)
ds_write_b128 v6,v[32:35] offset:16384
ds_write_b128 v6,v[36:39] offset:17408
s_waitcnt lgkmcnt(0)
s_add_u32 s56,s59,99072
buffer_load_dword v32,v5,s[4:7],s56 offen offset:0
buffer_load_dword v33,v5,s[4:7],s56 offen offset:1024
buffer_load_dword v34,v5,s[4:7],s56 offen offset:2048
buffer_load_dword v35,v5,s[4:7],s56 offen offset:3072
s_add_u32 s56,s59,115456
buffer_load_dword v36,v5,s[4:7],s56 offen offset:0
buffer_load_dword v37,v5,s[4:7],s56 offen offset:1024
buffer_load_dword v38,v5,s[4:7],s56 offen offset:2048
buffer_load_dword v39,v5,s[4:7],s56 offen offset:3072
s_waitcnt vmcnt(48)
ds_write_b128 v6,v[40:43] offset:18432
ds_write_b128 v6,v[44:47] offset:19456
s_waitcnt lgkmcnt(0)
s_waitcnt vmcnt(40)
ds_write_b128 v6,v[48:51] offset:20480
ds_write_b128 v6,v[52:55] offset:21504
s_waitcnt lgkmcnt(0)
s_waitcnt vmcnt(32)
ds_write_b128 v6,v[56:59] offset:22528
ds_write_b128 v6,v[60:63] offset:23552
s_waitcnt lgkmcnt(0)
s_waitcnt vmcnt(24)
ds_write_b128 v6,v[64:67] offset:24576
ds_write_b128 v6,v[68:71] offset:25600
s_waitcnt lgkmcnt(0)
s_waitcnt vmcnt(16)
ds_write_b128 v6,v[72:75] offset:26624
ds_write_b128 v6,v[76:79] offset:27648
s_waitcnt lgkmcnt(0)
s_waitcnt vmcnt(8)
ds_write_b128 v6,v[24:27] offset:28672
ds_write_b128 v6,v[28:31] offset:29696
s_waitcnt lgkmcnt(0)
s_waitcnt vmcnt(0)
ds_write_b128 v6,v[32:35] offset:30720
ds_write_b128 v6,v[36:39] offset:31744
s_waitcnt lgkmcnt(0)
v_mov_b32 v123,159744
s_cmp_lg_u32 s46,0
s_cbranch_scc1 L_gbd_138
v_mov_b32 v124,128
L_gb_137:
buffer_load_dword v125,v124,s[12:15],0 offen sc1
s_waitcnt vmcnt(0)
v_readfirstlane_b32 s56,v125
ds_write_b32 v123,v125
s_bitcmp1_b32 s56,8
s_cbranch_scc1 L_gbd_138
s_sleep 4
s_sub_u32 s49,s49,1
s_cmp_gt_i32 s49,0
s_cbranch_scc1 L_gb_137
s_branch L_abort
L_gbd_138:
s_waitcnt lgkmcnt(0)
s_barrier
ds_read_b32 v125,v123
s_waitcnt lgkmcnt(0)
v_readfirstlane_b32 s56,v125
s_barrier
s_lshr_b32 s56,s56,16
s_andn2_b32 s56,s56,s3
s_cbranch_scc1 L_spread
s_cmp_eq_u32 s48,0
s_cbranch_scc1 L_chd_139
v_and_b32 v120,15,v1
v_lshrrev_b32 v121,4,v1
v_mov_b32 v17,1
s_lshl_b32 s56,s46,2
v_add_u32 v125,s56,v121
v_xor_b32 v126,v125,v120
v_lshlrev_b32 v126,4,v126
v_lshl_add_u32 v20,v125,10,v126
s_lshl_b32 s56,s46,1
s_xor_b32 s56,s56,0
s_and_b32 s57,s56,3
s_lshl_b32 s57,s57,2
s_lshr_b32 s56,s56,2
s_lshl_b32 s56,s56,13
s_add_u32 s56,s56,131072
v_add_u32 v125,s57,v121
v_xor_b32 v125,v125,v120
v_lshlrev_b32 v125,4,v125
v_lshl_add_u32 v125,v120,8,v125
v_add_u32 v4,s56,v125
s_lshl_b32 s56,s46,1
s_xor_b32 s56,s56,1
s_and_b32 s57,s56,3
s_lshl_b32 s57,s57,2
s_lshr_b32 s56,s56,2
s_lshl_b32 s56,s56,13
s_add_u32 s56,s56,131072
v_add_u32 v125,s57,v121
v_xor_b32 v125,v125,v120
v_lshlrev_b32 v125,4,v125
v_lshl_add_u32 v125,v120,8,v125
v_add_u32 v5,s56,v125
s_lshl_b32 s56,s46,1
s_xor_b32 s56,s56,2
s_and_b32 s57,s56,3
s_lshl_b32 s57,s57,2
s_lshr_b32 s56,s56,2
s_lshl_b32 s56,s56,13
s_add_u32 s56,s56,131072
v_add_u32 v125,s57,v121
v_xor_b32 v125,v125,v120
v_lshlrev_b32 v125,4,v125
v_lshl_add_u32 v125,v120,8,v125
v_add_u32 v6,s56,v125
s_lshl_b32 s56,s46,1
s_xor_b32 s56,s56,3
s_and_b32 s57,s56,3
s_lshl_b32 s57,s57,2
s_lshr_b32 s56,s56,2
s_lshl_b32 s56,s56,13
s_add_u32 s56,s56,131072
v_add_u32 v125,s57,v121
v_xor_b32 v125,v125,v120
v_lshlrev_b32 v125,4,v125
v_lshl_add_u32 v125,v120,8,v125
v_add_u32 v7,s56,v125
s_lshl_b32 s56,s46,1
s_xor_b32 s56,s56,4
s_and_b32 s57,s56,3
s_lshl_b32 s57,s57,2
s_lshr_b32 s56,s56,2
s_lshl_b32 s56,s56,13
s_add_u32 s56,s56,131072
v_add_u32 v125,s57,v121
v_xor_b32 v125,v125,v120
v_lshlrev_b32 v125,4,v125
v_lshl_add_u32 v125,v120,8,v125
v_add_u32 v8,s56,v125
s_lshl_b32 s56,s46,1
s_xor_b32 s56,s56,5
s_and_b32 s57,s56,3
s_lshl_b32 s57,s57,2
s_lshr_b32 s56,s56,2
s_lshl_b32 s56,s56,13
s_add_u32 s56,s56,131072
v_add_u32 v125,s57,v121
v_xor_b32 v125,v125,v120
v_lshlrev_b32 v125,4,v125
v_lshl_add_u32 v125,v120,8,v125
v_add_u32 v9,s56,v125
s_lshl_b32 s56,s46,1
s_xor_b32 s56,s56,6
s_and_b32 s57,s56,3
s_lshl_b32 s57,s57,2
s_lshr_b32 s56,s56,2
s_lshl_b32 s56,s56,13
s_add_u32 s56,s56,131072
v_add_u32 v125,s57,v121
v_xor_b32 v125,v125,v120
v_lshlrev_b32 v125,4,v125
v_lshl_add_u32 v125,v120,8,v125
v_add_u32 v10,s56,v125
s_lshl_b32 s56,s46,1
s_xor_b32 s56,s56,7
s_and_b32 s57,s56,3
s_lshl_b32 s57,s57,2
s_lshr_b32 s56,s56,2
s_lshl_b32 s56,s56,13
s_add_u32 s56,s56,131072
v_add_u32 v125,s57,v121
v_xor_b32 v125,v125,v120
v_lshlrev_b32 v125,4,v125
v_lshl_add_u32 v125,v120,8,v125
v_add_u32 v11,s56,v125
s_cmp_eq_u32 s48,1
s_cselect_b32 s51,14,18
s_cselect_b32 s53,4,5
s_mov_b32 s72,0x80000000
s_lshl_b32 s70,s51,15
s_add_u32 s70,s70,0
s_add_u32 s71,s70,16384
s_add_u32 m0,s50,131072
s_nop 0
buffer_load_dwordx4 v20,s[8:11],s70 offen offset:0 sc1 lds
s_add_u32 m0,s50,135168
s_nop 0
buffer_load_dwordx4 v20,s[8:11],s71 offen offset:0 sc1 lds
s_add_u32 m0,s50,139008
s_nop 0
buffer_load_dwordx4 v20,s[8:11],s70 offen offset:256 sc1 lds
s_add_u32 m0,s50,143104
s_nop 0
buffer_load_dwordx4 v20,s[8:11],s71 offen offset:256 sc1 lds
s_waitcnt vmcnt(0)
L_chl_140:
s_mov_b64 s[68:69],s[70:71]
s_add_u32 s70,s70,32768
s_add_u32 s71,s71,32768
s_lshl_b32 s58,s51,5
s_add_u32 s58,s58,s47
s_mul_i32 s58,s58,24576
s_add_u32 s58,s58,100663296
s_add_u32 s61,s58,s50
s_add_u32 s62,s61,4096
s_add_u32 s63,s61,16384
s_add_u32 s64,s61,20480
s_add_u32 s65,s61,s50
s_add_u32 s65,s65,8192
s_waitcnt vmcnt(7)
s_barrier
ds_read_b128 v[72:75],v4 offset:0
ds_read_b128 v[76:79],v4 offset:4096
ds_read_b128 v[80:83],v5 offset:0
ds_read_b128 v[84:87],v5 offset:4096
s_add_u32 m0,s50,146944
s_nop 0
buffer_load_dwordx4 v20,s[8:11],s68 offen offset:512 sc1 lds
s_add_u32 m0,s50,151040
s_nop 0
buffer_load_dwordx4 v20,s[8:11],s69 offen offset:512 sc1 lds
s_add_u32 m0,s50,154880
s_nop 0
buffer_load_dwordx4 v20,s[8:11],s68 offen offset:768 sc1 lds
s_add_u32 m0,s50,158976
s_nop 0
buffer_load_dwordx4 v20,s[8:11],s69 offen offset:768 sc1 lds
s_waitcnt lgkmcnt(2)
v_mfma_f32_16x16x32_bf16 v[40:43],a[128:131],v[72:75],0
ds_read_b128 v[108:111],v6 offset:0
v_mfma_f32_16x16x32_bf16 v[56:59],v[72:75],v[128:131],0
v_mfma_f32_16x16x32_bf16 v[24:27],a[0:3],v[72:75],0
ds_read_b128 v[112:115],v6 offset:4096
v_mfma_f32_16x16x32_bf16 v[44:47],a[128:131],v[76:79],0
v_mfma_f32_16x16x32_bf16 v[60:63],v[76:79],v[128:131],0
v_mfma_f32_16x16x32_bf16 v[28:31],a[0:3],v[76:79],0
v_mfma_f32_16x16x32_bf16 v[48:51],a[136:139],v[72:75],0
v_mfma_f32_16x16x32_bf16 v[64:67],v[72:75],v[136:139],0
v_mfma_f32_16x16x32_bf16 v[32:35],a[8:11],v[72:75],0
v_mfma_f32_16x16x32_bf16 v[52:55],a[136:139],v[76:79],0
v_mfma_f32_16x16x32_bf16 v[68:71],v[76:79],v[136:139],0
v_mfma_f32_16x16x32_bf16 v[36:39],a[8:11],v[76:79],0
s_waitcnt lgkmcnt(2)
v_mfma_f32_16x16x32_bf16 v[40:43],a[132:135],v[80:83],v[40:43]
ds_read_b128 v[72:75],v7 offset:0
v_mfma_f32_16x16x32_bf16 v[56:59],v[80:83],v[132:135],v[56:59]
v_mfma_f32_16x16x32_bf16 v[24:27],a[4:7],v[80:83],v[24:27]
ds_read_b128 v[76:79],v7 offset:4096
v_mfma_f32_16x16x32_bf16 v[44:47],a[132:135],v[84:87],v[44:47]
v_mfma_f32_16x16x32_bf16 v[60:63],v[84:87],v[132:135],v[60:63]
v_mfma_f32_16x16x32_bf16 v[28:31],a[4:7],v[84:87],v[28:31]
v_mfma_f32_16x16x32_bf16 v[48:51],a[140:143],v[80:83],v[48:51]
v_mfma_f32_16x16x32_bf16 v[64:67],v[80:83],v[140:143],v[64:67]
v_mfma_f32_16x16x32_bf16 v[32:35],a[12:15],v[80:83],v[32:35]
v_mfma_f32_16x16x32_bf16 v[52:55],a[140:143],v[84:87],v[52:55]
v_mfma_f32_16x16x32_bf16 v[68:71],v[84:87],v[140:143],v[68:71]
v_mfma_f32_16x16x32_bf16 v[36:39],a[12:15],v[84:87],v[36:39]
s_waitcnt lgkmcnt(2)
v_mfma_f32_16x16x32_bf16 v[40:43],a[144:147],v[108:111],v[40:43]
ds_read_b128 v[80:83],v8 offset:0
v_mfma_f32_16x16x32_bf16 v[56:59],v[108:111],v[144:147],v[56:59]
v_mfma_f32_16x16x32_bf16 v[24:27],a[16:19],v[108:111],v[24:27]
ds_read_b128 v[84:87],v8 offset:4096
v_mfma_f32_16x16x32_bf16 v[44:47],a[144:147],v[112:115],v[44:47]
v_mfma_f32_16x16x32_bf16 v[60:63],v[112:115],v[144:147],v[60:63]
v_mfma_f32_16x16x32_bf16 v[28:31],a[16:19],v[112:115],v[28:31]
v_mfma_f32_16x16x32_bf16 v[48:51],a[152:155],v[108:111],v[48:51]
v_mfma_f32_16x16x32_bf16 v[64:67],v[108:111],v[152:155],v[64:67]
v_mfma_f32_16x16x32_bf16 v[32:35],a[24:27],v[108:111],v[32:35]
v_mfma_f32_16x16x32_bf16 v[52:55],a[152:155],v[112:115],v[52:55]
v_mfma_f32_16x16x32_bf16 v[68:71],v[112:115],v[152:155],v[68:71]
v_mfma_f32_16x16x32_bf16 v[36:39],a[24:27],v[112:115],v[36:39]
s_waitcnt lgkmcnt(2)
v_mfma_f32_16x16x32_bf16 v[40:43],a[148:151],v[72:75],v[40:43]
ds_read_b128 v[108:111],v9 offset:0
v_mfma_f32_16x16x32_bf16 v[56:59],v[72:75],v[148:151],v[56:59]
v_mfma_f32_16x16x32_bf16 v[24:27],a[20:23],v[72:75],v[24:27]
ds_read_b128 v[112:115],v9 offset:4096
v_mfma_f32_16x16x32_bf16 v[44:47],a[148:151],v[76:79],v[44:47]
v_mfma_f32_16x16x32_bf16 v[60:63],v[76:79],v[148:151],v[60:63]
v_mfma_f32_16x16x32_bf16 v[28:31],a[20:23],v[76:79],v[28:31]
v_mfma_f32_16x16x32_bf16 v[48:51],a[156:159],v[72:75],v[48:51]
v_mfma_f32_16x16x32_bf16 v[64:67],v[72:75],v[156:159],v[64:67]
v_mfma_f32_16x16x32_bf16 v[32:35],a[28:31],v[72:75],v[32:35]
v_mfma_f32_16x16x32_bf16 v[52:55],a[156:159],v[76:79],v[52:55]
v_mfma_f32_16x16x32_bf16 v[68:71],v[76:79],v[156:159],v[68:71]
v_mfma_f32_16x16x32_bf16 v[36:39],a[28:31],v[76:79],v[36:39]
s_waitcnt lgkmcnt(2)
v_mfma_f32_16x16x32_bf16 v[40:43],a[160:163],v[80:83],v[40:43]
ds_read_b128 v[72:75],v10 offset:0
v_mfma_f32_16x16x32_bf16 v[56:59],v[80:83],v[160:163],v[56:59]
v_mfma_f32_16x16x32_bf16 v[24:27],a[32:35],v[80:83],v[24:27]
ds_read_b128 v[76:79],v10 offset:4096
v_mfma_f32_16x16x32_bf16 v[44:47],a[160:163],v[84:87],v[44:47]
v_mfma_f32_16x16x32_bf16 v[60:63],v[84:87],v[160:163],v[60:63]
v_mfma_f32_16x16x32_bf16 v[28:31],a[32:35],v[84:87],v[28:31]
v_mfma_f32_16x16x32_bf16 v[48:51],a[168:171],v[80:83],v[48:51]
v_mfma_f32_16x16x32_bf16 v[64:67],v[80:83],v[168:171],v[64:67]
v_mfma_f32_16x16x32_bf16 v[32:35],a[40:43],v[80:83],v[32:35]
v_mfma_f32_16x16x32_bf16 v[52:55],a[168:171],v[84:87],v[52:55]
v_mfma_f32_16x16x32_bf16 v[68:71],v[84:87],v[168:171],v[68:71]
v_mfma_f32_16x16x32_bf16 v[36:39],a[40:43],v[84:87],v[36:39]
s_waitcnt lgkmcnt(2)
v_mfma_f32_16x16x32_bf16 v[40:43],a[164:167],v[108:111],v[40:43]
ds_read_b128 v[80:83],v11 offset:0
v_mfma_f32_16x16x32_bf16 v[56:59],v[108:111],v[164:167],v[56:59]
v_mfma_f32_16x16x32_bf16 v[24:27],a[36:39],v[108:111],v[24:27]
ds_read_b128 v[84:87],v11 offset:4096
v_mfma_f32_16x16x32_bf16 v[44:47],a[164:167],v[112:115],v[44:47]
v_mfma_f32_16x16x32_bf16 v[60:63],v[112:115],v[164:167],v[60:63]
v_mfma_f32_16x16x32_bf16 v[28:31],a[36:39],v[112:115],v[28:31]
v_mfma_f32_16x16x32_bf16 v[48:51],a[172:175],v[108:111],v[48:51]
v_mfma_f32_16x16x32_bf16 v[64:67],v[108:111],v[172:175],v[64:67]
v_mfma_f32_16x16x32_bf16 v[32:35],a[44:47],v[108:111],v[32:35]
v_mfma_f32_16x16x32_bf16 v[52:55],a[172:175],v[112:115],v[52:55]
v_mfma_f32_16x16x32_bf16 v[68:71],v[112:115],v[172:175],v[68:71]
v_mfma_f32_16x16x32_bf16 v[36:39],a[44:47],v[112:115],v[36:39]
s_waitcnt vmcnt(0)
s_barrier
s_or_b32 s72,s72,s52
buffer_store_dword v17,off,s[8:11],s72 sc1
s_waitcnt lgkmcnt(2)
v_mfma_f32_16x16x32_bf16 v[40:43],a[176:179],v[72:75],v[40:43]
ds_read_b128 v[108:111],v4 offset:16384
v_mfma_f32_16x16x32_bf16 v[56:59],v[72:75],v[176:179],v[56:59]
v_mfma_f32_16x16x32_bf16 v[24:27],a[48:51],v[72:75],v[24:27]
ds_read_b128 v[112:115],v4 offset:20480
v_mfma_f32_16x16x32_bf16 v[44:47],a[176:179],v[76:79],v[44:47]
v_mfma_f32_16x16x32_bf16 v[60:63],v[76:79],v[176:179],v[60:63]
v_mfma_f32_16x16x32_bf16 v[28:31],a[48:51],v[76:79],v[28:31]
v_mfma_f32_16x16x32_bf16 v[48:51],a[184:187],v[72:75],v[48:51]
v_mfma_f32_16x16x32_bf16 v[64:67],v[72:75],v[184:187],v[64:67]
v_mfma_f32_16x16x32_bf16 v[32:35],a[56:59],v[72:75],v[32:35]
v_mfma_f32_16x16x32_bf16 v[52:55],a[184:187],v[76:79],v[52:55]
v_mfma_f32_16x16x32_bf16 v[68:71],v[76:79],v[184:187],v[68:71]
v_mfma_f32_16x16x32_bf16 v[36:39],a[56:59],v[76:79],v[36:39]
s_waitcnt lgkmcnt(2)
v_mfma_f32_16x16x32_bf16 v[40:43],a[180:183],v[80:83],v[40:43]
ds_read_b128 v[72:75],v5 offset:16384
v_mfma_f32_16x16x32_bf16 v[56:59],v[80:83],v[180:183],v[56:59]
v_mfma_f32_16x16x32_bf16 v[24:27],a[52:55],v[80:83],v[24:27]
ds_read_b128 v[76:79],v5 offset:20480
v_mfma_f32_16x16x32_bf16 v[44:47],a[180:183],v[84:87],v[44:47]
v_mfma_f32_16x16x32_bf16 v[60:63],v[84:87],v[180:183],v[60:63]
v_mfma_f32_16x16x32_bf16 v[28:31],a[52:55],v[84:87],v[28:31]
v_mfma_f32_16x16x32_bf16 v[48:51],a[188:191],v[80:83],v[48:51]
v_mfma_f32_16x16x32_bf16 v[64:67],v[80:83],v[188:191],v[64:67]
v_mfma_f32_16x16x32_bf16 v[32:35],a[60:63],v[80:83],v[32:35]
v_mfma_f32_16x16x32_bf16 v[52:55],a[188:191],v[84:87],v[52:55]
v_mfma_f32_16x16x32_bf16 v[68:71],v[84:87],v[188:191],v[68:71]
v_mfma_f32_16x16x32_bf16 v[36:39],a[60:63],v[84:87],v[36:39]
s_waitcnt lgkmcnt(2)
v_mfma_f32_16x16x32_bf16 v[40:43],a[192:195],v[108:111],v[40:43]
ds_read_b128 v[80:83],v6 offset:16384
v_mfma_f32_16x16x32_bf16 v[56:59],v[108:111],v[192:195],v[56:59]
v_mfma_f32_16x16x32_bf16 v[24:27],a[64:67],v[108:111],v[24:27]
ds_read_b128 v[84:87],v6 offset:20480
v_mfma_f32_16x16x32_bf16 v[44:47],a[192:195],v[112:115],v[44:47]
v_mfma_f32_16x16x32_bf16 v[60:63],v[112:115],v[192:195],v[60:63]
v_mfma_f32_16x16x32_bf16 v[28:31],a[64:67],v[112:115],v[28:31]
v_mfma_f32_16x16x32_bf16 v[48:51],a[200:203],v[108:111],v[48:51]
v_mfma_f32_16x16x32_bf16 v[64:67],v[108:111],v[200:203],v[64:67]
v_mfma_f32_16x16x32_bf16 v[32:35],a[72:75],v[108:111],v[32:35]
v_mfma_f32_16x16x32_bf16 v[52:55],a[200:203],v[112:115],v[52:55]
v_mfma_f32_16x16x32_bf16 v[68:71],v[112:115],v[200:203],v[68:71]
v_mfma_f32_16x16x32_bf16 v[36:39],a[72:75],v[112:115],v[36:39]
s_waitcnt lgkmcnt(2)
v_mfma_f32_16x16x32_bf16 v[40:43],a[196:199],v[72:75],v[40:43]
ds_read_b128 v[108:111],v7 offset:16384
v_mfma_f32_16x16x32_bf16 v[56:59],v[72:75],v[196:199],v[56:59]
v_mfma_f32_16x16x32_bf16 v[24:27],a[68:71],v[72:75],v[24:27]
ds_read_b128 v[112:115],v7 offset:20480
v_mfma_f32_16x16x32_bf16 v[44:47],a[196:199],v[76:79],v[44:47]
v_mfma_f32_16x16x32_bf16 v[60:63],v[76:79],v[196:199],v[60:63]
v_mfma_f32_16x16x32_bf16 v[28:31],a[68:71],v[76:79],v[28:31]
v_mfma_f32_16x16x32_bf16 v[48:51],a[204:207],v[72:75],v[48:51]
v_mfma_f32_16x16x32_bf16 v[64:67],v[72:75],v[204:207],v[64:67]
v_mfma_f32_16x16x32_bf16 v[32:35],a[76:79],v[72:75],v[32:35]
v_mfma_f32_16x16x32_bf16 v[52:55],a[204:207],v[76:79],v[52:55]
v_mfma_f32_16x16x32_bf16 v[68:71],v[76:79],v[204:207],v[68:71]
v_mfma_f32_16x16x32_bf16 v[36:39],a[76:79],v[76:79],v[36:39]
s_waitcnt lgkmcnt(2)
v_mfma_f32_16x16x32_bf16 v[40:43],a[208:211],v[80:83],v[40:43]
ds_read_b128 v[72:75],v8 offset:16384
v_mfma_f32_16x16x32_bf16 v[56:59],v[80:83],v[208:211],v[56:59]
v_mfma_f32_16x16x32_bf16 v[24:27],a[80:83],v[80:83],v[24:27]
ds_read_b128 v[76:79],v8 offset:20480
v_mfma_f32_16x16x32_bf16 v[44:47],a[208:211],v[84:87],v[44:47]
v_mfma_f32_16x16x32_bf16 v[60:63],v[84:87],v[208:211],v[60:63]
v_mfma_f32_16x16x32_bf16 v[28:31],a[80:83],v[84:87],v[28:31]
v_mfma_f32_16x16x32_bf16 v[48:51],a[216:219],v[80:83],v[48:51]
v_mfma_f32_16x16x32_bf16 v[64:67],v[80:83],v[216:219],v[64:67]
v_mfma_f32_16x16x32_bf16 v[32:35],a[88:91],v[80:83],v[32:35]
v_mfma_f32_16x16x32_bf16 v[52:55],a[216:219],v[84:87],v[52:55]
v_mfma_f32_16x16x32_bf16 v[68:71],v[84:87],v[216:219],v[68:71]
v_mfma_f32_16x16x32_bf16 v[36:39],a[88:91],v[84:87],v[36:39]
s_waitcnt lgkmcnt(2)
v_mfma_f32_16x16x32_bf16 v[40:43],a[212:215],v[108:111],v[40:43]
ds_read_b128 v[80:83],v9 offset:16384
v_mfma_f32_16x16x32_bf16 v[56:59],v[108:111],v[212:215],v[56:59]
v_mfma_f32_16x16x32_bf16 v[24:27],a[84:87],v[108:111],v[24:27]
ds_read_b128 v[84:87],v9 offset:20480
v_mfma_f32_16x16x32_bf16 v[44:47],a[212:215],v[112:115],v[44:47]
v_mfma_f32_16x16x32_bf16 v[60:63],v[112:115],v[212:215],v[60:63]
v_mfma_f32_16x16x32_bf16 v[28:31],a[84:87],v[112:115],v[28:31]
v_mfma_f32_16x16x32_bf16 v[48:51],a[220:223],v[108:111],v[48:51]
v_mfma_f32_16x16x32_bf16 v[64:67],v[108:111],v[220:223],v[64:67]
v_mfma_f32_16x16x32_bf16 v[32:35],a[92:95],v[108:111],v[32:35]
v_mfma_f32_16x16x32_bf16 v[52:55],a[220:223],v[112:115],v[52:55]
v_mfma_f32_16x16x32_bf16 v[68:71],v[112:115],v[220:223],v[68:71]
v_mfma_f32_16x16x32_bf16 v[36:39],a[92:95],v[112:115],v[36:39]
s_barrier
s_waitcnt lgkmcnt(2)
v_mfma_f32_16x16x32_bf16 v[40:43],a[224:227],v[72:75],v[40:43]
ds_read_b128 v[108:111],v10 offset:16384
v_mfma_f32_16x16x32_bf16 v[56:59],v[72:75],v[224:227],v[56:59]
s_add_u32 m0,s50,131072
v_mfma_f32_16x16x32_bf16 v[24:27],a[96:99],v[72:75],v[24:27]
ds_read_b128 v[112:115],v10 offset:20480
v_mfma_f32_16x16x32_bf16 v[44:47],a[224:227],v[76:79],v[44:47]
buffer_load_dwordx4 v20,s[8:11],s70 offen offset:0 sc1 lds
v_mfma_f32_16x16x32_bf16 v[60:63],v[76:79],v[224:227],v[60:63]
s_add_u32 m0,s50,135168
v_mfma_f32_16x16x32_bf16 v[28:31],a[96:99],v[76:79],v[28:31]
buffer_load_dwordx4 v20,s[8:11],s71 offen offset:0 sc1 lds
v_mfma_f32_16x16x32_bf16 v[48:51],a[232:235],v[72:75],v[48:51]
s_add_u32 m0,s50,139008
v_mfma_f32_16x16x32_bf16 v[64:67],v[72:75],v[232:235],v[64:67]
buffer_load_dwordx4 v20,s[8:11],s70 offen offset:256 sc1 lds
v_mfma_f32_16x16x32_bf16 v[32:35],a[104:107],v[72:75],v[32:35]
s_add_u32 m0,s50,143104
v_mfma_f32_16x16x32_bf16 v[52:55],a[232:235],v[76:79],v[52:55]
buffer_load_dwordx4 v20,s[8:11],s71 offen offset:256 sc1 lds
v_mfma_f32_16x16x32_bf16 v[68:71],v[76:79],v[232:235],v[68:71]
v_mfma_f32_16x16x32_bf16 v[36:39],a[104:107],v[76:79],v[36:39]
s_waitcnt lgkmcnt(2)
v_mfma_f32_16x16x32_bf16 v[40:43],a[228:231],v[80:83],v[40:43]
ds_read_b128 v[72:75],v11 offset:16384
v_mfma_f32_16x16x32_bf16 v[56:59],v[80:83],v[228:231],v[56:59]
v_mfma_f32_16x16x32_bf16 v[24:27],a[100:103],v[80:83],v[24:27]
ds_read_b128 v[76:79],v11 offset:20480
v_mfma_f32_16x16x32_bf16 v[44:47],a[228:231],v[84:87],v[44:47]
v_mfma_f32_16x16x32_bf16 v[60:63],v[84:87],v[228:231],v[60:63]
v_mfma_f32_16x16x32_bf16 v[28:31],a[100:103],v[84:87],v[28:31]
v_mfma_f32_16x16x32_bf16 v[48:51],a[236:239],v[80:83],v[48:51]
v_mfma_f32_16x16x32_bf16 v[64:67],v[80:83],v[236:239],v[64:67]
v_mfma_f32_16x16x32_bf16 v[32:35],a[108:111],v[80:83],v[32:35]
v_mfma_f32_16x16x32_bf16 v[52:55],a[236:239],v[84:87],v[52:55]
v_mfma_f32_16x16x32_bf16 v[68:71],v[84:87],v[236:239],v[68:71]
v_mfma_f32_16x16x32_bf16 v[36:39],a[108:111],v[84:87],v[36:39]
s_waitcnt lgkmcnt(2)
v_mfma_f32_16x16x32_bf16 v[40:43],a[240:243],v[108:111],v[40:43]
v_mfma_f32_16x16x32_bf16 v[56:59],v[108:111],v[240:243],v[56:59]
v_mfma_f32_16x16x32_bf16 v[24:27],a[112:115],v[108:111],v[24:27]
v_mfma_f32_16x16x32_bf16 v[44:47],a[240:243],v[112:115],v[44:47]
v_mfma_f32_16x16x32_bf16 v[60:63],v[112:115],v[240:243],v[60:63]
v_mfma_f32_16x16x32_bf16 v[28:31],a[112:115],v[112:115],v[28:31]
v_mfma_f32_16x16x32_bf16 v[48:51],a[248:251],v[108:111],v[48:51]
v_mfma_f32_16x16x32_bf16 v[64:67],v[108:111],v[248:251],v[64:67]
v_mfma_f32_16x16x32_bf16 v[32:35],a[120:123],v[108:111],v[32:35]
v_mfma_f32_16x16x32_bf16 v[52:55],a[248:251],v[112:115],v[52:55]
v_mfma_f32_16x16x32_bf16 v[68:71],v[112:115],v[248:251],v[68:71]
v_mfma_f32_16x16x32_bf16 v[36:39],a[120:123],v[112:115],v[36:39]
s_waitcnt lgkmcnt(0)
v_mfma_f32_16x16x32_bf16 v[40:43],a[244:247],v[72:75],v[40:43]
v_mfma_f32_16x16x32_bf16 v[56:59],v[72:75],v[244:247],v[56:59]
v_mfma_f32_16x16x32_bf16 v[24:27],a[116:119],v[72:75],v[24:27]
v_mfma_f32_16x16x32_bf16 v[44:47],a[244:247],v[76:79],v[44:47]
v_mfma_f32_16x16x32_bf16 v[60:63],v[76:79],v[244:247],v[60:63]
v_mfma_f32_16x16x32_bf16 v[28:31],a[116:119],v[76:79],v[28:31]
v_mfma_f32_16x16x32_bf16 v[48:51],a[252:255],v[72:75],v[48:51]
v_mfma_f32_16x16x32_bf16 v[64:67],v[72:75],v[252:255],v[64:67]
v_mfma_f32_16x16x32_bf16 v[32:35],a[124:127],v[72:75],v[32:35]
v_mfma_f32_16x16x32_bf16 v[52:55],a[252:255],v[76:79],v[52:55]
v_mfma_f32_16x16x32_bf16 v[68:71],v[76:79],v[252:255],v[68:71]
v_mfma_f32_16x16x32_bf16 v[36:39],a[124:127],v[76:79],v[36:39]
s_lshl_b32 s56,s51,5
s_add_u32 s56,s56,s47
s_lshl_b32 s56,s56,12
s_add_u32 s56,s56,s50
s_add_u32 s56,s56,41943040
v_mov_b64 v[120:121],-1
v_mov_b64 v[122:123],-1
buffer_store_dwordx4 v[120:123],v0,s[8:11],s56 offen sc1
v_cvt_pk_bf16_f32 v72,v40,v48
v_cvt_pk_bf16_f32 v73,v41,v49
v_cvt_pk_bf16_f32 v74,v42,v50
v_cvt_pk_bf16_f32 v75,v43,v51
buffer_store_dwordx4 v[72:75],v0,s[8:11],s61 offen sc1
v_cvt_pk_bf16_f32 v76,v44,v52
v_cvt_pk_bf16_f32 v77,v45,v53
v_cvt_pk_bf16_f32 v78,v46,v54
v_cvt_pk_bf16_f32 v79,v47,v55
buffer_store_dwordx4 v[76:79],v0,s[8:11],s62 offen sc1
v_cvt_pk_bf16_f32 v80,v56,v57
v_cvt_pk_bf16_f32 v81,v58,v59
v_cvt_pk_bf16_f32 v82,v60,v61
v_cvt_pk_bf16_f32 v83,v62,v63
buffer_store_dwordx4 v[80:83],v0,s[8:11],s65 offen offset:0 sc1
v_cvt_pk_bf16_f32 v84,v64,v65
v_cvt_pk_bf16_f32 v85,v66,v67
v_cvt_pk_bf16_f32 v86,v68,v69
v_cvt_pk_bf16_f32 v87,v70,v71
buffer_store_dwordx4 v[84:87],v0,s[8:11],s65 offen offset:1024 sc1
v_cvt_pk_bf16_f32 v108,v24,v32
v_cvt_pk_bf16_f32 v109,v25,v33
v_cvt_pk_bf16_f32 v110,v26,v34
v_cvt_pk_bf16_f32 v111,v27,v35
buffer_store_dwordx4 v[108:111],v0,s[8:11],s63 offen sc1
v_cvt_pk_bf16_f32 v112,v28,v36
v_cvt_pk_bf16_f32 v113,v29,v37
v_cvt_pk_bf16_f32 v114,v30,v38
v_cvt_pk_bf16_f32 v115,v31,v39
buffer_store_dwordx4 v[112:115],v0,s[8:11],s64 offen sc1
s_lshl_b32 s72,s51,13
s_lshl2_add_u32 s72,s47,s72
s_add_u32 s72,s72,10485760
s_add_u32 s51,s51,1
s_sub_u32 s53,s53,1
s_cmp_gt_u32 s53,0
s_cbranch_scc1 L_chl_140
s_waitcnt vmcnt(0)
s_barrier
s_or_b32 s72,s72,s52
buffer_store_dword v17,off,s[8:11],s72 sc1
L_chd_139:
s_cmp_lg_u32 s3,0
s_cbranch_scc1 L_wc
s_cmp_eq_u32 s48,1
s_cbranch_scc1 L_rc1_141
s_cmp_eq_u32 s48,2
s_cbranch_scc1 L_rc2_142
v_and_b32 v120,15,v1
v_lshrrev_b32 v121,4,v1
v_and_b32 v122,2,v1
v_cmp_eq_u32 vcc,0,v122
v_mov_b32 v2,0xeeee
v_mov_b32 v123,0x4444
v_cndmask_b32 v2,v2,v123,vcc
v_and_b32 v122,1,v1
v_cmp_eq_u32 vcc,0,v122
v_mov_b32 v3,0xdddd
v_mov_b32 v123,0x8888
v_cndmask_b32 v3,v3,v123,vcc
v_lshrrev_b32 v122,1,v120
v_bfe_u32 v123,v120,2,1
v_xor_b32 v123,v123,v122
v_lshlrev_b32 v4,7,v123
v_and_b32 v123,1,v120
v_lshl_add_u32 v4,v123,6,v4
v_xor_b32 v123,v121,v122
v_and_b32 v123,3,v123
v_lshl_add_u32 v4,v123,4,v4
s_lshl_b32 s56,s46,10
s_add_u32 s56,s56,147456
v_add_u32 v4,s56,v4
v_lshlrev_b32 v122,1,v121
v_add_u32 v122,0,v122
v_and_b32 v123,1,v121
v_xor_b32 v123,v123,v122
v_lshlrev_b32 v5,7,v123
v_bfe_u32 v123,v120,3,1
v_lshl_add_u32 v5,v123,6,v5
v_xor_b32 v123,v120,v122
v_and_b32 v123,3,v123
v_lshl_add_u32 v5,v123,4,v5
v_bfe_u32 v123,v120,2,1
v_lshl_add_u32 v5,v123,3,v5
v_add_u32 v5,147456,v5
v_lshlrev_b32 v122,1,v121
v_add_u32 v122,1,v122
v_and_b32 v123,1,v121
v_xor_b32 v123,v123,v122
v_lshlrev_b32 v6,7,v123
v_bfe_u32 v123,v120,3,1
v_lshl_add_u32 v6,v123,6,v6
v_xor_b32 v123,v120,v122
v_and_b32 v123,3,v123
v_lshl_add_u32 v6,v123,4,v6
v_bfe_u32 v123,v120,2,1
v_lshl_add_u32 v6,v123,3,v6
v_add_u32 v6,147456,v6
v_lshlrev_b32 v7,7,v121
v_lshrrev_b32 v122,1,v120
v_lshl_add_u32 v8,v122,4,v7
v_add_u32 v8,151552,v8
v_lshrrev_b32 v122,2,v120
v_lshl_add_u32 v7,v122,5,v7
v_and_b32 v122,1,v120
v_lshl_add_u32 v7,v122,4,v7
v_and_b32 v122,2,v120
v_cmp_eq_u32 vcc,0,v122
s_lshl_b32 s56,s46,9
v_mov_b32 v122,2048
v_mov_b32 v123,s56
v_cndmask_b32 v122,v122,v123,vcc
v_add_u32 v7,v122,v7
v_add_u32 v7,151552,v7
v_lshrrev_b32 v122,3,v1
v_lshlrev_b32 v9,11,v122
v_and_b32 v122,7,v1
v_lshl_add_u32 v9,v122,3,v9
s_lshl_b32 s56,s46,14
s_lshl_b32 s57,s47,6
s_add_u32 s56,s56,s57
v_add_u32 v9,s56,v9
s_lshl_b32 s71,s46,5
s_add_u32 s71,s71,s47
s_bfe_u32 s56,s71,0x10003
s_lshl_b32 s56,s56,11
s_and_b32 s57,s71,1
s_lshl_b32 s57,s57,10
s_add_u32 s56,s56,s57
s_bfe_u32 s57,s71,0x10002
s_lshl_b32 s57,s57,9
s_add_u32 s56,s56,s57
s_bfe_u32 s57,s71,0x10001
s_lshl_b32 s57,s57,6
s_add_u32 s56,s56,s57
s_bfe_u32 s57,s71,0x10004
s_lshl_b32 s57,s57,8
s_add_u32 s56,s56,s57
s_bfe_u32 s57,s71,0x10005
s_lshl_b32 s57,s57,7
s_add_u32 s56,s56,s57
s_bfe_u32 s57,s71,0x10006
s_lshl_b32 s57,s57,12
s_add_u32 s56,s56,s57
v_and_b32 v122,3,v120
v_lshlrev_b32 v10,2,v122
v_bfe_u32 v122,v120,3,1
v_lshl_add_u32 v10,v122,4,v10
v_and_b32 v122,1,v121
v_lshl_add_u32 v10,v122,5,v10
v_add_u32 v10,s56,v10
v_and_b32 v123,36,v1
v_mov_b32 v122,0x80000000
v_cmp_eq_u32 vcc,0,v123
s_nop 1
v_cndmask_b32 v10,v122,v10,vcc
s_lshl_b32 s56,s46,15
v_add_u32 v11,s56,v0
s_lshl_b32 s71,s71,11
s_lshl_b32 s73,s46,11
s_mov_b32 s72,0xffc00000
s_mov_b32 s74,0
v_lshrrev_b32 v13,3,v1
v_lshlrev_b32 v13,9,v13
v_and_b32 v122,7,v1
v_lshl_add_u32 v13,v122,4,v13
v_and_b32 v122,15,v1
v_and_b32 v123,1,v1
v_lshlrev_b32 v123,4,v123
v_mov_b32 v124,0x3f80
v_lshlrev_b32 v124,v123,v124
v_lshrrev_b32 v122,1,v122
v_cmp_eq_u32 vcc,0,v122
s_nop 1
v_cndmask_b32 v18,0,v124,vcc
v_cmp_eq_u32 vcc,1,v122
s_nop 1
v_cndmask_b32 v19,0,v124,vcc
v_cmp_eq_u32 vcc,2,v122
s_nop 1
v_cndmask_b32 v20,0,v124,vcc
v_cmp_eq_u32 vcc,3,v122
s_nop 1
v_cndmask_b32 v21,0,v124,vcc
s_and_b32 s56,s46,1
s_lshl_b32 s56,s56,8
s_and_b32 s57,s46,2
s_lshl_b32 s57,s57,6
s_add_u32 s56,s56,s57
v_add_u32 v13,s56,v13
s_add_u32 s56,s50,155648
v_add_u32 v12,s56,v0
v_mov_b64 v[14:15],s[28:29]
v_mov_b64 v[16:17],s[28:29]
v_add_u32 v22,11550720,v10
s_lshl_b32 s18,s47,2
s_add_u32 s18,s18,10493952
v_mov_b32 v1,s80
s_mov_b32 s65,14680064
s_add_u32 s66,s71,14680064
s_add_u32 s69,s71,14942208
s_mov_b32 s30,0x40000000
s_mov_b32 s51,0
buffer_load_dwordx4 v[56:59],v0,s[8:11],s66 offen offset:0
buffer_load_dwordx4 v[60:63],v0,s[8:11],s66 offen offset:1024
buffer_load_dwordx4 v[64:67],v0,s[8:11],s69 offen offset:0
buffer_load_dwordx4 v[68:71],v0,s[8:11],s69 offen offset:1024
s_waitcnt vmcnt(0)
L_cst_146:
s_cmp_lg_u32 s46,0
s_cbranch_scc1 L_csw_151
s_lshl_b32 s59,s51,13
s_lshl2_add_u32 s59,s47,s59
s_add_u32 s59,s59,10485760
L_ww_152:
s_sleep 1
buffer_load_dword v122,off,s[8:11],s59 sc1
s_sub_u32 s49,s49,1
s_cbranch_scc1 L_abort
s_waitcnt vmcnt(0)
v_readfirstlane_b32 s61,v122
s_cmp_eq_u32 s61,0
s_cbranch_scc1 L_ww_152
L_wwd_153:
L_csw_151:
s_waitcnt lgkmcnt(0)
s_barrier
s_lshl_b32 s56,s51,5
s_add_u32 s56,s56,s47
s_mul_i32 s56,s56,24576
s_add_u32 s56,s56,100663296
s_add_u32 s67,s56,s73
s_add_u32 m0,s73,131072
s_add_u32 s57,s67,8192
buffer_load_dwordx4 v0,s[8:11],s67 offen sc1 lds
buffer_load_dwordx4 v0,s[8:11],s67 offen offset:1024 sc1 lds
s_add_u32 m0,s73,139264
s_add_u32 s67,s67,786432
buffer_load_dwordx4 v0,s[8:11],s57 offen sc1 lds
buffer_load_dwordx4 v0,s[8:11],s57 offen offset:1024 sc1 lds
s_lshl_b32 s75,s51,13
s_add_u32 s56,s75,11542528
buffer_load_dword v23,v10,s[8:11],s56 offen sc1
s_add_u32 s64,s75,11534336
s_add_u32 s70,s64,4096
s_lshl_b32 s68,s51,5
s_add_u32 s68,s68,s47
s_lshl_b32 s68,s68,12
s_lshl_b32 s56,s46,10
s_add_u32 s68,s68,s56
s_add_u32 s68,s68,41943040
s_mov_b32 s54,0x80000000
s_mov_b32 s77,0
s_mov_b32 s19,0
s_cmp_eq_u32 s51,63
s_cselect_b32 s76,1,s46
s_cmp_eq_u32 s76,0
s_cselect_b32 s76,1,0
v_mov_b64 v[96:97],0
v_mov_b64 v[98:99],0
v_mov_b64 v[100:101],0
v_mov_b64 v[102:103],0
v_mov_b64 v[104:105],0
v_mov_b64 v[106:107],0
v_mov_b64 v[108:109],0
v_mov_b64 v[110:111],0
v_mov_b64 v[112:113],0
v_mov_b64 v[114:115],0
v_mov_b64 v[116:117],0
v_mov_b64 v[118:119],0
s_waitcnt vmcnt(0) lgkmcnt(0)
s_barrier
v_add_u32 v55,131072,v0
ds_read_b128 v[56:59],v55 offset:0
ds_read_b128 v[60:63],v55 offset:4096
ds_read_b128 v[64:67],v55 offset:1024
ds_read_b128 v[68:71],v55 offset:5120
ds_read_b128 v[72:75],v55 offset:2048
ds_read_b128 v[76:79],v55 offset:6144
ds_read_b128 v[80:83],v55 offset:3072
ds_read_b128 v[84:87],v55 offset:7168
v_add_u32 v123,s73,v55
ds_read_b128 v[88:91],v123 offset:8192
ds_read_b128 v[92:95],v123 offset:9216
v_xor_b32 v120,1024,v12
v_xor_b32 v121,2048,v12
v_xor_b32 v122,3072,v12
buffer_load_dwordx4 v[24:27],v13,s[8:11],s64 offen sc1
buffer_load_dwordx4 v[24:27],v13,s[8:11],s64 offen sc1
L_chain_154:
L_cpa_155:
buffer_load_dwordx4 v[24:27],v13,s[8:11],s64 offen sc1
s_sub_u32 s49,s49,1
s_cbranch_scc1 L_abort
s_waitcnt vmcnt(2)
v_max3_u32 v123,v24,v25,v26
v_max_u32 v123,v27,v123
v_cmp_le_u32 vcc,s72,v123
ds_write_b128 v12,v[24:27] offset:0
s_cbranch_vccnz L_cpa_155
L_cgo_158:
v_smfmac_f32_16x16x64_bf16 v[96:99],v[24:27],a[0:7],v2
buffer_load_dwordx4 v[40:43],v13,s[8:11],s70 offen sc1
v_smfmac_f32_16x16x64_bf16 v[100:103],v[24:27],a[128:135],v2
s_waitcnt lgkmcnt(0)
s_barrier
ds_read_b128 v[28:31],v120 offset:0
v_smfmac_f32_16x16x64_bf16 v[104:107],v[24:27],a[8:15],v2
ds_read_b128 v[32:35],v121 offset:0
v_smfmac_f32_16x16x64_bf16 v[108:111],v[24:27],a[136:143],v2
ds_read_b128 v[36:39],v122 offset:0
v_smfmac_f32_16x16x64_bf16 v[112:115],v[24:27],v[128:135],v2
v_smfmac_f32_16x16x64_bf16 v[116:119],v[24:27],v[136:143],v2
s_waitcnt lgkmcnt(2)
v_smfmac_f32_16x16x64_bf16 v[96:99],v[28:31],a[16:23],v2
s_add_u32 m0,s73,131072
v_smfmac_f32_16x16x64_bf16 v[100:103],v[28:31],a[144:151],v2
s_add_u32 s57,s67,8192
v_smfmac_f32_16x16x64_bf16 v[104:107],v[28:31],a[24:31],v2
s_cmp_lt_u32 s19,s76
s_cbranch_scc1 L_ckw_147
L_ckb_148:
v_smfmac_f32_16x16x64_bf16 v[108:111],v[28:31],a[152:159],v2
s_waitcnt vmcnt(0) lgkmcnt(1)
v_smfmac_f32_16x16x64_bf16 v[96:99],v[32:35],a[32:39],v2
ds_write_b128 v12,v[40:43] offset:4096
v_max3_u32 v123,v40,v41,v42
v_smfmac_f32_16x16x64_bf16 v[100:103],v[32:35],a[160:167],v2
v_max_u32 v123,v43,v123
v_smfmac_f32_16x16x64_bf16 v[104:107],v[32:35],a[40:47],v2
v_cmp_le_u32 vcc,s72,v123
v_smfmac_f32_16x16x64_bf16 v[108:111],v[32:35],a[168:175],v2
v_smfmac_f32_16x16x64_bf16 v[112:115],v[28:31],v[144:151],v2
s_cbranch_vccnz L_cpb_161
L_cback_163:
s_waitcnt lgkmcnt(0)
s_barrier
v_smfmac_f32_16x16x64_bf16 v[96:99],v[36:39],a[48:55],v2
buffer_store_dwordx4 v[124:127],v0,s[8:11],s54 offen sc1
v_smfmac_f32_16x16x64_bf16 v[100:103],v[36:39],a[176:183],v2
ds_read_b128 v[44:47],v120 offset:4096
v_smfmac_f32_16x16x64_bf16 v[104:107],v[36:39],a[56:63],v2
buffer_load_dwordx4 v0,s[8:11],s67 offen sc1 lds
v_smfmac_f32_16x16x64_bf16 v[108:111],v[36:39],a[184:191],v2
ds_read_b128 v[48:51],v121 offset:4096
v_smfmac_f32_16x16x64_bf16 v[96:99],v[40:43],a[64:71],v2
buffer_load_dwordx4 v0,s[8:11],s67 offen offset:1024 sc1 lds
s_add_u32 m0,s73,139264
v_smfmac_f32_16x16x64_bf16 v[100:103],v[40:43],a[192:199],v2
ds_read_b128 v[52:55],v122 offset:4096
v_smfmac_f32_16x16x64_bf16 v[104:107],v[40:43],a[72:79],v2
buffer_load_dwordx4 v0,s[8:11],s57 offen sc1 lds
s_add_u32 s67,s67,786432
v_smfmac_f32_16x16x64_bf16 v[108:111],v[40:43],a[200:207],v2
s_waitcnt lgkmcnt(2)
v_smfmac_f32_16x16x64_bf16 v[96:99],v[44:47],a[80:87],v2
buffer_load_dwordx4 v0,s[8:11],s57 offen offset:1024 sc1 lds
v_smfmac_f32_16x16x64_bf16 v[100:103],v[44:47],a[208:215],v2
s_waitcnt lgkmcnt(1)
v_smfmac_f32_16x16x64_bf16 v[96:99],v[48:51],a[96:103],v2
buffer_load_dword v23,v22,s[8:11],s75 offen sc1
v_smfmac_f32_16x16x64_bf16 v[100:103],v[48:51],a[224:231],v2
s_waitcnt lgkmcnt(0)
v_smfmac_f32_16x16x64_bf16 v[96:99],v[52:55],a[112:119],v2
v_smfmac_f32_16x16x64_bf16 v[100:103],v[52:55],a[240:247],v2
v_smfmac_f32_16x16x64_bf16 v[104:107],v[44:47],a[88:95],v2
v_smfmac_f32_16x16x64_bf16 v[108:111],v[44:47],a[216:223],v2
v_smfmac_f32_16x16x64_bf16 v[104:107],v[48:51],a[104:111],v2
v_add_f32 v96,v96,v98
v_smfmac_f32_16x16x64_bf16 v[108:111],v[48:51],a[232:239],v2
v_add_f32 v97,v97,v99
v_smfmac_f32_16x16x64_bf16 v[104:107],v[52:55],a[120:127],v2
v_cvt_pk_bf16_f32 v120,v96,v97
v_smfmac_f32_16x16x64_bf16 v[108:111],v[52:55],a[248:255],v2
v_add_f32 v100,v100,v102
v_smfmac_f32_16x16x64_bf16 v[116:119],v[28:31],v[152:159],v2
v_add_f32 v101,v101,v103
v_smfmac_f32_16x16x64_bf16 v[112:115],v[32:35],v[160:167],v2
v_cvt_pk_bf16_f32 v121,v100,v101
v_add_f32 v104,v104,v106
v_add_f32 v105,v105,v107
v_cvt_pk_bf16_f32 v122,v104,v105
v_add_f32 v108,v108,v110
v_add_f32 v109,v109,v111
v_cvt_pk_bf16_f32 v123,v108,v109
ds_write_b128 v4,v[120:123]
v_smfmac_f32_16x16x64_bf16 v[116:119],v[32:35],v[168:175],v2
s_mov_b32 s54,s68
s_add_u32 s68,s68,131072
v_mov_b32 v125,0
v_smfmac_f32_16x16x64_bf16 v[112:115],v[36:39],v[176:183],v2
s_cmp_eq_u32 s51,63
s_cbranch_scc1 L_cend_157
v_smfmac_f32_16x16x64_bf16 v[116:119],v[36:39],v[184:191],v2
v_smfmac_f32_16x16x64_bf16 v[112:115],v[40:43],v[192:199],v2
s_waitcnt lgkmcnt(0)
s_barrier
ds_read_b64_tr_b16 v[96:97],v5 offset:0
ds_read_b64_tr_b16 v[98:99],v6 offset:0
v_smfmac_f32_16x16x64_bf16 v[116:119],v[40:43],v[200:207],v2
ds_read_b64_tr_b16 v[100:101],v5 offset:1024
v_smfmac_f32_16x16x64_bf16 v[112:115],v[44:47],v[208:215],v2
ds_read_b64_tr_b16 v[102:103],v6 offset:1024
v_smfmac_f32_16x16x64_bf16 v[116:119],v[44:47],v[216:223],v2
ds_read_b64_tr_b16 v[104:105],v5 offset:2048
v_smfmac_f32_16x16x64_bf16 v[112:115],v[48:51],v[224:231],v2
ds_read_b64_tr_b16 v[106:107],v6 offset:2048
s_waitcnt lgkmcnt(4)
v_mfma_f32_16x16x32_bf16 v[24:27],v[56:59],v[96:99],0
ds_read_b64_tr_b16 v[108:109],v5 offset:3072
v_mfma_f32_16x16x32_bf16 v[28:31],v[60:63],v[96:99],0
ds_read_b64_tr_b16 v[110:111],v6 offset:3072
v_mfma_f32_16x16x32_bf16 v[32:35],v[96:99],v[96:99],0
ds_read_b128 v[40:43],v11 offset:12288
s_waitcnt lgkmcnt(5)
v_mfma_f32_16x16x32_bf16 v[24:27],v[64:67],v[100:103],v[24:27]
ds_read_b128 v[56:59],v11 offset:0
v_mfma_f32_16x16x32_bf16 v[28:31],v[68:71],v[100:103],v[28:31]
ds_read_b128 v[60:63],v11 offset:1024
v_mfma_f32_16x16x32_bf16 v[32:35],v[100:103],v[100:103],v[32:35]
ds_read_b128 v[96:99],v11 offset:8192
s_waitcnt lgkmcnt(6)
v_mfma_f32_16x16x32_bf16 v[24:27],v[72:75],v[104:107],v[24:27]
ds_read_b128 v[64:67],v11 offset:2048
v_mfma_f32_16x16x32_bf16 v[28:31],v[76:79],v[104:107],v[28:31]
ds_read_b128 v[68:71],v11 offset:3072
v_mfma_f32_16x16x32_bf16 v[32:35],v[104:107],v[104:107],v[32:35]
ds_read_b128 v[100:103],v11 offset:9216
s_waitcnt lgkmcnt(7)
v_mfma_f32_16x16x32_bf16 v[24:27],v[80:83],v[108:111],v[24:27]
ds_read_b128 v[72:75],v11 offset:4096
v_mfma_f32_16x16x32_bf16 v[28:31],v[84:87],v[108:111],v[28:31]
ds_read_b128 v[76:79],v11 offset:5120
v_mfma_f32_16x16x32_bf16 v[32:35],v[108:111],v[108:111],v[32:35]
ds_read_b128 v[104:107],v11 offset:10240
v_smfmac_f32_16x16x64_bf16 v[116:119],v[48:51],v[232:239],v2
ds_read_b128 v[80:83],v11 offset:6144
v_smfmac_f32_16x16x64_bf16 v[112:115],v[52:55],v[240:247],v2
ds_read_b128 v[84:87],v11 offset:7168
v_smfmac_f32_16x16x64_bf16 v[116:119],v[52:55],v[248:255],v2
ds_read_b128 v[108:111],v11 offset:11264
v_max3_f32 v126,v24,v25,v26
v_max3_f32 v127,v27,v28,v29
v_max3_f32 v126,v30,v31,v126
v_max3_f32 v127,v34,v35,v127
v_max_f32 v126,v126,v127
v_max_f32 v127,v126,v127
v_pk_mul_f32 v[34:35],v[34:35],v[0:1] op_sel:[0,1]
v_pk_mul_f32 v[24:25],v[24:25],v[0:1] op_sel:[0,1]
v_permlane16_swap_b32 v126,v127
v_max_f32 v126,v126,v127
v_max_f32 v127,v126,v127
v_pk_mul_f32 v[26:27],v[26:27],v[0:1] op_sel:[0,1]
v_pk_mul_f32 v[28:29],v[28:29],v[0:1] op_sel:[0,1]
v_permlane32_swap_b32 v126,v127
v_max_f32 v126,v126,v127
v_mul_f32 v126,v1,v126
v_pk_mul_f32 v[30:31],v[30:31],v[0:1] op_sel:[0,1]
v_pk_add_f32 v[34:35],v[34:35],v[126:127] op_sel_hi:[1,0] neg_lo:[0,1] neg_hi:[0,1]
v_pk_add_f32 v[112:113],v[112:113],v[114:115]
v_pk_add_f32 v[116:117],v[116:117],v[118:119]
v_pk_add_f32 v[24:25],v[24:25],v[126:127] op_sel_hi:[1,0] neg_lo:[0,1] neg_hi:[0,1]
v_pk_add_f32 v[26:27],v[26:27],v[126:127] op_sel_hi:[1,0] neg_lo:[0,1] neg_hi:[0,1]
v_pk_add_f32 v[28:29],v[28:29],v[126:127] op_sel_hi:[1,0] neg_lo:[0,1] neg_hi:[0,1]
v_pk_add_f32 v[30:31],v[30:31],v[126:127] op_sel_hi:[1,0] neg_lo:[0,1] neg_hi:[0,1]
v_exp_f32 v34,v34
v_exp_f32 v35,v35
v_cvt_pk_bf16_f32 v126,v112,v113
v_cvt_pk_bf16_f32 v124,v34,v35
v_cvt_pk_bf16_f32 v127,v116,v117
v_cvt_pk_bf16_f32 v36,v116,v117
v_mfma_f32_16x16x16_bf16 v[32:35],v[14:15],v[124:125],0
ds_read_b128 v[44:47],v11 offset:13312
v_exp_f32 v24,v24
v_mfma_f32_16x16x16_bf16 v[112:115],v[126:127],v[124:125],0
ds_read_b128 v[48:51],v11 offset:14336
v_exp_f32 v25,v25
v_mfma_f32_16x16x16_bf16 v[116:119],v[36:37],v[124:125],0
ds_read_b128 v[52:55],v11 offset:15360
v_exp_f32 v26,v26
v_exp_f32 v27,v27
v_cvt_pk_bf16_f32 v120,v24,v25
v_exp_f32 v28,v28
v_exp_f32 v29,v29
v_cvt_pk_bf16_f32 v121,v26,v27
v_exp_f32 v30,v30
v_exp_f32 v31,v31
v_cvt_pk_bf16_f32 v122,v28,v29
v_cvt_pk_bf16_f32 v123,v30,v31
s_add_u32 s75,s75,8192
s_add_u32 s51,s51,1
v_mfma_f32_16x16x32_bf16 v[32:35],v[14:17],v[120:123],v[32:35]
v_mfma_f32_16x16x32_bf16 v[112:115],v[88:91],v[120:123],v[112:115]
ds_read_b128 v[88:91],v11 offset:16384
v_mfma_f32_16x16x32_bf16 v[116:119],v[92:95],v[120:123],v[116:119]
ds_read_b128 v[92:95],v11 offset:17408
v_rcp_f32 v32,v32
v_mov_b64 v[24:25],-1
v_mov_b64 v[26:27],-1
s_add_u32 s64,s75,11534336
s_add_u32 s70,s64,4096
v_pk_mul_f32 v[112:113],v[112:113],v[32:33] op_sel_hi:[1,0]
v_pk_mul_f32 v[114:115],v[114:115],v[32:33] op_sel_hi:[1,0]
v_pk_mul_f32 v[116:117],v[116:117],v[32:33] op_sel_hi:[1,0]
v_pk_mul_f32 v[118:119],v[118:119],v[32:33] op_sel_hi:[1,0]
v_cvt_pk_bf16_f32 v120,v112,v116
v_cvt_pk_bf16_f32 v121,v113,v117
v_cvt_pk_bf16_f32 v122,v114,v118
v_cvt_pk_bf16_f32 v123,v115,v119
ds_write_b128 v7,v[120:123]
buffer_store_dwordx4 v[24:27],v0,s[8:11],s69 offen
buffer_store_dwordx4 v[24:27],v0,s[8:11],s69 offen offset:1024
v_mov_b64 v[112:113],0
v_mov_b64 v[114:115],0
v_mov_b64 v[116:117],0
v_mov_b64 v[118:119],0
s_waitcnt lgkmcnt(0)
s_barrier
ds_read_b128 v[24:27],v8 offset:0
ds_read_b128 v[28:31],v8 offset:512
ds_read_b128 v[32:35],v8 offset:1024
ds_read_b128 v[36:39],v8 offset:1536
v_mov_b64 v[120:121],0
v_mov_b64 v[122:123],0
s_add_u32 s57,s65,65536
s_add_u32 s58,s65,131072
s_add_u32 s59,s65,196608
s_add_u32 s56,s18,s75
s_waitcnt lgkmcnt(3)
v_smfmac_f32_16x16x64_bf16 v[112:115],v[24:27],v[56:63],v3
ds_read_b128 v[56:59],v11 offset:18432
s_waitcnt lgkmcnt(3)
v_smfmac_f32_16x16x64_bf16 v[112:115],v[28:31],v[64:71],v3
ds_read_b128 v[60:63],v11 offset:19456
s_waitcnt lgkmcnt(3)
v_smfmac_f32_16x16x64_bf16 v[112:115],v[32:35],v[72:79],v3
ds_read_b128 v[64:67],v11 offset:20480
s_waitcnt lgkmcnt(3)
v_smfmac_f32_16x16x64_bf16 v[112:115],v[36:39],v[80:87],v3
ds_read_b128 v[68:71],v11 offset:21504
v_smfmac_f32_16x16x64_bf16 v[116:119],v[24:27],v[96:103],v3
ds_read_b128 v[72:75],v11 offset:22528
v_smfmac_f32_16x16x64_bf16 v[116:119],v[28:31],v[104:111],v3
ds_read_b128 v[76:79],v11 offset:23552
v_cvt_pk_bf16_f32 v112,v112,v113
v_smfmac_f32_16x16x64_bf16 v[116:119],v[32:35],v[40:47],v3
ds_read_b128 v[80:83],v11 offset:24576
v_cvt_pk_bf16_f32 v113,v114,v115
buffer_store_dwordx2 v[112:113],v9,s[8:11],s65 offen
v_smfmac_f32_16x16x64_bf16 v[116:119],v[36:39],v[48:55],v3
ds_read_b128 v[84:87],v11 offset:25600
v_mov_b64 v[112:113],0
v_smfmac_f32_16x16x64_bf16 v[120:123],v[24:27],v[88:95],v3
ds_read_b128 v[96:99],v11 offset:26624
ds_read_b128 v[100:103],v11 offset:27648
v_mov_b64 v[114:115],0
s_waitcnt lgkmcnt(8)
v_smfmac_f32_16x16x64_bf16 v[120:123],v[28:31],v[56:63],v3
ds_read_b128 v[104:107],v11 offset:28672
v_cvt_pk_bf16_f32 v116,v116,v117
s_waitcnt lgkmcnt(7)
v_smfmac_f32_16x16x64_bf16 v[120:123],v[32:35],v[64:71],v3
ds_read_b128 v[108:111],v11 offset:29696
ds_read_b128 v[40:43],v11 offset:30720
v_cvt_pk_bf16_f32 v117,v118,v119
buffer_store_dwordx2 v[116:117],v9,s[8:11],s57 offen
s_waitcnt lgkmcnt(7)
v_smfmac_f32_16x16x64_bf16 v[120:123],v[36:39],v[72:79],v3
ds_read_b128 v[44:47],v11 offset:31744
v_add_u32 v52,s50,v5
s_waitcnt lgkmcnt(6)
v_smfmac_f32_16x16x64_bf16 v[112:115],v[24:27],v[80:87],v3
v_add_u32 v54,s50,v6
s_waitcnt lgkmcnt(4)
v_smfmac_f32_16x16x64_bf16 v[112:115],v[28:31],v[96:103],v3
ds_read_b64_tr_b16 v[52:53],v52
v_cvt_pk_bf16_f32 v120,v120,v121
s_waitcnt lgkmcnt(3)
v_smfmac_f32_16x16x64_bf16 v[112:115],v[32:35],v[104:111],v3
ds_read_b64_tr_b16 v[54:55],v54
v_cvt_pk_bf16_f32 v121,v122,v123
buffer_store_dwordx2 v[120:121],v9,s[8:11],s58 offen
s_waitcnt lgkmcnt(2)
v_smfmac_f32_16x16x64_bf16 v[112:115],v[36:39],v[40:47],v3
v_mov_b64 v[116:117],0
v_mov_b64 v[118:119],0
s_xor_b32 s65,s65,262144
v_mov_b32_dpp v124,v126 quad_perm:[2,3,2,3] row_mask:0xf bank_mask:0xf
v_mov_b32_dpp v125,v127 quad_perm:[2,3,2,3] row_mask:0xf bank_mask:0xf
s_mov_b32 vcc_lo,0xcccccccc
s_mov_b32 vcc_hi,0xcccccccc
s_nop 0
v_cvt_pk_bf16_f32 v112,v112,v113
v_cvt_pk_bf16_f32 v113,v114,v115
buffer_store_dwordx2 v[112:113],v9,s[8:11],s59 offen
s_waitcnt lgkmcnt(0)
s_buffer_load_dword s19,s[8:11],s56
v_cndmask_b32 v124,v124,v52,vcc
v_cndmask_b32 v125,v125,v53,vcc
v_cndmask_b32 v126,v126,v54,vcc
v_cndmask_b32 v127,v127,v55,vcc
s_cmp_lt_u32 s46,2
s_waitcnt vmcnt(3)
s_cbranch_scc1 L_crg_164
s_cmp_eq_u32 s46,2
s_waitcnt vmcnt(1)
s_cbranch_scc1 L_crg_164
s_waitcnt vmcnt(0)
L_crg_164:
buffer_load_dwordx4 v[32:35],v0,s[8:11],s66 offen offset:0 sc1
buffer_load_dwordx4 v[36:39],v0,s[8:11],s66 offen offset:1024 sc1
v_mov_b64 v[96:97],0
v_mov_b64 v[98:99],0
v_mov_b64 v[100:101],0
v_mov_b64 v[102:103],0
v_mov_b64 v[104:105],0
v_mov_b64 v[106:107],0
v_mov_b64 v[108:109],0
v_mov_b64 v[110:111],0
v_mov_b64 v[112:113],0
v_mov_b64 v[114:115],0
v_add_u32 v55,131072,v0
v_add_u32 v123,s73,v55
v_xor_b32 v120,1024,v12
v_xor_b32 v121,2048,v12
v_xor_b32 v122,3072,v12
buffer_load_dwordx4 v[44:47],v0,s[8:11],s66 offen offset:0 sc1
buffer_load_dwordx4 v[48:51],v0,s[8:11],s66 offen offset:1024 sc1
s_cmp_ge_u32 s51,63
s_cselect_b32 s76,0,1
s_cmp_eq_u32 s46,0
s_cselect_b32 s76,s76,0
s_waitcnt vmcnt(3)
v_mfma_f32_16x16x32_bf16 v[28:31],v[18:21],v[32:35],0
s_waitcnt vmcnt(2)
v_mfma_f32_16x16x32_bf16 v[28:31],v[18:21],v[36:39],v[28:31]
s_nop 7
v_cmp_u_f32 vcc,v28,v28
v_add_f32_dpp v52,v28,v28 row_ror:8 row_mask:0xf bank_mask:0x3
v_add_f32_dpp v53,v29,v29 row_ror:8 row_mask:0xf bank_mask:0x3
v_add_f32_dpp v52,v30,v30 row_ror:8 row_mask:0xf bank_mask:0xc
v_add_f32_dpp v53,v31,v31 row_ror:8 row_mask:0xf bank_mask:0xc
s_nop 0
v_add_f32_dpp v52,v52,v52 row_shl:4 row_mask:0xf bank_mask:0x5
v_add_f32_dpp v53,v53,v53 row_shl:4 row_mask:0xf bank_mask:0x5
s_cbranch_vccnz L_crp_159
L_cok_165:
v_cvt_pk_bf16_f32 v54,v52,v53
buffer_store_dword v54,v10,s[8:11],s64 offen
s_mov_b32 s69,s66
s_xor_b32 s66,s66,262144
s_barrier
ds_read_b128 v[56:59],v55 offset:0
ds_read_b128 v[60:63],v55 offset:4096
ds_read_b128 v[64:67],v55 offset:1024
buffer_load_dwordx4 v[24:27],v13,s[8:11],s64 offen sc1
ds_read_b128 v[68:71],v55 offset:5120
ds_read_b128 v[72:75],v55 offset:2048
ds_read_b128 v[76:79],v55 offset:6144
ds_read_b128 v[80:83],v55 offset:3072
buffer_load_dwordx4 v[24:27],v13,s[8:11],s64 offen sc1
ds_read_b128 v[84:87],v55 offset:7168
ds_read_b128 v[88:91],v123 offset:8192
ds_read_b128 v[92:95],v123 offset:9216
s_branch L_chain_154
L_cpb_161:
buffer_load_dwordx4 v[40:43],v13,s[8:11],s70 offen sc1
s_sub_u32 s49,s49,1
s_cbranch_scc1 L_abort
s_waitcnt vmcnt(0)
v_max3_u32 v123,v40,v41,v42
v_max_u32 v123,v43,v123
v_cmp_le_u32 vcc,s72,v123
s_cbranch_vccnz L_cpb_161
ds_write_b128 v12,v[40:43] offset:4096
s_branch L_cback_163
L_crp_159:
buffer_load_dwordx4 v[32:35],v0,s[8:11],s66 offen offset:0 sc1
buffer_load_dwordx4 v[36:39],v0,s[8:11],s66 offen offset:1024 sc1
s_sub_u32 s49,s49,1
s_cbranch_scc1 L_abort
s_waitcnt vmcnt(3)
v_mfma_f32_16x16x32_bf16 v[28:31],v[18:21],v[44:47],0
s_waitcnt vmcnt(2)
v_mfma_f32_16x16x32_bf16 v[28:31],v[18:21],v[48:51],v[28:31]
s_nop 7
v_cmp_u_f32 vcc,v28,v28
v_add_f32_dpp v52,v28,v28 row_ror:8 row_mask:0xf bank_mask:0x3
v_add_f32_dpp v53,v29,v29 row_ror:8 row_mask:0xf bank_mask:0x3
v_add_f32_dpp v52,v30,v30 row_ror:8 row_mask:0xf bank_mask:0xc
v_add_f32_dpp v53,v31,v31 row_ror:8 row_mask:0xf bank_mask:0xc
s_nop 0
v_add_f32_dpp v52,v52,v52 row_shl:4 row_mask:0xf bank_mask:0x5
v_add_f32_dpp v53,v53,v53 row_shl:4 row_mask:0xf bank_mask:0x5
s_cbranch_vccz L_cok_165
buffer_load_dwordx4 v[44:47],v0,s[8:11],s66 offen offset:0 sc1
buffer_load_dwordx4 v[48:51],v0,s[8:11],s66 offen offset:1024 sc1
s_sub_u32 s49,s49,1
s_cbranch_scc1 L_abort
s_waitcnt vmcnt(3)
v_mfma_f32_16x16x32_bf16 v[28:31],v[18:21],v[32:35],0
s_waitcnt vmcnt(2)
v_mfma_f32_16x16x32_bf16 v[28:31],v[18:21],v[36:39],v[28:31]
s_nop 7
v_cmp_u_f32 vcc,v28,v28
v_add_f32_dpp v52,v28,v28 row_ror:8 row_mask:0xf bank_mask:0x3
v_add_f32_dpp v53,v29,v29 row_ror:8 row_mask:0xf bank_mask:0x3
v_add_f32_dpp v52,v30,v30 row_ror:8 row_mask:0xf bank_mask:0xc
v_add_f32_dpp v53,v31,v31 row_ror:8 row_mask:0xf bank_mask:0xc
s_nop 0
v_add_f32_dpp v52,v52,v52 row_shl:4 row_mask:0xf bank_mask:0x5
v_add_f32_dpp v53,v53,v53 row_shl:4 row_mask:0xf bank_mask:0x5
s_cbranch_vccz L_cok_165
s_branch L_crp_159
L_ckw_147:
s_add_u32 s59,s18,s75
L_ww_166:
s_sleep 1
buffer_load_dword v23,off,s[8:11],s59 sc1
s_sub_u32 s49,s49,1
s_cbranch_scc1 L_abort
s_waitcnt vmcnt(0)
v_readfirstlane_b32 s76,v23
s_cmp_eq_u32 s76,0
s_cbranch_scc1 L_ww_166
L_wwd_167:
s_branch L_ckb_148
L_cend_157:
v_smfmac_f32_16x16x64_bf16 v[116:119],v[36:39],v[184:191],v2
v_smfmac_f32_16x16x64_bf16 v[112:115],v[40:43],v[192:199],v2
v_smfmac_f32_16x16x64_bf16 v[116:119],v[40:43],v[200:207],v2
v_smfmac_f32_16x16x64_bf16 v[112:115],v[44:47],v[208:215],v2
v_smfmac_f32_16x16x64_bf16 v[116:119],v[44:47],v[216:223],v2
v_smfmac_f32_16x16x64_bf16 v[112:115],v[48:51],v[224:231],v2
v_smfmac_f32_16x16x64_bf16 v[116:119],v[48:51],v[232:239],v2
v_smfmac_f32_16x16x64_bf16 v[112:115],v[52:55],v[240:247],v2
v_smfmac_f32_16x16x64_bf16 v[116:119],v[52:55],v[248:255],v2
s_waitcnt lgkmcnt(0)
s_nop 2
v_pk_add_f32 v[112:113],v[112:113],v[114:115]
s_nop 2
v_pk_add_f32 v[116:117],v[116:117],v[118:119]
v_cvt_pk_bf16_f32 v126,v112,v113
v_cvt_pk_bf16_f32 v127,v116,v117
v_add_u32 v52,s50,v5
v_add_u32 v54,s50,v6
ds_read_b64_tr_b16 v[52:53],v52
ds_read_b64_tr_b16 v[54:55],v54
v_mov_b32_dpp v124,v126 quad_perm:[2,3,2,3] row_mask:0xf bank_mask:0xf
v_mov_b32_dpp v125,v127 quad_perm:[2,3,2,3] row_mask:0xf bank_mask:0xf
s_mov_b32 vcc_lo,0xcccccccc
s_mov_b32 vcc_hi,0xcccccccc
s_waitcnt lgkmcnt(0)
v_cndmask_b32 v124,v124,v52,vcc
v_cndmask_b32 v125,v125,v53,vcc
v_cndmask_b32 v126,v126,v54,vcc
v_cndmask_b32 v127,v127,v55,vcc
buffer_store_dwordx4 v[124:127],v0,s[8:11],s54 offen sc1
s_mov_b32 s51,64
s_waitcnt vmcnt(0)
s_barrier
s_nop 11
v_lshrrev_b32 v1,4,v0
s_mov_b32 s53,0
s_branch L_rb_7
L_rc1_141:
v_and_b32 v120,15,v1
v_lshrrev_b32 v121,4,v1
v_and_b32 v122,2,v1
v_cmp_eq_u32 vcc,0,v122
v_mov_b32 v2,0xeeee
v_mov_b32 v123,0x4444
v_cndmask_b32 v2,v2,v123,vcc
v_and_b32 v122,1,v1
v_cmp_eq_u32 vcc,0,v122
v_mov_b32 v3,0xdddd
v_mov_b32 v123,0x8888
v_cndmask_b32 v3,v3,v123,vcc
v_lshrrev_b32 v122,1,v120
v_bfe_u32 v123,v120,2,1
v_xor_b32 v123,v123,v122
v_lshlrev_b32 v4,7,v123
v_and_b32 v123,1,v120
v_lshl_add_u32 v4,v123,6,v4
v_xor_b32 v123,v121,v122
v_and_b32 v123,3,v123
v_lshl_add_u32 v4,v123,4,v4
s_lshl_b32 s56,s46,10
s_add_u32 s56,s56,147456
v_add_u32 v4,s56,v4
v_lshlrev_b32 v122,1,v121
v_add_u32 v122,0,v122
v_and_b32 v123,1,v121
v_xor_b32 v123,v123,v122
v_lshlrev_b32 v5,7,v123
v_bfe_u32 v123,v120,3,1
v_lshl_add_u32 v5,v123,6,v5
v_xor_b32 v123,v120,v122
v_and_b32 v123,3,v123
v_lshl_add_u32 v5,v123,4,v5
v_bfe_u32 v123,v120,2,1
v_lshl_add_u32 v5,v123,3,v5
v_add_u32 v5,147456,v5
v_lshlrev_b32 v122,1,v121
v_add_u32 v122,1,v122
v_and_b32 v123,1,v121
v_xor_b32 v123,v123,v122
v_lshlrev_b32 v6,7,v123
v_bfe_u32 v123,v120,3,1
v_lshl_add_u32 v6,v123,6,v6
v_xor_b32 v123,v120,v122
v_and_b32 v123,3,v123
v_lshl_add_u32 v6,v123,4,v6
v_bfe_u32 v123,v120,2,1
v_lshl_add_u32 v6,v123,3,v6
v_add_u32 v6,147456,v6
v_lshlrev_b32 v7,7,v121
v_lshrrev_b32 v122,1,v120
v_lshl_add_u32 v8,v122,4,v7
v_add_u32 v8,151552,v8
v_lshrrev_b32 v122,2,v120
v_lshl_add_u32 v7,v122,5,v7
v_and_b32 v122,1,v120
v_lshl_add_u32 v7,v122,4,v7
v_and_b32 v122,2,v120
v_cmp_eq_u32 vcc,0,v122
s_lshl_b32 s56,s46,9
v_mov_b32 v122,2048
v_mov_b32 v123,s56
v_cndmask_b32 v122,v122,v123,vcc
v_add_u32 v7,v122,v7
v_add_u32 v7,151552,v7
v_lshrrev_b32 v122,3,v1
v_lshlrev_b32 v9,11,v122
v_and_b32 v122,7,v1
v_lshl_add_u32 v9,v122,3,v9
s_lshl_b32 s56,s46,14
s_lshl_b32 s57,s47,6
s_add_u32 s56,s56,s57
v_add_u32 v9,s56,v9
s_lshl_b32 s71,s46,5
s_add_u32 s71,s71,s47
s_bfe_u32 s56,s71,0x10003
s_lshl_b32 s56,s56,11
s_and_b32 s57,s71,1
s_lshl_b32 s57,s57,10
s_add_u32 s56,s56,s57
s_bfe_u32 s57,s71,0x10002
s_lshl_b32 s57,s57,9
s_add_u32 s56,s56,s57
s_bfe_u32 s57,s71,0x10001
s_lshl_b32 s57,s57,6
s_add_u32 s56,s56,s57
s_bfe_u32 s57,s71,0x10004
s_lshl_b32 s57,s57,8
s_add_u32 s56,s56,s57
s_bfe_u32 s57,s71,0x10005
s_lshl_b32 s57,s57,7
s_add_u32 s56,s56,s57
s_bfe_u32 s57,s71,0x10006
s_lshl_b32 s57,s57,12
s_add_u32 s56,s56,s57
v_and_b32 v122,3,v120
v_lshlrev_b32 v10,2,v122
v_bfe_u32 v122,v120,3,1
v_lshl_add_u32 v10,v122,4,v10
v_and_b32 v122,1,v121
v_lshl_add_u32 v10,v122,5,v10
v_add_u32 v10,s56,v10
v_and_b32 v123,36,v1
v_mov_b32 v122,0x80000000
v_cmp_eq_u32 vcc,0,v123
s_nop 1
v_cndmask_b32 v10,v122,v10,vcc
s_lshl_b32 s56,s46,15
v_add_u32 v11,s56,v0
s_lshl_b32 s71,s71,11
s_lshl_b32 s73,s46,11
s_mov_b32 s72,0xffc00000
s_mov_b32 s74,0
v_lshrrev_b32 v13,3,v1
v_lshlrev_b32 v13,9,v13
v_and_b32 v122,7,v1
v_lshl_add_u32 v13,v122,4,v13
v_and_b32 v122,15,v1
v_and_b32 v123,1,v1
v_lshlrev_b32 v123,4,v123
v_mov_b32 v124,0x3f80
v_lshlrev_b32 v124,v123,v124
v_lshrrev_b32 v122,1,v122
v_cmp_eq_u32 vcc,0,v122
s_nop 1
v_cndmask_b32 v18,0,v124,vcc
v_cmp_eq_u32 vcc,1,v122
s_nop 1
v_cndmask_b32 v19,0,v124,vcc
v_cmp_eq_u32 vcc,2,v122
s_nop 1
v_cndmask_b32 v20,0,v124,vcc
v_cmp_eq_u32 vcc,3,v122
s_nop 1
v_cndmask_b32 v21,0,v124,vcc
s_and_b32 s56,s46,1
s_lshl_b32 s56,s56,8
s_and_b32 s57,s46,2
s_lshl_b32 s57,s57,6
s_add_u32 s56,s56,s57
v_add_u32 v13,s56,v13
s_add_u32 s56,s50,155648
v_add_u32 v12,s56,v0
v_mov_b64 v[14:15],s[28:29]
v_mov_b64 v[16:17],s[28:29]
v_add_u32 v22,12599296,v10
s_lshl_b32 s18,s47,2
s_add_u32 s18,s18,10494080
v_mov_b32 v1,s80
s_mov_b32 s65,15728640
s_add_u32 s66,s71,15728640
s_add_u32 s69,s71,15990784
s_mov_b32 s30,0x40000000
s_mov_b32 s51,0
buffer_load_dwordx4 v[56:59],v0,s[8:11],s66 offen offset:0
buffer_load_dwordx4 v[60:63],v0,s[8:11],s66 offen offset:1024
buffer_load_dwordx4 v[64:67],v0,s[8:11],s69 offen offset:0
buffer_load_dwordx4 v[68:71],v0,s[8:11],s69 offen offset:1024
s_waitcnt vmcnt(0)
L_cst_171:
s_cmp_lg_u32 s46,0
s_cbranch_scc1 L_csw_176
s_lshl_b32 s59,s51,13
s_lshl2_add_u32 s59,s47,s59
s_add_u32 s59,s59,10485888
L_ww_177:
s_sleep 1
buffer_load_dword v122,off,s[8:11],s59 sc1
s_sub_u32 s49,s49,1
s_cbranch_scc1 L_abort
s_waitcnt vmcnt(0)
v_readfirstlane_b32 s61,v122
s_cmp_eq_u32 s61,0
s_cbranch_scc1 L_ww_177
L_wwd_178:
L_csw_176:
s_waitcnt lgkmcnt(0)
s_barrier
s_lshl_b32 s56,s51,5
s_add_u32 s56,s56,s47
s_mul_i32 s56,s56,24576
s_add_u32 s56,s56,150994944
s_add_u32 s67,s56,s73
s_add_u32 m0,s73,131072
s_add_u32 s57,s67,8192
buffer_load_dwordx4 v0,s[8:11],s67 offen sc1 lds
buffer_load_dwordx4 v0,s[8:11],s67 offen offset:1024 sc1 lds
s_add_u32 m0,s73,139264
s_add_u32 s67,s67,786432
buffer_load_dwordx4 v0,s[8:11],s57 offen sc1 lds
buffer_load_dwordx4 v0,s[8:11],s57 offen offset:1024 sc1 lds
s_lshl_b32 s75,s51,13
s_add_u32 s56,s75,12591104
buffer_load_dword v23,v10,s[8:11],s56 offen sc1
s_add_u32 s64,s75,12582912
s_add_u32 s70,s64,4096
s_lshl_b32 s68,s51,5
s_add_u32 s68,s68,s47
s_lshl_b32 s68,s68,12
s_lshl_b32 s56,s46,10
s_add_u32 s68,s68,s56
s_add_u32 s68,s68,58720256
s_mov_b32 s54,0x80000000
s_mov_b32 s77,0
s_mov_b32 s19,0
s_cmp_eq_u32 s51,63
s_cselect_b32 s76,1,s46
s_cmp_eq_u32 s76,0
s_cselect_b32 s76,1,0
v_mov_b64 v[96:97],0
v_mov_b64 v[98:99],0
v_mov_b64 v[100:101],0
v_mov_b64 v[102:103],0
v_mov_b64 v[104:105],0
v_mov_b64 v[106:107],0
v_mov_b64 v[108:109],0
v_mov_b64 v[110:111],0
v_mov_b64 v[112:113],0
v_mov_b64 v[114:115],0
v_mov_b64 v[116:117],0
v_mov_b64 v[118:119],0
s_waitcnt vmcnt(0) lgkmcnt(0)
s_barrier
v_add_u32 v55,131072,v0
ds_read_b128 v[56:59],v55 offset:0
ds_read_b128 v[60:63],v55 offset:4096
ds_read_b128 v[64:67],v55 offset:1024
ds_read_b128 v[68:71],v55 offset:5120
ds_read_b128 v[72:75],v55 offset:2048
ds_read_b128 v[76:79],v55 offset:6144
ds_read_b128 v[80:83],v55 offset:3072
ds_read_b128 v[84:87],v55 offset:7168
v_add_u32 v123,s73,v55
ds_read_b128 v[88:91],v123 offset:8192
ds_read_b128 v[92:95],v123 offset:9216
v_xor_b32 v120,1024,v12
v_xor_b32 v121,2048,v12
v_xor_b32 v122,3072,v12
buffer_load_dwordx4 v[24:27],v13,s[8:11],s64 offen sc1
buffer_load_dwordx4 v[24:27],v13,s[8:11],s64 offen sc1
L_chain_179:
L_cpa_180:
buffer_load_dwordx4 v[24:27],v13,s[8:11],s64 offen sc1
s_sub_u32 s49,s49,1
s_cbranch_scc1 L_abort
s_waitcnt vmcnt(2)
v_max3_u32 v123,v24,v25,v26
v_max_u32 v123,v27,v123
v_cmp_le_u32 vcc,s72,v123
ds_write_b128 v12,v[24:27] offset:0
s_cbranch_vccnz L_cpa_180
L_cgo_183:
v_smfmac_f32_16x16x64_bf16 v[96:99],v[24:27],a[0:7],v2
buffer_load_dwordx4 v[40:43],v13,s[8:11],s70 offen sc1
v_smfmac_f32_16x16x64_bf16 v[100:103],v[24:27],a[128:135],v2
s_waitcnt lgkmcnt(0)
s_barrier
ds_read_b128 v[28:31],v120 offset:0
v_smfmac_f32_16x16x64_bf16 v[104:107],v[24:27],a[8:15],v2
ds_read_b128 v[32:35],v121 offset:0
v_smfmac_f32_16x16x64_bf16 v[108:111],v[24:27],a[136:143],v2
ds_read_b128 v[36:39],v122 offset:0
v_smfmac_f32_16x16x64_bf16 v[112:115],v[24:27],v[128:135],v2
v_smfmac_f32_16x16x64_bf16 v[116:119],v[24:27],v[136:143],v2
s_waitcnt lgkmcnt(2)
v_smfmac_f32_16x16x64_bf16 v[96:99],v[28:31],a[16:23],v2
s_add_u32 m0,s73,131072
v_smfmac_f32_16x16x64_bf16 v[100:103],v[28:31],a[144:151],v2
s_add_u32 s57,s67,8192
v_smfmac_f32_16x16x64_bf16 v[104:107],v[28:31],a[24:31],v2
s_cmp_lt_u32 s19,s76
s_cbranch_scc1 L_ckw_172
L_ckb_173:
v_smfmac_f32_16x16x64_bf16 v[108:111],v[28:31],a[152:159],v2
s_waitcnt vmcnt(0) lgkmcnt(1)
v_smfmac_f32_16x16x64_bf16 v[96:99],v[32:35],a[32:39],v2
ds_write_b128 v12,v[40:43] offset:4096
v_max3_u32 v123,v40,v41,v42
v_smfmac_f32_16x16x64_bf16 v[100:103],v[32:35],a[160:167],v2
v_max_u32 v123,v43,v123
v_smfmac_f32_16x16x64_bf16 v[104:107],v[32:35],a[40:47],v2
v_cmp_le_u32 vcc,s72,v123
v_smfmac_f32_16x16x64_bf16 v[108:111],v[32:35],a[168:175],v2
v_smfmac_f32_16x16x64_bf16 v[112:115],v[28:31],v[144:151],v2
s_cbranch_vccnz L_cpb_186
L_cback_188:
s_waitcnt lgkmcnt(0)
s_barrier
v_smfmac_f32_16x16x64_bf16 v[96:99],v[36:39],a[48:55],v2
buffer_store_dword v54,v10,s[8:11],s30 offen sc1
v_smfmac_f32_16x16x64_bf16 v[100:103],v[36:39],a[176:183],v2
ds_read_b128 v[44:47],v120 offset:4096
v_smfmac_f32_16x16x64_bf16 v[104:107],v[36:39],a[56:63],v2
buffer_store_dwordx4 v[124:127],v0,s[8:11],s54 offen sc1
v_smfmac_f32_16x16x64_bf16 v[108:111],v[36:39],a[184:191],v2
ds_read_b128 v[48:51],v121 offset:4096
v_smfmac_f32_16x16x64_bf16 v[96:99],v[40:43],a[64:71],v2
buffer_load_dwordx4 v0,s[8:11],s67 offen sc1 lds
v_smfmac_f32_16x16x64_bf16 v[100:103],v[40:43],a[192:199],v2
ds_read_b128 v[52:55],v122 offset:4096
v_smfmac_f32_16x16x64_bf16 v[104:107],v[40:43],a[72:79],v2
buffer_load_dwordx4 v0,s[8:11],s67 offen offset:1024 sc1 lds
s_add_u32 m0,s73,139264
v_smfmac_f32_16x16x64_bf16 v[108:111],v[40:43],a[200:207],v2
s_waitcnt lgkmcnt(2)
v_smfmac_f32_16x16x64_bf16 v[96:99],v[44:47],a[80:87],v2
buffer_load_dwordx4 v0,s[8:11],s57 offen sc1 lds
s_add_u32 s67,s67,786432
v_smfmac_f32_16x16x64_bf16 v[100:103],v[44:47],a[208:215],v2
s_waitcnt lgkmcnt(1)
v_smfmac_f32_16x16x64_bf16 v[96:99],v[48:51],a[96:103],v2
buffer_load_dwordx4 v0,s[8:11],s57 offen offset:1024 sc1 lds
v_smfmac_f32_16x16x64_bf16 v[100:103],v[48:51],a[224:231],v2
s_waitcnt lgkmcnt(0)
v_smfmac_f32_16x16x64_bf16 v[96:99],v[52:55],a[112:119],v2
buffer_load_dword v23,v22,s[8:11],s75 offen sc1
v_smfmac_f32_16x16x64_bf16 v[100:103],v[52:55],a[240:247],v2
v_smfmac_f32_16x16x64_bf16 v[104:107],v[44:47],a[88:95],v2
v_smfmac_f32_16x16x64_bf16 v[108:111],v[44:47],a[216:223],v2
v_smfmac_f32_16x16x64_bf16 v[104:107],v[48:51],a[104:111],v2
v_add_f32 v96,v96,v98
v_smfmac_f32_16x16x64_bf16 v[108:111],v[48:51],a[232:239],v2
v_add_f32 v97,v97,v99
v_smfmac_f32_16x16x64_bf16 v[104:107],v[52:55],a[120:127],v2
v_cvt_pk_bf16_f32 v120,v96,v97
v_smfmac_f32_16x16x64_bf16 v[108:111],v[52:55],a[248:255],v2
v_add_f32 v100,v100,v102
v_smfmac_f32_16x16x64_bf16 v[116:119],v[28:31],v[152:159],v2
v_add_f32 v101,v101,v103
v_smfmac_f32_16x16x64_bf16 v[112:115],v[32:35],v[160:167],v2
v_cvt_pk_bf16_f32 v121,v100,v101
v_add_f32 v104,v104,v106
v_add_f32 v105,v105,v107
v_cvt_pk_bf16_f32 v122,v104,v105
v_add_f32 v108,v108,v110
v_add_f32 v109,v109,v111
v_cvt_pk_bf16_f32 v123,v108,v109
ds_write_b128 v4,v[120:123]
v_smfmac_f32_16x16x64_bf16 v[116:119],v[32:35],v[168:175],v2
s_mov_b32 s54,s68
s_add_u32 s68,s68,131072
v_mov_b32 v125,0
v_smfmac_f32_16x16x64_bf16 v[112:115],v[36:39],v[176:183],v2
s_cmp_eq_u32 s51,63
s_cbranch_scc1 L_cend_182
v_smfmac_f32_16x16x64_bf16 v[116:119],v[36:39],v[184:191],v2
v_smfmac_f32_16x16x64_bf16 v[112:115],v[40:43],v[192:199],v2
s_waitcnt lgkmcnt(0)
s_barrier
ds_read_b64_tr_b16 v[96:97],v5 offset:0
ds_read_b64_tr_b16 v[98:99],v6 offset:0
v_smfmac_f32_16x16x64_bf16 v[116:119],v[40:43],v[200:207],v2
ds_read_b64_tr_b16 v[100:101],v5 offset:1024
v_smfmac_f32_16x16x64_bf16 v[112:115],v[44:47],v[208:215],v2
ds_read_b64_tr_b16 v[102:103],v6 offset:1024
v_smfmac_f32_16x16x64_bf16 v[116:119],v[44:47],v[216:223],v2
ds_read_b64_tr_b16 v[104:105],v5 offset:2048
v_smfmac_f32_16x16x64_bf16 v[112:115],v[48:51],v[224:231],v2
ds_read_b64_tr_b16 v[106:107],v6 offset:2048
s_waitcnt lgkmcnt(4)
v_mfma_f32_16x16x32_bf16 v[24:27],v[56:59],v[96:99],0
ds_read_b64_tr_b16 v[108:109],v5 offset:3072
v_mfma_f32_16x16x32_bf16 v[28:31],v[60:63],v[96:99],0
ds_read_b64_tr_b16 v[110:111],v6 offset:3072
v_mfma_f32_16x16x32_bf16 v[32:35],v[96:99],v[96:99],0
ds_read_b128 v[40:43],v11 offset:12288
s_waitcnt lgkmcnt(5)
v_mfma_f32_16x16x32_bf16 v[24:27],v[64:67],v[100:103],v[24:27]
ds_read_b128 v[56:59],v11 offset:0
v_mfma_f32_16x16x32_bf16 v[28:31],v[68:71],v[100:103],v[28:31]
ds_read_b128 v[60:63],v11 offset:1024
v_mfma_f32_16x16x32_bf16 v[32:35],v[100:103],v[100:103],v[32:35]
ds_read_b128 v[96:99],v11 offset:8192
s_waitcnt lgkmcnt(6)
v_mfma_f32_16x16x32_bf16 v[24:27],v[72:75],v[104:107],v[24:27]
ds_read_b128 v[64:67],v11 offset:2048
v_mfma_f32_16x16x32_bf16 v[28:31],v[76:79],v[104:107],v[28:31]
ds_read_b128 v[68:71],v11 offset:3072
v_mfma_f32_16x16x32_bf16 v[32:35],v[104:107],v[104:107],v[32:35]
ds_read_b128 v[100:103],v11 offset:9216
s_waitcnt lgkmcnt(7)
v_mfma_f32_16x16x32_bf16 v[24:27],v[80:83],v[108:111],v[24:27]
ds_read_b128 v[72:75],v11 offset:4096
v_mfma_f32_16x16x32_bf16 v[28:31],v[84:87],v[108:111],v[28:31]
ds_read_b128 v[76:79],v11 offset:5120
v_mfma_f32_16x16x32_bf16 v[32:35],v[108:111],v[108:111],v[32:35]
ds_read_b128 v[104:107],v11 offset:10240
v_smfmac_f32_16x16x64_bf16 v[116:119],v[48:51],v[232:239],v2
ds_read_b128 v[80:83],v11 offset:6144
v_smfmac_f32_16x16x64_bf16 v[112:115],v[52:55],v[240:247],v2
ds_read_b128 v[84:87],v11 offset:7168
v_smfmac_f32_16x16x64_bf16 v[116:119],v[52:55],v[248:255],v2
ds_read_b128 v[108:111],v11 offset:11264
v_max3_f32 v126,v24,v25,v26
v_max3_f32 v127,v27,v28,v29
v_max3_f32 v126,v30,v31,v126
v_max3_f32 v127,v34,v35,v127
v_max_f32 v126,v126,v127
v_max_f32 v127,v126,v127
v_pk_mul_f32 v[34:35],v[34:35],v[0:1] op_sel:[0,1]
v_pk_mul_f32 v[24:25],v[24:25],v[0:1] op_sel:[0,1]
v_permlane16_swap_b32 v126,v127
v_max_f32 v126,v126,v127
v_max_f32 v127,v126,v127
v_pk_mul_f32 v[26:27],v[26:27],v[0:1] op_sel:[0,1]
v_pk_mul_f32 v[28:29],v[28:29],v[0:1] op_sel:[0,1]
v_permlane32_swap_b32 v126,v127
v_max_f32 v126,v126,v127
v_mul_f32 v126,v1,v126
v_pk_mul_f32 v[30:31],v[30:31],v[0:1] op_sel:[0,1]
v_pk_add_f32 v[34:35],v[34:35],v[126:127] op_sel_hi:[1,0] neg_lo:[0,1] neg_hi:[0,1]
v_pk_add_f32 v[112:113],v[112:113],v[114:115]
v_pk_add_f32 v[116:117],v[116:117],v[118:119]
v_pk_add_f32 v[24:25],v[24:25],v[126:127] op_sel_hi:[1,0] neg_lo:[0,1] neg_hi:[0,1]
v_pk_add_f32 v[26:27],v[26:27],v[126:127] op_sel_hi:[1,0] neg_lo:[0,1] neg_hi:[0,1]
v_pk_add_f32 v[28:29],v[28:29],v[126:127] op_sel_hi:[1,0] neg_lo:[0,1] neg_hi:[0,1]
v_pk_add_f32 v[30:31],v[30:31],v[126:127] op_sel_hi:[1,0] neg_lo:[0,1] neg_hi:[0,1]
v_exp_f32 v34,v34
v_exp_f32 v35,v35
v_cvt_pk_bf16_f32 v126,v112,v113
v_cvt_pk_bf16_f32 v124,v34,v35
v_cvt_pk_bf16_f32 v127,v116,v117
v_cvt_pk_bf16_f32 v36,v116,v117
v_mfma_f32_16x16x16_bf16 v[32:35],v[14:15],v[124:125],0
ds_read_b128 v[44:47],v11 offset:13312
v_exp_f32 v24,v24
v_mfma_f32_16x16x16_bf16 v[112:115],v[126:127],v[124:125],0
ds_read_b128 v[48:51],v11 offset:14336
v_exp_f32 v25,v25
v_mfma_f32_16x16x16_bf16 v[116:119],v[36:37],v[124:125],0
ds_read_b128 v[52:55],v11 offset:15360
v_exp_f32 v26,v26
v_exp_f32 v27,v27
v_cvt_pk_bf16_f32 v120,v24,v25
v_exp_f32 v28,v28
v_exp_f32 v29,v29
v_cvt_pk_bf16_f32 v121,v26,v27
v_exp_f32 v30,v30
v_exp_f32 v31,v31
v_cvt_pk_bf16_f32 v122,v28,v29
v_cvt_pk_bf16_f32 v123,v30,v31
s_add_u32 s75,s75,8192
s_add_u32 s51,s51,1
v_mfma_f32_16x16x32_bf16 v[32:35],v[14:17],v[120:123],v[32:35]
v_mfma_f32_16x16x32_bf16 v[112:115],v[88:91],v[120:123],v[112:115]
ds_read_b128 v[88:91],v11 offset:16384
v_mfma_f32_16x16x32_bf16 v[116:119],v[92:95],v[120:123],v[116:119]
ds_read_b128 v[92:95],v11 offset:17408
v_rcp_f32 v32,v32
v_mov_b64 v[24:25],-1
v_mov_b64 v[26:27],-1
s_add_u32 s64,s75,12582912
s_add_u32 s70,s64,4096
v_pk_mul_f32 v[112:113],v[112:113],v[32:33] op_sel_hi:[1,0]
v_pk_mul_f32 v[114:115],v[114:115],v[32:33] op_sel_hi:[1,0]
v_pk_mul_f32 v[116:117],v[116:117],v[32:33] op_sel_hi:[1,0]
v_pk_mul_f32 v[118:119],v[118:119],v[32:33] op_sel_hi:[1,0]
v_cvt_pk_bf16_f32 v120,v112,v116
v_cvt_pk_bf16_f32 v121,v113,v117
v_cvt_pk_bf16_f32 v122,v114,v118
v_cvt_pk_bf16_f32 v123,v115,v119
ds_write_b128 v7,v[120:123]
buffer_store_dwordx4 v[24:27],v0,s[8:11],s69 offen
buffer_store_dwordx4 v[24:27],v0,s[8:11],s69 offen offset:1024
v_mov_b64 v[112:113],0
v_mov_b64 v[114:115],0
v_mov_b64 v[116:117],0
v_mov_b64 v[118:119],0
s_waitcnt lgkmcnt(0)
s_barrier
ds_read_b128 v[24:27],v8 offset:0
ds_read_b128 v[28:31],v8 offset:512
ds_read_b128 v[32:35],v8 offset:1024
ds_read_b128 v[36:39],v8 offset:1536
v_mov_b64 v[120:121],0
v_mov_b64 v[122:123],0
s_add_u32 s57,s65,65536
s_add_u32 s58,s65,131072
s_add_u32 s59,s65,196608
s_add_u32 s56,s18,s75
s_add_u32 s30,s75,17825792
s_waitcnt lgkmcnt(3)
v_smfmac_f32_16x16x64_bf16 v[112:115],v[24:27],v[56:63],v3
ds_read_b128 v[56:59],v11 offset:18432
s_waitcnt lgkmcnt(3)
v_smfmac_f32_16x16x64_bf16 v[112:115],v[28:31],v[64:71],v3
ds_read_b128 v[60:63],v11 offset:19456
s_waitcnt lgkmcnt(3)
v_smfmac_f32_16x16x64_bf16 v[112:115],v[32:35],v[72:79],v3
ds_read_b128 v[64:67],v11 offset:20480
s_waitcnt lgkmcnt(3)
v_smfmac_f32_16x16x64_bf16 v[112:115],v[36:39],v[80:87],v3
ds_read_b128 v[68:71],v11 offset:21504
v_smfmac_f32_16x16x64_bf16 v[116:119],v[24:27],v[96:103],v3
ds_read_b128 v[72:75],v11 offset:22528
v_smfmac_f32_16x16x64_bf16 v[116:119],v[28:31],v[104:111],v3
ds_read_b128 v[76:79],v11 offset:23552
v_cvt_pk_bf16_f32 v112,v112,v113
v_smfmac_f32_16x16x64_bf16 v[116:119],v[32:35],v[40:47],v3
ds_read_b128 v[80:83],v11 offset:24576
v_cvt_pk_bf16_f32 v113,v114,v115
buffer_store_dwordx2 v[112:113],v9,s[8:11],s65 offen
v_smfmac_f32_16x16x64_bf16 v[116:119],v[36:39],v[48:55],v3
ds_read_b128 v[84:87],v11 offset:25600
v_mov_b64 v[112:113],0
v_smfmac_f32_16x16x64_bf16 v[120:123],v[24:27],v[88:95],v3
ds_read_b128 v[96:99],v11 offset:26624
ds_read_b128 v[100:103],v11 offset:27648
v_mov_b64 v[114:115],0
s_waitcnt lgkmcnt(8)
v_smfmac_f32_16x16x64_bf16 v[120:123],v[28:31],v[56:63],v3
ds_read_b128 v[104:107],v11 offset:28672
v_cvt_pk_bf16_f32 v116,v116,v117
s_waitcnt lgkmcnt(7)
v_smfmac_f32_16x16x64_bf16 v[120:123],v[32:35],v[64:71],v3
ds_read_b128 v[108:111],v11 offset:29696
ds_read_b128 v[40:43],v11 offset:30720
v_cvt_pk_bf16_f32 v117,v118,v119
buffer_store_dwordx2 v[116:117],v9,s[8:11],s57 offen
s_waitcnt lgkmcnt(7)
v_smfmac_f32_16x16x64_bf16 v[120:123],v[36:39],v[72:79],v3
ds_read_b128 v[44:47],v11 offset:31744
v_add_u32 v52,s50,v5
s_waitcnt lgkmcnt(6)
v_smfmac_f32_16x16x64_bf16 v[112:115],v[24:27],v[80:87],v3
v_add_u32 v54,s50,v6
s_waitcnt lgkmcnt(4)
v_smfmac_f32_16x16x64_bf16 v[112:115],v[28:31],v[96:103],v3
ds_read_b64_tr_b16 v[52:53],v52
v_cvt_pk_bf16_f32 v120,v120,v121
s_waitcnt lgkmcnt(3)
v_smfmac_f32_16x16x64_bf16 v[112:115],v[32:35],v[104:111],v3
ds_read_b64_tr_b16 v[54:55],v54
v_cvt_pk_bf16_f32 v121,v122,v123
buffer_store_dwordx2 v[120:121],v9,s[8:11],s58 offen
s_waitcnt lgkmcnt(2)
v_smfmac_f32_16x16x64_bf16 v[112:115],v[36:39],v[40:47],v3
v_mov_b64 v[116:117],0
v_mov_b64 v[118:119],0
s_xor_b32 s65,s65,262144
v_mov_b32_dpp v124,v126 quad_perm:[2,3,2,3] row_mask:0xf bank_mask:0xf
v_mov_b32_dpp v125,v127 quad_perm:[2,3,2,3] row_mask:0xf bank_mask:0xf
s_mov_b32 vcc_lo,0xcccccccc
s_mov_b32 vcc_hi,0xcccccccc
s_nop 0
v_cvt_pk_bf16_f32 v112,v112,v113
v_cvt_pk_bf16_f32 v113,v114,v115
buffer_store_dwordx2 v[112:113],v9,s[8:11],s59 offen
s_waitcnt lgkmcnt(0)
s_buffer_load_dword s19,s[8:11],s56
v_cndmask_b32 v124,v124,v52,vcc
v_cndmask_b32 v125,v125,v53,vcc
v_cndmask_b32 v126,v126,v54,vcc
v_cndmask_b32 v127,v127,v55,vcc
s_cmp_lt_u32 s46,2
s_waitcnt vmcnt(3)
s_cbranch_scc1 L_crg_189
s_cmp_eq_u32 s46,2
s_waitcnt vmcnt(1)
s_cbranch_scc1 L_crg_189
s_waitcnt vmcnt(0)
L_crg_189:
buffer_load_dwordx4 v[32:35],v0,s[8:11],s66 offen offset:0 sc1
buffer_load_dwordx4 v[36:39],v0,s[8:11],s66 offen offset:1024 sc1
v_mov_b64 v[96:97],0
v_mov_b64 v[98:99],0
v_mov_b64 v[100:101],0
v_mov_b64 v[102:103],0
v_mov_b64 v[104:105],0
v_mov_b64 v[106:107],0
v_mov_b64 v[108:109],0
v_mov_b64 v[110:111],0
v_mov_b64 v[112:113],0
v_mov_b64 v[114:115],0
v_add_u32 v55,131072,v0
v_add_u32 v123,s73,v55
v_xor_b32 v120,1024,v12
v_xor_b32 v121,2048,v12
v_xor_b32 v122,3072,v12
buffer_load_dwordx4 v[44:47],v0,s[8:11],s66 offen offset:0 sc1
buffer_load_dwordx4 v[48:51],v0,s[8:11],s66 offen offset:1024 sc1
s_cmp_ge_u32 s51,63
s_cselect_b32 s76,0,1
s_cmp_eq_u32 s46,0
s_cselect_b32 s76,s76,0
s_waitcnt vmcnt(3)
v_mfma_f32_16x16x32_bf16 v[28:31],v[18:21],v[32:35],0
s_waitcnt vmcnt(2)
v_mfma_f32_16x16x32_bf16 v[28:31],v[18:21],v[36:39],v[28:31]
s_nop 7
v_cmp_u_f32 vcc,v28,v28
v_add_f32_dpp v52,v28,v28 row_ror:8 row_mask:0xf bank_mask:0x3
v_add_f32_dpp v53,v29,v29 row_ror:8 row_mask:0xf bank_mask:0x3
v_add_f32_dpp v52,v30,v30 row_ror:8 row_mask:0xf bank_mask:0xc
v_add_f32_dpp v53,v31,v31 row_ror:8 row_mask:0xf bank_mask:0xc
s_nop 0
v_add_f32_dpp v52,v52,v52 row_shl:4 row_mask:0xf bank_mask:0x5
v_add_f32_dpp v53,v53,v53 row_shl:4 row_mask:0xf bank_mask:0x5
s_cbranch_vccnz L_crp_184
L_cok_190:
v_cvt_pk_bf16_f32 v54,v52,v53
buffer_store_dword v54,v10,s[8:11],s64 offen
s_mov_b32 s69,s66
s_xor_b32 s66,s66,262144
s_barrier
ds_read_b128 v[56:59],v55 offset:0
ds_read_b128 v[60:63],v55 offset:4096
ds_read_b128 v[64:67],v55 offset:1024
buffer_load_dwordx4 v[24:27],v13,s[8:11],s64 offen sc1
ds_read_b128 v[68:71],v55 offset:5120
ds_read_b128 v[72:75],v55 offset:2048
ds_read_b128 v[76:79],v55 offset:6144
ds_read_b128 v[80:83],v55 offset:3072
buffer_load_dwordx4 v[24:27],v13,s[8:11],s64 offen sc1
ds_read_b128 v[84:87],v55 offset:7168
ds_read_b128 v[88:91],v123 offset:8192
ds_read_b128 v[92:95],v123 offset:9216
s_branch L_chain_179
L_cpb_186:
buffer_load_dwordx4 v[40:43],v13,s[8:11],s70 offen sc1
s_sub_u32 s49,s49,1
s_cbranch_scc1 L_abort
s_waitcnt vmcnt(0)
v_max3_u32 v123,v40,v41,v42
v_max_u32 v123,v43,v123
v_cmp_le_u32 vcc,s72,v123
s_cbranch_vccnz L_cpb_186
ds_write_b128 v12,v[40:43] offset:4096
s_branch L_cback_188
L_crp_184:
buffer_load_dwordx4 v[32:35],v0,s[8:11],s66 offen offset:0 sc1
buffer_load_dwordx4 v[36:39],v0,s[8:11],s66 offen offset:1024 sc1
s_sub_u32 s49,s49,1
s_cbranch_scc1 L_abort
s_waitcnt vmcnt(3)
v_mfma_f32_16x16x32_bf16 v[28:31],v[18:21],v[44:47],0
s_waitcnt vmcnt(2)
v_mfma_f32_16x16x32_bf16 v[28:31],v[18:21],v[48:51],v[28:31]
s_nop 7
v_cmp_u_f32 vcc,v28,v28
v_add_f32_dpp v52,v28,v28 row_ror:8 row_mask:0xf bank_mask:0x3
v_add_f32_dpp v53,v29,v29 row_ror:8 row_mask:0xf bank_mask:0x3
v_add_f32_dpp v52,v30,v30 row_ror:8 row_mask:0xf bank_mask:0xc
v_add_f32_dpp v53,v31,v31 row_ror:8 row_mask:0xf bank_mask:0xc
s_nop 0
v_add_f32_dpp v52,v52,v52 row_shl:4 row_mask:0xf bank_mask:0x5
v_add_f32_dpp v53,v53,v53 row_shl:4 row_mask:0xf bank_mask:0x5
s_cbranch_vccz L_cok_190
buffer_load_dwordx4 v[44:47],v0,s[8:11],s66 offen offset:0 sc1
buffer_load_dwordx4 v[48:51],v0,s[8:11],s66 offen offset:1024 sc1
s_sub_u32 s49,s49,1
s_cbranch_scc1 L_abort
s_waitcnt vmcnt(3)
v_mfma_f32_16x16x32_bf16 v[28:31],v[18:21],v[32:35],0
s_waitcnt vmcnt(2)
v_mfma_f32_16x16x32_bf16 v[28:31],v[18:21],v[36:39],v[28:31]
s_nop 7
v_cmp_u_f32 vcc,v28,v28
v_add_f32_dpp v52,v28,v28 row_ror:8 row_mask:0xf bank_mask:0x3
v_add_f32_dpp v53,v29,v29 row_ror:8 row_mask:0xf bank_mask:0x3
v_add_f32_dpp v52,v30,v30 row_ror:8 row_mask:0xf bank_mask:0xc
v_add_f32_dpp v53,v31,v31 row_ror:8 row_mask:0xf bank_mask:0xc
s_nop 0
v_add_f32_dpp v52,v52,v52 row_shl:4 row_mask:0xf bank_mask:0x5
v_add_f32_dpp v53,v53,v53 row_shl:4 row_mask:0xf bank_mask:0x5
s_cbranch_vccz L_cok_190
s_branch L_crp_184
L_ckw_172:
s_add_u32 s59,s18,s75
L_ww_191:
s_sleep 1
buffer_load_dword v23,off,s[8:11],s59 sc1
s_sub_u32 s49,s49,1
s_cbranch_scc1 L_abort
s_waitcnt vmcnt(0)
v_readfirstlane_b32 s76,v23
s_cmp_eq_u32 s76,0
s_cbranch_scc1 L_ww_191
L_wwd_192:
s_branch L_ckb_173
L_cend_182:
v_smfmac_f32_16x16x64_bf16 v[116:119],v[36:39],v[184:191],v2
v_smfmac_f32_16x16x64_bf16 v[112:115],v[40:43],v[192:199],v2
v_smfmac_f32_16x16x64_bf16 v[116:119],v[40:43],v[200:207],v2
v_smfmac_f32_16x16x64_bf16 v[112:115],v[44:47],v[208:215],v2
v_smfmac_f32_16x16x64_bf16 v[116:119],v[44:47],v[216:223],v2
v_smfmac_f32_16x16x64_bf16 v[112:115],v[48:51],v[224:231],v2
v_smfmac_f32_16x16x64_bf16 v[116:119],v[48:51],v[232:239],v2
v_smfmac_f32_16x16x64_bf16 v[112:115],v[52:55],v[240:247],v2
v_smfmac_f32_16x16x64_bf16 v[116:119],v[52:55],v[248:255],v2
s_waitcnt lgkmcnt(0)
s_nop 2
v_pk_add_f32 v[112:113],v[112:113],v[114:115]
s_nop 2
v_pk_add_f32 v[116:117],v[116:117],v[118:119]
v_cvt_pk_bf16_f32 v126,v112,v113
v_cvt_pk_bf16_f32 v127,v116,v117
v_add_u32 v52,s50,v5
v_add_u32 v54,s50,v6
ds_read_b64_tr_b16 v[52:53],v52
ds_read_b64_tr_b16 v[54:55],v54
v_mov_b32_dpp v124,v126 quad_perm:[2,3,2,3] row_mask:0xf bank_mask:0xf
v_mov_b32_dpp v125,v127 quad_perm:[2,3,2,3] row_mask:0xf bank_mask:0xf
s_mov_b32 vcc_lo,0xcccccccc
s_mov_b32 vcc_hi,0xcccccccc
s_waitcnt lgkmcnt(0)
v_cndmask_b32 v124,v124,v52,vcc
v_cndmask_b32 v125,v125,v53,vcc
v_cndmask_b32 v126,v126,v54,vcc
v_cndmask_b32 v127,v127,v55,vcc
buffer_store_dwordx4 v[124:127],v0,s[8:11],s54 offen sc1
s_mov_b32 s51,64
s_waitcnt vmcnt(0)
s_barrier
s_nop 11
v_lshrrev_b32 v1,4,v0
s_endpgm
L_rc2_142:
v_and_b32 v120,15,v1
v_lshrrev_b32 v121,4,v1
v_and_b32 v122,2,v1
v_cmp_eq_u32 vcc,0,v122
v_mov_b32 v2,0xeeee
v_mov_b32 v123,0x4444
v_cndmask_b32 v2,v2,v123,vcc
v_and_b32 v122,1,v1
v_cmp_eq_u32 vcc,0,v122
v_mov_b32 v3,0xdddd
v_mov_b32 v123,0x8888
v_cndmask_b32 v3,v3,v123,vcc
v_lshrrev_b32 v122,1,v120
v_bfe_u32 v123,v120,2,1
v_xor_b32 v123,v123,v122
v_lshlrev_b32 v4,7,v123
v_and_b32 v123,1,v120
v_lshl_add_u32 v4,v123,6,v4
v_xor_b32 v123,v121,v122
v_and_b32 v123,3,v123
v_lshl_add_u32 v4,v123,4,v4
s_lshl_b32 s56,s46,10
s_add_u32 s56,s56,147456
v_add_u32 v4,s56,v4
v_lshlrev_b32 v122,1,v121
v_add_u32 v122,0,v122
v_and_b32 v123,1,v121
v_xor_b32 v123,v123,v122
v_lshlrev_b32 v5,7,v123
v_bfe_u32 v123,v120,3,1
v_lshl_add_u32 v5,v123,6,v5
v_xor_b32 v123,v120,v122
v_and_b32 v123,3,v123
v_lshl_add_u32 v5,v123,4,v5
v_bfe_u32 v123,v120,2,1
v_lshl_add_u32 v5,v123,3,v5
v_add_u32 v5,147456,v5
v_lshlrev_b32 v122,1,v121
v_add_u32 v122,1,v122
v_and_b32 v123,1,v121
v_xor_b32 v123,v123,v122
v_lshlrev_b32 v6,7,v123
v_bfe_u32 v123,v120,3,1
v_lshl_add_u32 v6,v123,6,v6
v_xor_b32 v123,v120,v122
v_and_b32 v123,3,v123
v_lshl_add_u32 v6,v123,4,v6
v_bfe_u32 v123,v120,2,1
v_lshl_add_u32 v6,v123,3,v6
v_add_u32 v6,147456,v6
v_lshlrev_b32 v7,7,v121
v_lshrrev_b32 v122,1,v120
v_lshl_add_u32 v8,v122,4,v7
v_add_u32 v8,151552,v8
v_lshrrev_b32 v122,2,v120
v_lshl_add_u32 v7,v122,5,v7
v_and_b32 v122,1,v120
v_lshl_add_u32 v7,v122,4,v7
v_and_b32 v122,2,v120
v_cmp_eq_u32 vcc,0,v122
s_lshl_b32 s56,s46,9
v_mov_b32 v122,2048
v_mov_b32 v123,s56
v_cndmask_b32 v122,v122,v123,vcc
v_add_u32 v7,v122,v7
v_add_u32 v7,151552,v7
v_lshrrev_b32 v122,3,v1
v_lshlrev_b32 v9,11,v122
v_and_b32 v122,7,v1
v_lshl_add_u32 v9,v122,3,v9
s_lshl_b32 s56,s46,14
s_lshl_b32 s57,s47,6
s_add_u32 s56,s56,s57
v_add_u32 v9,s56,v9
s_lshl_b32 s71,s46,5
s_add_u32 s71,s71,s47
s_bfe_u32 s56,s71,0x10003
s_lshl_b32 s56,s56,11
s_and_b32 s57,s71,1
s_lshl_b32 s57,s57,10
s_add_u32 s56,s56,s57
s_bfe_u32 s57,s71,0x10002
s_lshl_b32 s57,s57,9
s_add_u32 s56,s56,s57
s_bfe_u32 s57,s71,0x10001
s_lshl_b32 s57,s57,6
s_add_u32 s56,s56,s57
s_bfe_u32 s57,s71,0x10004
s_lshl_b32 s57,s57,8
s_add_u32 s56,s56,s57
s_bfe_u32 s57,s71,0x10005
s_lshl_b32 s57,s57,7
s_add_u32 s56,s56,s57
s_bfe_u32 s57,s71,0x10006
s_lshl_b32 s57,s57,12
s_add_u32 s56,s56,s57
v_and_b32 v122,3,v120
v_lshlrev_b32 v10,2,v122
v_bfe_u32 v122,v120,3,1
v_lshl_add_u32 v10,v122,4,v10
v_and_b32 v122,1,v121
v_lshl_add_u32 v10,v122,5,v10
v_add_u32 v10,s56,v10
v_and_b32 v123,36,v1
v_mov_b32 v122,0x80000000
v_cmp_eq_u32 vcc,0,v123
s_nop 1
v_cndmask_b32 v10,v122,v10,vcc
s_lshl_b32 s56,s46,15
v_add_u32 v11,s56,v0
s_lshl_b32 s71,s71,11
s_lshl_b32 s73,s46,11
s_mov_b32 s72,0xffc00000
s_mov_b32 s74,0
v_lshrrev_b32 v13,3,v1
v_lshlrev_b32 v13,9,v13
v_and_b32 v122,7,v1
v_lshl_add_u32 v13,v122,4,v13
v_and_b32 v122,15,v1
v_and_b32 v123,1,v1
v_lshlrev_b32 v123,4,v123
v_mov_b32 v124,0x3f80
v_lshlrev_b32 v124,v123,v124
v_lshrrev_b32 v122,1,v122
v_cmp_eq_u32 vcc,0,v122
s_nop 1
v_cndmask_b32 v18,0,v124,vcc
v_cmp_eq_u32 vcc,1,v122
s_nop 1
v_cndmask_b32 v19,0,v124,vcc
v_cmp_eq_u32 vcc,2,v122
s_nop 1
v_cndmask_b32 v20,0,v124,vcc
v_cmp_eq_u32 vcc,3,v122
s_nop 1
v_cndmask_b32 v21,0,v124,vcc
s_and_b32 s56,s46,1
s_lshl_b32 s56,s56,8
s_and_b32 s57,s46,2
s_lshl_b32 s57,s57,6
s_add_u32 s56,s56,s57
v_add_u32 v13,s56,v13
s_add_u32 s56,s50,155648
v_add_u32 v12,s56,v0
v_mov_b64 v[14:15],s[28:29]
v_mov_b64 v[16:17],s[28:29]
v_add_u32 v22,13647872,v10
s_lshl_b32 s18,s47,2
s_add_u32 s18,s18,10494080
v_mov_b32 v1,s80
s_mov_b32 s65,16777216
s_add_u32 s66,s71,16777216
s_add_u32 s69,s71,17039360
s_mov_b32 s30,0x40000000
s_mov_b32 s51,0
v_lshrrev_b32 v120,2,v0
v_add_u32 v120,10510464,v120
v_or_b32 v120,s52,v120
s_mov_b64 vcc,-1
s_mov_b32 vcc_lo,0
v_cndmask_b32 v22,v22,v120,vcc
s_or_b32 s56,s52,10495616
v_writelane_b32 v22,s56,4
s_or_b32 s56,s47,s46
s_mov_b32 s56,10486784
s_cmov_b32 s56,0x80000000
v_writelane_b32 v22,s56,5
s_mov_b32 s30,0
s_mov_b32 s31,0
buffer_load_dwordx4 v[56:59],v0,s[8:11],s66 offen offset:0
buffer_load_dwordx4 v[60:63],v0,s[8:11],s66 offen offset:1024
buffer_load_dwordx4 v[64:67],v0,s[8:11],s69 offen offset:0
buffer_load_dwordx4 v[68:71],v0,s[8:11],s69 offen offset:1024
s_waitcnt vmcnt(0)
L_cst_196:
s_cmp_lg_u32 s46,0
s_cbranch_scc1 L_csw_201
s_lshl_b32 s59,s31,13
s_add_u32 s59,s59,10486016
v_lshrrev_b32 v121,2,v0
v_and_b32 v121,127,v121
L_ckk_202:
s_sleep 1
buffer_load_dword v120,v121,s[8:11],s59 offen sc1
s_sub_u32 s49,s49,1
s_cbranch_scc1 L_abort
s_waitcnt vmcnt(0)
v_cmp_eq_u32 vcc,0,v120
s_cbranch_vccnz L_ckk_202
v_max_u32_dpp v120,v120,v120 row_ror:8 row_mask:0xf bank_mask:0xf
s_nop 1
v_max_u32_dpp v120,v120,v120 row_ror:4 row_mask:0xf bank_mask:0xf
s_nop 1
v_max_u32_dpp v120,v120,v120 row_ror:2 row_mask:0xf bank_mask:0xf
s_nop 1
v_max_u32_dpp v120,v120,v120 row_ror:1 row_mask:0xf bank_mask:0xf
v_mov_b32 v121,v120
s_nop 1
v_permlane16_swap_b32 v120,v121
v_max_u32 v120,v120,v121
v_mov_b32 v121,v120
s_nop 1
v_permlane32_swap_b32 v120,v121
v_max_u32 v120,v120,v121
s_nop 0
v_readfirstlane_b32 s61,v120
s_max_u32 s30,s30,s61
s_add_u32 s31,s31,1
s_andn2_b32 s51,0x7ff,s30
s_lshr_b32 s51,s51,5
s_add_u32 s61,s51,2
s_min_u32 s61,s61,63
s_cmp_le_u32 s31,s61
s_cbranch_scc1 L_cst_196
v_mov_b32 v120,0
v_mov_b32 v121,s30
ds_write_b32 v8,v120 offset:2560
ds_write_b32 v8,v121 offset:3072
s_lshl_b32 s59,s51,13
s_lshl2_add_u32 s59,s47,s59
s_add_u32 s59,s59,10485888
L_ww_203:
s_sleep 1
buffer_load_dword v122,off,s[8:11],s59 sc1
s_sub_u32 s49,s49,1
s_cbranch_scc1 L_abort
s_waitcnt vmcnt(0)
v_readfirstlane_b32 s61,v122
s_cmp_eq_u32 s61,0
s_cbranch_scc1 L_ww_203
L_wwd_204:
L_csw_201:
s_waitcnt lgkmcnt(0)
s_barrier
ds_read_b32 v120,v8 offset:3072
s_waitcnt lgkmcnt(0)
v_readfirstlane_b32 s30,v120
s_andn2_b32 s51,0x7ff,s30
s_lshr_b32 s51,s51,5
s_lshl_b32 s56,s51,5
s_add_u32 s56,s56,s47
s_mul_i32 s56,s56,24576
s_add_u32 s56,s56,150994944
s_add_u32 s67,s56,s73
s_add_u32 m0,s73,131072
s_add_u32 s57,s67,8192
buffer_load_dwordx4 v0,s[8:11],s67 offen sc1 lds
buffer_load_dwordx4 v0,s[8:11],s67 offen offset:1024 sc1 lds
s_add_u32 m0,s73,139264
s_add_u32 s67,s67,786432
buffer_load_dwordx4 v0,s[8:11],s57 offen sc1 lds
buffer_load_dwordx4 v0,s[8:11],s57 offen offset:1024 sc1 lds
s_lshl_b32 s75,s51,13
s_add_u32 s56,s75,13639680
buffer_load_dword v23,v10,s[8:11],s56 offen sc1
s_add_u32 s64,s75,17825792
s_add_u32 s70,s64,4096
s_lshl_b32 s68,s51,5
s_add_u32 s68,s68,s47
s_lshl_b32 s68,s68,12
s_lshl_b32 s56,s46,10
s_add_u32 s68,s68,s56
s_add_u32 s68,s68,75497472
s_mov_b32 s54,0x80000000
s_mov_b32 s77,0
s_mov_b32 s19,0
s_cmp_eq_u32 s51,63
s_cselect_b32 s76,1,s46
s_cmp_eq_u32 s76,0
s_cselect_b32 s76,1,0
v_mov_b64 v[96:97],0
v_mov_b64 v[98:99],0
v_mov_b64 v[100:101],0
v_mov_b64 v[102:103],0
v_mov_b64 v[104:105],0
v_mov_b64 v[106:107],0
v_mov_b64 v[108:109],0
v_mov_b64 v[110:111],0
v_mov_b64 v[112:113],0
v_mov_b64 v[114:115],0
v_mov_b64 v[116:117],0
v_mov_b64 v[118:119],0
v_lshrrev_b32 v56,8,v0
v_lshlrev_b32 v56,5,v56
v_bfe_u32 v57,v0,5,1
v_lshl_add_u32 v56,v57,2,v56
s_lshl_b32 s56,s46,7
s_add_u32 s56,s56,155648
v_add_u32 v56,s56,v56
v_xor_b32 v57,128,v56
v_xor_b32 v58,256,v56
v_xor_b32 v59,384,v56
s_andn2_b32 s56,31,s30
s_lshr_b32 s57,s56,4
s_lshl_b32 s58,s57,12
s_and_b32 s59,s56,15
s_lshl4_add_u32 s58,s59,s58
s_add_u32 s58,s58,s50
s_add_u32 s58,s58,131072
v_bfe_u32 v60,v0,6,2
v_lshlrev_b32 v60,8,v60
v_bfe_u32 v61,v0,4,2
v_lshl_add_u32 v60,v61,2,v60
v_add_u32 v60,s58,v60
s_lshr_b32 s58,s59,2
s_lshl_b32 s58,s58,8
s_lshl3_add_u32 s58,s57,s58
s_and_b32 s59,s56,3
s_lshl1_add_u32 s58,s59,s58
s_add_u32 s58,s58,s73
s_add_u32 s58,s58,139264
v_and_b32 v61,255,v0
v_add_u32 v61,s58,v61
s_cmp_lg_u32 s46,0
s_cbranch_scc1 L_chd_206
s_lshl_b32 s59,s51,10
s_add_u32 s59,s59,11337728
L_chp_205:
buffer_load_dwordx4 v[120:123],v0,s[8:11],s59 offen sc1
s_sub_u32 s49,s49,1
s_cbranch_scc1 L_abort
s_waitcnt vmcnt(0)
v_max3_u32 v124,v120,v121,v122
v_max_u32 v124,v123,v124
v_cmp_eq_u32 vcc,-1,v124
s_cbranch_vccnz L_chp_205
ds_write_b128 v12,v[120:123]
L_chd_206:
s_waitcnt vmcnt(0) lgkmcnt(0)
s_barrier
ds_read2_b32 v[24:25],v56 offset0:0 offset1:2
ds_read2_b32 v[26:27],v56 offset0:4 offset1:6
ds_read2_b32 v[28:29],v57 offset0:0 offset1:2
ds_read2_b32 v[30:31],v57 offset0:4 offset1:6
ds_read2_b32 v[32:33],v58 offset0:0 offset1:2
ds_read2_b32 v[34:35],v58 offset0:4 offset1:6
ds_read2_b32 v[36:37],v59 offset0:0 offset1:2
ds_read2_b32 v[38:39],v59 offset0:4 offset1:6
s_waitcnt lgkmcnt(4)
ds_read2_b32 v[40:41],v56 offset0:128 offset1:130
ds_read2_b32 v[42:43],v56 offset0:132 offset1:134
ds_read2_b32 v[44:45],v57 offset0:128 offset1:130
ds_read2_b32 v[46:47],v57 offset0:132 offset1:134
ds_read2_b32 v[48:49],v58 offset0:128 offset1:130
ds_read2_b32 v[50:51],v58 offset0:132 offset1:134
ds_read2_b32 v[52:53],v59 offset0:128 offset1:130
ds_read2_b32 v[54:55],v59 offset0:132 offset1:134
s_waitcnt lgkmcnt(12)
v_smfmac_f32_16x16x64_bf16 v[100:103],v[24:27],a[128:135],v2
v_smfmac_f32_16x16x64_bf16 v[112:115],v[24:27],v[128:135],v2
v_smfmac_f32_16x16x64_bf16 v[108:111],v[24:27],a[136:143],v2
v_smfmac_f32_16x16x64_bf16 v[116:119],v[24:27],v[136:143],v2
s_waitcnt lgkmcnt(12)
v_smfmac_f32_16x16x64_bf16 v[100:103],v[28:31],a[144:151],v2
v_smfmac_f32_16x16x64_bf16 v[112:115],v[28:31],v[144:151],v2
v_smfmac_f32_16x16x64_bf16 v[108:111],v[28:31],a[152:159],v2
v_smfmac_f32_16x16x64_bf16 v[116:119],v[28:31],v[152:159],v2
s_waitcnt lgkmcnt(10)
v_smfmac_f32_16x16x64_bf16 v[100:103],v[32:35],a[160:167],v2
v_smfmac_f32_16x16x64_bf16 v[112:115],v[32:35],v[160:167],v2
v_smfmac_f32_16x16x64_bf16 v[108:111],v[32:35],a[168:175],v2
v_smfmac_f32_16x16x64_bf16 v[116:119],v[32:35],v[168:175],v2
s_waitcnt lgkmcnt(8)
v_smfmac_f32_16x16x64_bf16 v[100:103],v[36:39],a[176:183],v2
v_smfmac_f32_16x16x64_bf16 v[112:115],v[36:39],v[176:183],v2
v_smfmac_f32_16x16x64_bf16 v[108:111],v[36:39],a[184:191],v2
v_smfmac_f32_16x16x64_bf16 v[116:119],v[36:39],v[184:191],v2
s_waitcnt lgkmcnt(6)
v_smfmac_f32_16x16x64_bf16 v[100:103],v[40:43],a[192:199],v2
v_smfmac_f32_16x16x64_bf16 v[112:115],v[40:43],v[192:199],v2
v_smfmac_f32_16x16x64_bf16 v[108:111],v[40:43],a[200:207],v2
v_smfmac_f32_16x16x64_bf16 v[116:119],v[40:43],v[200:207],v2
s_waitcnt lgkmcnt(4)
v_smfmac_f32_16x16x64_bf16 v[100:103],v[44:47],a[208:215],v2
v_smfmac_f32_16x16x64_bf16 v[112:115],v[44:47],v[208:215],v2
v_smfmac_f32_16x16x64_bf16 v[108:111],v[44:47],a[216:223],v2
v_smfmac_f32_16x16x64_bf16 v[116:119],v[44:47],v[216:223],v2
s_waitcnt lgkmcnt(2)
v_smfmac_f32_16x16x64_bf16 v[100:103],v[48:51],a[224:231],v2
v_smfmac_f32_16x16x64_bf16 v[112:115],v[48:51],v[224:231],v2
v_smfmac_f32_16x16x64_bf16 v[108:111],v[48:51],a[232:239],v2
v_smfmac_f32_16x16x64_bf16 v[116:119],v[48:51],v[232:239],v2
s_waitcnt lgkmcnt(0)
v_smfmac_f32_16x16x64_bf16 v[100:103],v[52:55],a[240:247],v2
v_smfmac_f32_16x16x64_bf16 v[112:115],v[52:55],v[240:247],v2
v_smfmac_f32_16x16x64_bf16 v[108:111],v[52:55],a[248:255],v2
v_smfmac_f32_16x16x64_bf16 v[116:119],v[52:55],v[248:255],v2
v_add_f32 v100,v100,v102
v_add_f32 v112,v112,v114
s_nop 1
v_add_f32 v108,v108,v110
s_nop 2
v_add_f32 v116,v116,v118
v_cvt_pk_bf16_f32 v120,v100,v108
v_cvt_pk_bf16_f32 v121,v112,v116
ds_write_b32 v60,v120
ds_write_b16 v61,v121
ds_write_b16_d16_hi v61,v121 offset:1024
v_mov_b64 v[96:97],0
v_mov_b64 v[98:99],0
v_mov_b64 v[100:101],0
v_mov_b64 v[102:103],0
v_mov_b64 v[104:105],0
v_mov_b64 v[106:107],0
v_mov_b64 v[108:109],0
v_mov_b64 v[110:111],0
v_mov_b64 v[112:113],0
v_mov_b64 v[114:115],0
v_mov_b64 v[116:117],0
v_mov_b64 v[118:119],0
s_waitcnt vmcnt(0) lgkmcnt(0)
s_barrier
v_add_u32 v55,131072,v0
ds_read_b128 v[56:59],v55 offset:0
ds_read_b128 v[60:63],v55 offset:4096
ds_read_b128 v[64:67],v55 offset:1024
ds_read_b128 v[68:71],v55 offset:5120
ds_read_b128 v[72:75],v55 offset:2048
ds_read_b128 v[76:79],v55 offset:6144
ds_read_b128 v[80:83],v55 offset:3072
ds_read_b128 v[84:87],v55 offset:7168
v_add_u32 v123,s73,v55
ds_read_b128 v[88:91],v123 offset:8192
ds_read_b128 v[92:95],v123 offset:9216
v_xor_b32 v120,1024,v12
v_xor_b32 v121,2048,v12
v_xor_b32 v122,3072,v12
buffer_load_dwordx4 v[24:27],v13,s[8:11],s64 offen sc1
buffer_load_dwordx4 v[24:27],v13,s[8:11],s64 offen sc1
L_chain_207:
L_cpa_208:
buffer_load_dwordx4 v[24:27],v13,s[8:11],s64 offen sc1
s_sub_u32 s49,s49,1
s_cbranch_scc1 L_abort
s_waitcnt vmcnt(2)
v_max3_u32 v123,v24,v25,v26
v_max_u32 v123,v27,v123
v_cmp_le_u32 vcc,s72,v123
ds_write_b128 v12,v[24:27] offset:0
s_cbranch_vccnz L_cpa_208
L_cgo_211:
v_smfmac_f32_16x16x64_bf16 v[96:99],v[24:27],a[0:7],v2
buffer_load_dwordx4 v[40:43],v13,s[8:11],s70 offen sc1
v_smfmac_f32_16x16x64_bf16 v[100:103],v[24:27],a[128:135],v2
s_waitcnt lgkmcnt(0)
s_barrier
ds_read_b128 v[28:31],v120 offset:0
v_smfmac_f32_16x16x64_bf16 v[104:107],v[24:27],a[8:15],v2
ds_read_b128 v[32:35],v121 offset:0
v_smfmac_f32_16x16x64_bf16 v[108:111],v[24:27],a[136:143],v2
ds_read_b128 v[36:39],v122 offset:0
v_smfmac_f32_16x16x64_bf16 v[112:115],v[24:27],v[128:135],v2
v_smfmac_f32_16x16x64_bf16 v[116:119],v[24:27],v[136:143],v2
s_waitcnt lgkmcnt(2)
v_smfmac_f32_16x16x64_bf16 v[96:99],v[28:31],a[16:23],v2
s_add_u32 m0,s73,131072
v_smfmac_f32_16x16x64_bf16 v[100:103],v[28:31],a[144:151],v2
s_add_u32 s57,s67,8192
v_smfmac_f32_16x16x64_bf16 v[104:107],v[28:31],a[24:31],v2
s_cmp_lt_u32 s19,s76
s_cbranch_scc1 L_ckw_197
L_ckb_198:
v_smfmac_f32_16x16x64_bf16 v[108:111],v[28:31],a[152:159],v2
s_waitcnt vmcnt(0) lgkmcnt(1)
v_smfmac_f32_16x16x64_bf16 v[96:99],v[32:35],a[32:39],v2
ds_write_b128 v12,v[40:43] offset:4096
v_max3_u32 v123,v40,v41,v42
v_smfmac_f32_16x16x64_bf16 v[100:103],v[32:35],a[160:167],v2
v_max_u32 v123,v43,v123
v_smfmac_f32_16x16x64_bf16 v[104:107],v[32:35],a[40:47],v2
v_cmp_le_u32 vcc,s72,v123
v_smfmac_f32_16x16x64_bf16 v[108:111],v[32:35],a[168:175],v2
v_smfmac_f32_16x16x64_bf16 v[112:115],v[28:31],v[144:151],v2
s_cbranch_vccnz L_cpb_214
L_cback_216:
s_waitcnt lgkmcnt(0)
s_barrier
v_smfmac_f32_16x16x64_bf16 v[96:99],v[36:39],a[48:55],v2
buffer_store_dwordx4 v[124:127],v0,s[8:11],s54 offen sc1
v_smfmac_f32_16x16x64_bf16 v[100:103],v[36:39],a[176:183],v2
ds_read_b128 v[44:47],v120 offset:4096
v_smfmac_f32_16x16x64_bf16 v[104:107],v[36:39],a[56:63],v2
buffer_load_dwordx4 v0,s[8:11],s67 offen sc1 lds
v_smfmac_f32_16x16x64_bf16 v[108:111],v[36:39],a[184:191],v2
ds_read_b128 v[48:51],v121 offset:4096
v_smfmac_f32_16x16x64_bf16 v[96:99],v[40:43],a[64:71],v2
buffer_load_dwordx4 v0,s[8:11],s67 offen offset:1024 sc1 lds
s_add_u32 m0,s73,139264
v_smfmac_f32_16x16x64_bf16 v[100:103],v[40:43],a[192:199],v2
ds_read_b128 v[52:55],v122 offset:4096
v_smfmac_f32_16x16x64_bf16 v[104:107],v[40:43],a[72:79],v2
buffer_load_dwordx4 v0,s[8:11],s57 offen sc1 lds
s_add_u32 s67,s67,786432
v_smfmac_f32_16x16x64_bf16 v[108:111],v[40:43],a[200:207],v2
ds_read_b32 v123,v8 offset:2560
s_waitcnt lgkmcnt(3)
v_smfmac_f32_16x16x64_bf16 v[96:99],v[44:47],a[80:87],v2
buffer_load_dwordx4 v0,s[8:11],s57 offen offset:1024 sc1 lds
v_smfmac_f32_16x16x64_bf16 v[100:103],v[44:47],a[208:215],v2
s_waitcnt lgkmcnt(2)
v_smfmac_f32_16x16x64_bf16 v[96:99],v[48:51],a[96:103],v2
buffer_load_dword v23,v22,s[8:11],s75 offen sc1
v_smfmac_f32_16x16x64_bf16 v[100:103],v[48:51],a[224:231],v2
s_waitcnt lgkmcnt(0)
v_smfmac_f32_16x16x64_bf16 v[96:99],v[52:55],a[112:119],v2
v_smfmac_f32_16x16x64_bf16 v[100:103],v[52:55],a[240:247],v2
v_readfirstlane_b32 s58,v123
v_smfmac_f32_16x16x64_bf16 v[104:107],v[44:47],a[88:95],v2
v_smfmac_f32_16x16x64_bf16 v[108:111],v[44:47],a[216:223],v2
s_cmp_lg_u32 s58,0
s_cbranch_scc1 L_cjump_200
v_smfmac_f32_16x16x64_bf16 v[104:107],v[48:51],a[104:111],v2
v_add_f32 v96,v96,v98
v_smfmac_f32_16x16x64_bf16 v[108:111],v[48:51],a[232:239],v2
v_add_f32 v97,v97,v99
v_smfmac_f32_16x16x64_bf16 v[104:107],v[52:55],a[120:127],v2
v_cvt_pk_bf16_f32 v120,v96,v97
v_smfmac_f32_16x16x64_bf16 v[108:111],v[52:55],a[248:255],v2
v_add_f32 v100,v100,v102
v_smfmac_f32_16x16x64_bf16 v[116:119],v[28:31],v[152:159],v2
v_add_f32 v101,v101,v103
v_smfmac_f32_16x16x64_bf16 v[112:115],v[32:35],v[160:167],v2
v_cvt_pk_bf16_f32 v121,v100,v101
v_add_f32 v104,v104,v106
v_add_f32 v105,v105,v107
v_cvt_pk_bf16_f32 v122,v104,v105
v_add_f32 v108,v108,v110
v_add_f32 v109,v109,v111
v_cvt_pk_bf16_f32 v123,v108,v109
ds_write_b128 v4,v[120:123]
v_smfmac_f32_16x16x64_bf16 v[116:119],v[32:35],v[168:175],v2
s_mov_b32 s54,s68
s_add_u32 s68,s68,131072
v_mov_b32 v125,0
v_smfmac_f32_16x16x64_bf16 v[112:115],v[36:39],v[176:183],v2
s_cmp_eq_u32 s51,63
s_cbranch_scc1 L_cend_210
v_smfmac_f32_16x16x64_bf16 v[116:119],v[36:39],v[184:191],v2
v_smfmac_f32_16x16x64_bf16 v[112:115],v[40:43],v[192:199],v2
s_waitcnt lgkmcnt(0)
s_barrier
ds_read_b64_tr_b16 v[96:97],v5 offset:0
ds_read_b64_tr_b16 v[98:99],v6 offset:0
v_smfmac_f32_16x16x64_bf16 v[116:119],v[40:43],v[200:207],v2
ds_read_b64_tr_b16 v[100:101],v5 offset:1024
v_smfmac_f32_16x16x64_bf16 v[112:115],v[44:47],v[208:215],v2
ds_read_b64_tr_b16 v[102:103],v6 offset:1024
v_smfmac_f32_16x16x64_bf16 v[116:119],v[44:47],v[216:223],v2
ds_read_b64_tr_b16 v[104:105],v5 offset:2048
v_smfmac_f32_16x16x64_bf16 v[112:115],v[48:51],v[224:231],v2
ds_read_b64_tr_b16 v[106:107],v6 offset:2048
s_waitcnt lgkmcnt(4)
v_mfma_f32_16x16x32_bf16 v[24:27],v[56:59],v[96:99],0
ds_read_b64_tr_b16 v[108:109],v5 offset:3072
v_mfma_f32_16x16x32_bf16 v[28:31],v[60:63],v[96:99],0
ds_read_b64_tr_b16 v[110:111],v6 offset:3072
v_mfma_f32_16x16x32_bf16 v[32:35],v[96:99],v[96:99],0
ds_read_b128 v[40:43],v11 offset:12288
s_waitcnt lgkmcnt(5)
v_mfma_f32_16x16x32_bf16 v[24:27],v[64:67],v[100:103],v[24:27]
ds_read_b128 v[56:59],v11 offset:0
v_mfma_f32_16x16x32_bf16 v[28:31],v[68:71],v[100:103],v[28:31]
ds_read_b128 v[60:63],v11 offset:1024
v_mfma_f32_16x16x32_bf16 v[32:35],v[100:103],v[100:103],v[32:35]
ds_read_b128 v[96:99],v11 offset:8192
s_waitcnt lgkmcnt(6)
v_mfma_f32_16x16x32_bf16 v[24:27],v[72:75],v[104:107],v[24:27]
ds_read_b128 v[64:67],v11 offset:2048
v_mfma_f32_16x16x32_bf16 v[28:31],v[76:79],v[104:107],v[28:31]
ds_read_b128 v[68:71],v11 offset:3072
v_mfma_f32_16x16x32_bf16 v[32:35],v[104:107],v[104:107],v[32:35]
ds_read_b128 v[100:103],v11 offset:9216
s_waitcnt lgkmcnt(7)
v_mfma_f32_16x16x32_bf16 v[24:27],v[80:83],v[108:111],v[24:27]
ds_read_b128 v[72:75],v11 offset:4096
v_mfma_f32_16x16x32_bf16 v[28:31],v[84:87],v[108:111],v[28:31]
ds_read_b128 v[76:79],v11 offset:5120
v_mfma_f32_16x16x32_bf16 v[32:35],v[108:111],v[108:111],v[32:35]
ds_read_b128 v[104:107],v11 offset:10240
v_smfmac_f32_16x16x64_bf16 v[116:119],v[48:51],v[232:239],v2
ds_read_b128 v[80:83],v11 offset:6144
v_smfmac_f32_16x16x64_bf16 v[112:115],v[52:55],v[240:247],v2
ds_read_b128 v[84:87],v11 offset:7168
v_smfmac_f32_16x16x64_bf16 v[116:119],v[52:55],v[248:255],v2
ds_read_b128 v[108:111],v11 offset:11264
v_max3_f32 v126,v24,v25,v26
v_max3_f32 v127,v27,v28,v29
v_max3_f32 v126,v30,v31,v126
v_max3_f32 v127,v34,v35,v127
v_max_f32 v126,v126,v127
v_max_f32 v127,v126,v127
v_pk_mul_f32 v[34:35],v[34:35],v[0:1] op_sel:[0,1]
v_pk_mul_f32 v[24:25],v[24:25],v[0:1] op_sel:[0,1]
v_permlane16_swap_b32 v126,v127
v_max_f32 v126,v126,v127
v_max_f32 v127,v126,v127
v_pk_mul_f32 v[26:27],v[26:27],v[0:1] op_sel:[0,1]
v_pk_mul_f32 v[28:29],v[28:29],v[0:1] op_sel:[0,1]
v_permlane32_swap_b32 v126,v127
v_max_f32 v126,v126,v127
v_mul_f32 v126,v1,v126
v_pk_mul_f32 v[30:31],v[30:31],v[0:1] op_sel:[0,1]
v_pk_add_f32 v[34:35],v[34:35],v[126:127] op_sel_hi:[1,0] neg_lo:[0,1] neg_hi:[0,1]
v_pk_add_f32 v[112:113],v[112:113],v[114:115]
v_pk_add_f32 v[116:117],v[116:117],v[118:119]
v_pk_add_f32 v[24:25],v[24:25],v[126:127] op_sel_hi:[1,0] neg_lo:[0,1] neg_hi:[0,1]
v_pk_add_f32 v[26:27],v[26:27],v[126:127] op_sel_hi:[1,0] neg_lo:[0,1] neg_hi:[0,1]
v_pk_add_f32 v[28:29],v[28:29],v[126:127] op_sel_hi:[1,0] neg_lo:[0,1] neg_hi:[0,1]
v_pk_add_f32 v[30:31],v[30:31],v[126:127] op_sel_hi:[1,0] neg_lo:[0,1] neg_hi:[0,1]
v_exp_f32 v34,v34
v_exp_f32 v35,v35
v_cvt_pk_bf16_f32 v126,v112,v113
v_cvt_pk_bf16_f32 v124,v34,v35
v_cvt_pk_bf16_f32 v127,v116,v117
v_cvt_pk_bf16_f32 v36,v116,v117
v_mfma_f32_16x16x16_bf16 v[32:35],v[14:15],v[124:125],0
ds_read_b128 v[44:47],v11 offset:13312
v_exp_f32 v24,v24
v_mfma_f32_16x16x16_bf16 v[112:115],v[126:127],v[124:125],0
ds_read_b128 v[48:51],v11 offset:14336
v_exp_f32 v25,v25
v_mfma_f32_16x16x16_bf16 v[116:119],v[36:37],v[124:125],0
ds_read_b128 v[52:55],v11 offset:15360
v_exp_f32 v26,v26
v_exp_f32 v27,v27
v_cvt_pk_bf16_f32 v120,v24,v25
v_exp_f32 v28,v28
v_exp_f32 v29,v29
v_cvt_pk_bf16_f32 v121,v26,v27
v_exp_f32 v30,v30
v_exp_f32 v31,v31
v_cvt_pk_bf16_f32 v122,v28,v29
v_cvt_pk_bf16_f32 v123,v30,v31
s_add_u32 s75,s75,8192
s_add_u32 s51,s51,1
v_mfma_f32_16x16x32_bf16 v[32:35],v[14:17],v[120:123],v[32:35]
v_mfma_f32_16x16x32_bf16 v[112:115],v[88:91],v[120:123],v[112:115]
ds_read_b128 v[88:91],v11 offset:16384
v_mfma_f32_16x16x32_bf16 v[116:119],v[92:95],v[120:123],v[116:119]
ds_read_b128 v[92:95],v11 offset:17408
v_rcp_f32 v32,v32
v_mov_b64 v[24:25],-1
v_mov_b64 v[26:27],-1
s_add_u32 s64,s75,13631488
s_add_u32 s70,s64,4096
v_pk_mul_f32 v[112:113],v[112:113],v[32:33] op_sel_hi:[1,0]
v_pk_mul_f32 v[114:115],v[114:115],v[32:33] op_sel_hi:[1,0]
v_pk_mul_f32 v[116:117],v[116:117],v[32:33] op_sel_hi:[1,0]
v_pk_mul_f32 v[118:119],v[118:119],v[32:33] op_sel_hi:[1,0]
v_cvt_pk_bf16_f32 v120,v112,v116
v_cvt_pk_bf16_f32 v121,v113,v117
v_cvt_pk_bf16_f32 v122,v114,v118
v_cvt_pk_bf16_f32 v123,v115,v119
ds_write_b128 v7,v[120:123]
buffer_store_dwordx4 v[24:27],v0,s[8:11],s69 offen
buffer_store_dwordx4 v[24:27],v0,s[8:11],s69 offen offset:1024
v_mov_b64 v[112:113],0
v_mov_b64 v[114:115],0
v_mov_b64 v[116:117],0
v_mov_b64 v[118:119],0
s_waitcnt lgkmcnt(0)
s_barrier
ds_read_b128 v[24:27],v8 offset:0
ds_read_b128 v[28:31],v8 offset:512
ds_read_b128 v[32:35],v8 offset:1024
ds_read_b128 v[36:39],v8 offset:1536
v_mov_b64 v[120:121],0
v_mov_b64 v[122:123],0
s_add_u32 s57,s65,65536
s_add_u32 s58,s65,131072
s_add_u32 s59,s65,196608
s_add_u32 s56,s18,s75
s_waitcnt lgkmcnt(3)
v_smfmac_f32_16x16x64_bf16 v[112:115],v[24:27],v[56:63],v3
ds_read_b128 v[56:59],v11 offset:18432
s_waitcnt lgkmcnt(3)
v_smfmac_f32_16x16x64_bf16 v[112:115],v[28:31],v[64:71],v3
ds_read_b128 v[60:63],v11 offset:19456
s_waitcnt lgkmcnt(3)
v_smfmac_f32_16x16x64_bf16 v[112:115],v[32:35],v[72:79],v3
ds_read_b128 v[64:67],v11 offset:20480
s_waitcnt lgkmcnt(3)
v_smfmac_f32_16x16x64_bf16 v[112:115],v[36:39],v[80:87],v3
ds_read_b128 v[68:71],v11 offset:21504
v_smfmac_f32_16x16x64_bf16 v[116:119],v[24:27],v[96:103],v3
ds_read_b128 v[72:75],v11 offset:22528
v_smfmac_f32_16x16x64_bf16 v[116:119],v[28:31],v[104:111],v3
ds_read_b128 v[76:79],v11 offset:23552
v_cvt_pk_bf16_f32 v112,v112,v113
v_smfmac_f32_16x16x64_bf16 v[116:119],v[32:35],v[40:47],v3
ds_read_b128 v[80:83],v11 offset:24576
v_cvt_pk_bf16_f32 v113,v114,v115
buffer_store_dwordx2 v[112:113],v9,s[8:11],s65 offen
v_smfmac_f32_16x16x64_bf16 v[116:119],v[36:39],v[48:55],v3
ds_read_b128 v[84:87],v11 offset:25600
v_mov_b64 v[112:113],0
v_smfmac_f32_16x16x64_bf16 v[120:123],v[24:27],v[88:95],v3
ds_read_b128 v[96:99],v11 offset:26624
ds_read_b128 v[100:103],v11 offset:27648
v_mov_b64 v[114:115],0
s_waitcnt lgkmcnt(8)
v_smfmac_f32_16x16x64_bf16 v[120:123],v[28:31],v[56:63],v3
ds_read_b128 v[104:107],v11 offset:28672
v_cvt_pk_bf16_f32 v116,v116,v117
s_waitcnt lgkmcnt(7)
v_smfmac_f32_16x16x64_bf16 v[120:123],v[32:35],v[64:71],v3
ds_read_b128 v[108:111],v11 offset:29696
ds_read_b128 v[40:43],v11 offset:30720
v_cvt_pk_bf16_f32 v117,v118,v119
buffer_store_dwordx2 v[116:117],v9,s[8:11],s57 offen
s_waitcnt lgkmcnt(7)
v_smfmac_f32_16x16x64_bf16 v[120:123],v[36:39],v[72:79],v3
ds_read_b128 v[44:47],v11 offset:31744
v_add_u32 v52,s50,v5
s_waitcnt lgkmcnt(6)
v_smfmac_f32_16x16x64_bf16 v[112:115],v[24:27],v[80:87],v3
v_add_u32 v54,s50,v6
s_waitcnt lgkmcnt(4)
v_smfmac_f32_16x16x64_bf16 v[112:115],v[28:31],v[96:103],v3
ds_read_b64_tr_b16 v[52:53],v52
v_cvt_pk_bf16_f32 v120,v120,v121
s_waitcnt lgkmcnt(3)
v_smfmac_f32_16x16x64_bf16 v[112:115],v[32:35],v[104:111],v3
ds_read_b64_tr_b16 v[54:55],v54
v_cvt_pk_bf16_f32 v121,v122,v123
buffer_store_dwordx2 v[120:121],v9,s[8:11],s58 offen
s_waitcnt lgkmcnt(2)
v_smfmac_f32_16x16x64_bf16 v[112:115],v[36:39],v[40:47],v3
v_mov_b64 v[116:117],0
v_mov_b64 v[118:119],0
s_xor_b32 s65,s65,262144
v_mov_b32_dpp v124,v126 quad_perm:[2,3,2,3] row_mask:0xf bank_mask:0xf
v_mov_b32_dpp v125,v127 quad_perm:[2,3,2,3] row_mask:0xf bank_mask:0xf
s_mov_b32 vcc_lo,0xcccccccc
s_mov_b32 vcc_hi,0xcccccccc
s_nop 0
v_cvt_pk_bf16_f32 v112,v112,v113
v_cvt_pk_bf16_f32 v113,v114,v115
buffer_store_dwordx2 v[112:113],v9,s[8:11],s59 offen
s_waitcnt lgkmcnt(0)
s_buffer_load_dword s19,s[8:11],s56
v_cndmask_b32 v124,v124,v52,vcc
v_cndmask_b32 v125,v125,v53,vcc
v_cndmask_b32 v126,v126,v54,vcc
v_cndmask_b32 v127,v127,v55,vcc
s_cmp_lt_u32 s46,2
s_waitcnt vmcnt(3)
s_cbranch_scc1 L_crg_217
s_cmp_eq_u32 s46,2
s_waitcnt vmcnt(1)
s_cbranch_scc1 L_crg_217
s_waitcnt vmcnt(0)
L_crg_217:
buffer_load_dwordx4 v[32:35],v0,s[8:11],s66 offen offset:0 sc1
buffer_load_dwordx4 v[36:39],v0,s[8:11],s66 offen offset:1024 sc1
v_mov_b64 v[96:97],0
v_mov_b64 v[98:99],0
v_mov_b64 v[100:101],0
v_mov_b64 v[102:103],0
v_mov_b64 v[104:105],0
v_mov_b64 v[106:107],0
v_mov_b64 v[108:109],0
v_mov_b64 v[110:111],0
v_mov_b64 v[112:113],0
v_mov_b64 v[114:115],0
v_add_u32 v55,131072,v0
v_add_u32 v123,s73,v55
v_xor_b32 v120,1024,v12
v_xor_b32 v121,2048,v12
v_xor_b32 v122,3072,v12
buffer_load_dwordx4 v[44:47],v0,s[8:11],s66 offen offset:0 sc1
buffer_load_dwordx4 v[48:51],v0,s[8:11],s66 offen offset:1024 sc1
s_cmp_ge_u32 s51,63
s_cselect_b32 s76,0,1
v_readlane_b32 s56,v23,5
v_readlane_b32 s20,v23,4
v_add_u32 v23,-1,v23
v_cmp_le_u32 vcc,s30,v23
s_cmp_gt_u32 s51,61
s_cselect_b32 s77,0,vcc_hi
s_cmp_gt_u32 s20,s30
s_cselect_b32 s77,1,s77
s_cmp_lg_u32 s77,0
s_cselect_b32 s76,2,s76
s_cmp_gt_u32 s56,s30
s_cbranch_scc1 L_cld_193
L_clb_194:
s_cmp_eq_u32 s46,0
s_cselect_b32 s76,s76,0
s_waitcnt vmcnt(3)
v_mfma_f32_16x16x32_bf16 v[28:31],v[18:21],v[32:35],0
s_waitcnt vmcnt(2)
v_mfma_f32_16x16x32_bf16 v[28:31],v[18:21],v[36:39],v[28:31]
s_nop 7
v_cmp_u_f32 vcc,v28,v28
v_add_f32_dpp v52,v28,v28 row_ror:8 row_mask:0xf bank_mask:0x3
v_add_f32_dpp v53,v29,v29 row_ror:8 row_mask:0xf bank_mask:0x3
v_add_f32_dpp v52,v30,v30 row_ror:8 row_mask:0xf bank_mask:0xc
v_add_f32_dpp v53,v31,v31 row_ror:8 row_mask:0xf bank_mask:0xc
s_nop 0
v_add_f32_dpp v52,v52,v52 row_shl:4 row_mask:0xf bank_mask:0x5
v_add_f32_dpp v53,v53,v53 row_shl:4 row_mask:0xf bank_mask:0x5
s_cbranch_vccnz L_crp_212
L_cok_218:
v_cvt_pk_bf16_f32 v54,v52,v53
buffer_store_dword v54,v10,s[8:11],s64 offen
s_mov_b32 s69,s66
s_xor_b32 s66,s66,262144
s_barrier
ds_read_b128 v[56:59],v55 offset:0
ds_read_b128 v[60:63],v55 offset:4096
ds_read_b128 v[64:67],v55 offset:1024
buffer_load_dwordx4 v[24:27],v13,s[8:11],s64 offen sc1
ds_read_b128 v[68:71],v55 offset:5120
ds_read_b128 v[72:75],v55 offset:2048
ds_read_b128 v[76:79],v55 offset:6144
ds_read_b128 v[80:83],v55 offset:3072
buffer_load_dwordx4 v[24:27],v13,s[8:11],s64 offen sc1
ds_read_b128 v[84:87],v55 offset:7168
ds_read_b128 v[88:91],v123 offset:8192
ds_read_b128 v[92:95],v123 offset:9216
s_branch L_chain_207
L_cpb_214:
buffer_load_dwordx4 v[40:43],v13,s[8:11],s70 offen sc1
s_sub_u32 s49,s49,1
s_cbranch_scc1 L_abort
s_waitcnt vmcnt(0)
v_max3_u32 v123,v40,v41,v42
v_max_u32 v123,v43,v123
v_cmp_le_u32 vcc,s72,v123
s_cbranch_vccnz L_cpb_214
ds_write_b128 v12,v[40:43] offset:4096
s_branch L_cback_216
L_crp_212:
buffer_load_dwordx4 v[32:35],v0,s[8:11],s66 offen offset:0 sc1
buffer_load_dwordx4 v[36:39],v0,s[8:11],s66 offen offset:1024 sc1
s_sub_u32 s49,s49,1
s_cbranch_scc1 L_abort
s_waitcnt vmcnt(3)
v_mfma_f32_16x16x32_bf16 v[28:31],v[18:21],v[44:47],0
s_waitcnt vmcnt(2)
v_mfma_f32_16x16x32_bf16 v[28:31],v[18:21],v[48:51],v[28:31]
s_nop 7
v_cmp_u_f32 vcc,v28,v28
v_add_f32_dpp v52,v28,v28 row_ror:8 row_mask:0xf bank_mask:0x3
v_add_f32_dpp v53,v29,v29 row_ror:8 row_mask:0xf bank_mask:0x3
v_add_f32_dpp v52,v30,v30 row_ror:8 row_mask:0xf bank_mask:0xc
v_add_f32_dpp v53,v31,v31 row_ror:8 row_mask:0xf bank_mask:0xc
s_nop 0
v_add_f32_dpp v52,v52,v52 row_shl:4 row_mask:0xf bank_mask:0x5
v_add_f32_dpp v53,v53,v53 row_shl:4 row_mask:0xf bank_mask:0x5
s_cbranch_vccz L_cok_218
buffer_load_dwordx4 v[44:47],v0,s[8:11],s66 offen offset:0 sc1
buffer_load_dwordx4 v[48:51],v0,s[8:11],s66 offen offset:1024 sc1
s_sub_u32 s49,s49,1
s_cbranch_scc1 L_abort
s_waitcnt vmcnt(3)
v_mfma_f32_16x16x32_bf16 v[28:31],v[18:21],v[32:35],0
s_waitcnt vmcnt(2)
v_mfma_f32_16x16x32_bf16 v[28:31],v[18:21],v[36:39],v[28:31]
s_nop 7
v_cmp_u_f32 vcc,v28,v28
v_add_f32_dpp v52,v28,v28 row_ror:8 row_mask:0xf bank_mask:0x3
v_add_f32_dpp v53,v29,v29 row_ror:8 row_mask:0xf bank_mask:0x3
v_add_f32_dpp v52,v30,v30 row_ror:8 row_mask:0xf bank_mask:0xc
v_add_f32_dpp v53,v31,v31 row_ror:8 row_mask:0xf bank_mask:0xc
s_nop 0
v_add_f32_dpp v52,v52,v52 row_shl:4 row_mask:0xf bank_mask:0x5
v_add_f32_dpp v53,v53,v53 row_shl:4 row_mask:0xf bank_mask:0x5
s_cbranch_vccz L_cok_218
s_branch L_crp_212
L_ckw_197:
s_cmp_eq_u32 s77,0
s_cbranch_scc1 L_cjw_199
s_andn2_b32 s31,0x7ff,s20
s_lshr_b32 s31,s31,5
s_cmp_gt_u32 s20,s30
s_cbranch_scc1 L_cjs_195
s_add_u32 s31,s51,2
s_lshl_b32 s59,s31,13
s_add_u32 s59,s59,10486016
v_lshrrev_b32 v45,2,v0
v_and_b32 v45,127,v45
L_ckk_219:
s_sleep 1
buffer_load_dword v44,v45,s[8:11],s59 offen sc1
s_sub_u32 s49,s49,1
s_cbranch_scc1 L_abort
s_waitcnt vmcnt(0)
v_cmp_eq_u32 vcc,0,v44
s_cbranch_vccnz L_ckk_219
v_cmp_lt_u32 vcc,s30,v44
s_cbranch_vccz L_cjw_199
L_cjs_195:
ds_write_b32 v8,v2 offset:2560
s_waitcnt lgkmcnt(0)
s_branch L_ckb_198
L_cld_193:
v_mov_b32 v23,s56
s_add_u32 s56,s75,10495616
buffer_store_dword v23,off,s[8:11],s56
s_waitcnt vmcnt(0)
s_branch L_clb_194
L_cjw_199:
s_cmp_lg_u32 s19,0
s_cbranch_scc1 L_ckb_198
s_add_u32 s59,s18,s75
L_ww_220:
s_sleep 1
buffer_load_dword v23,off,s[8:11],s59 sc1
s_sub_u32 s49,s49,1
s_cbranch_scc1 L_abort
s_waitcnt vmcnt(0)
v_readfirstlane_b32 s76,v23
s_cmp_eq_u32 s76,0
s_cbranch_scc1 L_ww_220
L_wwd_221:
s_branch L_ckb_198
L_cjump_200:
s_waitcnt vmcnt(0) lgkmcnt(0)
s_barrier
s_branch L_cst_196
L_cend_210:
v_smfmac_f32_16x16x64_bf16 v[116:119],v[36:39],v[184:191],v2
v_smfmac_f32_16x16x64_bf16 v[112:115],v[40:43],v[192:199],v2
v_smfmac_f32_16x16x64_bf16 v[116:119],v[40:43],v[200:207],v2
v_smfmac_f32_16x16x64_bf16 v[112:115],v[44:47],v[208:215],v2
v_smfmac_f32_16x16x64_bf16 v[116:119],v[44:47],v[216:223],v2
v_smfmac_f32_16x16x64_bf16 v[112:115],v[48:51],v[224:231],v2
v_smfmac_f32_16x16x64_bf16 v[116:119],v[48:51],v[232:239],v2
v_smfmac_f32_16x16x64_bf16 v[112:115],v[52:55],v[240:247],v2
v_smfmac_f32_16x16x64_bf16 v[116:119],v[52:55],v[248:255],v2
s_waitcnt lgkmcnt(0)
s_nop 2
v_pk_add_f32 v[112:113],v[112:113],v[114:115]
s_nop 2
v_pk_add_f32 v[116:117],v[116:117],v[118:119]
v_cvt_pk_bf16_f32 v126,v112,v113
v_cvt_pk_bf16_f32 v127,v116,v117
v_add_u32 v52,s50,v5
v_add_u32 v54,s50,v6
ds_read_b64_tr_b16 v[52:53],v52
ds_read_b64_tr_b16 v[54:55],v54
v_mov_b32_dpp v124,v126 quad_perm:[2,3,2,3] row_mask:0xf bank_mask:0xf
v_mov_b32_dpp v125,v127 quad_perm:[2,3,2,3] row_mask:0xf bank_mask:0xf
s_mov_b32 vcc_lo,0xcccccccc
s_mov_b32 vcc_hi,0xcccccccc
s_waitcnt lgkmcnt(0)
v_cndmask_b32 v124,v124,v52,vcc
v_cndmask_b32 v125,v125,v53,vcc
v_cndmask_b32 v126,v126,v54,vcc
v_cndmask_b32 v127,v127,v55,vcc
buffer_store_dwordx4 v[124:127],v0,s[8:11],s54 offen sc1
s_mov_b32 s51,64
s_waitcnt vmcnt(0)
s_barrier
s_nop 11
v_lshrrev_b32 v1,4,v0
s_endpgm
L_abort2:
s_endpgm
L_wc:
s_nop 11
s_cmp_eq_u32 s48,1
s_cbranch_scc1 L_rc1_222
s_cmp_eq_u32 s48,2
s_cbranch_scc1 L_rc2_223
v_and_b32 v120,15,v1
v_lshrrev_b32 v121,4,v1
v_and_b32 v122,2,v1
v_cmp_eq_u32 vcc,0,v122
v_mov_b32 v2,0xeeee
v_mov_b32 v123,0x4444
v_cndmask_b32 v2,v2,v123,vcc
v_and_b32 v122,1,v1
v_cmp_eq_u32 vcc,0,v122
v_mov_b32 v3,0xdddd
v_mov_b32 v123,0x8888
v_cndmask_b32 v3,v3,v123,vcc
v_lshrrev_b32 v122,1,v120
v_bfe_u32 v123,v120,2,1
v_xor_b32 v123,v123,v122
v_lshlrev_b32 v4,7,v123
v_and_b32 v123,1,v120
v_lshl_add_u32 v4,v123,6,v4
v_xor_b32 v123,v121,v122
v_and_b32 v123,3,v123
v_lshl_add_u32 v4,v123,4,v4
s_lshl_b32 s56,s46,10
s_add_u32 s56,s56,147456
v_add_u32 v4,s56,v4
v_lshlrev_b32 v122,1,v121
v_add_u32 v122,0,v122
v_and_b32 v123,1,v121
v_xor_b32 v123,v123,v122
v_lshlrev_b32 v5,7,v123
v_bfe_u32 v123,v120,3,1
v_lshl_add_u32 v5,v123,6,v5
v_xor_b32 v123,v120,v122
v_and_b32 v123,3,v123
v_lshl_add_u32 v5,v123,4,v5
v_bfe_u32 v123,v120,2,1
v_lshl_add_u32 v5,v123,3,v5
v_add_u32 v5,147456,v5
v_lshlrev_b32 v122,1,v121
v_add_u32 v122,1,v122
v_and_b32 v123,1,v121
v_xor_b32 v123,v123,v122
v_lshlrev_b32 v6,7,v123
v_bfe_u32 v123,v120,3,1
v_lshl_add_u32 v6,v123,6,v6
v_xor_b32 v123,v120,v122
v_and_b32 v123,3,v123
v_lshl_add_u32 v6,v123,4,v6
v_bfe_u32 v123,v120,2,1
v_lshl_add_u32 v6,v123,3,v6
v_add_u32 v6,147456,v6
v_lshlrev_b32 v7,7,v121
v_lshrrev_b32 v122,1,v120
v_lshl_add_u32 v8,v122,4,v7
v_add_u32 v8,151552,v8
v_lshrrev_b32 v122,2,v120
v_lshl_add_u32 v7,v122,5,v7
v_and_b32 v122,1,v120
v_lshl_add_u32 v7,v122,4,v7
v_and_b32 v122,2,v120
v_cmp_eq_u32 vcc,0,v122
s_lshl_b32 s56,s46,9
v_mov_b32 v122,2048
v_mov_b32 v123,s56
v_cndmask_b32 v122,v122,v123,vcc
v_add_u32 v7,v122,v7
v_add_u32 v7,151552,v7
v_lshrrev_b32 v122,3,v1
v_lshlrev_b32 v9,11,v122
v_and_b32 v122,7,v1
v_lshl_add_u32 v9,v122,3,v9
s_lshl_b32 s56,s46,14
s_lshl_b32 s57,s47,6
s_add_u32 s56,s56,s57
v_add_u32 v9,s56,v9
s_lshl_b32 s71,s46,5
s_add_u32 s71,s71,s47
s_bfe_u32 s56,s71,0x10003
s_lshl_b32 s56,s56,11
s_and_b32 s57,s71,1
s_lshl_b32 s57,s57,10
s_add_u32 s56,s56,s57
s_bfe_u32 s57,s71,0x10002
s_lshl_b32 s57,s57,9
s_add_u32 s56,s56,s57
s_bfe_u32 s57,s71,0x10001
s_lshl_b32 s57,s57,6
s_add_u32 s56,s56,s57
s_bfe_u32 s57,s71,0x10004
s_lshl_b32 s57,s57,8
s_add_u32 s56,s56,s57
s_bfe_u32 s57,s71,0x10005
s_lshl_b32 s57,s57,7
s_add_u32 s56,s56,s57
s_bfe_u32 s57,s71,0x10006
s_lshl_b32 s57,s57,12
s_add_u32 s56,s56,s57
v_and_b32 v122,3,v120
v_lshlrev_b32 v10,2,v122
v_bfe_u32 v122,v120,3,1
v_lshl_add_u32 v10,v122,4,v10
v_and_b32 v122,1,v121
v_lshl_add_u32 v10,v122,5,v10
v_add_u32 v10,s56,v10
v_and_b32 v123,36,v1
v_mov_b32 v122,0x80000000
v_cmp_eq_u32 vcc,0,v123
s_nop 1
v_cndmask_b32 v10,v122,v10,vcc
s_lshl_b32 s56,s46,15
v_add_u32 v11,s56,v0
s_lshl_b32 s71,s71,11
s_lshl_b32 s73,s46,11
s_mov_b32 s72,0xffc00000
s_mov_b32 s74,0
v_lshrrev_b32 v13,3,v1
v_lshlrev_b32 v13,9,v13
v_and_b32 v122,7,v1
v_lshl_add_u32 v13,v122,4,v13
v_and_b32 v122,15,v1
v_and_b32 v123,1,v1
v_lshlrev_b32 v123,4,v123
v_mov_b32 v124,0x3f80
v_lshlrev_b32 v124,v123,v124
v_lshrrev_b32 v122,1,v122
v_cmp_eq_u32 vcc,0,v122
s_nop 1
v_cndmask_b32 v18,0,v124,vcc
v_cmp_eq_u32 vcc,1,v122
s_nop 1
v_cndmask_b32 v19,0,v124,vcc
v_cmp_eq_u32 vcc,2,v122
s_nop 1
v_cndmask_b32 v20,0,v124,vcc
v_cmp_eq_u32 vcc,3,v122
s_nop 1
v_cndmask_b32 v21,0,v124,vcc
s_and_b32 s56,s46,1
s_lshl_b32 s56,s56,8
s_and_b32 s57,s46,2
s_lshl_b32 s57,s57,6
s_add_u32 s56,s56,s57
v_add_u32 v13,s56,v13
s_add_u32 s56,s50,155648
v_add_u32 v12,s56,v0
v_mov_b64 v[14:15],s[28:29]
v_mov_b64 v[16:17],s[28:29]
v_add_u32 v22,11550720,v10
s_lshl_b32 s18,s47,2
s_add_u32 s18,s18,10493952
v_mov_b32 v1,s80
s_mov_b32 s65,14680064
s_add_u32 s66,s71,14680064
s_add_u32 s69,s71,14942208
s_mov_b32 s30,0x40000000
s_mov_b32 s51,0
L_cst_227:
s_cmp_lg_u32 s46,0
s_cbranch_scc1 L_csw_232
s_lshl_b32 s59,s51,13
s_lshl2_add_u32 s59,s47,s59
s_add_u32 s59,s59,10485760
L_ww_233:
s_sleep 1
buffer_load_dword v122,off,s[8:11],s59 sc1
s_sub_u32 s49,s49,1
s_cbranch_scc1 L_abort2
s_waitcnt vmcnt(0)
v_readfirstlane_b32 s61,v122
s_cmp_eq_u32 s61,0
s_cbranch_scc1 L_ww_233
L_wwd_234:
L_csw_232:
s_waitcnt lgkmcnt(0)
s_barrier
s_lshl_b32 s56,s51,5
s_add_u32 s56,s56,s47
s_mul_i32 s56,s56,24576
s_add_u32 s56,s56,100663296
s_add_u32 s67,s56,s73
s_add_u32 m0,s73,131072
s_add_u32 s57,s67,8192
buffer_load_dwordx4 v0,s[8:11],s67 offen sc1 lds
buffer_load_dwordx4 v0,s[8:11],s67 offen offset:1024 sc1 lds
s_add_u32 m0,s73,139264
s_add_u32 s67,s67,786432
buffer_load_dwordx4 v0,s[8:11],s57 offen sc1 lds
buffer_load_dwordx4 v0,s[8:11],s57 offen offset:1024 sc1 lds
s_lshl_b32 s75,s51,13
s_add_u32 s56,s75,11542528
buffer_load_dword v23,v10,s[8:11],s56 offen sc1
s_add_u32 s64,s75,11534336
s_add_u32 s70,s64,4096
s_lshl_b32 s68,s51,5
s_add_u32 s68,s68,s47
s_lshl_b32 s68,s68,12
s_lshl_b32 s56,s46,10
s_add_u32 s68,s68,s56
s_add_u32 s68,s68,41943040
s_mov_b32 s54,0x80000000
s_mov_b32 s77,0
s_mov_b32 s19,0
s_cmp_eq_u32 s51,63
s_cselect_b32 s76,1,s46
s_cmp_eq_u32 s76,0
s_cselect_b32 s76,1,0
v_mov_b64 v[96:97],0
v_mov_b64 v[98:99],0
v_mov_b64 v[100:101],0
v_mov_b64 v[102:103],0
v_mov_b64 v[104:105],0
v_mov_b64 v[106:107],0
v_mov_b64 v[108:109],0
v_mov_b64 v[110:111],0
v_mov_b64 v[112:113],0
v_mov_b64 v[114:115],0
v_mov_b64 v[116:117],0
v_mov_b64 v[118:119],0
s_waitcnt vmcnt(0) lgkmcnt(0)
s_barrier
v_add_u32 v55,131072,v0
ds_read_b128 v[56:59],v55 offset:0
ds_read_b128 v[60:63],v55 offset:4096
ds_read_b128 v[64:67],v55 offset:1024
ds_read_b128 v[68:71],v55 offset:5120
ds_read_b128 v[72:75],v55 offset:2048
ds_read_b128 v[76:79],v55 offset:6144
ds_read_b128 v[80:83],v55 offset:3072
ds_read_b128 v[84:87],v55 offset:7168
v_add_u32 v123,s73,v55
ds_read_b128 v[88:91],v123 offset:8192
ds_read_b128 v[92:95],v123 offset:9216
v_xor_b32 v120,1024,v12
v_xor_b32 v121,2048,v12
v_xor_b32 v122,3072,v12
buffer_load_dwordx4 v[24:27],v13,s[8:11],s64 offen sc1
buffer_load_dwordx4 v[24:27],v13,s[8:11],s64 offen sc1
L_chain_235:
L_cpa_236:
buffer_load_dwordx4 v[24:27],v13,s[8:11],s64 offen sc1
s_sub_u32 s49,s49,1
s_cbranch_scc1 L_abort2
s_waitcnt vmcnt(2)
v_max3_u32 v123,v24,v25,v26
v_max_u32 v123,v27,v123
v_cmp_le_u32 vcc,s72,v123
ds_write_b128 v12,v[24:27] offset:0
s_cbranch_vccnz L_cpa_236
L_cgo_239:
v_smfmac_f32_16x16x64_bf16 v[96:99],v[24:27],a[0:7],v2
buffer_load_dwordx4 v[40:43],v13,s[8:11],s70 offen sc1
v_smfmac_f32_16x16x64_bf16 v[100:103],v[24:27],a[128:135],v2
s_waitcnt lgkmcnt(0)
s_barrier
ds_read_b128 v[28:31],v120 offset:0
v_smfmac_f32_16x16x64_bf16 v[104:107],v[24:27],a[8:15],v2
ds_read_b128 v[32:35],v121 offset:0
v_smfmac_f32_16x16x64_bf16 v[108:111],v[24:27],a[136:143],v2
ds_read_b128 v[36:39],v122 offset:0
v_smfmac_f32_16x16x64_bf16 v[112:115],v[24:27],v[128:135],v2
v_smfmac_f32_16x16x64_bf16 v[116:119],v[24:27],v[136:143],v2
s_waitcnt lgkmcnt(2)
v_smfmac_f32_16x16x64_bf16 v[96:99],v[28:31],a[16:23],v2
s_add_u32 m0,s73,131072
v_smfmac_f32_16x16x64_bf16 v[100:103],v[28:31],a[144:151],v2
s_add_u32 s57,s67,8192
v_smfmac_f32_16x16x64_bf16 v[104:107],v[28:31],a[24:31],v2
s_cmp_lt_u32 s19,s76
s_cbranch_scc1 L_ckw_228
L_ckb_229:
v_smfmac_f32_16x16x64_bf16 v[108:111],v[28:31],a[152:159],v2
s_waitcnt vmcnt(0) lgkmcnt(1)
v_smfmac_f32_16x16x64_bf16 v[96:99],v[32:35],a[32:39],v2
ds_write_b128 v12,v[40:43] offset:4096
v_max3_u32 v123,v40,v41,v42
v_smfmac_f32_16x16x64_bf16 v[100:103],v[32:35],a[160:167],v2
v_max_u32 v123,v43,v123
v_smfmac_f32_16x16x64_bf16 v[104:107],v[32:35],a[40:47],v2
v_cmp_le_u32 vcc,s72,v123
v_smfmac_f32_16x16x64_bf16 v[108:111],v[32:35],a[168:175],v2
v_smfmac_f32_16x16x64_bf16 v[112:115],v[28:31],v[144:151],v2
s_cbranch_vccnz L_cpb_242
L_cback_244:
s_waitcnt lgkmcnt(0)
s_barrier
v_smfmac_f32_16x16x64_bf16 v[96:99],v[36:39],a[48:55],v2
buffer_store_dwordx4 v[124:127],v0,s[8:11],s54 offen sc1
v_smfmac_f32_16x16x64_bf16 v[100:103],v[36:39],a[176:183],v2
ds_read_b128 v[44:47],v120 offset:4096
v_smfmac_f32_16x16x64_bf16 v[104:107],v[36:39],a[56:63],v2
buffer_load_dwordx4 v0,s[8:11],s67 offen sc1 lds
v_smfmac_f32_16x16x64_bf16 v[108:111],v[36:39],a[184:191],v2
ds_read_b128 v[48:51],v121 offset:4096
v_smfmac_f32_16x16x64_bf16 v[96:99],v[40:43],a[64:71],v2
buffer_load_dwordx4 v0,s[8:11],s67 offen offset:1024 sc1 lds
s_add_u32 m0,s73,139264
v_smfmac_f32_16x16x64_bf16 v[100:103],v[40:43],a[192:199],v2
ds_read_b128 v[52:55],v122 offset:4096
v_smfmac_f32_16x16x64_bf16 v[104:107],v[40:43],a[72:79],v2
buffer_load_dwordx4 v0,s[8:11],s57 offen sc1 lds
s_add_u32 s67,s67,786432
v_smfmac_f32_16x16x64_bf16 v[108:111],v[40:43],a[200:207],v2
s_waitcnt lgkmcnt(2)
v_smfmac_f32_16x16x64_bf16 v[96:99],v[44:47],a[80:87],v2
buffer_load_dwordx4 v0,s[8:11],s57 offen offset:1024 sc1 lds
v_smfmac_f32_16x16x64_bf16 v[100:103],v[44:47],a[208:215],v2
s_waitcnt lgkmcnt(1)
v_smfmac_f32_16x16x64_bf16 v[96:99],v[48:51],a[96:103],v2
buffer_load_dword v23,v22,s[8:11],s75 offen sc1
v_smfmac_f32_16x16x64_bf16 v[100:103],v[48:51],a[224:231],v2
s_waitcnt lgkmcnt(0)
v_smfmac_f32_16x16x64_bf16 v[96:99],v[52:55],a[112:119],v2
v_smfmac_f32_16x16x64_bf16 v[100:103],v[52:55],a[240:247],v2
v_smfmac_f32_16x16x64_bf16 v[104:107],v[44:47],a[88:95],v2
v_smfmac_f32_16x16x64_bf16 v[108:111],v[44:47],a[216:223],v2
v_smfmac_f32_16x16x64_bf16 v[104:107],v[48:51],a[104:111],v2
v_add_f32 v96,v96,v98
v_smfmac_f32_16x16x64_bf16 v[108:111],v[48:51],a[232:239],v2
v_add_f32 v97,v97,v99
v_smfmac_f32_16x16x64_bf16 v[104:107],v[52:55],a[120:127],v2
v_cvt_pk_bf16_f32 v120,v96,v97
v_smfmac_f32_16x16x64_bf16 v[108:111],v[52:55],a[248:255],v2
v_add_f32 v100,v100,v102
v_smfmac_f32_16x16x64_bf16 v[116:119],v[28:31],v[152:159],v2
v_add_f32 v101,v101,v103
v_smfmac_f32_16x16x64_bf16 v[112:115],v[32:35],v[160:167],v2
v_cvt_pk_bf16_f32 v121,v100,v101
v_add_f32 v104,v104,v106
v_add_f32 v105,v105,v107
v_cvt_pk_bf16_f32 v122,v104,v105
v_add_f32 v108,v108,v110
v_add_f32 v109,v109,v111
v_cvt_pk_bf16_f32 v123,v108,v109
ds_write_b128 v4,v[120:123]
v_smfmac_f32_16x16x64_bf16 v[116:119],v[32:35],v[168:175],v2
s_mov_b32 s54,s68
s_add_u32 s68,s68,131072
v_mov_b32 v125,0
v_smfmac_f32_16x16x64_bf16 v[112:115],v[36:39],v[176:183],v2
s_cmp_eq_u32 s51,63
s_cbranch_scc1 L_cend_238
v_smfmac_f32_16x16x64_bf16 v[116:119],v[36:39],v[184:191],v2
v_smfmac_f32_16x16x64_bf16 v[112:115],v[40:43],v[192:199],v2
s_waitcnt lgkmcnt(0)
s_barrier
ds_read_b64_tr_b16 v[96:97],v5 offset:0
ds_read_b64_tr_b16 v[98:99],v6 offset:0
v_smfmac_f32_16x16x64_bf16 v[116:119],v[40:43],v[200:207],v2
ds_read_b64_tr_b16 v[100:101],v5 offset:1024
v_smfmac_f32_16x16x64_bf16 v[112:115],v[44:47],v[208:215],v2
ds_read_b64_tr_b16 v[102:103],v6 offset:1024
v_smfmac_f32_16x16x64_bf16 v[116:119],v[44:47],v[216:223],v2
ds_read_b64_tr_b16 v[104:105],v5 offset:2048
v_smfmac_f32_16x16x64_bf16 v[112:115],v[48:51],v[224:231],v2
ds_read_b64_tr_b16 v[106:107],v6 offset:2048
s_waitcnt lgkmcnt(4)
v_mfma_f32_16x16x32_bf16 v[24:27],v[56:59],v[96:99],0
ds_read_b64_tr_b16 v[108:109],v5 offset:3072
v_mfma_f32_16x16x32_bf16 v[28:31],v[60:63],v[96:99],0
ds_read_b64_tr_b16 v[110:111],v6 offset:3072
v_mfma_f32_16x16x32_bf16 v[32:35],v[96:99],v[96:99],0
ds_read_b128 v[40:43],v11 offset:12288
s_waitcnt lgkmcnt(5)
v_mfma_f32_16x16x32_bf16 v[24:27],v[64:67],v[100:103],v[24:27]
ds_read_b128 v[56:59],v11 offset:0
v_mfma_f32_16x16x32_bf16 v[28:31],v[68:71],v[100:103],v[28:31]
ds_read_b128 v[60:63],v11 offset:1024
v_mfma_f32_16x16x32_bf16 v[32:35],v[100:103],v[100:103],v[32:35]
ds_read_b128 v[96:99],v11 offset:8192
s_waitcnt lgkmcnt(6)
v_mfma_f32_16x16x32_bf16 v[24:27],v[72:75],v[104:107],v[24:27]
ds_read_b128 v[64:67],v11 offset:2048
v_mfma_f32_16x16x32_bf16 v[28:31],v[76:79],v[104:107],v[28:31]
ds_read_b128 v[68:71],v11 offset:3072
v_mfma_f32_16x16x32_bf16 v[32:35],v[104:107],v[104:107],v[32:35]
ds_read_b128 v[100:103],v11 offset:9216
s_waitcnt lgkmcnt(7)
v_mfma_f32_16x16x32_bf16 v[24:27],v[80:83],v[108:111],v[24:27]
ds_read_b128 v[72:75],v11 offset:4096
v_mfma_f32_16x16x32_bf16 v[28:31],v[84:87],v[108:111],v[28:31]
ds_read_b128 v[76:79],v11 offset:5120
v_mfma_f32_16x16x32_bf16 v[32:35],v[108:111],v[108:111],v[32:35]
ds_read_b128 v[104:107],v11 offset:10240
v_smfmac_f32_16x16x64_bf16 v[116:119],v[48:51],v[232:239],v2
ds_read_b128 v[80:83],v11 offset:6144
v_smfmac_f32_16x16x64_bf16 v[112:115],v[52:55],v[240:247],v2
ds_read_b128 v[84:87],v11 offset:7168
v_smfmac_f32_16x16x64_bf16 v[116:119],v[52:55],v[248:255],v2
ds_read_b128 v[108:111],v11 offset:11264
v_max3_f32 v126,v24,v25,v26
v_max3_f32 v127,v27,v28,v29
v_max3_f32 v126,v30,v31,v126
v_max3_f32 v127,v34,v35,v127
v_max_f32 v126,v126,v127
v_max_f32 v127,v126,v127
v_pk_mul_f32 v[34:35],v[34:35],v[0:1] op_sel:[0,1]
v_pk_mul_f32 v[24:25],v[24:25],v[0:1] op_sel:[0,1]
v_permlane16_swap_b32 v126,v127
v_max_f32 v126,v126,v127
v_max_f32 v127,v126,v127
v_pk_mul_f32 v[26:27],v[26:27],v[0:1] op_sel:[0,1]
v_pk_mul_f32 v[28:29],v[28:29],v[0:1] op_sel:[0,1]
v_permlane32_swap_b32 v126,v127
v_max_f32 v126,v126,v127
v_mul_f32 v126,v1,v126
v_pk_mul_f32 v[30:31],v[30:31],v[0:1] op_sel:[0,1]
v_pk_add_f32 v[34:35],v[34:35],v[126:127] op_sel_hi:[1,0] neg_lo:[0,1] neg_hi:[0,1]
v_pk_add_f32 v[112:113],v[112:113],v[114:115]
v_pk_add_f32 v[116:117],v[116:117],v[118:119]
v_pk_add_f32 v[24:25],v[24:25],v[126:127] op_sel_hi:[1,0] neg_lo:[0,1] neg_hi:[0,1]
v_pk_add_f32 v[26:27],v[26:27],v[126:127] op_sel_hi:[1,0] neg_lo:[0,1] neg_hi:[0,1]
v_pk_add_f32 v[28:29],v[28:29],v[126:127] op_sel_hi:[1,0] neg_lo:[0,1] neg_hi:[0,1]
v_pk_add_f32 v[30:31],v[30:31],v[126:127] op_sel_hi:[1,0] neg_lo:[0,1] neg_hi:[0,1]
v_exp_f32 v34,v34
v_exp_f32 v35,v35
v_cvt_pk_bf16_f32 v126,v112,v113
v_cvt_pk_bf16_f32 v124,v34,v35
v_cvt_pk_bf16_f32 v127,v116,v117
v_cvt_pk_bf16_f32 v36,v116,v117
v_mfma_f32_16x16x16_bf16 v[32:35],v[14:15],v[124:125],0
ds_read_b128 v[44:47],v11 offset:13312
v_exp_f32 v24,v24
v_mfma_f32_16x16x16_bf16 v[112:115],v[126:127],v[124:125],0
ds_read_b128 v[48:51],v11 offset:14336
v_exp_f32 v25,v25
v_mfma_f32_16x16x16_bf16 v[116:119],v[36:37],v[124:125],0
ds_read_b128 v[52:55],v11 offset:15360
v_exp_f32 v26,v26
v_exp_f32 v27,v27
v_cvt_pk_bf16_f32 v120,v24,v25
v_exp_f32 v28,v28
v_exp_f32 v29,v29
v_cvt_pk_bf16_f32 v121,v26,v27
v_exp_f32 v30,v30
v_exp_f32 v31,v31
v_cvt_pk_bf16_f32 v122,v28,v29
v_cvt_pk_bf16_f32 v123,v30,v31
s_add_u32 s75,s75,8192
s_add_u32 s51,s51,1
v_mfma_f32_16x16x32_bf16 v[32:35],v[14:17],v[120:123],v[32:35]
v_mfma_f32_16x16x32_bf16 v[112:115],v[88:91],v[120:123],v[112:115]
ds_read_b128 v[88:91],v11 offset:16384
v_mfma_f32_16x16x32_bf16 v[116:119],v[92:95],v[120:123],v[116:119]
ds_read_b128 v[92:95],v11 offset:17408
v_rcp_f32 v32,v32
v_mov_b64 v[24:25],-1
v_mov_b64 v[26:27],-1
s_add_u32 s64,s75,11534336
s_add_u32 s70,s64,4096
v_pk_mul_f32 v[112:113],v[112:113],v[32:33] op_sel_hi:[1,0]
v_pk_mul_f32 v[114:115],v[114:115],v[32:33] op_sel_hi:[1,0]
v_pk_mul_f32 v[116:117],v[116:117],v[32:33] op_sel_hi:[1,0]
v_pk_mul_f32 v[118:119],v[118:119],v[32:33] op_sel_hi:[1,0]
v_cvt_pk_bf16_f32 v120,v112,v116
v_cvt_pk_bf16_f32 v121,v113,v117
v_cvt_pk_bf16_f32 v122,v114,v118
v_cvt_pk_bf16_f32 v123,v115,v119
ds_write_b128 v7,v[120:123]
buffer_store_dwordx4 v[24:27],v0,s[8:11],s69 offen sc1
buffer_store_dwordx4 v[24:27],v0,s[8:11],s69 offen offset:1024 sc1
v_mov_b64 v[112:113],0
v_mov_b64 v[114:115],0
v_mov_b64 v[116:117],0
v_mov_b64 v[118:119],0
s_waitcnt lgkmcnt(0)
s_barrier
ds_read_b128 v[24:27],v8 offset:0
ds_read_b128 v[28:31],v8 offset:512
ds_read_b128 v[32:35],v8 offset:1024
ds_read_b128 v[36:39],v8 offset:1536
v_mov_b64 v[120:121],0
v_mov_b64 v[122:123],0
s_add_u32 s57,s65,65536
s_add_u32 s58,s65,131072
s_add_u32 s59,s65,196608
s_add_u32 s56,s18,s75
s_waitcnt lgkmcnt(3)
v_smfmac_f32_16x16x64_bf16 v[112:115],v[24:27],v[56:63],v3
ds_read_b128 v[56:59],v11 offset:18432
s_waitcnt lgkmcnt(3)
v_smfmac_f32_16x16x64_bf16 v[112:115],v[28:31],v[64:71],v3
ds_read_b128 v[60:63],v11 offset:19456
s_waitcnt lgkmcnt(3)
v_smfmac_f32_16x16x64_bf16 v[112:115],v[32:35],v[72:79],v3
ds_read_b128 v[64:67],v11 offset:20480
s_waitcnt lgkmcnt(3)
v_smfmac_f32_16x16x64_bf16 v[112:115],v[36:39],v[80:87],v3
ds_read_b128 v[68:71],v11 offset:21504
v_smfmac_f32_16x16x64_bf16 v[116:119],v[24:27],v[96:103],v3
ds_read_b128 v[72:75],v11 offset:22528
v_smfmac_f32_16x16x64_bf16 v[116:119],v[28:31],v[104:111],v3
ds_read_b128 v[76:79],v11 offset:23552
v_cvt_pk_bf16_f32 v112,v112,v113
v_smfmac_f32_16x16x64_bf16 v[116:119],v[32:35],v[40:47],v3
ds_read_b128 v[80:83],v11 offset:24576
v_cvt_pk_bf16_f32 v113,v114,v115
buffer_store_dwordx2 v[112:113],v9,s[8:11],s65 offen sc1
v_smfmac_f32_16x16x64_bf16 v[116:119],v[36:39],v[48:55],v3
ds_read_b128 v[84:87],v11 offset:25600
v_mov_b64 v[112:113],0
v_smfmac_f32_16x16x64_bf16 v[120:123],v[24:27],v[88:95],v3
ds_read_b128 v[96:99],v11 offset:26624
ds_read_b128 v[100:103],v11 offset:27648
v_mov_b64 v[114:115],0
s_waitcnt lgkmcnt(8)
v_smfmac_f32_16x16x64_bf16 v[120:123],v[28:31],v[56:63],v3
ds_read_b128 v[104:107],v11 offset:28672
v_cvt_pk_bf16_f32 v116,v116,v117
s_waitcnt lgkmcnt(7)
v_smfmac_f32_16x16x64_bf16 v[120:123],v[32:35],v[64:71],v3
ds_read_b128 v[108:111],v11 offset:29696
ds_read_b128 v[40:43],v11 offset:30720
v_cvt_pk_bf16_f32 v117,v118,v119
buffer_store_dwordx2 v[116:117],v9,s[8:11],s57 offen sc1
s_waitcnt lgkmcnt(7)
v_smfmac_f32_16x16x64_bf16 v[120:123],v[36:39],v[72:79],v3
ds_read_b128 v[44:47],v11 offset:31744
v_add_u32 v52,s50,v5
s_waitcnt lgkmcnt(6)
v_smfmac_f32_16x16x64_bf16 v[112:115],v[24:27],v[80:87],v3
v_add_u32 v54,s50,v6
s_waitcnt lgkmcnt(4)
v_smfmac_f32_16x16x64_bf16 v[112:115],v[28:31],v[96:103],v3
ds_read_b64_tr_b16 v[52:53],v52
v_cvt_pk_bf16_f32 v120,v120,v121
s_waitcnt lgkmcnt(3)
v_smfmac_f32_16x16x64_bf16 v[112:115],v[32:35],v[104:111],v3
ds_read_b64_tr_b16 v[54:55],v54
v_cvt_pk_bf16_f32 v121,v122,v123
buffer_store_dwordx2 v[120:121],v9,s[8:11],s58 offen sc1
s_waitcnt lgkmcnt(2)
v_smfmac_f32_16x16x64_bf16 v[112:115],v[36:39],v[40:47],v3
v_mov_b64 v[116:117],0
v_mov_b64 v[118:119],0
s_xor_b32 s65,s65,262144
v_mov_b32_dpp v124,v126 quad_perm:[2,3,2,3] row_mask:0xf bank_mask:0xf
v_mov_b32_dpp v125,v127 quad_perm:[2,3,2,3] row_mask:0xf bank_mask:0xf
s_mov_b32 vcc_lo,0xcccccccc
s_mov_b32 vcc_hi,0xcccccccc
s_nop 0
v_cvt_pk_bf16_f32 v112,v112,v113
v_cvt_pk_bf16_f32 v113,v114,v115
buffer_store_dwordx2 v[112:113],v9,s[8:11],s59 offen sc1
s_waitcnt lgkmcnt(0)
s_buffer_load_dword s19,s[8:11],s56
v_cndmask_b32 v124,v124,v52,vcc
v_cndmask_b32 v125,v125,v53,vcc
v_cndmask_b32 v126,v126,v54,vcc
v_cndmask_b32 v127,v127,v55,vcc
s_cmp_lt_u32 s46,2
s_waitcnt vmcnt(3)
s_cbranch_scc1 L_crg_245
s_cmp_eq_u32 s46,2
s_waitcnt vmcnt(1)
s_cbranch_scc1 L_crg_245
s_waitcnt vmcnt(0)
L_crg_245:
buffer_load_dwordx4 v[32:35],v0,s[8:11],s66 offen offset:0 sc1
buffer_load_dwordx4 v[36:39],v0,s[8:11],s66 offen offset:1024 sc1
v_mov_b64 v[96:97],0
v_mov_b64 v[98:99],0
v_mov_b64 v[100:101],0
v_mov_b64 v[102:103],0
v_mov_b64 v[104:105],0
v_mov_b64 v[106:107],0
v_mov_b64 v[108:109],0
v_mov_b64 v[110:111],0
v_mov_b64 v[112:113],0
v_mov_b64 v[114:115],0
v_add_u32 v55,131072,v0
v_add_u32 v123,s73,v55
v_xor_b32 v120,1024,v12
v_xor_b32 v121,2048,v12
v_xor_b32 v122,3072,v12
buffer_load_dwordx4 v[44:47],v0,s[8:11],s66 offen offset:0 sc1
buffer_load_dwordx4 v[48:51],v0,s[8:11],s66 offen offset:1024 sc1
s_cmp_ge_u32 s51,63
s_cselect_b32 s76,0,1
s_cmp_eq_u32 s46,0
s_cselect_b32 s76,s76,0
s_waitcnt vmcnt(3)
v_mfma_f32_16x16x32_bf16 v[28:31],v[18:21],v[32:35],0
s_waitcnt vmcnt(2)
v_mfma_f32_16x16x32_bf16 v[28:31],v[18:21],v[36:39],v[28:31]
s_nop 7
v_cmp_u_f32 vcc,v28,v28
v_add_f32_dpp v52,v28,v28 row_ror:8 row_mask:0xf bank_mask:0x3
v_add_f32_dpp v53,v29,v29 row_ror:8 row_mask:0xf bank_mask:0x3
v_add_f32_dpp v52,v30,v30 row_ror:8 row_mask:0xf bank_mask:0xc
v_add_f32_dpp v53,v31,v31 row_ror:8 row_mask:0xf bank_mask:0xc
s_nop 0
v_add_f32_dpp v52,v52,v52 row_shl:4 row_mask:0xf bank_mask:0x5
v_add_f32_dpp v53,v53,v53 row_shl:4 row_mask:0xf bank_mask:0x5
s_cbranch_vccnz L_crp_240
L_cok_246:
v_cvt_pk_bf16_f32 v54,v52,v53
buffer_store_dword v54,v10,s[8:11],s64 offen sc1
s_mov_b32 s69,s66
s_xor_b32 s66,s66,262144
s_barrier
ds_read_b128 v[56:59],v55 offset:0
ds_read_b128 v[60:63],v55 offset:4096
ds_read_b128 v[64:67],v55 offset:1024
buffer_load_dwordx4 v[24:27],v13,s[8:11],s64 offen sc1
ds_read_b128 v[68:71],v55 offset:5120
ds_read_b128 v[72:75],v55 offset:2048
ds_read_b128 v[76:79],v55 offset:6144
ds_read_b128 v[80:83],v55 offset:3072
buffer_load_dwordx4 v[24:27],v13,s[8:11],s64 offen sc1
ds_read_b128 v[84:87],v55 offset:7168
ds_read_b128 v[88:91],v123 offset:8192
ds_read_b128 v[92:95],v123 offset:9216
s_branch L_chain_235
L_cpb_242:
buffer_load_dwordx4 v[40:43],v13,s[8:11],s70 offen sc1
s_sub_u32 s49,s49,1
s_cbranch_scc1 L_abort2
s_waitcnt vmcnt(0)
v_max3_u32 v123,v40,v41,v42
v_max_u32 v123,v43,v123
v_cmp_le_u32 vcc,s72,v123
s_cbranch_vccnz L_cpb_242
ds_write_b128 v12,v[40:43] offset:4096
s_branch L_cback_244
L_crp_240:
buffer_load_dwordx4 v[32:35],v0,s[8:11],s66 offen offset:0 sc1
buffer_load_dwordx4 v[36:39],v0,s[8:11],s66 offen offset:1024 sc1
s_sub_u32 s49,s49,1
s_cbranch_scc1 L_abort2
s_waitcnt vmcnt(3)
v_mfma_f32_16x16x32_bf16 v[28:31],v[18:21],v[44:47],0
s_waitcnt vmcnt(2)
v_mfma_f32_16x16x32_bf16 v[28:31],v[18:21],v[48:51],v[28:31]
s_nop 7
v_cmp_u_f32 vcc,v28,v28
v_add_f32_dpp v52,v28,v28 row_ror:8 row_mask:0xf bank_mask:0x3
v_add_f32_dpp v53,v29,v29 row_ror:8 row_mask:0xf bank_mask:0x3
v_add_f32_dpp v52,v30,v30 row_ror:8 row_mask:0xf bank_mask:0xc
v_add_f32_dpp v53,v31,v31 row_ror:8 row_mask:0xf bank_mask:0xc
s_nop 0
v_add_f32_dpp v52,v52,v52 row_shl:4 row_mask:0xf bank_mask:0x5
v_add_f32_dpp v53,v53,v53 row_shl:4 row_mask:0xf bank_mask:0x5
s_cbranch_vccz L_cok_246
buffer_load_dwordx4 v[44:47],v0,s[8:11],s66 offen offset:0 sc1
buffer_load_dwordx4 v[48:51],v0,s[8:11],s66 offen offset:1024 sc1
s_sub_u32 s49,s49,1
s_cbranch_scc1 L_abort2
s_waitcnt vmcnt(3)
v_mfma_f32_16x16x32_bf16 v[28:31],v[18:21],v[32:35],0
s_waitcnt vmcnt(2)
v_mfma_f32_16x16x32_bf16 v[28:31],v[18:21],v[36:39],v[28:31]
s_nop 7
v_cmp_u_f32 vcc,v28,v28
v_add_f32_dpp v52,v28,v28 row_ror:8 row_mask:0xf bank_mask:0x3
v_add_f32_dpp v53,v29,v29 row_ror:8 row_mask:0xf bank_mask:0x3
v_add_f32_dpp v52,v30,v30 row_ror:8 row_mask:0xf bank_mask:0xc
v_add_f32_dpp v53,v31,v31 row_ror:8 row_mask:0xf bank_mask:0xc
s_nop 0
v_add_f32_dpp v52,v52,v52 row_shl:4 row_mask:0xf bank_mask:0x5
v_add_f32_dpp v53,v53,v53 row_shl:4 row_mask:0xf bank_mask:0x5
s_cbranch_vccz L_cok_246
s_branch L_crp_240
L_ckw_228:
s_add_u32 s59,s18,s75
L_ww_247:
s_sleep 1
buffer_load_dword v23,off,s[8:11],s59 sc1
s_sub_u32 s49,s49,1
s_cbranch_scc1 L_abort2
s_waitcnt vmcnt(0)
v_readfirstlane_b32 s76,v23
s_cmp_eq_u32 s76,0
s_cbranch_scc1 L_ww_247
L_wwd_248:
s_branch L_ckb_229
L_cend_238:
v_smfmac_f32_16x16x64_bf16 v[116:119],v[36:39],v[184:191],v2
v_smfmac_f32_16x16x64_bf16 v[112:115],v[40:43],v[192:199],v2
v_smfmac_f32_16x16x64_bf16 v[116:119],v[40:43],v[200:207],v2
v_smfmac_f32_16x16x64_bf16 v[112:115],v[44:47],v[208:215],v2
v_smfmac_f32_16x16x64_bf16 v[116:119],v[44:47],v[216:223],v2
v_smfmac_f32_16x16x64_bf16 v[112:115],v[48:51],v[224:231],v2
v_smfmac_f32_16x16x64_bf16 v[116:119],v[48:51],v[232:239],v2
v_smfmac_f32_16x16x64_bf16 v[112:115],v[52:55],v[240:247],v2
v_smfmac_f32_16x16x64_bf16 v[116:119],v[52:55],v[248:255],v2
s_waitcnt lgkmcnt(0)
s_nop 2
v_pk_add_f32 v[112:113],v[112:113],v[114:115]
s_nop 2
v_pk_add_f32 v[116:117],v[116:117],v[118:119]
v_cvt_pk_bf16_f32 v126,v112,v113
v_cvt_pk_bf16_f32 v127,v116,v117
v_add_u32 v52,s50,v5
v_add_u32 v54,s50,v6
ds_read_b64_tr_b16 v[52:53],v52
ds_read_b64_tr_b16 v[54:55],v54
v_mov_b32_dpp v124,v126 quad_perm:[2,3,2,3] row_mask:0xf bank_mask:0xf
v_mov_b32_dpp v125,v127 quad_perm:[2,3,2,3] row_mask:0xf bank_mask:0xf
s_mov_b32 vcc_lo,0xcccccccc
s_mov_b32 vcc_hi,0xcccccccc
s_waitcnt lgkmcnt(0)
v_cndmask_b32 v124,v124,v52,vcc
v_cndmask_b32 v125,v125,v53,vcc
v_cndmask_b32 v126,v126,v54,vcc
v_cndmask_b32 v127,v127,v55,vcc
buffer_store_dwordx4 v[124:127],v0,s[8:11],s54 offen sc1
s_mov_b32 s51,64
s_waitcnt vmcnt(0)
s_barrier
s_nop 11
v_lshrrev_b32 v1,4,v0
s_mov_b32 s53,0
s_branch L_rb_7
L_rc1_222:
v_and_b32 v120,15,v1
v_lshrrev_b32 v121,4,v1
v_and_b32 v122,2,v1
v_cmp_eq_u32 vcc,0,v122
v_mov_b32 v2,0xeeee
v_mov_b32 v123,0x4444
v_cndmask_b32 v2,v2,v123,vcc
v_and_b32 v122,1,v1
v_cmp_eq_u32 vcc,0,v122
v_mov_b32 v3,0xdddd
v_mov_b32 v123,0x8888
v_cndmask_b32 v3,v3,v123,vcc
v_lshrrev_b32 v122,1,v120
v_bfe_u32 v123,v120,2,1
v_xor_b32 v123,v123,v122
v_lshlrev_b32 v4,7,v123
v_and_b32 v123,1,v120
v_lshl_add_u32 v4,v123,6,v4
v_xor_b32 v123,v121,v122
v_and_b32 v123,3,v123
v_lshl_add_u32 v4,v123,4,v4
s_lshl_b32 s56,s46,10
s_add_u32 s56,s56,147456
v_add_u32 v4,s56,v4
v_lshlrev_b32 v122,1,v121
v_add_u32 v122,0,v122
v_and_b32 v123,1,v121
v_xor_b32 v123,v123,v122
v_lshlrev_b32 v5,7,v123
v_bfe_u32 v123,v120,3,1
v_lshl_add_u32 v5,v123,6,v5
v_xor_b32 v123,v120,v122
v_and_b32 v123,3,v123
v_lshl_add_u32 v5,v123,4,v5
v_bfe_u32 v123,v120,2,1
v_lshl_add_u32 v5,v123,3,v5
v_add_u32 v5,147456,v5
v_lshlrev_b32 v122,1,v121
v_add_u32 v122,1,v122
v_and_b32 v123,1,v121
v_xor_b32 v123,v123,v122
v_lshlrev_b32 v6,7,v123
v_bfe_u32 v123,v120,3,1
v_lshl_add_u32 v6,v123,6,v6
v_xor_b32 v123,v120,v122
v_and_b32 v123,3,v123
v_lshl_add_u32 v6,v123,4,v6
v_bfe_u32 v123,v120,2,1
v_lshl_add_u32 v6,v123,3,v6
v_add_u32 v6,147456,v6
v_lshlrev_b32 v7,7,v121
v_lshrrev_b32 v122,1,v120
v_lshl_add_u32 v8,v122,4,v7
v_add_u32 v8,151552,v8
v_lshrrev_b32 v122,2,v120
v_lshl_add_u32 v7,v122,5,v7
v_and_b32 v122,1,v120
v_lshl_add_u32 v7,v122,4,v7
v_and_b32 v122,2,v120
v_cmp_eq_u32 vcc,0,v122
s_lshl_b32 s56,s46,9
v_mov_b32 v122,2048
v_mov_b32 v123,s56
v_cndmask_b32 v122,v122,v123,vcc
v_add_u32 v7,v122,v7
v_add_u32 v7,151552,v7
v_lshrrev_b32 v122,3,v1
v_lshlrev_b32 v9,11,v122
v_and_b32 v122,7,v1
v_lshl_add_u32 v9,v122,3,v9
s_lshl_b32 s56,s46,14
s_lshl_b32 s57,s47,6
s_add_u32 s56,s56,s57
v_add_u32 v9,s56,v9
s_lshl_b32 s71,s46,5
s_add_u32 s71,s71,s47
s_bfe_u32 s56,s71,0x10003
s_lshl_b32 s56,s56,11
s_and_b32 s57,s71,1
s_lshl_b32 s57,s57,10
s_add_u32 s56,s56,s57
s_bfe_u32 s57,s71,0x10002
s_lshl_b32 s57,s57,9
s_add_u32 s56,s56,s57
s_bfe_u32 s57,s71,0x10001
s_lshl_b32 s57,s57,6
s_add_u32 s56,s56,s57
s_bfe_u32 s57,s71,0x10004
s_lshl_b32 s57,s57,8
s_add_u32 s56,s56,s57
s_bfe_u32 s57,s71,0x10005
s_lshl_b32 s57,s57,7
s_add_u32 s56,s56,s57
s_bfe_u32 s57,s71,0x10006
s_lshl_b32 s57,s57,12
s_add_u32 s56,s56,s57
v_and_b32 v122,3,v120
v_lshlrev_b32 v10,2,v122
v_bfe_u32 v122,v120,3,1
v_lshl_add_u32 v10,v122,4,v10
v_and_b32 v122,1,v121
v_lshl_add_u32 v10,v122,5,v10
v_add_u32 v10,s56,v10
v_and_b32 v123,36,v1
v_mov_b32 v122,0x80000000
v_cmp_eq_u32 vcc,0,v123
s_nop 1
v_cndmask_b32 v10,v122,v10,vcc
s_lshl_b32 s56,s46,15
v_add_u32 v11,s56,v0
s_lshl_b32 s71,s71,11
s_lshl_b32 s73,s46,11
s_mov_b32 s72,0xffc00000
s_mov_b32 s74,0
v_lshrrev_b32 v13,3,v1
v_lshlrev_b32 v13,9,v13
v_and_b32 v122,7,v1
v_lshl_add_u32 v13,v122,4,v13
v_and_b32 v122,15,v1
v_and_b32 v123,1,v1
v_lshlrev_b32 v123,4,v123
v_mov_b32 v124,0x3f80
v_lshlrev_b32 v124,v123,v124
v_lshrrev_b32 v122,1,v122
v_cmp_eq_u32 vcc,0,v122
s_nop 1
v_cndmask_b32 v18,0,v124,vcc
v_cmp_eq_u32 vcc,1,v122
s_nop 1
v_cndmask_b32 v19,0,v124,vcc
v_cmp_eq_u32 vcc,2,v122
s_nop 1
v_cndmask_b32 v20,0,v124,vcc
v_cmp_eq_u32 vcc,3,v122
s_nop 1
v_cndmask_b32 v21,0,v124,vcc
s_and_b32 s56,s46,1
s_lshl_b32 s56,s56,8
s_and_b32 s57,s46,2
s_lshl_b32 s57,s57,6
s_add_u32 s56,s56,s57
v_add_u32 v13,s56,v13
s_add_u32 s56,s50,155648
v_add_u32 v12,s56,v0
v_mov_b64 v[14:15],s[28:29]
v_mov_b64 v[16:17],s[28:29]
v_add_u32 v22,12599296,v10
s_lshl_b32 s18,s47,2
s_add_u32 s18,s18,10494080
v_mov_b32 v1,s80
s_mov_b32 s65,15728640
s_add_u32 s66,s71,15728640
s_add_u32 s69,s71,15990784
s_mov_b32 s30,0x40000000
s_mov_b32 s51,0
L_cst_252:
s_cmp_lg_u32 s46,0
s_cbranch_scc1 L_csw_257
s_lshl_b32 s59,s51,13
s_lshl2_add_u32 s59,s47,s59
s_add_u32 s59,s59,10485888
L_ww_258:
s_sleep 1
buffer_load_dword v122,off,s[8:11],s59 sc1
s_sub_u32 s49,s49,1
s_cbranch_scc1 L_abort2
s_waitcnt vmcnt(0)
v_readfirstlane_b32 s61,v122
s_cmp_eq_u32 s61,0
s_cbranch_scc1 L_ww_258
L_wwd_259:
L_csw_257:
s_waitcnt lgkmcnt(0)
s_barrier
s_lshl_b32 s56,s51,5
s_add_u32 s56,s56,s47
s_mul_i32 s56,s56,24576
s_add_u32 s56,s56,150994944
s_add_u32 s67,s56,s73
s_add_u32 m0,s73,131072
s_add_u32 s57,s67,8192
buffer_load_dwordx4 v0,s[8:11],s67 offen sc1 lds
buffer_load_dwordx4 v0,s[8:11],s67 offen offset:1024 sc1 lds
s_add_u32 m0,s73,139264
s_add_u32 s67,s67,786432
buffer_load_dwordx4 v0,s[8:11],s57 offen sc1 lds
buffer_load_dwordx4 v0,s[8:11],s57 offen offset:1024 sc1 lds
s_lshl_b32 s75,s51,13
s_add_u32 s56,s75,12591104
buffer_load_dword v23,v10,s[8:11],s56 offen sc1
s_add_u32 s64,s75,12582912
s_add_u32 s70,s64,4096
s_lshl_b32 s68,s51,5
s_add_u32 s68,s68,s47
s_lshl_b32 s68,s68,12
s_lshl_b32 s56,s46,10
s_add_u32 s68,s68,s56
s_add_u32 s68,s68,58720256
s_mov_b32 s54,0x80000000
s_mov_b32 s77,0
s_mov_b32 s19,0
s_cmp_eq_u32 s51,63
s_cselect_b32 s76,1,s46
s_cmp_eq_u32 s76,0
s_cselect_b32 s76,1,0
v_mov_b64 v[96:97],0
v_mov_b64 v[98:99],0
v_mov_b64 v[100:101],0
v_mov_b64 v[102:103],0
v_mov_b64 v[104:105],0
v_mov_b64 v[106:107],0
v_mov_b64 v[108:109],0
v_mov_b64 v[110:111],0
v_mov_b64 v[112:113],0
v_mov_b64 v[114:115],0
v_mov_b64 v[116:117],0
v_mov_b64 v[118:119],0
s_waitcnt vmcnt(0) lgkmcnt(0)
s_barrier
v_add_u32 v55,131072,v0
ds_read_b128 v[56:59],v55 offset:0
ds_read_b128 v[60:63],v55 offset:4096
ds_read_b128 v[64:67],v55 offset:1024
ds_read_b128 v[68:71],v55 offset:5120
ds_read_b128 v[72:75],v55 offset:2048
ds_read_b128 v[76:79],v55 offset:6144
ds_read_b128 v[80:83],v55 offset:3072
ds_read_b128 v[84:87],v55 offset:7168
v_add_u32 v123,s73,v55
ds_read_b128 v[88:91],v123 offset:8192
ds_read_b128 v[92:95],v123 offset:9216
v_xor_b32 v120,1024,v12
v_xor_b32 v121,2048,v12
v_xor_b32 v122,3072,v12
buffer_load_dwordx4 v[24:27],v13,s[8:11],s64 offen sc1
buffer_load_dwordx4 v[24:27],v13,s[8:11],s64 offen sc1
L_chain_260:
L_cpa_261:
buffer_load_dwordx4 v[24:27],v13,s[8:11],s64 offen sc1
s_sub_u32 s49,s49,1
s_cbranch_scc1 L_abort2
s_waitcnt vmcnt(2)
v_max3_u32 v123,v24,v25,v26
v_max_u32 v123,v27,v123
v_cmp_le_u32 vcc,s72,v123
ds_write_b128 v12,v[24:27] offset:0
s_cbranch_vccnz L_cpa_261
L_cgo_264:
v_smfmac_f32_16x16x64_bf16 v[96:99],v[24:27],a[0:7],v2
buffer_load_dwordx4 v[40:43],v13,s[8:11],s70 offen sc1
v_smfmac_f32_16x16x64_bf16 v[100:103],v[24:27],a[128:135],v2
s_waitcnt lgkmcnt(0)
s_barrier
ds_read_b128 v[28:31],v120 offset:0
v_smfmac_f32_16x16x64_bf16 v[104:107],v[24:27],a[8:15],v2
ds_read_b128 v[32:35],v121 offset:0
v_smfmac_f32_16x16x64_bf16 v[108:111],v[24:27],a[136:143],v2
ds_read_b128 v[36:39],v122 offset:0
v_smfmac_f32_16x16x64_bf16 v[112:115],v[24:27],v[128:135],v2
v_smfmac_f32_16x16x64_bf16 v[116:119],v[24:27],v[136:143],v2
s_waitcnt lgkmcnt(2)
v_smfmac_f32_16x16x64_bf16 v[96:99],v[28:31],a[16:23],v2
s_add_u32 m0,s73,131072
v_smfmac_f32_16x16x64_bf16 v[100:103],v[28:31],a[144:151],v2
s_add_u32 s57,s67,8192
v_smfmac_f32_16x16x64_bf16 v[104:107],v[28:31],a[24:31],v2
s_cmp_lt_u32 s19,s76
s_cbranch_scc1 L_ckw_253
L_ckb_254:
v_smfmac_f32_16x16x64_bf16 v[108:111],v[28:31],a[152:159],v2
s_waitcnt vmcnt(0) lgkmcnt(1)
v_smfmac_f32_16x16x64_bf16 v[96:99],v[32:35],a[32:39],v2
ds_write_b128 v12,v[40:43] offset:4096
v_max3_u32 v123,v40,v41,v42
v_smfmac_f32_16x16x64_bf16 v[100:103],v[32:35],a[160:167],v2
v_max_u32 v123,v43,v123
v_smfmac_f32_16x16x64_bf16 v[104:107],v[32:35],a[40:47],v2
v_cmp_le_u32 vcc,s72,v123
v_smfmac_f32_16x16x64_bf16 v[108:111],v[32:35],a[168:175],v2
v_smfmac_f32_16x16x64_bf16 v[112:115],v[28:31],v[144:151],v2
s_cbranch_vccnz L_cpb_267
L_cback_269:
s_waitcnt lgkmcnt(0)
s_barrier
v_smfmac_f32_16x16x64_bf16 v[96:99],v[36:39],a[48:55],v2
buffer_store_dword v54,v10,s[8:11],s30 offen sc1
v_smfmac_f32_16x16x64_bf16 v[100:103],v[36:39],a[176:183],v2
ds_read_b128 v[44:47],v120 offset:4096
v_smfmac_f32_16x16x64_bf16 v[104:107],v[36:39],a[56:63],v2
buffer_store_dwordx4 v[124:127],v0,s[8:11],s54 offen sc1
v_smfmac_f32_16x16x64_bf16 v[108:111],v[36:39],a[184:191],v2
ds_read_b128 v[48:51],v121 offset:4096
v_smfmac_f32_16x16x64_bf16 v[96:99],v[40:43],a[64:71],v2
buffer_load_dwordx4 v0,s[8:11],s67 offen sc1 lds
v_smfmac_f32_16x16x64_bf16 v[100:103],v[40:43],a[192:199],v2
ds_read_b128 v[52:55],v122 offset:4096
v_smfmac_f32_16x16x64_bf16 v[104:107],v[40:43],a[72:79],v2
buffer_load_dwordx4 v0,s[8:11],s67 offen offset:1024 sc1 lds
s_add_u32 m0,s73,139264
v_smfmac_f32_16x16x64_bf16 v[108:111],v[40:43],a[200:207],v2
s_waitcnt lgkmcnt(2)
v_smfmac_f32_16x16x64_bf16 v[96:99],v[44:47],a[80:87],v2
buffer_load_dwordx4 v0,s[8:11],s57 offen sc1 lds
s_add_u32 s67,s67,786432
v_smfmac_f32_16x16x64_bf16 v[100:103],v[44:47],a[208:215],v2
s_waitcnt lgkmcnt(1)
v_smfmac_f32_16x16x64_bf16 v[96:99],v[48:51],a[96:103],v2
buffer_load_dwordx4 v0,s[8:11],s57 offen offset:1024 sc1 lds
v_smfmac_f32_16x16x64_bf16 v[100:103],v[48:51],a[224:231],v2
s_waitcnt lgkmcnt(0)
v_smfmac_f32_16x16x64_bf16 v[96:99],v[52:55],a[112:119],v2
buffer_load_dword v23,v22,s[8:11],s75 offen sc1
v_smfmac_f32_16x16x64_bf16 v[100:103],v[52:55],a[240:247],v2
v_smfmac_f32_16x16x64_bf16 v[104:107],v[44:47],a[88:95],v2
v_smfmac_f32_16x16x64_bf16 v[108:111],v[44:47],a[216:223],v2
v_smfmac_f32_16x16x64_bf16 v[104:107],v[48:51],a[104:111],v2
v_add_f32 v96,v96,v98
v_smfmac_f32_16x16x64_bf16 v[108:111],v[48:51],a[232:239],v2
v_add_f32 v97,v97,v99
v_smfmac_f32_16x16x64_bf16 v[104:107],v[52:55],a[120:127],v2
v_cvt_pk_bf16_f32 v120,v96,v97
v_smfmac_f32_16x16x64_bf16 v[108:111],v[52:55],a[248:255],v2
v_add_f32 v100,v100,v102
v_smfmac_f32_16x16x64_bf16 v[116:119],v[28:31],v[152:159],v2
v_add_f32 v101,v101,v103
v_smfmac_f32_16x16x64_bf16 v[112:115],v[32:35],v[160:167],v2
v_cvt_pk_bf16_f32 v121,v100,v101
v_add_f32 v104,v104,v106
v_add_f32 v105,v105,v107
v_cvt_pk_bf16_f32 v122,v104,v105
v_add_f32 v108,v108,v110
v_add_f32 v109,v109,v111
v_cvt_pk_bf16_f32 v123,v108,v109
ds_write_b128 v4,v[120:123]
v_smfmac_f32_16x16x64_bf16 v[116:119],v[32:35],v[168:175],v2
s_mov_b32 s54,s68
s_add_u32 s68,s68,131072
v_mov_b32 v125,0
v_smfmac_f32_16x16x64_bf16 v[112:115],v[36:39],v[176:183],v2
s_cmp_eq_u32 s51,63
s_cbranch_scc1 L_cend_263
v_smfmac_f32_16x16x64_bf16 v[116:119],v[36:39],v[184:191],v2
v_smfmac_f32_16x16x64_bf16 v[112:115],v[40:43],v[192:199],v2
s_waitcnt lgkmcnt(0)
s_barrier
ds_read_b64_tr_b16 v[96:97],v5 offset:0
ds_read_b64_tr_b16 v[98:99],v6 offset:0
v_smfmac_f32_16x16x64_bf16 v[116:119],v[40:43],v[200:207],v2
ds_read_b64_tr_b16 v[100:101],v5 offset:1024
v_smfmac_f32_16x16x64_bf16 v[112:115],v[44:47],v[208:215],v2
ds_read_b64_tr_b16 v[102:103],v6 offset:1024
v_smfmac_f32_16x16x64_bf16 v[116:119],v[44:47],v[216:223],v2
ds_read_b64_tr_b16 v[104:105],v5 offset:2048
v_smfmac_f32_16x16x64_bf16 v[112:115],v[48:51],v[224:231],v2
ds_read_b64_tr_b16 v[106:107],v6 offset:2048
s_waitcnt lgkmcnt(4)
v_mfma_f32_16x16x32_bf16 v[24:27],v[56:59],v[96:99],0
ds_read_b64_tr_b16 v[108:109],v5 offset:3072
v_mfma_f32_16x16x32_bf16 v[28:31],v[60:63],v[96:99],0
ds_read_b64_tr_b16 v[110:111],v6 offset:3072
v_mfma_f32_16x16x32_bf16 v[32:35],v[96:99],v[96:99],0
ds_read_b128 v[40:43],v11 offset:12288
s_waitcnt lgkmcnt(5)
v_mfma_f32_16x16x32_bf16 v[24:27],v[64:67],v[100:103],v[24:27]
ds_read_b128 v[56:59],v11 offset:0
v_mfma_f32_16x16x32_bf16 v[28:31],v[68:71],v[100:103],v[28:31]
ds_read_b128 v[60:63],v11 offset:1024
v_mfma_f32_16x16x32_bf16 v[32:35],v[100:103],v[100:103],v[32:35]
ds_read_b128 v[96:99],v11 offset:8192
s_waitcnt lgkmcnt(6)
v_mfma_f32_16x16x32_bf16 v[24:27],v[72:75],v[104:107],v[24:27]
ds_read_b128 v[64:67],v11 offset:2048
v_mfma_f32_16x16x32_bf16 v[28:31],v[76:79],v[104:107],v[28:31]
ds_read_b128 v[68:71],v11 offset:3072
v_mfma_f32_16x16x32_bf16 v[32:35],v[104:107],v[104:107],v[32:35]
ds_read_b128 v[100:103],v11 offset:9216
s_waitcnt lgkmcnt(7)
v_mfma_f32_16x16x32_bf16 v[24:27],v[80:83],v[108:111],v[24:27]
ds_read_b128 v[72:75],v11 offset:4096
v_mfma_f32_16x16x32_bf16 v[28:31],v[84:87],v[108:111],v[28:31]
ds_read_b128 v[76:79],v11 offset:5120
v_mfma_f32_16x16x32_bf16 v[32:35],v[108:111],v[108:111],v[32:35]
ds_read_b128 v[104:107],v11 offset:10240
v_smfmac_f32_16x16x64_bf16 v[116:119],v[48:51],v[232:239],v2
ds_read_b128 v[80:83],v11 offset:6144
v_smfmac_f32_16x16x64_bf16 v[112:115],v[52:55],v[240:247],v2
ds_read_b128 v[84:87],v11 offset:7168
v_smfmac_f32_16x16x64_bf16 v[116:119],v[52:55],v[248:255],v2
ds_read_b128 v[108:111],v11 offset:11264
v_max3_f32 v126,v24,v25,v26
v_max3_f32 v127,v27,v28,v29
v_max3_f32 v126,v30,v31,v126
v_max3_f32 v127,v34,v35,v127
v_max_f32 v126,v126,v127
v_max_f32 v127,v126,v127
v_pk_mul_f32 v[34:35],v[34:35],v[0:1] op_sel:[0,1]
v_pk_mul_f32 v[24:25],v[24:25],v[0:1] op_sel:[0,1]
v_permlane16_swap_b32 v126,v127
v_max_f32 v126,v126,v127
v_max_f32 v127,v126,v127
v_pk_mul_f32 v[26:27],v[26:27],v[0:1] op_sel:[0,1]
v_pk_mul_f32 v[28:29],v[28:29],v[0:1] op_sel:[0,1]
v_permlane32_swap_b32 v126,v127
v_max_f32 v126,v126,v127
v_mul_f32 v126,v1,v126
v_pk_mul_f32 v[30:31],v[30:31],v[0:1] op_sel:[0,1]
v_pk_add_f32 v[34:35],v[34:35],v[126:127] op_sel_hi:[1,0] neg_lo:[0,1] neg_hi:[0,1]
v_pk_add_f32 v[112:113],v[112:113],v[114:115]
v_pk_add_f32 v[116:117],v[116:117],v[118:119]
v_pk_add_f32 v[24:25],v[24:25],v[126:127] op_sel_hi:[1,0] neg_lo:[0,1] neg_hi:[0,1]
v_pk_add_f32 v[26:27],v[26:27],v[126:127] op_sel_hi:[1,0] neg_lo:[0,1] neg_hi:[0,1]
v_pk_add_f32 v[28:29],v[28:29],v[126:127] op_sel_hi:[1,0] neg_lo:[0,1] neg_hi:[0,1]
v_pk_add_f32 v[30:31],v[30:31],v[126:127] op_sel_hi:[1,0] neg_lo:[0,1] neg_hi:[0,1]
v_exp_f32 v34,v34
v_exp_f32 v35,v35
v_cvt_pk_bf16_f32 v126,v112,v113
v_cvt_pk_bf16_f32 v124,v34,v35
v_cvt_pk_bf16_f32 v127,v116,v117
v_cvt_pk_bf16_f32 v36,v116,v117
v_mfma_f32_16x16x16_bf16 v[32:35],v[14:15],v[124:125],0
ds_read_b128 v[44:47],v11 offset:13312
v_exp_f32 v24,v24
v_mfma_f32_16x16x16_bf16 v[112:115],v[126:127],v[124:125],0
ds_read_b128 v[48:51],v11 offset:14336
v_exp_f32 v25,v25
v_mfma_f32_16x16x16_bf16 v[116:119],v[36:37],v[124:125],0
ds_read_b128 v[52:55],v11 offset:15360
v_exp_f32 v26,v26
v_exp_f32 v27,v27
v_cvt_pk_bf16_f32 v120,v24,v25
v_exp_f32 v28,v28
v_exp_f32 v29,v29
v_cvt_pk_bf16_f32 v121,v26,v27
v_exp_f32 v30,v30
v_exp_f32 v31,v31
v_cvt_pk_bf16_f32 v122,v28,v29
v_cvt_pk_bf16_f32 v123,v30,v31
s_add_u32 s75,s75,8192
s_add_u32 s51,s51,1
v_mfma_f32_16x16x32_bf16 v[32:35],v[14:17],v[120:123],v[32:35]
v_mfma_f32_16x16x32_bf16 v[112:115],v[88:91],v[120:123],v[112:115]
ds_read_b128 v[88:91],v11 offset:16384
v_mfma_f32_16x16x32_bf16 v[116:119],v[92:95],v[120:123],v[116:119]
ds_read_b128 v[92:95],v11 offset:17408
v_rcp_f32 v32,v32
v_mov_b64 v[24:25],-1
v_mov_b64 v[26:27],-1
s_add_u32 s64,s75,12582912
s_add_u32 s70,s64,4096
v_pk_mul_f32 v[112:113],v[112:113],v[32:33] op_sel_hi:[1,0]
v_pk_mul_f32 v[114:115],v[114:115],v[32:33] op_sel_hi:[1,0]
v_pk_mul_f32 v[116:117],v[116:117],v[32:33] op_sel_hi:[1,0]
v_pk_mul_f32 v[118:119],v[118:119],v[32:33] op_sel_hi:[1,0]
v_cvt_pk_bf16_f32 v120,v112,v116
v_cvt_pk_bf16_f32 v121,v113,v117
v_cvt_pk_bf16_f32 v122,v114,v118
v_cvt_pk_bf16_f32 v123,v115,v119
ds_write_b128 v7,v[120:123]
buffer_store_dwordx4 v[24:27],v0,s[8:11],s69 offen sc1
buffer_store_dwordx4 v[24:27],v0,s[8:11],s69 offen offset:1024 sc1
v_mov_b64 v[112:113],0
v_mov_b64 v[114:115],0
v_mov_b64 v[116:117],0
v_mov_b64 v[118:119],0
s_waitcnt lgkmcnt(0)
s_barrier
ds_read_b128 v[24:27],v8 offset:0
ds_read_b128 v[28:31],v8 offset:512
ds_read_b128 v[32:35],v8 offset:1024
ds_read_b128 v[36:39],v8 offset:1536
v_mov_b64 v[120:121],0
v_mov_b64 v[122:123],0
s_add_u32 s57,s65,65536
s_add_u32 s58,s65,131072
s_add_u32 s59,s65,196608
s_add_u32 s56,s18,s75
s_add_u32 s30,s75,17825792
s_waitcnt lgkmcnt(3)
v_smfmac_f32_16x16x64_bf16 v[112:115],v[24:27],v[56:63],v3
ds_read_b128 v[56:59],v11 offset:18432
s_waitcnt lgkmcnt(3)
v_smfmac_f32_16x16x64_bf16 v[112:115],v[28:31],v[64:71],v3
ds_read_b128 v[60:63],v11 offset:19456
s_waitcnt lgkmcnt(3)
v_smfmac_f32_16x16x64_bf16 v[112:115],v[32:35],v[72:79],v3
ds_read_b128 v[64:67],v11 offset:20480
s_waitcnt lgkmcnt(3)
v_smfmac_f32_16x16x64_bf16 v[112:115],v[36:39],v[80:87],v3
ds_read_b128 v[68:71],v11 offset:21504
v_smfmac_f32_16x16x64_bf16 v[116:119],v[24:27],v[96:103],v3
ds_read_b128 v[72:75],v11 offset:22528
v_smfmac_f32_16x16x64_bf16 v[116:119],v[28:31],v[104:111],v3
ds_read_b128 v[76:79],v11 offset:23552
v_cvt_pk_bf16_f32 v112,v112,v113
v_smfmac_f32_16x16x64_bf16 v[116:119],v[32:35],v[40:47],v3
ds_read_b128 v[80:83],v11 offset:24576
v_cvt_pk_bf16_f32 v113,v114,v115
buffer_store_dwordx2 v[112:113],v9,s[8:11],s65 offen sc1
v_smfmac_f32_16x16x64_bf16 v[116:119],v[36:39],v[48:55],v3
ds_read_b128 v[84:87],v11 offset:25600
v_mov_b64 v[112:113],0
v_smfmac_f32_16x16x64_bf16 v[120:123],v[24:27],v[88:95],v3
ds_read_b128 v[96:99],v11 offset:26624
ds_read_b128 v[100:103],v11 offset:27648
v_mov_b64 v[114:115],0
s_waitcnt lgkmcnt(8)
v_smfmac_f32_16x16x64_bf16 v[120:123],v[28:31],v[56:63],v3
ds_read_b128 v[104:107],v11 offset:28672
v_cvt_pk_bf16_f32 v116,v116,v117
s_waitcnt lgkmcnt(7)
v_smfmac_f32_16x16x64_bf16 v[120:123],v[32:35],v[64:71],v3
ds_read_b128 v[108:111],v11 offset:29696
ds_read_b128 v[40:43],v11 offset:30720
v_cvt_pk_bf16_f32 v117,v118,v119
buffer_store_dwordx2 v[116:117],v9,s[8:11],s57 offen sc1
s_waitcnt lgkmcnt(7)
v_smfmac_f32_16x16x64_bf16 v[120:123],v[36:39],v[72:79],v3
ds_read_b128 v[44:47],v11 offset:31744
v_add_u32 v52,s50,v5
s_waitcnt lgkmcnt(6)
v_smfmac_f32_16x16x64_bf16 v[112:115],v[24:27],v[80:87],v3
v_add_u32 v54,s50,v6
s_waitcnt lgkmcnt(4)
v_smfmac_f32_16x16x64_bf16 v[112:115],v[28:31],v[96:103],v3
ds_read_b64_tr_b16 v[52:53],v52
v_cvt_pk_bf16_f32 v120,v120,v121
s_waitcnt lgkmcnt(3)
v_smfmac_f32_16x16x64_bf16 v[112:115],v[32:35],v[104:111],v3
ds_read_b64_tr_b16 v[54:55],v54
v_cvt_pk_bf16_f32 v121,v122,v123
buffer_store_dwordx2 v[120:121],v9,s[8:11],s58 offen sc1
s_waitcnt lgkmcnt(2)
v_smfmac_f32_16x16x64_bf16 v[112:115],v[36:39],v[40:47],v3
v_mov_b64 v[116:117],0
v_mov_b64 v[118:119],0
s_xor_b32 s65,s65,262144
v_mov_b32_dpp v124,v126 quad_perm:[2,3,2,3] row_mask:0xf bank_mask:0xf
v_mov_b32_dpp v125,v127 quad_perm:[2,3,2,3] row_mask:0xf bank_mask:0xf
s_mov_b32 vcc_lo,0xcccccccc
s_mov_b32 vcc_hi,0xcccccccc
s_nop 0
v_cvt_pk_bf16_f32 v112,v112,v113
v_cvt_pk_bf16_f32 v113,v114,v115
buffer_store_dwordx2 v[112:113],v9,s[8:11],s59 offen sc1
s_waitcnt lgkmcnt(0)
s_buffer_load_dword s19,s[8:11],s56
v_cndmask_b32 v124,v124,v52,vcc
v_cndmask_b32 v125,v125,v53,vcc
v_cndmask_b32 v126,v126,v54,vcc
v_cndmask_b32 v127,v127,v55,vcc
s_cmp_lt_u32 s46,2
s_waitcnt vmcnt(3)
s_cbranch_scc1 L_crg_270
s_cmp_eq_u32 s46,2
s_waitcnt vmcnt(1)
s_cbranch_scc1 L_crg_270
s_waitcnt vmcnt(0)
L_crg_270:
buffer_load_dwordx4 v[32:35],v0,s[8:11],s66 offen offset:0 sc1
buffer_load_dwordx4 v[36:39],v0,s[8:11],s66 offen offset:1024 sc1
v_mov_b64 v[96:97],0
v_mov_b64 v[98:99],0
v_mov_b64 v[100:101],0
v_mov_b64 v[102:103],0
v_mov_b64 v[104:105],0
v_mov_b64 v[106:107],0
v_mov_b64 v[108:109],0
v_mov_b64 v[110:111],0
v_mov_b64 v[112:113],0
v_mov_b64 v[114:115],0
v_add_u32 v55,131072,v0
v_add_u32 v123,s73,v55
v_xor_b32 v120,1024,v12
v_xor_b32 v121,2048,v12
v_xor_b32 v122,3072,v12
buffer_load_dwordx4 v[44:47],v0,s[8:11],s66 offen offset:0 sc1
buffer_load_dwordx4 v[48:51],v0,s[8:11],s66 offen offset:1024 sc1
s_cmp_ge_u32 s51,63
s_cselect_b32 s76,0,1
s_cmp_eq_u32 s46,0
s_cselect_b32 s76,s76,0
s_waitcnt vmcnt(3)
v_mfma_f32_16x16x32_bf16 v[28:31],v[18:21],v[32:35],0
s_waitcnt vmcnt(2)
v_mfma_f32_16x16x32_bf16 v[28:31],v[18:21],v[36:39],v[28:31]
s_nop 7
v_cmp_u_f32 vcc,v28,v28
v_add_f32_dpp v52,v28,v28 row_ror:8 row_mask:0xf bank_mask:0x3
v_add_f32_dpp v53,v29,v29 row_ror:8 row_mask:0xf bank_mask:0x3
v_add_f32_dpp v52,v30,v30 row_ror:8 row_mask:0xf bank_mask:0xc
v_add_f32_dpp v53,v31,v31 row_ror:8 row_mask:0xf bank_mask:0xc
s_nop 0
v_add_f32_dpp v52,v52,v52 row_shl:4 row_mask:0xf bank_mask:0x5
v_add_f32_dpp v53,v53,v53 row_shl:4 row_mask:0xf bank_mask:0x5
s_cbranch_vccnz L_crp_265
L_cok_271:
v_cvt_pk_bf16_f32 v54,v52,v53
buffer_store_dword v54,v10,s[8:11],s64 offen sc1
s_mov_b32 s69,s66
s_xor_b32 s66,s66,262144
s_barrier
ds_read_b128 v[56:59],v55 offset:0
ds_read_b128 v[60:63],v55 offset:4096
ds_read_b128 v[64:67],v55 offset:1024
buffer_load_dwordx4 v[24:27],v13,s[8:11],s64 offen sc1
ds_read_b128 v[68:71],v55 offset:5120
ds_read_b128 v[72:75],v55 offset:2048
ds_read_b128 v[76:79],v55 offset:6144
ds_read_b128 v[80:83],v55 offset:3072
buffer_load_dwordx4 v[24:27],v13,s[8:11],s64 offen sc1
ds_read_b128 v[84:87],v55 offset:7168
ds_read_b128 v[88:91],v123 offset:8192
ds_read_b128 v[92:95],v123 offset:9216
s_branch L_chain_260
L_cpb_267:
buffer_load_dwordx4 v[40:43],v13,s[8:11],s70 offen sc1
s_sub_u32 s49,s49,1
s_cbranch_scc1 L_abort2
s_waitcnt vmcnt(0)
v_max3_u32 v123,v40,v41,v42
v_max_u32 v123,v43,v123
v_cmp_le_u32 vcc,s72,v123
s_cbranch_vccnz L_cpb_267
ds_write_b128 v12,v[40:43] offset:4096
s_branch L_cback_269
L_crp_265:
buffer_load_dwordx4 v[32:35],v0,s[8:11],s66 offen offset:0 sc1
buffer_load_dwordx4 v[36:39],v0,s[8:11],s66 offen offset:1024 sc1
s_sub_u32 s49,s49,1
s_cbranch_scc1 L_abort2
s_waitcnt vmcnt(3)
v_mfma_f32_16x16x32_bf16 v[28:31],v[18:21],v[44:47],0
s_waitcnt vmcnt(2)
v_mfma_f32_16x16x32_bf16 v[28:31],v[18:21],v[48:51],v[28:31]
s_nop 7
v_cmp_u_f32 vcc,v28,v28
v_add_f32_dpp v52,v28,v28 row_ror:8 row_mask:0xf bank_mask:0x3
v_add_f32_dpp v53,v29,v29 row_ror:8 row_mask:0xf bank_mask:0x3
v_add_f32_dpp v52,v30,v30 row_ror:8 row_mask:0xf bank_mask:0xc
v_add_f32_dpp v53,v31,v31 row_ror:8 row_mask:0xf bank_mask:0xc
s_nop 0
v_add_f32_dpp v52,v52,v52 row_shl:4 row_mask:0xf bank_mask:0x5
v_add_f32_dpp v53,v53,v53 row_shl:4 row_mask:0xf bank_mask:0x5
s_cbranch_vccz L_cok_271
buffer_load_dwordx4 v[44:47],v0,s[8:11],s66 offen offset:0 sc1
buffer_load_dwordx4 v[48:51],v0,s[8:11],s66 offen offset:1024 sc1
s_sub_u32 s49,s49,1
s_cbranch_scc1 L_abort2
s_waitcnt vmcnt(3)
v_mfma_f32_16x16x32_bf16 v[28:31],v[18:21],v[32:35],0
s_waitcnt vmcnt(2)
v_mfma_f32_16x16x32_bf16 v[28:31],v[18:21],v[36:39],v[28:31]
s_nop 7
v_cmp_u_f32 vcc,v28,v28
v_add_f32_dpp v52,v28,v28 row_ror:8 row_mask:0xf bank_mask:0x3
v_add_f32_dpp v53,v29,v29 row_ror:8 row_mask:0xf bank_mask:0x3
v_add_f32_dpp v52,v30,v30 row_ror:8 row_mask:0xf bank_mask:0xc
v_add_f32_dpp v53,v31,v31 row_ror:8 row_mask:0xf bank_mask:0xc
s_nop 0
v_add_f32_dpp v52,v52,v52 row_shl:4 row_mask:0xf bank_mask:0x5
v_add_f32_dpp v53,v53,v53 row_shl:4 row_mask:0xf bank_mask:0x5
s_cbranch_vccz L_cok_271
s_branch L_crp_265
L_ckw_253:
s_add_u32 s59,s18,s75
L_ww_272:
s_sleep 1
buffer_load_dword v23,off,s[8:11],s59 sc1
s_sub_u32 s49,s49,1
s_cbranch_scc1 L_abort2
s_waitcnt vmcnt(0)
v_readfirstlane_b32 s76,v23
s_cmp_eq_u32 s76,0
s_cbranch_scc1 L_ww_272
L_wwd_273:
s_branch L_ckb_254
L_cend_263:
v_smfmac_f32_16x16x64_bf16 v[116:119],v[36:39],v[184:191],v2
v_smfmac_f32_16x16x64_bf16 v[112:115],v[40:43],v[192:199],v2
v_smfmac_f32_16x16x64_bf16 v[116:119],v[40:43],v[200:207],v2
v_smfmac_f32_16x16x64_bf16 v[112:115],v[44:47],v[208:215],v2
v_smfmac_f32_16x16x64_bf16 v[116:119],v[44:47],v[216:223],v2
v_smfmac_f32_16x16x64_bf16 v[112:115],v[48:51],v[224:231],v2
v_smfmac_f32_16x16x64_bf16 v[116:119],v[48:51],v[232:239],v2
v_smfmac_f32_16x16x64_bf16 v[112:115],v[52:55],v[240:247],v2
v_smfmac_f32_16x16x64_bf16 v[116:119],v[52:55],v[248:255],v2
s_waitcnt lgkmcnt(0)
s_nop 2
v_pk_add_f32 v[112:113],v[112:113],v[114:115]
s_nop 2
v_pk_add_f32 v[116:117],v[116:117],v[118:119]
v_cvt_pk_bf16_f32 v126,v112,v113
v_cvt_pk_bf16_f32 v127,v116,v117
v_add_u32 v52,s50,v5
v_add_u32 v54,s50,v6
ds_read_b64_tr_b16 v[52:53],v52
ds_read_b64_tr_b16 v[54:55],v54
v_mov_b32_dpp v124,v126 quad_perm:[2,3,2,3] row_mask:0xf bank_mask:0xf
v_mov_b32_dpp v125,v127 quad_perm:[2,3,2,3] row_mask:0xf bank_mask:0xf
s_mov_b32 vcc_lo,0xcccccccc
s_mov_b32 vcc_hi,0xcccccccc
s_waitcnt lgkmcnt(0)
v_cndmask_b32 v124,v124,v52,vcc
v_cndmask_b32 v125,v125,v53,vcc
v_cndmask_b32 v126,v126,v54,vcc
v_cndmask_b32 v127,v127,v55,vcc
buffer_store_dwordx4 v[124:127],v0,s[8:11],s54 offen sc1
s_mov_b32 s51,64
s_waitcnt vmcnt(0)
s_barrier
s_nop 11
v_lshrrev_b32 v1,4,v0
s_endpgm
L_rc2_223:
v_and_b32 v120,15,v1
v_lshrrev_b32 v121,4,v1
v_and_b32 v122,2,v1
v_cmp_eq_u32 vcc,0,v122
v_mov_b32 v2,0xeeee
v_mov_b32 v123,0x4444
v_cndmask_b32 v2,v2,v123,vcc
v_and_b32 v122,1,v1
v_cmp_eq_u32 vcc,0,v122
v_mov_b32 v3,0xdddd
v_mov_b32 v123,0x8888
v_cndmask_b32 v3,v3,v123,vcc
v_lshrrev_b32 v122,1,v120
v_bfe_u32 v123,v120,2,1
v_xor_b32 v123,v123,v122
v_lshlrev_b32 v4,7,v123
v_and_b32 v123,1,v120
v_lshl_add_u32 v4,v123,6,v4
v_xor_b32 v123,v121,v122
v_and_b32 v123,3,v123
v_lshl_add_u32 v4,v123,4,v4
s_lshl_b32 s56,s46,10
s_add_u32 s56,s56,147456
v_add_u32 v4,s56,v4
v_lshlrev_b32 v122,1,v121
v_add_u32 v122,0,v122
v_and_b32 v123,1,v121
v_xor_b32 v123,v123,v122
v_lshlrev_b32 v5,7,v123
v_bfe_u32 v123,v120,3,1
v_lshl_add_u32 v5,v123,6,v5
v_xor_b32 v123,v120,v122
v_and_b32 v123,3,v123
v_lshl_add_u32 v5,v123,4,v5
v_bfe_u32 v123,v120,2,1
v_lshl_add_u32 v5,v123,3,v5
v_add_u32 v5,147456,v5
v_lshlrev_b32 v122,1,v121
v_add_u32 v122,1,v122
v_and_b32 v123,1,v121
v_xor_b32 v123,v123,v122
v_lshlrev_b32 v6,7,v123
v_bfe_u32 v123,v120,3,1
v_lshl_add_u32 v6,v123,6,v6
v_xor_b32 v123,v120,v122
v_and_b32 v123,3,v123
v_lshl_add_u32 v6,v123,4,v6
v_bfe_u32 v123,v120,2,1
v_lshl_add_u32 v6,v123,3,v6
v_add_u32 v6,147456,v6
v_lshlrev_b32 v7,7,v121
v_lshrrev_b32 v122,1,v120
v_lshl_add_u32 v8,v122,4,v7
v_add_u32 v8,151552,v8
v_lshrrev_b32 v122,2,v120
v_lshl_add_u32 v7,v122,5,v7
v_and_b32 v122,1,v120
v_lshl_add_u32 v7,v122,4,v7
v_and_b32 v122,2,v120
v_cmp_eq_u32 vcc,0,v122
s_lshl_b32 s56,s46,9
v_mov_b32 v122,2048
v_mov_b32 v123,s56
v_cndmask_b32 v122,v122,v123,vcc
v_add_u32 v7,v122,v7
v_add_u32 v7,151552,v7
v_lshrrev_b32 v122,3,v1
v_lshlrev_b32 v9,11,v122
v_and_b32 v122,7,v1
v_lshl_add_u32 v9,v122,3,v9
s_lshl_b32 s56,s46,14
s_lshl_b32 s57,s47,6
s_add_u32 s56,s56,s57
v_add_u32 v9,s56,v9
s_lshl_b32 s71,s46,5
s_add_u32 s71,s71,s47
s_bfe_u32 s56,s71,0x10003
s_lshl_b32 s56,s56,11
s_and_b32 s57,s71,1
s_lshl_b32 s57,s57,10
s_add_u32 s56,s56,s57
s_bfe_u32 s57,s71,0x10002
s_lshl_b32 s57,s57,9
s_add_u32 s56,s56,s57
s_bfe_u32 s57,s71,0x10001
s_lshl_b32 s57,s57,6
s_add_u32 s56,s56,s57
s_bfe_u32 s57,s71,0x10004
s_lshl_b32 s57,s57,8
s_add_u32 s56,s56,s57
s_bfe_u32 s57,s71,0x10005
s_lshl_b32 s57,s57,7
s_add_u32 s56,s56,s57
s_bfe_u32 s57,s71,0x10006
s_lshl_b32 s57,s57,12
s_add_u32 s56,s56,s57
v_and_b32 v122,3,v120
v_lshlrev_b32 v10,2,v122
v_bfe_u32 v122,v120,3,1
v_lshl_add_u32 v10,v122,4,v10
v_and_b32 v122,1,v121
v_lshl_add_u32 v10,v122,5,v10
v_add_u32 v10,s56,v10
v_and_b32 v123,36,v1
v_mov_b32 v122,0x80000000
v_cmp_eq_u32 vcc,0,v123
s_nop 1
v_cndmask_b32 v10,v122,v10,vcc
s_lshl_b32 s56,s46,15
v_add_u32 v11,s56,v0
s_lshl_b32 s71,s71,11
s_lshl_b32 s73,s46,11
s_mov_b32 s72,0xffc00000
s_mov_b32 s74,0
v_lshrrev_b32 v13,3,v1
v_lshlrev_b32 v13,9,v13
v_and_b32 v122,7,v1
v_lshl_add_u32 v13,v122,4,v13
v_and_b32 v122,15,v1
v_and_b32 v123,1,v1
v_lshlrev_b32 v123,4,v123
v_mov_b32 v124,0x3f80
v_lshlrev_b32 v124,v123,v124
v_lshrrev_b32 v122,1,v122
v_cmp_eq_u32 vcc,0,v122
s_nop 1
v_cndmask_b32 v18,0,v124,vcc
v_cmp_eq_u32 vcc,1,v122
s_nop 1
v_cndmask_b32 v19,0,v124,vcc
v_cmp_eq_u32 vcc,2,v122
s_nop 1
v_cndmask_b32 v20,0,v124,vcc
v_cmp_eq_u32 vcc,3,v122
s_nop 1
v_cndmask_b32 v21,0,v124,vcc
s_and_b32 s56,s46,1
s_lshl_b32 s56,s56,8
s_and_b32 s57,s46,2
s_lshl_b32 s57,s57,6
s_add_u32 s56,s56,s57
v_add_u32 v13,s56,v13
s_add_u32 s56,s50,155648
v_add_u32 v12,s56,v0
v_mov_b64 v[14:15],s[28:29]
v_mov_b64 v[16:17],s[28:29]
v_add_u32 v22,13647872,v10
s_lshl_b32 s18,s47,2
s_add_u32 s18,s18,10494080
v_mov_b32 v1,s80
s_mov_b32 s65,16777216
s_add_u32 s66,s71,16777216
s_add_u32 s69,s71,17039360
s_mov_b32 s30,0x40000000
s_mov_b32 s51,0
v_lshrrev_b32 v120,2,v0
v_add_u32 v120,10510464,v120
v_or_b32 v120,s52,v120
s_mov_b64 vcc,-1
s_mov_b32 vcc_lo,0
v_cndmask_b32 v22,v22,v120,vcc
s_or_b32 s56,s52,10495616
v_writelane_b32 v22,s56,4
s_or_b32 s56,s47,s46
s_mov_b32 s56,10486784
s_cmov_b32 s56,0x80000000
v_writelane_b32 v22,s56,5
s_mov_b32 s30,0
s_mov_b32 s31,0
L_cst_277:
s_cmp_lg_u32 s46,0
s_cbranch_scc1 L_csw_282
s_lshl_b32 s59,s31,13
s_add_u32 s59,s59,10486016
v_lshrrev_b32 v121,2,v0
v_and_b32 v121,127,v121
L_ckk_283:
s_sleep 1
buffer_load_dword v120,v121,s[8:11],s59 offen sc1
s_sub_u32 s49,s49,1
s_cbranch_scc1 L_abort2
s_waitcnt vmcnt(0)
v_cmp_eq_u32 vcc,0,v120
s_cbranch_vccnz L_ckk_283
v_max_u32_dpp v120,v120,v120 row_ror:8 row_mask:0xf bank_mask:0xf
s_nop 1
v_max_u32_dpp v120,v120,v120 row_ror:4 row_mask:0xf bank_mask:0xf
s_nop 1
v_max_u32_dpp v120,v120,v120 row_ror:2 row_mask:0xf bank_mask:0xf
s_nop 1
v_max_u32_dpp v120,v120,v120 row_ror:1 row_mask:0xf bank_mask:0xf
v_mov_b32 v121,v120
s_nop 1
v_permlane16_swap_b32 v120,v121
v_max_u32 v120,v120,v121
v_mov_b32 v121,v120
s_nop 1
v_permlane32_swap_b32 v120,v121
v_max_u32 v120,v120,v121
s_nop 0
v_readfirstlane_b32 s61,v120
s_max_u32 s30,s30,s61
s_add_u32 s31,s31,1
s_andn2_b32 s51,0x7ff,s30
s_lshr_b32 s51,s51,5
s_add_u32 s61,s51,2
s_min_u32 s61,s61,63
s_cmp_le_u32 s31,s61
s_cbranch_scc1 L_cst_277
v_mov_b32 v120,0
v_mov_b32 v121,s30
ds_write_b32 v8,v120 offset:2560
ds_write_b32 v8,v121 offset:3072
s_lshl_b32 s59,s51,13
s_lshl2_add_u32 s59,s47,s59
s_add_u32 s59,s59,10485888
L_ww_284:
s_sleep 1
buffer_load_dword v122,off,s[8:11],s59 sc1
s_sub_u32 s49,s49,1
s_cbranch_scc1 L_abort2
s_waitcnt vmcnt(0)
v_readfirstlane_b32 s61,v122
s_cmp_eq_u32 s61,0
s_cbranch_scc1 L_ww_284
L_wwd_285:
L_csw_282:
s_waitcnt lgkmcnt(0)
s_barrier
ds_read_b32 v120,v8 offset:3072
s_waitcnt lgkmcnt(0)
v_readfirstlane_b32 s30,v120
s_andn2_b32 s51,0x7ff,s30
s_lshr_b32 s51,s51,5
s_lshl_b32 s56,s51,5
s_add_u32 s56,s56,s47
s_mul_i32 s56,s56,24576
s_add_u32 s56,s56,150994944
s_add_u32 s67,s56,s73
s_add_u32 m0,s73,131072
s_add_u32 s57,s67,8192
buffer_load_dwordx4 v0,s[8:11],s67 offen sc1 lds
buffer_load_dwordx4 v0,s[8:11],s67 offen offset:1024 sc1 lds
s_add_u32 m0,s73,139264
s_add_u32 s67,s67,786432
buffer_load_dwordx4 v0,s[8:11],s57 offen sc1 lds
buffer_load_dwordx4 v0,s[8:11],s57 offen offset:1024 sc1 lds
s_lshl_b32 s75,s51,13
s_add_u32 s56,s75,13639680
buffer_load_dword v23,v10,s[8:11],s56 offen sc1
s_add_u32 s64,s75,17825792
s_add_u32 s70,s64,4096
s_lshl_b32 s68,s51,5
s_add_u32 s68,s68,s47
s_lshl_b32 s68,s68,12
s_lshl_b32 s56,s46,10
s_add_u32 s68,s68,s56
s_add_u32 s68,s68,75497472
s_mov_b32 s54,0x80000000
s_mov_b32 s77,0
s_mov_b32 s19,0
s_cmp_eq_u32 s51,63
s_cselect_b32 s76,1,s46
s_cmp_eq_u32 s76,0
s_cselect_b32 s76,1,0
v_mov_b64 v[96:97],0
v_mov_b64 v[98:99],0
v_mov_b64 v[100:101],0
v_mov_b64 v[102:103],0
v_mov_b64 v[104:105],0
v_mov_b64 v[106:107],0
v_mov_b64 v[108:109],0
v_mov_b64 v[110:111],0
v_mov_b64 v[112:113],0
v_mov_b64 v[114:115],0
v_mov_b64 v[116:117],0
v_mov_b64 v[118:119],0
v_lshrrev_b32 v56,8,v0
v_lshlrev_b32 v56,5,v56
v_bfe_u32 v57,v0,5,1
v_lshl_add_u32 v56,v57,2,v56
s_lshl_b32 s56,s46,7
s_add_u32 s56,s56,155648
v_add_u32 v56,s56,v56
v_xor_b32 v57,128,v56
v_xor_b32 v58,256,v56
v_xor_b32 v59,384,v56
s_andn2_b32 s56,31,s30
s_lshr_b32 s57,s56,4
s_lshl_b32 s58,s57,12
s_and_b32 s59,s56,15
s_lshl4_add_u32 s58,s59,s58
s_add_u32 s58,s58,s50
s_add_u32 s58,s58,131072
v_bfe_u32 v60,v0,6,2
v_lshlrev_b32 v60,8,v60
v_bfe_u32 v61,v0,4,2
v_lshl_add_u32 v60,v61,2,v60
v_add_u32 v60,s58,v60
s_lshr_b32 s58,s59,2
s_lshl_b32 s58,s58,8
s_lshl3_add_u32 s58,s57,s58
s_and_b32 s59,s56,3
s_lshl1_add_u32 s58,s59,s58
s_add_u32 s58,s58,s73
s_add_u32 s58,s58,139264
v_and_b32 v61,255,v0
v_add_u32 v61,s58,v61
s_cmp_lg_u32 s46,0
s_cbranch_scc1 L_chd_287
s_lshl_b32 s59,s51,10
s_add_u32 s59,s59,11337728
L_chp_286:
buffer_load_dwordx4 v[120:123],v0,s[8:11],s59 offen sc1
s_sub_u32 s49,s49,1
s_cbranch_scc1 L_abort2
s_waitcnt vmcnt(0)
v_max3_u32 v124,v120,v121,v122
v_max_u32 v124,v123,v124
v_cmp_eq_u32 vcc,-1,v124
s_cbranch_vccnz L_chp_286
ds_write_b128 v12,v[120:123]
L_chd_287:
s_waitcnt vmcnt(0) lgkmcnt(0)
s_barrier
ds_read2_b32 v[24:25],v56 offset0:0 offset1:2
ds_read2_b32 v[26:27],v56 offset0:4 offset1:6
ds_read2_b32 v[28:29],v57 offset0:0 offset1:2
ds_read2_b32 v[30:31],v57 offset0:4 offset1:6
ds_read2_b32 v[32:33],v58 offset0:0 offset1:2
ds_read2_b32 v[34:35],v58 offset0:4 offset1:6
ds_read2_b32 v[36:37],v59 offset0:0 offset1:2
ds_read2_b32 v[38:39],v59 offset0:4 offset1:6
s_waitcnt lgkmcnt(4)
ds_read2_b32 v[40:41],v56 offset0:128 offset1:130
ds_read2_b32 v[42:43],v56 offset0:132 offset1:134
ds_read2_b32 v[44:45],v57 offset0:128 offset1:130
ds_read2_b32 v[46:47],v57 offset0:132 offset1:134
ds_read2_b32 v[48:49],v58 offset0:128 offset1:130
ds_read2_b32 v[50:51],v58 offset0:132 offset1:134
ds_read2_b32 v[52:53],v59 offset0:128 offset1:130
ds_read2_b32 v[54:55],v59 offset0:132 offset1:134
s_waitcnt lgkmcnt(12)
v_smfmac_f32_16x16x64_bf16 v[100:103],v[24:27],a[128:135],v2
v_smfmac_f32_16x16x64_bf16 v[112:115],v[24:27],v[128:135],v2
v_smfmac_f32_16x16x64_bf16 v[108:111],v[24:27],a[136:143],v2
v_smfmac_f32_16x16x64_bf16 v[116:119],v[24:27],v[136:143],v2
s_waitcnt lgkmcnt(12)
v_smfmac_f32_16x16x64_bf16 v[100:103],v[28:31],a[144:151],v2
v_smfmac_f32_16x16x64_bf16 v[112:115],v[28:31],v[144:151],v2
v_smfmac_f32_16x16x64_bf16 v[108:111],v[28:31],a[152:159],v2
v_smfmac_f32_16x16x64_bf16 v[116:119],v[28:31],v[152:159],v2
s_waitcnt lgkmcnt(10)
v_smfmac_f32_16x16x64_bf16 v[100:103],v[32:35],a[160:167],v2
v_smfmac_f32_16x16x64_bf16 v[112:115],v[32:35],v[160:167],v2
v_smfmac_f32_16x16x64_bf16 v[108:111],v[32:35],a[168:175],v2
v_smfmac_f32_16x16x64_bf16 v[116:119],v[32:35],v[168:175],v2
s_waitcnt lgkmcnt(8)
v_smfmac_f32_16x16x64_bf16 v[100:103],v[36:39],a[176:183],v2
v_smfmac_f32_16x16x64_bf16 v[112:115],v[36:39],v[176:183],v2
v_smfmac_f32_16x16x64_bf16 v[108:111],v[36:39],a[184:191],v2
v_smfmac_f32_16x16x64_bf16 v[116:119],v[36:39],v[184:191],v2
s_waitcnt lgkmcnt(6)
v_smfmac_f32_16x16x64_bf16 v[100:103],v[40:43],a[192:199],v2
v_smfmac_f32_16x16x64_bf16 v[112:115],v[40:43],v[192:199],v2
v_smfmac_f32_16x16x64_bf16 v[108:111],v[40:43],a[200:207],v2
v_smfmac_f32_16x16x64_bf16 v[116:119],v[40:43],v[200:207],v2
s_waitcnt lgkmcnt(4)
v_smfmac_f32_16x16x64_bf16 v[100:103],v[44:47],a[208:215],v2
v_smfmac_f32_16x16x64_bf16 v[112:115],v[44:47],v[208:215],v2
v_smfmac_f32_16x16x64_bf16 v[108:111],v[44:47],a[216:223],v2
v_smfmac_f32_16x16x64_bf16 v[116:119],v[44:47],v[216:223],v2
s_waitcnt lgkmcnt(2)
v_smfmac_f32_16x16x64_bf16 v[100:103],v[48:51],a[224:231],v2
v_smfmac_f32_16x16x64_bf16 v[112:115],v[48:51],v[224:231],v2
v_smfmac_f32_16x16x64_bf16 v[108:111],v[48:51],a[232:239],v2
v_smfmac_f32_16x16x64_bf16 v[116:119],v[48:51],v[232:239],v2
s_waitcnt lgkmcnt(0)
v_smfmac_f32_16x16x64_bf16 v[100:103],v[52:55],a[240:247],v2
v_smfmac_f32_16x16x64_bf16 v[112:115],v[52:55],v[240:247],v2
v_smfmac_f32_16x16x64_bf16 v[108:111],v[52:55],a[248:255],v2
v_smfmac_f32_16x16x64_bf16 v[116:119],v[52:55],v[248:255],v2
v_add_f32 v100,v100,v102
v_add_f32 v112,v112,v114
s_nop 1
v_add_f32 v108,v108,v110
s_nop 2
v_add_f32 v116,v116,v118
v_cvt_pk_bf16_f32 v120,v100,v108
v_cvt_pk_bf16_f32 v121,v112,v116
ds_write_b32 v60,v120
ds_write_b16 v61,v121
ds_write_b16_d16_hi v61,v121 offset:1024
v_mov_b64 v[96:97],0
v_mov_b64 v[98:99],0
v_mov_b64 v[100:101],0
v_mov_b64 v[102:103],0
v_mov_b64 v[104:105],0
v_mov_b64 v[106:107],0
v_mov_b64 v[108:109],0
v_mov_b64 v[110:111],0
v_mov_b64 v[112:113],0
v_mov_b64 v[114:115],0
v_mov_b64 v[116:117],0
v_mov_b64 v[118:119],0
s_waitcnt vmcnt(0) lgkmcnt(0)
s_barrier
v_add_u32 v55,131072,v0
ds_read_b128 v[56:59],v55 offset:0
ds_read_b128 v[60:63],v55 offset:4096
ds_read_b128 v[64:67],v55 offset:1024
ds_read_b128 v[68:71],v55 offset:5120
ds_read_b128 v[72:75],v55 offset:2048
ds_read_b128 v[76:79],v55 offset:6144
ds_read_b128 v[80:83],v55 offset:3072
ds_read_b128 v[84:87],v55 offset:7168
v_add_u32 v123,s73,v55
ds_read_b128 v[88:91],v123 offset:8192
ds_read_b128 v[92:95],v123 offset:9216
v_xor_b32 v120,1024,v12
v_xor_b32 v121,2048,v12
v_xor_b32 v122,3072,v12
buffer_load_dwordx4 v[24:27],v13,s[8:11],s64 offen sc1
buffer_load_dwordx4 v[24:27],v13,s[8:11],s64 offen sc1
L_chain_288:
L_cpa_289:
buffer_load_dwordx4 v[24:27],v13,s[8:11],s64 offen sc1
s_sub_u32 s49,s49,1
s_cbranch_scc1 L_abort2
s_waitcnt vmcnt(2)
v_max3_u32 v123,v24,v25,v26
v_max_u32 v123,v27,v123
v_cmp_le_u32 vcc,s72,v123
ds_write_b128 v12,v[24:27] offset:0
s_cbranch_vccnz L_cpa_289
L_cgo_292:
v_smfmac_f32_16x16x64_bf16 v[96:99],v[24:27],a[0:7],v2
buffer_load_dwordx4 v[40:43],v13,s[8:11],s70 offen sc1
v_smfmac_f32_16x16x64_bf16 v[100:103],v[24:27],a[128:135],v2
s_waitcnt lgkmcnt(0)
s_barrier
ds_read_b128 v[28:31],v120 offset:0
v_smfmac_f32_16x16x64_bf16 v[104:107],v[24:27],a[8:15],v2
ds_read_b128 v[32:35],v121 offset:0
v_smfmac_f32_16x16x64_bf16 v[108:111],v[24:27],a[136:143],v2
ds_read_b128 v[36:39],v122 offset:0
v_smfmac_f32_16x16x64_bf16 v[112:115],v[24:27],v[128:135],v2
v_smfmac_f32_16x16x64_bf16 v[116:119],v[24:27],v[136:143],v2
s_waitcnt lgkmcnt(2)
v_smfmac_f32_16x16x64_bf16 v[96:99],v[28:31],a[16:23],v2
s_add_u32 m0,s73,131072
v_smfmac_f32_16x16x64_bf16 v[100:103],v[28:31],a[144:151],v2
s_add_u32 s57,s67,8192
v_smfmac_f32_16x16x64_bf16 v[104:107],v[28:31],a[24:31],v2
s_cmp_lt_u32 s19,s76
s_cbranch_scc1 L_ckw_278
L_ckb_279:
v_smfmac_f32_16x16x64_bf16 v[108:111],v[28:31],a[152:159],v2
s_waitcnt vmcnt(0) lgkmcnt(1)
v_smfmac_f32_16x16x64_bf16 v[96:99],v[32:35],a[32:39],v2
ds_write_b128 v12,v[40:43] offset:4096
v_max3_u32 v123,v40,v41,v42
v_smfmac_f32_16x16x64_bf16 v[100:103],v[32:35],a[160:167],v2
v_max_u32 v123,v43,v123
v_smfmac_f32_16x16x64_bf16 v[104:107],v[32:35],a[40:47],v2
v_cmp_le_u32 vcc,s72,v123
v_smfmac_f32_16x16x64_bf16 v[108:111],v[32:35],a[168:175],v2
v_smfmac_f32_16x16x64_bf16 v[112:115],v[28:31],v[144:151],v2
s_cbranch_vccnz L_cpb_295
L_cback_297:
s_waitcnt lgkmcnt(0)
s_barrier
v_smfmac_f32_16x16x64_bf16 v[96:99],v[36:39],a[48:55],v2
buffer_store_dwordx4 v[124:127],v0,s[8:11],s54 offen sc1
v_smfmac_f32_16x16x64_bf16 v[100:103],v[36:39],a[176:183],v2
ds_read_b128 v[44:47],v120 offset:4096
v_smfmac_f32_16x16x64_bf16 v[104:107],v[36:39],a[56:63],v2
buffer_load_dwordx4 v0,s[8:11],s67 offen sc1 lds
v_smfmac_f32_16x16x64_bf16 v[108:111],v[36:39],a[184:191],v2
ds_read_b128 v[48:51],v121 offset:4096
v_smfmac_f32_16x16x64_bf16 v[96:99],v[40:43],a[64:71],v2
buffer_load_dwordx4 v0,s[8:11],s67 offen offset:1024 sc1 lds
s_add_u32 m0,s73,139264
v_smfmac_f32_16x16x64_bf16 v[100:103],v[40:43],a[192:199],v2
ds_read_b128 v[52:55],v122 offset:4096
v_smfmac_f32_16x16x64_bf16 v[104:107],v[40:43],a[72:79],v2
buffer_load_dwordx4 v0,s[8:11],s57 offen sc1 lds
s_add_u32 s67,s67,786432
v_smfmac_f32_16x16x64_bf16 v[108:111],v[40:43],a[200:207],v2
ds_read_b32 v123,v8 offset:2560
s_waitcnt lgkmcnt(3)
v_smfmac_f32_16x16x64_bf16 v[96:99],v[44:47],a[80:87],v2
buffer_load_dwordx4 v0,s[8:11],s57 offen offset:1024 sc1 lds
v_smfmac_f32_16x16x64_bf16 v[100:103],v[44:47],a[208:215],v2
s_waitcnt lgkmcnt(2)
v_smfmac_f32_16x16x64_bf16 v[96:99],v[48:51],a[96:103],v2
buffer_load_dword v23,v22,s[8:11],s75 offen sc1
v_smfmac_f32_16x16x64_bf16 v[100:103],v[48:51],a[224:231],v2
s_waitcnt lgkmcnt(0)
v_smfmac_f32_16x16x64_bf16 v[96:99],v[52:55],a[112:119],v2
v_smfmac_f32_16x16x64_bf16 v[100:103],v[52:55],a[240:247],v2
v_readfirstlane_b32 s58,v123
v_smfmac_f32_16x16x64_bf16 v[104:107],v[44:47],a[88:95],v2
v_smfmac_f32_16x16x64_bf16 v[108:111],v[44:47],a[216:223],v2
s_cmp_lg_u32 s58,0
s_cbranch_scc1 L_cjump_281
v_smfmac_f32_16x16x64_bf16 v[104:107],v[48:51],a[104:111],v2
v_add_f32 v96,v96,v98
v_smfmac_f32_16x16x64_bf16 v[108:111],v[48:51],a[232:239],v2
v_add_f32 v97,v97,v99
v_smfmac_f32_16x16x64_bf16 v[104:107],v[52:55],a[120:127],v2
v_cvt_pk_bf16_f32 v120,v96,v97
v_smfmac_f32_16x16x64_bf16 v[108:111],v[52:55],a[248:255],v2
v_add_f32 v100,v100,v102
v_smfmac_f32_16x16x64_bf16 v[116:119],v[28:31],v[152:159],v2
v_add_f32 v101,v101,v103
v_smfmac_f32_16x16x64_bf16 v[112:115],v[32:35],v[160:167],v2
v_cvt_pk_bf16_f32 v121,v100,v101
v_add_f32 v104,v104,v106
v_add_f32 v105,v105,v107
v_cvt_pk_bf16_f32 v122,v104,v105
v_add_f32 v108,v108,v110
v_add_f32 v109,v109,v111
v_cvt_pk_bf16_f32 v123,v108,v109
ds_write_b128 v4,v[120:123]
v_smfmac_f32_16x16x64_bf16 v[116:119],v[32:35],v[168:175],v2
s_mov_b32 s54,s68
s_add_u32 s68,s68,131072
v_mov_b32 v125,0
v_smfmac_f32_16x16x64_bf16 v[112:115],v[36:39],v[176:183],v2
s_cmp_eq_u32 s51,63
s_cbranch_scc1 L_cend_291
v_smfmac_f32_16x16x64_bf16 v[116:119],v[36:39],v[184:191],v2
v_smfmac_f32_16x16x64_bf16 v[112:115],v[40:43],v[192:199],v2
s_waitcnt lgkmcnt(0)
s_barrier
ds_read_b64_tr_b16 v[96:97],v5 offset:0
ds_read_b64_tr_b16 v[98:99],v6 offset:0
v_smfmac_f32_16x16x64_bf16 v[116:119],v[40:43],v[200:207],v2
ds_read_b64_tr_b16 v[100:101],v5 offset:1024
v_smfmac_f32_16x16x64_bf16 v[112:115],v[44:47],v[208:215],v2
ds_read_b64_tr_b16 v[102:103],v6 offset:1024
v_smfmac_f32_16x16x64_bf16 v[116:119],v[44:47],v[216:223],v2
ds_read_b64_tr_b16 v[104:105],v5 offset:2048
v_smfmac_f32_16x16x64_bf16 v[112:115],v[48:51],v[224:231],v2
ds_read_b64_tr_b16 v[106:107],v6 offset:2048
s_waitcnt lgkmcnt(4)
v_mfma_f32_16x16x32_bf16 v[24:27],v[56:59],v[96:99],0
ds_read_b64_tr_b16 v[108:109],v5 offset:3072
v_mfma_f32_16x16x32_bf16 v[28:31],v[60:63],v[96:99],0
ds_read_b64_tr_b16 v[110:111],v6 offset:3072
v_mfma_f32_16x16x32_bf16 v[32:35],v[96:99],v[96:99],0
ds_read_b128 v[40:43],v11 offset:12288
s_waitcnt lgkmcnt(5)
v_mfma_f32_16x16x32_bf16 v[24:27],v[64:67],v[100:103],v[24:27]
ds_read_b128 v[56:59],v11 offset:0
v_mfma_f32_16x16x32_bf16 v[28:31],v[68:71],v[100:103],v[28:31]
ds_read_b128 v[60:63],v11 offset:1024
v_mfma_f32_16x16x32_bf16 v[32:35],v[100:103],v[100:103],v[32:35]
ds_read_b128 v[96:99],v11 offset:8192
s_waitcnt lgkmcnt(6)
v_mfma_f32_16x16x32_bf16 v[24:27],v[72:75],v[104:107],v[24:27]
ds_read_b128 v[64:67],v11 offset:2048
v_mfma_f32_16x16x32_bf16 v[28:31],v[76:79],v[104:107],v[28:31]
ds_read_b128 v[68:71],v11 offset:3072
v_mfma_f32_16x16x32_bf16 v[32:35],v[104:107],v[104:107],v[32:35]
ds_read_b128 v[100:103],v11 offset:9216
s_waitcnt lgkmcnt(7)
v_mfma_f32_16x16x32_bf16 v[24:27],v[80:83],v[108:111],v[24:27]
ds_read_b128 v[72:75],v11 offset:4096
v_mfma_f32_16x16x32_bf16 v[28:31],v[84:87],v[108:111],v[28:31]
ds_read_b128 v[76:79],v11 offset:5120
v_mfma_f32_16x16x32_bf16 v[32:35],v[108:111],v[108:111],v[32:35]
ds_read_b128 v[104:107],v11 offset:10240
v_smfmac_f32_16x16x64_bf16 v[116:119],v[48:51],v[232:239],v2
ds_read_b128 v[80:83],v11 offset:6144
v_smfmac_f32_16x16x64_bf16 v[112:115],v[52:55],v[240:247],v2
ds_read_b128 v[84:87],v11 offset:7168
v_smfmac_f32_16x16x64_bf16 v[116:119],v[52:55],v[248:255],v2
ds_read_b128 v[108:111],v11 offset:11264
v_max3_f32 v126,v24,v25,v26
v_max3_f32 v127,v27,v28,v29
v_max3_f32 v126,v30,v31,v126
v_max3_f32 v127,v34,v35,v127
v_max_f32 v126,v126,v127
v_max_f32 v127,v126,v127
v_pk_mul_f32 v[34:35],v[34:35],v[0:1] op_sel:[0,1]
v_pk_mul_f32 v[24:25],v[24:25],v[0:1] op_sel:[0,1]
v_permlane16_swap_b32 v126,v127
v_max_f32 v126,v126,v127
v_max_f32 v127,v126,v127
v_pk_mul_f32 v[26:27],v[26:27],v[0:1] op_sel:[0,1]
v_pk_mul_f32 v[28:29],v[28:29],v[0:1] op_sel:[0,1]
v_permlane32_swap_b32 v126,v127
v_max_f32 v126,v126,v127
v_mul_f32 v126,v1,v126
v_pk_mul_f32 v[30:31],v[30:31],v[0:1] op_sel:[0,1]
v_pk_add_f32 v[34:35],v[34:35],v[126:127] op_sel_hi:[1,0] neg_lo:[0,1] neg_hi:[0,1]
v_pk_add_f32 v[112:113],v[112:113],v[114:115]
v_pk_add_f32 v[116:117],v[116:117],v[118:119]
v_pk_add_f32 v[24:25],v[24:25],v[126:127] op_sel_hi:[1,0] neg_lo:[0,1] neg_hi:[0,1]
v_pk_add_f32 v[26:27],v[26:27],v[126:127] op_sel_hi:[1,0] neg_lo:[0,1] neg_hi:[0,1]
v_pk_add_f32 v[28:29],v[28:29],v[126:127] op_sel_hi:[1,0] neg_lo:[0,1] neg_hi:[0,1]
v_pk_add_f32 v[30:31],v[30:31],v[126:127] op_sel_hi:[1,0] neg_lo:[0,1] neg_hi:[0,1]
v_exp_f32 v34,v34
v_exp_f32 v35,v35
v_cvt_pk_bf16_f32 v126,v112,v113
v_cvt_pk_bf16_f32 v124,v34,v35
v_cvt_pk_bf16_f32 v127,v116,v117
v_cvt_pk_bf16_f32 v36,v116,v117
v_mfma_f32_16x16x16_bf16 v[32:35],v[14:15],v[124:125],0
ds_read_b128 v[44:47],v11 offset:13312
v_exp_f32 v24,v24
v_mfma_f32_16x16x16_bf16 v[112:115],v[126:127],v[124:125],0
ds_read_b128 v[48:51],v11 offset:14336
v_exp_f32 v25,v25
v_mfma_f32_16x16x16_bf16 v[116:119],v[36:37],v[124:125],0
ds_read_b128 v[52:55],v11 offset:15360
v_exp_f32 v26,v26
v_exp_f32 v27,v27
v_cvt_pk_bf16_f32 v120,v24,v25
v_exp_f32 v28,v28
v_exp_f32 v29,v29
v_cvt_pk_bf16_f32 v121,v26,v27
v_exp_f32 v30,v30
v_exp_f32 v31,v31
v_cvt_pk_bf16_f32 v122,v28,v29
v_cvt_pk_bf16_f32 v123,v30,v31
s_add_u32 s75,s75,8192
s_add_u32 s51,s51,1
v_mfma_f32_16x16x32_bf16 v[32:35],v[14:17],v[120:123],v[32:35]
v_mfma_f32_16x16x32_bf16 v[112:115],v[88:91],v[120:123],v[112:115]
ds_read_b128 v[88:91],v11 offset:16384
v_mfma_f32_16x16x32_bf16 v[116:119],v[92:95],v[120:123],v[116:119]
ds_read_b128 v[92:95],v11 offset:17408
v_rcp_f32 v32,v32
v_mov_b64 v[24:25],-1
v_mov_b64 v[26:27],-1
s_add_u32 s64,s75,13631488
s_add_u32 s70,s64,4096
v_pk_mul_f32 v[112:113],v[112:113],v[32:33] op_sel_hi:[1,0]
v_pk_mul_f32 v[114:115],v[114:115],v[32:33] op_sel_hi:[1,0]
v_pk_mul_f32 v[116:117],v[116:117],v[32:33] op_sel_hi:[1,0]
v_pk_mul_f32 v[118:119],v[118:119],v[32:33] op_sel_hi:[1,0]
v_cvt_pk_bf16_f32 v120,v112,v116
v_cvt_pk_bf16_f32 v121,v113,v117
v_cvt_pk_bf16_f32 v122,v114,v118
v_cvt_pk_bf16_f32 v123,v115,v119
ds_write_b128 v7,v[120:123]
buffer_store_dwordx4 v[24:27],v0,s[8:11],s69 offen sc1
buffer_store_dwordx4 v[24:27],v0,s[8:11],s69 offen offset:1024 sc1
v_mov_b64 v[112:113],0
v_mov_b64 v[114:115],0
v_mov_b64 v[116:117],0
v_mov_b64 v[118:119],0
s_waitcnt lgkmcnt(0)
s_barrier
ds_read_b128 v[24:27],v8 offset:0
ds_read_b128 v[28:31],v8 offset:512
ds_read_b128 v[32:35],v8 offset:1024
ds_read_b128 v[36:39],v8 offset:1536
v_mov_b64 v[120:121],0
v_mov_b64 v[122:123],0
s_add_u32 s57,s65,65536
s_add_u32 s58,s65,131072
s_add_u32 s59,s65,196608
s_add_u32 s56,s18,s75
s_waitcnt lgkmcnt(3)
v_smfmac_f32_16x16x64_bf16 v[112:115],v[24:27],v[56:63],v3
ds_read_b128 v[56:59],v11 offset:18432
s_waitcnt lgkmcnt(3)
v_smfmac_f32_16x16x64_bf16 v[112:115],v[28:31],v[64:71],v3
ds_read_b128 v[60:63],v11 offset:19456
s_waitcnt lgkmcnt(3)
v_smfmac_f32_16x16x64_bf16 v[112:115],v[32:35],v[72:79],v3
ds_read_b128 v[64:67],v11 offset:20480
s_waitcnt lgkmcnt(3)
v_smfmac_f32_16x16x64_bf16 v[112:115],v[36:39],v[80:87],v3
ds_read_b128 v[68:71],v11 offset:21504
v_smfmac_f32_16x16x64_bf16 v[116:119],v[24:27],v[96:103],v3
ds_read_b128 v[72:75],v11 offset:22528
v_smfmac_f32_16x16x64_bf16 v[116:119],v[28:31],v[104:111],v3
ds_read_b128 v[76:79],v11 offset:23552
v_cvt_pk_bf16_f32 v112,v112,v113
v_smfmac_f32_16x16x64_bf16 v[116:119],v[32:35],v[40:47],v3
ds_read_b128 v[80:83],v11 offset:24576
v_cvt_pk_bf16_f32 v113,v114,v115
buffer_store_dwordx2 v[112:113],v9,s[8:11],s65 offen sc1
v_smfmac_f32_16x16x64_bf16 v[116:119],v[36:39],v[48:55],v3
ds_read_b128 v[84:87],v11 offset:25600
v_mov_b64 v[112:113],0
v_smfmac_f32_16x16x64_bf16 v[120:123],v[24:27],v[88:95],v3
ds_read_b128 v[96:99],v11 offset:26624
ds_read_b128 v[100:103],v11 offset:27648
v_mov_b64 v[114:115],0
s_waitcnt lgkmcnt(8)
v_smfmac_f32_16x16x64_bf16 v[120:123],v[28:31],v[56:63],v3
ds_read_b128 v[104:107],v11 offset:28672
v_cvt_pk_bf16_f32 v116,v116,v117
s_waitcnt lgkmcnt(7)
v_smfmac_f32_16x16x64_bf16 v[120:123],v[32:35],v[64:71],v3
ds_read_b128 v[108:111],v11 offset:29696
ds_read_b128 v[40:43],v11 offset:30720
v_cvt_pk_bf16_f32 v117,v118,v119
buffer_store_dwordx2 v[116:117],v9,s[8:11],s57 offen sc1
s_waitcnt lgkmcnt(7)
v_smfmac_f32_16x16x64_bf16 v[120:123],v[36:39],v[72:79],v3
ds_read_b128 v[44:47],v11 offset:31744
v_add_u32 v52,s50,v5
s_waitcnt lgkmcnt(6)
v_smfmac_f32_16x16x64_bf16 v[112:115],v[24:27],v[80:87],v3
v_add_u32 v54,s50,v6
s_waitcnt lgkmcnt(4)
v_smfmac_f32_16x16x64_bf16 v[112:115],v[28:31],v[96:103],v3
ds_read_b64_tr_b16 v[52:53],v52
v_cvt_pk_bf16_f32 v120,v120,v121
s_waitcnt lgkmcnt(3)
v_smfmac_f32_16x16x64_bf16 v[112:115],v[32:35],v[104:111],v3
ds_read_b64_tr_b16 v[54:55],v54
v_cvt_pk_bf16_f32 v121,v122,v123
buffer_store_dwordx2 v[120:121],v9,s[8:11],s58 offen sc1
s_waitcnt lgkmcnt(2)
v_smfmac_f32_16x16x64_bf16 v[112:115],v[36:39],v[40:47],v3
v_mov_b64 v[116:117],0
v_mov_b64 v[118:119],0
s_xor_b32 s65,s65,262144
v_mov_b32_dpp v124,v126 quad_perm:[2,3,2,3] row_mask:0xf bank_mask:0xf
v_mov_b32_dpp v125,v127 quad_perm:[2,3,2,3] row_mask:0xf bank_mask:0xf
s_mov_b32 vcc_lo,0xcccccccc
s_mov_b32 vcc_hi,0xcccccccc
s_nop 0
v_cvt_pk_bf16_f32 v112,v112,v113
v_cvt_pk_bf16_f32 v113,v114,v115
buffer_store_dwordx2 v[112:113],v9,s[8:11],s59 offen sc1
s_waitcnt lgkmcnt(0)
s_buffer_load_dword s19,s[8:11],s56
v_cndmask_b32 v124,v124,v52,vcc
v_cndmask_b32 v125,v125,v53,vcc
v_cndmask_b32 v126,v126,v54,vcc
v_cndmask_b32 v127,v127,v55,vcc
s_cmp_lt_u32 s46,2
s_waitcnt vmcnt(3)
s_cbranch_scc1 L_crg_298
s_cmp_eq_u32 s46,2
s_waitcnt vmcnt(1)
s_cbranch_scc1 L_crg_298
s_waitcnt vmcnt(0)
L_crg_298:
buffer_load_dwordx4 v[32:35],v0,s[8:11],s66 offen offset:0 sc1
buffer_load_dwordx4 v[36:39],v0,s[8:11],s66 offen offset:1024 sc1
v_mov_b64 v[96:97],0
v_mov_b64 v[98:99],0
v_mov_b64 v[100:101],0
v_mov_b64 v[102:103],0
v_mov_b64 v[104:105],0
v_mov_b64 v[106:107],0
v_mov_b64 v[108:109],0
v_mov_b64 v[110:111],0
v_mov_b64 v[112:113],0
v_mov_b64 v[114:115],0
v_add_u32 v55,131072,v0
v_add_u32 v123,s73,v55
v_xor_b32 v120,1024,v12
v_xor_b32 v121,2048,v12
v_xor_b32 v122,3072,v12
buffer_load_dwordx4 v[44:47],v0,s[8:11],s66 offen offset:0 sc1
buffer_load_dwordx4 v[48:51],v0,s[8:11],s66 offen offset:1024 sc1
s_cmp_ge_u32 s51,63
s_cselect_b32 s76,0,1
v_readlane_b32 s56,v23,5
v_readlane_b32 s20,v23,4
v_add_u32 v23,-1,v23
v_cmp_le_u32 vcc,s30,v23
s_cmp_gt_u32 s51,61
s_cselect_b32 s77,0,vcc_hi
s_cmp_gt_u32 s20,s30
s_cselect_b32 s77,1,s77
s_cmp_lg_u32 s77,0
s_cselect_b32 s76,2,s76
s_cmp_gt_u32 s56,s30
s_cbranch_scc1 L_cld_274
L_clb_275:
s_cmp_eq_u32 s46,0
s_cselect_b32 s76,s76,0
s_waitcnt vmcnt(3)
v_mfma_f32_16x16x32_bf16 v[28:31],v[18:21],v[32:35],0
s_waitcnt vmcnt(2)
v_mfma_f32_16x16x32_bf16 v[28:31],v[18:21],v[36:39],v[28:31]
s_nop 7
v_cmp_u_f32 vcc,v28,v28
v_add_f32_dpp v52,v28,v28 row_ror:8 row_mask:0xf bank_mask:0x3
v_add_f32_dpp v53,v29,v29 row_ror:8 row_mask:0xf bank_mask:0x3
v_add_f32_dpp v52,v30,v30 row_ror:8 row_mask:0xf bank_mask:0xc
v_add_f32_dpp v53,v31,v31 row_ror:8 row_mask:0xf bank_mask:0xc
s_nop 0
v_add_f32_dpp v52,v52,v52 row_shl:4 row_mask:0xf bank_mask:0x5
v_add_f32_dpp v53,v53,v53 row_shl:4 row_mask:0xf bank_mask:0x5
s_cbranch_vccnz L_crp_293
L_cok_299:
v_cvt_pk_bf16_f32 v54,v52,v53
buffer_store_dword v54,v10,s[8:11],s64 offen sc1
s_mov_b32 s69,s66
s_xor_b32 s66,s66,262144
s_barrier
ds_read_b128 v[56:59],v55 offset:0
ds_read_b128 v[60:63],v55 offset:4096
ds_read_b128 v[64:67],v55 offset:1024
buffer_load_dwordx4 v[24:27],v13,s[8:11],s64 offen sc1
ds_read_b128 v[68:71],v55 offset:5120
ds_read_b128 v[72:75],v55 offset:2048
ds_read_b128 v[76:79],v55 offset:6144
ds_read_b128 v[80:83],v55 offset:3072
buffer_load_dwordx4 v[24:27],v13,s[8:11],s64 offen sc1
ds_read_b128 v[84:87],v55 offset:7168
ds_read_b128 v[88:91],v123 offset:8192
ds_read_b128 v[92:95],v123 offset:9216
s_branch L_chain_288
L_cpb_295:
buffer_load_dwordx4 v[40:43],v13,s[8:11],s70 offen sc1
s_sub_u32 s49,s49,1
s_cbranch_scc1 L_abort2
s_waitcnt vmcnt(0)
v_max3_u32 v123,v40,v41,v42
v_max_u32 v123,v43,v123
v_cmp_le_u32 vcc,s72,v123
s_cbranch_vccnz L_cpb_295
ds_write_b128 v12,v[40:43] offset:4096
s_branch L_cback_297
L_crp_293:
buffer_load_dwordx4 v[32:35],v0,s[8:11],s66 offen offset:0 sc1
buffer_load_dwordx4 v[36:39],v0,s[8:11],s66 offen offset:1024 sc1
s_sub_u32 s49,s49,1
s_cbranch_scc1 L_abort2
s_waitcnt vmcnt(3)
v_mfma_f32_16x16x32_bf16 v[28:31],v[18:21],v[44:47],0
s_waitcnt vmcnt(2)
v_mfma_f32_16x16x32_bf16 v[28:31],v[18:21],v[48:51],v[28:31]
s_nop 7
v_cmp_u_f32 vcc,v28,v28
v_add_f32_dpp v52,v28,v28 row_ror:8 row_mask:0xf bank_mask:0x3
v_add_f32_dpp v53,v29,v29 row_ror:8 row_mask:0xf bank_mask:0x3
v_add_f32_dpp v52,v30,v30 row_ror:8 row_mask:0xf bank_mask:0xc
v_add_f32_dpp v53,v31,v31 row_ror:8 row_mask:0xf bank_mask:0xc
s_nop 0
v_add_f32_dpp v52,v52,v52 row_shl:4 row_mask:0xf bank_mask:0x5
v_add_f32_dpp v53,v53,v53 row_shl:4 row_mask:0xf bank_mask:0x5
s_cbranch_vccz L_cok_299
buffer_load_dwordx4 v[44:47],v0,s[8:11],s66 offen offset:0 sc1
buffer_load_dwordx4 v[48:51],v0,s[8:11],s66 offen offset:1024 sc1
s_sub_u32 s49,s49,1
s_cbranch_scc1 L_abort2
s_waitcnt vmcnt(3)
v_mfma_f32_16x16x32_bf16 v[28:31],v[18:21],v[32:35],0
s_waitcnt vmcnt(2)
v_mfma_f32_16x16x32_bf16 v[28:31],v[18:21],v[36:39],v[28:31]
s_nop 7
v_cmp_u_f32 vcc,v28,v28
v_add_f32_dpp v52,v28,v28 row_ror:8 row_mask:0xf bank_mask:0x3
v_add_f32_dpp v53,v29,v29 row_ror:8 row_mask:0xf bank_mask:0x3
v_add_f32_dpp v52,v30,v30 row_ror:8 row_mask:0xf bank_mask:0xc
v_add_f32_dpp v53,v31,v31 row_ror:8 row_mask:0xf bank_mask:0xc
s_nop 0
v_add_f32_dpp v52,v52,v52 row_shl:4 row_mask:0xf bank_mask:0x5
v_add_f32_dpp v53,v53,v53 row_shl:4 row_mask:0xf bank_mask:0x5
s_cbranch_vccz L_cok_299
s_branch L_crp_293
L_ckw_278:
s_cmp_eq_u32 s77,0
s_cbranch_scc1 L_cjw_280
s_andn2_b32 s31,0x7ff,s20
s_lshr_b32 s31,s31,5
s_cmp_gt_u32 s20,s30
s_cbranch_scc1 L_cjs_276
s_add_u32 s31,s51,2
s_lshl_b32 s59,s31,13
s_add_u32 s59,s59,10486016
v_lshrrev_b32 v45,2,v0
v_and_b32 v45,127,v45
L_ckk_300:
s_sleep 1
buffer_load_dword v44,v45,s[8:11],s59 offen sc1
s_sub_u32 s49,s49,1
s_cbranch_scc1 L_abort2
s_waitcnt vmcnt(0)
v_cmp_eq_u32 vcc,0,v44
s_cbranch_vccnz L_ckk_300
v_cmp_lt_u32 vcc,s30,v44
s_cbranch_vccz L_cjw_280
L_cjs_276:
ds_write_b32 v8,v2 offset:2560
s_waitcnt lgkmcnt(0)
s_branch L_ckb_279
L_cld_274:
v_mov_b32 v23,s56
s_add_u32 s56,s75,10495616
buffer_store_dword v23,off,s[8:11],s56 sc1
s_waitcnt vmcnt(0)
s_branch L_clb_275
L_cjw_280:
s_cmp_lg_u32 s19,0
s_cbranch_scc1 L_ckb_279
s_add_u32 s59,s18,s75
L_ww_301:
s_sleep 1
buffer_load_dword v23,off,s[8:11],s59 sc1
s_sub_u32 s49,s49,1
s_cbranch_scc1 L_abort2
s_waitcnt vmcnt(0)
v_readfirstlane_b32 s76,v23
s_cmp_eq_u32 s76,0
s_cbranch_scc1 L_ww_301
L_wwd_302:
s_branch L_ckb_279
L_cjump_281:
s_waitcnt vmcnt(0) lgkmcnt(0)
s_barrier
s_branch L_cst_277
L_cend_291:
v_smfmac_f32_16x16x64_bf16 v[116:119],v[36:39],v[184:191],v2
v_smfmac_f32_16x16x64_bf16 v[112:115],v[40:43],v[192:199],v2
v_smfmac_f32_16x16x64_bf16 v[116:119],v[40:43],v[200:207],v2
v_smfmac_f32_16x16x64_bf16 v[112:115],v[44:47],v[208:215],v2
v_smfmac_f32_16x16x64_bf16 v[116:119],v[44:47],v[216:223],v2
v_smfmac_f32_16x16x64_bf16 v[112:115],v[48:51],v[224:231],v2
v_smfmac_f32_16x16x64_bf16 v[116:119],v[48:51],v[232:239],v2
v_smfmac_f32_16x16x64_bf16 v[112:115],v[52:55],v[240:247],v2
v_smfmac_f32_16x16x64_bf16 v[116:119],v[52:55],v[248:255],v2
s_waitcnt lgkmcnt(0)
s_nop 2
v_pk_add_f32 v[112:113],v[112:113],v[114:115]
s_nop 2
v_pk_add_f32 v[116:117],v[116:117],v[118:119]
v_cvt_pk_bf16_f32 v126,v112,v113
v_cvt_pk_bf16_f32 v127,v116,v117
v_add_u32 v52,s50,v5
v_add_u32 v54,s50,v6
ds_read_b64_tr_b16 v[52:53],v52
ds_read_b64_tr_b16 v[54:55],v54
v_mov_b32_dpp v124,v126 quad_perm:[2,3,2,3] row_mask:0xf bank_mask:0xf
v_mov_b32_dpp v125,v127 quad_perm:[2,3,2,3] row_mask:0xf bank_mask:0xf
s_mov_b32 vcc_lo,0xcccccccc
s_mov_b32 vcc_hi,0xcccccccc
s_waitcnt lgkmcnt(0)
v_cndmask_b32 v124,v124,v52,vcc
v_cndmask_b32 v125,v125,v53,vcc
v_cndmask_b32 v126,v126,v54,vcc
v_cndmask_b32 v127,v127,v55,vcc
buffer_store_dwordx4 v[124:127],v0,s[8:11],s54 offen sc1
s_mov_b32 s51,64
s_waitcnt vmcnt(0)
s_barrier
s_nop 11
v_lshrrev_b32 v1,4,v0
s_endpgm
L_wa:
s_nop 11
v_and_b32 v238,15,v1
v_and_b32 v239,1,v1
v_lshlrev_b32 v239,4,v239
v_mov_b32 v240,0x3f80
v_lshlrev_b32 v240,v239,v240
v_lshrrev_b32 v238,1,v238
v_cmp_eq_u32 vcc,0,v238
s_nop 1
v_cndmask_b32 v156,0,v240,vcc
v_cmp_eq_u32 vcc,1,v238
s_nop 1
v_cndmask_b32 v157,0,v240,vcc
v_cmp_eq_u32 vcc,2,v238
s_nop 1
v_cndmask_b32 v158,0,v240,vcc
v_cmp_eq_u32 vcc,3,v238
s_nop 1
v_cndmask_b32 v159,0,v240,vcc
s_mov_b32 s4,s32
s_mov_b32 s5,s33
s_mov_b32 s6,1024
s_mov_b32 s7,0x20000
buffer_load_dwordx4 v[224:227],v0,s[4:7],0 offen
v_and_b32 v238,15,v1
v_lshrrev_b32 v239,4,v1
v_lshlrev_b32 v240,2,v239
v_mov_b32 v241,0xf149f2ca
s_and_b32 s56,s46,1
s_lshl_b32 s56,s56,4
v_add_u32 v242,s56,v238
v_add_u32 v243,0,v240
v_cmp_gt_u32 vcc,v243,v242
s_nop 1
v_cndmask_b32 v8,0,v241,vcc
v_add_u32 v243,1,v240
v_cmp_gt_u32 vcc,v243,v242
s_nop 1
v_cndmask_b32 v9,0,v241,vcc
v_add_u32 v243,2,v240
v_cmp_gt_u32 vcc,v243,v242
s_nop 1
v_cndmask_b32 v10,0,v241,vcc
v_add_u32 v243,3,v240
v_cmp_gt_u32 vcc,v243,v242
s_nop 1
v_cndmask_b32 v11,0,v241,vcc
v_add_u32 v243,16,v240
v_cmp_gt_u32 vcc,v243,v242
s_nop 1
v_cndmask_b32 v12,0,v241,vcc
v_add_u32 v243,17,v240
v_cmp_gt_u32 vcc,v243,v242
s_nop 1
v_cndmask_b32 v13,0,v241,vcc
v_add_u32 v243,18,v240
v_cmp_gt_u32 vcc,v243,v242
s_nop 1
v_cndmask_b32 v14,0,v241,vcc
v_add_u32 v243,19,v240
v_cmp_gt_u32 vcc,v243,v242
s_nop 1
v_cndmask_b32 v15,0,v241,vcc
v_mov_b32 v152,s80
v_mov_b32 v145,0
v_mov_b32 v146,0
s_lshl_b32 s56,s46,12
s_add_u32 s56,s56,131072
v_add_u32 v3,s56,v0
v_add_u32 v4,131072,v0
s_lshl_b32 s56,s46,8
v_lshlrev_b32 v7,4,v238
v_add_u32 v7,s56,v7
v_lshl_add_u32 v5,v239,16,v7
v_lshlrev_b32 v6,1,v7
v_lshl_add_u32 v7,v239,10,v7
v_and_b32 v243,1,v239
v_lshl_add_u32 v6,v243,4,v6
v_lshrrev_b32 v243,1,v239
v_lshl_add_u32 v6,v243,12,v6
v_add_u32 v6,147456,v6
v_lshlrev_b32 v16,2,v1
v_lshlrev_b32 v21,3,v238
s_and_b32 s68,s47,15
s_lshl_b32 s56,s68,10
v_add_u32 v5,s56,v5
s_lshl_b32 s56,s68,15
v_add_u32 v7,s56,v7
s_lshl_b32 s69,s54,20
s_add_u32 s69,s69,20971520
s_lshl_b32 s87,s54,13
s_add_u32 s87,s87,10486272
s_lshl4_add_u32 s74,s68,s87
s_lshl2_add_u32 s74,s46,s74
s_lshl_b32 s68,s68,1
s_lshr_b32 s56,s46,1
s_add_u32 s68,s68,s56
s_mov_b32 s66,0
s_mov_b32 s67,0
s_mov_b32 s73,0x80000000
s_mov_b32 s75,0
s_mov_b32 s37,0
s_mov_b32 s42,4294966272
s_mov_b32 s43,4294967295
s_mov_b64 s[38:39],0
s_sub_u32 s36,s54,12
s_and_b32 s36,s36,3
s_mov_b32 s12,s40
s_mov_b32 s13,s41
s_mov_b32 s14,2097152
s_mov_b32 s15,0x20000
v_add_u32 v21,10487168,v21
v_mov_b32 v244,v21
s_and_b32 s56,s50,2048
s_add_u32 s56,s56,147456
v_lshlrev_b32 v23,5,v1
v_add_u32 v23,s56,v23
v_and_b32 v253,32,v0
v_lshrrev_b32 v245,2,v253
v_add_u32 v253,v253,v245
v_sub_u32 v253,v0,v253
v_add_u32 v253,8,v253
v_mov_b32 v254,0x80000000
s_mov_b32 s56,1408
v_writelane_b32 v254,s56,0
s_mov_b32 s56,256
v_writelane_b32 v254,s56,1
s_mov_b32 s56,1280
v_writelane_b32 v254,s56,2
v_mov_b32 v245,155648
s_lshl_b32 s56,s46,2
v_add_u32 v247,s56,v245
s_waitcnt vmcnt(0)
v_lshlrev_b32 v228,16,v224
v_and_b32 v229,0xffff0000,v224
v_lshlrev_b32 v230,16,v225
v_and_b32 v231,0xffff0000,v225
v_lshlrev_b32 v232,16,v226
v_and_b32 v233,0xffff0000,v226
v_lshlrev_b32 v234,16,v227
v_and_b32 v235,0xffff0000,v227
v_mul_f32 v255,v228,v228
v_fma_f32 v255,v229,v229,v255
v_fma_f32 v255,v230,v230,v255
v_fma_f32 v255,v231,v231,v255
v_fma_f32 v255,v232,v232,v255
v_fma_f32 v255,v233,v233,v255
v_fma_f32 v255,v234,v234,v255
v_fma_f32 v255,v235,v235,v255
s_nop 1
v_add_f32_dpp v255,v255,v255 row_ror:8 row_mask:0xf bank_mask:0xf
s_nop 1
v_add_f32_dpp v255,v255,v255 row_ror:4 row_mask:0xf bank_mask:0xf
s_nop 1
v_add_f32_dpp v255,v255,v255 row_ror:2 row_mask:0xf bank_mask:0xf
s_nop 1
v_add_f32_dpp v255,v255,v255 row_ror:1 row_mask:0xf bank_mask:0xf
v_mov_b32 v238,v255
s_nop 1
v_permlane16_swap_b32 v255,v238
v_add_f32 v255,v255,v238
v_mov_b32 v238,v255
s_nop 1
v_permlane32_swap_b32 v255,v238
v_add_f32 v255,v255,v238
v_sqrt_f32 v255,v255
v_sub_u32 v238,68,v1
v_cvt_f32_u32 v238,v238
v_log_f32 v238,v238
v_mov_b32 v239,0x3ff9999a
v_fmac_f32 v239,0x3e632166,v238
v_mul_f32 v255,v255,v239
v_or_b32 v255,0x80000000,v255
s_cmp_lt_u32 s54,2
s_cbranch_scc1 L_aa_303
s_sub_u32 s77,s54,2
s_mov_b32 s30,0
s_mov_b32 s86,1536
s_lshl_b32 s56,s77,5
s_add_u32 s56,s56,s68
s_mul_i32 s70,s56,24576
s_lshl_b32 s71,s56,12
s_lshl_b32 s59,s77,13
s_lshl2_add_u32 s59,s68,s59
s_add_u32 s59,s59,10485760
s_buffer_load_dword s32,s[8:11],s59
s_mov_b32 s33,1
s_add_u32 s70,s70,100663296
s_add_u32 s71,s71,41943040
v_mov_b32 v19,s59
s_branch L_aa_311
L_aa_317:
s_bitcmp1_b32 s46,0
s_cbranch_scc1 L_av_318
ds_read_b128 v[24:27],v4 offset:0
ds_read_b128 v[28:31],v4 offset:1024
s_min_u32 s56,s32,s33
s_cmp_lt_u32 s77,64
s_cselect_b32 s56,s56,0
s_cmp_eq_u32 s56,0
s_cselect_b32 s72,0x80000000,0
v_mov_b32 v248,s72
s_or_b32 s64,s70,s72
s_or_b32 s65,s71,s72
s_cmp_lt_u32 s30,s31
s_cselect_b32 s65,0x80000000,s65
s_and_b32 s57,s46,1
s_mul_i32 s58,s57,12288
s_add_u32 s64,s64,s58
s_lshl_b32 s57,s57,11
s_waitcnt lgkmcnt(1)
v_mfma_f32_16x16x32_bf16 v[160:163],v[24:27],a[0:3],0
ds_read_b128 v[32:35],v4 offset:2048
s_add_u32 s65,s65,s57
s_and_b32 s59,s50,2048
v_mfma_f32_16x16x32_bf16 v[164:167],v[24:27],a[4:7],0
ds_read_b128 v[36:39],v4 offset:3072
s_lshl_b32 s59,s59,4
s_xor_b32 s60,s67,65536
v_mfma_f32_16x16x32_bf16 v[168:171],v[24:27],a[8:11],0
ds_read_b128 v[40:43],v4 offset:8192
s_add_u32 s59,s59,s60
s_add_u32 s58,s58,s59
v_mfma_f32_16x16x32_bf16 v[172:175],v[24:27],a[12:15],0
ds_read_b128 v[44:47],v4 offset:9216
s_add_u32 s57,s57,s59
s_add_u32 m0,s58,0
v_mfma_f32_16x16x32_bf16 v[176:179],v[24:27],a[16:19],0
buffer_load_dwordx4 v0,s[8:11],s64 offen offset:0 sc1 lds
v_lshlrev_b32 v88,16,v224
v_and_b32 v89,0xffff0000,v224
v_mfma_f32_16x16x32_bf16 v[180:183],v[24:27],a[20:23],0
ds_read_b128 v[48:51],v4 offset:10240
v_lshlrev_b32 v90,16,v225
v_and_b32 v91,0xffff0000,v225
v_mfma_f32_16x16x32_bf16 v[184:187],v[24:27],a[24:27],0
ds_read_b128 v[52:55],v4 offset:11264
s_waitcnt vmcnt(8)
v_mfma_f32_16x16x32_bf16 v[128:131],v[156:159],v[192:195],0
ds_write_b32 v247,v248
v_lshlrev_b32 v92,16,v226
v_and_b32 v93,0xffff0000,v226
v_mfma_f32_16x16x32_bf16 v[188:191],v[24:27],a[28:31],0
ds_read_b128 v[56:59],v4 offset:4096
s_waitcnt vmcnt(7)
v_mfma_f32_16x16x32_bf16 v[128:131],v[156:159],v[196:199],v[128:131]
ds_read_b128 v[60:63],v4 offset:5120
v_lshlrev_b32 v94,16,v227
v_and_b32 v95,0xffff0000,v227
s_waitcnt lgkmcnt(9)
v_mfma_f32_16x16x32_bf16 v[160:163],v[28:31],a[32:35],v[160:163]
buffer_load_dwordx4 v0,s[8:11],s64 offen offset:1024 sc1 lds
s_waitcnt vmcnt(7)
v_mfma_f32_16x16x32_bf16 v[128:131],v[156:159],v[200:203],v[128:131]
ds_read_b128 v[64:67],v4 offset:6144
v_readfirstlane_b32 s22,v246
s_cmp_eq_u32 s22,0
s_cbranch_scc1 L_ag_319
L_agb_320:
v_mfma_f32_16x16x32_bf16 v[164:167],v[28:31],a[36:39],v[164:167]
ds_read_b128 v[68:71],v4 offset:7168
s_waitcnt vmcnt(6)
v_mfma_f32_16x16x32_bf16 v[128:131],v[156:159],v[204:207],v[128:131]
ds_read_b128 v[72:75],v4 offset:12288
s_lshl_b32 s18,s26,5
s_add_u32 s18,s18,s68
v_mfma_f32_16x16x32_bf16 v[168:171],v[28:31],a[40:43],v[168:171]
ds_read_b128 v[76:79],v4 offset:13312
s_waitcnt vmcnt(5)
v_mfma_f32_16x16x32_bf16 v[132:135],v[156:159],v[208:211],0
ds_read_b128 v[80:83],v4 offset:14336
s_lshl_b32 s19,s18,10
s_add_u32 s20,s19,6291456
v_mfma_f32_16x16x32_bf16 v[172:175],v[28:31],a[44:47],v[172:175]
ds_read_b128 v[84:87],v4 offset:15360
s_waitcnt vmcnt(4)
v_mfma_f32_16x16x32_bf16 v[132:135],v[156:159],v[212:215],v[132:135]
s_lshl_b32 s23,s51,5
s_add_u32 s23,s23,s68
s_lshl_b32 s24,s23,10
v_mfma_f32_16x16x32_bf16 v[176:179],v[28:31],a[48:51],v[176:179]
buffer_load_dwordx4 v0,s[8:11],s64 offen offset:2048 sc1 lds
s_waitcnt vmcnt(4)
v_mfma_f32_16x16x32_bf16 v[132:135],v[156:159],v[216:219],v[132:135]
s_lshl_b32 s25,s51,10
s_add_u32 s25,s25,2883584
s_cmp_eq_u32 s23,s55
s_cselect_b32 s25,s25,s24
v_mfma_f32_16x16x32_bf16 v[180:183],v[28:31],a[52:55],v[180:183]
ds_write_b128 v6,v[128:131]
s_waitcnt vmcnt(3)
v_mfma_f32_16x16x32_bf16 v[132:135],v[156:159],v[220:223],v[132:135]
s_add_u32 s25,s25,8388608
s_mov_b32 s6,268435456
s_cmp_eq_u32 s31,0
s_cselect_b32 s25,s24,s25
s_cselect_b64 s[4:5],s[16:17],s[44:45]
s_cmov_b32 s6,2097152
v_mfma_f32_16x16x32_bf16 v[184:187],v[28:31],a[56:59],v[184:187]
buffer_load_dwordx4 v[224:227],v0,s[4:7],s25 offen sc1
s_lshr_b32 s24,s55,5
s_cmp_lt_u32 s51,s24
s_cselect_b32 s24,1,2
v_mfma_f32_16x16x32_bf16 v[188:191],v[28:31],a[60:63],v[188:191]
v_mov_b32 v252,s24
s_lshl2_add_u32 s25,s51,11018240
s_waitcnt lgkmcnt(15)
v_mfma_f32_16x16x32_bf16 v[160:163],v[32:35],a[64:67],v[160:163]
ds_write_b128 v6,v[132:135] offset:2048
s_lshl_b32 s24,s68,16
s_add_u32 s24,s24,s31
v_mfma_f32_16x16x32_bf16 v[164:167],v[32:35],a[68:71],v[164:167]
buffer_load_dwordx4 v0,s[8:11],s64 offen offset:3072 sc1 lds
s_add_u32 s24,s24,s86
s_cmp_eq_u32 s24,1537
s_cselect_b32 s25,s25,0x80000000
v_mfma_f32_16x16x32_bf16 v[168:171],v[32:35],a[72:75],v[168:171]
buffer_store_dword v252,off,s[8:11],s25 sc1
s_bitcmp1_b64 s[38:39],s51
s_cselect_b32 s24,128,0
v_mfma_f32_16x16x32_bf16 v[172:175],v[32:35],a[76:79],v[172:175]
s_lshl_b32 s23,s51,13
s_lshl2_add_u32 s23,s68,s23
s_add_u32 s23,s23,10487168
v_mfma_f32_16x16x32_bf16 v[176:179],v[32:35],a[80:83],v[176:179]
s_waitcnt lgkmcnt(0)
s_barrier
s_add_u32 s23,s23,s24
v_mfma_f32_16x16x32_bf16 v[180:183],v[32:35],a[84:87],v[180:183]
ds_read_b128 v[96:99],v23
s_add_u32 m0,s58,4096
s_add_u32 s64,s64,4096
v_mfma_f32_16x16x32_bf16 v[184:187],v[32:35],a[88:91],v[184:187]
ds_read_b128 v[100:103],v23 offset:16
v_mfma_f32_16x16x32_bf16 v[188:191],v[32:35],a[92:95],v[188:191]
buffer_load_dwordx4 v0,s[8:11],s64 offen offset:0 sc1 lds
v_mfma_f32_16x16x32_bf16 v[160:163],v[36:39],a[96:99],v[160:163]
ds_read_b128 v[248:251],v245
v_mfma_f32_16x16x32_bf16 v[164:167],v[36:39],a[100:103],v[164:167]
buffer_load_dword v246,off,s[8:11],s23 sc1
v_lshrrev_b32 v244,4,v1
s_sub_u32 s23,s77,8
v_add_u32 v244,s23,v244
v_mfma_f32_16x16x32_bf16 v[168:171],v[36:39],a[104:107],v[168:171]
buffer_store_dword v20,off,s[8:11],s73 sc1
v_max_i32 v244,0,v244
v_lshl_add_u32 v244,v244,13,v21
s_mov_b32 s73,0x80000000
v_mfma_f32_16x16x32_bf16 v[172:175],v[36:39],a[108:111],v[172:175]
buffer_load_dwordx4 v0,s[8:11],s64 offen offset:1024 sc1 lds
v_mfma_f32_16x16x32_bf16 v[176:179],v[36:39],a[112:115],v[176:179]
buffer_load_dwordx2 v[242:243],v244,s[8:11],0 offen sc1
v_mfma_f32_16x16x32_bf16 v[180:183],v[36:39],a[116:119],v[180:183]
v_mfma_f32_16x16x32_bf16 v[184:187],v[36:39],a[120:123],v[184:187]
s_waitcnt lgkmcnt(0)
v_or3_b32 v248,v248,v249,v250
v_or_b32 v248,v248,v251
v_mfma_f32_16x16x32_bf16 v[188:191],v[36:39],a[124:127],v[188:191]
buffer_load_dwordx4 v0,s[8:11],s64 offen offset:2048 sc1 lds
v_readfirstlane_b32 s72,v248
s_waitcnt lgkmcnt(1)
v_cvt_pk_bf16_f32 v104,v96,v97
v_mfma_f32_16x16x32_bf16 v[160:163],v[40:43],a[128:131],v[160:163]
v_cvt_pk_bf16_f32 v105,v98,v99
v_cvt_pk_bf16_f32 v106,v100,v101
v_cvt_pk_bf16_f32 v107,v102,v103
v_mfma_f32_16x16x32_bf16 v[164:167],v[40:43],a[132:135],v[164:167]
v_lshlrev_b32 v96,16,v104
v_and_b32 v97,0xffff0000,v104
v_lshlrev_b32 v98,16,v105
v_mfma_f32_16x16x32_bf16 v[168:171],v[40:43],a[136:139],v[168:171]
v_and_b32 v99,0xffff0000,v105
v_lshlrev_b32 v100,16,v106
v_and_b32 v101,0xffff0000,v106
v_mfma_f32_16x16x32_bf16 v[172:175],v[40:43],a[140:143],v[172:175]
buffer_load_dwordx4 v0,s[8:11],s64 offen offset:3072 sc1 lds
v_lshlrev_b32 v102,16,v107
v_and_b32 v103,0xffff0000,v107
v_add_f32 v88,v88,v96
v_mfma_f32_16x16x32_bf16 v[176:179],v[40:43],a[144:147],v[176:179]
v_add_f32 v89,v89,v97
v_add_f32 v90,v90,v98
v_add_f32 v91,v91,v99
v_mfma_f32_16x16x32_bf16 v[180:183],v[40:43],a[148:151],v[180:183]
v_add_f32 v92,v92,v100
v_add_f32 v93,v93,v101
v_add_f32 v94,v94,v102
v_mfma_f32_16x16x32_bf16 v[184:187],v[40:43],a[152:155],v[184:187]
v_add_f32 v95,v95,v103
v_cvt_pk_bf16_f32 v104,v88,v89
v_cvt_pk_bf16_f32 v105,v90,v91
v_mfma_f32_16x16x32_bf16 v[188:191],v[40:43],a[156:159],v[188:191]
s_add_u32 m0,s58,8192
s_add_u32 s64,s64,4096
v_cvt_pk_bf16_f32 v106,v92,v93
v_cvt_pk_bf16_f32 v107,v94,v95
v_mfma_f32_16x16x32_bf16 v[160:163],v[44:47],a[160:163],v[160:163]
buffer_load_dwordx4 v0,s[8:11],s64 offen offset:0 sc1 lds
v_mfma_f32_16x16x32_bf16 v[164:167],v[44:47],a[164:167],v[164:167]
buffer_store_dwordx4 v[104:107],v0,s[8:11],s20 offen sc1
v_lshlrev_b32 v88,16,v104
v_and_b32 v89,0xffff0000,v104
v_lshlrev_b32 v90,16,v105
v_mfma_f32_16x16x32_bf16 v[168:171],v[44:47],a[168:171],v[168:171]
v_and_b32 v91,0xffff0000,v105
v_lshlrev_b32 v92,16,v106
v_and_b32 v93,0xffff0000,v106
v_mfma_f32_16x16x32_bf16 v[172:175],v[44:47],a[172:175],v[172:175]
v_lshlrev_b32 v94,16,v107
v_and_b32 v95,0xffff0000,v107
v_readfirstlane_b32 s78,v88
v_mfma_f32_16x16x32_bf16 v[176:179],v[44:47],a[176:179],v[176:179]
buffer_load_dwordx4 v0,s[8:11],s64 offen offset:1024 sc1 lds
v_add_f32 v120,v88,-s78
v_add_f32 v121,v89,-s78
v_add_f32 v122,v90,-s78
v_mfma_f32_16x16x32_bf16 v[180:183],v[44:47],a[180:183],v[180:183]
v_add_f32 v123,v91,-s78
v_add_f32 v124,v92,-s78
v_add_f32 v125,v93,-s78
v_mfma_f32_16x16x32_bf16 v[184:187],v[44:47],a[184:187],v[184:187]
v_add_f32 v126,v94,-s78
v_add_f32 v127,v95,-s78
v_add_f32 v128,v120,v122
v_mfma_f32_16x16x32_bf16 v[188:191],v[44:47],a[188:191],v[188:191]
v_add_f32 v129,v121,v123
v_mul_f32 v130,v120,v120
v_mul_f32 v131,v121,v121
v_mfma_f32_16x16x32_bf16 v[160:163],v[48:51],a[192:195],v[160:163]
buffer_load_dwordx4 v0,s[8:11],s64 offen offset:2048 sc1 lds
v_add_f32 v132,v124,v126
v_add_f32 v133,v125,v127
v_fma_f32 v130,v122,v122,v130
v_mfma_f32_16x16x32_bf16 v[164:167],v[48:51],a[196:199],v[164:167]
v_fma_f32 v131,v123,v123,v131
v_add_f32 v128,v128,v132
v_add_f32 v129,v129,v133
v_mfma_f32_16x16x32_bf16 v[168:171],v[48:51],a[200:203],v[168:171]
v_fma_f32 v130,v124,v124,v130
v_fma_f32 v131,v125,v125,v131
v_add_f32 v128,v128,v129
v_mfma_f32_16x16x32_bf16 v[172:175],v[48:51],a[204:207],v[172:175]
v_fma_f32 v130,v126,v126,v130
v_fma_f32 v131,v127,v127,v131
v_add_f32 v130,v130,v131
v_mfma_f32_16x16x32_bf16 v[176:179],v[48:51],a[208:211],v[176:179]
buffer_load_dwordx4 v0,s[8:11],s64 offen offset:3072 sc1 lds
v_permlane32_swap_b32 v128,v130
v_add_f32 v128,v128,v130
v_mfma_f32_16x16x32_bf16 v[180:183],v[48:51],a[212:215],v[180:183]
s_nop 0
v_add_f32_dpp v128,v128,v128 row_ror:8 row_mask:0xf bank_mask:0xf
v_mfma_f32_16x16x32_bf16 v[184:187],v[48:51],a[216:219],v[184:187]
s_nop 0
v_add_f32_dpp v128,v128,v128 row_ror:4 row_mask:0xf bank_mask:0xf
v_mfma_f32_16x16x32_bf16 v[188:191],v[48:51],a[220:223],v[188:191]
s_nop 0
v_add_f32_dpp v128,v128,v128 row_ror:2 row_mask:0xf bank_mask:0xf
v_mfma_f32_16x16x32_bf16 v[160:163],v[52:55],a[224:227],v[160:163]
s_add_u32 m0,s57,24576
v_add_f32_dpp v128,v128,v128 row_ror:1 row_mask:0xf bank_mask:0xf
v_mov_b32 v130,v128
v_mfma_f32_16x16x32_bf16 v[164:167],v[52:55],a[228:231],v[164:167]
buffer_load_dwordx4 v0,s[8:11],s65 offen offset:0 sc1 lds
v_permlane16_swap_b32 v128,v130
v_add_f32 v128,v128,v130
v_mul_f32 v128,0x3b000000,v128
v_mfma_f32_16x16x32_bf16 v[168:171],v[52:55],a[232:235],v[168:171]
v_mov_b32 v130,v128
v_mfma_f32_16x16x32_bf16 v[172:175],v[52:55],a[236:239],v[172:175]
s_nop 0
v_permlane32_swap_b32 v128,v130
v_fma_f32 v130,-v128,v128,v130
v_add_f32 v128,s78,v128
v_mfma_f32_16x16x32_bf16 v[176:179],v[52:55],a[240:243],v[176:179]
v_max_f32 v130,0,v130
v_cvt_pk_bf16_f32 v130,v128,v130
v_lshlrev_b32 v128,16,v130
v_mfma_f32_16x16x32_bf16 v[180:183],v[52:55],a[244:247],v[180:183]
buffer_load_dwordx4 v0,s[8:11],s65 offen offset:1024 sc1 lds
v_and_b32 v130,0xffff0000,v130
v_add_f32 v130,0x3727c5ac,v130
v_cvt_pk_bf16_f32 v130,v130,v130
v_mfma_f32_16x16x32_bf16 v[184:187],v[52:55],a[248:251],v[184:187]
v_and_b32 v130,0xffff0000,v130
v_sqrt_f32 v130,v130
v_add_f32 v120,v88,-v128
v_mfma_f32_16x16x32_bf16 v[188:191],v[52:55],a[252:255],v[188:191]
v_add_f32 v121,v89,-v128
v_add_f32 v122,v90,-v128
v_add_f32 v123,v91,-v128
v_mfma_f32_16x16x32_bf16 v[192:195],v[56:59],a[0:3],0
v_add_f32 v124,v92,-v128
v_add_f32 v125,v93,-v128
v_add_f32 v126,v94,-v128
v_mfma_f32_16x16x32_bf16 v[196:199],v[56:59],a[4:7],0
v_add_f32 v127,v95,-v128
v_cvt_pk_bf16_f32 v130,v130,v130
v_mfma_f32_16x16x32_bf16 v[200:203],v[56:59],a[8:11],0
v_and_b32 v130,0xffff0000,v130
v_rcp_f32 v130,v130
v_mfma_f32_16x16x32_bf16 v[204:207],v[56:59],a[12:15],0
v_cvt_pk_bf16_f32 v108,v120,v121
v_cvt_pk_bf16_f32 v109,v122,v123
v_mfma_f32_16x16x32_bf16 v[208:211],v[56:59],a[16:19],0
v_cvt_pk_bf16_f32 v110,v124,v125
v_cvt_pk_bf16_f32 v111,v126,v127
v_mfma_f32_16x16x32_bf16 v[212:215],v[56:59],a[20:23],0
v_lshlrev_b32 v120,16,v108
v_and_b32 v121,0xffff0000,v108
v_mfma_f32_16x16x32_bf16 v[216:219],v[56:59],a[24:27],0
v_lshlrev_b32 v122,16,v109
v_and_b32 v123,0xffff0000,v109
v_mfma_f32_16x16x32_bf16 v[220:223],v[56:59],a[28:31],0
v_lshlrev_b32 v124,16,v110
v_and_b32 v125,0xffff0000,v110
v_mfma_f32_16x16x32_bf16 v[192:195],v[60:63],a[32:35],v[192:195]
v_lshlrev_b32 v126,16,v111
v_and_b32 v127,0xffff0000,v111
v_mfma_f32_16x16x32_bf16 v[196:199],v[60:63],a[36:39],v[196:199]
v_mul_f32 v120,v120,v130
v_mul_f32 v121,v121,v130
v_mfma_f32_16x16x32_bf16 v[200:203],v[60:63],a[40:43],v[200:203]
v_mul_f32 v122,v122,v130
v_mul_f32 v123,v123,v130
v_mfma_f32_16x16x32_bf16 v[204:207],v[60:63],a[44:47],v[204:207]
v_mul_f32 v124,v124,v130
v_mul_f32 v125,v125,v130
v_mfma_f32_16x16x32_bf16 v[208:211],v[60:63],a[48:51],v[208:211]
v_mul_f32 v126,v126,v130
v_mul_f32 v127,v127,v130
v_mfma_f32_16x16x32_bf16 v[212:215],v[60:63],a[52:55],v[212:215]
v_cvt_pk_bf16_f32 v108,v120,v121
v_cvt_pk_bf16_f32 v109,v122,v123
v_mfma_f32_16x16x32_bf16 v[216:219],v[60:63],a[56:59],v[216:219]
v_cvt_pk_bf16_f32 v110,v124,v125
v_cvt_pk_bf16_f32 v111,v126,v127
v_mfma_f32_16x16x32_bf16 v[220:223],v[60:63],a[60:63],v[220:223]
v_lshlrev_b32 v112,16,v108
v_and_b32 v113,0xffff0000,v108
v_mfma_f32_16x16x32_bf16 v[192:195],v[64:67],a[64:67],v[192:195]
v_lshlrev_b32 v114,16,v109
v_and_b32 v115,0xffff0000,v109
v_mfma_f32_16x16x32_bf16 v[196:199],v[64:67],a[68:71],v[196:199]
v_lshlrev_b32 v116,16,v110
v_and_b32 v117,0xffff0000,v110
v_mfma_f32_16x16x32_bf16 v[200:203],v[64:67],a[72:75],v[200:203]
v_lshlrev_b32 v118,16,v111
v_and_b32 v119,0xffff0000,v111
v_mfma_f32_16x16x32_bf16 v[204:207],v[64:67],a[76:79],v[204:207]
v_add_f32 v88,v88,v112
v_add_f32 v89,v89,v113
v_mfma_f32_16x16x32_bf16 v[208:211],v[64:67],a[80:83],v[208:211]
v_cvt_pk_bf16_f32 v24,v160,v164
v_cvt_pk_bf16_f32 v25,v168,v172
v_mfma_f32_16x16x32_bf16 v[212:215],v[64:67],a[84:87],v[212:215]
v_cvt_pk_bf16_f32 v26,v176,v180
v_cvt_pk_bf16_f32 v27,v184,v188
v_mfma_f32_16x16x32_bf16 v[216:219],v[64:67],a[88:91],v[216:219]
v_cvt_pk_bf16_f32 v28,v161,v165
v_cvt_pk_bf16_f32 v29,v169,v173
v_mfma_f32_16x16x32_bf16 v[220:223],v[64:67],a[92:95],v[220:223]
v_cvt_pk_bf16_f32 v30,v177,v181
v_cvt_pk_bf16_f32 v31,v185,v189
v_mfma_f32_16x16x32_bf16 v[192:195],v[68:71],a[96:99],v[192:195]
v_cvt_pk_bf16_f32 v32,v162,v166
v_cvt_pk_bf16_f32 v33,v170,v174
v_mfma_f32_16x16x32_bf16 v[196:199],v[68:71],a[100:103],v[196:199]
v_cvt_pk_bf16_f32 v34,v178,v182
v_cvt_pk_bf16_f32 v35,v186,v190
v_mfma_f32_16x16x32_bf16 v[200:203],v[68:71],a[104:107],v[200:203]
v_cvt_pk_bf16_f32 v36,v163,v167
v_cvt_pk_bf16_f32 v37,v171,v175
v_mfma_f32_16x16x32_bf16 v[204:207],v[68:71],a[108:111],v[204:207]
v_cvt_pk_bf16_f32 v38,v179,v183
v_cvt_pk_bf16_f32 v39,v187,v191
v_mfma_f32_16x16x32_bf16 v[208:211],v[68:71],a[112:115],v[208:211]
s_add_u32 s62,s69,0
v_add_f32 v90,v90,v114
v_add_f32 v91,v91,v115
v_mfma_f32_16x16x32_bf16 v[212:215],v[68:71],a[116:119],v[212:215]
buffer_store_dwordx4 v[24:27],v5,s[8:11],s62 offen sc1
v_add_f32 v92,v92,v116
v_add_f32 v93,v93,v117
v_mfma_f32_16x16x32_bf16 v[216:219],v[68:71],a[120:123],v[216:219]
v_add_f32 v94,v94,v118
v_add_f32 v95,v95,v119
v_mfma_f32_16x16x32_bf16 v[220:223],v[68:71],a[124:127],v[220:223]
v_cvt_pk_bf16_f32 v96,v88,v89
v_cvt_pk_bf16_f32 v97,v90,v91
v_mfma_f32_16x16x32_bf16 v[192:195],v[72:75],a[128:131],v[192:195]
s_add_u32 s62,s69,16384
v_cvt_pk_bf16_f32 v98,v92,v93
v_cvt_pk_bf16_f32 v99,v94,v95
v_mfma_f32_16x16x32_bf16 v[196:199],v[72:75],a[132:135],v[196:199]
buffer_store_dwordx4 v[28:31],v5,s[8:11],s62 offen sc1
v_mfma_f32_16x16x32_bf16 v[200:203],v[72:75],a[136:139],v[200:203]
buffer_store_dwordx4 v[96:99],v0,s[12:15],s19 offen sc1
v_mul_f32 v236,v112,v228
v_mul_f32 v237,v113,v229
v_fma_f32 v236,v114,v230,v236
v_mfma_f32_16x16x32_bf16 v[204:207],v[72:75],a[140:143],v[204:207]
v_fma_f32 v237,v115,v231,v237
v_fma_f32 v236,v116,v232,v236
v_fma_f32 v237,v117,v233,v237
v_mfma_f32_16x16x32_bf16 v[208:211],v[72:75],a[144:147],v[208:211]
s_add_u32 s62,s69,32768
v_fma_f32 v236,v118,v234,v236
v_fma_f32 v237,v119,v235,v237
v_mfma_f32_16x16x32_bf16 v[212:215],v[72:75],a[148:151],v[212:215]
buffer_store_dwordx4 v[32:35],v5,s[8:11],s62 offen sc1
v_add_f32 v236,v236,v237
v_mfma_f32_16x16x32_bf16 v[216:219],v[72:75],a[152:155],v[216:219]
s_nop 0
v_add_f32_dpp v236,v236,v236 row_ror:8 row_mask:0xf bank_mask:0xf
v_mfma_f32_16x16x32_bf16 v[220:223],v[72:75],a[156:159],v[220:223]
s_nop 0
v_add_f32_dpp v236,v236,v236 row_ror:4 row_mask:0xf bank_mask:0xf
v_mfma_f32_16x16x32_bf16 v[192:195],v[76:79],a[160:163],v[192:195]
s_add_u32 s62,s69,49152
v_add_f32_dpp v236,v236,v236 row_ror:2 row_mask:0xf bank_mask:0xf
v_mfma_f32_16x16x32_bf16 v[196:199],v[76:79],a[164:167],v[196:199]
buffer_store_dwordx4 v[36:39],v5,s[8:11],s62 offen sc1
v_add_f32_dpp v236,v236,v236 row_ror:1 row_mask:0xf bank_mask:0xf
v_mov_b32 v237,v236
v_mfma_f32_16x16x32_bf16 v[200:203],v[76:79],a[168:171],v[200:203]
s_nop 0
v_permlane16_swap_b32 v236,v237
v_add_f32 v236,v236,v237
v_mov_b32 v237,v236
v_mfma_f32_16x16x32_bf16 v[204:207],v[76:79],a[172:175],v[204:207]
s_nop 0
v_permlane32_swap_b32 v236,v237
v_add_f32 v236,v236,v237
v_cvt_pk_bf16_f32 v236,v236,v236
v_mfma_f32_16x16x32_bf16 v[208:211],v[76:79],a[176:179],v[208:211]
v_and_b32 v236,0xffff0000,v236
v_ashrrev_i32 v237,31,v236
v_or_b32 v237,0x80000000,v237
v_mfma_f32_16x16x32_bf16 v[212:215],v[76:79],a[180:183],v[212:215]
v_xor_b32 v236,v236,v237
v_and_b32 v236,0xffff0000,v236
s_sub_u32 s20,4095,s18
v_mfma_f32_16x16x32_bf16 v[216:219],v[76:79],a[184:187],v[216:219]
v_or_b32 v20,s20,v236
s_lshl_b32 s73,s26,13
s_lshl2_add_u32 s73,s68,s73
v_mfma_f32_16x16x32_bf16 v[220:223],v[76:79],a[188:191],v[220:223]
s_add_u32 s73,s73,10485760
s_add_u32 s73,s73,s86
v_mfma_f32_16x16x32_bf16 v[192:195],v[80:83],a[192:195],v[192:195]
v_mfma_f32_16x16x32_bf16 v[196:199],v[80:83],a[196:199],v[196:199]
v_mfma_f32_16x16x32_bf16 v[192:195],v[84:87],a[224:227],v[192:195]
v_mfma_f32_16x16x32_bf16 v[196:199],v[84:87],a[228:231],v[196:199]
v_mfma_f32_16x16x32_bf16 v[200:203],v[80:83],a[200:203],v[200:203]
v_mfma_f32_16x16x32_bf16 v[204:207],v[80:83],a[204:207],v[204:207]
v_mfma_f32_16x16x32_bf16 v[200:203],v[84:87],a[232:235],v[200:203]
v_mfma_f32_16x16x32_bf16 v[204:207],v[84:87],a[236:239],v[204:207]
v_cvt_pk_bf16_f32 v40,v192,v196
v_cvt_pk_bf16_f32 v44,v193,v197
v_cvt_pk_bf16_f32 v48,v194,v198
v_mfma_f32_16x16x32_bf16 v[208:211],v[80:83],a[208:211],v[208:211]
v_cvt_pk_bf16_f32 v52,v195,v199
v_mfma_f32_16x16x32_bf16 v[212:215],v[80:83],a[212:215],v[212:215]
v_cvt_pk_bf16_f32 v41,v200,v204
v_cvt_pk_bf16_f32 v45,v201,v205
v_cvt_pk_bf16_f32 v49,v202,v206
v_mfma_f32_16x16x32_bf16 v[208:211],v[84:87],a[240:243],v[208:211]
v_cvt_pk_bf16_f32 v53,v203,v207
v_mfma_f32_16x16x32_bf16 v[212:215],v[84:87],a[244:247],v[212:215]
v_mfma_f32_16x16x32_bf16 v[216:219],v[80:83],a[216:219],v[216:219]
v_mfma_f32_16x16x32_bf16 v[220:223],v[80:83],a[220:223],v[220:223]
v_mfma_f32_16x16x32_bf16 v[216:219],v[84:87],a[248:251],v[216:219]
v_mfma_f32_16x16x32_bf16 v[220:223],v[84:87],a[252:255],v[220:223]
v_cvt_pk_bf16_f32 v42,v208,v212
v_cvt_pk_bf16_f32 v46,v209,v213
v_cvt_pk_bf16_f32 v50,v210,v214
v_cvt_pk_bf16_f32 v54,v211,v215
s_nop 3
v_cvt_pk_bf16_f32 v43,v216,v220
s_add_u32 s62,s69,262144
buffer_store_dwordx4 v[40:43],v5,s[8:11],s62 offen sc1
v_cvt_pk_bf16_f32 v47,v217,v221
s_add_u32 s62,s69,278528
buffer_store_dwordx4 v[44:47],v5,s[8:11],s62 offen sc1
v_cvt_pk_bf16_f32 v51,v218,v222
s_add_u32 s62,s69,294912
buffer_store_dwordx4 v[48:51],v5,s[8:11],s62 offen sc1
v_cvt_pk_bf16_f32 v55,v219,v223
s_add_u32 s62,s69,311296
buffer_store_dwordx4 v[52:55],v5,s[8:11],s62 offen sc1
s_cmp_lg_u32 s72,0
s_cbranch_scc1 L_aa_306
s_waitcnt vmcnt(9)
s_branch L_aa_316
L_av_318:
ds_read_b128 v[24:27],v4 offset:0
ds_read_b128 v[28:31],v4 offset:1024
s_min_u32 s56,s32,s33
s_cmp_lt_u32 s77,64
s_cselect_b32 s56,s56,0
s_cmp_eq_u32 s56,0
s_cselect_b32 s72,0x80000000,0
v_mov_b32 v248,s72
s_or_b32 s64,s70,s72
s_or_b32 s65,s71,s72
s_cmp_lt_u32 s30,s31
s_cselect_b32 s65,0x80000000,s65
s_and_b32 s57,s46,1
s_mul_i32 s58,s57,12288
s_add_u32 s64,s64,s58
s_lshl_b32 s57,s57,11
s_waitcnt lgkmcnt(1)
v_mfma_f32_16x16x32_bf16 v[160:163],v[24:27],a[0:3],0
ds_read_b128 v[32:35],v4 offset:2048
s_add_u32 s65,s65,s57
s_and_b32 s59,s50,2048
v_mfma_f32_16x16x32_bf16 v[164:167],v[24:27],a[4:7],0
ds_read_b128 v[36:39],v4 offset:3072
s_lshl_b32 s59,s59,4
s_xor_b32 s60,s67,65536
v_mfma_f32_16x16x32_bf16 v[168:171],v[24:27],a[8:11],0
ds_read_b128 v[40:43],v4 offset:8192
s_add_u32 s59,s59,s60
s_add_u32 s58,s58,s59
v_mfma_f32_16x16x32_bf16 v[172:175],v[24:27],a[12:15],0
ds_read_b128 v[44:47],v4 offset:9216
s_add_u32 s57,s57,s59
s_add_u32 m0,s58,0
v_mfma_f32_16x16x32_bf16 v[176:179],v[24:27],a[16:19],0
buffer_load_dwordx4 v0,s[8:11],s64 offen offset:0 sc1 lds
s_lshl_b32 s23,s51,5
s_add_u32 s23,s23,s68
v_mfma_f32_16x16x32_bf16 v[180:183],v[24:27],a[20:23],0
ds_read_b128 v[48:51],v4 offset:10240
s_lshl_b32 s24,s23,10
s_lshl_b32 s25,s51,10
v_mfma_f32_16x16x32_bf16 v[184:187],v[24:27],a[24:27],0
ds_read_b128 v[52:55],v4 offset:11264
s_waitcnt vmcnt(8)
v_mfma_f32_16x16x32_bf16 v[128:131],v[156:159],v[192:195],0
ds_write_b32 v247,v248
s_add_u32 s25,s25,2883584
s_cmp_eq_u32 s23,s55
s_cselect_b32 s25,s25,s24
v_mfma_f32_16x16x32_bf16 v[188:191],v[24:27],a[28:31],0
ds_read_b128 v[56:59],v4 offset:4096
s_waitcnt vmcnt(7)
v_mfma_f32_16x16x32_bf16 v[128:131],v[156:159],v[196:199],v[128:131]
ds_read_b128 v[60:63],v4 offset:5120
s_add_u32 s25,s25,8388608
s_mov_b32 s6,268435456
s_waitcnt lgkmcnt(9)
v_mfma_f32_16x16x32_bf16 v[160:163],v[28:31],a[32:35],v[160:163]
buffer_load_dwordx4 v0,s[8:11],s64 offen offset:1024 sc1 lds
s_waitcnt vmcnt(7)
v_mfma_f32_16x16x32_bf16 v[128:131],v[156:159],v[200:203],v[128:131]
ds_read_b128 v[64:67],v4 offset:6144
s_cmp_eq_u32 s31,0
s_cselect_b32 s25,s24,s25
s_cselect_b64 s[4:5],s[16:17],s[44:45]
s_cmov_b32 s6,2097152
v_mfma_f32_16x16x32_bf16 v[164:167],v[28:31],a[36:39],v[164:167]
ds_read_b128 v[68:71],v4 offset:7168
s_waitcnt vmcnt(6)
v_mfma_f32_16x16x32_bf16 v[128:131],v[156:159],v[204:207],v[128:131]
ds_read_b128 v[72:75],v4 offset:12288
v_mfma_f32_16x16x32_bf16 v[168:171],v[28:31],a[40:43],v[168:171]
ds_read_b128 v[76:79],v4 offset:13312
s_waitcnt vmcnt(5)
v_mfma_f32_16x16x32_bf16 v[132:135],v[156:159],v[208:211],0
ds_read_b128 v[80:83],v4 offset:14336
v_mfma_f32_16x16x32_bf16 v[172:175],v[28:31],a[44:47],v[172:175]
ds_read_b128 v[84:87],v4 offset:15360
s_waitcnt vmcnt(4)
v_mfma_f32_16x16x32_bf16 v[132:135],v[156:159],v[212:215],v[132:135]
buffer_load_dwordx4 v[224:227],v0,s[4:7],s25 offen sc1
s_lshr_b32 s24,s55,5
s_cmp_lt_u32 s51,s24
s_cselect_b32 s24,1,2
v_mfma_f32_16x16x32_bf16 v[176:179],v[28:31],a[48:51],v[176:179]
buffer_load_dwordx4 v0,s[8:11],s64 offen offset:2048 sc1 lds
s_waitcnt vmcnt(5)
v_mfma_f32_16x16x32_bf16 v[132:135],v[156:159],v[216:219],v[132:135]
v_mov_b32 v252,s24
s_lshl2_add_u32 s25,s51,11018240
v_mfma_f32_16x16x32_bf16 v[180:183],v[28:31],a[52:55],v[180:183]
ds_write_b128 v6,v[128:131]
s_waitcnt vmcnt(4)
v_mfma_f32_16x16x32_bf16 v[132:135],v[156:159],v[220:223],v[132:135]
s_lshl_b32 s24,s68,16
s_add_u32 s24,s24,s31
s_add_u32 s24,s24,s86
v_mfma_f32_16x16x32_bf16 v[184:187],v[28:31],a[56:59],v[184:187]
s_cmp_eq_u32 s24,1537
s_cselect_b32 s25,s25,0x80000000
v_mfma_f32_16x16x32_bf16 v[188:191],v[28:31],a[60:63],v[188:191]
buffer_store_dword v252,off,s[8:11],s25 sc1
s_bitcmp1_b64 s[38:39],s51
s_cselect_b32 s24,128,0
s_waitcnt lgkmcnt(15)
v_mfma_f32_16x16x32_bf16 v[160:163],v[32:35],a[64:67],v[160:163]
ds_write_b128 v6,v[132:135] offset:2048
s_lshl_b32 s23,s51,13
s_lshl2_add_u32 s23,s68,s23
v_mfma_f32_16x16x32_bf16 v[164:167],v[32:35],a[68:71],v[164:167]
buffer_load_dwordx4 v0,s[8:11],s64 offen offset:3072 sc1 lds
s_add_u32 s23,s23,10487168
s_add_u32 s23,s23,s24
v_mfma_f32_16x16x32_bf16 v[168:171],v[32:35],a[72:75],v[168:171]
buffer_load_dword v246,off,s[8:11],s23 sc1
v_lshrrev_b32 v244,4,v1
s_sub_u32 s23,s77,8
v_mfma_f32_16x16x32_bf16 v[172:175],v[32:35],a[76:79],v[172:175]
v_add_u32 v244,s23,v244
v_max_i32 v244,0,v244
v_mfma_f32_16x16x32_bf16 v[176:179],v[32:35],a[80:83],v[176:179]
s_waitcnt lgkmcnt(0)
s_barrier
v_lshl_add_u32 v244,v244,13,v21
v_mfma_f32_16x16x32_bf16 v[180:183],v[32:35],a[84:87],v[180:183]
ds_read_b128 v[248:251],v245
s_add_u32 m0,s58,4096
s_add_u32 s64,s64,4096
v_mfma_f32_16x16x32_bf16 v[184:187],v[32:35],a[88:91],v[184:187]
buffer_load_dwordx4 v0,s[8:11],s64 offen offset:0 sc1 lds
v_mfma_f32_16x16x32_bf16 v[188:191],v[32:35],a[92:95],v[188:191]
buffer_load_dwordx2 v[242:243],v244,s[8:11],0 offen sc1
v_mfma_f32_16x16x32_bf16 v[160:163],v[36:39],a[96:99],v[160:163]
buffer_store_dword v20,off,s[8:11],s73 sc1
s_mov_b32 s73,0x80000000
v_mfma_f32_16x16x32_bf16 v[164:167],v[36:39],a[100:103],v[164:167]
v_mfma_f32_16x16x32_bf16 v[168:171],v[36:39],a[104:107],v[168:171]
buffer_load_dwordx4 v0,s[8:11],s64 offen offset:1024 sc1 lds
v_mfma_f32_16x16x32_bf16 v[172:175],v[36:39],a[108:111],v[172:175]
v_mfma_f32_16x16x32_bf16 v[176:179],v[36:39],a[112:115],v[176:179]
s_waitcnt lgkmcnt(0)
v_or3_b32 v248,v248,v249,v250
v_or_b32 v248,v248,v251
v_mfma_f32_16x16x32_bf16 v[180:183],v[36:39],a[116:119],v[180:183]
v_mfma_f32_16x16x32_bf16 v[184:187],v[36:39],a[120:123],v[184:187]
buffer_load_dwordx4 v0,s[8:11],s64 offen offset:2048 sc1 lds
v_readfirstlane_b32 s72,v248
v_mfma_f32_16x16x32_bf16 v[188:191],v[36:39],a[124:127],v[188:191]
v_mfma_f32_16x16x32_bf16 v[160:163],v[40:43],a[128:131],v[160:163]
v_mfma_f32_16x16x32_bf16 v[164:167],v[40:43],a[132:135],v[164:167]
v_mfma_f32_16x16x32_bf16 v[168:171],v[40:43],a[136:139],v[168:171]
buffer_load_dwordx4 v0,s[8:11],s64 offen offset:3072 sc1 lds
v_mfma_f32_16x16x32_bf16 v[172:175],v[40:43],a[140:143],v[172:175]
v_mfma_f32_16x16x32_bf16 v[176:179],v[40:43],a[144:147],v[176:179]
v_mfma_f32_16x16x32_bf16 v[180:183],v[40:43],a[148:151],v[180:183]
v_mfma_f32_16x16x32_bf16 v[184:187],v[40:43],a[152:155],v[184:187]
s_add_u32 m0,s58,8192
s_add_u32 s64,s64,4096
v_mfma_f32_16x16x32_bf16 v[188:191],v[40:43],a[156:159],v[188:191]
buffer_load_dwordx4 v0,s[8:11],s64 offen offset:0 sc1 lds
v_mfma_f32_16x16x32_bf16 v[160:163],v[44:47],a[160:163],v[160:163]
v_mfma_f32_16x16x32_bf16 v[164:167],v[44:47],a[164:167],v[164:167]
v_mfma_f32_16x16x32_bf16 v[168:171],v[44:47],a[168:171],v[168:171]
v_mfma_f32_16x16x32_bf16 v[172:175],v[44:47],a[172:175],v[172:175]
buffer_load_dwordx4 v0,s[8:11],s64 offen offset:1024 sc1 lds
v_mfma_f32_16x16x32_bf16 v[176:179],v[44:47],a[176:179],v[176:179]
v_mfma_f32_16x16x32_bf16 v[180:183],v[44:47],a[180:183],v[180:183]
v_mfma_f32_16x16x32_bf16 v[184:187],v[44:47],a[184:187],v[184:187]
v_mfma_f32_16x16x32_bf16 v[188:191],v[44:47],a[188:191],v[188:191]
buffer_load_dwordx4 v0,s[8:11],s64 offen offset:2048 sc1 lds
v_mfma_f32_16x16x32_bf16 v[160:163],v[48:51],a[192:195],v[160:163]
v_mfma_f32_16x16x32_bf16 v[164:167],v[48:51],a[196:199],v[164:167]
v_mfma_f32_16x16x32_bf16 v[168:171],v[48:51],a[200:203],v[168:171]
v_mfma_f32_16x16x32_bf16 v[172:175],v[48:51],a[204:207],v[172:175]
buffer_load_dwordx4 v0,s[8:11],s64 offen offset:3072 sc1 lds
v_mfma_f32_16x16x32_bf16 v[176:179],v[48:51],a[208:211],v[176:179]
v_mfma_f32_16x16x32_bf16 v[180:183],v[48:51],a[212:215],v[180:183]
v_mfma_f32_16x16x32_bf16 v[184:187],v[48:51],a[216:219],v[184:187]
v_mfma_f32_16x16x32_bf16 v[188:191],v[48:51],a[220:223],v[188:191]
s_add_u32 m0,s57,24576
v_mfma_f32_16x16x32_bf16 v[160:163],v[52:55],a[224:227],v[160:163]
buffer_load_dwordx4 v0,s[8:11],s65 offen offset:0 sc1 lds
v_mfma_f32_16x16x32_bf16 v[164:167],v[52:55],a[228:231],v[164:167]
v_mfma_f32_16x16x32_bf16 v[168:171],v[52:55],a[232:235],v[168:171]
v_mfma_f32_16x16x32_bf16 v[172:175],v[52:55],a[236:239],v[172:175]
v_mfma_f32_16x16x32_bf16 v[176:179],v[52:55],a[240:243],v[176:179]
buffer_load_dwordx4 v0,s[8:11],s65 offen offset:1024 sc1 lds
v_mfma_f32_16x16x32_bf16 v[180:183],v[52:55],a[244:247],v[180:183]
v_mfma_f32_16x16x32_bf16 v[184:187],v[52:55],a[248:251],v[184:187]
v_mfma_f32_16x16x32_bf16 v[188:191],v[52:55],a[252:255],v[188:191]
v_mfma_f32_16x16x32_bf16 v[192:195],v[56:59],a[0:3],0
v_mfma_f32_16x16x32_bf16 v[196:199],v[56:59],a[4:7],0
v_mfma_f32_16x16x32_bf16 v[200:203],v[56:59],a[8:11],0
v_cvt_pk_bf16_f32 v24,v160,v164
v_cvt_pk_bf16_f32 v25,v168,v172
v_mfma_f32_16x16x32_bf16 v[204:207],v[56:59],a[12:15],0
v_cvt_pk_bf16_f32 v26,v176,v180
v_cvt_pk_bf16_f32 v27,v184,v188
v_mfma_f32_16x16x32_bf16 v[208:211],v[56:59],a[16:19],0
v_cvt_pk_bf16_f32 v28,v161,v165
v_cvt_pk_bf16_f32 v29,v169,v173
v_mfma_f32_16x16x32_bf16 v[212:215],v[56:59],a[20:23],0
v_cvt_pk_bf16_f32 v30,v177,v181
v_cvt_pk_bf16_f32 v31,v185,v189
v_mfma_f32_16x16x32_bf16 v[216:219],v[56:59],a[24:27],0
v_cvt_pk_bf16_f32 v32,v162,v166
v_cvt_pk_bf16_f32 v33,v170,v174
v_mfma_f32_16x16x32_bf16 v[220:223],v[56:59],a[28:31],0
v_cvt_pk_bf16_f32 v34,v178,v182
v_cvt_pk_bf16_f32 v35,v186,v190
v_mfma_f32_16x16x32_bf16 v[192:195],v[60:63],a[32:35],v[192:195]
v_cvt_pk_bf16_f32 v36,v163,v167
v_cvt_pk_bf16_f32 v37,v171,v175
v_mfma_f32_16x16x32_bf16 v[196:199],v[60:63],a[36:39],v[196:199]
v_cvt_pk_bf16_f32 v38,v179,v183
v_cvt_pk_bf16_f32 v39,v187,v191
v_mfma_f32_16x16x32_bf16 v[200:203],v[60:63],a[40:43],v[200:203]
v_mfma_f32_16x16x32_bf16 v[204:207],v[60:63],a[44:47],v[204:207]
v_mfma_f32_16x16x32_bf16 v[208:211],v[60:63],a[48:51],v[208:211]
v_mfma_f32_16x16x32_bf16 v[212:215],v[60:63],a[52:55],v[212:215]
v_mfma_f32_16x16x32_bf16 v[216:219],v[60:63],a[56:59],v[216:219]
v_mfma_f32_16x16x32_bf16 v[220:223],v[60:63],a[60:63],v[220:223]
v_mfma_f32_16x16x32_bf16 v[192:195],v[64:67],a[64:67],v[192:195]
v_mfma_f32_16x16x32_bf16 v[196:199],v[64:67],a[68:71],v[196:199]
v_mfma_f32_16x16x32_bf16 v[200:203],v[64:67],a[72:75],v[200:203]
v_mfma_f32_16x16x32_bf16 v[204:207],v[64:67],a[76:79],v[204:207]
v_mfma_f32_16x16x32_bf16 v[208:211],v[64:67],a[80:83],v[208:211]
v_mfma_f32_16x16x32_bf16 v[212:215],v[64:67],a[84:87],v[212:215]
v_mfma_f32_16x16x32_bf16 v[216:219],v[64:67],a[88:91],v[216:219]
v_mfma_f32_16x16x32_bf16 v[220:223],v[64:67],a[92:95],v[220:223]
v_mfma_f32_16x16x32_bf16 v[192:195],v[68:71],a[96:99],v[192:195]
v_mfma_f32_16x16x32_bf16 v[196:199],v[68:71],a[100:103],v[196:199]
v_mfma_f32_16x16x32_bf16 v[200:203],v[68:71],a[104:107],v[200:203]
v_mfma_f32_16x16x32_bf16 v[204:207],v[68:71],a[108:111],v[204:207]
v_mfma_f32_16x16x32_bf16 v[208:211],v[68:71],a[112:115],v[208:211]
s_add_u32 s62,s69,0
v_mfma_f32_16x16x32_bf16 v[212:215],v[68:71],a[116:119],v[212:215]
buffer_store_dwordx4 v[24:27],v5,s[8:11],s62 offen sc1
v_mfma_f32_16x16x32_bf16 v[216:219],v[68:71],a[120:123],v[216:219]
v_mfma_f32_16x16x32_bf16 v[220:223],v[68:71],a[124:127],v[220:223]
v_mfma_f32_16x16x32_bf16 v[192:195],v[72:75],a[128:131],v[192:195]
s_add_u32 s62,s69,16384
v_mfma_f32_16x16x32_bf16 v[196:199],v[72:75],a[132:135],v[196:199]
buffer_store_dwordx4 v[28:31],v5,s[8:11],s62 offen sc1
v_mfma_f32_16x16x32_bf16 v[200:203],v[72:75],a[136:139],v[200:203]
v_mfma_f32_16x16x32_bf16 v[204:207],v[72:75],a[140:143],v[204:207]
v_mfma_f32_16x16x32_bf16 v[208:211],v[72:75],a[144:147],v[208:211]
s_add_u32 s62,s69,32768
v_mfma_f32_16x16x32_bf16 v[212:215],v[72:75],a[148:151],v[212:215]
buffer_store_dwordx4 v[32:35],v5,s[8:11],s62 offen sc1
v_mfma_f32_16x16x32_bf16 v[216:219],v[72:75],a[152:155],v[216:219]
v_mfma_f32_16x16x32_bf16 v[220:223],v[72:75],a[156:159],v[220:223]
v_mfma_f32_16x16x32_bf16 v[192:195],v[76:79],a[160:163],v[192:195]
s_add_u32 s62,s69,49152
v_mfma_f32_16x16x32_bf16 v[196:199],v[76:79],a[164:167],v[196:199]
buffer_store_dwordx4 v[36:39],v5,s[8:11],s62 offen sc1
v_mfma_f32_16x16x32_bf16 v[200:203],v[76:79],a[168:171],v[200:203]
v_mfma_f32_16x16x32_bf16 v[204:207],v[76:79],a[172:175],v[204:207]
v_mfma_f32_16x16x32_bf16 v[208:211],v[76:79],a[176:179],v[208:211]
v_mfma_f32_16x16x32_bf16 v[212:215],v[76:79],a[180:183],v[212:215]
v_mfma_f32_16x16x32_bf16 v[216:219],v[76:79],a[184:187],v[216:219]
v_mfma_f32_16x16x32_bf16 v[220:223],v[76:79],a[188:191],v[220:223]
v_mfma_f32_16x16x32_bf16 v[192:195],v[80:83],a[192:195],v[192:195]
v_mfma_f32_16x16x32_bf16 v[196:199],v[80:83],a[196:199],v[196:199]
v_mfma_f32_16x16x32_bf16 v[192:195],v[84:87],a[224:227],v[192:195]
v_mfma_f32_16x16x32_bf16 v[196:199],v[84:87],a[228:231],v[196:199]
v_mfma_f32_16x16x32_bf16 v[200:203],v[80:83],a[200:203],v[200:203]
v_mfma_f32_16x16x32_bf16 v[204:207],v[80:83],a[204:207],v[204:207]
v_mfma_f32_16x16x32_bf16 v[200:203],v[84:87],a[232:235],v[200:203]
v_mfma_f32_16x16x32_bf16 v[204:207],v[84:87],a[236:239],v[204:207]
v_cvt_pk_bf16_f32 v40,v192,v196
v_cvt_pk_bf16_f32 v44,v193,v197
v_cvt_pk_bf16_f32 v48,v194,v198
v_mfma_f32_16x16x32_bf16 v[208:211],v[80:83],a[208:211],v[208:211]
v_cvt_pk_bf16_f32 v52,v195,v199
v_mfma_f32_16x16x32_bf16 v[212:215],v[80:83],a[212:215],v[212:215]
v_cvt_pk_bf16_f32 v41,v200,v204
v_cvt_pk_bf16_f32 v45,v201,v205
v_cvt_pk_bf16_f32 v49,v202,v206
v_mfma_f32_16x16x32_bf16 v[208:211],v[84:87],a[240:243],v[208:211]
v_cvt_pk_bf16_f32 v53,v203,v207
v_mfma_f32_16x16x32_bf16 v[212:215],v[84:87],a[244:247],v[212:215]
v_mfma_f32_16x16x32_bf16 v[216:219],v[80:83],a[216:219],v[216:219]
v_mfma_f32_16x16x32_bf16 v[220:223],v[80:83],a[220:223],v[220:223]
v_mfma_f32_16x16x32_bf16 v[216:219],v[84:87],a[248:251],v[216:219]
v_mfma_f32_16x16x32_bf16 v[220:223],v[84:87],a[252:255],v[220:223]
v_cvt_pk_bf16_f32 v42,v208,v212
v_cvt_pk_bf16_f32 v46,v209,v213
v_cvt_pk_bf16_f32 v50,v210,v214
v_cvt_pk_bf16_f32 v54,v211,v215
s_nop 3
v_cvt_pk_bf16_f32 v43,v216,v220
s_add_u32 s62,s69,262144
buffer_store_dwordx4 v[40:43],v5,s[8:11],s62 offen sc1
v_cvt_pk_bf16_f32 v47,v217,v221
s_add_u32 s62,s69,278528
buffer_store_dwordx4 v[44:47],v5,s[8:11],s62 offen sc1
v_cvt_pk_bf16_f32 v51,v218,v222
s_add_u32 s62,s69,294912
buffer_store_dwordx4 v[48:51],v5,s[8:11],s62 offen sc1
v_cvt_pk_bf16_f32 v55,v219,v223
s_add_u32 s62,s69,311296
buffer_store_dwordx4 v[52:55],v5,s[8:11],s62 offen sc1
s_cmp_lg_u32 s72,0
s_cbranch_scc1 L_aa_306
s_waitcnt vmcnt(8)
s_branch L_aa_316
L_aa_304:
ds_read_b128 v[24:27],v4 offset:0
ds_read_b128 v[28:31],v4 offset:1024
s_min_u32 s56,s32,s33
s_cmp_lt_u32 s77,64
s_cselect_b32 s56,s56,0
s_cmp_eq_u32 s56,0
s_cselect_b32 s72,0x80000000,0
v_mov_b32 v248,s72
s_or_b32 s64,s70,s72
s_or_b32 s65,s71,s72
s_cmp_lt_u32 s30,s31
s_cselect_b32 s65,0x80000000,s65
s_and_b32 s57,s46,1
s_mul_i32 s58,s57,12288
s_add_u32 s64,s64,s58
s_lshl_b32 s57,s57,11
s_waitcnt lgkmcnt(1)
v_mfma_f32_16x16x32_bf16 v[160:163],v[24:27],a[0:3],0
ds_read_b128 v[32:35],v4 offset:2048
s_add_u32 s65,s65,s57
s_and_b32 s59,s50,2048
v_mfma_f32_16x16x32_bf16 v[164:167],v[24:27],a[4:7],0
ds_read_b128 v[36:39],v4 offset:3072
s_lshl_b32 s59,s59,4
s_xor_b32 s60,s67,65536
v_mfma_f32_16x16x32_bf16 v[168:171],v[24:27],a[8:11],0
ds_read_b128 v[40:43],v4 offset:8192
s_add_u32 s59,s59,s60
s_add_u32 s58,s58,s59
v_mfma_f32_16x16x32_bf16 v[172:175],v[24:27],a[12:15],0
ds_read_b128 v[44:47],v4 offset:9216
s_add_u32 s57,s57,s59
s_add_u32 m0,s58,0
v_mfma_f32_16x16x32_bf16 v[176:179],v[24:27],a[16:19],0
buffer_load_dwordx4 v0,s[8:11],s64 offen offset:0 sc1 lds
s_lshl_b32 s23,s51,5
s_add_u32 s23,s23,s68
v_mfma_f32_16x16x32_bf16 v[180:183],v[24:27],a[20:23],0
ds_read_b128 v[48:51],v4 offset:10240
s_lshl_b32 s24,s23,10
s_lshl_b32 s25,s51,10
v_mfma_f32_16x16x32_bf16 v[184:187],v[24:27],a[24:27],0
ds_read_b128 v[52:55],v4 offset:11264
s_add_u32 s25,s25,2883584
s_cmp_eq_u32 s23,s55
s_cselect_b32 s25,s25,s24
v_mfma_f32_16x16x32_bf16 v[188:191],v[24:27],a[28:31],0
ds_write_b32 v247,v248
s_add_u32 s25,s25,8388608
s_mov_b32 s6,268435456
s_waitcnt lgkmcnt(7)
v_mfma_f32_16x16x32_bf16 v[160:163],v[28:31],a[32:35],v[160:163]
buffer_load_dwordx4 v0,s[8:11],s64 offen offset:1024 sc1 lds
s_cmp_eq_u32 s31,0
s_cselect_b32 s25,s24,s25
s_cselect_b64 s[4:5],s[16:17],s[44:45]
s_cmov_b32 s6,2097152
v_mfma_f32_16x16x32_bf16 v[164:167],v[28:31],a[36:39],v[164:167]
ds_read_b128 v[56:59],v4 offset:4096
v_mfma_f32_16x16x32_bf16 v[168:171],v[28:31],a[40:43],v[168:171]
ds_read_b128 v[60:63],v4 offset:5120
v_mfma_f32_16x16x32_bf16 v[172:175],v[28:31],a[44:47],v[172:175]
ds_read_b128 v[64:67],v4 offset:6144
v_mfma_f32_16x16x32_bf16 v[176:179],v[28:31],a[48:51],v[176:179]
buffer_load_dwordx4 v0,s[8:11],s64 offen offset:2048 sc1 lds
v_mfma_f32_16x16x32_bf16 v[180:183],v[28:31],a[52:55],v[180:183]
ds_read_b128 v[68:71],v4 offset:7168
v_mfma_f32_16x16x32_bf16 v[184:187],v[28:31],a[56:59],v[184:187]
ds_read_b128 v[72:75],v4 offset:12288
v_mfma_f32_16x16x32_bf16 v[188:191],v[28:31],a[60:63],v[188:191]
ds_read_b128 v[76:79],v4 offset:13312
s_waitcnt lgkmcnt(12)
v_mfma_f32_16x16x32_bf16 v[160:163],v[32:35],a[64:67],v[160:163]
buffer_load_dwordx4 v0,s[8:11],s64 offen offset:3072 sc1 lds
v_mfma_f32_16x16x32_bf16 v[164:167],v[32:35],a[68:71],v[164:167]
ds_read_b128 v[80:83],v4 offset:14336
v_mfma_f32_16x16x32_bf16 v[168:171],v[32:35],a[72:75],v[168:171]
ds_read_b128 v[84:87],v4 offset:15360
v_mfma_f32_16x16x32_bf16 v[172:175],v[32:35],a[76:79],v[172:175]
buffer_load_dwordx4 v[224:227],v0,s[4:7],s25 offen sc1
s_lshr_b32 s24,s55,5
s_cmp_lt_u32 s51,s24
s_cselect_b32 s24,1,2
v_mfma_f32_16x16x32_bf16 v[176:179],v[32:35],a[80:83],v[176:179]
s_add_u32 m0,s58,4096
s_add_u32 s64,s64,4096
v_mov_b32 v252,s24
v_mfma_f32_16x16x32_bf16 v[180:183],v[32:35],a[84:87],v[180:183]
buffer_load_dwordx4 v0,s[8:11],s64 offen offset:0 sc1 lds
s_lshl2_add_u32 s25,s51,11018240
s_lshl_b32 s24,s68,16
v_mfma_f32_16x16x32_bf16 v[184:187],v[32:35],a[88:91],v[184:187]
s_add_u32 s24,s24,s31
s_add_u32 s24,s24,s86
s_cmp_eq_u32 s24,1537
s_cselect_b32 s25,s25,0x80000000
v_mfma_f32_16x16x32_bf16 v[188:191],v[32:35],a[92:95],v[188:191]
buffer_store_dword v252,off,s[8:11],s25 sc1
s_waitcnt lgkmcnt(0)
s_barrier
s_waitcnt lgkmcnt(13)
v_mfma_f32_16x16x32_bf16 v[160:163],v[36:39],a[96:99],v[160:163]
ds_read_b128 v[248:251],v245
s_bitcmp1_b64 s[38:39],s51
s_cselect_b32 s24,128,0
v_mfma_f32_16x16x32_bf16 v[164:167],v[36:39],a[100:103],v[164:167]
buffer_load_dwordx4 v0,s[8:11],s64 offen offset:1024 sc1 lds
s_lshl_b32 s23,s51,13
s_lshl2_add_u32 s23,s68,s23
v_mfma_f32_16x16x32_bf16 v[168:171],v[36:39],a[104:107],v[168:171]
s_add_u32 s23,s23,10487168
s_add_u32 s23,s23,s24
v_mfma_f32_16x16x32_bf16 v[172:175],v[36:39],a[108:111],v[172:175]
buffer_load_dword v246,off,s[8:11],s23 sc1
v_lshrrev_b32 v244,4,v1
s_sub_u32 s23,s77,8
v_mfma_f32_16x16x32_bf16 v[176:179],v[36:39],a[112:115],v[176:179]
v_add_u32 v244,s23,v244
v_max_i32 v244,0,v244
v_mfma_f32_16x16x32_bf16 v[180:183],v[36:39],a[116:119],v[180:183]
buffer_load_dwordx4 v0,s[8:11],s64 offen offset:2048 sc1 lds
v_lshl_add_u32 v244,v244,13,v21
v_mfma_f32_16x16x32_bf16 v[184:187],v[36:39],a[120:123],v[184:187]
buffer_load_dwordx2 v[242:243],v244,s[8:11],0 offen sc1
s_waitcnt lgkmcnt(0)
v_or3_b32 v248,v248,v249,v250
v_mfma_f32_16x16x32_bf16 v[188:191],v[36:39],a[124:127],v[188:191]
v_or_b32 v248,v248,v251
v_mfma_f32_16x16x32_bf16 v[160:163],v[40:43],a[128:131],v[160:163]
v_readfirstlane_b32 s72,v248
v_mfma_f32_16x16x32_bf16 v[164:167],v[40:43],a[132:135],v[164:167]
buffer_load_dwordx4 v0,s[8:11],s64 offen offset:3072 sc1 lds
v_mfma_f32_16x16x32_bf16 v[168:171],v[40:43],a[136:139],v[168:171]
v_mfma_f32_16x16x32_bf16 v[172:175],v[40:43],a[140:143],v[172:175]
v_mfma_f32_16x16x32_bf16 v[176:179],v[40:43],a[144:147],v[176:179]
s_waitcnt vmcnt(12)
v_mfma_f32_16x16x32_bf16 v[180:183],v[40:43],a[148:151],v[180:183]
buffer_store_dword v20,off,s[8:11],s73 sc1
s_add_u32 m0,s58,8192
s_add_u32 s64,s64,4096
v_mfma_f32_16x16x32_bf16 v[184:187],v[40:43],a[152:155],v[184:187]
buffer_load_dwordx4 v0,s[8:11],s64 offen offset:0 sc1 lds
s_mov_b32 s73,0x80000000
v_mfma_f32_16x16x32_bf16 v[188:191],v[40:43],a[156:159],v[188:191]
v_mfma_f32_16x16x32_bf16 v[160:163],v[44:47],a[160:163],v[160:163]
v_mfma_f32_16x16x32_bf16 v[164:167],v[44:47],a[164:167],v[164:167]
v_mfma_f32_16x16x32_bf16 v[168:171],v[44:47],a[168:171],v[168:171]
buffer_load_dwordx4 v0,s[8:11],s64 offen offset:1024 sc1 lds
v_mfma_f32_16x16x32_bf16 v[172:175],v[44:47],a[172:175],v[172:175]
v_mfma_f32_16x16x32_bf16 v[176:179],v[44:47],a[176:179],v[176:179]
v_mfma_f32_16x16x32_bf16 v[180:183],v[44:47],a[180:183],v[180:183]
v_mfma_f32_16x16x32_bf16 v[184:187],v[44:47],a[184:187],v[184:187]
buffer_load_dwordx4 v0,s[8:11],s64 offen offset:2048 sc1 lds
v_mfma_f32_16x16x32_bf16 v[188:191],v[44:47],a[188:191],v[188:191]
v_mfma_f32_16x16x32_bf16 v[160:163],v[48:51],a[192:195],v[160:163]
v_mfma_f32_16x16x32_bf16 v[164:167],v[48:51],a[196:199],v[164:167]
v_mfma_f32_16x16x32_bf16 v[168:171],v[48:51],a[200:203],v[168:171]
buffer_load_dwordx4 v0,s[8:11],s64 offen offset:3072 sc1 lds
v_mfma_f32_16x16x32_bf16 v[172:175],v[48:51],a[204:207],v[172:175]
v_mfma_f32_16x16x32_bf16 v[176:179],v[48:51],a[208:211],v[176:179]
v_mfma_f32_16x16x32_bf16 v[180:183],v[48:51],a[212:215],v[180:183]
v_mfma_f32_16x16x32_bf16 v[184:187],v[48:51],a[216:219],v[184:187]
s_add_u32 m0,s57,24576
v_mfma_f32_16x16x32_bf16 v[188:191],v[48:51],a[220:223],v[188:191]
buffer_load_dwordx4 v0,s[8:11],s65 offen offset:0 sc1 lds
v_mfma_f32_16x16x32_bf16 v[160:163],v[52:55],a[224:227],v[160:163]
v_mfma_f32_16x16x32_bf16 v[164:167],v[52:55],a[228:231],v[164:167]
v_mfma_f32_16x16x32_bf16 v[168:171],v[52:55],a[232:235],v[168:171]
v_mfma_f32_16x16x32_bf16 v[172:175],v[52:55],a[236:239],v[172:175]
buffer_load_dwordx4 v0,s[8:11],s65 offen offset:1024 sc1 lds
v_mfma_f32_16x16x32_bf16 v[176:179],v[52:55],a[240:243],v[176:179]
v_mfma_f32_16x16x32_bf16 v[180:183],v[52:55],a[244:247],v[180:183]
v_mfma_f32_16x16x32_bf16 v[184:187],v[52:55],a[248:251],v[184:187]
v_mfma_f32_16x16x32_bf16 v[188:191],v[52:55],a[252:255],v[188:191]
v_mfma_f32_16x16x32_bf16 v[192:195],v[56:59],a[0:3],0
v_mfma_f32_16x16x32_bf16 v[196:199],v[56:59],a[4:7],0
v_mfma_f32_16x16x32_bf16 v[200:203],v[56:59],a[8:11],0
v_cvt_pk_bf16_f32 v24,v160,v164
v_cvt_pk_bf16_f32 v25,v168,v172
v_mfma_f32_16x16x32_bf16 v[204:207],v[56:59],a[12:15],0
v_cvt_pk_bf16_f32 v26,v176,v180
v_cvt_pk_bf16_f32 v27,v184,v188
v_mfma_f32_16x16x32_bf16 v[208:211],v[56:59],a[16:19],0
v_cvt_pk_bf16_f32 v28,v161,v165
v_cvt_pk_bf16_f32 v29,v169,v173
v_mfma_f32_16x16x32_bf16 v[212:215],v[56:59],a[20:23],0
v_cvt_pk_bf16_f32 v30,v177,v181
v_cvt_pk_bf16_f32 v31,v185,v189
v_mfma_f32_16x16x32_bf16 v[216:219],v[56:59],a[24:27],0
v_cvt_pk_bf16_f32 v32,v162,v166
v_cvt_pk_bf16_f32 v33,v170,v174
v_mfma_f32_16x16x32_bf16 v[220:223],v[56:59],a[28:31],0
v_cvt_pk_bf16_f32 v34,v178,v182
v_cvt_pk_bf16_f32 v35,v186,v190
v_mfma_f32_16x16x32_bf16 v[192:195],v[60:63],a[32:35],v[192:195]
v_cvt_pk_bf16_f32 v36,v163,v167
v_cvt_pk_bf16_f32 v37,v171,v175
v_mfma_f32_16x16x32_bf16 v[196:199],v[60:63],a[36:39],v[196:199]
v_cvt_pk_bf16_f32 v38,v179,v183
v_cvt_pk_bf16_f32 v39,v187,v191
v_mfma_f32_16x16x32_bf16 v[200:203],v[60:63],a[40:43],v[200:203]
v_mfma_f32_16x16x32_bf16 v[204:207],v[60:63],a[44:47],v[204:207]
v_mfma_f32_16x16x32_bf16 v[208:211],v[60:63],a[48:51],v[208:211]
v_mfma_f32_16x16x32_bf16 v[212:215],v[60:63],a[52:55],v[212:215]
v_mfma_f32_16x16x32_bf16 v[216:219],v[60:63],a[56:59],v[216:219]
v_mfma_f32_16x16x32_bf16 v[220:223],v[60:63],a[60:63],v[220:223]
v_mfma_f32_16x16x32_bf16 v[192:195],v[64:67],a[64:67],v[192:195]
v_mfma_f32_16x16x32_bf16 v[196:199],v[64:67],a[68:71],v[196:199]
v_mfma_f32_16x16x32_bf16 v[200:203],v[64:67],a[72:75],v[200:203]
v_mfma_f32_16x16x32_bf16 v[204:207],v[64:67],a[76:79],v[204:207]
v_mfma_f32_16x16x32_bf16 v[208:211],v[64:67],a[80:83],v[208:211]
v_mfma_f32_16x16x32_bf16 v[212:215],v[64:67],a[84:87],v[212:215]
v_mfma_f32_16x16x32_bf16 v[216:219],v[64:67],a[88:91],v[216:219]
v_mfma_f32_16x16x32_bf16 v[220:223],v[64:67],a[92:95],v[220:223]
v_mfma_f32_16x16x32_bf16 v[192:195],v[68:71],a[96:99],v[192:195]
v_mfma_f32_16x16x32_bf16 v[196:199],v[68:71],a[100:103],v[196:199]
v_mfma_f32_16x16x32_bf16 v[200:203],v[68:71],a[104:107],v[200:203]
v_mfma_f32_16x16x32_bf16 v[204:207],v[68:71],a[108:111],v[204:207]
v_mfma_f32_16x16x32_bf16 v[208:211],v[68:71],a[112:115],v[208:211]
s_add_u32 s62,s69,0
v_mfma_f32_16x16x32_bf16 v[212:215],v[68:71],a[116:119],v[212:215]
buffer_store_dwordx4 v[24:27],v5,s[8:11],s62 offen sc1
v_mfma_f32_16x16x32_bf16 v[216:219],v[68:71],a[120:123],v[216:219]
v_mfma_f32_16x16x32_bf16 v[220:223],v[68:71],a[124:127],v[220:223]
v_mfma_f32_16x16x32_bf16 v[192:195],v[72:75],a[128:131],v[192:195]
s_add_u32 s62,s69,16384
v_mfma_f32_16x16x32_bf16 v[196:199],v[72:75],a[132:135],v[196:199]
buffer_store_dwordx4 v[28:31],v5,s[8:11],s62 offen sc1
v_mfma_f32_16x16x32_bf16 v[200:203],v[72:75],a[136:139],v[200:203]
v_mfma_f32_16x16x32_bf16 v[204:207],v[72:75],a[140:143],v[204:207]
v_mfma_f32_16x16x32_bf16 v[208:211],v[72:75],a[144:147],v[208:211]
s_add_u32 s62,s69,32768
v_mfma_f32_16x16x32_bf16 v[212:215],v[72:75],a[148:151],v[212:215]
buffer_store_dwordx4 v[32:35],v5,s[8:11],s62 offen sc1
v_mfma_f32_16x16x32_bf16 v[216:219],v[72:75],a[152:155],v[216:219]
v_mfma_f32_16x16x32_bf16 v[220:223],v[72:75],a[156:159],v[220:223]
v_mfma_f32_16x16x32_bf16 v[192:195],v[76:79],a[160:163],v[192:195]
s_add_u32 s62,s69,49152
v_mfma_f32_16x16x32_bf16 v[196:199],v[76:79],a[164:167],v[196:199]
buffer_store_dwordx4 v[36:39],v5,s[8:11],s62 offen sc1
v_mfma_f32_16x16x32_bf16 v[200:203],v[76:79],a[168:171],v[200:203]
v_mfma_f32_16x16x32_bf16 v[204:207],v[76:79],a[172:175],v[204:207]
v_mfma_f32_16x16x32_bf16 v[208:211],v[76:79],a[176:179],v[208:211]
v_mfma_f32_16x16x32_bf16 v[212:215],v[76:79],a[180:183],v[212:215]
v_mfma_f32_16x16x32_bf16 v[216:219],v[76:79],a[184:187],v[216:219]
v_mfma_f32_16x16x32_bf16 v[220:223],v[76:79],a[188:191],v[220:223]
v_mfma_f32_16x16x32_bf16 v[192:195],v[80:83],a[192:195],v[192:195]
v_mfma_f32_16x16x32_bf16 v[196:199],v[80:83],a[196:199],v[196:199]
v_mfma_f32_16x16x32_bf16 v[192:195],v[84:87],a[224:227],v[192:195]
v_mfma_f32_16x16x32_bf16 v[196:199],v[84:87],a[228:231],v[196:199]
v_mfma_f32_16x16x32_bf16 v[200:203],v[80:83],a[200:203],v[200:203]
v_mfma_f32_16x16x32_bf16 v[204:207],v[80:83],a[204:207],v[204:207]
v_mfma_f32_16x16x32_bf16 v[200:203],v[84:87],a[232:235],v[200:203]
v_mfma_f32_16x16x32_bf16 v[204:207],v[84:87],a[236:239],v[204:207]
v_cvt_pk_bf16_f32 v40,v192,v196
v_cvt_pk_bf16_f32 v44,v193,v197
v_cvt_pk_bf16_f32 v48,v194,v198
v_mfma_f32_16x16x32_bf16 v[208:211],v[80:83],a[208:211],v[208:211]
v_cvt_pk_bf16_f32 v52,v195,v199
v_mfma_f32_16x16x32_bf16 v[212:215],v[80:83],a[212:215],v[212:215]
v_cvt_pk_bf16_f32 v41,v200,v204
v_cvt_pk_bf16_f32 v45,v201,v205
v_cvt_pk_bf16_f32 v49,v202,v206
v_mfma_f32_16x16x32_bf16 v[208:211],v[84:87],a[240:243],v[208:211]
v_cvt_pk_bf16_f32 v53,v203,v207
v_mfma_f32_16x16x32_bf16 v[212:215],v[84:87],a[244:247],v[212:215]
v_mfma_f32_16x16x32_bf16 v[216:219],v[80:83],a[216:219],v[216:219]
v_mfma_f32_16x16x32_bf16 v[220:223],v[80:83],a[220:223],v[220:223]
v_mfma_f32_16x16x32_bf16 v[216:219],v[84:87],a[248:251],v[216:219]
v_mfma_f32_16x16x32_bf16 v[220:223],v[84:87],a[252:255],v[220:223]
v_cvt_pk_bf16_f32 v42,v208,v212
v_cvt_pk_bf16_f32 v46,v209,v213
v_cvt_pk_bf16_f32 v50,v210,v214
v_cvt_pk_bf16_f32 v54,v211,v215
s_nop 3
v_cvt_pk_bf16_f32 v43,v216,v220
s_add_u32 s62,s69,262144
buffer_store_dwordx4 v[40:43],v5,s[8:11],s62 offen sc1
v_cvt_pk_bf16_f32 v47,v217,v221
s_add_u32 s62,s69,278528
buffer_store_dwordx4 v[44:47],v5,s[8:11],s62 offen sc1
v_cvt_pk_bf16_f32 v51,v218,v222
s_add_u32 s62,s69,294912
buffer_store_dwordx4 v[48:51],v5,s[8:11],s62 offen sc1
v_cvt_pk_bf16_f32 v55,v219,v223
s_add_u32 s62,s69,311296
buffer_store_dwordx4 v[52:55],v5,s[8:11],s62 offen sc1
s_cmp_lg_u32 s72,0
s_cbranch_scc1 L_aa_306
s_waitcnt vmcnt(8)
L_aa_316:
s_barrier
s_cmp_lt_u32 s30,s31
s_cbranch_scc1 L_ao_323
s_xor_b32 s67,s67,65536
s_and_b32 s56,s50,2048
s_lshl_b32 s56,s56,4
s_add_u32 s56,s56,s67
v_add_u32 v2,s56,v0
v_add_u32 v239,s56,v253
s_and_b32 s56,s50,1024
s_lshl_b32 s56,s56,2
v_add_u32 v238,s56,v2
s_mov_b32 s76,s71
s_mov_b32 s53,s77
ds_read_b128 v[24:27],v238 offset:16384
ds_read_b128 v[40:43],v2 offset:0
ds_read_b128 v[56:59],v2 offset:4096
ds_read_b128 v[28:31],v238 offset:17408
ds_read_b128 v[44:47],v2 offset:1024
ds_read_b128 v[60:63],v2 offset:5120
ds_read_b128 v[32:35],v238 offset:18432
ds_read_b128 v[48:51],v2 offset:2048
ds_read_b128 v[64:67],v2 offset:6144
ds_read_b128 v[36:39],v238 offset:19456
ds_read_b128 v[52:55],v2 offset:3072
ds_read_b128 v[68:71],v2 offset:7168
s_waitcnt lgkmcnt(9)
v_mfma_f32_16x16x32_bf16 v[128:131],v[40:43],v[24:27],v[8:11]
ds_read_b128 v[72:75],v2 offset:24576
v_mfma_f32_16x16x32_bf16 v[132:135],v[56:59],v[24:27],v[12:15]
ds_read_b128 v[76:79],v2 offset:25600
s_waitcnt lgkmcnt(8)
v_mfma_f32_16x16x32_bf16 v[128:131],v[44:47],v[28:31],v[128:131]
ds_read_b128 v[80:83],v2 offset:26624
v_mfma_f32_16x16x32_bf16 v[132:135],v[60:63],v[28:31],v[132:135]
ds_read_b128 v[84:87],v2 offset:27648
s_waitcnt lgkmcnt(7)
v_mfma_f32_16x16x32_bf16 v[128:131],v[48:51],v[32:35],v[128:131]
ds_read_b64 v[120:121],v239 offset:24576
v_mfma_f32_16x16x32_bf16 v[132:135],v[64:67],v[32:35],v[132:135]
ds_read_b64 v[122:123],v239 offset:25600
s_waitcnt lgkmcnt(6)
v_mfma_f32_16x16x32_bf16 v[128:131],v[52:55],v[36:39],v[128:131]
ds_read_b64 v[124:125],v239 offset:26624
v_mfma_f32_16x16x32_bf16 v[132:135],v[68:71],v[36:39],v[132:135]
ds_read_b64 v[126:127],v239 offset:27648
s_waitcnt lgkmcnt(4)
v_mfma_f32_16x16x32_bf16 v[136:139],v[72:75],v[24:27],0
ds_read_b128 v[88:91],v2 offset:8192
ds_read_b128 v[92:95],v2 offset:9216
v_mfma_f32_16x16x32_bf16 v[136:139],v[76:79],v[28:31],v[136:139]
ds_read_b128 v[96:99],v2 offset:10240
ds_read_b128 v[100:103],v2 offset:11264
v_mfma_f32_16x16x32_bf16 v[136:139],v[80:83],v[32:35],v[136:139]
ds_read_b128 v[104:107],v2 offset:12288
ds_read_b128 v[108:111],v2 offset:13312
v_mfma_f32_16x16x32_bf16 v[136:139],v[84:87],v[36:39],v[136:139]
ds_read_b128 v[112:115],v2 offset:14336
ds_read_b128 v[116:119],v2 offset:15360
s_cmp_eq_u32 s30,0
s_cbranch_scc1 L_aa_305
v_max3_u32 v238,v72,v73,v74
v_max3_u32 v238,v74,v75,v238
v_max3_u32 v238,v76,v77,v238
v_max3_u32 v238,v78,v79,v238
v_max3_u32 v238,v80,v81,v238
v_max3_u32 v238,v82,v83,v238
v_max3_u32 v238,v84,v85,v238
v_max3_u32 v238,v86,v87,v238
s_waitcnt lgkmcnt(8)
v_max3_u32 v238,v120,v121,v238
v_max3_u32 v238,v122,v123,v238
v_max3_u32 v238,v124,v125,v238
v_max3_u32 v238,v126,v127,v238
v_cmp_eq_u32 vcc,-1,v238
s_cmp_lg_u64 vcc,0
s_cselect_b32 s27,1,0
s_andn2_b32 s57,s27,s31
s_add_u32 s66,s66,4
s_bfe_u32 s56,s66,0x10002
s_bitset0_b32 s37,s56
s_lshl_b32 s56,s57,s56
s_or_b32 s37,s37,s56
s_or_b32 s56,s37,s66
v_mov_b32 v22,s56
s_xor_b32 s69,s69,524288
s_waitcnt vmcnt(0) lgkmcnt(0)
buffer_store_dword v22,off,s[8:11],s74 sc1
s_cmp_lg_u32 s86,1536
s_cbranch_scc1 L_ae_326
s_mov_b32 s77,s35
s_mov_b32 s30,0
s_lshl_b32 s56,s77,5
s_add_u32 s56,s56,s68
s_mul_i32 s70,s56,24576
s_lshl_b32 s71,s56,12
s_lshl_b32 s59,s77,13
s_lshl2_add_u32 s59,s68,s59
s_add_u32 s59,s59,10485760
s_buffer_load_dword s32,s[8:11],s59
s_mov_b32 s33,1
s_add_u32 s70,s70,100663296
s_add_u32 s71,s71,41943040
v_mov_b32 v19,s59
s_branch L_af_327
L_ae_326:
s_ff1_i32_b64 s77,s[84:85]
s_bitset0_b64 s[84:85],s77
s_min_u32 s77,s77,64
s_lshr_b32 s61,s55,5
s_lshl_b32 s56,s77,5
s_add_u32 s56,s56,s68
s_mul_i32 s70,s56,24576
s_lshl_b32 s71,s56,12
s_lshl_b32 s59,s77,13
s_lshl2_add_u32 s59,s68,s59
s_add_u32 s59,s59,10486144
s_cmp_lt_u32 s77,s61
s_cselect_b32 s57,0,16777216
s_mov_b32 s60,s59
s_buffer_load_dword s33,s[8:11],s60
s_add_u32 s71,s71,s57
s_add_u32 s71,s71,58720256
s_cmp_eq_u32 s77,s61
s_cselect_b32 s57,50331648,0
s_cselect_b32 s58,1536,0
s_add_u32 s59,s59,s58
s_buffer_load_dword s32,s[8:11],s59
s_add_u32 s70,s70,s57
s_add_u32 s70,s70,150994944
v_mov_b32 v19,s59
v_writelane_b32 v19,s60,1
L_af_327:
s_and_b32 s27,s27,s31
s_cbranch_scc1 L_ac_328
L_acb_329:
v_max3_f32 v238,v128,v129,v130
v_max3_f32 v239,v131,v132,v133
v_max3_f32 v238,v134,v135,v238
v_max3_f32 v239,v138,v139,v239
v_max_f32 v238,v238,v239
v_max_f32 v239,v238,v239
v_pk_mul_f32 v[128:129],v[128:129],v[152:153] op_sel_hi:[1,0]
v_pk_mul_f32 v[130:131],v[130:131],v[152:153] op_sel_hi:[1,0]
v_permlane16_swap_b32 v238,v239
v_max_f32 v238,v238,v239
v_max_f32 v239,v238,v239
v_pk_mul_f32 v[132:133],v[132:133],v[152:153] op_sel_hi:[1,0]
v_pk_mul_f32 v[134:135],v[134:135],v[152:153] op_sel_hi:[1,0]
v_permlane32_swap_b32 v238,v239
v_max_f32 v238,v238,v239
v_mul_f32 v238,v152,v238
v_pk_mul_f32 v[138:139],v[138:139],v[152:153] op_sel_hi:[1,0]
buffer_load_dword v17,v16,s[8:11],s87 offen sc1
v_pk_add_f32 v[128:129],v[128:129],v[238:239] op_sel_hi:[1,0] neg_lo:[0,1] neg_hi:[0,1]
v_pk_add_f32 v[130:131],v[130:131],v[238:239] op_sel_hi:[1,0] neg_lo:[0,1] neg_hi:[0,1]
v_pk_add_f32 v[132:133],v[132:133],v[238:239] op_sel_hi:[1,0] neg_lo:[0,1] neg_hi:[0,1]
v_pk_add_f32 v[134:135],v[134:135],v[238:239] op_sel_hi:[1,0] neg_lo:[0,1] neg_hi:[0,1]
v_pk_add_f32 v[138:139],v[138:139],v[238:239] op_sel_hi:[1,0] neg_lo:[0,1] neg_hi:[0,1]
v_exp_f32 v128,v128
v_exp_f32 v129,v129
v_exp_f32 v130,v130
v_exp_f32 v131,v131
v_exp_f32 v132,v132
v_exp_f32 v133,v133
v_exp_f32 v134,v134
v_exp_f32 v135,v135
v_exp_f32 v138,v138
v_exp_f32 v139,v139
v_pk_add_f32 v[148:149],v[128:129],v[130:131]
v_pk_add_f32 v[150:151],v[132:133],v[134:135]
v_pk_add_f32 v[148:149],v[148:149],v[138:139]
v_pk_add_f32 v[148:149],v[148:149],v[150:151]
v_add_f32 v150,v148,v149
v_add_f32 v151,v148,v149
s_nop 1
v_permlane16_swap_b32 v150,v151
v_add_f32 v148,v150,v151
v_add_f32 v149,v150,v151
s_nop 1
v_permlane32_swap_b32 v148,v149
v_add_f32 v148,v148,v149
v_rcp_f32 v148,v148
s_waitcnt vmcnt(0)
v_cmp_gt_u32 vcc,s66,v17
v_pk_mul_f32 v[138:139],v[138:139],v[148:149] op_sel_hi:[1,0]
v_pk_mul_f32 v[128:129],v[128:129],v[148:149] op_sel_hi:[1,0]
v_pk_mul_f32 v[130:131],v[130:131],v[148:149] op_sel_hi:[1,0]
v_pk_mul_f32 v[132:133],v[132:133],v[148:149] op_sel_hi:[1,0]
v_pk_mul_f32 v[134:135],v[134:135],v[148:149] op_sel_hi:[1,0]
s_cbranch_vccnz L_ap_331
L_apb_332:
s_xor_b32 s34,s69,524288
buffer_load_dwordx4 v[192:195],v7,s[8:11],s34 offen sc1
s_bfe_u32 s56,s66,0x10002
v_lshrrev_b32 v238,s56,v17
v_and_b32 v238,1,v238
v_cmp_ne_u32 vcc,0,v238
v_cvt_pk_bf16_f32 v144,v138,v139
v_cvt_pk_bf16_f32 v147,v138,v139
v_cvt_pk_bf16_f32 v140,v128,v129
v_cvt_pk_bf16_f32 v141,v130,v131
v_cvt_pk_bf16_f32 v142,v132,v133
v_cvt_pk_bf16_f32 v143,v134,v135
s_cbranch_vccnz L_ak_325
s_add_u32 s36,s36,4
v_mfma_f32_16x16x16_bf16 v[24:27],v[120:121],v[144:145],0
s_add_u32 s34,s34,4096
v_mfma_f32_16x16x16_bf16 v[28:31],v[120:121],v[146:147],0
buffer_load_dwordx4 v[196:199],v7,s[8:11],s34 offen sc1
v_mfma_f32_16x16x16_bf16 v[32:35],v[122:123],v[144:145],0
s_add_u32 s34,s34,4096
v_mfma_f32_16x16x16_bf16 v[36:39],v[122:123],v[146:147],0
buffer_load_dwordx4 v[200:203],v7,s[8:11],s34 offen sc1
v_mfma_f32_16x16x16_bf16 v[40:43],v[124:125],v[144:145],0
s_add_u32 s34,s34,4096
v_mfma_f32_16x16x16_bf16 v[44:47],v[124:125],v[146:147],0
buffer_load_dwordx4 v[204:207],v7,s[8:11],s34 offen sc1
v_mfma_f32_16x16x16_bf16 v[48:51],v[126:127],v[144:145],0
s_add_u32 s34,s34,4096
v_mfma_f32_16x16x16_bf16 v[52:55],v[126:127],v[146:147],0
buffer_load_dwordx4 v[208:211],v7,s[8:11],s34 offen sc1
v_mfma_f32_16x16x32_bf16 v[24:27],v[88:91],v[140:143],v[24:27]
s_add_u32 s34,s34,4096
v_mfma_f32_16x16x32_bf16 v[28:31],v[92:95],v[140:143],v[28:31]
buffer_load_dwordx4 v[212:215],v7,s[8:11],s34 offen sc1
v_mfma_f32_16x16x32_bf16 v[32:35],v[96:99],v[140:143],v[32:35]
s_add_u32 s34,s34,4096
v_mfma_f32_16x16x32_bf16 v[36:39],v[100:103],v[140:143],v[36:39]
buffer_load_dwordx4 v[216:219],v7,s[8:11],s34 offen sc1
v_cvt_pk_bf16_f32 v72,v24,v28
v_cvt_pk_bf16_f32 v73,v25,v29
v_mfma_f32_16x16x32_bf16 v[40:43],v[104:107],v[140:143],v[40:43]
s_add_u32 s34,s34,4096
v_cvt_pk_bf16_f32 v74,v26,v30
v_cvt_pk_bf16_f32 v75,v27,v31
v_mfma_f32_16x16x32_bf16 v[44:47],v[108:111],v[140:143],v[44:47]
ds_write_b128 v3,v[72:75] offset:0
v_cvt_pk_bf16_f32 v76,v32,v36
v_cvt_pk_bf16_f32 v77,v33,v37
v_mfma_f32_16x16x32_bf16 v[48:51],v[112:115],v[140:143],v[48:51]
buffer_load_dwordx4 v[220:223],v7,s[8:11],s34 offen sc1
v_cvt_pk_bf16_f32 v78,v34,v38
v_cvt_pk_bf16_f32 v79,v35,v39
v_mfma_f32_16x16x32_bf16 v[52:55],v[116:119],v[140:143],v[52:55]
ds_write_b128 v3,v[76:79] offset:1024
v_cvt_pk_bf16_f32 v80,v40,v44
v_cvt_pk_bf16_f32 v81,v41,v45
v_cvt_pk_bf16_f32 v82,v42,v46
v_cvt_pk_bf16_f32 v83,v43,v47
ds_write_b128 v3,v[80:83] offset:2048
s_nop 1
v_cvt_pk_bf16_f32 v84,v48,v52
v_cvt_pk_bf16_f32 v85,v49,v53
v_cvt_pk_bf16_f32 v86,v50,v54
v_cvt_pk_bf16_f32 v87,v51,v55
ds_write_b128 v3,v[84:87] offset:3072
s_cmp_eq_u32 s31,0
s_cbranch_scc1 L_ah_330
s_waitcnt lgkmcnt(0)
s_barrier
s_mov_b32 s26,s51
s_mov_b32 s51,s53
s_branch L_aa_317
L_ah_330:
s_waitcnt vmcnt(7)
v_mfma_f32_16x16x32_bf16 v[160:163],v[156:159],v[192:195],0
s_waitcnt vmcnt(6)
v_mfma_f32_16x16x32_bf16 v[160:163],v[156:159],v[196:199],v[160:163]
s_waitcnt vmcnt(5)
v_mfma_f32_16x16x32_bf16 v[160:163],v[156:159],v[200:203],v[160:163]
s_waitcnt vmcnt(4)
v_mfma_f32_16x16x32_bf16 v[160:163],v[156:159],v[204:207],v[160:163]
s_waitcnt vmcnt(3)
v_mfma_f32_16x16x32_bf16 v[164:167],v[156:159],v[208:211],0
s_waitcnt vmcnt(2)
v_mfma_f32_16x16x32_bf16 v[164:167],v[156:159],v[212:215],v[164:167]
s_waitcnt vmcnt(1)
v_mfma_f32_16x16x32_bf16 v[164:167],v[156:159],v[216:219],v[164:167]
ds_write_b128 v6,v[160:163]
s_waitcnt vmcnt(0)
v_mfma_f32_16x16x32_bf16 v[164:167],v[156:159],v[220:223],v[164:167]
s_nop 7
ds_write_b128 v6,v[164:167] offset:2048
s_waitcnt lgkmcnt(0)
s_barrier
buffer_store_dword v20,off,s[8:11],s73 sc1
s_mov_b32 s73,0x80000000
s_mov_b32 s27,1
s_branch L_aa_308
L_ao_323:
s_xor_b32 s67,s67,65536
s_and_b32 s56,s50,2048
s_lshl_b32 s56,s56,4
s_add_u32 s56,s56,s67
v_add_u32 v2,s56,v0
v_add_u32 v239,s56,v253
s_and_b32 s56,s50,1024
s_lshl_b32 s56,s56,2
v_add_u32 v238,s56,v2
s_mov_b32 s76,s71
s_mov_b32 s53,s77
ds_read_b128 v[24:27],v238 offset:16384
ds_read_b128 v[40:43],v2 offset:0
ds_read_b128 v[56:59],v2 offset:4096
ds_read_b128 v[28:31],v238 offset:17408
ds_read_b128 v[44:47],v2 offset:1024
ds_read_b128 v[60:63],v2 offset:5120
ds_read_b128 v[32:35],v238 offset:18432
ds_read_b128 v[48:51],v2 offset:2048
ds_read_b128 v[64:67],v2 offset:6144
ds_read_b128 v[36:39],v238 offset:19456
ds_read_b128 v[52:55],v2 offset:3072
ds_read_b128 v[68:71],v2 offset:7168
buffer_load_dwordx4 v[72:75],v0,s[8:11],s76 offen offset:0 sc1
buffer_load_dwordx4 v[76:79],v0,s[8:11],s76 offen offset:1024 sc1
buffer_load_dwordx4 v[80:83],v0,s[8:11],s76 offen offset:2048 sc1
buffer_load_dwordx4 v[84:87],v0,s[8:11],s76 offen offset:3072 sc1
buffer_load_dwordx2 v[120:121],v253,s[8:11],s76 offen offset:0 sc1
buffer_load_dwordx2 v[122:123],v253,s[8:11],s76 offen offset:1024 sc1
buffer_load_dwordx2 v[124:125],v253,s[8:11],s76 offen offset:2048 sc1
buffer_load_dwordx2 v[126:127],v253,s[8:11],s76 offen offset:3072 sc1
s_waitcnt lgkmcnt(9)
v_mfma_f32_16x16x32_bf16 v[128:131],v[40:43],v[24:27],v[8:11]
ds_read_b128 v[88:91],v2 offset:8192
v_mfma_f32_16x16x32_bf16 v[132:135],v[56:59],v[24:27],v[12:15]
ds_read_b128 v[92:95],v2 offset:9216
s_waitcnt lgkmcnt(8)
v_mfma_f32_16x16x32_bf16 v[128:131],v[44:47],v[28:31],v[128:131]
ds_read_b128 v[96:99],v2 offset:10240
v_mfma_f32_16x16x32_bf16 v[132:135],v[60:63],v[28:31],v[132:135]
ds_read_b128 v[100:103],v2 offset:11264
s_waitcnt lgkmcnt(7)
v_mfma_f32_16x16x32_bf16 v[128:131],v[48:51],v[32:35],v[128:131]
ds_read_b128 v[104:107],v2 offset:12288
v_mfma_f32_16x16x32_bf16 v[132:135],v[64:67],v[32:35],v[132:135]
ds_read_b128 v[108:111],v2 offset:13312
s_waitcnt lgkmcnt(6)
v_mfma_f32_16x16x32_bf16 v[128:131],v[52:55],v[36:39],v[128:131]
ds_read_b128 v[112:115],v2 offset:14336
v_mfma_f32_16x16x32_bf16 v[132:135],v[68:71],v[36:39],v[132:135]
ds_read_b128 v[116:119],v2 offset:15360
s_add_u32 s66,s66,4
s_bfe_u32 s56,s66,0x10002
s_bitset0_b32 s37,s56
s_lshl_b32 s56,0,s56
s_or_b32 s37,s37,s56
s_or_b32 s56,s37,s66
v_mov_b32 v22,s56
s_xor_b32 s69,s69,524288
s_waitcnt vmcnt(8) lgkmcnt(0)
buffer_store_dword v22,off,s[8:11],s74 sc1
s_mov_b32 s26,s51
s_mov_b32 s27,3
s_branch L_aa_312
L_aa_305:
s_add_u32 s66,s66,4
s_bfe_u32 s56,s66,0x10002
s_bitset0_b32 s37,s56
s_lshl_b32 s56,0,s56
s_or_b32 s37,s37,s56
s_or_b32 s56,s37,s66
v_mov_b32 v22,s56
s_xor_b32 s69,s69,524288
s_waitcnt vmcnt(0) lgkmcnt(0)
buffer_store_dword v22,off,s[8:11],s74 sc1
L_aq_333:
buffer_load_dword v17,v16,s[8:11],s87 offen sc1
s_sub_u32 s49,s49,1
s_cbranch_scc1 L_abort2
s_waitcnt vmcnt(0)
v_cmp_gt_u32 vcc,s66,v17
s_cbranch_vccnz L_aq_333
s_xor_b32 s34,s69,524288
buffer_load_dwordx4 v[160:163],v7,s[8:11],s34 offen sc1
s_add_u32 s34,s34,4096
buffer_load_dwordx4 v[164:167],v7,s[8:11],s34 offen sc1
s_add_u32 s34,s34,4096
buffer_load_dwordx4 v[168:171],v7,s[8:11],s34 offen sc1
s_add_u32 s34,s34,4096
buffer_load_dwordx4 v[172:175],v7,s[8:11],s34 offen sc1
s_add_u32 s34,s34,4096
buffer_load_dwordx4 v[176:179],v7,s[8:11],s34 offen sc1
s_add_u32 s34,s34,4096
buffer_load_dwordx4 v[180:183],v7,s[8:11],s34 offen sc1
s_add_u32 s34,s34,4096
buffer_load_dwordx4 v[184:187],v7,s[8:11],s34 offen sc1
s_add_u32 s34,s34,4096
buffer_load_dwordx4 v[188:191],v7,s[8:11],s34 offen sc1
buffer_load_dwordx4 v[72:75],v0,s[8:11],s76 offen offset:0 sc1
buffer_load_dwordx4 v[76:79],v0,s[8:11],s76 offen offset:1024 sc1
buffer_load_dwordx4 v[80:83],v0,s[8:11],s76 offen offset:2048 sc1
buffer_load_dwordx4 v[84:87],v0,s[8:11],s76 offen offset:3072 sc1
buffer_load_dwordx2 v[120:121],v253,s[8:11],s76 offen offset:0 sc1
buffer_load_dwordx2 v[122:123],v253,s[8:11],s76 offen offset:1024 sc1
buffer_load_dwordx2 v[124:125],v253,s[8:11],s76 offen offset:2048 sc1
buffer_load_dwordx2 v[126:127],v253,s[8:11],s76 offen offset:3072 sc1
s_waitcnt vmcnt(15)
v_mfma_f32_16x16x32_bf16 v[192:195],v[156:159],v[160:163],0
s_waitcnt vmcnt(14)
v_mfma_f32_16x16x32_bf16 v[192:195],v[156:159],v[164:167],v[192:195]
s_waitcnt vmcnt(13)
v_mfma_f32_16x16x32_bf16 v[192:195],v[156:159],v[168:171],v[192:195]
s_waitcnt vmcnt(12)
v_mfma_f32_16x16x32_bf16 v[192:195],v[156:159],v[172:175],v[192:195]
s_waitcnt vmcnt(11)
v_mfma_f32_16x16x32_bf16 v[196:199],v[156:159],v[176:179],0
s_waitcnt vmcnt(10)
v_mfma_f32_16x16x32_bf16 v[196:199],v[156:159],v[180:183],v[196:199]
s_waitcnt vmcnt(9)
v_mfma_f32_16x16x32_bf16 v[196:199],v[156:159],v[184:187],v[196:199]
ds_write_b128 v6,v[192:195]
s_waitcnt vmcnt(8)
v_mfma_f32_16x16x32_bf16 v[196:199],v[156:159],v[188:191],v[196:199]
s_nop 7
ds_write_b128 v6,v[196:199] offset:2048
s_waitcnt lgkmcnt(0)
s_barrier
buffer_store_dword v20,off,s[8:11],s73 sc1
s_mov_b32 s73,0x80000000
s_mov_b32 s27,0
s_branch L_aa_308
L_aa_306:
s_add_u32 s56,s30,s86
s_cmp_lg_u32 s56,1537
s_cbranch_scc1 L_al_324
s_add_u32 s66,s66,4
s_bfe_u32 s56,s66,0x10002
s_bitset0_b32 s37,s56
s_lshl_b32 s56,1,s56
s_or_b32 s37,s37,s56
s_or_b32 s56,s37,s66
v_mov_b32 v22,s56
s_xor_b32 s69,s69,524288
s_waitcnt vmcnt(0) lgkmcnt(0)
buffer_store_dword v22,off,s[8:11],s74 sc1
s_cmp_lg_u32 s86,1536
s_cbranch_scc1 L_ae_334
s_mov_b32 s77,s35
s_mov_b32 s30,0
s_lshl_b32 s56,s77,5
s_add_u32 s56,s56,s68
s_mul_i32 s70,s56,24576
s_lshl_b32 s71,s56,12
s_lshl_b32 s59,s77,13
s_lshl2_add_u32 s59,s68,s59
s_add_u32 s59,s59,10485760
s_buffer_load_dword s32,s[8:11],s59
s_mov_b32 s33,1
s_add_u32 s70,s70,100663296
s_add_u32 s71,s71,41943040
v_mov_b32 v19,s59
s_branch L_af_335
L_ae_334:
s_ff1_i32_b64 s77,s[84:85]
s_bitset0_b64 s[84:85],s77
s_min_u32 s77,s77,64
s_lshr_b32 s61,s55,5
s_lshl_b32 s56,s77,5
s_add_u32 s56,s56,s68
s_mul_i32 s70,s56,24576
s_lshl_b32 s71,s56,12
s_lshl_b32 s59,s77,13
s_lshl2_add_u32 s59,s68,s59
s_add_u32 s59,s59,10486144
s_cmp_lt_u32 s77,s61
s_cselect_b32 s57,0,16777216
s_mov_b32 s60,s59
s_buffer_load_dword s33,s[8:11],s60
s_add_u32 s71,s71,s57
s_add_u32 s71,s71,58720256
s_cmp_eq_u32 s77,s61
s_cselect_b32 s57,50331648,0
s_cselect_b32 s58,1536,0
s_add_u32 s59,s59,s58
s_buffer_load_dword s32,s[8:11],s59
s_add_u32 s70,s70,s57
s_add_u32 s70,s70,150994944
v_mov_b32 v19,s59
v_writelane_b32 v19,s60,1
L_af_335:
s_branch L_ak_325
L_al_324:
s_add_u32 s66,s66,4
s_bfe_u32 s56,s66,0x10002
s_bitset0_b32 s37,s56
s_lshl_b32 s56,0,s56
s_or_b32 s37,s37,s56
s_or_b32 s56,s37,s66
v_mov_b32 v22,s56
s_xor_b32 s69,s69,524288
s_waitcnt vmcnt(0) lgkmcnt(0)
buffer_store_dword v22,off,s[8:11],s74 sc1
L_ak_325:
L_aq_336:
buffer_load_dword v17,v16,s[8:11],s87 offen sc1
s_sub_u32 s49,s49,1
s_cbranch_scc1 L_abort2
s_waitcnt vmcnt(0)
v_cmp_gt_u32 vcc,s66,v17
s_cbranch_vccnz L_aq_336
s_xor_b32 s34,s69,524288
buffer_load_dwordx4 v[160:163],v7,s[8:11],s34 offen sc1
s_add_u32 s34,s34,4096
buffer_load_dwordx4 v[164:167],v7,s[8:11],s34 offen sc1
s_add_u32 s34,s34,4096
buffer_load_dwordx4 v[168:171],v7,s[8:11],s34 offen sc1
s_add_u32 s34,s34,4096
buffer_load_dwordx4 v[172:175],v7,s[8:11],s34 offen sc1
s_add_u32 s34,s34,4096
buffer_load_dwordx4 v[176:179],v7,s[8:11],s34 offen sc1
s_add_u32 s34,s34,4096
buffer_load_dwordx4 v[180:183],v7,s[8:11],s34 offen sc1
s_add_u32 s34,s34,4096
buffer_load_dwordx4 v[184:187],v7,s[8:11],s34 offen sc1
s_add_u32 s34,s34,4096
buffer_load_dwordx4 v[188:191],v7,s[8:11],s34 offen sc1
s_waitcnt vmcnt(7)
v_mfma_f32_16x16x32_bf16 v[192:195],v[156:159],v[160:163],0
s_waitcnt vmcnt(6)
v_mfma_f32_16x16x32_bf16 v[192:195],v[156:159],v[164:167],v[192:195]
s_waitcnt vmcnt(5)
v_mfma_f32_16x16x32_bf16 v[192:195],v[156:159],v[168:171],v[192:195]
s_waitcnt vmcnt(4)
v_mfma_f32_16x16x32_bf16 v[192:195],v[156:159],v[172:175],v[192:195]
s_waitcnt vmcnt(3)
v_mfma_f32_16x16x32_bf16 v[196:199],v[156:159],v[176:179],0
s_waitcnt vmcnt(2)
v_mfma_f32_16x16x32_bf16 v[196:199],v[156:159],v[180:183],v[196:199]
s_waitcnt vmcnt(1)
v_mfma_f32_16x16x32_bf16 v[196:199],v[156:159],v[184:187],v[196:199]
ds_write_b128 v6,v[192:195]
s_waitcnt vmcnt(0)
v_mfma_f32_16x16x32_bf16 v[196:199],v[156:159],v[188:191],v[196:199]
s_nop 7
ds_write_b128 v6,v[196:199] offset:2048
s_waitcnt lgkmcnt(0)
s_barrier
buffer_store_dword v20,off,s[8:11],s73 sc1
s_mov_b32 s73,0x80000000
s_mov_b32 s27,2
L_aa_308:
s_cmp_lg_u32 s31,0
s_cbranch_scc1 L_ar_339
s_bitcmp1_b32 s46,0
s_cbranch_scc1 L_ar_338
L_ar_337:
ds_read_b128 v[160:163],v23
ds_read_b128 v[164:167],v23 offset:16
v_lshlrev_b32 v200,16,v224
v_and_b32 v201,0xffff0000,v224
v_lshlrev_b32 v202,16,v225
v_and_b32 v203,0xffff0000,v225
v_lshlrev_b32 v204,16,v226
v_and_b32 v205,0xffff0000,v226
v_lshlrev_b32 v206,16,v227
v_and_b32 v207,0xffff0000,v227
s_lshl_b32 s18,s51,5
s_add_u32 s18,s18,s68
s_lshl_b32 s19,s18,10
s_add_u32 s20,s19,8388608
s_waitcnt lgkmcnt(0)
v_cvt_pk_bf16_f32 v168,v160,v161
v_cvt_pk_bf16_f32 v169,v162,v163
v_cvt_pk_bf16_f32 v170,v164,v165
v_cvt_pk_bf16_f32 v171,v166,v167
v_lshlrev_b32 v160,16,v168
v_and_b32 v161,0xffff0000,v168
v_lshlrev_b32 v162,16,v169
v_and_b32 v163,0xffff0000,v169
v_lshlrev_b32 v164,16,v170
v_and_b32 v165,0xffff0000,v170
v_lshlrev_b32 v166,16,v171
v_and_b32 v167,0xffff0000,v171
v_pk_add_f32 v[200:201],v[200:201],v[160:161]
v_pk_add_f32 v[202:203],v[202:203],v[162:163]
v_pk_add_f32 v[204:205],v[204:205],v[164:165]
v_pk_add_f32 v[206:207],v[206:207],v[166:167]
v_cvt_pk_bf16_f32 v168,v200,v201
v_cvt_pk_bf16_f32 v169,v202,v203
v_cvt_pk_bf16_f32 v170,v204,v205
v_cvt_pk_bf16_f32 v171,v206,v207
v_lshlrev_b32 v200,16,v168
v_and_b32 v201,0xffff0000,v168
v_lshlrev_b32 v202,16,v169
v_and_b32 v203,0xffff0000,v169
v_lshlrev_b32 v204,16,v170
v_and_b32 v205,0xffff0000,v170
v_lshlrev_b32 v206,16,v171
v_and_b32 v207,0xffff0000,v171
v_readfirstlane_b32 s78,v200
s_nop 1
v_pk_add_f32 v[184:185],v[200:201],s[78:79] op_sel_hi:[1,0] neg_lo:[0,1] neg_hi:[0,1]
v_pk_add_f32 v[186:187],v[202:203],s[78:79] op_sel_hi:[1,0] neg_lo:[0,1] neg_hi:[0,1]
v_pk_add_f32 v[188:189],v[204:205],s[78:79] op_sel_hi:[1,0] neg_lo:[0,1] neg_hi:[0,1]
v_pk_add_f32 v[190:191],v[206:207],s[78:79] op_sel_hi:[1,0] neg_lo:[0,1] neg_hi:[0,1]
v_pk_add_f32 v[192:193],v[184:185],v[186:187]
v_pk_mul_f32 v[194:195],v[184:185],v[184:185]
v_pk_add_f32 v[196:197],v[188:189],v[190:191]
v_pk_fma_f32 v[194:195],v[186:187],v[186:187],v[194:195]
v_pk_add_f32 v[192:193],v[192:193],v[196:197]
v_pk_fma_f32 v[194:195],v[188:189],v[188:189],v[194:195]
v_add_f32 v192,v192,v193
v_pk_fma_f32 v[194:195],v[190:191],v[190:191],v[194:195]
v_add_f32 v194,v194,v195
s_nop 1
v_permlane32_swap_b32 v192,v194
v_add_f32 v192,v192,v194
s_nop 1
v_add_f32_dpp v192,v192,v192 row_ror:8 row_mask:0xf bank_mask:0xf
s_nop 1
v_add_f32_dpp v192,v192,v192 row_ror:4 row_mask:0xf bank_mask:0xf
s_nop 1
v_add_f32_dpp v192,v192,v192 row_ror:2 row_mask:0xf bank_mask:0xf
s_nop 1
v_add_f32_dpp v192,v192,v192 row_ror:1 row_mask:0xf bank_mask:0xf
v_mov_b32 v194,v192
s_nop 1
v_permlane16_swap_b32 v192,v194
v_add_f32 v192,v192,v194
v_mul_f32 v192,0x3b000000,v192
v_mov_b32 v194,v192
s_nop 1
v_permlane32_swap_b32 v192,v194
v_fma_f32 v194,-v192,v192,v194
v_add_f32 v192,s78,v192
v_max_f32 v194,0,v194
v_cvt_pk_bf16_f32 v194,v192,v194
v_lshlrev_b32 v192,16,v194
v_and_b32 v194,0xffff0000,v194
v_add_f32 v194,0x3727c5ac,v194
v_cvt_pk_bf16_f32 v194,v194,v194
v_and_b32 v194,0xffff0000,v194
v_sqrt_f32 v194,v194
v_pk_add_f32 v[184:185],v[200:201],v[192:193] op_sel_hi:[1,0] neg_lo:[0,1] neg_hi:[0,1]
v_pk_add_f32 v[186:187],v[202:203],v[192:193] op_sel_hi:[1,0] neg_lo:[0,1] neg_hi:[0,1]
v_pk_add_f32 v[188:189],v[204:205],v[192:193] op_sel_hi:[1,0] neg_lo:[0,1] neg_hi:[0,1]
v_pk_add_f32 v[190:191],v[206:207],v[192:193] op_sel_hi:[1,0] neg_lo:[0,1] neg_hi:[0,1]
v_cvt_pk_bf16_f32 v194,v194,v194
v_and_b32 v194,0xffff0000,v194
v_rcp_f32 v194,v194
v_cvt_pk_bf16_f32 v172,v184,v185
v_cvt_pk_bf16_f32 v173,v186,v187
v_cvt_pk_bf16_f32 v174,v188,v189
v_cvt_pk_bf16_f32 v175,v190,v191
v_lshlrev_b32 v184,16,v172
v_and_b32 v185,0xffff0000,v172
v_lshlrev_b32 v186,16,v173
v_and_b32 v187,0xffff0000,v173
v_lshlrev_b32 v188,16,v174
v_and_b32 v189,0xffff0000,v174
v_lshlrev_b32 v190,16,v175
v_and_b32 v191,0xffff0000,v175
v_pk_mul_f32 v[184:185],v[184:185],v[194:195] op_sel_hi:[1,0]
v_pk_mul_f32 v[186:187],v[186:187],v[194:195] op_sel_hi:[1,0]
v_pk_mul_f32 v[188:189],v[188:189],v[194:195] op_sel_hi:[1,0]
v_pk_mul_f32 v[190:191],v[190:191],v[194:195] op_sel_hi:[1,0]
v_cvt_pk_bf16_f32 v172,v184,v185
v_cvt_pk_bf16_f32 v173,v186,v187
v_cvt_pk_bf16_f32 v174,v188,v189
v_cvt_pk_bf16_f32 v175,v190,v191
v_lshlrev_b32 v176,16,v172
v_and_b32 v177,0xffff0000,v172
v_lshlrev_b32 v178,16,v173
v_and_b32 v179,0xffff0000,v173
v_lshlrev_b32 v180,16,v174
v_and_b32 v181,0xffff0000,v174
v_lshlrev_b32 v182,16,v175
v_and_b32 v183,0xffff0000,v175
v_pk_add_f32 v[200:201],v[200:201],v[176:177]
v_pk_add_f32 v[202:203],v[202:203],v[178:179]
v_pk_add_f32 v[204:205],v[204:205],v[180:181]
v_pk_add_f32 v[206:207],v[206:207],v[182:183]
v_cvt_pk_bf16_f32 v160,v200,v201
v_cvt_pk_bf16_f32 v161,v202,v203
v_cvt_pk_bf16_f32 v162,v204,v205
v_cvt_pk_bf16_f32 v163,v206,v207
buffer_store_dwordx4 v[160:163],v0,s[8:11],s20 offen sc1
v_lshlrev_b32 v200,16,v160
v_and_b32 v201,0xffff0000,v160
v_lshlrev_b32 v202,16,v161
v_and_b32 v203,0xffff0000,v161
v_lshlrev_b32 v204,16,v162
v_and_b32 v205,0xffff0000,v162
v_lshlrev_b32 v206,16,v163
v_and_b32 v207,0xffff0000,v163
v_readfirstlane_b32 s78,v200
s_nop 1
v_pk_add_f32 v[184:185],v[200:201],s[78:79] op_sel_hi:[1,0] neg_lo:[0,1] neg_hi:[0,1]
v_pk_add_f32 v[186:187],v[202:203],s[78:79] op_sel_hi:[1,0] neg_lo:[0,1] neg_hi:[0,1]
v_pk_add_f32 v[188:189],v[204:205],s[78:79] op_sel_hi:[1,0] neg_lo:[0,1] neg_hi:[0,1]
v_pk_add_f32 v[190:191],v[206:207],s[78:79] op_sel_hi:[1,0] neg_lo:[0,1] neg_hi:[0,1]
v_pk_add_f32 v[192:193],v[184:185],v[186:187]
v_pk_mul_f32 v[194:195],v[184:185],v[184:185]
v_pk_add_f32 v[196:197],v[188:189],v[190:191]
v_pk_fma_f32 v[194:195],v[186:187],v[186:187],v[194:195]
v_pk_add_f32 v[192:193],v[192:193],v[196:197]
v_pk_fma_f32 v[194:195],v[188:189],v[188:189],v[194:195]
v_add_f32 v192,v192,v193
v_pk_fma_f32 v[194:195],v[190:191],v[190:191],v[194:195]
v_add_f32 v194,v194,v195
s_nop 1
v_permlane32_swap_b32 v192,v194
v_add_f32 v192,v192,v194
s_nop 1
v_add_f32_dpp v192,v192,v192 row_ror:8 row_mask:0xf bank_mask:0xf
s_nop 1
v_add_f32_dpp v192,v192,v192 row_ror:4 row_mask:0xf bank_mask:0xf
s_nop 1
v_add_f32_dpp v192,v192,v192 row_ror:2 row_mask:0xf bank_mask:0xf
s_nop 1
v_add_f32_dpp v192,v192,v192 row_ror:1 row_mask:0xf bank_mask:0xf
v_mov_b32 v194,v192
s_nop 1
v_permlane16_swap_b32 v192,v194
v_add_f32 v192,v192,v194
v_mul_f32 v192,0x3b000000,v192
v_mov_b32 v194,v192
s_nop 1
v_permlane32_swap_b32 v192,v194
v_fma_f32 v194,-v192,v192,v194
v_add_f32 v192,s78,v192
v_max_f32 v194,0,v194
v_cvt_pk_bf16_f32 v194,v192,v194
v_lshlrev_b32 v192,16,v194
v_and_b32 v194,0xffff0000,v194
v_add_f32 v194,0x3727c5ac,v194
v_cvt_pk_bf16_f32 v194,v194,v194
v_and_b32 v194,0xffff0000,v194
v_sqrt_f32 v194,v194
v_pk_add_f32 v[184:185],v[200:201],v[192:193] op_sel_hi:[1,0] neg_lo:[0,1] neg_hi:[0,1]
v_pk_add_f32 v[186:187],v[202:203],v[192:193] op_sel_hi:[1,0] neg_lo:[0,1] neg_hi:[0,1]
v_pk_add_f32 v[188:189],v[204:205],v[192:193] op_sel_hi:[1,0] neg_lo:[0,1] neg_hi:[0,1]
v_pk_add_f32 v[190:191],v[206:207],v[192:193] op_sel_hi:[1,0] neg_lo:[0,1] neg_hi:[0,1]
v_cvt_pk_bf16_f32 v194,v194,v194
v_and_b32 v194,0xffff0000,v194
v_rcp_f32 v194,v194
v_cvt_pk_bf16_f32 v164,v184,v185
v_cvt_pk_bf16_f32 v165,v186,v187
v_cvt_pk_bf16_f32 v166,v188,v189
v_cvt_pk_bf16_f32 v167,v190,v191
v_lshlrev_b32 v184,16,v164
v_and_b32 v185,0xffff0000,v164
v_lshlrev_b32 v186,16,v165
v_and_b32 v187,0xffff0000,v165
v_lshlrev_b32 v188,16,v166
v_and_b32 v189,0xffff0000,v166
v_lshlrev_b32 v190,16,v167
v_and_b32 v191,0xffff0000,v167
v_pk_mul_f32 v[184:185],v[184:185],v[194:195] op_sel_hi:[1,0]
v_pk_mul_f32 v[186:187],v[186:187],v[194:195] op_sel_hi:[1,0]
v_pk_mul_f32 v[188:189],v[188:189],v[194:195] op_sel_hi:[1,0]
v_pk_mul_f32 v[190:191],v[190:191],v[194:195] op_sel_hi:[1,0]
v_cvt_pk_bf16_f32 v164,v184,v185
v_cvt_pk_bf16_f32 v165,v186,v187
v_cvt_pk_bf16_f32 v166,v188,v189
v_cvt_pk_bf16_f32 v167,v190,v191
s_add_u32 s20,s19,2097152
buffer_store_dwordx4 v[164:167],v0,s[8:11],s20 offen sc1
v_mov_b32 v20,1
s_lshl_b32 s73,s51,13
s_lshl2_add_u32 s73,s68,s73
s_add_u32 s73,s73,10487552
s_branch L_aa_309
L_ar_338:
ds_read_b128 v[160:163],v23
ds_read_b128 v[164:167],v23 offset:16
v_lshlrev_b32 v200,16,v224
v_and_b32 v201,0xffff0000,v224
v_lshlrev_b32 v202,16,v225
v_and_b32 v203,0xffff0000,v225
v_lshlrev_b32 v204,16,v226
v_and_b32 v205,0xffff0000,v226
v_lshlrev_b32 v206,16,v227
v_and_b32 v207,0xffff0000,v227
s_lshl_b32 s18,s51,5
s_add_u32 s18,s18,s68
s_lshl_b32 s19,s18,10
s_add_u32 s20,s19,4194304
s_waitcnt lgkmcnt(0)
v_cvt_pk_bf16_f32 v168,v160,v161
v_cvt_pk_bf16_f32 v169,v162,v163
v_cvt_pk_bf16_f32 v170,v164,v165
v_cvt_pk_bf16_f32 v171,v166,v167
v_lshlrev_b32 v160,16,v168
v_and_b32 v161,0xffff0000,v168
v_lshlrev_b32 v162,16,v169
v_and_b32 v163,0xffff0000,v169
v_lshlrev_b32 v164,16,v170
v_and_b32 v165,0xffff0000,v170
v_lshlrev_b32 v166,16,v171
v_and_b32 v167,0xffff0000,v171
v_pk_add_f32 v[200:201],v[200:201],v[160:161]
v_pk_add_f32 v[202:203],v[202:203],v[162:163]
v_pk_add_f32 v[204:205],v[204:205],v[164:165]
v_pk_add_f32 v[206:207],v[206:207],v[166:167]
v_cvt_pk_bf16_f32 v168,v200,v201
v_cvt_pk_bf16_f32 v169,v202,v203
v_cvt_pk_bf16_f32 v170,v204,v205
v_cvt_pk_bf16_f32 v171,v206,v207
buffer_store_dwordx4 v[168:171],v0,s[8:11],s20 offen sc1
v_lshlrev_b32 v200,16,v168
v_and_b32 v201,0xffff0000,v168
v_lshlrev_b32 v202,16,v169
v_and_b32 v203,0xffff0000,v169
v_lshlrev_b32 v204,16,v170
v_and_b32 v205,0xffff0000,v170
v_lshlrev_b32 v206,16,v171
v_and_b32 v207,0xffff0000,v171
v_readfirstlane_b32 s78,v200
s_nop 1
v_pk_add_f32 v[184:185],v[200:201],s[78:79] op_sel_hi:[1,0] neg_lo:[0,1] neg_hi:[0,1]
v_pk_add_f32 v[186:187],v[202:203],s[78:79] op_sel_hi:[1,0] neg_lo:[0,1] neg_hi:[0,1]
v_pk_add_f32 v[188:189],v[204:205],s[78:79] op_sel_hi:[1,0] neg_lo:[0,1] neg_hi:[0,1]
v_pk_add_f32 v[190:191],v[206:207],s[78:79] op_sel_hi:[1,0] neg_lo:[0,1] neg_hi:[0,1]
v_pk_add_f32 v[192:193],v[184:185],v[186:187]
v_pk_mul_f32 v[194:195],v[184:185],v[184:185]
v_pk_add_f32 v[196:197],v[188:189],v[190:191]
v_pk_fma_f32 v[194:195],v[186:187],v[186:187],v[194:195]
v_pk_add_f32 v[192:193],v[192:193],v[196:197]
v_pk_fma_f32 v[194:195],v[188:189],v[188:189],v[194:195]
v_add_f32 v192,v192,v193
v_pk_fma_f32 v[194:195],v[190:191],v[190:191],v[194:195]
v_add_f32 v194,v194,v195
s_nop 1
v_permlane32_swap_b32 v192,v194
v_add_f32 v192,v192,v194
s_nop 1
v_add_f32_dpp v192,v192,v192 row_ror:8 row_mask:0xf bank_mask:0xf
s_nop 1
v_add_f32_dpp v192,v192,v192 row_ror:4 row_mask:0xf bank_mask:0xf
s_nop 1
v_add_f32_dpp v192,v192,v192 row_ror:2 row_mask:0xf bank_mask:0xf
s_nop 1
v_add_f32_dpp v192,v192,v192 row_ror:1 row_mask:0xf bank_mask:0xf
v_mov_b32 v194,v192
s_nop 1
v_permlane16_swap_b32 v192,v194
v_add_f32 v192,v192,v194
v_mul_f32 v192,0x3b000000,v192
v_mov_b32 v194,v192
s_nop 1
v_permlane32_swap_b32 v192,v194
v_fma_f32 v194,-v192,v192,v194
v_add_f32 v192,s78,v192
v_max_f32 v194,0,v194
v_cvt_pk_bf16_f32 v194,v192,v194
v_lshlrev_b32 v192,16,v194
v_and_b32 v194,0xffff0000,v194
v_add_f32 v194,0x3727c5ac,v194
v_cvt_pk_bf16_f32 v194,v194,v194
v_and_b32 v194,0xffff0000,v194
v_sqrt_f32 v194,v194
v_pk_add_f32 v[184:185],v[200:201],v[192:193] op_sel_hi:[1,0] neg_lo:[0,1] neg_hi:[0,1]
v_pk_add_f32 v[186:187],v[202:203],v[192:193] op_sel_hi:[1,0] neg_lo:[0,1] neg_hi:[0,1]
v_pk_add_f32 v[188:189],v[204:205],v[192:193] op_sel_hi:[1,0] neg_lo:[0,1] neg_hi:[0,1]
v_pk_add_f32 v[190:191],v[206:207],v[192:193] op_sel_hi:[1,0] neg_lo:[0,1] neg_hi:[0,1]
v_cvt_pk_bf16_f32 v194,v194,v194
v_and_b32 v194,0xffff0000,v194
v_rcp_f32 v194,v194
v_cvt_pk_bf16_f32 v172,v184,v185
v_cvt_pk_bf16_f32 v173,v186,v187
v_cvt_pk_bf16_f32 v174,v188,v189
v_cvt_pk_bf16_f32 v175,v190,v191
v_lshlrev_b32 v184,16,v172
v_and_b32 v185,0xffff0000,v172
v_lshlrev_b32 v186,16,v173
v_and_b32 v187,0xffff0000,v173
v_lshlrev_b32 v188,16,v174
v_and_b32 v189,0xffff0000,v174
v_lshlrev_b32 v190,16,v175
v_and_b32 v191,0xffff0000,v175
v_pk_mul_f32 v[184:185],v[184:185],v[194:195] op_sel_hi:[1,0]
v_pk_mul_f32 v[186:187],v[186:187],v[194:195] op_sel_hi:[1,0]
v_pk_mul_f32 v[188:189],v[188:189],v[194:195] op_sel_hi:[1,0]
v_pk_mul_f32 v[190:191],v[190:191],v[194:195] op_sel_hi:[1,0]
v_cvt_pk_bf16_f32 v172,v184,v185
v_cvt_pk_bf16_f32 v173,v186,v187
v_cvt_pk_bf16_f32 v174,v188,v189
v_cvt_pk_bf16_f32 v175,v190,v191
v_lshlrev_b32 v176,16,v172
v_and_b32 v177,0xffff0000,v172
v_lshlrev_b32 v178,16,v173
v_and_b32 v179,0xffff0000,v173
v_lshlrev_b32 v180,16,v174
v_and_b32 v181,0xffff0000,v174
v_lshlrev_b32 v182,16,v175
v_and_b32 v183,0xffff0000,v175
v_pk_mul_f32 v[236:237],v[176:177],v[228:229]
v_pk_fma_f32 v[236:237],v[178:179],v[230:231],v[236:237]
v_pk_fma_f32 v[236:237],v[180:181],v[232:233],v[236:237]
v_pk_fma_f32 v[236:237],v[182:183],v[234:235],v[236:237]
v_add_f32 v236,v236,v237
s_nop 1
v_add_f32_dpp v236,v236,v236 row_ror:8 row_mask:0xf bank_mask:0xf
s_nop 1
v_add_f32_dpp v236,v236,v236 row_ror:4 row_mask:0xf bank_mask:0xf
s_nop 1
v_add_f32_dpp v236,v236,v236 row_ror:2 row_mask:0xf bank_mask:0xf
s_nop 1
v_add_f32_dpp v236,v236,v236 row_ror:1 row_mask:0xf bank_mask:0xf
v_mov_b32 v237,v236
s_nop 1
v_permlane16_swap_b32 v236,v237
v_add_f32 v236,v236,v237
v_mov_b32 v237,v236
s_nop 1
v_permlane32_swap_b32 v236,v237
v_add_f32 v236,v236,v237
v_cvt_pk_bf16_f32 v236,v236,v236
v_and_b32 v236,0xffff0000,v236
v_ashrrev_i32 v237,31,v236
v_or_b32 v237,0x80000000,v237
v_xor_b32 v236,v236,v237
v_and_b32 v236,0xffff0000,v236
s_sub_u32 s20,4095,s18
v_or_b32 v20,s20,v236
s_lshl_b32 s20,s51,13
s_lshl2_add_u32 s20,s68,s20
s_add_u32 s20,s20,10485760
buffer_store_dword v20,v254,s[8:11],s20 offen sc1
s_branch L_aa_309
L_ar_339:
s_bitcmp1_b32 s46,0
s_cbranch_scc1 L_aa_309
ds_read_b128 v[160:163],v23
ds_read_b128 v[164:167],v23 offset:16
v_lshlrev_b32 v200,16,v224
v_and_b32 v201,0xffff0000,v224
v_lshlrev_b32 v202,16,v225
v_and_b32 v203,0xffff0000,v225
v_lshlrev_b32 v204,16,v226
v_and_b32 v205,0xffff0000,v226
v_lshlrev_b32 v206,16,v227
v_and_b32 v207,0xffff0000,v227
v_readfirstlane_b32 s22,v246
s_cmp_eq_u32 s22,0
s_cbranch_scc1 L_ag_340
L_agb_341:
s_lshl_b32 s18,s51,5
s_add_u32 s18,s18,s68
s_lshl_b32 s19,s18,10
s_add_u32 s20,s19,6291456
s_waitcnt lgkmcnt(0)
v_cvt_pk_bf16_f32 v168,v160,v161
v_cvt_pk_bf16_f32 v169,v162,v163
v_cvt_pk_bf16_f32 v170,v164,v165
v_cvt_pk_bf16_f32 v171,v166,v167
v_lshlrev_b32 v160,16,v168
v_and_b32 v161,0xffff0000,v168
v_lshlrev_b32 v162,16,v169
v_and_b32 v163,0xffff0000,v169
v_lshlrev_b32 v164,16,v170
v_and_b32 v165,0xffff0000,v170
v_lshlrev_b32 v166,16,v171
v_and_b32 v167,0xffff0000,v171
v_pk_add_f32 v[200:201],v[200:201],v[160:161]
v_pk_add_f32 v[202:203],v[202:203],v[162:163]
v_pk_add_f32 v[204:205],v[204:205],v[164:165]
v_pk_add_f32 v[206:207],v[206:207],v[166:167]
v_cvt_pk_bf16_f32 v168,v200,v201
v_cvt_pk_bf16_f32 v169,v202,v203
v_cvt_pk_bf16_f32 v170,v204,v205
v_cvt_pk_bf16_f32 v171,v206,v207
buffer_store_dwordx4 v[168:171],v0,s[8:11],s20 offen sc1
v_lshlrev_b32 v200,16,v168
v_and_b32 v201,0xffff0000,v168
v_lshlrev_b32 v202,16,v169
v_and_b32 v203,0xffff0000,v169
v_lshlrev_b32 v204,16,v170
v_and_b32 v205,0xffff0000,v170
v_lshlrev_b32 v206,16,v171
v_and_b32 v207,0xffff0000,v171
v_readfirstlane_b32 s78,v200
s_nop 1
v_pk_add_f32 v[184:185],v[200:201],s[78:79] op_sel_hi:[1,0] neg_lo:[0,1] neg_hi:[0,1]
v_pk_add_f32 v[186:187],v[202:203],s[78:79] op_sel_hi:[1,0] neg_lo:[0,1] neg_hi:[0,1]
v_pk_add_f32 v[188:189],v[204:205],s[78:79] op_sel_hi:[1,0] neg_lo:[0,1] neg_hi:[0,1]
v_pk_add_f32 v[190:191],v[206:207],s[78:79] op_sel_hi:[1,0] neg_lo:[0,1] neg_hi:[0,1]
v_pk_add_f32 v[192:193],v[184:185],v[186:187]
v_pk_mul_f32 v[194:195],v[184:185],v[184:185]
v_pk_add_f32 v[196:197],v[188:189],v[190:191]
v_pk_fma_f32 v[194:195],v[186:187],v[186:187],v[194:195]
v_pk_add_f32 v[192:193],v[192:193],v[196:197]
v_pk_fma_f32 v[194:195],v[188:189],v[188:189],v[194:195]
v_add_f32 v192,v192,v193
v_pk_fma_f32 v[194:195],v[190:191],v[190:191],v[194:195]
v_add_f32 v194,v194,v195
s_nop 1
v_permlane32_swap_b32 v192,v194
v_add_f32 v192,v192,v194
s_nop 1
v_add_f32_dpp v192,v192,v192 row_ror:8 row_mask:0xf bank_mask:0xf
s_nop 1
v_add_f32_dpp v192,v192,v192 row_ror:4 row_mask:0xf bank_mask:0xf
s_nop 1
v_add_f32_dpp v192,v192,v192 row_ror:2 row_mask:0xf bank_mask:0xf
s_nop 1
v_add_f32_dpp v192,v192,v192 row_ror:1 row_mask:0xf bank_mask:0xf
v_mov_b32 v194,v192
s_nop 1
v_permlane16_swap_b32 v192,v194
v_add_f32 v192,v192,v194
v_mul_f32 v192,0x3b000000,v192
v_mov_b32 v194,v192
s_nop 1
v_permlane32_swap_b32 v192,v194
v_fma_f32 v194,-v192,v192,v194
v_add_f32 v192,s78,v192
v_max_f32 v194,0,v194
v_cvt_pk_bf16_f32 v194,v192,v194
v_lshlrev_b32 v192,16,v194
v_and_b32 v194,0xffff0000,v194
v_add_f32 v194,0x3727c5ac,v194
v_cvt_pk_bf16_f32 v194,v194,v194
v_and_b32 v194,0xffff0000,v194
v_sqrt_f32 v194,v194
v_pk_add_f32 v[184:185],v[200:201],v[192:193] op_sel_hi:[1,0] neg_lo:[0,1] neg_hi:[0,1]
v_pk_add_f32 v[186:187],v[202:203],v[192:193] op_sel_hi:[1,0] neg_lo:[0,1] neg_hi:[0,1]
v_pk_add_f32 v[188:189],v[204:205],v[192:193] op_sel_hi:[1,0] neg_lo:[0,1] neg_hi:[0,1]
v_pk_add_f32 v[190:191],v[206:207],v[192:193] op_sel_hi:[1,0] neg_lo:[0,1] neg_hi:[0,1]
v_cvt_pk_bf16_f32 v194,v194,v194
v_and_b32 v194,0xffff0000,v194
v_rcp_f32 v194,v194
v_cvt_pk_bf16_f32 v172,v184,v185
v_cvt_pk_bf16_f32 v173,v186,v187
v_cvt_pk_bf16_f32 v174,v188,v189
v_cvt_pk_bf16_f32 v175,v190,v191
v_lshlrev_b32 v184,16,v172
v_and_b32 v185,0xffff0000,v172
v_lshlrev_b32 v186,16,v173
v_and_b32 v187,0xffff0000,v173
v_lshlrev_b32 v188,16,v174
v_and_b32 v189,0xffff0000,v174
v_lshlrev_b32 v190,16,v175
v_and_b32 v191,0xffff0000,v175
v_pk_mul_f32 v[184:185],v[184:185],v[194:195] op_sel_hi:[1,0]
v_pk_mul_f32 v[186:187],v[186:187],v[194:195] op_sel_hi:[1,0]
v_pk_mul_f32 v[188:189],v[188:189],v[194:195] op_sel_hi:[1,0]
v_pk_mul_f32 v[190:191],v[190:191],v[194:195] op_sel_hi:[1,0]
v_cvt_pk_bf16_f32 v172,v184,v185
v_cvt_pk_bf16_f32 v173,v186,v187
v_cvt_pk_bf16_f32 v174,v188,v189
v_cvt_pk_bf16_f32 v175,v190,v191
v_lshlrev_b32 v176,16,v172
v_and_b32 v177,0xffff0000,v172
v_lshlrev_b32 v178,16,v173
v_and_b32 v179,0xffff0000,v173
v_lshlrev_b32 v180,16,v174
v_and_b32 v181,0xffff0000,v174
v_lshlrev_b32 v182,16,v175
v_and_b32 v183,0xffff0000,v175
v_pk_add_f32 v[200:201],v[200:201],v[176:177]
v_pk_add_f32 v[202:203],v[202:203],v[178:179]
v_pk_add_f32 v[204:205],v[204:205],v[180:181]
v_pk_add_f32 v[206:207],v[206:207],v[182:183]
v_cvt_pk_bf16_f32 v160,v200,v201
v_cvt_pk_bf16_f32 v161,v202,v203
v_cvt_pk_bf16_f32 v162,v204,v205
v_cvt_pk_bf16_f32 v163,v206,v207
buffer_store_dwordx4 v[160:163],v0,s[12:15],s19 offen sc1
v_pk_mul_f32 v[236:237],v[176:177],v[228:229]
v_pk_fma_f32 v[236:237],v[178:179],v[230:231],v[236:237]
v_pk_fma_f32 v[236:237],v[180:181],v[232:233],v[236:237]
v_pk_fma_f32 v[236:237],v[182:183],v[234:235],v[236:237]
v_add_f32 v236,v236,v237
s_nop 1
v_add_f32_dpp v236,v236,v236 row_ror:8 row_mask:0xf bank_mask:0xf
s_nop 1
v_add_f32_dpp v236,v236,v236 row_ror:4 row_mask:0xf bank_mask:0xf
s_nop 1
v_add_f32_dpp v236,v236,v236 row_ror:2 row_mask:0xf bank_mask:0xf
s_nop 1
v_add_f32_dpp v236,v236,v236 row_ror:1 row_mask:0xf bank_mask:0xf
v_mov_b32 v237,v236
s_nop 1
v_permlane16_swap_b32 v236,v237
v_add_f32 v236,v236,v237
v_mov_b32 v237,v236
s_nop 1
v_permlane32_swap_b32 v236,v237
v_add_f32 v236,v236,v237
v_cvt_pk_bf16_f32 v236,v236,v236
v_and_b32 v236,0xffff0000,v236
v_ashrrev_i32 v237,31,v236
v_or_b32 v237,0x80000000,v237
v_xor_b32 v236,v236,v237
v_and_b32 v236,0xffff0000,v236
s_sub_u32 s20,4095,s18
v_or_b32 v20,s20,v236
s_lshl_b32 s73,s51,13
s_lshl2_add_u32 s73,s68,s73
s_add_u32 s73,s73,10485760
s_add_u32 s73,s73,s86
L_aa_309:
s_cmp_eq_u32 s27,1
s_cbranch_scc1 L_ad_342
s_cmp_eq_u32 s27,0
s_cbranch_scc1 L_aa_310
s_cmp_ge_u32 s77,64
s_cbranch_scc1 L_aa_313
L_aa_311:
s_waitcnt vmcnt(0)
buffer_store_dword v20,off,s[8:11],s73 sc1
s_mov_b32 s73,0x80000000
v_mov_b32 v18,0
s_mov_b32 s27,0
L_aw_343:
v_cmp_eq_u32 vcc,0,v18
s_cbranch_vccz L_awd_344
buffer_load_dword v18,v19,s[8:11],0 offen sc1
s_sub_u32 s49,s49,1
s_cbranch_scc1 L_abort2
s_waitcnt vmcnt(0)
s_branch L_aw_343
L_awd_344:
s_mov_b32 s64,s70
s_mov_b32 s65,s71
s_and_b32 s57,s46,1
s_mul_i32 s58,s57,12288
s_add_u32 s64,s64,s58
s_lshl_b32 s57,s57,11
s_add_u32 s65,s65,s57
s_and_b32 s59,s50,2048
s_lshl_b32 s59,s59,4
s_xor_b32 s60,s67,65536
s_add_u32 s59,s59,s60
s_add_u32 s58,s58,s59
s_add_u32 s57,s57,s59
s_add_u32 m0,s58,0
s_nop 0
buffer_load_dwordx4 v0,s[8:11],s64 offen offset:0 sc1 lds
buffer_load_dwordx4 v0,s[8:11],s64 offen offset:1024 sc1 lds
buffer_load_dwordx4 v0,s[8:11],s64 offen offset:2048 sc1 lds
buffer_load_dwordx4 v0,s[8:11],s64 offen offset:3072 sc1 lds
s_add_u32 m0,s58,4096
s_add_u32 s64,s64,4096
buffer_load_dwordx4 v0,s[8:11],s64 offen offset:0 sc1 lds
buffer_load_dwordx4 v0,s[8:11],s64 offen offset:1024 sc1 lds
buffer_load_dwordx4 v0,s[8:11],s64 offen offset:2048 sc1 lds
buffer_load_dwordx4 v0,s[8:11],s64 offen offset:3072 sc1 lds
s_add_u32 m0,s58,8192
s_add_u32 s64,s64,4096
buffer_load_dwordx4 v0,s[8:11],s64 offen offset:0 sc1 lds
buffer_load_dwordx4 v0,s[8:11],s64 offen offset:1024 sc1 lds
buffer_load_dwordx4 v0,s[8:11],s64 offen offset:2048 sc1 lds
buffer_load_dwordx4 v0,s[8:11],s64 offen offset:3072 sc1 lds
s_add_u32 m0,s57,24576
s_nop 0
buffer_load_dwordx4 v0,s[8:11],s65 offen offset:0 sc1 lds
buffer_load_dwordx4 v0,s[8:11],s65 offen offset:1024 sc1 lds
v_lshrrev_b32 v244,4,v1
s_sub_u32 s56,s77,8
v_add_u32 v244,s56,v244
v_max_i32 v244,0,v244
v_lshl_add_u32 v244,v244,13,v21
buffer_load_dwordx2 v[242:243],v244,s[8:11],0 offen sc1
s_waitcnt vmcnt(0) lgkmcnt(0)
s_barrier
s_xor_b32 s67,s67,65536
s_and_b32 s56,s50,2048
s_lshl_b32 s56,s56,4
s_add_u32 s56,s56,s67
v_add_u32 v2,s56,v0
v_add_u32 v239,s56,v253
s_and_b32 s56,s50,1024
s_lshl_b32 s56,s56,2
v_add_u32 v238,s56,v2
s_mov_b32 s76,s71
s_mov_b32 s53,s77
ds_read_b128 v[24:27],v238 offset:16384
ds_read_b128 v[40:43],v2 offset:0
ds_read_b128 v[56:59],v2 offset:4096
ds_read_b128 v[28:31],v238 offset:17408
ds_read_b128 v[44:47],v2 offset:1024
ds_read_b128 v[60:63],v2 offset:5120
ds_read_b128 v[32:35],v238 offset:18432
ds_read_b128 v[48:51],v2 offset:2048
ds_read_b128 v[64:67],v2 offset:6144
ds_read_b128 v[36:39],v238 offset:19456
ds_read_b128 v[52:55],v2 offset:3072
ds_read_b128 v[68:71],v2 offset:7168
s_waitcnt lgkmcnt(9)
v_mfma_f32_16x16x32_bf16 v[128:131],v[40:43],v[24:27],v[8:11]
ds_read_b128 v[72:75],v2 offset:24576
v_mfma_f32_16x16x32_bf16 v[132:135],v[56:59],v[24:27],v[12:15]
ds_read_b128 v[76:79],v2 offset:25600
s_waitcnt lgkmcnt(8)
v_mfma_f32_16x16x32_bf16 v[128:131],v[44:47],v[28:31],v[128:131]
ds_read_b128 v[80:83],v2 offset:26624
v_mfma_f32_16x16x32_bf16 v[132:135],v[60:63],v[28:31],v[132:135]
ds_read_b128 v[84:87],v2 offset:27648
s_waitcnt lgkmcnt(7)
v_mfma_f32_16x16x32_bf16 v[128:131],v[48:51],v[32:35],v[128:131]
ds_read_b64 v[120:121],v239 offset:24576
v_mfma_f32_16x16x32_bf16 v[132:135],v[64:67],v[32:35],v[132:135]
ds_read_b64 v[122:123],v239 offset:25600
s_waitcnt lgkmcnt(6)
v_mfma_f32_16x16x32_bf16 v[128:131],v[52:55],v[36:39],v[128:131]
ds_read_b64 v[124:125],v239 offset:26624
v_mfma_f32_16x16x32_bf16 v[132:135],v[68:71],v[36:39],v[132:135]
ds_read_b64 v[126:127],v239 offset:27648
s_waitcnt lgkmcnt(4)
v_mfma_f32_16x16x32_bf16 v[136:139],v[72:75],v[24:27],0
ds_read_b128 v[88:91],v2 offset:8192
ds_read_b128 v[92:95],v2 offset:9216
v_mfma_f32_16x16x32_bf16 v[136:139],v[76:79],v[28:31],v[136:139]
ds_read_b128 v[96:99],v2 offset:10240
ds_read_b128 v[100:103],v2 offset:11264
v_mfma_f32_16x16x32_bf16 v[136:139],v[80:83],v[32:35],v[136:139]
ds_read_b128 v[104:107],v2 offset:12288
ds_read_b128 v[108:111],v2 offset:13312
v_mfma_f32_16x16x32_bf16 v[136:139],v[84:87],v[36:39],v[136:139]
ds_read_b128 v[112:115],v2 offset:14336
ds_read_b128 v[116:119],v2 offset:15360
s_waitcnt lgkmcnt(0)
s_cmp_eq_u32 s30,0
s_cbranch_scc1 L_aa_312
s_cmp_lg_u32 s86,1536
s_cbranch_scc1 L_ae_345
s_mov_b32 s77,s35
s_mov_b32 s30,0
s_lshl_b32 s56,s77,5
s_add_u32 s56,s56,s68
s_mul_i32 s70,s56,24576
s_lshl_b32 s71,s56,12
s_lshl_b32 s59,s77,13
s_lshl2_add_u32 s59,s68,s59
s_add_u32 s59,s59,10485760
s_buffer_load_dword s32,s[8:11],s59
s_mov_b32 s33,1
s_add_u32 s70,s70,100663296
s_add_u32 s71,s71,41943040
v_mov_b32 v19,s59
s_branch L_af_346
L_ae_345:
s_ff1_i32_b64 s77,s[84:85]
s_bitset0_b64 s[84:85],s77
s_min_u32 s77,s77,64
s_lshr_b32 s61,s55,5
s_lshl_b32 s56,s77,5
s_add_u32 s56,s56,s68
s_mul_i32 s70,s56,24576
s_lshl_b32 s71,s56,12
s_lshl_b32 s59,s77,13
s_lshl2_add_u32 s59,s68,s59
s_add_u32 s59,s59,10486144
s_cmp_lt_u32 s77,s61
s_cselect_b32 s57,0,16777216
s_mov_b32 s60,s59
s_buffer_load_dword s33,s[8:11],s60
s_add_u32 s71,s71,s57
s_add_u32 s71,s71,58720256
s_cmp_eq_u32 s77,s61
s_cselect_b32 s57,50331648,0
s_cselect_b32 s58,1536,0
s_add_u32 s59,s59,s58
s_buffer_load_dword s32,s[8:11],s59
s_add_u32 s70,s70,s57
s_add_u32 s70,s70,150994944
v_mov_b32 v19,s59
v_writelane_b32 v19,s60,1
L_af_346:
v_max3_u32 v238,v72,v73,v74
v_max3_u32 v238,v74,v75,v238
v_max3_u32 v238,v76,v77,v238
v_max3_u32 v238,v78,v79,v238
v_max3_u32 v238,v80,v81,v238
v_max3_u32 v238,v82,v83,v238
v_max3_u32 v238,v84,v85,v238
v_max3_u32 v238,v86,v87,v238
v_max3_u32 v238,v120,v121,v238
v_max3_u32 v238,v122,v123,v238
v_max3_u32 v238,v124,v125,v238
v_max3_u32 v238,v126,v127,v238
v_cmp_eq_u32 vcc,-1,v238
s_cbranch_vccnz L_ac_347
L_acb_348:
v_max3_f32 v238,v128,v129,v130
v_max3_f32 v239,v131,v132,v133
v_max3_f32 v238,v134,v135,v238
v_max3_f32 v239,v138,v139,v239
v_max_f32 v238,v238,v239
v_max_f32 v239,v238,v239
v_pk_mul_f32 v[128:129],v[128:129],v[152:153] op_sel_hi:[1,0]
v_pk_mul_f32 v[130:131],v[130:131],v[152:153] op_sel_hi:[1,0]
v_permlane16_swap_b32 v238,v239
v_max_f32 v238,v238,v239
v_max_f32 v239,v238,v239
v_pk_mul_f32 v[132:133],v[132:133],v[152:153] op_sel_hi:[1,0]
v_pk_mul_f32 v[134:135],v[134:135],v[152:153] op_sel_hi:[1,0]
v_permlane32_swap_b32 v238,v239
v_max_f32 v238,v238,v239
v_mul_f32 v238,v152,v238
v_pk_mul_f32 v[138:139],v[138:139],v[152:153] op_sel_hi:[1,0]
v_pk_add_f32 v[128:129],v[128:129],v[238:239] op_sel_hi:[1,0] neg_lo:[0,1] neg_hi:[0,1]
v_pk_add_f32 v[130:131],v[130:131],v[238:239] op_sel_hi:[1,0] neg_lo:[0,1] neg_hi:[0,1]
v_pk_add_f32 v[132:133],v[132:133],v[238:239] op_sel_hi:[1,0] neg_lo:[0,1] neg_hi:[0,1]
v_pk_add_f32 v[134:135],v[134:135],v[238:239] op_sel_hi:[1,0] neg_lo:[0,1] neg_hi:[0,1]
v_pk_add_f32 v[138:139],v[138:139],v[238:239] op_sel_hi:[1,0] neg_lo:[0,1] neg_hi:[0,1]
v_exp_f32 v128,v128
v_exp_f32 v129,v129
v_exp_f32 v130,v130
v_exp_f32 v131,v131
v_exp_f32 v132,v132
v_exp_f32 v133,v133
v_exp_f32 v134,v134
v_exp_f32 v135,v135
v_exp_f32 v138,v138
v_exp_f32 v139,v139
v_pk_add_f32 v[148:149],v[128:129],v[130:131]
v_pk_add_f32 v[150:151],v[132:133],v[134:135]
v_pk_add_f32 v[148:149],v[148:149],v[138:139]
v_pk_add_f32 v[148:149],v[148:149],v[150:151]
v_add_f32 v150,v148,v149
v_add_f32 v151,v148,v149
s_nop 1
v_permlane16_swap_b32 v150,v151
v_add_f32 v148,v150,v151
v_add_f32 v149,v150,v151
s_nop 1
v_permlane32_swap_b32 v148,v149
v_add_f32 v148,v148,v149
v_rcp_f32 v148,v148
s_nop 0
v_pk_mul_f32 v[138:139],v[138:139],v[148:149] op_sel_hi:[1,0]
v_pk_mul_f32 v[128:129],v[128:129],v[148:149] op_sel_hi:[1,0]
v_pk_mul_f32 v[130:131],v[130:131],v[148:149] op_sel_hi:[1,0]
v_pk_mul_f32 v[132:133],v[132:133],v[148:149] op_sel_hi:[1,0]
v_pk_mul_f32 v[134:135],v[134:135],v[148:149] op_sel_hi:[1,0]
v_cvt_pk_bf16_f32 v144,v138,v139
v_cvt_pk_bf16_f32 v147,v138,v139
s_nop 0
v_mfma_f32_16x16x16_bf16 v[24:27],v[120:121],v[144:145],0
v_cvt_pk_bf16_f32 v140,v128,v129
v_mfma_f32_16x16x16_bf16 v[28:31],v[120:121],v[146:147],0
v_cvt_pk_bf16_f32 v141,v130,v131
v_mfma_f32_16x16x16_bf16 v[32:35],v[122:123],v[144:145],0
v_cvt_pk_bf16_f32 v142,v132,v133
v_mfma_f32_16x16x16_bf16 v[36:39],v[122:123],v[146:147],0
v_cvt_pk_bf16_f32 v143,v134,v135
v_mfma_f32_16x16x16_bf16 v[40:43],v[124:125],v[144:145],0
v_mfma_f32_16x16x16_bf16 v[44:47],v[124:125],v[146:147],0
v_mfma_f32_16x16x16_bf16 v[48:51],v[126:127],v[144:145],0
v_mfma_f32_16x16x16_bf16 v[52:55],v[126:127],v[146:147],0
v_mfma_f32_16x16x32_bf16 v[24:27],v[88:91],v[140:143],v[24:27]
v_mfma_f32_16x16x32_bf16 v[28:31],v[92:95],v[140:143],v[28:31]
v_mfma_f32_16x16x32_bf16 v[32:35],v[96:99],v[140:143],v[32:35]
v_mfma_f32_16x16x32_bf16 v[36:39],v[100:103],v[140:143],v[36:39]
v_cvt_pk_bf16_f32 v72,v24,v28
v_cvt_pk_bf16_f32 v73,v25,v29
v_mfma_f32_16x16x32_bf16 v[40:43],v[104:107],v[140:143],v[40:43]
v_cvt_pk_bf16_f32 v74,v26,v30
v_cvt_pk_bf16_f32 v75,v27,v31
v_mfma_f32_16x16x32_bf16 v[44:47],v[108:111],v[140:143],v[44:47]
ds_write_b128 v3,v[72:75] offset:0
v_cvt_pk_bf16_f32 v76,v32,v36
v_cvt_pk_bf16_f32 v77,v33,v37
v_mfma_f32_16x16x32_bf16 v[48:51],v[112:115],v[140:143],v[48:51]
v_cvt_pk_bf16_f32 v78,v34,v38
v_cvt_pk_bf16_f32 v79,v35,v39
v_mfma_f32_16x16x32_bf16 v[52:55],v[116:119],v[140:143],v[52:55]
ds_write_b128 v3,v[76:79] offset:1024
v_cvt_pk_bf16_f32 v80,v40,v44
v_cvt_pk_bf16_f32 v81,v41,v45
v_cvt_pk_bf16_f32 v82,v42,v46
v_cvt_pk_bf16_f32 v83,v43,v47
ds_write_b128 v3,v[80:83] offset:2048
s_nop 1
v_cvt_pk_bf16_f32 v84,v48,v52
v_cvt_pk_bf16_f32 v85,v49,v53
v_cvt_pk_bf16_f32 v86,v50,v54
v_cvt_pk_bf16_f32 v87,v51,v55
ds_write_b128 v3,v[84:87] offset:3072
s_waitcnt lgkmcnt(0)
s_barrier
L_ad_342:
s_mov_b32 s51,s53
s_mov_b32 s31,1
s_branch L_aa_304
L_aa_310:
s_waitcnt vmcnt(0)
buffer_store_dword v20,off,s[8:11],s73 sc1
s_mov_b32 s73,0x80000000
L_aa_312:
s_mov_b32 s51,s53
s_mov_b32 s31,0
s_add_u32 s35,s53,4
s_cmp_lt_u32 s53,5
s_cbranch_scc1 L_ab_349
s_cmp_ge_u32 s53,62
s_cbranch_scc1 L_am_351
L_aw_352:
v_min_u32 v239,v242,v243
v_cmp_eq_u32 vcc,0,v239
s_cbranch_vccz L_awd_353
s_sleep 4
buffer_load_dwordx2 v[242:243],v244,s[8:11],0 offen sc1
s_sub_u32 s49,s49,1
s_cbranch_scc1 L_abort2
s_waitcnt vmcnt(0)
s_branch L_aw_352
L_awd_353:
v_max_u32 v242,v242,v243
s_nop 1
v_max_u32_dpp v242,v242,v242 row_ror:8 row_mask:0xf bank_mask:0xf
s_nop 1
v_max_u32_dpp v242,v242,v242 row_ror:4 row_mask:0xf bank_mask:0xf
s_nop 1
v_max_u32_dpp v242,v242,v242 row_ror:2 row_mask:0xf bank_mask:0xf
s_nop 1
v_max_u32_dpp v242,v242,v242 row_ror:1 row_mask:0xf bank_mask:0xf
v_mov_b32 v243,v242
s_nop 1
v_permlane16_swap_b32 v242,v243
v_max_u32 v242,v242,v243
v_mov_b32 v243,v242
s_nop 1
v_permlane32_swap_b32 v242,v243
v_max_u32 v242,v242,v243
s_nop 0
v_readfirstlane_b32 s56,v242
v_readlane_b32 s57,v255,s53
s_max_u32 s75,s75,s56
s_bitcmp0_b64 s[42:43],s53
s_cbranch_scc1 L_ab_349
s_mov_b32 s77,s36
s_and_b32 s55,s75,0x7ff
s_sub_u32 s55,2047,s55
s_cmp_lt_u32 s75,s57
s_cselect_b32 s55,4095,s55
s_lshr_b32 s61,s55,5
s_mov_b32 s30,1
s_lshl_b32 s56,s77,5
s_add_u32 s56,s56,s68
s_mul_i32 s70,s56,24576
s_lshl_b32 s71,s56,12
s_lshl_b32 s59,s77,13
s_lshl2_add_u32 s59,s68,s59
s_add_u32 s59,s59,10486144
s_cmp_lt_u32 s77,s61
s_cselect_b32 s57,0,16777216
s_mov_b32 s60,s59
s_add_u32 s71,s71,s57
s_add_u32 s71,s71,58720256
s_cmp_eq_u32 s77,s61
s_cselect_b32 s57,50331648,0
s_cselect_b32 s58,1536,0
s_add_u32 s59,s59,s58
s_add_u32 s70,s70,s57
s_add_u32 s70,s70,150994944
v_mov_b32 v19,s59
v_writelane_b32 v19,s60,1
s_branch L_aj_350
L_ab_349:
s_mov_b32 s77,s35
s_mov_b32 s30,0
s_lshl_b32 s56,s77,5
s_add_u32 s56,s56,s68
s_mul_i32 s70,s56,24576
s_lshl_b32 s71,s56,12
s_lshl_b32 s59,s77,13
s_lshl2_add_u32 s59,s68,s59
s_add_u32 s59,s59,10485760
s_mov_b32 s33,1
s_add_u32 s70,s70,100663296
s_add_u32 s71,s71,41943040
v_mov_b32 v19,s59
L_aj_350:
buffer_load_dword v18,v19,s[8:11],0 offen sc1
s_waitcnt vmcnt(2)
v_mfma_f32_16x16x32_bf16 v[136:139],v[72:75],v[24:27],0
v_max3_u32 v238,v72,v73,v74
v_max3_u32 v238,v74,v75,v238
v_mfma_f32_16x16x32_bf16 v[136:139],v[76:79],v[28:31],v[136:139]
v_max3_u32 v238,v76,v77,v238
v_max3_u32 v238,v78,v79,v238
v_mfma_f32_16x16x32_bf16 v[136:139],v[80:83],v[32:35],v[136:139]
v_max3_u32 v238,v80,v81,v238
v_max3_u32 v238,v82,v83,v238
v_mfma_f32_16x16x32_bf16 v[136:139],v[84:87],v[36:39],v[136:139]
v_max3_u32 v238,v84,v85,v238
v_max3_u32 v238,v86,v87,v238
v_max3_u32 v238,v120,v121,v238
v_max3_u32 v238,v122,v123,v238
v_max3_u32 v238,v124,v125,v238
v_max3_u32 v238,v126,v127,v238
v_cmp_eq_u32 vcc,-1,v238
s_cbranch_vccz L_aa_315
L_aa_314:
buffer_load_dwordx4 v[72:75],v0,s[8:11],s76 offen offset:0 sc1
buffer_load_dwordx4 v[76:79],v0,s[8:11],s76 offen offset:1024 sc1
buffer_load_dwordx4 v[80:83],v0,s[8:11],s76 offen offset:2048 sc1
buffer_load_dwordx4 v[84:87],v0,s[8:11],s76 offen offset:3072 sc1
buffer_load_dwordx2 v[120:121],v253,s[8:11],s76 offen offset:0 sc1
buffer_load_dwordx2 v[122:123],v253,s[8:11],s76 offen offset:1024 sc1
buffer_load_dwordx2 v[124:125],v253,s[8:11],s76 offen offset:2048 sc1
buffer_load_dwordx2 v[126:127],v253,s[8:11],s76 offen offset:3072 sc1
buffer_load_dword v18,v19,s[8:11],0 offen sc1
s_sub_u32 s49,s49,1
s_cbranch_scc1 L_abort2
s_waitcnt vmcnt(8)
v_mfma_f32_16x16x32_bf16 v[136:139],v[72:75],v[24:27],0
v_max3_u32 v238,v72,v73,v74
v_max3_u32 v238,v74,v75,v238
s_waitcnt vmcnt(7)
v_mfma_f32_16x16x32_bf16 v[136:139],v[76:79],v[28:31],v[136:139]
v_max3_u32 v238,v76,v77,v238
v_max3_u32 v238,v78,v79,v238
s_waitcnt vmcnt(6)
v_mfma_f32_16x16x32_bf16 v[136:139],v[80:83],v[32:35],v[136:139]
v_max3_u32 v238,v80,v81,v238
v_max3_u32 v238,v82,v83,v238
s_waitcnt vmcnt(5)
v_mfma_f32_16x16x32_bf16 v[136:139],v[84:87],v[36:39],v[136:139]
v_max3_u32 v238,v84,v85,v238
v_max3_u32 v238,v86,v87,v238
s_waitcnt vmcnt(1)
v_max3_u32 v238,v120,v121,v238
v_max3_u32 v238,v122,v123,v238
v_max3_u32 v238,v124,v125,v238
v_max3_u32 v238,v126,v127,v238
v_cmp_eq_u32 vcc,-1,v238
s_cbranch_vccnz L_aa_314
L_aa_315:
s_cmp_lg_u32 s27,3
s_cbranch_scc1 L_ai_354
v_max3_f32 v238,v128,v129,v130
v_max3_f32 v239,v131,v132,v133
v_max3_f32 v238,v134,v135,v238
v_max3_f32 v239,v138,v139,v239
v_max_f32 v238,v238,v239
v_max_f32 v239,v238,v239
v_pk_mul_f32 v[128:129],v[128:129],v[152:153] op_sel_hi:[1,0]
v_pk_mul_f32 v[130:131],v[130:131],v[152:153] op_sel_hi:[1,0]
v_permlane16_swap_b32 v238,v239
v_max_f32 v238,v238,v239
v_max_f32 v239,v238,v239
v_pk_mul_f32 v[132:133],v[132:133],v[152:153] op_sel_hi:[1,0]
v_pk_mul_f32 v[134:135],v[134:135],v[152:153] op_sel_hi:[1,0]
v_permlane32_swap_b32 v238,v239
v_max_f32 v238,v238,v239
v_mul_f32 v238,v152,v238
v_pk_mul_f32 v[138:139],v[138:139],v[152:153] op_sel_hi:[1,0]
buffer_load_dword v17,v16,s[8:11],s87 offen sc1
v_pk_add_f32 v[128:129],v[128:129],v[238:239] op_sel_hi:[1,0] neg_lo:[0,1] neg_hi:[0,1]
v_pk_add_f32 v[130:131],v[130:131],v[238:239] op_sel_hi:[1,0] neg_lo:[0,1] neg_hi:[0,1]
v_pk_add_f32 v[132:133],v[132:133],v[238:239] op_sel_hi:[1,0] neg_lo:[0,1] neg_hi:[0,1]
v_pk_add_f32 v[134:135],v[134:135],v[238:239] op_sel_hi:[1,0] neg_lo:[0,1] neg_hi:[0,1]
v_pk_add_f32 v[138:139],v[138:139],v[238:239] op_sel_hi:[1,0] neg_lo:[0,1] neg_hi:[0,1]
v_exp_f32 v128,v128
v_exp_f32 v129,v129
v_exp_f32 v130,v130
v_exp_f32 v131,v131
v_exp_f32 v132,v132
v_exp_f32 v133,v133
v_exp_f32 v134,v134
v_exp_f32 v135,v135
v_exp_f32 v138,v138
v_exp_f32 v139,v139
v_pk_add_f32 v[148:149],v[128:129],v[130:131]
v_pk_add_f32 v[150:151],v[132:133],v[134:135]
v_pk_add_f32 v[148:149],v[148:149],v[138:139]
v_pk_add_f32 v[148:149],v[148:149],v[150:151]
v_add_f32 v150,v148,v149
v_add_f32 v151,v148,v149
s_nop 1
v_permlane16_swap_b32 v150,v151
v_add_f32 v148,v150,v151
v_add_f32 v149,v150,v151
s_nop 1
v_permlane32_swap_b32 v148,v149
v_add_f32 v148,v148,v149
v_rcp_f32 v148,v148
s_waitcnt vmcnt(0)
v_cmp_gt_u32 vcc,s66,v17
v_pk_mul_f32 v[138:139],v[138:139],v[148:149] op_sel_hi:[1,0]
v_pk_mul_f32 v[128:129],v[128:129],v[148:149] op_sel_hi:[1,0]
v_pk_mul_f32 v[130:131],v[130:131],v[148:149] op_sel_hi:[1,0]
v_pk_mul_f32 v[132:133],v[132:133],v[148:149] op_sel_hi:[1,0]
v_pk_mul_f32 v[134:135],v[134:135],v[148:149] op_sel_hi:[1,0]
s_cbranch_vccnz L_ap_355
L_apb_356:
s_xor_b32 s34,s69,524288
buffer_load_dwordx4 v[192:195],v7,s[8:11],s34 offen sc1
v_cvt_pk_bf16_f32 v144,v138,v139
v_cvt_pk_bf16_f32 v147,v138,v139
s_nop 0
v_mfma_f32_16x16x16_bf16 v[24:27],v[120:121],v[144:145],0
s_add_u32 s34,s34,4096
v_cvt_pk_bf16_f32 v140,v128,v129
v_mfma_f32_16x16x16_bf16 v[28:31],v[120:121],v[146:147],0
buffer_load_dwordx4 v[196:199],v7,s[8:11],s34 offen sc1
v_cvt_pk_bf16_f32 v141,v130,v131
v_mfma_f32_16x16x16_bf16 v[32:35],v[122:123],v[144:145],0
s_add_u32 s34,s34,4096
v_cvt_pk_bf16_f32 v142,v132,v133
v_mfma_f32_16x16x16_bf16 v[36:39],v[122:123],v[146:147],0
buffer_load_dwordx4 v[200:203],v7,s[8:11],s34 offen sc1
v_cvt_pk_bf16_f32 v143,v134,v135
v_mfma_f32_16x16x16_bf16 v[40:43],v[124:125],v[144:145],0
s_add_u32 s34,s34,4096
v_mfma_f32_16x16x16_bf16 v[44:47],v[124:125],v[146:147],0
buffer_load_dwordx4 v[204:207],v7,s[8:11],s34 offen sc1
v_mfma_f32_16x16x16_bf16 v[48:51],v[126:127],v[144:145],0
s_add_u32 s34,s34,4096
v_mfma_f32_16x16x16_bf16 v[52:55],v[126:127],v[146:147],0
buffer_load_dwordx4 v[208:211],v7,s[8:11],s34 offen sc1
v_mfma_f32_16x16x32_bf16 v[24:27],v[88:91],v[140:143],v[24:27]
s_add_u32 s34,s34,4096
v_mfma_f32_16x16x32_bf16 v[28:31],v[92:95],v[140:143],v[28:31]
buffer_load_dwordx4 v[212:215],v7,s[8:11],s34 offen sc1
v_mfma_f32_16x16x32_bf16 v[32:35],v[96:99],v[140:143],v[32:35]
s_add_u32 s34,s34,4096
v_mfma_f32_16x16x32_bf16 v[36:39],v[100:103],v[140:143],v[36:39]
buffer_load_dwordx4 v[216:219],v7,s[8:11],s34 offen sc1
v_cvt_pk_bf16_f32 v72,v24,v28
v_cvt_pk_bf16_f32 v73,v25,v29
v_mfma_f32_16x16x32_bf16 v[40:43],v[104:107],v[140:143],v[40:43]
s_add_u32 s34,s34,4096
v_cvt_pk_bf16_f32 v74,v26,v30
v_cvt_pk_bf16_f32 v75,v27,v31
v_mfma_f32_16x16x32_bf16 v[44:47],v[108:111],v[140:143],v[44:47]
ds_write_b128 v3,v[72:75] offset:0
v_cvt_pk_bf16_f32 v76,v32,v36
v_cvt_pk_bf16_f32 v77,v33,v37
v_mfma_f32_16x16x32_bf16 v[48:51],v[112:115],v[140:143],v[48:51]
buffer_load_dwordx4 v[220:223],v7,s[8:11],s34 offen sc1
v_cvt_pk_bf16_f32 v78,v34,v38
v_cvt_pk_bf16_f32 v79,v35,v39
v_mfma_f32_16x16x32_bf16 v[52:55],v[116:119],v[140:143],v[52:55]
ds_write_b128 v3,v[76:79] offset:1024
v_cvt_pk_bf16_f32 v80,v40,v44
v_cvt_pk_bf16_f32 v81,v41,v45
v_cvt_pk_bf16_f32 v82,v42,v46
v_cvt_pk_bf16_f32 v83,v43,v47
ds_write_b128 v3,v[80:83] offset:2048
s_nop 1
v_cvt_pk_bf16_f32 v84,v48,v52
v_cvt_pk_bf16_f32 v85,v49,v53
v_cvt_pk_bf16_f32 v86,v50,v54
v_cvt_pk_bf16_f32 v87,v51,v55
ds_write_b128 v3,v[84:87] offset:3072
v_readlane_b32 s32,v18,0
v_readlane_b32 s33,v18,1
s_waitcnt lgkmcnt(0)
s_barrier
s_branch L_aa_317
L_ai_354:
v_max3_f32 v238,v128,v129,v130
v_max3_f32 v239,v131,v132,v133
v_max3_f32 v238,v134,v135,v238
v_max3_f32 v239,v138,v139,v239
v_max_f32 v238,v238,v239
v_max_f32 v239,v238,v239
v_pk_mul_f32 v[128:129],v[128:129],v[152:153] op_sel_hi:[1,0]
v_pk_mul_f32 v[130:131],v[130:131],v[152:153] op_sel_hi:[1,0]
v_permlane16_swap_b32 v238,v239
v_max_f32 v238,v238,v239
v_max_f32 v239,v238,v239
v_pk_mul_f32 v[132:133],v[132:133],v[152:153] op_sel_hi:[1,0]
v_pk_mul_f32 v[134:135],v[134:135],v[152:153] op_sel_hi:[1,0]
v_permlane32_swap_b32 v238,v239
v_max_f32 v238,v238,v239
v_mul_f32 v238,v152,v238
v_pk_mul_f32 v[138:139],v[138:139],v[152:153] op_sel_hi:[1,0]
v_pk_add_f32 v[128:129],v[128:129],v[238:239] op_sel_hi:[1,0] neg_lo:[0,1] neg_hi:[0,1]
v_pk_add_f32 v[130:131],v[130:131],v[238:239] op_sel_hi:[1,0] neg_lo:[0,1] neg_hi:[0,1]
v_pk_add_f32 v[132:133],v[132:133],v[238:239] op_sel_hi:[1,0] neg_lo:[0,1] neg_hi:[0,1]
v_pk_add_f32 v[134:135],v[134:135],v[238:239] op_sel_hi:[1,0] neg_lo:[0,1] neg_hi:[0,1]
v_pk_add_f32 v[138:139],v[138:139],v[238:239] op_sel_hi:[1,0] neg_lo:[0,1] neg_hi:[0,1]
v_exp_f32 v128,v128
v_exp_f32 v129,v129
v_exp_f32 v130,v130
v_exp_f32 v131,v131
v_exp_f32 v132,v132
v_exp_f32 v133,v133
v_exp_f32 v134,v134
v_exp_f32 v135,v135
v_exp_f32 v138,v138
v_exp_f32 v139,v139
v_pk_add_f32 v[148:149],v[128:129],v[130:131]
v_pk_add_f32 v[150:151],v[132:133],v[134:135]
v_pk_add_f32 v[148:149],v[148:149],v[138:139]
v_pk_add_f32 v[148:149],v[148:149],v[150:151]
v_add_f32 v150,v148,v149
v_add_f32 v151,v148,v149
s_nop 1
v_permlane16_swap_b32 v150,v151
v_add_f32 v148,v150,v151
v_add_f32 v149,v150,v151
s_nop 1
v_permlane32_swap_b32 v148,v149
v_add_f32 v148,v148,v149
v_rcp_f32 v148,v148
s_nop 0
v_pk_mul_f32 v[138:139],v[138:139],v[148:149] op_sel_hi:[1,0]
v_pk_mul_f32 v[128:129],v[128:129],v[148:149] op_sel_hi:[1,0]
v_pk_mul_f32 v[130:131],v[130:131],v[148:149] op_sel_hi:[1,0]
v_pk_mul_f32 v[132:133],v[132:133],v[148:149] op_sel_hi:[1,0]
v_pk_mul_f32 v[134:135],v[134:135],v[148:149] op_sel_hi:[1,0]
v_cvt_pk_bf16_f32 v144,v138,v139
v_cvt_pk_bf16_f32 v147,v138,v139
s_nop 0
v_mfma_f32_16x16x16_bf16 v[24:27],v[120:121],v[144:145],0
v_cvt_pk_bf16_f32 v140,v128,v129
v_mfma_f32_16x16x16_bf16 v[28:31],v[120:121],v[146:147],0
v_cvt_pk_bf16_f32 v141,v130,v131
v_mfma_f32_16x16x16_bf16 v[32:35],v[122:123],v[144:145],0
v_cvt_pk_bf16_f32 v142,v132,v133
v_mfma_f32_16x16x16_bf16 v[36:39],v[122:123],v[146:147],0
v_cvt_pk_bf16_f32 v143,v134,v135
v_mfma_f32_16x16x16_bf16 v[40:43],v[124:125],v[144:145],0
v_mfma_f32_16x16x16_bf16 v[44:47],v[124:125],v[146:147],0
v_mfma_f32_16x16x16_bf16 v[48:51],v[126:127],v[144:145],0
v_mfma_f32_16x16x16_bf16 v[52:55],v[126:127],v[146:147],0
v_mfma_f32_16x16x32_bf16 v[24:27],v[88:91],v[140:143],v[24:27]
v_mfma_f32_16x16x32_bf16 v[28:31],v[92:95],v[140:143],v[28:31]
v_mfma_f32_16x16x32_bf16 v[32:35],v[96:99],v[140:143],v[32:35]
v_mfma_f32_16x16x32_bf16 v[36:39],v[100:103],v[140:143],v[36:39]
v_cvt_pk_bf16_f32 v72,v24,v28
v_cvt_pk_bf16_f32 v73,v25,v29
v_mfma_f32_16x16x32_bf16 v[40:43],v[104:107],v[140:143],v[40:43]
v_cvt_pk_bf16_f32 v74,v26,v30
v_cvt_pk_bf16_f32 v75,v27,v31
v_mfma_f32_16x16x32_bf16 v[44:47],v[108:111],v[140:143],v[44:47]
ds_write_b128 v3,v[72:75] offset:0
v_cvt_pk_bf16_f32 v76,v32,v36
v_cvt_pk_bf16_f32 v77,v33,v37
v_mfma_f32_16x16x32_bf16 v[48:51],v[112:115],v[140:143],v[48:51]
v_cvt_pk_bf16_f32 v78,v34,v38
v_cvt_pk_bf16_f32 v79,v35,v39
v_mfma_f32_16x16x32_bf16 v[52:55],v[116:119],v[140:143],v[52:55]
ds_write_b128 v3,v[76:79] offset:1024
v_cvt_pk_bf16_f32 v80,v40,v44
v_cvt_pk_bf16_f32 v81,v41,v45
v_cvt_pk_bf16_f32 v82,v42,v46
v_cvt_pk_bf16_f32 v83,v43,v47
ds_write_b128 v3,v[80:83] offset:2048
s_nop 1
v_cvt_pk_bf16_f32 v84,v48,v52
v_cvt_pk_bf16_f32 v85,v49,v53
v_cvt_pk_bf16_f32 v86,v50,v54
v_cvt_pk_bf16_f32 v87,v51,v55
ds_write_b128 v3,v[84:87] offset:3072
s_waitcnt vmcnt(0)
v_readlane_b32 s32,v18,0
v_readlane_b32 s33,v18,1
s_waitcnt lgkmcnt(0)
s_barrier
s_branch L_aa_304
L_aa_313:
s_cmp_lg_u32 s86,1536
s_cbranch_scc1 L_az_357
s_cmp_ge_u32 s35,66
s_cbranch_scc1 L_aa_303
v_subrev_u32 v248,s36,v1
v_and_b32 v248,0x80000003,v248
v_cmp_eq_u32 vcc,0,v248
v_lshlrev_b32 v248,2,v1
v_mov_b32 v249,0x40000000
v_cndmask_b32 v248,v249,v248,vcc
v_mov_b32 v249,3
s_or_b32 s59,s68,s46
s_mov_b32 s59,11018240
s_cmov_b32 s59,0x80000000
buffer_store_dword v249,v248,s[8:11],s59 offen sc1
L_aa_303:
s_waitcnt vmcnt(0)
buffer_store_dword v20,off,s[8:11],s73 sc1
s_mov_b32 s73,0x80000000
v_lshlrev_b32 v238,2,v1
v_add_u32 v248,155712,v238
s_cmp_lg_u32 s46,0
s_cbranch_scc1 L_an_358
s_lshl_b32 s59,s54,13
s_add_u32 s59,s59,11026432
L_fp_359:
s_sleep 1
buffer_load_dword v239,v238,s[8:11],s59 offen sc1
s_sub_u32 s49,s49,1
s_cbranch_scc1 L_abort2
s_waitcnt vmcnt(0)
v_cmp_eq_u32 vcc,0,v239
s_cbranch_vccnz L_fp_359
ds_write_b32 v248,v239
s_waitcnt lgkmcnt(0)
L_an_358:
s_barrier
ds_read_b32 v239,v248
s_mov_b32 s86,768
s_mov_b32 s30,1
s_waitcnt lgkmcnt(0)
v_readfirstlane_b32 s55,v239
v_and_b32 v239,255,v239
s_lshr_b32 s55,s55,8
s_lshr_b32 s61,s55,5
v_cmp_ne_u32 s[38:39],3,v239
v_cmp_le_u32 vcc,s61,v1
s_nop 1
v_cndmask_b32 v238,1,2,vcc
v_cmp_ne_u32 s[84:85],v238,v239
s_bcnt1_i32_b64 s56,s[84:85]
s_nop 0
v_mbcnt_lo_u32_b32 v238,s84,0
v_mbcnt_hi_u32_b32 v238,s85,v238
s_mul_i32 s56,s56,14
s_add_u32 s56,s56,48
s_lshr_b32 s56,s56,7
s_lshl_b32 s56,s56,1
v_cmp_gt_u32 vcc,s56,v238
v_and_b32 v239,1,v238
v_and_b32 v238,3,v238
v_add_u32 v238,2,v238
v_cndmask_b32 v238,v238,v239,vcc
v_cmp_eq_u32 vcc,s54,v238
s_and_b64 s[84:85],s[84:85],vcc
s_ff1_i32_b64 s77,s[84:85]
s_bitset0_b64 s[84:85],s77
s_min_u32 s77,s77,64
s_lshl_b32 s56,s77,5
s_add_u32 s56,s56,s68
s_mul_i32 s70,s56,24576
s_lshl_b32 s71,s56,12
s_lshl_b32 s59,s77,13
s_lshl2_add_u32 s59,s68,s59
s_add_u32 s59,s59,10486144
s_cmp_lt_u32 s77,s61
s_cselect_b32 s57,0,16777216
s_mov_b32 s60,s59
s_buffer_load_dword s33,s[8:11],s60
s_add_u32 s71,s71,s57
s_add_u32 s71,s71,58720256
s_cmp_eq_u32 s77,s61
s_cselect_b32 s57,50331648,0
s_cselect_b32 s58,1536,0
s_add_u32 s59,s59,s58
s_buffer_load_dword s32,s[8:11],s59
s_add_u32 s70,s70,s57
s_add_u32 s70,s70,150994944
v_mov_b32 v19,s59
v_writelane_b32 v19,s60,1
s_cmp_lt_u32 s77,64
s_cbranch_scc1 L_aa_311
L_az_357:
s_waitcnt vmcnt(0)
buffer_store_dword v20,off,s[8:11],s73 sc1
s_mov_b32 s73,0x80000000
s_endpgm
L_ag_319:
s_lshl_b32 s21,s26,13
s_lshl2_add_u32 s21,s68,s21
s_add_u32 s21,s21,10487296
L_ww_360:
buffer_load_dword v246,off,s[8:11],s21 sc1
s_sub_u32 s49,s49,1
s_cbranch_scc1 L_abort2
s_waitcnt vmcnt(0)
v_readfirstlane_b32 s22,v246
s_cmp_eq_u32 s22,0
s_cbranch_scc1 L_ww_360
L_wwd_361:
s_branch L_agb_320
L_ac_328:
buffer_store_dword v20,off,s[8:11],s73 sc1
s_mov_b32 s73,0x80000000
buffer_load_dwordx4 v[72:75],v0,s[8:11],s76 offen offset:0 sc1
buffer_load_dwordx4 v[76:79],v0,s[8:11],s76 offen offset:1024 sc1
buffer_load_dwordx4 v[80:83],v0,s[8:11],s76 offen offset:2048 sc1
buffer_load_dwordx4 v[84:87],v0,s[8:11],s76 offen offset:3072 sc1
buffer_load_dwordx2 v[120:121],v253,s[8:11],s76 offen offset:0 sc1
buffer_load_dwordx2 v[122:123],v253,s[8:11],s76 offen offset:1024 sc1
buffer_load_dwordx2 v[124:125],v253,s[8:11],s76 offen offset:2048 sc1
buffer_load_dwordx2 v[126:127],v253,s[8:11],s76 offen offset:3072 sc1
s_sub_u32 s49,s49,1
s_cbranch_scc1 L_abort2
s_waitcnt vmcnt(7)
v_mfma_f32_16x16x32_bf16 v[136:139],v[72:75],v[24:27],0
v_max3_u32 v238,v72,v73,v74
v_max3_u32 v238,v74,v75,v238
s_waitcnt vmcnt(6)
v_mfma_f32_16x16x32_bf16 v[136:139],v[76:79],v[28:31],v[136:139]
v_max3_u32 v238,v76,v77,v238
v_max3_u32 v238,v78,v79,v238
s_waitcnt vmcnt(5)
v_mfma_f32_16x16x32_bf16 v[136:139],v[80:83],v[32:35],v[136:139]
v_max3_u32 v238,v80,v81,v238
v_max3_u32 v238,v82,v83,v238
s_waitcnt vmcnt(4)
v_mfma_f32_16x16x32_bf16 v[136:139],v[84:87],v[36:39],v[136:139]
v_max3_u32 v238,v84,v85,v238
v_max3_u32 v238,v86,v87,v238
s_waitcnt vmcnt(0)
v_max3_u32 v238,v120,v121,v238
v_max3_u32 v238,v122,v123,v238
v_max3_u32 v238,v124,v125,v238
v_max3_u32 v238,v126,v127,v238
v_cmp_eq_u32 vcc,-1,v238
s_cbranch_vccnz L_ac_328
s_branch L_acb_329
L_ap_331:
L_aw_362:
v_cmp_gt_u32 vcc,s66,v17
s_cbranch_vccz L_awd_363
buffer_load_dword v17,v16,s[8:11],s87 offen sc1
s_sub_u32 s49,s49,1
s_cbranch_scc1 L_abort2
s_waitcnt vmcnt(0)
s_branch L_aw_362
L_awd_363:
s_branch L_apb_332
L_ag_340:
s_lshl_b32 s21,s51,13
s_lshl2_add_u32 s21,s68,s21
s_add_u32 s21,s21,10487296
L_ww_364:
buffer_load_dword v246,off,s[8:11],s21 sc1
s_sub_u32 s49,s49,1
s_cbranch_scc1 L_abort2
s_waitcnt vmcnt(0)
v_readfirstlane_b32 s22,v246
s_cmp_eq_u32 s22,0
s_cbranch_scc1 L_ww_364
L_wwd_365:
s_branch L_agb_341
L_ac_347:
buffer_store_dword v20,off,s[8:11],s73 sc1
s_mov_b32 s73,0x80000000
buffer_load_dwordx4 v[72:75],v0,s[8:11],s76 offen offset:0 sc1
buffer_load_dwordx4 v[76:79],v0,s[8:11],s76 offen offset:1024 sc1
buffer_load_dwordx4 v[80:83],v0,s[8:11],s76 offen offset:2048 sc1
buffer_load_dwordx4 v[84:87],v0,s[8:11],s76 offen offset:3072 sc1
buffer_load_dwordx2 v[120:121],v253,s[8:11],s76 offen offset:0 sc1
buffer_load_dwordx2 v[122:123],v253,s[8:11],s76 offen offset:1024 sc1
buffer_load_dwordx2 v[124:125],v253,s[8:11],s76 offen offset:2048 sc1
buffer_load_dwordx2 v[126:127],v253,s[8:11],s76 offen offset:3072 sc1
s_sub_u32 s49,s49,1
s_cbranch_scc1 L_abort2
s_waitcnt vmcnt(7)
v_mfma_f32_16x16x32_bf16 v[136:139],v[72:75],v[24:27],0
v_max3_u32 v238,v72,v73,v74
v_max3_u32 v238,v74,v75,v238
s_waitcnt vmcnt(6)
v_mfma_f32_16x16x32_bf16 v[136:139],v[76:79],v[28:31],v[136:139]
v_max3_u32 v238,v76,v77,v238
v_max3_u32 v238,v78,v79,v238
s_waitcnt vmcnt(5)
v_mfma_f32_16x16x32_bf16 v[136:139],v[80:83],v[32:35],v[136:139]
v_max3_u32 v238,v80,v81,v238
v_max3_u32 v238,v82,v83,v238
s_waitcnt vmcnt(4)
v_mfma_f32_16x16x32_bf16 v[136:139],v[84:87],v[36:39],v[136:139]
v_max3_u32 v238,v84,v85,v238
v_max3_u32 v238,v86,v87,v238
s_waitcnt vmcnt(0)
v_max3_u32 v238,v120,v121,v238
v_max3_u32 v238,v122,v123,v238
v_max3_u32 v238,v124,v125,v238
v_max3_u32 v238,v126,v127,v238
v_cmp_eq_u32 vcc,-1,v238
s_cbranch_vccnz L_ac_347
s_branch L_acb_348
L_am_351:
v_subrev_u32 v248,s36,v1
v_and_b32 v248,0x80000003,v248
v_cmp_eq_u32 vcc,0,v248
v_lshlrev_b32 v248,2,v1
v_mov_b32 v249,0x40000000
v_cndmask_b32 v248,v249,v248,vcc
v_mov_b32 v249,3
s_or_b32 s59,s68,s46
s_mov_b32 s59,11018240
s_cmov_b32 s59,0x80000000
buffer_store_dword v249,v248,s[8:11],s59 offen sc1
s_branch L_ab_349
L_ap_355:
L_aw_366:
v_cmp_gt_u32 vcc,s66,v17
s_cbranch_vccz L_awd_367
buffer_load_dword v17,v16,s[8:11],s87 offen sc1
s_sub_u32 s49,s49,1
s_cbranch_scc1 L_abort2
s_waitcnt vmcnt(0)
s_branch L_aw_366
L_awd_367:
s_branch L_apb_356
s_endpgm
L_wm:
s_nop 11
v_and_b32 v120,15,v1
v_lshrrev_b32 v121,4,v1
v_mov_b32 v17,1
s_lshl_b32 s56,s46,15
v_add_u32 v18,s56,v0
s_lshl_b32 s56,s46,2
v_add_u32 v125,s56,v121
v_xor_b32 v126,v125,v120
v_lshlrev_b32 v126,4,v126
v_lshl_add_u32 v20,v125,10,v126
v_add_u32 v125,0,v121
v_xor_b32 v125,v125,v120
v_lshlrev_b32 v125,4,v125
v_lshl_add_u32 v125,v120,8,v125
v_add_u32 v4,131072,v125
v_add_u32 v125,4,v121
v_xor_b32 v125,v125,v120
v_lshlrev_b32 v125,4,v125
v_lshl_add_u32 v125,v120,8,v125
v_add_u32 v5,131072,v125
v_add_u32 v125,8,v121
v_xor_b32 v125,v125,v120
v_lshlrev_b32 v125,4,v125
v_lshl_add_u32 v125,v120,8,v125
v_add_u32 v6,131072,v125
v_add_u32 v125,12,v121
v_xor_b32 v125,v125,v120
v_lshlrev_b32 v125,4,v125
v_lshl_add_u32 v125,v120,8,v125
v_add_u32 v7,131072,v125
v_lshlrev_b32 v21,5,v120
v_and_b32 v125,1,v121
v_lshl_add_u32 v21,v125,4,v21
s_lshl_b32 s56,s46,9
v_lshrrev_b32 v125,1,v121
v_lshl_add_u32 v21,v125,11,v21
s_add_u32 s56,s56,155648
v_add_u32 v21,s56,v21
v_lshlrev_b32 v22,4,v120
v_lshl_add_u32 v22,v121,10,v22
s_lshl_b32 s56,s46,8
v_add_u32 v22,s56,v22
s_mov_b32 s54,0
s_mov_b32 s31,0
s_mov_b32 s53,6
s_mov_b32 s72,0x80000000
s_mov_b32 s73,0
s_mov_b32 s77,-1
s_mov_b32 s86,0
s_mov_b32 s19,0
s_mov_b32 s74,2675965952
s_mov_b32 s75,613566756
v_and_b32 v23,15,v1
v_lshlrev_b32 v23,3,v23
v_lshrrev_b32 v16,4,v1
v_lshl_add_u32 v23,v16,13,v23
v_mov_b32 v19,159744
v_lshl_add_u32 v16,v16,2,v19
v_and_b32 v9,15,v1
v_lshrrev_b32 v10,4,v1
v_and_b32 v124,1,v1
v_lshlrev_b32 v124,4,v124
v_mov_b32 v125,0xffff
v_lshlrev_b32 v125,v124,v125
v_lshrrev_b32 v124,2,v9
v_cmp_eq_u32 vcc,0,v124
s_nop 1
v_cndmask_b32 v12,0,v125,vcc
v_cmp_eq_u32 vcc,1,v124
s_nop 1
v_cndmask_b32 v13,0,v125,vcc
v_and_b32 v124,2,v1
v_cmp_eq_u32 vcc,0,v124
v_mov_b32 v14,0xeeee
v_mov_b32 v124,0x4444
v_cndmask_b32 v14,v14,v124,vcc
v_lshlrev_b32 v11,14,v10
v_lshl_add_u32 v11,v9,4,v11
s_lshl_b32 s65,s51,15
s_add_u32 s65,s65,92274688
s_lshl_b32 s62,s47,10
s_add_u32 s62,s62,s65
s_lshl_b32 s63,s47,16
s_lshl_b32 s60,s46,8
s_add_u32 s63,s63,s60
s_mov_b32 s4,s38
s_mov_b32 s5,s39
s_mov_b32 s6,1835008
s_mov_b32 s7,0x20000
buffer_load_dwordx4 v[24:27],v11,s[4:7],s63 offen offset:0
buffer_load_dwordx4 v[28:31],v11,s[4:7],s63 offen offset:1024
buffer_load_dwordx4 v[32:35],v11,s[4:7],s63 offen offset:2048
buffer_load_dwordx4 v[36:39],v11,s[4:7],s63 offen offset:3072
s_add_u32 s63,s63,4096
buffer_load_dwordx4 v[40:43],v11,s[4:7],s63 offen offset:0
buffer_load_dwordx4 v[44:47],v11,s[4:7],s63 offen offset:1024
buffer_load_dwordx4 v[48:51],v11,s[4:7],s63 offen offset:2048
buffer_load_dwordx4 v[52:55],v11,s[4:7],s63 offen offset:3072
s_add_u32 s63,s63,4096
buffer_load_dwordx4 v[56:59],v11,s[4:7],s63 offen offset:0
buffer_load_dwordx4 v[60:63],v11,s[4:7],s63 offen offset:1024
buffer_load_dwordx4 v[64:67],v11,s[4:7],s63 offen offset:2048
buffer_load_dwordx4 v[68:71],v11,s[4:7],s63 offen offset:3072
s_add_u32 s63,s63,4096
buffer_load_dwordx4 v[72:75],v11,s[4:7],s63 offen offset:0
buffer_load_dwordx4 v[76:79],v11,s[4:7],s63 offen offset:1024
buffer_load_dwordx4 v[80:83],v11,s[4:7],s63 offen offset:2048
buffer_load_dwordx4 v[84:87],v11,s[4:7],s63 offen offset:3072
s_mov_b32 s4,s32
s_mov_b32 s5,s33
s_mov_b32 s6,1024
s_mov_b32 s7,0x20000
buffer_load_dwordx4 v[88:91],v0,s[4:7],0 offen
s_waitcnt vmcnt(0)
v_lshlrev_b32 v96,16,v88
v_and_b32 v97,0xffff0000,v88
v_lshlrev_b32 v98,16,v89
v_and_b32 v99,0xffff0000,v89
v_lshlrev_b32 v100,16,v90
v_and_b32 v101,0xffff0000,v90
v_lshlrev_b32 v102,16,v91
v_and_b32 v103,0xffff0000,v91
v_mul_f32 v88,v96,v96
v_fma_f32 v88,v97,v97,v88
v_fma_f32 v88,v98,v98,v88
v_fma_f32 v88,v99,v99,v88
v_fma_f32 v88,v100,v100,v88
v_fma_f32 v88,v101,v101,v88
v_fma_f32 v88,v102,v102,v88
v_fma_f32 v88,v103,v103,v88
s_nop 1
v_add_f32_dpp v88,v88,v88 row_ror:8 row_mask:0xf bank_mask:0xf
s_nop 1
v_add_f32_dpp v88,v88,v88 row_ror:4 row_mask:0xf bank_mask:0xf
s_nop 1
v_add_f32_dpp v88,v88,v88 row_ror:2 row_mask:0xf bank_mask:0xf
s_nop 1
v_add_f32_dpp v88,v88,v88 row_ror:1 row_mask:0xf bank_mask:0xf
v_mov_b32 v89,v88
s_nop 1
v_permlane16_swap_b32 v88,v89
v_add_f32 v88,v88,v89
v_mov_b32 v89,v88
s_nop 1
v_permlane32_swap_b32 v88,v89
v_add_f32 v88,v88,v89
v_sqrt_f32 v88,v88
s_nop 0
v_mul_f32 v88,0x40333333,v88
s_nop 0
v_readfirstlane_b32 s25,v88
s_bitset1_b32 s25,31
s_ff1_i32_b64 s30,s[74:75]
s_bitset0_b64 s[74:75],s30
s_min_u32 s30,s30,127
s_lshl_b32 s70,s30,15
s_add_u32 s70,s70,0
s_add_u32 s71,s70,16384
L_mo_371:
s_cmp_lg_u32 s19,0
s_cbranch_scc1 L_mo_372
s_add_u32 m0,s50,131072
s_nop 0
buffer_load_dwordx4 v20,s[8:11],s70 offen offset:0 sc1 lds
s_add_u32 m0,s50,135168
s_nop 0
buffer_load_dwordx4 v20,s[8:11],s71 offen offset:0 sc1 lds
s_add_u32 m0,s50,139008
s_nop 0
buffer_load_dwordx4 v20,s[8:11],s70 offen offset:256 sc1 lds
s_add_u32 m0,s50,143104
s_nop 0
buffer_load_dwordx4 v20,s[8:11],s71 offen offset:256 sc1 lds
s_add_u32 m0,s50,146944
s_nop 0
buffer_load_dwordx4 v20,s[8:11],s70 offen offset:512 sc1 lds
s_add_u32 m0,s50,151040
s_nop 0
buffer_load_dwordx4 v20,s[8:11],s71 offen offset:512 sc1 lds
s_mov_b32 s19,1
s_waitcnt vmcnt(0)
L_mo_372:
s_mov_b32 s51,s30
s_mov_b64 s[68:69],s[70:71]
s_ff1_i32_b64 s30,s[74:75]
s_bitset0_b64 s[74:75],s30
s_min_u32 s30,s30,127
s_lshl_b32 s70,s30,15
s_add_u32 s70,s70,0
s_add_u32 s71,s70,16384
s_lshl_b32 s76,s31,13
s_add_u32 s76,s76,10487040
s_lshl_b32 s58,s51,5
s_add_u32 s58,s58,s47
s_mul_i32 s58,s58,24576
s_add_u32 s58,s58,100663296
s_add_u32 s61,s58,s50
s_add_u32 s62,s61,4096
s_add_u32 s63,s61,16384
s_add_u32 s64,s61,20480
s_add_u32 s65,s61,s50
s_add_u32 s65,s65,8192
s_waitcnt vmcnt(12)
s_barrier
ds_read_b128 v[72:75],v4 offset:0
ds_read_b128 v[76:79],v4 offset:4096
ds_read_b128 v[80:83],v5 offset:0
ds_read_b128 v[84:87],v5 offset:4096
s_add_u32 m0,s50,154880
s_nop 0
buffer_load_dwordx4 v20,s[8:11],s68 offen offset:768 sc1 lds
s_add_u32 m0,s50,158976
s_nop 0
buffer_load_dwordx4 v20,s[8:11],s69 offen offset:768 sc1 lds
s_waitcnt lgkmcnt(2)
v_mfma_f32_16x16x32_bf16 v[40:43],a[128:131],v[72:75],0
ds_read_b128 v[108:111],v6 offset:0
v_mfma_f32_16x16x32_bf16 v[56:59],v[72:75],v[128:131],0
v_mfma_f32_16x16x32_bf16 v[24:27],a[0:3],v[72:75],0
ds_read_b128 v[112:115],v6 offset:4096
v_mfma_f32_16x16x32_bf16 v[44:47],a[128:131],v[76:79],0
v_mfma_f32_16x16x32_bf16 v[60:63],v[76:79],v[128:131],0
v_mfma_f32_16x16x32_bf16 v[28:31],a[0:3],v[76:79],0
v_mfma_f32_16x16x32_bf16 v[48:51],a[136:139],v[72:75],0
v_mfma_f32_16x16x32_bf16 v[64:67],v[72:75],v[136:139],0
v_mfma_f32_16x16x32_bf16 v[32:35],a[8:11],v[72:75],0
v_mfma_f32_16x16x32_bf16 v[52:55],a[136:139],v[76:79],0
v_mfma_f32_16x16x32_bf16 v[68:71],v[76:79],v[136:139],0
v_mfma_f32_16x16x32_bf16 v[36:39],a[8:11],v[76:79],0
s_waitcnt lgkmcnt(2)
v_mfma_f32_16x16x32_bf16 v[40:43],a[132:135],v[80:83],v[40:43]
ds_read_b128 v[72:75],v7 offset:0
v_mfma_f32_16x16x32_bf16 v[56:59],v[80:83],v[132:135],v[56:59]
v_mfma_f32_16x16x32_bf16 v[24:27],a[4:7],v[80:83],v[24:27]
ds_read_b128 v[76:79],v7 offset:4096
v_mfma_f32_16x16x32_bf16 v[44:47],a[132:135],v[84:87],v[44:47]
v_mfma_f32_16x16x32_bf16 v[60:63],v[84:87],v[132:135],v[60:63]
v_mfma_f32_16x16x32_bf16 v[28:31],a[4:7],v[84:87],v[28:31]
v_mfma_f32_16x16x32_bf16 v[48:51],a[140:143],v[80:83],v[48:51]
v_mfma_f32_16x16x32_bf16 v[64:67],v[80:83],v[140:143],v[64:67]
v_mfma_f32_16x16x32_bf16 v[32:35],a[12:15],v[80:83],v[32:35]
v_mfma_f32_16x16x32_bf16 v[52:55],a[140:143],v[84:87],v[52:55]
v_mfma_f32_16x16x32_bf16 v[68:71],v[84:87],v[140:143],v[68:71]
v_mfma_f32_16x16x32_bf16 v[36:39],a[12:15],v[84:87],v[36:39]
s_waitcnt vmcnt(12)
s_barrier
s_waitcnt lgkmcnt(2)
v_mfma_f32_16x16x32_bf16 v[40:43],a[144:147],v[108:111],v[40:43]
ds_read_b128 v[80:83],v4 offset:8192
v_mfma_f32_16x16x32_bf16 v[56:59],v[108:111],v[144:147],v[56:59]
v_mfma_f32_16x16x32_bf16 v[24:27],a[16:19],v[108:111],v[24:27]
ds_read_b128 v[84:87],v4 offset:12288
v_mfma_f32_16x16x32_bf16 v[44:47],a[144:147],v[112:115],v[44:47]
v_mfma_f32_16x16x32_bf16 v[60:63],v[112:115],v[144:147],v[60:63]
v_mfma_f32_16x16x32_bf16 v[28:31],a[16:19],v[112:115],v[28:31]
v_mfma_f32_16x16x32_bf16 v[48:51],a[152:155],v[108:111],v[48:51]
v_mfma_f32_16x16x32_bf16 v[64:67],v[108:111],v[152:155],v[64:67]
v_mfma_f32_16x16x32_bf16 v[32:35],a[24:27],v[108:111],v[32:35]
v_mfma_f32_16x16x32_bf16 v[52:55],a[152:155],v[112:115],v[52:55]
v_mfma_f32_16x16x32_bf16 v[68:71],v[112:115],v[152:155],v[68:71]
v_mfma_f32_16x16x32_bf16 v[36:39],a[24:27],v[112:115],v[36:39]
s_waitcnt lgkmcnt(2)
v_mfma_f32_16x16x32_bf16 v[40:43],a[148:151],v[72:75],v[40:43]
ds_read_b128 v[108:111],v5 offset:8192
v_mfma_f32_16x16x32_bf16 v[56:59],v[72:75],v[148:151],v[56:59]
v_mfma_f32_16x16x32_bf16 v[24:27],a[20:23],v[72:75],v[24:27]
ds_read_b128 v[112:115],v5 offset:12288
v_mfma_f32_16x16x32_bf16 v[44:47],a[148:151],v[76:79],v[44:47]
v_mfma_f32_16x16x32_bf16 v[60:63],v[76:79],v[148:151],v[60:63]
v_mfma_f32_16x16x32_bf16 v[28:31],a[20:23],v[76:79],v[28:31]
v_mfma_f32_16x16x32_bf16 v[48:51],a[156:159],v[72:75],v[48:51]
v_mfma_f32_16x16x32_bf16 v[64:67],v[72:75],v[156:159],v[64:67]
v_mfma_f32_16x16x32_bf16 v[32:35],a[28:31],v[72:75],v[32:35]
v_mfma_f32_16x16x32_bf16 v[52:55],a[156:159],v[76:79],v[52:55]
v_mfma_f32_16x16x32_bf16 v[68:71],v[76:79],v[156:159],v[68:71]
v_mfma_f32_16x16x32_bf16 v[36:39],a[28:31],v[76:79],v[36:39]
s_waitcnt lgkmcnt(2)
v_mfma_f32_16x16x32_bf16 v[40:43],a[160:163],v[80:83],v[40:43]
ds_read_b128 v[72:75],v6 offset:8192
v_mfma_f32_16x16x32_bf16 v[56:59],v[80:83],v[160:163],v[56:59]
v_mfma_f32_16x16x32_bf16 v[24:27],a[32:35],v[80:83],v[24:27]
ds_read_b128 v[76:79],v6 offset:12288
v_mfma_f32_16x16x32_bf16 v[44:47],a[160:163],v[84:87],v[44:47]
v_mfma_f32_16x16x32_bf16 v[60:63],v[84:87],v[160:163],v[60:63]
v_mfma_f32_16x16x32_bf16 v[28:31],a[32:35],v[84:87],v[28:31]
v_mfma_f32_16x16x32_bf16 v[48:51],a[168:171],v[80:83],v[48:51]
v_mfma_f32_16x16x32_bf16 v[64:67],v[80:83],v[168:171],v[64:67]
v_mfma_f32_16x16x32_bf16 v[32:35],a[40:43],v[80:83],v[32:35]
v_mfma_f32_16x16x32_bf16 v[52:55],a[168:171],v[84:87],v[52:55]
v_mfma_f32_16x16x32_bf16 v[68:71],v[84:87],v[168:171],v[68:71]
v_mfma_f32_16x16x32_bf16 v[36:39],a[40:43],v[84:87],v[36:39]
s_waitcnt lgkmcnt(2)
v_mfma_f32_16x16x32_bf16 v[40:43],a[164:167],v[108:111],v[40:43]
ds_read_b128 v[80:83],v7 offset:8192
v_mfma_f32_16x16x32_bf16 v[56:59],v[108:111],v[164:167],v[56:59]
v_mfma_f32_16x16x32_bf16 v[24:27],a[36:39],v[108:111],v[24:27]
ds_read_b128 v[84:87],v7 offset:12288
v_mfma_f32_16x16x32_bf16 v[44:47],a[164:167],v[112:115],v[44:47]
v_mfma_f32_16x16x32_bf16 v[60:63],v[112:115],v[164:167],v[60:63]
v_mfma_f32_16x16x32_bf16 v[28:31],a[36:39],v[112:115],v[28:31]
v_mfma_f32_16x16x32_bf16 v[48:51],a[172:175],v[108:111],v[48:51]
v_mfma_f32_16x16x32_bf16 v[64:67],v[108:111],v[172:175],v[64:67]
v_mfma_f32_16x16x32_bf16 v[32:35],a[44:47],v[108:111],v[32:35]
v_mfma_f32_16x16x32_bf16 v[52:55],a[172:175],v[112:115],v[52:55]
v_mfma_f32_16x16x32_bf16 v[68:71],v[112:115],v[172:175],v[68:71]
v_mfma_f32_16x16x32_bf16 v[36:39],a[44:47],v[112:115],v[36:39]
s_waitcnt vmcnt(10)
s_barrier
s_waitcnt lgkmcnt(2)
v_mfma_f32_16x16x32_bf16 v[40:43],a[176:179],v[72:75],v[40:43]
ds_read_b128 v[108:111],v4 offset:16384
v_mfma_f32_16x16x32_bf16 v[56:59],v[72:75],v[176:179],v[56:59]
v_mfma_f32_16x16x32_bf16 v[24:27],a[48:51],v[72:75],v[24:27]
ds_read_b128 v[112:115],v4 offset:20480
v_mfma_f32_16x16x32_bf16 v[44:47],a[176:179],v[76:79],v[44:47]
v_mfma_f32_16x16x32_bf16 v[60:63],v[76:79],v[176:179],v[60:63]
v_mfma_f32_16x16x32_bf16 v[28:31],a[48:51],v[76:79],v[28:31]
v_mfma_f32_16x16x32_bf16 v[48:51],a[184:187],v[72:75],v[48:51]
v_mfma_f32_16x16x32_bf16 v[64:67],v[72:75],v[184:187],v[64:67]
v_mfma_f32_16x16x32_bf16 v[32:35],a[56:59],v[72:75],v[32:35]
v_mfma_f32_16x16x32_bf16 v[52:55],a[184:187],v[76:79],v[52:55]
v_mfma_f32_16x16x32_bf16 v[68:71],v[76:79],v[184:187],v[68:71]
v_mfma_f32_16x16x32_bf16 v[36:39],a[56:59],v[76:79],v[36:39]
s_waitcnt vmcnt(2)
s_barrier
s_or_b32 s72,s72,s52
buffer_store_dword v17,off,s[8:11],s72 sc1
s_waitcnt lgkmcnt(2)
v_mfma_f32_16x16x32_bf16 v[40:43],a[180:183],v[80:83],v[40:43]
ds_read_b128 v[72:75],v5 offset:16384
v_mfma_f32_16x16x32_bf16 v[56:59],v[80:83],v[180:183],v[56:59]
v_mfma_f32_16x16x32_bf16 v[24:27],a[52:55],v[80:83],v[24:27]
ds_read_b128 v[76:79],v5 offset:20480
v_mfma_f32_16x16x32_bf16 v[44:47],a[180:183],v[84:87],v[44:47]
v_mfma_f32_16x16x32_bf16 v[60:63],v[84:87],v[180:183],v[60:63]
v_mfma_f32_16x16x32_bf16 v[28:31],a[52:55],v[84:87],v[28:31]
v_mfma_f32_16x16x32_bf16 v[48:51],a[188:191],v[80:83],v[48:51]
v_mfma_f32_16x16x32_bf16 v[64:67],v[80:83],v[188:191],v[64:67]
v_mfma_f32_16x16x32_bf16 v[32:35],a[60:63],v[80:83],v[32:35]
v_mfma_f32_16x16x32_bf16 v[52:55],a[188:191],v[84:87],v[52:55]
v_mfma_f32_16x16x32_bf16 v[68:71],v[84:87],v[188:191],v[68:71]
v_mfma_f32_16x16x32_bf16 v[36:39],a[60:63],v[84:87],v[36:39]
s_waitcnt lgkmcnt(2)
v_mfma_f32_16x16x32_bf16 v[40:43],a[192:195],v[108:111],v[40:43]
ds_read_b128 v[80:83],v6 offset:16384
v_mfma_f32_16x16x32_bf16 v[56:59],v[108:111],v[192:195],v[56:59]
v_mfma_f32_16x16x32_bf16 v[24:27],a[64:67],v[108:111],v[24:27]
ds_read_b128 v[84:87],v6 offset:20480
v_mfma_f32_16x16x32_bf16 v[44:47],a[192:195],v[112:115],v[44:47]
v_mfma_f32_16x16x32_bf16 v[60:63],v[112:115],v[192:195],v[60:63]
v_mfma_f32_16x16x32_bf16 v[28:31],a[64:67],v[112:115],v[28:31]
v_mfma_f32_16x16x32_bf16 v[48:51],a[200:203],v[108:111],v[48:51]
v_mfma_f32_16x16x32_bf16 v[64:67],v[108:111],v[200:203],v[64:67]
v_mfma_f32_16x16x32_bf16 v[32:35],a[72:75],v[108:111],v[32:35]
v_mfma_f32_16x16x32_bf16 v[52:55],a[200:203],v[112:115],v[52:55]
v_mfma_f32_16x16x32_bf16 v[68:71],v[112:115],v[200:203],v[68:71]
v_mfma_f32_16x16x32_bf16 v[36:39],a[72:75],v[112:115],v[36:39]
s_waitcnt lgkmcnt(2)
v_mfma_f32_16x16x32_bf16 v[40:43],a[196:199],v[72:75],v[40:43]
ds_read_b128 v[108:111],v7 offset:16384
v_mfma_f32_16x16x32_bf16 v[56:59],v[72:75],v[196:199],v[56:59]
v_mfma_f32_16x16x32_bf16 v[24:27],a[68:71],v[72:75],v[24:27]
ds_read_b128 v[112:115],v7 offset:20480
v_mfma_f32_16x16x32_bf16 v[44:47],a[196:199],v[76:79],v[44:47]
v_mfma_f32_16x16x32_bf16 v[60:63],v[76:79],v[196:199],v[60:63]
v_mfma_f32_16x16x32_bf16 v[28:31],a[68:71],v[76:79],v[28:31]
v_mfma_f32_16x16x32_bf16 v[48:51],a[204:207],v[72:75],v[48:51]
v_mfma_f32_16x16x32_bf16 v[64:67],v[72:75],v[204:207],v[64:67]
v_mfma_f32_16x16x32_bf16 v[32:35],a[76:79],v[72:75],v[32:35]
v_mfma_f32_16x16x32_bf16 v[52:55],a[204:207],v[76:79],v[52:55]
v_mfma_f32_16x16x32_bf16 v[68:71],v[76:79],v[204:207],v[68:71]
v_mfma_f32_16x16x32_bf16 v[36:39],a[76:79],v[76:79],v[36:39]
s_waitcnt vmcnt(1)
s_barrier
s_waitcnt lgkmcnt(2)
v_mfma_f32_16x16x32_bf16 v[40:43],a[208:211],v[80:83],v[40:43]
ds_read_b128 v[72:75],v4 offset:24576
v_mfma_f32_16x16x32_bf16 v[56:59],v[80:83],v[208:211],v[56:59]
v_mfma_f32_16x16x32_bf16 v[24:27],a[80:83],v[80:83],v[24:27]
ds_read_b128 v[76:79],v4 offset:28672
v_mfma_f32_16x16x32_bf16 v[44:47],a[208:211],v[84:87],v[44:47]
v_mfma_f32_16x16x32_bf16 v[60:63],v[84:87],v[208:211],v[60:63]
v_mfma_f32_16x16x32_bf16 v[28:31],a[80:83],v[84:87],v[28:31]
v_mfma_f32_16x16x32_bf16 v[48:51],a[216:219],v[80:83],v[48:51]
v_mfma_f32_16x16x32_bf16 v[64:67],v[80:83],v[216:219],v[64:67]
v_mfma_f32_16x16x32_bf16 v[32:35],a[88:91],v[80:83],v[32:35]
v_mfma_f32_16x16x32_bf16 v[52:55],a[216:219],v[84:87],v[52:55]
v_mfma_f32_16x16x32_bf16 v[68:71],v[84:87],v[216:219],v[68:71]
v_mfma_f32_16x16x32_bf16 v[36:39],a[88:91],v[84:87],v[36:39]
s_waitcnt lgkmcnt(2)
v_mfma_f32_16x16x32_bf16 v[40:43],a[212:215],v[108:111],v[40:43]
ds_read_b128 v[80:83],v5 offset:24576
v_mfma_f32_16x16x32_bf16 v[56:59],v[108:111],v[212:215],v[56:59]
v_mfma_f32_16x16x32_bf16 v[24:27],a[84:87],v[108:111],v[24:27]
ds_read_b128 v[84:87],v5 offset:28672
v_mfma_f32_16x16x32_bf16 v[44:47],a[212:215],v[112:115],v[44:47]
v_mfma_f32_16x16x32_bf16 v[60:63],v[112:115],v[212:215],v[60:63]
v_mfma_f32_16x16x32_bf16 v[28:31],a[84:87],v[112:115],v[28:31]
v_mfma_f32_16x16x32_bf16 v[48:51],a[220:223],v[108:111],v[48:51]
v_mfma_f32_16x16x32_bf16 v[64:67],v[108:111],v[220:223],v[64:67]
v_mfma_f32_16x16x32_bf16 v[32:35],a[92:95],v[108:111],v[32:35]
v_mfma_f32_16x16x32_bf16 v[52:55],a[220:223],v[112:115],v[52:55]
v_mfma_f32_16x16x32_bf16 v[68:71],v[112:115],v[220:223],v[68:71]
v_mfma_f32_16x16x32_bf16 v[36:39],a[92:95],v[112:115],v[36:39]
s_barrier
s_waitcnt lgkmcnt(2)
v_mfma_f32_16x16x32_bf16 v[40:43],a[224:227],v[72:75],v[40:43]
ds_read_b128 v[108:111],v6 offset:24576
v_mfma_f32_16x16x32_bf16 v[56:59],v[72:75],v[224:227],v[56:59]
s_add_u32 m0,s50,131072
v_mfma_f32_16x16x32_bf16 v[24:27],a[96:99],v[72:75],v[24:27]
ds_read_b128 v[112:115],v6 offset:28672
v_mfma_f32_16x16x32_bf16 v[44:47],a[224:227],v[76:79],v[44:47]
buffer_load_dwordx4 v20,s[8:11],s70 offen offset:0 sc1 lds
v_mfma_f32_16x16x32_bf16 v[60:63],v[76:79],v[224:227],v[60:63]
s_add_u32 m0,s50,135168
v_mfma_f32_16x16x32_bf16 v[28:31],a[96:99],v[76:79],v[28:31]
buffer_load_dwordx4 v20,s[8:11],s71 offen offset:0 sc1 lds
v_mfma_f32_16x16x32_bf16 v[48:51],a[232:235],v[72:75],v[48:51]
s_add_u32 m0,s50,139008
v_mfma_f32_16x16x32_bf16 v[64:67],v[72:75],v[232:235],v[64:67]
buffer_load_dwordx4 v20,s[8:11],s70 offen offset:256 sc1 lds
v_mfma_f32_16x16x32_bf16 v[32:35],a[104:107],v[72:75],v[32:35]
s_add_u32 m0,s50,143104
v_mfma_f32_16x16x32_bf16 v[52:55],a[232:235],v[76:79],v[52:55]
buffer_load_dwordx4 v20,s[8:11],s71 offen offset:256 sc1 lds
v_mfma_f32_16x16x32_bf16 v[68:71],v[76:79],v[232:235],v[68:71]
s_add_u32 m0,s50,146944
v_mfma_f32_16x16x32_bf16 v[36:39],a[104:107],v[76:79],v[36:39]
buffer_load_dwordx4 v20,s[8:11],s70 offen offset:512 sc1 lds
s_waitcnt lgkmcnt(2)
v_mfma_f32_16x16x32_bf16 v[40:43],a[228:231],v[80:83],v[40:43]
ds_read_b128 v[72:75],v7 offset:24576
v_mfma_f32_16x16x32_bf16 v[56:59],v[80:83],v[228:231],v[56:59]
s_add_u32 m0,s50,151040
v_mfma_f32_16x16x32_bf16 v[24:27],a[100:103],v[80:83],v[24:27]
ds_read_b128 v[76:79],v7 offset:28672
v_mfma_f32_16x16x32_bf16 v[44:47],a[228:231],v[84:87],v[44:47]
buffer_load_dwordx4 v20,s[8:11],s71 offen offset:512 sc1 lds
v_mfma_f32_16x16x32_bf16 v[60:63],v[84:87],v[228:231],v[60:63]
buffer_load_dwordx2 v[124:125],v23,s[8:11],s76 offen sc1
v_mfma_f32_16x16x32_bf16 v[28:31],a[100:103],v[84:87],v[28:31]
v_mfma_f32_16x16x32_bf16 v[48:51],a[236:239],v[80:83],v[48:51]
v_mfma_f32_16x16x32_bf16 v[64:67],v[80:83],v[236:239],v[64:67]
v_mfma_f32_16x16x32_bf16 v[32:35],a[108:111],v[80:83],v[32:35]
v_mfma_f32_16x16x32_bf16 v[52:55],a[236:239],v[84:87],v[52:55]
v_mfma_f32_16x16x32_bf16 v[68:71],v[84:87],v[236:239],v[68:71]
v_mfma_f32_16x16x32_bf16 v[36:39],a[108:111],v[84:87],v[36:39]
s_waitcnt lgkmcnt(2)
v_mfma_f32_16x16x32_bf16 v[40:43],a[240:243],v[108:111],v[40:43]
v_mfma_f32_16x16x32_bf16 v[56:59],v[108:111],v[240:243],v[56:59]
v_mfma_f32_16x16x32_bf16 v[24:27],a[112:115],v[108:111],v[24:27]
v_mfma_f32_16x16x32_bf16 v[44:47],a[240:243],v[112:115],v[44:47]
v_mfma_f32_16x16x32_bf16 v[60:63],v[112:115],v[240:243],v[60:63]
v_mfma_f32_16x16x32_bf16 v[28:31],a[112:115],v[112:115],v[28:31]
v_mfma_f32_16x16x32_bf16 v[48:51],a[248:251],v[108:111],v[48:51]
v_mfma_f32_16x16x32_bf16 v[64:67],v[108:111],v[248:251],v[64:67]
v_mfma_f32_16x16x32_bf16 v[32:35],a[120:123],v[108:111],v[32:35]
v_mfma_f32_16x16x32_bf16 v[52:55],a[248:251],v[112:115],v[52:55]
v_mfma_f32_16x16x32_bf16 v[68:71],v[112:115],v[248:251],v[68:71]
v_mfma_f32_16x16x32_bf16 v[36:39],a[120:123],v[112:115],v[36:39]
s_waitcnt lgkmcnt(0)
v_mfma_f32_16x16x32_bf16 v[40:43],a[244:247],v[72:75],v[40:43]
v_mfma_f32_16x16x32_bf16 v[56:59],v[72:75],v[244:247],v[56:59]
v_mfma_f32_16x16x32_bf16 v[24:27],a[116:119],v[72:75],v[24:27]
v_mfma_f32_16x16x32_bf16 v[44:47],a[244:247],v[76:79],v[44:47]
v_mfma_f32_16x16x32_bf16 v[60:63],v[76:79],v[244:247],v[60:63]
v_mfma_f32_16x16x32_bf16 v[28:31],a[116:119],v[76:79],v[28:31]
v_mfma_f32_16x16x32_bf16 v[48:51],a[252:255],v[72:75],v[48:51]
v_mfma_f32_16x16x32_bf16 v[64:67],v[72:75],v[252:255],v[64:67]
v_mfma_f32_16x16x32_bf16 v[32:35],a[124:127],v[72:75],v[32:35]
v_mfma_f32_16x16x32_bf16 v[52:55],a[252:255],v[76:79],v[52:55]
v_mfma_f32_16x16x32_bf16 v[68:71],v[76:79],v[252:255],v[68:71]
v_mfma_f32_16x16x32_bf16 v[36:39],a[124:127],v[76:79],v[36:39]
s_lshl_b32 s56,s51,5
s_add_u32 s56,s56,s47
s_lshl_b32 s56,s56,12
s_add_u32 s56,s56,s50
s_add_u32 s56,s56,41943040
v_mov_b64 v[120:121],-1
v_mov_b64 v[122:123],-1
buffer_store_dwordx4 v[120:123],v0,s[8:11],s56 offen sc1
v_cvt_pk_bf16_f32 v72,v40,v48
v_cvt_pk_bf16_f32 v73,v41,v49
v_cvt_pk_bf16_f32 v74,v42,v50
v_cvt_pk_bf16_f32 v75,v43,v51
buffer_store_dwordx4 v[72:75],v0,s[8:11],s61 offen sc1
v_cvt_pk_bf16_f32 v76,v44,v52
v_cvt_pk_bf16_f32 v77,v45,v53
v_cvt_pk_bf16_f32 v78,v46,v54
v_cvt_pk_bf16_f32 v79,v47,v55
buffer_store_dwordx4 v[76:79],v0,s[8:11],s62 offen sc1
v_cvt_pk_bf16_f32 v80,v56,v57
v_cvt_pk_bf16_f32 v81,v58,v59
v_cvt_pk_bf16_f32 v82,v60,v61
v_cvt_pk_bf16_f32 v83,v62,v63
buffer_store_dwordx4 v[80:83],v0,s[8:11],s65 offen offset:0 sc1
v_cvt_pk_bf16_f32 v84,v64,v65
v_cvt_pk_bf16_f32 v85,v66,v67
v_cvt_pk_bf16_f32 v86,v68,v69
v_cvt_pk_bf16_f32 v87,v70,v71
buffer_store_dwordx4 v[84:87],v0,s[8:11],s65 offen offset:1024 sc1
v_cvt_pk_bf16_f32 v108,v24,v32
v_cvt_pk_bf16_f32 v109,v25,v33
v_cvt_pk_bf16_f32 v110,v26,v34
v_cvt_pk_bf16_f32 v111,v27,v35
buffer_store_dwordx4 v[108:111],v0,s[8:11],s63 offen sc1
v_cvt_pk_bf16_f32 v112,v28,v36
v_cvt_pk_bf16_f32 v113,v29,v37
v_cvt_pk_bf16_f32 v114,v30,v38
v_cvt_pk_bf16_f32 v115,v31,v39
buffer_store_dwordx4 v[112:115],v0,s[8:11],s64 offen sc1
s_lshl_b32 s72,s51,13
s_lshl2_add_u32 s72,s47,s72
s_add_u32 s72,s72,10485760
s_sub_u32 s53,s53,1
s_cmp_gt_i32 s53,3
s_cbranch_scc1 L_mo_372
s_cmp_gt_i32 s53,0
s_cselect_b32 s87,1,3
s_mov_b32 s18,0
s_waitcnt vmcnt(7)
s_branch L_mo_377
L_mo_370:
s_mov_b32 s55,s22
s_mov_b32 s22,s23
s_mov_b32 s23,s24
s_mov_b32 s24,-1
s_cmp_lg_u32 s55,-1
s_cbranch_scc1 L_mp_368
s_sub_u32 s56,s30,s31
s_cmp_gt_i32 s77,0
s_cselect_b32 s57,6,15
s_cmp_lg_u32 s86,0
s_cselect_b32 s57,9,s57
s_cmp_lt_i32 s56,s57
s_cbranch_scc1 L_mo_371
s_cmp_lt_i32 s56,30
s_cselect_b32 s87,s18,0
s_cmp_ge_u32 s31,8
s_cselect_b32 s56,1,s18
s_and_b32 s56,s56,s86
s_cselect_b32 s87,2,s87
s_mul_i32 s56,s87,s18
s_cmp_lg_u32 s56,0
s_cbranch_scc1 L_mo_375
s_mov_b32 s18,0
s_lshr_b32 s56,s72,31
s_or_b32 s56,s56,s87
s_cbranch_scc1 L_mo_381
s_waitcnt vmcnt(0)
s_barrier
s_or_b32 s72,s72,s52
buffer_store_dword v17,off,s[8:11],s72 sc1
s_mov_b32 s72,0x80000000
L_mo_381:
s_cmp_lg_u32 s46,0
s_cbranch_scc1 L_mo_379
s_lshl_b32 s76,s31,13
s_add_u32 s76,s76,10487040
L_mo_378:
buffer_load_dwordx2 v[124:125],v23,s[8:11],s76 offen sc1
s_sub_u32 s49,s49,1
s_cbranch_scc1 L_abort2
s_waitcnt vmcnt(0)
L_mo_377:
v_min_u32 v123,v124,v125
v_max_u32 v125,v124,v125
v_cmp_eq_u32 vcc,0,v123
s_nop 1
v_cndmask_b32 v125,v125,-1,vcc
s_and_b32 s56,vcc_lo,0xffff
s_cbranch_scc0 L_mo_382
s_cmp_lg_u32 s87,0
s_cbranch_scc1 L_mo_382
s_mov_b32 s18,1
s_sleep 2
s_branch L_mo_378
L_mo_382:
v_max_u32_dpp v125,v125,v125 row_ror:8 row_mask:0xf bank_mask:0xf
s_nop 1
v_max_u32_dpp v125,v125,v125 row_ror:4 row_mask:0xf bank_mask:0xf
s_nop 1
v_max_u32_dpp v125,v125,v125 row_ror:2 row_mask:0xf bank_mask:0xf
s_nop 1
v_max_u32_dpp v125,v125,v125 row_ror:1 row_mask:0xf bank_mask:0xf
L_mo_379:
s_sub_u32 s49,s49,1
s_cbranch_scc1 L_abort2
v_mov_b32 v124,s18
s_barrier
s_cmp_lg_u32 s46,0
s_cbranch_scc1 L_mo_380
ds_write_b32 v16,v125
ds_write_b32 v19,v124 offset:16
s_waitcnt lgkmcnt(0)
L_mo_380:
s_barrier
ds_read_b128 v[120:123],v19
ds_read_b32 v124,v19 offset:16
s_waitcnt lgkmcnt(0)
v_readfirstlane_b32 s55,v120
v_readfirstlane_b32 s22,v121
v_readfirstlane_b32 s23,v122
v_readfirstlane_b32 s24,v123
v_readfirstlane_b32 s18,v124
s_cmp_lg_u32 s55,-1
s_cbranch_scc1 L_mp_368
L_mo_375:
s_mov_b32 s22,-1
s_cmp_eq_u32 s87,1
s_cbranch_scc1 L_mo_371
s_cmp_eq_u32 s87,2
s_cbranch_scc1 L_mo_376
s_branch L_mo_370
L_mp_368:
s_mov_b32 s53,0
s_sub_u32 s73,s73,1
s_max_i32 s73,s73,0
s_sub_u32 s77,s77,1
s_min_u32 s61,s73,2
s_cmp_lt_u32 s31,5
s_cselect_b32 s60,s25,0
s_cmp_lt_u32 s55,s60
s_cselect_b32 s61,2,s61
s_cmp_le_u32 s55,s54
s_cbranch_scc1 L_mr_369
s_mov_b32 s77,s61
s_mov_b32 s54,s55
s_mov_b32 s86,0
s_or_b32 s61,s47,s46
s_cbranch_scc1 L_mr_369
v_mov_b32 v120,s54
v_lshlrev_b32 v121,13,v1
s_mov_b32 s61,10486784
buffer_store_dword v120,v121,s[8:11],s61 offen sc1
L_mr_369:
s_cmp_lg_u32 s31,63
s_cbranch_scc1 L_mo_373
s_min_i32 s77,s77,0
s_or_b32 s61,s47,s46
s_cbranch_scc1 L_mo_373
s_mov_b32 s59,11018240
v_lshlrev_b32 v120,2,v1
L_fp_384:
s_sleep 0
buffer_load_dword v121,v120,s[8:11],s59 offen sc1
s_sub_u32 s49,s49,1
s_cbranch_scc1 L_abort2
s_waitcnt vmcnt(0)
v_cmp_eq_u32 vcc,0,v121
s_cbranch_vccnz L_fp_384
s_andn2_b32 s62,0x7ff,s54
v_lshl_or_b32 v121,s62,8,v121
s_add_u32 s59,s59,8192
buffer_store_dword v121,v120,s[8:11],s59 offen sc1
s_add_u32 s59,s59,8192
buffer_store_dword v121,v120,s[8:11],s59 offen sc1
s_add_u32 s59,s59,8192
buffer_store_dword v121,v120,s[8:11],s59 offen sc1
s_add_u32 s59,s59,8192
buffer_store_dword v121,v120,s[8:11],s59 offen sc1
s_add_u32 s59,s59,8192
buffer_store_dword v121,v120,s[8:11],s59 offen sc1
s_add_u32 s59,s59,8192
buffer_store_dword v121,v120,s[8:11],s59 offen sc1
L_mo_373:
s_add_u32 s31,s31,1
s_cmp_gt_i32 s77,0
s_cmov_b32 s18,0
s_cbranch_scc1 L_mo_370
s_cmp_lg_u32 s77,0
s_cbranch_scc1 L_mo_374
s_andn2_b32 s51,0x7ff,s54
s_lshr_b32 s51,s51,5
s_add_u32 s73,s73,2
s_mov_b32 s86,1
s_mov_b32 s19,0
s_mov_b32 s18,0
s_waitcnt vmcnt(8)
s_barrier
s_andn2_b32 s64,0x7ff,s54
s_lshl_b32 s56,s64,10
s_add_u32 s58,s56,4194304
buffer_load_dwordx4 v[88:91],v0,s[8:11],s58 offen sc1
v_and_b32 v9,15,v1
v_lshrrev_b32 v10,4,v1
v_and_b32 v124,1,v1
v_lshlrev_b32 v124,4,v124
v_mov_b32 v125,0xffff
v_lshlrev_b32 v125,v124,v125
v_lshrrev_b32 v124,2,v9
v_cmp_eq_u32 vcc,0,v124
s_nop 1
v_cndmask_b32 v12,0,v125,vcc
v_cmp_eq_u32 vcc,1,v124
s_nop 1
v_cndmask_b32 v13,0,v125,vcc
v_and_b32 v124,2,v1
v_cmp_eq_u32 vcc,0,v124
v_mov_b32 v14,0xeeee
v_mov_b32 v124,0x4444
v_cndmask_b32 v14,v14,v124,vcc
v_lshlrev_b32 v11,14,v10
v_lshl_add_u32 v11,v9,4,v11
s_lshl_b32 s65,s51,15
s_add_u32 s65,s65,92274688
s_lshl_b32 s62,s47,10
s_add_u32 s62,s62,s65
s_lshl_b32 s63,s47,16
s_lshl_b32 s60,s46,8
s_add_u32 s63,s63,s60
s_mov_b32 s4,s38
s_mov_b32 s5,s39
s_mov_b32 s6,1835008
s_mov_b32 s7,0x20000
s_lshl_b32 s57,s46,11
s_add_u32 s57,s57,139264
v_add_u32 v8,s57,v0
v_and_b32 v2,1,v10
v_lshrrev_b32 v3,1,v10
v_lshlrev_b32 v2,7,v2
v_lshl_add_u32 v2,v3,10,v2
s_lshl_b32 s59,s46,8
s_add_u32 s59,s57,s59
v_add_u32 v2,s59,v2
s_mov_b32 s60,0x01000100
s_mov_b32 s61,0x03020302
s_waitcnt vmcnt(0)
L_mx_385:
v_max3_u32 v124,v88,v89,v90
v_max_u32 v124,v91,v124
v_cmp_eq_u32 vcc,-1,v124
s_cbranch_vccz L_mxd_386
buffer_load_dwordx4 v[88:91],v0,s[8:11],s58 offen sc1
s_sub_u32 s49,s49,1
s_cbranch_scc1 L_abort2
s_waitcnt vmcnt(0)
s_branch L_mx_385
L_mxd_386:
buffer_load_dwordx4 v[24:27],v11,s[4:7],s63 offen offset:0
buffer_load_dwordx4 v[28:31],v11,s[4:7],s63 offen offset:1024
buffer_load_dwordx4 v[32:35],v11,s[4:7],s63 offen offset:2048
buffer_load_dwordx4 v[36:39],v11,s[4:7],s63 offen offset:3072
v_lshlrev_b32 v96,16,v88
v_and_b32 v97,0xffff0000,v88
v_lshlrev_b32 v98,16,v89
v_and_b32 v99,0xffff0000,v89
v_lshlrev_b32 v100,16,v90
v_and_b32 v101,0xffff0000,v90
v_lshlrev_b32 v102,16,v91
v_and_b32 v103,0xffff0000,v91
v_readfirstlane_b32 s78,v96
s_nop 1
v_pk_add_f32 v[108:109],v[96:97],s[78:79] op_sel_hi:[1,0] neg_lo:[0,1] neg_hi:[0,1]
v_pk_add_f32 v[110:111],v[98:99],s[78:79] op_sel_hi:[1,0] neg_lo:[0,1] neg_hi:[0,1]
v_pk_add_f32 v[112:113],v[100:101],s[78:79] op_sel_hi:[1,0] neg_lo:[0,1] neg_hi:[0,1]
v_pk_add_f32 v[114:115],v[102:103],s[78:79] op_sel_hi:[1,0] neg_lo:[0,1] neg_hi:[0,1]
v_pk_add_f32 v[116:117],v[108:109],v[110:111]
v_pk_mul_f32 v[118:119],v[108:109],v[108:109]
v_pk_add_f32 v[120:121],v[112:113],v[114:115]
v_pk_fma_f32 v[118:119],v[110:111],v[110:111],v[118:119]
v_pk_add_f32 v[116:117],v[116:117],v[120:121]
v_pk_fma_f32 v[118:119],v[112:113],v[112:113],v[118:119]
v_add_f32 v116,v116,v117
v_pk_fma_f32 v[118:119],v[114:115],v[114:115],v[118:119]
v_add_f32 v118,v118,v119
s_nop 1
v_permlane32_swap_b32 v116,v118
v_add_f32 v116,v116,v118
s_nop 1
v_add_f32_dpp v116,v116,v116 row_ror:8 row_mask:0xf bank_mask:0xf
s_nop 1
v_add_f32_dpp v116,v116,v116 row_ror:4 row_mask:0xf bank_mask:0xf
s_nop 1
v_add_f32_dpp v116,v116,v116 row_ror:2 row_mask:0xf bank_mask:0xf
s_nop 1
v_add_f32_dpp v116,v116,v116 row_ror:1 row_mask:0xf bank_mask:0xf
v_mov_b32 v118,v116
s_nop 1
v_permlane16_swap_b32 v116,v118
v_add_f32 v116,v116,v118
v_mul_f32 v116,0x3b000000,v116
v_mov_b32 v118,v116
s_nop 1
v_permlane32_swap_b32 v116,v118
v_fma_f32 v118,-v116,v116,v118
v_add_f32 v116,s78,v116
v_max_f32 v118,0,v118
v_cvt_pk_bf16_f32 v118,v116,v118
v_lshlrev_b32 v116,16,v118
v_and_b32 v118,0xffff0000,v118
v_add_f32 v118,0x3727c5ac,v118
v_cvt_pk_bf16_f32 v118,v118,v118
v_and_b32 v118,0xffff0000,v118
v_sqrt_f32 v118,v118
v_pk_add_f32 v[108:109],v[96:97],v[116:117] op_sel_hi:[1,0] neg_lo:[0,1] neg_hi:[0,1]
v_pk_add_f32 v[110:111],v[98:99],v[116:117] op_sel_hi:[1,0] neg_lo:[0,1] neg_hi:[0,1]
v_pk_add_f32 v[112:113],v[100:101],v[116:117] op_sel_hi:[1,0] neg_lo:[0,1] neg_hi:[0,1]
v_pk_add_f32 v[114:115],v[102:103],v[116:117] op_sel_hi:[1,0] neg_lo:[0,1] neg_hi:[0,1]
v_cvt_pk_bf16_f32 v118,v118,v118
v_and_b32 v118,0xffff0000,v118
v_rcp_f32 v118,v118
v_cvt_pk_bf16_f32 v104,v108,v109
v_cvt_pk_bf16_f32 v105,v110,v111
v_cvt_pk_bf16_f32 v106,v112,v113
v_cvt_pk_bf16_f32 v107,v114,v115
v_lshlrev_b32 v108,16,v104
v_and_b32 v109,0xffff0000,v104
v_lshlrev_b32 v110,16,v105
v_and_b32 v111,0xffff0000,v105
v_lshlrev_b32 v112,16,v106
v_and_b32 v113,0xffff0000,v106
v_lshlrev_b32 v114,16,v107
v_and_b32 v115,0xffff0000,v107
v_pk_mul_f32 v[108:109],v[108:109],v[118:119] op_sel_hi:[1,0]
v_pk_mul_f32 v[110:111],v[110:111],v[118:119] op_sel_hi:[1,0]
v_pk_mul_f32 v[112:113],v[112:113],v[118:119] op_sel_hi:[1,0]
v_pk_mul_f32 v[114:115],v[114:115],v[118:119] op_sel_hi:[1,0]
v_cvt_pk_bf16_f32 v104,v108,v109
v_cvt_pk_bf16_f32 v105,v110,v111
v_cvt_pk_bf16_f32 v106,v112,v113
v_cvt_pk_bf16_f32 v107,v114,v115
v_perm_b32 v88,v104,v104,s60
v_perm_b32 v89,v105,v105,s60
v_perm_b32 v90,v106,v106,s60
v_perm_b32 v91,v107,v107,s60
ds_write_b128 v8,v[88:91]
v_perm_b32 v92,v104,v104,s61
v_perm_b32 v93,v105,v105,s61
v_perm_b32 v94,v106,v106,s61
v_perm_b32 v95,v107,v107,s61
ds_write_b128 v8,v[92:95] offset:1024
s_mov_b32 s58,s57
ds_read_b128 v[88:91],v2 offset:0
ds_read_b128 v[92:95],v2 offset:64
ds_read_b128 v[108:111],v18 offset:0
ds_read_b128 v[112:115],v18 offset:1024
ds_read_b128 v[64:67],v18 offset:2048
ds_read_b128 v[68:71],v18 offset:3072
ds_read_b128 v[72:75],v18 offset:4096
ds_read_b128 v[76:79],v18 offset:5120
ds_read_b128 v[80:83],v18 offset:6144
ds_read_b128 v[84:87],v18 offset:7168
v_mov_b64 v[116:117],0
v_mov_b64 v[118:119],0
s_waitcnt lgkmcnt(8)
v_and_b32 v120,v12,v88
v_and_b32 v121,v13,v88
v_and_b32 v122,v12,v92
v_and_b32 v123,v13,v92
s_waitcnt lgkmcnt(6)
s_nop 0
v_smfmac_f32_16x16x64_bf16 v[116:119],v[120:123],v[108:115],v14
ds_read_b128 v[108:111],v18 offset:8192
ds_read_b128 v[112:115],v18 offset:9216
s_add_u32 s63,s63,4096
buffer_load_dwordx4 v[40:43],v11,s[4:7],s63 offen offset:0
v_and_b32 v124,v12,v89
v_and_b32 v125,v13,v89
v_and_b32 v126,v12,v93
v_and_b32 v127,v13,v93
s_waitcnt lgkmcnt(6)
s_nop 0
v_smfmac_f32_16x16x64_bf16 v[116:119],v[124:127],v[64:71],v14
ds_read_b128 v[64:67],v18 offset:10240
ds_read_b128 v[68:71],v18 offset:11264
buffer_load_dwordx4 v[44:47],v11,s[4:7],s63 offen offset:1024
v_and_b32 v120,v12,v90
v_and_b32 v121,v13,v90
v_and_b32 v122,v12,v94
v_and_b32 v123,v13,v94
s_waitcnt lgkmcnt(6)
s_nop 0
v_smfmac_f32_16x16x64_bf16 v[116:119],v[120:123],v[72:79],v14
ds_read_b128 v[72:75],v18 offset:12288
ds_read_b128 v[76:79],v18 offset:13312
buffer_load_dwordx4 v[48:51],v11,s[4:7],s63 offen offset:2048
v_and_b32 v124,v12,v91
v_and_b32 v125,v13,v91
v_and_b32 v126,v12,v95
v_and_b32 v127,v13,v95
ds_read_b128 v[88:91],v2 offset:16
ds_read_b128 v[92:95],v2 offset:80
s_waitcnt lgkmcnt(8)
v_smfmac_f32_16x16x64_bf16 v[116:119],v[124:127],v[80:87],v14
ds_read_b128 v[80:83],v18 offset:14336
ds_read_b128 v[84:87],v18 offset:15360
buffer_load_dwordx4 v[52:55],v11,s[4:7],s63 offen offset:3072
s_waitcnt lgkmcnt(2)
v_and_b32 v120,v12,v88
v_and_b32 v121,v13,v88
v_and_b32 v122,v12,v92
v_and_b32 v123,v13,v92
s_waitcnt lgkmcnt(8)
s_nop 0
v_smfmac_f32_16x16x64_bf16 v[116:119],v[120:123],v[108:115],v14
ds_read_b128 v[108:111],v18 offset:16384
ds_read_b128 v[112:115],v18 offset:17408
s_add_u32 s63,s63,4096
buffer_load_dwordx4 v[56:59],v11,s[4:7],s63 offen offset:0
v_and_b32 v124,v12,v89
v_and_b32 v125,v13,v89
v_and_b32 v126,v12,v93
v_and_b32 v127,v13,v93
s_waitcnt lgkmcnt(8)
s_nop 0
v_smfmac_f32_16x16x64_bf16 v[116:119],v[124:127],v[64:71],v14
ds_read_b128 v[64:67],v18 offset:18432
ds_read_b128 v[68:71],v18 offset:19456
buffer_load_dwordx4 v[60:63],v11,s[4:7],s63 offen offset:1024
v_and_b32 v120,v12,v90
v_and_b32 v121,v13,v90
v_and_b32 v122,v12,v94
v_and_b32 v123,v13,v94
s_waitcnt lgkmcnt(8)
s_nop 0
v_smfmac_f32_16x16x64_bf16 v[116:119],v[120:123],v[72:79],v14
ds_read_b128 v[72:75],v18 offset:20480
ds_read_b128 v[76:79],v18 offset:21504
v_and_b32 v124,v12,v91
v_and_b32 v125,v13,v91
v_and_b32 v126,v12,v95
v_and_b32 v127,v13,v95
ds_read_b128 v[88:91],v2 offset:32
ds_read_b128 v[92:95],v2 offset:96
s_waitcnt lgkmcnt(8)
v_smfmac_f32_16x16x64_bf16 v[116:119],v[124:127],v[80:87],v14
ds_read_b128 v[80:83],v18 offset:22528
ds_read_b128 v[84:87],v18 offset:23552
s_waitcnt lgkmcnt(2)
v_and_b32 v120,v12,v88
v_and_b32 v121,v13,v88
v_and_b32 v122,v12,v92
v_and_b32 v123,v13,v92
s_waitcnt lgkmcnt(8)
s_nop 0
v_smfmac_f32_16x16x64_bf16 v[116:119],v[120:123],v[108:115],v14
ds_read_b128 v[108:111],v18 offset:24576
ds_read_b128 v[112:115],v18 offset:25600
v_and_b32 v124,v12,v89
v_and_b32 v125,v13,v89
v_and_b32 v126,v12,v93
v_and_b32 v127,v13,v93
s_waitcnt lgkmcnt(8)
s_nop 0
v_smfmac_f32_16x16x64_bf16 v[116:119],v[124:127],v[64:71],v14
ds_read_b128 v[64:67],v18 offset:26624
ds_read_b128 v[68:71],v18 offset:27648
v_and_b32 v120,v12,v90
v_and_b32 v121,v13,v90
v_and_b32 v122,v12,v94
v_and_b32 v123,v13,v94
s_waitcnt lgkmcnt(8)
s_nop 0
v_smfmac_f32_16x16x64_bf16 v[116:119],v[120:123],v[72:79],v14
ds_read_b128 v[72:75],v18 offset:28672
ds_read_b128 v[76:79],v18 offset:29696
v_and_b32 v124,v12,v91
v_and_b32 v125,v13,v91
v_and_b32 v126,v12,v95
v_and_b32 v127,v13,v95
ds_read_b128 v[88:91],v2 offset:48
ds_read_b128 v[92:95],v2 offset:112
s_waitcnt lgkmcnt(8)
v_smfmac_f32_16x16x64_bf16 v[116:119],v[124:127],v[80:87],v14
ds_read_b128 v[80:83],v18 offset:30720
ds_read_b128 v[84:87],v18 offset:31744
s_waitcnt lgkmcnt(2)
v_and_b32 v120,v12,v88
v_and_b32 v121,v13,v88
v_and_b32 v122,v12,v92
v_and_b32 v123,v13,v92
s_waitcnt lgkmcnt(8)
s_nop 0
v_smfmac_f32_16x16x64_bf16 v[116:119],v[120:123],v[108:115],v14
v_and_b32 v124,v12,v89
v_and_b32 v125,v13,v89
v_and_b32 v126,v12,v93
v_and_b32 v127,v13,v93
s_waitcnt lgkmcnt(6)
s_nop 0
v_smfmac_f32_16x16x64_bf16 v[116:119],v[124:127],v[64:71],v14
buffer_load_dwordx4 v[64:67],v11,s[4:7],s63 offen offset:2048
buffer_load_dwordx4 v[68:71],v11,s[4:7],s63 offen offset:3072
v_and_b32 v120,v12,v90
v_and_b32 v121,v13,v90
v_and_b32 v122,v12,v94
v_and_b32 v123,v13,v94
s_waitcnt lgkmcnt(4)
s_nop 0
v_smfmac_f32_16x16x64_bf16 v[116:119],v[120:123],v[72:79],v14
s_add_u32 s63,s63,4096
buffer_load_dwordx4 v[72:75],v11,s[4:7],s63 offen offset:0
buffer_load_dwordx4 v[76:79],v11,s[4:7],s63 offen offset:1024
v_and_b32 v124,v12,v91
v_and_b32 v125,v13,v91
v_and_b32 v126,v12,v95
v_and_b32 v127,v13,v95
s_waitcnt lgkmcnt(0)
s_nop 0
v_smfmac_f32_16x16x64_bf16 v[116:119],v[124:127],v[80:87],v14
buffer_load_dwordx4 v[80:83],v11,s[4:7],s63 offen offset:2048
buffer_load_dwordx4 v[84:87],v11,s[4:7],s63 offen offset:3072
v_lshlrev_b32 v8,5,v9
v_and_b32 v124,1,v10
v_lshl_add_u32 v8,v124,4,v8
v_lshrrev_b32 v124,1,v10
v_lshl_add_u32 v8,v124,11,v8
s_lshl_b32 s60,s46,9
s_add_u32 s60,s60,147456
v_add_u32 v8,s60,v8
ds_write_b128 v8,v[116:119]
v_lshlrev_b32 v8,2,v1
v_add_u32 v8,147456,v8
v_and_b32 v2,1,v1
v_lshrrev_b32 v3,1,v1
v_lshlrev_b32 v3,2,v3
v_lshl_add_u32 v2,v2,7,v3
v_add_u32 v2,s58,v2
v_lshlrev_b32 v3,6,v10
v_add_u32 v3,s58,v3
s_waitcnt lgkmcnt(0)
s_barrier
ds_read2st64_b32 v[88:89],v8 offset0:0 offset1:1
ds_read2st64_b32 v[90:91],v8 offset0:2 offset1:3
ds_read2st64_b32 v[92:93],v8 offset0:4 offset1:5
ds_read2st64_b32 v[94:95],v8 offset0:6 offset1:7
s_waitcnt lgkmcnt(0)
v_pk_add_f32 v[88:89],v[88:89],v[90:91]
v_pk_add_f32 v[92:93],v[92:93],v[94:95]
v_pk_add_f32 v[88:89],v[88:89],v[92:93]
v_cvt_pk_bf16_f32 v88,v88,v88
v_and_b32 v88,0xffff0000,v88
v_cvt_pk_bf16_f32 v89,v89,v89
v_and_b32 v89,0xffff0000,v89
v_mul_f32 v90,0xbfb8aa3b,v88
v_exp_f32 v90,v90
s_nop 0
v_add_f32 v90,1.0,v90
v_rcp_f32 v90,v90
s_nop 0
v_mul_f32 v88,v88,v90
v_cvt_pk_bf16_f32 v88,v88,v88
v_and_b32 v88,0xffff0000,v88
v_mul_f32 v88,v88,v89
v_cvt_pk_bf16_f32 v88,v88,v88
ds_write_b32 v2,v88
ds_read_b128 v[88:91],v3
ds_read_b128 v[108:111],v3 offset:32
ds_read_b128 v[92:95],v3 offset:16
ds_read_b128 v[112:115],v3 offset:48
v_mov_b64 v[116:117],0
v_mov_b64 v[118:119],0
s_waitcnt vmcnt(0) lgkmcnt(0)
v_and_b32 v120,v12,v88
v_and_b32 v121,v13,v88
v_and_b32 v122,v12,v108
v_and_b32 v123,v13,v108
v_and_b32 v124,v12,v89
v_and_b32 v125,v13,v89
v_smfmac_f32_16x16x64_bf16 v[116:119],v[120:123],v[24:31],v14
v_and_b32 v126,v12,v109
v_and_b32 v127,v13,v109
v_and_b32 v120,v12,v90
v_and_b32 v121,v13,v90
v_smfmac_f32_16x16x64_bf16 v[116:119],v[124:127],v[32:39],v14
v_and_b32 v122,v12,v110
v_and_b32 v123,v13,v110
v_and_b32 v124,v12,v91
v_and_b32 v125,v13,v91
v_smfmac_f32_16x16x64_bf16 v[116:119],v[120:123],v[40:47],v14
v_and_b32 v126,v12,v111
v_and_b32 v127,v13,v111
v_and_b32 v120,v12,v92
v_and_b32 v121,v13,v92
v_smfmac_f32_16x16x64_bf16 v[116:119],v[124:127],v[48:55],v14
v_and_b32 v122,v12,v112
v_and_b32 v123,v13,v112
v_and_b32 v124,v12,v93
v_and_b32 v125,v13,v93
v_smfmac_f32_16x16x64_bf16 v[116:119],v[120:123],v[56:63],v14
v_and_b32 v126,v12,v113
v_and_b32 v127,v13,v113
v_and_b32 v120,v12,v94
v_and_b32 v121,v13,v94
v_smfmac_f32_16x16x64_bf16 v[116:119],v[124:127],v[64:71],v14
v_and_b32 v122,v12,v114
v_and_b32 v123,v13,v114
v_and_b32 v124,v12,v95
v_and_b32 v125,v13,v95
v_smfmac_f32_16x16x64_bf16 v[116:119],v[120:123],v[72:79],v14
v_and_b32 v126,v12,v115
v_and_b32 v127,v13,v115
s_nop 1
v_smfmac_f32_16x16x64_bf16 v[116:119],v[124:127],v[80:87],v14
v_lshlrev_b32 v8,4,v9
v_and_b32 v124,1,v10
v_lshl_add_u32 v8,v124,3,v8
v_and_b32 v124,2,v10
v_lshl_add_u32 v8,v124,30,v8
s_lshl_b32 s60,s46,8
s_add_u32 s59,s62,s60
s_nop 0
v_cvt_pk_bf16_f32 v24,v116,v117
v_cvt_pk_bf16_f32 v25,v118,v119
buffer_store_dwordx2 v[24:25],v8,s[8:11],s59 offen sc1
s_lshl_b32 s59,s51,13
s_lshl2_add_u32 s59,s47,s59
s_add_u32 s59,s59,10486912
s_waitcnt vmcnt(0)
s_barrier
s_or_b32 s59,s59,s52
buffer_store_dword v17,off,s[8:11],s59 sc1
s_lshl_b32 s59,s51,13
s_add_u32 s59,s59,10486912
v_and_b32 v124,31,v1
v_lshlrev_b32 v124,2,v124
L_fw_388:
buffer_load_dword v125,v124,s[8:11],s59 offen sc1
s_sub_u32 s49,s49,1
s_cbranch_scc1 L_abort2
s_waitcnt vmcnt(0)
v_cmp_eq_u32 vcc,0,v125
s_cbranch_vccnz L_fw_388
s_add_u32 s63,s65,0
buffer_load_dwordx4 v[24:27],v22,s[8:11],s63 offen sc1
s_add_u32 s63,s65,4096
buffer_load_dwordx4 v[28:31],v22,s[8:11],s63 offen sc1
s_add_u32 s63,s65,8192
buffer_load_dwordx4 v[32:35],v22,s[8:11],s63 offen sc1
s_add_u32 s63,s65,12288
buffer_load_dwordx4 v[36:39],v22,s[8:11],s63 offen sc1
s_add_u32 s63,s65,16384
buffer_load_dwordx4 v[40:43],v22,s[8:11],s63 offen sc1
s_add_u32 s63,s65,20480
buffer_load_dwordx4 v[44:47],v22,s[8:11],s63 offen sc1
s_add_u32 s63,s65,24576
buffer_load_dwordx4 v[48:51],v22,s[8:11],s63 offen sc1
s_add_u32 s63,s65,28672
buffer_load_dwordx4 v[52:55],v22,s[8:11],s63 offen sc1
v_and_b32 v64,15,v1
v_and_b32 v65,1,v1
v_lshlrev_b32 v65,4,v65
v_mov_b32 v66,0x3f80
v_lshlrev_b32 v66,v65,v66
v_lshrrev_b32 v64,1,v64
v_cmp_eq_u32 vcc,0,v64
s_nop 1
v_cndmask_b32 v56,0,v66,vcc
v_cmp_eq_u32 vcc,1,v64
s_nop 1
v_cndmask_b32 v57,0,v66,vcc
v_cmp_eq_u32 vcc,2,v64
s_nop 1
v_cndmask_b32 v58,0,v66,vcc
v_cmp_eq_u32 vcc,3,v64
s_nop 1
v_cndmask_b32 v59,0,v66,vcc
s_waitcnt vmcnt(7)
s_nop 0
v_mfma_f32_16x16x32_bf16 v[60:63],v[56:59],v[24:27],0
s_waitcnt vmcnt(6)
v_mfma_f32_16x16x32_bf16 v[60:63],v[56:59],v[28:31],v[60:63]
s_waitcnt vmcnt(5)
v_mfma_f32_16x16x32_bf16 v[60:63],v[56:59],v[32:35],v[60:63]
s_waitcnt vmcnt(4)
v_mfma_f32_16x16x32_bf16 v[60:63],v[56:59],v[36:39],v[60:63]
s_waitcnt vmcnt(3)
v_mfma_f32_16x16x32_bf16 v[60:63],v[56:59],v[40:43],v[60:63]
s_waitcnt vmcnt(2)
v_mfma_f32_16x16x32_bf16 v[60:63],v[56:59],v[44:47],v[60:63]
s_waitcnt vmcnt(1)
v_mfma_f32_16x16x32_bf16 v[60:63],v[56:59],v[48:51],v[60:63]
s_waitcnt vmcnt(0)
v_mfma_f32_16x16x32_bf16 v[60:63],v[56:59],v[52:55],v[60:63]
s_nop 7
ds_write_b128 v21,v[60:63]
s_waitcnt lgkmcnt(0)
s_barrier
s_cmp_lg_u32 s46,0
s_cbranch_scc1 L_moed_387
v_lshlrev_b32 v56,5,v1
v_add_u32 v56,155648,v56
ds_read_b128 v[24:27],v56
ds_read_b128 v[28:31],v56 offset:16
s_and_b32 s59,s54,0xffff0000
s_xor_b32 s60,s59,0x80000000
s_xor_b32 s61,s59,0xffff0000
s_cmp_lt_i32 s59,0
s_cselect_b32 s59,s60,s61
v_mov_b32 v56,s59
v_mul_f32 v56,0xbfb8aa3b,v56
v_exp_f32 v56,v56
s_nop 0
v_add_f32 v56,1.0,v56
v_rcp_f32 v56,v56
s_nop 0
v_cvt_pk_bf16_f32 v56,v56,v56
v_and_b32 v56,0xffff0000,v56
v_lshlrev_b32 v48,16,v104
v_and_b32 v49,0xffff0000,v104
v_lshlrev_b32 v50,16,v105
v_and_b32 v51,0xffff0000,v105
v_lshlrev_b32 v52,16,v106
v_and_b32 v53,0xffff0000,v106
v_lshlrev_b32 v54,16,v107
v_and_b32 v55,0xffff0000,v107
s_waitcnt lgkmcnt(0)
v_cvt_pk_bf16_f32 v40,v24,v25
v_cvt_pk_bf16_f32 v41,v26,v27
v_cvt_pk_bf16_f32 v42,v28,v29
v_cvt_pk_bf16_f32 v43,v30,v31
v_lshlrev_b32 v24,16,v40
v_and_b32 v25,0xffff0000,v40
v_lshlrev_b32 v26,16,v41
v_and_b32 v27,0xffff0000,v41
v_lshlrev_b32 v28,16,v42
v_and_b32 v29,0xffff0000,v42
v_lshlrev_b32 v30,16,v43
v_and_b32 v31,0xffff0000,v43
v_pk_mul_f32 v[24:25],v[24:25],v[56:57] op_sel_hi:[1,0]
v_pk_mul_f32 v[26:27],v[26:27],v[56:57] op_sel_hi:[1,0]
v_pk_mul_f32 v[28:29],v[28:29],v[56:57] op_sel_hi:[1,0]
v_pk_mul_f32 v[30:31],v[30:31],v[56:57] op_sel_hi:[1,0]
v_cvt_pk_bf16_f32 v40,v24,v25
v_cvt_pk_bf16_f32 v41,v26,v27
v_cvt_pk_bf16_f32 v42,v28,v29
v_cvt_pk_bf16_f32 v43,v30,v31
v_lshlrev_b32 v24,16,v40
v_and_b32 v25,0xffff0000,v40
v_lshlrev_b32 v26,16,v41
v_and_b32 v27,0xffff0000,v41
v_lshlrev_b32 v28,16,v42
v_and_b32 v29,0xffff0000,v42
v_lshlrev_b32 v30,16,v43
v_and_b32 v31,0xffff0000,v43
v_pk_add_f32 v[24:25],v[24:25],v[48:49]
v_pk_add_f32 v[26:27],v[26:27],v[50:51]
v_pk_add_f32 v[28:29],v[28:29],v[52:53]
v_pk_add_f32 v[30:31],v[30:31],v[54:55]
v_cvt_pk_bf16_f32 v40,v24,v25
v_cvt_pk_bf16_f32 v41,v26,v27
v_cvt_pk_bf16_f32 v42,v28,v29
v_cvt_pk_bf16_f32 v43,v30,v31
v_lshlrev_b32 v24,16,v40
v_and_b32 v25,0xffff0000,v40
v_lshlrev_b32 v26,16,v41
v_and_b32 v27,0xffff0000,v41
v_lshlrev_b32 v28,16,v42
v_and_b32 v29,0xffff0000,v42
v_lshlrev_b32 v30,16,v43
v_and_b32 v31,0xffff0000,v43
v_pk_add_f32 v[96:97],v[96:97],v[24:25]
v_pk_add_f32 v[98:99],v[98:99],v[26:27]
v_pk_add_f32 v[100:101],v[100:101],v[28:29]
v_pk_add_f32 v[102:103],v[102:103],v[30:31]
v_cvt_pk_bf16_f32 v80,v96,v97
v_cvt_pk_bf16_f32 v81,v98,v99
v_cvt_pk_bf16_f32 v82,v100,v101
v_cvt_pk_bf16_f32 v83,v102,v103
v_lshlrev_b32 v96,16,v80
v_and_b32 v97,0xffff0000,v80
v_lshlrev_b32 v98,16,v81
v_and_b32 v99,0xffff0000,v81
v_lshlrev_b32 v100,16,v82
v_and_b32 v101,0xffff0000,v82
v_lshlrev_b32 v102,16,v83
v_and_b32 v103,0xffff0000,v83
v_readfirstlane_b32 s78,v96
s_nop 1
v_pk_add_f32 v[58:59],v[96:97],s[78:79] op_sel_hi:[1,0] neg_lo:[0,1] neg_hi:[0,1]
v_pk_add_f32 v[60:61],v[98:99],s[78:79] op_sel_hi:[1,0] neg_lo:[0,1] neg_hi:[0,1]
v_pk_add_f32 v[62:63],v[100:101],s[78:79] op_sel_hi:[1,0] neg_lo:[0,1] neg_hi:[0,1]
v_pk_add_f32 v[64:65],v[102:103],s[78:79] op_sel_hi:[1,0] neg_lo:[0,1] neg_hi:[0,1]
v_pk_add_f32 v[66:67],v[58:59],v[60:61]
v_pk_mul_f32 v[68:69],v[58:59],v[58:59]
v_pk_add_f32 v[70:71],v[62:63],v[64:65]
v_pk_fma_f32 v[68:69],v[60:61],v[60:61],v[68:69]
v_pk_add_f32 v[66:67],v[66:67],v[70:71]
v_pk_fma_f32 v[68:69],v[62:63],v[62:63],v[68:69]
v_add_f32 v66,v66,v67
v_pk_fma_f32 v[68:69],v[64:65],v[64:65],v[68:69]
v_add_f32 v68,v68,v69
s_nop 1
v_permlane32_swap_b32 v66,v68
v_add_f32 v66,v66,v68
s_nop 1
v_add_f32_dpp v66,v66,v66 row_ror:8 row_mask:0xf bank_mask:0xf
s_nop 1
v_add_f32_dpp v66,v66,v66 row_ror:4 row_mask:0xf bank_mask:0xf
s_nop 1
v_add_f32_dpp v66,v66,v66 row_ror:2 row_mask:0xf bank_mask:0xf
s_nop 1
v_add_f32_dpp v66,v66,v66 row_ror:1 row_mask:0xf bank_mask:0xf
v_mov_b32 v68,v66
s_nop 1
v_permlane16_swap_b32 v66,v68
v_add_f32 v66,v66,v68
v_mul_f32 v66,0x3b000000,v66
v_mov_b32 v68,v66
s_nop 1
v_permlane32_swap_b32 v66,v68
v_fma_f32 v68,-v66,v66,v68
v_add_f32 v66,s78,v66
v_max_f32 v68,0,v68
v_cvt_pk_bf16_f32 v68,v66,v68
v_lshlrev_b32 v66,16,v68
v_and_b32 v68,0xffff0000,v68
v_add_f32 v68,0x3727c5ac,v68
v_cvt_pk_bf16_f32 v68,v68,v68
v_and_b32 v68,0xffff0000,v68
v_sqrt_f32 v68,v68
v_pk_add_f32 v[58:59],v[96:97],v[66:67] op_sel_hi:[1,0] neg_lo:[0,1] neg_hi:[0,1]
v_pk_add_f32 v[60:61],v[98:99],v[66:67] op_sel_hi:[1,0] neg_lo:[0,1] neg_hi:[0,1]
v_pk_add_f32 v[62:63],v[100:101],v[66:67] op_sel_hi:[1,0] neg_lo:[0,1] neg_hi:[0,1]
v_pk_add_f32 v[64:65],v[102:103],v[66:67] op_sel_hi:[1,0] neg_lo:[0,1] neg_hi:[0,1]
v_cvt_pk_bf16_f32 v68,v68,v68
v_and_b32 v68,0xffff0000,v68
v_rcp_f32 v68,v68
v_cvt_pk_bf16_f32 v84,v58,v59
v_cvt_pk_bf16_f32 v85,v60,v61
v_cvt_pk_bf16_f32 v86,v62,v63
v_cvt_pk_bf16_f32 v87,v64,v65
v_lshlrev_b32 v58,16,v84
v_and_b32 v59,0xffff0000,v84
v_lshlrev_b32 v60,16,v85
v_and_b32 v61,0xffff0000,v85
v_lshlrev_b32 v62,16,v86
v_and_b32 v63,0xffff0000,v86
v_lshlrev_b32 v64,16,v87
v_and_b32 v65,0xffff0000,v87
v_pk_mul_f32 v[58:59],v[58:59],v[68:69] op_sel_hi:[1,0]
v_pk_mul_f32 v[60:61],v[60:61],v[68:69] op_sel_hi:[1,0]
v_pk_mul_f32 v[62:63],v[62:63],v[68:69] op_sel_hi:[1,0]
v_pk_mul_f32 v[64:65],v[64:65],v[68:69] op_sel_hi:[1,0]
v_cvt_pk_bf16_f32 v84,v58,v59
v_cvt_pk_bf16_f32 v85,v60,v61
v_cvt_pk_bf16_f32 v86,v62,v63
v_cvt_pk_bf16_f32 v87,v64,v65
s_lshl_b32 s58,s51,10
s_add_u32 s58,s58,11272192
s_add_u32 s59,s58,65536
s_cmp_eq_u32 s47,0
s_cselect_b32 s59,s59,0x80000000
s_add_u32 s57,s56,98566144
buffer_store_dwordx4 v[84:87],v0,s[8:11],s59 offen sc1
buffer_store_dwordx4 v[80:83],v0,s[8:11],s58 offen sc1
buffer_store_dwordx4 v[84:87],v0,s[8:11],s57 offen sc1
L_moed_387:
s_barrier
L_mo_374:
s_mov_b32 s77,-1
s_cmp_lt_u32 s31,64
s_cbranch_scc1 L_mo_370
s_cmp_eq_u32 s86,0
s_cbranch_scc1 L_mo_383
L_mo_376:
s_andn2_b32 s51,0x7ff,s54
s_lshr_b32 s51,s51,5
s_andn2_b32 s56,31,s54
v_lshrrev_b32 v2,10,v20
v_add_u32 v3,16,v2
v_add_u32 v8,96468992,v20
v_cmp_eq_u32 vcc,s56,v2
s_nop 1
v_cndmask_b32 v2,v20,v8,vcc
v_cmp_eq_u32 vcc,s56,v3
s_nop 1
v_cndmask_b32 v3,v20,v8,vcc
s_waitcnt vmcnt(0)
s_lshl_b32 s59,s51,13
s_add_u32 s59,s59,10487552
s_cmp_lg_u32 s46,0
s_cbranch_scc1 L_fd_392
v_and_b32 v124,31,v1
v_lshlrev_b32 v124,2,v124
s_branch L_ff_393
L_fw_391:
s_sleep 2
L_ff_393:
buffer_load_dword v125,v124,s[8:11],s59 offen sc1
s_sub_u32 s49,s49,1
s_cbranch_scc1 L_abort2
s_waitcnt vmcnt(0)
v_cmp_eq_u32 vcc,0,v125
s_cbranch_vccnz L_fw_391
L_fd_392:
s_barrier
s_or_b32 s72,s72,s52
buffer_store_dword v17,off,s[8:11],s72 sc1
s_lshl_b32 s66,s51,15
s_add_u32 s66,s66,2097152
s_add_u32 s67,s66,16384
s_add_u32 m0,s50,131072
s_nop 0
buffer_load_dwordx4 v2,s[8:11],s66 offen offset:0 sc1 lds
s_add_u32 m0,s50,135168
s_nop 0
buffer_load_dwordx4 v3,s[8:11],s67 offen offset:0 sc1 lds
s_add_u32 m0,s50,139008
s_nop 0
buffer_load_dwordx4 v2,s[8:11],s66 offen offset:256 sc1 lds
s_add_u32 m0,s50,143104
s_nop 0
buffer_load_dwordx4 v3,s[8:11],s67 offen offset:256 sc1 lds
s_add_u32 m0,s50,146944
s_nop 0
buffer_load_dwordx4 v2,s[8:11],s66 offen offset:512 sc1 lds
s_add_u32 m0,s50,151040
s_nop 0
buffer_load_dwordx4 v3,s[8:11],s67 offen offset:512 sc1 lds
s_waitcnt vmcnt(4)
s_barrier
ds_read_b128 v[104:107],v4 offset:0
ds_read_b128 v[108:111],v4 offset:4096
ds_read_b128 v[112:115],v5 offset:0
ds_read_b128 v[116:119],v5 offset:4096
s_add_u32 m0,s50,154880
s_nop 0
buffer_load_dwordx4 v2,s[8:11],s66 offen offset:768 sc1 lds
s_add_u32 m0,s50,158976
s_nop 0
buffer_load_dwordx4 v3,s[8:11],s67 offen offset:768 sc1 lds
s_waitcnt lgkmcnt(2)
v_mfma_f32_16x16x32_bf16 v[24:27],a[128:131],v[104:107],0
ds_read_b128 v[120:123],v6 offset:0
v_mfma_f32_16x16x32_bf16 v[40:43],v[104:107],v[128:131],0
s_lshl_b32 s58,s51,5
v_mfma_f32_16x16x32_bf16 v[28:31],a[128:131],v[108:111],0
ds_read_b128 v[124:127],v6 offset:4096
v_mfma_f32_16x16x32_bf16 v[44:47],v[108:111],v[128:131],0
s_add_u32 s58,s58,s47
v_mfma_f32_16x16x32_bf16 v[32:35],a[136:139],v[104:107],0
s_mul_i32 s58,s58,24576
v_mfma_f32_16x16x32_bf16 v[48:51],v[104:107],v[136:139],0
s_add_u32 s58,s58,201326592
v_mfma_f32_16x16x32_bf16 v[36:39],a[136:139],v[108:111],0
s_add_u32 s61,s58,s50
v_mfma_f32_16x16x32_bf16 v[52:55],v[108:111],v[136:139],0
s_add_u32 s62,s61,4096
s_waitcnt lgkmcnt(2)
v_mfma_f32_16x16x32_bf16 v[24:27],a[132:135],v[112:115],v[24:27]
ds_read_b128 v[104:107],v7 offset:0
v_mfma_f32_16x16x32_bf16 v[40:43],v[112:115],v[132:135],v[40:43]
s_add_u32 s63,s61,16384
v_mfma_f32_16x16x32_bf16 v[28:31],a[132:135],v[116:119],v[28:31]
ds_read_b128 v[108:111],v7 offset:4096
v_mfma_f32_16x16x32_bf16 v[44:47],v[116:119],v[132:135],v[44:47]
s_add_u32 s64,s61,20480
v_mfma_f32_16x16x32_bf16 v[32:35],a[140:143],v[112:115],v[32:35]
s_add_u32 s65,s61,s50
v_mfma_f32_16x16x32_bf16 v[48:51],v[112:115],v[140:143],v[48:51]
s_add_u32 s65,s65,8192
v_mfma_f32_16x16x32_bf16 v[36:39],a[140:143],v[116:119],v[36:39]
v_mfma_f32_16x16x32_bf16 v[52:55],v[116:119],v[140:143],v[52:55]
s_waitcnt vmcnt(4)
s_barrier
s_waitcnt lgkmcnt(2)
v_mfma_f32_16x16x32_bf16 v[24:27],a[144:147],v[120:123],v[24:27]
ds_read_b128 v[112:115],v4 offset:8192
v_mfma_f32_16x16x32_bf16 v[40:43],v[120:123],v[144:147],v[40:43]
v_mfma_f32_16x16x32_bf16 v[28:31],a[144:147],v[124:127],v[28:31]
ds_read_b128 v[116:119],v4 offset:12288
v_mfma_f32_16x16x32_bf16 v[44:47],v[124:127],v[144:147],v[44:47]
v_mfma_f32_16x16x32_bf16 v[32:35],a[152:155],v[120:123],v[32:35]
v_mfma_f32_16x16x32_bf16 v[48:51],v[120:123],v[152:155],v[48:51]
v_mfma_f32_16x16x32_bf16 v[36:39],a[152:155],v[124:127],v[36:39]
v_mfma_f32_16x16x32_bf16 v[52:55],v[124:127],v[152:155],v[52:55]
s_waitcnt lgkmcnt(2)
v_mfma_f32_16x16x32_bf16 v[24:27],a[148:151],v[104:107],v[24:27]
ds_read_b128 v[120:123],v5 offset:8192
v_mfma_f32_16x16x32_bf16 v[40:43],v[104:107],v[148:151],v[40:43]
v_mfma_f32_16x16x32_bf16 v[28:31],a[148:151],v[108:111],v[28:31]
ds_read_b128 v[124:127],v5 offset:12288
v_mfma_f32_16x16x32_bf16 v[44:47],v[108:111],v[148:151],v[44:47]
v_mfma_f32_16x16x32_bf16 v[32:35],a[156:159],v[104:107],v[32:35]
v_mfma_f32_16x16x32_bf16 v[48:51],v[104:107],v[156:159],v[48:51]
v_mfma_f32_16x16x32_bf16 v[36:39],a[156:159],v[108:111],v[36:39]
v_mfma_f32_16x16x32_bf16 v[52:55],v[108:111],v[156:159],v[52:55]
s_waitcnt lgkmcnt(2)
v_mfma_f32_16x16x32_bf16 v[24:27],a[160:163],v[112:115],v[24:27]
ds_read_b128 v[104:107],v6 offset:8192
v_mfma_f32_16x16x32_bf16 v[40:43],v[112:115],v[160:163],v[40:43]
v_mfma_f32_16x16x32_bf16 v[28:31],a[160:163],v[116:119],v[28:31]
ds_read_b128 v[108:111],v6 offset:12288
v_mfma_f32_16x16x32_bf16 v[44:47],v[116:119],v[160:163],v[44:47]
v_mfma_f32_16x16x32_bf16 v[32:35],a[168:171],v[112:115],v[32:35]
v_mfma_f32_16x16x32_bf16 v[48:51],v[112:115],v[168:171],v[48:51]
v_mfma_f32_16x16x32_bf16 v[36:39],a[168:171],v[116:119],v[36:39]
v_mfma_f32_16x16x32_bf16 v[52:55],v[116:119],v[168:171],v[52:55]
s_waitcnt lgkmcnt(2)
v_mfma_f32_16x16x32_bf16 v[24:27],a[164:167],v[120:123],v[24:27]
ds_read_b128 v[112:115],v7 offset:8192
v_mfma_f32_16x16x32_bf16 v[40:43],v[120:123],v[164:167],v[40:43]
v_mfma_f32_16x16x32_bf16 v[28:31],a[164:167],v[124:127],v[28:31]
ds_read_b128 v[116:119],v7 offset:12288
v_mfma_f32_16x16x32_bf16 v[44:47],v[124:127],v[164:167],v[44:47]
v_mfma_f32_16x16x32_bf16 v[32:35],a[172:175],v[120:123],v[32:35]
v_mfma_f32_16x16x32_bf16 v[48:51],v[120:123],v[172:175],v[48:51]
v_mfma_f32_16x16x32_bf16 v[36:39],a[172:175],v[124:127],v[36:39]
v_mfma_f32_16x16x32_bf16 v[52:55],v[124:127],v[172:175],v[52:55]
s_waitcnt vmcnt(2)
s_barrier
s_waitcnt lgkmcnt(2)
v_mfma_f32_16x16x32_bf16 v[24:27],a[176:179],v[104:107],v[24:27]
ds_read_b128 v[120:123],v4 offset:16384
v_mfma_f32_16x16x32_bf16 v[40:43],v[104:107],v[176:179],v[40:43]
v_mfma_f32_16x16x32_bf16 v[28:31],a[176:179],v[108:111],v[28:31]
ds_read_b128 v[124:127],v4 offset:20480
v_mfma_f32_16x16x32_bf16 v[44:47],v[108:111],v[176:179],v[44:47]
v_mfma_f32_16x16x32_bf16 v[32:35],a[184:187],v[104:107],v[32:35]
v_mfma_f32_16x16x32_bf16 v[48:51],v[104:107],v[184:187],v[48:51]
v_mfma_f32_16x16x32_bf16 v[36:39],a[184:187],v[108:111],v[36:39]
v_mfma_f32_16x16x32_bf16 v[52:55],v[108:111],v[184:187],v[52:55]
s_waitcnt lgkmcnt(2)
v_mfma_f32_16x16x32_bf16 v[24:27],a[180:183],v[112:115],v[24:27]
ds_read_b128 v[104:107],v5 offset:16384
v_mfma_f32_16x16x32_bf16 v[40:43],v[112:115],v[180:183],v[40:43]
v_mfma_f32_16x16x32_bf16 v[28:31],a[180:183],v[116:119],v[28:31]
ds_read_b128 v[108:111],v5 offset:20480
v_mfma_f32_16x16x32_bf16 v[44:47],v[116:119],v[180:183],v[44:47]
v_mfma_f32_16x16x32_bf16 v[32:35],a[188:191],v[112:115],v[32:35]
v_mfma_f32_16x16x32_bf16 v[48:51],v[112:115],v[188:191],v[48:51]
v_mfma_f32_16x16x32_bf16 v[36:39],a[188:191],v[116:119],v[36:39]
v_mfma_f32_16x16x32_bf16 v[52:55],v[116:119],v[188:191],v[52:55]
s_waitcnt lgkmcnt(2)
v_mfma_f32_16x16x32_bf16 v[24:27],a[192:195],v[120:123],v[24:27]
ds_read_b128 v[112:115],v6 offset:16384
v_mfma_f32_16x16x32_bf16 v[40:43],v[120:123],v[192:195],v[40:43]
v_mfma_f32_16x16x32_bf16 v[28:31],a[192:195],v[124:127],v[28:31]
ds_read_b128 v[116:119],v6 offset:20480
v_mfma_f32_16x16x32_bf16 v[44:47],v[124:127],v[192:195],v[44:47]
v_mfma_f32_16x16x32_bf16 v[32:35],a[200:203],v[120:123],v[32:35]
v_mfma_f32_16x16x32_bf16 v[48:51],v[120:123],v[200:203],v[48:51]
v_mfma_f32_16x16x32_bf16 v[36:39],a[200:203],v[124:127],v[36:39]
v_mfma_f32_16x16x32_bf16 v[52:55],v[124:127],v[200:203],v[52:55]
s_waitcnt lgkmcnt(2)
v_mfma_f32_16x16x32_bf16 v[24:27],a[196:199],v[104:107],v[24:27]
ds_read_b128 v[120:123],v7 offset:16384
v_mfma_f32_16x16x32_bf16 v[40:43],v[104:107],v[196:199],v[40:43]
v_mfma_f32_16x16x32_bf16 v[28:31],a[196:199],v[108:111],v[28:31]
ds_read_b128 v[124:127],v7 offset:20480
v_mfma_f32_16x16x32_bf16 v[44:47],v[108:111],v[196:199],v[44:47]
v_mfma_f32_16x16x32_bf16 v[32:35],a[204:207],v[104:107],v[32:35]
v_mfma_f32_16x16x32_bf16 v[48:51],v[104:107],v[204:207],v[48:51]
v_mfma_f32_16x16x32_bf16 v[36:39],a[204:207],v[108:111],v[36:39]
v_mfma_f32_16x16x32_bf16 v[52:55],v[108:111],v[204:207],v[52:55]
s_waitcnt vmcnt(0)
s_barrier
s_waitcnt lgkmcnt(2)
v_mfma_f32_16x16x32_bf16 v[24:27],a[208:211],v[112:115],v[24:27]
ds_read_b128 v[104:107],v4 offset:24576
v_mfma_f32_16x16x32_bf16 v[40:43],v[112:115],v[208:211],v[40:43]
v_mfma_f32_16x16x32_bf16 v[28:31],a[208:211],v[116:119],v[28:31]
ds_read_b128 v[108:111],v4 offset:28672
v_mfma_f32_16x16x32_bf16 v[44:47],v[116:119],v[208:211],v[44:47]
v_mfma_f32_16x16x32_bf16 v[32:35],a[216:219],v[112:115],v[32:35]
v_mfma_f32_16x16x32_bf16 v[48:51],v[112:115],v[216:219],v[48:51]
v_mfma_f32_16x16x32_bf16 v[36:39],a[216:219],v[116:119],v[36:39]
v_mfma_f32_16x16x32_bf16 v[52:55],v[116:119],v[216:219],v[52:55]
s_waitcnt lgkmcnt(2)
v_mfma_f32_16x16x32_bf16 v[24:27],a[212:215],v[120:123],v[24:27]
ds_read_b128 v[112:115],v5 offset:24576
v_mfma_f32_16x16x32_bf16 v[40:43],v[120:123],v[212:215],v[40:43]
v_mfma_f32_16x16x32_bf16 v[28:31],a[212:215],v[124:127],v[28:31]
ds_read_b128 v[116:119],v5 offset:28672
v_mfma_f32_16x16x32_bf16 v[44:47],v[124:127],v[212:215],v[44:47]
v_mfma_f32_16x16x32_bf16 v[32:35],a[220:223],v[120:123],v[32:35]
v_mfma_f32_16x16x32_bf16 v[48:51],v[120:123],v[220:223],v[48:51]
v_mfma_f32_16x16x32_bf16 v[36:39],a[220:223],v[124:127],v[36:39]
v_mfma_f32_16x16x32_bf16 v[52:55],v[124:127],v[220:223],v[52:55]
s_waitcnt lgkmcnt(2)
v_mfma_f32_16x16x32_bf16 v[24:27],a[224:227],v[104:107],v[24:27]
ds_read_b128 v[120:123],v6 offset:24576
v_mfma_f32_16x16x32_bf16 v[40:43],v[104:107],v[224:227],v[40:43]
v_mfma_f32_16x16x32_bf16 v[28:31],a[224:227],v[108:111],v[28:31]
ds_read_b128 v[124:127],v6 offset:28672
v_mfma_f32_16x16x32_bf16 v[44:47],v[108:111],v[224:227],v[44:47]
v_mfma_f32_16x16x32_bf16 v[32:35],a[232:235],v[104:107],v[32:35]
v_mfma_f32_16x16x32_bf16 v[48:51],v[104:107],v[232:235],v[48:51]
v_mfma_f32_16x16x32_bf16 v[36:39],a[232:235],v[108:111],v[36:39]
v_mfma_f32_16x16x32_bf16 v[52:55],v[108:111],v[232:235],v[52:55]
s_waitcnt lgkmcnt(2)
v_mfma_f32_16x16x32_bf16 v[24:27],a[228:231],v[112:115],v[24:27]
ds_read_b128 v[104:107],v7 offset:24576
v_mfma_f32_16x16x32_bf16 v[40:43],v[112:115],v[228:231],v[40:43]
v_mfma_f32_16x16x32_bf16 v[28:31],a[228:231],v[116:119],v[28:31]
ds_read_b128 v[108:111],v7 offset:28672
v_mfma_f32_16x16x32_bf16 v[44:47],v[116:119],v[228:231],v[44:47]
v_mfma_f32_16x16x32_bf16 v[32:35],a[236:239],v[112:115],v[32:35]
v_mfma_f32_16x16x32_bf16 v[48:51],v[112:115],v[236:239],v[48:51]
v_mfma_f32_16x16x32_bf16 v[36:39],a[236:239],v[116:119],v[36:39]
v_mfma_f32_16x16x32_bf16 v[52:55],v[116:119],v[236:239],v[52:55]
s_waitcnt lgkmcnt(2)
v_mfma_f32_16x16x32_bf16 v[24:27],a[240:243],v[120:123],v[24:27]
ds_read_b128 v[112:115],v4 offset:0
v_mfma_f32_16x16x32_bf16 v[40:43],v[120:123],v[240:243],v[40:43]
v_mfma_f32_16x16x32_bf16 v[28:31],a[240:243],v[124:127],v[28:31]
ds_read_b128 v[116:119],v4 offset:4096
v_mfma_f32_16x16x32_bf16 v[44:47],v[124:127],v[240:243],v[44:47]
v_mfma_f32_16x16x32_bf16 v[32:35],a[248:251],v[120:123],v[32:35]
v_mfma_f32_16x16x32_bf16 v[48:51],v[120:123],v[248:251],v[48:51]
v_mfma_f32_16x16x32_bf16 v[36:39],a[248:251],v[124:127],v[36:39]
v_mfma_f32_16x16x32_bf16 v[52:55],v[124:127],v[248:251],v[52:55]
s_waitcnt lgkmcnt(2)
v_mfma_f32_16x16x32_bf16 v[24:27],a[244:247],v[104:107],v[24:27]
ds_read_b128 v[120:123],v5 offset:0
v_mfma_f32_16x16x32_bf16 v[40:43],v[104:107],v[244:247],v[40:43]
v_mfma_f32_16x16x32_bf16 v[28:31],a[244:247],v[108:111],v[28:31]
ds_read_b128 v[124:127],v5 offset:4096
v_mfma_f32_16x16x32_bf16 v[44:47],v[108:111],v[244:247],v[44:47]
v_mfma_f32_16x16x32_bf16 v[32:35],a[252:255],v[104:107],v[32:35]
v_mfma_f32_16x16x32_bf16 v[48:51],v[104:107],v[252:255],v[48:51]
v_mfma_f32_16x16x32_bf16 v[36:39],a[252:255],v[108:111],v[36:39]
v_mfma_f32_16x16x32_bf16 v[52:55],v[108:111],v[252:255],v[52:55]
s_waitcnt lgkmcnt(2)
v_mfma_f32_16x16x32_bf16 v[88:91],a[0:3],v[112:115],0
ds_read_b128 v[104:107],v6 offset:0
v_mfma_f32_16x16x32_bf16 v[92:95],a[0:3],v[116:119],0
v_mfma_f32_16x16x32_bf16 v[96:99],a[8:11],v[112:115],0
ds_read_b128 v[108:111],v6 offset:4096
v_cvt_pk_bf16_f32 v56,v24,v32
v_cvt_pk_bf16_f32 v57,v25,v33
v_mfma_f32_16x16x32_bf16 v[100:103],a[8:11],v[116:119],0
v_cvt_pk_bf16_f32 v58,v26,v34
v_cvt_pk_bf16_f32 v59,v27,v35
s_waitcnt lgkmcnt(2)
v_mfma_f32_16x16x32_bf16 v[88:91],a[4:7],v[120:123],v[88:91]
ds_read_b128 v[112:115],v7 offset:0
v_mfma_f32_16x16x32_bf16 v[92:95],a[4:7],v[124:127],v[92:95]
buffer_store_dwordx4 v[56:59],v0,s[8:11],s61 offen sc1
v_cvt_pk_bf16_f32 v60,v28,v36
v_cvt_pk_bf16_f32 v61,v29,v37
v_mfma_f32_16x16x32_bf16 v[96:99],a[12:15],v[120:123],v[96:99]
ds_read_b128 v[116:119],v7 offset:4096
v_cvt_pk_bf16_f32 v62,v30,v38
v_cvt_pk_bf16_f32 v63,v31,v39
v_mfma_f32_16x16x32_bf16 v[100:103],a[12:15],v[124:127],v[100:103]
buffer_store_dwordx4 v[60:63],v0,s[8:11],s62 offen sc1
v_cvt_pk_bf16_f32 v64,v40,v41
v_cvt_pk_bf16_f32 v65,v42,v43
s_waitcnt lgkmcnt(2)
v_mfma_f32_16x16x32_bf16 v[88:91],a[16:19],v[104:107],v[88:91]
ds_read_b128 v[120:123],v4 offset:8192
v_cvt_pk_bf16_f32 v66,v44,v45
v_cvt_pk_bf16_f32 v67,v46,v47
v_mfma_f32_16x16x32_bf16 v[92:95],a[16:19],v[108:111],v[92:95]
buffer_store_dwordx4 v[64:67],v0,s[8:11],s65 offen offset:0 sc1
v_cvt_pk_bf16_f32 v68,v48,v49
v_cvt_pk_bf16_f32 v69,v50,v51
v_mfma_f32_16x16x32_bf16 v[96:99],a[24:27],v[104:107],v[96:99]
ds_read_b128 v[124:127],v4 offset:12288
v_cvt_pk_bf16_f32 v70,v52,v53
v_cvt_pk_bf16_f32 v71,v54,v55
v_mfma_f32_16x16x32_bf16 v[100:103],a[24:27],v[108:111],v[100:103]
buffer_store_dwordx4 v[68:71],v0,s[8:11],s65 offen offset:1024 sc1
s_waitcnt lgkmcnt(2)
v_mfma_f32_16x16x32_bf16 v[88:91],a[20:23],v[112:115],v[88:91]
ds_read_b128 v[104:107],v5 offset:8192
v_mfma_f32_16x16x32_bf16 v[92:95],a[20:23],v[116:119],v[92:95]
v_mfma_f32_16x16x32_bf16 v[96:99],a[28:31],v[112:115],v[96:99]
ds_read_b128 v[108:111],v5 offset:12288
v_mfma_f32_16x16x32_bf16 v[100:103],a[28:31],v[116:119],v[100:103]
s_waitcnt lgkmcnt(2)
v_mfma_f32_16x16x32_bf16 v[88:91],a[32:35],v[120:123],v[88:91]
ds_read_b128 v[112:115],v6 offset:8192
v_mfma_f32_16x16x32_bf16 v[92:95],a[32:35],v[124:127],v[92:95]
v_mfma_f32_16x16x32_bf16 v[96:99],a[40:43],v[120:123],v[96:99]
ds_read_b128 v[116:119],v6 offset:12288
v_mfma_f32_16x16x32_bf16 v[100:103],a[40:43],v[124:127],v[100:103]
s_waitcnt lgkmcnt(2)
v_mfma_f32_16x16x32_bf16 v[88:91],a[36:39],v[104:107],v[88:91]
ds_read_b128 v[120:123],v7 offset:8192
v_mfma_f32_16x16x32_bf16 v[92:95],a[36:39],v[108:111],v[92:95]
v_mfma_f32_16x16x32_bf16 v[96:99],a[44:47],v[104:107],v[96:99]
ds_read_b128 v[124:127],v7 offset:12288
v_mfma_f32_16x16x32_bf16 v[100:103],a[44:47],v[108:111],v[100:103]
s_waitcnt lgkmcnt(2)
v_mfma_f32_16x16x32_bf16 v[88:91],a[48:51],v[112:115],v[88:91]
ds_read_b128 v[104:107],v4 offset:16384
v_mfma_f32_16x16x32_bf16 v[92:95],a[48:51],v[116:119],v[92:95]
v_mfma_f32_16x16x32_bf16 v[96:99],a[56:59],v[112:115],v[96:99]
ds_read_b128 v[108:111],v4 offset:20480
v_mfma_f32_16x16x32_bf16 v[100:103],a[56:59],v[116:119],v[100:103]
s_waitcnt lgkmcnt(2)
v_mfma_f32_16x16x32_bf16 v[88:91],a[52:55],v[120:123],v[88:91]
ds_read_b128 v[112:115],v5 offset:16384
v_mfma_f32_16x16x32_bf16 v[92:95],a[52:55],v[124:127],v[92:95]
v_mfma_f32_16x16x32_bf16 v[96:99],a[60:63],v[120:123],v[96:99]
ds_read_b128 v[116:119],v5 offset:20480
v_mfma_f32_16x16x32_bf16 v[100:103],a[60:63],v[124:127],v[100:103]
s_waitcnt lgkmcnt(2)
v_mfma_f32_16x16x32_bf16 v[88:91],a[64:67],v[104:107],v[88:91]
ds_read_b128 v[120:123],v6 offset:16384
v_mfma_f32_16x16x32_bf16 v[92:95],a[64:67],v[108:111],v[92:95]
v_mfma_f32_16x16x32_bf16 v[96:99],a[72:75],v[104:107],v[96:99]
ds_read_b128 v[124:127],v6 offset:20480
v_mfma_f32_16x16x32_bf16 v[100:103],a[72:75],v[108:111],v[100:103]
s_waitcnt lgkmcnt(2)
v_mfma_f32_16x16x32_bf16 v[88:91],a[68:71],v[112:115],v[88:91]
ds_read_b128 v[104:107],v7 offset:16384
v_mfma_f32_16x16x32_bf16 v[92:95],a[68:71],v[116:119],v[92:95]
v_mfma_f32_16x16x32_bf16 v[96:99],a[76:79],v[112:115],v[96:99]
ds_read_b128 v[108:111],v7 offset:20480
v_mfma_f32_16x16x32_bf16 v[100:103],a[76:79],v[116:119],v[100:103]
s_waitcnt lgkmcnt(2)
v_mfma_f32_16x16x32_bf16 v[88:91],a[80:83],v[120:123],v[88:91]
ds_read_b128 v[112:115],v4 offset:24576
v_mfma_f32_16x16x32_bf16 v[92:95],a[80:83],v[124:127],v[92:95]
v_mfma_f32_16x16x32_bf16 v[96:99],a[88:91],v[120:123],v[96:99]
ds_read_b128 v[116:119],v4 offset:28672
v_mfma_f32_16x16x32_bf16 v[100:103],a[88:91],v[124:127],v[100:103]
s_waitcnt lgkmcnt(2)
v_mfma_f32_16x16x32_bf16 v[88:91],a[84:87],v[104:107],v[88:91]
ds_read_b128 v[120:123],v5 offset:24576
v_mfma_f32_16x16x32_bf16 v[92:95],a[84:87],v[108:111],v[92:95]
v_mfma_f32_16x16x32_bf16 v[96:99],a[92:95],v[104:107],v[96:99]
ds_read_b128 v[124:127],v5 offset:28672
v_mfma_f32_16x16x32_bf16 v[100:103],a[92:95],v[108:111],v[100:103]
s_waitcnt lgkmcnt(2)
v_mfma_f32_16x16x32_bf16 v[88:91],a[96:99],v[112:115],v[88:91]
ds_read_b128 v[104:107],v6 offset:24576
v_mfma_f32_16x16x32_bf16 v[92:95],a[96:99],v[116:119],v[92:95]
v_mfma_f32_16x16x32_bf16 v[96:99],a[104:107],v[112:115],v[96:99]
ds_read_b128 v[108:111],v6 offset:28672
v_mfma_f32_16x16x32_bf16 v[100:103],a[104:107],v[116:119],v[100:103]
s_waitcnt lgkmcnt(2)
v_mfma_f32_16x16x32_bf16 v[88:91],a[100:103],v[120:123],v[88:91]
ds_read_b128 v[112:115],v7 offset:24576
v_mfma_f32_16x16x32_bf16 v[92:95],a[100:103],v[124:127],v[92:95]
v_mfma_f32_16x16x32_bf16 v[96:99],a[108:111],v[120:123],v[96:99]
ds_read_b128 v[116:119],v7 offset:28672
v_mfma_f32_16x16x32_bf16 v[100:103],a[108:111],v[124:127],v[100:103]
s_waitcnt lgkmcnt(2)
v_mfma_f32_16x16x32_bf16 v[88:91],a[112:115],v[104:107],v[88:91]
v_mfma_f32_16x16x32_bf16 v[92:95],a[112:115],v[108:111],v[92:95]
v_mfma_f32_16x16x32_bf16 v[96:99],a[120:123],v[104:107],v[96:99]
v_mfma_f32_16x16x32_bf16 v[100:103],a[120:123],v[108:111],v[100:103]
s_waitcnt lgkmcnt(0)
v_mfma_f32_16x16x32_bf16 v[88:91],a[116:119],v[112:115],v[88:91]
v_mfma_f32_16x16x32_bf16 v[92:95],a[116:119],v[116:119],v[92:95]
v_mfma_f32_16x16x32_bf16 v[96:99],a[124:127],v[112:115],v[96:99]
v_mfma_f32_16x16x32_bf16 v[100:103],a[124:127],v[116:119],v[100:103]
s_nop 3
v_cvt_pk_bf16_f32 v104,v88,v96
v_cvt_pk_bf16_f32 v105,v89,v97
v_cvt_pk_bf16_f32 v106,v90,v98
v_cvt_pk_bf16_f32 v107,v91,v99
v_cvt_pk_bf16_f32 v108,v92,v100
v_cvt_pk_bf16_f32 v109,v93,v101
v_cvt_pk_bf16_f32 v110,v94,v102
v_cvt_pk_bf16_f32 v111,v95,v103
buffer_store_dwordx4 v[104:107],v0,s[8:11],s63 offen sc1
buffer_store_dwordx4 v[108:111],v0,s[8:11],s64 offen sc1
s_waitcnt vmcnt(6)
s_barrier
s_add_u32 m0,s50,131072
s_nop 0
buffer_load_dwordx4 v20,s[8:11],s70 offen offset:0 sc1 lds
s_add_u32 m0,s50,135168
s_nop 0
buffer_load_dwordx4 v20,s[8:11],s71 offen offset:0 sc1 lds
s_add_u32 m0,s50,139008
s_nop 0
buffer_load_dwordx4 v20,s[8:11],s70 offen offset:256 sc1 lds
s_add_u32 m0,s50,143104
s_nop 0
buffer_load_dwordx4 v20,s[8:11],s71 offen offset:256 sc1 lds
s_add_u32 m0,s50,146944
s_nop 0
buffer_load_dwordx4 v20,s[8:11],s70 offen offset:512 sc1 lds
s_add_u32 m0,s50,151040
s_nop 0
buffer_load_dwordx4 v20,s[8:11],s71 offen offset:512 sc1 lds
s_lshl_b32 s59,s51,13
s_lshl2_add_u32 s59,s47,s59
s_add_u32 s59,s59,10487680
s_waitcnt vmcnt(0)
s_barrier
s_or_b32 s59,s59,s52
buffer_store_dword v17,off,s[8:11],s59 sc1
s_mov_b32 s72,0x80000000
s_mov_b32 s86,0
s_mov_b32 s19,1
s_mov_b32 s18,0
s_cmp_lt_u32 s31,64
s_cbranch_scc1 L_mo_370
L_mo_383:
s_mov_b32 s51,64
v_and_b32 v9,15,v1
v_lshrrev_b32 v10,4,v1
v_and_b32 v124,1,v1
v_lshlrev_b32 v124,4,v124
v_mov_b32 v125,0xffff
v_lshlrev_b32 v125,v124,v125
v_lshrrev_b32 v124,2,v9
v_cmp_eq_u32 vcc,0,v124
s_nop 1
v_cndmask_b32 v12,0,v125,vcc
v_cmp_eq_u32 vcc,1,v124
s_nop 1
v_cndmask_b32 v13,0,v125,vcc
v_and_b32 v124,2,v1
v_cmp_eq_u32 vcc,0,v124
v_mov_b32 v14,0xeeee
v_mov_b32 v124,0x4444
v_cndmask_b32 v14,v14,v124,vcc
v_lshlrev_b32 v11,14,v10
v_lshl_add_u32 v11,v9,4,v11
s_lshl_b32 s65,s51,15
s_add_u32 s65,s65,92274688
s_lshl_b32 s62,s47,10
s_add_u32 s62,s62,s65
s_lshl_b32 s63,s47,16
s_lshl_b32 s60,s46,8
s_add_u32 s63,s63,s60
s_mov_b32 s4,s38
s_mov_b32 s5,s39
s_mov_b32 s6,1835008
s_mov_b32 s7,0x20000
buffer_load_dwordx4 v[24:27],v11,s[4:7],s63 offen offset:0
buffer_load_dwordx4 v[28:31],v11,s[4:7],s63 offen offset:1024
buffer_load_dwordx4 v[32:35],v11,s[4:7],s63 offen offset:2048
buffer_load_dwordx4 v[36:39],v11,s[4:7],s63 offen offset:3072
s_add_u32 s63,s63,4096
buffer_load_dwordx4 v[40:43],v11,s[4:7],s63 offen offset:0
buffer_load_dwordx4 v[44:47],v11,s[4:7],s63 offen offset:1024
buffer_load_dwordx4 v[48:51],v11,s[4:7],s63 offen offset:2048
buffer_load_dwordx4 v[52:55],v11,s[4:7],s63 offen offset:3072
s_add_u32 s63,s63,4096
buffer_load_dwordx4 v[56:59],v11,s[4:7],s63 offen offset:0
buffer_load_dwordx4 v[60:63],v11,s[4:7],s63 offen offset:1024
buffer_load_dwordx4 v[64:67],v11,s[4:7],s63 offen offset:2048
buffer_load_dwordx4 v[68:71],v11,s[4:7],s63 offen offset:3072
s_add_u32 s63,s63,4096
buffer_load_dwordx4 v[72:75],v11,s[4:7],s63 offen offset:0
buffer_load_dwordx4 v[76:79],v11,s[4:7],s63 offen offset:1024
buffer_load_dwordx4 v[80:83],v11,s[4:7],s63 offen offset:2048
buffer_load_dwordx4 v[84:87],v11,s[4:7],s63 offen offset:3072
ds_read_b128 a[0:3],v18 offset:0
ds_read_b128 a[4:7],v18 offset:1024
ds_read_b128 a[8:11],v18 offset:2048
ds_read_b128 a[12:15],v18 offset:3072
ds_read_b128 a[16:19],v18 offset:4096
ds_read_b128 a[20:23],v18 offset:5120
ds_read_b128 a[24:27],v18 offset:6144
ds_read_b128 a[28:31],v18 offset:7168
ds_read_b128 a[32:35],v18 offset:8192
ds_read_b128 a[36:39],v18 offset:9216
ds_read_b128 a[40:43],v18 offset:10240
ds_read_b128 a[44:47],v18 offset:11264
ds_read_b128 a[48:51],v18 offset:12288
ds_read_b128 a[52:55],v18 offset:13312
ds_read_b128 a[56:59],v18 offset:14336
ds_read_b128 a[60:63],v18 offset:15360
ds_read_b128 a[64:67],v18 offset:16384
ds_read_b128 a[68:71],v18 offset:17408
ds_read_b128 a[72:75],v18 offset:18432
ds_read_b128 a[76:79],v18 offset:19456
ds_read_b128 a[80:83],v18 offset:20480
ds_read_b128 a[84:87],v18 offset:21504
ds_read_b128 a[88:91],v18 offset:22528
ds_read_b128 a[92:95],v18 offset:23552
ds_read_b128 a[96:99],v18 offset:24576
ds_read_b128 a[100:103],v18 offset:25600
ds_read_b128 a[104:107],v18 offset:26624
ds_read_b128 a[108:111],v18 offset:27648
ds_read_b128 a[112:115],v18 offset:28672
ds_read_b128 a[116:119],v18 offset:29696
ds_read_b128 a[120:123],v18 offset:30720
ds_read_b128 a[124:127],v18 offset:31744
s_and_b32 s61,s54,0x7ff
s_sub_u32 s61,2047,s61
s_lshr_b32 s61,s61,5
s_cmp_lg_u32 s46,0
s_cbranch_scc1 L_mw_394
s_mov_b32 s59,11018240
v_lshlrev_b32 v2,2,v1
L_fp_395:
s_sleep 2
buffer_load_dword v3,v2,s[8:11],s59 offen sc1
s_sub_u32 s49,s49,1
s_cbranch_scc1 L_abort2
s_waitcnt vmcnt(0)
v_cmp_eq_u32 vcc,0,v3
s_cbranch_vccnz L_fp_395
v_cmp_le_u32 vcc,s61,v1
s_nop 1
v_cndmask_b32 v2,1,2,vcc
v_cmp_ne_u32 s[84:85],v2,v3
s_lshl_b32 s56,s47,1
s_lshr_b64 s[20:21],s[84:85],s56
v_lshrrev_b32 v2,5,v1
v_lshrrev_b32 v3,v2,s20
v_and_b32 v3,1,v3
v_mul_u32_u24 v3,768,v3
v_lshlrev_b32 v2,13,v2
v_sub_u32 v2,v2,v3
v_and_b32 v3,31,v1
v_lshl_add_u32 v2,v3,2,v2
v_add_u32 v2,1536,v2
s_lshl_b32 s59,s47,14
s_add_u32 s59,s59,10485760
v_mov_b32 v3,1
s_cmp_ge_u32 s47,28
s_cbranch_scc1 L_mf_396
L_fp_402:
s_sleep 1
buffer_load_dword v3,v2,s[8:11],s59 offen sc1
s_sub_u32 s49,s49,1
s_cbranch_scc1 L_abort2
s_waitcnt vmcnt(0)
v_cmp_eq_u32 vcc,0,v3
s_cbranch_vccnz L_fp_402
v_max_u32_dpp v3,v3,v3 row_ror:8 row_mask:0xf bank_mask:0xf
s_nop 1
v_max_u32_dpp v3,v3,v3 row_ror:4 row_mask:0xf bank_mask:0xf
s_nop 1
v_max_u32_dpp v3,v3,v3 row_ror:2 row_mask:0xf bank_mask:0xf
s_nop 1
v_max_u32_dpp v3,v3,v3 row_ror:1 row_mask:0xf bank_mask:0xf
v_mov_b32 v2,v3
s_nop 1
v_permlane16_swap_b32 v3,v2
v_max_u32 v3,v3,v2
v_mov_b32 v2,v3
s_nop 1
v_permlane32_swap_b32 v3,v2
v_max_u32 v3,v3,v2
L_mf_396:
s_lshl_b32 s59,s51,13
s_lshl2_add_u32 s59,s47,s59
s_add_u32 s59,s59,10487424
buffer_store_dword v3,off,s[8:11],s59 sc1
L_mw_394:
s_barrier
s_lshl_b32 s59,s51,13
s_add_u32 s59,s59,10487424
v_and_b32 v124,31,v1
v_lshlrev_b32 v124,2,v124
s_branch L_ff_405
L_fw_403:
s_sleep 1
L_ff_405:
buffer_load_dword v125,v124,s[8:11],s59 offen sc1
s_sub_u32 s49,s49,1
s_cbranch_scc1 L_abort2
s_waitcnt vmcnt(0)
v_cmp_eq_u32 vcc,0,v125
s_cbranch_vccnz L_fw_403
v_max_u32_dpp v125,v125,v125 row_ror:8 row_mask:0xf bank_mask:0xf
s_nop 1
v_max_u32_dpp v125,v125,v125 row_ror:4 row_mask:0xf bank_mask:0xf
s_nop 1
v_max_u32_dpp v125,v125,v125 row_ror:2 row_mask:0xf bank_mask:0xf
s_nop 1
v_max_u32_dpp v125,v125,v125 row_ror:1 row_mask:0xf bank_mask:0xf
v_mov_b32 v124,v125
s_nop 1
v_permlane16_swap_b32 v125,v124
v_max_u32 v125,v125,v124
v_mov_b32 v124,v125
s_nop 1
v_permlane32_swap_b32 v125,v124
v_max_u32 v125,v125,v124
s_nop 0
v_readfirstlane_b32 s55,v125
L_mf_397:
s_andn2_b32 s64,0x7ff,s55
s_lshl_b32 s56,s64,10
s_add_u32 s58,s56,6291456
buffer_load_dwordx4 v[88:91],v0,s[8:11],s58 offen sc1
s_lshl_b32 s57,s46,11
s_add_u32 s57,s57,139264
v_add_u32 v8,s57,v0
v_and_b32 v2,1,v10
v_lshrrev_b32 v3,1,v10
v_lshlrev_b32 v2,7,v2
v_lshl_add_u32 v2,v3,10,v2
s_lshl_b32 s59,s46,8
s_add_u32 s59,s57,s59
v_add_u32 v2,s59,v2
s_mov_b32 s60,0x01000100
s_mov_b32 s61,0x03020302
s_waitcnt vmcnt(0)
v_lshlrev_b32 v96,16,v88
v_and_b32 v97,0xffff0000,v88
v_lshlrev_b32 v98,16,v89
v_and_b32 v99,0xffff0000,v89
v_lshlrev_b32 v100,16,v90
v_and_b32 v101,0xffff0000,v90
v_lshlrev_b32 v102,16,v91
v_and_b32 v103,0xffff0000,v91
v_readfirstlane_b32 s78,v96
s_nop 1
v_pk_add_f32 v[108:109],v[96:97],s[78:79] op_sel_hi:[1,0] neg_lo:[0,1] neg_hi:[0,1]
v_pk_add_f32 v[110:111],v[98:99],s[78:79] op_sel_hi:[1,0] neg_lo:[0,1] neg_hi:[0,1]
v_pk_add_f32 v[112:113],v[100:101],s[78:79] op_sel_hi:[1,0] neg_lo:[0,1] neg_hi:[0,1]
v_pk_add_f32 v[114:115],v[102:103],s[78:79] op_sel_hi:[1,0] neg_lo:[0,1] neg_hi:[0,1]
v_pk_add_f32 v[116:117],v[108:109],v[110:111]
v_pk_mul_f32 v[118:119],v[108:109],v[108:109]
v_pk_add_f32 v[120:121],v[112:113],v[114:115]
v_pk_fma_f32 v[118:119],v[110:111],v[110:111],v[118:119]
v_pk_add_f32 v[116:117],v[116:117],v[120:121]
v_pk_fma_f32 v[118:119],v[112:113],v[112:113],v[118:119]
v_add_f32 v116,v116,v117
v_pk_fma_f32 v[118:119],v[114:115],v[114:115],v[118:119]
v_add_f32 v118,v118,v119
s_nop 1
v_permlane32_swap_b32 v116,v118
v_add_f32 v116,v116,v118
s_nop 1
v_add_f32_dpp v116,v116,v116 row_ror:8 row_mask:0xf bank_mask:0xf
s_nop 1
v_add_f32_dpp v116,v116,v116 row_ror:4 row_mask:0xf bank_mask:0xf
s_nop 1
v_add_f32_dpp v116,v116,v116 row_ror:2 row_mask:0xf bank_mask:0xf
s_nop 1
v_add_f32_dpp v116,v116,v116 row_ror:1 row_mask:0xf bank_mask:0xf
v_mov_b32 v118,v116
s_nop 1
v_permlane16_swap_b32 v116,v118
v_add_f32 v116,v116,v118
v_mul_f32 v116,0x3b000000,v116
v_mov_b32 v118,v116
s_nop 1
v_permlane32_swap_b32 v116,v118
v_fma_f32 v118,-v116,v116,v118
v_add_f32 v116,s78,v116
v_max_f32 v118,0,v118
v_cvt_pk_bf16_f32 v118,v116,v118
v_lshlrev_b32 v116,16,v118
v_and_b32 v118,0xffff0000,v118
v_add_f32 v118,0x3727c5ac,v118
v_cvt_pk_bf16_f32 v118,v118,v118
v_and_b32 v118,0xffff0000,v118
v_sqrt_f32 v118,v118
v_pk_add_f32 v[108:109],v[96:97],v[116:117] op_sel_hi:[1,0] neg_lo:[0,1] neg_hi:[0,1]
v_pk_add_f32 v[110:111],v[98:99],v[116:117] op_sel_hi:[1,0] neg_lo:[0,1] neg_hi:[0,1]
v_pk_add_f32 v[112:113],v[100:101],v[116:117] op_sel_hi:[1,0] neg_lo:[0,1] neg_hi:[0,1]
v_pk_add_f32 v[114:115],v[102:103],v[116:117] op_sel_hi:[1,0] neg_lo:[0,1] neg_hi:[0,1]
v_cvt_pk_bf16_f32 v118,v118,v118
v_and_b32 v118,0xffff0000,v118
v_rcp_f32 v118,v118
v_cvt_pk_bf16_f32 v104,v108,v109
v_cvt_pk_bf16_f32 v105,v110,v111
v_cvt_pk_bf16_f32 v106,v112,v113
v_cvt_pk_bf16_f32 v107,v114,v115
v_lshlrev_b32 v108,16,v104
v_and_b32 v109,0xffff0000,v104
v_lshlrev_b32 v110,16,v105
v_and_b32 v111,0xffff0000,v105
v_lshlrev_b32 v112,16,v106
v_and_b32 v113,0xffff0000,v106
v_lshlrev_b32 v114,16,v107
v_and_b32 v115,0xffff0000,v107
v_pk_mul_f32 v[108:109],v[108:109],v[118:119] op_sel_hi:[1,0]
v_pk_mul_f32 v[110:111],v[110:111],v[118:119] op_sel_hi:[1,0]
v_pk_mul_f32 v[112:113],v[112:113],v[118:119] op_sel_hi:[1,0]
v_pk_mul_f32 v[114:115],v[114:115],v[118:119] op_sel_hi:[1,0]
v_cvt_pk_bf16_f32 v104,v108,v109
v_cvt_pk_bf16_f32 v105,v110,v111
v_cvt_pk_bf16_f32 v106,v112,v113
v_cvt_pk_bf16_f32 v107,v114,v115
v_perm_b32 v88,v104,v104,s60
v_perm_b32 v89,v105,v105,s60
v_perm_b32 v90,v106,v106,s60
v_perm_b32 v91,v107,v107,s60
ds_write_b128 v8,v[88:91]
v_perm_b32 v92,v104,v104,s61
v_perm_b32 v93,v105,v105,s61
v_perm_b32 v94,v106,v106,s61
v_perm_b32 v95,v107,v107,s61
ds_write_b128 v8,v[92:95] offset:1024
s_mov_b32 s58,s57
ds_read_b128 v[128:131],v2 offset:0
ds_read_b128 v[144:147],v2 offset:64
ds_read_b128 v[132:135],v2 offset:16
ds_read_b128 v[148:151],v2 offset:80
ds_read_b128 v[136:139],v2 offset:32
ds_read_b128 v[152:155],v2 offset:96
ds_read_b128 v[140:143],v2 offset:48
ds_read_b128 v[156:159],v2 offset:112
v_mov_b64 v[116:117],0
v_mov_b64 v[118:119],0
s_waitcnt lgkmcnt(6)
v_and_b32 v120,v12,v128
v_and_b32 v121,v13,v128
v_and_b32 v122,v12,v144
v_and_b32 v123,v13,v144
v_and_b32 v124,v12,v129
v_and_b32 v125,v13,v129
v_smfmac_f32_16x16x64_bf16 v[116:119],v[120:123],a[0:7],v14
v_and_b32 v126,v12,v145
v_and_b32 v127,v13,v145
v_and_b32 v120,v12,v130
v_and_b32 v121,v13,v130
v_smfmac_f32_16x16x64_bf16 v[116:119],v[124:127],a[8:15],v14
v_and_b32 v122,v12,v146
v_and_b32 v123,v13,v146
v_and_b32 v124,v12,v131
v_and_b32 v125,v13,v131
v_smfmac_f32_16x16x64_bf16 v[116:119],v[120:123],a[16:23],v14
v_and_b32 v126,v12,v147
v_and_b32 v127,v13,v147
s_waitcnt lgkmcnt(4)
v_and_b32 v120,v12,v132
v_and_b32 v121,v13,v132
v_smfmac_f32_16x16x64_bf16 v[116:119],v[124:127],a[24:31],v14
v_and_b32 v122,v12,v148
v_and_b32 v123,v13,v148
v_and_b32 v124,v12,v133
v_and_b32 v125,v13,v133
v_smfmac_f32_16x16x64_bf16 v[116:119],v[120:123],a[32:39],v14
v_and_b32 v126,v12,v149
v_and_b32 v127,v13,v149
v_and_b32 v120,v12,v134
v_and_b32 v121,v13,v134
v_smfmac_f32_16x16x64_bf16 v[116:119],v[124:127],a[40:47],v14
v_and_b32 v122,v12,v150
v_and_b32 v123,v13,v150
v_and_b32 v124,v12,v135
v_and_b32 v125,v13,v135
v_smfmac_f32_16x16x64_bf16 v[116:119],v[120:123],a[48:55],v14
v_and_b32 v126,v12,v151
v_and_b32 v127,v13,v151
s_waitcnt lgkmcnt(2)
v_and_b32 v120,v12,v136
v_and_b32 v121,v13,v136
v_smfmac_f32_16x16x64_bf16 v[116:119],v[124:127],a[56:63],v14
v_and_b32 v122,v12,v152
v_and_b32 v123,v13,v152
v_and_b32 v124,v12,v137
v_and_b32 v125,v13,v137
v_smfmac_f32_16x16x64_bf16 v[116:119],v[120:123],a[64:71],v14
v_and_b32 v126,v12,v153
v_and_b32 v127,v13,v153
v_and_b32 v120,v12,v138
v_and_b32 v121,v13,v138
v_smfmac_f32_16x16x64_bf16 v[116:119],v[124:127],a[72:79],v14
v_and_b32 v122,v12,v154
v_and_b32 v123,v13,v154
v_and_b32 v124,v12,v139
v_and_b32 v125,v13,v139
v_smfmac_f32_16x16x64_bf16 v[116:119],v[120:123],a[80:87],v14
v_and_b32 v126,v12,v155
v_and_b32 v127,v13,v155
s_waitcnt lgkmcnt(0)
v_and_b32 v120,v12,v140
v_and_b32 v121,v13,v140
v_smfmac_f32_16x16x64_bf16 v[116:119],v[124:127],a[88:95],v14
v_and_b32 v122,v12,v156
v_and_b32 v123,v13,v156
v_and_b32 v124,v12,v141
v_and_b32 v125,v13,v141
v_smfmac_f32_16x16x64_bf16 v[116:119],v[120:123],a[96:103],v14
v_and_b32 v126,v12,v157
v_and_b32 v127,v13,v157
v_and_b32 v120,v12,v142
v_and_b32 v121,v13,v142
v_smfmac_f32_16x16x64_bf16 v[116:119],v[124:127],a[104:111],v14
v_and_b32 v122,v12,v158
v_and_b32 v123,v13,v158
v_and_b32 v124,v12,v143
v_and_b32 v125,v13,v143
v_smfmac_f32_16x16x64_bf16 v[116:119],v[120:123],a[112:119],v14
v_and_b32 v126,v12,v159
v_and_b32 v127,v13,v159
s_nop 1
v_smfmac_f32_16x16x64_bf16 v[116:119],v[124:127],a[120:127],v14
v_lshlrev_b32 v8,5,v9
v_and_b32 v124,1,v10
v_lshl_add_u32 v8,v124,4,v8
v_lshrrev_b32 v124,1,v10
v_lshl_add_u32 v8,v124,11,v8
s_lshl_b32 s60,s46,9
s_add_u32 s60,s60,147456
v_add_u32 v8,s60,v8
ds_write_b128 v8,v[116:119]
v_lshlrev_b32 v8,2,v1
v_add_u32 v8,147456,v8
v_and_b32 v2,1,v1
v_lshrrev_b32 v3,1,v1
v_lshlrev_b32 v3,2,v3
v_lshl_add_u32 v2,v2,7,v3
v_add_u32 v2,s58,v2
v_lshlrev_b32 v3,6,v10
v_add_u32 v3,s58,v3
s_waitcnt lgkmcnt(0)
s_barrier
ds_read2st64_b32 v[88:89],v8 offset0:0 offset1:1
ds_read2st64_b32 v[90:91],v8 offset0:2 offset1:3
ds_read2st64_b32 v[92:93],v8 offset0:4 offset1:5
ds_read2st64_b32 v[94:95],v8 offset0:6 offset1:7
s_waitcnt lgkmcnt(0)
v_pk_add_f32 v[88:89],v[88:89],v[90:91]
v_pk_add_f32 v[92:93],v[92:93],v[94:95]
v_pk_add_f32 v[88:89],v[88:89],v[92:93]
v_cvt_pk_bf16_f32 v88,v88,v88
v_and_b32 v88,0xffff0000,v88
v_cvt_pk_bf16_f32 v89,v89,v89
v_and_b32 v89,0xffff0000,v89
v_mul_f32 v90,0xbfb8aa3b,v88
v_exp_f32 v90,v90
s_nop 0
v_add_f32 v90,1.0,v90
v_rcp_f32 v90,v90
s_nop 0
v_mul_f32 v88,v88,v90
v_cvt_pk_bf16_f32 v88,v88,v88
v_and_b32 v88,0xffff0000,v88
v_mul_f32 v88,v88,v89
v_cvt_pk_bf16_f32 v88,v88,v88
ds_write_b32 v2,v88
ds_read_b128 v[88:91],v3
ds_read_b128 v[108:111],v3 offset:32
ds_read_b128 v[92:95],v3 offset:16
ds_read_b128 v[112:115],v3 offset:48
v_mov_b64 v[116:117],0
v_mov_b64 v[118:119],0
s_waitcnt vmcnt(0) lgkmcnt(0)
v_and_b32 v120,v12,v88
v_and_b32 v121,v13,v88
v_and_b32 v122,v12,v108
v_and_b32 v123,v13,v108
v_and_b32 v124,v12,v89
v_and_b32 v125,v13,v89
v_smfmac_f32_16x16x64_bf16 v[116:119],v[120:123],v[24:31],v14
v_and_b32 v126,v12,v109
v_and_b32 v127,v13,v109
v_and_b32 v120,v12,v90
v_and_b32 v121,v13,v90
v_smfmac_f32_16x16x64_bf16 v[116:119],v[124:127],v[32:39],v14
v_and_b32 v122,v12,v110
v_and_b32 v123,v13,v110
v_and_b32 v124,v12,v91
v_and_b32 v125,v13,v91
v_smfmac_f32_16x16x64_bf16 v[116:119],v[120:123],v[40:47],v14
v_and_b32 v126,v12,v111
v_and_b32 v127,v13,v111
v_and_b32 v120,v12,v92
v_and_b32 v121,v13,v92
v_smfmac_f32_16x16x64_bf16 v[116:119],v[124:127],v[48:55],v14
v_and_b32 v122,v12,v112
v_and_b32 v123,v13,v112
v_and_b32 v124,v12,v93
v_and_b32 v125,v13,v93
v_smfmac_f32_16x16x64_bf16 v[116:119],v[120:123],v[56:63],v14
v_and_b32 v126,v12,v113
v_and_b32 v127,v13,v113
v_and_b32 v120,v12,v94
v_and_b32 v121,v13,v94
v_smfmac_f32_16x16x64_bf16 v[116:119],v[124:127],v[64:71],v14
v_and_b32 v122,v12,v114
v_and_b32 v123,v13,v114
v_and_b32 v124,v12,v95
v_and_b32 v125,v13,v95
v_smfmac_f32_16x16x64_bf16 v[116:119],v[120:123],v[72:79],v14
v_and_b32 v126,v12,v115
v_and_b32 v127,v13,v115
s_nop 1
v_smfmac_f32_16x16x64_bf16 v[116:119],v[124:127],v[80:87],v14
v_lshlrev_b32 v8,4,v9
v_and_b32 v124,1,v10
v_lshl_add_u32 v8,v124,3,v8
v_and_b32 v124,2,v10
v_lshl_add_u32 v8,v124,30,v8
s_lshl_b32 s60,s46,8
s_add_u32 s59,s62,s60
s_nop 0
v_cvt_pk_bf16_f32 v24,v116,v117
v_cvt_pk_bf16_f32 v25,v118,v119
buffer_store_dwordx2 v[24:25],v8,s[8:11],s59 offen sc1
s_lshl_b32 s59,s51,13
s_lshl2_add_u32 s59,s47,s59
s_add_u32 s59,s59,10486912
s_waitcnt vmcnt(0)
s_barrier
s_or_b32 s59,s59,s52
buffer_store_dword v17,off,s[8:11],s59 sc1
s_cmp_lg_u32 s47,0
s_cbranch_scc1 L_moed_406
s_lshl_b32 s59,s51,13
s_add_u32 s59,s59,10486912
v_and_b32 v124,31,v1
v_lshlrev_b32 v124,2,v124
L_fw_407:
buffer_load_dword v125,v124,s[8:11],s59 offen sc1
s_sub_u32 s49,s49,1
s_cbranch_scc1 L_abort2
s_waitcnt vmcnt(0)
v_cmp_eq_u32 vcc,0,v125
s_cbranch_vccnz L_fw_407
s_add_u32 s63,s65,0
buffer_load_dwordx4 v[24:27],v22,s[8:11],s63 offen sc1
s_add_u32 s63,s65,4096
buffer_load_dwordx4 v[28:31],v22,s[8:11],s63 offen sc1
s_add_u32 s63,s65,8192
buffer_load_dwordx4 v[32:35],v22,s[8:11],s63 offen sc1
s_add_u32 s63,s65,12288
buffer_load_dwordx4 v[36:39],v22,s[8:11],s63 offen sc1
s_add_u32 s63,s65,16384
buffer_load_dwordx4 v[40:43],v22,s[8:11],s63 offen sc1
s_add_u32 s63,s65,20480
buffer_load_dwordx4 v[44:47],v22,s[8:11],s63 offen sc1
s_add_u32 s63,s65,24576
buffer_load_dwordx4 v[48:51],v22,s[8:11],s63 offen sc1
s_add_u32 s63,s65,28672
buffer_load_dwordx4 v[52:55],v22,s[8:11],s63 offen sc1
v_and_b32 v64,15,v1
v_and_b32 v65,1,v1
v_lshlrev_b32 v65,4,v65
v_mov_b32 v66,0x3f80
v_lshlrev_b32 v66,v65,v66
v_lshrrev_b32 v64,1,v64
v_cmp_eq_u32 vcc,0,v64
s_nop 1
v_cndmask_b32 v56,0,v66,vcc
v_cmp_eq_u32 vcc,1,v64
s_nop 1
v_cndmask_b32 v57,0,v66,vcc
v_cmp_eq_u32 vcc,2,v64
s_nop 1
v_cndmask_b32 v58,0,v66,vcc
v_cmp_eq_u32 vcc,3,v64
s_nop 1
v_cndmask_b32 v59,0,v66,vcc
s_waitcnt vmcnt(7)
s_nop 0
v_mfma_f32_16x16x32_bf16 v[60:63],v[56:59],v[24:27],0
s_waitcnt vmcnt(6)
v_mfma_f32_16x16x32_bf16 v[60:63],v[56:59],v[28:31],v[60:63]
s_waitcnt vmcnt(5)
v_mfma_f32_16x16x32_bf16 v[60:63],v[56:59],v[32:35],v[60:63]
s_waitcnt vmcnt(4)
v_mfma_f32_16x16x32_bf16 v[60:63],v[56:59],v[36:39],v[60:63]
s_waitcnt vmcnt(3)
v_mfma_f32_16x16x32_bf16 v[60:63],v[56:59],v[40:43],v[60:63]
s_waitcnt vmcnt(2)
v_mfma_f32_16x16x32_bf16 v[60:63],v[56:59],v[44:47],v[60:63]
s_waitcnt vmcnt(1)
v_mfma_f32_16x16x32_bf16 v[60:63],v[56:59],v[48:51],v[60:63]
s_waitcnt vmcnt(0)
v_mfma_f32_16x16x32_bf16 v[60:63],v[56:59],v[52:55],v[60:63]
s_nop 7
ds_write_b128 v21,v[60:63]
s_waitcnt lgkmcnt(0)
s_barrier
s_cmp_lg_u32 s46,0
s_cbranch_scc1 L_moed_406
v_lshlrev_b32 v56,5,v1
v_add_u32 v56,155648,v56
ds_read_b128 v[24:27],v56
ds_read_b128 v[28:31],v56 offset:16
s_and_b32 s59,s55,0xffff0000
s_xor_b32 s60,s59,0x80000000
s_xor_b32 s61,s59,0xffff0000
s_cmp_lt_i32 s59,0
s_cselect_b32 s59,s60,s61
v_mov_b32 v56,s59
v_mul_f32 v56,0xbfb8aa3b,v56
v_exp_f32 v56,v56
s_nop 0
v_add_f32 v56,1.0,v56
v_rcp_f32 v56,v56
s_nop 0
v_cvt_pk_bf16_f32 v56,v56,v56
v_and_b32 v56,0xffff0000,v56
v_lshlrev_b32 v48,16,v104
v_and_b32 v49,0xffff0000,v104
v_lshlrev_b32 v50,16,v105
v_and_b32 v51,0xffff0000,v105
v_lshlrev_b32 v52,16,v106
v_and_b32 v53,0xffff0000,v106
v_lshlrev_b32 v54,16,v107
v_and_b32 v55,0xffff0000,v107
s_waitcnt lgkmcnt(0)
v_cvt_pk_bf16_f32 v40,v24,v25
v_cvt_pk_bf16_f32 v41,v26,v27
v_cvt_pk_bf16_f32 v42,v28,v29
v_cvt_pk_bf16_f32 v43,v30,v31
v_lshlrev_b32 v24,16,v40
v_and_b32 v25,0xffff0000,v40
v_lshlrev_b32 v26,16,v41
v_and_b32 v27,0xffff0000,v41
v_lshlrev_b32 v28,16,v42
v_and_b32 v29,0xffff0000,v42
v_lshlrev_b32 v30,16,v43
v_and_b32 v31,0xffff0000,v43
v_pk_mul_f32 v[24:25],v[24:25],v[56:57] op_sel_hi:[1,0]
v_pk_mul_f32 v[26:27],v[26:27],v[56:57] op_sel_hi:[1,0]
v_pk_mul_f32 v[28:29],v[28:29],v[56:57] op_sel_hi:[1,0]
v_pk_mul_f32 v[30:31],v[30:31],v[56:57] op_sel_hi:[1,0]
v_cvt_pk_bf16_f32 v40,v24,v25
v_cvt_pk_bf16_f32 v41,v26,v27
v_cvt_pk_bf16_f32 v42,v28,v29
v_cvt_pk_bf16_f32 v43,v30,v31
v_lshlrev_b32 v24,16,v40
v_and_b32 v25,0xffff0000,v40
v_lshlrev_b32 v26,16,v41
v_and_b32 v27,0xffff0000,v41
v_lshlrev_b32 v28,16,v42
v_and_b32 v29,0xffff0000,v42
v_lshlrev_b32 v30,16,v43
v_and_b32 v31,0xffff0000,v43
v_pk_add_f32 v[24:25],v[24:25],v[48:49]
v_pk_add_f32 v[26:27],v[26:27],v[50:51]
v_pk_add_f32 v[28:29],v[28:29],v[52:53]
v_pk_add_f32 v[30:31],v[30:31],v[54:55]
v_cvt_pk_bf16_f32 v40,v24,v25
v_cvt_pk_bf16_f32 v41,v26,v27
v_cvt_pk_bf16_f32 v42,v28,v29
v_cvt_pk_bf16_f32 v43,v30,v31
v_lshlrev_b32 v24,16,v40
v_and_b32 v25,0xffff0000,v40
v_lshlrev_b32 v26,16,v41
v_and_b32 v27,0xffff0000,v41
v_lshlrev_b32 v28,16,v42
v_and_b32 v29,0xffff0000,v42
v_lshlrev_b32 v30,16,v43
v_and_b32 v31,0xffff0000,v43
v_pk_add_f32 v[96:97],v[96:97],v[24:25]
v_pk_add_f32 v[98:99],v[98:99],v[26:27]
v_pk_add_f32 v[100:101],v[100:101],v[28:29]
v_pk_add_f32 v[102:103],v[102:103],v[30:31]
v_cvt_pk_bf16_f32 v160,v96,v97
v_cvt_pk_bf16_f32 v161,v98,v99
v_cvt_pk_bf16_f32 v162,v100,v101
v_cvt_pk_bf16_f32 v163,v102,v103
L_moed_406:
s_or_b32 s61,s47,s46
s_cselect_b32 s61,1,0
s_add_u32 s51,s51,1
s_lshl1_add_u32 s61,s51,s61
s_cmp_gt_u32 s61,132
s_cbranch_scc1 L_mf_401
s_cmp_eq_u32 s61,132
s_cbranch_scc1 L_mf_399
v_and_b32 v9,15,v1
v_lshrrev_b32 v10,4,v1
v_and_b32 v124,1,v1
v_lshlrev_b32 v124,4,v124
v_mov_b32 v125,0xffff
v_lshlrev_b32 v125,v124,v125
v_lshrrev_b32 v124,2,v9
v_cmp_eq_u32 vcc,0,v124
s_nop 1
v_cndmask_b32 v12,0,v125,vcc
v_cmp_eq_u32 vcc,1,v124
s_nop 1
v_cndmask_b32 v13,0,v125,vcc
v_and_b32 v124,2,v1
v_cmp_eq_u32 vcc,0,v124
v_mov_b32 v14,0xeeee
v_mov_b32 v124,0x4444
v_cndmask_b32 v14,v14,v124,vcc
v_lshlrev_b32 v11,14,v10
v_lshl_add_u32 v11,v9,4,v11
s_lshl_b32 s65,s51,15
s_add_u32 s65,s65,92274688
s_lshl_b32 s62,s47,10
s_add_u32 s62,s62,s65
s_lshl_b32 s63,s47,16
s_lshl_b32 s60,s46,8
s_add_u32 s63,s63,s60
s_mov_b32 s4,s38
s_mov_b32 s5,s39
s_mov_b32 s6,1835008
s_mov_b32 s7,0x20000
buffer_load_dwordx4 v[24:27],v11,s[4:7],s63 offen offset:0
buffer_load_dwordx4 v[28:31],v11,s[4:7],s63 offen offset:1024
buffer_load_dwordx4 v[32:35],v11,s[4:7],s63 offen offset:2048
buffer_load_dwordx4 v[36:39],v11,s[4:7],s63 offen offset:3072
s_add_u32 s63,s63,4096
buffer_load_dwordx4 v[40:43],v11,s[4:7],s63 offen offset:0
buffer_load_dwordx4 v[44:47],v11,s[4:7],s63 offen offset:1024
buffer_load_dwordx4 v[48:51],v11,s[4:7],s63 offen offset:2048
buffer_load_dwordx4 v[52:55],v11,s[4:7],s63 offen offset:3072
s_add_u32 s63,s63,4096
buffer_load_dwordx4 v[56:59],v11,s[4:7],s63 offen offset:0
buffer_load_dwordx4 v[60:63],v11,s[4:7],s63 offen offset:1024
buffer_load_dwordx4 v[64:67],v11,s[4:7],s63 offen offset:2048
buffer_load_dwordx4 v[68:71],v11,s[4:7],s63 offen offset:3072
s_add_u32 s63,s63,4096
buffer_load_dwordx4 v[72:75],v11,s[4:7],s63 offen offset:0
buffer_load_dwordx4 v[76:79],v11,s[4:7],s63 offen offset:1024
buffer_load_dwordx4 v[80:83],v11,s[4:7],s63 offen offset:2048
buffer_load_dwordx4 v[84:87],v11,s[4:7],s63 offen offset:3072
s_cmp_eq_u32 s61,131
s_cbranch_scc1 L_mf_400
v_lshrrev_b32 v2,3,v1
s_lshr_b32 s20,s85,24
v_lshrrev_b32 v3,v2,s20
v_and_b32 v3,1,v3
v_mul_u32_u24 v3,768,v3
v_lshlrev_b32 v2,13,v2
v_sub_u32 v2,v2,v3
v_and_b32 v3,0x70,v0
v_add_u32 v2,v2,v3
v_add_u32 v2,1536,v2
s_mov_b32 s59,10944512
L_mf_398:
buffer_load_dwordx4 v[164:167],v2,s[8:11],s59 offen sc1
s_sub_u32 s49,s49,1
s_cbranch_scc1 L_abort2
s_waitcnt vmcnt(0)
v_min3_u32 v168,v164,v165,v166
v_min_u32 v168,v167,v168
v_cmp_eq_u32 vcc,0,v168
s_cbranch_vccnz L_mf_398
v_max3_u32 v168,v164,v165,v166
v_max3_u32 v168,v167,v168,s55
v_cmp_lt_u32 vcc,s55,v168
s_mov_b32 s59,11019904
s_cbranch_vccz L_mf_399
v_max_u32_dpp v168,v168,v168 row_ror:8 row_mask:0xf bank_mask:0xf
s_nop 1
v_max_u32_dpp v168,v168,v168 row_ror:4 row_mask:0xf bank_mask:0xf
s_nop 1
v_max_u32_dpp v168,v168,v168 row_ror:2 row_mask:0xf bank_mask:0xf
s_nop 1
v_max_u32_dpp v168,v168,v168 row_ror:1 row_mask:0xf bank_mask:0xf
v_mov_b32 v169,v168
s_nop 1
v_permlane16_swap_b32 v168,v169
v_max_u32 v168,v168,v169
v_mov_b32 v169,v168
s_nop 1
v_permlane32_swap_b32 v168,v169
v_max_u32 v168,v168,v169
buffer_store_dword v168,off,s[8:11],s59 sc1
s_branch L_mf_400
L_mf_399:
s_mov_b32 s4,s40
s_mov_b32 s5,s41
s_mov_b32 s6,2097152
s_mov_b32 s7,0x20000
buffer_store_dwordx4 v[160:163],v0,s[4:7],s56 offen sc1
v_mov_b32 v168,s55
s_mov_b32 s59,11019904
buffer_store_dword v168,off,s[8:11],s59 sc1
s_endpgm
L_mf_400:
s_mov_b32 s59,11019904
L_ww_410:
s_sleep 1
buffer_load_dword v2,off,s[8:11],s59 sc1
s_sub_u32 s49,s49,1
s_cbranch_scc1 L_abort2
s_waitcnt vmcnt(0)
v_readfirstlane_b32 s61,v2
s_cmp_eq_u32 s61,0
s_cbranch_scc1 L_ww_410
L_wwd_411:
s_cmp_eq_u32 s61,s55
s_cbranch_scc1 L_mf_401
s_mov_b32 s55,s61
s_barrier
s_branch L_mf_397
L_mf_401:
s_waitcnt vmcnt(0)
s_endpgm
.section .rodata,"a"
.p2align 6
.amdhsa_kernel interleave_layers__memory_aug_recurrent_mem_tr__moe_arch_mod__prompt_kernel
  .amdhsa_next_free_vgpr 512
  .amdhsa_next_free_sgpr 102
  .amdhsa_accum_offset 256
  .amdhsa_group_segment_fixed_size 0
  .amdhsa_kernarg_size 120
  .amdhsa_user_sgpr_count 2
  .amdhsa_user_sgpr_kernarg_segment_ptr 1
  .amdhsa_system_sgpr_workgroup_id_x 1
  .amdhsa_float_denorm_mode_32 3
.end_amdhsa_kernel
```

```asm
; @launch grid=(256,1,1) block=(256,1,1) lds=163840
.amdgcn_target "amdgcn-amd-amdhsa--gfx950"
.text
.globl interleave_layers__memory_aug_recurrent_mem_tr__moe_arch_mod__prompt_kernel
.p2align 8
.type interleave_layers__memory_aug_recurrent_mem_tr__moe_arch_mod__prompt_kernel,@function
interleave_layers__memory_aug_recurrent_mem_tr__moe_arch_mod__prompt_kernel:
s_cmp_ge_u32 s2,256
s_cbranch_scc1 L_abort
s_load_dwordx16 s[16:31],s[0:1],0
s_load_dwordx8 s[32:39],s[0:1],64
s_load_dwordx4 s[40:43],s[0:1],96
s_load_dwordx2 s[44:45],s[0:1],112
v_lshrrev_b32 v2,6,v0
v_and_b32 v1,63,v0
v_readfirstlane_b32 s46,v2
v_lshlrev_b32 v0,4,v1
s_getreg_b32 s48,hwreg(HW_REG_XCC_ID)
s_and_b32 s48,s48,7
s_mov_b32 s49,100000
s_mov_b32 s80,0x3e0293ee
s_waitcnt lgkmcnt(0)
s_mov_b32 s8,s44
s_mov_b32 s9,s45
s_mov_b32 s10,268435456
s_mov_b32 s11,0x20000
s_mov_b32 s12,s42
s_mov_b32 s13,s43
s_mov_b32 s14,256
s_mov_b32 s15,0x20000
s_cmp_lg_u32 s46,0
s_cbranch_scc1 L_tk_1
s_lshl_b32 s56,s48,2
v_mov_b32 v14,s56
v_mov_b32 v15,1
s_or_b32 s56,s48,8
v_mov_b32 v16,s56
v_mov_b32 v17,0
s_mov_b64 exec,1
buffer_atomic_cmpswap v[16:17],off,s[12:15],0 offset:192 sc0
buffer_atomic_add v15,v14,s[12:15],0 offen sc0
s_mov_b64 exec,-1
L_tk_1:
s_mov_b32 s4,s16
s_mov_b32 s5,s17
s_mov_b32 s6,2097152
s_mov_b32 s7,0x20000
s_lshl_b32 s56,s2,3
s_lshl_b32 s59,s46,1
s_add_u32 s56,s56,s59
s_lshl_b32 s59,s56,10
buffer_load_dwordx4 v[24:27],v0,s[4:7],s59 offen
buffer_load_dwordx4 v[28:31],v0,s[4:7],s59 offen offset:1024
s_lshl_b32 s56,s2,12
s_lshl_b32 s57,s46,10
s_add_u32 s56,s56,s57
v_add_u32 v2,s56,v0
v_mov_b32 v4,-1
v_mov_b32 v5,-1
v_mov_b32 v6,-1
v_mov_b32 v7,-1
v_mov_b32 v8,0
v_mov_b32 v9,0
v_mov_b32 v10,0
v_mov_b32 v11,0
v_cmp_gt_u32 vcc,524288,v2
v_mov_b32 v3,14155776
v_mov_b32 v12,11542528
v_cndmask_b32 v3,v3,v12,vcc
v_add_u32 v3,v3,v2
s_mov_b32 s56,0
buffer_store_dwordx4 v[4:7],v3,s[8:11],s56 offen sc1
s_mov_b32 s56,1048576
buffer_store_dwordx4 v[4:7],v3,s[8:11],s56 offen sc1
s_mov_b32 s56,2097152
buffer_store_dwordx4 v[4:7],v3,s[8:11],s56 offen sc1
s_mov_b32 s56,4194304
buffer_store_dwordx4 v[4:7],v2,s[8:11],s56 offen sc1
s_mov_b32 s56,5242880
buffer_store_dwordx4 v[4:7],v2,s[8:11],s56 offen sc1
v_add_u32 v3,17309696,v2
v_mov_b32 v12,0x80000000
v_cndmask_b32 v3,v3,v12,vcc
buffer_store_dwordx4 v[4:7],v3,s[8:11],0 offen sc1
v_cmp_gt_u32 vcc,147456,v2
v_lshrrev_b32 v3,11,v2
v_lshlrev_b32 v3,13,v3
v_and_b32 v13,0x7ff,v2
v_add_u32 v3,v3,v13
v_add_u32 v3,10485760,v3
v_cndmask_b32 v3,v12,v3,vcc
buffer_store_dwordx4 v[8:11],v3,s[8:11],0 offen sc1
v_add_u32 v3,11075584,v2
v_lshrrev_b32 v13,16,v2
v_cmp_eq_u32 vcc,4,v13
s_nop 1
v_cndmask_b32 v3,v12,v3,vcc
buffer_store_dwordx4 v[4:7],v3,s[8:11],0 offen sc1
s_waitcnt vmcnt(8)
v_lshlrev_b32 v32,16,v24
v_and_b32 v33,0xffff0000,v24
v_lshlrev_b32 v34,16,v25
v_and_b32 v35,0xffff0000,v25
v_lshlrev_b32 v36,16,v26
v_and_b32 v37,0xffff0000,v26
v_lshlrev_b32 v38,16,v27
v_and_b32 v39,0xffff0000,v27
v_readfirstlane_b32 s78,v32
s_nop 1
v_pk_add_f32 v[48:49],v[32:33],s[78:79] op_sel_hi:[1,0] neg_lo:[0,1] neg_hi:[0,1]
v_pk_add_f32 v[50:51],v[34:35],s[78:79] op_sel_hi:[1,0] neg_lo:[0,1] neg_hi:[0,1]
v_pk_add_f32 v[52:53],v[36:37],s[78:79] op_sel_hi:[1,0] neg_lo:[0,1] neg_hi:[0,1]
v_pk_add_f32 v[54:55],v[38:39],s[78:79] op_sel_hi:[1,0] neg_lo:[0,1] neg_hi:[0,1]
v_pk_add_f32 v[56:57],v[48:49],v[50:51]
v_pk_mul_f32 v[58:59],v[48:49],v[48:49]
v_pk_add_f32 v[60:61],v[52:53],v[54:55]
v_pk_fma_f32 v[58:59],v[50:51],v[50:51],v[58:59]
v_pk_add_f32 v[56:57],v[56:57],v[60:61]
v_pk_fma_f32 v[58:59],v[52:53],v[52:53],v[58:59]
v_add_f32 v56,v56,v57
v_pk_fma_f32 v[58:59],v[54:55],v[54:55],v[58:59]
v_add_f32 v58,v58,v59
s_nop 1
v_permlane32_swap_b32 v56,v58
v_add_f32 v56,v56,v58
s_nop 1
v_add_f32_dpp v56,v56,v56 row_ror:8 row_mask:0xf bank_mask:0xf
s_nop 1
v_add_f32_dpp v56,v56,v56 row_ror:4 row_mask:0xf bank_mask:0xf
s_nop 1
v_add_f32_dpp v56,v56,v56 row_ror:2 row_mask:0xf bank_mask:0xf
s_nop 1
v_add_f32_dpp v56,v56,v56 row_ror:1 row_mask:0xf bank_mask:0xf
v_mov_b32 v58,v56
s_nop 1
v_permlane16_swap_b32 v56,v58
v_add_f32 v56,v56,v58
v_mul_f32 v56,0x3b000000,v56
v_mov_b32 v58,v56
s_nop 1
v_permlane32_swap_b32 v56,v58
v_fma_f32 v58,-v56,v56,v58
v_add_f32 v56,s78,v56
v_max_f32 v58,0,v58
v_cvt_pk_bf16_f32 v58,v56,v58
v_lshlrev_b32 v56,16,v58
v_and_b32 v58,0xffff0000,v58
v_add_f32 v58,0x3727c5ac,v58
v_cvt_pk_bf16_f32 v58,v58,v58
v_and_b32 v58,0xffff0000,v58
v_sqrt_f32 v58,v58
v_pk_add_f32 v[48:49],v[32:33],v[56:57] op_sel_hi:[1,0] neg_lo:[0,1] neg_hi:[0,1]
v_pk_add_f32 v[50:51],v[34:35],v[56:57] op_sel_hi:[1,0] neg_lo:[0,1] neg_hi:[0,1]
v_pk_add_f32 v[52:53],v[36:37],v[56:57] op_sel_hi:[1,0] neg_lo:[0,1] neg_hi:[0,1]
v_pk_add_f32 v[54:55],v[38:39],v[56:57] op_sel_hi:[1,0] neg_lo:[0,1] neg_hi:[0,1]
v_cvt_pk_bf16_f32 v58,v58,v58
v_and_b32 v58,0xffff0000,v58
v_rcp_f32 v58,v58
v_cvt_pk_bf16_f32 v40,v48,v49
v_cvt_pk_bf16_f32 v41,v50,v51
v_cvt_pk_bf16_f32 v42,v52,v53
v_cvt_pk_bf16_f32 v43,v54,v55
v_lshlrev_b32 v48,16,v40
v_and_b32 v49,0xffff0000,v40
v_lshlrev_b32 v50,16,v41
v_and_b32 v51,0xffff0000,v41
v_lshlrev_b32 v52,16,v42
v_and_b32 v53,0xffff0000,v42
v_lshlrev_b32 v54,16,v43
v_and_b32 v55,0xffff0000,v43
v_pk_mul_f32 v[48:49],v[48:49],v[58:59] op_sel_hi:[1,0]
v_pk_mul_f32 v[50:51],v[50:51],v[58:59] op_sel_hi:[1,0]
v_pk_mul_f32 v[52:53],v[52:53],v[58:59] op_sel_hi:[1,0]
v_pk_mul_f32 v[54:55],v[54:55],v[58:59] op_sel_hi:[1,0]
v_cvt_pk_bf16_f32 v40,v48,v49
v_cvt_pk_bf16_f32 v41,v50,v51
v_cvt_pk_bf16_f32 v42,v52,v53
v_cvt_pk_bf16_f32 v43,v54,v55
buffer_store_dwordx4 v[40:43],v0,s[8:11],s59 offen offset:0 sc1
v_lshlrev_b32 v32,16,v28
v_and_b32 v33,0xffff0000,v28
v_lshlrev_b32 v34,16,v29
v_and_b32 v35,0xffff0000,v29
v_lshlrev_b32 v36,16,v30
v_and_b32 v37,0xffff0000,v30
v_lshlrev_b32 v38,16,v31
v_and_b32 v39,0xffff0000,v31
v_readfirstlane_b32 s78,v32
s_nop 1
v_pk_add_f32 v[48:49],v[32:33],s[78:79] op_sel_hi:[1,0] neg_lo:[0,1] neg_hi:[0,1]
v_pk_add_f32 v[50:51],v[34:35],s[78:79] op_sel_hi:[1,0] neg_lo:[0,1] neg_hi:[0,1]
v_pk_add_f32 v[52:53],v[36:37],s[78:79] op_sel_hi:[1,0] neg_lo:[0,1] neg_hi:[0,1]
v_pk_add_f32 v[54:55],v[38:39],s[78:79] op_sel_hi:[1,0] neg_lo:[0,1] neg_hi:[0,1]
v_pk_add_f32 v[56:57],v[48:49],v[50:51]
v_pk_mul_f32 v[58:59],v[48:49],v[48:49]
v_pk_add_f32 v[60:61],v[52:53],v[54:55]
v_pk_fma_f32 v[58:59],v[50:51],v[50:51],v[58:59]
v_pk_add_f32 v[56:57],v[56:57],v[60:61]
v_pk_fma_f32 v[58:59],v[52:53],v[52:53],v[58:59]
v_add_f32 v56,v56,v57
v_pk_fma_f32 v[58:59],v[54:55],v[54:55],v[58:59]
v_add_f32 v58,v58,v59
s_nop 1
v_permlane32_swap_b32 v56,v58
v_add_f32 v56,v56,v58
s_nop 1
v_add_f32_dpp v56,v56,v56 row_ror:8 row_mask:0xf bank_mask:0xf
s_nop 1
v_add_f32_dpp v56,v56,v56 row_ror:4 row_mask:0xf bank_mask:0xf
s_nop 1
v_add_f32_dpp v56,v56,v56 row_ror:2 row_mask:0xf bank_mask:0xf
s_nop 1
v_add_f32_dpp v56,v56,v56 row_ror:1 row_mask:0xf bank_mask:0xf
v_mov_b32 v58,v56
s_nop 1
v_permlane16_swap_b32 v56,v58
v_add_f32 v56,v56,v58
v_mul_f32 v56,0x3b000000,v56
v_mov_b32 v58,v56
s_nop 1
v_permlane32_swap_b32 v56,v58
v_fma_f32 v58,-v56,v56,v58
v_add_f32 v56,s78,v56
v_max_f32 v58,0,v58
v_cvt_pk_bf16_f32 v58,v56,v58
v_lshlrev_b32 v56,16,v58
v_and_b32 v58,0xffff0000,v58
v_add_f32 v58,0x3727c5ac,v58
v_cvt_pk_bf16_f32 v58,v58,v58
v_and_b32 v58,0xffff0000,v58
v_sqrt_f32 v58,v58
v_pk_add_f32 v[48:49],v[32:33],v[56:57] op_sel_hi:[1,0] neg_lo:[0,1] neg_hi:[0,1]
v_pk_add_f32 v[50:51],v[34:35],v[56:57] op_sel_hi:[1,0] neg_lo:[0,1] neg_hi:[0,1]
v_pk_add_f32 v[52:53],v[36:37],v[56:57] op_sel_hi:[1,0] neg_lo:[0,1] neg_hi:[0,1]
v_pk_add_f32 v[54:55],v[38:39],v[56:57] op_sel_hi:[1,0] neg_lo:[0,1] neg_hi:[0,1]
v_cvt_pk_bf16_f32 v58,v58,v58
v_and_b32 v58,0xffff0000,v58
v_rcp_f32 v58,v58
v_cvt_pk_bf16_f32 v44,v48,v49
v_cvt_pk_bf16_f32 v45,v50,v51
v_cvt_pk_bf16_f32 v46,v52,v53
v_cvt_pk_bf16_f32 v47,v54,v55
v_lshlrev_b32 v48,16,v44
v_and_b32 v49,0xffff0000,v44
v_lshlrev_b32 v50,16,v45
v_and_b32 v51,0xffff0000,v45
v_lshlrev_b32 v52,16,v46
v_and_b32 v53,0xffff0000,v46
v_lshlrev_b32 v54,16,v47
v_and_b32 v55,0xffff0000,v47
v_pk_mul_f32 v[48:49],v[48:49],v[58:59] op_sel_hi:[1,0]
v_pk_mul_f32 v[50:51],v[50:51],v[58:59] op_sel_hi:[1,0]
v_pk_mul_f32 v[52:53],v[52:53],v[58:59] op_sel_hi:[1,0]
v_pk_mul_f32 v[54:55],v[54:55],v[58:59] op_sel_hi:[1,0]
v_cvt_pk_bf16_f32 v44,v48,v49
v_cvt_pk_bf16_f32 v45,v50,v51
v_cvt_pk_bf16_f32 v46,v52,v53
v_cvt_pk_bf16_f32 v47,v54,v55
buffer_store_dwordx4 v[44:47],v0,s[8:11],s59 offen offset:1024 sc1
s_mov_b32 s4,s18
s_mov_b32 s5,s19
s_mov_b32 s6,8192
s_mov_b32 s7,0x20000
s_cmp_ge_u32 s2,2
s_cbranch_scc1 L_m0_2
s_lshl_b32 s56,s2,2
s_add_u32 s56,s56,s46
v_bfe_u32 v2,v1,2,2
v_and_b32 v3,1,v1
v_lshl_add_u32 v2,v2,1,v3
v_lshlrev_b32 v2,10,v2
v_lshrrev_b32 v3,4,v1
v_lshl_add_u32 v2,v3,5,v2
v_and_b32 v3,2,v1
v_lshl_add_u32 v2,v3,1,v2
s_lshl_b32 s57,s56,7
buffer_load_dword v32,v2,s[4:7],s57 offen offset:0
buffer_load_dword v33,v2,s[4:7],s57 offen offset:8
buffer_load_dword v34,v2,s[4:7],s57 offen offset:16
buffer_load_dword v35,v2,s[4:7],s57 offen offset:24
v_lshrrev_b32 v2,3,v1
v_lshlrev_b32 v2,9,v2
v_and_b32 v3,7,v1
v_lshl_add_u32 v2,v3,4,v2
s_and_b32 s57,s56,1
s_lshl_b32 s57,s57,8
s_and_b32 s58,s56,2
s_lshl_b32 s58,s58,6
s_add_u32 s57,s57,s58
s_and_b32 s58,s56,4
s_lshl_b32 s58,s58,10
s_add_u32 s57,s57,s58
s_waitcnt vmcnt(0)
s_add_u32 s58,s57,11534336
buffer_store_dwordx4 v[32:35],v2,s[8:11],s58 offen sc1
s_add_u32 s58,s57,12582912
buffer_store_dwordx4 v[32:35],v2,s[8:11],s58 offen sc1
s_add_u32 s58,s57,17825792
buffer_store_dwordx4 v[32:35],v2,s[8:11],s58 offen sc1
L_m0_2:
s_cmp_lg_u32 s46,0
s_cbranch_scc1 L_tk_3
s_mov_b64 exec,1
v_mov_b32 v4,159744
ds_write2_b32 v4,v15,v16 offset1:1
s_mov_b64 exec,-1
s_waitcnt lgkmcnt(0)
L_tk_3:
s_barrier
v_mov_b32 v4,159744
ds_read_b64 v[2:3],v4
s_waitcnt lgkmcnt(0)
v_readfirstlane_b32 s47,v2
v_readfirstlane_b32 s56,v3
s_cmp_eq_u32 s56,0
s_cselect_b32 s56,s48,s56
s_and_b32 s56,s56,7
s_xor_b32 s48,s48,s56
s_lshl_b32 s48,s48,2
s_lshr_b32 s48,1399931488,s48
s_and_b32 s48,s48,7
s_mov_b32 s3,0
s_cmp_ge_u32 s47,32
s_cselect_b32 s53,0x10001,1
s_and_b32 s47,s47,31
s_lshl_b32 s50,s46,10
s_cmp_eq_u32 s46,0
s_cselect_b32 s52,0,0x80000000
s_mov_b32 s28,0x3f803f80
s_mov_b32 s29,0x3f803f80
s_mov_b32 s51,0
s_bfe_u32 s56,s48,0x10001
s_and_b32 s57,s48,1
s_add_u32 s58,s56,6
s_sub_u32 s59,5,s57
s_cmp_ge_u32 s47,16
s_cselect_b32 s58,s58,s59
s_cselect_b32 s57,s57,s56
s_and_b32 s59,s47,15
s_lshl4_add_u32 s57,s57,s59
s_cmp_ge_u32 s48,4
s_cselect_b32 s48,s58,s48
s_cselect_b32 s47,s57,s47
L_roles:
s_lshl_b32 s56,1,s48
s_and_b32 s56,s56,6
s_cbranch_scc0 L_x_10
s_waitcnt vmcnt(0)
s_barrier
s_cmp_lg_u32 s46,0
s_cbranch_scc1 L_ar_11
v_mov_b32 v8,128
v_mov_b32 v9,s53
s_mov_b64 exec,1
buffer_atomic_add v9,v8,s[12:15],0 offen
s_mov_b64 exec,-1
L_ar_11:
s_mov_b32 s53,0
v_mov_b32 v123,159744
s_cmp_lg_u32 s46,0
s_cbranch_scc1 L_gbd_13
v_mov_b32 v124,128
L_gb_12:
buffer_load_dword v125,v124,s[12:15],0 offen sc1
s_waitcnt vmcnt(0)
v_readfirstlane_b32 s56,v125
ds_write_b32 v123,v125
s_bitcmp1_b32 s56,8
s_cbranch_scc1 L_gbd_13
s_sleep 4
s_sub_u32 s49,s49,1
s_cmp_gt_i32 s49,0
s_cbranch_scc1 L_gb_12
s_branch L_abort
L_gbd_13:
s_waitcnt lgkmcnt(0)
s_barrier
ds_read_b32 v125,v123
s_waitcnt lgkmcnt(0)
v_readfirstlane_b32 s56,v125
s_barrier
s_lshr_b32 s56,s56,16
s_andn2_b32 s56,s56,s3
s_cbranch_scc1 L_spread
L_x_10:
s_cmp_ge_u32 s48,6
s_cbranch_scc1 L_ra_6
v_lshrrev_b32 v2,2,v1
v_lshrrev_b32 v3,5,v1
v_xor_b32 v2,v2,v3
v_lshlrev_b32 v2,13,v2
v_and_b32 v3,3,v1
v_lshl_add_u32 v2,v3,4,v2
v_and_b32 v3,15,v1
v_lshlrev_b32 v3,2,v3
v_lshrrev_b32 v4,4,v1
v_lshl_add_u32 v3,v4,9,v3
v_and_b32 v4,1,v4
v_lshl_add_u32 v3,v4,6,v3
s_lshl_b32 s59,s46,15
s_cmp_lt_u32 s48,3
s_cselect_b32 s63,s46,0
s_lshl_b32 s56,s63,12
s_add_u32 s56,s59,s56
v_add_u32 v3,s56,v3
v_xor_b32 v4,64,v3
s_lshl_b32 s58,s47,8
s_lshl_b32 s56,s46,6
s_add_u32 s58,s58,s56
s_mov_b32 s61,0x05040100
s_mov_b32 s62,0x07060302
s_mov_b32 s4,s22
s_mov_b32 s5,s23
s_mov_b32 s6,4194304
s_mov_b32 s7,0x20000
s_xor_b32 m0,s59,0
s_xor_b32 s60,s58,0
buffer_load_dwordx4 v2,s[4:7],s60 offen lds
s_add_u32 m0,m0,1024
s_add_u32 s60,s60,131072
buffer_load_dwordx4 v2,s[4:7],s60 offen lds
s_xor_b32 m0,s59,2048
s_xor_b32 s60,s58,262144
buffer_load_dwordx4 v2,s[4:7],s60 offen lds
s_add_u32 m0,m0,1024
s_add_u32 s60,s60,131072
buffer_load_dwordx4 v2,s[4:7],s60 offen lds
s_xor_b32 m0,s59,4096
s_xor_b32 s60,s58,524288
buffer_load_dwordx4 v2,s[4:7],s60 offen lds
s_add_u32 m0,m0,1024
s_add_u32 s60,s60,131072
buffer_load_dwordx4 v2,s[4:7],s60 offen lds
s_xor_b32 m0,s59,6144
s_xor_b32 s60,s58,786432
buffer_load_dwordx4 v2,s[4:7],s60 offen lds
s_add_u32 m0,m0,1024
s_add_u32 s60,s60,131072
buffer_load_dwordx4 v2,s[4:7],s60 offen lds
s_xor_b32 m0,s59,8192
s_xor_b32 s60,s58,1048576
buffer_load_dwordx4 v2,s[4:7],s60 offen lds
s_add_u32 m0,m0,1024
s_add_u32 s60,s60,131072
buffer_load_dwordx4 v2,s[4:7],s60 offen lds
s_xor_b32 m0,s59,10240
s_xor_b32 s60,s58,1310720
buffer_load_dwordx4 v2,s[4:7],s60 offen lds
s_add_u32 m0,m0,1024
s_add_u32 s60,s60,131072
buffer_load_dwordx4 v2,s[4:7],s60 offen lds
s_xor_b32 m0,s59,12288
s_xor_b32 s60,s58,1572864
buffer_load_dwordx4 v2,s[4:7],s60 offen lds
s_add_u32 m0,m0,1024
s_add_u32 s60,s60,131072
buffer_load_dwordx4 v2,s[4:7],s60 offen lds
s_xor_b32 m0,s59,14336
s_xor_b32 s60,s58,1835008
buffer_load_dwordx4 v2,s[4:7],s60 offen lds
s_add_u32 m0,m0,1024
s_add_u32 s60,s60,131072
buffer_load_dwordx4 v2,s[4:7],s60 offen lds
s_xor_b32 m0,s59,16384
s_xor_b32 s60,s58,2097152
buffer_load_dwordx4 v2,s[4:7],s60 offen lds
s_add_u32 m0,m0,1024
s_add_u32 s60,s60,131072
buffer_load_dwordx4 v2,s[4:7],s60 offen lds
s_xor_b32 m0,s59,18432
s_xor_b32 s60,s58,2359296
buffer_load_dwordx4 v2,s[4:7],s60 offen lds
s_add_u32 m0,m0,1024
s_add_u32 s60,s60,131072
buffer_load_dwordx4 v2,s[4:7],s60 offen lds
s_xor_b32 m0,s59,20480
s_xor_b32 s60,s58,2621440
buffer_load_dwordx4 v2,s[4:7],s60 offen lds
s_add_u32 m0,m0,1024
s_add_u32 s60,s60,131072
buffer_load_dwordx4 v2,s[4:7],s60 offen lds
s_xor_b32 m0,s59,22528
s_xor_b32 s60,s58,2883584
buffer_load_dwordx4 v2,s[4:7],s60 offen lds
s_add_u32 m0,m0,1024
s_add_u32 s60,s60,131072
buffer_load_dwordx4 v2,s[4:7],s60 offen lds
s_xor_b32 m0,s59,24576
s_xor_b32 s60,s58,3145728
buffer_load_dwordx4 v2,s[4:7],s60 offen lds
s_add_u32 m0,m0,1024
s_add_u32 s60,s60,131072
buffer_load_dwordx4 v2,s[4:7],s60 offen lds
s_xor_b32 m0,s59,26624
s_xor_b32 s60,s58,3407872
buffer_load_dwordx4 v2,s[4:7],s60 offen lds
s_add_u32 m0,m0,1024
s_add_u32 s60,s60,131072
buffer_load_dwordx4 v2,s[4:7],s60 offen lds
s_xor_b32 m0,s59,28672
s_xor_b32 s60,s58,3670016
buffer_load_dwordx4 v2,s[4:7],s60 offen lds
s_add_u32 m0,m0,1024
s_add_u32 s60,s60,131072
buffer_load_dwordx4 v2,s[4:7],s60 offen lds
s_xor_b32 m0,s59,30720
s_xor_b32 s60,s58,3932160
buffer_load_dwordx4 v2,s[4:7],s60 offen lds
s_add_u32 m0,m0,1024
s_add_u32 s60,s60,131072
buffer_load_dwordx4 v2,s[4:7],s60 offen lds
s_waitcnt vmcnt(30)
s_barrier
s_cmp_lg_u32 s46,0
s_cbranch_scc1 L_ar_14
v_mov_b32 v8,128
v_mov_b32 v9,s53
s_mov_b64 exec,1
buffer_atomic_add v9,v8,s[12:15],0 offen
s_mov_b64 exec,-1
L_ar_14:
s_mov_b32 s53,0
s_waitcnt vmcnt(16)
v_xor_b32 v5,0,v3
v_xor_b32 v6,0,v4
ds_read2_b32 v[96:97],v5 offset1:32
ds_read2_b32 v[100:101],v6 offset1:32
ds_read2_b32 v[98:99],v5 offset0:64 offset1:96
ds_read2_b32 v[102:103],v6 offset0:64 offset1:96
v_xor_b32 v5,2048,v3
v_xor_b32 v6,2048,v4
ds_read2_b32 v[104:105],v5 offset1:32
ds_read2_b32 v[108:109],v6 offset1:32
ds_read2_b32 v[106:107],v5 offset0:64 offset1:96
ds_read2_b32 v[110:111],v6 offset0:64 offset1:96
s_waitcnt lgkmcnt(4)
v_perm_b32 v112,v100,v96,s61
v_perm_b32 v113,v101,v97,s61
v_perm_b32 v114,v102,v98,s61
v_perm_b32 v115,v103,v99,s61
v_perm_b32 v116,v100,v96,s62
v_perm_b32 v117,v101,v97,s62
v_perm_b32 v118,v102,v98,s62
v_perm_b32 v119,v103,v99,s62
v_accvgpr_write_b32 a128,v112
v_accvgpr_write_b32 a129,v113
v_accvgpr_write_b32 a130,v114
v_accvgpr_write_b32 a131,v115
v_accvgpr_write_b32 a136,v116
v_accvgpr_write_b32 a137,v117
v_accvgpr_write_b32 a138,v118
v_accvgpr_write_b32 a139,v119
v_xor_b32 v5,4096,v3
v_xor_b32 v6,4096,v4
ds_read2_b32 v[96:97],v5 offset1:32
ds_read2_b32 v[100:101],v6 offset1:32
ds_read2_b32 v[98:99],v5 offset0:64 offset1:96
ds_read2_b32 v[102:103],v6 offset0:64 offset1:96
s_waitcnt lgkmcnt(4)
v_perm_b32 v112,v108,v104,s61
v_perm_b32 v113,v109,v105,s61
v_perm_b32 v114,v110,v106,s61
v_perm_b32 v115,v111,v107,s61
v_perm_b32 v116,v108,v104,s62
v_perm_b32 v117,v109,v105,s62
v_perm_b32 v118,v110,v106,s62
v_perm_b32 v119,v111,v107,s62
v_accvgpr_write_b32 a132,v112
v_accvgpr_write_b32 a133,v113
v_accvgpr_write_b32 a134,v114
v_accvgpr_write_b32 a135,v115
v_accvgpr_write_b32 a140,v116
v_accvgpr_write_b32 a141,v117
v_accvgpr_write_b32 a142,v118
v_accvgpr_write_b32 a143,v119
v_xor_b32 v5,6144,v3
v_xor_b32 v6,6144,v4
ds_read2_b32 v[104:105],v5 offset1:32
ds_read2_b32 v[108:109],v6 offset1:32
ds_read2_b32 v[106:107],v5 offset0:64 offset1:96
ds_read2_b32 v[110:111],v6 offset0:64 offset1:96
s_waitcnt lgkmcnt(4)
v_perm_b32 v112,v100,v96,s61
v_perm_b32 v113,v101,v97,s61
v_perm_b32 v114,v102,v98,s61
v_perm_b32 v115,v103,v99,s61
v_perm_b32 v116,v100,v96,s62
v_perm_b32 v117,v101,v97,s62
v_perm_b32 v118,v102,v98,s62
v_perm_b32 v119,v103,v99,s62
v_accvgpr_write_b32 a144,v112
v_accvgpr_write_b32 a145,v113
v_accvgpr_write_b32 a146,v114
v_accvgpr_write_b32 a147,v115
v_accvgpr_write_b32 a152,v116
v_accvgpr_write_b32 a153,v117
v_accvgpr_write_b32 a154,v118
v_accvgpr_write_b32 a155,v119
v_xor_b32 v5,8192,v3
v_xor_b32 v6,8192,v4
ds_read2_b32 v[96:97],v5 offset1:32
ds_read2_b32 v[100:101],v6 offset1:32
ds_read2_b32 v[98:99],v5 offset0:64 offset1:96
ds_read2_b32 v[102:103],v6 offset0:64 offset1:96
s_waitcnt lgkmcnt(4)
v_perm_b32 v112,v108,v104,s61
v_perm_b32 v113,v109,v105,s61
v_perm_b32 v114,v110,v106,s61
v_perm_b32 v115,v111,v107,s61
v_perm_b32 v116,v108,v104,s62
v_perm_b32 v117,v109,v105,s62
v_perm_b32 v118,v110,v106,s62
v_perm_b32 v119,v111,v107,s62
v_accvgpr_write_b32 a148,v112
v_accvgpr_write_b32 a149,v113
v_accvgpr_write_b32 a150,v114
v_accvgpr_write_b32 a151,v115
v_accvgpr_write_b32 a156,v116
v_accvgpr_write_b32 a157,v117
v_accvgpr_write_b32 a158,v118
v_accvgpr_write_b32 a159,v119
v_xor_b32 v5,10240,v3
v_xor_b32 v6,10240,v4
ds_read2_b32 v[104:105],v5 offset1:32
ds_read2_b32 v[108:109],v6 offset1:32
ds_read2_b32 v[106:107],v5 offset0:64 offset1:96
ds_read2_b32 v[110:111],v6 offset0:64 offset1:96
s_waitcnt lgkmcnt(4)
v_perm_b32 v112,v100,v96,s61
v_perm_b32 v113,v101,v97,s61
v_perm_b32 v114,v102,v98,s61
v_perm_b32 v115,v103,v99,s61
v_perm_b32 v116,v100,v96,s62
v_perm_b32 v117,v101,v97,s62
v_perm_b32 v118,v102,v98,s62
v_perm_b32 v119,v103,v99,s62
v_accvgpr_write_b32 a160,v112
v_accvgpr_write_b32 a161,v113
v_accvgpr_write_b32 a162,v114
v_accvgpr_write_b32 a163,v115
v_accvgpr_write_b32 a168,v116
v_accvgpr_write_b32 a169,v117
v_accvgpr_write_b32 a170,v118
v_accvgpr_write_b32 a171,v119
v_xor_b32 v5,12288,v3
v_xor_b32 v6,12288,v4
ds_read2_b32 v[96:97],v5 offset1:32
ds_read2_b32 v[100:101],v6 offset1:32
ds_read2_b32 v[98:99],v5 offset0:64 offset1:96
ds_read2_b32 v[102:103],v6 offset0:64 offset1:96
s_waitcnt lgkmcnt(4)
v_perm_b32 v112,v108,v104,s61
v_perm_b32 v113,v109,v105,s61
v_perm_b32 v114,v110,v106,s61
v_perm_b32 v115,v111,v107,s61
v_perm_b32 v116,v108,v104,s62
v_perm_b32 v117,v109,v105,s62
v_perm_b32 v118,v110,v106,s62
v_perm_b32 v119,v111,v107,s62
v_accvgpr_write_b32 a164,v112
v_accvgpr_write_b32 a165,v113
v_accvgpr_write_b32 a166,v114
v_accvgpr_write_b32 a167,v115
v_accvgpr_write_b32 a172,v116
v_accvgpr_write_b32 a173,v117
v_accvgpr_write_b32 a174,v118
v_accvgpr_write_b32 a175,v119
v_xor_b32 v5,14336,v3
v_xor_b32 v6,14336,v4
ds_read2_b32 v[104:105],v5 offset1:32
ds_read2_b32 v[108:109],v6 offset1:32
ds_read2_b32 v[106:107],v5 offset0:64 offset1:96
ds_read2_b32 v[110:111],v6 offset0:64 offset1:96
s_waitcnt lgkmcnt(4)
v_perm_b32 v112,v100,v96,s61
v_perm_b32 v113,v101,v97,s61
v_perm_b32 v114,v102,v98,s61
v_perm_b32 v115,v103,v99,s61
v_perm_b32 v116,v100,v96,s62
v_perm_b32 v117,v101,v97,s62
v_perm_b32 v118,v102,v98,s62
v_perm_b32 v119,v103,v99,s62
v_accvgpr_write_b32 a176,v112
v_accvgpr_write_b32 a177,v113
v_accvgpr_write_b32 a178,v114
v_accvgpr_write_b32 a179,v115
v_accvgpr_write_b32 a184,v116
v_accvgpr_write_b32 a185,v117
v_accvgpr_write_b32 a186,v118
v_accvgpr_write_b32 a187,v119
s_waitcnt lgkmcnt(0)
s_mov_b32 s4,s24
s_mov_b32 s5,s25
s_mov_b32 s6,4194304
s_mov_b32 s7,0x20000
s_xor_b32 m0,s59,0
s_xor_b32 s60,s58,0
buffer_load_dwordx4 v2,s[4:7],s60 offen lds
s_add_u32 m0,m0,1024
s_add_u32 s60,s60,131072
buffer_load_dwordx4 v2,s[4:7],s60 offen lds
s_xor_b32 m0,s59,2048
s_xor_b32 s60,s58,262144
buffer_load_dwordx4 v2,s[4:7],s60 offen lds
s_add_u32 m0,m0,1024
s_add_u32 s60,s60,131072
buffer_load_dwordx4 v2,s[4:7],s60 offen lds
s_xor_b32 m0,s59,4096
s_xor_b32 s60,s58,524288
buffer_load_dwordx4 v2,s[4:7],s60 offen lds
s_add_u32 m0,m0,1024
s_add_u32 s60,s60,131072
buffer_load_dwordx4 v2,s[4:7],s60 offen lds
s_xor_b32 m0,s59,6144
s_xor_b32 s60,s58,786432
buffer_load_dwordx4 v2,s[4:7],s60 offen lds
s_add_u32 m0,m0,1024
s_add_u32 s60,s60,131072
buffer_load_dwordx4 v2,s[4:7],s60 offen lds
s_xor_b32 m0,s59,8192
s_xor_b32 s60,s58,1048576
buffer_load_dwordx4 v2,s[4:7],s60 offen lds
s_add_u32 m0,m0,1024
s_add_u32 s60,s60,131072
buffer_load_dwordx4 v2,s[4:7],s60 offen lds
s_xor_b32 m0,s59,10240
s_xor_b32 s60,s58,1310720
buffer_load_dwordx4 v2,s[4:7],s60 offen lds
s_add_u32 m0,m0,1024
s_add_u32 s60,s60,131072
buffer_load_dwordx4 v2,s[4:7],s60 offen lds
s_xor_b32 m0,s59,12288
s_xor_b32 s60,s58,1572864
buffer_load_dwordx4 v2,s[4:7],s60 offen lds
s_add_u32 m0,m0,1024
s_add_u32 s60,s60,131072
buffer_load_dwordx4 v2,s[4:7],s60 offen lds
s_xor_b32 m0,s59,14336
s_xor_b32 s60,s58,1835008
buffer_load_dwordx4 v2,s[4:7],s60 offen lds
s_add_u32 m0,m0,1024
s_add_u32 s60,s60,131072
buffer_load_dwordx4 v2,s[4:7],s60 offen lds
v_perm_b32 v112,v108,v104,s61
v_perm_b32 v113,v109,v105,s61
v_perm_b32 v114,v110,v106,s61
v_perm_b32 v115,v111,v107,s61
v_perm_b32 v116,v108,v104,s62
v_perm_b32 v117,v109,v105,s62
v_perm_b32 v118,v110,v106,s62
v_perm_b32 v119,v111,v107,s62
v_accvgpr_write_b32 a180,v112
v_accvgpr_write_b32 a181,v113
v_accvgpr_write_b32 a182,v114
v_accvgpr_write_b32 a183,v115
v_accvgpr_write_b32 a188,v116
v_accvgpr_write_b32 a189,v117
v_accvgpr_write_b32 a190,v118
v_accvgpr_write_b32 a191,v119
s_waitcnt vmcnt(16)
v_xor_b32 v5,16384,v3
v_xor_b32 v6,16384,v4
ds_read2_b32 v[96:97],v5 offset1:32
ds_read2_b32 v[100:101],v6 offset1:32
ds_read2_b32 v[98:99],v5 offset0:64 offset1:96
ds_read2_b32 v[102:103],v6 offset0:64 offset1:96
v_xor_b32 v5,18432,v3
v_xor_b32 v6,18432,v4
ds_read2_b32 v[104:105],v5 offset1:32
ds_read2_b32 v[108:109],v6 offset1:32
ds_read2_b32 v[106:107],v5 offset0:64 offset1:96
ds_read2_b32 v[110:111],v6 offset0:64 offset1:96
s_waitcnt lgkmcnt(4)
v_perm_b32 v112,v100,v96,s61
v_perm_b32 v113,v101,v97,s61
v_perm_b32 v114,v102,v98,s61
v_perm_b32 v115,v103,v99,s61
v_perm_b32 v116,v100,v96,s62
v_perm_b32 v117,v101,v97,s62
v_perm_b32 v118,v102,v98,s62
v_perm_b32 v119,v103,v99,s62
v_accvgpr_write_b32 a192,v112
v_accvgpr_write_b32 a193,v113
v_accvgpr_write_b32 a194,v114
v_accvgpr_write_b32 a195,v115
v_accvgpr_write_b32 a200,v116
v_accvgpr_write_b32 a201,v117
v_accvgpr_write_b32 a202,v118
v_accvgpr_write_b32 a203,v119
v_xor_b32 v5,20480,v3
v_xor_b32 v6,20480,v4
ds_read2_b32 v[96:97],v5 offset1:32
ds_read2_b32 v[100:101],v6 offset1:32
ds_read2_b32 v[98:99],v5 offset0:64 offset1:96
ds_read2_b32 v[102:103],v6 offset0:64 offset1:96
s_waitcnt lgkmcnt(4)
v_perm_b32 v112,v108,v104,s61
v_perm_b32 v113,v109,v105,s61
v_perm_b32 v114,v110,v106,s61
v_perm_b32 v115,v111,v107,s61
v_perm_b32 v116,v108,v104,s62
v_perm_b32 v117,v109,v105,s62
v_perm_b32 v118,v110,v106,s62
v_perm_b32 v119,v111,v107,s62
v_accvgpr_write_b32 a196,v112
v_accvgpr_write_b32 a197,v113
v_accvgpr_write_b32 a198,v114
v_accvgpr_write_b32 a199,v115
v_accvgpr_write_b32 a204,v116
v_accvgpr_write_b32 a205,v117
v_accvgpr_write_b32 a206,v118
v_accvgpr_write_b32 a207,v119
v_xor_b32 v5,22528,v3
v_xor_b32 v6,22528,v4
ds_read2_b32 v[104:105],v5 offset1:32
ds_read2_b32 v[108:109],v6 offset1:32
ds_read2_b32 v[106:107],v5 offset0:64 offset1:96
ds_read2_b32 v[110:111],v6 offset0:64 offset1:96
s_waitcnt lgkmcnt(4)
v_perm_b32 v112,v100,v96,s61
v_perm_b32 v113,v101,v97,s61
v_perm_b32 v114,v102,v98,s61
v_perm_b32 v115,v103,v99,s61
v_perm_b32 v116,v100,v96,s62
v_perm_b32 v117,v101,v97,s62
v_perm_b32 v118,v102,v98,s62
v_perm_b32 v119,v103,v99,s62
v_accvgpr_write_b32 a208,v112
v_accvgpr_write_b32 a209,v113
v_accvgpr_write_b32 a210,v114
v_accvgpr_write_b32 a211,v115
v_accvgpr_write_b32 a216,v116
v_accvgpr_write_b32 a217,v117
v_accvgpr_write_b32 a218,v118
v_accvgpr_write_b32 a219,v119
v_xor_b32 v5,24576,v3
v_xor_b32 v6,24576,v4
ds_read2_b32 v[96:97],v5 offset1:32
ds_read2_b32 v[100:101],v6 offset1:32
ds_read2_b32 v[98:99],v5 offset0:64 offset1:96
ds_read2_b32 v[102:103],v6 offset0:64 offset1:96
s_waitcnt lgkmcnt(4)
v_perm_b32 v112,v108,v104,s61
v_perm_b32 v113,v109,v105,s61
v_perm_b32 v114,v110,v106,s61
v_perm_b32 v115,v111,v107,s61
v_perm_b32 v116,v108,v104,s62
v_perm_b32 v117,v109,v105,s62
v_perm_b32 v118,v110,v106,s62
v_perm_b32 v119,v111,v107,s62
v_accvgpr_write_b32 a212,v112
v_accvgpr_write_b32 a213,v113
v_accvgpr_write_b32 a214,v114
v_accvgpr_write_b32 a215,v115
v_accvgpr_write_b32 a220,v116
v_accvgpr_write_b32 a221,v117
v_accvgpr_write_b32 a222,v118
v_accvgpr_write_b32 a223,v119
v_xor_b32 v5,26624,v3
v_xor_b32 v6,26624,v4
ds_read2_b32 v[104:105],v5 offset1:32
ds_read2_b32 v[108:109],v6 offset1:32
ds_read2_b32 v[106:107],v5 offset0:64 offset1:96
ds_read2_b32 v[110:111],v6 offset0:64 offset1:96
s_waitcnt lgkmcnt(4)
v_perm_b32 v112,v100,v96,s61
v_perm_b32 v113,v101,v97,s61
v_perm_b32 v114,v102,v98,s61
v_perm_b32 v115,v103,v99,s61
v_perm_b32 v116,v100,v96,s62
v_perm_b32 v117,v101,v97,s62
v_perm_b32 v118,v102,v98,s62
v_perm_b32 v119,v103,v99,s62
v_accvgpr_write_b32 a224,v112
v_accvgpr_write_b32 a225,v113
v_accvgpr_write_b32 a226,v114
v_accvgpr_write_b32 a227,v115
v_accvgpr_write_b32 a232,v116
v_accvgpr_write_b32 a233,v117
v_accvgpr_write_b32 a234,v118
v_accvgpr_write_b32 a235,v119
v_xor_b32 v5,28672,v3
v_xor_b32 v6,28672,v4
ds_read2_b32 v[96:97],v5 offset1:32
ds_read2_b32 v[100:101],v6 offset1:32
ds_read2_b32 v[98:99],v5 offset0:64 offset1:96
ds_read2_b32 v[102:103],v6 offset0:64 offset1:96
s_waitcnt lgkmcnt(4)
v_perm_b32 v112,v108,v104,s61
v_perm_b32 v113,v109,v105,s61
v_perm_b32 v114,v110,v106,s61
v_perm_b32 v115,v111,v107,s61
v_perm_b32 v116,v108,v104,s62
v_perm_b32 v117,v109,v105,s62
v_perm_b32 v118,v110,v106,s62
v_perm_b32 v119,v111,v107,s62
v_accvgpr_write_b32 a228,v112
v_accvgpr_write_b32 a229,v113
v_accvgpr_write_b32 a230,v114
v_accvgpr_write_b32 a231,v115
v_accvgpr_write_b32 a236,v116
v_accvgpr_write_b32 a237,v117
v_accvgpr_write_b32 a238,v118
v_accvgpr_write_b32 a239,v119
v_xor_b32 v5,30720,v3
v_xor_b32 v6,30720,v4
ds_read2_b32 v[104:105],v5 offset1:32
ds_read2_b32 v[108:109],v6 offset1:32
ds_read2_b32 v[106:107],v5 offset0:64 offset1:96
ds_read2_b32 v[110:111],v6 offset0:64 offset1:96
s_waitcnt lgkmcnt(4)
v_perm_b32 v112,v100,v96,s61
v_perm_b32 v113,v101,v97,s61
v_perm_b32 v114,v102,v98,s61
v_perm_b32 v115,v103,v99,s61
v_perm_b32 v116,v100,v96,s62
v_perm_b32 v117,v101,v97,s62
v_perm_b32 v118,v102,v98,s62
v_perm_b32 v119,v103,v99,s62
v_accvgpr_write_b32 a240,v112
v_accvgpr_write_b32 a241,v113
v_accvgpr_write_b32 a242,v114
v_accvgpr_write_b32 a243,v115
v_accvgpr_write_b32 a248,v116
v_accvgpr_write_b32 a249,v117
v_accvgpr_write_b32 a250,v118
v_accvgpr_write_b32 a251,v119
s_waitcnt lgkmcnt(0)
s_xor_b32 m0,s59,16384
s_xor_b32 s60,s58,2097152
buffer_load_dwordx4 v2,s[4:7],s60 offen lds
s_add_u32 m0,m0,1024
s_add_u32 s60,s60,131072
buffer_load_dwordx4 v2,s[4:7],s60 offen lds
s_xor_b32 m0,s59,18432
s_xor_b32 s60,s58,2359296
buffer_load_dwordx4 v2,s[4:7],s60 offen lds
s_add_u32 m0,m0,1024
s_add_u32 s60,s60,131072
buffer_load_dwordx4 v2,s[4:7],s60 offen lds
s_xor_b32 m0,s59,20480
s_xor_b32 s60,s58,2621440
buffer_load_dwordx4 v2,s[4:7],s60 offen lds
s_add_u32 m0,m0,1024
s_add_u32 s60,s60,131072
buffer_load_dwordx4 v2,s[4:7],s60 offen lds
s_xor_b32 m0,s59,22528
s_xor_b32 s60,s58,2883584
buffer_load_dwordx4 v2,s[4:7],s60 offen lds
s_add_u32 m0,m0,1024
s_add_u32 s60,s60,131072
buffer_load_dwordx4 v2,s[4:7],s60 offen lds
s_xor_b32 m0,s59,24576
s_xor_b32 s60,s58,3145728
buffer_load_dwordx4 v2,s[4:7],s60 offen lds
s_add_u32 m0,m0,1024
s_add_u32 s60,s60,131072
buffer_load_dwordx4 v2,s[4:7],s60 offen lds
s_xor_b32 m0,s59,26624
s_xor_b32 s60,s58,3407872
buffer_load_dwordx4 v2,s[4:7],s60 offen lds
s_add_u32 m0,m0,1024
s_add_u32 s60,s60,131072
buffer_load_dwordx4 v2,s[4:7],s60 offen lds
s_xor_b32 m0,s59,28672
s_xor_b32 s60,s58,3670016
buffer_load_dwordx4 v2,s[4:7],s60 offen lds
s_add_u32 m0,m0,1024
s_add_u32 s60,s60,131072
buffer_load_dwordx4 v2,s[4:7],s60 offen lds
s_xor_b32 m0,s59,30720
s_xor_b32 s60,s58,3932160
buffer_load_dwordx4 v2,s[4:7],s60 offen lds
s_add_u32 m0,m0,1024
s_add_u32 s60,s60,131072
buffer_load_dwordx4 v2,s[4:7],s60 offen lds
v_perm_b32 v112,v108,v104,s61
v_perm_b32 v113,v109,v105,s61
v_perm_b32 v114,v110,v106,s61
v_perm_b32 v115,v111,v107,s61
v_perm_b32 v116,v108,v104,s62
v_perm_b32 v117,v109,v105,s62
v_perm_b32 v118,v110,v106,s62
v_perm_b32 v119,v111,v107,s62
v_accvgpr_write_b32 a244,v112
v_accvgpr_write_b32 a245,v113
v_accvgpr_write_b32 a246,v114
v_accvgpr_write_b32 a247,v115
v_accvgpr_write_b32 a252,v116
v_accvgpr_write_b32 a253,v117
v_accvgpr_write_b32 a254,v118
v_accvgpr_write_b32 a255,v119
s_waitcnt vmcnt(16)
v_xor_b32 v5,0,v3
v_xor_b32 v6,0,v4
ds_read2_b32 v[96:97],v5 offset1:32
ds_read2_b32 v[100:101],v6 offset1:32
ds_read2_b32 v[98:99],v5 offset0:64 offset1:96
ds_read2_b32 v[102:103],v6 offset0:64 offset1:96
v_xor_b32 v5,2048,v3
v_xor_b32 v6,2048,v4
ds_read2_b32 v[104:105],v5 offset1:32
ds_read2_b32 v[108:109],v6 offset1:32
ds_read2_b32 v[106:107],v5 offset0:64 offset1:96
ds_read2_b32 v[110:111],v6 offset0:64 offset1:96
s_waitcnt lgkmcnt(4)
v_perm_b32 v128,v100,v96,s61
v_perm_b32 v129,v101,v97,s61
v_perm_b32 v130,v102,v98,s61
v_perm_b32 v131,v103,v99,s61
v_perm_b32 v136,v100,v96,s62
v_perm_b32 v137,v101,v97,s62
v_perm_b32 v138,v102,v98,s62
v_perm_b32 v139,v103,v99,s62
v_xor_b32 v5,4096,v3
v_xor_b32 v6,4096,v4
ds_read2_b32 v[96:97],v5 offset1:32
ds_read2_b32 v[100:101],v6 offset1:32
ds_read2_b32 v[98:99],v5 offset0:64 offset1:96
ds_read2_b32 v[102:103],v6 offset0:64 offset1:96
s_waitcnt lgkmcnt(4)
v_perm_b32 v132,v108,v104,s61
v_perm_b32 v133,v109,v105,s61
v_perm_b32 v134,v110,v106,s61
v_perm_b32 v135,v111,v107,s61
v_perm_b32 v140,v108,v104,s62
v_perm_b32 v141,v109,v105,s62
v_perm_b32 v142,v110,v106,s62
v_perm_b32 v143,v111,v107,s62
v_xor_b32 v5,6144,v3
v_xor_b32 v6,6144,v4
ds_read2_b32 v[104:105],v5 offset1:32
ds_read2_b32 v[108:109],v6 offset1:32
ds_read2_b32 v[106:107],v5 offset0:64 offset1:96
ds_read2_b32 v[110:111],v6 offset0:64 offset1:96
s_waitcnt lgkmcnt(4)
v_perm_b32 v144,v100,v96,s61
v_perm_b32 v145,v101,v97,s61
v_perm_b32 v146,v102,v98,s61
v_perm_b32 v147,v103,v99,s61
v_perm_b32 v152,v100,v96,s62
v_perm_b32 v153,v101,v97,s62
v_perm_b32 v154,v102,v98,s62
v_perm_b32 v155,v103,v99,s62
v_xor_b32 v5,8192,v3
v_xor_b32 v6,8192,v4
ds_read2_b32 v[96:97],v5 offset1:32
ds_read2_b32 v[100:101],v6 offset1:32
ds_read2_b32 v[98:99],v5 offset0:64 offset1:96
ds_read2_b32 v[102:103],v6 offset0:64 offset1:96
s_waitcnt lgkmcnt(4)
v_perm_b32 v148,v108,v104,s61
v_perm_b32 v149,v109,v105,s61
v_perm_b32 v150,v110,v106,s61
v_perm_b32 v151,v111,v107,s61
v_perm_b32 v156,v108,v104,s62
v_perm_b32 v157,v109,v105,s62
v_perm_b32 v158,v110,v106,s62
v_perm_b32 v159,v111,v107,s62
v_xor_b32 v5,10240,v3
v_xor_b32 v6,10240,v4
ds_read2_b32 v[104:105],v5 offset1:32
ds_read2_b32 v[108:109],v6 offset1:32
ds_read2_b32 v[106:107],v5 offset0:64 offset1:96
ds_read2_b32 v[110:111],v6 offset0:64 offset1:96
s_waitcnt lgkmcnt(4)
v_perm_b32 v160,v100,v96,s61
v_perm_b32 v161,v101,v97,s61
v_perm_b32 v162,v102,v98,s61
v_perm_b32 v163,v103,v99,s61
v_perm_b32 v168,v100,v96,s62
v_perm_b32 v169,v101,v97,s62
v_perm_b32 v170,v102,v98,s62
v_perm_b32 v171,v103,v99,s62
v_xor_b32 v5,12288,v3
v_xor_b32 v6,12288,v4
ds_read2_b32 v[96:97],v5 offset1:32
ds_read2_b32 v[100:101],v6 offset1:32
ds_read2_b32 v[98:99],v5 offset0:64 offset1:96
ds_read2_b32 v[102:103],v6 offset0:64 offset1:96
s_waitcnt lgkmcnt(4)
v_perm_b32 v164,v108,v104,s61
v_perm_b32 v165,v109,v105,s61
v_perm_b32 v166,v110,v106,s61
v_perm_b32 v167,v111,v107,s61
v_perm_b32 v172,v108,v104,s62
v_perm_b32 v173,v109,v105,s62
v_perm_b32 v174,v110,v106,s62
v_perm_b32 v175,v111,v107,s62
v_xor_b32 v5,14336,v3
v_xor_b32 v6,14336,v4
ds_read2_b32 v[104:105],v5 offset1:32
ds_read2_b32 v[108:109],v6 offset1:32
ds_read2_b32 v[106:107],v5 offset0:64 offset1:96
ds_read2_b32 v[110:111],v6 offset0:64 offset1:96
s_waitcnt lgkmcnt(4)
v_perm_b32 v176,v100,v96,s61
v_perm_b32 v177,v101,v97,s61
v_perm_b32 v178,v102,v98,s61
v_perm_b32 v179,v103,v99,s61
v_perm_b32 v184,v100,v96,s62
v_perm_b32 v185,v101,v97,s62
v_perm_b32 v186,v102,v98,s62
v_perm_b32 v187,v103,v99,s62
s_waitcnt lgkmcnt(0)
s_mov_b32 s4,s20
s_mov_b32 s5,s21
s_mov_b32 s6,4194304
s_mov_b32 s7,0x20000
s_xor_b32 m0,s59,0
s_xor_b32 s60,s58,0
buffer_load_dwordx4 v2,s[4:7],s60 offen lds
s_add_u32 m0,m0,1024
s_add_u32 s60,s60,131072
buffer_load_dwordx4 v2,s[4:7],s60 offen lds
s_xor_b32 m0,s59,2048
s_xor_b32 s60,s58,262144
buffer_load_dwordx4 v2,s[4:7],s60 offen lds
s_add_u32 m0,m0,1024
s_add_u32 s60,s60,131072
buffer_load_dwordx4 v2,s[4:7],s60 offen lds
s_xor_b32 m0,s59,4096
s_xor_b32 s60,s58,524288
buffer_load_dwordx4 v2,s[4:7],s60 offen lds
s_add_u32 m0,m0,1024
s_add_u32 s60,s60,131072
buffer_load_dwordx4 v2,s[4:7],s60 offen lds
s_xor_b32 m0,s59,6144
s_xor_b32 s60,s58,786432
buffer_load_dwordx4 v2,s[4:7],s60 offen lds
s_add_u32 m0,m0,1024
s_add_u32 s60,s60,131072
buffer_load_dwordx4 v2,s[4:7],s60 offen lds
s_xor_b32 m0,s59,8192
s_xor_b32 s60,s58,1048576
buffer_load_dwordx4 v2,s[4:7],s60 offen lds
s_add_u32 m0,m0,1024
s_add_u32 s60,s60,131072
buffer_load_dwordx4 v2,s[4:7],s60 offen lds
s_xor_b32 m0,s59,10240
s_xor_b32 s60,s58,1310720
buffer_load_dwordx4 v2,s[4:7],s60 offen lds
s_add_u32 m0,m0,1024
s_add_u32 s60,s60,131072
buffer_load_dwordx4 v2,s[4:7],s60 offen lds
s_xor_b32 m0,s59,12288
s_xor_b32 s60,s58,1572864
buffer_load_dwordx4 v2,s[4:7],s60 offen lds
s_add_u32 m0,m0,1024
s_add_u32 s60,s60,131072
buffer_load_dwordx4 v2,s[4:7],s60 offen lds
s_xor_b32 m0,s59,14336
s_xor_b32 s60,s58,1835008
buffer_load_dwordx4 v2,s[4:7],s60 offen lds
s_add_u32 m0,m0,1024
s_add_u32 s60,s60,131072
buffer_load_dwordx4 v2,s[4:7],s60 offen lds
v_perm_b32 v180,v108,v104,s61
v_perm_b32 v181,v109,v105,s61
v_perm_b32 v182,v110,v106,s61
v_perm_b32 v183,v111,v107,s61
v_perm_b32 v188,v108,v104,s62
v_perm_b32 v189,v109,v105,s62
v_perm_b32 v190,v110,v106,s62
v_perm_b32 v191,v111,v107,s62
s_waitcnt vmcnt(16)
v_xor_b32 v5,16384,v3
v_xor_b32 v6,16384,v4
ds_read2_b32 v[96:97],v5 offset1:32
ds_read2_b32 v[100:101],v6 offset1:32
ds_read2_b32 v[98:99],v5 offset0:64 offset1:96
ds_read2_b32 v[102:103],v6 offset0:64 offset1:96
v_xor_b32 v5,18432,v3
v_xor_b32 v6,18432,v4
ds_read2_b32 v[104:105],v5 offset1:32
ds_read2_b32 v[108:109],v6 offset1:32
ds_read2_b32 v[106:107],v5 offset0:64 offset1:96
ds_read2_b32 v[110:111],v6 offset0:64 offset1:96
s_waitcnt lgkmcnt(4)
v_perm_b32 v192,v100,v96,s61
v_perm_b32 v193,v101,v97,s61
v_perm_b32 v194,v102,v98,s61
v_perm_b32 v195,v103,v99,s61
v_perm_b32 v200,v100,v96,s62
v_perm_b32 v201,v101,v97,s62
v_perm_b32 v202,v102,v98,s62
v_perm_b32 v203,v103,v99,s62
v_xor_b32 v5,20480,v3
v_xor_b32 v6,20480,v4
ds_read2_b32 v[96:97],v5 offset1:32
ds_read2_b32 v[100:101],v6 offset1:32
ds_read2_b32 v[98:99],v5 offset0:64 offset1:96
ds_read2_b32 v[102:103],v6 offset0:64 offset1:96
s_waitcnt lgkmcnt(4)
v_perm_b32 v196,v108,v104,s61
v_perm_b32 v197,v109,v105,s61
v_perm_b32 v198,v110,v106,s61
v_perm_b32 v199,v111,v107,s61
v_perm_b32 v204,v108,v104,s62
v_perm_b32 v205,v109,v105,s62
v_perm_b32 v206,v110,v106,s62
v_perm_b32 v207,v111,v107,s62
v_xor_b32 v5,22528,v3
v_xor_b32 v6,22528,v4
ds_read2_b32 v[104:105],v5 offset1:32
ds_read2_b32 v[108:109],v6 offset1:32
ds_read2_b32 v[106:107],v5 offset0:64 offset1:96
ds_read2_b32 v[110:111],v6 offset0:64 offset1:96
s_waitcnt lgkmcnt(4)
v_perm_b32 v208,v100,v96,s61
v_perm_b32 v209,v101,v97,s61
v_perm_b32 v210,v102,v98,s61
v_perm_b32 v211,v103,v99,s61
v_perm_b32 v216,v100,v96,s62
v_perm_b32 v217,v101,v97,s62
v_perm_b32 v218,v102,v98,s62
v_perm_b32 v219,v103,v99,s62
v_xor_b32 v5,24576,v3
v_xor_b32 v6,24576,v4
ds_read2_b32 v[96:97],v5 offset1:32
ds_read2_b32 v[100:101],v6 offset1:32
ds_read2_b32 v[98:99],v5 offset0:64 offset1:96
ds_read2_b32 v[102:103],v6 offset0:64 offset1:96
s_waitcnt lgkmcnt(4)
v_perm_b32 v212,v108,v104,s61
v_perm_b32 v213,v109,v105,s61
v_perm_b32 v214,v110,v106,s61
v_perm_b32 v215,v111,v107,s61
v_perm_b32 v220,v108,v104,s62
v_perm_b32 v221,v109,v105,s62
v_perm_b32 v222,v110,v106,s62
v_perm_b32 v223,v111,v107,s62
v_xor_b32 v5,26624,v3
v_xor_b32 v6,26624,v4
ds_read2_b32 v[104:105],v5 offset1:32
ds_read2_b32 v[108:109],v6 offset1:32
ds_read2_b32 v[106:107],v5 offset0:64 offset1:96
ds_read2_b32 v[110:111],v6 offset0:64 offset1:96
s_waitcnt lgkmcnt(4)
v_perm_b32 v224,v100,v96,s61
v_perm_b32 v225,v101,v97,s61
v_perm_b32 v226,v102,v98,s61
v_perm_b32 v227,v103,v99,s61
v_perm_b32 v232,v100,v96,s62
v_perm_b32 v233,v101,v97,s62
v_perm_b32 v234,v102,v98,s62
v_perm_b32 v235,v103,v99,s62
v_xor_b32 v5,28672,v3
v_xor_b32 v6,28672,v4
ds_read2_b32 v[96:97],v5 offset1:32
ds_read2_b32 v[100:101],v6 offset1:32
ds_read2_b32 v[98:99],v5 offset0:64 offset1:96
ds_read2_b32 v[102:103],v6 offset0:64 offset1:96
s_waitcnt lgkmcnt(4)
v_perm_b32 v228,v108,v104,s61
v_perm_b32 v229,v109,v105,s61
v_perm_b32 v230,v110,v106,s61
v_perm_b32 v231,v111,v107,s61
v_perm_b32 v236,v108,v104,s62
v_perm_b32 v237,v109,v105,s62
v_perm_b32 v238,v110,v106,s62
v_perm_b32 v239,v111,v107,s62
v_xor_b32 v5,30720,v3
v_xor_b32 v6,30720,v4
ds_read2_b32 v[104:105],v5 offset1:32
ds_read2_b32 v[108:109],v6 offset1:32
ds_read2_b32 v[106:107],v5 offset0:64 offset1:96
ds_read2_b32 v[110:111],v6 offset0:64 offset1:96
s_waitcnt lgkmcnt(4)
v_perm_b32 v240,v100,v96,s61
v_perm_b32 v241,v101,v97,s61
v_perm_b32 v242,v102,v98,s61
v_perm_b32 v243,v103,v99,s61
v_perm_b32 v248,v100,v96,s62
v_perm_b32 v249,v101,v97,s62
v_perm_b32 v250,v102,v98,s62
v_perm_b32 v251,v103,v99,s62
s_waitcnt lgkmcnt(0)
s_xor_b32 m0,s59,16384
s_xor_b32 s60,s58,2097152
buffer_load_dwordx4 v2,s[4:7],s60 offen lds
s_add_u32 m0,m0,1024
s_add_u32 s60,s60,131072
buffer_load_dwordx4 v2,s[4:7],s60 offen lds
s_xor_b32 m0,s59,18432
s_xor_b32 s60,s58,2359296
buffer_load_dwordx4 v2,s[4:7],s60 offen lds
s_add_u32 m0,m0,1024
s_add_u32 s60,s60,131072
buffer_load_dwordx4 v2,s[4:7],s60 offen lds
s_xor_b32 m0,s59,20480
s_xor_b32 s60,s58,2621440
buffer_load_dwordx4 v2,s[4:7],s60 offen lds
s_add_u32 m0,m0,1024
s_add_u32 s60,s60,131072
buffer_load_dwordx4 v2,s[4:7],s60 offen lds
s_xor_b32 m0,s59,22528
s_xor_b32 s60,s58,2883584
buffer_load_dwordx4 v2,s[4:7],s60 offen lds
s_add_u32 m0,m0,1024
s_add_u32 s60,s60,131072
buffer_load_dwordx4 v2,s[4:7],s60 offen lds
s_xor_b32 m0,s59,24576
s_xor_b32 s60,s58,3145728
buffer_load_dwordx4 v2,s[4:7],s60 offen lds
s_add_u32 m0,m0,1024
s_add_u32 s60,s60,131072
buffer_load_dwordx4 v2,s[4:7],s60 offen lds
s_xor_b32 m0,s59,26624
s_xor_b32 s60,s58,3407872
buffer_load_dwordx4 v2,s[4:7],s60 offen lds
s_add_u32 m0,m0,1024
s_add_u32 s60,s60,131072
buffer_load_dwordx4 v2,s[4:7],s60 offen lds
s_xor_b32 m0,s59,28672
s_xor_b32 s60,s58,3670016
buffer_load_dwordx4 v2,s[4:7],s60 offen lds
s_add_u32 m0,m0,1024
s_add_u32 s60,s60,131072
buffer_load_dwordx4 v2,s[4:7],s60 offen lds
s_xor_b32 m0,s59,30720
s_xor_b32 s60,s58,3932160
buffer_load_dwordx4 v2,s[4:7],s60 offen lds
s_add_u32 m0,m0,1024
s_add_u32 s60,s60,131072
buffer_load_dwordx4 v2,s[4:7],s60 offen lds
v_perm_b32 v244,v108,v104,s61
v_perm_b32 v245,v109,v105,s61
v_perm_b32 v246,v110,v106,s61
v_perm_b32 v247,v111,v107,s61
v_perm_b32 v252,v108,v104,s62
v_perm_b32 v253,v109,v105,s62
v_perm_b32 v254,v110,v106,s62
v_perm_b32 v255,v111,v107,s62
s_waitcnt vmcnt(16)
v_xor_b32 v5,0,v3
v_xor_b32 v6,0,v4
ds_read2_b32 v[96:97],v5 offset1:32
ds_read2_b32 v[100:101],v6 offset1:32
ds_read2_b32 v[98:99],v5 offset0:64 offset1:96
ds_read2_b32 v[102:103],v6 offset0:64 offset1:96
v_xor_b32 v5,2048,v3
v_xor_b32 v6,2048,v4
ds_read2_b32 v[104:105],v5 offset1:32
ds_read2_b32 v[108:109],v6 offset1:32
ds_read2_b32 v[106:107],v5 offset0:64 offset1:96
ds_read2_b32 v[110:111],v6 offset0:64 offset1:96
s_waitcnt lgkmcnt(4)
v_perm_b32 v112,v100,v96,s61
v_perm_b32 v113,v101,v97,s61
v_perm_b32 v114,v102,v98,s61
v_perm_b32 v115,v103,v99,s61
v_perm_b32 v116,v100,v96,s62
v_perm_b32 v117,v101,v97,s62
v_perm_b32 v118,v102,v98,s62
v_perm_b32 v119,v103,v99,s62
v_accvgpr_write_b32 a0,v112
v_accvgpr_write_b32 a1,v113
v_accvgpr_write_b32 a2,v114
v_accvgpr_write_b32 a3,v115
v_accvgpr_write_b32 a8,v116
v_accvgpr_write_b32 a9,v117
v_accvgpr_write_b32 a10,v118
v_accvgpr_write_b32 a11,v119
v_xor_b32 v5,4096,v3
v_xor_b32 v6,4096,v4
ds_read2_b32 v[96:97],v5 offset1:32
ds_read2_b32 v[100:101],v6 offset1:32
ds_read2_b32 v[98:99],v5 offset0:64 offset1:96
ds_read2_b32 v[102:103],v6 offset0:64 offset1:96
s_waitcnt lgkmcnt(4)
v_perm_b32 v112,v108,v104,s61
v_perm_b32 v113,v109,v105,s61
v_perm_b32 v114,v110,v106,s61
v_perm_b32 v115,v111,v107,s61
v_perm_b32 v116,v108,v104,s62
v_perm_b32 v117,v109,v105,s62
v_perm_b32 v118,v110,v106,s62
v_perm_b32 v119,v111,v107,s62
v_accvgpr_write_b32 a4,v112
v_accvgpr_write_b32 a5,v113
v_accvgpr_write_b32 a6,v114
v_accvgpr_write_b32 a7,v115
v_accvgpr_write_b32 a12,v116
v_accvgpr_write_b32 a13,v117
v_accvgpr_write_b32 a14,v118
v_accvgpr_write_b32 a15,v119
v_xor_b32 v5,6144,v3
v_xor_b32 v6,6144,v4
ds_read2_b32 v[104:105],v5 offset1:32
ds_read2_b32 v[108:109],v6 offset1:32
ds_read2_b32 v[106:107],v5 offset0:64 offset1:96
ds_read2_b32 v[110:111],v6 offset0:64 offset1:96
s_waitcnt lgkmcnt(4)
v_perm_b32 v112,v100,v96,s61
v_perm_b32 v113,v101,v97,s61
v_perm_b32 v114,v102,v98,s61
v_perm_b32 v115,v103,v99,s61
v_perm_b32 v116,v100,v96,s62
v_perm_b32 v117,v101,v97,s62
v_perm_b32 v118,v102,v98,s62
v_perm_b32 v119,v103,v99,s62
v_accvgpr_write_b32 a16,v112
v_accvgpr_write_b32 a17,v113
v_accvgpr_write_b32 a18,v114
v_accvgpr_write_b32 a19,v115
v_accvgpr_write_b32 a24,v116
v_accvgpr_write_b32 a25,v117
v_accvgpr_write_b32 a26,v118
v_accvgpr_write_b32 a27,v119
v_xor_b32 v5,8192,v3
v_xor_b32 v6,8192,v4
ds_read2_b32 v[96:97],v5 offset1:32
ds_read2_b32 v[100:101],v6 offset1:32
ds_read2_b32 v[98:99],v5 offset0:64 offset1:96
ds_read2_b32 v[102:103],v6 offset0:64 offset1:96
s_waitcnt lgkmcnt(4)
v_perm_b32 v112,v108,v104,s61
v_perm_b32 v113,v109,v105,s61
v_perm_b32 v114,v110,v106,s61
v_perm_b32 v115,v111,v107,s61
v_perm_b32 v116,v108,v104,s62
v_perm_b32 v117,v109,v105,s62
v_perm_b32 v118,v110,v106,s62
v_perm_b32 v119,v111,v107,s62
v_accvgpr_write_b32 a20,v112
v_accvgpr_write_b32 a21,v113
v_accvgpr_write_b32 a22,v114
v_accvgpr_write_b32 a23,v115
v_accvgpr_write_b32 a28,v116
v_accvgpr_write_b32 a29,v117
v_accvgpr_write_b32 a30,v118
v_accvgpr_write_b32 a31,v119
v_xor_b32 v5,10240,v3
v_xor_b32 v6,10240,v4
ds_read2_b32 v[104:105],v5 offset1:32
ds_read2_b32 v[108:109],v6 offset1:32
ds_read2_b32 v[106:107],v5 offset0:64 offset1:96
ds_read2_b32 v[110:111],v6 offset0:64 offset1:96
s_waitcnt lgkmcnt(4)
v_perm_b32 v112,v100,v96,s61
v_perm_b32 v113,v101,v97,s61
v_perm_b32 v114,v102,v98,s61
v_perm_b32 v115,v103,v99,s61
v_perm_b32 v116,v100,v96,s62
v_perm_b32 v117,v101,v97,s62
v_perm_b32 v118,v102,v98,s62
v_perm_b32 v119,v103,v99,s62
v_accvgpr_write_b32 a32,v112
v_accvgpr_write_b32 a33,v113
v_accvgpr_write_b32 a34,v114
v_accvgpr_write_b32 a35,v115
v_accvgpr_write_b32 a40,v116
v_accvgpr_write_b32 a41,v117
v_accvgpr_write_b32 a42,v118
v_accvgpr_write_b32 a43,v119
v_xor_b32 v5,12288,v3
v_xor_b32 v6,12288,v4
ds_read2_b32 v[96:97],v5 offset1:32
ds_read2_b32 v[100:101],v6 offset1:32
ds_read2_b32 v[98:99],v5 offset0:64 offset1:96
ds_read2_b32 v[102:103],v6 offset0:64 offset1:96
s_waitcnt lgkmcnt(4)
v_perm_b32 v112,v108,v104,s61
v_perm_b32 v113,v109,v105,s61
v_perm_b32 v114,v110,v106,s61
v_perm_b32 v115,v111,v107,s61
v_perm_b32 v116,v108,v104,s62
v_perm_b32 v117,v109,v105,s62
v_perm_b32 v118,v110,v106,s62
v_perm_b32 v119,v111,v107,s62
v_accvgpr_write_b32 a36,v112
v_accvgpr_write_b32 a37,v113
v_accvgpr_write_b32 a38,v114
v_accvgpr_write_b32 a39,v115
v_accvgpr_write_b32 a44,v116
v_accvgpr_write_b32 a45,v117
v_accvgpr_write_b32 a46,v118
v_accvgpr_write_b32 a47,v119
v_xor_b32 v5,14336,v3
v_xor_b32 v6,14336,v4
ds_read2_b32 v[104:105],v5 offset1:32
ds_read2_b32 v[108:109],v6 offset1:32
ds_read2_b32 v[106:107],v5 offset0:64 offset1:96
ds_read2_b32 v[110:111],v6 offset0:64 offset1:96
s_waitcnt lgkmcnt(4)
v_perm_b32 v112,v100,v96,s61
v_perm_b32 v113,v101,v97,s61
v_perm_b32 v114,v102,v98,s61
v_perm_b32 v115,v103,v99,s61
v_perm_b32 v116,v100,v96,s62
v_perm_b32 v117,v101,v97,s62
v_perm_b32 v118,v102,v98,s62
v_perm_b32 v119,v103,v99,s62
v_accvgpr_write_b32 a48,v112
v_accvgpr_write_b32 a49,v113
v_accvgpr_write_b32 a50,v114
v_accvgpr_write_b32 a51,v115
v_accvgpr_write_b32 a56,v116
v_accvgpr_write_b32 a57,v117
v_accvgpr_write_b32 a58,v118
v_accvgpr_write_b32 a59,v119
s_waitcnt lgkmcnt(0)
v_perm_b32 v112,v108,v104,s61
v_perm_b32 v113,v109,v105,s61
v_perm_b32 v114,v110,v106,s61
v_perm_b32 v115,v111,v107,s61
v_perm_b32 v116,v108,v104,s62
v_perm_b32 v117,v109,v105,s62
v_perm_b32 v118,v110,v106,s62
v_perm_b32 v119,v111,v107,s62
v_accvgpr_write_b32 a52,v112
v_accvgpr_write_b32 a53,v113
v_accvgpr_write_b32 a54,v114
v_accvgpr_write_b32 a55,v115
v_accvgpr_write_b32 a60,v116
v_accvgpr_write_b32 a61,v117
v_accvgpr_write_b32 a62,v118
v_accvgpr_write_b32 a63,v119
s_mov_b32 s4,s26
s_mov_b32 s5,s27
s_mov_b32 s6,4194304
s_mov_b32 s7,0x20000
v_and_b32 v92,3,v1
v_lshlrev_b32 v93,4,v92
v_bfe_u32 v94,v1,2,2
v_lshl_add_u32 v92,v94,12,v93
v_lshl_add_u32 v93,v94,8,v93
v_and_b32 v94,1,v94
v_lshl_add_u32 v93,v94,6,v93
v_lshrrev_b32 v94,4,v1
v_lshl_add_u32 v92,v94,8,v92
v_lshl_add_u32 v93,v94,13,v93
s_lshl_b32 s56,s46,15
v_add_u32 v93,s56,v93
v_xor_b32 v94,64,v93
s_lshl_b32 s56,s47,17
s_lshl_b32 s57,s46,6
s_add_u32 s56,s56,s57
v_add_u32 v92,s56,v92
s_cmp_ge_u32 s48,3
s_cbranch_scc1 L_lw_15
s_mov_b32 s56,0
buffer_load_dwordx4 v[24:27],v92,s[4:7],s56 offen offset:0
buffer_load_dwordx4 v[28:31],v92,s[4:7],s56 offen offset:1024
buffer_load_dwordx4 v[32:35],v92,s[4:7],s56 offen offset:2048
buffer_load_dwordx4 v[36:39],v92,s[4:7],s56 offen offset:3072
s_mov_b32 s56,16384
buffer_load_dwordx4 v[40:43],v92,s[4:7],s56 offen offset:0
buffer_load_dwordx4 v[44:47],v92,s[4:7],s56 offen offset:1024
buffer_load_dwordx4 v[48:51],v92,s[4:7],s56 offen offset:2048
buffer_load_dwordx4 v[52:55],v92,s[4:7],s56 offen offset:3072
s_mov_b32 s56,32768
buffer_load_dwordx4 v[56:59],v92,s[4:7],s56 offen offset:0
buffer_load_dwordx4 v[60:63],v92,s[4:7],s56 offen offset:1024
buffer_load_dwordx4 v[64:67],v92,s[4:7],s56 offen offset:2048
buffer_load_dwordx4 v[68:71],v92,s[4:7],s56 offen offset:3072
s_mov_b32 s56,49152
buffer_load_dwordx4 v[72:75],v92,s[4:7],s56 offen offset:0
buffer_load_dwordx4 v[76:79],v92,s[4:7],s56 offen offset:1024
buffer_load_dwordx4 v[80:83],v92,s[4:7],s56 offen offset:2048
buffer_load_dwordx4 v[84:87],v92,s[4:7],s56 offen offset:3072
s_waitcnt vmcnt(16)
s_branch L_lj_16
L_lw_15:
s_waitcnt vmcnt(0)
L_lj_16:
v_xor_b32 v5,16384,v3
v_xor_b32 v6,16384,v4
ds_read2_b32 v[96:97],v5 offset1:32
ds_read2_b32 v[100:101],v6 offset1:32
ds_read2_b32 v[98:99],v5 offset0:64 offset1:96
ds_read2_b32 v[102:103],v6 offset0:64 offset1:96
v_xor_b32 v5,18432,v3
v_xor_b32 v6,18432,v4
ds_read2_b32 v[104:105],v5 offset1:32
ds_read2_b32 v[108:109],v6 offset1:32
ds_read2_b32 v[106:107],v5 offset0:64 offset1:96
ds_read2_b32 v[110:111],v6 offset0:64 offset1:96
s_waitcnt lgkmcnt(4)
v_perm_b32 v112,v100,v96,s61
v_perm_b32 v113,v101,v97,s61
v_perm_b32 v114,v102,v98,s61
v_perm_b32 v115,v103,v99,s61
v_perm_b32 v116,v100,v96,s62
v_perm_b32 v117,v101,v97,s62
v_perm_b32 v118,v102,v98,s62
v_perm_b32 v119,v103,v99,s62
v_accvgpr_write_b32 a64,v112
v_accvgpr_write_b32 a65,v113
v_accvgpr_write_b32 a66,v114
v_accvgpr_write_b32 a67,v115
v_accvgpr_write_b32 a72,v116
v_accvgpr_write_b32 a73,v117
v_accvgpr_write_b32 a74,v118
v_accvgpr_write_b32 a75,v119
v_xor_b32 v5,20480,v3
v_xor_b32 v6,20480,v4
ds_read2_b32 v[96:97],v5 offset1:32
ds_read2_b32 v[100:101],v6 offset1:32
ds_read2_b32 v[98:99],v5 offset0:64 offset1:96
ds_read2_b32 v[102:103],v6 offset0:64 offset1:96
s_waitcnt lgkmcnt(4)
v_perm_b32 v112,v108,v104,s61
v_perm_b32 v113,v109,v105,s61
v_perm_b32 v114,v110,v106,s61
v_perm_b32 v115,v111,v107,s61
v_perm_b32 v116,v108,v104,s62
v_perm_b32 v117,v109,v105,s62
v_perm_b32 v118,v110,v106,s62
v_perm_b32 v119,v111,v107,s62
v_accvgpr_write_b32 a68,v112
v_accvgpr_write_b32 a69,v113
v_accvgpr_write_b32 a70,v114
v_accvgpr_write_b32 a71,v115
v_accvgpr_write_b32 a76,v116
v_accvgpr_write_b32 a77,v117
v_accvgpr_write_b32 a78,v118
v_accvgpr_write_b32 a79,v119
v_xor_b32 v5,22528,v3
v_xor_b32 v6,22528,v4
ds_read2_b32 v[104:105],v5 offset1:32
ds_read2_b32 v[108:109],v6 offset1:32
ds_read2_b32 v[106:107],v5 offset0:64 offset1:96
ds_read2_b32 v[110:111],v6 offset0:64 offset1:96
s_waitcnt lgkmcnt(4)
v_perm_b32 v112,v100,v96,s61
v_perm_b32 v113,v101,v97,s61
v_perm_b32 v114,v102,v98,s61
v_perm_b32 v115,v103,v99,s61
v_perm_b32 v116,v100,v96,s62
v_perm_b32 v117,v101,v97,s62
v_perm_b32 v118,v102,v98,s62
v_perm_b32 v119,v103,v99,s62
v_accvgpr_write_b32 a80,v112
v_accvgpr_write_b32 a81,v113
v_accvgpr_write_b32 a82,v114
v_accvgpr_write_b32 a83,v115
v_accvgpr_write_b32 a88,v116
v_accvgpr_write_b32 a89,v117
v_accvgpr_write_b32 a90,v118
v_accvgpr_write_b32 a91,v119
v_xor_b32 v5,24576,v3
v_xor_b32 v6,24576,v4
ds_read2_b32 v[96:97],v5 offset1:32
ds_read2_b32 v[100:101],v6 offset1:32
ds_read2_b32 v[98:99],v5 offset0:64 offset1:96
ds_read2_b32 v[102:103],v6 offset0:64 offset1:96
s_waitcnt lgkmcnt(4)
v_perm_b32 v112,v108,v104,s61
v_perm_b32 v113,v109,v105,s61
v_perm_b32 v114,v110,v106,s61
v_perm_b32 v115,v111,v107,s61
v_perm_b32 v116,v108,v104,s62
v_perm_b32 v117,v109,v105,s62
v_perm_b32 v118,v110,v106,s62
v_perm_b32 v119,v111,v107,s62
v_accvgpr_write_b32 a84,v112
v_accvgpr_write_b32 a85,v113
v_accvgpr_write_b32 a86,v114
v_accvgpr_write_b32 a87,v115
v_accvgpr_write_b32 a92,v116
v_accvgpr_write_b32 a93,v117
v_accvgpr_write_b32 a94,v118
v_accvgpr_write_b32 a95,v119
v_xor_b32 v5,26624,v3
v_xor_b32 v6,26624,v4
ds_read2_b32 v[104:105],v5 offset1:32
ds_read2_b32 v[108:109],v6 offset1:32
ds_read2_b32 v[106:107],v5 offset0:64 offset1:96
ds_read2_b32 v[110:111],v6 offset0:64 offset1:96
s_waitcnt lgkmcnt(4)
v_perm_b32 v112,v100,v96,s61
v_perm_b32 v113,v101,v97,s61
v_perm_b32 v114,v102,v98,s61
v_perm_b32 v115,v103,v99,s61
v_perm_b32 v116,v100,v96,s62
v_perm_b32 v117,v101,v97,s62
v_perm_b32 v118,v102,v98,s62
v_perm_b32 v119,v103,v99,s62
v_accvgpr_write_b32 a96,v112
v_accvgpr_write_b32 a97,v113
v_accvgpr_write_b32 a98,v114
v_accvgpr_write_b32 a99,v115
v_accvgpr_write_b32 a104,v116
v_accvgpr_write_b32 a105,v117
v_accvgpr_write_b32 a106,v118
v_accvgpr_write_b32 a107,v119
v_xor_b32 v5,28672,v3
v_xor_b32 v6,28672,v4
ds_read2_b32 v[96:97],v5 offset1:32
ds_read2_b32 v[100:101],v6 offset1:32
ds_read2_b32 v[98:99],v5 offset0:64 offset1:96
ds_read2_b32 v[102:103],v6 offset0:64 offset1:96
s_waitcnt lgkmcnt(4)
v_perm_b32 v112,v108,v104,s61
v_perm_b32 v113,v109,v105,s61
v_perm_b32 v114,v110,v106,s61
v_perm_b32 v115,v111,v107,s61
v_perm_b32 v116,v108,v104,s62
v_perm_b32 v117,v109,v105,s62
v_perm_b32 v118,v110,v106,s62
v_perm_b32 v119,v111,v107,s62
v_accvgpr_write_b32 a100,v112
v_accvgpr_write_b32 a101,v113
v_accvgpr_write_b32 a102,v114
v_accvgpr_write_b32 a103,v115
v_accvgpr_write_b32 a108,v116
v_accvgpr_write_b32 a109,v117
v_accvgpr_write_b32 a110,v118
v_accvgpr_write_b32 a111,v119
v_xor_b32 v5,30720,v3
v_xor_b32 v6,30720,v4
ds_read2_b32 v[104:105],v5 offset1:32
ds_read2_b32 v[108:109],v6 offset1:32
ds_read2_b32 v[106:107],v5 offset0:64 offset1:96
ds_read2_b32 v[110:111],v6 offset0:64 offset1:96
s_waitcnt lgkmcnt(4)
v_perm_b32 v112,v100,v96,s61
v_perm_b32 v113,v101,v97,s61
v_perm_b32 v114,v102,v98,s61
v_perm_b32 v115,v103,v99,s61
v_perm_b32 v116,v100,v96,s62
v_perm_b32 v117,v101,v97,s62
v_perm_b32 v118,v102,v98,s62
v_perm_b32 v119,v103,v99,s62
v_accvgpr_write_b32 a112,v112
v_accvgpr_write_b32 a113,v113
v_accvgpr_write_b32 a114,v114
v_accvgpr_write_b32 a115,v115
v_accvgpr_write_b32 a120,v116
v_accvgpr_write_b32 a121,v117
v_accvgpr_write_b32 a122,v118
v_accvgpr_write_b32 a123,v119
s_waitcnt lgkmcnt(0)
v_perm_b32 v112,v108,v104,s61
v_perm_b32 v113,v109,v105,s61
v_perm_b32 v114,v110,v106,s61
v_perm_b32 v115,v111,v107,s61
v_perm_b32 v116,v108,v104,s62
v_perm_b32 v117,v109,v105,s62
v_perm_b32 v118,v110,v106,s62
v_perm_b32 v119,v111,v107,s62
v_accvgpr_write_b32 a116,v112
v_accvgpr_write_b32 a117,v113
v_accvgpr_write_b32 a118,v114
v_accvgpr_write_b32 a119,v115
v_accvgpr_write_b32 a124,v116
v_accvgpr_write_b32 a125,v117
v_accvgpr_write_b32 a126,v118
v_accvgpr_write_b32 a127,v119
s_cmp_lt_u32 s48,3
s_cbranch_scc1 L_rch_4
s_cmp_eq_u32 s48,3
s_cbranch_scc1 L_rm_5
v_mov_b32 v123,159744
s_cmp_lg_u32 s46,0
s_cbranch_scc1 L_gbd_18
v_mov_b32 v124,128
L_gb_17:
buffer_load_dword v125,v124,s[12:15],0 offen sc1
s_waitcnt vmcnt(0)
v_readfirstlane_b32 s56,v125
ds_write_b32 v123,v125
s_bitcmp1_b32 s56,8
s_cbranch_scc1 L_gbd_18
s_sleep 4
s_sub_u32 s49,s49,1
s_cmp_gt_i32 s49,0
s_cbranch_scc1 L_gb_17
s_branch L_abort
L_gbd_18:
s_waitcnt lgkmcnt(0)
s_barrier
ds_read_b32 v125,v123
s_waitcnt lgkmcnt(0)
v_readfirstlane_b32 s56,v125
s_barrier
s_lshr_b32 s56,s56,16
s_andn2_b32 s56,s56,s3
s_cbranch_scc1 L_spread
v_and_b32 v120,15,v1
v_lshrrev_b32 v121,4,v1
v_mov_b32 v17,1
s_lshl_b32 s56,s46,15
v_add_u32 v18,s56,v0
s_lshl_b32 s56,s46,2
v_add_u32 v125,s56,v121
v_xor_b32 v126,v125,v120
v_lshlrev_b32 v126,4,v126
v_lshl_add_u32 v20,v125,10,v126
v_add_u32 v125,0,v121
v_xor_b32 v125,v125,v120
v_lshlrev_b32 v125,4,v125
v_lshl_add_u32 v125,v120,8,v125
v_add_u32 v4,65536,v125
v_add_u32 v125,4,v121
v_xor_b32 v125,v125,v120
v_lshlrev_b32 v125,4,v125
v_lshl_add_u32 v125,v120,8,v125
v_add_u32 v5,65536,v125
v_add_u32 v125,8,v121
v_xor_b32 v125,v125,v120
v_lshlrev_b32 v125,4,v125
v_lshl_add_u32 v125,v120,8,v125
v_add_u32 v6,65536,v125
v_add_u32 v125,12,v121
v_xor_b32 v125,v125,v120
v_lshlrev_b32 v125,4,v125
v_lshl_add_u32 v125,v120,8,v125
v_add_u32 v7,65536,v125
v_lshlrev_b32 v21,5,v120
v_and_b32 v125,1,v121
v_lshl_add_u32 v21,v125,4,v21
s_lshl_b32 s56,s46,9
v_lshrrev_b32 v125,1,v121
v_lshl_add_u32 v21,v125,11,v21
s_add_u32 s56,s56,155648
v_add_u32 v21,s56,v21
v_lshlrev_b32 v22,4,v120
v_lshl_add_u32 v22,v121,10,v22
s_lshl_b32 s56,s46,8
v_add_u32 v22,s56,v22
s_sub_u32 s54,s48,4
s_cmp_eq_u32 s54,0
s_mov_b32 s72,1073752746
s_mov_b32 s73,1145324612
s_cmov_b32 s72,268440917
s_cmov_b32 s73,286331153
s_mov_b32 s70,0x80000000
s_mov_b32 s53,7
s_mov_b32 s74,s50
s_xor_b32 s75,s74,32768
v_and_b32 v23,31,v1
v_lshlrev_b32 v23,2,v23
v_mov_b32 v19,s50
v_mov_b32 v16,0
s_ff1_i32_b64 s55,s[72:73]
s_bitset0_b64 s[72:73],s55
s_min_u32 s55,s55,127
s_lshl_b32 s68,s55,15
s_add_u32 s68,s68,0
s_add_u32 s69,s68,16384
s_add_u32 m0,s75,65536
s_nop 0
buffer_load_dwordx4 v20,s[8:11],s68 offen offset:0 sc1 lds
s_add_u32 m0,s75,69632
s_nop 0
buffer_load_dwordx4 v20,s[8:11],s69 offen offset:0 sc1 lds
s_add_u32 m0,s75,73472
s_nop 0
buffer_load_dwordx4 v20,s[8:11],s68 offen offset:256 sc1 lds
s_add_u32 m0,s75,77568
s_nop 0
buffer_load_dwordx4 v20,s[8:11],s69 offen offset:256 sc1 lds
s_add_u32 m0,s75,81408
s_nop 0
buffer_load_dwordx4 v20,s[8:11],s68 offen offset:512 sc1 lds
s_add_u32 m0,s75,85504
s_nop 0
buffer_load_dwordx4 v20,s[8:11],s69 offen offset:512 sc1 lds
s_add_u32 m0,s75,89344
s_nop 0
buffer_load_dwordx4 v20,s[8:11],s68 offen offset:768 sc1 lds
s_add_u32 m0,s75,93440
s_nop 0
buffer_load_dwordx4 v20,s[8:11],s69 offen offset:768 sc1 lds
s_waitcnt vmcnt(0)
s_barrier
L_p_19:
s_mov_b32 s75,s74
s_xor_b32 s74,s74,32768
v_xor_b32 v4,32768,v4
v_xor_b32 v5,32768,v5
v_xor_b32 v6,32768,v6
v_xor_b32 v7,32768,v7
ds_read_b128 v[104:107],v4 offset:0
ds_read_b128 v[108:111],v4 offset:4096
ds_read_b128 v[112:115],v5 offset:0
ds_read_b128 v[116:119],v5 offset:4096
s_waitcnt lgkmcnt(2)
v_mfma_f32_16x16x32_bf16 v[24:27],a[128:131],v[104:107],0
ds_read_b128 v[120:123],v6 offset:0
v_mfma_f32_16x16x32_bf16 v[40:43],v[104:107],v[128:131],0
s_mov_b32 s51,s55
v_mfma_f32_16x16x32_bf16 v[28:31],a[128:131],v[108:111],0
ds_read_b128 v[124:127],v6 offset:4096
v_mfma_f32_16x16x32_bf16 v[44:47],v[108:111],v[128:131],0
s_mov_b32 s77,0
v_mfma_f32_16x16x32_bf16 v[32:35],a[136:139],v[104:107],0
s_sub_u32 s53,s53,1
v_mfma_f32_16x16x32_bf16 v[48:51],v[104:107],v[136:139],0
s_ff1_i32_b64 s55,s[72:73]
v_mfma_f32_16x16x32_bf16 v[36:39],a[136:139],v[108:111],0
s_bitset0_b64 s[72:73],s55
v_mfma_f32_16x16x32_bf16 v[52:55],v[108:111],v[136:139],0
s_min_u32 s55,s55,127
s_waitcnt lgkmcnt(2)
v_mfma_f32_16x16x32_bf16 v[24:27],a[132:135],v[112:115],v[24:27]
ds_read_b128 v[104:107],v7 offset:0
v_mfma_f32_16x16x32_bf16 v[40:43],v[112:115],v[132:135],v[40:43]
s_lshl_b32 s58,s51,5
v_mfma_f32_16x16x32_bf16 v[28:31],a[132:135],v[116:119],v[28:31]
ds_read_b128 v[108:111],v7 offset:4096
v_mfma_f32_16x16x32_bf16 v[44:47],v[116:119],v[132:135],v[44:47]
s_add_u32 s58,s58,s47
v_mfma_f32_16x16x32_bf16 v[32:35],a[140:143],v[112:115],v[32:35]
s_mul_i32 s58,s58,24576
v_mfma_f32_16x16x32_bf16 v[48:51],v[112:115],v[140:143],v[48:51]
s_add_u32 s58,s58,100663296
v_mfma_f32_16x16x32_bf16 v[36:39],a[140:143],v[116:119],v[36:39]
s_add_u32 s61,s58,s50
v_mfma_f32_16x16x32_bf16 v[52:55],v[116:119],v[140:143],v[52:55]
s_add_u32 s62,s61,4096
s_waitcnt lgkmcnt(2)
v_mfma_f32_16x16x32_bf16 v[24:27],a[144:147],v[120:123],v[24:27]
ds_read_b128 v[112:115],v4 offset:8192
v_mfma_f32_16x16x32_bf16 v[40:43],v[120:123],v[144:147],v[40:43]
s_add_u32 s63,s61,16384
v_mfma_f32_16x16x32_bf16 v[28:31],a[144:147],v[124:127],v[28:31]
ds_read_b128 v[116:119],v4 offset:12288
v_mfma_f32_16x16x32_bf16 v[44:47],v[124:127],v[144:147],v[44:47]
s_add_u32 s64,s61,20480
v_mfma_f32_16x16x32_bf16 v[32:35],a[152:155],v[120:123],v[32:35]
s_add_u32 s65,s61,s50
v_mfma_f32_16x16x32_bf16 v[48:51],v[120:123],v[152:155],v[48:51]
s_add_u32 s65,s65,8192
v_mfma_f32_16x16x32_bf16 v[36:39],a[152:155],v[124:127],v[36:39]
v_mfma_f32_16x16x32_bf16 v[52:55],v[124:127],v[152:155],v[52:55]
s_waitcnt lgkmcnt(2)
v_mfma_f32_16x16x32_bf16 v[24:27],a[148:151],v[104:107],v[24:27]
ds_read_b128 v[120:123],v5 offset:8192
v_mfma_f32_16x16x32_bf16 v[40:43],v[104:107],v[148:151],v[40:43]
v_mfma_f32_16x16x32_bf16 v[28:31],a[148:151],v[108:111],v[28:31]
ds_read_b128 v[124:127],v5 offset:12288
v_mfma_f32_16x16x32_bf16 v[44:47],v[108:111],v[148:151],v[44:47]
v_mfma_f32_16x16x32_bf16 v[32:35],a[156:159],v[104:107],v[32:35]
v_mfma_f32_16x16x32_bf16 v[48:51],v[104:107],v[156:159],v[48:51]
v_mfma_f32_16x16x32_bf16 v[36:39],a[156:159],v[108:111],v[36:39]
v_mfma_f32_16x16x32_bf16 v[52:55],v[108:111],v[156:159],v[52:55]
s_waitcnt lgkmcnt(2)
v_mfma_f32_16x16x32_bf16 v[24:27],a[160:163],v[112:115],v[24:27]
ds_read_b128 v[104:107],v6 offset:8192
v_mfma_f32_16x16x32_bf16 v[40:43],v[112:115],v[160:163],v[40:43]
v_mfma_f32_16x16x32_bf16 v[28:31],a[160:163],v[116:119],v[28:31]
ds_read_b128 v[108:111],v6 offset:12288
v_mfma_f32_16x16x32_bf16 v[44:47],v[116:119],v[160:163],v[44:47]
v_mfma_f32_16x16x32_bf16 v[32:35],a[168:171],v[112:115],v[32:35]
v_mfma_f32_16x16x32_bf16 v[48:51],v[112:115],v[168:171],v[48:51]
v_mfma_f32_16x16x32_bf16 v[36:39],a[168:171],v[116:119],v[36:39]
v_mfma_f32_16x16x32_bf16 v[52:55],v[116:119],v[168:171],v[52:55]
s_waitcnt lgkmcnt(2)
v_mfma_f32_16x16x32_bf16 v[24:27],a[164:167],v[120:123],v[24:27]
ds_read_b128 v[112:115],v7 offset:8192
v_mfma_f32_16x16x32_bf16 v[40:43],v[120:123],v[164:167],v[40:43]
s_lshl_b32 s56,s54,13
v_mfma_f32_16x16x32_bf16 v[28:31],a[164:167],v[124:127],v[28:31]
ds_read_b128 v[116:119],v7 offset:12288
v_mfma_f32_16x16x32_bf16 v[44:47],v[124:127],v[164:167],v[44:47]
s_add_u32 s56,s56,10487552
v_mfma_f32_16x16x32_bf16 v[32:35],a[172:175],v[120:123],v[32:35]
s_or_b32 s56,s56,s52
v_mfma_f32_16x16x32_bf16 v[48:51],v[120:123],v[172:175],v[48:51]
buffer_load_dword v76,v23,s[8:11],s56 offen sc1
v_mfma_f32_16x16x32_bf16 v[36:39],a[172:175],v[124:127],v[36:39]
v_mfma_f32_16x16x32_bf16 v[52:55],v[124:127],v[172:175],v[52:55]
s_waitcnt lgkmcnt(2)
v_mfma_f32_16x16x32_bf16 v[24:27],a[176:179],v[104:107],v[24:27]
ds_read_b128 v[120:123],v4 offset:16384
v_mfma_f32_16x16x32_bf16 v[40:43],v[104:107],v[176:179],v[40:43]
v_mfma_f32_16x16x32_bf16 v[28:31],a[176:179],v[108:111],v[28:31]
ds_read_b128 v[124:127],v4 offset:20480
v_mfma_f32_16x16x32_bf16 v[44:47],v[108:111],v[176:179],v[44:47]
v_mfma_f32_16x16x32_bf16 v[32:35],a[184:187],v[104:107],v[32:35]
v_mfma_f32_16x16x32_bf16 v[48:51],v[104:107],v[184:187],v[48:51]
v_mfma_f32_16x16x32_bf16 v[36:39],a[184:187],v[108:111],v[36:39]
v_mfma_f32_16x16x32_bf16 v[52:55],v[108:111],v[184:187],v[52:55]
s_waitcnt lgkmcnt(2)
v_mfma_f32_16x16x32_bf16 v[24:27],a[180:183],v[112:115],v[24:27]
ds_read_b128 v[104:107],v5 offset:16384
v_mfma_f32_16x16x32_bf16 v[40:43],v[112:115],v[180:183],v[40:43]
v_mfma_f32_16x16x32_bf16 v[28:31],a[180:183],v[116:119],v[28:31]
ds_read_b128 v[108:111],v5 offset:20480
v_mfma_f32_16x16x32_bf16 v[44:47],v[116:119],v[180:183],v[44:47]
v_mfma_f32_16x16x32_bf16 v[32:35],a[188:191],v[112:115],v[32:35]
v_mfma_f32_16x16x32_bf16 v[48:51],v[112:115],v[188:191],v[48:51]
v_mfma_f32_16x16x32_bf16 v[36:39],a[188:191],v[116:119],v[36:39]
v_mfma_f32_16x16x32_bf16 v[52:55],v[116:119],v[188:191],v[52:55]
s_waitcnt lgkmcnt(2)
v_mfma_f32_16x16x32_bf16 v[24:27],a[192:195],v[120:123],v[24:27]
ds_read_b128 v[112:115],v6 offset:16384
v_mfma_f32_16x16x32_bf16 v[40:43],v[120:123],v[192:195],v[40:43]
v_mfma_f32_16x16x32_bf16 v[28:31],a[192:195],v[124:127],v[28:31]
ds_read_b128 v[116:119],v6 offset:20480
v_mfma_f32_16x16x32_bf16 v[44:47],v[124:127],v[192:195],v[44:47]
v_mfma_f32_16x16x32_bf16 v[32:35],a[200:203],v[120:123],v[32:35]
v_mfma_f32_16x16x32_bf16 v[48:51],v[120:123],v[200:203],v[48:51]
v_mfma_f32_16x16x32_bf16 v[36:39],a[200:203],v[124:127],v[36:39]
v_mfma_f32_16x16x32_bf16 v[52:55],v[124:127],v[200:203],v[52:55]
s_waitcnt lgkmcnt(2)
v_mfma_f32_16x16x32_bf16 v[24:27],a[196:199],v[104:107],v[24:27]
ds_read_b128 v[120:123],v7 offset:16384
v_mfma_f32_16x16x32_bf16 v[40:43],v[104:107],v[196:199],v[40:43]
s_waitcnt vmcnt(0)
v_mfma_f32_16x16x32_bf16 v[28:31],a[196:199],v[108:111],v[28:31]
ds_read_b128 v[124:127],v7 offset:20480
v_mfma_f32_16x16x32_bf16 v[44:47],v[108:111],v[196:199],v[44:47]
v_cmp_eq_u32 vcc,0,v76
v_mfma_f32_16x16x32_bf16 v[32:35],a[204:207],v[104:107],v[32:35]
s_nop 0
v_mov_b32 v76,vcc_lo
v_mfma_f32_16x16x32_bf16 v[48:51],v[104:107],v[204:207],v[48:51]
ds_write_b32 v19,v76
v_mfma_f32_16x16x32_bf16 v[36:39],a[204:207],v[108:111],v[36:39]
v_mfma_f32_16x16x32_bf16 v[52:55],v[108:111],v[204:207],v[52:55]
s_waitcnt vmcnt(0) lgkmcnt(0)
s_barrier
s_or_b32 s70,s70,s52
buffer_store_dword v17,off,s[8:11],s70 sc1
ds_read_b32 v76,v16
v_mfma_f32_16x16x32_bf16 v[24:27],a[208:211],v[112:115],v[24:27]
ds_read_b128 v[104:107],v4 offset:24576
v_mfma_f32_16x16x32_bf16 v[40:43],v[112:115],v[208:211],v[40:43]
s_lshl_b32 s56,s51,5
s_add_u32 s56,s56,s47
s_lshl_b32 s56,s56,12
v_mfma_f32_16x16x32_bf16 v[28:31],a[208:211],v[116:119],v[28:31]
ds_read_b128 v[108:111],v4 offset:28672
v_mfma_f32_16x16x32_bf16 v[44:47],v[116:119],v[208:211],v[44:47]
s_add_u32 s56,s56,s50
s_add_u32 s56,s56,41943040
v_mfma_f32_16x16x32_bf16 v[32:35],a[216:219],v[112:115],v[32:35]
v_mov_b64 v[72:73],-1
v_mov_b64 v[74:75],-1
v_mfma_f32_16x16x32_bf16 v[48:51],v[112:115],v[216:219],v[48:51]
buffer_store_dwordx4 v[72:75],v0,s[8:11],s56 offen sc1
v_mfma_f32_16x16x32_bf16 v[36:39],a[216:219],v[116:119],v[36:39]
v_mfma_f32_16x16x32_bf16 v[52:55],v[116:119],v[216:219],v[52:55]
s_waitcnt lgkmcnt(2)
v_mfma_f32_16x16x32_bf16 v[24:27],a[212:215],v[120:123],v[24:27]
ds_read_b128 v[112:115],v5 offset:24576
v_mfma_f32_16x16x32_bf16 v[40:43],v[120:123],v[212:215],v[40:43]
v_readfirstlane_b32 s57,v76
v_mfma_f32_16x16x32_bf16 v[28:31],a[212:215],v[124:127],v[28:31]
ds_read_b128 v[116:119],v5 offset:28672
v_mfma_f32_16x16x32_bf16 v[44:47],v[124:127],v[212:215],v[44:47]
s_sub_u32 s59,s55,s54
s_cmp_lt_i32 s59,44
s_cselect_b32 s76,2,0
v_mfma_f32_16x16x32_bf16 v[32:35],a[220:223],v[120:123],v[32:35]
s_cmp_gt_i32 s53,0
s_cselect_b32 s76,s76,0
v_mfma_f32_16x16x32_bf16 v[48:51],v[120:123],v[220:223],v[48:51]
s_cmp_eq_u32 s57,0
s_cselect_b32 s76,1,s76
v_mfma_f32_16x16x32_bf16 v[36:39],a[220:223],v[124:127],v[36:39]
s_cmp_lt_i32 s59,12
s_cselect_b32 s76,2,s76
s_add_u32 s57,s54,64
v_mfma_f32_16x16x32_bf16 v[52:55],v[124:127],v[220:223],v[52:55]
s_cmp_eq_u32 s76,1
s_cselect_b32 s68,s57,s55
s_lshl_b32 s68,s68,15
s_waitcnt lgkmcnt(2)
v_mfma_f32_16x16x32_bf16 v[24:27],a[224:227],v[104:107],v[24:27]
ds_read_b128 v[120:123],v6 offset:24576
v_mfma_f32_16x16x32_bf16 v[40:43],v[104:107],v[224:227],v[40:43]
s_cmp_eq_u32 s76,0
s_cselect_b32 s68,0x80000000,s68
s_add_u32 s69,s68,16384
v_mfma_f32_16x16x32_bf16 v[28:31],a[224:227],v[108:111],v[28:31]
ds_read_b128 v[124:127],v6 offset:28672
v_mfma_f32_16x16x32_bf16 v[44:47],v[108:111],v[224:227],v[44:47]
s_add_u32 m0,s75,65536
v_mfma_f32_16x16x32_bf16 v[32:35],a[232:235],v[104:107],v[32:35]
buffer_load_dwordx4 v20,s[8:11],s68 offen offset:0 sc1 lds
v_mfma_f32_16x16x32_bf16 v[48:51],v[104:107],v[232:235],v[48:51]
s_add_u32 m0,s75,69632
v_mfma_f32_16x16x32_bf16 v[36:39],a[232:235],v[108:111],v[36:39]
buffer_load_dwordx4 v20,s[8:11],s69 offen offset:0 sc1 lds
v_mfma_f32_16x16x32_bf16 v[52:55],v[108:111],v[232:235],v[52:55]
s_add_u32 m0,s75,73472
s_waitcnt lgkmcnt(2)
v_mfma_f32_16x16x32_bf16 v[24:27],a[228:231],v[112:115],v[24:27]
ds_read_b128 v[104:107],v7 offset:24576
v_mfma_f32_16x16x32_bf16 v[40:43],v[112:115],v[228:231],v[40:43]
buffer_load_dwordx4 v20,s[8:11],s68 offen offset:256 sc1 lds
v_mfma_f32_16x16x32_bf16 v[28:31],a[228:231],v[116:119],v[28:31]
ds_read_b128 v[108:111],v7 offset:28672
v_mfma_f32_16x16x32_bf16 v[44:47],v[116:119],v[228:231],v[44:47]
s_add_u32 m0,s75,77568
v_mfma_f32_16x16x32_bf16 v[32:35],a[236:239],v[112:115],v[32:35]
buffer_load_dwordx4 v20,s[8:11],s69 offen offset:256 sc1 lds
v_mfma_f32_16x16x32_bf16 v[48:51],v[112:115],v[236:239],v[48:51]
s_add_u32 m0,s75,81408
v_mfma_f32_16x16x32_bf16 v[36:39],a[236:239],v[116:119],v[36:39]
buffer_load_dwordx4 v20,s[8:11],s68 offen offset:512 sc1 lds
v_mfma_f32_16x16x32_bf16 v[52:55],v[116:119],v[236:239],v[52:55]
s_add_u32 m0,s75,85504
s_waitcnt lgkmcnt(2)
v_mfma_f32_16x16x32_bf16 v[24:27],a[240:243],v[120:123],v[24:27]
ds_read_b128 v[112:115],v4 offset:0
v_mfma_f32_16x16x32_bf16 v[40:43],v[120:123],v[240:243],v[40:43]
buffer_load_dwordx4 v20,s[8:11],s69 offen offset:512 sc1 lds
v_mfma_f32_16x16x32_bf16 v[28:31],a[240:243],v[124:127],v[28:31]
ds_read_b128 v[116:119],v4 offset:4096
v_mfma_f32_16x16x32_bf16 v[44:47],v[124:127],v[240:243],v[44:47]
s_add_u32 m0,s75,89344
v_mfma_f32_16x16x32_bf16 v[32:35],a[248:251],v[120:123],v[32:35]
buffer_load_dwordx4 v20,s[8:11],s68 offen offset:768 sc1 lds
v_mfma_f32_16x16x32_bf16 v[48:51],v[120:123],v[248:251],v[48:51]
s_add_u32 m0,s75,93440
v_mfma_f32_16x16x32_bf16 v[36:39],a[248:251],v[124:127],v[36:39]
buffer_load_dwordx4 v20,s[8:11],s69 offen offset:768 sc1 lds
v_mfma_f32_16x16x32_bf16 v[52:55],v[124:127],v[248:251],v[52:55]
s_waitcnt lgkmcnt(2)
v_mfma_f32_16x16x32_bf16 v[24:27],a[244:247],v[104:107],v[24:27]
ds_read_b128 v[120:123],v5 offset:0
v_mfma_f32_16x16x32_bf16 v[40:43],v[104:107],v[244:247],v[40:43]
v_mfma_f32_16x16x32_bf16 v[28:31],a[244:247],v[108:111],v[28:31]
ds_read_b128 v[124:127],v5 offset:4096
v_mfma_f32_16x16x32_bf16 v[44:47],v[108:111],v[244:247],v[44:47]
v_mfma_f32_16x16x32_bf16 v[32:35],a[252:255],v[104:107],v[32:35]
v_mfma_f32_16x16x32_bf16 v[48:51],v[104:107],v[252:255],v[48:51]
v_mfma_f32_16x16x32_bf16 v[36:39],a[252:255],v[108:111],v[36:39]
v_mfma_f32_16x16x32_bf16 v[52:55],v[108:111],v[252:255],v[52:55]
s_waitcnt lgkmcnt(2)
v_mfma_f32_16x16x32_bf16 v[88:91],a[0:3],v[112:115],0
ds_read_b128 v[104:107],v6 offset:0
v_mfma_f32_16x16x32_bf16 v[92:95],a[0:3],v[116:119],0
v_mfma_f32_16x16x32_bf16 v[96:99],a[8:11],v[112:115],0
ds_read_b128 v[108:111],v6 offset:4096
v_cvt_pk_bf16_f32 v56,v24,v32
v_cvt_pk_bf16_f32 v57,v25,v33
v_mfma_f32_16x16x32_bf16 v[100:103],a[8:11],v[116:119],0
v_cvt_pk_bf16_f32 v58,v26,v34
v_cvt_pk_bf16_f32 v59,v27,v35
s_waitcnt lgkmcnt(2)
v_mfma_f32_16x16x32_bf16 v[88:91],a[4:7],v[120:123],v[88:91]
ds_read_b128 v[112:115],v7 offset:0
v_mfma_f32_16x16x32_bf16 v[92:95],a[4:7],v[124:127],v[92:95]
buffer_store_dwordx4 v[56:59],v0,s[8:11],s61 offen sc1
v_cvt_pk_bf16_f32 v60,v28,v36
v_cvt_pk_bf16_f32 v61,v29,v37
v_mfma_f32_16x16x32_bf16 v[96:99],a[12:15],v[120:123],v[96:99]
ds_read_b128 v[116:119],v7 offset:4096
v_cvt_pk_bf16_f32 v62,v30,v38
v_cvt_pk_bf16_f32 v63,v31,v39
v_mfma_f32_16x16x32_bf16 v[100:103],a[12:15],v[124:127],v[100:103]
buffer_store_dwordx4 v[60:63],v0,s[8:11],s62 offen sc1
v_cvt_pk_bf16_f32 v64,v40,v41
v_cvt_pk_bf16_f32 v65,v42,v43
s_waitcnt lgkmcnt(2)
v_mfma_f32_16x16x32_bf16 v[88:91],a[16:19],v[104:107],v[88:91]
ds_read_b128 v[120:123],v4 offset:8192
v_cvt_pk_bf16_f32 v66,v44,v45
v_cvt_pk_bf16_f32 v67,v46,v47
v_mfma_f32_16x16x32_bf16 v[92:95],a[16:19],v[108:111],v[92:95]
buffer_store_dwordx4 v[64:67],v0,s[8:11],s65 offen offset:0 sc1
v_cvt_pk_bf16_f32 v68,v48,v49
v_cvt_pk_bf16_f32 v69,v50,v51
v_mfma_f32_16x16x32_bf16 v[96:99],a[24:27],v[104:107],v[96:99]
ds_read_b128 v[124:127],v4 offset:12288
v_cvt_pk_bf16_f32 v70,v52,v53
v_cvt_pk_bf16_f32 v71,v54,v55
v_mfma_f32_16x16x32_bf16 v[100:103],a[24:27],v[108:111],v[100:103]
buffer_store_dwordx4 v[68:71],v0,s[8:11],s65 offen offset:1024 sc1
s_waitcnt lgkmcnt(2)
v_mfma_f32_16x16x32_bf16 v[88:91],a[20:23],v[112:115],v[88:91]
ds_read_b128 v[104:107],v5 offset:8192
v_mfma_f32_16x16x32_bf16 v[92:95],a[20:23],v[116:119],v[92:95]
v_mfma_f32_16x16x32_bf16 v[96:99],a[28:31],v[112:115],v[96:99]
ds_read_b128 v[108:111],v5 offset:12288
v_mfma_f32_16x16x32_bf16 v[100:103],a[28:31],v[116:119],v[100:103]
s_waitcnt lgkmcnt(2)
v_mfma_f32_16x16x32_bf16 v[88:91],a[32:35],v[120:123],v[88:91]
ds_read_b128 v[112:115],v6 offset:8192
v_mfma_f32_16x16x32_bf16 v[92:95],a[32:35],v[124:127],v[92:95]
v_mfma_f32_16x16x32_bf16 v[96:99],a[40:43],v[120:123],v[96:99]
ds_read_b128 v[116:119],v6 offset:12288
v_mfma_f32_16x16x32_bf16 v[100:103],a[40:43],v[124:127],v[100:103]
s_waitcnt lgkmcnt(2)
v_mfma_f32_16x16x32_bf16 v[88:91],a[36:39],v[104:107],v[88:91]
ds_read_b128 v[120:123],v7 offset:8192
v_mfma_f32_16x16x32_bf16 v[92:95],a[36:39],v[108:111],v[92:95]
s_lshl_b32 s56,s54,13
v_mfma_f32_16x16x32_bf16 v[96:99],a[44:47],v[104:107],v[96:99]
ds_read_b128 v[124:127],v7 offset:12288
v_mfma_f32_16x16x32_bf16 v[100:103],a[44:47],v[108:111],v[100:103]
s_add_u32 s56,s56,10487552
s_waitcnt lgkmcnt(2)
v_mfma_f32_16x16x32_bf16 v[88:91],a[48:51],v[112:115],v[88:91]
ds_read_b128 v[104:107],v4 offset:16384
v_mfma_f32_16x16x32_bf16 v[92:95],a[48:51],v[116:119],v[92:95]
s_or_b32 s56,s56,s52
v_mfma_f32_16x16x32_bf16 v[96:99],a[56:59],v[112:115],v[96:99]
ds_read_b128 v[108:111],v4 offset:20480
v_mfma_f32_16x16x32_bf16 v[100:103],a[56:59],v[116:119],v[100:103]
buffer_load_dword v76,v23,s[8:11],s56 offen sc1
s_waitcnt lgkmcnt(2)
v_mfma_f32_16x16x32_bf16 v[88:91],a[52:55],v[120:123],v[88:91]
ds_read_b128 v[112:115],v5 offset:16384
v_mfma_f32_16x16x32_bf16 v[92:95],a[52:55],v[124:127],v[92:95]
v_mfma_f32_16x16x32_bf16 v[96:99],a[60:63],v[120:123],v[96:99]
ds_read_b128 v[116:119],v5 offset:20480
v_mfma_f32_16x16x32_bf16 v[100:103],a[60:63],v[124:127],v[100:103]
s_waitcnt lgkmcnt(2)
v_mfma_f32_16x16x32_bf16 v[88:91],a[64:67],v[104:107],v[88:91]
ds_read_b128 v[120:123],v6 offset:16384
v_mfma_f32_16x16x32_bf16 v[92:95],a[64:67],v[108:111],v[92:95]
v_mfma_f32_16x16x32_bf16 v[96:99],a[72:75],v[104:107],v[96:99]
ds_read_b128 v[124:127],v6 offset:20480
v_mfma_f32_16x16x32_bf16 v[100:103],a[72:75],v[108:111],v[100:103]
s_waitcnt lgkmcnt(2)
v_mfma_f32_16x16x32_bf16 v[88:91],a[68:71],v[112:115],v[88:91]
ds_read_b128 v[104:107],v7 offset:16384
v_mfma_f32_16x16x32_bf16 v[92:95],a[68:71],v[116:119],v[92:95]
v_mfma_f32_16x16x32_bf16 v[96:99],a[76:79],v[112:115],v[96:99]
ds_read_b128 v[108:111],v7 offset:20480
v_mfma_f32_16x16x32_bf16 v[100:103],a[76:79],v[116:119],v[100:103]
s_waitcnt lgkmcnt(2)
v_mfma_f32_16x16x32_bf16 v[88:91],a[80:83],v[120:123],v[88:91]
ds_read_b128 v[112:115],v4 offset:24576
v_mfma_f32_16x16x32_bf16 v[92:95],a[80:83],v[124:127],v[92:95]
v_mfma_f32_16x16x32_bf16 v[96:99],a[88:91],v[120:123],v[96:99]
ds_read_b128 v[116:119],v4 offset:28672
v_mfma_f32_16x16x32_bf16 v[100:103],a[88:91],v[124:127],v[100:103]
s_waitcnt lgkmcnt(2)
v_mfma_f32_16x16x32_bf16 v[88:91],a[84:87],v[104:107],v[88:91]
ds_read_b128 v[120:123],v5 offset:24576
v_mfma_f32_16x16x32_bf16 v[92:95],a[84:87],v[108:111],v[92:95]
v_mfma_f32_16x16x32_bf16 v[96:99],a[92:95],v[104:107],v[96:99]
ds_read_b128 v[124:127],v5 offset:28672
v_mfma_f32_16x16x32_bf16 v[100:103],a[92:95],v[108:111],v[100:103]
s_waitcnt lgkmcnt(2)
v_mfma_f32_16x16x32_bf16 v[88:91],a[96:99],v[112:115],v[88:91]
ds_read_b128 v[104:107],v6 offset:24576
v_mfma_f32_16x16x32_bf16 v[92:95],a[96:99],v[116:119],v[92:95]
v_mfma_f32_16x16x32_bf16 v[96:99],a[104:107],v[112:115],v[96:99]
ds_read_b128 v[108:111],v6 offset:28672
v_mfma_f32_16x16x32_bf16 v[100:103],a[104:107],v[116:119],v[100:103]
s_waitcnt lgkmcnt(2)
v_mfma_f32_16x16x32_bf16 v[88:91],a[100:103],v[120:123],v[88:91]
ds_read_b128 v[112:115],v7 offset:24576
v_mfma_f32_16x16x32_bf16 v[92:95],a[100:103],v[124:127],v[92:95]
v_mfma_f32_16x16x32_bf16 v[96:99],a[108:111],v[120:123],v[96:99]
ds_read_b128 v[116:119],v7 offset:28672
v_mfma_f32_16x16x32_bf16 v[100:103],a[108:111],v[124:127],v[100:103]
s_waitcnt lgkmcnt(2)
v_mfma_f32_16x16x32_bf16 v[88:91],a[112:115],v[104:107],v[88:91]
v_mfma_f32_16x16x32_bf16 v[92:95],a[112:115],v[108:111],v[92:95]
v_mfma_f32_16x16x32_bf16 v[96:99],a[120:123],v[104:107],v[96:99]
v_mfma_f32_16x16x32_bf16 v[100:103],a[120:123],v[108:111],v[100:103]
s_waitcnt lgkmcnt(0)
v_mfma_f32_16x16x32_bf16 v[88:91],a[116:119],v[112:115],v[88:91]
v_mfma_f32_16x16x32_bf16 v[92:95],a[116:119],v[116:119],v[92:95]
v_mfma_f32_16x16x32_bf16 v[96:99],a[124:127],v[112:115],v[96:99]
v_mfma_f32_16x16x32_bf16 v[100:103],a[124:127],v[116:119],v[100:103]
s_nop 3
v_cvt_pk_bf16_f32 v104,v88,v96
v_cvt_pk_bf16_f32 v105,v89,v97
v_cvt_pk_bf16_f32 v106,v90,v98
v_cvt_pk_bf16_f32 v107,v91,v99
v_cvt_pk_bf16_f32 v108,v92,v100
v_cvt_pk_bf16_f32 v109,v93,v101
v_cvt_pk_bf16_f32 v110,v94,v102
v_cvt_pk_bf16_f32 v111,v95,v103
buffer_store_dwordx4 v[104:107],v0,s[8:11],s63 offen sc1
buffer_store_dwordx4 v[108:111],v0,s[8:11],s64 offen sc1
s_waitcnt vmcnt(7)
s_barrier
s_lshl_b32 s70,s51,13
s_lshl2_add_u32 s70,s47,s70
s_add_u32 s70,s70,10485760
s_cmp_ge_u32 s51,2
s_cbranch_scc1 L_p_21
s_waitcnt vmcnt(0)
s_barrier
s_or_b32 s70,s70,s52
buffer_store_dword v17,off,s[8:11],s70 sc1
L_p_21:
s_cmp_eq_u32 s76,2
s_cbranch_scc1 L_p_19
s_mov_b32 s53,0
s_mov_b32 s51,s54
s_add_u32 s54,s54,2
s_cmp_eq_u32 s76,1
s_cbranch_scc1 L_p_20
s_cmp_lg_u32 s77,0
s_waitcnt vmcnt(3)
s_cbranch_scc1 L_p_23
s_waitcnt vmcnt(2)
L_p_23:
v_cmp_eq_u32 vcc,0,v76
s_nop 1
v_mov_b32 v76,vcc_lo
ds_write_b32 v19,v76
s_lshl_b32 s66,s51,15
s_add_u32 s66,s66,2097152
s_add_u32 s67,s66,16384
s_waitcnt lgkmcnt(0)
s_barrier
ds_read_b32 v76,v16
s_waitcnt lgkmcnt(0)
v_cmp_eq_u32 vcc,0,v76
s_cbranch_vccnz L_p_24
s_waitcnt vmcnt(0)
s_barrier
s_or_b32 s70,s70,s52
buffer_store_dword v17,off,s[8:11],s70 sc1
s_mov_b32 s70,0x80000000
s_mov_b32 s53,1
s_cmp_ge_u32 s51,64
s_cbranch_scc1 L_p_22
s_lshl_b32 s59,s51,13
s_add_u32 s59,s59,10487552
s_cmp_lg_u32 s46,0
s_cbranch_scc1 L_fd_26
v_and_b32 v124,31,v1
v_lshlrev_b32 v124,2,v124
s_branch L_ff_27
L_fw_25:
s_sleep 2
L_ff_27:
buffer_load_dword v125,v124,s[8:11],s59 offen sc1
s_sub_u32 s49,s49,1
s_cbranch_scc1 L_abort
s_waitcnt vmcnt(0)
v_cmp_eq_u32 vcc,0,v125
s_cbranch_vccnz L_fw_25
L_fd_26:
s_barrier
L_p_24:
s_add_u32 m0,s74,65536
s_nop 0
buffer_load_dwordx4 v20,s[8:11],s66 offen offset:0 sc1 lds
s_add_u32 m0,s74,69632
s_nop 0
buffer_load_dwordx4 v20,s[8:11],s67 offen offset:0 sc1 lds
s_add_u32 m0,s74,73472
s_nop 0
buffer_load_dwordx4 v20,s[8:11],s66 offen offset:256 sc1 lds
s_add_u32 m0,s74,77568
s_nop 0
buffer_load_dwordx4 v20,s[8:11],s67 offen offset:256 sc1 lds
s_add_u32 m0,s74,81408
s_nop 0
buffer_load_dwordx4 v20,s[8:11],s66 offen offset:512 sc1 lds
s_add_u32 m0,s74,85504
s_nop 0
buffer_load_dwordx4 v20,s[8:11],s67 offen offset:512 sc1 lds
s_add_u32 m0,s74,89344
s_nop 0
buffer_load_dwordx4 v20,s[8:11],s66 offen offset:768 sc1 lds
s_add_u32 m0,s74,93440
s_nop 0
buffer_load_dwordx4 v20,s[8:11],s67 offen offset:768 sc1 lds
s_lshl_b32 s56,s54,13
s_add_u32 s56,s56,10487552
s_or_b32 s56,s56,s52
buffer_load_dword v76,v23,s[8:11],s56 offen sc1
s_waitcnt vmcnt(7)
s_barrier
ds_read_b128 v[104:107],v4 offset:0
ds_read_b128 v[108:111],v4 offset:4096
ds_read_b128 v[112:115],v5 offset:0
ds_read_b128 v[116:119],v5 offset:4096
s_waitcnt lgkmcnt(2)
v_mfma_f32_16x16x32_bf16 v[24:27],a[128:131],v[104:107],0
ds_read_b128 v[120:123],v6 offset:0
v_mfma_f32_16x16x32_bf16 v[40:43],v[104:107],v[128:131],0
s_lshl_b32 s58,s51,5
v_mfma_f32_16x16x32_bf16 v[28:31],a[128:131],v[108:111],0
ds_read_b128 v[124:127],v6 offset:4096
v_mfma_f32_16x16x32_bf16 v[44:47],v[108:111],v[128:131],0
s_add_u32 s58,s58,s47
v_mfma_f32_16x16x32_bf16 v[32:35],a[136:139],v[104:107],0
s_mul_i32 s58,s58,24576
v_mfma_f32_16x16x32_bf16 v[48:51],v[104:107],v[136:139],0
s_add_u32 s58,s58,150994944
v_mfma_f32_16x16x32_bf16 v[36:39],a[136:139],v[108:111],0
s_add_u32 s61,s58,s50
v_mfma_f32_16x16x32_bf16 v[52:55],v[108:111],v[136:139],0
s_add_u32 s62,s61,4096
s_waitcnt lgkmcnt(2)
v_mfma_f32_16x16x32_bf16 v[24:27],a[132:135],v[112:115],v[24:27]
ds_read_b128 v[104:107],v7 offset:0
v_mfma_f32_16x16x32_bf16 v[40:43],v[112:115],v[132:135],v[40:43]
s_add_u32 s63,s61,16384
v_mfma_f32_16x16x32_bf16 v[28:31],a[132:135],v[116:119],v[28:31]
ds_read_b128 v[108:111],v7 offset:4096
v_mfma_f32_16x16x32_bf16 v[44:47],v[116:119],v[132:135],v[44:47]
s_add_u32 s64,s61,20480
v_mfma_f32_16x16x32_bf16 v[32:35],a[140:143],v[112:115],v[32:35]
s_add_u32 s65,s61,s50
v_mfma_f32_16x16x32_bf16 v[48:51],v[112:115],v[140:143],v[48:51]
s_add_u32 s65,s65,8192
v_mfma_f32_16x16x32_bf16 v[36:39],a[140:143],v[116:119],v[36:39]
v_mfma_f32_16x16x32_bf16 v[52:55],v[116:119],v[140:143],v[52:55]
s_waitcnt vmcnt(5)
s_barrier
s_waitcnt lgkmcnt(2)
v_mfma_f32_16x16x32_bf16 v[24:27],a[144:147],v[120:123],v[24:27]
ds_read_b128 v[112:115],v4 offset:8192
v_mfma_f32_16x16x32_bf16 v[40:43],v[120:123],v[144:147],v[40:43]
v_mfma_f32_16x16x32_bf16 v[28:31],a[144:147],v[124:127],v[28:31]
ds_read_b128 v[116:119],v4 offset:12288
v_mfma_f32_16x16x32_bf16 v[44:47],v[124:127],v[144:147],v[44:47]
v_mfma_f32_16x16x32_bf16 v[32:35],a[152:155],v[120:123],v[32:35]
v_mfma_f32_16x16x32_bf16 v[48:51],v[120:123],v[152:155],v[48:51]
v_mfma_f32_16x16x32_bf16 v[36:39],a[152:155],v[124:127],v[36:39]
v_mfma_f32_16x16x32_bf16 v[52:55],v[124:127],v[152:155],v[52:55]
s_waitcnt lgkmcnt(2)
v_mfma_f32_16x16x32_bf16 v[24:27],a[148:151],v[104:107],v[24:27]
ds_read_b128 v[120:123],v5 offset:8192
v_mfma_f32_16x16x32_bf16 v[40:43],v[104:107],v[148:151],v[40:43]
v_mfma_f32_16x16x32_bf16 v[28:31],a[148:151],v[108:111],v[28:31]
ds_read_b128 v[124:127],v5 offset:12288
v_mfma_f32_16x16x32_bf16 v[44:47],v[108:111],v[148:151],v[44:47]
v_mfma_f32_16x16x32_bf16 v[32:35],a[156:159],v[104:107],v[32:35]
v_mfma_f32_16x16x32_bf16 v[48:51],v[104:107],v[156:159],v[48:51]
v_mfma_f32_16x16x32_bf16 v[36:39],a[156:159],v[108:111],v[36:39]
v_mfma_f32_16x16x32_bf16 v[52:55],v[108:111],v[156:159],v[52:55]
s_waitcnt lgkmcnt(2)
v_mfma_f32_16x16x32_bf16 v[24:27],a[160:163],v[112:115],v[24:27]
ds_read_b128 v[104:107],v6 offset:8192
v_mfma_f32_16x16x32_bf16 v[40:43],v[112:115],v[160:163],v[40:43]
v_mfma_f32_16x16x32_bf16 v[28:31],a[160:163],v[116:119],v[28:31]
ds_read_b128 v[108:111],v6 offset:12288
v_mfma_f32_16x16x32_bf16 v[44:47],v[116:119],v[160:163],v[44:47]
v_mfma_f32_16x16x32_bf16 v[32:35],a[168:171],v[112:115],v[32:35]
v_mfma_f32_16x16x32_bf16 v[48:51],v[112:115],v[168:171],v[48:51]
v_mfma_f32_16x16x32_bf16 v[36:39],a[168:171],v[116:119],v[36:39]
v_mfma_f32_16x16x32_bf16 v[52:55],v[116:119],v[168:171],v[52:55]
s_waitcnt lgkmcnt(2)
v_mfma_f32_16x16x32_bf16 v[24:27],a[164:167],v[120:123],v[24:27]
ds_read_b128 v[112:115],v7 offset:8192
v_mfma_f32_16x16x32_bf16 v[40:43],v[120:123],v[164:167],v[40:43]
v_mfma_f32_16x16x32_bf16 v[28:31],a[164:167],v[124:127],v[28:31]
ds_read_b128 v[116:119],v7 offset:12288
v_mfma_f32_16x16x32_bf16 v[44:47],v[124:127],v[164:167],v[44:47]
v_mfma_f32_16x16x32_bf16 v[32:35],a[172:175],v[120:123],v[32:35]
v_mfma_f32_16x16x32_bf16 v[48:51],v[120:123],v[172:175],v[48:51]
v_mfma_f32_16x16x32_bf16 v[36:39],a[172:175],v[124:127],v[36:39]
v_mfma_f32_16x16x32_bf16 v[52:55],v[124:127],v[172:175],v[52:55]
s_waitcnt vmcnt(3)
s_barrier
s_waitcnt lgkmcnt(2)
v_mfma_f32_16x16x32_bf16 v[24:27],a[176:179],v[104:107],v[24:27]
ds_read_b128 v[120:123],v4 offset:16384
v_mfma_f32_16x16x32_bf16 v[40:43],v[104:107],v[176:179],v[40:43]
v_mfma_f32_16x16x32_bf16 v[28:31],a[176:179],v[108:111],v[28:31]
ds_read_b128 v[124:127],v4 offset:20480
v_mfma_f32_16x16x32_bf16 v[44:47],v[108:111],v[176:179],v[44:47]
v_mfma_f32_16x16x32_bf16 v[32:35],a[184:187],v[104:107],v[32:35]
v_mfma_f32_16x16x32_bf16 v[48:51],v[104:107],v[184:187],v[48:51]
v_mfma_f32_16x16x32_bf16 v[36:39],a[184:187],v[108:111],v[36:39]
v_mfma_f32_16x16x32_bf16 v[52:55],v[108:111],v[184:187],v[52:55]
s_waitcnt lgkmcnt(2)
v_mfma_f32_16x16x32_bf16 v[24:27],a[180:183],v[112:115],v[24:27]
ds_read_b128 v[104:107],v5 offset:16384
v_mfma_f32_16x16x32_bf16 v[40:43],v[112:115],v[180:183],v[40:43]
v_mfma_f32_16x16x32_bf16 v[28:31],a[180:183],v[116:119],v[28:31]
ds_read_b128 v[108:111],v5 offset:20480
v_mfma_f32_16x16x32_bf16 v[44:47],v[116:119],v[180:183],v[44:47]
v_mfma_f32_16x16x32_bf16 v[32:35],a[188:191],v[112:115],v[32:35]
v_mfma_f32_16x16x32_bf16 v[48:51],v[112:115],v[188:191],v[48:51]
v_mfma_f32_16x16x32_bf16 v[36:39],a[188:191],v[116:119],v[36:39]
v_mfma_f32_16x16x32_bf16 v[52:55],v[116:119],v[188:191],v[52:55]
s_waitcnt lgkmcnt(2)
v_mfma_f32_16x16x32_bf16 v[24:27],a[192:195],v[120:123],v[24:27]
ds_read_b128 v[112:115],v6 offset:16384
v_mfma_f32_16x16x32_bf16 v[40:43],v[120:123],v[192:195],v[40:43]
v_mfma_f32_16x16x32_bf16 v[28:31],a[192:195],v[124:127],v[28:31]
ds_read_b128 v[116:119],v6 offset:20480
v_mfma_f32_16x16x32_bf16 v[44:47],v[124:127],v[192:195],v[44:47]
v_mfma_f32_16x16x32_bf16 v[32:35],a[200:203],v[120:123],v[32:35]
v_mfma_f32_16x16x32_bf16 v[48:51],v[120:123],v[200:203],v[48:51]
v_mfma_f32_16x16x32_bf16 v[36:39],a[200:203],v[124:127],v[36:39]
v_mfma_f32_16x16x32_bf16 v[52:55],v[124:127],v[200:203],v[52:55]
s_waitcnt lgkmcnt(2)
v_mfma_f32_16x16x32_bf16 v[24:27],a[196:199],v[104:107],v[24:27]
ds_read_b128 v[120:123],v7 offset:16384
v_mfma_f32_16x16x32_bf16 v[40:43],v[104:107],v[196:199],v[40:43]
s_waitcnt vmcnt(0)
v_mfma_f32_16x16x32_bf16 v[28:31],a[196:199],v[108:111],v[28:31]
ds_read_b128 v[124:127],v7 offset:20480
v_mfma_f32_16x16x32_bf16 v[44:47],v[108:111],v[196:199],v[44:47]
v_cmp_eq_u32 vcc,0,v76
v_mfma_f32_16x16x32_bf16 v[32:35],a[204:207],v[104:107],v[32:35]
s_nop 0
v_mov_b32 v76,vcc_lo
v_mfma_f32_16x16x32_bf16 v[48:51],v[104:107],v[204:207],v[48:51]
ds_write_b32 v19,v76
v_mfma_f32_16x16x32_bf16 v[36:39],a[204:207],v[108:111],v[36:39]
v_mfma_f32_16x16x32_bf16 v[52:55],v[108:111],v[204:207],v[52:55]
s_waitcnt vmcnt(0) lgkmcnt(0)
s_barrier
s_or_b32 s70,s70,s52
buffer_store_dword v17,off,s[8:11],s70 sc1
ds_read_b32 v76,v16
v_mfma_f32_16x16x32_bf16 v[24:27],a[208:211],v[112:115],v[24:27]
ds_read_b128 v[104:107],v4 offset:24576
v_mfma_f32_16x16x32_bf16 v[40:43],v[112:115],v[208:211],v[40:43]
s_lshl_b32 s56,s51,5
s_add_u32 s56,s56,s47
s_lshl_b32 s56,s56,12
v_mfma_f32_16x16x32_bf16 v[28:31],a[208:211],v[116:119],v[28:31]
ds_read_b128 v[108:111],v4 offset:28672
v_mfma_f32_16x16x32_bf16 v[44:47],v[116:119],v[208:211],v[44:47]
s_add_u32 s56,s56,s50
s_add_u32 s56,s56,58720256
v_mfma_f32_16x16x32_bf16 v[32:35],a[216:219],v[112:115],v[32:35]
v_mov_b64 v[72:73],-1
v_mov_b64 v[74:75],-1
v_mfma_f32_16x16x32_bf16 v[48:51],v[112:115],v[216:219],v[48:51]
buffer_store_dwordx4 v[72:75],v0,s[8:11],s56 offen sc1
v_mfma_f32_16x16x32_bf16 v[36:39],a[216:219],v[116:119],v[36:39]
s_add_u32 s56,s56,16777216
v_mfma_f32_16x16x32_bf16 v[52:55],v[116:119],v[216:219],v[52:55]
buffer_store_dwordx4 v[72:75],v0,s[8:11],s56 offen sc1
s_waitcnt lgkmcnt(2)
v_mfma_f32_16x16x32_bf16 v[24:27],a[212:215],v[120:123],v[24:27]
ds_read_b128 v[112:115],v5 offset:24576
v_mfma_f32_16x16x32_bf16 v[40:43],v[120:123],v[212:215],v[40:43]
v_readfirstlane_b32 s57,v76
v_mfma_f32_16x16x32_bf16 v[28:31],a[212:215],v[124:127],v[28:31]
ds_read_b128 v[116:119],v5 offset:28672
v_mfma_f32_16x16x32_bf16 v[44:47],v[124:127],v[212:215],v[44:47]
s_sub_u32 s59,s55,s54
s_cmp_lt_i32 s59,44
s_cselect_b32 s76,2,0
v_mfma_f32_16x16x32_bf16 v[32:35],a[220:223],v[120:123],v[32:35]
s_cmp_gt_i32 s53,0
s_cselect_b32 s76,s76,0
v_mfma_f32_16x16x32_bf16 v[48:51],v[120:123],v[220:223],v[48:51]
s_cmp_eq_u32 s57,0
s_cselect_b32 s76,1,s76
v_mfma_f32_16x16x32_bf16 v[36:39],a[220:223],v[124:127],v[36:39]
s_cmp_lt_i32 s59,12
s_cselect_b32 s76,2,s76
s_add_u32 s57,s54,64
v_mfma_f32_16x16x32_bf16 v[52:55],v[124:127],v[220:223],v[52:55]
s_cmp_eq_u32 s76,1
s_cselect_b32 s68,s57,s55
s_lshl_b32 s68,s68,15
s_waitcnt lgkmcnt(2)
v_mfma_f32_16x16x32_bf16 v[24:27],a[224:227],v[104:107],v[24:27]
ds_read_b128 v[120:123],v6 offset:24576
v_mfma_f32_16x16x32_bf16 v[40:43],v[104:107],v[224:227],v[40:43]
s_cmp_eq_u32 s76,0
s_cselect_b32 s68,0x80000000,s68
s_add_u32 s69,s68,16384
v_mfma_f32_16x16x32_bf16 v[28:31],a[224:227],v[108:111],v[28:31]
ds_read_b128 v[124:127],v6 offset:28672
v_mfma_f32_16x16x32_bf16 v[44:47],v[108:111],v[224:227],v[44:47]
s_add_u32 m0,s75,65536
v_mfma_f32_16x16x32_bf16 v[32:35],a[232:235],v[104:107],v[32:35]
buffer_load_dwordx4 v20,s[8:11],s68 offen offset:0 sc1 lds
v_mfma_f32_16x16x32_bf16 v[48:51],v[104:107],v[232:235],v[48:51]
s_add_u32 m0,s75,69632
v_mfma_f32_16x16x32_bf16 v[36:39],a[232:235],v[108:111],v[36:39]
buffer_load_dwordx4 v20,s[8:11],s69 offen offset:0 sc1 lds
v_mfma_f32_16x16x32_bf16 v[52:55],v[108:111],v[232:235],v[52:55]
s_add_u32 m0,s75,73472
s_waitcnt lgkmcnt(2)
v_mfma_f32_16x16x32_bf16 v[24:27],a[228:231],v[112:115],v[24:27]
ds_read_b128 v[104:107],v7 offset:24576
v_mfma_f32_16x16x32_bf16 v[40:43],v[112:115],v[228:231],v[40:43]
buffer_load_dwordx4 v20,s[8:11],s68 offen offset:256 sc1 lds
v_mfma_f32_16x16x32_bf16 v[28:31],a[228:231],v[116:119],v[28:31]
ds_read_b128 v[108:111],v7 offset:28672
v_mfma_f32_16x16x32_bf16 v[44:47],v[116:119],v[228:231],v[44:47]
s_add_u32 m0,s75,77568
v_mfma_f32_16x16x32_bf16 v[32:35],a[236:239],v[112:115],v[32:35]
buffer_load_dwordx4 v20,s[8:11],s69 offen offset:256 sc1 lds
v_mfma_f32_16x16x32_bf16 v[48:51],v[112:115],v[236:239],v[48:51]
s_add_u32 m0,s75,81408
v_mfma_f32_16x16x32_bf16 v[36:39],a[236:239],v[116:119],v[36:39]
buffer_load_dwordx4 v20,s[8:11],s68 offen offset:512 sc1 lds
v_mfma_f32_16x16x32_bf16 v[52:55],v[116:119],v[236:239],v[52:55]
s_add_u32 m0,s75,85504
s_waitcnt lgkmcnt(2)
v_mfma_f32_16x16x32_bf16 v[24:27],a[240:243],v[120:123],v[24:27]
ds_read_b128 v[112:115],v4 offset:0
v_mfma_f32_16x16x32_bf16 v[40:43],v[120:123],v[240:243],v[40:43]
buffer_load_dwordx4 v20,s[8:11],s69 offen offset:512 sc1 lds
v_mfma_f32_16x16x32_bf16 v[28:31],a[240:243],v[124:127],v[28:31]
ds_read_b128 v[116:119],v4 offset:4096
v_mfma_f32_16x16x32_bf16 v[44:47],v[124:127],v[240:243],v[44:47]
s_add_u32 m0,s75,89344
v_mfma_f32_16x16x32_bf16 v[32:35],a[248:251],v[120:123],v[32:35]
buffer_load_dwordx4 v20,s[8:11],s68 offen offset:768 sc1 lds
v_mfma_f32_16x16x32_bf16 v[48:51],v[120:123],v[248:251],v[48:51]
s_add_u32 m0,s75,93440
v_mfma_f32_16x16x32_bf16 v[36:39],a[248:251],v[124:127],v[36:39]
buffer_load_dwordx4 v20,s[8:11],s69 offen offset:768 sc1 lds
v_mfma_f32_16x16x32_bf16 v[52:55],v[124:127],v[248:251],v[52:55]
s_waitcnt lgkmcnt(2)
v_mfma_f32_16x16x32_bf16 v[24:27],a[244:247],v[104:107],v[24:27]
ds_read_b128 v[120:123],v5 offset:0
v_mfma_f32_16x16x32_bf16 v[40:43],v[104:107],v[244:247],v[40:43]
v_mfma_f32_16x16x32_bf16 v[28:31],a[244:247],v[108:111],v[28:31]
ds_read_b128 v[124:127],v5 offset:4096
v_mfma_f32_16x16x32_bf16 v[44:47],v[108:111],v[244:247],v[44:47]
v_mfma_f32_16x16x32_bf16 v[32:35],a[252:255],v[104:107],v[32:35]
v_mfma_f32_16x16x32_bf16 v[48:51],v[104:107],v[252:255],v[48:51]
v_mfma_f32_16x16x32_bf16 v[36:39],a[252:255],v[108:111],v[36:39]
v_mfma_f32_16x16x32_bf16 v[52:55],v[108:111],v[252:255],v[52:55]
s_waitcnt lgkmcnt(2)
v_mfma_f32_16x16x32_bf16 v[88:91],a[0:3],v[112:115],0
ds_read_b128 v[104:107],v6 offset:0
v_mfma_f32_16x16x32_bf16 v[92:95],a[0:3],v[116:119],0
v_mfma_f32_16x16x32_bf16 v[96:99],a[8:11],v[112:115],0
ds_read_b128 v[108:111],v6 offset:4096
v_cvt_pk_bf16_f32 v56,v24,v32
v_cvt_pk_bf16_f32 v57,v25,v33
v_mfma_f32_16x16x32_bf16 v[100:103],a[8:11],v[116:119],0
v_cvt_pk_bf16_f32 v58,v26,v34
v_cvt_pk_bf16_f32 v59,v27,v35
s_waitcnt lgkmcnt(2)
v_mfma_f32_16x16x32_bf16 v[88:91],a[4:7],v[120:123],v[88:91]
ds_read_b128 v[112:115],v7 offset:0
v_mfma_f32_16x16x32_bf16 v[92:95],a[4:7],v[124:127],v[92:95]
buffer_store_dwordx4 v[56:59],v0,s[8:11],s61 offen sc1
v_cvt_pk_bf16_f32 v60,v28,v36
v_cvt_pk_bf16_f32 v61,v29,v37
v_mfma_f32_16x16x32_bf16 v[96:99],a[12:15],v[120:123],v[96:99]
ds_read_b128 v[116:119],v7 offset:4096
v_cvt_pk_bf16_f32 v62,v30,v38
v_cvt_pk_bf16_f32 v63,v31,v39
v_mfma_f32_16x16x32_bf16 v[100:103],a[12:15],v[124:127],v[100:103]
buffer_store_dwordx4 v[60:63],v0,s[8:11],s62 offen sc1
v_cvt_pk_bf16_f32 v64,v40,v41
v_cvt_pk_bf16_f32 v65,v42,v43
s_waitcnt lgkmcnt(2)
v_mfma_f32_16x16x32_bf16 v[88:91],a[16:19],v[104:107],v[88:91]
ds_read_b128 v[120:123],v4 offset:8192
v_cvt_pk_bf16_f32 v66,v44,v45
v_cvt_pk_bf16_f32 v67,v46,v47
v_mfma_f32_16x16x32_bf16 v[92:95],a[16:19],v[108:111],v[92:95]
buffer_store_dwordx4 v[64:67],v0,s[8:11],s65 offen offset:0 sc1
v_cvt_pk_bf16_f32 v68,v48,v49
v_cvt_pk_bf16_f32 v69,v50,v51
v_mfma_f32_16x16x32_bf16 v[96:99],a[24:27],v[104:107],v[96:99]
ds_read_b128 v[124:127],v4 offset:12288
v_cvt_pk_bf16_f32 v70,v52,v53
v_cvt_pk_bf16_f32 v71,v54,v55
v_mfma_f32_16x16x32_bf16 v[100:103],a[24:27],v[108:111],v[100:103]
buffer_store_dwordx4 v[68:71],v0,s[8:11],s65 offen offset:1024 sc1
s_waitcnt lgkmcnt(2)
v_mfma_f32_16x16x32_bf16 v[88:91],a[20:23],v[112:115],v[88:91]
ds_read_b128 v[104:107],v5 offset:8192
v_mfma_f32_16x16x32_bf16 v[92:95],a[20:23],v[116:119],v[92:95]
v_mfma_f32_16x16x32_bf16 v[96:99],a[28:31],v[112:115],v[96:99]
ds_read_b128 v[108:111],v5 offset:12288
v_mfma_f32_16x16x32_bf16 v[100:103],a[28:31],v[116:119],v[100:103]
s_waitcnt lgkmcnt(2)
v_mfma_f32_16x16x32_bf16 v[88:91],a[32:35],v[120:123],v[88:91]
ds_read_b128 v[112:115],v6 offset:8192
v_mfma_f32_16x16x32_bf16 v[92:95],a[32:35],v[124:127],v[92:95]
v_mfma_f32_16x16x32_bf16 v[96:99],a[40:43],v[120:123],v[96:99]
ds_read_b128 v[116:119],v6 offset:12288
v_mfma_f32_16x16x32_bf16 v[100:103],a[40:43],v[124:127],v[100:103]
s_waitcnt lgkmcnt(2)
v_mfma_f32_16x16x32_bf16 v[88:91],a[36:39],v[104:107],v[88:91]
ds_read_b128 v[120:123],v7 offset:8192
v_mfma_f32_16x16x32_bf16 v[92:95],a[36:39],v[108:111],v[92:95]
s_lshl_b32 s56,s54,13
v_mfma_f32_16x16x32_bf16 v[96:99],a[44:47],v[104:107],v[96:99]
ds_read_b128 v[124:127],v7 offset:12288
v_mfma_f32_16x16x32_bf16 v[100:103],a[44:47],v[108:111],v[100:103]
s_add_u32 s56,s56,10487552
s_waitcnt lgkmcnt(2)
v_mfma_f32_16x16x32_bf16 v[88:91],a[48:51],v[112:115],v[88:91]
ds_read_b128 v[104:107],v4 offset:16384
v_mfma_f32_16x16x32_bf16 v[92:95],a[48:51],v[116:119],v[92:95]
s_or_b32 s56,s56,s52
v_mfma_f32_16x16x32_bf16 v[96:99],a[56:59],v[112:115],v[96:99]
ds_read_b128 v[108:111],v4 offset:20480
v_mfma_f32_16x16x32_bf16 v[100:103],a[56:59],v[116:119],v[100:103]
buffer_load_dword v76,v23,s[8:11],s56 offen sc1
s_waitcnt lgkmcnt(2)
v_mfma_f32_16x16x32_bf16 v[88:91],a[52:55],v[120:123],v[88:91]
ds_read_b128 v[112:115],v5 offset:16384
v_mfma_f32_16x16x32_bf16 v[92:95],a[52:55],v[124:127],v[92:95]
v_mfma_f32_16x16x32_bf16 v[96:99],a[60:63],v[120:123],v[96:99]
ds_read_b128 v[116:119],v5 offset:20480
v_mfma_f32_16x16x32_bf16 v[100:103],a[60:63],v[124:127],v[100:103]
s_waitcnt lgkmcnt(2)
v_mfma_f32_16x16x32_bf16 v[88:91],a[64:67],v[104:107],v[88:91]
ds_read_b128 v[120:123],v6 offset:16384
v_mfma_f32_16x16x32_bf16 v[92:95],a[64:67],v[108:111],v[92:95]
v_mfma_f32_16x16x32_bf16 v[96:99],a[72:75],v[104:107],v[96:99]
ds_read_b128 v[124:127],v6 offset:20480
v_mfma_f32_16x16x32_bf16 v[100:103],a[72:75],v[108:111],v[100:103]
s_waitcnt lgkmcnt(2)
v_mfma_f32_16x16x32_bf16 v[88:91],a[68:71],v[112:115],v[88:91]
ds_read_b128 v[104:107],v7 offset:16384
v_mfma_f32_16x16x32_bf16 v[92:95],a[68:71],v[116:119],v[92:95]
v_mfma_f32_16x16x32_bf16 v[96:99],a[76:79],v[112:115],v[96:99]
ds_read_b128 v[108:111],v7 offset:20480
v_mfma_f32_16x16x32_bf16 v[100:103],a[76:79],v[116:119],v[100:103]
s_waitcnt lgkmcnt(2)
v_mfma_f32_16x16x32_bf16 v[88:91],a[80:83],v[120:123],v[88:91]
ds_read_b128 v[112:115],v4 offset:24576
v_mfma_f32_16x16x32_bf16 v[92:95],a[80:83],v[124:127],v[92:95]
v_mfma_f32_16x16x32_bf16 v[96:99],a[88:91],v[120:123],v[96:99]
ds_read_b128 v[116:119],v4 offset:28672
v_mfma_f32_16x16x32_bf16 v[100:103],a[88:91],v[124:127],v[100:103]
s_waitcnt lgkmcnt(2)
v_mfma_f32_16x16x32_bf16 v[88:91],a[84:87],v[104:107],v[88:91]
ds_read_b128 v[120:123],v5 offset:24576
v_mfma_f32_16x16x32_bf16 v[92:95],a[84:87],v[108:111],v[92:95]
v_mfma_f32_16x16x32_bf16 v[96:99],a[92:95],v[104:107],v[96:99]
ds_read_b128 v[124:127],v5 offset:28672
v_mfma_f32_16x16x32_bf16 v[100:103],a[92:95],v[108:111],v[100:103]
s_waitcnt lgkmcnt(2)
v_mfma_f32_16x16x32_bf16 v[88:91],a[96:99],v[112:115],v[88:91]
ds_read_b128 v[104:107],v6 offset:24576
v_mfma_f32_16x16x32_bf16 v[92:95],a[96:99],v[116:119],v[92:95]
v_mfma_f32_16x16x32_bf16 v[96:99],a[104:107],v[112:115],v[96:99]
ds_read_b128 v[108:111],v6 offset:28672
v_mfma_f32_16x16x32_bf16 v[100:103],a[104:107],v[116:119],v[100:103]
s_waitcnt lgkmcnt(2)
v_mfma_f32_16x16x32_bf16 v[88:91],a[100:103],v[120:123],v[88:91]
ds_read_b128 v[112:115],v7 offset:24576
v_mfma_f32_16x16x32_bf16 v[92:95],a[100:103],v[124:127],v[92:95]
v_mfma_f32_16x16x32_bf16 v[96:99],a[108:111],v[120:123],v[96:99]
ds_read_b128 v[116:119],v7 offset:28672
v_mfma_f32_16x16x32_bf16 v[100:103],a[108:111],v[124:127],v[100:103]
s_waitcnt lgkmcnt(2)
v_mfma_f32_16x16x32_bf16 v[88:91],a[112:115],v[104:107],v[88:91]
v_mfma_f32_16x16x32_bf16 v[92:95],a[112:115],v[108:111],v[92:95]
v_mfma_f32_16x16x32_bf16 v[96:99],a[120:123],v[104:107],v[96:99]
v_mfma_f32_16x16x32_bf16 v[100:103],a[120:123],v[108:111],v[100:103]
s_waitcnt lgkmcnt(0)
v_mfma_f32_16x16x32_bf16 v[88:91],a[116:119],v[112:115],v[88:91]
v_mfma_f32_16x16x32_bf16 v[92:95],a[116:119],v[116:119],v[92:95]
v_mfma_f32_16x16x32_bf16 v[96:99],a[124:127],v[112:115],v[96:99]
v_mfma_f32_16x16x32_bf16 v[100:103],a[124:127],v[116:119],v[100:103]
s_nop 3
v_cvt_pk_bf16_f32 v104,v88,v96
v_cvt_pk_bf16_f32 v105,v89,v97
v_cvt_pk_bf16_f32 v106,v90,v98
v_cvt_pk_bf16_f32 v107,v91,v99
v_cvt_pk_bf16_f32 v108,v92,v100
v_cvt_pk_bf16_f32 v109,v93,v101
v_cvt_pk_bf16_f32 v110,v94,v102
v_cvt_pk_bf16_f32 v111,v95,v103
buffer_store_dwordx4 v[104:107],v0,s[8:11],s63 offen sc1
buffer_store_dwordx4 v[108:111],v0,s[8:11],s64 offen sc1
s_lshl_b32 s59,s51,13
s_lshl2_add_u32 s59,s47,s59
s_add_u32 s59,s59,10485888
s_waitcnt vmcnt(3)
s_barrier
s_or_b32 s59,s59,s52
buffer_store_dword v17,off,s[8:11],s59 sc1
s_mov_b32 s77,1
s_lshl_b32 s70,s51,13
s_lshl2_add_u32 s70,s47,s70
s_add_u32 s70,s70,10486144
s_branch L_p_21
L_p_20:
s_mov_b32 s75,s74
s_xor_b32 s74,s74,32768
v_xor_b32 v4,32768,v4
v_xor_b32 v5,32768,v5
v_xor_b32 v6,32768,v6
v_xor_b32 v7,32768,v7
ds_read_b128 v[104:107],v4 offset:0
ds_read_b128 v[108:111],v4 offset:4096
ds_read_b128 v[112:115],v5 offset:0
ds_read_b128 v[116:119],v5 offset:4096
s_waitcnt lgkmcnt(2)
v_mfma_f32_16x16x32_bf16 v[24:27],a[128:131],v[104:107],0
ds_read_b128 v[120:123],v6 offset:0
v_mfma_f32_16x16x32_bf16 v[40:43],v[104:107],v[128:131],0
s_lshl_b32 s58,s51,5
v_mfma_f32_16x16x32_bf16 v[28:31],a[128:131],v[108:111],0
ds_read_b128 v[124:127],v6 offset:4096
v_mfma_f32_16x16x32_bf16 v[44:47],v[108:111],v[128:131],0
s_add_u32 s58,s58,s47
v_mfma_f32_16x16x32_bf16 v[32:35],a[136:139],v[104:107],0
s_mul_i32 s58,s58,24576
v_mfma_f32_16x16x32_bf16 v[48:51],v[104:107],v[136:139],0
s_add_u32 s58,s58,150994944
v_mfma_f32_16x16x32_bf16 v[36:39],a[136:139],v[108:111],0
s_add_u32 s61,s58,s50
v_mfma_f32_16x16x32_bf16 v[52:55],v[108:111],v[136:139],0
s_add_u32 s62,s61,4096
s_waitcnt lgkmcnt(2)
v_mfma_f32_16x16x32_bf16 v[24:27],a[132:135],v[112:115],v[24:27]
ds_read_b128 v[104:107],v7 offset:0
v_mfma_f32_16x16x32_bf16 v[40:43],v[112:115],v[132:135],v[40:43]
s_add_u32 s63,s61,16384
v_mfma_f32_16x16x32_bf16 v[28:31],a[132:135],v[116:119],v[28:31]
ds_read_b128 v[108:111],v7 offset:4096
v_mfma_f32_16x16x32_bf16 v[44:47],v[116:119],v[132:135],v[44:47]
s_add_u32 s64,s61,20480
v_mfma_f32_16x16x32_bf16 v[32:35],a[140:143],v[112:115],v[32:35]
s_add_u32 s65,s61,s50
v_mfma_f32_16x16x32_bf16 v[48:51],v[112:115],v[140:143],v[48:51]
s_add_u32 s65,s65,8192
v_mfma_f32_16x16x32_bf16 v[36:39],a[140:143],v[116:119],v[36:39]
v_mfma_f32_16x16x32_bf16 v[52:55],v[116:119],v[140:143],v[52:55]
s_waitcnt lgkmcnt(2)
v_mfma_f32_16x16x32_bf16 v[24:27],a[144:147],v[120:123],v[24:27]
ds_read_b128 v[112:115],v4 offset:8192
v_mfma_f32_16x16x32_bf16 v[40:43],v[120:123],v[144:147],v[40:43]
v_mfma_f32_16x16x32_bf16 v[28:31],a[144:147],v[124:127],v[28:31]
ds_read_b128 v[116:119],v4 offset:12288
v_mfma_f32_16x16x32_bf16 v[44:47],v[124:127],v[144:147],v[44:47]
v_mfma_f32_16x16x32_bf16 v[32:35],a[152:155],v[120:123],v[32:35]
v_mfma_f32_16x16x32_bf16 v[48:51],v[120:123],v[152:155],v[48:51]
v_mfma_f32_16x16x32_bf16 v[36:39],a[152:155],v[124:127],v[36:39]
v_mfma_f32_16x16x32_bf16 v[52:55],v[124:127],v[152:155],v[52:55]
s_waitcnt lgkmcnt(2)
v_mfma_f32_16x16x32_bf16 v[24:27],a[148:151],v[104:107],v[24:27]
ds_read_b128 v[120:123],v5 offset:8192
v_mfma_f32_16x16x32_bf16 v[40:43],v[104:107],v[148:151],v[40:43]
v_mfma_f32_16x16x32_bf16 v[28:31],a[148:151],v[108:111],v[28:31]
ds_read_b128 v[124:127],v5 offset:12288
v_mfma_f32_16x16x32_bf16 v[44:47],v[108:111],v[148:151],v[44:47]
v_mfma_f32_16x16x32_bf16 v[32:35],a[156:159],v[104:107],v[32:35]
v_mfma_f32_16x16x32_bf16 v[48:51],v[104:107],v[156:159],v[48:51]
v_mfma_f32_16x16x32_bf16 v[36:39],a[156:159],v[108:111],v[36:39]
v_mfma_f32_16x16x32_bf16 v[52:55],v[108:111],v[156:159],v[52:55]
s_waitcnt lgkmcnt(2)
v_mfma_f32_16x16x32_bf16 v[24:27],a[160:163],v[112:115],v[24:27]
ds_read_b128 v[104:107],v6 offset:8192
v_mfma_f32_16x16x32_bf16 v[40:43],v[112:115],v[160:163],v[40:43]
v_mfma_f32_16x16x32_bf16 v[28:31],a[160:163],v[116:119],v[28:31]
ds_read_b128 v[108:111],v6 offset:12288
v_mfma_f32_16x16x32_bf16 v[44:47],v[116:119],v[160:163],v[44:47]
v_mfma_f32_16x16x32_bf16 v[32:35],a[168:171],v[112:115],v[32:35]
v_mfma_f32_16x16x32_bf16 v[48:51],v[112:115],v[168:171],v[48:51]
v_mfma_f32_16x16x32_bf16 v[36:39],a[168:171],v[116:119],v[36:39]
v_mfma_f32_16x16x32_bf16 v[52:55],v[116:119],v[168:171],v[52:55]
s_waitcnt lgkmcnt(2)
v_mfma_f32_16x16x32_bf16 v[24:27],a[164:167],v[120:123],v[24:27]
ds_read_b128 v[112:115],v7 offset:8192
v_mfma_f32_16x16x32_bf16 v[40:43],v[120:123],v[164:167],v[40:43]
s_lshl_b32 s56,s54,13
v_mfma_f32_16x16x32_bf16 v[28:31],a[164:167],v[124:127],v[28:31]
ds_read_b128 v[116:119],v7 offset:12288
v_mfma_f32_16x16x32_bf16 v[44:47],v[124:127],v[164:167],v[44:47]
s_add_u32 s56,s56,10487552
v_mfma_f32_16x16x32_bf16 v[32:35],a[172:175],v[120:123],v[32:35]
s_or_b32 s56,s56,s52
v_mfma_f32_16x16x32_bf16 v[48:51],v[120:123],v[172:175],v[48:51]
buffer_load_dword v76,v23,s[8:11],s56 offen sc1
v_mfma_f32_16x16x32_bf16 v[36:39],a[172:175],v[124:127],v[36:39]
v_mfma_f32_16x16x32_bf16 v[52:55],v[124:127],v[172:175],v[52:55]
s_waitcnt lgkmcnt(2)
v_mfma_f32_16x16x32_bf16 v[24:27],a[176:179],v[104:107],v[24:27]
ds_read_b128 v[120:123],v4 offset:16384
v_mfma_f32_16x16x32_bf16 v[40:43],v[104:107],v[176:179],v[40:43]
v_mfma_f32_16x16x32_bf16 v[28:31],a[176:179],v[108:111],v[28:31]
ds_read_b128 v[124:127],v4 offset:20480
v_mfma_f32_16x16x32_bf16 v[44:47],v[108:111],v[176:179],v[44:47]
v_mfma_f32_16x16x32_bf16 v[32:35],a[184:187],v[104:107],v[32:35]
v_mfma_f32_16x16x32_bf16 v[48:51],v[104:107],v[184:187],v[48:51]
v_mfma_f32_16x16x32_bf16 v[36:39],a[184:187],v[108:111],v[36:39]
v_mfma_f32_16x16x32_bf16 v[52:55],v[108:111],v[184:187],v[52:55]
s_waitcnt lgkmcnt(2)
v_mfma_f32_16x16x32_bf16 v[24:27],a[180:183],v[112:115],v[24:27]
ds_read_b128 v[104:107],v5 offset:16384
v_mfma_f32_16x16x32_bf16 v[40:43],v[112:115],v[180:183],v[40:43]
v_mfma_f32_16x16x32_bf16 v[28:31],a[180:183],v[116:119],v[28:31]
ds_read_b128 v[108:111],v5 offset:20480
v_mfma_f32_16x16x32_bf16 v[44:47],v[116:119],v[180:183],v[44:47]
v_mfma_f32_16x16x32_bf16 v[32:35],a[188:191],v[112:115],v[32:35]
v_mfma_f32_16x16x32_bf16 v[48:51],v[112:115],v[188:191],v[48:51]
v_mfma_f32_16x16x32_bf16 v[36:39],a[188:191],v[116:119],v[36:39]
v_mfma_f32_16x16x32_bf16 v[52:55],v[116:119],v[188:191],v[52:55]
s_waitcnt lgkmcnt(2)
v_mfma_f32_16x16x32_bf16 v[24:27],a[192:195],v[120:123],v[24:27]
ds_read_b128 v[112:115],v6 offset:16384
v_mfma_f32_16x16x32_bf16 v[40:43],v[120:123],v[192:195],v[40:43]
v_mfma_f32_16x16x32_bf16 v[28:31],a[192:195],v[124:127],v[28:31]
ds_read_b128 v[116:119],v6 offset:20480
v_mfma_f32_16x16x32_bf16 v[44:47],v[124:127],v[192:195],v[44:47]
v_mfma_f32_16x16x32_bf16 v[32:35],a[200:203],v[120:123],v[32:35]
v_mfma_f32_16x16x32_bf16 v[48:51],v[120:123],v[200:203],v[48:51]
v_mfma_f32_16x16x32_bf16 v[36:39],a[200:203],v[124:127],v[36:39]
v_mfma_f32_16x16x32_bf16 v[52:55],v[124:127],v[200:203],v[52:55]
s_waitcnt lgkmcnt(2)
v_mfma_f32_16x16x32_bf16 v[24:27],a[196:199],v[104:107],v[24:27]
ds_read_b128 v[120:123],v7 offset:16384
v_mfma_f32_16x16x32_bf16 v[40:43],v[104:107],v[196:199],v[40:43]
s_waitcnt vmcnt(0)
v_mfma_f32_16x16x32_bf16 v[28:31],a[196:199],v[108:111],v[28:31]
ds_read_b128 v[124:127],v7 offset:20480
v_mfma_f32_16x16x32_bf16 v[44:47],v[108:111],v[196:199],v[44:47]
v_cmp_eq_u32 vcc,0,v76
v_mfma_f32_16x16x32_bf16 v[32:35],a[204:207],v[104:107],v[32:35]
s_nop 0
v_mov_b32 v76,vcc_lo
v_mfma_f32_16x16x32_bf16 v[48:51],v[104:107],v[204:207],v[48:51]
ds_write_b32 v19,v76
v_mfma_f32_16x16x32_bf16 v[36:39],a[204:207],v[108:111],v[36:39]
v_mfma_f32_16x16x32_bf16 v[52:55],v[108:111],v[204:207],v[52:55]
s_waitcnt vmcnt(0) lgkmcnt(0)
s_barrier
s_or_b32 s70,s70,s52
buffer_store_dword v17,off,s[8:11],s70 sc1
ds_read_b32 v76,v16
v_mfma_f32_16x16x32_bf16 v[24:27],a[208:211],v[112:115],v[24:27]
ds_read_b128 v[104:107],v4 offset:24576
v_mfma_f32_16x16x32_bf16 v[40:43],v[112:115],v[208:211],v[40:43]
s_lshl_b32 s56,s51,5
s_add_u32 s56,s56,s47
s_lshl_b32 s56,s56,12
v_mfma_f32_16x16x32_bf16 v[28:31],a[208:211],v[116:119],v[28:31]
ds_read_b128 v[108:111],v4 offset:28672
v_mfma_f32_16x16x32_bf16 v[44:47],v[116:119],v[208:211],v[44:47]
s_add_u32 s56,s56,s50
s_add_u32 s56,s56,58720256
v_mfma_f32_16x16x32_bf16 v[32:35],a[216:219],v[112:115],v[32:35]
v_mov_b64 v[72:73],-1
v_mov_b64 v[74:75],-1
v_mfma_f32_16x16x32_bf16 v[48:51],v[112:115],v[216:219],v[48:51]
buffer_store_dwordx4 v[72:75],v0,s[8:11],s56 offen sc1
v_mfma_f32_16x16x32_bf16 v[36:39],a[216:219],v[116:119],v[36:39]
s_add_u32 s56,s56,16777216
v_mfma_f32_16x16x32_bf16 v[52:55],v[116:119],v[216:219],v[52:55]
buffer_store_dwordx4 v[72:75],v0,s[8:11],s56 offen sc1
s_waitcnt lgkmcnt(2)
v_mfma_f32_16x16x32_bf16 v[24:27],a[212:215],v[120:123],v[24:27]
ds_read_b128 v[112:115],v5 offset:24576
v_mfma_f32_16x16x32_bf16 v[40:43],v[120:123],v[212:215],v[40:43]
v_readfirstlane_b32 s57,v76
v_mfma_f32_16x16x32_bf16 v[28:31],a[212:215],v[124:127],v[28:31]
ds_read_b128 v[116:119],v5 offset:28672
v_mfma_f32_16x16x32_bf16 v[44:47],v[124:127],v[212:215],v[44:47]
s_sub_u32 s59,s55,s54
s_cmp_lt_i32 s59,44
s_cselect_b32 s76,2,0
v_mfma_f32_16x16x32_bf16 v[32:35],a[220:223],v[120:123],v[32:35]
s_cmp_gt_i32 s53,0
s_cselect_b32 s76,s76,0
v_mfma_f32_16x16x32_bf16 v[48:51],v[120:123],v[220:223],v[48:51]
s_cmp_eq_u32 s57,0
s_cselect_b32 s76,1,s76
v_mfma_f32_16x16x32_bf16 v[36:39],a[220:223],v[124:127],v[36:39]
s_cmp_lt_i32 s59,12
s_cselect_b32 s76,2,s76
s_add_u32 s57,s54,64
v_mfma_f32_16x16x32_bf16 v[52:55],v[124:127],v[220:223],v[52:55]
s_cmp_eq_u32 s76,1
s_cselect_b32 s68,s57,s55
s_lshl_b32 s68,s68,15
s_waitcnt lgkmcnt(2)
v_mfma_f32_16x16x32_bf16 v[24:27],a[224:227],v[104:107],v[24:27]
ds_read_b128 v[120:123],v6 offset:24576
v_mfma_f32_16x16x32_bf16 v[40:43],v[104:107],v[224:227],v[40:43]
s_cmp_eq_u32 s76,0
s_cselect_b32 s68,0x80000000,s68
s_add_u32 s69,s68,16384
v_mfma_f32_16x16x32_bf16 v[28:31],a[224:227],v[108:111],v[28:31]
ds_read_b128 v[124:127],v6 offset:28672
v_mfma_f32_16x16x32_bf16 v[44:47],v[108:111],v[224:227],v[44:47]
s_add_u32 m0,s75,65536
v_mfma_f32_16x16x32_bf16 v[32:35],a[232:235],v[104:107],v[32:35]
buffer_load_dwordx4 v20,s[8:11],s68 offen offset:0 sc1 lds
v_mfma_f32_16x16x32_bf16 v[48:51],v[104:107],v[232:235],v[48:51]
s_add_u32 m0,s75,69632
v_mfma_f32_16x16x32_bf16 v[36:39],a[232:235],v[108:111],v[36:39]
buffer_load_dwordx4 v20,s[8:11],s69 offen offset:0 sc1 lds
v_mfma_f32_16x16x32_bf16 v[52:55],v[108:111],v[232:235],v[52:55]
s_add_u32 m0,s75,73472
s_waitcnt lgkmcnt(2)
v_mfma_f32_16x16x32_bf16 v[24:27],a[228:231],v[112:115],v[24:27]
ds_read_b128 v[104:107],v7 offset:24576
v_mfma_f32_16x16x32_bf16 v[40:43],v[112:115],v[228:231],v[40:43]
buffer_load_dwordx4 v20,s[8:11],s68 offen offset:256 sc1 lds
v_mfma_f32_16x16x32_bf16 v[28:31],a[228:231],v[116:119],v[28:31]
ds_read_b128 v[108:111],v7 offset:28672
v_mfma_f32_16x16x32_bf16 v[44:47],v[116:119],v[228:231],v[44:47]
s_add_u32 m0,s75,77568
v_mfma_f32_16x16x32_bf16 v[32:35],a[236:239],v[112:115],v[32:35]
buffer_load_dwordx4 v20,s[8:11],s69 offen offset:256 sc1 lds
v_mfma_f32_16x16x32_bf16 v[48:51],v[112:115],v[236:239],v[48:51]
s_add_u32 m0,s75,81408
v_mfma_f32_16x16x32_bf16 v[36:39],a[236:239],v[116:119],v[36:39]
buffer_load_dwordx4 v20,s[8:11],s68 offen offset:512 sc1 lds
v_mfma_f32_16x16x32_bf16 v[52:55],v[116:119],v[236:239],v[52:55]
s_add_u32 m0,s75,85504
s_waitcnt lgkmcnt(2)
v_mfma_f32_16x16x32_bf16 v[24:27],a[240:243],v[120:123],v[24:27]
ds_read_b128 v[112:115],v4 offset:0
v_mfma_f32_16x16x32_bf16 v[40:43],v[120:123],v[240:243],v[40:43]
buffer_load_dwordx4 v20,s[8:11],s69 offen offset:512 sc1 lds
v_mfma_f32_16x16x32_bf16 v[28:31],a[240:243],v[124:127],v[28:31]
ds_read_b128 v[116:119],v4 offset:4096
v_mfma_f32_16x16x32_bf16 v[44:47],v[124:127],v[240:243],v[44:47]
s_add_u32 m0,s75,89344
v_mfma_f32_16x16x32_bf16 v[32:35],a[248:251],v[120:123],v[32:35]
buffer_load_dwordx4 v20,s[8:11],s68 offen offset:768 sc1 lds
v_mfma_f32_16x16x32_bf16 v[48:51],v[120:123],v[248:251],v[48:51]
s_add_u32 m0,s75,93440
v_mfma_f32_16x16x32_bf16 v[36:39],a[248:251],v[124:127],v[36:39]
buffer_load_dwordx4 v20,s[8:11],s69 offen offset:768 sc1 lds
v_mfma_f32_16x16x32_bf16 v[52:55],v[124:127],v[248:251],v[52:55]
s_waitcnt lgkmcnt(2)
v_mfma_f32_16x16x32_bf16 v[24:27],a[244:247],v[104:107],v[24:27]
ds_read_b128 v[120:123],v5 offset:0
v_mfma_f32_16x16x32_bf16 v[40:43],v[104:107],v[244:247],v[40:43]
v_mfma_f32_16x16x32_bf16 v[28:31],a[244:247],v[108:111],v[28:31]
ds_read_b128 v[124:127],v5 offset:4096
v_mfma_f32_16x16x32_bf16 v[44:47],v[108:111],v[244:247],v[44:47]
v_mfma_f32_16x16x32_bf16 v[32:35],a[252:255],v[104:107],v[32:35]
v_mfma_f32_16x16x32_bf16 v[48:51],v[104:107],v[252:255],v[48:51]
v_mfma_f32_16x16x32_bf16 v[36:39],a[252:255],v[108:111],v[36:39]
v_mfma_f32_16x16x32_bf16 v[52:55],v[108:111],v[252:255],v[52:55]
s_waitcnt lgkmcnt(2)
v_mfma_f32_16x16x32_bf16 v[88:91],a[0:3],v[112:115],0
ds_read_b128 v[104:107],v6 offset:0
v_mfma_f32_16x16x32_bf16 v[92:95],a[0:3],v[116:119],0
v_mfma_f32_16x16x32_bf16 v[96:99],a[8:11],v[112:115],0
ds_read_b128 v[108:111],v6 offset:4096
v_cvt_pk_bf16_f32 v56,v24,v32
v_cvt_pk_bf16_f32 v57,v25,v33
v_mfma_f32_16x16x32_bf16 v[100:103],a[8:11],v[116:119],0
v_cvt_pk_bf16_f32 v58,v26,v34
v_cvt_pk_bf16_f32 v59,v27,v35
s_waitcnt lgkmcnt(2)
v_mfma_f32_16x16x32_bf16 v[88:91],a[4:7],v[120:123],v[88:91]
ds_read_b128 v[112:115],v7 offset:0
v_mfma_f32_16x16x32_bf16 v[92:95],a[4:7],v[124:127],v[92:95]
buffer_store_dwordx4 v[56:59],v0,s[8:11],s61 offen sc1
v_cvt_pk_bf16_f32 v60,v28,v36
v_cvt_pk_bf16_f32 v61,v29,v37
v_mfma_f32_16x16x32_bf16 v[96:99],a[12:15],v[120:123],v[96:99]
ds_read_b128 v[116:119],v7 offset:4096
v_cvt_pk_bf16_f32 v62,v30,v38
v_cvt_pk_bf16_f32 v63,v31,v39
v_mfma_f32_16x16x32_bf16 v[100:103],a[12:15],v[124:127],v[100:103]
buffer_store_dwordx4 v[60:63],v0,s[8:11],s62 offen sc1
v_cvt_pk_bf16_f32 v64,v40,v41
v_cvt_pk_bf16_f32 v65,v42,v43
s_waitcnt lgkmcnt(2)
v_mfma_f32_16x16x32_bf16 v[88:91],a[16:19],v[104:107],v[88:91]
ds_read_b128 v[120:123],v4 offset:8192
v_cvt_pk_bf16_f32 v66,v44,v45
v_cvt_pk_bf16_f32 v67,v46,v47
v_mfma_f32_16x16x32_bf16 v[92:95],a[16:19],v[108:111],v[92:95]
buffer_store_dwordx4 v[64:67],v0,s[8:11],s65 offen offset:0 sc1
v_cvt_pk_bf16_f32 v68,v48,v49
v_cvt_pk_bf16_f32 v69,v50,v51
v_mfma_f32_16x16x32_bf16 v[96:99],a[24:27],v[104:107],v[96:99]
ds_read_b128 v[124:127],v4 offset:12288
v_cvt_pk_bf16_f32 v70,v52,v53
v_cvt_pk_bf16_f32 v71,v54,v55
v_mfma_f32_16x16x32_bf16 v[100:103],a[24:27],v[108:111],v[100:103]
buffer_store_dwordx4 v[68:71],v0,s[8:11],s65 offen offset:1024 sc1
s_waitcnt lgkmcnt(2)
v_mfma_f32_16x16x32_bf16 v[88:91],a[20:23],v[112:115],v[88:91]
ds_read_b128 v[104:107],v5 offset:8192
v_mfma_f32_16x16x32_bf16 v[92:95],a[20:23],v[116:119],v[92:95]
v_mfma_f32_16x16x32_bf16 v[96:99],a[28:31],v[112:115],v[96:99]
ds_read_b128 v[108:111],v5 offset:12288
v_mfma_f32_16x16x32_bf16 v[100:103],a[28:31],v[116:119],v[100:103]
s_waitcnt lgkmcnt(2)
v_mfma_f32_16x16x32_bf16 v[88:91],a[32:35],v[120:123],v[88:91]
ds_read_b128 v[112:115],v6 offset:8192
v_mfma_f32_16x16x32_bf16 v[92:95],a[32:35],v[124:127],v[92:95]
v_mfma_f32_16x16x32_bf16 v[96:99],a[40:43],v[120:123],v[96:99]
ds_read_b128 v[116:119],v6 offset:12288
v_mfma_f32_16x16x32_bf16 v[100:103],a[40:43],v[124:127],v[100:103]
s_waitcnt lgkmcnt(2)
v_mfma_f32_16x16x32_bf16 v[88:91],a[36:39],v[104:107],v[88:91]
ds_read_b128 v[120:123],v7 offset:8192
v_mfma_f32_16x16x32_bf16 v[92:95],a[36:39],v[108:111],v[92:95]
s_lshl_b32 s56,s54,13
v_mfma_f32_16x16x32_bf16 v[96:99],a[44:47],v[104:107],v[96:99]
ds_read_b128 v[124:127],v7 offset:12288
v_mfma_f32_16x16x32_bf16 v[100:103],a[44:47],v[108:111],v[100:103]
s_add_u32 s56,s56,10487552
s_waitcnt lgkmcnt(2)
v_mfma_f32_16x16x32_bf16 v[88:91],a[48:51],v[112:115],v[88:91]
ds_read_b128 v[104:107],v4 offset:16384
v_mfma_f32_16x16x32_bf16 v[92:95],a[48:51],v[116:119],v[92:95]
s_or_b32 s56,s56,s52
v_mfma_f32_16x16x32_bf16 v[96:99],a[56:59],v[112:115],v[96:99]
ds_read_b128 v[108:111],v4 offset:20480
v_mfma_f32_16x16x32_bf16 v[100:103],a[56:59],v[116:119],v[100:103]
buffer_load_dword v76,v23,s[8:11],s56 offen sc1
s_waitcnt lgkmcnt(2)
v_mfma_f32_16x16x32_bf16 v[88:91],a[52:55],v[120:123],v[88:91]
ds_read_b128 v[112:115],v5 offset:16384
v_mfma_f32_16x16x32_bf16 v[92:95],a[52:55],v[124:127],v[92:95]
v_mfma_f32_16x16x32_bf16 v[96:99],a[60:63],v[120:123],v[96:99]
ds_read_b128 v[116:119],v5 offset:20480
v_mfma_f32_16x16x32_bf16 v[100:103],a[60:63],v[124:127],v[100:103]
s_waitcnt lgkmcnt(2)
v_mfma_f32_16x16x32_bf16 v[88:91],a[64:67],v[104:107],v[88:91]
ds_read_b128 v[120:123],v6 offset:16384
v_mfma_f32_16x16x32_bf16 v[92:95],a[64:67],v[108:111],v[92:95]
v_mfma_f32_16x16x32_bf16 v[96:99],a[72:75],v[104:107],v[96:99]
ds_read_b128 v[124:127],v6 offset:20480
v_mfma_f32_16x16x32_bf16 v[100:103],a[72:75],v[108:111],v[100:103]
s_waitcnt lgkmcnt(2)
v_mfma_f32_16x16x32_bf16 v[88:91],a[68:71],v[112:115],v[88:91]
ds_read_b128 v[104:107],v7 offset:16384
v_mfma_f32_16x16x32_bf16 v[92:95],a[68:71],v[116:119],v[92:95]
v_mfma_f32_16x16x32_bf16 v[96:99],a[76:79],v[112:115],v[96:99]
ds_read_b128 v[108:111],v7 offset:20480
v_mfma_f32_16x16x32_bf16 v[100:103],a[76:79],v[116:119],v[100:103]
s_waitcnt lgkmcnt(2)
v_mfma_f32_16x16x32_bf16 v[88:91],a[80:83],v[120:123],v[88:91]
ds_read_b128 v[112:115],v4 offset:24576
v_mfma_f32_16x16x32_bf16 v[92:95],a[80:83],v[124:127],v[92:95]
v_mfma_f32_16x16x32_bf16 v[96:99],a[88:91],v[120:123],v[96:99]
ds_read_b128 v[116:119],v4 offset:28672
v_mfma_f32_16x16x32_bf16 v[100:103],a[88:91],v[124:127],v[100:103]
s_waitcnt lgkmcnt(2)
v_mfma_f32_16x16x32_bf16 v[88:91],a[84:87],v[104:107],v[88:91]
ds_read_b128 v[120:123],v5 offset:24576
v_mfma_f32_16x16x32_bf16 v[92:95],a[84:87],v[108:111],v[92:95]
v_mfma_f32_16x16x32_bf16 v[96:99],a[92:95],v[104:107],v[96:99]
ds_read_b128 v[124:127],v5 offset:28672
v_mfma_f32_16x16x32_bf16 v[100:103],a[92:95],v[108:111],v[100:103]
s_waitcnt lgkmcnt(2)
v_mfma_f32_16x16x32_bf16 v[88:91],a[96:99],v[112:115],v[88:91]
ds_read_b128 v[104:107],v6 offset:24576
v_mfma_f32_16x16x32_bf16 v[92:95],a[96:99],v[116:119],v[92:95]
v_mfma_f32_16x16x32_bf16 v[96:99],a[104:107],v[112:115],v[96:99]
ds_read_b128 v[108:111],v6 offset:28672
v_mfma_f32_16x16x32_bf16 v[100:103],a[104:107],v[116:119],v[100:103]
s_waitcnt lgkmcnt(2)
v_mfma_f32_16x16x32_bf16 v[88:91],a[100:103],v[120:123],v[88:91]
ds_read_b128 v[112:115],v7 offset:24576
v_mfma_f32_16x16x32_bf16 v[92:95],a[100:103],v[124:127],v[92:95]
v_mfma_f32_16x16x32_bf16 v[96:99],a[108:111],v[120:123],v[96:99]
ds_read_b128 v[116:119],v7 offset:28672
v_mfma_f32_16x16x32_bf16 v[100:103],a[108:111],v[124:127],v[100:103]
s_waitcnt lgkmcnt(2)
v_mfma_f32_16x16x32_bf16 v[88:91],a[112:115],v[104:107],v[88:91]
v_mfma_f32_16x16x32_bf16 v[92:95],a[112:115],v[108:111],v[92:95]
v_mfma_f32_16x16x32_bf16 v[96:99],a[120:123],v[104:107],v[96:99]
v_mfma_f32_16x16x32_bf16 v[100:103],a[120:123],v[108:111],v[100:103]
s_waitcnt lgkmcnt(0)
v_mfma_f32_16x16x32_bf16 v[88:91],a[116:119],v[112:115],v[88:91]
v_mfma_f32_16x16x32_bf16 v[92:95],a[116:119],v[116:119],v[92:95]
v_mfma_f32_16x16x32_bf16 v[96:99],a[124:127],v[112:115],v[96:99]
v_mfma_f32_16x16x32_bf16 v[100:103],a[124:127],v[116:119],v[100:103]
s_nop 3
v_cvt_pk_bf16_f32 v104,v88,v96
v_cvt_pk_bf16_f32 v105,v89,v97
v_cvt_pk_bf16_f32 v106,v90,v98
v_cvt_pk_bf16_f32 v107,v91,v99
v_cvt_pk_bf16_f32 v108,v92,v100
v_cvt_pk_bf16_f32 v109,v93,v101
v_cvt_pk_bf16_f32 v110,v94,v102
v_cvt_pk_bf16_f32 v111,v95,v103
buffer_store_dwordx4 v[104:107],v0,s[8:11],s63 offen sc1
buffer_store_dwordx4 v[108:111],v0,s[8:11],s64 offen sc1
s_lshl_b32 s59,s51,13
s_lshl2_add_u32 s59,s47,s59
s_add_u32 s59,s59,10485888
s_waitcnt vmcnt(3)
s_barrier
s_or_b32 s59,s59,s52
buffer_store_dword v17,off,s[8:11],s59 sc1
s_mov_b32 s77,1
s_lshl_b32 s70,s51,13
s_lshl2_add_u32 s70,s47,s70
s_add_u32 s70,s70,10486144
s_branch L_p_21
L_p_22:
s_endpgm
L_rm_5:
v_and_b32 v33,15,v1
v_lshrrev_b32 v34,4,v1
s_min_u32 s60,s47,27
s_lshl_b32 s60,s60,7
s_mul_i32 s59,s46,458752
s_add_u32 s60,s60,s59
v_mul_u32_u24 v36,114688,v34
v_and_b32 v35,7,v33
v_lshl_add_u32 v36,v35,4,v36
v_add_u32 v36,s60,v36
v_cmp_gt_u32 vcc,8,v33
v_mov_b32 v38,s36
v_mov_b32 v39,s37
v_mov_b32 v40,s34
v_mov_b32 v41,s35
v_cndmask_b32 v38,v38,v40,vcc
v_cndmask_b32 v39,v39,v41,vcc
v_add_co_u32 v38,vcc,v38,v36
s_nop 1
v_addc_co_u32 v39,vcc,0,v39,vcc
s_lshl_b32 s56,s46,15
v_add_u32 v37,s56,v0
global_load_dwordx4 v[44:47],v[38:39],off
v_add_co_u32 v38,vcc,3584,v38
s_nop 1
v_addc_co_u32 v39,vcc,0,v39,vcc
global_load_dwordx4 v[48:51],v[38:39],off
v_add_co_u32 v38,vcc,3584,v38
s_nop 1
v_addc_co_u32 v39,vcc,0,v39,vcc
global_load_dwordx4 v[52:55],v[38:39],off
v_add_co_u32 v38,vcc,3584,v38
s_nop 1
v_addc_co_u32 v39,vcc,0,v39,vcc
global_load_dwordx4 v[56:59],v[38:39],off
v_add_co_u32 v38,vcc,3584,v38
s_nop 1
v_addc_co_u32 v39,vcc,0,v39,vcc
global_load_dwordx4 v[60:63],v[38:39],off
v_add_co_u32 v38,vcc,3584,v38
s_nop 1
v_addc_co_u32 v39,vcc,0,v39,vcc
global_load_dwordx4 v[64:67],v[38:39],off
v_add_co_u32 v38,vcc,3584,v38
s_nop 1
v_addc_co_u32 v39,vcc,0,v39,vcc
global_load_dwordx4 v[68:71],v[38:39],off
v_add_co_u32 v38,vcc,3584,v38
s_nop 1
v_addc_co_u32 v39,vcc,0,v39,vcc
global_load_dwordx4 v[72:75],v[38:39],off
v_add_co_u32 v38,vcc,3584,v38
s_nop 1
v_addc_co_u32 v39,vcc,0,v39,vcc
global_load_dwordx4 v[76:79],v[38:39],off
v_add_co_u32 v38,vcc,3584,v38
s_nop 1
v_addc_co_u32 v39,vcc,0,v39,vcc
global_load_dwordx4 v[80:83],v[38:39],off
v_add_co_u32 v38,vcc,3584,v38
s_nop 1
v_addc_co_u32 v39,vcc,0,v39,vcc
global_load_dwordx4 v[84:87],v[38:39],off
v_add_co_u32 v38,vcc,3584,v38
s_nop 1
v_addc_co_u32 v39,vcc,0,v39,vcc
global_load_dwordx4 v[88:91],v[38:39],off
v_add_co_u32 v38,vcc,3584,v38
s_nop 1
v_addc_co_u32 v39,vcc,0,v39,vcc
global_load_dwordx4 v[92:95],v[38:39],off
v_add_co_u32 v38,vcc,3584,v38
s_nop 1
v_addc_co_u32 v39,vcc,0,v39,vcc
global_load_dwordx4 v[96:99],v[38:39],off
v_add_co_u32 v38,vcc,3584,v38
s_nop 1
v_addc_co_u32 v39,vcc,0,v39,vcc
global_load_dwordx4 v[100:103],v[38:39],off
v_add_co_u32 v38,vcc,3584,v38
s_nop 1
v_addc_co_u32 v39,vcc,0,v39,vcc
global_load_dwordx4 v[104:107],v[38:39],off
v_add_co_u32 v38,vcc,3584,v38
s_nop 1
v_addc_co_u32 v39,vcc,0,v39,vcc
s_waitcnt vmcnt(15)
ds_write_b128 v37,v[44:47] offset:0
s_waitcnt vmcnt(14)
ds_write_b128 v37,v[48:51] offset:1024
s_waitcnt vmcnt(13)
ds_write_b128 v37,v[52:55] offset:2048
s_waitcnt vmcnt(12)
ds_write_b128 v37,v[56:59] offset:3072
s_waitcnt vmcnt(11)
ds_write_b128 v37,v[60:63] offset:4096
s_waitcnt vmcnt(10)
ds_write_b128 v37,v[64:67] offset:5120
s_waitcnt vmcnt(9)
ds_write_b128 v37,v[68:71] offset:6144
s_waitcnt vmcnt(8)
ds_write_b128 v37,v[72:75] offset:7168
s_waitcnt lgkmcnt(0)
s_waitcnt vmcnt(7)
ds_write_b128 v37,v[76:79] offset:8192
s_waitcnt vmcnt(6)
ds_write_b128 v37,v[80:83] offset:9216
s_waitcnt vmcnt(5)
ds_write_b128 v37,v[84:87] offset:10240
s_waitcnt vmcnt(4)
ds_write_b128 v37,v[88:91] offset:11264
s_waitcnt vmcnt(3)
ds_write_b128 v37,v[92:95] offset:12288
s_waitcnt vmcnt(2)
ds_write_b128 v37,v[96:99] offset:13312
s_waitcnt vmcnt(1)
ds_write_b128 v37,v[100:103] offset:14336
s_waitcnt vmcnt(0)
ds_write_b128 v37,v[104:107] offset:15360
s_waitcnt lgkmcnt(0)
global_load_dwordx4 v[44:47],v[38:39],off
v_add_co_u32 v38,vcc,3584,v38
s_nop 1
v_addc_co_u32 v39,vcc,0,v39,vcc
global_load_dwordx4 v[48:51],v[38:39],off
v_add_co_u32 v38,vcc,3584,v38
s_nop 1
v_addc_co_u32 v39,vcc,0,v39,vcc
global_load_dwordx4 v[52:55],v[38:39],off
v_add_co_u32 v38,vcc,3584,v38
s_nop 1
v_addc_co_u32 v39,vcc,0,v39,vcc
global_load_dwordx4 v[56:59],v[38:39],off
v_add_co_u32 v38,vcc,3584,v38
s_nop 1
v_addc_co_u32 v39,vcc,0,v39,vcc
global_load_dwordx4 v[60:63],v[38:39],off
v_add_co_u32 v38,vcc,3584,v38
s_nop 1
v_addc_co_u32 v39,vcc,0,v39,vcc
global_load_dwordx4 v[64:67],v[38:39],off
v_add_co_u32 v38,vcc,3584,v38
s_nop 1
v_addc_co_u32 v39,vcc,0,v39,vcc
global_load_dwordx4 v[68:71],v[38:39],off
v_add_co_u32 v38,vcc,3584,v38
s_nop 1
v_addc_co_u32 v39,vcc,0,v39,vcc
global_load_dwordx4 v[72:75],v[38:39],off
v_add_co_u32 v38,vcc,3584,v38
s_nop 1
v_addc_co_u32 v39,vcc,0,v39,vcc
global_load_dwordx4 v[76:79],v[38:39],off
v_add_co_u32 v38,vcc,3584,v38
s_nop 1
v_addc_co_u32 v39,vcc,0,v39,vcc
global_load_dwordx4 v[80:83],v[38:39],off
v_add_co_u32 v38,vcc,3584,v38
s_nop 1
v_addc_co_u32 v39,vcc,0,v39,vcc
global_load_dwordx4 v[84:87],v[38:39],off
v_add_co_u32 v38,vcc,3584,v38
s_nop 1
v_addc_co_u32 v39,vcc,0,v39,vcc
global_load_dwordx4 v[88:91],v[38:39],off
v_add_co_u32 v38,vcc,3584,v38
s_nop 1
v_addc_co_u32 v39,vcc,0,v39,vcc
global_load_dwordx4 v[92:95],v[38:39],off
v_add_co_u32 v38,vcc,3584,v38
s_nop 1
v_addc_co_u32 v39,vcc,0,v39,vcc
global_load_dwordx4 v[96:99],v[38:39],off
v_add_co_u32 v38,vcc,3584,v38
s_nop 1
v_addc_co_u32 v39,vcc,0,v39,vcc
global_load_dwordx4 v[100:103],v[38:39],off
v_add_co_u32 v38,vcc,3584,v38
s_nop 1
v_addc_co_u32 v39,vcc,0,v39,vcc
global_load_dwordx4 v[104:107],v[38:39],off
v_add_co_u32 v38,vcc,3584,v38
s_nop 1
v_addc_co_u32 v39,vcc,0,v39,vcc
s_waitcnt vmcnt(15)
ds_write_b128 v37,v[44:47] offset:16384
s_waitcnt vmcnt(14)
ds_write_b128 v37,v[48:51] offset:17408
s_waitcnt vmcnt(13)
ds_write_b128 v37,v[52:55] offset:18432
s_waitcnt vmcnt(12)
ds_write_b128 v37,v[56:59] offset:19456
s_waitcnt vmcnt(11)
ds_write_b128 v37,v[60:63] offset:20480
s_waitcnt vmcnt(10)
ds_write_b128 v37,v[64:67] offset:21504
s_waitcnt vmcnt(9)
ds_write_b128 v37,v[68:71] offset:22528
s_waitcnt vmcnt(8)
ds_write_b128 v37,v[72:75] offset:23552
s_waitcnt lgkmcnt(0)
s_waitcnt vmcnt(7)
ds_write_b128 v37,v[76:79] offset:24576
s_waitcnt vmcnt(6)
ds_write_b128 v37,v[80:83] offset:25600
s_waitcnt vmcnt(5)
ds_write_b128 v37,v[84:87] offset:26624
s_waitcnt vmcnt(4)
ds_write_b128 v37,v[88:91] offset:27648
s_waitcnt vmcnt(3)
ds_write_b128 v37,v[92:95] offset:28672
s_waitcnt vmcnt(2)
ds_write_b128 v37,v[96:99] offset:29696
s_waitcnt vmcnt(1)
ds_write_b128 v37,v[100:103] offset:30720
s_waitcnt vmcnt(0)
ds_write_b128 v37,v[104:107] offset:31744
s_waitcnt lgkmcnt(0)
v_mov_b32 v123,159744
s_cmp_lg_u32 s46,0
s_cbranch_scc1 L_gbd_29
v_mov_b32 v124,128
L_gb_28:
buffer_load_dword v125,v124,s[12:15],0 offen sc1
s_waitcnt vmcnt(0)
v_readfirstlane_b32 s56,v125
ds_write_b32 v123,v125
s_bitcmp1_b32 s56,8
s_cbranch_scc1 L_gbd_29
s_sleep 4
s_sub_u32 s49,s49,1
s_cmp_gt_i32 s49,0
s_cbranch_scc1 L_gb_28
s_branch L_abort
L_gbd_29:
s_waitcnt lgkmcnt(0)
s_barrier
ds_read_b32 v125,v123
s_waitcnt lgkmcnt(0)
v_readfirstlane_b32 s56,v125
s_barrier
s_lshr_b32 s56,s56,16
s_andn2_b32 s56,s56,s3
s_cbranch_scc1 L_spread
s_cmp_lg_u32 s3,0
s_cbranch_scc1 L_wm
v_and_b32 v120,15,v1
v_lshrrev_b32 v121,4,v1
v_mov_b32 v17,1
s_lshl_b32 s56,s46,15
v_add_u32 v18,s56,v0
s_lshl_b32 s56,s46,2
v_add_u32 v125,s56,v121
v_xor_b32 v126,v125,v120
v_lshlrev_b32 v126,4,v126
v_lshl_add_u32 v20,v125,10,v126
v_add_u32 v125,0,v121
v_xor_b32 v125,v125,v120
v_lshlrev_b32 v125,4,v125
v_lshl_add_u32 v125,v120,8,v125
v_add_u32 v4,131072,v125
v_add_u32 v125,4,v121
v_xor_b32 v125,v125,v120
v_lshlrev_b32 v125,4,v125
v_lshl_add_u32 v125,v120,8,v125
v_add_u32 v5,131072,v125
v_add_u32 v125,8,v121
v_xor_b32 v125,v125,v120
v_lshlrev_b32 v125,4,v125
v_lshl_add_u32 v125,v120,8,v125
v_add_u32 v6,131072,v125
v_add_u32 v125,12,v121
v_xor_b32 v125,v125,v120
v_lshlrev_b32 v125,4,v125
v_lshl_add_u32 v125,v120,8,v125
v_add_u32 v7,131072,v125
v_lshlrev_b32 v21,5,v120
v_and_b32 v125,1,v121
v_lshl_add_u32 v21,v125,4,v21
s_lshl_b32 s56,s46,9
v_lshrrev_b32 v125,1,v121
v_lshl_add_u32 v21,v125,11,v21
s_add_u32 s56,s56,155648
v_add_u32 v21,s56,v21
v_lshlrev_b32 v22,4,v120
v_lshl_add_u32 v22,v121,10,v22
s_lshl_b32 s56,s46,8
v_add_u32 v22,s56,v22
s_mov_b32 s54,0
s_mov_b32 s31,0
s_mov_b32 s53,6
s_mov_b32 s72,0x80000000
s_mov_b32 s73,0
s_mov_b32 s77,-1
s_mov_b32 s86,0
s_mov_b32 s19,0
s_mov_b32 s74,2948595712
s_mov_b32 s75,2863311530
v_and_b32 v23,15,v1
v_lshlrev_b32 v23,3,v23
v_lshrrev_b32 v16,4,v1
v_lshl_add_u32 v23,v16,13,v23
v_mov_b32 v19,159744
v_lshl_add_u32 v16,v16,2,v19
v_and_b32 v9,15,v1
v_lshrrev_b32 v10,4,v1
v_and_b32 v124,1,v1
v_lshlrev_b32 v124,4,v124
v_mov_b32 v125,0xffff
v_lshlrev_b32 v125,v124,v125
v_lshrrev_b32 v124,2,v9
v_cmp_eq_u32 vcc,0,v124
s_nop 1
v_cndmask_b32 v12,0,v125,vcc
v_cmp_eq_u32 vcc,1,v124
s_nop 1
v_cndmask_b32 v13,0,v125,vcc
v_and_b32 v124,2,v1
v_cmp_eq_u32 vcc,0,v124
v_mov_b32 v14,0xeeee
v_mov_b32 v124,0x4444
v_cndmask_b32 v14,v14,v124,vcc
v_lshlrev_b32 v11,14,v10
v_lshl_add_u32 v11,v9,4,v11
s_lshl_b32 s65,s51,15
s_add_u32 s65,s65,92274688
s_lshl_b32 s62,s47,10
s_add_u32 s62,s62,s65
s_lshl_b32 s63,s47,16
s_lshl_b32 s60,s46,8
s_add_u32 s63,s63,s60
s_mov_b32 s4,s38
s_mov_b32 s5,s39
s_mov_b32 s6,1835008
s_mov_b32 s7,0x20000
buffer_load_dwordx4 v[24:27],v11,s[4:7],s63 offen offset:0
buffer_load_dwordx4 v[28:31],v11,s[4:7],s63 offen offset:1024
buffer_load_dwordx4 v[32:35],v11,s[4:7],s63 offen offset:2048
buffer_load_dwordx4 v[36:39],v11,s[4:7],s63 offen offset:3072
s_add_u32 s63,s63,4096
buffer_load_dwordx4 v[40:43],v11,s[4:7],s63 offen offset:0
buffer_load_dwordx4 v[44:47],v11,s[4:7],s63 offen offset:1024
buffer_load_dwordx4 v[48:51],v11,s[4:7],s63 offen offset:2048
buffer_load_dwordx4 v[52:55],v11,s[4:7],s63 offen offset:3072
s_add_u32 s63,s63,4096
buffer_load_dwordx4 v[56:59],v11,s[4:7],s63 offen offset:0
buffer_load_dwordx4 v[60:63],v11,s[4:7],s63 offen offset:1024
buffer_load_dwordx4 v[64:67],v11,s[4:7],s63 offen offset:2048
buffer_load_dwordx4 v[68:71],v11,s[4:7],s63 offen offset:3072
s_add_u32 s63,s63,4096
buffer_load_dwordx4 v[72:75],v11,s[4:7],s63 offen offset:0
buffer_load_dwordx4 v[76:79],v11,s[4:7],s63 offen offset:1024
buffer_load_dwordx4 v[80:83],v11,s[4:7],s63 offen offset:2048
buffer_load_dwordx4 v[84:87],v11,s[4:7],s63 offen offset:3072
s_mov_b32 s4,s32
s_mov_b32 s5,s33
s_mov_b32 s6,1024
s_mov_b32 s7,0x20000
buffer_load_dwordx4 v[88:91],v0,s[4:7],0 offen
s_waitcnt vmcnt(0)
v_lshlrev_b32 v96,16,v88
v_and_b32 v97,0xffff0000,v88
v_lshlrev_b32 v98,16,v89
v_and_b32 v99,0xffff0000,v89
v_lshlrev_b32 v100,16,v90
v_and_b32 v101,0xffff0000,v90
v_lshlrev_b32 v102,16,v91
v_and_b32 v103,0xffff0000,v91
v_mul_f32 v88,v96,v96
v_fma_f32 v88,v97,v97,v88
v_fma_f32 v88,v98,v98,v88
v_fma_f32 v88,v99,v99,v88
v_fma_f32 v88,v100,v100,v88
v_fma_f32 v88,v101,v101,v88
v_fma_f32 v88,v102,v102,v88
v_fma_f32 v88,v103,v103,v88
s_nop 1
v_add_f32_dpp v88,v88,v88 row_ror:8 row_mask:0xf bank_mask:0xf
s_nop 1
v_add_f32_dpp v88,v88,v88 row_ror:4 row_mask:0xf bank_mask:0xf
s_nop 1
v_add_f32_dpp v88,v88,v88 row_ror:2 row_mask:0xf bank_mask:0xf
s_nop 1
v_add_f32_dpp v88,v88,v88 row_ror:1 row_mask:0xf bank_mask:0xf
v_mov_b32 v89,v88
s_nop 1
v_permlane16_swap_b32 v88,v89
v_add_f32 v88,v88,v89
v_mov_b32 v89,v88
s_nop 1
v_permlane32_swap_b32 v88,v89
v_add_f32 v88,v88,v89
v_sqrt_f32 v88,v88
s_nop 0
v_mul_f32 v88,0x40333333,v88
s_nop 0
v_readfirstlane_b32 s25,v88
s_bitset1_b32 s25,31
s_ff1_i32_b64 s30,s[74:75]
s_bitset0_b64 s[74:75],s30
s_min_u32 s30,s30,127
s_lshl_b32 s70,s30,15
s_add_u32 s70,s70,0
s_add_u32 s71,s70,16384
L_mo_33:
s_cmp_lg_u32 s19,0
s_cbranch_scc1 L_mo_34
s_add_u32 m0,s50,131072
s_nop 0
buffer_load_dwordx4 v20,s[8:11],s70 offen offset:0 sc1 lds
s_add_u32 m0,s50,135168
s_nop 0
buffer_load_dwordx4 v20,s[8:11],s71 offen offset:0 sc1 lds
s_add_u32 m0,s50,139008
s_nop 0
buffer_load_dwordx4 v20,s[8:11],s70 offen offset:256 sc1 lds
s_add_u32 m0,s50,143104
s_nop 0
buffer_load_dwordx4 v20,s[8:11],s71 offen offset:256 sc1 lds
s_add_u32 m0,s50,146944
s_nop 0
buffer_load_dwordx4 v20,s[8:11],s70 offen offset:512 sc1 lds
s_add_u32 m0,s50,151040
s_nop 0
buffer_load_dwordx4 v20,s[8:11],s71 offen offset:512 sc1 lds
s_mov_b32 s19,1
s_waitcnt vmcnt(0)
L_mo_34:
s_mov_b32 s51,s30
s_mov_b64 s[68:69],s[70:71]
s_ff1_i32_b64 s30,s[74:75]
s_bitset0_b64 s[74:75],s30
s_min_u32 s30,s30,127
s_lshl_b32 s70,s30,15
s_add_u32 s70,s70,0
s_add_u32 s71,s70,16384
s_lshl_b32 s76,s31,13
s_add_u32 s76,s76,10487040
s_lshl_b32 s58,s51,5
s_add_u32 s58,s58,s47
s_mul_i32 s58,s58,24576
s_add_u32 s58,s58,100663296
s_add_u32 s61,s58,s50
s_add_u32 s62,s61,4096
s_add_u32 s63,s61,16384
s_add_u32 s64,s61,20480
s_add_u32 s65,s61,s50
s_add_u32 s65,s65,8192
s_waitcnt vmcnt(12)
s_barrier
ds_read_b128 v[72:75],v4 offset:0
ds_read_b128 v[76:79],v4 offset:4096
ds_read_b128 v[80:83],v5 offset:0
ds_read_b128 v[84:87],v5 offset:4096
s_add_u32 m0,s50,154880
s_nop 0
buffer_load_dwordx4 v20,s[8:11],s68 offen offset:768 sc1 lds
s_add_u32 m0,s50,158976
s_nop 0
buffer_load_dwordx4 v20,s[8:11],s69 offen offset:768 sc1 lds
s_waitcnt lgkmcnt(2)
v_mfma_f32_16x16x32_bf16 v[40:43],a[128:131],v[72:75],0
ds_read_b128 v[108:111],v6 offset:0
v_mfma_f32_16x16x32_bf16 v[56:59],v[72:75],v[128:131],0
v_mfma_f32_16x16x32_bf16 v[24:27],a[0:3],v[72:75],0
ds_read_b128 v[112:115],v6 offset:4096
v_mfma_f32_16x16x32_bf16 v[44:47],a[128:131],v[76:79],0
v_mfma_f32_16x16x32_bf16 v[60:63],v[76:79],v[128:131],0
v_mfma_f32_16x16x32_bf16 v[28:31],a[0:3],v[76:79],0
v_mfma_f32_16x16x32_bf16 v[48:51],a[136:139],v[72:75],0
v_mfma_f32_16x16x32_bf16 v[64:67],v[72:75],v[136:139],0
v_mfma_f32_16x16x32_bf16 v[32:35],a[8:11],v[72:75],0
v_mfma_f32_16x16x32_bf16 v[52:55],a[136:139],v[76:79],0
v_mfma_f32_16x16x32_bf16 v[68:71],v[76:79],v[136:139],0
v_mfma_f32_16x16x32_bf16 v[36:39],a[8:11],v[76:79],0
s_waitcnt lgkmcnt(2)
v_mfma_f32_16x16x32_bf16 v[40:43],a[132:135],v[80:83],v[40:43]
ds_read_b128 v[72:75],v7 offset:0
v_mfma_f32_16x16x32_bf16 v[56:59],v[80:83],v[132:135],v[56:59]
v_mfma_f32_16x16x32_bf16 v[24:27],a[4:7],v[80:83],v[24:27]
ds_read_b128 v[76:79],v7 offset:4096
v_mfma_f32_16x16x32_bf16 v[44:47],a[132:135],v[84:87],v[44:47]
v_mfma_f32_16x16x32_bf16 v[60:63],v[84:87],v[132:135],v[60:63]
v_mfma_f32_16x16x32_bf16 v[28:31],a[4:7],v[84:87],v[28:31]
v_mfma_f32_16x16x32_bf16 v[48:51],a[140:143],v[80:83],v[48:51]
v_mfma_f32_16x16x32_bf16 v[64:67],v[80:83],v[140:143],v[64:67]
v_mfma_f32_16x16x32_bf16 v[32:35],a[12:15],v[80:83],v[32:35]
v_mfma_f32_16x16x32_bf16 v[52:55],a[140:143],v[84:87],v[52:55]
v_mfma_f32_16x16x32_bf16 v[68:71],v[84:87],v[140:143],v[68:71]
v_mfma_f32_16x16x32_bf16 v[36:39],a[12:15],v[84:87],v[36:39]
s_waitcnt vmcnt(12)
s_barrier
s_waitcnt lgkmcnt(2)
v_mfma_f32_16x16x32_bf16 v[40:43],a[144:147],v[108:111],v[40:43]
ds_read_b128 v[80:83],v4 offset:8192
v_mfma_f32_16x16x32_bf16 v[56:59],v[108:111],v[144:147],v[56:59]
v_mfma_f32_16x16x32_bf16 v[24:27],a[16:19],v[108:111],v[24:27]
ds_read_b128 v[84:87],v4 offset:12288
v_mfma_f32_16x16x32_bf16 v[44:47],a[144:147],v[112:115],v[44:47]
v_mfma_f32_16x16x32_bf16 v[60:63],v[112:115],v[144:147],v[60:63]
v_mfma_f32_16x16x32_bf16 v[28:31],a[16:19],v[112:115],v[28:31]
v_mfma_f32_16x16x32_bf16 v[48:51],a[152:155],v[108:111],v[48:51]
v_mfma_f32_16x16x32_bf16 v[64:67],v[108:111],v[152:155],v[64:67]
v_mfma_f32_16x16x32_bf16 v[32:35],a[24:27],v[108:111],v[32:35]
v_mfma_f32_16x16x32_bf16 v[52:55],a[152:155],v[112:115],v[52:55]
v_mfma_f32_16x16x32_bf16 v[68:71],v[112:115],v[152:155],v[68:71]
v_mfma_f32_16x16x32_bf16 v[36:39],a[24:27],v[112:115],v[36:39]
s_waitcnt lgkmcnt(2)
v_mfma_f32_16x16x32_bf16 v[40:43],a[148:151],v[72:75],v[40:43]
ds_read_b128 v[108:111],v5 offset:8192
v_mfma_f32_16x16x32_bf16 v[56:59],v[72:75],v[148:151],v[56:59]
v_mfma_f32_16x16x32_bf16 v[24:27],a[20:23],v[72:75],v[24:27]
ds_read_b128 v[112:115],v5 offset:12288
v_mfma_f32_16x16x32_bf16 v[44:47],a[148:151],v[76:79],v[44:47]
v_mfma_f32_16x16x32_bf16 v[60:63],v[76:79],v[148:151],v[60:63]
v_mfma_f32_16x16x32_bf16 v[28:31],a[20:23],v[76:79],v[28:31]
v_mfma_f32_16x16x32_bf16 v[48:51],a[156:159],v[72:75],v[48:51]
v_mfma_f32_16x16x32_bf16 v[64:67],v[72:75],v[156:159],v[64:67]
v_mfma_f32_16x16x32_bf16 v[32:35],a[28:31],v[72:75],v[32:35]
v_mfma_f32_16x16x32_bf16 v[52:55],a[156:159],v[76:79],v[52:55]
v_mfma_f32_16x16x32_bf16 v[68:71],v[76:79],v[156:159],v[68:71]
v_mfma_f32_16x16x32_bf16 v[36:39],a[28:31],v[76:79],v[36:39]
s_waitcnt lgkmcnt(2)
v_mfma_f32_16x16x32_bf16 v[40:43],a[160:163],v[80:83],v[40:43]
ds_read_b128 v[72:75],v6 offset:8192
v_mfma_f32_16x16x32_bf16 v[56:59],v[80:83],v[160:163],v[56:59]
v_mfma_f32_16x16x32_bf16 v[24:27],a[32:35],v[80:83],v[24:27]
ds_read_b128 v[76:79],v6 offset:12288
v_mfma_f32_16x16x32_bf16 v[44:47],a[160:163],v[84:87],v[44:47]
v_mfma_f32_16x16x32_bf16 v[60:63],v[84:87],v[160:163],v[60:63]
v_mfma_f32_16x16x32_bf16 v[28:31],a[32:35],v[84:87],v[28:31]
v_mfma_f32_16x16x32_bf16 v[48:51],a[168:171],v[80:83],v[48:51]
v_mfma_f32_16x16x32_bf16 v[64:67],v[80:83],v[168:171],v[64:67]
v_mfma_f32_16x16x32_bf16 v[32:35],a[40:43],v[80:83],v[32:35]
v_mfma_f32_16x16x32_bf16 v[52:55],a[168:171],v[84:87],v[52:55]
v_mfma_f32_16x16x32_bf16 v[68:71],v[84:87],v[168:171],v[68:71]
v_mfma_f32_16x16x32_bf16 v[36:39],a[40:43],v[84:87],v[36:39]
s_waitcnt lgkmcnt(2)
v_mfma_f32_16x16x32_bf16 v[40:43],a[164:167],v[108:111],v[40:43]
ds_read_b128 v[80:83],v7 offset:8192
v_mfma_f32_16x16x32_bf16 v[56:59],v[108:111],v[164:167],v[56:59]
v_mfma_f32_16x16x32_bf16 v[24:27],a[36:39],v[108:111],v[24:27]
ds_read_b128 v[84:87],v7 offset:12288
v_mfma_f32_16x16x32_bf16 v[44:47],a[164:167],v[112:115],v[44:47]
v_mfma_f32_16x16x32_bf16 v[60:63],v[112:115],v[164:167],v[60:63]
v_mfma_f32_16x16x32_bf16 v[28:31],a[36:39],v[112:115],v[28:31]
v_mfma_f32_16x16x32_bf16 v[48:51],a[172:175],v[108:111],v[48:51]
v_mfma_f32_16x16x32_bf16 v[64:67],v[108:111],v[172:175],v[64:67]
v_mfma_f32_16x16x32_bf16 v[32:35],a[44:47],v[108:111],v[32:35]
v_mfma_f32_16x16x32_bf16 v[52:55],a[172:175],v[112:115],v[52:55]
v_mfma_f32_16x16x32_bf16 v[68:71],v[112:115],v[172:175],v[68:71]
v_mfma_f32_16x16x32_bf16 v[36:39],a[44:47],v[112:115],v[36:39]
s_waitcnt vmcnt(10)
s_barrier
s_waitcnt lgkmcnt(2)
v_mfma_f32_16x16x32_bf16 v[40:43],a[176:179],v[72:75],v[40:43]
ds_read_b128 v[108:111],v4 offset:16384
v_mfma_f32_16x16x32_bf16 v[56:59],v[72:75],v[176:179],v[56:59]
v_mfma_f32_16x16x32_bf16 v[24:27],a[48:51],v[72:75],v[24:27]
ds_read_b128 v[112:115],v4 offset:20480
v_mfma_f32_16x16x32_bf16 v[44:47],a[176:179],v[76:79],v[44:47]
v_mfma_f32_16x16x32_bf16 v[60:63],v[76:79],v[176:179],v[60:63]
v_mfma_f32_16x16x32_bf16 v[28:31],a[48:51],v[76:79],v[28:31]
v_mfma_f32_16x16x32_bf16 v[48:51],a[184:187],v[72:75],v[48:51]
v_mfma_f32_16x16x32_bf16 v[64:67],v[72:75],v[184:187],v[64:67]
v_mfma_f32_16x16x32_bf16 v[32:35],a[56:59],v[72:75],v[32:35]
v_mfma_f32_16x16x32_bf16 v[52:55],a[184:187],v[76:79],v[52:55]
v_mfma_f32_16x16x32_bf16 v[68:71],v[76:79],v[184:187],v[68:71]
v_mfma_f32_16x16x32_bf16 v[36:39],a[56:59],v[76:79],v[36:39]
s_waitcnt vmcnt(2)
s_barrier
s_or_b32 s72,s72,s52
buffer_store_dword v17,off,s[8:11],s72 sc1
s_waitcnt lgkmcnt(2)
v_mfma_f32_16x16x32_bf16 v[40:43],a[180:183],v[80:83],v[40:43]
ds_read_b128 v[72:75],v5 offset:16384
v_mfma_f32_16x16x32_bf16 v[56:59],v[80:83],v[180:183],v[56:59]
v_mfma_f32_16x16x32_bf16 v[24:27],a[52:55],v[80:83],v[24:27]
ds_read_b128 v[76:79],v5 offset:20480
v_mfma_f32_16x16x32_bf16 v[44:47],a[180:183],v[84:87],v[44:47]
v_mfma_f32_16x16x32_bf16 v[60:63],v[84:87],v[180:183],v[60:63]
v_mfma_f32_16x16x32_bf16 v[28:31],a[52:55],v[84:87],v[28:31]
v_mfma_f32_16x16x32_bf16 v[48:51],a[188:191],v[80:83],v[48:51]
v_mfma_f32_16x16x32_bf16 v[64:67],v[80:83],v[188:191],v[64:67]
v_mfma_f32_16x16x32_bf16 v[32:35],a[60:63],v[80:83],v[32:35]
v_mfma_f32_16x16x32_bf16 v[52:55],a[188:191],v[84:87],v[52:55]
v_mfma_f32_16x16x32_bf16 v[68:71],v[84:87],v[188:191],v[68:71]
v_mfma_f32_16x16x32_bf16 v[36:39],a[60:63],v[84:87],v[36:39]
s_waitcnt lgkmcnt(2)
v_mfma_f32_16x16x32_bf16 v[40:43],a[192:195],v[108:111],v[40:43]
ds_read_b128 v[80:83],v6 offset:16384
v_mfma_f32_16x16x32_bf16 v[56:59],v[108:111],v[192:195],v[56:59]
v_mfma_f32_16x16x32_bf16 v[24:27],a[64:67],v[108:111],v[24:27]
ds_read_b128 v[84:87],v6 offset:20480
v_mfma_f32_16x16x32_bf16 v[44:47],a[192:195],v[112:115],v[44:47]
v_mfma_f32_16x16x32_bf16 v[60:63],v[112:115],v[192:195],v[60:63]
v_mfma_f32_16x16x32_bf16 v[28:31],a[64:67],v[112:115],v[28:31]
v_mfma_f32_16x16x32_bf16 v[48:51],a[200:203],v[108:111],v[48:51]
v_mfma_f32_16x16x32_bf16 v[64:67],v[108:111],v[200:203],v[64:67]
v_mfma_f32_16x16x32_bf16 v[32:35],a[72:75],v[108:111],v[32:35]
v_mfma_f32_16x16x32_bf16 v[52:55],a[200:203],v[112:115],v[52:55]
v_mfma_f32_16x16x32_bf16 v[68:71],v[112:115],v[200:203],v[68:71]
v_mfma_f32_16x16x32_bf16 v[36:39],a[72:75],v[112:115],v[36:39]
s_waitcnt lgkmcnt(2)
v_mfma_f32_16x16x32_bf16 v[40:43],a[196:199],v[72:75],v[40:43]
ds_read_b128 v[108:111],v7 offset:16384
v_mfma_f32_16x16x32_bf16 v[56:59],v[72:75],v[196:199],v[56:59]
v_mfma_f32_16x16x32_bf16 v[24:27],a[68:71],v[72:75],v[24:27]
ds_read_b128 v[112:115],v7 offset:20480
v_mfma_f32_16x16x32_bf16 v[44:47],a[196:199],v[76:79],v[44:47]
v_mfma_f32_16x16x32_bf16 v[60:63],v[76:79],v[196:199],v[60:63]
v_mfma_f32_16x16x32_bf16 v[28:31],a[68:71],v[76:79],v[28:31]
v_mfma_f32_16x16x32_bf16 v[48:51],a[204:207],v[72:75],v[48:51]
v_mfma_f32_16x16x32_bf16 v[64:67],v[72:75],v[204:207],v[64:67]
v_mfma_f32_16x16x32_bf16 v[32:35],a[76:79],v[72:75],v[32:35]
v_mfma_f32_16x16x32_bf16 v[52:55],a[204:207],v[76:79],v[52:55]
v_mfma_f32_16x16x32_bf16 v[68:71],v[76:79],v[204:207],v[68:71]
v_mfma_f32_16x16x32_bf16 v[36:39],a[76:79],v[76:79],v[36:39]
s_waitcnt vmcnt(1)
s_barrier
s_waitcnt lgkmcnt(2)
v_mfma_f32_16x16x32_bf16 v[40:43],a[208:211],v[80:83],v[40:43]
ds_read_b128 v[72:75],v4 offset:24576
v_mfma_f32_16x16x32_bf16 v[56:59],v[80:83],v[208:211],v[56:59]
v_mfma_f32_16x16x32_bf16 v[24:27],a[80:83],v[80:83],v[24:27]
ds_read_b128 v[76:79],v4 offset:28672
v_mfma_f32_16x16x32_bf16 v[44:47],a[208:211],v[84:87],v[44:47]
v_mfma_f32_16x16x32_bf16 v[60:63],v[84:87],v[208:211],v[60:63]
v_mfma_f32_16x16x32_bf16 v[28:31],a[80:83],v[84:87],v[28:31]
v_mfma_f32_16x16x32_bf16 v[48:51],a[216:219],v[80:83],v[48:51]
v_mfma_f32_16x16x32_bf16 v[64:67],v[80:83],v[216:219],v[64:67]
v_mfma_f32_16x16x32_bf16 v[32:35],a[88:91],v[80:83],v[32:35]
v_mfma_f32_16x16x32_bf16 v[52:55],a[216:219],v[84:87],v[52:55]
v_mfma_f32_16x16x32_bf16 v[68:71],v[84:87],v[216:219],v[68:71]
v_mfma_f32_16x16x32_bf16 v[36:39],a[88:91],v[84:87],v[36:39]
s_waitcnt lgkmcnt(2)
v_mfma_f32_16x16x32_bf16 v[40:43],a[212:215],v[108:111],v[40:43]
ds_read_b128 v[80:83],v5 offset:24576
v_mfma_f32_16x16x32_bf16 v[56:59],v[108:111],v[212:215],v[56:59]
v_mfma_f32_16x16x32_bf16 v[24:27],a[84:87],v[108:111],v[24:27]
ds_read_b128 v[84:87],v5 offset:28672
v_mfma_f32_16x16x32_bf16 v[44:47],a[212:215],v[112:115],v[44:47]
v_mfma_f32_16x16x32_bf16 v[60:63],v[112:115],v[212:215],v[60:63]
v_mfma_f32_16x16x32_bf16 v[28:31],a[84:87],v[112:115],v[28:31]
v_mfma_f32_16x16x32_bf16 v[48:51],a[220:223],v[108:111],v[48:51]
v_mfma_f32_16x16x32_bf16 v[64:67],v[108:111],v[220:223],v[64:67]
v_mfma_f32_16x16x32_bf16 v[32:35],a[92:95],v[108:111],v[32:35]
v_mfma_f32_16x16x32_bf16 v[52:55],a[220:223],v[112:115],v[52:55]
v_mfma_f32_16x16x32_bf16 v[68:71],v[112:115],v[220:223],v[68:71]
v_mfma_f32_16x16x32_bf16 v[36:39],a[92:95],v[112:115],v[36:39]
s_barrier
s_waitcnt lgkmcnt(2)
v_mfma_f32_16x16x32_bf16 v[40:43],a[224:227],v[72:75],v[40:43]
ds_read_b128 v[108:111],v6 offset:24576
v_mfma_f32_16x16x32_bf16 v[56:59],v[72:75],v[224:227],v[56:59]
s_add_u32 m0,s50,131072
v_mfma_f32_16x16x32_bf16 v[24:27],a[96:99],v[72:75],v[24:27]
ds_read_b128 v[112:115],v6 offset:28672
v_mfma_f32_16x16x32_bf16 v[44:47],a[224:227],v[76:79],v[44:47]
buffer_load_dwordx4 v20,s[8:11],s70 offen offset:0 sc1 lds
v_mfma_f32_16x16x32_bf16 v[60:63],v[76:79],v[224:227],v[60:63]
s_add_u32 m0,s50,135168
v_mfma_f32_16x16x32_bf16 v[28:31],a[96:99],v[76:79],v[28:31]
buffer_load_dwordx4 v20,s[8:11],s71 offen offset:0 sc1 lds
v_mfma_f32_16x16x32_bf16 v[48:51],a[232:235],v[72:75],v[48:51]
s_add_u32 m0,s50,139008
v_mfma_f32_16x16x32_bf16 v[64:67],v[72:75],v[232:235],v[64:67]
buffer_load_dwordx4 v20,s[8:11],s70 offen offset:256 sc1 lds
v_mfma_f32_16x16x32_bf16 v[32:35],a[104:107],v[72:75],v[32:35]
s_add_u32 m0,s50,143104
v_mfma_f32_16x16x32_bf16 v[52:55],a[232:235],v[76:79],v[52:55]
buffer_load_dwordx4 v20,s[8:11],s71 offen offset:256 sc1 lds
v_mfma_f32_16x16x32_bf16 v[68:71],v[76:79],v[232:235],v[68:71]
s_add_u32 m0,s50,146944
v_mfma_f32_16x16x32_bf16 v[36:39],a[104:107],v[76:79],v[36:39]
buffer_load_dwordx4 v20,s[8:11],s70 offen offset:512 sc1 lds
s_waitcnt lgkmcnt(2)
v_mfma_f32_16x16x32_bf16 v[40:43],a[228:231],v[80:83],v[40:43]
ds_read_b128 v[72:75],v7 offset:24576
v_mfma_f32_16x16x32_bf16 v[56:59],v[80:83],v[228:231],v[56:59]
s_add_u32 m0,s50,151040
v_mfma_f32_16x16x32_bf16 v[24:27],a[100:103],v[80:83],v[24:27]
ds_read_b128 v[76:79],v7 offset:28672
v_mfma_f32_16x16x32_bf16 v[44:47],a[228:231],v[84:87],v[44:47]
buffer_load_dwordx4 v20,s[8:11],s71 offen offset:512 sc1 lds
v_mfma_f32_16x16x32_bf16 v[60:63],v[84:87],v[228:231],v[60:63]
buffer_load_dwordx2 v[124:125],v23,s[8:11],s76 offen sc1
v_mfma_f32_16x16x32_bf16 v[28:31],a[100:103],v[84:87],v[28:31]
v_mfma_f32_16x16x32_bf16 v[48:51],a[236:239],v[80:83],v[48:51]
v_mfma_f32_16x16x32_bf16 v[64:67],v[80:83],v[236:239],v[64:67]
v_mfma_f32_16x16x32_bf16 v[32:35],a[108:111],v[80:83],v[32:35]
v_mfma_f32_16x16x32_bf16 v[52:55],a[236:239],v[84:87],v[52:55]
v_mfma_f32_16x16x32_bf16 v[68:71],v[84:87],v[236:239],v[68:71]
v_mfma_f32_16x16x32_bf16 v[36:39],a[108:111],v[84:87],v[36:39]
s_waitcnt lgkmcnt(2)
v_mfma_f32_16x16x32_bf16 v[40:43],a[240:243],v[108:111],v[40:43]
v_mfma_f32_16x16x32_bf16 v[56:59],v[108:111],v[240:243],v[56:59]
v_mfma_f32_16x16x32_bf16 v[24:27],a[112:115],v[108:111],v[24:27]
v_mfma_f32_16x16x32_bf16 v[44:47],a[240:243],v[112:115],v[44:47]
v_mfma_f32_16x16x32_bf16 v[60:63],v[112:115],v[240:243],v[60:63]
v_mfma_f32_16x16x32_bf16 v[28:31],a[112:115],v[112:115],v[28:31]
v_mfma_f32_16x16x32_bf16 v[48:51],a[248:251],v[108:111],v[48:51]
v_mfma_f32_16x16x32_bf16 v[64:67],v[108:111],v[248:251],v[64:67]
v_mfma_f32_16x16x32_bf16 v[32:35],a[120:123],v[108:111],v[32:35]
v_mfma_f32_16x16x32_bf16 v[52:55],a[248:251],v[112:115],v[52:55]
v_mfma_f32_16x16x32_bf16 v[68:71],v[112:115],v[248:251],v[68:71]
v_mfma_f32_16x16x32_bf16 v[36:39],a[120:123],v[112:115],v[36:39]
s_waitcnt lgkmcnt(0)
v_mfma_f32_16x16x32_bf16 v[40:43],a[244:247],v[72:75],v[40:43]
v_mfma_f32_16x16x32_bf16 v[56:59],v[72:75],v[244:247],v[56:59]
v_mfma_f32_16x16x32_bf16 v[24:27],a[116:119],v[72:75],v[24:27]
v_mfma_f32_16x16x32_bf16 v[44:47],a[244:247],v[76:79],v[44:47]
v_mfma_f32_16x16x32_bf16 v[60:63],v[76:79],v[244:247],v[60:63]
v_mfma_f32_16x16x32_bf16 v[28:31],a[116:119],v[76:79],v[28:31]
v_mfma_f32_16x16x32_bf16 v[48:51],a[252:255],v[72:75],v[48:51]
v_mfma_f32_16x16x32_bf16 v[64:67],v[72:75],v[252:255],v[64:67]
v_mfma_f32_16x16x32_bf16 v[32:35],a[124:127],v[72:75],v[32:35]
v_mfma_f32_16x16x32_bf16 v[52:55],a[252:255],v[76:79],v[52:55]
v_mfma_f32_16x16x32_bf16 v[68:71],v[76:79],v[252:255],v[68:71]
v_mfma_f32_16x16x32_bf16 v[36:39],a[124:127],v[76:79],v[36:39]
s_lshl_b32 s56,s51,5
s_add_u32 s56,s56,s47
s_lshl_b32 s56,s56,12
s_add_u32 s56,s56,s50
s_add_u32 s56,s56,41943040
v_mov_b64 v[120:121],-1
v_mov_b64 v[122:123],-1
buffer_store_dwordx4 v[120:123],v0,s[8:11],s56 offen sc1
v_cvt_pk_bf16_f32 v72,v40,v48
v_cvt_pk_bf16_f32 v73,v41,v49
v_cvt_pk_bf16_f32 v74,v42,v50
v_cvt_pk_bf16_f32 v75,v43,v51
buffer_store_dwordx4 v[72:75],v0,s[8:11],s61 offen sc1
v_cvt_pk_bf16_f32 v76,v44,v52
v_cvt_pk_bf16_f32 v77,v45,v53
v_cvt_pk_bf16_f32 v78,v46,v54
v_cvt_pk_bf16_f32 v79,v47,v55
buffer_store_dwordx4 v[76:79],v0,s[8:11],s62 offen sc1
v_cvt_pk_bf16_f32 v80,v56,v57
v_cvt_pk_bf16_f32 v81,v58,v59
v_cvt_pk_bf16_f32 v82,v60,v61
v_cvt_pk_bf16_f32 v83,v62,v63
buffer_store_dwordx4 v[80:83],v0,s[8:11],s65 offen offset:0 sc1
v_cvt_pk_bf16_f32 v84,v64,v65
v_cvt_pk_bf16_f32 v85,v66,v67
v_cvt_pk_bf16_f32 v86,v68,v69
v_cvt_pk_bf16_f32 v87,v70,v71
buffer_store_dwordx4 v[84:87],v0,s[8:11],s65 offen offset:1024 sc1
v_cvt_pk_bf16_f32 v108,v24,v32
v_cvt_pk_bf16_f32 v109,v25,v33
v_cvt_pk_bf16_f32 v110,v26,v34
v_cvt_pk_bf16_f32 v111,v27,v35
buffer_store_dwordx4 v[108:111],v0,s[8:11],s63 offen sc1
v_cvt_pk_bf16_f32 v112,v28,v36
v_cvt_pk_bf16_f32 v113,v29,v37
v_cvt_pk_bf16_f32 v114,v30,v38
v_cvt_pk_bf16_f32 v115,v31,v39
buffer_store_dwordx4 v[112:115],v0,s[8:11],s64 offen sc1
s_lshl_b32 s72,s51,13
s_lshl2_add_u32 s72,s47,s72
s_add_u32 s72,s72,10485760
s_sub_u32 s53,s53,1
s_cmp_gt_i32 s53,3
s_cbranch_scc1 L_mo_34
s_cmp_gt_i32 s53,0
s_cselect_b32 s87,1,3
s_mov_b32 s18,0
s_waitcnt vmcnt(7)
s_branch L_mo_39
L_mo_32:
s_mov_b32 s55,s22
s_mov_b32 s22,s23
s_mov_b32 s23,s24
s_mov_b32 s24,-1
s_cmp_lg_u32 s55,-1
s_cbranch_scc1 L_mp_30
s_sub_u32 s56,s30,s31
s_cmp_gt_i32 s77,0
s_cselect_b32 s57,6,15
s_cmp_lg_u32 s86,0
s_cselect_b32 s57,9,s57
s_cmp_lt_i32 s56,s57
s_cbranch_scc1 L_mo_33
s_cmp_lt_i32 s56,30
s_cselect_b32 s87,s18,0
s_cmp_ge_u32 s31,8
s_cselect_b32 s56,1,s18
s_and_b32 s56,s56,s86
s_cselect_b32 s87,2,s87
s_mul_i32 s56,s87,s18
s_cmp_lg_u32 s56,0
s_cbranch_scc1 L_mo_37
s_mov_b32 s18,0
s_lshr_b32 s56,s72,31
s_or_b32 s56,s56,s87
s_cbranch_scc1 L_mo_43
s_waitcnt vmcnt(0)
s_barrier
s_or_b32 s72,s72,s52
buffer_store_dword v17,off,s[8:11],s72 sc1
s_mov_b32 s72,0x80000000
L_mo_43:
s_cmp_lg_u32 s46,0
s_cbranch_scc1 L_mo_41
s_lshl_b32 s76,s31,13
s_add_u32 s76,s76,10487040
L_mo_40:
buffer_load_dwordx2 v[124:125],v23,s[8:11],s76 offen sc1
s_sub_u32 s49,s49,1
s_cbranch_scc1 L_abort
s_waitcnt vmcnt(0)
L_mo_39:
v_min_u32 v123,v124,v125
v_max_u32 v125,v124,v125
v_cmp_eq_u32 vcc,0,v123
s_nop 1
v_cndmask_b32 v125,v125,-1,vcc
s_and_b32 s56,vcc_lo,0xffff
s_cbranch_scc0 L_mo_44
s_cmp_lg_u32 s87,0
s_cbranch_scc1 L_mo_44
s_mov_b32 s18,1
s_sleep 2
s_branch L_mo_40
L_mo_44:
v_max_u32_dpp v125,v125,v125 row_ror:8 row_mask:0xf bank_mask:0xf
s_nop 1
v_max_u32_dpp v125,v125,v125 row_ror:4 row_mask:0xf bank_mask:0xf
s_nop 1
v_max_u32_dpp v125,v125,v125 row_ror:2 row_mask:0xf bank_mask:0xf
s_nop 1
v_max_u32_dpp v125,v125,v125 row_ror:1 row_mask:0xf bank_mask:0xf
L_mo_41:
s_sub_u32 s49,s49,1
s_cbranch_scc1 L_abort
v_mov_b32 v124,s18
s_barrier
s_cmp_lg_u32 s46,0
s_cbranch_scc1 L_mo_42
ds_write_b32 v16,v125
ds_write_b32 v19,v124 offset:16
s_waitcnt lgkmcnt(0)
L_mo_42:
s_barrier
ds_read_b128 v[120:123],v19
ds_read_b32 v124,v19 offset:16
s_waitcnt lgkmcnt(0)
v_readfirstlane_b32 s55,v120
v_readfirstlane_b32 s22,v121
v_readfirstlane_b32 s23,v122
v_readfirstlane_b32 s24,v123
v_readfirstlane_b32 s18,v124
s_cmp_lg_u32 s55,-1
s_cbranch_scc1 L_mp_30
L_mo_37:
s_mov_b32 s22,-1
s_cmp_eq_u32 s87,1
s_cbranch_scc1 L_mo_33
s_cmp_eq_u32 s87,2
s_cbranch_scc1 L_mo_38
s_branch L_mo_32
L_mp_30:
s_mov_b32 s53,0
s_sub_u32 s73,s73,1
s_max_i32 s73,s73,0
s_sub_u32 s77,s77,1
s_min_u32 s61,s73,2
s_cmp_lt_u32 s31,5
s_cselect_b32 s60,s25,0
s_cmp_lt_u32 s55,s60
s_cselect_b32 s61,2,s61
s_cmp_le_u32 s55,s54
s_cbranch_scc1 L_mr_31
s_mov_b32 s77,s61
s_mov_b32 s54,s55
s_mov_b32 s86,0
s_or_b32 s61,s47,s46
s_cbranch_scc1 L_mr_31
v_mov_b32 v120,s54
v_lshlrev_b32 v121,13,v1
s_mov_b32 s61,10486784
buffer_store_dword v120,v121,s[8:11],s61 offen sc1
L_mr_31:
s_cmp_lg_u32 s31,63
s_cbranch_scc1 L_mo_35
s_min_i32 s77,s77,0
s_or_b32 s61,s47,s46
s_cbranch_scc1 L_mo_35
s_mov_b32 s59,11018240
v_lshlrev_b32 v120,2,v1
L_fp_46:
s_sleep 0
buffer_load_dword v121,v120,s[8:11],s59 offen sc1
s_sub_u32 s49,s49,1
s_cbranch_scc1 L_abort
s_waitcnt vmcnt(0)
v_cmp_eq_u32 vcc,0,v121
s_cbranch_vccnz L_fp_46
s_andn2_b32 s62,0x7ff,s54
v_lshl_or_b32 v121,s62,8,v121
s_add_u32 s59,s59,8192
buffer_store_dword v121,v120,s[8:11],s59 offen sc1
s_add_u32 s59,s59,8192
buffer_store_dword v121,v120,s[8:11],s59 offen sc1
s_add_u32 s59,s59,8192
buffer_store_dword v121,v120,s[8:11],s59 offen sc1
s_add_u32 s59,s59,8192
buffer_store_dword v121,v120,s[8:11],s59 offen sc1
s_add_u32 s59,s59,8192
buffer_store_dword v121,v120,s[8:11],s59 offen sc1
s_add_u32 s59,s59,8192
buffer_store_dword v121,v120,s[8:11],s59 offen sc1
L_mo_35:
s_add_u32 s31,s31,1
s_cmp_gt_i32 s77,0
s_cmov_b32 s18,0
s_cbranch_scc1 L_mo_32
s_cmp_lg_u32 s77,0
s_cbranch_scc1 L_mo_36
s_andn2_b32 s51,0x7ff,s54
s_lshr_b32 s51,s51,5
s_add_u32 s73,s73,2
s_mov_b32 s86,1
s_mov_b32 s19,0
s_mov_b32 s18,0
s_waitcnt vmcnt(8)
s_barrier
s_andn2_b32 s64,0x7ff,s54
s_lshl_b32 s56,s64,10
s_add_u32 s58,s56,4194304
buffer_load_dwordx4 v[88:91],v0,s[8:11],s58 offen sc1
v_and_b32 v9,15,v1
v_lshrrev_b32 v10,4,v1
v_and_b32 v124,1,v1
v_lshlrev_b32 v124,4,v124
v_mov_b32 v125,0xffff
v_lshlrev_b32 v125,v124,v125
v_lshrrev_b32 v124,2,v9
v_cmp_eq_u32 vcc,0,v124
s_nop 1
v_cndmask_b32 v12,0,v125,vcc
v_cmp_eq_u32 vcc,1,v124
s_nop 1
v_cndmask_b32 v13,0,v125,vcc
v_and_b32 v124,2,v1
v_cmp_eq_u32 vcc,0,v124
v_mov_b32 v14,0xeeee
v_mov_b32 v124,0x4444
v_cndmask_b32 v14,v14,v124,vcc
v_lshlrev_b32 v11,14,v10
v_lshl_add_u32 v11,v9,4,v11
s_lshl_b32 s65,s51,15
s_add_u32 s65,s65,92274688
s_lshl_b32 s62,s47,10
s_add_u32 s62,s62,s65
s_lshl_b32 s63,s47,16
s_lshl_b32 s60,s46,8
s_add_u32 s63,s63,s60
s_mov_b32 s4,s38
s_mov_b32 s5,s39
s_mov_b32 s6,1835008
s_mov_b32 s7,0x20000
s_lshl_b32 s57,s46,11
s_add_u32 s57,s57,139264
v_add_u32 v8,s57,v0
v_and_b32 v2,1,v10
v_lshrrev_b32 v3,1,v10
v_lshlrev_b32 v2,7,v2
v_lshl_add_u32 v2,v3,10,v2
s_lshl_b32 s59,s46,8
s_add_u32 s59,s57,s59
v_add_u32 v2,s59,v2
s_mov_b32 s60,0x01000100
s_mov_b32 s61,0x03020302
s_waitcnt vmcnt(0)
L_mx_47:
v_max3_u32 v124,v88,v89,v90
v_max_u32 v124,v91,v124
v_cmp_eq_u32 vcc,-1,v124
s_cbranch_vccz L_mxd_48
buffer_load_dwordx4 v[88:91],v0,s[8:11],s58 offen sc1
s_sub_u32 s49,s49,1
s_cbranch_scc1 L_abort
s_waitcnt vmcnt(0)
s_branch L_mx_47
L_mxd_48:
buffer_load_dwordx4 v[24:27],v11,s[4:7],s63 offen offset:0
buffer_load_dwordx4 v[28:31],v11,s[4:7],s63 offen offset:1024
buffer_load_dwordx4 v[32:35],v11,s[4:7],s63 offen offset:2048
buffer_load_dwordx4 v[36:39],v11,s[4:7],s63 offen offset:3072
v_lshlrev_b32 v96,16,v88
v_and_b32 v97,0xffff0000,v88
v_lshlrev_b32 v98,16,v89
v_and_b32 v99,0xffff0000,v89
v_lshlrev_b32 v100,16,v90
v_and_b32 v101,0xffff0000,v90
v_lshlrev_b32 v102,16,v91
v_and_b32 v103,0xffff0000,v91
v_readfirstlane_b32 s78,v96
s_nop 1
v_pk_add_f32 v[108:109],v[96:97],s[78:79] op_sel_hi:[1,0] neg_lo:[0,1] neg_hi:[0,1]
v_pk_add_f32 v[110:111],v[98:99],s[78:79] op_sel_hi:[1,0] neg_lo:[0,1] neg_hi:[0,1]
v_pk_add_f32 v[112:113],v[100:101],s[78:79] op_sel_hi:[1,0] neg_lo:[0,1] neg_hi:[0,1]
v_pk_add_f32 v[114:115],v[102:103],s[78:79] op_sel_hi:[1,0] neg_lo:[0,1] neg_hi:[0,1]
v_pk_add_f32 v[116:117],v[108:109],v[110:111]
v_pk_mul_f32 v[118:119],v[108:109],v[108:109]
v_pk_add_f32 v[120:121],v[112:113],v[114:115]
v_pk_fma_f32 v[118:119],v[110:111],v[110:111],v[118:119]
v_pk_add_f32 v[116:117],v[116:117],v[120:121]
v_pk_fma_f32 v[118:119],v[112:113],v[112:113],v[118:119]
v_add_f32 v116,v116,v117
v_pk_fma_f32 v[118:119],v[114:115],v[114:115],v[118:119]
v_add_f32 v118,v118,v119
s_nop 1
v_permlane32_swap_b32 v116,v118
v_add_f32 v116,v116,v118
s_nop 1
v_add_f32_dpp v116,v116,v116 row_ror:8 row_mask:0xf bank_mask:0xf
s_nop 1
v_add_f32_dpp v116,v116,v116 row_ror:4 row_mask:0xf bank_mask:0xf
s_nop 1
v_add_f32_dpp v116,v116,v116 row_ror:2 row_mask:0xf bank_mask:0xf
s_nop 1
v_add_f32_dpp v116,v116,v116 row_ror:1 row_mask:0xf bank_mask:0xf
v_mov_b32 v118,v116
s_nop 1
v_permlane16_swap_b32 v116,v118
v_add_f32 v116,v116,v118
v_mul_f32 v116,0x3b000000,v116
v_mov_b32 v118,v116
s_nop 1
v_permlane32_swap_b32 v116,v118
v_fma_f32 v118,-v116,v116,v118
v_add_f32 v116,s78,v116
v_max_f32 v118,0,v118
v_cvt_pk_bf16_f32 v118,v116,v118
v_lshlrev_b32 v116,16,v118
v_and_b32 v118,0xffff0000,v118
v_add_f32 v118,0x3727c5ac,v118
v_cvt_pk_bf16_f32 v118,v118,v118
v_and_b32 v118,0xffff0000,v118
v_sqrt_f32 v118,v118
v_pk_add_f32 v[108:109],v[96:97],v[116:117] op_sel_hi:[1,0] neg_lo:[0,1] neg_hi:[0,1]
v_pk_add_f32 v[110:111],v[98:99],v[116:117] op_sel_hi:[1,0] neg_lo:[0,1] neg_hi:[0,1]
v_pk_add_f32 v[112:113],v[100:101],v[116:117] op_sel_hi:[1,0] neg_lo:[0,1] neg_hi:[0,1]
v_pk_add_f32 v[114:115],v[102:103],v[116:117] op_sel_hi:[1,0] neg_lo:[0,1] neg_hi:[0,1]
v_cvt_pk_bf16_f32 v118,v118,v118
v_and_b32 v118,0xffff0000,v118
v_rcp_f32 v118,v118
v_cvt_pk_bf16_f32 v104,v108,v109
v_cvt_pk_bf16_f32 v105,v110,v111
v_cvt_pk_bf16_f32 v106,v112,v113
v_cvt_pk_bf16_f32 v107,v114,v115
v_lshlrev_b32 v108,16,v104
v_and_b32 v109,0xffff0000,v104
v_lshlrev_b32 v110,16,v105
v_and_b32 v111,0xffff0000,v105
v_lshlrev_b32 v112,16,v106
v_and_b32 v113,0xffff0000,v106
v_lshlrev_b32 v114,16,v107
v_and_b32 v115,0xffff0000,v107
v_pk_mul_f32 v[108:109],v[108:109],v[118:119] op_sel_hi:[1,0]
v_pk_mul_f32 v[110:111],v[110:111],v[118:119] op_sel_hi:[1,0]
v_pk_mul_f32 v[112:113],v[112:113],v[118:119] op_sel_hi:[1,0]
v_pk_mul_f32 v[114:115],v[114:115],v[118:119] op_sel_hi:[1,0]
v_cvt_pk_bf16_f32 v104,v108,v109
v_cvt_pk_bf16_f32 v105,v110,v111
v_cvt_pk_bf16_f32 v106,v112,v113
v_cvt_pk_bf16_f32 v107,v114,v115
v_perm_b32 v88,v104,v104,s60
v_perm_b32 v89,v105,v105,s60
v_perm_b32 v90,v106,v106,s60
v_perm_b32 v91,v107,v107,s60
ds_write_b128 v8,v[88:91]
v_perm_b32 v92,v104,v104,s61
v_perm_b32 v93,v105,v105,s61
v_perm_b32 v94,v106,v106,s61
v_perm_b32 v95,v107,v107,s61
ds_write_b128 v8,v[92:95] offset:1024
s_mov_b32 s58,s57
ds_read_b128 v[88:91],v2 offset:0
ds_read_b128 v[92:95],v2 offset:64
ds_read_b128 v[108:111],v18 offset:0
ds_read_b128 v[112:115],v18 offset:1024
ds_read_b128 v[64:67],v18 offset:2048
ds_read_b128 v[68:71],v18 offset:3072
ds_read_b128 v[72:75],v18 offset:4096
ds_read_b128 v[76:79],v18 offset:5120
ds_read_b128 v[80:83],v18 offset:6144
ds_read_b128 v[84:87],v18 offset:7168
v_mov_b64 v[116:117],0
v_mov_b64 v[118:119],0
s_waitcnt lgkmcnt(8)
v_and_b32 v120,v12,v88
v_and_b32 v121,v13,v88
v_and_b32 v122,v12,v92
v_and_b32 v123,v13,v92
s_waitcnt lgkmcnt(6)
s_nop 0
v_smfmac_f32_16x16x64_bf16 v[116:119],v[120:123],v[108:115],v14
ds_read_b128 v[108:111],v18 offset:8192
ds_read_b128 v[112:115],v18 offset:9216
s_add_u32 s63,s63,4096
buffer_load_dwordx4 v[40:43],v11,s[4:7],s63 offen offset:0
v_and_b32 v124,v12,v89
v_and_b32 v125,v13,v89
v_and_b32 v126,v12,v93
v_and_b32 v127,v13,v93
s_waitcnt lgkmcnt(6)
s_nop 0
v_smfmac_f32_16x16x64_bf16 v[116:119],v[124:127],v[64:71],v14
ds_read_b128 v[64:67],v18 offset:10240
ds_read_b128 v[68:71],v18 offset:11264
buffer_load_dwordx4 v[44:47],v11,s[4:7],s63 offen offset:1024
v_and_b32 v120,v12,v90
v_and_b32 v121,v13,v90
v_and_b32 v122,v12,v94
v_and_b32 v123,v13,v94
s_waitcnt lgkmcnt(6)
s_nop 0
v_smfmac_f32_16x16x64_bf16 v[116:119],v[120:123],v[72:79],v14
ds_read_b128 v[72:75],v18 offset:12288
ds_read_b128 v[76:79],v18 offset:13312
buffer_load_dwordx4 v[48:51],v11,s[4:7],s63 offen offset:2048
v_and_b32 v124,v12,v91
v_and_b32 v125,v13,v91
v_and_b32 v126,v12,v95
v_and_b32 v127,v13,v95
ds_read_b128 v[88:91],v2 offset:16
ds_read_b128 v[92:95],v2 offset:80
s_waitcnt lgkmcnt(8)
v_smfmac_f32_16x16x64_bf16 v[116:119],v[124:127],v[80:87],v14
ds_read_b128 v[80:83],v18 offset:14336
ds_read_b128 v[84:87],v18 offset:15360
buffer_load_dwordx4 v[52:55],v11,s[4:7],s63 offen offset:3072
s_waitcnt lgkmcnt(2)
v_and_b32 v120,v12,v88
v_and_b32 v121,v13,v88
v_and_b32 v122,v12,v92
v_and_b32 v123,v13,v92
s_waitcnt lgkmcnt(8)
s_nop 0
v_smfmac_f32_16x16x64_bf16 v[116:119],v[120:123],v[108:115],v14
ds_read_b128 v[108:111],v18 offset:16384
ds_read_b128 v[112:115],v18 offset:17408
s_add_u32 s63,s63,4096
buffer_load_dwordx4 v[56:59],v11,s[4:7],s63 offen offset:0
v_and_b32 v124,v12,v89
v_and_b32 v125,v13,v89
v_and_b32 v126,v12,v93
v_and_b32 v127,v13,v93
s_waitcnt lgkmcnt(8)
s_nop 0
v_smfmac_f32_16x16x64_bf16 v[116:119],v[124:127],v[64:71],v14
ds_read_b128 v[64:67],v18 offset:18432
ds_read_b128 v[68:71],v18 offset:19456
buffer_load_dwordx4 v[60:63],v11,s[4:7],s63 offen offset:1024
v_and_b32 v120,v12,v90
v_and_b32 v121,v13,v90
v_and_b32 v122,v12,v94
v_and_b32 v123,v13,v94
s_waitcnt lgkmcnt(8)
s_nop 0
v_smfmac_f32_16x16x64_bf16 v[116:119],v[120:123],v[72:79],v14
ds_read_b128 v[72:75],v18 offset:20480
ds_read_b128 v[76:79],v18 offset:21504
buffer_load_dword v15,v0,s[8:11],s62 offen
v_and_b32 v124,v12,v91
v_and_b32 v125,v13,v91
v_and_b32 v126,v12,v95
v_and_b32 v127,v13,v95
ds_read_b128 v[88:91],v2 offset:32
ds_read_b128 v[92:95],v2 offset:96
s_waitcnt lgkmcnt(8)
v_smfmac_f32_16x16x64_bf16 v[116:119],v[124:127],v[80:87],v14
ds_read_b128 v[80:83],v18 offset:22528
ds_read_b128 v[84:87],v18 offset:23552
s_waitcnt lgkmcnt(2)
v_and_b32 v120,v12,v88
v_and_b32 v121,v13,v88
v_and_b32 v122,v12,v92
v_and_b32 v123,v13,v92
s_waitcnt lgkmcnt(8)
s_nop 0
v_smfmac_f32_16x16x64_bf16 v[116:119],v[120:123],v[108:115],v14
ds_read_b128 v[108:111],v18 offset:24576
ds_read_b128 v[112:115],v18 offset:25600
v_and_b32 v124,v12,v89
v_and_b32 v125,v13,v89
v_and_b32 v126,v12,v93
v_and_b32 v127,v13,v93
s_waitcnt lgkmcnt(8)
s_nop 0
v_smfmac_f32_16x16x64_bf16 v[116:119],v[124:127],v[64:71],v14
ds_read_b128 v[64:67],v18 offset:26624
ds_read_b128 v[68:71],v18 offset:27648
v_and_b32 v120,v12,v90
v_and_b32 v121,v13,v90
v_and_b32 v122,v12,v94
v_and_b32 v123,v13,v94
s_waitcnt lgkmcnt(8)
s_nop 0
v_smfmac_f32_16x16x64_bf16 v[116:119],v[120:123],v[72:79],v14
ds_read_b128 v[72:75],v18 offset:28672
ds_read_b128 v[76:79],v18 offset:29696
v_and_b32 v124,v12,v91
v_and_b32 v125,v13,v91
v_and_b32 v126,v12,v95
v_and_b32 v127,v13,v95
ds_read_b128 v[88:91],v2 offset:48
ds_read_b128 v[92:95],v2 offset:112
s_waitcnt lgkmcnt(8)
v_smfmac_f32_16x16x64_bf16 v[116:119],v[124:127],v[80:87],v14
ds_read_b128 v[80:83],v18 offset:30720
ds_read_b128 v[84:87],v18 offset:31744
s_waitcnt lgkmcnt(2)
v_and_b32 v120,v12,v88
v_and_b32 v121,v13,v88
v_and_b32 v122,v12,v92
v_and_b32 v123,v13,v92
s_waitcnt lgkmcnt(8)
s_nop 0
v_smfmac_f32_16x16x64_bf16 v[116:119],v[120:123],v[108:115],v14
v_and_b32 v124,v12,v89
v_and_b32 v125,v13,v89
v_and_b32 v126,v12,v93
v_and_b32 v127,v13,v93
s_waitcnt lgkmcnt(6)
s_nop 0
v_smfmac_f32_16x16x64_bf16 v[116:119],v[124:127],v[64:71],v14
buffer_load_dwordx4 v[64:67],v11,s[4:7],s63 offen offset:2048
buffer_load_dwordx4 v[68:71],v11,s[4:7],s63 offen offset:3072
v_and_b32 v120,v12,v90
v_and_b32 v121,v13,v90
v_and_b32 v122,v12,v94
v_and_b32 v123,v13,v94
s_waitcnt lgkmcnt(4)
s_nop 0
v_smfmac_f32_16x16x64_bf16 v[116:119],v[120:123],v[72:79],v14
s_add_u32 s63,s63,4096
buffer_load_dwordx4 v[72:75],v11,s[4:7],s63 offen offset:0
buffer_load_dwordx4 v[76:79],v11,s[4:7],s63 offen offset:1024
v_and_b32 v124,v12,v91
v_and_b32 v125,v13,v91
v_and_b32 v126,v12,v95
v_and_b32 v127,v13,v95
s_waitcnt lgkmcnt(0)
s_nop 0
v_smfmac_f32_16x16x64_bf16 v[116:119],v[124:127],v[80:87],v14
buffer_load_dwordx4 v[80:83],v11,s[4:7],s63 offen offset:2048
buffer_load_dwordx4 v[84:87],v11,s[4:7],s63 offen offset:3072
v_lshlrev_b32 v8,5,v9
v_and_b32 v124,1,v10
v_lshl_add_u32 v8,v124,4,v8
v_lshrrev_b32 v124,1,v10
v_lshl_add_u32 v8,v124,11,v8
s_lshl_b32 s60,s46,9
s_add_u32 s60,s60,147456
v_add_u32 v8,s60,v8
ds_write_b128 v8,v[116:119]
v_lshlrev_b32 v8,2,v1
v_add_u32 v8,147456,v8
v_and_b32 v2,1,v1
v_lshrrev_b32 v3,1,v1
v_lshlrev_b32 v3,2,v3
v_lshl_add_u32 v2,v2,7,v3
v_add_u32 v2,s58,v2
v_lshlrev_b32 v3,6,v10
v_add_u32 v3,s58,v3
s_waitcnt lgkmcnt(0)
s_barrier
ds_read2st64_b32 v[88:89],v8 offset0:0 offset1:1
ds_read2st64_b32 v[90:91],v8 offset0:2 offset1:3
ds_read2st64_b32 v[92:93],v8 offset0:4 offset1:5
ds_read2st64_b32 v[94:95],v8 offset0:6 offset1:7
s_waitcnt lgkmcnt(0)
v_pk_add_f32 v[88:89],v[88:89],v[90:91]
v_pk_add_f32 v[92:93],v[92:93],v[94:95]
v_pk_add_f32 v[88:89],v[88:89],v[92:93]
v_cvt_pk_bf16_f32 v88,v88,v88
v_and_b32 v88,0xffff0000,v88
v_cvt_pk_bf16_f32 v89,v89,v89
v_and_b32 v89,0xffff0000,v89
v_mul_f32 v90,0xbfb8aa3b,v88
v_exp_f32 v90,v90
s_nop 0
v_add_f32 v90,1.0,v90
v_rcp_f32 v90,v90
s_nop 0
v_mul_f32 v88,v88,v90
v_cvt_pk_bf16_f32 v88,v88,v88
v_and_b32 v88,0xffff0000,v88
v_mul_f32 v88,v88,v89
v_cvt_pk_bf16_f32 v88,v88,v88
ds_write_b32 v2,v88
ds_read_b128 v[88:91],v3
ds_read_b128 v[108:111],v3 offset:32
ds_read_b128 v[92:95],v3 offset:16
ds_read_b128 v[112:115],v3 offset:48
v_mov_b64 v[116:117],0
v_mov_b64 v[118:119],0
s_waitcnt vmcnt(0) lgkmcnt(0)
v_and_b32 v120,v12,v88
v_and_b32 v121,v13,v88
v_and_b32 v122,v12,v108
v_and_b32 v123,v13,v108
v_and_b32 v124,v12,v89
v_and_b32 v125,v13,v89
v_smfmac_f32_16x16x64_bf16 v[116:119],v[120:123],v[24:31],v14
v_and_b32 v126,v12,v109
v_and_b32 v127,v13,v109
v_and_b32 v120,v12,v90
v_and_b32 v121,v13,v90
v_smfmac_f32_16x16x64_bf16 v[116:119],v[124:127],v[32:39],v14
v_and_b32 v122,v12,v110
v_and_b32 v123,v13,v110
v_and_b32 v124,v12,v91
v_and_b32 v125,v13,v91
v_smfmac_f32_16x16x64_bf16 v[116:119],v[120:123],v[40:47],v14
v_and_b32 v126,v12,v111
v_and_b32 v127,v13,v111
v_and_b32 v120,v12,v92
v_and_b32 v121,v13,v92
v_smfmac_f32_16x16x64_bf16 v[116:119],v[124:127],v[48:55],v14
v_and_b32 v122,v12,v112
v_and_b32 v123,v13,v112
v_and_b32 v124,v12,v93
v_and_b32 v125,v13,v93
v_smfmac_f32_16x16x64_bf16 v[116:119],v[120:123],v[56:63],v14
v_and_b32 v126,v12,v113
v_and_b32 v127,v13,v113
v_and_b32 v120,v12,v94
v_and_b32 v121,v13,v94
v_smfmac_f32_16x16x64_bf16 v[116:119],v[124:127],v[64:71],v14
v_and_b32 v122,v12,v114
v_and_b32 v123,v13,v114
v_and_b32 v124,v12,v95
v_and_b32 v125,v13,v95
v_smfmac_f32_16x16x64_bf16 v[116:119],v[120:123],v[72:79],v14
v_and_b32 v126,v12,v115
v_and_b32 v127,v13,v115
s_nop 1
v_smfmac_f32_16x16x64_bf16 v[116:119],v[124:127],v[80:87],v14
v_lshlrev_b32 v8,4,v9
v_and_b32 v124,1,v10
v_lshl_add_u32 v8,v124,3,v8
v_and_b32 v124,2,v10
v_lshl_add_u32 v8,v124,30,v8
s_lshl_b32 s60,s46,8
s_add_u32 s59,s62,s60
s_nop 0
v_cvt_pk_bf16_f32 v24,v116,v117
v_cvt_pk_bf16_f32 v25,v118,v119
buffer_store_dwordx2 v[24:25],v8,s[8:11],s59 offen
s_lshl_b32 s59,s51,13
s_lshl2_add_u32 s59,s47,s59
s_add_u32 s59,s59,10486912
s_waitcnt vmcnt(0)
s_barrier
s_or_b32 s59,s59,s52
buffer_store_dword v17,off,s[8:11],s59
s_lshl_b32 s59,s51,13
s_add_u32 s59,s59,10486912
v_and_b32 v124,31,v1
v_lshlrev_b32 v124,2,v124
L_fw_50:
buffer_load_dword v125,v124,s[8:11],s59 offen sc1
s_sub_u32 s49,s49,1
s_cbranch_scc1 L_abort
s_waitcnt vmcnt(0)
v_cmp_eq_u32 vcc,0,v125
s_cbranch_vccnz L_fw_50
s_add_u32 s63,s65,0
buffer_load_dwordx4 v[24:27],v22,s[8:11],s63 offen sc1
s_add_u32 s63,s65,4096
buffer_load_dwordx4 v[28:31],v22,s[8:11],s63 offen sc1
s_add_u32 s63,s65,8192
buffer_load_dwordx4 v[32:35],v22,s[8:11],s63 offen sc1
s_add_u32 s63,s65,12288
buffer_load_dwordx4 v[36:39],v22,s[8:11],s63 offen sc1
s_add_u32 s63,s65,16384
buffer_load_dwordx4 v[40:43],v22,s[8:11],s63 offen sc1
s_add_u32 s63,s65,20480
buffer_load_dwordx4 v[44:47],v22,s[8:11],s63 offen sc1
s_add_u32 s63,s65,24576
buffer_load_dwordx4 v[48:51],v22,s[8:11],s63 offen sc1
s_add_u32 s63,s65,28672
buffer_load_dwordx4 v[52:55],v22,s[8:11],s63 offen sc1
v_and_b32 v64,15,v1
v_and_b32 v65,1,v1
v_lshlrev_b32 v65,4,v65
v_mov_b32 v66,0x3f80
v_lshlrev_b32 v66,v65,v66
v_lshrrev_b32 v64,1,v64
v_cmp_eq_u32 vcc,0,v64
s_nop 1
v_cndmask_b32 v56,0,v66,vcc
v_cmp_eq_u32 vcc,1,v64
s_nop 1
v_cndmask_b32 v57,0,v66,vcc
v_cmp_eq_u32 vcc,2,v64
s_nop 1
v_cndmask_b32 v58,0,v66,vcc
v_cmp_eq_u32 vcc,3,v64
s_nop 1
v_cndmask_b32 v59,0,v66,vcc
s_waitcnt vmcnt(7)
s_nop 0
v_mfma_f32_16x16x32_bf16 v[60:63],v[56:59],v[24:27],0
s_waitcnt vmcnt(6)
v_mfma_f32_16x16x32_bf16 v[60:63],v[56:59],v[28:31],v[60:63]
s_waitcnt vmcnt(5)
v_mfma_f32_16x16x32_bf16 v[60:63],v[56:59],v[32:35],v[60:63]
s_waitcnt vmcnt(4)
v_mfma_f32_16x16x32_bf16 v[60:63],v[56:59],v[36:39],v[60:63]
s_waitcnt vmcnt(3)
v_mfma_f32_16x16x32_bf16 v[60:63],v[56:59],v[40:43],v[60:63]
s_waitcnt vmcnt(2)
v_mfma_f32_16x16x32_bf16 v[60:63],v[56:59],v[44:47],v[60:63]
s_waitcnt vmcnt(1)
v_mfma_f32_16x16x32_bf16 v[60:63],v[56:59],v[48:51],v[60:63]
s_waitcnt vmcnt(0)
v_mfma_f32_16x16x32_bf16 v[60:63],v[56:59],v[52:55],v[60:63]
s_nop 7
ds_write_b128 v21,v[60:63]
s_waitcnt lgkmcnt(0)
s_barrier
s_cmp_lg_u32 s46,0
s_cbranch_scc1 L_moed_49
v_lshlrev_b32 v56,5,v1
v_add_u32 v56,155648,v56
ds_read_b128 v[24:27],v56
ds_read_b128 v[28:31],v56 offset:16
s_and_b32 s59,s54,0xffff0000
s_xor_b32 s60,s59,0x80000000
s_xor_b32 s61,s59,0xffff0000
s_cmp_lt_i32 s59,0
s_cselect_b32 s59,s60,s61
v_mov_b32 v56,s59
v_mul_f32 v56,0xbfb8aa3b,v56
v_exp_f32 v56,v56
s_nop 0
v_add_f32 v56,1.0,v56
v_rcp_f32 v56,v56
s_nop 0
v_cvt_pk_bf16_f32 v56,v56,v56
v_and_b32 v56,0xffff0000,v56
v_lshlrev_b32 v48,16,v104
v_and_b32 v49,0xffff0000,v104
v_lshlrev_b32 v50,16,v105
v_and_b32 v51,0xffff0000,v105
v_lshlrev_b32 v52,16,v106
v_and_b32 v53,0xffff0000,v106
v_lshlrev_b32 v54,16,v107
v_and_b32 v55,0xffff0000,v107
s_waitcnt lgkmcnt(0)
v_cvt_pk_bf16_f32 v40,v24,v25
v_cvt_pk_bf16_f32 v41,v26,v27
v_cvt_pk_bf16_f32 v42,v28,v29
v_cvt_pk_bf16_f32 v43,v30,v31
v_lshlrev_b32 v24,16,v40
v_and_b32 v25,0xffff0000,v40
v_lshlrev_b32 v26,16,v41
v_and_b32 v27,0xffff0000,v41
v_lshlrev_b32 v28,16,v42
v_and_b32 v29,0xffff0000,v42
v_lshlrev_b32 v30,16,v43
v_and_b32 v31,0xffff0000,v43
v_pk_mul_f32 v[24:25],v[24:25],v[56:57] op_sel_hi:[1,0]
v_pk_mul_f32 v[26:27],v[26:27],v[56:57] op_sel_hi:[1,0]
v_pk_mul_f32 v[28:29],v[28:29],v[56:57] op_sel_hi:[1,0]
v_pk_mul_f32 v[30:31],v[30:31],v[56:57] op_sel_hi:[1,0]
v_cvt_pk_bf16_f32 v40,v24,v25
v_cvt_pk_bf16_f32 v41,v26,v27
v_cvt_pk_bf16_f32 v42,v28,v29
v_cvt_pk_bf16_f32 v43,v30,v31
v_lshlrev_b32 v24,16,v40
v_and_b32 v25,0xffff0000,v40
v_lshlrev_b32 v26,16,v41
v_and_b32 v27,0xffff0000,v41
v_lshlrev_b32 v28,16,v42
v_and_b32 v29,0xffff0000,v42
v_lshlrev_b32 v30,16,v43
v_and_b32 v31,0xffff0000,v43
v_pk_add_f32 v[24:25],v[24:25],v[48:49]
v_pk_add_f32 v[26:27],v[26:27],v[50:51]
v_pk_add_f32 v[28:29],v[28:29],v[52:53]
v_pk_add_f32 v[30:31],v[30:31],v[54:55]
v_cvt_pk_bf16_f32 v40,v24,v25
v_cvt_pk_bf16_f32 v41,v26,v27
v_cvt_pk_bf16_f32 v42,v28,v29
v_cvt_pk_bf16_f32 v43,v30,v31
v_lshlrev_b32 v24,16,v40
v_and_b32 v25,0xffff0000,v40
v_lshlrev_b32 v26,16,v41
v_and_b32 v27,0xffff0000,v41
v_lshlrev_b32 v28,16,v42
v_and_b32 v29,0xffff0000,v42
v_lshlrev_b32 v30,16,v43
v_and_b32 v31,0xffff0000,v43
v_pk_add_f32 v[96:97],v[96:97],v[24:25]
v_pk_add_f32 v[98:99],v[98:99],v[26:27]
v_pk_add_f32 v[100:101],v[100:101],v[28:29]
v_pk_add_f32 v[102:103],v[102:103],v[30:31]
v_cvt_pk_bf16_f32 v80,v96,v97
v_cvt_pk_bf16_f32 v81,v98,v99
v_cvt_pk_bf16_f32 v82,v100,v101
v_cvt_pk_bf16_f32 v83,v102,v103
v_lshlrev_b32 v96,16,v80
v_and_b32 v97,0xffff0000,v80
v_lshlrev_b32 v98,16,v81
v_and_b32 v99,0xffff0000,v81
v_lshlrev_b32 v100,16,v82
v_and_b32 v101,0xffff0000,v82
v_lshlrev_b32 v102,16,v83
v_and_b32 v103,0xffff0000,v83
v_readfirstlane_b32 s78,v96
s_nop 1
v_pk_add_f32 v[58:59],v[96:97],s[78:79] op_sel_hi:[1,0] neg_lo:[0,1] neg_hi:[0,1]
v_pk_add_f32 v[60:61],v[98:99],s[78:79] op_sel_hi:[1,0] neg_lo:[0,1] neg_hi:[0,1]
v_pk_add_f32 v[62:63],v[100:101],s[78:79] op_sel_hi:[1,0] neg_lo:[0,1] neg_hi:[0,1]
v_pk_add_f32 v[64:65],v[102:103],s[78:79] op_sel_hi:[1,0] neg_lo:[0,1] neg_hi:[0,1]
v_pk_add_f32 v[66:67],v[58:59],v[60:61]
v_pk_mul_f32 v[68:69],v[58:59],v[58:59]
v_pk_add_f32 v[70:71],v[62:63],v[64:65]
v_pk_fma_f32 v[68:69],v[60:61],v[60:61],v[68:69]
v_pk_add_f32 v[66:67],v[66:67],v[70:71]
v_pk_fma_f32 v[68:69],v[62:63],v[62:63],v[68:69]
v_add_f32 v66,v66,v67
v_pk_fma_f32 v[68:69],v[64:65],v[64:65],v[68:69]
v_add_f32 v68,v68,v69
s_nop 1
v_permlane32_swap_b32 v66,v68
v_add_f32 v66,v66,v68
s_nop 1
v_add_f32_dpp v66,v66,v66 row_ror:8 row_mask:0xf bank_mask:0xf
s_nop 1
v_add_f32_dpp v66,v66,v66 row_ror:4 row_mask:0xf bank_mask:0xf
s_nop 1
v_add_f32_dpp v66,v66,v66 row_ror:2 row_mask:0xf bank_mask:0xf
s_nop 1
v_add_f32_dpp v66,v66,v66 row_ror:1 row_mask:0xf bank_mask:0xf
v_mov_b32 v68,v66
s_nop 1
v_permlane16_swap_b32 v66,v68
v_add_f32 v66,v66,v68
v_mul_f32 v66,0x3b000000,v66
v_mov_b32 v68,v66
s_nop 1
v_permlane32_swap_b32 v66,v68
v_fma_f32 v68,-v66,v66,v68
v_add_f32 v66,s78,v66
v_max_f32 v68,0,v68
v_cvt_pk_bf16_f32 v68,v66,v68
v_lshlrev_b32 v66,16,v68
v_and_b32 v68,0xffff0000,v68
v_add_f32 v68,0x3727c5ac,v68
v_cvt_pk_bf16_f32 v68,v68,v68
v_and_b32 v68,0xffff0000,v68
v_sqrt_f32 v68,v68
v_pk_add_f32 v[58:59],v[96:97],v[66:67] op_sel_hi:[1,0] neg_lo:[0,1] neg_hi:[0,1]
v_pk_add_f32 v[60:61],v[98:99],v[66:67] op_sel_hi:[1,0] neg_lo:[0,1] neg_hi:[0,1]
v_pk_add_f32 v[62:63],v[100:101],v[66:67] op_sel_hi:[1,0] neg_lo:[0,1] neg_hi:[0,1]
v_pk_add_f32 v[64:65],v[102:103],v[66:67] op_sel_hi:[1,0] neg_lo:[0,1] neg_hi:[0,1]
v_cvt_pk_bf16_f32 v68,v68,v68
v_and_b32 v68,0xffff0000,v68
v_rcp_f32 v68,v68
v_cvt_pk_bf16_f32 v84,v58,v59
v_cvt_pk_bf16_f32 v85,v60,v61
v_cvt_pk_bf16_f32 v86,v62,v63
v_cvt_pk_bf16_f32 v87,v64,v65
v_lshlrev_b32 v58,16,v84
v_and_b32 v59,0xffff0000,v84
v_lshlrev_b32 v60,16,v85
v_and_b32 v61,0xffff0000,v85
v_lshlrev_b32 v62,16,v86
v_and_b32 v63,0xffff0000,v86
v_lshlrev_b32 v64,16,v87
v_and_b32 v65,0xffff0000,v87
v_pk_mul_f32 v[58:59],v[58:59],v[68:69] op_sel_hi:[1,0]
v_pk_mul_f32 v[60:61],v[60:61],v[68:69] op_sel_hi:[1,0]
v_pk_mul_f32 v[62:63],v[62:63],v[68:69] op_sel_hi:[1,0]
v_pk_mul_f32 v[64:65],v[64:65],v[68:69] op_sel_hi:[1,0]
v_cvt_pk_bf16_f32 v84,v58,v59
v_cvt_pk_bf16_f32 v85,v60,v61
v_cvt_pk_bf16_f32 v86,v62,v63
v_cvt_pk_bf16_f32 v87,v64,v65
s_lshl_b32 s58,s51,10
s_add_u32 s58,s58,11272192
s_add_u32 s59,s58,65536
s_cmp_eq_u32 s47,0
s_cselect_b32 s59,s59,0x80000000
s_add_u32 s57,s56,98566144
buffer_store_dwordx4 v[84:87],v0,s[8:11],s59 offen sc1
buffer_store_dwordx4 v[80:83],v0,s[8:11],s58 offen sc1
buffer_store_dwordx4 v[84:87],v0,s[8:11],s57 offen sc1
L_moed_49:
s_barrier
L_mo_36:
s_mov_b32 s77,-1
s_cmp_lt_u32 s31,64
s_cbranch_scc1 L_mo_32
s_cmp_eq_u32 s86,0
s_cbranch_scc1 L_mo_45
L_mo_38:
s_andn2_b32 s51,0x7ff,s54
s_lshr_b32 s51,s51,5
s_andn2_b32 s56,31,s54
v_lshrrev_b32 v2,10,v20
v_add_u32 v3,16,v2
v_add_u32 v8,96468992,v20
v_cmp_eq_u32 vcc,s56,v2
s_nop 1
v_cndmask_b32 v2,v20,v8,vcc
v_cmp_eq_u32 vcc,s56,v3
s_nop 1
v_cndmask_b32 v3,v20,v8,vcc
s_waitcnt vmcnt(0)
s_lshl_b32 s59,s51,13
s_add_u32 s59,s59,10487552
s_cmp_lg_u32 s46,0
s_cbranch_scc1 L_fd_54
v_and_b32 v124,31,v1
v_lshlrev_b32 v124,2,v124
s_branch L_ff_55
L_fw_53:
s_sleep 2
L_ff_55:
buffer_load_dword v125,v124,s[8:11],s59 offen sc1
s_sub_u32 s49,s49,1
s_cbranch_scc1 L_abort
s_waitcnt vmcnt(0)
v_cmp_eq_u32 vcc,0,v125
s_cbranch_vccnz L_fw_53
L_fd_54:
s_barrier
s_or_b32 s72,s72,s52
buffer_store_dword v17,off,s[8:11],s72 sc1
s_lshl_b32 s66,s51,15
s_add_u32 s66,s66,2097152
s_add_u32 s67,s66,16384
s_add_u32 m0,s50,131072
s_nop 0
buffer_load_dwordx4 v2,s[8:11],s66 offen offset:0 sc1 lds
s_add_u32 m0,s50,135168
s_nop 0
buffer_load_dwordx4 v3,s[8:11],s67 offen offset:0 sc1 lds
s_add_u32 m0,s50,139008
s_nop 0
buffer_load_dwordx4 v2,s[8:11],s66 offen offset:256 sc1 lds
s_add_u32 m0,s50,143104
s_nop 0
buffer_load_dwordx4 v3,s[8:11],s67 offen offset:256 sc1 lds
s_add_u32 m0,s50,146944
s_nop 0
buffer_load_dwordx4 v2,s[8:11],s66 offen offset:512 sc1 lds
s_add_u32 m0,s50,151040
s_nop 0
buffer_load_dwordx4 v3,s[8:11],s67 offen offset:512 sc1 lds
s_waitcnt vmcnt(4)
s_barrier
ds_read_b128 v[104:107],v4 offset:0
ds_read_b128 v[108:111],v4 offset:4096
ds_read_b128 v[112:115],v5 offset:0
ds_read_b128 v[116:119],v5 offset:4096
s_add_u32 m0,s50,154880
s_nop 0
buffer_load_dwordx4 v2,s[8:11],s66 offen offset:768 sc1 lds
s_add_u32 m0,s50,158976
s_nop 0
buffer_load_dwordx4 v3,s[8:11],s67 offen offset:768 sc1 lds
s_waitcnt lgkmcnt(2)
v_mfma_f32_16x16x32_bf16 v[24:27],a[128:131],v[104:107],0
ds_read_b128 v[120:123],v6 offset:0
v_mfma_f32_16x16x32_bf16 v[40:43],v[104:107],v[128:131],0
s_lshl_b32 s58,s51,5
v_mfma_f32_16x16x32_bf16 v[28:31],a[128:131],v[108:111],0
ds_read_b128 v[124:127],v6 offset:4096
v_mfma_f32_16x16x32_bf16 v[44:47],v[108:111],v[128:131],0
s_add_u32 s58,s58,s47
v_mfma_f32_16x16x32_bf16 v[32:35],a[136:139],v[104:107],0
s_mul_i32 s58,s58,24576
v_mfma_f32_16x16x32_bf16 v[48:51],v[104:107],v[136:139],0
s_add_u32 s58,s58,201326592
v_mfma_f32_16x16x32_bf16 v[36:39],a[136:139],v[108:111],0
s_add_u32 s61,s58,s50
v_mfma_f32_16x16x32_bf16 v[52:55],v[108:111],v[136:139],0
s_add_u32 s62,s61,4096
s_waitcnt lgkmcnt(2)
v_mfma_f32_16x16x32_bf16 v[24:27],a[132:135],v[112:115],v[24:27]
ds_read_b128 v[104:107],v7 offset:0
v_mfma_f32_16x16x32_bf16 v[40:43],v[112:115],v[132:135],v[40:43]
s_add_u32 s63,s61,16384
v_mfma_f32_16x16x32_bf16 v[28:31],a[132:135],v[116:119],v[28:31]
ds_read_b128 v[108:111],v7 offset:4096
v_mfma_f32_16x16x32_bf16 v[44:47],v[116:119],v[132:135],v[44:47]
s_add_u32 s64,s61,20480
v_mfma_f32_16x16x32_bf16 v[32:35],a[140:143],v[112:115],v[32:35]
s_add_u32 s65,s61,s50
v_mfma_f32_16x16x32_bf16 v[48:51],v[112:115],v[140:143],v[48:51]
s_add_u32 s65,s65,8192
v_mfma_f32_16x16x32_bf16 v[36:39],a[140:143],v[116:119],v[36:39]
v_mfma_f32_16x16x32_bf16 v[52:55],v[116:119],v[140:143],v[52:55]
s_waitcnt vmcnt(4)
s_barrier
s_waitcnt lgkmcnt(2)
v_mfma_f32_16x16x32_bf16 v[24:27],a[144:147],v[120:123],v[24:27]
ds_read_b128 v[112:115],v4 offset:8192
v_mfma_f32_16x16x32_bf16 v[40:43],v[120:123],v[144:147],v[40:43]
v_mfma_f32_16x16x32_bf16 v[28:31],a[144:147],v[124:127],v[28:31]
ds_read_b128 v[116:119],v4 offset:12288
v_mfma_f32_16x16x32_bf16 v[44:47],v[124:127],v[144:147],v[44:47]
v_mfma_f32_16x16x32_bf16 v[32:35],a[152:155],v[120:123],v[32:35]
v_mfma_f32_16x16x32_bf16 v[48:51],v[120:123],v[152:155],v[48:51]
v_mfma_f32_16x16x32_bf16 v[36:39],a[152:155],v[124:127],v[36:39]
v_mfma_f32_16x16x32_bf16 v[52:55],v[124:127],v[152:155],v[52:55]
s_waitcnt lgkmcnt(2)
v_mfma_f32_16x16x32_bf16 v[24:27],a[148:151],v[104:107],v[24:27]
ds_read_b128 v[120:123],v5 offset:8192
v_mfma_f32_16x16x32_bf16 v[40:43],v[104:107],v[148:151],v[40:43]
v_mfma_f32_16x16x32_bf16 v[28:31],a[148:151],v[108:111],v[28:31]
ds_read_b128 v[124:127],v5 offset:12288
v_mfma_f32_16x16x32_bf16 v[44:47],v[108:111],v[148:151],v[44:47]
v_mfma_f32_16x16x32_bf16 v[32:35],a[156:159],v[104:107],v[32:35]
v_mfma_f32_16x16x32_bf16 v[48:51],v[104:107],v[156:159],v[48:51]
v_mfma_f32_16x16x32_bf16 v[36:39],a[156:159],v[108:111],v[36:39]
v_mfma_f32_16x16x32_bf16 v[52:55],v[108:111],v[156:159],v[52:55]
s_waitcnt lgkmcnt(2)
v_mfma_f32_16x16x32_bf16 v[24:27],a[160:163],v[112:115],v[24:27]
ds_read_b128 v[104:107],v6 offset:8192
v_mfma_f32_16x16x32_bf16 v[40:43],v[112:115],v[160:163],v[40:43]
v_mfma_f32_16x16x32_bf16 v[28:31],a[160:163],v[116:119],v[28:31]
ds_read_b128 v[108:111],v6 offset:12288
v_mfma_f32_16x16x32_bf16 v[44:47],v[116:119],v[160:163],v[44:47]
v_mfma_f32_16x16x32_bf16 v[32:35],a[168:171],v[112:115],v[32:35]
v_mfma_f32_16x16x32_bf16 v[48:51],v[112:115],v[168:171],v[48:51]
v_mfma_f32_16x16x32_bf16 v[36:39],a[168:171],v[116:119],v[36:39]
v_mfma_f32_16x16x32_bf16 v[52:55],v[116:119],v[168:171],v[52:55]
s_waitcnt lgkmcnt(2)
v_mfma_f32_16x16x32_bf16 v[24:27],a[164:167],v[120:123],v[24:27]
ds_read_b128 v[112:115],v7 offset:8192
v_mfma_f32_16x16x32_bf16 v[40:43],v[120:123],v[164:167],v[40:43]
v_mfma_f32_16x16x32_bf16 v[28:31],a[164:167],v[124:127],v[28:31]
ds_read_b128 v[116:119],v7 offset:12288
v_mfma_f32_16x16x32_bf16 v[44:47],v[124:127],v[164:167],v[44:47]
v_mfma_f32_16x16x32_bf16 v[32:35],a[172:175],v[120:123],v[32:35]
v_mfma_f32_16x16x32_bf16 v[48:51],v[120:123],v[172:175],v[48:51]
v_mfma_f32_16x16x32_bf16 v[36:39],a[172:175],v[124:127],v[36:39]
v_mfma_f32_16x16x32_bf16 v[52:55],v[124:127],v[172:175],v[52:55]
s_waitcnt vmcnt(2)
s_barrier
s_waitcnt lgkmcnt(2)
v_mfma_f32_16x16x32_bf16 v[24:27],a[176:179],v[104:107],v[24:27]
ds_read_b128 v[120:123],v4 offset:16384
v_mfma_f32_16x16x32_bf16 v[40:43],v[104:107],v[176:179],v[40:43]
v_mfma_f32_16x16x32_bf16 v[28:31],a[176:179],v[108:111],v[28:31]
ds_read_b128 v[124:127],v4 offset:20480
v_mfma_f32_16x16x32_bf16 v[44:47],v[108:111],v[176:179],v[44:47]
v_mfma_f32_16x16x32_bf16 v[32:35],a[184:187],v[104:107],v[32:35]
v_mfma_f32_16x16x32_bf16 v[48:51],v[104:107],v[184:187],v[48:51]
v_mfma_f32_16x16x32_bf16 v[36:39],a[184:187],v[108:111],v[36:39]
v_mfma_f32_16x16x32_bf16 v[52:55],v[108:111],v[184:187],v[52:55]
s_waitcnt lgkmcnt(2)
v_mfma_f32_16x16x32_bf16 v[24:27],a[180:183],v[112:115],v[24:27]
ds_read_b128 v[104:107],v5 offset:16384
v_mfma_f32_16x16x32_bf16 v[40:43],v[112:115],v[180:183],v[40:43]
v_mfma_f32_16x16x32_bf16 v[28:31],a[180:183],v[116:119],v[28:31]
ds_read_b128 v[108:111],v5 offset:20480
v_mfma_f32_16x16x32_bf16 v[44:47],v[116:119],v[180:183],v[44:47]
v_mfma_f32_16x16x32_bf16 v[32:35],a[188:191],v[112:115],v[32:35]
v_mfma_f32_16x16x32_bf16 v[48:51],v[112:115],v[188:191],v[48:51]
v_mfma_f32_16x16x32_bf16 v[36:39],a[188:191],v[116:119],v[36:39]
v_mfma_f32_16x16x32_bf16 v[52:55],v[116:119],v[188:191],v[52:55]
s_waitcnt lgkmcnt(2)
v_mfma_f32_16x16x32_bf16 v[24:27],a[192:195],v[120:123],v[24:27]
ds_read_b128 v[112:115],v6 offset:16384
v_mfma_f32_16x16x32_bf16 v[40:43],v[120:123],v[192:195],v[40:43]
v_mfma_f32_16x16x32_bf16 v[28:31],a[192:195],v[124:127],v[28:31]
ds_read_b128 v[116:119],v6 offset:20480
v_mfma_f32_16x16x32_bf16 v[44:47],v[124:127],v[192:195],v[44:47]
v_mfma_f32_16x16x32_bf16 v[32:35],a[200:203],v[120:123],v[32:35]
v_mfma_f32_16x16x32_bf16 v[48:51],v[120:123],v[200:203],v[48:51]
v_mfma_f32_16x16x32_bf16 v[36:39],a[200:203],v[124:127],v[36:39]
v_mfma_f32_16x16x32_bf16 v[52:55],v[124:127],v[200:203],v[52:55]
s_waitcnt lgkmcnt(2)
v_mfma_f32_16x16x32_bf16 v[24:27],a[196:199],v[104:107],v[24:27]
ds_read_b128 v[120:123],v7 offset:16384
v_mfma_f32_16x16x32_bf16 v[40:43],v[104:107],v[196:199],v[40:43]
v_mfma_f32_16x16x32_bf16 v[28:31],a[196:199],v[108:111],v[28:31]
ds_read_b128 v[124:127],v7 offset:20480
v_mfma_f32_16x16x32_bf16 v[44:47],v[108:111],v[196:199],v[44:47]
v_mfma_f32_16x16x32_bf16 v[32:35],a[204:207],v[104:107],v[32:35]
v_mfma_f32_16x16x32_bf16 v[48:51],v[104:107],v[204:207],v[48:51]
v_mfma_f32_16x16x32_bf16 v[36:39],a[204:207],v[108:111],v[36:39]
v_mfma_f32_16x16x32_bf16 v[52:55],v[108:111],v[204:207],v[52:55]
s_waitcnt vmcnt(0)
s_barrier
s_waitcnt lgkmcnt(2)
v_mfma_f32_16x16x32_bf16 v[24:27],a[208:211],v[112:115],v[24:27]
ds_read_b128 v[104:107],v4 offset:24576
v_mfma_f32_16x16x32_bf16 v[40:43],v[112:115],v[208:211],v[40:43]
v_mfma_f32_16x16x32_bf16 v[28:31],a[208:211],v[116:119],v[28:31]
ds_read_b128 v[108:111],v4 offset:28672
v_mfma_f32_16x16x32_bf16 v[44:47],v[116:119],v[208:211],v[44:47]
v_mfma_f32_16x16x32_bf16 v[32:35],a[216:219],v[112:115],v[32:35]
v_mfma_f32_16x16x32_bf16 v[48:51],v[112:115],v[216:219],v[48:51]
v_mfma_f32_16x16x32_bf16 v[36:39],a[216:219],v[116:119],v[36:39]
v_mfma_f32_16x16x32_bf16 v[52:55],v[116:119],v[216:219],v[52:55]
s_waitcnt lgkmcnt(2)
v_mfma_f32_16x16x32_bf16 v[24:27],a[212:215],v[120:123],v[24:27]
ds_read_b128 v[112:115],v5 offset:24576
v_mfma_f32_16x16x32_bf16 v[40:43],v[120:123],v[212:215],v[40:43]
v_mfma_f32_16x16x32_bf16 v[28:31],a[212:215],v[124:127],v[28:31]
ds_read_b128 v[116:119],v5 offset:28672
v_mfma_f32_16x16x32_bf16 v[44:47],v[124:127],v[212:215],v[44:47]
v_mfma_f32_16x16x32_bf16 v[32:35],a[220:223],v[120:123],v[32:35]
v_mfma_f32_16x16x32_bf16 v[48:51],v[120:123],v[220:223],v[48:51]
v_mfma_f32_16x16x32_bf16 v[36:39],a[220:223],v[124:127],v[36:39]
v_mfma_f32_16x16x32_bf16 v[52:55],v[124:127],v[220:223],v[52:55]
s_waitcnt lgkmcnt(2)
v_mfma_f32_16x16x32_bf16 v[24:27],a[224:227],v[104:107],v[24:27]
ds_read_b128 v[120:123],v6 offset:24576
v_mfma_f32_16x16x32_bf16 v[40:43],v[104:107],v[224:227],v[40:43]
v_mfma_f32_16x16x32_bf16 v[28:31],a[224:227],v[108:111],v[28:31]
ds_read_b128 v[124:127],v6 offset:28672
v_mfma_f32_16x16x32_bf16 v[44:47],v[108:111],v[224:227],v[44:47]
v_mfma_f32_16x16x32_bf16 v[32:35],a[232:235],v[104:107],v[32:35]
v_mfma_f32_16x16x32_bf16 v[48:51],v[104:107],v[232:235],v[48:51]
v_mfma_f32_16x16x32_bf16 v[36:39],a[232:235],v[108:111],v[36:39]
v_mfma_f32_16x16x32_bf16 v[52:55],v[108:111],v[232:235],v[52:55]
s_waitcnt lgkmcnt(2)
v_mfma_f32_16x16x32_bf16 v[24:27],a[228:231],v[112:115],v[24:27]
ds_read_b128 v[104:107],v7 offset:24576
v_mfma_f32_16x16x32_bf16 v[40:43],v[112:115],v[228:231],v[40:43]
v_mfma_f32_16x16x32_bf16 v[28:31],a[228:231],v[116:119],v[28:31]
ds_read_b128 v[108:111],v7 offset:28672
v_mfma_f32_16x16x32_bf16 v[44:47],v[116:119],v[228:231],v[44:47]
v_mfma_f32_16x16x32_bf16 v[32:35],a[236:239],v[112:115],v[32:35]
v_mfma_f32_16x16x32_bf16 v[48:51],v[112:115],v[236:239],v[48:51]
v_mfma_f32_16x16x32_bf16 v[36:39],a[236:239],v[116:119],v[36:39]
v_mfma_f32_16x16x32_bf16 v[52:55],v[116:119],v[236:239],v[52:55]
s_waitcnt lgkmcnt(2)
v_mfma_f32_16x16x32_bf16 v[24:27],a[240:243],v[120:123],v[24:27]
ds_read_b128 v[112:115],v4 offset:0
v_mfma_f32_16x16x32_bf16 v[40:43],v[120:123],v[240:243],v[40:43]
v_mfma_f32_16x16x32_bf16 v[28:31],a[240:243],v[124:127],v[28:31]
ds_read_b128 v[116:119],v4 offset:4096
v_mfma_f32_16x16x32_bf16 v[44:47],v[124:127],v[240:243],v[44:47]
v_mfma_f32_16x16x32_bf16 v[32:35],a[248:251],v[120:123],v[32:35]
v_mfma_f32_16x16x32_bf16 v[48:51],v[120:123],v[248:251],v[48:51]
v_mfma_f32_16x16x32_bf16 v[36:39],a[248:251],v[124:127],v[36:39]
v_mfma_f32_16x16x32_bf16 v[52:55],v[124:127],v[248:251],v[52:55]
s_waitcnt lgkmcnt(2)
v_mfma_f32_16x16x32_bf16 v[24:27],a[244:247],v[104:107],v[24:27]
ds_read_b128 v[120:123],v5 offset:0
v_mfma_f32_16x16x32_bf16 v[40:43],v[104:107],v[244:247],v[40:43]
v_mfma_f32_16x16x32_bf16 v[28:31],a[244:247],v[108:111],v[28:31]
ds_read_b128 v[124:127],v5 offset:4096
v_mfma_f32_16x16x32_bf16 v[44:47],v[108:111],v[244:247],v[44:47]
v_mfma_f32_16x16x32_bf16 v[32:35],a[252:255],v[104:107],v[32:35]
v_mfma_f32_16x16x32_bf16 v[48:51],v[104:107],v[252:255],v[48:51]
v_mfma_f32_16x16x32_bf16 v[36:39],a[252:255],v[108:111],v[36:39]
v_mfma_f32_16x16x32_bf16 v[52:55],v[108:111],v[252:255],v[52:55]
s_waitcnt lgkmcnt(2)
v_mfma_f32_16x16x32_bf16 v[88:91],a[0:3],v[112:115],0
ds_read_b128 v[104:107],v6 offset:0
v_mfma_f32_16x16x32_bf16 v[92:95],a[0:3],v[116:119],0
v_mfma_f32_16x16x32_bf16 v[96:99],a[8:11],v[112:115],0
ds_read_b128 v[108:111],v6 offset:4096
v_cvt_pk_bf16_f32 v56,v24,v32
v_cvt_pk_bf16_f32 v57,v25,v33
v_mfma_f32_16x16x32_bf16 v[100:103],a[8:11],v[116:119],0
v_cvt_pk_bf16_f32 v58,v26,v34
v_cvt_pk_bf16_f32 v59,v27,v35
s_waitcnt lgkmcnt(2)
v_mfma_f32_16x16x32_bf16 v[88:91],a[4:7],v[120:123],v[88:91]
ds_read_b128 v[112:115],v7 offset:0
v_mfma_f32_16x16x32_bf16 v[92:95],a[4:7],v[124:127],v[92:95]
buffer_store_dwordx4 v[56:59],v0,s[8:11],s61 offen sc1
v_cvt_pk_bf16_f32 v60,v28,v36
v_cvt_pk_bf16_f32 v61,v29,v37
v_mfma_f32_16x16x32_bf16 v[96:99],a[12:15],v[120:123],v[96:99]
ds_read_b128 v[116:119],v7 offset:4096
v_cvt_pk_bf16_f32 v62,v30,v38
v_cvt_pk_bf16_f32 v63,v31,v39
v_mfma_f32_16x16x32_bf16 v[100:103],a[12:15],v[124:127],v[100:103]
buffer_store_dwordx4 v[60:63],v0,s[8:11],s62 offen sc1
v_cvt_pk_bf16_f32 v64,v40,v41
v_cvt_pk_bf16_f32 v65,v42,v43
s_waitcnt lgkmcnt(2)
v_mfma_f32_16x16x32_bf16 v[88:91],a[16:19],v[104:107],v[88:91]
ds_read_b128 v[120:123],v4 offset:8192
v_cvt_pk_bf16_f32 v66,v44,v45
v_cvt_pk_bf16_f32 v67,v46,v47
v_mfma_f32_16x16x32_bf16 v[92:95],a[16:19],v[108:111],v[92:95]
buffer_store_dwordx4 v[64:67],v0,s[8:11],s65 offen offset:0 sc1
v_cvt_pk_bf16_f32 v68,v48,v49
v_cvt_pk_bf16_f32 v69,v50,v51
v_mfma_f32_16x16x32_bf16 v[96:99],a[24:27],v[104:107],v[96:99]
ds_read_b128 v[124:127],v4 offset:12288
v_cvt_pk_bf16_f32 v70,v52,v53
v_cvt_pk_bf16_f32 v71,v54,v55
v_mfma_f32_16x16x32_bf16 v[100:103],a[24:27],v[108:111],v[100:103]
buffer_store_dwordx4 v[68:71],v0,s[8:11],s65 offen offset:1024 sc1
s_waitcnt lgkmcnt(2)
v_mfma_f32_16x16x32_bf16 v[88:91],a[20:23],v[112:115],v[88:91]
ds_read_b128 v[104:107],v5 offset:8192
v_mfma_f32_16x16x32_bf16 v[92:95],a[20:23],v[116:119],v[92:95]
v_mfma_f32_16x16x32_bf16 v[96:99],a[28:31],v[112:115],v[96:99]
ds_read_b128 v[108:111],v5 offset:12288
v_mfma_f32_16x16x32_bf16 v[100:103],a[28:31],v[116:119],v[100:103]
s_waitcnt lgkmcnt(2)
v_mfma_f32_16x16x32_bf16 v[88:91],a[32:35],v[120:123],v[88:91]
ds_read_b128 v[112:115],v6 offset:8192
v_mfma_f32_16x16x32_bf16 v[92:95],a[32:35],v[124:127],v[92:95]
v_mfma_f32_16x16x32_bf16 v[96:99],a[40:43],v[120:123],v[96:99]
ds_read_b128 v[116:119],v6 offset:12288
v_mfma_f32_16x16x32_bf16 v[100:103],a[40:43],v[124:127],v[100:103]
s_waitcnt lgkmcnt(2)
v_mfma_f32_16x16x32_bf16 v[88:91],a[36:39],v[104:107],v[88:91]
ds_read_b128 v[120:123],v7 offset:8192
v_mfma_f32_16x16x32_bf16 v[92:95],a[36:39],v[108:111],v[92:95]
v_mfma_f32_16x16x32_bf16 v[96:99],a[44:47],v[104:107],v[96:99]
ds_read_b128 v[124:127],v7 offset:12288
v_mfma_f32_16x16x32_bf16 v[100:103],a[44:47],v[108:111],v[100:103]
s_waitcnt lgkmcnt(2)
v_mfma_f32_16x16x32_bf16 v[88:91],a[48:51],v[112:115],v[88:91]
ds_read_b128 v[104:107],v4 offset:16384
v_mfma_f32_16x16x32_bf16 v[92:95],a[48:51],v[116:119],v[92:95]
v_mfma_f32_16x16x32_bf16 v[96:99],a[56:59],v[112:115],v[96:99]
ds_read_b128 v[108:111],v4 offset:20480
v_mfma_f32_16x16x32_bf16 v[100:103],a[56:59],v[116:119],v[100:103]
s_waitcnt lgkmcnt(2)
v_mfma_f32_16x16x32_bf16 v[88:91],a[52:55],v[120:123],v[88:91]
ds_read_b128 v[112:115],v5 offset:16384
v_mfma_f32_16x16x32_bf16 v[92:95],a[52:55],v[124:127],v[92:95]
v_mfma_f32_16x16x32_bf16 v[96:99],a[60:63],v[120:123],v[96:99]
ds_read_b128 v[116:119],v5 offset:20480
v_mfma_f32_16x16x32_bf16 v[100:103],a[60:63],v[124:127],v[100:103]
s_waitcnt lgkmcnt(2)
v_mfma_f32_16x16x32_bf16 v[88:91],a[64:67],v[104:107],v[88:91]
ds_read_b128 v[120:123],v6 offset:16384
v_mfma_f32_16x16x32_bf16 v[92:95],a[64:67],v[108:111],v[92:95]
v_mfma_f32_16x16x32_bf16 v[96:99],a[72:75],v[104:107],v[96:99]
ds_read_b128 v[124:127],v6 offset:20480
v_mfma_f32_16x16x32_bf16 v[100:103],a[72:75],v[108:111],v[100:103]
s_waitcnt lgkmcnt(2)
v_mfma_f32_16x16x32_bf16 v[88:91],a[68:71],v[112:115],v[88:91]
ds_read_b128 v[104:107],v7 offset:16384
v_mfma_f32_16x16x32_bf16 v[92:95],a[68:71],v[116:119],v[92:95]
v_mfma_f32_16x16x32_bf16 v[96:99],a[76:79],v[112:115],v[96:99]
ds_read_b128 v[108:111],v7 offset:20480
v_mfma_f32_16x16x32_bf16 v[100:103],a[76:79],v[116:119],v[100:103]
s_waitcnt lgkmcnt(2)
v_mfma_f32_16x16x32_bf16 v[88:91],a[80:83],v[120:123],v[88:91]
ds_read_b128 v[112:115],v4 offset:24576
v_mfma_f32_16x16x32_bf16 v[92:95],a[80:83],v[124:127],v[92:95]
v_mfma_f32_16x16x32_bf16 v[96:99],a[88:91],v[120:123],v[96:99]
ds_read_b128 v[116:119],v4 offset:28672
v_mfma_f32_16x16x32_bf16 v[100:103],a[88:91],v[124:127],v[100:103]
s_waitcnt lgkmcnt(2)
v_mfma_f32_16x16x32_bf16 v[88:91],a[84:87],v[104:107],v[88:91]
ds_read_b128 v[120:123],v5 offset:24576
v_mfma_f32_16x16x32_bf16 v[92:95],a[84:87],v[108:111],v[92:95]
v_mfma_f32_16x16x32_bf16 v[96:99],a[92:95],v[104:107],v[96:99]
ds_read_b128 v[124:127],v5 offset:28672
v_mfma_f32_16x16x32_bf16 v[100:103],a[92:95],v[108:111],v[100:103]
s_waitcnt lgkmcnt(2)
v_mfma_f32_16x16x32_bf16 v[88:91],a[96:99],v[112:115],v[88:91]
ds_read_b128 v[104:107],v6 offset:24576
v_mfma_f32_16x16x32_bf16 v[92:95],a[96:99],v[116:119],v[92:95]
v_mfma_f32_16x16x32_bf16 v[96:99],a[104:107],v[112:115],v[96:99]
ds_read_b128 v[108:111],v6 offset:28672
v_mfma_f32_16x16x32_bf16 v[100:103],a[104:107],v[116:119],v[100:103]
s_waitcnt lgkmcnt(2)
v_mfma_f32_16x16x32_bf16 v[88:91],a[100:103],v[120:123],v[88:91]
ds_read_b128 v[112:115],v7 offset:24576
v_mfma_f32_16x16x32_bf16 v[92:95],a[100:103],v[124:127],v[92:95]
v_mfma_f32_16x16x32_bf16 v[96:99],a[108:111],v[120:123],v[96:99]
ds_read_b128 v[116:119],v7 offset:28672
v_mfma_f32_16x16x32_bf16 v[100:103],a[108:111],v[124:127],v[100:103]
s_waitcnt lgkmcnt(2)
v_mfma_f32_16x16x32_bf16 v[88:91],a[112:115],v[104:107],v[88:91]
v_mfma_f32_16x16x32_bf16 v[92:95],a[112:115],v[108:111],v[92:95]
v_mfma_f32_16x16x32_bf16 v[96:99],a[120:123],v[104:107],v[96:99]
v_mfma_f32_16x16x32_bf16 v[100:103],a[120:123],v[108:111],v[100:103]
s_waitcnt lgkmcnt(0)
v_mfma_f32_16x16x32_bf16 v[88:91],a[116:119],v[112:115],v[88:91]
v_mfma_f32_16x16x32_bf16 v[92:95],a[116:119],v[116:119],v[92:95]
v_mfma_f32_16x16x32_bf16 v[96:99],a[124:127],v[112:115],v[96:99]
v_mfma_f32_16x16x32_bf16 v[100:103],a[124:127],v[116:119],v[100:103]
s_nop 3
v_cvt_pk_bf16_f32 v104,v88,v96
v_cvt_pk_bf16_f32 v105,v89,v97
v_cvt_pk_bf16_f32 v106,v90,v98
v_cvt_pk_bf16_f32 v107,v91,v99
v_cvt_pk_bf16_f32 v108,v92,v100
v_cvt_pk_bf16_f32 v109,v93,v101
v_cvt_pk_bf16_f32 v110,v94,v102
v_cvt_pk_bf16_f32 v111,v95,v103
buffer_store_dwordx4 v[104:107],v0,s[8:11],s63 offen sc1
buffer_store_dwordx4 v[108:111],v0,s[8:11],s64 offen sc1
s_waitcnt vmcnt(6)
s_barrier
s_add_u32 m0,s50,131072
s_nop 0
buffer_load_dwordx4 v20,s[8:11],s70 offen offset:0 sc1 lds
s_add_u32 m0,s50,135168
s_nop 0
buffer_load_dwordx4 v20,s[8:11],s71 offen offset:0 sc1 lds
s_add_u32 m0,s50,139008
s_nop 0
buffer_load_dwordx4 v20,s[8:11],s70 offen offset:256 sc1 lds
s_add_u32 m0,s50,143104
s_nop 0
buffer_load_dwordx4 v20,s[8:11],s71 offen offset:256 sc1 lds
s_add_u32 m0,s50,146944
s_nop 0
buffer_load_dwordx4 v20,s[8:11],s70 offen offset:512 sc1 lds
s_add_u32 m0,s50,151040
s_nop 0
buffer_load_dwordx4 v20,s[8:11],s71 offen offset:512 sc1 lds
s_lshl_b32 s59,s51,13
s_lshl2_add_u32 s59,s47,s59
s_add_u32 s59,s59,10487680
s_waitcnt vmcnt(0)
s_barrier
s_or_b32 s59,s59,s52
buffer_store_dword v17,off,s[8:11],s59 sc1
s_mov_b32 s72,0x80000000
s_mov_b32 s86,0
s_mov_b32 s19,1
s_mov_b32 s18,0
s_cmp_lt_u32 s31,64
s_cbranch_scc1 L_mo_32
L_mo_45:
s_mov_b32 s51,64
v_and_b32 v9,15,v1
v_lshrrev_b32 v10,4,v1
v_and_b32 v124,1,v1
v_lshlrev_b32 v124,4,v124
v_mov_b32 v125,0xffff
v_lshlrev_b32 v125,v124,v125
v_lshrrev_b32 v124,2,v9
v_cmp_eq_u32 vcc,0,v124
s_nop 1
v_cndmask_b32 v12,0,v125,vcc
v_cmp_eq_u32 vcc,1,v124
s_nop 1
v_cndmask_b32 v13,0,v125,vcc
v_and_b32 v124,2,v1
v_cmp_eq_u32 vcc,0,v124
v_mov_b32 v14,0xeeee
v_mov_b32 v124,0x4444
v_cndmask_b32 v14,v14,v124,vcc
v_lshlrev_b32 v11,14,v10
v_lshl_add_u32 v11,v9,4,v11
s_lshl_b32 s65,s51,15
s_add_u32 s65,s65,92274688
s_lshl_b32 s62,s47,10
s_add_u32 s62,s62,s65
s_lshl_b32 s63,s47,16
s_lshl_b32 s60,s46,8
s_add_u32 s63,s63,s60
s_mov_b32 s4,s38
s_mov_b32 s5,s39
s_mov_b32 s6,1835008
s_mov_b32 s7,0x20000
buffer_load_dwordx4 v[24:27],v11,s[4:7],s63 offen offset:0
buffer_load_dwordx4 v[28:31],v11,s[4:7],s63 offen offset:1024
buffer_load_dwordx4 v[32:35],v11,s[4:7],s63 offen offset:2048
buffer_load_dwordx4 v[36:39],v11,s[4:7],s63 offen offset:3072
s_add_u32 s63,s63,4096
buffer_load_dwordx4 v[40:43],v11,s[4:7],s63 offen offset:0
buffer_load_dwordx4 v[44:47],v11,s[4:7],s63 offen offset:1024
buffer_load_dwordx4 v[48:51],v11,s[4:7],s63 offen offset:2048
buffer_load_dwordx4 v[52:55],v11,s[4:7],s63 offen offset:3072
s_add_u32 s63,s63,4096
buffer_load_dwordx4 v[56:59],v11,s[4:7],s63 offen offset:0
buffer_load_dwordx4 v[60:63],v11,s[4:7],s63 offen offset:1024
buffer_load_dwordx4 v[64:67],v11,s[4:7],s63 offen offset:2048
buffer_load_dwordx4 v[68:71],v11,s[4:7],s63 offen offset:3072
s_add_u32 s63,s63,4096
buffer_load_dwordx4 v[72:75],v11,s[4:7],s63 offen offset:0
buffer_load_dwordx4 v[76:79],v11,s[4:7],s63 offen offset:1024
buffer_load_dwordx4 v[80:83],v11,s[4:7],s63 offen offset:2048
buffer_load_dwordx4 v[84:87],v11,s[4:7],s63 offen offset:3072
buffer_load_dword v15,v0,s[8:11],s62 offen
ds_read_b128 a[0:3],v18 offset:0
ds_read_b128 a[4:7],v18 offset:1024
ds_read_b128 a[8:11],v18 offset:2048
ds_read_b128 a[12:15],v18 offset:3072
ds_read_b128 a[16:19],v18 offset:4096
ds_read_b128 a[20:23],v18 offset:5120
ds_read_b128 a[24:27],v18 offset:6144
ds_read_b128 a[28:31],v18 offset:7168
ds_read_b128 a[32:35],v18 offset:8192
ds_read_b128 a[36:39],v18 offset:9216
ds_read_b128 a[40:43],v18 offset:10240
ds_read_b128 a[44:47],v18 offset:11264
ds_read_b128 a[48:51],v18 offset:12288
ds_read_b128 a[52:55],v18 offset:13312
ds_read_b128 a[56:59],v18 offset:14336
ds_read_b128 a[60:63],v18 offset:15360
ds_read_b128 a[64:67],v18 offset:16384
ds_read_b128 a[68:71],v18 offset:17408
ds_read_b128 a[72:75],v18 offset:18432
ds_read_b128 a[76:79],v18 offset:19456
ds_read_b128 a[80:83],v18 offset:20480
ds_read_b128 a[84:87],v18 offset:21504
ds_read_b128 a[88:91],v18 offset:22528
ds_read_b128 a[92:95],v18 offset:23552
ds_read_b128 a[96:99],v18 offset:24576
ds_read_b128 a[100:103],v18 offset:25600
ds_read_b128 a[104:107],v18 offset:26624
ds_read_b128 a[108:111],v18 offset:27648
ds_read_b128 a[112:115],v18 offset:28672
ds_read_b128 a[116:119],v18 offset:29696
ds_read_b128 a[120:123],v18 offset:30720
ds_read_b128 a[124:127],v18 offset:31744
s_and_b32 s61,s54,0x7ff
s_sub_u32 s61,2047,s61
s_lshr_b32 s61,s61,5
s_cmp_lg_u32 s46,0
s_cbranch_scc1 L_mw_56
s_mov_b32 s59,11018240
v_lshlrev_b32 v2,2,v1
L_fp_57:
s_sleep 2
buffer_load_dword v3,v2,s[8:11],s59 offen sc1
s_sub_u32 s49,s49,1
s_cbranch_scc1 L_abort
s_waitcnt vmcnt(0)
v_cmp_eq_u32 vcc,0,v3
s_cbranch_vccnz L_fp_57
v_cmp_le_u32 vcc,s61,v1
s_nop 1
v_cndmask_b32 v2,1,2,vcc
v_cmp_ne_u32 s[84:85],v2,v3
s_lshl_b32 s56,s47,1
s_lshr_b64 s[20:21],s[84:85],s56
v_lshrrev_b32 v2,5,v1
v_lshrrev_b32 v3,v2,s20
v_and_b32 v3,1,v3
v_mul_u32_u24 v3,768,v3
v_lshlrev_b32 v2,13,v2
v_sub_u32 v2,v2,v3
v_and_b32 v3,31,v1
v_lshl_add_u32 v2,v3,2,v2
v_add_u32 v2,1536,v2
s_lshl_b32 s59,s47,14
s_add_u32 s59,s59,10485760
v_mov_b32 v3,1
s_cmp_ge_u32 s47,28
s_cbranch_scc1 L_mf_58
L_fp_64:
s_sleep 1
buffer_load_dword v3,v2,s[8:11],s59 offen sc1
s_sub_u32 s49,s49,1
s_cbranch_scc1 L_abort
s_waitcnt vmcnt(0)
v_cmp_eq_u32 vcc,0,v3
s_cbranch_vccnz L_fp_64
v_max_u32_dpp v3,v3,v3 row_ror:8 row_mask:0xf bank_mask:0xf
s_nop 1
v_max_u32_dpp v3,v3,v3 row_ror:4 row_mask:0xf bank_mask:0xf
s_nop 1
v_max_u32_dpp v3,v3,v3 row_ror:2 row_mask:0xf bank_mask:0xf
s_nop 1
v_max_u32_dpp v3,v3,v3 row_ror:1 row_mask:0xf bank_mask:0xf
v_mov_b32 v2,v3
s_nop 1
v_permlane16_swap_b32 v3,v2
v_max_u32 v3,v3,v2
v_mov_b32 v2,v3
s_nop 1
v_permlane32_swap_b32 v3,v2
v_max_u32 v3,v3,v2
L_mf_58:
s_lshl_b32 s59,s51,13
s_lshl2_add_u32 s59,s47,s59
s_add_u32 s59,s59,10487424
buffer_store_dword v3,off,s[8:11],s59
L_mw_56:
s_barrier
s_lshl_b32 s59,s51,13
s_add_u32 s59,s59,10487424
v_and_b32 v124,31,v1
v_lshlrev_b32 v124,2,v124
s_branch L_ff_67
L_fw_65:
s_sleep 1
L_ff_67:
buffer_load_dword v125,v124,s[8:11],s59 offen sc1
s_sub_u32 s49,s49,1
s_cbranch_scc1 L_abort
s_waitcnt vmcnt(0)
v_cmp_eq_u32 vcc,0,v125
s_cbranch_vccnz L_fw_65
v_max_u32_dpp v125,v125,v125 row_ror:8 row_mask:0xf bank_mask:0xf
s_nop 1
v_max_u32_dpp v125,v125,v125 row_ror:4 row_mask:0xf bank_mask:0xf
s_nop 1
v_max_u32_dpp v125,v125,v125 row_ror:2 row_mask:0xf bank_mask:0xf
s_nop 1
v_max_u32_dpp v125,v125,v125 row_ror:1 row_mask:0xf bank_mask:0xf
v_mov_b32 v124,v125
s_nop 1
v_permlane16_swap_b32 v125,v124
v_max_u32 v125,v125,v124
v_mov_b32 v124,v125
s_nop 1
v_permlane32_swap_b32 v125,v124
v_max_u32 v125,v125,v124
s_nop 0
v_readfirstlane_b32 s55,v125
L_mf_59:
s_andn2_b32 s64,0x7ff,s55
s_lshl_b32 s56,s64,10
s_add_u32 s58,s56,6291456
buffer_load_dwordx4 v[88:91],v0,s[8:11],s58 offen sc1
s_lshl_b32 s57,s46,11
s_add_u32 s57,s57,139264
v_add_u32 v8,s57,v0
v_and_b32 v2,1,v10
v_lshrrev_b32 v3,1,v10
v_lshlrev_b32 v2,7,v2
v_lshl_add_u32 v2,v3,10,v2
s_lshl_b32 s59,s46,8
s_add_u32 s59,s57,s59
v_add_u32 v2,s59,v2
s_mov_b32 s60,0x01000100
s_mov_b32 s61,0x03020302
s_waitcnt vmcnt(0)
v_lshlrev_b32 v96,16,v88
v_and_b32 v97,0xffff0000,v88
v_lshlrev_b32 v98,16,v89
v_and_b32 v99,0xffff0000,v89
v_lshlrev_b32 v100,16,v90
v_and_b32 v101,0xffff0000,v90
v_lshlrev_b32 v102,16,v91
v_and_b32 v103,0xffff0000,v91
v_readfirstlane_b32 s78,v96
s_nop 1
v_pk_add_f32 v[108:109],v[96:97],s[78:79] op_sel_hi:[1,0] neg_lo:[0,1] neg_hi:[0,1]
v_pk_add_f32 v[110:111],v[98:99],s[78:79] op_sel_hi:[1,0] neg_lo:[0,1] neg_hi:[0,1]
v_pk_add_f32 v[112:113],v[100:101],s[78:79] op_sel_hi:[1,0] neg_lo:[0,1] neg_hi:[0,1]
v_pk_add_f32 v[114:115],v[102:103],s[78:79] op_sel_hi:[1,0] neg_lo:[0,1] neg_hi:[0,1]
v_pk_add_f32 v[116:117],v[108:109],v[110:111]
v_pk_mul_f32 v[118:119],v[108:109],v[108:109]
v_pk_add_f32 v[120:121],v[112:113],v[114:115]
v_pk_fma_f32 v[118:119],v[110:111],v[110:111],v[118:119]
v_pk_add_f32 v[116:117],v[116:117],v[120:121]
v_pk_fma_f32 v[118:119],v[112:113],v[112:113],v[118:119]
v_add_f32 v116,v116,v117
v_pk_fma_f32 v[118:119],v[114:115],v[114:115],v[118:119]
v_add_f32 v118,v118,v119
s_nop 1
v_permlane32_swap_b32 v116,v118
v_add_f32 v116,v116,v118
s_nop 1
v_add_f32_dpp v116,v116,v116 row_ror:8 row_mask:0xf bank_mask:0xf
s_nop 1
v_add_f32_dpp v116,v116,v116 row_ror:4 row_mask:0xf bank_mask:0xf
s_nop 1
v_add_f32_dpp v116,v116,v116 row_ror:2 row_mask:0xf bank_mask:0xf
s_nop 1
v_add_f32_dpp v116,v116,v116 row_ror:1 row_mask:0xf bank_mask:0xf
v_mov_b32 v118,v116
s_nop 1
v_permlane16_swap_b32 v116,v118
v_add_f32 v116,v116,v118
v_mul_f32 v116,0x3b000000,v116
v_mov_b32 v118,v116
s_nop 1
v_permlane32_swap_b32 v116,v118
v_fma_f32 v118,-v116,v116,v118
v_add_f32 v116,s78,v116
v_max_f32 v118,0,v118
v_cvt_pk_bf16_f32 v118,v116,v118
v_lshlrev_b32 v116,16,v118
v_and_b32 v118,0xffff0000,v118
v_add_f32 v118,0x3727c5ac,v118
v_cvt_pk_bf16_f32 v118,v118,v118
v_and_b32 v118,0xffff0000,v118
v_sqrt_f32 v118,v118
v_pk_add_f32 v[108:109],v[96:97],v[116:117] op_sel_hi:[1,0] neg_lo:[0,1] neg_hi:[0,1]
v_pk_add_f32 v[110:111],v[98:99],v[116:117] op_sel_hi:[1,0] neg_lo:[0,1] neg_hi:[0,1]
v_pk_add_f32 v[112:113],v[100:101],v[116:117] op_sel_hi:[1,0] neg_lo:[0,1] neg_hi:[0,1]
v_pk_add_f32 v[114:115],v[102:103],v[116:117] op_sel_hi:[1,0] neg_lo:[0,1] neg_hi:[0,1]
v_cvt_pk_bf16_f32 v118,v118,v118
v_and_b32 v118,0xffff0000,v118
v_rcp_f32 v118,v118
v_cvt_pk_bf16_f32 v104,v108,v109
v_cvt_pk_bf16_f32 v105,v110,v111
v_cvt_pk_bf16_f32 v106,v112,v113
v_cvt_pk_bf16_f32 v107,v114,v115
v_lshlrev_b32 v108,16,v104
v_and_b32 v109,0xffff0000,v104
v_lshlrev_b32 v110,16,v105
v_and_b32 v111,0xffff0000,v105
v_lshlrev_b32 v112,16,v106
v_and_b32 v113,0xffff0000,v106
v_lshlrev_b32 v114,16,v107
v_and_b32 v115,0xffff0000,v107
v_pk_mul_f32 v[108:109],v[108:109],v[118:119] op_sel_hi:[1,0]
v_pk_mul_f32 v[110:111],v[110:111],v[118:119] op_sel_hi:[1,0]
v_pk_mul_f32 v[112:113],v[112:113],v[118:119] op_sel_hi:[1,0]
v_pk_mul_f32 v[114:115],v[114:115],v[118:119] op_sel_hi:[1,0]
v_cvt_pk_bf16_f32 v104,v108,v109
v_cvt_pk_bf16_f32 v105,v110,v111
v_cvt_pk_bf16_f32 v106,v112,v113
v_cvt_pk_bf16_f32 v107,v114,v115
v_perm_b32 v88,v104,v104,s60
v_perm_b32 v89,v105,v105,s60
v_perm_b32 v90,v106,v106,s60
v_perm_b32 v91,v107,v107,s60
ds_write_b128 v8,v[88:91]
v_perm_b32 v92,v104,v104,s61
v_perm_b32 v93,v105,v105,s61
v_perm_b32 v94,v106,v106,s61
v_perm_b32 v95,v107,v107,s61
ds_write_b128 v8,v[92:95] offset:1024
s_mov_b32 s58,s57
ds_read_b128 v[128:131],v2 offset:0
ds_read_b128 v[144:147],v2 offset:64
ds_read_b128 v[132:135],v2 offset:16
ds_read_b128 v[148:151],v2 offset:80
ds_read_b128 v[136:139],v2 offset:32
ds_read_b128 v[152:155],v2 offset:96
ds_read_b128 v[140:143],v2 offset:48
ds_read_b128 v[156:159],v2 offset:112
v_mov_b64 v[116:117],0
v_mov_b64 v[118:119],0
s_waitcnt lgkmcnt(6)
v_and_b32 v120,v12,v128
v_and_b32 v121,v13,v128
v_and_b32 v122,v12,v144
v_and_b32 v123,v13,v144
v_and_b32 v124,v12,v129
v_and_b32 v125,v13,v129
v_smfmac_f32_16x16x64_bf16 v[116:119],v[120:123],a[0:7],v14
v_and_b32 v126,v12,v145
v_and_b32 v127,v13,v145
v_and_b32 v120,v12,v130
v_and_b32 v121,v13,v130
v_smfmac_f32_16x16x64_bf16 v[116:119],v[124:127],a[8:15],v14
v_and_b32 v122,v12,v146
v_and_b32 v123,v13,v146
v_and_b32 v124,v12,v131
v_and_b32 v125,v13,v131
v_smfmac_f32_16x16x64_bf16 v[116:119],v[120:123],a[16:23],v14
v_and_b32 v126,v12,v147
v_and_b32 v127,v13,v147
s_waitcnt lgkmcnt(4)
v_and_b32 v120,v12,v132
v_and_b32 v121,v13,v132
v_smfmac_f32_16x16x64_bf16 v[116:119],v[124:127],a[24:31],v14
v_and_b32 v122,v12,v148
v_and_b32 v123,v13,v148
v_and_b32 v124,v12,v133
v_and_b32 v125,v13,v133
v_smfmac_f32_16x16x64_bf16 v[116:119],v[120:123],a[32:39],v14
v_and_b32 v126,v12,v149
v_and_b32 v127,v13,v149
v_and_b32 v120,v12,v134
v_and_b32 v121,v13,v134
v_smfmac_f32_16x16x64_bf16 v[116:119],v[124:127],a[40:47],v14
v_and_b32 v122,v12,v150
v_and_b32 v123,v13,v150
v_and_b32 v124,v12,v135
v_and_b32 v125,v13,v135
v_smfmac_f32_16x16x64_bf16 v[116:119],v[120:123],a[48:55],v14
v_and_b32 v126,v12,v151
v_and_b32 v127,v13,v151
s_waitcnt lgkmcnt(2)
v_and_b32 v120,v12,v136
v_and_b32 v121,v13,v136
v_smfmac_f32_16x16x64_bf16 v[116:119],v[124:127],a[56:63],v14
v_and_b32 v122,v12,v152
v_and_b32 v123,v13,v152
v_and_b32 v124,v12,v137
v_and_b32 v125,v13,v137
v_smfmac_f32_16x16x64_bf16 v[116:119],v[120:123],a[64:71],v14
v_and_b32 v126,v12,v153
v_and_b32 v127,v13,v153
v_and_b32 v120,v12,v138
v_and_b32 v121,v13,v138
v_smfmac_f32_16x16x64_bf16 v[116:119],v[124:127],a[72:79],v14
v_and_b32 v122,v12,v154
v_and_b32 v123,v13,v154
v_and_b32 v124,v12,v139
v_and_b32 v125,v13,v139
v_smfmac_f32_16x16x64_bf16 v[116:119],v[120:123],a[80:87],v14
v_and_b32 v126,v12,v155
v_and_b32 v127,v13,v155
s_waitcnt lgkmcnt(0)
v_and_b32 v120,v12,v140
v_and_b32 v121,v13,v140
v_smfmac_f32_16x16x64_bf16 v[116:119],v[124:127],a[88:95],v14
v_and_b32 v122,v12,v156
v_and_b32 v123,v13,v156
v_and_b32 v124,v12,v141
v_and_b32 v125,v13,v141
v_smfmac_f32_16x16x64_bf16 v[116:119],v[120:123],a[96:103],v14
v_and_b32 v126,v12,v157
v_and_b32 v127,v13,v157
v_and_b32 v120,v12,v142
v_and_b32 v121,v13,v142
v_smfmac_f32_16x16x64_bf16 v[116:119],v[124:127],a[104:111],v14
v_and_b32 v122,v12,v158
v_and_b32 v123,v13,v158
v_and_b32 v124,v12,v143
v_and_b32 v125,v13,v143
v_smfmac_f32_16x16x64_bf16 v[116:119],v[120:123],a[112:119],v14
v_and_b32 v126,v12,v159
v_and_b32 v127,v13,v159
s_nop 1
v_smfmac_f32_16x16x64_bf16 v[116:119],v[124:127],a[120:127],v14
v_lshlrev_b32 v8,5,v9
v_and_b32 v124,1,v10
v_lshl_add_u32 v8,v124,4,v8
v_lshrrev_b32 v124,1,v10
v_lshl_add_u32 v8,v124,11,v8
s_lshl_b32 s60,s46,9
s_add_u32 s60,s60,147456
v_add_u32 v8,s60,v8
ds_write_b128 v8,v[116:119]
v_lshlrev_b32 v8,2,v1
v_add_u32 v8,147456,v8
v_and_b32 v2,1,v1
v_lshrrev_b32 v3,1,v1
v_lshlrev_b32 v3,2,v3
v_lshl_add_u32 v2,v2,7,v3
v_add_u32 v2,s58,v2
v_lshlrev_b32 v3,6,v10
v_add_u32 v3,s58,v3
s_waitcnt lgkmcnt(0)
s_barrier
ds_read2st64_b32 v[88:89],v8 offset0:0 offset1:1
ds_read2st64_b32 v[90:91],v8 offset0:2 offset1:3
ds_read2st64_b32 v[92:93],v8 offset0:4 offset1:5
ds_read2st64_b32 v[94:95],v8 offset0:6 offset1:7
s_waitcnt lgkmcnt(0)
v_pk_add_f32 v[88:89],v[88:89],v[90:91]
v_pk_add_f32 v[92:93],v[92:93],v[94:95]
v_pk_add_f32 v[88:89],v[88:89],v[92:93]
v_cvt_pk_bf16_f32 v88,v88,v88
v_and_b32 v88,0xffff0000,v88
v_cvt_pk_bf16_f32 v89,v89,v89
v_and_b32 v89,0xffff0000,v89
v_mul_f32 v90,0xbfb8aa3b,v88
v_exp_f32 v90,v90
s_nop 0
v_add_f32 v90,1.0,v90
v_rcp_f32 v90,v90
s_nop 0
v_mul_f32 v88,v88,v90
v_cvt_pk_bf16_f32 v88,v88,v88
v_and_b32 v88,0xffff0000,v88
v_mul_f32 v88,v88,v89
v_cvt_pk_bf16_f32 v88,v88,v88
ds_write_b32 v2,v88
ds_read_b128 v[88:91],v3
ds_read_b128 v[108:111],v3 offset:32
ds_read_b128 v[92:95],v3 offset:16
ds_read_b128 v[112:115],v3 offset:48
v_mov_b64 v[116:117],0
v_mov_b64 v[118:119],0
s_waitcnt vmcnt(0) lgkmcnt(0)
v_and_b32 v120,v12,v88
v_and_b32 v121,v13,v88
v_and_b32 v122,v12,v108
v_and_b32 v123,v13,v108
v_and_b32 v124,v12,v89
v_and_b32 v125,v13,v89
v_smfmac_f32_16x16x64_bf16 v[116:119],v[120:123],v[24:31],v14
v_and_b32 v126,v12,v109
v_and_b32 v127,v13,v109
v_and_b32 v120,v12,v90
v_and_b32 v121,v13,v90
v_smfmac_f32_16x16x64_bf16 v[116:119],v[124:127],v[32:39],v14
v_and_b32 v122,v12,v110
v_and_b32 v123,v13,v110
v_and_b32 v124,v12,v91
v_and_b32 v125,v13,v91
v_smfmac_f32_16x16x64_bf16 v[116:119],v[120:123],v[40:47],v14
v_and_b32 v126,v12,v111
v_and_b32 v127,v13,v111
v_and_b32 v120,v12,v92
v_and_b32 v121,v13,v92
v_smfmac_f32_16x16x64_bf16 v[116:119],v[124:127],v[48:55],v14
v_and_b32 v122,v12,v112
v_and_b32 v123,v13,v112
v_and_b32 v124,v12,v93
v_and_b32 v125,v13,v93
v_smfmac_f32_16x16x64_bf16 v[116:119],v[120:123],v[56:63],v14
v_and_b32 v126,v12,v113
v_and_b32 v127,v13,v113
v_and_b32 v120,v12,v94
v_and_b32 v121,v13,v94
v_smfmac_f32_16x16x64_bf16 v[116:119],v[124:127],v[64:71],v14
v_and_b32 v122,v12,v114
v_and_b32 v123,v13,v114
v_and_b32 v124,v12,v95
v_and_b32 v125,v13,v95
v_smfmac_f32_16x16x64_bf16 v[116:119],v[120:123],v[72:79],v14
v_and_b32 v126,v12,v115
v_and_b32 v127,v13,v115
s_nop 1
v_smfmac_f32_16x16x64_bf16 v[116:119],v[124:127],v[80:87],v14
v_lshlrev_b32 v8,4,v9
v_and_b32 v124,1,v10
v_lshl_add_u32 v8,v124,3,v8
v_and_b32 v124,2,v10
v_lshl_add_u32 v8,v124,30,v8
s_lshl_b32 s60,s46,8
s_add_u32 s59,s62,s60
s_nop 0
v_cvt_pk_bf16_f32 v24,v116,v117
v_cvt_pk_bf16_f32 v25,v118,v119
buffer_store_dwordx2 v[24:25],v8,s[8:11],s59 offen
s_lshl_b32 s59,s51,13
s_lshl2_add_u32 s59,s47,s59
s_add_u32 s59,s59,10486912
s_waitcnt vmcnt(0)
s_barrier
s_or_b32 s59,s59,s52
buffer_store_dword v17,off,s[8:11],s59
s_cmp_lg_u32 s47,0
s_cbranch_scc1 L_moed_68
s_lshl_b32 s59,s51,13
s_add_u32 s59,s59,10486912
v_and_b32 v124,31,v1
v_lshlrev_b32 v124,2,v124
L_fw_69:
buffer_load_dword v125,v124,s[8:11],s59 offen sc1
s_sub_u32 s49,s49,1
s_cbranch_scc1 L_abort
s_waitcnt vmcnt(0)
v_cmp_eq_u32 vcc,0,v125
s_cbranch_vccnz L_fw_69
s_add_u32 s63,s65,0
buffer_load_dwordx4 v[24:27],v22,s[8:11],s63 offen sc1
s_add_u32 s63,s65,4096
buffer_load_dwordx4 v[28:31],v22,s[8:11],s63 offen sc1
s_add_u32 s63,s65,8192
buffer_load_dwordx4 v[32:35],v22,s[8:11],s63 offen sc1
s_add_u32 s63,s65,12288
buffer_load_dwordx4 v[36:39],v22,s[8:11],s63 offen sc1
s_add_u32 s63,s65,16384
buffer_load_dwordx4 v[40:43],v22,s[8:11],s63 offen sc1
s_add_u32 s63,s65,20480
buffer_load_dwordx4 v[44:47],v22,s[8:11],s63 offen sc1
s_add_u32 s63,s65,24576
buffer_load_dwordx4 v[48:51],v22,s[8:11],s63 offen sc1
s_add_u32 s63,s65,28672
buffer_load_dwordx4 v[52:55],v22,s[8:11],s63 offen sc1
v_and_b32 v64,15,v1
v_and_b32 v65,1,v1
v_lshlrev_b32 v65,4,v65
v_mov_b32 v66,0x3f80
v_lshlrev_b32 v66,v65,v66
v_lshrrev_b32 v64,1,v64
v_cmp_eq_u32 vcc,0,v64
s_nop 1
v_cndmask_b32 v56,0,v66,vcc
v_cmp_eq_u32 vcc,1,v64
s_nop 1
v_cndmask_b32 v57,0,v66,vcc
v_cmp_eq_u32 vcc,2,v64
s_nop 1
v_cndmask_b32 v58,0,v66,vcc
v_cmp_eq_u32 vcc,3,v64
s_nop 1
v_cndmask_b32 v59,0,v66,vcc
s_waitcnt vmcnt(7)
s_nop 0
v_mfma_f32_16x16x32_bf16 v[60:63],v[56:59],v[24:27],0
s_waitcnt vmcnt(6)
v_mfma_f32_16x16x32_bf16 v[60:63],v[56:59],v[28:31],v[60:63]
s_waitcnt vmcnt(5)
v_mfma_f32_16x16x32_bf16 v[60:63],v[56:59],v[32:35],v[60:63]
s_waitcnt vmcnt(4)
v_mfma_f32_16x16x32_bf16 v[60:63],v[56:59],v[36:39],v[60:63]
s_waitcnt vmcnt(3)
v_mfma_f32_16x16x32_bf16 v[60:63],v[56:59],v[40:43],v[60:63]
s_waitcnt vmcnt(2)
v_mfma_f32_16x16x32_bf16 v[60:63],v[56:59],v[44:47],v[60:63]
s_waitcnt vmcnt(1)
v_mfma_f32_16x16x32_bf16 v[60:63],v[56:59],v[48:51],v[60:63]
s_waitcnt vmcnt(0)
v_mfma_f32_16x16x32_bf16 v[60:63],v[56:59],v[52:55],v[60:63]
s_nop 7
ds_write_b128 v21,v[60:63]
s_waitcnt lgkmcnt(0)
s_barrier
s_cmp_lg_u32 s46,0
s_cbranch_scc1 L_moed_68
v_lshlrev_b32 v56,5,v1
v_add_u32 v56,155648,v56
ds_read_b128 v[24:27],v56
ds_read_b128 v[28:31],v56 offset:16
s_and_b32 s59,s55,0xffff0000
s_xor_b32 s60,s59,0x80000000
s_xor_b32 s61,s59,0xffff0000
s_cmp_lt_i32 s59,0
s_cselect_b32 s59,s60,s61
v_mov_b32 v56,s59
v_mul_f32 v56,0xbfb8aa3b,v56
v_exp_f32 v56,v56
s_nop 0
v_add_f32 v56,1.0,v56
v_rcp_f32 v56,v56
s_nop 0
v_cvt_pk_bf16_f32 v56,v56,v56
v_and_b32 v56,0xffff0000,v56
v_lshlrev_b32 v48,16,v104
v_and_b32 v49,0xffff0000,v104
v_lshlrev_b32 v50,16,v105
v_and_b32 v51,0xffff0000,v105
v_lshlrev_b32 v52,16,v106
v_and_b32 v53,0xffff0000,v106
v_lshlrev_b32 v54,16,v107
v_and_b32 v55,0xffff0000,v107
s_waitcnt lgkmcnt(0)
v_cvt_pk_bf16_f32 v40,v24,v25
v_cvt_pk_bf16_f32 v41,v26,v27
v_cvt_pk_bf16_f32 v42,v28,v29
v_cvt_pk_bf16_f32 v43,v30,v31
v_lshlrev_b32 v24,16,v40
v_and_b32 v25,0xffff0000,v40
v_lshlrev_b32 v26,16,v41
v_and_b32 v27,0xffff0000,v41
v_lshlrev_b32 v28,16,v42
v_and_b32 v29,0xffff0000,v42
v_lshlrev_b32 v30,16,v43
v_and_b32 v31,0xffff0000,v43
v_pk_mul_f32 v[24:25],v[24:25],v[56:57] op_sel_hi:[1,0]
v_pk_mul_f32 v[26:27],v[26:27],v[56:57] op_sel_hi:[1,0]
v_pk_mul_f32 v[28:29],v[28:29],v[56:57] op_sel_hi:[1,0]
v_pk_mul_f32 v[30:31],v[30:31],v[56:57] op_sel_hi:[1,0]
v_cvt_pk_bf16_f32 v40,v24,v25
v_cvt_pk_bf16_f32 v41,v26,v27
v_cvt_pk_bf16_f32 v42,v28,v29
v_cvt_pk_bf16_f32 v43,v30,v31
v_lshlrev_b32 v24,16,v40
v_and_b32 v25,0xffff0000,v40
v_lshlrev_b32 v26,16,v41
v_and_b32 v27,0xffff0000,v41
v_lshlrev_b32 v28,16,v42
v_and_b32 v29,0xffff0000,v42
v_lshlrev_b32 v30,16,v43
v_and_b32 v31,0xffff0000,v43
v_pk_add_f32 v[24:25],v[24:25],v[48:49]
v_pk_add_f32 v[26:27],v[26:27],v[50:51]
v_pk_add_f32 v[28:29],v[28:29],v[52:53]
v_pk_add_f32 v[30:31],v[30:31],v[54:55]
v_cvt_pk_bf16_f32 v40,v24,v25
v_cvt_pk_bf16_f32 v41,v26,v27
v_cvt_pk_bf16_f32 v42,v28,v29
v_cvt_pk_bf16_f32 v43,v30,v31
v_lshlrev_b32 v24,16,v40
v_and_b32 v25,0xffff0000,v40
v_lshlrev_b32 v26,16,v41
v_and_b32 v27,0xffff0000,v41
v_lshlrev_b32 v28,16,v42
v_and_b32 v29,0xffff0000,v42
v_lshlrev_b32 v30,16,v43
v_and_b32 v31,0xffff0000,v43
v_pk_add_f32 v[96:97],v[96:97],v[24:25]
v_pk_add_f32 v[98:99],v[98:99],v[26:27]
v_pk_add_f32 v[100:101],v[100:101],v[28:29]
v_pk_add_f32 v[102:103],v[102:103],v[30:31]
v_cvt_pk_bf16_f32 v160,v96,v97
v_cvt_pk_bf16_f32 v161,v98,v99
v_cvt_pk_bf16_f32 v162,v100,v101
v_cvt_pk_bf16_f32 v163,v102,v103
L_moed_68:
s_or_b32 s61,s47,s46
s_cselect_b32 s61,1,0
s_add_u32 s51,s51,1
s_lshl1_add_u32 s61,s51,s61
s_cmp_gt_u32 s61,132
s_cbranch_scc1 L_mf_63
s_cmp_eq_u32 s61,132
s_cbranch_scc1 L_mf_61
v_and_b32 v9,15,v1
v_lshrrev_b32 v10,4,v1
v_and_b32 v124,1,v1
v_lshlrev_b32 v124,4,v124
v_mov_b32 v125,0xffff
v_lshlrev_b32 v125,v124,v125
v_lshrrev_b32 v124,2,v9
v_cmp_eq_u32 vcc,0,v124
s_nop 1
v_cndmask_b32 v12,0,v125,vcc
v_cmp_eq_u32 vcc,1,v124
s_nop 1
v_cndmask_b32 v13,0,v125,vcc
v_and_b32 v124,2,v1
v_cmp_eq_u32 vcc,0,v124
v_mov_b32 v14,0xeeee
v_mov_b32 v124,0x4444
v_cndmask_b32 v14,v14,v124,vcc
v_lshlrev_b32 v11,14,v10
v_lshl_add_u32 v11,v9,4,v11
s_lshl_b32 s65,s51,15
s_add_u32 s65,s65,92274688
s_lshl_b32 s62,s47,10
s_add_u32 s62,s62,s65
s_lshl_b32 s63,s47,16
s_lshl_b32 s60,s46,8
s_add_u32 s63,s63,s60
s_mov_b32 s4,s38
s_mov_b32 s5,s39
s_mov_b32 s6,1835008
s_mov_b32 s7,0x20000
buffer_load_dwordx4 v[24:27],v11,s[4:7],s63 offen offset:0
buffer_load_dwordx4 v[28:31],v11,s[4:7],s63 offen offset:1024
buffer_load_dwordx4 v[32:35],v11,s[4:7],s63 offen offset:2048
buffer_load_dwordx4 v[36:39],v11,s[4:7],s63 offen offset:3072
s_add_u32 s63,s63,4096
buffer_load_dwordx4 v[40:43],v11,s[4:7],s63 offen offset:0
buffer_load_dwordx4 v[44:47],v11,s[4:7],s63 offen offset:1024
buffer_load_dwordx4 v[48:51],v11,s[4:7],s63 offen offset:2048
buffer_load_dwordx4 v[52:55],v11,s[4:7],s63 offen offset:3072
s_add_u32 s63,s63,4096
buffer_load_dwordx4 v[56:59],v11,s[4:7],s63 offen offset:0
buffer_load_dwordx4 v[60:63],v11,s[4:7],s63 offen offset:1024
buffer_load_dwordx4 v[64:67],v11,s[4:7],s63 offen offset:2048
buffer_load_dwordx4 v[68:71],v11,s[4:7],s63 offen offset:3072
s_add_u32 s63,s63,4096
buffer_load_dwordx4 v[72:75],v11,s[4:7],s63 offen offset:0
buffer_load_dwordx4 v[76:79],v11,s[4:7],s63 offen offset:1024
buffer_load_dwordx4 v[80:83],v11,s[4:7],s63 offen offset:2048
buffer_load_dwordx4 v[84:87],v11,s[4:7],s63 offen offset:3072
buffer_load_dword v15,v0,s[8:11],s62 offen
s_cmp_eq_u32 s61,131
s_cbranch_scc1 L_mf_62
v_lshrrev_b32 v2,3,v1
s_lshr_b32 s20,s85,24
v_lshrrev_b32 v3,v2,s20
v_and_b32 v3,1,v3
v_mul_u32_u24 v3,768,v3
v_lshlrev_b32 v2,13,v2
v_sub_u32 v2,v2,v3
v_and_b32 v3,0x70,v0
v_add_u32 v2,v2,v3
v_add_u32 v2,1536,v2
s_mov_b32 s59,10944512
L_mf_60:
buffer_load_dwordx4 v[164:167],v2,s[8:11],s59 offen sc1
s_sub_u32 s49,s49,1
s_cbranch_scc1 L_abort
s_waitcnt vmcnt(0)
v_min3_u32 v168,v164,v165,v166
v_min_u32 v168,v167,v168
v_cmp_eq_u32 vcc,0,v168
s_cbranch_vccnz L_mf_60
v_max3_u32 v168,v164,v165,v166
v_max3_u32 v168,v167,v168,s55
v_cmp_lt_u32 vcc,s55,v168
s_mov_b32 s59,11019904
s_cbranch_vccz L_mf_61
v_max_u32_dpp v168,v168,v168 row_ror:8 row_mask:0xf bank_mask:0xf
s_nop 1
v_max_u32_dpp v168,v168,v168 row_ror:4 row_mask:0xf bank_mask:0xf
s_nop 1
v_max_u32_dpp v168,v168,v168 row_ror:2 row_mask:0xf bank_mask:0xf
s_nop 1
v_max_u32_dpp v168,v168,v168 row_ror:1 row_mask:0xf bank_mask:0xf
v_mov_b32 v169,v168
s_nop 1
v_permlane16_swap_b32 v168,v169
v_max_u32 v168,v168,v169
v_mov_b32 v169,v168
s_nop 1
v_permlane32_swap_b32 v168,v169
v_max_u32 v168,v168,v169
buffer_store_dword v168,off,s[8:11],s59
s_branch L_mf_62
L_mf_61:
s_mov_b32 s4,s40
s_mov_b32 s5,s41
s_mov_b32 s6,2097152
s_mov_b32 s7,0x20000
buffer_store_dwordx4 v[160:163],v0,s[4:7],s56 offen sc1
v_mov_b32 v168,s55
s_mov_b32 s59,11019904
buffer_store_dword v168,off,s[8:11],s59
s_endpgm
L_mf_62:
s_mov_b32 s59,11019904
L_ww_72:
s_sleep 1
buffer_load_dword v2,off,s[8:11],s59 sc1
s_sub_u32 s49,s49,1
s_cbranch_scc1 L_abort
s_waitcnt vmcnt(0)
v_readfirstlane_b32 s61,v2
s_cmp_eq_u32 s61,0
s_cbranch_scc1 L_ww_72
L_wwd_73:
s_cmp_eq_u32 s61,s55
s_cbranch_scc1 L_mf_63
s_mov_b32 s55,s61
s_barrier
s_branch L_mf_59
L_mf_63:
s_waitcnt vmcnt(0)
s_endpgm
L_abort:
s_endpgm
L_spread:
s_mov_b32 s3,-1
s_lshr_b32 s48,s2,5
s_and_b32 s47,s2,31
s_branch L_roles
L_ra_6:
s_and_b32 s56,s48,1
s_lshl_b32 s56,s56,12
s_add_u32 s56,s56,s50
s_and_b32 s57,s47,15
s_lshl_b32 s57,s57,13
s_add_u32 s56,s56,s57
s_mov_b32 s4,s22
s_mov_b32 s5,s23
s_mov_b32 s6,4194304
s_mov_b32 s7,0x20000
s_add_u32 s57,s56,0
buffer_load_dwordx4 v[24:27],v0,s[4:7],s57 offen
s_add_u32 s57,s56,131072
buffer_load_dwordx4 v[24:27],v0,s[4:7],s57 offen
s_add_u32 s57,s56,262144
buffer_load_dwordx4 v[24:27],v0,s[4:7],s57 offen
s_add_u32 s57,s56,393216
buffer_load_dwordx4 v[24:27],v0,s[4:7],s57 offen
s_add_u32 s57,s56,524288
buffer_load_dwordx4 v[24:27],v0,s[4:7],s57 offen
s_add_u32 s57,s56,655360
buffer_load_dwordx4 v[24:27],v0,s[4:7],s57 offen
s_add_u32 s57,s56,786432
buffer_load_dwordx4 v[24:27],v0,s[4:7],s57 offen
s_add_u32 s57,s56,917504
buffer_load_dwordx4 v[24:27],v0,s[4:7],s57 offen
s_add_u32 s57,s56,1048576
buffer_load_dwordx4 v[24:27],v0,s[4:7],s57 offen
s_add_u32 s57,s56,1179648
buffer_load_dwordx4 v[24:27],v0,s[4:7],s57 offen
s_waitcnt vmcnt(9)
s_add_u32 s57,s56,1310720
buffer_load_dwordx4 v[24:27],v0,s[4:7],s57 offen
s_barrier
s_cmp_lg_u32 s46,0
s_cbranch_scc1 L_ar_74
v_mov_b32 v8,128
v_mov_b32 v9,s53
s_mov_b64 exec,1
buffer_atomic_add v9,v8,s[12:15],0 offen
s_mov_b64 exec,-1
L_ar_74:
s_mov_b32 s53,0
s_waitcnt vmcnt(9)
s_add_u32 s57,s56,1441792
buffer_load_dwordx4 v[24:27],v0,s[4:7],s57 offen
s_waitcnt vmcnt(9)
s_add_u32 s57,s56,1572864
buffer_load_dwordx4 v[24:27],v0,s[4:7],s57 offen
s_waitcnt vmcnt(9)
s_add_u32 s57,s56,1703936
buffer_load_dwordx4 v[24:27],v0,s[4:7],s57 offen
s_waitcnt vmcnt(9)
s_add_u32 s57,s56,1835008
buffer_load_dwordx4 v[24:27],v0,s[4:7],s57 offen
s_waitcnt vmcnt(9)
s_add_u32 s57,s56,1966080
buffer_load_dwordx4 v[24:27],v0,s[4:7],s57 offen
s_waitcnt vmcnt(9)
s_add_u32 s57,s56,2097152
buffer_load_dwordx4 v[24:27],v0,s[4:7],s57 offen
s_waitcnt vmcnt(9)
s_add_u32 s57,s56,2228224
buffer_load_dwordx4 v[24:27],v0,s[4:7],s57 offen
s_waitcnt vmcnt(9)
s_add_u32 s57,s56,2359296
buffer_load_dwordx4 v[24:27],v0,s[4:7],s57 offen
s_waitcnt vmcnt(9)
s_add_u32 s57,s56,2490368
buffer_load_dwordx4 v[24:27],v0,s[4:7],s57 offen
s_waitcnt vmcnt(9)
s_add_u32 s57,s56,2621440
buffer_load_dwordx4 v[24:27],v0,s[4:7],s57 offen
s_waitcnt vmcnt(9)
s_add_u32 s57,s56,2752512
buffer_load_dwordx4 v[24:27],v0,s[4:7],s57 offen
s_waitcnt vmcnt(9)
s_add_u32 s57,s56,2883584
buffer_load_dwordx4 v[24:27],v0,s[4:7],s57 offen
s_waitcnt vmcnt(9)
s_add_u32 s57,s56,3014656
buffer_load_dwordx4 v[24:27],v0,s[4:7],s57 offen
s_waitcnt vmcnt(9)
s_add_u32 s57,s56,3145728
buffer_load_dwordx4 v[24:27],v0,s[4:7],s57 offen
s_waitcnt vmcnt(9)
s_add_u32 s57,s56,3276800
buffer_load_dwordx4 v[24:27],v0,s[4:7],s57 offen
s_waitcnt vmcnt(9)
s_add_u32 s57,s56,3407872
buffer_load_dwordx4 v[24:27],v0,s[4:7],s57 offen
s_waitcnt vmcnt(9)
s_add_u32 s57,s56,3538944
buffer_load_dwordx4 v[24:27],v0,s[4:7],s57 offen
s_waitcnt vmcnt(9)
s_add_u32 s57,s56,3670016
buffer_load_dwordx4 v[24:27],v0,s[4:7],s57 offen
s_waitcnt vmcnt(9)
s_add_u32 s57,s56,3801088
buffer_load_dwordx4 v[24:27],v0,s[4:7],s57 offen
s_waitcnt vmcnt(9)
s_add_u32 s57,s56,3932160
buffer_load_dwordx4 v[24:27],v0,s[4:7],s57 offen
s_waitcnt vmcnt(9)
s_add_u32 s57,s56,4063232
buffer_load_dwordx4 v[24:27],v0,s[4:7],s57 offen
s_mov_b32 s4,s24
s_mov_b32 s5,s25
s_mov_b32 s6,4194304
s_mov_b32 s7,0x20000
s_waitcnt vmcnt(9)
s_add_u32 s57,s56,0
buffer_load_dwordx4 v[24:27],v0,s[4:7],s57 offen
s_waitcnt vmcnt(9)
s_add_u32 s57,s56,131072
buffer_load_dwordx4 v[24:27],v0,s[4:7],s57 offen
s_waitcnt vmcnt(9)
s_add_u32 s57,s56,262144
buffer_load_dwordx4 v[24:27],v0,s[4:7],s57 offen
s_waitcnt vmcnt(9)
s_add_u32 s57,s56,393216
buffer_load_dwordx4 v[24:27],v0,s[4:7],s57 offen
s_waitcnt vmcnt(9)
s_add_u32 s57,s56,524288
buffer_load_dwordx4 v[24:27],v0,s[4:7],s57 offen
s_waitcnt vmcnt(9)
s_add_u32 s57,s56,655360
buffer_load_dwordx4 v[24:27],v0,s[4:7],s57 offen
s_waitcnt vmcnt(9)
s_add_u32 s57,s56,786432
buffer_load_dwordx4 v[24:27],v0,s[4:7],s57 offen
s_waitcnt vmcnt(9)
s_add_u32 s57,s56,917504
buffer_load_dwordx4 v[24:27],v0,s[4:7],s57 offen
s_waitcnt vmcnt(9)
s_add_u32 s57,s56,1048576
buffer_load_dwordx4 v[24:27],v0,s[4:7],s57 offen
s_waitcnt vmcnt(9)
s_add_u32 s57,s56,1179648
buffer_load_dwordx4 v[24:27],v0,s[4:7],s57 offen
s_waitcnt vmcnt(9)
s_add_u32 s57,s56,1310720
buffer_load_dwordx4 v[24:27],v0,s[4:7],s57 offen
s_waitcnt vmcnt(9)
s_add_u32 s57,s56,1441792
buffer_load_dwordx4 v[24:27],v0,s[4:7],s57 offen
s_waitcnt vmcnt(9)
s_add_u32 s57,s56,1572864
buffer_load_dwordx4 v[24:27],v0,s[4:7],s57 offen
s_waitcnt vmcnt(9)
s_add_u32 s57,s56,1703936
buffer_load_dwordx4 v[24:27],v0,s[4:7],s57 offen
s_waitcnt vmcnt(9)
s_add_u32 s57,s56,1835008
buffer_load_dwordx4 v[24:27],v0,s[4:7],s57 offen
s_waitcnt vmcnt(9)
s_add_u32 s57,s56,1966080
buffer_load_dwordx4 v[24:27],v0,s[4:7],s57 offen
s_waitcnt vmcnt(9)
s_add_u32 s57,s56,2097152
buffer_load_dwordx4 v[24:27],v0,s[4:7],s57 offen
s_waitcnt vmcnt(9)
s_add_u32 s57,s56,2228224
buffer_load_dwordx4 v[24:27],v0,s[4:7],s57 offen
s_waitcnt vmcnt(9)
s_add_u32 s57,s56,2359296
buffer_load_dwordx4 v[24:27],v0,s[4:7],s57 offen
s_waitcnt vmcnt(9)
s_add_u32 s57,s56,2490368
buffer_load_dwordx4 v[24:27],v0,s[4:7],s57 offen
s_waitcnt vmcnt(9)
s_add_u32 s57,s56,2621440
buffer_load_dwordx4 v[24:27],v0,s[4:7],s57 offen
s_waitcnt vmcnt(9)
s_add_u32 s57,s56,2752512
buffer_load_dwordx4 v[24:27],v0,s[4:7],s57 offen
s_waitcnt vmcnt(9)
s_add_u32 s57,s56,2883584
buffer_load_dwordx4 v[24:27],v0,s[4:7],s57 offen
s_waitcnt vmcnt(9)
s_add_u32 s57,s56,3014656
buffer_load_dwordx4 v[24:27],v0,s[4:7],s57 offen
s_waitcnt vmcnt(9)
s_add_u32 s57,s56,3145728
buffer_load_dwordx4 v[24:27],v0,s[4:7],s57 offen
s_waitcnt vmcnt(9)
s_add_u32 s57,s56,3276800
buffer_load_dwordx4 v[24:27],v0,s[4:7],s57 offen
s_waitcnt vmcnt(9)
s_add_u32 s57,s56,3407872
buffer_load_dwordx4 v[24:27],v0,s[4:7],s57 offen
s_waitcnt vmcnt(9)
s_add_u32 s57,s56,3538944
buffer_load_dwordx4 v[24:27],v0,s[4:7],s57 offen
s_waitcnt vmcnt(9)
s_add_u32 s57,s56,3670016
buffer_load_dwordx4 v[24:27],v0,s[4:7],s57 offen
s_waitcnt vmcnt(9)
s_add_u32 s57,s56,3801088
buffer_load_dwordx4 v[24:27],v0,s[4:7],s57 offen
s_waitcnt vmcnt(9)
s_add_u32 s57,s56,3932160
buffer_load_dwordx4 v[24:27],v0,s[4:7],s57 offen
s_waitcnt vmcnt(9)
s_add_u32 s57,s56,4063232
buffer_load_dwordx4 v[24:27],v0,s[4:7],s57 offen
s_mov_b32 s4,s20
s_mov_b32 s5,s21
s_mov_b32 s6,4194304
s_mov_b32 s7,0x20000
s_waitcnt vmcnt(9)
s_add_u32 s57,s56,0
buffer_load_dwordx4 v[24:27],v0,s[4:7],s57 offen
s_waitcnt vmcnt(9)
s_add_u32 s57,s56,131072
buffer_load_dwordx4 v[24:27],v0,s[4:7],s57 offen
s_waitcnt vmcnt(9)
s_add_u32 s57,s56,262144
buffer_load_dwordx4 v[24:27],v0,s[4:7],s57 offen
s_waitcnt vmcnt(9)
s_add_u32 s57,s56,393216
buffer_load_dwordx4 v[24:27],v0,s[4:7],s57 offen
s_waitcnt vmcnt(9)
s_add_u32 s57,s56,524288
buffer_load_dwordx4 v[24:27],v0,s[4:7],s57 offen
s_waitcnt vmcnt(9)
s_add_u32 s57,s56,655360
buffer_load_dwordx4 v[24:27],v0,s[4:7],s57 offen
s_waitcnt vmcnt(9)
s_add_u32 s57,s56,786432
buffer_load_dwordx4 v[24:27],v0,s[4:7],s57 offen
s_waitcnt vmcnt(9)
s_add_u32 s57,s56,917504
buffer_load_dwordx4 v[24:27],v0,s[4:7],s57 offen
s_waitcnt vmcnt(9)
s_add_u32 s57,s56,1048576
buffer_load_dwordx4 v[24:27],v0,s[4:7],s57 offen
s_waitcnt vmcnt(9)
s_add_u32 s57,s56,1179648
buffer_load_dwordx4 v[24:27],v0,s[4:7],s57 offen
s_waitcnt vmcnt(9)
s_add_u32 s57,s56,1310720
buffer_load_dwordx4 v[24:27],v0,s[4:7],s57 offen
s_waitcnt vmcnt(9)
s_add_u32 s57,s56,1441792
buffer_load_dwordx4 v[24:27],v0,s[4:7],s57 offen
s_waitcnt vmcnt(9)
s_add_u32 s57,s56,1572864
buffer_load_dwordx4 v[24:27],v0,s[4:7],s57 offen
s_waitcnt vmcnt(9)
s_add_u32 s57,s56,1703936
buffer_load_dwordx4 v[24:27],v0,s[4:7],s57 offen
s_waitcnt vmcnt(9)
s_add_u32 s57,s56,1835008
buffer_load_dwordx4 v[24:27],v0,s[4:7],s57 offen
s_waitcnt vmcnt(9)
s_add_u32 s57,s56,1966080
buffer_load_dwordx4 v[24:27],v0,s[4:7],s57 offen
s_waitcnt vmcnt(9)
s_add_u32 s57,s56,2097152
buffer_load_dwordx4 v[24:27],v0,s[4:7],s57 offen
s_waitcnt vmcnt(9)
s_add_u32 s57,s56,2228224
buffer_load_dwordx4 v[24:27],v0,s[4:7],s57 offen
s_waitcnt vmcnt(9)
s_add_u32 s57,s56,2359296
buffer_load_dwordx4 v[24:27],v0,s[4:7],s57 offen
s_waitcnt vmcnt(9)
s_add_u32 s57,s56,2490368
buffer_load_dwordx4 v[24:27],v0,s[4:7],s57 offen
s_waitcnt vmcnt(9)
s_add_u32 s57,s56,2621440
buffer_load_dwordx4 v[24:27],v0,s[4:7],s57 offen
s_waitcnt vmcnt(9)
s_add_u32 s57,s56,2752512
buffer_load_dwordx4 v[24:27],v0,s[4:7],s57 offen
s_waitcnt vmcnt(9)
s_add_u32 s57,s56,2883584
buffer_load_dwordx4 v[24:27],v0,s[4:7],s57 offen
s_waitcnt vmcnt(9)
s_add_u32 s57,s56,3014656
buffer_load_dwordx4 v[24:27],v0,s[4:7],s57 offen
s_waitcnt vmcnt(9)
s_add_u32 s57,s56,3145728
buffer_load_dwordx4 v[24:27],v0,s[4:7],s57 offen
s_waitcnt vmcnt(9)
s_add_u32 s57,s56,3276800
buffer_load_dwordx4 v[24:27],v0,s[4:7],s57 offen
s_waitcnt vmcnt(9)
s_add_u32 s57,s56,3407872
buffer_load_dwordx4 v[24:27],v0,s[4:7],s57 offen
s_waitcnt vmcnt(9)
s_add_u32 s57,s56,3538944
buffer_load_dwordx4 v[24:27],v0,s[4:7],s57 offen
s_waitcnt vmcnt(9)
s_add_u32 s57,s56,3670016
buffer_load_dwordx4 v[24:27],v0,s[4:7],s57 offen
s_waitcnt vmcnt(9)
s_add_u32 s57,s56,3801088
buffer_load_dwordx4 v[24:27],v0,s[4:7],s57 offen
s_waitcnt vmcnt(9)
s_add_u32 s57,s56,3932160
buffer_load_dwordx4 v[24:27],v0,s[4:7],s57 offen
s_waitcnt vmcnt(9)
s_add_u32 s57,s56,4063232
buffer_load_dwordx4 v[24:27],v0,s[4:7],s57 offen
L_rb_7:
s_mov_b32 s4,s26
s_mov_b32 s5,s27
s_mov_b32 s6,4194304
s_mov_b32 s7,0x20000
v_and_b32 v2,15,v1
v_lshlrev_b32 v2,4,v2
v_lshrrev_b32 v3,4,v1
v_lshl_add_u32 v2,v3,13,v2
s_and_b32 s56,s47,15
s_lshl_b32 s56,s56,18
s_lshl_b32 s57,s46,8
s_add_u32 s56,s56,s57
s_mov_b32 s61,0x05040100
s_mov_b32 s62,0x07060302
s_add_u32 s57,s56,0
buffer_load_dwordx4 v[24:27],v2,s[4:7],s57 offen offset:0
buffer_load_dwordx4 v[28:31],v2,s[4:7],s57 offen offset:1024
buffer_load_dwordx4 v[32:35],v2,s[4:7],s57 offen offset:2048
buffer_load_dwordx4 v[36:39],v2,s[4:7],s57 offen offset:3072
s_add_u32 s57,s56,4096
buffer_load_dwordx4 v[40:43],v2,s[4:7],s57 offen offset:0
buffer_load_dwordx4 v[44:47],v2,s[4:7],s57 offen offset:1024
buffer_load_dwordx4 v[48:51],v2,s[4:7],s57 offen offset:2048
buffer_load_dwordx4 v[52:55],v2,s[4:7],s57 offen offset:3072
s_add_u32 s57,s56,32768
buffer_load_dwordx4 v[56:59],v2,s[4:7],s57 offen offset:0
buffer_load_dwordx4 v[60:63],v2,s[4:7],s57 offen offset:1024
buffer_load_dwordx4 v[64:67],v2,s[4:7],s57 offen offset:2048
buffer_load_dwordx4 v[68:71],v2,s[4:7],s57 offen offset:3072
s_add_u32 s57,s56,36864
buffer_load_dwordx4 v[72:75],v2,s[4:7],s57 offen offset:0
buffer_load_dwordx4 v[76:79],v2,s[4:7],s57 offen offset:1024
buffer_load_dwordx4 v[80:83],v2,s[4:7],s57 offen offset:2048
buffer_load_dwordx4 v[84:87],v2,s[4:7],s57 offen offset:3072
s_add_u32 s57,s56,65536
buffer_load_dwordx4 v[88:91],v2,s[4:7],s57 offen offset:0
buffer_load_dwordx4 v[92:95],v2,s[4:7],s57 offen offset:1024
buffer_load_dwordx4 v[96:99],v2,s[4:7],s57 offen offset:2048
buffer_load_dwordx4 v[100:103],v2,s[4:7],s57 offen offset:3072
s_add_u32 s57,s56,69632
buffer_load_dwordx4 v[104:107],v2,s[4:7],s57 offen offset:0
buffer_load_dwordx4 v[108:111],v2,s[4:7],s57 offen offset:1024
buffer_load_dwordx4 v[112:115],v2,s[4:7],s57 offen offset:2048
buffer_load_dwordx4 v[116:119],v2,s[4:7],s57 offen offset:3072
s_add_u32 s57,s56,98304
buffer_load_dwordx4 v[120:123],v2,s[4:7],s57 offen offset:0
buffer_load_dwordx4 v[124:127],v2,s[4:7],s57 offen offset:1024
buffer_load_dwordx4 v[128:131],v2,s[4:7],s57 offen offset:2048
buffer_load_dwordx4 v[132:135],v2,s[4:7],s57 offen offset:3072
s_add_u32 s57,s56,102400
buffer_load_dwordx4 v[136:139],v2,s[4:7],s57 offen offset:0
buffer_load_dwordx4 v[140:143],v2,s[4:7],s57 offen offset:1024
buffer_load_dwordx4 v[144:147],v2,s[4:7],s57 offen offset:2048
buffer_load_dwordx4 v[148:151],v2,s[4:7],s57 offen offset:3072
s_add_u32 s57,s56,131072
buffer_load_dwordx4 v[152:155],v2,s[4:7],s57 offen offset:0
buffer_load_dwordx4 v[156:159],v2,s[4:7],s57 offen offset:1024
buffer_load_dwordx4 v[160:163],v2,s[4:7],s57 offen offset:2048
buffer_load_dwordx4 v[164:167],v2,s[4:7],s57 offen offset:3072
s_add_u32 s57,s56,135168
buffer_load_dwordx4 v[168:171],v2,s[4:7],s57 offen offset:0
buffer_load_dwordx4 v[172:175],v2,s[4:7],s57 offen offset:1024
buffer_load_dwordx4 v[176:179],v2,s[4:7],s57 offen offset:2048
buffer_load_dwordx4 v[180:183],v2,s[4:7],s57 offen offset:3072
s_add_u32 s57,s56,163840
buffer_load_dwordx4 v[184:187],v2,s[4:7],s57 offen offset:0
buffer_load_dwordx4 v[188:191],v2,s[4:7],s57 offen offset:1024
buffer_load_dwordx4 v[192:195],v2,s[4:7],s57 offen offset:2048
buffer_load_dwordx4 v[196:199],v2,s[4:7],s57 offen offset:3072
s_add_u32 s57,s56,167936
buffer_load_dwordx4 v[200:203],v2,s[4:7],s57 offen offset:0
buffer_load_dwordx4 v[204:207],v2,s[4:7],s57 offen offset:1024
buffer_load_dwordx4 v[208:211],v2,s[4:7],s57 offen offset:2048
buffer_load_dwordx4 v[212:215],v2,s[4:7],s57 offen offset:3072
s_waitcnt vmcnt(40)
v_perm_b32 v216,v28,v24,s61
v_perm_b32 v217,v36,v32,s61
v_perm_b32 v218,v44,v40,s61
v_perm_b32 v219,v52,v48,s61
v_accvgpr_write_b32 a0,v216
v_accvgpr_write_b32 a1,v217
v_accvgpr_write_b32 a2,v218
v_accvgpr_write_b32 a3,v219
v_perm_b32 v216,v28,v24,s62
v_perm_b32 v217,v36,v32,s62
v_perm_b32 v218,v44,v40,s62
v_perm_b32 v219,v52,v48,s62
v_accvgpr_write_b32 a4,v216
v_accvgpr_write_b32 a5,v217
v_accvgpr_write_b32 a6,v218
v_accvgpr_write_b32 a7,v219
v_perm_b32 v216,v29,v25,s61
v_perm_b32 v217,v37,v33,s61
v_perm_b32 v218,v45,v41,s61
v_perm_b32 v219,v53,v49,s61
v_accvgpr_write_b32 a8,v216
v_accvgpr_write_b32 a9,v217
v_accvgpr_write_b32 a10,v218
v_accvgpr_write_b32 a11,v219
v_perm_b32 v216,v29,v25,s62
v_perm_b32 v217,v37,v33,s62
v_perm_b32 v218,v45,v41,s62
v_perm_b32 v219,v53,v49,s62
v_accvgpr_write_b32 a12,v216
v_accvgpr_write_b32 a13,v217
v_accvgpr_write_b32 a14,v218
v_accvgpr_write_b32 a15,v219
v_perm_b32 v216,v30,v26,s61
v_perm_b32 v217,v38,v34,s61
v_perm_b32 v218,v46,v42,s61
v_perm_b32 v219,v54,v50,s61
v_accvgpr_write_b32 a16,v216
v_accvgpr_write_b32 a17,v217
v_accvgpr_write_b32 a18,v218
v_accvgpr_write_b32 a19,v219
v_perm_b32 v216,v30,v26,s62
v_perm_b32 v217,v38,v34,s62
v_perm_b32 v218,v46,v42,s62
v_perm_b32 v219,v54,v50,s62
v_accvgpr_write_b32 a20,v216
v_accvgpr_write_b32 a21,v217
v_accvgpr_write_b32 a22,v218
v_accvgpr_write_b32 a23,v219
v_perm_b32 v216,v31,v27,s61
v_perm_b32 v217,v39,v35,s61
v_perm_b32 v218,v47,v43,s61
v_perm_b32 v219,v55,v51,s61
v_accvgpr_write_b32 a24,v216
v_accvgpr_write_b32 a25,v217
v_accvgpr_write_b32 a26,v218
v_accvgpr_write_b32 a27,v219
v_perm_b32 v216,v31,v27,s62
v_perm_b32 v217,v39,v35,s62
v_perm_b32 v218,v47,v43,s62
v_perm_b32 v219,v55,v51,s62
v_accvgpr_write_b32 a28,v216
v_accvgpr_write_b32 a29,v217
v_accvgpr_write_b32 a30,v218
v_accvgpr_write_b32 a31,v219
s_add_u32 s57,s56,196608
buffer_load_dwordx4 v[24:27],v2,s[4:7],s57 offen offset:0
buffer_load_dwordx4 v[28:31],v2,s[4:7],s57 offen offset:1024
buffer_load_dwordx4 v[32:35],v2,s[4:7],s57 offen offset:2048
buffer_load_dwordx4 v[36:39],v2,s[4:7],s57 offen offset:3072
s_add_u32 s57,s56,200704
buffer_load_dwordx4 v[40:43],v2,s[4:7],s57 offen offset:0
buffer_load_dwordx4 v[44:47],v2,s[4:7],s57 offen offset:1024
buffer_load_dwordx4 v[48:51],v2,s[4:7],s57 offen offset:2048
buffer_load_dwordx4 v[52:55],v2,s[4:7],s57 offen offset:3072
s_barrier
s_cmp_lg_u32 s46,0
s_cbranch_scc1 L_ar_75
v_mov_b32 v8,128
v_mov_b32 v9,s53
s_mov_b64 exec,1
buffer_atomic_add v9,v8,s[12:15],0 offen
s_mov_b64 exec,-1
L_ar_75:
s_mov_b32 s53,0
s_waitcnt vmcnt(40)
v_perm_b32 v216,v60,v56,s61
v_perm_b32 v217,v68,v64,s61
v_perm_b32 v218,v76,v72,s61
v_perm_b32 v219,v84,v80,s61
v_accvgpr_write_b32 a32,v216
v_accvgpr_write_b32 a33,v217
v_accvgpr_write_b32 a34,v218
v_accvgpr_write_b32 a35,v219
v_perm_b32 v216,v60,v56,s62
v_perm_b32 v217,v68,v64,s62
v_perm_b32 v218,v76,v72,s62
v_perm_b32 v219,v84,v80,s62
v_accvgpr_write_b32 a36,v216
v_accvgpr_write_b32 a37,v217
v_accvgpr_write_b32 a38,v218
v_accvgpr_write_b32 a39,v219
v_perm_b32 v216,v61,v57,s61
v_perm_b32 v217,v69,v65,s61
v_perm_b32 v218,v77,v73,s61
v_perm_b32 v219,v85,v81,s61
v_accvgpr_write_b32 a40,v216
v_accvgpr_write_b32 a41,v217
v_accvgpr_write_b32 a42,v218
v_accvgpr_write_b32 a43,v219
v_perm_b32 v216,v61,v57,s62
v_perm_b32 v217,v69,v65,s62
v_perm_b32 v218,v77,v73,s62
v_perm_b32 v219,v85,v81,s62
v_accvgpr_write_b32 a44,v216
v_accvgpr_write_b32 a45,v217
v_accvgpr_write_b32 a46,v218
v_accvgpr_write_b32 a47,v219
v_perm_b32 v216,v62,v58,s61
v_perm_b32 v217,v70,v66,s61
v_perm_b32 v218,v78,v74,s61
v_perm_b32 v219,v86,v82,s61
v_accvgpr_write_b32 a48,v216
v_accvgpr_write_b32 a49,v217
v_accvgpr_write_b32 a50,v218
v_accvgpr_write_b32 a51,v219
v_perm_b32 v216,v62,v58,s62
v_perm_b32 v217,v70,v66,s62
v_perm_b32 v218,v78,v74,s62
v_perm_b32 v219,v86,v82,s62
v_accvgpr_write_b32 a52,v216
v_accvgpr_write_b32 a53,v217
v_accvgpr_write_b32 a54,v218
v_accvgpr_write_b32 a55,v219
v_perm_b32 v216,v63,v59,s61
v_perm_b32 v217,v71,v67,s61
v_perm_b32 v218,v79,v75,s61
v_perm_b32 v219,v87,v83,s61
v_accvgpr_write_b32 a56,v216
v_accvgpr_write_b32 a57,v217
v_accvgpr_write_b32 a58,v218
v_accvgpr_write_b32 a59,v219
v_perm_b32 v216,v63,v59,s62
v_perm_b32 v217,v71,v67,s62
v_perm_b32 v218,v79,v75,s62
v_perm_b32 v219,v87,v83,s62
v_accvgpr_write_b32 a60,v216
v_accvgpr_write_b32 a61,v217
v_accvgpr_write_b32 a62,v218
v_accvgpr_write_b32 a63,v219
s_add_u32 s57,s56,229376
buffer_load_dwordx4 v[56:59],v2,s[4:7],s57 offen offset:0
buffer_load_dwordx4 v[60:63],v2,s[4:7],s57 offen offset:1024
buffer_load_dwordx4 v[64:67],v2,s[4:7],s57 offen offset:2048
buffer_load_dwordx4 v[68:71],v2,s[4:7],s57 offen offset:3072
s_add_u32 s57,s56,233472
buffer_load_dwordx4 v[72:75],v2,s[4:7],s57 offen offset:0
buffer_load_dwordx4 v[76:79],v2,s[4:7],s57 offen offset:1024
buffer_load_dwordx4 v[80:83],v2,s[4:7],s57 offen offset:2048
buffer_load_dwordx4 v[84:87],v2,s[4:7],s57 offen offset:3072
s_waitcnt vmcnt(40)
v_perm_b32 v216,v92,v88,s61
v_perm_b32 v217,v100,v96,s61
v_perm_b32 v218,v108,v104,s61
v_perm_b32 v219,v116,v112,s61
v_accvgpr_write_b32 a64,v216
v_accvgpr_write_b32 a65,v217
v_accvgpr_write_b32 a66,v218
v_accvgpr_write_b32 a67,v219
v_perm_b32 v216,v92,v88,s62
v_perm_b32 v217,v100,v96,s62
v_perm_b32 v218,v108,v104,s62
v_perm_b32 v219,v116,v112,s62
v_accvgpr_write_b32 a68,v216
v_accvgpr_write_b32 a69,v217
v_accvgpr_write_b32 a70,v218
v_accvgpr_write_b32 a71,v219
v_perm_b32 v216,v93,v89,s61
v_perm_b32 v217,v101,v97,s61
v_perm_b32 v218,v109,v105,s61
v_perm_b32 v219,v117,v113,s61
v_accvgpr_write_b32 a72,v216
v_accvgpr_write_b32 a73,v217
v_accvgpr_write_b32 a74,v218
v_accvgpr_write_b32 a75,v219
v_perm_b32 v216,v93,v89,s62
v_perm_b32 v217,v101,v97,s62
v_perm_b32 v218,v109,v105,s62
v_perm_b32 v219,v117,v113,s62
v_accvgpr_write_b32 a76,v216
v_accvgpr_write_b32 a77,v217
v_accvgpr_write_b32 a78,v218
v_accvgpr_write_b32 a79,v219
v_perm_b32 v216,v94,v90,s61
v_perm_b32 v217,v102,v98,s61
v_perm_b32 v218,v110,v106,s61
v_perm_b32 v219,v118,v114,s61
v_accvgpr_write_b32 a80,v216
v_accvgpr_write_b32 a81,v217
v_accvgpr_write_b32 a82,v218
v_accvgpr_write_b32 a83,v219
v_perm_b32 v216,v94,v90,s62
v_perm_b32 v217,v102,v98,s62
v_perm_b32 v218,v110,v106,s62
v_perm_b32 v219,v118,v114,s62
v_accvgpr_write_b32 a84,v216
v_accvgpr_write_b32 a85,v217
v_accvgpr_write_b32 a86,v218
v_accvgpr_write_b32 a87,v219
v_perm_b32 v216,v95,v91,s61
v_perm_b32 v217,v103,v99,s61
v_perm_b32 v218,v111,v107,s61
v_perm_b32 v219,v119,v115,s61
v_accvgpr_write_b32 a88,v216
v_accvgpr_write_b32 a89,v217
v_accvgpr_write_b32 a90,v218
v_accvgpr_write_b32 a91,v219
v_perm_b32 v216,v95,v91,s62
v_perm_b32 v217,v103,v99,s62
v_perm_b32 v218,v111,v107,s62
v_perm_b32 v219,v119,v115,s62
v_accvgpr_write_b32 a92,v216
v_accvgpr_write_b32 a93,v217
v_accvgpr_write_b32 a94,v218
v_accvgpr_write_b32 a95,v219
s_waitcnt vmcnt(32)
v_perm_b32 v216,v124,v120,s61
v_perm_b32 v217,v132,v128,s61
v_perm_b32 v218,v140,v136,s61
v_perm_b32 v219,v148,v144,s61
v_accvgpr_write_b32 a96,v216
v_accvgpr_write_b32 a97,v217
v_accvgpr_write_b32 a98,v218
v_accvgpr_write_b32 a99,v219
v_perm_b32 v216,v124,v120,s62
v_perm_b32 v217,v132,v128,s62
v_perm_b32 v218,v140,v136,s62
v_perm_b32 v219,v148,v144,s62
v_accvgpr_write_b32 a100,v216
v_accvgpr_write_b32 a101,v217
v_accvgpr_write_b32 a102,v218
v_accvgpr_write_b32 a103,v219
v_perm_b32 v216,v125,v121,s61
v_perm_b32 v217,v133,v129,s61
v_perm_b32 v218,v141,v137,s61
v_perm_b32 v219,v149,v145,s61
v_accvgpr_write_b32 a104,v216
v_accvgpr_write_b32 a105,v217
v_accvgpr_write_b32 a106,v218
v_accvgpr_write_b32 a107,v219
v_perm_b32 v216,v125,v121,s62
v_perm_b32 v217,v133,v129,s62
v_perm_b32 v218,v141,v137,s62
v_perm_b32 v219,v149,v145,s62
v_accvgpr_write_b32 a108,v216
v_accvgpr_write_b32 a109,v217
v_accvgpr_write_b32 a110,v218
v_accvgpr_write_b32 a111,v219
v_perm_b32 v216,v126,v122,s61
v_perm_b32 v217,v134,v130,s61
v_perm_b32 v218,v142,v138,s61
v_perm_b32 v219,v150,v146,s61
v_accvgpr_write_b32 a112,v216
v_accvgpr_write_b32 a113,v217
v_accvgpr_write_b32 a114,v218
v_accvgpr_write_b32 a115,v219
v_perm_b32 v216,v126,v122,s62
v_perm_b32 v217,v134,v130,s62
v_perm_b32 v218,v142,v138,s62
v_perm_b32 v219,v150,v146,s62
v_accvgpr_write_b32 a116,v216
v_accvgpr_write_b32 a117,v217
v_accvgpr_write_b32 a118,v218
v_accvgpr_write_b32 a119,v219
v_perm_b32 v216,v127,v123,s61
v_perm_b32 v217,v135,v131,s61
v_perm_b32 v218,v143,v139,s61
v_perm_b32 v219,v151,v147,s61
v_accvgpr_write_b32 a120,v216
v_accvgpr_write_b32 a121,v217
v_accvgpr_write_b32 a122,v218
v_accvgpr_write_b32 a123,v219
v_perm_b32 v216,v127,v123,s62
v_perm_b32 v217,v135,v131,s62
v_perm_b32 v218,v143,v139,s62
v_perm_b32 v219,v151,v147,s62
v_accvgpr_write_b32 a124,v216
v_accvgpr_write_b32 a125,v217
v_accvgpr_write_b32 a126,v218
v_accvgpr_write_b32 a127,v219
s_waitcnt vmcnt(24)
v_perm_b32 v216,v156,v152,s61
v_perm_b32 v217,v164,v160,s61
v_perm_b32 v218,v172,v168,s61
v_perm_b32 v219,v180,v176,s61
v_accvgpr_write_b32 a128,v216
v_accvgpr_write_b32 a129,v217
v_accvgpr_write_b32 a130,v218
v_accvgpr_write_b32 a131,v219
v_perm_b32 v216,v156,v152,s62
v_perm_b32 v217,v164,v160,s62
v_perm_b32 v218,v172,v168,s62
v_perm_b32 v219,v180,v176,s62
v_accvgpr_write_b32 a132,v216
v_accvgpr_write_b32 a133,v217
v_accvgpr_write_b32 a134,v218
v_accvgpr_write_b32 a135,v219
v_perm_b32 v216,v157,v153,s61
v_perm_b32 v217,v165,v161,s61
v_perm_b32 v218,v173,v169,s61
v_perm_b32 v219,v181,v177,s61
v_accvgpr_write_b32 a136,v216
v_accvgpr_write_b32 a137,v217
v_accvgpr_write_b32 a138,v218
v_accvgpr_write_b32 a139,v219
v_perm_b32 v216,v157,v153,s62
v_perm_b32 v217,v165,v161,s62
v_perm_b32 v218,v173,v169,s62
v_perm_b32 v219,v181,v177,s62
v_accvgpr_write_b32 a140,v216
v_accvgpr_write_b32 a141,v217
v_accvgpr_write_b32 a142,v218
v_accvgpr_write_b32 a143,v219
v_perm_b32 v216,v158,v154,s61
v_perm_b32 v217,v166,v162,s61
v_perm_b32 v218,v174,v170,s61
v_perm_b32 v219,v182,v178,s61
v_accvgpr_write_b32 a144,v216
v_accvgpr_write_b32 a145,v217
v_accvgpr_write_b32 a146,v218
v_accvgpr_write_b32 a147,v219
v_perm_b32 v216,v158,v154,s62
v_perm_b32 v217,v166,v162,s62
v_perm_b32 v218,v174,v170,s62
v_perm_b32 v219,v182,v178,s62
v_accvgpr_write_b32 a148,v216
v_accvgpr_write_b32 a149,v217
v_accvgpr_write_b32 a150,v218
v_accvgpr_write_b32 a151,v219
v_perm_b32 v216,v159,v155,s61
v_perm_b32 v217,v167,v163,s61
v_perm_b32 v218,v175,v171,s61
v_perm_b32 v219,v183,v179,s61
v_accvgpr_write_b32 a152,v216
v_accvgpr_write_b32 a153,v217
v_accvgpr_write_b32 a154,v218
v_accvgpr_write_b32 a155,v219
v_perm_b32 v216,v159,v155,s62
v_perm_b32 v217,v167,v163,s62
v_perm_b32 v218,v175,v171,s62
v_perm_b32 v219,v183,v179,s62
v_accvgpr_write_b32 a156,v216
v_accvgpr_write_b32 a157,v217
v_accvgpr_write_b32 a158,v218
v_accvgpr_write_b32 a159,v219
s_waitcnt vmcnt(16)
v_perm_b32 v216,v188,v184,s61
v_perm_b32 v217,v196,v192,s61
v_perm_b32 v218,v204,v200,s61
v_perm_b32 v219,v212,v208,s61
v_accvgpr_write_b32 a160,v216
v_accvgpr_write_b32 a161,v217
v_accvgpr_write_b32 a162,v218
v_accvgpr_write_b32 a163,v219
v_perm_b32 v216,v188,v184,s62
v_perm_b32 v217,v196,v192,s62
v_perm_b32 v218,v204,v200,s62
v_perm_b32 v219,v212,v208,s62
v_accvgpr_write_b32 a164,v216
v_accvgpr_write_b32 a165,v217
v_accvgpr_write_b32 a166,v218
v_accvgpr_write_b32 a167,v219
v_perm_b32 v216,v189,v185,s61
v_perm_b32 v217,v197,v193,s61
v_perm_b32 v218,v205,v201,s61
v_perm_b32 v219,v213,v209,s61
v_accvgpr_write_b32 a168,v216
v_accvgpr_write_b32 a169,v217
v_accvgpr_write_b32 a170,v218
v_accvgpr_write_b32 a171,v219
v_perm_b32 v216,v189,v185,s62
v_perm_b32 v217,v197,v193,s62
v_perm_b32 v218,v205,v201,s62
v_perm_b32 v219,v213,v209,s62
v_accvgpr_write_b32 a172,v216
v_accvgpr_write_b32 a173,v217
v_accvgpr_write_b32 a174,v218
v_accvgpr_write_b32 a175,v219
v_perm_b32 v216,v190,v186,s61
v_perm_b32 v217,v198,v194,s61
v_perm_b32 v218,v206,v202,s61
v_perm_b32 v219,v214,v210,s61
v_accvgpr_write_b32 a176,v216
v_accvgpr_write_b32 a177,v217
v_accvgpr_write_b32 a178,v218
v_accvgpr_write_b32 a179,v219
v_perm_b32 v216,v190,v186,s62
v_perm_b32 v217,v198,v194,s62
v_perm_b32 v218,v206,v202,s62
v_perm_b32 v219,v214,v210,s62
v_accvgpr_write_b32 a180,v216
v_accvgpr_write_b32 a181,v217
v_accvgpr_write_b32 a182,v218
v_accvgpr_write_b32 a183,v219
v_perm_b32 v216,v191,v187,s61
v_perm_b32 v217,v199,v195,s61
v_perm_b32 v218,v207,v203,s61
v_perm_b32 v219,v215,v211,s61
v_accvgpr_write_b32 a184,v216
v_accvgpr_write_b32 a185,v217
v_accvgpr_write_b32 a186,v218
v_accvgpr_write_b32 a187,v219
v_perm_b32 v216,v191,v187,s62
v_perm_b32 v217,v199,v195,s62
v_perm_b32 v218,v207,v203,s62
v_perm_b32 v219,v215,v211,s62
v_accvgpr_write_b32 a188,v216
v_accvgpr_write_b32 a189,v217
v_accvgpr_write_b32 a190,v218
v_accvgpr_write_b32 a191,v219
s_waitcnt vmcnt(8)
v_perm_b32 v216,v28,v24,s61
v_perm_b32 v217,v36,v32,s61
v_perm_b32 v218,v44,v40,s61
v_perm_b32 v219,v52,v48,s61
v_accvgpr_write_b32 a192,v216
v_accvgpr_write_b32 a193,v217
v_accvgpr_write_b32 a194,v218
v_accvgpr_write_b32 a195,v219
v_perm_b32 v216,v28,v24,s62
v_perm_b32 v217,v36,v32,s62
v_perm_b32 v218,v44,v40,s62
v_perm_b32 v219,v52,v48,s62
v_accvgpr_write_b32 a196,v216
v_accvgpr_write_b32 a197,v217
v_accvgpr_write_b32 a198,v218
v_accvgpr_write_b32 a199,v219
v_perm_b32 v216,v29,v25,s61
v_perm_b32 v217,v37,v33,s61
v_perm_b32 v218,v45,v41,s61
v_perm_b32 v219,v53,v49,s61
v_accvgpr_write_b32 a200,v216
v_accvgpr_write_b32 a201,v217
v_accvgpr_write_b32 a202,v218
v_accvgpr_write_b32 a203,v219
v_perm_b32 v216,v29,v25,s62
v_perm_b32 v217,v37,v33,s62
v_perm_b32 v218,v45,v41,s62
v_perm_b32 v219,v53,v49,s62
v_accvgpr_write_b32 a204,v216
v_accvgpr_write_b32 a205,v217
v_accvgpr_write_b32 a206,v218
v_accvgpr_write_b32 a207,v219
v_perm_b32 v216,v30,v26,s61
v_perm_b32 v217,v38,v34,s61
v_perm_b32 v218,v46,v42,s61
v_perm_b32 v219,v54,v50,s61
v_accvgpr_write_b32 a208,v216
v_accvgpr_write_b32 a209,v217
v_accvgpr_write_b32 a210,v218
v_accvgpr_write_b32 a211,v219
v_perm_b32 v216,v30,v26,s62
v_perm_b32 v217,v38,v34,s62
v_perm_b32 v218,v46,v42,s62
v_perm_b32 v219,v54,v50,s62
v_accvgpr_write_b32 a212,v216
v_accvgpr_write_b32 a213,v217
v_accvgpr_write_b32 a214,v218
v_accvgpr_write_b32 a215,v219
v_perm_b32 v216,v31,v27,s61
v_perm_b32 v217,v39,v35,s61
v_perm_b32 v218,v47,v43,s61
v_perm_b32 v219,v55,v51,s61
v_accvgpr_write_b32 a216,v216
v_accvgpr_write_b32 a217,v217
v_accvgpr_write_b32 a218,v218
v_accvgpr_write_b32 a219,v219
v_perm_b32 v216,v31,v27,s62
v_perm_b32 v217,v39,v35,s62
v_perm_b32 v218,v47,v43,s62
v_perm_b32 v219,v55,v51,s62
v_accvgpr_write_b32 a220,v216
v_accvgpr_write_b32 a221,v217
v_accvgpr_write_b32 a222,v218
v_accvgpr_write_b32 a223,v219
s_waitcnt vmcnt(0)
v_perm_b32 v216,v60,v56,s61
v_perm_b32 v217,v68,v64,s61
v_perm_b32 v218,v76,v72,s61
v_perm_b32 v219,v84,v80,s61
v_accvgpr_write_b32 a224,v216
v_accvgpr_write_b32 a225,v217
v_accvgpr_write_b32 a226,v218
v_accvgpr_write_b32 a227,v219
v_perm_b32 v216,v60,v56,s62
v_perm_b32 v217,v68,v64,s62
v_perm_b32 v218,v76,v72,s62
v_perm_b32 v219,v84,v80,s62
v_accvgpr_write_b32 a228,v216
v_accvgpr_write_b32 a229,v217
v_accvgpr_write_b32 a230,v218
v_accvgpr_write_b32 a231,v219
v_perm_b32 v216,v61,v57,s61
v_perm_b32 v217,v69,v65,s61
v_perm_b32 v218,v77,v73,s61
v_perm_b32 v219,v85,v81,s61
v_accvgpr_write_b32 a232,v216
v_accvgpr_write_b32 a233,v217
v_accvgpr_write_b32 a234,v218
v_accvgpr_write_b32 a235,v219
v_perm_b32 v216,v61,v57,s62
v_perm_b32 v217,v69,v65,s62
v_perm_b32 v218,v77,v73,s62
v_perm_b32 v219,v85,v81,s62
v_accvgpr_write_b32 a236,v216
v_accvgpr_write_b32 a237,v217
v_accvgpr_write_b32 a238,v218
v_accvgpr_write_b32 a239,v219
v_perm_b32 v216,v62,v58,s61
v_perm_b32 v217,v70,v66,s61
v_perm_b32 v218,v78,v74,s61
v_perm_b32 v219,v86,v82,s61
v_accvgpr_write_b32 a240,v216
v_accvgpr_write_b32 a241,v217
v_accvgpr_write_b32 a242,v218
v_accvgpr_write_b32 a243,v219
v_perm_b32 v216,v62,v58,s62
v_perm_b32 v217,v70,v66,s62
v_perm_b32 v218,v78,v74,s62
v_perm_b32 v219,v86,v82,s62
v_accvgpr_write_b32 a244,v216
v_accvgpr_write_b32 a245,v217
v_accvgpr_write_b32 a246,v218
v_accvgpr_write_b32 a247,v219
v_perm_b32 v216,v63,v59,s61
v_perm_b32 v217,v71,v67,s61
v_perm_b32 v218,v79,v75,s61
v_perm_b32 v219,v87,v83,s61
v_accvgpr_write_b32 a248,v216
v_accvgpr_write_b32 a249,v217
v_accvgpr_write_b32 a250,v218
v_accvgpr_write_b32 a251,v219
v_perm_b32 v216,v63,v59,s62
v_perm_b32 v217,v71,v67,s62
v_perm_b32 v218,v79,v75,s62
v_perm_b32 v219,v87,v83,s62
v_accvgpr_write_b32 a252,v216
v_accvgpr_write_b32 a253,v217
v_accvgpr_write_b32 a254,v218
v_accvgpr_write_b32 a255,v219
v_mov_b32 v123,159744
s_cmp_lg_u32 s46,0
s_cbranch_scc1 L_gbd_77
v_mov_b32 v124,128
L_gb_76:
buffer_load_dword v125,v124,s[12:15],0 offen sc1
s_waitcnt vmcnt(0)
v_readfirstlane_b32 s56,v125
ds_write_b32 v123,v125
s_bitcmp1_b32 s56,8
s_cbranch_scc1 L_gbd_77
s_sleep 4
s_sub_u32 s49,s49,1
s_cmp_gt_i32 s49,0
s_cbranch_scc1 L_gb_76
s_branch L_abort
L_gbd_77:
s_waitcnt lgkmcnt(0)
s_barrier
ds_read_b32 v125,v123
s_waitcnt lgkmcnt(0)
v_readfirstlane_b32 s56,v125
s_barrier
s_lshr_b32 s56,s56,16
s_andn2_b32 s56,s56,s3
s_cbranch_scc1 L_spread
s_max_u32 s54,s48,5
s_sub_u32 s54,s54,5
s_lshl_b32 s54,s54,1
s_lshr_b32 s56,s47,4
s_add_u32 s54,s54,s56
s_cmp_lg_u32 s3,0
s_cbranch_scc1 L_wa
v_and_b32 v238,15,v1
v_and_b32 v239,1,v1
v_lshlrev_b32 v239,4,v239
v_mov_b32 v240,0x3f80
v_lshlrev_b32 v240,v239,v240
v_lshrrev_b32 v238,1,v238
v_cmp_eq_u32 vcc,0,v238
s_nop 1
v_cndmask_b32 v156,0,v240,vcc
v_cmp_eq_u32 vcc,1,v238
s_nop 1
v_cndmask_b32 v157,0,v240,vcc
v_cmp_eq_u32 vcc,2,v238
s_nop 1
v_cndmask_b32 v158,0,v240,vcc
v_cmp_eq_u32 vcc,3,v238
s_nop 1
v_cndmask_b32 v159,0,v240,vcc
s_mov_b32 s4,s32
s_mov_b32 s5,s33
s_mov_b32 s6,1024
s_mov_b32 s7,0x20000
buffer_load_dwordx4 v[224:227],v0,s[4:7],0 offen
v_and_b32 v238,15,v1
v_lshrrev_b32 v239,4,v1
v_lshlrev_b32 v240,2,v239
v_mov_b32 v241,0xf149f2ca
s_and_b32 s56,s46,1
s_lshl_b32 s56,s56,4
v_add_u32 v242,s56,v238
v_add_u32 v243,0,v240
v_cmp_gt_u32 vcc,v243,v242
s_nop 1
v_cndmask_b32 v8,0,v241,vcc
v_add_u32 v243,1,v240
v_cmp_gt_u32 vcc,v243,v242
s_nop 1
v_cndmask_b32 v9,0,v241,vcc
v_add_u32 v243,2,v240
v_cmp_gt_u32 vcc,v243,v242
s_nop 1
v_cndmask_b32 v10,0,v241,vcc
v_add_u32 v243,3,v240
v_cmp_gt_u32 vcc,v243,v242
s_nop 1
v_cndmask_b32 v11,0,v241,vcc
v_add_u32 v243,16,v240
v_cmp_gt_u32 vcc,v243,v242
s_nop 1
v_cndmask_b32 v12,0,v241,vcc
v_add_u32 v243,17,v240
v_cmp_gt_u32 vcc,v243,v242
s_nop 1
v_cndmask_b32 v13,0,v241,vcc
v_add_u32 v243,18,v240
v_cmp_gt_u32 vcc,v243,v242
s_nop 1
v_cndmask_b32 v14,0,v241,vcc
v_add_u32 v243,19,v240
v_cmp_gt_u32 vcc,v243,v242
s_nop 1
v_cndmask_b32 v15,0,v241,vcc
v_mov_b32 v152,s80
v_mov_b32 v145,0
v_mov_b32 v146,0
s_lshl_b32 s56,s46,12
s_add_u32 s56,s56,131072
v_add_u32 v3,s56,v0
v_add_u32 v4,131072,v0
s_lshl_b32 s56,s46,8
v_lshlrev_b32 v7,4,v238
v_add_u32 v7,s56,v7
v_lshl_add_u32 v5,v239,16,v7
v_lshlrev_b32 v6,1,v7
v_lshl_add_u32 v7,v239,10,v7
v_and_b32 v243,1,v239
v_lshl_add_u32 v6,v243,4,v6
v_lshrrev_b32 v243,1,v239
v_lshl_add_u32 v6,v243,12,v6
v_add_u32 v6,147456,v6
v_lshlrev_b32 v16,2,v1
v_lshlrev_b32 v21,3,v238
s_and_b32 s68,s47,15
s_lshl_b32 s56,s68,10
v_add_u32 v5,s56,v5
s_lshl_b32 s56,s68,15
v_add_u32 v7,s56,v7
s_lshl_b32 s69,s54,20
s_add_u32 s69,s69,20971520
s_lshl_b32 s87,s54,13
s_add_u32 s87,s87,10486272
s_lshl4_add_u32 s74,s68,s87
s_lshl2_add_u32 s74,s46,s74
s_lshl_b32 s68,s68,1
s_lshr_b32 s56,s46,1
s_add_u32 s68,s68,s56
s_mov_b32 s66,0
s_mov_b32 s67,0
s_mov_b32 s73,0x80000000
s_mov_b32 s75,0
s_mov_b32 s37,0
s_mov_b32 s42,4294966272
s_mov_b32 s43,4294967295
s_mov_b64 s[38:39],0
s_sub_u32 s36,s54,12
s_and_b32 s36,s36,3
s_mov_b32 s12,s40
s_mov_b32 s13,s41
s_mov_b32 s14,2097152
s_mov_b32 s15,0x20000
s_and_b32 s29,s46,1
s_mul_i32 s28,s29,12288
s_lshl_b32 s29,s29,11
s_and_b32 s56,s50,2048
s_lshl_b32 s56,s56,4
s_add_u32 s56,s56,65536
s_add_u32 s40,s56,s28
s_add_u32 s41,s56,s29
v_add_u32 v21,10487168,v21
v_mov_b32 v244,v21
s_and_b32 s56,s50,2048
s_add_u32 s56,s56,147456
v_lshlrev_b32 v23,5,v1
v_add_u32 v23,s56,v23
v_and_b32 v253,32,v0
v_lshrrev_b32 v245,2,v253
v_add_u32 v253,v253,v245
v_sub_u32 v253,v0,v253
v_add_u32 v253,8,v253
v_mov_b32 v254,0x80000000
s_mov_b32 s56,1408
v_writelane_b32 v254,s56,0
s_mov_b32 s56,256
v_writelane_b32 v254,s56,1
s_mov_b32 s56,1280
v_writelane_b32 v254,s56,2
v_mov_b32 v245,155648
s_lshl_b32 s56,s46,2
v_add_u32 v247,s56,v245
s_waitcnt vmcnt(0)
v_lshlrev_b32 v228,16,v224
v_and_b32 v229,0xffff0000,v224
v_lshlrev_b32 v230,16,v225
v_and_b32 v231,0xffff0000,v225
v_lshlrev_b32 v232,16,v226
v_and_b32 v233,0xffff0000,v226
v_lshlrev_b32 v234,16,v227
v_and_b32 v235,0xffff0000,v227
v_mul_f32 v255,v228,v228
v_fma_f32 v255,v229,v229,v255
v_fma_f32 v255,v230,v230,v255
v_fma_f32 v255,v231,v231,v255
v_fma_f32 v255,v232,v232,v255
v_fma_f32 v255,v233,v233,v255
v_fma_f32 v255,v234,v234,v255
v_fma_f32 v255,v235,v235,v255
s_nop 1
v_add_f32_dpp v255,v255,v255 row_ror:8 row_mask:0xf bank_mask:0xf
s_nop 1
v_add_f32_dpp v255,v255,v255 row_ror:4 row_mask:0xf bank_mask:0xf
s_nop 1
v_add_f32_dpp v255,v255,v255 row_ror:2 row_mask:0xf bank_mask:0xf
s_nop 1
v_add_f32_dpp v255,v255,v255 row_ror:1 row_mask:0xf bank_mask:0xf
v_mov_b32 v238,v255
s_nop 1
v_permlane16_swap_b32 v255,v238
v_add_f32 v255,v255,v238
v_mov_b32 v238,v255
s_nop 1
v_permlane32_swap_b32 v255,v238
v_add_f32 v255,v255,v238
v_sqrt_f32 v255,v255
v_sub_u32 v238,68,v1
v_cvt_f32_u32 v238,v238
v_log_f32 v238,v238
v_mov_b32 v239,0x3ff9999a
v_fmac_f32 v239,0x3e632166,v238
v_mul_f32 v255,v255,v239
v_or_b32 v255,0x80000000,v255
s_xor_b32 s34,s69,524288
buffer_load_dwordx4 v[160:163],v7,s[8:11],s34 offen
s_add_u32 s34,s34,4096
buffer_load_dwordx4 v[164:167],v7,s[8:11],s34 offen
s_add_u32 s34,s34,4096
buffer_load_dwordx4 v[168:171],v7,s[8:11],s34 offen
s_add_u32 s34,s34,4096
buffer_load_dwordx4 v[172:175],v7,s[8:11],s34 offen
s_add_u32 s34,s34,4096
buffer_load_dwordx4 v[176:179],v7,s[8:11],s34 offen
s_add_u32 s34,s34,4096
buffer_load_dwordx4 v[180:183],v7,s[8:11],s34 offen
s_add_u32 s34,s34,4096
buffer_load_dwordx4 v[184:187],v7,s[8:11],s34 offen
s_add_u32 s34,s34,4096
buffer_load_dwordx4 v[188:191],v7,s[8:11],s34 offen
s_xor_b32 s69,s69,524288
s_xor_b32 s34,s69,524288
buffer_load_dwordx4 v[160:163],v7,s[8:11],s34 offen
s_add_u32 s34,s34,4096
buffer_load_dwordx4 v[164:167],v7,s[8:11],s34 offen
s_add_u32 s34,s34,4096
buffer_load_dwordx4 v[168:171],v7,s[8:11],s34 offen
s_add_u32 s34,s34,4096
buffer_load_dwordx4 v[172:175],v7,s[8:11],s34 offen
s_add_u32 s34,s34,4096
buffer_load_dwordx4 v[176:179],v7,s[8:11],s34 offen
s_add_u32 s34,s34,4096
buffer_load_dwordx4 v[180:183],v7,s[8:11],s34 offen
s_add_u32 s34,s34,4096
buffer_load_dwordx4 v[184:187],v7,s[8:11],s34 offen
s_add_u32 s34,s34,4096
buffer_load_dwordx4 v[188:191],v7,s[8:11],s34 offen
s_xor_b32 s69,s69,524288
s_cmp_lt_u32 s54,2
s_cbranch_scc1 L_aa_78
s_sub_u32 s77,s54,2
s_mov_b32 s30,0
s_mov_b32 s86,1536
s_lshl_b32 s56,s77,5
s_add_u32 s56,s56,s68
s_mul_i32 s70,s56,24576
s_lshl_b32 s71,s56,12
s_lshl_b32 s59,s77,13
s_lshl2_add_u32 s59,s68,s59
s_add_u32 s59,s59,10485760
s_buffer_load_dword s32,s[8:11],s59
s_mov_b32 s33,1
s_add_u32 s70,s70,100663296
s_add_u32 s71,s71,41943040
v_mov_b32 v19,s59
s_branch L_aa_86
L_aa_92:
s_bitcmp1_b32 s46,0
s_cbranch_scc1 L_av_93
ds_read_b128 v[24:27],v4 offset:0
ds_read_b128 v[28:31],v4 offset:1024
s_min_u32 s56,s32,s33
s_cmp_lt_u32 s77,64
s_cselect_b32 s56,s56,0
s_cmp_eq_u32 s56,0
s_cselect_b32 s72,0x80000000,0
v_mov_b32 v248,s72
s_or_b32 s64,s70,s72
s_or_b32 s65,s71,s72
s_cmp_lt_u32 s30,s31
s_cselect_b32 s65,0x80000000,s65
s_add_u32 s64,s64,s28
s_add_u32 s65,s65,s29
s_xor_b32 s58,s67,s40
s_xor_b32 s57,s67,s41
s_add_u32 m0,s58,0
s_waitcnt lgkmcnt(1)
v_mfma_f32_16x16x32_bf16 v[160:163],v[24:27],a[0:3],0
buffer_load_dwordx4 v0,s[8:11],s64 offen offset:0 sc1 lds
v_mfma_f32_16x16x32_bf16 v[164:167],v[24:27],a[4:7],0
ds_read_b128 v[32:35],v4 offset:2048
v_lshlrev_b32 v88,16,v224
v_mfma_f32_16x16x32_bf16 v[168:171],v[24:27],a[8:11],0
ds_read_b128 v[36:39],v4 offset:3072
v_and_b32 v89,0xffff0000,v224
v_mfma_f32_16x16x32_bf16 v[172:175],v[24:27],a[12:15],0
ds_read_b128 v[40:43],v4 offset:8192
v_lshlrev_b32 v90,16,v225
v_mfma_f32_16x16x32_bf16 v[176:179],v[24:27],a[16:19],0
buffer_load_dwordx4 v0,s[8:11],s64 offen offset:1024 sc1 lds
v_mfma_f32_16x16x32_bf16 v[180:183],v[24:27],a[20:23],0
ds_read_b128 v[44:47],v4 offset:9216
v_and_b32 v91,0xffff0000,v225
v_mfma_f32_16x16x32_bf16 v[184:187],v[24:27],a[24:27],0
ds_read_b128 v[48:51],v4 offset:10240
s_waitcnt vmcnt(9)
v_mfma_f32_16x16x32_bf16 v[188:191],v[24:27],a[28:31],0
ds_read_b128 v[52:55],v4 offset:11264
v_mfma_f32_16x16x32_bf16 v[128:131],v[156:159],v[192:195],0
ds_write_b32 v247,v248
v_lshlrev_b32 v92,16,v226
s_waitcnt lgkmcnt(7)
v_mfma_f32_16x16x32_bf16 v[160:163],v[28:31],a[32:35],v[160:163]
buffer_load_dwordx4 v0,s[8:11],s64 offen offset:2048 sc1 lds
v_mfma_f32_16x16x32_bf16 v[164:167],v[28:31],a[36:39],v[164:167]
ds_read_b128 v[56:59],v4 offset:4096
s_waitcnt vmcnt(9)
v_mfma_f32_16x16x32_bf16 v[168:171],v[28:31],a[40:43],v[168:171]
ds_read_b128 v[60:63],v4 offset:5120
v_mfma_f32_16x16x32_bf16 v[128:131],v[156:159],v[196:199],v[128:131]
ds_read_b128 v[64:67],v4 offset:6144
v_and_b32 v93,0xffff0000,v226
v_mfma_f32_16x16x32_bf16 v[172:175],v[28:31],a[44:47],v[172:175]
ds_read_b128 v[68:71],v4 offset:7168
s_waitcnt vmcnt(8)
v_mfma_f32_16x16x32_bf16 v[176:179],v[28:31],a[48:51],v[176:179]
buffer_load_dwordx4 v0,s[8:11],s64 offen offset:3072 sc1 lds
v_mfma_f32_16x16x32_bf16 v[180:183],v[28:31],a[52:55],v[180:183]
ds_read_b128 v[72:75],v4 offset:12288
v_mfma_f32_16x16x32_bf16 v[128:131],v[156:159],v[200:203],v[128:131]
ds_read_b128 v[76:79],v4 offset:13312
v_lshlrev_b32 v94,16,v227
v_mfma_f32_16x16x32_bf16 v[184:187],v[28:31],a[56:59],v[184:187]
ds_read_b128 v[80:83],v4 offset:14336
s_waitcnt vmcnt(8)
v_mfma_f32_16x16x32_bf16 v[188:191],v[28:31],a[60:63],v[188:191]
ds_read_b128 v[84:87],v4 offset:15360
v_mfma_f32_16x16x32_bf16 v[128:131],v[156:159],v[204:207],v[128:131]
v_and_b32 v95,0xffff0000,v227
v_readfirstlane_b32 s22,v246
s_waitcnt lgkmcnt(14)
v_mfma_f32_16x16x32_bf16 v[160:163],v[32:35],a[64:67],v[160:163]
s_waitcnt vmcnt(7)
v_mfma_f32_16x16x32_bf16 v[132:135],v[156:159],v[208:211],0
s_add_u32 m0,s58,4096
s_add_u32 s64,s64,4096
s_cmp_eq_u32 s22,0
s_cbranch_scc1 L_ag_94
L_agb_95:
v_mfma_f32_16x16x32_bf16 v[164:167],v[32:35],a[68:71],v[164:167]
buffer_load_dwordx4 v0,s[8:11],s64 offen offset:0 sc1 lds
v_mfma_f32_16x16x32_bf16 v[168:171],v[32:35],a[72:75],v[168:171]
s_waitcnt vmcnt(7)
v_mfma_f32_16x16x32_bf16 v[132:135],v[156:159],v[212:215],v[132:135]
s_lshl_b32 s18,s26,5
s_add_u32 s18,s18,s68
s_lshl_b32 s19,s18,10
v_mfma_f32_16x16x32_bf16 v[172:175],v[32:35],a[76:79],v[172:175]
s_waitcnt vmcnt(6)
v_mfma_f32_16x16x32_bf16 v[132:135],v[156:159],v[216:219],v[132:135]
s_add_u32 s20,s19,6291456
s_lshl_b32 s23,s51,5
s_add_u32 s23,s23,s68
v_mfma_f32_16x16x32_bf16 v[176:179],v[32:35],a[80:83],v[176:179]
ds_write_b128 v6,v[128:131]
v_mfma_f32_16x16x32_bf16 v[180:183],v[32:35],a[84:87],v[180:183]
buffer_load_dwordx4 v0,s[8:11],s64 offen offset:1024 sc1 lds
v_mfma_f32_16x16x32_bf16 v[184:187],v[32:35],a[88:91],v[184:187]
s_waitcnt vmcnt(6)
v_mfma_f32_16x16x32_bf16 v[132:135],v[156:159],v[220:223],v[132:135]
s_lshl_b32 s24,s23,10
s_lshl_b32 s25,s51,10
s_add_u32 s25,s25,2883584
v_mfma_f32_16x16x32_bf16 v[188:191],v[32:35],a[92:95],v[188:191]
s_cmp_eq_u32 s23,s55
s_cselect_b32 s25,s25,s24
s_add_u32 s25,s25,8388608
s_waitcnt lgkmcnt(14)
v_mfma_f32_16x16x32_bf16 v[160:163],v[36:39],a[96:99],v[160:163]
s_mov_b32 s6,268435456
s_cmp_eq_u32 s31,0
s_cselect_b32 s25,s24,s25
s_cselect_b64 s[4:5],s[16:17],s[44:45]
s_cmov_b32 s6,2097152
v_mfma_f32_16x16x32_bf16 v[164:167],v[36:39],a[100:103],v[164:167]
ds_write_b128 v6,v[132:135] offset:2048
v_mfma_f32_16x16x32_bf16 v[168:171],v[36:39],a[104:107],v[168:171]
buffer_load_dwordx4 v0,s[8:11],s64 offen offset:2048 sc1 lds
v_mfma_f32_16x16x32_bf16 v[172:175],v[36:39],a[108:111],v[172:175]
buffer_load_dwordx4 v[224:227],v0,s[4:7],s25 offen sc1
v_mfma_f32_16x16x32_bf16 v[176:179],v[36:39],a[112:115],v[176:179]
s_lshr_b32 s24,s55,5
s_cmp_lt_u32 s51,s24
s_cselect_b32 s24,1,2
v_mfma_f32_16x16x32_bf16 v[180:183],v[36:39],a[116:119],v[180:183]
v_mov_b32 v252,s24
s_lshl2_add_u32 s25,s51,11018240
v_mfma_f32_16x16x32_bf16 v[184:187],v[36:39],a[120:123],v[184:187]
buffer_load_dwordx4 v0,s[8:11],s64 offen offset:3072 sc1 lds
v_mfma_f32_16x16x32_bf16 v[188:191],v[36:39],a[124:127],v[188:191]
s_waitcnt lgkmcnt(0)
s_barrier
s_lshl_b32 s24,s68,16
s_waitcnt lgkmcnt(14)
v_mfma_f32_16x16x32_bf16 v[160:163],v[40:43],a[128:131],v[160:163]
ds_read_b128 v[96:99],v23
s_add_u32 s24,s24,s31
v_mfma_f32_16x16x32_bf16 v[164:167],v[40:43],a[132:135],v[164:167]
ds_read_b128 v[100:103],v23 offset:16
s_add_u32 s24,s24,s86
v_mfma_f32_16x16x32_bf16 v[168:171],v[40:43],a[136:139],v[168:171]
ds_read_b128 v[248:251],v245
s_add_u32 m0,s58,8192
s_add_u32 s64,s64,4096
v_mfma_f32_16x16x32_bf16 v[172:175],v[40:43],a[140:143],v[172:175]
buffer_load_dwordx4 v0,s[8:11],s64 offen offset:0 sc1 lds
s_cmp_eq_u32 s24,1537
s_cselect_b32 s25,s25,0x80000000
v_mfma_f32_16x16x32_bf16 v[176:179],v[40:43],a[144:147],v[176:179]
buffer_store_dword v252,off,s[8:11],s25 sc1
s_bitcmp1_b64 s[38:39],s51
s_cselect_b32 s24,128,0
v_mfma_f32_16x16x32_bf16 v[180:183],v[40:43],a[148:151],v[180:183]
buffer_store_dword v20,off,s[8:11],s73 sc1
s_lshl_b32 s23,s51,13
v_mfma_f32_16x16x32_bf16 v[184:187],v[40:43],a[152:155],v[184:187]
s_lshl2_add_u32 s23,s68,s23
s_add_u32 s23,s23,10487168
s_add_u32 s23,s23,s24
s_mov_b32 s73,0x80000000
v_mfma_f32_16x16x32_bf16 v[188:191],v[40:43],a[156:159],v[188:191]
buffer_load_dwordx4 v0,s[8:11],s64 offen offset:1024 sc1 lds
v_mfma_f32_16x16x32_bf16 v[160:163],v[44:47],a[160:163],v[160:163]
buffer_load_dword v246,off,s[8:11],s23 sc1
v_lshrrev_b32 v244,4,v1
v_mfma_f32_16x16x32_bf16 v[164:167],v[44:47],a[164:167],v[164:167]
s_waitcnt lgkmcnt(0)
v_or3_b32 v248,v248,v249,v250
v_or_b32 v248,v248,v251
s_sub_u32 s23,s77,8
v_mfma_f32_16x16x32_bf16 v[168:171],v[44:47],a[168:171],v[168:171]
v_readfirstlane_b32 s72,v248
v_add_u32 v244,s23,v244
v_max_i32 v244,0,v244
v_mfma_f32_16x16x32_bf16 v[172:175],v[44:47],a[172:175],v[172:175]
buffer_load_dwordx4 v0,s[8:11],s64 offen offset:2048 sc1 lds
v_lshl_add_u32 v244,v244,13,v21
v_mfma_f32_16x16x32_bf16 v[176:179],v[44:47],a[176:179],v[176:179]
buffer_load_dwordx2 v[242:243],v244,s[8:11],0 offen sc1
s_waitcnt lgkmcnt(1)
v_mfma_f32_16x16x32_bf16 v[180:183],v[44:47],a[180:183],v[180:183]
v_cvt_pk_bf16_f32 v104,v96,v97
v_cvt_pk_bf16_f32 v105,v98,v99
v_cvt_pk_bf16_f32 v106,v100,v101
v_mfma_f32_16x16x32_bf16 v[184:187],v[44:47],a[184:187],v[184:187]
v_cvt_pk_bf16_f32 v107,v102,v103
v_lshlrev_b32 v96,16,v104
v_and_b32 v97,0xffff0000,v104
v_mfma_f32_16x16x32_bf16 v[188:191],v[44:47],a[188:191],v[188:191]
buffer_load_dwordx4 v0,s[8:11],s64 offen offset:3072 sc1 lds
v_lshlrev_b32 v98,16,v105
v_mfma_f32_16x16x32_bf16 v[160:163],v[48:51],a[192:195],v[160:163]
v_and_b32 v99,0xffff0000,v105
v_lshlrev_b32 v100,16,v106
v_and_b32 v101,0xffff0000,v106
v_mfma_f32_16x16x32_bf16 v[164:167],v[48:51],a[196:199],v[164:167]
v_lshlrev_b32 v102,16,v107
v_and_b32 v103,0xffff0000,v107
v_add_f32 v88,v88,v96
v_mfma_f32_16x16x32_bf16 v[168:171],v[48:51],a[200:203],v[168:171]
v_add_f32 v89,v89,v97
v_add_f32 v90,v90,v98
v_add_f32 v91,v91,v99
v_mfma_f32_16x16x32_bf16 v[172:175],v[48:51],a[204:207],v[172:175]
s_add_u32 m0,s57,24576
v_add_f32 v92,v92,v100
v_add_f32 v93,v93,v101
v_add_f32 v94,v94,v102
v_mfma_f32_16x16x32_bf16 v[176:179],v[48:51],a[208:211],v[176:179]
buffer_load_dwordx4 v0,s[8:11],s65 offen offset:0 sc1 lds
v_add_f32 v95,v95,v103
v_mfma_f32_16x16x32_bf16 v[180:183],v[48:51],a[212:215],v[180:183]
v_cvt_pk_bf16_f32 v104,v88,v89
v_cvt_pk_bf16_f32 v105,v90,v91
v_cvt_pk_bf16_f32 v106,v92,v93
v_mfma_f32_16x16x32_bf16 v[184:187],v[48:51],a[216:219],v[184:187]
v_cvt_pk_bf16_f32 v107,v94,v95
v_mfma_f32_16x16x32_bf16 v[188:191],v[48:51],a[220:223],v[188:191]
buffer_store_dwordx4 v[104:107],v0,s[8:11],s20 offen sc1
v_lshlrev_b32 v88,16,v104
v_mfma_f32_16x16x32_bf16 v[160:163],v[52:55],a[224:227],v[160:163]
buffer_load_dwordx4 v0,s[8:11],s65 offen offset:1024 sc1 lds
v_and_b32 v89,0xffff0000,v104
v_mfma_f32_16x16x32_bf16 v[164:167],v[52:55],a[228:231],v[164:167]
v_lshlrev_b32 v90,16,v105
v_and_b32 v91,0xffff0000,v105
v_lshlrev_b32 v92,16,v106
v_mfma_f32_16x16x32_bf16 v[168:171],v[52:55],a[232:235],v[168:171]
v_and_b32 v93,0xffff0000,v106
v_lshlrev_b32 v94,16,v107
v_and_b32 v95,0xffff0000,v107
v_mfma_f32_16x16x32_bf16 v[172:175],v[52:55],a[236:239],v[172:175]
v_readfirstlane_b32 s78,v88
v_mfma_f32_16x16x32_bf16 v[176:179],v[52:55],a[240:243],v[176:179]
s_nop 0
v_add_f32 v120,v88,-s78
v_add_f32 v121,v89,-s78
v_add_f32 v122,v90,-s78
v_mfma_f32_16x16x32_bf16 v[180:183],v[52:55],a[244:247],v[180:183]
v_add_f32 v123,v91,-s78
v_add_f32 v124,v92,-s78
v_add_f32 v125,v93,-s78
v_mfma_f32_16x16x32_bf16 v[184:187],v[52:55],a[248:251],v[184:187]
v_add_f32 v126,v94,-s78
v_add_f32 v127,v95,-s78
v_add_f32 v128,v120,v122
v_mfma_f32_16x16x32_bf16 v[188:191],v[52:55],a[252:255],v[188:191]
v_add_f32 v129,v121,v123
v_mul_f32 v130,v120,v120
v_mul_f32 v131,v121,v121
v_mfma_f32_16x16x32_bf16 v[192:195],v[56:59],a[0:3],0
v_add_f32 v132,v124,v126
v_add_f32 v133,v125,v127
v_fma_f32 v130,v122,v122,v130
v_mfma_f32_16x16x32_bf16 v[196:199],v[56:59],a[4:7],0
v_fma_f32 v131,v123,v123,v131
v_add_f32 v128,v128,v132
v_add_f32 v129,v129,v133
v_mfma_f32_16x16x32_bf16 v[200:203],v[56:59],a[8:11],0
v_fma_f32 v130,v124,v124,v130
v_fma_f32 v131,v125,v125,v131
v_add_f32 v128,v128,v129
v_mfma_f32_16x16x32_bf16 v[204:207],v[56:59],a[12:15],0
v_fma_f32 v130,v126,v126,v130
v_fma_f32 v131,v127,v127,v131
v_add_f32 v130,v130,v131
v_mfma_f32_16x16x32_bf16 v[208:211],v[56:59],a[16:19],0
s_nop 0
v_permlane32_swap_b32 v128,v130
v_add_f32 v128,v128,v130
v_cvt_pk_bf16_f32 v24,v160,v164
v_mfma_f32_16x16x32_bf16 v[212:215],v[56:59],a[20:23],0
v_add_f32_dpp v128,v128,v128 row_ror:8 row_mask:0xf bank_mask:0xf
v_cvt_pk_bf16_f32 v25,v168,v172
v_cvt_pk_bf16_f32 v26,v176,v180
v_mfma_f32_16x16x32_bf16 v[216:219],v[56:59],a[24:27],0
v_add_f32_dpp v128,v128,v128 row_ror:4 row_mask:0xf bank_mask:0xf
v_cvt_pk_bf16_f32 v27,v184,v188
v_cvt_pk_bf16_f32 v28,v161,v165
v_mfma_f32_16x16x32_bf16 v[220:223],v[56:59],a[28:31],0
v_add_f32_dpp v128,v128,v128 row_ror:2 row_mask:0xf bank_mask:0xf
v_cvt_pk_bf16_f32 v29,v169,v173
v_cvt_pk_bf16_f32 v30,v177,v181
v_mfma_f32_16x16x32_bf16 v[192:195],v[60:63],a[32:35],v[192:195]
v_add_f32_dpp v128,v128,v128 row_ror:1 row_mask:0xf bank_mask:0xf
v_mov_b32 v130,v128
v_cvt_pk_bf16_f32 v31,v185,v189
v_mfma_f32_16x16x32_bf16 v[196:199],v[60:63],a[36:39],v[196:199]
v_permlane16_swap_b32 v128,v130
v_add_f32 v128,v128,v130
v_mul_f32 v128,0x3b000000,v128
v_mfma_f32_16x16x32_bf16 v[200:203],v[60:63],a[40:43],v[200:203]
v_mov_b32 v130,v128
v_cvt_pk_bf16_f32 v32,v162,v166
v_cvt_pk_bf16_f32 v33,v170,v174
v_mfma_f32_16x16x32_bf16 v[204:207],v[60:63],a[44:47],v[204:207]
v_permlane32_swap_b32 v128,v130
v_fma_f32 v130,-v128,v128,v130
v_add_f32 v128,s78,v128
v_mfma_f32_16x16x32_bf16 v[208:211],v[60:63],a[48:51],v[208:211]
v_max_f32 v130,0,v130
v_cvt_pk_bf16_f32 v130,v128,v130
v_lshlrev_b32 v128,16,v130
v_mfma_f32_16x16x32_bf16 v[212:215],v[60:63],a[52:55],v[212:215]
v_and_b32 v130,0xffff0000,v130
v_add_f32 v130,0x3727c5ac,v130
v_cvt_pk_bf16_f32 v130,v130,v130
v_mfma_f32_16x16x32_bf16 v[216:219],v[60:63],a[56:59],v[216:219]
v_and_b32 v130,0xffff0000,v130
v_sqrt_f32 v130,v130
v_add_f32 v120,v88,-v128
v_mfma_f32_16x16x32_bf16 v[220:223],v[60:63],a[60:63],v[220:223]
v_add_f32 v121,v89,-v128
v_add_f32 v122,v90,-v128
v_add_f32 v123,v91,-v128
v_mfma_f32_16x16x32_bf16 v[192:195],v[64:67],a[64:67],v[192:195]
v_add_f32 v124,v92,-v128
v_add_f32 v125,v93,-v128
v_add_f32 v126,v94,-v128
v_mfma_f32_16x16x32_bf16 v[196:199],v[64:67],a[68:71],v[196:199]
v_add_f32 v127,v95,-v128
v_cvt_pk_bf16_f32 v130,v130,v130
v_and_b32 v130,0xffff0000,v130
v_mfma_f32_16x16x32_bf16 v[200:203],v[64:67],a[72:75],v[200:203]
v_rcp_f32 v130,v130
v_cvt_pk_bf16_f32 v108,v120,v121
v_cvt_pk_bf16_f32 v109,v122,v123
v_mfma_f32_16x16x32_bf16 v[204:207],v[64:67],a[76:79],v[204:207]
v_cvt_pk_bf16_f32 v110,v124,v125
v_cvt_pk_bf16_f32 v111,v126,v127
v_lshlrev_b32 v120,16,v108
v_mfma_f32_16x16x32_bf16 v[208:211],v[64:67],a[80:83],v[208:211]
v_cvt_pk_bf16_f32 v34,v178,v182
v_cvt_pk_bf16_f32 v35,v186,v190
v_cvt_pk_bf16_f32 v36,v163,v167
v_mfma_f32_16x16x32_bf16 v[212:215],v[64:67],a[84:87],v[212:215]
v_cvt_pk_bf16_f32 v37,v171,v175
v_cvt_pk_bf16_f32 v38,v179,v183
v_cvt_pk_bf16_f32 v39,v187,v191
v_mfma_f32_16x16x32_bf16 v[216:219],v[64:67],a[88:91],v[216:219]
v_and_b32 v121,0xffff0000,v108
v_lshlrev_b32 v122,16,v109
v_and_b32 v123,0xffff0000,v109
v_mfma_f32_16x16x32_bf16 v[220:223],v[64:67],a[92:95],v[220:223]
v_lshlrev_b32 v124,16,v110
v_and_b32 v125,0xffff0000,v110
v_lshlrev_b32 v126,16,v111
v_mfma_f32_16x16x32_bf16 v[192:195],v[68:71],a[96:99],v[192:195]
v_and_b32 v127,0xffff0000,v111
v_mul_f32 v120,v120,v130
v_mul_f32 v121,v121,v130
v_mfma_f32_16x16x32_bf16 v[196:199],v[68:71],a[100:103],v[196:199]
v_mul_f32 v122,v122,v130
v_mul_f32 v123,v123,v130
v_mul_f32 v124,v124,v130
v_mfma_f32_16x16x32_bf16 v[200:203],v[68:71],a[104:107],v[200:203]
v_mul_f32 v125,v125,v130
v_mul_f32 v126,v126,v130
v_mul_f32 v127,v127,v130
v_mfma_f32_16x16x32_bf16 v[204:207],v[68:71],a[108:111],v[204:207]
v_cvt_pk_bf16_f32 v108,v120,v121
v_cvt_pk_bf16_f32 v109,v122,v123
v_cvt_pk_bf16_f32 v110,v124,v125
v_mfma_f32_16x16x32_bf16 v[208:211],v[68:71],a[112:115],v[208:211]
s_add_u32 s62,s69,0
v_cvt_pk_bf16_f32 v111,v126,v127
v_lshlrev_b32 v112,16,v108
v_and_b32 v113,0xffff0000,v108
v_mfma_f32_16x16x32_bf16 v[212:215],v[68:71],a[116:119],v[212:215]
buffer_store_dwordx4 v[24:27],v5,s[8:11],s62 offen
v_lshlrev_b32 v114,16,v109
v_mfma_f32_16x16x32_bf16 v[216:219],v[68:71],a[120:123],v[216:219]
v_and_b32 v115,0xffff0000,v109
v_lshlrev_b32 v116,16,v110
v_and_b32 v117,0xffff0000,v110
v_mfma_f32_16x16x32_bf16 v[220:223],v[68:71],a[124:127],v[220:223]
v_lshlrev_b32 v118,16,v111
v_and_b32 v119,0xffff0000,v111
v_add_f32 v88,v88,v112
v_mfma_f32_16x16x32_bf16 v[192:195],v[72:75],a[128:131],v[192:195]
s_add_u32 s62,s69,16384
v_add_f32 v89,v89,v113
v_add_f32 v90,v90,v114
v_add_f32 v91,v91,v115
v_mfma_f32_16x16x32_bf16 v[196:199],v[72:75],a[132:135],v[196:199]
buffer_store_dwordx4 v[28:31],v5,s[8:11],s62 offen
v_add_f32 v92,v92,v116
v_mfma_f32_16x16x32_bf16 v[200:203],v[72:75],a[136:139],v[200:203]
v_add_f32 v93,v93,v117
v_add_f32 v94,v94,v118
v_add_f32 v95,v95,v119
v_mfma_f32_16x16x32_bf16 v[204:207],v[72:75],a[140:143],v[204:207]
v_cvt_pk_bf16_f32 v96,v88,v89
v_cvt_pk_bf16_f32 v97,v90,v91
v_cvt_pk_bf16_f32 v98,v92,v93
v_mfma_f32_16x16x32_bf16 v[208:211],v[72:75],a[144:147],v[208:211]
s_add_u32 s62,s69,32768
v_cvt_pk_bf16_f32 v99,v94,v95
v_mfma_f32_16x16x32_bf16 v[212:215],v[72:75],a[148:151],v[212:215]
buffer_store_dwordx4 v[32:35],v5,s[8:11],s62 offen
v_mfma_f32_16x16x32_bf16 v[216:219],v[72:75],a[152:155],v[216:219]
buffer_store_dwordx4 v[96:99],v0,s[12:15],s19 offen sc1
v_mul_f32 v236,v112,v228
v_mfma_f32_16x16x32_bf16 v[220:223],v[72:75],a[156:159],v[220:223]
v_mul_f32 v237,v113,v229
v_fma_f32 v236,v114,v230,v236
v_fma_f32 v237,v115,v231,v237
v_mfma_f32_16x16x32_bf16 v[192:195],v[76:79],a[160:163],v[192:195]
s_add_u32 s62,s69,49152
v_fma_f32 v236,v116,v232,v236
v_fma_f32 v237,v117,v233,v237
v_fma_f32 v236,v118,v234,v236
v_mfma_f32_16x16x32_bf16 v[196:199],v[76:79],a[164:167],v[196:199]
buffer_store_dwordx4 v[36:39],v5,s[8:11],s62 offen
v_fma_f32 v237,v119,v235,v237
v_mfma_f32_16x16x32_bf16 v[200:203],v[76:79],a[168:171],v[200:203]
v_add_f32 v236,v236,v237
v_mfma_f32_16x16x32_bf16 v[204:207],v[76:79],a[172:175],v[204:207]
s_nop 0
v_add_f32_dpp v236,v236,v236 row_ror:8 row_mask:0xf bank_mask:0xf
v_mfma_f32_16x16x32_bf16 v[208:211],v[76:79],a[176:179],v[208:211]
s_nop 0
v_add_f32_dpp v236,v236,v236 row_ror:4 row_mask:0xf bank_mask:0xf
v_mfma_f32_16x16x32_bf16 v[212:215],v[76:79],a[180:183],v[212:215]
s_nop 0
v_add_f32_dpp v236,v236,v236 row_ror:2 row_mask:0xf bank_mask:0xf
v_mfma_f32_16x16x32_bf16 v[216:219],v[76:79],a[184:187],v[216:219]
s_nop 0
v_add_f32_dpp v236,v236,v236 row_ror:1 row_mask:0xf bank_mask:0xf
v_mov_b32 v237,v236
v_mfma_f32_16x16x32_bf16 v[220:223],v[76:79],a[188:191],v[220:223]
s_nop 0
v_permlane16_swap_b32 v236,v237
v_add_f32 v236,v236,v237
v_mov_b32 v237,v236
v_mfma_f32_16x16x32_bf16 v[192:195],v[80:83],a[192:195],v[192:195]
s_nop 0
v_permlane32_swap_b32 v236,v237
v_add_f32 v236,v236,v237
v_cvt_pk_bf16_f32 v236,v236,v236
v_mfma_f32_16x16x32_bf16 v[196:199],v[80:83],a[196:199],v[196:199]
v_and_b32 v236,0xffff0000,v236
v_ashrrev_i32 v237,31,v236
v_or_b32 v237,0x80000000,v237
v_mfma_f32_16x16x32_bf16 v[192:195],v[84:87],a[224:227],v[192:195]
v_xor_b32 v236,v236,v237
v_and_b32 v236,0xffff0000,v236
s_sub_u32 s20,4095,s18
v_mfma_f32_16x16x32_bf16 v[196:199],v[84:87],a[228:231],v[196:199]
v_or_b32 v20,s20,v236
s_lshl_b32 s73,s26,13
s_lshl2_add_u32 s73,s68,s73
v_mfma_f32_16x16x32_bf16 v[200:203],v[80:83],a[200:203],v[200:203]
s_add_u32 s73,s73,10485760
s_add_u32 s73,s73,s86
v_mfma_f32_16x16x32_bf16 v[204:207],v[80:83],a[204:207],v[204:207]
v_cvt_pk_bf16_f32 v40,v192,v196
v_cvt_pk_bf16_f32 v44,v193,v197
v_cvt_pk_bf16_f32 v48,v194,v198
v_mfma_f32_16x16x32_bf16 v[200:203],v[84:87],a[232:235],v[200:203]
v_cvt_pk_bf16_f32 v52,v195,v199
v_mfma_f32_16x16x32_bf16 v[204:207],v[84:87],a[236:239],v[204:207]
v_mfma_f32_16x16x32_bf16 v[208:211],v[80:83],a[208:211],v[208:211]
v_mfma_f32_16x16x32_bf16 v[212:215],v[80:83],a[212:215],v[212:215]
v_mfma_f32_16x16x32_bf16 v[208:211],v[84:87],a[240:243],v[208:211]
v_mfma_f32_16x16x32_bf16 v[212:215],v[84:87],a[244:247],v[212:215]
v_cvt_pk_bf16_f32 v41,v200,v204
v_cvt_pk_bf16_f32 v45,v201,v205
v_cvt_pk_bf16_f32 v49,v202,v206
v_mfma_f32_16x16x32_bf16 v[216:219],v[80:83],a[216:219],v[216:219]
v_cvt_pk_bf16_f32 v53,v203,v207
v_mfma_f32_16x16x32_bf16 v[220:223],v[80:83],a[220:223],v[220:223]
v_cvt_pk_bf16_f32 v42,v208,v212
v_cvt_pk_bf16_f32 v46,v209,v213
v_cvt_pk_bf16_f32 v50,v210,v214
v_mfma_f32_16x16x32_bf16 v[216:219],v[84:87],a[248:251],v[216:219]
v_cvt_pk_bf16_f32 v54,v211,v215
v_mfma_f32_16x16x32_bf16 v[220:223],v[84:87],a[252:255],v[220:223]
s_nop 7
v_cvt_pk_bf16_f32 v43,v216,v220
s_add_u32 s62,s69,262144
buffer_store_dwordx4 v[40:43],v5,s[8:11],s62 offen
v_cvt_pk_bf16_f32 v47,v217,v221
s_add_u32 s62,s69,278528
buffer_store_dwordx4 v[44:47],v5,s[8:11],s62 offen
v_cvt_pk_bf16_f32 v51,v218,v222
s_add_u32 s62,s69,294912
buffer_store_dwordx4 v[48:51],v5,s[8:11],s62 offen
v_cvt_pk_bf16_f32 v55,v219,v223
s_add_u32 s62,s69,311296
buffer_store_dwordx4 v[52:55],v5,s[8:11],s62 offen
s_cmp_lg_u32 s72,0
s_cbranch_scc1 L_aa_81
s_waitcnt vmcnt(9)
s_branch L_aa_91
L_av_93:
ds_read_b128 v[24:27],v4 offset:0
ds_read_b128 v[28:31],v4 offset:1024
s_min_u32 s56,s32,s33
s_cmp_lt_u32 s77,64
s_cselect_b32 s56,s56,0
s_cmp_eq_u32 s56,0
s_cselect_b32 s72,0x80000000,0
v_mov_b32 v248,s72
s_or_b32 s64,s70,s72
s_or_b32 s65,s71,s72
s_cmp_lt_u32 s30,s31
s_cselect_b32 s65,0x80000000,s65
s_add_u32 s64,s64,s28
s_add_u32 s65,s65,s29
s_xor_b32 s58,s67,s40
s_xor_b32 s57,s67,s41
s_add_u32 m0,s58,0
s_waitcnt lgkmcnt(1)
v_mfma_f32_16x16x32_bf16 v[160:163],v[24:27],a[0:3],0
buffer_load_dwordx4 v0,s[8:11],s64 offen offset:0 sc1 lds
v_mfma_f32_16x16x32_bf16 v[164:167],v[24:27],a[4:7],0
ds_read_b128 v[32:35],v4 offset:2048
s_lshl_b32 s23,s51,5
v_mfma_f32_16x16x32_bf16 v[168:171],v[24:27],a[8:11],0
ds_read_b128 v[36:39],v4 offset:3072
s_add_u32 s23,s23,s68
v_mfma_f32_16x16x32_bf16 v[172:175],v[24:27],a[12:15],0
ds_read_b128 v[40:43],v4 offset:8192
s_lshl_b32 s24,s23,10
v_mfma_f32_16x16x32_bf16 v[176:179],v[24:27],a[16:19],0
buffer_load_dwordx4 v0,s[8:11],s64 offen offset:1024 sc1 lds
v_mfma_f32_16x16x32_bf16 v[180:183],v[24:27],a[20:23],0
ds_read_b128 v[44:47],v4 offset:9216
s_lshl_b32 s25,s51,10
v_mfma_f32_16x16x32_bf16 v[184:187],v[24:27],a[24:27],0
ds_read_b128 v[48:51],v4 offset:10240
s_waitcnt vmcnt(9)
v_mfma_f32_16x16x32_bf16 v[188:191],v[24:27],a[28:31],0
ds_read_b128 v[52:55],v4 offset:11264
v_mfma_f32_16x16x32_bf16 v[128:131],v[156:159],v[192:195],0
ds_write_b32 v247,v248
s_add_u32 s25,s25,2883584
s_waitcnt lgkmcnt(7)
v_mfma_f32_16x16x32_bf16 v[160:163],v[28:31],a[32:35],v[160:163]
buffer_load_dwordx4 v0,s[8:11],s64 offen offset:2048 sc1 lds
v_mfma_f32_16x16x32_bf16 v[164:167],v[28:31],a[36:39],v[164:167]
ds_read_b128 v[56:59],v4 offset:4096
s_waitcnt vmcnt(9)
v_mfma_f32_16x16x32_bf16 v[168:171],v[28:31],a[40:43],v[168:171]
ds_read_b128 v[60:63],v4 offset:5120
v_mfma_f32_16x16x32_bf16 v[128:131],v[156:159],v[196:199],v[128:131]
ds_read_b128 v[64:67],v4 offset:6144
s_cmp_eq_u32 s23,s55
s_cselect_b32 s25,s25,s24
v_mfma_f32_16x16x32_bf16 v[172:175],v[28:31],a[44:47],v[172:175]
ds_read_b128 v[68:71],v4 offset:7168
s_waitcnt vmcnt(8)
v_mfma_f32_16x16x32_bf16 v[176:179],v[28:31],a[48:51],v[176:179]
buffer_load_dwordx4 v0,s[8:11],s64 offen offset:3072 sc1 lds
v_mfma_f32_16x16x32_bf16 v[180:183],v[28:31],a[52:55],v[180:183]
ds_read_b128 v[72:75],v4 offset:12288
v_mfma_f32_16x16x32_bf16 v[128:131],v[156:159],v[200:203],v[128:131]
ds_read_b128 v[76:79],v4 offset:13312
s_add_u32 s25,s25,8388608
v_mfma_f32_16x16x32_bf16 v[184:187],v[28:31],a[56:59],v[184:187]
ds_read_b128 v[80:83],v4 offset:14336
s_waitcnt vmcnt(8)
v_mfma_f32_16x16x32_bf16 v[188:191],v[28:31],a[60:63],v[188:191]
ds_read_b128 v[84:87],v4 offset:15360
v_mfma_f32_16x16x32_bf16 v[128:131],v[156:159],v[204:207],v[128:131]
s_mov_b32 s6,268435456
s_cmp_eq_u32 s31,0
s_cselect_b32 s25,s24,s25
s_cselect_b64 s[4:5],s[16:17],s[44:45]
s_cmov_b32 s6,2097152
s_waitcnt lgkmcnt(14)
v_mfma_f32_16x16x32_bf16 v[160:163],v[32:35],a[64:67],v[160:163]
buffer_load_dwordx4 v[224:227],v0,s[4:7],s25 offen sc1
v_mfma_f32_16x16x32_bf16 v[164:167],v[32:35],a[68:71],v[164:167]
s_waitcnt vmcnt(8)
v_mfma_f32_16x16x32_bf16 v[132:135],v[156:159],v[208:211],0
s_add_u32 m0,s58,4096
s_add_u32 s64,s64,4096
s_lshr_b32 s24,s55,5
v_mfma_f32_16x16x32_bf16 v[168:171],v[32:35],a[72:75],v[168:171]
buffer_load_dwordx4 v0,s[8:11],s64 offen offset:0 sc1 lds
v_mfma_f32_16x16x32_bf16 v[172:175],v[32:35],a[76:79],v[172:175]
s_waitcnt vmcnt(8)
v_mfma_f32_16x16x32_bf16 v[132:135],v[156:159],v[212:215],v[132:135]
s_cmp_lt_u32 s51,s24
s_cselect_b32 s24,1,2
v_mov_b32 v252,s24
v_mfma_f32_16x16x32_bf16 v[176:179],v[32:35],a[80:83],v[176:179]
s_waitcnt vmcnt(7)
v_mfma_f32_16x16x32_bf16 v[132:135],v[156:159],v[216:219],v[132:135]
s_lshl2_add_u32 s25,s51,11018240
s_lshl_b32 s24,s68,16
s_add_u32 s24,s24,s31
v_mfma_f32_16x16x32_bf16 v[180:183],v[32:35],a[84:87],v[180:183]
ds_write_b128 v6,v[128:131]
v_mfma_f32_16x16x32_bf16 v[184:187],v[32:35],a[88:91],v[184:187]
buffer_load_dwordx4 v0,s[8:11],s64 offen offset:1024 sc1 lds
v_mfma_f32_16x16x32_bf16 v[188:191],v[32:35],a[92:95],v[188:191]
s_waitcnt vmcnt(7)
v_mfma_f32_16x16x32_bf16 v[132:135],v[156:159],v[220:223],v[132:135]
s_add_u32 s24,s24,s86
s_cmp_eq_u32 s24,1537
s_cselect_b32 s25,s25,0x80000000
s_waitcnt lgkmcnt(14)
v_mfma_f32_16x16x32_bf16 v[160:163],v[36:39],a[96:99],v[160:163]
buffer_store_dword v252,off,s[8:11],s25 sc1
v_mfma_f32_16x16x32_bf16 v[164:167],v[36:39],a[100:103],v[164:167]
s_bitcmp1_b64 s[38:39],s51
s_cselect_b32 s24,128,0
s_lshl_b32 s23,s51,13
v_mfma_f32_16x16x32_bf16 v[168:171],v[36:39],a[104:107],v[168:171]
ds_write_b128 v6,v[132:135] offset:2048
v_mfma_f32_16x16x32_bf16 v[172:175],v[36:39],a[108:111],v[172:175]
buffer_load_dwordx4 v0,s[8:11],s64 offen offset:2048 sc1 lds
v_mfma_f32_16x16x32_bf16 v[176:179],v[36:39],a[112:115],v[176:179]
s_lshl2_add_u32 s23,s68,s23
s_add_u32 s23,s23,10487168
s_add_u32 s23,s23,s24
v_mfma_f32_16x16x32_bf16 v[180:183],v[36:39],a[116:119],v[180:183]
buffer_load_dword v246,off,s[8:11],s23 sc1
v_mfma_f32_16x16x32_bf16 v[184:187],v[36:39],a[120:123],v[184:187]
v_lshrrev_b32 v244,4,v1
s_sub_u32 s23,s77,8
v_mfma_f32_16x16x32_bf16 v[188:191],v[36:39],a[124:127],v[188:191]
buffer_load_dwordx4 v0,s[8:11],s64 offen offset:3072 sc1 lds
s_waitcnt lgkmcnt(14)
v_mfma_f32_16x16x32_bf16 v[160:163],v[40:43],a[128:131],v[160:163]
s_waitcnt lgkmcnt(0)
s_barrier
v_add_u32 v244,s23,v244
v_mfma_f32_16x16x32_bf16 v[164:167],v[40:43],a[132:135],v[164:167]
ds_read_b128 v[248:251],v245
v_max_i32 v244,0,v244
v_mfma_f32_16x16x32_bf16 v[168:171],v[40:43],a[136:139],v[168:171]
buffer_store_dword v20,off,s[8:11],s73 sc1
v_mfma_f32_16x16x32_bf16 v[172:175],v[40:43],a[140:143],v[172:175]
s_add_u32 m0,s58,8192
s_add_u32 s64,s64,4096
v_lshl_add_u32 v244,v244,13,v21
v_mfma_f32_16x16x32_bf16 v[176:179],v[40:43],a[144:147],v[176:179]
buffer_load_dwordx4 v0,s[8:11],s64 offen offset:0 sc1 lds
v_mfma_f32_16x16x32_bf16 v[180:183],v[40:43],a[148:151],v[180:183]
buffer_load_dwordx2 v[242:243],v244,s[8:11],0 offen sc1
v_mfma_f32_16x16x32_bf16 v[184:187],v[40:43],a[152:155],v[184:187]
s_mov_b32 s73,0x80000000
v_mfma_f32_16x16x32_bf16 v[188:191],v[40:43],a[156:159],v[188:191]
s_waitcnt lgkmcnt(0)
v_or3_b32 v248,v248,v249,v250
v_or_b32 v248,v248,v251
v_mfma_f32_16x16x32_bf16 v[160:163],v[44:47],a[160:163],v[160:163]
buffer_load_dwordx4 v0,s[8:11],s64 offen offset:1024 sc1 lds
v_mfma_f32_16x16x32_bf16 v[164:167],v[44:47],a[164:167],v[164:167]
v_mfma_f32_16x16x32_bf16 v[168:171],v[44:47],a[168:171],v[168:171]
v_readfirstlane_b32 s72,v248
v_mfma_f32_16x16x32_bf16 v[172:175],v[44:47],a[172:175],v[172:175]
v_mfma_f32_16x16x32_bf16 v[176:179],v[44:47],a[176:179],v[176:179]
buffer_load_dwordx4 v0,s[8:11],s64 offen offset:2048 sc1 lds
v_mfma_f32_16x16x32_bf16 v[180:183],v[44:47],a[180:183],v[180:183]
v_mfma_f32_16x16x32_bf16 v[184:187],v[44:47],a[184:187],v[184:187]
v_mfma_f32_16x16x32_bf16 v[188:191],v[44:47],a[188:191],v[188:191]
v_mfma_f32_16x16x32_bf16 v[160:163],v[48:51],a[192:195],v[160:163]
buffer_load_dwordx4 v0,s[8:11],s64 offen offset:3072 sc1 lds
v_mfma_f32_16x16x32_bf16 v[164:167],v[48:51],a[196:199],v[164:167]
v_mfma_f32_16x16x32_bf16 v[168:171],v[48:51],a[200:203],v[168:171]
v_mfma_f32_16x16x32_bf16 v[172:175],v[48:51],a[204:207],v[172:175]
v_mfma_f32_16x16x32_bf16 v[176:179],v[48:51],a[208:211],v[176:179]
s_add_u32 m0,s57,24576
v_mfma_f32_16x16x32_bf16 v[180:183],v[48:51],a[212:215],v[180:183]
buffer_load_dwordx4 v0,s[8:11],s65 offen offset:0 sc1 lds
v_mfma_f32_16x16x32_bf16 v[184:187],v[48:51],a[216:219],v[184:187]
v_mfma_f32_16x16x32_bf16 v[188:191],v[48:51],a[220:223],v[188:191]
v_mfma_f32_16x16x32_bf16 v[160:163],v[52:55],a[224:227],v[160:163]
v_mfma_f32_16x16x32_bf16 v[164:167],v[52:55],a[228:231],v[164:167]
buffer_load_dwordx4 v0,s[8:11],s65 offen offset:1024 sc1 lds
v_mfma_f32_16x16x32_bf16 v[168:171],v[52:55],a[232:235],v[168:171]
v_mfma_f32_16x16x32_bf16 v[172:175],v[52:55],a[236:239],v[172:175]
v_mfma_f32_16x16x32_bf16 v[176:179],v[52:55],a[240:243],v[176:179]
v_mfma_f32_16x16x32_bf16 v[180:183],v[52:55],a[244:247],v[180:183]
v_mfma_f32_16x16x32_bf16 v[184:187],v[52:55],a[248:251],v[184:187]
v_mfma_f32_16x16x32_bf16 v[188:191],v[52:55],a[252:255],v[188:191]
v_mfma_f32_16x16x32_bf16 v[192:195],v[56:59],a[0:3],0
v_mfma_f32_16x16x32_bf16 v[196:199],v[56:59],a[4:7],0
v_mfma_f32_16x16x32_bf16 v[200:203],v[56:59],a[8:11],0
v_cvt_pk_bf16_f32 v24,v160,v164
v_cvt_pk_bf16_f32 v25,v168,v172
v_mfma_f32_16x16x32_bf16 v[204:207],v[56:59],a[12:15],0
v_cvt_pk_bf16_f32 v26,v176,v180
v_cvt_pk_bf16_f32 v27,v184,v188
v_mfma_f32_16x16x32_bf16 v[208:211],v[56:59],a[16:19],0
v_cvt_pk_bf16_f32 v28,v161,v165
v_cvt_pk_bf16_f32 v29,v169,v173
v_mfma_f32_16x16x32_bf16 v[212:215],v[56:59],a[20:23],0
v_cvt_pk_bf16_f32 v30,v177,v181
v_cvt_pk_bf16_f32 v31,v185,v189
v_mfma_f32_16x16x32_bf16 v[216:219],v[56:59],a[24:27],0
v_cvt_pk_bf16_f32 v32,v162,v166
v_cvt_pk_bf16_f32 v33,v170,v174
v_mfma_f32_16x16x32_bf16 v[220:223],v[56:59],a[28:31],0
v_cvt_pk_bf16_f32 v34,v178,v182
v_cvt_pk_bf16_f32 v35,v186,v190
v_mfma_f32_16x16x32_bf16 v[192:195],v[60:63],a[32:35],v[192:195]
v_cvt_pk_bf16_f32 v36,v163,v167
v_cvt_pk_bf16_f32 v37,v171,v175
v_mfma_f32_16x16x32_bf16 v[196:199],v[60:63],a[36:39],v[196:199]
v_cvt_pk_bf16_f32 v38,v179,v183
v_cvt_pk_bf16_f32 v39,v187,v191
v_mfma_f32_16x16x32_bf16 v[200:203],v[60:63],a[40:43],v[200:203]
v_mfma_f32_16x16x32_bf16 v[204:207],v[60:63],a[44:47],v[204:207]
v_mfma_f32_16x16x32_bf16 v[208:211],v[60:63],a[48:51],v[208:211]
v_mfma_f32_16x16x32_bf16 v[212:215],v[60:63],a[52:55],v[212:215]
v_mfma_f32_16x16x32_bf16 v[216:219],v[60:63],a[56:59],v[216:219]
v_mfma_f32_16x16x32_bf16 v[220:223],v[60:63],a[60:63],v[220:223]
v_mfma_f32_16x16x32_bf16 v[192:195],v[64:67],a[64:67],v[192:195]
v_mfma_f32_16x16x32_bf16 v[196:199],v[64:67],a[68:71],v[196:199]
v_mfma_f32_16x16x32_bf16 v[200:203],v[64:67],a[72:75],v[200:203]
v_mfma_f32_16x16x32_bf16 v[204:207],v[64:67],a[76:79],v[204:207]
v_mfma_f32_16x16x32_bf16 v[208:211],v[64:67],a[80:83],v[208:211]
v_mfma_f32_16x16x32_bf16 v[212:215],v[64:67],a[84:87],v[212:215]
v_mfma_f32_16x16x32_bf16 v[216:219],v[64:67],a[88:91],v[216:219]
v_mfma_f32_16x16x32_bf16 v[220:223],v[64:67],a[92:95],v[220:223]
v_mfma_f32_16x16x32_bf16 v[192:195],v[68:71],a[96:99],v[192:195]
v_mfma_f32_16x16x32_bf16 v[196:199],v[68:71],a[100:103],v[196:199]
v_mfma_f32_16x16x32_bf16 v[200:203],v[68:71],a[104:107],v[200:203]
v_mfma_f32_16x16x32_bf16 v[204:207],v[68:71],a[108:111],v[204:207]
v_mfma_f32_16x16x32_bf16 v[208:211],v[68:71],a[112:115],v[208:211]
s_add_u32 s62,s69,0
v_mfma_f32_16x16x32_bf16 v[212:215],v[68:71],a[116:119],v[212:215]
buffer_store_dwordx4 v[24:27],v5,s[8:11],s62 offen
v_mfma_f32_16x16x32_bf16 v[216:219],v[68:71],a[120:123],v[216:219]
v_mfma_f32_16x16x32_bf16 v[220:223],v[68:71],a[124:127],v[220:223]
v_mfma_f32_16x16x32_bf16 v[192:195],v[72:75],a[128:131],v[192:195]
v_mfma_f32_16x16x32_bf16 v[196:199],v[72:75],a[132:135],v[196:199]
s_add_u32 s62,s69,16384
v_mfma_f32_16x16x32_bf16 v[200:203],v[72:75],a[136:139],v[200:203]
buffer_store_dwordx4 v[28:31],v5,s[8:11],s62 offen
v_mfma_f32_16x16x32_bf16 v[204:207],v[72:75],a[140:143],v[204:207]
v_mfma_f32_16x16x32_bf16 v[208:211],v[72:75],a[144:147],v[208:211]
v_mfma_f32_16x16x32_bf16 v[212:215],v[72:75],a[148:151],v[212:215]
v_mfma_f32_16x16x32_bf16 v[216:219],v[72:75],a[152:155],v[216:219]
s_add_u32 s62,s69,32768
v_mfma_f32_16x16x32_bf16 v[220:223],v[72:75],a[156:159],v[220:223]
buffer_store_dwordx4 v[32:35],v5,s[8:11],s62 offen
v_mfma_f32_16x16x32_bf16 v[192:195],v[76:79],a[160:163],v[192:195]
v_mfma_f32_16x16x32_bf16 v[196:199],v[76:79],a[164:167],v[196:199]
v_mfma_f32_16x16x32_bf16 v[200:203],v[76:79],a[168:171],v[200:203]
v_mfma_f32_16x16x32_bf16 v[204:207],v[76:79],a[172:175],v[204:207]
s_add_u32 s62,s69,49152
v_mfma_f32_16x16x32_bf16 v[208:211],v[76:79],a[176:179],v[208:211]
buffer_store_dwordx4 v[36:39],v5,s[8:11],s62 offen
v_mfma_f32_16x16x32_bf16 v[212:215],v[76:79],a[180:183],v[212:215]
v_mfma_f32_16x16x32_bf16 v[216:219],v[76:79],a[184:187],v[216:219]
v_mfma_f32_16x16x32_bf16 v[220:223],v[76:79],a[188:191],v[220:223]
v_mfma_f32_16x16x32_bf16 v[192:195],v[80:83],a[192:195],v[192:195]
v_mfma_f32_16x16x32_bf16 v[196:199],v[80:83],a[196:199],v[196:199]
v_mfma_f32_16x16x32_bf16 v[192:195],v[84:87],a[224:227],v[192:195]
v_mfma_f32_16x16x32_bf16 v[196:199],v[84:87],a[228:231],v[196:199]
v_mfma_f32_16x16x32_bf16 v[200:203],v[80:83],a[200:203],v[200:203]
v_mfma_f32_16x16x32_bf16 v[204:207],v[80:83],a[204:207],v[204:207]
v_mfma_f32_16x16x32_bf16 v[200:203],v[84:87],a[232:235],v[200:203]
v_mfma_f32_16x16x32_bf16 v[204:207],v[84:87],a[236:239],v[204:207]
v_cvt_pk_bf16_f32 v40,v192,v196
v_cvt_pk_bf16_f32 v44,v193,v197
v_cvt_pk_bf16_f32 v48,v194,v198
v_mfma_f32_16x16x32_bf16 v[208:211],v[80:83],a[208:211],v[208:211]
v_cvt_pk_bf16_f32 v52,v195,v199
v_mfma_f32_16x16x32_bf16 v[212:215],v[80:83],a[212:215],v[212:215]
v_cvt_pk_bf16_f32 v41,v200,v204
v_cvt_pk_bf16_f32 v45,v201,v205
v_cvt_pk_bf16_f32 v49,v202,v206
v_mfma_f32_16x16x32_bf16 v[208:211],v[84:87],a[240:243],v[208:211]
v_cvt_pk_bf16_f32 v53,v203,v207
v_mfma_f32_16x16x32_bf16 v[212:215],v[84:87],a[244:247],v[212:215]
v_mfma_f32_16x16x32_bf16 v[216:219],v[80:83],a[216:219],v[216:219]
v_mfma_f32_16x16x32_bf16 v[220:223],v[80:83],a[220:223],v[220:223]
v_mfma_f32_16x16x32_bf16 v[216:219],v[84:87],a[248:251],v[216:219]
v_mfma_f32_16x16x32_bf16 v[220:223],v[84:87],a[252:255],v[220:223]
v_cvt_pk_bf16_f32 v42,v208,v212
v_cvt_pk_bf16_f32 v46,v209,v213
v_cvt_pk_bf16_f32 v50,v210,v214
v_cvt_pk_bf16_f32 v54,v211,v215
s_nop 3
v_cvt_pk_bf16_f32 v43,v216,v220
s_add_u32 s62,s69,262144
buffer_store_dwordx4 v[40:43],v5,s[8:11],s62 offen
v_cvt_pk_bf16_f32 v47,v217,v221
s_add_u32 s62,s69,278528
buffer_store_dwordx4 v[44:47],v5,s[8:11],s62 offen
v_cvt_pk_bf16_f32 v51,v218,v222
s_add_u32 s62,s69,294912
buffer_store_dwordx4 v[48:51],v5,s[8:11],s62 offen
v_cvt_pk_bf16_f32 v55,v219,v223
s_add_u32 s62,s69,311296
buffer_store_dwordx4 v[52:55],v5,s[8:11],s62 offen
s_cmp_lg_u32 s72,0
s_cbranch_scc1 L_aa_81
s_waitcnt vmcnt(8)
s_branch L_aa_91
L_av_96:
s_bitcmp1_b32 s46,0
s_cbranch_scc1 L_av_97
ds_read_b128 v[24:27],v4 offset:0
ds_read_b128 v[28:31],v4 offset:1024
s_min_u32 s56,s32,s33
s_cmp_lt_u32 s77,64
s_cselect_b32 s56,s56,0
s_cmp_eq_u32 s56,0
s_cselect_b32 s72,0x80000000,0
v_mov_b32 v248,s72
s_or_b32 s64,s70,s72
s_or_b32 s65,s71,s72
s_cmp_lt_u32 s30,s31
s_cselect_b32 s65,0x80000000,s65
s_add_u32 s64,s64,s28
s_add_u32 s65,s65,s29
s_xor_b32 s58,s67,s40
s_xor_b32 s57,s67,s41
s_add_u32 m0,s58,0
s_waitcnt lgkmcnt(1)
v_mfma_f32_16x16x32_bf16 v[160:163],v[24:27],a[0:3],0
buffer_load_dwordx4 v0,s[8:11],s64 offen offset:0 sc1 lds
v_mfma_f32_16x16x32_bf16 v[164:167],v[24:27],a[4:7],0
ds_read_b128 v[32:35],v4 offset:2048
v_lshlrev_b32 v88,16,v224
v_mfma_f32_16x16x32_bf16 v[168:171],v[24:27],a[8:11],0
ds_read_b128 v[36:39],v4 offset:3072
v_and_b32 v89,0xffff0000,v224
v_mfma_f32_16x16x32_bf16 v[172:175],v[24:27],a[12:15],0
ds_read_b128 v[40:43],v4 offset:8192
v_lshlrev_b32 v90,16,v225
v_mfma_f32_16x16x32_bf16 v[176:179],v[24:27],a[16:19],0
buffer_load_dwordx4 v0,s[8:11],s64 offen offset:1024 sc1 lds
v_mfma_f32_16x16x32_bf16 v[180:183],v[24:27],a[20:23],0
ds_read_b128 v[44:47],v4 offset:9216
v_and_b32 v91,0xffff0000,v225
v_mfma_f32_16x16x32_bf16 v[184:187],v[24:27],a[24:27],0
ds_read_b128 v[48:51],v4 offset:10240
s_waitcnt vmcnt(9)
v_mfma_f32_16x16x32_bf16 v[188:191],v[24:27],a[28:31],0
ds_read_b128 v[52:55],v4 offset:11264
v_mfma_f32_16x16x32_bf16 v[128:131],v[156:159],v[192:195],0
ds_write_b32 v247,v248
v_lshlrev_b32 v92,16,v226
s_waitcnt lgkmcnt(7)
v_mfma_f32_16x16x32_bf16 v[160:163],v[28:31],a[32:35],v[160:163]
buffer_load_dwordx4 v0,s[8:11],s64 offen offset:2048 sc1 lds
v_mfma_f32_16x16x32_bf16 v[164:167],v[28:31],a[36:39],v[164:167]
ds_read_b128 v[56:59],v4 offset:4096
s_waitcnt vmcnt(9)
v_mfma_f32_16x16x32_bf16 v[168:171],v[28:31],a[40:43],v[168:171]
ds_read_b128 v[60:63],v4 offset:5120
v_mfma_f32_16x16x32_bf16 v[128:131],v[156:159],v[196:199],v[128:131]
ds_read_b128 v[64:67],v4 offset:6144
v_and_b32 v93,0xffff0000,v226
v_mfma_f32_16x16x32_bf16 v[172:175],v[28:31],a[44:47],v[172:175]
ds_read_b128 v[68:71],v4 offset:7168
s_waitcnt vmcnt(8)
v_mfma_f32_16x16x32_bf16 v[176:179],v[28:31],a[48:51],v[176:179]
buffer_load_dwordx4 v0,s[8:11],s64 offen offset:3072 sc1 lds
v_mfma_f32_16x16x32_bf16 v[180:183],v[28:31],a[52:55],v[180:183]
ds_read_b128 v[72:75],v4 offset:12288
v_mfma_f32_16x16x32_bf16 v[128:131],v[156:159],v[200:203],v[128:131]
ds_read_b128 v[76:79],v4 offset:13312
v_lshlrev_b32 v94,16,v227
v_mfma_f32_16x16x32_bf16 v[184:187],v[28:31],a[56:59],v[184:187]
ds_read_b128 v[80:83],v4 offset:14336
s_waitcnt vmcnt(8)
v_mfma_f32_16x16x32_bf16 v[188:191],v[28:31],a[60:63],v[188:191]
ds_read_b128 v[84:87],v4 offset:15360
v_mfma_f32_16x16x32_bf16 v[128:131],v[156:159],v[204:207],v[128:131]
v_and_b32 v95,0xffff0000,v227
s_lshl_b32 s18,s26,5
s_waitcnt lgkmcnt(14)
v_mfma_f32_16x16x32_bf16 v[160:163],v[32:35],a[64:67],v[160:163]
s_waitcnt vmcnt(7)
v_mfma_f32_16x16x32_bf16 v[132:135],v[156:159],v[208:211],0
s_add_u32 m0,s58,4096
s_add_u32 s64,s64,4096
s_add_u32 s18,s18,s68
v_mfma_f32_16x16x32_bf16 v[164:167],v[32:35],a[68:71],v[164:167]
buffer_load_dwordx4 v0,s[8:11],s64 offen offset:0 sc1 lds
v_mfma_f32_16x16x32_bf16 v[168:171],v[32:35],a[72:75],v[168:171]
s_waitcnt vmcnt(7)
v_mfma_f32_16x16x32_bf16 v[132:135],v[156:159],v[212:215],v[132:135]
s_lshl_b32 s19,s18,10
s_add_u32 s20,s19,8388608
s_lshl_b32 s23,s51,5
v_mfma_f32_16x16x32_bf16 v[172:175],v[32:35],a[76:79],v[172:175]
s_waitcnt vmcnt(6)
v_mfma_f32_16x16x32_bf16 v[132:135],v[156:159],v[216:219],v[132:135]
s_add_u32 s23,s23,s68
s_lshl_b32 s24,s23,10
s_lshl_b32 s25,s51,10
v_mfma_f32_16x16x32_bf16 v[176:179],v[32:35],a[80:83],v[176:179]
ds_write_b128 v6,v[128:131]
v_mfma_f32_16x16x32_bf16 v[180:183],v[32:35],a[84:87],v[180:183]
buffer_load_dwordx4 v0,s[8:11],s64 offen offset:1024 sc1 lds
v_mfma_f32_16x16x32_bf16 v[184:187],v[32:35],a[88:91],v[184:187]
s_waitcnt vmcnt(6)
v_mfma_f32_16x16x32_bf16 v[132:135],v[156:159],v[220:223],v[132:135]
s_add_u32 s25,s25,2883584
s_cmp_eq_u32 s23,s55
s_cselect_b32 s25,s25,s24
v_mfma_f32_16x16x32_bf16 v[188:191],v[32:35],a[92:95],v[188:191]
s_add_u32 s25,s25,8388608
s_mov_b32 s6,268435456
s_cmp_eq_u32 s31,0
s_cselect_b32 s25,s24,s25
s_cselect_b64 s[4:5],s[16:17],s[44:45]
s_cmov_b32 s6,2097152
s_waitcnt lgkmcnt(14)
v_mfma_f32_16x16x32_bf16 v[160:163],v[36:39],a[96:99],v[160:163]
buffer_load_dwordx4 v[224:227],v0,s[4:7],s25 offen sc1
v_mfma_f32_16x16x32_bf16 v[164:167],v[36:39],a[100:103],v[164:167]
ds_write_b128 v6,v[132:135] offset:2048
v_mfma_f32_16x16x32_bf16 v[168:171],v[36:39],a[104:107],v[168:171]
buffer_load_dwordx4 v0,s[8:11],s64 offen offset:2048 sc1 lds
v_mfma_f32_16x16x32_bf16 v[172:175],v[36:39],a[108:111],v[172:175]
s_lshr_b32 s24,s55,5
s_cmp_lt_u32 s51,s24
s_cselect_b32 s24,1,2
v_mfma_f32_16x16x32_bf16 v[176:179],v[36:39],a[112:115],v[176:179]
v_mov_b32 v252,s24
s_lshl2_add_u32 s25,s51,11018240
v_mfma_f32_16x16x32_bf16 v[180:183],v[36:39],a[116:119],v[180:183]
s_lshl_b32 s24,s68,16
s_add_u32 s24,s24,s31
s_add_u32 s24,s24,s86
v_mfma_f32_16x16x32_bf16 v[184:187],v[36:39],a[120:123],v[184:187]
buffer_load_dwordx4 v0,s[8:11],s64 offen offset:3072 sc1 lds
v_mfma_f32_16x16x32_bf16 v[188:191],v[36:39],a[124:127],v[188:191]
s_waitcnt lgkmcnt(0)
s_barrier
s_cmp_eq_u32 s24,1537
s_cselect_b32 s25,s25,0x80000000
s_waitcnt lgkmcnt(14)
v_mfma_f32_16x16x32_bf16 v[160:163],v[40:43],a[128:131],v[160:163]
ds_read_b128 v[96:99],v23
v_mfma_f32_16x16x32_bf16 v[164:167],v[40:43],a[132:135],v[164:167]
ds_read_b128 v[100:103],v23 offset:16
v_mfma_f32_16x16x32_bf16 v[168:171],v[40:43],a[136:139],v[168:171]
buffer_store_dword v20,off,s[8:11],s73 sc1
s_add_u32 m0,s58,8192
s_add_u32 s64,s64,4096
s_mov_b32 s73,0x80000000
v_mfma_f32_16x16x32_bf16 v[172:175],v[40:43],a[140:143],v[172:175]
buffer_load_dwordx4 v0,s[8:11],s64 offen offset:0 sc1 lds
v_mfma_f32_16x16x32_bf16 v[176:179],v[40:43],a[144:147],v[176:179]
ds_read_b128 v[248:251],v245
v_mfma_f32_16x16x32_bf16 v[180:183],v[40:43],a[148:151],v[180:183]
buffer_store_dword v252,off,s[8:11],s25 sc1
s_bitcmp1_b64 s[38:39],s51
s_cselect_b32 s24,128,0
s_lshl_b32 s23,s51,13
v_mfma_f32_16x16x32_bf16 v[184:187],v[40:43],a[152:155],v[184:187]
s_lshl2_add_u32 s23,s68,s23
s_add_u32 s23,s23,10487168
s_add_u32 s23,s23,s24
v_mfma_f32_16x16x32_bf16 v[188:191],v[40:43],a[156:159],v[188:191]
buffer_load_dwordx4 v0,s[8:11],s64 offen offset:1024 sc1 lds
s_waitcnt lgkmcnt(1)
v_cvt_pk_bf16_f32 v104,v96,v97
v_cvt_pk_bf16_f32 v105,v98,v99
v_mfma_f32_16x16x32_bf16 v[160:163],v[44:47],a[160:163],v[160:163]
buffer_load_dword v246,off,s[8:11],s23 sc1
v_cvt_pk_bf16_f32 v106,v100,v101
v_cvt_pk_bf16_f32 v107,v102,v103
v_lshlrev_b32 v96,16,v104
v_mfma_f32_16x16x32_bf16 v[164:167],v[44:47],a[164:167],v[164:167]
v_and_b32 v97,0xffff0000,v104
v_lshlrev_b32 v98,16,v105
v_and_b32 v99,0xffff0000,v105
v_lshlrev_b32 v100,16,v106
v_and_b32 v101,0xffff0000,v106
v_mfma_f32_16x16x32_bf16 v[168:171],v[44:47],a[168:171],v[168:171]
s_waitcnt lgkmcnt(0)
v_lshlrev_b32 v102,16,v107
v_and_b32 v103,0xffff0000,v107
v_add_f32 v88,v88,v96
v_add_f32 v89,v89,v97
v_add_f32 v90,v90,v98
v_mfma_f32_16x16x32_bf16 v[172:175],v[44:47],a[172:175],v[172:175]
buffer_load_dwordx4 v0,s[8:11],s64 offen offset:2048 sc1 lds
v_add_f32 v91,v91,v99
v_add_f32 v92,v92,v100
v_add_f32 v93,v93,v101
v_mfma_f32_16x16x32_bf16 v[176:179],v[44:47],a[176:179],v[176:179]
v_add_f32 v94,v94,v102
v_add_f32 v95,v95,v103
v_cvt_pk_bf16_f32 v104,v88,v89
v_cvt_pk_bf16_f32 v105,v90,v91
v_cvt_pk_bf16_f32 v106,v92,v93
v_mfma_f32_16x16x32_bf16 v[180:183],v[44:47],a[180:183],v[180:183]
v_cvt_pk_bf16_f32 v107,v94,v95
v_lshlrev_b32 v88,16,v104
v_and_b32 v89,0xffff0000,v104
v_lshlrev_b32 v90,16,v105
v_and_b32 v91,0xffff0000,v105
v_mfma_f32_16x16x32_bf16 v[184:187],v[44:47],a[184:187],v[184:187]
v_lshlrev_b32 v92,16,v106
v_and_b32 v93,0xffff0000,v106
v_lshlrev_b32 v94,16,v107
v_and_b32 v95,0xffff0000,v107
v_readfirstlane_b32 s78,v88
v_mfma_f32_16x16x32_bf16 v[188:191],v[44:47],a[188:191],v[188:191]
buffer_load_dwordx4 v0,s[8:11],s64 offen offset:3072 sc1 lds
v_add_f32 v120,v88,-s78
v_add_f32 v121,v89,-s78
v_add_f32 v122,v90,-s78
v_mfma_f32_16x16x32_bf16 v[160:163],v[48:51],a[192:195],v[160:163]
v_add_f32 v123,v91,-s78
v_add_f32 v124,v92,-s78
v_add_f32 v125,v93,-s78
v_add_f32 v126,v94,-s78
v_add_f32 v127,v95,-s78
v_mfma_f32_16x16x32_bf16 v[164:167],v[48:51],a[196:199],v[164:167]
v_add_f32 v128,v120,v122
v_add_f32 v129,v121,v123
v_mul_f32 v130,v120,v120
v_mul_f32 v131,v121,v121
v_add_f32 v132,v124,v126
v_mfma_f32_16x16x32_bf16 v[168:171],v[48:51],a[200:203],v[168:171]
v_add_f32 v133,v125,v127
v_fma_f32 v130,v122,v122,v130
v_fma_f32 v131,v123,v123,v131
v_add_f32 v128,v128,v132
v_add_f32 v129,v129,v133
v_mfma_f32_16x16x32_bf16 v[172:175],v[48:51],a[204:207],v[172:175]
v_fma_f32 v130,v124,v124,v130
v_fma_f32 v131,v125,v125,v131
v_add_f32 v128,v128,v129
v_fma_f32 v130,v126,v126,v130
v_fma_f32 v131,v127,v127,v131
v_mfma_f32_16x16x32_bf16 v[176:179],v[48:51],a[208:211],v[176:179]
v_add_f32 v130,v130,v131
v_or3_b32 v248,v248,v249,v250
v_or_b32 v248,v248,v251
v_permlane32_swap_b32 v128,v130
v_add_f32 v128,v128,v130
v_mfma_f32_16x16x32_bf16 v[180:183],v[48:51],a[212:215],v[180:183]
s_nop 0
v_add_f32_dpp v128,v128,v128 row_ror:8 row_mask:0xf bank_mask:0xf
v_lshrrev_b32 v244,4,v1
s_sub_u32 s23,s77,8
v_add_f32_dpp v128,v128,v128 row_ror:4 row_mask:0xf bank_mask:0xf
v_add_u32 v244,s23,v244
v_mfma_f32_16x16x32_bf16 v[184:187],v[48:51],a[216:219],v[184:187]
v_add_f32_dpp v128,v128,v128 row_ror:2 row_mask:0xf bank_mask:0xf
v_readfirstlane_b32 s72,v248
v_max_i32 v244,0,v244
v_add_f32_dpp v128,v128,v128 row_ror:1 row_mask:0xf bank_mask:0xf
v_mov_b32 v130,v128
v_mfma_f32_16x16x32_bf16 v[188:191],v[48:51],a[220:223],v[188:191]
s_nop 0
v_permlane16_swap_b32 v128,v130
v_add_f32 v128,v128,v130
v_mul_f32 v128,0x3b000000,v128
v_mov_b32 v130,v128
v_lshl_add_u32 v244,v244,13,v21
v_mfma_f32_16x16x32_bf16 v[160:163],v[52:55],a[224:227],v[160:163]
buffer_load_dwordx2 v[242:243],v244,s[8:11],0 offen sc1
v_permlane32_swap_b32 v128,v130
v_fma_f32 v130,-v128,v128,v130
v_add_f32 v128,s78,v128
v_mfma_f32_16x16x32_bf16 v[164:167],v[52:55],a[228:231],v[164:167]
v_max_f32 v130,0,v130
v_cvt_pk_bf16_f32 v130,v128,v130
v_lshlrev_b32 v128,16,v130
v_and_b32 v130,0xffff0000,v130
v_add_f32 v130,0x3727c5ac,v130
v_mfma_f32_16x16x32_bf16 v[168:171],v[52:55],a[232:235],v[168:171]
v_cvt_pk_bf16_f32 v130,v130,v130
v_and_b32 v130,0xffff0000,v130
v_sqrt_f32 v130,v130
v_add_f32 v120,v88,-v128
v_add_f32 v121,v89,-v128
v_mfma_f32_16x16x32_bf16 v[172:175],v[52:55],a[236:239],v[172:175]
v_add_f32 v122,v90,-v128
v_add_f32 v123,v91,-v128
v_add_f32 v124,v92,-v128
v_add_f32 v125,v93,-v128
v_add_f32 v126,v94,-v128
v_mfma_f32_16x16x32_bf16 v[176:179],v[52:55],a[240:243],v[176:179]
v_add_f32 v127,v95,-v128
v_cvt_pk_bf16_f32 v130,v130,v130
v_and_b32 v130,0xffff0000,v130
v_rcp_f32 v130,v130
v_cvt_pk_bf16_f32 v108,v120,v121
v_mfma_f32_16x16x32_bf16 v[180:183],v[52:55],a[244:247],v[180:183]
v_cvt_pk_bf16_f32 v109,v122,v123
v_cvt_pk_bf16_f32 v110,v124,v125
v_cvt_pk_bf16_f32 v111,v126,v127
v_lshlrev_b32 v120,16,v108
v_and_b32 v121,0xffff0000,v108
v_mfma_f32_16x16x32_bf16 v[184:187],v[52:55],a[248:251],v[184:187]
v_lshlrev_b32 v122,16,v109
v_and_b32 v123,0xffff0000,v109
v_lshlrev_b32 v124,16,v110
v_and_b32 v125,0xffff0000,v110
v_lshlrev_b32 v126,16,v111
v_mfma_f32_16x16x32_bf16 v[188:191],v[52:55],a[252:255],v[188:191]
v_and_b32 v127,0xffff0000,v111
v_mul_f32 v120,v120,v130
v_mul_f32 v121,v121,v130
v_mul_f32 v122,v122,v130
v_mul_f32 v123,v123,v130
v_mfma_f32_16x16x32_bf16 v[192:195],v[56:59],a[0:3],0
v_mul_f32 v124,v124,v130
v_mul_f32 v125,v125,v130
v_mul_f32 v126,v126,v130
v_mul_f32 v127,v127,v130
v_cvt_pk_bf16_f32 v108,v120,v121
v_mfma_f32_16x16x32_bf16 v[196:199],v[56:59],a[4:7],0
v_cvt_pk_bf16_f32 v109,v122,v123
v_cvt_pk_bf16_f32 v110,v124,v125
v_cvt_pk_bf16_f32 v111,v126,v127
v_lshlrev_b32 v112,16,v108
v_and_b32 v113,0xffff0000,v108
v_mfma_f32_16x16x32_bf16 v[200:203],v[56:59],a[8:11],0
v_lshlrev_b32 v114,16,v109
v_and_b32 v115,0xffff0000,v109
v_lshlrev_b32 v116,16,v110
v_and_b32 v117,0xffff0000,v110
v_lshlrev_b32 v118,16,v111
v_mfma_f32_16x16x32_bf16 v[204:207],v[56:59],a[12:15],0
v_and_b32 v119,0xffff0000,v111
v_add_f32 v88,v88,v112
v_add_f32 v89,v89,v113
v_add_f32 v90,v90,v114
v_add_f32 v91,v91,v115
v_mfma_f32_16x16x32_bf16 v[208:211],v[56:59],a[16:19],0
v_add_f32 v92,v92,v116
v_add_f32 v93,v93,v117
v_add_f32 v94,v94,v118
v_add_f32 v95,v95,v119
v_cvt_pk_bf16_f32 v96,v88,v89
v_mfma_f32_16x16x32_bf16 v[212:215],v[56:59],a[20:23],0
v_cvt_pk_bf16_f32 v97,v90,v91
v_cvt_pk_bf16_f32 v98,v92,v93
v_cvt_pk_bf16_f32 v99,v94,v95
v_cvt_pk_bf16_f32 v24,v160,v164
v_cvt_pk_bf16_f32 v25,v168,v172
v_mfma_f32_16x16x32_bf16 v[216:219],v[56:59],a[24:27],0
buffer_store_dwordx4 v[96:99],v0,s[8:11],s20 offen sc1
v_lshlrev_b32 v88,16,v96
v_and_b32 v89,0xffff0000,v96
v_lshlrev_b32 v90,16,v97
v_mfma_f32_16x16x32_bf16 v[220:223],v[56:59],a[28:31],0
v_and_b32 v91,0xffff0000,v97
v_lshlrev_b32 v92,16,v98
v_and_b32 v93,0xffff0000,v98
v_lshlrev_b32 v94,16,v99
v_and_b32 v95,0xffff0000,v99
v_mfma_f32_16x16x32_bf16 v[192:195],v[60:63],a[32:35],v[192:195]
v_readfirstlane_b32 s78,v88
v_cvt_pk_bf16_f32 v26,v176,v180
v_cvt_pk_bf16_f32 v27,v184,v188
v_add_f32 v120,v88,-s78
v_add_f32 v121,v89,-s78
v_mfma_f32_16x16x32_bf16 v[196:199],v[60:63],a[36:39],v[196:199]
v_add_f32 v122,v90,-s78
v_add_f32 v123,v91,-s78
v_add_f32 v124,v92,-s78
v_add_f32 v125,v93,-s78
v_add_f32 v126,v94,-s78
v_mfma_f32_16x16x32_bf16 v[200:203],v[60:63],a[40:43],v[200:203]
v_add_f32 v127,v95,-s78
v_add_f32 v128,v120,v122
v_add_f32 v129,v121,v123
v_mul_f32 v130,v120,v120
v_mul_f32 v131,v121,v121
v_mfma_f32_16x16x32_bf16 v[204:207],v[60:63],a[44:47],v[204:207]
v_add_f32 v132,v124,v126
v_add_f32 v133,v125,v127
v_fma_f32 v130,v122,v122,v130
v_fma_f32 v131,v123,v123,v131
v_add_f32 v128,v128,v132
v_mfma_f32_16x16x32_bf16 v[208:211],v[60:63],a[48:51],v[208:211]
v_add_f32 v129,v129,v133
v_fma_f32 v130,v124,v124,v130
v_fma_f32 v131,v125,v125,v131
v_add_f32 v128,v128,v129
v_fma_f32 v130,v126,v126,v130
v_mfma_f32_16x16x32_bf16 v[212:215],v[60:63],a[52:55],v[212:215]
v_fma_f32 v131,v127,v127,v131
v_add_f32 v130,v130,v131
v_cvt_pk_bf16_f32 v28,v161,v165
v_cvt_pk_bf16_f32 v29,v169,v173
v_permlane32_swap_b32 v128,v130
v_mfma_f32_16x16x32_bf16 v[216:219],v[60:63],a[56:59],v[216:219]
v_add_f32 v128,v128,v130
v_cvt_pk_bf16_f32 v30,v177,v181
v_cvt_pk_bf16_f32 v31,v185,v189
v_add_f32_dpp v128,v128,v128 row_ror:8 row_mask:0xf bank_mask:0xf
v_cvt_pk_bf16_f32 v32,v162,v166
v_mfma_f32_16x16x32_bf16 v[220:223],v[60:63],a[60:63],v[220:223]
v_add_f32_dpp v128,v128,v128 row_ror:4 row_mask:0xf bank_mask:0xf
v_cvt_pk_bf16_f32 v33,v170,v174
v_cvt_pk_bf16_f32 v34,v178,v182
v_add_f32_dpp v128,v128,v128 row_ror:2 row_mask:0xf bank_mask:0xf
v_cvt_pk_bf16_f32 v35,v186,v190
v_mfma_f32_16x16x32_bf16 v[192:195],v[64:67],a[64:67],v[192:195]
v_add_f32_dpp v128,v128,v128 row_ror:1 row_mask:0xf bank_mask:0xf
v_mov_b32 v130,v128
v_cvt_pk_bf16_f32 v36,v163,v167
v_cvt_pk_bf16_f32 v37,v171,v175
v_permlane16_swap_b32 v128,v130
v_mfma_f32_16x16x32_bf16 v[196:199],v[64:67],a[68:71],v[196:199]
v_add_f32 v128,v128,v130
v_mul_f32 v128,0x3b000000,v128
v_mov_b32 v130,v128
v_cvt_pk_bf16_f32 v38,v179,v183
v_cvt_pk_bf16_f32 v39,v187,v191
v_mfma_f32_16x16x32_bf16 v[200:203],v[64:67],a[72:75],v[200:203]
v_permlane32_swap_b32 v128,v130
v_fma_f32 v130,-v128,v128,v130
v_add_f32 v128,s78,v128
v_max_f32 v130,0,v130
v_cvt_pk_bf16_f32 v130,v128,v130
v_mfma_f32_16x16x32_bf16 v[204:207],v[64:67],a[76:79],v[204:207]
v_lshlrev_b32 v128,16,v130
v_and_b32 v130,0xffff0000,v130
v_add_f32 v130,0x3727c5ac,v130
v_cvt_pk_bf16_f32 v130,v130,v130
v_and_b32 v130,0xffff0000,v130
v_mfma_f32_16x16x32_bf16 v[208:211],v[64:67],a[80:83],v[208:211]
v_sqrt_f32 v130,v130
v_add_f32 v120,v88,-v128
v_add_f32 v121,v89,-v128
v_add_f32 v122,v90,-v128
v_add_f32 v123,v91,-v128
v_mfma_f32_16x16x32_bf16 v[212:215],v[64:67],a[84:87],v[212:215]
v_add_f32 v124,v92,-v128
v_add_f32 v125,v93,-v128
v_add_f32 v126,v94,-v128
v_add_f32 v127,v95,-v128
v_cvt_pk_bf16_f32 v130,v130,v130
v_mfma_f32_16x16x32_bf16 v[216:219],v[64:67],a[88:91],v[216:219]
v_and_b32 v130,0xffff0000,v130
v_rcp_f32 v130,v130
v_cvt_pk_bf16_f32 v100,v120,v121
v_cvt_pk_bf16_f32 v101,v122,v123
v_cvt_pk_bf16_f32 v102,v124,v125
v_mfma_f32_16x16x32_bf16 v[220:223],v[64:67],a[92:95],v[220:223]
v_cvt_pk_bf16_f32 v103,v126,v127
v_lshlrev_b32 v120,16,v100
v_and_b32 v121,0xffff0000,v100
v_lshlrev_b32 v122,16,v101
v_and_b32 v123,0xffff0000,v101
v_mfma_f32_16x16x32_bf16 v[192:195],v[68:71],a[96:99],v[192:195]
v_lshlrev_b32 v124,16,v102
v_and_b32 v125,0xffff0000,v102
v_lshlrev_b32 v126,16,v103
v_and_b32 v127,0xffff0000,v103
v_mul_f32 v120,v120,v130
v_mfma_f32_16x16x32_bf16 v[196:199],v[68:71],a[100:103],v[196:199]
v_mul_f32 v121,v121,v130
v_mul_f32 v122,v122,v130
v_mul_f32 v123,v123,v130
v_mul_f32 v124,v124,v130
v_mul_f32 v125,v125,v130
v_mfma_f32_16x16x32_bf16 v[200:203],v[68:71],a[104:107],v[200:203]
v_mul_f32 v126,v126,v130
v_mul_f32 v127,v127,v130
v_cvt_pk_bf16_f32 v100,v120,v121
v_cvt_pk_bf16_f32 v101,v122,v123
v_cvt_pk_bf16_f32 v102,v124,v125
v_mfma_f32_16x16x32_bf16 v[204:207],v[68:71],a[108:111],v[204:207]
v_cvt_pk_bf16_f32 v103,v126,v127
s_add_u32 s20,s19,2097152
v_mfma_f32_16x16x32_bf16 v[208:211],v[68:71],a[112:115],v[208:211]
buffer_store_dwordx4 v[100:103],v0,s[8:11],s20 offen sc1
v_mov_b32 v20,1
s_lshl_b32 s73,s26,13
s_lshl2_add_u32 s73,s68,s73
v_mfma_f32_16x16x32_bf16 v[212:215],v[68:71],a[116:119],v[212:215]
s_add_u32 s73,s73,10487552
s_add_u32 s62,s69,0
v_mfma_f32_16x16x32_bf16 v[216:219],v[68:71],a[120:123],v[216:219]
buffer_store_dwordx4 v[24:27],v5,s[8:11],s62 offen
v_mfma_f32_16x16x32_bf16 v[220:223],v[68:71],a[124:127],v[220:223]
v_mfma_f32_16x16x32_bf16 v[192:195],v[72:75],a[128:131],v[192:195]
v_mfma_f32_16x16x32_bf16 v[196:199],v[72:75],a[132:135],v[196:199]
v_mfma_f32_16x16x32_bf16 v[200:203],v[72:75],a[136:139],v[200:203]
s_add_u32 s62,s69,16384
v_mfma_f32_16x16x32_bf16 v[204:207],v[72:75],a[140:143],v[204:207]
buffer_store_dwordx4 v[28:31],v5,s[8:11],s62 offen
v_mfma_f32_16x16x32_bf16 v[208:211],v[72:75],a[144:147],v[208:211]
v_mfma_f32_16x16x32_bf16 v[212:215],v[72:75],a[148:151],v[212:215]
v_mfma_f32_16x16x32_bf16 v[216:219],v[72:75],a[152:155],v[216:219]
v_mfma_f32_16x16x32_bf16 v[220:223],v[72:75],a[156:159],v[220:223]
s_add_u32 s62,s69,32768
v_mfma_f32_16x16x32_bf16 v[192:195],v[76:79],a[160:163],v[192:195]
buffer_store_dwordx4 v[32:35],v5,s[8:11],s62 offen
v_mfma_f32_16x16x32_bf16 v[196:199],v[76:79],a[164:167],v[196:199]
v_mfma_f32_16x16x32_bf16 v[200:203],v[76:79],a[168:171],v[200:203]
v_mfma_f32_16x16x32_bf16 v[204:207],v[76:79],a[172:175],v[204:207]
v_mfma_f32_16x16x32_bf16 v[208:211],v[76:79],a[176:179],v[208:211]
s_add_u32 s62,s69,49152
v_mfma_f32_16x16x32_bf16 v[212:215],v[76:79],a[180:183],v[212:215]
buffer_store_dwordx4 v[36:39],v5,s[8:11],s62 offen
v_mfma_f32_16x16x32_bf16 v[216:219],v[76:79],a[184:187],v[216:219]
v_mfma_f32_16x16x32_bf16 v[220:223],v[76:79],a[188:191],v[220:223]
v_mfma_f32_16x16x32_bf16 v[192:195],v[80:83],a[192:195],v[192:195]
v_mfma_f32_16x16x32_bf16 v[196:199],v[80:83],a[196:199],v[196:199]
v_mfma_f32_16x16x32_bf16 v[192:195],v[84:87],a[224:227],v[192:195]
v_mfma_f32_16x16x32_bf16 v[196:199],v[84:87],a[228:231],v[196:199]
v_mfma_f32_16x16x32_bf16 v[200:203],v[80:83],a[200:203],v[200:203]
v_mfma_f32_16x16x32_bf16 v[204:207],v[80:83],a[204:207],v[204:207]
v_mfma_f32_16x16x32_bf16 v[200:203],v[84:87],a[232:235],v[200:203]
v_mfma_f32_16x16x32_bf16 v[204:207],v[84:87],a[236:239],v[204:207]
v_cvt_pk_bf16_f32 v40,v192,v196
v_cvt_pk_bf16_f32 v44,v193,v197
v_mfma_f32_16x16x32_bf16 v[208:211],v[80:83],a[208:211],v[208:211]
v_cvt_pk_bf16_f32 v48,v194,v198
v_cvt_pk_bf16_f32 v52,v195,v199
v_mfma_f32_16x16x32_bf16 v[212:215],v[80:83],a[212:215],v[212:215]
v_cvt_pk_bf16_f32 v41,v200,v204
v_cvt_pk_bf16_f32 v45,v201,v205
v_mfma_f32_16x16x32_bf16 v[208:211],v[84:87],a[240:243],v[208:211]
v_cvt_pk_bf16_f32 v49,v202,v206
v_cvt_pk_bf16_f32 v53,v203,v207
v_mfma_f32_16x16x32_bf16 v[212:215],v[84:87],a[244:247],v[212:215]
v_mfma_f32_16x16x32_bf16 v[216:219],v[80:83],a[216:219],v[216:219]
v_mfma_f32_16x16x32_bf16 v[220:223],v[80:83],a[220:223],v[220:223]
v_mfma_f32_16x16x32_bf16 v[216:219],v[84:87],a[248:251],v[216:219]
v_mfma_f32_16x16x32_bf16 v[220:223],v[84:87],a[252:255],v[220:223]
v_cvt_pk_bf16_f32 v42,v208,v212
v_cvt_pk_bf16_f32 v46,v209,v213
v_cvt_pk_bf16_f32 v50,v210,v214
v_cvt_pk_bf16_f32 v54,v211,v215
s_nop 3
v_cvt_pk_bf16_f32 v43,v216,v220
s_add_u32 s62,s69,262144
buffer_store_dwordx4 v[40:43],v5,s[8:11],s62 offen
v_cvt_pk_bf16_f32 v47,v217,v221
s_add_u32 s62,s69,278528
buffer_store_dwordx4 v[44:47],v5,s[8:11],s62 offen
v_cvt_pk_bf16_f32 v51,v218,v222
s_add_u32 s62,s69,294912
buffer_store_dwordx4 v[48:51],v5,s[8:11],s62 offen
v_cvt_pk_bf16_f32 v55,v219,v223
s_add_u32 s62,s69,311296
buffer_store_dwordx4 v[52:55],v5,s[8:11],s62 offen
s_waitcnt vmcnt(8)
buffer_store_dword v20,off,s[8:11],s73 sc1
s_mov_b32 s73,0x80000000
s_cmp_lg_u32 s72,0
s_cbranch_scc1 L_aa_81
s_waitcnt vmcnt(12)
s_branch L_aa_91
L_av_97:
ds_read_b128 v[24:27],v4 offset:0
ds_read_b128 v[28:31],v4 offset:1024
s_min_u32 s56,s32,s33
s_cmp_lt_u32 s77,64
s_cselect_b32 s56,s56,0
s_cmp_eq_u32 s56,0
s_cselect_b32 s72,0x80000000,0
v_mov_b32 v248,s72
s_or_b32 s64,s70,s72
s_or_b32 s65,s71,s72
s_cmp_lt_u32 s30,s31
s_cselect_b32 s65,0x80000000,s65
s_add_u32 s64,s64,s28
s_add_u32 s65,s65,s29
s_xor_b32 s58,s67,s40
s_xor_b32 s57,s67,s41
s_add_u32 m0,s58,0
s_waitcnt lgkmcnt(1)
v_mfma_f32_16x16x32_bf16 v[160:163],v[24:27],a[0:3],0
buffer_load_dwordx4 v0,s[8:11],s64 offen offset:0 sc1 lds
v_mfma_f32_16x16x32_bf16 v[164:167],v[24:27],a[4:7],0
ds_read_b128 v[32:35],v4 offset:2048
v_lshlrev_b32 v88,16,v224
v_mfma_f32_16x16x32_bf16 v[168:171],v[24:27],a[8:11],0
ds_read_b128 v[36:39],v4 offset:3072
v_and_b32 v89,0xffff0000,v224
v_mfma_f32_16x16x32_bf16 v[172:175],v[24:27],a[12:15],0
ds_read_b128 v[40:43],v4 offset:8192
v_lshlrev_b32 v90,16,v225
v_mfma_f32_16x16x32_bf16 v[176:179],v[24:27],a[16:19],0
buffer_load_dwordx4 v0,s[8:11],s64 offen offset:1024 sc1 lds
v_mfma_f32_16x16x32_bf16 v[180:183],v[24:27],a[20:23],0
ds_read_b128 v[44:47],v4 offset:9216
v_and_b32 v91,0xffff0000,v225
v_mfma_f32_16x16x32_bf16 v[184:187],v[24:27],a[24:27],0
ds_read_b128 v[48:51],v4 offset:10240
s_waitcnt vmcnt(9)
v_mfma_f32_16x16x32_bf16 v[188:191],v[24:27],a[28:31],0
ds_read_b128 v[52:55],v4 offset:11264
v_mfma_f32_16x16x32_bf16 v[128:131],v[156:159],v[192:195],0
ds_write_b32 v247,v248
v_lshlrev_b32 v92,16,v226
s_waitcnt lgkmcnt(7)
v_mfma_f32_16x16x32_bf16 v[160:163],v[28:31],a[32:35],v[160:163]
buffer_load_dwordx4 v0,s[8:11],s64 offen offset:2048 sc1 lds
v_mfma_f32_16x16x32_bf16 v[164:167],v[28:31],a[36:39],v[164:167]
ds_read_b128 v[56:59],v4 offset:4096
s_waitcnt vmcnt(9)
v_mfma_f32_16x16x32_bf16 v[168:171],v[28:31],a[40:43],v[168:171]
ds_read_b128 v[60:63],v4 offset:5120
v_mfma_f32_16x16x32_bf16 v[128:131],v[156:159],v[196:199],v[128:131]
ds_read_b128 v[64:67],v4 offset:6144
v_and_b32 v93,0xffff0000,v226
v_mfma_f32_16x16x32_bf16 v[172:175],v[28:31],a[44:47],v[172:175]
ds_read_b128 v[68:71],v4 offset:7168
s_waitcnt vmcnt(8)
v_mfma_f32_16x16x32_bf16 v[176:179],v[28:31],a[48:51],v[176:179]
buffer_load_dwordx4 v0,s[8:11],s64 offen offset:3072 sc1 lds
v_mfma_f32_16x16x32_bf16 v[180:183],v[28:31],a[52:55],v[180:183]
ds_read_b128 v[72:75],v4 offset:12288
v_mfma_f32_16x16x32_bf16 v[128:131],v[156:159],v[200:203],v[128:131]
ds_read_b128 v[76:79],v4 offset:13312
v_lshlrev_b32 v94,16,v227
v_mfma_f32_16x16x32_bf16 v[184:187],v[28:31],a[56:59],v[184:187]
ds_read_b128 v[80:83],v4 offset:14336
s_waitcnt vmcnt(8)
v_mfma_f32_16x16x32_bf16 v[188:191],v[28:31],a[60:63],v[188:191]
ds_read_b128 v[84:87],v4 offset:15360
v_mfma_f32_16x16x32_bf16 v[128:131],v[156:159],v[204:207],v[128:131]
v_and_b32 v95,0xffff0000,v227
s_lshl_b32 s18,s26,5
s_waitcnt lgkmcnt(14)
v_mfma_f32_16x16x32_bf16 v[160:163],v[32:35],a[64:67],v[160:163]
s_waitcnt vmcnt(7)
v_mfma_f32_16x16x32_bf16 v[132:135],v[156:159],v[208:211],0
s_add_u32 m0,s58,4096
s_add_u32 s64,s64,4096
s_add_u32 s18,s18,s68
v_mfma_f32_16x16x32_bf16 v[164:167],v[32:35],a[68:71],v[164:167]
buffer_load_dwordx4 v0,s[8:11],s64 offen offset:0 sc1 lds
v_mfma_f32_16x16x32_bf16 v[168:171],v[32:35],a[72:75],v[168:171]
s_waitcnt vmcnt(7)
v_mfma_f32_16x16x32_bf16 v[132:135],v[156:159],v[212:215],v[132:135]
s_lshl_b32 s19,s18,10
s_add_u32 s20,s19,4194304
s_lshl_b32 s23,s51,5
v_mfma_f32_16x16x32_bf16 v[172:175],v[32:35],a[76:79],v[172:175]
s_waitcnt vmcnt(6)
v_mfma_f32_16x16x32_bf16 v[132:135],v[156:159],v[216:219],v[132:135]
s_add_u32 s23,s23,s68
s_lshl_b32 s24,s23,10
s_lshl_b32 s25,s51,10
v_mfma_f32_16x16x32_bf16 v[176:179],v[32:35],a[80:83],v[176:179]
ds_write_b128 v6,v[128:131]
v_mfma_f32_16x16x32_bf16 v[180:183],v[32:35],a[84:87],v[180:183]
buffer_load_dwordx4 v0,s[8:11],s64 offen offset:1024 sc1 lds
v_mfma_f32_16x16x32_bf16 v[184:187],v[32:35],a[88:91],v[184:187]
s_waitcnt vmcnt(6)
v_mfma_f32_16x16x32_bf16 v[132:135],v[156:159],v[220:223],v[132:135]
s_add_u32 s25,s25,2883584
s_cmp_eq_u32 s23,s55
s_cselect_b32 s25,s25,s24
v_mfma_f32_16x16x32_bf16 v[188:191],v[32:35],a[92:95],v[188:191]
s_add_u32 s25,s25,8388608
s_mov_b32 s6,268435456
s_cmp_eq_u32 s31,0
s_cselect_b32 s25,s24,s25
s_cselect_b64 s[4:5],s[16:17],s[44:45]
s_cmov_b32 s6,2097152
s_waitcnt lgkmcnt(14)
v_mfma_f32_16x16x32_bf16 v[160:163],v[36:39],a[96:99],v[160:163]
buffer_load_dwordx4 v[224:227],v0,s[4:7],s25 offen sc1
v_mfma_f32_16x16x32_bf16 v[164:167],v[36:39],a[100:103],v[164:167]
ds_write_b128 v6,v[132:135] offset:2048
v_mfma_f32_16x16x32_bf16 v[168:171],v[36:39],a[104:107],v[168:171]
buffer_load_dwordx4 v0,s[8:11],s64 offen offset:2048 sc1 lds
v_mfma_f32_16x16x32_bf16 v[172:175],v[36:39],a[108:111],v[172:175]
s_lshr_b32 s24,s55,5
s_cmp_lt_u32 s51,s24
s_cselect_b32 s24,1,2
v_mfma_f32_16x16x32_bf16 v[176:179],v[36:39],a[112:115],v[176:179]
v_mov_b32 v252,s24
s_lshl2_add_u32 s25,s51,11018240
v_mfma_f32_16x16x32_bf16 v[180:183],v[36:39],a[116:119],v[180:183]
s_lshl_b32 s24,s68,16
s_add_u32 s24,s24,s31
s_add_u32 s24,s24,s86
v_mfma_f32_16x16x32_bf16 v[184:187],v[36:39],a[120:123],v[184:187]
buffer_load_dwordx4 v0,s[8:11],s64 offen offset:3072 sc1 lds
v_mfma_f32_16x16x32_bf16 v[188:191],v[36:39],a[124:127],v[188:191]
s_waitcnt lgkmcnt(0)
s_barrier
s_cmp_eq_u32 s24,1537
s_cselect_b32 s25,s25,0x80000000
s_waitcnt lgkmcnt(14)
v_mfma_f32_16x16x32_bf16 v[160:163],v[40:43],a[128:131],v[160:163]
ds_read_b128 v[96:99],v23
v_mfma_f32_16x16x32_bf16 v[164:167],v[40:43],a[132:135],v[164:167]
ds_read_b128 v[100:103],v23 offset:16
v_mfma_f32_16x16x32_bf16 v[168:171],v[40:43],a[136:139],v[168:171]
buffer_store_dword v20,off,s[8:11],s73 sc1
s_add_u32 m0,s58,8192
s_add_u32 s64,s64,4096
s_mov_b32 s73,0x80000000
v_mfma_f32_16x16x32_bf16 v[172:175],v[40:43],a[140:143],v[172:175]
buffer_load_dwordx4 v0,s[8:11],s64 offen offset:0 sc1 lds
v_mfma_f32_16x16x32_bf16 v[176:179],v[40:43],a[144:147],v[176:179]
ds_read_b128 v[248:251],v245
v_mfma_f32_16x16x32_bf16 v[180:183],v[40:43],a[148:151],v[180:183]
buffer_store_dword v252,off,s[8:11],s25 sc1
s_bitcmp1_b64 s[38:39],s51
s_cselect_b32 s24,128,0
s_lshl_b32 s23,s51,13
v_mfma_f32_16x16x32_bf16 v[184:187],v[40:43],a[152:155],v[184:187]
s_lshl2_add_u32 s23,s68,s23
s_add_u32 s23,s23,10487168
s_add_u32 s23,s23,s24
v_mfma_f32_16x16x32_bf16 v[188:191],v[40:43],a[156:159],v[188:191]
buffer_load_dwordx4 v0,s[8:11],s64 offen offset:1024 sc1 lds
s_waitcnt lgkmcnt(1)
v_cvt_pk_bf16_f32 v104,v96,v97
v_cvt_pk_bf16_f32 v105,v98,v99
v_mfma_f32_16x16x32_bf16 v[160:163],v[44:47],a[160:163],v[160:163]
buffer_load_dword v246,off,s[8:11],s23 sc1
v_cvt_pk_bf16_f32 v106,v100,v101
v_cvt_pk_bf16_f32 v107,v102,v103
v_lshlrev_b32 v96,16,v104
v_mfma_f32_16x16x32_bf16 v[164:167],v[44:47],a[164:167],v[164:167]
v_and_b32 v97,0xffff0000,v104
v_lshlrev_b32 v98,16,v105
v_and_b32 v99,0xffff0000,v105
v_lshlrev_b32 v100,16,v106
v_and_b32 v101,0xffff0000,v106
v_mfma_f32_16x16x32_bf16 v[168:171],v[44:47],a[168:171],v[168:171]
s_waitcnt lgkmcnt(0)
v_lshlrev_b32 v102,16,v107
v_and_b32 v103,0xffff0000,v107
v_add_f32 v88,v88,v96
v_add_f32 v89,v89,v97
v_add_f32 v90,v90,v98
v_mfma_f32_16x16x32_bf16 v[172:175],v[44:47],a[172:175],v[172:175]
buffer_load_dwordx4 v0,s[8:11],s64 offen offset:2048 sc1 lds
v_add_f32 v91,v91,v99
v_add_f32 v92,v92,v100
v_add_f32 v93,v93,v101
v_mfma_f32_16x16x32_bf16 v[176:179],v[44:47],a[176:179],v[176:179]
v_add_f32 v94,v94,v102
v_add_f32 v95,v95,v103
v_cvt_pk_bf16_f32 v104,v88,v89
v_cvt_pk_bf16_f32 v105,v90,v91
v_cvt_pk_bf16_f32 v106,v92,v93
v_mfma_f32_16x16x32_bf16 v[180:183],v[44:47],a[180:183],v[180:183]
v_cvt_pk_bf16_f32 v107,v94,v95
v_or3_b32 v248,v248,v249,v250
v_or_b32 v248,v248,v251
v_lshrrev_b32 v244,4,v1
s_sub_u32 s23,s77,8
v_mfma_f32_16x16x32_bf16 v[184:187],v[44:47],a[184:187],v[184:187]
buffer_store_dwordx4 v[104:107],v0,s[8:11],s20 offen sc1
v_lshlrev_b32 v88,16,v104
v_and_b32 v89,0xffff0000,v104
v_lshlrev_b32 v90,16,v105
v_mfma_f32_16x16x32_bf16 v[188:191],v[44:47],a[188:191],v[188:191]
buffer_load_dwordx4 v0,s[8:11],s64 offen offset:3072 sc1 lds
v_and_b32 v91,0xffff0000,v105
v_lshlrev_b32 v92,16,v106
v_and_b32 v93,0xffff0000,v106
v_mfma_f32_16x16x32_bf16 v[160:163],v[48:51],a[192:195],v[160:163]
v_lshlrev_b32 v94,16,v107
v_and_b32 v95,0xffff0000,v107
v_readfirstlane_b32 s78,v88
v_readfirstlane_b32 s72,v248
v_add_u32 v244,s23,v244
v_mfma_f32_16x16x32_bf16 v[164:167],v[48:51],a[196:199],v[164:167]
v_add_f32 v120,v88,-s78
v_add_f32 v121,v89,-s78
v_add_f32 v122,v90,-s78
v_add_f32 v123,v91,-s78
v_add_f32 v124,v92,-s78
v_mfma_f32_16x16x32_bf16 v[168:171],v[48:51],a[200:203],v[168:171]
v_add_f32 v125,v93,-s78
v_add_f32 v126,v94,-s78
v_add_f32 v127,v95,-s78
v_add_f32 v128,v120,v122
v_add_f32 v129,v121,v123
v_mfma_f32_16x16x32_bf16 v[172:175],v[48:51],a[204:207],v[172:175]
v_mul_f32 v130,v120,v120
v_mul_f32 v131,v121,v121
v_add_f32 v132,v124,v126
v_add_f32 v133,v125,v127
v_fma_f32 v130,v122,v122,v130
v_mfma_f32_16x16x32_bf16 v[176:179],v[48:51],a[208:211],v[176:179]
v_fma_f32 v131,v123,v123,v131
v_add_f32 v128,v128,v132
v_add_f32 v129,v129,v133
v_fma_f32 v130,v124,v124,v130
v_fma_f32 v131,v125,v125,v131
v_mfma_f32_16x16x32_bf16 v[180:183],v[48:51],a[212:215],v[180:183]
v_add_f32 v128,v128,v129
v_fma_f32 v130,v126,v126,v130
v_fma_f32 v131,v127,v127,v131
v_add_f32 v130,v130,v131
v_max_i32 v244,0,v244
v_mfma_f32_16x16x32_bf16 v[184:187],v[48:51],a[216:219],v[184:187]
v_permlane32_swap_b32 v128,v130
v_add_f32 v128,v128,v130
v_lshl_add_u32 v244,v244,13,v21
v_mfma_f32_16x16x32_bf16 v[188:191],v[48:51],a[220:223],v[188:191]
buffer_load_dwordx2 v[242:243],v244,s[8:11],0 offen sc1
v_add_f32_dpp v128,v128,v128 row_ror:8 row_mask:0xf bank_mask:0xf
v_mfma_f32_16x16x32_bf16 v[160:163],v[52:55],a[224:227],v[160:163]
s_nop 0
v_add_f32_dpp v128,v128,v128 row_ror:4 row_mask:0xf bank_mask:0xf
v_mfma_f32_16x16x32_bf16 v[164:167],v[52:55],a[228:231],v[164:167]
s_nop 0
v_add_f32_dpp v128,v128,v128 row_ror:2 row_mask:0xf bank_mask:0xf
v_mfma_f32_16x16x32_bf16 v[168:171],v[52:55],a[232:235],v[168:171]
s_nop 0
v_add_f32_dpp v128,v128,v128 row_ror:1 row_mask:0xf bank_mask:0xf
v_mov_b32 v130,v128
v_mfma_f32_16x16x32_bf16 v[172:175],v[52:55],a[236:239],v[172:175]
s_nop 0
v_permlane16_swap_b32 v128,v130
v_add_f32 v128,v128,v130
v_mul_f32 v128,0x3b000000,v128
v_mov_b32 v130,v128
v_mfma_f32_16x16x32_bf16 v[176:179],v[52:55],a[240:243],v[176:179]
s_nop 0
v_permlane32_swap_b32 v128,v130
v_fma_f32 v130,-v128,v128,v130
v_add_f32 v128,s78,v128
v_max_f32 v130,0,v130
v_cvt_pk_bf16_f32 v130,v128,v130
v_mfma_f32_16x16x32_bf16 v[180:183],v[52:55],a[244:247],v[180:183]
v_lshlrev_b32 v128,16,v130
v_and_b32 v130,0xffff0000,v130
v_add_f32 v130,0x3727c5ac,v130
v_cvt_pk_bf16_f32 v130,v130,v130
v_and_b32 v130,0xffff0000,v130
v_mfma_f32_16x16x32_bf16 v[184:187],v[52:55],a[248:251],v[184:187]
v_sqrt_f32 v130,v130
v_add_f32 v120,v88,-v128
v_add_f32 v121,v89,-v128
v_add_f32 v122,v90,-v128
v_add_f32 v123,v91,-v128
v_mfma_f32_16x16x32_bf16 v[188:191],v[52:55],a[252:255],v[188:191]
v_add_f32 v124,v92,-v128
v_add_f32 v125,v93,-v128
v_add_f32 v126,v94,-v128
v_add_f32 v127,v95,-v128
v_cvt_pk_bf16_f32 v130,v130,v130
v_mfma_f32_16x16x32_bf16 v[192:195],v[56:59],a[0:3],0
v_and_b32 v130,0xffff0000,v130
v_rcp_f32 v130,v130
v_cvt_pk_bf16_f32 v108,v120,v121
v_cvt_pk_bf16_f32 v109,v122,v123
v_cvt_pk_bf16_f32 v110,v124,v125
v_mfma_f32_16x16x32_bf16 v[196:199],v[56:59],a[4:7],0
v_cvt_pk_bf16_f32 v111,v126,v127
v_lshlrev_b32 v120,16,v108
v_and_b32 v121,0xffff0000,v108
v_lshlrev_b32 v122,16,v109
v_and_b32 v123,0xffff0000,v109
v_mfma_f32_16x16x32_bf16 v[200:203],v[56:59],a[8:11],0
v_lshlrev_b32 v124,16,v110
v_and_b32 v125,0xffff0000,v110
v_lshlrev_b32 v126,16,v111
v_and_b32 v127,0xffff0000,v111
v_mul_f32 v120,v120,v130
v_mfma_f32_16x16x32_bf16 v[204:207],v[56:59],a[12:15],0
v_mul_f32 v121,v121,v130
v_mul_f32 v122,v122,v130
v_mul_f32 v123,v123,v130
v_mul_f32 v124,v124,v130
v_mul_f32 v125,v125,v130
v_mfma_f32_16x16x32_bf16 v[208:211],v[56:59],a[16:19],0
v_mul_f32 v126,v126,v130
v_mul_f32 v127,v127,v130
v_cvt_pk_bf16_f32 v108,v120,v121
v_cvt_pk_bf16_f32 v109,v122,v123
v_cvt_pk_bf16_f32 v110,v124,v125
v_mfma_f32_16x16x32_bf16 v[212:215],v[56:59],a[20:23],0
v_cvt_pk_bf16_f32 v111,v126,v127
v_lshlrev_b32 v112,16,v108
v_and_b32 v113,0xffff0000,v108
v_lshlrev_b32 v114,16,v109
v_and_b32 v115,0xffff0000,v109
v_mfma_f32_16x16x32_bf16 v[216:219],v[56:59],a[24:27],0
v_lshlrev_b32 v116,16,v110
v_and_b32 v117,0xffff0000,v110
v_lshlrev_b32 v118,16,v111
v_and_b32 v119,0xffff0000,v111
v_mul_f32 v236,v112,v228
v_mfma_f32_16x16x32_bf16 v[220:223],v[56:59],a[28:31],0
v_mul_f32 v237,v113,v229
v_fma_f32 v236,v114,v230,v236
v_fma_f32 v237,v115,v231,v237
v_fma_f32 v236,v116,v232,v236
v_fma_f32 v237,v117,v233,v237
v_mfma_f32_16x16x32_bf16 v[192:195],v[60:63],a[32:35],v[192:195]
v_fma_f32 v236,v118,v234,v236
v_fma_f32 v237,v119,v235,v237
v_add_f32 v236,v236,v237
v_cvt_pk_bf16_f32 v24,v160,v164
v_cvt_pk_bf16_f32 v25,v168,v172
v_mfma_f32_16x16x32_bf16 v[196:199],v[60:63],a[36:39],v[196:199]
v_add_f32_dpp v236,v236,v236 row_ror:8 row_mask:0xf bank_mask:0xf
v_cvt_pk_bf16_f32 v26,v176,v180
v_cvt_pk_bf16_f32 v27,v184,v188
v_add_f32_dpp v236,v236,v236 row_ror:4 row_mask:0xf bank_mask:0xf
v_cvt_pk_bf16_f32 v28,v161,v165
v_mfma_f32_16x16x32_bf16 v[200:203],v[60:63],a[40:43],v[200:203]
v_add_f32_dpp v236,v236,v236 row_ror:2 row_mask:0xf bank_mask:0xf
v_cvt_pk_bf16_f32 v29,v169,v173
v_cvt_pk_bf16_f32 v30,v177,v181
v_add_f32_dpp v236,v236,v236 row_ror:1 row_mask:0xf bank_mask:0xf
v_mov_b32 v237,v236
v_mfma_f32_16x16x32_bf16 v[204:207],v[60:63],a[44:47],v[204:207]
s_nop 0
v_permlane16_swap_b32 v236,v237
v_add_f32 v236,v236,v237
v_mov_b32 v237,v236
v_cvt_pk_bf16_f32 v31,v185,v189
v_cvt_pk_bf16_f32 v32,v162,v166
v_mfma_f32_16x16x32_bf16 v[208:211],v[60:63],a[48:51],v[208:211]
v_permlane32_swap_b32 v236,v237
v_add_f32 v236,v236,v237
v_cvt_pk_bf16_f32 v236,v236,v236
v_and_b32 v236,0xffff0000,v236
v_ashrrev_i32 v237,31,v236
v_mfma_f32_16x16x32_bf16 v[212:215],v[60:63],a[52:55],v[212:215]
v_or_b32 v237,0x80000000,v237
v_xor_b32 v236,v236,v237
v_and_b32 v236,0xffff0000,v236
s_sub_u32 s20,4095,s18
v_or_b32 v20,s20,v236
v_mfma_f32_16x16x32_bf16 v[216:219],v[60:63],a[56:59],v[216:219]
s_lshl_b32 s20,s26,13
s_lshl2_add_u32 s20,s68,s20
s_add_u32 s20,s20,10485760
v_mfma_f32_16x16x32_bf16 v[220:223],v[60:63],a[60:63],v[220:223]
buffer_store_dword v20,v254,s[8:11],s20 offen sc1
v_mfma_f32_16x16x32_bf16 v[192:195],v[64:67],a[64:67],v[192:195]
v_cvt_pk_bf16_f32 v33,v170,v174
v_cvt_pk_bf16_f32 v34,v178,v182
v_mfma_f32_16x16x32_bf16 v[196:199],v[64:67],a[68:71],v[196:199]
v_cvt_pk_bf16_f32 v35,v186,v190
v_cvt_pk_bf16_f32 v36,v163,v167
v_mfma_f32_16x16x32_bf16 v[200:203],v[64:67],a[72:75],v[200:203]
v_cvt_pk_bf16_f32 v37,v171,v175
v_cvt_pk_bf16_f32 v38,v179,v183
v_mfma_f32_16x16x32_bf16 v[204:207],v[64:67],a[76:79],v[204:207]
v_cvt_pk_bf16_f32 v39,v187,v191
v_mfma_f32_16x16x32_bf16 v[208:211],v[64:67],a[80:83],v[208:211]
v_mfma_f32_16x16x32_bf16 v[212:215],v[64:67],a[84:87],v[212:215]
v_mfma_f32_16x16x32_bf16 v[216:219],v[64:67],a[88:91],v[216:219]
v_mfma_f32_16x16x32_bf16 v[220:223],v[64:67],a[92:95],v[220:223]
v_mfma_f32_16x16x32_bf16 v[192:195],v[68:71],a[96:99],v[192:195]
v_mfma_f32_16x16x32_bf16 v[196:199],v[68:71],a[100:103],v[196:199]
v_mfma_f32_16x16x32_bf16 v[200:203],v[68:71],a[104:107],v[200:203]
v_mfma_f32_16x16x32_bf16 v[204:207],v[68:71],a[108:111],v[204:207]
v_mfma_f32_16x16x32_bf16 v[208:211],v[68:71],a[112:115],v[208:211]
s_add_u32 s62,s69,0
v_mfma_f32_16x16x32_bf16 v[212:215],v[68:71],a[116:119],v[212:215]
buffer_store_dwordx4 v[24:27],v5,s[8:11],s62 offen
v_mfma_f32_16x16x32_bf16 v[216:219],v[68:71],a[120:123],v[216:219]
v_mfma_f32_16x16x32_bf16 v[220:223],v[68:71],a[124:127],v[220:223]
v_mfma_f32_16x16x32_bf16 v[192:195],v[72:75],a[128:131],v[192:195]
v_mfma_f32_16x16x32_bf16 v[196:199],v[72:75],a[132:135],v[196:199]
s_add_u32 s62,s69,16384
v_mfma_f32_16x16x32_bf16 v[200:203],v[72:75],a[136:139],v[200:203]
buffer_store_dwordx4 v[28:31],v5,s[8:11],s62 offen
v_mfma_f32_16x16x32_bf16 v[204:207],v[72:75],a[140:143],v[204:207]
v_mfma_f32_16x16x32_bf16 v[208:211],v[72:75],a[144:147],v[208:211]
v_mfma_f32_16x16x32_bf16 v[212:215],v[72:75],a[148:151],v[212:215]
v_mfma_f32_16x16x32_bf16 v[216:219],v[72:75],a[152:155],v[216:219]
s_add_u32 s62,s69,32768
v_mfma_f32_16x16x32_bf16 v[220:223],v[72:75],a[156:159],v[220:223]
buffer_store_dwordx4 v[32:35],v5,s[8:11],s62 offen
v_mfma_f32_16x16x32_bf16 v[192:195],v[76:79],a[160:163],v[192:195]
v_mfma_f32_16x16x32_bf16 v[196:199],v[76:79],a[164:167],v[196:199]
v_mfma_f32_16x16x32_bf16 v[200:203],v[76:79],a[168:171],v[200:203]
v_mfma_f32_16x16x32_bf16 v[204:207],v[76:79],a[172:175],v[204:207]
s_add_u32 s62,s69,49152
v_mfma_f32_16x16x32_bf16 v[208:211],v[76:79],a[176:179],v[208:211]
buffer_store_dwordx4 v[36:39],v5,s[8:11],s62 offen
v_mfma_f32_16x16x32_bf16 v[212:215],v[76:79],a[180:183],v[212:215]
v_mfma_f32_16x16x32_bf16 v[216:219],v[76:79],a[184:187],v[216:219]
v_mfma_f32_16x16x32_bf16 v[220:223],v[76:79],a[188:191],v[220:223]
v_mfma_f32_16x16x32_bf16 v[192:195],v[80:83],a[192:195],v[192:195]
v_mfma_f32_16x16x32_bf16 v[196:199],v[80:83],a[196:199],v[196:199]
v_mfma_f32_16x16x32_bf16 v[192:195],v[84:87],a[224:227],v[192:195]
v_mfma_f32_16x16x32_bf16 v[196:199],v[84:87],a[228:231],v[196:199]
v_mfma_f32_16x16x32_bf16 v[200:203],v[80:83],a[200:203],v[200:203]
v_mfma_f32_16x16x32_bf16 v[204:207],v[80:83],a[204:207],v[204:207]
v_mfma_f32_16x16x32_bf16 v[200:203],v[84:87],a[232:235],v[200:203]
v_mfma_f32_16x16x32_bf16 v[204:207],v[84:87],a[236:239],v[204:207]
v_cvt_pk_bf16_f32 v40,v192,v196
v_cvt_pk_bf16_f32 v44,v193,v197
v_mfma_f32_16x16x32_bf16 v[208:211],v[80:83],a[208:211],v[208:211]
v_cvt_pk_bf16_f32 v48,v194,v198
v_cvt_pk_bf16_f32 v52,v195,v199
v_mfma_f32_16x16x32_bf16 v[212:215],v[80:83],a[212:215],v[212:215]
v_cvt_pk_bf16_f32 v41,v200,v204
v_cvt_pk_bf16_f32 v45,v201,v205
v_mfma_f32_16x16x32_bf16 v[208:211],v[84:87],a[240:243],v[208:211]
v_cvt_pk_bf16_f32 v49,v202,v206
v_cvt_pk_bf16_f32 v53,v203,v207
v_mfma_f32_16x16x32_bf16 v[212:215],v[84:87],a[244:247],v[212:215]
v_mfma_f32_16x16x32_bf16 v[216:219],v[80:83],a[216:219],v[216:219]
v_mfma_f32_16x16x32_bf16 v[220:223],v[80:83],a[220:223],v[220:223]
v_mfma_f32_16x16x32_bf16 v[216:219],v[84:87],a[248:251],v[216:219]
v_mfma_f32_16x16x32_bf16 v[220:223],v[84:87],a[252:255],v[220:223]
v_cvt_pk_bf16_f32 v42,v208,v212
v_cvt_pk_bf16_f32 v46,v209,v213
v_cvt_pk_bf16_f32 v50,v210,v214
v_cvt_pk_bf16_f32 v54,v211,v215
s_nop 3
v_cvt_pk_bf16_f32 v43,v216,v220
s_add_u32 s62,s69,262144
buffer_store_dwordx4 v[40:43],v5,s[8:11],s62 offen
v_cvt_pk_bf16_f32 v47,v217,v221
s_add_u32 s62,s69,278528
buffer_store_dwordx4 v[44:47],v5,s[8:11],s62 offen
v_cvt_pk_bf16_f32 v51,v218,v222
s_add_u32 s62,s69,294912
buffer_store_dwordx4 v[48:51],v5,s[8:11],s62 offen
v_cvt_pk_bf16_f32 v55,v219,v223
s_add_u32 s62,s69,311296
buffer_store_dwordx4 v[52:55],v5,s[8:11],s62 offen
s_cmp_lg_u32 s72,0
s_cbranch_scc1 L_aa_81
s_waitcnt vmcnt(10)
s_branch L_aa_91
L_aa_79:
ds_read_b128 v[24:27],v4 offset:0
ds_read_b128 v[28:31],v4 offset:1024
s_min_u32 s56,s32,s33
s_cmp_lt_u32 s77,64
s_cselect_b32 s56,s56,0
s_cmp_eq_u32 s56,0
s_cselect_b32 s72,0x80000000,0
v_mov_b32 v248,s72
s_or_b32 s64,s70,s72
s_or_b32 s65,s71,s72
s_cmp_lt_u32 s30,s31
s_cselect_b32 s65,0x80000000,s65
s_add_u32 s64,s64,s28
s_add_u32 s65,s65,s29
s_xor_b32 s58,s67,s40
s_xor_b32 s57,s67,s41
s_add_u32 m0,s58,0
s_waitcnt lgkmcnt(1)
v_mfma_f32_16x16x32_bf16 v[160:163],v[24:27],a[0:3],0
buffer_load_dwordx4 v0,s[8:11],s64 offen offset:0 sc1 lds
v_mfma_f32_16x16x32_bf16 v[164:167],v[24:27],a[4:7],0
ds_read_b128 v[32:35],v4 offset:2048
s_lshl_b32 s23,s51,5
v_mfma_f32_16x16x32_bf16 v[168:171],v[24:27],a[8:11],0
ds_read_b128 v[36:39],v4 offset:3072
s_add_u32 s23,s23,s68
v_mfma_f32_16x16x32_bf16 v[172:175],v[24:27],a[12:15],0
ds_read_b128 v[40:43],v4 offset:8192
s_lshl_b32 s24,s23,10
v_mfma_f32_16x16x32_bf16 v[176:179],v[24:27],a[16:19],0
buffer_load_dwordx4 v0,s[8:11],s64 offen offset:1024 sc1 lds
v_mfma_f32_16x16x32_bf16 v[180:183],v[24:27],a[20:23],0
ds_read_b128 v[44:47],v4 offset:9216
s_lshl_b32 s25,s51,10
v_mfma_f32_16x16x32_bf16 v[184:187],v[24:27],a[24:27],0
ds_read_b128 v[48:51],v4 offset:10240
s_add_u32 s25,s25,2883584
v_mfma_f32_16x16x32_bf16 v[188:191],v[24:27],a[28:31],0
ds_read_b128 v[52:55],v4 offset:11264
s_cmp_eq_u32 s23,s55
s_cselect_b32 s25,s25,s24
s_waitcnt lgkmcnt(6)
v_mfma_f32_16x16x32_bf16 v[160:163],v[28:31],a[32:35],v[160:163]
buffer_load_dwordx4 v0,s[8:11],s64 offen offset:2048 sc1 lds
v_mfma_f32_16x16x32_bf16 v[164:167],v[28:31],a[36:39],v[164:167]
ds_write_b32 v247,v248
s_add_u32 s25,s25,8388608
v_mfma_f32_16x16x32_bf16 v[168:171],v[28:31],a[40:43],v[168:171]
ds_read_b128 v[56:59],v4 offset:4096
s_mov_b32 s6,268435456
v_mfma_f32_16x16x32_bf16 v[172:175],v[28:31],a[44:47],v[172:175]
ds_read_b128 v[60:63],v4 offset:5120
s_cmp_eq_u32 s31,0
s_cselect_b32 s25,s24,s25
s_cselect_b64 s[4:5],s[16:17],s[44:45]
s_cmov_b32 s6,2097152
v_mfma_f32_16x16x32_bf16 v[176:179],v[28:31],a[48:51],v[176:179]
buffer_load_dwordx4 v0,s[8:11],s64 offen offset:3072 sc1 lds
v_mfma_f32_16x16x32_bf16 v[180:183],v[28:31],a[52:55],v[180:183]
ds_read_b128 v[64:67],v4 offset:6144
v_mfma_f32_16x16x32_bf16 v[184:187],v[28:31],a[56:59],v[184:187]
ds_read_b128 v[68:71],v4 offset:7168
v_mfma_f32_16x16x32_bf16 v[188:191],v[28:31],a[60:63],v[188:191]
ds_read_b128 v[72:75],v4 offset:12288
s_waitcnt lgkmcnt(11)
v_mfma_f32_16x16x32_bf16 v[160:163],v[32:35],a[64:67],v[160:163]
ds_read_b128 v[76:79],v4 offset:13312
s_add_u32 m0,s58,4096
v_mfma_f32_16x16x32_bf16 v[164:167],v[32:35],a[68:71],v[164:167]
ds_read_b128 v[80:83],v4 offset:14336
s_add_u32 s64,s64,4096
v_mfma_f32_16x16x32_bf16 v[168:171],v[32:35],a[72:75],v[168:171]
buffer_load_dwordx4 v0,s[8:11],s64 offen offset:0 sc1 lds
v_mfma_f32_16x16x32_bf16 v[172:175],v[32:35],a[76:79],v[172:175]
ds_read_b128 v[84:87],v4 offset:15360
v_mfma_f32_16x16x32_bf16 v[176:179],v[32:35],a[80:83],v[176:179]
buffer_load_dwordx4 v[224:227],v0,s[4:7],s25 offen sc1
v_mfma_f32_16x16x32_bf16 v[180:183],v[32:35],a[84:87],v[180:183]
s_lshr_b32 s24,s55,5
s_cmp_lt_u32 s51,s24
s_cselect_b32 s24,1,2
v_mfma_f32_16x16x32_bf16 v[184:187],v[32:35],a[88:91],v[184:187]
buffer_load_dwordx4 v0,s[8:11],s64 offen offset:1024 sc1 lds
v_mfma_f32_16x16x32_bf16 v[188:191],v[32:35],a[92:95],v[188:191]
v_mov_b32 v252,s24
s_lshl2_add_u32 s25,s51,11018240
s_waitcnt lgkmcnt(13)
v_mfma_f32_16x16x32_bf16 v[160:163],v[36:39],a[96:99],v[160:163]
s_waitcnt lgkmcnt(0)
s_barrier
s_lshl_b32 s24,s68,16
v_mfma_f32_16x16x32_bf16 v[164:167],v[36:39],a[100:103],v[164:167]
ds_read_b128 v[248:251],v245
s_add_u32 s24,s24,s31
v_mfma_f32_16x16x32_bf16 v[168:171],v[36:39],a[104:107],v[168:171]
buffer_load_dwordx4 v0,s[8:11],s64 offen offset:2048 sc1 lds
v_mfma_f32_16x16x32_bf16 v[172:175],v[36:39],a[108:111],v[172:175]
s_add_u32 s24,s24,s86
s_cmp_eq_u32 s24,1537
s_cselect_b32 s25,s25,0x80000000
v_mfma_f32_16x16x32_bf16 v[176:179],v[36:39],a[112:115],v[176:179]
buffer_store_dword v252,off,s[8:11],s25 sc1
v_mfma_f32_16x16x32_bf16 v[180:183],v[36:39],a[116:119],v[180:183]
s_bitcmp1_b64 s[38:39],s51
s_cselect_b32 s24,128,0
s_lshl_b32 s23,s51,13
v_mfma_f32_16x16x32_bf16 v[184:187],v[36:39],a[120:123],v[184:187]
buffer_load_dwordx4 v0,s[8:11],s64 offen offset:3072 sc1 lds
v_mfma_f32_16x16x32_bf16 v[188:191],v[36:39],a[124:127],v[188:191]
s_waitcnt lgkmcnt(0)
v_or3_b32 v248,v248,v249,v250
v_or_b32 v248,v248,v251
v_mfma_f32_16x16x32_bf16 v[160:163],v[40:43],a[128:131],v[160:163]
s_lshl2_add_u32 s23,s68,s23
s_add_u32 s23,s23,10487168
s_add_u32 s23,s23,s24
v_mfma_f32_16x16x32_bf16 v[164:167],v[40:43],a[132:135],v[164:167]
buffer_load_dword v246,off,s[8:11],s23 sc1
v_mfma_f32_16x16x32_bf16 v[168:171],v[40:43],a[136:139],v[168:171]
s_add_u32 m0,s58,8192
s_add_u32 s64,s64,4096
v_readfirstlane_b32 s72,v248
v_mfma_f32_16x16x32_bf16 v[172:175],v[40:43],a[140:143],v[172:175]
buffer_load_dwordx4 v0,s[8:11],s64 offen offset:0 sc1 lds
v_mfma_f32_16x16x32_bf16 v[176:179],v[40:43],a[144:147],v[176:179]
s_waitcnt vmcnt(12)
v_lshrrev_b32 v244,4,v1
s_sub_u32 s23,s77,8
v_mfma_f32_16x16x32_bf16 v[180:183],v[40:43],a[148:151],v[180:183]
buffer_store_dword v20,off,s[8:11],s73 sc1
v_mfma_f32_16x16x32_bf16 v[184:187],v[40:43],a[152:155],v[184:187]
s_mov_b32 s73,0x80000000
v_add_u32 v244,s23,v244
v_max_i32 v244,0,v244
v_mfma_f32_16x16x32_bf16 v[188:191],v[40:43],a[156:159],v[188:191]
buffer_load_dwordx4 v0,s[8:11],s64 offen offset:1024 sc1 lds
v_mfma_f32_16x16x32_bf16 v[160:163],v[44:47],a[160:163],v[160:163]
v_lshl_add_u32 v244,v244,13,v21
v_mfma_f32_16x16x32_bf16 v[164:167],v[44:47],a[164:167],v[164:167]
buffer_load_dwordx2 v[242:243],v244,s[8:11],0 offen sc1
v_mfma_f32_16x16x32_bf16 v[168:171],v[44:47],a[168:171],v[168:171]
v_mfma_f32_16x16x32_bf16 v[172:175],v[44:47],a[172:175],v[172:175]
buffer_load_dwordx4 v0,s[8:11],s64 offen offset:2048 sc1 lds
v_mfma_f32_16x16x32_bf16 v[176:179],v[44:47],a[176:179],v[176:179]
v_mfma_f32_16x16x32_bf16 v[180:183],v[44:47],a[180:183],v[180:183]
v_mfma_f32_16x16x32_bf16 v[184:187],v[44:47],a[184:187],v[184:187]
v_mfma_f32_16x16x32_bf16 v[188:191],v[44:47],a[188:191],v[188:191]
buffer_load_dwordx4 v0,s[8:11],s64 offen offset:3072 sc1 lds
v_mfma_f32_16x16x32_bf16 v[160:163],v[48:51],a[192:195],v[160:163]
v_mfma_f32_16x16x32_bf16 v[164:167],v[48:51],a[196:199],v[164:167]
v_mfma_f32_16x16x32_bf16 v[168:171],v[48:51],a[200:203],v[168:171]
v_mfma_f32_16x16x32_bf16 v[172:175],v[48:51],a[204:207],v[172:175]
s_add_u32 m0,s57,24576
v_mfma_f32_16x16x32_bf16 v[176:179],v[48:51],a[208:211],v[176:179]
buffer_load_dwordx4 v0,s[8:11],s65 offen offset:0 sc1 lds
v_mfma_f32_16x16x32_bf16 v[180:183],v[48:51],a[212:215],v[180:183]
v_mfma_f32_16x16x32_bf16 v[184:187],v[48:51],a[216:219],v[184:187]
v_mfma_f32_16x16x32_bf16 v[188:191],v[48:51],a[220:223],v[188:191]
v_mfma_f32_16x16x32_bf16 v[160:163],v[52:55],a[224:227],v[160:163]
buffer_load_dwordx4 v0,s[8:11],s65 offen offset:1024 sc1 lds
v_mfma_f32_16x16x32_bf16 v[164:167],v[52:55],a[228:231],v[164:167]
v_mfma_f32_16x16x32_bf16 v[168:171],v[52:55],a[232:235],v[168:171]
v_mfma_f32_16x16x32_bf16 v[172:175],v[52:55],a[236:239],v[172:175]
v_mfma_f32_16x16x32_bf16 v[176:179],v[52:55],a[240:243],v[176:179]
v_mfma_f32_16x16x32_bf16 v[180:183],v[52:55],a[244:247],v[180:183]
v_mfma_f32_16x16x32_bf16 v[184:187],v[52:55],a[248:251],v[184:187]
v_mfma_f32_16x16x32_bf16 v[188:191],v[52:55],a[252:255],v[188:191]
v_mfma_f32_16x16x32_bf16 v[192:195],v[56:59],a[0:3],0
v_mfma_f32_16x16x32_bf16 v[196:199],v[56:59],a[4:7],0
v_mfma_f32_16x16x32_bf16 v[200:203],v[56:59],a[8:11],0
v_cvt_pk_bf16_f32 v24,v160,v164
v_cvt_pk_bf16_f32 v25,v168,v172
v_mfma_f32_16x16x32_bf16 v[204:207],v[56:59],a[12:15],0
v_cvt_pk_bf16_f32 v26,v176,v180
v_cvt_pk_bf16_f32 v27,v184,v188
v_mfma_f32_16x16x32_bf16 v[208:211],v[56:59],a[16:19],0
v_cvt_pk_bf16_f32 v28,v161,v165
v_cvt_pk_bf16_f32 v29,v169,v173
v_mfma_f32_16x16x32_bf16 v[212:215],v[56:59],a[20:23],0
v_cvt_pk_bf16_f32 v30,v177,v181
v_cvt_pk_bf16_f32 v31,v185,v189
v_mfma_f32_16x16x32_bf16 v[216:219],v[56:59],a[24:27],0
v_cvt_pk_bf16_f32 v32,v162,v166
v_cvt_pk_bf16_f32 v33,v170,v174
v_mfma_f32_16x16x32_bf16 v[220:223],v[56:59],a[28:31],0
v_cvt_pk_bf16_f32 v34,v178,v182
v_cvt_pk_bf16_f32 v35,v186,v190
v_mfma_f32_16x16x32_bf16 v[192:195],v[60:63],a[32:35],v[192:195]
v_cvt_pk_bf16_f32 v36,v163,v167
v_cvt_pk_bf16_f32 v37,v171,v175
v_mfma_f32_16x16x32_bf16 v[196:199],v[60:63],a[36:39],v[196:199]
v_cvt_pk_bf16_f32 v38,v179,v183
v_cvt_pk_bf16_f32 v39,v187,v191
v_mfma_f32_16x16x32_bf16 v[200:203],v[60:63],a[40:43],v[200:203]
v_mfma_f32_16x16x32_bf16 v[204:207],v[60:63],a[44:47],v[204:207]
v_mfma_f32_16x16x32_bf16 v[208:211],v[60:63],a[48:51],v[208:211]
v_mfma_f32_16x16x32_bf16 v[212:215],v[60:63],a[52:55],v[212:215]
v_mfma_f32_16x16x32_bf16 v[216:219],v[60:63],a[56:59],v[216:219]
v_mfma_f32_16x16x32_bf16 v[220:223],v[60:63],a[60:63],v[220:223]
v_mfma_f32_16x16x32_bf16 v[192:195],v[64:67],a[64:67],v[192:195]
v_mfma_f32_16x16x32_bf16 v[196:199],v[64:67],a[68:71],v[196:199]
v_mfma_f32_16x16x32_bf16 v[200:203],v[64:67],a[72:75],v[200:203]
v_mfma_f32_16x16x32_bf16 v[204:207],v[64:67],a[76:79],v[204:207]
v_mfma_f32_16x16x32_bf16 v[208:211],v[64:67],a[80:83],v[208:211]
v_mfma_f32_16x16x32_bf16 v[212:215],v[64:67],a[84:87],v[212:215]
v_mfma_f32_16x16x32_bf16 v[216:219],v[64:67],a[88:91],v[216:219]
v_mfma_f32_16x16x32_bf16 v[220:223],v[64:67],a[92:95],v[220:223]
v_mfma_f32_16x16x32_bf16 v[192:195],v[68:71],a[96:99],v[192:195]
v_mfma_f32_16x16x32_bf16 v[196:199],v[68:71],a[100:103],v[196:199]
v_mfma_f32_16x16x32_bf16 v[200:203],v[68:71],a[104:107],v[200:203]
v_mfma_f32_16x16x32_bf16 v[204:207],v[68:71],a[108:111],v[204:207]
v_mfma_f32_16x16x32_bf16 v[208:211],v[68:71],a[112:115],v[208:211]
s_add_u32 s62,s69,0
v_mfma_f32_16x16x32_bf16 v[212:215],v[68:71],a[116:119],v[212:215]
buffer_store_dwordx4 v[24:27],v5,s[8:11],s62 offen
v_mfma_f32_16x16x32_bf16 v[216:219],v[68:71],a[120:123],v[216:219]
v_mfma_f32_16x16x32_bf16 v[220:223],v[68:71],a[124:127],v[220:223]
v_mfma_f32_16x16x32_bf16 v[192:195],v[72:75],a[128:131],v[192:195]
v_mfma_f32_16x16x32_bf16 v[196:199],v[72:75],a[132:135],v[196:199]
s_add_u32 s62,s69,16384
v_mfma_f32_16x16x32_bf16 v[200:203],v[72:75],a[136:139],v[200:203]
buffer_store_dwordx4 v[28:31],v5,s[8:11],s62 offen
v_mfma_f32_16x16x32_bf16 v[204:207],v[72:75],a[140:143],v[204:207]
v_mfma_f32_16x16x32_bf16 v[208:211],v[72:75],a[144:147],v[208:211]
v_mfma_f32_16x16x32_bf16 v[212:215],v[72:75],a[148:151],v[212:215]
v_mfma_f32_16x16x32_bf16 v[216:219],v[72:75],a[152:155],v[216:219]
s_add_u32 s62,s69,32768
v_mfma_f32_16x16x32_bf16 v[220:223],v[72:75],a[156:159],v[220:223]
buffer_store_dwordx4 v[32:35],v5,s[8:11],s62 offen
v_mfma_f32_16x16x32_bf16 v[192:195],v[76:79],a[160:163],v[192:195]
v_mfma_f32_16x16x32_bf16 v[196:199],v[76:79],a[164:167],v[196:199]
v_mfma_f32_16x16x32_bf16 v[200:203],v[76:79],a[168:171],v[200:203]
v_mfma_f32_16x16x32_bf16 v[204:207],v[76:79],a[172:175],v[204:207]
s_add_u32 s62,s69,49152
v_mfma_f32_16x16x32_bf16 v[208:211],v[76:79],a[176:179],v[208:211]
buffer_store_dwordx4 v[36:39],v5,s[8:11],s62 offen
v_mfma_f32_16x16x32_bf16 v[212:215],v[76:79],a[180:183],v[212:215]
v_mfma_f32_16x16x32_bf16 v[216:219],v[76:79],a[184:187],v[216:219]
v_mfma_f32_16x16x32_bf16 v[220:223],v[76:79],a[188:191],v[220:223]
v_mfma_f32_16x16x32_bf16 v[192:195],v[80:83],a[192:195],v[192:195]
v_mfma_f32_16x16x32_bf16 v[196:199],v[80:83],a[196:199],v[196:199]
v_mfma_f32_16x16x32_bf16 v[192:195],v[84:87],a[224:227],v[192:195]
v_mfma_f32_16x16x32_bf16 v[196:199],v[84:87],a[228:231],v[196:199]
v_mfma_f32_16x16x32_bf16 v[200:203],v[80:83],a[200:203],v[200:203]
v_mfma_f32_16x16x32_bf16 v[204:207],v[80:83],a[204:207],v[204:207]
v_mfma_f32_16x16x32_bf16 v[200:203],v[84:87],a[232:235],v[200:203]
v_mfma_f32_16x16x32_bf16 v[204:207],v[84:87],a[236:239],v[204:207]
v_cvt_pk_bf16_f32 v40,v192,v196
v_cvt_pk_bf16_f32 v44,v193,v197
v_cvt_pk_bf16_f32 v48,v194,v198
v_mfma_f32_16x16x32_bf16 v[208:211],v[80:83],a[208:211],v[208:211]
v_cvt_pk_bf16_f32 v52,v195,v199
v_mfma_f32_16x16x32_bf16 v[212:215],v[80:83],a[212:215],v[212:215]
v_cvt_pk_bf16_f32 v41,v200,v204
v_cvt_pk_bf16_f32 v45,v201,v205
v_cvt_pk_bf16_f32 v49,v202,v206
v_mfma_f32_16x16x32_bf16 v[208:211],v[84:87],a[240:243],v[208:211]
v_cvt_pk_bf16_f32 v53,v203,v207
v_mfma_f32_16x16x32_bf16 v[212:215],v[84:87],a[244:247],v[212:215]
v_mfma_f32_16x16x32_bf16 v[216:219],v[80:83],a[216:219],v[216:219]
v_mfma_f32_16x16x32_bf16 v[220:223],v[80:83],a[220:223],v[220:223]
v_mfma_f32_16x16x32_bf16 v[216:219],v[84:87],a[248:251],v[216:219]
v_mfma_f32_16x16x32_bf16 v[220:223],v[84:87],a[252:255],v[220:223]
v_cvt_pk_bf16_f32 v42,v208,v212
v_cvt_pk_bf16_f32 v46,v209,v213
v_cvt_pk_bf16_f32 v50,v210,v214
v_cvt_pk_bf16_f32 v54,v211,v215
s_nop 3
v_cvt_pk_bf16_f32 v43,v216,v220
s_add_u32 s62,s69,262144
buffer_store_dwordx4 v[40:43],v5,s[8:11],s62 offen
v_cvt_pk_bf16_f32 v47,v217,v221
s_add_u32 s62,s69,278528
buffer_store_dwordx4 v[44:47],v5,s[8:11],s62 offen
v_cvt_pk_bf16_f32 v51,v218,v222
s_add_u32 s62,s69,294912
buffer_store_dwordx4 v[48:51],v5,s[8:11],s62 offen
v_cvt_pk_bf16_f32 v55,v219,v223
s_add_u32 s62,s69,311296
buffer_store_dwordx4 v[52:55],v5,s[8:11],s62 offen
s_cmp_lg_u32 s72,0
s_cbranch_scc1 L_aa_81
s_waitcnt vmcnt(8)
L_aa_91:
s_barrier
s_cmp_lt_u32 s30,s31
s_cbranch_scc1 L_ao_98
s_xor_b32 s67,s67,65536
s_and_b32 s56,s50,2048
s_lshl_b32 s56,s56,4
s_add_u32 s56,s56,s67
v_add_u32 v2,s56,v0
v_add_u32 v239,s56,v253
s_and_b32 s56,s50,1024
s_lshl_b32 s56,s56,2
v_add_u32 v238,s56,v2
s_mov_b32 s76,s71
s_mov_b32 s53,s77
ds_read_b128 v[24:27],v238 offset:16384
ds_read_b128 v[40:43],v2 offset:0
ds_read_b128 v[56:59],v2 offset:4096
ds_read_b128 v[28:31],v238 offset:17408
ds_read_b128 v[44:47],v2 offset:1024
ds_read_b128 v[60:63],v2 offset:5120
ds_read_b128 v[32:35],v238 offset:18432
ds_read_b128 v[48:51],v2 offset:2048
ds_read_b128 v[64:67],v2 offset:6144
ds_read_b128 v[36:39],v238 offset:19456
ds_read_b128 v[52:55],v2 offset:3072
ds_read_b128 v[68:71],v2 offset:7168
s_waitcnt lgkmcnt(9)
v_mfma_f32_16x16x32_bf16 v[128:131],v[40:43],v[24:27],v[8:11]
ds_read_b128 v[72:75],v2 offset:24576
v_mfma_f32_16x16x32_bf16 v[132:135],v[56:59],v[24:27],v[12:15]
ds_read_b128 v[76:79],v2 offset:25600
s_waitcnt lgkmcnt(8)
v_mfma_f32_16x16x32_bf16 v[128:131],v[44:47],v[28:31],v[128:131]
ds_read_b128 v[80:83],v2 offset:26624
v_mfma_f32_16x16x32_bf16 v[132:135],v[60:63],v[28:31],v[132:135]
ds_read_b128 v[84:87],v2 offset:27648
s_waitcnt lgkmcnt(7)
v_mfma_f32_16x16x32_bf16 v[128:131],v[48:51],v[32:35],v[128:131]
ds_read_b64 v[120:121],v239 offset:24576
v_mfma_f32_16x16x32_bf16 v[132:135],v[64:67],v[32:35],v[132:135]
ds_read_b64 v[122:123],v239 offset:25600
s_waitcnt lgkmcnt(6)
v_mfma_f32_16x16x32_bf16 v[128:131],v[52:55],v[36:39],v[128:131]
ds_read_b64 v[124:125],v239 offset:26624
v_mfma_f32_16x16x32_bf16 v[132:135],v[68:71],v[36:39],v[132:135]
ds_read_b64 v[126:127],v239 offset:27648
s_waitcnt lgkmcnt(4)
v_mfma_f32_16x16x32_bf16 v[136:139],v[72:75],v[24:27],0
ds_read_b128 v[88:91],v2 offset:8192
ds_read_b128 v[92:95],v2 offset:9216
v_mfma_f32_16x16x32_bf16 v[136:139],v[76:79],v[28:31],v[136:139]
ds_read_b128 v[96:99],v2 offset:10240
ds_read_b128 v[100:103],v2 offset:11264
v_mfma_f32_16x16x32_bf16 v[136:139],v[80:83],v[32:35],v[136:139]
ds_read_b128 v[104:107],v2 offset:12288
ds_read_b128 v[108:111],v2 offset:13312
v_mfma_f32_16x16x32_bf16 v[136:139],v[84:87],v[36:39],v[136:139]
ds_read_b128 v[112:115],v2 offset:14336
ds_read_b128 v[116:119],v2 offset:15360
s_cmp_eq_u32 s30,0
s_cbranch_scc1 L_aa_80
v_max3_u32 v238,v72,v73,v74
v_max3_u32 v238,v74,v75,v238
v_max3_u32 v238,v76,v77,v238
v_max3_u32 v238,v78,v79,v238
v_max3_u32 v238,v80,v81,v238
v_max3_u32 v238,v82,v83,v238
v_max3_u32 v238,v84,v85,v238
v_max3_u32 v238,v86,v87,v238
s_waitcnt lgkmcnt(8)
v_max3_u32 v238,v120,v121,v238
v_max3_u32 v238,v122,v123,v238
v_max3_u32 v238,v124,v125,v238
v_max3_u32 v238,v126,v127,v238
v_cmp_eq_u32 vcc,-1,v238
s_cmp_lg_u64 vcc,0
s_cselect_b32 s27,1,0
s_andn2_b32 s57,s27,s31
s_add_u32 s66,s66,4
s_bfe_u32 s56,s66,0x10002
s_bitset0_b32 s37,s56
s_lshl_b32 s56,s57,s56
s_or_b32 s37,s37,s56
s_or_b32 s56,s37,s66
v_mov_b32 v22,s56
s_xor_b32 s69,s69,524288
s_waitcnt vmcnt(0) lgkmcnt(0)
buffer_store_dword v22,off,s[8:11],s74
s_cmp_lg_u32 s86,1536
s_cbranch_scc1 L_ae_101
s_mov_b32 s77,s35
s_mov_b32 s30,0
s_lshl_b32 s56,s77,5
s_add_u32 s56,s56,s68
s_mul_i32 s70,s56,24576
s_lshl_b32 s71,s56,12
s_lshl_b32 s59,s77,13
s_lshl2_add_u32 s59,s68,s59
s_add_u32 s59,s59,10485760
s_buffer_load_dword s32,s[8:11],s59
s_mov_b32 s33,1
s_add_u32 s70,s70,100663296
s_add_u32 s71,s71,41943040
v_mov_b32 v19,s59
s_branch L_af_102
L_ae_101:
s_ff1_i32_b64 s77,s[84:85]
s_bitset0_b64 s[84:85],s77
s_min_u32 s77,s77,64
s_lshr_b32 s61,s55,5
s_lshl_b32 s56,s77,5
s_add_u32 s56,s56,s68
s_mul_i32 s70,s56,24576
s_lshl_b32 s71,s56,12
s_lshl_b32 s59,s77,13
s_lshl2_add_u32 s59,s68,s59
s_add_u32 s59,s59,10486144
s_cmp_lt_u32 s77,s61
s_cselect_b32 s57,0,16777216
s_mov_b32 s60,s59
s_buffer_load_dword s33,s[8:11],s60
s_add_u32 s71,s71,s57
s_add_u32 s71,s71,58720256
s_cmp_eq_u32 s77,s61
s_cselect_b32 s57,50331648,0
s_cselect_b32 s58,1536,0
s_add_u32 s59,s59,s58
s_buffer_load_dword s32,s[8:11],s59
s_add_u32 s70,s70,s57
s_add_u32 s70,s70,150994944
v_mov_b32 v19,s59
v_writelane_b32 v19,s60,1
L_af_102:
s_and_b32 s27,s27,s31
s_cbranch_scc1 L_ac_103
L_acb_104:
v_max3_f32 v238,v128,v129,v130
v_max3_f32 v239,v131,v132,v133
v_max3_f32 v238,v134,v135,v238
v_max3_f32 v239,v138,v139,v239
v_max_f32 v238,v238,v239
v_max_f32 v239,v238,v239
v_pk_mul_f32 v[128:129],v[128:129],v[152:153] op_sel_hi:[1,0]
v_pk_mul_f32 v[130:131],v[130:131],v[152:153] op_sel_hi:[1,0]
v_permlane16_swap_b32 v238,v239
v_max_f32 v238,v238,v239
v_max_f32 v239,v238,v239
v_pk_mul_f32 v[132:133],v[132:133],v[152:153] op_sel_hi:[1,0]
v_pk_mul_f32 v[134:135],v[134:135],v[152:153] op_sel_hi:[1,0]
v_permlane32_swap_b32 v238,v239
v_max_f32 v238,v238,v239
v_mul_f32 v238,v152,v238
v_pk_mul_f32 v[138:139],v[138:139],v[152:153] op_sel_hi:[1,0]
buffer_load_dword v17,v16,s[8:11],s87 offen sc1
v_pk_add_f32 v[128:129],v[128:129],v[238:239] op_sel_hi:[1,0] neg_lo:[0,1] neg_hi:[0,1]
v_pk_add_f32 v[130:131],v[130:131],v[238:239] op_sel_hi:[1,0] neg_lo:[0,1] neg_hi:[0,1]
v_pk_add_f32 v[132:133],v[132:133],v[238:239] op_sel_hi:[1,0] neg_lo:[0,1] neg_hi:[0,1]
v_pk_add_f32 v[134:135],v[134:135],v[238:239] op_sel_hi:[1,0] neg_lo:[0,1] neg_hi:[0,1]
v_pk_add_f32 v[138:139],v[138:139],v[238:239] op_sel_hi:[1,0] neg_lo:[0,1] neg_hi:[0,1]
v_exp_f32 v128,v128
v_exp_f32 v129,v129
v_exp_f32 v130,v130
v_exp_f32 v131,v131
v_exp_f32 v132,v132
v_exp_f32 v133,v133
v_exp_f32 v134,v134
v_exp_f32 v135,v135
v_exp_f32 v138,v138
v_exp_f32 v139,v139
v_pk_add_f32 v[148:149],v[128:129],v[130:131]
v_pk_add_f32 v[150:151],v[132:133],v[134:135]
v_pk_add_f32 v[148:149],v[148:149],v[138:139]
v_pk_add_f32 v[148:149],v[148:149],v[150:151]
v_add_f32 v150,v148,v149
v_add_f32 v151,v148,v149
s_nop 1
v_permlane16_swap_b32 v150,v151
v_add_f32 v148,v150,v151
v_add_f32 v149,v150,v151
s_nop 1
v_permlane32_swap_b32 v148,v149
v_add_f32 v148,v148,v149
v_rcp_f32 v148,v148
s_waitcnt vmcnt(0)
v_cmp_gt_u32 vcc,s66,v17
v_pk_mul_f32 v[138:139],v[138:139],v[148:149] op_sel_hi:[1,0]
v_pk_mul_f32 v[128:129],v[128:129],v[148:149] op_sel_hi:[1,0]
v_pk_mul_f32 v[130:131],v[130:131],v[148:149] op_sel_hi:[1,0]
v_pk_mul_f32 v[132:133],v[132:133],v[148:149] op_sel_hi:[1,0]
v_pk_mul_f32 v[134:135],v[134:135],v[148:149] op_sel_hi:[1,0]
s_cbranch_vccnz L_ap_106
L_apb_107:
s_xor_b32 s34,s69,524288
buffer_load_dwordx4 v[192:195],v7,s[8:11],s34 offen sc1
s_bfe_u32 s56,s66,0x10002
v_lshrrev_b32 v238,s56,v17
v_and_b32 v238,1,v238
v_cmp_ne_u32 vcc,0,v238
v_cvt_pk_bf16_f32 v144,v138,v139
v_cvt_pk_bf16_f32 v147,v138,v139
v_cvt_pk_bf16_f32 v140,v128,v129
v_cvt_pk_bf16_f32 v141,v130,v131
v_cvt_pk_bf16_f32 v142,v132,v133
v_cvt_pk_bf16_f32 v143,v134,v135
s_cbranch_vccnz L_ak_100
s_add_u32 s36,s36,4
v_mfma_f32_16x16x16_bf16 v[24:27],v[120:121],v[144:145],0
s_add_u32 s34,s34,4096
v_mfma_f32_16x16x16_bf16 v[28:31],v[120:121],v[146:147],0
buffer_load_dwordx4 v[196:199],v7,s[8:11],s34 offen sc1
v_mfma_f32_16x16x16_bf16 v[32:35],v[122:123],v[144:145],0
s_add_u32 s34,s34,4096
v_mfma_f32_16x16x16_bf16 v[36:39],v[122:123],v[146:147],0
buffer_load_dwordx4 v[200:203],v7,s[8:11],s34 offen sc1
v_mfma_f32_16x16x16_bf16 v[40:43],v[124:125],v[144:145],0
s_add_u32 s34,s34,4096
v_mfma_f32_16x16x16_bf16 v[44:47],v[124:125],v[146:147],0
buffer_load_dwordx4 v[204:207],v7,s[8:11],s34 offen sc1
v_mfma_f32_16x16x16_bf16 v[48:51],v[126:127],v[144:145],0
s_add_u32 s34,s34,4096
v_mfma_f32_16x16x16_bf16 v[52:55],v[126:127],v[146:147],0
buffer_load_dwordx4 v[208:211],v7,s[8:11],s34 offen sc1
v_mfma_f32_16x16x32_bf16 v[24:27],v[88:91],v[140:143],v[24:27]
s_add_u32 s34,s34,4096
v_mfma_f32_16x16x32_bf16 v[28:31],v[92:95],v[140:143],v[28:31]
buffer_load_dwordx4 v[212:215],v7,s[8:11],s34 offen sc1
v_mfma_f32_16x16x32_bf16 v[32:35],v[96:99],v[140:143],v[32:35]
s_add_u32 s34,s34,4096
v_mfma_f32_16x16x32_bf16 v[36:39],v[100:103],v[140:143],v[36:39]
buffer_load_dwordx4 v[216:219],v7,s[8:11],s34 offen sc1
v_cvt_pk_bf16_f32 v72,v24,v28
v_cvt_pk_bf16_f32 v73,v25,v29
v_mfma_f32_16x16x32_bf16 v[40:43],v[104:107],v[140:143],v[40:43]
s_add_u32 s34,s34,4096
v_cvt_pk_bf16_f32 v74,v26,v30
v_cvt_pk_bf16_f32 v75,v27,v31
v_mfma_f32_16x16x32_bf16 v[44:47],v[108:111],v[140:143],v[44:47]
ds_write_b128 v3,v[72:75] offset:0
v_cvt_pk_bf16_f32 v76,v32,v36
v_cvt_pk_bf16_f32 v77,v33,v37
v_mfma_f32_16x16x32_bf16 v[48:51],v[112:115],v[140:143],v[48:51]
buffer_load_dwordx4 v[220:223],v7,s[8:11],s34 offen sc1
v_cvt_pk_bf16_f32 v78,v34,v38
v_cvt_pk_bf16_f32 v79,v35,v39
v_mfma_f32_16x16x32_bf16 v[52:55],v[116:119],v[140:143],v[52:55]
ds_write_b128 v3,v[76:79] offset:1024
v_cvt_pk_bf16_f32 v80,v40,v44
v_cvt_pk_bf16_f32 v81,v41,v45
v_cvt_pk_bf16_f32 v82,v42,v46
v_cvt_pk_bf16_f32 v83,v43,v47
ds_write_b128 v3,v[80:83] offset:2048
s_nop 1
v_cvt_pk_bf16_f32 v84,v48,v52
v_cvt_pk_bf16_f32 v85,v49,v53
v_cvt_pk_bf16_f32 v86,v50,v54
v_cvt_pk_bf16_f32 v87,v51,v55
ds_write_b128 v3,v[84:87] offset:3072
s_cmp_eq_u32 s31,0
s_cbranch_scc1 L_ah_105
s_waitcnt lgkmcnt(0)
s_barrier
s_mov_b32 s26,s51
s_mov_b32 s51,s53
s_branch L_aa_92
L_ah_105:
s_waitcnt lgkmcnt(0)
s_barrier
s_mov_b32 s26,s51
s_mov_b32 s51,s53
s_mov_b32 s31,1
s_branch L_av_96
L_ao_98:
s_xor_b32 s67,s67,65536
s_and_b32 s56,s50,2048
s_lshl_b32 s56,s56,4
s_add_u32 s56,s56,s67
v_add_u32 v2,s56,v0
v_add_u32 v239,s56,v253
s_and_b32 s56,s50,1024
s_lshl_b32 s56,s56,2
v_add_u32 v238,s56,v2
s_mov_b32 s76,s71
s_mov_b32 s53,s77
ds_read_b128 v[24:27],v238 offset:16384
ds_read_b128 v[40:43],v2 offset:0
ds_read_b128 v[56:59],v2 offset:4096
ds_read_b128 v[28:31],v238 offset:17408
ds_read_b128 v[44:47],v2 offset:1024
ds_read_b128 v[60:63],v2 offset:5120
ds_read_b128 v[32:35],v238 offset:18432
ds_read_b128 v[48:51],v2 offset:2048
ds_read_b128 v[64:67],v2 offset:6144
ds_read_b128 v[36:39],v238 offset:19456
ds_read_b128 v[52:55],v2 offset:3072
ds_read_b128 v[68:71],v2 offset:7168
buffer_load_dwordx4 v[72:75],v0,s[8:11],s76 offen offset:0 sc1
buffer_load_dwordx4 v[76:79],v0,s[8:11],s76 offen offset:1024 sc1
buffer_load_dwordx4 v[80:83],v0,s[8:11],s76 offen offset:2048 sc1
buffer_load_dwordx4 v[84:87],v0,s[8:11],s76 offen offset:3072 sc1
buffer_load_dwordx2 v[120:121],v253,s[8:11],s76 offen offset:0 sc1
buffer_load_dwordx2 v[122:123],v253,s[8:11],s76 offen offset:1024 sc1
buffer_load_dwordx2 v[124:125],v253,s[8:11],s76 offen offset:2048 sc1
buffer_load_dwordx2 v[126:127],v253,s[8:11],s76 offen offset:3072 sc1
s_waitcnt lgkmcnt(9)
v_mfma_f32_16x16x32_bf16 v[128:131],v[40:43],v[24:27],v[8:11]
ds_read_b128 v[88:91],v2 offset:8192
v_mfma_f32_16x16x32_bf16 v[132:135],v[56:59],v[24:27],v[12:15]
ds_read_b128 v[92:95],v2 offset:9216
s_waitcnt lgkmcnt(8)
v_mfma_f32_16x16x32_bf16 v[128:131],v[44:47],v[28:31],v[128:131]
ds_read_b128 v[96:99],v2 offset:10240
v_mfma_f32_16x16x32_bf16 v[132:135],v[60:63],v[28:31],v[132:135]
ds_read_b128 v[100:103],v2 offset:11264
s_waitcnt lgkmcnt(7)
v_mfma_f32_16x16x32_bf16 v[128:131],v[48:51],v[32:35],v[128:131]
ds_read_b128 v[104:107],v2 offset:12288
v_mfma_f32_16x16x32_bf16 v[132:135],v[64:67],v[32:35],v[132:135]
ds_read_b128 v[108:111],v2 offset:13312
s_waitcnt lgkmcnt(6)
v_mfma_f32_16x16x32_bf16 v[128:131],v[52:55],v[36:39],v[128:131]
ds_read_b128 v[112:115],v2 offset:14336
v_mfma_f32_16x16x32_bf16 v[132:135],v[68:71],v[36:39],v[132:135]
ds_read_b128 v[116:119],v2 offset:15360
s_add_u32 s66,s66,4
s_bfe_u32 s56,s66,0x10002
s_bitset0_b32 s37,s56
s_lshl_b32 s56,0,s56
s_or_b32 s37,s37,s56
s_or_b32 s56,s37,s66
v_mov_b32 v22,s56
s_xor_b32 s69,s69,524288
s_waitcnt vmcnt(8) lgkmcnt(0)
buffer_store_dword v22,off,s[8:11],s74
s_mov_b32 s26,s51
s_mov_b32 s27,3
s_branch L_aa_87
L_aa_80:
s_add_u32 s66,s66,4
s_bfe_u32 s56,s66,0x10002
s_bitset0_b32 s37,s56
s_lshl_b32 s56,0,s56
s_or_b32 s37,s37,s56
s_or_b32 s56,s37,s66
v_mov_b32 v22,s56
s_xor_b32 s69,s69,524288
s_waitcnt vmcnt(0) lgkmcnt(0)
buffer_store_dword v22,off,s[8:11],s74
L_aq_108:
buffer_load_dword v17,v16,s[8:11],s87 offen sc1
s_sub_u32 s49,s49,1
s_cbranch_scc1 L_abort
s_waitcnt vmcnt(0)
v_cmp_gt_u32 vcc,s66,v17
s_cbranch_vccnz L_aq_108
s_xor_b32 s34,s69,524288
buffer_load_dwordx4 v[160:163],v7,s[8:11],s34 offen sc1
s_add_u32 s34,s34,4096
buffer_load_dwordx4 v[164:167],v7,s[8:11],s34 offen sc1
s_add_u32 s34,s34,4096
buffer_load_dwordx4 v[168:171],v7,s[8:11],s34 offen sc1
s_add_u32 s34,s34,4096
buffer_load_dwordx4 v[172:175],v7,s[8:11],s34 offen sc1
s_add_u32 s34,s34,4096
buffer_load_dwordx4 v[176:179],v7,s[8:11],s34 offen sc1
s_add_u32 s34,s34,4096
buffer_load_dwordx4 v[180:183],v7,s[8:11],s34 offen sc1
s_add_u32 s34,s34,4096
buffer_load_dwordx4 v[184:187],v7,s[8:11],s34 offen sc1
s_add_u32 s34,s34,4096
buffer_load_dwordx4 v[188:191],v7,s[8:11],s34 offen sc1
buffer_load_dwordx4 v[72:75],v0,s[8:11],s76 offen offset:0 sc1
buffer_load_dwordx4 v[76:79],v0,s[8:11],s76 offen offset:1024 sc1
buffer_load_dwordx4 v[80:83],v0,s[8:11],s76 offen offset:2048 sc1
buffer_load_dwordx4 v[84:87],v0,s[8:11],s76 offen offset:3072 sc1
buffer_load_dwordx2 v[120:121],v253,s[8:11],s76 offen offset:0 sc1
buffer_load_dwordx2 v[122:123],v253,s[8:11],s76 offen offset:1024 sc1
buffer_load_dwordx2 v[124:125],v253,s[8:11],s76 offen offset:2048 sc1
buffer_load_dwordx2 v[126:127],v253,s[8:11],s76 offen offset:3072 sc1
s_waitcnt vmcnt(15)
v_mfma_f32_16x16x32_bf16 v[192:195],v[156:159],v[160:163],0
s_waitcnt vmcnt(14)
v_mfma_f32_16x16x32_bf16 v[192:195],v[156:159],v[164:167],v[192:195]
s_waitcnt vmcnt(13)
v_mfma_f32_16x16x32_bf16 v[192:195],v[156:159],v[168:171],v[192:195]
s_waitcnt vmcnt(12)
v_mfma_f32_16x16x32_bf16 v[192:195],v[156:159],v[172:175],v[192:195]
s_waitcnt vmcnt(11)
v_mfma_f32_16x16x32_bf16 v[196:199],v[156:159],v[176:179],0
s_waitcnt vmcnt(10)
v_mfma_f32_16x16x32_bf16 v[196:199],v[156:159],v[180:183],v[196:199]
s_waitcnt vmcnt(9)
v_mfma_f32_16x16x32_bf16 v[196:199],v[156:159],v[184:187],v[196:199]
ds_write_b128 v6,v[192:195]
s_waitcnt vmcnt(8)
v_mfma_f32_16x16x32_bf16 v[196:199],v[156:159],v[188:191],v[196:199]
s_nop 7
ds_write_b128 v6,v[196:199] offset:2048
s_waitcnt lgkmcnt(0)
s_barrier
buffer_store_dword v20,off,s[8:11],s73 sc1
s_mov_b32 s73,0x80000000
s_mov_b32 s27,0
s_branch L_aa_83
L_aa_81:
s_add_u32 s56,s30,s86
s_cmp_lg_u32 s56,1537
s_cbranch_scc1 L_al_99
s_add_u32 s66,s66,4
s_bfe_u32 s56,s66,0x10002
s_bitset0_b32 s37,s56
s_lshl_b32 s56,1,s56
s_or_b32 s37,s37,s56
s_or_b32 s56,s37,s66
v_mov_b32 v22,s56
s_xor_b32 s69,s69,524288
s_waitcnt vmcnt(0) lgkmcnt(0)
buffer_store_dword v22,off,s[8:11],s74
s_cmp_lg_u32 s86,1536
s_cbranch_scc1 L_ae_109
s_mov_b32 s77,s35
s_mov_b32 s30,0
s_lshl_b32 s56,s77,5
s_add_u32 s56,s56,s68
s_mul_i32 s70,s56,24576
s_lshl_b32 s71,s56,12
s_lshl_b32 s59,s77,13
s_lshl2_add_u32 s59,s68,s59
s_add_u32 s59,s59,10485760
s_buffer_load_dword s32,s[8:11],s59
s_mov_b32 s33,1
s_add_u32 s70,s70,100663296
s_add_u32 s71,s71,41943040
v_mov_b32 v19,s59
s_branch L_af_110
L_ae_109:
s_ff1_i32_b64 s77,s[84:85]
s_bitset0_b64 s[84:85],s77
s_min_u32 s77,s77,64
s_lshr_b32 s61,s55,5
s_lshl_b32 s56,s77,5
s_add_u32 s56,s56,s68
s_mul_i32 s70,s56,24576
s_lshl_b32 s71,s56,12
s_lshl_b32 s59,s77,13
s_lshl2_add_u32 s59,s68,s59
s_add_u32 s59,s59,10486144
s_cmp_lt_u32 s77,s61
s_cselect_b32 s57,0,16777216
s_mov_b32 s60,s59
s_buffer_load_dword s33,s[8:11],s60
s_add_u32 s71,s71,s57
s_add_u32 s71,s71,58720256
s_cmp_eq_u32 s77,s61
s_cselect_b32 s57,50331648,0
s_cselect_b32 s58,1536,0
s_add_u32 s59,s59,s58
s_buffer_load_dword s32,s[8:11],s59
s_add_u32 s70,s70,s57
s_add_u32 s70,s70,150994944
v_mov_b32 v19,s59
v_writelane_b32 v19,s60,1
L_af_110:
s_branch L_ak_100
L_al_99:
s_add_u32 s66,s66,4
s_bfe_u32 s56,s66,0x10002
s_bitset0_b32 s37,s56
s_lshl_b32 s56,0,s56
s_or_b32 s37,s37,s56
s_or_b32 s56,s37,s66
v_mov_b32 v22,s56
s_xor_b32 s69,s69,524288
s_waitcnt vmcnt(0) lgkmcnt(0)
buffer_store_dword v22,off,s[8:11],s74
L_ak_100:
L_aq_111:
buffer_load_dword v17,v16,s[8:11],s87 offen sc1
s_sub_u32 s49,s49,1
s_cbranch_scc1 L_abort
s_waitcnt vmcnt(0)
v_cmp_gt_u32 vcc,s66,v17
s_cbranch_vccnz L_aq_111
s_xor_b32 s34,s69,524288
buffer_load_dwordx4 v[160:163],v7,s[8:11],s34 offen sc1
s_add_u32 s34,s34,4096
buffer_load_dwordx4 v[164:167],v7,s[8:11],s34 offen sc1
s_add_u32 s34,s34,4096
buffer_load_dwordx4 v[168:171],v7,s[8:11],s34 offen sc1
s_add_u32 s34,s34,4096
buffer_load_dwordx4 v[172:175],v7,s[8:11],s34 offen sc1
s_add_u32 s34,s34,4096
buffer_load_dwordx4 v[176:179],v7,s[8:11],s34 offen sc1
s_add_u32 s34,s34,4096
buffer_load_dwordx4 v[180:183],v7,s[8:11],s34 offen sc1
s_add_u32 s34,s34,4096
buffer_load_dwordx4 v[184:187],v7,s[8:11],s34 offen sc1
s_add_u32 s34,s34,4096
buffer_load_dwordx4 v[188:191],v7,s[8:11],s34 offen sc1
s_waitcnt vmcnt(7)
v_mfma_f32_16x16x32_bf16 v[192:195],v[156:159],v[160:163],0
s_waitcnt vmcnt(6)
v_mfma_f32_16x16x32_bf16 v[192:195],v[156:159],v[164:167],v[192:195]
s_waitcnt vmcnt(5)
v_mfma_f32_16x16x32_bf16 v[192:195],v[156:159],v[168:171],v[192:195]
s_waitcnt vmcnt(4)
v_mfma_f32_16x16x32_bf16 v[192:195],v[156:159],v[172:175],v[192:195]
s_waitcnt vmcnt(3)
v_mfma_f32_16x16x32_bf16 v[196:199],v[156:159],v[176:179],0
s_waitcnt vmcnt(2)
v_mfma_f32_16x16x32_bf16 v[196:199],v[156:159],v[180:183],v[196:199]
s_waitcnt vmcnt(1)
v_mfma_f32_16x16x32_bf16 v[196:199],v[156:159],v[184:187],v[196:199]
ds_write_b128 v6,v[192:195]
s_waitcnt vmcnt(0)
v_mfma_f32_16x16x32_bf16 v[196:199],v[156:159],v[188:191],v[196:199]
s_nop 7
ds_write_b128 v6,v[196:199] offset:2048
s_waitcnt lgkmcnt(0)
s_barrier
buffer_store_dword v20,off,s[8:11],s73 sc1
s_mov_b32 s73,0x80000000
s_mov_b32 s27,2
L_aa_83:
s_cmp_lg_u32 s31,0
s_cbranch_scc1 L_ar_114
s_bitcmp1_b32 s46,0
s_cbranch_scc1 L_ar_113
L_ar_112:
ds_read_b128 v[160:163],v23
ds_read_b128 v[164:167],v23 offset:16
v_lshlrev_b32 v200,16,v224
v_and_b32 v201,0xffff0000,v224
v_lshlrev_b32 v202,16,v225
v_and_b32 v203,0xffff0000,v225
v_lshlrev_b32 v204,16,v226
v_and_b32 v205,0xffff0000,v226
v_lshlrev_b32 v206,16,v227
v_and_b32 v207,0xffff0000,v227
s_lshl_b32 s18,s51,5
s_add_u32 s18,s18,s68
s_lshl_b32 s19,s18,10
s_add_u32 s20,s19,8388608
s_waitcnt lgkmcnt(0)
v_cvt_pk_bf16_f32 v168,v160,v161
v_cvt_pk_bf16_f32 v169,v162,v163
v_cvt_pk_bf16_f32 v170,v164,v165
v_cvt_pk_bf16_f32 v171,v166,v167
v_lshlrev_b32 v160,16,v168
v_and_b32 v161,0xffff0000,v168
v_lshlrev_b32 v162,16,v169
v_and_b32 v163,0xffff0000,v169
v_lshlrev_b32 v164,16,v170
v_and_b32 v165,0xffff0000,v170
v_lshlrev_b32 v166,16,v171
v_and_b32 v167,0xffff0000,v171
v_pk_add_f32 v[200:201],v[200:201],v[160:161]
v_pk_add_f32 v[202:203],v[202:203],v[162:163]
v_pk_add_f32 v[204:205],v[204:205],v[164:165]
v_pk_add_f32 v[206:207],v[206:207],v[166:167]
v_cvt_pk_bf16_f32 v168,v200,v201
v_cvt_pk_bf16_f32 v169,v202,v203
v_cvt_pk_bf16_f32 v170,v204,v205
v_cvt_pk_bf16_f32 v171,v206,v207
v_lshlrev_b32 v200,16,v168
v_and_b32 v201,0xffff0000,v168
v_lshlrev_b32 v202,16,v169
v_and_b32 v203,0xffff0000,v169
v_lshlrev_b32 v204,16,v170
v_and_b32 v205,0xffff0000,v170
v_lshlrev_b32 v206,16,v171
v_and_b32 v207,0xffff0000,v171
v_readfirstlane_b32 s78,v200
s_nop 1
v_pk_add_f32 v[184:185],v[200:201],s[78:79] op_sel_hi:[1,0] neg_lo:[0,1] neg_hi:[0,1]
v_pk_add_f32 v[186:187],v[202:203],s[78:79] op_sel_hi:[1,0] neg_lo:[0,1] neg_hi:[0,1]
v_pk_add_f32 v[188:189],v[204:205],s[78:79] op_sel_hi:[1,0] neg_lo:[0,1] neg_hi:[0,1]
v_pk_add_f32 v[190:191],v[206:207],s[78:79] op_sel_hi:[1,0] neg_lo:[0,1] neg_hi:[0,1]
v_pk_add_f32 v[192:193],v[184:185],v[186:187]
v_pk_mul_f32 v[194:195],v[184:185],v[184:185]
v_pk_add_f32 v[196:197],v[188:189],v[190:191]
v_pk_fma_f32 v[194:195],v[186:187],v[186:187],v[194:195]
v_pk_add_f32 v[192:193],v[192:193],v[196:197]
v_pk_fma_f32 v[194:195],v[188:189],v[188:189],v[194:195]
v_add_f32 v192,v192,v193
v_pk_fma_f32 v[194:195],v[190:191],v[190:191],v[194:195]
v_add_f32 v194,v194,v195
s_nop 1
v_permlane32_swap_b32 v192,v194
v_add_f32 v192,v192,v194
s_nop 1
v_add_f32_dpp v192,v192,v192 row_ror:8 row_mask:0xf bank_mask:0xf
s_nop 1
v_add_f32_dpp v192,v192,v192 row_ror:4 row_mask:0xf bank_mask:0xf
s_nop 1
v_add_f32_dpp v192,v192,v192 row_ror:2 row_mask:0xf bank_mask:0xf
s_nop 1
v_add_f32_dpp v192,v192,v192 row_ror:1 row_mask:0xf bank_mask:0xf
v_mov_b32 v194,v192
s_nop 1
v_permlane16_swap_b32 v192,v194
v_add_f32 v192,v192,v194
v_mul_f32 v192,0x3b000000,v192
v_mov_b32 v194,v192
s_nop 1
v_permlane32_swap_b32 v192,v194
v_fma_f32 v194,-v192,v192,v194
v_add_f32 v192,s78,v192
v_max_f32 v194,0,v194
v_cvt_pk_bf16_f32 v194,v192,v194
v_lshlrev_b32 v192,16,v194
v_and_b32 v194,0xffff0000,v194
v_add_f32 v194,0x3727c5ac,v194
v_cvt_pk_bf16_f32 v194,v194,v194
v_and_b32 v194,0xffff0000,v194
v_sqrt_f32 v194,v194
v_pk_add_f32 v[184:185],v[200:201],v[192:193] op_sel_hi:[1,0] neg_lo:[0,1] neg_hi:[0,1]
v_pk_add_f32 v[186:187],v[202:203],v[192:193] op_sel_hi:[1,0] neg_lo:[0,1] neg_hi:[0,1]
v_pk_add_f32 v[188:189],v[204:205],v[192:193] op_sel_hi:[1,0] neg_lo:[0,1] neg_hi:[0,1]
v_pk_add_f32 v[190:191],v[206:207],v[192:193] op_sel_hi:[1,0] neg_lo:[0,1] neg_hi:[0,1]
v_cvt_pk_bf16_f32 v194,v194,v194
v_and_b32 v194,0xffff0000,v194
v_rcp_f32 v194,v194
v_cvt_pk_bf16_f32 v172,v184,v185
v_cvt_pk_bf16_f32 v173,v186,v187
v_cvt_pk_bf16_f32 v174,v188,v189
v_cvt_pk_bf16_f32 v175,v190,v191
v_lshlrev_b32 v184,16,v172
v_and_b32 v185,0xffff0000,v172
v_lshlrev_b32 v186,16,v173
v_and_b32 v187,0xffff0000,v173
v_lshlrev_b32 v188,16,v174
v_and_b32 v189,0xffff0000,v174
v_lshlrev_b32 v190,16,v175
v_and_b32 v191,0xffff0000,v175
v_pk_mul_f32 v[184:185],v[184:185],v[194:195] op_sel_hi:[1,0]
v_pk_mul_f32 v[186:187],v[186:187],v[194:195] op_sel_hi:[1,0]
v_pk_mul_f32 v[188:189],v[188:189],v[194:195] op_sel_hi:[1,0]
v_pk_mul_f32 v[190:191],v[190:191],v[194:195] op_sel_hi:[1,0]
v_cvt_pk_bf16_f32 v172,v184,v185
v_cvt_pk_bf16_f32 v173,v186,v187
v_cvt_pk_bf16_f32 v174,v188,v189
v_cvt_pk_bf16_f32 v175,v190,v191
v_lshlrev_b32 v176,16,v172
v_and_b32 v177,0xffff0000,v172
v_lshlrev_b32 v178,16,v173
v_and_b32 v179,0xffff0000,v173
v_lshlrev_b32 v180,16,v174
v_and_b32 v181,0xffff0000,v174
v_lshlrev_b32 v182,16,v175
v_and_b32 v183,0xffff0000,v175
v_pk_add_f32 v[200:201],v[200:201],v[176:177]
v_pk_add_f32 v[202:203],v[202:203],v[178:179]
v_pk_add_f32 v[204:205],v[204:205],v[180:181]
v_pk_add_f32 v[206:207],v[206:207],v[182:183]
v_cvt_pk_bf16_f32 v160,v200,v201
v_cvt_pk_bf16_f32 v161,v202,v203
v_cvt_pk_bf16_f32 v162,v204,v205
v_cvt_pk_bf16_f32 v163,v206,v207
buffer_store_dwordx4 v[160:163],v0,s[8:11],s20 offen sc1
v_lshlrev_b32 v200,16,v160
v_and_b32 v201,0xffff0000,v160
v_lshlrev_b32 v202,16,v161
v_and_b32 v203,0xffff0000,v161
v_lshlrev_b32 v204,16,v162
v_and_b32 v205,0xffff0000,v162
v_lshlrev_b32 v206,16,v163
v_and_b32 v207,0xffff0000,v163
v_readfirstlane_b32 s78,v200
s_nop 1
v_pk_add_f32 v[184:185],v[200:201],s[78:79] op_sel_hi:[1,0] neg_lo:[0,1] neg_hi:[0,1]
v_pk_add_f32 v[186:187],v[202:203],s[78:79] op_sel_hi:[1,0] neg_lo:[0,1] neg_hi:[0,1]
v_pk_add_f32 v[188:189],v[204:205],s[78:79] op_sel_hi:[1,0] neg_lo:[0,1] neg_hi:[0,1]
v_pk_add_f32 v[190:191],v[206:207],s[78:79] op_sel_hi:[1,0] neg_lo:[0,1] neg_hi:[0,1]
v_pk_add_f32 v[192:193],v[184:185],v[186:187]
v_pk_mul_f32 v[194:195],v[184:185],v[184:185]
v_pk_add_f32 v[196:197],v[188:189],v[190:191]
v_pk_fma_f32 v[194:195],v[186:187],v[186:187],v[194:195]
v_pk_add_f32 v[192:193],v[192:193],v[196:197]
v_pk_fma_f32 v[194:195],v[188:189],v[188:189],v[194:195]
v_add_f32 v192,v192,v193
v_pk_fma_f32 v[194:195],v[190:191],v[190:191],v[194:195]
v_add_f32 v194,v194,v195
s_nop 1
v_permlane32_swap_b32 v192,v194
v_add_f32 v192,v192,v194
s_nop 1
v_add_f32_dpp v192,v192,v192 row_ror:8 row_mask:0xf bank_mask:0xf
s_nop 1
v_add_f32_dpp v192,v192,v192 row_ror:4 row_mask:0xf bank_mask:0xf
s_nop 1
v_add_f32_dpp v192,v192,v192 row_ror:2 row_mask:0xf bank_mask:0xf
s_nop 1
v_add_f32_dpp v192,v192,v192 row_ror:1 row_mask:0xf bank_mask:0xf
v_mov_b32 v194,v192
s_nop 1
v_permlane16_swap_b32 v192,v194
v_add_f32 v192,v192,v194
v_mul_f32 v192,0x3b000000,v192
v_mov_b32 v194,v192
s_nop 1
v_permlane32_swap_b32 v192,v194
v_fma_f32 v194,-v192,v192,v194
v_add_f32 v192,s78,v192
v_max_f32 v194,0,v194
v_cvt_pk_bf16_f32 v194,v192,v194
v_lshlrev_b32 v192,16,v194
v_and_b32 v194,0xffff0000,v194
v_add_f32 v194,0x3727c5ac,v194
v_cvt_pk_bf16_f32 v194,v194,v194
v_and_b32 v194,0xffff0000,v194
v_sqrt_f32 v194,v194
v_pk_add_f32 v[184:185],v[200:201],v[192:193] op_sel_hi:[1,0] neg_lo:[0,1] neg_hi:[0,1]
v_pk_add_f32 v[186:187],v[202:203],v[192:193] op_sel_hi:[1,0] neg_lo:[0,1] neg_hi:[0,1]
v_pk_add_f32 v[188:189],v[204:205],v[192:193] op_sel_hi:[1,0] neg_lo:[0,1] neg_hi:[0,1]
v_pk_add_f32 v[190:191],v[206:207],v[192:193] op_sel_hi:[1,0] neg_lo:[0,1] neg_hi:[0,1]
v_cvt_pk_bf16_f32 v194,v194,v194
v_and_b32 v194,0xffff0000,v194
v_rcp_f32 v194,v194
v_cvt_pk_bf16_f32 v164,v184,v185
v_cvt_pk_bf16_f32 v165,v186,v187
v_cvt_pk_bf16_f32 v166,v188,v189
v_cvt_pk_bf16_f32 v167,v190,v191
v_lshlrev_b32 v184,16,v164
v_and_b32 v185,0xffff0000,v164
v_lshlrev_b32 v186,16,v165
v_and_b32 v187,0xffff0000,v165
v_lshlrev_b32 v188,16,v166
v_and_b32 v189,0xffff0000,v166
v_lshlrev_b32 v190,16,v167
v_and_b32 v191,0xffff0000,v167
v_pk_mul_f32 v[184:185],v[184:185],v[194:195] op_sel_hi:[1,0]
v_pk_mul_f32 v[186:187],v[186:187],v[194:195] op_sel_hi:[1,0]
v_pk_mul_f32 v[188:189],v[188:189],v[194:195] op_sel_hi:[1,0]
v_pk_mul_f32 v[190:191],v[190:191],v[194:195] op_sel_hi:[1,0]
v_cvt_pk_bf16_f32 v164,v184,v185
v_cvt_pk_bf16_f32 v165,v186,v187
v_cvt_pk_bf16_f32 v166,v188,v189
v_cvt_pk_bf16_f32 v167,v190,v191
s_add_u32 s20,s19,2097152
buffer_store_dwordx4 v[164:167],v0,s[8:11],s20 offen sc1
v_mov_b32 v20,1
s_lshl_b32 s73,s51,13
s_lshl2_add_u32 s73,s68,s73
s_add_u32 s73,s73,10487552
s_branch L_aa_84
L_ar_113:
ds_read_b128 v[160:163],v23
ds_read_b128 v[164:167],v23 offset:16
v_lshlrev_b32 v200,16,v224
v_and_b32 v201,0xffff0000,v224
v_lshlrev_b32 v202,16,v225
v_and_b32 v203,0xffff0000,v225
v_lshlrev_b32 v204,16,v226
v_and_b32 v205,0xffff0000,v226
v_lshlrev_b32 v206,16,v227
v_and_b32 v207,0xffff0000,v227
s_lshl_b32 s18,s51,5
s_add_u32 s18,s18,s68
s_lshl_b32 s19,s18,10
s_add_u32 s20,s19,4194304
s_waitcnt lgkmcnt(0)
v_cvt_pk_bf16_f32 v168,v160,v161
v_cvt_pk_bf16_f32 v169,v162,v163
v_cvt_pk_bf16_f32 v170,v164,v165
v_cvt_pk_bf16_f32 v171,v166,v167
v_lshlrev_b32 v160,16,v168
v_and_b32 v161,0xffff0000,v168
v_lshlrev_b32 v162,16,v169
v_and_b32 v163,0xffff0000,v169
v_lshlrev_b32 v164,16,v170
v_and_b32 v165,0xffff0000,v170
v_lshlrev_b32 v166,16,v171
v_and_b32 v167,0xffff0000,v171
v_pk_add_f32 v[200:201],v[200:201],v[160:161]
v_pk_add_f32 v[202:203],v[202:203],v[162:163]
v_pk_add_f32 v[204:205],v[204:205],v[164:165]
v_pk_add_f32 v[206:207],v[206:207],v[166:167]
v_cvt_pk_bf16_f32 v168,v200,v201
v_cvt_pk_bf16_f32 v169,v202,v203
v_cvt_pk_bf16_f32 v170,v204,v205
v_cvt_pk_bf16_f32 v171,v206,v207
buffer_store_dwordx4 v[168:171],v0,s[8:11],s20 offen sc1
v_lshlrev_b32 v200,16,v168
v_and_b32 v201,0xffff0000,v168
v_lshlrev_b32 v202,16,v169
v_and_b32 v203,0xffff0000,v169
v_lshlrev_b32 v204,16,v170
v_and_b32 v205,0xffff0000,v170
v_lshlrev_b32 v206,16,v171
v_and_b32 v207,0xffff0000,v171
v_readfirstlane_b32 s78,v200
s_nop 1
v_pk_add_f32 v[184:185],v[200:201],s[78:79] op_sel_hi:[1,0] neg_lo:[0,1] neg_hi:[0,1]
v_pk_add_f32 v[186:187],v[202:203],s[78:79] op_sel_hi:[1,0] neg_lo:[0,1] neg_hi:[0,1]
v_pk_add_f32 v[188:189],v[204:205],s[78:79] op_sel_hi:[1,0] neg_lo:[0,1] neg_hi:[0,1]
v_pk_add_f32 v[190:191],v[206:207],s[78:79] op_sel_hi:[1,0] neg_lo:[0,1] neg_hi:[0,1]
v_pk_add_f32 v[192:193],v[184:185],v[186:187]
v_pk_mul_f32 v[194:195],v[184:185],v[184:185]
v_pk_add_f32 v[196:197],v[188:189],v[190:191]
v_pk_fma_f32 v[194:195],v[186:187],v[186:187],v[194:195]
v_pk_add_f32 v[192:193],v[192:193],v[196:197]
v_pk_fma_f32 v[194:195],v[188:189],v[188:189],v[194:195]
v_add_f32 v192,v192,v193
v_pk_fma_f32 v[194:195],v[190:191],v[190:191],v[194:195]
v_add_f32 v194,v194,v195
s_nop 1
v_permlane32_swap_b32 v192,v194
v_add_f32 v192,v192,v194
s_nop 1
v_add_f32_dpp v192,v192,v192 row_ror:8 row_mask:0xf bank_mask:0xf
s_nop 1
v_add_f32_dpp v192,v192,v192 row_ror:4 row_mask:0xf bank_mask:0xf
s_nop 1
v_add_f32_dpp v192,v192,v192 row_ror:2 row_mask:0xf bank_mask:0xf
s_nop 1
v_add_f32_dpp v192,v192,v192 row_ror:1 row_mask:0xf bank_mask:0xf
v_mov_b32 v194,v192
s_nop 1
v_permlane16_swap_b32 v192,v194
v_add_f32 v192,v192,v194
v_mul_f32 v192,0x3b000000,v192
v_mov_b32 v194,v192
s_nop 1
v_permlane32_swap_b32 v192,v194
v_fma_f32 v194,-v192,v192,v194
v_add_f32 v192,s78,v192
v_max_f32 v194,0,v194
v_cvt_pk_bf16_f32 v194,v192,v194
v_lshlrev_b32 v192,16,v194
v_and_b32 v194,0xffff0000,v194
v_add_f32 v194,0x3727c5ac,v194
v_cvt_pk_bf16_f32 v194,v194,v194
v_and_b32 v194,0xffff0000,v194
v_sqrt_f32 v194,v194
v_pk_add_f32 v[184:185],v[200:201],v[192:193] op_sel_hi:[1,0] neg_lo:[0,1] neg_hi:[0,1]
v_pk_add_f32 v[186:187],v[202:203],v[192:193] op_sel_hi:[1,0] neg_lo:[0,1] neg_hi:[0,1]
v_pk_add_f32 v[188:189],v[204:205],v[192:193] op_sel_hi:[1,0] neg_lo:[0,1] neg_hi:[0,1]
v_pk_add_f32 v[190:191],v[206:207],v[192:193] op_sel_hi:[1,0] neg_lo:[0,1] neg_hi:[0,1]
v_cvt_pk_bf16_f32 v194,v194,v194
v_and_b32 v194,0xffff0000,v194
v_rcp_f32 v194,v194
v_cvt_pk_bf16_f32 v172,v184,v185
v_cvt_pk_bf16_f32 v173,v186,v187
v_cvt_pk_bf16_f32 v174,v188,v189
v_cvt_pk_bf16_f32 v175,v190,v191
v_lshlrev_b32 v184,16,v172
v_and_b32 v185,0xffff0000,v172
v_lshlrev_b32 v186,16,v173
v_and_b32 v187,0xffff0000,v173
v_lshlrev_b32 v188,16,v174
v_and_b32 v189,0xffff0000,v174
v_lshlrev_b32 v190,16,v175
v_and_b32 v191,0xffff0000,v175
v_pk_mul_f32 v[184:185],v[184:185],v[194:195] op_sel_hi:[1,0]
v_pk_mul_f32 v[186:187],v[186:187],v[194:195] op_sel_hi:[1,0]
v_pk_mul_f32 v[188:189],v[188:189],v[194:195] op_sel_hi:[1,0]
v_pk_mul_f32 v[190:191],v[190:191],v[194:195] op_sel_hi:[1,0]
v_cvt_pk_bf16_f32 v172,v184,v185
v_cvt_pk_bf16_f32 v173,v186,v187
v_cvt_pk_bf16_f32 v174,v188,v189
v_cvt_pk_bf16_f32 v175,v190,v191
v_lshlrev_b32 v176,16,v172
v_and_b32 v177,0xffff0000,v172
v_lshlrev_b32 v178,16,v173
v_and_b32 v179,0xffff0000,v173
v_lshlrev_b32 v180,16,v174
v_and_b32 v181,0xffff0000,v174
v_lshlrev_b32 v182,16,v175
v_and_b32 v183,0xffff0000,v175
v_pk_mul_f32 v[236:237],v[176:177],v[228:229]
v_pk_fma_f32 v[236:237],v[178:179],v[230:231],v[236:237]
v_pk_fma_f32 v[236:237],v[180:181],v[232:233],v[236:237]
v_pk_fma_f32 v[236:237],v[182:183],v[234:235],v[236:237]
v_add_f32 v236,v236,v237
s_nop 1
v_add_f32_dpp v236,v236,v236 row_ror:8 row_mask:0xf bank_mask:0xf
s_nop 1
v_add_f32_dpp v236,v236,v236 row_ror:4 row_mask:0xf bank_mask:0xf
s_nop 1
v_add_f32_dpp v236,v236,v236 row_ror:2 row_mask:0xf bank_mask:0xf
s_nop 1
v_add_f32_dpp v236,v236,v236 row_ror:1 row_mask:0xf bank_mask:0xf
v_mov_b32 v237,v236
s_nop 1
v_permlane16_swap_b32 v236,v237
v_add_f32 v236,v236,v237
v_mov_b32 v237,v236
s_nop 1
v_permlane32_swap_b32 v236,v237
v_add_f32 v236,v236,v237
v_cvt_pk_bf16_f32 v236,v236,v236
v_and_b32 v236,0xffff0000,v236
v_ashrrev_i32 v237,31,v236
v_or_b32 v237,0x80000000,v237
v_xor_b32 v236,v236,v237
v_and_b32 v236,0xffff0000,v236
s_sub_u32 s20,4095,s18
v_or_b32 v20,s20,v236
s_lshl_b32 s20,s51,13
s_lshl2_add_u32 s20,s68,s20
s_add_u32 s20,s20,10485760
buffer_store_dword v20,v254,s[8:11],s20 offen sc1
s_branch L_aa_84
L_ar_114:
s_bitcmp1_b32 s46,0
s_cbranch_scc1 L_aa_84
ds_read_b128 v[160:163],v23
ds_read_b128 v[164:167],v23 offset:16
v_lshlrev_b32 v200,16,v224
v_and_b32 v201,0xffff0000,v224
v_lshlrev_b32 v202,16,v225
v_and_b32 v203,0xffff0000,v225
v_lshlrev_b32 v204,16,v226
v_and_b32 v205,0xffff0000,v226
v_lshlrev_b32 v206,16,v227
v_and_b32 v207,0xffff0000,v227
v_readfirstlane_b32 s22,v246
s_cmp_eq_u32 s22,0
s_cbranch_scc1 L_ag_115
L_agb_116:
s_lshl_b32 s18,s51,5
s_add_u32 s18,s18,s68
s_lshl_b32 s19,s18,10
s_add_u32 s20,s19,6291456
s_waitcnt lgkmcnt(0)
v_cvt_pk_bf16_f32 v168,v160,v161
v_cvt_pk_bf16_f32 v169,v162,v163
v_cvt_pk_bf16_f32 v170,v164,v165
v_cvt_pk_bf16_f32 v171,v166,v167
v_lshlrev_b32 v160,16,v168
v_and_b32 v161,0xffff0000,v168
v_lshlrev_b32 v162,16,v169
v_and_b32 v163,0xffff0000,v169
v_lshlrev_b32 v164,16,v170
v_and_b32 v165,0xffff0000,v170
v_lshlrev_b32 v166,16,v171
v_and_b32 v167,0xffff0000,v171
v_pk_add_f32 v[200:201],v[200:201],v[160:161]
v_pk_add_f32 v[202:203],v[202:203],v[162:163]
v_pk_add_f32 v[204:205],v[204:205],v[164:165]
v_pk_add_f32 v[206:207],v[206:207],v[166:167]
v_cvt_pk_bf16_f32 v168,v200,v201
v_cvt_pk_bf16_f32 v169,v202,v203
v_cvt_pk_bf16_f32 v170,v204,v205
v_cvt_pk_bf16_f32 v171,v206,v207
buffer_store_dwordx4 v[168:171],v0,s[8:11],s20 offen sc1
v_lshlrev_b32 v200,16,v168
v_and_b32 v201,0xffff0000,v168
v_lshlrev_b32 v202,16,v169
v_and_b32 v203,0xffff0000,v169
v_lshlrev_b32 v204,16,v170
v_and_b32 v205,0xffff0000,v170
v_lshlrev_b32 v206,16,v171
v_and_b32 v207,0xffff0000,v171
v_readfirstlane_b32 s78,v200
s_nop 1
v_pk_add_f32 v[184:185],v[200:201],s[78:79] op_sel_hi:[1,0] neg_lo:[0,1] neg_hi:[0,1]
v_pk_add_f32 v[186:187],v[202:203],s[78:79] op_sel_hi:[1,0] neg_lo:[0,1] neg_hi:[0,1]
v_pk_add_f32 v[188:189],v[204:205],s[78:79] op_sel_hi:[1,0] neg_lo:[0,1] neg_hi:[0,1]
v_pk_add_f32 v[190:191],v[206:207],s[78:79] op_sel_hi:[1,0] neg_lo:[0,1] neg_hi:[0,1]
v_pk_add_f32 v[192:193],v[184:185],v[186:187]
v_pk_mul_f32 v[194:195],v[184:185],v[184:185]
v_pk_add_f32 v[196:197],v[188:189],v[190:191]
v_pk_fma_f32 v[194:195],v[186:187],v[186:187],v[194:195]
v_pk_add_f32 v[192:193],v[192:193],v[196:197]
v_pk_fma_f32 v[194:195],v[188:189],v[188:189],v[194:195]
v_add_f32 v192,v192,v193
v_pk_fma_f32 v[194:195],v[190:191],v[190:191],v[194:195]
v_add_f32 v194,v194,v195
s_nop 1
v_permlane32_swap_b32 v192,v194
v_add_f32 v192,v192,v194
s_nop 1
v_add_f32_dpp v192,v192,v192 row_ror:8 row_mask:0xf bank_mask:0xf
s_nop 1
v_add_f32_dpp v192,v192,v192 row_ror:4 row_mask:0xf bank_mask:0xf
s_nop 1
v_add_f32_dpp v192,v192,v192 row_ror:2 row_mask:0xf bank_mask:0xf
s_nop 1
v_add_f32_dpp v192,v192,v192 row_ror:1 row_mask:0xf bank_mask:0xf
v_mov_b32 v194,v192
s_nop 1
v_permlane16_swap_b32 v192,v194
v_add_f32 v192,v192,v194
v_mul_f32 v192,0x3b000000,v192
v_mov_b32 v194,v192
s_nop 1
v_permlane32_swap_b32 v192,v194
v_fma_f32 v194,-v192,v192,v194
v_add_f32 v192,s78,v192
v_max_f32 v194,0,v194
v_cvt_pk_bf16_f32 v194,v192,v194
v_lshlrev_b32 v192,16,v194
v_and_b32 v194,0xffff0000,v194
v_add_f32 v194,0x3727c5ac,v194
v_cvt_pk_bf16_f32 v194,v194,v194
v_and_b32 v194,0xffff0000,v194
v_sqrt_f32 v194,v194
v_pk_add_f32 v[184:185],v[200:201],v[192:193] op_sel_hi:[1,0] neg_lo:[0,1] neg_hi:[0,1]
v_pk_add_f32 v[186:187],v[202:203],v[192:193] op_sel_hi:[1,0] neg_lo:[0,1] neg_hi:[0,1]
v_pk_add_f32 v[188:189],v[204:205],v[192:193] op_sel_hi:[1,0] neg_lo:[0,1] neg_hi:[0,1]
v_pk_add_f32 v[190:191],v[206:207],v[192:193] op_sel_hi:[1,0] neg_lo:[0,1] neg_hi:[0,1]
v_cvt_pk_bf16_f32 v194,v194,v194
v_and_b32 v194,0xffff0000,v194
v_rcp_f32 v194,v194
v_cvt_pk_bf16_f32 v172,v184,v185
v_cvt_pk_bf16_f32 v173,v186,v187
v_cvt_pk_bf16_f32 v174,v188,v189
v_cvt_pk_bf16_f32 v175,v190,v191
v_lshlrev_b32 v184,16,v172
v_and_b32 v185,0xffff0000,v172
v_lshlrev_b32 v186,16,v173
v_and_b32 v187,0xffff0000,v173
v_lshlrev_b32 v188,16,v174
v_and_b32 v189,0xffff0000,v174
v_lshlrev_b32 v190,16,v175
v_and_b32 v191,0xffff0000,v175
v_pk_mul_f32 v[184:185],v[184:185],v[194:195] op_sel_hi:[1,0]
v_pk_mul_f32 v[186:187],v[186:187],v[194:195] op_sel_hi:[1,0]
v_pk_mul_f32 v[188:189],v[188:189],v[194:195] op_sel_hi:[1,0]
v_pk_mul_f32 v[190:191],v[190:191],v[194:195] op_sel_hi:[1,0]
v_cvt_pk_bf16_f32 v172,v184,v185
v_cvt_pk_bf16_f32 v173,v186,v187
v_cvt_pk_bf16_f32 v174,v188,v189
v_cvt_pk_bf16_f32 v175,v190,v191
v_lshlrev_b32 v176,16,v172
v_and_b32 v177,0xffff0000,v172
v_lshlrev_b32 v178,16,v173
v_and_b32 v179,0xffff0000,v173
v_lshlrev_b32 v180,16,v174
v_and_b32 v181,0xffff0000,v174
v_lshlrev_b32 v182,16,v175
v_and_b32 v183,0xffff0000,v175
v_pk_add_f32 v[200:201],v[200:201],v[176:177]
v_pk_add_f32 v[202:203],v[202:203],v[178:179]
v_pk_add_f32 v[204:205],v[204:205],v[180:181]
v_pk_add_f32 v[206:207],v[206:207],v[182:183]
v_cvt_pk_bf16_f32 v160,v200,v201
v_cvt_pk_bf16_f32 v161,v202,v203
v_cvt_pk_bf16_f32 v162,v204,v205
v_cvt_pk_bf16_f32 v163,v206,v207
buffer_store_dwordx4 v[160:163],v0,s[12:15],s19 offen sc1
v_pk_mul_f32 v[236:237],v[176:177],v[228:229]
v_pk_fma_f32 v[236:237],v[178:179],v[230:231],v[236:237]
v_pk_fma_f32 v[236:237],v[180:181],v[232:233],v[236:237]
v_pk_fma_f32 v[236:237],v[182:183],v[234:235],v[236:237]
v_add_f32 v236,v236,v237
s_nop 1
v_add_f32_dpp v236,v236,v236 row_ror:8 row_mask:0xf bank_mask:0xf
s_nop 1
v_add_f32_dpp v236,v236,v236 row_ror:4 row_mask:0xf bank_mask:0xf
s_nop 1
v_add_f32_dpp v236,v236,v236 row_ror:2 row_mask:0xf bank_mask:0xf
s_nop 1
v_add_f32_dpp v236,v236,v236 row_ror:1 row_mask:0xf bank_mask:0xf
v_mov_b32 v237,v236
s_nop 1
v_permlane16_swap_b32 v236,v237
v_add_f32 v236,v236,v237
v_mov_b32 v237,v236
s_nop 1
v_permlane32_swap_b32 v236,v237
v_add_f32 v236,v236,v237
v_cvt_pk_bf16_f32 v236,v236,v236
v_and_b32 v236,0xffff0000,v236
v_ashrrev_i32 v237,31,v236
v_or_b32 v237,0x80000000,v237
v_xor_b32 v236,v236,v237
v_and_b32 v236,0xffff0000,v236
s_sub_u32 s20,4095,s18
v_or_b32 v20,s20,v236
s_lshl_b32 s73,s51,13
s_lshl2_add_u32 s73,s68,s73
s_add_u32 s73,s73,10485760
s_add_u32 s73,s73,s86
L_aa_84:
s_cmp_eq_u32 s27,1
s_cbranch_scc1 L_ad_117
s_cmp_eq_u32 s27,0
s_cbranch_scc1 L_aa_85
s_cmp_ge_u32 s77,64
s_cbranch_scc1 L_aa_88
L_aa_86:
s_waitcnt vmcnt(0)
buffer_store_dword v20,off,s[8:11],s73 sc1
s_mov_b32 s73,0x80000000
v_mov_b32 v18,0
s_mov_b32 s27,0
L_aw_118:
v_cmp_eq_u32 vcc,0,v18
s_cbranch_vccz L_awd_119
buffer_load_dword v18,v19,s[8:11],0 offen sc1
s_sub_u32 s49,s49,1
s_cbranch_scc1 L_abort
s_waitcnt vmcnt(0)
s_branch L_aw_118
L_awd_119:
s_mov_b32 s64,s70
s_mov_b32 s65,s71
s_add_u32 s64,s64,s28
s_add_u32 s65,s65,s29
s_xor_b32 s58,s67,s40
s_xor_b32 s57,s67,s41
s_add_u32 m0,s58,0
s_nop 0
buffer_load_dwordx4 v0,s[8:11],s64 offen offset:0 sc1 lds
buffer_load_dwordx4 v0,s[8:11],s64 offen offset:1024 sc1 lds
buffer_load_dwordx4 v0,s[8:11],s64 offen offset:2048 sc1 lds
buffer_load_dwordx4 v0,s[8:11],s64 offen offset:3072 sc1 lds
s_add_u32 m0,s58,4096
s_add_u32 s64,s64,4096
buffer_load_dwordx4 v0,s[8:11],s64 offen offset:0 sc1 lds
buffer_load_dwordx4 v0,s[8:11],s64 offen offset:1024 sc1 lds
buffer_load_dwordx4 v0,s[8:11],s64 offen offset:2048 sc1 lds
buffer_load_dwordx4 v0,s[8:11],s64 offen offset:3072 sc1 lds
s_add_u32 m0,s58,8192
s_add_u32 s64,s64,4096
buffer_load_dwordx4 v0,s[8:11],s64 offen offset:0 sc1 lds
buffer_load_dwordx4 v0,s[8:11],s64 offen offset:1024 sc1 lds
buffer_load_dwordx4 v0,s[8:11],s64 offen offset:2048 sc1 lds
buffer_load_dwordx4 v0,s[8:11],s64 offen offset:3072 sc1 lds
s_add_u32 m0,s57,24576
s_nop 0
buffer_load_dwordx4 v0,s[8:11],s65 offen offset:0 sc1 lds
buffer_load_dwordx4 v0,s[8:11],s65 offen offset:1024 sc1 lds
v_lshrrev_b32 v244,4,v1
s_sub_u32 s56,s77,8
v_add_u32 v244,s56,v244
v_max_i32 v244,0,v244
v_lshl_add_u32 v244,v244,13,v21
buffer_load_dwordx2 v[242:243],v244,s[8:11],0 offen sc1
s_waitcnt vmcnt(0) lgkmcnt(0)
s_barrier
s_xor_b32 s67,s67,65536
s_and_b32 s56,s50,2048
s_lshl_b32 s56,s56,4
s_add_u32 s56,s56,s67
v_add_u32 v2,s56,v0
v_add_u32 v239,s56,v253
s_and_b32 s56,s50,1024
s_lshl_b32 s56,s56,2
v_add_u32 v238,s56,v2
s_mov_b32 s76,s71
s_mov_b32 s53,s77
ds_read_b128 v[24:27],v238 offset:16384
ds_read_b128 v[40:43],v2 offset:0
ds_read_b128 v[56:59],v2 offset:4096
ds_read_b128 v[28:31],v238 offset:17408
ds_read_b128 v[44:47],v2 offset:1024
ds_read_b128 v[60:63],v2 offset:5120
ds_read_b128 v[32:35],v238 offset:18432
ds_read_b128 v[48:51],v2 offset:2048
ds_read_b128 v[64:67],v2 offset:6144
ds_read_b128 v[36:39],v238 offset:19456
ds_read_b128 v[52:55],v2 offset:3072
ds_read_b128 v[68:71],v2 offset:7168
s_waitcnt lgkmcnt(9)
v_mfma_f32_16x16x32_bf16 v[128:131],v[40:43],v[24:27],v[8:11]
ds_read_b128 v[72:75],v2 offset:24576
v_mfma_f32_16x16x32_bf16 v[132:135],v[56:59],v[24:27],v[12:15]
ds_read_b128 v[76:79],v2 offset:25600
s_waitcnt lgkmcnt(8)
v_mfma_f32_16x16x32_bf16 v[128:131],v[44:47],v[28:31],v[128:131]
ds_read_b128 v[80:83],v2 offset:26624
v_mfma_f32_16x16x32_bf16 v[132:135],v[60:63],v[28:31],v[132:135]
ds_read_b128 v[84:87],v2 offset:27648
s_waitcnt lgkmcnt(7)
v_mfma_f32_16x16x32_bf16 v[128:131],v[48:51],v[32:35],v[128:131]
ds_read_b64 v[120:121],v239 offset:24576
v_mfma_f32_16x16x32_bf16 v[132:135],v[64:67],v[32:35],v[132:135]
ds_read_b64 v[122:123],v239 offset:25600
s_waitcnt lgkmcnt(6)
v_mfma_f32_16x16x32_bf16 v[128:131],v[52:55],v[36:39],v[128:131]
ds_read_b64 v[124:125],v239 offset:26624
v_mfma_f32_16x16x32_bf16 v[132:135],v[68:71],v[36:39],v[132:135]
ds_read_b64 v[126:127],v239 offset:27648
s_waitcnt lgkmcnt(4)
v_mfma_f32_16x16x32_bf16 v[136:139],v[72:75],v[24:27],0
ds_read_b128 v[88:91],v2 offset:8192
ds_read_b128 v[92:95],v2 offset:9216
v_mfma_f32_16x16x32_bf16 v[136:139],v[76:79],v[28:31],v[136:139]
ds_read_b128 v[96:99],v2 offset:10240
ds_read_b128 v[100:103],v2 offset:11264
v_mfma_f32_16x16x32_bf16 v[136:139],v[80:83],v[32:35],v[136:139]
ds_read_b128 v[104:107],v2 offset:12288
ds_read_b128 v[108:111],v2 offset:13312
v_mfma_f32_16x16x32_bf16 v[136:139],v[84:87],v[36:39],v[136:139]
ds_read_b128 v[112:115],v2 offset:14336
ds_read_b128 v[116:119],v2 offset:15360
s_waitcnt lgkmcnt(0)
s_cmp_eq_u32 s30,0
s_cbranch_scc1 L_aa_87
s_cmp_lg_u32 s86,1536
s_cbranch_scc1 L_ae_120
s_mov_b32 s77,s35
s_mov_b32 s30,0
s_lshl_b32 s56,s77,5
s_add_u32 s56,s56,s68
s_mul_i32 s70,s56,24576
s_lshl_b32 s71,s56,12
s_lshl_b32 s59,s77,13
s_lshl2_add_u32 s59,s68,s59
s_add_u32 s59,s59,10485760
s_buffer_load_dword s32,s[8:11],s59
s_mov_b32 s33,1
s_add_u32 s70,s70,100663296
s_add_u32 s71,s71,41943040
v_mov_b32 v19,s59
s_branch L_af_121
L_ae_120:
s_ff1_i32_b64 s77,s[84:85]
s_bitset0_b64 s[84:85],s77
s_min_u32 s77,s77,64
s_lshr_b32 s61,s55,5
s_lshl_b32 s56,s77,5
s_add_u32 s56,s56,s68
s_mul_i32 s70,s56,24576
s_lshl_b32 s71,s56,12
s_lshl_b32 s59,s77,13
s_lshl2_add_u32 s59,s68,s59
s_add_u32 s59,s59,10486144
s_cmp_lt_u32 s77,s61
s_cselect_b32 s57,0,16777216
s_mov_b32 s60,s59
s_buffer_load_dword s33,s[8:11],s60
s_add_u32 s71,s71,s57
s_add_u32 s71,s71,58720256
s_cmp_eq_u32 s77,s61
s_cselect_b32 s57,50331648,0
s_cselect_b32 s58,1536,0
s_add_u32 s59,s59,s58
s_buffer_load_dword s32,s[8:11],s59
s_add_u32 s70,s70,s57
s_add_u32 s70,s70,150994944
v_mov_b32 v19,s59
v_writelane_b32 v19,s60,1
L_af_121:
v_max3_u32 v238,v72,v73,v74
v_max3_u32 v238,v74,v75,v238
v_max3_u32 v238,v76,v77,v238
v_max3_u32 v238,v78,v79,v238
v_max3_u32 v238,v80,v81,v238
v_max3_u32 v238,v82,v83,v238
v_max3_u32 v238,v84,v85,v238
v_max3_u32 v238,v86,v87,v238
v_max3_u32 v238,v120,v121,v238
v_max3_u32 v238,v122,v123,v238
v_max3_u32 v238,v124,v125,v238
v_max3_u32 v238,v126,v127,v238
v_cmp_eq_u32 vcc,-1,v238
s_cbranch_vccnz L_ac_122
L_acb_123:
v_max3_f32 v238,v128,v129,v130
v_max3_f32 v239,v131,v132,v133
v_max3_f32 v238,v134,v135,v238
v_max3_f32 v239,v138,v139,v239
v_max_f32 v238,v238,v239
v_max_f32 v239,v238,v239
v_pk_mul_f32 v[128:129],v[128:129],v[152:153] op_sel_hi:[1,0]
v_pk_mul_f32 v[130:131],v[130:131],v[152:153] op_sel_hi:[1,0]
v_permlane16_swap_b32 v238,v239
v_max_f32 v238,v238,v239
v_max_f32 v239,v238,v239
v_pk_mul_f32 v[132:133],v[132:133],v[152:153] op_sel_hi:[1,0]
v_pk_mul_f32 v[134:135],v[134:135],v[152:153] op_sel_hi:[1,0]
v_permlane32_swap_b32 v238,v239
v_max_f32 v238,v238,v239
v_mul_f32 v238,v152,v238
v_pk_mul_f32 v[138:139],v[138:139],v[152:153] op_sel_hi:[1,0]
v_pk_add_f32 v[128:129],v[128:129],v[238:239] op_sel_hi:[1,0] neg_lo:[0,1] neg_hi:[0,1]
v_pk_add_f32 v[130:131],v[130:131],v[238:239] op_sel_hi:[1,0] neg_lo:[0,1] neg_hi:[0,1]
v_pk_add_f32 v[132:133],v[132:133],v[238:239] op_sel_hi:[1,0] neg_lo:[0,1] neg_hi:[0,1]
v_pk_add_f32 v[134:135],v[134:135],v[238:239] op_sel_hi:[1,0] neg_lo:[0,1] neg_hi:[0,1]
v_pk_add_f32 v[138:139],v[138:139],v[238:239] op_sel_hi:[1,0] neg_lo:[0,1] neg_hi:[0,1]
v_exp_f32 v128,v128
v_exp_f32 v129,v129
v_exp_f32 v130,v130
v_exp_f32 v131,v131
v_exp_f32 v132,v132
v_exp_f32 v133,v133
v_exp_f32 v134,v134
v_exp_f32 v135,v135
v_exp_f32 v138,v138
v_exp_f32 v139,v139
v_pk_add_f32 v[148:149],v[128:129],v[130:131]
v_pk_add_f32 v[150:151],v[132:133],v[134:135]
v_pk_add_f32 v[148:149],v[148:149],v[138:139]
v_pk_add_f32 v[148:149],v[148:149],v[150:151]
v_add_f32 v150,v148,v149
v_add_f32 v151,v148,v149
s_nop 1
v_permlane16_swap_b32 v150,v151
v_add_f32 v148,v150,v151
v_add_f32 v149,v150,v151
s_nop 1
v_permlane32_swap_b32 v148,v149
v_add_f32 v148,v148,v149
v_rcp_f32 v148,v148
s_nop 0
v_pk_mul_f32 v[138:139],v[138:139],v[148:149] op_sel_hi:[1,0]
v_pk_mul_f32 v[128:129],v[128:129],v[148:149] op_sel_hi:[1,0]
v_pk_mul_f32 v[130:131],v[130:131],v[148:149] op_sel_hi:[1,0]
v_pk_mul_f32 v[132:133],v[132:133],v[148:149] op_sel_hi:[1,0]
v_pk_mul_f32 v[134:135],v[134:135],v[148:149] op_sel_hi:[1,0]
v_cvt_pk_bf16_f32 v144,v138,v139
v_cvt_pk_bf16_f32 v147,v138,v139
s_nop 0
v_mfma_f32_16x16x16_bf16 v[24:27],v[120:121],v[144:145],0
v_cvt_pk_bf16_f32 v140,v128,v129
v_mfma_f32_16x16x16_bf16 v[28:31],v[120:121],v[146:147],0
v_cvt_pk_bf16_f32 v141,v130,v131
v_mfma_f32_16x16x16_bf16 v[32:35],v[122:123],v[144:145],0
v_cvt_pk_bf16_f32 v142,v132,v133
v_mfma_f32_16x16x16_bf16 v[36:39],v[122:123],v[146:147],0
v_cvt_pk_bf16_f32 v143,v134,v135
v_mfma_f32_16x16x16_bf16 v[40:43],v[124:125],v[144:145],0
v_mfma_f32_16x16x16_bf16 v[44:47],v[124:125],v[146:147],0
v_mfma_f32_16x16x16_bf16 v[48:51],v[126:127],v[144:145],0
v_mfma_f32_16x16x16_bf16 v[52:55],v[126:127],v[146:147],0
v_mfma_f32_16x16x32_bf16 v[24:27],v[88:91],v[140:143],v[24:27]
v_mfma_f32_16x16x32_bf16 v[28:31],v[92:95],v[140:143],v[28:31]
v_mfma_f32_16x16x32_bf16 v[32:35],v[96:99],v[140:143],v[32:35]
v_mfma_f32_16x16x32_bf16 v[36:39],v[100:103],v[140:143],v[36:39]
v_cvt_pk_bf16_f32 v72,v24,v28
v_cvt_pk_bf16_f32 v73,v25,v29
v_mfma_f32_16x16x32_bf16 v[40:43],v[104:107],v[140:143],v[40:43]
v_cvt_pk_bf16_f32 v74,v26,v30
v_cvt_pk_bf16_f32 v75,v27,v31
v_mfma_f32_16x16x32_bf16 v[44:47],v[108:111],v[140:143],v[44:47]
ds_write_b128 v3,v[72:75] offset:0
v_cvt_pk_bf16_f32 v76,v32,v36
v_cvt_pk_bf16_f32 v77,v33,v37
v_mfma_f32_16x16x32_bf16 v[48:51],v[112:115],v[140:143],v[48:51]
v_cvt_pk_bf16_f32 v78,v34,v38
v_cvt_pk_bf16_f32 v79,v35,v39
v_mfma_f32_16x16x32_bf16 v[52:55],v[116:119],v[140:143],v[52:55]
ds_write_b128 v3,v[76:79] offset:1024
v_cvt_pk_bf16_f32 v80,v40,v44
v_cvt_pk_bf16_f32 v81,v41,v45
v_cvt_pk_bf16_f32 v82,v42,v46
v_cvt_pk_bf16_f32 v83,v43,v47
ds_write_b128 v3,v[80:83] offset:2048
s_nop 1
v_cvt_pk_bf16_f32 v84,v48,v52
v_cvt_pk_bf16_f32 v85,v49,v53
v_cvt_pk_bf16_f32 v86,v50,v54
v_cvt_pk_bf16_f32 v87,v51,v55
ds_write_b128 v3,v[84:87] offset:3072
s_waitcnt lgkmcnt(0)
s_barrier
L_ad_117:
s_mov_b32 s51,s53
s_mov_b32 s31,1
s_branch L_aa_79
L_aa_85:
s_waitcnt vmcnt(0)
buffer_store_dword v20,off,s[8:11],s73 sc1
s_mov_b32 s73,0x80000000
L_aa_87:
s_mov_b32 s51,s53
s_mov_b32 s31,0
s_add_u32 s35,s53,4
s_cmp_lt_u32 s53,5
s_cbranch_scc1 L_ab_124
s_cmp_ge_u32 s53,62
s_cbranch_scc1 L_am_126
L_aw_127:
v_min_u32 v239,v242,v243
v_cmp_eq_u32 vcc,0,v239
s_cbranch_vccz L_awd_128
s_sleep 4
buffer_load_dwordx2 v[242:243],v244,s[8:11],0 offen sc1
s_sub_u32 s49,s49,1
s_cbranch_scc1 L_abort
s_waitcnt vmcnt(0)
s_branch L_aw_127
L_awd_128:
v_max_u32 v242,v242,v243
s_nop 1
v_max_u32_dpp v242,v242,v242 row_ror:8 row_mask:0xf bank_mask:0xf
s_nop 1
v_max_u32_dpp v242,v242,v242 row_ror:4 row_mask:0xf bank_mask:0xf
s_nop 1
v_max_u32_dpp v242,v242,v242 row_ror:2 row_mask:0xf bank_mask:0xf
s_nop 1
v_max_u32_dpp v242,v242,v242 row_ror:1 row_mask:0xf bank_mask:0xf
v_mov_b32 v243,v242
s_nop 1
v_permlane16_swap_b32 v242,v243
v_max_u32 v242,v242,v243
v_mov_b32 v243,v242
s_nop 1
v_permlane32_swap_b32 v242,v243
v_max_u32 v242,v242,v243
s_nop 0
v_readfirstlane_b32 s56,v242
v_readlane_b32 s57,v255,s53
s_max_u32 s75,s75,s56
s_bitcmp0_b64 s[42:43],s53
s_cbranch_scc1 L_ab_124
s_mov_b32 s77,s36
s_and_b32 s55,s75,0x7ff
s_sub_u32 s55,2047,s55
s_cmp_lt_u32 s75,s57
s_cselect_b32 s55,4095,s55
s_lshr_b32 s61,s55,5
s_mov_b32 s30,1
s_lshl_b32 s56,s77,5
s_add_u32 s56,s56,s68
s_mul_i32 s70,s56,24576
s_lshl_b32 s71,s56,12
s_lshl_b32 s59,s77,13
s_lshl2_add_u32 s59,s68,s59
s_add_u32 s59,s59,10486144
s_cmp_lt_u32 s77,s61
s_cselect_b32 s57,0,16777216
s_mov_b32 s60,s59
s_add_u32 s71,s71,s57
s_add_u32 s71,s71,58720256
s_cmp_eq_u32 s77,s61
s_cselect_b32 s57,50331648,0
s_cselect_b32 s58,1536,0
s_add_u32 s59,s59,s58
s_add_u32 s70,s70,s57
s_add_u32 s70,s70,150994944
v_mov_b32 v19,s59
v_writelane_b32 v19,s60,1
s_branch L_aj_125
L_ab_124:
s_mov_b32 s77,s35
s_mov_b32 s30,0
s_lshl_b32 s56,s77,5
s_add_u32 s56,s56,s68
s_mul_i32 s70,s56,24576
s_lshl_b32 s71,s56,12
s_lshl_b32 s59,s77,13
s_lshl2_add_u32 s59,s68,s59
s_add_u32 s59,s59,10485760
s_mov_b32 s33,1
s_add_u32 s70,s70,100663296
s_add_u32 s71,s71,41943040
v_mov_b32 v19,s59
L_aj_125:
buffer_load_dword v18,v19,s[8:11],0 offen sc1
s_waitcnt vmcnt(2)
v_mfma_f32_16x16x32_bf16 v[136:139],v[72:75],v[24:27],0
v_max3_u32 v238,v72,v73,v74
v_max3_u32 v238,v74,v75,v238
v_mfma_f32_16x16x32_bf16 v[136:139],v[76:79],v[28:31],v[136:139]
v_max3_u32 v238,v76,v77,v238
v_max3_u32 v238,v78,v79,v238
v_mfma_f32_16x16x32_bf16 v[136:139],v[80:83],v[32:35],v[136:139]
v_max3_u32 v238,v80,v81,v238
v_max3_u32 v238,v82,v83,v238
v_mfma_f32_16x16x32_bf16 v[136:139],v[84:87],v[36:39],v[136:139]
v_max3_u32 v238,v84,v85,v238
v_max3_u32 v238,v86,v87,v238
v_max3_u32 v238,v120,v121,v238
v_max3_u32 v238,v122,v123,v238
v_max3_u32 v238,v124,v125,v238
v_max3_u32 v238,v126,v127,v238
v_cmp_eq_u32 vcc,-1,v238
s_cbranch_vccz L_aa_90
L_aa_89:
buffer_load_dwordx4 v[72:75],v0,s[8:11],s76 offen offset:0 sc1
buffer_load_dwordx4 v[76:79],v0,s[8:11],s76 offen offset:1024 sc1
buffer_load_dwordx4 v[80:83],v0,s[8:11],s76 offen offset:2048 sc1
buffer_load_dwordx4 v[84:87],v0,s[8:11],s76 offen offset:3072 sc1
buffer_load_dwordx2 v[120:121],v253,s[8:11],s76 offen offset:0 sc1
buffer_load_dwordx2 v[122:123],v253,s[8:11],s76 offen offset:1024 sc1
buffer_load_dwordx2 v[124:125],v253,s[8:11],s76 offen offset:2048 sc1
buffer_load_dwordx2 v[126:127],v253,s[8:11],s76 offen offset:3072 sc1
buffer_load_dword v18,v19,s[8:11],0 offen sc1
s_sub_u32 s49,s49,1
s_cbranch_scc1 L_abort
s_waitcnt vmcnt(8)
v_mfma_f32_16x16x32_bf16 v[136:139],v[72:75],v[24:27],0
v_max3_u32 v238,v72,v73,v74
v_max3_u32 v238,v74,v75,v238
s_waitcnt vmcnt(7)
v_mfma_f32_16x16x32_bf16 v[136:139],v[76:79],v[28:31],v[136:139]
v_max3_u32 v238,v76,v77,v238
v_max3_u32 v238,v78,v79,v238
s_waitcnt vmcnt(6)
v_mfma_f32_16x16x32_bf16 v[136:139],v[80:83],v[32:35],v[136:139]
v_max3_u32 v238,v80,v81,v238
v_max3_u32 v238,v82,v83,v238
s_waitcnt vmcnt(5)
v_mfma_f32_16x16x32_bf16 v[136:139],v[84:87],v[36:39],v[136:139]
v_max3_u32 v238,v84,v85,v238
v_max3_u32 v238,v86,v87,v238
s_waitcnt vmcnt(1)
v_max3_u32 v238,v120,v121,v238
v_max3_u32 v238,v122,v123,v238
v_max3_u32 v238,v124,v125,v238
v_max3_u32 v238,v126,v127,v238
v_cmp_eq_u32 vcc,-1,v238
s_cbranch_vccnz L_aa_89
L_aa_90:
s_cmp_lg_u32 s27,3
s_cbranch_scc1 L_ai_129
v_max3_f32 v238,v128,v129,v130
v_max3_f32 v239,v131,v132,v133
v_max3_f32 v238,v134,v135,v238
v_max3_f32 v239,v138,v139,v239
v_max_f32 v238,v238,v239
v_max_f32 v239,v238,v239
v_pk_mul_f32 v[128:129],v[128:129],v[152:153] op_sel_hi:[1,0]
v_pk_mul_f32 v[130:131],v[130:131],v[152:153] op_sel_hi:[1,0]
v_permlane16_swap_b32 v238,v239
v_max_f32 v238,v238,v239
v_max_f32 v239,v238,v239
v_pk_mul_f32 v[132:133],v[132:133],v[152:153] op_sel_hi:[1,0]
v_pk_mul_f32 v[134:135],v[134:135],v[152:153] op_sel_hi:[1,0]
v_permlane32_swap_b32 v238,v239
v_max_f32 v238,v238,v239
v_mul_f32 v238,v152,v238
v_pk_mul_f32 v[138:139],v[138:139],v[152:153] op_sel_hi:[1,0]
buffer_load_dword v17,v16,s[8:11],s87 offen sc1
v_pk_add_f32 v[128:129],v[128:129],v[238:239] op_sel_hi:[1,0] neg_lo:[0,1] neg_hi:[0,1]
v_pk_add_f32 v[130:131],v[130:131],v[238:239] op_sel_hi:[1,0] neg_lo:[0,1] neg_hi:[0,1]
v_pk_add_f32 v[132:133],v[132:133],v[238:239] op_sel_hi:[1,0] neg_lo:[0,1] neg_hi:[0,1]
v_pk_add_f32 v[134:135],v[134:135],v[238:239] op_sel_hi:[1,0] neg_lo:[0,1] neg_hi:[0,1]
v_pk_add_f32 v[138:139],v[138:139],v[238:239] op_sel_hi:[1,0] neg_lo:[0,1] neg_hi:[0,1]
v_exp_f32 v128,v128
v_exp_f32 v129,v129
v_exp_f32 v130,v130
v_exp_f32 v131,v131
v_exp_f32 v132,v132
v_exp_f32 v133,v133
v_exp_f32 v134,v134
v_exp_f32 v135,v135
v_exp_f32 v138,v138
v_exp_f32 v139,v139
v_pk_add_f32 v[148:149],v[128:129],v[130:131]
v_pk_add_f32 v[150:151],v[132:133],v[134:135]
v_pk_add_f32 v[148:149],v[148:149],v[138:139]
v_pk_add_f32 v[148:149],v[148:149],v[150:151]
v_add_f32 v150,v148,v149
v_add_f32 v151,v148,v149
s_nop 1
v_permlane16_swap_b32 v150,v151
v_add_f32 v148,v150,v151
v_add_f32 v149,v150,v151
s_nop 1
v_permlane32_swap_b32 v148,v149
v_add_f32 v148,v148,v149
v_rcp_f32 v148,v148
s_waitcnt vmcnt(0)
v_cmp_gt_u32 vcc,s66,v17
v_pk_mul_f32 v[138:139],v[138:139],v[148:149] op_sel_hi:[1,0]
v_pk_mul_f32 v[128:129],v[128:129],v[148:149] op_sel_hi:[1,0]
v_pk_mul_f32 v[130:131],v[130:131],v[148:149] op_sel_hi:[1,0]
v_pk_mul_f32 v[132:133],v[132:133],v[148:149] op_sel_hi:[1,0]
v_pk_mul_f32 v[134:135],v[134:135],v[148:149] op_sel_hi:[1,0]
s_cbranch_vccnz L_ap_130
L_apb_131:
s_xor_b32 s34,s69,524288
buffer_load_dwordx4 v[192:195],v7,s[8:11],s34 offen sc1
v_cvt_pk_bf16_f32 v144,v138,v139
v_cvt_pk_bf16_f32 v147,v138,v139
s_nop 0
v_mfma_f32_16x16x16_bf16 v[24:27],v[120:121],v[144:145],0
s_add_u32 s34,s34,4096
v_cvt_pk_bf16_f32 v140,v128,v129
v_mfma_f32_16x16x16_bf16 v[28:31],v[120:121],v[146:147],0
buffer_load_dwordx4 v[196:199],v7,s[8:11],s34 offen sc1
v_cvt_pk_bf16_f32 v141,v130,v131
v_mfma_f32_16x16x16_bf16 v[32:35],v[122:123],v[144:145],0
s_add_u32 s34,s34,4096
v_cvt_pk_bf16_f32 v142,v132,v133
v_mfma_f32_16x16x16_bf16 v[36:39],v[122:123],v[146:147],0
buffer_load_dwordx4 v[200:203],v7,s[8:11],s34 offen sc1
v_cvt_pk_bf16_f32 v143,v134,v135
v_mfma_f32_16x16x16_bf16 v[40:43],v[124:125],v[144:145],0
s_add_u32 s34,s34,4096
v_mfma_f32_16x16x16_bf16 v[44:47],v[124:125],v[146:147],0
buffer_load_dwordx4 v[204:207],v7,s[8:11],s34 offen sc1
v_mfma_f32_16x16x16_bf16 v[48:51],v[126:127],v[144:145],0
s_add_u32 s34,s34,4096
v_mfma_f32_16x16x16_bf16 v[52:55],v[126:127],v[146:147],0
buffer_load_dwordx4 v[208:211],v7,s[8:11],s34 offen sc1
v_mfma_f32_16x16x32_bf16 v[24:27],v[88:91],v[140:143],v[24:27]
s_add_u32 s34,s34,4096
v_mfma_f32_16x16x32_bf16 v[28:31],v[92:95],v[140:143],v[28:31]
buffer_load_dwordx4 v[212:215],v7,s[8:11],s34 offen sc1
v_mfma_f32_16x16x32_bf16 v[32:35],v[96:99],v[140:143],v[32:35]
s_add_u32 s34,s34,4096
v_mfma_f32_16x16x32_bf16 v[36:39],v[100:103],v[140:143],v[36:39]
buffer_load_dwordx4 v[216:219],v7,s[8:11],s34 offen sc1
v_cvt_pk_bf16_f32 v72,v24,v28
v_cvt_pk_bf16_f32 v73,v25,v29
v_mfma_f32_16x16x32_bf16 v[40:43],v[104:107],v[140:143],v[40:43]
s_add_u32 s34,s34,4096
v_cvt_pk_bf16_f32 v74,v26,v30
v_cvt_pk_bf16_f32 v75,v27,v31
v_mfma_f32_16x16x32_bf16 v[44:47],v[108:111],v[140:143],v[44:47]
ds_write_b128 v3,v[72:75] offset:0
v_cvt_pk_bf16_f32 v76,v32,v36
v_cvt_pk_bf16_f32 v77,v33,v37
v_mfma_f32_16x16x32_bf16 v[48:51],v[112:115],v[140:143],v[48:51]
buffer_load_dwordx4 v[220:223],v7,s[8:11],s34 offen sc1
v_cvt_pk_bf16_f32 v78,v34,v38
v_cvt_pk_bf16_f32 v79,v35,v39
v_mfma_f32_16x16x32_bf16 v[52:55],v[116:119],v[140:143],v[52:55]
ds_write_b128 v3,v[76:79] offset:1024
v_cvt_pk_bf16_f32 v80,v40,v44
v_cvt_pk_bf16_f32 v81,v41,v45
v_cvt_pk_bf16_f32 v82,v42,v46
v_cvt_pk_bf16_f32 v83,v43,v47
ds_write_b128 v3,v[80:83] offset:2048
s_nop 1
v_cvt_pk_bf16_f32 v84,v48,v52
v_cvt_pk_bf16_f32 v85,v49,v53
v_cvt_pk_bf16_f32 v86,v50,v54
v_cvt_pk_bf16_f32 v87,v51,v55
ds_write_b128 v3,v[84:87] offset:3072
v_readlane_b32 s32,v18,0
v_readlane_b32 s33,v18,1
s_waitcnt lgkmcnt(0)
s_barrier
s_branch L_aa_92
L_ai_129:
v_max3_f32 v238,v128,v129,v130
v_max3_f32 v239,v131,v132,v133
v_max3_f32 v238,v134,v135,v238
v_max3_f32 v239,v138,v139,v239
v_max_f32 v238,v238,v239
v_max_f32 v239,v238,v239
v_pk_mul_f32 v[128:129],v[128:129],v[152:153] op_sel_hi:[1,0]
v_pk_mul_f32 v[130:131],v[130:131],v[152:153] op_sel_hi:[1,0]
v_permlane16_swap_b32 v238,v239
v_max_f32 v238,v238,v239
v_max_f32 v239,v238,v239
v_pk_mul_f32 v[132:133],v[132:133],v[152:153] op_sel_hi:[1,0]
v_pk_mul_f32 v[134:135],v[134:135],v[152:153] op_sel_hi:[1,0]
v_permlane32_swap_b32 v238,v239
v_max_f32 v238,v238,v239
v_mul_f32 v238,v152,v238
v_pk_mul_f32 v[138:139],v[138:139],v[152:153] op_sel_hi:[1,0]
v_pk_add_f32 v[128:129],v[128:129],v[238:239] op_sel_hi:[1,0] neg_lo:[0,1] neg_hi:[0,1]
v_pk_add_f32 v[130:131],v[130:131],v[238:239] op_sel_hi:[1,0] neg_lo:[0,1] neg_hi:[0,1]
v_pk_add_f32 v[132:133],v[132:133],v[238:239] op_sel_hi:[1,0] neg_lo:[0,1] neg_hi:[0,1]
v_pk_add_f32 v[134:135],v[134:135],v[238:239] op_sel_hi:[1,0] neg_lo:[0,1] neg_hi:[0,1]
v_pk_add_f32 v[138:139],v[138:139],v[238:239] op_sel_hi:[1,0] neg_lo:[0,1] neg_hi:[0,1]
v_exp_f32 v128,v128
v_exp_f32 v129,v129
v_exp_f32 v130,v130
v_exp_f32 v131,v131
v_exp_f32 v132,v132
v_exp_f32 v133,v133
v_exp_f32 v134,v134
v_exp_f32 v135,v135
v_exp_f32 v138,v138
v_exp_f32 v139,v139
v_pk_add_f32 v[148:149],v[128:129],v[130:131]
v_pk_add_f32 v[150:151],v[132:133],v[134:135]
v_pk_add_f32 v[148:149],v[148:149],v[138:139]
v_pk_add_f32 v[148:149],v[148:149],v[150:151]
v_add_f32 v150,v148,v149
v_add_f32 v151,v148,v149
s_nop 1
v_permlane16_swap_b32 v150,v151
v_add_f32 v148,v150,v151
v_add_f32 v149,v150,v151
s_nop 1
v_permlane32_swap_b32 v148,v149
v_add_f32 v148,v148,v149
v_rcp_f32 v148,v148
s_nop 0
v_pk_mul_f32 v[138:139],v[138:139],v[148:149] op_sel_hi:[1,0]
v_pk_mul_f32 v[128:129],v[128:129],v[148:149] op_sel_hi:[1,0]
v_pk_mul_f32 v[130:131],v[130:131],v[148:149] op_sel_hi:[1,0]
v_pk_mul_f32 v[132:133],v[132:133],v[148:149] op_sel_hi:[1,0]
v_pk_mul_f32 v[134:135],v[134:135],v[148:149] op_sel_hi:[1,0]
v_cvt_pk_bf16_f32 v144,v138,v139
v_cvt_pk_bf16_f32 v147,v138,v139
s_nop 0
v_mfma_f32_16x16x16_bf16 v[24:27],v[120:121],v[144:145],0
v_cvt_pk_bf16_f32 v140,v128,v129
v_mfma_f32_16x16x16_bf16 v[28:31],v[120:121],v[146:147],0
v_cvt_pk_bf16_f32 v141,v130,v131
v_mfma_f32_16x16x16_bf16 v[32:35],v[122:123],v[144:145],0
v_cvt_pk_bf16_f32 v142,v132,v133
v_mfma_f32_16x16x16_bf16 v[36:39],v[122:123],v[146:147],0
v_cvt_pk_bf16_f32 v143,v134,v135
v_mfma_f32_16x16x16_bf16 v[40:43],v[124:125],v[144:145],0
v_mfma_f32_16x16x16_bf16 v[44:47],v[124:125],v[146:147],0
v_mfma_f32_16x16x16_bf16 v[48:51],v[126:127],v[144:145],0
v_mfma_f32_16x16x16_bf16 v[52:55],v[126:127],v[146:147],0
v_mfma_f32_16x16x32_bf16 v[24:27],v[88:91],v[140:143],v[24:27]
v_mfma_f32_16x16x32_bf16 v[28:31],v[92:95],v[140:143],v[28:31]
v_mfma_f32_16x16x32_bf16 v[32:35],v[96:99],v[140:143],v[32:35]
v_mfma_f32_16x16x32_bf16 v[36:39],v[100:103],v[140:143],v[36:39]
v_cvt_pk_bf16_f32 v72,v24,v28
v_cvt_pk_bf16_f32 v73,v25,v29
v_mfma_f32_16x16x32_bf16 v[40:43],v[104:107],v[140:143],v[40:43]
v_cvt_pk_bf16_f32 v74,v26,v30
v_cvt_pk_bf16_f32 v75,v27,v31
v_mfma_f32_16x16x32_bf16 v[44:47],v[108:111],v[140:143],v[44:47]
ds_write_b128 v3,v[72:75] offset:0
v_cvt_pk_bf16_f32 v76,v32,v36
v_cvt_pk_bf16_f32 v77,v33,v37
v_mfma_f32_16x16x32_bf16 v[48:51],v[112:115],v[140:143],v[48:51]
v_cvt_pk_bf16_f32 v78,v34,v38
v_cvt_pk_bf16_f32 v79,v35,v39
v_mfma_f32_16x16x32_bf16 v[52:55],v[116:119],v[140:143],v[52:55]
ds_write_b128 v3,v[76:79] offset:1024
v_cvt_pk_bf16_f32 v80,v40,v44
v_cvt_pk_bf16_f32 v81,v41,v45
v_cvt_pk_bf16_f32 v82,v42,v46
v_cvt_pk_bf16_f32 v83,v43,v47
ds_write_b128 v3,v[80:83] offset:2048
s_nop 1
v_cvt_pk_bf16_f32 v84,v48,v52
v_cvt_pk_bf16_f32 v85,v49,v53
v_cvt_pk_bf16_f32 v86,v50,v54
v_cvt_pk_bf16_f32 v87,v51,v55
ds_write_b128 v3,v[84:87] offset:3072
s_waitcnt vmcnt(0)
v_readlane_b32 s32,v18,0
v_readlane_b32 s33,v18,1
s_waitcnt lgkmcnt(0)
s_barrier
s_branch L_aa_79
L_aa_88:
s_cmp_lg_u32 s86,1536
s_cbranch_scc1 L_az_132
s_cmp_ge_u32 s35,66
s_cbranch_scc1 L_aa_78
v_subrev_u32 v248,s36,v1
v_and_b32 v248,0x80000003,v248
v_cmp_eq_u32 vcc,0,v248
v_lshlrev_b32 v248,2,v1
v_mov_b32 v249,0x40000000
v_cndmask_b32 v248,v249,v248,vcc
v_mov_b32 v249,3
s_or_b32 s59,s68,s46
s_mov_b32 s59,11018240
s_cmov_b32 s59,0x80000000
buffer_store_dword v249,v248,s[8:11],s59 offen sc1
L_aa_78:
s_waitcnt vmcnt(0)
buffer_store_dword v20,off,s[8:11],s73 sc1
s_mov_b32 s73,0x80000000
v_lshlrev_b32 v238,2,v1
v_add_u32 v248,155712,v238
s_cmp_lg_u32 s46,0
s_cbranch_scc1 L_an_133
s_lshl_b32 s59,s54,13
s_add_u32 s59,s59,11026432
L_fp_134:
s_sleep 1
buffer_load_dword v239,v238,s[8:11],s59 offen sc1
s_sub_u32 s49,s49,1
s_cbranch_scc1 L_abort
s_waitcnt vmcnt(0)
v_cmp_eq_u32 vcc,0,v239
s_cbranch_vccnz L_fp_134
ds_write_b32 v248,v239
s_waitcnt lgkmcnt(0)
L_an_133:
s_barrier
ds_read_b32 v239,v248
s_mov_b32 s86,768
s_mov_b32 s30,1
s_waitcnt lgkmcnt(0)
v_readfirstlane_b32 s55,v239
v_and_b32 v239,255,v239
s_lshr_b32 s55,s55,8
s_lshr_b32 s61,s55,5
v_cmp_ne_u32 s[38:39],3,v239
v_cmp_le_u32 vcc,s61,v1
s_nop 1
v_cndmask_b32 v238,1,2,vcc
v_cmp_ne_u32 s[84:85],v238,v239
s_bcnt1_i32_b64 s56,s[84:85]
s_nop 0
v_mbcnt_lo_u32_b32 v238,s84,0
v_mbcnt_hi_u32_b32 v238,s85,v238
s_mul_i32 s56,s56,12
s_add_u32 s56,s56,48
s_lshr_b32 s56,s56,7
s_lshl_b32 s56,s56,1
v_cmp_gt_u32 vcc,s56,v238
v_and_b32 v239,1,v238
v_and_b32 v238,3,v238
v_add_u32 v238,2,v238
v_cndmask_b32 v238,v238,v239,vcc
v_cmp_eq_u32 vcc,s54,v238
s_and_b64 s[84:85],s[84:85],vcc
s_ff1_i32_b64 s77,s[84:85]
s_bitset0_b64 s[84:85],s77
s_min_u32 s77,s77,64
s_lshl_b32 s56,s77,5
s_add_u32 s56,s56,s68
s_mul_i32 s70,s56,24576
s_lshl_b32 s71,s56,12
s_lshl_b32 s59,s77,13
s_lshl2_add_u32 s59,s68,s59
s_add_u32 s59,s59,10486144
s_cmp_lt_u32 s77,s61
s_cselect_b32 s57,0,16777216
s_mov_b32 s60,s59
s_buffer_load_dword s33,s[8:11],s60
s_add_u32 s71,s71,s57
s_add_u32 s71,s71,58720256
s_cmp_eq_u32 s77,s61
s_cselect_b32 s57,50331648,0
s_cselect_b32 s58,1536,0
s_add_u32 s59,s59,s58
s_buffer_load_dword s32,s[8:11],s59
s_add_u32 s70,s70,s57
s_add_u32 s70,s70,150994944
v_mov_b32 v19,s59
v_writelane_b32 v19,s60,1
s_cmp_lt_u32 s77,64
s_cbranch_scc1 L_aa_86
L_az_132:
s_waitcnt vmcnt(0)
buffer_store_dword v20,off,s[8:11],s73 sc1
s_mov_b32 s73,0x80000000
s_endpgm
L_ag_94:
s_lshl_b32 s21,s26,13
s_lshl2_add_u32 s21,s68,s21
s_add_u32 s21,s21,10487296
L_ww_135:
buffer_load_dword v246,off,s[8:11],s21 sc1
s_sub_u32 s49,s49,1
s_cbranch_scc1 L_abort
s_waitcnt vmcnt(0)
v_readfirstlane_b32 s22,v246
s_cmp_eq_u32 s22,0
s_cbranch_scc1 L_ww_135
L_wwd_136:
s_branch L_agb_95
L_ac_103:
buffer_store_dword v20,off,s[8:11],s73 sc1
s_mov_b32 s73,0x80000000
buffer_load_dwordx4 v[72:75],v0,s[8:11],s76 offen offset:0 sc1
buffer_load_dwordx4 v[76:79],v0,s[8:11],s76 offen offset:1024 sc1
buffer_load_dwordx4 v[80:83],v0,s[8:11],s76 offen offset:2048 sc1
buffer_load_dwordx4 v[84:87],v0,s[8:11],s76 offen offset:3072 sc1
buffer_load_dwordx2 v[120:121],v253,s[8:11],s76 offen offset:0 sc1
buffer_load_dwordx2 v[122:123],v253,s[8:11],s76 offen offset:1024 sc1
buffer_load_dwordx2 v[124:125],v253,s[8:11],s76 offen offset:2048 sc1
buffer_load_dwordx2 v[126:127],v253,s[8:11],s76 offen offset:3072 sc1
s_sub_u32 s49,s49,1
s_cbranch_scc1 L_abort
s_waitcnt vmcnt(7)
v_mfma_f32_16x16x32_bf16 v[136:139],v[72:75],v[24:27],0
v_max3_u32 v238,v72,v73,v74
v_max3_u32 v238,v74,v75,v238
s_waitcnt vmcnt(6)
v_mfma_f32_16x16x32_bf16 v[136:139],v[76:79],v[28:31],v[136:139]
v_max3_u32 v238,v76,v77,v238
v_max3_u32 v238,v78,v79,v238
s_waitcnt vmcnt(5)
v_mfma_f32_16x16x32_bf16 v[136:139],v[80:83],v[32:35],v[136:139]
v_max3_u32 v238,v80,v81,v238
v_max3_u32 v238,v82,v83,v238
s_waitcnt vmcnt(4)
v_mfma_f32_16x16x32_bf16 v[136:139],v[84:87],v[36:39],v[136:139]
v_max3_u32 v238,v84,v85,v238
v_max3_u32 v238,v86,v87,v238
s_waitcnt vmcnt(0)
v_max3_u32 v238,v120,v121,v238
v_max3_u32 v238,v122,v123,v238
v_max3_u32 v238,v124,v125,v238
v_max3_u32 v238,v126,v127,v238
v_cmp_eq_u32 vcc,-1,v238
s_cbranch_vccnz L_ac_103
s_branch L_acb_104
L_ap_106:
L_aw_137:
v_cmp_gt_u32 vcc,s66,v17
s_cbranch_vccz L_awd_138
buffer_load_dword v17,v16,s[8:11],s87 offen sc1
s_sub_u32 s49,s49,1
s_cbranch_scc1 L_abort
s_waitcnt vmcnt(0)
s_branch L_aw_137
L_awd_138:
s_branch L_apb_107
L_ag_115:
s_lshl_b32 s21,s51,13
s_lshl2_add_u32 s21,s68,s21
s_add_u32 s21,s21,10487296
L_ww_139:
buffer_load_dword v246,off,s[8:11],s21 sc1
s_sub_u32 s49,s49,1
s_cbranch_scc1 L_abort
s_waitcnt vmcnt(0)
v_readfirstlane_b32 s22,v246
s_cmp_eq_u32 s22,0
s_cbranch_scc1 L_ww_139
L_wwd_140:
s_branch L_agb_116
L_ac_122:
buffer_store_dword v20,off,s[8:11],s73 sc1
s_mov_b32 s73,0x80000000
buffer_load_dwordx4 v[72:75],v0,s[8:11],s76 offen offset:0 sc1
buffer_load_dwordx4 v[76:79],v0,s[8:11],s76 offen offset:1024 sc1
buffer_load_dwordx4 v[80:83],v0,s[8:11],s76 offen offset:2048 sc1
buffer_load_dwordx4 v[84:87],v0,s[8:11],s76 offen offset:3072 sc1
buffer_load_dwordx2 v[120:121],v253,s[8:11],s76 offen offset:0 sc1
buffer_load_dwordx2 v[122:123],v253,s[8:11],s76 offen offset:1024 sc1
buffer_load_dwordx2 v[124:125],v253,s[8:11],s76 offen offset:2048 sc1
buffer_load_dwordx2 v[126:127],v253,s[8:11],s76 offen offset:3072 sc1
s_sub_u32 s49,s49,1
s_cbranch_scc1 L_abort
s_waitcnt vmcnt(7)
v_mfma_f32_16x16x32_bf16 v[136:139],v[72:75],v[24:27],0
v_max3_u32 v238,v72,v73,v74
v_max3_u32 v238,v74,v75,v238
s_waitcnt vmcnt(6)
v_mfma_f32_16x16x32_bf16 v[136:139],v[76:79],v[28:31],v[136:139]
v_max3_u32 v238,v76,v77,v238
v_max3_u32 v238,v78,v79,v238
s_waitcnt vmcnt(5)
v_mfma_f32_16x16x32_bf16 v[136:139],v[80:83],v[32:35],v[136:139]
v_max3_u32 v238,v80,v81,v238
v_max3_u32 v238,v82,v83,v238
s_waitcnt vmcnt(4)
v_mfma_f32_16x16x32_bf16 v[136:139],v[84:87],v[36:39],v[136:139]
v_max3_u32 v238,v84,v85,v238
v_max3_u32 v238,v86,v87,v238
s_waitcnt vmcnt(0)
v_max3_u32 v238,v120,v121,v238
v_max3_u32 v238,v122,v123,v238
v_max3_u32 v238,v124,v125,v238
v_max3_u32 v238,v126,v127,v238
v_cmp_eq_u32 vcc,-1,v238
s_cbranch_vccnz L_ac_122
s_branch L_acb_123
L_am_126:
v_subrev_u32 v248,s36,v1
v_and_b32 v248,0x80000003,v248
v_cmp_eq_u32 vcc,0,v248
v_lshlrev_b32 v248,2,v1
v_mov_b32 v249,0x40000000
v_cndmask_b32 v248,v249,v248,vcc
v_mov_b32 v249,3
s_or_b32 s59,s68,s46
s_mov_b32 s59,11018240
s_cmov_b32 s59,0x80000000
buffer_store_dword v249,v248,s[8:11],s59 offen sc1
s_branch L_ab_124
L_ap_130:
L_aw_141:
v_cmp_gt_u32 vcc,s66,v17
s_cbranch_vccz L_awd_142
buffer_load_dword v17,v16,s[8:11],s87 offen sc1
s_sub_u32 s49,s49,1
s_cbranch_scc1 L_abort
s_waitcnt vmcnt(0)
s_branch L_aw_141
L_awd_142:
s_branch L_apb_131
s_endpgm
L_rch_4:
s_waitcnt vmcnt(12)
v_swap_b32 v25,v28
v_swap_b32 v26,v32
v_swap_b32 v27,v36
v_swap_b32 v30,v33
v_swap_b32 v31,v37
v_swap_b32 v35,v38
ds_write_b128 v93,v[24:27] offset:0
ds_write_b128 v94,v[28:31] offset:0
ds_write_b128 v93,v[32:35] offset:128
ds_write_b128 v94,v[36:39] offset:128
s_waitcnt lgkmcnt(0)
s_mov_b32 s56,65536
buffer_load_dwordx4 v[24:27],v92,s[4:7],s56 offen offset:0
buffer_load_dwordx4 v[28:31],v92,s[4:7],s56 offen offset:1024
buffer_load_dwordx4 v[32:35],v92,s[4:7],s56 offen offset:2048
buffer_load_dwordx4 v[36:39],v92,s[4:7],s56 offen offset:3072
s_waitcnt vmcnt(12)
v_swap_b32 v41,v44
v_swap_b32 v42,v48
v_swap_b32 v43,v52
v_swap_b32 v46,v49
v_swap_b32 v47,v53
v_swap_b32 v51,v54
ds_write_b128 v93,v[40:43] offset:1024
ds_write_b128 v94,v[44:47] offset:1024
ds_write_b128 v93,v[48:51] offset:1152
ds_write_b128 v94,v[52:55] offset:1152
s_waitcnt lgkmcnt(0)
s_mov_b32 s56,81920
buffer_load_dwordx4 v[40:43],v92,s[4:7],s56 offen offset:0
buffer_load_dwordx4 v[44:47],v92,s[4:7],s56 offen offset:1024
buffer_load_dwordx4 v[48:51],v92,s[4:7],s56 offen offset:2048
buffer_load_dwordx4 v[52:55],v92,s[4:7],s56 offen offset:3072
s_waitcnt vmcnt(12)
v_swap_b32 v57,v60
v_swap_b32 v58,v64
v_swap_b32 v59,v68
v_swap_b32 v62,v65
v_swap_b32 v63,v69
v_swap_b32 v67,v70
ds_write_b128 v93,v[56:59] offset:2048
ds_write_b128 v94,v[60:63] offset:2048
ds_write_b128 v93,v[64:67] offset:2176
ds_write_b128 v94,v[68:71] offset:2176
s_waitcnt lgkmcnt(0)
s_mov_b32 s56,98304
buffer_load_dwordx4 v[56:59],v92,s[4:7],s56 offen offset:0
buffer_load_dwordx4 v[60:63],v92,s[4:7],s56 offen offset:1024
buffer_load_dwordx4 v[64:67],v92,s[4:7],s56 offen offset:2048
buffer_load_dwordx4 v[68:71],v92,s[4:7],s56 offen offset:3072
s_waitcnt vmcnt(12)
v_swap_b32 v73,v76
v_swap_b32 v74,v80
v_swap_b32 v75,v84
v_swap_b32 v78,v81
v_swap_b32 v79,v85
v_swap_b32 v83,v86
ds_write_b128 v93,v[72:75] offset:3072
ds_write_b128 v94,v[76:79] offset:3072
ds_write_b128 v93,v[80:83] offset:3200
ds_write_b128 v94,v[84:87] offset:3200
s_waitcnt lgkmcnt(0)
s_mov_b32 s56,114688
buffer_load_dwordx4 v[72:75],v92,s[4:7],s56 offen offset:0
buffer_load_dwordx4 v[76:79],v92,s[4:7],s56 offen offset:1024
buffer_load_dwordx4 v[80:83],v92,s[4:7],s56 offen offset:2048
buffer_load_dwordx4 v[84:87],v92,s[4:7],s56 offen offset:3072
s_cmp_eq_u32 s48,0
s_cbranch_scc1 L_rs_143
s_waitcnt vmcnt(12)
v_swap_b32 v25,v28
v_swap_b32 v26,v32
v_swap_b32 v27,v36
v_swap_b32 v30,v33
v_swap_b32 v31,v37
v_swap_b32 v35,v38
ds_write_b128 v93,v[24:27] offset:4096
ds_write_b128 v94,v[28:31] offset:4096
ds_write_b128 v93,v[32:35] offset:4224
ds_write_b128 v94,v[36:39] offset:4224
s_waitcnt vmcnt(8)
v_swap_b32 v41,v44
v_swap_b32 v42,v48
v_swap_b32 v43,v52
v_swap_b32 v46,v49
v_swap_b32 v47,v53
v_swap_b32 v51,v54
ds_write_b128 v93,v[40:43] offset:5120
ds_write_b128 v94,v[44:47] offset:5120
ds_write_b128 v93,v[48:51] offset:5248
ds_write_b128 v94,v[52:55] offset:5248
s_waitcnt vmcnt(4)
v_swap_b32 v57,v60
v_swap_b32 v58,v64
v_swap_b32 v59,v68
v_swap_b32 v62,v65
v_swap_b32 v63,v69
v_swap_b32 v67,v70
ds_write_b128 v93,v[56:59] offset:6144
ds_write_b128 v94,v[60:63] offset:6144
ds_write_b128 v93,v[64:67] offset:6272
ds_write_b128 v94,v[68:71] offset:6272
s_waitcnt vmcnt(0)
v_swap_b32 v73,v76
v_swap_b32 v74,v80
v_swap_b32 v75,v84
v_swap_b32 v78,v81
v_swap_b32 v79,v85
v_swap_b32 v83,v86
ds_write_b128 v93,v[72:75] offset:7168
ds_write_b128 v94,v[76:79] offset:7168
ds_write_b128 v93,v[80:83] offset:7296
ds_write_b128 v94,v[84:87] offset:7296
L_rs_143:
v_mov_b32 v123,159744
s_cmp_lg_u32 s46,0
s_cbranch_scc1 L_gbd_145
v_mov_b32 v124,128
s_buffer_load_dword s56,s[12:15],128
s_waitcnt lgkmcnt(0)
v_mov_b32 v125,s56
ds_write_b32 v123,v125
s_bitcmp1_b32 s56,8
s_cbranch_scc1 L_gbd_145
L_gb_144:
buffer_load_dword v125,v124,s[12:15],0 offen sc1
s_waitcnt vmcnt(0)
v_readfirstlane_b32 s56,v125
ds_write_b32 v123,v125
s_bitcmp1_b32 s56,8
s_cbranch_scc1 L_gbd_145
s_sleep 4
s_sub_u32 s49,s49,1
s_cmp_gt_i32 s49,0
s_cbranch_scc1 L_gb_144
s_branch L_abort
L_gbd_145:
s_waitcnt lgkmcnt(0)
s_barrier
ds_read_b32 v125,v123
s_waitcnt lgkmcnt(0)
v_readfirstlane_b32 s56,v125
s_barrier
s_lshr_b32 s56,s56,16
s_andn2_b32 s56,s56,s3
s_cbranch_scc1 L_spread
s_cmp_eq_u32 s48,0
s_cbranch_scc1 L_chd_146
v_and_b32 v120,15,v1
v_lshrrev_b32 v121,4,v1
v_mov_b32 v17,1
s_lshl_b32 s56,s46,2
v_add_u32 v125,s56,v121
v_xor_b32 v126,v125,v120
v_lshlrev_b32 v126,4,v126
v_lshl_add_u32 v20,v125,10,v126
s_lshl_b32 s56,s46,1
s_xor_b32 s56,s56,0
s_and_b32 s57,s56,3
s_lshl_b32 s57,s57,2
s_lshr_b32 s56,s56,2
s_lshl_b32 s56,s56,13
s_add_u32 s56,s56,131072
v_add_u32 v125,s57,v121
v_xor_b32 v125,v125,v120
v_lshlrev_b32 v125,4,v125
v_lshl_add_u32 v125,v120,8,v125
v_add_u32 v4,s56,v125
s_lshl_b32 s56,s46,1
s_xor_b32 s56,s56,1
s_and_b32 s57,s56,3
s_lshl_b32 s57,s57,2
s_lshr_b32 s56,s56,2
s_lshl_b32 s56,s56,13
s_add_u32 s56,s56,131072
v_add_u32 v125,s57,v121
v_xor_b32 v125,v125,v120
v_lshlrev_b32 v125,4,v125
v_lshl_add_u32 v125,v120,8,v125
v_add_u32 v5,s56,v125
s_lshl_b32 s56,s46,1
s_xor_b32 s56,s56,2
s_and_b32 s57,s56,3
s_lshl_b32 s57,s57,2
s_lshr_b32 s56,s56,2
s_lshl_b32 s56,s56,13
s_add_u32 s56,s56,131072
v_add_u32 v125,s57,v121
v_xor_b32 v125,v125,v120
v_lshlrev_b32 v125,4,v125
v_lshl_add_u32 v125,v120,8,v125
v_add_u32 v6,s56,v125
s_lshl_b32 s56,s46,1
s_xor_b32 s56,s56,3
s_and_b32 s57,s56,3
s_lshl_b32 s57,s57,2
s_lshr_b32 s56,s56,2
s_lshl_b32 s56,s56,13
s_add_u32 s56,s56,131072
v_add_u32 v125,s57,v121
v_xor_b32 v125,v125,v120
v_lshlrev_b32 v125,4,v125
v_lshl_add_u32 v125,v120,8,v125
v_add_u32 v7,s56,v125
s_lshl_b32 s56,s46,1
s_xor_b32 s56,s56,4
s_and_b32 s57,s56,3
s_lshl_b32 s57,s57,2
s_lshr_b32 s56,s56,2
s_lshl_b32 s56,s56,13
s_add_u32 s56,s56,131072
v_add_u32 v125,s57,v121
v_xor_b32 v125,v125,v120
v_lshlrev_b32 v125,4,v125
v_lshl_add_u32 v125,v120,8,v125
v_add_u32 v8,s56,v125
s_lshl_b32 s56,s46,1
s_xor_b32 s56,s56,5
s_and_b32 s57,s56,3
s_lshl_b32 s57,s57,2
s_lshr_b32 s56,s56,2
s_lshl_b32 s56,s56,13
s_add_u32 s56,s56,131072
v_add_u32 v125,s57,v121
v_xor_b32 v125,v125,v120
v_lshlrev_b32 v125,4,v125
v_lshl_add_u32 v125,v120,8,v125
v_add_u32 v9,s56,v125
s_lshl_b32 s56,s46,1
s_xor_b32 s56,s56,6
s_and_b32 s57,s56,3
s_lshl_b32 s57,s57,2
s_lshr_b32 s56,s56,2
s_lshl_b32 s56,s56,13
s_add_u32 s56,s56,131072
v_add_u32 v125,s57,v121
v_xor_b32 v125,v125,v120
v_lshlrev_b32 v125,4,v125
v_lshl_add_u32 v125,v120,8,v125
v_add_u32 v10,s56,v125
s_lshl_b32 s56,s46,1
s_xor_b32 s56,s56,7
s_and_b32 s57,s56,3
s_lshl_b32 s57,s57,2
s_lshr_b32 s56,s56,2
s_lshl_b32 s56,s56,13
s_add_u32 s56,s56,131072
v_add_u32 v125,s57,v121
v_xor_b32 v125,v125,v120
v_lshlrev_b32 v125,4,v125
v_lshl_add_u32 v125,v120,8,v125
v_add_u32 v11,s56,v125
s_cmp_eq_u32 s48,1
s_cselect_b32 s51,14,17
s_cselect_b32 s53,3,5
s_mov_b32 s72,0x80000000
s_lshl_b32 s70,s51,15
s_add_u32 s70,s70,0
s_add_u32 s71,s70,16384
s_add_u32 m0,s50,131072
s_nop 0
buffer_load_dwordx4 v20,s[8:11],s70 offen offset:0 sc1 lds
s_add_u32 m0,s50,135168
s_nop 0
buffer_load_dwordx4 v20,s[8:11],s71 offen offset:0 sc1 lds
s_add_u32 m0,s50,139008
s_nop 0
buffer_load_dwordx4 v20,s[8:11],s70 offen offset:256 sc1 lds
s_add_u32 m0,s50,143104
s_nop 0
buffer_load_dwordx4 v20,s[8:11],s71 offen offset:256 sc1 lds
s_waitcnt vmcnt(0)
L_chl_147:
s_mov_b64 s[68:69],s[70:71]
s_add_u32 s70,s70,32768
s_add_u32 s71,s71,32768
s_lshl_b32 s58,s51,5
s_add_u32 s58,s58,s47
s_mul_i32 s58,s58,24576
s_add_u32 s58,s58,100663296
s_add_u32 s61,s58,s50
s_add_u32 s62,s61,4096
s_add_u32 s63,s61,16384
s_add_u32 s64,s61,20480
s_add_u32 s65,s61,s50
s_add_u32 s65,s65,8192
s_waitcnt vmcnt(7)
s_barrier
ds_read_b128 v[72:75],v4 offset:0
ds_read_b128 v[76:79],v4 offset:4096
ds_read_b128 v[80:83],v5 offset:0
ds_read_b128 v[84:87],v5 offset:4096
s_add_u32 m0,s50,146944
s_nop 0
buffer_load_dwordx4 v20,s[8:11],s68 offen offset:512 sc1 lds
s_add_u32 m0,s50,151040
s_nop 0
buffer_load_dwordx4 v20,s[8:11],s69 offen offset:512 sc1 lds
s_add_u32 m0,s50,154880
s_nop 0
buffer_load_dwordx4 v20,s[8:11],s68 offen offset:768 sc1 lds
s_add_u32 m0,s50,158976
s_nop 0
buffer_load_dwordx4 v20,s[8:11],s69 offen offset:768 sc1 lds
s_waitcnt lgkmcnt(2)
v_mfma_f32_16x16x32_bf16 v[40:43],a[128:131],v[72:75],0
ds_read_b128 v[108:111],v6 offset:0
v_mfma_f32_16x16x32_bf16 v[56:59],v[72:75],v[128:131],0
v_mfma_f32_16x16x32_bf16 v[24:27],a[0:3],v[72:75],0
ds_read_b128 v[112:115],v6 offset:4096
v_mfma_f32_16x16x32_bf16 v[44:47],a[128:131],v[76:79],0
v_mfma_f32_16x16x32_bf16 v[60:63],v[76:79],v[128:131],0
v_mfma_f32_16x16x32_bf16 v[28:31],a[0:3],v[76:79],0
v_mfma_f32_16x16x32_bf16 v[48:51],a[136:139],v[72:75],0
v_mfma_f32_16x16x32_bf16 v[64:67],v[72:75],v[136:139],0
v_mfma_f32_16x16x32_bf16 v[32:35],a[8:11],v[72:75],0
v_mfma_f32_16x16x32_bf16 v[52:55],a[136:139],v[76:79],0
v_mfma_f32_16x16x32_bf16 v[68:71],v[76:79],v[136:139],0
v_mfma_f32_16x16x32_bf16 v[36:39],a[8:11],v[76:79],0
s_waitcnt lgkmcnt(2)
v_mfma_f32_16x16x32_bf16 v[40:43],a[132:135],v[80:83],v[40:43]
ds_read_b128 v[72:75],v7 offset:0
v_mfma_f32_16x16x32_bf16 v[56:59],v[80:83],v[132:135],v[56:59]
v_mfma_f32_16x16x32_bf16 v[24:27],a[4:7],v[80:83],v[24:27]
ds_read_b128 v[76:79],v7 offset:4096
v_mfma_f32_16x16x32_bf16 v[44:47],a[132:135],v[84:87],v[44:47]
v_mfma_f32_16x16x32_bf16 v[60:63],v[84:87],v[132:135],v[60:63]
v_mfma_f32_16x16x32_bf16 v[28:31],a[4:7],v[84:87],v[28:31]
v_mfma_f32_16x16x32_bf16 v[48:51],a[140:143],v[80:83],v[48:51]
v_mfma_f32_16x16x32_bf16 v[64:67],v[80:83],v[140:143],v[64:67]
v_mfma_f32_16x16x32_bf16 v[32:35],a[12:15],v[80:83],v[32:35]
v_mfma_f32_16x16x32_bf16 v[52:55],a[140:143],v[84:87],v[52:55]
v_mfma_f32_16x16x32_bf16 v[68:71],v[84:87],v[140:143],v[68:71]
v_mfma_f32_16x16x32_bf16 v[36:39],a[12:15],v[84:87],v[36:39]
s_waitcnt lgkmcnt(2)
v_mfma_f32_16x16x32_bf16 v[40:43],a[144:147],v[108:111],v[40:43]
ds_read_b128 v[80:83],v8 offset:0
v_mfma_f32_16x16x32_bf16 v[56:59],v[108:111],v[144:147],v[56:59]
v_mfma_f32_16x16x32_bf16 v[24:27],a[16:19],v[108:111],v[24:27]
ds_read_b128 v[84:87],v8 offset:4096
v_mfma_f32_16x16x32_bf16 v[44:47],a[144:147],v[112:115],v[44:47]
v_mfma_f32_16x16x32_bf16 v[60:63],v[112:115],v[144:147],v[60:63]
v_mfma_f32_16x16x32_bf16 v[28:31],a[16:19],v[112:115],v[28:31]
v_mfma_f32_16x16x32_bf16 v[48:51],a[152:155],v[108:111],v[48:51]
v_mfma_f32_16x16x32_bf16 v[64:67],v[108:111],v[152:155],v[64:67]
v_mfma_f32_16x16x32_bf16 v[32:35],a[24:27],v[108:111],v[32:35]
v_mfma_f32_16x16x32_bf16 v[52:55],a[152:155],v[112:115],v[52:55]
v_mfma_f32_16x16x32_bf16 v[68:71],v[112:115],v[152:155],v[68:71]
v_mfma_f32_16x16x32_bf16 v[36:39],a[24:27],v[112:115],v[36:39]
s_waitcnt lgkmcnt(2)
v_mfma_f32_16x16x32_bf16 v[40:43],a[148:151],v[72:75],v[40:43]
ds_read_b128 v[108:111],v9 offset:0
v_mfma_f32_16x16x32_bf16 v[56:59],v[72:75],v[148:151],v[56:59]
v_mfma_f32_16x16x32_bf16 v[24:27],a[20:23],v[72:75],v[24:27]
ds_read_b128 v[112:115],v9 offset:4096
v_mfma_f32_16x16x32_bf16 v[44:47],a[148:151],v[76:79],v[44:47]
v_mfma_f32_16x16x32_bf16 v[60:63],v[76:79],v[148:151],v[60:63]
v_mfma_f32_16x16x32_bf16 v[28:31],a[20:23],v[76:79],v[28:31]
v_mfma_f32_16x16x32_bf16 v[48:51],a[156:159],v[72:75],v[48:51]
v_mfma_f32_16x16x32_bf16 v[64:67],v[72:75],v[156:159],v[64:67]
v_mfma_f32_16x16x32_bf16 v[32:35],a[28:31],v[72:75],v[32:35]
v_mfma_f32_16x16x32_bf16 v[52:55],a[156:159],v[76:79],v[52:55]
v_mfma_f32_16x16x32_bf16 v[68:71],v[76:79],v[156:159],v[68:71]
v_mfma_f32_16x16x32_bf16 v[36:39],a[28:31],v[76:79],v[36:39]
s_waitcnt lgkmcnt(2)
v_mfma_f32_16x16x32_bf16 v[40:43],a[160:163],v[80:83],v[40:43]
ds_read_b128 v[72:75],v10 offset:0
v_mfma_f32_16x16x32_bf16 v[56:59],v[80:83],v[160:163],v[56:59]
v_mfma_f32_16x16x32_bf16 v[24:27],a[32:35],v[80:83],v[24:27]
ds_read_b128 v[76:79],v10 offset:4096
v_mfma_f32_16x16x32_bf16 v[44:47],a[160:163],v[84:87],v[44:47]
v_mfma_f32_16x16x32_bf16 v[60:63],v[84:87],v[160:163],v[60:63]
v_mfma_f32_16x16x32_bf16 v[28:31],a[32:35],v[84:87],v[28:31]
v_mfma_f32_16x16x32_bf16 v[48:51],a[168:171],v[80:83],v[48:51]
v_mfma_f32_16x16x32_bf16 v[64:67],v[80:83],v[168:171],v[64:67]
v_mfma_f32_16x16x32_bf16 v[32:35],a[40:43],v[80:83],v[32:35]
v_mfma_f32_16x16x32_bf16 v[52:55],a[168:171],v[84:87],v[52:55]
v_mfma_f32_16x16x32_bf16 v[68:71],v[84:87],v[168:171],v[68:71]
v_mfma_f32_16x16x32_bf16 v[36:39],a[40:43],v[84:87],v[36:39]
s_waitcnt lgkmcnt(2)
v_mfma_f32_16x16x32_bf16 v[40:43],a[164:167],v[108:111],v[40:43]
ds_read_b128 v[80:83],v11 offset:0
v_mfma_f32_16x16x32_bf16 v[56:59],v[108:111],v[164:167],v[56:59]
v_mfma_f32_16x16x32_bf16 v[24:27],a[36:39],v[108:111],v[24:27]
ds_read_b128 v[84:87],v11 offset:4096
v_mfma_f32_16x16x32_bf16 v[44:47],a[164:167],v[112:115],v[44:47]
v_mfma_f32_16x16x32_bf16 v[60:63],v[112:115],v[164:167],v[60:63]
v_mfma_f32_16x16x32_bf16 v[28:31],a[36:39],v[112:115],v[28:31]
v_mfma_f32_16x16x32_bf16 v[48:51],a[172:175],v[108:111],v[48:51]
v_mfma_f32_16x16x32_bf16 v[64:67],v[108:111],v[172:175],v[64:67]
v_mfma_f32_16x16x32_bf16 v[32:35],a[44:47],v[108:111],v[32:35]
v_mfma_f32_16x16x32_bf16 v[52:55],a[172:175],v[112:115],v[52:55]
v_mfma_f32_16x16x32_bf16 v[68:71],v[112:115],v[172:175],v[68:71]
v_mfma_f32_16x16x32_bf16 v[36:39],a[44:47],v[112:115],v[36:39]
s_waitcnt vmcnt(0)
s_barrier
s_or_b32 s72,s72,s52
buffer_store_dword v17,off,s[8:11],s72 sc1
s_waitcnt lgkmcnt(2)
v_mfma_f32_16x16x32_bf16 v[40:43],a[176:179],v[72:75],v[40:43]
ds_read_b128 v[108:111],v4 offset:16384
v_mfma_f32_16x16x32_bf16 v[56:59],v[72:75],v[176:179],v[56:59]
v_mfma_f32_16x16x32_bf16 v[24:27],a[48:51],v[72:75],v[24:27]
ds_read_b128 v[112:115],v4 offset:20480
v_mfma_f32_16x16x32_bf16 v[44:47],a[176:179],v[76:79],v[44:47]
v_mfma_f32_16x16x32_bf16 v[60:63],v[76:79],v[176:179],v[60:63]
v_mfma_f32_16x16x32_bf16 v[28:31],a[48:51],v[76:79],v[28:31]
v_mfma_f32_16x16x32_bf16 v[48:51],a[184:187],v[72:75],v[48:51]
v_mfma_f32_16x16x32_bf16 v[64:67],v[72:75],v[184:187],v[64:67]
v_mfma_f32_16x16x32_bf16 v[32:35],a[56:59],v[72:75],v[32:35]
v_mfma_f32_16x16x32_bf16 v[52:55],a[184:187],v[76:79],v[52:55]
v_mfma_f32_16x16x32_bf16 v[68:71],v[76:79],v[184:187],v[68:71]
v_mfma_f32_16x16x32_bf16 v[36:39],a[56:59],v[76:79],v[36:39]
s_waitcnt lgkmcnt(2)
v_mfma_f32_16x16x32_bf16 v[40:43],a[180:183],v[80:83],v[40:43]
ds_read_b128 v[72:75],v5 offset:16384
v_mfma_f32_16x16x32_bf16 v[56:59],v[80:83],v[180:183],v[56:59]
v_mfma_f32_16x16x32_bf16 v[24:27],a[52:55],v[80:83],v[24:27]
ds_read_b128 v[76:79],v5 offset:20480
v_mfma_f32_16x16x32_bf16 v[44:47],a[180:183],v[84:87],v[44:47]
v_mfma_f32_16x16x32_bf16 v[60:63],v[84:87],v[180:183],v[60:63]
v_mfma_f32_16x16x32_bf16 v[28:31],a[52:55],v[84:87],v[28:31]
v_mfma_f32_16x16x32_bf16 v[48:51],a[188:191],v[80:83],v[48:51]
v_mfma_f32_16x16x32_bf16 v[64:67],v[80:83],v[188:191],v[64:67]
v_mfma_f32_16x16x32_bf16 v[32:35],a[60:63],v[80:83],v[32:35]
v_mfma_f32_16x16x32_bf16 v[52:55],a[188:191],v[84:87],v[52:55]
v_mfma_f32_16x16x32_bf16 v[68:71],v[84:87],v[188:191],v[68:71]
v_mfma_f32_16x16x32_bf16 v[36:39],a[60:63],v[84:87],v[36:39]
s_waitcnt lgkmcnt(2)
v_mfma_f32_16x16x32_bf16 v[40:43],a[192:195],v[108:111],v[40:43]
ds_read_b128 v[80:83],v6 offset:16384
v_mfma_f32_16x16x32_bf16 v[56:59],v[108:111],v[192:195],v[56:59]
v_mfma_f32_16x16x32_bf16 v[24:27],a[64:67],v[108:111],v[24:27]
ds_read_b128 v[84:87],v6 offset:20480
v_mfma_f32_16x16x32_bf16 v[44:47],a[192:195],v[112:115],v[44:47]
v_mfma_f32_16x16x32_bf16 v[60:63],v[112:115],v[192:195],v[60:63]
v_mfma_f32_16x16x32_bf16 v[28:31],a[64:67],v[112:115],v[28:31]
v_mfma_f32_16x16x32_bf16 v[48:51],a[200:203],v[108:111],v[48:51]
v_mfma_f32_16x16x32_bf16 v[64:67],v[108:111],v[200:203],v[64:67]
v_mfma_f32_16x16x32_bf16 v[32:35],a[72:75],v[108:111],v[32:35]
v_mfma_f32_16x16x32_bf16 v[52:55],a[200:203],v[112:115],v[52:55]
v_mfma_f32_16x16x32_bf16 v[68:71],v[112:115],v[200:203],v[68:71]
v_mfma_f32_16x16x32_bf16 v[36:39],a[72:75],v[112:115],v[36:39]
s_waitcnt lgkmcnt(2)
v_mfma_f32_16x16x32_bf16 v[40:43],a[196:199],v[72:75],v[40:43]
ds_read_b128 v[108:111],v7 offset:16384
v_mfma_f32_16x16x32_bf16 v[56:59],v[72:75],v[196:199],v[56:59]
v_mfma_f32_16x16x32_bf16 v[24:27],a[68:71],v[72:75],v[24:27]
ds_read_b128 v[112:115],v7 offset:20480
v_mfma_f32_16x16x32_bf16 v[44:47],a[196:199],v[76:79],v[44:47]
v_mfma_f32_16x16x32_bf16 v[60:63],v[76:79],v[196:199],v[60:63]
v_mfma_f32_16x16x32_bf16 v[28:31],a[68:71],v[76:79],v[28:31]
v_mfma_f32_16x16x32_bf16 v[48:51],a[204:207],v[72:75],v[48:51]
v_mfma_f32_16x16x32_bf16 v[64:67],v[72:75],v[204:207],v[64:67]
v_mfma_f32_16x16x32_bf16 v[32:35],a[76:79],v[72:75],v[32:35]
v_mfma_f32_16x16x32_bf16 v[52:55],a[204:207],v[76:79],v[52:55]
v_mfma_f32_16x16x32_bf16 v[68:71],v[76:79],v[204:207],v[68:71]
v_mfma_f32_16x16x32_bf16 v[36:39],a[76:79],v[76:79],v[36:39]
s_waitcnt lgkmcnt(2)
v_mfma_f32_16x16x32_bf16 v[40:43],a[208:211],v[80:83],v[40:43]
ds_read_b128 v[72:75],v8 offset:16384
v_mfma_f32_16x16x32_bf16 v[56:59],v[80:83],v[208:211],v[56:59]
v_mfma_f32_16x16x32_bf16 v[24:27],a[80:83],v[80:83],v[24:27]
ds_read_b128 v[76:79],v8 offset:20480
v_mfma_f32_16x16x32_bf16 v[44:47],a[208:211],v[84:87],v[44:47]
v_mfma_f32_16x16x32_bf16 v[60:63],v[84:87],v[208:211],v[60:63]
v_mfma_f32_16x16x32_bf16 v[28:31],a[80:83],v[84:87],v[28:31]
v_mfma_f32_16x16x32_bf16 v[48:51],a[216:219],v[80:83],v[48:51]
v_mfma_f32_16x16x32_bf16 v[64:67],v[80:83],v[216:219],v[64:67]
v_mfma_f32_16x16x32_bf16 v[32:35],a[88:91],v[80:83],v[32:35]
v_mfma_f32_16x16x32_bf16 v[52:55],a[216:219],v[84:87],v[52:55]
v_mfma_f32_16x16x32_bf16 v[68:71],v[84:87],v[216:219],v[68:71]
v_mfma_f32_16x16x32_bf16 v[36:39],a[88:91],v[84:87],v[36:39]
s_waitcnt lgkmcnt(2)
v_mfma_f32_16x16x32_bf16 v[40:43],a[212:215],v[108:111],v[40:43]
ds_read_b128 v[80:83],v9 offset:16384
v_mfma_f32_16x16x32_bf16 v[56:59],v[108:111],v[212:215],v[56:59]
v_mfma_f32_16x16x32_bf16 v[24:27],a[84:87],v[108:111],v[24:27]
ds_read_b128 v[84:87],v9 offset:20480
v_mfma_f32_16x16x32_bf16 v[44:47],a[212:215],v[112:115],v[44:47]
v_mfma_f32_16x16x32_bf16 v[60:63],v[112:115],v[212:215],v[60:63]
v_mfma_f32_16x16x32_bf16 v[28:31],a[84:87],v[112:115],v[28:31]
v_mfma_f32_16x16x32_bf16 v[48:51],a[220:223],v[108:111],v[48:51]
v_mfma_f32_16x16x32_bf16 v[64:67],v[108:111],v[220:223],v[64:67]
v_mfma_f32_16x16x32_bf16 v[32:35],a[92:95],v[108:111],v[32:35]
v_mfma_f32_16x16x32_bf16 v[52:55],a[220:223],v[112:115],v[52:55]
v_mfma_f32_16x16x32_bf16 v[68:71],v[112:115],v[220:223],v[68:71]
v_mfma_f32_16x16x32_bf16 v[36:39],a[92:95],v[112:115],v[36:39]
s_barrier
s_waitcnt lgkmcnt(2)
v_mfma_f32_16x16x32_bf16 v[40:43],a[224:227],v[72:75],v[40:43]
ds_read_b128 v[108:111],v10 offset:16384
v_mfma_f32_16x16x32_bf16 v[56:59],v[72:75],v[224:227],v[56:59]
s_add_u32 m0,s50,131072
v_mfma_f32_16x16x32_bf16 v[24:27],a[96:99],v[72:75],v[24:27]
ds_read_b128 v[112:115],v10 offset:20480
v_mfma_f32_16x16x32_bf16 v[44:47],a[224:227],v[76:79],v[44:47]
buffer_load_dwordx4 v20,s[8:11],s70 offen offset:0 sc1 lds
v_mfma_f32_16x16x32_bf16 v[60:63],v[76:79],v[224:227],v[60:63]
s_add_u32 m0,s50,135168
v_mfma_f32_16x16x32_bf16 v[28:31],a[96:99],v[76:79],v[28:31]
buffer_load_dwordx4 v20,s[8:11],s71 offen offset:0 sc1 lds
v_mfma_f32_16x16x32_bf16 v[48:51],a[232:235],v[72:75],v[48:51]
s_add_u32 m0,s50,139008
v_mfma_f32_16x16x32_bf16 v[64:67],v[72:75],v[232:235],v[64:67]
buffer_load_dwordx4 v20,s[8:11],s70 offen offset:256 sc1 lds
v_mfma_f32_16x16x32_bf16 v[32:35],a[104:107],v[72:75],v[32:35]
s_add_u32 m0,s50,143104
v_mfma_f32_16x16x32_bf16 v[52:55],a[232:235],v[76:79],v[52:55]
buffer_load_dwordx4 v20,s[8:11],s71 offen offset:256 sc1 lds
v_mfma_f32_16x16x32_bf16 v[68:71],v[76:79],v[232:235],v[68:71]
v_mfma_f32_16x16x32_bf16 v[36:39],a[104:107],v[76:79],v[36:39]
s_waitcnt lgkmcnt(2)
v_mfma_f32_16x16x32_bf16 v[40:43],a[228:231],v[80:83],v[40:43]
ds_read_b128 v[72:75],v11 offset:16384
v_mfma_f32_16x16x32_bf16 v[56:59],v[80:83],v[228:231],v[56:59]
v_mfma_f32_16x16x32_bf16 v[24:27],a[100:103],v[80:83],v[24:27]
ds_read_b128 v[76:79],v11 offset:20480
v_mfma_f32_16x16x32_bf16 v[44:47],a[228:231],v[84:87],v[44:47]
v_mfma_f32_16x16x32_bf16 v[60:63],v[84:87],v[228:231],v[60:63]
v_mfma_f32_16x16x32_bf16 v[28:31],a[100:103],v[84:87],v[28:31]
v_mfma_f32_16x16x32_bf16 v[48:51],a[236:239],v[80:83],v[48:51]
v_mfma_f32_16x16x32_bf16 v[64:67],v[80:83],v[236:239],v[64:67]
v_mfma_f32_16x16x32_bf16 v[32:35],a[108:111],v[80:83],v[32:35]
v_mfma_f32_16x16x32_bf16 v[52:55],a[236:239],v[84:87],v[52:55]
v_mfma_f32_16x16x32_bf16 v[68:71],v[84:87],v[236:239],v[68:71]
v_mfma_f32_16x16x32_bf16 v[36:39],a[108:111],v[84:87],v[36:39]
s_waitcnt lgkmcnt(2)
v_mfma_f32_16x16x32_bf16 v[40:43],a[240:243],v[108:111],v[40:43]
v_mfma_f32_16x16x32_bf16 v[56:59],v[108:111],v[240:243],v[56:59]
v_mfma_f32_16x16x32_bf16 v[24:27],a[112:115],v[108:111],v[24:27]
v_mfma_f32_16x16x32_bf16 v[44:47],a[240:243],v[112:115],v[44:47]
v_mfma_f32_16x16x32_bf16 v[60:63],v[112:115],v[240:243],v[60:63]
v_mfma_f32_16x16x32_bf16 v[28:31],a[112:115],v[112:115],v[28:31]
v_mfma_f32_16x16x32_bf16 v[48:51],a[248:251],v[108:111],v[48:51]
v_mfma_f32_16x16x32_bf16 v[64:67],v[108:111],v[248:251],v[64:67]
v_mfma_f32_16x16x32_bf16 v[32:35],a[120:123],v[108:111],v[32:35]
v_mfma_f32_16x16x32_bf16 v[52:55],a[248:251],v[112:115],v[52:55]
v_mfma_f32_16x16x32_bf16 v[68:71],v[112:115],v[248:251],v[68:71]
v_mfma_f32_16x16x32_bf16 v[36:39],a[120:123],v[112:115],v[36:39]
s_waitcnt lgkmcnt(0)
v_mfma_f32_16x16x32_bf16 v[40:43],a[244:247],v[72:75],v[40:43]
v_mfma_f32_16x16x32_bf16 v[56:59],v[72:75],v[244:247],v[56:59]
v_mfma_f32_16x16x32_bf16 v[24:27],a[116:119],v[72:75],v[24:27]
v_mfma_f32_16x16x32_bf16 v[44:47],a[244:247],v[76:79],v[44:47]
v_mfma_f32_16x16x32_bf16 v[60:63],v[76:79],v[244:247],v[60:63]
v_mfma_f32_16x16x32_bf16 v[28:31],a[116:119],v[76:79],v[28:31]
v_mfma_f32_16x16x32_bf16 v[48:51],a[252:255],v[72:75],v[48:51]
v_mfma_f32_16x16x32_bf16 v[64:67],v[72:75],v[252:255],v[64:67]
v_mfma_f32_16x16x32_bf16 v[32:35],a[124:127],v[72:75],v[32:35]
v_mfma_f32_16x16x32_bf16 v[52:55],a[252:255],v[76:79],v[52:55]
v_mfma_f32_16x16x32_bf16 v[68:71],v[76:79],v[252:255],v[68:71]
v_mfma_f32_16x16x32_bf16 v[36:39],a[124:127],v[76:79],v[36:39]
s_lshl_b32 s56,s51,5
s_add_u32 s56,s56,s47
s_lshl_b32 s56,s56,12
s_add_u32 s56,s56,s50
s_add_u32 s56,s56,41943040
v_mov_b64 v[120:121],-1
v_mov_b64 v[122:123],-1
buffer_store_dwordx4 v[120:123],v0,s[8:11],s56 offen sc1
v_cvt_pk_bf16_f32 v72,v40,v48
v_cvt_pk_bf16_f32 v73,v41,v49
v_cvt_pk_bf16_f32 v74,v42,v50
v_cvt_pk_bf16_f32 v75,v43,v51
buffer_store_dwordx4 v[72:75],v0,s[8:11],s61 offen sc1
v_cvt_pk_bf16_f32 v76,v44,v52
v_cvt_pk_bf16_f32 v77,v45,v53
v_cvt_pk_bf16_f32 v78,v46,v54
v_cvt_pk_bf16_f32 v79,v47,v55
buffer_store_dwordx4 v[76:79],v0,s[8:11],s62 offen sc1
v_cvt_pk_bf16_f32 v80,v56,v57
v_cvt_pk_bf16_f32 v81,v58,v59
v_cvt_pk_bf16_f32 v82,v60,v61
v_cvt_pk_bf16_f32 v83,v62,v63
buffer_store_dwordx4 v[80:83],v0,s[8:11],s65 offen offset:0 sc1
v_cvt_pk_bf16_f32 v84,v64,v65
v_cvt_pk_bf16_f32 v85,v66,v67
v_cvt_pk_bf16_f32 v86,v68,v69
v_cvt_pk_bf16_f32 v87,v70,v71
buffer_store_dwordx4 v[84:87],v0,s[8:11],s65 offen offset:1024 sc1
v_cvt_pk_bf16_f32 v108,v24,v32
v_cvt_pk_bf16_f32 v109,v25,v33
v_cvt_pk_bf16_f32 v110,v26,v34
v_cvt_pk_bf16_f32 v111,v27,v35
buffer_store_dwordx4 v[108:111],v0,s[8:11],s63 offen sc1
v_cvt_pk_bf16_f32 v112,v28,v36
v_cvt_pk_bf16_f32 v113,v29,v37
v_cvt_pk_bf16_f32 v114,v30,v38
v_cvt_pk_bf16_f32 v115,v31,v39
buffer_store_dwordx4 v[112:115],v0,s[8:11],s64 offen sc1
s_lshl_b32 s72,s51,13
s_lshl2_add_u32 s72,s47,s72
s_add_u32 s72,s72,10485760
s_add_u32 s51,s51,1
s_sub_u32 s53,s53,1
s_cmp_gt_u32 s53,0
s_cbranch_scc1 L_chl_147
s_waitcnt vmcnt(0)
s_barrier
s_or_b32 s72,s72,s52
buffer_store_dword v17,off,s[8:11],s72 sc1
L_chd_146:
s_cmp_lg_u32 s3,0
s_cbranch_scc1 L_wc
s_cmp_eq_u32 s48,1
s_cbranch_scc1 L_rc1_148
s_cmp_eq_u32 s48,2
s_cbranch_scc1 L_rc2_149
v_and_b32 v120,15,v1
v_lshrrev_b32 v121,4,v1
v_and_b32 v122,2,v1
v_cmp_eq_u32 vcc,0,v122
v_mov_b32 v2,0xeeee
v_mov_b32 v123,0x4444
v_cndmask_b32 v2,v2,v123,vcc
v_and_b32 v122,1,v1
v_cmp_eq_u32 vcc,0,v122
v_mov_b32 v3,0xdddd
v_mov_b32 v123,0x8888
v_cndmask_b32 v3,v3,v123,vcc
v_lshrrev_b32 v122,1,v120
v_bfe_u32 v123,v120,2,1
v_xor_b32 v123,v123,v122
v_lshlrev_b32 v4,7,v123
v_and_b32 v123,1,v120
v_lshl_add_u32 v4,v123,6,v4
v_xor_b32 v123,v121,v122
v_and_b32 v123,3,v123
v_lshl_add_u32 v4,v123,4,v4
s_lshl_b32 s56,s46,10
s_add_u32 s56,s56,147456
v_add_u32 v4,s56,v4
v_lshlrev_b32 v122,1,v121
v_add_u32 v122,0,v122
v_and_b32 v123,1,v121
v_xor_b32 v123,v123,v122
v_lshlrev_b32 v5,7,v123
v_bfe_u32 v123,v120,3,1
v_lshl_add_u32 v5,v123,6,v5
v_xor_b32 v123,v120,v122
v_and_b32 v123,3,v123
v_lshl_add_u32 v5,v123,4,v5
v_bfe_u32 v123,v120,2,1
v_lshl_add_u32 v5,v123,3,v5
v_add_u32 v5,147456,v5
v_lshlrev_b32 v122,1,v121
v_add_u32 v122,1,v122
v_and_b32 v123,1,v121
v_xor_b32 v123,v123,v122
v_lshlrev_b32 v6,7,v123
v_bfe_u32 v123,v120,3,1
v_lshl_add_u32 v6,v123,6,v6
v_xor_b32 v123,v120,v122
v_and_b32 v123,3,v123
v_lshl_add_u32 v6,v123,4,v6
v_bfe_u32 v123,v120,2,1
v_lshl_add_u32 v6,v123,3,v6
v_add_u32 v6,147456,v6
v_lshlrev_b32 v7,7,v121
v_lshrrev_b32 v122,1,v120
v_lshl_add_u32 v8,v122,4,v7
v_add_u32 v8,151552,v8
v_lshrrev_b32 v122,2,v120
v_lshl_add_u32 v7,v122,5,v7
v_and_b32 v122,1,v120
v_lshl_add_u32 v7,v122,4,v7
v_and_b32 v122,2,v120
v_cmp_eq_u32 vcc,0,v122
s_lshl_b32 s56,s46,9
v_mov_b32 v122,2048
v_mov_b32 v123,s56
v_cndmask_b32 v122,v122,v123,vcc
v_add_u32 v7,v122,v7
v_add_u32 v7,151552,v7
v_lshrrev_b32 v122,3,v1
v_lshlrev_b32 v9,11,v122
v_and_b32 v122,7,v1
v_lshl_add_u32 v9,v122,3,v9
s_lshl_b32 s56,s46,14
s_lshl_b32 s57,s47,6
s_add_u32 s56,s56,s57
v_add_u32 v9,s56,v9
s_lshl_b32 s71,s46,5
s_add_u32 s71,s71,s47
s_bfe_u32 s56,s71,0x10003
s_lshl_b32 s56,s56,11
s_and_b32 s57,s71,1
s_lshl_b32 s57,s57,10
s_add_u32 s56,s56,s57
s_bfe_u32 s57,s71,0x10002
s_lshl_b32 s57,s57,9
s_add_u32 s56,s56,s57
s_bfe_u32 s57,s71,0x10001
s_lshl_b32 s57,s57,6
s_add_u32 s56,s56,s57
s_bfe_u32 s57,s71,0x10004
s_lshl_b32 s57,s57,8
s_add_u32 s56,s56,s57
s_bfe_u32 s57,s71,0x10005
s_lshl_b32 s57,s57,7
s_add_u32 s56,s56,s57
s_bfe_u32 s57,s71,0x10006
s_lshl_b32 s57,s57,12
s_add_u32 s56,s56,s57
v_and_b32 v122,3,v120
v_lshlrev_b32 v10,2,v122
v_bfe_u32 v122,v120,3,1
v_lshl_add_u32 v10,v122,4,v10
v_and_b32 v122,1,v121
v_lshl_add_u32 v10,v122,5,v10
v_add_u32 v10,s56,v10
v_and_b32 v123,36,v1
v_mov_b32 v122,0x80000000
v_cmp_eq_u32 vcc,0,v123
s_nop 1
v_cndmask_b32 v10,v122,v10,vcc
s_lshl_b32 s71,s71,11
s_lshl_b32 s73,s46,11
s_mov_b32 s72,0xffc00000
s_mov_b32 s74,0
v_and_b32 v11,1,v121
v_xor_b32 v11,v11,v120
v_and_b32 v11,3,v11
v_lshrrev_b32 v122,2,v120
v_lshl_add_u32 v11,v11,2,v122
v_lshl_add_u32 v11,v121,4,v11
v_lshlrev_b32 v11,4,v11
s_lshl_b32 s56,s46,15
v_add_u32 v11,s56,v11
v_lshrrev_b32 v13,3,v1
v_lshlrev_b32 v13,9,v13
v_and_b32 v122,7,v1
v_lshl_add_u32 v13,v122,4,v13
v_and_b32 v122,15,v1
v_and_b32 v123,1,v1
v_lshlrev_b32 v123,4,v123
v_mov_b32 v124,0x3f80
v_lshlrev_b32 v124,v123,v124
v_lshrrev_b32 v122,1,v122
v_cmp_eq_u32 vcc,0,v122
s_nop 1
v_cndmask_b32 v18,0,v124,vcc
v_cmp_eq_u32 vcc,1,v122
s_nop 1
v_cndmask_b32 v19,0,v124,vcc
v_cmp_eq_u32 vcc,2,v122
s_nop 1
v_cndmask_b32 v20,0,v124,vcc
v_cmp_eq_u32 vcc,3,v122
s_nop 1
v_cndmask_b32 v21,0,v124,vcc
s_and_b32 s56,s46,1
s_lshl_b32 s56,s56,8
s_and_b32 s57,s46,2
s_lshl_b32 s57,s57,6
s_add_u32 s56,s56,s57
v_add_u32 v13,s56,v13
s_add_u32 s56,s50,155648
v_add_u32 v12,s56,v0
v_mov_b64 v[14:15],s[28:29]
v_mov_b64 v[16:17],s[28:29]
v_add_u32 v22,11550720,v10
s_lshl_b32 s18,s47,2
s_add_u32 s18,s18,10493952
v_mov_b32 v1,s80
s_mov_b32 s65,14680064
s_add_u32 s66,s71,14680064
s_add_u32 s69,s71,14942208
s_mov_b32 s30,0x40000000
s_mov_b32 s51,0
buffer_load_dwordx4 v[88:91],v0,s[8:11],s66 offen offset:0
buffer_load_dwordx4 v[88:91],v0,s[8:11],s66 offen offset:1024
buffer_load_dwordx4 v[88:91],v0,s[8:11],s69 offen offset:0
buffer_load_dwordx4 v[88:91],v0,s[8:11],s69 offen offset:1024
L_cst_153:
s_cmp_lg_u32 s46,0
s_cbranch_scc1 L_csw_158
s_lshl_b32 s59,s51,13
s_lshl2_add_u32 s59,s47,s59
s_add_u32 s59,s59,10485760
s_buffer_load_dword s61,s[8:11],s59
s_waitcnt lgkmcnt(0)
s_cmp_lg_u32 s61,0
s_cbranch_scc1 L_wwd_160
L_ww_159:
s_sleep 1
buffer_load_dword v122,off,s[8:11],s59 sc1
s_sub_u32 s49,s49,1
s_cbranch_scc1 L_abort
s_waitcnt vmcnt(0)
v_readfirstlane_b32 s61,v122
s_cmp_eq_u32 s61,0
s_cbranch_scc1 L_ww_159
L_wwd_160:
L_csw_158:
s_waitcnt lgkmcnt(0)
s_barrier
s_lshl_b32 s56,s51,5
s_add_u32 s56,s56,s47
s_mul_i32 s56,s56,24576
s_add_u32 s56,s56,100663296
s_add_u32 s67,s56,s73
s_add_u32 m0,s73,131072
s_add_u32 s57,s67,8192
buffer_load_dwordx4 v0,s[8:11],s67 offen sc1 lds
buffer_load_dwordx4 v0,s[8:11],s67 offen offset:1024 sc1 lds
s_add_u32 m0,s73,139264
s_add_u32 s67,s67,786432
buffer_load_dwordx4 v0,s[8:11],s57 offen sc1 lds
buffer_load_dwordx4 v0,s[8:11],s57 offen offset:1024 sc1 lds
s_lshl_b32 s75,s51,13
s_add_u32 s56,s75,11542528
buffer_load_dword v23,v10,s[8:11],s56 offen sc1
s_add_u32 s64,s75,11534336
s_add_u32 s70,s64,4096
s_lshl_b32 s68,s51,5
s_add_u32 s68,s68,s47
s_lshl_b32 s68,s68,12
s_lshl_b32 s56,s46,10
s_add_u32 s68,s68,s56
s_add_u32 s68,s68,41943040
s_mov_b32 s54,0x80000000
s_mov_b32 s77,0
s_mov_b32 s19,0
s_cmp_eq_u32 s51,63
s_cselect_b32 s76,1,s46
s_cmp_eq_u32 s76,0
s_cselect_b32 s76,1,0
v_mov_b64 v[96:97],0
v_mov_b64 v[98:99],0
v_mov_b64 v[100:101],0
v_mov_b64 v[102:103],0
v_mov_b64 v[104:105],0
v_mov_b64 v[106:107],0
v_mov_b64 v[108:109],0
v_mov_b64 v[110:111],0
v_mov_b64 v[112:113],0
v_mov_b64 v[114:115],0
v_mov_b64 v[116:117],0
v_mov_b64 v[118:119],0
buffer_load_dwordx4 v[88:91],v13,s[8:11],s64 offen
buffer_load_dwordx4 v[88:91],v13,s[8:11],s70 offen
s_waitcnt vmcnt(19)
v_swap_b32 v25,v28
v_swap_b32 v26,v32
v_swap_b32 v27,v36
v_swap_b32 v30,v33
v_swap_b32 v31,v37
v_swap_b32 v35,v38
ds_write_b128 v93,v[24:27] offset:4096
ds_write_b128 v94,v[28:31] offset:4096
ds_write_b128 v93,v[32:35] offset:4224
ds_write_b128 v94,v[36:39] offset:4224
s_waitcnt vmcnt(15)
v_swap_b32 v41,v44
v_swap_b32 v42,v48
v_swap_b32 v43,v52
v_swap_b32 v46,v49
v_swap_b32 v47,v53
v_swap_b32 v51,v54
ds_write_b128 v93,v[40:43] offset:5120
ds_write_b128 v94,v[44:47] offset:5120
ds_write_b128 v93,v[48:51] offset:5248
ds_write_b128 v94,v[52:55] offset:5248
s_waitcnt vmcnt(11)
v_swap_b32 v57,v60
v_swap_b32 v58,v64
v_swap_b32 v59,v68
v_swap_b32 v62,v65
v_swap_b32 v63,v69
v_swap_b32 v67,v70
ds_write_b128 v93,v[56:59] offset:6144
ds_write_b128 v94,v[60:63] offset:6144
ds_write_b128 v93,v[64:67] offset:6272
ds_write_b128 v94,v[68:71] offset:6272
s_waitcnt vmcnt(7)
v_swap_b32 v73,v76
v_swap_b32 v74,v80
v_swap_b32 v75,v84
v_swap_b32 v78,v81
v_swap_b32 v79,v85
v_swap_b32 v83,v86
ds_write_b128 v93,v[72:75] offset:7168
ds_write_b128 v94,v[76:79] offset:7168
ds_write_b128 v93,v[80:83] offset:7296
ds_write_b128 v94,v[84:87] offset:7296
s_buffer_load_dword s19,s[8:11],s18
s_waitcnt vmcnt(0) lgkmcnt(0)
s_barrier
v_add_u32 v55,131072,v0
ds_read_b128 v[56:59],v55 offset:0
ds_read_b128 v[60:63],v55 offset:4096
ds_read_b128 v[64:67],v55 offset:1024
ds_read_b128 v[68:71],v55 offset:5120
ds_read_b128 v[72:75],v55 offset:2048
ds_read_b128 v[76:79],v55 offset:6144
ds_read_b128 v[80:83],v55 offset:3072
ds_read_b128 v[84:87],v55 offset:7168
v_add_u32 v123,s73,v55
ds_read_b128 v[88:91],v123 offset:8192
ds_read_b128 v[92:95],v123 offset:9216
v_xor_b32 v120,1024,v12
v_xor_b32 v121,2048,v12
v_xor_b32 v122,3072,v12
buffer_load_dwordx4 v[24:27],v13,s[8:11],s64 offen sc1
buffer_load_dwordx4 v[24:27],v13,s[8:11],s64 offen sc1
L_chain_161:
L_cpa_162:
buffer_load_dwordx4 v[24:27],v13,s[8:11],s64 offen sc1
s_sub_u32 s49,s49,1
s_cbranch_scc1 L_abort
s_waitcnt vmcnt(2)
v_max3_u32 v123,v24,v25,v26
v_max_u32 v123,v27,v123
v_cmp_le_u32 vcc,s72,v123
ds_write_b128 v12,v[24:27] offset:0
s_cbranch_vccnz L_cpa_162
L_cgo_165:
v_smfmac_f32_16x16x64_bf16 v[96:99],v[24:27],a[0:7],v2
buffer_load_dwordx4 v[40:43],v13,s[8:11],s70 offen sc1
v_smfmac_f32_16x16x64_bf16 v[100:103],v[24:27],a[128:135],v2
s_waitcnt lgkmcnt(0)
s_barrier
ds_read_b128 v[28:31],v120 offset:0
v_smfmac_f32_16x16x64_bf16 v[104:107],v[24:27],a[8:15],v2
ds_read_b128 v[32:35],v121 offset:0
v_smfmac_f32_16x16x64_bf16 v[108:111],v[24:27],a[136:143],v2
ds_read_b128 v[36:39],v122 offset:0
v_smfmac_f32_16x16x64_bf16 v[112:115],v[24:27],v[128:135],v2
v_smfmac_f32_16x16x64_bf16 v[116:119],v[24:27],v[136:143],v2
s_waitcnt lgkmcnt(2)
v_smfmac_f32_16x16x64_bf16 v[96:99],v[28:31],a[16:23],v2
s_add_u32 m0,s73,131072
v_smfmac_f32_16x16x64_bf16 v[100:103],v[28:31],a[144:151],v2
s_add_u32 s57,s67,8192
v_smfmac_f32_16x16x64_bf16 v[104:107],v[28:31],a[24:31],v2
s_cmp_lt_u32 s19,s76
s_cbranch_scc1 L_ckw_154
L_ckb_155:
v_smfmac_f32_16x16x64_bf16 v[108:111],v[28:31],a[152:159],v2
s_waitcnt vmcnt(0) lgkmcnt(1)
v_smfmac_f32_16x16x64_bf16 v[96:99],v[32:35],a[32:39],v2
ds_write_b128 v12,v[40:43] offset:4096
v_max3_u32 v123,v40,v41,v42
v_smfmac_f32_16x16x64_bf16 v[100:103],v[32:35],a[160:167],v2
v_max_u32 v123,v43,v123
v_smfmac_f32_16x16x64_bf16 v[104:107],v[32:35],a[40:47],v2
v_cmp_le_u32 vcc,s72,v123
v_smfmac_f32_16x16x64_bf16 v[108:111],v[32:35],a[168:175],v2
v_smfmac_f32_16x16x64_bf16 v[112:115],v[28:31],v[144:151],v2
s_cbranch_vccnz L_cpb_168
L_cback_170:
s_waitcnt lgkmcnt(0)
s_barrier
v_smfmac_f32_16x16x64_bf16 v[96:99],v[36:39],a[48:55],v2
buffer_store_dwordx4 v[124:127],v0,s[8:11],s54 offen sc1
v_smfmac_f32_16x16x64_bf16 v[100:103],v[36:39],a[176:183],v2
ds_read_b128 v[44:47],v120 offset:4096
v_smfmac_f32_16x16x64_bf16 v[104:107],v[36:39],a[56:63],v2
buffer_load_dwordx4 v0,s[8:11],s67 offen sc1 lds
v_smfmac_f32_16x16x64_bf16 v[108:111],v[36:39],a[184:191],v2
ds_read_b128 v[48:51],v121 offset:4096
v_smfmac_f32_16x16x64_bf16 v[96:99],v[40:43],a[64:71],v2
buffer_load_dwordx4 v0,s[8:11],s67 offen offset:1024 sc1 lds
s_add_u32 m0,s73,139264
v_smfmac_f32_16x16x64_bf16 v[100:103],v[40:43],a[192:199],v2
ds_read_b128 v[52:55],v122 offset:4096
v_smfmac_f32_16x16x64_bf16 v[104:107],v[40:43],a[72:79],v2
buffer_load_dwordx4 v0,s[8:11],s57 offen sc1 lds
s_add_u32 s67,s67,786432
v_smfmac_f32_16x16x64_bf16 v[108:111],v[40:43],a[200:207],v2
s_waitcnt lgkmcnt(2)
v_smfmac_f32_16x16x64_bf16 v[96:99],v[44:47],a[80:87],v2
buffer_load_dwordx4 v0,s[8:11],s57 offen offset:1024 sc1 lds
v_smfmac_f32_16x16x64_bf16 v[100:103],v[44:47],a[208:215],v2
s_waitcnt lgkmcnt(1)
v_smfmac_f32_16x16x64_bf16 v[96:99],v[48:51],a[96:103],v2
buffer_load_dword v23,v22,s[8:11],s75 offen sc1
v_smfmac_f32_16x16x64_bf16 v[100:103],v[48:51],a[224:231],v2
s_waitcnt lgkmcnt(0)
v_smfmac_f32_16x16x64_bf16 v[96:99],v[52:55],a[112:119],v2
v_smfmac_f32_16x16x64_bf16 v[100:103],v[52:55],a[240:247],v2
v_smfmac_f32_16x16x64_bf16 v[104:107],v[44:47],a[88:95],v2
v_smfmac_f32_16x16x64_bf16 v[108:111],v[44:47],a[216:223],v2
v_smfmac_f32_16x16x64_bf16 v[104:107],v[48:51],a[104:111],v2
v_add_f32 v96,v96,v98
v_smfmac_f32_16x16x64_bf16 v[108:111],v[48:51],a[232:239],v2
v_add_f32 v97,v97,v99
v_smfmac_f32_16x16x64_bf16 v[104:107],v[52:55],a[120:127],v2
v_cvt_pk_bf16_f32 v120,v96,v97
v_smfmac_f32_16x16x64_bf16 v[108:111],v[52:55],a[248:255],v2
v_add_f32 v100,v100,v102
v_smfmac_f32_16x16x64_bf16 v[116:119],v[28:31],v[152:159],v2
v_add_f32 v101,v101,v103
v_smfmac_f32_16x16x64_bf16 v[112:115],v[32:35],v[160:167],v2
v_cvt_pk_bf16_f32 v121,v100,v101
v_add_f32 v104,v104,v106
v_add_f32 v105,v105,v107
v_cvt_pk_bf16_f32 v122,v104,v105
v_add_f32 v108,v108,v110
v_add_f32 v109,v109,v111
v_cvt_pk_bf16_f32 v123,v108,v109
ds_write_b128 v4,v[120:123]
v_smfmac_f32_16x16x64_bf16 v[116:119],v[32:35],v[168:175],v2
s_mov_b32 s54,s68
s_add_u32 s68,s68,131072
v_mov_b32 v125,0
v_smfmac_f32_16x16x64_bf16 v[112:115],v[36:39],v[176:183],v2
s_cmp_eq_u32 s51,63
s_cbranch_scc1 L_cend_164
v_smfmac_f32_16x16x64_bf16 v[116:119],v[36:39],v[184:191],v2
v_smfmac_f32_16x16x64_bf16 v[112:115],v[40:43],v[192:199],v2
s_waitcnt lgkmcnt(0)
s_barrier
ds_read_b64_tr_b16 v[96:97],v5 offset:0
ds_read_b64_tr_b16 v[98:99],v6 offset:0
v_smfmac_f32_16x16x64_bf16 v[116:119],v[40:43],v[200:207],v2
ds_read_b64_tr_b16 v[100:101],v5 offset:1024
v_smfmac_f32_16x16x64_bf16 v[112:115],v[44:47],v[208:215],v2
ds_read_b64_tr_b16 v[102:103],v6 offset:1024
v_smfmac_f32_16x16x64_bf16 v[116:119],v[44:47],v[216:223],v2
ds_read_b64_tr_b16 v[104:105],v5 offset:2048
v_smfmac_f32_16x16x64_bf16 v[112:115],v[48:51],v[224:231],v2
ds_read_b64_tr_b16 v[106:107],v6 offset:2048
s_waitcnt lgkmcnt(4)
v_mfma_f32_16x16x32_bf16 v[24:27],v[56:59],v[96:99],0
ds_read_b64_tr_b16 v[108:109],v5 offset:3072
v_mfma_f32_16x16x32_bf16 v[28:31],v[60:63],v[96:99],0
ds_read_b64_tr_b16 v[110:111],v6 offset:3072
v_mfma_f32_16x16x32_bf16 v[32:35],v[96:99],v[96:99],0
ds_read_b128 v[40:43],v11 offset:12288
s_waitcnt lgkmcnt(5)
v_mfma_f32_16x16x32_bf16 v[24:27],v[64:67],v[100:103],v[24:27]
ds_read_b128 v[56:59],v11 offset:0
v_mfma_f32_16x16x32_bf16 v[28:31],v[68:71],v[100:103],v[28:31]
ds_read_b128 v[60:63],v11 offset:1024
v_mfma_f32_16x16x32_bf16 v[32:35],v[100:103],v[100:103],v[32:35]
ds_read_b128 v[96:99],v11 offset:8192
s_waitcnt lgkmcnt(6)
v_mfma_f32_16x16x32_bf16 v[24:27],v[72:75],v[104:107],v[24:27]
ds_read_b128 v[64:67],v11 offset:2048
v_mfma_f32_16x16x32_bf16 v[28:31],v[76:79],v[104:107],v[28:31]
ds_read_b128 v[68:71],v11 offset:3072
v_mfma_f32_16x16x32_bf16 v[32:35],v[104:107],v[104:107],v[32:35]
ds_read_b128 v[100:103],v11 offset:9216
s_waitcnt lgkmcnt(7)
v_mfma_f32_16x16x32_bf16 v[24:27],v[80:83],v[108:111],v[24:27]
ds_read_b128 v[72:75],v11 offset:4096
v_mfma_f32_16x16x32_bf16 v[28:31],v[84:87],v[108:111],v[28:31]
ds_read_b128 v[76:79],v11 offset:5120
v_mfma_f32_16x16x32_bf16 v[32:35],v[108:111],v[108:111],v[32:35]
ds_read_b128 v[104:107],v11 offset:10240
v_smfmac_f32_16x16x64_bf16 v[116:119],v[48:51],v[232:239],v2
ds_read_b128 v[80:83],v11 offset:6144
v_smfmac_f32_16x16x64_bf16 v[112:115],v[52:55],v[240:247],v2
ds_read_b128 v[84:87],v11 offset:7168
v_smfmac_f32_16x16x64_bf16 v[116:119],v[52:55],v[248:255],v2
ds_read_b128 v[108:111],v11 offset:11264
v_max3_f32 v126,v24,v25,v26
v_max3_f32 v127,v27,v28,v29
v_max3_f32 v126,v30,v31,v126
v_max3_f32 v127,v34,v35,v127
v_max_f32 v126,v126,v127
v_max_f32 v127,v126,v127
v_pk_mul_f32 v[34:35],v[34:35],v[0:1] op_sel:[0,1]
v_pk_mul_f32 v[24:25],v[24:25],v[0:1] op_sel:[0,1]
v_permlane16_swap_b32 v126,v127
v_max_f32 v126,v126,v127
v_max_f32 v127,v126,v127
v_pk_mul_f32 v[26:27],v[26:27],v[0:1] op_sel:[0,1]
v_pk_mul_f32 v[28:29],v[28:29],v[0:1] op_sel:[0,1]
v_permlane32_swap_b32 v126,v127
v_max_f32 v126,v126,v127
v_mul_f32 v126,v1,v126
v_pk_mul_f32 v[30:31],v[30:31],v[0:1] op_sel:[0,1]
v_pk_add_f32 v[34:35],v[34:35],v[126:127] op_sel_hi:[1,0] neg_lo:[0,1] neg_hi:[0,1]
v_pk_add_f32 v[112:113],v[112:113],v[114:115]
v_pk_add_f32 v[116:117],v[116:117],v[118:119]
v_pk_add_f32 v[24:25],v[24:25],v[126:127] op_sel_hi:[1,0] neg_lo:[0,1] neg_hi:[0,1]
v_pk_add_f32 v[26:27],v[26:27],v[126:127] op_sel_hi:[1,0] neg_lo:[0,1] neg_hi:[0,1]
v_pk_add_f32 v[28:29],v[28:29],v[126:127] op_sel_hi:[1,0] neg_lo:[0,1] neg_hi:[0,1]
v_pk_add_f32 v[30:31],v[30:31],v[126:127] op_sel_hi:[1,0] neg_lo:[0,1] neg_hi:[0,1]
v_exp_f32 v34,v34
v_exp_f32 v35,v35
v_cvt_pk_bf16_f32 v126,v112,v113
v_cvt_pk_bf16_f32 v124,v34,v35
v_cvt_pk_bf16_f32 v127,v116,v117
v_cvt_pk_bf16_f32 v36,v116,v117
v_mfma_f32_16x16x16_bf16 v[32:35],v[14:15],v[124:125],0
ds_read_b128 v[44:47],v11 offset:13312
v_exp_f32 v24,v24
v_mfma_f32_16x16x16_bf16 v[112:115],v[126:127],v[124:125],0
ds_read_b128 v[48:51],v11 offset:14336
v_exp_f32 v25,v25
v_mfma_f32_16x16x16_bf16 v[116:119],v[36:37],v[124:125],0
ds_read_b128 v[52:55],v11 offset:15360
v_exp_f32 v26,v26
v_exp_f32 v27,v27
v_cvt_pk_bf16_f32 v120,v24,v25
v_exp_f32 v28,v28
v_exp_f32 v29,v29
v_cvt_pk_bf16_f32 v121,v26,v27
v_exp_f32 v30,v30
v_exp_f32 v31,v31
v_cvt_pk_bf16_f32 v122,v28,v29
v_cvt_pk_bf16_f32 v123,v30,v31
s_add_u32 s75,s75,8192
s_add_u32 s51,s51,1
v_mfma_f32_16x16x32_bf16 v[32:35],v[14:17],v[120:123],v[32:35]
v_mfma_f32_16x16x32_bf16 v[112:115],v[88:91],v[120:123],v[112:115]
ds_read_b128 v[88:91],v11 offset:16384
v_mfma_f32_16x16x32_bf16 v[116:119],v[92:95],v[120:123],v[116:119]
ds_read_b128 v[92:95],v11 offset:17408
v_rcp_f32 v32,v32
v_mov_b64 v[24:25],-1
v_mov_b64 v[26:27],-1
s_add_u32 s64,s75,11534336
s_add_u32 s70,s64,4096
v_pk_mul_f32 v[112:113],v[112:113],v[32:33] op_sel_hi:[1,0]
v_pk_mul_f32 v[114:115],v[114:115],v[32:33] op_sel_hi:[1,0]
v_pk_mul_f32 v[116:117],v[116:117],v[32:33] op_sel_hi:[1,0]
v_pk_mul_f32 v[118:119],v[118:119],v[32:33] op_sel_hi:[1,0]
v_cvt_pk_bf16_f32 v120,v112,v116
v_cvt_pk_bf16_f32 v121,v113,v117
v_cvt_pk_bf16_f32 v122,v114,v118
v_cvt_pk_bf16_f32 v123,v115,v119
ds_write_b128 v7,v[120:123]
buffer_store_dwordx4 v[24:27],v0,s[8:11],s69 offen
buffer_store_dwordx4 v[24:27],v0,s[8:11],s69 offen offset:1024
v_mov_b64 v[112:113],0
v_mov_b64 v[114:115],0
v_mov_b64 v[116:117],0
v_mov_b64 v[118:119],0
s_waitcnt lgkmcnt(0)
s_barrier
ds_read_b128 v[24:27],v8 offset:0
ds_read_b128 v[28:31],v8 offset:512
ds_read_b128 v[32:35],v8 offset:1024
ds_read_b128 v[36:39],v8 offset:1536
v_mov_b64 v[120:121],0
v_mov_b64 v[122:123],0
s_add_u32 s57,s65,65536
s_add_u32 s58,s65,131072
s_add_u32 s59,s65,196608
s_add_u32 s56,s18,s75
s_waitcnt lgkmcnt(3)
v_smfmac_f32_16x16x64_bf16 v[112:115],v[24:27],v[56:63],v3
ds_read_b128 v[56:59],v11 offset:18432
s_waitcnt lgkmcnt(3)
v_smfmac_f32_16x16x64_bf16 v[112:115],v[28:31],v[64:71],v3
ds_read_b128 v[60:63],v11 offset:19456
s_waitcnt lgkmcnt(3)
v_smfmac_f32_16x16x64_bf16 v[112:115],v[32:35],v[72:79],v3
ds_read_b128 v[64:67],v11 offset:20480
s_waitcnt lgkmcnt(3)
v_smfmac_f32_16x16x64_bf16 v[112:115],v[36:39],v[80:87],v3
ds_read_b128 v[68:71],v11 offset:21504
v_smfmac_f32_16x16x64_bf16 v[116:119],v[24:27],v[96:103],v3
ds_read_b128 v[72:75],v11 offset:22528
v_smfmac_f32_16x16x64_bf16 v[116:119],v[28:31],v[104:111],v3
ds_read_b128 v[76:79],v11 offset:23552
v_cvt_pk_bf16_f32 v112,v112,v113
v_smfmac_f32_16x16x64_bf16 v[116:119],v[32:35],v[40:47],v3
ds_read_b128 v[80:83],v11 offset:24576
v_cvt_pk_bf16_f32 v113,v114,v115
buffer_store_dwordx2 v[112:113],v9,s[8:11],s65 offen
v_smfmac_f32_16x16x64_bf16 v[116:119],v[36:39],v[48:55],v3
ds_read_b128 v[84:87],v11 offset:25600
v_mov_b64 v[112:113],0
v_smfmac_f32_16x16x64_bf16 v[120:123],v[24:27],v[88:95],v3
ds_read_b128 v[96:99],v11 offset:26624
ds_read_b128 v[100:103],v11 offset:27648
v_mov_b64 v[114:115],0
s_waitcnt lgkmcnt(8)
v_smfmac_f32_16x16x64_bf16 v[120:123],v[28:31],v[56:63],v3
ds_read_b128 v[104:107],v11 offset:28672
v_cvt_pk_bf16_f32 v116,v116,v117
s_waitcnt lgkmcnt(7)
v_smfmac_f32_16x16x64_bf16 v[120:123],v[32:35],v[64:71],v3
ds_read_b128 v[108:111],v11 offset:29696
ds_read_b128 v[40:43],v11 offset:30720
v_cvt_pk_bf16_f32 v117,v118,v119
buffer_store_dwordx2 v[116:117],v9,s[8:11],s57 offen
s_waitcnt lgkmcnt(7)
v_smfmac_f32_16x16x64_bf16 v[120:123],v[36:39],v[72:79],v3
ds_read_b128 v[44:47],v11 offset:31744
v_add_u32 v52,s50,v5
s_waitcnt lgkmcnt(6)
v_smfmac_f32_16x16x64_bf16 v[112:115],v[24:27],v[80:87],v3
v_add_u32 v54,s50,v6
s_waitcnt lgkmcnt(4)
v_smfmac_f32_16x16x64_bf16 v[112:115],v[28:31],v[96:103],v3
ds_read_b64_tr_b16 v[52:53],v52
v_cvt_pk_bf16_f32 v120,v120,v121
s_waitcnt lgkmcnt(3)
v_smfmac_f32_16x16x64_bf16 v[112:115],v[32:35],v[104:111],v3
ds_read_b64_tr_b16 v[54:55],v54
v_cvt_pk_bf16_f32 v121,v122,v123
buffer_store_dwordx2 v[120:121],v9,s[8:11],s58 offen
s_waitcnt lgkmcnt(2)
v_smfmac_f32_16x16x64_bf16 v[112:115],v[36:39],v[40:47],v3
v_mov_b64 v[116:117],0
v_mov_b64 v[118:119],0
s_xor_b32 s65,s65,262144
v_mov_b32_dpp v124,v126 quad_perm:[2,3,2,3] row_mask:0xf bank_mask:0xf
v_mov_b32_dpp v125,v127 quad_perm:[2,3,2,3] row_mask:0xf bank_mask:0xf
s_mov_b32 vcc_lo,0xcccccccc
s_mov_b32 vcc_hi,0xcccccccc
s_nop 0
v_cvt_pk_bf16_f32 v112,v112,v113
v_cvt_pk_bf16_f32 v113,v114,v115
buffer_store_dwordx2 v[112:113],v9,s[8:11],s59 offen
s_waitcnt lgkmcnt(0)
s_buffer_load_dword s19,s[8:11],s56
v_cndmask_b32 v124,v124,v52,vcc
v_cndmask_b32 v125,v125,v53,vcc
v_cndmask_b32 v126,v126,v54,vcc
v_cndmask_b32 v127,v127,v55,vcc
s_cmp_lt_u32 s46,2
s_waitcnt vmcnt(3)
s_cbranch_scc1 L_crg_171
s_cmp_eq_u32 s46,2
s_waitcnt vmcnt(1)
s_cbranch_scc1 L_crg_171
s_waitcnt vmcnt(0)
L_crg_171:
buffer_load_dwordx4 v[32:35],v0,s[8:11],s66 offen offset:0 sc1
buffer_load_dwordx4 v[36:39],v0,s[8:11],s66 offen offset:1024 sc1
v_mov_b64 v[96:97],0
v_mov_b64 v[98:99],0
v_mov_b64 v[100:101],0
v_mov_b64 v[102:103],0
v_mov_b64 v[104:105],0
v_mov_b64 v[106:107],0
v_mov_b64 v[108:109],0
v_mov_b64 v[110:111],0
v_mov_b64 v[112:113],0
v_mov_b64 v[114:115],0
v_add_u32 v55,131072,v0
v_add_u32 v123,s73,v55
v_xor_b32 v120,1024,v12
v_xor_b32 v121,2048,v12
v_xor_b32 v122,3072,v12
buffer_load_dwordx4 v[44:47],v0,s[8:11],s66 offen offset:0 sc1
buffer_load_dwordx4 v[48:51],v0,s[8:11],s66 offen offset:1024 sc1
s_cmp_ge_u32 s51,63
s_cselect_b32 s76,0,1
s_cmp_eq_u32 s46,0
s_cselect_b32 s76,s76,0
s_waitcnt vmcnt(3)
v_mfma_f32_16x16x32_bf16 v[28:31],v[18:21],v[32:35],0
s_waitcnt vmcnt(2)
v_mfma_f32_16x16x32_bf16 v[28:31],v[18:21],v[36:39],v[28:31]
s_nop 7
v_cmp_u_f32 vcc,v28,v28
v_add_f32_dpp v52,v28,v28 row_ror:8 row_mask:0xf bank_mask:0x3
v_add_f32_dpp v53,v29,v29 row_ror:8 row_mask:0xf bank_mask:0x3
v_add_f32_dpp v52,v30,v30 row_ror:8 row_mask:0xf bank_mask:0xc
v_add_f32_dpp v53,v31,v31 row_ror:8 row_mask:0xf bank_mask:0xc
s_nop 0
v_add_f32_dpp v52,v52,v52 row_shl:4 row_mask:0xf bank_mask:0x5
v_add_f32_dpp v53,v53,v53 row_shl:4 row_mask:0xf bank_mask:0x5
s_cbranch_vccnz L_crp_166
L_cok_172:
v_cvt_pk_bf16_f32 v54,v52,v53
buffer_store_dword v54,v10,s[8:11],s64 offen
s_mov_b32 s69,s66
s_xor_b32 s66,s66,262144
s_barrier
ds_read_b128 v[56:59],v55 offset:0
ds_read_b128 v[60:63],v55 offset:4096
ds_read_b128 v[64:67],v55 offset:1024
buffer_load_dwordx4 v[24:27],v13,s[8:11],s64 offen sc1
ds_read_b128 v[68:71],v55 offset:5120
ds_read_b128 v[72:75],v55 offset:2048
ds_read_b128 v[76:79],v55 offset:6144
ds_read_b128 v[80:83],v55 offset:3072
buffer_load_dwordx4 v[24:27],v13,s[8:11],s64 offen sc1
ds_read_b128 v[84:87],v55 offset:7168
ds_read_b128 v[88:91],v123 offset:8192
ds_read_b128 v[92:95],v123 offset:9216
s_branch L_chain_161
L_cpb_168:
buffer_load_dwordx4 v[40:43],v13,s[8:11],s70 offen sc1
s_sub_u32 s49,s49,1
s_cbranch_scc1 L_abort
s_waitcnt vmcnt(0)
v_max3_u32 v123,v40,v41,v42
v_max_u32 v123,v43,v123
v_cmp_le_u32 vcc,s72,v123
s_cbranch_vccnz L_cpb_168
ds_write_b128 v12,v[40:43] offset:4096
s_branch L_cback_170
L_crp_166:
buffer_load_dwordx4 v[32:35],v0,s[8:11],s66 offen offset:0 sc1
buffer_load_dwordx4 v[36:39],v0,s[8:11],s66 offen offset:1024 sc1
s_sub_u32 s49,s49,1
s_cbranch_scc1 L_abort
s_waitcnt vmcnt(3)
v_mfma_f32_16x16x32_bf16 v[28:31],v[18:21],v[44:47],0
s_waitcnt vmcnt(2)
v_mfma_f32_16x16x32_bf16 v[28:31],v[18:21],v[48:51],v[28:31]
s_nop 7
v_cmp_u_f32 vcc,v28,v28
v_add_f32_dpp v52,v28,v28 row_ror:8 row_mask:0xf bank_mask:0x3
v_add_f32_dpp v53,v29,v29 row_ror:8 row_mask:0xf bank_mask:0x3
v_add_f32_dpp v52,v30,v30 row_ror:8 row_mask:0xf bank_mask:0xc
v_add_f32_dpp v53,v31,v31 row_ror:8 row_mask:0xf bank_mask:0xc
s_nop 0
v_add_f32_dpp v52,v52,v52 row_shl:4 row_mask:0xf bank_mask:0x5
v_add_f32_dpp v53,v53,v53 row_shl:4 row_mask:0xf bank_mask:0x5
s_cbranch_vccz L_cok_172
buffer_load_dwordx4 v[44:47],v0,s[8:11],s66 offen offset:0 sc1
buffer_load_dwordx4 v[48:51],v0,s[8:11],s66 offen offset:1024 sc1
s_sub_u32 s49,s49,1
s_cbranch_scc1 L_abort
s_waitcnt vmcnt(3)
v_mfma_f32_16x16x32_bf16 v[28:31],v[18:21],v[32:35],0
s_waitcnt vmcnt(2)
v_mfma_f32_16x16x32_bf16 v[28:31],v[18:21],v[36:39],v[28:31]
s_nop 7
v_cmp_u_f32 vcc,v28,v28
v_add_f32_dpp v52,v28,v28 row_ror:8 row_mask:0xf bank_mask:0x3
v_add_f32_dpp v53,v29,v29 row_ror:8 row_mask:0xf bank_mask:0x3
v_add_f32_dpp v52,v30,v30 row_ror:8 row_mask:0xf bank_mask:0xc
v_add_f32_dpp v53,v31,v31 row_ror:8 row_mask:0xf bank_mask:0xc
s_nop 0
v_add_f32_dpp v52,v52,v52 row_shl:4 row_mask:0xf bank_mask:0x5
v_add_f32_dpp v53,v53,v53 row_shl:4 row_mask:0xf bank_mask:0x5
s_cbranch_vccz L_cok_172
s_branch L_crp_166
L_ckw_154:
s_add_u32 s59,s18,s75
L_ww_173:
s_sleep 1
buffer_load_dword v23,off,s[8:11],s59 sc1
s_sub_u32 s49,s49,1
s_cbranch_scc1 L_abort
s_waitcnt vmcnt(0)
v_readfirstlane_b32 s76,v23
s_cmp_eq_u32 s76,0
s_cbranch_scc1 L_ww_173
L_wwd_174:
s_branch L_ckb_155
L_cend_164:
v_smfmac_f32_16x16x64_bf16 v[116:119],v[36:39],v[184:191],v2
v_smfmac_f32_16x16x64_bf16 v[112:115],v[40:43],v[192:199],v2
v_smfmac_f32_16x16x64_bf16 v[116:119],v[40:43],v[200:207],v2
v_smfmac_f32_16x16x64_bf16 v[112:115],v[44:47],v[208:215],v2
v_smfmac_f32_16x16x64_bf16 v[116:119],v[44:47],v[216:223],v2
v_smfmac_f32_16x16x64_bf16 v[112:115],v[48:51],v[224:231],v2
v_smfmac_f32_16x16x64_bf16 v[116:119],v[48:51],v[232:239],v2
v_smfmac_f32_16x16x64_bf16 v[112:115],v[52:55],v[240:247],v2
v_smfmac_f32_16x16x64_bf16 v[116:119],v[52:55],v[248:255],v2
s_waitcnt lgkmcnt(0)
s_nop 2
v_pk_add_f32 v[112:113],v[112:113],v[114:115]
s_nop 2
v_pk_add_f32 v[116:117],v[116:117],v[118:119]
v_cvt_pk_bf16_f32 v126,v112,v113
v_cvt_pk_bf16_f32 v127,v116,v117
v_add_u32 v52,s50,v5
v_add_u32 v54,s50,v6
ds_read_b64_tr_b16 v[52:53],v52
ds_read_b64_tr_b16 v[54:55],v54
v_mov_b32_dpp v124,v126 quad_perm:[2,3,2,3] row_mask:0xf bank_mask:0xf
v_mov_b32_dpp v125,v127 quad_perm:[2,3,2,3] row_mask:0xf bank_mask:0xf
s_mov_b32 vcc_lo,0xcccccccc
s_mov_b32 vcc_hi,0xcccccccc
s_waitcnt lgkmcnt(0)
v_cndmask_b32 v124,v124,v52,vcc
v_cndmask_b32 v125,v125,v53,vcc
v_cndmask_b32 v126,v126,v54,vcc
v_cndmask_b32 v127,v127,v55,vcc
buffer_store_dwordx4 v[124:127],v0,s[8:11],s54 offen sc1
s_mov_b32 s51,64
s_waitcnt vmcnt(0)
s_barrier
s_nop 11
v_lshrrev_b32 v1,4,v0
s_mov_b32 s53,0
s_branch L_rb_7
L_rc1_148:
v_and_b32 v120,15,v1
v_lshrrev_b32 v121,4,v1
v_and_b32 v122,2,v1
v_cmp_eq_u32 vcc,0,v122
v_mov_b32 v2,0xeeee
v_mov_b32 v123,0x4444
v_cndmask_b32 v2,v2,v123,vcc
v_and_b32 v122,1,v1
v_cmp_eq_u32 vcc,0,v122
v_mov_b32 v3,0xdddd
v_mov_b32 v123,0x8888
v_cndmask_b32 v3,v3,v123,vcc
v_lshrrev_b32 v122,1,v120
v_bfe_u32 v123,v120,2,1
v_xor_b32 v123,v123,v122
v_lshlrev_b32 v4,7,v123
v_and_b32 v123,1,v120
v_lshl_add_u32 v4,v123,6,v4
v_xor_b32 v123,v121,v122
v_and_b32 v123,3,v123
v_lshl_add_u32 v4,v123,4,v4
s_lshl_b32 s56,s46,10
s_add_u32 s56,s56,147456
v_add_u32 v4,s56,v4
v_lshlrev_b32 v122,1,v121
v_add_u32 v122,0,v122
v_and_b32 v123,1,v121
v_xor_b32 v123,v123,v122
v_lshlrev_b32 v5,7,v123
v_bfe_u32 v123,v120,3,1
v_lshl_add_u32 v5,v123,6,v5
v_xor_b32 v123,v120,v122
v_and_b32 v123,3,v123
v_lshl_add_u32 v5,v123,4,v5
v_bfe_u32 v123,v120,2,1
v_lshl_add_u32 v5,v123,3,v5
v_add_u32 v5,147456,v5
v_lshlrev_b32 v122,1,v121
v_add_u32 v122,1,v122
v_and_b32 v123,1,v121
v_xor_b32 v123,v123,v122
v_lshlrev_b32 v6,7,v123
v_bfe_u32 v123,v120,3,1
v_lshl_add_u32 v6,v123,6,v6
v_xor_b32 v123,v120,v122
v_and_b32 v123,3,v123
v_lshl_add_u32 v6,v123,4,v6
v_bfe_u32 v123,v120,2,1
v_lshl_add_u32 v6,v123,3,v6
v_add_u32 v6,147456,v6
v_lshlrev_b32 v7,7,v121
v_lshrrev_b32 v122,1,v120
v_lshl_add_u32 v8,v122,4,v7
v_add_u32 v8,151552,v8
v_lshrrev_b32 v122,2,v120
v_lshl_add_u32 v7,v122,5,v7
v_and_b32 v122,1,v120
v_lshl_add_u32 v7,v122,4,v7
v_and_b32 v122,2,v120
v_cmp_eq_u32 vcc,0,v122
s_lshl_b32 s56,s46,9
v_mov_b32 v122,2048
v_mov_b32 v123,s56
v_cndmask_b32 v122,v122,v123,vcc
v_add_u32 v7,v122,v7
v_add_u32 v7,151552,v7
v_lshrrev_b32 v122,3,v1
v_lshlrev_b32 v9,11,v122
v_and_b32 v122,7,v1
v_lshl_add_u32 v9,v122,3,v9
s_lshl_b32 s56,s46,14
s_lshl_b32 s57,s47,6
s_add_u32 s56,s56,s57
v_add_u32 v9,s56,v9
s_lshl_b32 s71,s46,5
s_add_u32 s71,s71,s47
s_bfe_u32 s56,s71,0x10003
s_lshl_b32 s56,s56,11
s_and_b32 s57,s71,1
s_lshl_b32 s57,s57,10
s_add_u32 s56,s56,s57
s_bfe_u32 s57,s71,0x10002
s_lshl_b32 s57,s57,9
s_add_u32 s56,s56,s57
s_bfe_u32 s57,s71,0x10001
s_lshl_b32 s57,s57,6
s_add_u32 s56,s56,s57
s_bfe_u32 s57,s71,0x10004
s_lshl_b32 s57,s57,8
s_add_u32 s56,s56,s57
s_bfe_u32 s57,s71,0x10005
s_lshl_b32 s57,s57,7
s_add_u32 s56,s56,s57
s_bfe_u32 s57,s71,0x10006
s_lshl_b32 s57,s57,12
s_add_u32 s56,s56,s57
v_and_b32 v122,3,v120
v_lshlrev_b32 v10,2,v122
v_bfe_u32 v122,v120,3,1
v_lshl_add_u32 v10,v122,4,v10
v_and_b32 v122,1,v121
v_lshl_add_u32 v10,v122,5,v10
v_add_u32 v10,s56,v10
v_and_b32 v123,36,v1
v_mov_b32 v122,0x80000000
v_cmp_eq_u32 vcc,0,v123
s_nop 1
v_cndmask_b32 v10,v122,v10,vcc
s_lshl_b32 s71,s71,11
s_lshl_b32 s73,s46,11
s_mov_b32 s72,0xffc00000
s_mov_b32 s74,0
v_and_b32 v11,1,v121
v_xor_b32 v11,v11,v120
v_and_b32 v11,3,v11
v_lshrrev_b32 v122,2,v120
v_lshl_add_u32 v11,v11,2,v122
v_lshl_add_u32 v11,v121,4,v11
v_lshlrev_b32 v11,4,v11
s_lshl_b32 s56,s46,15
v_add_u32 v11,s56,v11
v_lshrrev_b32 v13,3,v1
v_lshlrev_b32 v13,9,v13
v_and_b32 v122,7,v1
v_lshl_add_u32 v13,v122,4,v13
v_and_b32 v122,15,v1
v_and_b32 v123,1,v1
v_lshlrev_b32 v123,4,v123
v_mov_b32 v124,0x3f80
v_lshlrev_b32 v124,v123,v124
v_lshrrev_b32 v122,1,v122
v_cmp_eq_u32 vcc,0,v122
s_nop 1
v_cndmask_b32 v18,0,v124,vcc
v_cmp_eq_u32 vcc,1,v122
s_nop 1
v_cndmask_b32 v19,0,v124,vcc
v_cmp_eq_u32 vcc,2,v122
s_nop 1
v_cndmask_b32 v20,0,v124,vcc
v_cmp_eq_u32 vcc,3,v122
s_nop 1
v_cndmask_b32 v21,0,v124,vcc
s_and_b32 s56,s46,1
s_lshl_b32 s56,s56,8
s_and_b32 s57,s46,2
s_lshl_b32 s57,s57,6
s_add_u32 s56,s56,s57
v_add_u32 v13,s56,v13
s_add_u32 s56,s50,155648
v_add_u32 v12,s56,v0
v_mov_b64 v[14:15],s[28:29]
v_mov_b64 v[16:17],s[28:29]
v_add_u32 v22,12599296,v10
s_lshl_b32 s18,s47,2
s_add_u32 s18,s18,10494080
v_mov_b32 v1,s80
s_mov_b32 s65,15728640
s_add_u32 s66,s71,15728640
s_add_u32 s69,s71,15990784
s_mov_b32 s30,0x40000000
s_mov_b32 s51,0
buffer_load_dwordx4 v[88:91],v0,s[8:11],s66 offen offset:0
buffer_load_dwordx4 v[88:91],v0,s[8:11],s66 offen offset:1024
buffer_load_dwordx4 v[88:91],v0,s[8:11],s69 offen offset:0
buffer_load_dwordx4 v[88:91],v0,s[8:11],s69 offen offset:1024
s_waitcnt vmcnt(0)
L_cst_178:
s_cmp_lg_u32 s46,0
s_cbranch_scc1 L_csw_183
s_lshl_b32 s59,s51,13
s_lshl2_add_u32 s59,s47,s59
s_add_u32 s59,s59,10485888
L_ww_184:
s_sleep 1
buffer_load_dword v122,off,s[8:11],s59 sc1
s_sub_u32 s49,s49,1
s_cbranch_scc1 L_abort
s_waitcnt vmcnt(0)
v_readfirstlane_b32 s61,v122
s_cmp_eq_u32 s61,0
s_cbranch_scc1 L_ww_184
L_wwd_185:
L_csw_183:
s_waitcnt lgkmcnt(0)
s_barrier
s_lshl_b32 s56,s51,5
s_add_u32 s56,s56,s47
s_mul_i32 s56,s56,24576
s_add_u32 s56,s56,150994944
s_add_u32 s67,s56,s73
s_add_u32 m0,s73,131072
s_add_u32 s57,s67,8192
buffer_load_dwordx4 v0,s[8:11],s67 offen sc1 lds
buffer_load_dwordx4 v0,s[8:11],s67 offen offset:1024 sc1 lds
s_add_u32 m0,s73,139264
s_add_u32 s67,s67,786432
buffer_load_dwordx4 v0,s[8:11],s57 offen sc1 lds
buffer_load_dwordx4 v0,s[8:11],s57 offen offset:1024 sc1 lds
s_lshl_b32 s75,s51,13
s_add_u32 s56,s75,12591104
buffer_load_dword v23,v10,s[8:11],s56 offen sc1
s_add_u32 s64,s75,12582912
s_add_u32 s70,s64,4096
s_lshl_b32 s68,s51,5
s_add_u32 s68,s68,s47
s_lshl_b32 s68,s68,12
s_lshl_b32 s56,s46,10
s_add_u32 s68,s68,s56
s_add_u32 s68,s68,58720256
s_mov_b32 s54,0x80000000
s_mov_b32 s77,0
s_mov_b32 s19,0
s_cmp_eq_u32 s51,63
s_cselect_b32 s76,1,s46
s_cmp_eq_u32 s76,0
s_cselect_b32 s76,1,0
v_mov_b64 v[96:97],0
v_mov_b64 v[98:99],0
v_mov_b64 v[100:101],0
v_mov_b64 v[102:103],0
v_mov_b64 v[104:105],0
v_mov_b64 v[106:107],0
v_mov_b64 v[108:109],0
v_mov_b64 v[110:111],0
v_mov_b64 v[112:113],0
v_mov_b64 v[114:115],0
v_mov_b64 v[116:117],0
v_mov_b64 v[118:119],0
s_waitcnt vmcnt(0) lgkmcnt(0)
s_barrier
v_add_u32 v55,131072,v0
ds_read_b128 v[56:59],v55 offset:0
ds_read_b128 v[60:63],v55 offset:4096
ds_read_b128 v[64:67],v55 offset:1024
ds_read_b128 v[68:71],v55 offset:5120
ds_read_b128 v[72:75],v55 offset:2048
ds_read_b128 v[76:79],v55 offset:6144
ds_read_b128 v[80:83],v55 offset:3072
ds_read_b128 v[84:87],v55 offset:7168
v_add_u32 v123,s73,v55
ds_read_b128 v[88:91],v123 offset:8192
ds_read_b128 v[92:95],v123 offset:9216
v_xor_b32 v120,1024,v12
v_xor_b32 v121,2048,v12
v_xor_b32 v122,3072,v12
buffer_load_dwordx4 v[24:27],v13,s[8:11],s64 offen sc1
buffer_load_dwordx4 v[24:27],v13,s[8:11],s64 offen sc1
L_chain_186:
L_cpa_187:
buffer_load_dwordx4 v[24:27],v13,s[8:11],s64 offen sc1
s_sub_u32 s49,s49,1
s_cbranch_scc1 L_abort
s_waitcnt vmcnt(2)
v_max3_u32 v123,v24,v25,v26
v_max_u32 v123,v27,v123
v_cmp_le_u32 vcc,s72,v123
ds_write_b128 v12,v[24:27] offset:0
s_cbranch_vccnz L_cpa_187
L_cgo_190:
v_smfmac_f32_16x16x64_bf16 v[96:99],v[24:27],a[0:7],v2
buffer_load_dwordx4 v[40:43],v13,s[8:11],s70 offen sc1
v_smfmac_f32_16x16x64_bf16 v[100:103],v[24:27],a[128:135],v2
s_waitcnt lgkmcnt(0)
s_barrier
ds_read_b128 v[28:31],v120 offset:0
v_smfmac_f32_16x16x64_bf16 v[104:107],v[24:27],a[8:15],v2
ds_read_b128 v[32:35],v121 offset:0
v_smfmac_f32_16x16x64_bf16 v[108:111],v[24:27],a[136:143],v2
ds_read_b128 v[36:39],v122 offset:0
v_smfmac_f32_16x16x64_bf16 v[112:115],v[24:27],v[128:135],v2
v_smfmac_f32_16x16x64_bf16 v[116:119],v[24:27],v[136:143],v2
s_waitcnt lgkmcnt(2)
v_smfmac_f32_16x16x64_bf16 v[96:99],v[28:31],a[16:23],v2
s_add_u32 m0,s73,131072
v_smfmac_f32_16x16x64_bf16 v[100:103],v[28:31],a[144:151],v2
s_add_u32 s57,s67,8192
v_smfmac_f32_16x16x64_bf16 v[104:107],v[28:31],a[24:31],v2
s_cmp_lt_u32 s19,s76
s_cbranch_scc1 L_ckw_179
L_ckb_180:
v_smfmac_f32_16x16x64_bf16 v[108:111],v[28:31],a[152:159],v2
s_waitcnt vmcnt(0) lgkmcnt(1)
v_smfmac_f32_16x16x64_bf16 v[96:99],v[32:35],a[32:39],v2
ds_write_b128 v12,v[40:43] offset:4096
v_max3_u32 v123,v40,v41,v42
v_smfmac_f32_16x16x64_bf16 v[100:103],v[32:35],a[160:167],v2
v_max_u32 v123,v43,v123
v_smfmac_f32_16x16x64_bf16 v[104:107],v[32:35],a[40:47],v2
v_cmp_le_u32 vcc,s72,v123
v_smfmac_f32_16x16x64_bf16 v[108:111],v[32:35],a[168:175],v2
v_smfmac_f32_16x16x64_bf16 v[112:115],v[28:31],v[144:151],v2
s_cbranch_vccnz L_cpb_193
L_cback_195:
s_waitcnt lgkmcnt(0)
s_barrier
v_smfmac_f32_16x16x64_bf16 v[96:99],v[36:39],a[48:55],v2
buffer_store_dword v54,v10,s[8:11],s30 offen sc1
v_smfmac_f32_16x16x64_bf16 v[100:103],v[36:39],a[176:183],v2
ds_read_b128 v[44:47],v120 offset:4096
v_smfmac_f32_16x16x64_bf16 v[104:107],v[36:39],a[56:63],v2
buffer_store_dwordx4 v[124:127],v0,s[8:11],s54 offen sc1
v_smfmac_f32_16x16x64_bf16 v[108:111],v[36:39],a[184:191],v2
ds_read_b128 v[48:51],v121 offset:4096
v_smfmac_f32_16x16x64_bf16 v[96:99],v[40:43],a[64:71],v2
buffer_load_dwordx4 v0,s[8:11],s67 offen sc1 lds
v_smfmac_f32_16x16x64_bf16 v[100:103],v[40:43],a[192:199],v2
ds_read_b128 v[52:55],v122 offset:4096
v_smfmac_f32_16x16x64_bf16 v[104:107],v[40:43],a[72:79],v2
buffer_load_dwordx4 v0,s[8:11],s67 offen offset:1024 sc1 lds
s_add_u32 m0,s73,139264
v_smfmac_f32_16x16x64_bf16 v[108:111],v[40:43],a[200:207],v2
s_waitcnt lgkmcnt(2)
v_smfmac_f32_16x16x64_bf16 v[96:99],v[44:47],a[80:87],v2
buffer_load_dwordx4 v0,s[8:11],s57 offen sc1 lds
s_add_u32 s67,s67,786432
v_smfmac_f32_16x16x64_bf16 v[100:103],v[44:47],a[208:215],v2
s_waitcnt lgkmcnt(1)
v_smfmac_f32_16x16x64_bf16 v[96:99],v[48:51],a[96:103],v2
buffer_load_dwordx4 v0,s[8:11],s57 offen offset:1024 sc1 lds
v_smfmac_f32_16x16x64_bf16 v[100:103],v[48:51],a[224:231],v2
s_waitcnt lgkmcnt(0)
v_smfmac_f32_16x16x64_bf16 v[96:99],v[52:55],a[112:119],v2
buffer_load_dword v23,v22,s[8:11],s75 offen sc1
v_smfmac_f32_16x16x64_bf16 v[100:103],v[52:55],a[240:247],v2
v_smfmac_f32_16x16x64_bf16 v[104:107],v[44:47],a[88:95],v2
v_smfmac_f32_16x16x64_bf16 v[108:111],v[44:47],a[216:223],v2
v_smfmac_f32_16x16x64_bf16 v[104:107],v[48:51],a[104:111],v2
v_add_f32 v96,v96,v98
v_smfmac_f32_16x16x64_bf16 v[108:111],v[48:51],a[232:239],v2
v_add_f32 v97,v97,v99
v_smfmac_f32_16x16x64_bf16 v[104:107],v[52:55],a[120:127],v2
v_cvt_pk_bf16_f32 v120,v96,v97
v_smfmac_f32_16x16x64_bf16 v[108:111],v[52:55],a[248:255],v2
v_add_f32 v100,v100,v102
v_smfmac_f32_16x16x64_bf16 v[116:119],v[28:31],v[152:159],v2
v_add_f32 v101,v101,v103
v_smfmac_f32_16x16x64_bf16 v[112:115],v[32:35],v[160:167],v2
v_cvt_pk_bf16_f32 v121,v100,v101
v_add_f32 v104,v104,v106
v_add_f32 v105,v105,v107
v_cvt_pk_bf16_f32 v122,v104,v105
v_add_f32 v108,v108,v110
v_add_f32 v109,v109,v111
v_cvt_pk_bf16_f32 v123,v108,v109
ds_write_b128 v4,v[120:123]
v_smfmac_f32_16x16x64_bf16 v[116:119],v[32:35],v[168:175],v2
s_mov_b32 s54,s68
s_add_u32 s68,s68,131072
v_mov_b32 v125,0
v_smfmac_f32_16x16x64_bf16 v[112:115],v[36:39],v[176:183],v2
s_cmp_eq_u32 s51,63
s_cbranch_scc1 L_cend_189
v_smfmac_f32_16x16x64_bf16 v[116:119],v[36:39],v[184:191],v2
v_smfmac_f32_16x16x64_bf16 v[112:115],v[40:43],v[192:199],v2
s_waitcnt lgkmcnt(0)
s_barrier
ds_read_b64_tr_b16 v[96:97],v5 offset:0
ds_read_b64_tr_b16 v[98:99],v6 offset:0
v_smfmac_f32_16x16x64_bf16 v[116:119],v[40:43],v[200:207],v2
ds_read_b64_tr_b16 v[100:101],v5 offset:1024
v_smfmac_f32_16x16x64_bf16 v[112:115],v[44:47],v[208:215],v2
ds_read_b64_tr_b16 v[102:103],v6 offset:1024
v_smfmac_f32_16x16x64_bf16 v[116:119],v[44:47],v[216:223],v2
ds_read_b64_tr_b16 v[104:105],v5 offset:2048
v_smfmac_f32_16x16x64_bf16 v[112:115],v[48:51],v[224:231],v2
ds_read_b64_tr_b16 v[106:107],v6 offset:2048
s_waitcnt lgkmcnt(4)
v_mfma_f32_16x16x32_bf16 v[24:27],v[56:59],v[96:99],0
ds_read_b64_tr_b16 v[108:109],v5 offset:3072
v_mfma_f32_16x16x32_bf16 v[28:31],v[60:63],v[96:99],0
ds_read_b64_tr_b16 v[110:111],v6 offset:3072
v_mfma_f32_16x16x32_bf16 v[32:35],v[96:99],v[96:99],0
ds_read_b128 v[40:43],v11 offset:12288
s_waitcnt lgkmcnt(5)
v_mfma_f32_16x16x32_bf16 v[24:27],v[64:67],v[100:103],v[24:27]
ds_read_b128 v[56:59],v11 offset:0
v_mfma_f32_16x16x32_bf16 v[28:31],v[68:71],v[100:103],v[28:31]
ds_read_b128 v[60:63],v11 offset:1024
v_mfma_f32_16x16x32_bf16 v[32:35],v[100:103],v[100:103],v[32:35]
ds_read_b128 v[96:99],v11 offset:8192
s_waitcnt lgkmcnt(6)
v_mfma_f32_16x16x32_bf16 v[24:27],v[72:75],v[104:107],v[24:27]
ds_read_b128 v[64:67],v11 offset:2048
v_mfma_f32_16x16x32_bf16 v[28:31],v[76:79],v[104:107],v[28:31]
ds_read_b128 v[68:71],v11 offset:3072
v_mfma_f32_16x16x32_bf16 v[32:35],v[104:107],v[104:107],v[32:35]
ds_read_b128 v[100:103],v11 offset:9216
s_waitcnt lgkmcnt(7)
v_mfma_f32_16x16x32_bf16 v[24:27],v[80:83],v[108:111],v[24:27]
ds_read_b128 v[72:75],v11 offset:4096
v_mfma_f32_16x16x32_bf16 v[28:31],v[84:87],v[108:111],v[28:31]
ds_read_b128 v[76:79],v11 offset:5120
v_mfma_f32_16x16x32_bf16 v[32:35],v[108:111],v[108:111],v[32:35]
ds_read_b128 v[104:107],v11 offset:10240
v_smfmac_f32_16x16x64_bf16 v[116:119],v[48:51],v[232:239],v2
ds_read_b128 v[80:83],v11 offset:6144
v_smfmac_f32_16x16x64_bf16 v[112:115],v[52:55],v[240:247],v2
ds_read_b128 v[84:87],v11 offset:7168
v_smfmac_f32_16x16x64_bf16 v[116:119],v[52:55],v[248:255],v2
ds_read_b128 v[108:111],v11 offset:11264
v_max3_f32 v126,v24,v25,v26
v_max3_f32 v127,v27,v28,v29
v_max3_f32 v126,v30,v31,v126
v_max3_f32 v127,v34,v35,v127
v_max_f32 v126,v126,v127
v_max_f32 v127,v126,v127
v_pk_mul_f32 v[34:35],v[34:35],v[0:1] op_sel:[0,1]
v_pk_mul_f32 v[24:25],v[24:25],v[0:1] op_sel:[0,1]
v_permlane16_swap_b32 v126,v127
v_max_f32 v126,v126,v127
v_max_f32 v127,v126,v127
v_pk_mul_f32 v[26:27],v[26:27],v[0:1] op_sel:[0,1]
v_pk_mul_f32 v[28:29],v[28:29],v[0:1] op_sel:[0,1]
v_permlane32_swap_b32 v126,v127
v_max_f32 v126,v126,v127
v_mul_f32 v126,v1,v126
v_pk_mul_f32 v[30:31],v[30:31],v[0:1] op_sel:[0,1]
v_pk_add_f32 v[34:35],v[34:35],v[126:127] op_sel_hi:[1,0] neg_lo:[0,1] neg_hi:[0,1]
v_pk_add_f32 v[112:113],v[112:113],v[114:115]
v_pk_add_f32 v[116:117],v[116:117],v[118:119]
v_pk_add_f32 v[24:25],v[24:25],v[126:127] op_sel_hi:[1,0] neg_lo:[0,1] neg_hi:[0,1]
v_pk_add_f32 v[26:27],v[26:27],v[126:127] op_sel_hi:[1,0] neg_lo:[0,1] neg_hi:[0,1]
v_pk_add_f32 v[28:29],v[28:29],v[126:127] op_sel_hi:[1,0] neg_lo:[0,1] neg_hi:[0,1]
v_pk_add_f32 v[30:31],v[30:31],v[126:127] op_sel_hi:[1,0] neg_lo:[0,1] neg_hi:[0,1]
v_exp_f32 v34,v34
v_exp_f32 v35,v35
v_cvt_pk_bf16_f32 v126,v112,v113
v_cvt_pk_bf16_f32 v124,v34,v35
v_cvt_pk_bf16_f32 v127,v116,v117
v_cvt_pk_bf16_f32 v36,v116,v117
v_mfma_f32_16x16x16_bf16 v[32:35],v[14:15],v[124:125],0
ds_read_b128 v[44:47],v11 offset:13312
v_exp_f32 v24,v24
v_mfma_f32_16x16x16_bf16 v[112:115],v[126:127],v[124:125],0
ds_read_b128 v[48:51],v11 offset:14336
v_exp_f32 v25,v25
v_mfma_f32_16x16x16_bf16 v[116:119],v[36:37],v[124:125],0
ds_read_b128 v[52:55],v11 offset:15360
v_exp_f32 v26,v26
v_exp_f32 v27,v27
v_cvt_pk_bf16_f32 v120,v24,v25
v_exp_f32 v28,v28
v_exp_f32 v29,v29
v_cvt_pk_bf16_f32 v121,v26,v27
v_exp_f32 v30,v30
v_exp_f32 v31,v31
v_cvt_pk_bf16_f32 v122,v28,v29
v_cvt_pk_bf16_f32 v123,v30,v31
s_add_u32 s75,s75,8192
s_add_u32 s51,s51,1
v_mfma_f32_16x16x32_bf16 v[32:35],v[14:17],v[120:123],v[32:35]
v_mfma_f32_16x16x32_bf16 v[112:115],v[88:91],v[120:123],v[112:115]
ds_read_b128 v[88:91],v11 offset:16384
v_mfma_f32_16x16x32_bf16 v[116:119],v[92:95],v[120:123],v[116:119]
ds_read_b128 v[92:95],v11 offset:17408
v_rcp_f32 v32,v32
v_mov_b64 v[24:25],-1
v_mov_b64 v[26:27],-1
s_add_u32 s64,s75,12582912
s_add_u32 s70,s64,4096
v_pk_mul_f32 v[112:113],v[112:113],v[32:33] op_sel_hi:[1,0]
v_pk_mul_f32 v[114:115],v[114:115],v[32:33] op_sel_hi:[1,0]
v_pk_mul_f32 v[116:117],v[116:117],v[32:33] op_sel_hi:[1,0]
v_pk_mul_f32 v[118:119],v[118:119],v[32:33] op_sel_hi:[1,0]
v_cvt_pk_bf16_f32 v120,v112,v116
v_cvt_pk_bf16_f32 v121,v113,v117
v_cvt_pk_bf16_f32 v122,v114,v118
v_cvt_pk_bf16_f32 v123,v115,v119
ds_write_b128 v7,v[120:123]
buffer_store_dwordx4 v[24:27],v0,s[8:11],s69 offen
buffer_store_dwordx4 v[24:27],v0,s[8:11],s69 offen offset:1024
v_mov_b64 v[112:113],0
v_mov_b64 v[114:115],0
v_mov_b64 v[116:117],0
v_mov_b64 v[118:119],0
s_waitcnt lgkmcnt(0)
s_barrier
ds_read_b128 v[24:27],v8 offset:0
ds_read_b128 v[28:31],v8 offset:512
ds_read_b128 v[32:35],v8 offset:1024
ds_read_b128 v[36:39],v8 offset:1536
v_mov_b64 v[120:121],0
v_mov_b64 v[122:123],0
s_add_u32 s57,s65,65536
s_add_u32 s58,s65,131072
s_add_u32 s59,s65,196608
s_add_u32 s56,s18,s75
s_add_u32 s30,s75,17825792
s_waitcnt lgkmcnt(3)
v_smfmac_f32_16x16x64_bf16 v[112:115],v[24:27],v[56:63],v3
ds_read_b128 v[56:59],v11 offset:18432
s_waitcnt lgkmcnt(3)
v_smfmac_f32_16x16x64_bf16 v[112:115],v[28:31],v[64:71],v3
ds_read_b128 v[60:63],v11 offset:19456
s_waitcnt lgkmcnt(3)
v_smfmac_f32_16x16x64_bf16 v[112:115],v[32:35],v[72:79],v3
ds_read_b128 v[64:67],v11 offset:20480
s_waitcnt lgkmcnt(3)
v_smfmac_f32_16x16x64_bf16 v[112:115],v[36:39],v[80:87],v3
ds_read_b128 v[68:71],v11 offset:21504
v_smfmac_f32_16x16x64_bf16 v[116:119],v[24:27],v[96:103],v3
ds_read_b128 v[72:75],v11 offset:22528
v_smfmac_f32_16x16x64_bf16 v[116:119],v[28:31],v[104:111],v3
ds_read_b128 v[76:79],v11 offset:23552
v_cvt_pk_bf16_f32 v112,v112,v113
v_smfmac_f32_16x16x64_bf16 v[116:119],v[32:35],v[40:47],v3
ds_read_b128 v[80:83],v11 offset:24576
v_cvt_pk_bf16_f32 v113,v114,v115
buffer_store_dwordx2 v[112:113],v9,s[8:11],s65 offen
v_smfmac_f32_16x16x64_bf16 v[116:119],v[36:39],v[48:55],v3
ds_read_b128 v[84:87],v11 offset:25600
v_mov_b64 v[112:113],0
v_smfmac_f32_16x16x64_bf16 v[120:123],v[24:27],v[88:95],v3
ds_read_b128 v[96:99],v11 offset:26624
ds_read_b128 v[100:103],v11 offset:27648
v_mov_b64 v[114:115],0
s_waitcnt lgkmcnt(8)
v_smfmac_f32_16x16x64_bf16 v[120:123],v[28:31],v[56:63],v3
ds_read_b128 v[104:107],v11 offset:28672
v_cvt_pk_bf16_f32 v116,v116,v117
s_waitcnt lgkmcnt(7)
v_smfmac_f32_16x16x64_bf16 v[120:123],v[32:35],v[64:71],v3
ds_read_b128 v[108:111],v11 offset:29696
ds_read_b128 v[40:43],v11 offset:30720
v_cvt_pk_bf16_f32 v117,v118,v119
buffer_store_dwordx2 v[116:117],v9,s[8:11],s57 offen
s_waitcnt lgkmcnt(7)
v_smfmac_f32_16x16x64_bf16 v[120:123],v[36:39],v[72:79],v3
ds_read_b128 v[44:47],v11 offset:31744
v_add_u32 v52,s50,v5
s_waitcnt lgkmcnt(6)
v_smfmac_f32_16x16x64_bf16 v[112:115],v[24:27],v[80:87],v3
v_add_u32 v54,s50,v6
s_waitcnt lgkmcnt(4)
v_smfmac_f32_16x16x64_bf16 v[112:115],v[28:31],v[96:103],v3
ds_read_b64_tr_b16 v[52:53],v52
v_cvt_pk_bf16_f32 v120,v120,v121
s_waitcnt lgkmcnt(3)
v_smfmac_f32_16x16x64_bf16 v[112:115],v[32:35],v[104:111],v3
ds_read_b64_tr_b16 v[54:55],v54
v_cvt_pk_bf16_f32 v121,v122,v123
buffer_store_dwordx2 v[120:121],v9,s[8:11],s58 offen
s_waitcnt lgkmcnt(2)
v_smfmac_f32_16x16x64_bf16 v[112:115],v[36:39],v[40:47],v3
v_mov_b64 v[116:117],0
v_mov_b64 v[118:119],0
s_xor_b32 s65,s65,262144
v_mov_b32_dpp v124,v126 quad_perm:[2,3,2,3] row_mask:0xf bank_mask:0xf
v_mov_b32_dpp v125,v127 quad_perm:[2,3,2,3] row_mask:0xf bank_mask:0xf
s_mov_b32 vcc_lo,0xcccccccc
s_mov_b32 vcc_hi,0xcccccccc
s_nop 0
v_cvt_pk_bf16_f32 v112,v112,v113
v_cvt_pk_bf16_f32 v113,v114,v115
buffer_store_dwordx2 v[112:113],v9,s[8:11],s59 offen
s_waitcnt lgkmcnt(0)
s_buffer_load_dword s19,s[8:11],s56
v_cndmask_b32 v124,v124,v52,vcc
v_cndmask_b32 v125,v125,v53,vcc
v_cndmask_b32 v126,v126,v54,vcc
v_cndmask_b32 v127,v127,v55,vcc
s_cmp_lt_u32 s46,2
s_waitcnt vmcnt(3)
s_cbranch_scc1 L_crg_196
s_cmp_eq_u32 s46,2
s_waitcnt vmcnt(1)
s_cbranch_scc1 L_crg_196
s_waitcnt vmcnt(0)
L_crg_196:
buffer_load_dwordx4 v[32:35],v0,s[8:11],s66 offen offset:0 sc1
buffer_load_dwordx4 v[36:39],v0,s[8:11],s66 offen offset:1024 sc1
v_mov_b64 v[96:97],0
v_mov_b64 v[98:99],0
v_mov_b64 v[100:101],0
v_mov_b64 v[102:103],0
v_mov_b64 v[104:105],0
v_mov_b64 v[106:107],0
v_mov_b64 v[108:109],0
v_mov_b64 v[110:111],0
v_mov_b64 v[112:113],0
v_mov_b64 v[114:115],0
v_add_u32 v55,131072,v0
v_add_u32 v123,s73,v55
v_xor_b32 v120,1024,v12
v_xor_b32 v121,2048,v12
v_xor_b32 v122,3072,v12
buffer_load_dwordx4 v[44:47],v0,s[8:11],s66 offen offset:0 sc1
buffer_load_dwordx4 v[48:51],v0,s[8:11],s66 offen offset:1024 sc1
s_cmp_ge_u32 s51,63
s_cselect_b32 s76,0,1
s_cmp_eq_u32 s46,0
s_cselect_b32 s76,s76,0
s_waitcnt vmcnt(3)
v_mfma_f32_16x16x32_bf16 v[28:31],v[18:21],v[32:35],0
s_waitcnt vmcnt(2)
v_mfma_f32_16x16x32_bf16 v[28:31],v[18:21],v[36:39],v[28:31]
s_nop 7
v_cmp_u_f32 vcc,v28,v28
v_add_f32_dpp v52,v28,v28 row_ror:8 row_mask:0xf bank_mask:0x3
v_add_f32_dpp v53,v29,v29 row_ror:8 row_mask:0xf bank_mask:0x3
v_add_f32_dpp v52,v30,v30 row_ror:8 row_mask:0xf bank_mask:0xc
v_add_f32_dpp v53,v31,v31 row_ror:8 row_mask:0xf bank_mask:0xc
s_nop 0
v_add_f32_dpp v52,v52,v52 row_shl:4 row_mask:0xf bank_mask:0x5
v_add_f32_dpp v53,v53,v53 row_shl:4 row_mask:0xf bank_mask:0x5
s_cbranch_vccnz L_crp_191
L_cok_197:
v_cvt_pk_bf16_f32 v54,v52,v53
buffer_store_dword v54,v10,s[8:11],s64 offen
s_mov_b32 s69,s66
s_xor_b32 s66,s66,262144
s_barrier
ds_read_b128 v[56:59],v55 offset:0
ds_read_b128 v[60:63],v55 offset:4096
ds_read_b128 v[64:67],v55 offset:1024
buffer_load_dwordx4 v[24:27],v13,s[8:11],s64 offen sc1
ds_read_b128 v[68:71],v55 offset:5120
ds_read_b128 v[72:75],v55 offset:2048
ds_read_b128 v[76:79],v55 offset:6144
ds_read_b128 v[80:83],v55 offset:3072
buffer_load_dwordx4 v[24:27],v13,s[8:11],s64 offen sc1
ds_read_b128 v[84:87],v55 offset:7168
ds_read_b128 v[88:91],v123 offset:8192
ds_read_b128 v[92:95],v123 offset:9216
s_branch L_chain_186
L_cpb_193:
buffer_load_dwordx4 v[40:43],v13,s[8:11],s70 offen sc1
s_sub_u32 s49,s49,1
s_cbranch_scc1 L_abort
s_waitcnt vmcnt(0)
v_max3_u32 v123,v40,v41,v42
v_max_u32 v123,v43,v123
v_cmp_le_u32 vcc,s72,v123
s_cbranch_vccnz L_cpb_193
ds_write_b128 v12,v[40:43] offset:4096
s_branch L_cback_195
L_crp_191:
buffer_load_dwordx4 v[32:35],v0,s[8:11],s66 offen offset:0 sc1
buffer_load_dwordx4 v[36:39],v0,s[8:11],s66 offen offset:1024 sc1
s_sub_u32 s49,s49,1
s_cbranch_scc1 L_abort
s_waitcnt vmcnt(3)
v_mfma_f32_16x16x32_bf16 v[28:31],v[18:21],v[44:47],0
s_waitcnt vmcnt(2)
v_mfma_f32_16x16x32_bf16 v[28:31],v[18:21],v[48:51],v[28:31]
s_nop 7
v_cmp_u_f32 vcc,v28,v28
v_add_f32_dpp v52,v28,v28 row_ror:8 row_mask:0xf bank_mask:0x3
v_add_f32_dpp v53,v29,v29 row_ror:8 row_mask:0xf bank_mask:0x3
v_add_f32_dpp v52,v30,v30 row_ror:8 row_mask:0xf bank_mask:0xc
v_add_f32_dpp v53,v31,v31 row_ror:8 row_mask:0xf bank_mask:0xc
s_nop 0
v_add_f32_dpp v52,v52,v52 row_shl:4 row_mask:0xf bank_mask:0x5
v_add_f32_dpp v53,v53,v53 row_shl:4 row_mask:0xf bank_mask:0x5
s_cbranch_vccz L_cok_197
buffer_load_dwordx4 v[44:47],v0,s[8:11],s66 offen offset:0 sc1
buffer_load_dwordx4 v[48:51],v0,s[8:11],s66 offen offset:1024 sc1
s_sub_u32 s49,s49,1
s_cbranch_scc1 L_abort
s_waitcnt vmcnt(3)
v_mfma_f32_16x16x32_bf16 v[28:31],v[18:21],v[32:35],0
s_waitcnt vmcnt(2)
v_mfma_f32_16x16x32_bf16 v[28:31],v[18:21],v[36:39],v[28:31]
s_nop 7
v_cmp_u_f32 vcc,v28,v28
v_add_f32_dpp v52,v28,v28 row_ror:8 row_mask:0xf bank_mask:0x3
v_add_f32_dpp v53,v29,v29 row_ror:8 row_mask:0xf bank_mask:0x3
v_add_f32_dpp v52,v30,v30 row_ror:8 row_mask:0xf bank_mask:0xc
v_add_f32_dpp v53,v31,v31 row_ror:8 row_mask:0xf bank_mask:0xc
s_nop 0
v_add_f32_dpp v52,v52,v52 row_shl:4 row_mask:0xf bank_mask:0x5
v_add_f32_dpp v53,v53,v53 row_shl:4 row_mask:0xf bank_mask:0x5
s_cbranch_vccz L_cok_197
s_branch L_crp_191
L_ckw_179:
s_add_u32 s59,s18,s75
L_ww_198:
s_sleep 1
buffer_load_dword v23,off,s[8:11],s59 sc1
s_sub_u32 s49,s49,1
s_cbranch_scc1 L_abort
s_waitcnt vmcnt(0)
v_readfirstlane_b32 s76,v23
s_cmp_eq_u32 s76,0
s_cbranch_scc1 L_ww_198
L_wwd_199:
s_branch L_ckb_180
L_cend_189:
v_smfmac_f32_16x16x64_bf16 v[116:119],v[36:39],v[184:191],v2
v_smfmac_f32_16x16x64_bf16 v[112:115],v[40:43],v[192:199],v2
v_smfmac_f32_16x16x64_bf16 v[116:119],v[40:43],v[200:207],v2
v_smfmac_f32_16x16x64_bf16 v[112:115],v[44:47],v[208:215],v2
v_smfmac_f32_16x16x64_bf16 v[116:119],v[44:47],v[216:223],v2
v_smfmac_f32_16x16x64_bf16 v[112:115],v[48:51],v[224:231],v2
v_smfmac_f32_16x16x64_bf16 v[116:119],v[48:51],v[232:239],v2
v_smfmac_f32_16x16x64_bf16 v[112:115],v[52:55],v[240:247],v2
v_smfmac_f32_16x16x64_bf16 v[116:119],v[52:55],v[248:255],v2
s_waitcnt lgkmcnt(0)
s_nop 2
v_pk_add_f32 v[112:113],v[112:113],v[114:115]
s_nop 2
v_pk_add_f32 v[116:117],v[116:117],v[118:119]
v_cvt_pk_bf16_f32 v126,v112,v113
v_cvt_pk_bf16_f32 v127,v116,v117
v_add_u32 v52,s50,v5
v_add_u32 v54,s50,v6
ds_read_b64_tr_b16 v[52:53],v52
ds_read_b64_tr_b16 v[54:55],v54
v_mov_b32_dpp v124,v126 quad_perm:[2,3,2,3] row_mask:0xf bank_mask:0xf
v_mov_b32_dpp v125,v127 quad_perm:[2,3,2,3] row_mask:0xf bank_mask:0xf
s_mov_b32 vcc_lo,0xcccccccc
s_mov_b32 vcc_hi,0xcccccccc
s_waitcnt lgkmcnt(0)
v_cndmask_b32 v124,v124,v52,vcc
v_cndmask_b32 v125,v125,v53,vcc
v_cndmask_b32 v126,v126,v54,vcc
v_cndmask_b32 v127,v127,v55,vcc
buffer_store_dwordx4 v[124:127],v0,s[8:11],s54 offen sc1
s_mov_b32 s51,64
s_waitcnt vmcnt(0)
s_barrier
s_nop 11
v_lshrrev_b32 v1,4,v0
s_endpgm
L_rc2_149:
v_and_b32 v120,15,v1
v_lshrrev_b32 v121,4,v1
v_and_b32 v122,2,v1
v_cmp_eq_u32 vcc,0,v122
v_mov_b32 v2,0xeeee
v_mov_b32 v123,0x4444
v_cndmask_b32 v2,v2,v123,vcc
v_and_b32 v122,1,v1
v_cmp_eq_u32 vcc,0,v122
v_mov_b32 v3,0xdddd
v_mov_b32 v123,0x8888
v_cndmask_b32 v3,v3,v123,vcc
v_lshrrev_b32 v122,1,v120
v_bfe_u32 v123,v120,2,1
v_xor_b32 v123,v123,v122
v_lshlrev_b32 v4,7,v123
v_and_b32 v123,1,v120
v_lshl_add_u32 v4,v123,6,v4
v_xor_b32 v123,v121,v122
v_and_b32 v123,3,v123
v_lshl_add_u32 v4,v123,4,v4
s_lshl_b32 s56,s46,10
s_add_u32 s56,s56,147456
v_add_u32 v4,s56,v4
v_lshlrev_b32 v122,1,v121
v_add_u32 v122,0,v122
v_and_b32 v123,1,v121
v_xor_b32 v123,v123,v122
v_lshlrev_b32 v5,7,v123
v_bfe_u32 v123,v120,3,1
v_lshl_add_u32 v5,v123,6,v5
v_xor_b32 v123,v120,v122
v_and_b32 v123,3,v123
v_lshl_add_u32 v5,v123,4,v5
v_bfe_u32 v123,v120,2,1
v_lshl_add_u32 v5,v123,3,v5
v_add_u32 v5,147456,v5
v_lshlrev_b32 v122,1,v121
v_add_u32 v122,1,v122
v_and_b32 v123,1,v121
v_xor_b32 v123,v123,v122
v_lshlrev_b32 v6,7,v123
v_bfe_u32 v123,v120,3,1
v_lshl_add_u32 v6,v123,6,v6
v_xor_b32 v123,v120,v122
v_and_b32 v123,3,v123
v_lshl_add_u32 v6,v123,4,v6
v_bfe_u32 v123,v120,2,1
v_lshl_add_u32 v6,v123,3,v6
v_add_u32 v6,147456,v6
v_lshlrev_b32 v7,7,v121
v_lshrrev_b32 v122,1,v120
v_lshl_add_u32 v8,v122,4,v7
v_add_u32 v8,151552,v8
v_lshrrev_b32 v122,2,v120
v_lshl_add_u32 v7,v122,5,v7
v_and_b32 v122,1,v120
v_lshl_add_u32 v7,v122,4,v7
v_and_b32 v122,2,v120
v_cmp_eq_u32 vcc,0,v122
s_lshl_b32 s56,s46,9
v_mov_b32 v122,2048
v_mov_b32 v123,s56
v_cndmask_b32 v122,v122,v123,vcc
v_add_u32 v7,v122,v7
v_add_u32 v7,151552,v7
v_lshrrev_b32 v122,3,v1
v_lshlrev_b32 v9,11,v122
v_and_b32 v122,7,v1
v_lshl_add_u32 v9,v122,3,v9
s_lshl_b32 s56,s46,14
s_lshl_b32 s57,s47,6
s_add_u32 s56,s56,s57
v_add_u32 v9,s56,v9
s_lshl_b32 s71,s46,5
s_add_u32 s71,s71,s47
s_bfe_u32 s56,s71,0x10003
s_lshl_b32 s56,s56,11
s_and_b32 s57,s71,1
s_lshl_b32 s57,s57,10
s_add_u32 s56,s56,s57
s_bfe_u32 s57,s71,0x10002
s_lshl_b32 s57,s57,9
s_add_u32 s56,s56,s57
s_bfe_u32 s57,s71,0x10001
s_lshl_b32 s57,s57,6
s_add_u32 s56,s56,s57
s_bfe_u32 s57,s71,0x10004
s_lshl_b32 s57,s57,8
s_add_u32 s56,s56,s57
s_bfe_u32 s57,s71,0x10005
s_lshl_b32 s57,s57,7
s_add_u32 s56,s56,s57
s_bfe_u32 s57,s71,0x10006
s_lshl_b32 s57,s57,12
s_add_u32 s56,s56,s57
v_and_b32 v122,3,v120
v_lshlrev_b32 v10,2,v122
v_bfe_u32 v122,v120,3,1
v_lshl_add_u32 v10,v122,4,v10
v_and_b32 v122,1,v121
v_lshl_add_u32 v10,v122,5,v10
v_add_u32 v10,s56,v10
v_and_b32 v123,36,v1
v_mov_b32 v122,0x80000000
v_cmp_eq_u32 vcc,0,v123
s_nop 1
v_cndmask_b32 v10,v122,v10,vcc
s_lshl_b32 s71,s71,11
s_lshl_b32 s73,s46,11
s_mov_b32 s72,0xffc00000
s_mov_b32 s74,0
v_and_b32 v11,1,v121
v_xor_b32 v11,v11,v120
v_and_b32 v11,3,v11
v_lshrrev_b32 v122,2,v120
v_lshl_add_u32 v11,v11,2,v122
v_lshl_add_u32 v11,v121,4,v11
v_lshlrev_b32 v11,4,v11
s_lshl_b32 s56,s46,15
v_add_u32 v11,s56,v11
v_lshrrev_b32 v13,3,v1
v_lshlrev_b32 v13,9,v13
v_and_b32 v122,7,v1
v_lshl_add_u32 v13,v122,4,v13
v_and_b32 v122,15,v1
v_and_b32 v123,1,v1
v_lshlrev_b32 v123,4,v123
v_mov_b32 v124,0x3f80
v_lshlrev_b32 v124,v123,v124
v_lshrrev_b32 v122,1,v122
v_cmp_eq_u32 vcc,0,v122
s_nop 1
v_cndmask_b32 v18,0,v124,vcc
v_cmp_eq_u32 vcc,1,v122
s_nop 1
v_cndmask_b32 v19,0,v124,vcc
v_cmp_eq_u32 vcc,2,v122
s_nop 1
v_cndmask_b32 v20,0,v124,vcc
v_cmp_eq_u32 vcc,3,v122
s_nop 1
v_cndmask_b32 v21,0,v124,vcc
s_and_b32 s56,s46,1
s_lshl_b32 s56,s56,8
s_and_b32 s57,s46,2
s_lshl_b32 s57,s57,6
s_add_u32 s56,s56,s57
v_add_u32 v13,s56,v13
s_add_u32 s56,s50,155648
v_add_u32 v12,s56,v0
v_mov_b64 v[14:15],s[28:29]
v_mov_b64 v[16:17],s[28:29]
v_add_u32 v22,13647872,v10
s_lshl_b32 s18,s47,2
s_add_u32 s18,s18,10494080
v_mov_b32 v1,s80
s_mov_b32 s65,16777216
s_add_u32 s66,s71,16777216
s_add_u32 s69,s71,17039360
s_mov_b32 s30,0x40000000
s_mov_b32 s51,0
v_lshrrev_b32 v120,2,v0
v_add_u32 v120,10510464,v120
v_or_b32 v120,s52,v120
s_mov_b64 vcc,-1
s_mov_b32 vcc_lo,0
v_cndmask_b32 v22,v22,v120,vcc
s_or_b32 s56,s52,10495616
v_writelane_b32 v22,s56,4
s_or_b32 s56,s47,s46
s_mov_b32 s56,10486784
s_cmov_b32 s56,0x80000000
v_writelane_b32 v22,s56,5
s_mov_b32 s30,0
s_mov_b32 s31,0
buffer_load_dwordx4 v[88:91],v0,s[8:11],s66 offen offset:0
buffer_load_dwordx4 v[88:91],v0,s[8:11],s66 offen offset:1024
buffer_load_dwordx4 v[88:91],v0,s[8:11],s69 offen offset:0
buffer_load_dwordx4 v[88:91],v0,s[8:11],s69 offen offset:1024
s_waitcnt vmcnt(0)
L_cst_203:
s_cmp_lg_u32 s46,0
s_cbranch_scc1 L_csw_208
s_lshl_b32 s59,s31,13
s_add_u32 s59,s59,10486016
v_lshrrev_b32 v121,2,v0
v_and_b32 v121,127,v121
L_ckk_209:
s_sleep 1
buffer_load_dword v120,v121,s[8:11],s59 offen sc1
s_sub_u32 s49,s49,1
s_cbranch_scc1 L_abort
s_waitcnt vmcnt(0)
v_cmp_eq_u32 vcc,0,v120
s_cbranch_vccnz L_ckk_209
v_max_u32_dpp v120,v120,v120 row_ror:8 row_mask:0xf bank_mask:0xf
s_nop 1
v_max_u32_dpp v120,v120,v120 row_ror:4 row_mask:0xf bank_mask:0xf
s_nop 1
v_max_u32_dpp v120,v120,v120 row_ror:2 row_mask:0xf bank_mask:0xf
s_nop 1
v_max_u32_dpp v120,v120,v120 row_ror:1 row_mask:0xf bank_mask:0xf
v_mov_b32 v121,v120
s_nop 1
v_permlane16_swap_b32 v120,v121
v_max_u32 v120,v120,v121
v_mov_b32 v121,v120
s_nop 1
v_permlane32_swap_b32 v120,v121
v_max_u32 v120,v120,v121
s_nop 0
v_readfirstlane_b32 s61,v120
s_max_u32 s30,s30,s61
s_add_u32 s31,s31,1
s_andn2_b32 s51,0x7ff,s30
s_lshr_b32 s51,s51,5
s_add_u32 s61,s51,2
s_min_u32 s61,s61,63
s_cmp_le_u32 s31,s61
s_cbranch_scc1 L_cst_203
v_mov_b32 v120,0
v_mov_b32 v121,s30
ds_write_b32 v8,v120 offset:2560
ds_write_b32 v8,v121 offset:3072
s_lshl_b32 s59,s51,13
s_lshl2_add_u32 s59,s47,s59
s_add_u32 s59,s59,10485888
L_ww_210:
s_sleep 1
buffer_load_dword v122,off,s[8:11],s59 sc1
s_sub_u32 s49,s49,1
s_cbranch_scc1 L_abort
s_waitcnt vmcnt(0)
v_readfirstlane_b32 s61,v122
s_cmp_eq_u32 s61,0
s_cbranch_scc1 L_ww_210
L_wwd_211:
L_csw_208:
s_waitcnt lgkmcnt(0)
s_barrier
ds_read_b32 v120,v8 offset:3072
s_waitcnt lgkmcnt(0)
v_readfirstlane_b32 s30,v120
s_andn2_b32 s51,0x7ff,s30
s_lshr_b32 s51,s51,5
s_lshl_b32 s56,s51,5
s_add_u32 s56,s56,s47
s_mul_i32 s56,s56,24576
s_add_u32 s56,s56,150994944
s_add_u32 s67,s56,s73
s_add_u32 m0,s73,131072
s_add_u32 s57,s67,8192
buffer_load_dwordx4 v0,s[8:11],s67 offen sc1 lds
buffer_load_dwordx4 v0,s[8:11],s67 offen offset:1024 sc1 lds
s_add_u32 m0,s73,139264
s_add_u32 s67,s67,786432
buffer_load_dwordx4 v0,s[8:11],s57 offen sc1 lds
buffer_load_dwordx4 v0,s[8:11],s57 offen offset:1024 sc1 lds
s_lshl_b32 s75,s51,13
s_add_u32 s56,s75,13639680
buffer_load_dword v23,v10,s[8:11],s56 offen sc1
s_add_u32 s64,s75,17825792
s_add_u32 s70,s64,4096
s_lshl_b32 s68,s51,5
s_add_u32 s68,s68,s47
s_lshl_b32 s68,s68,12
s_lshl_b32 s56,s46,10
s_add_u32 s68,s68,s56
s_add_u32 s68,s68,75497472
s_mov_b32 s54,0x80000000
s_mov_b32 s77,0
s_mov_b32 s19,0
s_cmp_eq_u32 s51,63
s_cselect_b32 s76,1,s46
s_cmp_eq_u32 s76,0
s_cselect_b32 s76,1,0
v_mov_b64 v[96:97],0
v_mov_b64 v[98:99],0
v_mov_b64 v[100:101],0
v_mov_b64 v[102:103],0
v_mov_b64 v[104:105],0
v_mov_b64 v[106:107],0
v_mov_b64 v[108:109],0
v_mov_b64 v[110:111],0
v_mov_b64 v[112:113],0
v_mov_b64 v[114:115],0
v_mov_b64 v[116:117],0
v_mov_b64 v[118:119],0
v_lshrrev_b32 v56,8,v0
v_lshlrev_b32 v56,5,v56
v_bfe_u32 v57,v0,5,1
v_lshl_add_u32 v56,v57,2,v56
s_lshl_b32 s56,s46,7
s_add_u32 s56,s56,155648
v_add_u32 v56,s56,v56
v_xor_b32 v57,128,v56
v_xor_b32 v58,256,v56
v_xor_b32 v59,384,v56
s_andn2_b32 s56,31,s30
s_lshr_b32 s57,s56,4
s_lshl_b32 s58,s57,12
s_and_b32 s59,s56,15
s_lshl4_add_u32 s58,s59,s58
s_add_u32 s58,s58,s50
s_add_u32 s58,s58,131072
v_bfe_u32 v60,v0,6,2
v_lshlrev_b32 v60,8,v60
v_bfe_u32 v61,v0,4,2
v_lshl_add_u32 v60,v61,2,v60
v_add_u32 v60,s58,v60
s_lshr_b32 s58,s59,2
s_lshl_b32 s58,s58,8
s_lshl3_add_u32 s58,s57,s58
s_and_b32 s59,s56,3
s_lshl1_add_u32 s58,s59,s58
s_add_u32 s58,s58,s73
s_add_u32 s58,s58,139264
v_and_b32 v61,255,v0
v_add_u32 v61,s58,v61
s_cmp_lg_u32 s46,0
s_cbranch_scc1 L_chd_213
s_lshl_b32 s59,s51,10
s_add_u32 s59,s59,11337728
L_chp_212:
buffer_load_dwordx4 v[120:123],v0,s[8:11],s59 offen sc1
s_sub_u32 s49,s49,1
s_cbranch_scc1 L_abort
s_waitcnt vmcnt(0)
v_max3_u32 v124,v120,v121,v122
v_max_u32 v124,v123,v124
v_cmp_eq_u32 vcc,-1,v124
s_cbranch_vccnz L_chp_212
ds_write_b128 v12,v[120:123]
L_chd_213:
s_waitcnt vmcnt(0) lgkmcnt(0)
s_barrier
ds_read2_b32 v[24:25],v56 offset0:0 offset1:2
ds_read2_b32 v[26:27],v56 offset0:4 offset1:6
ds_read2_b32 v[28:29],v57 offset0:0 offset1:2
ds_read2_b32 v[30:31],v57 offset0:4 offset1:6
ds_read2_b32 v[32:33],v58 offset0:0 offset1:2
ds_read2_b32 v[34:35],v58 offset0:4 offset1:6
ds_read2_b32 v[36:37],v59 offset0:0 offset1:2
ds_read2_b32 v[38:39],v59 offset0:4 offset1:6
s_waitcnt lgkmcnt(4)
ds_read2_b32 v[40:41],v56 offset0:128 offset1:130
ds_read2_b32 v[42:43],v56 offset0:132 offset1:134
ds_read2_b32 v[44:45],v57 offset0:128 offset1:130
ds_read2_b32 v[46:47],v57 offset0:132 offset1:134
ds_read2_b32 v[48:49],v58 offset0:128 offset1:130
ds_read2_b32 v[50:51],v58 offset0:132 offset1:134
ds_read2_b32 v[52:53],v59 offset0:128 offset1:130
ds_read2_b32 v[54:55],v59 offset0:132 offset1:134
s_waitcnt lgkmcnt(12)
v_smfmac_f32_16x16x64_bf16 v[100:103],v[24:27],a[128:135],v2
v_smfmac_f32_16x16x64_bf16 v[112:115],v[24:27],v[128:135],v2
v_smfmac_f32_16x16x64_bf16 v[108:111],v[24:27],a[136:143],v2
v_smfmac_f32_16x16x64_bf16 v[116:119],v[24:27],v[136:143],v2
s_waitcnt lgkmcnt(12)
v_smfmac_f32_16x16x64_bf16 v[100:103],v[28:31],a[144:151],v2
v_smfmac_f32_16x16x64_bf16 v[112:115],v[28:31],v[144:151],v2
v_smfmac_f32_16x16x64_bf16 v[108:111],v[28:31],a[152:159],v2
v_smfmac_f32_16x16x64_bf16 v[116:119],v[28:31],v[152:159],v2
s_waitcnt lgkmcnt(10)
v_smfmac_f32_16x16x64_bf16 v[100:103],v[32:35],a[160:167],v2
v_smfmac_f32_16x16x64_bf16 v[112:115],v[32:35],v[160:167],v2
v_smfmac_f32_16x16x64_bf16 v[108:111],v[32:35],a[168:175],v2
v_smfmac_f32_16x16x64_bf16 v[116:119],v[32:35],v[168:175],v2
s_waitcnt lgkmcnt(8)
v_smfmac_f32_16x16x64_bf16 v[100:103],v[36:39],a[176:183],v2
v_smfmac_f32_16x16x64_bf16 v[112:115],v[36:39],v[176:183],v2
v_smfmac_f32_16x16x64_bf16 v[108:111],v[36:39],a[184:191],v2
v_smfmac_f32_16x16x64_bf16 v[116:119],v[36:39],v[184:191],v2
s_waitcnt lgkmcnt(6)
v_smfmac_f32_16x16x64_bf16 v[100:103],v[40:43],a[192:199],v2
v_smfmac_f32_16x16x64_bf16 v[112:115],v[40:43],v[192:199],v2
v_smfmac_f32_16x16x64_bf16 v[108:111],v[40:43],a[200:207],v2
v_smfmac_f32_16x16x64_bf16 v[116:119],v[40:43],v[200:207],v2
s_waitcnt lgkmcnt(4)
v_smfmac_f32_16x16x64_bf16 v[100:103],v[44:47],a[208:215],v2
v_smfmac_f32_16x16x64_bf16 v[112:115],v[44:47],v[208:215],v2
v_smfmac_f32_16x16x64_bf16 v[108:111],v[44:47],a[216:223],v2
v_smfmac_f32_16x16x64_bf16 v[116:119],v[44:47],v[216:223],v2
s_waitcnt lgkmcnt(2)
v_smfmac_f32_16x16x64_bf16 v[100:103],v[48:51],a[224:231],v2
v_smfmac_f32_16x16x64_bf16 v[112:115],v[48:51],v[224:231],v2
v_smfmac_f32_16x16x64_bf16 v[108:111],v[48:51],a[232:239],v2
v_smfmac_f32_16x16x64_bf16 v[116:119],v[48:51],v[232:239],v2
s_waitcnt lgkmcnt(0)
v_smfmac_f32_16x16x64_bf16 v[100:103],v[52:55],a[240:247],v2
v_smfmac_f32_16x16x64_bf16 v[112:115],v[52:55],v[240:247],v2
v_smfmac_f32_16x16x64_bf16 v[108:111],v[52:55],a[248:255],v2
v_smfmac_f32_16x16x64_bf16 v[116:119],v[52:55],v[248:255],v2
v_add_f32 v100,v100,v102
v_add_f32 v112,v112,v114
s_nop 1
v_add_f32 v108,v108,v110
s_nop 2
v_add_f32 v116,v116,v118
v_cvt_pk_bf16_f32 v120,v100,v108
v_cvt_pk_bf16_f32 v121,v112,v116
ds_write_b32 v60,v120
ds_write_b16 v61,v121
ds_write_b16_d16_hi v61,v121 offset:1024
v_mov_b64 v[96:97],0
v_mov_b64 v[98:99],0
v_mov_b64 v[100:101],0
v_mov_b64 v[102:103],0
v_mov_b64 v[104:105],0
v_mov_b64 v[106:107],0
v_mov_b64 v[108:109],0
v_mov_b64 v[110:111],0
v_mov_b64 v[112:113],0
v_mov_b64 v[114:115],0
v_mov_b64 v[116:117],0
v_mov_b64 v[118:119],0
s_waitcnt vmcnt(0) lgkmcnt(0)
s_barrier
v_add_u32 v55,131072,v0
ds_read_b128 v[56:59],v55 offset:0
ds_read_b128 v[60:63],v55 offset:4096
ds_read_b128 v[64:67],v55 offset:1024
ds_read_b128 v[68:71],v55 offset:5120
ds_read_b128 v[72:75],v55 offset:2048
ds_read_b128 v[76:79],v55 offset:6144
ds_read_b128 v[80:83],v55 offset:3072
ds_read_b128 v[84:87],v55 offset:7168
v_add_u32 v123,s73,v55
ds_read_b128 v[88:91],v123 offset:8192
ds_read_b128 v[92:95],v123 offset:9216
v_xor_b32 v120,1024,v12
v_xor_b32 v121,2048,v12
v_xor_b32 v122,3072,v12
buffer_load_dwordx4 v[24:27],v13,s[8:11],s64 offen sc1
buffer_load_dwordx4 v[24:27],v13,s[8:11],s64 offen sc1
L_chain_214:
L_cpa_215:
buffer_load_dwordx4 v[24:27],v13,s[8:11],s64 offen sc1
s_sub_u32 s49,s49,1
s_cbranch_scc1 L_abort
s_waitcnt vmcnt(2)
v_max3_u32 v123,v24,v25,v26
v_max_u32 v123,v27,v123
v_cmp_le_u32 vcc,s72,v123
ds_write_b128 v12,v[24:27] offset:0
s_cbranch_vccnz L_cpa_215
L_cgo_218:
v_smfmac_f32_16x16x64_bf16 v[96:99],v[24:27],a[0:7],v2
buffer_load_dwordx4 v[40:43],v13,s[8:11],s70 offen sc1
v_smfmac_f32_16x16x64_bf16 v[100:103],v[24:27],a[128:135],v2
s_waitcnt lgkmcnt(0)
s_barrier
ds_read_b128 v[28:31],v120 offset:0
v_smfmac_f32_16x16x64_bf16 v[104:107],v[24:27],a[8:15],v2
ds_read_b128 v[32:35],v121 offset:0
v_smfmac_f32_16x16x64_bf16 v[108:111],v[24:27],a[136:143],v2
ds_read_b128 v[36:39],v122 offset:0
v_smfmac_f32_16x16x64_bf16 v[112:115],v[24:27],v[128:135],v2
v_smfmac_f32_16x16x64_bf16 v[116:119],v[24:27],v[136:143],v2
s_waitcnt lgkmcnt(2)
v_smfmac_f32_16x16x64_bf16 v[96:99],v[28:31],a[16:23],v2
s_add_u32 m0,s73,131072
v_smfmac_f32_16x16x64_bf16 v[100:103],v[28:31],a[144:151],v2
s_add_u32 s57,s67,8192
v_smfmac_f32_16x16x64_bf16 v[104:107],v[28:31],a[24:31],v2
s_cmp_lt_u32 s19,s76
s_cbranch_scc1 L_ckw_204
L_ckb_205:
v_smfmac_f32_16x16x64_bf16 v[108:111],v[28:31],a[152:159],v2
s_waitcnt vmcnt(0) lgkmcnt(1)
v_smfmac_f32_16x16x64_bf16 v[96:99],v[32:35],a[32:39],v2
ds_write_b128 v12,v[40:43] offset:4096
v_max3_u32 v123,v40,v41,v42
v_smfmac_f32_16x16x64_bf16 v[100:103],v[32:35],a[160:167],v2
v_max_u32 v123,v43,v123
v_smfmac_f32_16x16x64_bf16 v[104:107],v[32:35],a[40:47],v2
v_cmp_le_u32 vcc,s72,v123
v_smfmac_f32_16x16x64_bf16 v[108:111],v[32:35],a[168:175],v2
v_smfmac_f32_16x16x64_bf16 v[112:115],v[28:31],v[144:151],v2
s_cbranch_vccnz L_cpb_221
L_cback_223:
s_waitcnt lgkmcnt(0)
s_barrier
v_smfmac_f32_16x16x64_bf16 v[96:99],v[36:39],a[48:55],v2
buffer_store_dwordx4 v[124:127],v0,s[8:11],s54 offen sc1
v_smfmac_f32_16x16x64_bf16 v[100:103],v[36:39],a[176:183],v2
ds_read_b128 v[44:47],v120 offset:4096
v_smfmac_f32_16x16x64_bf16 v[104:107],v[36:39],a[56:63],v2
buffer_load_dwordx4 v0,s[8:11],s67 offen sc1 lds
v_smfmac_f32_16x16x64_bf16 v[108:111],v[36:39],a[184:191],v2
ds_read_b128 v[48:51],v121 offset:4096
v_smfmac_f32_16x16x64_bf16 v[96:99],v[40:43],a[64:71],v2
buffer_load_dwordx4 v0,s[8:11],s67 offen offset:1024 sc1 lds
s_add_u32 m0,s73,139264
v_smfmac_f32_16x16x64_bf16 v[100:103],v[40:43],a[192:199],v2
ds_read_b128 v[52:55],v122 offset:4096
v_smfmac_f32_16x16x64_bf16 v[104:107],v[40:43],a[72:79],v2
buffer_load_dwordx4 v0,s[8:11],s57 offen sc1 lds
s_add_u32 s67,s67,786432
v_smfmac_f32_16x16x64_bf16 v[108:111],v[40:43],a[200:207],v2
ds_read_b32 v123,v8 offset:2560
s_waitcnt lgkmcnt(3)
v_smfmac_f32_16x16x64_bf16 v[96:99],v[44:47],a[80:87],v2
buffer_load_dwordx4 v0,s[8:11],s57 offen offset:1024 sc1 lds
v_smfmac_f32_16x16x64_bf16 v[100:103],v[44:47],a[208:215],v2
s_waitcnt lgkmcnt(2)
v_smfmac_f32_16x16x64_bf16 v[96:99],v[48:51],a[96:103],v2
buffer_load_dword v23,v22,s[8:11],s75 offen sc1
v_smfmac_f32_16x16x64_bf16 v[100:103],v[48:51],a[224:231],v2
s_waitcnt lgkmcnt(0)
v_smfmac_f32_16x16x64_bf16 v[96:99],v[52:55],a[112:119],v2
v_smfmac_f32_16x16x64_bf16 v[100:103],v[52:55],a[240:247],v2
v_readfirstlane_b32 s58,v123
v_smfmac_f32_16x16x64_bf16 v[104:107],v[44:47],a[88:95],v2
v_smfmac_f32_16x16x64_bf16 v[108:111],v[44:47],a[216:223],v2
s_cmp_lg_u32 s58,0
s_cbranch_scc1 L_cjump_207
v_smfmac_f32_16x16x64_bf16 v[104:107],v[48:51],a[104:111],v2
v_add_f32 v96,v96,v98
v_smfmac_f32_16x16x64_bf16 v[108:111],v[48:51],a[232:239],v2
v_add_f32 v97,v97,v99
v_smfmac_f32_16x16x64_bf16 v[104:107],v[52:55],a[120:127],v2
v_cvt_pk_bf16_f32 v120,v96,v97
v_smfmac_f32_16x16x64_bf16 v[108:111],v[52:55],a[248:255],v2
v_add_f32 v100,v100,v102
v_smfmac_f32_16x16x64_bf16 v[116:119],v[28:31],v[152:159],v2
v_add_f32 v101,v101,v103
v_smfmac_f32_16x16x64_bf16 v[112:115],v[32:35],v[160:167],v2
v_cvt_pk_bf16_f32 v121,v100,v101
v_add_f32 v104,v104,v106
v_add_f32 v105,v105,v107
v_cvt_pk_bf16_f32 v122,v104,v105
v_add_f32 v108,v108,v110
v_add_f32 v109,v109,v111
v_cvt_pk_bf16_f32 v123,v108,v109
ds_write_b128 v4,v[120:123]
v_smfmac_f32_16x16x64_bf16 v[116:119],v[32:35],v[168:175],v2
s_mov_b32 s54,s68
s_add_u32 s68,s68,131072
v_mov_b32 v125,0
v_smfmac_f32_16x16x64_bf16 v[112:115],v[36:39],v[176:183],v2
s_cmp_eq_u32 s51,63
s_cbranch_scc1 L_cend_217
v_smfmac_f32_16x16x64_bf16 v[116:119],v[36:39],v[184:191],v2
v_smfmac_f32_16x16x64_bf16 v[112:115],v[40:43],v[192:199],v2
s_waitcnt lgkmcnt(0)
s_barrier
ds_read_b64_tr_b16 v[96:97],v5 offset:0
ds_read_b64_tr_b16 v[98:99],v6 offset:0
v_smfmac_f32_16x16x64_bf16 v[116:119],v[40:43],v[200:207],v2
ds_read_b64_tr_b16 v[100:101],v5 offset:1024
v_smfmac_f32_16x16x64_bf16 v[112:115],v[44:47],v[208:215],v2
ds_read_b64_tr_b16 v[102:103],v6 offset:1024
v_smfmac_f32_16x16x64_bf16 v[116:119],v[44:47],v[216:223],v2
ds_read_b64_tr_b16 v[104:105],v5 offset:2048
v_smfmac_f32_16x16x64_bf16 v[112:115],v[48:51],v[224:231],v2
ds_read_b64_tr_b16 v[106:107],v6 offset:2048
s_waitcnt lgkmcnt(4)
v_mfma_f32_16x16x32_bf16 v[24:27],v[56:59],v[96:99],0
ds_read_b64_tr_b16 v[108:109],v5 offset:3072
v_mfma_f32_16x16x32_bf16 v[28:31],v[60:63],v[96:99],0
ds_read_b64_tr_b16 v[110:111],v6 offset:3072
v_mfma_f32_16x16x32_bf16 v[32:35],v[96:99],v[96:99],0
ds_read_b128 v[40:43],v11 offset:12288
s_waitcnt lgkmcnt(5)
v_mfma_f32_16x16x32_bf16 v[24:27],v[64:67],v[100:103],v[24:27]
ds_read_b128 v[56:59],v11 offset:0
v_mfma_f32_16x16x32_bf16 v[28:31],v[68:71],v[100:103],v[28:31]
ds_read_b128 v[60:63],v11 offset:1024
v_mfma_f32_16x16x32_bf16 v[32:35],v[100:103],v[100:103],v[32:35]
ds_read_b128 v[96:99],v11 offset:8192
s_waitcnt lgkmcnt(6)
v_mfma_f32_16x16x32_bf16 v[24:27],v[72:75],v[104:107],v[24:27]
ds_read_b128 v[64:67],v11 offset:2048
v_mfma_f32_16x16x32_bf16 v[28:31],v[76:79],v[104:107],v[28:31]
ds_read_b128 v[68:71],v11 offset:3072
v_mfma_f32_16x16x32_bf16 v[32:35],v[104:107],v[104:107],v[32:35]
ds_read_b128 v[100:103],v11 offset:9216
s_waitcnt lgkmcnt(7)
v_mfma_f32_16x16x32_bf16 v[24:27],v[80:83],v[108:111],v[24:27]
ds_read_b128 v[72:75],v11 offset:4096
v_mfma_f32_16x16x32_bf16 v[28:31],v[84:87],v[108:111],v[28:31]
ds_read_b128 v[76:79],v11 offset:5120
v_mfma_f32_16x16x32_bf16 v[32:35],v[108:111],v[108:111],v[32:35]
ds_read_b128 v[104:107],v11 offset:10240
v_smfmac_f32_16x16x64_bf16 v[116:119],v[48:51],v[232:239],v2
ds_read_b128 v[80:83],v11 offset:6144
v_smfmac_f32_16x16x64_bf16 v[112:115],v[52:55],v[240:247],v2
ds_read_b128 v[84:87],v11 offset:7168
v_smfmac_f32_16x16x64_bf16 v[116:119],v[52:55],v[248:255],v2
ds_read_b128 v[108:111],v11 offset:11264
v_max3_f32 v126,v24,v25,v26
v_max3_f32 v127,v27,v28,v29
v_max3_f32 v126,v30,v31,v126
v_max3_f32 v127,v34,v35,v127
v_max_f32 v126,v126,v127
v_max_f32 v127,v126,v127
v_pk_mul_f32 v[34:35],v[34:35],v[0:1] op_sel:[0,1]
v_pk_mul_f32 v[24:25],v[24:25],v[0:1] op_sel:[0,1]
v_permlane16_swap_b32 v126,v127
v_max_f32 v126,v126,v127
v_max_f32 v127,v126,v127
v_pk_mul_f32 v[26:27],v[26:27],v[0:1] op_sel:[0,1]
v_pk_mul_f32 v[28:29],v[28:29],v[0:1] op_sel:[0,1]
v_permlane32_swap_b32 v126,v127
v_max_f32 v126,v126,v127
v_mul_f32 v126,v1,v126
v_pk_mul_f32 v[30:31],v[30:31],v[0:1] op_sel:[0,1]
v_pk_add_f32 v[34:35],v[34:35],v[126:127] op_sel_hi:[1,0] neg_lo:[0,1] neg_hi:[0,1]
v_pk_add_f32 v[112:113],v[112:113],v[114:115]
v_pk_add_f32 v[116:117],v[116:117],v[118:119]
v_pk_add_f32 v[24:25],v[24:25],v[126:127] op_sel_hi:[1,0] neg_lo:[0,1] neg_hi:[0,1]
v_pk_add_f32 v[26:27],v[26:27],v[126:127] op_sel_hi:[1,0] neg_lo:[0,1] neg_hi:[0,1]
v_pk_add_f32 v[28:29],v[28:29],v[126:127] op_sel_hi:[1,0] neg_lo:[0,1] neg_hi:[0,1]
v_pk_add_f32 v[30:31],v[30:31],v[126:127] op_sel_hi:[1,0] neg_lo:[0,1] neg_hi:[0,1]
v_exp_f32 v34,v34
v_exp_f32 v35,v35
v_cvt_pk_bf16_f32 v126,v112,v113
v_cvt_pk_bf16_f32 v124,v34,v35
v_cvt_pk_bf16_f32 v127,v116,v117
v_cvt_pk_bf16_f32 v36,v116,v117
v_mfma_f32_16x16x16_bf16 v[32:35],v[14:15],v[124:125],0
ds_read_b128 v[44:47],v11 offset:13312
v_exp_f32 v24,v24
v_mfma_f32_16x16x16_bf16 v[112:115],v[126:127],v[124:125],0
ds_read_b128 v[48:51],v11 offset:14336
v_exp_f32 v25,v25
v_mfma_f32_16x16x16_bf16 v[116:119],v[36:37],v[124:125],0
ds_read_b128 v[52:55],v11 offset:15360
v_exp_f32 v26,v26
v_exp_f32 v27,v27
v_cvt_pk_bf16_f32 v120,v24,v25
v_exp_f32 v28,v28
v_exp_f32 v29,v29
v_cvt_pk_bf16_f32 v121,v26,v27
v_exp_f32 v30,v30
v_exp_f32 v31,v31
v_cvt_pk_bf16_f32 v122,v28,v29
v_cvt_pk_bf16_f32 v123,v30,v31
s_add_u32 s75,s75,8192
s_add_u32 s51,s51,1
v_mfma_f32_16x16x32_bf16 v[32:35],v[14:17],v[120:123],v[32:35]
v_mfma_f32_16x16x32_bf16 v[112:115],v[88:91],v[120:123],v[112:115]
ds_read_b128 v[88:91],v11 offset:16384
v_mfma_f32_16x16x32_bf16 v[116:119],v[92:95],v[120:123],v[116:119]
ds_read_b128 v[92:95],v11 offset:17408
v_rcp_f32 v32,v32
v_mov_b64 v[24:25],-1
v_mov_b64 v[26:27],-1
s_add_u32 s64,s75,13631488
s_add_u32 s70,s64,4096
v_pk_mul_f32 v[112:113],v[112:113],v[32:33] op_sel_hi:[1,0]
v_pk_mul_f32 v[114:115],v[114:115],v[32:33] op_sel_hi:[1,0]
v_pk_mul_f32 v[116:117],v[116:117],v[32:33] op_sel_hi:[1,0]
v_pk_mul_f32 v[118:119],v[118:119],v[32:33] op_sel_hi:[1,0]
v_cvt_pk_bf16_f32 v120,v112,v116
v_cvt_pk_bf16_f32 v121,v113,v117
v_cvt_pk_bf16_f32 v122,v114,v118
v_cvt_pk_bf16_f32 v123,v115,v119
ds_write_b128 v7,v[120:123]
buffer_store_dwordx4 v[24:27],v0,s[8:11],s69 offen
buffer_store_dwordx4 v[24:27],v0,s[8:11],s69 offen offset:1024
v_mov_b64 v[112:113],0
v_mov_b64 v[114:115],0
v_mov_b64 v[116:117],0
v_mov_b64 v[118:119],0
s_waitcnt lgkmcnt(0)
s_barrier
ds_read_b128 v[24:27],v8 offset:0
ds_read_b128 v[28:31],v8 offset:512
ds_read_b128 v[32:35],v8 offset:1024
ds_read_b128 v[36:39],v8 offset:1536
v_mov_b64 v[120:121],0
v_mov_b64 v[122:123],0
s_add_u32 s57,s65,65536
s_add_u32 s58,s65,131072
s_add_u32 s59,s65,196608
s_add_u32 s56,s18,s75
s_waitcnt lgkmcnt(3)
v_smfmac_f32_16x16x64_bf16 v[112:115],v[24:27],v[56:63],v3
ds_read_b128 v[56:59],v11 offset:18432
s_waitcnt lgkmcnt(3)
v_smfmac_f32_16x16x64_bf16 v[112:115],v[28:31],v[64:71],v3
ds_read_b128 v[60:63],v11 offset:19456
s_waitcnt lgkmcnt(3)
v_smfmac_f32_16x16x64_bf16 v[112:115],v[32:35],v[72:79],v3
ds_read_b128 v[64:67],v11 offset:20480
s_waitcnt lgkmcnt(3)
v_smfmac_f32_16x16x64_bf16 v[112:115],v[36:39],v[80:87],v3
ds_read_b128 v[68:71],v11 offset:21504
v_smfmac_f32_16x16x64_bf16 v[116:119],v[24:27],v[96:103],v3
ds_read_b128 v[72:75],v11 offset:22528
v_smfmac_f32_16x16x64_bf16 v[116:119],v[28:31],v[104:111],v3
ds_read_b128 v[76:79],v11 offset:23552
v_cvt_pk_bf16_f32 v112,v112,v113
v_smfmac_f32_16x16x64_bf16 v[116:119],v[32:35],v[40:47],v3
ds_read_b128 v[80:83],v11 offset:24576
v_cvt_pk_bf16_f32 v113,v114,v115
buffer_store_dwordx2 v[112:113],v9,s[8:11],s65 offen
v_smfmac_f32_16x16x64_bf16 v[116:119],v[36:39],v[48:55],v3
ds_read_b128 v[84:87],v11 offset:25600
v_mov_b64 v[112:113],0
v_smfmac_f32_16x16x64_bf16 v[120:123],v[24:27],v[88:95],v3
ds_read_b128 v[96:99],v11 offset:26624
ds_read_b128 v[100:103],v11 offset:27648
v_mov_b64 v[114:115],0
s_waitcnt lgkmcnt(8)
v_smfmac_f32_16x16x64_bf16 v[120:123],v[28:31],v[56:63],v3
ds_read_b128 v[104:107],v11 offset:28672
v_cvt_pk_bf16_f32 v116,v116,v117
s_waitcnt lgkmcnt(7)
v_smfmac_f32_16x16x64_bf16 v[120:123],v[32:35],v[64:71],v3
ds_read_b128 v[108:111],v11 offset:29696
ds_read_b128 v[40:43],v11 offset:30720
v_cvt_pk_bf16_f32 v117,v118,v119
buffer_store_dwordx2 v[116:117],v9,s[8:11],s57 offen
s_waitcnt lgkmcnt(7)
v_smfmac_f32_16x16x64_bf16 v[120:123],v[36:39],v[72:79],v3
ds_read_b128 v[44:47],v11 offset:31744
v_add_u32 v52,s50,v5
s_waitcnt lgkmcnt(6)
v_smfmac_f32_16x16x64_bf16 v[112:115],v[24:27],v[80:87],v3
v_add_u32 v54,s50,v6
s_waitcnt lgkmcnt(4)
v_smfmac_f32_16x16x64_bf16 v[112:115],v[28:31],v[96:103],v3
ds_read_b64_tr_b16 v[52:53],v52
v_cvt_pk_bf16_f32 v120,v120,v121
s_waitcnt lgkmcnt(3)
v_smfmac_f32_16x16x64_bf16 v[112:115],v[32:35],v[104:111],v3
ds_read_b64_tr_b16 v[54:55],v54
v_cvt_pk_bf16_f32 v121,v122,v123
buffer_store_dwordx2 v[120:121],v9,s[8:11],s58 offen
s_waitcnt lgkmcnt(2)
v_smfmac_f32_16x16x64_bf16 v[112:115],v[36:39],v[40:47],v3
v_mov_b64 v[116:117],0
v_mov_b64 v[118:119],0
s_xor_b32 s65,s65,262144
v_mov_b32_dpp v124,v126 quad_perm:[2,3,2,3] row_mask:0xf bank_mask:0xf
v_mov_b32_dpp v125,v127 quad_perm:[2,3,2,3] row_mask:0xf bank_mask:0xf
s_mov_b32 vcc_lo,0xcccccccc
s_mov_b32 vcc_hi,0xcccccccc
s_nop 0
v_cvt_pk_bf16_f32 v112,v112,v113
v_cvt_pk_bf16_f32 v113,v114,v115
buffer_store_dwordx2 v[112:113],v9,s[8:11],s59 offen
s_waitcnt lgkmcnt(0)
s_buffer_load_dword s19,s[8:11],s56
v_cndmask_b32 v124,v124,v52,vcc
v_cndmask_b32 v125,v125,v53,vcc
v_cndmask_b32 v126,v126,v54,vcc
v_cndmask_b32 v127,v127,v55,vcc
s_cmp_lt_u32 s46,2
s_waitcnt vmcnt(3)
s_cbranch_scc1 L_crg_224
s_cmp_eq_u32 s46,2
s_waitcnt vmcnt(1)
s_cbranch_scc1 L_crg_224
s_waitcnt vmcnt(0)
L_crg_224:
buffer_load_dwordx4 v[32:35],v0,s[8:11],s66 offen offset:0 sc1
buffer_load_dwordx4 v[36:39],v0,s[8:11],s66 offen offset:1024 sc1
v_mov_b64 v[96:97],0
v_mov_b64 v[98:99],0
v_mov_b64 v[100:101],0
v_mov_b64 v[102:103],0
v_mov_b64 v[104:105],0
v_mov_b64 v[106:107],0
v_mov_b64 v[108:109],0
v_mov_b64 v[110:111],0
v_mov_b64 v[112:113],0
v_mov_b64 v[114:115],0
v_add_u32 v55,131072,v0
v_add_u32 v123,s73,v55
v_xor_b32 v120,1024,v12
v_xor_b32 v121,2048,v12
v_xor_b32 v122,3072,v12
buffer_load_dwordx4 v[44:47],v0,s[8:11],s66 offen offset:0 sc1
buffer_load_dwordx4 v[48:51],v0,s[8:11],s66 offen offset:1024 sc1
s_cmp_ge_u32 s51,63
s_cselect_b32 s76,0,1
v_readlane_b32 s56,v23,5
v_readlane_b32 s20,v23,4
v_add_u32 v23,-1,v23
v_cmp_le_u32 vcc,s30,v23
s_cmp_gt_u32 s51,61
s_cselect_b32 s77,0,vcc_hi
s_cmp_gt_u32 s20,s30
s_cselect_b32 s77,1,s77
s_cmp_lg_u32 s77,0
s_cselect_b32 s76,2,s76
s_cmp_gt_u32 s56,s30
s_cbranch_scc1 L_cld_200
L_clb_201:
s_cmp_eq_u32 s46,0
s_cselect_b32 s76,s76,0
s_waitcnt vmcnt(3)
v_mfma_f32_16x16x32_bf16 v[28:31],v[18:21],v[32:35],0
s_waitcnt vmcnt(2)
v_mfma_f32_16x16x32_bf16 v[28:31],v[18:21],v[36:39],v[28:31]
s_nop 7
v_cmp_u_f32 vcc,v28,v28
v_add_f32_dpp v52,v28,v28 row_ror:8 row_mask:0xf bank_mask:0x3
v_add_f32_dpp v53,v29,v29 row_ror:8 row_mask:0xf bank_mask:0x3
v_add_f32_dpp v52,v30,v30 row_ror:8 row_mask:0xf bank_mask:0xc
v_add_f32_dpp v53,v31,v31 row_ror:8 row_mask:0xf bank_mask:0xc
s_nop 0
v_add_f32_dpp v52,v52,v52 row_shl:4 row_mask:0xf bank_mask:0x5
v_add_f32_dpp v53,v53,v53 row_shl:4 row_mask:0xf bank_mask:0x5
s_cbranch_vccnz L_crp_219
L_cok_225:
v_cvt_pk_bf16_f32 v54,v52,v53
buffer_store_dword v54,v10,s[8:11],s64 offen
s_mov_b32 s69,s66
s_xor_b32 s66,s66,262144
s_barrier
ds_read_b128 v[56:59],v55 offset:0
ds_read_b128 v[60:63],v55 offset:4096
ds_read_b128 v[64:67],v55 offset:1024
buffer_load_dwordx4 v[24:27],v13,s[8:11],s64 offen sc1
ds_read_b128 v[68:71],v55 offset:5120
ds_read_b128 v[72:75],v55 offset:2048
ds_read_b128 v[76:79],v55 offset:6144
ds_read_b128 v[80:83],v55 offset:3072
buffer_load_dwordx4 v[24:27],v13,s[8:11],s64 offen sc1
ds_read_b128 v[84:87],v55 offset:7168
ds_read_b128 v[88:91],v123 offset:8192
ds_read_b128 v[92:95],v123 offset:9216
s_branch L_chain_214
L_cpb_221:
buffer_load_dwordx4 v[40:43],v13,s[8:11],s70 offen sc1
s_sub_u32 s49,s49,1
s_cbranch_scc1 L_abort
s_waitcnt vmcnt(0)
v_max3_u32 v123,v40,v41,v42
v_max_u32 v123,v43,v123
v_cmp_le_u32 vcc,s72,v123
s_cbranch_vccnz L_cpb_221
ds_write_b128 v12,v[40:43] offset:4096
s_branch L_cback_223
L_crp_219:
buffer_load_dwordx4 v[32:35],v0,s[8:11],s66 offen offset:0 sc1
buffer_load_dwordx4 v[36:39],v0,s[8:11],s66 offen offset:1024 sc1
s_sub_u32 s49,s49,1
s_cbranch_scc1 L_abort
s_waitcnt vmcnt(3)
v_mfma_f32_16x16x32_bf16 v[28:31],v[18:21],v[44:47],0
s_waitcnt vmcnt(2)
v_mfma_f32_16x16x32_bf16 v[28:31],v[18:21],v[48:51],v[28:31]
s_nop 7
v_cmp_u_f32 vcc,v28,v28
v_add_f32_dpp v52,v28,v28 row_ror:8 row_mask:0xf bank_mask:0x3
v_add_f32_dpp v53,v29,v29 row_ror:8 row_mask:0xf bank_mask:0x3
v_add_f32_dpp v52,v30,v30 row_ror:8 row_mask:0xf bank_mask:0xc
v_add_f32_dpp v53,v31,v31 row_ror:8 row_mask:0xf bank_mask:0xc
s_nop 0
v_add_f32_dpp v52,v52,v52 row_shl:4 row_mask:0xf bank_mask:0x5
v_add_f32_dpp v53,v53,v53 row_shl:4 row_mask:0xf bank_mask:0x5
s_cbranch_vccz L_cok_225
buffer_load_dwordx4 v[44:47],v0,s[8:11],s66 offen offset:0 sc1
buffer_load_dwordx4 v[48:51],v0,s[8:11],s66 offen offset:1024 sc1
s_sub_u32 s49,s49,1
s_cbranch_scc1 L_abort
s_waitcnt vmcnt(3)
v_mfma_f32_16x16x32_bf16 v[28:31],v[18:21],v[32:35],0
s_waitcnt vmcnt(2)
v_mfma_f32_16x16x32_bf16 v[28:31],v[18:21],v[36:39],v[28:31]
s_nop 7
v_cmp_u_f32 vcc,v28,v28
v_add_f32_dpp v52,v28,v28 row_ror:8 row_mask:0xf bank_mask:0x3
v_add_f32_dpp v53,v29,v29 row_ror:8 row_mask:0xf bank_mask:0x3
v_add_f32_dpp v52,v30,v30 row_ror:8 row_mask:0xf bank_mask:0xc
v_add_f32_dpp v53,v31,v31 row_ror:8 row_mask:0xf bank_mask:0xc
s_nop 0
v_add_f32_dpp v52,v52,v52 row_shl:4 row_mask:0xf bank_mask:0x5
v_add_f32_dpp v53,v53,v53 row_shl:4 row_mask:0xf bank_mask:0x5
s_cbranch_vccz L_cok_225
s_branch L_crp_219
L_ckw_204:
s_cmp_eq_u32 s77,0
s_cbranch_scc1 L_cjw_206
s_andn2_b32 s31,0x7ff,s20
s_lshr_b32 s31,s31,5
s_cmp_gt_u32 s20,s30
s_cbranch_scc1 L_cjs_202
s_add_u32 s31,s51,2
s_lshl_b32 s59,s31,13
s_add_u32 s59,s59,10486016
v_lshrrev_b32 v45,2,v0
v_and_b32 v45,127,v45
L_ckk_226:
s_sleep 1
buffer_load_dword v44,v45,s[8:11],s59 offen sc1
s_sub_u32 s49,s49,1
s_cbranch_scc1 L_abort
s_waitcnt vmcnt(0)
v_cmp_eq_u32 vcc,0,v44
s_cbranch_vccnz L_ckk_226
v_cmp_lt_u32 vcc,s30,v44
s_cbranch_vccz L_cjw_206
L_cjs_202:
ds_write_b32 v8,v2 offset:2560
s_waitcnt lgkmcnt(0)
s_branch L_ckb_205
L_cld_200:
v_mov_b32 v23,s56
s_add_u32 s56,s75,10495616
buffer_store_dword v23,off,s[8:11],s56
s_waitcnt vmcnt(0)
s_branch L_clb_201
L_cjw_206:
s_cmp_lg_u32 s19,0
s_cbranch_scc1 L_ckb_205
s_add_u32 s59,s18,s75
L_ww_227:
s_sleep 1
buffer_load_dword v23,off,s[8:11],s59 sc1
s_sub_u32 s49,s49,1
s_cbranch_scc1 L_abort
s_waitcnt vmcnt(0)
v_readfirstlane_b32 s76,v23
s_cmp_eq_u32 s76,0
s_cbranch_scc1 L_ww_227
L_wwd_228:
s_branch L_ckb_205
L_cjump_207:
s_waitcnt vmcnt(0) lgkmcnt(0)
s_barrier
s_branch L_cst_203
L_cend_217:
v_smfmac_f32_16x16x64_bf16 v[116:119],v[36:39],v[184:191],v2
v_smfmac_f32_16x16x64_bf16 v[112:115],v[40:43],v[192:199],v2
v_smfmac_f32_16x16x64_bf16 v[116:119],v[40:43],v[200:207],v2
v_smfmac_f32_16x16x64_bf16 v[112:115],v[44:47],v[208:215],v2
v_smfmac_f32_16x16x64_bf16 v[116:119],v[44:47],v[216:223],v2
v_smfmac_f32_16x16x64_bf16 v[112:115],v[48:51],v[224:231],v2
v_smfmac_f32_16x16x64_bf16 v[116:119],v[48:51],v[232:239],v2
v_smfmac_f32_16x16x64_bf16 v[112:115],v[52:55],v[240:247],v2
v_smfmac_f32_16x16x64_bf16 v[116:119],v[52:55],v[248:255],v2
s_waitcnt lgkmcnt(0)
s_nop 2
v_pk_add_f32 v[112:113],v[112:113],v[114:115]
s_nop 2
v_pk_add_f32 v[116:117],v[116:117],v[118:119]
v_cvt_pk_bf16_f32 v126,v112,v113
v_cvt_pk_bf16_f32 v127,v116,v117
v_add_u32 v52,s50,v5
v_add_u32 v54,s50,v6
ds_read_b64_tr_b16 v[52:53],v52
ds_read_b64_tr_b16 v[54:55],v54
v_mov_b32_dpp v124,v126 quad_perm:[2,3,2,3] row_mask:0xf bank_mask:0xf
v_mov_b32_dpp v125,v127 quad_perm:[2,3,2,3] row_mask:0xf bank_mask:0xf
s_mov_b32 vcc_lo,0xcccccccc
s_mov_b32 vcc_hi,0xcccccccc
s_waitcnt lgkmcnt(0)
v_cndmask_b32 v124,v124,v52,vcc
v_cndmask_b32 v125,v125,v53,vcc
v_cndmask_b32 v126,v126,v54,vcc
v_cndmask_b32 v127,v127,v55,vcc
buffer_store_dwordx4 v[124:127],v0,s[8:11],s54 offen sc1
s_mov_b32 s51,64
s_waitcnt vmcnt(0)
s_barrier
s_nop 11
v_lshrrev_b32 v1,4,v0
s_endpgm
L_abort2:
s_endpgm
L_wc:
s_nop 11
s_cmp_eq_u32 s48,1
s_cbranch_scc1 L_rc1_229
s_cmp_eq_u32 s48,2
s_cbranch_scc1 L_rc2_230
v_and_b32 v120,15,v1
v_lshrrev_b32 v121,4,v1
v_and_b32 v122,2,v1
v_cmp_eq_u32 vcc,0,v122
v_mov_b32 v2,0xeeee
v_mov_b32 v123,0x4444
v_cndmask_b32 v2,v2,v123,vcc
v_and_b32 v122,1,v1
v_cmp_eq_u32 vcc,0,v122
v_mov_b32 v3,0xdddd
v_mov_b32 v123,0x8888
v_cndmask_b32 v3,v3,v123,vcc
v_lshrrev_b32 v122,1,v120
v_bfe_u32 v123,v120,2,1
v_xor_b32 v123,v123,v122
v_lshlrev_b32 v4,7,v123
v_and_b32 v123,1,v120
v_lshl_add_u32 v4,v123,6,v4
v_xor_b32 v123,v121,v122
v_and_b32 v123,3,v123
v_lshl_add_u32 v4,v123,4,v4
s_lshl_b32 s56,s46,10
s_add_u32 s56,s56,147456
v_add_u32 v4,s56,v4
v_lshlrev_b32 v122,1,v121
v_add_u32 v122,0,v122
v_and_b32 v123,1,v121
v_xor_b32 v123,v123,v122
v_lshlrev_b32 v5,7,v123
v_bfe_u32 v123,v120,3,1
v_lshl_add_u32 v5,v123,6,v5
v_xor_b32 v123,v120,v122
v_and_b32 v123,3,v123
v_lshl_add_u32 v5,v123,4,v5
v_bfe_u32 v123,v120,2,1
v_lshl_add_u32 v5,v123,3,v5
v_add_u32 v5,147456,v5
v_lshlrev_b32 v122,1,v121
v_add_u32 v122,1,v122
v_and_b32 v123,1,v121
v_xor_b32 v123,v123,v122
v_lshlrev_b32 v6,7,v123
v_bfe_u32 v123,v120,3,1
v_lshl_add_u32 v6,v123,6,v6
v_xor_b32 v123,v120,v122
v_and_b32 v123,3,v123
v_lshl_add_u32 v6,v123,4,v6
v_bfe_u32 v123,v120,2,1
v_lshl_add_u32 v6,v123,3,v6
v_add_u32 v6,147456,v6
v_lshlrev_b32 v7,7,v121
v_lshrrev_b32 v122,1,v120
v_lshl_add_u32 v8,v122,4,v7
v_add_u32 v8,151552,v8
v_lshrrev_b32 v122,2,v120
v_lshl_add_u32 v7,v122,5,v7
v_and_b32 v122,1,v120
v_lshl_add_u32 v7,v122,4,v7
v_and_b32 v122,2,v120
v_cmp_eq_u32 vcc,0,v122
s_lshl_b32 s56,s46,9
v_mov_b32 v122,2048
v_mov_b32 v123,s56
v_cndmask_b32 v122,v122,v123,vcc
v_add_u32 v7,v122,v7
v_add_u32 v7,151552,v7
v_lshrrev_b32 v122,3,v1
v_lshlrev_b32 v9,11,v122
v_and_b32 v122,7,v1
v_lshl_add_u32 v9,v122,3,v9
s_lshl_b32 s56,s46,14
s_lshl_b32 s57,s47,6
s_add_u32 s56,s56,s57
v_add_u32 v9,s56,v9
s_lshl_b32 s71,s46,5
s_add_u32 s71,s71,s47
s_bfe_u32 s56,s71,0x10003
s_lshl_b32 s56,s56,11
s_and_b32 s57,s71,1
s_lshl_b32 s57,s57,10
s_add_u32 s56,s56,s57
s_bfe_u32 s57,s71,0x10002
s_lshl_b32 s57,s57,9
s_add_u32 s56,s56,s57
s_bfe_u32 s57,s71,0x10001
s_lshl_b32 s57,s57,6
s_add_u32 s56,s56,s57
s_bfe_u32 s57,s71,0x10004
s_lshl_b32 s57,s57,8
s_add_u32 s56,s56,s57
s_bfe_u32 s57,s71,0x10005
s_lshl_b32 s57,s57,7
s_add_u32 s56,s56,s57
s_bfe_u32 s57,s71,0x10006
s_lshl_b32 s57,s57,12
s_add_u32 s56,s56,s57
v_and_b32 v122,3,v120
v_lshlrev_b32 v10,2,v122
v_bfe_u32 v122,v120,3,1
v_lshl_add_u32 v10,v122,4,v10
v_and_b32 v122,1,v121
v_lshl_add_u32 v10,v122,5,v10
v_add_u32 v10,s56,v10
v_and_b32 v123,36,v1
v_mov_b32 v122,0x80000000
v_cmp_eq_u32 vcc,0,v123
s_nop 1
v_cndmask_b32 v10,v122,v10,vcc
s_lshl_b32 s71,s71,11
s_lshl_b32 s73,s46,11
s_mov_b32 s72,0xffc00000
s_mov_b32 s74,0
v_and_b32 v11,1,v121
v_xor_b32 v11,v11,v120
v_and_b32 v11,3,v11
v_lshrrev_b32 v122,2,v120
v_lshl_add_u32 v11,v11,2,v122
v_lshl_add_u32 v11,v121,4,v11
v_lshlrev_b32 v11,4,v11
s_lshl_b32 s56,s46,15
v_add_u32 v11,s56,v11
v_lshrrev_b32 v13,3,v1
v_lshlrev_b32 v13,9,v13
v_and_b32 v122,7,v1
v_lshl_add_u32 v13,v122,4,v13
v_and_b32 v122,15,v1
v_and_b32 v123,1,v1
v_lshlrev_b32 v123,4,v123
v_mov_b32 v124,0x3f80
v_lshlrev_b32 v124,v123,v124
v_lshrrev_b32 v122,1,v122
v_cmp_eq_u32 vcc,0,v122
s_nop 1
v_cndmask_b32 v18,0,v124,vcc
v_cmp_eq_u32 vcc,1,v122
s_nop 1
v_cndmask_b32 v19,0,v124,vcc
v_cmp_eq_u32 vcc,2,v122
s_nop 1
v_cndmask_b32 v20,0,v124,vcc
v_cmp_eq_u32 vcc,3,v122
s_nop 1
v_cndmask_b32 v21,0,v124,vcc
s_and_b32 s56,s46,1
s_lshl_b32 s56,s56,8
s_and_b32 s57,s46,2
s_lshl_b32 s57,s57,6
s_add_u32 s56,s56,s57
v_add_u32 v13,s56,v13
s_add_u32 s56,s50,155648
v_add_u32 v12,s56,v0
v_mov_b64 v[14:15],s[28:29]
v_mov_b64 v[16:17],s[28:29]
v_add_u32 v22,11550720,v10
s_lshl_b32 s18,s47,2
s_add_u32 s18,s18,10493952
v_mov_b32 v1,s80
s_mov_b32 s65,14680064
s_add_u32 s66,s71,14680064
s_add_u32 s69,s71,14942208
s_mov_b32 s30,0x40000000
s_mov_b32 s51,0
L_cst_234:
s_cmp_lg_u32 s46,0
s_cbranch_scc1 L_csw_239
s_lshl_b32 s59,s51,13
s_lshl2_add_u32 s59,s47,s59
s_add_u32 s59,s59,10485760
s_buffer_load_dword s61,s[8:11],s59
s_waitcnt lgkmcnt(0)
s_cmp_lg_u32 s61,0
s_cbranch_scc1 L_wwd_241
L_ww_240:
s_sleep 1
buffer_load_dword v122,off,s[8:11],s59 sc1
s_sub_u32 s49,s49,1
s_cbranch_scc1 L_abort2
s_waitcnt vmcnt(0)
v_readfirstlane_b32 s61,v122
s_cmp_eq_u32 s61,0
s_cbranch_scc1 L_ww_240
L_wwd_241:
L_csw_239:
s_waitcnt lgkmcnt(0)
s_barrier
s_lshl_b32 s56,s51,5
s_add_u32 s56,s56,s47
s_mul_i32 s56,s56,24576
s_add_u32 s56,s56,100663296
s_add_u32 s67,s56,s73
s_add_u32 m0,s73,131072
s_add_u32 s57,s67,8192
buffer_load_dwordx4 v0,s[8:11],s67 offen sc1 lds
buffer_load_dwordx4 v0,s[8:11],s67 offen offset:1024 sc1 lds
s_add_u32 m0,s73,139264
s_add_u32 s67,s67,786432
buffer_load_dwordx4 v0,s[8:11],s57 offen sc1 lds
buffer_load_dwordx4 v0,s[8:11],s57 offen offset:1024 sc1 lds
s_lshl_b32 s75,s51,13
s_add_u32 s56,s75,11542528
buffer_load_dword v23,v10,s[8:11],s56 offen sc1
s_add_u32 s64,s75,11534336
s_add_u32 s70,s64,4096
s_lshl_b32 s68,s51,5
s_add_u32 s68,s68,s47
s_lshl_b32 s68,s68,12
s_lshl_b32 s56,s46,10
s_add_u32 s68,s68,s56
s_add_u32 s68,s68,41943040
s_mov_b32 s54,0x80000000
s_mov_b32 s77,0
s_mov_b32 s19,0
s_cmp_eq_u32 s51,63
s_cselect_b32 s76,1,s46
s_cmp_eq_u32 s76,0
s_cselect_b32 s76,1,0
v_mov_b64 v[96:97],0
v_mov_b64 v[98:99],0
v_mov_b64 v[100:101],0
v_mov_b64 v[102:103],0
v_mov_b64 v[104:105],0
v_mov_b64 v[106:107],0
v_mov_b64 v[108:109],0
v_mov_b64 v[110:111],0
v_mov_b64 v[112:113],0
v_mov_b64 v[114:115],0
v_mov_b64 v[116:117],0
v_mov_b64 v[118:119],0
buffer_load_dwordx4 v[88:91],v13,s[8:11],s64 offen
buffer_load_dwordx4 v[88:91],v13,s[8:11],s70 offen
s_waitcnt vmcnt(19)
v_swap_b32 v25,v28
v_swap_b32 v26,v32
v_swap_b32 v27,v36
v_swap_b32 v30,v33
v_swap_b32 v31,v37
v_swap_b32 v35,v38
ds_write_b128 v93,v[24:27] offset:4096
ds_write_b128 v94,v[28:31] offset:4096
ds_write_b128 v93,v[32:35] offset:4224
ds_write_b128 v94,v[36:39] offset:4224
s_waitcnt vmcnt(15)
v_swap_b32 v41,v44
v_swap_b32 v42,v48
v_swap_b32 v43,v52
v_swap_b32 v46,v49
v_swap_b32 v47,v53
v_swap_b32 v51,v54
ds_write_b128 v93,v[40:43] offset:5120
ds_write_b128 v94,v[44:47] offset:5120
ds_write_b128 v93,v[48:51] offset:5248
ds_write_b128 v94,v[52:55] offset:5248
s_waitcnt vmcnt(11)
v_swap_b32 v57,v60
v_swap_b32 v58,v64
v_swap_b32 v59,v68
v_swap_b32 v62,v65
v_swap_b32 v63,v69
v_swap_b32 v67,v70
ds_write_b128 v93,v[56:59] offset:6144
ds_write_b128 v94,v[60:63] offset:6144
ds_write_b128 v93,v[64:67] offset:6272
ds_write_b128 v94,v[68:71] offset:6272
s_waitcnt vmcnt(7)
v_swap_b32 v73,v76
v_swap_b32 v74,v80
v_swap_b32 v75,v84
v_swap_b32 v78,v81
v_swap_b32 v79,v85
v_swap_b32 v83,v86
ds_write_b128 v93,v[72:75] offset:7168
ds_write_b128 v94,v[76:79] offset:7168
ds_write_b128 v93,v[80:83] offset:7296
ds_write_b128 v94,v[84:87] offset:7296
s_buffer_load_dword s19,s[8:11],s18
s_waitcnt vmcnt(0) lgkmcnt(0)
s_barrier
v_add_u32 v55,131072,v0
ds_read_b128 v[56:59],v55 offset:0
ds_read_b128 v[60:63],v55 offset:4096
ds_read_b128 v[64:67],v55 offset:1024
ds_read_b128 v[68:71],v55 offset:5120
ds_read_b128 v[72:75],v55 offset:2048
ds_read_b128 v[76:79],v55 offset:6144
ds_read_b128 v[80:83],v55 offset:3072
ds_read_b128 v[84:87],v55 offset:7168
v_add_u32 v123,s73,v55
ds_read_b128 v[88:91],v123 offset:8192
ds_read_b128 v[92:95],v123 offset:9216
v_xor_b32 v120,1024,v12
v_xor_b32 v121,2048,v12
v_xor_b32 v122,3072,v12
buffer_load_dwordx4 v[24:27],v13,s[8:11],s64 offen sc1
buffer_load_dwordx4 v[24:27],v13,s[8:11],s64 offen sc1
L_chain_242:
L_cpa_243:
buffer_load_dwordx4 v[24:27],v13,s[8:11],s64 offen sc1
s_sub_u32 s49,s49,1
s_cbranch_scc1 L_abort2
s_waitcnt vmcnt(2)
v_max3_u32 v123,v24,v25,v26
v_max_u32 v123,v27,v123
v_cmp_le_u32 vcc,s72,v123
ds_write_b128 v12,v[24:27] offset:0
s_cbranch_vccnz L_cpa_243
L_cgo_246:
v_smfmac_f32_16x16x64_bf16 v[96:99],v[24:27],a[0:7],v2
buffer_load_dwordx4 v[40:43],v13,s[8:11],s70 offen sc1
v_smfmac_f32_16x16x64_bf16 v[100:103],v[24:27],a[128:135],v2
s_waitcnt lgkmcnt(0)
s_barrier
ds_read_b128 v[28:31],v120 offset:0
v_smfmac_f32_16x16x64_bf16 v[104:107],v[24:27],a[8:15],v2
ds_read_b128 v[32:35],v121 offset:0
v_smfmac_f32_16x16x64_bf16 v[108:111],v[24:27],a[136:143],v2
ds_read_b128 v[36:39],v122 offset:0
v_smfmac_f32_16x16x64_bf16 v[112:115],v[24:27],v[128:135],v2
v_smfmac_f32_16x16x64_bf16 v[116:119],v[24:27],v[136:143],v2
s_waitcnt lgkmcnt(2)
v_smfmac_f32_16x16x64_bf16 v[96:99],v[28:31],a[16:23],v2
s_add_u32 m0,s73,131072
v_smfmac_f32_16x16x64_bf16 v[100:103],v[28:31],a[144:151],v2
s_add_u32 s57,s67,8192
v_smfmac_f32_16x16x64_bf16 v[104:107],v[28:31],a[24:31],v2
s_cmp_lt_u32 s19,s76
s_cbranch_scc1 L_ckw_235
L_ckb_236:
v_smfmac_f32_16x16x64_bf16 v[108:111],v[28:31],a[152:159],v2
s_waitcnt vmcnt(0) lgkmcnt(1)
v_smfmac_f32_16x16x64_bf16 v[96:99],v[32:35],a[32:39],v2
ds_write_b128 v12,v[40:43] offset:4096
v_max3_u32 v123,v40,v41,v42
v_smfmac_f32_16x16x64_bf16 v[100:103],v[32:35],a[160:167],v2
v_max_u32 v123,v43,v123
v_smfmac_f32_16x16x64_bf16 v[104:107],v[32:35],a[40:47],v2
v_cmp_le_u32 vcc,s72,v123
v_smfmac_f32_16x16x64_bf16 v[108:111],v[32:35],a[168:175],v2
v_smfmac_f32_16x16x64_bf16 v[112:115],v[28:31],v[144:151],v2
s_cbranch_vccnz L_cpb_249
L_cback_251:
s_waitcnt lgkmcnt(0)
s_barrier
v_smfmac_f32_16x16x64_bf16 v[96:99],v[36:39],a[48:55],v2
buffer_store_dwordx4 v[124:127],v0,s[8:11],s54 offen sc1
v_smfmac_f32_16x16x64_bf16 v[100:103],v[36:39],a[176:183],v2
ds_read_b128 v[44:47],v120 offset:4096
v_smfmac_f32_16x16x64_bf16 v[104:107],v[36:39],a[56:63],v2
buffer_load_dwordx4 v0,s[8:11],s67 offen sc1 lds
v_smfmac_f32_16x16x64_bf16 v[108:111],v[36:39],a[184:191],v2
ds_read_b128 v[48:51],v121 offset:4096
v_smfmac_f32_16x16x64_bf16 v[96:99],v[40:43],a[64:71],v2
buffer_load_dwordx4 v0,s[8:11],s67 offen offset:1024 sc1 lds
s_add_u32 m0,s73,139264
v_smfmac_f32_16x16x64_bf16 v[100:103],v[40:43],a[192:199],v2
ds_read_b128 v[52:55],v122 offset:4096
v_smfmac_f32_16x16x64_bf16 v[104:107],v[40:43],a[72:79],v2
buffer_load_dwordx4 v0,s[8:11],s57 offen sc1 lds
s_add_u32 s67,s67,786432
v_smfmac_f32_16x16x64_bf16 v[108:111],v[40:43],a[200:207],v2
s_waitcnt lgkmcnt(2)
v_smfmac_f32_16x16x64_bf16 v[96:99],v[44:47],a[80:87],v2
buffer_load_dwordx4 v0,s[8:11],s57 offen offset:1024 sc1 lds
v_smfmac_f32_16x16x64_bf16 v[100:103],v[44:47],a[208:215],v2
s_waitcnt lgkmcnt(1)
v_smfmac_f32_16x16x64_bf16 v[96:99],v[48:51],a[96:103],v2
buffer_load_dword v23,v22,s[8:11],s75 offen sc1
v_smfmac_f32_16x16x64_bf16 v[100:103],v[48:51],a[224:231],v2
s_waitcnt lgkmcnt(0)
v_smfmac_f32_16x16x64_bf16 v[96:99],v[52:55],a[112:119],v2
v_smfmac_f32_16x16x64_bf16 v[100:103],v[52:55],a[240:247],v2
v_smfmac_f32_16x16x64_bf16 v[104:107],v[44:47],a[88:95],v2
v_smfmac_f32_16x16x64_bf16 v[108:111],v[44:47],a[216:223],v2
v_smfmac_f32_16x16x64_bf16 v[104:107],v[48:51],a[104:111],v2
v_add_f32 v96,v96,v98
v_smfmac_f32_16x16x64_bf16 v[108:111],v[48:51],a[232:239],v2
v_add_f32 v97,v97,v99
v_smfmac_f32_16x16x64_bf16 v[104:107],v[52:55],a[120:127],v2
v_cvt_pk_bf16_f32 v120,v96,v97
v_smfmac_f32_16x16x64_bf16 v[108:111],v[52:55],a[248:255],v2
v_add_f32 v100,v100,v102
v_smfmac_f32_16x16x64_bf16 v[116:119],v[28:31],v[152:159],v2
v_add_f32 v101,v101,v103
v_smfmac_f32_16x16x64_bf16 v[112:115],v[32:35],v[160:167],v2
v_cvt_pk_bf16_f32 v121,v100,v101
v_add_f32 v104,v104,v106
v_add_f32 v105,v105,v107
v_cvt_pk_bf16_f32 v122,v104,v105
v_add_f32 v108,v108,v110
v_add_f32 v109,v109,v111
v_cvt_pk_bf16_f32 v123,v108,v109
ds_write_b128 v4,v[120:123]
v_smfmac_f32_16x16x64_bf16 v[116:119],v[32:35],v[168:175],v2
s_mov_b32 s54,s68
s_add_u32 s68,s68,131072
v_mov_b32 v125,0
v_smfmac_f32_16x16x64_bf16 v[112:115],v[36:39],v[176:183],v2
s_cmp_eq_u32 s51,63
s_cbranch_scc1 L_cend_245
v_smfmac_f32_16x16x64_bf16 v[116:119],v[36:39],v[184:191],v2
v_smfmac_f32_16x16x64_bf16 v[112:115],v[40:43],v[192:199],v2
s_waitcnt lgkmcnt(0)
s_barrier
ds_read_b64_tr_b16 v[96:97],v5 offset:0
ds_read_b64_tr_b16 v[98:99],v6 offset:0
v_smfmac_f32_16x16x64_bf16 v[116:119],v[40:43],v[200:207],v2
ds_read_b64_tr_b16 v[100:101],v5 offset:1024
v_smfmac_f32_16x16x64_bf16 v[112:115],v[44:47],v[208:215],v2
ds_read_b64_tr_b16 v[102:103],v6 offset:1024
v_smfmac_f32_16x16x64_bf16 v[116:119],v[44:47],v[216:223],v2
ds_read_b64_tr_b16 v[104:105],v5 offset:2048
v_smfmac_f32_16x16x64_bf16 v[112:115],v[48:51],v[224:231],v2
ds_read_b64_tr_b16 v[106:107],v6 offset:2048
s_waitcnt lgkmcnt(4)
v_mfma_f32_16x16x32_bf16 v[24:27],v[56:59],v[96:99],0
ds_read_b64_tr_b16 v[108:109],v5 offset:3072
v_mfma_f32_16x16x32_bf16 v[28:31],v[60:63],v[96:99],0
ds_read_b64_tr_b16 v[110:111],v6 offset:3072
v_mfma_f32_16x16x32_bf16 v[32:35],v[96:99],v[96:99],0
ds_read_b128 v[40:43],v11 offset:12288
s_waitcnt lgkmcnt(5)
v_mfma_f32_16x16x32_bf16 v[24:27],v[64:67],v[100:103],v[24:27]
ds_read_b128 v[56:59],v11 offset:0
v_mfma_f32_16x16x32_bf16 v[28:31],v[68:71],v[100:103],v[28:31]
ds_read_b128 v[60:63],v11 offset:1024
v_mfma_f32_16x16x32_bf16 v[32:35],v[100:103],v[100:103],v[32:35]
ds_read_b128 v[96:99],v11 offset:8192
s_waitcnt lgkmcnt(6)
v_mfma_f32_16x16x32_bf16 v[24:27],v[72:75],v[104:107],v[24:27]
ds_read_b128 v[64:67],v11 offset:2048
v_mfma_f32_16x16x32_bf16 v[28:31],v[76:79],v[104:107],v[28:31]
ds_read_b128 v[68:71],v11 offset:3072
v_mfma_f32_16x16x32_bf16 v[32:35],v[104:107],v[104:107],v[32:35]
ds_read_b128 v[100:103],v11 offset:9216
s_waitcnt lgkmcnt(7)
v_mfma_f32_16x16x32_bf16 v[24:27],v[80:83],v[108:111],v[24:27]
ds_read_b128 v[72:75],v11 offset:4096
v_mfma_f32_16x16x32_bf16 v[28:31],v[84:87],v[108:111],v[28:31]
ds_read_b128 v[76:79],v11 offset:5120
v_mfma_f32_16x16x32_bf16 v[32:35],v[108:111],v[108:111],v[32:35]
ds_read_b128 v[104:107],v11 offset:10240
v_smfmac_f32_16x16x64_bf16 v[116:119],v[48:51],v[232:239],v2
ds_read_b128 v[80:83],v11 offset:6144
v_smfmac_f32_16x16x64_bf16 v[112:115],v[52:55],v[240:247],v2
ds_read_b128 v[84:87],v11 offset:7168
v_smfmac_f32_16x16x64_bf16 v[116:119],v[52:55],v[248:255],v2
ds_read_b128 v[108:111],v11 offset:11264
v_max3_f32 v126,v24,v25,v26
v_max3_f32 v127,v27,v28,v29
v_max3_f32 v126,v30,v31,v126
v_max3_f32 v127,v34,v35,v127
v_max_f32 v126,v126,v127
v_max_f32 v127,v126,v127
v_pk_mul_f32 v[34:35],v[34:35],v[0:1] op_sel:[0,1]
v_pk_mul_f32 v[24:25],v[24:25],v[0:1] op_sel:[0,1]
v_permlane16_swap_b32 v126,v127
v_max_f32 v126,v126,v127
v_max_f32 v127,v126,v127
v_pk_mul_f32 v[26:27],v[26:27],v[0:1] op_sel:[0,1]
v_pk_mul_f32 v[28:29],v[28:29],v[0:1] op_sel:[0,1]
v_permlane32_swap_b32 v126,v127
v_max_f32 v126,v126,v127
v_mul_f32 v126,v1,v126
v_pk_mul_f32 v[30:31],v[30:31],v[0:1] op_sel:[0,1]
v_pk_add_f32 v[34:35],v[34:35],v[126:127] op_sel_hi:[1,0] neg_lo:[0,1] neg_hi:[0,1]
v_pk_add_f32 v[112:113],v[112:113],v[114:115]
v_pk_add_f32 v[116:117],v[116:117],v[118:119]
v_pk_add_f32 v[24:25],v[24:25],v[126:127] op_sel_hi:[1,0] neg_lo:[0,1] neg_hi:[0,1]
v_pk_add_f32 v[26:27],v[26:27],v[126:127] op_sel_hi:[1,0] neg_lo:[0,1] neg_hi:[0,1]
v_pk_add_f32 v[28:29],v[28:29],v[126:127] op_sel_hi:[1,0] neg_lo:[0,1] neg_hi:[0,1]
v_pk_add_f32 v[30:31],v[30:31],v[126:127] op_sel_hi:[1,0] neg_lo:[0,1] neg_hi:[0,1]
v_exp_f32 v34,v34
v_exp_f32 v35,v35
v_cvt_pk_bf16_f32 v126,v112,v113
v_cvt_pk_bf16_f32 v124,v34,v35
v_cvt_pk_bf16_f32 v127,v116,v117
v_cvt_pk_bf16_f32 v36,v116,v117
v_mfma_f32_16x16x16_bf16 v[32:35],v[14:15],v[124:125],0
ds_read_b128 v[44:47],v11 offset:13312
v_exp_f32 v24,v24
v_mfma_f32_16x16x16_bf16 v[112:115],v[126:127],v[124:125],0
ds_read_b128 v[48:51],v11 offset:14336
v_exp_f32 v25,v25
v_mfma_f32_16x16x16_bf16 v[116:119],v[36:37],v[124:125],0
ds_read_b128 v[52:55],v11 offset:15360
v_exp_f32 v26,v26
v_exp_f32 v27,v27
v_cvt_pk_bf16_f32 v120,v24,v25
v_exp_f32 v28,v28
v_exp_f32 v29,v29
v_cvt_pk_bf16_f32 v121,v26,v27
v_exp_f32 v30,v30
v_exp_f32 v31,v31
v_cvt_pk_bf16_f32 v122,v28,v29
v_cvt_pk_bf16_f32 v123,v30,v31
s_add_u32 s75,s75,8192
s_add_u32 s51,s51,1
v_mfma_f32_16x16x32_bf16 v[32:35],v[14:17],v[120:123],v[32:35]
v_mfma_f32_16x16x32_bf16 v[112:115],v[88:91],v[120:123],v[112:115]
ds_read_b128 v[88:91],v11 offset:16384
v_mfma_f32_16x16x32_bf16 v[116:119],v[92:95],v[120:123],v[116:119]
ds_read_b128 v[92:95],v11 offset:17408
v_rcp_f32 v32,v32
v_mov_b64 v[24:25],-1
v_mov_b64 v[26:27],-1
s_add_u32 s64,s75,11534336
s_add_u32 s70,s64,4096
v_pk_mul_f32 v[112:113],v[112:113],v[32:33] op_sel_hi:[1,0]
v_pk_mul_f32 v[114:115],v[114:115],v[32:33] op_sel_hi:[1,0]
v_pk_mul_f32 v[116:117],v[116:117],v[32:33] op_sel_hi:[1,0]
v_pk_mul_f32 v[118:119],v[118:119],v[32:33] op_sel_hi:[1,0]
v_cvt_pk_bf16_f32 v120,v112,v116
v_cvt_pk_bf16_f32 v121,v113,v117
v_cvt_pk_bf16_f32 v122,v114,v118
v_cvt_pk_bf16_f32 v123,v115,v119
ds_write_b128 v7,v[120:123]
buffer_store_dwordx4 v[24:27],v0,s[8:11],s69 offen sc1
buffer_store_dwordx4 v[24:27],v0,s[8:11],s69 offen offset:1024 sc1
v_mov_b64 v[112:113],0
v_mov_b64 v[114:115],0
v_mov_b64 v[116:117],0
v_mov_b64 v[118:119],0
s_waitcnt lgkmcnt(0)
s_barrier
ds_read_b128 v[24:27],v8 offset:0
ds_read_b128 v[28:31],v8 offset:512
ds_read_b128 v[32:35],v8 offset:1024
ds_read_b128 v[36:39],v8 offset:1536
v_mov_b64 v[120:121],0
v_mov_b64 v[122:123],0
s_add_u32 s57,s65,65536
s_add_u32 s58,s65,131072
s_add_u32 s59,s65,196608
s_add_u32 s56,s18,s75
s_waitcnt lgkmcnt(3)
v_smfmac_f32_16x16x64_bf16 v[112:115],v[24:27],v[56:63],v3
ds_read_b128 v[56:59],v11 offset:18432
s_waitcnt lgkmcnt(3)
v_smfmac_f32_16x16x64_bf16 v[112:115],v[28:31],v[64:71],v3
ds_read_b128 v[60:63],v11 offset:19456
s_waitcnt lgkmcnt(3)
v_smfmac_f32_16x16x64_bf16 v[112:115],v[32:35],v[72:79],v3
ds_read_b128 v[64:67],v11 offset:20480
s_waitcnt lgkmcnt(3)
v_smfmac_f32_16x16x64_bf16 v[112:115],v[36:39],v[80:87],v3
ds_read_b128 v[68:71],v11 offset:21504
v_smfmac_f32_16x16x64_bf16 v[116:119],v[24:27],v[96:103],v3
ds_read_b128 v[72:75],v11 offset:22528
v_smfmac_f32_16x16x64_bf16 v[116:119],v[28:31],v[104:111],v3
ds_read_b128 v[76:79],v11 offset:23552
v_cvt_pk_bf16_f32 v112,v112,v113
v_smfmac_f32_16x16x64_bf16 v[116:119],v[32:35],v[40:47],v3
ds_read_b128 v[80:83],v11 offset:24576
v_cvt_pk_bf16_f32 v113,v114,v115
buffer_store_dwordx2 v[112:113],v9,s[8:11],s65 offen sc1
v_smfmac_f32_16x16x64_bf16 v[116:119],v[36:39],v[48:55],v3
ds_read_b128 v[84:87],v11 offset:25600
v_mov_b64 v[112:113],0
v_smfmac_f32_16x16x64_bf16 v[120:123],v[24:27],v[88:95],v3
ds_read_b128 v[96:99],v11 offset:26624
ds_read_b128 v[100:103],v11 offset:27648
v_mov_b64 v[114:115],0
s_waitcnt lgkmcnt(8)
v_smfmac_f32_16x16x64_bf16 v[120:123],v[28:31],v[56:63],v3
ds_read_b128 v[104:107],v11 offset:28672
v_cvt_pk_bf16_f32 v116,v116,v117
s_waitcnt lgkmcnt(7)
v_smfmac_f32_16x16x64_bf16 v[120:123],v[32:35],v[64:71],v3
ds_read_b128 v[108:111],v11 offset:29696
ds_read_b128 v[40:43],v11 offset:30720
v_cvt_pk_bf16_f32 v117,v118,v119
buffer_store_dwordx2 v[116:117],v9,s[8:11],s57 offen sc1
s_waitcnt lgkmcnt(7)
v_smfmac_f32_16x16x64_bf16 v[120:123],v[36:39],v[72:79],v3
ds_read_b128 v[44:47],v11 offset:31744
v_add_u32 v52,s50,v5
s_waitcnt lgkmcnt(6)
v_smfmac_f32_16x16x64_bf16 v[112:115],v[24:27],v[80:87],v3
v_add_u32 v54,s50,v6
s_waitcnt lgkmcnt(4)
v_smfmac_f32_16x16x64_bf16 v[112:115],v[28:31],v[96:103],v3
ds_read_b64_tr_b16 v[52:53],v52
v_cvt_pk_bf16_f32 v120,v120,v121
s_waitcnt lgkmcnt(3)
v_smfmac_f32_16x16x64_bf16 v[112:115],v[32:35],v[104:111],v3
ds_read_b64_tr_b16 v[54:55],v54
v_cvt_pk_bf16_f32 v121,v122,v123
buffer_store_dwordx2 v[120:121],v9,s[8:11],s58 offen sc1
s_waitcnt lgkmcnt(2)
v_smfmac_f32_16x16x64_bf16 v[112:115],v[36:39],v[40:47],v3
v_mov_b64 v[116:117],0
v_mov_b64 v[118:119],0
s_xor_b32 s65,s65,262144
v_mov_b32_dpp v124,v126 quad_perm:[2,3,2,3] row_mask:0xf bank_mask:0xf
v_mov_b32_dpp v125,v127 quad_perm:[2,3,2,3] row_mask:0xf bank_mask:0xf
s_mov_b32 vcc_lo,0xcccccccc
s_mov_b32 vcc_hi,0xcccccccc
s_nop 0
v_cvt_pk_bf16_f32 v112,v112,v113
v_cvt_pk_bf16_f32 v113,v114,v115
buffer_store_dwordx2 v[112:113],v9,s[8:11],s59 offen sc1
s_waitcnt lgkmcnt(0)
s_buffer_load_dword s19,s[8:11],s56
v_cndmask_b32 v124,v124,v52,vcc
v_cndmask_b32 v125,v125,v53,vcc
v_cndmask_b32 v126,v126,v54,vcc
v_cndmask_b32 v127,v127,v55,vcc
s_cmp_lt_u32 s46,2
s_waitcnt vmcnt(3)
s_cbranch_scc1 L_crg_252
s_cmp_eq_u32 s46,2
s_waitcnt vmcnt(1)
s_cbranch_scc1 L_crg_252
s_waitcnt vmcnt(0)
L_crg_252:
buffer_load_dwordx4 v[32:35],v0,s[8:11],s66 offen offset:0 sc1
buffer_load_dwordx4 v[36:39],v0,s[8:11],s66 offen offset:1024 sc1
v_mov_b64 v[96:97],0
v_mov_b64 v[98:99],0
v_mov_b64 v[100:101],0
v_mov_b64 v[102:103],0
v_mov_b64 v[104:105],0
v_mov_b64 v[106:107],0
v_mov_b64 v[108:109],0
v_mov_b64 v[110:111],0
v_mov_b64 v[112:113],0
v_mov_b64 v[114:115],0
v_add_u32 v55,131072,v0
v_add_u32 v123,s73,v55
v_xor_b32 v120,1024,v12
v_xor_b32 v121,2048,v12
v_xor_b32 v122,3072,v12
buffer_load_dwordx4 v[44:47],v0,s[8:11],s66 offen offset:0 sc1
buffer_load_dwordx4 v[48:51],v0,s[8:11],s66 offen offset:1024 sc1
s_cmp_ge_u32 s51,63
s_cselect_b32 s76,0,1
s_cmp_eq_u32 s46,0
s_cselect_b32 s76,s76,0
s_waitcnt vmcnt(3)
v_mfma_f32_16x16x32_bf16 v[28:31],v[18:21],v[32:35],0
s_waitcnt vmcnt(2)
v_mfma_f32_16x16x32_bf16 v[28:31],v[18:21],v[36:39],v[28:31]
s_nop 7
v_cmp_u_f32 vcc,v28,v28
v_add_f32_dpp v52,v28,v28 row_ror:8 row_mask:0xf bank_mask:0x3
v_add_f32_dpp v53,v29,v29 row_ror:8 row_mask:0xf bank_mask:0x3
v_add_f32_dpp v52,v30,v30 row_ror:8 row_mask:0xf bank_mask:0xc
v_add_f32_dpp v53,v31,v31 row_ror:8 row_mask:0xf bank_mask:0xc
s_nop 0
v_add_f32_dpp v52,v52,v52 row_shl:4 row_mask:0xf bank_mask:0x5
v_add_f32_dpp v53,v53,v53 row_shl:4 row_mask:0xf bank_mask:0x5
s_cbranch_vccnz L_crp_247
L_cok_253:
v_cvt_pk_bf16_f32 v54,v52,v53
buffer_store_dword v54,v10,s[8:11],s64 offen sc1
s_mov_b32 s69,s66
s_xor_b32 s66,s66,262144
s_barrier
ds_read_b128 v[56:59],v55 offset:0
ds_read_b128 v[60:63],v55 offset:4096
ds_read_b128 v[64:67],v55 offset:1024
buffer_load_dwordx4 v[24:27],v13,s[8:11],s64 offen sc1
ds_read_b128 v[68:71],v55 offset:5120
ds_read_b128 v[72:75],v55 offset:2048
ds_read_b128 v[76:79],v55 offset:6144
ds_read_b128 v[80:83],v55 offset:3072
buffer_load_dwordx4 v[24:27],v13,s[8:11],s64 offen sc1
ds_read_b128 v[84:87],v55 offset:7168
ds_read_b128 v[88:91],v123 offset:8192
ds_read_b128 v[92:95],v123 offset:9216
s_branch L_chain_242
L_cpb_249:
buffer_load_dwordx4 v[40:43],v13,s[8:11],s70 offen sc1
s_sub_u32 s49,s49,1
s_cbranch_scc1 L_abort2
s_waitcnt vmcnt(0)
v_max3_u32 v123,v40,v41,v42
v_max_u32 v123,v43,v123
v_cmp_le_u32 vcc,s72,v123
s_cbranch_vccnz L_cpb_249
ds_write_b128 v12,v[40:43] offset:4096
s_branch L_cback_251
L_crp_247:
buffer_load_dwordx4 v[32:35],v0,s[8:11],s66 offen offset:0 sc1
buffer_load_dwordx4 v[36:39],v0,s[8:11],s66 offen offset:1024 sc1
s_sub_u32 s49,s49,1
s_cbranch_scc1 L_abort2
s_waitcnt vmcnt(3)
v_mfma_f32_16x16x32_bf16 v[28:31],v[18:21],v[44:47],0
s_waitcnt vmcnt(2)
v_mfma_f32_16x16x32_bf16 v[28:31],v[18:21],v[48:51],v[28:31]
s_nop 7
v_cmp_u_f32 vcc,v28,v28
v_add_f32_dpp v52,v28,v28 row_ror:8 row_mask:0xf bank_mask:0x3
v_add_f32_dpp v53,v29,v29 row_ror:8 row_mask:0xf bank_mask:0x3
v_add_f32_dpp v52,v30,v30 row_ror:8 row_mask:0xf bank_mask:0xc
v_add_f32_dpp v53,v31,v31 row_ror:8 row_mask:0xf bank_mask:0xc
s_nop 0
v_add_f32_dpp v52,v52,v52 row_shl:4 row_mask:0xf bank_mask:0x5
v_add_f32_dpp v53,v53,v53 row_shl:4 row_mask:0xf bank_mask:0x5
s_cbranch_vccz L_cok_253
buffer_load_dwordx4 v[44:47],v0,s[8:11],s66 offen offset:0 sc1
buffer_load_dwordx4 v[48:51],v0,s[8:11],s66 offen offset:1024 sc1
s_sub_u32 s49,s49,1
s_cbranch_scc1 L_abort2
s_waitcnt vmcnt(3)
v_mfma_f32_16x16x32_bf16 v[28:31],v[18:21],v[32:35],0
s_waitcnt vmcnt(2)
v_mfma_f32_16x16x32_bf16 v[28:31],v[18:21],v[36:39],v[28:31]
s_nop 7
v_cmp_u_f32 vcc,v28,v28
v_add_f32_dpp v52,v28,v28 row_ror:8 row_mask:0xf bank_mask:0x3
v_add_f32_dpp v53,v29,v29 row_ror:8 row_mask:0xf bank_mask:0x3
v_add_f32_dpp v52,v30,v30 row_ror:8 row_mask:0xf bank_mask:0xc
v_add_f32_dpp v53,v31,v31 row_ror:8 row_mask:0xf bank_mask:0xc
s_nop 0
v_add_f32_dpp v52,v52,v52 row_shl:4 row_mask:0xf bank_mask:0x5
v_add_f32_dpp v53,v53,v53 row_shl:4 row_mask:0xf bank_mask:0x5
s_cbranch_vccz L_cok_253
s_branch L_crp_247
L_ckw_235:
s_add_u32 s59,s18,s75
L_ww_254:
s_sleep 1
buffer_load_dword v23,off,s[8:11],s59 sc1
s_sub_u32 s49,s49,1
s_cbranch_scc1 L_abort2
s_waitcnt vmcnt(0)
v_readfirstlane_b32 s76,v23
s_cmp_eq_u32 s76,0
s_cbranch_scc1 L_ww_254
L_wwd_255:
s_branch L_ckb_236
L_cend_245:
v_smfmac_f32_16x16x64_bf16 v[116:119],v[36:39],v[184:191],v2
v_smfmac_f32_16x16x64_bf16 v[112:115],v[40:43],v[192:199],v2
v_smfmac_f32_16x16x64_bf16 v[116:119],v[40:43],v[200:207],v2
v_smfmac_f32_16x16x64_bf16 v[112:115],v[44:47],v[208:215],v2
v_smfmac_f32_16x16x64_bf16 v[116:119],v[44:47],v[216:223],v2
v_smfmac_f32_16x16x64_bf16 v[112:115],v[48:51],v[224:231],v2
v_smfmac_f32_16x16x64_bf16 v[116:119],v[48:51],v[232:239],v2
v_smfmac_f32_16x16x64_bf16 v[112:115],v[52:55],v[240:247],v2
v_smfmac_f32_16x16x64_bf16 v[116:119],v[52:55],v[248:255],v2
s_waitcnt lgkmcnt(0)
s_nop 2
v_pk_add_f32 v[112:113],v[112:113],v[114:115]
s_nop 2
v_pk_add_f32 v[116:117],v[116:117],v[118:119]
v_cvt_pk_bf16_f32 v126,v112,v113
v_cvt_pk_bf16_f32 v127,v116,v117
v_add_u32 v52,s50,v5
v_add_u32 v54,s50,v6
ds_read_b64_tr_b16 v[52:53],v52
ds_read_b64_tr_b16 v[54:55],v54
v_mov_b32_dpp v124,v126 quad_perm:[2,3,2,3] row_mask:0xf bank_mask:0xf
v_mov_b32_dpp v125,v127 quad_perm:[2,3,2,3] row_mask:0xf bank_mask:0xf
s_mov_b32 vcc_lo,0xcccccccc
s_mov_b32 vcc_hi,0xcccccccc
s_waitcnt lgkmcnt(0)
v_cndmask_b32 v124,v124,v52,vcc
v_cndmask_b32 v125,v125,v53,vcc
v_cndmask_b32 v126,v126,v54,vcc
v_cndmask_b32 v127,v127,v55,vcc
buffer_store_dwordx4 v[124:127],v0,s[8:11],s54 offen sc1
s_mov_b32 s51,64
s_waitcnt vmcnt(0)
s_barrier
s_nop 11
v_lshrrev_b32 v1,4,v0
s_mov_b32 s53,0
s_branch L_rb_7
L_rc1_229:
v_and_b32 v120,15,v1
v_lshrrev_b32 v121,4,v1
v_and_b32 v122,2,v1
v_cmp_eq_u32 vcc,0,v122
v_mov_b32 v2,0xeeee
v_mov_b32 v123,0x4444
v_cndmask_b32 v2,v2,v123,vcc
v_and_b32 v122,1,v1
v_cmp_eq_u32 vcc,0,v122
v_mov_b32 v3,0xdddd
v_mov_b32 v123,0x8888
v_cndmask_b32 v3,v3,v123,vcc
v_lshrrev_b32 v122,1,v120
v_bfe_u32 v123,v120,2,1
v_xor_b32 v123,v123,v122
v_lshlrev_b32 v4,7,v123
v_and_b32 v123,1,v120
v_lshl_add_u32 v4,v123,6,v4
v_xor_b32 v123,v121,v122
v_and_b32 v123,3,v123
v_lshl_add_u32 v4,v123,4,v4
s_lshl_b32 s56,s46,10
s_add_u32 s56,s56,147456
v_add_u32 v4,s56,v4
v_lshlrev_b32 v122,1,v121
v_add_u32 v122,0,v122
v_and_b32 v123,1,v121
v_xor_b32 v123,v123,v122
v_lshlrev_b32 v5,7,v123
v_bfe_u32 v123,v120,3,1
v_lshl_add_u32 v5,v123,6,v5
v_xor_b32 v123,v120,v122
v_and_b32 v123,3,v123
v_lshl_add_u32 v5,v123,4,v5
v_bfe_u32 v123,v120,2,1
v_lshl_add_u32 v5,v123,3,v5
v_add_u32 v5,147456,v5
v_lshlrev_b32 v122,1,v121
v_add_u32 v122,1,v122
v_and_b32 v123,1,v121
v_xor_b32 v123,v123,v122
v_lshlrev_b32 v6,7,v123
v_bfe_u32 v123,v120,3,1
v_lshl_add_u32 v6,v123,6,v6
v_xor_b32 v123,v120,v122
v_and_b32 v123,3,v123
v_lshl_add_u32 v6,v123,4,v6
v_bfe_u32 v123,v120,2,1
v_lshl_add_u32 v6,v123,3,v6
v_add_u32 v6,147456,v6
v_lshlrev_b32 v7,7,v121
v_lshrrev_b32 v122,1,v120
v_lshl_add_u32 v8,v122,4,v7
v_add_u32 v8,151552,v8
v_lshrrev_b32 v122,2,v120
v_lshl_add_u32 v7,v122,5,v7
v_and_b32 v122,1,v120
v_lshl_add_u32 v7,v122,4,v7
v_and_b32 v122,2,v120
v_cmp_eq_u32 vcc,0,v122
s_lshl_b32 s56,s46,9
v_mov_b32 v122,2048
v_mov_b32 v123,s56
v_cndmask_b32 v122,v122,v123,vcc
v_add_u32 v7,v122,v7
v_add_u32 v7,151552,v7
v_lshrrev_b32 v122,3,v1
v_lshlrev_b32 v9,11,v122
v_and_b32 v122,7,v1
v_lshl_add_u32 v9,v122,3,v9
s_lshl_b32 s56,s46,14
s_lshl_b32 s57,s47,6
s_add_u32 s56,s56,s57
v_add_u32 v9,s56,v9
s_lshl_b32 s71,s46,5
s_add_u32 s71,s71,s47
s_bfe_u32 s56,s71,0x10003
s_lshl_b32 s56,s56,11
s_and_b32 s57,s71,1
s_lshl_b32 s57,s57,10
s_add_u32 s56,s56,s57
s_bfe_u32 s57,s71,0x10002
s_lshl_b32 s57,s57,9
s_add_u32 s56,s56,s57
s_bfe_u32 s57,s71,0x10001
s_lshl_b32 s57,s57,6
s_add_u32 s56,s56,s57
s_bfe_u32 s57,s71,0x10004
s_lshl_b32 s57,s57,8
s_add_u32 s56,s56,s57
s_bfe_u32 s57,s71,0x10005
s_lshl_b32 s57,s57,7
s_add_u32 s56,s56,s57
s_bfe_u32 s57,s71,0x10006
s_lshl_b32 s57,s57,12
s_add_u32 s56,s56,s57
v_and_b32 v122,3,v120
v_lshlrev_b32 v10,2,v122
v_bfe_u32 v122,v120,3,1
v_lshl_add_u32 v10,v122,4,v10
v_and_b32 v122,1,v121
v_lshl_add_u32 v10,v122,5,v10
v_add_u32 v10,s56,v10
v_and_b32 v123,36,v1
v_mov_b32 v122,0x80000000
v_cmp_eq_u32 vcc,0,v123
s_nop 1
v_cndmask_b32 v10,v122,v10,vcc
s_lshl_b32 s71,s71,11
s_lshl_b32 s73,s46,11
s_mov_b32 s72,0xffc00000
s_mov_b32 s74,0
v_and_b32 v11,1,v121
v_xor_b32 v11,v11,v120
v_and_b32 v11,3,v11
v_lshrrev_b32 v122,2,v120
v_lshl_add_u32 v11,v11,2,v122
v_lshl_add_u32 v11,v121,4,v11
v_lshlrev_b32 v11,4,v11
s_lshl_b32 s56,s46,15
v_add_u32 v11,s56,v11
v_lshrrev_b32 v13,3,v1
v_lshlrev_b32 v13,9,v13
v_and_b32 v122,7,v1
v_lshl_add_u32 v13,v122,4,v13
v_and_b32 v122,15,v1
v_and_b32 v123,1,v1
v_lshlrev_b32 v123,4,v123
v_mov_b32 v124,0x3f80
v_lshlrev_b32 v124,v123,v124
v_lshrrev_b32 v122,1,v122
v_cmp_eq_u32 vcc,0,v122
s_nop 1
v_cndmask_b32 v18,0,v124,vcc
v_cmp_eq_u32 vcc,1,v122
s_nop 1
v_cndmask_b32 v19,0,v124,vcc
v_cmp_eq_u32 vcc,2,v122
s_nop 1
v_cndmask_b32 v20,0,v124,vcc
v_cmp_eq_u32 vcc,3,v122
s_nop 1
v_cndmask_b32 v21,0,v124,vcc
s_and_b32 s56,s46,1
s_lshl_b32 s56,s56,8
s_and_b32 s57,s46,2
s_lshl_b32 s57,s57,6
s_add_u32 s56,s56,s57
v_add_u32 v13,s56,v13
s_add_u32 s56,s50,155648
v_add_u32 v12,s56,v0
v_mov_b64 v[14:15],s[28:29]
v_mov_b64 v[16:17],s[28:29]
v_add_u32 v22,12599296,v10
s_lshl_b32 s18,s47,2
s_add_u32 s18,s18,10494080
v_mov_b32 v1,s80
s_mov_b32 s65,15728640
s_add_u32 s66,s71,15728640
s_add_u32 s69,s71,15990784
s_mov_b32 s30,0x40000000
s_mov_b32 s51,0
L_cst_259:
s_cmp_lg_u32 s46,0
s_cbranch_scc1 L_csw_264
s_lshl_b32 s59,s51,13
s_lshl2_add_u32 s59,s47,s59
s_add_u32 s59,s59,10485888
L_ww_265:
s_sleep 1
buffer_load_dword v122,off,s[8:11],s59 sc1
s_sub_u32 s49,s49,1
s_cbranch_scc1 L_abort2
s_waitcnt vmcnt(0)
v_readfirstlane_b32 s61,v122
s_cmp_eq_u32 s61,0
s_cbranch_scc1 L_ww_265
L_wwd_266:
L_csw_264:
s_waitcnt lgkmcnt(0)
s_barrier
s_lshl_b32 s56,s51,5
s_add_u32 s56,s56,s47
s_mul_i32 s56,s56,24576
s_add_u32 s56,s56,150994944
s_add_u32 s67,s56,s73
s_add_u32 m0,s73,131072
s_add_u32 s57,s67,8192
buffer_load_dwordx4 v0,s[8:11],s67 offen sc1 lds
buffer_load_dwordx4 v0,s[8:11],s67 offen offset:1024 sc1 lds
s_add_u32 m0,s73,139264
s_add_u32 s67,s67,786432
buffer_load_dwordx4 v0,s[8:11],s57 offen sc1 lds
buffer_load_dwordx4 v0,s[8:11],s57 offen offset:1024 sc1 lds
s_lshl_b32 s75,s51,13
s_add_u32 s56,s75,12591104
buffer_load_dword v23,v10,s[8:11],s56 offen sc1
s_add_u32 s64,s75,12582912
s_add_u32 s70,s64,4096
s_lshl_b32 s68,s51,5
s_add_u32 s68,s68,s47
s_lshl_b32 s68,s68,12
s_lshl_b32 s56,s46,10
s_add_u32 s68,s68,s56
s_add_u32 s68,s68,58720256
s_mov_b32 s54,0x80000000
s_mov_b32 s77,0
s_mov_b32 s19,0
s_cmp_eq_u32 s51,63
s_cselect_b32 s76,1,s46
s_cmp_eq_u32 s76,0
s_cselect_b32 s76,1,0
v_mov_b64 v[96:97],0
v_mov_b64 v[98:99],0
v_mov_b64 v[100:101],0
v_mov_b64 v[102:103],0
v_mov_b64 v[104:105],0
v_mov_b64 v[106:107],0
v_mov_b64 v[108:109],0
v_mov_b64 v[110:111],0
v_mov_b64 v[112:113],0
v_mov_b64 v[114:115],0
v_mov_b64 v[116:117],0
v_mov_b64 v[118:119],0
s_waitcnt vmcnt(0) lgkmcnt(0)
s_barrier
v_add_u32 v55,131072,v0
ds_read_b128 v[56:59],v55 offset:0
ds_read_b128 v[60:63],v55 offset:4096
ds_read_b128 v[64:67],v55 offset:1024
ds_read_b128 v[68:71],v55 offset:5120
ds_read_b128 v[72:75],v55 offset:2048
ds_read_b128 v[76:79],v55 offset:6144
ds_read_b128 v[80:83],v55 offset:3072
ds_read_b128 v[84:87],v55 offset:7168
v_add_u32 v123,s73,v55
ds_read_b128 v[88:91],v123 offset:8192
ds_read_b128 v[92:95],v123 offset:9216
v_xor_b32 v120,1024,v12
v_xor_b32 v121,2048,v12
v_xor_b32 v122,3072,v12
buffer_load_dwordx4 v[24:27],v13,s[8:11],s64 offen sc1
buffer_load_dwordx4 v[24:27],v13,s[8:11],s64 offen sc1
L_chain_267:
L_cpa_268:
buffer_load_dwordx4 v[24:27],v13,s[8:11],s64 offen sc1
s_sub_u32 s49,s49,1
s_cbranch_scc1 L_abort2
s_waitcnt vmcnt(2)
v_max3_u32 v123,v24,v25,v26
v_max_u32 v123,v27,v123
v_cmp_le_u32 vcc,s72,v123
ds_write_b128 v12,v[24:27] offset:0
s_cbranch_vccnz L_cpa_268
L_cgo_271:
v_smfmac_f32_16x16x64_bf16 v[96:99],v[24:27],a[0:7],v2
buffer_load_dwordx4 v[40:43],v13,s[8:11],s70 offen sc1
v_smfmac_f32_16x16x64_bf16 v[100:103],v[24:27],a[128:135],v2
s_waitcnt lgkmcnt(0)
s_barrier
ds_read_b128 v[28:31],v120 offset:0
v_smfmac_f32_16x16x64_bf16 v[104:107],v[24:27],a[8:15],v2
ds_read_b128 v[32:35],v121 offset:0
v_smfmac_f32_16x16x64_bf16 v[108:111],v[24:27],a[136:143],v2
ds_read_b128 v[36:39],v122 offset:0
v_smfmac_f32_16x16x64_bf16 v[112:115],v[24:27],v[128:135],v2
v_smfmac_f32_16x16x64_bf16 v[116:119],v[24:27],v[136:143],v2
s_waitcnt lgkmcnt(2)
v_smfmac_f32_16x16x64_bf16 v[96:99],v[28:31],a[16:23],v2
s_add_u32 m0,s73,131072
v_smfmac_f32_16x16x64_bf16 v[100:103],v[28:31],a[144:151],v2
s_add_u32 s57,s67,8192
v_smfmac_f32_16x16x64_bf16 v[104:107],v[28:31],a[24:31],v2
s_cmp_lt_u32 s19,s76
s_cbranch_scc1 L_ckw_260
L_ckb_261:
v_smfmac_f32_16x16x64_bf16 v[108:111],v[28:31],a[152:159],v2
s_waitcnt vmcnt(0) lgkmcnt(1)
v_smfmac_f32_16x16x64_bf16 v[96:99],v[32:35],a[32:39],v2
ds_write_b128 v12,v[40:43] offset:4096
v_max3_u32 v123,v40,v41,v42
v_smfmac_f32_16x16x64_bf16 v[100:103],v[32:35],a[160:167],v2
v_max_u32 v123,v43,v123
v_smfmac_f32_16x16x64_bf16 v[104:107],v[32:35],a[40:47],v2
v_cmp_le_u32 vcc,s72,v123
v_smfmac_f32_16x16x64_bf16 v[108:111],v[32:35],a[168:175],v2
v_smfmac_f32_16x16x64_bf16 v[112:115],v[28:31],v[144:151],v2
s_cbranch_vccnz L_cpb_274
L_cback_276:
s_waitcnt lgkmcnt(0)
s_barrier
v_smfmac_f32_16x16x64_bf16 v[96:99],v[36:39],a[48:55],v2
buffer_store_dword v54,v10,s[8:11],s30 offen sc1
v_smfmac_f32_16x16x64_bf16 v[100:103],v[36:39],a[176:183],v2
ds_read_b128 v[44:47],v120 offset:4096
v_smfmac_f32_16x16x64_bf16 v[104:107],v[36:39],a[56:63],v2
buffer_store_dwordx4 v[124:127],v0,s[8:11],s54 offen sc1
v_smfmac_f32_16x16x64_bf16 v[108:111],v[36:39],a[184:191],v2
ds_read_b128 v[48:51],v121 offset:4096
v_smfmac_f32_16x16x64_bf16 v[96:99],v[40:43],a[64:71],v2
buffer_load_dwordx4 v0,s[8:11],s67 offen sc1 lds
v_smfmac_f32_16x16x64_bf16 v[100:103],v[40:43],a[192:199],v2
ds_read_b128 v[52:55],v122 offset:4096
v_smfmac_f32_16x16x64_bf16 v[104:107],v[40:43],a[72:79],v2
buffer_load_dwordx4 v0,s[8:11],s67 offen offset:1024 sc1 lds
s_add_u32 m0,s73,139264
v_smfmac_f32_16x16x64_bf16 v[108:111],v[40:43],a[200:207],v2
s_waitcnt lgkmcnt(2)
v_smfmac_f32_16x16x64_bf16 v[96:99],v[44:47],a[80:87],v2
buffer_load_dwordx4 v0,s[8:11],s57 offen sc1 lds
s_add_u32 s67,s67,786432
v_smfmac_f32_16x16x64_bf16 v[100:103],v[44:47],a[208:215],v2
s_waitcnt lgkmcnt(1)
v_smfmac_f32_16x16x64_bf16 v[96:99],v[48:51],a[96:103],v2
buffer_load_dwordx4 v0,s[8:11],s57 offen offset:1024 sc1 lds
v_smfmac_f32_16x16x64_bf16 v[100:103],v[48:51],a[224:231],v2
s_waitcnt lgkmcnt(0)
v_smfmac_f32_16x16x64_bf16 v[96:99],v[52:55],a[112:119],v2
buffer_load_dword v23,v22,s[8:11],s75 offen sc1
v_smfmac_f32_16x16x64_bf16 v[100:103],v[52:55],a[240:247],v2
v_smfmac_f32_16x16x64_bf16 v[104:107],v[44:47],a[88:95],v2
v_smfmac_f32_16x16x64_bf16 v[108:111],v[44:47],a[216:223],v2
v_smfmac_f32_16x16x64_bf16 v[104:107],v[48:51],a[104:111],v2
v_add_f32 v96,v96,v98
v_smfmac_f32_16x16x64_bf16 v[108:111],v[48:51],a[232:239],v2
v_add_f32 v97,v97,v99
v_smfmac_f32_16x16x64_bf16 v[104:107],v[52:55],a[120:127],v2
v_cvt_pk_bf16_f32 v120,v96,v97
v_smfmac_f32_16x16x64_bf16 v[108:111],v[52:55],a[248:255],v2
v_add_f32 v100,v100,v102
v_smfmac_f32_16x16x64_bf16 v[116:119],v[28:31],v[152:159],v2
v_add_f32 v101,v101,v103
v_smfmac_f32_16x16x64_bf16 v[112:115],v[32:35],v[160:167],v2
v_cvt_pk_bf16_f32 v121,v100,v101
v_add_f32 v104,v104,v106
v_add_f32 v105,v105,v107
v_cvt_pk_bf16_f32 v122,v104,v105
v_add_f32 v108,v108,v110
v_add_f32 v109,v109,v111
v_cvt_pk_bf16_f32 v123,v108,v109
ds_write_b128 v4,v[120:123]
v_smfmac_f32_16x16x64_bf16 v[116:119],v[32:35],v[168:175],v2
s_mov_b32 s54,s68
s_add_u32 s68,s68,131072
v_mov_b32 v125,0
v_smfmac_f32_16x16x64_bf16 v[112:115],v[36:39],v[176:183],v2
s_cmp_eq_u32 s51,63
s_cbranch_scc1 L_cend_270
v_smfmac_f32_16x16x64_bf16 v[116:119],v[36:39],v[184:191],v2
v_smfmac_f32_16x16x64_bf16 v[112:115],v[40:43],v[192:199],v2
s_waitcnt lgkmcnt(0)
s_barrier
ds_read_b64_tr_b16 v[96:97],v5 offset:0
ds_read_b64_tr_b16 v[98:99],v6 offset:0
v_smfmac_f32_16x16x64_bf16 v[116:119],v[40:43],v[200:207],v2
ds_read_b64_tr_b16 v[100:101],v5 offset:1024
v_smfmac_f32_16x16x64_bf16 v[112:115],v[44:47],v[208:215],v2
ds_read_b64_tr_b16 v[102:103],v6 offset:1024
v_smfmac_f32_16x16x64_bf16 v[116:119],v[44:47],v[216:223],v2
ds_read_b64_tr_b16 v[104:105],v5 offset:2048
v_smfmac_f32_16x16x64_bf16 v[112:115],v[48:51],v[224:231],v2
ds_read_b64_tr_b16 v[106:107],v6 offset:2048
s_waitcnt lgkmcnt(4)
v_mfma_f32_16x16x32_bf16 v[24:27],v[56:59],v[96:99],0
ds_read_b64_tr_b16 v[108:109],v5 offset:3072
v_mfma_f32_16x16x32_bf16 v[28:31],v[60:63],v[96:99],0
ds_read_b64_tr_b16 v[110:111],v6 offset:3072
v_mfma_f32_16x16x32_bf16 v[32:35],v[96:99],v[96:99],0
ds_read_b128 v[40:43],v11 offset:12288
s_waitcnt lgkmcnt(5)
v_mfma_f32_16x16x32_bf16 v[24:27],v[64:67],v[100:103],v[24:27]
ds_read_b128 v[56:59],v11 offset:0
v_mfma_f32_16x16x32_bf16 v[28:31],v[68:71],v[100:103],v[28:31]
ds_read_b128 v[60:63],v11 offset:1024
v_mfma_f32_16x16x32_bf16 v[32:35],v[100:103],v[100:103],v[32:35]
ds_read_b128 v[96:99],v11 offset:8192
s_waitcnt lgkmcnt(6)
v_mfma_f32_16x16x32_bf16 v[24:27],v[72:75],v[104:107],v[24:27]
ds_read_b128 v[64:67],v11 offset:2048
v_mfma_f32_16x16x32_bf16 v[28:31],v[76:79],v[104:107],v[28:31]
ds_read_b128 v[68:71],v11 offset:3072
v_mfma_f32_16x16x32_bf16 v[32:35],v[104:107],v[104:107],v[32:35]
ds_read_b128 v[100:103],v11 offset:9216
s_waitcnt lgkmcnt(7)
v_mfma_f32_16x16x32_bf16 v[24:27],v[80:83],v[108:111],v[24:27]
ds_read_b128 v[72:75],v11 offset:4096
v_mfma_f32_16x16x32_bf16 v[28:31],v[84:87],v[108:111],v[28:31]
ds_read_b128 v[76:79],v11 offset:5120
v_mfma_f32_16x16x32_bf16 v[32:35],v[108:111],v[108:111],v[32:35]
ds_read_b128 v[104:107],v11 offset:10240
v_smfmac_f32_16x16x64_bf16 v[116:119],v[48:51],v[232:239],v2
ds_read_b128 v[80:83],v11 offset:6144
v_smfmac_f32_16x16x64_bf16 v[112:115],v[52:55],v[240:247],v2
ds_read_b128 v[84:87],v11 offset:7168
v_smfmac_f32_16x16x64_bf16 v[116:119],v[52:55],v[248:255],v2
ds_read_b128 v[108:111],v11 offset:11264
v_max3_f32 v126,v24,v25,v26
v_max3_f32 v127,v27,v28,v29
v_max3_f32 v126,v30,v31,v126
v_max3_f32 v127,v34,v35,v127
v_max_f32 v126,v126,v127
v_max_f32 v127,v126,v127
v_pk_mul_f32 v[34:35],v[34:35],v[0:1] op_sel:[0,1]
v_pk_mul_f32 v[24:25],v[24:25],v[0:1] op_sel:[0,1]
v_permlane16_swap_b32 v126,v127
v_max_f32 v126,v126,v127
v_max_f32 v127,v126,v127
v_pk_mul_f32 v[26:27],v[26:27],v[0:1] op_sel:[0,1]
v_pk_mul_f32 v[28:29],v[28:29],v[0:1] op_sel:[0,1]
v_permlane32_swap_b32 v126,v127
v_max_f32 v126,v126,v127
v_mul_f32 v126,v1,v126
v_pk_mul_f32 v[30:31],v[30:31],v[0:1] op_sel:[0,1]
v_pk_add_f32 v[34:35],v[34:35],v[126:127] op_sel_hi:[1,0] neg_lo:[0,1] neg_hi:[0,1]
v_pk_add_f32 v[112:113],v[112:113],v[114:115]
v_pk_add_f32 v[116:117],v[116:117],v[118:119]
v_pk_add_f32 v[24:25],v[24:25],v[126:127] op_sel_hi:[1,0] neg_lo:[0,1] neg_hi:[0,1]
v_pk_add_f32 v[26:27],v[26:27],v[126:127] op_sel_hi:[1,0] neg_lo:[0,1] neg_hi:[0,1]
v_pk_add_f32 v[28:29],v[28:29],v[126:127] op_sel_hi:[1,0] neg_lo:[0,1] neg_hi:[0,1]
v_pk_add_f32 v[30:31],v[30:31],v[126:127] op_sel_hi:[1,0] neg_lo:[0,1] neg_hi:[0,1]
v_exp_f32 v34,v34
v_exp_f32 v35,v35
v_cvt_pk_bf16_f32 v126,v112,v113
v_cvt_pk_bf16_f32 v124,v34,v35
v_cvt_pk_bf16_f32 v127,v116,v117
v_cvt_pk_bf16_f32 v36,v116,v117
v_mfma_f32_16x16x16_bf16 v[32:35],v[14:15],v[124:125],0
ds_read_b128 v[44:47],v11 offset:13312
v_exp_f32 v24,v24
v_mfma_f32_16x16x16_bf16 v[112:115],v[126:127],v[124:125],0
ds_read_b128 v[48:51],v11 offset:14336
v_exp_f32 v25,v25
v_mfma_f32_16x16x16_bf16 v[116:119],v[36:37],v[124:125],0
ds_read_b128 v[52:55],v11 offset:15360
v_exp_f32 v26,v26
v_exp_f32 v27,v27
v_cvt_pk_bf16_f32 v120,v24,v25
v_exp_f32 v28,v28
v_exp_f32 v29,v29
v_cvt_pk_bf16_f32 v121,v26,v27
v_exp_f32 v30,v30
v_exp_f32 v31,v31
v_cvt_pk_bf16_f32 v122,v28,v29
v_cvt_pk_bf16_f32 v123,v30,v31
s_add_u32 s75,s75,8192
s_add_u32 s51,s51,1
v_mfma_f32_16x16x32_bf16 v[32:35],v[14:17],v[120:123],v[32:35]
v_mfma_f32_16x16x32_bf16 v[112:115],v[88:91],v[120:123],v[112:115]
ds_read_b128 v[88:91],v11 offset:16384
v_mfma_f32_16x16x32_bf16 v[116:119],v[92:95],v[120:123],v[116:119]
ds_read_b128 v[92:95],v11 offset:17408
v_rcp_f32 v32,v32
v_mov_b64 v[24:25],-1
v_mov_b64 v[26:27],-1
s_add_u32 s64,s75,12582912
s_add_u32 s70,s64,4096
v_pk_mul_f32 v[112:113],v[112:113],v[32:33] op_sel_hi:[1,0]
v_pk_mul_f32 v[114:115],v[114:115],v[32:33] op_sel_hi:[1,0]
v_pk_mul_f32 v[116:117],v[116:117],v[32:33] op_sel_hi:[1,0]
v_pk_mul_f32 v[118:119],v[118:119],v[32:33] op_sel_hi:[1,0]
v_cvt_pk_bf16_f32 v120,v112,v116
v_cvt_pk_bf16_f32 v121,v113,v117
v_cvt_pk_bf16_f32 v122,v114,v118
v_cvt_pk_bf16_f32 v123,v115,v119
ds_write_b128 v7,v[120:123]
buffer_store_dwordx4 v[24:27],v0,s[8:11],s69 offen sc1
buffer_store_dwordx4 v[24:27],v0,s[8:11],s69 offen offset:1024 sc1
v_mov_b64 v[112:113],0
v_mov_b64 v[114:115],0
v_mov_b64 v[116:117],0
v_mov_b64 v[118:119],0
s_waitcnt lgkmcnt(0)
s_barrier
ds_read_b128 v[24:27],v8 offset:0
ds_read_b128 v[28:31],v8 offset:512
ds_read_b128 v[32:35],v8 offset:1024
ds_read_b128 v[36:39],v8 offset:1536
v_mov_b64 v[120:121],0
v_mov_b64 v[122:123],0
s_add_u32 s57,s65,65536
s_add_u32 s58,s65,131072
s_add_u32 s59,s65,196608
s_add_u32 s56,s18,s75
s_add_u32 s30,s75,17825792
s_waitcnt lgkmcnt(3)
v_smfmac_f32_16x16x64_bf16 v[112:115],v[24:27],v[56:63],v3
ds_read_b128 v[56:59],v11 offset:18432
s_waitcnt lgkmcnt(3)
v_smfmac_f32_16x16x64_bf16 v[112:115],v[28:31],v[64:71],v3
ds_read_b128 v[60:63],v11 offset:19456
s_waitcnt lgkmcnt(3)
v_smfmac_f32_16x16x64_bf16 v[112:115],v[32:35],v[72:79],v3
ds_read_b128 v[64:67],v11 offset:20480
s_waitcnt lgkmcnt(3)
v_smfmac_f32_16x16x64_bf16 v[112:115],v[36:39],v[80:87],v3
ds_read_b128 v[68:71],v11 offset:21504
v_smfmac_f32_16x16x64_bf16 v[116:119],v[24:27],v[96:103],v3
ds_read_b128 v[72:75],v11 offset:22528
v_smfmac_f32_16x16x64_bf16 v[116:119],v[28:31],v[104:111],v3
ds_read_b128 v[76:79],v11 offset:23552
v_cvt_pk_bf16_f32 v112,v112,v113
v_smfmac_f32_16x16x64_bf16 v[116:119],v[32:35],v[40:47],v3
ds_read_b128 v[80:83],v11 offset:24576
v_cvt_pk_bf16_f32 v113,v114,v115
buffer_store_dwordx2 v[112:113],v9,s[8:11],s65 offen sc1
v_smfmac_f32_16x16x64_bf16 v[116:119],v[36:39],v[48:55],v3
ds_read_b128 v[84:87],v11 offset:25600
v_mov_b64 v[112:113],0
v_smfmac_f32_16x16x64_bf16 v[120:123],v[24:27],v[88:95],v3
ds_read_b128 v[96:99],v11 offset:26624
ds_read_b128 v[100:103],v11 offset:27648
v_mov_b64 v[114:115],0
s_waitcnt lgkmcnt(8)
v_smfmac_f32_16x16x64_bf16 v[120:123],v[28:31],v[56:63],v3
ds_read_b128 v[104:107],v11 offset:28672
v_cvt_pk_bf16_f32 v116,v116,v117
s_waitcnt lgkmcnt(7)
v_smfmac_f32_16x16x64_bf16 v[120:123],v[32:35],v[64:71],v3
ds_read_b128 v[108:111],v11 offset:29696
ds_read_b128 v[40:43],v11 offset:30720
v_cvt_pk_bf16_f32 v117,v118,v119
buffer_store_dwordx2 v[116:117],v9,s[8:11],s57 offen sc1
s_waitcnt lgkmcnt(7)
v_smfmac_f32_16x16x64_bf16 v[120:123],v[36:39],v[72:79],v3
ds_read_b128 v[44:47],v11 offset:31744
v_add_u32 v52,s50,v5
s_waitcnt lgkmcnt(6)
v_smfmac_f32_16x16x64_bf16 v[112:115],v[24:27],v[80:87],v3
v_add_u32 v54,s50,v6
s_waitcnt lgkmcnt(4)
v_smfmac_f32_16x16x64_bf16 v[112:115],v[28:31],v[96:103],v3
ds_read_b64_tr_b16 v[52:53],v52
v_cvt_pk_bf16_f32 v120,v120,v121
s_waitcnt lgkmcnt(3)
v_smfmac_f32_16x16x64_bf16 v[112:115],v[32:35],v[104:111],v3
ds_read_b64_tr_b16 v[54:55],v54
v_cvt_pk_bf16_f32 v121,v122,v123
buffer_store_dwordx2 v[120:121],v9,s[8:11],s58 offen sc1
s_waitcnt lgkmcnt(2)
v_smfmac_f32_16x16x64_bf16 v[112:115],v[36:39],v[40:47],v3
v_mov_b64 v[116:117],0
v_mov_b64 v[118:119],0
s_xor_b32 s65,s65,262144
v_mov_b32_dpp v124,v126 quad_perm:[2,3,2,3] row_mask:0xf bank_mask:0xf
v_mov_b32_dpp v125,v127 quad_perm:[2,3,2,3] row_mask:0xf bank_mask:0xf
s_mov_b32 vcc_lo,0xcccccccc
s_mov_b32 vcc_hi,0xcccccccc
s_nop 0
v_cvt_pk_bf16_f32 v112,v112,v113
v_cvt_pk_bf16_f32 v113,v114,v115
buffer_store_dwordx2 v[112:113],v9,s[8:11],s59 offen sc1
s_waitcnt lgkmcnt(0)
s_buffer_load_dword s19,s[8:11],s56
v_cndmask_b32 v124,v124,v52,vcc
v_cndmask_b32 v125,v125,v53,vcc
v_cndmask_b32 v126,v126,v54,vcc
v_cndmask_b32 v127,v127,v55,vcc
s_cmp_lt_u32 s46,2
s_waitcnt vmcnt(3)
s_cbranch_scc1 L_crg_277
s_cmp_eq_u32 s46,2
s_waitcnt vmcnt(1)
s_cbranch_scc1 L_crg_277
s_waitcnt vmcnt(0)
L_crg_277:
buffer_load_dwordx4 v[32:35],v0,s[8:11],s66 offen offset:0 sc1
buffer_load_dwordx4 v[36:39],v0,s[8:11],s66 offen offset:1024 sc1
v_mov_b64 v[96:97],0
v_mov_b64 v[98:99],0
v_mov_b64 v[100:101],0
v_mov_b64 v[102:103],0
v_mov_b64 v[104:105],0
v_mov_b64 v[106:107],0
v_mov_b64 v[108:109],0
v_mov_b64 v[110:111],0
v_mov_b64 v[112:113],0
v_mov_b64 v[114:115],0
v_add_u32 v55,131072,v0
v_add_u32 v123,s73,v55
v_xor_b32 v120,1024,v12
v_xor_b32 v121,2048,v12
v_xor_b32 v122,3072,v12
buffer_load_dwordx4 v[44:47],v0,s[8:11],s66 offen offset:0 sc1
buffer_load_dwordx4 v[48:51],v0,s[8:11],s66 offen offset:1024 sc1
s_cmp_ge_u32 s51,63
s_cselect_b32 s76,0,1
s_cmp_eq_u32 s46,0
s_cselect_b32 s76,s76,0
s_waitcnt vmcnt(3)
v_mfma_f32_16x16x32_bf16 v[28:31],v[18:21],v[32:35],0
s_waitcnt vmcnt(2)
v_mfma_f32_16x16x32_bf16 v[28:31],v[18:21],v[36:39],v[28:31]
s_nop 7
v_cmp_u_f32 vcc,v28,v28
v_add_f32_dpp v52,v28,v28 row_ror:8 row_mask:0xf bank_mask:0x3
v_add_f32_dpp v53,v29,v29 row_ror:8 row_mask:0xf bank_mask:0x3
v_add_f32_dpp v52,v30,v30 row_ror:8 row_mask:0xf bank_mask:0xc
v_add_f32_dpp v53,v31,v31 row_ror:8 row_mask:0xf bank_mask:0xc
s_nop 0
v_add_f32_dpp v52,v52,v52 row_shl:4 row_mask:0xf bank_mask:0x5
v_add_f32_dpp v53,v53,v53 row_shl:4 row_mask:0xf bank_mask:0x5
s_cbranch_vccnz L_crp_272
L_cok_278:
v_cvt_pk_bf16_f32 v54,v52,v53
buffer_store_dword v54,v10,s[8:11],s64 offen sc1
s_mov_b32 s69,s66
s_xor_b32 s66,s66,262144
s_barrier
ds_read_b128 v[56:59],v55 offset:0
ds_read_b128 v[60:63],v55 offset:4096
ds_read_b128 v[64:67],v55 offset:1024
buffer_load_dwordx4 v[24:27],v13,s[8:11],s64 offen sc1
ds_read_b128 v[68:71],v55 offset:5120
ds_read_b128 v[72:75],v55 offset:2048
ds_read_b128 v[76:79],v55 offset:6144
ds_read_b128 v[80:83],v55 offset:3072
buffer_load_dwordx4 v[24:27],v13,s[8:11],s64 offen sc1
ds_read_b128 v[84:87],v55 offset:7168
ds_read_b128 v[88:91],v123 offset:8192
ds_read_b128 v[92:95],v123 offset:9216
s_branch L_chain_267
L_cpb_274:
buffer_load_dwordx4 v[40:43],v13,s[8:11],s70 offen sc1
s_sub_u32 s49,s49,1
s_cbranch_scc1 L_abort2
s_waitcnt vmcnt(0)
v_max3_u32 v123,v40,v41,v42
v_max_u32 v123,v43,v123
v_cmp_le_u32 vcc,s72,v123
s_cbranch_vccnz L_cpb_274
ds_write_b128 v12,v[40:43] offset:4096
s_branch L_cback_276
L_crp_272:
buffer_load_dwordx4 v[32:35],v0,s[8:11],s66 offen offset:0 sc1
buffer_load_dwordx4 v[36:39],v0,s[8:11],s66 offen offset:1024 sc1
s_sub_u32 s49,s49,1
s_cbranch_scc1 L_abort2
s_waitcnt vmcnt(3)
v_mfma_f32_16x16x32_bf16 v[28:31],v[18:21],v[44:47],0
s_waitcnt vmcnt(2)
v_mfma_f32_16x16x32_bf16 v[28:31],v[18:21],v[48:51],v[28:31]
s_nop 7
v_cmp_u_f32 vcc,v28,v28
v_add_f32_dpp v52,v28,v28 row_ror:8 row_mask:0xf bank_mask:0x3
v_add_f32_dpp v53,v29,v29 row_ror:8 row_mask:0xf bank_mask:0x3
v_add_f32_dpp v52,v30,v30 row_ror:8 row_mask:0xf bank_mask:0xc
v_add_f32_dpp v53,v31,v31 row_ror:8 row_mask:0xf bank_mask:0xc
s_nop 0
v_add_f32_dpp v52,v52,v52 row_shl:4 row_mask:0xf bank_mask:0x5
v_add_f32_dpp v53,v53,v53 row_shl:4 row_mask:0xf bank_mask:0x5
s_cbranch_vccz L_cok_278
buffer_load_dwordx4 v[44:47],v0,s[8:11],s66 offen offset:0 sc1
buffer_load_dwordx4 v[48:51],v0,s[8:11],s66 offen offset:1024 sc1
s_sub_u32 s49,s49,1
s_cbranch_scc1 L_abort2
s_waitcnt vmcnt(3)
v_mfma_f32_16x16x32_bf16 v[28:31],v[18:21],v[32:35],0
s_waitcnt vmcnt(2)
v_mfma_f32_16x16x32_bf16 v[28:31],v[18:21],v[36:39],v[28:31]
s_nop 7
v_cmp_u_f32 vcc,v28,v28
v_add_f32_dpp v52,v28,v28 row_ror:8 row_mask:0xf bank_mask:0x3
v_add_f32_dpp v53,v29,v29 row_ror:8 row_mask:0xf bank_mask:0x3
v_add_f32_dpp v52,v30,v30 row_ror:8 row_mask:0xf bank_mask:0xc
v_add_f32_dpp v53,v31,v31 row_ror:8 row_mask:0xf bank_mask:0xc
s_nop 0
v_add_f32_dpp v52,v52,v52 row_shl:4 row_mask:0xf bank_mask:0x5
v_add_f32_dpp v53,v53,v53 row_shl:4 row_mask:0xf bank_mask:0x5
s_cbranch_vccz L_cok_278
s_branch L_crp_272
L_ckw_260:
s_add_u32 s59,s18,s75
L_ww_279:
s_sleep 1
buffer_load_dword v23,off,s[8:11],s59 sc1
s_sub_u32 s49,s49,1
s_cbranch_scc1 L_abort2
s_waitcnt vmcnt(0)
v_readfirstlane_b32 s76,v23
s_cmp_eq_u32 s76,0
s_cbranch_scc1 L_ww_279
L_wwd_280:
s_branch L_ckb_261
L_cend_270:
v_smfmac_f32_16x16x64_bf16 v[116:119],v[36:39],v[184:191],v2
v_smfmac_f32_16x16x64_bf16 v[112:115],v[40:43],v[192:199],v2
v_smfmac_f32_16x16x64_bf16 v[116:119],v[40:43],v[200:207],v2
v_smfmac_f32_16x16x64_bf16 v[112:115],v[44:47],v[208:215],v2
v_smfmac_f32_16x16x64_bf16 v[116:119],v[44:47],v[216:223],v2
v_smfmac_f32_16x16x64_bf16 v[112:115],v[48:51],v[224:231],v2
v_smfmac_f32_16x16x64_bf16 v[116:119],v[48:51],v[232:239],v2
v_smfmac_f32_16x16x64_bf16 v[112:115],v[52:55],v[240:247],v2
v_smfmac_f32_16x16x64_bf16 v[116:119],v[52:55],v[248:255],v2
s_waitcnt lgkmcnt(0)
s_nop 2
v_pk_add_f32 v[112:113],v[112:113],v[114:115]
s_nop 2
v_pk_add_f32 v[116:117],v[116:117],v[118:119]
v_cvt_pk_bf16_f32 v126,v112,v113
v_cvt_pk_bf16_f32 v127,v116,v117
v_add_u32 v52,s50,v5
v_add_u32 v54,s50,v6
ds_read_b64_tr_b16 v[52:53],v52
ds_read_b64_tr_b16 v[54:55],v54
v_mov_b32_dpp v124,v126 quad_perm:[2,3,2,3] row_mask:0xf bank_mask:0xf
v_mov_b32_dpp v125,v127 quad_perm:[2,3,2,3] row_mask:0xf bank_mask:0xf
s_mov_b32 vcc_lo,0xcccccccc
s_mov_b32 vcc_hi,0xcccccccc
s_waitcnt lgkmcnt(0)
v_cndmask_b32 v124,v124,v52,vcc
v_cndmask_b32 v125,v125,v53,vcc
v_cndmask_b32 v126,v126,v54,vcc
v_cndmask_b32 v127,v127,v55,vcc
buffer_store_dwordx4 v[124:127],v0,s[8:11],s54 offen sc1
s_mov_b32 s51,64
s_waitcnt vmcnt(0)
s_barrier
s_nop 11
v_lshrrev_b32 v1,4,v0
s_endpgm
L_rc2_230:
v_and_b32 v120,15,v1
v_lshrrev_b32 v121,4,v1
v_and_b32 v122,2,v1
v_cmp_eq_u32 vcc,0,v122
v_mov_b32 v2,0xeeee
v_mov_b32 v123,0x4444
v_cndmask_b32 v2,v2,v123,vcc
v_and_b32 v122,1,v1
v_cmp_eq_u32 vcc,0,v122
v_mov_b32 v3,0xdddd
v_mov_b32 v123,0x8888
v_cndmask_b32 v3,v3,v123,vcc
v_lshrrev_b32 v122,1,v120
v_bfe_u32 v123,v120,2,1
v_xor_b32 v123,v123,v122
v_lshlrev_b32 v4,7,v123
v_and_b32 v123,1,v120
v_lshl_add_u32 v4,v123,6,v4
v_xor_b32 v123,v121,v122
v_and_b32 v123,3,v123
v_lshl_add_u32 v4,v123,4,v4
s_lshl_b32 s56,s46,10
s_add_u32 s56,s56,147456
v_add_u32 v4,s56,v4
v_lshlrev_b32 v122,1,v121
v_add_u32 v122,0,v122
v_and_b32 v123,1,v121
v_xor_b32 v123,v123,v122
v_lshlrev_b32 v5,7,v123
v_bfe_u32 v123,v120,3,1
v_lshl_add_u32 v5,v123,6,v5
v_xor_b32 v123,v120,v122
v_and_b32 v123,3,v123
v_lshl_add_u32 v5,v123,4,v5
v_bfe_u32 v123,v120,2,1
v_lshl_add_u32 v5,v123,3,v5
v_add_u32 v5,147456,v5
v_lshlrev_b32 v122,1,v121
v_add_u32 v122,1,v122
v_and_b32 v123,1,v121
v_xor_b32 v123,v123,v122
v_lshlrev_b32 v6,7,v123
v_bfe_u32 v123,v120,3,1
v_lshl_add_u32 v6,v123,6,v6
v_xor_b32 v123,v120,v122
v_and_b32 v123,3,v123
v_lshl_add_u32 v6,v123,4,v6
v_bfe_u32 v123,v120,2,1
v_lshl_add_u32 v6,v123,3,v6
v_add_u32 v6,147456,v6
v_lshlrev_b32 v7,7,v121
v_lshrrev_b32 v122,1,v120
v_lshl_add_u32 v8,v122,4,v7
v_add_u32 v8,151552,v8
v_lshrrev_b32 v122,2,v120
v_lshl_add_u32 v7,v122,5,v7
v_and_b32 v122,1,v120
v_lshl_add_u32 v7,v122,4,v7
v_and_b32 v122,2,v120
v_cmp_eq_u32 vcc,0,v122
s_lshl_b32 s56,s46,9
v_mov_b32 v122,2048
v_mov_b32 v123,s56
v_cndmask_b32 v122,v122,v123,vcc
v_add_u32 v7,v122,v7
v_add_u32 v7,151552,v7
v_lshrrev_b32 v122,3,v1
v_lshlrev_b32 v9,11,v122
v_and_b32 v122,7,v1
v_lshl_add_u32 v9,v122,3,v9
s_lshl_b32 s56,s46,14
s_lshl_b32 s57,s47,6
s_add_u32 s56,s56,s57
v_add_u32 v9,s56,v9
s_lshl_b32 s71,s46,5
s_add_u32 s71,s71,s47
s_bfe_u32 s56,s71,0x10003
s_lshl_b32 s56,s56,11
s_and_b32 s57,s71,1
s_lshl_b32 s57,s57,10
s_add_u32 s56,s56,s57
s_bfe_u32 s57,s71,0x10002
s_lshl_b32 s57,s57,9
s_add_u32 s56,s56,s57
s_bfe_u32 s57,s71,0x10001
s_lshl_b32 s57,s57,6
s_add_u32 s56,s56,s57
s_bfe_u32 s57,s71,0x10004
s_lshl_b32 s57,s57,8
s_add_u32 s56,s56,s57
s_bfe_u32 s57,s71,0x10005
s_lshl_b32 s57,s57,7
s_add_u32 s56,s56,s57
s_bfe_u32 s57,s71,0x10006
s_lshl_b32 s57,s57,12
s_add_u32 s56,s56,s57
v_and_b32 v122,3,v120
v_lshlrev_b32 v10,2,v122
v_bfe_u32 v122,v120,3,1
v_lshl_add_u32 v10,v122,4,v10
v_and_b32 v122,1,v121
v_lshl_add_u32 v10,v122,5,v10
v_add_u32 v10,s56,v10
v_and_b32 v123,36,v1
v_mov_b32 v122,0x80000000
v_cmp_eq_u32 vcc,0,v123
s_nop 1
v_cndmask_b32 v10,v122,v10,vcc
s_lshl_b32 s71,s71,11
s_lshl_b32 s73,s46,11
s_mov_b32 s72,0xffc00000
s_mov_b32 s74,0
v_and_b32 v11,1,v121
v_xor_b32 v11,v11,v120
v_and_b32 v11,3,v11
v_lshrrev_b32 v122,2,v120
v_lshl_add_u32 v11,v11,2,v122
v_lshl_add_u32 v11,v121,4,v11
v_lshlrev_b32 v11,4,v11
s_lshl_b32 s56,s46,15
v_add_u32 v11,s56,v11
v_lshrrev_b32 v13,3,v1
v_lshlrev_b32 v13,9,v13
v_and_b32 v122,7,v1
v_lshl_add_u32 v13,v122,4,v13
v_and_b32 v122,15,v1
v_and_b32 v123,1,v1
v_lshlrev_b32 v123,4,v123
v_mov_b32 v124,0x3f80
v_lshlrev_b32 v124,v123,v124
v_lshrrev_b32 v122,1,v122
v_cmp_eq_u32 vcc,0,v122
s_nop 1
v_cndmask_b32 v18,0,v124,vcc
v_cmp_eq_u32 vcc,1,v122
s_nop 1
v_cndmask_b32 v19,0,v124,vcc
v_cmp_eq_u32 vcc,2,v122
s_nop 1
v_cndmask_b32 v20,0,v124,vcc
v_cmp_eq_u32 vcc,3,v122
s_nop 1
v_cndmask_b32 v21,0,v124,vcc
s_and_b32 s56,s46,1
s_lshl_b32 s56,s56,8
s_and_b32 s57,s46,2
s_lshl_b32 s57,s57,6
s_add_u32 s56,s56,s57
v_add_u32 v13,s56,v13
s_add_u32 s56,s50,155648
v_add_u32 v12,s56,v0
v_mov_b64 v[14:15],s[28:29]
v_mov_b64 v[16:17],s[28:29]
v_add_u32 v22,13647872,v10
s_lshl_b32 s18,s47,2
s_add_u32 s18,s18,10494080
v_mov_b32 v1,s80
s_mov_b32 s65,16777216
s_add_u32 s66,s71,16777216
s_add_u32 s69,s71,17039360
s_mov_b32 s30,0x40000000
s_mov_b32 s51,0
v_lshrrev_b32 v120,2,v0
v_add_u32 v120,10510464,v120
v_or_b32 v120,s52,v120
s_mov_b64 vcc,-1
s_mov_b32 vcc_lo,0
v_cndmask_b32 v22,v22,v120,vcc
s_or_b32 s56,s52,10495616
v_writelane_b32 v22,s56,4
s_or_b32 s56,s47,s46
s_mov_b32 s56,10486784
s_cmov_b32 s56,0x80000000
v_writelane_b32 v22,s56,5
s_mov_b32 s30,0
s_mov_b32 s31,0
L_cst_284:
s_cmp_lg_u32 s46,0
s_cbranch_scc1 L_csw_289
s_lshl_b32 s59,s31,13
s_add_u32 s59,s59,10486016
v_lshrrev_b32 v121,2,v0
v_and_b32 v121,127,v121
L_ckk_290:
s_sleep 1
buffer_load_dword v120,v121,s[8:11],s59 offen sc1
s_sub_u32 s49,s49,1
s_cbranch_scc1 L_abort2
s_waitcnt vmcnt(0)
v_cmp_eq_u32 vcc,0,v120
s_cbranch_vccnz L_ckk_290
v_max_u32_dpp v120,v120,v120 row_ror:8 row_mask:0xf bank_mask:0xf
s_nop 1
v_max_u32_dpp v120,v120,v120 row_ror:4 row_mask:0xf bank_mask:0xf
s_nop 1
v_max_u32_dpp v120,v120,v120 row_ror:2 row_mask:0xf bank_mask:0xf
s_nop 1
v_max_u32_dpp v120,v120,v120 row_ror:1 row_mask:0xf bank_mask:0xf
v_mov_b32 v121,v120
s_nop 1
v_permlane16_swap_b32 v120,v121
v_max_u32 v120,v120,v121
v_mov_b32 v121,v120
s_nop 1
v_permlane32_swap_b32 v120,v121
v_max_u32 v120,v120,v121
s_nop 0
v_readfirstlane_b32 s61,v120
s_max_u32 s30,s30,s61
s_add_u32 s31,s31,1
s_andn2_b32 s51,0x7ff,s30
s_lshr_b32 s51,s51,5
s_add_u32 s61,s51,2
s_min_u32 s61,s61,63
s_cmp_le_u32 s31,s61
s_cbranch_scc1 L_cst_284
v_mov_b32 v120,0
v_mov_b32 v121,s30
ds_write_b32 v8,v120 offset:2560
ds_write_b32 v8,v121 offset:3072
s_lshl_b32 s59,s51,13
s_lshl2_add_u32 s59,s47,s59
s_add_u32 s59,s59,10485888
L_ww_291:
s_sleep 1
buffer_load_dword v122,off,s[8:11],s59 sc1
s_sub_u32 s49,s49,1
s_cbranch_scc1 L_abort2
s_waitcnt vmcnt(0)
v_readfirstlane_b32 s61,v122
s_cmp_eq_u32 s61,0
s_cbranch_scc1 L_ww_291
L_wwd_292:
L_csw_289:
s_waitcnt lgkmcnt(0)
s_barrier
ds_read_b32 v120,v8 offset:3072
s_waitcnt lgkmcnt(0)
v_readfirstlane_b32 s30,v120
s_andn2_b32 s51,0x7ff,s30
s_lshr_b32 s51,s51,5
s_lshl_b32 s56,s51,5
s_add_u32 s56,s56,s47
s_mul_i32 s56,s56,24576
s_add_u32 s56,s56,150994944
s_add_u32 s67,s56,s73
s_add_u32 m0,s73,131072
s_add_u32 s57,s67,8192
buffer_load_dwordx4 v0,s[8:11],s67 offen sc1 lds
buffer_load_dwordx4 v0,s[8:11],s67 offen offset:1024 sc1 lds
s_add_u32 m0,s73,139264
s_add_u32 s67,s67,786432
buffer_load_dwordx4 v0,s[8:11],s57 offen sc1 lds
buffer_load_dwordx4 v0,s[8:11],s57 offen offset:1024 sc1 lds
s_lshl_b32 s75,s51,13
s_add_u32 s56,s75,13639680
buffer_load_dword v23,v10,s[8:11],s56 offen sc1
s_add_u32 s64,s75,17825792
s_add_u32 s70,s64,4096
s_lshl_b32 s68,s51,5
s_add_u32 s68,s68,s47
s_lshl_b32 s68,s68,12
s_lshl_b32 s56,s46,10
s_add_u32 s68,s68,s56
s_add_u32 s68,s68,75497472
s_mov_b32 s54,0x80000000
s_mov_b32 s77,0
s_mov_b32 s19,0
s_cmp_eq_u32 s51,63
s_cselect_b32 s76,1,s46
s_cmp_eq_u32 s76,0
s_cselect_b32 s76,1,0
v_mov_b64 v[96:97],0
v_mov_b64 v[98:99],0
v_mov_b64 v[100:101],0
v_mov_b64 v[102:103],0
v_mov_b64 v[104:105],0
v_mov_b64 v[106:107],0
v_mov_b64 v[108:109],0
v_mov_b64 v[110:111],0
v_mov_b64 v[112:113],0
v_mov_b64 v[114:115],0
v_mov_b64 v[116:117],0
v_mov_b64 v[118:119],0
v_lshrrev_b32 v56,8,v0
v_lshlrev_b32 v56,5,v56
v_bfe_u32 v57,v0,5,1
v_lshl_add_u32 v56,v57,2,v56
s_lshl_b32 s56,s46,7
s_add_u32 s56,s56,155648
v_add_u32 v56,s56,v56
v_xor_b32 v57,128,v56
v_xor_b32 v58,256,v56
v_xor_b32 v59,384,v56
s_andn2_b32 s56,31,s30
s_lshr_b32 s57,s56,4
s_lshl_b32 s58,s57,12
s_and_b32 s59,s56,15
s_lshl4_add_u32 s58,s59,s58
s_add_u32 s58,s58,s50
s_add_u32 s58,s58,131072
v_bfe_u32 v60,v0,6,2
v_lshlrev_b32 v60,8,v60
v_bfe_u32 v61,v0,4,2
v_lshl_add_u32 v60,v61,2,v60
v_add_u32 v60,s58,v60
s_lshr_b32 s58,s59,2
s_lshl_b32 s58,s58,8
s_lshl3_add_u32 s58,s57,s58
s_and_b32 s59,s56,3
s_lshl1_add_u32 s58,s59,s58
s_add_u32 s58,s58,s73
s_add_u32 s58,s58,139264
v_and_b32 v61,255,v0
v_add_u32 v61,s58,v61
s_cmp_lg_u32 s46,0
s_cbranch_scc1 L_chd_294
s_lshl_b32 s59,s51,10
s_add_u32 s59,s59,11337728
L_chp_293:
buffer_load_dwordx4 v[120:123],v0,s[8:11],s59 offen sc1
s_sub_u32 s49,s49,1
s_cbranch_scc1 L_abort2
s_waitcnt vmcnt(0)
v_max3_u32 v124,v120,v121,v122
v_max_u32 v124,v123,v124
v_cmp_eq_u32 vcc,-1,v124
s_cbranch_vccnz L_chp_293
ds_write_b128 v12,v[120:123]
L_chd_294:
s_waitcnt vmcnt(0) lgkmcnt(0)
s_barrier
ds_read2_b32 v[24:25],v56 offset0:0 offset1:2
ds_read2_b32 v[26:27],v56 offset0:4 offset1:6
ds_read2_b32 v[28:29],v57 offset0:0 offset1:2
ds_read2_b32 v[30:31],v57 offset0:4 offset1:6
ds_read2_b32 v[32:33],v58 offset0:0 offset1:2
ds_read2_b32 v[34:35],v58 offset0:4 offset1:6
ds_read2_b32 v[36:37],v59 offset0:0 offset1:2
ds_read2_b32 v[38:39],v59 offset0:4 offset1:6
s_waitcnt lgkmcnt(4)
ds_read2_b32 v[40:41],v56 offset0:128 offset1:130
ds_read2_b32 v[42:43],v56 offset0:132 offset1:134
ds_read2_b32 v[44:45],v57 offset0:128 offset1:130
ds_read2_b32 v[46:47],v57 offset0:132 offset1:134
ds_read2_b32 v[48:49],v58 offset0:128 offset1:130
ds_read2_b32 v[50:51],v58 offset0:132 offset1:134
ds_read2_b32 v[52:53],v59 offset0:128 offset1:130
ds_read2_b32 v[54:55],v59 offset0:132 offset1:134
s_waitcnt lgkmcnt(12)
v_smfmac_f32_16x16x64_bf16 v[100:103],v[24:27],a[128:135],v2
v_smfmac_f32_16x16x64_bf16 v[112:115],v[24:27],v[128:135],v2
v_smfmac_f32_16x16x64_bf16 v[108:111],v[24:27],a[136:143],v2
v_smfmac_f32_16x16x64_bf16 v[116:119],v[24:27],v[136:143],v2
s_waitcnt lgkmcnt(12)
v_smfmac_f32_16x16x64_bf16 v[100:103],v[28:31],a[144:151],v2
v_smfmac_f32_16x16x64_bf16 v[112:115],v[28:31],v[144:151],v2
v_smfmac_f32_16x16x64_bf16 v[108:111],v[28:31],a[152:159],v2
v_smfmac_f32_16x16x64_bf16 v[116:119],v[28:31],v[152:159],v2
s_waitcnt lgkmcnt(10)
v_smfmac_f32_16x16x64_bf16 v[100:103],v[32:35],a[160:167],v2
v_smfmac_f32_16x16x64_bf16 v[112:115],v[32:35],v[160:167],v2
v_smfmac_f32_16x16x64_bf16 v[108:111],v[32:35],a[168:175],v2
v_smfmac_f32_16x16x64_bf16 v[116:119],v[32:35],v[168:175],v2
s_waitcnt lgkmcnt(8)
v_smfmac_f32_16x16x64_bf16 v[100:103],v[36:39],a[176:183],v2
v_smfmac_f32_16x16x64_bf16 v[112:115],v[36:39],v[176:183],v2
v_smfmac_f32_16x16x64_bf16 v[108:111],v[36:39],a[184:191],v2
v_smfmac_f32_16x16x64_bf16 v[116:119],v[36:39],v[184:191],v2
s_waitcnt lgkmcnt(6)
v_smfmac_f32_16x16x64_bf16 v[100:103],v[40:43],a[192:199],v2
v_smfmac_f32_16x16x64_bf16 v[112:115],v[40:43],v[192:199],v2
v_smfmac_f32_16x16x64_bf16 v[108:111],v[40:43],a[200:207],v2
v_smfmac_f32_16x16x64_bf16 v[116:119],v[40:43],v[200:207],v2
s_waitcnt lgkmcnt(4)
v_smfmac_f32_16x16x64_bf16 v[100:103],v[44:47],a[208:215],v2
v_smfmac_f32_16x16x64_bf16 v[112:115],v[44:47],v[208:215],v2
v_smfmac_f32_16x16x64_bf16 v[108:111],v[44:47],a[216:223],v2
v_smfmac_f32_16x16x64_bf16 v[116:119],v[44:47],v[216:223],v2
s_waitcnt lgkmcnt(2)
v_smfmac_f32_16x16x64_bf16 v[100:103],v[48:51],a[224:231],v2
v_smfmac_f32_16x16x64_bf16 v[112:115],v[48:51],v[224:231],v2
v_smfmac_f32_16x16x64_bf16 v[108:111],v[48:51],a[232:239],v2
v_smfmac_f32_16x16x64_bf16 v[116:119],v[48:51],v[232:239],v2
s_waitcnt lgkmcnt(0)
v_smfmac_f32_16x16x64_bf16 v[100:103],v[52:55],a[240:247],v2
v_smfmac_f32_16x16x64_bf16 v[112:115],v[52:55],v[240:247],v2
v_smfmac_f32_16x16x64_bf16 v[108:111],v[52:55],a[248:255],v2
v_smfmac_f32_16x16x64_bf16 v[116:119],v[52:55],v[248:255],v2
v_add_f32 v100,v100,v102
v_add_f32 v112,v112,v114
s_nop 1
v_add_f32 v108,v108,v110
s_nop 2
v_add_f32 v116,v116,v118
v_cvt_pk_bf16_f32 v120,v100,v108
v_cvt_pk_bf16_f32 v121,v112,v116
ds_write_b32 v60,v120
ds_write_b16 v61,v121
ds_write_b16_d16_hi v61,v121 offset:1024
v_mov_b64 v[96:97],0
v_mov_b64 v[98:99],0
v_mov_b64 v[100:101],0
v_mov_b64 v[102:103],0
v_mov_b64 v[104:105],0
v_mov_b64 v[106:107],0
v_mov_b64 v[108:109],0
v_mov_b64 v[110:111],0
v_mov_b64 v[112:113],0
v_mov_b64 v[114:115],0
v_mov_b64 v[116:117],0
v_mov_b64 v[118:119],0
s_waitcnt vmcnt(0) lgkmcnt(0)
s_barrier
v_add_u32 v55,131072,v0
ds_read_b128 v[56:59],v55 offset:0
ds_read_b128 v[60:63],v55 offset:4096
ds_read_b128 v[64:67],v55 offset:1024
ds_read_b128 v[68:71],v55 offset:5120
ds_read_b128 v[72:75],v55 offset:2048
ds_read_b128 v[76:79],v55 offset:6144
ds_read_b128 v[80:83],v55 offset:3072
ds_read_b128 v[84:87],v55 offset:7168
v_add_u32 v123,s73,v55
ds_read_b128 v[88:91],v123 offset:8192
ds_read_b128 v[92:95],v123 offset:9216
v_xor_b32 v120,1024,v12
v_xor_b32 v121,2048,v12
v_xor_b32 v122,3072,v12
buffer_load_dwordx4 v[24:27],v13,s[8:11],s64 offen sc1
buffer_load_dwordx4 v[24:27],v13,s[8:11],s64 offen sc1
L_chain_295:
L_cpa_296:
buffer_load_dwordx4 v[24:27],v13,s[8:11],s64 offen sc1
s_sub_u32 s49,s49,1
s_cbranch_scc1 L_abort2
s_waitcnt vmcnt(2)
v_max3_u32 v123,v24,v25,v26
v_max_u32 v123,v27,v123
v_cmp_le_u32 vcc,s72,v123
ds_write_b128 v12,v[24:27] offset:0
s_cbranch_vccnz L_cpa_296
L_cgo_299:
v_smfmac_f32_16x16x64_bf16 v[96:99],v[24:27],a[0:7],v2
buffer_load_dwordx4 v[40:43],v13,s[8:11],s70 offen sc1
v_smfmac_f32_16x16x64_bf16 v[100:103],v[24:27],a[128:135],v2
s_waitcnt lgkmcnt(0)
s_barrier
ds_read_b128 v[28:31],v120 offset:0
v_smfmac_f32_16x16x64_bf16 v[104:107],v[24:27],a[8:15],v2
ds_read_b128 v[32:35],v121 offset:0
v_smfmac_f32_16x16x64_bf16 v[108:111],v[24:27],a[136:143],v2
ds_read_b128 v[36:39],v122 offset:0
v_smfmac_f32_16x16x64_bf16 v[112:115],v[24:27],v[128:135],v2
v_smfmac_f32_16x16x64_bf16 v[116:119],v[24:27],v[136:143],v2
s_waitcnt lgkmcnt(2)
v_smfmac_f32_16x16x64_bf16 v[96:99],v[28:31],a[16:23],v2
s_add_u32 m0,s73,131072
v_smfmac_f32_16x16x64_bf16 v[100:103],v[28:31],a[144:151],v2
s_add_u32 s57,s67,8192
v_smfmac_f32_16x16x64_bf16 v[104:107],v[28:31],a[24:31],v2
s_cmp_lt_u32 s19,s76
s_cbranch_scc1 L_ckw_285
L_ckb_286:
v_smfmac_f32_16x16x64_bf16 v[108:111],v[28:31],a[152:159],v2
s_waitcnt vmcnt(0) lgkmcnt(1)
v_smfmac_f32_16x16x64_bf16 v[96:99],v[32:35],a[32:39],v2
ds_write_b128 v12,v[40:43] offset:4096
v_max3_u32 v123,v40,v41,v42
v_smfmac_f32_16x16x64_bf16 v[100:103],v[32:35],a[160:167],v2
v_max_u32 v123,v43,v123
v_smfmac_f32_16x16x64_bf16 v[104:107],v[32:35],a[40:47],v2
v_cmp_le_u32 vcc,s72,v123
v_smfmac_f32_16x16x64_bf16 v[108:111],v[32:35],a[168:175],v2
v_smfmac_f32_16x16x64_bf16 v[112:115],v[28:31],v[144:151],v2
s_cbranch_vccnz L_cpb_302
L_cback_304:
s_waitcnt lgkmcnt(0)
s_barrier
v_smfmac_f32_16x16x64_bf16 v[96:99],v[36:39],a[48:55],v2
buffer_store_dwordx4 v[124:127],v0,s[8:11],s54 offen sc1
v_smfmac_f32_16x16x64_bf16 v[100:103],v[36:39],a[176:183],v2
ds_read_b128 v[44:47],v120 offset:4096
v_smfmac_f32_16x16x64_bf16 v[104:107],v[36:39],a[56:63],v2
buffer_load_dwordx4 v0,s[8:11],s67 offen sc1 lds
v_smfmac_f32_16x16x64_bf16 v[108:111],v[36:39],a[184:191],v2
ds_read_b128 v[48:51],v121 offset:4096
v_smfmac_f32_16x16x64_bf16 v[96:99],v[40:43],a[64:71],v2
buffer_load_dwordx4 v0,s[8:11],s67 offen offset:1024 sc1 lds
s_add_u32 m0,s73,139264
v_smfmac_f32_16x16x64_bf16 v[100:103],v[40:43],a[192:199],v2
ds_read_b128 v[52:55],v122 offset:4096
v_smfmac_f32_16x16x64_bf16 v[104:107],v[40:43],a[72:79],v2
buffer_load_dwordx4 v0,s[8:11],s57 offen sc1 lds
s_add_u32 s67,s67,786432
v_smfmac_f32_16x16x64_bf16 v[108:111],v[40:43],a[200:207],v2
ds_read_b32 v123,v8 offset:2560
s_waitcnt lgkmcnt(3)
v_smfmac_f32_16x16x64_bf16 v[96:99],v[44:47],a[80:87],v2
buffer_load_dwordx4 v0,s[8:11],s57 offen offset:1024 sc1 lds
v_smfmac_f32_16x16x64_bf16 v[100:103],v[44:47],a[208:215],v2
s_waitcnt lgkmcnt(2)
v_smfmac_f32_16x16x64_bf16 v[96:99],v[48:51],a[96:103],v2
buffer_load_dword v23,v22,s[8:11],s75 offen sc1
v_smfmac_f32_16x16x64_bf16 v[100:103],v[48:51],a[224:231],v2
s_waitcnt lgkmcnt(0)
v_smfmac_f32_16x16x64_bf16 v[96:99],v[52:55],a[112:119],v2
v_smfmac_f32_16x16x64_bf16 v[100:103],v[52:55],a[240:247],v2
v_readfirstlane_b32 s58,v123
v_smfmac_f32_16x16x64_bf16 v[104:107],v[44:47],a[88:95],v2
v_smfmac_f32_16x16x64_bf16 v[108:111],v[44:47],a[216:223],v2
s_cmp_lg_u32 s58,0
s_cbranch_scc1 L_cjump_288
v_smfmac_f32_16x16x64_bf16 v[104:107],v[48:51],a[104:111],v2
v_add_f32 v96,v96,v98
v_smfmac_f32_16x16x64_bf16 v[108:111],v[48:51],a[232:239],v2
v_add_f32 v97,v97,v99
v_smfmac_f32_16x16x64_bf16 v[104:107],v[52:55],a[120:127],v2
v_cvt_pk_bf16_f32 v120,v96,v97
v_smfmac_f32_16x16x64_bf16 v[108:111],v[52:55],a[248:255],v2
v_add_f32 v100,v100,v102
v_smfmac_f32_16x16x64_bf16 v[116:119],v[28:31],v[152:159],v2
v_add_f32 v101,v101,v103
v_smfmac_f32_16x16x64_bf16 v[112:115],v[32:35],v[160:167],v2
v_cvt_pk_bf16_f32 v121,v100,v101
v_add_f32 v104,v104,v106
v_add_f32 v105,v105,v107
v_cvt_pk_bf16_f32 v122,v104,v105
v_add_f32 v108,v108,v110
v_add_f32 v109,v109,v111
v_cvt_pk_bf16_f32 v123,v108,v109
ds_write_b128 v4,v[120:123]
v_smfmac_f32_16x16x64_bf16 v[116:119],v[32:35],v[168:175],v2
s_mov_b32 s54,s68
s_add_u32 s68,s68,131072
v_mov_b32 v125,0
v_smfmac_f32_16x16x64_bf16 v[112:115],v[36:39],v[176:183],v2
s_cmp_eq_u32 s51,63
s_cbranch_scc1 L_cend_298
v_smfmac_f32_16x16x64_bf16 v[116:119],v[36:39],v[184:191],v2
v_smfmac_f32_16x16x64_bf16 v[112:115],v[40:43],v[192:199],v2
s_waitcnt lgkmcnt(0)
s_barrier
ds_read_b64_tr_b16 v[96:97],v5 offset:0
ds_read_b64_tr_b16 v[98:99],v6 offset:0
v_smfmac_f32_16x16x64_bf16 v[116:119],v[40:43],v[200:207],v2
ds_read_b64_tr_b16 v[100:101],v5 offset:1024
v_smfmac_f32_16x16x64_bf16 v[112:115],v[44:47],v[208:215],v2
ds_read_b64_tr_b16 v[102:103],v6 offset:1024
v_smfmac_f32_16x16x64_bf16 v[116:119],v[44:47],v[216:223],v2
ds_read_b64_tr_b16 v[104:105],v5 offset:2048
v_smfmac_f32_16x16x64_bf16 v[112:115],v[48:51],v[224:231],v2
ds_read_b64_tr_b16 v[106:107],v6 offset:2048
s_waitcnt lgkmcnt(4)
v_mfma_f32_16x16x32_bf16 v[24:27],v[56:59],v[96:99],0
ds_read_b64_tr_b16 v[108:109],v5 offset:3072
v_mfma_f32_16x16x32_bf16 v[28:31],v[60:63],v[96:99],0
ds_read_b64_tr_b16 v[110:111],v6 offset:3072
v_mfma_f32_16x16x32_bf16 v[32:35],v[96:99],v[96:99],0
ds_read_b128 v[40:43],v11 offset:12288
s_waitcnt lgkmcnt(5)
v_mfma_f32_16x16x32_bf16 v[24:27],v[64:67],v[100:103],v[24:27]
ds_read_b128 v[56:59],v11 offset:0
v_mfma_f32_16x16x32_bf16 v[28:31],v[68:71],v[100:103],v[28:31]
ds_read_b128 v[60:63],v11 offset:1024
v_mfma_f32_16x16x32_bf16 v[32:35],v[100:103],v[100:103],v[32:35]
ds_read_b128 v[96:99],v11 offset:8192
s_waitcnt lgkmcnt(6)
v_mfma_f32_16x16x32_bf16 v[24:27],v[72:75],v[104:107],v[24:27]
ds_read_b128 v[64:67],v11 offset:2048
v_mfma_f32_16x16x32_bf16 v[28:31],v[76:79],v[104:107],v[28:31]
ds_read_b128 v[68:71],v11 offset:3072
v_mfma_f32_16x16x32_bf16 v[32:35],v[104:107],v[104:107],v[32:35]
ds_read_b128 v[100:103],v11 offset:9216
s_waitcnt lgkmcnt(7)
v_mfma_f32_16x16x32_bf16 v[24:27],v[80:83],v[108:111],v[24:27]
ds_read_b128 v[72:75],v11 offset:4096
v_mfma_f32_16x16x32_bf16 v[28:31],v[84:87],v[108:111],v[28:31]
ds_read_b128 v[76:79],v11 offset:5120
v_mfma_f32_16x16x32_bf16 v[32:35],v[108:111],v[108:111],v[32:35]
ds_read_b128 v[104:107],v11 offset:10240
v_smfmac_f32_16x16x64_bf16 v[116:119],v[48:51],v[232:239],v2
ds_read_b128 v[80:83],v11 offset:6144
v_smfmac_f32_16x16x64_bf16 v[112:115],v[52:55],v[240:247],v2
ds_read_b128 v[84:87],v11 offset:7168
v_smfmac_f32_16x16x64_bf16 v[116:119],v[52:55],v[248:255],v2
ds_read_b128 v[108:111],v11 offset:11264
v_max3_f32 v126,v24,v25,v26
v_max3_f32 v127,v27,v28,v29
v_max3_f32 v126,v30,v31,v126
v_max3_f32 v127,v34,v35,v127
v_max_f32 v126,v126,v127
v_max_f32 v127,v126,v127
v_pk_mul_f32 v[34:35],v[34:35],v[0:1] op_sel:[0,1]
v_pk_mul_f32 v[24:25],v[24:25],v[0:1] op_sel:[0,1]
v_permlane16_swap_b32 v126,v127
v_max_f32 v126,v126,v127
v_max_f32 v127,v126,v127
v_pk_mul_f32 v[26:27],v[26:27],v[0:1] op_sel:[0,1]
v_pk_mul_f32 v[28:29],v[28:29],v[0:1] op_sel:[0,1]
v_permlane32_swap_b32 v126,v127
v_max_f32 v126,v126,v127
v_mul_f32 v126,v1,v126
v_pk_mul_f32 v[30:31],v[30:31],v[0:1] op_sel:[0,1]
v_pk_add_f32 v[34:35],v[34:35],v[126:127] op_sel_hi:[1,0] neg_lo:[0,1] neg_hi:[0,1]
v_pk_add_f32 v[112:113],v[112:113],v[114:115]
v_pk_add_f32 v[116:117],v[116:117],v[118:119]
v_pk_add_f32 v[24:25],v[24:25],v[126:127] op_sel_hi:[1,0] neg_lo:[0,1] neg_hi:[0,1]
v_pk_add_f32 v[26:27],v[26:27],v[126:127] op_sel_hi:[1,0] neg_lo:[0,1] neg_hi:[0,1]
v_pk_add_f32 v[28:29],v[28:29],v[126:127] op_sel_hi:[1,0] neg_lo:[0,1] neg_hi:[0,1]
v_pk_add_f32 v[30:31],v[30:31],v[126:127] op_sel_hi:[1,0] neg_lo:[0,1] neg_hi:[0,1]
v_exp_f32 v34,v34
v_exp_f32 v35,v35
v_cvt_pk_bf16_f32 v126,v112,v113
v_cvt_pk_bf16_f32 v124,v34,v35
v_cvt_pk_bf16_f32 v127,v116,v117
v_cvt_pk_bf16_f32 v36,v116,v117
v_mfma_f32_16x16x16_bf16 v[32:35],v[14:15],v[124:125],0
ds_read_b128 v[44:47],v11 offset:13312
v_exp_f32 v24,v24
v_mfma_f32_16x16x16_bf16 v[112:115],v[126:127],v[124:125],0
ds_read_b128 v[48:51],v11 offset:14336
v_exp_f32 v25,v25
v_mfma_f32_16x16x16_bf16 v[116:119],v[36:37],v[124:125],0
ds_read_b128 v[52:55],v11 offset:15360
v_exp_f32 v26,v26
v_exp_f32 v27,v27
v_cvt_pk_bf16_f32 v120,v24,v25
v_exp_f32 v28,v28
v_exp_f32 v29,v29
v_cvt_pk_bf16_f32 v121,v26,v27
v_exp_f32 v30,v30
v_exp_f32 v31,v31
v_cvt_pk_bf16_f32 v122,v28,v29
v_cvt_pk_bf16_f32 v123,v30,v31
s_add_u32 s75,s75,8192
s_add_u32 s51,s51,1
v_mfma_f32_16x16x32_bf16 v[32:35],v[14:17],v[120:123],v[32:35]
v_mfma_f32_16x16x32_bf16 v[112:115],v[88:91],v[120:123],v[112:115]
ds_read_b128 v[88:91],v11 offset:16384
v_mfma_f32_16x16x32_bf16 v[116:119],v[92:95],v[120:123],v[116:119]
ds_read_b128 v[92:95],v11 offset:17408
v_rcp_f32 v32,v32
v_mov_b64 v[24:25],-1
v_mov_b64 v[26:27],-1
s_add_u32 s64,s75,13631488
s_add_u32 s70,s64,4096
v_pk_mul_f32 v[112:113],v[112:113],v[32:33] op_sel_hi:[1,0]
v_pk_mul_f32 v[114:115],v[114:115],v[32:33] op_sel_hi:[1,0]
v_pk_mul_f32 v[116:117],v[116:117],v[32:33] op_sel_hi:[1,0]
v_pk_mul_f32 v[118:119],v[118:119],v[32:33] op_sel_hi:[1,0]
v_cvt_pk_bf16_f32 v120,v112,v116
v_cvt_pk_bf16_f32 v121,v113,v117
v_cvt_pk_bf16_f32 v122,v114,v118
v_cvt_pk_bf16_f32 v123,v115,v119
ds_write_b128 v7,v[120:123]
buffer_store_dwordx4 v[24:27],v0,s[8:11],s69 offen sc1
buffer_store_dwordx4 v[24:27],v0,s[8:11],s69 offen offset:1024 sc1
v_mov_b64 v[112:113],0
v_mov_b64 v[114:115],0
v_mov_b64 v[116:117],0
v_mov_b64 v[118:119],0
s_waitcnt lgkmcnt(0)
s_barrier
ds_read_b128 v[24:27],v8 offset:0
ds_read_b128 v[28:31],v8 offset:512
ds_read_b128 v[32:35],v8 offset:1024
ds_read_b128 v[36:39],v8 offset:1536
v_mov_b64 v[120:121],0
v_mov_b64 v[122:123],0
s_add_u32 s57,s65,65536
s_add_u32 s58,s65,131072
s_add_u32 s59,s65,196608
s_add_u32 s56,s18,s75
s_waitcnt lgkmcnt(3)
v_smfmac_f32_16x16x64_bf16 v[112:115],v[24:27],v[56:63],v3
ds_read_b128 v[56:59],v11 offset:18432
s_waitcnt lgkmcnt(3)
v_smfmac_f32_16x16x64_bf16 v[112:115],v[28:31],v[64:71],v3
ds_read_b128 v[60:63],v11 offset:19456
s_waitcnt lgkmcnt(3)
v_smfmac_f32_16x16x64_bf16 v[112:115],v[32:35],v[72:79],v3
ds_read_b128 v[64:67],v11 offset:20480
s_waitcnt lgkmcnt(3)
v_smfmac_f32_16x16x64_bf16 v[112:115],v[36:39],v[80:87],v3
ds_read_b128 v[68:71],v11 offset:21504
v_smfmac_f32_16x16x64_bf16 v[116:119],v[24:27],v[96:103],v3
ds_read_b128 v[72:75],v11 offset:22528
v_smfmac_f32_16x16x64_bf16 v[116:119],v[28:31],v[104:111],v3
ds_read_b128 v[76:79],v11 offset:23552
v_cvt_pk_bf16_f32 v112,v112,v113
v_smfmac_f32_16x16x64_bf16 v[116:119],v[32:35],v[40:47],v3
ds_read_b128 v[80:83],v11 offset:24576
v_cvt_pk_bf16_f32 v113,v114,v115
buffer_store_dwordx2 v[112:113],v9,s[8:11],s65 offen sc1
v_smfmac_f32_16x16x64_bf16 v[116:119],v[36:39],v[48:55],v3
ds_read_b128 v[84:87],v11 offset:25600
v_mov_b64 v[112:113],0
v_smfmac_f32_16x16x64_bf16 v[120:123],v[24:27],v[88:95],v3
ds_read_b128 v[96:99],v11 offset:26624
ds_read_b128 v[100:103],v11 offset:27648
v_mov_b64 v[114:115],0
s_waitcnt lgkmcnt(8)
v_smfmac_f32_16x16x64_bf16 v[120:123],v[28:31],v[56:63],v3
ds_read_b128 v[104:107],v11 offset:28672
v_cvt_pk_bf16_f32 v116,v116,v117
s_waitcnt lgkmcnt(7)
v_smfmac_f32_16x16x64_bf16 v[120:123],v[32:35],v[64:71],v3
ds_read_b128 v[108:111],v11 offset:29696
ds_read_b128 v[40:43],v11 offset:30720
v_cvt_pk_bf16_f32 v117,v118,v119
buffer_store_dwordx2 v[116:117],v9,s[8:11],s57 offen sc1
s_waitcnt lgkmcnt(7)
v_smfmac_f32_16x16x64_bf16 v[120:123],v[36:39],v[72:79],v3
ds_read_b128 v[44:47],v11 offset:31744
v_add_u32 v52,s50,v5
s_waitcnt lgkmcnt(6)
v_smfmac_f32_16x16x64_bf16 v[112:115],v[24:27],v[80:87],v3
v_add_u32 v54,s50,v6
s_waitcnt lgkmcnt(4)
v_smfmac_f32_16x16x64_bf16 v[112:115],v[28:31],v[96:103],v3
ds_read_b64_tr_b16 v[52:53],v52
v_cvt_pk_bf16_f32 v120,v120,v121
s_waitcnt lgkmcnt(3)
v_smfmac_f32_16x16x64_bf16 v[112:115],v[32:35],v[104:111],v3
ds_read_b64_tr_b16 v[54:55],v54
v_cvt_pk_bf16_f32 v121,v122,v123
buffer_store_dwordx2 v[120:121],v9,s[8:11],s58 offen sc1
s_waitcnt lgkmcnt(2)
v_smfmac_f32_16x16x64_bf16 v[112:115],v[36:39],v[40:47],v3
v_mov_b64 v[116:117],0
v_mov_b64 v[118:119],0
s_xor_b32 s65,s65,262144
v_mov_b32_dpp v124,v126 quad_perm:[2,3,2,3] row_mask:0xf bank_mask:0xf
v_mov_b32_dpp v125,v127 quad_perm:[2,3,2,3] row_mask:0xf bank_mask:0xf
s_mov_b32 vcc_lo,0xcccccccc
s_mov_b32 vcc_hi,0xcccccccc
s_nop 0
v_cvt_pk_bf16_f32 v112,v112,v113
v_cvt_pk_bf16_f32 v113,v114,v115
buffer_store_dwordx2 v[112:113],v9,s[8:11],s59 offen sc1
s_waitcnt lgkmcnt(0)
s_buffer_load_dword s19,s[8:11],s56
v_cndmask_b32 v124,v124,v52,vcc
v_cndmask_b32 v125,v125,v53,vcc
v_cndmask_b32 v126,v126,v54,vcc
v_cndmask_b32 v127,v127,v55,vcc
s_cmp_lt_u32 s46,2
s_waitcnt vmcnt(3)
s_cbranch_scc1 L_crg_305
s_cmp_eq_u32 s46,2
s_waitcnt vmcnt(1)
s_cbranch_scc1 L_crg_305
s_waitcnt vmcnt(0)
L_crg_305:
buffer_load_dwordx4 v[32:35],v0,s[8:11],s66 offen offset:0 sc1
buffer_load_dwordx4 v[36:39],v0,s[8:11],s66 offen offset:1024 sc1
v_mov_b64 v[96:97],0
v_mov_b64 v[98:99],0
v_mov_b64 v[100:101],0
v_mov_b64 v[102:103],0
v_mov_b64 v[104:105],0
v_mov_b64 v[106:107],0
v_mov_b64 v[108:109],0
v_mov_b64 v[110:111],0
v_mov_b64 v[112:113],0
v_mov_b64 v[114:115],0
v_add_u32 v55,131072,v0
v_add_u32 v123,s73,v55
v_xor_b32 v120,1024,v12
v_xor_b32 v121,2048,v12
v_xor_b32 v122,3072,v12
buffer_load_dwordx4 v[44:47],v0,s[8:11],s66 offen offset:0 sc1
buffer_load_dwordx4 v[48:51],v0,s[8:11],s66 offen offset:1024 sc1
s_cmp_ge_u32 s51,63
s_cselect_b32 s76,0,1
v_readlane_b32 s56,v23,5
v_readlane_b32 s20,v23,4
v_add_u32 v23,-1,v23
v_cmp_le_u32 vcc,s30,v23
s_cmp_gt_u32 s51,61
s_cselect_b32 s77,0,vcc_hi
s_cmp_gt_u32 s20,s30
s_cselect_b32 s77,1,s77
s_cmp_lg_u32 s77,0
s_cselect_b32 s76,2,s76
s_cmp_gt_u32 s56,s30
s_cbranch_scc1 L_cld_281
L_clb_282:
s_cmp_eq_u32 s46,0
s_cselect_b32 s76,s76,0
s_waitcnt vmcnt(3)
v_mfma_f32_16x16x32_bf16 v[28:31],v[18:21],v[32:35],0
s_waitcnt vmcnt(2)
v_mfma_f32_16x16x32_bf16 v[28:31],v[18:21],v[36:39],v[28:31]
s_nop 7
v_cmp_u_f32 vcc,v28,v28
v_add_f32_dpp v52,v28,v28 row_ror:8 row_mask:0xf bank_mask:0x3
v_add_f32_dpp v53,v29,v29 row_ror:8 row_mask:0xf bank_mask:0x3
v_add_f32_dpp v52,v30,v30 row_ror:8 row_mask:0xf bank_mask:0xc
v_add_f32_dpp v53,v31,v31 row_ror:8 row_mask:0xf bank_mask:0xc
s_nop 0
v_add_f32_dpp v52,v52,v52 row_shl:4 row_mask:0xf bank_mask:0x5
v_add_f32_dpp v53,v53,v53 row_shl:4 row_mask:0xf bank_mask:0x5
s_cbranch_vccnz L_crp_300
L_cok_306:
v_cvt_pk_bf16_f32 v54,v52,v53
buffer_store_dword v54,v10,s[8:11],s64 offen sc1
s_mov_b32 s69,s66
s_xor_b32 s66,s66,262144
s_barrier
ds_read_b128 v[56:59],v55 offset:0
ds_read_b128 v[60:63],v55 offset:4096
ds_read_b128 v[64:67],v55 offset:1024
buffer_load_dwordx4 v[24:27],v13,s[8:11],s64 offen sc1
ds_read_b128 v[68:71],v55 offset:5120
ds_read_b128 v[72:75],v55 offset:2048
ds_read_b128 v[76:79],v55 offset:6144
ds_read_b128 v[80:83],v55 offset:3072
buffer_load_dwordx4 v[24:27],v13,s[8:11],s64 offen sc1
ds_read_b128 v[84:87],v55 offset:7168
ds_read_b128 v[88:91],v123 offset:8192
ds_read_b128 v[92:95],v123 offset:9216
s_branch L_chain_295
L_cpb_302:
buffer_load_dwordx4 v[40:43],v13,s[8:11],s70 offen sc1
s_sub_u32 s49,s49,1
s_cbranch_scc1 L_abort2
s_waitcnt vmcnt(0)
v_max3_u32 v123,v40,v41,v42
v_max_u32 v123,v43,v123
v_cmp_le_u32 vcc,s72,v123
s_cbranch_vccnz L_cpb_302
ds_write_b128 v12,v[40:43] offset:4096
s_branch L_cback_304
L_crp_300:
buffer_load_dwordx4 v[32:35],v0,s[8:11],s66 offen offset:0 sc1
buffer_load_dwordx4 v[36:39],v0,s[8:11],s66 offen offset:1024 sc1
s_sub_u32 s49,s49,1
s_cbranch_scc1 L_abort2
s_waitcnt vmcnt(3)
v_mfma_f32_16x16x32_bf16 v[28:31],v[18:21],v[44:47],0
s_waitcnt vmcnt(2)
v_mfma_f32_16x16x32_bf16 v[28:31],v[18:21],v[48:51],v[28:31]
s_nop 7
v_cmp_u_f32 vcc,v28,v28
v_add_f32_dpp v52,v28,v28 row_ror:8 row_mask:0xf bank_mask:0x3
v_add_f32_dpp v53,v29,v29 row_ror:8 row_mask:0xf bank_mask:0x3
v_add_f32_dpp v52,v30,v30 row_ror:8 row_mask:0xf bank_mask:0xc
v_add_f32_dpp v53,v31,v31 row_ror:8 row_mask:0xf bank_mask:0xc
s_nop 0
v_add_f32_dpp v52,v52,v52 row_shl:4 row_mask:0xf bank_mask:0x5
v_add_f32_dpp v53,v53,v53 row_shl:4 row_mask:0xf bank_mask:0x5
s_cbranch_vccz L_cok_306
buffer_load_dwordx4 v[44:47],v0,s[8:11],s66 offen offset:0 sc1
buffer_load_dwordx4 v[48:51],v0,s[8:11],s66 offen offset:1024 sc1
s_sub_u32 s49,s49,1
s_cbranch_scc1 L_abort2
s_waitcnt vmcnt(3)
v_mfma_f32_16x16x32_bf16 v[28:31],v[18:21],v[32:35],0
s_waitcnt vmcnt(2)
v_mfma_f32_16x16x32_bf16 v[28:31],v[18:21],v[36:39],v[28:31]
s_nop 7
v_cmp_u_f32 vcc,v28,v28
v_add_f32_dpp v52,v28,v28 row_ror:8 row_mask:0xf bank_mask:0x3
v_add_f32_dpp v53,v29,v29 row_ror:8 row_mask:0xf bank_mask:0x3
v_add_f32_dpp v52,v30,v30 row_ror:8 row_mask:0xf bank_mask:0xc
v_add_f32_dpp v53,v31,v31 row_ror:8 row_mask:0xf bank_mask:0xc
s_nop 0
v_add_f32_dpp v52,v52,v52 row_shl:4 row_mask:0xf bank_mask:0x5
v_add_f32_dpp v53,v53,v53 row_shl:4 row_mask:0xf bank_mask:0x5
s_cbranch_vccz L_cok_306
s_branch L_crp_300
L_ckw_285:
s_cmp_eq_u32 s77,0
s_cbranch_scc1 L_cjw_287
s_andn2_b32 s31,0x7ff,s20
s_lshr_b32 s31,s31,5
s_cmp_gt_u32 s20,s30
s_cbranch_scc1 L_cjs_283
s_add_u32 s31,s51,2
s_lshl_b32 s59,s31,13
s_add_u32 s59,s59,10486016
v_lshrrev_b32 v45,2,v0
v_and_b32 v45,127,v45
L_ckk_307:
s_sleep 1
buffer_load_dword v44,v45,s[8:11],s59 offen sc1
s_sub_u32 s49,s49,1
s_cbranch_scc1 L_abort2
s_waitcnt vmcnt(0)
v_cmp_eq_u32 vcc,0,v44
s_cbranch_vccnz L_ckk_307
v_cmp_lt_u32 vcc,s30,v44
s_cbranch_vccz L_cjw_287
L_cjs_283:
ds_write_b32 v8,v2 offset:2560
s_waitcnt lgkmcnt(0)
s_branch L_ckb_286
L_cld_281:
v_mov_b32 v23,s56
s_add_u32 s56,s75,10495616
buffer_store_dword v23,off,s[8:11],s56 sc1
s_waitcnt vmcnt(0)
s_branch L_clb_282
L_cjw_287:
s_cmp_lg_u32 s19,0
s_cbranch_scc1 L_ckb_286
s_add_u32 s59,s18,s75
L_ww_308:
s_sleep 1
buffer_load_dword v23,off,s[8:11],s59 sc1
s_sub_u32 s49,s49,1
s_cbranch_scc1 L_abort2
s_waitcnt vmcnt(0)
v_readfirstlane_b32 s76,v23
s_cmp_eq_u32 s76,0
s_cbranch_scc1 L_ww_308
L_wwd_309:
s_branch L_ckb_286
L_cjump_288:
s_waitcnt vmcnt(0) lgkmcnt(0)
s_barrier
s_branch L_cst_284
L_cend_298:
v_smfmac_f32_16x16x64_bf16 v[116:119],v[36:39],v[184:191],v2
v_smfmac_f32_16x16x64_bf16 v[112:115],v[40:43],v[192:199],v2
v_smfmac_f32_16x16x64_bf16 v[116:119],v[40:43],v[200:207],v2
v_smfmac_f32_16x16x64_bf16 v[112:115],v[44:47],v[208:215],v2
v_smfmac_f32_16x16x64_bf16 v[116:119],v[44:47],v[216:223],v2
v_smfmac_f32_16x16x64_bf16 v[112:115],v[48:51],v[224:231],v2
v_smfmac_f32_16x16x64_bf16 v[116:119],v[48:51],v[232:239],v2
v_smfmac_f32_16x16x64_bf16 v[112:115],v[52:55],v[240:247],v2
v_smfmac_f32_16x16x64_bf16 v[116:119],v[52:55],v[248:255],v2
s_waitcnt lgkmcnt(0)
s_nop 2
v_pk_add_f32 v[112:113],v[112:113],v[114:115]
s_nop 2
v_pk_add_f32 v[116:117],v[116:117],v[118:119]
v_cvt_pk_bf16_f32 v126,v112,v113
v_cvt_pk_bf16_f32 v127,v116,v117
v_add_u32 v52,s50,v5
v_add_u32 v54,s50,v6
ds_read_b64_tr_b16 v[52:53],v52
ds_read_b64_tr_b16 v[54:55],v54
v_mov_b32_dpp v124,v126 quad_perm:[2,3,2,3] row_mask:0xf bank_mask:0xf
v_mov_b32_dpp v125,v127 quad_perm:[2,3,2,3] row_mask:0xf bank_mask:0xf
s_mov_b32 vcc_lo,0xcccccccc
s_mov_b32 vcc_hi,0xcccccccc
s_waitcnt lgkmcnt(0)
v_cndmask_b32 v124,v124,v52,vcc
v_cndmask_b32 v125,v125,v53,vcc
v_cndmask_b32 v126,v126,v54,vcc
v_cndmask_b32 v127,v127,v55,vcc
buffer_store_dwordx4 v[124:127],v0,s[8:11],s54 offen sc1
s_mov_b32 s51,64
s_waitcnt vmcnt(0)
s_barrier
s_nop 11
v_lshrrev_b32 v1,4,v0
s_endpgm
L_wa:
s_nop 11
v_and_b32 v238,15,v1
v_and_b32 v239,1,v1
v_lshlrev_b32 v239,4,v239
v_mov_b32 v240,0x3f80
v_lshlrev_b32 v240,v239,v240
v_lshrrev_b32 v238,1,v238
v_cmp_eq_u32 vcc,0,v238
s_nop 1
v_cndmask_b32 v156,0,v240,vcc
v_cmp_eq_u32 vcc,1,v238
s_nop 1
v_cndmask_b32 v157,0,v240,vcc
v_cmp_eq_u32 vcc,2,v238
s_nop 1
v_cndmask_b32 v158,0,v240,vcc
v_cmp_eq_u32 vcc,3,v238
s_nop 1
v_cndmask_b32 v159,0,v240,vcc
s_mov_b32 s4,s32
s_mov_b32 s5,s33
s_mov_b32 s6,1024
s_mov_b32 s7,0x20000
buffer_load_dwordx4 v[224:227],v0,s[4:7],0 offen
v_and_b32 v238,15,v1
v_lshrrev_b32 v239,4,v1
v_lshlrev_b32 v240,2,v239
v_mov_b32 v241,0xf149f2ca
s_and_b32 s56,s46,1
s_lshl_b32 s56,s56,4
v_add_u32 v242,s56,v238
v_add_u32 v243,0,v240
v_cmp_gt_u32 vcc,v243,v242
s_nop 1
v_cndmask_b32 v8,0,v241,vcc
v_add_u32 v243,1,v240
v_cmp_gt_u32 vcc,v243,v242
s_nop 1
v_cndmask_b32 v9,0,v241,vcc
v_add_u32 v243,2,v240
v_cmp_gt_u32 vcc,v243,v242
s_nop 1
v_cndmask_b32 v10,0,v241,vcc
v_add_u32 v243,3,v240
v_cmp_gt_u32 vcc,v243,v242
s_nop 1
v_cndmask_b32 v11,0,v241,vcc
v_add_u32 v243,16,v240
v_cmp_gt_u32 vcc,v243,v242
s_nop 1
v_cndmask_b32 v12,0,v241,vcc
v_add_u32 v243,17,v240
v_cmp_gt_u32 vcc,v243,v242
s_nop 1
v_cndmask_b32 v13,0,v241,vcc
v_add_u32 v243,18,v240
v_cmp_gt_u32 vcc,v243,v242
s_nop 1
v_cndmask_b32 v14,0,v241,vcc
v_add_u32 v243,19,v240
v_cmp_gt_u32 vcc,v243,v242
s_nop 1
v_cndmask_b32 v15,0,v241,vcc
v_mov_b32 v152,s80
v_mov_b32 v145,0
v_mov_b32 v146,0
s_lshl_b32 s56,s46,12
s_add_u32 s56,s56,131072
v_add_u32 v3,s56,v0
v_add_u32 v4,131072,v0
s_lshl_b32 s56,s46,8
v_lshlrev_b32 v7,4,v238
v_add_u32 v7,s56,v7
v_lshl_add_u32 v5,v239,16,v7
v_lshlrev_b32 v6,1,v7
v_lshl_add_u32 v7,v239,10,v7
v_and_b32 v243,1,v239
v_lshl_add_u32 v6,v243,4,v6
v_lshrrev_b32 v243,1,v239
v_lshl_add_u32 v6,v243,12,v6
v_add_u32 v6,147456,v6
v_lshlrev_b32 v16,2,v1
v_lshlrev_b32 v21,3,v238
s_and_b32 s68,s47,15
s_lshl_b32 s56,s68,10
v_add_u32 v5,s56,v5
s_lshl_b32 s56,s68,15
v_add_u32 v7,s56,v7
s_lshl_b32 s69,s54,20
s_add_u32 s69,s69,20971520
s_lshl_b32 s87,s54,13
s_add_u32 s87,s87,10486272
s_lshl4_add_u32 s74,s68,s87
s_lshl2_add_u32 s74,s46,s74
s_lshl_b32 s68,s68,1
s_lshr_b32 s56,s46,1
s_add_u32 s68,s68,s56
s_mov_b32 s66,0
s_mov_b32 s67,0
s_mov_b32 s73,0x80000000
s_mov_b32 s75,0
s_mov_b32 s37,0
s_mov_b32 s42,4294966272
s_mov_b32 s43,4294967295
s_mov_b64 s[38:39],0
s_sub_u32 s36,s54,12
s_and_b32 s36,s36,3
s_mov_b32 s12,s40
s_mov_b32 s13,s41
s_mov_b32 s14,2097152
s_mov_b32 s15,0x20000
s_and_b32 s29,s46,1
s_mul_i32 s28,s29,12288
s_lshl_b32 s29,s29,11
s_and_b32 s56,s50,2048
s_lshl_b32 s56,s56,4
s_add_u32 s56,s56,65536
s_add_u32 s40,s56,s28
s_add_u32 s41,s56,s29
v_add_u32 v21,10487168,v21
v_mov_b32 v244,v21
s_and_b32 s56,s50,2048
s_add_u32 s56,s56,147456
v_lshlrev_b32 v23,5,v1
v_add_u32 v23,s56,v23
v_and_b32 v253,32,v0
v_lshrrev_b32 v245,2,v253
v_add_u32 v253,v253,v245
v_sub_u32 v253,v0,v253
v_add_u32 v253,8,v253
v_mov_b32 v254,0x80000000
s_mov_b32 s56,1408
v_writelane_b32 v254,s56,0
s_mov_b32 s56,256
v_writelane_b32 v254,s56,1
s_mov_b32 s56,1280
v_writelane_b32 v254,s56,2
v_mov_b32 v245,155648
s_lshl_b32 s56,s46,2
v_add_u32 v247,s56,v245
s_waitcnt vmcnt(0)
v_lshlrev_b32 v228,16,v224
v_and_b32 v229,0xffff0000,v224
v_lshlrev_b32 v230,16,v225
v_and_b32 v231,0xffff0000,v225
v_lshlrev_b32 v232,16,v226
v_and_b32 v233,0xffff0000,v226
v_lshlrev_b32 v234,16,v227
v_and_b32 v235,0xffff0000,v227
v_mul_f32 v255,v228,v228
v_fma_f32 v255,v229,v229,v255
v_fma_f32 v255,v230,v230,v255
v_fma_f32 v255,v231,v231,v255
v_fma_f32 v255,v232,v232,v255
v_fma_f32 v255,v233,v233,v255
v_fma_f32 v255,v234,v234,v255
v_fma_f32 v255,v235,v235,v255
s_nop 1
v_add_f32_dpp v255,v255,v255 row_ror:8 row_mask:0xf bank_mask:0xf
s_nop 1
v_add_f32_dpp v255,v255,v255 row_ror:4 row_mask:0xf bank_mask:0xf
s_nop 1
v_add_f32_dpp v255,v255,v255 row_ror:2 row_mask:0xf bank_mask:0xf
s_nop 1
v_add_f32_dpp v255,v255,v255 row_ror:1 row_mask:0xf bank_mask:0xf
v_mov_b32 v238,v255
s_nop 1
v_permlane16_swap_b32 v255,v238
v_add_f32 v255,v255,v238
v_mov_b32 v238,v255
s_nop 1
v_permlane32_swap_b32 v255,v238
v_add_f32 v255,v255,v238
v_sqrt_f32 v255,v255
v_sub_u32 v238,68,v1
v_cvt_f32_u32 v238,v238
v_log_f32 v238,v238
v_mov_b32 v239,0x3ff9999a
v_fmac_f32 v239,0x3e632166,v238
v_mul_f32 v255,v255,v239
v_or_b32 v255,0x80000000,v255
s_cmp_lt_u32 s54,2
s_cbranch_scc1 L_aa_310
s_sub_u32 s77,s54,2
s_mov_b32 s30,0
s_mov_b32 s86,1536
s_lshl_b32 s56,s77,5
s_add_u32 s56,s56,s68
s_mul_i32 s70,s56,24576
s_lshl_b32 s71,s56,12
s_lshl_b32 s59,s77,13
s_lshl2_add_u32 s59,s68,s59
s_add_u32 s59,s59,10485760
s_buffer_load_dword s32,s[8:11],s59
s_mov_b32 s33,1
s_add_u32 s70,s70,100663296
s_add_u32 s71,s71,41943040
v_mov_b32 v19,s59
s_branch L_aa_318
L_aa_324:
s_bitcmp1_b32 s46,0
s_cbranch_scc1 L_av_325
ds_read_b128 v[24:27],v4 offset:0
ds_read_b128 v[28:31],v4 offset:1024
s_min_u32 s56,s32,s33
s_cmp_lt_u32 s77,64
s_cselect_b32 s56,s56,0
s_cmp_eq_u32 s56,0
s_cselect_b32 s72,0x80000000,0
v_mov_b32 v248,s72
s_or_b32 s64,s70,s72
s_or_b32 s65,s71,s72
s_cmp_lt_u32 s30,s31
s_cselect_b32 s65,0x80000000,s65
s_add_u32 s64,s64,s28
s_add_u32 s65,s65,s29
s_xor_b32 s58,s67,s40
s_xor_b32 s57,s67,s41
s_add_u32 m0,s58,0
s_waitcnt lgkmcnt(1)
v_mfma_f32_16x16x32_bf16 v[160:163],v[24:27],a[0:3],0
buffer_load_dwordx4 v0,s[8:11],s64 offen offset:0 sc1 lds
v_mfma_f32_16x16x32_bf16 v[164:167],v[24:27],a[4:7],0
ds_read_b128 v[32:35],v4 offset:2048
v_lshlrev_b32 v88,16,v224
v_mfma_f32_16x16x32_bf16 v[168:171],v[24:27],a[8:11],0
ds_read_b128 v[36:39],v4 offset:3072
v_and_b32 v89,0xffff0000,v224
v_mfma_f32_16x16x32_bf16 v[172:175],v[24:27],a[12:15],0
ds_read_b128 v[40:43],v4 offset:8192
v_lshlrev_b32 v90,16,v225
v_mfma_f32_16x16x32_bf16 v[176:179],v[24:27],a[16:19],0
buffer_load_dwordx4 v0,s[8:11],s64 offen offset:1024 sc1 lds
v_mfma_f32_16x16x32_bf16 v[180:183],v[24:27],a[20:23],0
ds_read_b128 v[44:47],v4 offset:9216
v_and_b32 v91,0xffff0000,v225
v_mfma_f32_16x16x32_bf16 v[184:187],v[24:27],a[24:27],0
ds_read_b128 v[48:51],v4 offset:10240
s_waitcnt vmcnt(9)
v_mfma_f32_16x16x32_bf16 v[188:191],v[24:27],a[28:31],0
ds_read_b128 v[52:55],v4 offset:11264
v_mfma_f32_16x16x32_bf16 v[128:131],v[156:159],v[192:195],0
ds_write_b32 v247,v248
v_lshlrev_b32 v92,16,v226
s_waitcnt lgkmcnt(7)
v_mfma_f32_16x16x32_bf16 v[160:163],v[28:31],a[32:35],v[160:163]
buffer_load_dwordx4 v0,s[8:11],s64 offen offset:2048 sc1 lds
v_mfma_f32_16x16x32_bf16 v[164:167],v[28:31],a[36:39],v[164:167]
ds_read_b128 v[56:59],v4 offset:4096
s_waitcnt vmcnt(9)
v_mfma_f32_16x16x32_bf16 v[168:171],v[28:31],a[40:43],v[168:171]
ds_read_b128 v[60:63],v4 offset:5120
v_mfma_f32_16x16x32_bf16 v[128:131],v[156:159],v[196:199],v[128:131]
ds_read_b128 v[64:67],v4 offset:6144
v_and_b32 v93,0xffff0000,v226
v_mfma_f32_16x16x32_bf16 v[172:175],v[28:31],a[44:47],v[172:175]
ds_read_b128 v[68:71],v4 offset:7168
s_waitcnt vmcnt(8)
v_mfma_f32_16x16x32_bf16 v[176:179],v[28:31],a[48:51],v[176:179]
buffer_load_dwordx4 v0,s[8:11],s64 offen offset:3072 sc1 lds
v_mfma_f32_16x16x32_bf16 v[180:183],v[28:31],a[52:55],v[180:183]
ds_read_b128 v[72:75],v4 offset:12288
v_mfma_f32_16x16x32_bf16 v[128:131],v[156:159],v[200:203],v[128:131]
ds_read_b128 v[76:79],v4 offset:13312
v_lshlrev_b32 v94,16,v227
v_mfma_f32_16x16x32_bf16 v[184:187],v[28:31],a[56:59],v[184:187]
ds_read_b128 v[80:83],v4 offset:14336
s_waitcnt vmcnt(8)
v_mfma_f32_16x16x32_bf16 v[188:191],v[28:31],a[60:63],v[188:191]
ds_read_b128 v[84:87],v4 offset:15360
v_mfma_f32_16x16x32_bf16 v[128:131],v[156:159],v[204:207],v[128:131]
v_and_b32 v95,0xffff0000,v227
v_readfirstlane_b32 s22,v246
s_waitcnt lgkmcnt(14)
v_mfma_f32_16x16x32_bf16 v[160:163],v[32:35],a[64:67],v[160:163]
s_waitcnt vmcnt(7)
v_mfma_f32_16x16x32_bf16 v[132:135],v[156:159],v[208:211],0
s_add_u32 m0,s58,4096
s_add_u32 s64,s64,4096
s_cmp_eq_u32 s22,0
s_cbranch_scc1 L_ag_326
L_agb_327:
v_mfma_f32_16x16x32_bf16 v[164:167],v[32:35],a[68:71],v[164:167]
buffer_load_dwordx4 v0,s[8:11],s64 offen offset:0 sc1 lds
v_mfma_f32_16x16x32_bf16 v[168:171],v[32:35],a[72:75],v[168:171]
s_waitcnt vmcnt(7)
v_mfma_f32_16x16x32_bf16 v[132:135],v[156:159],v[212:215],v[132:135]
s_lshl_b32 s18,s26,5
s_add_u32 s18,s18,s68
s_lshl_b32 s19,s18,10
v_mfma_f32_16x16x32_bf16 v[172:175],v[32:35],a[76:79],v[172:175]
s_waitcnt vmcnt(6)
v_mfma_f32_16x16x32_bf16 v[132:135],v[156:159],v[216:219],v[132:135]
s_add_u32 s20,s19,6291456
s_lshl_b32 s23,s51,5
s_add_u32 s23,s23,s68
v_mfma_f32_16x16x32_bf16 v[176:179],v[32:35],a[80:83],v[176:179]
ds_write_b128 v6,v[128:131]
v_mfma_f32_16x16x32_bf16 v[180:183],v[32:35],a[84:87],v[180:183]
buffer_load_dwordx4 v0,s[8:11],s64 offen offset:1024 sc1 lds
v_mfma_f32_16x16x32_bf16 v[184:187],v[32:35],a[88:91],v[184:187]
s_waitcnt vmcnt(6)
v_mfma_f32_16x16x32_bf16 v[132:135],v[156:159],v[220:223],v[132:135]
s_lshl_b32 s24,s23,10
s_lshl_b32 s25,s51,10
s_add_u32 s25,s25,2883584
v_mfma_f32_16x16x32_bf16 v[188:191],v[32:35],a[92:95],v[188:191]
s_cmp_eq_u32 s23,s55
s_cselect_b32 s25,s25,s24
s_add_u32 s25,s25,8388608
s_waitcnt lgkmcnt(14)
v_mfma_f32_16x16x32_bf16 v[160:163],v[36:39],a[96:99],v[160:163]
s_mov_b32 s6,268435456
s_cmp_eq_u32 s31,0
s_cselect_b32 s25,s24,s25
s_cselect_b64 s[4:5],s[16:17],s[44:45]
s_cmov_b32 s6,2097152
v_mfma_f32_16x16x32_bf16 v[164:167],v[36:39],a[100:103],v[164:167]
ds_write_b128 v6,v[132:135] offset:2048
v_mfma_f32_16x16x32_bf16 v[168:171],v[36:39],a[104:107],v[168:171]
buffer_load_dwordx4 v0,s[8:11],s64 offen offset:2048 sc1 lds
v_mfma_f32_16x16x32_bf16 v[172:175],v[36:39],a[108:111],v[172:175]
buffer_load_dwordx4 v[224:227],v0,s[4:7],s25 offen sc1
v_mfma_f32_16x16x32_bf16 v[176:179],v[36:39],a[112:115],v[176:179]
s_lshr_b32 s24,s55,5
s_cmp_lt_u32 s51,s24
s_cselect_b32 s24,1,2
v_mfma_f32_16x16x32_bf16 v[180:183],v[36:39],a[116:119],v[180:183]
v_mov_b32 v252,s24
s_lshl2_add_u32 s25,s51,11018240
v_mfma_f32_16x16x32_bf16 v[184:187],v[36:39],a[120:123],v[184:187]
buffer_load_dwordx4 v0,s[8:11],s64 offen offset:3072 sc1 lds
v_mfma_f32_16x16x32_bf16 v[188:191],v[36:39],a[124:127],v[188:191]
s_waitcnt lgkmcnt(0)
s_barrier
s_lshl_b32 s24,s68,16
s_waitcnt lgkmcnt(14)
v_mfma_f32_16x16x32_bf16 v[160:163],v[40:43],a[128:131],v[160:163]
ds_read_b128 v[96:99],v23
s_add_u32 s24,s24,s31
v_mfma_f32_16x16x32_bf16 v[164:167],v[40:43],a[132:135],v[164:167]
ds_read_b128 v[100:103],v23 offset:16
s_add_u32 s24,s24,s86
v_mfma_f32_16x16x32_bf16 v[168:171],v[40:43],a[136:139],v[168:171]
ds_read_b128 v[248:251],v245
s_add_u32 m0,s58,8192
s_add_u32 s64,s64,4096
v_mfma_f32_16x16x32_bf16 v[172:175],v[40:43],a[140:143],v[172:175]
buffer_load_dwordx4 v0,s[8:11],s64 offen offset:0 sc1 lds
s_cmp_eq_u32 s24,1537
s_cselect_b32 s25,s25,0x80000000
v_mfma_f32_16x16x32_bf16 v[176:179],v[40:43],a[144:147],v[176:179]
buffer_store_dword v252,off,s[8:11],s25 sc1
s_bitcmp1_b64 s[38:39],s51
s_cselect_b32 s24,128,0
v_mfma_f32_16x16x32_bf16 v[180:183],v[40:43],a[148:151],v[180:183]
buffer_store_dword v20,off,s[8:11],s73 sc1
s_lshl_b32 s23,s51,13
v_mfma_f32_16x16x32_bf16 v[184:187],v[40:43],a[152:155],v[184:187]
s_lshl2_add_u32 s23,s68,s23
s_add_u32 s23,s23,10487168
s_add_u32 s23,s23,s24
s_mov_b32 s73,0x80000000
v_mfma_f32_16x16x32_bf16 v[188:191],v[40:43],a[156:159],v[188:191]
buffer_load_dwordx4 v0,s[8:11],s64 offen offset:1024 sc1 lds
v_mfma_f32_16x16x32_bf16 v[160:163],v[44:47],a[160:163],v[160:163]
buffer_load_dword v246,off,s[8:11],s23 sc1
v_lshrrev_b32 v244,4,v1
v_mfma_f32_16x16x32_bf16 v[164:167],v[44:47],a[164:167],v[164:167]
s_waitcnt lgkmcnt(0)
v_or3_b32 v248,v248,v249,v250
v_or_b32 v248,v248,v251
s_sub_u32 s23,s77,8
v_mfma_f32_16x16x32_bf16 v[168:171],v[44:47],a[168:171],v[168:171]
v_readfirstlane_b32 s72,v248
v_add_u32 v244,s23,v244
v_max_i32 v244,0,v244
v_mfma_f32_16x16x32_bf16 v[172:175],v[44:47],a[172:175],v[172:175]
buffer_load_dwordx4 v0,s[8:11],s64 offen offset:2048 sc1 lds
v_lshl_add_u32 v244,v244,13,v21
v_mfma_f32_16x16x32_bf16 v[176:179],v[44:47],a[176:179],v[176:179]
buffer_load_dwordx2 v[242:243],v244,s[8:11],0 offen sc1
s_waitcnt lgkmcnt(1)
v_mfma_f32_16x16x32_bf16 v[180:183],v[44:47],a[180:183],v[180:183]
v_cvt_pk_bf16_f32 v104,v96,v97
v_cvt_pk_bf16_f32 v105,v98,v99
v_cvt_pk_bf16_f32 v106,v100,v101
v_mfma_f32_16x16x32_bf16 v[184:187],v[44:47],a[184:187],v[184:187]
v_cvt_pk_bf16_f32 v107,v102,v103
v_lshlrev_b32 v96,16,v104
v_and_b32 v97,0xffff0000,v104
v_mfma_f32_16x16x32_bf16 v[188:191],v[44:47],a[188:191],v[188:191]
buffer_load_dwordx4 v0,s[8:11],s64 offen offset:3072 sc1 lds
v_lshlrev_b32 v98,16,v105
v_mfma_f32_16x16x32_bf16 v[160:163],v[48:51],a[192:195],v[160:163]
v_and_b32 v99,0xffff0000,v105
v_lshlrev_b32 v100,16,v106
v_and_b32 v101,0xffff0000,v106
v_mfma_f32_16x16x32_bf16 v[164:167],v[48:51],a[196:199],v[164:167]
v_lshlrev_b32 v102,16,v107
v_and_b32 v103,0xffff0000,v107
v_add_f32 v88,v88,v96
v_mfma_f32_16x16x32_bf16 v[168:171],v[48:51],a[200:203],v[168:171]
v_add_f32 v89,v89,v97
v_add_f32 v90,v90,v98
v_add_f32 v91,v91,v99
v_mfma_f32_16x16x32_bf16 v[172:175],v[48:51],a[204:207],v[172:175]
s_add_u32 m0,s57,24576
v_add_f32 v92,v92,v100
v_add_f32 v93,v93,v101
v_add_f32 v94,v94,v102
v_mfma_f32_16x16x32_bf16 v[176:179],v[48:51],a[208:211],v[176:179]
buffer_load_dwordx4 v0,s[8:11],s65 offen offset:0 sc1 lds
v_add_f32 v95,v95,v103
v_mfma_f32_16x16x32_bf16 v[180:183],v[48:51],a[212:215],v[180:183]
v_cvt_pk_bf16_f32 v104,v88,v89
v_cvt_pk_bf16_f32 v105,v90,v91
v_cvt_pk_bf16_f32 v106,v92,v93
v_mfma_f32_16x16x32_bf16 v[184:187],v[48:51],a[216:219],v[184:187]
v_cvt_pk_bf16_f32 v107,v94,v95
v_mfma_f32_16x16x32_bf16 v[188:191],v[48:51],a[220:223],v[188:191]
buffer_store_dwordx4 v[104:107],v0,s[8:11],s20 offen sc1
v_lshlrev_b32 v88,16,v104
v_mfma_f32_16x16x32_bf16 v[160:163],v[52:55],a[224:227],v[160:163]
buffer_load_dwordx4 v0,s[8:11],s65 offen offset:1024 sc1 lds
v_and_b32 v89,0xffff0000,v104
v_mfma_f32_16x16x32_bf16 v[164:167],v[52:55],a[228:231],v[164:167]
v_lshlrev_b32 v90,16,v105
v_and_b32 v91,0xffff0000,v105
v_lshlrev_b32 v92,16,v106
v_mfma_f32_16x16x32_bf16 v[168:171],v[52:55],a[232:235],v[168:171]
v_and_b32 v93,0xffff0000,v106
v_lshlrev_b32 v94,16,v107
v_and_b32 v95,0xffff0000,v107
v_mfma_f32_16x16x32_bf16 v[172:175],v[52:55],a[236:239],v[172:175]
v_readfirstlane_b32 s78,v88
v_mfma_f32_16x16x32_bf16 v[176:179],v[52:55],a[240:243],v[176:179]
s_nop 0
v_add_f32 v120,v88,-s78
v_add_f32 v121,v89,-s78
v_add_f32 v122,v90,-s78
v_mfma_f32_16x16x32_bf16 v[180:183],v[52:55],a[244:247],v[180:183]
v_add_f32 v123,v91,-s78
v_add_f32 v124,v92,-s78
v_add_f32 v125,v93,-s78
v_mfma_f32_16x16x32_bf16 v[184:187],v[52:55],a[248:251],v[184:187]
v_add_f32 v126,v94,-s78
v_add_f32 v127,v95,-s78
v_add_f32 v128,v120,v122
v_mfma_f32_16x16x32_bf16 v[188:191],v[52:55],a[252:255],v[188:191]
v_add_f32 v129,v121,v123
v_mul_f32 v130,v120,v120
v_mul_f32 v131,v121,v121
v_mfma_f32_16x16x32_bf16 v[192:195],v[56:59],a[0:3],0
v_add_f32 v132,v124,v126
v_add_f32 v133,v125,v127
v_fma_f32 v130,v122,v122,v130
v_mfma_f32_16x16x32_bf16 v[196:199],v[56:59],a[4:7],0
v_fma_f32 v131,v123,v123,v131
v_add_f32 v128,v128,v132
v_add_f32 v129,v129,v133
v_mfma_f32_16x16x32_bf16 v[200:203],v[56:59],a[8:11],0
v_fma_f32 v130,v124,v124,v130
v_fma_f32 v131,v125,v125,v131
v_add_f32 v128,v128,v129
v_mfma_f32_16x16x32_bf16 v[204:207],v[56:59],a[12:15],0
v_fma_f32 v130,v126,v126,v130
v_fma_f32 v131,v127,v127,v131
v_add_f32 v130,v130,v131
v_mfma_f32_16x16x32_bf16 v[208:211],v[56:59],a[16:19],0
s_nop 0
v_permlane32_swap_b32 v128,v130
v_add_f32 v128,v128,v130
v_cvt_pk_bf16_f32 v24,v160,v164
v_mfma_f32_16x16x32_bf16 v[212:215],v[56:59],a[20:23],0
v_add_f32_dpp v128,v128,v128 row_ror:8 row_mask:0xf bank_mask:0xf
v_cvt_pk_bf16_f32 v25,v168,v172
v_cvt_pk_bf16_f32 v26,v176,v180
v_mfma_f32_16x16x32_bf16 v[216:219],v[56:59],a[24:27],0
v_add_f32_dpp v128,v128,v128 row_ror:4 row_mask:0xf bank_mask:0xf
v_cvt_pk_bf16_f32 v27,v184,v188
v_cvt_pk_bf16_f32 v28,v161,v165
v_mfma_f32_16x16x32_bf16 v[220:223],v[56:59],a[28:31],0
v_add_f32_dpp v128,v128,v128 row_ror:2 row_mask:0xf bank_mask:0xf
v_cvt_pk_bf16_f32 v29,v169,v173
v_cvt_pk_bf16_f32 v30,v177,v181
v_mfma_f32_16x16x32_bf16 v[192:195],v[60:63],a[32:35],v[192:195]
v_add_f32_dpp v128,v128,v128 row_ror:1 row_mask:0xf bank_mask:0xf
v_mov_b32 v130,v128
v_cvt_pk_bf16_f32 v31,v185,v189
v_mfma_f32_16x16x32_bf16 v[196:199],v[60:63],a[36:39],v[196:199]
v_permlane16_swap_b32 v128,v130
v_add_f32 v128,v128,v130
v_mul_f32 v128,0x3b000000,v128
v_mfma_f32_16x16x32_bf16 v[200:203],v[60:63],a[40:43],v[200:203]
v_mov_b32 v130,v128
v_cvt_pk_bf16_f32 v32,v162,v166
v_cvt_pk_bf16_f32 v33,v170,v174
v_mfma_f32_16x16x32_bf16 v[204:207],v[60:63],a[44:47],v[204:207]
v_permlane32_swap_b32 v128,v130
v_fma_f32 v130,-v128,v128,v130
v_add_f32 v128,s78,v128
v_mfma_f32_16x16x32_bf16 v[208:211],v[60:63],a[48:51],v[208:211]
v_max_f32 v130,0,v130
v_cvt_pk_bf16_f32 v130,v128,v130
v_lshlrev_b32 v128,16,v130
v_mfma_f32_16x16x32_bf16 v[212:215],v[60:63],a[52:55],v[212:215]
v_and_b32 v130,0xffff0000,v130
v_add_f32 v130,0x3727c5ac,v130
v_cvt_pk_bf16_f32 v130,v130,v130
v_mfma_f32_16x16x32_bf16 v[216:219],v[60:63],a[56:59],v[216:219]
v_and_b32 v130,0xffff0000,v130
v_sqrt_f32 v130,v130
v_add_f32 v120,v88,-v128
v_mfma_f32_16x16x32_bf16 v[220:223],v[60:63],a[60:63],v[220:223]
v_add_f32 v121,v89,-v128
v_add_f32 v122,v90,-v128
v_add_f32 v123,v91,-v128
v_mfma_f32_16x16x32_bf16 v[192:195],v[64:67],a[64:67],v[192:195]
v_add_f32 v124,v92,-v128
v_add_f32 v125,v93,-v128
v_add_f32 v126,v94,-v128
v_mfma_f32_16x16x32_bf16 v[196:199],v[64:67],a[68:71],v[196:199]
v_add_f32 v127,v95,-v128
v_cvt_pk_bf16_f32 v130,v130,v130
v_and_b32 v130,0xffff0000,v130
v_mfma_f32_16x16x32_bf16 v[200:203],v[64:67],a[72:75],v[200:203]
v_rcp_f32 v130,v130
v_cvt_pk_bf16_f32 v108,v120,v121
v_cvt_pk_bf16_f32 v109,v122,v123
v_mfma_f32_16x16x32_bf16 v[204:207],v[64:67],a[76:79],v[204:207]
v_cvt_pk_bf16_f32 v110,v124,v125
v_cvt_pk_bf16_f32 v111,v126,v127
v_lshlrev_b32 v120,16,v108
v_mfma_f32_16x16x32_bf16 v[208:211],v[64:67],a[80:83],v[208:211]
v_cvt_pk_bf16_f32 v34,v178,v182
v_cvt_pk_bf16_f32 v35,v186,v190
v_cvt_pk_bf16_f32 v36,v163,v167
v_mfma_f32_16x16x32_bf16 v[212:215],v[64:67],a[84:87],v[212:215]
v_cvt_pk_bf16_f32 v37,v171,v175
v_cvt_pk_bf16_f32 v38,v179,v183
v_cvt_pk_bf16_f32 v39,v187,v191
v_mfma_f32_16x16x32_bf16 v[216:219],v[64:67],a[88:91],v[216:219]
v_and_b32 v121,0xffff0000,v108
v_lshlrev_b32 v122,16,v109
v_and_b32 v123,0xffff0000,v109
v_mfma_f32_16x16x32_bf16 v[220:223],v[64:67],a[92:95],v[220:223]
v_lshlrev_b32 v124,16,v110
v_and_b32 v125,0xffff0000,v110
v_lshlrev_b32 v126,16,v111
v_mfma_f32_16x16x32_bf16 v[192:195],v[68:71],a[96:99],v[192:195]
v_and_b32 v127,0xffff0000,v111
v_mul_f32 v120,v120,v130
v_mul_f32 v121,v121,v130
v_mfma_f32_16x16x32_bf16 v[196:199],v[68:71],a[100:103],v[196:199]
v_mul_f32 v122,v122,v130
v_mul_f32 v123,v123,v130
v_mul_f32 v124,v124,v130
v_mfma_f32_16x16x32_bf16 v[200:203],v[68:71],a[104:107],v[200:203]
v_mul_f32 v125,v125,v130
v_mul_f32 v126,v126,v130
v_mul_f32 v127,v127,v130
v_mfma_f32_16x16x32_bf16 v[204:207],v[68:71],a[108:111],v[204:207]
v_cvt_pk_bf16_f32 v108,v120,v121
v_cvt_pk_bf16_f32 v109,v122,v123
v_cvt_pk_bf16_f32 v110,v124,v125
v_mfma_f32_16x16x32_bf16 v[208:211],v[68:71],a[112:115],v[208:211]
s_add_u32 s62,s69,0
v_cvt_pk_bf16_f32 v111,v126,v127
v_lshlrev_b32 v112,16,v108
v_and_b32 v113,0xffff0000,v108
v_mfma_f32_16x16x32_bf16 v[212:215],v[68:71],a[116:119],v[212:215]
buffer_store_dwordx4 v[24:27],v5,s[8:11],s62 offen sc1
v_lshlrev_b32 v114,16,v109
v_mfma_f32_16x16x32_bf16 v[216:219],v[68:71],a[120:123],v[216:219]
v_and_b32 v115,0xffff0000,v109
v_lshlrev_b32 v116,16,v110
v_and_b32 v117,0xffff0000,v110
v_mfma_f32_16x16x32_bf16 v[220:223],v[68:71],a[124:127],v[220:223]
v_lshlrev_b32 v118,16,v111
v_and_b32 v119,0xffff0000,v111
v_add_f32 v88,v88,v112
v_mfma_f32_16x16x32_bf16 v[192:195],v[72:75],a[128:131],v[192:195]
s_add_u32 s62,s69,16384
v_add_f32 v89,v89,v113
v_add_f32 v90,v90,v114
v_add_f32 v91,v91,v115
v_mfma_f32_16x16x32_bf16 v[196:199],v[72:75],a[132:135],v[196:199]
buffer_store_dwordx4 v[28:31],v5,s[8:11],s62 offen sc1
v_add_f32 v92,v92,v116
v_mfma_f32_16x16x32_bf16 v[200:203],v[72:75],a[136:139],v[200:203]
v_add_f32 v93,v93,v117
v_add_f32 v94,v94,v118
v_add_f32 v95,v95,v119
v_mfma_f32_16x16x32_bf16 v[204:207],v[72:75],a[140:143],v[204:207]
v_cvt_pk_bf16_f32 v96,v88,v89
v_cvt_pk_bf16_f32 v97,v90,v91
v_cvt_pk_bf16_f32 v98,v92,v93
v_mfma_f32_16x16x32_bf16 v[208:211],v[72:75],a[144:147],v[208:211]
s_add_u32 s62,s69,32768
v_cvt_pk_bf16_f32 v99,v94,v95
v_mfma_f32_16x16x32_bf16 v[212:215],v[72:75],a[148:151],v[212:215]
buffer_store_dwordx4 v[32:35],v5,s[8:11],s62 offen sc1
v_mfma_f32_16x16x32_bf16 v[216:219],v[72:75],a[152:155],v[216:219]
buffer_store_dwordx4 v[96:99],v0,s[12:15],s19 offen sc1
v_mul_f32 v236,v112,v228
v_mfma_f32_16x16x32_bf16 v[220:223],v[72:75],a[156:159],v[220:223]
v_mul_f32 v237,v113,v229
v_fma_f32 v236,v114,v230,v236
v_fma_f32 v237,v115,v231,v237
v_mfma_f32_16x16x32_bf16 v[192:195],v[76:79],a[160:163],v[192:195]
s_add_u32 s62,s69,49152
v_fma_f32 v236,v116,v232,v236
v_fma_f32 v237,v117,v233,v237
v_fma_f32 v236,v118,v234,v236
v_mfma_f32_16x16x32_bf16 v[196:199],v[76:79],a[164:167],v[196:199]
buffer_store_dwordx4 v[36:39],v5,s[8:11],s62 offen sc1
v_fma_f32 v237,v119,v235,v237
v_mfma_f32_16x16x32_bf16 v[200:203],v[76:79],a[168:171],v[200:203]
v_add_f32 v236,v236,v237
v_mfma_f32_16x16x32_bf16 v[204:207],v[76:79],a[172:175],v[204:207]
s_nop 0
v_add_f32_dpp v236,v236,v236 row_ror:8 row_mask:0xf bank_mask:0xf
v_mfma_f32_16x16x32_bf16 v[208:211],v[76:79],a[176:179],v[208:211]
s_nop 0
v_add_f32_dpp v236,v236,v236 row_ror:4 row_mask:0xf bank_mask:0xf
v_mfma_f32_16x16x32_bf16 v[212:215],v[76:79],a[180:183],v[212:215]
s_nop 0
v_add_f32_dpp v236,v236,v236 row_ror:2 row_mask:0xf bank_mask:0xf
v_mfma_f32_16x16x32_bf16 v[216:219],v[76:79],a[184:187],v[216:219]
s_nop 0
v_add_f32_dpp v236,v236,v236 row_ror:1 row_mask:0xf bank_mask:0xf
v_mov_b32 v237,v236
v_mfma_f32_16x16x32_bf16 v[220:223],v[76:79],a[188:191],v[220:223]
s_nop 0
v_permlane16_swap_b32 v236,v237
v_add_f32 v236,v236,v237
v_mov_b32 v237,v236
v_mfma_f32_16x16x32_bf16 v[192:195],v[80:83],a[192:195],v[192:195]
s_nop 0
v_permlane32_swap_b32 v236,v237
v_add_f32 v236,v236,v237
v_cvt_pk_bf16_f32 v236,v236,v236
v_mfma_f32_16x16x32_bf16 v[196:199],v[80:83],a[196:199],v[196:199]
v_and_b32 v236,0xffff0000,v236
v_ashrrev_i32 v237,31,v236
v_or_b32 v237,0x80000000,v237
v_mfma_f32_16x16x32_bf16 v[192:195],v[84:87],a[224:227],v[192:195]
v_xor_b32 v236,v236,v237
v_and_b32 v236,0xffff0000,v236
s_sub_u32 s20,4095,s18
v_mfma_f32_16x16x32_bf16 v[196:199],v[84:87],a[228:231],v[196:199]
v_or_b32 v20,s20,v236
s_lshl_b32 s73,s26,13
s_lshl2_add_u32 s73,s68,s73
v_mfma_f32_16x16x32_bf16 v[200:203],v[80:83],a[200:203],v[200:203]
s_add_u32 s73,s73,10485760
s_add_u32 s73,s73,s86
v_mfma_f32_16x16x32_bf16 v[204:207],v[80:83],a[204:207],v[204:207]
v_cvt_pk_bf16_f32 v40,v192,v196
v_cvt_pk_bf16_f32 v44,v193,v197
v_cvt_pk_bf16_f32 v48,v194,v198
v_mfma_f32_16x16x32_bf16 v[200:203],v[84:87],a[232:235],v[200:203]
v_cvt_pk_bf16_f32 v52,v195,v199
v_mfma_f32_16x16x32_bf16 v[204:207],v[84:87],a[236:239],v[204:207]
v_mfma_f32_16x16x32_bf16 v[208:211],v[80:83],a[208:211],v[208:211]
v_mfma_f32_16x16x32_bf16 v[212:215],v[80:83],a[212:215],v[212:215]
v_mfma_f32_16x16x32_bf16 v[208:211],v[84:87],a[240:243],v[208:211]
v_mfma_f32_16x16x32_bf16 v[212:215],v[84:87],a[244:247],v[212:215]
v_cvt_pk_bf16_f32 v41,v200,v204
v_cvt_pk_bf16_f32 v45,v201,v205
v_cvt_pk_bf16_f32 v49,v202,v206
v_mfma_f32_16x16x32_bf16 v[216:219],v[80:83],a[216:219],v[216:219]
v_cvt_pk_bf16_f32 v53,v203,v207
v_mfma_f32_16x16x32_bf16 v[220:223],v[80:83],a[220:223],v[220:223]
v_cvt_pk_bf16_f32 v42,v208,v212
v_cvt_pk_bf16_f32 v46,v209,v213
v_cvt_pk_bf16_f32 v50,v210,v214
v_mfma_f32_16x16x32_bf16 v[216:219],v[84:87],a[248:251],v[216:219]
v_cvt_pk_bf16_f32 v54,v211,v215
v_mfma_f32_16x16x32_bf16 v[220:223],v[84:87],a[252:255],v[220:223]
s_nop 7
v_cvt_pk_bf16_f32 v43,v216,v220
s_add_u32 s62,s69,262144
buffer_store_dwordx4 v[40:43],v5,s[8:11],s62 offen sc1
v_cvt_pk_bf16_f32 v47,v217,v221
s_add_u32 s62,s69,278528
buffer_store_dwordx4 v[44:47],v5,s[8:11],s62 offen sc1
v_cvt_pk_bf16_f32 v51,v218,v222
s_add_u32 s62,s69,294912
buffer_store_dwordx4 v[48:51],v5,s[8:11],s62 offen sc1
v_cvt_pk_bf16_f32 v55,v219,v223
s_add_u32 s62,s69,311296
buffer_store_dwordx4 v[52:55],v5,s[8:11],s62 offen sc1
s_cmp_lg_u32 s72,0
s_cbranch_scc1 L_aa_313
s_waitcnt vmcnt(9)
s_branch L_aa_323
L_av_325:
ds_read_b128 v[24:27],v4 offset:0
ds_read_b128 v[28:31],v4 offset:1024
s_min_u32 s56,s32,s33
s_cmp_lt_u32 s77,64
s_cselect_b32 s56,s56,0
s_cmp_eq_u32 s56,0
s_cselect_b32 s72,0x80000000,0
v_mov_b32 v248,s72
s_or_b32 s64,s70,s72
s_or_b32 s65,s71,s72
s_cmp_lt_u32 s30,s31
s_cselect_b32 s65,0x80000000,s65
s_add_u32 s64,s64,s28
s_add_u32 s65,s65,s29
s_xor_b32 s58,s67,s40
s_xor_b32 s57,s67,s41
s_add_u32 m0,s58,0
s_waitcnt lgkmcnt(1)
v_mfma_f32_16x16x32_bf16 v[160:163],v[24:27],a[0:3],0
buffer_load_dwordx4 v0,s[8:11],s64 offen offset:0 sc1 lds
v_mfma_f32_16x16x32_bf16 v[164:167],v[24:27],a[4:7],0
ds_read_b128 v[32:35],v4 offset:2048
s_lshl_b32 s23,s51,5
v_mfma_f32_16x16x32_bf16 v[168:171],v[24:27],a[8:11],0
ds_read_b128 v[36:39],v4 offset:3072
s_add_u32 s23,s23,s68
v_mfma_f32_16x16x32_bf16 v[172:175],v[24:27],a[12:15],0
ds_read_b128 v[40:43],v4 offset:8192
s_lshl_b32 s24,s23,10
v_mfma_f32_16x16x32_bf16 v[176:179],v[24:27],a[16:19],0
buffer_load_dwordx4 v0,s[8:11],s64 offen offset:1024 sc1 lds
v_mfma_f32_16x16x32_bf16 v[180:183],v[24:27],a[20:23],0
ds_read_b128 v[44:47],v4 offset:9216
s_lshl_b32 s25,s51,10
v_mfma_f32_16x16x32_bf16 v[184:187],v[24:27],a[24:27],0
ds_read_b128 v[48:51],v4 offset:10240
s_waitcnt vmcnt(9)
v_mfma_f32_16x16x32_bf16 v[188:191],v[24:27],a[28:31],0
ds_read_b128 v[52:55],v4 offset:11264
v_mfma_f32_16x16x32_bf16 v[128:131],v[156:159],v[192:195],0
ds_write_b32 v247,v248
s_add_u32 s25,s25,2883584
s_waitcnt lgkmcnt(7)
v_mfma_f32_16x16x32_bf16 v[160:163],v[28:31],a[32:35],v[160:163]
buffer_load_dwordx4 v0,s[8:11],s64 offen offset:2048 sc1 lds
v_mfma_f32_16x16x32_bf16 v[164:167],v[28:31],a[36:39],v[164:167]
ds_read_b128 v[56:59],v4 offset:4096
s_waitcnt vmcnt(9)
v_mfma_f32_16x16x32_bf16 v[168:171],v[28:31],a[40:43],v[168:171]
ds_read_b128 v[60:63],v4 offset:5120
v_mfma_f32_16x16x32_bf16 v[128:131],v[156:159],v[196:199],v[128:131]
ds_read_b128 v[64:67],v4 offset:6144
s_cmp_eq_u32 s23,s55
s_cselect_b32 s25,s25,s24
v_mfma_f32_16x16x32_bf16 v[172:175],v[28:31],a[44:47],v[172:175]
ds_read_b128 v[68:71],v4 offset:7168
s_waitcnt vmcnt(8)
v_mfma_f32_16x16x32_bf16 v[176:179],v[28:31],a[48:51],v[176:179]
buffer_load_dwordx4 v0,s[8:11],s64 offen offset:3072 sc1 lds
v_mfma_f32_16x16x32_bf16 v[180:183],v[28:31],a[52:55],v[180:183]
ds_read_b128 v[72:75],v4 offset:12288
v_mfma_f32_16x16x32_bf16 v[128:131],v[156:159],v[200:203],v[128:131]
ds_read_b128 v[76:79],v4 offset:13312
s_add_u32 s25,s25,8388608
v_mfma_f32_16x16x32_bf16 v[184:187],v[28:31],a[56:59],v[184:187]
ds_read_b128 v[80:83],v4 offset:14336
s_waitcnt vmcnt(8)
v_mfma_f32_16x16x32_bf16 v[188:191],v[28:31],a[60:63],v[188:191]
ds_read_b128 v[84:87],v4 offset:15360
v_mfma_f32_16x16x32_bf16 v[128:131],v[156:159],v[204:207],v[128:131]
s_mov_b32 s6,268435456
s_cmp_eq_u32 s31,0
s_cselect_b32 s25,s24,s25
s_cselect_b64 s[4:5],s[16:17],s[44:45]
s_cmov_b32 s6,2097152
s_waitcnt lgkmcnt(14)
v_mfma_f32_16x16x32_bf16 v[160:163],v[32:35],a[64:67],v[160:163]
buffer_load_dwordx4 v[224:227],v0,s[4:7],s25 offen sc1
v_mfma_f32_16x16x32_bf16 v[164:167],v[32:35],a[68:71],v[164:167]
s_waitcnt vmcnt(8)
v_mfma_f32_16x16x32_bf16 v[132:135],v[156:159],v[208:211],0
s_add_u32 m0,s58,4096
s_add_u32 s64,s64,4096
s_lshr_b32 s24,s55,5
v_mfma_f32_16x16x32_bf16 v[168:171],v[32:35],a[72:75],v[168:171]
buffer_load_dwordx4 v0,s[8:11],s64 offen offset:0 sc1 lds
v_mfma_f32_16x16x32_bf16 v[172:175],v[32:35],a[76:79],v[172:175]
s_waitcnt vmcnt(8)
v_mfma_f32_16x16x32_bf16 v[132:135],v[156:159],v[212:215],v[132:135]
s_cmp_lt_u32 s51,s24
s_cselect_b32 s24,1,2
v_mov_b32 v252,s24
v_mfma_f32_16x16x32_bf16 v[176:179],v[32:35],a[80:83],v[176:179]
s_waitcnt vmcnt(7)
v_mfma_f32_16x16x32_bf16 v[132:135],v[156:159],v[216:219],v[132:135]
s_lshl2_add_u32 s25,s51,11018240
s_lshl_b32 s24,s68,16
s_add_u32 s24,s24,s31
v_mfma_f32_16x16x32_bf16 v[180:183],v[32:35],a[84:87],v[180:183]
ds_write_b128 v6,v[128:131]
v_mfma_f32_16x16x32_bf16 v[184:187],v[32:35],a[88:91],v[184:187]
buffer_load_dwordx4 v0,s[8:11],s64 offen offset:1024 sc1 lds
v_mfma_f32_16x16x32_bf16 v[188:191],v[32:35],a[92:95],v[188:191]
s_waitcnt vmcnt(7)
v_mfma_f32_16x16x32_bf16 v[132:135],v[156:159],v[220:223],v[132:135]
s_add_u32 s24,s24,s86
s_cmp_eq_u32 s24,1537
s_cselect_b32 s25,s25,0x80000000
s_waitcnt lgkmcnt(14)
v_mfma_f32_16x16x32_bf16 v[160:163],v[36:39],a[96:99],v[160:163]
buffer_store_dword v252,off,s[8:11],s25 sc1
v_mfma_f32_16x16x32_bf16 v[164:167],v[36:39],a[100:103],v[164:167]
s_bitcmp1_b64 s[38:39],s51
s_cselect_b32 s24,128,0
s_lshl_b32 s23,s51,13
v_mfma_f32_16x16x32_bf16 v[168:171],v[36:39],a[104:107],v[168:171]
ds_write_b128 v6,v[132:135] offset:2048
v_mfma_f32_16x16x32_bf16 v[172:175],v[36:39],a[108:111],v[172:175]
buffer_load_dwordx4 v0,s[8:11],s64 offen offset:2048 sc1 lds
v_mfma_f32_16x16x32_bf16 v[176:179],v[36:39],a[112:115],v[176:179]
s_lshl2_add_u32 s23,s68,s23
s_add_u32 s23,s23,10487168
s_add_u32 s23,s23,s24
v_mfma_f32_16x16x32_bf16 v[180:183],v[36:39],a[116:119],v[180:183]
buffer_load_dword v246,off,s[8:11],s23 sc1
v_mfma_f32_16x16x32_bf16 v[184:187],v[36:39],a[120:123],v[184:187]
v_lshrrev_b32 v244,4,v1
s_sub_u32 s23,s77,8
v_mfma_f32_16x16x32_bf16 v[188:191],v[36:39],a[124:127],v[188:191]
buffer_load_dwordx4 v0,s[8:11],s64 offen offset:3072 sc1 lds
s_waitcnt lgkmcnt(14)
v_mfma_f32_16x16x32_bf16 v[160:163],v[40:43],a[128:131],v[160:163]
s_waitcnt lgkmcnt(0)
s_barrier
v_add_u32 v244,s23,v244
v_mfma_f32_16x16x32_bf16 v[164:167],v[40:43],a[132:135],v[164:167]
ds_read_b128 v[248:251],v245
v_max_i32 v244,0,v244
v_mfma_f32_16x16x32_bf16 v[168:171],v[40:43],a[136:139],v[168:171]
buffer_store_dword v20,off,s[8:11],s73 sc1
v_mfma_f32_16x16x32_bf16 v[172:175],v[40:43],a[140:143],v[172:175]
s_add_u32 m0,s58,8192
s_add_u32 s64,s64,4096
v_lshl_add_u32 v244,v244,13,v21
v_mfma_f32_16x16x32_bf16 v[176:179],v[40:43],a[144:147],v[176:179]
buffer_load_dwordx4 v0,s[8:11],s64 offen offset:0 sc1 lds
v_mfma_f32_16x16x32_bf16 v[180:183],v[40:43],a[148:151],v[180:183]
buffer_load_dwordx2 v[242:243],v244,s[8:11],0 offen sc1
v_mfma_f32_16x16x32_bf16 v[184:187],v[40:43],a[152:155],v[184:187]
s_mov_b32 s73,0x80000000
v_mfma_f32_16x16x32_bf16 v[188:191],v[40:43],a[156:159],v[188:191]
s_waitcnt lgkmcnt(0)
v_or3_b32 v248,v248,v249,v250
v_or_b32 v248,v248,v251
v_mfma_f32_16x16x32_bf16 v[160:163],v[44:47],a[160:163],v[160:163]
buffer_load_dwordx4 v0,s[8:11],s64 offen offset:1024 sc1 lds
v_mfma_f32_16x16x32_bf16 v[164:167],v[44:47],a[164:167],v[164:167]
v_mfma_f32_16x16x32_bf16 v[168:171],v[44:47],a[168:171],v[168:171]
v_readfirstlane_b32 s72,v248
v_mfma_f32_16x16x32_bf16 v[172:175],v[44:47],a[172:175],v[172:175]
v_mfma_f32_16x16x32_bf16 v[176:179],v[44:47],a[176:179],v[176:179]
buffer_load_dwordx4 v0,s[8:11],s64 offen offset:2048 sc1 lds
v_mfma_f32_16x16x32_bf16 v[180:183],v[44:47],a[180:183],v[180:183]
v_mfma_f32_16x16x32_bf16 v[184:187],v[44:47],a[184:187],v[184:187]
v_mfma_f32_16x16x32_bf16 v[188:191],v[44:47],a[188:191],v[188:191]
v_mfma_f32_16x16x32_bf16 v[160:163],v[48:51],a[192:195],v[160:163]
buffer_load_dwordx4 v0,s[8:11],s64 offen offset:3072 sc1 lds
v_mfma_f32_16x16x32_bf16 v[164:167],v[48:51],a[196:199],v[164:167]
v_mfma_f32_16x16x32_bf16 v[168:171],v[48:51],a[200:203],v[168:171]
v_mfma_f32_16x16x32_bf16 v[172:175],v[48:51],a[204:207],v[172:175]
v_mfma_f32_16x16x32_bf16 v[176:179],v[48:51],a[208:211],v[176:179]
s_add_u32 m0,s57,24576
v_mfma_f32_16x16x32_bf16 v[180:183],v[48:51],a[212:215],v[180:183]
buffer_load_dwordx4 v0,s[8:11],s65 offen offset:0 sc1 lds
v_mfma_f32_16x16x32_bf16 v[184:187],v[48:51],a[216:219],v[184:187]
v_mfma_f32_16x16x32_bf16 v[188:191],v[48:51],a[220:223],v[188:191]
v_mfma_f32_16x16x32_bf16 v[160:163],v[52:55],a[224:227],v[160:163]
v_mfma_f32_16x16x32_bf16 v[164:167],v[52:55],a[228:231],v[164:167]
buffer_load_dwordx4 v0,s[8:11],s65 offen offset:1024 sc1 lds
v_mfma_f32_16x16x32_bf16 v[168:171],v[52:55],a[232:235],v[168:171]
v_mfma_f32_16x16x32_bf16 v[172:175],v[52:55],a[236:239],v[172:175]
v_mfma_f32_16x16x32_bf16 v[176:179],v[52:55],a[240:243],v[176:179]
v_mfma_f32_16x16x32_bf16 v[180:183],v[52:55],a[244:247],v[180:183]
v_mfma_f32_16x16x32_bf16 v[184:187],v[52:55],a[248:251],v[184:187]
v_mfma_f32_16x16x32_bf16 v[188:191],v[52:55],a[252:255],v[188:191]
v_mfma_f32_16x16x32_bf16 v[192:195],v[56:59],a[0:3],0
v_mfma_f32_16x16x32_bf16 v[196:199],v[56:59],a[4:7],0
v_mfma_f32_16x16x32_bf16 v[200:203],v[56:59],a[8:11],0
v_cvt_pk_bf16_f32 v24,v160,v164
v_cvt_pk_bf16_f32 v25,v168,v172
v_mfma_f32_16x16x32_bf16 v[204:207],v[56:59],a[12:15],0
v_cvt_pk_bf16_f32 v26,v176,v180
v_cvt_pk_bf16_f32 v27,v184,v188
v_mfma_f32_16x16x32_bf16 v[208:211],v[56:59],a[16:19],0
v_cvt_pk_bf16_f32 v28,v161,v165
v_cvt_pk_bf16_f32 v29,v169,v173
v_mfma_f32_16x16x32_bf16 v[212:215],v[56:59],a[20:23],0
v_cvt_pk_bf16_f32 v30,v177,v181
v_cvt_pk_bf16_f32 v31,v185,v189
v_mfma_f32_16x16x32_bf16 v[216:219],v[56:59],a[24:27],0
v_cvt_pk_bf16_f32 v32,v162,v166
v_cvt_pk_bf16_f32 v33,v170,v174
v_mfma_f32_16x16x32_bf16 v[220:223],v[56:59],a[28:31],0
v_cvt_pk_bf16_f32 v34,v178,v182
v_cvt_pk_bf16_f32 v35,v186,v190
v_mfma_f32_16x16x32_bf16 v[192:195],v[60:63],a[32:35],v[192:195]
v_cvt_pk_bf16_f32 v36,v163,v167
v_cvt_pk_bf16_f32 v37,v171,v175
v_mfma_f32_16x16x32_bf16 v[196:199],v[60:63],a[36:39],v[196:199]
v_cvt_pk_bf16_f32 v38,v179,v183
v_cvt_pk_bf16_f32 v39,v187,v191
v_mfma_f32_16x16x32_bf16 v[200:203],v[60:63],a[40:43],v[200:203]
v_mfma_f32_16x16x32_bf16 v[204:207],v[60:63],a[44:47],v[204:207]
v_mfma_f32_16x16x32_bf16 v[208:211],v[60:63],a[48:51],v[208:211]
v_mfma_f32_16x16x32_bf16 v[212:215],v[60:63],a[52:55],v[212:215]
v_mfma_f32_16x16x32_bf16 v[216:219],v[60:63],a[56:59],v[216:219]
v_mfma_f32_16x16x32_bf16 v[220:223],v[60:63],a[60:63],v[220:223]
v_mfma_f32_16x16x32_bf16 v[192:195],v[64:67],a[64:67],v[192:195]
v_mfma_f32_16x16x32_bf16 v[196:199],v[64:67],a[68:71],v[196:199]
v_mfma_f32_16x16x32_bf16 v[200:203],v[64:67],a[72:75],v[200:203]
v_mfma_f32_16x16x32_bf16 v[204:207],v[64:67],a[76:79],v[204:207]
v_mfma_f32_16x16x32_bf16 v[208:211],v[64:67],a[80:83],v[208:211]
v_mfma_f32_16x16x32_bf16 v[212:215],v[64:67],a[84:87],v[212:215]
v_mfma_f32_16x16x32_bf16 v[216:219],v[64:67],a[88:91],v[216:219]
v_mfma_f32_16x16x32_bf16 v[220:223],v[64:67],a[92:95],v[220:223]
v_mfma_f32_16x16x32_bf16 v[192:195],v[68:71],a[96:99],v[192:195]
v_mfma_f32_16x16x32_bf16 v[196:199],v[68:71],a[100:103],v[196:199]
v_mfma_f32_16x16x32_bf16 v[200:203],v[68:71],a[104:107],v[200:203]
v_mfma_f32_16x16x32_bf16 v[204:207],v[68:71],a[108:111],v[204:207]
v_mfma_f32_16x16x32_bf16 v[208:211],v[68:71],a[112:115],v[208:211]
s_add_u32 s62,s69,0
v_mfma_f32_16x16x32_bf16 v[212:215],v[68:71],a[116:119],v[212:215]
buffer_store_dwordx4 v[24:27],v5,s[8:11],s62 offen sc1
v_mfma_f32_16x16x32_bf16 v[216:219],v[68:71],a[120:123],v[216:219]
v_mfma_f32_16x16x32_bf16 v[220:223],v[68:71],a[124:127],v[220:223]
v_mfma_f32_16x16x32_bf16 v[192:195],v[72:75],a[128:131],v[192:195]
v_mfma_f32_16x16x32_bf16 v[196:199],v[72:75],a[132:135],v[196:199]
s_add_u32 s62,s69,16384
v_mfma_f32_16x16x32_bf16 v[200:203],v[72:75],a[136:139],v[200:203]
buffer_store_dwordx4 v[28:31],v5,s[8:11],s62 offen sc1
v_mfma_f32_16x16x32_bf16 v[204:207],v[72:75],a[140:143],v[204:207]
v_mfma_f32_16x16x32_bf16 v[208:211],v[72:75],a[144:147],v[208:211]
v_mfma_f32_16x16x32_bf16 v[212:215],v[72:75],a[148:151],v[212:215]
v_mfma_f32_16x16x32_bf16 v[216:219],v[72:75],a[152:155],v[216:219]
s_add_u32 s62,s69,32768
v_mfma_f32_16x16x32_bf16 v[220:223],v[72:75],a[156:159],v[220:223]
buffer_store_dwordx4 v[32:35],v5,s[8:11],s62 offen sc1
v_mfma_f32_16x16x32_bf16 v[192:195],v[76:79],a[160:163],v[192:195]
v_mfma_f32_16x16x32_bf16 v[196:199],v[76:79],a[164:167],v[196:199]
v_mfma_f32_16x16x32_bf16 v[200:203],v[76:79],a[168:171],v[200:203]
v_mfma_f32_16x16x32_bf16 v[204:207],v[76:79],a[172:175],v[204:207]
s_add_u32 s62,s69,49152
v_mfma_f32_16x16x32_bf16 v[208:211],v[76:79],a[176:179],v[208:211]
buffer_store_dwordx4 v[36:39],v5,s[8:11],s62 offen sc1
v_mfma_f32_16x16x32_bf16 v[212:215],v[76:79],a[180:183],v[212:215]
v_mfma_f32_16x16x32_bf16 v[216:219],v[76:79],a[184:187],v[216:219]
v_mfma_f32_16x16x32_bf16 v[220:223],v[76:79],a[188:191],v[220:223]
v_mfma_f32_16x16x32_bf16 v[192:195],v[80:83],a[192:195],v[192:195]
v_mfma_f32_16x16x32_bf16 v[196:199],v[80:83],a[196:199],v[196:199]
v_mfma_f32_16x16x32_bf16 v[192:195],v[84:87],a[224:227],v[192:195]
v_mfma_f32_16x16x32_bf16 v[196:199],v[84:87],a[228:231],v[196:199]
v_mfma_f32_16x16x32_bf16 v[200:203],v[80:83],a[200:203],v[200:203]
v_mfma_f32_16x16x32_bf16 v[204:207],v[80:83],a[204:207],v[204:207]
v_mfma_f32_16x16x32_bf16 v[200:203],v[84:87],a[232:235],v[200:203]
v_mfma_f32_16x16x32_bf16 v[204:207],v[84:87],a[236:239],v[204:207]
v_cvt_pk_bf16_f32 v40,v192,v196
v_cvt_pk_bf16_f32 v44,v193,v197
v_cvt_pk_bf16_f32 v48,v194,v198
v_mfma_f32_16x16x32_bf16 v[208:211],v[80:83],a[208:211],v[208:211]
v_cvt_pk_bf16_f32 v52,v195,v199
v_mfma_f32_16x16x32_bf16 v[212:215],v[80:83],a[212:215],v[212:215]
v_cvt_pk_bf16_f32 v41,v200,v204
v_cvt_pk_bf16_f32 v45,v201,v205
v_cvt_pk_bf16_f32 v49,v202,v206
v_mfma_f32_16x16x32_bf16 v[208:211],v[84:87],a[240:243],v[208:211]
v_cvt_pk_bf16_f32 v53,v203,v207
v_mfma_f32_16x16x32_bf16 v[212:215],v[84:87],a[244:247],v[212:215]
v_mfma_f32_16x16x32_bf16 v[216:219],v[80:83],a[216:219],v[216:219]
v_mfma_f32_16x16x32_bf16 v[220:223],v[80:83],a[220:223],v[220:223]
v_mfma_f32_16x16x32_bf16 v[216:219],v[84:87],a[248:251],v[216:219]
v_mfma_f32_16x16x32_bf16 v[220:223],v[84:87],a[252:255],v[220:223]
v_cvt_pk_bf16_f32 v42,v208,v212
v_cvt_pk_bf16_f32 v46,v209,v213
v_cvt_pk_bf16_f32 v50,v210,v214
v_cvt_pk_bf16_f32 v54,v211,v215
s_nop 3
v_cvt_pk_bf16_f32 v43,v216,v220
s_add_u32 s62,s69,262144
buffer_store_dwordx4 v[40:43],v5,s[8:11],s62 offen sc1
v_cvt_pk_bf16_f32 v47,v217,v221
s_add_u32 s62,s69,278528
buffer_store_dwordx4 v[44:47],v5,s[8:11],s62 offen sc1
v_cvt_pk_bf16_f32 v51,v218,v222
s_add_u32 s62,s69,294912
buffer_store_dwordx4 v[48:51],v5,s[8:11],s62 offen sc1
v_cvt_pk_bf16_f32 v55,v219,v223
s_add_u32 s62,s69,311296
buffer_store_dwordx4 v[52:55],v5,s[8:11],s62 offen sc1
s_cmp_lg_u32 s72,0
s_cbranch_scc1 L_aa_313
s_waitcnt vmcnt(8)
s_branch L_aa_323
L_av_328:
s_bitcmp1_b32 s46,0
s_cbranch_scc1 L_av_329
ds_read_b128 v[24:27],v4 offset:0
ds_read_b128 v[28:31],v4 offset:1024
s_min_u32 s56,s32,s33
s_cmp_lt_u32 s77,64
s_cselect_b32 s56,s56,0
s_cmp_eq_u32 s56,0
s_cselect_b32 s72,0x80000000,0
v_mov_b32 v248,s72
s_or_b32 s64,s70,s72
s_or_b32 s65,s71,s72
s_cmp_lt_u32 s30,s31
s_cselect_b32 s65,0x80000000,s65
s_add_u32 s64,s64,s28
s_add_u32 s65,s65,s29
s_xor_b32 s58,s67,s40
s_xor_b32 s57,s67,s41
s_add_u32 m0,s58,0
s_waitcnt lgkmcnt(1)
v_mfma_f32_16x16x32_bf16 v[160:163],v[24:27],a[0:3],0
buffer_load_dwordx4 v0,s[8:11],s64 offen offset:0 sc1 lds
v_mfma_f32_16x16x32_bf16 v[164:167],v[24:27],a[4:7],0
ds_read_b128 v[32:35],v4 offset:2048
v_lshlrev_b32 v88,16,v224
v_mfma_f32_16x16x32_bf16 v[168:171],v[24:27],a[8:11],0
ds_read_b128 v[36:39],v4 offset:3072
v_and_b32 v89,0xffff0000,v224
v_mfma_f32_16x16x32_bf16 v[172:175],v[24:27],a[12:15],0
ds_read_b128 v[40:43],v4 offset:8192
v_lshlrev_b32 v90,16,v225
v_mfma_f32_16x16x32_bf16 v[176:179],v[24:27],a[16:19],0
buffer_load_dwordx4 v0,s[8:11],s64 offen offset:1024 sc1 lds
v_mfma_f32_16x16x32_bf16 v[180:183],v[24:27],a[20:23],0
ds_read_b128 v[44:47],v4 offset:9216
v_and_b32 v91,0xffff0000,v225
v_mfma_f32_16x16x32_bf16 v[184:187],v[24:27],a[24:27],0
ds_read_b128 v[48:51],v4 offset:10240
s_waitcnt vmcnt(9)
v_mfma_f32_16x16x32_bf16 v[188:191],v[24:27],a[28:31],0
ds_read_b128 v[52:55],v4 offset:11264
v_mfma_f32_16x16x32_bf16 v[128:131],v[156:159],v[192:195],0
ds_write_b32 v247,v248
v_lshlrev_b32 v92,16,v226
s_waitcnt lgkmcnt(7)
v_mfma_f32_16x16x32_bf16 v[160:163],v[28:31],a[32:35],v[160:163]
buffer_load_dwordx4 v0,s[8:11],s64 offen offset:2048 sc1 lds
v_mfma_f32_16x16x32_bf16 v[164:167],v[28:31],a[36:39],v[164:167]
ds_read_b128 v[56:59],v4 offset:4096
s_waitcnt vmcnt(9)
v_mfma_f32_16x16x32_bf16 v[168:171],v[28:31],a[40:43],v[168:171]
ds_read_b128 v[60:63],v4 offset:5120
v_mfma_f32_16x16x32_bf16 v[128:131],v[156:159],v[196:199],v[128:131]
ds_read_b128 v[64:67],v4 offset:6144
v_and_b32 v93,0xffff0000,v226
v_mfma_f32_16x16x32_bf16 v[172:175],v[28:31],a[44:47],v[172:175]
ds_read_b128 v[68:71],v4 offset:7168
s_waitcnt vmcnt(8)
v_mfma_f32_16x16x32_bf16 v[176:179],v[28:31],a[48:51],v[176:179]
buffer_load_dwordx4 v0,s[8:11],s64 offen offset:3072 sc1 lds
v_mfma_f32_16x16x32_bf16 v[180:183],v[28:31],a[52:55],v[180:183]
ds_read_b128 v[72:75],v4 offset:12288
v_mfma_f32_16x16x32_bf16 v[128:131],v[156:159],v[200:203],v[128:131]
ds_read_b128 v[76:79],v4 offset:13312
v_lshlrev_b32 v94,16,v227
v_mfma_f32_16x16x32_bf16 v[184:187],v[28:31],a[56:59],v[184:187]
ds_read_b128 v[80:83],v4 offset:14336
s_waitcnt vmcnt(8)
v_mfma_f32_16x16x32_bf16 v[188:191],v[28:31],a[60:63],v[188:191]
ds_read_b128 v[84:87],v4 offset:15360
v_mfma_f32_16x16x32_bf16 v[128:131],v[156:159],v[204:207],v[128:131]
v_and_b32 v95,0xffff0000,v227
s_lshl_b32 s18,s26,5
s_waitcnt lgkmcnt(14)
v_mfma_f32_16x16x32_bf16 v[160:163],v[32:35],a[64:67],v[160:163]
s_waitcnt vmcnt(7)
v_mfma_f32_16x16x32_bf16 v[132:135],v[156:159],v[208:211],0
s_add_u32 m0,s58,4096
s_add_u32 s64,s64,4096
s_add_u32 s18,s18,s68
v_mfma_f32_16x16x32_bf16 v[164:167],v[32:35],a[68:71],v[164:167]
buffer_load_dwordx4 v0,s[8:11],s64 offen offset:0 sc1 lds
v_mfma_f32_16x16x32_bf16 v[168:171],v[32:35],a[72:75],v[168:171]
s_waitcnt vmcnt(7)
v_mfma_f32_16x16x32_bf16 v[132:135],v[156:159],v[212:215],v[132:135]
s_lshl_b32 s19,s18,10
s_add_u32 s20,s19,8388608
s_lshl_b32 s23,s51,5
v_mfma_f32_16x16x32_bf16 v[172:175],v[32:35],a[76:79],v[172:175]
s_waitcnt vmcnt(6)
v_mfma_f32_16x16x32_bf16 v[132:135],v[156:159],v[216:219],v[132:135]
s_add_u32 s23,s23,s68
s_lshl_b32 s24,s23,10
s_lshl_b32 s25,s51,10
v_mfma_f32_16x16x32_bf16 v[176:179],v[32:35],a[80:83],v[176:179]
ds_write_b128 v6,v[128:131]
v_mfma_f32_16x16x32_bf16 v[180:183],v[32:35],a[84:87],v[180:183]
buffer_load_dwordx4 v0,s[8:11],s64 offen offset:1024 sc1 lds
v_mfma_f32_16x16x32_bf16 v[184:187],v[32:35],a[88:91],v[184:187]
s_waitcnt vmcnt(6)
v_mfma_f32_16x16x32_bf16 v[132:135],v[156:159],v[220:223],v[132:135]
s_add_u32 s25,s25,2883584
s_cmp_eq_u32 s23,s55
s_cselect_b32 s25,s25,s24
v_mfma_f32_16x16x32_bf16 v[188:191],v[32:35],a[92:95],v[188:191]
s_add_u32 s25,s25,8388608
s_mov_b32 s6,268435456
s_cmp_eq_u32 s31,0
s_cselect_b32 s25,s24,s25
s_cselect_b64 s[4:5],s[16:17],s[44:45]
s_cmov_b32 s6,2097152
s_waitcnt lgkmcnt(14)
v_mfma_f32_16x16x32_bf16 v[160:163],v[36:39],a[96:99],v[160:163]
buffer_load_dwordx4 v[224:227],v0,s[4:7],s25 offen sc1
v_mfma_f32_16x16x32_bf16 v[164:167],v[36:39],a[100:103],v[164:167]
ds_write_b128 v6,v[132:135] offset:2048
v_mfma_f32_16x16x32_bf16 v[168:171],v[36:39],a[104:107],v[168:171]
buffer_load_dwordx4 v0,s[8:11],s64 offen offset:2048 sc1 lds
v_mfma_f32_16x16x32_bf16 v[172:175],v[36:39],a[108:111],v[172:175]
s_lshr_b32 s24,s55,5
s_cmp_lt_u32 s51,s24
s_cselect_b32 s24,1,2
v_mfma_f32_16x16x32_bf16 v[176:179],v[36:39],a[112:115],v[176:179]
v_mov_b32 v252,s24
s_lshl2_add_u32 s25,s51,11018240
v_mfma_f32_16x16x32_bf16 v[180:183],v[36:39],a[116:119],v[180:183]
s_lshl_b32 s24,s68,16
s_add_u32 s24,s24,s31
s_add_u32 s24,s24,s86
v_mfma_f32_16x16x32_bf16 v[184:187],v[36:39],a[120:123],v[184:187]
buffer_load_dwordx4 v0,s[8:11],s64 offen offset:3072 sc1 lds
v_mfma_f32_16x16x32_bf16 v[188:191],v[36:39],a[124:127],v[188:191]
s_waitcnt lgkmcnt(0)
s_barrier
s_cmp_eq_u32 s24,1537
s_cselect_b32 s25,s25,0x80000000
s_waitcnt lgkmcnt(14)
v_mfma_f32_16x16x32_bf16 v[160:163],v[40:43],a[128:131],v[160:163]
ds_read_b128 v[96:99],v23
v_mfma_f32_16x16x32_bf16 v[164:167],v[40:43],a[132:135],v[164:167]
ds_read_b128 v[100:103],v23 offset:16
v_mfma_f32_16x16x32_bf16 v[168:171],v[40:43],a[136:139],v[168:171]
buffer_store_dword v20,off,s[8:11],s73 sc1
s_add_u32 m0,s58,8192
s_add_u32 s64,s64,4096
s_mov_b32 s73,0x80000000
v_mfma_f32_16x16x32_bf16 v[172:175],v[40:43],a[140:143],v[172:175]
buffer_load_dwordx4 v0,s[8:11],s64 offen offset:0 sc1 lds
v_mfma_f32_16x16x32_bf16 v[176:179],v[40:43],a[144:147],v[176:179]
ds_read_b128 v[248:251],v245
v_mfma_f32_16x16x32_bf16 v[180:183],v[40:43],a[148:151],v[180:183]
buffer_store_dword v252,off,s[8:11],s25 sc1
s_bitcmp1_b64 s[38:39],s51
s_cselect_b32 s24,128,0
s_lshl_b32 s23,s51,13
v_mfma_f32_16x16x32_bf16 v[184:187],v[40:43],a[152:155],v[184:187]
s_lshl2_add_u32 s23,s68,s23
s_add_u32 s23,s23,10487168
s_add_u32 s23,s23,s24
v_mfma_f32_16x16x32_bf16 v[188:191],v[40:43],a[156:159],v[188:191]
buffer_load_dwordx4 v0,s[8:11],s64 offen offset:1024 sc1 lds
s_waitcnt lgkmcnt(1)
v_cvt_pk_bf16_f32 v104,v96,v97
v_cvt_pk_bf16_f32 v105,v98,v99
v_mfma_f32_16x16x32_bf16 v[160:163],v[44:47],a[160:163],v[160:163]
buffer_load_dword v246,off,s[8:11],s23 sc1
v_cvt_pk_bf16_f32 v106,v100,v101
v_cvt_pk_bf16_f32 v107,v102,v103
v_lshlrev_b32 v96,16,v104
v_mfma_f32_16x16x32_bf16 v[164:167],v[44:47],a[164:167],v[164:167]
v_and_b32 v97,0xffff0000,v104
v_lshlrev_b32 v98,16,v105
v_and_b32 v99,0xffff0000,v105
v_lshlrev_b32 v100,16,v106
v_and_b32 v101,0xffff0000,v106
v_mfma_f32_16x16x32_bf16 v[168:171],v[44:47],a[168:171],v[168:171]
s_waitcnt lgkmcnt(0)
v_lshlrev_b32 v102,16,v107
v_and_b32 v103,0xffff0000,v107
v_add_f32 v88,v88,v96
v_add_f32 v89,v89,v97
v_add_f32 v90,v90,v98
v_mfma_f32_16x16x32_bf16 v[172:175],v[44:47],a[172:175],v[172:175]
buffer_load_dwordx4 v0,s[8:11],s64 offen offset:2048 sc1 lds
v_add_f32 v91,v91,v99
v_add_f32 v92,v92,v100
v_add_f32 v93,v93,v101
v_mfma_f32_16x16x32_bf16 v[176:179],v[44:47],a[176:179],v[176:179]
v_add_f32 v94,v94,v102
v_add_f32 v95,v95,v103
v_cvt_pk_bf16_f32 v104,v88,v89
v_cvt_pk_bf16_f32 v105,v90,v91
v_cvt_pk_bf16_f32 v106,v92,v93
v_mfma_f32_16x16x32_bf16 v[180:183],v[44:47],a[180:183],v[180:183]
v_cvt_pk_bf16_f32 v107,v94,v95
v_lshlrev_b32 v88,16,v104
v_and_b32 v89,0xffff0000,v104
v_lshlrev_b32 v90,16,v105
v_and_b32 v91,0xffff0000,v105
v_mfma_f32_16x16x32_bf16 v[184:187],v[44:47],a[184:187],v[184:187]
v_lshlrev_b32 v92,16,v106
v_and_b32 v93,0xffff0000,v106
v_lshlrev_b32 v94,16,v107
v_and_b32 v95,0xffff0000,v107
v_readfirstlane_b32 s78,v88
v_mfma_f32_16x16x32_bf16 v[188:191],v[44:47],a[188:191],v[188:191]
buffer_load_dwordx4 v0,s[8:11],s64 offen offset:3072 sc1 lds
v_add_f32 v120,v88,-s78
v_add_f32 v121,v89,-s78
v_add_f32 v122,v90,-s78
v_mfma_f32_16x16x32_bf16 v[160:163],v[48:51],a[192:195],v[160:163]
v_add_f32 v123,v91,-s78
v_add_f32 v124,v92,-s78
v_add_f32 v125,v93,-s78
v_add_f32 v126,v94,-s78
v_add_f32 v127,v95,-s78
v_mfma_f32_16x16x32_bf16 v[164:167],v[48:51],a[196:199],v[164:167]
v_add_f32 v128,v120,v122
v_add_f32 v129,v121,v123
v_mul_f32 v130,v120,v120
v_mul_f32 v131,v121,v121
v_add_f32 v132,v124,v126
v_mfma_f32_16x16x32_bf16 v[168:171],v[48:51],a[200:203],v[168:171]
v_add_f32 v133,v125,v127
v_fma_f32 v130,v122,v122,v130
v_fma_f32 v131,v123,v123,v131
v_add_f32 v128,v128,v132
v_add_f32 v129,v129,v133
v_mfma_f32_16x16x32_bf16 v[172:175],v[48:51],a[204:207],v[172:175]
v_fma_f32 v130,v124,v124,v130
v_fma_f32 v131,v125,v125,v131
v_add_f32 v128,v128,v129
v_fma_f32 v130,v126,v126,v130
v_fma_f32 v131,v127,v127,v131
v_mfma_f32_16x16x32_bf16 v[176:179],v[48:51],a[208:211],v[176:179]
v_add_f32 v130,v130,v131
v_or3_b32 v248,v248,v249,v250
v_or_b32 v248,v248,v251
v_permlane32_swap_b32 v128,v130
v_add_f32 v128,v128,v130
v_mfma_f32_16x16x32_bf16 v[180:183],v[48:51],a[212:215],v[180:183]
s_nop 0
v_add_f32_dpp v128,v128,v128 row_ror:8 row_mask:0xf bank_mask:0xf
v_lshrrev_b32 v244,4,v1
s_sub_u32 s23,s77,8
v_add_f32_dpp v128,v128,v128 row_ror:4 row_mask:0xf bank_mask:0xf
v_add_u32 v244,s23,v244
v_mfma_f32_16x16x32_bf16 v[184:187],v[48:51],a[216:219],v[184:187]
v_add_f32_dpp v128,v128,v128 row_ror:2 row_mask:0xf bank_mask:0xf
v_readfirstlane_b32 s72,v248
v_max_i32 v244,0,v244
v_add_f32_dpp v128,v128,v128 row_ror:1 row_mask:0xf bank_mask:0xf
v_mov_b32 v130,v128
v_mfma_f32_16x16x32_bf16 v[188:191],v[48:51],a[220:223],v[188:191]
s_nop 0
v_permlane16_swap_b32 v128,v130
v_add_f32 v128,v128,v130
v_mul_f32 v128,0x3b000000,v128
v_mov_b32 v130,v128
v_lshl_add_u32 v244,v244,13,v21
v_mfma_f32_16x16x32_bf16 v[160:163],v[52:55],a[224:227],v[160:163]
buffer_load_dwordx2 v[242:243],v244,s[8:11],0 offen sc1
v_permlane32_swap_b32 v128,v130
v_fma_f32 v130,-v128,v128,v130
v_add_f32 v128,s78,v128
v_mfma_f32_16x16x32_bf16 v[164:167],v[52:55],a[228:231],v[164:167]
v_max_f32 v130,0,v130
v_cvt_pk_bf16_f32 v130,v128,v130
v_lshlrev_b32 v128,16,v130
v_and_b32 v130,0xffff0000,v130
v_add_f32 v130,0x3727c5ac,v130
v_mfma_f32_16x16x32_bf16 v[168:171],v[52:55],a[232:235],v[168:171]
v_cvt_pk_bf16_f32 v130,v130,v130
v_and_b32 v130,0xffff0000,v130
v_sqrt_f32 v130,v130
v_add_f32 v120,v88,-v128
v_add_f32 v121,v89,-v128
v_mfma_f32_16x16x32_bf16 v[172:175],v[52:55],a[236:239],v[172:175]
v_add_f32 v122,v90,-v128
v_add_f32 v123,v91,-v128
v_add_f32 v124,v92,-v128
v_add_f32 v125,v93,-v128
v_add_f32 v126,v94,-v128
v_mfma_f32_16x16x32_bf16 v[176:179],v[52:55],a[240:243],v[176:179]
v_add_f32 v127,v95,-v128
v_cvt_pk_bf16_f32 v130,v130,v130
v_and_b32 v130,0xffff0000,v130
v_rcp_f32 v130,v130
v_cvt_pk_bf16_f32 v108,v120,v121
v_mfma_f32_16x16x32_bf16 v[180:183],v[52:55],a[244:247],v[180:183]
v_cvt_pk_bf16_f32 v109,v122,v123
v_cvt_pk_bf16_f32 v110,v124,v125
v_cvt_pk_bf16_f32 v111,v126,v127
v_lshlrev_b32 v120,16,v108
v_and_b32 v121,0xffff0000,v108
v_mfma_f32_16x16x32_bf16 v[184:187],v[52:55],a[248:251],v[184:187]
v_lshlrev_b32 v122,16,v109
v_and_b32 v123,0xffff0000,v109
v_lshlrev_b32 v124,16,v110
v_and_b32 v125,0xffff0000,v110
v_lshlrev_b32 v126,16,v111
v_mfma_f32_16x16x32_bf16 v[188:191],v[52:55],a[252:255],v[188:191]
v_and_b32 v127,0xffff0000,v111
v_mul_f32 v120,v120,v130
v_mul_f32 v121,v121,v130
v_mul_f32 v122,v122,v130
v_mul_f32 v123,v123,v130
v_mfma_f32_16x16x32_bf16 v[192:195],v[56:59],a[0:3],0
v_mul_f32 v124,v124,v130
v_mul_f32 v125,v125,v130
v_mul_f32 v126,v126,v130
v_mul_f32 v127,v127,v130
v_cvt_pk_bf16_f32 v108,v120,v121
v_mfma_f32_16x16x32_bf16 v[196:199],v[56:59],a[4:7],0
v_cvt_pk_bf16_f32 v109,v122,v123
v_cvt_pk_bf16_f32 v110,v124,v125
v_cvt_pk_bf16_f32 v111,v126,v127
v_lshlrev_b32 v112,16,v108
v_and_b32 v113,0xffff0000,v108
v_mfma_f32_16x16x32_bf16 v[200:203],v[56:59],a[8:11],0
v_lshlrev_b32 v114,16,v109
v_and_b32 v115,0xffff0000,v109
v_lshlrev_b32 v116,16,v110
v_and_b32 v117,0xffff0000,v110
v_lshlrev_b32 v118,16,v111
v_mfma_f32_16x16x32_bf16 v[204:207],v[56:59],a[12:15],0
v_and_b32 v119,0xffff0000,v111
v_add_f32 v88,v88,v112
v_add_f32 v89,v89,v113
v_add_f32 v90,v90,v114
v_add_f32 v91,v91,v115
v_mfma_f32_16x16x32_bf16 v[208:211],v[56:59],a[16:19],0
v_add_f32 v92,v92,v116
v_add_f32 v93,v93,v117
v_add_f32 v94,v94,v118
v_add_f32 v95,v95,v119
v_cvt_pk_bf16_f32 v96,v88,v89
v_mfma_f32_16x16x32_bf16 v[212:215],v[56:59],a[20:23],0
v_cvt_pk_bf16_f32 v97,v90,v91
v_cvt_pk_bf16_f32 v98,v92,v93
v_cvt_pk_bf16_f32 v99,v94,v95
v_cvt_pk_bf16_f32 v24,v160,v164
v_cvt_pk_bf16_f32 v25,v168,v172
v_mfma_f32_16x16x32_bf16 v[216:219],v[56:59],a[24:27],0
buffer_store_dwordx4 v[96:99],v0,s[8:11],s20 offen sc1
v_lshlrev_b32 v88,16,v96
v_and_b32 v89,0xffff0000,v96
v_lshlrev_b32 v90,16,v97
v_mfma_f32_16x16x32_bf16 v[220:223],v[56:59],a[28:31],0
v_and_b32 v91,0xffff0000,v97
v_lshlrev_b32 v92,16,v98
v_and_b32 v93,0xffff0000,v98
v_lshlrev_b32 v94,16,v99
v_and_b32 v95,0xffff0000,v99
v_mfma_f32_16x16x32_bf16 v[192:195],v[60:63],a[32:35],v[192:195]
v_readfirstlane_b32 s78,v88
v_cvt_pk_bf16_f32 v26,v176,v180
v_cvt_pk_bf16_f32 v27,v184,v188
v_add_f32 v120,v88,-s78
v_add_f32 v121,v89,-s78
v_mfma_f32_16x16x32_bf16 v[196:199],v[60:63],a[36:39],v[196:199]
v_add_f32 v122,v90,-s78
v_add_f32 v123,v91,-s78
v_add_f32 v124,v92,-s78
v_add_f32 v125,v93,-s78
v_add_f32 v126,v94,-s78
v_mfma_f32_16x16x32_bf16 v[200:203],v[60:63],a[40:43],v[200:203]
v_add_f32 v127,v95,-s78
v_add_f32 v128,v120,v122
v_add_f32 v129,v121,v123
v_mul_f32 v130,v120,v120
v_mul_f32 v131,v121,v121
v_mfma_f32_16x16x32_bf16 v[204:207],v[60:63],a[44:47],v[204:207]
v_add_f32 v132,v124,v126
v_add_f32 v133,v125,v127
v_fma_f32 v130,v122,v122,v130
v_fma_f32 v131,v123,v123,v131
v_add_f32 v128,v128,v132
v_mfma_f32_16x16x32_bf16 v[208:211],v[60:63],a[48:51],v[208:211]
v_add_f32 v129,v129,v133
v_fma_f32 v130,v124,v124,v130
v_fma_f32 v131,v125,v125,v131
v_add_f32 v128,v128,v129
v_fma_f32 v130,v126,v126,v130
v_mfma_f32_16x16x32_bf16 v[212:215],v[60:63],a[52:55],v[212:215]
v_fma_f32 v131,v127,v127,v131
v_add_f32 v130,v130,v131
v_cvt_pk_bf16_f32 v28,v161,v165
v_cvt_pk_bf16_f32 v29,v169,v173
v_permlane32_swap_b32 v128,v130
v_mfma_f32_16x16x32_bf16 v[216:219],v[60:63],a[56:59],v[216:219]
v_add_f32 v128,v128,v130
v_cvt_pk_bf16_f32 v30,v177,v181
v_cvt_pk_bf16_f32 v31,v185,v189
v_add_f32_dpp v128,v128,v128 row_ror:8 row_mask:0xf bank_mask:0xf
v_cvt_pk_bf16_f32 v32,v162,v166
v_mfma_f32_16x16x32_bf16 v[220:223],v[60:63],a[60:63],v[220:223]
v_add_f32_dpp v128,v128,v128 row_ror:4 row_mask:0xf bank_mask:0xf
v_cvt_pk_bf16_f32 v33,v170,v174
v_cvt_pk_bf16_f32 v34,v178,v182
v_add_f32_dpp v128,v128,v128 row_ror:2 row_mask:0xf bank_mask:0xf
v_cvt_pk_bf16_f32 v35,v186,v190
v_mfma_f32_16x16x32_bf16 v[192:195],v[64:67],a[64:67],v[192:195]
v_add_f32_dpp v128,v128,v128 row_ror:1 row_mask:0xf bank_mask:0xf
v_mov_b32 v130,v128
v_cvt_pk_bf16_f32 v36,v163,v167
v_cvt_pk_bf16_f32 v37,v171,v175
v_permlane16_swap_b32 v128,v130
v_mfma_f32_16x16x32_bf16 v[196:199],v[64:67],a[68:71],v[196:199]
v_add_f32 v128,v128,v130
v_mul_f32 v128,0x3b000000,v128
v_mov_b32 v130,v128
v_cvt_pk_bf16_f32 v38,v179,v183
v_cvt_pk_bf16_f32 v39,v187,v191
v_mfma_f32_16x16x32_bf16 v[200:203],v[64:67],a[72:75],v[200:203]
v_permlane32_swap_b32 v128,v130
v_fma_f32 v130,-v128,v128,v130
v_add_f32 v128,s78,v128
v_max_f32 v130,0,v130
v_cvt_pk_bf16_f32 v130,v128,v130
v_mfma_f32_16x16x32_bf16 v[204:207],v[64:67],a[76:79],v[204:207]
v_lshlrev_b32 v128,16,v130
v_and_b32 v130,0xffff0000,v130
v_add_f32 v130,0x3727c5ac,v130
v_cvt_pk_bf16_f32 v130,v130,v130
v_and_b32 v130,0xffff0000,v130
v_mfma_f32_16x16x32_bf16 v[208:211],v[64:67],a[80:83],v[208:211]
v_sqrt_f32 v130,v130
v_add_f32 v120,v88,-v128
v_add_f32 v121,v89,-v128
v_add_f32 v122,v90,-v128
v_add_f32 v123,v91,-v128
v_mfma_f32_16x16x32_bf16 v[212:215],v[64:67],a[84:87],v[212:215]
v_add_f32 v124,v92,-v128
v_add_f32 v125,v93,-v128
v_add_f32 v126,v94,-v128
v_add_f32 v127,v95,-v128
v_cvt_pk_bf16_f32 v130,v130,v130
v_mfma_f32_16x16x32_bf16 v[216:219],v[64:67],a[88:91],v[216:219]
v_and_b32 v130,0xffff0000,v130
v_rcp_f32 v130,v130
v_cvt_pk_bf16_f32 v100,v120,v121
v_cvt_pk_bf16_f32 v101,v122,v123
v_cvt_pk_bf16_f32 v102,v124,v125
v_mfma_f32_16x16x32_bf16 v[220:223],v[64:67],a[92:95],v[220:223]
v_cvt_pk_bf16_f32 v103,v126,v127
v_lshlrev_b32 v120,16,v100
v_and_b32 v121,0xffff0000,v100
v_lshlrev_b32 v122,16,v101
v_and_b32 v123,0xffff0000,v101
v_mfma_f32_16x16x32_bf16 v[192:195],v[68:71],a[96:99],v[192:195]
v_lshlrev_b32 v124,16,v102
v_and_b32 v125,0xffff0000,v102
v_lshlrev_b32 v126,16,v103
v_and_b32 v127,0xffff0000,v103
v_mul_f32 v120,v120,v130
v_mfma_f32_16x16x32_bf16 v[196:199],v[68:71],a[100:103],v[196:199]
v_mul_f32 v121,v121,v130
v_mul_f32 v122,v122,v130
v_mul_f32 v123,v123,v130
v_mul_f32 v124,v124,v130
v_mul_f32 v125,v125,v130
v_mfma_f32_16x16x32_bf16 v[200:203],v[68:71],a[104:107],v[200:203]
v_mul_f32 v126,v126,v130
v_mul_f32 v127,v127,v130
v_cvt_pk_bf16_f32 v100,v120,v121
v_cvt_pk_bf16_f32 v101,v122,v123
v_cvt_pk_bf16_f32 v102,v124,v125
v_mfma_f32_16x16x32_bf16 v[204:207],v[68:71],a[108:111],v[204:207]
v_cvt_pk_bf16_f32 v103,v126,v127
s_add_u32 s20,s19,2097152
v_mfma_f32_16x16x32_bf16 v[208:211],v[68:71],a[112:115],v[208:211]
buffer_store_dwordx4 v[100:103],v0,s[8:11],s20 offen sc1
v_mov_b32 v20,1
s_lshl_b32 s73,s26,13
s_lshl2_add_u32 s73,s68,s73
v_mfma_f32_16x16x32_bf16 v[212:215],v[68:71],a[116:119],v[212:215]
s_add_u32 s73,s73,10487552
s_add_u32 s62,s69,0
v_mfma_f32_16x16x32_bf16 v[216:219],v[68:71],a[120:123],v[216:219]
buffer_store_dwordx4 v[24:27],v5,s[8:11],s62 offen sc1
v_mfma_f32_16x16x32_bf16 v[220:223],v[68:71],a[124:127],v[220:223]
v_mfma_f32_16x16x32_bf16 v[192:195],v[72:75],a[128:131],v[192:195]
v_mfma_f32_16x16x32_bf16 v[196:199],v[72:75],a[132:135],v[196:199]
v_mfma_f32_16x16x32_bf16 v[200:203],v[72:75],a[136:139],v[200:203]
s_add_u32 s62,s69,16384
v_mfma_f32_16x16x32_bf16 v[204:207],v[72:75],a[140:143],v[204:207]
buffer_store_dwordx4 v[28:31],v5,s[8:11],s62 offen sc1
v_mfma_f32_16x16x32_bf16 v[208:211],v[72:75],a[144:147],v[208:211]
v_mfma_f32_16x16x32_bf16 v[212:215],v[72:75],a[148:151],v[212:215]
v_mfma_f32_16x16x32_bf16 v[216:219],v[72:75],a[152:155],v[216:219]
v_mfma_f32_16x16x32_bf16 v[220:223],v[72:75],a[156:159],v[220:223]
s_add_u32 s62,s69,32768
v_mfma_f32_16x16x32_bf16 v[192:195],v[76:79],a[160:163],v[192:195]
buffer_store_dwordx4 v[32:35],v5,s[8:11],s62 offen sc1
v_mfma_f32_16x16x32_bf16 v[196:199],v[76:79],a[164:167],v[196:199]
v_mfma_f32_16x16x32_bf16 v[200:203],v[76:79],a[168:171],v[200:203]
v_mfma_f32_16x16x32_bf16 v[204:207],v[76:79],a[172:175],v[204:207]
v_mfma_f32_16x16x32_bf16 v[208:211],v[76:79],a[176:179],v[208:211]
s_add_u32 s62,s69,49152
v_mfma_f32_16x16x32_bf16 v[212:215],v[76:79],a[180:183],v[212:215]
buffer_store_dwordx4 v[36:39],v5,s[8:11],s62 offen sc1
v_mfma_f32_16x16x32_bf16 v[216:219],v[76:79],a[184:187],v[216:219]
v_mfma_f32_16x16x32_bf16 v[220:223],v[76:79],a[188:191],v[220:223]
v_mfma_f32_16x16x32_bf16 v[192:195],v[80:83],a[192:195],v[192:195]
v_mfma_f32_16x16x32_bf16 v[196:199],v[80:83],a[196:199],v[196:199]
v_mfma_f32_16x16x32_bf16 v[192:195],v[84:87],a[224:227],v[192:195]
v_mfma_f32_16x16x32_bf16 v[196:199],v[84:87],a[228:231],v[196:199]
v_mfma_f32_16x16x32_bf16 v[200:203],v[80:83],a[200:203],v[200:203]
v_mfma_f32_16x16x32_bf16 v[204:207],v[80:83],a[204:207],v[204:207]
v_mfma_f32_16x16x32_bf16 v[200:203],v[84:87],a[232:235],v[200:203]
v_mfma_f32_16x16x32_bf16 v[204:207],v[84:87],a[236:239],v[204:207]
v_cvt_pk_bf16_f32 v40,v192,v196
v_cvt_pk_bf16_f32 v44,v193,v197
v_mfma_f32_16x16x32_bf16 v[208:211],v[80:83],a[208:211],v[208:211]
v_cvt_pk_bf16_f32 v48,v194,v198
v_cvt_pk_bf16_f32 v52,v195,v199
v_mfma_f32_16x16x32_bf16 v[212:215],v[80:83],a[212:215],v[212:215]
v_cvt_pk_bf16_f32 v41,v200,v204
v_cvt_pk_bf16_f32 v45,v201,v205
v_mfma_f32_16x16x32_bf16 v[208:211],v[84:87],a[240:243],v[208:211]
v_cvt_pk_bf16_f32 v49,v202,v206
v_cvt_pk_bf16_f32 v53,v203,v207
v_mfma_f32_16x16x32_bf16 v[212:215],v[84:87],a[244:247],v[212:215]
v_mfma_f32_16x16x32_bf16 v[216:219],v[80:83],a[216:219],v[216:219]
v_mfma_f32_16x16x32_bf16 v[220:223],v[80:83],a[220:223],v[220:223]
v_mfma_f32_16x16x32_bf16 v[216:219],v[84:87],a[248:251],v[216:219]
v_mfma_f32_16x16x32_bf16 v[220:223],v[84:87],a[252:255],v[220:223]
v_cvt_pk_bf16_f32 v42,v208,v212
v_cvt_pk_bf16_f32 v46,v209,v213
v_cvt_pk_bf16_f32 v50,v210,v214
v_cvt_pk_bf16_f32 v54,v211,v215
s_nop 3
v_cvt_pk_bf16_f32 v43,v216,v220
s_add_u32 s62,s69,262144
buffer_store_dwordx4 v[40:43],v5,s[8:11],s62 offen sc1
v_cvt_pk_bf16_f32 v47,v217,v221
s_add_u32 s62,s69,278528
buffer_store_dwordx4 v[44:47],v5,s[8:11],s62 offen sc1
v_cvt_pk_bf16_f32 v51,v218,v222
s_add_u32 s62,s69,294912
buffer_store_dwordx4 v[48:51],v5,s[8:11],s62 offen sc1
v_cvt_pk_bf16_f32 v55,v219,v223
s_add_u32 s62,s69,311296
buffer_store_dwordx4 v[52:55],v5,s[8:11],s62 offen sc1
s_waitcnt vmcnt(8)
buffer_store_dword v20,off,s[8:11],s73 sc1
s_mov_b32 s73,0x80000000
s_cmp_lg_u32 s72,0
s_cbranch_scc1 L_aa_313
s_waitcnt vmcnt(12)
s_branch L_aa_323
L_av_329:
ds_read_b128 v[24:27],v4 offset:0
ds_read_b128 v[28:31],v4 offset:1024
s_min_u32 s56,s32,s33
s_cmp_lt_u32 s77,64
s_cselect_b32 s56,s56,0
s_cmp_eq_u32 s56,0
s_cselect_b32 s72,0x80000000,0
v_mov_b32 v248,s72
s_or_b32 s64,s70,s72
s_or_b32 s65,s71,s72
s_cmp_lt_u32 s30,s31
s_cselect_b32 s65,0x80000000,s65
s_add_u32 s64,s64,s28
s_add_u32 s65,s65,s29
s_xor_b32 s58,s67,s40
s_xor_b32 s57,s67,s41
s_add_u32 m0,s58,0
s_waitcnt lgkmcnt(1)
v_mfma_f32_16x16x32_bf16 v[160:163],v[24:27],a[0:3],0
buffer_load_dwordx4 v0,s[8:11],s64 offen offset:0 sc1 lds
v_mfma_f32_16x16x32_bf16 v[164:167],v[24:27],a[4:7],0
ds_read_b128 v[32:35],v4 offset:2048
v_lshlrev_b32 v88,16,v224
v_mfma_f32_16x16x32_bf16 v[168:171],v[24:27],a[8:11],0
ds_read_b128 v[36:39],v4 offset:3072
v_and_b32 v89,0xffff0000,v224
v_mfma_f32_16x16x32_bf16 v[172:175],v[24:27],a[12:15],0
ds_read_b128 v[40:43],v4 offset:8192
v_lshlrev_b32 v90,16,v225
v_mfma_f32_16x16x32_bf16 v[176:179],v[24:27],a[16:19],0
buffer_load_dwordx4 v0,s[8:11],s64 offen offset:1024 sc1 lds
v_mfma_f32_16x16x32_bf16 v[180:183],v[24:27],a[20:23],0
ds_read_b128 v[44:47],v4 offset:9216
v_and_b32 v91,0xffff0000,v225
v_mfma_f32_16x16x32_bf16 v[184:187],v[24:27],a[24:27],0
ds_read_b128 v[48:51],v4 offset:10240
s_waitcnt vmcnt(9)
v_mfma_f32_16x16x32_bf16 v[188:191],v[24:27],a[28:31],0
ds_read_b128 v[52:55],v4 offset:11264
v_mfma_f32_16x16x32_bf16 v[128:131],v[156:159],v[192:195],0
ds_write_b32 v247,v248
v_lshlrev_b32 v92,16,v226
s_waitcnt lgkmcnt(7)
v_mfma_f32_16x16x32_bf16 v[160:163],v[28:31],a[32:35],v[160:163]
buffer_load_dwordx4 v0,s[8:11],s64 offen offset:2048 sc1 lds
v_mfma_f32_16x16x32_bf16 v[164:167],v[28:31],a[36:39],v[164:167]
ds_read_b128 v[56:59],v4 offset:4096
s_waitcnt vmcnt(9)
v_mfma_f32_16x16x32_bf16 v[168:171],v[28:31],a[40:43],v[168:171]
ds_read_b128 v[60:63],v4 offset:5120
v_mfma_f32_16x16x32_bf16 v[128:131],v[156:159],v[196:199],v[128:131]
ds_read_b128 v[64:67],v4 offset:6144
v_and_b32 v93,0xffff0000,v226
v_mfma_f32_16x16x32_bf16 v[172:175],v[28:31],a[44:47],v[172:175]
ds_read_b128 v[68:71],v4 offset:7168
s_waitcnt vmcnt(8)
v_mfma_f32_16x16x32_bf16 v[176:179],v[28:31],a[48:51],v[176:179]
buffer_load_dwordx4 v0,s[8:11],s64 offen offset:3072 sc1 lds
v_mfma_f32_16x16x32_bf16 v[180:183],v[28:31],a[52:55],v[180:183]
ds_read_b128 v[72:75],v4 offset:12288
v_mfma_f32_16x16x32_bf16 v[128:131],v[156:159],v[200:203],v[128:131]
ds_read_b128 v[76:79],v4 offset:13312
v_lshlrev_b32 v94,16,v227
v_mfma_f32_16x16x32_bf16 v[184:187],v[28:31],a[56:59],v[184:187]
ds_read_b128 v[80:83],v4 offset:14336
s_waitcnt vmcnt(8)
v_mfma_f32_16x16x32_bf16 v[188:191],v[28:31],a[60:63],v[188:191]
ds_read_b128 v[84:87],v4 offset:15360
v_mfma_f32_16x16x32_bf16 v[128:131],v[156:159],v[204:207],v[128:131]
v_and_b32 v95,0xffff0000,v227
s_lshl_b32 s18,s26,5
s_waitcnt lgkmcnt(14)
v_mfma_f32_16x16x32_bf16 v[160:163],v[32:35],a[64:67],v[160:163]
s_waitcnt vmcnt(7)
v_mfma_f32_16x16x32_bf16 v[132:135],v[156:159],v[208:211],0
s_add_u32 m0,s58,4096
s_add_u32 s64,s64,4096
s_add_u32 s18,s18,s68
v_mfma_f32_16x16x32_bf16 v[164:167],v[32:35],a[68:71],v[164:167]
buffer_load_dwordx4 v0,s[8:11],s64 offen offset:0 sc1 lds
v_mfma_f32_16x16x32_bf16 v[168:171],v[32:35],a[72:75],v[168:171]
s_waitcnt vmcnt(7)
v_mfma_f32_16x16x32_bf16 v[132:135],v[156:159],v[212:215],v[132:135]
s_lshl_b32 s19,s18,10
s_add_u32 s20,s19,4194304
s_lshl_b32 s23,s51,5
v_mfma_f32_16x16x32_bf16 v[172:175],v[32:35],a[76:79],v[172:175]
s_waitcnt vmcnt(6)
v_mfma_f32_16x16x32_bf16 v[132:135],v[156:159],v[216:219],v[132:135]
s_add_u32 s23,s23,s68
s_lshl_b32 s24,s23,10
s_lshl_b32 s25,s51,10
v_mfma_f32_16x16x32_bf16 v[176:179],v[32:35],a[80:83],v[176:179]
ds_write_b128 v6,v[128:131]
v_mfma_f32_16x16x32_bf16 v[180:183],v[32:35],a[84:87],v[180:183]
buffer_load_dwordx4 v0,s[8:11],s64 offen offset:1024 sc1 lds
v_mfma_f32_16x16x32_bf16 v[184:187],v[32:35],a[88:91],v[184:187]
s_waitcnt vmcnt(6)
v_mfma_f32_16x16x32_bf16 v[132:135],v[156:159],v[220:223],v[132:135]
s_add_u32 s25,s25,2883584
s_cmp_eq_u32 s23,s55
s_cselect_b32 s25,s25,s24
v_mfma_f32_16x16x32_bf16 v[188:191],v[32:35],a[92:95],v[188:191]
s_add_u32 s25,s25,8388608
s_mov_b32 s6,268435456
s_cmp_eq_u32 s31,0
s_cselect_b32 s25,s24,s25
s_cselect_b64 s[4:5],s[16:17],s[44:45]
s_cmov_b32 s6,2097152
s_waitcnt lgkmcnt(14)
v_mfma_f32_16x16x32_bf16 v[160:163],v[36:39],a[96:99],v[160:163]
buffer_load_dwordx4 v[224:227],v0,s[4:7],s25 offen sc1
v_mfma_f32_16x16x32_bf16 v[164:167],v[36:39],a[100:103],v[164:167]
ds_write_b128 v6,v[132:135] offset:2048
v_mfma_f32_16x16x32_bf16 v[168:171],v[36:39],a[104:107],v[168:171]
buffer_load_dwordx4 v0,s[8:11],s64 offen offset:2048 sc1 lds
v_mfma_f32_16x16x32_bf16 v[172:175],v[36:39],a[108:111],v[172:175]
s_lshr_b32 s24,s55,5
s_cmp_lt_u32 s51,s24
s_cselect_b32 s24,1,2
v_mfma_f32_16x16x32_bf16 v[176:179],v[36:39],a[112:115],v[176:179]
v_mov_b32 v252,s24
s_lshl2_add_u32 s25,s51,11018240
v_mfma_f32_16x16x32_bf16 v[180:183],v[36:39],a[116:119],v[180:183]
s_lshl_b32 s24,s68,16
s_add_u32 s24,s24,s31
s_add_u32 s24,s24,s86
v_mfma_f32_16x16x32_bf16 v[184:187],v[36:39],a[120:123],v[184:187]
buffer_load_dwordx4 v0,s[8:11],s64 offen offset:3072 sc1 lds
v_mfma_f32_16x16x32_bf16 v[188:191],v[36:39],a[124:127],v[188:191]
s_waitcnt lgkmcnt(0)
s_barrier
s_cmp_eq_u32 s24,1537
s_cselect_b32 s25,s25,0x80000000
s_waitcnt lgkmcnt(14)
v_mfma_f32_16x16x32_bf16 v[160:163],v[40:43],a[128:131],v[160:163]
ds_read_b128 v[96:99],v23
v_mfma_f32_16x16x32_bf16 v[164:167],v[40:43],a[132:135],v[164:167]
ds_read_b128 v[100:103],v23 offset:16
v_mfma_f32_16x16x32_bf16 v[168:171],v[40:43],a[136:139],v[168:171]
buffer_store_dword v20,off,s[8:11],s73 sc1
s_add_u32 m0,s58,8192
s_add_u32 s64,s64,4096
s_mov_b32 s73,0x80000000
v_mfma_f32_16x16x32_bf16 v[172:175],v[40:43],a[140:143],v[172:175]
buffer_load_dwordx4 v0,s[8:11],s64 offen offset:0 sc1 lds
v_mfma_f32_16x16x32_bf16 v[176:179],v[40:43],a[144:147],v[176:179]
ds_read_b128 v[248:251],v245
v_mfma_f32_16x16x32_bf16 v[180:183],v[40:43],a[148:151],v[180:183]
buffer_store_dword v252,off,s[8:11],s25 sc1
s_bitcmp1_b64 s[38:39],s51
s_cselect_b32 s24,128,0
s_lshl_b32 s23,s51,13
v_mfma_f32_16x16x32_bf16 v[184:187],v[40:43],a[152:155],v[184:187]
s_lshl2_add_u32 s23,s68,s23
s_add_u32 s23,s23,10487168
s_add_u32 s23,s23,s24
v_mfma_f32_16x16x32_bf16 v[188:191],v[40:43],a[156:159],v[188:191]
buffer_load_dwordx4 v0,s[8:11],s64 offen offset:1024 sc1 lds
s_waitcnt lgkmcnt(1)
v_cvt_pk_bf16_f32 v104,v96,v97
v_cvt_pk_bf16_f32 v105,v98,v99
v_mfma_f32_16x16x32_bf16 v[160:163],v[44:47],a[160:163],v[160:163]
buffer_load_dword v246,off,s[8:11],s23 sc1
v_cvt_pk_bf16_f32 v106,v100,v101
v_cvt_pk_bf16_f32 v107,v102,v103
v_lshlrev_b32 v96,16,v104
v_mfma_f32_16x16x32_bf16 v[164:167],v[44:47],a[164:167],v[164:167]
v_and_b32 v97,0xffff0000,v104
v_lshlrev_b32 v98,16,v105
v_and_b32 v99,0xffff0000,v105
v_lshlrev_b32 v100,16,v106
v_and_b32 v101,0xffff0000,v106
v_mfma_f32_16x16x32_bf16 v[168:171],v[44:47],a[168:171],v[168:171]
s_waitcnt lgkmcnt(0)
v_lshlrev_b32 v102,16,v107
v_and_b32 v103,0xffff0000,v107
v_add_f32 v88,v88,v96
v_add_f32 v89,v89,v97
v_add_f32 v90,v90,v98
v_mfma_f32_16x16x32_bf16 v[172:175],v[44:47],a[172:175],v[172:175]
buffer_load_dwordx4 v0,s[8:11],s64 offen offset:2048 sc1 lds
v_add_f32 v91,v91,v99
v_add_f32 v92,v92,v100
v_add_f32 v93,v93,v101
v_mfma_f32_16x16x32_bf16 v[176:179],v[44:47],a[176:179],v[176:179]
v_add_f32 v94,v94,v102
v_add_f32 v95,v95,v103
v_cvt_pk_bf16_f32 v104,v88,v89
v_cvt_pk_bf16_f32 v105,v90,v91
v_cvt_pk_bf16_f32 v106,v92,v93
v_mfma_f32_16x16x32_bf16 v[180:183],v[44:47],a[180:183],v[180:183]
v_cvt_pk_bf16_f32 v107,v94,v95
v_or3_b32 v248,v248,v249,v250
v_or_b32 v248,v248,v251
v_lshrrev_b32 v244,4,v1
s_sub_u32 s23,s77,8
v_mfma_f32_16x16x32_bf16 v[184:187],v[44:47],a[184:187],v[184:187]
buffer_store_dwordx4 v[104:107],v0,s[8:11],s20 offen sc1
v_lshlrev_b32 v88,16,v104
v_and_b32 v89,0xffff0000,v104
v_lshlrev_b32 v90,16,v105
v_mfma_f32_16x16x32_bf16 v[188:191],v[44:47],a[188:191],v[188:191]
buffer_load_dwordx4 v0,s[8:11],s64 offen offset:3072 sc1 lds
v_and_b32 v91,0xffff0000,v105
v_lshlrev_b32 v92,16,v106
v_and_b32 v93,0xffff0000,v106
v_mfma_f32_16x16x32_bf16 v[160:163],v[48:51],a[192:195],v[160:163]
v_lshlrev_b32 v94,16,v107
v_and_b32 v95,0xffff0000,v107
v_readfirstlane_b32 s78,v88
v_readfirstlane_b32 s72,v248
v_add_u32 v244,s23,v244
v_mfma_f32_16x16x32_bf16 v[164:167],v[48:51],a[196:199],v[164:167]
v_add_f32 v120,v88,-s78
v_add_f32 v121,v89,-s78
v_add_f32 v122,v90,-s78
v_add_f32 v123,v91,-s78
v_add_f32 v124,v92,-s78
v_mfma_f32_16x16x32_bf16 v[168:171],v[48:51],a[200:203],v[168:171]
v_add_f32 v125,v93,-s78
v_add_f32 v126,v94,-s78
v_add_f32 v127,v95,-s78
v_add_f32 v128,v120,v122
v_add_f32 v129,v121,v123
v_mfma_f32_16x16x32_bf16 v[172:175],v[48:51],a[204:207],v[172:175]
v_mul_f32 v130,v120,v120
v_mul_f32 v131,v121,v121
v_add_f32 v132,v124,v126
v_add_f32 v133,v125,v127
v_fma_f32 v130,v122,v122,v130
v_mfma_f32_16x16x32_bf16 v[176:179],v[48:51],a[208:211],v[176:179]
v_fma_f32 v131,v123,v123,v131
v_add_f32 v128,v128,v132
v_add_f32 v129,v129,v133
v_fma_f32 v130,v124,v124,v130
v_fma_f32 v131,v125,v125,v131
v_mfma_f32_16x16x32_bf16 v[180:183],v[48:51],a[212:215],v[180:183]
v_add_f32 v128,v128,v129
v_fma_f32 v130,v126,v126,v130
v_fma_f32 v131,v127,v127,v131
v_add_f32 v130,v130,v131
v_max_i32 v244,0,v244
v_mfma_f32_16x16x32_bf16 v[184:187],v[48:51],a[216:219],v[184:187]
v_permlane32_swap_b32 v128,v130
v_add_f32 v128,v128,v130
v_lshl_add_u32 v244,v244,13,v21
v_mfma_f32_16x16x32_bf16 v[188:191],v[48:51],a[220:223],v[188:191]
buffer_load_dwordx2 v[242:243],v244,s[8:11],0 offen sc1
v_add_f32_dpp v128,v128,v128 row_ror:8 row_mask:0xf bank_mask:0xf
v_mfma_f32_16x16x32_bf16 v[160:163],v[52:55],a[224:227],v[160:163]
s_nop 0
v_add_f32_dpp v128,v128,v128 row_ror:4 row_mask:0xf bank_mask:0xf
v_mfma_f32_16x16x32_bf16 v[164:167],v[52:55],a[228:231],v[164:167]
s_nop 0
v_add_f32_dpp v128,v128,v128 row_ror:2 row_mask:0xf bank_mask:0xf
v_mfma_f32_16x16x32_bf16 v[168:171],v[52:55],a[232:235],v[168:171]
s_nop 0
v_add_f32_dpp v128,v128,v128 row_ror:1 row_mask:0xf bank_mask:0xf
v_mov_b32 v130,v128
v_mfma_f32_16x16x32_bf16 v[172:175],v[52:55],a[236:239],v[172:175]
s_nop 0
v_permlane16_swap_b32 v128,v130
v_add_f32 v128,v128,v130
v_mul_f32 v128,0x3b000000,v128
v_mov_b32 v130,v128
v_mfma_f32_16x16x32_bf16 v[176:179],v[52:55],a[240:243],v[176:179]
s_nop 0
v_permlane32_swap_b32 v128,v130
v_fma_f32 v130,-v128,v128,v130
v_add_f32 v128,s78,v128
v_max_f32 v130,0,v130
v_cvt_pk_bf16_f32 v130,v128,v130
v_mfma_f32_16x16x32_bf16 v[180:183],v[52:55],a[244:247],v[180:183]
v_lshlrev_b32 v128,16,v130
v_and_b32 v130,0xffff0000,v130
v_add_f32 v130,0x3727c5ac,v130
v_cvt_pk_bf16_f32 v130,v130,v130
v_and_b32 v130,0xffff0000,v130
v_mfma_f32_16x16x32_bf16 v[184:187],v[52:55],a[248:251],v[184:187]
v_sqrt_f32 v130,v130
v_add_f32 v120,v88,-v128
v_add_f32 v121,v89,-v128
v_add_f32 v122,v90,-v128
v_add_f32 v123,v91,-v128
v_mfma_f32_16x16x32_bf16 v[188:191],v[52:55],a[252:255],v[188:191]
v_add_f32 v124,v92,-v128
v_add_f32 v125,v93,-v128
v_add_f32 v126,v94,-v128
v_add_f32 v127,v95,-v128
v_cvt_pk_bf16_f32 v130,v130,v130
v_mfma_f32_16x16x32_bf16 v[192:195],v[56:59],a[0:3],0
v_and_b32 v130,0xffff0000,v130
v_rcp_f32 v130,v130
v_cvt_pk_bf16_f32 v108,v120,v121
v_cvt_pk_bf16_f32 v109,v122,v123
v_cvt_pk_bf16_f32 v110,v124,v125
v_mfma_f32_16x16x32_bf16 v[196:199],v[56:59],a[4:7],0
v_cvt_pk_bf16_f32 v111,v126,v127
v_lshlrev_b32 v120,16,v108
v_and_b32 v121,0xffff0000,v108
v_lshlrev_b32 v122,16,v109
v_and_b32 v123,0xffff0000,v109
v_mfma_f32_16x16x32_bf16 v[200:203],v[56:59],a[8:11],0
v_lshlrev_b32 v124,16,v110
v_and_b32 v125,0xffff0000,v110
v_lshlrev_b32 v126,16,v111
v_and_b32 v127,0xffff0000,v111
v_mul_f32 v120,v120,v130
v_mfma_f32_16x16x32_bf16 v[204:207],v[56:59],a[12:15],0
v_mul_f32 v121,v121,v130
v_mul_f32 v122,v122,v130
v_mul_f32 v123,v123,v130
v_mul_f32 v124,v124,v130
v_mul_f32 v125,v125,v130
v_mfma_f32_16x16x32_bf16 v[208:211],v[56:59],a[16:19],0
v_mul_f32 v126,v126,v130
v_mul_f32 v127,v127,v130
v_cvt_pk_bf16_f32 v108,v120,v121
v_cvt_pk_bf16_f32 v109,v122,v123
v_cvt_pk_bf16_f32 v110,v124,v125
v_mfma_f32_16x16x32_bf16 v[212:215],v[56:59],a[20:23],0
v_cvt_pk_bf16_f32 v111,v126,v127
v_lshlrev_b32 v112,16,v108
v_and_b32 v113,0xffff0000,v108
v_lshlrev_b32 v114,16,v109
v_and_b32 v115,0xffff0000,v109
v_mfma_f32_16x16x32_bf16 v[216:219],v[56:59],a[24:27],0
v_lshlrev_b32 v116,16,v110
v_and_b32 v117,0xffff0000,v110
v_lshlrev_b32 v118,16,v111
v_and_b32 v119,0xffff0000,v111
v_mul_f32 v236,v112,v228
v_mfma_f32_16x16x32_bf16 v[220:223],v[56:59],a[28:31],0
v_mul_f32 v237,v113,v229
v_fma_f32 v236,v114,v230,v236
v_fma_f32 v237,v115,v231,v237
v_fma_f32 v236,v116,v232,v236
v_fma_f32 v237,v117,v233,v237
v_mfma_f32_16x16x32_bf16 v[192:195],v[60:63],a[32:35],v[192:195]
v_fma_f32 v236,v118,v234,v236
v_fma_f32 v237,v119,v235,v237
v_add_f32 v236,v236,v237
v_cvt_pk_bf16_f32 v24,v160,v164
v_cvt_pk_bf16_f32 v25,v168,v172
v_mfma_f32_16x16x32_bf16 v[196:199],v[60:63],a[36:39],v[196:199]
v_add_f32_dpp v236,v236,v236 row_ror:8 row_mask:0xf bank_mask:0xf
v_cvt_pk_bf16_f32 v26,v176,v180
v_cvt_pk_bf16_f32 v27,v184,v188
v_add_f32_dpp v236,v236,v236 row_ror:4 row_mask:0xf bank_mask:0xf
v_cvt_pk_bf16_f32 v28,v161,v165
v_mfma_f32_16x16x32_bf16 v[200:203],v[60:63],a[40:43],v[200:203]
v_add_f32_dpp v236,v236,v236 row_ror:2 row_mask:0xf bank_mask:0xf
v_cvt_pk_bf16_f32 v29,v169,v173
v_cvt_pk_bf16_f32 v30,v177,v181
v_add_f32_dpp v236,v236,v236 row_ror:1 row_mask:0xf bank_mask:0xf
v_mov_b32 v237,v236
v_mfma_f32_16x16x32_bf16 v[204:207],v[60:63],a[44:47],v[204:207]
s_nop 0
v_permlane16_swap_b32 v236,v237
v_add_f32 v236,v236,v237
v_mov_b32 v237,v236
v_cvt_pk_bf16_f32 v31,v185,v189
v_cvt_pk_bf16_f32 v32,v162,v166
v_mfma_f32_16x16x32_bf16 v[208:211],v[60:63],a[48:51],v[208:211]
v_permlane32_swap_b32 v236,v237
v_add_f32 v236,v236,v237
v_cvt_pk_bf16_f32 v236,v236,v236
v_and_b32 v236,0xffff0000,v236
v_ashrrev_i32 v237,31,v236
v_mfma_f32_16x16x32_bf16 v[212:215],v[60:63],a[52:55],v[212:215]
v_or_b32 v237,0x80000000,v237
v_xor_b32 v236,v236,v237
v_and_b32 v236,0xffff0000,v236
s_sub_u32 s20,4095,s18
v_or_b32 v20,s20,v236
v_mfma_f32_16x16x32_bf16 v[216:219],v[60:63],a[56:59],v[216:219]
s_lshl_b32 s20,s26,13
s_lshl2_add_u32 s20,s68,s20
s_add_u32 s20,s20,10485760
v_mfma_f32_16x16x32_bf16 v[220:223],v[60:63],a[60:63],v[220:223]
buffer_store_dword v20,v254,s[8:11],s20 offen sc1
v_mfma_f32_16x16x32_bf16 v[192:195],v[64:67],a[64:67],v[192:195]
v_cvt_pk_bf16_f32 v33,v170,v174
v_cvt_pk_bf16_f32 v34,v178,v182
v_mfma_f32_16x16x32_bf16 v[196:199],v[64:67],a[68:71],v[196:199]
v_cvt_pk_bf16_f32 v35,v186,v190
v_cvt_pk_bf16_f32 v36,v163,v167
v_mfma_f32_16x16x32_bf16 v[200:203],v[64:67],a[72:75],v[200:203]
v_cvt_pk_bf16_f32 v37,v171,v175
v_cvt_pk_bf16_f32 v38,v179,v183
v_mfma_f32_16x16x32_bf16 v[204:207],v[64:67],a[76:79],v[204:207]
v_cvt_pk_bf16_f32 v39,v187,v191
v_mfma_f32_16x16x32_bf16 v[208:211],v[64:67],a[80:83],v[208:211]
v_mfma_f32_16x16x32_bf16 v[212:215],v[64:67],a[84:87],v[212:215]
v_mfma_f32_16x16x32_bf16 v[216:219],v[64:67],a[88:91],v[216:219]
v_mfma_f32_16x16x32_bf16 v[220:223],v[64:67],a[92:95],v[220:223]
v_mfma_f32_16x16x32_bf16 v[192:195],v[68:71],a[96:99],v[192:195]
v_mfma_f32_16x16x32_bf16 v[196:199],v[68:71],a[100:103],v[196:199]
v_mfma_f32_16x16x32_bf16 v[200:203],v[68:71],a[104:107],v[200:203]
v_mfma_f32_16x16x32_bf16 v[204:207],v[68:71],a[108:111],v[204:207]
v_mfma_f32_16x16x32_bf16 v[208:211],v[68:71],a[112:115],v[208:211]
s_add_u32 s62,s69,0
v_mfma_f32_16x16x32_bf16 v[212:215],v[68:71],a[116:119],v[212:215]
buffer_store_dwordx4 v[24:27],v5,s[8:11],s62 offen sc1
v_mfma_f32_16x16x32_bf16 v[216:219],v[68:71],a[120:123],v[216:219]
v_mfma_f32_16x16x32_bf16 v[220:223],v[68:71],a[124:127],v[220:223]
v_mfma_f32_16x16x32_bf16 v[192:195],v[72:75],a[128:131],v[192:195]
v_mfma_f32_16x16x32_bf16 v[196:199],v[72:75],a[132:135],v[196:199]
s_add_u32 s62,s69,16384
v_mfma_f32_16x16x32_bf16 v[200:203],v[72:75],a[136:139],v[200:203]
buffer_store_dwordx4 v[28:31],v5,s[8:11],s62 offen sc1
v_mfma_f32_16x16x32_bf16 v[204:207],v[72:75],a[140:143],v[204:207]
v_mfma_f32_16x16x32_bf16 v[208:211],v[72:75],a[144:147],v[208:211]
v_mfma_f32_16x16x32_bf16 v[212:215],v[72:75],a[148:151],v[212:215]
v_mfma_f32_16x16x32_bf16 v[216:219],v[72:75],a[152:155],v[216:219]
s_add_u32 s62,s69,32768
v_mfma_f32_16x16x32_bf16 v[220:223],v[72:75],a[156:159],v[220:223]
buffer_store_dwordx4 v[32:35],v5,s[8:11],s62 offen sc1
v_mfma_f32_16x16x32_bf16 v[192:195],v[76:79],a[160:163],v[192:195]
v_mfma_f32_16x16x32_bf16 v[196:199],v[76:79],a[164:167],v[196:199]
v_mfma_f32_16x16x32_bf16 v[200:203],v[76:79],a[168:171],v[200:203]
v_mfma_f32_16x16x32_bf16 v[204:207],v[76:79],a[172:175],v[204:207]
s_add_u32 s62,s69,49152
v_mfma_f32_16x16x32_bf16 v[208:211],v[76:79],a[176:179],v[208:211]
buffer_store_dwordx4 v[36:39],v5,s[8:11],s62 offen sc1
v_mfma_f32_16x16x32_bf16 v[212:215],v[76:79],a[180:183],v[212:215]
v_mfma_f32_16x16x32_bf16 v[216:219],v[76:79],a[184:187],v[216:219]
v_mfma_f32_16x16x32_bf16 v[220:223],v[76:79],a[188:191],v[220:223]
v_mfma_f32_16x16x32_bf16 v[192:195],v[80:83],a[192:195],v[192:195]
v_mfma_f32_16x16x32_bf16 v[196:199],v[80:83],a[196:199],v[196:199]
v_mfma_f32_16x16x32_bf16 v[192:195],v[84:87],a[224:227],v[192:195]
v_mfma_f32_16x16x32_bf16 v[196:199],v[84:87],a[228:231],v[196:199]
v_mfma_f32_16x16x32_bf16 v[200:203],v[80:83],a[200:203],v[200:203]
v_mfma_f32_16x16x32_bf16 v[204:207],v[80:83],a[204:207],v[204:207]
v_mfma_f32_16x16x32_bf16 v[200:203],v[84:87],a[232:235],v[200:203]
v_mfma_f32_16x16x32_bf16 v[204:207],v[84:87],a[236:239],v[204:207]
v_cvt_pk_bf16_f32 v40,v192,v196
v_cvt_pk_bf16_f32 v44,v193,v197
v_mfma_f32_16x16x32_bf16 v[208:211],v[80:83],a[208:211],v[208:211]
v_cvt_pk_bf16_f32 v48,v194,v198
v_cvt_pk_bf16_f32 v52,v195,v199
v_mfma_f32_16x16x32_bf16 v[212:215],v[80:83],a[212:215],v[212:215]
v_cvt_pk_bf16_f32 v41,v200,v204
v_cvt_pk_bf16_f32 v45,v201,v205
v_mfma_f32_16x16x32_bf16 v[208:211],v[84:87],a[240:243],v[208:211]
v_cvt_pk_bf16_f32 v49,v202,v206
v_cvt_pk_bf16_f32 v53,v203,v207
v_mfma_f32_16x16x32_bf16 v[212:215],v[84:87],a[244:247],v[212:215]
v_mfma_f32_16x16x32_bf16 v[216:219],v[80:83],a[216:219],v[216:219]
v_mfma_f32_16x16x32_bf16 v[220:223],v[80:83],a[220:223],v[220:223]
v_mfma_f32_16x16x32_bf16 v[216:219],v[84:87],a[248:251],v[216:219]
v_mfma_f32_16x16x32_bf16 v[220:223],v[84:87],a[252:255],v[220:223]
v_cvt_pk_bf16_f32 v42,v208,v212
v_cvt_pk_bf16_f32 v46,v209,v213
v_cvt_pk_bf16_f32 v50,v210,v214
v_cvt_pk_bf16_f32 v54,v211,v215
s_nop 3
v_cvt_pk_bf16_f32 v43,v216,v220
s_add_u32 s62,s69,262144
buffer_store_dwordx4 v[40:43],v5,s[8:11],s62 offen sc1
v_cvt_pk_bf16_f32 v47,v217,v221
s_add_u32 s62,s69,278528
buffer_store_dwordx4 v[44:47],v5,s[8:11],s62 offen sc1
v_cvt_pk_bf16_f32 v51,v218,v222
s_add_u32 s62,s69,294912
buffer_store_dwordx4 v[48:51],v5,s[8:11],s62 offen sc1
v_cvt_pk_bf16_f32 v55,v219,v223
s_add_u32 s62,s69,311296
buffer_store_dwordx4 v[52:55],v5,s[8:11],s62 offen sc1
s_cmp_lg_u32 s72,0
s_cbranch_scc1 L_aa_313
s_waitcnt vmcnt(10)
s_branch L_aa_323
L_aa_311:
ds_read_b128 v[24:27],v4 offset:0
ds_read_b128 v[28:31],v4 offset:1024
s_min_u32 s56,s32,s33
s_cmp_lt_u32 s77,64
s_cselect_b32 s56,s56,0
s_cmp_eq_u32 s56,0
s_cselect_b32 s72,0x80000000,0
v_mov_b32 v248,s72
s_or_b32 s64,s70,s72
s_or_b32 s65,s71,s72
s_cmp_lt_u32 s30,s31
s_cselect_b32 s65,0x80000000,s65
s_add_u32 s64,s64,s28
s_add_u32 s65,s65,s29
s_xor_b32 s58,s67,s40
s_xor_b32 s57,s67,s41
s_add_u32 m0,s58,0
s_waitcnt lgkmcnt(1)
v_mfma_f32_16x16x32_bf16 v[160:163],v[24:27],a[0:3],0
buffer_load_dwordx4 v0,s[8:11],s64 offen offset:0 sc1 lds
v_mfma_f32_16x16x32_bf16 v[164:167],v[24:27],a[4:7],0
ds_read_b128 v[32:35],v4 offset:2048
s_lshl_b32 s23,s51,5
v_mfma_f32_16x16x32_bf16 v[168:171],v[24:27],a[8:11],0
ds_read_b128 v[36:39],v4 offset:3072
s_add_u32 s23,s23,s68
v_mfma_f32_16x16x32_bf16 v[172:175],v[24:27],a[12:15],0
ds_read_b128 v[40:43],v4 offset:8192
s_lshl_b32 s24,s23,10
v_mfma_f32_16x16x32_bf16 v[176:179],v[24:27],a[16:19],0
buffer_load_dwordx4 v0,s[8:11],s64 offen offset:1024 sc1 lds
v_mfma_f32_16x16x32_bf16 v[180:183],v[24:27],a[20:23],0
ds_read_b128 v[44:47],v4 offset:9216
s_lshl_b32 s25,s51,10
v_mfma_f32_16x16x32_bf16 v[184:187],v[24:27],a[24:27],0
ds_read_b128 v[48:51],v4 offset:10240
s_add_u32 s25,s25,2883584
v_mfma_f32_16x16x32_bf16 v[188:191],v[24:27],a[28:31],0
ds_read_b128 v[52:55],v4 offset:11264
s_cmp_eq_u32 s23,s55
s_cselect_b32 s25,s25,s24
s_waitcnt lgkmcnt(6)
v_mfma_f32_16x16x32_bf16 v[160:163],v[28:31],a[32:35],v[160:163]
buffer_load_dwordx4 v0,s[8:11],s64 offen offset:2048 sc1 lds
v_mfma_f32_16x16x32_bf16 v[164:167],v[28:31],a[36:39],v[164:167]
ds_write_b32 v247,v248
s_add_u32 s25,s25,8388608
v_mfma_f32_16x16x32_bf16 v[168:171],v[28:31],a[40:43],v[168:171]
ds_read_b128 v[56:59],v4 offset:4096
s_mov_b32 s6,268435456
v_mfma_f32_16x16x32_bf16 v[172:175],v[28:31],a[44:47],v[172:175]
ds_read_b128 v[60:63],v4 offset:5120
s_cmp_eq_u32 s31,0
s_cselect_b32 s25,s24,s25
s_cselect_b64 s[4:5],s[16:17],s[44:45]
s_cmov_b32 s6,2097152
v_mfma_f32_16x16x32_bf16 v[176:179],v[28:31],a[48:51],v[176:179]
buffer_load_dwordx4 v0,s[8:11],s64 offen offset:3072 sc1 lds
v_mfma_f32_16x16x32_bf16 v[180:183],v[28:31],a[52:55],v[180:183]
ds_read_b128 v[64:67],v4 offset:6144
v_mfma_f32_16x16x32_bf16 v[184:187],v[28:31],a[56:59],v[184:187]
ds_read_b128 v[68:71],v4 offset:7168
v_mfma_f32_16x16x32_bf16 v[188:191],v[28:31],a[60:63],v[188:191]
ds_read_b128 v[72:75],v4 offset:12288
s_waitcnt lgkmcnt(11)
v_mfma_f32_16x16x32_bf16 v[160:163],v[32:35],a[64:67],v[160:163]
ds_read_b128 v[76:79],v4 offset:13312
s_add_u32 m0,s58,4096
v_mfma_f32_16x16x32_bf16 v[164:167],v[32:35],a[68:71],v[164:167]
ds_read_b128 v[80:83],v4 offset:14336
s_add_u32 s64,s64,4096
v_mfma_f32_16x16x32_bf16 v[168:171],v[32:35],a[72:75],v[168:171]
buffer_load_dwordx4 v0,s[8:11],s64 offen offset:0 sc1 lds
v_mfma_f32_16x16x32_bf16 v[172:175],v[32:35],a[76:79],v[172:175]
ds_read_b128 v[84:87],v4 offset:15360
v_mfma_f32_16x16x32_bf16 v[176:179],v[32:35],a[80:83],v[176:179]
buffer_load_dwordx4 v[224:227],v0,s[4:7],s25 offen sc1
v_mfma_f32_16x16x32_bf16 v[180:183],v[32:35],a[84:87],v[180:183]
s_lshr_b32 s24,s55,5
s_cmp_lt_u32 s51,s24
s_cselect_b32 s24,1,2
v_mfma_f32_16x16x32_bf16 v[184:187],v[32:35],a[88:91],v[184:187]
buffer_load_dwordx4 v0,s[8:11],s64 offen offset:1024 sc1 lds
v_mfma_f32_16x16x32_bf16 v[188:191],v[32:35],a[92:95],v[188:191]
v_mov_b32 v252,s24
s_lshl2_add_u32 s25,s51,11018240
s_waitcnt lgkmcnt(13)
v_mfma_f32_16x16x32_bf16 v[160:163],v[36:39],a[96:99],v[160:163]
s_waitcnt lgkmcnt(0)
s_barrier
s_lshl_b32 s24,s68,16
v_mfma_f32_16x16x32_bf16 v[164:167],v[36:39],a[100:103],v[164:167]
ds_read_b128 v[248:251],v245
s_add_u32 s24,s24,s31
v_mfma_f32_16x16x32_bf16 v[168:171],v[36:39],a[104:107],v[168:171]
buffer_load_dwordx4 v0,s[8:11],s64 offen offset:2048 sc1 lds
v_mfma_f32_16x16x32_bf16 v[172:175],v[36:39],a[108:111],v[172:175]
s_add_u32 s24,s24,s86
s_cmp_eq_u32 s24,1537
s_cselect_b32 s25,s25,0x80000000
v_mfma_f32_16x16x32_bf16 v[176:179],v[36:39],a[112:115],v[176:179]
buffer_store_dword v252,off,s[8:11],s25 sc1
v_mfma_f32_16x16x32_bf16 v[180:183],v[36:39],a[116:119],v[180:183]
s_bitcmp1_b64 s[38:39],s51
s_cselect_b32 s24,128,0
s_lshl_b32 s23,s51,13
v_mfma_f32_16x16x32_bf16 v[184:187],v[36:39],a[120:123],v[184:187]
buffer_load_dwordx4 v0,s[8:11],s64 offen offset:3072 sc1 lds
v_mfma_f32_16x16x32_bf16 v[188:191],v[36:39],a[124:127],v[188:191]
s_waitcnt lgkmcnt(0)
v_or3_b32 v248,v248,v249,v250
v_or_b32 v248,v248,v251
v_mfma_f32_16x16x32_bf16 v[160:163],v[40:43],a[128:131],v[160:163]
s_lshl2_add_u32 s23,s68,s23
s_add_u32 s23,s23,10487168
s_add_u32 s23,s23,s24
v_mfma_f32_16x16x32_bf16 v[164:167],v[40:43],a[132:135],v[164:167]
buffer_load_dword v246,off,s[8:11],s23 sc1
v_mfma_f32_16x16x32_bf16 v[168:171],v[40:43],a[136:139],v[168:171]
s_add_u32 m0,s58,8192
s_add_u32 s64,s64,4096
v_readfirstlane_b32 s72,v248
v_mfma_f32_16x16x32_bf16 v[172:175],v[40:43],a[140:143],v[172:175]
buffer_load_dwordx4 v0,s[8:11],s64 offen offset:0 sc1 lds
v_mfma_f32_16x16x32_bf16 v[176:179],v[40:43],a[144:147],v[176:179]
s_waitcnt vmcnt(12)
v_lshrrev_b32 v244,4,v1
s_sub_u32 s23,s77,8
v_mfma_f32_16x16x32_bf16 v[180:183],v[40:43],a[148:151],v[180:183]
buffer_store_dword v20,off,s[8:11],s73 sc1
v_mfma_f32_16x16x32_bf16 v[184:187],v[40:43],a[152:155],v[184:187]
s_mov_b32 s73,0x80000000
v_add_u32 v244,s23,v244
v_max_i32 v244,0,v244
v_mfma_f32_16x16x32_bf16 v[188:191],v[40:43],a[156:159],v[188:191]
buffer_load_dwordx4 v0,s[8:11],s64 offen offset:1024 sc1 lds
v_mfma_f32_16x16x32_bf16 v[160:163],v[44:47],a[160:163],v[160:163]
v_lshl_add_u32 v244,v244,13,v21
v_mfma_f32_16x16x32_bf16 v[164:167],v[44:47],a[164:167],v[164:167]
buffer_load_dwordx2 v[242:243],v244,s[8:11],0 offen sc1
v_mfma_f32_16x16x32_bf16 v[168:171],v[44:47],a[168:171],v[168:171]
v_mfma_f32_16x16x32_bf16 v[172:175],v[44:47],a[172:175],v[172:175]
buffer_load_dwordx4 v0,s[8:11],s64 offen offset:2048 sc1 lds
v_mfma_f32_16x16x32_bf16 v[176:179],v[44:47],a[176:179],v[176:179]
v_mfma_f32_16x16x32_bf16 v[180:183],v[44:47],a[180:183],v[180:183]
v_mfma_f32_16x16x32_bf16 v[184:187],v[44:47],a[184:187],v[184:187]
v_mfma_f32_16x16x32_bf16 v[188:191],v[44:47],a[188:191],v[188:191]
buffer_load_dwordx4 v0,s[8:11],s64 offen offset:3072 sc1 lds
v_mfma_f32_16x16x32_bf16 v[160:163],v[48:51],a[192:195],v[160:163]
v_mfma_f32_16x16x32_bf16 v[164:167],v[48:51],a[196:199],v[164:167]
v_mfma_f32_16x16x32_bf16 v[168:171],v[48:51],a[200:203],v[168:171]
v_mfma_f32_16x16x32_bf16 v[172:175],v[48:51],a[204:207],v[172:175]
s_add_u32 m0,s57,24576
v_mfma_f32_16x16x32_bf16 v[176:179],v[48:51],a[208:211],v[176:179]
buffer_load_dwordx4 v0,s[8:11],s65 offen offset:0 sc1 lds
v_mfma_f32_16x16x32_bf16 v[180:183],v[48:51],a[212:215],v[180:183]
v_mfma_f32_16x16x32_bf16 v[184:187],v[48:51],a[216:219],v[184:187]
v_mfma_f32_16x16x32_bf16 v[188:191],v[48:51],a[220:223],v[188:191]
v_mfma_f32_16x16x32_bf16 v[160:163],v[52:55],a[224:227],v[160:163]
buffer_load_dwordx4 v0,s[8:11],s65 offen offset:1024 sc1 lds
v_mfma_f32_16x16x32_bf16 v[164:167],v[52:55],a[228:231],v[164:167]
v_mfma_f32_16x16x32_bf16 v[168:171],v[52:55],a[232:235],v[168:171]
v_mfma_f32_16x16x32_bf16 v[172:175],v[52:55],a[236:239],v[172:175]
v_mfma_f32_16x16x32_bf16 v[176:179],v[52:55],a[240:243],v[176:179]
v_mfma_f32_16x16x32_bf16 v[180:183],v[52:55],a[244:247],v[180:183]
v_mfma_f32_16x16x32_bf16 v[184:187],v[52:55],a[248:251],v[184:187]
v_mfma_f32_16x16x32_bf16 v[188:191],v[52:55],a[252:255],v[188:191]
v_mfma_f32_16x16x32_bf16 v[192:195],v[56:59],a[0:3],0
v_mfma_f32_16x16x32_bf16 v[196:199],v[56:59],a[4:7],0
v_mfma_f32_16x16x32_bf16 v[200:203],v[56:59],a[8:11],0
v_cvt_pk_bf16_f32 v24,v160,v164
v_cvt_pk_bf16_f32 v25,v168,v172
v_mfma_f32_16x16x32_bf16 v[204:207],v[56:59],a[12:15],0
v_cvt_pk_bf16_f32 v26,v176,v180
v_cvt_pk_bf16_f32 v27,v184,v188
v_mfma_f32_16x16x32_bf16 v[208:211],v[56:59],a[16:19],0
v_cvt_pk_bf16_f32 v28,v161,v165
v_cvt_pk_bf16_f32 v29,v169,v173
v_mfma_f32_16x16x32_bf16 v[212:215],v[56:59],a[20:23],0
v_cvt_pk_bf16_f32 v30,v177,v181
v_cvt_pk_bf16_f32 v31,v185,v189
v_mfma_f32_16x16x32_bf16 v[216:219],v[56:59],a[24:27],0
v_cvt_pk_bf16_f32 v32,v162,v166
v_cvt_pk_bf16_f32 v33,v170,v174
v_mfma_f32_16x16x32_bf16 v[220:223],v[56:59],a[28:31],0
v_cvt_pk_bf16_f32 v34,v178,v182
v_cvt_pk_bf16_f32 v35,v186,v190
v_mfma_f32_16x16x32_bf16 v[192:195],v[60:63],a[32:35],v[192:195]
v_cvt_pk_bf16_f32 v36,v163,v167
v_cvt_pk_bf16_f32 v37,v171,v175
v_mfma_f32_16x16x32_bf16 v[196:199],v[60:63],a[36:39],v[196:199]
v_cvt_pk_bf16_f32 v38,v179,v183
v_cvt_pk_bf16_f32 v39,v187,v191
v_mfma_f32_16x16x32_bf16 v[200:203],v[60:63],a[40:43],v[200:203]
v_mfma_f32_16x16x32_bf16 v[204:207],v[60:63],a[44:47],v[204:207]
v_mfma_f32_16x16x32_bf16 v[208:211],v[60:63],a[48:51],v[208:211]
v_mfma_f32_16x16x32_bf16 v[212:215],v[60:63],a[52:55],v[212:215]
v_mfma_f32_16x16x32_bf16 v[216:219],v[60:63],a[56:59],v[216:219]
v_mfma_f32_16x16x32_bf16 v[220:223],v[60:63],a[60:63],v[220:223]
v_mfma_f32_16x16x32_bf16 v[192:195],v[64:67],a[64:67],v[192:195]
v_mfma_f32_16x16x32_bf16 v[196:199],v[64:67],a[68:71],v[196:199]
v_mfma_f32_16x16x32_bf16 v[200:203],v[64:67],a[72:75],v[200:203]
v_mfma_f32_16x16x32_bf16 v[204:207],v[64:67],a[76:79],v[204:207]
v_mfma_f32_16x16x32_bf16 v[208:211],v[64:67],a[80:83],v[208:211]
v_mfma_f32_16x16x32_bf16 v[212:215],v[64:67],a[84:87],v[212:215]
v_mfma_f32_16x16x32_bf16 v[216:219],v[64:67],a[88:91],v[216:219]
v_mfma_f32_16x16x32_bf16 v[220:223],v[64:67],a[92:95],v[220:223]
v_mfma_f32_16x16x32_bf16 v[192:195],v[68:71],a[96:99],v[192:195]
v_mfma_f32_16x16x32_bf16 v[196:199],v[68:71],a[100:103],v[196:199]
v_mfma_f32_16x16x32_bf16 v[200:203],v[68:71],a[104:107],v[200:203]
v_mfma_f32_16x16x32_bf16 v[204:207],v[68:71],a[108:111],v[204:207]
v_mfma_f32_16x16x32_bf16 v[208:211],v[68:71],a[112:115],v[208:211]
s_add_u32 s62,s69,0
v_mfma_f32_16x16x32_bf16 v[212:215],v[68:71],a[116:119],v[212:215]
buffer_store_dwordx4 v[24:27],v5,s[8:11],s62 offen sc1
v_mfma_f32_16x16x32_bf16 v[216:219],v[68:71],a[120:123],v[216:219]
v_mfma_f32_16x16x32_bf16 v[220:223],v[68:71],a[124:127],v[220:223]
v_mfma_f32_16x16x32_bf16 v[192:195],v[72:75],a[128:131],v[192:195]
v_mfma_f32_16x16x32_bf16 v[196:199],v[72:75],a[132:135],v[196:199]
s_add_u32 s62,s69,16384
v_mfma_f32_16x16x32_bf16 v[200:203],v[72:75],a[136:139],v[200:203]
buffer_store_dwordx4 v[28:31],v5,s[8:11],s62 offen sc1
v_mfma_f32_16x16x32_bf16 v[204:207],v[72:75],a[140:143],v[204:207]
v_mfma_f32_16x16x32_bf16 v[208:211],v[72:75],a[144:147],v[208:211]
v_mfma_f32_16x16x32_bf16 v[212:215],v[72:75],a[148:151],v[212:215]
v_mfma_f32_16x16x32_bf16 v[216:219],v[72:75],a[152:155],v[216:219]
s_add_u32 s62,s69,32768
v_mfma_f32_16x16x32_bf16 v[220:223],v[72:75],a[156:159],v[220:223]
buffer_store_dwordx4 v[32:35],v5,s[8:11],s62 offen sc1
v_mfma_f32_16x16x32_bf16 v[192:195],v[76:79],a[160:163],v[192:195]
v_mfma_f32_16x16x32_bf16 v[196:199],v[76:79],a[164:167],v[196:199]
v_mfma_f32_16x16x32_bf16 v[200:203],v[76:79],a[168:171],v[200:203]
v_mfma_f32_16x16x32_bf16 v[204:207],v[76:79],a[172:175],v[204:207]
s_add_u32 s62,s69,49152
v_mfma_f32_16x16x32_bf16 v[208:211],v[76:79],a[176:179],v[208:211]
buffer_store_dwordx4 v[36:39],v5,s[8:11],s62 offen sc1
v_mfma_f32_16x16x32_bf16 v[212:215],v[76:79],a[180:183],v[212:215]
v_mfma_f32_16x16x32_bf16 v[216:219],v[76:79],a[184:187],v[216:219]
v_mfma_f32_16x16x32_bf16 v[220:223],v[76:79],a[188:191],v[220:223]
v_mfma_f32_16x16x32_bf16 v[192:195],v[80:83],a[192:195],v[192:195]
v_mfma_f32_16x16x32_bf16 v[196:199],v[80:83],a[196:199],v[196:199]
v_mfma_f32_16x16x32_bf16 v[192:195],v[84:87],a[224:227],v[192:195]
v_mfma_f32_16x16x32_bf16 v[196:199],v[84:87],a[228:231],v[196:199]
v_mfma_f32_16x16x32_bf16 v[200:203],v[80:83],a[200:203],v[200:203]
v_mfma_f32_16x16x32_bf16 v[204:207],v[80:83],a[204:207],v[204:207]
v_mfma_f32_16x16x32_bf16 v[200:203],v[84:87],a[232:235],v[200:203]
v_mfma_f32_16x16x32_bf16 v[204:207],v[84:87],a[236:239],v[204:207]
v_cvt_pk_bf16_f32 v40,v192,v196
v_cvt_pk_bf16_f32 v44,v193,v197
v_cvt_pk_bf16_f32 v48,v194,v198
v_mfma_f32_16x16x32_bf16 v[208:211],v[80:83],a[208:211],v[208:211]
v_cvt_pk_bf16_f32 v52,v195,v199
v_mfma_f32_16x16x32_bf16 v[212:215],v[80:83],a[212:215],v[212:215]
v_cvt_pk_bf16_f32 v41,v200,v204
v_cvt_pk_bf16_f32 v45,v201,v205
v_cvt_pk_bf16_f32 v49,v202,v206
v_mfma_f32_16x16x32_bf16 v[208:211],v[84:87],a[240:243],v[208:211]
v_cvt_pk_bf16_f32 v53,v203,v207
v_mfma_f32_16x16x32_bf16 v[212:215],v[84:87],a[244:247],v[212:215]
v_mfma_f32_16x16x32_bf16 v[216:219],v[80:83],a[216:219],v[216:219]
v_mfma_f32_16x16x32_bf16 v[220:223],v[80:83],a[220:223],v[220:223]
v_mfma_f32_16x16x32_bf16 v[216:219],v[84:87],a[248:251],v[216:219]
v_mfma_f32_16x16x32_bf16 v[220:223],v[84:87],a[252:255],v[220:223]
v_cvt_pk_bf16_f32 v42,v208,v212
v_cvt_pk_bf16_f32 v46,v209,v213
v_cvt_pk_bf16_f32 v50,v210,v214
v_cvt_pk_bf16_f32 v54,v211,v215
s_nop 3
v_cvt_pk_bf16_f32 v43,v216,v220
s_add_u32 s62,s69,262144
buffer_store_dwordx4 v[40:43],v5,s[8:11],s62 offen sc1
v_cvt_pk_bf16_f32 v47,v217,v221
s_add_u32 s62,s69,278528
buffer_store_dwordx4 v[44:47],v5,s[8:11],s62 offen sc1
v_cvt_pk_bf16_f32 v51,v218,v222
s_add_u32 s62,s69,294912
buffer_store_dwordx4 v[48:51],v5,s[8:11],s62 offen sc1
v_cvt_pk_bf16_f32 v55,v219,v223
s_add_u32 s62,s69,311296
buffer_store_dwordx4 v[52:55],v5,s[8:11],s62 offen sc1
s_cmp_lg_u32 s72,0
s_cbranch_scc1 L_aa_313
s_waitcnt vmcnt(8)
L_aa_323:
s_barrier
s_cmp_lt_u32 s30,s31
s_cbranch_scc1 L_ao_330
s_xor_b32 s67,s67,65536
s_and_b32 s56,s50,2048
s_lshl_b32 s56,s56,4
s_add_u32 s56,s56,s67
v_add_u32 v2,s56,v0
v_add_u32 v239,s56,v253
s_and_b32 s56,s50,1024
s_lshl_b32 s56,s56,2
v_add_u32 v238,s56,v2
s_mov_b32 s76,s71
s_mov_b32 s53,s77
ds_read_b128 v[24:27],v238 offset:16384
ds_read_b128 v[40:43],v2 offset:0
ds_read_b128 v[56:59],v2 offset:4096
ds_read_b128 v[28:31],v238 offset:17408
ds_read_b128 v[44:47],v2 offset:1024
ds_read_b128 v[60:63],v2 offset:5120
ds_read_b128 v[32:35],v238 offset:18432
ds_read_b128 v[48:51],v2 offset:2048
ds_read_b128 v[64:67],v2 offset:6144
ds_read_b128 v[36:39],v238 offset:19456
ds_read_b128 v[52:55],v2 offset:3072
ds_read_b128 v[68:71],v2 offset:7168
s_waitcnt lgkmcnt(9)
v_mfma_f32_16x16x32_bf16 v[128:131],v[40:43],v[24:27],v[8:11]
ds_read_b128 v[72:75],v2 offset:24576
v_mfma_f32_16x16x32_bf16 v[132:135],v[56:59],v[24:27],v[12:15]
ds_read_b128 v[76:79],v2 offset:25600
s_waitcnt lgkmcnt(8)
v_mfma_f32_16x16x32_bf16 v[128:131],v[44:47],v[28:31],v[128:131]
ds_read_b128 v[80:83],v2 offset:26624
v_mfma_f32_16x16x32_bf16 v[132:135],v[60:63],v[28:31],v[132:135]
ds_read_b128 v[84:87],v2 offset:27648
s_waitcnt lgkmcnt(7)
v_mfma_f32_16x16x32_bf16 v[128:131],v[48:51],v[32:35],v[128:131]
ds_read_b64 v[120:121],v239 offset:24576
v_mfma_f32_16x16x32_bf16 v[132:135],v[64:67],v[32:35],v[132:135]
ds_read_b64 v[122:123],v239 offset:25600
s_waitcnt lgkmcnt(6)
v_mfma_f32_16x16x32_bf16 v[128:131],v[52:55],v[36:39],v[128:131]
ds_read_b64 v[124:125],v239 offset:26624
v_mfma_f32_16x16x32_bf16 v[132:135],v[68:71],v[36:39],v[132:135]
ds_read_b64 v[126:127],v239 offset:27648
s_waitcnt lgkmcnt(4)
v_mfma_f32_16x16x32_bf16 v[136:139],v[72:75],v[24:27],0
ds_read_b128 v[88:91],v2 offset:8192
ds_read_b128 v[92:95],v2 offset:9216
v_mfma_f32_16x16x32_bf16 v[136:139],v[76:79],v[28:31],v[136:139]
ds_read_b128 v[96:99],v2 offset:10240
ds_read_b128 v[100:103],v2 offset:11264
v_mfma_f32_16x16x32_bf16 v[136:139],v[80:83],v[32:35],v[136:139]
ds_read_b128 v[104:107],v2 offset:12288
ds_read_b128 v[108:111],v2 offset:13312
v_mfma_f32_16x16x32_bf16 v[136:139],v[84:87],v[36:39],v[136:139]
ds_read_b128 v[112:115],v2 offset:14336
ds_read_b128 v[116:119],v2 offset:15360
s_cmp_eq_u32 s30,0
s_cbranch_scc1 L_aa_312
v_max3_u32 v238,v72,v73,v74
v_max3_u32 v238,v74,v75,v238
v_max3_u32 v238,v76,v77,v238
v_max3_u32 v238,v78,v79,v238
v_max3_u32 v238,v80,v81,v238
v_max3_u32 v238,v82,v83,v238
v_max3_u32 v238,v84,v85,v238
v_max3_u32 v238,v86,v87,v238
s_waitcnt lgkmcnt(8)
v_max3_u32 v238,v120,v121,v238
v_max3_u32 v238,v122,v123,v238
v_max3_u32 v238,v124,v125,v238
v_max3_u32 v238,v126,v127,v238
v_cmp_eq_u32 vcc,-1,v238
s_cmp_lg_u64 vcc,0
s_cselect_b32 s27,1,0
s_andn2_b32 s57,s27,s31
s_add_u32 s66,s66,4
s_bfe_u32 s56,s66,0x10002
s_bitset0_b32 s37,s56
s_lshl_b32 s56,s57,s56
s_or_b32 s37,s37,s56
s_or_b32 s56,s37,s66
v_mov_b32 v22,s56
s_xor_b32 s69,s69,524288
s_waitcnt vmcnt(0) lgkmcnt(0)
buffer_store_dword v22,off,s[8:11],s74 sc1
s_cmp_lg_u32 s86,1536
s_cbranch_scc1 L_ae_333
s_mov_b32 s77,s35
s_mov_b32 s30,0
s_lshl_b32 s56,s77,5
s_add_u32 s56,s56,s68
s_mul_i32 s70,s56,24576
s_lshl_b32 s71,s56,12
s_lshl_b32 s59,s77,13
s_lshl2_add_u32 s59,s68,s59
s_add_u32 s59,s59,10485760
s_buffer_load_dword s32,s[8:11],s59
s_mov_b32 s33,1
s_add_u32 s70,s70,100663296
s_add_u32 s71,s71,41943040
v_mov_b32 v19,s59
s_branch L_af_334
L_ae_333:
s_ff1_i32_b64 s77,s[84:85]
s_bitset0_b64 s[84:85],s77
s_min_u32 s77,s77,64
s_lshr_b32 s61,s55,5
s_lshl_b32 s56,s77,5
s_add_u32 s56,s56,s68
s_mul_i32 s70,s56,24576
s_lshl_b32 s71,s56,12
s_lshl_b32 s59,s77,13
s_lshl2_add_u32 s59,s68,s59
s_add_u32 s59,s59,10486144
s_cmp_lt_u32 s77,s61
s_cselect_b32 s57,0,16777216
s_mov_b32 s60,s59
s_buffer_load_dword s33,s[8:11],s60
s_add_u32 s71,s71,s57
s_add_u32 s71,s71,58720256
s_cmp_eq_u32 s77,s61
s_cselect_b32 s57,50331648,0
s_cselect_b32 s58,1536,0
s_add_u32 s59,s59,s58
s_buffer_load_dword s32,s[8:11],s59
s_add_u32 s70,s70,s57
s_add_u32 s70,s70,150994944
v_mov_b32 v19,s59
v_writelane_b32 v19,s60,1
L_af_334:
s_and_b32 s27,s27,s31
s_cbranch_scc1 L_ac_335
L_acb_336:
v_max3_f32 v238,v128,v129,v130
v_max3_f32 v239,v131,v132,v133
v_max3_f32 v238,v134,v135,v238
v_max3_f32 v239,v138,v139,v239
v_max_f32 v238,v238,v239
v_max_f32 v239,v238,v239
v_pk_mul_f32 v[128:129],v[128:129],v[152:153] op_sel_hi:[1,0]
v_pk_mul_f32 v[130:131],v[130:131],v[152:153] op_sel_hi:[1,0]
v_permlane16_swap_b32 v238,v239
v_max_f32 v238,v238,v239
v_max_f32 v239,v238,v239
v_pk_mul_f32 v[132:133],v[132:133],v[152:153] op_sel_hi:[1,0]
v_pk_mul_f32 v[134:135],v[134:135],v[152:153] op_sel_hi:[1,0]
v_permlane32_swap_b32 v238,v239
v_max_f32 v238,v238,v239
v_mul_f32 v238,v152,v238
v_pk_mul_f32 v[138:139],v[138:139],v[152:153] op_sel_hi:[1,0]
buffer_load_dword v17,v16,s[8:11],s87 offen sc1
v_pk_add_f32 v[128:129],v[128:129],v[238:239] op_sel_hi:[1,0] neg_lo:[0,1] neg_hi:[0,1]
v_pk_add_f32 v[130:131],v[130:131],v[238:239] op_sel_hi:[1,0] neg_lo:[0,1] neg_hi:[0,1]
v_pk_add_f32 v[132:133],v[132:133],v[238:239] op_sel_hi:[1,0] neg_lo:[0,1] neg_hi:[0,1]
v_pk_add_f32 v[134:135],v[134:135],v[238:239] op_sel_hi:[1,0] neg_lo:[0,1] neg_hi:[0,1]
v_pk_add_f32 v[138:139],v[138:139],v[238:239] op_sel_hi:[1,0] neg_lo:[0,1] neg_hi:[0,1]
v_exp_f32 v128,v128
v_exp_f32 v129,v129
v_exp_f32 v130,v130
v_exp_f32 v131,v131
v_exp_f32 v132,v132
v_exp_f32 v133,v133
v_exp_f32 v134,v134
v_exp_f32 v135,v135
v_exp_f32 v138,v138
v_exp_f32 v139,v139
v_pk_add_f32 v[148:149],v[128:129],v[130:131]
v_pk_add_f32 v[150:151],v[132:133],v[134:135]
v_pk_add_f32 v[148:149],v[148:149],v[138:139]
v_pk_add_f32 v[148:149],v[148:149],v[150:151]
v_add_f32 v150,v148,v149
v_add_f32 v151,v148,v149
s_nop 1
v_permlane16_swap_b32 v150,v151
v_add_f32 v148,v150,v151
v_add_f32 v149,v150,v151
s_nop 1
v_permlane32_swap_b32 v148,v149
v_add_f32 v148,v148,v149
v_rcp_f32 v148,v148
s_waitcnt vmcnt(0)
v_cmp_gt_u32 vcc,s66,v17
v_pk_mul_f32 v[138:139],v[138:139],v[148:149] op_sel_hi:[1,0]
v_pk_mul_f32 v[128:129],v[128:129],v[148:149] op_sel_hi:[1,0]
v_pk_mul_f32 v[130:131],v[130:131],v[148:149] op_sel_hi:[1,0]
v_pk_mul_f32 v[132:133],v[132:133],v[148:149] op_sel_hi:[1,0]
v_pk_mul_f32 v[134:135],v[134:135],v[148:149] op_sel_hi:[1,0]
s_cbranch_vccnz L_ap_338
L_apb_339:
s_xor_b32 s34,s69,524288
buffer_load_dwordx4 v[192:195],v7,s[8:11],s34 offen sc1
s_bfe_u32 s56,s66,0x10002
v_lshrrev_b32 v238,s56,v17
v_and_b32 v238,1,v238
v_cmp_ne_u32 vcc,0,v238
v_cvt_pk_bf16_f32 v144,v138,v139
v_cvt_pk_bf16_f32 v147,v138,v139
v_cvt_pk_bf16_f32 v140,v128,v129
v_cvt_pk_bf16_f32 v141,v130,v131
v_cvt_pk_bf16_f32 v142,v132,v133
v_cvt_pk_bf16_f32 v143,v134,v135
s_cbranch_vccnz L_ak_332
s_add_u32 s36,s36,4
v_mfma_f32_16x16x16_bf16 v[24:27],v[120:121],v[144:145],0
s_add_u32 s34,s34,4096
v_mfma_f32_16x16x16_bf16 v[28:31],v[120:121],v[146:147],0
buffer_load_dwordx4 v[196:199],v7,s[8:11],s34 offen sc1
v_mfma_f32_16x16x16_bf16 v[32:35],v[122:123],v[144:145],0
s_add_u32 s34,s34,4096
v_mfma_f32_16x16x16_bf16 v[36:39],v[122:123],v[146:147],0
buffer_load_dwordx4 v[200:203],v7,s[8:11],s34 offen sc1
v_mfma_f32_16x16x16_bf16 v[40:43],v[124:125],v[144:145],0
s_add_u32 s34,s34,4096
v_mfma_f32_16x16x16_bf16 v[44:47],v[124:125],v[146:147],0
buffer_load_dwordx4 v[204:207],v7,s[8:11],s34 offen sc1
v_mfma_f32_16x16x16_bf16 v[48:51],v[126:127],v[144:145],0
s_add_u32 s34,s34,4096
v_mfma_f32_16x16x16_bf16 v[52:55],v[126:127],v[146:147],0
buffer_load_dwordx4 v[208:211],v7,s[8:11],s34 offen sc1
v_mfma_f32_16x16x32_bf16 v[24:27],v[88:91],v[140:143],v[24:27]
s_add_u32 s34,s34,4096
v_mfma_f32_16x16x32_bf16 v[28:31],v[92:95],v[140:143],v[28:31]
buffer_load_dwordx4 v[212:215],v7,s[8:11],s34 offen sc1
v_mfma_f32_16x16x32_bf16 v[32:35],v[96:99],v[140:143],v[32:35]
s_add_u32 s34,s34,4096
v_mfma_f32_16x16x32_bf16 v[36:39],v[100:103],v[140:143],v[36:39]
buffer_load_dwordx4 v[216:219],v7,s[8:11],s34 offen sc1
v_cvt_pk_bf16_f32 v72,v24,v28
v_cvt_pk_bf16_f32 v73,v25,v29
v_mfma_f32_16x16x32_bf16 v[40:43],v[104:107],v[140:143],v[40:43]
s_add_u32 s34,s34,4096
v_cvt_pk_bf16_f32 v74,v26,v30
v_cvt_pk_bf16_f32 v75,v27,v31
v_mfma_f32_16x16x32_bf16 v[44:47],v[108:111],v[140:143],v[44:47]
ds_write_b128 v3,v[72:75] offset:0
v_cvt_pk_bf16_f32 v76,v32,v36
v_cvt_pk_bf16_f32 v77,v33,v37
v_mfma_f32_16x16x32_bf16 v[48:51],v[112:115],v[140:143],v[48:51]
buffer_load_dwordx4 v[220:223],v7,s[8:11],s34 offen sc1
v_cvt_pk_bf16_f32 v78,v34,v38
v_cvt_pk_bf16_f32 v79,v35,v39
v_mfma_f32_16x16x32_bf16 v[52:55],v[116:119],v[140:143],v[52:55]
ds_write_b128 v3,v[76:79] offset:1024
v_cvt_pk_bf16_f32 v80,v40,v44
v_cvt_pk_bf16_f32 v81,v41,v45
v_cvt_pk_bf16_f32 v82,v42,v46
v_cvt_pk_bf16_f32 v83,v43,v47
ds_write_b128 v3,v[80:83] offset:2048
s_nop 1
v_cvt_pk_bf16_f32 v84,v48,v52
v_cvt_pk_bf16_f32 v85,v49,v53
v_cvt_pk_bf16_f32 v86,v50,v54
v_cvt_pk_bf16_f32 v87,v51,v55
ds_write_b128 v3,v[84:87] offset:3072
s_cmp_eq_u32 s31,0
s_cbranch_scc1 L_ah_337
s_waitcnt lgkmcnt(0)
s_barrier
s_mov_b32 s26,s51
s_mov_b32 s51,s53
s_branch L_aa_324
L_ah_337:
s_waitcnt lgkmcnt(0)
s_barrier
s_mov_b32 s26,s51
s_mov_b32 s51,s53
s_mov_b32 s31,1
s_branch L_av_328
L_ao_330:
s_xor_b32 s67,s67,65536
s_and_b32 s56,s50,2048
s_lshl_b32 s56,s56,4
s_add_u32 s56,s56,s67
v_add_u32 v2,s56,v0
v_add_u32 v239,s56,v253
s_and_b32 s56,s50,1024
s_lshl_b32 s56,s56,2
v_add_u32 v238,s56,v2
s_mov_b32 s76,s71
s_mov_b32 s53,s77
ds_read_b128 v[24:27],v238 offset:16384
ds_read_b128 v[40:43],v2 offset:0
ds_read_b128 v[56:59],v2 offset:4096
ds_read_b128 v[28:31],v238 offset:17408
ds_read_b128 v[44:47],v2 offset:1024
ds_read_b128 v[60:63],v2 offset:5120
ds_read_b128 v[32:35],v238 offset:18432
ds_read_b128 v[48:51],v2 offset:2048
ds_read_b128 v[64:67],v2 offset:6144
ds_read_b128 v[36:39],v238 offset:19456
ds_read_b128 v[52:55],v2 offset:3072
ds_read_b128 v[68:71],v2 offset:7168
buffer_load_dwordx4 v[72:75],v0,s[8:11],s76 offen offset:0 sc1
buffer_load_dwordx4 v[76:79],v0,s[8:11],s76 offen offset:1024 sc1
buffer_load_dwordx4 v[80:83],v0,s[8:11],s76 offen offset:2048 sc1
buffer_load_dwordx4 v[84:87],v0,s[8:11],s76 offen offset:3072 sc1
buffer_load_dwordx2 v[120:121],v253,s[8:11],s76 offen offset:0 sc1
buffer_load_dwordx2 v[122:123],v253,s[8:11],s76 offen offset:1024 sc1
buffer_load_dwordx2 v[124:125],v253,s[8:11],s76 offen offset:2048 sc1
buffer_load_dwordx2 v[126:127],v253,s[8:11],s76 offen offset:3072 sc1
s_waitcnt lgkmcnt(9)
v_mfma_f32_16x16x32_bf16 v[128:131],v[40:43],v[24:27],v[8:11]
ds_read_b128 v[88:91],v2 offset:8192
v_mfma_f32_16x16x32_bf16 v[132:135],v[56:59],v[24:27],v[12:15]
ds_read_b128 v[92:95],v2 offset:9216
s_waitcnt lgkmcnt(8)
v_mfma_f32_16x16x32_bf16 v[128:131],v[44:47],v[28:31],v[128:131]
ds_read_b128 v[96:99],v2 offset:10240
v_mfma_f32_16x16x32_bf16 v[132:135],v[60:63],v[28:31],v[132:135]
ds_read_b128 v[100:103],v2 offset:11264
s_waitcnt lgkmcnt(7)
v_mfma_f32_16x16x32_bf16 v[128:131],v[48:51],v[32:35],v[128:131]
ds_read_b128 v[104:107],v2 offset:12288
v_mfma_f32_16x16x32_bf16 v[132:135],v[64:67],v[32:35],v[132:135]
ds_read_b128 v[108:111],v2 offset:13312
s_waitcnt lgkmcnt(6)
v_mfma_f32_16x16x32_bf16 v[128:131],v[52:55],v[36:39],v[128:131]
ds_read_b128 v[112:115],v2 offset:14336
v_mfma_f32_16x16x32_bf16 v[132:135],v[68:71],v[36:39],v[132:135]
ds_read_b128 v[116:119],v2 offset:15360
s_add_u32 s66,s66,4
s_bfe_u32 s56,s66,0x10002
s_bitset0_b32 s37,s56
s_lshl_b32 s56,0,s56
s_or_b32 s37,s37,s56
s_or_b32 s56,s37,s66
v_mov_b32 v22,s56
s_xor_b32 s69,s69,524288
s_waitcnt vmcnt(8) lgkmcnt(0)
buffer_store_dword v22,off,s[8:11],s74 sc1
s_mov_b32 s26,s51
s_mov_b32 s27,3
s_branch L_aa_319
L_aa_312:
s_add_u32 s66,s66,4
s_bfe_u32 s56,s66,0x10002
s_bitset0_b32 s37,s56
s_lshl_b32 s56,0,s56
s_or_b32 s37,s37,s56
s_or_b32 s56,s37,s66
v_mov_b32 v22,s56
s_xor_b32 s69,s69,524288
s_waitcnt vmcnt(0) lgkmcnt(0)
buffer_store_dword v22,off,s[8:11],s74 sc1
L_aq_340:
buffer_load_dword v17,v16,s[8:11],s87 offen sc1
s_sub_u32 s49,s49,1
s_cbranch_scc1 L_abort2
s_waitcnt vmcnt(0)
v_cmp_gt_u32 vcc,s66,v17
s_cbranch_vccnz L_aq_340
s_xor_b32 s34,s69,524288
buffer_load_dwordx4 v[160:163],v7,s[8:11],s34 offen sc1
s_add_u32 s34,s34,4096
buffer_load_dwordx4 v[164:167],v7,s[8:11],s34 offen sc1
s_add_u32 s34,s34,4096
buffer_load_dwordx4 v[168:171],v7,s[8:11],s34 offen sc1
s_add_u32 s34,s34,4096
buffer_load_dwordx4 v[172:175],v7,s[8:11],s34 offen sc1
s_add_u32 s34,s34,4096
buffer_load_dwordx4 v[176:179],v7,s[8:11],s34 offen sc1
s_add_u32 s34,s34,4096
buffer_load_dwordx4 v[180:183],v7,s[8:11],s34 offen sc1
s_add_u32 s34,s34,4096
buffer_load_dwordx4 v[184:187],v7,s[8:11],s34 offen sc1
s_add_u32 s34,s34,4096
buffer_load_dwordx4 v[188:191],v7,s[8:11],s34 offen sc1
buffer_load_dwordx4 v[72:75],v0,s[8:11],s76 offen offset:0 sc1
buffer_load_dwordx4 v[76:79],v0,s[8:11],s76 offen offset:1024 sc1
buffer_load_dwordx4 v[80:83],v0,s[8:11],s76 offen offset:2048 sc1
buffer_load_dwordx4 v[84:87],v0,s[8:11],s76 offen offset:3072 sc1
buffer_load_dwordx2 v[120:121],v253,s[8:11],s76 offen offset:0 sc1
buffer_load_dwordx2 v[122:123],v253,s[8:11],s76 offen offset:1024 sc1
buffer_load_dwordx2 v[124:125],v253,s[8:11],s76 offen offset:2048 sc1
buffer_load_dwordx2 v[126:127],v253,s[8:11],s76 offen offset:3072 sc1
s_waitcnt vmcnt(15)
v_mfma_f32_16x16x32_bf16 v[192:195],v[156:159],v[160:163],0
s_waitcnt vmcnt(14)
v_mfma_f32_16x16x32_bf16 v[192:195],v[156:159],v[164:167],v[192:195]
s_waitcnt vmcnt(13)
v_mfma_f32_16x16x32_bf16 v[192:195],v[156:159],v[168:171],v[192:195]
s_waitcnt vmcnt(12)
v_mfma_f32_16x16x32_bf16 v[192:195],v[156:159],v[172:175],v[192:195]
s_waitcnt vmcnt(11)
v_mfma_f32_16x16x32_bf16 v[196:199],v[156:159],v[176:179],0
s_waitcnt vmcnt(10)
v_mfma_f32_16x16x32_bf16 v[196:199],v[156:159],v[180:183],v[196:199]
s_waitcnt vmcnt(9)
v_mfma_f32_16x16x32_bf16 v[196:199],v[156:159],v[184:187],v[196:199]
ds_write_b128 v6,v[192:195]
s_waitcnt vmcnt(8)
v_mfma_f32_16x16x32_bf16 v[196:199],v[156:159],v[188:191],v[196:199]
s_nop 7
ds_write_b128 v6,v[196:199] offset:2048
s_waitcnt lgkmcnt(0)
s_barrier
buffer_store_dword v20,off,s[8:11],s73 sc1
s_mov_b32 s73,0x80000000
s_mov_b32 s27,0
s_branch L_aa_315
L_aa_313:
s_add_u32 s56,s30,s86
s_cmp_lg_u32 s56,1537
s_cbranch_scc1 L_al_331
s_add_u32 s66,s66,4
s_bfe_u32 s56,s66,0x10002
s_bitset0_b32 s37,s56
s_lshl_b32 s56,1,s56
s_or_b32 s37,s37,s56
s_or_b32 s56,s37,s66
v_mov_b32 v22,s56
s_xor_b32 s69,s69,524288
s_waitcnt vmcnt(0) lgkmcnt(0)
buffer_store_dword v22,off,s[8:11],s74 sc1
s_cmp_lg_u32 s86,1536
s_cbranch_scc1 L_ae_341
s_mov_b32 s77,s35
s_mov_b32 s30,0
s_lshl_b32 s56,s77,5
s_add_u32 s56,s56,s68
s_mul_i32 s70,s56,24576
s_lshl_b32 s71,s56,12
s_lshl_b32 s59,s77,13
s_lshl2_add_u32 s59,s68,s59
s_add_u32 s59,s59,10485760
s_buffer_load_dword s32,s[8:11],s59
s_mov_b32 s33,1
s_add_u32 s70,s70,100663296
s_add_u32 s71,s71,41943040
v_mov_b32 v19,s59
s_branch L_af_342
L_ae_341:
s_ff1_i32_b64 s77,s[84:85]
s_bitset0_b64 s[84:85],s77
s_min_u32 s77,s77,64
s_lshr_b32 s61,s55,5
s_lshl_b32 s56,s77,5
s_add_u32 s56,s56,s68
s_mul_i32 s70,s56,24576
s_lshl_b32 s71,s56,12
s_lshl_b32 s59,s77,13
s_lshl2_add_u32 s59,s68,s59
s_add_u32 s59,s59,10486144
s_cmp_lt_u32 s77,s61
s_cselect_b32 s57,0,16777216
s_mov_b32 s60,s59
s_buffer_load_dword s33,s[8:11],s60
s_add_u32 s71,s71,s57
s_add_u32 s71,s71,58720256
s_cmp_eq_u32 s77,s61
s_cselect_b32 s57,50331648,0
s_cselect_b32 s58,1536,0
s_add_u32 s59,s59,s58
s_buffer_load_dword s32,s[8:11],s59
s_add_u32 s70,s70,s57
s_add_u32 s70,s70,150994944
v_mov_b32 v19,s59
v_writelane_b32 v19,s60,1
L_af_342:
s_branch L_ak_332
L_al_331:
s_add_u32 s66,s66,4
s_bfe_u32 s56,s66,0x10002
s_bitset0_b32 s37,s56
s_lshl_b32 s56,0,s56
s_or_b32 s37,s37,s56
s_or_b32 s56,s37,s66
v_mov_b32 v22,s56
s_xor_b32 s69,s69,524288
s_waitcnt vmcnt(0) lgkmcnt(0)
buffer_store_dword v22,off,s[8:11],s74 sc1
L_ak_332:
L_aq_343:
buffer_load_dword v17,v16,s[8:11],s87 offen sc1
s_sub_u32 s49,s49,1
s_cbranch_scc1 L_abort2
s_waitcnt vmcnt(0)
v_cmp_gt_u32 vcc,s66,v17
s_cbranch_vccnz L_aq_343
s_xor_b32 s34,s69,524288
buffer_load_dwordx4 v[160:163],v7,s[8:11],s34 offen sc1
s_add_u32 s34,s34,4096
buffer_load_dwordx4 v[164:167],v7,s[8:11],s34 offen sc1
s_add_u32 s34,s34,4096
buffer_load_dwordx4 v[168:171],v7,s[8:11],s34 offen sc1
s_add_u32 s34,s34,4096
buffer_load_dwordx4 v[172:175],v7,s[8:11],s34 offen sc1
s_add_u32 s34,s34,4096
buffer_load_dwordx4 v[176:179],v7,s[8:11],s34 offen sc1
s_add_u32 s34,s34,4096
buffer_load_dwordx4 v[180:183],v7,s[8:11],s34 offen sc1
s_add_u32 s34,s34,4096
buffer_load_dwordx4 v[184:187],v7,s[8:11],s34 offen sc1
s_add_u32 s34,s34,4096
buffer_load_dwordx4 v[188:191],v7,s[8:11],s34 offen sc1
s_waitcnt vmcnt(7)
v_mfma_f32_16x16x32_bf16 v[192:195],v[156:159],v[160:163],0
s_waitcnt vmcnt(6)
v_mfma_f32_16x16x32_bf16 v[192:195],v[156:159],v[164:167],v[192:195]
s_waitcnt vmcnt(5)
v_mfma_f32_16x16x32_bf16 v[192:195],v[156:159],v[168:171],v[192:195]
s_waitcnt vmcnt(4)
v_mfma_f32_16x16x32_bf16 v[192:195],v[156:159],v[172:175],v[192:195]
s_waitcnt vmcnt(3)
v_mfma_f32_16x16x32_bf16 v[196:199],v[156:159],v[176:179],0
s_waitcnt vmcnt(2)
v_mfma_f32_16x16x32_bf16 v[196:199],v[156:159],v[180:183],v[196:199]
s_waitcnt vmcnt(1)
v_mfma_f32_16x16x32_bf16 v[196:199],v[156:159],v[184:187],v[196:199]
ds_write_b128 v6,v[192:195]
s_waitcnt vmcnt(0)
v_mfma_f32_16x16x32_bf16 v[196:199],v[156:159],v[188:191],v[196:199]
s_nop 7
ds_write_b128 v6,v[196:199] offset:2048
s_waitcnt lgkmcnt(0)
s_barrier
buffer_store_dword v20,off,s[8:11],s73 sc1
s_mov_b32 s73,0x80000000
s_mov_b32 s27,2
L_aa_315:
s_cmp_lg_u32 s31,0
s_cbranch_scc1 L_ar_346
s_bitcmp1_b32 s46,0
s_cbranch_scc1 L_ar_345
L_ar_344:
ds_read_b128 v[160:163],v23
ds_read_b128 v[164:167],v23 offset:16
v_lshlrev_b32 v200,16,v224
v_and_b32 v201,0xffff0000,v224
v_lshlrev_b32 v202,16,v225
v_and_b32 v203,0xffff0000,v225
v_lshlrev_b32 v204,16,v226
v_and_b32 v205,0xffff0000,v226
v_lshlrev_b32 v206,16,v227
v_and_b32 v207,0xffff0000,v227
s_lshl_b32 s18,s51,5
s_add_u32 s18,s18,s68
s_lshl_b32 s19,s18,10
s_add_u32 s20,s19,8388608
s_waitcnt lgkmcnt(0)
v_cvt_pk_bf16_f32 v168,v160,v161
v_cvt_pk_bf16_f32 v169,v162,v163
v_cvt_pk_bf16_f32 v170,v164,v165
v_cvt_pk_bf16_f32 v171,v166,v167
v_lshlrev_b32 v160,16,v168
v_and_b32 v161,0xffff0000,v168
v_lshlrev_b32 v162,16,v169
v_and_b32 v163,0xffff0000,v169
v_lshlrev_b32 v164,16,v170
v_and_b32 v165,0xffff0000,v170
v_lshlrev_b32 v166,16,v171
v_and_b32 v167,0xffff0000,v171
v_pk_add_f32 v[200:201],v[200:201],v[160:161]
v_pk_add_f32 v[202:203],v[202:203],v[162:163]
v_pk_add_f32 v[204:205],v[204:205],v[164:165]
v_pk_add_f32 v[206:207],v[206:207],v[166:167]
v_cvt_pk_bf16_f32 v168,v200,v201
v_cvt_pk_bf16_f32 v169,v202,v203
v_cvt_pk_bf16_f32 v170,v204,v205
v_cvt_pk_bf16_f32 v171,v206,v207
v_lshlrev_b32 v200,16,v168
v_and_b32 v201,0xffff0000,v168
v_lshlrev_b32 v202,16,v169
v_and_b32 v203,0xffff0000,v169
v_lshlrev_b32 v204,16,v170
v_and_b32 v205,0xffff0000,v170
v_lshlrev_b32 v206,16,v171
v_and_b32 v207,0xffff0000,v171
v_readfirstlane_b32 s78,v200
s_nop 1
v_pk_add_f32 v[184:185],v[200:201],s[78:79] op_sel_hi:[1,0] neg_lo:[0,1] neg_hi:[0,1]
v_pk_add_f32 v[186:187],v[202:203],s[78:79] op_sel_hi:[1,0] neg_lo:[0,1] neg_hi:[0,1]
v_pk_add_f32 v[188:189],v[204:205],s[78:79] op_sel_hi:[1,0] neg_lo:[0,1] neg_hi:[0,1]
v_pk_add_f32 v[190:191],v[206:207],s[78:79] op_sel_hi:[1,0] neg_lo:[0,1] neg_hi:[0,1]
v_pk_add_f32 v[192:193],v[184:185],v[186:187]
v_pk_mul_f32 v[194:195],v[184:185],v[184:185]
v_pk_add_f32 v[196:197],v[188:189],v[190:191]
v_pk_fma_f32 v[194:195],v[186:187],v[186:187],v[194:195]
v_pk_add_f32 v[192:193],v[192:193],v[196:197]
v_pk_fma_f32 v[194:195],v[188:189],v[188:189],v[194:195]
v_add_f32 v192,v192,v193
v_pk_fma_f32 v[194:195],v[190:191],v[190:191],v[194:195]
v_add_f32 v194,v194,v195
s_nop 1
v_permlane32_swap_b32 v192,v194
v_add_f32 v192,v192,v194
s_nop 1
v_add_f32_dpp v192,v192,v192 row_ror:8 row_mask:0xf bank_mask:0xf
s_nop 1
v_add_f32_dpp v192,v192,v192 row_ror:4 row_mask:0xf bank_mask:0xf
s_nop 1
v_add_f32_dpp v192,v192,v192 row_ror:2 row_mask:0xf bank_mask:0xf
s_nop 1
v_add_f32_dpp v192,v192,v192 row_ror:1 row_mask:0xf bank_mask:0xf
v_mov_b32 v194,v192
s_nop 1
v_permlane16_swap_b32 v192,v194
v_add_f32 v192,v192,v194
v_mul_f32 v192,0x3b000000,v192
v_mov_b32 v194,v192
s_nop 1
v_permlane32_swap_b32 v192,v194
v_fma_f32 v194,-v192,v192,v194
v_add_f32 v192,s78,v192
v_max_f32 v194,0,v194
v_cvt_pk_bf16_f32 v194,v192,v194
v_lshlrev_b32 v192,16,v194
v_and_b32 v194,0xffff0000,v194
v_add_f32 v194,0x3727c5ac,v194
v_cvt_pk_bf16_f32 v194,v194,v194
v_and_b32 v194,0xffff0000,v194
v_sqrt_f32 v194,v194
v_pk_add_f32 v[184:185],v[200:201],v[192:193] op_sel_hi:[1,0] neg_lo:[0,1] neg_hi:[0,1]
v_pk_add_f32 v[186:187],v[202:203],v[192:193] op_sel_hi:[1,0] neg_lo:[0,1] neg_hi:[0,1]
v_pk_add_f32 v[188:189],v[204:205],v[192:193] op_sel_hi:[1,0] neg_lo:[0,1] neg_hi:[0,1]
v_pk_add_f32 v[190:191],v[206:207],v[192:193] op_sel_hi:[1,0] neg_lo:[0,1] neg_hi:[0,1]
v_cvt_pk_bf16_f32 v194,v194,v194
v_and_b32 v194,0xffff0000,v194
v_rcp_f32 v194,v194
v_cvt_pk_bf16_f32 v172,v184,v185
v_cvt_pk_bf16_f32 v173,v186,v187
v_cvt_pk_bf16_f32 v174,v188,v189
v_cvt_pk_bf16_f32 v175,v190,v191
v_lshlrev_b32 v184,16,v172
v_and_b32 v185,0xffff0000,v172
v_lshlrev_b32 v186,16,v173
v_and_b32 v187,0xffff0000,v173
v_lshlrev_b32 v188,16,v174
v_and_b32 v189,0xffff0000,v174
v_lshlrev_b32 v190,16,v175
v_and_b32 v191,0xffff0000,v175
v_pk_mul_f32 v[184:185],v[184:185],v[194:195] op_sel_hi:[1,0]
v_pk_mul_f32 v[186:187],v[186:187],v[194:195] op_sel_hi:[1,0]
v_pk_mul_f32 v[188:189],v[188:189],v[194:195] op_sel_hi:[1,0]
v_pk_mul_f32 v[190:191],v[190:191],v[194:195] op_sel_hi:[1,0]
v_cvt_pk_bf16_f32 v172,v184,v185
v_cvt_pk_bf16_f32 v173,v186,v187
v_cvt_pk_bf16_f32 v174,v188,v189
v_cvt_pk_bf16_f32 v175,v190,v191
v_lshlrev_b32 v176,16,v172
v_and_b32 v177,0xffff0000,v172
v_lshlrev_b32 v178,16,v173
v_and_b32 v179,0xffff0000,v173
v_lshlrev_b32 v180,16,v174
v_and_b32 v181,0xffff0000,v174
v_lshlrev_b32 v182,16,v175
v_and_b32 v183,0xffff0000,v175
v_pk_add_f32 v[200:201],v[200:201],v[176:177]
v_pk_add_f32 v[202:203],v[202:203],v[178:179]
v_pk_add_f32 v[204:205],v[204:205],v[180:181]
v_pk_add_f32 v[206:207],v[206:207],v[182:183]
v_cvt_pk_bf16_f32 v160,v200,v201
v_cvt_pk_bf16_f32 v161,v202,v203
v_cvt_pk_bf16_f32 v162,v204,v205
v_cvt_pk_bf16_f32 v163,v206,v207
buffer_store_dwordx4 v[160:163],v0,s[8:11],s20 offen sc1
v_lshlrev_b32 v200,16,v160
v_and_b32 v201,0xffff0000,v160
v_lshlrev_b32 v202,16,v161
v_and_b32 v203,0xffff0000,v161
v_lshlrev_b32 v204,16,v162
v_and_b32 v205,0xffff0000,v162
v_lshlrev_b32 v206,16,v163
v_and_b32 v207,0xffff0000,v163
v_readfirstlane_b32 s78,v200
s_nop 1
v_pk_add_f32 v[184:185],v[200:201],s[78:79] op_sel_hi:[1,0] neg_lo:[0,1] neg_hi:[0,1]
v_pk_add_f32 v[186:187],v[202:203],s[78:79] op_sel_hi:[1,0] neg_lo:[0,1] neg_hi:[0,1]
v_pk_add_f32 v[188:189],v[204:205],s[78:79] op_sel_hi:[1,0] neg_lo:[0,1] neg_hi:[0,1]
v_pk_add_f32 v[190:191],v[206:207],s[78:79] op_sel_hi:[1,0] neg_lo:[0,1] neg_hi:[0,1]
v_pk_add_f32 v[192:193],v[184:185],v[186:187]
v_pk_mul_f32 v[194:195],v[184:185],v[184:185]
v_pk_add_f32 v[196:197],v[188:189],v[190:191]
v_pk_fma_f32 v[194:195],v[186:187],v[186:187],v[194:195]
v_pk_add_f32 v[192:193],v[192:193],v[196:197]
v_pk_fma_f32 v[194:195],v[188:189],v[188:189],v[194:195]
v_add_f32 v192,v192,v193
v_pk_fma_f32 v[194:195],v[190:191],v[190:191],v[194:195]
v_add_f32 v194,v194,v195
s_nop 1
v_permlane32_swap_b32 v192,v194
v_add_f32 v192,v192,v194
s_nop 1
v_add_f32_dpp v192,v192,v192 row_ror:8 row_mask:0xf bank_mask:0xf
s_nop 1
v_add_f32_dpp v192,v192,v192 row_ror:4 row_mask:0xf bank_mask:0xf
s_nop 1
v_add_f32_dpp v192,v192,v192 row_ror:2 row_mask:0xf bank_mask:0xf
s_nop 1
v_add_f32_dpp v192,v192,v192 row_ror:1 row_mask:0xf bank_mask:0xf
v_mov_b32 v194,v192
s_nop 1
v_permlane16_swap_b32 v192,v194
v_add_f32 v192,v192,v194
v_mul_f32 v192,0x3b000000,v192
v_mov_b32 v194,v192
s_nop 1
v_permlane32_swap_b32 v192,v194
v_fma_f32 v194,-v192,v192,v194
v_add_f32 v192,s78,v192
v_max_f32 v194,0,v194
v_cvt_pk_bf16_f32 v194,v192,v194
v_lshlrev_b32 v192,16,v194
v_and_b32 v194,0xffff0000,v194
v_add_f32 v194,0x3727c5ac,v194
v_cvt_pk_bf16_f32 v194,v194,v194
v_and_b32 v194,0xffff0000,v194
v_sqrt_f32 v194,v194
v_pk_add_f32 v[184:185],v[200:201],v[192:193] op_sel_hi:[1,0] neg_lo:[0,1] neg_hi:[0,1]
v_pk_add_f32 v[186:187],v[202:203],v[192:193] op_sel_hi:[1,0] neg_lo:[0,1] neg_hi:[0,1]
v_pk_add_f32 v[188:189],v[204:205],v[192:193] op_sel_hi:[1,0] neg_lo:[0,1] neg_hi:[0,1]
v_pk_add_f32 v[190:191],v[206:207],v[192:193] op_sel_hi:[1,0] neg_lo:[0,1] neg_hi:[0,1]
v_cvt_pk_bf16_f32 v194,v194,v194
v_and_b32 v194,0xffff0000,v194
v_rcp_f32 v194,v194
v_cvt_pk_bf16_f32 v164,v184,v185
v_cvt_pk_bf16_f32 v165,v186,v187
v_cvt_pk_bf16_f32 v166,v188,v189
v_cvt_pk_bf16_f32 v167,v190,v191
v_lshlrev_b32 v184,16,v164
v_and_b32 v185,0xffff0000,v164
v_lshlrev_b32 v186,16,v165
v_and_b32 v187,0xffff0000,v165
v_lshlrev_b32 v188,16,v166
v_and_b32 v189,0xffff0000,v166
v_lshlrev_b32 v190,16,v167
v_and_b32 v191,0xffff0000,v167
v_pk_mul_f32 v[184:185],v[184:185],v[194:195] op_sel_hi:[1,0]
v_pk_mul_f32 v[186:187],v[186:187],v[194:195] op_sel_hi:[1,0]
v_pk_mul_f32 v[188:189],v[188:189],v[194:195] op_sel_hi:[1,0]
v_pk_mul_f32 v[190:191],v[190:191],v[194:195] op_sel_hi:[1,0]
v_cvt_pk_bf16_f32 v164,v184,v185
v_cvt_pk_bf16_f32 v165,v186,v187
v_cvt_pk_bf16_f32 v166,v188,v189
v_cvt_pk_bf16_f32 v167,v190,v191
s_add_u32 s20,s19,2097152
buffer_store_dwordx4 v[164:167],v0,s[8:11],s20 offen sc1
v_mov_b32 v20,1
s_lshl_b32 s73,s51,13
s_lshl2_add_u32 s73,s68,s73
s_add_u32 s73,s73,10487552
s_branch L_aa_316
L_ar_345:
ds_read_b128 v[160:163],v23
ds_read_b128 v[164:167],v23 offset:16
v_lshlrev_b32 v200,16,v224
v_and_b32 v201,0xffff0000,v224
v_lshlrev_b32 v202,16,v225
v_and_b32 v203,0xffff0000,v225
v_lshlrev_b32 v204,16,v226
v_and_b32 v205,0xffff0000,v226
v_lshlrev_b32 v206,16,v227
v_and_b32 v207,0xffff0000,v227
s_lshl_b32 s18,s51,5
s_add_u32 s18,s18,s68
s_lshl_b32 s19,s18,10
s_add_u32 s20,s19,4194304
s_waitcnt lgkmcnt(0)
v_cvt_pk_bf16_f32 v168,v160,v161
v_cvt_pk_bf16_f32 v169,v162,v163
v_cvt_pk_bf16_f32 v170,v164,v165
v_cvt_pk_bf16_f32 v171,v166,v167
v_lshlrev_b32 v160,16,v168
v_and_b32 v161,0xffff0000,v168
v_lshlrev_b32 v162,16,v169
v_and_b32 v163,0xffff0000,v169
v_lshlrev_b32 v164,16,v170
v_and_b32 v165,0xffff0000,v170
v_lshlrev_b32 v166,16,v171
v_and_b32 v167,0xffff0000,v171
v_pk_add_f32 v[200:201],v[200:201],v[160:161]
v_pk_add_f32 v[202:203],v[202:203],v[162:163]
v_pk_add_f32 v[204:205],v[204:205],v[164:165]
v_pk_add_f32 v[206:207],v[206:207],v[166:167]
v_cvt_pk_bf16_f32 v168,v200,v201
v_cvt_pk_bf16_f32 v169,v202,v203
v_cvt_pk_bf16_f32 v170,v204,v205
v_cvt_pk_bf16_f32 v171,v206,v207
buffer_store_dwordx4 v[168:171],v0,s[8:11],s20 offen sc1
v_lshlrev_b32 v200,16,v168
v_and_b32 v201,0xffff0000,v168
v_lshlrev_b32 v202,16,v169
v_and_b32 v203,0xffff0000,v169
v_lshlrev_b32 v204,16,v170
v_and_b32 v205,0xffff0000,v170
v_lshlrev_b32 v206,16,v171
v_and_b32 v207,0xffff0000,v171
v_readfirstlane_b32 s78,v200
s_nop 1
v_pk_add_f32 v[184:185],v[200:201],s[78:79] op_sel_hi:[1,0] neg_lo:[0,1] neg_hi:[0,1]
v_pk_add_f32 v[186:187],v[202:203],s[78:79] op_sel_hi:[1,0] neg_lo:[0,1] neg_hi:[0,1]
v_pk_add_f32 v[188:189],v[204:205],s[78:79] op_sel_hi:[1,0] neg_lo:[0,1] neg_hi:[0,1]
v_pk_add_f32 v[190:191],v[206:207],s[78:79] op_sel_hi:[1,0] neg_lo:[0,1] neg_hi:[0,1]
v_pk_add_f32 v[192:193],v[184:185],v[186:187]
v_pk_mul_f32 v[194:195],v[184:185],v[184:185]
v_pk_add_f32 v[196:197],v[188:189],v[190:191]
v_pk_fma_f32 v[194:195],v[186:187],v[186:187],v[194:195]
v_pk_add_f32 v[192:193],v[192:193],v[196:197]
v_pk_fma_f32 v[194:195],v[188:189],v[188:189],v[194:195]
v_add_f32 v192,v192,v193
v_pk_fma_f32 v[194:195],v[190:191],v[190:191],v[194:195]
v_add_f32 v194,v194,v195
s_nop 1
v_permlane32_swap_b32 v192,v194
v_add_f32 v192,v192,v194
s_nop 1
v_add_f32_dpp v192,v192,v192 row_ror:8 row_mask:0xf bank_mask:0xf
s_nop 1
v_add_f32_dpp v192,v192,v192 row_ror:4 row_mask:0xf bank_mask:0xf
s_nop 1
v_add_f32_dpp v192,v192,v192 row_ror:2 row_mask:0xf bank_mask:0xf
s_nop 1
v_add_f32_dpp v192,v192,v192 row_ror:1 row_mask:0xf bank_mask:0xf
v_mov_b32 v194,v192
s_nop 1
v_permlane16_swap_b32 v192,v194
v_add_f32 v192,v192,v194
v_mul_f32 v192,0x3b000000,v192
v_mov_b32 v194,v192
s_nop 1
v_permlane32_swap_b32 v192,v194
v_fma_f32 v194,-v192,v192,v194
v_add_f32 v192,s78,v192
v_max_f32 v194,0,v194
v_cvt_pk_bf16_f32 v194,v192,v194
v_lshlrev_b32 v192,16,v194
v_and_b32 v194,0xffff0000,v194
v_add_f32 v194,0x3727c5ac,v194
v_cvt_pk_bf16_f32 v194,v194,v194
v_and_b32 v194,0xffff0000,v194
v_sqrt_f32 v194,v194
v_pk_add_f32 v[184:185],v[200:201],v[192:193] op_sel_hi:[1,0] neg_lo:[0,1] neg_hi:[0,1]
v_pk_add_f32 v[186:187],v[202:203],v[192:193] op_sel_hi:[1,0] neg_lo:[0,1] neg_hi:[0,1]
v_pk_add_f32 v[188:189],v[204:205],v[192:193] op_sel_hi:[1,0] neg_lo:[0,1] neg_hi:[0,1]
v_pk_add_f32 v[190:191],v[206:207],v[192:193] op_sel_hi:[1,0] neg_lo:[0,1] neg_hi:[0,1]
v_cvt_pk_bf16_f32 v194,v194,v194
v_and_b32 v194,0xffff0000,v194
v_rcp_f32 v194,v194
v_cvt_pk_bf16_f32 v172,v184,v185
v_cvt_pk_bf16_f32 v173,v186,v187
v_cvt_pk_bf16_f32 v174,v188,v189
v_cvt_pk_bf16_f32 v175,v190,v191
v_lshlrev_b32 v184,16,v172
v_and_b32 v185,0xffff0000,v172
v_lshlrev_b32 v186,16,v173
v_and_b32 v187,0xffff0000,v173
v_lshlrev_b32 v188,16,v174
v_and_b32 v189,0xffff0000,v174
v_lshlrev_b32 v190,16,v175
v_and_b32 v191,0xffff0000,v175
v_pk_mul_f32 v[184:185],v[184:185],v[194:195] op_sel_hi:[1,0]
v_pk_mul_f32 v[186:187],v[186:187],v[194:195] op_sel_hi:[1,0]
v_pk_mul_f32 v[188:189],v[188:189],v[194:195] op_sel_hi:[1,0]
v_pk_mul_f32 v[190:191],v[190:191],v[194:195] op_sel_hi:[1,0]
v_cvt_pk_bf16_f32 v172,v184,v185
v_cvt_pk_bf16_f32 v173,v186,v187
v_cvt_pk_bf16_f32 v174,v188,v189
v_cvt_pk_bf16_f32 v175,v190,v191
v_lshlrev_b32 v176,16,v172
v_and_b32 v177,0xffff0000,v172
v_lshlrev_b32 v178,16,v173
v_and_b32 v179,0xffff0000,v173
v_lshlrev_b32 v180,16,v174
v_and_b32 v181,0xffff0000,v174
v_lshlrev_b32 v182,16,v175
v_and_b32 v183,0xffff0000,v175
v_pk_mul_f32 v[236:237],v[176:177],v[228:229]
v_pk_fma_f32 v[236:237],v[178:179],v[230:231],v[236:237]
v_pk_fma_f32 v[236:237],v[180:181],v[232:233],v[236:237]
v_pk_fma_f32 v[236:237],v[182:183],v[234:235],v[236:237]
v_add_f32 v236,v236,v237
s_nop 1
v_add_f32_dpp v236,v236,v236 row_ror:8 row_mask:0xf bank_mask:0xf
s_nop 1
v_add_f32_dpp v236,v236,v236 row_ror:4 row_mask:0xf bank_mask:0xf
s_nop 1
v_add_f32_dpp v236,v236,v236 row_ror:2 row_mask:0xf bank_mask:0xf
s_nop 1
v_add_f32_dpp v236,v236,v236 row_ror:1 row_mask:0xf bank_mask:0xf
v_mov_b32 v237,v236
s_nop 1
v_permlane16_swap_b32 v236,v237
v_add_f32 v236,v236,v237
v_mov_b32 v237,v236
s_nop 1
v_permlane32_swap_b32 v236,v237
v_add_f32 v236,v236,v237
v_cvt_pk_bf16_f32 v236,v236,v236
v_and_b32 v236,0xffff0000,v236
v_ashrrev_i32 v237,31,v236
v_or_b32 v237,0x80000000,v237
v_xor_b32 v236,v236,v237
v_and_b32 v236,0xffff0000,v236
s_sub_u32 s20,4095,s18
v_or_b32 v20,s20,v236
s_lshl_b32 s20,s51,13
s_lshl2_add_u32 s20,s68,s20
s_add_u32 s20,s20,10485760
buffer_store_dword v20,v254,s[8:11],s20 offen sc1
s_branch L_aa_316
L_ar_346:
s_bitcmp1_b32 s46,0
s_cbranch_scc1 L_aa_316
ds_read_b128 v[160:163],v23
ds_read_b128 v[164:167],v23 offset:16
v_lshlrev_b32 v200,16,v224
v_and_b32 v201,0xffff0000,v224
v_lshlrev_b32 v202,16,v225
v_and_b32 v203,0xffff0000,v225
v_lshlrev_b32 v204,16,v226
v_and_b32 v205,0xffff0000,v226
v_lshlrev_b32 v206,16,v227
v_and_b32 v207,0xffff0000,v227
v_readfirstlane_b32 s22,v246
s_cmp_eq_u32 s22,0
s_cbranch_scc1 L_ag_347
L_agb_348:
s_lshl_b32 s18,s51,5
s_add_u32 s18,s18,s68
s_lshl_b32 s19,s18,10
s_add_u32 s20,s19,6291456
s_waitcnt lgkmcnt(0)
v_cvt_pk_bf16_f32 v168,v160,v161
v_cvt_pk_bf16_f32 v169,v162,v163
v_cvt_pk_bf16_f32 v170,v164,v165
v_cvt_pk_bf16_f32 v171,v166,v167
v_lshlrev_b32 v160,16,v168
v_and_b32 v161,0xffff0000,v168
v_lshlrev_b32 v162,16,v169
v_and_b32 v163,0xffff0000,v169
v_lshlrev_b32 v164,16,v170
v_and_b32 v165,0xffff0000,v170
v_lshlrev_b32 v166,16,v171
v_and_b32 v167,0xffff0000,v171
v_pk_add_f32 v[200:201],v[200:201],v[160:161]
v_pk_add_f32 v[202:203],v[202:203],v[162:163]
v_pk_add_f32 v[204:205],v[204:205],v[164:165]
v_pk_add_f32 v[206:207],v[206:207],v[166:167]
v_cvt_pk_bf16_f32 v168,v200,v201
v_cvt_pk_bf16_f32 v169,v202,v203
v_cvt_pk_bf16_f32 v170,v204,v205
v_cvt_pk_bf16_f32 v171,v206,v207
buffer_store_dwordx4 v[168:171],v0,s[8:11],s20 offen sc1
v_lshlrev_b32 v200,16,v168
v_and_b32 v201,0xffff0000,v168
v_lshlrev_b32 v202,16,v169
v_and_b32 v203,0xffff0000,v169
v_lshlrev_b32 v204,16,v170
v_and_b32 v205,0xffff0000,v170
v_lshlrev_b32 v206,16,v171
v_and_b32 v207,0xffff0000,v171
v_readfirstlane_b32 s78,v200
s_nop 1
v_pk_add_f32 v[184:185],v[200:201],s[78:79] op_sel_hi:[1,0] neg_lo:[0,1] neg_hi:[0,1]
v_pk_add_f32 v[186:187],v[202:203],s[78:79] op_sel_hi:[1,0] neg_lo:[0,1] neg_hi:[0,1]
v_pk_add_f32 v[188:189],v[204:205],s[78:79] op_sel_hi:[1,0] neg_lo:[0,1] neg_hi:[0,1]
v_pk_add_f32 v[190:191],v[206:207],s[78:79] op_sel_hi:[1,0] neg_lo:[0,1] neg_hi:[0,1]
v_pk_add_f32 v[192:193],v[184:185],v[186:187]
v_pk_mul_f32 v[194:195],v[184:185],v[184:185]
v_pk_add_f32 v[196:197],v[188:189],v[190:191]
v_pk_fma_f32 v[194:195],v[186:187],v[186:187],v[194:195]
v_pk_add_f32 v[192:193],v[192:193],v[196:197]
v_pk_fma_f32 v[194:195],v[188:189],v[188:189],v[194:195]
v_add_f32 v192,v192,v193
v_pk_fma_f32 v[194:195],v[190:191],v[190:191],v[194:195]
v_add_f32 v194,v194,v195
s_nop 1
v_permlane32_swap_b32 v192,v194
v_add_f32 v192,v192,v194
s_nop 1
v_add_f32_dpp v192,v192,v192 row_ror:8 row_mask:0xf bank_mask:0xf
s_nop 1
v_add_f32_dpp v192,v192,v192 row_ror:4 row_mask:0xf bank_mask:0xf
s_nop 1
v_add_f32_dpp v192,v192,v192 row_ror:2 row_mask:0xf bank_mask:0xf
s_nop 1
v_add_f32_dpp v192,v192,v192 row_ror:1 row_mask:0xf bank_mask:0xf
v_mov_b32 v194,v192
s_nop 1
v_permlane16_swap_b32 v192,v194
v_add_f32 v192,v192,v194
v_mul_f32 v192,0x3b000000,v192
v_mov_b32 v194,v192
s_nop 1
v_permlane32_swap_b32 v192,v194
v_fma_f32 v194,-v192,v192,v194
v_add_f32 v192,s78,v192
v_max_f32 v194,0,v194
v_cvt_pk_bf16_f32 v194,v192,v194
v_lshlrev_b32 v192,16,v194
v_and_b32 v194,0xffff0000,v194
v_add_f32 v194,0x3727c5ac,v194
v_cvt_pk_bf16_f32 v194,v194,v194
v_and_b32 v194,0xffff0000,v194
v_sqrt_f32 v194,v194
v_pk_add_f32 v[184:185],v[200:201],v[192:193] op_sel_hi:[1,0] neg_lo:[0,1] neg_hi:[0,1]
v_pk_add_f32 v[186:187],v[202:203],v[192:193] op_sel_hi:[1,0] neg_lo:[0,1] neg_hi:[0,1]
v_pk_add_f32 v[188:189],v[204:205],v[192:193] op_sel_hi:[1,0] neg_lo:[0,1] neg_hi:[0,1]
v_pk_add_f32 v[190:191],v[206:207],v[192:193] op_sel_hi:[1,0] neg_lo:[0,1] neg_hi:[0,1]
v_cvt_pk_bf16_f32 v194,v194,v194
v_and_b32 v194,0xffff0000,v194
v_rcp_f32 v194,v194
v_cvt_pk_bf16_f32 v172,v184,v185
v_cvt_pk_bf16_f32 v173,v186,v187
v_cvt_pk_bf16_f32 v174,v188,v189
v_cvt_pk_bf16_f32 v175,v190,v191
v_lshlrev_b32 v184,16,v172
v_and_b32 v185,0xffff0000,v172
v_lshlrev_b32 v186,16,v173
v_and_b32 v187,0xffff0000,v173
v_lshlrev_b32 v188,16,v174
v_and_b32 v189,0xffff0000,v174
v_lshlrev_b32 v190,16,v175
v_and_b32 v191,0xffff0000,v175
v_pk_mul_f32 v[184:185],v[184:185],v[194:195] op_sel_hi:[1,0]
v_pk_mul_f32 v[186:187],v[186:187],v[194:195] op_sel_hi:[1,0]
v_pk_mul_f32 v[188:189],v[188:189],v[194:195] op_sel_hi:[1,0]
v_pk_mul_f32 v[190:191],v[190:191],v[194:195] op_sel_hi:[1,0]
v_cvt_pk_bf16_f32 v172,v184,v185
v_cvt_pk_bf16_f32 v173,v186,v187
v_cvt_pk_bf16_f32 v174,v188,v189
v_cvt_pk_bf16_f32 v175,v190,v191
v_lshlrev_b32 v176,16,v172
v_and_b32 v177,0xffff0000,v172
v_lshlrev_b32 v178,16,v173
v_and_b32 v179,0xffff0000,v173
v_lshlrev_b32 v180,16,v174
v_and_b32 v181,0xffff0000,v174
v_lshlrev_b32 v182,16,v175
v_and_b32 v183,0xffff0000,v175
v_pk_add_f32 v[200:201],v[200:201],v[176:177]
v_pk_add_f32 v[202:203],v[202:203],v[178:179]
v_pk_add_f32 v[204:205],v[204:205],v[180:181]
v_pk_add_f32 v[206:207],v[206:207],v[182:183]
v_cvt_pk_bf16_f32 v160,v200,v201
v_cvt_pk_bf16_f32 v161,v202,v203
v_cvt_pk_bf16_f32 v162,v204,v205
v_cvt_pk_bf16_f32 v163,v206,v207
buffer_store_dwordx4 v[160:163],v0,s[12:15],s19 offen sc1
v_pk_mul_f32 v[236:237],v[176:177],v[228:229]
v_pk_fma_f32 v[236:237],v[178:179],v[230:231],v[236:237]
v_pk_fma_f32 v[236:237],v[180:181],v[232:233],v[236:237]
v_pk_fma_f32 v[236:237],v[182:183],v[234:235],v[236:237]
v_add_f32 v236,v236,v237
s_nop 1
v_add_f32_dpp v236,v236,v236 row_ror:8 row_mask:0xf bank_mask:0xf
s_nop 1
v_add_f32_dpp v236,v236,v236 row_ror:4 row_mask:0xf bank_mask:0xf
s_nop 1
v_add_f32_dpp v236,v236,v236 row_ror:2 row_mask:0xf bank_mask:0xf
s_nop 1
v_add_f32_dpp v236,v236,v236 row_ror:1 row_mask:0xf bank_mask:0xf
v_mov_b32 v237,v236
s_nop 1
v_permlane16_swap_b32 v236,v237
v_add_f32 v236,v236,v237
v_mov_b32 v237,v236
s_nop 1
v_permlane32_swap_b32 v236,v237
v_add_f32 v236,v236,v237
v_cvt_pk_bf16_f32 v236,v236,v236
v_and_b32 v236,0xffff0000,v236
v_ashrrev_i32 v237,31,v236
v_or_b32 v237,0x80000000,v237
v_xor_b32 v236,v236,v237
v_and_b32 v236,0xffff0000,v236
s_sub_u32 s20,4095,s18
v_or_b32 v20,s20,v236
s_lshl_b32 s73,s51,13
s_lshl2_add_u32 s73,s68,s73
s_add_u32 s73,s73,10485760
s_add_u32 s73,s73,s86
L_aa_316:
s_cmp_eq_u32 s27,1
s_cbranch_scc1 L_ad_349
s_cmp_eq_u32 s27,0
s_cbranch_scc1 L_aa_317
s_cmp_ge_u32 s77,64
s_cbranch_scc1 L_aa_320
L_aa_318:
s_waitcnt vmcnt(0)
buffer_store_dword v20,off,s[8:11],s73 sc1
s_mov_b32 s73,0x80000000
v_mov_b32 v18,0
s_mov_b32 s27,0
L_aw_350:
v_cmp_eq_u32 vcc,0,v18
s_cbranch_vccz L_awd_351
buffer_load_dword v18,v19,s[8:11],0 offen sc1
s_sub_u32 s49,s49,1
s_cbranch_scc1 L_abort2
s_waitcnt vmcnt(0)
s_branch L_aw_350
L_awd_351:
s_mov_b32 s64,s70
s_mov_b32 s65,s71
s_add_u32 s64,s64,s28
s_add_u32 s65,s65,s29
s_xor_b32 s58,s67,s40
s_xor_b32 s57,s67,s41
s_add_u32 m0,s58,0
s_nop 0
buffer_load_dwordx4 v0,s[8:11],s64 offen offset:0 sc1 lds
buffer_load_dwordx4 v0,s[8:11],s64 offen offset:1024 sc1 lds
buffer_load_dwordx4 v0,s[8:11],s64 offen offset:2048 sc1 lds
buffer_load_dwordx4 v0,s[8:11],s64 offen offset:3072 sc1 lds
s_add_u32 m0,s58,4096
s_add_u32 s64,s64,4096
buffer_load_dwordx4 v0,s[8:11],s64 offen offset:0 sc1 lds
buffer_load_dwordx4 v0,s[8:11],s64 offen offset:1024 sc1 lds
buffer_load_dwordx4 v0,s[8:11],s64 offen offset:2048 sc1 lds
buffer_load_dwordx4 v0,s[8:11],s64 offen offset:3072 sc1 lds
s_add_u32 m0,s58,8192
s_add_u32 s64,s64,4096
buffer_load_dwordx4 v0,s[8:11],s64 offen offset:0 sc1 lds
buffer_load_dwordx4 v0,s[8:11],s64 offen offset:1024 sc1 lds
buffer_load_dwordx4 v0,s[8:11],s64 offen offset:2048 sc1 lds
buffer_load_dwordx4 v0,s[8:11],s64 offen offset:3072 sc1 lds
s_add_u32 m0,s57,24576
s_nop 0
buffer_load_dwordx4 v0,s[8:11],s65 offen offset:0 sc1 lds
buffer_load_dwordx4 v0,s[8:11],s65 offen offset:1024 sc1 lds
v_lshrrev_b32 v244,4,v1
s_sub_u32 s56,s77,8
v_add_u32 v244,s56,v244
v_max_i32 v244,0,v244
v_lshl_add_u32 v244,v244,13,v21
buffer_load_dwordx2 v[242:243],v244,s[8:11],0 offen sc1
s_waitcnt vmcnt(0) lgkmcnt(0)
s_barrier
s_xor_b32 s67,s67,65536
s_and_b32 s56,s50,2048
s_lshl_b32 s56,s56,4
s_add_u32 s56,s56,s67
v_add_u32 v2,s56,v0
v_add_u32 v239,s56,v253
s_and_b32 s56,s50,1024
s_lshl_b32 s56,s56,2
v_add_u32 v238,s56,v2
s_mov_b32 s76,s71
s_mov_b32 s53,s77
ds_read_b128 v[24:27],v238 offset:16384
ds_read_b128 v[40:43],v2 offset:0
ds_read_b128 v[56:59],v2 offset:4096
ds_read_b128 v[28:31],v238 offset:17408
ds_read_b128 v[44:47],v2 offset:1024
ds_read_b128 v[60:63],v2 offset:5120
ds_read_b128 v[32:35],v238 offset:18432
ds_read_b128 v[48:51],v2 offset:2048
ds_read_b128 v[64:67],v2 offset:6144
ds_read_b128 v[36:39],v238 offset:19456
ds_read_b128 v[52:55],v2 offset:3072
ds_read_b128 v[68:71],v2 offset:7168
s_waitcnt lgkmcnt(9)
v_mfma_f32_16x16x32_bf16 v[128:131],v[40:43],v[24:27],v[8:11]
ds_read_b128 v[72:75],v2 offset:24576
v_mfma_f32_16x16x32_bf16 v[132:135],v[56:59],v[24:27],v[12:15]
ds_read_b128 v[76:79],v2 offset:25600
s_waitcnt lgkmcnt(8)
v_mfma_f32_16x16x32_bf16 v[128:131],v[44:47],v[28:31],v[128:131]
ds_read_b128 v[80:83],v2 offset:26624
v_mfma_f32_16x16x32_bf16 v[132:135],v[60:63],v[28:31],v[132:135]
ds_read_b128 v[84:87],v2 offset:27648
s_waitcnt lgkmcnt(7)
v_mfma_f32_16x16x32_bf16 v[128:131],v[48:51],v[32:35],v[128:131]
ds_read_b64 v[120:121],v239 offset:24576
v_mfma_f32_16x16x32_bf16 v[132:135],v[64:67],v[32:35],v[132:135]
ds_read_b64 v[122:123],v239 offset:25600
s_waitcnt lgkmcnt(6)
v_mfma_f32_16x16x32_bf16 v[128:131],v[52:55],v[36:39],v[128:131]
ds_read_b64 v[124:125],v239 offset:26624
v_mfma_f32_16x16x32_bf16 v[132:135],v[68:71],v[36:39],v[132:135]
ds_read_b64 v[126:127],v239 offset:27648
s_waitcnt lgkmcnt(4)
v_mfma_f32_16x16x32_bf16 v[136:139],v[72:75],v[24:27],0
ds_read_b128 v[88:91],v2 offset:8192
ds_read_b128 v[92:95],v2 offset:9216
v_mfma_f32_16x16x32_bf16 v[136:139],v[76:79],v[28:31],v[136:139]
ds_read_b128 v[96:99],v2 offset:10240
ds_read_b128 v[100:103],v2 offset:11264
v_mfma_f32_16x16x32_bf16 v[136:139],v[80:83],v[32:35],v[136:139]
ds_read_b128 v[104:107],v2 offset:12288
ds_read_b128 v[108:111],v2 offset:13312
v_mfma_f32_16x16x32_bf16 v[136:139],v[84:87],v[36:39],v[136:139]
ds_read_b128 v[112:115],v2 offset:14336
ds_read_b128 v[116:119],v2 offset:15360
s_waitcnt lgkmcnt(0)
s_cmp_eq_u32 s30,0
s_cbranch_scc1 L_aa_319
s_cmp_lg_u32 s86,1536
s_cbranch_scc1 L_ae_352
s_mov_b32 s77,s35
s_mov_b32 s30,0
s_lshl_b32 s56,s77,5
s_add_u32 s56,s56,s68
s_mul_i32 s70,s56,24576
s_lshl_b32 s71,s56,12
s_lshl_b32 s59,s77,13
s_lshl2_add_u32 s59,s68,s59
s_add_u32 s59,s59,10485760
s_buffer_load_dword s32,s[8:11],s59
s_mov_b32 s33,1
s_add_u32 s70,s70,100663296
s_add_u32 s71,s71,41943040
v_mov_b32 v19,s59
s_branch L_af_353
L_ae_352:
s_ff1_i32_b64 s77,s[84:85]
s_bitset0_b64 s[84:85],s77
s_min_u32 s77,s77,64
s_lshr_b32 s61,s55,5
s_lshl_b32 s56,s77,5
s_add_u32 s56,s56,s68
s_mul_i32 s70,s56,24576
s_lshl_b32 s71,s56,12
s_lshl_b32 s59,s77,13
s_lshl2_add_u32 s59,s68,s59
s_add_u32 s59,s59,10486144
s_cmp_lt_u32 s77,s61
s_cselect_b32 s57,0,16777216
s_mov_b32 s60,s59
s_buffer_load_dword s33,s[8:11],s60
s_add_u32 s71,s71,s57
s_add_u32 s71,s71,58720256
s_cmp_eq_u32 s77,s61
s_cselect_b32 s57,50331648,0
s_cselect_b32 s58,1536,0
s_add_u32 s59,s59,s58
s_buffer_load_dword s32,s[8:11],s59
s_add_u32 s70,s70,s57
s_add_u32 s70,s70,150994944
v_mov_b32 v19,s59
v_writelane_b32 v19,s60,1
L_af_353:
v_max3_u32 v238,v72,v73,v74
v_max3_u32 v238,v74,v75,v238
v_max3_u32 v238,v76,v77,v238
v_max3_u32 v238,v78,v79,v238
v_max3_u32 v238,v80,v81,v238
v_max3_u32 v238,v82,v83,v238
v_max3_u32 v238,v84,v85,v238
v_max3_u32 v238,v86,v87,v238
v_max3_u32 v238,v120,v121,v238
v_max3_u32 v238,v122,v123,v238
v_max3_u32 v238,v124,v125,v238
v_max3_u32 v238,v126,v127,v238
v_cmp_eq_u32 vcc,-1,v238
s_cbranch_vccnz L_ac_354
L_acb_355:
v_max3_f32 v238,v128,v129,v130
v_max3_f32 v239,v131,v132,v133
v_max3_f32 v238,v134,v135,v238
v_max3_f32 v239,v138,v139,v239
v_max_f32 v238,v238,v239
v_max_f32 v239,v238,v239
v_pk_mul_f32 v[128:129],v[128:129],v[152:153] op_sel_hi:[1,0]
v_pk_mul_f32 v[130:131],v[130:131],v[152:153] op_sel_hi:[1,0]
v_permlane16_swap_b32 v238,v239
v_max_f32 v238,v238,v239
v_max_f32 v239,v238,v239
v_pk_mul_f32 v[132:133],v[132:133],v[152:153] op_sel_hi:[1,0]
v_pk_mul_f32 v[134:135],v[134:135],v[152:153] op_sel_hi:[1,0]
v_permlane32_swap_b32 v238,v239
v_max_f32 v238,v238,v239
v_mul_f32 v238,v152,v238
v_pk_mul_f32 v[138:139],v[138:139],v[152:153] op_sel_hi:[1,0]
v_pk_add_f32 v[128:129],v[128:129],v[238:239] op_sel_hi:[1,0] neg_lo:[0,1] neg_hi:[0,1]
v_pk_add_f32 v[130:131],v[130:131],v[238:239] op_sel_hi:[1,0] neg_lo:[0,1] neg_hi:[0,1]
v_pk_add_f32 v[132:133],v[132:133],v[238:239] op_sel_hi:[1,0] neg_lo:[0,1] neg_hi:[0,1]
v_pk_add_f32 v[134:135],v[134:135],v[238:239] op_sel_hi:[1,0] neg_lo:[0,1] neg_hi:[0,1]
v_pk_add_f32 v[138:139],v[138:139],v[238:239] op_sel_hi:[1,0] neg_lo:[0,1] neg_hi:[0,1]
v_exp_f32 v128,v128
v_exp_f32 v129,v129
v_exp_f32 v130,v130
v_exp_f32 v131,v131
v_exp_f32 v132,v132
v_exp_f32 v133,v133
v_exp_f32 v134,v134
v_exp_f32 v135,v135
v_exp_f32 v138,v138
v_exp_f32 v139,v139
v_pk_add_f32 v[148:149],v[128:129],v[130:131]
v_pk_add_f32 v[150:151],v[132:133],v[134:135]
v_pk_add_f32 v[148:149],v[148:149],v[138:139]
v_pk_add_f32 v[148:149],v[148:149],v[150:151]
v_add_f32 v150,v148,v149
v_add_f32 v151,v148,v149
s_nop 1
v_permlane16_swap_b32 v150,v151
v_add_f32 v148,v150,v151
v_add_f32 v149,v150,v151
s_nop 1
v_permlane32_swap_b32 v148,v149
v_add_f32 v148,v148,v149
v_rcp_f32 v148,v148
s_nop 0
v_pk_mul_f32 v[138:139],v[138:139],v[148:149] op_sel_hi:[1,0]
v_pk_mul_f32 v[128:129],v[128:129],v[148:149] op_sel_hi:[1,0]
v_pk_mul_f32 v[130:131],v[130:131],v[148:149] op_sel_hi:[1,0]
v_pk_mul_f32 v[132:133],v[132:133],v[148:149] op_sel_hi:[1,0]
v_pk_mul_f32 v[134:135],v[134:135],v[148:149] op_sel_hi:[1,0]
v_cvt_pk_bf16_f32 v144,v138,v139
v_cvt_pk_bf16_f32 v147,v138,v139
s_nop 0
v_mfma_f32_16x16x16_bf16 v[24:27],v[120:121],v[144:145],0
v_cvt_pk_bf16_f32 v140,v128,v129
v_mfma_f32_16x16x16_bf16 v[28:31],v[120:121],v[146:147],0
v_cvt_pk_bf16_f32 v141,v130,v131
v_mfma_f32_16x16x16_bf16 v[32:35],v[122:123],v[144:145],0
v_cvt_pk_bf16_f32 v142,v132,v133
v_mfma_f32_16x16x16_bf16 v[36:39],v[122:123],v[146:147],0
v_cvt_pk_bf16_f32 v143,v134,v135
v_mfma_f32_16x16x16_bf16 v[40:43],v[124:125],v[144:145],0
v_mfma_f32_16x16x16_bf16 v[44:47],v[124:125],v[146:147],0
v_mfma_f32_16x16x16_bf16 v[48:51],v[126:127],v[144:145],0
v_mfma_f32_16x16x16_bf16 v[52:55],v[126:127],v[146:147],0
v_mfma_f32_16x16x32_bf16 v[24:27],v[88:91],v[140:143],v[24:27]
v_mfma_f32_16x16x32_bf16 v[28:31],v[92:95],v[140:143],v[28:31]
v_mfma_f32_16x16x32_bf16 v[32:35],v[96:99],v[140:143],v[32:35]
v_mfma_f32_16x16x32_bf16 v[36:39],v[100:103],v[140:143],v[36:39]
v_cvt_pk_bf16_f32 v72,v24,v28
v_cvt_pk_bf16_f32 v73,v25,v29
v_mfma_f32_16x16x32_bf16 v[40:43],v[104:107],v[140:143],v[40:43]
v_cvt_pk_bf16_f32 v74,v26,v30
v_cvt_pk_bf16_f32 v75,v27,v31
v_mfma_f32_16x16x32_bf16 v[44:47],v[108:111],v[140:143],v[44:47]
ds_write_b128 v3,v[72:75] offset:0
v_cvt_pk_bf16_f32 v76,v32,v36
v_cvt_pk_bf16_f32 v77,v33,v37
v_mfma_f32_16x16x32_bf16 v[48:51],v[112:115],v[140:143],v[48:51]
v_cvt_pk_bf16_f32 v78,v34,v38
v_cvt_pk_bf16_f32 v79,v35,v39
v_mfma_f32_16x16x32_bf16 v[52:55],v[116:119],v[140:143],v[52:55]
ds_write_b128 v3,v[76:79] offset:1024
v_cvt_pk_bf16_f32 v80,v40,v44
v_cvt_pk_bf16_f32 v81,v41,v45
v_cvt_pk_bf16_f32 v82,v42,v46
v_cvt_pk_bf16_f32 v83,v43,v47
ds_write_b128 v3,v[80:83] offset:2048
s_nop 1
v_cvt_pk_bf16_f32 v84,v48,v52
v_cvt_pk_bf16_f32 v85,v49,v53
v_cvt_pk_bf16_f32 v86,v50,v54
v_cvt_pk_bf16_f32 v87,v51,v55
ds_write_b128 v3,v[84:87] offset:3072
s_waitcnt lgkmcnt(0)
s_barrier
L_ad_349:
s_mov_b32 s51,s53
s_mov_b32 s31,1
s_branch L_aa_311
L_aa_317:
s_waitcnt vmcnt(0)
buffer_store_dword v20,off,s[8:11],s73 sc1
s_mov_b32 s73,0x80000000
L_aa_319:
s_mov_b32 s51,s53
s_mov_b32 s31,0
s_add_u32 s35,s53,4
s_cmp_lt_u32 s53,5
s_cbranch_scc1 L_ab_356
s_cmp_ge_u32 s53,62
s_cbranch_scc1 L_am_358
L_aw_359:
v_min_u32 v239,v242,v243
v_cmp_eq_u32 vcc,0,v239
s_cbranch_vccz L_awd_360
s_sleep 4
buffer_load_dwordx2 v[242:243],v244,s[8:11],0 offen sc1
s_sub_u32 s49,s49,1
s_cbranch_scc1 L_abort2
s_waitcnt vmcnt(0)
s_branch L_aw_359
L_awd_360:
v_max_u32 v242,v242,v243
s_nop 1
v_max_u32_dpp v242,v242,v242 row_ror:8 row_mask:0xf bank_mask:0xf
s_nop 1
v_max_u32_dpp v242,v242,v242 row_ror:4 row_mask:0xf bank_mask:0xf
s_nop 1
v_max_u32_dpp v242,v242,v242 row_ror:2 row_mask:0xf bank_mask:0xf
s_nop 1
v_max_u32_dpp v242,v242,v242 row_ror:1 row_mask:0xf bank_mask:0xf
v_mov_b32 v243,v242
s_nop 1
v_permlane16_swap_b32 v242,v243
v_max_u32 v242,v242,v243
v_mov_b32 v243,v242
s_nop 1
v_permlane32_swap_b32 v242,v243
v_max_u32 v242,v242,v243
s_nop 0
v_readfirstlane_b32 s56,v242
v_readlane_b32 s57,v255,s53
s_max_u32 s75,s75,s56
s_bitcmp0_b64 s[42:43],s53
s_cbranch_scc1 L_ab_356
s_mov_b32 s77,s36
s_and_b32 s55,s75,0x7ff
s_sub_u32 s55,2047,s55
s_cmp_lt_u32 s75,s57
s_cselect_b32 s55,4095,s55
s_lshr_b32 s61,s55,5
s_mov_b32 s30,1
s_lshl_b32 s56,s77,5
s_add_u32 s56,s56,s68
s_mul_i32 s70,s56,24576
s_lshl_b32 s71,s56,12
s_lshl_b32 s59,s77,13
s_lshl2_add_u32 s59,s68,s59
s_add_u32 s59,s59,10486144
s_cmp_lt_u32 s77,s61
s_cselect_b32 s57,0,16777216
s_mov_b32 s60,s59
s_add_u32 s71,s71,s57
s_add_u32 s71,s71,58720256
s_cmp_eq_u32 s77,s61
s_cselect_b32 s57,50331648,0
s_cselect_b32 s58,1536,0
s_add_u32 s59,s59,s58
s_add_u32 s70,s70,s57
s_add_u32 s70,s70,150994944
v_mov_b32 v19,s59
v_writelane_b32 v19,s60,1
s_branch L_aj_357
L_ab_356:
s_mov_b32 s77,s35
s_mov_b32 s30,0
s_lshl_b32 s56,s77,5
s_add_u32 s56,s56,s68
s_mul_i32 s70,s56,24576
s_lshl_b32 s71,s56,12
s_lshl_b32 s59,s77,13
s_lshl2_add_u32 s59,s68,s59
s_add_u32 s59,s59,10485760
s_mov_b32 s33,1
s_add_u32 s70,s70,100663296
s_add_u32 s71,s71,41943040
v_mov_b32 v19,s59
L_aj_357:
buffer_load_dword v18,v19,s[8:11],0 offen sc1
s_waitcnt vmcnt(2)
v_mfma_f32_16x16x32_bf16 v[136:139],v[72:75],v[24:27],0
v_max3_u32 v238,v72,v73,v74
v_max3_u32 v238,v74,v75,v238
v_mfma_f32_16x16x32_bf16 v[136:139],v[76:79],v[28:31],v[136:139]
v_max3_u32 v238,v76,v77,v238
v_max3_u32 v238,v78,v79,v238
v_mfma_f32_16x16x32_bf16 v[136:139],v[80:83],v[32:35],v[136:139]
v_max3_u32 v238,v80,v81,v238
v_max3_u32 v238,v82,v83,v238
v_mfma_f32_16x16x32_bf16 v[136:139],v[84:87],v[36:39],v[136:139]
v_max3_u32 v238,v84,v85,v238
v_max3_u32 v238,v86,v87,v238
v_max3_u32 v238,v120,v121,v238
v_max3_u32 v238,v122,v123,v238
v_max3_u32 v238,v124,v125,v238
v_max3_u32 v238,v126,v127,v238
v_cmp_eq_u32 vcc,-1,v238
s_cbranch_vccz L_aa_322
L_aa_321:
buffer_load_dwordx4 v[72:75],v0,s[8:11],s76 offen offset:0 sc1
buffer_load_dwordx4 v[76:79],v0,s[8:11],s76 offen offset:1024 sc1
buffer_load_dwordx4 v[80:83],v0,s[8:11],s76 offen offset:2048 sc1
buffer_load_dwordx4 v[84:87],v0,s[8:11],s76 offen offset:3072 sc1
buffer_load_dwordx2 v[120:121],v253,s[8:11],s76 offen offset:0 sc1
buffer_load_dwordx2 v[122:123],v253,s[8:11],s76 offen offset:1024 sc1
buffer_load_dwordx2 v[124:125],v253,s[8:11],s76 offen offset:2048 sc1
buffer_load_dwordx2 v[126:127],v253,s[8:11],s76 offen offset:3072 sc1
buffer_load_dword v18,v19,s[8:11],0 offen sc1
s_sub_u32 s49,s49,1
s_cbranch_scc1 L_abort2
s_waitcnt vmcnt(8)
v_mfma_f32_16x16x32_bf16 v[136:139],v[72:75],v[24:27],0
v_max3_u32 v238,v72,v73,v74
v_max3_u32 v238,v74,v75,v238
s_waitcnt vmcnt(7)
v_mfma_f32_16x16x32_bf16 v[136:139],v[76:79],v[28:31],v[136:139]
v_max3_u32 v238,v76,v77,v238
v_max3_u32 v238,v78,v79,v238
s_waitcnt vmcnt(6)
v_mfma_f32_16x16x32_bf16 v[136:139],v[80:83],v[32:35],v[136:139]
v_max3_u32 v238,v80,v81,v238
v_max3_u32 v238,v82,v83,v238
s_waitcnt vmcnt(5)
v_mfma_f32_16x16x32_bf16 v[136:139],v[84:87],v[36:39],v[136:139]
v_max3_u32 v238,v84,v85,v238
v_max3_u32 v238,v86,v87,v238
s_waitcnt vmcnt(1)
v_max3_u32 v238,v120,v121,v238
v_max3_u32 v238,v122,v123,v238
v_max3_u32 v238,v124,v125,v238
v_max3_u32 v238,v126,v127,v238
v_cmp_eq_u32 vcc,-1,v238
s_cbranch_vccnz L_aa_321
L_aa_322:
s_cmp_lg_u32 s27,3
s_cbranch_scc1 L_ai_361
v_max3_f32 v238,v128,v129,v130
v_max3_f32 v239,v131,v132,v133
v_max3_f32 v238,v134,v135,v238
v_max3_f32 v239,v138,v139,v239
v_max_f32 v238,v238,v239
v_max_f32 v239,v238,v239
v_pk_mul_f32 v[128:129],v[128:129],v[152:153] op_sel_hi:[1,0]
v_pk_mul_f32 v[130:131],v[130:131],v[152:153] op_sel_hi:[1,0]
v_permlane16_swap_b32 v238,v239
v_max_f32 v238,v238,v239
v_max_f32 v239,v238,v239
v_pk_mul_f32 v[132:133],v[132:133],v[152:153] op_sel_hi:[1,0]
v_pk_mul_f32 v[134:135],v[134:135],v[152:153] op_sel_hi:[1,0]
v_permlane32_swap_b32 v238,v239
v_max_f32 v238,v238,v239
v_mul_f32 v238,v152,v238
v_pk_mul_f32 v[138:139],v[138:139],v[152:153] op_sel_hi:[1,0]
buffer_load_dword v17,v16,s[8:11],s87 offen sc1
v_pk_add_f32 v[128:129],v[128:129],v[238:239] op_sel_hi:[1,0] neg_lo:[0,1] neg_hi:[0,1]
v_pk_add_f32 v[130:131],v[130:131],v[238:239] op_sel_hi:[1,0] neg_lo:[0,1] neg_hi:[0,1]
v_pk_add_f32 v[132:133],v[132:133],v[238:239] op_sel_hi:[1,0] neg_lo:[0,1] neg_hi:[0,1]
v_pk_add_f32 v[134:135],v[134:135],v[238:239] op_sel_hi:[1,0] neg_lo:[0,1] neg_hi:[0,1]
v_pk_add_f32 v[138:139],v[138:139],v[238:239] op_sel_hi:[1,0] neg_lo:[0,1] neg_hi:[0,1]
v_exp_f32 v128,v128
v_exp_f32 v129,v129
v_exp_f32 v130,v130
v_exp_f32 v131,v131
v_exp_f32 v132,v132
v_exp_f32 v133,v133
v_exp_f32 v134,v134
v_exp_f32 v135,v135
v_exp_f32 v138,v138
v_exp_f32 v139,v139
v_pk_add_f32 v[148:149],v[128:129],v[130:131]
v_pk_add_f32 v[150:151],v[132:133],v[134:135]
v_pk_add_f32 v[148:149],v[148:149],v[138:139]
v_pk_add_f32 v[148:149],v[148:149],v[150:151]
v_add_f32 v150,v148,v149
v_add_f32 v151,v148,v149
s_nop 1
v_permlane16_swap_b32 v150,v151
v_add_f32 v148,v150,v151
v_add_f32 v149,v150,v151
s_nop 1
v_permlane32_swap_b32 v148,v149
v_add_f32 v148,v148,v149
v_rcp_f32 v148,v148
s_waitcnt vmcnt(0)
v_cmp_gt_u32 vcc,s66,v17
v_pk_mul_f32 v[138:139],v[138:139],v[148:149] op_sel_hi:[1,0]
v_pk_mul_f32 v[128:129],v[128:129],v[148:149] op_sel_hi:[1,0]
v_pk_mul_f32 v[130:131],v[130:131],v[148:149] op_sel_hi:[1,0]
v_pk_mul_f32 v[132:133],v[132:133],v[148:149] op_sel_hi:[1,0]
v_pk_mul_f32 v[134:135],v[134:135],v[148:149] op_sel_hi:[1,0]
s_cbranch_vccnz L_ap_362
L_apb_363:
s_xor_b32 s34,s69,524288
buffer_load_dwordx4 v[192:195],v7,s[8:11],s34 offen sc1
v_cvt_pk_bf16_f32 v144,v138,v139
v_cvt_pk_bf16_f32 v147,v138,v139
s_nop 0
v_mfma_f32_16x16x16_bf16 v[24:27],v[120:121],v[144:145],0
s_add_u32 s34,s34,4096
v_cvt_pk_bf16_f32 v140,v128,v129
v_mfma_f32_16x16x16_bf16 v[28:31],v[120:121],v[146:147],0
buffer_load_dwordx4 v[196:199],v7,s[8:11],s34 offen sc1
v_cvt_pk_bf16_f32 v141,v130,v131
v_mfma_f32_16x16x16_bf16 v[32:35],v[122:123],v[144:145],0
s_add_u32 s34,s34,4096
v_cvt_pk_bf16_f32 v142,v132,v133
v_mfma_f32_16x16x16_bf16 v[36:39],v[122:123],v[146:147],0
buffer_load_dwordx4 v[200:203],v7,s[8:11],s34 offen sc1
v_cvt_pk_bf16_f32 v143,v134,v135
v_mfma_f32_16x16x16_bf16 v[40:43],v[124:125],v[144:145],0
s_add_u32 s34,s34,4096
v_mfma_f32_16x16x16_bf16 v[44:47],v[124:125],v[146:147],0
buffer_load_dwordx4 v[204:207],v7,s[8:11],s34 offen sc1
v_mfma_f32_16x16x16_bf16 v[48:51],v[126:127],v[144:145],0
s_add_u32 s34,s34,4096
v_mfma_f32_16x16x16_bf16 v[52:55],v[126:127],v[146:147],0
buffer_load_dwordx4 v[208:211],v7,s[8:11],s34 offen sc1
v_mfma_f32_16x16x32_bf16 v[24:27],v[88:91],v[140:143],v[24:27]
s_add_u32 s34,s34,4096
v_mfma_f32_16x16x32_bf16 v[28:31],v[92:95],v[140:143],v[28:31]
buffer_load_dwordx4 v[212:215],v7,s[8:11],s34 offen sc1
v_mfma_f32_16x16x32_bf16 v[32:35],v[96:99],v[140:143],v[32:35]
s_add_u32 s34,s34,4096
v_mfma_f32_16x16x32_bf16 v[36:39],v[100:103],v[140:143],v[36:39]
buffer_load_dwordx4 v[216:219],v7,s[8:11],s34 offen sc1
v_cvt_pk_bf16_f32 v72,v24,v28
v_cvt_pk_bf16_f32 v73,v25,v29
v_mfma_f32_16x16x32_bf16 v[40:43],v[104:107],v[140:143],v[40:43]
s_add_u32 s34,s34,4096
v_cvt_pk_bf16_f32 v74,v26,v30
v_cvt_pk_bf16_f32 v75,v27,v31
v_mfma_f32_16x16x32_bf16 v[44:47],v[108:111],v[140:143],v[44:47]
ds_write_b128 v3,v[72:75] offset:0
v_cvt_pk_bf16_f32 v76,v32,v36
v_cvt_pk_bf16_f32 v77,v33,v37
v_mfma_f32_16x16x32_bf16 v[48:51],v[112:115],v[140:143],v[48:51]
buffer_load_dwordx4 v[220:223],v7,s[8:11],s34 offen sc1
v_cvt_pk_bf16_f32 v78,v34,v38
v_cvt_pk_bf16_f32 v79,v35,v39
v_mfma_f32_16x16x32_bf16 v[52:55],v[116:119],v[140:143],v[52:55]
ds_write_b128 v3,v[76:79] offset:1024
v_cvt_pk_bf16_f32 v80,v40,v44
v_cvt_pk_bf16_f32 v81,v41,v45
v_cvt_pk_bf16_f32 v82,v42,v46
v_cvt_pk_bf16_f32 v83,v43,v47
ds_write_b128 v3,v[80:83] offset:2048
s_nop 1
v_cvt_pk_bf16_f32 v84,v48,v52
v_cvt_pk_bf16_f32 v85,v49,v53
v_cvt_pk_bf16_f32 v86,v50,v54
v_cvt_pk_bf16_f32 v87,v51,v55
ds_write_b128 v3,v[84:87] offset:3072
v_readlane_b32 s32,v18,0
v_readlane_b32 s33,v18,1
s_waitcnt lgkmcnt(0)
s_barrier
s_branch L_aa_324
L_ai_361:
v_max3_f32 v238,v128,v129,v130
v_max3_f32 v239,v131,v132,v133
v_max3_f32 v238,v134,v135,v238
v_max3_f32 v239,v138,v139,v239
v_max_f32 v238,v238,v239
v_max_f32 v239,v238,v239
v_pk_mul_f32 v[128:129],v[128:129],v[152:153] op_sel_hi:[1,0]
v_pk_mul_f32 v[130:131],v[130:131],v[152:153] op_sel_hi:[1,0]
v_permlane16_swap_b32 v238,v239
v_max_f32 v238,v238,v239
v_max_f32 v239,v238,v239
v_pk_mul_f32 v[132:133],v[132:133],v[152:153] op_sel_hi:[1,0]
v_pk_mul_f32 v[134:135],v[134:135],v[152:153] op_sel_hi:[1,0]
v_permlane32_swap_b32 v238,v239
v_max_f32 v238,v238,v239
v_mul_f32 v238,v152,v238
v_pk_mul_f32 v[138:139],v[138:139],v[152:153] op_sel_hi:[1,0]
v_pk_add_f32 v[128:129],v[128:129],v[238:239] op_sel_hi:[1,0] neg_lo:[0,1] neg_hi:[0,1]
v_pk_add_f32 v[130:131],v[130:131],v[238:239] op_sel_hi:[1,0] neg_lo:[0,1] neg_hi:[0,1]
v_pk_add_f32 v[132:133],v[132:133],v[238:239] op_sel_hi:[1,0] neg_lo:[0,1] neg_hi:[0,1]
v_pk_add_f32 v[134:135],v[134:135],v[238:239] op_sel_hi:[1,0] neg_lo:[0,1] neg_hi:[0,1]
v_pk_add_f32 v[138:139],v[138:139],v[238:239] op_sel_hi:[1,0] neg_lo:[0,1] neg_hi:[0,1]
v_exp_f32 v128,v128
v_exp_f32 v129,v129
v_exp_f32 v130,v130
v_exp_f32 v131,v131
v_exp_f32 v132,v132
v_exp_f32 v133,v133
v_exp_f32 v134,v134
v_exp_f32 v135,v135
v_exp_f32 v138,v138
v_exp_f32 v139,v139
v_pk_add_f32 v[148:149],v[128:129],v[130:131]
v_pk_add_f32 v[150:151],v[132:133],v[134:135]
v_pk_add_f32 v[148:149],v[148:149],v[138:139]
v_pk_add_f32 v[148:149],v[148:149],v[150:151]
v_add_f32 v150,v148,v149
v_add_f32 v151,v148,v149
s_nop 1
v_permlane16_swap_b32 v150,v151
v_add_f32 v148,v150,v151
v_add_f32 v149,v150,v151
s_nop 1
v_permlane32_swap_b32 v148,v149
v_add_f32 v148,v148,v149
v_rcp_f32 v148,v148
s_nop 0
v_pk_mul_f32 v[138:139],v[138:139],v[148:149] op_sel_hi:[1,0]
v_pk_mul_f32 v[128:129],v[128:129],v[148:149] op_sel_hi:[1,0]
v_pk_mul_f32 v[130:131],v[130:131],v[148:149] op_sel_hi:[1,0]
v_pk_mul_f32 v[132:133],v[132:133],v[148:149] op_sel_hi:[1,0]
v_pk_mul_f32 v[134:135],v[134:135],v[148:149] op_sel_hi:[1,0]
v_cvt_pk_bf16_f32 v144,v138,v139
v_cvt_pk_bf16_f32 v147,v138,v139
s_nop 0
v_mfma_f32_16x16x16_bf16 v[24:27],v[120:121],v[144:145],0
v_cvt_pk_bf16_f32 v140,v128,v129
v_mfma_f32_16x16x16_bf16 v[28:31],v[120:121],v[146:147],0
v_cvt_pk_bf16_f32 v141,v130,v131
v_mfma_f32_16x16x16_bf16 v[32:35],v[122:123],v[144:145],0
v_cvt_pk_bf16_f32 v142,v132,v133
v_mfma_f32_16x16x16_bf16 v[36:39],v[122:123],v[146:147],0
v_cvt_pk_bf16_f32 v143,v134,v135
v_mfma_f32_16x16x16_bf16 v[40:43],v[124:125],v[144:145],0
v_mfma_f32_16x16x16_bf16 v[44:47],v[124:125],v[146:147],0
v_mfma_f32_16x16x16_bf16 v[48:51],v[126:127],v[144:145],0
v_mfma_f32_16x16x16_bf16 v[52:55],v[126:127],v[146:147],0
v_mfma_f32_16x16x32_bf16 v[24:27],v[88:91],v[140:143],v[24:27]
v_mfma_f32_16x16x32_bf16 v[28:31],v[92:95],v[140:143],v[28:31]
v_mfma_f32_16x16x32_bf16 v[32:35],v[96:99],v[140:143],v[32:35]
v_mfma_f32_16x16x32_bf16 v[36:39],v[100:103],v[140:143],v[36:39]
v_cvt_pk_bf16_f32 v72,v24,v28
v_cvt_pk_bf16_f32 v73,v25,v29
v_mfma_f32_16x16x32_bf16 v[40:43],v[104:107],v[140:143],v[40:43]
v_cvt_pk_bf16_f32 v74,v26,v30
v_cvt_pk_bf16_f32 v75,v27,v31
v_mfma_f32_16x16x32_bf16 v[44:47],v[108:111],v[140:143],v[44:47]
ds_write_b128 v3,v[72:75] offset:0
v_cvt_pk_bf16_f32 v76,v32,v36
v_cvt_pk_bf16_f32 v77,v33,v37
v_mfma_f32_16x16x32_bf16 v[48:51],v[112:115],v[140:143],v[48:51]
v_cvt_pk_bf16_f32 v78,v34,v38
v_cvt_pk_bf16_f32 v79,v35,v39
v_mfma_f32_16x16x32_bf16 v[52:55],v[116:119],v[140:143],v[52:55]
ds_write_b128 v3,v[76:79] offset:1024
v_cvt_pk_bf16_f32 v80,v40,v44
v_cvt_pk_bf16_f32 v81,v41,v45
v_cvt_pk_bf16_f32 v82,v42,v46
v_cvt_pk_bf16_f32 v83,v43,v47
ds_write_b128 v3,v[80:83] offset:2048
s_nop 1
v_cvt_pk_bf16_f32 v84,v48,v52
v_cvt_pk_bf16_f32 v85,v49,v53
v_cvt_pk_bf16_f32 v86,v50,v54
v_cvt_pk_bf16_f32 v87,v51,v55
ds_write_b128 v3,v[84:87] offset:3072
s_waitcnt vmcnt(0)
v_readlane_b32 s32,v18,0
v_readlane_b32 s33,v18,1
s_waitcnt lgkmcnt(0)
s_barrier
s_branch L_aa_311
L_aa_320:
s_cmp_lg_u32 s86,1536
s_cbranch_scc1 L_az_364
s_cmp_ge_u32 s35,66
s_cbranch_scc1 L_aa_310
v_subrev_u32 v248,s36,v1
v_and_b32 v248,0x80000003,v248
v_cmp_eq_u32 vcc,0,v248
v_lshlrev_b32 v248,2,v1
v_mov_b32 v249,0x40000000
v_cndmask_b32 v248,v249,v248,vcc
v_mov_b32 v249,3
s_or_b32 s59,s68,s46
s_mov_b32 s59,11018240
s_cmov_b32 s59,0x80000000
buffer_store_dword v249,v248,s[8:11],s59 offen sc1
L_aa_310:
s_waitcnt vmcnt(0)
buffer_store_dword v20,off,s[8:11],s73 sc1
s_mov_b32 s73,0x80000000
v_lshlrev_b32 v238,2,v1
v_add_u32 v248,155712,v238
s_cmp_lg_u32 s46,0
s_cbranch_scc1 L_an_365
s_lshl_b32 s59,s54,13
s_add_u32 s59,s59,11026432
L_fp_366:
s_sleep 1
buffer_load_dword v239,v238,s[8:11],s59 offen sc1
s_sub_u32 s49,s49,1
s_cbranch_scc1 L_abort2
s_waitcnt vmcnt(0)
v_cmp_eq_u32 vcc,0,v239
s_cbranch_vccnz L_fp_366
ds_write_b32 v248,v239
s_waitcnt lgkmcnt(0)
L_an_365:
s_barrier
ds_read_b32 v239,v248
s_mov_b32 s86,768
s_mov_b32 s30,1
s_waitcnt lgkmcnt(0)
v_readfirstlane_b32 s55,v239
v_and_b32 v239,255,v239
s_lshr_b32 s55,s55,8
s_lshr_b32 s61,s55,5
v_cmp_ne_u32 s[38:39],3,v239
v_cmp_le_u32 vcc,s61,v1
s_nop 1
v_cndmask_b32 v238,1,2,vcc
v_cmp_ne_u32 s[84:85],v238,v239
s_bcnt1_i32_b64 s56,s[84:85]
s_nop 0
v_mbcnt_lo_u32_b32 v238,s84,0
v_mbcnt_hi_u32_b32 v238,s85,v238
s_mul_i32 s56,s56,12
s_add_u32 s56,s56,48
s_lshr_b32 s56,s56,7
s_lshl_b32 s56,s56,1
v_cmp_gt_u32 vcc,s56,v238
v_and_b32 v239,1,v238
v_and_b32 v238,3,v238
v_add_u32 v238,2,v238
v_cndmask_b32 v238,v238,v239,vcc
v_cmp_eq_u32 vcc,s54,v238
s_and_b64 s[84:85],s[84:85],vcc
s_ff1_i32_b64 s77,s[84:85]
s_bitset0_b64 s[84:85],s77
s_min_u32 s77,s77,64
s_lshl_b32 s56,s77,5
s_add_u32 s56,s56,s68
s_mul_i32 s70,s56,24576
s_lshl_b32 s71,s56,12
s_lshl_b32 s59,s77,13
s_lshl2_add_u32 s59,s68,s59
s_add_u32 s59,s59,10486144
s_cmp_lt_u32 s77,s61
s_cselect_b32 s57,0,16777216
s_mov_b32 s60,s59
s_buffer_load_dword s33,s[8:11],s60
s_add_u32 s71,s71,s57
s_add_u32 s71,s71,58720256
s_cmp_eq_u32 s77,s61
s_cselect_b32 s57,50331648,0
s_cselect_b32 s58,1536,0
s_add_u32 s59,s59,s58
s_buffer_load_dword s32,s[8:11],s59
s_add_u32 s70,s70,s57
s_add_u32 s70,s70,150994944
v_mov_b32 v19,s59
v_writelane_b32 v19,s60,1
s_cmp_lt_u32 s77,64
s_cbranch_scc1 L_aa_318
L_az_364:
s_waitcnt vmcnt(0)
buffer_store_dword v20,off,s[8:11],s73 sc1
s_mov_b32 s73,0x80000000
s_endpgm
L_ag_326:
s_lshl_b32 s21,s26,13
s_lshl2_add_u32 s21,s68,s21
s_add_u32 s21,s21,10487296
L_ww_367:
buffer_load_dword v246,off,s[8:11],s21 sc1
s_sub_u32 s49,s49,1
s_cbranch_scc1 L_abort2
s_waitcnt vmcnt(0)
v_readfirstlane_b32 s22,v246
s_cmp_eq_u32 s22,0
s_cbranch_scc1 L_ww_367
L_wwd_368:
s_branch L_agb_327
L_ac_335:
buffer_store_dword v20,off,s[8:11],s73 sc1
s_mov_b32 s73,0x80000000
buffer_load_dwordx4 v[72:75],v0,s[8:11],s76 offen offset:0 sc1
buffer_load_dwordx4 v[76:79],v0,s[8:11],s76 offen offset:1024 sc1
buffer_load_dwordx4 v[80:83],v0,s[8:11],s76 offen offset:2048 sc1
buffer_load_dwordx4 v[84:87],v0,s[8:11],s76 offen offset:3072 sc1
buffer_load_dwordx2 v[120:121],v253,s[8:11],s76 offen offset:0 sc1
buffer_load_dwordx2 v[122:123],v253,s[8:11],s76 offen offset:1024 sc1
buffer_load_dwordx2 v[124:125],v253,s[8:11],s76 offen offset:2048 sc1
buffer_load_dwordx2 v[126:127],v253,s[8:11],s76 offen offset:3072 sc1
s_sub_u32 s49,s49,1
s_cbranch_scc1 L_abort2
s_waitcnt vmcnt(7)
v_mfma_f32_16x16x32_bf16 v[136:139],v[72:75],v[24:27],0
v_max3_u32 v238,v72,v73,v74
v_max3_u32 v238,v74,v75,v238
s_waitcnt vmcnt(6)
v_mfma_f32_16x16x32_bf16 v[136:139],v[76:79],v[28:31],v[136:139]
v_max3_u32 v238,v76,v77,v238
v_max3_u32 v238,v78,v79,v238
s_waitcnt vmcnt(5)
v_mfma_f32_16x16x32_bf16 v[136:139],v[80:83],v[32:35],v[136:139]
v_max3_u32 v238,v80,v81,v238
v_max3_u32 v238,v82,v83,v238
s_waitcnt vmcnt(4)
v_mfma_f32_16x16x32_bf16 v[136:139],v[84:87],v[36:39],v[136:139]
v_max3_u32 v238,v84,v85,v238
v_max3_u32 v238,v86,v87,v238
s_waitcnt vmcnt(0)
v_max3_u32 v238,v120,v121,v238
v_max3_u32 v238,v122,v123,v238
v_max3_u32 v238,v124,v125,v238
v_max3_u32 v238,v126,v127,v238
v_cmp_eq_u32 vcc,-1,v238
s_cbranch_vccnz L_ac_335
s_branch L_acb_336
L_ap_338:
L_aw_369:
v_cmp_gt_u32 vcc,s66,v17
s_cbranch_vccz L_awd_370
buffer_load_dword v17,v16,s[8:11],s87 offen sc1
s_sub_u32 s49,s49,1
s_cbranch_scc1 L_abort2
s_waitcnt vmcnt(0)
s_branch L_aw_369
L_awd_370:
s_branch L_apb_339
L_ag_347:
s_lshl_b32 s21,s51,13
s_lshl2_add_u32 s21,s68,s21
s_add_u32 s21,s21,10487296
L_ww_371:
buffer_load_dword v246,off,s[8:11],s21 sc1
s_sub_u32 s49,s49,1
s_cbranch_scc1 L_abort2
s_waitcnt vmcnt(0)
v_readfirstlane_b32 s22,v246
s_cmp_eq_u32 s22,0
s_cbranch_scc1 L_ww_371
L_wwd_372:
s_branch L_agb_348
L_ac_354:
buffer_store_dword v20,off,s[8:11],s73 sc1
s_mov_b32 s73,0x80000000
buffer_load_dwordx4 v[72:75],v0,s[8:11],s76 offen offset:0 sc1
buffer_load_dwordx4 v[76:79],v0,s[8:11],s76 offen offset:1024 sc1
buffer_load_dwordx4 v[80:83],v0,s[8:11],s76 offen offset:2048 sc1
buffer_load_dwordx4 v[84:87],v0,s[8:11],s76 offen offset:3072 sc1
buffer_load_dwordx2 v[120:121],v253,s[8:11],s76 offen offset:0 sc1
buffer_load_dwordx2 v[122:123],v253,s[8:11],s76 offen offset:1024 sc1
buffer_load_dwordx2 v[124:125],v253,s[8:11],s76 offen offset:2048 sc1
buffer_load_dwordx2 v[126:127],v253,s[8:11],s76 offen offset:3072 sc1
s_sub_u32 s49,s49,1
s_cbranch_scc1 L_abort2
s_waitcnt vmcnt(7)
v_mfma_f32_16x16x32_bf16 v[136:139],v[72:75],v[24:27],0
v_max3_u32 v238,v72,v73,v74
v_max3_u32 v238,v74,v75,v238
s_waitcnt vmcnt(6)
v_mfma_f32_16x16x32_bf16 v[136:139],v[76:79],v[28:31],v[136:139]
v_max3_u32 v238,v76,v77,v238
v_max3_u32 v238,v78,v79,v238
s_waitcnt vmcnt(5)
v_mfma_f32_16x16x32_bf16 v[136:139],v[80:83],v[32:35],v[136:139]
v_max3_u32 v238,v80,v81,v238
v_max3_u32 v238,v82,v83,v238
s_waitcnt vmcnt(4)
v_mfma_f32_16x16x32_bf16 v[136:139],v[84:87],v[36:39],v[136:139]
v_max3_u32 v238,v84,v85,v238
v_max3_u32 v238,v86,v87,v238
s_waitcnt vmcnt(0)
v_max3_u32 v238,v120,v121,v238
v_max3_u32 v238,v122,v123,v238
v_max3_u32 v238,v124,v125,v238
v_max3_u32 v238,v126,v127,v238
v_cmp_eq_u32 vcc,-1,v238
s_cbranch_vccnz L_ac_354
s_branch L_acb_355
L_am_358:
v_subrev_u32 v248,s36,v1
v_and_b32 v248,0x80000003,v248
v_cmp_eq_u32 vcc,0,v248
v_lshlrev_b32 v248,2,v1
v_mov_b32 v249,0x40000000
v_cndmask_b32 v248,v249,v248,vcc
v_mov_b32 v249,3
s_or_b32 s59,s68,s46
s_mov_b32 s59,11018240
s_cmov_b32 s59,0x80000000
buffer_store_dword v249,v248,s[8:11],s59 offen sc1
s_branch L_ab_356
L_ap_362:
L_aw_373:
v_cmp_gt_u32 vcc,s66,v17
s_cbranch_vccz L_awd_374
buffer_load_dword v17,v16,s[8:11],s87 offen sc1
s_sub_u32 s49,s49,1
s_cbranch_scc1 L_abort2
s_waitcnt vmcnt(0)
s_branch L_aw_373
L_awd_374:
s_branch L_apb_363
s_endpgm
L_wm:
s_nop 11
v_and_b32 v120,15,v1
v_lshrrev_b32 v121,4,v1
v_mov_b32 v17,1
s_lshl_b32 s56,s46,15
v_add_u32 v18,s56,v0
s_lshl_b32 s56,s46,2
v_add_u32 v125,s56,v121
v_xor_b32 v126,v125,v120
v_lshlrev_b32 v126,4,v126
v_lshl_add_u32 v20,v125,10,v126
v_add_u32 v125,0,v121
v_xor_b32 v125,v125,v120
v_lshlrev_b32 v125,4,v125
v_lshl_add_u32 v125,v120,8,v125
v_add_u32 v4,131072,v125
v_add_u32 v125,4,v121
v_xor_b32 v125,v125,v120
v_lshlrev_b32 v125,4,v125
v_lshl_add_u32 v125,v120,8,v125
v_add_u32 v5,131072,v125
v_add_u32 v125,8,v121
v_xor_b32 v125,v125,v120
v_lshlrev_b32 v125,4,v125
v_lshl_add_u32 v125,v120,8,v125
v_add_u32 v6,131072,v125
v_add_u32 v125,12,v121
v_xor_b32 v125,v125,v120
v_lshlrev_b32 v125,4,v125
v_lshl_add_u32 v125,v120,8,v125
v_add_u32 v7,131072,v125
v_lshlrev_b32 v21,5,v120
v_and_b32 v125,1,v121
v_lshl_add_u32 v21,v125,4,v21
s_lshl_b32 s56,s46,9
v_lshrrev_b32 v125,1,v121
v_lshl_add_u32 v21,v125,11,v21
s_add_u32 s56,s56,155648
v_add_u32 v21,s56,v21
v_lshlrev_b32 v22,4,v120
v_lshl_add_u32 v22,v121,10,v22
s_lshl_b32 s56,s46,8
v_add_u32 v22,s56,v22
s_mov_b32 s54,0
s_mov_b32 s31,0
s_mov_b32 s53,6
s_mov_b32 s72,0x80000000
s_mov_b32 s73,0
s_mov_b32 s77,-1
s_mov_b32 s86,0
s_mov_b32 s19,0
s_mov_b32 s74,2948595712
s_mov_b32 s75,2863311530
v_and_b32 v23,15,v1
v_lshlrev_b32 v23,3,v23
v_lshrrev_b32 v16,4,v1
v_lshl_add_u32 v23,v16,13,v23
v_mov_b32 v19,159744
v_lshl_add_u32 v16,v16,2,v19
v_and_b32 v9,15,v1
v_lshrrev_b32 v10,4,v1
v_and_b32 v124,1,v1
v_lshlrev_b32 v124,4,v124
v_mov_b32 v125,0xffff
v_lshlrev_b32 v125,v124,v125
v_lshrrev_b32 v124,2,v9
v_cmp_eq_u32 vcc,0,v124
s_nop 1
v_cndmask_b32 v12,0,v125,vcc
v_cmp_eq_u32 vcc,1,v124
s_nop 1
v_cndmask_b32 v13,0,v125,vcc
v_and_b32 v124,2,v1
v_cmp_eq_u32 vcc,0,v124
v_mov_b32 v14,0xeeee
v_mov_b32 v124,0x4444
v_cndmask_b32 v14,v14,v124,vcc
v_lshlrev_b32 v11,14,v10
v_lshl_add_u32 v11,v9,4,v11
s_lshl_b32 s65,s51,15
s_add_u32 s65,s65,92274688
s_lshl_b32 s62,s47,10
s_add_u32 s62,s62,s65
s_lshl_b32 s63,s47,16
s_lshl_b32 s60,s46,8
s_add_u32 s63,s63,s60
s_mov_b32 s4,s38
s_mov_b32 s5,s39
s_mov_b32 s6,1835008
s_mov_b32 s7,0x20000
buffer_load_dwordx4 v[24:27],v11,s[4:7],s63 offen offset:0
buffer_load_dwordx4 v[28:31],v11,s[4:7],s63 offen offset:1024
buffer_load_dwordx4 v[32:35],v11,s[4:7],s63 offen offset:2048
buffer_load_dwordx4 v[36:39],v11,s[4:7],s63 offen offset:3072
s_add_u32 s63,s63,4096
buffer_load_dwordx4 v[40:43],v11,s[4:7],s63 offen offset:0
buffer_load_dwordx4 v[44:47],v11,s[4:7],s63 offen offset:1024
buffer_load_dwordx4 v[48:51],v11,s[4:7],s63 offen offset:2048
buffer_load_dwordx4 v[52:55],v11,s[4:7],s63 offen offset:3072
s_add_u32 s63,s63,4096
buffer_load_dwordx4 v[56:59],v11,s[4:7],s63 offen offset:0
buffer_load_dwordx4 v[60:63],v11,s[4:7],s63 offen offset:1024
buffer_load_dwordx4 v[64:67],v11,s[4:7],s63 offen offset:2048
buffer_load_dwordx4 v[68:71],v11,s[4:7],s63 offen offset:3072
s_add_u32 s63,s63,4096
buffer_load_dwordx4 v[72:75],v11,s[4:7],s63 offen offset:0
buffer_load_dwordx4 v[76:79],v11,s[4:7],s63 offen offset:1024
buffer_load_dwordx4 v[80:83],v11,s[4:7],s63 offen offset:2048
buffer_load_dwordx4 v[84:87],v11,s[4:7],s63 offen offset:3072
s_mov_b32 s4,s32
s_mov_b32 s5,s33
s_mov_b32 s6,1024
s_mov_b32 s7,0x20000
buffer_load_dwordx4 v[88:91],v0,s[4:7],0 offen
s_waitcnt vmcnt(0)
v_lshlrev_b32 v96,16,v88
v_and_b32 v97,0xffff0000,v88
v_lshlrev_b32 v98,16,v89
v_and_b32 v99,0xffff0000,v89
v_lshlrev_b32 v100,16,v90
v_and_b32 v101,0xffff0000,v90
v_lshlrev_b32 v102,16,v91
v_and_b32 v103,0xffff0000,v91
v_mul_f32 v88,v96,v96
v_fma_f32 v88,v97,v97,v88
v_fma_f32 v88,v98,v98,v88
v_fma_f32 v88,v99,v99,v88
v_fma_f32 v88,v100,v100,v88
v_fma_f32 v88,v101,v101,v88
v_fma_f32 v88,v102,v102,v88
v_fma_f32 v88,v103,v103,v88
s_nop 1
v_add_f32_dpp v88,v88,v88 row_ror:8 row_mask:0xf bank_mask:0xf
s_nop 1
v_add_f32_dpp v88,v88,v88 row_ror:4 row_mask:0xf bank_mask:0xf
s_nop 1
v_add_f32_dpp v88,v88,v88 row_ror:2 row_mask:0xf bank_mask:0xf
s_nop 1
v_add_f32_dpp v88,v88,v88 row_ror:1 row_mask:0xf bank_mask:0xf
v_mov_b32 v89,v88
s_nop 1
v_permlane16_swap_b32 v88,v89
v_add_f32 v88,v88,v89
v_mov_b32 v89,v88
s_nop 1
v_permlane32_swap_b32 v88,v89
v_add_f32 v88,v88,v89
v_sqrt_f32 v88,v88
s_nop 0
v_mul_f32 v88,0x40333333,v88
s_nop 0
v_readfirstlane_b32 s25,v88
s_bitset1_b32 s25,31
s_ff1_i32_b64 s30,s[74:75]
s_bitset0_b64 s[74:75],s30
s_min_u32 s30,s30,127
s_lshl_b32 s70,s30,15
s_add_u32 s70,s70,0
s_add_u32 s71,s70,16384
L_mo_378:
s_cmp_lg_u32 s19,0
s_cbranch_scc1 L_mo_379
s_add_u32 m0,s50,131072
s_nop 0
buffer_load_dwordx4 v20,s[8:11],s70 offen offset:0 sc1 lds
s_add_u32 m0,s50,135168
s_nop 0
buffer_load_dwordx4 v20,s[8:11],s71 offen offset:0 sc1 lds
s_add_u32 m0,s50,139008
s_nop 0
buffer_load_dwordx4 v20,s[8:11],s70 offen offset:256 sc1 lds
s_add_u32 m0,s50,143104
s_nop 0
buffer_load_dwordx4 v20,s[8:11],s71 offen offset:256 sc1 lds
s_add_u32 m0,s50,146944
s_nop 0
buffer_load_dwordx4 v20,s[8:11],s70 offen offset:512 sc1 lds
s_add_u32 m0,s50,151040
s_nop 0
buffer_load_dwordx4 v20,s[8:11],s71 offen offset:512 sc1 lds
s_mov_b32 s19,1
s_waitcnt vmcnt(0)
L_mo_379:
s_mov_b32 s51,s30
s_mov_b64 s[68:69],s[70:71]
s_ff1_i32_b64 s30,s[74:75]
s_bitset0_b64 s[74:75],s30
s_min_u32 s30,s30,127
s_lshl_b32 s70,s30,15
s_add_u32 s70,s70,0
s_add_u32 s71,s70,16384
s_lshl_b32 s76,s31,13
s_add_u32 s76,s76,10487040
s_lshl_b32 s58,s51,5
s_add_u32 s58,s58,s47
s_mul_i32 s58,s58,24576
s_add_u32 s58,s58,100663296
s_add_u32 s61,s58,s50
s_add_u32 s62,s61,4096
s_add_u32 s63,s61,16384
s_add_u32 s64,s61,20480
s_add_u32 s65,s61,s50
s_add_u32 s65,s65,8192
s_waitcnt vmcnt(12)
s_barrier
ds_read_b128 v[72:75],v4 offset:0
ds_read_b128 v[76:79],v4 offset:4096
ds_read_b128 v[80:83],v5 offset:0
ds_read_b128 v[84:87],v5 offset:4096
s_add_u32 m0,s50,154880
s_nop 0
buffer_load_dwordx4 v20,s[8:11],s68 offen offset:768 sc1 lds
s_add_u32 m0,s50,158976
s_nop 0
buffer_load_dwordx4 v20,s[8:11],s69 offen offset:768 sc1 lds
s_waitcnt lgkmcnt(2)
v_mfma_f32_16x16x32_bf16 v[40:43],a[128:131],v[72:75],0
ds_read_b128 v[108:111],v6 offset:0
v_mfma_f32_16x16x32_bf16 v[56:59],v[72:75],v[128:131],0
v_mfma_f32_16x16x32_bf16 v[24:27],a[0:3],v[72:75],0
ds_read_b128 v[112:115],v6 offset:4096
v_mfma_f32_16x16x32_bf16 v[44:47],a[128:131],v[76:79],0
v_mfma_f32_16x16x32_bf16 v[60:63],v[76:79],v[128:131],0
v_mfma_f32_16x16x32_bf16 v[28:31],a[0:3],v[76:79],0
v_mfma_f32_16x16x32_bf16 v[48:51],a[136:139],v[72:75],0
v_mfma_f32_16x16x32_bf16 v[64:67],v[72:75],v[136:139],0
v_mfma_f32_16x16x32_bf16 v[32:35],a[8:11],v[72:75],0
v_mfma_f32_16x16x32_bf16 v[52:55],a[136:139],v[76:79],0
v_mfma_f32_16x16x32_bf16 v[68:71],v[76:79],v[136:139],0
v_mfma_f32_16x16x32_bf16 v[36:39],a[8:11],v[76:79],0
s_waitcnt lgkmcnt(2)
v_mfma_f32_16x16x32_bf16 v[40:43],a[132:135],v[80:83],v[40:43]
ds_read_b128 v[72:75],v7 offset:0
v_mfma_f32_16x16x32_bf16 v[56:59],v[80:83],v[132:135],v[56:59]
v_mfma_f32_16x16x32_bf16 v[24:27],a[4:7],v[80:83],v[24:27]
ds_read_b128 v[76:79],v7 offset:4096
v_mfma_f32_16x16x32_bf16 v[44:47],a[132:135],v[84:87],v[44:47]
v_mfma_f32_16x16x32_bf16 v[60:63],v[84:87],v[132:135],v[60:63]
v_mfma_f32_16x16x32_bf16 v[28:31],a[4:7],v[84:87],v[28:31]
v_mfma_f32_16x16x32_bf16 v[48:51],a[140:143],v[80:83],v[48:51]
v_mfma_f32_16x16x32_bf16 v[64:67],v[80:83],v[140:143],v[64:67]
v_mfma_f32_16x16x32_bf16 v[32:35],a[12:15],v[80:83],v[32:35]
v_mfma_f32_16x16x32_bf16 v[52:55],a[140:143],v[84:87],v[52:55]
v_mfma_f32_16x16x32_bf16 v[68:71],v[84:87],v[140:143],v[68:71]
v_mfma_f32_16x16x32_bf16 v[36:39],a[12:15],v[84:87],v[36:39]
s_waitcnt vmcnt(12)
s_barrier
s_waitcnt lgkmcnt(2)
v_mfma_f32_16x16x32_bf16 v[40:43],a[144:147],v[108:111],v[40:43]
ds_read_b128 v[80:83],v4 offset:8192
v_mfma_f32_16x16x32_bf16 v[56:59],v[108:111],v[144:147],v[56:59]
v_mfma_f32_16x16x32_bf16 v[24:27],a[16:19],v[108:111],v[24:27]
ds_read_b128 v[84:87],v4 offset:12288
v_mfma_f32_16x16x32_bf16 v[44:47],a[144:147],v[112:115],v[44:47]
v_mfma_f32_16x16x32_bf16 v[60:63],v[112:115],v[144:147],v[60:63]
v_mfma_f32_16x16x32_bf16 v[28:31],a[16:19],v[112:115],v[28:31]
v_mfma_f32_16x16x32_bf16 v[48:51],a[152:155],v[108:111],v[48:51]
v_mfma_f32_16x16x32_bf16 v[64:67],v[108:111],v[152:155],v[64:67]
v_mfma_f32_16x16x32_bf16 v[32:35],a[24:27],v[108:111],v[32:35]
v_mfma_f32_16x16x32_bf16 v[52:55],a[152:155],v[112:115],v[52:55]
v_mfma_f32_16x16x32_bf16 v[68:71],v[112:115],v[152:155],v[68:71]
v_mfma_f32_16x16x32_bf16 v[36:39],a[24:27],v[112:115],v[36:39]
s_waitcnt lgkmcnt(2)
v_mfma_f32_16x16x32_bf16 v[40:43],a[148:151],v[72:75],v[40:43]
ds_read_b128 v[108:111],v5 offset:8192
v_mfma_f32_16x16x32_bf16 v[56:59],v[72:75],v[148:151],v[56:59]
v_mfma_f32_16x16x32_bf16 v[24:27],a[20:23],v[72:75],v[24:27]
ds_read_b128 v[112:115],v5 offset:12288
v_mfma_f32_16x16x32_bf16 v[44:47],a[148:151],v[76:79],v[44:47]
v_mfma_f32_16x16x32_bf16 v[60:63],v[76:79],v[148:151],v[60:63]
v_mfma_f32_16x16x32_bf16 v[28:31],a[20:23],v[76:79],v[28:31]
v_mfma_f32_16x16x32_bf16 v[48:51],a[156:159],v[72:75],v[48:51]
v_mfma_f32_16x16x32_bf16 v[64:67],v[72:75],v[156:159],v[64:67]
v_mfma_f32_16x16x32_bf16 v[32:35],a[28:31],v[72:75],v[32:35]
v_mfma_f32_16x16x32_bf16 v[52:55],a[156:159],v[76:79],v[52:55]
v_mfma_f32_16x16x32_bf16 v[68:71],v[76:79],v[156:159],v[68:71]
v_mfma_f32_16x16x32_bf16 v[36:39],a[28:31],v[76:79],v[36:39]
s_waitcnt lgkmcnt(2)
v_mfma_f32_16x16x32_bf16 v[40:43],a[160:163],v[80:83],v[40:43]
ds_read_b128 v[72:75],v6 offset:8192
v_mfma_f32_16x16x32_bf16 v[56:59],v[80:83],v[160:163],v[56:59]
v_mfma_f32_16x16x32_bf16 v[24:27],a[32:35],v[80:83],v[24:27]
ds_read_b128 v[76:79],v6 offset:12288
v_mfma_f32_16x16x32_bf16 v[44:47],a[160:163],v[84:87],v[44:47]
v_mfma_f32_16x16x32_bf16 v[60:63],v[84:87],v[160:163],v[60:63]
v_mfma_f32_16x16x32_bf16 v[28:31],a[32:35],v[84:87],v[28:31]
v_mfma_f32_16x16x32_bf16 v[48:51],a[168:171],v[80:83],v[48:51]
v_mfma_f32_16x16x32_bf16 v[64:67],v[80:83],v[168:171],v[64:67]
v_mfma_f32_16x16x32_bf16 v[32:35],a[40:43],v[80:83],v[32:35]
v_mfma_f32_16x16x32_bf16 v[52:55],a[168:171],v[84:87],v[52:55]
v_mfma_f32_16x16x32_bf16 v[68:71],v[84:87],v[168:171],v[68:71]
v_mfma_f32_16x16x32_bf16 v[36:39],a[40:43],v[84:87],v[36:39]
s_waitcnt lgkmcnt(2)
v_mfma_f32_16x16x32_bf16 v[40:43],a[164:167],v[108:111],v[40:43]
ds_read_b128 v[80:83],v7 offset:8192
v_mfma_f32_16x16x32_bf16 v[56:59],v[108:111],v[164:167],v[56:59]
v_mfma_f32_16x16x32_bf16 v[24:27],a[36:39],v[108:111],v[24:27]
ds_read_b128 v[84:87],v7 offset:12288
v_mfma_f32_16x16x32_bf16 v[44:47],a[164:167],v[112:115],v[44:47]
v_mfma_f32_16x16x32_bf16 v[60:63],v[112:115],v[164:167],v[60:63]
v_mfma_f32_16x16x32_bf16 v[28:31],a[36:39],v[112:115],v[28:31]
v_mfma_f32_16x16x32_bf16 v[48:51],a[172:175],v[108:111],v[48:51]
v_mfma_f32_16x16x32_bf16 v[64:67],v[108:111],v[172:175],v[64:67]
v_mfma_f32_16x16x32_bf16 v[32:35],a[44:47],v[108:111],v[32:35]
v_mfma_f32_16x16x32_bf16 v[52:55],a[172:175],v[112:115],v[52:55]
v_mfma_f32_16x16x32_bf16 v[68:71],v[112:115],v[172:175],v[68:71]
v_mfma_f32_16x16x32_bf16 v[36:39],a[44:47],v[112:115],v[36:39]
s_waitcnt vmcnt(10)
s_barrier
s_waitcnt lgkmcnt(2)
v_mfma_f32_16x16x32_bf16 v[40:43],a[176:179],v[72:75],v[40:43]
ds_read_b128 v[108:111],v4 offset:16384
v_mfma_f32_16x16x32_bf16 v[56:59],v[72:75],v[176:179],v[56:59]
v_mfma_f32_16x16x32_bf16 v[24:27],a[48:51],v[72:75],v[24:27]
ds_read_b128 v[112:115],v4 offset:20480
v_mfma_f32_16x16x32_bf16 v[44:47],a[176:179],v[76:79],v[44:47]
v_mfma_f32_16x16x32_bf16 v[60:63],v[76:79],v[176:179],v[60:63]
v_mfma_f32_16x16x32_bf16 v[28:31],a[48:51],v[76:79],v[28:31]
v_mfma_f32_16x16x32_bf16 v[48:51],a[184:187],v[72:75],v[48:51]
v_mfma_f32_16x16x32_bf16 v[64:67],v[72:75],v[184:187],v[64:67]
v_mfma_f32_16x16x32_bf16 v[32:35],a[56:59],v[72:75],v[32:35]
v_mfma_f32_16x16x32_bf16 v[52:55],a[184:187],v[76:79],v[52:55]
v_mfma_f32_16x16x32_bf16 v[68:71],v[76:79],v[184:187],v[68:71]
v_mfma_f32_16x16x32_bf16 v[36:39],a[56:59],v[76:79],v[36:39]
s_waitcnt vmcnt(2)
s_barrier
s_or_b32 s72,s72,s52
buffer_store_dword v17,off,s[8:11],s72 sc1
s_waitcnt lgkmcnt(2)
v_mfma_f32_16x16x32_bf16 v[40:43],a[180:183],v[80:83],v[40:43]
ds_read_b128 v[72:75],v5 offset:16384
v_mfma_f32_16x16x32_bf16 v[56:59],v[80:83],v[180:183],v[56:59]
v_mfma_f32_16x16x32_bf16 v[24:27],a[52:55],v[80:83],v[24:27]
ds_read_b128 v[76:79],v5 offset:20480
v_mfma_f32_16x16x32_bf16 v[44:47],a[180:183],v[84:87],v[44:47]
v_mfma_f32_16x16x32_bf16 v[60:63],v[84:87],v[180:183],v[60:63]
v_mfma_f32_16x16x32_bf16 v[28:31],a[52:55],v[84:87],v[28:31]
v_mfma_f32_16x16x32_bf16 v[48:51],a[188:191],v[80:83],v[48:51]
v_mfma_f32_16x16x32_bf16 v[64:67],v[80:83],v[188:191],v[64:67]
v_mfma_f32_16x16x32_bf16 v[32:35],a[60:63],v[80:83],v[32:35]
v_mfma_f32_16x16x32_bf16 v[52:55],a[188:191],v[84:87],v[52:55]
v_mfma_f32_16x16x32_bf16 v[68:71],v[84:87],v[188:191],v[68:71]
v_mfma_f32_16x16x32_bf16 v[36:39],a[60:63],v[84:87],v[36:39]
s_waitcnt lgkmcnt(2)
v_mfma_f32_16x16x32_bf16 v[40:43],a[192:195],v[108:111],v[40:43]
ds_read_b128 v[80:83],v6 offset:16384
v_mfma_f32_16x16x32_bf16 v[56:59],v[108:111],v[192:195],v[56:59]
v_mfma_f32_16x16x32_bf16 v[24:27],a[64:67],v[108:111],v[24:27]
ds_read_b128 v[84:87],v6 offset:20480
v_mfma_f32_16x16x32_bf16 v[44:47],a[192:195],v[112:115],v[44:47]
v_mfma_f32_16x16x32_bf16 v[60:63],v[112:115],v[192:195],v[60:63]
v_mfma_f32_16x16x32_bf16 v[28:31],a[64:67],v[112:115],v[28:31]
v_mfma_f32_16x16x32_bf16 v[48:51],a[200:203],v[108:111],v[48:51]
v_mfma_f32_16x16x32_bf16 v[64:67],v[108:111],v[200:203],v[64:67]
v_mfma_f32_16x16x32_bf16 v[32:35],a[72:75],v[108:111],v[32:35]
v_mfma_f32_16x16x32_bf16 v[52:55],a[200:203],v[112:115],v[52:55]
v_mfma_f32_16x16x32_bf16 v[68:71],v[112:115],v[200:203],v[68:71]
v_mfma_f32_16x16x32_bf16 v[36:39],a[72:75],v[112:115],v[36:39]
s_waitcnt lgkmcnt(2)
v_mfma_f32_16x16x32_bf16 v[40:43],a[196:199],v[72:75],v[40:43]
ds_read_b128 v[108:111],v7 offset:16384
v_mfma_f32_16x16x32_bf16 v[56:59],v[72:75],v[196:199],v[56:59]
v_mfma_f32_16x16x32_bf16 v[24:27],a[68:71],v[72:75],v[24:27]
ds_read_b128 v[112:115],v7 offset:20480
v_mfma_f32_16x16x32_bf16 v[44:47],a[196:199],v[76:79],v[44:47]
v_mfma_f32_16x16x32_bf16 v[60:63],v[76:79],v[196:199],v[60:63]
v_mfma_f32_16x16x32_bf16 v[28:31],a[68:71],v[76:79],v[28:31]
v_mfma_f32_16x16x32_bf16 v[48:51],a[204:207],v[72:75],v[48:51]
v_mfma_f32_16x16x32_bf16 v[64:67],v[72:75],v[204:207],v[64:67]
v_mfma_f32_16x16x32_bf16 v[32:35],a[76:79],v[72:75],v[32:35]
v_mfma_f32_16x16x32_bf16 v[52:55],a[204:207],v[76:79],v[52:55]
v_mfma_f32_16x16x32_bf16 v[68:71],v[76:79],v[204:207],v[68:71]
v_mfma_f32_16x16x32_bf16 v[36:39],a[76:79],v[76:79],v[36:39]
s_waitcnt vmcnt(1)
s_barrier
s_waitcnt lgkmcnt(2)
v_mfma_f32_16x16x32_bf16 v[40:43],a[208:211],v[80:83],v[40:43]
ds_read_b128 v[72:75],v4 offset:24576
v_mfma_f32_16x16x32_bf16 v[56:59],v[80:83],v[208:211],v[56:59]
v_mfma_f32_16x16x32_bf16 v[24:27],a[80:83],v[80:83],v[24:27]
ds_read_b128 v[76:79],v4 offset:28672
v_mfma_f32_16x16x32_bf16 v[44:47],a[208:211],v[84:87],v[44:47]
v_mfma_f32_16x16x32_bf16 v[60:63],v[84:87],v[208:211],v[60:63]
v_mfma_f32_16x16x32_bf16 v[28:31],a[80:83],v[84:87],v[28:31]
v_mfma_f32_16x16x32_bf16 v[48:51],a[216:219],v[80:83],v[48:51]
v_mfma_f32_16x16x32_bf16 v[64:67],v[80:83],v[216:219],v[64:67]
v_mfma_f32_16x16x32_bf16 v[32:35],a[88:91],v[80:83],v[32:35]
v_mfma_f32_16x16x32_bf16 v[52:55],a[216:219],v[84:87],v[52:55]
v_mfma_f32_16x16x32_bf16 v[68:71],v[84:87],v[216:219],v[68:71]
v_mfma_f32_16x16x32_bf16 v[36:39],a[88:91],v[84:87],v[36:39]
s_waitcnt lgkmcnt(2)
v_mfma_f32_16x16x32_bf16 v[40:43],a[212:215],v[108:111],v[40:43]
ds_read_b128 v[80:83],v5 offset:24576
v_mfma_f32_16x16x32_bf16 v[56:59],v[108:111],v[212:215],v[56:59]
v_mfma_f32_16x16x32_bf16 v[24:27],a[84:87],v[108:111],v[24:27]
ds_read_b128 v[84:87],v5 offset:28672
v_mfma_f32_16x16x32_bf16 v[44:47],a[212:215],v[112:115],v[44:47]
v_mfma_f32_16x16x32_bf16 v[60:63],v[112:115],v[212:215],v[60:63]
v_mfma_f32_16x16x32_bf16 v[28:31],a[84:87],v[112:115],v[28:31]
v_mfma_f32_16x16x32_bf16 v[48:51],a[220:223],v[108:111],v[48:51]
v_mfma_f32_16x16x32_bf16 v[64:67],v[108:111],v[220:223],v[64:67]
v_mfma_f32_16x16x32_bf16 v[32:35],a[92:95],v[108:111],v[32:35]
v_mfma_f32_16x16x32_bf16 v[52:55],a[220:223],v[112:115],v[52:55]
v_mfma_f32_16x16x32_bf16 v[68:71],v[112:115],v[220:223],v[68:71]
v_mfma_f32_16x16x32_bf16 v[36:39],a[92:95],v[112:115],v[36:39]
s_barrier
s_waitcnt lgkmcnt(2)
v_mfma_f32_16x16x32_bf16 v[40:43],a[224:227],v[72:75],v[40:43]
ds_read_b128 v[108:111],v6 offset:24576
v_mfma_f32_16x16x32_bf16 v[56:59],v[72:75],v[224:227],v[56:59]
s_add_u32 m0,s50,131072
v_mfma_f32_16x16x32_bf16 v[24:27],a[96:99],v[72:75],v[24:27]
ds_read_b128 v[112:115],v6 offset:28672
v_mfma_f32_16x16x32_bf16 v[44:47],a[224:227],v[76:79],v[44:47]
buffer_load_dwordx4 v20,s[8:11],s70 offen offset:0 sc1 lds
v_mfma_f32_16x16x32_bf16 v[60:63],v[76:79],v[224:227],v[60:63]
s_add_u32 m0,s50,135168
v_mfma_f32_16x16x32_bf16 v[28:31],a[96:99],v[76:79],v[28:31]
buffer_load_dwordx4 v20,s[8:11],s71 offen offset:0 sc1 lds
v_mfma_f32_16x16x32_bf16 v[48:51],a[232:235],v[72:75],v[48:51]
s_add_u32 m0,s50,139008
v_mfma_f32_16x16x32_bf16 v[64:67],v[72:75],v[232:235],v[64:67]
buffer_load_dwordx4 v20,s[8:11],s70 offen offset:256 sc1 lds
v_mfma_f32_16x16x32_bf16 v[32:35],a[104:107],v[72:75],v[32:35]
s_add_u32 m0,s50,143104
v_mfma_f32_16x16x32_bf16 v[52:55],a[232:235],v[76:79],v[52:55]
buffer_load_dwordx4 v20,s[8:11],s71 offen offset:256 sc1 lds
v_mfma_f32_16x16x32_bf16 v[68:71],v[76:79],v[232:235],v[68:71]
s_add_u32 m0,s50,146944
v_mfma_f32_16x16x32_bf16 v[36:39],a[104:107],v[76:79],v[36:39]
buffer_load_dwordx4 v20,s[8:11],s70 offen offset:512 sc1 lds
s_waitcnt lgkmcnt(2)
v_mfma_f32_16x16x32_bf16 v[40:43],a[228:231],v[80:83],v[40:43]
ds_read_b128 v[72:75],v7 offset:24576
v_mfma_f32_16x16x32_bf16 v[56:59],v[80:83],v[228:231],v[56:59]
s_add_u32 m0,s50,151040
v_mfma_f32_16x16x32_bf16 v[24:27],a[100:103],v[80:83],v[24:27]
ds_read_b128 v[76:79],v7 offset:28672
v_mfma_f32_16x16x32_bf16 v[44:47],a[228:231],v[84:87],v[44:47]
buffer_load_dwordx4 v20,s[8:11],s71 offen offset:512 sc1 lds
v_mfma_f32_16x16x32_bf16 v[60:63],v[84:87],v[228:231],v[60:63]
buffer_load_dwordx2 v[124:125],v23,s[8:11],s76 offen sc1
v_mfma_f32_16x16x32_bf16 v[28:31],a[100:103],v[84:87],v[28:31]
v_mfma_f32_16x16x32_bf16 v[48:51],a[236:239],v[80:83],v[48:51]
v_mfma_f32_16x16x32_bf16 v[64:67],v[80:83],v[236:239],v[64:67]
v_mfma_f32_16x16x32_bf16 v[32:35],a[108:111],v[80:83],v[32:35]
v_mfma_f32_16x16x32_bf16 v[52:55],a[236:239],v[84:87],v[52:55]
v_mfma_f32_16x16x32_bf16 v[68:71],v[84:87],v[236:239],v[68:71]
v_mfma_f32_16x16x32_bf16 v[36:39],a[108:111],v[84:87],v[36:39]
s_waitcnt lgkmcnt(2)
v_mfma_f32_16x16x32_bf16 v[40:43],a[240:243],v[108:111],v[40:43]
v_mfma_f32_16x16x32_bf16 v[56:59],v[108:111],v[240:243],v[56:59]
v_mfma_f32_16x16x32_bf16 v[24:27],a[112:115],v[108:111],v[24:27]
v_mfma_f32_16x16x32_bf16 v[44:47],a[240:243],v[112:115],v[44:47]
v_mfma_f32_16x16x32_bf16 v[60:63],v[112:115],v[240:243],v[60:63]
v_mfma_f32_16x16x32_bf16 v[28:31],a[112:115],v[112:115],v[28:31]
v_mfma_f32_16x16x32_bf16 v[48:51],a[248:251],v[108:111],v[48:51]
v_mfma_f32_16x16x32_bf16 v[64:67],v[108:111],v[248:251],v[64:67]
v_mfma_f32_16x16x32_bf16 v[32:35],a[120:123],v[108:111],v[32:35]
v_mfma_f32_16x16x32_bf16 v[52:55],a[248:251],v[112:115],v[52:55]
v_mfma_f32_16x16x32_bf16 v[68:71],v[112:115],v[248:251],v[68:71]
v_mfma_f32_16x16x32_bf16 v[36:39],a[120:123],v[112:115],v[36:39]
s_waitcnt lgkmcnt(0)
v_mfma_f32_16x16x32_bf16 v[40:43],a[244:247],v[72:75],v[40:43]
v_mfma_f32_16x16x32_bf16 v[56:59],v[72:75],v[244:247],v[56:59]
v_mfma_f32_16x16x32_bf16 v[24:27],a[116:119],v[72:75],v[24:27]
v_mfma_f32_16x16x32_bf16 v[44:47],a[244:247],v[76:79],v[44:47]
v_mfma_f32_16x16x32_bf16 v[60:63],v[76:79],v[244:247],v[60:63]
v_mfma_f32_16x16x32_bf16 v[28:31],a[116:119],v[76:79],v[28:31]
v_mfma_f32_16x16x32_bf16 v[48:51],a[252:255],v[72:75],v[48:51]
v_mfma_f32_16x16x32_bf16 v[64:67],v[72:75],v[252:255],v[64:67]
v_mfma_f32_16x16x32_bf16 v[32:35],a[124:127],v[72:75],v[32:35]
v_mfma_f32_16x16x32_bf16 v[52:55],a[252:255],v[76:79],v[52:55]
v_mfma_f32_16x16x32_bf16 v[68:71],v[76:79],v[252:255],v[68:71]
v_mfma_f32_16x16x32_bf16 v[36:39],a[124:127],v[76:79],v[36:39]
s_lshl_b32 s56,s51,5
s_add_u32 s56,s56,s47
s_lshl_b32 s56,s56,12
s_add_u32 s56,s56,s50
s_add_u32 s56,s56,41943040
v_mov_b64 v[120:121],-1
v_mov_b64 v[122:123],-1
buffer_store_dwordx4 v[120:123],v0,s[8:11],s56 offen sc1
v_cvt_pk_bf16_f32 v72,v40,v48
v_cvt_pk_bf16_f32 v73,v41,v49
v_cvt_pk_bf16_f32 v74,v42,v50
v_cvt_pk_bf16_f32 v75,v43,v51
buffer_store_dwordx4 v[72:75],v0,s[8:11],s61 offen sc1
v_cvt_pk_bf16_f32 v76,v44,v52
v_cvt_pk_bf16_f32 v77,v45,v53
v_cvt_pk_bf16_f32 v78,v46,v54
v_cvt_pk_bf16_f32 v79,v47,v55
buffer_store_dwordx4 v[76:79],v0,s[8:11],s62 offen sc1
v_cvt_pk_bf16_f32 v80,v56,v57
v_cvt_pk_bf16_f32 v81,v58,v59
v_cvt_pk_bf16_f32 v82,v60,v61
v_cvt_pk_bf16_f32 v83,v62,v63
buffer_store_dwordx4 v[80:83],v0,s[8:11],s65 offen offset:0 sc1
v_cvt_pk_bf16_f32 v84,v64,v65
v_cvt_pk_bf16_f32 v85,v66,v67
v_cvt_pk_bf16_f32 v86,v68,v69
v_cvt_pk_bf16_f32 v87,v70,v71
buffer_store_dwordx4 v[84:87],v0,s[8:11],s65 offen offset:1024 sc1
v_cvt_pk_bf16_f32 v108,v24,v32
v_cvt_pk_bf16_f32 v109,v25,v33
v_cvt_pk_bf16_f32 v110,v26,v34
v_cvt_pk_bf16_f32 v111,v27,v35
buffer_store_dwordx4 v[108:111],v0,s[8:11],s63 offen sc1
v_cvt_pk_bf16_f32 v112,v28,v36
v_cvt_pk_bf16_f32 v113,v29,v37
v_cvt_pk_bf16_f32 v114,v30,v38
v_cvt_pk_bf16_f32 v115,v31,v39
buffer_store_dwordx4 v[112:115],v0,s[8:11],s64 offen sc1
s_lshl_b32 s72,s51,13
s_lshl2_add_u32 s72,s47,s72
s_add_u32 s72,s72,10485760
s_sub_u32 s53,s53,1
s_cmp_gt_i32 s53,3
s_cbranch_scc1 L_mo_379
s_cmp_gt_i32 s53,0
s_cselect_b32 s87,1,3
s_mov_b32 s18,0
s_waitcnt vmcnt(7)
s_branch L_mo_384
L_mo_377:
s_mov_b32 s55,s22
s_mov_b32 s22,s23
s_mov_b32 s23,s24
s_mov_b32 s24,-1
s_cmp_lg_u32 s55,-1
s_cbranch_scc1 L_mp_375
s_sub_u32 s56,s30,s31
s_cmp_gt_i32 s77,0
s_cselect_b32 s57,6,15
s_cmp_lg_u32 s86,0
s_cselect_b32 s57,9,s57
s_cmp_lt_i32 s56,s57
s_cbranch_scc1 L_mo_378
s_cmp_lt_i32 s56,30
s_cselect_b32 s87,s18,0
s_cmp_ge_u32 s31,8
s_cselect_b32 s56,1,s18
s_and_b32 s56,s56,s86
s_cselect_b32 s87,2,s87
s_mul_i32 s56,s87,s18
s_cmp_lg_u32 s56,0
s_cbranch_scc1 L_mo_382
s_mov_b32 s18,0
s_lshr_b32 s56,s72,31
s_or_b32 s56,s56,s87
s_cbranch_scc1 L_mo_388
s_waitcnt vmcnt(0)
s_barrier
s_or_b32 s72,s72,s52
buffer_store_dword v17,off,s[8:11],s72 sc1
s_mov_b32 s72,0x80000000
L_mo_388:
s_cmp_lg_u32 s46,0
s_cbranch_scc1 L_mo_386
s_lshl_b32 s76,s31,13
s_add_u32 s76,s76,10487040
L_mo_385:
buffer_load_dwordx2 v[124:125],v23,s[8:11],s76 offen sc1
s_sub_u32 s49,s49,1
s_cbranch_scc1 L_abort2
s_waitcnt vmcnt(0)
L_mo_384:
v_min_u32 v123,v124,v125
v_max_u32 v125,v124,v125
v_cmp_eq_u32 vcc,0,v123
s_nop 1
v_cndmask_b32 v125,v125,-1,vcc
s_and_b32 s56,vcc_lo,0xffff
s_cbranch_scc0 L_mo_389
s_cmp_lg_u32 s87,0
s_cbranch_scc1 L_mo_389
s_mov_b32 s18,1
s_sleep 2
s_branch L_mo_385
L_mo_389:
v_max_u32_dpp v125,v125,v125 row_ror:8 row_mask:0xf bank_mask:0xf
s_nop 1
v_max_u32_dpp v125,v125,v125 row_ror:4 row_mask:0xf bank_mask:0xf
s_nop 1
v_max_u32_dpp v125,v125,v125 row_ror:2 row_mask:0xf bank_mask:0xf
s_nop 1
v_max_u32_dpp v125,v125,v125 row_ror:1 row_mask:0xf bank_mask:0xf
L_mo_386:
s_sub_u32 s49,s49,1
s_cbranch_scc1 L_abort2
v_mov_b32 v124,s18
s_barrier
s_cmp_lg_u32 s46,0
s_cbranch_scc1 L_mo_387
ds_write_b32 v16,v125
ds_write_b32 v19,v124 offset:16
s_waitcnt lgkmcnt(0)
L_mo_387:
s_barrier
ds_read_b128 v[120:123],v19
ds_read_b32 v124,v19 offset:16
s_waitcnt lgkmcnt(0)
v_readfirstlane_b32 s55,v120
v_readfirstlane_b32 s22,v121
v_readfirstlane_b32 s23,v122
v_readfirstlane_b32 s24,v123
v_readfirstlane_b32 s18,v124
s_cmp_lg_u32 s55,-1
s_cbranch_scc1 L_mp_375
L_mo_382:
s_mov_b32 s22,-1
s_cmp_eq_u32 s87,1
s_cbranch_scc1 L_mo_378
s_cmp_eq_u32 s87,2
s_cbranch_scc1 L_mo_383
s_branch L_mo_377
L_mp_375:
s_mov_b32 s53,0
s_sub_u32 s73,s73,1
s_max_i32 s73,s73,0
s_sub_u32 s77,s77,1
s_min_u32 s61,s73,2
s_cmp_lt_u32 s31,5
s_cselect_b32 s60,s25,0
s_cmp_lt_u32 s55,s60
s_cselect_b32 s61,2,s61
s_cmp_le_u32 s55,s54
s_cbranch_scc1 L_mr_376
s_mov_b32 s77,s61
s_mov_b32 s54,s55
s_mov_b32 s86,0
s_or_b32 s61,s47,s46
s_cbranch_scc1 L_mr_376
v_mov_b32 v120,s54
v_lshlrev_b32 v121,13,v1
s_mov_b32 s61,10486784
buffer_store_dword v120,v121,s[8:11],s61 offen sc1
L_mr_376:
s_cmp_lg_u32 s31,63
s_cbranch_scc1 L_mo_380
s_min_i32 s77,s77,0
s_or_b32 s61,s47,s46
s_cbranch_scc1 L_mo_380
s_mov_b32 s59,11018240
v_lshlrev_b32 v120,2,v1
L_fp_391:
s_sleep 0
buffer_load_dword v121,v120,s[8:11],s59 offen sc1
s_sub_u32 s49,s49,1
s_cbranch_scc1 L_abort2
s_waitcnt vmcnt(0)
v_cmp_eq_u32 vcc,0,v121
s_cbranch_vccnz L_fp_391
s_andn2_b32 s62,0x7ff,s54
v_lshl_or_b32 v121,s62,8,v121
s_add_u32 s59,s59,8192
buffer_store_dword v121,v120,s[8:11],s59 offen sc1
s_add_u32 s59,s59,8192
buffer_store_dword v121,v120,s[8:11],s59 offen sc1
s_add_u32 s59,s59,8192
buffer_store_dword v121,v120,s[8:11],s59 offen sc1
s_add_u32 s59,s59,8192
buffer_store_dword v121,v120,s[8:11],s59 offen sc1
s_add_u32 s59,s59,8192
buffer_store_dword v121,v120,s[8:11],s59 offen sc1
s_add_u32 s59,s59,8192
buffer_store_dword v121,v120,s[8:11],s59 offen sc1
L_mo_380:
s_add_u32 s31,s31,1
s_cmp_gt_i32 s77,0
s_cmov_b32 s18,0
s_cbranch_scc1 L_mo_377
s_cmp_lg_u32 s77,0
s_cbranch_scc1 L_mo_381
s_andn2_b32 s51,0x7ff,s54
s_lshr_b32 s51,s51,5
s_add_u32 s73,s73,2
s_mov_b32 s86,1
s_mov_b32 s19,0
s_mov_b32 s18,0
s_waitcnt vmcnt(8)
s_barrier
s_andn2_b32 s64,0x7ff,s54
s_lshl_b32 s56,s64,10
s_add_u32 s58,s56,4194304
buffer_load_dwordx4 v[88:91],v0,s[8:11],s58 offen sc1
v_and_b32 v9,15,v1
v_lshrrev_b32 v10,4,v1
v_and_b32 v124,1,v1
v_lshlrev_b32 v124,4,v124
v_mov_b32 v125,0xffff
v_lshlrev_b32 v125,v124,v125
v_lshrrev_b32 v124,2,v9
v_cmp_eq_u32 vcc,0,v124
s_nop 1
v_cndmask_b32 v12,0,v125,vcc
v_cmp_eq_u32 vcc,1,v124
s_nop 1
v_cndmask_b32 v13,0,v125,vcc
v_and_b32 v124,2,v1
v_cmp_eq_u32 vcc,0,v124
v_mov_b32 v14,0xeeee
v_mov_b32 v124,0x4444
v_cndmask_b32 v14,v14,v124,vcc
v_lshlrev_b32 v11,14,v10
v_lshl_add_u32 v11,v9,4,v11
s_lshl_b32 s65,s51,15
s_add_u32 s65,s65,92274688
s_lshl_b32 s62,s47,10
s_add_u32 s62,s62,s65
s_lshl_b32 s63,s47,16
s_lshl_b32 s60,s46,8
s_add_u32 s63,s63,s60
s_mov_b32 s4,s38
s_mov_b32 s5,s39
s_mov_b32 s6,1835008
s_mov_b32 s7,0x20000
s_lshl_b32 s57,s46,11
s_add_u32 s57,s57,139264
v_add_u32 v8,s57,v0
v_and_b32 v2,1,v10
v_lshrrev_b32 v3,1,v10
v_lshlrev_b32 v2,7,v2
v_lshl_add_u32 v2,v3,10,v2
s_lshl_b32 s59,s46,8
s_add_u32 s59,s57,s59
v_add_u32 v2,s59,v2
s_mov_b32 s60,0x01000100
s_mov_b32 s61,0x03020302
s_waitcnt vmcnt(0)
L_mx_392:
v_max3_u32 v124,v88,v89,v90
v_max_u32 v124,v91,v124
v_cmp_eq_u32 vcc,-1,v124
s_cbranch_vccz L_mxd_393
buffer_load_dwordx4 v[88:91],v0,s[8:11],s58 offen sc1
s_sub_u32 s49,s49,1
s_cbranch_scc1 L_abort2
s_waitcnt vmcnt(0)
s_branch L_mx_392
L_mxd_393:
buffer_load_dwordx4 v[24:27],v11,s[4:7],s63 offen offset:0
buffer_load_dwordx4 v[28:31],v11,s[4:7],s63 offen offset:1024
buffer_load_dwordx4 v[32:35],v11,s[4:7],s63 offen offset:2048
buffer_load_dwordx4 v[36:39],v11,s[4:7],s63 offen offset:3072
v_lshlrev_b32 v96,16,v88
v_and_b32 v97,0xffff0000,v88
v_lshlrev_b32 v98,16,v89
v_and_b32 v99,0xffff0000,v89
v_lshlrev_b32 v100,16,v90
v_and_b32 v101,0xffff0000,v90
v_lshlrev_b32 v102,16,v91
v_and_b32 v103,0xffff0000,v91
v_readfirstlane_b32 s78,v96
s_nop 1
v_pk_add_f32 v[108:109],v[96:97],s[78:79] op_sel_hi:[1,0] neg_lo:[0,1] neg_hi:[0,1]
v_pk_add_f32 v[110:111],v[98:99],s[78:79] op_sel_hi:[1,0] neg_lo:[0,1] neg_hi:[0,1]
v_pk_add_f32 v[112:113],v[100:101],s[78:79] op_sel_hi:[1,0] neg_lo:[0,1] neg_hi:[0,1]
v_pk_add_f32 v[114:115],v[102:103],s[78:79] op_sel_hi:[1,0] neg_lo:[0,1] neg_hi:[0,1]
v_pk_add_f32 v[116:117],v[108:109],v[110:111]
v_pk_mul_f32 v[118:119],v[108:109],v[108:109]
v_pk_add_f32 v[120:121],v[112:113],v[114:115]
v_pk_fma_f32 v[118:119],v[110:111],v[110:111],v[118:119]
v_pk_add_f32 v[116:117],v[116:117],v[120:121]
v_pk_fma_f32 v[118:119],v[112:113],v[112:113],v[118:119]
v_add_f32 v116,v116,v117
v_pk_fma_f32 v[118:119],v[114:115],v[114:115],v[118:119]
v_add_f32 v118,v118,v119
s_nop 1
v_permlane32_swap_b32 v116,v118
v_add_f32 v116,v116,v118
s_nop 1
v_add_f32_dpp v116,v116,v116 row_ror:8 row_mask:0xf bank_mask:0xf
s_nop 1
v_add_f32_dpp v116,v116,v116 row_ror:4 row_mask:0xf bank_mask:0xf
s_nop 1
v_add_f32_dpp v116,v116,v116 row_ror:2 row_mask:0xf bank_mask:0xf
s_nop 1
v_add_f32_dpp v116,v116,v116 row_ror:1 row_mask:0xf bank_mask:0xf
v_mov_b32 v118,v116
s_nop 1
v_permlane16_swap_b32 v116,v118
v_add_f32 v116,v116,v118
v_mul_f32 v116,0x3b000000,v116
v_mov_b32 v118,v116
s_nop 1
v_permlane32_swap_b32 v116,v118
v_fma_f32 v118,-v116,v116,v118
v_add_f32 v116,s78,v116
v_max_f32 v118,0,v118
v_cvt_pk_bf16_f32 v118,v116,v118
v_lshlrev_b32 v116,16,v118
v_and_b32 v118,0xffff0000,v118
v_add_f32 v118,0x3727c5ac,v118
v_cvt_pk_bf16_f32 v118,v118,v118
v_and_b32 v118,0xffff0000,v118
v_sqrt_f32 v118,v118
v_pk_add_f32 v[108:109],v[96:97],v[116:117] op_sel_hi:[1,0] neg_lo:[0,1] neg_hi:[0,1]
v_pk_add_f32 v[110:111],v[98:99],v[116:117] op_sel_hi:[1,0] neg_lo:[0,1] neg_hi:[0,1]
v_pk_add_f32 v[112:113],v[100:101],v[116:117] op_sel_hi:[1,0] neg_lo:[0,1] neg_hi:[0,1]
v_pk_add_f32 v[114:115],v[102:103],v[116:117] op_sel_hi:[1,0] neg_lo:[0,1] neg_hi:[0,1]
v_cvt_pk_bf16_f32 v118,v118,v118
v_and_b32 v118,0xffff0000,v118
v_rcp_f32 v118,v118
v_cvt_pk_bf16_f32 v104,v108,v109
v_cvt_pk_bf16_f32 v105,v110,v111
v_cvt_pk_bf16_f32 v106,v112,v113
v_cvt_pk_bf16_f32 v107,v114,v115
v_lshlrev_b32 v108,16,v104
v_and_b32 v109,0xffff0000,v104
v_lshlrev_b32 v110,16,v105
v_and_b32 v111,0xffff0000,v105
v_lshlrev_b32 v112,16,v106
v_and_b32 v113,0xffff0000,v106
v_lshlrev_b32 v114,16,v107
v_and_b32 v115,0xffff0000,v107
v_pk_mul_f32 v[108:109],v[108:109],v[118:119] op_sel_hi:[1,0]
v_pk_mul_f32 v[110:111],v[110:111],v[118:119] op_sel_hi:[1,0]
v_pk_mul_f32 v[112:113],v[112:113],v[118:119] op_sel_hi:[1,0]
v_pk_mul_f32 v[114:115],v[114:115],v[118:119] op_sel_hi:[1,0]
v_cvt_pk_bf16_f32 v104,v108,v109
v_cvt_pk_bf16_f32 v105,v110,v111
v_cvt_pk_bf16_f32 v106,v112,v113
v_cvt_pk_bf16_f32 v107,v114,v115
v_perm_b32 v88,v104,v104,s60
v_perm_b32 v89,v105,v105,s60
v_perm_b32 v90,v106,v106,s60
v_perm_b32 v91,v107,v107,s60
ds_write_b128 v8,v[88:91]
v_perm_b32 v92,v104,v104,s61
v_perm_b32 v93,v105,v105,s61
v_perm_b32 v94,v106,v106,s61
v_perm_b32 v95,v107,v107,s61
ds_write_b128 v8,v[92:95] offset:1024
s_mov_b32 s58,s57
ds_read_b128 v[88:91],v2 offset:0
ds_read_b128 v[92:95],v2 offset:64
ds_read_b128 v[108:111],v18 offset:0
ds_read_b128 v[112:115],v18 offset:1024
ds_read_b128 v[64:67],v18 offset:2048
ds_read_b128 v[68:71],v18 offset:3072
ds_read_b128 v[72:75],v18 offset:4096
ds_read_b128 v[76:79],v18 offset:5120
ds_read_b128 v[80:83],v18 offset:6144
ds_read_b128 v[84:87],v18 offset:7168
v_mov_b64 v[116:117],0
v_mov_b64 v[118:119],0
s_waitcnt lgkmcnt(8)
v_and_b32 v120,v12,v88
v_and_b32 v121,v13,v88
v_and_b32 v122,v12,v92
v_and_b32 v123,v13,v92
s_waitcnt lgkmcnt(6)
s_nop 0
v_smfmac_f32_16x16x64_bf16 v[116:119],v[120:123],v[108:115],v14
ds_read_b128 v[108:111],v18 offset:8192
ds_read_b128 v[112:115],v18 offset:9216
s_add_u32 s63,s63,4096
buffer_load_dwordx4 v[40:43],v11,s[4:7],s63 offen offset:0
v_and_b32 v124,v12,v89
v_and_b32 v125,v13,v89
v_and_b32 v126,v12,v93
v_and_b32 v127,v13,v93
s_waitcnt lgkmcnt(6)
s_nop 0
v_smfmac_f32_16x16x64_bf16 v[116:119],v[124:127],v[64:71],v14
ds_read_b128 v[64:67],v18 offset:10240
ds_read_b128 v[68:71],v18 offset:11264
buffer_load_dwordx4 v[44:47],v11,s[4:7],s63 offen offset:1024
v_and_b32 v120,v12,v90
v_and_b32 v121,v13,v90
v_and_b32 v122,v12,v94
v_and_b32 v123,v13,v94
s_waitcnt lgkmcnt(6)
s_nop 0
v_smfmac_f32_16x16x64_bf16 v[116:119],v[120:123],v[72:79],v14
ds_read_b128 v[72:75],v18 offset:12288
ds_read_b128 v[76:79],v18 offset:13312
buffer_load_dwordx4 v[48:51],v11,s[4:7],s63 offen offset:2048
v_and_b32 v124,v12,v91
v_and_b32 v125,v13,v91
v_and_b32 v126,v12,v95
v_and_b32 v127,v13,v95
ds_read_b128 v[88:91],v2 offset:16
ds_read_b128 v[92:95],v2 offset:80
s_waitcnt lgkmcnt(8)
v_smfmac_f32_16x16x64_bf16 v[116:119],v[124:127],v[80:87],v14
ds_read_b128 v[80:83],v18 offset:14336
ds_read_b128 v[84:87],v18 offset:15360
buffer_load_dwordx4 v[52:55],v11,s[4:7],s63 offen offset:3072
s_waitcnt lgkmcnt(2)
v_and_b32 v120,v12,v88
v_and_b32 v121,v13,v88
v_and_b32 v122,v12,v92
v_and_b32 v123,v13,v92
s_waitcnt lgkmcnt(8)
s_nop 0
v_smfmac_f32_16x16x64_bf16 v[116:119],v[120:123],v[108:115],v14
ds_read_b128 v[108:111],v18 offset:16384
ds_read_b128 v[112:115],v18 offset:17408
s_add_u32 s63,s63,4096
buffer_load_dwordx4 v[56:59],v11,s[4:7],s63 offen offset:0
v_and_b32 v124,v12,v89
v_and_b32 v125,v13,v89
v_and_b32 v126,v12,v93
v_and_b32 v127,v13,v93
s_waitcnt lgkmcnt(8)
s_nop 0
v_smfmac_f32_16x16x64_bf16 v[116:119],v[124:127],v[64:71],v14
ds_read_b128 v[64:67],v18 offset:18432
ds_read_b128 v[68:71],v18 offset:19456
buffer_load_dwordx4 v[60:63],v11,s[4:7],s63 offen offset:1024
v_and_b32 v120,v12,v90
v_and_b32 v121,v13,v90
v_and_b32 v122,v12,v94
v_and_b32 v123,v13,v94
s_waitcnt lgkmcnt(8)
s_nop 0
v_smfmac_f32_16x16x64_bf16 v[116:119],v[120:123],v[72:79],v14
ds_read_b128 v[72:75],v18 offset:20480
ds_read_b128 v[76:79],v18 offset:21504
v_and_b32 v124,v12,v91
v_and_b32 v125,v13,v91
v_and_b32 v126,v12,v95
v_and_b32 v127,v13,v95
ds_read_b128 v[88:91],v2 offset:32
ds_read_b128 v[92:95],v2 offset:96
s_waitcnt lgkmcnt(8)
v_smfmac_f32_16x16x64_bf16 v[116:119],v[124:127],v[80:87],v14
ds_read_b128 v[80:83],v18 offset:22528
ds_read_b128 v[84:87],v18 offset:23552
s_waitcnt lgkmcnt(2)
v_and_b32 v120,v12,v88
v_and_b32 v121,v13,v88
v_and_b32 v122,v12,v92
v_and_b32 v123,v13,v92
s_waitcnt lgkmcnt(8)
s_nop 0
v_smfmac_f32_16x16x64_bf16 v[116:119],v[120:123],v[108:115],v14
ds_read_b128 v[108:111],v18 offset:24576
ds_read_b128 v[112:115],v18 offset:25600
v_and_b32 v124,v12,v89
v_and_b32 v125,v13,v89
v_and_b32 v126,v12,v93
v_and_b32 v127,v13,v93
s_waitcnt lgkmcnt(8)
s_nop 0
v_smfmac_f32_16x16x64_bf16 v[116:119],v[124:127],v[64:71],v14
ds_read_b128 v[64:67],v18 offset:26624
ds_read_b128 v[68:71],v18 offset:27648
v_and_b32 v120,v12,v90
v_and_b32 v121,v13,v90
v_and_b32 v122,v12,v94
v_and_b32 v123,v13,v94
s_waitcnt lgkmcnt(8)
s_nop 0
v_smfmac_f32_16x16x64_bf16 v[116:119],v[120:123],v[72:79],v14
ds_read_b128 v[72:75],v18 offset:28672
ds_read_b128 v[76:79],v18 offset:29696
v_and_b32 v124,v12,v91
v_and_b32 v125,v13,v91
v_and_b32 v126,v12,v95
v_and_b32 v127,v13,v95
ds_read_b128 v[88:91],v2 offset:48
ds_read_b128 v[92:95],v2 offset:112
s_waitcnt lgkmcnt(8)
v_smfmac_f32_16x16x64_bf16 v[116:119],v[124:127],v[80:87],v14
ds_read_b128 v[80:83],v18 offset:30720
ds_read_b128 v[84:87],v18 offset:31744
s_waitcnt lgkmcnt(2)
v_and_b32 v120,v12,v88
v_and_b32 v121,v13,v88
v_and_b32 v122,v12,v92
v_and_b32 v123,v13,v92
s_waitcnt lgkmcnt(8)
s_nop 0
v_smfmac_f32_16x16x64_bf16 v[116:119],v[120:123],v[108:115],v14
v_and_b32 v124,v12,v89
v_and_b32 v125,v13,v89
v_and_b32 v126,v12,v93
v_and_b32 v127,v13,v93
s_waitcnt lgkmcnt(6)
s_nop 0
v_smfmac_f32_16x16x64_bf16 v[116:119],v[124:127],v[64:71],v14
buffer_load_dwordx4 v[64:67],v11,s[4:7],s63 offen offset:2048
buffer_load_dwordx4 v[68:71],v11,s[4:7],s63 offen offset:3072
v_and_b32 v120,v12,v90
v_and_b32 v121,v13,v90
v_and_b32 v122,v12,v94
v_and_b32 v123,v13,v94
s_waitcnt lgkmcnt(4)
s_nop 0
v_smfmac_f32_16x16x64_bf16 v[116:119],v[120:123],v[72:79],v14
s_add_u32 s63,s63,4096
buffer_load_dwordx4 v[72:75],v11,s[4:7],s63 offen offset:0
buffer_load_dwordx4 v[76:79],v11,s[4:7],s63 offen offset:1024
v_and_b32 v124,v12,v91
v_and_b32 v125,v13,v91
v_and_b32 v126,v12,v95
v_and_b32 v127,v13,v95
s_waitcnt lgkmcnt(0)
s_nop 0
v_smfmac_f32_16x16x64_bf16 v[116:119],v[124:127],v[80:87],v14
buffer_load_dwordx4 v[80:83],v11,s[4:7],s63 offen offset:2048
buffer_load_dwordx4 v[84:87],v11,s[4:7],s63 offen offset:3072
v_lshlrev_b32 v8,5,v9
v_and_b32 v124,1,v10
v_lshl_add_u32 v8,v124,4,v8
v_lshrrev_b32 v124,1,v10
v_lshl_add_u32 v8,v124,11,v8
s_lshl_b32 s60,s46,9
s_add_u32 s60,s60,147456
v_add_u32 v8,s60,v8
ds_write_b128 v8,v[116:119]
v_lshlrev_b32 v8,2,v1
v_add_u32 v8,147456,v8
v_and_b32 v2,1,v1
v_lshrrev_b32 v3,1,v1
v_lshlrev_b32 v3,2,v3
v_lshl_add_u32 v2,v2,7,v3
v_add_u32 v2,s58,v2
v_lshlrev_b32 v3,6,v10
v_add_u32 v3,s58,v3
s_waitcnt lgkmcnt(0)
s_barrier
ds_read2st64_b32 v[88:89],v8 offset0:0 offset1:1
ds_read2st64_b32 v[90:91],v8 offset0:2 offset1:3
ds_read2st64_b32 v[92:93],v8 offset0:4 offset1:5
ds_read2st64_b32 v[94:95],v8 offset0:6 offset1:7
s_waitcnt lgkmcnt(0)
v_pk_add_f32 v[88:89],v[88:89],v[90:91]
v_pk_add_f32 v[92:93],v[92:93],v[94:95]
v_pk_add_f32 v[88:89],v[88:89],v[92:93]
v_cvt_pk_bf16_f32 v88,v88,v88
v_and_b32 v88,0xffff0000,v88
v_cvt_pk_bf16_f32 v89,v89,v89
v_and_b32 v89,0xffff0000,v89
v_mul_f32 v90,0xbfb8aa3b,v88
v_exp_f32 v90,v90
s_nop 0
v_add_f32 v90,1.0,v90
v_rcp_f32 v90,v90
s_nop 0
v_mul_f32 v88,v88,v90
v_cvt_pk_bf16_f32 v88,v88,v88
v_and_b32 v88,0xffff0000,v88
v_mul_f32 v88,v88,v89
v_cvt_pk_bf16_f32 v88,v88,v88
ds_write_b32 v2,v88
ds_read_b128 v[88:91],v3
ds_read_b128 v[108:111],v3 offset:32
ds_read_b128 v[92:95],v3 offset:16
ds_read_b128 v[112:115],v3 offset:48
v_mov_b64 v[116:117],0
v_mov_b64 v[118:119],0
s_waitcnt vmcnt(0) lgkmcnt(0)
v_and_b32 v120,v12,v88
v_and_b32 v121,v13,v88
v_and_b32 v122,v12,v108
v_and_b32 v123,v13,v108
v_and_b32 v124,v12,v89
v_and_b32 v125,v13,v89
v_smfmac_f32_16x16x64_bf16 v[116:119],v[120:123],v[24:31],v14
v_and_b32 v126,v12,v109
v_and_b32 v127,v13,v109
v_and_b32 v120,v12,v90
v_and_b32 v121,v13,v90
v_smfmac_f32_16x16x64_bf16 v[116:119],v[124:127],v[32:39],v14
v_and_b32 v122,v12,v110
v_and_b32 v123,v13,v110
v_and_b32 v124,v12,v91
v_and_b32 v125,v13,v91
v_smfmac_f32_16x16x64_bf16 v[116:119],v[120:123],v[40:47],v14
v_and_b32 v126,v12,v111
v_and_b32 v127,v13,v111
v_and_b32 v120,v12,v92
v_and_b32 v121,v13,v92
v_smfmac_f32_16x16x64_bf16 v[116:119],v[124:127],v[48:55],v14
v_and_b32 v122,v12,v112
v_and_b32 v123,v13,v112
v_and_b32 v124,v12,v93
v_and_b32 v125,v13,v93
v_smfmac_f32_16x16x64_bf16 v[116:119],v[120:123],v[56:63],v14
v_and_b32 v126,v12,v113
v_and_b32 v127,v13,v113
v_and_b32 v120,v12,v94
v_and_b32 v121,v13,v94
v_smfmac_f32_16x16x64_bf16 v[116:119],v[124:127],v[64:71],v14
v_and_b32 v122,v12,v114
v_and_b32 v123,v13,v114
v_and_b32 v124,v12,v95
v_and_b32 v125,v13,v95
v_smfmac_f32_16x16x64_bf16 v[116:119],v[120:123],v[72:79],v14
v_and_b32 v126,v12,v115
v_and_b32 v127,v13,v115
s_nop 1
v_smfmac_f32_16x16x64_bf16 v[116:119],v[124:127],v[80:87],v14
v_lshlrev_b32 v8,4,v9
v_and_b32 v124,1,v10
v_lshl_add_u32 v8,v124,3,v8
v_and_b32 v124,2,v10
v_lshl_add_u32 v8,v124,30,v8
s_lshl_b32 s60,s46,8
s_add_u32 s59,s62,s60
s_nop 0
v_cvt_pk_bf16_f32 v24,v116,v117
v_cvt_pk_bf16_f32 v25,v118,v119
buffer_store_dwordx2 v[24:25],v8,s[8:11],s59 offen sc1
s_lshl_b32 s59,s51,13
s_lshl2_add_u32 s59,s47,s59
s_add_u32 s59,s59,10486912
s_waitcnt vmcnt(0)
s_barrier
s_or_b32 s59,s59,s52
buffer_store_dword v17,off,s[8:11],s59 sc1
s_lshl_b32 s59,s51,13
s_add_u32 s59,s59,10486912
v_and_b32 v124,31,v1
v_lshlrev_b32 v124,2,v124
L_fw_395:
buffer_load_dword v125,v124,s[8:11],s59 offen sc1
s_sub_u32 s49,s49,1
s_cbranch_scc1 L_abort2
s_waitcnt vmcnt(0)
v_cmp_eq_u32 vcc,0,v125
s_cbranch_vccnz L_fw_395
s_add_u32 s63,s65,0
buffer_load_dwordx4 v[24:27],v22,s[8:11],s63 offen sc1
s_add_u32 s63,s65,4096
buffer_load_dwordx4 v[28:31],v22,s[8:11],s63 offen sc1
s_add_u32 s63,s65,8192
buffer_load_dwordx4 v[32:35],v22,s[8:11],s63 offen sc1
s_add_u32 s63,s65,12288
buffer_load_dwordx4 v[36:39],v22,s[8:11],s63 offen sc1
s_add_u32 s63,s65,16384
buffer_load_dwordx4 v[40:43],v22,s[8:11],s63 offen sc1
s_add_u32 s63,s65,20480
buffer_load_dwordx4 v[44:47],v22,s[8:11],s63 offen sc1
s_add_u32 s63,s65,24576
buffer_load_dwordx4 v[48:51],v22,s[8:11],s63 offen sc1
s_add_u32 s63,s65,28672
buffer_load_dwordx4 v[52:55],v22,s[8:11],s63 offen sc1
v_and_b32 v64,15,v1
v_and_b32 v65,1,v1
v_lshlrev_b32 v65,4,v65
v_mov_b32 v66,0x3f80
v_lshlrev_b32 v66,v65,v66
v_lshrrev_b32 v64,1,v64
v_cmp_eq_u32 vcc,0,v64
s_nop 1
v_cndmask_b32 v56,0,v66,vcc
v_cmp_eq_u32 vcc,1,v64
s_nop 1
v_cndmask_b32 v57,0,v66,vcc
v_cmp_eq_u32 vcc,2,v64
s_nop 1
v_cndmask_b32 v58,0,v66,vcc
v_cmp_eq_u32 vcc,3,v64
s_nop 1
v_cndmask_b32 v59,0,v66,vcc
s_waitcnt vmcnt(7)
s_nop 0
v_mfma_f32_16x16x32_bf16 v[60:63],v[56:59],v[24:27],0
s_waitcnt vmcnt(6)
v_mfma_f32_16x16x32_bf16 v[60:63],v[56:59],v[28:31],v[60:63]
s_waitcnt vmcnt(5)
v_mfma_f32_16x16x32_bf16 v[60:63],v[56:59],v[32:35],v[60:63]
s_waitcnt vmcnt(4)
v_mfma_f32_16x16x32_bf16 v[60:63],v[56:59],v[36:39],v[60:63]
s_waitcnt vmcnt(3)
v_mfma_f32_16x16x32_bf16 v[60:63],v[56:59],v[40:43],v[60:63]
s_waitcnt vmcnt(2)
v_mfma_f32_16x16x32_bf16 v[60:63],v[56:59],v[44:47],v[60:63]
s_waitcnt vmcnt(1)
v_mfma_f32_16x16x32_bf16 v[60:63],v[56:59],v[48:51],v[60:63]
s_waitcnt vmcnt(0)
v_mfma_f32_16x16x32_bf16 v[60:63],v[56:59],v[52:55],v[60:63]
s_nop 7
ds_write_b128 v21,v[60:63]
s_waitcnt lgkmcnt(0)
s_barrier
s_cmp_lg_u32 s46,0
s_cbranch_scc1 L_moed_394
v_lshlrev_b32 v56,5,v1
v_add_u32 v56,155648,v56
ds_read_b128 v[24:27],v56
ds_read_b128 v[28:31],v56 offset:16
s_and_b32 s59,s54,0xffff0000
s_xor_b32 s60,s59,0x80000000
s_xor_b32 s61,s59,0xffff0000
s_cmp_lt_i32 s59,0
s_cselect_b32 s59,s60,s61
v_mov_b32 v56,s59
v_mul_f32 v56,0xbfb8aa3b,v56
v_exp_f32 v56,v56
s_nop 0
v_add_f32 v56,1.0,v56
v_rcp_f32 v56,v56
s_nop 0
v_cvt_pk_bf16_f32 v56,v56,v56
v_and_b32 v56,0xffff0000,v56
v_lshlrev_b32 v48,16,v104
v_and_b32 v49,0xffff0000,v104
v_lshlrev_b32 v50,16,v105
v_and_b32 v51,0xffff0000,v105
v_lshlrev_b32 v52,16,v106
v_and_b32 v53,0xffff0000,v106
v_lshlrev_b32 v54,16,v107
v_and_b32 v55,0xffff0000,v107
s_waitcnt lgkmcnt(0)
v_cvt_pk_bf16_f32 v40,v24,v25
v_cvt_pk_bf16_f32 v41,v26,v27
v_cvt_pk_bf16_f32 v42,v28,v29
v_cvt_pk_bf16_f32 v43,v30,v31
v_lshlrev_b32 v24,16,v40
v_and_b32 v25,0xffff0000,v40
v_lshlrev_b32 v26,16,v41
v_and_b32 v27,0xffff0000,v41
v_lshlrev_b32 v28,16,v42
v_and_b32 v29,0xffff0000,v42
v_lshlrev_b32 v30,16,v43
v_and_b32 v31,0xffff0000,v43
v_pk_mul_f32 v[24:25],v[24:25],v[56:57] op_sel_hi:[1,0]
v_pk_mul_f32 v[26:27],v[26:27],v[56:57] op_sel_hi:[1,0]
v_pk_mul_f32 v[28:29],v[28:29],v[56:57] op_sel_hi:[1,0]
v_pk_mul_f32 v[30:31],v[30:31],v[56:57] op_sel_hi:[1,0]
v_cvt_pk_bf16_f32 v40,v24,v25
v_cvt_pk_bf16_f32 v41,v26,v27
v_cvt_pk_bf16_f32 v42,v28,v29
v_cvt_pk_bf16_f32 v43,v30,v31
v_lshlrev_b32 v24,16,v40
v_and_b32 v25,0xffff0000,v40
v_lshlrev_b32 v26,16,v41
v_and_b32 v27,0xffff0000,v41
v_lshlrev_b32 v28,16,v42
v_and_b32 v29,0xffff0000,v42
v_lshlrev_b32 v30,16,v43
v_and_b32 v31,0xffff0000,v43
v_pk_add_f32 v[24:25],v[24:25],v[48:49]
v_pk_add_f32 v[26:27],v[26:27],v[50:51]
v_pk_add_f32 v[28:29],v[28:29],v[52:53]
v_pk_add_f32 v[30:31],v[30:31],v[54:55]
v_cvt_pk_bf16_f32 v40,v24,v25
v_cvt_pk_bf16_f32 v41,v26,v27
v_cvt_pk_bf16_f32 v42,v28,v29
v_cvt_pk_bf16_f32 v43,v30,v31
v_lshlrev_b32 v24,16,v40
v_and_b32 v25,0xffff0000,v40
v_lshlrev_b32 v26,16,v41
v_and_b32 v27,0xffff0000,v41
v_lshlrev_b32 v28,16,v42
v_and_b32 v29,0xffff0000,v42
v_lshlrev_b32 v30,16,v43
v_and_b32 v31,0xffff0000,v43
v_pk_add_f32 v[96:97],v[96:97],v[24:25]
v_pk_add_f32 v[98:99],v[98:99],v[26:27]
v_pk_add_f32 v[100:101],v[100:101],v[28:29]
v_pk_add_f32 v[102:103],v[102:103],v[30:31]
v_cvt_pk_bf16_f32 v80,v96,v97
v_cvt_pk_bf16_f32 v81,v98,v99
v_cvt_pk_bf16_f32 v82,v100,v101
v_cvt_pk_bf16_f32 v83,v102,v103
v_lshlrev_b32 v96,16,v80
v_and_b32 v97,0xffff0000,v80
v_lshlrev_b32 v98,16,v81
v_and_b32 v99,0xffff0000,v81
v_lshlrev_b32 v100,16,v82
v_and_b32 v101,0xffff0000,v82
v_lshlrev_b32 v102,16,v83
v_and_b32 v103,0xffff0000,v83
v_readfirstlane_b32 s78,v96
s_nop 1
v_pk_add_f32 v[58:59],v[96:97],s[78:79] op_sel_hi:[1,0] neg_lo:[0,1] neg_hi:[0,1]
v_pk_add_f32 v[60:61],v[98:99],s[78:79] op_sel_hi:[1,0] neg_lo:[0,1] neg_hi:[0,1]
v_pk_add_f32 v[62:63],v[100:101],s[78:79] op_sel_hi:[1,0] neg_lo:[0,1] neg_hi:[0,1]
v_pk_add_f32 v[64:65],v[102:103],s[78:79] op_sel_hi:[1,0] neg_lo:[0,1] neg_hi:[0,1]
v_pk_add_f32 v[66:67],v[58:59],v[60:61]
v_pk_mul_f32 v[68:69],v[58:59],v[58:59]
v_pk_add_f32 v[70:71],v[62:63],v[64:65]
v_pk_fma_f32 v[68:69],v[60:61],v[60:61],v[68:69]
v_pk_add_f32 v[66:67],v[66:67],v[70:71]
v_pk_fma_f32 v[68:69],v[62:63],v[62:63],v[68:69]
v_add_f32 v66,v66,v67
v_pk_fma_f32 v[68:69],v[64:65],v[64:65],v[68:69]
v_add_f32 v68,v68,v69
s_nop 1
v_permlane32_swap_b32 v66,v68
v_add_f32 v66,v66,v68
s_nop 1
v_add_f32_dpp v66,v66,v66 row_ror:8 row_mask:0xf bank_mask:0xf
s_nop 1
v_add_f32_dpp v66,v66,v66 row_ror:4 row_mask:0xf bank_mask:0xf
s_nop 1
v_add_f32_dpp v66,v66,v66 row_ror:2 row_mask:0xf bank_mask:0xf
s_nop 1
v_add_f32_dpp v66,v66,v66 row_ror:1 row_mask:0xf bank_mask:0xf
v_mov_b32 v68,v66
s_nop 1
v_permlane16_swap_b32 v66,v68
v_add_f32 v66,v66,v68
v_mul_f32 v66,0x3b000000,v66
v_mov_b32 v68,v66
s_nop 1
v_permlane32_swap_b32 v66,v68
v_fma_f32 v68,-v66,v66,v68
v_add_f32 v66,s78,v66
v_max_f32 v68,0,v68
v_cvt_pk_bf16_f32 v68,v66,v68
v_lshlrev_b32 v66,16,v68
v_and_b32 v68,0xffff0000,v68
v_add_f32 v68,0x3727c5ac,v68
v_cvt_pk_bf16_f32 v68,v68,v68
v_and_b32 v68,0xffff0000,v68
v_sqrt_f32 v68,v68
v_pk_add_f32 v[58:59],v[96:97],v[66:67] op_sel_hi:[1,0] neg_lo:[0,1] neg_hi:[0,1]
v_pk_add_f32 v[60:61],v[98:99],v[66:67] op_sel_hi:[1,0] neg_lo:[0,1] neg_hi:[0,1]
v_pk_add_f32 v[62:63],v[100:101],v[66:67] op_sel_hi:[1,0] neg_lo:[0,1] neg_hi:[0,1]
v_pk_add_f32 v[64:65],v[102:103],v[66:67] op_sel_hi:[1,0] neg_lo:[0,1] neg_hi:[0,1]
v_cvt_pk_bf16_f32 v68,v68,v68
v_and_b32 v68,0xffff0000,v68
v_rcp_f32 v68,v68
v_cvt_pk_bf16_f32 v84,v58,v59
v_cvt_pk_bf16_f32 v85,v60,v61
v_cvt_pk_bf16_f32 v86,v62,v63
v_cvt_pk_bf16_f32 v87,v64,v65
v_lshlrev_b32 v58,16,v84
v_and_b32 v59,0xffff0000,v84
v_lshlrev_b32 v60,16,v85
v_and_b32 v61,0xffff0000,v85
v_lshlrev_b32 v62,16,v86
v_and_b32 v63,0xffff0000,v86
v_lshlrev_b32 v64,16,v87
v_and_b32 v65,0xffff0000,v87
v_pk_mul_f32 v[58:59],v[58:59],v[68:69] op_sel_hi:[1,0]
v_pk_mul_f32 v[60:61],v[60:61],v[68:69] op_sel_hi:[1,0]
v_pk_mul_f32 v[62:63],v[62:63],v[68:69] op_sel_hi:[1,0]
v_pk_mul_f32 v[64:65],v[64:65],v[68:69] op_sel_hi:[1,0]
v_cvt_pk_bf16_f32 v84,v58,v59
v_cvt_pk_bf16_f32 v85,v60,v61
v_cvt_pk_bf16_f32 v86,v62,v63
v_cvt_pk_bf16_f32 v87,v64,v65
s_lshl_b32 s58,s51,10
s_add_u32 s58,s58,11272192
s_add_u32 s59,s58,65536
s_cmp_eq_u32 s47,0
s_cselect_b32 s59,s59,0x80000000
s_add_u32 s57,s56,98566144
buffer_store_dwordx4 v[84:87],v0,s[8:11],s59 offen sc1
buffer_store_dwordx4 v[80:83],v0,s[8:11],s58 offen sc1
buffer_store_dwordx4 v[84:87],v0,s[8:11],s57 offen sc1
L_moed_394:
s_barrier
L_mo_381:
s_mov_b32 s77,-1
s_cmp_lt_u32 s31,64
s_cbranch_scc1 L_mo_377
s_cmp_eq_u32 s86,0
s_cbranch_scc1 L_mo_390
L_mo_383:
s_andn2_b32 s51,0x7ff,s54
s_lshr_b32 s51,s51,5
s_andn2_b32 s56,31,s54
v_lshrrev_b32 v2,10,v20
v_add_u32 v3,16,v2
v_add_u32 v8,96468992,v20
v_cmp_eq_u32 vcc,s56,v2
s_nop 1
v_cndmask_b32 v2,v20,v8,vcc
v_cmp_eq_u32 vcc,s56,v3
s_nop 1
v_cndmask_b32 v3,v20,v8,vcc
s_waitcnt vmcnt(0)
s_lshl_b32 s59,s51,13
s_add_u32 s59,s59,10487552
s_cmp_lg_u32 s46,0
s_cbranch_scc1 L_fd_399
v_and_b32 v124,31,v1
v_lshlrev_b32 v124,2,v124
s_branch L_ff_400
L_fw_398:
s_sleep 2
L_ff_400:
buffer_load_dword v125,v124,s[8:11],s59 offen sc1
s_sub_u32 s49,s49,1
s_cbranch_scc1 L_abort2
s_waitcnt vmcnt(0)
v_cmp_eq_u32 vcc,0,v125
s_cbranch_vccnz L_fw_398
L_fd_399:
s_barrier
s_or_b32 s72,s72,s52
buffer_store_dword v17,off,s[8:11],s72 sc1
s_lshl_b32 s66,s51,15
s_add_u32 s66,s66,2097152
s_add_u32 s67,s66,16384
s_add_u32 m0,s50,131072
s_nop 0
buffer_load_dwordx4 v2,s[8:11],s66 offen offset:0 sc1 lds
s_add_u32 m0,s50,135168
s_nop 0
buffer_load_dwordx4 v3,s[8:11],s67 offen offset:0 sc1 lds
s_add_u32 m0,s50,139008
s_nop 0
buffer_load_dwordx4 v2,s[8:11],s66 offen offset:256 sc1 lds
s_add_u32 m0,s50,143104
s_nop 0
buffer_load_dwordx4 v3,s[8:11],s67 offen offset:256 sc1 lds
s_add_u32 m0,s50,146944
s_nop 0
buffer_load_dwordx4 v2,s[8:11],s66 offen offset:512 sc1 lds
s_add_u32 m0,s50,151040
s_nop 0
buffer_load_dwordx4 v3,s[8:11],s67 offen offset:512 sc1 lds
s_waitcnt vmcnt(4)
s_barrier
ds_read_b128 v[104:107],v4 offset:0
ds_read_b128 v[108:111],v4 offset:4096
ds_read_b128 v[112:115],v5 offset:0
ds_read_b128 v[116:119],v5 offset:4096
s_add_u32 m0,s50,154880
s_nop 0
buffer_load_dwordx4 v2,s[8:11],s66 offen offset:768 sc1 lds
s_add_u32 m0,s50,158976
s_nop 0
buffer_load_dwordx4 v3,s[8:11],s67 offen offset:768 sc1 lds
s_waitcnt lgkmcnt(2)
v_mfma_f32_16x16x32_bf16 v[24:27],a[128:131],v[104:107],0
ds_read_b128 v[120:123],v6 offset:0
v_mfma_f32_16x16x32_bf16 v[40:43],v[104:107],v[128:131],0
s_lshl_b32 s58,s51,5
v_mfma_f32_16x16x32_bf16 v[28:31],a[128:131],v[108:111],0
ds_read_b128 v[124:127],v6 offset:4096
v_mfma_f32_16x16x32_bf16 v[44:47],v[108:111],v[128:131],0
s_add_u32 s58,s58,s47
v_mfma_f32_16x16x32_bf16 v[32:35],a[136:139],v[104:107],0
s_mul_i32 s58,s58,24576
v_mfma_f32_16x16x32_bf16 v[48:51],v[104:107],v[136:139],0
s_add_u32 s58,s58,201326592
v_mfma_f32_16x16x32_bf16 v[36:39],a[136:139],v[108:111],0
s_add_u32 s61,s58,s50
v_mfma_f32_16x16x32_bf16 v[52:55],v[108:111],v[136:139],0
s_add_u32 s62,s61,4096
s_waitcnt lgkmcnt(2)
v_mfma_f32_16x16x32_bf16 v[24:27],a[132:135],v[112:115],v[24:27]
ds_read_b128 v[104:107],v7 offset:0
v_mfma_f32_16x16x32_bf16 v[40:43],v[112:115],v[132:135],v[40:43]
s_add_u32 s63,s61,16384
v_mfma_f32_16x16x32_bf16 v[28:31],a[132:135],v[116:119],v[28:31]
ds_read_b128 v[108:111],v7 offset:4096
v_mfma_f32_16x16x32_bf16 v[44:47],v[116:119],v[132:135],v[44:47]
s_add_u32 s64,s61,20480
v_mfma_f32_16x16x32_bf16 v[32:35],a[140:143],v[112:115],v[32:35]
s_add_u32 s65,s61,s50
v_mfma_f32_16x16x32_bf16 v[48:51],v[112:115],v[140:143],v[48:51]
s_add_u32 s65,s65,8192
v_mfma_f32_16x16x32_bf16 v[36:39],a[140:143],v[116:119],v[36:39]
v_mfma_f32_16x16x32_bf16 v[52:55],v[116:119],v[140:143],v[52:55]
s_waitcnt vmcnt(4)
s_barrier
s_waitcnt lgkmcnt(2)
v_mfma_f32_16x16x32_bf16 v[24:27],a[144:147],v[120:123],v[24:27]
ds_read_b128 v[112:115],v4 offset:8192
v_mfma_f32_16x16x32_bf16 v[40:43],v[120:123],v[144:147],v[40:43]
v_mfma_f32_16x16x32_bf16 v[28:31],a[144:147],v[124:127],v[28:31]
ds_read_b128 v[116:119],v4 offset:12288
v_mfma_f32_16x16x32_bf16 v[44:47],v[124:127],v[144:147],v[44:47]
v_mfma_f32_16x16x32_bf16 v[32:35],a[152:155],v[120:123],v[32:35]
v_mfma_f32_16x16x32_bf16 v[48:51],v[120:123],v[152:155],v[48:51]
v_mfma_f32_16x16x32_bf16 v[36:39],a[152:155],v[124:127],v[36:39]
v_mfma_f32_16x16x32_bf16 v[52:55],v[124:127],v[152:155],v[52:55]
s_waitcnt lgkmcnt(2)
v_mfma_f32_16x16x32_bf16 v[24:27],a[148:151],v[104:107],v[24:27]
ds_read_b128 v[120:123],v5 offset:8192
v_mfma_f32_16x16x32_bf16 v[40:43],v[104:107],v[148:151],v[40:43]
v_mfma_f32_16x16x32_bf16 v[28:31],a[148:151],v[108:111],v[28:31]
ds_read_b128 v[124:127],v5 offset:12288
v_mfma_f32_16x16x32_bf16 v[44:47],v[108:111],v[148:151],v[44:47]
v_mfma_f32_16x16x32_bf16 v[32:35],a[156:159],v[104:107],v[32:35]
v_mfma_f32_16x16x32_bf16 v[48:51],v[104:107],v[156:159],v[48:51]
v_mfma_f32_16x16x32_bf16 v[36:39],a[156:159],v[108:111],v[36:39]
v_mfma_f32_16x16x32_bf16 v[52:55],v[108:111],v[156:159],v[52:55]
s_waitcnt lgkmcnt(2)
v_mfma_f32_16x16x32_bf16 v[24:27],a[160:163],v[112:115],v[24:27]
ds_read_b128 v[104:107],v6 offset:8192
v_mfma_f32_16x16x32_bf16 v[40:43],v[112:115],v[160:163],v[40:43]
v_mfma_f32_16x16x32_bf16 v[28:31],a[160:163],v[116:119],v[28:31]
ds_read_b128 v[108:111],v6 offset:12288
v_mfma_f32_16x16x32_bf16 v[44:47],v[116:119],v[160:163],v[44:47]
v_mfma_f32_16x16x32_bf16 v[32:35],a[168:171],v[112:115],v[32:35]
v_mfma_f32_16x16x32_bf16 v[48:51],v[112:115],v[168:171],v[48:51]
v_mfma_f32_16x16x32_bf16 v[36:39],a[168:171],v[116:119],v[36:39]
v_mfma_f32_16x16x32_bf16 v[52:55],v[116:119],v[168:171],v[52:55]
s_waitcnt lgkmcnt(2)
v_mfma_f32_16x16x32_bf16 v[24:27],a[164:167],v[120:123],v[24:27]
ds_read_b128 v[112:115],v7 offset:8192
v_mfma_f32_16x16x32_bf16 v[40:43],v[120:123],v[164:167],v[40:43]
v_mfma_f32_16x16x32_bf16 v[28:31],a[164:167],v[124:127],v[28:31]
ds_read_b128 v[116:119],v7 offset:12288
v_mfma_f32_16x16x32_bf16 v[44:47],v[124:127],v[164:167],v[44:47]
v_mfma_f32_16x16x32_bf16 v[32:35],a[172:175],v[120:123],v[32:35]
v_mfma_f32_16x16x32_bf16 v[48:51],v[120:123],v[172:175],v[48:51]
v_mfma_f32_16x16x32_bf16 v[36:39],a[172:175],v[124:127],v[36:39]
v_mfma_f32_16x16x32_bf16 v[52:55],v[124:127],v[172:175],v[52:55]
s_waitcnt vmcnt(2)
s_barrier
s_waitcnt lgkmcnt(2)
v_mfma_f32_16x16x32_bf16 v[24:27],a[176:179],v[104:107],v[24:27]
ds_read_b128 v[120:123],v4 offset:16384
v_mfma_f32_16x16x32_bf16 v[40:43],v[104:107],v[176:179],v[40:43]
v_mfma_f32_16x16x32_bf16 v[28:31],a[176:179],v[108:111],v[28:31]
ds_read_b128 v[124:127],v4 offset:20480
v_mfma_f32_16x16x32_bf16 v[44:47],v[108:111],v[176:179],v[44:47]
v_mfma_f32_16x16x32_bf16 v[32:35],a[184:187],v[104:107],v[32:35]
v_mfma_f32_16x16x32_bf16 v[48:51],v[104:107],v[184:187],v[48:51]
v_mfma_f32_16x16x32_bf16 v[36:39],a[184:187],v[108:111],v[36:39]
v_mfma_f32_16x16x32_bf16 v[52:55],v[108:111],v[184:187],v[52:55]
s_waitcnt lgkmcnt(2)
v_mfma_f32_16x16x32_bf16 v[24:27],a[180:183],v[112:115],v[24:27]
ds_read_b128 v[104:107],v5 offset:16384
v_mfma_f32_16x16x32_bf16 v[40:43],v[112:115],v[180:183],v[40:43]
v_mfma_f32_16x16x32_bf16 v[28:31],a[180:183],v[116:119],v[28:31]
ds_read_b128 v[108:111],v5 offset:20480
v_mfma_f32_16x16x32_bf16 v[44:47],v[116:119],v[180:183],v[44:47]
v_mfma_f32_16x16x32_bf16 v[32:35],a[188:191],v[112:115],v[32:35]
v_mfma_f32_16x16x32_bf16 v[48:51],v[112:115],v[188:191],v[48:51]
v_mfma_f32_16x16x32_bf16 v[36:39],a[188:191],v[116:119],v[36:39]
v_mfma_f32_16x16x32_bf16 v[52:55],v[116:119],v[188:191],v[52:55]
s_waitcnt lgkmcnt(2)
v_mfma_f32_16x16x32_bf16 v[24:27],a[192:195],v[120:123],v[24:27]
ds_read_b128 v[112:115],v6 offset:16384
v_mfma_f32_16x16x32_bf16 v[40:43],v[120:123],v[192:195],v[40:43]
v_mfma_f32_16x16x32_bf16 v[28:31],a[192:195],v[124:127],v[28:31]
ds_read_b128 v[116:119],v6 offset:20480
v_mfma_f32_16x16x32_bf16 v[44:47],v[124:127],v[192:195],v[44:47]
v_mfma_f32_16x16x32_bf16 v[32:35],a[200:203],v[120:123],v[32:35]
v_mfma_f32_16x16x32_bf16 v[48:51],v[120:123],v[200:203],v[48:51]
v_mfma_f32_16x16x32_bf16 v[36:39],a[200:203],v[124:127],v[36:39]
v_mfma_f32_16x16x32_bf16 v[52:55],v[124:127],v[200:203],v[52:55]
s_waitcnt lgkmcnt(2)
v_mfma_f32_16x16x32_bf16 v[24:27],a[196:199],v[104:107],v[24:27]
ds_read_b128 v[120:123],v7 offset:16384
v_mfma_f32_16x16x32_bf16 v[40:43],v[104:107],v[196:199],v[40:43]
v_mfma_f32_16x16x32_bf16 v[28:31],a[196:199],v[108:111],v[28:31]
ds_read_b128 v[124:127],v7 offset:20480
v_mfma_f32_16x16x32_bf16 v[44:47],v[108:111],v[196:199],v[44:47]
v_mfma_f32_16x16x32_bf16 v[32:35],a[204:207],v[104:107],v[32:35]
v_mfma_f32_16x16x32_bf16 v[48:51],v[104:107],v[204:207],v[48:51]
v_mfma_f32_16x16x32_bf16 v[36:39],a[204:207],v[108:111],v[36:39]
v_mfma_f32_16x16x32_bf16 v[52:55],v[108:111],v[204:207],v[52:55]
s_waitcnt vmcnt(0)
s_barrier
s_waitcnt lgkmcnt(2)
v_mfma_f32_16x16x32_bf16 v[24:27],a[208:211],v[112:115],v[24:27]
ds_read_b128 v[104:107],v4 offset:24576
v_mfma_f32_16x16x32_bf16 v[40:43],v[112:115],v[208:211],v[40:43]
v_mfma_f32_16x16x32_bf16 v[28:31],a[208:211],v[116:119],v[28:31]
ds_read_b128 v[108:111],v4 offset:28672
v_mfma_f32_16x16x32_bf16 v[44:47],v[116:119],v[208:211],v[44:47]
v_mfma_f32_16x16x32_bf16 v[32:35],a[216:219],v[112:115],v[32:35]
v_mfma_f32_16x16x32_bf16 v[48:51],v[112:115],v[216:219],v[48:51]
v_mfma_f32_16x16x32_bf16 v[36:39],a[216:219],v[116:119],v[36:39]
v_mfma_f32_16x16x32_bf16 v[52:55],v[116:119],v[216:219],v[52:55]
s_waitcnt lgkmcnt(2)
v_mfma_f32_16x16x32_bf16 v[24:27],a[212:215],v[120:123],v[24:27]
ds_read_b128 v[112:115],v5 offset:24576
v_mfma_f32_16x16x32_bf16 v[40:43],v[120:123],v[212:215],v[40:43]
v_mfma_f32_16x16x32_bf16 v[28:31],a[212:215],v[124:127],v[28:31]
ds_read_b128 v[116:119],v5 offset:28672
v_mfma_f32_16x16x32_bf16 v[44:47],v[124:127],v[212:215],v[44:47]
v_mfma_f32_16x16x32_bf16 v[32:35],a[220:223],v[120:123],v[32:35]
v_mfma_f32_16x16x32_bf16 v[48:51],v[120:123],v[220:223],v[48:51]
v_mfma_f32_16x16x32_bf16 v[36:39],a[220:223],v[124:127],v[36:39]
v_mfma_f32_16x16x32_bf16 v[52:55],v[124:127],v[220:223],v[52:55]
s_waitcnt lgkmcnt(2)
v_mfma_f32_16x16x32_bf16 v[24:27],a[224:227],v[104:107],v[24:27]
ds_read_b128 v[120:123],v6 offset:24576
v_mfma_f32_16x16x32_bf16 v[40:43],v[104:107],v[224:227],v[40:43]
v_mfma_f32_16x16x32_bf16 v[28:31],a[224:227],v[108:111],v[28:31]
ds_read_b128 v[124:127],v6 offset:28672
v_mfma_f32_16x16x32_bf16 v[44:47],v[108:111],v[224:227],v[44:47]
v_mfma_f32_16x16x32_bf16 v[32:35],a[232:235],v[104:107],v[32:35]
v_mfma_f32_16x16x32_bf16 v[48:51],v[104:107],v[232:235],v[48:51]
v_mfma_f32_16x16x32_bf16 v[36:39],a[232:235],v[108:111],v[36:39]
v_mfma_f32_16x16x32_bf16 v[52:55],v[108:111],v[232:235],v[52:55]
s_waitcnt lgkmcnt(2)
v_mfma_f32_16x16x32_bf16 v[24:27],a[228:231],v[112:115],v[24:27]
ds_read_b128 v[104:107],v7 offset:24576
v_mfma_f32_16x16x32_bf16 v[40:43],v[112:115],v[228:231],v[40:43]
v_mfma_f32_16x16x32_bf16 v[28:31],a[228:231],v[116:119],v[28:31]
ds_read_b128 v[108:111],v7 offset:28672
v_mfma_f32_16x16x32_bf16 v[44:47],v[116:119],v[228:231],v[44:47]
v_mfma_f32_16x16x32_bf16 v[32:35],a[236:239],v[112:115],v[32:35]
v_mfma_f32_16x16x32_bf16 v[48:51],v[112:115],v[236:239],v[48:51]
v_mfma_f32_16x16x32_bf16 v[36:39],a[236:239],v[116:119],v[36:39]
v_mfma_f32_16x16x32_bf16 v[52:55],v[116:119],v[236:239],v[52:55]
s_waitcnt lgkmcnt(2)
v_mfma_f32_16x16x32_bf16 v[24:27],a[240:243],v[120:123],v[24:27]
ds_read_b128 v[112:115],v4 offset:0
v_mfma_f32_16x16x32_bf16 v[40:43],v[120:123],v[240:243],v[40:43]
v_mfma_f32_16x16x32_bf16 v[28:31],a[240:243],v[124:127],v[28:31]
ds_read_b128 v[116:119],v4 offset:4096
v_mfma_f32_16x16x32_bf16 v[44:47],v[124:127],v[240:243],v[44:47]
v_mfma_f32_16x16x32_bf16 v[32:35],a[248:251],v[120:123],v[32:35]
v_mfma_f32_16x16x32_bf16 v[48:51],v[120:123],v[248:251],v[48:51]
v_mfma_f32_16x16x32_bf16 v[36:39],a[248:251],v[124:127],v[36:39]
v_mfma_f32_16x16x32_bf16 v[52:55],v[124:127],v[248:251],v[52:55]
s_waitcnt lgkmcnt(2)
v_mfma_f32_16x16x32_bf16 v[24:27],a[244:247],v[104:107],v[24:27]
ds_read_b128 v[120:123],v5 offset:0
v_mfma_f32_16x16x32_bf16 v[40:43],v[104:107],v[244:247],v[40:43]
v_mfma_f32_16x16x32_bf16 v[28:31],a[244:247],v[108:111],v[28:31]
ds_read_b128 v[124:127],v5 offset:4096
v_mfma_f32_16x16x32_bf16 v[44:47],v[108:111],v[244:247],v[44:47]
v_mfma_f32_16x16x32_bf16 v[32:35],a[252:255],v[104:107],v[32:35]
v_mfma_f32_16x16x32_bf16 v[48:51],v[104:107],v[252:255],v[48:51]
v_mfma_f32_16x16x32_bf16 v[36:39],a[252:255],v[108:111],v[36:39]
v_mfma_f32_16x16x32_bf16 v[52:55],v[108:111],v[252:255],v[52:55]
s_waitcnt lgkmcnt(2)
v_mfma_f32_16x16x32_bf16 v[88:91],a[0:3],v[112:115],0
ds_read_b128 v[104:107],v6 offset:0
v_mfma_f32_16x16x32_bf16 v[92:95],a[0:3],v[116:119],0
v_mfma_f32_16x16x32_bf16 v[96:99],a[8:11],v[112:115],0
ds_read_b128 v[108:111],v6 offset:4096
v_cvt_pk_bf16_f32 v56,v24,v32
v_cvt_pk_bf16_f32 v57,v25,v33
v_mfma_f32_16x16x32_bf16 v[100:103],a[8:11],v[116:119],0
v_cvt_pk_bf16_f32 v58,v26,v34
v_cvt_pk_bf16_f32 v59,v27,v35
s_waitcnt lgkmcnt(2)
v_mfma_f32_16x16x32_bf16 v[88:91],a[4:7],v[120:123],v[88:91]
ds_read_b128 v[112:115],v7 offset:0
v_mfma_f32_16x16x32_bf16 v[92:95],a[4:7],v[124:127],v[92:95]
buffer_store_dwordx4 v[56:59],v0,s[8:11],s61 offen sc1
v_cvt_pk_bf16_f32 v60,v28,v36
v_cvt_pk_bf16_f32 v61,v29,v37
v_mfma_f32_16x16x32_bf16 v[96:99],a[12:15],v[120:123],v[96:99]
ds_read_b128 v[116:119],v7 offset:4096
v_cvt_pk_bf16_f32 v62,v30,v38
v_cvt_pk_bf16_f32 v63,v31,v39
v_mfma_f32_16x16x32_bf16 v[100:103],a[12:15],v[124:127],v[100:103]
buffer_store_dwordx4 v[60:63],v0,s[8:11],s62 offen sc1
v_cvt_pk_bf16_f32 v64,v40,v41
v_cvt_pk_bf16_f32 v65,v42,v43
s_waitcnt lgkmcnt(2)
v_mfma_f32_16x16x32_bf16 v[88:91],a[16:19],v[104:107],v[88:91]
ds_read_b128 v[120:123],v4 offset:8192
v_cvt_pk_bf16_f32 v66,v44,v45
v_cvt_pk_bf16_f32 v67,v46,v47
v_mfma_f32_16x16x32_bf16 v[92:95],a[16:19],v[108:111],v[92:95]
buffer_store_dwordx4 v[64:67],v0,s[8:11],s65 offen offset:0 sc1
v_cvt_pk_bf16_f32 v68,v48,v49
v_cvt_pk_bf16_f32 v69,v50,v51
v_mfma_f32_16x16x32_bf16 v[96:99],a[24:27],v[104:107],v[96:99]
ds_read_b128 v[124:127],v4 offset:12288
v_cvt_pk_bf16_f32 v70,v52,v53
v_cvt_pk_bf16_f32 v71,v54,v55
v_mfma_f32_16x16x32_bf16 v[100:103],a[24:27],v[108:111],v[100:103]
buffer_store_dwordx4 v[68:71],v0,s[8:11],s65 offen offset:1024 sc1
s_waitcnt lgkmcnt(2)
v_mfma_f32_16x16x32_bf16 v[88:91],a[20:23],v[112:115],v[88:91]
ds_read_b128 v[104:107],v5 offset:8192
v_mfma_f32_16x16x32_bf16 v[92:95],a[20:23],v[116:119],v[92:95]
v_mfma_f32_16x16x32_bf16 v[96:99],a[28:31],v[112:115],v[96:99]
ds_read_b128 v[108:111],v5 offset:12288
v_mfma_f32_16x16x32_bf16 v[100:103],a[28:31],v[116:119],v[100:103]
s_waitcnt lgkmcnt(2)
v_mfma_f32_16x16x32_bf16 v[88:91],a[32:35],v[120:123],v[88:91]
ds_read_b128 v[112:115],v6 offset:8192
v_mfma_f32_16x16x32_bf16 v[92:95],a[32:35],v[124:127],v[92:95]
v_mfma_f32_16x16x32_bf16 v[96:99],a[40:43],v[120:123],v[96:99]
ds_read_b128 v[116:119],v6 offset:12288
v_mfma_f32_16x16x32_bf16 v[100:103],a[40:43],v[124:127],v[100:103]
s_waitcnt lgkmcnt(2)
v_mfma_f32_16x16x32_bf16 v[88:91],a[36:39],v[104:107],v[88:91]
ds_read_b128 v[120:123],v7 offset:8192
v_mfma_f32_16x16x32_bf16 v[92:95],a[36:39],v[108:111],v[92:95]
v_mfma_f32_16x16x32_bf16 v[96:99],a[44:47],v[104:107],v[96:99]
ds_read_b128 v[124:127],v7 offset:12288
v_mfma_f32_16x16x32_bf16 v[100:103],a[44:47],v[108:111],v[100:103]
s_waitcnt lgkmcnt(2)
v_mfma_f32_16x16x32_bf16 v[88:91],a[48:51],v[112:115],v[88:91]
ds_read_b128 v[104:107],v4 offset:16384
v_mfma_f32_16x16x32_bf16 v[92:95],a[48:51],v[116:119],v[92:95]
v_mfma_f32_16x16x32_bf16 v[96:99],a[56:59],v[112:115],v[96:99]
ds_read_b128 v[108:111],v4 offset:20480
v_mfma_f32_16x16x32_bf16 v[100:103],a[56:59],v[116:119],v[100:103]
s_waitcnt lgkmcnt(2)
v_mfma_f32_16x16x32_bf16 v[88:91],a[52:55],v[120:123],v[88:91]
ds_read_b128 v[112:115],v5 offset:16384
v_mfma_f32_16x16x32_bf16 v[92:95],a[52:55],v[124:127],v[92:95]
v_mfma_f32_16x16x32_bf16 v[96:99],a[60:63],v[120:123],v[96:99]
ds_read_b128 v[116:119],v5 offset:20480
v_mfma_f32_16x16x32_bf16 v[100:103],a[60:63],v[124:127],v[100:103]
s_waitcnt lgkmcnt(2)
v_mfma_f32_16x16x32_bf16 v[88:91],a[64:67],v[104:107],v[88:91]
ds_read_b128 v[120:123],v6 offset:16384
v_mfma_f32_16x16x32_bf16 v[92:95],a[64:67],v[108:111],v[92:95]
v_mfma_f32_16x16x32_bf16 v[96:99],a[72:75],v[104:107],v[96:99]
ds_read_b128 v[124:127],v6 offset:20480
v_mfma_f32_16x16x32_bf16 v[100:103],a[72:75],v[108:111],v[100:103]
s_waitcnt lgkmcnt(2)
v_mfma_f32_16x16x32_bf16 v[88:91],a[68:71],v[112:115],v[88:91]
ds_read_b128 v[104:107],v7 offset:16384
v_mfma_f32_16x16x32_bf16 v[92:95],a[68:71],v[116:119],v[92:95]
v_mfma_f32_16x16x32_bf16 v[96:99],a[76:79],v[112:115],v[96:99]
ds_read_b128 v[108:111],v7 offset:20480
v_mfma_f32_16x16x32_bf16 v[100:103],a[76:79],v[116:119],v[100:103]
s_waitcnt lgkmcnt(2)
v_mfma_f32_16x16x32_bf16 v[88:91],a[80:83],v[120:123],v[88:91]
ds_read_b128 v[112:115],v4 offset:24576
v_mfma_f32_16x16x32_bf16 v[92:95],a[80:83],v[124:127],v[92:95]
v_mfma_f32_16x16x32_bf16 v[96:99],a[88:91],v[120:123],v[96:99]
ds_read_b128 v[116:119],v4 offset:28672
v_mfma_f32_16x16x32_bf16 v[100:103],a[88:91],v[124:127],v[100:103]
s_waitcnt lgkmcnt(2)
v_mfma_f32_16x16x32_bf16 v[88:91],a[84:87],v[104:107],v[88:91]
ds_read_b128 v[120:123],v5 offset:24576
v_mfma_f32_16x16x32_bf16 v[92:95],a[84:87],v[108:111],v[92:95]
v_mfma_f32_16x16x32_bf16 v[96:99],a[92:95],v[104:107],v[96:99]
ds_read_b128 v[124:127],v5 offset:28672
v_mfma_f32_16x16x32_bf16 v[100:103],a[92:95],v[108:111],v[100:103]
s_waitcnt lgkmcnt(2)
v_mfma_f32_16x16x32_bf16 v[88:91],a[96:99],v[112:115],v[88:91]
ds_read_b128 v[104:107],v6 offset:24576
v_mfma_f32_16x16x32_bf16 v[92:95],a[96:99],v[116:119],v[92:95]
v_mfma_f32_16x16x32_bf16 v[96:99],a[104:107],v[112:115],v[96:99]
ds_read_b128 v[108:111],v6 offset:28672
v_mfma_f32_16x16x32_bf16 v[100:103],a[104:107],v[116:119],v[100:103]
s_waitcnt lgkmcnt(2)
v_mfma_f32_16x16x32_bf16 v[88:91],a[100:103],v[120:123],v[88:91]
ds_read_b128 v[112:115],v7 offset:24576
v_mfma_f32_16x16x32_bf16 v[92:95],a[100:103],v[124:127],v[92:95]
v_mfma_f32_16x16x32_bf16 v[96:99],a[108:111],v[120:123],v[96:99]
ds_read_b128 v[116:119],v7 offset:28672
v_mfma_f32_16x16x32_bf16 v[100:103],a[108:111],v[124:127],v[100:103]
s_waitcnt lgkmcnt(2)
v_mfma_f32_16x16x32_bf16 v[88:91],a[112:115],v[104:107],v[88:91]
v_mfma_f32_16x16x32_bf16 v[92:95],a[112:115],v[108:111],v[92:95]
v_mfma_f32_16x16x32_bf16 v[96:99],a[120:123],v[104:107],v[96:99]
v_mfma_f32_16x16x32_bf16 v[100:103],a[120:123],v[108:111],v[100:103]
s_waitcnt lgkmcnt(0)
v_mfma_f32_16x16x32_bf16 v[88:91],a[116:119],v[112:115],v[88:91]
v_mfma_f32_16x16x32_bf16 v[92:95],a[116:119],v[116:119],v[92:95]
v_mfma_f32_16x16x32_bf16 v[96:99],a[124:127],v[112:115],v[96:99]
v_mfma_f32_16x16x32_bf16 v[100:103],a[124:127],v[116:119],v[100:103]
s_nop 3
v_cvt_pk_bf16_f32 v104,v88,v96
v_cvt_pk_bf16_f32 v105,v89,v97
v_cvt_pk_bf16_f32 v106,v90,v98
v_cvt_pk_bf16_f32 v107,v91,v99
v_cvt_pk_bf16_f32 v108,v92,v100
v_cvt_pk_bf16_f32 v109,v93,v101
v_cvt_pk_bf16_f32 v110,v94,v102
v_cvt_pk_bf16_f32 v111,v95,v103
buffer_store_dwordx4 v[104:107],v0,s[8:11],s63 offen sc1
buffer_store_dwordx4 v[108:111],v0,s[8:11],s64 offen sc1
s_waitcnt vmcnt(6)
s_barrier
s_add_u32 m0,s50,131072
s_nop 0
buffer_load_dwordx4 v20,s[8:11],s70 offen offset:0 sc1 lds
s_add_u32 m0,s50,135168
s_nop 0
buffer_load_dwordx4 v20,s[8:11],s71 offen offset:0 sc1 lds
s_add_u32 m0,s50,139008
s_nop 0
buffer_load_dwordx4 v20,s[8:11],s70 offen offset:256 sc1 lds
s_add_u32 m0,s50,143104
s_nop 0
buffer_load_dwordx4 v20,s[8:11],s71 offen offset:256 sc1 lds
s_add_u32 m0,s50,146944
s_nop 0
buffer_load_dwordx4 v20,s[8:11],s70 offen offset:512 sc1 lds
s_add_u32 m0,s50,151040
s_nop 0
buffer_load_dwordx4 v20,s[8:11],s71 offen offset:512 sc1 lds
s_lshl_b32 s59,s51,13
s_lshl2_add_u32 s59,s47,s59
s_add_u32 s59,s59,10487680
s_waitcnt vmcnt(0)
s_barrier
s_or_b32 s59,s59,s52
buffer_store_dword v17,off,s[8:11],s59 sc1
s_mov_b32 s72,0x80000000
s_mov_b32 s86,0
s_mov_b32 s19,1
s_mov_b32 s18,0
s_cmp_lt_u32 s31,64
s_cbranch_scc1 L_mo_377
L_mo_390:
s_mov_b32 s51,64
v_and_b32 v9,15,v1
v_lshrrev_b32 v10,4,v1
v_and_b32 v124,1,v1
v_lshlrev_b32 v124,4,v124
v_mov_b32 v125,0xffff
v_lshlrev_b32 v125,v124,v125
v_lshrrev_b32 v124,2,v9
v_cmp_eq_u32 vcc,0,v124
s_nop 1
v_cndmask_b32 v12,0,v125,vcc
v_cmp_eq_u32 vcc,1,v124
s_nop 1
v_cndmask_b32 v13,0,v125,vcc
v_and_b32 v124,2,v1
v_cmp_eq_u32 vcc,0,v124
v_mov_b32 v14,0xeeee
v_mov_b32 v124,0x4444
v_cndmask_b32 v14,v14,v124,vcc
v_lshlrev_b32 v11,14,v10
v_lshl_add_u32 v11,v9,4,v11
s_lshl_b32 s65,s51,15
s_add_u32 s65,s65,92274688
s_lshl_b32 s62,s47,10
s_add_u32 s62,s62,s65
s_lshl_b32 s63,s47,16
s_lshl_b32 s60,s46,8
s_add_u32 s63,s63,s60
s_mov_b32 s4,s38
s_mov_b32 s5,s39
s_mov_b32 s6,1835008
s_mov_b32 s7,0x20000
buffer_load_dwordx4 v[24:27],v11,s[4:7],s63 offen offset:0
buffer_load_dwordx4 v[28:31],v11,s[4:7],s63 offen offset:1024
buffer_load_dwordx4 v[32:35],v11,s[4:7],s63 offen offset:2048
buffer_load_dwordx4 v[36:39],v11,s[4:7],s63 offen offset:3072
s_add_u32 s63,s63,4096
buffer_load_dwordx4 v[40:43],v11,s[4:7],s63 offen offset:0
buffer_load_dwordx4 v[44:47],v11,s[4:7],s63 offen offset:1024
buffer_load_dwordx4 v[48:51],v11,s[4:7],s63 offen offset:2048
buffer_load_dwordx4 v[52:55],v11,s[4:7],s63 offen offset:3072
s_add_u32 s63,s63,4096
buffer_load_dwordx4 v[56:59],v11,s[4:7],s63 offen offset:0
buffer_load_dwordx4 v[60:63],v11,s[4:7],s63 offen offset:1024
buffer_load_dwordx4 v[64:67],v11,s[4:7],s63 offen offset:2048
buffer_load_dwordx4 v[68:71],v11,s[4:7],s63 offen offset:3072
s_add_u32 s63,s63,4096
buffer_load_dwordx4 v[72:75],v11,s[4:7],s63 offen offset:0
buffer_load_dwordx4 v[76:79],v11,s[4:7],s63 offen offset:1024
buffer_load_dwordx4 v[80:83],v11,s[4:7],s63 offen offset:2048
buffer_load_dwordx4 v[84:87],v11,s[4:7],s63 offen offset:3072
ds_read_b128 a[0:3],v18 offset:0
ds_read_b128 a[4:7],v18 offset:1024
ds_read_b128 a[8:11],v18 offset:2048
ds_read_b128 a[12:15],v18 offset:3072
ds_read_b128 a[16:19],v18 offset:4096
ds_read_b128 a[20:23],v18 offset:5120
ds_read_b128 a[24:27],v18 offset:6144
ds_read_b128 a[28:31],v18 offset:7168
ds_read_b128 a[32:35],v18 offset:8192
ds_read_b128 a[36:39],v18 offset:9216
ds_read_b128 a[40:43],v18 offset:10240
ds_read_b128 a[44:47],v18 offset:11264
ds_read_b128 a[48:51],v18 offset:12288
ds_read_b128 a[52:55],v18 offset:13312
ds_read_b128 a[56:59],v18 offset:14336
ds_read_b128 a[60:63],v18 offset:15360
ds_read_b128 a[64:67],v18 offset:16384
ds_read_b128 a[68:71],v18 offset:17408
ds_read_b128 a[72:75],v18 offset:18432
ds_read_b128 a[76:79],v18 offset:19456
ds_read_b128 a[80:83],v18 offset:20480
ds_read_b128 a[84:87],v18 offset:21504
ds_read_b128 a[88:91],v18 offset:22528
ds_read_b128 a[92:95],v18 offset:23552
ds_read_b128 a[96:99],v18 offset:24576
ds_read_b128 a[100:103],v18 offset:25600
ds_read_b128 a[104:107],v18 offset:26624
ds_read_b128 a[108:111],v18 offset:27648
ds_read_b128 a[112:115],v18 offset:28672
ds_read_b128 a[116:119],v18 offset:29696
ds_read_b128 a[120:123],v18 offset:30720
ds_read_b128 a[124:127],v18 offset:31744
s_and_b32 s61,s54,0x7ff
s_sub_u32 s61,2047,s61
s_lshr_b32 s61,s61,5
s_cmp_lg_u32 s46,0
s_cbranch_scc1 L_mw_401
s_mov_b32 s59,11018240
v_lshlrev_b32 v2,2,v1
L_fp_402:
s_sleep 2
buffer_load_dword v3,v2,s[8:11],s59 offen sc1
s_sub_u32 s49,s49,1
s_cbranch_scc1 L_abort2
s_waitcnt vmcnt(0)
v_cmp_eq_u32 vcc,0,v3
s_cbranch_vccnz L_fp_402
v_cmp_le_u32 vcc,s61,v1
s_nop 1
v_cndmask_b32 v2,1,2,vcc
v_cmp_ne_u32 s[84:85],v2,v3
s_lshl_b32 s56,s47,1
s_lshr_b64 s[20:21],s[84:85],s56
v_lshrrev_b32 v2,5,v1
v_lshrrev_b32 v3,v2,s20
v_and_b32 v3,1,v3
v_mul_u32_u24 v3,768,v3
v_lshlrev_b32 v2,13,v2
v_sub_u32 v2,v2,v3
v_and_b32 v3,31,v1
v_lshl_add_u32 v2,v3,2,v2
v_add_u32 v2,1536,v2
s_lshl_b32 s59,s47,14
s_add_u32 s59,s59,10485760
v_mov_b32 v3,1
s_cmp_ge_u32 s47,28
s_cbranch_scc1 L_mf_403
L_fp_409:
s_sleep 1
buffer_load_dword v3,v2,s[8:11],s59 offen sc1
s_sub_u32 s49,s49,1
s_cbranch_scc1 L_abort2
s_waitcnt vmcnt(0)
v_cmp_eq_u32 vcc,0,v3
s_cbranch_vccnz L_fp_409
v_max_u32_dpp v3,v3,v3 row_ror:8 row_mask:0xf bank_mask:0xf
s_nop 1
v_max_u32_dpp v3,v3,v3 row_ror:4 row_mask:0xf bank_mask:0xf
s_nop 1
v_max_u32_dpp v3,v3,v3 row_ror:2 row_mask:0xf bank_mask:0xf
s_nop 1
v_max_u32_dpp v3,v3,v3 row_ror:1 row_mask:0xf bank_mask:0xf
v_mov_b32 v2,v3
s_nop 1
v_permlane16_swap_b32 v3,v2
v_max_u32 v3,v3,v2
v_mov_b32 v2,v3
s_nop 1
v_permlane32_swap_b32 v3,v2
v_max_u32 v3,v3,v2
L_mf_403:
s_lshl_b32 s59,s51,13
s_lshl2_add_u32 s59,s47,s59
s_add_u32 s59,s59,10487424
buffer_store_dword v3,off,s[8:11],s59 sc1
L_mw_401:
s_barrier
s_lshl_b32 s59,s51,13
s_add_u32 s59,s59,10487424
v_and_b32 v124,31,v1
v_lshlrev_b32 v124,2,v124
s_branch L_ff_412
L_fw_410:
s_sleep 1
L_ff_412:
buffer_load_dword v125,v124,s[8:11],s59 offen sc1
s_sub_u32 s49,s49,1
s_cbranch_scc1 L_abort2
s_waitcnt vmcnt(0)
v_cmp_eq_u32 vcc,0,v125
s_cbranch_vccnz L_fw_410
v_max_u32_dpp v125,v125,v125 row_ror:8 row_mask:0xf bank_mask:0xf
s_nop 1
v_max_u32_dpp v125,v125,v125 row_ror:4 row_mask:0xf bank_mask:0xf
s_nop 1
v_max_u32_dpp v125,v125,v125 row_ror:2 row_mask:0xf bank_mask:0xf
s_nop 1
v_max_u32_dpp v125,v125,v125 row_ror:1 row_mask:0xf bank_mask:0xf
v_mov_b32 v124,v125
s_nop 1
v_permlane16_swap_b32 v125,v124
v_max_u32 v125,v125,v124
v_mov_b32 v124,v125
s_nop 1
v_permlane32_swap_b32 v125,v124
v_max_u32 v125,v125,v124
s_nop 0
v_readfirstlane_b32 s55,v125
L_mf_404:
s_andn2_b32 s64,0x7ff,s55
s_lshl_b32 s56,s64,10
s_add_u32 s58,s56,6291456
buffer_load_dwordx4 v[88:91],v0,s[8:11],s58 offen sc1
s_lshl_b32 s57,s46,11
s_add_u32 s57,s57,139264
v_add_u32 v8,s57,v0
v_and_b32 v2,1,v10
v_lshrrev_b32 v3,1,v10
v_lshlrev_b32 v2,7,v2
v_lshl_add_u32 v2,v3,10,v2
s_lshl_b32 s59,s46,8
s_add_u32 s59,s57,s59
v_add_u32 v2,s59,v2
s_mov_b32 s60,0x01000100
s_mov_b32 s61,0x03020302
s_waitcnt vmcnt(0)
v_lshlrev_b32 v96,16,v88
v_and_b32 v97,0xffff0000,v88
v_lshlrev_b32 v98,16,v89
v_and_b32 v99,0xffff0000,v89
v_lshlrev_b32 v100,16,v90
v_and_b32 v101,0xffff0000,v90
v_lshlrev_b32 v102,16,v91
v_and_b32 v103,0xffff0000,v91
v_readfirstlane_b32 s78,v96
s_nop 1
v_pk_add_f32 v[108:109],v[96:97],s[78:79] op_sel_hi:[1,0] neg_lo:[0,1] neg_hi:[0,1]
v_pk_add_f32 v[110:111],v[98:99],s[78:79] op_sel_hi:[1,0] neg_lo:[0,1] neg_hi:[0,1]
v_pk_add_f32 v[112:113],v[100:101],s[78:79] op_sel_hi:[1,0] neg_lo:[0,1] neg_hi:[0,1]
v_pk_add_f32 v[114:115],v[102:103],s[78:79] op_sel_hi:[1,0] neg_lo:[0,1] neg_hi:[0,1]
v_pk_add_f32 v[116:117],v[108:109],v[110:111]
v_pk_mul_f32 v[118:119],v[108:109],v[108:109]
v_pk_add_f32 v[120:121],v[112:113],v[114:115]
v_pk_fma_f32 v[118:119],v[110:111],v[110:111],v[118:119]
v_pk_add_f32 v[116:117],v[116:117],v[120:121]
v_pk_fma_f32 v[118:119],v[112:113],v[112:113],v[118:119]
v_add_f32 v116,v116,v117
v_pk_fma_f32 v[118:119],v[114:115],v[114:115],v[118:119]
v_add_f32 v118,v118,v119
s_nop 1
v_permlane32_swap_b32 v116,v118
v_add_f32 v116,v116,v118
s_nop 1
v_add_f32_dpp v116,v116,v116 row_ror:8 row_mask:0xf bank_mask:0xf
s_nop 1
v_add_f32_dpp v116,v116,v116 row_ror:4 row_mask:0xf bank_mask:0xf
s_nop 1
v_add_f32_dpp v116,v116,v116 row_ror:2 row_mask:0xf bank_mask:0xf
s_nop 1
v_add_f32_dpp v116,v116,v116 row_ror:1 row_mask:0xf bank_mask:0xf
v_mov_b32 v118,v116
s_nop 1
v_permlane16_swap_b32 v116,v118
v_add_f32 v116,v116,v118
v_mul_f32 v116,0x3b000000,v116
v_mov_b32 v118,v116
s_nop 1
v_permlane32_swap_b32 v116,v118
v_fma_f32 v118,-v116,v116,v118
v_add_f32 v116,s78,v116
v_max_f32 v118,0,v118
v_cvt_pk_bf16_f32 v118,v116,v118
v_lshlrev_b32 v116,16,v118
v_and_b32 v118,0xffff0000,v118
v_add_f32 v118,0x3727c5ac,v118
v_cvt_pk_bf16_f32 v118,v118,v118
v_and_b32 v118,0xffff0000,v118
v_sqrt_f32 v118,v118
v_pk_add_f32 v[108:109],v[96:97],v[116:117] op_sel_hi:[1,0] neg_lo:[0,1] neg_hi:[0,1]
v_pk_add_f32 v[110:111],v[98:99],v[116:117] op_sel_hi:[1,0] neg_lo:[0,1] neg_hi:[0,1]
v_pk_add_f32 v[112:113],v[100:101],v[116:117] op_sel_hi:[1,0] neg_lo:[0,1] neg_hi:[0,1]
v_pk_add_f32 v[114:115],v[102:103],v[116:117] op_sel_hi:[1,0] neg_lo:[0,1] neg_hi:[0,1]
v_cvt_pk_bf16_f32 v118,v118,v118
v_and_b32 v118,0xffff0000,v118
v_rcp_f32 v118,v118
v_cvt_pk_bf16_f32 v104,v108,v109
v_cvt_pk_bf16_f32 v105,v110,v111
v_cvt_pk_bf16_f32 v106,v112,v113
v_cvt_pk_bf16_f32 v107,v114,v115
v_lshlrev_b32 v108,16,v104
v_and_b32 v109,0xffff0000,v104
v_lshlrev_b32 v110,16,v105
v_and_b32 v111,0xffff0000,v105
v_lshlrev_b32 v112,16,v106
v_and_b32 v113,0xffff0000,v106
v_lshlrev_b32 v114,16,v107
v_and_b32 v115,0xffff0000,v107
v_pk_mul_f32 v[108:109],v[108:109],v[118:119] op_sel_hi:[1,0]
v_pk_mul_f32 v[110:111],v[110:111],v[118:119] op_sel_hi:[1,0]
v_pk_mul_f32 v[112:113],v[112:113],v[118:119] op_sel_hi:[1,0]
v_pk_mul_f32 v[114:115],v[114:115],v[118:119] op_sel_hi:[1,0]
v_cvt_pk_bf16_f32 v104,v108,v109
v_cvt_pk_bf16_f32 v105,v110,v111
v_cvt_pk_bf16_f32 v106,v112,v113
v_cvt_pk_bf16_f32 v107,v114,v115
v_perm_b32 v88,v104,v104,s60
v_perm_b32 v89,v105,v105,s60
v_perm_b32 v90,v106,v106,s60
v_perm_b32 v91,v107,v107,s60
ds_write_b128 v8,v[88:91]
v_perm_b32 v92,v104,v104,s61
v_perm_b32 v93,v105,v105,s61
v_perm_b32 v94,v106,v106,s61
v_perm_b32 v95,v107,v107,s61
ds_write_b128 v8,v[92:95] offset:1024
s_mov_b32 s58,s57
ds_read_b128 v[128:131],v2 offset:0
ds_read_b128 v[144:147],v2 offset:64
ds_read_b128 v[132:135],v2 offset:16
ds_read_b128 v[148:151],v2 offset:80
ds_read_b128 v[136:139],v2 offset:32
ds_read_b128 v[152:155],v2 offset:96
ds_read_b128 v[140:143],v2 offset:48
ds_read_b128 v[156:159],v2 offset:112
v_mov_b64 v[116:117],0
v_mov_b64 v[118:119],0
s_waitcnt lgkmcnt(6)
v_and_b32 v120,v12,v128
v_and_b32 v121,v13,v128
v_and_b32 v122,v12,v144
v_and_b32 v123,v13,v144
v_and_b32 v124,v12,v129
v_and_b32 v125,v13,v129
v_smfmac_f32_16x16x64_bf16 v[116:119],v[120:123],a[0:7],v14
v_and_b32 v126,v12,v145
v_and_b32 v127,v13,v145
v_and_b32 v120,v12,v130
v_and_b32 v121,v13,v130
v_smfmac_f32_16x16x64_bf16 v[116:119],v[124:127],a[8:15],v14
v_and_b32 v122,v12,v146
v_and_b32 v123,v13,v146
v_and_b32 v124,v12,v131
v_and_b32 v125,v13,v131
v_smfmac_f32_16x16x64_bf16 v[116:119],v[120:123],a[16:23],v14
v_and_b32 v126,v12,v147
v_and_b32 v127,v13,v147
s_waitcnt lgkmcnt(4)
v_and_b32 v120,v12,v132
v_and_b32 v121,v13,v132
v_smfmac_f32_16x16x64_bf16 v[116:119],v[124:127],a[24:31],v14
v_and_b32 v122,v12,v148
v_and_b32 v123,v13,v148
v_and_b32 v124,v12,v133
v_and_b32 v125,v13,v133
v_smfmac_f32_16x16x64_bf16 v[116:119],v[120:123],a[32:39],v14
v_and_b32 v126,v12,v149
v_and_b32 v127,v13,v149
v_and_b32 v120,v12,v134
v_and_b32 v121,v13,v134
v_smfmac_f32_16x16x64_bf16 v[116:119],v[124:127],a[40:47],v14
v_and_b32 v122,v12,v150
v_and_b32 v123,v13,v150
v_and_b32 v124,v12,v135
v_and_b32 v125,v13,v135
v_smfmac_f32_16x16x64_bf16 v[116:119],v[120:123],a[48:55],v14
v_and_b32 v126,v12,v151
v_and_b32 v127,v13,v151
s_waitcnt lgkmcnt(2)
v_and_b32 v120,v12,v136
v_and_b32 v121,v13,v136
v_smfmac_f32_16x16x64_bf16 v[116:119],v[124:127],a[56:63],v14
v_and_b32 v122,v12,v152
v_and_b32 v123,v13,v152
v_and_b32 v124,v12,v137
v_and_b32 v125,v13,v137
v_smfmac_f32_16x16x64_bf16 v[116:119],v[120:123],a[64:71],v14
v_and_b32 v126,v12,v153
v_and_b32 v127,v13,v153
v_and_b32 v120,v12,v138
v_and_b32 v121,v13,v138
v_smfmac_f32_16x16x64_bf16 v[116:119],v[124:127],a[72:79],v14
v_and_b32 v122,v12,v154
v_and_b32 v123,v13,v154
v_and_b32 v124,v12,v139
v_and_b32 v125,v13,v139
v_smfmac_f32_16x16x64_bf16 v[116:119],v[120:123],a[80:87],v14
v_and_b32 v126,v12,v155
v_and_b32 v127,v13,v155
s_waitcnt lgkmcnt(0)
v_and_b32 v120,v12,v140
v_and_b32 v121,v13,v140
v_smfmac_f32_16x16x64_bf16 v[116:119],v[124:127],a[88:95],v14
v_and_b32 v122,v12,v156
v_and_b32 v123,v13,v156
v_and_b32 v124,v12,v141
v_and_b32 v125,v13,v141
v_smfmac_f32_16x16x64_bf16 v[116:119],v[120:123],a[96:103],v14
v_and_b32 v126,v12,v157
v_and_b32 v127,v13,v157
v_and_b32 v120,v12,v142
v_and_b32 v121,v13,v142
v_smfmac_f32_16x16x64_bf16 v[116:119],v[124:127],a[104:111],v14
v_and_b32 v122,v12,v158
v_and_b32 v123,v13,v158
v_and_b32 v124,v12,v143
v_and_b32 v125,v13,v143
v_smfmac_f32_16x16x64_bf16 v[116:119],v[120:123],a[112:119],v14
v_and_b32 v126,v12,v159
v_and_b32 v127,v13,v159
s_nop 1
v_smfmac_f32_16x16x64_bf16 v[116:119],v[124:127],a[120:127],v14
v_lshlrev_b32 v8,5,v9
v_and_b32 v124,1,v10
v_lshl_add_u32 v8,v124,4,v8
v_lshrrev_b32 v124,1,v10
v_lshl_add_u32 v8,v124,11,v8
s_lshl_b32 s60,s46,9
s_add_u32 s60,s60,147456
v_add_u32 v8,s60,v8
ds_write_b128 v8,v[116:119]
v_lshlrev_b32 v8,2,v1
v_add_u32 v8,147456,v8
v_and_b32 v2,1,v1
v_lshrrev_b32 v3,1,v1
v_lshlrev_b32 v3,2,v3
v_lshl_add_u32 v2,v2,7,v3
v_add_u32 v2,s58,v2
v_lshlrev_b32 v3,6,v10
v_add_u32 v3,s58,v3
s_waitcnt lgkmcnt(0)
s_barrier
ds_read2st64_b32 v[88:89],v8 offset0:0 offset1:1
ds_read2st64_b32 v[90:91],v8 offset0:2 offset1:3
ds_read2st64_b32 v[92:93],v8 offset0:4 offset1:5
ds_read2st64_b32 v[94:95],v8 offset0:6 offset1:7
s_waitcnt lgkmcnt(0)
v_pk_add_f32 v[88:89],v[88:89],v[90:91]
v_pk_add_f32 v[92:93],v[92:93],v[94:95]
v_pk_add_f32 v[88:89],v[88:89],v[92:93]
v_cvt_pk_bf16_f32 v88,v88,v88
v_and_b32 v88,0xffff0000,v88
v_cvt_pk_bf16_f32 v89,v89,v89
v_and_b32 v89,0xffff0000,v89
v_mul_f32 v90,0xbfb8aa3b,v88
v_exp_f32 v90,v90
s_nop 0
v_add_f32 v90,1.0,v90
v_rcp_f32 v90,v90
s_nop 0
v_mul_f32 v88,v88,v90
v_cvt_pk_bf16_f32 v88,v88,v88
v_and_b32 v88,0xffff0000,v88
v_mul_f32 v88,v88,v89
v_cvt_pk_bf16_f32 v88,v88,v88
ds_write_b32 v2,v88
ds_read_b128 v[88:91],v3
ds_read_b128 v[108:111],v3 offset:32
ds_read_b128 v[92:95],v3 offset:16
ds_read_b128 v[112:115],v3 offset:48
v_mov_b64 v[116:117],0
v_mov_b64 v[118:119],0
s_waitcnt vmcnt(0) lgkmcnt(0)
v_and_b32 v120,v12,v88
v_and_b32 v121,v13,v88
v_and_b32 v122,v12,v108
v_and_b32 v123,v13,v108
v_and_b32 v124,v12,v89
v_and_b32 v125,v13,v89
v_smfmac_f32_16x16x64_bf16 v[116:119],v[120:123],v[24:31],v14
v_and_b32 v126,v12,v109
v_and_b32 v127,v13,v109
v_and_b32 v120,v12,v90
v_and_b32 v121,v13,v90
v_smfmac_f32_16x16x64_bf16 v[116:119],v[124:127],v[32:39],v14
v_and_b32 v122,v12,v110
v_and_b32 v123,v13,v110
v_and_b32 v124,v12,v91
v_and_b32 v125,v13,v91
v_smfmac_f32_16x16x64_bf16 v[116:119],v[120:123],v[40:47],v14
v_and_b32 v126,v12,v111
v_and_b32 v127,v13,v111
v_and_b32 v120,v12,v92
v_and_b32 v121,v13,v92
v_smfmac_f32_16x16x64_bf16 v[116:119],v[124:127],v[48:55],v14
v_and_b32 v122,v12,v112
v_and_b32 v123,v13,v112
v_and_b32 v124,v12,v93
v_and_b32 v125,v13,v93
v_smfmac_f32_16x16x64_bf16 v[116:119],v[120:123],v[56:63],v14
v_and_b32 v126,v12,v113
v_and_b32 v127,v13,v113
v_and_b32 v120,v12,v94
v_and_b32 v121,v13,v94
v_smfmac_f32_16x16x64_bf16 v[116:119],v[124:127],v[64:71],v14
v_and_b32 v122,v12,v114
v_and_b32 v123,v13,v114
v_and_b32 v124,v12,v95
v_and_b32 v125,v13,v95
v_smfmac_f32_16x16x64_bf16 v[116:119],v[120:123],v[72:79],v14
v_and_b32 v126,v12,v115
v_and_b32 v127,v13,v115
s_nop 1
v_smfmac_f32_16x16x64_bf16 v[116:119],v[124:127],v[80:87],v14
v_lshlrev_b32 v8,4,v9
v_and_b32 v124,1,v10
v_lshl_add_u32 v8,v124,3,v8
v_and_b32 v124,2,v10
v_lshl_add_u32 v8,v124,30,v8
s_lshl_b32 s60,s46,8
s_add_u32 s59,s62,s60
s_nop 0
v_cvt_pk_bf16_f32 v24,v116,v117
v_cvt_pk_bf16_f32 v25,v118,v119
buffer_store_dwordx2 v[24:25],v8,s[8:11],s59 offen sc1
s_lshl_b32 s59,s51,13
s_lshl2_add_u32 s59,s47,s59
s_add_u32 s59,s59,10486912
s_waitcnt vmcnt(0)
s_barrier
s_or_b32 s59,s59,s52
buffer_store_dword v17,off,s[8:11],s59 sc1
s_cmp_lg_u32 s47,0
s_cbranch_scc1 L_moed_413
s_lshl_b32 s59,s51,13
s_add_u32 s59,s59,10486912
v_and_b32 v124,31,v1
v_lshlrev_b32 v124,2,v124
L_fw_414:
buffer_load_dword v125,v124,s[8:11],s59 offen sc1
s_sub_u32 s49,s49,1
s_cbranch_scc1 L_abort2
s_waitcnt vmcnt(0)
v_cmp_eq_u32 vcc,0,v125
s_cbranch_vccnz L_fw_414
s_add_u32 s63,s65,0
buffer_load_dwordx4 v[24:27],v22,s[8:11],s63 offen sc1
s_add_u32 s63,s65,4096
buffer_load_dwordx4 v[28:31],v22,s[8:11],s63 offen sc1
s_add_u32 s63,s65,8192
buffer_load_dwordx4 v[32:35],v22,s[8:11],s63 offen sc1
s_add_u32 s63,s65,12288
buffer_load_dwordx4 v[36:39],v22,s[8:11],s63 offen sc1
s_add_u32 s63,s65,16384
buffer_load_dwordx4 v[40:43],v22,s[8:11],s63 offen sc1
s_add_u32 s63,s65,20480
buffer_load_dwordx4 v[44:47],v22,s[8:11],s63 offen sc1
s_add_u32 s63,s65,24576
buffer_load_dwordx4 v[48:51],v22,s[8:11],s63 offen sc1
s_add_u32 s63,s65,28672
buffer_load_dwordx4 v[52:55],v22,s[8:11],s63 offen sc1
v_and_b32 v64,15,v1
v_and_b32 v65,1,v1
v_lshlrev_b32 v65,4,v65
v_mov_b32 v66,0x3f80
v_lshlrev_b32 v66,v65,v66
v_lshrrev_b32 v64,1,v64
v_cmp_eq_u32 vcc,0,v64
s_nop 1
v_cndmask_b32 v56,0,v66,vcc
v_cmp_eq_u32 vcc,1,v64
s_nop 1
v_cndmask_b32 v57,0,v66,vcc
v_cmp_eq_u32 vcc,2,v64
s_nop 1
v_cndmask_b32 v58,0,v66,vcc
v_cmp_eq_u32 vcc,3,v64
s_nop 1
v_cndmask_b32 v59,0,v66,vcc
s_waitcnt vmcnt(7)
s_nop 0
v_mfma_f32_16x16x32_bf16 v[60:63],v[56:59],v[24:27],0
s_waitcnt vmcnt(6)
v_mfma_f32_16x16x32_bf16 v[60:63],v[56:59],v[28:31],v[60:63]
s_waitcnt vmcnt(5)
v_mfma_f32_16x16x32_bf16 v[60:63],v[56:59],v[32:35],v[60:63]
s_waitcnt vmcnt(4)
v_mfma_f32_16x16x32_bf16 v[60:63],v[56:59],v[36:39],v[60:63]
s_waitcnt vmcnt(3)
v_mfma_f32_16x16x32_bf16 v[60:63],v[56:59],v[40:43],v[60:63]
s_waitcnt vmcnt(2)
v_mfma_f32_16x16x32_bf16 v[60:63],v[56:59],v[44:47],v[60:63]
s_waitcnt vmcnt(1)
v_mfma_f32_16x16x32_bf16 v[60:63],v[56:59],v[48:51],v[60:63]
s_waitcnt vmcnt(0)
v_mfma_f32_16x16x32_bf16 v[60:63],v[56:59],v[52:55],v[60:63]
s_nop 7
ds_write_b128 v21,v[60:63]
s_waitcnt lgkmcnt(0)
s_barrier
s_cmp_lg_u32 s46,0
s_cbranch_scc1 L_moed_413
v_lshlrev_b32 v56,5,v1
v_add_u32 v56,155648,v56
ds_read_b128 v[24:27],v56
ds_read_b128 v[28:31],v56 offset:16
s_and_b32 s59,s55,0xffff0000
s_xor_b32 s60,s59,0x80000000
s_xor_b32 s61,s59,0xffff0000
s_cmp_lt_i32 s59,0
s_cselect_b32 s59,s60,s61
v_mov_b32 v56,s59
v_mul_f32 v56,0xbfb8aa3b,v56
v_exp_f32 v56,v56
s_nop 0
v_add_f32 v56,1.0,v56
v_rcp_f32 v56,v56
s_nop 0
v_cvt_pk_bf16_f32 v56,v56,v56
v_and_b32 v56,0xffff0000,v56
v_lshlrev_b32 v48,16,v104
v_and_b32 v49,0xffff0000,v104
v_lshlrev_b32 v50,16,v105
v_and_b32 v51,0xffff0000,v105
v_lshlrev_b32 v52,16,v106
v_and_b32 v53,0xffff0000,v106
v_lshlrev_b32 v54,16,v107
v_and_b32 v55,0xffff0000,v107
s_waitcnt lgkmcnt(0)
v_cvt_pk_bf16_f32 v40,v24,v25
v_cvt_pk_bf16_f32 v41,v26,v27
v_cvt_pk_bf16_f32 v42,v28,v29
v_cvt_pk_bf16_f32 v43,v30,v31
v_lshlrev_b32 v24,16,v40
v_and_b32 v25,0xffff0000,v40
v_lshlrev_b32 v26,16,v41
v_and_b32 v27,0xffff0000,v41
v_lshlrev_b32 v28,16,v42
v_and_b32 v29,0xffff0000,v42
v_lshlrev_b32 v30,16,v43
v_and_b32 v31,0xffff0000,v43
v_pk_mul_f32 v[24:25],v[24:25],v[56:57] op_sel_hi:[1,0]
v_pk_mul_f32 v[26:27],v[26:27],v[56:57] op_sel_hi:[1,0]
v_pk_mul_f32 v[28:29],v[28:29],v[56:57] op_sel_hi:[1,0]
v_pk_mul_f32 v[30:31],v[30:31],v[56:57] op_sel_hi:[1,0]
v_cvt_pk_bf16_f32 v40,v24,v25
v_cvt_pk_bf16_f32 v41,v26,v27
v_cvt_pk_bf16_f32 v42,v28,v29
v_cvt_pk_bf16_f32 v43,v30,v31
v_lshlrev_b32 v24,16,v40
v_and_b32 v25,0xffff0000,v40
v_lshlrev_b32 v26,16,v41
v_and_b32 v27,0xffff0000,v41
v_lshlrev_b32 v28,16,v42
v_and_b32 v29,0xffff0000,v42
v_lshlrev_b32 v30,16,v43
v_and_b32 v31,0xffff0000,v43
v_pk_add_f32 v[24:25],v[24:25],v[48:49]
v_pk_add_f32 v[26:27],v[26:27],v[50:51]
v_pk_add_f32 v[28:29],v[28:29],v[52:53]
v_pk_add_f32 v[30:31],v[30:31],v[54:55]
v_cvt_pk_bf16_f32 v40,v24,v25
v_cvt_pk_bf16_f32 v41,v26,v27
v_cvt_pk_bf16_f32 v42,v28,v29
v_cvt_pk_bf16_f32 v43,v30,v31
v_lshlrev_b32 v24,16,v40
v_and_b32 v25,0xffff0000,v40
v_lshlrev_b32 v26,16,v41
v_and_b32 v27,0xffff0000,v41
v_lshlrev_b32 v28,16,v42
v_and_b32 v29,0xffff0000,v42
v_lshlrev_b32 v30,16,v43
v_and_b32 v31,0xffff0000,v43
v_pk_add_f32 v[96:97],v[96:97],v[24:25]
v_pk_add_f32 v[98:99],v[98:99],v[26:27]
v_pk_add_f32 v[100:101],v[100:101],v[28:29]
v_pk_add_f32 v[102:103],v[102:103],v[30:31]
v_cvt_pk_bf16_f32 v160,v96,v97
v_cvt_pk_bf16_f32 v161,v98,v99
v_cvt_pk_bf16_f32 v162,v100,v101
v_cvt_pk_bf16_f32 v163,v102,v103
L_moed_413:
s_or_b32 s61,s47,s46
s_cselect_b32 s61,1,0
s_add_u32 s51,s51,1
s_lshl1_add_u32 s61,s51,s61
s_cmp_gt_u32 s61,132
s_cbranch_scc1 L_mf_408
s_cmp_eq_u32 s61,132
s_cbranch_scc1 L_mf_406
v_and_b32 v9,15,v1
v_lshrrev_b32 v10,4,v1
v_and_b32 v124,1,v1
v_lshlrev_b32 v124,4,v124
v_mov_b32 v125,0xffff
v_lshlrev_b32 v125,v124,v125
v_lshrrev_b32 v124,2,v9
v_cmp_eq_u32 vcc,0,v124
s_nop 1
v_cndmask_b32 v12,0,v125,vcc
v_cmp_eq_u32 vcc,1,v124
s_nop 1
v_cndmask_b32 v13,0,v125,vcc
v_and_b32 v124,2,v1
v_cmp_eq_u32 vcc,0,v124
v_mov_b32 v14,0xeeee
v_mov_b32 v124,0x4444
v_cndmask_b32 v14,v14,v124,vcc
v_lshlrev_b32 v11,14,v10
v_lshl_add_u32 v11,v9,4,v11
s_lshl_b32 s65,s51,15
s_add_u32 s65,s65,92274688
s_lshl_b32 s62,s47,10
s_add_u32 s62,s62,s65
s_lshl_b32 s63,s47,16
s_lshl_b32 s60,s46,8
s_add_u32 s63,s63,s60
s_mov_b32 s4,s38
s_mov_b32 s5,s39
s_mov_b32 s6,1835008
s_mov_b32 s7,0x20000
buffer_load_dwordx4 v[24:27],v11,s[4:7],s63 offen offset:0
buffer_load_dwordx4 v[28:31],v11,s[4:7],s63 offen offset:1024
buffer_load_dwordx4 v[32:35],v11,s[4:7],s63 offen offset:2048
buffer_load_dwordx4 v[36:39],v11,s[4:7],s63 offen offset:3072
s_add_u32 s63,s63,4096
buffer_load_dwordx4 v[40:43],v11,s[4:7],s63 offen offset:0
buffer_load_dwordx4 v[44:47],v11,s[4:7],s63 offen offset:1024
buffer_load_dwordx4 v[48:51],v11,s[4:7],s63 offen offset:2048
buffer_load_dwordx4 v[52:55],v11,s[4:7],s63 offen offset:3072
s_add_u32 s63,s63,4096
buffer_load_dwordx4 v[56:59],v11,s[4:7],s63 offen offset:0
buffer_load_dwordx4 v[60:63],v11,s[4:7],s63 offen offset:1024
buffer_load_dwordx4 v[64:67],v11,s[4:7],s63 offen offset:2048
buffer_load_dwordx4 v[68:71],v11,s[4:7],s63 offen offset:3072
s_add_u32 s63,s63,4096
buffer_load_dwordx4 v[72:75],v11,s[4:7],s63 offen offset:0
buffer_load_dwordx4 v[76:79],v11,s[4:7],s63 offen offset:1024
buffer_load_dwordx4 v[80:83],v11,s[4:7],s63 offen offset:2048
buffer_load_dwordx4 v[84:87],v11,s[4:7],s63 offen offset:3072
s_cmp_eq_u32 s61,131
s_cbranch_scc1 L_mf_407
v_lshrrev_b32 v2,3,v1
s_lshr_b32 s20,s85,24
v_lshrrev_b32 v3,v2,s20
v_and_b32 v3,1,v3
v_mul_u32_u24 v3,768,v3
v_lshlrev_b32 v2,13,v2
v_sub_u32 v2,v2,v3
v_and_b32 v3,0x70,v0
v_add_u32 v2,v2,v3
v_add_u32 v2,1536,v2
s_mov_b32 s59,10944512
L_mf_405:
buffer_load_dwordx4 v[164:167],v2,s[8:11],s59 offen sc1
s_sub_u32 s49,s49,1
s_cbranch_scc1 L_abort2
s_waitcnt vmcnt(0)
v_min3_u32 v168,v164,v165,v166
v_min_u32 v168,v167,v168
v_cmp_eq_u32 vcc,0,v168
s_cbranch_vccnz L_mf_405
v_max3_u32 v168,v164,v165,v166
v_max3_u32 v168,v167,v168,s55
v_cmp_lt_u32 vcc,s55,v168
s_mov_b32 s59,11019904
s_cbranch_vccz L_mf_406
v_max_u32_dpp v168,v168,v168 row_ror:8 row_mask:0xf bank_mask:0xf
s_nop 1
v_max_u32_dpp v168,v168,v168 row_ror:4 row_mask:0xf bank_mask:0xf
s_nop 1
v_max_u32_dpp v168,v168,v168 row_ror:2 row_mask:0xf bank_mask:0xf
s_nop 1
v_max_u32_dpp v168,v168,v168 row_ror:1 row_mask:0xf bank_mask:0xf
v_mov_b32 v169,v168
s_nop 1
v_permlane16_swap_b32 v168,v169
v_max_u32 v168,v168,v169
v_mov_b32 v169,v168
s_nop 1
v_permlane32_swap_b32 v168,v169
v_max_u32 v168,v168,v169
buffer_store_dword v168,off,s[8:11],s59 sc1
s_branch L_mf_407
L_mf_406:
s_mov_b32 s4,s40
s_mov_b32 s5,s41
s_mov_b32 s6,2097152
s_mov_b32 s7,0x20000
buffer_store_dwordx4 v[160:163],v0,s[4:7],s56 offen sc1
v_mov_b32 v168,s55
s_mov_b32 s59,11019904
buffer_store_dword v168,off,s[8:11],s59 sc1
s_endpgm
L_mf_407:
s_mov_b32 s59,11019904
L_ww_417:
s_sleep 1
buffer_load_dword v2,off,s[8:11],s59 sc1
s_sub_u32 s49,s49,1
s_cbranch_scc1 L_abort2
s_waitcnt vmcnt(0)
v_readfirstlane_b32 s61,v2
s_cmp_eq_u32 s61,0
s_cbranch_scc1 L_ww_417
L_wwd_418:
s_cmp_eq_u32 s61,s55
s_cbranch_scc1 L_mf_408
s_mov_b32 s55,s61
s_barrier
s_branch L_mf_404
L_mf_408:
s_waitcnt vmcnt(0)
s_endpgm
.section .rodata,"a"
.p2align 6
.amdhsa_kernel interleave_layers__memory_aug_recurrent_mem_tr__moe_arch_mod__prompt_kernel
  .amdhsa_next_free_vgpr 512
  .amdhsa_next_free_sgpr 102
  .amdhsa_accum_offset 256
  .amdhsa_group_segment_fixed_size 0
  .amdhsa_kernarg_size 120
  .amdhsa_user_sgpr_count 2
  .amdhsa_user_sgpr_kernarg_segment_ptr 1
  .amdhsa_system_sgpr_workgroup_id_x 1
  .amdhsa_float_denorm_mode_32 3
.end_amdhsa_kernel
```

```asm
; @launch grid=(256,1,1) block=(256,1,1) lds=163840
.amdgcn_target "amdgcn-amd-amdhsa--gfx950"
.text
.globl interleave_layers__memory_aug_recurrent_mem_tr__moe_arch_mod__prompt_kernel
.p2align 8
.type interleave_layers__memory_aug_recurrent_mem_tr__moe_arch_mod__prompt_kernel,@function
interleave_layers__memory_aug_recurrent_mem_tr__moe_arch_mod__prompt_kernel:
s_cmp_ge_u32 s2,256
s_cbranch_scc1 L_abort
s_load_dwordx16 s[16:31],s[0:1],0
s_load_dwordx8 s[32:39],s[0:1],64
s_load_dwordx4 s[40:43],s[0:1],96
s_load_dwordx2 s[44:45],s[0:1],112
v_lshrrev_b32 v2,6,v0
v_and_b32 v1,63,v0
v_readfirstlane_b32 s46,v2
v_lshlrev_b32 v0,4,v1
s_getreg_b32 s48,hwreg(HW_REG_XCC_ID)
s_and_b32 s48,s48,7
s_mov_b32 s49,100000
s_mov_b32 s80,0x3e0293ee
s_waitcnt lgkmcnt(0)
s_mov_b32 s8,s44
s_mov_b32 s9,s45
s_mov_b32 s10,268435456
s_mov_b32 s11,0x20000
s_mov_b32 s12,s42
s_mov_b32 s13,s43
s_mov_b32 s14,256
s_mov_b32 s15,0x20000
s_cmp_lg_u32 s46,0
s_cbranch_scc1 L_tk_1
s_lshl_b32 s56,s48,2
v_mov_b32 v14,s56
v_mov_b32 v15,1
s_or_b32 s56,s48,8
v_mov_b32 v16,s56
v_mov_b32 v17,0
s_mov_b64 exec,1
buffer_atomic_cmpswap v[16:17],off,s[12:15],0 offset:192 sc0
buffer_atomic_add v15,v14,s[12:15],0 offen sc0
s_mov_b64 exec,-1
L_tk_1:
s_mov_b32 s4,s16
s_mov_b32 s5,s17
s_mov_b32 s6,2097152
s_mov_b32 s7,0x20000
s_lshl_b32 s56,s2,3
s_lshl_b32 s59,s46,1
s_add_u32 s56,s56,s59
s_lshl_b32 s59,s56,10
buffer_load_dwordx4 v[24:27],v0,s[4:7],s59 offen
buffer_load_dwordx4 v[28:31],v0,s[4:7],s59 offen offset:1024
s_lshl_b32 s56,s2,12
s_lshl_b32 s57,s46,10
s_add_u32 s56,s56,s57
v_add_u32 v2,s56,v0
v_mov_b32 v4,-1
v_mov_b32 v5,-1
v_mov_b32 v6,-1
v_mov_b32 v7,-1
v_mov_b32 v8,0
v_mov_b32 v9,0
v_mov_b32 v10,0
v_mov_b32 v11,0
v_cmp_gt_u32 vcc,524288,v2
v_mov_b32 v3,14155776
v_mov_b32 v12,11542528
v_cndmask_b32 v3,v3,v12,vcc
v_add_u32 v3,v3,v2
s_mov_b32 s56,0
buffer_store_dwordx4 v[4:7],v3,s[8:11],s56 offen sc1
s_mov_b32 s56,1048576
buffer_store_dwordx4 v[4:7],v3,s[8:11],s56 offen sc1
s_mov_b32 s56,2097152
buffer_store_dwordx4 v[4:7],v3,s[8:11],s56 offen sc1
s_mov_b32 s56,4194304
buffer_store_dwordx4 v[4:7],v2,s[8:11],s56 offen sc1
s_mov_b32 s56,5242880
buffer_store_dwordx4 v[4:7],v2,s[8:11],s56 offen sc1
v_add_u32 v3,17309696,v2
v_mov_b32 v12,0x80000000
v_cndmask_b32 v3,v3,v12,vcc
buffer_store_dwordx4 v[4:7],v3,s[8:11],0 offen sc1
v_cmp_gt_u32 vcc,147456,v2
v_lshrrev_b32 v3,11,v2
v_lshlrev_b32 v3,13,v3
v_and_b32 v13,0x7ff,v2
v_add_u32 v3,v3,v13
v_add_u32 v3,10485760,v3
v_cndmask_b32 v3,v12,v3,vcc
buffer_store_dwordx4 v[8:11],v3,s[8:11],0 offen sc1
v_add_u32 v3,11075584,v2
v_lshrrev_b32 v13,16,v2
v_cmp_eq_u32 vcc,4,v13
s_nop 1
v_cndmask_b32 v3,v12,v3,vcc
buffer_store_dwordx4 v[4:7],v3,s[8:11],0 offen sc1
s_waitcnt vmcnt(8)
v_lshlrev_b32 v32,16,v24
v_and_b32 v33,0xffff0000,v24
v_lshlrev_b32 v34,16,v25
v_and_b32 v35,0xffff0000,v25
v_lshlrev_b32 v36,16,v26
v_and_b32 v37,0xffff0000,v26
v_lshlrev_b32 v38,16,v27
v_and_b32 v39,0xffff0000,v27
v_readfirstlane_b32 s78,v32
s_nop 1
v_pk_add_f32 v[48:49],v[32:33],s[78:79] op_sel_hi:[1,0] neg_lo:[0,1] neg_hi:[0,1]
v_pk_add_f32 v[50:51],v[34:35],s[78:79] op_sel_hi:[1,0] neg_lo:[0,1] neg_hi:[0,1]
v_pk_add_f32 v[52:53],v[36:37],s[78:79] op_sel_hi:[1,0] neg_lo:[0,1] neg_hi:[0,1]
v_pk_add_f32 v[54:55],v[38:39],s[78:79] op_sel_hi:[1,0] neg_lo:[0,1] neg_hi:[0,1]
v_pk_add_f32 v[56:57],v[48:49],v[50:51]
v_pk_mul_f32 v[58:59],v[48:49],v[48:49]
v_pk_add_f32 v[60:61],v[52:53],v[54:55]
v_pk_fma_f32 v[58:59],v[50:51],v[50:51],v[58:59]
v_pk_add_f32 v[56:57],v[56:57],v[60:61]
v_pk_fma_f32 v[58:59],v[52:53],v[52:53],v[58:59]
v_add_f32 v56,v56,v57
v_pk_fma_f32 v[58:59],v[54:55],v[54:55],v[58:59]
v_add_f32 v58,v58,v59
s_nop 1
v_permlane32_swap_b32 v56,v58
v_add_f32 v56,v56,v58
s_nop 1
v_add_f32_dpp v56,v56,v56 row_ror:8 row_mask:0xf bank_mask:0xf
s_nop 1
v_add_f32_dpp v56,v56,v56 row_ror:4 row_mask:0xf bank_mask:0xf
s_nop 1
v_add_f32_dpp v56,v56,v56 row_ror:2 row_mask:0xf bank_mask:0xf
s_nop 1
v_add_f32_dpp v56,v56,v56 row_ror:1 row_mask:0xf bank_mask:0xf
v_mov_b32 v58,v56
s_nop 1
v_permlane16_swap_b32 v56,v58
v_add_f32 v56,v56,v58
v_mul_f32 v56,0x3b000000,v56
v_mov_b32 v58,v56
s_nop 1
v_permlane32_swap_b32 v56,v58
v_fma_f32 v58,-v56,v56,v58
v_add_f32 v56,s78,v56
v_max_f32 v58,0,v58
v_cvt_pk_bf16_f32 v58,v56,v58
v_lshlrev_b32 v56,16,v58
v_and_b32 v58,0xffff0000,v58
v_add_f32 v58,0x3727c5ac,v58
v_cvt_pk_bf16_f32 v58,v58,v58
v_and_b32 v58,0xffff0000,v58
v_sqrt_f32 v58,v58
v_pk_add_f32 v[48:49],v[32:33],v[56:57] op_sel_hi:[1,0] neg_lo:[0,1] neg_hi:[0,1]
v_pk_add_f32 v[50:51],v[34:35],v[56:57] op_sel_hi:[1,0] neg_lo:[0,1] neg_hi:[0,1]
v_pk_add_f32 v[52:53],v[36:37],v[56:57] op_sel_hi:[1,0] neg_lo:[0,1] neg_hi:[0,1]
v_pk_add_f32 v[54:55],v[38:39],v[56:57] op_sel_hi:[1,0] neg_lo:[0,1] neg_hi:[0,1]
v_cvt_pk_bf16_f32 v58,v58,v58
v_and_b32 v58,0xffff0000,v58
v_rcp_f32 v58,v58
v_cvt_pk_bf16_f32 v40,v48,v49
v_cvt_pk_bf16_f32 v41,v50,v51
v_cvt_pk_bf16_f32 v42,v52,v53
v_cvt_pk_bf16_f32 v43,v54,v55
v_lshlrev_b32 v48,16,v40
v_and_b32 v49,0xffff0000,v40
v_lshlrev_b32 v50,16,v41
v_and_b32 v51,0xffff0000,v41
v_lshlrev_b32 v52,16,v42
v_and_b32 v53,0xffff0000,v42
v_lshlrev_b32 v54,16,v43
v_and_b32 v55,0xffff0000,v43
v_pk_mul_f32 v[48:49],v[48:49],v[58:59] op_sel_hi:[1,0]
v_pk_mul_f32 v[50:51],v[50:51],v[58:59] op_sel_hi:[1,0]
v_pk_mul_f32 v[52:53],v[52:53],v[58:59] op_sel_hi:[1,0]
v_pk_mul_f32 v[54:55],v[54:55],v[58:59] op_sel_hi:[1,0]
v_cvt_pk_bf16_f32 v40,v48,v49
v_cvt_pk_bf16_f32 v41,v50,v51
v_cvt_pk_bf16_f32 v42,v52,v53
v_cvt_pk_bf16_f32 v43,v54,v55
buffer_store_dwordx4 v[40:43],v0,s[8:11],s59 offen offset:0 sc1
v_lshlrev_b32 v32,16,v28
v_and_b32 v33,0xffff0000,v28
v_lshlrev_b32 v34,16,v29
v_and_b32 v35,0xffff0000,v29
v_lshlrev_b32 v36,16,v30
v_and_b32 v37,0xffff0000,v30
v_lshlrev_b32 v38,16,v31
v_and_b32 v39,0xffff0000,v31
v_readfirstlane_b32 s78,v32
s_nop 1
v_pk_add_f32 v[48:49],v[32:33],s[78:79] op_sel_hi:[1,0] neg_lo:[0,1] neg_hi:[0,1]
v_pk_add_f32 v[50:51],v[34:35],s[78:79] op_sel_hi:[1,0] neg_lo:[0,1] neg_hi:[0,1]
v_pk_add_f32 v[52:53],v[36:37],s[78:79] op_sel_hi:[1,0] neg_lo:[0,1] neg_hi:[0,1]
v_pk_add_f32 v[54:55],v[38:39],s[78:79] op_sel_hi:[1,0] neg_lo:[0,1] neg_hi:[0,1]
v_pk_add_f32 v[56:57],v[48:49],v[50:51]
v_pk_mul_f32 v[58:59],v[48:49],v[48:49]
v_pk_add_f32 v[60:61],v[52:53],v[54:55]
v_pk_fma_f32 v[58:59],v[50:51],v[50:51],v[58:59]
v_pk_add_f32 v[56:57],v[56:57],v[60:61]
v_pk_fma_f32 v[58:59],v[52:53],v[52:53],v[58:59]
v_add_f32 v56,v56,v57
v_pk_fma_f32 v[58:59],v[54:55],v[54:55],v[58:59]
v_add_f32 v58,v58,v59
s_nop 1
v_permlane32_swap_b32 v56,v58
v_add_f32 v56,v56,v58
s_nop 1
v_add_f32_dpp v56,v56,v56 row_ror:8 row_mask:0xf bank_mask:0xf
s_nop 1
v_add_f32_dpp v56,v56,v56 row_ror:4 row_mask:0xf bank_mask:0xf
s_nop 1
v_add_f32_dpp v56,v56,v56 row_ror:2 row_mask:0xf bank_mask:0xf
s_nop 1
v_add_f32_dpp v56,v56,v56 row_ror:1 row_mask:0xf bank_mask:0xf
v_mov_b32 v58,v56
s_nop 1
v_permlane16_swap_b32 v56,v58
v_add_f32 v56,v56,v58
v_mul_f32 v56,0x3b000000,v56
v_mov_b32 v58,v56
s_nop 1
v_permlane32_swap_b32 v56,v58
v_fma_f32 v58,-v56,v56,v58
v_add_f32 v56,s78,v56
v_max_f32 v58,0,v58
v_cvt_pk_bf16_f32 v58,v56,v58
v_lshlrev_b32 v56,16,v58
v_and_b32 v58,0xffff0000,v58
v_add_f32 v58,0x3727c5ac,v58
v_cvt_pk_bf16_f32 v58,v58,v58
v_and_b32 v58,0xffff0000,v58
v_sqrt_f32 v58,v58
v_pk_add_f32 v[48:49],v[32:33],v[56:57] op_sel_hi:[1,0] neg_lo:[0,1] neg_hi:[0,1]
v_pk_add_f32 v[50:51],v[34:35],v[56:57] op_sel_hi:[1,0] neg_lo:[0,1] neg_hi:[0,1]
v_pk_add_f32 v[52:53],v[36:37],v[56:57] op_sel_hi:[1,0] neg_lo:[0,1] neg_hi:[0,1]
v_pk_add_f32 v[54:55],v[38:39],v[56:57] op_sel_hi:[1,0] neg_lo:[0,1] neg_hi:[0,1]
v_cvt_pk_bf16_f32 v58,v58,v58
v_and_b32 v58,0xffff0000,v58
v_rcp_f32 v58,v58
v_cvt_pk_bf16_f32 v44,v48,v49
v_cvt_pk_bf16_f32 v45,v50,v51
v_cvt_pk_bf16_f32 v46,v52,v53
v_cvt_pk_bf16_f32 v47,v54,v55
v_lshlrev_b32 v48,16,v44
v_and_b32 v49,0xffff0000,v44
v_lshlrev_b32 v50,16,v45
v_and_b32 v51,0xffff0000,v45
v_lshlrev_b32 v52,16,v46
v_and_b32 v53,0xffff0000,v46
v_lshlrev_b32 v54,16,v47
v_and_b32 v55,0xffff0000,v47
v_pk_mul_f32 v[48:49],v[48:49],v[58:59] op_sel_hi:[1,0]
v_pk_mul_f32 v[50:51],v[50:51],v[58:59] op_sel_hi:[1,0]
v_pk_mul_f32 v[52:53],v[52:53],v[58:59] op_sel_hi:[1,0]
v_pk_mul_f32 v[54:55],v[54:55],v[58:59] op_sel_hi:[1,0]
v_cvt_pk_bf16_f32 v44,v48,v49
v_cvt_pk_bf16_f32 v45,v50,v51
v_cvt_pk_bf16_f32 v46,v52,v53
v_cvt_pk_bf16_f32 v47,v54,v55
buffer_store_dwordx4 v[44:47],v0,s[8:11],s59 offen offset:1024 sc1
s_mov_b32 s4,s18
s_mov_b32 s5,s19
s_mov_b32 s6,8192
s_mov_b32 s7,0x20000
s_cmp_ge_u32 s2,2
s_cbranch_scc1 L_m0_2
s_lshl_b32 s56,s2,2
s_add_u32 s56,s56,s46
v_bfe_u32 v2,v1,2,2
v_and_b32 v3,1,v1
v_lshl_add_u32 v2,v2,1,v3
v_lshlrev_b32 v2,10,v2
v_lshrrev_b32 v3,4,v1
v_lshl_add_u32 v2,v3,5,v2
v_and_b32 v3,2,v1
v_lshl_add_u32 v2,v3,1,v2
s_lshl_b32 s57,s56,7
buffer_load_dword v32,v2,s[4:7],s57 offen offset:0
buffer_load_dword v33,v2,s[4:7],s57 offen offset:8
buffer_load_dword v34,v2,s[4:7],s57 offen offset:16
buffer_load_dword v35,v2,s[4:7],s57 offen offset:24
v_lshrrev_b32 v2,3,v1
v_lshlrev_b32 v2,9,v2
v_and_b32 v3,7,v1
v_lshl_add_u32 v2,v3,4,v2
s_and_b32 s57,s56,1
s_lshl_b32 s57,s57,8
s_and_b32 s58,s56,2
s_lshl_b32 s58,s58,6
s_add_u32 s57,s57,s58
s_and_b32 s58,s56,4
s_lshl_b32 s58,s58,10
s_add_u32 s57,s57,s58
s_waitcnt vmcnt(0)
s_add_u32 s58,s57,11534336
buffer_store_dwordx4 v[32:35],v2,s[8:11],s58 offen sc1
s_add_u32 s58,s57,12582912
buffer_store_dwordx4 v[32:35],v2,s[8:11],s58 offen sc1
s_add_u32 s58,s57,17825792
buffer_store_dwordx4 v[32:35],v2,s[8:11],s58 offen sc1
L_m0_2:
s_cmp_lg_u32 s46,0
s_cbranch_scc1 L_tk_3
s_mov_b64 exec,1
v_mov_b32 v4,159744
ds_write2_b32 v4,v15,v16 offset1:1
s_mov_b64 exec,-1
s_waitcnt lgkmcnt(0)
L_tk_3:
s_barrier
v_mov_b32 v4,159744
ds_read_b64 v[2:3],v4
s_waitcnt lgkmcnt(0)
v_readfirstlane_b32 s47,v2
v_readfirstlane_b32 s56,v3
s_cmp_eq_u32 s56,0
s_cselect_b32 s56,s48,s56
s_and_b32 s56,s56,7
s_xor_b32 s48,s48,s56
s_lshl_b32 s48,s48,2
s_lshr_b32 s48,1399931488,s48
s_and_b32 s48,s48,7
s_mov_b32 s3,0
s_cmp_ge_u32 s47,32
s_cselect_b32 s53,0x10001,1
s_and_b32 s47,s47,31
s_lshl_b32 s50,s46,10
s_cmp_eq_u32 s46,0
s_cselect_b32 s52,0,0x80000000
s_mov_b32 s28,0x3f803f80
s_mov_b32 s29,0x3f803f80
s_mov_b32 s51,0
s_bfe_u32 s56,s48,0x10001
s_and_b32 s57,s48,1
s_add_u32 s58,s56,6
s_sub_u32 s59,5,s57
s_cmp_ge_u32 s47,16
s_cselect_b32 s58,s58,s59
s_cselect_b32 s57,s57,s56
s_and_b32 s59,s47,15
s_lshl4_add_u32 s57,s57,s59
s_cmp_ge_u32 s48,4
s_cselect_b32 s48,s58,s48
s_cselect_b32 s47,s57,s47
L_roles:
s_lshl_b32 s56,1,s48
s_and_b32 s56,s56,6
s_cbranch_scc0 L_x_10
s_waitcnt vmcnt(0)
s_barrier
s_cmp_lg_u32 s46,0
s_cbranch_scc1 L_ar_11
v_mov_b32 v8,128
v_mov_b32 v9,s53
s_mov_b64 exec,1
buffer_atomic_add v9,v8,s[12:15],0 offen
s_mov_b64 exec,-1
L_ar_11:
s_mov_b32 s53,0
v_mov_b32 v123,159744
s_cmp_lg_u32 s46,0
s_cbranch_scc1 L_gbd_13
v_mov_b32 v124,128
L_gb_12:
buffer_load_dword v125,v124,s[12:15],0 offen sc1
s_waitcnt vmcnt(0)
v_readfirstlane_b32 s56,v125
ds_write_b32 v123,v125
s_bitcmp1_b32 s56,8
s_cbranch_scc1 L_gbd_13
s_sleep 4
s_sub_u32 s49,s49,1
s_cmp_gt_i32 s49,0
s_cbranch_scc1 L_gb_12
s_branch L_abort
L_gbd_13:
s_waitcnt lgkmcnt(0)
s_barrier
ds_read_b32 v125,v123
s_waitcnt lgkmcnt(0)
v_readfirstlane_b32 s56,v125
s_barrier
s_lshr_b32 s56,s56,16
s_andn2_b32 s56,s56,s3
s_cbranch_scc1 L_spread
L_x_10:
s_cmp_ge_u32 s48,6
s_cbranch_scc1 L_ra_6
v_lshrrev_b32 v2,2,v1
v_lshrrev_b32 v3,5,v1
v_xor_b32 v2,v2,v3
v_lshlrev_b32 v2,13,v2
v_and_b32 v3,3,v1
v_lshl_add_u32 v2,v3,4,v2
v_and_b32 v3,15,v1
v_lshlrev_b32 v3,2,v3
v_lshrrev_b32 v4,4,v1
v_lshl_add_u32 v3,v4,9,v3
v_and_b32 v4,1,v4
v_lshl_add_u32 v3,v4,6,v3
s_lshl_b32 s59,s46,15
s_cmp_lt_u32 s48,3
s_cselect_b32 s63,s46,0
s_lshl_b32 s56,s63,12
s_add_u32 s56,s59,s56
v_add_u32 v3,s56,v3
v_xor_b32 v4,64,v3
s_lshl_b32 s58,s47,8
s_lshl_b32 s56,s46,6
s_add_u32 s58,s58,s56
s_mov_b32 s61,0x05040100
s_mov_b32 s62,0x07060302
s_mov_b32 s4,s22
s_mov_b32 s5,s23
s_mov_b32 s6,4194304
s_mov_b32 s7,0x20000
s_xor_b32 m0,s59,0
s_xor_b32 s60,s58,0
buffer_load_dwordx4 v2,s[4:7],s60 offen lds
s_add_u32 m0,m0,1024
s_add_u32 s60,s60,131072
buffer_load_dwordx4 v2,s[4:7],s60 offen lds
s_xor_b32 m0,s59,2048
s_xor_b32 s60,s58,262144
buffer_load_dwordx4 v2,s[4:7],s60 offen lds
s_add_u32 m0,m0,1024
s_add_u32 s60,s60,131072
buffer_load_dwordx4 v2,s[4:7],s60 offen lds
s_xor_b32 m0,s59,4096
s_xor_b32 s60,s58,524288
buffer_load_dwordx4 v2,s[4:7],s60 offen lds
s_add_u32 m0,m0,1024
s_add_u32 s60,s60,131072
buffer_load_dwordx4 v2,s[4:7],s60 offen lds
s_xor_b32 m0,s59,6144
s_xor_b32 s60,s58,786432
buffer_load_dwordx4 v2,s[4:7],s60 offen lds
s_add_u32 m0,m0,1024
s_add_u32 s60,s60,131072
buffer_load_dwordx4 v2,s[4:7],s60 offen lds
s_xor_b32 m0,s59,8192
s_xor_b32 s60,s58,1048576
buffer_load_dwordx4 v2,s[4:7],s60 offen lds
s_add_u32 m0,m0,1024
s_add_u32 s60,s60,131072
buffer_load_dwordx4 v2,s[4:7],s60 offen lds
s_xor_b32 m0,s59,10240
s_xor_b32 s60,s58,1310720
buffer_load_dwordx4 v2,s[4:7],s60 offen lds
s_add_u32 m0,m0,1024
s_add_u32 s60,s60,131072
buffer_load_dwordx4 v2,s[4:7],s60 offen lds
s_xor_b32 m0,s59,12288
s_xor_b32 s60,s58,1572864
buffer_load_dwordx4 v2,s[4:7],s60 offen lds
s_add_u32 m0,m0,1024
s_add_u32 s60,s60,131072
buffer_load_dwordx4 v2,s[4:7],s60 offen lds
s_xor_b32 m0,s59,14336
s_xor_b32 s60,s58,1835008
buffer_load_dwordx4 v2,s[4:7],s60 offen lds
s_add_u32 m0,m0,1024
s_add_u32 s60,s60,131072
buffer_load_dwordx4 v2,s[4:7],s60 offen lds
s_xor_b32 m0,s59,16384
s_xor_b32 s60,s58,2097152
buffer_load_dwordx4 v2,s[4:7],s60 offen lds
s_add_u32 m0,m0,1024
s_add_u32 s60,s60,131072
buffer_load_dwordx4 v2,s[4:7],s60 offen lds
s_xor_b32 m0,s59,18432
s_xor_b32 s60,s58,2359296
buffer_load_dwordx4 v2,s[4:7],s60 offen lds
s_add_u32 m0,m0,1024
s_add_u32 s60,s60,131072
buffer_load_dwordx4 v2,s[4:7],s60 offen lds
s_xor_b32 m0,s59,20480
s_xor_b32 s60,s58,2621440
buffer_load_dwordx4 v2,s[4:7],s60 offen lds
s_add_u32 m0,m0,1024
s_add_u32 s60,s60,131072
buffer_load_dwordx4 v2,s[4:7],s60 offen lds
s_xor_b32 m0,s59,22528
s_xor_b32 s60,s58,2883584
buffer_load_dwordx4 v2,s[4:7],s60 offen lds
s_add_u32 m0,m0,1024
s_add_u32 s60,s60,131072
buffer_load_dwordx4 v2,s[4:7],s60 offen lds
s_xor_b32 m0,s59,24576
s_xor_b32 s60,s58,3145728
buffer_load_dwordx4 v2,s[4:7],s60 offen lds
s_add_u32 m0,m0,1024
s_add_u32 s60,s60,131072
buffer_load_dwordx4 v2,s[4:7],s60 offen lds
s_xor_b32 m0,s59,26624
s_xor_b32 s60,s58,3407872
buffer_load_dwordx4 v2,s[4:7],s60 offen lds
s_add_u32 m0,m0,1024
s_add_u32 s60,s60,131072
buffer_load_dwordx4 v2,s[4:7],s60 offen lds
s_xor_b32 m0,s59,28672
s_xor_b32 s60,s58,3670016
buffer_load_dwordx4 v2,s[4:7],s60 offen lds
s_add_u32 m0,m0,1024
s_add_u32 s60,s60,131072
buffer_load_dwordx4 v2,s[4:7],s60 offen lds
s_xor_b32 m0,s59,30720
s_xor_b32 s60,s58,3932160
buffer_load_dwordx4 v2,s[4:7],s60 offen lds
s_add_u32 m0,m0,1024
s_add_u32 s60,s60,131072
buffer_load_dwordx4 v2,s[4:7],s60 offen lds
s_waitcnt vmcnt(30)
s_barrier
s_cmp_lg_u32 s46,0
s_cbranch_scc1 L_ar_14
v_mov_b32 v8,128
v_mov_b32 v9,s53
s_mov_b64 exec,1
buffer_atomic_add v9,v8,s[12:15],0 offen
s_mov_b64 exec,-1
L_ar_14:
s_mov_b32 s53,0
s_waitcnt vmcnt(16)
v_xor_b32 v5,0,v3
v_xor_b32 v6,0,v4
ds_read2_b32 v[96:97],v5 offset1:32
ds_read2_b32 v[100:101],v6 offset1:32
ds_read2_b32 v[98:99],v5 offset0:64 offset1:96
ds_read2_b32 v[102:103],v6 offset0:64 offset1:96
v_xor_b32 v5,2048,v3
v_xor_b32 v6,2048,v4
ds_read2_b32 v[104:105],v5 offset1:32
ds_read2_b32 v[108:109],v6 offset1:32
ds_read2_b32 v[106:107],v5 offset0:64 offset1:96
ds_read2_b32 v[110:111],v6 offset0:64 offset1:96
s_waitcnt lgkmcnt(4)
v_perm_b32 v112,v100,v96,s61
v_perm_b32 v113,v101,v97,s61
v_perm_b32 v114,v102,v98,s61
v_perm_b32 v115,v103,v99,s61
v_perm_b32 v116,v100,v96,s62
v_perm_b32 v117,v101,v97,s62
v_perm_b32 v118,v102,v98,s62
v_perm_b32 v119,v103,v99,s62
v_accvgpr_write_b32 a128,v112
v_accvgpr_write_b32 a129,v113
v_accvgpr_write_b32 a130,v114
v_accvgpr_write_b32 a131,v115
v_accvgpr_write_b32 a136,v116
v_accvgpr_write_b32 a137,v117
v_accvgpr_write_b32 a138,v118
v_accvgpr_write_b32 a139,v119
v_xor_b32 v5,4096,v3
v_xor_b32 v6,4096,v4
ds_read2_b32 v[96:97],v5 offset1:32
ds_read2_b32 v[100:101],v6 offset1:32
ds_read2_b32 v[98:99],v5 offset0:64 offset1:96
ds_read2_b32 v[102:103],v6 offset0:64 offset1:96
s_waitcnt lgkmcnt(4)
v_perm_b32 v112,v108,v104,s61
v_perm_b32 v113,v109,v105,s61
v_perm_b32 v114,v110,v106,s61
v_perm_b32 v115,v111,v107,s61
v_perm_b32 v116,v108,v104,s62
v_perm_b32 v117,v109,v105,s62
v_perm_b32 v118,v110,v106,s62
v_perm_b32 v119,v111,v107,s62
v_accvgpr_write_b32 a132,v112
v_accvgpr_write_b32 a133,v113
v_accvgpr_write_b32 a134,v114
v_accvgpr_write_b32 a135,v115
v_accvgpr_write_b32 a140,v116
v_accvgpr_write_b32 a141,v117
v_accvgpr_write_b32 a142,v118
v_accvgpr_write_b32 a143,v119
v_xor_b32 v5,6144,v3
v_xor_b32 v6,6144,v4
ds_read2_b32 v[104:105],v5 offset1:32
ds_read2_b32 v[108:109],v6 offset1:32
ds_read2_b32 v[106:107],v5 offset0:64 offset1:96
ds_read2_b32 v[110:111],v6 offset0:64 offset1:96
s_waitcnt lgkmcnt(4)
v_perm_b32 v112,v100,v96,s61
v_perm_b32 v113,v101,v97,s61
v_perm_b32 v114,v102,v98,s61
v_perm_b32 v115,v103,v99,s61
v_perm_b32 v116,v100,v96,s62
v_perm_b32 v117,v101,v97,s62
v_perm_b32 v118,v102,v98,s62
v_perm_b32 v119,v103,v99,s62
v_accvgpr_write_b32 a144,v112
v_accvgpr_write_b32 a145,v113
v_accvgpr_write_b32 a146,v114
v_accvgpr_write_b32 a147,v115
v_accvgpr_write_b32 a152,v116
v_accvgpr_write_b32 a153,v117
v_accvgpr_write_b32 a154,v118
v_accvgpr_write_b32 a155,v119
v_xor_b32 v5,8192,v3
v_xor_b32 v6,8192,v4
ds_read2_b32 v[96:97],v5 offset1:32
ds_read2_b32 v[100:101],v6 offset1:32
ds_read2_b32 v[98:99],v5 offset0:64 offset1:96
ds_read2_b32 v[102:103],v6 offset0:64 offset1:96
s_waitcnt lgkmcnt(4)
v_perm_b32 v112,v108,v104,s61
v_perm_b32 v113,v109,v105,s61
v_perm_b32 v114,v110,v106,s61
v_perm_b32 v115,v111,v107,s61
v_perm_b32 v116,v108,v104,s62
v_perm_b32 v117,v109,v105,s62
v_perm_b32 v118,v110,v106,s62
v_perm_b32 v119,v111,v107,s62
v_accvgpr_write_b32 a148,v112
v_accvgpr_write_b32 a149,v113
v_accvgpr_write_b32 a150,v114
v_accvgpr_write_b32 a151,v115
v_accvgpr_write_b32 a156,v116
v_accvgpr_write_b32 a157,v117
v_accvgpr_write_b32 a158,v118
v_accvgpr_write_b32 a159,v119
v_xor_b32 v5,10240,v3
v_xor_b32 v6,10240,v4
ds_read2_b32 v[104:105],v5 offset1:32
ds_read2_b32 v[108:109],v6 offset1:32
ds_read2_b32 v[106:107],v5 offset0:64 offset1:96
ds_read2_b32 v[110:111],v6 offset0:64 offset1:96
s_waitcnt lgkmcnt(4)
v_perm_b32 v112,v100,v96,s61
v_perm_b32 v113,v101,v97,s61
v_perm_b32 v114,v102,v98,s61
v_perm_b32 v115,v103,v99,s61
v_perm_b32 v116,v100,v96,s62
v_perm_b32 v117,v101,v97,s62
v_perm_b32 v118,v102,v98,s62
v_perm_b32 v119,v103,v99,s62
v_accvgpr_write_b32 a160,v112
v_accvgpr_write_b32 a161,v113
v_accvgpr_write_b32 a162,v114
v_accvgpr_write_b32 a163,v115
v_accvgpr_write_b32 a168,v116
v_accvgpr_write_b32 a169,v117
v_accvgpr_write_b32 a170,v118
v_accvgpr_write_b32 a171,v119
v_xor_b32 v5,12288,v3
v_xor_b32 v6,12288,v4
ds_read2_b32 v[96:97],v5 offset1:32
ds_read2_b32 v[100:101],v6 offset1:32
ds_read2_b32 v[98:99],v5 offset0:64 offset1:96
ds_read2_b32 v[102:103],v6 offset0:64 offset1:96
s_waitcnt lgkmcnt(4)
v_perm_b32 v112,v108,v104,s61
v_perm_b32 v113,v109,v105,s61
v_perm_b32 v114,v110,v106,s61
v_perm_b32 v115,v111,v107,s61
v_perm_b32 v116,v108,v104,s62
v_perm_b32 v117,v109,v105,s62
v_perm_b32 v118,v110,v106,s62
v_perm_b32 v119,v111,v107,s62
v_accvgpr_write_b32 a164,v112
v_accvgpr_write_b32 a165,v113
v_accvgpr_write_b32 a166,v114
v_accvgpr_write_b32 a167,v115
v_accvgpr_write_b32 a172,v116
v_accvgpr_write_b32 a173,v117
v_accvgpr_write_b32 a174,v118
v_accvgpr_write_b32 a175,v119
v_xor_b32 v5,14336,v3
v_xor_b32 v6,14336,v4
ds_read2_b32 v[104:105],v5 offset1:32
ds_read2_b32 v[108:109],v6 offset1:32
ds_read2_b32 v[106:107],v5 offset0:64 offset1:96
ds_read2_b32 v[110:111],v6 offset0:64 offset1:96
s_waitcnt lgkmcnt(4)
v_perm_b32 v112,v100,v96,s61
v_perm_b32 v113,v101,v97,s61
v_perm_b32 v114,v102,v98,s61
v_perm_b32 v115,v103,v99,s61
v_perm_b32 v116,v100,v96,s62
v_perm_b32 v117,v101,v97,s62
v_perm_b32 v118,v102,v98,s62
v_perm_b32 v119,v103,v99,s62
v_accvgpr_write_b32 a176,v112
v_accvgpr_write_b32 a177,v113
v_accvgpr_write_b32 a178,v114
v_accvgpr_write_b32 a179,v115
v_accvgpr_write_b32 a184,v116
v_accvgpr_write_b32 a185,v117
v_accvgpr_write_b32 a186,v118
v_accvgpr_write_b32 a187,v119
s_waitcnt lgkmcnt(0)
s_mov_b32 s4,s24
s_mov_b32 s5,s25
s_mov_b32 s6,4194304
s_mov_b32 s7,0x20000
s_xor_b32 m0,s59,0
s_xor_b32 s60,s58,0
buffer_load_dwordx4 v2,s[4:7],s60 offen lds
s_add_u32 m0,m0,1024
s_add_u32 s60,s60,131072
buffer_load_dwordx4 v2,s[4:7],s60 offen lds
s_xor_b32 m0,s59,2048
s_xor_b32 s60,s58,262144
buffer_load_dwordx4 v2,s[4:7],s60 offen lds
s_add_u32 m0,m0,1024
s_add_u32 s60,s60,131072
buffer_load_dwordx4 v2,s[4:7],s60 offen lds
s_xor_b32 m0,s59,4096
s_xor_b32 s60,s58,524288
buffer_load_dwordx4 v2,s[4:7],s60 offen lds
s_add_u32 m0,m0,1024
s_add_u32 s60,s60,131072
buffer_load_dwordx4 v2,s[4:7],s60 offen lds
s_xor_b32 m0,s59,6144
s_xor_b32 s60,s58,786432
buffer_load_dwordx4 v2,s[4:7],s60 offen lds
s_add_u32 m0,m0,1024
s_add_u32 s60,s60,131072
buffer_load_dwordx4 v2,s[4:7],s60 offen lds
s_xor_b32 m0,s59,8192
s_xor_b32 s60,s58,1048576
buffer_load_dwordx4 v2,s[4:7],s60 offen lds
s_add_u32 m0,m0,1024
s_add_u32 s60,s60,131072
buffer_load_dwordx4 v2,s[4:7],s60 offen lds
s_xor_b32 m0,s59,10240
s_xor_b32 s60,s58,1310720
buffer_load_dwordx4 v2,s[4:7],s60 offen lds
s_add_u32 m0,m0,1024
s_add_u32 s60,s60,131072
buffer_load_dwordx4 v2,s[4:7],s60 offen lds
s_xor_b32 m0,s59,12288
s_xor_b32 s60,s58,1572864
buffer_load_dwordx4 v2,s[4:7],s60 offen lds
s_add_u32 m0,m0,1024
s_add_u32 s60,s60,131072
buffer_load_dwordx4 v2,s[4:7],s60 offen lds
s_xor_b32 m0,s59,14336
s_xor_b32 s60,s58,1835008
buffer_load_dwordx4 v2,s[4:7],s60 offen lds
s_add_u32 m0,m0,1024
s_add_u32 s60,s60,131072
buffer_load_dwordx4 v2,s[4:7],s60 offen lds
v_perm_b32 v112,v108,v104,s61
v_perm_b32 v113,v109,v105,s61
v_perm_b32 v114,v110,v106,s61
v_perm_b32 v115,v111,v107,s61
v_perm_b32 v116,v108,v104,s62
v_perm_b32 v117,v109,v105,s62
v_perm_b32 v118,v110,v106,s62
v_perm_b32 v119,v111,v107,s62
v_accvgpr_write_b32 a180,v112
v_accvgpr_write_b32 a181,v113
v_accvgpr_write_b32 a182,v114
v_accvgpr_write_b32 a183,v115
v_accvgpr_write_b32 a188,v116
v_accvgpr_write_b32 a189,v117
v_accvgpr_write_b32 a190,v118
v_accvgpr_write_b32 a191,v119
s_waitcnt vmcnt(16)
v_xor_b32 v5,16384,v3
v_xor_b32 v6,16384,v4
ds_read2_b32 v[96:97],v5 offset1:32
ds_read2_b32 v[100:101],v6 offset1:32
ds_read2_b32 v[98:99],v5 offset0:64 offset1:96
ds_read2_b32 v[102:103],v6 offset0:64 offset1:96
v_xor_b32 v5,18432,v3
v_xor_b32 v6,18432,v4
ds_read2_b32 v[104:105],v5 offset1:32
ds_read2_b32 v[108:109],v6 offset1:32
ds_read2_b32 v[106:107],v5 offset0:64 offset1:96
ds_read2_b32 v[110:111],v6 offset0:64 offset1:96
s_waitcnt lgkmcnt(4)
v_perm_b32 v112,v100,v96,s61
v_perm_b32 v113,v101,v97,s61
v_perm_b32 v114,v102,v98,s61
v_perm_b32 v115,v103,v99,s61
v_perm_b32 v116,v100,v96,s62
v_perm_b32 v117,v101,v97,s62
v_perm_b32 v118,v102,v98,s62
v_perm_b32 v119,v103,v99,s62
v_accvgpr_write_b32 a192,v112
v_accvgpr_write_b32 a193,v113
v_accvgpr_write_b32 a194,v114
v_accvgpr_write_b32 a195,v115
v_accvgpr_write_b32 a200,v116
v_accvgpr_write_b32 a201,v117
v_accvgpr_write_b32 a202,v118
v_accvgpr_write_b32 a203,v119
v_xor_b32 v5,20480,v3
v_xor_b32 v6,20480,v4
ds_read2_b32 v[96:97],v5 offset1:32
ds_read2_b32 v[100:101],v6 offset1:32
ds_read2_b32 v[98:99],v5 offset0:64 offset1:96
ds_read2_b32 v[102:103],v6 offset0:64 offset1:96
s_waitcnt lgkmcnt(4)
v_perm_b32 v112,v108,v104,s61
v_perm_b32 v113,v109,v105,s61
v_perm_b32 v114,v110,v106,s61
v_perm_b32 v115,v111,v107,s61
v_perm_b32 v116,v108,v104,s62
v_perm_b32 v117,v109,v105,s62
v_perm_b32 v118,v110,v106,s62
v_perm_b32 v119,v111,v107,s62
v_accvgpr_write_b32 a196,v112
v_accvgpr_write_b32 a197,v113
v_accvgpr_write_b32 a198,v114
v_accvgpr_write_b32 a199,v115
v_accvgpr_write_b32 a204,v116
v_accvgpr_write_b32 a205,v117
v_accvgpr_write_b32 a206,v118
v_accvgpr_write_b32 a207,v119
v_xor_b32 v5,22528,v3
v_xor_b32 v6,22528,v4
ds_read2_b32 v[104:105],v5 offset1:32
ds_read2_b32 v[108:109],v6 offset1:32
ds_read2_b32 v[106:107],v5 offset0:64 offset1:96
ds_read2_b32 v[110:111],v6 offset0:64 offset1:96
s_waitcnt lgkmcnt(4)
v_perm_b32 v112,v100,v96,s61
v_perm_b32 v113,v101,v97,s61
v_perm_b32 v114,v102,v98,s61
v_perm_b32 v115,v103,v99,s61
v_perm_b32 v116,v100,v96,s62
v_perm_b32 v117,v101,v97,s62
v_perm_b32 v118,v102,v98,s62
v_perm_b32 v119,v103,v99,s62
v_accvgpr_write_b32 a208,v112
v_accvgpr_write_b32 a209,v113
v_accvgpr_write_b32 a210,v114
v_accvgpr_write_b32 a211,v115
v_accvgpr_write_b32 a216,v116
v_accvgpr_write_b32 a217,v117
v_accvgpr_write_b32 a218,v118
v_accvgpr_write_b32 a219,v119
v_xor_b32 v5,24576,v3
v_xor_b32 v6,24576,v4
ds_read2_b32 v[96:97],v5 offset1:32
ds_read2_b32 v[100:101],v6 offset1:32
ds_read2_b32 v[98:99],v5 offset0:64 offset1:96
ds_read2_b32 v[102:103],v6 offset0:64 offset1:96
s_waitcnt lgkmcnt(4)
v_perm_b32 v112,v108,v104,s61
v_perm_b32 v113,v109,v105,s61
v_perm_b32 v114,v110,v106,s61
v_perm_b32 v115,v111,v107,s61
v_perm_b32 v116,v108,v104,s62
v_perm_b32 v117,v109,v105,s62
v_perm_b32 v118,v110,v106,s62
v_perm_b32 v119,v111,v107,s62
v_accvgpr_write_b32 a212,v112
v_accvgpr_write_b32 a213,v113
v_accvgpr_write_b32 a214,v114
v_accvgpr_write_b32 a215,v115
v_accvgpr_write_b32 a220,v116
v_accvgpr_write_b32 a221,v117
v_accvgpr_write_b32 a222,v118
v_accvgpr_write_b32 a223,v119
v_xor_b32 v5,26624,v3
v_xor_b32 v6,26624,v4
ds_read2_b32 v[104:105],v5 offset1:32
ds_read2_b32 v[108:109],v6 offset1:32
ds_read2_b32 v[106:107],v5 offset0:64 offset1:96
ds_read2_b32 v[110:111],v6 offset0:64 offset1:96
s_waitcnt lgkmcnt(4)
v_perm_b32 v112,v100,v96,s61
v_perm_b32 v113,v101,v97,s61
v_perm_b32 v114,v102,v98,s61
v_perm_b32 v115,v103,v99,s61
v_perm_b32 v116,v100,v96,s62
v_perm_b32 v117,v101,v97,s62
v_perm_b32 v118,v102,v98,s62
v_perm_b32 v119,v103,v99,s62
v_accvgpr_write_b32 a224,v112
v_accvgpr_write_b32 a225,v113
v_accvgpr_write_b32 a226,v114
v_accvgpr_write_b32 a227,v115
v_accvgpr_write_b32 a232,v116
v_accvgpr_write_b32 a233,v117
v_accvgpr_write_b32 a234,v118
v_accvgpr_write_b32 a235,v119
v_xor_b32 v5,28672,v3
v_xor_b32 v6,28672,v4
ds_read2_b32 v[96:97],v5 offset1:32
ds_read2_b32 v[100:101],v6 offset1:32
ds_read2_b32 v[98:99],v5 offset0:64 offset1:96
ds_read2_b32 v[102:103],v6 offset0:64 offset1:96
s_waitcnt lgkmcnt(4)
v_perm_b32 v112,v108,v104,s61
v_perm_b32 v113,v109,v105,s61
v_perm_b32 v114,v110,v106,s61
v_perm_b32 v115,v111,v107,s61
v_perm_b32 v116,v108,v104,s62
v_perm_b32 v117,v109,v105,s62
v_perm_b32 v118,v110,v106,s62
v_perm_b32 v119,v111,v107,s62
v_accvgpr_write_b32 a228,v112
v_accvgpr_write_b32 a229,v113
v_accvgpr_write_b32 a230,v114
v_accvgpr_write_b32 a231,v115
v_accvgpr_write_b32 a236,v116
v_accvgpr_write_b32 a237,v117
v_accvgpr_write_b32 a238,v118
v_accvgpr_write_b32 a239,v119
v_xor_b32 v5,30720,v3
v_xor_b32 v6,30720,v4
ds_read2_b32 v[104:105],v5 offset1:32
ds_read2_b32 v[108:109],v6 offset1:32
ds_read2_b32 v[106:107],v5 offset0:64 offset1:96
ds_read2_b32 v[110:111],v6 offset0:64 offset1:96
s_waitcnt lgkmcnt(4)
v_perm_b32 v112,v100,v96,s61
v_perm_b32 v113,v101,v97,s61
v_perm_b32 v114,v102,v98,s61
v_perm_b32 v115,v103,v99,s61
v_perm_b32 v116,v100,v96,s62
v_perm_b32 v117,v101,v97,s62
v_perm_b32 v118,v102,v98,s62
v_perm_b32 v119,v103,v99,s62
v_accvgpr_write_b32 a240,v112
v_accvgpr_write_b32 a241,v113
v_accvgpr_write_b32 a242,v114
v_accvgpr_write_b32 a243,v115
v_accvgpr_write_b32 a248,v116
v_accvgpr_write_b32 a249,v117
v_accvgpr_write_b32 a250,v118
v_accvgpr_write_b32 a251,v119
s_waitcnt lgkmcnt(0)
s_xor_b32 m0,s59,16384
s_xor_b32 s60,s58,2097152
buffer_load_dwordx4 v2,s[4:7],s60 offen lds
s_add_u32 m0,m0,1024
s_add_u32 s60,s60,131072
buffer_load_dwordx4 v2,s[4:7],s60 offen lds
s_xor_b32 m0,s59,18432
s_xor_b32 s60,s58,2359296
buffer_load_dwordx4 v2,s[4:7],s60 offen lds
s_add_u32 m0,m0,1024
s_add_u32 s60,s60,131072
buffer_load_dwordx4 v2,s[4:7],s60 offen lds
s_xor_b32 m0,s59,20480
s_xor_b32 s60,s58,2621440
buffer_load_dwordx4 v2,s[4:7],s60 offen lds
s_add_u32 m0,m0,1024
s_add_u32 s60,s60,131072
buffer_load_dwordx4 v2,s[4:7],s60 offen lds
s_xor_b32 m0,s59,22528
s_xor_b32 s60,s58,2883584
buffer_load_dwordx4 v2,s[4:7],s60 offen lds
s_add_u32 m0,m0,1024
s_add_u32 s60,s60,131072
buffer_load_dwordx4 v2,s[4:7],s60 offen lds
s_xor_b32 m0,s59,24576
s_xor_b32 s60,s58,3145728
buffer_load_dwordx4 v2,s[4:7],s60 offen lds
s_add_u32 m0,m0,1024
s_add_u32 s60,s60,131072
buffer_load_dwordx4 v2,s[4:7],s60 offen lds
s_xor_b32 m0,s59,26624
s_xor_b32 s60,s58,3407872
buffer_load_dwordx4 v2,s[4:7],s60 offen lds
s_add_u32 m0,m0,1024
s_add_u32 s60,s60,131072
buffer_load_dwordx4 v2,s[4:7],s60 offen lds
s_xor_b32 m0,s59,28672
s_xor_b32 s60,s58,3670016
buffer_load_dwordx4 v2,s[4:7],s60 offen lds
s_add_u32 m0,m0,1024
s_add_u32 s60,s60,131072
buffer_load_dwordx4 v2,s[4:7],s60 offen lds
s_xor_b32 m0,s59,30720
s_xor_b32 s60,s58,3932160
buffer_load_dwordx4 v2,s[4:7],s60 offen lds
s_add_u32 m0,m0,1024
s_add_u32 s60,s60,131072
buffer_load_dwordx4 v2,s[4:7],s60 offen lds
v_perm_b32 v112,v108,v104,s61
v_perm_b32 v113,v109,v105,s61
v_perm_b32 v114,v110,v106,s61
v_perm_b32 v115,v111,v107,s61
v_perm_b32 v116,v108,v104,s62
v_perm_b32 v117,v109,v105,s62
v_perm_b32 v118,v110,v106,s62
v_perm_b32 v119,v111,v107,s62
v_accvgpr_write_b32 a244,v112
v_accvgpr_write_b32 a245,v113
v_accvgpr_write_b32 a246,v114
v_accvgpr_write_b32 a247,v115
v_accvgpr_write_b32 a252,v116
v_accvgpr_write_b32 a253,v117
v_accvgpr_write_b32 a254,v118
v_accvgpr_write_b32 a255,v119
s_waitcnt vmcnt(16)
v_xor_b32 v5,0,v3
v_xor_b32 v6,0,v4
ds_read2_b32 v[96:97],v5 offset1:32
ds_read2_b32 v[100:101],v6 offset1:32
ds_read2_b32 v[98:99],v5 offset0:64 offset1:96
ds_read2_b32 v[102:103],v6 offset0:64 offset1:96
v_xor_b32 v5,2048,v3
v_xor_b32 v6,2048,v4
ds_read2_b32 v[104:105],v5 offset1:32
ds_read2_b32 v[108:109],v6 offset1:32
ds_read2_b32 v[106:107],v5 offset0:64 offset1:96
ds_read2_b32 v[110:111],v6 offset0:64 offset1:96
s_waitcnt lgkmcnt(4)
v_perm_b32 v128,v100,v96,s61
v_perm_b32 v129,v101,v97,s61
v_perm_b32 v130,v102,v98,s61
v_perm_b32 v131,v103,v99,s61
v_perm_b32 v136,v100,v96,s62
v_perm_b32 v137,v101,v97,s62
v_perm_b32 v138,v102,v98,s62
v_perm_b32 v139,v103,v99,s62
v_xor_b32 v5,4096,v3
v_xor_b32 v6,4096,v4
ds_read2_b32 v[96:97],v5 offset1:32
ds_read2_b32 v[100:101],v6 offset1:32
ds_read2_b32 v[98:99],v5 offset0:64 offset1:96
ds_read2_b32 v[102:103],v6 offset0:64 offset1:96
s_waitcnt lgkmcnt(4)
v_perm_b32 v132,v108,v104,s61
v_perm_b32 v133,v109,v105,s61
v_perm_b32 v134,v110,v106,s61
v_perm_b32 v135,v111,v107,s61
v_perm_b32 v140,v108,v104,s62
v_perm_b32 v141,v109,v105,s62
v_perm_b32 v142,v110,v106,s62
v_perm_b32 v143,v111,v107,s62
v_xor_b32 v5,6144,v3
v_xor_b32 v6,6144,v4
ds_read2_b32 v[104:105],v5 offset1:32
ds_read2_b32 v[108:109],v6 offset1:32
ds_read2_b32 v[106:107],v5 offset0:64 offset1:96
ds_read2_b32 v[110:111],v6 offset0:64 offset1:96
s_waitcnt lgkmcnt(4)
v_perm_b32 v144,v100,v96,s61
v_perm_b32 v145,v101,v97,s61
v_perm_b32 v146,v102,v98,s61
v_perm_b32 v147,v103,v99,s61
v_perm_b32 v152,v100,v96,s62
v_perm_b32 v153,v101,v97,s62
v_perm_b32 v154,v102,v98,s62
v_perm_b32 v155,v103,v99,s62
v_xor_b32 v5,8192,v3
v_xor_b32 v6,8192,v4
ds_read2_b32 v[96:97],v5 offset1:32
ds_read2_b32 v[100:101],v6 offset1:32
ds_read2_b32 v[98:99],v5 offset0:64 offset1:96
ds_read2_b32 v[102:103],v6 offset0:64 offset1:96
s_waitcnt lgkmcnt(4)
v_perm_b32 v148,v108,v104,s61
v_perm_b32 v149,v109,v105,s61
v_perm_b32 v150,v110,v106,s61
v_perm_b32 v151,v111,v107,s61
v_perm_b32 v156,v108,v104,s62
v_perm_b32 v157,v109,v105,s62
v_perm_b32 v158,v110,v106,s62
v_perm_b32 v159,v111,v107,s62
v_xor_b32 v5,10240,v3
v_xor_b32 v6,10240,v4
ds_read2_b32 v[104:105],v5 offset1:32
ds_read2_b32 v[108:109],v6 offset1:32
ds_read2_b32 v[106:107],v5 offset0:64 offset1:96
ds_read2_b32 v[110:111],v6 offset0:64 offset1:96
s_waitcnt lgkmcnt(4)
v_perm_b32 v160,v100,v96,s61
v_perm_b32 v161,v101,v97,s61
v_perm_b32 v162,v102,v98,s61
v_perm_b32 v163,v103,v99,s61
v_perm_b32 v168,v100,v96,s62
v_perm_b32 v169,v101,v97,s62
v_perm_b32 v170,v102,v98,s62
v_perm_b32 v171,v103,v99,s62
v_xor_b32 v5,12288,v3
v_xor_b32 v6,12288,v4
ds_read2_b32 v[96:97],v5 offset1:32
ds_read2_b32 v[100:101],v6 offset1:32
ds_read2_b32 v[98:99],v5 offset0:64 offset1:96
ds_read2_b32 v[102:103],v6 offset0:64 offset1:96
s_waitcnt lgkmcnt(4)
v_perm_b32 v164,v108,v104,s61
v_perm_b32 v165,v109,v105,s61
v_perm_b32 v166,v110,v106,s61
v_perm_b32 v167,v111,v107,s61
v_perm_b32 v172,v108,v104,s62
v_perm_b32 v173,v109,v105,s62
v_perm_b32 v174,v110,v106,s62
v_perm_b32 v175,v111,v107,s62
v_xor_b32 v5,14336,v3
v_xor_b32 v6,14336,v4
ds_read2_b32 v[104:105],v5 offset1:32
ds_read2_b32 v[108:109],v6 offset1:32
ds_read2_b32 v[106:107],v5 offset0:64 offset1:96
ds_read2_b32 v[110:111],v6 offset0:64 offset1:96
s_waitcnt lgkmcnt(4)
v_perm_b32 v176,v100,v96,s61
v_perm_b32 v177,v101,v97,s61
v_perm_b32 v178,v102,v98,s61
v_perm_b32 v179,v103,v99,s61
v_perm_b32 v184,v100,v96,s62
v_perm_b32 v185,v101,v97,s62
v_perm_b32 v186,v102,v98,s62
v_perm_b32 v187,v103,v99,s62
s_waitcnt lgkmcnt(0)
s_mov_b32 s4,s20
s_mov_b32 s5,s21
s_mov_b32 s6,4194304
s_mov_b32 s7,0x20000
s_xor_b32 m0,s59,0
s_xor_b32 s60,s58,0
buffer_load_dwordx4 v2,s[4:7],s60 offen lds
s_add_u32 m0,m0,1024
s_add_u32 s60,s60,131072
buffer_load_dwordx4 v2,s[4:7],s60 offen lds
s_xor_b32 m0,s59,2048
s_xor_b32 s60,s58,262144
buffer_load_dwordx4 v2,s[4:7],s60 offen lds
s_add_u32 m0,m0,1024
s_add_u32 s60,s60,131072
buffer_load_dwordx4 v2,s[4:7],s60 offen lds
s_xor_b32 m0,s59,4096
s_xor_b32 s60,s58,524288
buffer_load_dwordx4 v2,s[4:7],s60 offen lds
s_add_u32 m0,m0,1024
s_add_u32 s60,s60,131072
buffer_load_dwordx4 v2,s[4:7],s60 offen lds
s_xor_b32 m0,s59,6144
s_xor_b32 s60,s58,786432
buffer_load_dwordx4 v2,s[4:7],s60 offen lds
s_add_u32 m0,m0,1024
s_add_u32 s60,s60,131072
buffer_load_dwordx4 v2,s[4:7],s60 offen lds
s_xor_b32 m0,s59,8192
s_xor_b32 s60,s58,1048576
buffer_load_dwordx4 v2,s[4:7],s60 offen lds
s_add_u32 m0,m0,1024
s_add_u32 s60,s60,131072
buffer_load_dwordx4 v2,s[4:7],s60 offen lds
s_xor_b32 m0,s59,10240
s_xor_b32 s60,s58,1310720
buffer_load_dwordx4 v2,s[4:7],s60 offen lds
s_add_u32 m0,m0,1024
s_add_u32 s60,s60,131072
buffer_load_dwordx4 v2,s[4:7],s60 offen lds
s_xor_b32 m0,s59,12288
s_xor_b32 s60,s58,1572864
buffer_load_dwordx4 v2,s[4:7],s60 offen lds
s_add_u32 m0,m0,1024
s_add_u32 s60,s60,131072
buffer_load_dwordx4 v2,s[4:7],s60 offen lds
s_xor_b32 m0,s59,14336
s_xor_b32 s60,s58,1835008
buffer_load_dwordx4 v2,s[4:7],s60 offen lds
s_add_u32 m0,m0,1024
s_add_u32 s60,s60,131072
buffer_load_dwordx4 v2,s[4:7],s60 offen lds
v_perm_b32 v180,v108,v104,s61
v_perm_b32 v181,v109,v105,s61
v_perm_b32 v182,v110,v106,s61
v_perm_b32 v183,v111,v107,s61
v_perm_b32 v188,v108,v104,s62
v_perm_b32 v189,v109,v105,s62
v_perm_b32 v190,v110,v106,s62
v_perm_b32 v191,v111,v107,s62
s_waitcnt vmcnt(16)
v_xor_b32 v5,16384,v3
v_xor_b32 v6,16384,v4
ds_read2_b32 v[96:97],v5 offset1:32
ds_read2_b32 v[100:101],v6 offset1:32
ds_read2_b32 v[98:99],v5 offset0:64 offset1:96
ds_read2_b32 v[102:103],v6 offset0:64 offset1:96
v_xor_b32 v5,18432,v3
v_xor_b32 v6,18432,v4
ds_read2_b32 v[104:105],v5 offset1:32
ds_read2_b32 v[108:109],v6 offset1:32
ds_read2_b32 v[106:107],v5 offset0:64 offset1:96
ds_read2_b32 v[110:111],v6 offset0:64 offset1:96
s_waitcnt lgkmcnt(4)
v_perm_b32 v192,v100,v96,s61
v_perm_b32 v193,v101,v97,s61
v_perm_b32 v194,v102,v98,s61
v_perm_b32 v195,v103,v99,s61
v_perm_b32 v200,v100,v96,s62
v_perm_b32 v201,v101,v97,s62
v_perm_b32 v202,v102,v98,s62
v_perm_b32 v203,v103,v99,s62
v_xor_b32 v5,20480,v3
v_xor_b32 v6,20480,v4
ds_read2_b32 v[96:97],v5 offset1:32
ds_read2_b32 v[100:101],v6 offset1:32
ds_read2_b32 v[98:99],v5 offset0:64 offset1:96
ds_read2_b32 v[102:103],v6 offset0:64 offset1:96
s_waitcnt lgkmcnt(4)
v_perm_b32 v196,v108,v104,s61
v_perm_b32 v197,v109,v105,s61
v_perm_b32 v198,v110,v106,s61
v_perm_b32 v199,v111,v107,s61
v_perm_b32 v204,v108,v104,s62
v_perm_b32 v205,v109,v105,s62
v_perm_b32 v206,v110,v106,s62
v_perm_b32 v207,v111,v107,s62
v_xor_b32 v5,22528,v3
v_xor_b32 v6,22528,v4
ds_read2_b32 v[104:105],v5 offset1:32
ds_read2_b32 v[108:109],v6 offset1:32
ds_read2_b32 v[106:107],v5 offset0:64 offset1:96
ds_read2_b32 v[110:111],v6 offset0:64 offset1:96
s_waitcnt lgkmcnt(4)
v_perm_b32 v208,v100,v96,s61
v_perm_b32 v209,v101,v97,s61
v_perm_b32 v210,v102,v98,s61
v_perm_b32 v211,v103,v99,s61
v_perm_b32 v216,v100,v96,s62
v_perm_b32 v217,v101,v97,s62
v_perm_b32 v218,v102,v98,s62
v_perm_b32 v219,v103,v99,s62
v_xor_b32 v5,24576,v3
v_xor_b32 v6,24576,v4
ds_read2_b32 v[96:97],v5 offset1:32
ds_read2_b32 v[100:101],v6 offset1:32
ds_read2_b32 v[98:99],v5 offset0:64 offset1:96
ds_read2_b32 v[102:103],v6 offset0:64 offset1:96
s_waitcnt lgkmcnt(4)
v_perm_b32 v212,v108,v104,s61
v_perm_b32 v213,v109,v105,s61
v_perm_b32 v214,v110,v106,s61
v_perm_b32 v215,v111,v107,s61
v_perm_b32 v220,v108,v104,s62
v_perm_b32 v221,v109,v105,s62
v_perm_b32 v222,v110,v106,s62
v_perm_b32 v223,v111,v107,s62
v_xor_b32 v5,26624,v3
v_xor_b32 v6,26624,v4
ds_read2_b32 v[104:105],v5 offset1:32
ds_read2_b32 v[108:109],v6 offset1:32
ds_read2_b32 v[106:107],v5 offset0:64 offset1:96
ds_read2_b32 v[110:111],v6 offset0:64 offset1:96
s_waitcnt lgkmcnt(4)
v_perm_b32 v224,v100,v96,s61
v_perm_b32 v225,v101,v97,s61
v_perm_b32 v226,v102,v98,s61
v_perm_b32 v227,v103,v99,s61
v_perm_b32 v232,v100,v96,s62
v_perm_b32 v233,v101,v97,s62
v_perm_b32 v234,v102,v98,s62
v_perm_b32 v235,v103,v99,s62
v_xor_b32 v5,28672,v3
v_xor_b32 v6,28672,v4
ds_read2_b32 v[96:97],v5 offset1:32
ds_read2_b32 v[100:101],v6 offset1:32
ds_read2_b32 v[98:99],v5 offset0:64 offset1:96
ds_read2_b32 v[102:103],v6 offset0:64 offset1:96
s_waitcnt lgkmcnt(4)
v_perm_b32 v228,v108,v104,s61
v_perm_b32 v229,v109,v105,s61
v_perm_b32 v230,v110,v106,s61
v_perm_b32 v231,v111,v107,s61
v_perm_b32 v236,v108,v104,s62
v_perm_b32 v237,v109,v105,s62
v_perm_b32 v238,v110,v106,s62
v_perm_b32 v239,v111,v107,s62
v_xor_b32 v5,30720,v3
v_xor_b32 v6,30720,v4
ds_read2_b32 v[104:105],v5 offset1:32
ds_read2_b32 v[108:109],v6 offset1:32
ds_read2_b32 v[106:107],v5 offset0:64 offset1:96
ds_read2_b32 v[110:111],v6 offset0:64 offset1:96
s_waitcnt lgkmcnt(4)
v_perm_b32 v240,v100,v96,s61
v_perm_b32 v241,v101,v97,s61
v_perm_b32 v242,v102,v98,s61
v_perm_b32 v243,v103,v99,s61
v_perm_b32 v248,v100,v96,s62
v_perm_b32 v249,v101,v97,s62
v_perm_b32 v250,v102,v98,s62
v_perm_b32 v251,v103,v99,s62
s_waitcnt lgkmcnt(0)
s_xor_b32 m0,s59,16384
s_xor_b32 s60,s58,2097152
buffer_load_dwordx4 v2,s[4:7],s60 offen lds
s_add_u32 m0,m0,1024
s_add_u32 s60,s60,131072
buffer_load_dwordx4 v2,s[4:7],s60 offen lds
s_xor_b32 m0,s59,18432
s_xor_b32 s60,s58,2359296
buffer_load_dwordx4 v2,s[4:7],s60 offen lds
s_add_u32 m0,m0,1024
s_add_u32 s60,s60,131072
buffer_load_dwordx4 v2,s[4:7],s60 offen lds
s_xor_b32 m0,s59,20480
s_xor_b32 s60,s58,2621440
buffer_load_dwordx4 v2,s[4:7],s60 offen lds
s_add_u32 m0,m0,1024
s_add_u32 s60,s60,131072
buffer_load_dwordx4 v2,s[4:7],s60 offen lds
s_xor_b32 m0,s59,22528
s_xor_b32 s60,s58,2883584
buffer_load_dwordx4 v2,s[4:7],s60 offen lds
s_add_u32 m0,m0,1024
s_add_u32 s60,s60,131072
buffer_load_dwordx4 v2,s[4:7],s60 offen lds
s_xor_b32 m0,s59,24576
s_xor_b32 s60,s58,3145728
buffer_load_dwordx4 v2,s[4:7],s60 offen lds
s_add_u32 m0,m0,1024
s_add_u32 s60,s60,131072
buffer_load_dwordx4 v2,s[4:7],s60 offen lds
s_xor_b32 m0,s59,26624
s_xor_b32 s60,s58,3407872
buffer_load_dwordx4 v2,s[4:7],s60 offen lds
s_add_u32 m0,m0,1024
s_add_u32 s60,s60,131072
buffer_load_dwordx4 v2,s[4:7],s60 offen lds
s_xor_b32 m0,s59,28672
s_xor_b32 s60,s58,3670016
buffer_load_dwordx4 v2,s[4:7],s60 offen lds
s_add_u32 m0,m0,1024
s_add_u32 s60,s60,131072
buffer_load_dwordx4 v2,s[4:7],s60 offen lds
s_xor_b32 m0,s59,30720
s_xor_b32 s60,s58,3932160
buffer_load_dwordx4 v2,s[4:7],s60 offen lds
s_add_u32 m0,m0,1024
s_add_u32 s60,s60,131072
buffer_load_dwordx4 v2,s[4:7],s60 offen lds
v_perm_b32 v244,v108,v104,s61
v_perm_b32 v245,v109,v105,s61
v_perm_b32 v246,v110,v106,s61
v_perm_b32 v247,v111,v107,s61
v_perm_b32 v252,v108,v104,s62
v_perm_b32 v253,v109,v105,s62
v_perm_b32 v254,v110,v106,s62
v_perm_b32 v255,v111,v107,s62
s_waitcnt vmcnt(16)
v_xor_b32 v5,0,v3
v_xor_b32 v6,0,v4
ds_read2_b32 v[96:97],v5 offset1:32
ds_read2_b32 v[100:101],v6 offset1:32
ds_read2_b32 v[98:99],v5 offset0:64 offset1:96
ds_read2_b32 v[102:103],v6 offset0:64 offset1:96
v_xor_b32 v5,2048,v3
v_xor_b32 v6,2048,v4
ds_read2_b32 v[104:105],v5 offset1:32
ds_read2_b32 v[108:109],v6 offset1:32
ds_read2_b32 v[106:107],v5 offset0:64 offset1:96
ds_read2_b32 v[110:111],v6 offset0:64 offset1:96
s_waitcnt lgkmcnt(4)
v_perm_b32 v112,v100,v96,s61
v_perm_b32 v113,v101,v97,s61
v_perm_b32 v114,v102,v98,s61
v_perm_b32 v115,v103,v99,s61
v_perm_b32 v116,v100,v96,s62
v_perm_b32 v117,v101,v97,s62
v_perm_b32 v118,v102,v98,s62
v_perm_b32 v119,v103,v99,s62
v_accvgpr_write_b32 a0,v112
v_accvgpr_write_b32 a1,v113
v_accvgpr_write_b32 a2,v114
v_accvgpr_write_b32 a3,v115
v_accvgpr_write_b32 a8,v116
v_accvgpr_write_b32 a9,v117
v_accvgpr_write_b32 a10,v118
v_accvgpr_write_b32 a11,v119
v_xor_b32 v5,4096,v3
v_xor_b32 v6,4096,v4
ds_read2_b32 v[96:97],v5 offset1:32
ds_read2_b32 v[100:101],v6 offset1:32
ds_read2_b32 v[98:99],v5 offset0:64 offset1:96
ds_read2_b32 v[102:103],v6 offset0:64 offset1:96
s_waitcnt lgkmcnt(4)
v_perm_b32 v112,v108,v104,s61
v_perm_b32 v113,v109,v105,s61
v_perm_b32 v114,v110,v106,s61
v_perm_b32 v115,v111,v107,s61
v_perm_b32 v116,v108,v104,s62
v_perm_b32 v117,v109,v105,s62
v_perm_b32 v118,v110,v106,s62
v_perm_b32 v119,v111,v107,s62
v_accvgpr_write_b32 a4,v112
v_accvgpr_write_b32 a5,v113
v_accvgpr_write_b32 a6,v114
v_accvgpr_write_b32 a7,v115
v_accvgpr_write_b32 a12,v116
v_accvgpr_write_b32 a13,v117
v_accvgpr_write_b32 a14,v118
v_accvgpr_write_b32 a15,v119
v_xor_b32 v5,6144,v3
v_xor_b32 v6,6144,v4
ds_read2_b32 v[104:105],v5 offset1:32
ds_read2_b32 v[108:109],v6 offset1:32
ds_read2_b32 v[106:107],v5 offset0:64 offset1:96
ds_read2_b32 v[110:111],v6 offset0:64 offset1:96
s_waitcnt lgkmcnt(4)
v_perm_b32 v112,v100,v96,s61
v_perm_b32 v113,v101,v97,s61
v_perm_b32 v114,v102,v98,s61
v_perm_b32 v115,v103,v99,s61
v_perm_b32 v116,v100,v96,s62
v_perm_b32 v117,v101,v97,s62
v_perm_b32 v118,v102,v98,s62
v_perm_b32 v119,v103,v99,s62
v_accvgpr_write_b32 a16,v112
v_accvgpr_write_b32 a17,v113
v_accvgpr_write_b32 a18,v114
v_accvgpr_write_b32 a19,v115
v_accvgpr_write_b32 a24,v116
v_accvgpr_write_b32 a25,v117
v_accvgpr_write_b32 a26,v118
v_accvgpr_write_b32 a27,v119
v_xor_b32 v5,8192,v3
v_xor_b32 v6,8192,v4
ds_read2_b32 v[96:97],v5 offset1:32
ds_read2_b32 v[100:101],v6 offset1:32
ds_read2_b32 v[98:99],v5 offset0:64 offset1:96
ds_read2_b32 v[102:103],v6 offset0:64 offset1:96
s_waitcnt lgkmcnt(4)
v_perm_b32 v112,v108,v104,s61
v_perm_b32 v113,v109,v105,s61
v_perm_b32 v114,v110,v106,s61
v_perm_b32 v115,v111,v107,s61
v_perm_b32 v116,v108,v104,s62
v_perm_b32 v117,v109,v105,s62
v_perm_b32 v118,v110,v106,s62
v_perm_b32 v119,v111,v107,s62
v_accvgpr_write_b32 a20,v112
v_accvgpr_write_b32 a21,v113
v_accvgpr_write_b32 a22,v114
v_accvgpr_write_b32 a23,v115
v_accvgpr_write_b32 a28,v116
v_accvgpr_write_b32 a29,v117
v_accvgpr_write_b32 a30,v118
v_accvgpr_write_b32 a31,v119
v_xor_b32 v5,10240,v3
v_xor_b32 v6,10240,v4
ds_read2_b32 v[104:105],v5 offset1:32
ds_read2_b32 v[108:109],v6 offset1:32
ds_read2_b32 v[106:107],v5 offset0:64 offset1:96
ds_read2_b32 v[110:111],v6 offset0:64 offset1:96
s_waitcnt lgkmcnt(4)
v_perm_b32 v112,v100,v96,s61
v_perm_b32 v113,v101,v97,s61
v_perm_b32 v114,v102,v98,s61
v_perm_b32 v115,v103,v99,s61
v_perm_b32 v116,v100,v96,s62
v_perm_b32 v117,v101,v97,s62
v_perm_b32 v118,v102,v98,s62
v_perm_b32 v119,v103,v99,s62
v_accvgpr_write_b32 a32,v112
v_accvgpr_write_b32 a33,v113
v_accvgpr_write_b32 a34,v114
v_accvgpr_write_b32 a35,v115
v_accvgpr_write_b32 a40,v116
v_accvgpr_write_b32 a41,v117
v_accvgpr_write_b32 a42,v118
v_accvgpr_write_b32 a43,v119
v_xor_b32 v5,12288,v3
v_xor_b32 v6,12288,v4
ds_read2_b32 v[96:97],v5 offset1:32
ds_read2_b32 v[100:101],v6 offset1:32
ds_read2_b32 v[98:99],v5 offset0:64 offset1:96
ds_read2_b32 v[102:103],v6 offset0:64 offset1:96
s_waitcnt lgkmcnt(4)
v_perm_b32 v112,v108,v104,s61
v_perm_b32 v113,v109,v105,s61
v_perm_b32 v114,v110,v106,s61
v_perm_b32 v115,v111,v107,s61
v_perm_b32 v116,v108,v104,s62
v_perm_b32 v117,v109,v105,s62
v_perm_b32 v118,v110,v106,s62
v_perm_b32 v119,v111,v107,s62
v_accvgpr_write_b32 a36,v112
v_accvgpr_write_b32 a37,v113
v_accvgpr_write_b32 a38,v114
v_accvgpr_write_b32 a39,v115
v_accvgpr_write_b32 a44,v116
v_accvgpr_write_b32 a45,v117
v_accvgpr_write_b32 a46,v118
v_accvgpr_write_b32 a47,v119
v_xor_b32 v5,14336,v3
v_xor_b32 v6,14336,v4
ds_read2_b32 v[104:105],v5 offset1:32
ds_read2_b32 v[108:109],v6 offset1:32
ds_read2_b32 v[106:107],v5 offset0:64 offset1:96
ds_read2_b32 v[110:111],v6 offset0:64 offset1:96
s_waitcnt lgkmcnt(4)
v_perm_b32 v112,v100,v96,s61
v_perm_b32 v113,v101,v97,s61
v_perm_b32 v114,v102,v98,s61
v_perm_b32 v115,v103,v99,s61
v_perm_b32 v116,v100,v96,s62
v_perm_b32 v117,v101,v97,s62
v_perm_b32 v118,v102,v98,s62
v_perm_b32 v119,v103,v99,s62
v_accvgpr_write_b32 a48,v112
v_accvgpr_write_b32 a49,v113
v_accvgpr_write_b32 a50,v114
v_accvgpr_write_b32 a51,v115
v_accvgpr_write_b32 a56,v116
v_accvgpr_write_b32 a57,v117
v_accvgpr_write_b32 a58,v118
v_accvgpr_write_b32 a59,v119
s_waitcnt lgkmcnt(0)
v_perm_b32 v112,v108,v104,s61
v_perm_b32 v113,v109,v105,s61
v_perm_b32 v114,v110,v106,s61
v_perm_b32 v115,v111,v107,s61
v_perm_b32 v116,v108,v104,s62
v_perm_b32 v117,v109,v105,s62
v_perm_b32 v118,v110,v106,s62
v_perm_b32 v119,v111,v107,s62
v_accvgpr_write_b32 a52,v112
v_accvgpr_write_b32 a53,v113
v_accvgpr_write_b32 a54,v114
v_accvgpr_write_b32 a55,v115
v_accvgpr_write_b32 a60,v116
v_accvgpr_write_b32 a61,v117
v_accvgpr_write_b32 a62,v118
v_accvgpr_write_b32 a63,v119
s_mov_b32 s4,s26
s_mov_b32 s5,s27
s_mov_b32 s6,4194304
s_mov_b32 s7,0x20000
v_and_b32 v92,3,v1
v_lshlrev_b32 v93,4,v92
v_bfe_u32 v94,v1,2,2
v_lshl_add_u32 v92,v94,12,v93
v_lshl_add_u32 v93,v94,8,v93
v_and_b32 v94,1,v94
v_lshl_add_u32 v93,v94,6,v93
v_lshrrev_b32 v94,4,v1
v_lshl_add_u32 v92,v94,8,v92
v_lshl_add_u32 v93,v94,13,v93
s_lshl_b32 s56,s46,15
v_add_u32 v93,s56,v93
v_xor_b32 v94,64,v93
s_lshl_b32 s56,s47,17
s_lshl_b32 s57,s46,6
s_add_u32 s56,s56,s57
v_add_u32 v92,s56,v92
s_cmp_ge_u32 s48,3
s_cbranch_scc1 L_lw_15
s_mov_b32 s56,0
buffer_load_dwordx4 v[24:27],v92,s[4:7],s56 offen offset:0
buffer_load_dwordx4 v[28:31],v92,s[4:7],s56 offen offset:1024
buffer_load_dwordx4 v[32:35],v92,s[4:7],s56 offen offset:2048
buffer_load_dwordx4 v[36:39],v92,s[4:7],s56 offen offset:3072
s_mov_b32 s56,16384
buffer_load_dwordx4 v[40:43],v92,s[4:7],s56 offen offset:0
buffer_load_dwordx4 v[44:47],v92,s[4:7],s56 offen offset:1024
buffer_load_dwordx4 v[48:51],v92,s[4:7],s56 offen offset:2048
buffer_load_dwordx4 v[52:55],v92,s[4:7],s56 offen offset:3072
s_mov_b32 s56,32768
buffer_load_dwordx4 v[56:59],v92,s[4:7],s56 offen offset:0
buffer_load_dwordx4 v[60:63],v92,s[4:7],s56 offen offset:1024
buffer_load_dwordx4 v[64:67],v92,s[4:7],s56 offen offset:2048
buffer_load_dwordx4 v[68:71],v92,s[4:7],s56 offen offset:3072
s_mov_b32 s56,49152
buffer_load_dwordx4 v[72:75],v92,s[4:7],s56 offen offset:0
buffer_load_dwordx4 v[76:79],v92,s[4:7],s56 offen offset:1024
buffer_load_dwordx4 v[80:83],v92,s[4:7],s56 offen offset:2048
buffer_load_dwordx4 v[84:87],v92,s[4:7],s56 offen offset:3072
s_waitcnt vmcnt(16)
s_branch L_lj_16
L_lw_15:
s_waitcnt vmcnt(0)
L_lj_16:
v_xor_b32 v5,16384,v3
v_xor_b32 v6,16384,v4
ds_read2_b32 v[96:97],v5 offset1:32
ds_read2_b32 v[100:101],v6 offset1:32
ds_read2_b32 v[98:99],v5 offset0:64 offset1:96
ds_read2_b32 v[102:103],v6 offset0:64 offset1:96
v_xor_b32 v5,18432,v3
v_xor_b32 v6,18432,v4
ds_read2_b32 v[104:105],v5 offset1:32
ds_read2_b32 v[108:109],v6 offset1:32
ds_read2_b32 v[106:107],v5 offset0:64 offset1:96
ds_read2_b32 v[110:111],v6 offset0:64 offset1:96
s_waitcnt lgkmcnt(4)
v_perm_b32 v112,v100,v96,s61
v_perm_b32 v113,v101,v97,s61
v_perm_b32 v114,v102,v98,s61
v_perm_b32 v115,v103,v99,s61
v_perm_b32 v116,v100,v96,s62
v_perm_b32 v117,v101,v97,s62
v_perm_b32 v118,v102,v98,s62
v_perm_b32 v119,v103,v99,s62
v_accvgpr_write_b32 a64,v112
v_accvgpr_write_b32 a65,v113
v_accvgpr_write_b32 a66,v114
v_accvgpr_write_b32 a67,v115
v_accvgpr_write_b32 a72,v116
v_accvgpr_write_b32 a73,v117
v_accvgpr_write_b32 a74,v118
v_accvgpr_write_b32 a75,v119
v_xor_b32 v5,20480,v3
v_xor_b32 v6,20480,v4
ds_read2_b32 v[96:97],v5 offset1:32
ds_read2_b32 v[100:101],v6 offset1:32
ds_read2_b32 v[98:99],v5 offset0:64 offset1:96
ds_read2_b32 v[102:103],v6 offset0:64 offset1:96
s_waitcnt lgkmcnt(4)
v_perm_b32 v112,v108,v104,s61
v_perm_b32 v113,v109,v105,s61
v_perm_b32 v114,v110,v106,s61
v_perm_b32 v115,v111,v107,s61
v_perm_b32 v116,v108,v104,s62
v_perm_b32 v117,v109,v105,s62
v_perm_b32 v118,v110,v106,s62
v_perm_b32 v119,v111,v107,s62
v_accvgpr_write_b32 a68,v112
v_accvgpr_write_b32 a69,v113
v_accvgpr_write_b32 a70,v114
v_accvgpr_write_b32 a71,v115
v_accvgpr_write_b32 a76,v116
v_accvgpr_write_b32 a77,v117
v_accvgpr_write_b32 a78,v118
v_accvgpr_write_b32 a79,v119
v_xor_b32 v5,22528,v3
v_xor_b32 v6,22528,v4
ds_read2_b32 v[104:105],v5 offset1:32
ds_read2_b32 v[108:109],v6 offset1:32
ds_read2_b32 v[106:107],v5 offset0:64 offset1:96
ds_read2_b32 v[110:111],v6 offset0:64 offset1:96
s_waitcnt lgkmcnt(4)
v_perm_b32 v112,v100,v96,s61
v_perm_b32 v113,v101,v97,s61
v_perm_b32 v114,v102,v98,s61
v_perm_b32 v115,v103,v99,s61
v_perm_b32 v116,v100,v96,s62
v_perm_b32 v117,v101,v97,s62
v_perm_b32 v118,v102,v98,s62
v_perm_b32 v119,v103,v99,s62
v_accvgpr_write_b32 a80,v112
v_accvgpr_write_b32 a81,v113
v_accvgpr_write_b32 a82,v114
v_accvgpr_write_b32 a83,v115
v_accvgpr_write_b32 a88,v116
v_accvgpr_write_b32 a89,v117
v_accvgpr_write_b32 a90,v118
v_accvgpr_write_b32 a91,v119
v_xor_b32 v5,24576,v3
v_xor_b32 v6,24576,v4
ds_read2_b32 v[96:97],v5 offset1:32
ds_read2_b32 v[100:101],v6 offset1:32
ds_read2_b32 v[98:99],v5 offset0:64 offset1:96
ds_read2_b32 v[102:103],v6 offset0:64 offset1:96
s_waitcnt lgkmcnt(4)
v_perm_b32 v112,v108,v104,s61
v_perm_b32 v113,v109,v105,s61
v_perm_b32 v114,v110,v106,s61
v_perm_b32 v115,v111,v107,s61
v_perm_b32 v116,v108,v104,s62
v_perm_b32 v117,v109,v105,s62
v_perm_b32 v118,v110,v106,s62
v_perm_b32 v119,v111,v107,s62
v_accvgpr_write_b32 a84,v112
v_accvgpr_write_b32 a85,v113
v_accvgpr_write_b32 a86,v114
v_accvgpr_write_b32 a87,v115
v_accvgpr_write_b32 a92,v116
v_accvgpr_write_b32 a93,v117
v_accvgpr_write_b32 a94,v118
v_accvgpr_write_b32 a95,v119
v_xor_b32 v5,26624,v3
v_xor_b32 v6,26624,v4
ds_read2_b32 v[104:105],v5 offset1:32
ds_read2_b32 v[108:109],v6 offset1:32
ds_read2_b32 v[106:107],v5 offset0:64 offset1:96
ds_read2_b32 v[110:111],v6 offset0:64 offset1:96
s_waitcnt lgkmcnt(4)
v_perm_b32 v112,v100,v96,s61
v_perm_b32 v113,v101,v97,s61
v_perm_b32 v114,v102,v98,s61
v_perm_b32 v115,v103,v99,s61
v_perm_b32 v116,v100,v96,s62
v_perm_b32 v117,v101,v97,s62
v_perm_b32 v118,v102,v98,s62
v_perm_b32 v119,v103,v99,s62
v_accvgpr_write_b32 a96,v112
v_accvgpr_write_b32 a97,v113
v_accvgpr_write_b32 a98,v114
v_accvgpr_write_b32 a99,v115
v_accvgpr_write_b32 a104,v116
v_accvgpr_write_b32 a105,v117
v_accvgpr_write_b32 a106,v118
v_accvgpr_write_b32 a107,v119
v_xor_b32 v5,28672,v3
v_xor_b32 v6,28672,v4
ds_read2_b32 v[96:97],v5 offset1:32
ds_read2_b32 v[100:101],v6 offset1:32
ds_read2_b32 v[98:99],v5 offset0:64 offset1:96
ds_read2_b32 v[102:103],v6 offset0:64 offset1:96
s_waitcnt lgkmcnt(4)
v_perm_b32 v112,v108,v104,s61
v_perm_b32 v113,v109,v105,s61
v_perm_b32 v114,v110,v106,s61
v_perm_b32 v115,v111,v107,s61
v_perm_b32 v116,v108,v104,s62
v_perm_b32 v117,v109,v105,s62
v_perm_b32 v118,v110,v106,s62
v_perm_b32 v119,v111,v107,s62
v_accvgpr_write_b32 a100,v112
v_accvgpr_write_b32 a101,v113
v_accvgpr_write_b32 a102,v114
v_accvgpr_write_b32 a103,v115
v_accvgpr_write_b32 a108,v116
v_accvgpr_write_b32 a109,v117
v_accvgpr_write_b32 a110,v118
v_accvgpr_write_b32 a111,v119
v_xor_b32 v5,30720,v3
v_xor_b32 v6,30720,v4
ds_read2_b32 v[104:105],v5 offset1:32
ds_read2_b32 v[108:109],v6 offset1:32
ds_read2_b32 v[106:107],v5 offset0:64 offset1:96
ds_read2_b32 v[110:111],v6 offset0:64 offset1:96
s_waitcnt lgkmcnt(4)
v_perm_b32 v112,v100,v96,s61
v_perm_b32 v113,v101,v97,s61
v_perm_b32 v114,v102,v98,s61
v_perm_b32 v115,v103,v99,s61
v_perm_b32 v116,v100,v96,s62
v_perm_b32 v117,v101,v97,s62
v_perm_b32 v118,v102,v98,s62
v_perm_b32 v119,v103,v99,s62
v_accvgpr_write_b32 a112,v112
v_accvgpr_write_b32 a113,v113
v_accvgpr_write_b32 a114,v114
v_accvgpr_write_b32 a115,v115
v_accvgpr_write_b32 a120,v116
v_accvgpr_write_b32 a121,v117
v_accvgpr_write_b32 a122,v118
v_accvgpr_write_b32 a123,v119
s_waitcnt lgkmcnt(0)
v_perm_b32 v112,v108,v104,s61
v_perm_b32 v113,v109,v105,s61
v_perm_b32 v114,v110,v106,s61
v_perm_b32 v115,v111,v107,s61
v_perm_b32 v116,v108,v104,s62
v_perm_b32 v117,v109,v105,s62
v_perm_b32 v118,v110,v106,s62
v_perm_b32 v119,v111,v107,s62
v_accvgpr_write_b32 a116,v112
v_accvgpr_write_b32 a117,v113
v_accvgpr_write_b32 a118,v114
v_accvgpr_write_b32 a119,v115
v_accvgpr_write_b32 a124,v116
v_accvgpr_write_b32 a125,v117
v_accvgpr_write_b32 a126,v118
v_accvgpr_write_b32 a127,v119
s_cmp_lt_u32 s48,3
s_cbranch_scc1 L_rch_4
s_cmp_eq_u32 s48,3
s_cbranch_scc1 L_rm_5
v_mov_b32 v123,159744
s_cmp_lg_u32 s46,0
s_cbranch_scc1 L_gbd_18
v_mov_b32 v124,128
L_gb_17:
buffer_load_dword v125,v124,s[12:15],0 offen sc1
s_waitcnt vmcnt(0)
v_readfirstlane_b32 s56,v125
ds_write_b32 v123,v125
s_bitcmp1_b32 s56,8
s_cbranch_scc1 L_gbd_18
s_sleep 4
s_sub_u32 s49,s49,1
s_cmp_gt_i32 s49,0
s_cbranch_scc1 L_gb_17
s_branch L_abort
L_gbd_18:
s_waitcnt lgkmcnt(0)
s_barrier
ds_read_b32 v125,v123
s_waitcnt lgkmcnt(0)
v_readfirstlane_b32 s56,v125
s_barrier
s_lshr_b32 s56,s56,16
s_andn2_b32 s56,s56,s3
s_cbranch_scc1 L_spread
v_and_b32 v120,15,v1
v_lshrrev_b32 v121,4,v1
v_mov_b32 v17,1
s_lshl_b32 s56,s46,15
v_add_u32 v18,s56,v0
s_lshl_b32 s56,s46,2
v_add_u32 v125,s56,v121
v_xor_b32 v126,v125,v120
v_lshlrev_b32 v126,4,v126
v_lshl_add_u32 v20,v125,10,v126
v_add_u32 v125,0,v121
v_xor_b32 v125,v125,v120
v_lshlrev_b32 v125,4,v125
v_lshl_add_u32 v125,v120,8,v125
v_add_u32 v4,65536,v125
v_add_u32 v125,4,v121
v_xor_b32 v125,v125,v120
v_lshlrev_b32 v125,4,v125
v_lshl_add_u32 v125,v120,8,v125
v_add_u32 v5,65536,v125
v_add_u32 v125,8,v121
v_xor_b32 v125,v125,v120
v_lshlrev_b32 v125,4,v125
v_lshl_add_u32 v125,v120,8,v125
v_add_u32 v6,65536,v125
v_add_u32 v125,12,v121
v_xor_b32 v125,v125,v120
v_lshlrev_b32 v125,4,v125
v_lshl_add_u32 v125,v120,8,v125
v_add_u32 v7,65536,v125
v_lshlrev_b32 v21,5,v120
v_and_b32 v125,1,v121
v_lshl_add_u32 v21,v125,4,v21
s_lshl_b32 s56,s46,9
v_lshrrev_b32 v125,1,v121
v_lshl_add_u32 v21,v125,11,v21
s_add_u32 s56,s56,155648
v_add_u32 v21,s56,v21
v_lshlrev_b32 v22,4,v120
v_lshl_add_u32 v22,v121,10,v22
s_lshl_b32 s56,s46,8
v_add_u32 v22,s56,v22
s_sub_u32 s54,s48,4
s_cmp_eq_u32 s54,0
s_mov_b32 s72,1073752746
s_mov_b32 s73,1145324612
s_cmov_b32 s72,268440917
s_cmov_b32 s73,286331153
s_mov_b32 s70,0x80000000
s_mov_b32 s53,7
s_mov_b32 s74,s50
s_xor_b32 s75,s74,32768
v_and_b32 v23,31,v1
v_lshlrev_b32 v23,2,v23
v_mov_b32 v19,s50
v_mov_b32 v16,0
s_ff1_i32_b64 s55,s[72:73]
s_bitset0_b64 s[72:73],s55
s_min_u32 s55,s55,127
s_lshl_b32 s68,s55,15
s_add_u32 s68,s68,0
s_add_u32 s69,s68,16384
s_add_u32 m0,s75,65536
s_nop 0
buffer_load_dwordx4 v20,s[8:11],s68 offen offset:0 sc1 lds
s_add_u32 m0,s75,69632
s_nop 0
buffer_load_dwordx4 v20,s[8:11],s69 offen offset:0 sc1 lds
s_add_u32 m0,s75,73472
s_nop 0
buffer_load_dwordx4 v20,s[8:11],s68 offen offset:256 sc1 lds
s_add_u32 m0,s75,77568
s_nop 0
buffer_load_dwordx4 v20,s[8:11],s69 offen offset:256 sc1 lds
s_add_u32 m0,s75,81408
s_nop 0
buffer_load_dwordx4 v20,s[8:11],s68 offen offset:512 sc1 lds
s_add_u32 m0,s75,85504
s_nop 0
buffer_load_dwordx4 v20,s[8:11],s69 offen offset:512 sc1 lds
s_add_u32 m0,s75,89344
s_nop 0
buffer_load_dwordx4 v20,s[8:11],s68 offen offset:768 sc1 lds
s_add_u32 m0,s75,93440
s_nop 0
buffer_load_dwordx4 v20,s[8:11],s69 offen offset:768 sc1 lds
s_waitcnt vmcnt(0)
s_barrier
L_p_19:
s_mov_b32 s75,s74
s_xor_b32 s74,s74,32768
v_xor_b32 v4,32768,v4
v_xor_b32 v5,32768,v5
v_xor_b32 v6,32768,v6
v_xor_b32 v7,32768,v7
ds_read_b128 v[104:107],v4 offset:0
ds_read_b128 v[108:111],v4 offset:4096
ds_read_b128 v[112:115],v5 offset:0
ds_read_b128 v[116:119],v5 offset:4096
s_waitcnt lgkmcnt(2)
v_mfma_f32_16x16x32_bf16 v[24:27],a[128:131],v[104:107],0
ds_read_b128 v[120:123],v6 offset:0
v_mfma_f32_16x16x32_bf16 v[40:43],v[104:107],v[128:131],0
s_mov_b32 s51,s55
v_mfma_f32_16x16x32_bf16 v[28:31],a[128:131],v[108:111],0
ds_read_b128 v[124:127],v6 offset:4096
v_mfma_f32_16x16x32_bf16 v[44:47],v[108:111],v[128:131],0
s_mov_b32 s77,0
v_mfma_f32_16x16x32_bf16 v[32:35],a[136:139],v[104:107],0
s_sub_u32 s53,s53,1
v_mfma_f32_16x16x32_bf16 v[48:51],v[104:107],v[136:139],0
s_ff1_i32_b64 s55,s[72:73]
v_mfma_f32_16x16x32_bf16 v[36:39],a[136:139],v[108:111],0
s_bitset0_b64 s[72:73],s55
v_mfma_f32_16x16x32_bf16 v[52:55],v[108:111],v[136:139],0
s_min_u32 s55,s55,127
s_waitcnt lgkmcnt(2)
v_mfma_f32_16x16x32_bf16 v[24:27],a[132:135],v[112:115],v[24:27]
ds_read_b128 v[104:107],v7 offset:0
v_mfma_f32_16x16x32_bf16 v[40:43],v[112:115],v[132:135],v[40:43]
s_lshl_b32 s58,s51,5
v_mfma_f32_16x16x32_bf16 v[28:31],a[132:135],v[116:119],v[28:31]
ds_read_b128 v[108:111],v7 offset:4096
v_mfma_f32_16x16x32_bf16 v[44:47],v[116:119],v[132:135],v[44:47]
s_add_u32 s58,s58,s47
v_mfma_f32_16x16x32_bf16 v[32:35],a[140:143],v[112:115],v[32:35]
s_mul_i32 s58,s58,24576
v_mfma_f32_16x16x32_bf16 v[48:51],v[112:115],v[140:143],v[48:51]
s_add_u32 s58,s58,100663296
v_mfma_f32_16x16x32_bf16 v[36:39],a[140:143],v[116:119],v[36:39]
s_add_u32 s61,s58,s50
v_mfma_f32_16x16x32_bf16 v[52:55],v[116:119],v[140:143],v[52:55]
s_add_u32 s62,s61,4096
s_waitcnt lgkmcnt(2)
v_mfma_f32_16x16x32_bf16 v[24:27],a[144:147],v[120:123],v[24:27]
ds_read_b128 v[112:115],v4 offset:8192
v_mfma_f32_16x16x32_bf16 v[40:43],v[120:123],v[144:147],v[40:43]
s_add_u32 s63,s61,16384
v_mfma_f32_16x16x32_bf16 v[28:31],a[144:147],v[124:127],v[28:31]
ds_read_b128 v[116:119],v4 offset:12288
v_mfma_f32_16x16x32_bf16 v[44:47],v[124:127],v[144:147],v[44:47]
s_add_u32 s64,s61,20480
v_mfma_f32_16x16x32_bf16 v[32:35],a[152:155],v[120:123],v[32:35]
s_add_u32 s65,s61,s50
v_mfma_f32_16x16x32_bf16 v[48:51],v[120:123],v[152:155],v[48:51]
s_add_u32 s65,s65,8192
v_mfma_f32_16x16x32_bf16 v[36:39],a[152:155],v[124:127],v[36:39]
v_mfma_f32_16x16x32_bf16 v[52:55],v[124:127],v[152:155],v[52:55]
s_waitcnt lgkmcnt(2)
v_mfma_f32_16x16x32_bf16 v[24:27],a[148:151],v[104:107],v[24:27]
ds_read_b128 v[120:123],v5 offset:8192
v_mfma_f32_16x16x32_bf16 v[40:43],v[104:107],v[148:151],v[40:43]
v_mfma_f32_16x16x32_bf16 v[28:31],a[148:151],v[108:111],v[28:31]
ds_read_b128 v[124:127],v5 offset:12288
v_mfma_f32_16x16x32_bf16 v[44:47],v[108:111],v[148:151],v[44:47]
v_mfma_f32_16x16x32_bf16 v[32:35],a[156:159],v[104:107],v[32:35]
v_mfma_f32_16x16x32_bf16 v[48:51],v[104:107],v[156:159],v[48:51]
v_mfma_f32_16x16x32_bf16 v[36:39],a[156:159],v[108:111],v[36:39]
v_mfma_f32_16x16x32_bf16 v[52:55],v[108:111],v[156:159],v[52:55]
s_waitcnt lgkmcnt(2)
v_mfma_f32_16x16x32_bf16 v[24:27],a[160:163],v[112:115],v[24:27]
ds_read_b128 v[104:107],v6 offset:8192
v_mfma_f32_16x16x32_bf16 v[40:43],v[112:115],v[160:163],v[40:43]
v_mfma_f32_16x16x32_bf16 v[28:31],a[160:163],v[116:119],v[28:31]
ds_read_b128 v[108:111],v6 offset:12288
v_mfma_f32_16x16x32_bf16 v[44:47],v[116:119],v[160:163],v[44:47]
v_mfma_f32_16x16x32_bf16 v[32:35],a[168:171],v[112:115],v[32:35]
v_mfma_f32_16x16x32_bf16 v[48:51],v[112:115],v[168:171],v[48:51]
v_mfma_f32_16x16x32_bf16 v[36:39],a[168:171],v[116:119],v[36:39]
v_mfma_f32_16x16x32_bf16 v[52:55],v[116:119],v[168:171],v[52:55]
s_waitcnt lgkmcnt(2)
v_mfma_f32_16x16x32_bf16 v[24:27],a[164:167],v[120:123],v[24:27]
ds_read_b128 v[112:115],v7 offset:8192
v_mfma_f32_16x16x32_bf16 v[40:43],v[120:123],v[164:167],v[40:43]
s_lshl_b32 s56,s54,13
v_mfma_f32_16x16x32_bf16 v[28:31],a[164:167],v[124:127],v[28:31]
ds_read_b128 v[116:119],v7 offset:12288
v_mfma_f32_16x16x32_bf16 v[44:47],v[124:127],v[164:167],v[44:47]
s_add_u32 s56,s56,10487552
v_mfma_f32_16x16x32_bf16 v[32:35],a[172:175],v[120:123],v[32:35]
s_or_b32 s56,s56,s52
v_mfma_f32_16x16x32_bf16 v[48:51],v[120:123],v[172:175],v[48:51]
buffer_load_dword v76,v23,s[8:11],s56 offen sc1
v_mfma_f32_16x16x32_bf16 v[36:39],a[172:175],v[124:127],v[36:39]
v_mfma_f32_16x16x32_bf16 v[52:55],v[124:127],v[172:175],v[52:55]
s_waitcnt lgkmcnt(2)
v_mfma_f32_16x16x32_bf16 v[24:27],a[176:179],v[104:107],v[24:27]
ds_read_b128 v[120:123],v4 offset:16384
v_mfma_f32_16x16x32_bf16 v[40:43],v[104:107],v[176:179],v[40:43]
v_mfma_f32_16x16x32_bf16 v[28:31],a[176:179],v[108:111],v[28:31]
ds_read_b128 v[124:127],v4 offset:20480
v_mfma_f32_16x16x32_bf16 v[44:47],v[108:111],v[176:179],v[44:47]
v_mfma_f32_16x16x32_bf16 v[32:35],a[184:187],v[104:107],v[32:35]
v_mfma_f32_16x16x32_bf16 v[48:51],v[104:107],v[184:187],v[48:51]
v_mfma_f32_16x16x32_bf16 v[36:39],a[184:187],v[108:111],v[36:39]
v_mfma_f32_16x16x32_bf16 v[52:55],v[108:111],v[184:187],v[52:55]
s_waitcnt lgkmcnt(2)
v_mfma_f32_16x16x32_bf16 v[24:27],a[180:183],v[112:115],v[24:27]
ds_read_b128 v[104:107],v5 offset:16384
v_mfma_f32_16x16x32_bf16 v[40:43],v[112:115],v[180:183],v[40:43]
v_mfma_f32_16x16x32_bf16 v[28:31],a[180:183],v[116:119],v[28:31]
ds_read_b128 v[108:111],v5 offset:20480
v_mfma_f32_16x16x32_bf16 v[44:47],v[116:119],v[180:183],v[44:47]
v_mfma_f32_16x16x32_bf16 v[32:35],a[188:191],v[112:115],v[32:35]
v_mfma_f32_16x16x32_bf16 v[48:51],v[112:115],v[188:191],v[48:51]
v_mfma_f32_16x16x32_bf16 v[36:39],a[188:191],v[116:119],v[36:39]
v_mfma_f32_16x16x32_bf16 v[52:55],v[116:119],v[188:191],v[52:55]
s_waitcnt lgkmcnt(2)
v_mfma_f32_16x16x32_bf16 v[24:27],a[192:195],v[120:123],v[24:27]
ds_read_b128 v[112:115],v6 offset:16384
v_mfma_f32_16x16x32_bf16 v[40:43],v[120:123],v[192:195],v[40:43]
v_mfma_f32_16x16x32_bf16 v[28:31],a[192:195],v[124:127],v[28:31]
ds_read_b128 v[116:119],v6 offset:20480
v_mfma_f32_16x16x32_bf16 v[44:47],v[124:127],v[192:195],v[44:47]
v_mfma_f32_16x16x32_bf16 v[32:35],a[200:203],v[120:123],v[32:35]
v_mfma_f32_16x16x32_bf16 v[48:51],v[120:123],v[200:203],v[48:51]
v_mfma_f32_16x16x32_bf16 v[36:39],a[200:203],v[124:127],v[36:39]
v_mfma_f32_16x16x32_bf16 v[52:55],v[124:127],v[200:203],v[52:55]
s_waitcnt lgkmcnt(2)
v_mfma_f32_16x16x32_bf16 v[24:27],a[196:199],v[104:107],v[24:27]
ds_read_b128 v[120:123],v7 offset:16384
v_mfma_f32_16x16x32_bf16 v[40:43],v[104:107],v[196:199],v[40:43]
s_waitcnt vmcnt(0)
v_mfma_f32_16x16x32_bf16 v[28:31],a[196:199],v[108:111],v[28:31]
ds_read_b128 v[124:127],v7 offset:20480
v_mfma_f32_16x16x32_bf16 v[44:47],v[108:111],v[196:199],v[44:47]
v_cmp_eq_u32 vcc,0,v76
v_mfma_f32_16x16x32_bf16 v[32:35],a[204:207],v[104:107],v[32:35]
s_nop 0
v_mov_b32 v76,vcc_lo
v_mfma_f32_16x16x32_bf16 v[48:51],v[104:107],v[204:207],v[48:51]
ds_write_b32 v19,v76
v_mfma_f32_16x16x32_bf16 v[36:39],a[204:207],v[108:111],v[36:39]
v_mfma_f32_16x16x32_bf16 v[52:55],v[108:111],v[204:207],v[52:55]
s_waitcnt vmcnt(0) lgkmcnt(0)
s_barrier
s_or_b32 s70,s70,s52
buffer_store_dword v17,off,s[8:11],s70 sc1
ds_read_b32 v76,v16
v_mfma_f32_16x16x32_bf16 v[24:27],a[208:211],v[112:115],v[24:27]
ds_read_b128 v[104:107],v4 offset:24576
v_mfma_f32_16x16x32_bf16 v[40:43],v[112:115],v[208:211],v[40:43]
s_lshl_b32 s56,s51,5
s_add_u32 s56,s56,s47
s_lshl_b32 s56,s56,12
v_mfma_f32_16x16x32_bf16 v[28:31],a[208:211],v[116:119],v[28:31]
ds_read_b128 v[108:111],v4 offset:28672
v_mfma_f32_16x16x32_bf16 v[44:47],v[116:119],v[208:211],v[44:47]
s_add_u32 s56,s56,s50
s_add_u32 s56,s56,41943040
v_mfma_f32_16x16x32_bf16 v[32:35],a[216:219],v[112:115],v[32:35]
v_mov_b64 v[72:73],-1
v_mov_b64 v[74:75],-1
v_mfma_f32_16x16x32_bf16 v[48:51],v[112:115],v[216:219],v[48:51]
buffer_store_dwordx4 v[72:75],v0,s[8:11],s56 offen sc1
v_mfma_f32_16x16x32_bf16 v[36:39],a[216:219],v[116:119],v[36:39]
v_mfma_f32_16x16x32_bf16 v[52:55],v[116:119],v[216:219],v[52:55]
s_waitcnt lgkmcnt(2)
v_mfma_f32_16x16x32_bf16 v[24:27],a[212:215],v[120:123],v[24:27]
ds_read_b128 v[112:115],v5 offset:24576
v_mfma_f32_16x16x32_bf16 v[40:43],v[120:123],v[212:215],v[40:43]
v_readfirstlane_b32 s57,v76
v_mfma_f32_16x16x32_bf16 v[28:31],a[212:215],v[124:127],v[28:31]
ds_read_b128 v[116:119],v5 offset:28672
v_mfma_f32_16x16x32_bf16 v[44:47],v[124:127],v[212:215],v[44:47]
s_sub_u32 s59,s55,s54
s_cmp_lt_i32 s59,44
s_cselect_b32 s76,2,0
v_mfma_f32_16x16x32_bf16 v[32:35],a[220:223],v[120:123],v[32:35]
s_cmp_gt_i32 s53,0
s_cselect_b32 s76,s76,0
v_mfma_f32_16x16x32_bf16 v[48:51],v[120:123],v[220:223],v[48:51]
s_cmp_eq_u32 s57,0
s_cselect_b32 s76,1,s76
v_mfma_f32_16x16x32_bf16 v[36:39],a[220:223],v[124:127],v[36:39]
s_cmp_lt_i32 s59,12
s_cselect_b32 s76,2,s76
s_add_u32 s57,s54,64
v_mfma_f32_16x16x32_bf16 v[52:55],v[124:127],v[220:223],v[52:55]
s_cmp_eq_u32 s76,1
s_cselect_b32 s68,s57,s55
s_lshl_b32 s68,s68,15
s_waitcnt lgkmcnt(2)
v_mfma_f32_16x16x32_bf16 v[24:27],a[224:227],v[104:107],v[24:27]
ds_read_b128 v[120:123],v6 offset:24576
v_mfma_f32_16x16x32_bf16 v[40:43],v[104:107],v[224:227],v[40:43]
s_cmp_eq_u32 s76,0
s_cselect_b32 s68,0x80000000,s68
s_add_u32 s69,s68,16384
v_mfma_f32_16x16x32_bf16 v[28:31],a[224:227],v[108:111],v[28:31]
ds_read_b128 v[124:127],v6 offset:28672
v_mfma_f32_16x16x32_bf16 v[44:47],v[108:111],v[224:227],v[44:47]
s_add_u32 m0,s75,65536
v_mfma_f32_16x16x32_bf16 v[32:35],a[232:235],v[104:107],v[32:35]
buffer_load_dwordx4 v20,s[8:11],s68 offen offset:0 sc1 lds
v_mfma_f32_16x16x32_bf16 v[48:51],v[104:107],v[232:235],v[48:51]
s_add_u32 m0,s75,69632
v_mfma_f32_16x16x32_bf16 v[36:39],a[232:235],v[108:111],v[36:39]
buffer_load_dwordx4 v20,s[8:11],s69 offen offset:0 sc1 lds
v_mfma_f32_16x16x32_bf16 v[52:55],v[108:111],v[232:235],v[52:55]
s_add_u32 m0,s75,73472
s_waitcnt lgkmcnt(2)
v_mfma_f32_16x16x32_bf16 v[24:27],a[228:231],v[112:115],v[24:27]
ds_read_b128 v[104:107],v7 offset:24576
v_mfma_f32_16x16x32_bf16 v[40:43],v[112:115],v[228:231],v[40:43]
buffer_load_dwordx4 v20,s[8:11],s68 offen offset:256 sc1 lds
v_mfma_f32_16x16x32_bf16 v[28:31],a[228:231],v[116:119],v[28:31]
ds_read_b128 v[108:111],v7 offset:28672
v_mfma_f32_16x16x32_bf16 v[44:47],v[116:119],v[228:231],v[44:47]
s_add_u32 m0,s75,77568
v_mfma_f32_16x16x32_bf16 v[32:35],a[236:239],v[112:115],v[32:35]
buffer_load_dwordx4 v20,s[8:11],s69 offen offset:256 sc1 lds
v_mfma_f32_16x16x32_bf16 v[48:51],v[112:115],v[236:239],v[48:51]
s_add_u32 m0,s75,81408
v_mfma_f32_16x16x32_bf16 v[36:39],a[236:239],v[116:119],v[36:39]
buffer_load_dwordx4 v20,s[8:11],s68 offen offset:512 sc1 lds
v_mfma_f32_16x16x32_bf16 v[52:55],v[116:119],v[236:239],v[52:55]
s_add_u32 m0,s75,85504
s_waitcnt lgkmcnt(2)
v_mfma_f32_16x16x32_bf16 v[24:27],a[240:243],v[120:123],v[24:27]
ds_read_b128 v[112:115],v4 offset:0
v_mfma_f32_16x16x32_bf16 v[40:43],v[120:123],v[240:243],v[40:43]
buffer_load_dwordx4 v20,s[8:11],s69 offen offset:512 sc1 lds
v_mfma_f32_16x16x32_bf16 v[28:31],a[240:243],v[124:127],v[28:31]
ds_read_b128 v[116:119],v4 offset:4096
v_mfma_f32_16x16x32_bf16 v[44:47],v[124:127],v[240:243],v[44:47]
s_add_u32 m0,s75,89344
v_mfma_f32_16x16x32_bf16 v[32:35],a[248:251],v[120:123],v[32:35]
buffer_load_dwordx4 v20,s[8:11],s68 offen offset:768 sc1 lds
v_mfma_f32_16x16x32_bf16 v[48:51],v[120:123],v[248:251],v[48:51]
s_add_u32 m0,s75,93440
v_mfma_f32_16x16x32_bf16 v[36:39],a[248:251],v[124:127],v[36:39]
buffer_load_dwordx4 v20,s[8:11],s69 offen offset:768 sc1 lds
v_mfma_f32_16x16x32_bf16 v[52:55],v[124:127],v[248:251],v[52:55]
s_waitcnt lgkmcnt(2)
v_mfma_f32_16x16x32_bf16 v[24:27],a[244:247],v[104:107],v[24:27]
ds_read_b128 v[120:123],v5 offset:0
v_mfma_f32_16x16x32_bf16 v[40:43],v[104:107],v[244:247],v[40:43]
v_mfma_f32_16x16x32_bf16 v[28:31],a[244:247],v[108:111],v[28:31]
ds_read_b128 v[124:127],v5 offset:4096
v_mfma_f32_16x16x32_bf16 v[44:47],v[108:111],v[244:247],v[44:47]
v_mfma_f32_16x16x32_bf16 v[32:35],a[252:255],v[104:107],v[32:35]
v_mfma_f32_16x16x32_bf16 v[48:51],v[104:107],v[252:255],v[48:51]
v_mfma_f32_16x16x32_bf16 v[36:39],a[252:255],v[108:111],v[36:39]
v_mfma_f32_16x16x32_bf16 v[52:55],v[108:111],v[252:255],v[52:55]
s_waitcnt lgkmcnt(2)
v_mfma_f32_16x16x32_bf16 v[88:91],a[0:3],v[112:115],0
ds_read_b128 v[104:107],v6 offset:0
v_mfma_f32_16x16x32_bf16 v[92:95],a[0:3],v[116:119],0
v_mfma_f32_16x16x32_bf16 v[96:99],a[8:11],v[112:115],0
ds_read_b128 v[108:111],v6 offset:4096
v_cvt_pk_bf16_f32 v56,v24,v32
v_cvt_pk_bf16_f32 v57,v25,v33
v_mfma_f32_16x16x32_bf16 v[100:103],a[8:11],v[116:119],0
v_cvt_pk_bf16_f32 v58,v26,v34
v_cvt_pk_bf16_f32 v59,v27,v35
s_waitcnt lgkmcnt(2)
v_mfma_f32_16x16x32_bf16 v[88:91],a[4:7],v[120:123],v[88:91]
ds_read_b128 v[112:115],v7 offset:0
v_mfma_f32_16x16x32_bf16 v[92:95],a[4:7],v[124:127],v[92:95]
buffer_store_dwordx4 v[56:59],v0,s[8:11],s61 offen sc1
v_cvt_pk_bf16_f32 v60,v28,v36
v_cvt_pk_bf16_f32 v61,v29,v37
v_mfma_f32_16x16x32_bf16 v[96:99],a[12:15],v[120:123],v[96:99]
ds_read_b128 v[116:119],v7 offset:4096
v_cvt_pk_bf16_f32 v62,v30,v38
v_cvt_pk_bf16_f32 v63,v31,v39
v_mfma_f32_16x16x32_bf16 v[100:103],a[12:15],v[124:127],v[100:103]
buffer_store_dwordx4 v[60:63],v0,s[8:11],s62 offen sc1
v_cvt_pk_bf16_f32 v64,v40,v41
v_cvt_pk_bf16_f32 v65,v42,v43
s_waitcnt lgkmcnt(2)
v_mfma_f32_16x16x32_bf16 v[88:91],a[16:19],v[104:107],v[88:91]
ds_read_b128 v[120:123],v4 offset:8192
v_cvt_pk_bf16_f32 v66,v44,v45
v_cvt_pk_bf16_f32 v67,v46,v47
v_mfma_f32_16x16x32_bf16 v[92:95],a[16:19],v[108:111],v[92:95]
buffer_store_dwordx4 v[64:67],v0,s[8:11],s65 offen offset:0 sc1
v_cvt_pk_bf16_f32 v68,v48,v49
v_cvt_pk_bf16_f32 v69,v50,v51
v_mfma_f32_16x16x32_bf16 v[96:99],a[24:27],v[104:107],v[96:99]
ds_read_b128 v[124:127],v4 offset:12288
v_cvt_pk_bf16_f32 v70,v52,v53
v_cvt_pk_bf16_f32 v71,v54,v55
v_mfma_f32_16x16x32_bf16 v[100:103],a[24:27],v[108:111],v[100:103]
buffer_store_dwordx4 v[68:71],v0,s[8:11],s65 offen offset:1024 sc1
s_waitcnt lgkmcnt(2)
v_mfma_f32_16x16x32_bf16 v[88:91],a[20:23],v[112:115],v[88:91]
ds_read_b128 v[104:107],v5 offset:8192
v_mfma_f32_16x16x32_bf16 v[92:95],a[20:23],v[116:119],v[92:95]
v_mfma_f32_16x16x32_bf16 v[96:99],a[28:31],v[112:115],v[96:99]
ds_read_b128 v[108:111],v5 offset:12288
v_mfma_f32_16x16x32_bf16 v[100:103],a[28:31],v[116:119],v[100:103]
s_waitcnt lgkmcnt(2)
v_mfma_f32_16x16x32_bf16 v[88:91],a[32:35],v[120:123],v[88:91]
ds_read_b128 v[112:115],v6 offset:8192
v_mfma_f32_16x16x32_bf16 v[92:95],a[32:35],v[124:127],v[92:95]
v_mfma_f32_16x16x32_bf16 v[96:99],a[40:43],v[120:123],v[96:99]
ds_read_b128 v[116:119],v6 offset:12288
v_mfma_f32_16x16x32_bf16 v[100:103],a[40:43],v[124:127],v[100:103]
s_waitcnt lgkmcnt(2)
v_mfma_f32_16x16x32_bf16 v[88:91],a[36:39],v[104:107],v[88:91]
ds_read_b128 v[120:123],v7 offset:8192
v_mfma_f32_16x16x32_bf16 v[92:95],a[36:39],v[108:111],v[92:95]
s_lshl_b32 s56,s54,13
v_mfma_f32_16x16x32_bf16 v[96:99],a[44:47],v[104:107],v[96:99]
ds_read_b128 v[124:127],v7 offset:12288
v_mfma_f32_16x16x32_bf16 v[100:103],a[44:47],v[108:111],v[100:103]
s_add_u32 s56,s56,10487552
s_waitcnt lgkmcnt(2)
v_mfma_f32_16x16x32_bf16 v[88:91],a[48:51],v[112:115],v[88:91]
ds_read_b128 v[104:107],v4 offset:16384
v_mfma_f32_16x16x32_bf16 v[92:95],a[48:51],v[116:119],v[92:95]
s_or_b32 s56,s56,s52
v_mfma_f32_16x16x32_bf16 v[96:99],a[56:59],v[112:115],v[96:99]
ds_read_b128 v[108:111],v4 offset:20480
v_mfma_f32_16x16x32_bf16 v[100:103],a[56:59],v[116:119],v[100:103]
buffer_load_dword v76,v23,s[8:11],s56 offen sc1
s_waitcnt lgkmcnt(2)
v_mfma_f32_16x16x32_bf16 v[88:91],a[52:55],v[120:123],v[88:91]
ds_read_b128 v[112:115],v5 offset:16384
v_mfma_f32_16x16x32_bf16 v[92:95],a[52:55],v[124:127],v[92:95]
v_mfma_f32_16x16x32_bf16 v[96:99],a[60:63],v[120:123],v[96:99]
ds_read_b128 v[116:119],v5 offset:20480
v_mfma_f32_16x16x32_bf16 v[100:103],a[60:63],v[124:127],v[100:103]
s_waitcnt lgkmcnt(2)
v_mfma_f32_16x16x32_bf16 v[88:91],a[64:67],v[104:107],v[88:91]
ds_read_b128 v[120:123],v6 offset:16384
v_mfma_f32_16x16x32_bf16 v[92:95],a[64:67],v[108:111],v[92:95]
v_mfma_f32_16x16x32_bf16 v[96:99],a[72:75],v[104:107],v[96:99]
ds_read_b128 v[124:127],v6 offset:20480
v_mfma_f32_16x16x32_bf16 v[100:103],a[72:75],v[108:111],v[100:103]
s_waitcnt lgkmcnt(2)
v_mfma_f32_16x16x32_bf16 v[88:91],a[68:71],v[112:115],v[88:91]
ds_read_b128 v[104:107],v7 offset:16384
v_mfma_f32_16x16x32_bf16 v[92:95],a[68:71],v[116:119],v[92:95]
v_mfma_f32_16x16x32_bf16 v[96:99],a[76:79],v[112:115],v[96:99]
ds_read_b128 v[108:111],v7 offset:20480
v_mfma_f32_16x16x32_bf16 v[100:103],a[76:79],v[116:119],v[100:103]
s_waitcnt lgkmcnt(2)
v_mfma_f32_16x16x32_bf16 v[88:91],a[80:83],v[120:123],v[88:91]
ds_read_b128 v[112:115],v4 offset:24576
v_mfma_f32_16x16x32_bf16 v[92:95],a[80:83],v[124:127],v[92:95]
v_mfma_f32_16x16x32_bf16 v[96:99],a[88:91],v[120:123],v[96:99]
ds_read_b128 v[116:119],v4 offset:28672
v_mfma_f32_16x16x32_bf16 v[100:103],a[88:91],v[124:127],v[100:103]
s_waitcnt lgkmcnt(2)
v_mfma_f32_16x16x32_bf16 v[88:91],a[84:87],v[104:107],v[88:91]
ds_read_b128 v[120:123],v5 offset:24576
v_mfma_f32_16x16x32_bf16 v[92:95],a[84:87],v[108:111],v[92:95]
v_mfma_f32_16x16x32_bf16 v[96:99],a[92:95],v[104:107],v[96:99]
ds_read_b128 v[124:127],v5 offset:28672
v_mfma_f32_16x16x32_bf16 v[100:103],a[92:95],v[108:111],v[100:103]
s_waitcnt lgkmcnt(2)
v_mfma_f32_16x16x32_bf16 v[88:91],a[96:99],v[112:115],v[88:91]
ds_read_b128 v[104:107],v6 offset:24576
v_mfma_f32_16x16x32_bf16 v[92:95],a[96:99],v[116:119],v[92:95]
v_mfma_f32_16x16x32_bf16 v[96:99],a[104:107],v[112:115],v[96:99]
ds_read_b128 v[108:111],v6 offset:28672
v_mfma_f32_16x16x32_bf16 v[100:103],a[104:107],v[116:119],v[100:103]
s_waitcnt lgkmcnt(2)
v_mfma_f32_16x16x32_bf16 v[88:91],a[100:103],v[120:123],v[88:91]
ds_read_b128 v[112:115],v7 offset:24576
v_mfma_f32_16x16x32_bf16 v[92:95],a[100:103],v[124:127],v[92:95]
v_mfma_f32_16x16x32_bf16 v[96:99],a[108:111],v[120:123],v[96:99]
ds_read_b128 v[116:119],v7 offset:28672
v_mfma_f32_16x16x32_bf16 v[100:103],a[108:111],v[124:127],v[100:103]
s_waitcnt lgkmcnt(2)
v_mfma_f32_16x16x32_bf16 v[88:91],a[112:115],v[104:107],v[88:91]
v_mfma_f32_16x16x32_bf16 v[92:95],a[112:115],v[108:111],v[92:95]
v_mfma_f32_16x16x32_bf16 v[96:99],a[120:123],v[104:107],v[96:99]
v_mfma_f32_16x16x32_bf16 v[100:103],a[120:123],v[108:111],v[100:103]
s_waitcnt lgkmcnt(0)
v_mfma_f32_16x16x32_bf16 v[88:91],a[116:119],v[112:115],v[88:91]
v_mfma_f32_16x16x32_bf16 v[92:95],a[116:119],v[116:119],v[92:95]
v_mfma_f32_16x16x32_bf16 v[96:99],a[124:127],v[112:115],v[96:99]
v_mfma_f32_16x16x32_bf16 v[100:103],a[124:127],v[116:119],v[100:103]
s_nop 3
v_cvt_pk_bf16_f32 v104,v88,v96
v_cvt_pk_bf16_f32 v105,v89,v97
v_cvt_pk_bf16_f32 v106,v90,v98
v_cvt_pk_bf16_f32 v107,v91,v99
v_cvt_pk_bf16_f32 v108,v92,v100
v_cvt_pk_bf16_f32 v109,v93,v101
v_cvt_pk_bf16_f32 v110,v94,v102
v_cvt_pk_bf16_f32 v111,v95,v103
buffer_store_dwordx4 v[104:107],v0,s[8:11],s63 offen sc1
buffer_store_dwordx4 v[108:111],v0,s[8:11],s64 offen sc1
s_waitcnt vmcnt(7)
s_barrier
s_lshl_b32 s70,s51,13
s_lshl2_add_u32 s70,s47,s70
s_add_u32 s70,s70,10485760
s_cmp_ge_u32 s51,2
s_cbranch_scc1 L_p_21
s_waitcnt vmcnt(0)
s_barrier
s_or_b32 s70,s70,s52
buffer_store_dword v17,off,s[8:11],s70 sc1
L_p_21:
s_cmp_eq_u32 s76,2
s_cbranch_scc1 L_p_19
s_mov_b32 s53,0
s_mov_b32 s51,s54
s_add_u32 s54,s54,2
s_cmp_eq_u32 s76,1
s_cbranch_scc1 L_p_20
s_cmp_lg_u32 s77,0
s_waitcnt vmcnt(3)
s_cbranch_scc1 L_p_23
s_waitcnt vmcnt(2)
L_p_23:
v_cmp_eq_u32 vcc,0,v76
s_nop 1
v_mov_b32 v76,vcc_lo
ds_write_b32 v19,v76
s_lshl_b32 s66,s51,15
s_add_u32 s66,s66,2097152
s_add_u32 s67,s66,16384
s_waitcnt lgkmcnt(0)
s_barrier
ds_read_b32 v76,v16
s_waitcnt lgkmcnt(0)
v_cmp_eq_u32 vcc,0,v76
s_cbranch_vccnz L_p_24
s_waitcnt vmcnt(0)
s_barrier
s_or_b32 s70,s70,s52
buffer_store_dword v17,off,s[8:11],s70 sc1
s_mov_b32 s70,0x80000000
s_mov_b32 s53,1
s_cmp_ge_u32 s51,64
s_cbranch_scc1 L_p_22
s_lshl_b32 s59,s51,13
s_add_u32 s59,s59,10487552
s_cmp_lg_u32 s46,0
s_cbranch_scc1 L_fd_26
v_and_b32 v124,31,v1
v_lshlrev_b32 v124,2,v124
s_branch L_ff_27
L_fw_25:
s_sleep 2
L_ff_27:
buffer_load_dword v125,v124,s[8:11],s59 offen sc1
s_sub_u32 s49,s49,1
s_cbranch_scc1 L_abort
s_waitcnt vmcnt(0)
v_cmp_eq_u32 vcc,0,v125
s_cbranch_vccnz L_fw_25
L_fd_26:
s_barrier
L_p_24:
s_add_u32 m0,s74,65536
s_nop 0
buffer_load_dwordx4 v20,s[8:11],s66 offen offset:0 sc1 lds
s_add_u32 m0,s74,69632
s_nop 0
buffer_load_dwordx4 v20,s[8:11],s67 offen offset:0 sc1 lds
s_add_u32 m0,s74,73472
s_nop 0
buffer_load_dwordx4 v20,s[8:11],s66 offen offset:256 sc1 lds
s_add_u32 m0,s74,77568
s_nop 0
buffer_load_dwordx4 v20,s[8:11],s67 offen offset:256 sc1 lds
s_add_u32 m0,s74,81408
s_nop 0
buffer_load_dwordx4 v20,s[8:11],s66 offen offset:512 sc1 lds
s_add_u32 m0,s74,85504
s_nop 0
buffer_load_dwordx4 v20,s[8:11],s67 offen offset:512 sc1 lds
s_add_u32 m0,s74,89344
s_nop 0
buffer_load_dwordx4 v20,s[8:11],s66 offen offset:768 sc1 lds
s_add_u32 m0,s74,93440
s_nop 0
buffer_load_dwordx4 v20,s[8:11],s67 offen offset:768 sc1 lds
s_lshl_b32 s56,s54,13
s_add_u32 s56,s56,10487552
s_or_b32 s56,s56,s52
buffer_load_dword v76,v23,s[8:11],s56 offen sc1
s_waitcnt vmcnt(7)
s_barrier
ds_read_b128 v[104:107],v4 offset:0
ds_read_b128 v[108:111],v4 offset:4096
ds_read_b128 v[112:115],v5 offset:0
ds_read_b128 v[116:119],v5 offset:4096
s_waitcnt lgkmcnt(2)
v_mfma_f32_16x16x32_bf16 v[24:27],a[128:131],v[104:107],0
ds_read_b128 v[120:123],v6 offset:0
v_mfma_f32_16x16x32_bf16 v[40:43],v[104:107],v[128:131],0
s_lshl_b32 s58,s51,5
v_mfma_f32_16x16x32_bf16 v[28:31],a[128:131],v[108:111],0
ds_read_b128 v[124:127],v6 offset:4096
v_mfma_f32_16x16x32_bf16 v[44:47],v[108:111],v[128:131],0
s_add_u32 s58,s58,s47
v_mfma_f32_16x16x32_bf16 v[32:35],a[136:139],v[104:107],0
s_mul_i32 s58,s58,24576
v_mfma_f32_16x16x32_bf16 v[48:51],v[104:107],v[136:139],0
s_add_u32 s58,s58,150994944
v_mfma_f32_16x16x32_bf16 v[36:39],a[136:139],v[108:111],0
s_add_u32 s61,s58,s50
v_mfma_f32_16x16x32_bf16 v[52:55],v[108:111],v[136:139],0
s_add_u32 s62,s61,4096
s_waitcnt lgkmcnt(2)
v_mfma_f32_16x16x32_bf16 v[24:27],a[132:135],v[112:115],v[24:27]
ds_read_b128 v[104:107],v7 offset:0
v_mfma_f32_16x16x32_bf16 v[40:43],v[112:115],v[132:135],v[40:43]
s_add_u32 s63,s61,16384
v_mfma_f32_16x16x32_bf16 v[28:31],a[132:135],v[116:119],v[28:31]
ds_read_b128 v[108:111],v7 offset:4096
v_mfma_f32_16x16x32_bf16 v[44:47],v[116:119],v[132:135],v[44:47]
s_add_u32 s64,s61,20480
v_mfma_f32_16x16x32_bf16 v[32:35],a[140:143],v[112:115],v[32:35]
s_add_u32 s65,s61,s50
v_mfma_f32_16x16x32_bf16 v[48:51],v[112:115],v[140:143],v[48:51]
s_add_u32 s65,s65,8192
v_mfma_f32_16x16x32_bf16 v[36:39],a[140:143],v[116:119],v[36:39]
v_mfma_f32_16x16x32_bf16 v[52:55],v[116:119],v[140:143],v[52:55]
s_waitcnt vmcnt(5)
s_barrier
s_waitcnt lgkmcnt(2)
v_mfma_f32_16x16x32_bf16 v[24:27],a[144:147],v[120:123],v[24:27]
ds_read_b128 v[112:115],v4 offset:8192
v_mfma_f32_16x16x32_bf16 v[40:43],v[120:123],v[144:147],v[40:43]
v_mfma_f32_16x16x32_bf16 v[28:31],a[144:147],v[124:127],v[28:31]
ds_read_b128 v[116:119],v4 offset:12288
v_mfma_f32_16x16x32_bf16 v[44:47],v[124:127],v[144:147],v[44:47]
v_mfma_f32_16x16x32_bf16 v[32:35],a[152:155],v[120:123],v[32:35]
v_mfma_f32_16x16x32_bf16 v[48:51],v[120:123],v[152:155],v[48:51]
v_mfma_f32_16x16x32_bf16 v[36:39],a[152:155],v[124:127],v[36:39]
v_mfma_f32_16x16x32_bf16 v[52:55],v[124:127],v[152:155],v[52:55]
s_waitcnt lgkmcnt(2)
v_mfma_f32_16x16x32_bf16 v[24:27],a[148:151],v[104:107],v[24:27]
ds_read_b128 v[120:123],v5 offset:8192
v_mfma_f32_16x16x32_bf16 v[40:43],v[104:107],v[148:151],v[40:43]
v_mfma_f32_16x16x32_bf16 v[28:31],a[148:151],v[108:111],v[28:31]
ds_read_b128 v[124:127],v5 offset:12288
v_mfma_f32_16x16x32_bf16 v[44:47],v[108:111],v[148:151],v[44:47]
v_mfma_f32_16x16x32_bf16 v[32:35],a[156:159],v[104:107],v[32:35]
v_mfma_f32_16x16x32_bf16 v[48:51],v[104:107],v[156:159],v[48:51]
v_mfma_f32_16x16x32_bf16 v[36:39],a[156:159],v[108:111],v[36:39]
v_mfma_f32_16x16x32_bf16 v[52:55],v[108:111],v[156:159],v[52:55]
s_waitcnt lgkmcnt(2)
v_mfma_f32_16x16x32_bf16 v[24:27],a[160:163],v[112:115],v[24:27]
ds_read_b128 v[104:107],v6 offset:8192
v_mfma_f32_16x16x32_bf16 v[40:43],v[112:115],v[160:163],v[40:43]
v_mfma_f32_16x16x32_bf16 v[28:31],a[160:163],v[116:119],v[28:31]
ds_read_b128 v[108:111],v6 offset:12288
v_mfma_f32_16x16x32_bf16 v[44:47],v[116:119],v[160:163],v[44:47]
v_mfma_f32_16x16x32_bf16 v[32:35],a[168:171],v[112:115],v[32:35]
v_mfma_f32_16x16x32_bf16 v[48:51],v[112:115],v[168:171],v[48:51]
v_mfma_f32_16x16x32_bf16 v[36:39],a[168:171],v[116:119],v[36:39]
v_mfma_f32_16x16x32_bf16 v[52:55],v[116:119],v[168:171],v[52:55]
s_waitcnt lgkmcnt(2)
v_mfma_f32_16x16x32_bf16 v[24:27],a[164:167],v[120:123],v[24:27]
ds_read_b128 v[112:115],v7 offset:8192
v_mfma_f32_16x16x32_bf16 v[40:43],v[120:123],v[164:167],v[40:43]
v_mfma_f32_16x16x32_bf16 v[28:31],a[164:167],v[124:127],v[28:31]
ds_read_b128 v[116:119],v7 offset:12288
v_mfma_f32_16x16x32_bf16 v[44:47],v[124:127],v[164:167],v[44:47]
v_mfma_f32_16x16x32_bf16 v[32:35],a[172:175],v[120:123],v[32:35]
v_mfma_f32_16x16x32_bf16 v[48:51],v[120:123],v[172:175],v[48:51]
v_mfma_f32_16x16x32_bf16 v[36:39],a[172:175],v[124:127],v[36:39]
v_mfma_f32_16x16x32_bf16 v[52:55],v[124:127],v[172:175],v[52:55]
s_waitcnt vmcnt(3)
s_barrier
s_waitcnt lgkmcnt(2)
v_mfma_f32_16x16x32_bf16 v[24:27],a[176:179],v[104:107],v[24:27]
ds_read_b128 v[120:123],v4 offset:16384
v_mfma_f32_16x16x32_bf16 v[40:43],v[104:107],v[176:179],v[40:43]
v_mfma_f32_16x16x32_bf16 v[28:31],a[176:179],v[108:111],v[28:31]
ds_read_b128 v[124:127],v4 offset:20480
v_mfma_f32_16x16x32_bf16 v[44:47],v[108:111],v[176:179],v[44:47]
v_mfma_f32_16x16x32_bf16 v[32:35],a[184:187],v[104:107],v[32:35]
v_mfma_f32_16x16x32_bf16 v[48:51],v[104:107],v[184:187],v[48:51]
v_mfma_f32_16x16x32_bf16 v[36:39],a[184:187],v[108:111],v[36:39]
v_mfma_f32_16x16x32_bf16 v[52:55],v[108:111],v[184:187],v[52:55]
s_waitcnt lgkmcnt(2)
v_mfma_f32_16x16x32_bf16 v[24:27],a[180:183],v[112:115],v[24:27]
ds_read_b128 v[104:107],v5 offset:16384
v_mfma_f32_16x16x32_bf16 v[40:43],v[112:115],v[180:183],v[40:43]
v_mfma_f32_16x16x32_bf16 v[28:31],a[180:183],v[116:119],v[28:31]
ds_read_b128 v[108:111],v5 offset:20480
v_mfma_f32_16x16x32_bf16 v[44:47],v[116:119],v[180:183],v[44:47]
v_mfma_f32_16x16x32_bf16 v[32:35],a[188:191],v[112:115],v[32:35]
v_mfma_f32_16x16x32_bf16 v[48:51],v[112:115],v[188:191],v[48:51]
v_mfma_f32_16x16x32_bf16 v[36:39],a[188:191],v[116:119],v[36:39]
v_mfma_f32_16x16x32_bf16 v[52:55],v[116:119],v[188:191],v[52:55]
s_waitcnt lgkmcnt(2)
v_mfma_f32_16x16x32_bf16 v[24:27],a[192:195],v[120:123],v[24:27]
ds_read_b128 v[112:115],v6 offset:16384
v_mfma_f32_16x16x32_bf16 v[40:43],v[120:123],v[192:195],v[40:43]
v_mfma_f32_16x16x32_bf16 v[28:31],a[192:195],v[124:127],v[28:31]
ds_read_b128 v[116:119],v6 offset:20480
v_mfma_f32_16x16x32_bf16 v[44:47],v[124:127],v[192:195],v[44:47]
v_mfma_f32_16x16x32_bf16 v[32:35],a[200:203],v[120:123],v[32:35]
v_mfma_f32_16x16x32_bf16 v[48:51],v[120:123],v[200:203],v[48:51]
v_mfma_f32_16x16x32_bf16 v[36:39],a[200:203],v[124:127],v[36:39]
v_mfma_f32_16x16x32_bf16 v[52:55],v[124:127],v[200:203],v[52:55]
s_waitcnt lgkmcnt(2)
v_mfma_f32_16x16x32_bf16 v[24:27],a[196:199],v[104:107],v[24:27]
ds_read_b128 v[120:123],v7 offset:16384
v_mfma_f32_16x16x32_bf16 v[40:43],v[104:107],v[196:199],v[40:43]
s_waitcnt vmcnt(0)
v_mfma_f32_16x16x32_bf16 v[28:31],a[196:199],v[108:111],v[28:31]
ds_read_b128 v[124:127],v7 offset:20480
v_mfma_f32_16x16x32_bf16 v[44:47],v[108:111],v[196:199],v[44:47]
v_cmp_eq_u32 vcc,0,v76
v_mfma_f32_16x16x32_bf16 v[32:35],a[204:207],v[104:107],v[32:35]
s_nop 0
v_mov_b32 v76,vcc_lo
v_mfma_f32_16x16x32_bf16 v[48:51],v[104:107],v[204:207],v[48:51]
ds_write_b32 v19,v76
v_mfma_f32_16x16x32_bf16 v[36:39],a[204:207],v[108:111],v[36:39]
v_mfma_f32_16x16x32_bf16 v[52:55],v[108:111],v[204:207],v[52:55]
s_waitcnt vmcnt(0) lgkmcnt(0)
s_barrier
s_or_b32 s70,s70,s52
buffer_store_dword v17,off,s[8:11],s70 sc1
ds_read_b32 v76,v16
v_mfma_f32_16x16x32_bf16 v[24:27],a[208:211],v[112:115],v[24:27]
ds_read_b128 v[104:107],v4 offset:24576
v_mfma_f32_16x16x32_bf16 v[40:43],v[112:115],v[208:211],v[40:43]
s_lshl_b32 s56,s51,5
s_add_u32 s56,s56,s47
s_lshl_b32 s56,s56,12
v_mfma_f32_16x16x32_bf16 v[28:31],a[208:211],v[116:119],v[28:31]
ds_read_b128 v[108:111],v4 offset:28672
v_mfma_f32_16x16x32_bf16 v[44:47],v[116:119],v[208:211],v[44:47]
s_add_u32 s56,s56,s50
s_add_u32 s56,s56,58720256
v_mfma_f32_16x16x32_bf16 v[32:35],a[216:219],v[112:115],v[32:35]
v_mov_b64 v[72:73],-1
v_mov_b64 v[74:75],-1
v_mfma_f32_16x16x32_bf16 v[48:51],v[112:115],v[216:219],v[48:51]
buffer_store_dwordx4 v[72:75],v0,s[8:11],s56 offen sc1
v_mfma_f32_16x16x32_bf16 v[36:39],a[216:219],v[116:119],v[36:39]
s_add_u32 s56,s56,16777216
v_mfma_f32_16x16x32_bf16 v[52:55],v[116:119],v[216:219],v[52:55]
buffer_store_dwordx4 v[72:75],v0,s[8:11],s56 offen sc1
s_waitcnt lgkmcnt(2)
v_mfma_f32_16x16x32_bf16 v[24:27],a[212:215],v[120:123],v[24:27]
ds_read_b128 v[112:115],v5 offset:24576
v_mfma_f32_16x16x32_bf16 v[40:43],v[120:123],v[212:215],v[40:43]
v_readfirstlane_b32 s57,v76
v_mfma_f32_16x16x32_bf16 v[28:31],a[212:215],v[124:127],v[28:31]
ds_read_b128 v[116:119],v5 offset:28672
v_mfma_f32_16x16x32_bf16 v[44:47],v[124:127],v[212:215],v[44:47]
s_sub_u32 s59,s55,s54
s_cmp_lt_i32 s59,44
s_cselect_b32 s76,2,0
v_mfma_f32_16x16x32_bf16 v[32:35],a[220:223],v[120:123],v[32:35]
s_cmp_gt_i32 s53,0
s_cselect_b32 s76,s76,0
v_mfma_f32_16x16x32_bf16 v[48:51],v[120:123],v[220:223],v[48:51]
s_cmp_eq_u32 s57,0
s_cselect_b32 s76,1,s76
v_mfma_f32_16x16x32_bf16 v[36:39],a[220:223],v[124:127],v[36:39]
s_cmp_lt_i32 s59,12
s_cselect_b32 s76,2,s76
s_add_u32 s57,s54,64
v_mfma_f32_16x16x32_bf16 v[52:55],v[124:127],v[220:223],v[52:55]
s_cmp_eq_u32 s76,1
s_cselect_b32 s68,s57,s55
s_lshl_b32 s68,s68,15
s_waitcnt lgkmcnt(2)
v_mfma_f32_16x16x32_bf16 v[24:27],a[224:227],v[104:107],v[24:27]
ds_read_b128 v[120:123],v6 offset:24576
v_mfma_f32_16x16x32_bf16 v[40:43],v[104:107],v[224:227],v[40:43]
s_cmp_eq_u32 s76,0
s_cselect_b32 s68,0x80000000,s68
s_add_u32 s69,s68,16384
v_mfma_f32_16x16x32_bf16 v[28:31],a[224:227],v[108:111],v[28:31]
ds_read_b128 v[124:127],v6 offset:28672
v_mfma_f32_16x16x32_bf16 v[44:47],v[108:111],v[224:227],v[44:47]
s_add_u32 m0,s75,65536
v_mfma_f32_16x16x32_bf16 v[32:35],a[232:235],v[104:107],v[32:35]
buffer_load_dwordx4 v20,s[8:11],s68 offen offset:0 sc1 lds
v_mfma_f32_16x16x32_bf16 v[48:51],v[104:107],v[232:235],v[48:51]
s_add_u32 m0,s75,69632
v_mfma_f32_16x16x32_bf16 v[36:39],a[232:235],v[108:111],v[36:39]
buffer_load_dwordx4 v20,s[8:11],s69 offen offset:0 sc1 lds
v_mfma_f32_16x16x32_bf16 v[52:55],v[108:111],v[232:235],v[52:55]
s_add_u32 m0,s75,73472
s_waitcnt lgkmcnt(2)
v_mfma_f32_16x16x32_bf16 v[24:27],a[228:231],v[112:115],v[24:27]
ds_read_b128 v[104:107],v7 offset:24576
v_mfma_f32_16x16x32_bf16 v[40:43],v[112:115],v[228:231],v[40:43]
buffer_load_dwordx4 v20,s[8:11],s68 offen offset:256 sc1 lds
v_mfma_f32_16x16x32_bf16 v[28:31],a[228:231],v[116:119],v[28:31]
ds_read_b128 v[108:111],v7 offset:28672
v_mfma_f32_16x16x32_bf16 v[44:47],v[116:119],v[228:231],v[44:47]
s_add_u32 m0,s75,77568
v_mfma_f32_16x16x32_bf16 v[32:35],a[236:239],v[112:115],v[32:35]
buffer_load_dwordx4 v20,s[8:11],s69 offen offset:256 sc1 lds
v_mfma_f32_16x16x32_bf16 v[48:51],v[112:115],v[236:239],v[48:51]
s_add_u32 m0,s75,81408
v_mfma_f32_16x16x32_bf16 v[36:39],a[236:239],v[116:119],v[36:39]
buffer_load_dwordx4 v20,s[8:11],s68 offen offset:512 sc1 lds
v_mfma_f32_16x16x32_bf16 v[52:55],v[116:119],v[236:239],v[52:55]
s_add_u32 m0,s75,85504
s_waitcnt lgkmcnt(2)
v_mfma_f32_16x16x32_bf16 v[24:27],a[240:243],v[120:123],v[24:27]
ds_read_b128 v[112:115],v4 offset:0
v_mfma_f32_16x16x32_bf16 v[40:43],v[120:123],v[240:243],v[40:43]
buffer_load_dwordx4 v20,s[8:11],s69 offen offset:512 sc1 lds
v_mfma_f32_16x16x32_bf16 v[28:31],a[240:243],v[124:127],v[28:31]
ds_read_b128 v[116:119],v4 offset:4096
v_mfma_f32_16x16x32_bf16 v[44:47],v[124:127],v[240:243],v[44:47]
s_add_u32 m0,s75,89344
v_mfma_f32_16x16x32_bf16 v[32:35],a[248:251],v[120:123],v[32:35]
buffer_load_dwordx4 v20,s[8:11],s68 offen offset:768 sc1 lds
v_mfma_f32_16x16x32_bf16 v[48:51],v[120:123],v[248:251],v[48:51]
s_add_u32 m0,s75,93440
v_mfma_f32_16x16x32_bf16 v[36:39],a[248:251],v[124:127],v[36:39]
buffer_load_dwordx4 v20,s[8:11],s69 offen offset:768 sc1 lds
v_mfma_f32_16x16x32_bf16 v[52:55],v[124:127],v[248:251],v[52:55]
s_waitcnt lgkmcnt(2)
v_mfma_f32_16x16x32_bf16 v[24:27],a[244:247],v[104:107],v[24:27]
ds_read_b128 v[120:123],v5 offset:0
v_mfma_f32_16x16x32_bf16 v[40:43],v[104:107],v[244:247],v[40:43]
v_mfma_f32_16x16x32_bf16 v[28:31],a[244:247],v[108:111],v[28:31]
ds_read_b128 v[124:127],v5 offset:4096
v_mfma_f32_16x16x32_bf16 v[44:47],v[108:111],v[244:247],v[44:47]
v_mfma_f32_16x16x32_bf16 v[32:35],a[252:255],v[104:107],v[32:35]
v_mfma_f32_16x16x32_bf16 v[48:51],v[104:107],v[252:255],v[48:51]
v_mfma_f32_16x16x32_bf16 v[36:39],a[252:255],v[108:111],v[36:39]
v_mfma_f32_16x16x32_bf16 v[52:55],v[108:111],v[252:255],v[52:55]
s_waitcnt lgkmcnt(2)
v_mfma_f32_16x16x32_bf16 v[88:91],a[0:3],v[112:115],0
ds_read_b128 v[104:107],v6 offset:0
v_mfma_f32_16x16x32_bf16 v[92:95],a[0:3],v[116:119],0
v_mfma_f32_16x16x32_bf16 v[96:99],a[8:11],v[112:115],0
ds_read_b128 v[108:111],v6 offset:4096
v_cvt_pk_bf16_f32 v56,v24,v32
v_cvt_pk_bf16_f32 v57,v25,v33
v_mfma_f32_16x16x32_bf16 v[100:103],a[8:11],v[116:119],0
v_cvt_pk_bf16_f32 v58,v26,v34
v_cvt_pk_bf16_f32 v59,v27,v35
s_waitcnt lgkmcnt(2)
v_mfma_f32_16x16x32_bf16 v[88:91],a[4:7],v[120:123],v[88:91]
ds_read_b128 v[112:115],v7 offset:0
v_mfma_f32_16x16x32_bf16 v[92:95],a[4:7],v[124:127],v[92:95]
buffer_store_dwordx4 v[56:59],v0,s[8:11],s61 offen sc1
v_cvt_pk_bf16_f32 v60,v28,v36
v_cvt_pk_bf16_f32 v61,v29,v37
v_mfma_f32_16x16x32_bf16 v[96:99],a[12:15],v[120:123],v[96:99]
ds_read_b128 v[116:119],v7 offset:4096
v_cvt_pk_bf16_f32 v62,v30,v38
v_cvt_pk_bf16_f32 v63,v31,v39
v_mfma_f32_16x16x32_bf16 v[100:103],a[12:15],v[124:127],v[100:103]
buffer_store_dwordx4 v[60:63],v0,s[8:11],s62 offen sc1
v_cvt_pk_bf16_f32 v64,v40,v41
v_cvt_pk_bf16_f32 v65,v42,v43
s_waitcnt lgkmcnt(2)
v_mfma_f32_16x16x32_bf16 v[88:91],a[16:19],v[104:107],v[88:91]
ds_read_b128 v[120:123],v4 offset:8192
v_cvt_pk_bf16_f32 v66,v44,v45
v_cvt_pk_bf16_f32 v67,v46,v47
v_mfma_f32_16x16x32_bf16 v[92:95],a[16:19],v[108:111],v[92:95]
buffer_store_dwordx4 v[64:67],v0,s[8:11],s65 offen offset:0 sc1
v_cvt_pk_bf16_f32 v68,v48,v49
v_cvt_pk_bf16_f32 v69,v50,v51
v_mfma_f32_16x16x32_bf16 v[96:99],a[24:27],v[104:107],v[96:99]
ds_read_b128 v[124:127],v4 offset:12288
v_cvt_pk_bf16_f32 v70,v52,v53
v_cvt_pk_bf16_f32 v71,v54,v55
v_mfma_f32_16x16x32_bf16 v[100:103],a[24:27],v[108:111],v[100:103]
buffer_store_dwordx4 v[68:71],v0,s[8:11],s65 offen offset:1024 sc1
s_waitcnt lgkmcnt(2)
v_mfma_f32_16x16x32_bf16 v[88:91],a[20:23],v[112:115],v[88:91]
ds_read_b128 v[104:107],v5 offset:8192
v_mfma_f32_16x16x32_bf16 v[92:95],a[20:23],v[116:119],v[92:95]
v_mfma_f32_16x16x32_bf16 v[96:99],a[28:31],v[112:115],v[96:99]
ds_read_b128 v[108:111],v5 offset:12288
v_mfma_f32_16x16x32_bf16 v[100:103],a[28:31],v[116:119],v[100:103]
s_waitcnt lgkmcnt(2)
v_mfma_f32_16x16x32_bf16 v[88:91],a[32:35],v[120:123],v[88:91]
ds_read_b128 v[112:115],v6 offset:8192
v_mfma_f32_16x16x32_bf16 v[92:95],a[32:35],v[124:127],v[92:95]
v_mfma_f32_16x16x32_bf16 v[96:99],a[40:43],v[120:123],v[96:99]
ds_read_b128 v[116:119],v6 offset:12288
v_mfma_f32_16x16x32_bf16 v[100:103],a[40:43],v[124:127],v[100:103]
s_waitcnt lgkmcnt(2)
v_mfma_f32_16x16x32_bf16 v[88:91],a[36:39],v[104:107],v[88:91]
ds_read_b128 v[120:123],v7 offset:8192
v_mfma_f32_16x16x32_bf16 v[92:95],a[36:39],v[108:111],v[92:95]
s_lshl_b32 s56,s54,13
v_mfma_f32_16x16x32_bf16 v[96:99],a[44:47],v[104:107],v[96:99]
ds_read_b128 v[124:127],v7 offset:12288
v_mfma_f32_16x16x32_bf16 v[100:103],a[44:47],v[108:111],v[100:103]
s_add_u32 s56,s56,10487552
s_waitcnt lgkmcnt(2)
v_mfma_f32_16x16x32_bf16 v[88:91],a[48:51],v[112:115],v[88:91]
ds_read_b128 v[104:107],v4 offset:16384
v_mfma_f32_16x16x32_bf16 v[92:95],a[48:51],v[116:119],v[92:95]
s_or_b32 s56,s56,s52
v_mfma_f32_16x16x32_bf16 v[96:99],a[56:59],v[112:115],v[96:99]
ds_read_b128 v[108:111],v4 offset:20480
v_mfma_f32_16x16x32_bf16 v[100:103],a[56:59],v[116:119],v[100:103]
buffer_load_dword v76,v23,s[8:11],s56 offen sc1
s_waitcnt lgkmcnt(2)
v_mfma_f32_16x16x32_bf16 v[88:91],a[52:55],v[120:123],v[88:91]
ds_read_b128 v[112:115],v5 offset:16384
v_mfma_f32_16x16x32_bf16 v[92:95],a[52:55],v[124:127],v[92:95]
v_mfma_f32_16x16x32_bf16 v[96:99],a[60:63],v[120:123],v[96:99]
ds_read_b128 v[116:119],v5 offset:20480
v_mfma_f32_16x16x32_bf16 v[100:103],a[60:63],v[124:127],v[100:103]
s_waitcnt lgkmcnt(2)
v_mfma_f32_16x16x32_bf16 v[88:91],a[64:67],v[104:107],v[88:91]
ds_read_b128 v[120:123],v6 offset:16384
v_mfma_f32_16x16x32_bf16 v[92:95],a[64:67],v[108:111],v[92:95]
v_mfma_f32_16x16x32_bf16 v[96:99],a[72:75],v[104:107],v[96:99]
ds_read_b128 v[124:127],v6 offset:20480
v_mfma_f32_16x16x32_bf16 v[100:103],a[72:75],v[108:111],v[100:103]
s_waitcnt lgkmcnt(2)
v_mfma_f32_16x16x32_bf16 v[88:91],a[68:71],v[112:115],v[88:91]
ds_read_b128 v[104:107],v7 offset:16384
v_mfma_f32_16x16x32_bf16 v[92:95],a[68:71],v[116:119],v[92:95]
v_mfma_f32_16x16x32_bf16 v[96:99],a[76:79],v[112:115],v[96:99]
ds_read_b128 v[108:111],v7 offset:20480
v_mfma_f32_16x16x32_bf16 v[100:103],a[76:79],v[116:119],v[100:103]
s_waitcnt lgkmcnt(2)
v_mfma_f32_16x16x32_bf16 v[88:91],a[80:83],v[120:123],v[88:91]
ds_read_b128 v[112:115],v4 offset:24576
v_mfma_f32_16x16x32_bf16 v[92:95],a[80:83],v[124:127],v[92:95]
v_mfma_f32_16x16x32_bf16 v[96:99],a[88:91],v[120:123],v[96:99]
ds_read_b128 v[116:119],v4 offset:28672
v_mfma_f32_16x16x32_bf16 v[100:103],a[88:91],v[124:127],v[100:103]
s_waitcnt lgkmcnt(2)
v_mfma_f32_16x16x32_bf16 v[88:91],a[84:87],v[104:107],v[88:91]
ds_read_b128 v[120:123],v5 offset:24576
v_mfma_f32_16x16x32_bf16 v[92:95],a[84:87],v[108:111],v[92:95]
v_mfma_f32_16x16x32_bf16 v[96:99],a[92:95],v[104:107],v[96:99]
ds_read_b128 v[124:127],v5 offset:28672
v_mfma_f32_16x16x32_bf16 v[100:103],a[92:95],v[108:111],v[100:103]
s_waitcnt lgkmcnt(2)
v_mfma_f32_16x16x32_bf16 v[88:91],a[96:99],v[112:115],v[88:91]
ds_read_b128 v[104:107],v6 offset:24576
v_mfma_f32_16x16x32_bf16 v[92:95],a[96:99],v[116:119],v[92:95]
v_mfma_f32_16x16x32_bf16 v[96:99],a[104:107],v[112:115],v[96:99]
ds_read_b128 v[108:111],v6 offset:28672
v_mfma_f32_16x16x32_bf16 v[100:103],a[104:107],v[116:119],v[100:103]
s_waitcnt lgkmcnt(2)
v_mfma_f32_16x16x32_bf16 v[88:91],a[100:103],v[120:123],v[88:91]
ds_read_b128 v[112:115],v7 offset:24576
v_mfma_f32_16x16x32_bf16 v[92:95],a[100:103],v[124:127],v[92:95]
v_mfma_f32_16x16x32_bf16 v[96:99],a[108:111],v[120:123],v[96:99]
ds_read_b128 v[116:119],v7 offset:28672
v_mfma_f32_16x16x32_bf16 v[100:103],a[108:111],v[124:127],v[100:103]
s_waitcnt lgkmcnt(2)
v_mfma_f32_16x16x32_bf16 v[88:91],a[112:115],v[104:107],v[88:91]
v_mfma_f32_16x16x32_bf16 v[92:95],a[112:115],v[108:111],v[92:95]
v_mfma_f32_16x16x32_bf16 v[96:99],a[120:123],v[104:107],v[96:99]
v_mfma_f32_16x16x32_bf16 v[100:103],a[120:123],v[108:111],v[100:103]
s_waitcnt lgkmcnt(0)
v_mfma_f32_16x16x32_bf16 v[88:91],a[116:119],v[112:115],v[88:91]
v_mfma_f32_16x16x32_bf16 v[92:95],a[116:119],v[116:119],v[92:95]
v_mfma_f32_16x16x32_bf16 v[96:99],a[124:127],v[112:115],v[96:99]
v_mfma_f32_16x16x32_bf16 v[100:103],a[124:127],v[116:119],v[100:103]
s_nop 3
v_cvt_pk_bf16_f32 v104,v88,v96
v_cvt_pk_bf16_f32 v105,v89,v97
v_cvt_pk_bf16_f32 v106,v90,v98
v_cvt_pk_bf16_f32 v107,v91,v99
v_cvt_pk_bf16_f32 v108,v92,v100
v_cvt_pk_bf16_f32 v109,v93,v101
v_cvt_pk_bf16_f32 v110,v94,v102
v_cvt_pk_bf16_f32 v111,v95,v103
buffer_store_dwordx4 v[104:107],v0,s[8:11],s63 offen sc1
buffer_store_dwordx4 v[108:111],v0,s[8:11],s64 offen sc1
s_lshl_b32 s59,s51,13
s_lshl2_add_u32 s59,s47,s59
s_add_u32 s59,s59,10485888
s_waitcnt vmcnt(3)
s_barrier
s_or_b32 s59,s59,s52
buffer_store_dword v17,off,s[8:11],s59 sc1
s_mov_b32 s77,1
s_lshl_b32 s70,s51,13
s_lshl2_add_u32 s70,s47,s70
s_add_u32 s70,s70,10486144
s_branch L_p_21
L_p_20:
s_mov_b32 s75,s74
s_xor_b32 s74,s74,32768
v_xor_b32 v4,32768,v4
v_xor_b32 v5,32768,v5
v_xor_b32 v6,32768,v6
v_xor_b32 v7,32768,v7
ds_read_b128 v[104:107],v4 offset:0
ds_read_b128 v[108:111],v4 offset:4096
ds_read_b128 v[112:115],v5 offset:0
ds_read_b128 v[116:119],v5 offset:4096
s_waitcnt lgkmcnt(2)
v_mfma_f32_16x16x32_bf16 v[24:27],a[128:131],v[104:107],0
ds_read_b128 v[120:123],v6 offset:0
v_mfma_f32_16x16x32_bf16 v[40:43],v[104:107],v[128:131],0
s_lshl_b32 s58,s51,5
v_mfma_f32_16x16x32_bf16 v[28:31],a[128:131],v[108:111],0
ds_read_b128 v[124:127],v6 offset:4096
v_mfma_f32_16x16x32_bf16 v[44:47],v[108:111],v[128:131],0
s_add_u32 s58,s58,s47
v_mfma_f32_16x16x32_bf16 v[32:35],a[136:139],v[104:107],0
s_mul_i32 s58,s58,24576
v_mfma_f32_16x16x32_bf16 v[48:51],v[104:107],v[136:139],0
s_add_u32 s58,s58,150994944
v_mfma_f32_16x16x32_bf16 v[36:39],a[136:139],v[108:111],0
s_add_u32 s61,s58,s50
v_mfma_f32_16x16x32_bf16 v[52:55],v[108:111],v[136:139],0
s_add_u32 s62,s61,4096
s_waitcnt lgkmcnt(2)
v_mfma_f32_16x16x32_bf16 v[24:27],a[132:135],v[112:115],v[24:27]
ds_read_b128 v[104:107],v7 offset:0
v_mfma_f32_16x16x32_bf16 v[40:43],v[112:115],v[132:135],v[40:43]
s_add_u32 s63,s61,16384
v_mfma_f32_16x16x32_bf16 v[28:31],a[132:135],v[116:119],v[28:31]
ds_read_b128 v[108:111],v7 offset:4096
v_mfma_f32_16x16x32_bf16 v[44:47],v[116:119],v[132:135],v[44:47]
s_add_u32 s64,s61,20480
v_mfma_f32_16x16x32_bf16 v[32:35],a[140:143],v[112:115],v[32:35]
s_add_u32 s65,s61,s50
v_mfma_f32_16x16x32_bf16 v[48:51],v[112:115],v[140:143],v[48:51]
s_add_u32 s65,s65,8192
v_mfma_f32_16x16x32_bf16 v[36:39],a[140:143],v[116:119],v[36:39]
v_mfma_f32_16x16x32_bf16 v[52:55],v[116:119],v[140:143],v[52:55]
s_waitcnt lgkmcnt(2)
v_mfma_f32_16x16x32_bf16 v[24:27],a[144:147],v[120:123],v[24:27]
ds_read_b128 v[112:115],v4 offset:8192
v_mfma_f32_16x16x32_bf16 v[40:43],v[120:123],v[144:147],v[40:43]
v_mfma_f32_16x16x32_bf16 v[28:31],a[144:147],v[124:127],v[28:31]
ds_read_b128 v[116:119],v4 offset:12288
v_mfma_f32_16x16x32_bf16 v[44:47],v[124:127],v[144:147],v[44:47]
v_mfma_f32_16x16x32_bf16 v[32:35],a[152:155],v[120:123],v[32:35]
v_mfma_f32_16x16x32_bf16 v[48:51],v[120:123],v[152:155],v[48:51]
v_mfma_f32_16x16x32_bf16 v[36:39],a[152:155],v[124:127],v[36:39]
v_mfma_f32_16x16x32_bf16 v[52:55],v[124:127],v[152:155],v[52:55]
s_waitcnt lgkmcnt(2)
v_mfma_f32_16x16x32_bf16 v[24:27],a[148:151],v[104:107],v[24:27]
ds_read_b128 v[120:123],v5 offset:8192
v_mfma_f32_16x16x32_bf16 v[40:43],v[104:107],v[148:151],v[40:43]
v_mfma_f32_16x16x32_bf16 v[28:31],a[148:151],v[108:111],v[28:31]
ds_read_b128 v[124:127],v5 offset:12288
v_mfma_f32_16x16x32_bf16 v[44:47],v[108:111],v[148:151],v[44:47]
v_mfma_f32_16x16x32_bf16 v[32:35],a[156:159],v[104:107],v[32:35]
v_mfma_f32_16x16x32_bf16 v[48:51],v[104:107],v[156:159],v[48:51]
v_mfma_f32_16x16x32_bf16 v[36:39],a[156:159],v[108:111],v[36:39]
v_mfma_f32_16x16x32_bf16 v[52:55],v[108:111],v[156:159],v[52:55]
s_waitcnt lgkmcnt(2)
v_mfma_f32_16x16x32_bf16 v[24:27],a[160:163],v[112:115],v[24:27]
ds_read_b128 v[104:107],v6 offset:8192
v_mfma_f32_16x16x32_bf16 v[40:43],v[112:115],v[160:163],v[40:43]
v_mfma_f32_16x16x32_bf16 v[28:31],a[160:163],v[116:119],v[28:31]
ds_read_b128 v[108:111],v6 offset:12288
v_mfma_f32_16x16x32_bf16 v[44:47],v[116:119],v[160:163],v[44:47]
v_mfma_f32_16x16x32_bf16 v[32:35],a[168:171],v[112:115],v[32:35]
v_mfma_f32_16x16x32_bf16 v[48:51],v[112:115],v[168:171],v[48:51]
v_mfma_f32_16x16x32_bf16 v[36:39],a[168:171],v[116:119],v[36:39]
v_mfma_f32_16x16x32_bf16 v[52:55],v[116:119],v[168:171],v[52:55]
s_waitcnt lgkmcnt(2)
v_mfma_f32_16x16x32_bf16 v[24:27],a[164:167],v[120:123],v[24:27]
ds_read_b128 v[112:115],v7 offset:8192
v_mfma_f32_16x16x32_bf16 v[40:43],v[120:123],v[164:167],v[40:43]
s_lshl_b32 s56,s54,13
v_mfma_f32_16x16x32_bf16 v[28:31],a[164:167],v[124:127],v[28:31]
ds_read_b128 v[116:119],v7 offset:12288
v_mfma_f32_16x16x32_bf16 v[44:47],v[124:127],v[164:167],v[44:47]
s_add_u32 s56,s56,10487552
v_mfma_f32_16x16x32_bf16 v[32:35],a[172:175],v[120:123],v[32:35]
s_or_b32 s56,s56,s52
v_mfma_f32_16x16x32_bf16 v[48:51],v[120:123],v[172:175],v[48:51]
buffer_load_dword v76,v23,s[8:11],s56 offen sc1
v_mfma_f32_16x16x32_bf16 v[36:39],a[172:175],v[124:127],v[36:39]
v_mfma_f32_16x16x32_bf16 v[52:55],v[124:127],v[172:175],v[52:55]
s_waitcnt lgkmcnt(2)
v_mfma_f32_16x16x32_bf16 v[24:27],a[176:179],v[104:107],v[24:27]
ds_read_b128 v[120:123],v4 offset:16384
v_mfma_f32_16x16x32_bf16 v[40:43],v[104:107],v[176:179],v[40:43]
v_mfma_f32_16x16x32_bf16 v[28:31],a[176:179],v[108:111],v[28:31]
ds_read_b128 v[124:127],v4 offset:20480
v_mfma_f32_16x16x32_bf16 v[44:47],v[108:111],v[176:179],v[44:47]
v_mfma_f32_16x16x32_bf16 v[32:35],a[184:187],v[104:107],v[32:35]
v_mfma_f32_16x16x32_bf16 v[48:51],v[104:107],v[184:187],v[48:51]
v_mfma_f32_16x16x32_bf16 v[36:39],a[184:187],v[108:111],v[36:39]
v_mfma_f32_16x16x32_bf16 v[52:55],v[108:111],v[184:187],v[52:55]
s_waitcnt lgkmcnt(2)
v_mfma_f32_16x16x32_bf16 v[24:27],a[180:183],v[112:115],v[24:27]
ds_read_b128 v[104:107],v5 offset:16384
v_mfma_f32_16x16x32_bf16 v[40:43],v[112:115],v[180:183],v[40:43]
v_mfma_f32_16x16x32_bf16 v[28:31],a[180:183],v[116:119],v[28:31]
ds_read_b128 v[108:111],v5 offset:20480
v_mfma_f32_16x16x32_bf16 v[44:47],v[116:119],v[180:183],v[44:47]
v_mfma_f32_16x16x32_bf16 v[32:35],a[188:191],v[112:115],v[32:35]
v_mfma_f32_16x16x32_bf16 v[48:51],v[112:115],v[188:191],v[48:51]
v_mfma_f32_16x16x32_bf16 v[36:39],a[188:191],v[116:119],v[36:39]
v_mfma_f32_16x16x32_bf16 v[52:55],v[116:119],v[188:191],v[52:55]
s_waitcnt lgkmcnt(2)
v_mfma_f32_16x16x32_bf16 v[24:27],a[192:195],v[120:123],v[24:27]
ds_read_b128 v[112:115],v6 offset:16384
v_mfma_f32_16x16x32_bf16 v[40:43],v[120:123],v[192:195],v[40:43]
v_mfma_f32_16x16x32_bf16 v[28:31],a[192:195],v[124:127],v[28:31]
ds_read_b128 v[116:119],v6 offset:20480
v_mfma_f32_16x16x32_bf16 v[44:47],v[124:127],v[192:195],v[44:47]
v_mfma_f32_16x16x32_bf16 v[32:35],a[200:203],v[120:123],v[32:35]
v_mfma_f32_16x16x32_bf16 v[48:51],v[120:123],v[200:203],v[48:51]
v_mfma_f32_16x16x32_bf16 v[36:39],a[200:203],v[124:127],v[36:39]
v_mfma_f32_16x16x32_bf16 v[52:55],v[124:127],v[200:203],v[52:55]
s_waitcnt lgkmcnt(2)
v_mfma_f32_16x16x32_bf16 v[24:27],a[196:199],v[104:107],v[24:27]
ds_read_b128 v[120:123],v7 offset:16384
v_mfma_f32_16x16x32_bf16 v[40:43],v[104:107],v[196:199],v[40:43]
s_waitcnt vmcnt(0)
v_mfma_f32_16x16x32_bf16 v[28:31],a[196:199],v[108:111],v[28:31]
ds_read_b128 v[124:127],v7 offset:20480
v_mfma_f32_16x16x32_bf16 v[44:47],v[108:111],v[196:199],v[44:47]
v_cmp_eq_u32 vcc,0,v76
v_mfma_f32_16x16x32_bf16 v[32:35],a[204:207],v[104:107],v[32:35]
s_nop 0
v_mov_b32 v76,vcc_lo
v_mfma_f32_16x16x32_bf16 v[48:51],v[104:107],v[204:207],v[48:51]
ds_write_b32 v19,v76
v_mfma_f32_16x16x32_bf16 v[36:39],a[204:207],v[108:111],v[36:39]
v_mfma_f32_16x16x32_bf16 v[52:55],v[108:111],v[204:207],v[52:55]
s_waitcnt vmcnt(0) lgkmcnt(0)
s_barrier
s_or_b32 s70,s70,s52
buffer_store_dword v17,off,s[8:11],s70 sc1
ds_read_b32 v76,v16
v_mfma_f32_16x16x32_bf16 v[24:27],a[208:211],v[112:115],v[24:27]
ds_read_b128 v[104:107],v4 offset:24576
v_mfma_f32_16x16x32_bf16 v[40:43],v[112:115],v[208:211],v[40:43]
s_lshl_b32 s56,s51,5
s_add_u32 s56,s56,s47
s_lshl_b32 s56,s56,12
v_mfma_f32_16x16x32_bf16 v[28:31],a[208:211],v[116:119],v[28:31]
ds_read_b128 v[108:111],v4 offset:28672
v_mfma_f32_16x16x32_bf16 v[44:47],v[116:119],v[208:211],v[44:47]
s_add_u32 s56,s56,s50
s_add_u32 s56,s56,58720256
v_mfma_f32_16x16x32_bf16 v[32:35],a[216:219],v[112:115],v[32:35]
v_mov_b64 v[72:73],-1
v_mov_b64 v[74:75],-1
v_mfma_f32_16x16x32_bf16 v[48:51],v[112:115],v[216:219],v[48:51]
buffer_store_dwordx4 v[72:75],v0,s[8:11],s56 offen sc1
v_mfma_f32_16x16x32_bf16 v[36:39],a[216:219],v[116:119],v[36:39]
s_add_u32 s56,s56,16777216
v_mfma_f32_16x16x32_bf16 v[52:55],v[116:119],v[216:219],v[52:55]
buffer_store_dwordx4 v[72:75],v0,s[8:11],s56 offen sc1
s_waitcnt lgkmcnt(2)
v_mfma_f32_16x16x32_bf16 v[24:27],a[212:215],v[120:123],v[24:27]
ds_read_b128 v[112:115],v5 offset:24576
v_mfma_f32_16x16x32_bf16 v[40:43],v[120:123],v[212:215],v[40:43]
v_readfirstlane_b32 s57,v76
v_mfma_f32_16x16x32_bf16 v[28:31],a[212:215],v[124:127],v[28:31]
ds_read_b128 v[116:119],v5 offset:28672
v_mfma_f32_16x16x32_bf16 v[44:47],v[124:127],v[212:215],v[44:47]
s_sub_u32 s59,s55,s54
s_cmp_lt_i32 s59,44
s_cselect_b32 s76,2,0
v_mfma_f32_16x16x32_bf16 v[32:35],a[220:223],v[120:123],v[32:35]
s_cmp_gt_i32 s53,0
s_cselect_b32 s76,s76,0
v_mfma_f32_16x16x32_bf16 v[48:51],v[120:123],v[220:223],v[48:51]
s_cmp_eq_u32 s57,0
s_cselect_b32 s76,1,s76
v_mfma_f32_16x16x32_bf16 v[36:39],a[220:223],v[124:127],v[36:39]
s_cmp_lt_i32 s59,12
s_cselect_b32 s76,2,s76
s_add_u32 s57,s54,64
v_mfma_f32_16x16x32_bf16 v[52:55],v[124:127],v[220:223],v[52:55]
s_cmp_eq_u32 s76,1
s_cselect_b32 s68,s57,s55
s_lshl_b32 s68,s68,15
s_waitcnt lgkmcnt(2)
v_mfma_f32_16x16x32_bf16 v[24:27],a[224:227],v[104:107],v[24:27]
ds_read_b128 v[120:123],v6 offset:24576
v_mfma_f32_16x16x32_bf16 v[40:43],v[104:107],v[224:227],v[40:43]
s_cmp_eq_u32 s76,0
s_cselect_b32 s68,0x80000000,s68
s_add_u32 s69,s68,16384
v_mfma_f32_16x16x32_bf16 v[28:31],a[224:227],v[108:111],v[28:31]
ds_read_b128 v[124:127],v6 offset:28672
v_mfma_f32_16x16x32_bf16 v[44:47],v[108:111],v[224:227],v[44:47]
s_add_u32 m0,s75,65536
v_mfma_f32_16x16x32_bf16 v[32:35],a[232:235],v[104:107],v[32:35]
buffer_load_dwordx4 v20,s[8:11],s68 offen offset:0 sc1 lds
v_mfma_f32_16x16x32_bf16 v[48:51],v[104:107],v[232:235],v[48:51]
s_add_u32 m0,s75,69632
v_mfma_f32_16x16x32_bf16 v[36:39],a[232:235],v[108:111],v[36:39]
buffer_load_dwordx4 v20,s[8:11],s69 offen offset:0 sc1 lds
v_mfma_f32_16x16x32_bf16 v[52:55],v[108:111],v[232:235],v[52:55]
s_add_u32 m0,s75,73472
s_waitcnt lgkmcnt(2)
v_mfma_f32_16x16x32_bf16 v[24:27],a[228:231],v[112:115],v[24:27]
ds_read_b128 v[104:107],v7 offset:24576
v_mfma_f32_16x16x32_bf16 v[40:43],v[112:115],v[228:231],v[40:43]
buffer_load_dwordx4 v20,s[8:11],s68 offen offset:256 sc1 lds
v_mfma_f32_16x16x32_bf16 v[28:31],a[228:231],v[116:119],v[28:31]
ds_read_b128 v[108:111],v7 offset:28672
v_mfma_f32_16x16x32_bf16 v[44:47],v[116:119],v[228:231],v[44:47]
s_add_u32 m0,s75,77568
v_mfma_f32_16x16x32_bf16 v[32:35],a[236:239],v[112:115],v[32:35]
buffer_load_dwordx4 v20,s[8:11],s69 offen offset:256 sc1 lds
v_mfma_f32_16x16x32_bf16 v[48:51],v[112:115],v[236:239],v[48:51]
s_add_u32 m0,s75,81408
v_mfma_f32_16x16x32_bf16 v[36:39],a[236:239],v[116:119],v[36:39]
buffer_load_dwordx4 v20,s[8:11],s68 offen offset:512 sc1 lds
v_mfma_f32_16x16x32_bf16 v[52:55],v[116:119],v[236:239],v[52:55]
s_add_u32 m0,s75,85504
s_waitcnt lgkmcnt(2)
v_mfma_f32_16x16x32_bf16 v[24:27],a[240:243],v[120:123],v[24:27]
ds_read_b128 v[112:115],v4 offset:0
v_mfma_f32_16x16x32_bf16 v[40:43],v[120:123],v[240:243],v[40:43]
buffer_load_dwordx4 v20,s[8:11],s69 offen offset:512 sc1 lds
v_mfma_f32_16x16x32_bf16 v[28:31],a[240:243],v[124:127],v[28:31]
ds_read_b128 v[116:119],v4 offset:4096
v_mfma_f32_16x16x32_bf16 v[44:47],v[124:127],v[240:243],v[44:47]
s_add_u32 m0,s75,89344
v_mfma_f32_16x16x32_bf16 v[32:35],a[248:251],v[120:123],v[32:35]
buffer_load_dwordx4 v20,s[8:11],s68 offen offset:768 sc1 lds
v_mfma_f32_16x16x32_bf16 v[48:51],v[120:123],v[248:251],v[48:51]
s_add_u32 m0,s75,93440
v_mfma_f32_16x16x32_bf16 v[36:39],a[248:251],v[124:127],v[36:39]
buffer_load_dwordx4 v20,s[8:11],s69 offen offset:768 sc1 lds
v_mfma_f32_16x16x32_bf16 v[52:55],v[124:127],v[248:251],v[52:55]
s_waitcnt lgkmcnt(2)
v_mfma_f32_16x16x32_bf16 v[24:27],a[244:247],v[104:107],v[24:27]
ds_read_b128 v[120:123],v5 offset:0
v_mfma_f32_16x16x32_bf16 v[40:43],v[104:107],v[244:247],v[40:43]
v_mfma_f32_16x16x32_bf16 v[28:31],a[244:247],v[108:111],v[28:31]
ds_read_b128 v[124:127],v5 offset:4096
v_mfma_f32_16x16x32_bf16 v[44:47],v[108:111],v[244:247],v[44:47]
v_mfma_f32_16x16x32_bf16 v[32:35],a[252:255],v[104:107],v[32:35]
v_mfma_f32_16x16x32_bf16 v[48:51],v[104:107],v[252:255],v[48:51]
v_mfma_f32_16x16x32_bf16 v[36:39],a[252:255],v[108:111],v[36:39]
v_mfma_f32_16x16x32_bf16 v[52:55],v[108:111],v[252:255],v[52:55]
s_waitcnt lgkmcnt(2)
v_mfma_f32_16x16x32_bf16 v[88:91],a[0:3],v[112:115],0
ds_read_b128 v[104:107],v6 offset:0
v_mfma_f32_16x16x32_bf16 v[92:95],a[0:3],v[116:119],0
v_mfma_f32_16x16x32_bf16 v[96:99],a[8:11],v[112:115],0
ds_read_b128 v[108:111],v6 offset:4096
v_cvt_pk_bf16_f32 v56,v24,v32
v_cvt_pk_bf16_f32 v57,v25,v33
v_mfma_f32_16x16x32_bf16 v[100:103],a[8:11],v[116:119],0
v_cvt_pk_bf16_f32 v58,v26,v34
v_cvt_pk_bf16_f32 v59,v27,v35
s_waitcnt lgkmcnt(2)
v_mfma_f32_16x16x32_bf16 v[88:91],a[4:7],v[120:123],v[88:91]
ds_read_b128 v[112:115],v7 offset:0
v_mfma_f32_16x16x32_bf16 v[92:95],a[4:7],v[124:127],v[92:95]
buffer_store_dwordx4 v[56:59],v0,s[8:11],s61 offen sc1
v_cvt_pk_bf16_f32 v60,v28,v36
v_cvt_pk_bf16_f32 v61,v29,v37
v_mfma_f32_16x16x32_bf16 v[96:99],a[12:15],v[120:123],v[96:99]
ds_read_b128 v[116:119],v7 offset:4096
v_cvt_pk_bf16_f32 v62,v30,v38
v_cvt_pk_bf16_f32 v63,v31,v39
v_mfma_f32_16x16x32_bf16 v[100:103],a[12:15],v[124:127],v[100:103]
buffer_store_dwordx4 v[60:63],v0,s[8:11],s62 offen sc1
v_cvt_pk_bf16_f32 v64,v40,v41
v_cvt_pk_bf16_f32 v65,v42,v43
s_waitcnt lgkmcnt(2)
v_mfma_f32_16x16x32_bf16 v[88:91],a[16:19],v[104:107],v[88:91]
ds_read_b128 v[120:123],v4 offset:8192
v_cvt_pk_bf16_f32 v66,v44,v45
v_cvt_pk_bf16_f32 v67,v46,v47
v_mfma_f32_16x16x32_bf16 v[92:95],a[16:19],v[108:111],v[92:95]
buffer_store_dwordx4 v[64:67],v0,s[8:11],s65 offen offset:0 sc1
v_cvt_pk_bf16_f32 v68,v48,v49
v_cvt_pk_bf16_f32 v69,v50,v51
v_mfma_f32_16x16x32_bf16 v[96:99],a[24:27],v[104:107],v[96:99]
ds_read_b128 v[124:127],v4 offset:12288
v_cvt_pk_bf16_f32 v70,v52,v53
v_cvt_pk_bf16_f32 v71,v54,v55
v_mfma_f32_16x16x32_bf16 v[100:103],a[24:27],v[108:111],v[100:103]
buffer_store_dwordx4 v[68:71],v0,s[8:11],s65 offen offset:1024 sc1
s_waitcnt lgkmcnt(2)
v_mfma_f32_16x16x32_bf16 v[88:91],a[20:23],v[112:115],v[88:91]
ds_read_b128 v[104:107],v5 offset:8192
v_mfma_f32_16x16x32_bf16 v[92:95],a[20:23],v[116:119],v[92:95]
v_mfma_f32_16x16x32_bf16 v[96:99],a[28:31],v[112:115],v[96:99]
ds_read_b128 v[108:111],v5 offset:12288
v_mfma_f32_16x16x32_bf16 v[100:103],a[28:31],v[116:119],v[100:103]
s_waitcnt lgkmcnt(2)
v_mfma_f32_16x16x32_bf16 v[88:91],a[32:35],v[120:123],v[88:91]
ds_read_b128 v[112:115],v6 offset:8192
v_mfma_f32_16x16x32_bf16 v[92:95],a[32:35],v[124:127],v[92:95]
v_mfma_f32_16x16x32_bf16 v[96:99],a[40:43],v[120:123],v[96:99]
ds_read_b128 v[116:119],v6 offset:12288
v_mfma_f32_16x16x32_bf16 v[100:103],a[40:43],v[124:127],v[100:103]
s_waitcnt lgkmcnt(2)
v_mfma_f32_16x16x32_bf16 v[88:91],a[36:39],v[104:107],v[88:91]
ds_read_b128 v[120:123],v7 offset:8192
v_mfma_f32_16x16x32_bf16 v[92:95],a[36:39],v[108:111],v[92:95]
s_lshl_b32 s56,s54,13
v_mfma_f32_16x16x32_bf16 v[96:99],a[44:47],v[104:107],v[96:99]
ds_read_b128 v[124:127],v7 offset:12288
v_mfma_f32_16x16x32_bf16 v[100:103],a[44:47],v[108:111],v[100:103]
s_add_u32 s56,s56,10487552
s_waitcnt lgkmcnt(2)
v_mfma_f32_16x16x32_bf16 v[88:91],a[48:51],v[112:115],v[88:91]
ds_read_b128 v[104:107],v4 offset:16384
v_mfma_f32_16x16x32_bf16 v[92:95],a[48:51],v[116:119],v[92:95]
s_or_b32 s56,s56,s52
v_mfma_f32_16x16x32_bf16 v[96:99],a[56:59],v[112:115],v[96:99]
ds_read_b128 v[108:111],v4 offset:20480
v_mfma_f32_16x16x32_bf16 v[100:103],a[56:59],v[116:119],v[100:103]
buffer_load_dword v76,v23,s[8:11],s56 offen sc1
s_waitcnt lgkmcnt(2)
v_mfma_f32_16x16x32_bf16 v[88:91],a[52:55],v[120:123],v[88:91]
ds_read_b128 v[112:115],v5 offset:16384
v_mfma_f32_16x16x32_bf16 v[92:95],a[52:55],v[124:127],v[92:95]
v_mfma_f32_16x16x32_bf16 v[96:99],a[60:63],v[120:123],v[96:99]
ds_read_b128 v[116:119],v5 offset:20480
v_mfma_f32_16x16x32_bf16 v[100:103],a[60:63],v[124:127],v[100:103]
s_waitcnt lgkmcnt(2)
v_mfma_f32_16x16x32_bf16 v[88:91],a[64:67],v[104:107],v[88:91]
ds_read_b128 v[120:123],v6 offset:16384
v_mfma_f32_16x16x32_bf16 v[92:95],a[64:67],v[108:111],v[92:95]
v_mfma_f32_16x16x32_bf16 v[96:99],a[72:75],v[104:107],v[96:99]
ds_read_b128 v[124:127],v6 offset:20480
v_mfma_f32_16x16x32_bf16 v[100:103],a[72:75],v[108:111],v[100:103]
s_waitcnt lgkmcnt(2)
v_mfma_f32_16x16x32_bf16 v[88:91],a[68:71],v[112:115],v[88:91]
ds_read_b128 v[104:107],v7 offset:16384
v_mfma_f32_16x16x32_bf16 v[92:95],a[68:71],v[116:119],v[92:95]
v_mfma_f32_16x16x32_bf16 v[96:99],a[76:79],v[112:115],v[96:99]
ds_read_b128 v[108:111],v7 offset:20480
v_mfma_f32_16x16x32_bf16 v[100:103],a[76:79],v[116:119],v[100:103]
s_waitcnt lgkmcnt(2)
v_mfma_f32_16x16x32_bf16 v[88:91],a[80:83],v[120:123],v[88:91]
ds_read_b128 v[112:115],v4 offset:24576
v_mfma_f32_16x16x32_bf16 v[92:95],a[80:83],v[124:127],v[92:95]
v_mfma_f32_16x16x32_bf16 v[96:99],a[88:91],v[120:123],v[96:99]
ds_read_b128 v[116:119],v4 offset:28672
v_mfma_f32_16x16x32_bf16 v[100:103],a[88:91],v[124:127],v[100:103]
s_waitcnt lgkmcnt(2)
v_mfma_f32_16x16x32_bf16 v[88:91],a[84:87],v[104:107],v[88:91]
ds_read_b128 v[120:123],v5 offset:24576
v_mfma_f32_16x16x32_bf16 v[92:95],a[84:87],v[108:111],v[92:95]
v_mfma_f32_16x16x32_bf16 v[96:99],a[92:95],v[104:107],v[96:99]
ds_read_b128 v[124:127],v5 offset:28672
v_mfma_f32_16x16x32_bf16 v[100:103],a[92:95],v[108:111],v[100:103]
s_waitcnt lgkmcnt(2)
v_mfma_f32_16x16x32_bf16 v[88:91],a[96:99],v[112:115],v[88:91]
ds_read_b128 v[104:107],v6 offset:24576
v_mfma_f32_16x16x32_bf16 v[92:95],a[96:99],v[116:119],v[92:95]
v_mfma_f32_16x16x32_bf16 v[96:99],a[104:107],v[112:115],v[96:99]
ds_read_b128 v[108:111],v6 offset:28672
v_mfma_f32_16x16x32_bf16 v[100:103],a[104:107],v[116:119],v[100:103]
s_waitcnt lgkmcnt(2)
v_mfma_f32_16x16x32_bf16 v[88:91],a[100:103],v[120:123],v[88:91]
ds_read_b128 v[112:115],v7 offset:24576
v_mfma_f32_16x16x32_bf16 v[92:95],a[100:103],v[124:127],v[92:95]
v_mfma_f32_16x16x32_bf16 v[96:99],a[108:111],v[120:123],v[96:99]
ds_read_b128 v[116:119],v7 offset:28672
v_mfma_f32_16x16x32_bf16 v[100:103],a[108:111],v[124:127],v[100:103]
s_waitcnt lgkmcnt(2)
v_mfma_f32_16x16x32_bf16 v[88:91],a[112:115],v[104:107],v[88:91]
v_mfma_f32_16x16x32_bf16 v[92:95],a[112:115],v[108:111],v[92:95]
v_mfma_f32_16x16x32_bf16 v[96:99],a[120:123],v[104:107],v[96:99]
v_mfma_f32_16x16x32_bf16 v[100:103],a[120:123],v[108:111],v[100:103]
s_waitcnt lgkmcnt(0)
v_mfma_f32_16x16x32_bf16 v[88:91],a[116:119],v[112:115],v[88:91]
v_mfma_f32_16x16x32_bf16 v[92:95],a[116:119],v[116:119],v[92:95]
v_mfma_f32_16x16x32_bf16 v[96:99],a[124:127],v[112:115],v[96:99]
v_mfma_f32_16x16x32_bf16 v[100:103],a[124:127],v[116:119],v[100:103]
s_nop 3
v_cvt_pk_bf16_f32 v104,v88,v96
v_cvt_pk_bf16_f32 v105,v89,v97
v_cvt_pk_bf16_f32 v106,v90,v98
v_cvt_pk_bf16_f32 v107,v91,v99
v_cvt_pk_bf16_f32 v108,v92,v100
v_cvt_pk_bf16_f32 v109,v93,v101
v_cvt_pk_bf16_f32 v110,v94,v102
v_cvt_pk_bf16_f32 v111,v95,v103
buffer_store_dwordx4 v[104:107],v0,s[8:11],s63 offen sc1
buffer_store_dwordx4 v[108:111],v0,s[8:11],s64 offen sc1
s_lshl_b32 s59,s51,13
s_lshl2_add_u32 s59,s47,s59
s_add_u32 s59,s59,10485888
s_waitcnt vmcnt(3)
s_barrier
s_or_b32 s59,s59,s52
buffer_store_dword v17,off,s[8:11],s59 sc1
s_mov_b32 s77,1
s_lshl_b32 s70,s51,13
s_lshl2_add_u32 s70,s47,s70
s_add_u32 s70,s70,10486144
s_branch L_p_21
L_p_22:
s_endpgm
L_rm_5:
v_and_b32 v33,15,v1
v_lshrrev_b32 v34,4,v1
s_min_u32 s60,s47,27
s_lshl_b32 s60,s60,7
s_mul_i32 s59,s46,458752
s_add_u32 s60,s60,s59
v_mul_u32_u24 v36,114688,v34
v_and_b32 v35,7,v33
v_lshl_add_u32 v36,v35,4,v36
v_add_u32 v36,s60,v36
v_cmp_gt_u32 vcc,8,v33
v_mov_b32 v38,s36
v_mov_b32 v39,s37
v_mov_b32 v40,s34
v_mov_b32 v41,s35
v_cndmask_b32 v38,v38,v40,vcc
v_cndmask_b32 v39,v39,v41,vcc
v_add_co_u32 v38,vcc,v38,v36
s_nop 1
v_addc_co_u32 v39,vcc,0,v39,vcc
s_lshl_b32 s56,s46,15
v_add_u32 v37,s56,v0
global_load_dwordx4 v[44:47],v[38:39],off
v_add_co_u32 v38,vcc,3584,v38
s_nop 1
v_addc_co_u32 v39,vcc,0,v39,vcc
global_load_dwordx4 v[48:51],v[38:39],off
v_add_co_u32 v38,vcc,3584,v38
s_nop 1
v_addc_co_u32 v39,vcc,0,v39,vcc
global_load_dwordx4 v[52:55],v[38:39],off
v_add_co_u32 v38,vcc,3584,v38
s_nop 1
v_addc_co_u32 v39,vcc,0,v39,vcc
global_load_dwordx4 v[56:59],v[38:39],off
v_add_co_u32 v38,vcc,3584,v38
s_nop 1
v_addc_co_u32 v39,vcc,0,v39,vcc
global_load_dwordx4 v[60:63],v[38:39],off
v_add_co_u32 v38,vcc,3584,v38
s_nop 1
v_addc_co_u32 v39,vcc,0,v39,vcc
global_load_dwordx4 v[64:67],v[38:39],off
v_add_co_u32 v38,vcc,3584,v38
s_nop 1
v_addc_co_u32 v39,vcc,0,v39,vcc
global_load_dwordx4 v[68:71],v[38:39],off
v_add_co_u32 v38,vcc,3584,v38
s_nop 1
v_addc_co_u32 v39,vcc,0,v39,vcc
global_load_dwordx4 v[72:75],v[38:39],off
v_add_co_u32 v38,vcc,3584,v38
s_nop 1
v_addc_co_u32 v39,vcc,0,v39,vcc
global_load_dwordx4 v[76:79],v[38:39],off
v_add_co_u32 v38,vcc,3584,v38
s_nop 1
v_addc_co_u32 v39,vcc,0,v39,vcc
global_load_dwordx4 v[80:83],v[38:39],off
v_add_co_u32 v38,vcc,3584,v38
s_nop 1
v_addc_co_u32 v39,vcc,0,v39,vcc
global_load_dwordx4 v[84:87],v[38:39],off
v_add_co_u32 v38,vcc,3584,v38
s_nop 1
v_addc_co_u32 v39,vcc,0,v39,vcc
global_load_dwordx4 v[88:91],v[38:39],off
v_add_co_u32 v38,vcc,3584,v38
s_nop 1
v_addc_co_u32 v39,vcc,0,v39,vcc
global_load_dwordx4 v[92:95],v[38:39],off
v_add_co_u32 v38,vcc,3584,v38
s_nop 1
v_addc_co_u32 v39,vcc,0,v39,vcc
global_load_dwordx4 v[96:99],v[38:39],off
v_add_co_u32 v38,vcc,3584,v38
s_nop 1
v_addc_co_u32 v39,vcc,0,v39,vcc
global_load_dwordx4 v[100:103],v[38:39],off
v_add_co_u32 v38,vcc,3584,v38
s_nop 1
v_addc_co_u32 v39,vcc,0,v39,vcc
global_load_dwordx4 v[104:107],v[38:39],off
v_add_co_u32 v38,vcc,3584,v38
s_nop 1
v_addc_co_u32 v39,vcc,0,v39,vcc
s_waitcnt vmcnt(15)
ds_write_b128 v37,v[44:47] offset:0
s_waitcnt vmcnt(14)
ds_write_b128 v37,v[48:51] offset:1024
s_waitcnt vmcnt(13)
ds_write_b128 v37,v[52:55] offset:2048
s_waitcnt vmcnt(12)
ds_write_b128 v37,v[56:59] offset:3072
s_waitcnt vmcnt(11)
ds_write_b128 v37,v[60:63] offset:4096
s_waitcnt vmcnt(10)
ds_write_b128 v37,v[64:67] offset:5120
s_waitcnt vmcnt(9)
ds_write_b128 v37,v[68:71] offset:6144
s_waitcnt vmcnt(8)
ds_write_b128 v37,v[72:75] offset:7168
s_waitcnt lgkmcnt(0)
s_waitcnt vmcnt(7)
ds_write_b128 v37,v[76:79] offset:8192
s_waitcnt vmcnt(6)
ds_write_b128 v37,v[80:83] offset:9216
s_waitcnt vmcnt(5)
ds_write_b128 v37,v[84:87] offset:10240
s_waitcnt vmcnt(4)
ds_write_b128 v37,v[88:91] offset:11264
s_waitcnt vmcnt(3)
ds_write_b128 v37,v[92:95] offset:12288
s_waitcnt vmcnt(2)
ds_write_b128 v37,v[96:99] offset:13312
s_waitcnt vmcnt(1)
ds_write_b128 v37,v[100:103] offset:14336
s_waitcnt vmcnt(0)
ds_write_b128 v37,v[104:107] offset:15360
s_waitcnt lgkmcnt(0)
global_load_dwordx4 v[44:47],v[38:39],off
v_add_co_u32 v38,vcc,3584,v38
s_nop 1
v_addc_co_u32 v39,vcc,0,v39,vcc
global_load_dwordx4 v[48:51],v[38:39],off
v_add_co_u32 v38,vcc,3584,v38
s_nop 1
v_addc_co_u32 v39,vcc,0,v39,vcc
global_load_dwordx4 v[52:55],v[38:39],off
v_add_co_u32 v38,vcc,3584,v38
s_nop 1
v_addc_co_u32 v39,vcc,0,v39,vcc
global_load_dwordx4 v[56:59],v[38:39],off
v_add_co_u32 v38,vcc,3584,v38
s_nop 1
v_addc_co_u32 v39,vcc,0,v39,vcc
global_load_dwordx4 v[60:63],v[38:39],off
v_add_co_u32 v38,vcc,3584,v38
s_nop 1
v_addc_co_u32 v39,vcc,0,v39,vcc
global_load_dwordx4 v[64:67],v[38:39],off
v_add_co_u32 v38,vcc,3584,v38
s_nop 1
v_addc_co_u32 v39,vcc,0,v39,vcc
global_load_dwordx4 v[68:71],v[38:39],off
v_add_co_u32 v38,vcc,3584,v38
s_nop 1
v_addc_co_u32 v39,vcc,0,v39,vcc
global_load_dwordx4 v[72:75],v[38:39],off
v_add_co_u32 v38,vcc,3584,v38
s_nop 1
v_addc_co_u32 v39,vcc,0,v39,vcc
global_load_dwordx4 v[76:79],v[38:39],off
v_add_co_u32 v38,vcc,3584,v38
s_nop 1
v_addc_co_u32 v39,vcc,0,v39,vcc
global_load_dwordx4 v[80:83],v[38:39],off
v_add_co_u32 v38,vcc,3584,v38
s_nop 1
v_addc_co_u32 v39,vcc,0,v39,vcc
global_load_dwordx4 v[84:87],v[38:39],off
v_add_co_u32 v38,vcc,3584,v38
s_nop 1
v_addc_co_u32 v39,vcc,0,v39,vcc
global_load_dwordx4 v[88:91],v[38:39],off
v_add_co_u32 v38,vcc,3584,v38
s_nop 1
v_addc_co_u32 v39,vcc,0,v39,vcc
global_load_dwordx4 v[92:95],v[38:39],off
v_add_co_u32 v38,vcc,3584,v38
s_nop 1
v_addc_co_u32 v39,vcc,0,v39,vcc
global_load_dwordx4 v[96:99],v[38:39],off
v_add_co_u32 v38,vcc,3584,v38
s_nop 1
v_addc_co_u32 v39,vcc,0,v39,vcc
global_load_dwordx4 v[100:103],v[38:39],off
v_add_co_u32 v38,vcc,3584,v38
s_nop 1
v_addc_co_u32 v39,vcc,0,v39,vcc
global_load_dwordx4 v[104:107],v[38:39],off
v_add_co_u32 v38,vcc,3584,v38
s_nop 1
v_addc_co_u32 v39,vcc,0,v39,vcc
s_waitcnt vmcnt(15)
ds_write_b128 v37,v[44:47] offset:16384
s_waitcnt vmcnt(14)
ds_write_b128 v37,v[48:51] offset:17408
s_waitcnt vmcnt(13)
ds_write_b128 v37,v[52:55] offset:18432
s_waitcnt vmcnt(12)
ds_write_b128 v37,v[56:59] offset:19456
s_waitcnt vmcnt(11)
ds_write_b128 v37,v[60:63] offset:20480
s_waitcnt vmcnt(10)
ds_write_b128 v37,v[64:67] offset:21504
s_waitcnt vmcnt(9)
ds_write_b128 v37,v[68:71] offset:22528
s_waitcnt vmcnt(8)
ds_write_b128 v37,v[72:75] offset:23552
s_waitcnt lgkmcnt(0)
s_waitcnt vmcnt(7)
ds_write_b128 v37,v[76:79] offset:24576
s_waitcnt vmcnt(6)
ds_write_b128 v37,v[80:83] offset:25600
s_waitcnt vmcnt(5)
ds_write_b128 v37,v[84:87] offset:26624
s_waitcnt vmcnt(4)
ds_write_b128 v37,v[88:91] offset:27648
s_waitcnt vmcnt(3)
ds_write_b128 v37,v[92:95] offset:28672
s_waitcnt vmcnt(2)
ds_write_b128 v37,v[96:99] offset:29696
s_waitcnt vmcnt(1)
ds_write_b128 v37,v[100:103] offset:30720
s_waitcnt vmcnt(0)
ds_write_b128 v37,v[104:107] offset:31744
s_waitcnt lgkmcnt(0)
v_mov_b32 v123,159744
s_cmp_lg_u32 s46,0
s_cbranch_scc1 L_gbd_29
v_mov_b32 v124,128
L_gb_28:
buffer_load_dword v125,v124,s[12:15],0 offen sc1
s_waitcnt vmcnt(0)
v_readfirstlane_b32 s56,v125
ds_write_b32 v123,v125
s_bitcmp1_b32 s56,8
s_cbranch_scc1 L_gbd_29
s_sleep 4
s_sub_u32 s49,s49,1
s_cmp_gt_i32 s49,0
s_cbranch_scc1 L_gb_28
s_branch L_abort
L_gbd_29:
s_waitcnt lgkmcnt(0)
s_barrier
ds_read_b32 v125,v123
s_waitcnt lgkmcnt(0)
v_readfirstlane_b32 s56,v125
s_barrier
s_lshr_b32 s56,s56,16
s_andn2_b32 s56,s56,s3
s_cbranch_scc1 L_spread
s_cmp_lg_u32 s3,0
s_cbranch_scc1 L_wm
v_and_b32 v120,15,v1
v_lshrrev_b32 v121,4,v1
v_mov_b32 v17,1
s_lshl_b32 s56,s46,15
v_add_u32 v18,s56,v0
s_lshl_b32 s56,s46,2
v_add_u32 v125,s56,v121
v_xor_b32 v126,v125,v120
v_lshlrev_b32 v126,4,v126
v_lshl_add_u32 v20,v125,10,v126
v_add_u32 v125,0,v121
v_xor_b32 v125,v125,v120
v_lshlrev_b32 v125,4,v125
v_lshl_add_u32 v125,v120,8,v125
v_add_u32 v4,131072,v125
v_add_u32 v125,4,v121
v_xor_b32 v125,v125,v120
v_lshlrev_b32 v125,4,v125
v_lshl_add_u32 v125,v120,8,v125
v_add_u32 v5,131072,v125
v_add_u32 v125,8,v121
v_xor_b32 v125,v125,v120
v_lshlrev_b32 v125,4,v125
v_lshl_add_u32 v125,v120,8,v125
v_add_u32 v6,131072,v125
v_add_u32 v125,12,v121
v_xor_b32 v125,v125,v120
v_lshlrev_b32 v125,4,v125
v_lshl_add_u32 v125,v120,8,v125
v_add_u32 v7,131072,v125
v_lshlrev_b32 v21,5,v120
v_and_b32 v125,1,v121
v_lshl_add_u32 v21,v125,4,v21
s_lshl_b32 s56,s46,9
v_lshrrev_b32 v125,1,v121
v_lshl_add_u32 v21,v125,11,v21
s_add_u32 s56,s56,155648
v_add_u32 v21,s56,v21
v_lshlrev_b32 v22,4,v120
v_lshl_add_u32 v22,v121,10,v22
s_lshl_b32 s56,s46,8
v_add_u32 v22,s56,v22
s_mov_b32 s54,0
s_mov_b32 s31,0
s_mov_b32 s53,6
s_mov_b32 s72,0x80000000
s_mov_b32 s73,0
s_mov_b32 s77,-1
s_mov_b32 s86,0
s_mov_b32 s19,0
s_mov_b32 s74,2948595712
s_mov_b32 s75,2863311530
v_and_b32 v23,15,v1
v_lshlrev_b32 v23,3,v23
v_lshrrev_b32 v16,4,v1
v_lshl_add_u32 v23,v16,13,v23
v_mov_b32 v19,159744
v_lshl_add_u32 v16,v16,2,v19
v_and_b32 v9,15,v1
v_lshrrev_b32 v10,4,v1
v_and_b32 v124,1,v1
v_lshlrev_b32 v124,4,v124
v_mov_b32 v125,0xffff
v_lshlrev_b32 v125,v124,v125
v_lshrrev_b32 v124,2,v9
v_cmp_eq_u32 vcc,0,v124
s_nop 1
v_cndmask_b32 v12,0,v125,vcc
v_cmp_eq_u32 vcc,1,v124
s_nop 1
v_cndmask_b32 v13,0,v125,vcc
v_and_b32 v124,2,v1
v_cmp_eq_u32 vcc,0,v124
v_mov_b32 v14,0xeeee
v_mov_b32 v124,0x4444
v_cndmask_b32 v14,v14,v124,vcc
v_lshlrev_b32 v11,14,v10
v_lshl_add_u32 v11,v9,4,v11
s_lshl_b32 s65,s51,15
s_add_u32 s65,s65,92274688
s_lshl_b32 s62,s47,10
s_add_u32 s62,s62,s65
s_lshl_b32 s63,s47,16
s_lshl_b32 s60,s46,8
s_add_u32 s63,s63,s60
s_mov_b32 s4,s38
s_mov_b32 s5,s39
s_mov_b32 s6,1835008
s_mov_b32 s7,0x20000
buffer_load_dwordx4 v[24:27],v11,s[4:7],s63 offen offset:0
buffer_load_dwordx4 v[28:31],v11,s[4:7],s63 offen offset:1024
buffer_load_dwordx4 v[32:35],v11,s[4:7],s63 offen offset:2048
buffer_load_dwordx4 v[36:39],v11,s[4:7],s63 offen offset:3072
s_add_u32 s63,s63,4096
buffer_load_dwordx4 v[40:43],v11,s[4:7],s63 offen offset:0
buffer_load_dwordx4 v[44:47],v11,s[4:7],s63 offen offset:1024
buffer_load_dwordx4 v[48:51],v11,s[4:7],s63 offen offset:2048
buffer_load_dwordx4 v[52:55],v11,s[4:7],s63 offen offset:3072
s_add_u32 s63,s63,4096
buffer_load_dwordx4 v[56:59],v11,s[4:7],s63 offen offset:0
buffer_load_dwordx4 v[60:63],v11,s[4:7],s63 offen offset:1024
buffer_load_dwordx4 v[64:67],v11,s[4:7],s63 offen offset:2048
buffer_load_dwordx4 v[68:71],v11,s[4:7],s63 offen offset:3072
s_add_u32 s63,s63,4096
buffer_load_dwordx4 v[72:75],v11,s[4:7],s63 offen offset:0
buffer_load_dwordx4 v[76:79],v11,s[4:7],s63 offen offset:1024
buffer_load_dwordx4 v[80:83],v11,s[4:7],s63 offen offset:2048
buffer_load_dwordx4 v[84:87],v11,s[4:7],s63 offen offset:3072
s_mov_b32 s4,s32
s_mov_b32 s5,s33
s_mov_b32 s6,1024
s_mov_b32 s7,0x20000
buffer_load_dwordx4 v[88:91],v0,s[4:7],0 offen
s_waitcnt vmcnt(0)
v_lshlrev_b32 v96,16,v88
v_and_b32 v97,0xffff0000,v88
v_lshlrev_b32 v98,16,v89
v_and_b32 v99,0xffff0000,v89
v_lshlrev_b32 v100,16,v90
v_and_b32 v101,0xffff0000,v90
v_lshlrev_b32 v102,16,v91
v_and_b32 v103,0xffff0000,v91
v_mul_f32 v88,v96,v96
v_fma_f32 v88,v97,v97,v88
v_fma_f32 v88,v98,v98,v88
v_fma_f32 v88,v99,v99,v88
v_fma_f32 v88,v100,v100,v88
v_fma_f32 v88,v101,v101,v88
v_fma_f32 v88,v102,v102,v88
v_fma_f32 v88,v103,v103,v88
s_nop 1
v_add_f32_dpp v88,v88,v88 row_ror:8 row_mask:0xf bank_mask:0xf
s_nop 1
v_add_f32_dpp v88,v88,v88 row_ror:4 row_mask:0xf bank_mask:0xf
s_nop 1
v_add_f32_dpp v88,v88,v88 row_ror:2 row_mask:0xf bank_mask:0xf
s_nop 1
v_add_f32_dpp v88,v88,v88 row_ror:1 row_mask:0xf bank_mask:0xf
v_mov_b32 v89,v88
s_nop 1
v_permlane16_swap_b32 v88,v89
v_add_f32 v88,v88,v89
v_mov_b32 v89,v88
s_nop 1
v_permlane32_swap_b32 v88,v89
v_add_f32 v88,v88,v89
v_sqrt_f32 v88,v88
s_nop 0
v_mul_f32 v88,0x40333333,v88
s_nop 0
v_readfirstlane_b32 s25,v88
s_bitset1_b32 s25,31
s_ff1_i32_b64 s30,s[74:75]
s_bitset0_b64 s[74:75],s30
s_min_u32 s30,s30,127
s_lshl_b32 s70,s30,15
s_add_u32 s70,s70,0
s_add_u32 s71,s70,16384
L_mo_34:
s_cmp_lg_u32 s19,0
s_cbranch_scc1 L_mo_35
s_add_u32 m0,s50,131072
s_nop 0
buffer_load_dwordx4 v20,s[8:11],s70 offen offset:0 sc1 lds
s_add_u32 m0,s50,135168
s_nop 0
buffer_load_dwordx4 v20,s[8:11],s71 offen offset:0 sc1 lds
s_add_u32 m0,s50,139008
s_nop 0
buffer_load_dwordx4 v20,s[8:11],s70 offen offset:256 sc1 lds
s_add_u32 m0,s50,143104
s_nop 0
buffer_load_dwordx4 v20,s[8:11],s71 offen offset:256 sc1 lds
s_add_u32 m0,s50,146944
s_nop 0
buffer_load_dwordx4 v20,s[8:11],s70 offen offset:512 sc1 lds
s_add_u32 m0,s50,151040
s_nop 0
buffer_load_dwordx4 v20,s[8:11],s71 offen offset:512 sc1 lds
s_mov_b32 s19,1
s_waitcnt vmcnt(0)
L_mo_35:
s_mov_b32 s51,s30
s_mov_b64 s[68:69],s[70:71]
s_ff1_i32_b64 s30,s[74:75]
s_bitset0_b64 s[74:75],s30
s_min_u32 s30,s30,127
s_lshl_b32 s70,s30,15
s_add_u32 s70,s70,0
s_add_u32 s71,s70,16384
s_lshl_b32 s76,s31,13
s_add_u32 s76,s76,10487040
s_lshl_b32 s58,s51,5
s_add_u32 s58,s58,s47
s_mul_i32 s58,s58,24576
s_add_u32 s58,s58,100663296
s_add_u32 s61,s58,s50
s_add_u32 s62,s61,4096
s_add_u32 s63,s61,16384
s_add_u32 s64,s61,20480
s_add_u32 s65,s61,s50
s_add_u32 s65,s65,8192
s_waitcnt vmcnt(12)
s_barrier
ds_read_b128 v[72:75],v4 offset:0
ds_read_b128 v[76:79],v4 offset:4096
ds_read_b128 v[80:83],v5 offset:0
ds_read_b128 v[84:87],v5 offset:4096
s_add_u32 m0,s50,154880
s_nop 0
buffer_load_dwordx4 v20,s[8:11],s68 offen offset:768 sc1 lds
s_add_u32 m0,s50,158976
s_nop 0
buffer_load_dwordx4 v20,s[8:11],s69 offen offset:768 sc1 lds
s_waitcnt lgkmcnt(2)
v_mfma_f32_16x16x32_bf16 v[40:43],a[128:131],v[72:75],0
ds_read_b128 v[108:111],v6 offset:0
v_mfma_f32_16x16x32_bf16 v[56:59],v[72:75],v[128:131],0
v_mfma_f32_16x16x32_bf16 v[24:27],a[0:3],v[72:75],0
ds_read_b128 v[112:115],v6 offset:4096
v_mfma_f32_16x16x32_bf16 v[44:47],a[128:131],v[76:79],0
v_mfma_f32_16x16x32_bf16 v[60:63],v[76:79],v[128:131],0
v_mfma_f32_16x16x32_bf16 v[28:31],a[0:3],v[76:79],0
v_mfma_f32_16x16x32_bf16 v[48:51],a[136:139],v[72:75],0
v_mfma_f32_16x16x32_bf16 v[64:67],v[72:75],v[136:139],0
v_mfma_f32_16x16x32_bf16 v[32:35],a[8:11],v[72:75],0
v_mfma_f32_16x16x32_bf16 v[52:55],a[136:139],v[76:79],0
v_mfma_f32_16x16x32_bf16 v[68:71],v[76:79],v[136:139],0
v_mfma_f32_16x16x32_bf16 v[36:39],a[8:11],v[76:79],0
s_waitcnt lgkmcnt(2)
v_mfma_f32_16x16x32_bf16 v[40:43],a[132:135],v[80:83],v[40:43]
ds_read_b128 v[72:75],v7 offset:0
v_mfma_f32_16x16x32_bf16 v[56:59],v[80:83],v[132:135],v[56:59]
v_mfma_f32_16x16x32_bf16 v[24:27],a[4:7],v[80:83],v[24:27]
ds_read_b128 v[76:79],v7 offset:4096
v_mfma_f32_16x16x32_bf16 v[44:47],a[132:135],v[84:87],v[44:47]
v_mfma_f32_16x16x32_bf16 v[60:63],v[84:87],v[132:135],v[60:63]
v_mfma_f32_16x16x32_bf16 v[28:31],a[4:7],v[84:87],v[28:31]
v_mfma_f32_16x16x32_bf16 v[48:51],a[140:143],v[80:83],v[48:51]
v_mfma_f32_16x16x32_bf16 v[64:67],v[80:83],v[140:143],v[64:67]
v_mfma_f32_16x16x32_bf16 v[32:35],a[12:15],v[80:83],v[32:35]
v_mfma_f32_16x16x32_bf16 v[52:55],a[140:143],v[84:87],v[52:55]
v_mfma_f32_16x16x32_bf16 v[68:71],v[84:87],v[140:143],v[68:71]
v_mfma_f32_16x16x32_bf16 v[36:39],a[12:15],v[84:87],v[36:39]
s_waitcnt vmcnt(12)
s_barrier
s_waitcnt lgkmcnt(2)
v_mfma_f32_16x16x32_bf16 v[40:43],a[144:147],v[108:111],v[40:43]
ds_read_b128 v[80:83],v4 offset:8192
v_mfma_f32_16x16x32_bf16 v[56:59],v[108:111],v[144:147],v[56:59]
v_mfma_f32_16x16x32_bf16 v[24:27],a[16:19],v[108:111],v[24:27]
ds_read_b128 v[84:87],v4 offset:12288
v_mfma_f32_16x16x32_bf16 v[44:47],a[144:147],v[112:115],v[44:47]
v_mfma_f32_16x16x32_bf16 v[60:63],v[112:115],v[144:147],v[60:63]
v_mfma_f32_16x16x32_bf16 v[28:31],a[16:19],v[112:115],v[28:31]
v_mfma_f32_16x16x32_bf16 v[48:51],a[152:155],v[108:111],v[48:51]
v_mfma_f32_16x16x32_bf16 v[64:67],v[108:111],v[152:155],v[64:67]
v_mfma_f32_16x16x32_bf16 v[32:35],a[24:27],v[108:111],v[32:35]
v_mfma_f32_16x16x32_bf16 v[52:55],a[152:155],v[112:115],v[52:55]
v_mfma_f32_16x16x32_bf16 v[68:71],v[112:115],v[152:155],v[68:71]
v_mfma_f32_16x16x32_bf16 v[36:39],a[24:27],v[112:115],v[36:39]
s_waitcnt lgkmcnt(2)
v_mfma_f32_16x16x32_bf16 v[40:43],a[148:151],v[72:75],v[40:43]
ds_read_b128 v[108:111],v5 offset:8192
v_mfma_f32_16x16x32_bf16 v[56:59],v[72:75],v[148:151],v[56:59]
v_mfma_f32_16x16x32_bf16 v[24:27],a[20:23],v[72:75],v[24:27]
ds_read_b128 v[112:115],v5 offset:12288
v_mfma_f32_16x16x32_bf16 v[44:47],a[148:151],v[76:79],v[44:47]
v_mfma_f32_16x16x32_bf16 v[60:63],v[76:79],v[148:151],v[60:63]
v_mfma_f32_16x16x32_bf16 v[28:31],a[20:23],v[76:79],v[28:31]
v_mfma_f32_16x16x32_bf16 v[48:51],a[156:159],v[72:75],v[48:51]
v_mfma_f32_16x16x32_bf16 v[64:67],v[72:75],v[156:159],v[64:67]
v_mfma_f32_16x16x32_bf16 v[32:35],a[28:31],v[72:75],v[32:35]
v_mfma_f32_16x16x32_bf16 v[52:55],a[156:159],v[76:79],v[52:55]
v_mfma_f32_16x16x32_bf16 v[68:71],v[76:79],v[156:159],v[68:71]
v_mfma_f32_16x16x32_bf16 v[36:39],a[28:31],v[76:79],v[36:39]
s_waitcnt lgkmcnt(2)
v_mfma_f32_16x16x32_bf16 v[40:43],a[160:163],v[80:83],v[40:43]
ds_read_b128 v[72:75],v6 offset:8192
v_mfma_f32_16x16x32_bf16 v[56:59],v[80:83],v[160:163],v[56:59]
v_mfma_f32_16x16x32_bf16 v[24:27],a[32:35],v[80:83],v[24:27]
ds_read_b128 v[76:79],v6 offset:12288
v_mfma_f32_16x16x32_bf16 v[44:47],a[160:163],v[84:87],v[44:47]
v_mfma_f32_16x16x32_bf16 v[60:63],v[84:87],v[160:163],v[60:63]
v_mfma_f32_16x16x32_bf16 v[28:31],a[32:35],v[84:87],v[28:31]
v_mfma_f32_16x16x32_bf16 v[48:51],a[168:171],v[80:83],v[48:51]
v_mfma_f32_16x16x32_bf16 v[64:67],v[80:83],v[168:171],v[64:67]
v_mfma_f32_16x16x32_bf16 v[32:35],a[40:43],v[80:83],v[32:35]
v_mfma_f32_16x16x32_bf16 v[52:55],a[168:171],v[84:87],v[52:55]
v_mfma_f32_16x16x32_bf16 v[68:71],v[84:87],v[168:171],v[68:71]
v_mfma_f32_16x16x32_bf16 v[36:39],a[40:43],v[84:87],v[36:39]
s_waitcnt lgkmcnt(2)
v_mfma_f32_16x16x32_bf16 v[40:43],a[164:167],v[108:111],v[40:43]
ds_read_b128 v[80:83],v7 offset:8192
v_mfma_f32_16x16x32_bf16 v[56:59],v[108:111],v[164:167],v[56:59]
v_mfma_f32_16x16x32_bf16 v[24:27],a[36:39],v[108:111],v[24:27]
ds_read_b128 v[84:87],v7 offset:12288
v_mfma_f32_16x16x32_bf16 v[44:47],a[164:167],v[112:115],v[44:47]
v_mfma_f32_16x16x32_bf16 v[60:63],v[112:115],v[164:167],v[60:63]
v_mfma_f32_16x16x32_bf16 v[28:31],a[36:39],v[112:115],v[28:31]
v_mfma_f32_16x16x32_bf16 v[48:51],a[172:175],v[108:111],v[48:51]
v_mfma_f32_16x16x32_bf16 v[64:67],v[108:111],v[172:175],v[64:67]
v_mfma_f32_16x16x32_bf16 v[32:35],a[44:47],v[108:111],v[32:35]
v_mfma_f32_16x16x32_bf16 v[52:55],a[172:175],v[112:115],v[52:55]
v_mfma_f32_16x16x32_bf16 v[68:71],v[112:115],v[172:175],v[68:71]
v_mfma_f32_16x16x32_bf16 v[36:39],a[44:47],v[112:115],v[36:39]
s_waitcnt vmcnt(10)
s_barrier
s_waitcnt lgkmcnt(2)
v_mfma_f32_16x16x32_bf16 v[40:43],a[176:179],v[72:75],v[40:43]
ds_read_b128 v[108:111],v4 offset:16384
v_mfma_f32_16x16x32_bf16 v[56:59],v[72:75],v[176:179],v[56:59]
v_mfma_f32_16x16x32_bf16 v[24:27],a[48:51],v[72:75],v[24:27]
ds_read_b128 v[112:115],v4 offset:20480
v_mfma_f32_16x16x32_bf16 v[44:47],a[176:179],v[76:79],v[44:47]
v_mfma_f32_16x16x32_bf16 v[60:63],v[76:79],v[176:179],v[60:63]
v_mfma_f32_16x16x32_bf16 v[28:31],a[48:51],v[76:79],v[28:31]
v_mfma_f32_16x16x32_bf16 v[48:51],a[184:187],v[72:75],v[48:51]
v_mfma_f32_16x16x32_bf16 v[64:67],v[72:75],v[184:187],v[64:67]
v_mfma_f32_16x16x32_bf16 v[32:35],a[56:59],v[72:75],v[32:35]
v_mfma_f32_16x16x32_bf16 v[52:55],a[184:187],v[76:79],v[52:55]
v_mfma_f32_16x16x32_bf16 v[68:71],v[76:79],v[184:187],v[68:71]
v_mfma_f32_16x16x32_bf16 v[36:39],a[56:59],v[76:79],v[36:39]
s_waitcnt vmcnt(2)
s_barrier
s_or_b32 s72,s72,s52
buffer_store_dword v17,off,s[8:11],s72 sc1
s_waitcnt lgkmcnt(2)
v_mfma_f32_16x16x32_bf16 v[40:43],a[180:183],v[80:83],v[40:43]
ds_read_b128 v[72:75],v5 offset:16384
v_mfma_f32_16x16x32_bf16 v[56:59],v[80:83],v[180:183],v[56:59]
v_mfma_f32_16x16x32_bf16 v[24:27],a[52:55],v[80:83],v[24:27]
ds_read_b128 v[76:79],v5 offset:20480
v_mfma_f32_16x16x32_bf16 v[44:47],a[180:183],v[84:87],v[44:47]
v_mfma_f32_16x16x32_bf16 v[60:63],v[84:87],v[180:183],v[60:63]
v_mfma_f32_16x16x32_bf16 v[28:31],a[52:55],v[84:87],v[28:31]
v_mfma_f32_16x16x32_bf16 v[48:51],a[188:191],v[80:83],v[48:51]
v_mfma_f32_16x16x32_bf16 v[64:67],v[80:83],v[188:191],v[64:67]
v_mfma_f32_16x16x32_bf16 v[32:35],a[60:63],v[80:83],v[32:35]
v_mfma_f32_16x16x32_bf16 v[52:55],a[188:191],v[84:87],v[52:55]
v_mfma_f32_16x16x32_bf16 v[68:71],v[84:87],v[188:191],v[68:71]
v_mfma_f32_16x16x32_bf16 v[36:39],a[60:63],v[84:87],v[36:39]
s_waitcnt lgkmcnt(2)
v_mfma_f32_16x16x32_bf16 v[40:43],a[192:195],v[108:111],v[40:43]
ds_read_b128 v[80:83],v6 offset:16384
v_mfma_f32_16x16x32_bf16 v[56:59],v[108:111],v[192:195],v[56:59]
v_mfma_f32_16x16x32_bf16 v[24:27],a[64:67],v[108:111],v[24:27]
ds_read_b128 v[84:87],v6 offset:20480
v_mfma_f32_16x16x32_bf16 v[44:47],a[192:195],v[112:115],v[44:47]
v_mfma_f32_16x16x32_bf16 v[60:63],v[112:115],v[192:195],v[60:63]
v_mfma_f32_16x16x32_bf16 v[28:31],a[64:67],v[112:115],v[28:31]
v_mfma_f32_16x16x32_bf16 v[48:51],a[200:203],v[108:111],v[48:51]
v_mfma_f32_16x16x32_bf16 v[64:67],v[108:111],v[200:203],v[64:67]
v_mfma_f32_16x16x32_bf16 v[32:35],a[72:75],v[108:111],v[32:35]
v_mfma_f32_16x16x32_bf16 v[52:55],a[200:203],v[112:115],v[52:55]
v_mfma_f32_16x16x32_bf16 v[68:71],v[112:115],v[200:203],v[68:71]
v_mfma_f32_16x16x32_bf16 v[36:39],a[72:75],v[112:115],v[36:39]
s_waitcnt lgkmcnt(2)
v_mfma_f32_16x16x32_bf16 v[40:43],a[196:199],v[72:75],v[40:43]
ds_read_b128 v[108:111],v7 offset:16384
v_mfma_f32_16x16x32_bf16 v[56:59],v[72:75],v[196:199],v[56:59]
v_mfma_f32_16x16x32_bf16 v[24:27],a[68:71],v[72:75],v[24:27]
ds_read_b128 v[112:115],v7 offset:20480
v_mfma_f32_16x16x32_bf16 v[44:47],a[196:199],v[76:79],v[44:47]
v_mfma_f32_16x16x32_bf16 v[60:63],v[76:79],v[196:199],v[60:63]
v_mfma_f32_16x16x32_bf16 v[28:31],a[68:71],v[76:79],v[28:31]
v_mfma_f32_16x16x32_bf16 v[48:51],a[204:207],v[72:75],v[48:51]
v_mfma_f32_16x16x32_bf16 v[64:67],v[72:75],v[204:207],v[64:67]
v_mfma_f32_16x16x32_bf16 v[32:35],a[76:79],v[72:75],v[32:35]
v_mfma_f32_16x16x32_bf16 v[52:55],a[204:207],v[76:79],v[52:55]
v_mfma_f32_16x16x32_bf16 v[68:71],v[76:79],v[204:207],v[68:71]
v_mfma_f32_16x16x32_bf16 v[36:39],a[76:79],v[76:79],v[36:39]
s_waitcnt vmcnt(1)
s_barrier
s_waitcnt lgkmcnt(2)
v_mfma_f32_16x16x32_bf16 v[40:43],a[208:211],v[80:83],v[40:43]
ds_read_b128 v[72:75],v4 offset:24576
v_mfma_f32_16x16x32_bf16 v[56:59],v[80:83],v[208:211],v[56:59]
v_mfma_f32_16x16x32_bf16 v[24:27],a[80:83],v[80:83],v[24:27]
ds_read_b128 v[76:79],v4 offset:28672
v_mfma_f32_16x16x32_bf16 v[44:47],a[208:211],v[84:87],v[44:47]
v_mfma_f32_16x16x32_bf16 v[60:63],v[84:87],v[208:211],v[60:63]
v_mfma_f32_16x16x32_bf16 v[28:31],a[80:83],v[84:87],v[28:31]
v_mfma_f32_16x16x32_bf16 v[48:51],a[216:219],v[80:83],v[48:51]
v_mfma_f32_16x16x32_bf16 v[64:67],v[80:83],v[216:219],v[64:67]
v_mfma_f32_16x16x32_bf16 v[32:35],a[88:91],v[80:83],v[32:35]
v_mfma_f32_16x16x32_bf16 v[52:55],a[216:219],v[84:87],v[52:55]
v_mfma_f32_16x16x32_bf16 v[68:71],v[84:87],v[216:219],v[68:71]
v_mfma_f32_16x16x32_bf16 v[36:39],a[88:91],v[84:87],v[36:39]
s_waitcnt lgkmcnt(2)
v_mfma_f32_16x16x32_bf16 v[40:43],a[212:215],v[108:111],v[40:43]
ds_read_b128 v[80:83],v5 offset:24576
v_mfma_f32_16x16x32_bf16 v[56:59],v[108:111],v[212:215],v[56:59]
v_mfma_f32_16x16x32_bf16 v[24:27],a[84:87],v[108:111],v[24:27]
ds_read_b128 v[84:87],v5 offset:28672
v_mfma_f32_16x16x32_bf16 v[44:47],a[212:215],v[112:115],v[44:47]
v_mfma_f32_16x16x32_bf16 v[60:63],v[112:115],v[212:215],v[60:63]
v_mfma_f32_16x16x32_bf16 v[28:31],a[84:87],v[112:115],v[28:31]
v_mfma_f32_16x16x32_bf16 v[48:51],a[220:223],v[108:111],v[48:51]
v_mfma_f32_16x16x32_bf16 v[64:67],v[108:111],v[220:223],v[64:67]
v_mfma_f32_16x16x32_bf16 v[32:35],a[92:95],v[108:111],v[32:35]
v_mfma_f32_16x16x32_bf16 v[52:55],a[220:223],v[112:115],v[52:55]
v_mfma_f32_16x16x32_bf16 v[68:71],v[112:115],v[220:223],v[68:71]
v_mfma_f32_16x16x32_bf16 v[36:39],a[92:95],v[112:115],v[36:39]
s_barrier
s_waitcnt lgkmcnt(2)
v_mfma_f32_16x16x32_bf16 v[40:43],a[224:227],v[72:75],v[40:43]
ds_read_b128 v[108:111],v6 offset:24576
v_mfma_f32_16x16x32_bf16 v[56:59],v[72:75],v[224:227],v[56:59]
s_add_u32 m0,s50,131072
v_mfma_f32_16x16x32_bf16 v[24:27],a[96:99],v[72:75],v[24:27]
ds_read_b128 v[112:115],v6 offset:28672
v_mfma_f32_16x16x32_bf16 v[44:47],a[224:227],v[76:79],v[44:47]
buffer_load_dwordx4 v20,s[8:11],s70 offen offset:0 sc1 lds
v_mfma_f32_16x16x32_bf16 v[60:63],v[76:79],v[224:227],v[60:63]
s_add_u32 m0,s50,135168
v_mfma_f32_16x16x32_bf16 v[28:31],a[96:99],v[76:79],v[28:31]
buffer_load_dwordx4 v20,s[8:11],s71 offen offset:0 sc1 lds
v_mfma_f32_16x16x32_bf16 v[48:51],a[232:235],v[72:75],v[48:51]
s_add_u32 m0,s50,139008
v_mfma_f32_16x16x32_bf16 v[64:67],v[72:75],v[232:235],v[64:67]
buffer_load_dwordx4 v20,s[8:11],s70 offen offset:256 sc1 lds
v_mfma_f32_16x16x32_bf16 v[32:35],a[104:107],v[72:75],v[32:35]
s_add_u32 m0,s50,143104
v_mfma_f32_16x16x32_bf16 v[52:55],a[232:235],v[76:79],v[52:55]
buffer_load_dwordx4 v20,s[8:11],s71 offen offset:256 sc1 lds
v_mfma_f32_16x16x32_bf16 v[68:71],v[76:79],v[232:235],v[68:71]
s_add_u32 m0,s50,146944
v_mfma_f32_16x16x32_bf16 v[36:39],a[104:107],v[76:79],v[36:39]
buffer_load_dwordx4 v20,s[8:11],s70 offen offset:512 sc1 lds
s_waitcnt lgkmcnt(2)
v_mfma_f32_16x16x32_bf16 v[40:43],a[228:231],v[80:83],v[40:43]
ds_read_b128 v[72:75],v7 offset:24576
v_mfma_f32_16x16x32_bf16 v[56:59],v[80:83],v[228:231],v[56:59]
s_add_u32 m0,s50,151040
v_mfma_f32_16x16x32_bf16 v[24:27],a[100:103],v[80:83],v[24:27]
ds_read_b128 v[76:79],v7 offset:28672
v_mfma_f32_16x16x32_bf16 v[44:47],a[228:231],v[84:87],v[44:47]
buffer_load_dwordx4 v20,s[8:11],s71 offen offset:512 sc1 lds
v_mfma_f32_16x16x32_bf16 v[60:63],v[84:87],v[228:231],v[60:63]
buffer_load_dwordx2 v[124:125],v23,s[8:11],s76 offen sc1
v_mfma_f32_16x16x32_bf16 v[28:31],a[100:103],v[84:87],v[28:31]
v_mfma_f32_16x16x32_bf16 v[48:51],a[236:239],v[80:83],v[48:51]
v_mfma_f32_16x16x32_bf16 v[64:67],v[80:83],v[236:239],v[64:67]
v_mfma_f32_16x16x32_bf16 v[32:35],a[108:111],v[80:83],v[32:35]
v_mfma_f32_16x16x32_bf16 v[52:55],a[236:239],v[84:87],v[52:55]
v_mfma_f32_16x16x32_bf16 v[68:71],v[84:87],v[236:239],v[68:71]
v_mfma_f32_16x16x32_bf16 v[36:39],a[108:111],v[84:87],v[36:39]
s_waitcnt lgkmcnt(2)
v_mfma_f32_16x16x32_bf16 v[40:43],a[240:243],v[108:111],v[40:43]
v_mfma_f32_16x16x32_bf16 v[56:59],v[108:111],v[240:243],v[56:59]
v_mfma_f32_16x16x32_bf16 v[24:27],a[112:115],v[108:111],v[24:27]
v_mfma_f32_16x16x32_bf16 v[44:47],a[240:243],v[112:115],v[44:47]
v_mfma_f32_16x16x32_bf16 v[60:63],v[112:115],v[240:243],v[60:63]
v_mfma_f32_16x16x32_bf16 v[28:31],a[112:115],v[112:115],v[28:31]
v_mfma_f32_16x16x32_bf16 v[48:51],a[248:251],v[108:111],v[48:51]
v_mfma_f32_16x16x32_bf16 v[64:67],v[108:111],v[248:251],v[64:67]
v_mfma_f32_16x16x32_bf16 v[32:35],a[120:123],v[108:111],v[32:35]
v_mfma_f32_16x16x32_bf16 v[52:55],a[248:251],v[112:115],v[52:55]
v_mfma_f32_16x16x32_bf16 v[68:71],v[112:115],v[248:251],v[68:71]
v_mfma_f32_16x16x32_bf16 v[36:39],a[120:123],v[112:115],v[36:39]
s_waitcnt lgkmcnt(0)
v_mfma_f32_16x16x32_bf16 v[40:43],a[244:247],v[72:75],v[40:43]
v_mfma_f32_16x16x32_bf16 v[56:59],v[72:75],v[244:247],v[56:59]
v_mfma_f32_16x16x32_bf16 v[24:27],a[116:119],v[72:75],v[24:27]
v_mfma_f32_16x16x32_bf16 v[44:47],a[244:247],v[76:79],v[44:47]
v_mfma_f32_16x16x32_bf16 v[60:63],v[76:79],v[244:247],v[60:63]
v_mfma_f32_16x16x32_bf16 v[28:31],a[116:119],v[76:79],v[28:31]
v_mfma_f32_16x16x32_bf16 v[48:51],a[252:255],v[72:75],v[48:51]
v_mfma_f32_16x16x32_bf16 v[64:67],v[72:75],v[252:255],v[64:67]
v_mfma_f32_16x16x32_bf16 v[32:35],a[124:127],v[72:75],v[32:35]
v_mfma_f32_16x16x32_bf16 v[52:55],a[252:255],v[76:79],v[52:55]
v_mfma_f32_16x16x32_bf16 v[68:71],v[76:79],v[252:255],v[68:71]
v_mfma_f32_16x16x32_bf16 v[36:39],a[124:127],v[76:79],v[36:39]
s_lshl_b32 s56,s51,5
s_add_u32 s56,s56,s47
s_lshl_b32 s56,s56,12
s_add_u32 s56,s56,s50
s_add_u32 s56,s56,41943040
v_mov_b64 v[120:121],-1
v_mov_b64 v[122:123],-1
buffer_store_dwordx4 v[120:123],v0,s[8:11],s56 offen sc1
v_cvt_pk_bf16_f32 v72,v40,v48
v_cvt_pk_bf16_f32 v73,v41,v49
v_cvt_pk_bf16_f32 v74,v42,v50
v_cvt_pk_bf16_f32 v75,v43,v51
buffer_store_dwordx4 v[72:75],v0,s[8:11],s61 offen sc1
v_cvt_pk_bf16_f32 v76,v44,v52
v_cvt_pk_bf16_f32 v77,v45,v53
v_cvt_pk_bf16_f32 v78,v46,v54
v_cvt_pk_bf16_f32 v79,v47,v55
buffer_store_dwordx4 v[76:79],v0,s[8:11],s62 offen sc1
v_cvt_pk_bf16_f32 v80,v56,v57
v_cvt_pk_bf16_f32 v81,v58,v59
v_cvt_pk_bf16_f32 v82,v60,v61
v_cvt_pk_bf16_f32 v83,v62,v63
buffer_store_dwordx4 v[80:83],v0,s[8:11],s65 offen offset:0 sc1
v_cvt_pk_bf16_f32 v84,v64,v65
v_cvt_pk_bf16_f32 v85,v66,v67
v_cvt_pk_bf16_f32 v86,v68,v69
v_cvt_pk_bf16_f32 v87,v70,v71
buffer_store_dwordx4 v[84:87],v0,s[8:11],s65 offen offset:1024 sc1
v_cvt_pk_bf16_f32 v108,v24,v32
v_cvt_pk_bf16_f32 v109,v25,v33
v_cvt_pk_bf16_f32 v110,v26,v34
v_cvt_pk_bf16_f32 v111,v27,v35
buffer_store_dwordx4 v[108:111],v0,s[8:11],s63 offen sc1
v_cvt_pk_bf16_f32 v112,v28,v36
v_cvt_pk_bf16_f32 v113,v29,v37
v_cvt_pk_bf16_f32 v114,v30,v38
v_cvt_pk_bf16_f32 v115,v31,v39
buffer_store_dwordx4 v[112:115],v0,s[8:11],s64 offen sc1
s_lshl_b32 s72,s51,13
s_lshl2_add_u32 s72,s47,s72
s_add_u32 s72,s72,10485760
s_sub_u32 s53,s53,1
s_cmp_gt_i32 s53,3
s_cbranch_scc1 L_mo_35
s_cmp_gt_i32 s53,0
s_cselect_b32 s87,1,3
s_mov_b32 s18,0
s_waitcnt vmcnt(7)
s_branch L_mo_40
L_mo_33:
s_mov_b32 s55,s22
s_mov_b32 s22,s23
s_mov_b32 s23,s24
s_mov_b32 s24,-1
v_mov_b32 v3,0
s_cmp_lg_u32 s55,-1
s_cbranch_scc1 L_mp_30
s_sub_u32 s56,s30,s31
s_cmp_gt_i32 s77,0
s_cselect_b32 s57,6,15
s_cmp_lg_u32 s86,0
s_cselect_b32 s57,9,s57
s_cmp_lt_i32 s56,s57
s_cbranch_scc1 L_mo_34
s_cmp_lt_i32 s56,30
s_cselect_b32 s87,s18,0
s_cmp_ge_u32 s31,8
s_cselect_b32 s56,1,s18
s_and_b32 s56,s56,s86
s_cselect_b32 s87,2,s87
s_mul_i32 s56,s87,s18
s_cmp_lg_u32 s56,0
s_cbranch_scc1 L_mo_38
s_mov_b32 s18,0
s_lshr_b32 s56,s72,31
s_or_b32 s56,s56,s87
s_cbranch_scc1 L_mo_44
s_waitcnt vmcnt(0)
s_barrier
s_or_b32 s72,s72,s52
buffer_store_dword v17,off,s[8:11],s72 sc1
s_mov_b32 s72,0x80000000
L_mo_44:
s_cmp_lg_u32 s46,0
s_cbranch_scc1 L_mo_42
s_lshl_b32 s76,s31,13
s_add_u32 s76,s76,10487040
s_lshl_b32 s57,s47,8
s_add_u32 s57,s57,s31
s_cmp_eq_u32 s57,63
s_mov_b32 s57,0x80000000
s_cmov_b32 s57,11018240
v_lshlrev_b32 v2,2,v1
L_mo_41:
buffer_load_dwordx2 v[124:125],v23,s[8:11],s76 offen sc1
buffer_load_dword v3,v2,s[8:11],s57 offen sc1
s_sub_u32 s49,s49,1
s_cbranch_scc1 L_abort
s_waitcnt vmcnt(0)
L_mo_40:
v_min_u32 v123,v124,v125
v_max_u32 v125,v124,v125
v_cmp_eq_u32 vcc,0,v123
s_nop 1
v_cndmask_b32 v125,v125,-1,vcc
s_and_b32 s56,vcc_lo,0xffff
s_cbranch_scc0 L_mo_45
s_cmp_lg_u32 s87,0
s_cbranch_scc1 L_mo_45
s_mov_b32 s18,1
s_sleep 2
s_branch L_mo_41
L_mo_45:
v_max_u32_dpp v125,v125,v125 row_ror:8 row_mask:0xf bank_mask:0xf
s_nop 1
v_max_u32_dpp v125,v125,v125 row_ror:4 row_mask:0xf bank_mask:0xf
s_nop 1
v_max_u32_dpp v125,v125,v125 row_ror:2 row_mask:0xf bank_mask:0xf
s_nop 1
v_max_u32_dpp v125,v125,v125 row_ror:1 row_mask:0xf bank_mask:0xf
L_mo_42:
s_sub_u32 s49,s49,1
s_cbranch_scc1 L_abort
v_mov_b32 v124,s18
s_barrier
s_cmp_lg_u32 s46,0
s_cbranch_scc1 L_mo_43
ds_write_b32 v16,v125
ds_write_b32 v19,v124 offset:16
s_waitcnt lgkmcnt(0)
L_mo_43:
s_barrier
ds_read_b128 v[120:123],v19
ds_read_b32 v124,v19 offset:16
s_waitcnt lgkmcnt(0)
v_readfirstlane_b32 s55,v120
v_readfirstlane_b32 s22,v121
v_readfirstlane_b32 s23,v122
v_readfirstlane_b32 s24,v123
v_readfirstlane_b32 s18,v124
s_cmp_lg_u32 s55,-1
s_cbranch_scc1 L_mp_30
L_mo_38:
s_mov_b32 s22,-1
s_cmp_eq_u32 s87,1
s_cbranch_scc1 L_mo_34
s_cmp_eq_u32 s87,2
s_cbranch_scc1 L_mo_39
s_branch L_mo_33
L_mp_30:
s_mov_b32 s53,0
s_sub_u32 s73,s73,1
s_max_i32 s73,s73,0
s_sub_u32 s77,s77,1
s_min_u32 s61,s73,2
s_cmp_lt_u32 s31,5
s_cselect_b32 s60,s25,0
s_cmp_lt_u32 s55,s60
s_cselect_b32 s61,2,s61
s_cmp_le_u32 s55,s54
s_cbranch_scc1 L_mr_31
s_mov_b32 s77,s61
s_mov_b32 s54,s55
s_mov_b32 s86,0
s_or_b32 s61,s47,s46
s_cbranch_scc1 L_mr_31
v_mov_b32 v120,s54
v_lshlrev_b32 v121,13,v1
s_mov_b32 s61,10486784
buffer_store_dword v120,v121,s[8:11],s61 offen sc1
L_mr_31:
s_cmp_lg_u32 s31,63
s_cbranch_scc1 L_mo_36
s_min_i32 s77,s77,0
s_or_b32 s61,s47,s46
s_cbranch_scc1 L_mo_36
s_mov_b32 s59,11018240
v_lshlrev_b32 v120,2,v1
v_mov_b32 v121,v3
v_cmp_eq_u32 vcc,0,v3
s_cbranch_vccz L_mg_32
L_fp_47:
s_sleep 0
buffer_load_dword v121,v120,s[8:11],s59 offen sc1
s_sub_u32 s49,s49,1
s_cbranch_scc1 L_abort
s_waitcnt vmcnt(0)
v_cmp_eq_u32 vcc,0,v121
s_cbranch_vccnz L_fp_47
L_mg_32:
s_andn2_b32 s62,0x7ff,s54
v_lshl_or_b32 v121,s62,8,v121
s_add_u32 s59,s59,8192
buffer_store_dword v121,v120,s[8:11],s59 offen sc1
s_add_u32 s59,s59,8192
buffer_store_dword v121,v120,s[8:11],s59 offen sc1
s_add_u32 s59,s59,8192
buffer_store_dword v121,v120,s[8:11],s59 offen sc1
s_add_u32 s59,s59,8192
buffer_store_dword v121,v120,s[8:11],s59 offen sc1
s_add_u32 s59,s59,8192
buffer_store_dword v121,v120,s[8:11],s59 offen sc1
s_add_u32 s59,s59,8192
buffer_store_dword v121,v120,s[8:11],s59 offen sc1
L_mo_36:
s_add_u32 s31,s31,1
s_cmp_gt_i32 s77,0
s_cmov_b32 s18,0
s_cbranch_scc1 L_mo_33
s_cmp_lg_u32 s77,0
s_cbranch_scc1 L_mo_37
s_andn2_b32 s51,0x7ff,s54
s_lshr_b32 s51,s51,5
s_add_u32 s73,s73,2
s_mov_b32 s86,1
s_mov_b32 s19,0
s_mov_b32 s18,0
s_waitcnt vmcnt(8)
s_barrier
s_andn2_b32 s64,0x7ff,s54
s_lshl_b32 s56,s64,10
s_add_u32 s58,s56,4194304
buffer_load_dwordx4 v[88:91],v0,s[8:11],s58 offen sc1
v_and_b32 v9,15,v1
v_lshrrev_b32 v10,4,v1
v_and_b32 v124,1,v1
v_lshlrev_b32 v124,4,v124
v_mov_b32 v125,0xffff
v_lshlrev_b32 v125,v124,v125
v_lshrrev_b32 v124,2,v9
v_cmp_eq_u32 vcc,0,v124
s_nop 1
v_cndmask_b32 v12,0,v125,vcc
v_cmp_eq_u32 vcc,1,v124
s_nop 1
v_cndmask_b32 v13,0,v125,vcc
v_and_b32 v124,2,v1
v_cmp_eq_u32 vcc,0,v124
v_mov_b32 v14,0xeeee
v_mov_b32 v124,0x4444
v_cndmask_b32 v14,v14,v124,vcc
v_lshlrev_b32 v11,14,v10
v_lshl_add_u32 v11,v9,4,v11
s_lshl_b32 s65,s51,15
s_add_u32 s65,s65,92274688
s_lshl_b32 s62,s47,10
s_add_u32 s62,s62,s65
s_lshl_b32 s63,s47,16
s_lshl_b32 s60,s46,8
s_add_u32 s63,s63,s60
s_mov_b32 s4,s38
s_mov_b32 s5,s39
s_mov_b32 s6,1835008
s_mov_b32 s7,0x20000
s_lshl_b32 s57,s46,11
s_add_u32 s57,s57,139264
v_add_u32 v8,s57,v0
v_and_b32 v2,1,v10
v_lshrrev_b32 v3,1,v10
v_lshlrev_b32 v2,7,v2
v_lshl_add_u32 v2,v3,10,v2
s_lshl_b32 s59,s46,8
s_add_u32 s59,s57,s59
v_add_u32 v2,s59,v2
s_mov_b32 s60,0x01000100
s_mov_b32 s61,0x03020302
s_waitcnt vmcnt(0)
L_mx_48:
v_max3_u32 v124,v88,v89,v90
v_max_u32 v124,v91,v124
v_cmp_eq_u32 vcc,-1,v124
s_cbranch_vccz L_mxd_49
buffer_load_dwordx4 v[88:91],v0,s[8:11],s58 offen sc1
s_sub_u32 s49,s49,1
s_cbranch_scc1 L_abort
s_waitcnt vmcnt(0)
s_branch L_mx_48
L_mxd_49:
buffer_load_dwordx4 v[24:27],v11,s[4:7],s63 offen offset:0
buffer_load_dwordx4 v[28:31],v11,s[4:7],s63 offen offset:1024
buffer_load_dwordx4 v[32:35],v11,s[4:7],s63 offen offset:2048
buffer_load_dwordx4 v[36:39],v11,s[4:7],s63 offen offset:3072
v_lshlrev_b32 v96,16,v88
v_and_b32 v97,0xffff0000,v88
v_lshlrev_b32 v98,16,v89
v_and_b32 v99,0xffff0000,v89
v_lshlrev_b32 v100,16,v90
v_and_b32 v101,0xffff0000,v90
v_lshlrev_b32 v102,16,v91
v_and_b32 v103,0xffff0000,v91
v_readfirstlane_b32 s78,v96
s_nop 1
v_pk_add_f32 v[108:109],v[96:97],s[78:79] op_sel_hi:[1,0] neg_lo:[0,1] neg_hi:[0,1]
v_pk_add_f32 v[110:111],v[98:99],s[78:79] op_sel_hi:[1,0] neg_lo:[0,1] neg_hi:[0,1]
v_pk_add_f32 v[112:113],v[100:101],s[78:79] op_sel_hi:[1,0] neg_lo:[0,1] neg_hi:[0,1]
v_pk_add_f32 v[114:115],v[102:103],s[78:79] op_sel_hi:[1,0] neg_lo:[0,1] neg_hi:[0,1]
v_pk_add_f32 v[116:117],v[108:109],v[110:111]
v_pk_mul_f32 v[118:119],v[108:109],v[108:109]
v_pk_add_f32 v[120:121],v[112:113],v[114:115]
v_pk_fma_f32 v[118:119],v[110:111],v[110:111],v[118:119]
v_pk_add_f32 v[116:117],v[116:117],v[120:121]
v_pk_fma_f32 v[118:119],v[112:113],v[112:113],v[118:119]
v_add_f32 v116,v116,v117
v_pk_fma_f32 v[118:119],v[114:115],v[114:115],v[118:119]
v_add_f32 v118,v118,v119
s_nop 1
v_permlane32_swap_b32 v116,v118
v_add_f32 v116,v116,v118
s_nop 1
v_add_f32_dpp v116,v116,v116 row_ror:8 row_mask:0xf bank_mask:0xf
s_nop 1
v_add_f32_dpp v116,v116,v116 row_ror:4 row_mask:0xf bank_mask:0xf
s_nop 1
v_add_f32_dpp v116,v116,v116 row_ror:2 row_mask:0xf bank_mask:0xf
s_nop 1
v_add_f32_dpp v116,v116,v116 row_ror:1 row_mask:0xf bank_mask:0xf
v_mov_b32 v118,v116
s_nop 1
v_permlane16_swap_b32 v116,v118
v_add_f32 v116,v116,v118
v_mul_f32 v116,0x3b000000,v116
v_mov_b32 v118,v116
s_nop 1
v_permlane32_swap_b32 v116,v118
v_fma_f32 v118,-v116,v116,v118
v_add_f32 v116,s78,v116
v_max_f32 v118,0,v118
v_cvt_pk_bf16_f32 v118,v116,v118
v_lshlrev_b32 v116,16,v118
v_and_b32 v118,0xffff0000,v118
v_add_f32 v118,0x3727c5ac,v118
v_cvt_pk_bf16_f32 v118,v118,v118
v_and_b32 v118,0xffff0000,v118
v_sqrt_f32 v118,v118
v_pk_add_f32 v[108:109],v[96:97],v[116:117] op_sel_hi:[1,0] neg_lo:[0,1] neg_hi:[0,1]
v_pk_add_f32 v[110:111],v[98:99],v[116:117] op_sel_hi:[1,0] neg_lo:[0,1] neg_hi:[0,1]
v_pk_add_f32 v[112:113],v[100:101],v[116:117] op_sel_hi:[1,0] neg_lo:[0,1] neg_hi:[0,1]
v_pk_add_f32 v[114:115],v[102:103],v[116:117] op_sel_hi:[1,0] neg_lo:[0,1] neg_hi:[0,1]
v_cvt_pk_bf16_f32 v118,v118,v118
v_and_b32 v118,0xffff0000,v118
v_rcp_f32 v118,v118
v_cvt_pk_bf16_f32 v104,v108,v109
v_cvt_pk_bf16_f32 v105,v110,v111
v_cvt_pk_bf16_f32 v106,v112,v113
v_cvt_pk_bf16_f32 v107,v114,v115
v_lshlrev_b32 v108,16,v104
v_and_b32 v109,0xffff0000,v104
v_lshlrev_b32 v110,16,v105
v_and_b32 v111,0xffff0000,v105
v_lshlrev_b32 v112,16,v106
v_and_b32 v113,0xffff0000,v106
v_lshlrev_b32 v114,16,v107
v_and_b32 v115,0xffff0000,v107
v_pk_mul_f32 v[108:109],v[108:109],v[118:119] op_sel_hi:[1,0]
v_pk_mul_f32 v[110:111],v[110:111],v[118:119] op_sel_hi:[1,0]
v_pk_mul_f32 v[112:113],v[112:113],v[118:119] op_sel_hi:[1,0]
v_pk_mul_f32 v[114:115],v[114:115],v[118:119] op_sel_hi:[1,0]
v_cvt_pk_bf16_f32 v104,v108,v109
v_cvt_pk_bf16_f32 v105,v110,v111
v_cvt_pk_bf16_f32 v106,v112,v113
v_cvt_pk_bf16_f32 v107,v114,v115
v_perm_b32 v88,v104,v104,s60
v_perm_b32 v89,v105,v105,s60
v_perm_b32 v90,v106,v106,s60
v_perm_b32 v91,v107,v107,s60
ds_write_b128 v8,v[88:91]
v_perm_b32 v92,v104,v104,s61
v_perm_b32 v93,v105,v105,s61
v_perm_b32 v94,v106,v106,s61
v_perm_b32 v95,v107,v107,s61
ds_write_b128 v8,v[92:95] offset:1024
s_mov_b32 s58,s57
ds_read_b128 v[88:91],v2 offset:0
ds_read_b128 v[92:95],v2 offset:64
ds_read_b128 v[108:111],v18 offset:0
ds_read_b128 v[112:115],v18 offset:1024
ds_read_b128 v[64:67],v18 offset:2048
ds_read_b128 v[68:71],v18 offset:3072
ds_read_b128 v[72:75],v18 offset:4096
ds_read_b128 v[76:79],v18 offset:5120
ds_read_b128 v[80:83],v18 offset:6144
ds_read_b128 v[84:87],v18 offset:7168
v_mov_b64 v[116:117],0
v_mov_b64 v[118:119],0
s_waitcnt lgkmcnt(8)
v_and_b32 v120,v12,v88
v_and_b32 v121,v13,v88
v_and_b32 v122,v12,v92
v_and_b32 v123,v13,v92
s_waitcnt lgkmcnt(6)
s_nop 0
v_smfmac_f32_16x16x64_bf16 v[116:119],v[120:123],v[108:115],v14
ds_read_b128 v[108:111],v18 offset:8192
ds_read_b128 v[112:115],v18 offset:9216
s_add_u32 s63,s63,4096
buffer_load_dwordx4 v[40:43],v11,s[4:7],s63 offen offset:0
v_and_b32 v124,v12,v89
v_and_b32 v125,v13,v89
v_and_b32 v126,v12,v93
v_and_b32 v127,v13,v93
s_waitcnt lgkmcnt(6)
s_nop 0
v_smfmac_f32_16x16x64_bf16 v[116:119],v[124:127],v[64:71],v14
ds_read_b128 v[64:67],v18 offset:10240
ds_read_b128 v[68:71],v18 offset:11264
buffer_load_dwordx4 v[44:47],v11,s[4:7],s63 offen offset:1024
v_and_b32 v120,v12,v90
v_and_b32 v121,v13,v90
v_and_b32 v122,v12,v94
v_and_b32 v123,v13,v94
s_waitcnt lgkmcnt(6)
s_nop 0
v_smfmac_f32_16x16x64_bf16 v[116:119],v[120:123],v[72:79],v14
ds_read_b128 v[72:75],v18 offset:12288
ds_read_b128 v[76:79],v18 offset:13312
buffer_load_dwordx4 v[48:51],v11,s[4:7],s63 offen offset:2048
v_and_b32 v124,v12,v91
v_and_b32 v125,v13,v91
v_and_b32 v126,v12,v95
v_and_b32 v127,v13,v95
ds_read_b128 v[88:91],v2 offset:16
ds_read_b128 v[92:95],v2 offset:80
s_waitcnt lgkmcnt(8)
v_smfmac_f32_16x16x64_bf16 v[116:119],v[124:127],v[80:87],v14
ds_read_b128 v[80:83],v18 offset:14336
ds_read_b128 v[84:87],v18 offset:15360
buffer_load_dwordx4 v[52:55],v11,s[4:7],s63 offen offset:3072
s_waitcnt lgkmcnt(2)
v_and_b32 v120,v12,v88
v_and_b32 v121,v13,v88
v_and_b32 v122,v12,v92
v_and_b32 v123,v13,v92
s_waitcnt lgkmcnt(8)
s_nop 0
v_smfmac_f32_16x16x64_bf16 v[116:119],v[120:123],v[108:115],v14
ds_read_b128 v[108:111],v18 offset:16384
ds_read_b128 v[112:115],v18 offset:17408
s_add_u32 s63,s63,4096
buffer_load_dwordx4 v[56:59],v11,s[4:7],s63 offen offset:0
v_and_b32 v124,v12,v89
v_and_b32 v125,v13,v89
v_and_b32 v126,v12,v93
v_and_b32 v127,v13,v93
s_waitcnt lgkmcnt(8)
s_nop 0
v_smfmac_f32_16x16x64_bf16 v[116:119],v[124:127],v[64:71],v14
ds_read_b128 v[64:67],v18 offset:18432
ds_read_b128 v[68:71],v18 offset:19456
buffer_load_dwordx4 v[60:63],v11,s[4:7],s63 offen offset:1024
v_and_b32 v120,v12,v90
v_and_b32 v121,v13,v90
v_and_b32 v122,v12,v94
v_and_b32 v123,v13,v94
s_waitcnt lgkmcnt(8)
s_nop 0
v_smfmac_f32_16x16x64_bf16 v[116:119],v[120:123],v[72:79],v14
ds_read_b128 v[72:75],v18 offset:20480
ds_read_b128 v[76:79],v18 offset:21504
buffer_load_dword v15,v0,s[8:11],s62 offen
v_and_b32 v124,v12,v91
v_and_b32 v125,v13,v91
v_and_b32 v126,v12,v95
v_and_b32 v127,v13,v95
ds_read_b128 v[88:91],v2 offset:32
ds_read_b128 v[92:95],v2 offset:96
s_waitcnt lgkmcnt(8)
v_smfmac_f32_16x16x64_bf16 v[116:119],v[124:127],v[80:87],v14
ds_read_b128 v[80:83],v18 offset:22528
ds_read_b128 v[84:87],v18 offset:23552
s_waitcnt lgkmcnt(2)
v_and_b32 v120,v12,v88
v_and_b32 v121,v13,v88
v_and_b32 v122,v12,v92
v_and_b32 v123,v13,v92
s_waitcnt lgkmcnt(8)
s_nop 0
v_smfmac_f32_16x16x64_bf16 v[116:119],v[120:123],v[108:115],v14
ds_read_b128 v[108:111],v18 offset:24576
ds_read_b128 v[112:115],v18 offset:25600
v_and_b32 v124,v12,v89
v_and_b32 v125,v13,v89
v_and_b32 v126,v12,v93
v_and_b32 v127,v13,v93
s_waitcnt lgkmcnt(8)
s_nop 0
v_smfmac_f32_16x16x64_bf16 v[116:119],v[124:127],v[64:71],v14
ds_read_b128 v[64:67],v18 offset:26624
ds_read_b128 v[68:71],v18 offset:27648
v_and_b32 v120,v12,v90
v_and_b32 v121,v13,v90
v_and_b32 v122,v12,v94
v_and_b32 v123,v13,v94
s_waitcnt lgkmcnt(8)
s_nop 0
v_smfmac_f32_16x16x64_bf16 v[116:119],v[120:123],v[72:79],v14
ds_read_b128 v[72:75],v18 offset:28672
ds_read_b128 v[76:79],v18 offset:29696
v_and_b32 v124,v12,v91
v_and_b32 v125,v13,v91
v_and_b32 v126,v12,v95
v_and_b32 v127,v13,v95
ds_read_b128 v[88:91],v2 offset:48
ds_read_b128 v[92:95],v2 offset:112
s_waitcnt lgkmcnt(8)
v_smfmac_f32_16x16x64_bf16 v[116:119],v[124:127],v[80:87],v14
ds_read_b128 v[80:83],v18 offset:30720
ds_read_b128 v[84:87],v18 offset:31744
s_waitcnt lgkmcnt(2)
v_and_b32 v120,v12,v88
v_and_b32 v121,v13,v88
v_and_b32 v122,v12,v92
v_and_b32 v123,v13,v92
s_waitcnt lgkmcnt(8)
s_nop 0
v_smfmac_f32_16x16x64_bf16 v[116:119],v[120:123],v[108:115],v14
v_and_b32 v124,v12,v89
v_and_b32 v125,v13,v89
v_and_b32 v126,v12,v93
v_and_b32 v127,v13,v93
s_waitcnt lgkmcnt(6)
s_nop 0
v_smfmac_f32_16x16x64_bf16 v[116:119],v[124:127],v[64:71],v14
buffer_load_dwordx4 v[64:67],v11,s[4:7],s63 offen offset:2048
buffer_load_dwordx4 v[68:71],v11,s[4:7],s63 offen offset:3072
v_and_b32 v120,v12,v90
v_and_b32 v121,v13,v90
v_and_b32 v122,v12,v94
v_and_b32 v123,v13,v94
s_waitcnt lgkmcnt(4)
s_nop 0
v_smfmac_f32_16x16x64_bf16 v[116:119],v[120:123],v[72:79],v14
s_add_u32 s63,s63,4096
buffer_load_dwordx4 v[72:75],v11,s[4:7],s63 offen offset:0
buffer_load_dwordx4 v[76:79],v11,s[4:7],s63 offen offset:1024
v_and_b32 v124,v12,v91
v_and_b32 v125,v13,v91
v_and_b32 v126,v12,v95
v_and_b32 v127,v13,v95
s_waitcnt lgkmcnt(0)
s_nop 0
v_smfmac_f32_16x16x64_bf16 v[116:119],v[124:127],v[80:87],v14
buffer_load_dwordx4 v[80:83],v11,s[4:7],s63 offen offset:2048
buffer_load_dwordx4 v[84:87],v11,s[4:7],s63 offen offset:3072
v_lshlrev_b32 v8,5,v9
v_and_b32 v124,1,v10
v_lshl_add_u32 v8,v124,4,v8
v_lshrrev_b32 v124,1,v10
v_lshl_add_u32 v8,v124,11,v8
s_lshl_b32 s60,s46,9
s_add_u32 s60,s60,147456
v_add_u32 v8,s60,v8
ds_write_b128 v8,v[116:119]
v_lshlrev_b32 v8,2,v1
v_add_u32 v8,147456,v8
v_and_b32 v2,1,v1
v_lshrrev_b32 v3,1,v1
v_lshlrev_b32 v3,2,v3
v_lshl_add_u32 v2,v2,7,v3
v_add_u32 v2,s58,v2
v_lshlrev_b32 v3,6,v10
v_add_u32 v3,s58,v3
s_waitcnt lgkmcnt(0)
s_barrier
ds_read2st64_b32 v[88:89],v8 offset0:0 offset1:1
ds_read2st64_b32 v[90:91],v8 offset0:2 offset1:3
ds_read2st64_b32 v[92:93],v8 offset0:4 offset1:5
ds_read2st64_b32 v[94:95],v8 offset0:6 offset1:7
s_waitcnt lgkmcnt(0)
v_pk_add_f32 v[88:89],v[88:89],v[90:91]
v_pk_add_f32 v[92:93],v[92:93],v[94:95]
v_pk_add_f32 v[88:89],v[88:89],v[92:93]
v_cvt_pk_bf16_f32 v88,v88,v88
v_and_b32 v88,0xffff0000,v88
v_cvt_pk_bf16_f32 v89,v89,v89
v_and_b32 v89,0xffff0000,v89
v_mul_f32 v90,0xbfb8aa3b,v88
v_exp_f32 v90,v90
s_nop 0
v_add_f32 v90,1.0,v90
v_rcp_f32 v90,v90
s_nop 0
v_mul_f32 v88,v88,v90
v_cvt_pk_bf16_f32 v88,v88,v88
v_and_b32 v88,0xffff0000,v88
v_mul_f32 v88,v88,v89
v_cvt_pk_bf16_f32 v88,v88,v88
ds_write_b32 v2,v88
ds_read_b128 v[88:91],v3
ds_read_b128 v[108:111],v3 offset:32
ds_read_b128 v[92:95],v3 offset:16
ds_read_b128 v[112:115],v3 offset:48
v_mov_b64 v[116:117],0
v_mov_b64 v[118:119],0
s_waitcnt vmcnt(0) lgkmcnt(0)
v_and_b32 v120,v12,v88
v_and_b32 v121,v13,v88
v_and_b32 v122,v12,v108
v_and_b32 v123,v13,v108
v_and_b32 v124,v12,v89
v_and_b32 v125,v13,v89
v_smfmac_f32_16x16x64_bf16 v[116:119],v[120:123],v[24:31],v14
v_and_b32 v126,v12,v109
v_and_b32 v127,v13,v109
v_and_b32 v120,v12,v90
v_and_b32 v121,v13,v90
v_smfmac_f32_16x16x64_bf16 v[116:119],v[124:127],v[32:39],v14
v_and_b32 v122,v12,v110
v_and_b32 v123,v13,v110
v_and_b32 v124,v12,v91
v_and_b32 v125,v13,v91
v_smfmac_f32_16x16x64_bf16 v[116:119],v[120:123],v[40:47],v14
v_and_b32 v126,v12,v111
v_and_b32 v127,v13,v111
v_and_b32 v120,v12,v92
v_and_b32 v121,v13,v92
v_smfmac_f32_16x16x64_bf16 v[116:119],v[124:127],v[48:55],v14
v_and_b32 v122,v12,v112
v_and_b32 v123,v13,v112
v_and_b32 v124,v12,v93
v_and_b32 v125,v13,v93
v_smfmac_f32_16x16x64_bf16 v[116:119],v[120:123],v[56:63],v14
v_and_b32 v126,v12,v113
v_and_b32 v127,v13,v113
v_and_b32 v120,v12,v94
v_and_b32 v121,v13,v94
v_smfmac_f32_16x16x64_bf16 v[116:119],v[124:127],v[64:71],v14
v_and_b32 v122,v12,v114
v_and_b32 v123,v13,v114
v_and_b32 v124,v12,v95
v_and_b32 v125,v13,v95
v_smfmac_f32_16x16x64_bf16 v[116:119],v[120:123],v[72:79],v14
v_and_b32 v126,v12,v115
v_and_b32 v127,v13,v115
s_nop 1
v_smfmac_f32_16x16x64_bf16 v[116:119],v[124:127],v[80:87],v14
v_lshlrev_b32 v8,4,v9
v_and_b32 v124,1,v10
v_lshl_add_u32 v8,v124,3,v8
v_and_b32 v124,2,v10
v_lshl_add_u32 v8,v124,30,v8
s_lshl_b32 s60,s46,8
s_add_u32 s59,s62,s60
s_nop 0
v_cvt_pk_bf16_f32 v88,v116,v117
v_cvt_pk_bf16_f32 v89,v118,v119
buffer_store_dwordx2 v[88:89],v8,s[8:11],s59 offen
s_lshl_b32 s59,s51,13
s_lshl2_add_u32 s59,s47,s59
s_add_u32 s59,s59,10486912
s_waitcnt vmcnt(0)
s_barrier
s_or_b32 s59,s59,s52
buffer_store_dword v17,off,s[8:11],s59
s_lshl_b32 s59,s51,13
s_add_u32 s59,s59,10486912
v_and_b32 v124,31,v1
v_lshlrev_b32 v124,2,v124
L_fw_51:
buffer_load_dword v125,v124,s[8:11],s59 offen sc1
s_sub_u32 s49,s49,1
s_cbranch_scc1 L_abort
s_waitcnt vmcnt(0)
v_cmp_eq_u32 vcc,0,v125
s_cbranch_vccnz L_fw_51
s_add_u32 s63,s65,0
buffer_load_dwordx4 v[24:27],v22,s[8:11],s63 offen sc1
s_add_u32 s63,s65,4096
buffer_load_dwordx4 v[28:31],v22,s[8:11],s63 offen sc1
s_add_u32 s63,s65,8192
buffer_load_dwordx4 v[32:35],v22,s[8:11],s63 offen sc1
s_add_u32 s63,s65,12288
buffer_load_dwordx4 v[36:39],v22,s[8:11],s63 offen sc1
s_add_u32 s63,s65,16384
buffer_load_dwordx4 v[40:43],v22,s[8:11],s63 offen sc1
s_add_u32 s63,s65,20480
buffer_load_dwordx4 v[44:47],v22,s[8:11],s63 offen sc1
s_add_u32 s63,s65,24576
buffer_load_dwordx4 v[48:51],v22,s[8:11],s63 offen sc1
s_add_u32 s63,s65,28672
buffer_load_dwordx4 v[52:55],v22,s[8:11],s63 offen sc1
v_and_b32 v64,15,v1
v_and_b32 v65,1,v1
v_lshlrev_b32 v65,4,v65
v_mov_b32 v66,0x3f80
v_lshlrev_b32 v66,v65,v66
v_lshrrev_b32 v64,1,v64
v_cmp_eq_u32 vcc,0,v64
s_nop 1
v_cndmask_b32 v56,0,v66,vcc
v_cmp_eq_u32 vcc,1,v64
s_nop 1
v_cndmask_b32 v57,0,v66,vcc
v_cmp_eq_u32 vcc,2,v64
s_nop 1
v_cndmask_b32 v58,0,v66,vcc
v_cmp_eq_u32 vcc,3,v64
s_nop 1
v_cndmask_b32 v59,0,v66,vcc
s_waitcnt vmcnt(7)
s_nop 0
v_mfma_f32_16x16x32_bf16 v[60:63],v[56:59],v[24:27],0
s_waitcnt vmcnt(6)
v_mfma_f32_16x16x32_bf16 v[60:63],v[56:59],v[28:31],v[60:63]
s_waitcnt vmcnt(5)
v_mfma_f32_16x16x32_bf16 v[60:63],v[56:59],v[32:35],v[60:63]
s_waitcnt vmcnt(4)
v_mfma_f32_16x16x32_bf16 v[60:63],v[56:59],v[36:39],v[60:63]
s_waitcnt vmcnt(3)
v_mfma_f32_16x16x32_bf16 v[60:63],v[56:59],v[40:43],v[60:63]
s_waitcnt vmcnt(2)
v_mfma_f32_16x16x32_bf16 v[60:63],v[56:59],v[44:47],v[60:63]
s_waitcnt vmcnt(1)
v_mfma_f32_16x16x32_bf16 v[60:63],v[56:59],v[48:51],v[60:63]
s_waitcnt vmcnt(0)
v_mfma_f32_16x16x32_bf16 v[60:63],v[56:59],v[52:55],v[60:63]
s_nop 7
ds_write_b128 v21,v[60:63]
s_waitcnt lgkmcnt(0)
s_barrier
s_cmp_lg_u32 s46,0
s_cbranch_scc1 L_moed_50
v_lshlrev_b32 v56,5,v1
v_add_u32 v56,155648,v56
ds_read_b128 v[24:27],v56
ds_read_b128 v[28:31],v56 offset:16
s_and_b32 s59,s54,0xffff0000
s_xor_b32 s60,s59,0x80000000
s_xor_b32 s61,s59,0xffff0000
s_cmp_lt_i32 s59,0
s_cselect_b32 s59,s60,s61
v_mov_b32 v56,s59
v_mul_f32 v56,0xbfb8aa3b,v56
v_exp_f32 v56,v56
s_nop 0
v_add_f32 v56,1.0,v56
v_rcp_f32 v56,v56
s_nop 0
v_cvt_pk_bf16_f32 v56,v56,v56
v_and_b32 v56,0xffff0000,v56
v_lshlrev_b32 v48,16,v104
v_and_b32 v49,0xffff0000,v104
v_lshlrev_b32 v50,16,v105
v_and_b32 v51,0xffff0000,v105
v_lshlrev_b32 v52,16,v106
v_and_b32 v53,0xffff0000,v106
v_lshlrev_b32 v54,16,v107
v_and_b32 v55,0xffff0000,v107
s_waitcnt lgkmcnt(0)
v_cvt_pk_bf16_f32 v40,v24,v25
v_cvt_pk_bf16_f32 v41,v26,v27
v_cvt_pk_bf16_f32 v42,v28,v29
v_cvt_pk_bf16_f32 v43,v30,v31
v_lshlrev_b32 v24,16,v40
v_and_b32 v25,0xffff0000,v40
v_lshlrev_b32 v26,16,v41
v_and_b32 v27,0xffff0000,v41
v_lshlrev_b32 v28,16,v42
v_and_b32 v29,0xffff0000,v42
v_lshlrev_b32 v30,16,v43
v_and_b32 v31,0xffff0000,v43
v_pk_mul_f32 v[24:25],v[24:25],v[56:57] op_sel_hi:[1,0]
v_pk_mul_f32 v[26:27],v[26:27],v[56:57] op_sel_hi:[1,0]
v_pk_mul_f32 v[28:29],v[28:29],v[56:57] op_sel_hi:[1,0]
v_pk_mul_f32 v[30:31],v[30:31],v[56:57] op_sel_hi:[1,0]
v_cvt_pk_bf16_f32 v40,v24,v25
v_cvt_pk_bf16_f32 v41,v26,v27
v_cvt_pk_bf16_f32 v42,v28,v29
v_cvt_pk_bf16_f32 v43,v30,v31
v_lshlrev_b32 v24,16,v40
v_and_b32 v25,0xffff0000,v40
v_lshlrev_b32 v26,16,v41
v_and_b32 v27,0xffff0000,v41
v_lshlrev_b32 v28,16,v42
v_and_b32 v29,0xffff0000,v42
v_lshlrev_b32 v30,16,v43
v_and_b32 v31,0xffff0000,v43
v_pk_add_f32 v[24:25],v[24:25],v[48:49]
v_pk_add_f32 v[26:27],v[26:27],v[50:51]
v_pk_add_f32 v[28:29],v[28:29],v[52:53]
v_pk_add_f32 v[30:31],v[30:31],v[54:55]
v_cvt_pk_bf16_f32 v40,v24,v25
v_cvt_pk_bf16_f32 v41,v26,v27
v_cvt_pk_bf16_f32 v42,v28,v29
v_cvt_pk_bf16_f32 v43,v30,v31
v_lshlrev_b32 v24,16,v40
v_and_b32 v25,0xffff0000,v40
v_lshlrev_b32 v26,16,v41
v_and_b32 v27,0xffff0000,v41
v_lshlrev_b32 v28,16,v42
v_and_b32 v29,0xffff0000,v42
v_lshlrev_b32 v30,16,v43
v_and_b32 v31,0xffff0000,v43
v_pk_add_f32 v[96:97],v[96:97],v[24:25]
v_pk_add_f32 v[98:99],v[98:99],v[26:27]
v_pk_add_f32 v[100:101],v[100:101],v[28:29]
v_pk_add_f32 v[102:103],v[102:103],v[30:31]
v_cvt_pk_bf16_f32 v80,v96,v97
v_cvt_pk_bf16_f32 v81,v98,v99
v_cvt_pk_bf16_f32 v82,v100,v101
v_cvt_pk_bf16_f32 v83,v102,v103
v_lshlrev_b32 v96,16,v80
v_and_b32 v97,0xffff0000,v80
v_lshlrev_b32 v98,16,v81
v_and_b32 v99,0xffff0000,v81
v_lshlrev_b32 v100,16,v82
v_and_b32 v101,0xffff0000,v82
v_lshlrev_b32 v102,16,v83
v_and_b32 v103,0xffff0000,v83
v_readfirstlane_b32 s78,v96
s_nop 1
v_pk_add_f32 v[58:59],v[96:97],s[78:79] op_sel_hi:[1,0] neg_lo:[0,1] neg_hi:[0,1]
v_pk_add_f32 v[60:61],v[98:99],s[78:79] op_sel_hi:[1,0] neg_lo:[0,1] neg_hi:[0,1]
v_pk_add_f32 v[62:63],v[100:101],s[78:79] op_sel_hi:[1,0] neg_lo:[0,1] neg_hi:[0,1]
v_pk_add_f32 v[64:65],v[102:103],s[78:79] op_sel_hi:[1,0] neg_lo:[0,1] neg_hi:[0,1]
v_pk_add_f32 v[66:67],v[58:59],v[60:61]
v_pk_mul_f32 v[68:69],v[58:59],v[58:59]
v_pk_add_f32 v[70:71],v[62:63],v[64:65]
v_pk_fma_f32 v[68:69],v[60:61],v[60:61],v[68:69]
v_pk_add_f32 v[66:67],v[66:67],v[70:71]
v_pk_fma_f32 v[68:69],v[62:63],v[62:63],v[68:69]
v_add_f32 v66,v66,v67
v_pk_fma_f32 v[68:69],v[64:65],v[64:65],v[68:69]
v_add_f32 v68,v68,v69
s_nop 1
v_permlane32_swap_b32 v66,v68
v_add_f32 v66,v66,v68
s_nop 1
v_add_f32_dpp v66,v66,v66 row_ror:8 row_mask:0xf bank_mask:0xf
s_nop 1
v_add_f32_dpp v66,v66,v66 row_ror:4 row_mask:0xf bank_mask:0xf
s_nop 1
v_add_f32_dpp v66,v66,v66 row_ror:2 row_mask:0xf bank_mask:0xf
s_nop 1
v_add_f32_dpp v66,v66,v66 row_ror:1 row_mask:0xf bank_mask:0xf
v_mov_b32 v68,v66
s_nop 1
v_permlane16_swap_b32 v66,v68
v_add_f32 v66,v66,v68
v_mul_f32 v66,0x3b000000,v66
v_mov_b32 v68,v66
s_nop 1
v_permlane32_swap_b32 v66,v68
v_fma_f32 v68,-v66,v66,v68
v_add_f32 v66,s78,v66
v_max_f32 v68,0,v68
v_cvt_pk_bf16_f32 v68,v66,v68
v_lshlrev_b32 v66,16,v68
v_and_b32 v68,0xffff0000,v68
v_add_f32 v68,0x3727c5ac,v68
v_cvt_pk_bf16_f32 v68,v68,v68
v_and_b32 v68,0xffff0000,v68
v_sqrt_f32 v68,v68
v_pk_add_f32 v[58:59],v[96:97],v[66:67] op_sel_hi:[1,0] neg_lo:[0,1] neg_hi:[0,1]
v_pk_add_f32 v[60:61],v[98:99],v[66:67] op_sel_hi:[1,0] neg_lo:[0,1] neg_hi:[0,1]
v_pk_add_f32 v[62:63],v[100:101],v[66:67] op_sel_hi:[1,0] neg_lo:[0,1] neg_hi:[0,1]
v_pk_add_f32 v[64:65],v[102:103],v[66:67] op_sel_hi:[1,0] neg_lo:[0,1] neg_hi:[0,1]
v_cvt_pk_bf16_f32 v68,v68,v68
v_and_b32 v68,0xffff0000,v68
v_rcp_f32 v68,v68
v_cvt_pk_bf16_f32 v84,v58,v59
v_cvt_pk_bf16_f32 v85,v60,v61
v_cvt_pk_bf16_f32 v86,v62,v63
v_cvt_pk_bf16_f32 v87,v64,v65
v_lshlrev_b32 v58,16,v84
v_and_b32 v59,0xffff0000,v84
v_lshlrev_b32 v60,16,v85
v_and_b32 v61,0xffff0000,v85
v_lshlrev_b32 v62,16,v86
v_and_b32 v63,0xffff0000,v86
v_lshlrev_b32 v64,16,v87
v_and_b32 v65,0xffff0000,v87
v_pk_mul_f32 v[58:59],v[58:59],v[68:69] op_sel_hi:[1,0]
v_pk_mul_f32 v[60:61],v[60:61],v[68:69] op_sel_hi:[1,0]
v_pk_mul_f32 v[62:63],v[62:63],v[68:69] op_sel_hi:[1,0]
v_pk_mul_f32 v[64:65],v[64:65],v[68:69] op_sel_hi:[1,0]
v_cvt_pk_bf16_f32 v84,v58,v59
v_cvt_pk_bf16_f32 v85,v60,v61
v_cvt_pk_bf16_f32 v86,v62,v63
v_cvt_pk_bf16_f32 v87,v64,v65
s_lshl_b32 s58,s51,10
s_add_u32 s58,s58,11272192
s_add_u32 s59,s58,65536
s_cmp_eq_u32 s47,0
s_cselect_b32 s59,s59,0x80000000
s_add_u32 s57,s56,98566144
buffer_store_dwordx4 v[84:87],v0,s[8:11],s59 offen sc1
buffer_store_dwordx4 v[80:83],v0,s[8:11],s58 offen sc1
buffer_store_dwordx4 v[84:87],v0,s[8:11],s57 offen sc1
L_moed_50:
s_barrier
L_mo_37:
s_mov_b32 s77,-1
s_cmp_lt_u32 s31,64
s_cbranch_scc1 L_mo_33
s_cmp_eq_u32 s86,0
s_cbranch_scc1 L_mo_46
L_mo_39:
s_andn2_b32 s51,0x7ff,s54
s_lshr_b32 s51,s51,5
s_andn2_b32 s56,31,s54
v_lshrrev_b32 v2,10,v20
v_add_u32 v3,16,v2
v_add_u32 v8,96468992,v20
v_cmp_eq_u32 vcc,s56,v2
s_nop 1
v_cndmask_b32 v2,v20,v8,vcc
v_cmp_eq_u32 vcc,s56,v3
s_nop 1
v_cndmask_b32 v3,v20,v8,vcc
s_waitcnt vmcnt(0)
s_lshl_b32 s59,s51,13
s_add_u32 s59,s59,10487552
s_cmp_lg_u32 s46,0
s_cbranch_scc1 L_fd_55
v_and_b32 v124,31,v1
v_lshlrev_b32 v124,2,v124
s_branch L_ff_56
L_fw_54:
s_sleep 2
L_ff_56:
buffer_load_dword v125,v124,s[8:11],s59 offen sc1
s_sub_u32 s49,s49,1
s_cbranch_scc1 L_abort
s_waitcnt vmcnt(0)
v_cmp_eq_u32 vcc,0,v125
s_cbranch_vccnz L_fw_54
L_fd_55:
s_barrier
s_or_b32 s72,s72,s52
buffer_store_dword v17,off,s[8:11],s72 sc1
s_lshl_b32 s66,s51,15
s_add_u32 s66,s66,2097152
s_add_u32 s67,s66,16384
s_add_u32 m0,s50,131072
s_nop 0
buffer_load_dwordx4 v2,s[8:11],s66 offen offset:0 sc1 lds
s_add_u32 m0,s50,135168
s_nop 0
buffer_load_dwordx4 v3,s[8:11],s67 offen offset:0 sc1 lds
s_add_u32 m0,s50,139008
s_nop 0
buffer_load_dwordx4 v2,s[8:11],s66 offen offset:256 sc1 lds
s_add_u32 m0,s50,143104
s_nop 0
buffer_load_dwordx4 v3,s[8:11],s67 offen offset:256 sc1 lds
s_add_u32 m0,s50,146944
s_nop 0
buffer_load_dwordx4 v2,s[8:11],s66 offen offset:512 sc1 lds
s_add_u32 m0,s50,151040
s_nop 0
buffer_load_dwordx4 v3,s[8:11],s67 offen offset:512 sc1 lds
s_waitcnt vmcnt(4)
s_barrier
ds_read_b128 v[104:107],v4 offset:0
ds_read_b128 v[108:111],v4 offset:4096
ds_read_b128 v[112:115],v5 offset:0
ds_read_b128 v[116:119],v5 offset:4096
s_add_u32 m0,s50,154880
s_nop 0
buffer_load_dwordx4 v2,s[8:11],s66 offen offset:768 sc1 lds
s_add_u32 m0,s50,158976
s_nop 0
buffer_load_dwordx4 v3,s[8:11],s67 offen offset:768 sc1 lds
s_waitcnt lgkmcnt(2)
v_mfma_f32_16x16x32_bf16 v[24:27],a[128:131],v[104:107],0
ds_read_b128 v[120:123],v6 offset:0
v_mfma_f32_16x16x32_bf16 v[40:43],v[104:107],v[128:131],0
s_lshl_b32 s58,s51,5
v_mfma_f32_16x16x32_bf16 v[28:31],a[128:131],v[108:111],0
ds_read_b128 v[124:127],v6 offset:4096
v_mfma_f32_16x16x32_bf16 v[44:47],v[108:111],v[128:131],0
s_add_u32 s58,s58,s47
v_mfma_f32_16x16x32_bf16 v[32:35],a[136:139],v[104:107],0
s_mul_i32 s58,s58,24576
v_mfma_f32_16x16x32_bf16 v[48:51],v[104:107],v[136:139],0
s_add_u32 s58,s58,201326592
v_mfma_f32_16x16x32_bf16 v[36:39],a[136:139],v[108:111],0
s_add_u32 s61,s58,s50
v_mfma_f32_16x16x32_bf16 v[52:55],v[108:111],v[136:139],0
s_add_u32 s62,s61,4096
s_waitcnt lgkmcnt(2)
v_mfma_f32_16x16x32_bf16 v[24:27],a[132:135],v[112:115],v[24:27]
ds_read_b128 v[104:107],v7 offset:0
v_mfma_f32_16x16x32_bf16 v[40:43],v[112:115],v[132:135],v[40:43]
s_add_u32 s63,s61,16384
v_mfma_f32_16x16x32_bf16 v[28:31],a[132:135],v[116:119],v[28:31]
ds_read_b128 v[108:111],v7 offset:4096
v_mfma_f32_16x16x32_bf16 v[44:47],v[116:119],v[132:135],v[44:47]
s_add_u32 s64,s61,20480
v_mfma_f32_16x16x32_bf16 v[32:35],a[140:143],v[112:115],v[32:35]
s_add_u32 s65,s61,s50
v_mfma_f32_16x16x32_bf16 v[48:51],v[112:115],v[140:143],v[48:51]
s_add_u32 s65,s65,8192
v_mfma_f32_16x16x32_bf16 v[36:39],a[140:143],v[116:119],v[36:39]
v_mfma_f32_16x16x32_bf16 v[52:55],v[116:119],v[140:143],v[52:55]
s_waitcnt vmcnt(4)
s_barrier
s_waitcnt lgkmcnt(2)
v_mfma_f32_16x16x32_bf16 v[24:27],a[144:147],v[120:123],v[24:27]
ds_read_b128 v[112:115],v4 offset:8192
v_mfma_f32_16x16x32_bf16 v[40:43],v[120:123],v[144:147],v[40:43]
v_mfma_f32_16x16x32_bf16 v[28:31],a[144:147],v[124:127],v[28:31]
ds_read_b128 v[116:119],v4 offset:12288
v_mfma_f32_16x16x32_bf16 v[44:47],v[124:127],v[144:147],v[44:47]
v_mfma_f32_16x16x32_bf16 v[32:35],a[152:155],v[120:123],v[32:35]
v_mfma_f32_16x16x32_bf16 v[48:51],v[120:123],v[152:155],v[48:51]
v_mfma_f32_16x16x32_bf16 v[36:39],a[152:155],v[124:127],v[36:39]
v_mfma_f32_16x16x32_bf16 v[52:55],v[124:127],v[152:155],v[52:55]
s_waitcnt lgkmcnt(2)
v_mfma_f32_16x16x32_bf16 v[24:27],a[148:151],v[104:107],v[24:27]
ds_read_b128 v[120:123],v5 offset:8192
v_mfma_f32_16x16x32_bf16 v[40:43],v[104:107],v[148:151],v[40:43]
v_mfma_f32_16x16x32_bf16 v[28:31],a[148:151],v[108:111],v[28:31]
ds_read_b128 v[124:127],v5 offset:12288
v_mfma_f32_16x16x32_bf16 v[44:47],v[108:111],v[148:151],v[44:47]
v_mfma_f32_16x16x32_bf16 v[32:35],a[156:159],v[104:107],v[32:35]
v_mfma_f32_16x16x32_bf16 v[48:51],v[104:107],v[156:159],v[48:51]
v_mfma_f32_16x16x32_bf16 v[36:39],a[156:159],v[108:111],v[36:39]
v_mfma_f32_16x16x32_bf16 v[52:55],v[108:111],v[156:159],v[52:55]
s_waitcnt lgkmcnt(2)
v_mfma_f32_16x16x32_bf16 v[24:27],a[160:163],v[112:115],v[24:27]
ds_read_b128 v[104:107],v6 offset:8192
v_mfma_f32_16x16x32_bf16 v[40:43],v[112:115],v[160:163],v[40:43]
v_mfma_f32_16x16x32_bf16 v[28:31],a[160:163],v[116:119],v[28:31]
ds_read_b128 v[108:111],v6 offset:12288
v_mfma_f32_16x16x32_bf16 v[44:47],v[116:119],v[160:163],v[44:47]
v_mfma_f32_16x16x32_bf16 v[32:35],a[168:171],v[112:115],v[32:35]
v_mfma_f32_16x16x32_bf16 v[48:51],v[112:115],v[168:171],v[48:51]
v_mfma_f32_16x16x32_bf16 v[36:39],a[168:171],v[116:119],v[36:39]
v_mfma_f32_16x16x32_bf16 v[52:55],v[116:119],v[168:171],v[52:55]
s_waitcnt lgkmcnt(2)
v_mfma_f32_16x16x32_bf16 v[24:27],a[164:167],v[120:123],v[24:27]
ds_read_b128 v[112:115],v7 offset:8192
v_mfma_f32_16x16x32_bf16 v[40:43],v[120:123],v[164:167],v[40:43]
v_mfma_f32_16x16x32_bf16 v[28:31],a[164:167],v[124:127],v[28:31]
ds_read_b128 v[116:119],v7 offset:12288
v_mfma_f32_16x16x32_bf16 v[44:47],v[124:127],v[164:167],v[44:47]
v_mfma_f32_16x16x32_bf16 v[32:35],a[172:175],v[120:123],v[32:35]
v_mfma_f32_16x16x32_bf16 v[48:51],v[120:123],v[172:175],v[48:51]
v_mfma_f32_16x16x32_bf16 v[36:39],a[172:175],v[124:127],v[36:39]
v_mfma_f32_16x16x32_bf16 v[52:55],v[124:127],v[172:175],v[52:55]
s_waitcnt vmcnt(2)
s_barrier
s_waitcnt lgkmcnt(2)
v_mfma_f32_16x16x32_bf16 v[24:27],a[176:179],v[104:107],v[24:27]
ds_read_b128 v[120:123],v4 offset:16384
v_mfma_f32_16x16x32_bf16 v[40:43],v[104:107],v[176:179],v[40:43]
v_mfma_f32_16x16x32_bf16 v[28:31],a[176:179],v[108:111],v[28:31]
ds_read_b128 v[124:127],v4 offset:20480
v_mfma_f32_16x16x32_bf16 v[44:47],v[108:111],v[176:179],v[44:47]
v_mfma_f32_16x16x32_bf16 v[32:35],a[184:187],v[104:107],v[32:35]
v_mfma_f32_16x16x32_bf16 v[48:51],v[104:107],v[184:187],v[48:51]
v_mfma_f32_16x16x32_bf16 v[36:39],a[184:187],v[108:111],v[36:39]
v_mfma_f32_16x16x32_bf16 v[52:55],v[108:111],v[184:187],v[52:55]
s_waitcnt lgkmcnt(2)
v_mfma_f32_16x16x32_bf16 v[24:27],a[180:183],v[112:115],v[24:27]
ds_read_b128 v[104:107],v5 offset:16384
v_mfma_f32_16x16x32_bf16 v[40:43],v[112:115],v[180:183],v[40:43]
v_mfma_f32_16x16x32_bf16 v[28:31],a[180:183],v[116:119],v[28:31]
ds_read_b128 v[108:111],v5 offset:20480
v_mfma_f32_16x16x32_bf16 v[44:47],v[116:119],v[180:183],v[44:47]
v_mfma_f32_16x16x32_bf16 v[32:35],a[188:191],v[112:115],v[32:35]
v_mfma_f32_16x16x32_bf16 v[48:51],v[112:115],v[188:191],v[48:51]
v_mfma_f32_16x16x32_bf16 v[36:39],a[188:191],v[116:119],v[36:39]
v_mfma_f32_16x16x32_bf16 v[52:55],v[116:119],v[188:191],v[52:55]
s_waitcnt lgkmcnt(2)
v_mfma_f32_16x16x32_bf16 v[24:27],a[192:195],v[120:123],v[24:27]
ds_read_b128 v[112:115],v6 offset:16384
v_mfma_f32_16x16x32_bf16 v[40:43],v[120:123],v[192:195],v[40:43]
v_mfma_f32_16x16x32_bf16 v[28:31],a[192:195],v[124:127],v[28:31]
ds_read_b128 v[116:119],v6 offset:20480
v_mfma_f32_16x16x32_bf16 v[44:47],v[124:127],v[192:195],v[44:47]
v_mfma_f32_16x16x32_bf16 v[32:35],a[200:203],v[120:123],v[32:35]
v_mfma_f32_16x16x32_bf16 v[48:51],v[120:123],v[200:203],v[48:51]
v_mfma_f32_16x16x32_bf16 v[36:39],a[200:203],v[124:127],v[36:39]
v_mfma_f32_16x16x32_bf16 v[52:55],v[124:127],v[200:203],v[52:55]
s_waitcnt lgkmcnt(2)
v_mfma_f32_16x16x32_bf16 v[24:27],a[196:199],v[104:107],v[24:27]
ds_read_b128 v[120:123],v7 offset:16384
v_mfma_f32_16x16x32_bf16 v[40:43],v[104:107],v[196:199],v[40:43]
v_mfma_f32_16x16x32_bf16 v[28:31],a[196:199],v[108:111],v[28:31]
ds_read_b128 v[124:127],v7 offset:20480
v_mfma_f32_16x16x32_bf16 v[44:47],v[108:111],v[196:199],v[44:47]
v_mfma_f32_16x16x32_bf16 v[32:35],a[204:207],v[104:107],v[32:35]
v_mfma_f32_16x16x32_bf16 v[48:51],v[104:107],v[204:207],v[48:51]
v_mfma_f32_16x16x32_bf16 v[36:39],a[204:207],v[108:111],v[36:39]
v_mfma_f32_16x16x32_bf16 v[52:55],v[108:111],v[204:207],v[52:55]
s_waitcnt vmcnt(0)
s_barrier
s_waitcnt lgkmcnt(2)
v_mfma_f32_16x16x32_bf16 v[24:27],a[208:211],v[112:115],v[24:27]
ds_read_b128 v[104:107],v4 offset:24576
v_mfma_f32_16x16x32_bf16 v[40:43],v[112:115],v[208:211],v[40:43]
v_mfma_f32_16x16x32_bf16 v[28:31],a[208:211],v[116:119],v[28:31]
ds_read_b128 v[108:111],v4 offset:28672
v_mfma_f32_16x16x32_bf16 v[44:47],v[116:119],v[208:211],v[44:47]
v_mfma_f32_16x16x32_bf16 v[32:35],a[216:219],v[112:115],v[32:35]
v_mfma_f32_16x16x32_bf16 v[48:51],v[112:115],v[216:219],v[48:51]
v_mfma_f32_16x16x32_bf16 v[36:39],a[216:219],v[116:119],v[36:39]
v_mfma_f32_16x16x32_bf16 v[52:55],v[116:119],v[216:219],v[52:55]
s_waitcnt lgkmcnt(2)
v_mfma_f32_16x16x32_bf16 v[24:27],a[212:215],v[120:123],v[24:27]
ds_read_b128 v[112:115],v5 offset:24576
v_mfma_f32_16x16x32_bf16 v[40:43],v[120:123],v[212:215],v[40:43]
v_mfma_f32_16x16x32_bf16 v[28:31],a[212:215],v[124:127],v[28:31]
ds_read_b128 v[116:119],v5 offset:28672
v_mfma_f32_16x16x32_bf16 v[44:47],v[124:127],v[212:215],v[44:47]
v_mfma_f32_16x16x32_bf16 v[32:35],a[220:223],v[120:123],v[32:35]
v_mfma_f32_16x16x32_bf16 v[48:51],v[120:123],v[220:223],v[48:51]
v_mfma_f32_16x16x32_bf16 v[36:39],a[220:223],v[124:127],v[36:39]
v_mfma_f32_16x16x32_bf16 v[52:55],v[124:127],v[220:223],v[52:55]
s_waitcnt lgkmcnt(2)
v_mfma_f32_16x16x32_bf16 v[24:27],a[224:227],v[104:107],v[24:27]
ds_read_b128 v[120:123],v6 offset:24576
v_mfma_f32_16x16x32_bf16 v[40:43],v[104:107],v[224:227],v[40:43]
v_mfma_f32_16x16x32_bf16 v[28:31],a[224:227],v[108:111],v[28:31]
ds_read_b128 v[124:127],v6 offset:28672
v_mfma_f32_16x16x32_bf16 v[44:47],v[108:111],v[224:227],v[44:47]
v_mfma_f32_16x16x32_bf16 v[32:35],a[232:235],v[104:107],v[32:35]
v_mfma_f32_16x16x32_bf16 v[48:51],v[104:107],v[232:235],v[48:51]
v_mfma_f32_16x16x32_bf16 v[36:39],a[232:235],v[108:111],v[36:39]
v_mfma_f32_16x16x32_bf16 v[52:55],v[108:111],v[232:235],v[52:55]
s_waitcnt lgkmcnt(2)
v_mfma_f32_16x16x32_bf16 v[24:27],a[228:231],v[112:115],v[24:27]
ds_read_b128 v[104:107],v7 offset:24576
v_mfma_f32_16x16x32_bf16 v[40:43],v[112:115],v[228:231],v[40:43]
v_mfma_f32_16x16x32_bf16 v[28:31],a[228:231],v[116:119],v[28:31]
ds_read_b128 v[108:111],v7 offset:28672
v_mfma_f32_16x16x32_bf16 v[44:47],v[116:119],v[228:231],v[44:47]
v_mfma_f32_16x16x32_bf16 v[32:35],a[236:239],v[112:115],v[32:35]
v_mfma_f32_16x16x32_bf16 v[48:51],v[112:115],v[236:239],v[48:51]
v_mfma_f32_16x16x32_bf16 v[36:39],a[236:239],v[116:119],v[36:39]
v_mfma_f32_16x16x32_bf16 v[52:55],v[116:119],v[236:239],v[52:55]
s_waitcnt lgkmcnt(2)
v_mfma_f32_16x16x32_bf16 v[24:27],a[240:243],v[120:123],v[24:27]
ds_read_b128 v[112:115],v4 offset:0
v_mfma_f32_16x16x32_bf16 v[40:43],v[120:123],v[240:243],v[40:43]
v_mfma_f32_16x16x32_bf16 v[28:31],a[240:243],v[124:127],v[28:31]
ds_read_b128 v[116:119],v4 offset:4096
v_mfma_f32_16x16x32_bf16 v[44:47],v[124:127],v[240:243],v[44:47]
v_mfma_f32_16x16x32_bf16 v[32:35],a[248:251],v[120:123],v[32:35]
v_mfma_f32_16x16x32_bf16 v[48:51],v[120:123],v[248:251],v[48:51]
v_mfma_f32_16x16x32_bf16 v[36:39],a[248:251],v[124:127],v[36:39]
v_mfma_f32_16x16x32_bf16 v[52:55],v[124:127],v[248:251],v[52:55]
s_waitcnt lgkmcnt(2)
v_mfma_f32_16x16x32_bf16 v[24:27],a[244:247],v[104:107],v[24:27]
ds_read_b128 v[120:123],v5 offset:0
v_mfma_f32_16x16x32_bf16 v[40:43],v[104:107],v[244:247],v[40:43]
v_mfma_f32_16x16x32_bf16 v[28:31],a[244:247],v[108:111],v[28:31]
ds_read_b128 v[124:127],v5 offset:4096
v_mfma_f32_16x16x32_bf16 v[44:47],v[108:111],v[244:247],v[44:47]
v_mfma_f32_16x16x32_bf16 v[32:35],a[252:255],v[104:107],v[32:35]
v_mfma_f32_16x16x32_bf16 v[48:51],v[104:107],v[252:255],v[48:51]
v_mfma_f32_16x16x32_bf16 v[36:39],a[252:255],v[108:111],v[36:39]
v_mfma_f32_16x16x32_bf16 v[52:55],v[108:111],v[252:255],v[52:55]
s_waitcnt lgkmcnt(2)
v_mfma_f32_16x16x32_bf16 v[88:91],a[0:3],v[112:115],0
ds_read_b128 v[104:107],v6 offset:0
v_mfma_f32_16x16x32_bf16 v[92:95],a[0:3],v[116:119],0
v_mfma_f32_16x16x32_bf16 v[96:99],a[8:11],v[112:115],0
ds_read_b128 v[108:111],v6 offset:4096
v_cvt_pk_bf16_f32 v56,v24,v32
v_cvt_pk_bf16_f32 v57,v25,v33
v_mfma_f32_16x16x32_bf16 v[100:103],a[8:11],v[116:119],0
v_cvt_pk_bf16_f32 v58,v26,v34
v_cvt_pk_bf16_f32 v59,v27,v35
s_waitcnt lgkmcnt(2)
v_mfma_f32_16x16x32_bf16 v[88:91],a[4:7],v[120:123],v[88:91]
ds_read_b128 v[112:115],v7 offset:0
v_mfma_f32_16x16x32_bf16 v[92:95],a[4:7],v[124:127],v[92:95]
buffer_store_dwordx4 v[56:59],v0,s[8:11],s61 offen sc1
v_cvt_pk_bf16_f32 v60,v28,v36
v_cvt_pk_bf16_f32 v61,v29,v37
v_mfma_f32_16x16x32_bf16 v[96:99],a[12:15],v[120:123],v[96:99]
ds_read_b128 v[116:119],v7 offset:4096
v_cvt_pk_bf16_f32 v62,v30,v38
v_cvt_pk_bf16_f32 v63,v31,v39
v_mfma_f32_16x16x32_bf16 v[100:103],a[12:15],v[124:127],v[100:103]
buffer_store_dwordx4 v[60:63],v0,s[8:11],s62 offen sc1
v_cvt_pk_bf16_f32 v64,v40,v41
v_cvt_pk_bf16_f32 v65,v42,v43
s_waitcnt lgkmcnt(2)
v_mfma_f32_16x16x32_bf16 v[88:91],a[16:19],v[104:107],v[88:91]
ds_read_b128 v[120:123],v4 offset:8192
v_cvt_pk_bf16_f32 v66,v44,v45
v_cvt_pk_bf16_f32 v67,v46,v47
v_mfma_f32_16x16x32_bf16 v[92:95],a[16:19],v[108:111],v[92:95]
buffer_store_dwordx4 v[64:67],v0,s[8:11],s65 offen offset:0 sc1
v_cvt_pk_bf16_f32 v68,v48,v49
v_cvt_pk_bf16_f32 v69,v50,v51
v_mfma_f32_16x16x32_bf16 v[96:99],a[24:27],v[104:107],v[96:99]
ds_read_b128 v[124:127],v4 offset:12288
v_cvt_pk_bf16_f32 v70,v52,v53
v_cvt_pk_bf16_f32 v71,v54,v55
v_mfma_f32_16x16x32_bf16 v[100:103],a[24:27],v[108:111],v[100:103]
buffer_store_dwordx4 v[68:71],v0,s[8:11],s65 offen offset:1024 sc1
s_waitcnt lgkmcnt(2)
v_mfma_f32_16x16x32_bf16 v[88:91],a[20:23],v[112:115],v[88:91]
ds_read_b128 v[104:107],v5 offset:8192
v_mfma_f32_16x16x32_bf16 v[92:95],a[20:23],v[116:119],v[92:95]
v_mfma_f32_16x16x32_bf16 v[96:99],a[28:31],v[112:115],v[96:99]
ds_read_b128 v[108:111],v5 offset:12288
v_mfma_f32_16x16x32_bf16 v[100:103],a[28:31],v[116:119],v[100:103]
s_waitcnt lgkmcnt(2)
v_mfma_f32_16x16x32_bf16 v[88:91],a[32:35],v[120:123],v[88:91]
ds_read_b128 v[112:115],v6 offset:8192
v_mfma_f32_16x16x32_bf16 v[92:95],a[32:35],v[124:127],v[92:95]
v_mfma_f32_16x16x32_bf16 v[96:99],a[40:43],v[120:123],v[96:99]
ds_read_b128 v[116:119],v6 offset:12288
v_mfma_f32_16x16x32_bf16 v[100:103],a[40:43],v[124:127],v[100:103]
s_waitcnt lgkmcnt(2)
v_mfma_f32_16x16x32_bf16 v[88:91],a[36:39],v[104:107],v[88:91]
ds_read_b128 v[120:123],v7 offset:8192
v_mfma_f32_16x16x32_bf16 v[92:95],a[36:39],v[108:111],v[92:95]
v_mfma_f32_16x16x32_bf16 v[96:99],a[44:47],v[104:107],v[96:99]
ds_read_b128 v[124:127],v7 offset:12288
v_mfma_f32_16x16x32_bf16 v[100:103],a[44:47],v[108:111],v[100:103]
s_waitcnt lgkmcnt(2)
v_mfma_f32_16x16x32_bf16 v[88:91],a[48:51],v[112:115],v[88:91]
ds_read_b128 v[104:107],v4 offset:16384
v_mfma_f32_16x16x32_bf16 v[92:95],a[48:51],v[116:119],v[92:95]
v_mfma_f32_16x16x32_bf16 v[96:99],a[56:59],v[112:115],v[96:99]
ds_read_b128 v[108:111],v4 offset:20480
v_mfma_f32_16x16x32_bf16 v[100:103],a[56:59],v[116:119],v[100:103]
s_waitcnt lgkmcnt(2)
v_mfma_f32_16x16x32_bf16 v[88:91],a[52:55],v[120:123],v[88:91]
ds_read_b128 v[112:115],v5 offset:16384
v_mfma_f32_16x16x32_bf16 v[92:95],a[52:55],v[124:127],v[92:95]
v_mfma_f32_16x16x32_bf16 v[96:99],a[60:63],v[120:123],v[96:99]
ds_read_b128 v[116:119],v5 offset:20480
v_mfma_f32_16x16x32_bf16 v[100:103],a[60:63],v[124:127],v[100:103]
s_waitcnt lgkmcnt(2)
v_mfma_f32_16x16x32_bf16 v[88:91],a[64:67],v[104:107],v[88:91]
ds_read_b128 v[120:123],v6 offset:16384
v_mfma_f32_16x16x32_bf16 v[92:95],a[64:67],v[108:111],v[92:95]
v_mfma_f32_16x16x32_bf16 v[96:99],a[72:75],v[104:107],v[96:99]
ds_read_b128 v[124:127],v6 offset:20480
v_mfma_f32_16x16x32_bf16 v[100:103],a[72:75],v[108:111],v[100:103]
s_waitcnt lgkmcnt(2)
v_mfma_f32_16x16x32_bf16 v[88:91],a[68:71],v[112:115],v[88:91]
ds_read_b128 v[104:107],v7 offset:16384
v_mfma_f32_16x16x32_bf16 v[92:95],a[68:71],v[116:119],v[92:95]
v_mfma_f32_16x16x32_bf16 v[96:99],a[76:79],v[112:115],v[96:99]
ds_read_b128 v[108:111],v7 offset:20480
v_mfma_f32_16x16x32_bf16 v[100:103],a[76:79],v[116:119],v[100:103]
s_waitcnt lgkmcnt(2)
v_mfma_f32_16x16x32_bf16 v[88:91],a[80:83],v[120:123],v[88:91]
ds_read_b128 v[112:115],v4 offset:24576
v_mfma_f32_16x16x32_bf16 v[92:95],a[80:83],v[124:127],v[92:95]
v_mfma_f32_16x16x32_bf16 v[96:99],a[88:91],v[120:123],v[96:99]
ds_read_b128 v[116:119],v4 offset:28672
v_mfma_f32_16x16x32_bf16 v[100:103],a[88:91],v[124:127],v[100:103]
s_waitcnt lgkmcnt(2)
v_mfma_f32_16x16x32_bf16 v[88:91],a[84:87],v[104:107],v[88:91]
ds_read_b128 v[120:123],v5 offset:24576
v_mfma_f32_16x16x32_bf16 v[92:95],a[84:87],v[108:111],v[92:95]
v_mfma_f32_16x16x32_bf16 v[96:99],a[92:95],v[104:107],v[96:99]
ds_read_b128 v[124:127],v5 offset:28672
v_mfma_f32_16x16x32_bf16 v[100:103],a[92:95],v[108:111],v[100:103]
s_waitcnt lgkmcnt(2)
v_mfma_f32_16x16x32_bf16 v[88:91],a[96:99],v[112:115],v[88:91]
ds_read_b128 v[104:107],v6 offset:24576
v_mfma_f32_16x16x32_bf16 v[92:95],a[96:99],v[116:119],v[92:95]
v_mfma_f32_16x16x32_bf16 v[96:99],a[104:107],v[112:115],v[96:99]
ds_read_b128 v[108:111],v6 offset:28672
v_mfma_f32_16x16x32_bf16 v[100:103],a[104:107],v[116:119],v[100:103]
s_waitcnt lgkmcnt(2)
v_mfma_f32_16x16x32_bf16 v[88:91],a[100:103],v[120:123],v[88:91]
ds_read_b128 v[112:115],v7 offset:24576
v_mfma_f32_16x16x32_bf16 v[92:95],a[100:103],v[124:127],v[92:95]
v_mfma_f32_16x16x32_bf16 v[96:99],a[108:111],v[120:123],v[96:99]
ds_read_b128 v[116:119],v7 offset:28672
v_mfma_f32_16x16x32_bf16 v[100:103],a[108:111],v[124:127],v[100:103]
s_waitcnt lgkmcnt(2)
v_mfma_f32_16x16x32_bf16 v[88:91],a[112:115],v[104:107],v[88:91]
v_mfma_f32_16x16x32_bf16 v[92:95],a[112:115],v[108:111],v[92:95]
v_mfma_f32_16x16x32_bf16 v[96:99],a[120:123],v[104:107],v[96:99]
v_mfma_f32_16x16x32_bf16 v[100:103],a[120:123],v[108:111],v[100:103]
s_waitcnt lgkmcnt(0)
v_mfma_f32_16x16x32_bf16 v[88:91],a[116:119],v[112:115],v[88:91]
v_mfma_f32_16x16x32_bf16 v[92:95],a[116:119],v[116:119],v[92:95]
v_mfma_f32_16x16x32_bf16 v[96:99],a[124:127],v[112:115],v[96:99]
v_mfma_f32_16x16x32_bf16 v[100:103],a[124:127],v[116:119],v[100:103]
s_nop 3
v_cvt_pk_bf16_f32 v104,v88,v96
v_cvt_pk_bf16_f32 v105,v89,v97
v_cvt_pk_bf16_f32 v106,v90,v98
v_cvt_pk_bf16_f32 v107,v91,v99
v_cvt_pk_bf16_f32 v108,v92,v100
v_cvt_pk_bf16_f32 v109,v93,v101
v_cvt_pk_bf16_f32 v110,v94,v102
v_cvt_pk_bf16_f32 v111,v95,v103
buffer_store_dwordx4 v[104:107],v0,s[8:11],s63 offen sc1
buffer_store_dwordx4 v[108:111],v0,s[8:11],s64 offen sc1
s_waitcnt vmcnt(6)
s_barrier
s_add_u32 m0,s50,131072
s_nop 0
buffer_load_dwordx4 v20,s[8:11],s70 offen offset:0 sc1 lds
s_add_u32 m0,s50,135168
s_nop 0
buffer_load_dwordx4 v20,s[8:11],s71 offen offset:0 sc1 lds
s_add_u32 m0,s50,139008
s_nop 0
buffer_load_dwordx4 v20,s[8:11],s70 offen offset:256 sc1 lds
s_add_u32 m0,s50,143104
s_nop 0
buffer_load_dwordx4 v20,s[8:11],s71 offen offset:256 sc1 lds
s_add_u32 m0,s50,146944
s_nop 0
buffer_load_dwordx4 v20,s[8:11],s70 offen offset:512 sc1 lds
s_add_u32 m0,s50,151040
s_nop 0
buffer_load_dwordx4 v20,s[8:11],s71 offen offset:512 sc1 lds
s_lshl_b32 s59,s51,13
s_lshl2_add_u32 s59,s47,s59
s_add_u32 s59,s59,10487680
s_waitcnt vmcnt(0)
s_barrier
s_or_b32 s59,s59,s52
buffer_store_dword v17,off,s[8:11],s59 sc1
s_mov_b32 s72,0x80000000
s_mov_b32 s86,0
s_mov_b32 s19,1
s_mov_b32 s18,0
s_cmp_lt_u32 s31,64
s_cbranch_scc1 L_mo_33
L_mo_46:
s_mov_b32 s51,64
s_cmp_eq_u32 s47,31
s_cbranch_scc1 L_mf_57
v_and_b32 v9,15,v1
v_lshrrev_b32 v10,4,v1
v_and_b32 v124,1,v1
v_lshlrev_b32 v124,4,v124
v_mov_b32 v125,0xffff
v_lshlrev_b32 v125,v124,v125
v_lshrrev_b32 v124,2,v9
v_cmp_eq_u32 vcc,0,v124
s_nop 1
v_cndmask_b32 v12,0,v125,vcc
v_cmp_eq_u32 vcc,1,v124
s_nop 1
v_cndmask_b32 v13,0,v125,vcc
v_and_b32 v124,2,v1
v_cmp_eq_u32 vcc,0,v124
v_mov_b32 v14,0xeeee
v_mov_b32 v124,0x4444
v_cndmask_b32 v14,v14,v124,vcc
v_lshlrev_b32 v11,14,v10
v_lshl_add_u32 v11,v9,4,v11
s_lshl_b32 s65,s51,15
s_add_u32 s65,s65,92274688
s_lshl_b32 s62,s47,10
s_add_u32 s62,s62,s65
s_lshl_b32 s63,s47,16
s_lshl_b32 s60,s46,8
s_add_u32 s63,s63,s60
s_mov_b32 s4,s38
s_mov_b32 s5,s39
s_mov_b32 s6,1835008
s_mov_b32 s7,0x20000
buffer_load_dwordx4 v[24:27],v11,s[4:7],s63 offen offset:0
buffer_load_dwordx4 v[28:31],v11,s[4:7],s63 offen offset:1024
buffer_load_dwordx4 v[32:35],v11,s[4:7],s63 offen offset:2048
buffer_load_dwordx4 v[36:39],v11,s[4:7],s63 offen offset:3072
s_add_u32 s63,s63,4096
buffer_load_dwordx4 v[40:43],v11,s[4:7],s63 offen offset:0
buffer_load_dwordx4 v[44:47],v11,s[4:7],s63 offen offset:1024
buffer_load_dwordx4 v[48:51],v11,s[4:7],s63 offen offset:2048
buffer_load_dwordx4 v[52:55],v11,s[4:7],s63 offen offset:3072
s_add_u32 s63,s63,4096
buffer_load_dwordx4 v[56:59],v11,s[4:7],s63 offen offset:0
buffer_load_dwordx4 v[60:63],v11,s[4:7],s63 offen offset:1024
buffer_load_dwordx4 v[64:67],v11,s[4:7],s63 offen offset:2048
buffer_load_dwordx4 v[68:71],v11,s[4:7],s63 offen offset:3072
s_add_u32 s63,s63,4096
buffer_load_dwordx4 v[72:75],v11,s[4:7],s63 offen offset:0
buffer_load_dwordx4 v[76:79],v11,s[4:7],s63 offen offset:1024
buffer_load_dwordx4 v[80:83],v11,s[4:7],s63 offen offset:2048
buffer_load_dwordx4 v[84:87],v11,s[4:7],s63 offen offset:3072
buffer_load_dword v15,v0,s[8:11],s62 offen
ds_read_b128 a[0:3],v18 offset:0
ds_read_b128 a[4:7],v18 offset:1024
ds_read_b128 a[8:11],v18 offset:2048
ds_read_b128 a[12:15],v18 offset:3072
ds_read_b128 a[16:19],v18 offset:4096
ds_read_b128 a[20:23],v18 offset:5120
ds_read_b128 a[24:27],v18 offset:6144
ds_read_b128 a[28:31],v18 offset:7168
ds_read_b128 a[32:35],v18 offset:8192
ds_read_b128 a[36:39],v18 offset:9216
ds_read_b128 a[40:43],v18 offset:10240
ds_read_b128 a[44:47],v18 offset:11264
ds_read_b128 a[48:51],v18 offset:12288
ds_read_b128 a[52:55],v18 offset:13312
ds_read_b128 a[56:59],v18 offset:14336
ds_read_b128 a[60:63],v18 offset:15360
ds_read_b128 a[64:67],v18 offset:16384
ds_read_b128 a[68:71],v18 offset:17408
ds_read_b128 a[72:75],v18 offset:18432
ds_read_b128 a[76:79],v18 offset:19456
ds_read_b128 a[80:83],v18 offset:20480
ds_read_b128 a[84:87],v18 offset:21504
ds_read_b128 a[88:91],v18 offset:22528
ds_read_b128 a[92:95],v18 offset:23552
ds_read_b128 a[96:99],v18 offset:24576
ds_read_b128 a[100:103],v18 offset:25600
ds_read_b128 a[104:107],v18 offset:26624
ds_read_b128 a[108:111],v18 offset:27648
ds_read_b128 a[112:115],v18 offset:28672
ds_read_b128 a[116:119],v18 offset:29696
ds_read_b128 a[120:123],v18 offset:30720
ds_read_b128 a[124:127],v18 offset:31744
s_add_u32 s59,s62,32768
buffer_load_dword v15,v0,s[8:11],s59 offen
s_add_u32 s59,s62,65536
buffer_load_dword v15,v0,s[8:11],s59 offen
s_add_u32 s59,s62,98304
buffer_load_dword v15,v0,s[8:11],s59 offen
s_add_u32 s59,s62,131072
buffer_load_dword v15,v0,s[8:11],s59 offen
s_add_u32 s59,s62,163840
buffer_load_dword v15,v0,s[8:11],s59 offen
L_mf_58:
s_lshl_b32 s59,s51,13
s_lshl_b32 s61,s46,7
s_add_u32 s59,s59,s61
s_add_u32 s59,s59,10486272
L_ww_63:
s_sleep 1
buffer_load_dword v2,off,s[8:11],s59 sc1
s_sub_u32 s49,s49,1
s_cbranch_scc1 L_abort
s_waitcnt vmcnt(0)
v_readfirstlane_b32 s55,v2
s_cmp_eq_u32 s55,0
s_cbranch_scc1 L_ww_63
L_wwd_64:
s_cmp_eq_u32 s55,1
s_cbranch_scc1 L_mf_59
s_barrier
s_andn2_b32 s64,0x7ff,s55
s_lshl_b32 s56,s64,10
s_add_u32 s58,s56,6291456
buffer_load_dwordx4 v[88:91],v0,s[8:11],s58 offen sc1
s_lshl_b32 s57,s46,11
s_add_u32 s57,s57,139264
v_add_u32 v8,s57,v0
v_and_b32 v2,1,v10
v_lshrrev_b32 v3,1,v10
v_lshlrev_b32 v2,7,v2
v_lshl_add_u32 v2,v3,10,v2
s_lshl_b32 s59,s46,8
s_add_u32 s59,s57,s59
v_add_u32 v2,s59,v2
s_mov_b32 s60,0x01000100
s_mov_b32 s61,0x03020302
s_waitcnt vmcnt(0)
v_lshlrev_b32 v96,16,v88
v_and_b32 v97,0xffff0000,v88
v_lshlrev_b32 v98,16,v89
v_and_b32 v99,0xffff0000,v89
v_lshlrev_b32 v100,16,v90
v_and_b32 v101,0xffff0000,v90
v_lshlrev_b32 v102,16,v91
v_and_b32 v103,0xffff0000,v91
v_readfirstlane_b32 s78,v96
s_nop 1
v_pk_add_f32 v[108:109],v[96:97],s[78:79] op_sel_hi:[1,0] neg_lo:[0,1] neg_hi:[0,1]
v_pk_add_f32 v[110:111],v[98:99],s[78:79] op_sel_hi:[1,0] neg_lo:[0,1] neg_hi:[0,1]
v_pk_add_f32 v[112:113],v[100:101],s[78:79] op_sel_hi:[1,0] neg_lo:[0,1] neg_hi:[0,1]
v_pk_add_f32 v[114:115],v[102:103],s[78:79] op_sel_hi:[1,0] neg_lo:[0,1] neg_hi:[0,1]
v_pk_add_f32 v[116:117],v[108:109],v[110:111]
v_pk_mul_f32 v[118:119],v[108:109],v[108:109]
v_pk_add_f32 v[120:121],v[112:113],v[114:115]
v_pk_fma_f32 v[118:119],v[110:111],v[110:111],v[118:119]
v_pk_add_f32 v[116:117],v[116:117],v[120:121]
v_pk_fma_f32 v[118:119],v[112:113],v[112:113],v[118:119]
v_add_f32 v116,v116,v117
v_pk_fma_f32 v[118:119],v[114:115],v[114:115],v[118:119]
v_add_f32 v118,v118,v119
s_nop 1
v_permlane32_swap_b32 v116,v118
v_add_f32 v116,v116,v118
s_nop 1
v_add_f32_dpp v116,v116,v116 row_ror:8 row_mask:0xf bank_mask:0xf
s_nop 1
v_add_f32_dpp v116,v116,v116 row_ror:4 row_mask:0xf bank_mask:0xf
s_nop 1
v_add_f32_dpp v116,v116,v116 row_ror:2 row_mask:0xf bank_mask:0xf
s_nop 1
v_add_f32_dpp v116,v116,v116 row_ror:1 row_mask:0xf bank_mask:0xf
v_mov_b32 v118,v116
s_nop 1
v_permlane16_swap_b32 v116,v118
v_add_f32 v116,v116,v118
v_mul_f32 v116,0x3b000000,v116
v_mov_b32 v118,v116
s_nop 1
v_permlane32_swap_b32 v116,v118
v_fma_f32 v118,-v116,v116,v118
v_add_f32 v116,s78,v116
v_max_f32 v118,0,v118
v_cvt_pk_bf16_f32 v118,v116,v118
v_lshlrev_b32 v116,16,v118
v_and_b32 v118,0xffff0000,v118
v_add_f32 v118,0x3727c5ac,v118
v_cvt_pk_bf16_f32 v118,v118,v118
v_and_b32 v118,0xffff0000,v118
v_sqrt_f32 v118,v118
v_pk_add_f32 v[108:109],v[96:97],v[116:117] op_sel_hi:[1,0] neg_lo:[0,1] neg_hi:[0,1]
v_pk_add_f32 v[110:111],v[98:99],v[116:117] op_sel_hi:[1,0] neg_lo:[0,1] neg_hi:[0,1]
v_pk_add_f32 v[112:113],v[100:101],v[116:117] op_sel_hi:[1,0] neg_lo:[0,1] neg_hi:[0,1]
v_pk_add_f32 v[114:115],v[102:103],v[116:117] op_sel_hi:[1,0] neg_lo:[0,1] neg_hi:[0,1]
v_cvt_pk_bf16_f32 v118,v118,v118
v_and_b32 v118,0xffff0000,v118
v_rcp_f32 v118,v118
v_cvt_pk_bf16_f32 v104,v108,v109
v_cvt_pk_bf16_f32 v105,v110,v111
v_cvt_pk_bf16_f32 v106,v112,v113
v_cvt_pk_bf16_f32 v107,v114,v115
v_lshlrev_b32 v108,16,v104
v_and_b32 v109,0xffff0000,v104
v_lshlrev_b32 v110,16,v105
v_and_b32 v111,0xffff0000,v105
v_lshlrev_b32 v112,16,v106
v_and_b32 v113,0xffff0000,v106
v_lshlrev_b32 v114,16,v107
v_and_b32 v115,0xffff0000,v107
v_pk_mul_f32 v[108:109],v[108:109],v[118:119] op_sel_hi:[1,0]
v_pk_mul_f32 v[110:111],v[110:111],v[118:119] op_sel_hi:[1,0]
v_pk_mul_f32 v[112:113],v[112:113],v[118:119] op_sel_hi:[1,0]
v_pk_mul_f32 v[114:115],v[114:115],v[118:119] op_sel_hi:[1,0]
v_cvt_pk_bf16_f32 v104,v108,v109
v_cvt_pk_bf16_f32 v105,v110,v111
v_cvt_pk_bf16_f32 v106,v112,v113
v_cvt_pk_bf16_f32 v107,v114,v115
v_perm_b32 v88,v104,v104,s60
v_perm_b32 v89,v105,v105,s60
v_perm_b32 v90,v106,v106,s60
v_perm_b32 v91,v107,v107,s60
ds_write_b128 v8,v[88:91]
v_perm_b32 v92,v104,v104,s61
v_perm_b32 v93,v105,v105,s61
v_perm_b32 v94,v106,v106,s61
v_perm_b32 v95,v107,v107,s61
ds_write_b128 v8,v[92:95] offset:1024
s_mov_b32 s58,s57
ds_read_b128 v[128:131],v2 offset:0
ds_read_b128 v[144:147],v2 offset:64
ds_read_b128 v[132:135],v2 offset:16
ds_read_b128 v[148:151],v2 offset:80
ds_read_b128 v[136:139],v2 offset:32
ds_read_b128 v[152:155],v2 offset:96
ds_read_b128 v[140:143],v2 offset:48
ds_read_b128 v[156:159],v2 offset:112
v_mov_b64 v[116:117],0
v_mov_b64 v[118:119],0
s_waitcnt lgkmcnt(6)
v_and_b32 v120,v12,v128
v_and_b32 v121,v13,v128
v_and_b32 v122,v12,v144
v_and_b32 v123,v13,v144
v_and_b32 v124,v12,v129
v_and_b32 v125,v13,v129
v_smfmac_f32_16x16x64_bf16 v[116:119],v[120:123],a[0:7],v14
v_and_b32 v126,v12,v145
v_and_b32 v127,v13,v145
v_and_b32 v120,v12,v130
v_and_b32 v121,v13,v130
v_smfmac_f32_16x16x64_bf16 v[116:119],v[124:127],a[8:15],v14
v_and_b32 v122,v12,v146
v_and_b32 v123,v13,v146
v_and_b32 v124,v12,v131
v_and_b32 v125,v13,v131
v_smfmac_f32_16x16x64_bf16 v[116:119],v[120:123],a[16:23],v14
v_and_b32 v126,v12,v147
v_and_b32 v127,v13,v147
s_waitcnt lgkmcnt(4)
v_and_b32 v120,v12,v132
v_and_b32 v121,v13,v132
v_smfmac_f32_16x16x64_bf16 v[116:119],v[124:127],a[24:31],v14
v_and_b32 v122,v12,v148
v_and_b32 v123,v13,v148
v_and_b32 v124,v12,v133
v_and_b32 v125,v13,v133
v_smfmac_f32_16x16x64_bf16 v[116:119],v[120:123],a[32:39],v14
v_and_b32 v126,v12,v149
v_and_b32 v127,v13,v149
v_and_b32 v120,v12,v134
v_and_b32 v121,v13,v134
v_smfmac_f32_16x16x64_bf16 v[116:119],v[124:127],a[40:47],v14
v_and_b32 v122,v12,v150
v_and_b32 v123,v13,v150
v_and_b32 v124,v12,v135
v_and_b32 v125,v13,v135
v_smfmac_f32_16x16x64_bf16 v[116:119],v[120:123],a[48:55],v14
v_and_b32 v126,v12,v151
v_and_b32 v127,v13,v151
s_waitcnt lgkmcnt(2)
v_and_b32 v120,v12,v136
v_and_b32 v121,v13,v136
v_smfmac_f32_16x16x64_bf16 v[116:119],v[124:127],a[56:63],v14
v_and_b32 v122,v12,v152
v_and_b32 v123,v13,v152
v_and_b32 v124,v12,v137
v_and_b32 v125,v13,v137
v_smfmac_f32_16x16x64_bf16 v[116:119],v[120:123],a[64:71],v14
v_and_b32 v126,v12,v153
v_and_b32 v127,v13,v153
v_and_b32 v120,v12,v138
v_and_b32 v121,v13,v138
v_smfmac_f32_16x16x64_bf16 v[116:119],v[124:127],a[72:79],v14
v_and_b32 v122,v12,v154
v_and_b32 v123,v13,v154
v_and_b32 v124,v12,v139
v_and_b32 v125,v13,v139
v_smfmac_f32_16x16x64_bf16 v[116:119],v[120:123],a[80:87],v14
v_and_b32 v126,v12,v155
v_and_b32 v127,v13,v155
s_waitcnt lgkmcnt(0)
v_and_b32 v120,v12,v140
v_and_b32 v121,v13,v140
v_smfmac_f32_16x16x64_bf16 v[116:119],v[124:127],a[88:95],v14
v_and_b32 v122,v12,v156
v_and_b32 v123,v13,v156
v_and_b32 v124,v12,v141
v_and_b32 v125,v13,v141
v_smfmac_f32_16x16x64_bf16 v[116:119],v[120:123],a[96:103],v14
v_and_b32 v126,v12,v157
v_and_b32 v127,v13,v157
v_and_b32 v120,v12,v142
v_and_b32 v121,v13,v142
v_smfmac_f32_16x16x64_bf16 v[116:119],v[124:127],a[104:111],v14
v_and_b32 v122,v12,v158
v_and_b32 v123,v13,v158
v_and_b32 v124,v12,v143
v_and_b32 v125,v13,v143
v_smfmac_f32_16x16x64_bf16 v[116:119],v[120:123],a[112:119],v14
v_and_b32 v126,v12,v159
v_and_b32 v127,v13,v159
s_nop 1
v_smfmac_f32_16x16x64_bf16 v[116:119],v[124:127],a[120:127],v14
v_lshlrev_b32 v8,5,v9
v_and_b32 v124,1,v10
v_lshl_add_u32 v8,v124,4,v8
v_lshrrev_b32 v124,1,v10
v_lshl_add_u32 v8,v124,11,v8
s_lshl_b32 s60,s46,9
s_add_u32 s60,s60,147456
v_add_u32 v8,s60,v8
ds_write_b128 v8,v[116:119]
v_lshlrev_b32 v8,2,v1
v_add_u32 v8,147456,v8
v_and_b32 v2,1,v1
v_lshrrev_b32 v3,1,v1
v_lshlrev_b32 v3,2,v3
v_lshl_add_u32 v2,v2,7,v3
v_add_u32 v2,s58,v2
v_lshlrev_b32 v3,6,v10
v_add_u32 v3,s58,v3
s_waitcnt lgkmcnt(0)
s_barrier
ds_read2st64_b32 v[88:89],v8 offset0:0 offset1:1
ds_read2st64_b32 v[90:91],v8 offset0:2 offset1:3
ds_read2st64_b32 v[92:93],v8 offset0:4 offset1:5
ds_read2st64_b32 v[94:95],v8 offset0:6 offset1:7
s_waitcnt lgkmcnt(0)
v_pk_add_f32 v[88:89],v[88:89],v[90:91]
v_pk_add_f32 v[92:93],v[92:93],v[94:95]
v_pk_add_f32 v[88:89],v[88:89],v[92:93]
v_cvt_pk_bf16_f32 v88,v88,v88
v_and_b32 v88,0xffff0000,v88
v_cvt_pk_bf16_f32 v89,v89,v89
v_and_b32 v89,0xffff0000,v89
v_mul_f32 v90,0xbfb8aa3b,v88
v_exp_f32 v90,v90
s_nop 0
v_add_f32 v90,1.0,v90
v_rcp_f32 v90,v90
s_nop 0
v_mul_f32 v88,v88,v90
v_cvt_pk_bf16_f32 v88,v88,v88
v_and_b32 v88,0xffff0000,v88
v_mul_f32 v88,v88,v89
v_cvt_pk_bf16_f32 v88,v88,v88
ds_write_b32 v2,v88
ds_read_b128 v[88:91],v3
ds_read_b128 v[108:111],v3 offset:32
ds_read_b128 v[92:95],v3 offset:16
ds_read_b128 v[112:115],v3 offset:48
v_mov_b64 v[116:117],0
v_mov_b64 v[118:119],0
s_waitcnt vmcnt(0) lgkmcnt(0)
v_and_b32 v120,v12,v88
v_and_b32 v121,v13,v88
v_and_b32 v122,v12,v108
v_and_b32 v123,v13,v108
v_and_b32 v124,v12,v89
v_and_b32 v125,v13,v89
v_smfmac_f32_16x16x64_bf16 v[116:119],v[120:123],v[24:31],v14
v_and_b32 v126,v12,v109
v_and_b32 v127,v13,v109
v_and_b32 v120,v12,v90
v_and_b32 v121,v13,v90
v_smfmac_f32_16x16x64_bf16 v[116:119],v[124:127],v[32:39],v14
v_and_b32 v122,v12,v110
v_and_b32 v123,v13,v110
v_and_b32 v124,v12,v91
v_and_b32 v125,v13,v91
v_smfmac_f32_16x16x64_bf16 v[116:119],v[120:123],v[40:47],v14
v_and_b32 v126,v12,v111
v_and_b32 v127,v13,v111
v_and_b32 v120,v12,v92
v_and_b32 v121,v13,v92
v_smfmac_f32_16x16x64_bf16 v[116:119],v[124:127],v[48:55],v14
v_and_b32 v122,v12,v112
v_and_b32 v123,v13,v112
v_and_b32 v124,v12,v93
v_and_b32 v125,v13,v93
v_smfmac_f32_16x16x64_bf16 v[116:119],v[120:123],v[56:63],v14
v_and_b32 v126,v12,v113
v_and_b32 v127,v13,v113
v_and_b32 v120,v12,v94
v_and_b32 v121,v13,v94
v_smfmac_f32_16x16x64_bf16 v[116:119],v[124:127],v[64:71],v14
v_and_b32 v122,v12,v114
v_and_b32 v123,v13,v114
v_and_b32 v124,v12,v95
v_and_b32 v125,v13,v95
v_smfmac_f32_16x16x64_bf16 v[116:119],v[120:123],v[72:79],v14
v_and_b32 v126,v12,v115
v_and_b32 v127,v13,v115
s_nop 1
v_smfmac_f32_16x16x64_bf16 v[116:119],v[124:127],v[80:87],v14
v_lshlrev_b32 v8,4,v9
v_and_b32 v124,1,v10
v_lshl_add_u32 v8,v124,3,v8
v_and_b32 v124,2,v10
v_lshl_add_u32 v8,v124,30,v8
s_lshl_b32 s60,s46,8
s_add_u32 s59,s62,s60
s_nop 0
v_cvt_pk_bf16_f32 v88,v116,v117
v_cvt_pk_bf16_f32 v89,v118,v119
buffer_store_dwordx2 v[88:89],v8,s[8:11],s59 offen
s_lshl_b32 s59,s51,13
s_lshl2_add_u32 s59,s47,s59
s_add_u32 s59,s59,10486912
s_waitcnt vmcnt(0)
s_barrier
s_or_b32 s59,s59,s52
buffer_store_dword v17,off,s[8:11],s59
s_cmp_lg_u32 s47,0
s_cbranch_scc1 L_moed_65
s_lshl_b32 s59,s51,13
s_add_u32 s59,s59,10486912
v_and_b32 v124,31,v1
v_lshlrev_b32 v124,2,v124
L_fw_66:
buffer_load_dword v125,v124,s[8:11],s59 offen sc1
s_sub_u32 s49,s49,1
s_cbranch_scc1 L_abort
s_waitcnt vmcnt(0)
v_cmp_eq_u32 vcc,0,v125
s_cbranch_vccnz L_fw_66
s_add_u32 s63,s65,0
buffer_load_dwordx4 v[168:171],v22,s[8:11],s63 offen sc1
s_add_u32 s63,s65,4096
buffer_load_dwordx4 v[172:175],v22,s[8:11],s63 offen sc1
s_add_u32 s63,s65,8192
buffer_load_dwordx4 v[176:179],v22,s[8:11],s63 offen sc1
s_add_u32 s63,s65,12288
buffer_load_dwordx4 v[180:183],v22,s[8:11],s63 offen sc1
s_add_u32 s63,s65,16384
buffer_load_dwordx4 v[184:187],v22,s[8:11],s63 offen sc1
s_add_u32 s63,s65,20480
buffer_load_dwordx4 v[188:191],v22,s[8:11],s63 offen sc1
s_add_u32 s63,s65,24576
buffer_load_dwordx4 v[192:195],v22,s[8:11],s63 offen sc1
s_add_u32 s63,s65,28672
buffer_load_dwordx4 v[196:199],v22,s[8:11],s63 offen sc1
v_and_b32 v208,15,v1
v_and_b32 v209,1,v1
v_lshlrev_b32 v209,4,v209
v_mov_b32 v210,0x3f80
v_lshlrev_b32 v210,v209,v210
v_lshrrev_b32 v208,1,v208
v_cmp_eq_u32 vcc,0,v208
s_nop 1
v_cndmask_b32 v200,0,v210,vcc
v_cmp_eq_u32 vcc,1,v208
s_nop 1
v_cndmask_b32 v201,0,v210,vcc
v_cmp_eq_u32 vcc,2,v208
s_nop 1
v_cndmask_b32 v202,0,v210,vcc
v_cmp_eq_u32 vcc,3,v208
s_nop 1
v_cndmask_b32 v203,0,v210,vcc
s_waitcnt vmcnt(7)
s_nop 0
v_mfma_f32_16x16x32_bf16 v[204:207],v[200:203],v[168:171],0
s_waitcnt vmcnt(6)
v_mfma_f32_16x16x32_bf16 v[204:207],v[200:203],v[172:175],v[204:207]
s_waitcnt vmcnt(5)
v_mfma_f32_16x16x32_bf16 v[204:207],v[200:203],v[176:179],v[204:207]
s_waitcnt vmcnt(4)
v_mfma_f32_16x16x32_bf16 v[204:207],v[200:203],v[180:183],v[204:207]
s_waitcnt vmcnt(3)
v_mfma_f32_16x16x32_bf16 v[204:207],v[200:203],v[184:187],v[204:207]
s_waitcnt vmcnt(2)
v_mfma_f32_16x16x32_bf16 v[204:207],v[200:203],v[188:191],v[204:207]
s_waitcnt vmcnt(1)
v_mfma_f32_16x16x32_bf16 v[204:207],v[200:203],v[192:195],v[204:207]
s_waitcnt vmcnt(0)
v_mfma_f32_16x16x32_bf16 v[204:207],v[200:203],v[196:199],v[204:207]
s_nop 7
ds_write_b128 v21,v[204:207]
s_waitcnt lgkmcnt(0)
s_barrier
s_cmp_lg_u32 s46,0
s_cbranch_scc1 L_moed_65
v_lshlrev_b32 v200,5,v1
v_add_u32 v200,155648,v200
ds_read_b128 v[168:171],v200
ds_read_b128 v[172:175],v200 offset:16
s_and_b32 s59,s55,0xffff0000
s_xor_b32 s60,s59,0x80000000
s_xor_b32 s61,s59,0xffff0000
s_cmp_lt_i32 s59,0
s_cselect_b32 s59,s60,s61
v_mov_b32 v200,s59
v_mul_f32 v200,0xbfb8aa3b,v200
v_exp_f32 v200,v200
s_nop 0
v_add_f32 v200,1.0,v200
v_rcp_f32 v200,v200
s_nop 0
v_cvt_pk_bf16_f32 v200,v200,v200
v_and_b32 v200,0xffff0000,v200
v_lshlrev_b32 v192,16,v104
v_and_b32 v193,0xffff0000,v104
v_lshlrev_b32 v194,16,v105
v_and_b32 v195,0xffff0000,v105
v_lshlrev_b32 v196,16,v106
v_and_b32 v197,0xffff0000,v106
v_lshlrev_b32 v198,16,v107
v_and_b32 v199,0xffff0000,v107
s_waitcnt lgkmcnt(0)
v_cvt_pk_bf16_f32 v184,v168,v169
v_cvt_pk_bf16_f32 v185,v170,v171
v_cvt_pk_bf16_f32 v186,v172,v173
v_cvt_pk_bf16_f32 v187,v174,v175
v_lshlrev_b32 v168,16,v184
v_and_b32 v169,0xffff0000,v184
v_lshlrev_b32 v170,16,v185
v_and_b32 v171,0xffff0000,v185
v_lshlrev_b32 v172,16,v186
v_and_b32 v173,0xffff0000,v186
v_lshlrev_b32 v174,16,v187
v_and_b32 v175,0xffff0000,v187
v_pk_mul_f32 v[168:169],v[168:169],v[200:201] op_sel_hi:[1,0]
v_pk_mul_f32 v[170:171],v[170:171],v[200:201] op_sel_hi:[1,0]
v_pk_mul_f32 v[172:173],v[172:173],v[200:201] op_sel_hi:[1,0]
v_pk_mul_f32 v[174:175],v[174:175],v[200:201] op_sel_hi:[1,0]
v_cvt_pk_bf16_f32 v184,v168,v169
v_cvt_pk_bf16_f32 v185,v170,v171
v_cvt_pk_bf16_f32 v186,v172,v173
v_cvt_pk_bf16_f32 v187,v174,v175
v_lshlrev_b32 v168,16,v184
v_and_b32 v169,0xffff0000,v184
v_lshlrev_b32 v170,16,v185
v_and_b32 v171,0xffff0000,v185
v_lshlrev_b32 v172,16,v186
v_and_b32 v173,0xffff0000,v186
v_lshlrev_b32 v174,16,v187
v_and_b32 v175,0xffff0000,v187
v_pk_add_f32 v[168:169],v[168:169],v[192:193]
v_pk_add_f32 v[170:171],v[170:171],v[194:195]
v_pk_add_f32 v[172:173],v[172:173],v[196:197]
v_pk_add_f32 v[174:175],v[174:175],v[198:199]
v_cvt_pk_bf16_f32 v184,v168,v169
v_cvt_pk_bf16_f32 v185,v170,v171
v_cvt_pk_bf16_f32 v186,v172,v173
v_cvt_pk_bf16_f32 v187,v174,v175
v_lshlrev_b32 v168,16,v184
v_and_b32 v169,0xffff0000,v184
v_lshlrev_b32 v170,16,v185
v_and_b32 v171,0xffff0000,v185
v_lshlrev_b32 v172,16,v186
v_and_b32 v173,0xffff0000,v186
v_lshlrev_b32 v174,16,v187
v_and_b32 v175,0xffff0000,v187
v_pk_add_f32 v[96:97],v[96:97],v[168:169]
v_pk_add_f32 v[98:99],v[98:99],v[170:171]
v_pk_add_f32 v[100:101],v[100:101],v[172:173]
v_pk_add_f32 v[102:103],v[102:103],v[174:175]
v_cvt_pk_bf16_f32 v160,v96,v97
v_cvt_pk_bf16_f32 v161,v98,v99
v_cvt_pk_bf16_f32 v162,v100,v101
v_cvt_pk_bf16_f32 v163,v102,v103
L_moed_65:
s_add_u32 s51,s51,1
s_add_u32 s62,s62,32768
s_add_u32 s65,s65,32768
s_branch L_mf_58
L_mf_59:
s_mov_b32 s4,s40
s_mov_b32 s5,s41
s_mov_b32 s6,2097152
s_mov_b32 s7,0x20000
s_or_b32 s61,s47,s46
s_cselect_b32 s56,0x80000000,s56
buffer_store_dwordx4 v[160:163],v0,s[4:7],s56 offen sc1
s_waitcnt vmcnt(0)
s_endpgm
L_mf_57:
s_cmp_lg_u32 s46,0
s_cbranch_scc1 L_mf_62
v_mov_b64 v[24:25],0
v_mov_b64 v[26:27],0
s_mov_b32 s56,94403584
buffer_store_dwordx4 v[24:27],v0,s[8:11],s56 offen
s_mov_b32 s56,94436352
buffer_store_dwordx4 v[24:27],v0,s[8:11],s56 offen
s_mov_b32 s56,94469120
buffer_store_dwordx4 v[24:27],v0,s[8:11],s56 offen
s_mov_b32 s56,94501888
buffer_store_dwordx4 v[24:27],v0,s[8:11],s56 offen
s_mov_b32 s56,94534656
buffer_store_dwordx4 v[24:27],v0,s[8:11],s56 offen
s_mov_b32 s56,94567424
buffer_store_dwordx4 v[24:27],v0,s[8:11],s56 offen
s_andn2_b32 s61,0x7ff,s54
s_lshr_b32 s61,s61,5
s_mov_b32 s59,11018240
v_lshlrev_b32 v2,2,v1
L_fp_69:
s_sleep 2
buffer_load_dword v3,v2,s[8:11],s59 offen sc1
s_sub_u32 s49,s49,1
s_cbranch_scc1 L_abort
s_waitcnt vmcnt(0)
v_cmp_eq_u32 vcc,0,v3
s_cbranch_vccnz L_fp_69
v_cmp_le_u32 vcc,s61,v1
s_nop 1
v_cndmask_b32 v2,1,2,vcc
v_cmp_ne_u32 s[84:85],v2,v3
s_mov_b32 s56,11011324
buffer_store_dword v17,off,s[8:11],s56
s_mov_b32 s56,11019516
buffer_store_dword v17,off,s[8:11],s56
s_mov_b32 s56,11027708
buffer_store_dword v17,off,s[8:11],s56
s_mov_b32 s56,11035900
buffer_store_dword v17,off,s[8:11],s56
s_mov_b32 s56,11044092
buffer_store_dword v17,off,s[8:11],s56
s_mov_b32 s56,11052284
buffer_store_dword v17,off,s[8:11],s56
v_lshrrev_b32 v2,3,v1
v_and_b32 v3,0x70,v0
v_lshl_add_u32 v3,v2,13,v3
s_lshr_b64 s[20:21],s[84:85],0
v_lshrrev_b32 v60,v2,s20
v_and_b32 v60,1,v60
v_mul_u32_u24 v60,768,v60
v_sub_u32 v60,v3,v60
v_add_u32 v60,10487296,v60
s_lshr_b64 s[20:21],s[84:85],8
v_lshrrev_b32 v61,v2,s20
v_and_b32 v61,1,v61
v_mul_u32_u24 v61,768,v61
v_sub_u32 v61,v3,v61
v_add_u32 v61,10552832,v61
s_lshr_b64 s[20:21],s[84:85],16
v_lshrrev_b32 v62,v2,s20
v_and_b32 v62,1,v62
v_mul_u32_u24 v62,768,v62
v_sub_u32 v62,v3,v62
v_add_u32 v62,10618368,v62
s_lshr_b64 s[20:21],s[84:85],24
v_lshrrev_b32 v63,v2,s20
v_and_b32 v63,1,v63
v_mul_u32_u24 v63,768,v63
v_sub_u32 v63,v3,v63
v_add_u32 v63,10683904,v63
s_lshr_b64 s[20:21],s[84:85],32
v_lshrrev_b32 v64,v2,s20
v_and_b32 v64,1,v64
v_mul_u32_u24 v64,768,v64
v_sub_u32 v64,v3,v64
v_add_u32 v64,10749440,v64
s_lshr_b64 s[20:21],s[84:85],40
v_lshrrev_b32 v65,v2,s20
v_and_b32 v65,1,v65
v_mul_u32_u24 v65,768,v65
v_sub_u32 v65,v3,v65
v_add_u32 v65,10814976,v65
s_lshr_b64 s[20:21],s[84:85],48
v_lshrrev_b32 v66,v2,s20
v_and_b32 v66,1,v66
v_mul_u32_u24 v66,768,v66
v_sub_u32 v66,v3,v66
v_add_u32 v66,10880512,v66
s_lshr_b64 s[20:21],s[84:85],56
v_lshrrev_b32 v67,v2,s20
v_and_b32 v67,1,v67
v_mul_u32_u24 v67,768,v67
v_sub_u32 v67,v3,v67
v_add_u32 v67,10946048,v67
v_and_b32 v68,3,v1
v_lshlrev_b32 v68,7,v68
v_add_u32 v68,10486272,v68
v_and_b32 v69,31,v1
v_lshlrev_b32 v69,2,v69
v_add_u32 v69,10478720,v69
s_mov_b32 s66,0
s_mov_b32 s67,524288
L_mf_60:
buffer_load_dwordx4 v[24:27],v60,s[8:11],0 offen sc1
buffer_load_dwordx4 v[28:31],v61,s[8:11],0 offen sc1
buffer_load_dwordx4 v[32:35],v62,s[8:11],0 offen sc1
buffer_load_dwordx4 v[36:39],v63,s[8:11],0 offen sc1
buffer_load_dwordx4 v[40:43],v64,s[8:11],0 offen sc1
buffer_load_dwordx4 v[44:47],v65,s[8:11],0 offen sc1
buffer_load_dwordx4 v[48:51],v66,s[8:11],0 offen sc1
buffer_load_dwordx4 v[52:55],v67,s[8:11],0 offen sc1
buffer_load_dword v70,v69,s[8:11],s67 offen sc1
s_sub_u32 s49,s49,1
s_cbranch_scc1 L_abort
s_mov_b32 s57,0
s_waitcnt vmcnt(8)
v_min3_u32 v56,v24,v25,v26
v_max3_u32 v57,v24,v25,v24
v_min_u32 v56,v27,v56
v_max3_u32 v57,v26,v27,v57
v_cmp_eq_u32 vcc,0,v56
s_bcnt1_i32_b64 s56,vcc
s_add_u32 s57,s57,s56
s_waitcnt vmcnt(7)
v_min3_u32 v56,v28,v29,v30
v_max3_u32 v57,v28,v29,v57
v_min_u32 v56,v31,v56
v_max3_u32 v57,v30,v31,v57
v_cmp_eq_u32 vcc,0,v56
s_bcnt1_i32_b64 s56,vcc
s_add_u32 s57,s57,s56
s_waitcnt vmcnt(6)
v_min3_u32 v56,v32,v33,v34
v_max3_u32 v57,v32,v33,v57
v_min_u32 v56,v35,v56
v_max3_u32 v57,v34,v35,v57
v_cmp_eq_u32 vcc,0,v56
s_bcnt1_i32_b64 s56,vcc
s_add_u32 s57,s57,s56
s_waitcnt vmcnt(5)
v_min3_u32 v56,v36,v37,v38
v_max3_u32 v57,v36,v37,v57
v_min_u32 v56,v39,v56
v_max3_u32 v57,v38,v39,v57
v_cmp_eq_u32 vcc,0,v56
s_bcnt1_i32_b64 s56,vcc
s_add_u32 s57,s57,s56
s_waitcnt vmcnt(4)
v_min3_u32 v56,v40,v41,v42
v_max3_u32 v57,v40,v41,v57
v_min_u32 v56,v43,v56
v_max3_u32 v57,v42,v43,v57
v_cmp_eq_u32 vcc,0,v56
s_bcnt1_i32_b64 s56,vcc
s_add_u32 s57,s57,s56
s_waitcnt vmcnt(3)
v_min3_u32 v56,v44,v45,v46
v_max3_u32 v57,v44,v45,v57
v_min_u32 v56,v47,v56
v_max3_u32 v57,v46,v47,v57
v_cmp_eq_u32 vcc,0,v56
s_bcnt1_i32_b64 s56,vcc
s_add_u32 s57,s57,s56
s_waitcnt vmcnt(2)
v_min3_u32 v56,v48,v49,v50
v_max3_u32 v57,v48,v49,v57
v_min_u32 v56,v51,v56
v_max3_u32 v57,v50,v51,v57
v_cmp_eq_u32 vcc,0,v56
s_bcnt1_i32_b64 s56,vcc
s_add_u32 s57,s57,s56
s_waitcnt vmcnt(1)
v_min3_u32 v56,v52,v53,v54
v_max3_u32 v57,v52,v53,v57
v_min_u32 v56,v55,v56
v_max3_u32 v57,v54,v55,v57
v_cmp_eq_u32 vcc,0,v56
s_bcnt1_i32_b64 s56,vcc
s_add_u32 s57,s57,s56
v_max_u32_dpp v57,v57,v57 row_ror:8 row_mask:0xf bank_mask:0xf
s_nop 1
v_max_u32_dpp v57,v57,v57 row_ror:4 row_mask:0xf bank_mask:0xf
s_nop 1
v_max_u32_dpp v57,v57,v57 row_ror:2 row_mask:0xf bank_mask:0xf
s_nop 1
v_max_u32_dpp v57,v57,v57 row_ror:1 row_mask:0xf bank_mask:0xf
v_mov_b32 v58,v57
s_nop 1
v_permlane16_swap_b32 v57,v58
v_max_u32 v57,v57,v58
v_mov_b32 v58,v57
s_nop 1
v_permlane32_swap_b32 v57,v58
v_max_u32 v57,v57,v58
s_nop 0
v_readfirstlane_b32 s55,v57
s_cmp_lg_u32 s55,s66
s_cbranch_scc1 L_mf_61
s_cmp_lg_u32 s57,0
s_cbranch_scc1 L_mf_60
v_mov_b32 v57,1
buffer_store_dword v57,v68,s[8:11],s67 offen
L_mf_62:
s_waitcnt vmcnt(0)
s_endpgm
L_mf_61:
s_waitcnt vmcnt(0)
v_cmp_eq_u32 vcc,0,v70
s_cmp_eq_u32 s66,0
s_cselect_b32 s56,0,vcc_lo
s_cmp_gt_u32 s57,112
s_cselect_b32 s56,1,s56
s_cmp_ge_u32 s67,565248
s_cselect_b32 s56,1,s56
s_cmp_eq_u32 s57,0
s_cselect_b32 s56,0,s56
s_cmp_lg_u32 s56,0
s_cbranch_scc1 L_mf_60
buffer_store_dword v57,v68,s[8:11],s67 offen
s_mov_b32 s66,s55
s_add_u32 s67,s67,8192
s_branch L_mf_60
s_endpgm
L_abort:
s_endpgm
L_spread:
s_mov_b32 s3,-1
s_lshr_b32 s48,s2,5
s_and_b32 s47,s2,31
s_branch L_roles
L_ra_6:
s_and_b32 s56,s48,1
s_lshl_b32 s56,s56,12
s_add_u32 s56,s56,s50
s_and_b32 s57,s47,15
s_lshl_b32 s57,s57,13
s_add_u32 s56,s56,s57
s_mov_b32 s4,s22
s_mov_b32 s5,s23
s_mov_b32 s6,4194304
s_mov_b32 s7,0x20000
s_add_u32 s57,s56,0
buffer_load_dwordx4 v[24:27],v0,s[4:7],s57 offen
s_add_u32 s57,s56,131072
buffer_load_dwordx4 v[24:27],v0,s[4:7],s57 offen
s_add_u32 s57,s56,262144
buffer_load_dwordx4 v[24:27],v0,s[4:7],s57 offen
s_add_u32 s57,s56,393216
buffer_load_dwordx4 v[24:27],v0,s[4:7],s57 offen
s_add_u32 s57,s56,524288
buffer_load_dwordx4 v[24:27],v0,s[4:7],s57 offen
s_add_u32 s57,s56,655360
buffer_load_dwordx4 v[24:27],v0,s[4:7],s57 offen
s_add_u32 s57,s56,786432
buffer_load_dwordx4 v[24:27],v0,s[4:7],s57 offen
s_add_u32 s57,s56,917504
buffer_load_dwordx4 v[24:27],v0,s[4:7],s57 offen
s_add_u32 s57,s56,1048576
buffer_load_dwordx4 v[24:27],v0,s[4:7],s57 offen
s_add_u32 s57,s56,1179648
buffer_load_dwordx4 v[24:27],v0,s[4:7],s57 offen
s_waitcnt vmcnt(9)
s_add_u32 s57,s56,1310720
buffer_load_dwordx4 v[24:27],v0,s[4:7],s57 offen
s_barrier
s_cmp_lg_u32 s46,0
s_cbranch_scc1 L_ar_70
v_mov_b32 v8,128
v_mov_b32 v9,s53
s_mov_b64 exec,1
buffer_atomic_add v9,v8,s[12:15],0 offen
s_mov_b64 exec,-1
L_ar_70:
s_mov_b32 s53,0
s_waitcnt vmcnt(9)
s_add_u32 s57,s56,1441792
buffer_load_dwordx4 v[24:27],v0,s[4:7],s57 offen
s_waitcnt vmcnt(9)
s_add_u32 s57,s56,1572864
buffer_load_dwordx4 v[24:27],v0,s[4:7],s57 offen
s_waitcnt vmcnt(9)
s_add_u32 s57,s56,1703936
buffer_load_dwordx4 v[24:27],v0,s[4:7],s57 offen
s_waitcnt vmcnt(9)
s_add_u32 s57,s56,1835008
buffer_load_dwordx4 v[24:27],v0,s[4:7],s57 offen
s_waitcnt vmcnt(9)
s_add_u32 s57,s56,1966080
buffer_load_dwordx4 v[24:27],v0,s[4:7],s57 offen
s_waitcnt vmcnt(9)
s_add_u32 s57,s56,2097152
buffer_load_dwordx4 v[24:27],v0,s[4:7],s57 offen
s_waitcnt vmcnt(9)
s_add_u32 s57,s56,2228224
buffer_load_dwordx4 v[24:27],v0,s[4:7],s57 offen
s_waitcnt vmcnt(9)
s_add_u32 s57,s56,2359296
buffer_load_dwordx4 v[24:27],v0,s[4:7],s57 offen
s_waitcnt vmcnt(9)
s_add_u32 s57,s56,2490368
buffer_load_dwordx4 v[24:27],v0,s[4:7],s57 offen
s_waitcnt vmcnt(9)
s_add_u32 s57,s56,2621440
buffer_load_dwordx4 v[24:27],v0,s[4:7],s57 offen
s_waitcnt vmcnt(9)
s_add_u32 s57,s56,2752512
buffer_load_dwordx4 v[24:27],v0,s[4:7],s57 offen
s_waitcnt vmcnt(9)
s_add_u32 s57,s56,2883584
buffer_load_dwordx4 v[24:27],v0,s[4:7],s57 offen
s_waitcnt vmcnt(9)
s_add_u32 s57,s56,3014656
buffer_load_dwordx4 v[24:27],v0,s[4:7],s57 offen
s_waitcnt vmcnt(9)
s_add_u32 s57,s56,3145728
buffer_load_dwordx4 v[24:27],v0,s[4:7],s57 offen
s_waitcnt vmcnt(9)
s_add_u32 s57,s56,3276800
buffer_load_dwordx4 v[24:27],v0,s[4:7],s57 offen
s_waitcnt vmcnt(9)
s_add_u32 s57,s56,3407872
buffer_load_dwordx4 v[24:27],v0,s[4:7],s57 offen
s_waitcnt vmcnt(9)
s_add_u32 s57,s56,3538944
buffer_load_dwordx4 v[24:27],v0,s[4:7],s57 offen
s_waitcnt vmcnt(9)
s_add_u32 s57,s56,3670016
buffer_load_dwordx4 v[24:27],v0,s[4:7],s57 offen
s_waitcnt vmcnt(9)
s_add_u32 s57,s56,3801088
buffer_load_dwordx4 v[24:27],v0,s[4:7],s57 offen
s_waitcnt vmcnt(9)
s_add_u32 s57,s56,3932160
buffer_load_dwordx4 v[24:27],v0,s[4:7],s57 offen
s_waitcnt vmcnt(9)
s_add_u32 s57,s56,4063232
buffer_load_dwordx4 v[24:27],v0,s[4:7],s57 offen
s_mov_b32 s4,s24
s_mov_b32 s5,s25
s_mov_b32 s6,4194304
s_mov_b32 s7,0x20000
s_waitcnt vmcnt(9)
s_add_u32 s57,s56,0
buffer_load_dwordx4 v[24:27],v0,s[4:7],s57 offen
s_waitcnt vmcnt(9)
s_add_u32 s57,s56,131072
buffer_load_dwordx4 v[24:27],v0,s[4:7],s57 offen
s_waitcnt vmcnt(9)
s_add_u32 s57,s56,262144
buffer_load_dwordx4 v[24:27],v0,s[4:7],s57 offen
s_waitcnt vmcnt(9)
s_add_u32 s57,s56,393216
buffer_load_dwordx4 v[24:27],v0,s[4:7],s57 offen
s_waitcnt vmcnt(9)
s_add_u32 s57,s56,524288
buffer_load_dwordx4 v[24:27],v0,s[4:7],s57 offen
s_waitcnt vmcnt(9)
s_add_u32 s57,s56,655360
buffer_load_dwordx4 v[24:27],v0,s[4:7],s57 offen
s_waitcnt vmcnt(9)
s_add_u32 s57,s56,786432
buffer_load_dwordx4 v[24:27],v0,s[4:7],s57 offen
s_waitcnt vmcnt(9)
s_add_u32 s57,s56,917504
buffer_load_dwordx4 v[24:27],v0,s[4:7],s57 offen
s_waitcnt vmcnt(9)
s_add_u32 s57,s56,1048576
buffer_load_dwordx4 v[24:27],v0,s[4:7],s57 offen
s_waitcnt vmcnt(9)
s_add_u32 s57,s56,1179648
buffer_load_dwordx4 v[24:27],v0,s[4:7],s57 offen
s_waitcnt vmcnt(9)
s_add_u32 s57,s56,1310720
buffer_load_dwordx4 v[24:27],v0,s[4:7],s57 offen
s_waitcnt vmcnt(9)
s_add_u32 s57,s56,1441792
buffer_load_dwordx4 v[24:27],v0,s[4:7],s57 offen
s_waitcnt vmcnt(9)
s_add_u32 s57,s56,1572864
buffer_load_dwordx4 v[24:27],v0,s[4:7],s57 offen
s_waitcnt vmcnt(9)
s_add_u32 s57,s56,1703936
buffer_load_dwordx4 v[24:27],v0,s[4:7],s57 offen
s_waitcnt vmcnt(9)
s_add_u32 s57,s56,1835008
buffer_load_dwordx4 v[24:27],v0,s[4:7],s57 offen
s_waitcnt vmcnt(9)
s_add_u32 s57,s56,1966080
buffer_load_dwordx4 v[24:27],v0,s[4:7],s57 offen
s_waitcnt vmcnt(9)
s_add_u32 s57,s56,2097152
buffer_load_dwordx4 v[24:27],v0,s[4:7],s57 offen
s_waitcnt vmcnt(9)
s_add_u32 s57,s56,2228224
buffer_load_dwordx4 v[24:27],v0,s[4:7],s57 offen
s_waitcnt vmcnt(9)
s_add_u32 s57,s56,2359296
buffer_load_dwordx4 v[24:27],v0,s[4:7],s57 offen
s_waitcnt vmcnt(9)
s_add_u32 s57,s56,2490368
buffer_load_dwordx4 v[24:27],v0,s[4:7],s57 offen
s_waitcnt vmcnt(9)
s_add_u32 s57,s56,2621440
buffer_load_dwordx4 v[24:27],v0,s[4:7],s57 offen
s_waitcnt vmcnt(9)
s_add_u32 s57,s56,2752512
buffer_load_dwordx4 v[24:27],v0,s[4:7],s57 offen
s_waitcnt vmcnt(9)
s_add_u32 s57,s56,2883584
buffer_load_dwordx4 v[24:27],v0,s[4:7],s57 offen
s_waitcnt vmcnt(9)
s_add_u32 s57,s56,3014656
buffer_load_dwordx4 v[24:27],v0,s[4:7],s57 offen
s_waitcnt vmcnt(9)
s_add_u32 s57,s56,3145728
buffer_load_dwordx4 v[24:27],v0,s[4:7],s57 offen
s_waitcnt vmcnt(9)
s_add_u32 s57,s56,3276800
buffer_load_dwordx4 v[24:27],v0,s[4:7],s57 offen
s_waitcnt vmcnt(9)
s_add_u32 s57,s56,3407872
buffer_load_dwordx4 v[24:27],v0,s[4:7],s57 offen
s_waitcnt vmcnt(9)
s_add_u32 s57,s56,3538944
buffer_load_dwordx4 v[24:27],v0,s[4:7],s57 offen
s_waitcnt vmcnt(9)
s_add_u32 s57,s56,3670016
buffer_load_dwordx4 v[24:27],v0,s[4:7],s57 offen
s_waitcnt vmcnt(9)
s_add_u32 s57,s56,3801088
buffer_load_dwordx4 v[24:27],v0,s[4:7],s57 offen
s_waitcnt vmcnt(9)
s_add_u32 s57,s56,3932160
buffer_load_dwordx4 v[24:27],v0,s[4:7],s57 offen
s_waitcnt vmcnt(9)
s_add_u32 s57,s56,4063232
buffer_load_dwordx4 v[24:27],v0,s[4:7],s57 offen
s_mov_b32 s4,s20
s_mov_b32 s5,s21
s_mov_b32 s6,4194304
s_mov_b32 s7,0x20000
s_waitcnt vmcnt(9)
s_add_u32 s57,s56,0
buffer_load_dwordx4 v[24:27],v0,s[4:7],s57 offen
s_waitcnt vmcnt(9)
s_add_u32 s57,s56,131072
buffer_load_dwordx4 v[24:27],v0,s[4:7],s57 offen
s_waitcnt vmcnt(9)
s_add_u32 s57,s56,262144
buffer_load_dwordx4 v[24:27],v0,s[4:7],s57 offen
s_waitcnt vmcnt(9)
s_add_u32 s57,s56,393216
buffer_load_dwordx4 v[24:27],v0,s[4:7],s57 offen
s_waitcnt vmcnt(9)
s_add_u32 s57,s56,524288
buffer_load_dwordx4 v[24:27],v0,s[4:7],s57 offen
s_waitcnt vmcnt(9)
s_add_u32 s57,s56,655360
buffer_load_dwordx4 v[24:27],v0,s[4:7],s57 offen
s_waitcnt vmcnt(9)
s_add_u32 s57,s56,786432
buffer_load_dwordx4 v[24:27],v0,s[4:7],s57 offen
s_waitcnt vmcnt(9)
s_add_u32 s57,s56,917504
buffer_load_dwordx4 v[24:27],v0,s[4:7],s57 offen
s_waitcnt vmcnt(9)
s_add_u32 s57,s56,1048576
buffer_load_dwordx4 v[24:27],v0,s[4:7],s57 offen
s_waitcnt vmcnt(9)
s_add_u32 s57,s56,1179648
buffer_load_dwordx4 v[24:27],v0,s[4:7],s57 offen
s_waitcnt vmcnt(9)
s_add_u32 s57,s56,1310720
buffer_load_dwordx4 v[24:27],v0,s[4:7],s57 offen
s_waitcnt vmcnt(9)
s_add_u32 s57,s56,1441792
buffer_load_dwordx4 v[24:27],v0,s[4:7],s57 offen
s_waitcnt vmcnt(9)
s_add_u32 s57,s56,1572864
buffer_load_dwordx4 v[24:27],v0,s[4:7],s57 offen
s_waitcnt vmcnt(9)
s_add_u32 s57,s56,1703936
buffer_load_dwordx4 v[24:27],v0,s[4:7],s57 offen
s_waitcnt vmcnt(9)
s_add_u32 s57,s56,1835008
buffer_load_dwordx4 v[24:27],v0,s[4:7],s57 offen
s_waitcnt vmcnt(9)
s_add_u32 s57,s56,1966080
buffer_load_dwordx4 v[24:27],v0,s[4:7],s57 offen
s_waitcnt vmcnt(9)
s_add_u32 s57,s56,2097152
buffer_load_dwordx4 v[24:27],v0,s[4:7],s57 offen
s_waitcnt vmcnt(9)
s_add_u32 s57,s56,2228224
buffer_load_dwordx4 v[24:27],v0,s[4:7],s57 offen
s_waitcnt vmcnt(9)
s_add_u32 s57,s56,2359296
buffer_load_dwordx4 v[24:27],v0,s[4:7],s57 offen
s_waitcnt vmcnt(9)
s_add_u32 s57,s56,2490368
buffer_load_dwordx4 v[24:27],v0,s[4:7],s57 offen
s_waitcnt vmcnt(9)
s_add_u32 s57,s56,2621440
buffer_load_dwordx4 v[24:27],v0,s[4:7],s57 offen
s_waitcnt vmcnt(9)
s_add_u32 s57,s56,2752512
buffer_load_dwordx4 v[24:27],v0,s[4:7],s57 offen
s_waitcnt vmcnt(9)
s_add_u32 s57,s56,2883584
buffer_load_dwordx4 v[24:27],v0,s[4:7],s57 offen
s_waitcnt vmcnt(9)
s_add_u32 s57,s56,3014656
buffer_load_dwordx4 v[24:27],v0,s[4:7],s57 offen
s_waitcnt vmcnt(9)
s_add_u32 s57,s56,3145728
buffer_load_dwordx4 v[24:27],v0,s[4:7],s57 offen
s_waitcnt vmcnt(9)
s_add_u32 s57,s56,3276800
buffer_load_dwordx4 v[24:27],v0,s[4:7],s57 offen
s_waitcnt vmcnt(9)
s_add_u32 s57,s56,3407872
buffer_load_dwordx4 v[24:27],v0,s[4:7],s57 offen
s_waitcnt vmcnt(9)
s_add_u32 s57,s56,3538944
buffer_load_dwordx4 v[24:27],v0,s[4:7],s57 offen
s_waitcnt vmcnt(9)
s_add_u32 s57,s56,3670016
buffer_load_dwordx4 v[24:27],v0,s[4:7],s57 offen
s_waitcnt vmcnt(9)
s_add_u32 s57,s56,3801088
buffer_load_dwordx4 v[24:27],v0,s[4:7],s57 offen
s_waitcnt vmcnt(9)
s_add_u32 s57,s56,3932160
buffer_load_dwordx4 v[24:27],v0,s[4:7],s57 offen
s_waitcnt vmcnt(9)
s_add_u32 s57,s56,4063232
buffer_load_dwordx4 v[24:27],v0,s[4:7],s57 offen
L_rb_7:
s_mov_b32 s4,s26
s_mov_b32 s5,s27
s_mov_b32 s6,4194304
s_mov_b32 s7,0x20000
v_and_b32 v2,15,v1
v_lshlrev_b32 v2,4,v2
v_lshrrev_b32 v3,4,v1
v_lshl_add_u32 v2,v3,13,v2
s_and_b32 s56,s47,15
s_lshl_b32 s56,s56,18
s_lshl_b32 s57,s46,8
s_add_u32 s56,s56,s57
s_mov_b32 s61,0x05040100
s_mov_b32 s62,0x07060302
s_add_u32 s57,s56,0
buffer_load_dwordx4 v[24:27],v2,s[4:7],s57 offen offset:0
buffer_load_dwordx4 v[28:31],v2,s[4:7],s57 offen offset:1024
buffer_load_dwordx4 v[32:35],v2,s[4:7],s57 offen offset:2048
buffer_load_dwordx4 v[36:39],v2,s[4:7],s57 offen offset:3072
s_add_u32 s57,s56,4096
buffer_load_dwordx4 v[40:43],v2,s[4:7],s57 offen offset:0
buffer_load_dwordx4 v[44:47],v2,s[4:7],s57 offen offset:1024
buffer_load_dwordx4 v[48:51],v2,s[4:7],s57 offen offset:2048
buffer_load_dwordx4 v[52:55],v2,s[4:7],s57 offen offset:3072
s_add_u32 s57,s56,32768
buffer_load_dwordx4 v[56:59],v2,s[4:7],s57 offen offset:0
buffer_load_dwordx4 v[60:63],v2,s[4:7],s57 offen offset:1024
buffer_load_dwordx4 v[64:67],v2,s[4:7],s57 offen offset:2048
buffer_load_dwordx4 v[68:71],v2,s[4:7],s57 offen offset:3072
s_add_u32 s57,s56,36864
buffer_load_dwordx4 v[72:75],v2,s[4:7],s57 offen offset:0
buffer_load_dwordx4 v[76:79],v2,s[4:7],s57 offen offset:1024
buffer_load_dwordx4 v[80:83],v2,s[4:7],s57 offen offset:2048
buffer_load_dwordx4 v[84:87],v2,s[4:7],s57 offen offset:3072
s_add_u32 s57,s56,65536
buffer_load_dwordx4 v[88:91],v2,s[4:7],s57 offen offset:0
buffer_load_dwordx4 v[92:95],v2,s[4:7],s57 offen offset:1024
buffer_load_dwordx4 v[96:99],v2,s[4:7],s57 offen offset:2048
buffer_load_dwordx4 v[100:103],v2,s[4:7],s57 offen offset:3072
s_add_u32 s57,s56,69632
buffer_load_dwordx4 v[104:107],v2,s[4:7],s57 offen offset:0
buffer_load_dwordx4 v[108:111],v2,s[4:7],s57 offen offset:1024
buffer_load_dwordx4 v[112:115],v2,s[4:7],s57 offen offset:2048
buffer_load_dwordx4 v[116:119],v2,s[4:7],s57 offen offset:3072
s_add_u32 s57,s56,98304
buffer_load_dwordx4 v[120:123],v2,s[4:7],s57 offen offset:0
buffer_load_dwordx4 v[124:127],v2,s[4:7],s57 offen offset:1024
buffer_load_dwordx4 v[128:131],v2,s[4:7],s57 offen offset:2048
buffer_load_dwordx4 v[132:135],v2,s[4:7],s57 offen offset:3072
s_add_u32 s57,s56,102400
buffer_load_dwordx4 v[136:139],v2,s[4:7],s57 offen offset:0
buffer_load_dwordx4 v[140:143],v2,s[4:7],s57 offen offset:1024
buffer_load_dwordx4 v[144:147],v2,s[4:7],s57 offen offset:2048
buffer_load_dwordx4 v[148:151],v2,s[4:7],s57 offen offset:3072
s_add_u32 s57,s56,131072
buffer_load_dwordx4 v[152:155],v2,s[4:7],s57 offen offset:0
buffer_load_dwordx4 v[156:159],v2,s[4:7],s57 offen offset:1024
buffer_load_dwordx4 v[160:163],v2,s[4:7],s57 offen offset:2048
buffer_load_dwordx4 v[164:167],v2,s[4:7],s57 offen offset:3072
s_add_u32 s57,s56,135168
buffer_load_dwordx4 v[168:171],v2,s[4:7],s57 offen offset:0
buffer_load_dwordx4 v[172:175],v2,s[4:7],s57 offen offset:1024
buffer_load_dwordx4 v[176:179],v2,s[4:7],s57 offen offset:2048
buffer_load_dwordx4 v[180:183],v2,s[4:7],s57 offen offset:3072
s_add_u32 s57,s56,163840
buffer_load_dwordx4 v[184:187],v2,s[4:7],s57 offen offset:0
buffer_load_dwordx4 v[188:191],v2,s[4:7],s57 offen offset:1024
buffer_load_dwordx4 v[192:195],v2,s[4:7],s57 offen offset:2048
buffer_load_dwordx4 v[196:199],v2,s[4:7],s57 offen offset:3072
s_add_u32 s57,s56,167936
buffer_load_dwordx4 v[200:203],v2,s[4:7],s57 offen offset:0
buffer_load_dwordx4 v[204:207],v2,s[4:7],s57 offen offset:1024
buffer_load_dwordx4 v[208:211],v2,s[4:7],s57 offen offset:2048
buffer_load_dwordx4 v[212:215],v2,s[4:7],s57 offen offset:3072
s_waitcnt vmcnt(40)
v_perm_b32 v216,v28,v24,s61
v_perm_b32 v217,v36,v32,s61
v_perm_b32 v218,v44,v40,s61
v_perm_b32 v219,v52,v48,s61
v_accvgpr_write_b32 a0,v216
v_accvgpr_write_b32 a1,v217
v_accvgpr_write_b32 a2,v218
v_accvgpr_write_b32 a3,v219
v_perm_b32 v216,v28,v24,s62
v_perm_b32 v217,v36,v32,s62
v_perm_b32 v218,v44,v40,s62
v_perm_b32 v219,v52,v48,s62
v_accvgpr_write_b32 a4,v216
v_accvgpr_write_b32 a5,v217
v_accvgpr_write_b32 a6,v218
v_accvgpr_write_b32 a7,v219
v_perm_b32 v216,v29,v25,s61
v_perm_b32 v217,v37,v33,s61
v_perm_b32 v218,v45,v41,s61
v_perm_b32 v219,v53,v49,s61
v_accvgpr_write_b32 a8,v216
v_accvgpr_write_b32 a9,v217
v_accvgpr_write_b32 a10,v218
v_accvgpr_write_b32 a11,v219
v_perm_b32 v216,v29,v25,s62
v_perm_b32 v217,v37,v33,s62
v_perm_b32 v218,v45,v41,s62
v_perm_b32 v219,v53,v49,s62
v_accvgpr_write_b32 a12,v216
v_accvgpr_write_b32 a13,v217
v_accvgpr_write_b32 a14,v218
v_accvgpr_write_b32 a15,v219
v_perm_b32 v216,v30,v26,s61
v_perm_b32 v217,v38,v34,s61
v_perm_b32 v218,v46,v42,s61
v_perm_b32 v219,v54,v50,s61
v_accvgpr_write_b32 a16,v216
v_accvgpr_write_b32 a17,v217
v_accvgpr_write_b32 a18,v218
v_accvgpr_write_b32 a19,v219
v_perm_b32 v216,v30,v26,s62
v_perm_b32 v217,v38,v34,s62
v_perm_b32 v218,v46,v42,s62
v_perm_b32 v219,v54,v50,s62
v_accvgpr_write_b32 a20,v216
v_accvgpr_write_b32 a21,v217
v_accvgpr_write_b32 a22,v218
v_accvgpr_write_b32 a23,v219
v_perm_b32 v216,v31,v27,s61
v_perm_b32 v217,v39,v35,s61
v_perm_b32 v218,v47,v43,s61
v_perm_b32 v219,v55,v51,s61
v_accvgpr_write_b32 a24,v216
v_accvgpr_write_b32 a25,v217
v_accvgpr_write_b32 a26,v218
v_accvgpr_write_b32 a27,v219
v_perm_b32 v216,v31,v27,s62
v_perm_b32 v217,v39,v35,s62
v_perm_b32 v218,v47,v43,s62
v_perm_b32 v219,v55,v51,s62
v_accvgpr_write_b32 a28,v216
v_accvgpr_write_b32 a29,v217
v_accvgpr_write_b32 a30,v218
v_accvgpr_write_b32 a31,v219
s_add_u32 s57,s56,196608
buffer_load_dwordx4 v[24:27],v2,s[4:7],s57 offen offset:0
buffer_load_dwordx4 v[28:31],v2,s[4:7],s57 offen offset:1024
buffer_load_dwordx4 v[32:35],v2,s[4:7],s57 offen offset:2048
buffer_load_dwordx4 v[36:39],v2,s[4:7],s57 offen offset:3072
s_add_u32 s57,s56,200704
buffer_load_dwordx4 v[40:43],v2,s[4:7],s57 offen offset:0
buffer_load_dwordx4 v[44:47],v2,s[4:7],s57 offen offset:1024
buffer_load_dwordx4 v[48:51],v2,s[4:7],s57 offen offset:2048
buffer_load_dwordx4 v[52:55],v2,s[4:7],s57 offen offset:3072
s_barrier
s_cmp_lg_u32 s46,0
s_cbranch_scc1 L_ar_71
v_mov_b32 v8,128
v_mov_b32 v9,s53
s_mov_b64 exec,1
buffer_atomic_add v9,v8,s[12:15],0 offen
s_mov_b64 exec,-1
L_ar_71:
s_mov_b32 s53,0
s_waitcnt vmcnt(40)
v_perm_b32 v216,v60,v56,s61
v_perm_b32 v217,v68,v64,s61
v_perm_b32 v218,v76,v72,s61
v_perm_b32 v219,v84,v80,s61
v_accvgpr_write_b32 a32,v216
v_accvgpr_write_b32 a33,v217
v_accvgpr_write_b32 a34,v218
v_accvgpr_write_b32 a35,v219
v_perm_b32 v216,v60,v56,s62
v_perm_b32 v217,v68,v64,s62
v_perm_b32 v218,v76,v72,s62
v_perm_b32 v219,v84,v80,s62
v_accvgpr_write_b32 a36,v216
v_accvgpr_write_b32 a37,v217
v_accvgpr_write_b32 a38,v218
v_accvgpr_write_b32 a39,v219
v_perm_b32 v216,v61,v57,s61
v_perm_b32 v217,v69,v65,s61
v_perm_b32 v218,v77,v73,s61
v_perm_b32 v219,v85,v81,s61
v_accvgpr_write_b32 a40,v216
v_accvgpr_write_b32 a41,v217
v_accvgpr_write_b32 a42,v218
v_accvgpr_write_b32 a43,v219
v_perm_b32 v216,v61,v57,s62
v_perm_b32 v217,v69,v65,s62
v_perm_b32 v218,v77,v73,s62
v_perm_b32 v219,v85,v81,s62
v_accvgpr_write_b32 a44,v216
v_accvgpr_write_b32 a45,v217
v_accvgpr_write_b32 a46,v218
v_accvgpr_write_b32 a47,v219
v_perm_b32 v216,v62,v58,s61
v_perm_b32 v217,v70,v66,s61
v_perm_b32 v218,v78,v74,s61
v_perm_b32 v219,v86,v82,s61
v_accvgpr_write_b32 a48,v216
v_accvgpr_write_b32 a49,v217
v_accvgpr_write_b32 a50,v218
v_accvgpr_write_b32 a51,v219
v_perm_b32 v216,v62,v58,s62
v_perm_b32 v217,v70,v66,s62
v_perm_b32 v218,v78,v74,s62
v_perm_b32 v219,v86,v82,s62
v_accvgpr_write_b32 a52,v216
v_accvgpr_write_b32 a53,v217
v_accvgpr_write_b32 a54,v218
v_accvgpr_write_b32 a55,v219
v_perm_b32 v216,v63,v59,s61
v_perm_b32 v217,v71,v67,s61
v_perm_b32 v218,v79,v75,s61
v_perm_b32 v219,v87,v83,s61
v_accvgpr_write_b32 a56,v216
v_accvgpr_write_b32 a57,v217
v_accvgpr_write_b32 a58,v218
v_accvgpr_write_b32 a59,v219
v_perm_b32 v216,v63,v59,s62
v_perm_b32 v217,v71,v67,s62
v_perm_b32 v218,v79,v75,s62
v_perm_b32 v219,v87,v83,s62
v_accvgpr_write_b32 a60,v216
v_accvgpr_write_b32 a61,v217
v_accvgpr_write_b32 a62,v218
v_accvgpr_write_b32 a63,v219
s_add_u32 s57,s56,229376
buffer_load_dwordx4 v[56:59],v2,s[4:7],s57 offen offset:0
buffer_load_dwordx4 v[60:63],v2,s[4:7],s57 offen offset:1024
buffer_load_dwordx4 v[64:67],v2,s[4:7],s57 offen offset:2048
buffer_load_dwordx4 v[68:71],v2,s[4:7],s57 offen offset:3072
s_add_u32 s57,s56,233472
buffer_load_dwordx4 v[72:75],v2,s[4:7],s57 offen offset:0
buffer_load_dwordx4 v[76:79],v2,s[4:7],s57 offen offset:1024
buffer_load_dwordx4 v[80:83],v2,s[4:7],s57 offen offset:2048
buffer_load_dwordx4 v[84:87],v2,s[4:7],s57 offen offset:3072
s_waitcnt vmcnt(40)
v_perm_b32 v216,v92,v88,s61
v_perm_b32 v217,v100,v96,s61
v_perm_b32 v218,v108,v104,s61
v_perm_b32 v219,v116,v112,s61
v_accvgpr_write_b32 a64,v216
v_accvgpr_write_b32 a65,v217
v_accvgpr_write_b32 a66,v218
v_accvgpr_write_b32 a67,v219
v_perm_b32 v216,v92,v88,s62
v_perm_b32 v217,v100,v96,s62
v_perm_b32 v218,v108,v104,s62
v_perm_b32 v219,v116,v112,s62
v_accvgpr_write_b32 a68,v216
v_accvgpr_write_b32 a69,v217
v_accvgpr_write_b32 a70,v218
v_accvgpr_write_b32 a71,v219
v_perm_b32 v216,v93,v89,s61
v_perm_b32 v217,v101,v97,s61
v_perm_b32 v218,v109,v105,s61
v_perm_b32 v219,v117,v113,s61
v_accvgpr_write_b32 a72,v216
v_accvgpr_write_b32 a73,v217
v_accvgpr_write_b32 a74,v218
v_accvgpr_write_b32 a75,v219
v_perm_b32 v216,v93,v89,s62
v_perm_b32 v217,v101,v97,s62
v_perm_b32 v218,v109,v105,s62
v_perm_b32 v219,v117,v113,s62
v_accvgpr_write_b32 a76,v216
v_accvgpr_write_b32 a77,v217
v_accvgpr_write_b32 a78,v218
v_accvgpr_write_b32 a79,v219
v_perm_b32 v216,v94,v90,s61
v_perm_b32 v217,v102,v98,s61
v_perm_b32 v218,v110,v106,s61
v_perm_b32 v219,v118,v114,s61
v_accvgpr_write_b32 a80,v216
v_accvgpr_write_b32 a81,v217
v_accvgpr_write_b32 a82,v218
v_accvgpr_write_b32 a83,v219
v_perm_b32 v216,v94,v90,s62
v_perm_b32 v217,v102,v98,s62
v_perm_b32 v218,v110,v106,s62
v_perm_b32 v219,v118,v114,s62
v_accvgpr_write_b32 a84,v216
v_accvgpr_write_b32 a85,v217
v_accvgpr_write_b32 a86,v218
v_accvgpr_write_b32 a87,v219
v_perm_b32 v216,v95,v91,s61
v_perm_b32 v217,v103,v99,s61
v_perm_b32 v218,v111,v107,s61
v_perm_b32 v219,v119,v115,s61
v_accvgpr_write_b32 a88,v216
v_accvgpr_write_b32 a89,v217
v_accvgpr_write_b32 a90,v218
v_accvgpr_write_b32 a91,v219
v_perm_b32 v216,v95,v91,s62
v_perm_b32 v217,v103,v99,s62
v_perm_b32 v218,v111,v107,s62
v_perm_b32 v219,v119,v115,s62
v_accvgpr_write_b32 a92,v216
v_accvgpr_write_b32 a93,v217
v_accvgpr_write_b32 a94,v218
v_accvgpr_write_b32 a95,v219
s_waitcnt vmcnt(32)
v_perm_b32 v216,v124,v120,s61
v_perm_b32 v217,v132,v128,s61
v_perm_b32 v218,v140,v136,s61
v_perm_b32 v219,v148,v144,s61
v_accvgpr_write_b32 a96,v216
v_accvgpr_write_b32 a97,v217
v_accvgpr_write_b32 a98,v218
v_accvgpr_write_b32 a99,v219
v_perm_b32 v216,v124,v120,s62
v_perm_b32 v217,v132,v128,s62
v_perm_b32 v218,v140,v136,s62
v_perm_b32 v219,v148,v144,s62
v_accvgpr_write_b32 a100,v216
v_accvgpr_write_b32 a101,v217
v_accvgpr_write_b32 a102,v218
v_accvgpr_write_b32 a103,v219
v_perm_b32 v216,v125,v121,s61
v_perm_b32 v217,v133,v129,s61
v_perm_b32 v218,v141,v137,s61
v_perm_b32 v219,v149,v145,s61
v_accvgpr_write_b32 a104,v216
v_accvgpr_write_b32 a105,v217
v_accvgpr_write_b32 a106,v218
v_accvgpr_write_b32 a107,v219
v_perm_b32 v216,v125,v121,s62
v_perm_b32 v217,v133,v129,s62
v_perm_b32 v218,v141,v137,s62
v_perm_b32 v219,v149,v145,s62
v_accvgpr_write_b32 a108,v216
v_accvgpr_write_b32 a109,v217
v_accvgpr_write_b32 a110,v218
v_accvgpr_write_b32 a111,v219
v_perm_b32 v216,v126,v122,s61
v_perm_b32 v217,v134,v130,s61
v_perm_b32 v218,v142,v138,s61
v_perm_b32 v219,v150,v146,s61
v_accvgpr_write_b32 a112,v216
v_accvgpr_write_b32 a113,v217
v_accvgpr_write_b32 a114,v218
v_accvgpr_write_b32 a115,v219
v_perm_b32 v216,v126,v122,s62
v_perm_b32 v217,v134,v130,s62
v_perm_b32 v218,v142,v138,s62
v_perm_b32 v219,v150,v146,s62
v_accvgpr_write_b32 a116,v216
v_accvgpr_write_b32 a117,v217
v_accvgpr_write_b32 a118,v218
v_accvgpr_write_b32 a119,v219
v_perm_b32 v216,v127,v123,s61
v_perm_b32 v217,v135,v131,s61
v_perm_b32 v218,v143,v139,s61
v_perm_b32 v219,v151,v147,s61
v_accvgpr_write_b32 a120,v216
v_accvgpr_write_b32 a121,v217
v_accvgpr_write_b32 a122,v218
v_accvgpr_write_b32 a123,v219
v_perm_b32 v216,v127,v123,s62
v_perm_b32 v217,v135,v131,s62
v_perm_b32 v218,v143,v139,s62
v_perm_b32 v219,v151,v147,s62
v_accvgpr_write_b32 a124,v216
v_accvgpr_write_b32 a125,v217
v_accvgpr_write_b32 a126,v218
v_accvgpr_write_b32 a127,v219
s_waitcnt vmcnt(24)
v_perm_b32 v216,v156,v152,s61
v_perm_b32 v217,v164,v160,s61
v_perm_b32 v218,v172,v168,s61
v_perm_b32 v219,v180,v176,s61
v_accvgpr_write_b32 a128,v216
v_accvgpr_write_b32 a129,v217
v_accvgpr_write_b32 a130,v218
v_accvgpr_write_b32 a131,v219
v_perm_b32 v216,v156,v152,s62
v_perm_b32 v217,v164,v160,s62
v_perm_b32 v218,v172,v168,s62
v_perm_b32 v219,v180,v176,s62
v_accvgpr_write_b32 a132,v216
v_accvgpr_write_b32 a133,v217
v_accvgpr_write_b32 a134,v218
v_accvgpr_write_b32 a135,v219
v_perm_b32 v216,v157,v153,s61
v_perm_b32 v217,v165,v161,s61
v_perm_b32 v218,v173,v169,s61
v_perm_b32 v219,v181,v177,s61
v_accvgpr_write_b32 a136,v216
v_accvgpr_write_b32 a137,v217
v_accvgpr_write_b32 a138,v218
v_accvgpr_write_b32 a139,v219
v_perm_b32 v216,v157,v153,s62
v_perm_b32 v217,v165,v161,s62
v_perm_b32 v218,v173,v169,s62
v_perm_b32 v219,v181,v177,s62
v_accvgpr_write_b32 a140,v216
v_accvgpr_write_b32 a141,v217
v_accvgpr_write_b32 a142,v218
v_accvgpr_write_b32 a143,v219
v_perm_b32 v216,v158,v154,s61
v_perm_b32 v217,v166,v162,s61
v_perm_b32 v218,v174,v170,s61
v_perm_b32 v219,v182,v178,s61
v_accvgpr_write_b32 a144,v216
v_accvgpr_write_b32 a145,v217
v_accvgpr_write_b32 a146,v218
v_accvgpr_write_b32 a147,v219
v_perm_b32 v216,v158,v154,s62
v_perm_b32 v217,v166,v162,s62
v_perm_b32 v218,v174,v170,s62
v_perm_b32 v219,v182,v178,s62
v_accvgpr_write_b32 a148,v216
v_accvgpr_write_b32 a149,v217
v_accvgpr_write_b32 a150,v218
v_accvgpr_write_b32 a151,v219
v_perm_b32 v216,v159,v155,s61
v_perm_b32 v217,v167,v163,s61
v_perm_b32 v218,v175,v171,s61
v_perm_b32 v219,v183,v179,s61
v_accvgpr_write_b32 a152,v216
v_accvgpr_write_b32 a153,v217
v_accvgpr_write_b32 a154,v218
v_accvgpr_write_b32 a155,v219
v_perm_b32 v216,v159,v155,s62
v_perm_b32 v217,v167,v163,s62
v_perm_b32 v218,v175,v171,s62
v_perm_b32 v219,v183,v179,s62
v_accvgpr_write_b32 a156,v216
v_accvgpr_write_b32 a157,v217
v_accvgpr_write_b32 a158,v218
v_accvgpr_write_b32 a159,v219
s_waitcnt vmcnt(16)
v_perm_b32 v216,v188,v184,s61
v_perm_b32 v217,v196,v192,s61
v_perm_b32 v218,v204,v200,s61
v_perm_b32 v219,v212,v208,s61
v_accvgpr_write_b32 a160,v216
v_accvgpr_write_b32 a161,v217
v_accvgpr_write_b32 a162,v218
v_accvgpr_write_b32 a163,v219
v_perm_b32 v216,v188,v184,s62
v_perm_b32 v217,v196,v192,s62
v_perm_b32 v218,v204,v200,s62
v_perm_b32 v219,v212,v208,s62
v_accvgpr_write_b32 a164,v216
v_accvgpr_write_b32 a165,v217
v_accvgpr_write_b32 a166,v218
v_accvgpr_write_b32 a167,v219
v_perm_b32 v216,v189,v185,s61
v_perm_b32 v217,v197,v193,s61
v_perm_b32 v218,v205,v201,s61
v_perm_b32 v219,v213,v209,s61
v_accvgpr_write_b32 a168,v216
v_accvgpr_write_b32 a169,v217
v_accvgpr_write_b32 a170,v218
v_accvgpr_write_b32 a171,v219
v_perm_b32 v216,v189,v185,s62
v_perm_b32 v217,v197,v193,s62
v_perm_b32 v218,v205,v201,s62
v_perm_b32 v219,v213,v209,s62
v_accvgpr_write_b32 a172,v216
v_accvgpr_write_b32 a173,v217
v_accvgpr_write_b32 a174,v218
v_accvgpr_write_b32 a175,v219
v_perm_b32 v216,v190,v186,s61
v_perm_b32 v217,v198,v194,s61
v_perm_b32 v218,v206,v202,s61
v_perm_b32 v219,v214,v210,s61
v_accvgpr_write_b32 a176,v216
v_accvgpr_write_b32 a177,v217
v_accvgpr_write_b32 a178,v218
v_accvgpr_write_b32 a179,v219
v_perm_b32 v216,v190,v186,s62
v_perm_b32 v217,v198,v194,s62
v_perm_b32 v218,v206,v202,s62
v_perm_b32 v219,v214,v210,s62
v_accvgpr_write_b32 a180,v216
v_accvgpr_write_b32 a181,v217
v_accvgpr_write_b32 a182,v218
v_accvgpr_write_b32 a183,v219
v_perm_b32 v216,v191,v187,s61
v_perm_b32 v217,v199,v195,s61
v_perm_b32 v218,v207,v203,s61
v_perm_b32 v219,v215,v211,s61
v_accvgpr_write_b32 a184,v216
v_accvgpr_write_b32 a185,v217
v_accvgpr_write_b32 a186,v218
v_accvgpr_write_b32 a187,v219
v_perm_b32 v216,v191,v187,s62
v_perm_b32 v217,v199,v195,s62
v_perm_b32 v218,v207,v203,s62
v_perm_b32 v219,v215,v211,s62
v_accvgpr_write_b32 a188,v216
v_accvgpr_write_b32 a189,v217
v_accvgpr_write_b32 a190,v218
v_accvgpr_write_b32 a191,v219
s_waitcnt vmcnt(8)
v_perm_b32 v216,v28,v24,s61
v_perm_b32 v217,v36,v32,s61
v_perm_b32 v218,v44,v40,s61
v_perm_b32 v219,v52,v48,s61
v_accvgpr_write_b32 a192,v216
v_accvgpr_write_b32 a193,v217
v_accvgpr_write_b32 a194,v218
v_accvgpr_write_b32 a195,v219
v_perm_b32 v216,v28,v24,s62
v_perm_b32 v217,v36,v32,s62
v_perm_b32 v218,v44,v40,s62
v_perm_b32 v219,v52,v48,s62
v_accvgpr_write_b32 a196,v216
v_accvgpr_write_b32 a197,v217
v_accvgpr_write_b32 a198,v218
v_accvgpr_write_b32 a199,v219
v_perm_b32 v216,v29,v25,s61
v_perm_b32 v217,v37,v33,s61
v_perm_b32 v218,v45,v41,s61
v_perm_b32 v219,v53,v49,s61
v_accvgpr_write_b32 a200,v216
v_accvgpr_write_b32 a201,v217
v_accvgpr_write_b32 a202,v218
v_accvgpr_write_b32 a203,v219
v_perm_b32 v216,v29,v25,s62
v_perm_b32 v217,v37,v33,s62
v_perm_b32 v218,v45,v41,s62
v_perm_b32 v219,v53,v49,s62
v_accvgpr_write_b32 a204,v216
v_accvgpr_write_b32 a205,v217
v_accvgpr_write_b32 a206,v218
v_accvgpr_write_b32 a207,v219
v_perm_b32 v216,v30,v26,s61
v_perm_b32 v217,v38,v34,s61
v_perm_b32 v218,v46,v42,s61
v_perm_b32 v219,v54,v50,s61
v_accvgpr_write_b32 a208,v216
v_accvgpr_write_b32 a209,v217
v_accvgpr_write_b32 a210,v218
v_accvgpr_write_b32 a211,v219
v_perm_b32 v216,v30,v26,s62
v_perm_b32 v217,v38,v34,s62
v_perm_b32 v218,v46,v42,s62
v_perm_b32 v219,v54,v50,s62
v_accvgpr_write_b32 a212,v216
v_accvgpr_write_b32 a213,v217
v_accvgpr_write_b32 a214,v218
v_accvgpr_write_b32 a215,v219
v_perm_b32 v216,v31,v27,s61
v_perm_b32 v217,v39,v35,s61
v_perm_b32 v218,v47,v43,s61
v_perm_b32 v219,v55,v51,s61
v_accvgpr_write_b32 a216,v216
v_accvgpr_write_b32 a217,v217
v_accvgpr_write_b32 a218,v218
v_accvgpr_write_b32 a219,v219
v_perm_b32 v216,v31,v27,s62
v_perm_b32 v217,v39,v35,s62
v_perm_b32 v218,v47,v43,s62
v_perm_b32 v219,v55,v51,s62
v_accvgpr_write_b32 a220,v216
v_accvgpr_write_b32 a221,v217
v_accvgpr_write_b32 a222,v218
v_accvgpr_write_b32 a223,v219
s_waitcnt vmcnt(0)
v_perm_b32 v216,v60,v56,s61
v_perm_b32 v217,v68,v64,s61
v_perm_b32 v218,v76,v72,s61
v_perm_b32 v219,v84,v80,s61
v_accvgpr_write_b32 a224,v216
v_accvgpr_write_b32 a225,v217
v_accvgpr_write_b32 a226,v218
v_accvgpr_write_b32 a227,v219
v_perm_b32 v216,v60,v56,s62
v_perm_b32 v217,v68,v64,s62
v_perm_b32 v218,v76,v72,s62
v_perm_b32 v219,v84,v80,s62
v_accvgpr_write_b32 a228,v216
v_accvgpr_write_b32 a229,v217
v_accvgpr_write_b32 a230,v218
v_accvgpr_write_b32 a231,v219
v_perm_b32 v216,v61,v57,s61
v_perm_b32 v217,v69,v65,s61
v_perm_b32 v218,v77,v73,s61
v_perm_b32 v219,v85,v81,s61
v_accvgpr_write_b32 a232,v216
v_accvgpr_write_b32 a233,v217
v_accvgpr_write_b32 a234,v218
v_accvgpr_write_b32 a235,v219
v_perm_b32 v216,v61,v57,s62
v_perm_b32 v217,v69,v65,s62
v_perm_b32 v218,v77,v73,s62
v_perm_b32 v219,v85,v81,s62
v_accvgpr_write_b32 a236,v216
v_accvgpr_write_b32 a237,v217
v_accvgpr_write_b32 a238,v218
v_accvgpr_write_b32 a239,v219
v_perm_b32 v216,v62,v58,s61
v_perm_b32 v217,v70,v66,s61
v_perm_b32 v218,v78,v74,s61
v_perm_b32 v219,v86,v82,s61
v_accvgpr_write_b32 a240,v216
v_accvgpr_write_b32 a241,v217
v_accvgpr_write_b32 a242,v218
v_accvgpr_write_b32 a243,v219
v_perm_b32 v216,v62,v58,s62
v_perm_b32 v217,v70,v66,s62
v_perm_b32 v218,v78,v74,s62
v_perm_b32 v219,v86,v82,s62
v_accvgpr_write_b32 a244,v216
v_accvgpr_write_b32 a245,v217
v_accvgpr_write_b32 a246,v218
v_accvgpr_write_b32 a247,v219
v_perm_b32 v216,v63,v59,s61
v_perm_b32 v217,v71,v67,s61
v_perm_b32 v218,v79,v75,s61
v_perm_b32 v219,v87,v83,s61
v_accvgpr_write_b32 a248,v216
v_accvgpr_write_b32 a249,v217
v_accvgpr_write_b32 a250,v218
v_accvgpr_write_b32 a251,v219
v_perm_b32 v216,v63,v59,s62
v_perm_b32 v217,v71,v67,s62
v_perm_b32 v218,v79,v75,s62
v_perm_b32 v219,v87,v83,s62
v_accvgpr_write_b32 a252,v216
v_accvgpr_write_b32 a253,v217
v_accvgpr_write_b32 a254,v218
v_accvgpr_write_b32 a255,v219
v_mov_b32 v123,159744
s_cmp_lg_u32 s46,0
s_cbranch_scc1 L_gbd_73
v_mov_b32 v124,128
L_gb_72:
buffer_load_dword v125,v124,s[12:15],0 offen sc1
s_waitcnt vmcnt(0)
v_readfirstlane_b32 s56,v125
ds_write_b32 v123,v125
s_bitcmp1_b32 s56,8
s_cbranch_scc1 L_gbd_73
s_sleep 4
s_sub_u32 s49,s49,1
s_cmp_gt_i32 s49,0
s_cbranch_scc1 L_gb_72
s_branch L_abort
L_gbd_73:
s_waitcnt lgkmcnt(0)
s_barrier
ds_read_b32 v125,v123
s_waitcnt lgkmcnt(0)
v_readfirstlane_b32 s56,v125
s_barrier
s_lshr_b32 s56,s56,16
s_andn2_b32 s56,s56,s3
s_cbranch_scc1 L_spread
s_max_u32 s54,s48,5
s_sub_u32 s54,s54,5
s_lshl_b32 s54,s54,1
s_lshr_b32 s56,s47,4
s_add_u32 s54,s54,s56
s_cmp_lg_u32 s3,0
s_cbranch_scc1 L_wa
v_and_b32 v238,15,v1
v_and_b32 v239,1,v1
v_lshlrev_b32 v239,4,v239
v_mov_b32 v240,0x3f80
v_lshlrev_b32 v240,v239,v240
v_lshrrev_b32 v238,1,v238
v_cmp_eq_u32 vcc,0,v238
s_nop 1
v_cndmask_b32 v156,0,v240,vcc
v_cmp_eq_u32 vcc,1,v238
s_nop 1
v_cndmask_b32 v157,0,v240,vcc
v_cmp_eq_u32 vcc,2,v238
s_nop 1
v_cndmask_b32 v158,0,v240,vcc
v_cmp_eq_u32 vcc,3,v238
s_nop 1
v_cndmask_b32 v159,0,v240,vcc
s_mov_b32 s4,s32
s_mov_b32 s5,s33
s_mov_b32 s6,1024
s_mov_b32 s7,0x20000
buffer_load_dwordx4 v[224:227],v0,s[4:7],0 offen
v_and_b32 v238,15,v1
v_lshrrev_b32 v239,4,v1
v_lshlrev_b32 v240,2,v239
v_mov_b32 v241,0xf149f2ca
s_and_b32 s56,s46,1
s_lshl_b32 s56,s56,4
v_add_u32 v242,s56,v238
v_add_u32 v243,0,v240
v_cmp_gt_u32 vcc,v243,v242
s_nop 1
v_cndmask_b32 v8,0,v241,vcc
v_add_u32 v243,1,v240
v_cmp_gt_u32 vcc,v243,v242
s_nop 1
v_cndmask_b32 v9,0,v241,vcc
v_add_u32 v243,2,v240
v_cmp_gt_u32 vcc,v243,v242
s_nop 1
v_cndmask_b32 v10,0,v241,vcc
v_add_u32 v243,3,v240
v_cmp_gt_u32 vcc,v243,v242
s_nop 1
v_cndmask_b32 v11,0,v241,vcc
v_add_u32 v243,16,v240
v_cmp_gt_u32 vcc,v243,v242
s_nop 1
v_cndmask_b32 v12,0,v241,vcc
v_add_u32 v243,17,v240
v_cmp_gt_u32 vcc,v243,v242
s_nop 1
v_cndmask_b32 v13,0,v241,vcc
v_add_u32 v243,18,v240
v_cmp_gt_u32 vcc,v243,v242
s_nop 1
v_cndmask_b32 v14,0,v241,vcc
v_add_u32 v243,19,v240
v_cmp_gt_u32 vcc,v243,v242
s_nop 1
v_cndmask_b32 v15,0,v241,vcc
v_mov_b32 v152,s80
v_mov_b32 v145,0
v_mov_b32 v146,0
s_lshl_b32 s56,s46,12
s_add_u32 s56,s56,131072
v_add_u32 v3,s56,v0
v_add_u32 v4,131072,v0
s_lshl_b32 s56,s46,8
v_lshlrev_b32 v7,4,v238
v_add_u32 v7,s56,v7
v_lshl_add_u32 v5,v239,16,v7
v_lshlrev_b32 v6,1,v7
v_lshl_add_u32 v7,v239,10,v7
v_and_b32 v243,1,v239
v_lshl_add_u32 v6,v243,4,v6
v_lshrrev_b32 v243,1,v239
v_lshl_add_u32 v6,v243,12,v6
v_add_u32 v6,147456,v6
v_lshlrev_b32 v16,2,v1
v_lshlrev_b32 v21,3,v238
s_and_b32 s68,s47,15
s_lshl_b32 s56,s68,10
v_add_u32 v5,s56,v5
s_lshl_b32 s56,s68,15
v_add_u32 v7,s56,v7
s_lshl_b32 s69,s54,20
s_add_u32 s69,s69,20971520
s_lshl_b32 s87,s54,13
s_add_u32 s87,s87,10486272
s_lshl4_add_u32 s74,s68,s87
s_lshl2_add_u32 s74,s46,s74
s_lshl_b32 s68,s68,1
s_lshr_b32 s56,s46,1
s_add_u32 s68,s68,s56
s_mov_b32 s66,0
s_mov_b32 s67,0
s_mov_b32 s73,0x80000000
s_mov_b32 s75,0
s_mov_b32 s37,0
s_mov_b32 s42,4294966272
s_mov_b32 s43,4294967295
s_mov_b64 s[38:39],0
s_sub_u32 s36,s54,12
s_and_b32 s36,s36,3
s_mov_b32 s12,s40
s_mov_b32 s13,s41
s_mov_b32 s14,2097152
s_mov_b32 s15,0x20000
s_and_b32 s29,s46,1
s_mul_i32 s28,s29,12288
s_lshl_b32 s29,s29,11
s_and_b32 s56,s50,2048
s_lshl_b32 s56,s56,4
s_add_u32 s56,s56,65536
s_add_u32 s40,s56,s28
s_add_u32 s41,s56,s29
v_add_u32 v21,10487168,v21
v_mov_b32 v244,v21
s_and_b32 s56,s50,2048
s_add_u32 s56,s56,147456
v_lshlrev_b32 v23,5,v1
v_add_u32 v23,s56,v23
v_and_b32 v253,32,v0
v_lshrrev_b32 v245,2,v253
v_add_u32 v253,v253,v245
v_sub_u32 v253,v0,v253
v_add_u32 v253,8,v253
v_mov_b32 v254,0x80000000
s_mov_b32 s56,1408
v_writelane_b32 v254,s56,0
s_mov_b32 s56,256
v_writelane_b32 v254,s56,1
s_mov_b32 s56,1280
v_writelane_b32 v254,s56,2
v_mov_b32 v245,155648
s_lshl_b32 s56,s46,2
v_add_u32 v247,s56,v245
s_waitcnt vmcnt(0)
v_lshlrev_b32 v228,16,v224
v_and_b32 v229,0xffff0000,v224
v_lshlrev_b32 v230,16,v225
v_and_b32 v231,0xffff0000,v225
v_lshlrev_b32 v232,16,v226
v_and_b32 v233,0xffff0000,v226
v_lshlrev_b32 v234,16,v227
v_and_b32 v235,0xffff0000,v227
v_mul_f32 v255,v228,v228
v_fma_f32 v255,v229,v229,v255
v_fma_f32 v255,v230,v230,v255
v_fma_f32 v255,v231,v231,v255
v_fma_f32 v255,v232,v232,v255
v_fma_f32 v255,v233,v233,v255
v_fma_f32 v255,v234,v234,v255
v_fma_f32 v255,v235,v235,v255
s_nop 1
v_add_f32_dpp v255,v255,v255 row_ror:8 row_mask:0xf bank_mask:0xf
s_nop 1
v_add_f32_dpp v255,v255,v255 row_ror:4 row_mask:0xf bank_mask:0xf
s_nop 1
v_add_f32_dpp v255,v255,v255 row_ror:2 row_mask:0xf bank_mask:0xf
s_nop 1
v_add_f32_dpp v255,v255,v255 row_ror:1 row_mask:0xf bank_mask:0xf
v_mov_b32 v238,v255
s_nop 1
v_permlane16_swap_b32 v255,v238
v_add_f32 v255,v255,v238
v_mov_b32 v238,v255
s_nop 1
v_permlane32_swap_b32 v255,v238
v_add_f32 v255,v255,v238
v_sqrt_f32 v255,v255
v_sub_u32 v238,68,v1
v_cvt_f32_u32 v238,v238
v_log_f32 v238,v238
v_mov_b32 v239,0x3ff9999a
v_fmac_f32 v239,0x3e632166,v238
v_mul_f32 v255,v255,v239
v_or_b32 v255,0x80000000,v255
s_xor_b32 s34,s69,524288
buffer_load_dwordx4 v[160:163],v7,s[8:11],s34 offen
s_add_u32 s34,s34,4096
buffer_load_dwordx4 v[164:167],v7,s[8:11],s34 offen
s_add_u32 s34,s34,4096
buffer_load_dwordx4 v[168:171],v7,s[8:11],s34 offen
s_add_u32 s34,s34,4096
buffer_load_dwordx4 v[172:175],v7,s[8:11],s34 offen
s_add_u32 s34,s34,4096
buffer_load_dwordx4 v[176:179],v7,s[8:11],s34 offen
s_add_u32 s34,s34,4096
buffer_load_dwordx4 v[180:183],v7,s[8:11],s34 offen
s_add_u32 s34,s34,4096
buffer_load_dwordx4 v[184:187],v7,s[8:11],s34 offen
s_add_u32 s34,s34,4096
buffer_load_dwordx4 v[188:191],v7,s[8:11],s34 offen
s_xor_b32 s69,s69,524288
s_xor_b32 s34,s69,524288
buffer_load_dwordx4 v[160:163],v7,s[8:11],s34 offen
s_add_u32 s34,s34,4096
buffer_load_dwordx4 v[164:167],v7,s[8:11],s34 offen
s_add_u32 s34,s34,4096
buffer_load_dwordx4 v[168:171],v7,s[8:11],s34 offen
s_add_u32 s34,s34,4096
buffer_load_dwordx4 v[172:175],v7,s[8:11],s34 offen
s_add_u32 s34,s34,4096
buffer_load_dwordx4 v[176:179],v7,s[8:11],s34 offen
s_add_u32 s34,s34,4096
buffer_load_dwordx4 v[180:183],v7,s[8:11],s34 offen
s_add_u32 s34,s34,4096
buffer_load_dwordx4 v[184:187],v7,s[8:11],s34 offen
s_add_u32 s34,s34,4096
buffer_load_dwordx4 v[188:191],v7,s[8:11],s34 offen
s_xor_b32 s69,s69,524288
s_cmp_lt_u32 s54,2
s_cbranch_scc1 L_aa_74
s_sub_u32 s77,s54,2
s_mov_b32 s30,0
s_mov_b32 s86,1536
s_lshl_b32 s56,s77,5
s_add_u32 s56,s56,s68
s_mul_i32 s70,s56,24576
s_lshl_b32 s71,s56,12
s_lshl_b32 s59,s77,13
s_lshl2_add_u32 s59,s68,s59
s_add_u32 s59,s59,10485760
s_buffer_load_dword s32,s[8:11],s59
s_mov_b32 s33,1
s_add_u32 s70,s70,100663296
s_add_u32 s71,s71,41943040
v_mov_b32 v19,s59
s_branch L_aa_82
L_aa_88:
s_bitcmp1_b32 s46,0
s_cbranch_scc1 L_av_89
ds_read_b128 v[24:27],v4 offset:0
ds_read_b128 v[28:31],v4 offset:1024
s_min_u32 s56,s32,s33
s_cmp_lt_u32 s77,64
s_cselect_b32 s56,s56,0
s_cmp_eq_u32 s56,0
s_cselect_b32 s72,0x80000000,0
v_mov_b32 v248,s72
s_or_b32 s64,s70,s72
s_or_b32 s65,s71,s72
s_cmp_lt_u32 s30,s31
s_cselect_b32 s65,0x80000000,s65
s_add_u32 s64,s64,s28
s_add_u32 s65,s65,s29
s_xor_b32 s58,s67,s40
s_xor_b32 s57,s67,s41
s_add_u32 m0,s58,0
s_waitcnt lgkmcnt(1)
v_mfma_f32_16x16x32_bf16 v[160:163],v[24:27],a[0:3],0
buffer_load_dwordx4 v0,s[8:11],s64 offen offset:0 sc1 lds
v_mfma_f32_16x16x32_bf16 v[164:167],v[24:27],a[4:7],0
ds_read_b128 v[32:35],v4 offset:2048
v_lshlrev_b32 v88,16,v224
v_mfma_f32_16x16x32_bf16 v[168:171],v[24:27],a[8:11],0
ds_read_b128 v[36:39],v4 offset:3072
v_and_b32 v89,0xffff0000,v224
v_mfma_f32_16x16x32_bf16 v[172:175],v[24:27],a[12:15],0
ds_read_b128 v[40:43],v4 offset:8192
v_lshlrev_b32 v90,16,v225
v_mfma_f32_16x16x32_bf16 v[176:179],v[24:27],a[16:19],0
buffer_load_dwordx4 v0,s[8:11],s64 offen offset:1024 sc1 lds
v_mfma_f32_16x16x32_bf16 v[180:183],v[24:27],a[20:23],0
ds_read_b128 v[44:47],v4 offset:9216
v_and_b32 v91,0xffff0000,v225
v_mfma_f32_16x16x32_bf16 v[184:187],v[24:27],a[24:27],0
ds_read_b128 v[48:51],v4 offset:10240
s_waitcnt vmcnt(9)
v_mfma_f32_16x16x32_bf16 v[188:191],v[24:27],a[28:31],0
ds_read_b128 v[52:55],v4 offset:11264
v_mfma_f32_16x16x32_bf16 v[128:131],v[156:159],v[192:195],0
ds_write_b32 v247,v248
v_lshlrev_b32 v92,16,v226
s_waitcnt lgkmcnt(7)
v_mfma_f32_16x16x32_bf16 v[160:163],v[28:31],a[32:35],v[160:163]
buffer_load_dwordx4 v0,s[8:11],s64 offen offset:2048 sc1 lds
v_mfma_f32_16x16x32_bf16 v[164:167],v[28:31],a[36:39],v[164:167]
ds_read_b128 v[56:59],v4 offset:4096
s_waitcnt vmcnt(9)
v_mfma_f32_16x16x32_bf16 v[168:171],v[28:31],a[40:43],v[168:171]
ds_read_b128 v[60:63],v4 offset:5120
v_mfma_f32_16x16x32_bf16 v[128:131],v[156:159],v[196:199],v[128:131]
ds_read_b128 v[64:67],v4 offset:6144
v_and_b32 v93,0xffff0000,v226
v_mfma_f32_16x16x32_bf16 v[172:175],v[28:31],a[44:47],v[172:175]
ds_read_b128 v[68:71],v4 offset:7168
s_waitcnt vmcnt(8)
v_mfma_f32_16x16x32_bf16 v[176:179],v[28:31],a[48:51],v[176:179]
buffer_load_dwordx4 v0,s[8:11],s64 offen offset:3072 sc1 lds
v_mfma_f32_16x16x32_bf16 v[180:183],v[28:31],a[52:55],v[180:183]
ds_read_b128 v[72:75],v4 offset:12288
v_mfma_f32_16x16x32_bf16 v[128:131],v[156:159],v[200:203],v[128:131]
ds_read_b128 v[76:79],v4 offset:13312
v_lshlrev_b32 v94,16,v227
v_mfma_f32_16x16x32_bf16 v[184:187],v[28:31],a[56:59],v[184:187]
ds_read_b128 v[80:83],v4 offset:14336
s_waitcnt vmcnt(8)
v_mfma_f32_16x16x32_bf16 v[188:191],v[28:31],a[60:63],v[188:191]
ds_read_b128 v[84:87],v4 offset:15360
v_mfma_f32_16x16x32_bf16 v[128:131],v[156:159],v[204:207],v[128:131]
v_and_b32 v95,0xffff0000,v227
v_readfirstlane_b32 s22,v246
s_waitcnt lgkmcnt(14)
v_mfma_f32_16x16x32_bf16 v[160:163],v[32:35],a[64:67],v[160:163]
s_waitcnt vmcnt(7)
v_mfma_f32_16x16x32_bf16 v[132:135],v[156:159],v[208:211],0
s_add_u32 m0,s58,4096
s_add_u32 s64,s64,4096
s_cmp_eq_u32 s22,0
s_cbranch_scc1 L_ag_90
L_agb_91:
v_mfma_f32_16x16x32_bf16 v[164:167],v[32:35],a[68:71],v[164:167]
buffer_load_dwordx4 v0,s[8:11],s64 offen offset:0 sc1 lds
v_mfma_f32_16x16x32_bf16 v[168:171],v[32:35],a[72:75],v[168:171]
s_waitcnt vmcnt(7)
v_mfma_f32_16x16x32_bf16 v[132:135],v[156:159],v[212:215],v[132:135]
s_lshl_b32 s18,s26,5
s_add_u32 s18,s18,s68
s_lshl_b32 s19,s18,10
v_mfma_f32_16x16x32_bf16 v[172:175],v[32:35],a[76:79],v[172:175]
s_waitcnt vmcnt(6)
v_mfma_f32_16x16x32_bf16 v[132:135],v[156:159],v[216:219],v[132:135]
s_add_u32 s20,s19,6291456
s_lshl_b32 s23,s51,5
s_add_u32 s23,s23,s68
v_mfma_f32_16x16x32_bf16 v[176:179],v[32:35],a[80:83],v[176:179]
ds_write_b128 v6,v[128:131]
v_mfma_f32_16x16x32_bf16 v[180:183],v[32:35],a[84:87],v[180:183]
buffer_load_dwordx4 v0,s[8:11],s64 offen offset:1024 sc1 lds
v_mfma_f32_16x16x32_bf16 v[184:187],v[32:35],a[88:91],v[184:187]
s_waitcnt vmcnt(6)
v_mfma_f32_16x16x32_bf16 v[132:135],v[156:159],v[220:223],v[132:135]
s_lshl_b32 s24,s23,10
s_lshl_b32 s25,s51,10
s_add_u32 s25,s25,2883584
v_mfma_f32_16x16x32_bf16 v[188:191],v[32:35],a[92:95],v[188:191]
s_cmp_eq_u32 s23,s55
s_cselect_b32 s25,s25,s24
s_add_u32 s25,s25,8388608
s_waitcnt lgkmcnt(14)
v_mfma_f32_16x16x32_bf16 v[160:163],v[36:39],a[96:99],v[160:163]
s_mov_b32 s6,268435456
s_cmp_eq_u32 s31,0
s_cselect_b32 s25,s24,s25
s_cselect_b64 s[4:5],s[16:17],s[44:45]
s_cmov_b32 s6,2097152
v_mfma_f32_16x16x32_bf16 v[164:167],v[36:39],a[100:103],v[164:167]
ds_write_b128 v6,v[132:135] offset:2048
v_mfma_f32_16x16x32_bf16 v[168:171],v[36:39],a[104:107],v[168:171]
buffer_load_dwordx4 v0,s[8:11],s64 offen offset:2048 sc1 lds
v_mfma_f32_16x16x32_bf16 v[172:175],v[36:39],a[108:111],v[172:175]
buffer_load_dwordx4 v[224:227],v0,s[4:7],s25 offen sc1
v_mfma_f32_16x16x32_bf16 v[176:179],v[36:39],a[112:115],v[176:179]
s_lshr_b32 s24,s55,5
s_cmp_lt_u32 s51,s24
s_cselect_b32 s24,1,2
v_mfma_f32_16x16x32_bf16 v[180:183],v[36:39],a[116:119],v[180:183]
v_mov_b32 v252,s24
s_lshl2_add_u32 s25,s51,11018240
v_mfma_f32_16x16x32_bf16 v[184:187],v[36:39],a[120:123],v[184:187]
buffer_load_dwordx4 v0,s[8:11],s64 offen offset:3072 sc1 lds
v_mfma_f32_16x16x32_bf16 v[188:191],v[36:39],a[124:127],v[188:191]
s_waitcnt lgkmcnt(0)
s_barrier
s_lshl_b32 s24,s68,16
s_waitcnt lgkmcnt(14)
v_mfma_f32_16x16x32_bf16 v[160:163],v[40:43],a[128:131],v[160:163]
ds_read_b128 v[96:99],v23
s_add_u32 s24,s24,s31
v_mfma_f32_16x16x32_bf16 v[164:167],v[40:43],a[132:135],v[164:167]
ds_read_b128 v[100:103],v23 offset:16
s_add_u32 s24,s24,s86
v_mfma_f32_16x16x32_bf16 v[168:171],v[40:43],a[136:139],v[168:171]
ds_read_b128 v[248:251],v245
s_add_u32 m0,s58,8192
s_add_u32 s64,s64,4096
v_mfma_f32_16x16x32_bf16 v[172:175],v[40:43],a[140:143],v[172:175]
buffer_load_dwordx4 v0,s[8:11],s64 offen offset:0 sc1 lds
s_cmp_eq_u32 s24,1537
s_cselect_b32 s25,s25,0x80000000
v_mfma_f32_16x16x32_bf16 v[176:179],v[40:43],a[144:147],v[176:179]
buffer_store_dword v252,off,s[8:11],s25 sc1
s_bitcmp1_b64 s[38:39],s51
s_cselect_b32 s24,128,0
v_mfma_f32_16x16x32_bf16 v[180:183],v[40:43],a[148:151],v[180:183]
buffer_store_dword v20,off,s[8:11],s73 sc1
s_lshl_b32 s23,s51,13
v_mfma_f32_16x16x32_bf16 v[184:187],v[40:43],a[152:155],v[184:187]
s_lshl2_add_u32 s23,s68,s23
s_add_u32 s23,s23,10487168
s_add_u32 s23,s23,s24
s_mov_b32 s73,0x80000000
v_mfma_f32_16x16x32_bf16 v[188:191],v[40:43],a[156:159],v[188:191]
buffer_load_dwordx4 v0,s[8:11],s64 offen offset:1024 sc1 lds
v_mfma_f32_16x16x32_bf16 v[160:163],v[44:47],a[160:163],v[160:163]
buffer_load_dword v246,off,s[8:11],s23 sc1
v_lshrrev_b32 v244,4,v1
v_mfma_f32_16x16x32_bf16 v[164:167],v[44:47],a[164:167],v[164:167]
s_waitcnt lgkmcnt(0)
v_or3_b32 v248,v248,v249,v250
v_or_b32 v248,v248,v251
s_sub_u32 s23,s77,8
v_mfma_f32_16x16x32_bf16 v[168:171],v[44:47],a[168:171],v[168:171]
v_readfirstlane_b32 s72,v248
v_add_u32 v244,s23,v244
v_max_i32 v244,0,v244
v_mfma_f32_16x16x32_bf16 v[172:175],v[44:47],a[172:175],v[172:175]
buffer_load_dwordx4 v0,s[8:11],s64 offen offset:2048 sc1 lds
v_lshl_add_u32 v244,v244,13,v21
v_mfma_f32_16x16x32_bf16 v[176:179],v[44:47],a[176:179],v[176:179]
buffer_load_dwordx2 v[242:243],v244,s[8:11],0 offen sc1
s_waitcnt lgkmcnt(1)
v_mfma_f32_16x16x32_bf16 v[180:183],v[44:47],a[180:183],v[180:183]
v_cvt_pk_bf16_f32 v104,v96,v97
v_cvt_pk_bf16_f32 v105,v98,v99
v_cvt_pk_bf16_f32 v106,v100,v101
v_mfma_f32_16x16x32_bf16 v[184:187],v[44:47],a[184:187],v[184:187]
v_cvt_pk_bf16_f32 v107,v102,v103
v_lshlrev_b32 v96,16,v104
v_and_b32 v97,0xffff0000,v104
v_mfma_f32_16x16x32_bf16 v[188:191],v[44:47],a[188:191],v[188:191]
buffer_load_dwordx4 v0,s[8:11],s64 offen offset:3072 sc1 lds
v_lshlrev_b32 v98,16,v105
v_mfma_f32_16x16x32_bf16 v[160:163],v[48:51],a[192:195],v[160:163]
v_and_b32 v99,0xffff0000,v105
v_lshlrev_b32 v100,16,v106
v_and_b32 v101,0xffff0000,v106
v_mfma_f32_16x16x32_bf16 v[164:167],v[48:51],a[196:199],v[164:167]
v_lshlrev_b32 v102,16,v107
v_and_b32 v103,0xffff0000,v107
v_add_f32 v88,v88,v96
v_mfma_f32_16x16x32_bf16 v[168:171],v[48:51],a[200:203],v[168:171]
v_add_f32 v89,v89,v97
v_add_f32 v90,v90,v98
v_add_f32 v91,v91,v99
v_mfma_f32_16x16x32_bf16 v[172:175],v[48:51],a[204:207],v[172:175]
s_add_u32 m0,s57,24576
v_add_f32 v92,v92,v100
v_add_f32 v93,v93,v101
v_add_f32 v94,v94,v102
v_mfma_f32_16x16x32_bf16 v[176:179],v[48:51],a[208:211],v[176:179]
buffer_load_dwordx4 v0,s[8:11],s65 offen offset:0 sc1 lds
v_add_f32 v95,v95,v103
v_mfma_f32_16x16x32_bf16 v[180:183],v[48:51],a[212:215],v[180:183]
v_cvt_pk_bf16_f32 v104,v88,v89
v_cvt_pk_bf16_f32 v105,v90,v91
v_cvt_pk_bf16_f32 v106,v92,v93
v_mfma_f32_16x16x32_bf16 v[184:187],v[48:51],a[216:219],v[184:187]
v_cvt_pk_bf16_f32 v107,v94,v95
v_mfma_f32_16x16x32_bf16 v[188:191],v[48:51],a[220:223],v[188:191]
buffer_store_dwordx4 v[104:107],v0,s[8:11],s20 offen sc1
v_lshlrev_b32 v88,16,v104
v_mfma_f32_16x16x32_bf16 v[160:163],v[52:55],a[224:227],v[160:163]
buffer_load_dwordx4 v0,s[8:11],s65 offen offset:1024 sc1 lds
v_and_b32 v89,0xffff0000,v104
v_mfma_f32_16x16x32_bf16 v[164:167],v[52:55],a[228:231],v[164:167]
v_lshlrev_b32 v90,16,v105
v_and_b32 v91,0xffff0000,v105
v_lshlrev_b32 v92,16,v106
v_mfma_f32_16x16x32_bf16 v[168:171],v[52:55],a[232:235],v[168:171]
v_and_b32 v93,0xffff0000,v106
v_lshlrev_b32 v94,16,v107
v_and_b32 v95,0xffff0000,v107
v_mfma_f32_16x16x32_bf16 v[172:175],v[52:55],a[236:239],v[172:175]
v_readfirstlane_b32 s78,v88
v_mfma_f32_16x16x32_bf16 v[176:179],v[52:55],a[240:243],v[176:179]
s_nop 0
v_add_f32 v120,v88,-s78
v_add_f32 v121,v89,-s78
v_add_f32 v122,v90,-s78
v_mfma_f32_16x16x32_bf16 v[180:183],v[52:55],a[244:247],v[180:183]
v_add_f32 v123,v91,-s78
v_add_f32 v124,v92,-s78
v_add_f32 v125,v93,-s78
v_mfma_f32_16x16x32_bf16 v[184:187],v[52:55],a[248:251],v[184:187]
v_add_f32 v126,v94,-s78
v_add_f32 v127,v95,-s78
v_add_f32 v128,v120,v122
v_mfma_f32_16x16x32_bf16 v[188:191],v[52:55],a[252:255],v[188:191]
v_add_f32 v129,v121,v123
v_mul_f32 v130,v120,v120
v_mul_f32 v131,v121,v121
v_mfma_f32_16x16x32_bf16 v[192:195],v[56:59],a[0:3],0
v_add_f32 v132,v124,v126
v_add_f32 v133,v125,v127
v_fma_f32 v130,v122,v122,v130
v_mfma_f32_16x16x32_bf16 v[196:199],v[56:59],a[4:7],0
v_fma_f32 v131,v123,v123,v131
v_add_f32 v128,v128,v132
v_add_f32 v129,v129,v133
v_mfma_f32_16x16x32_bf16 v[200:203],v[56:59],a[8:11],0
v_fma_f32 v130,v124,v124,v130
v_fma_f32 v131,v125,v125,v131
v_add_f32 v128,v128,v129
v_mfma_f32_16x16x32_bf16 v[204:207],v[56:59],a[12:15],0
v_fma_f32 v130,v126,v126,v130
v_fma_f32 v131,v127,v127,v131
v_add_f32 v130,v130,v131
v_mfma_f32_16x16x32_bf16 v[208:211],v[56:59],a[16:19],0
s_nop 0
v_permlane32_swap_b32 v128,v130
v_add_f32 v128,v128,v130
v_cvt_pk_bf16_f32 v24,v160,v164
v_mfma_f32_16x16x32_bf16 v[212:215],v[56:59],a[20:23],0
v_add_f32_dpp v128,v128,v128 row_ror:8 row_mask:0xf bank_mask:0xf
v_cvt_pk_bf16_f32 v25,v168,v172
v_cvt_pk_bf16_f32 v26,v176,v180
v_mfma_f32_16x16x32_bf16 v[216:219],v[56:59],a[24:27],0
v_add_f32_dpp v128,v128,v128 row_ror:4 row_mask:0xf bank_mask:0xf
v_cvt_pk_bf16_f32 v27,v184,v188
v_cvt_pk_bf16_f32 v28,v161,v165
v_mfma_f32_16x16x32_bf16 v[220:223],v[56:59],a[28:31],0
v_add_f32_dpp v128,v128,v128 row_ror:2 row_mask:0xf bank_mask:0xf
v_cvt_pk_bf16_f32 v29,v169,v173
v_cvt_pk_bf16_f32 v30,v177,v181
v_mfma_f32_16x16x32_bf16 v[192:195],v[60:63],a[32:35],v[192:195]
v_add_f32_dpp v128,v128,v128 row_ror:1 row_mask:0xf bank_mask:0xf
v_mov_b32 v130,v128
v_cvt_pk_bf16_f32 v31,v185,v189
v_mfma_f32_16x16x32_bf16 v[196:199],v[60:63],a[36:39],v[196:199]
v_permlane16_swap_b32 v128,v130
v_add_f32 v128,v128,v130
v_mul_f32 v128,0x3b000000,v128
v_mfma_f32_16x16x32_bf16 v[200:203],v[60:63],a[40:43],v[200:203]
v_mov_b32 v130,v128
v_cvt_pk_bf16_f32 v32,v162,v166
v_cvt_pk_bf16_f32 v33,v170,v174
v_mfma_f32_16x16x32_bf16 v[204:207],v[60:63],a[44:47],v[204:207]
v_permlane32_swap_b32 v128,v130
v_fma_f32 v130,-v128,v128,v130
v_add_f32 v128,s78,v128
v_mfma_f32_16x16x32_bf16 v[208:211],v[60:63],a[48:51],v[208:211]
v_max_f32 v130,0,v130
v_cvt_pk_bf16_f32 v130,v128,v130
v_lshlrev_b32 v128,16,v130
v_mfma_f32_16x16x32_bf16 v[212:215],v[60:63],a[52:55],v[212:215]
v_and_b32 v130,0xffff0000,v130
v_add_f32 v130,0x3727c5ac,v130
v_cvt_pk_bf16_f32 v130,v130,v130
v_mfma_f32_16x16x32_bf16 v[216:219],v[60:63],a[56:59],v[216:219]
v_and_b32 v130,0xffff0000,v130
v_sqrt_f32 v130,v130
v_add_f32 v120,v88,-v128
v_mfma_f32_16x16x32_bf16 v[220:223],v[60:63],a[60:63],v[220:223]
v_add_f32 v121,v89,-v128
v_add_f32 v122,v90,-v128
v_add_f32 v123,v91,-v128
v_mfma_f32_16x16x32_bf16 v[192:195],v[64:67],a[64:67],v[192:195]
v_add_f32 v124,v92,-v128
v_add_f32 v125,v93,-v128
v_add_f32 v126,v94,-v128
v_mfma_f32_16x16x32_bf16 v[196:199],v[64:67],a[68:71],v[196:199]
v_add_f32 v127,v95,-v128
v_cvt_pk_bf16_f32 v130,v130,v130
v_and_b32 v130,0xffff0000,v130
v_mfma_f32_16x16x32_bf16 v[200:203],v[64:67],a[72:75],v[200:203]
v_rcp_f32 v130,v130
v_cvt_pk_bf16_f32 v108,v120,v121
v_cvt_pk_bf16_f32 v109,v122,v123
v_mfma_f32_16x16x32_bf16 v[204:207],v[64:67],a[76:79],v[204:207]
v_cvt_pk_bf16_f32 v110,v124,v125
v_cvt_pk_bf16_f32 v111,v126,v127
v_lshlrev_b32 v120,16,v108
v_mfma_f32_16x16x32_bf16 v[208:211],v[64:67],a[80:83],v[208:211]
v_cvt_pk_bf16_f32 v34,v178,v182
v_cvt_pk_bf16_f32 v35,v186,v190
v_cvt_pk_bf16_f32 v36,v163,v167
v_mfma_f32_16x16x32_bf16 v[212:215],v[64:67],a[84:87],v[212:215]
v_cvt_pk_bf16_f32 v37,v171,v175
v_cvt_pk_bf16_f32 v38,v179,v183
v_cvt_pk_bf16_f32 v39,v187,v191
v_mfma_f32_16x16x32_bf16 v[216:219],v[64:67],a[88:91],v[216:219]
v_and_b32 v121,0xffff0000,v108
v_lshlrev_b32 v122,16,v109
v_and_b32 v123,0xffff0000,v109
v_mfma_f32_16x16x32_bf16 v[220:223],v[64:67],a[92:95],v[220:223]
v_lshlrev_b32 v124,16,v110
v_and_b32 v125,0xffff0000,v110
v_lshlrev_b32 v126,16,v111
v_mfma_f32_16x16x32_bf16 v[192:195],v[68:71],a[96:99],v[192:195]
v_and_b32 v127,0xffff0000,v111
v_mul_f32 v120,v120,v130
v_mul_f32 v121,v121,v130
v_mfma_f32_16x16x32_bf16 v[196:199],v[68:71],a[100:103],v[196:199]
v_mul_f32 v122,v122,v130
v_mul_f32 v123,v123,v130
v_mul_f32 v124,v124,v130
v_mfma_f32_16x16x32_bf16 v[200:203],v[68:71],a[104:107],v[200:203]
v_mul_f32 v125,v125,v130
v_mul_f32 v126,v126,v130
v_mul_f32 v127,v127,v130
v_mfma_f32_16x16x32_bf16 v[204:207],v[68:71],a[108:111],v[204:207]
v_cvt_pk_bf16_f32 v108,v120,v121
v_cvt_pk_bf16_f32 v109,v122,v123
v_cvt_pk_bf16_f32 v110,v124,v125
v_mfma_f32_16x16x32_bf16 v[208:211],v[68:71],a[112:115],v[208:211]
s_add_u32 s62,s69,0
v_cvt_pk_bf16_f32 v111,v126,v127
v_lshlrev_b32 v112,16,v108
v_and_b32 v113,0xffff0000,v108
v_mfma_f32_16x16x32_bf16 v[212:215],v[68:71],a[116:119],v[212:215]
buffer_store_dwordx4 v[24:27],v5,s[8:11],s62 offen
v_lshlrev_b32 v114,16,v109
v_mfma_f32_16x16x32_bf16 v[216:219],v[68:71],a[120:123],v[216:219]
v_and_b32 v115,0xffff0000,v109
v_lshlrev_b32 v116,16,v110
v_and_b32 v117,0xffff0000,v110
v_mfma_f32_16x16x32_bf16 v[220:223],v[68:71],a[124:127],v[220:223]
v_lshlrev_b32 v118,16,v111
v_and_b32 v119,0xffff0000,v111
v_add_f32 v88,v88,v112
v_mfma_f32_16x16x32_bf16 v[192:195],v[72:75],a[128:131],v[192:195]
s_add_u32 s62,s69,16384
v_add_f32 v89,v89,v113
v_add_f32 v90,v90,v114
v_add_f32 v91,v91,v115
v_mfma_f32_16x16x32_bf16 v[196:199],v[72:75],a[132:135],v[196:199]
buffer_store_dwordx4 v[28:31],v5,s[8:11],s62 offen
v_add_f32 v92,v92,v116
v_mfma_f32_16x16x32_bf16 v[200:203],v[72:75],a[136:139],v[200:203]
v_add_f32 v93,v93,v117
v_add_f32 v94,v94,v118
v_add_f32 v95,v95,v119
v_mfma_f32_16x16x32_bf16 v[204:207],v[72:75],a[140:143],v[204:207]
v_cvt_pk_bf16_f32 v96,v88,v89
v_cvt_pk_bf16_f32 v97,v90,v91
v_cvt_pk_bf16_f32 v98,v92,v93
v_mfma_f32_16x16x32_bf16 v[208:211],v[72:75],a[144:147],v[208:211]
s_add_u32 s62,s69,32768
v_cvt_pk_bf16_f32 v99,v94,v95
v_mfma_f32_16x16x32_bf16 v[212:215],v[72:75],a[148:151],v[212:215]
buffer_store_dwordx4 v[32:35],v5,s[8:11],s62 offen
v_mfma_f32_16x16x32_bf16 v[216:219],v[72:75],a[152:155],v[216:219]
buffer_store_dwordx4 v[96:99],v0,s[12:15],s19 offen sc1
v_mul_f32 v236,v112,v228
v_mfma_f32_16x16x32_bf16 v[220:223],v[72:75],a[156:159],v[220:223]
v_mul_f32 v237,v113,v229
v_fma_f32 v236,v114,v230,v236
v_fma_f32 v237,v115,v231,v237
v_mfma_f32_16x16x32_bf16 v[192:195],v[76:79],a[160:163],v[192:195]
s_add_u32 s62,s69,49152
v_fma_f32 v236,v116,v232,v236
v_fma_f32 v237,v117,v233,v237
v_fma_f32 v236,v118,v234,v236
v_mfma_f32_16x16x32_bf16 v[196:199],v[76:79],a[164:167],v[196:199]
buffer_store_dwordx4 v[36:39],v5,s[8:11],s62 offen
v_fma_f32 v237,v119,v235,v237
v_mfma_f32_16x16x32_bf16 v[200:203],v[76:79],a[168:171],v[200:203]
v_add_f32 v236,v236,v237
v_mfma_f32_16x16x32_bf16 v[204:207],v[76:79],a[172:175],v[204:207]
s_nop 0
v_add_f32_dpp v236,v236,v236 row_ror:8 row_mask:0xf bank_mask:0xf
v_mfma_f32_16x16x32_bf16 v[208:211],v[76:79],a[176:179],v[208:211]
s_nop 0
v_add_f32_dpp v236,v236,v236 row_ror:4 row_mask:0xf bank_mask:0xf
v_mfma_f32_16x16x32_bf16 v[212:215],v[76:79],a[180:183],v[212:215]
s_nop 0
v_add_f32_dpp v236,v236,v236 row_ror:2 row_mask:0xf bank_mask:0xf
v_mfma_f32_16x16x32_bf16 v[216:219],v[76:79],a[184:187],v[216:219]
s_nop 0
v_add_f32_dpp v236,v236,v236 row_ror:1 row_mask:0xf bank_mask:0xf
v_mov_b32 v237,v236
v_mfma_f32_16x16x32_bf16 v[220:223],v[76:79],a[188:191],v[220:223]
s_nop 0
v_permlane16_swap_b32 v236,v237
v_add_f32 v236,v236,v237
v_mov_b32 v237,v236
v_mfma_f32_16x16x32_bf16 v[192:195],v[80:83],a[192:195],v[192:195]
s_nop 0
v_permlane32_swap_b32 v236,v237
v_add_f32 v236,v236,v237
v_cvt_pk_bf16_f32 v236,v236,v236
v_mfma_f32_16x16x32_bf16 v[196:199],v[80:83],a[196:199],v[196:199]
v_and_b32 v236,0xffff0000,v236
v_ashrrev_i32 v237,31,v236
v_or_b32 v237,0x80000000,v237
v_mfma_f32_16x16x32_bf16 v[192:195],v[84:87],a[224:227],v[192:195]
v_xor_b32 v236,v236,v237
v_and_b32 v236,0xffff0000,v236
s_sub_u32 s20,4095,s18
v_mfma_f32_16x16x32_bf16 v[196:199],v[84:87],a[228:231],v[196:199]
v_or_b32 v20,s20,v236
s_lshl_b32 s73,s26,13
s_lshl2_add_u32 s73,s68,s73
v_mfma_f32_16x16x32_bf16 v[200:203],v[80:83],a[200:203],v[200:203]
s_add_u32 s73,s73,10485760
s_add_u32 s73,s73,s86
v_mfma_f32_16x16x32_bf16 v[204:207],v[80:83],a[204:207],v[204:207]
v_cvt_pk_bf16_f32 v40,v192,v196
v_cvt_pk_bf16_f32 v44,v193,v197
v_cvt_pk_bf16_f32 v48,v194,v198
v_mfma_f32_16x16x32_bf16 v[200:203],v[84:87],a[232:235],v[200:203]
v_cvt_pk_bf16_f32 v52,v195,v199
v_mfma_f32_16x16x32_bf16 v[204:207],v[84:87],a[236:239],v[204:207]
v_mfma_f32_16x16x32_bf16 v[208:211],v[80:83],a[208:211],v[208:211]
v_mfma_f32_16x16x32_bf16 v[212:215],v[80:83],a[212:215],v[212:215]
v_mfma_f32_16x16x32_bf16 v[208:211],v[84:87],a[240:243],v[208:211]
v_mfma_f32_16x16x32_bf16 v[212:215],v[84:87],a[244:247],v[212:215]
v_cvt_pk_bf16_f32 v41,v200,v204
v_cvt_pk_bf16_f32 v45,v201,v205
v_cvt_pk_bf16_f32 v49,v202,v206
v_mfma_f32_16x16x32_bf16 v[216:219],v[80:83],a[216:219],v[216:219]
v_cvt_pk_bf16_f32 v53,v203,v207
v_mfma_f32_16x16x32_bf16 v[220:223],v[80:83],a[220:223],v[220:223]
v_cvt_pk_bf16_f32 v42,v208,v212
v_cvt_pk_bf16_f32 v46,v209,v213
v_cvt_pk_bf16_f32 v50,v210,v214
v_mfma_f32_16x16x32_bf16 v[216:219],v[84:87],a[248:251],v[216:219]
v_cvt_pk_bf16_f32 v54,v211,v215
v_mfma_f32_16x16x32_bf16 v[220:223],v[84:87],a[252:255],v[220:223]
s_nop 7
v_cvt_pk_bf16_f32 v43,v216,v220
s_add_u32 s62,s69,262144
buffer_store_dwordx4 v[40:43],v5,s[8:11],s62 offen
v_cvt_pk_bf16_f32 v47,v217,v221
s_add_u32 s62,s69,278528
buffer_store_dwordx4 v[44:47],v5,s[8:11],s62 offen
v_cvt_pk_bf16_f32 v51,v218,v222
s_add_u32 s62,s69,294912
buffer_store_dwordx4 v[48:51],v5,s[8:11],s62 offen
v_cvt_pk_bf16_f32 v55,v219,v223
s_add_u32 s62,s69,311296
buffer_store_dwordx4 v[52:55],v5,s[8:11],s62 offen
s_cmp_lg_u32 s72,0
s_cbranch_scc1 L_aa_77
s_waitcnt vmcnt(9)
s_branch L_aa_87
L_av_89:
ds_read_b128 v[24:27],v4 offset:0
ds_read_b128 v[28:31],v4 offset:1024
s_min_u32 s56,s32,s33
s_cmp_lt_u32 s77,64
s_cselect_b32 s56,s56,0
s_cmp_eq_u32 s56,0
s_cselect_b32 s72,0x80000000,0
v_mov_b32 v248,s72
s_or_b32 s64,s70,s72
s_or_b32 s65,s71,s72
s_cmp_lt_u32 s30,s31
s_cselect_b32 s65,0x80000000,s65
s_add_u32 s64,s64,s28
s_add_u32 s65,s65,s29
s_xor_b32 s58,s67,s40
s_xor_b32 s57,s67,s41
s_add_u32 m0,s58,0
s_waitcnt lgkmcnt(1)
v_mfma_f32_16x16x32_bf16 v[160:163],v[24:27],a[0:3],0
buffer_load_dwordx4 v0,s[8:11],s64 offen offset:0 sc1 lds
v_mfma_f32_16x16x32_bf16 v[164:167],v[24:27],a[4:7],0
ds_read_b128 v[32:35],v4 offset:2048
s_lshl_b32 s23,s51,5
v_mfma_f32_16x16x32_bf16 v[168:171],v[24:27],a[8:11],0
ds_read_b128 v[36:39],v4 offset:3072
s_add_u32 s23,s23,s68
v_mfma_f32_16x16x32_bf16 v[172:175],v[24:27],a[12:15],0
ds_read_b128 v[40:43],v4 offset:8192
s_lshl_b32 s24,s23,10
v_mfma_f32_16x16x32_bf16 v[176:179],v[24:27],a[16:19],0
buffer_load_dwordx4 v0,s[8:11],s64 offen offset:1024 sc1 lds
v_mfma_f32_16x16x32_bf16 v[180:183],v[24:27],a[20:23],0
ds_read_b128 v[44:47],v4 offset:9216
s_lshl_b32 s25,s51,10
v_mfma_f32_16x16x32_bf16 v[184:187],v[24:27],a[24:27],0
ds_read_b128 v[48:51],v4 offset:10240
s_waitcnt vmcnt(9)
v_mfma_f32_16x16x32_bf16 v[188:191],v[24:27],a[28:31],0
ds_read_b128 v[52:55],v4 offset:11264
v_mfma_f32_16x16x32_bf16 v[128:131],v[156:159],v[192:195],0
ds_write_b32 v247,v248
s_add_u32 s25,s25,2883584
s_waitcnt lgkmcnt(7)
v_mfma_f32_16x16x32_bf16 v[160:163],v[28:31],a[32:35],v[160:163]
buffer_load_dwordx4 v0,s[8:11],s64 offen offset:2048 sc1 lds
v_mfma_f32_16x16x32_bf16 v[164:167],v[28:31],a[36:39],v[164:167]
ds_read_b128 v[56:59],v4 offset:4096
s_waitcnt vmcnt(9)
v_mfma_f32_16x16x32_bf16 v[168:171],v[28:31],a[40:43],v[168:171]
ds_read_b128 v[60:63],v4 offset:5120
v_mfma_f32_16x16x32_bf16 v[128:131],v[156:159],v[196:199],v[128:131]
ds_read_b128 v[64:67],v4 offset:6144
s_cmp_eq_u32 s23,s55
s_cselect_b32 s25,s25,s24
v_mfma_f32_16x16x32_bf16 v[172:175],v[28:31],a[44:47],v[172:175]
ds_read_b128 v[68:71],v4 offset:7168
s_waitcnt vmcnt(8)
v_mfma_f32_16x16x32_bf16 v[176:179],v[28:31],a[48:51],v[176:179]
buffer_load_dwordx4 v0,s[8:11],s64 offen offset:3072 sc1 lds
v_mfma_f32_16x16x32_bf16 v[180:183],v[28:31],a[52:55],v[180:183]
ds_read_b128 v[72:75],v4 offset:12288
v_mfma_f32_16x16x32_bf16 v[128:131],v[156:159],v[200:203],v[128:131]
ds_read_b128 v[76:79],v4 offset:13312
s_add_u32 s25,s25,8388608
v_mfma_f32_16x16x32_bf16 v[184:187],v[28:31],a[56:59],v[184:187]
ds_read_b128 v[80:83],v4 offset:14336
s_waitcnt vmcnt(8)
v_mfma_f32_16x16x32_bf16 v[188:191],v[28:31],a[60:63],v[188:191]
ds_read_b128 v[84:87],v4 offset:15360
v_mfma_f32_16x16x32_bf16 v[128:131],v[156:159],v[204:207],v[128:131]
s_mov_b32 s6,268435456
s_cmp_eq_u32 s31,0
s_cselect_b32 s25,s24,s25
s_cselect_b64 s[4:5],s[16:17],s[44:45]
s_cmov_b32 s6,2097152
s_waitcnt lgkmcnt(14)
v_mfma_f32_16x16x32_bf16 v[160:163],v[32:35],a[64:67],v[160:163]
buffer_load_dwordx4 v[224:227],v0,s[4:7],s25 offen sc1
v_mfma_f32_16x16x32_bf16 v[164:167],v[32:35],a[68:71],v[164:167]
s_waitcnt vmcnt(8)
v_mfma_f32_16x16x32_bf16 v[132:135],v[156:159],v[208:211],0
s_add_u32 m0,s58,4096
s_add_u32 s64,s64,4096
s_lshr_b32 s24,s55,5
v_mfma_f32_16x16x32_bf16 v[168:171],v[32:35],a[72:75],v[168:171]
buffer_load_dwordx4 v0,s[8:11],s64 offen offset:0 sc1 lds
v_mfma_f32_16x16x32_bf16 v[172:175],v[32:35],a[76:79],v[172:175]
s_waitcnt vmcnt(8)
v_mfma_f32_16x16x32_bf16 v[132:135],v[156:159],v[212:215],v[132:135]
s_cmp_lt_u32 s51,s24
s_cselect_b32 s24,1,2
v_mov_b32 v252,s24
v_mfma_f32_16x16x32_bf16 v[176:179],v[32:35],a[80:83],v[176:179]
s_waitcnt vmcnt(7)
v_mfma_f32_16x16x32_bf16 v[132:135],v[156:159],v[216:219],v[132:135]
s_lshl2_add_u32 s25,s51,11018240
s_lshl_b32 s24,s68,16
s_add_u32 s24,s24,s31
v_mfma_f32_16x16x32_bf16 v[180:183],v[32:35],a[84:87],v[180:183]
ds_write_b128 v6,v[128:131]
v_mfma_f32_16x16x32_bf16 v[184:187],v[32:35],a[88:91],v[184:187]
buffer_load_dwordx4 v0,s[8:11],s64 offen offset:1024 sc1 lds
v_mfma_f32_16x16x32_bf16 v[188:191],v[32:35],a[92:95],v[188:191]
s_waitcnt vmcnt(7)
v_mfma_f32_16x16x32_bf16 v[132:135],v[156:159],v[220:223],v[132:135]
s_add_u32 s24,s24,s86
s_cmp_eq_u32 s24,1537
s_cselect_b32 s25,s25,0x80000000
s_waitcnt lgkmcnt(14)
v_mfma_f32_16x16x32_bf16 v[160:163],v[36:39],a[96:99],v[160:163]
buffer_store_dword v252,off,s[8:11],s25 sc1
v_mfma_f32_16x16x32_bf16 v[164:167],v[36:39],a[100:103],v[164:167]
s_bitcmp1_b64 s[38:39],s51
s_cselect_b32 s24,128,0
s_lshl_b32 s23,s51,13
v_mfma_f32_16x16x32_bf16 v[168:171],v[36:39],a[104:107],v[168:171]
ds_write_b128 v6,v[132:135] offset:2048
v_mfma_f32_16x16x32_bf16 v[172:175],v[36:39],a[108:111],v[172:175]
buffer_load_dwordx4 v0,s[8:11],s64 offen offset:2048 sc1 lds
v_mfma_f32_16x16x32_bf16 v[176:179],v[36:39],a[112:115],v[176:179]
s_lshl2_add_u32 s23,s68,s23
s_add_u32 s23,s23,10487168
s_add_u32 s23,s23,s24
v_mfma_f32_16x16x32_bf16 v[180:183],v[36:39],a[116:119],v[180:183]
buffer_load_dword v246,off,s[8:11],s23 sc1
v_mfma_f32_16x16x32_bf16 v[184:187],v[36:39],a[120:123],v[184:187]
v_lshrrev_b32 v244,4,v1
s_sub_u32 s23,s77,8
v_mfma_f32_16x16x32_bf16 v[188:191],v[36:39],a[124:127],v[188:191]
buffer_load_dwordx4 v0,s[8:11],s64 offen offset:3072 sc1 lds
s_waitcnt lgkmcnt(14)
v_mfma_f32_16x16x32_bf16 v[160:163],v[40:43],a[128:131],v[160:163]
s_waitcnt lgkmcnt(0)
s_barrier
v_add_u32 v244,s23,v244
v_mfma_f32_16x16x32_bf16 v[164:167],v[40:43],a[132:135],v[164:167]
ds_read_b128 v[248:251],v245
v_max_i32 v244,0,v244
v_mfma_f32_16x16x32_bf16 v[168:171],v[40:43],a[136:139],v[168:171]
buffer_store_dword v20,off,s[8:11],s73 sc1
v_mfma_f32_16x16x32_bf16 v[172:175],v[40:43],a[140:143],v[172:175]
s_add_u32 m0,s58,8192
s_add_u32 s64,s64,4096
v_lshl_add_u32 v244,v244,13,v21
v_mfma_f32_16x16x32_bf16 v[176:179],v[40:43],a[144:147],v[176:179]
buffer_load_dwordx4 v0,s[8:11],s64 offen offset:0 sc1 lds
v_mfma_f32_16x16x32_bf16 v[180:183],v[40:43],a[148:151],v[180:183]
buffer_load_dwordx2 v[242:243],v244,s[8:11],0 offen sc1
v_mfma_f32_16x16x32_bf16 v[184:187],v[40:43],a[152:155],v[184:187]
s_mov_b32 s73,0x80000000
v_mfma_f32_16x16x32_bf16 v[188:191],v[40:43],a[156:159],v[188:191]
s_waitcnt lgkmcnt(0)
v_or3_b32 v248,v248,v249,v250
v_or_b32 v248,v248,v251
v_mfma_f32_16x16x32_bf16 v[160:163],v[44:47],a[160:163],v[160:163]
buffer_load_dwordx4 v0,s[8:11],s64 offen offset:1024 sc1 lds
v_mfma_f32_16x16x32_bf16 v[164:167],v[44:47],a[164:167],v[164:167]
v_mfma_f32_16x16x32_bf16 v[168:171],v[44:47],a[168:171],v[168:171]
v_readfirstlane_b32 s72,v248
v_mfma_f32_16x16x32_bf16 v[172:175],v[44:47],a[172:175],v[172:175]
v_mfma_f32_16x16x32_bf16 v[176:179],v[44:47],a[176:179],v[176:179]
buffer_load_dwordx4 v0,s[8:11],s64 offen offset:2048 sc1 lds
v_mfma_f32_16x16x32_bf16 v[180:183],v[44:47],a[180:183],v[180:183]
v_mfma_f32_16x16x32_bf16 v[184:187],v[44:47],a[184:187],v[184:187]
v_mfma_f32_16x16x32_bf16 v[188:191],v[44:47],a[188:191],v[188:191]
v_mfma_f32_16x16x32_bf16 v[160:163],v[48:51],a[192:195],v[160:163]
buffer_load_dwordx4 v0,s[8:11],s64 offen offset:3072 sc1 lds
v_mfma_f32_16x16x32_bf16 v[164:167],v[48:51],a[196:199],v[164:167]
v_mfma_f32_16x16x32_bf16 v[168:171],v[48:51],a[200:203],v[168:171]
v_mfma_f32_16x16x32_bf16 v[172:175],v[48:51],a[204:207],v[172:175]
v_mfma_f32_16x16x32_bf16 v[176:179],v[48:51],a[208:211],v[176:179]
s_add_u32 m0,s57,24576
v_mfma_f32_16x16x32_bf16 v[180:183],v[48:51],a[212:215],v[180:183]
buffer_load_dwordx4 v0,s[8:11],s65 offen offset:0 sc1 lds
v_mfma_f32_16x16x32_bf16 v[184:187],v[48:51],a[216:219],v[184:187]
v_mfma_f32_16x16x32_bf16 v[188:191],v[48:51],a[220:223],v[188:191]
v_mfma_f32_16x16x32_bf16 v[160:163],v[52:55],a[224:227],v[160:163]
v_mfma_f32_16x16x32_bf16 v[164:167],v[52:55],a[228:231],v[164:167]
buffer_load_dwordx4 v0,s[8:11],s65 offen offset:1024 sc1 lds
v_mfma_f32_16x16x32_bf16 v[168:171],v[52:55],a[232:235],v[168:171]
v_mfma_f32_16x16x32_bf16 v[172:175],v[52:55],a[236:239],v[172:175]
v_mfma_f32_16x16x32_bf16 v[176:179],v[52:55],a[240:243],v[176:179]
v_mfma_f32_16x16x32_bf16 v[180:183],v[52:55],a[244:247],v[180:183]
v_mfma_f32_16x16x32_bf16 v[184:187],v[52:55],a[248:251],v[184:187]
v_mfma_f32_16x16x32_bf16 v[188:191],v[52:55],a[252:255],v[188:191]
v_mfma_f32_16x16x32_bf16 v[192:195],v[56:59],a[0:3],0
v_mfma_f32_16x16x32_bf16 v[196:199],v[56:59],a[4:7],0
v_mfma_f32_16x16x32_bf16 v[200:203],v[56:59],a[8:11],0
v_cvt_pk_bf16_f32 v24,v160,v164
v_cvt_pk_bf16_f32 v25,v168,v172
v_mfma_f32_16x16x32_bf16 v[204:207],v[56:59],a[12:15],0
v_cvt_pk_bf16_f32 v26,v176,v180
v_cvt_pk_bf16_f32 v27,v184,v188
v_mfma_f32_16x16x32_bf16 v[208:211],v[56:59],a[16:19],0
v_cvt_pk_bf16_f32 v28,v161,v165
v_cvt_pk_bf16_f32 v29,v169,v173
v_mfma_f32_16x16x32_bf16 v[212:215],v[56:59],a[20:23],0
v_cvt_pk_bf16_f32 v30,v177,v181
v_cvt_pk_bf16_f32 v31,v185,v189
v_mfma_f32_16x16x32_bf16 v[216:219],v[56:59],a[24:27],0
v_cvt_pk_bf16_f32 v32,v162,v166
v_cvt_pk_bf16_f32 v33,v170,v174
v_mfma_f32_16x16x32_bf16 v[220:223],v[56:59],a[28:31],0
v_cvt_pk_bf16_f32 v34,v178,v182
v_cvt_pk_bf16_f32 v35,v186,v190
v_mfma_f32_16x16x32_bf16 v[192:195],v[60:63],a[32:35],v[192:195]
v_cvt_pk_bf16_f32 v36,v163,v167
v_cvt_pk_bf16_f32 v37,v171,v175
v_mfma_f32_16x16x32_bf16 v[196:199],v[60:63],a[36:39],v[196:199]
v_cvt_pk_bf16_f32 v38,v179,v183
v_cvt_pk_bf16_f32 v39,v187,v191
v_mfma_f32_16x16x32_bf16 v[200:203],v[60:63],a[40:43],v[200:203]
v_mfma_f32_16x16x32_bf16 v[204:207],v[60:63],a[44:47],v[204:207]
v_mfma_f32_16x16x32_bf16 v[208:211],v[60:63],a[48:51],v[208:211]
v_mfma_f32_16x16x32_bf16 v[212:215],v[60:63],a[52:55],v[212:215]
v_mfma_f32_16x16x32_bf16 v[216:219],v[60:63],a[56:59],v[216:219]
v_mfma_f32_16x16x32_bf16 v[220:223],v[60:63],a[60:63],v[220:223]
v_mfma_f32_16x16x32_bf16 v[192:195],v[64:67],a[64:67],v[192:195]
v_mfma_f32_16x16x32_bf16 v[196:199],v[64:67],a[68:71],v[196:199]
v_mfma_f32_16x16x32_bf16 v[200:203],v[64:67],a[72:75],v[200:203]
v_mfma_f32_16x16x32_bf16 v[204:207],v[64:67],a[76:79],v[204:207]
v_mfma_f32_16x16x32_bf16 v[208:211],v[64:67],a[80:83],v[208:211]
v_mfma_f32_16x16x32_bf16 v[212:215],v[64:67],a[84:87],v[212:215]
v_mfma_f32_16x16x32_bf16 v[216:219],v[64:67],a[88:91],v[216:219]
v_mfma_f32_16x16x32_bf16 v[220:223],v[64:67],a[92:95],v[220:223]
v_mfma_f32_16x16x32_bf16 v[192:195],v[68:71],a[96:99],v[192:195]
v_mfma_f32_16x16x32_bf16 v[196:199],v[68:71],a[100:103],v[196:199]
v_mfma_f32_16x16x32_bf16 v[200:203],v[68:71],a[104:107],v[200:203]
v_mfma_f32_16x16x32_bf16 v[204:207],v[68:71],a[108:111],v[204:207]
v_mfma_f32_16x16x32_bf16 v[208:211],v[68:71],a[112:115],v[208:211]
s_add_u32 s62,s69,0
v_mfma_f32_16x16x32_bf16 v[212:215],v[68:71],a[116:119],v[212:215]
buffer_store_dwordx4 v[24:27],v5,s[8:11],s62 offen
v_mfma_f32_16x16x32_bf16 v[216:219],v[68:71],a[120:123],v[216:219]
v_mfma_f32_16x16x32_bf16 v[220:223],v[68:71],a[124:127],v[220:223]
v_mfma_f32_16x16x32_bf16 v[192:195],v[72:75],a[128:131],v[192:195]
v_mfma_f32_16x16x32_bf16 v[196:199],v[72:75],a[132:135],v[196:199]
s_add_u32 s62,s69,16384
v_mfma_f32_16x16x32_bf16 v[200:203],v[72:75],a[136:139],v[200:203]
buffer_store_dwordx4 v[28:31],v5,s[8:11],s62 offen
v_mfma_f32_16x16x32_bf16 v[204:207],v[72:75],a[140:143],v[204:207]
v_mfma_f32_16x16x32_bf16 v[208:211],v[72:75],a[144:147],v[208:211]
v_mfma_f32_16x16x32_bf16 v[212:215],v[72:75],a[148:151],v[212:215]
v_mfma_f32_16x16x32_bf16 v[216:219],v[72:75],a[152:155],v[216:219]
s_add_u32 s62,s69,32768
v_mfma_f32_16x16x32_bf16 v[220:223],v[72:75],a[156:159],v[220:223]
buffer_store_dwordx4 v[32:35],v5,s[8:11],s62 offen
v_mfma_f32_16x16x32_bf16 v[192:195],v[76:79],a[160:163],v[192:195]
v_mfma_f32_16x16x32_bf16 v[196:199],v[76:79],a[164:167],v[196:199]
v_mfma_f32_16x16x32_bf16 v[200:203],v[76:79],a[168:171],v[200:203]
v_mfma_f32_16x16x32_bf16 v[204:207],v[76:79],a[172:175],v[204:207]
s_add_u32 s62,s69,49152
v_mfma_f32_16x16x32_bf16 v[208:211],v[76:79],a[176:179],v[208:211]
buffer_store_dwordx4 v[36:39],v5,s[8:11],s62 offen
v_mfma_f32_16x16x32_bf16 v[212:215],v[76:79],a[180:183],v[212:215]
v_mfma_f32_16x16x32_bf16 v[216:219],v[76:79],a[184:187],v[216:219]
v_mfma_f32_16x16x32_bf16 v[220:223],v[76:79],a[188:191],v[220:223]
v_mfma_f32_16x16x32_bf16 v[192:195],v[80:83],a[192:195],v[192:195]
v_mfma_f32_16x16x32_bf16 v[196:199],v[80:83],a[196:199],v[196:199]
v_mfma_f32_16x16x32_bf16 v[192:195],v[84:87],a[224:227],v[192:195]
v_mfma_f32_16x16x32_bf16 v[196:199],v[84:87],a[228:231],v[196:199]
v_mfma_f32_16x16x32_bf16 v[200:203],v[80:83],a[200:203],v[200:203]
v_mfma_f32_16x16x32_bf16 v[204:207],v[80:83],a[204:207],v[204:207]
v_mfma_f32_16x16x32_bf16 v[200:203],v[84:87],a[232:235],v[200:203]
v_mfma_f32_16x16x32_bf16 v[204:207],v[84:87],a[236:239],v[204:207]
v_cvt_pk_bf16_f32 v40,v192,v196
v_cvt_pk_bf16_f32 v44,v193,v197
v_cvt_pk_bf16_f32 v48,v194,v198
v_mfma_f32_16x16x32_bf16 v[208:211],v[80:83],a[208:211],v[208:211]
v_cvt_pk_bf16_f32 v52,v195,v199
v_mfma_f32_16x16x32_bf16 v[212:215],v[80:83],a[212:215],v[212:215]
v_cvt_pk_bf16_f32 v41,v200,v204
v_cvt_pk_bf16_f32 v45,v201,v205
v_cvt_pk_bf16_f32 v49,v202,v206
v_mfma_f32_16x16x32_bf16 v[208:211],v[84:87],a[240:243],v[208:211]
v_cvt_pk_bf16_f32 v53,v203,v207
v_mfma_f32_16x16x32_bf16 v[212:215],v[84:87],a[244:247],v[212:215]
v_mfma_f32_16x16x32_bf16 v[216:219],v[80:83],a[216:219],v[216:219]
v_mfma_f32_16x16x32_bf16 v[220:223],v[80:83],a[220:223],v[220:223]
v_mfma_f32_16x16x32_bf16 v[216:219],v[84:87],a[248:251],v[216:219]
v_mfma_f32_16x16x32_bf16 v[220:223],v[84:87],a[252:255],v[220:223]
v_cvt_pk_bf16_f32 v42,v208,v212
v_cvt_pk_bf16_f32 v46,v209,v213
v_cvt_pk_bf16_f32 v50,v210,v214
v_cvt_pk_bf16_f32 v54,v211,v215
s_nop 3
v_cvt_pk_bf16_f32 v43,v216,v220
s_add_u32 s62,s69,262144
buffer_store_dwordx4 v[40:43],v5,s[8:11],s62 offen
v_cvt_pk_bf16_f32 v47,v217,v221
s_add_u32 s62,s69,278528
buffer_store_dwordx4 v[44:47],v5,s[8:11],s62 offen
v_cvt_pk_bf16_f32 v51,v218,v222
s_add_u32 s62,s69,294912
buffer_store_dwordx4 v[48:51],v5,s[8:11],s62 offen
v_cvt_pk_bf16_f32 v55,v219,v223
s_add_u32 s62,s69,311296
buffer_store_dwordx4 v[52:55],v5,s[8:11],s62 offen
s_cmp_lg_u32 s72,0
s_cbranch_scc1 L_aa_77
s_waitcnt vmcnt(8)
s_branch L_aa_87
L_av_92:
s_bitcmp1_b32 s46,0
s_cbranch_scc1 L_av_93
ds_read_b128 v[24:27],v4 offset:0
ds_read_b128 v[28:31],v4 offset:1024
s_min_u32 s56,s32,s33
s_cmp_lt_u32 s77,64
s_cselect_b32 s56,s56,0
s_cmp_eq_u32 s56,0
s_cselect_b32 s72,0x80000000,0
v_mov_b32 v248,s72
s_or_b32 s64,s70,s72
s_or_b32 s65,s71,s72
s_cmp_lt_u32 s30,s31
s_cselect_b32 s65,0x80000000,s65
s_add_u32 s64,s64,s28
s_add_u32 s65,s65,s29
s_xor_b32 s58,s67,s40
s_xor_b32 s57,s67,s41
s_add_u32 m0,s58,0
s_waitcnt lgkmcnt(1)
v_mfma_f32_16x16x32_bf16 v[160:163],v[24:27],a[0:3],0
buffer_load_dwordx4 v0,s[8:11],s64 offen offset:0 sc1 lds
v_mfma_f32_16x16x32_bf16 v[164:167],v[24:27],a[4:7],0
ds_read_b128 v[32:35],v4 offset:2048
v_lshlrev_b32 v88,16,v224
v_mfma_f32_16x16x32_bf16 v[168:171],v[24:27],a[8:11],0
ds_read_b128 v[36:39],v4 offset:3072
v_and_b32 v89,0xffff0000,v224
v_mfma_f32_16x16x32_bf16 v[172:175],v[24:27],a[12:15],0
ds_read_b128 v[40:43],v4 offset:8192
v_lshlrev_b32 v90,16,v225
v_mfma_f32_16x16x32_bf16 v[176:179],v[24:27],a[16:19],0
buffer_load_dwordx4 v0,s[8:11],s64 offen offset:1024 sc1 lds
v_mfma_f32_16x16x32_bf16 v[180:183],v[24:27],a[20:23],0
ds_read_b128 v[44:47],v4 offset:9216
v_and_b32 v91,0xffff0000,v225
v_mfma_f32_16x16x32_bf16 v[184:187],v[24:27],a[24:27],0
ds_read_b128 v[48:51],v4 offset:10240
s_waitcnt vmcnt(9)
v_mfma_f32_16x16x32_bf16 v[188:191],v[24:27],a[28:31],0
ds_read_b128 v[52:55],v4 offset:11264
v_mfma_f32_16x16x32_bf16 v[128:131],v[156:159],v[192:195],0
ds_write_b32 v247,v248
v_lshlrev_b32 v92,16,v226
s_waitcnt lgkmcnt(7)
v_mfma_f32_16x16x32_bf16 v[160:163],v[28:31],a[32:35],v[160:163]
buffer_load_dwordx4 v0,s[8:11],s64 offen offset:2048 sc1 lds
v_mfma_f32_16x16x32_bf16 v[164:167],v[28:31],a[36:39],v[164:167]
ds_read_b128 v[56:59],v4 offset:4096
s_waitcnt vmcnt(9)
v_mfma_f32_16x16x32_bf16 v[168:171],v[28:31],a[40:43],v[168:171]
ds_read_b128 v[60:63],v4 offset:5120
v_mfma_f32_16x16x32_bf16 v[128:131],v[156:159],v[196:199],v[128:131]
ds_read_b128 v[64:67],v4 offset:6144
v_and_b32 v93,0xffff0000,v226
v_mfma_f32_16x16x32_bf16 v[172:175],v[28:31],a[44:47],v[172:175]
ds_read_b128 v[68:71],v4 offset:7168
s_waitcnt vmcnt(8)
v_mfma_f32_16x16x32_bf16 v[176:179],v[28:31],a[48:51],v[176:179]
buffer_load_dwordx4 v0,s[8:11],s64 offen offset:3072 sc1 lds
v_mfma_f32_16x16x32_bf16 v[180:183],v[28:31],a[52:55],v[180:183]
ds_read_b128 v[72:75],v4 offset:12288
v_mfma_f32_16x16x32_bf16 v[128:131],v[156:159],v[200:203],v[128:131]
ds_read_b128 v[76:79],v4 offset:13312
v_lshlrev_b32 v94,16,v227
v_mfma_f32_16x16x32_bf16 v[184:187],v[28:31],a[56:59],v[184:187]
ds_read_b128 v[80:83],v4 offset:14336
s_waitcnt vmcnt(8)
v_mfma_f32_16x16x32_bf16 v[188:191],v[28:31],a[60:63],v[188:191]
ds_read_b128 v[84:87],v4 offset:15360
v_mfma_f32_16x16x32_bf16 v[128:131],v[156:159],v[204:207],v[128:131]
v_and_b32 v95,0xffff0000,v227
s_lshl_b32 s18,s26,5
s_waitcnt lgkmcnt(14)
v_mfma_f32_16x16x32_bf16 v[160:163],v[32:35],a[64:67],v[160:163]
s_waitcnt vmcnt(7)
v_mfma_f32_16x16x32_bf16 v[132:135],v[156:159],v[208:211],0
s_add_u32 m0,s58,4096
s_add_u32 s64,s64,4096
s_add_u32 s18,s18,s68
v_mfma_f32_16x16x32_bf16 v[164:167],v[32:35],a[68:71],v[164:167]
buffer_load_dwordx4 v0,s[8:11],s64 offen offset:0 sc1 lds
v_mfma_f32_16x16x32_bf16 v[168:171],v[32:35],a[72:75],v[168:171]
s_waitcnt vmcnt(7)
v_mfma_f32_16x16x32_bf16 v[132:135],v[156:159],v[212:215],v[132:135]
s_lshl_b32 s19,s18,10
s_add_u32 s20,s19,8388608
s_lshl_b32 s23,s51,5
v_mfma_f32_16x16x32_bf16 v[172:175],v[32:35],a[76:79],v[172:175]
s_waitcnt vmcnt(6)
v_mfma_f32_16x16x32_bf16 v[132:135],v[156:159],v[216:219],v[132:135]
s_add_u32 s23,s23,s68
s_lshl_b32 s24,s23,10
s_lshl_b32 s25,s51,10
v_mfma_f32_16x16x32_bf16 v[176:179],v[32:35],a[80:83],v[176:179]
ds_write_b128 v6,v[128:131]
v_mfma_f32_16x16x32_bf16 v[180:183],v[32:35],a[84:87],v[180:183]
buffer_load_dwordx4 v0,s[8:11],s64 offen offset:1024 sc1 lds
v_mfma_f32_16x16x32_bf16 v[184:187],v[32:35],a[88:91],v[184:187]
s_waitcnt vmcnt(6)
v_mfma_f32_16x16x32_bf16 v[132:135],v[156:159],v[220:223],v[132:135]
s_add_u32 s25,s25,2883584
s_cmp_eq_u32 s23,s55
s_cselect_b32 s25,s25,s24
v_mfma_f32_16x16x32_bf16 v[188:191],v[32:35],a[92:95],v[188:191]
s_add_u32 s25,s25,8388608
s_mov_b32 s6,268435456
s_cmp_eq_u32 s31,0
s_cselect_b32 s25,s24,s25
s_cselect_b64 s[4:5],s[16:17],s[44:45]
s_cmov_b32 s6,2097152
s_waitcnt lgkmcnt(14)
v_mfma_f32_16x16x32_bf16 v[160:163],v[36:39],a[96:99],v[160:163]
buffer_load_dwordx4 v[224:227],v0,s[4:7],s25 offen sc1
v_mfma_f32_16x16x32_bf16 v[164:167],v[36:39],a[100:103],v[164:167]
ds_write_b128 v6,v[132:135] offset:2048
v_mfma_f32_16x16x32_bf16 v[168:171],v[36:39],a[104:107],v[168:171]
buffer_load_dwordx4 v0,s[8:11],s64 offen offset:2048 sc1 lds
v_mfma_f32_16x16x32_bf16 v[172:175],v[36:39],a[108:111],v[172:175]
s_lshr_b32 s24,s55,5
s_cmp_lt_u32 s51,s24
s_cselect_b32 s24,1,2
v_mfma_f32_16x16x32_bf16 v[176:179],v[36:39],a[112:115],v[176:179]
v_mov_b32 v252,s24
s_lshl2_add_u32 s25,s51,11018240
v_mfma_f32_16x16x32_bf16 v[180:183],v[36:39],a[116:119],v[180:183]
s_lshl_b32 s24,s68,16
s_add_u32 s24,s24,s31
s_add_u32 s24,s24,s86
v_mfma_f32_16x16x32_bf16 v[184:187],v[36:39],a[120:123],v[184:187]
buffer_load_dwordx4 v0,s[8:11],s64 offen offset:3072 sc1 lds
v_mfma_f32_16x16x32_bf16 v[188:191],v[36:39],a[124:127],v[188:191]
s_waitcnt lgkmcnt(0)
s_barrier
s_cmp_eq_u32 s24,1537
s_cselect_b32 s25,s25,0x80000000
s_waitcnt lgkmcnt(14)
v_mfma_f32_16x16x32_bf16 v[160:163],v[40:43],a[128:131],v[160:163]
ds_read_b128 v[96:99],v23
v_mfma_f32_16x16x32_bf16 v[164:167],v[40:43],a[132:135],v[164:167]
ds_read_b128 v[100:103],v23 offset:16
v_mfma_f32_16x16x32_bf16 v[168:171],v[40:43],a[136:139],v[168:171]
buffer_store_dword v20,off,s[8:11],s73 sc1
s_add_u32 m0,s58,8192
s_add_u32 s64,s64,4096
s_mov_b32 s73,0x80000000
v_mfma_f32_16x16x32_bf16 v[172:175],v[40:43],a[140:143],v[172:175]
buffer_load_dwordx4 v0,s[8:11],s64 offen offset:0 sc1 lds
v_mfma_f32_16x16x32_bf16 v[176:179],v[40:43],a[144:147],v[176:179]
ds_read_b128 v[248:251],v245
v_mfma_f32_16x16x32_bf16 v[180:183],v[40:43],a[148:151],v[180:183]
buffer_store_dword v252,off,s[8:11],s25 sc1
s_bitcmp1_b64 s[38:39],s51
s_cselect_b32 s24,128,0
s_lshl_b32 s23,s51,13
v_mfma_f32_16x16x32_bf16 v[184:187],v[40:43],a[152:155],v[184:187]
s_lshl2_add_u32 s23,s68,s23
s_add_u32 s23,s23,10487168
s_add_u32 s23,s23,s24
v_mfma_f32_16x16x32_bf16 v[188:191],v[40:43],a[156:159],v[188:191]
buffer_load_dwordx4 v0,s[8:11],s64 offen offset:1024 sc1 lds
s_waitcnt lgkmcnt(1)
v_cvt_pk_bf16_f32 v104,v96,v97
v_cvt_pk_bf16_f32 v105,v98,v99
v_mfma_f32_16x16x32_bf16 v[160:163],v[44:47],a[160:163],v[160:163]
buffer_load_dword v246,off,s[8:11],s23 sc1
v_cvt_pk_bf16_f32 v106,v100,v101
v_cvt_pk_bf16_f32 v107,v102,v103
v_lshlrev_b32 v96,16,v104
v_mfma_f32_16x16x32_bf16 v[164:167],v[44:47],a[164:167],v[164:167]
v_and_b32 v97,0xffff0000,v104
v_lshlrev_b32 v98,16,v105
v_and_b32 v99,0xffff0000,v105
v_lshlrev_b32 v100,16,v106
v_and_b32 v101,0xffff0000,v106
v_mfma_f32_16x16x32_bf16 v[168:171],v[44:47],a[168:171],v[168:171]
s_waitcnt lgkmcnt(0)
v_lshlrev_b32 v102,16,v107
v_and_b32 v103,0xffff0000,v107
v_add_f32 v88,v88,v96
v_add_f32 v89,v89,v97
v_add_f32 v90,v90,v98
v_mfma_f32_16x16x32_bf16 v[172:175],v[44:47],a[172:175],v[172:175]
buffer_load_dwordx4 v0,s[8:11],s64 offen offset:2048 sc1 lds
v_add_f32 v91,v91,v99
v_add_f32 v92,v92,v100
v_add_f32 v93,v93,v101
v_mfma_f32_16x16x32_bf16 v[176:179],v[44:47],a[176:179],v[176:179]
v_add_f32 v94,v94,v102
v_add_f32 v95,v95,v103
v_cvt_pk_bf16_f32 v104,v88,v89
v_cvt_pk_bf16_f32 v105,v90,v91
v_cvt_pk_bf16_f32 v106,v92,v93
v_mfma_f32_16x16x32_bf16 v[180:183],v[44:47],a[180:183],v[180:183]
v_cvt_pk_bf16_f32 v107,v94,v95
v_lshlrev_b32 v88,16,v104
v_and_b32 v89,0xffff0000,v104
v_lshlrev_b32 v90,16,v105
v_and_b32 v91,0xffff0000,v105
v_mfma_f32_16x16x32_bf16 v[184:187],v[44:47],a[184:187],v[184:187]
v_lshlrev_b32 v92,16,v106
v_and_b32 v93,0xffff0000,v106
v_lshlrev_b32 v94,16,v107
v_and_b32 v95,0xffff0000,v107
v_readfirstlane_b32 s78,v88
v_mfma_f32_16x16x32_bf16 v[188:191],v[44:47],a[188:191],v[188:191]
buffer_load_dwordx4 v0,s[8:11],s64 offen offset:3072 sc1 lds
v_add_f32 v120,v88,-s78
v_add_f32 v121,v89,-s78
v_add_f32 v122,v90,-s78
v_mfma_f32_16x16x32_bf16 v[160:163],v[48:51],a[192:195],v[160:163]
v_add_f32 v123,v91,-s78
v_add_f32 v124,v92,-s78
v_add_f32 v125,v93,-s78
v_add_f32 v126,v94,-s78
v_add_f32 v127,v95,-s78
v_mfma_f32_16x16x32_bf16 v[164:167],v[48:51],a[196:199],v[164:167]
v_add_f32 v128,v120,v122
v_add_f32 v129,v121,v123
v_mul_f32 v130,v120,v120
v_mul_f32 v131,v121,v121
v_add_f32 v132,v124,v126
v_mfma_f32_16x16x32_bf16 v[168:171],v[48:51],a[200:203],v[168:171]
v_add_f32 v133,v125,v127
v_fma_f32 v130,v122,v122,v130
v_fma_f32 v131,v123,v123,v131
v_add_f32 v128,v128,v132
v_add_f32 v129,v129,v133
v_mfma_f32_16x16x32_bf16 v[172:175],v[48:51],a[204:207],v[172:175]
v_fma_f32 v130,v124,v124,v130
v_fma_f32 v131,v125,v125,v131
v_add_f32 v128,v128,v129
v_fma_f32 v130,v126,v126,v130
v_fma_f32 v131,v127,v127,v131
v_mfma_f32_16x16x32_bf16 v[176:179],v[48:51],a[208:211],v[176:179]
v_add_f32 v130,v130,v131
v_or3_b32 v248,v248,v249,v250
v_or_b32 v248,v248,v251
v_permlane32_swap_b32 v128,v130
v_add_f32 v128,v128,v130
v_mfma_f32_16x16x32_bf16 v[180:183],v[48:51],a[212:215],v[180:183]
s_nop 0
v_add_f32_dpp v128,v128,v128 row_ror:8 row_mask:0xf bank_mask:0xf
v_lshrrev_b32 v244,4,v1
s_sub_u32 s23,s77,8
v_add_f32_dpp v128,v128,v128 row_ror:4 row_mask:0xf bank_mask:0xf
v_add_u32 v244,s23,v244
v_mfma_f32_16x16x32_bf16 v[184:187],v[48:51],a[216:219],v[184:187]
v_add_f32_dpp v128,v128,v128 row_ror:2 row_mask:0xf bank_mask:0xf
v_readfirstlane_b32 s72,v248
v_max_i32 v244,0,v244
v_add_f32_dpp v128,v128,v128 row_ror:1 row_mask:0xf bank_mask:0xf
v_mov_b32 v130,v128
v_mfma_f32_16x16x32_bf16 v[188:191],v[48:51],a[220:223],v[188:191]
s_nop 0
v_permlane16_swap_b32 v128,v130
v_add_f32 v128,v128,v130
v_mul_f32 v128,0x3b000000,v128
v_mov_b32 v130,v128
v_lshl_add_u32 v244,v244,13,v21
v_mfma_f32_16x16x32_bf16 v[160:163],v[52:55],a[224:227],v[160:163]
buffer_load_dwordx2 v[242:243],v244,s[8:11],0 offen sc1
v_permlane32_swap_b32 v128,v130
v_fma_f32 v130,-v128,v128,v130
v_add_f32 v128,s78,v128
v_mfma_f32_16x16x32_bf16 v[164:167],v[52:55],a[228:231],v[164:167]
v_max_f32 v130,0,v130
v_cvt_pk_bf16_f32 v130,v128,v130
v_lshlrev_b32 v128,16,v130
v_and_b32 v130,0xffff0000,v130
v_add_f32 v130,0x3727c5ac,v130
v_mfma_f32_16x16x32_bf16 v[168:171],v[52:55],a[232:235],v[168:171]
v_cvt_pk_bf16_f32 v130,v130,v130
v_and_b32 v130,0xffff0000,v130
v_sqrt_f32 v130,v130
v_add_f32 v120,v88,-v128
v_add_f32 v121,v89,-v128
v_mfma_f32_16x16x32_bf16 v[172:175],v[52:55],a[236:239],v[172:175]
v_add_f32 v122,v90,-v128
v_add_f32 v123,v91,-v128
v_add_f32 v124,v92,-v128
v_add_f32 v125,v93,-v128
v_add_f32 v126,v94,-v128
v_mfma_f32_16x16x32_bf16 v[176:179],v[52:55],a[240:243],v[176:179]
v_add_f32 v127,v95,-v128
v_cvt_pk_bf16_f32 v130,v130,v130
v_and_b32 v130,0xffff0000,v130
v_rcp_f32 v130,v130
v_cvt_pk_bf16_f32 v108,v120,v121
v_mfma_f32_16x16x32_bf16 v[180:183],v[52:55],a[244:247],v[180:183]
v_cvt_pk_bf16_f32 v109,v122,v123
v_cvt_pk_bf16_f32 v110,v124,v125
v_cvt_pk_bf16_f32 v111,v126,v127
v_lshlrev_b32 v120,16,v108
v_and_b32 v121,0xffff0000,v108
v_mfma_f32_16x16x32_bf16 v[184:187],v[52:55],a[248:251],v[184:187]
v_lshlrev_b32 v122,16,v109
v_and_b32 v123,0xffff0000,v109
v_lshlrev_b32 v124,16,v110
v_and_b32 v125,0xffff0000,v110
v_lshlrev_b32 v126,16,v111
v_mfma_f32_16x16x32_bf16 v[188:191],v[52:55],a[252:255],v[188:191]
v_and_b32 v127,0xffff0000,v111
v_mul_f32 v120,v120,v130
v_mul_f32 v121,v121,v130
v_mul_f32 v122,v122,v130
v_mul_f32 v123,v123,v130
v_mfma_f32_16x16x32_bf16 v[192:195],v[56:59],a[0:3],0
v_mul_f32 v124,v124,v130
v_mul_f32 v125,v125,v130
v_mul_f32 v126,v126,v130
v_mul_f32 v127,v127,v130
v_cvt_pk_bf16_f32 v108,v120,v121
v_mfma_f32_16x16x32_bf16 v[196:199],v[56:59],a[4:7],0
v_cvt_pk_bf16_f32 v109,v122,v123
v_cvt_pk_bf16_f32 v110,v124,v125
v_cvt_pk_bf16_f32 v111,v126,v127
v_lshlrev_b32 v112,16,v108
v_and_b32 v113,0xffff0000,v108
v_mfma_f32_16x16x32_bf16 v[200:203],v[56:59],a[8:11],0
v_lshlrev_b32 v114,16,v109
v_and_b32 v115,0xffff0000,v109
v_lshlrev_b32 v116,16,v110
v_and_b32 v117,0xffff0000,v110
v_lshlrev_b32 v118,16,v111
v_mfma_f32_16x16x32_bf16 v[204:207],v[56:59],a[12:15],0
v_and_b32 v119,0xffff0000,v111
v_add_f32 v88,v88,v112
v_add_f32 v89,v89,v113
v_add_f32 v90,v90,v114
v_add_f32 v91,v91,v115
v_mfma_f32_16x16x32_bf16 v[208:211],v[56:59],a[16:19],0
v_add_f32 v92,v92,v116
v_add_f32 v93,v93,v117
v_add_f32 v94,v94,v118
v_add_f32 v95,v95,v119
v_cvt_pk_bf16_f32 v96,v88,v89
v_mfma_f32_16x16x32_bf16 v[212:215],v[56:59],a[20:23],0
v_cvt_pk_bf16_f32 v97,v90,v91
v_cvt_pk_bf16_f32 v98,v92,v93
v_cvt_pk_bf16_f32 v99,v94,v95
v_cvt_pk_bf16_f32 v24,v160,v164
v_cvt_pk_bf16_f32 v25,v168,v172
v_mfma_f32_16x16x32_bf16 v[216:219],v[56:59],a[24:27],0
buffer_store_dwordx4 v[96:99],v0,s[8:11],s20 offen sc1
v_lshlrev_b32 v88,16,v96
v_and_b32 v89,0xffff0000,v96
v_lshlrev_b32 v90,16,v97
v_mfma_f32_16x16x32_bf16 v[220:223],v[56:59],a[28:31],0
v_and_b32 v91,0xffff0000,v97
v_lshlrev_b32 v92,16,v98
v_and_b32 v93,0xffff0000,v98
v_lshlrev_b32 v94,16,v99
v_and_b32 v95,0xffff0000,v99
v_mfma_f32_16x16x32_bf16 v[192:195],v[60:63],a[32:35],v[192:195]
v_readfirstlane_b32 s78,v88
v_cvt_pk_bf16_f32 v26,v176,v180
v_cvt_pk_bf16_f32 v27,v184,v188
v_add_f32 v120,v88,-s78
v_add_f32 v121,v89,-s78
v_mfma_f32_16x16x32_bf16 v[196:199],v[60:63],a[36:39],v[196:199]
v_add_f32 v122,v90,-s78
v_add_f32 v123,v91,-s78
v_add_f32 v124,v92,-s78
v_add_f32 v125,v93,-s78
v_add_f32 v126,v94,-s78
v_mfma_f32_16x16x32_bf16 v[200:203],v[60:63],a[40:43],v[200:203]
v_add_f32 v127,v95,-s78
v_add_f32 v128,v120,v122
v_add_f32 v129,v121,v123
v_mul_f32 v130,v120,v120
v_mul_f32 v131,v121,v121
v_mfma_f32_16x16x32_bf16 v[204:207],v[60:63],a[44:47],v[204:207]
v_add_f32 v132,v124,v126
v_add_f32 v133,v125,v127
v_fma_f32 v130,v122,v122,v130
v_fma_f32 v131,v123,v123,v131
v_add_f32 v128,v128,v132
v_mfma_f32_16x16x32_bf16 v[208:211],v[60:63],a[48:51],v[208:211]
v_add_f32 v129,v129,v133
v_fma_f32 v130,v124,v124,v130
v_fma_f32 v131,v125,v125,v131
v_add_f32 v128,v128,v129
v_fma_f32 v130,v126,v126,v130
v_mfma_f32_16x16x32_bf16 v[212:215],v[60:63],a[52:55],v[212:215]
v_fma_f32 v131,v127,v127,v131
v_add_f32 v130,v130,v131
v_cvt_pk_bf16_f32 v28,v161,v165
v_cvt_pk_bf16_f32 v29,v169,v173
v_permlane32_swap_b32 v128,v130
v_mfma_f32_16x16x32_bf16 v[216:219],v[60:63],a[56:59],v[216:219]
v_add_f32 v128,v128,v130
v_cvt_pk_bf16_f32 v30,v177,v181
v_cvt_pk_bf16_f32 v31,v185,v189
v_add_f32_dpp v128,v128,v128 row_ror:8 row_mask:0xf bank_mask:0xf
v_cvt_pk_bf16_f32 v32,v162,v166
v_mfma_f32_16x16x32_bf16 v[220:223],v[60:63],a[60:63],v[220:223]
v_add_f32_dpp v128,v128,v128 row_ror:4 row_mask:0xf bank_mask:0xf
v_cvt_pk_bf16_f32 v33,v170,v174
v_cvt_pk_bf16_f32 v34,v178,v182
v_add_f32_dpp v128,v128,v128 row_ror:2 row_mask:0xf bank_mask:0xf
v_cvt_pk_bf16_f32 v35,v186,v190
v_mfma_f32_16x16x32_bf16 v[192:195],v[64:67],a[64:67],v[192:195]
v_add_f32_dpp v128,v128,v128 row_ror:1 row_mask:0xf bank_mask:0xf
v_mov_b32 v130,v128
v_cvt_pk_bf16_f32 v36,v163,v167
v_cvt_pk_bf16_f32 v37,v171,v175
v_permlane16_swap_b32 v128,v130
v_mfma_f32_16x16x32_bf16 v[196:199],v[64:67],a[68:71],v[196:199]
v_add_f32 v128,v128,v130
v_mul_f32 v128,0x3b000000,v128
v_mov_b32 v130,v128
v_cvt_pk_bf16_f32 v38,v179,v183
v_cvt_pk_bf16_f32 v39,v187,v191
v_mfma_f32_16x16x32_bf16 v[200:203],v[64:67],a[72:75],v[200:203]
v_permlane32_swap_b32 v128,v130
v_fma_f32 v130,-v128,v128,v130
v_add_f32 v128,s78,v128
v_max_f32 v130,0,v130
v_cvt_pk_bf16_f32 v130,v128,v130
v_mfma_f32_16x16x32_bf16 v[204:207],v[64:67],a[76:79],v[204:207]
v_lshlrev_b32 v128,16,v130
v_and_b32 v130,0xffff0000,v130
v_add_f32 v130,0x3727c5ac,v130
v_cvt_pk_bf16_f32 v130,v130,v130
v_and_b32 v130,0xffff0000,v130
v_mfma_f32_16x16x32_bf16 v[208:211],v[64:67],a[80:83],v[208:211]
v_sqrt_f32 v130,v130
v_add_f32 v120,v88,-v128
v_add_f32 v121,v89,-v128
v_add_f32 v122,v90,-v128
v_add_f32 v123,v91,-v128
v_mfma_f32_16x16x32_bf16 v[212:215],v[64:67],a[84:87],v[212:215]
v_add_f32 v124,v92,-v128
v_add_f32 v125,v93,-v128
v_add_f32 v126,v94,-v128
v_add_f32 v127,v95,-v128
v_cvt_pk_bf16_f32 v130,v130,v130
v_mfma_f32_16x16x32_bf16 v[216:219],v[64:67],a[88:91],v[216:219]
v_and_b32 v130,0xffff0000,v130
v_rcp_f32 v130,v130
v_cvt_pk_bf16_f32 v100,v120,v121
v_cvt_pk_bf16_f32 v101,v122,v123
v_cvt_pk_bf16_f32 v102,v124,v125
v_mfma_f32_16x16x32_bf16 v[220:223],v[64:67],a[92:95],v[220:223]
v_cvt_pk_bf16_f32 v103,v126,v127
v_lshlrev_b32 v120,16,v100
v_and_b32 v121,0xffff0000,v100
v_lshlrev_b32 v122,16,v101
v_and_b32 v123,0xffff0000,v101
v_mfma_f32_16x16x32_bf16 v[192:195],v[68:71],a[96:99],v[192:195]
v_lshlrev_b32 v124,16,v102
v_and_b32 v125,0xffff0000,v102
v_lshlrev_b32 v126,16,v103
v_and_b32 v127,0xffff0000,v103
v_mul_f32 v120,v120,v130
v_mfma_f32_16x16x32_bf16 v[196:199],v[68:71],a[100:103],v[196:199]
v_mul_f32 v121,v121,v130
v_mul_f32 v122,v122,v130
v_mul_f32 v123,v123,v130
v_mul_f32 v124,v124,v130
v_mul_f32 v125,v125,v130
v_mfma_f32_16x16x32_bf16 v[200:203],v[68:71],a[104:107],v[200:203]
v_mul_f32 v126,v126,v130
v_mul_f32 v127,v127,v130
v_cvt_pk_bf16_f32 v100,v120,v121
v_cvt_pk_bf16_f32 v101,v122,v123
v_cvt_pk_bf16_f32 v102,v124,v125
v_mfma_f32_16x16x32_bf16 v[204:207],v[68:71],a[108:111],v[204:207]
v_cvt_pk_bf16_f32 v103,v126,v127
s_add_u32 s20,s19,2097152
v_mfma_f32_16x16x32_bf16 v[208:211],v[68:71],a[112:115],v[208:211]
buffer_store_dwordx4 v[100:103],v0,s[8:11],s20 offen sc1
v_mov_b32 v20,1
s_lshl_b32 s73,s26,13
s_lshl2_add_u32 s73,s68,s73
v_mfma_f32_16x16x32_bf16 v[212:215],v[68:71],a[116:119],v[212:215]
s_add_u32 s73,s73,10487552
s_add_u32 s62,s69,0
v_mfma_f32_16x16x32_bf16 v[216:219],v[68:71],a[120:123],v[216:219]
buffer_store_dwordx4 v[24:27],v5,s[8:11],s62 offen
v_mfma_f32_16x16x32_bf16 v[220:223],v[68:71],a[124:127],v[220:223]
v_mfma_f32_16x16x32_bf16 v[192:195],v[72:75],a[128:131],v[192:195]
v_mfma_f32_16x16x32_bf16 v[196:199],v[72:75],a[132:135],v[196:199]
v_mfma_f32_16x16x32_bf16 v[200:203],v[72:75],a[136:139],v[200:203]
s_add_u32 s62,s69,16384
v_mfma_f32_16x16x32_bf16 v[204:207],v[72:75],a[140:143],v[204:207]
buffer_store_dwordx4 v[28:31],v5,s[8:11],s62 offen
v_mfma_f32_16x16x32_bf16 v[208:211],v[72:75],a[144:147],v[208:211]
v_mfma_f32_16x16x32_bf16 v[212:215],v[72:75],a[148:151],v[212:215]
v_mfma_f32_16x16x32_bf16 v[216:219],v[72:75],a[152:155],v[216:219]
v_mfma_f32_16x16x32_bf16 v[220:223],v[72:75],a[156:159],v[220:223]
s_add_u32 s62,s69,32768
v_mfma_f32_16x16x32_bf16 v[192:195],v[76:79],a[160:163],v[192:195]
buffer_store_dwordx4 v[32:35],v5,s[8:11],s62 offen
v_mfma_f32_16x16x32_bf16 v[196:199],v[76:79],a[164:167],v[196:199]
v_mfma_f32_16x16x32_bf16 v[200:203],v[76:79],a[168:171],v[200:203]
v_mfma_f32_16x16x32_bf16 v[204:207],v[76:79],a[172:175],v[204:207]
v_mfma_f32_16x16x32_bf16 v[208:211],v[76:79],a[176:179],v[208:211]
s_add_u32 s62,s69,49152
v_mfma_f32_16x16x32_bf16 v[212:215],v[76:79],a[180:183],v[212:215]
buffer_store_dwordx4 v[36:39],v5,s[8:11],s62 offen
v_mfma_f32_16x16x32_bf16 v[216:219],v[76:79],a[184:187],v[216:219]
v_mfma_f32_16x16x32_bf16 v[220:223],v[76:79],a[188:191],v[220:223]
v_mfma_f32_16x16x32_bf16 v[192:195],v[80:83],a[192:195],v[192:195]
v_mfma_f32_16x16x32_bf16 v[196:199],v[80:83],a[196:199],v[196:199]
v_mfma_f32_16x16x32_bf16 v[192:195],v[84:87],a[224:227],v[192:195]
v_mfma_f32_16x16x32_bf16 v[196:199],v[84:87],a[228:231],v[196:199]
v_mfma_f32_16x16x32_bf16 v[200:203],v[80:83],a[200:203],v[200:203]
v_mfma_f32_16x16x32_bf16 v[204:207],v[80:83],a[204:207],v[204:207]
v_mfma_f32_16x16x32_bf16 v[200:203],v[84:87],a[232:235],v[200:203]
v_mfma_f32_16x16x32_bf16 v[204:207],v[84:87],a[236:239],v[204:207]
v_cvt_pk_bf16_f32 v40,v192,v196
v_cvt_pk_bf16_f32 v44,v193,v197
v_mfma_f32_16x16x32_bf16 v[208:211],v[80:83],a[208:211],v[208:211]
v_cvt_pk_bf16_f32 v48,v194,v198
v_cvt_pk_bf16_f32 v52,v195,v199
v_mfma_f32_16x16x32_bf16 v[212:215],v[80:83],a[212:215],v[212:215]
v_cvt_pk_bf16_f32 v41,v200,v204
v_cvt_pk_bf16_f32 v45,v201,v205
v_mfma_f32_16x16x32_bf16 v[208:211],v[84:87],a[240:243],v[208:211]
v_cvt_pk_bf16_f32 v49,v202,v206
v_cvt_pk_bf16_f32 v53,v203,v207
v_mfma_f32_16x16x32_bf16 v[212:215],v[84:87],a[244:247],v[212:215]
v_mfma_f32_16x16x32_bf16 v[216:219],v[80:83],a[216:219],v[216:219]
v_mfma_f32_16x16x32_bf16 v[220:223],v[80:83],a[220:223],v[220:223]
v_mfma_f32_16x16x32_bf16 v[216:219],v[84:87],a[248:251],v[216:219]
v_mfma_f32_16x16x32_bf16 v[220:223],v[84:87],a[252:255],v[220:223]
v_cvt_pk_bf16_f32 v42,v208,v212
v_cvt_pk_bf16_f32 v46,v209,v213
v_cvt_pk_bf16_f32 v50,v210,v214
v_cvt_pk_bf16_f32 v54,v211,v215
s_nop 3
v_cvt_pk_bf16_f32 v43,v216,v220
s_add_u32 s62,s69,262144
buffer_store_dwordx4 v[40:43],v5,s[8:11],s62 offen
v_cvt_pk_bf16_f32 v47,v217,v221
s_add_u32 s62,s69,278528
buffer_store_dwordx4 v[44:47],v5,s[8:11],s62 offen
v_cvt_pk_bf16_f32 v51,v218,v222
s_add_u32 s62,s69,294912
buffer_store_dwordx4 v[48:51],v5,s[8:11],s62 offen
v_cvt_pk_bf16_f32 v55,v219,v223
s_add_u32 s62,s69,311296
buffer_store_dwordx4 v[52:55],v5,s[8:11],s62 offen
s_waitcnt vmcnt(8)
buffer_store_dword v20,off,s[8:11],s73 sc1
s_mov_b32 s73,0x80000000
s_cmp_lg_u32 s72,0
s_cbranch_scc1 L_aa_77
s_waitcnt vmcnt(12)
s_branch L_aa_87
L_av_93:
ds_read_b128 v[24:27],v4 offset:0
ds_read_b128 v[28:31],v4 offset:1024
s_min_u32 s56,s32,s33
s_cmp_lt_u32 s77,64
s_cselect_b32 s56,s56,0
s_cmp_eq_u32 s56,0
s_cselect_b32 s72,0x80000000,0
v_mov_b32 v248,s72
s_or_b32 s64,s70,s72
s_or_b32 s65,s71,s72
s_cmp_lt_u32 s30,s31
s_cselect_b32 s65,0x80000000,s65
s_add_u32 s64,s64,s28
s_add_u32 s65,s65,s29
s_xor_b32 s58,s67,s40
s_xor_b32 s57,s67,s41
s_add_u32 m0,s58,0
s_waitcnt lgkmcnt(1)
v_mfma_f32_16x16x32_bf16 v[160:163],v[24:27],a[0:3],0
buffer_load_dwordx4 v0,s[8:11],s64 offen offset:0 sc1 lds
v_mfma_f32_16x16x32_bf16 v[164:167],v[24:27],a[4:7],0
ds_read_b128 v[32:35],v4 offset:2048
v_lshlrev_b32 v88,16,v224
v_mfma_f32_16x16x32_bf16 v[168:171],v[24:27],a[8:11],0
ds_read_b128 v[36:39],v4 offset:3072
v_and_b32 v89,0xffff0000,v224
v_mfma_f32_16x16x32_bf16 v[172:175],v[24:27],a[12:15],0
ds_read_b128 v[40:43],v4 offset:8192
v_lshlrev_b32 v90,16,v225
v_mfma_f32_16x16x32_bf16 v[176:179],v[24:27],a[16:19],0
buffer_load_dwordx4 v0,s[8:11],s64 offen offset:1024 sc1 lds
v_mfma_f32_16x16x32_bf16 v[180:183],v[24:27],a[20:23],0
ds_read_b128 v[44:47],v4 offset:9216
v_and_b32 v91,0xffff0000,v225
v_mfma_f32_16x16x32_bf16 v[184:187],v[24:27],a[24:27],0
ds_read_b128 v[48:51],v4 offset:10240
s_waitcnt vmcnt(9)
v_mfma_f32_16x16x32_bf16 v[188:191],v[24:27],a[28:31],0
ds_read_b128 v[52:55],v4 offset:11264
v_mfma_f32_16x16x32_bf16 v[128:131],v[156:159],v[192:195],0
ds_write_b32 v247,v248
v_lshlrev_b32 v92,16,v226
s_waitcnt lgkmcnt(7)
v_mfma_f32_16x16x32_bf16 v[160:163],v[28:31],a[32:35],v[160:163]
buffer_load_dwordx4 v0,s[8:11],s64 offen offset:2048 sc1 lds
v_mfma_f32_16x16x32_bf16 v[164:167],v[28:31],a[36:39],v[164:167]
ds_read_b128 v[56:59],v4 offset:4096
s_waitcnt vmcnt(9)
v_mfma_f32_16x16x32_bf16 v[168:171],v[28:31],a[40:43],v[168:171]
ds_read_b128 v[60:63],v4 offset:5120
v_mfma_f32_16x16x32_bf16 v[128:131],v[156:159],v[196:199],v[128:131]
ds_read_b128 v[64:67],v4 offset:6144
v_and_b32 v93,0xffff0000,v226
v_mfma_f32_16x16x32_bf16 v[172:175],v[28:31],a[44:47],v[172:175]
ds_read_b128 v[68:71],v4 offset:7168
s_waitcnt vmcnt(8)
v_mfma_f32_16x16x32_bf16 v[176:179],v[28:31],a[48:51],v[176:179]
buffer_load_dwordx4 v0,s[8:11],s64 offen offset:3072 sc1 lds
v_mfma_f32_16x16x32_bf16 v[180:183],v[28:31],a[52:55],v[180:183]
ds_read_b128 v[72:75],v4 offset:12288
v_mfma_f32_16x16x32_bf16 v[128:131],v[156:159],v[200:203],v[128:131]
ds_read_b128 v[76:79],v4 offset:13312
v_lshlrev_b32 v94,16,v227
v_mfma_f32_16x16x32_bf16 v[184:187],v[28:31],a[56:59],v[184:187]
ds_read_b128 v[80:83],v4 offset:14336
s_waitcnt vmcnt(8)
v_mfma_f32_16x16x32_bf16 v[188:191],v[28:31],a[60:63],v[188:191]
ds_read_b128 v[84:87],v4 offset:15360
v_mfma_f32_16x16x32_bf16 v[128:131],v[156:159],v[204:207],v[128:131]
v_and_b32 v95,0xffff0000,v227
s_lshl_b32 s18,s26,5
s_waitcnt lgkmcnt(14)
v_mfma_f32_16x16x32_bf16 v[160:163],v[32:35],a[64:67],v[160:163]
s_waitcnt vmcnt(7)
v_mfma_f32_16x16x32_bf16 v[132:135],v[156:159],v[208:211],0
s_add_u32 m0,s58,4096
s_add_u32 s64,s64,4096
s_add_u32 s18,s18,s68
v_mfma_f32_16x16x32_bf16 v[164:167],v[32:35],a[68:71],v[164:167]
buffer_load_dwordx4 v0,s[8:11],s64 offen offset:0 sc1 lds
v_mfma_f32_16x16x32_bf16 v[168:171],v[32:35],a[72:75],v[168:171]
s_waitcnt vmcnt(7)
v_mfma_f32_16x16x32_bf16 v[132:135],v[156:159],v[212:215],v[132:135]
s_lshl_b32 s19,s18,10
s_add_u32 s20,s19,4194304
s_lshl_b32 s23,s51,5
v_mfma_f32_16x16x32_bf16 v[172:175],v[32:35],a[76:79],v[172:175]
s_waitcnt vmcnt(6)
v_mfma_f32_16x16x32_bf16 v[132:135],v[156:159],v[216:219],v[132:135]
s_add_u32 s23,s23,s68
s_lshl_b32 s24,s23,10
s_lshl_b32 s25,s51,10
v_mfma_f32_16x16x32_bf16 v[176:179],v[32:35],a[80:83],v[176:179]
ds_write_b128 v6,v[128:131]
v_mfma_f32_16x16x32_bf16 v[180:183],v[32:35],a[84:87],v[180:183]
buffer_load_dwordx4 v0,s[8:11],s64 offen offset:1024 sc1 lds
v_mfma_f32_16x16x32_bf16 v[184:187],v[32:35],a[88:91],v[184:187]
s_waitcnt vmcnt(6)
v_mfma_f32_16x16x32_bf16 v[132:135],v[156:159],v[220:223],v[132:135]
s_add_u32 s25,s25,2883584
s_cmp_eq_u32 s23,s55
s_cselect_b32 s25,s25,s24
v_mfma_f32_16x16x32_bf16 v[188:191],v[32:35],a[92:95],v[188:191]
s_add_u32 s25,s25,8388608
s_mov_b32 s6,268435456
s_cmp_eq_u32 s31,0
s_cselect_b32 s25,s24,s25
s_cselect_b64 s[4:5],s[16:17],s[44:45]
s_cmov_b32 s6,2097152
s_waitcnt lgkmcnt(14)
v_mfma_f32_16x16x32_bf16 v[160:163],v[36:39],a[96:99],v[160:163]
buffer_load_dwordx4 v[224:227],v0,s[4:7],s25 offen sc1
v_mfma_f32_16x16x32_bf16 v[164:167],v[36:39],a[100:103],v[164:167]
ds_write_b128 v6,v[132:135] offset:2048
v_mfma_f32_16x16x32_bf16 v[168:171],v[36:39],a[104:107],v[168:171]
buffer_load_dwordx4 v0,s[8:11],s64 offen offset:2048 sc1 lds
v_mfma_f32_16x16x32_bf16 v[172:175],v[36:39],a[108:111],v[172:175]
s_lshr_b32 s24,s55,5
s_cmp_lt_u32 s51,s24
s_cselect_b32 s24,1,2
v_mfma_f32_16x16x32_bf16 v[176:179],v[36:39],a[112:115],v[176:179]
v_mov_b32 v252,s24
s_lshl2_add_u32 s25,s51,11018240
v_mfma_f32_16x16x32_bf16 v[180:183],v[36:39],a[116:119],v[180:183]
s_lshl_b32 s24,s68,16
s_add_u32 s24,s24,s31
s_add_u32 s24,s24,s86
v_mfma_f32_16x16x32_bf16 v[184:187],v[36:39],a[120:123],v[184:187]
buffer_load_dwordx4 v0,s[8:11],s64 offen offset:3072 sc1 lds
v_mfma_f32_16x16x32_bf16 v[188:191],v[36:39],a[124:127],v[188:191]
s_waitcnt lgkmcnt(0)
s_barrier
s_cmp_eq_u32 s24,1537
s_cselect_b32 s25,s25,0x80000000
s_waitcnt lgkmcnt(14)
v_mfma_f32_16x16x32_bf16 v[160:163],v[40:43],a[128:131],v[160:163]
ds_read_b128 v[96:99],v23
v_mfma_f32_16x16x32_bf16 v[164:167],v[40:43],a[132:135],v[164:167]
ds_read_b128 v[100:103],v23 offset:16
v_mfma_f32_16x16x32_bf16 v[168:171],v[40:43],a[136:139],v[168:171]
buffer_store_dword v20,off,s[8:11],s73 sc1
s_add_u32 m0,s58,8192
s_add_u32 s64,s64,4096
s_mov_b32 s73,0x80000000
v_mfma_f32_16x16x32_bf16 v[172:175],v[40:43],a[140:143],v[172:175]
buffer_load_dwordx4 v0,s[8:11],s64 offen offset:0 sc1 lds
v_mfma_f32_16x16x32_bf16 v[176:179],v[40:43],a[144:147],v[176:179]
ds_read_b128 v[248:251],v245
v_mfma_f32_16x16x32_bf16 v[180:183],v[40:43],a[148:151],v[180:183]
buffer_store_dword v252,off,s[8:11],s25 sc1
s_bitcmp1_b64 s[38:39],s51
s_cselect_b32 s24,128,0
s_lshl_b32 s23,s51,13
v_mfma_f32_16x16x32_bf16 v[184:187],v[40:43],a[152:155],v[184:187]
s_lshl2_add_u32 s23,s68,s23
s_add_u32 s23,s23,10487168
s_add_u32 s23,s23,s24
v_mfma_f32_16x16x32_bf16 v[188:191],v[40:43],a[156:159],v[188:191]
buffer_load_dwordx4 v0,s[8:11],s64 offen offset:1024 sc1 lds
s_waitcnt lgkmcnt(1)
v_cvt_pk_bf16_f32 v104,v96,v97
v_cvt_pk_bf16_f32 v105,v98,v99
v_mfma_f32_16x16x32_bf16 v[160:163],v[44:47],a[160:163],v[160:163]
buffer_load_dword v246,off,s[8:11],s23 sc1
v_cvt_pk_bf16_f32 v106,v100,v101
v_cvt_pk_bf16_f32 v107,v102,v103
v_lshlrev_b32 v96,16,v104
v_mfma_f32_16x16x32_bf16 v[164:167],v[44:47],a[164:167],v[164:167]
v_and_b32 v97,0xffff0000,v104
v_lshlrev_b32 v98,16,v105
v_and_b32 v99,0xffff0000,v105
v_lshlrev_b32 v100,16,v106
v_and_b32 v101,0xffff0000,v106
v_mfma_f32_16x16x32_bf16 v[168:171],v[44:47],a[168:171],v[168:171]
s_waitcnt lgkmcnt(0)
v_lshlrev_b32 v102,16,v107
v_and_b32 v103,0xffff0000,v107
v_add_f32 v88,v88,v96
v_add_f32 v89,v89,v97
v_add_f32 v90,v90,v98
v_mfma_f32_16x16x32_bf16 v[172:175],v[44:47],a[172:175],v[172:175]
buffer_load_dwordx4 v0,s[8:11],s64 offen offset:2048 sc1 lds
v_add_f32 v91,v91,v99
v_add_f32 v92,v92,v100
v_add_f32 v93,v93,v101
v_mfma_f32_16x16x32_bf16 v[176:179],v[44:47],a[176:179],v[176:179]
v_add_f32 v94,v94,v102
v_add_f32 v95,v95,v103
v_cvt_pk_bf16_f32 v104,v88,v89
v_cvt_pk_bf16_f32 v105,v90,v91
v_cvt_pk_bf16_f32 v106,v92,v93
v_mfma_f32_16x16x32_bf16 v[180:183],v[44:47],a[180:183],v[180:183]
v_cvt_pk_bf16_f32 v107,v94,v95
v_or3_b32 v248,v248,v249,v250
v_or_b32 v248,v248,v251
v_lshrrev_b32 v244,4,v1
s_sub_u32 s23,s77,8
v_mfma_f32_16x16x32_bf16 v[184:187],v[44:47],a[184:187],v[184:187]
buffer_store_dwordx4 v[104:107],v0,s[8:11],s20 offen sc1
v_lshlrev_b32 v88,16,v104
v_and_b32 v89,0xffff0000,v104
v_lshlrev_b32 v90,16,v105
v_mfma_f32_16x16x32_bf16 v[188:191],v[44:47],a[188:191],v[188:191]
buffer_load_dwordx4 v0,s[8:11],s64 offen offset:3072 sc1 lds
v_and_b32 v91,0xffff0000,v105
v_lshlrev_b32 v92,16,v106
v_and_b32 v93,0xffff0000,v106
v_mfma_f32_16x16x32_bf16 v[160:163],v[48:51],a[192:195],v[160:163]
v_lshlrev_b32 v94,16,v107
v_and_b32 v95,0xffff0000,v107
v_readfirstlane_b32 s78,v88
v_readfirstlane_b32 s72,v248
v_add_u32 v244,s23,v244
v_mfma_f32_16x16x32_bf16 v[164:167],v[48:51],a[196:199],v[164:167]
v_add_f32 v120,v88,-s78
v_add_f32 v121,v89,-s78
v_add_f32 v122,v90,-s78
v_add_f32 v123,v91,-s78
v_add_f32 v124,v92,-s78
v_mfma_f32_16x16x32_bf16 v[168:171],v[48:51],a[200:203],v[168:171]
v_add_f32 v125,v93,-s78
v_add_f32 v126,v94,-s78
v_add_f32 v127,v95,-s78
v_add_f32 v128,v120,v122
v_add_f32 v129,v121,v123
v_mfma_f32_16x16x32_bf16 v[172:175],v[48:51],a[204:207],v[172:175]
v_mul_f32 v130,v120,v120
v_mul_f32 v131,v121,v121
v_add_f32 v132,v124,v126
v_add_f32 v133,v125,v127
v_fma_f32 v130,v122,v122,v130
v_mfma_f32_16x16x32_bf16 v[176:179],v[48:51],a[208:211],v[176:179]
v_fma_f32 v131,v123,v123,v131
v_add_f32 v128,v128,v132
v_add_f32 v129,v129,v133
v_fma_f32 v130,v124,v124,v130
v_fma_f32 v131,v125,v125,v131
v_mfma_f32_16x16x32_bf16 v[180:183],v[48:51],a[212:215],v[180:183]
v_add_f32 v128,v128,v129
v_fma_f32 v130,v126,v126,v130
v_fma_f32 v131,v127,v127,v131
v_add_f32 v130,v130,v131
v_max_i32 v244,0,v244
v_mfma_f32_16x16x32_bf16 v[184:187],v[48:51],a[216:219],v[184:187]
v_permlane32_swap_b32 v128,v130
v_add_f32 v128,v128,v130
v_lshl_add_u32 v244,v244,13,v21
v_mfma_f32_16x16x32_bf16 v[188:191],v[48:51],a[220:223],v[188:191]
buffer_load_dwordx2 v[242:243],v244,s[8:11],0 offen sc1
v_add_f32_dpp v128,v128,v128 row_ror:8 row_mask:0xf bank_mask:0xf
v_mfma_f32_16x16x32_bf16 v[160:163],v[52:55],a[224:227],v[160:163]
s_nop 0
v_add_f32_dpp v128,v128,v128 row_ror:4 row_mask:0xf bank_mask:0xf
v_mfma_f32_16x16x32_bf16 v[164:167],v[52:55],a[228:231],v[164:167]
s_nop 0
v_add_f32_dpp v128,v128,v128 row_ror:2 row_mask:0xf bank_mask:0xf
v_mfma_f32_16x16x32_bf16 v[168:171],v[52:55],a[232:235],v[168:171]
s_nop 0
v_add_f32_dpp v128,v128,v128 row_ror:1 row_mask:0xf bank_mask:0xf
v_mov_b32 v130,v128
v_mfma_f32_16x16x32_bf16 v[172:175],v[52:55],a[236:239],v[172:175]
s_nop 0
v_permlane16_swap_b32 v128,v130
v_add_f32 v128,v128,v130
v_mul_f32 v128,0x3b000000,v128
v_mov_b32 v130,v128
v_mfma_f32_16x16x32_bf16 v[176:179],v[52:55],a[240:243],v[176:179]
s_nop 0
v_permlane32_swap_b32 v128,v130
v_fma_f32 v130,-v128,v128,v130
v_add_f32 v128,s78,v128
v_max_f32 v130,0,v130
v_cvt_pk_bf16_f32 v130,v128,v130
v_mfma_f32_16x16x32_bf16 v[180:183],v[52:55],a[244:247],v[180:183]
v_lshlrev_b32 v128,16,v130
v_and_b32 v130,0xffff0000,v130
v_add_f32 v130,0x3727c5ac,v130
v_cvt_pk_bf16_f32 v130,v130,v130
v_and_b32 v130,0xffff0000,v130
v_mfma_f32_16x16x32_bf16 v[184:187],v[52:55],a[248:251],v[184:187]
v_sqrt_f32 v130,v130
v_add_f32 v120,v88,-v128
v_add_f32 v121,v89,-v128
v_add_f32 v122,v90,-v128
v_add_f32 v123,v91,-v128
v_mfma_f32_16x16x32_bf16 v[188:191],v[52:55],a[252:255],v[188:191]
v_add_f32 v124,v92,-v128
v_add_f32 v125,v93,-v128
v_add_f32 v126,v94,-v128
v_add_f32 v127,v95,-v128
v_cvt_pk_bf16_f32 v130,v130,v130
v_mfma_f32_16x16x32_bf16 v[192:195],v[56:59],a[0:3],0
v_and_b32 v130,0xffff0000,v130
v_rcp_f32 v130,v130
v_cvt_pk_bf16_f32 v108,v120,v121
v_cvt_pk_bf16_f32 v109,v122,v123
v_cvt_pk_bf16_f32 v110,v124,v125
v_mfma_f32_16x16x32_bf16 v[196:199],v[56:59],a[4:7],0
v_cvt_pk_bf16_f32 v111,v126,v127
v_lshlrev_b32 v120,16,v108
v_and_b32 v121,0xffff0000,v108
v_lshlrev_b32 v122,16,v109
v_and_b32 v123,0xffff0000,v109
v_mfma_f32_16x16x32_bf16 v[200:203],v[56:59],a[8:11],0
v_lshlrev_b32 v124,16,v110
v_and_b32 v125,0xffff0000,v110
v_lshlrev_b32 v126,16,v111
v_and_b32 v127,0xffff0000,v111
v_mul_f32 v120,v120,v130
v_mfma_f32_16x16x32_bf16 v[204:207],v[56:59],a[12:15],0
v_mul_f32 v121,v121,v130
v_mul_f32 v122,v122,v130
v_mul_f32 v123,v123,v130
v_mul_f32 v124,v124,v130
v_mul_f32 v125,v125,v130
v_mfma_f32_16x16x32_bf16 v[208:211],v[56:59],a[16:19],0
v_mul_f32 v126,v126,v130
v_mul_f32 v127,v127,v130
v_cvt_pk_bf16_f32 v108,v120,v121
v_cvt_pk_bf16_f32 v109,v122,v123
v_cvt_pk_bf16_f32 v110,v124,v125
v_mfma_f32_16x16x32_bf16 v[212:215],v[56:59],a[20:23],0
v_cvt_pk_bf16_f32 v111,v126,v127
v_lshlrev_b32 v112,16,v108
v_and_b32 v113,0xffff0000,v108
v_lshlrev_b32 v114,16,v109
v_and_b32 v115,0xffff0000,v109
v_mfma_f32_16x16x32_bf16 v[216:219],v[56:59],a[24:27],0
v_lshlrev_b32 v116,16,v110
v_and_b32 v117,0xffff0000,v110
v_lshlrev_b32 v118,16,v111
v_and_b32 v119,0xffff0000,v111
v_mul_f32 v236,v112,v228
v_mfma_f32_16x16x32_bf16 v[220:223],v[56:59],a[28:31],0
v_mul_f32 v237,v113,v229
v_fma_f32 v236,v114,v230,v236
v_fma_f32 v237,v115,v231,v237
v_fma_f32 v236,v116,v232,v236
v_fma_f32 v237,v117,v233,v237
v_mfma_f32_16x16x32_bf16 v[192:195],v[60:63],a[32:35],v[192:195]
v_fma_f32 v236,v118,v234,v236
v_fma_f32 v237,v119,v235,v237
v_add_f32 v236,v236,v237
v_cvt_pk_bf16_f32 v24,v160,v164
v_cvt_pk_bf16_f32 v25,v168,v172
v_mfma_f32_16x16x32_bf16 v[196:199],v[60:63],a[36:39],v[196:199]
v_add_f32_dpp v236,v236,v236 row_ror:8 row_mask:0xf bank_mask:0xf
v_cvt_pk_bf16_f32 v26,v176,v180
v_cvt_pk_bf16_f32 v27,v184,v188
v_add_f32_dpp v236,v236,v236 row_ror:4 row_mask:0xf bank_mask:0xf
v_cvt_pk_bf16_f32 v28,v161,v165
v_mfma_f32_16x16x32_bf16 v[200:203],v[60:63],a[40:43],v[200:203]
v_add_f32_dpp v236,v236,v236 row_ror:2 row_mask:0xf bank_mask:0xf
v_cvt_pk_bf16_f32 v29,v169,v173
v_cvt_pk_bf16_f32 v30,v177,v181
v_add_f32_dpp v236,v236,v236 row_ror:1 row_mask:0xf bank_mask:0xf
v_mov_b32 v237,v236
v_mfma_f32_16x16x32_bf16 v[204:207],v[60:63],a[44:47],v[204:207]
s_nop 0
v_permlane16_swap_b32 v236,v237
v_add_f32 v236,v236,v237
v_mov_b32 v237,v236
v_cvt_pk_bf16_f32 v31,v185,v189
v_cvt_pk_bf16_f32 v32,v162,v166
v_mfma_f32_16x16x32_bf16 v[208:211],v[60:63],a[48:51],v[208:211]
v_permlane32_swap_b32 v236,v237
v_add_f32 v236,v236,v237
v_cvt_pk_bf16_f32 v236,v236,v236
v_and_b32 v236,0xffff0000,v236
v_ashrrev_i32 v237,31,v236
v_mfma_f32_16x16x32_bf16 v[212:215],v[60:63],a[52:55],v[212:215]
v_or_b32 v237,0x80000000,v237
v_xor_b32 v236,v236,v237
v_and_b32 v236,0xffff0000,v236
s_sub_u32 s20,4095,s18
v_or_b32 v20,s20,v236
v_mfma_f32_16x16x32_bf16 v[216:219],v[60:63],a[56:59],v[216:219]
s_lshl_b32 s20,s26,13
s_lshl2_add_u32 s20,s68,s20
s_add_u32 s20,s20,10485760
v_mfma_f32_16x16x32_bf16 v[220:223],v[60:63],a[60:63],v[220:223]
buffer_store_dword v20,v254,s[8:11],s20 offen sc1
v_mfma_f32_16x16x32_bf16 v[192:195],v[64:67],a[64:67],v[192:195]
v_cvt_pk_bf16_f32 v33,v170,v174
v_cvt_pk_bf16_f32 v34,v178,v182
v_mfma_f32_16x16x32_bf16 v[196:199],v[64:67],a[68:71],v[196:199]
v_cvt_pk_bf16_f32 v35,v186,v190
v_cvt_pk_bf16_f32 v36,v163,v167
v_mfma_f32_16x16x32_bf16 v[200:203],v[64:67],a[72:75],v[200:203]
v_cvt_pk_bf16_f32 v37,v171,v175
v_cvt_pk_bf16_f32 v38,v179,v183
v_mfma_f32_16x16x32_bf16 v[204:207],v[64:67],a[76:79],v[204:207]
v_cvt_pk_bf16_f32 v39,v187,v191
v_mfma_f32_16x16x32_bf16 v[208:211],v[64:67],a[80:83],v[208:211]
v_mfma_f32_16x16x32_bf16 v[212:215],v[64:67],a[84:87],v[212:215]
v_mfma_f32_16x16x32_bf16 v[216:219],v[64:67],a[88:91],v[216:219]
v_mfma_f32_16x16x32_bf16 v[220:223],v[64:67],a[92:95],v[220:223]
v_mfma_f32_16x16x32_bf16 v[192:195],v[68:71],a[96:99],v[192:195]
v_mfma_f32_16x16x32_bf16 v[196:199],v[68:71],a[100:103],v[196:199]
v_mfma_f32_16x16x32_bf16 v[200:203],v[68:71],a[104:107],v[200:203]
v_mfma_f32_16x16x32_bf16 v[204:207],v[68:71],a[108:111],v[204:207]
v_mfma_f32_16x16x32_bf16 v[208:211],v[68:71],a[112:115],v[208:211]
s_add_u32 s62,s69,0
v_mfma_f32_16x16x32_bf16 v[212:215],v[68:71],a[116:119],v[212:215]
buffer_store_dwordx4 v[24:27],v5,s[8:11],s62 offen
v_mfma_f32_16x16x32_bf16 v[216:219],v[68:71],a[120:123],v[216:219]
v_mfma_f32_16x16x32_bf16 v[220:223],v[68:71],a[124:127],v[220:223]
v_mfma_f32_16x16x32_bf16 v[192:195],v[72:75],a[128:131],v[192:195]
v_mfma_f32_16x16x32_bf16 v[196:199],v[72:75],a[132:135],v[196:199]
s_add_u32 s62,s69,16384
v_mfma_f32_16x16x32_bf16 v[200:203],v[72:75],a[136:139],v[200:203]
buffer_store_dwordx4 v[28:31],v5,s[8:11],s62 offen
v_mfma_f32_16x16x32_bf16 v[204:207],v[72:75],a[140:143],v[204:207]
v_mfma_f32_16x16x32_bf16 v[208:211],v[72:75],a[144:147],v[208:211]
v_mfma_f32_16x16x32_bf16 v[212:215],v[72:75],a[148:151],v[212:215]
v_mfma_f32_16x16x32_bf16 v[216:219],v[72:75],a[152:155],v[216:219]
s_add_u32 s62,s69,32768
v_mfma_f32_16x16x32_bf16 v[220:223],v[72:75],a[156:159],v[220:223]
buffer_store_dwordx4 v[32:35],v5,s[8:11],s62 offen
v_mfma_f32_16x16x32_bf16 v[192:195],v[76:79],a[160:163],v[192:195]
v_mfma_f32_16x16x32_bf16 v[196:199],v[76:79],a[164:167],v[196:199]
v_mfma_f32_16x16x32_bf16 v[200:203],v[76:79],a[168:171],v[200:203]
v_mfma_f32_16x16x32_bf16 v[204:207],v[76:79],a[172:175],v[204:207]
s_add_u32 s62,s69,49152
v_mfma_f32_16x16x32_bf16 v[208:211],v[76:79],a[176:179],v[208:211]
buffer_store_dwordx4 v[36:39],v5,s[8:11],s62 offen
v_mfma_f32_16x16x32_bf16 v[212:215],v[76:79],a[180:183],v[212:215]
v_mfma_f32_16x16x32_bf16 v[216:219],v[76:79],a[184:187],v[216:219]
v_mfma_f32_16x16x32_bf16 v[220:223],v[76:79],a[188:191],v[220:223]
v_mfma_f32_16x16x32_bf16 v[192:195],v[80:83],a[192:195],v[192:195]
v_mfma_f32_16x16x32_bf16 v[196:199],v[80:83],a[196:199],v[196:199]
v_mfma_f32_16x16x32_bf16 v[192:195],v[84:87],a[224:227],v[192:195]
v_mfma_f32_16x16x32_bf16 v[196:199],v[84:87],a[228:231],v[196:199]
v_mfma_f32_16x16x32_bf16 v[200:203],v[80:83],a[200:203],v[200:203]
v_mfma_f32_16x16x32_bf16 v[204:207],v[80:83],a[204:207],v[204:207]
v_mfma_f32_16x16x32_bf16 v[200:203],v[84:87],a[232:235],v[200:203]
v_mfma_f32_16x16x32_bf16 v[204:207],v[84:87],a[236:239],v[204:207]
v_cvt_pk_bf16_f32 v40,v192,v196
v_cvt_pk_bf16_f32 v44,v193,v197
v_mfma_f32_16x16x32_bf16 v[208:211],v[80:83],a[208:211],v[208:211]
v_cvt_pk_bf16_f32 v48,v194,v198
v_cvt_pk_bf16_f32 v52,v195,v199
v_mfma_f32_16x16x32_bf16 v[212:215],v[80:83],a[212:215],v[212:215]
v_cvt_pk_bf16_f32 v41,v200,v204
v_cvt_pk_bf16_f32 v45,v201,v205
v_mfma_f32_16x16x32_bf16 v[208:211],v[84:87],a[240:243],v[208:211]
v_cvt_pk_bf16_f32 v49,v202,v206
v_cvt_pk_bf16_f32 v53,v203,v207
v_mfma_f32_16x16x32_bf16 v[212:215],v[84:87],a[244:247],v[212:215]
v_mfma_f32_16x16x32_bf16 v[216:219],v[80:83],a[216:219],v[216:219]
v_mfma_f32_16x16x32_bf16 v[220:223],v[80:83],a[220:223],v[220:223]
v_mfma_f32_16x16x32_bf16 v[216:219],v[84:87],a[248:251],v[216:219]
v_mfma_f32_16x16x32_bf16 v[220:223],v[84:87],a[252:255],v[220:223]
v_cvt_pk_bf16_f32 v42,v208,v212
v_cvt_pk_bf16_f32 v46,v209,v213
v_cvt_pk_bf16_f32 v50,v210,v214
v_cvt_pk_bf16_f32 v54,v211,v215
s_nop 3
v_cvt_pk_bf16_f32 v43,v216,v220
s_add_u32 s62,s69,262144
buffer_store_dwordx4 v[40:43],v5,s[8:11],s62 offen
v_cvt_pk_bf16_f32 v47,v217,v221
s_add_u32 s62,s69,278528
buffer_store_dwordx4 v[44:47],v5,s[8:11],s62 offen
v_cvt_pk_bf16_f32 v51,v218,v222
s_add_u32 s62,s69,294912
buffer_store_dwordx4 v[48:51],v5,s[8:11],s62 offen
v_cvt_pk_bf16_f32 v55,v219,v223
s_add_u32 s62,s69,311296
buffer_store_dwordx4 v[52:55],v5,s[8:11],s62 offen
s_cmp_lg_u32 s72,0
s_cbranch_scc1 L_aa_77
s_waitcnt vmcnt(10)
s_branch L_aa_87
L_aa_75:
ds_read_b128 v[24:27],v4 offset:0
ds_read_b128 v[28:31],v4 offset:1024
s_min_u32 s56,s32,s33
s_cmp_lt_u32 s77,64
s_cselect_b32 s56,s56,0
s_cmp_eq_u32 s56,0
s_cselect_b32 s72,0x80000000,0
v_mov_b32 v248,s72
s_or_b32 s64,s70,s72
s_or_b32 s65,s71,s72
s_cmp_lt_u32 s30,s31
s_cselect_b32 s65,0x80000000,s65
s_add_u32 s64,s64,s28
s_add_u32 s65,s65,s29
s_xor_b32 s58,s67,s40
s_xor_b32 s57,s67,s41
s_add_u32 m0,s58,0
s_waitcnt lgkmcnt(1)
v_mfma_f32_16x16x32_bf16 v[160:163],v[24:27],a[0:3],0
buffer_load_dwordx4 v0,s[8:11],s64 offen offset:0 sc1 lds
v_mfma_f32_16x16x32_bf16 v[164:167],v[24:27],a[4:7],0
ds_read_b128 v[32:35],v4 offset:2048
s_lshl_b32 s23,s51,5
v_mfma_f32_16x16x32_bf16 v[168:171],v[24:27],a[8:11],0
ds_read_b128 v[36:39],v4 offset:3072
s_add_u32 s23,s23,s68
v_mfma_f32_16x16x32_bf16 v[172:175],v[24:27],a[12:15],0
ds_read_b128 v[40:43],v4 offset:8192
s_lshl_b32 s24,s23,10
v_mfma_f32_16x16x32_bf16 v[176:179],v[24:27],a[16:19],0
buffer_load_dwordx4 v0,s[8:11],s64 offen offset:1024 sc1 lds
v_mfma_f32_16x16x32_bf16 v[180:183],v[24:27],a[20:23],0
ds_read_b128 v[44:47],v4 offset:9216
s_lshl_b32 s25,s51,10
v_mfma_f32_16x16x32_bf16 v[184:187],v[24:27],a[24:27],0
ds_read_b128 v[48:51],v4 offset:10240
s_add_u32 s25,s25,2883584
v_mfma_f32_16x16x32_bf16 v[188:191],v[24:27],a[28:31],0
ds_read_b128 v[52:55],v4 offset:11264
s_cmp_eq_u32 s23,s55
s_cselect_b32 s25,s25,s24
s_waitcnt lgkmcnt(6)
v_mfma_f32_16x16x32_bf16 v[160:163],v[28:31],a[32:35],v[160:163]
buffer_load_dwordx4 v0,s[8:11],s64 offen offset:2048 sc1 lds
v_mfma_f32_16x16x32_bf16 v[164:167],v[28:31],a[36:39],v[164:167]
ds_write_b32 v247,v248
s_add_u32 s25,s25,8388608
v_mfma_f32_16x16x32_bf16 v[168:171],v[28:31],a[40:43],v[168:171]
ds_read_b128 v[56:59],v4 offset:4096
s_mov_b32 s6,268435456
v_mfma_f32_16x16x32_bf16 v[172:175],v[28:31],a[44:47],v[172:175]
ds_read_b128 v[60:63],v4 offset:5120
s_cmp_eq_u32 s31,0
s_cselect_b32 s25,s24,s25
s_cselect_b64 s[4:5],s[16:17],s[44:45]
s_cmov_b32 s6,2097152
v_mfma_f32_16x16x32_bf16 v[176:179],v[28:31],a[48:51],v[176:179]
buffer_load_dwordx4 v0,s[8:11],s64 offen offset:3072 sc1 lds
v_mfma_f32_16x16x32_bf16 v[180:183],v[28:31],a[52:55],v[180:183]
ds_read_b128 v[64:67],v4 offset:6144
v_mfma_f32_16x16x32_bf16 v[184:187],v[28:31],a[56:59],v[184:187]
ds_read_b128 v[68:71],v4 offset:7168
v_mfma_f32_16x16x32_bf16 v[188:191],v[28:31],a[60:63],v[188:191]
ds_read_b128 v[72:75],v4 offset:12288
s_waitcnt lgkmcnt(11)
v_mfma_f32_16x16x32_bf16 v[160:163],v[32:35],a[64:67],v[160:163]
ds_read_b128 v[76:79],v4 offset:13312
s_add_u32 m0,s58,4096
v_mfma_f32_16x16x32_bf16 v[164:167],v[32:35],a[68:71],v[164:167]
ds_read_b128 v[80:83],v4 offset:14336
s_add_u32 s64,s64,4096
v_mfma_f32_16x16x32_bf16 v[168:171],v[32:35],a[72:75],v[168:171]
buffer_load_dwordx4 v0,s[8:11],s64 offen offset:0 sc1 lds
v_mfma_f32_16x16x32_bf16 v[172:175],v[32:35],a[76:79],v[172:175]
ds_read_b128 v[84:87],v4 offset:15360
v_mfma_f32_16x16x32_bf16 v[176:179],v[32:35],a[80:83],v[176:179]
buffer_load_dwordx4 v[224:227],v0,s[4:7],s25 offen sc1
v_mfma_f32_16x16x32_bf16 v[180:183],v[32:35],a[84:87],v[180:183]
s_lshr_b32 s24,s55,5
s_cmp_lt_u32 s51,s24
s_cselect_b32 s24,1,2
v_mfma_f32_16x16x32_bf16 v[184:187],v[32:35],a[88:91],v[184:187]
buffer_load_dwordx4 v0,s[8:11],s64 offen offset:1024 sc1 lds
v_mfma_f32_16x16x32_bf16 v[188:191],v[32:35],a[92:95],v[188:191]
v_mov_b32 v252,s24
s_lshl2_add_u32 s25,s51,11018240
s_waitcnt lgkmcnt(13)
v_mfma_f32_16x16x32_bf16 v[160:163],v[36:39],a[96:99],v[160:163]
s_waitcnt lgkmcnt(0)
s_barrier
s_lshl_b32 s24,s68,16
v_mfma_f32_16x16x32_bf16 v[164:167],v[36:39],a[100:103],v[164:167]
ds_read_b128 v[248:251],v245
s_add_u32 s24,s24,s31
v_mfma_f32_16x16x32_bf16 v[168:171],v[36:39],a[104:107],v[168:171]
buffer_load_dwordx4 v0,s[8:11],s64 offen offset:2048 sc1 lds
v_mfma_f32_16x16x32_bf16 v[172:175],v[36:39],a[108:111],v[172:175]
s_add_u32 s24,s24,s86
s_cmp_eq_u32 s24,1537
s_cselect_b32 s25,s25,0x80000000
v_mfma_f32_16x16x32_bf16 v[176:179],v[36:39],a[112:115],v[176:179]
buffer_store_dword v252,off,s[8:11],s25 sc1
v_mfma_f32_16x16x32_bf16 v[180:183],v[36:39],a[116:119],v[180:183]
s_bitcmp1_b64 s[38:39],s51
s_cselect_b32 s24,128,0
s_lshl_b32 s23,s51,13
v_mfma_f32_16x16x32_bf16 v[184:187],v[36:39],a[120:123],v[184:187]
buffer_load_dwordx4 v0,s[8:11],s64 offen offset:3072 sc1 lds
v_mfma_f32_16x16x32_bf16 v[188:191],v[36:39],a[124:127],v[188:191]
s_waitcnt lgkmcnt(0)
v_or3_b32 v248,v248,v249,v250
v_or_b32 v248,v248,v251
v_mfma_f32_16x16x32_bf16 v[160:163],v[40:43],a[128:131],v[160:163]
s_lshl2_add_u32 s23,s68,s23
s_add_u32 s23,s23,10487168
s_add_u32 s23,s23,s24
v_mfma_f32_16x16x32_bf16 v[164:167],v[40:43],a[132:135],v[164:167]
buffer_load_dword v246,off,s[8:11],s23 sc1
v_mfma_f32_16x16x32_bf16 v[168:171],v[40:43],a[136:139],v[168:171]
s_add_u32 m0,s58,8192
s_add_u32 s64,s64,4096
v_readfirstlane_b32 s72,v248
v_mfma_f32_16x16x32_bf16 v[172:175],v[40:43],a[140:143],v[172:175]
buffer_load_dwordx4 v0,s[8:11],s64 offen offset:0 sc1 lds
v_mfma_f32_16x16x32_bf16 v[176:179],v[40:43],a[144:147],v[176:179]
s_waitcnt vmcnt(12)
v_lshrrev_b32 v244,4,v1
s_sub_u32 s23,s77,8
v_mfma_f32_16x16x32_bf16 v[180:183],v[40:43],a[148:151],v[180:183]
buffer_store_dword v20,off,s[8:11],s73 sc1
v_mfma_f32_16x16x32_bf16 v[184:187],v[40:43],a[152:155],v[184:187]
s_mov_b32 s73,0x80000000
v_add_u32 v244,s23,v244
v_max_i32 v244,0,v244
v_mfma_f32_16x16x32_bf16 v[188:191],v[40:43],a[156:159],v[188:191]
buffer_load_dwordx4 v0,s[8:11],s64 offen offset:1024 sc1 lds
v_mfma_f32_16x16x32_bf16 v[160:163],v[44:47],a[160:163],v[160:163]
v_lshl_add_u32 v244,v244,13,v21
v_mfma_f32_16x16x32_bf16 v[164:167],v[44:47],a[164:167],v[164:167]
buffer_load_dwordx2 v[242:243],v244,s[8:11],0 offen sc1
v_mfma_f32_16x16x32_bf16 v[168:171],v[44:47],a[168:171],v[168:171]
v_mfma_f32_16x16x32_bf16 v[172:175],v[44:47],a[172:175],v[172:175]
buffer_load_dwordx4 v0,s[8:11],s64 offen offset:2048 sc1 lds
v_mfma_f32_16x16x32_bf16 v[176:179],v[44:47],a[176:179],v[176:179]
v_mfma_f32_16x16x32_bf16 v[180:183],v[44:47],a[180:183],v[180:183]
v_mfma_f32_16x16x32_bf16 v[184:187],v[44:47],a[184:187],v[184:187]
v_mfma_f32_16x16x32_bf16 v[188:191],v[44:47],a[188:191],v[188:191]
buffer_load_dwordx4 v0,s[8:11],s64 offen offset:3072 sc1 lds
v_mfma_f32_16x16x32_bf16 v[160:163],v[48:51],a[192:195],v[160:163]
v_mfma_f32_16x16x32_bf16 v[164:167],v[48:51],a[196:199],v[164:167]
v_mfma_f32_16x16x32_bf16 v[168:171],v[48:51],a[200:203],v[168:171]
v_mfma_f32_16x16x32_bf16 v[172:175],v[48:51],a[204:207],v[172:175]
s_add_u32 m0,s57,24576
v_mfma_f32_16x16x32_bf16 v[176:179],v[48:51],a[208:211],v[176:179]
buffer_load_dwordx4 v0,s[8:11],s65 offen offset:0 sc1 lds
v_mfma_f32_16x16x32_bf16 v[180:183],v[48:51],a[212:215],v[180:183]
v_mfma_f32_16x16x32_bf16 v[184:187],v[48:51],a[216:219],v[184:187]
v_mfma_f32_16x16x32_bf16 v[188:191],v[48:51],a[220:223],v[188:191]
v_mfma_f32_16x16x32_bf16 v[160:163],v[52:55],a[224:227],v[160:163]
buffer_load_dwordx4 v0,s[8:11],s65 offen offset:1024 sc1 lds
v_mfma_f32_16x16x32_bf16 v[164:167],v[52:55],a[228:231],v[164:167]
v_mfma_f32_16x16x32_bf16 v[168:171],v[52:55],a[232:235],v[168:171]
v_mfma_f32_16x16x32_bf16 v[172:175],v[52:55],a[236:239],v[172:175]
v_mfma_f32_16x16x32_bf16 v[176:179],v[52:55],a[240:243],v[176:179]
v_mfma_f32_16x16x32_bf16 v[180:183],v[52:55],a[244:247],v[180:183]
v_mfma_f32_16x16x32_bf16 v[184:187],v[52:55],a[248:251],v[184:187]
v_mfma_f32_16x16x32_bf16 v[188:191],v[52:55],a[252:255],v[188:191]
v_mfma_f32_16x16x32_bf16 v[192:195],v[56:59],a[0:3],0
v_mfma_f32_16x16x32_bf16 v[196:199],v[56:59],a[4:7],0
v_mfma_f32_16x16x32_bf16 v[200:203],v[56:59],a[8:11],0
v_cvt_pk_bf16_f32 v24,v160,v164
v_cvt_pk_bf16_f32 v25,v168,v172
v_mfma_f32_16x16x32_bf16 v[204:207],v[56:59],a[12:15],0
v_cvt_pk_bf16_f32 v26,v176,v180
v_cvt_pk_bf16_f32 v27,v184,v188
v_mfma_f32_16x16x32_bf16 v[208:211],v[56:59],a[16:19],0
v_cvt_pk_bf16_f32 v28,v161,v165
v_cvt_pk_bf16_f32 v29,v169,v173
v_mfma_f32_16x16x32_bf16 v[212:215],v[56:59],a[20:23],0
v_cvt_pk_bf16_f32 v30,v177,v181
v_cvt_pk_bf16_f32 v31,v185,v189
v_mfma_f32_16x16x32_bf16 v[216:219],v[56:59],a[24:27],0
v_cvt_pk_bf16_f32 v32,v162,v166
v_cvt_pk_bf16_f32 v33,v170,v174
v_mfma_f32_16x16x32_bf16 v[220:223],v[56:59],a[28:31],0
v_cvt_pk_bf16_f32 v34,v178,v182
v_cvt_pk_bf16_f32 v35,v186,v190
v_mfma_f32_16x16x32_bf16 v[192:195],v[60:63],a[32:35],v[192:195]
v_cvt_pk_bf16_f32 v36,v163,v167
v_cvt_pk_bf16_f32 v37,v171,v175
v_mfma_f32_16x16x32_bf16 v[196:199],v[60:63],a[36:39],v[196:199]
v_cvt_pk_bf16_f32 v38,v179,v183
v_cvt_pk_bf16_f32 v39,v187,v191
v_mfma_f32_16x16x32_bf16 v[200:203],v[60:63],a[40:43],v[200:203]
v_mfma_f32_16x16x32_bf16 v[204:207],v[60:63],a[44:47],v[204:207]
v_mfma_f32_16x16x32_bf16 v[208:211],v[60:63],a[48:51],v[208:211]
v_mfma_f32_16x16x32_bf16 v[212:215],v[60:63],a[52:55],v[212:215]
v_mfma_f32_16x16x32_bf16 v[216:219],v[60:63],a[56:59],v[216:219]
v_mfma_f32_16x16x32_bf16 v[220:223],v[60:63],a[60:63],v[220:223]
v_mfma_f32_16x16x32_bf16 v[192:195],v[64:67],a[64:67],v[192:195]
v_mfma_f32_16x16x32_bf16 v[196:199],v[64:67],a[68:71],v[196:199]
v_mfma_f32_16x16x32_bf16 v[200:203],v[64:67],a[72:75],v[200:203]
v_mfma_f32_16x16x32_bf16 v[204:207],v[64:67],a[76:79],v[204:207]
v_mfma_f32_16x16x32_bf16 v[208:211],v[64:67],a[80:83],v[208:211]
v_mfma_f32_16x16x32_bf16 v[212:215],v[64:67],a[84:87],v[212:215]
v_mfma_f32_16x16x32_bf16 v[216:219],v[64:67],a[88:91],v[216:219]
v_mfma_f32_16x16x32_bf16 v[220:223],v[64:67],a[92:95],v[220:223]
v_mfma_f32_16x16x32_bf16 v[192:195],v[68:71],a[96:99],v[192:195]
v_mfma_f32_16x16x32_bf16 v[196:199],v[68:71],a[100:103],v[196:199]
v_mfma_f32_16x16x32_bf16 v[200:203],v[68:71],a[104:107],v[200:203]
v_mfma_f32_16x16x32_bf16 v[204:207],v[68:71],a[108:111],v[204:207]
v_mfma_f32_16x16x32_bf16 v[208:211],v[68:71],a[112:115],v[208:211]
s_add_u32 s62,s69,0
v_mfma_f32_16x16x32_bf16 v[212:215],v[68:71],a[116:119],v[212:215]
buffer_store_dwordx4 v[24:27],v5,s[8:11],s62 offen
v_mfma_f32_16x16x32_bf16 v[216:219],v[68:71],a[120:123],v[216:219]
v_mfma_f32_16x16x32_bf16 v[220:223],v[68:71],a[124:127],v[220:223]
v_mfma_f32_16x16x32_bf16 v[192:195],v[72:75],a[128:131],v[192:195]
v_mfma_f32_16x16x32_bf16 v[196:199],v[72:75],a[132:135],v[196:199]
s_add_u32 s62,s69,16384
v_mfma_f32_16x16x32_bf16 v[200:203],v[72:75],a[136:139],v[200:203]
buffer_store_dwordx4 v[28:31],v5,s[8:11],s62 offen
v_mfma_f32_16x16x32_bf16 v[204:207],v[72:75],a[140:143],v[204:207]
v_mfma_f32_16x16x32_bf16 v[208:211],v[72:75],a[144:147],v[208:211]
v_mfma_f32_16x16x32_bf16 v[212:215],v[72:75],a[148:151],v[212:215]
v_mfma_f32_16x16x32_bf16 v[216:219],v[72:75],a[152:155],v[216:219]
s_add_u32 s62,s69,32768
v_mfma_f32_16x16x32_bf16 v[220:223],v[72:75],a[156:159],v[220:223]
buffer_store_dwordx4 v[32:35],v5,s[8:11],s62 offen
v_mfma_f32_16x16x32_bf16 v[192:195],v[76:79],a[160:163],v[192:195]
v_mfma_f32_16x16x32_bf16 v[196:199],v[76:79],a[164:167],v[196:199]
v_mfma_f32_16x16x32_bf16 v[200:203],v[76:79],a[168:171],v[200:203]
v_mfma_f32_16x16x32_bf16 v[204:207],v[76:79],a[172:175],v[204:207]
s_add_u32 s62,s69,49152
v_mfma_f32_16x16x32_bf16 v[208:211],v[76:79],a[176:179],v[208:211]
buffer_store_dwordx4 v[36:39],v5,s[8:11],s62 offen
v_mfma_f32_16x16x32_bf16 v[212:215],v[76:79],a[180:183],v[212:215]
v_mfma_f32_16x16x32_bf16 v[216:219],v[76:79],a[184:187],v[216:219]
v_mfma_f32_16x16x32_bf16 v[220:223],v[76:79],a[188:191],v[220:223]
v_mfma_f32_16x16x32_bf16 v[192:195],v[80:83],a[192:195],v[192:195]
v_mfma_f32_16x16x32_bf16 v[196:199],v[80:83],a[196:199],v[196:199]
v_mfma_f32_16x16x32_bf16 v[192:195],v[84:87],a[224:227],v[192:195]
v_mfma_f32_16x16x32_bf16 v[196:199],v[84:87],a[228:231],v[196:199]
v_mfma_f32_16x16x32_bf16 v[200:203],v[80:83],a[200:203],v[200:203]
v_mfma_f32_16x16x32_bf16 v[204:207],v[80:83],a[204:207],v[204:207]
v_mfma_f32_16x16x32_bf16 v[200:203],v[84:87],a[232:235],v[200:203]
v_mfma_f32_16x16x32_bf16 v[204:207],v[84:87],a[236:239],v[204:207]
v_cvt_pk_bf16_f32 v40,v192,v196
v_cvt_pk_bf16_f32 v44,v193,v197
v_cvt_pk_bf16_f32 v48,v194,v198
v_mfma_f32_16x16x32_bf16 v[208:211],v[80:83],a[208:211],v[208:211]
v_cvt_pk_bf16_f32 v52,v195,v199
v_mfma_f32_16x16x32_bf16 v[212:215],v[80:83],a[212:215],v[212:215]
v_cvt_pk_bf16_f32 v41,v200,v204
v_cvt_pk_bf16_f32 v45,v201,v205
v_cvt_pk_bf16_f32 v49,v202,v206
v_mfma_f32_16x16x32_bf16 v[208:211],v[84:87],a[240:243],v[208:211]
v_cvt_pk_bf16_f32 v53,v203,v207
v_mfma_f32_16x16x32_bf16 v[212:215],v[84:87],a[244:247],v[212:215]
v_mfma_f32_16x16x32_bf16 v[216:219],v[80:83],a[216:219],v[216:219]
v_mfma_f32_16x16x32_bf16 v[220:223],v[80:83],a[220:223],v[220:223]
v_mfma_f32_16x16x32_bf16 v[216:219],v[84:87],a[248:251],v[216:219]
v_mfma_f32_16x16x32_bf16 v[220:223],v[84:87],a[252:255],v[220:223]
v_cvt_pk_bf16_f32 v42,v208,v212
v_cvt_pk_bf16_f32 v46,v209,v213
v_cvt_pk_bf16_f32 v50,v210,v214
v_cvt_pk_bf16_f32 v54,v211,v215
s_nop 3
v_cvt_pk_bf16_f32 v43,v216,v220
s_add_u32 s62,s69,262144
buffer_store_dwordx4 v[40:43],v5,s[8:11],s62 offen
v_cvt_pk_bf16_f32 v47,v217,v221
s_add_u32 s62,s69,278528
buffer_store_dwordx4 v[44:47],v5,s[8:11],s62 offen
v_cvt_pk_bf16_f32 v51,v218,v222
s_add_u32 s62,s69,294912
buffer_store_dwordx4 v[48:51],v5,s[8:11],s62 offen
v_cvt_pk_bf16_f32 v55,v219,v223
s_add_u32 s62,s69,311296
buffer_store_dwordx4 v[52:55],v5,s[8:11],s62 offen
s_cmp_lg_u32 s72,0
s_cbranch_scc1 L_aa_77
s_waitcnt vmcnt(8)
L_aa_87:
s_barrier
s_cmp_lt_u32 s30,s31
s_cbranch_scc1 L_ao_94
s_xor_b32 s67,s67,65536
s_and_b32 s56,s50,2048
s_lshl_b32 s56,s56,4
s_add_u32 s56,s56,s67
v_add_u32 v2,s56,v0
v_add_u32 v239,s56,v253
s_and_b32 s56,s50,1024
s_lshl_b32 s56,s56,2
v_add_u32 v238,s56,v2
s_mov_b32 s76,s71
s_mov_b32 s53,s77
ds_read_b128 v[24:27],v238 offset:16384
ds_read_b128 v[40:43],v2 offset:0
ds_read_b128 v[56:59],v2 offset:4096
ds_read_b128 v[28:31],v238 offset:17408
ds_read_b128 v[44:47],v2 offset:1024
ds_read_b128 v[60:63],v2 offset:5120
ds_read_b128 v[32:35],v238 offset:18432
ds_read_b128 v[48:51],v2 offset:2048
ds_read_b128 v[64:67],v2 offset:6144
ds_read_b128 v[36:39],v238 offset:19456
ds_read_b128 v[52:55],v2 offset:3072
ds_read_b128 v[68:71],v2 offset:7168
s_waitcnt lgkmcnt(9)
v_mfma_f32_16x16x32_bf16 v[128:131],v[40:43],v[24:27],v[8:11]
ds_read_b128 v[72:75],v2 offset:24576
v_mfma_f32_16x16x32_bf16 v[132:135],v[56:59],v[24:27],v[12:15]
ds_read_b128 v[76:79],v2 offset:25600
s_waitcnt lgkmcnt(8)
v_mfma_f32_16x16x32_bf16 v[128:131],v[44:47],v[28:31],v[128:131]
ds_read_b128 v[80:83],v2 offset:26624
v_mfma_f32_16x16x32_bf16 v[132:135],v[60:63],v[28:31],v[132:135]
ds_read_b128 v[84:87],v2 offset:27648
s_waitcnt lgkmcnt(7)
v_mfma_f32_16x16x32_bf16 v[128:131],v[48:51],v[32:35],v[128:131]
ds_read_b64 v[120:121],v239 offset:24576
v_mfma_f32_16x16x32_bf16 v[132:135],v[64:67],v[32:35],v[132:135]
ds_read_b64 v[122:123],v239 offset:25600
s_waitcnt lgkmcnt(6)
v_mfma_f32_16x16x32_bf16 v[128:131],v[52:55],v[36:39],v[128:131]
ds_read_b64 v[124:125],v239 offset:26624
v_mfma_f32_16x16x32_bf16 v[132:135],v[68:71],v[36:39],v[132:135]
ds_read_b64 v[126:127],v239 offset:27648
s_waitcnt lgkmcnt(4)
v_mfma_f32_16x16x32_bf16 v[136:139],v[72:75],v[24:27],0
ds_read_b128 v[88:91],v2 offset:8192
ds_read_b128 v[92:95],v2 offset:9216
v_mfma_f32_16x16x32_bf16 v[136:139],v[76:79],v[28:31],v[136:139]
ds_read_b128 v[96:99],v2 offset:10240
ds_read_b128 v[100:103],v2 offset:11264
v_mfma_f32_16x16x32_bf16 v[136:139],v[80:83],v[32:35],v[136:139]
ds_read_b128 v[104:107],v2 offset:12288
ds_read_b128 v[108:111],v2 offset:13312
v_mfma_f32_16x16x32_bf16 v[136:139],v[84:87],v[36:39],v[136:139]
ds_read_b128 v[112:115],v2 offset:14336
ds_read_b128 v[116:119],v2 offset:15360
s_cmp_eq_u32 s30,0
s_cbranch_scc1 L_aa_76
v_max3_u32 v238,v72,v73,v74
v_max3_u32 v238,v74,v75,v238
v_max3_u32 v238,v76,v77,v238
v_max3_u32 v238,v78,v79,v238
v_max3_u32 v238,v80,v81,v238
v_max3_u32 v238,v82,v83,v238
v_max3_u32 v238,v84,v85,v238
v_max3_u32 v238,v86,v87,v238
s_waitcnt lgkmcnt(8)
v_max3_u32 v238,v120,v121,v238
v_max3_u32 v238,v122,v123,v238
v_max3_u32 v238,v124,v125,v238
v_max3_u32 v238,v126,v127,v238
v_cmp_eq_u32 vcc,-1,v238
s_cmp_lg_u64 vcc,0
s_cselect_b32 s27,1,0
s_andn2_b32 s57,s27,s31
s_add_u32 s66,s66,4
s_bfe_u32 s56,s66,0x10002
s_bitset0_b32 s37,s56
s_lshl_b32 s56,s57,s56
s_or_b32 s37,s37,s56
s_or_b32 s56,s37,s66
v_mov_b32 v22,s56
s_xor_b32 s69,s69,524288
s_waitcnt vmcnt(0) lgkmcnt(0)
buffer_store_dword v22,off,s[8:11],s74
s_cmp_lg_u32 s86,1536
s_cbranch_scc1 L_ae_97
s_mov_b32 s77,s35
s_mov_b32 s30,0
s_lshl_b32 s56,s77,5
s_add_u32 s56,s56,s68
s_mul_i32 s70,s56,24576
s_lshl_b32 s71,s56,12
s_lshl_b32 s59,s77,13
s_lshl2_add_u32 s59,s68,s59
s_add_u32 s59,s59,10485760
s_buffer_load_dword s32,s[8:11],s59
s_mov_b32 s33,1
s_add_u32 s70,s70,100663296
s_add_u32 s71,s71,41943040
v_mov_b32 v19,s59
s_branch L_af_98
L_ae_97:
s_ff1_i32_b64 s77,s[84:85]
s_bitset0_b64 s[84:85],s77
s_min_u32 s77,s77,64
s_lshr_b32 s61,s55,5
s_lshl_b32 s56,s77,5
s_add_u32 s56,s56,s68
s_mul_i32 s70,s56,24576
s_lshl_b32 s71,s56,12
s_lshl_b32 s59,s77,13
s_lshl2_add_u32 s59,s68,s59
s_add_u32 s59,s59,10486144
s_cmp_lt_u32 s77,s61
s_cselect_b32 s57,0,16777216
s_mov_b32 s60,s59
s_buffer_load_dword s33,s[8:11],s60
s_add_u32 s71,s71,s57
s_add_u32 s71,s71,58720256
s_cmp_eq_u32 s77,s61
s_cselect_b32 s57,50331648,0
s_cselect_b32 s58,1536,0
s_add_u32 s59,s59,s58
s_buffer_load_dword s32,s[8:11],s59
s_add_u32 s70,s70,s57
s_add_u32 s70,s70,150994944
v_mov_b32 v19,s59
v_writelane_b32 v19,s60,1
L_af_98:
s_cmp_ge_u32 s53,60
s_cbranch_scc1 L_a4_99
L_a4_100:
s_and_b32 s27,s27,s31
s_cbranch_scc1 L_ac_102
L_acb_103:
v_max3_f32 v238,v128,v129,v130
v_max3_f32 v239,v131,v132,v133
v_max3_f32 v238,v134,v135,v238
v_max3_f32 v239,v138,v139,v239
v_max_f32 v238,v238,v239
v_max_f32 v239,v238,v239
v_pk_mul_f32 v[128:129],v[128:129],v[152:153] op_sel_hi:[1,0]
v_pk_mul_f32 v[130:131],v[130:131],v[152:153] op_sel_hi:[1,0]
v_permlane16_swap_b32 v238,v239
v_max_f32 v238,v238,v239
v_max_f32 v239,v238,v239
v_pk_mul_f32 v[132:133],v[132:133],v[152:153] op_sel_hi:[1,0]
v_pk_mul_f32 v[134:135],v[134:135],v[152:153] op_sel_hi:[1,0]
v_permlane32_swap_b32 v238,v239
v_max_f32 v238,v238,v239
v_mul_f32 v238,v152,v238
v_pk_mul_f32 v[138:139],v[138:139],v[152:153] op_sel_hi:[1,0]
buffer_load_dword v17,v16,s[8:11],s87 offen sc1
v_pk_add_f32 v[128:129],v[128:129],v[238:239] op_sel_hi:[1,0] neg_lo:[0,1] neg_hi:[0,1]
v_pk_add_f32 v[130:131],v[130:131],v[238:239] op_sel_hi:[1,0] neg_lo:[0,1] neg_hi:[0,1]
v_pk_add_f32 v[132:133],v[132:133],v[238:239] op_sel_hi:[1,0] neg_lo:[0,1] neg_hi:[0,1]
v_pk_add_f32 v[134:135],v[134:135],v[238:239] op_sel_hi:[1,0] neg_lo:[0,1] neg_hi:[0,1]
v_pk_add_f32 v[138:139],v[138:139],v[238:239] op_sel_hi:[1,0] neg_lo:[0,1] neg_hi:[0,1]
v_exp_f32 v128,v128
v_exp_f32 v129,v129
v_exp_f32 v130,v130
v_exp_f32 v131,v131
v_exp_f32 v132,v132
v_exp_f32 v133,v133
v_exp_f32 v134,v134
v_exp_f32 v135,v135
v_exp_f32 v138,v138
v_exp_f32 v139,v139
v_pk_add_f32 v[148:149],v[128:129],v[130:131]
v_pk_add_f32 v[150:151],v[132:133],v[134:135]
v_pk_add_f32 v[148:149],v[148:149],v[138:139]
v_pk_add_f32 v[148:149],v[148:149],v[150:151]
v_add_f32 v150,v148,v149
v_add_f32 v151,v148,v149
s_nop 1
v_permlane16_swap_b32 v150,v151
v_add_f32 v148,v150,v151
v_add_f32 v149,v150,v151
s_nop 1
v_permlane32_swap_b32 v148,v149
v_add_f32 v148,v148,v149
v_rcp_f32 v148,v148
s_waitcnt vmcnt(0)
v_cmp_gt_u32 vcc,s66,v17
v_pk_mul_f32 v[138:139],v[138:139],v[148:149] op_sel_hi:[1,0]
v_pk_mul_f32 v[128:129],v[128:129],v[148:149] op_sel_hi:[1,0]
v_pk_mul_f32 v[130:131],v[130:131],v[148:149] op_sel_hi:[1,0]
v_pk_mul_f32 v[132:133],v[132:133],v[148:149] op_sel_hi:[1,0]
v_pk_mul_f32 v[134:135],v[134:135],v[148:149] op_sel_hi:[1,0]
s_cbranch_vccnz L_ap_105
L_apb_106:
s_xor_b32 s34,s69,524288
buffer_load_dwordx4 v[192:195],v7,s[8:11],s34 offen sc1
s_bfe_u32 s56,s66,0x10002
v_lshrrev_b32 v238,s56,v17
v_and_b32 v238,1,v238
v_cmp_ne_u32 vcc,0,v238
v_cvt_pk_bf16_f32 v144,v138,v139
v_cvt_pk_bf16_f32 v147,v138,v139
v_cvt_pk_bf16_f32 v140,v128,v129
v_cvt_pk_bf16_f32 v141,v130,v131
v_cvt_pk_bf16_f32 v142,v132,v133
v_cvt_pk_bf16_f32 v143,v134,v135
s_cbranch_vccnz L_ak_96
s_add_u32 s36,s36,4
v_mfma_f32_16x16x16_bf16 v[24:27],v[120:121],v[144:145],0
s_add_u32 s34,s34,4096
v_mfma_f32_16x16x16_bf16 v[28:31],v[120:121],v[146:147],0
buffer_load_dwordx4 v[196:199],v7,s[8:11],s34 offen sc1
v_mfma_f32_16x16x16_bf16 v[32:35],v[122:123],v[144:145],0
s_add_u32 s34,s34,4096
v_mfma_f32_16x16x16_bf16 v[36:39],v[122:123],v[146:147],0
buffer_load_dwordx4 v[200:203],v7,s[8:11],s34 offen sc1
v_mfma_f32_16x16x16_bf16 v[40:43],v[124:125],v[144:145],0
s_add_u32 s34,s34,4096
v_mfma_f32_16x16x16_bf16 v[44:47],v[124:125],v[146:147],0
buffer_load_dwordx4 v[204:207],v7,s[8:11],s34 offen sc1
v_mfma_f32_16x16x16_bf16 v[48:51],v[126:127],v[144:145],0
s_add_u32 s34,s34,4096
v_mfma_f32_16x16x16_bf16 v[52:55],v[126:127],v[146:147],0
buffer_load_dwordx4 v[208:211],v7,s[8:11],s34 offen sc1
v_mfma_f32_16x16x32_bf16 v[24:27],v[88:91],v[140:143],v[24:27]
s_add_u32 s34,s34,4096
v_mfma_f32_16x16x32_bf16 v[28:31],v[92:95],v[140:143],v[28:31]
buffer_load_dwordx4 v[212:215],v7,s[8:11],s34 offen sc1
v_mfma_f32_16x16x32_bf16 v[32:35],v[96:99],v[140:143],v[32:35]
s_add_u32 s34,s34,4096
v_mfma_f32_16x16x32_bf16 v[36:39],v[100:103],v[140:143],v[36:39]
buffer_load_dwordx4 v[216:219],v7,s[8:11],s34 offen sc1
v_cvt_pk_bf16_f32 v72,v24,v28
v_cvt_pk_bf16_f32 v73,v25,v29
v_mfma_f32_16x16x32_bf16 v[40:43],v[104:107],v[140:143],v[40:43]
s_add_u32 s34,s34,4096
v_cvt_pk_bf16_f32 v74,v26,v30
v_cvt_pk_bf16_f32 v75,v27,v31
v_mfma_f32_16x16x32_bf16 v[44:47],v[108:111],v[140:143],v[44:47]
ds_write_b128 v3,v[72:75] offset:0
v_cvt_pk_bf16_f32 v76,v32,v36
v_cvt_pk_bf16_f32 v77,v33,v37
v_mfma_f32_16x16x32_bf16 v[48:51],v[112:115],v[140:143],v[48:51]
buffer_load_dwordx4 v[220:223],v7,s[8:11],s34 offen sc1
v_cvt_pk_bf16_f32 v78,v34,v38
v_cvt_pk_bf16_f32 v79,v35,v39
v_mfma_f32_16x16x32_bf16 v[52:55],v[116:119],v[140:143],v[52:55]
ds_write_b128 v3,v[76:79] offset:1024
v_cvt_pk_bf16_f32 v80,v40,v44
v_cvt_pk_bf16_f32 v81,v41,v45
v_cvt_pk_bf16_f32 v82,v42,v46
v_cvt_pk_bf16_f32 v83,v43,v47
ds_write_b128 v3,v[80:83] offset:2048
s_nop 1
v_cvt_pk_bf16_f32 v84,v48,v52
v_cvt_pk_bf16_f32 v85,v49,v53
v_cvt_pk_bf16_f32 v86,v50,v54
v_cvt_pk_bf16_f32 v87,v51,v55
ds_write_b128 v3,v[84:87] offset:3072
s_cmp_eq_u32 s31,0
s_cbranch_scc1 L_ah_104
s_waitcnt lgkmcnt(0)
s_barrier
s_mov_b32 s26,s51
s_mov_b32 s51,s53
s_branch L_aa_88
L_ah_104:
s_cmp_ge_u32 s35,64
s_cbranch_scc1 L_a1_107
L_a2_108:
s_waitcnt lgkmcnt(0)
s_barrier
s_mov_b32 s26,s51
s_mov_b32 s51,s53
s_mov_b32 s31,1
s_branch L_av_92
L_ao_94:
s_xor_b32 s67,s67,65536
s_and_b32 s56,s50,2048
s_lshl_b32 s56,s56,4
s_add_u32 s56,s56,s67
v_add_u32 v2,s56,v0
v_add_u32 v239,s56,v253
s_and_b32 s56,s50,1024
s_lshl_b32 s56,s56,2
v_add_u32 v238,s56,v2
s_mov_b32 s76,s71
s_mov_b32 s53,s77
ds_read_b128 v[24:27],v238 offset:16384
ds_read_b128 v[40:43],v2 offset:0
ds_read_b128 v[56:59],v2 offset:4096
ds_read_b128 v[28:31],v238 offset:17408
ds_read_b128 v[44:47],v2 offset:1024
ds_read_b128 v[60:63],v2 offset:5120
ds_read_b128 v[32:35],v238 offset:18432
ds_read_b128 v[48:51],v2 offset:2048
ds_read_b128 v[64:67],v2 offset:6144
ds_read_b128 v[36:39],v238 offset:19456
ds_read_b128 v[52:55],v2 offset:3072
ds_read_b128 v[68:71],v2 offset:7168
buffer_load_dwordx4 v[72:75],v0,s[8:11],s76 offen offset:0 sc1
buffer_load_dwordx4 v[76:79],v0,s[8:11],s76 offen offset:1024 sc1
buffer_load_dwordx4 v[80:83],v0,s[8:11],s76 offen offset:2048 sc1
buffer_load_dwordx4 v[84:87],v0,s[8:11],s76 offen offset:3072 sc1
buffer_load_dwordx2 v[120:121],v253,s[8:11],s76 offen offset:0 sc1
buffer_load_dwordx2 v[122:123],v253,s[8:11],s76 offen offset:1024 sc1
buffer_load_dwordx2 v[124:125],v253,s[8:11],s76 offen offset:2048 sc1
buffer_load_dwordx2 v[126:127],v253,s[8:11],s76 offen offset:3072 sc1
s_waitcnt lgkmcnt(9)
v_mfma_f32_16x16x32_bf16 v[128:131],v[40:43],v[24:27],v[8:11]
ds_read_b128 v[88:91],v2 offset:8192
v_mfma_f32_16x16x32_bf16 v[132:135],v[56:59],v[24:27],v[12:15]
ds_read_b128 v[92:95],v2 offset:9216
s_waitcnt lgkmcnt(8)
v_mfma_f32_16x16x32_bf16 v[128:131],v[44:47],v[28:31],v[128:131]
ds_read_b128 v[96:99],v2 offset:10240
v_mfma_f32_16x16x32_bf16 v[132:135],v[60:63],v[28:31],v[132:135]
ds_read_b128 v[100:103],v2 offset:11264
s_waitcnt lgkmcnt(7)
v_mfma_f32_16x16x32_bf16 v[128:131],v[48:51],v[32:35],v[128:131]
ds_read_b128 v[104:107],v2 offset:12288
v_mfma_f32_16x16x32_bf16 v[132:135],v[64:67],v[32:35],v[132:135]
ds_read_b128 v[108:111],v2 offset:13312
s_waitcnt lgkmcnt(6)
v_mfma_f32_16x16x32_bf16 v[128:131],v[52:55],v[36:39],v[128:131]
ds_read_b128 v[112:115],v2 offset:14336
v_mfma_f32_16x16x32_bf16 v[132:135],v[68:71],v[36:39],v[132:135]
ds_read_b128 v[116:119],v2 offset:15360
s_add_u32 s66,s66,4
s_bfe_u32 s56,s66,0x10002
s_bitset0_b32 s37,s56
s_lshl_b32 s56,0,s56
s_or_b32 s37,s37,s56
s_or_b32 s56,s37,s66
v_mov_b32 v22,s56
s_xor_b32 s69,s69,524288
s_waitcnt vmcnt(8) lgkmcnt(0)
buffer_store_dword v22,off,s[8:11],s74
s_mov_b32 s26,s51
s_mov_b32 s27,3
s_branch L_aa_83
L_aa_76:
s_add_u32 s66,s66,4
s_bfe_u32 s56,s66,0x10002
s_bitset0_b32 s37,s56
s_lshl_b32 s56,0,s56
s_or_b32 s37,s37,s56
s_or_b32 s56,s37,s66
v_mov_b32 v22,s56
s_xor_b32 s69,s69,524288
s_waitcnt vmcnt(0) lgkmcnt(0)
buffer_store_dword v22,off,s[8:11],s74
L_aq_109:
buffer_load_dword v17,v16,s[8:11],s87 offen sc1
s_sub_u32 s49,s49,1
s_cbranch_scc1 L_abort
s_waitcnt vmcnt(0)
v_cmp_gt_u32 vcc,s66,v17
s_cbranch_vccnz L_aq_109
s_xor_b32 s34,s69,524288
buffer_load_dwordx4 v[160:163],v7,s[8:11],s34 offen sc1
s_add_u32 s34,s34,4096
buffer_load_dwordx4 v[164:167],v7,s[8:11],s34 offen sc1
s_add_u32 s34,s34,4096
buffer_load_dwordx4 v[168:171],v7,s[8:11],s34 offen sc1
s_add_u32 s34,s34,4096
buffer_load_dwordx4 v[172:175],v7,s[8:11],s34 offen sc1
s_add_u32 s34,s34,4096
buffer_load_dwordx4 v[176:179],v7,s[8:11],s34 offen sc1
s_add_u32 s34,s34,4096
buffer_load_dwordx4 v[180:183],v7,s[8:11],s34 offen sc1
s_add_u32 s34,s34,4096
buffer_load_dwordx4 v[184:187],v7,s[8:11],s34 offen sc1
s_add_u32 s34,s34,4096
buffer_load_dwordx4 v[188:191],v7,s[8:11],s34 offen sc1
buffer_load_dwordx4 v[72:75],v0,s[8:11],s76 offen offset:0 sc1
buffer_load_dwordx4 v[76:79],v0,s[8:11],s76 offen offset:1024 sc1
buffer_load_dwordx4 v[80:83],v0,s[8:11],s76 offen offset:2048 sc1
buffer_load_dwordx4 v[84:87],v0,s[8:11],s76 offen offset:3072 sc1
buffer_load_dwordx2 v[120:121],v253,s[8:11],s76 offen offset:0 sc1
buffer_load_dwordx2 v[122:123],v253,s[8:11],s76 offen offset:1024 sc1
buffer_load_dwordx2 v[124:125],v253,s[8:11],s76 offen offset:2048 sc1
buffer_load_dwordx2 v[126:127],v253,s[8:11],s76 offen offset:3072 sc1
s_waitcnt vmcnt(15)
v_mfma_f32_16x16x32_bf16 v[192:195],v[156:159],v[160:163],0
s_waitcnt vmcnt(14)
v_mfma_f32_16x16x32_bf16 v[192:195],v[156:159],v[164:167],v[192:195]
s_waitcnt vmcnt(13)
v_mfma_f32_16x16x32_bf16 v[192:195],v[156:159],v[168:171],v[192:195]
s_waitcnt vmcnt(12)
v_mfma_f32_16x16x32_bf16 v[192:195],v[156:159],v[172:175],v[192:195]
s_waitcnt vmcnt(11)
v_mfma_f32_16x16x32_bf16 v[196:199],v[156:159],v[176:179],0
s_waitcnt vmcnt(10)
v_mfma_f32_16x16x32_bf16 v[196:199],v[156:159],v[180:183],v[196:199]
s_waitcnt vmcnt(9)
v_mfma_f32_16x16x32_bf16 v[196:199],v[156:159],v[184:187],v[196:199]
ds_write_b128 v6,v[192:195]
s_waitcnt vmcnt(8)
v_mfma_f32_16x16x32_bf16 v[196:199],v[156:159],v[188:191],v[196:199]
s_nop 7
ds_write_b128 v6,v[196:199] offset:2048
s_waitcnt lgkmcnt(0)
s_barrier
buffer_store_dword v20,off,s[8:11],s73 sc1
s_mov_b32 s73,0x80000000
s_mov_b32 s27,0
s_branch L_aa_79
L_aa_77:
s_add_u32 s56,s30,s86
s_cmp_lg_u32 s56,1537
s_cbranch_scc1 L_al_95
s_add_u32 s66,s66,4
s_bfe_u32 s56,s66,0x10002
s_bitset0_b32 s37,s56
s_lshl_b32 s56,1,s56
s_or_b32 s37,s37,s56
s_or_b32 s56,s37,s66
v_mov_b32 v22,s56
s_xor_b32 s69,s69,524288
s_waitcnt vmcnt(0) lgkmcnt(0)
buffer_store_dword v22,off,s[8:11],s74
s_cmp_lg_u32 s86,1536
s_cbranch_scc1 L_ae_110
s_mov_b32 s77,s35
s_mov_b32 s30,0
s_lshl_b32 s56,s77,5
s_add_u32 s56,s56,s68
s_mul_i32 s70,s56,24576
s_lshl_b32 s71,s56,12
s_lshl_b32 s59,s77,13
s_lshl2_add_u32 s59,s68,s59
s_add_u32 s59,s59,10485760
s_buffer_load_dword s32,s[8:11],s59
s_mov_b32 s33,1
s_add_u32 s70,s70,100663296
s_add_u32 s71,s71,41943040
v_mov_b32 v19,s59
s_branch L_af_111
L_ae_110:
s_ff1_i32_b64 s77,s[84:85]
s_bitset0_b64 s[84:85],s77
s_min_u32 s77,s77,64
s_lshr_b32 s61,s55,5
s_lshl_b32 s56,s77,5
s_add_u32 s56,s56,s68
s_mul_i32 s70,s56,24576
s_lshl_b32 s71,s56,12
s_lshl_b32 s59,s77,13
s_lshl2_add_u32 s59,s68,s59
s_add_u32 s59,s59,10486144
s_cmp_lt_u32 s77,s61
s_cselect_b32 s57,0,16777216
s_mov_b32 s60,s59
s_buffer_load_dword s33,s[8:11],s60
s_add_u32 s71,s71,s57
s_add_u32 s71,s71,58720256
s_cmp_eq_u32 s77,s61
s_cselect_b32 s57,50331648,0
s_cselect_b32 s58,1536,0
s_add_u32 s59,s59,s58
s_buffer_load_dword s32,s[8:11],s59
s_add_u32 s70,s70,s57
s_add_u32 s70,s70,150994944
v_mov_b32 v19,s59
v_writelane_b32 v19,s60,1
L_af_111:
s_branch L_ak_96
L_al_95:
s_add_u32 s66,s66,4
s_bfe_u32 s56,s66,0x10002
s_bitset0_b32 s37,s56
s_lshl_b32 s56,0,s56
s_or_b32 s37,s37,s56
s_or_b32 s56,s37,s66
v_mov_b32 v22,s56
s_xor_b32 s69,s69,524288
s_waitcnt vmcnt(0) lgkmcnt(0)
buffer_store_dword v22,off,s[8:11],s74
buffer_store_dword v20,off,s[8:11],s73 sc1
s_mov_b32 s73,0x80000000
L_ak_96:
L_aq_112:
buffer_load_dword v17,v16,s[8:11],s87 offen sc1
s_sub_u32 s49,s49,1
s_cbranch_scc1 L_abort
s_waitcnt vmcnt(0)
v_cmp_gt_u32 vcc,s66,v17
s_cbranch_vccnz L_aq_112
s_xor_b32 s34,s69,524288
buffer_load_dwordx4 v[160:163],v7,s[8:11],s34 offen sc1
s_add_u32 s34,s34,4096
buffer_load_dwordx4 v[164:167],v7,s[8:11],s34 offen sc1
s_add_u32 s34,s34,4096
buffer_load_dwordx4 v[168:171],v7,s[8:11],s34 offen sc1
s_add_u32 s34,s34,4096
buffer_load_dwordx4 v[172:175],v7,s[8:11],s34 offen sc1
s_add_u32 s34,s34,4096
buffer_load_dwordx4 v[176:179],v7,s[8:11],s34 offen sc1
s_add_u32 s34,s34,4096
buffer_load_dwordx4 v[180:183],v7,s[8:11],s34 offen sc1
s_add_u32 s34,s34,4096
buffer_load_dwordx4 v[184:187],v7,s[8:11],s34 offen sc1
s_add_u32 s34,s34,4096
buffer_load_dwordx4 v[188:191],v7,s[8:11],s34 offen sc1
s_waitcnt vmcnt(7)
v_mfma_f32_16x16x32_bf16 v[192:195],v[156:159],v[160:163],0
s_waitcnt vmcnt(6)
v_mfma_f32_16x16x32_bf16 v[192:195],v[156:159],v[164:167],v[192:195]
s_waitcnt vmcnt(5)
v_mfma_f32_16x16x32_bf16 v[192:195],v[156:159],v[168:171],v[192:195]
s_waitcnt vmcnt(4)
v_mfma_f32_16x16x32_bf16 v[192:195],v[156:159],v[172:175],v[192:195]
s_waitcnt vmcnt(3)
v_mfma_f32_16x16x32_bf16 v[196:199],v[156:159],v[176:179],0
s_waitcnt vmcnt(2)
v_mfma_f32_16x16x32_bf16 v[196:199],v[156:159],v[180:183],v[196:199]
s_waitcnt vmcnt(1)
v_mfma_f32_16x16x32_bf16 v[196:199],v[156:159],v[184:187],v[196:199]
ds_write_b128 v6,v[192:195]
s_waitcnt vmcnt(0)
v_mfma_f32_16x16x32_bf16 v[196:199],v[156:159],v[188:191],v[196:199]
s_nop 7
ds_write_b128 v6,v[196:199] offset:2048
s_waitcnt lgkmcnt(0)
s_barrier
buffer_store_dword v20,off,s[8:11],s73 sc1
s_mov_b32 s73,0x80000000
s_mov_b32 s27,2
L_aa_79:
s_cmp_lg_u32 s31,0
s_cbranch_scc1 L_ar_115
s_bitcmp1_b32 s46,0
s_cbranch_scc1 L_ar_114
L_ar_113:
ds_read_b128 v[160:163],v23
ds_read_b128 v[164:167],v23 offset:16
v_lshlrev_b32 v200,16,v224
v_and_b32 v201,0xffff0000,v224
v_lshlrev_b32 v202,16,v225
v_and_b32 v203,0xffff0000,v225
v_lshlrev_b32 v204,16,v226
v_and_b32 v205,0xffff0000,v226
v_lshlrev_b32 v206,16,v227
v_and_b32 v207,0xffff0000,v227
s_lshl_b32 s18,s51,5
s_add_u32 s18,s18,s68
s_lshl_b32 s19,s18,10
s_add_u32 s20,s19,8388608
s_waitcnt lgkmcnt(0)
v_cvt_pk_bf16_f32 v168,v160,v161
v_cvt_pk_bf16_f32 v169,v162,v163
v_cvt_pk_bf16_f32 v170,v164,v165
v_cvt_pk_bf16_f32 v171,v166,v167
v_lshlrev_b32 v160,16,v168
v_and_b32 v161,0xffff0000,v168
v_lshlrev_b32 v162,16,v169
v_and_b32 v163,0xffff0000,v169
v_lshlrev_b32 v164,16,v170
v_and_b32 v165,0xffff0000,v170
v_lshlrev_b32 v166,16,v171
v_and_b32 v167,0xffff0000,v171
v_pk_add_f32 v[200:201],v[200:201],v[160:161]
v_pk_add_f32 v[202:203],v[202:203],v[162:163]
v_pk_add_f32 v[204:205],v[204:205],v[164:165]
v_pk_add_f32 v[206:207],v[206:207],v[166:167]
v_cvt_pk_bf16_f32 v168,v200,v201
v_cvt_pk_bf16_f32 v169,v202,v203
v_cvt_pk_bf16_f32 v170,v204,v205
v_cvt_pk_bf16_f32 v171,v206,v207
v_lshlrev_b32 v200,16,v168
v_and_b32 v201,0xffff0000,v168
v_lshlrev_b32 v202,16,v169
v_and_b32 v203,0xffff0000,v169
v_lshlrev_b32 v204,16,v170
v_and_b32 v205,0xffff0000,v170
v_lshlrev_b32 v206,16,v171
v_and_b32 v207,0xffff0000,v171
v_readfirstlane_b32 s78,v200
s_nop 1
v_pk_add_f32 v[184:185],v[200:201],s[78:79] op_sel_hi:[1,0] neg_lo:[0,1] neg_hi:[0,1]
v_pk_add_f32 v[186:187],v[202:203],s[78:79] op_sel_hi:[1,0] neg_lo:[0,1] neg_hi:[0,1]
v_pk_add_f32 v[188:189],v[204:205],s[78:79] op_sel_hi:[1,0] neg_lo:[0,1] neg_hi:[0,1]
v_pk_add_f32 v[190:191],v[206:207],s[78:79] op_sel_hi:[1,0] neg_lo:[0,1] neg_hi:[0,1]
v_pk_add_f32 v[192:193],v[184:185],v[186:187]
v_pk_mul_f32 v[194:195],v[184:185],v[184:185]
v_pk_add_f32 v[196:197],v[188:189],v[190:191]
v_pk_fma_f32 v[194:195],v[186:187],v[186:187],v[194:195]
v_pk_add_f32 v[192:193],v[192:193],v[196:197]
v_pk_fma_f32 v[194:195],v[188:189],v[188:189],v[194:195]
v_add_f32 v192,v192,v193
v_pk_fma_f32 v[194:195],v[190:191],v[190:191],v[194:195]
v_add_f32 v194,v194,v195
s_nop 1
v_permlane32_swap_b32 v192,v194
v_add_f32 v192,v192,v194
s_nop 1
v_add_f32_dpp v192,v192,v192 row_ror:8 row_mask:0xf bank_mask:0xf
s_nop 1
v_add_f32_dpp v192,v192,v192 row_ror:4 row_mask:0xf bank_mask:0xf
s_nop 1
v_add_f32_dpp v192,v192,v192 row_ror:2 row_mask:0xf bank_mask:0xf
s_nop 1
v_add_f32_dpp v192,v192,v192 row_ror:1 row_mask:0xf bank_mask:0xf
v_mov_b32 v194,v192
s_nop 1
v_permlane16_swap_b32 v192,v194
v_add_f32 v192,v192,v194
v_mul_f32 v192,0x3b000000,v192
v_mov_b32 v194,v192
s_nop 1
v_permlane32_swap_b32 v192,v194
v_fma_f32 v194,-v192,v192,v194
v_add_f32 v192,s78,v192
v_max_f32 v194,0,v194
v_cvt_pk_bf16_f32 v194,v192,v194
v_lshlrev_b32 v192,16,v194
v_and_b32 v194,0xffff0000,v194
v_add_f32 v194,0x3727c5ac,v194
v_cvt_pk_bf16_f32 v194,v194,v194
v_and_b32 v194,0xffff0000,v194
v_sqrt_f32 v194,v194
v_pk_add_f32 v[184:185],v[200:201],v[192:193] op_sel_hi:[1,0] neg_lo:[0,1] neg_hi:[0,1]
v_pk_add_f32 v[186:187],v[202:203],v[192:193] op_sel_hi:[1,0] neg_lo:[0,1] neg_hi:[0,1]
v_pk_add_f32 v[188:189],v[204:205],v[192:193] op_sel_hi:[1,0] neg_lo:[0,1] neg_hi:[0,1]
v_pk_add_f32 v[190:191],v[206:207],v[192:193] op_sel_hi:[1,0] neg_lo:[0,1] neg_hi:[0,1]
v_cvt_pk_bf16_f32 v194,v194,v194
v_and_b32 v194,0xffff0000,v194
v_rcp_f32 v194,v194
v_cvt_pk_bf16_f32 v172,v184,v185
v_cvt_pk_bf16_f32 v173,v186,v187
v_cvt_pk_bf16_f32 v174,v188,v189
v_cvt_pk_bf16_f32 v175,v190,v191
v_lshlrev_b32 v184,16,v172
v_and_b32 v185,0xffff0000,v172
v_lshlrev_b32 v186,16,v173
v_and_b32 v187,0xffff0000,v173
v_lshlrev_b32 v188,16,v174
v_and_b32 v189,0xffff0000,v174
v_lshlrev_b32 v190,16,v175
v_and_b32 v191,0xffff0000,v175
v_pk_mul_f32 v[184:185],v[184:185],v[194:195] op_sel_hi:[1,0]
v_pk_mul_f32 v[186:187],v[186:187],v[194:195] op_sel_hi:[1,0]
v_pk_mul_f32 v[188:189],v[188:189],v[194:195] op_sel_hi:[1,0]
v_pk_mul_f32 v[190:191],v[190:191],v[194:195] op_sel_hi:[1,0]
v_cvt_pk_bf16_f32 v172,v184,v185
v_cvt_pk_bf16_f32 v173,v186,v187
v_cvt_pk_bf16_f32 v174,v188,v189
v_cvt_pk_bf16_f32 v175,v190,v191
v_lshlrev_b32 v176,16,v172
v_and_b32 v177,0xffff0000,v172
v_lshlrev_b32 v178,16,v173
v_and_b32 v179,0xffff0000,v173
v_lshlrev_b32 v180,16,v174
v_and_b32 v181,0xffff0000,v174
v_lshlrev_b32 v182,16,v175
v_and_b32 v183,0xffff0000,v175
v_pk_add_f32 v[200:201],v[200:201],v[176:177]
v_pk_add_f32 v[202:203],v[202:203],v[178:179]
v_pk_add_f32 v[204:205],v[204:205],v[180:181]
v_pk_add_f32 v[206:207],v[206:207],v[182:183]
v_cvt_pk_bf16_f32 v160,v200,v201
v_cvt_pk_bf16_f32 v161,v202,v203
v_cvt_pk_bf16_f32 v162,v204,v205
v_cvt_pk_bf16_f32 v163,v206,v207
buffer_store_dwordx4 v[160:163],v0,s[8:11],s20 offen sc1
v_lshlrev_b32 v200,16,v160
v_and_b32 v201,0xffff0000,v160
v_lshlrev_b32 v202,16,v161
v_and_b32 v203,0xffff0000,v161
v_lshlrev_b32 v204,16,v162
v_and_b32 v205,0xffff0000,v162
v_lshlrev_b32 v206,16,v163
v_and_b32 v207,0xffff0000,v163
v_readfirstlane_b32 s78,v200
s_nop 1
v_pk_add_f32 v[184:185],v[200:201],s[78:79] op_sel_hi:[1,0] neg_lo:[0,1] neg_hi:[0,1]
v_pk_add_f32 v[186:187],v[202:203],s[78:79] op_sel_hi:[1,0] neg_lo:[0,1] neg_hi:[0,1]
v_pk_add_f32 v[188:189],v[204:205],s[78:79] op_sel_hi:[1,0] neg_lo:[0,1] neg_hi:[0,1]
v_pk_add_f32 v[190:191],v[206:207],s[78:79] op_sel_hi:[1,0] neg_lo:[0,1] neg_hi:[0,1]
v_pk_add_f32 v[192:193],v[184:185],v[186:187]
v_pk_mul_f32 v[194:195],v[184:185],v[184:185]
v_pk_add_f32 v[196:197],v[188:189],v[190:191]
v_pk_fma_f32 v[194:195],v[186:187],v[186:187],v[194:195]
v_pk_add_f32 v[192:193],v[192:193],v[196:197]
v_pk_fma_f32 v[194:195],v[188:189],v[188:189],v[194:195]
v_add_f32 v192,v192,v193
v_pk_fma_f32 v[194:195],v[190:191],v[190:191],v[194:195]
v_add_f32 v194,v194,v195
s_nop 1
v_permlane32_swap_b32 v192,v194
v_add_f32 v192,v192,v194
s_nop 1
v_add_f32_dpp v192,v192,v192 row_ror:8 row_mask:0xf bank_mask:0xf
s_nop 1
v_add_f32_dpp v192,v192,v192 row_ror:4 row_mask:0xf bank_mask:0xf
s_nop 1
v_add_f32_dpp v192,v192,v192 row_ror:2 row_mask:0xf bank_mask:0xf
s_nop 1
v_add_f32_dpp v192,v192,v192 row_ror:1 row_mask:0xf bank_mask:0xf
v_mov_b32 v194,v192
s_nop 1
v_permlane16_swap_b32 v192,v194
v_add_f32 v192,v192,v194
v_mul_f32 v192,0x3b000000,v192
v_mov_b32 v194,v192
s_nop 1
v_permlane32_swap_b32 v192,v194
v_fma_f32 v194,-v192,v192,v194
v_add_f32 v192,s78,v192
v_max_f32 v194,0,v194
v_cvt_pk_bf16_f32 v194,v192,v194
v_lshlrev_b32 v192,16,v194
v_and_b32 v194,0xffff0000,v194
v_add_f32 v194,0x3727c5ac,v194
v_cvt_pk_bf16_f32 v194,v194,v194
v_and_b32 v194,0xffff0000,v194
v_sqrt_f32 v194,v194
v_pk_add_f32 v[184:185],v[200:201],v[192:193] op_sel_hi:[1,0] neg_lo:[0,1] neg_hi:[0,1]
v_pk_add_f32 v[186:187],v[202:203],v[192:193] op_sel_hi:[1,0] neg_lo:[0,1] neg_hi:[0,1]
v_pk_add_f32 v[188:189],v[204:205],v[192:193] op_sel_hi:[1,0] neg_lo:[0,1] neg_hi:[0,1]
v_pk_add_f32 v[190:191],v[206:207],v[192:193] op_sel_hi:[1,0] neg_lo:[0,1] neg_hi:[0,1]
v_cvt_pk_bf16_f32 v194,v194,v194
v_and_b32 v194,0xffff0000,v194
v_rcp_f32 v194,v194
v_cvt_pk_bf16_f32 v164,v184,v185
v_cvt_pk_bf16_f32 v165,v186,v187
v_cvt_pk_bf16_f32 v166,v188,v189
v_cvt_pk_bf16_f32 v167,v190,v191
v_lshlrev_b32 v184,16,v164
v_and_b32 v185,0xffff0000,v164
v_lshlrev_b32 v186,16,v165
v_and_b32 v187,0xffff0000,v165
v_lshlrev_b32 v188,16,v166
v_and_b32 v189,0xffff0000,v166
v_lshlrev_b32 v190,16,v167
v_and_b32 v191,0xffff0000,v167
v_pk_mul_f32 v[184:185],v[184:185],v[194:195] op_sel_hi:[1,0]
v_pk_mul_f32 v[186:187],v[186:187],v[194:195] op_sel_hi:[1,0]
v_pk_mul_f32 v[188:189],v[188:189],v[194:195] op_sel_hi:[1,0]
v_pk_mul_f32 v[190:191],v[190:191],v[194:195] op_sel_hi:[1,0]
v_cvt_pk_bf16_f32 v164,v184,v185
v_cvt_pk_bf16_f32 v165,v186,v187
v_cvt_pk_bf16_f32 v166,v188,v189
v_cvt_pk_bf16_f32 v167,v190,v191
s_add_u32 s20,s19,2097152
buffer_store_dwordx4 v[164:167],v0,s[8:11],s20 offen sc1
v_mov_b32 v20,1
s_lshl_b32 s73,s51,13
s_lshl2_add_u32 s73,s68,s73
s_add_u32 s73,s73,10487552
s_branch L_aa_80
L_ar_114:
ds_read_b128 v[160:163],v23
ds_read_b128 v[164:167],v23 offset:16
v_lshlrev_b32 v200,16,v224
v_and_b32 v201,0xffff0000,v224
v_lshlrev_b32 v202,16,v225
v_and_b32 v203,0xffff0000,v225
v_lshlrev_b32 v204,16,v226
v_and_b32 v205,0xffff0000,v226
v_lshlrev_b32 v206,16,v227
v_and_b32 v207,0xffff0000,v227
s_lshl_b32 s18,s51,5
s_add_u32 s18,s18,s68
s_lshl_b32 s19,s18,10
s_add_u32 s20,s19,4194304
s_waitcnt lgkmcnt(0)
v_cvt_pk_bf16_f32 v168,v160,v161
v_cvt_pk_bf16_f32 v169,v162,v163
v_cvt_pk_bf16_f32 v170,v164,v165
v_cvt_pk_bf16_f32 v171,v166,v167
v_lshlrev_b32 v160,16,v168
v_and_b32 v161,0xffff0000,v168
v_lshlrev_b32 v162,16,v169
v_and_b32 v163,0xffff0000,v169
v_lshlrev_b32 v164,16,v170
v_and_b32 v165,0xffff0000,v170
v_lshlrev_b32 v166,16,v171
v_and_b32 v167,0xffff0000,v171
v_pk_add_f32 v[200:201],v[200:201],v[160:161]
v_pk_add_f32 v[202:203],v[202:203],v[162:163]
v_pk_add_f32 v[204:205],v[204:205],v[164:165]
v_pk_add_f32 v[206:207],v[206:207],v[166:167]
v_cvt_pk_bf16_f32 v168,v200,v201
v_cvt_pk_bf16_f32 v169,v202,v203
v_cvt_pk_bf16_f32 v170,v204,v205
v_cvt_pk_bf16_f32 v171,v206,v207
buffer_store_dwordx4 v[168:171],v0,s[8:11],s20 offen sc1
v_lshlrev_b32 v200,16,v168
v_and_b32 v201,0xffff0000,v168
v_lshlrev_b32 v202,16,v169
v_and_b32 v203,0xffff0000,v169
v_lshlrev_b32 v204,16,v170
v_and_b32 v205,0xffff0000,v170
v_lshlrev_b32 v206,16,v171
v_and_b32 v207,0xffff0000,v171
v_readfirstlane_b32 s78,v200
s_nop 1
v_pk_add_f32 v[184:185],v[200:201],s[78:79] op_sel_hi:[1,0] neg_lo:[0,1] neg_hi:[0,1]
v_pk_add_f32 v[186:187],v[202:203],s[78:79] op_sel_hi:[1,0] neg_lo:[0,1] neg_hi:[0,1]
v_pk_add_f32 v[188:189],v[204:205],s[78:79] op_sel_hi:[1,0] neg_lo:[0,1] neg_hi:[0,1]
v_pk_add_f32 v[190:191],v[206:207],s[78:79] op_sel_hi:[1,0] neg_lo:[0,1] neg_hi:[0,1]
v_pk_add_f32 v[192:193],v[184:185],v[186:187]
v_pk_mul_f32 v[194:195],v[184:185],v[184:185]
v_pk_add_f32 v[196:197],v[188:189],v[190:191]
v_pk_fma_f32 v[194:195],v[186:187],v[186:187],v[194:195]
v_pk_add_f32 v[192:193],v[192:193],v[196:197]
v_pk_fma_f32 v[194:195],v[188:189],v[188:189],v[194:195]
v_add_f32 v192,v192,v193
v_pk_fma_f32 v[194:195],v[190:191],v[190:191],v[194:195]
v_add_f32 v194,v194,v195
s_nop 1
v_permlane32_swap_b32 v192,v194
v_add_f32 v192,v192,v194
s_nop 1
v_add_f32_dpp v192,v192,v192 row_ror:8 row_mask:0xf bank_mask:0xf
s_nop 1
v_add_f32_dpp v192,v192,v192 row_ror:4 row_mask:0xf bank_mask:0xf
s_nop 1
v_add_f32_dpp v192,v192,v192 row_ror:2 row_mask:0xf bank_mask:0xf
s_nop 1
v_add_f32_dpp v192,v192,v192 row_ror:1 row_mask:0xf bank_mask:0xf
v_mov_b32 v194,v192
s_nop 1
v_permlane16_swap_b32 v192,v194
v_add_f32 v192,v192,v194
v_mul_f32 v192,0x3b000000,v192
v_mov_b32 v194,v192
s_nop 1
v_permlane32_swap_b32 v192,v194
v_fma_f32 v194,-v192,v192,v194
v_add_f32 v192,s78,v192
v_max_f32 v194,0,v194
v_cvt_pk_bf16_f32 v194,v192,v194
v_lshlrev_b32 v192,16,v194
v_and_b32 v194,0xffff0000,v194
v_add_f32 v194,0x3727c5ac,v194
v_cvt_pk_bf16_f32 v194,v194,v194
v_and_b32 v194,0xffff0000,v194
v_sqrt_f32 v194,v194
v_pk_add_f32 v[184:185],v[200:201],v[192:193] op_sel_hi:[1,0] neg_lo:[0,1] neg_hi:[0,1]
v_pk_add_f32 v[186:187],v[202:203],v[192:193] op_sel_hi:[1,0] neg_lo:[0,1] neg_hi:[0,1]
v_pk_add_f32 v[188:189],v[204:205],v[192:193] op_sel_hi:[1,0] neg_lo:[0,1] neg_hi:[0,1]
v_pk_add_f32 v[190:191],v[206:207],v[192:193] op_sel_hi:[1,0] neg_lo:[0,1] neg_hi:[0,1]
v_cvt_pk_bf16_f32 v194,v194,v194
v_and_b32 v194,0xffff0000,v194
v_rcp_f32 v194,v194
v_cvt_pk_bf16_f32 v172,v184,v185
v_cvt_pk_bf16_f32 v173,v186,v187
v_cvt_pk_bf16_f32 v174,v188,v189
v_cvt_pk_bf16_f32 v175,v190,v191
v_lshlrev_b32 v184,16,v172
v_and_b32 v185,0xffff0000,v172
v_lshlrev_b32 v186,16,v173
v_and_b32 v187,0xffff0000,v173
v_lshlrev_b32 v188,16,v174
v_and_b32 v189,0xffff0000,v174
v_lshlrev_b32 v190,16,v175
v_and_b32 v191,0xffff0000,v175
v_pk_mul_f32 v[184:185],v[184:185],v[194:195] op_sel_hi:[1,0]
v_pk_mul_f32 v[186:187],v[186:187],v[194:195] op_sel_hi:[1,0]
v_pk_mul_f32 v[188:189],v[188:189],v[194:195] op_sel_hi:[1,0]
v_pk_mul_f32 v[190:191],v[190:191],v[194:195] op_sel_hi:[1,0]
v_cvt_pk_bf16_f32 v172,v184,v185
v_cvt_pk_bf16_f32 v173,v186,v187
v_cvt_pk_bf16_f32 v174,v188,v189
v_cvt_pk_bf16_f32 v175,v190,v191
v_lshlrev_b32 v176,16,v172
v_and_b32 v177,0xffff0000,v172
v_lshlrev_b32 v178,16,v173
v_and_b32 v179,0xffff0000,v173
v_lshlrev_b32 v180,16,v174
v_and_b32 v181,0xffff0000,v174
v_lshlrev_b32 v182,16,v175
v_and_b32 v183,0xffff0000,v175
v_pk_mul_f32 v[236:237],v[176:177],v[228:229]
v_pk_fma_f32 v[236:237],v[178:179],v[230:231],v[236:237]
v_pk_fma_f32 v[236:237],v[180:181],v[232:233],v[236:237]
v_pk_fma_f32 v[236:237],v[182:183],v[234:235],v[236:237]
v_add_f32 v236,v236,v237
s_nop 1
v_add_f32_dpp v236,v236,v236 row_ror:8 row_mask:0xf bank_mask:0xf
s_nop 1
v_add_f32_dpp v236,v236,v236 row_ror:4 row_mask:0xf bank_mask:0xf
s_nop 1
v_add_f32_dpp v236,v236,v236 row_ror:2 row_mask:0xf bank_mask:0xf
s_nop 1
v_add_f32_dpp v236,v236,v236 row_ror:1 row_mask:0xf bank_mask:0xf
v_mov_b32 v237,v236
s_nop 1
v_permlane16_swap_b32 v236,v237
v_add_f32 v236,v236,v237
v_mov_b32 v237,v236
s_nop 1
v_permlane32_swap_b32 v236,v237
v_add_f32 v236,v236,v237
v_cvt_pk_bf16_f32 v236,v236,v236
v_and_b32 v236,0xffff0000,v236
v_ashrrev_i32 v237,31,v236
v_or_b32 v237,0x80000000,v237
v_xor_b32 v236,v236,v237
v_and_b32 v236,0xffff0000,v236
s_sub_u32 s20,4095,s18
v_or_b32 v20,s20,v236
s_lshl_b32 s20,s51,13
s_lshl2_add_u32 s20,s68,s20
s_add_u32 s20,s20,10485760
buffer_store_dword v20,v254,s[8:11],s20 offen sc1
s_branch L_aa_80
L_ar_115:
s_bitcmp1_b32 s46,0
s_cbranch_scc1 L_aa_80
ds_read_b128 v[160:163],v23
ds_read_b128 v[164:167],v23 offset:16
v_lshlrev_b32 v200,16,v224
v_and_b32 v201,0xffff0000,v224
v_lshlrev_b32 v202,16,v225
v_and_b32 v203,0xffff0000,v225
v_lshlrev_b32 v204,16,v226
v_and_b32 v205,0xffff0000,v226
v_lshlrev_b32 v206,16,v227
v_and_b32 v207,0xffff0000,v227
v_readfirstlane_b32 s22,v246
s_cmp_eq_u32 s22,0
s_cbranch_scc1 L_ag_116
L_agb_117:
s_lshl_b32 s18,s51,5
s_add_u32 s18,s18,s68
s_lshl_b32 s19,s18,10
s_add_u32 s20,s19,6291456
s_waitcnt lgkmcnt(0)
v_cvt_pk_bf16_f32 v168,v160,v161
v_cvt_pk_bf16_f32 v169,v162,v163
v_cvt_pk_bf16_f32 v170,v164,v165
v_cvt_pk_bf16_f32 v171,v166,v167
v_lshlrev_b32 v160,16,v168
v_and_b32 v161,0xffff0000,v168
v_lshlrev_b32 v162,16,v169
v_and_b32 v163,0xffff0000,v169
v_lshlrev_b32 v164,16,v170
v_and_b32 v165,0xffff0000,v170
v_lshlrev_b32 v166,16,v171
v_and_b32 v167,0xffff0000,v171
v_pk_add_f32 v[200:201],v[200:201],v[160:161]
v_pk_add_f32 v[202:203],v[202:203],v[162:163]
v_pk_add_f32 v[204:205],v[204:205],v[164:165]
v_pk_add_f32 v[206:207],v[206:207],v[166:167]
v_cvt_pk_bf16_f32 v168,v200,v201
v_cvt_pk_bf16_f32 v169,v202,v203
v_cvt_pk_bf16_f32 v170,v204,v205
v_cvt_pk_bf16_f32 v171,v206,v207
buffer_store_dwordx4 v[168:171],v0,s[8:11],s20 offen sc1
v_lshlrev_b32 v200,16,v168
v_and_b32 v201,0xffff0000,v168
v_lshlrev_b32 v202,16,v169
v_and_b32 v203,0xffff0000,v169
v_lshlrev_b32 v204,16,v170
v_and_b32 v205,0xffff0000,v170
v_lshlrev_b32 v206,16,v171
v_and_b32 v207,0xffff0000,v171
v_readfirstlane_b32 s78,v200
s_nop 1
v_pk_add_f32 v[184:185],v[200:201],s[78:79] op_sel_hi:[1,0] neg_lo:[0,1] neg_hi:[0,1]
v_pk_add_f32 v[186:187],v[202:203],s[78:79] op_sel_hi:[1,0] neg_lo:[0,1] neg_hi:[0,1]
v_pk_add_f32 v[188:189],v[204:205],s[78:79] op_sel_hi:[1,0] neg_lo:[0,1] neg_hi:[0,1]
v_pk_add_f32 v[190:191],v[206:207],s[78:79] op_sel_hi:[1,0] neg_lo:[0,1] neg_hi:[0,1]
v_pk_add_f32 v[192:193],v[184:185],v[186:187]
v_pk_mul_f32 v[194:195],v[184:185],v[184:185]
v_pk_add_f32 v[196:197],v[188:189],v[190:191]
v_pk_fma_f32 v[194:195],v[186:187],v[186:187],v[194:195]
v_pk_add_f32 v[192:193],v[192:193],v[196:197]
v_pk_fma_f32 v[194:195],v[188:189],v[188:189],v[194:195]
v_add_f32 v192,v192,v193
v_pk_fma_f32 v[194:195],v[190:191],v[190:191],v[194:195]
v_add_f32 v194,v194,v195
s_nop 1
v_permlane32_swap_b32 v192,v194
v_add_f32 v192,v192,v194
s_nop 1
v_add_f32_dpp v192,v192,v192 row_ror:8 row_mask:0xf bank_mask:0xf
s_nop 1
v_add_f32_dpp v192,v192,v192 row_ror:4 row_mask:0xf bank_mask:0xf
s_nop 1
v_add_f32_dpp v192,v192,v192 row_ror:2 row_mask:0xf bank_mask:0xf
s_nop 1
v_add_f32_dpp v192,v192,v192 row_ror:1 row_mask:0xf bank_mask:0xf
v_mov_b32 v194,v192
s_nop 1
v_permlane16_swap_b32 v192,v194
v_add_f32 v192,v192,v194
v_mul_f32 v192,0x3b000000,v192
v_mov_b32 v194,v192
s_nop 1
v_permlane32_swap_b32 v192,v194
v_fma_f32 v194,-v192,v192,v194
v_add_f32 v192,s78,v192
v_max_f32 v194,0,v194
v_cvt_pk_bf16_f32 v194,v192,v194
v_lshlrev_b32 v192,16,v194
v_and_b32 v194,0xffff0000,v194
v_add_f32 v194,0x3727c5ac,v194
v_cvt_pk_bf16_f32 v194,v194,v194
v_and_b32 v194,0xffff0000,v194
v_sqrt_f32 v194,v194
v_pk_add_f32 v[184:185],v[200:201],v[192:193] op_sel_hi:[1,0] neg_lo:[0,1] neg_hi:[0,1]
v_pk_add_f32 v[186:187],v[202:203],v[192:193] op_sel_hi:[1,0] neg_lo:[0,1] neg_hi:[0,1]
v_pk_add_f32 v[188:189],v[204:205],v[192:193] op_sel_hi:[1,0] neg_lo:[0,1] neg_hi:[0,1]
v_pk_add_f32 v[190:191],v[206:207],v[192:193] op_sel_hi:[1,0] neg_lo:[0,1] neg_hi:[0,1]
v_cvt_pk_bf16_f32 v194,v194,v194
v_and_b32 v194,0xffff0000,v194
v_rcp_f32 v194,v194
v_cvt_pk_bf16_f32 v172,v184,v185
v_cvt_pk_bf16_f32 v173,v186,v187
v_cvt_pk_bf16_f32 v174,v188,v189
v_cvt_pk_bf16_f32 v175,v190,v191
v_lshlrev_b32 v184,16,v172
v_and_b32 v185,0xffff0000,v172
v_lshlrev_b32 v186,16,v173
v_and_b32 v187,0xffff0000,v173
v_lshlrev_b32 v188,16,v174
v_and_b32 v189,0xffff0000,v174
v_lshlrev_b32 v190,16,v175
v_and_b32 v191,0xffff0000,v175
v_pk_mul_f32 v[184:185],v[184:185],v[194:195] op_sel_hi:[1,0]
v_pk_mul_f32 v[186:187],v[186:187],v[194:195] op_sel_hi:[1,0]
v_pk_mul_f32 v[188:189],v[188:189],v[194:195] op_sel_hi:[1,0]
v_pk_mul_f32 v[190:191],v[190:191],v[194:195] op_sel_hi:[1,0]
v_cvt_pk_bf16_f32 v172,v184,v185
v_cvt_pk_bf16_f32 v173,v186,v187
v_cvt_pk_bf16_f32 v174,v188,v189
v_cvt_pk_bf16_f32 v175,v190,v191
v_lshlrev_b32 v176,16,v172
v_and_b32 v177,0xffff0000,v172
v_lshlrev_b32 v178,16,v173
v_and_b32 v179,0xffff0000,v173
v_lshlrev_b32 v180,16,v174
v_and_b32 v181,0xffff0000,v174
v_lshlrev_b32 v182,16,v175
v_and_b32 v183,0xffff0000,v175
v_pk_add_f32 v[200:201],v[200:201],v[176:177]
v_pk_add_f32 v[202:203],v[202:203],v[178:179]
v_pk_add_f32 v[204:205],v[204:205],v[180:181]
v_pk_add_f32 v[206:207],v[206:207],v[182:183]
v_cvt_pk_bf16_f32 v160,v200,v201
v_cvt_pk_bf16_f32 v161,v202,v203
v_cvt_pk_bf16_f32 v162,v204,v205
v_cvt_pk_bf16_f32 v163,v206,v207
buffer_store_dwordx4 v[160:163],v0,s[12:15],s19 offen sc1
v_pk_mul_f32 v[236:237],v[176:177],v[228:229]
v_pk_fma_f32 v[236:237],v[178:179],v[230:231],v[236:237]
v_pk_fma_f32 v[236:237],v[180:181],v[232:233],v[236:237]
v_pk_fma_f32 v[236:237],v[182:183],v[234:235],v[236:237]
v_add_f32 v236,v236,v237
s_nop 1
v_add_f32_dpp v236,v236,v236 row_ror:8 row_mask:0xf bank_mask:0xf
s_nop 1
v_add_f32_dpp v236,v236,v236 row_ror:4 row_mask:0xf bank_mask:0xf
s_nop 1
v_add_f32_dpp v236,v236,v236 row_ror:2 row_mask:0xf bank_mask:0xf
s_nop 1
v_add_f32_dpp v236,v236,v236 row_ror:1 row_mask:0xf bank_mask:0xf
v_mov_b32 v237,v236
s_nop 1
v_permlane16_swap_b32 v236,v237
v_add_f32 v236,v236,v237
v_mov_b32 v237,v236
s_nop 1
v_permlane32_swap_b32 v236,v237
v_add_f32 v236,v236,v237
v_cvt_pk_bf16_f32 v236,v236,v236
v_and_b32 v236,0xffff0000,v236
v_ashrrev_i32 v237,31,v236
v_or_b32 v237,0x80000000,v237
v_xor_b32 v236,v236,v237
v_and_b32 v236,0xffff0000,v236
s_sub_u32 s20,4095,s18
v_or_b32 v20,s20,v236
s_lshl_b32 s73,s51,13
s_lshl2_add_u32 s73,s68,s73
s_add_u32 s73,s73,10485760
s_add_u32 s73,s73,s86
L_aa_80:
s_cmp_eq_u32 s27,1
s_cbranch_scc1 L_ad_118
s_cmp_eq_u32 s27,0
s_cbranch_scc1 L_aa_81
s_cmp_eq_u32 s27,4
s_cbranch_scc1 L_a4_101
s_cmp_ge_u32 s77,64
s_cbranch_scc1 L_aa_84
L_aa_82:
s_waitcnt vmcnt(0)
buffer_store_dword v20,off,s[8:11],s73 sc1
s_mov_b32 s73,0x80000000
v_mov_b32 v18,0
s_mov_b32 s27,0
L_aw_119:
v_cmp_eq_u32 vcc,0,v18
s_cbranch_vccz L_awd_120
buffer_load_dword v18,v19,s[8:11],0 offen sc1
s_sub_u32 s49,s49,1
s_cbranch_scc1 L_abort
s_waitcnt vmcnt(0)
s_branch L_aw_119
L_awd_120:
L_a3_121:
s_mov_b32 s64,s70
s_mov_b32 s65,s71
s_add_u32 s64,s64,s28
s_add_u32 s65,s65,s29
s_xor_b32 s58,s67,s40
s_xor_b32 s57,s67,s41
s_add_u32 m0,s58,0
s_nop 0
buffer_load_dwordx4 v0,s[8:11],s64 offen offset:0 sc1 lds
buffer_load_dwordx4 v0,s[8:11],s64 offen offset:1024 sc1 lds
buffer_load_dwordx4 v0,s[8:11],s64 offen offset:2048 sc1 lds
buffer_load_dwordx4 v0,s[8:11],s64 offen offset:3072 sc1 lds
s_add_u32 m0,s58,4096
s_add_u32 s64,s64,4096
buffer_load_dwordx4 v0,s[8:11],s64 offen offset:0 sc1 lds
buffer_load_dwordx4 v0,s[8:11],s64 offen offset:1024 sc1 lds
buffer_load_dwordx4 v0,s[8:11],s64 offen offset:2048 sc1 lds
buffer_load_dwordx4 v0,s[8:11],s64 offen offset:3072 sc1 lds
s_add_u32 m0,s58,8192
s_add_u32 s64,s64,4096
buffer_load_dwordx4 v0,s[8:11],s64 offen offset:0 sc1 lds
buffer_load_dwordx4 v0,s[8:11],s64 offen offset:1024 sc1 lds
buffer_load_dwordx4 v0,s[8:11],s64 offen offset:2048 sc1 lds
buffer_load_dwordx4 v0,s[8:11],s64 offen offset:3072 sc1 lds
s_add_u32 m0,s57,24576
s_nop 0
buffer_load_dwordx4 v0,s[8:11],s65 offen offset:0 sc1 lds
buffer_load_dwordx4 v0,s[8:11],s65 offen offset:1024 sc1 lds
v_lshrrev_b32 v244,4,v1
s_sub_u32 s56,s77,8
v_add_u32 v244,s56,v244
v_max_i32 v244,0,v244
v_lshl_add_u32 v244,v244,13,v21
buffer_load_dwordx2 v[242:243],v244,s[8:11],0 offen sc1
s_waitcnt vmcnt(0) lgkmcnt(0)
s_barrier
s_xor_b32 s67,s67,65536
s_and_b32 s56,s50,2048
s_lshl_b32 s56,s56,4
s_add_u32 s56,s56,s67
v_add_u32 v2,s56,v0
v_add_u32 v239,s56,v253
s_and_b32 s56,s50,1024
s_lshl_b32 s56,s56,2
v_add_u32 v238,s56,v2
s_mov_b32 s76,s71
s_mov_b32 s53,s77
ds_read_b128 v[24:27],v238 offset:16384
ds_read_b128 v[40:43],v2 offset:0
ds_read_b128 v[56:59],v2 offset:4096
ds_read_b128 v[28:31],v238 offset:17408
ds_read_b128 v[44:47],v2 offset:1024
ds_read_b128 v[60:63],v2 offset:5120
ds_read_b128 v[32:35],v238 offset:18432
ds_read_b128 v[48:51],v2 offset:2048
ds_read_b128 v[64:67],v2 offset:6144
ds_read_b128 v[36:39],v238 offset:19456
ds_read_b128 v[52:55],v2 offset:3072
ds_read_b128 v[68:71],v2 offset:7168
s_waitcnt lgkmcnt(9)
v_mfma_f32_16x16x32_bf16 v[128:131],v[40:43],v[24:27],v[8:11]
ds_read_b128 v[72:75],v2 offset:24576
v_mfma_f32_16x16x32_bf16 v[132:135],v[56:59],v[24:27],v[12:15]
ds_read_b128 v[76:79],v2 offset:25600
s_waitcnt lgkmcnt(8)
v_mfma_f32_16x16x32_bf16 v[128:131],v[44:47],v[28:31],v[128:131]
ds_read_b128 v[80:83],v2 offset:26624
v_mfma_f32_16x16x32_bf16 v[132:135],v[60:63],v[28:31],v[132:135]
ds_read_b128 v[84:87],v2 offset:27648
s_waitcnt lgkmcnt(7)
v_mfma_f32_16x16x32_bf16 v[128:131],v[48:51],v[32:35],v[128:131]
ds_read_b64 v[120:121],v239 offset:24576
v_mfma_f32_16x16x32_bf16 v[132:135],v[64:67],v[32:35],v[132:135]
ds_read_b64 v[122:123],v239 offset:25600
s_waitcnt lgkmcnt(6)
v_mfma_f32_16x16x32_bf16 v[128:131],v[52:55],v[36:39],v[128:131]
ds_read_b64 v[124:125],v239 offset:26624
v_mfma_f32_16x16x32_bf16 v[132:135],v[68:71],v[36:39],v[132:135]
ds_read_b64 v[126:127],v239 offset:27648
s_waitcnt lgkmcnt(4)
v_mfma_f32_16x16x32_bf16 v[136:139],v[72:75],v[24:27],0
ds_read_b128 v[88:91],v2 offset:8192
ds_read_b128 v[92:95],v2 offset:9216
v_mfma_f32_16x16x32_bf16 v[136:139],v[76:79],v[28:31],v[136:139]
ds_read_b128 v[96:99],v2 offset:10240
ds_read_b128 v[100:103],v2 offset:11264
v_mfma_f32_16x16x32_bf16 v[136:139],v[80:83],v[32:35],v[136:139]
ds_read_b128 v[104:107],v2 offset:12288
ds_read_b128 v[108:111],v2 offset:13312
v_mfma_f32_16x16x32_bf16 v[136:139],v[84:87],v[36:39],v[136:139]
ds_read_b128 v[112:115],v2 offset:14336
ds_read_b128 v[116:119],v2 offset:15360
s_waitcnt lgkmcnt(0)
s_cmp_eq_u32 s30,0
s_cbranch_scc1 L_aa_83
s_cmp_lg_u32 s86,1536
s_cbranch_scc1 L_ae_122
s_mov_b32 s77,s35
s_mov_b32 s30,0
s_lshl_b32 s56,s77,5
s_add_u32 s56,s56,s68
s_mul_i32 s70,s56,24576
s_lshl_b32 s71,s56,12
s_lshl_b32 s59,s77,13
s_lshl2_add_u32 s59,s68,s59
s_add_u32 s59,s59,10485760
s_buffer_load_dword s32,s[8:11],s59
s_mov_b32 s33,1
s_add_u32 s70,s70,100663296
s_add_u32 s71,s71,41943040
v_mov_b32 v19,s59
s_branch L_af_123
L_ae_122:
s_ff1_i32_b64 s77,s[84:85]
s_bitset0_b64 s[84:85],s77
s_min_u32 s77,s77,64
s_lshr_b32 s61,s55,5
s_lshl_b32 s56,s77,5
s_add_u32 s56,s56,s68
s_mul_i32 s70,s56,24576
s_lshl_b32 s71,s56,12
s_lshl_b32 s59,s77,13
s_lshl2_add_u32 s59,s68,s59
s_add_u32 s59,s59,10486144
s_cmp_lt_u32 s77,s61
s_cselect_b32 s57,0,16777216
s_mov_b32 s60,s59
s_buffer_load_dword s33,s[8:11],s60
s_add_u32 s71,s71,s57
s_add_u32 s71,s71,58720256
s_cmp_eq_u32 s77,s61
s_cselect_b32 s57,50331648,0
s_cselect_b32 s58,1536,0
s_add_u32 s59,s59,s58
s_buffer_load_dword s32,s[8:11],s59
s_add_u32 s70,s70,s57
s_add_u32 s70,s70,150994944
v_mov_b32 v19,s59
v_writelane_b32 v19,s60,1
L_af_123:
L_a4_101:
s_waitcnt vmcnt(0)
buffer_store_dword v20,off,s[8:11],s73 sc1
s_mov_b32 s73,0x80000000
v_max3_u32 v238,v72,v73,v74
v_max3_u32 v238,v74,v75,v238
v_max3_u32 v238,v76,v77,v238
v_max3_u32 v238,v78,v79,v238
v_max3_u32 v238,v80,v81,v238
v_max3_u32 v238,v82,v83,v238
v_max3_u32 v238,v84,v85,v238
v_max3_u32 v238,v86,v87,v238
v_max3_u32 v238,v120,v121,v238
v_max3_u32 v238,v122,v123,v238
v_max3_u32 v238,v124,v125,v238
v_max3_u32 v238,v126,v127,v238
v_cmp_eq_u32 vcc,-1,v238
s_cbranch_vccnz L_ac_124
L_acb_125:
v_max3_f32 v238,v128,v129,v130
v_max3_f32 v239,v131,v132,v133
v_max3_f32 v238,v134,v135,v238
v_max3_f32 v239,v138,v139,v239
v_max_f32 v238,v238,v239
v_max_f32 v239,v238,v239
v_pk_mul_f32 v[128:129],v[128:129],v[152:153] op_sel_hi:[1,0]
v_pk_mul_f32 v[130:131],v[130:131],v[152:153] op_sel_hi:[1,0]
v_permlane16_swap_b32 v238,v239
v_max_f32 v238,v238,v239
v_max_f32 v239,v238,v239
v_pk_mul_f32 v[132:133],v[132:133],v[152:153] op_sel_hi:[1,0]
v_pk_mul_f32 v[134:135],v[134:135],v[152:153] op_sel_hi:[1,0]
v_permlane32_swap_b32 v238,v239
v_max_f32 v238,v238,v239
v_mul_f32 v238,v152,v238
v_pk_mul_f32 v[138:139],v[138:139],v[152:153] op_sel_hi:[1,0]
v_pk_add_f32 v[128:129],v[128:129],v[238:239] op_sel_hi:[1,0] neg_lo:[0,1] neg_hi:[0,1]
v_pk_add_f32 v[130:131],v[130:131],v[238:239] op_sel_hi:[1,0] neg_lo:[0,1] neg_hi:[0,1]
v_pk_add_f32 v[132:133],v[132:133],v[238:239] op_sel_hi:[1,0] neg_lo:[0,1] neg_hi:[0,1]
v_pk_add_f32 v[134:135],v[134:135],v[238:239] op_sel_hi:[1,0] neg_lo:[0,1] neg_hi:[0,1]
v_pk_add_f32 v[138:139],v[138:139],v[238:239] op_sel_hi:[1,0] neg_lo:[0,1] neg_hi:[0,1]
v_exp_f32 v128,v128
v_exp_f32 v129,v129
v_exp_f32 v130,v130
v_exp_f32 v131,v131
v_exp_f32 v132,v132
v_exp_f32 v133,v133
v_exp_f32 v134,v134
v_exp_f32 v135,v135
v_exp_f32 v138,v138
v_exp_f32 v139,v139
v_pk_add_f32 v[148:149],v[128:129],v[130:131]
v_pk_add_f32 v[150:151],v[132:133],v[134:135]
v_pk_add_f32 v[148:149],v[148:149],v[138:139]
v_pk_add_f32 v[148:149],v[148:149],v[150:151]
v_add_f32 v150,v148,v149
v_add_f32 v151,v148,v149
s_nop 1
v_permlane16_swap_b32 v150,v151
v_add_f32 v148,v150,v151
v_add_f32 v149,v150,v151
s_nop 1
v_permlane32_swap_b32 v148,v149
v_add_f32 v148,v148,v149
v_rcp_f32 v148,v148
s_nop 0
v_pk_mul_f32 v[138:139],v[138:139],v[148:149] op_sel_hi:[1,0]
v_pk_mul_f32 v[128:129],v[128:129],v[148:149] op_sel_hi:[1,0]
v_pk_mul_f32 v[130:131],v[130:131],v[148:149] op_sel_hi:[1,0]
v_pk_mul_f32 v[132:133],v[132:133],v[148:149] op_sel_hi:[1,0]
v_pk_mul_f32 v[134:135],v[134:135],v[148:149] op_sel_hi:[1,0]
v_cvt_pk_bf16_f32 v144,v138,v139
v_cvt_pk_bf16_f32 v147,v138,v139
s_nop 0
v_mfma_f32_16x16x16_bf16 v[24:27],v[120:121],v[144:145],0
v_cvt_pk_bf16_f32 v140,v128,v129
v_mfma_f32_16x16x16_bf16 v[28:31],v[120:121],v[146:147],0
v_cvt_pk_bf16_f32 v141,v130,v131
v_mfma_f32_16x16x16_bf16 v[32:35],v[122:123],v[144:145],0
v_cvt_pk_bf16_f32 v142,v132,v133
v_mfma_f32_16x16x16_bf16 v[36:39],v[122:123],v[146:147],0
v_cvt_pk_bf16_f32 v143,v134,v135
v_mfma_f32_16x16x16_bf16 v[40:43],v[124:125],v[144:145],0
v_mfma_f32_16x16x16_bf16 v[44:47],v[124:125],v[146:147],0
v_mfma_f32_16x16x16_bf16 v[48:51],v[126:127],v[144:145],0
v_mfma_f32_16x16x16_bf16 v[52:55],v[126:127],v[146:147],0
v_mfma_f32_16x16x32_bf16 v[24:27],v[88:91],v[140:143],v[24:27]
v_mfma_f32_16x16x32_bf16 v[28:31],v[92:95],v[140:143],v[28:31]
v_mfma_f32_16x16x32_bf16 v[32:35],v[96:99],v[140:143],v[32:35]
v_mfma_f32_16x16x32_bf16 v[36:39],v[100:103],v[140:143],v[36:39]
v_cvt_pk_bf16_f32 v72,v24,v28
v_cvt_pk_bf16_f32 v73,v25,v29
v_mfma_f32_16x16x32_bf16 v[40:43],v[104:107],v[140:143],v[40:43]
v_cvt_pk_bf16_f32 v74,v26,v30
v_cvt_pk_bf16_f32 v75,v27,v31
v_mfma_f32_16x16x32_bf16 v[44:47],v[108:111],v[140:143],v[44:47]
ds_write_b128 v3,v[72:75] offset:0
v_cvt_pk_bf16_f32 v76,v32,v36
v_cvt_pk_bf16_f32 v77,v33,v37
v_mfma_f32_16x16x32_bf16 v[48:51],v[112:115],v[140:143],v[48:51]
v_cvt_pk_bf16_f32 v78,v34,v38
v_cvt_pk_bf16_f32 v79,v35,v39
v_mfma_f32_16x16x32_bf16 v[52:55],v[116:119],v[140:143],v[52:55]
ds_write_b128 v3,v[76:79] offset:1024
v_cvt_pk_bf16_f32 v80,v40,v44
v_cvt_pk_bf16_f32 v81,v41,v45
v_cvt_pk_bf16_f32 v82,v42,v46
v_cvt_pk_bf16_f32 v83,v43,v47
ds_write_b128 v3,v[80:83] offset:2048
s_nop 1
v_cvt_pk_bf16_f32 v84,v48,v52
v_cvt_pk_bf16_f32 v85,v49,v53
v_cvt_pk_bf16_f32 v86,v50,v54
v_cvt_pk_bf16_f32 v87,v51,v55
ds_write_b128 v3,v[84:87] offset:3072
s_waitcnt lgkmcnt(0)
s_barrier
L_ad_118:
s_mov_b32 s51,s53
s_mov_b32 s31,1
s_branch L_aa_75
L_aa_81:
s_waitcnt vmcnt(0)
buffer_store_dword v20,off,s[8:11],s73 sc1
s_mov_b32 s73,0x80000000
L_aa_83:
s_mov_b32 s51,s53
s_mov_b32 s31,0
s_add_u32 s35,s53,4
s_cmp_lt_u32 s53,5
s_cbranch_scc1 L_ab_126
s_cmp_ge_u32 s53,62
s_cbranch_scc1 L_am_128
L_aw_129:
v_min_u32 v239,v242,v243
v_cmp_eq_u32 vcc,0,v239
s_cbranch_vccz L_awd_130
s_sleep 4
buffer_load_dwordx2 v[242:243],v244,s[8:11],0 offen sc1
s_sub_u32 s49,s49,1
s_cbranch_scc1 L_abort
s_waitcnt vmcnt(0)
s_branch L_aw_129
L_awd_130:
v_max_u32 v242,v242,v243
s_nop 1
v_max_u32_dpp v242,v242,v242 row_ror:8 row_mask:0xf bank_mask:0xf
s_nop 1
v_max_u32_dpp v242,v242,v242 row_ror:4 row_mask:0xf bank_mask:0xf
s_nop 1
v_max_u32_dpp v242,v242,v242 row_ror:2 row_mask:0xf bank_mask:0xf
s_nop 1
v_max_u32_dpp v242,v242,v242 row_ror:1 row_mask:0xf bank_mask:0xf
v_mov_b32 v243,v242
s_nop 1
v_permlane16_swap_b32 v242,v243
v_max_u32 v242,v242,v243
v_mov_b32 v243,v242
s_nop 1
v_permlane32_swap_b32 v242,v243
v_max_u32 v242,v242,v243
s_nop 0
v_readfirstlane_b32 s56,v242
v_readlane_b32 s57,v255,s53
s_max_u32 s75,s75,s56
s_bitcmp0_b64 s[42:43],s53
s_cbranch_scc1 L_ab_126
s_mov_b32 s77,s36
s_and_b32 s55,s75,0x7ff
s_sub_u32 s55,2047,s55
s_cmp_lt_u32 s75,s57
s_cselect_b32 s55,4095,s55
s_lshr_b32 s61,s55,5
s_mov_b32 s30,1
s_lshl_b32 s56,s77,5
s_add_u32 s56,s56,s68
s_mul_i32 s70,s56,24576
s_lshl_b32 s71,s56,12
s_lshl_b32 s59,s77,13
s_lshl2_add_u32 s59,s68,s59
s_add_u32 s59,s59,10486144
s_cmp_lt_u32 s77,s61
s_cselect_b32 s57,0,16777216
s_mov_b32 s60,s59
s_add_u32 s71,s71,s57
s_add_u32 s71,s71,58720256
s_cmp_eq_u32 s77,s61
s_cselect_b32 s57,50331648,0
s_cselect_b32 s58,1536,0
s_add_u32 s59,s59,s58
s_add_u32 s70,s70,s57
s_add_u32 s70,s70,150994944
v_mov_b32 v19,s59
v_writelane_b32 v19,s60,1
s_branch L_aj_127
L_ab_126:
s_mov_b32 s77,s35
s_mov_b32 s30,0
s_lshl_b32 s56,s77,5
s_add_u32 s56,s56,s68
s_mul_i32 s70,s56,24576
s_lshl_b32 s71,s56,12
s_lshl_b32 s59,s77,13
s_lshl2_add_u32 s59,s68,s59
s_add_u32 s59,s59,10485760
s_mov_b32 s33,1
s_add_u32 s70,s70,100663296
s_add_u32 s71,s71,41943040
v_mov_b32 v19,s59
L_aj_127:
buffer_load_dword v18,v19,s[8:11],0 offen sc1
s_waitcnt vmcnt(2)
v_mfma_f32_16x16x32_bf16 v[136:139],v[72:75],v[24:27],0
v_max3_u32 v238,v72,v73,v74
v_max3_u32 v238,v74,v75,v238
v_mfma_f32_16x16x32_bf16 v[136:139],v[76:79],v[28:31],v[136:139]
v_max3_u32 v238,v76,v77,v238
v_max3_u32 v238,v78,v79,v238
v_mfma_f32_16x16x32_bf16 v[136:139],v[80:83],v[32:35],v[136:139]
v_max3_u32 v238,v80,v81,v238
v_max3_u32 v238,v82,v83,v238
v_mfma_f32_16x16x32_bf16 v[136:139],v[84:87],v[36:39],v[136:139]
v_max3_u32 v238,v84,v85,v238
v_max3_u32 v238,v86,v87,v238
v_max3_u32 v238,v120,v121,v238
v_max3_u32 v238,v122,v123,v238
v_max3_u32 v238,v124,v125,v238
v_max3_u32 v238,v126,v127,v238
v_cmp_eq_u32 vcc,-1,v238
s_cbranch_vccz L_aa_86
L_aa_85:
buffer_load_dwordx4 v[72:75],v0,s[8:11],s76 offen offset:0 sc1
buffer_load_dwordx4 v[76:79],v0,s[8:11],s76 offen offset:1024 sc1
buffer_load_dwordx4 v[80:83],v0,s[8:11],s76 offen offset:2048 sc1
buffer_load_dwordx4 v[84:87],v0,s[8:11],s76 offen offset:3072 sc1
buffer_load_dwordx2 v[120:121],v253,s[8:11],s76 offen offset:0 sc1
buffer_load_dwordx2 v[122:123],v253,s[8:11],s76 offen offset:1024 sc1
buffer_load_dwordx2 v[124:125],v253,s[8:11],s76 offen offset:2048 sc1
buffer_load_dwordx2 v[126:127],v253,s[8:11],s76 offen offset:3072 sc1
buffer_load_dword v18,v19,s[8:11],0 offen sc1
s_sub_u32 s49,s49,1
s_cbranch_scc1 L_abort
s_waitcnt vmcnt(8)
v_mfma_f32_16x16x32_bf16 v[136:139],v[72:75],v[24:27],0
v_max3_u32 v238,v72,v73,v74
v_max3_u32 v238,v74,v75,v238
s_waitcnt vmcnt(7)
v_mfma_f32_16x16x32_bf16 v[136:139],v[76:79],v[28:31],v[136:139]
v_max3_u32 v238,v76,v77,v238
v_max3_u32 v238,v78,v79,v238
s_waitcnt vmcnt(6)
v_mfma_f32_16x16x32_bf16 v[136:139],v[80:83],v[32:35],v[136:139]
v_max3_u32 v238,v80,v81,v238
v_max3_u32 v238,v82,v83,v238
s_waitcnt vmcnt(5)
v_mfma_f32_16x16x32_bf16 v[136:139],v[84:87],v[36:39],v[136:139]
v_max3_u32 v238,v84,v85,v238
v_max3_u32 v238,v86,v87,v238
s_waitcnt vmcnt(1)
v_max3_u32 v238,v120,v121,v238
v_max3_u32 v238,v122,v123,v238
v_max3_u32 v238,v124,v125,v238
v_max3_u32 v238,v126,v127,v238
v_cmp_eq_u32 vcc,-1,v238
s_cbranch_vccnz L_aa_85
L_aa_86:
s_cmp_lg_u32 s27,3
s_cbranch_scc1 L_ai_131
v_max3_f32 v238,v128,v129,v130
v_max3_f32 v239,v131,v132,v133
v_max3_f32 v238,v134,v135,v238
v_max3_f32 v239,v138,v139,v239
v_max_f32 v238,v238,v239
v_max_f32 v239,v238,v239
v_pk_mul_f32 v[128:129],v[128:129],v[152:153] op_sel_hi:[1,0]
v_pk_mul_f32 v[130:131],v[130:131],v[152:153] op_sel_hi:[1,0]
v_permlane16_swap_b32 v238,v239
v_max_f32 v238,v238,v239
v_max_f32 v239,v238,v239
v_pk_mul_f32 v[132:133],v[132:133],v[152:153] op_sel_hi:[1,0]
v_pk_mul_f32 v[134:135],v[134:135],v[152:153] op_sel_hi:[1,0]
v_permlane32_swap_b32 v238,v239
v_max_f32 v238,v238,v239
v_mul_f32 v238,v152,v238
v_pk_mul_f32 v[138:139],v[138:139],v[152:153] op_sel_hi:[1,0]
buffer_load_dword v17,v16,s[8:11],s87 offen sc1
v_pk_add_f32 v[128:129],v[128:129],v[238:239] op_sel_hi:[1,0] neg_lo:[0,1] neg_hi:[0,1]
v_pk_add_f32 v[130:131],v[130:131],v[238:239] op_sel_hi:[1,0] neg_lo:[0,1] neg_hi:[0,1]
v_pk_add_f32 v[132:133],v[132:133],v[238:239] op_sel_hi:[1,0] neg_lo:[0,1] neg_hi:[0,1]
v_pk_add_f32 v[134:135],v[134:135],v[238:239] op_sel_hi:[1,0] neg_lo:[0,1] neg_hi:[0,1]
v_pk_add_f32 v[138:139],v[138:139],v[238:239] op_sel_hi:[1,0] neg_lo:[0,1] neg_hi:[0,1]
v_exp_f32 v128,v128
v_exp_f32 v129,v129
v_exp_f32 v130,v130
v_exp_f32 v131,v131
v_exp_f32 v132,v132
v_exp_f32 v133,v133
v_exp_f32 v134,v134
v_exp_f32 v135,v135
v_exp_f32 v138,v138
v_exp_f32 v139,v139
v_pk_add_f32 v[148:149],v[128:129],v[130:131]
v_pk_add_f32 v[150:151],v[132:133],v[134:135]
v_pk_add_f32 v[148:149],v[148:149],v[138:139]
v_pk_add_f32 v[148:149],v[148:149],v[150:151]
v_add_f32 v150,v148,v149
v_add_f32 v151,v148,v149
s_nop 1
v_permlane16_swap_b32 v150,v151
v_add_f32 v148,v150,v151
v_add_f32 v149,v150,v151
s_nop 1
v_permlane32_swap_b32 v148,v149
v_add_f32 v148,v148,v149
v_rcp_f32 v148,v148
s_waitcnt vmcnt(0)
v_cmp_gt_u32 vcc,s66,v17
v_pk_mul_f32 v[138:139],v[138:139],v[148:149] op_sel_hi:[1,0]
v_pk_mul_f32 v[128:129],v[128:129],v[148:149] op_sel_hi:[1,0]
v_pk_mul_f32 v[130:131],v[130:131],v[148:149] op_sel_hi:[1,0]
v_pk_mul_f32 v[132:133],v[132:133],v[148:149] op_sel_hi:[1,0]
v_pk_mul_f32 v[134:135],v[134:135],v[148:149] op_sel_hi:[1,0]
s_cbranch_vccnz L_ap_132
L_apb_133:
s_xor_b32 s34,s69,524288
buffer_load_dwordx4 v[192:195],v7,s[8:11],s34 offen sc1
v_cvt_pk_bf16_f32 v144,v138,v139
v_cvt_pk_bf16_f32 v147,v138,v139
s_nop 0
v_mfma_f32_16x16x16_bf16 v[24:27],v[120:121],v[144:145],0
s_add_u32 s34,s34,4096
v_cvt_pk_bf16_f32 v140,v128,v129
v_mfma_f32_16x16x16_bf16 v[28:31],v[120:121],v[146:147],0
buffer_load_dwordx4 v[196:199],v7,s[8:11],s34 offen sc1
v_cvt_pk_bf16_f32 v141,v130,v131
v_mfma_f32_16x16x16_bf16 v[32:35],v[122:123],v[144:145],0
s_add_u32 s34,s34,4096
v_cvt_pk_bf16_f32 v142,v132,v133
v_mfma_f32_16x16x16_bf16 v[36:39],v[122:123],v[146:147],0
buffer_load_dwordx4 v[200:203],v7,s[8:11],s34 offen sc1
v_cvt_pk_bf16_f32 v143,v134,v135
v_mfma_f32_16x16x16_bf16 v[40:43],v[124:125],v[144:145],0
s_add_u32 s34,s34,4096
v_mfma_f32_16x16x16_bf16 v[44:47],v[124:125],v[146:147],0
buffer_load_dwordx4 v[204:207],v7,s[8:11],s34 offen sc1
v_mfma_f32_16x16x16_bf16 v[48:51],v[126:127],v[144:145],0
s_add_u32 s34,s34,4096
v_mfma_f32_16x16x16_bf16 v[52:55],v[126:127],v[146:147],0
buffer_load_dwordx4 v[208:211],v7,s[8:11],s34 offen sc1
v_mfma_f32_16x16x32_bf16 v[24:27],v[88:91],v[140:143],v[24:27]
s_add_u32 s34,s34,4096
v_mfma_f32_16x16x32_bf16 v[28:31],v[92:95],v[140:143],v[28:31]
buffer_load_dwordx4 v[212:215],v7,s[8:11],s34 offen sc1
v_mfma_f32_16x16x32_bf16 v[32:35],v[96:99],v[140:143],v[32:35]
s_add_u32 s34,s34,4096
v_mfma_f32_16x16x32_bf16 v[36:39],v[100:103],v[140:143],v[36:39]
buffer_load_dwordx4 v[216:219],v7,s[8:11],s34 offen sc1
v_cvt_pk_bf16_f32 v72,v24,v28
v_cvt_pk_bf16_f32 v73,v25,v29
v_mfma_f32_16x16x32_bf16 v[40:43],v[104:107],v[140:143],v[40:43]
s_add_u32 s34,s34,4096
v_cvt_pk_bf16_f32 v74,v26,v30
v_cvt_pk_bf16_f32 v75,v27,v31
v_mfma_f32_16x16x32_bf16 v[44:47],v[108:111],v[140:143],v[44:47]
ds_write_b128 v3,v[72:75] offset:0
v_cvt_pk_bf16_f32 v76,v32,v36
v_cvt_pk_bf16_f32 v77,v33,v37
v_mfma_f32_16x16x32_bf16 v[48:51],v[112:115],v[140:143],v[48:51]
buffer_load_dwordx4 v[220:223],v7,s[8:11],s34 offen sc1
v_cvt_pk_bf16_f32 v78,v34,v38
v_cvt_pk_bf16_f32 v79,v35,v39
v_mfma_f32_16x16x32_bf16 v[52:55],v[116:119],v[140:143],v[52:55]
ds_write_b128 v3,v[76:79] offset:1024
v_cvt_pk_bf16_f32 v80,v40,v44
v_cvt_pk_bf16_f32 v81,v41,v45
v_cvt_pk_bf16_f32 v82,v42,v46
v_cvt_pk_bf16_f32 v83,v43,v47
ds_write_b128 v3,v[80:83] offset:2048
s_nop 1
v_cvt_pk_bf16_f32 v84,v48,v52
v_cvt_pk_bf16_f32 v85,v49,v53
v_cvt_pk_bf16_f32 v86,v50,v54
v_cvt_pk_bf16_f32 v87,v51,v55
ds_write_b128 v3,v[84:87] offset:3072
v_readlane_b32 s32,v18,0
v_readlane_b32 s33,v18,1
s_waitcnt lgkmcnt(0)
s_barrier
s_branch L_aa_88
L_ai_131:
v_max3_f32 v238,v128,v129,v130
v_max3_f32 v239,v131,v132,v133
v_max3_f32 v238,v134,v135,v238
v_max3_f32 v239,v138,v139,v239
v_max_f32 v238,v238,v239
v_max_f32 v239,v238,v239
v_pk_mul_f32 v[128:129],v[128:129],v[152:153] op_sel_hi:[1,0]
v_pk_mul_f32 v[130:131],v[130:131],v[152:153] op_sel_hi:[1,0]
v_permlane16_swap_b32 v238,v239
v_max_f32 v238,v238,v239
v_max_f32 v239,v238,v239
v_pk_mul_f32 v[132:133],v[132:133],v[152:153] op_sel_hi:[1,0]
v_pk_mul_f32 v[134:135],v[134:135],v[152:153] op_sel_hi:[1,0]
v_permlane32_swap_b32 v238,v239
v_max_f32 v238,v238,v239
v_mul_f32 v238,v152,v238
v_pk_mul_f32 v[138:139],v[138:139],v[152:153] op_sel_hi:[1,0]
v_pk_add_f32 v[128:129],v[128:129],v[238:239] op_sel_hi:[1,0] neg_lo:[0,1] neg_hi:[0,1]
v_pk_add_f32 v[130:131],v[130:131],v[238:239] op_sel_hi:[1,0] neg_lo:[0,1] neg_hi:[0,1]
v_pk_add_f32 v[132:133],v[132:133],v[238:239] op_sel_hi:[1,0] neg_lo:[0,1] neg_hi:[0,1]
v_pk_add_f32 v[134:135],v[134:135],v[238:239] op_sel_hi:[1,0] neg_lo:[0,1] neg_hi:[0,1]
v_pk_add_f32 v[138:139],v[138:139],v[238:239] op_sel_hi:[1,0] neg_lo:[0,1] neg_hi:[0,1]
v_exp_f32 v128,v128
v_exp_f32 v129,v129
v_exp_f32 v130,v130
v_exp_f32 v131,v131
v_exp_f32 v132,v132
v_exp_f32 v133,v133
v_exp_f32 v134,v134
v_exp_f32 v135,v135
v_exp_f32 v138,v138
v_exp_f32 v139,v139
v_pk_add_f32 v[148:149],v[128:129],v[130:131]
v_pk_add_f32 v[150:151],v[132:133],v[134:135]
v_pk_add_f32 v[148:149],v[148:149],v[138:139]
v_pk_add_f32 v[148:149],v[148:149],v[150:151]
v_add_f32 v150,v148,v149
v_add_f32 v151,v148,v149
s_nop 1
v_permlane16_swap_b32 v150,v151
v_add_f32 v148,v150,v151
v_add_f32 v149,v150,v151
s_nop 1
v_permlane32_swap_b32 v148,v149
v_add_f32 v148,v148,v149
v_rcp_f32 v148,v148
s_nop 0
v_pk_mul_f32 v[138:139],v[138:139],v[148:149] op_sel_hi:[1,0]
v_pk_mul_f32 v[128:129],v[128:129],v[148:149] op_sel_hi:[1,0]
v_pk_mul_f32 v[130:131],v[130:131],v[148:149] op_sel_hi:[1,0]
v_pk_mul_f32 v[132:133],v[132:133],v[148:149] op_sel_hi:[1,0]
v_pk_mul_f32 v[134:135],v[134:135],v[148:149] op_sel_hi:[1,0]
v_cvt_pk_bf16_f32 v144,v138,v139
v_cvt_pk_bf16_f32 v147,v138,v139
s_nop 0
v_mfma_f32_16x16x16_bf16 v[24:27],v[120:121],v[144:145],0
v_cvt_pk_bf16_f32 v140,v128,v129
v_mfma_f32_16x16x16_bf16 v[28:31],v[120:121],v[146:147],0
v_cvt_pk_bf16_f32 v141,v130,v131
v_mfma_f32_16x16x16_bf16 v[32:35],v[122:123],v[144:145],0
v_cvt_pk_bf16_f32 v142,v132,v133
v_mfma_f32_16x16x16_bf16 v[36:39],v[122:123],v[146:147],0
v_cvt_pk_bf16_f32 v143,v134,v135
v_mfma_f32_16x16x16_bf16 v[40:43],v[124:125],v[144:145],0
v_mfma_f32_16x16x16_bf16 v[44:47],v[124:125],v[146:147],0
v_mfma_f32_16x16x16_bf16 v[48:51],v[126:127],v[144:145],0
v_mfma_f32_16x16x16_bf16 v[52:55],v[126:127],v[146:147],0
v_mfma_f32_16x16x32_bf16 v[24:27],v[88:91],v[140:143],v[24:27]
v_mfma_f32_16x16x32_bf16 v[28:31],v[92:95],v[140:143],v[28:31]
v_mfma_f32_16x16x32_bf16 v[32:35],v[96:99],v[140:143],v[32:35]
v_mfma_f32_16x16x32_bf16 v[36:39],v[100:103],v[140:143],v[36:39]
v_cvt_pk_bf16_f32 v72,v24,v28
v_cvt_pk_bf16_f32 v73,v25,v29
v_mfma_f32_16x16x32_bf16 v[40:43],v[104:107],v[140:143],v[40:43]
v_cvt_pk_bf16_f32 v74,v26,v30
v_cvt_pk_bf16_f32 v75,v27,v31
v_mfma_f32_16x16x32_bf16 v[44:47],v[108:111],v[140:143],v[44:47]
ds_write_b128 v3,v[72:75] offset:0
v_cvt_pk_bf16_f32 v76,v32,v36
v_cvt_pk_bf16_f32 v77,v33,v37
v_mfma_f32_16x16x32_bf16 v[48:51],v[112:115],v[140:143],v[48:51]
v_cvt_pk_bf16_f32 v78,v34,v38
v_cvt_pk_bf16_f32 v79,v35,v39
v_mfma_f32_16x16x32_bf16 v[52:55],v[116:119],v[140:143],v[52:55]
ds_write_b128 v3,v[76:79] offset:1024
v_cvt_pk_bf16_f32 v80,v40,v44
v_cvt_pk_bf16_f32 v81,v41,v45
v_cvt_pk_bf16_f32 v82,v42,v46
v_cvt_pk_bf16_f32 v83,v43,v47
ds_write_b128 v3,v[80:83] offset:2048
s_nop 1
v_cvt_pk_bf16_f32 v84,v48,v52
v_cvt_pk_bf16_f32 v85,v49,v53
v_cvt_pk_bf16_f32 v86,v50,v54
v_cvt_pk_bf16_f32 v87,v51,v55
ds_write_b128 v3,v[84:87] offset:3072
s_waitcnt vmcnt(0)
v_readlane_b32 s32,v18,0
v_readlane_b32 s33,v18,1
s_waitcnt lgkmcnt(0)
s_barrier
s_branch L_aa_75
L_aa_84:
s_cmp_lg_u32 s86,1536
s_cbranch_scc1 L_az_134
s_cmp_ge_u32 s35,66
s_cbranch_scc1 L_aa_74
v_subrev_u32 v248,s36,v1
v_and_b32 v248,0x80000003,v248
v_cmp_eq_u32 vcc,0,v248
v_lshlrev_b32 v248,2,v1
v_mov_b32 v249,0x40000000
v_cndmask_b32 v248,v249,v248,vcc
v_mov_b32 v249,3
s_or_b32 s59,s68,s46
s_mov_b32 s59,11018240
s_cmov_b32 s59,0x80000000
buffer_store_dword v249,v248,s[8:11],s59 offen sc1
L_aa_74:
s_waitcnt vmcnt(0)
buffer_store_dword v20,off,s[8:11],s73 sc1
s_mov_b32 s73,0x80000000
v_lshlrev_b32 v238,2,v1
v_add_u32 v248,155712,v238
s_cmp_lg_u32 s46,0
s_cbranch_scc1 L_an_135
s_lshl_b32 s59,s54,13
s_add_u32 s59,s59,11026432
L_fp_136:
s_sleep 1
buffer_load_dword v239,v238,s[8:11],s59 offen sc1
s_sub_u32 s49,s49,1
s_cbranch_scc1 L_abort
s_waitcnt vmcnt(0)
v_cmp_eq_u32 vcc,0,v239
s_cbranch_vccnz L_fp_136
ds_write_b32 v248,v239
s_waitcnt lgkmcnt(0)
L_an_135:
s_barrier
ds_read_b32 v239,v248
s_mov_b32 s86,768
s_mov_b32 s30,1
s_waitcnt lgkmcnt(0)
v_readfirstlane_b32 s55,v239
v_and_b32 v239,255,v239
s_lshr_b32 s55,s55,8
s_lshr_b32 s61,s55,5
v_cmp_ne_u32 s[38:39],3,v239
v_cmp_le_u32 vcc,s61,v1
s_nop 1
v_cndmask_b32 v238,1,2,vcc
v_cmp_ne_u32 s[84:85],v238,v239
s_bcnt1_i32_b64 s56,s[84:85]
s_nop 0
v_mbcnt_lo_u32_b32 v238,s84,0
v_mbcnt_hi_u32_b32 v238,s85,v238
s_mul_i32 s56,s56,12
s_add_u32 s56,s56,48
s_lshr_b32 s56,s56,7
s_lshl_b32 s56,s56,1
v_cmp_gt_u32 vcc,s56,v238
v_and_b32 v239,1,v238
v_and_b32 v238,3,v238
v_add_u32 v238,2,v238
v_cndmask_b32 v238,v238,v239,vcc
v_cmp_eq_u32 vcc,s54,v238
s_and_b64 s[84:85],s[84:85],vcc
s_ff1_i32_b64 s77,s[84:85]
s_bitset0_b64 s[84:85],s77
s_min_u32 s77,s77,64
s_lshl_b32 s56,s77,5
s_add_u32 s56,s56,s68
s_mul_i32 s70,s56,24576
s_lshl_b32 s71,s56,12
s_lshl_b32 s59,s77,13
s_lshl2_add_u32 s59,s68,s59
s_add_u32 s59,s59,10486144
s_cmp_lt_u32 s77,s61
s_cselect_b32 s57,0,16777216
s_mov_b32 s60,s59
s_buffer_load_dword s33,s[8:11],s60
s_add_u32 s71,s71,s57
s_add_u32 s71,s71,58720256
s_cmp_eq_u32 s77,s61
s_cselect_b32 s57,50331648,0
s_cselect_b32 s58,1536,0
s_add_u32 s59,s59,s58
s_buffer_load_dword s32,s[8:11],s59
s_add_u32 s70,s70,s57
s_add_u32 s70,s70,150994944
v_mov_b32 v19,s59
v_writelane_b32 v19,s60,1
s_cmp_ge_u32 s77,64
s_cbranch_scc1 L_az_134
s_cmp_eq_u32 s77,s61
s_cbranch_scc1 L_aa_82
s_mov_b32 s27,0
s_bitcmp1_b64 s[38:39],s77
s_cbranch_scc1 L_a3_121
s_branch L_aa_82
L_az_134:
s_waitcnt vmcnt(0)
buffer_store_dword v20,off,s[8:11],s73 sc1
s_mov_b32 s73,0x80000000
s_endpgm
L_ag_90:
s_lshl_b32 s21,s26,13
s_lshl2_add_u32 s21,s68,s21
s_add_u32 s21,s21,10487296
L_ww_137:
buffer_load_dword v246,off,s[8:11],s21 sc1
s_sub_u32 s49,s49,1
s_cbranch_scc1 L_abort
s_waitcnt vmcnt(0)
v_readfirstlane_b32 s22,v246
s_cmp_eq_u32 s22,0
s_cbranch_scc1 L_ww_137
L_wwd_138:
s_branch L_agb_91
L_a4_99:
v_mov_b32 v248,s27
ds_write_b32 v247,v248 offset:16
s_waitcnt lgkmcnt(0)
s_barrier
ds_read_b128 v[248:251],v245 offset:16
s_waitcnt lgkmcnt(0)
v_or3_b32 v248,v248,v249,v250
v_or_b32 v248,v248,v251
v_cmp_ne_u32 vcc,0,v248
s_cbranch_vccz L_a4_100
L_aq_139:
buffer_load_dword v17,v16,s[8:11],s87 offen sc1
s_sub_u32 s49,s49,1
s_cbranch_scc1 L_abort
s_waitcnt vmcnt(0)
v_cmp_gt_u32 vcc,s66,v17
s_cbranch_vccnz L_aq_139
s_xor_b32 s34,s69,524288
buffer_load_dwordx4 v[160:163],v7,s[8:11],s34 offen sc1
s_add_u32 s34,s34,4096
buffer_load_dwordx4 v[164:167],v7,s[8:11],s34 offen sc1
s_add_u32 s34,s34,4096
buffer_load_dwordx4 v[168:171],v7,s[8:11],s34 offen sc1
s_add_u32 s34,s34,4096
buffer_load_dwordx4 v[172:175],v7,s[8:11],s34 offen sc1
s_add_u32 s34,s34,4096
buffer_load_dwordx4 v[176:179],v7,s[8:11],s34 offen sc1
s_add_u32 s34,s34,4096
buffer_load_dwordx4 v[180:183],v7,s[8:11],s34 offen sc1
s_add_u32 s34,s34,4096
buffer_load_dwordx4 v[184:187],v7,s[8:11],s34 offen sc1
s_add_u32 s34,s34,4096
buffer_load_dwordx4 v[188:191],v7,s[8:11],s34 offen sc1
s_waitcnt vmcnt(7)
v_mfma_f32_16x16x32_bf16 v[192:195],v[156:159],v[160:163],0
s_waitcnt vmcnt(6)
v_mfma_f32_16x16x32_bf16 v[192:195],v[156:159],v[164:167],v[192:195]
s_waitcnt vmcnt(5)
v_mfma_f32_16x16x32_bf16 v[192:195],v[156:159],v[168:171],v[192:195]
s_waitcnt vmcnt(4)
v_mfma_f32_16x16x32_bf16 v[192:195],v[156:159],v[172:175],v[192:195]
s_waitcnt vmcnt(3)
v_mfma_f32_16x16x32_bf16 v[196:199],v[156:159],v[176:179],0
s_waitcnt vmcnt(2)
v_mfma_f32_16x16x32_bf16 v[196:199],v[156:159],v[180:183],v[196:199]
s_waitcnt vmcnt(1)
v_mfma_f32_16x16x32_bf16 v[196:199],v[156:159],v[184:187],v[196:199]
ds_write_b128 v6,v[192:195]
s_waitcnt vmcnt(0)
v_mfma_f32_16x16x32_bf16 v[196:199],v[156:159],v[188:191],v[196:199]
s_nop 7
ds_write_b128 v6,v[196:199] offset:2048
s_waitcnt lgkmcnt(0)
s_barrier
buffer_store_dword v20,off,s[8:11],s73 sc1
s_mov_b32 s73,0x80000000
s_mov_b32 s27,4
s_branch L_aa_79
L_ac_102:
buffer_store_dword v20,off,s[8:11],s73 sc1
s_mov_b32 s73,0x80000000
buffer_load_dwordx4 v[72:75],v0,s[8:11],s76 offen offset:0 sc1
buffer_load_dwordx4 v[76:79],v0,s[8:11],s76 offen offset:1024 sc1
buffer_load_dwordx4 v[80:83],v0,s[8:11],s76 offen offset:2048 sc1
buffer_load_dwordx4 v[84:87],v0,s[8:11],s76 offen offset:3072 sc1
buffer_load_dwordx2 v[120:121],v253,s[8:11],s76 offen offset:0 sc1
buffer_load_dwordx2 v[122:123],v253,s[8:11],s76 offen offset:1024 sc1
buffer_load_dwordx2 v[124:125],v253,s[8:11],s76 offen offset:2048 sc1
buffer_load_dwordx2 v[126:127],v253,s[8:11],s76 offen offset:3072 sc1
s_sub_u32 s49,s49,1
s_cbranch_scc1 L_abort
s_waitcnt vmcnt(7)
v_mfma_f32_16x16x32_bf16 v[136:139],v[72:75],v[24:27],0
v_max3_u32 v238,v72,v73,v74
v_max3_u32 v238,v74,v75,v238
s_waitcnt vmcnt(6)
v_mfma_f32_16x16x32_bf16 v[136:139],v[76:79],v[28:31],v[136:139]
v_max3_u32 v238,v76,v77,v238
v_max3_u32 v238,v78,v79,v238
s_waitcnt vmcnt(5)
v_mfma_f32_16x16x32_bf16 v[136:139],v[80:83],v[32:35],v[136:139]
v_max3_u32 v238,v80,v81,v238
v_max3_u32 v238,v82,v83,v238
s_waitcnt vmcnt(4)
v_mfma_f32_16x16x32_bf16 v[136:139],v[84:87],v[36:39],v[136:139]
v_max3_u32 v238,v84,v85,v238
v_max3_u32 v238,v86,v87,v238
s_waitcnt vmcnt(0)
v_max3_u32 v238,v120,v121,v238
v_max3_u32 v238,v122,v123,v238
v_max3_u32 v238,v124,v125,v238
v_max3_u32 v238,v126,v127,v238
v_cmp_eq_u32 vcc,-1,v238
s_cbranch_vccnz L_ac_102
s_branch L_acb_103
L_ap_105:
L_aw_140:
v_cmp_gt_u32 vcc,s66,v17
s_cbranch_vccz L_awd_141
buffer_load_dword v17,v16,s[8:11],s87 offen sc1
s_sub_u32 s49,s49,1
s_cbranch_scc1 L_abort
s_waitcnt vmcnt(0)
s_branch L_aw_140
L_awd_141:
s_branch L_apb_106
L_a1_107:
v_subrev_u32 v248,s36,v1
v_and_b32 v248,0x80000003,v248
v_cmp_eq_u32 vcc,0,v248
v_lshlrev_b32 v248,2,v1
v_mov_b32 v249,0x40000000
v_cndmask_b32 v248,v249,v248,vcc
v_mov_b32 v249,3
s_or_b32 s59,s68,s46
s_mov_b32 s59,11018240
s_cmov_b32 s59,0x80000000
buffer_store_dword v249,v248,s[8:11],s59 offen sc1
s_branch L_a2_108
L_ag_116:
s_lshl_b32 s21,s51,13
s_lshl2_add_u32 s21,s68,s21
s_add_u32 s21,s21,10487296
L_ww_142:
buffer_load_dword v246,off,s[8:11],s21 sc1
s_sub_u32 s49,s49,1
s_cbranch_scc1 L_abort
s_waitcnt vmcnt(0)
v_readfirstlane_b32 s22,v246
s_cmp_eq_u32 s22,0
s_cbranch_scc1 L_ww_142
L_wwd_143:
s_branch L_agb_117
L_ac_124:
buffer_store_dword v20,off,s[8:11],s73 sc1
s_mov_b32 s73,0x80000000
buffer_load_dwordx4 v[72:75],v0,s[8:11],s76 offen offset:0 sc1
buffer_load_dwordx4 v[76:79],v0,s[8:11],s76 offen offset:1024 sc1
buffer_load_dwordx4 v[80:83],v0,s[8:11],s76 offen offset:2048 sc1
buffer_load_dwordx4 v[84:87],v0,s[8:11],s76 offen offset:3072 sc1
buffer_load_dwordx2 v[120:121],v253,s[8:11],s76 offen offset:0 sc1
buffer_load_dwordx2 v[122:123],v253,s[8:11],s76 offen offset:1024 sc1
buffer_load_dwordx2 v[124:125],v253,s[8:11],s76 offen offset:2048 sc1
buffer_load_dwordx2 v[126:127],v253,s[8:11],s76 offen offset:3072 sc1
s_sub_u32 s49,s49,1
s_cbranch_scc1 L_abort
s_waitcnt vmcnt(7)
v_mfma_f32_16x16x32_bf16 v[136:139],v[72:75],v[24:27],0
v_max3_u32 v238,v72,v73,v74
v_max3_u32 v238,v74,v75,v238
s_waitcnt vmcnt(6)
v_mfma_f32_16x16x32_bf16 v[136:139],v[76:79],v[28:31],v[136:139]
v_max3_u32 v238,v76,v77,v238
v_max3_u32 v238,v78,v79,v238
s_waitcnt vmcnt(5)
v_mfma_f32_16x16x32_bf16 v[136:139],v[80:83],v[32:35],v[136:139]
v_max3_u32 v238,v80,v81,v238
v_max3_u32 v238,v82,v83,v238
s_waitcnt vmcnt(4)
v_mfma_f32_16x16x32_bf16 v[136:139],v[84:87],v[36:39],v[136:139]
v_max3_u32 v238,v84,v85,v238
v_max3_u32 v238,v86,v87,v238
s_waitcnt vmcnt(0)
v_max3_u32 v238,v120,v121,v238
v_max3_u32 v238,v122,v123,v238
v_max3_u32 v238,v124,v125,v238
v_max3_u32 v238,v126,v127,v238
v_cmp_eq_u32 vcc,-1,v238
s_cbranch_vccnz L_ac_124
s_branch L_acb_125
L_am_128:
v_subrev_u32 v248,s36,v1
v_and_b32 v248,0x80000003,v248
v_cmp_eq_u32 vcc,0,v248
v_lshlrev_b32 v248,2,v1
v_mov_b32 v249,0x40000000
v_cndmask_b32 v248,v249,v248,vcc
v_mov_b32 v249,3
s_or_b32 s59,s68,s46
s_mov_b32 s59,11018240
s_cmov_b32 s59,0x80000000
buffer_store_dword v249,v248,s[8:11],s59 offen sc1
s_branch L_ab_126
L_ap_132:
L_aw_144:
v_cmp_gt_u32 vcc,s66,v17
s_cbranch_vccz L_awd_145
buffer_load_dword v17,v16,s[8:11],s87 offen sc1
s_sub_u32 s49,s49,1
s_cbranch_scc1 L_abort
s_waitcnt vmcnt(0)
s_branch L_aw_144
L_awd_145:
s_branch L_apb_133
s_endpgm
L_rch_4:
s_waitcnt vmcnt(12)
v_swap_b32 v25,v28
v_swap_b32 v26,v32
v_swap_b32 v27,v36
v_swap_b32 v30,v33
v_swap_b32 v31,v37
v_swap_b32 v35,v38
ds_write_b128 v93,v[24:27] offset:0
ds_write_b128 v94,v[28:31] offset:0
ds_write_b128 v93,v[32:35] offset:128
ds_write_b128 v94,v[36:39] offset:128
s_waitcnt lgkmcnt(0)
s_mov_b32 s56,65536
buffer_load_dwordx4 v[24:27],v92,s[4:7],s56 offen offset:0
buffer_load_dwordx4 v[28:31],v92,s[4:7],s56 offen offset:1024
buffer_load_dwordx4 v[32:35],v92,s[4:7],s56 offen offset:2048
buffer_load_dwordx4 v[36:39],v92,s[4:7],s56 offen offset:3072
s_waitcnt vmcnt(12)
v_swap_b32 v41,v44
v_swap_b32 v42,v48
v_swap_b32 v43,v52
v_swap_b32 v46,v49
v_swap_b32 v47,v53
v_swap_b32 v51,v54
ds_write_b128 v93,v[40:43] offset:1024
ds_write_b128 v94,v[44:47] offset:1024
ds_write_b128 v93,v[48:51] offset:1152
ds_write_b128 v94,v[52:55] offset:1152
s_waitcnt lgkmcnt(0)
s_mov_b32 s56,81920
buffer_load_dwordx4 v[40:43],v92,s[4:7],s56 offen offset:0
buffer_load_dwordx4 v[44:47],v92,s[4:7],s56 offen offset:1024
buffer_load_dwordx4 v[48:51],v92,s[4:7],s56 offen offset:2048
buffer_load_dwordx4 v[52:55],v92,s[4:7],s56 offen offset:3072
s_waitcnt vmcnt(12)
v_swap_b32 v57,v60
v_swap_b32 v58,v64
v_swap_b32 v59,v68
v_swap_b32 v62,v65
v_swap_b32 v63,v69
v_swap_b32 v67,v70
ds_write_b128 v93,v[56:59] offset:2048
ds_write_b128 v94,v[60:63] offset:2048
ds_write_b128 v93,v[64:67] offset:2176
ds_write_b128 v94,v[68:71] offset:2176
s_waitcnt lgkmcnt(0)
s_mov_b32 s56,98304
buffer_load_dwordx4 v[56:59],v92,s[4:7],s56 offen offset:0
buffer_load_dwordx4 v[60:63],v92,s[4:7],s56 offen offset:1024
buffer_load_dwordx4 v[64:67],v92,s[4:7],s56 offen offset:2048
buffer_load_dwordx4 v[68:71],v92,s[4:7],s56 offen offset:3072
s_waitcnt vmcnt(12)
v_swap_b32 v73,v76
v_swap_b32 v74,v80
v_swap_b32 v75,v84
v_swap_b32 v78,v81
v_swap_b32 v79,v85
v_swap_b32 v83,v86
ds_write_b128 v93,v[72:75] offset:3072
ds_write_b128 v94,v[76:79] offset:3072
ds_write_b128 v93,v[80:83] offset:3200
ds_write_b128 v94,v[84:87] offset:3200
s_waitcnt lgkmcnt(0)
s_mov_b32 s56,114688
buffer_load_dwordx4 v[72:75],v92,s[4:7],s56 offen offset:0
buffer_load_dwordx4 v[76:79],v92,s[4:7],s56 offen offset:1024
buffer_load_dwordx4 v[80:83],v92,s[4:7],s56 offen offset:2048
buffer_load_dwordx4 v[84:87],v92,s[4:7],s56 offen offset:3072
s_cmp_eq_u32 s48,0
s_cbranch_scc1 L_rs_146
s_waitcnt vmcnt(12)
v_swap_b32 v25,v28
v_swap_b32 v26,v32
v_swap_b32 v27,v36
v_swap_b32 v30,v33
v_swap_b32 v31,v37
v_swap_b32 v35,v38
ds_write_b128 v93,v[24:27] offset:4096
ds_write_b128 v94,v[28:31] offset:4096
ds_write_b128 v93,v[32:35] offset:4224
ds_write_b128 v94,v[36:39] offset:4224
s_waitcnt vmcnt(8)
v_swap_b32 v41,v44
v_swap_b32 v42,v48
v_swap_b32 v43,v52
v_swap_b32 v46,v49
v_swap_b32 v47,v53
v_swap_b32 v51,v54
ds_write_b128 v93,v[40:43] offset:5120
ds_write_b128 v94,v[44:47] offset:5120
ds_write_b128 v93,v[48:51] offset:5248
ds_write_b128 v94,v[52:55] offset:5248
s_waitcnt vmcnt(4)
v_swap_b32 v57,v60
v_swap_b32 v58,v64
v_swap_b32 v59,v68
v_swap_b32 v62,v65
v_swap_b32 v63,v69
v_swap_b32 v67,v70
ds_write_b128 v93,v[56:59] offset:6144
ds_write_b128 v94,v[60:63] offset:6144
ds_write_b128 v93,v[64:67] offset:6272
ds_write_b128 v94,v[68:71] offset:6272
s_waitcnt vmcnt(0)
v_swap_b32 v73,v76
v_swap_b32 v74,v80
v_swap_b32 v75,v84
v_swap_b32 v78,v81
v_swap_b32 v79,v85
v_swap_b32 v83,v86
ds_write_b128 v93,v[72:75] offset:7168
ds_write_b128 v94,v[76:79] offset:7168
ds_write_b128 v93,v[80:83] offset:7296
ds_write_b128 v94,v[84:87] offset:7296
L_rs_146:
v_mov_b32 v123,159744
s_cmp_lg_u32 s46,0
s_cbranch_scc1 L_gbd_148
v_mov_b32 v124,128
s_buffer_load_dword s56,s[12:15],128
s_waitcnt lgkmcnt(0)
v_mov_b32 v125,s56
ds_write_b32 v123,v125
s_bitcmp1_b32 s56,8
s_cbranch_scc1 L_gbd_148
L_gb_147:
buffer_load_dword v125,v124,s[12:15],0 offen sc1
s_waitcnt vmcnt(0)
v_readfirstlane_b32 s56,v125
ds_write_b32 v123,v125
s_bitcmp1_b32 s56,8
s_cbranch_scc1 L_gbd_148
s_sleep 4
s_sub_u32 s49,s49,1
s_cmp_gt_i32 s49,0
s_cbranch_scc1 L_gb_147
s_branch L_abort
L_gbd_148:
s_waitcnt lgkmcnt(0)
s_barrier
ds_read_b32 v125,v123
s_waitcnt lgkmcnt(0)
v_readfirstlane_b32 s56,v125
s_barrier
s_lshr_b32 s56,s56,16
s_andn2_b32 s56,s56,s3
s_cbranch_scc1 L_spread
s_cmp_eq_u32 s48,0
s_cbranch_scc1 L_chd_149
v_and_b32 v120,15,v1
v_lshrrev_b32 v121,4,v1
v_mov_b32 v17,1
s_lshl_b32 s56,s46,2
v_add_u32 v125,s56,v121
v_xor_b32 v126,v125,v120
v_lshlrev_b32 v126,4,v126
v_lshl_add_u32 v20,v125,10,v126
s_lshl_b32 s56,s46,1
s_xor_b32 s56,s56,0
s_and_b32 s57,s56,3
s_lshl_b32 s57,s57,2
s_lshr_b32 s56,s56,2
s_lshl_b32 s56,s56,13
s_add_u32 s56,s56,131072
v_add_u32 v125,s57,v121
v_xor_b32 v125,v125,v120
v_lshlrev_b32 v125,4,v125
v_lshl_add_u32 v125,v120,8,v125
v_add_u32 v4,s56,v125
s_lshl_b32 s56,s46,1
s_xor_b32 s56,s56,1
s_and_b32 s57,s56,3
s_lshl_b32 s57,s57,2
s_lshr_b32 s56,s56,2
s_lshl_b32 s56,s56,13
s_add_u32 s56,s56,131072
v_add_u32 v125,s57,v121
v_xor_b32 v125,v125,v120
v_lshlrev_b32 v125,4,v125
v_lshl_add_u32 v125,v120,8,v125
v_add_u32 v5,s56,v125
s_lshl_b32 s56,s46,1
s_xor_b32 s56,s56,2
s_and_b32 s57,s56,3
s_lshl_b32 s57,s57,2
s_lshr_b32 s56,s56,2
s_lshl_b32 s56,s56,13
s_add_u32 s56,s56,131072
v_add_u32 v125,s57,v121
v_xor_b32 v125,v125,v120
v_lshlrev_b32 v125,4,v125
v_lshl_add_u32 v125,v120,8,v125
v_add_u32 v6,s56,v125
s_lshl_b32 s56,s46,1
s_xor_b32 s56,s56,3
s_and_b32 s57,s56,3
s_lshl_b32 s57,s57,2
s_lshr_b32 s56,s56,2
s_lshl_b32 s56,s56,13
s_add_u32 s56,s56,131072
v_add_u32 v125,s57,v121
v_xor_b32 v125,v125,v120
v_lshlrev_b32 v125,4,v125
v_lshl_add_u32 v125,v120,8,v125
v_add_u32 v7,s56,v125
s_lshl_b32 s56,s46,1
s_xor_b32 s56,s56,4
s_and_b32 s57,s56,3
s_lshl_b32 s57,s57,2
s_lshr_b32 s56,s56,2
s_lshl_b32 s56,s56,13
s_add_u32 s56,s56,131072
v_add_u32 v125,s57,v121
v_xor_b32 v125,v125,v120
v_lshlrev_b32 v125,4,v125
v_lshl_add_u32 v125,v120,8,v125
v_add_u32 v8,s56,v125
s_lshl_b32 s56,s46,1
s_xor_b32 s56,s56,5
s_and_b32 s57,s56,3
s_lshl_b32 s57,s57,2
s_lshr_b32 s56,s56,2
s_lshl_b32 s56,s56,13
s_add_u32 s56,s56,131072
v_add_u32 v125,s57,v121
v_xor_b32 v125,v125,v120
v_lshlrev_b32 v125,4,v125
v_lshl_add_u32 v125,v120,8,v125
v_add_u32 v9,s56,v125
s_lshl_b32 s56,s46,1
s_xor_b32 s56,s56,6
s_and_b32 s57,s56,3
s_lshl_b32 s57,s57,2
s_lshr_b32 s56,s56,2
s_lshl_b32 s56,s56,13
s_add_u32 s56,s56,131072
v_add_u32 v125,s57,v121
v_xor_b32 v125,v125,v120
v_lshlrev_b32 v125,4,v125
v_lshl_add_u32 v125,v120,8,v125
v_add_u32 v10,s56,v125
s_lshl_b32 s56,s46,1
s_xor_b32 s56,s56,7
s_and_b32 s57,s56,3
s_lshl_b32 s57,s57,2
s_lshr_b32 s56,s56,2
s_lshl_b32 s56,s56,13
s_add_u32 s56,s56,131072
v_add_u32 v125,s57,v121
v_xor_b32 v125,v125,v120
v_lshlrev_b32 v125,4,v125
v_lshl_add_u32 v125,v120,8,v125
v_add_u32 v11,s56,v125
s_cmp_eq_u32 s48,1
s_cselect_b32 s51,14,17
s_cselect_b32 s53,3,5
s_mov_b32 s72,0x80000000
s_lshl_b32 s70,s51,15
s_add_u32 s70,s70,0
s_add_u32 s71,s70,16384
s_add_u32 m0,s50,131072
s_nop 0
buffer_load_dwordx4 v20,s[8:11],s70 offen offset:0 sc1 lds
s_add_u32 m0,s50,135168
s_nop 0
buffer_load_dwordx4 v20,s[8:11],s71 offen offset:0 sc1 lds
s_add_u32 m0,s50,139008
s_nop 0
buffer_load_dwordx4 v20,s[8:11],s70 offen offset:256 sc1 lds
s_add_u32 m0,s50,143104
s_nop 0
buffer_load_dwordx4 v20,s[8:11],s71 offen offset:256 sc1 lds
s_waitcnt vmcnt(0)
L_chl_150:
s_mov_b64 s[68:69],s[70:71]
s_add_u32 s70,s70,32768
s_add_u32 s71,s71,32768
s_lshl_b32 s58,s51,5
s_add_u32 s58,s58,s47
s_mul_i32 s58,s58,24576
s_add_u32 s58,s58,100663296
s_add_u32 s61,s58,s50
s_add_u32 s62,s61,4096
s_add_u32 s63,s61,16384
s_add_u32 s64,s61,20480
s_add_u32 s65,s61,s50
s_add_u32 s65,s65,8192
s_waitcnt vmcnt(7)
s_barrier
ds_read_b128 v[72:75],v4 offset:0
ds_read_b128 v[76:79],v4 offset:4096
ds_read_b128 v[80:83],v5 offset:0
ds_read_b128 v[84:87],v5 offset:4096
s_add_u32 m0,s50,146944
s_nop 0
buffer_load_dwordx4 v20,s[8:11],s68 offen offset:512 sc1 lds
s_add_u32 m0,s50,151040
s_nop 0
buffer_load_dwordx4 v20,s[8:11],s69 offen offset:512 sc1 lds
s_add_u32 m0,s50,154880
s_nop 0
buffer_load_dwordx4 v20,s[8:11],s68 offen offset:768 sc1 lds
s_add_u32 m0,s50,158976
s_nop 0
buffer_load_dwordx4 v20,s[8:11],s69 offen offset:768 sc1 lds
s_waitcnt lgkmcnt(2)
v_mfma_f32_16x16x32_bf16 v[40:43],a[128:131],v[72:75],0
ds_read_b128 v[108:111],v6 offset:0
v_mfma_f32_16x16x32_bf16 v[56:59],v[72:75],v[128:131],0
v_mfma_f32_16x16x32_bf16 v[24:27],a[0:3],v[72:75],0
ds_read_b128 v[112:115],v6 offset:4096
v_mfma_f32_16x16x32_bf16 v[44:47],a[128:131],v[76:79],0
v_mfma_f32_16x16x32_bf16 v[60:63],v[76:79],v[128:131],0
v_mfma_f32_16x16x32_bf16 v[28:31],a[0:3],v[76:79],0
v_mfma_f32_16x16x32_bf16 v[48:51],a[136:139],v[72:75],0
v_mfma_f32_16x16x32_bf16 v[64:67],v[72:75],v[136:139],0
v_mfma_f32_16x16x32_bf16 v[32:35],a[8:11],v[72:75],0
v_mfma_f32_16x16x32_bf16 v[52:55],a[136:139],v[76:79],0
v_mfma_f32_16x16x32_bf16 v[68:71],v[76:79],v[136:139],0
v_mfma_f32_16x16x32_bf16 v[36:39],a[8:11],v[76:79],0
s_waitcnt lgkmcnt(2)
v_mfma_f32_16x16x32_bf16 v[40:43],a[132:135],v[80:83],v[40:43]
ds_read_b128 v[72:75],v7 offset:0
v_mfma_f32_16x16x32_bf16 v[56:59],v[80:83],v[132:135],v[56:59]
v_mfma_f32_16x16x32_bf16 v[24:27],a[4:7],v[80:83],v[24:27]
ds_read_b128 v[76:79],v7 offset:4096
v_mfma_f32_16x16x32_bf16 v[44:47],a[132:135],v[84:87],v[44:47]
v_mfma_f32_16x16x32_bf16 v[60:63],v[84:87],v[132:135],v[60:63]
v_mfma_f32_16x16x32_bf16 v[28:31],a[4:7],v[84:87],v[28:31]
v_mfma_f32_16x16x32_bf16 v[48:51],a[140:143],v[80:83],v[48:51]
v_mfma_f32_16x16x32_bf16 v[64:67],v[80:83],v[140:143],v[64:67]
v_mfma_f32_16x16x32_bf16 v[32:35],a[12:15],v[80:83],v[32:35]
v_mfma_f32_16x16x32_bf16 v[52:55],a[140:143],v[84:87],v[52:55]
v_mfma_f32_16x16x32_bf16 v[68:71],v[84:87],v[140:143],v[68:71]
v_mfma_f32_16x16x32_bf16 v[36:39],a[12:15],v[84:87],v[36:39]
s_waitcnt lgkmcnt(2)
v_mfma_f32_16x16x32_bf16 v[40:43],a[144:147],v[108:111],v[40:43]
ds_read_b128 v[80:83],v8 offset:0
v_mfma_f32_16x16x32_bf16 v[56:59],v[108:111],v[144:147],v[56:59]
v_mfma_f32_16x16x32_bf16 v[24:27],a[16:19],v[108:111],v[24:27]
ds_read_b128 v[84:87],v8 offset:4096
v_mfma_f32_16x16x32_bf16 v[44:47],a[144:147],v[112:115],v[44:47]
v_mfma_f32_16x16x32_bf16 v[60:63],v[112:115],v[144:147],v[60:63]
v_mfma_f32_16x16x32_bf16 v[28:31],a[16:19],v[112:115],v[28:31]
v_mfma_f32_16x16x32_bf16 v[48:51],a[152:155],v[108:111],v[48:51]
v_mfma_f32_16x16x32_bf16 v[64:67],v[108:111],v[152:155],v[64:67]
v_mfma_f32_16x16x32_bf16 v[32:35],a[24:27],v[108:111],v[32:35]
v_mfma_f32_16x16x32_bf16 v[52:55],a[152:155],v[112:115],v[52:55]
v_mfma_f32_16x16x32_bf16 v[68:71],v[112:115],v[152:155],v[68:71]
v_mfma_f32_16x16x32_bf16 v[36:39],a[24:27],v[112:115],v[36:39]
s_waitcnt lgkmcnt(2)
v_mfma_f32_16x16x32_bf16 v[40:43],a[148:151],v[72:75],v[40:43]
ds_read_b128 v[108:111],v9 offset:0
v_mfma_f32_16x16x32_bf16 v[56:59],v[72:75],v[148:151],v[56:59]
v_mfma_f32_16x16x32_bf16 v[24:27],a[20:23],v[72:75],v[24:27]
ds_read_b128 v[112:115],v9 offset:4096
v_mfma_f32_16x16x32_bf16 v[44:47],a[148:151],v[76:79],v[44:47]
v_mfma_f32_16x16x32_bf16 v[60:63],v[76:79],v[148:151],v[60:63]
v_mfma_f32_16x16x32_bf16 v[28:31],a[20:23],v[76:79],v[28:31]
v_mfma_f32_16x16x32_bf16 v[48:51],a[156:159],v[72:75],v[48:51]
v_mfma_f32_16x16x32_bf16 v[64:67],v[72:75],v[156:159],v[64:67]
v_mfma_f32_16x16x32_bf16 v[32:35],a[28:31],v[72:75],v[32:35]
v_mfma_f32_16x16x32_bf16 v[52:55],a[156:159],v[76:79],v[52:55]
v_mfma_f32_16x16x32_bf16 v[68:71],v[76:79],v[156:159],v[68:71]
v_mfma_f32_16x16x32_bf16 v[36:39],a[28:31],v[76:79],v[36:39]
s_waitcnt lgkmcnt(2)
v_mfma_f32_16x16x32_bf16 v[40:43],a[160:163],v[80:83],v[40:43]
ds_read_b128 v[72:75],v10 offset:0
v_mfma_f32_16x16x32_bf16 v[56:59],v[80:83],v[160:163],v[56:59]
v_mfma_f32_16x16x32_bf16 v[24:27],a[32:35],v[80:83],v[24:27]
ds_read_b128 v[76:79],v10 offset:4096
v_mfma_f32_16x16x32_bf16 v[44:47],a[160:163],v[84:87],v[44:47]
v_mfma_f32_16x16x32_bf16 v[60:63],v[84:87],v[160:163],v[60:63]
v_mfma_f32_16x16x32_bf16 v[28:31],a[32:35],v[84:87],v[28:31]
v_mfma_f32_16x16x32_bf16 v[48:51],a[168:171],v[80:83],v[48:51]
v_mfma_f32_16x16x32_bf16 v[64:67],v[80:83],v[168:171],v[64:67]
v_mfma_f32_16x16x32_bf16 v[32:35],a[40:43],v[80:83],v[32:35]
v_mfma_f32_16x16x32_bf16 v[52:55],a[168:171],v[84:87],v[52:55]
v_mfma_f32_16x16x32_bf16 v[68:71],v[84:87],v[168:171],v[68:71]
v_mfma_f32_16x16x32_bf16 v[36:39],a[40:43],v[84:87],v[36:39]
s_waitcnt lgkmcnt(2)
v_mfma_f32_16x16x32_bf16 v[40:43],a[164:167],v[108:111],v[40:43]
ds_read_b128 v[80:83],v11 offset:0
v_mfma_f32_16x16x32_bf16 v[56:59],v[108:111],v[164:167],v[56:59]
v_mfma_f32_16x16x32_bf16 v[24:27],a[36:39],v[108:111],v[24:27]
ds_read_b128 v[84:87],v11 offset:4096
v_mfma_f32_16x16x32_bf16 v[44:47],a[164:167],v[112:115],v[44:47]
v_mfma_f32_16x16x32_bf16 v[60:63],v[112:115],v[164:167],v[60:63]
v_mfma_f32_16x16x32_bf16 v[28:31],a[36:39],v[112:115],v[28:31]
v_mfma_f32_16x16x32_bf16 v[48:51],a[172:175],v[108:111],v[48:51]
v_mfma_f32_16x16x32_bf16 v[64:67],v[108:111],v[172:175],v[64:67]
v_mfma_f32_16x16x32_bf16 v[32:35],a[44:47],v[108:111],v[32:35]
v_mfma_f32_16x16x32_bf16 v[52:55],a[172:175],v[112:115],v[52:55]
v_mfma_f32_16x16x32_bf16 v[68:71],v[112:115],v[172:175],v[68:71]
v_mfma_f32_16x16x32_bf16 v[36:39],a[44:47],v[112:115],v[36:39]
s_waitcnt vmcnt(0)
s_barrier
s_or_b32 s72,s72,s52
buffer_store_dword v17,off,s[8:11],s72 sc1
s_waitcnt lgkmcnt(2)
v_mfma_f32_16x16x32_bf16 v[40:43],a[176:179],v[72:75],v[40:43]
ds_read_b128 v[108:111],v4 offset:16384
v_mfma_f32_16x16x32_bf16 v[56:59],v[72:75],v[176:179],v[56:59]
v_mfma_f32_16x16x32_bf16 v[24:27],a[48:51],v[72:75],v[24:27]
ds_read_b128 v[112:115],v4 offset:20480
v_mfma_f32_16x16x32_bf16 v[44:47],a[176:179],v[76:79],v[44:47]
v_mfma_f32_16x16x32_bf16 v[60:63],v[76:79],v[176:179],v[60:63]
v_mfma_f32_16x16x32_bf16 v[28:31],a[48:51],v[76:79],v[28:31]
v_mfma_f32_16x16x32_bf16 v[48:51],a[184:187],v[72:75],v[48:51]
v_mfma_f32_16x16x32_bf16 v[64:67],v[72:75],v[184:187],v[64:67]
v_mfma_f32_16x16x32_bf16 v[32:35],a[56:59],v[72:75],v[32:35]
v_mfma_f32_16x16x32_bf16 v[52:55],a[184:187],v[76:79],v[52:55]
v_mfma_f32_16x16x32_bf16 v[68:71],v[76:79],v[184:187],v[68:71]
v_mfma_f32_16x16x32_bf16 v[36:39],a[56:59],v[76:79],v[36:39]
s_waitcnt lgkmcnt(2)
v_mfma_f32_16x16x32_bf16 v[40:43],a[180:183],v[80:83],v[40:43]
ds_read_b128 v[72:75],v5 offset:16384
v_mfma_f32_16x16x32_bf16 v[56:59],v[80:83],v[180:183],v[56:59]
v_mfma_f32_16x16x32_bf16 v[24:27],a[52:55],v[80:83],v[24:27]
ds_read_b128 v[76:79],v5 offset:20480
v_mfma_f32_16x16x32_bf16 v[44:47],a[180:183],v[84:87],v[44:47]
v_mfma_f32_16x16x32_bf16 v[60:63],v[84:87],v[180:183],v[60:63]
v_mfma_f32_16x16x32_bf16 v[28:31],a[52:55],v[84:87],v[28:31]
v_mfma_f32_16x16x32_bf16 v[48:51],a[188:191],v[80:83],v[48:51]
v_mfma_f32_16x16x32_bf16 v[64:67],v[80:83],v[188:191],v[64:67]
v_mfma_f32_16x16x32_bf16 v[32:35],a[60:63],v[80:83],v[32:35]
v_mfma_f32_16x16x32_bf16 v[52:55],a[188:191],v[84:87],v[52:55]
v_mfma_f32_16x16x32_bf16 v[68:71],v[84:87],v[188:191],v[68:71]
v_mfma_f32_16x16x32_bf16 v[36:39],a[60:63],v[84:87],v[36:39]
s_waitcnt lgkmcnt(2)
v_mfma_f32_16x16x32_bf16 v[40:43],a[192:195],v[108:111],v[40:43]
ds_read_b128 v[80:83],v6 offset:16384
v_mfma_f32_16x16x32_bf16 v[56:59],v[108:111],v[192:195],v[56:59]
v_mfma_f32_16x16x32_bf16 v[24:27],a[64:67],v[108:111],v[24:27]
ds_read_b128 v[84:87],v6 offset:20480
v_mfma_f32_16x16x32_bf16 v[44:47],a[192:195],v[112:115],v[44:47]
v_mfma_f32_16x16x32_bf16 v[60:63],v[112:115],v[192:195],v[60:63]
v_mfma_f32_16x16x32_bf16 v[28:31],a[64:67],v[112:115],v[28:31]
v_mfma_f32_16x16x32_bf16 v[48:51],a[200:203],v[108:111],v[48:51]
v_mfma_f32_16x16x32_bf16 v[64:67],v[108:111],v[200:203],v[64:67]
v_mfma_f32_16x16x32_bf16 v[32:35],a[72:75],v[108:111],v[32:35]
v_mfma_f32_16x16x32_bf16 v[52:55],a[200:203],v[112:115],v[52:55]
v_mfma_f32_16x16x32_bf16 v[68:71],v[112:115],v[200:203],v[68:71]
v_mfma_f32_16x16x32_bf16 v[36:39],a[72:75],v[112:115],v[36:39]
s_waitcnt lgkmcnt(2)
v_mfma_f32_16x16x32_bf16 v[40:43],a[196:199],v[72:75],v[40:43]
ds_read_b128 v[108:111],v7 offset:16384
v_mfma_f32_16x16x32_bf16 v[56:59],v[72:75],v[196:199],v[56:59]
v_mfma_f32_16x16x32_bf16 v[24:27],a[68:71],v[72:75],v[24:27]
ds_read_b128 v[112:115],v7 offset:20480
v_mfma_f32_16x16x32_bf16 v[44:47],a[196:199],v[76:79],v[44:47]
v_mfma_f32_16x16x32_bf16 v[60:63],v[76:79],v[196:199],v[60:63]
v_mfma_f32_16x16x32_bf16 v[28:31],a[68:71],v[76:79],v[28:31]
v_mfma_f32_16x16x32_bf16 v[48:51],a[204:207],v[72:75],v[48:51]
v_mfma_f32_16x16x32_bf16 v[64:67],v[72:75],v[204:207],v[64:67]
v_mfma_f32_16x16x32_bf16 v[32:35],a[76:79],v[72:75],v[32:35]
v_mfma_f32_16x16x32_bf16 v[52:55],a[204:207],v[76:79],v[52:55]
v_mfma_f32_16x16x32_bf16 v[68:71],v[76:79],v[204:207],v[68:71]
v_mfma_f32_16x16x32_bf16 v[36:39],a[76:79],v[76:79],v[36:39]
s_waitcnt lgkmcnt(2)
v_mfma_f32_16x16x32_bf16 v[40:43],a[208:211],v[80:83],v[40:43]
ds_read_b128 v[72:75],v8 offset:16384
v_mfma_f32_16x16x32_bf16 v[56:59],v[80:83],v[208:211],v[56:59]
v_mfma_f32_16x16x32_bf16 v[24:27],a[80:83],v[80:83],v[24:27]
ds_read_b128 v[76:79],v8 offset:20480
v_mfma_f32_16x16x32_bf16 v[44:47],a[208:211],v[84:87],v[44:47]
v_mfma_f32_16x16x32_bf16 v[60:63],v[84:87],v[208:211],v[60:63]
v_mfma_f32_16x16x32_bf16 v[28:31],a[80:83],v[84:87],v[28:31]
v_mfma_f32_16x16x32_bf16 v[48:51],a[216:219],v[80:83],v[48:51]
v_mfma_f32_16x16x32_bf16 v[64:67],v[80:83],v[216:219],v[64:67]
v_mfma_f32_16x16x32_bf16 v[32:35],a[88:91],v[80:83],v[32:35]
v_mfma_f32_16x16x32_bf16 v[52:55],a[216:219],v[84:87],v[52:55]
v_mfma_f32_16x16x32_bf16 v[68:71],v[84:87],v[216:219],v[68:71]
v_mfma_f32_16x16x32_bf16 v[36:39],a[88:91],v[84:87],v[36:39]
s_waitcnt lgkmcnt(2)
v_mfma_f32_16x16x32_bf16 v[40:43],a[212:215],v[108:111],v[40:43]
ds_read_b128 v[80:83],v9 offset:16384
v_mfma_f32_16x16x32_bf16 v[56:59],v[108:111],v[212:215],v[56:59]
v_mfma_f32_16x16x32_bf16 v[24:27],a[84:87],v[108:111],v[24:27]
ds_read_b128 v[84:87],v9 offset:20480
v_mfma_f32_16x16x32_bf16 v[44:47],a[212:215],v[112:115],v[44:47]
v_mfma_f32_16x16x32_bf16 v[60:63],v[112:115],v[212:215],v[60:63]
v_mfma_f32_16x16x32_bf16 v[28:31],a[84:87],v[112:115],v[28:31]
v_mfma_f32_16x16x32_bf16 v[48:51],a[220:223],v[108:111],v[48:51]
v_mfma_f32_16x16x32_bf16 v[64:67],v[108:111],v[220:223],v[64:67]
v_mfma_f32_16x16x32_bf16 v[32:35],a[92:95],v[108:111],v[32:35]
v_mfma_f32_16x16x32_bf16 v[52:55],a[220:223],v[112:115],v[52:55]
v_mfma_f32_16x16x32_bf16 v[68:71],v[112:115],v[220:223],v[68:71]
v_mfma_f32_16x16x32_bf16 v[36:39],a[92:95],v[112:115],v[36:39]
s_barrier
s_waitcnt lgkmcnt(2)
v_mfma_f32_16x16x32_bf16 v[40:43],a[224:227],v[72:75],v[40:43]
ds_read_b128 v[108:111],v10 offset:16384
v_mfma_f32_16x16x32_bf16 v[56:59],v[72:75],v[224:227],v[56:59]
s_add_u32 m0,s50,131072
v_mfma_f32_16x16x32_bf16 v[24:27],a[96:99],v[72:75],v[24:27]
ds_read_b128 v[112:115],v10 offset:20480
v_mfma_f32_16x16x32_bf16 v[44:47],a[224:227],v[76:79],v[44:47]
buffer_load_dwordx4 v20,s[8:11],s70 offen offset:0 sc1 lds
v_mfma_f32_16x16x32_bf16 v[60:63],v[76:79],v[224:227],v[60:63]
s_add_u32 m0,s50,135168
v_mfma_f32_16x16x32_bf16 v[28:31],a[96:99],v[76:79],v[28:31]
buffer_load_dwordx4 v20,s[8:11],s71 offen offset:0 sc1 lds
v_mfma_f32_16x16x32_bf16 v[48:51],a[232:235],v[72:75],v[48:51]
s_add_u32 m0,s50,139008
v_mfma_f32_16x16x32_bf16 v[64:67],v[72:75],v[232:235],v[64:67]
buffer_load_dwordx4 v20,s[8:11],s70 offen offset:256 sc1 lds
v_mfma_f32_16x16x32_bf16 v[32:35],a[104:107],v[72:75],v[32:35]
s_add_u32 m0,s50,143104
v_mfma_f32_16x16x32_bf16 v[52:55],a[232:235],v[76:79],v[52:55]
buffer_load_dwordx4 v20,s[8:11],s71 offen offset:256 sc1 lds
v_mfma_f32_16x16x32_bf16 v[68:71],v[76:79],v[232:235],v[68:71]
v_mfma_f32_16x16x32_bf16 v[36:39],a[104:107],v[76:79],v[36:39]
s_waitcnt lgkmcnt(2)
v_mfma_f32_16x16x32_bf16 v[40:43],a[228:231],v[80:83],v[40:43]
ds_read_b128 v[72:75],v11 offset:16384
v_mfma_f32_16x16x32_bf16 v[56:59],v[80:83],v[228:231],v[56:59]
v_mfma_f32_16x16x32_bf16 v[24:27],a[100:103],v[80:83],v[24:27]
ds_read_b128 v[76:79],v11 offset:20480
v_mfma_f32_16x16x32_bf16 v[44:47],a[228:231],v[84:87],v[44:47]
v_mfma_f32_16x16x32_bf16 v[60:63],v[84:87],v[228:231],v[60:63]
v_mfma_f32_16x16x32_bf16 v[28:31],a[100:103],v[84:87],v[28:31]
v_mfma_f32_16x16x32_bf16 v[48:51],a[236:239],v[80:83],v[48:51]
v_mfma_f32_16x16x32_bf16 v[64:67],v[80:83],v[236:239],v[64:67]
v_mfma_f32_16x16x32_bf16 v[32:35],a[108:111],v[80:83],v[32:35]
v_mfma_f32_16x16x32_bf16 v[52:55],a[236:239],v[84:87],v[52:55]
v_mfma_f32_16x16x32_bf16 v[68:71],v[84:87],v[236:239],v[68:71]
v_mfma_f32_16x16x32_bf16 v[36:39],a[108:111],v[84:87],v[36:39]
s_waitcnt lgkmcnt(2)
v_mfma_f32_16x16x32_bf16 v[40:43],a[240:243],v[108:111],v[40:43]
v_mfma_f32_16x16x32_bf16 v[56:59],v[108:111],v[240:243],v[56:59]
v_mfma_f32_16x16x32_bf16 v[24:27],a[112:115],v[108:111],v[24:27]
v_mfma_f32_16x16x32_bf16 v[44:47],a[240:243],v[112:115],v[44:47]
v_mfma_f32_16x16x32_bf16 v[60:63],v[112:115],v[240:243],v[60:63]
v_mfma_f32_16x16x32_bf16 v[28:31],a[112:115],v[112:115],v[28:31]
v_mfma_f32_16x16x32_bf16 v[48:51],a[248:251],v[108:111],v[48:51]
v_mfma_f32_16x16x32_bf16 v[64:67],v[108:111],v[248:251],v[64:67]
v_mfma_f32_16x16x32_bf16 v[32:35],a[120:123],v[108:111],v[32:35]
v_mfma_f32_16x16x32_bf16 v[52:55],a[248:251],v[112:115],v[52:55]
v_mfma_f32_16x16x32_bf16 v[68:71],v[112:115],v[248:251],v[68:71]
v_mfma_f32_16x16x32_bf16 v[36:39],a[120:123],v[112:115],v[36:39]
s_waitcnt lgkmcnt(0)
v_mfma_f32_16x16x32_bf16 v[40:43],a[244:247],v[72:75],v[40:43]
v_mfma_f32_16x16x32_bf16 v[56:59],v[72:75],v[244:247],v[56:59]
v_mfma_f32_16x16x32_bf16 v[24:27],a[116:119],v[72:75],v[24:27]
v_mfma_f32_16x16x32_bf16 v[44:47],a[244:247],v[76:79],v[44:47]
v_mfma_f32_16x16x32_bf16 v[60:63],v[76:79],v[244:247],v[60:63]
v_mfma_f32_16x16x32_bf16 v[28:31],a[116:119],v[76:79],v[28:31]
v_mfma_f32_16x16x32_bf16 v[48:51],a[252:255],v[72:75],v[48:51]
v_mfma_f32_16x16x32_bf16 v[64:67],v[72:75],v[252:255],v[64:67]
v_mfma_f32_16x16x32_bf16 v[32:35],a[124:127],v[72:75],v[32:35]
v_mfma_f32_16x16x32_bf16 v[52:55],a[252:255],v[76:79],v[52:55]
v_mfma_f32_16x16x32_bf16 v[68:71],v[76:79],v[252:255],v[68:71]
v_mfma_f32_16x16x32_bf16 v[36:39],a[124:127],v[76:79],v[36:39]
s_lshl_b32 s56,s51,5
s_add_u32 s56,s56,s47
s_lshl_b32 s56,s56,12
s_add_u32 s56,s56,s50
s_add_u32 s56,s56,41943040
v_mov_b64 v[120:121],-1
v_mov_b64 v[122:123],-1
buffer_store_dwordx4 v[120:123],v0,s[8:11],s56 offen sc1
v_cvt_pk_bf16_f32 v72,v40,v48
v_cvt_pk_bf16_f32 v73,v41,v49
v_cvt_pk_bf16_f32 v74,v42,v50
v_cvt_pk_bf16_f32 v75,v43,v51
buffer_store_dwordx4 v[72:75],v0,s[8:11],s61 offen sc1
v_cvt_pk_bf16_f32 v76,v44,v52
v_cvt_pk_bf16_f32 v77,v45,v53
v_cvt_pk_bf16_f32 v78,v46,v54
v_cvt_pk_bf16_f32 v79,v47,v55
buffer_store_dwordx4 v[76:79],v0,s[8:11],s62 offen sc1
v_cvt_pk_bf16_f32 v80,v56,v57
v_cvt_pk_bf16_f32 v81,v58,v59
v_cvt_pk_bf16_f32 v82,v60,v61
v_cvt_pk_bf16_f32 v83,v62,v63
buffer_store_dwordx4 v[80:83],v0,s[8:11],s65 offen offset:0 sc1
v_cvt_pk_bf16_f32 v84,v64,v65
v_cvt_pk_bf16_f32 v85,v66,v67
v_cvt_pk_bf16_f32 v86,v68,v69
v_cvt_pk_bf16_f32 v87,v70,v71
buffer_store_dwordx4 v[84:87],v0,s[8:11],s65 offen offset:1024 sc1
v_cvt_pk_bf16_f32 v108,v24,v32
v_cvt_pk_bf16_f32 v109,v25,v33
v_cvt_pk_bf16_f32 v110,v26,v34
v_cvt_pk_bf16_f32 v111,v27,v35
buffer_store_dwordx4 v[108:111],v0,s[8:11],s63 offen sc1
v_cvt_pk_bf16_f32 v112,v28,v36
v_cvt_pk_bf16_f32 v113,v29,v37
v_cvt_pk_bf16_f32 v114,v30,v38
v_cvt_pk_bf16_f32 v115,v31,v39
buffer_store_dwordx4 v[112:115],v0,s[8:11],s64 offen sc1
s_lshl_b32 s72,s51,13
s_lshl2_add_u32 s72,s47,s72
s_add_u32 s72,s72,10485760
s_add_u32 s51,s51,1
s_sub_u32 s53,s53,1
s_cmp_gt_u32 s53,0
s_cbranch_scc1 L_chl_150
s_waitcnt vmcnt(0)
s_barrier
s_or_b32 s72,s72,s52
buffer_store_dword v17,off,s[8:11],s72 sc1
L_chd_149:
s_cmp_lg_u32 s3,0
s_cbranch_scc1 L_wc
s_cmp_eq_u32 s48,1
s_cbranch_scc1 L_rc1_151
s_cmp_eq_u32 s48,2
s_cbranch_scc1 L_rc2_152
v_and_b32 v120,15,v1
v_lshrrev_b32 v121,4,v1
v_and_b32 v122,2,v1
v_cmp_eq_u32 vcc,0,v122
v_mov_b32 v2,0xeeee
v_mov_b32 v123,0x4444
v_cndmask_b32 v2,v2,v123,vcc
v_and_b32 v122,1,v1
v_cmp_eq_u32 vcc,0,v122
v_mov_b32 v3,0xdddd
v_mov_b32 v123,0x8888
v_cndmask_b32 v3,v3,v123,vcc
v_lshrrev_b32 v122,1,v120
v_bfe_u32 v123,v120,2,1
v_xor_b32 v123,v123,v122
v_lshlrev_b32 v4,7,v123
v_and_b32 v123,1,v120
v_lshl_add_u32 v4,v123,6,v4
v_xor_b32 v123,v121,v122
v_and_b32 v123,3,v123
v_lshl_add_u32 v4,v123,4,v4
s_lshl_b32 s56,s46,10
s_add_u32 s56,s56,147456
v_add_u32 v4,s56,v4
v_lshlrev_b32 v122,1,v121
v_add_u32 v122,0,v122
v_and_b32 v123,1,v121
v_xor_b32 v123,v123,v122
v_lshlrev_b32 v5,7,v123
v_bfe_u32 v123,v120,3,1
v_lshl_add_u32 v5,v123,6,v5
v_xor_b32 v123,v120,v122
v_and_b32 v123,3,v123
v_lshl_add_u32 v5,v123,4,v5
v_bfe_u32 v123,v120,2,1
v_lshl_add_u32 v5,v123,3,v5
v_add_u32 v5,147456,v5
v_lshlrev_b32 v122,1,v121
v_add_u32 v122,1,v122
v_and_b32 v123,1,v121
v_xor_b32 v123,v123,v122
v_lshlrev_b32 v6,7,v123
v_bfe_u32 v123,v120,3,1
v_lshl_add_u32 v6,v123,6,v6
v_xor_b32 v123,v120,v122
v_and_b32 v123,3,v123
v_lshl_add_u32 v6,v123,4,v6
v_bfe_u32 v123,v120,2,1
v_lshl_add_u32 v6,v123,3,v6
v_add_u32 v6,147456,v6
v_lshlrev_b32 v7,7,v121
v_lshrrev_b32 v122,1,v120
v_lshl_add_u32 v8,v122,4,v7
v_add_u32 v8,151552,v8
v_lshrrev_b32 v122,2,v120
v_lshl_add_u32 v7,v122,5,v7
v_and_b32 v122,1,v120
v_lshl_add_u32 v7,v122,4,v7
v_and_b32 v122,2,v120
v_cmp_eq_u32 vcc,0,v122
s_lshl_b32 s56,s46,9
v_mov_b32 v122,2048
v_mov_b32 v123,s56
v_cndmask_b32 v122,v122,v123,vcc
v_add_u32 v7,v122,v7
v_add_u32 v7,151552,v7
v_lshrrev_b32 v122,3,v1
v_lshlrev_b32 v9,11,v122
v_and_b32 v122,7,v1
v_lshl_add_u32 v9,v122,3,v9
s_lshl_b32 s56,s46,14
s_lshl_b32 s57,s47,6
s_add_u32 s56,s56,s57
v_add_u32 v9,s56,v9
s_lshl_b32 s71,s46,5
s_add_u32 s71,s71,s47
s_bfe_u32 s56,s71,0x10003
s_lshl_b32 s56,s56,11
s_and_b32 s57,s71,1
s_lshl_b32 s57,s57,10
s_add_u32 s56,s56,s57
s_bfe_u32 s57,s71,0x10002
s_lshl_b32 s57,s57,9
s_add_u32 s56,s56,s57
s_bfe_u32 s57,s71,0x10001
s_lshl_b32 s57,s57,6
s_add_u32 s56,s56,s57
s_bfe_u32 s57,s71,0x10004
s_lshl_b32 s57,s57,8
s_add_u32 s56,s56,s57
s_bfe_u32 s57,s71,0x10005
s_lshl_b32 s57,s57,7
s_add_u32 s56,s56,s57
s_bfe_u32 s57,s71,0x10006
s_lshl_b32 s57,s57,12
s_add_u32 s56,s56,s57
v_and_b32 v122,3,v120
v_lshlrev_b32 v10,2,v122
v_bfe_u32 v122,v120,3,1
v_lshl_add_u32 v10,v122,4,v10
v_and_b32 v122,1,v121
v_lshl_add_u32 v10,v122,5,v10
v_add_u32 v10,s56,v10
v_and_b32 v123,36,v1
v_mov_b32 v122,0x80000000
v_cmp_eq_u32 vcc,0,v123
s_nop 1
v_cndmask_b32 v10,v122,v10,vcc
s_lshl_b32 s71,s71,11
s_lshl_b32 s73,s46,11
s_mov_b32 s72,0xffc00000
s_mov_b32 s74,0
v_and_b32 v11,1,v121
v_xor_b32 v11,v11,v120
v_and_b32 v11,3,v11
v_lshrrev_b32 v122,2,v120
v_lshl_add_u32 v11,v11,2,v122
v_lshl_add_u32 v11,v121,4,v11
v_lshlrev_b32 v11,4,v11
s_lshl_b32 s56,s46,15
v_add_u32 v11,s56,v11
v_lshrrev_b32 v13,3,v1
v_lshlrev_b32 v13,9,v13
v_and_b32 v122,7,v1
v_lshl_add_u32 v13,v122,4,v13
v_and_b32 v122,15,v1
v_and_b32 v123,1,v1
v_lshlrev_b32 v123,4,v123
v_mov_b32 v124,0x3f80
v_lshlrev_b32 v124,v123,v124
v_lshrrev_b32 v122,1,v122
v_cmp_eq_u32 vcc,0,v122
s_nop 1
v_cndmask_b32 v18,0,v124,vcc
v_cmp_eq_u32 vcc,1,v122
s_nop 1
v_cndmask_b32 v19,0,v124,vcc
v_cmp_eq_u32 vcc,2,v122
s_nop 1
v_cndmask_b32 v20,0,v124,vcc
v_cmp_eq_u32 vcc,3,v122
s_nop 1
v_cndmask_b32 v21,0,v124,vcc
s_and_b32 s56,s46,1
s_lshl_b32 s56,s56,8
s_and_b32 s57,s46,2
s_lshl_b32 s57,s57,6
s_add_u32 s56,s56,s57
v_add_u32 v13,s56,v13
s_add_u32 s56,s50,155648
v_add_u32 v12,s56,v0
v_mov_b64 v[14:15],s[28:29]
v_mov_b64 v[16:17],s[28:29]
v_add_u32 v22,11550720,v10
s_lshl_b32 s18,s47,2
s_add_u32 s18,s18,10493952
v_mov_b32 v1,s80
s_mov_b32 s65,14680064
s_add_u32 s66,s71,14680064
s_add_u32 s69,s71,14942208
s_mov_b32 s30,0x40000000
s_mov_b32 s51,0
buffer_load_dwordx4 v[88:91],v0,s[8:11],s66 offen offset:0
buffer_load_dwordx4 v[88:91],v0,s[8:11],s66 offen offset:1024
buffer_load_dwordx4 v[88:91],v0,s[8:11],s69 offen offset:0
buffer_load_dwordx4 v[88:91],v0,s[8:11],s69 offen offset:1024
L_cst_156:
s_cmp_lg_u32 s46,0
s_cbranch_scc1 L_csw_161
s_lshl_b32 s59,s51,13
s_lshl2_add_u32 s59,s47,s59
s_add_u32 s59,s59,10485760
s_buffer_load_dword s61,s[8:11],s59
s_waitcnt lgkmcnt(0)
s_cmp_lg_u32 s61,0
s_cbranch_scc1 L_wwd_163
L_ww_162:
s_sleep 1
buffer_load_dword v122,off,s[8:11],s59 sc1
s_sub_u32 s49,s49,1
s_cbranch_scc1 L_abort
s_waitcnt vmcnt(0)
v_readfirstlane_b32 s61,v122
s_cmp_eq_u32 s61,0
s_cbranch_scc1 L_ww_162
L_wwd_163:
L_csw_161:
s_waitcnt lgkmcnt(0)
s_barrier
s_lshl_b32 s56,s51,5
s_add_u32 s56,s56,s47
s_mul_i32 s56,s56,24576
s_add_u32 s56,s56,100663296
s_add_u32 s67,s56,s73
s_add_u32 m0,s73,131072
s_add_u32 s57,s67,8192
buffer_load_dwordx4 v0,s[8:11],s67 offen sc1 lds
buffer_load_dwordx4 v0,s[8:11],s67 offen offset:1024 sc1 lds
s_add_u32 m0,s73,139264
s_add_u32 s67,s67,786432
buffer_load_dwordx4 v0,s[8:11],s57 offen sc1 lds
buffer_load_dwordx4 v0,s[8:11],s57 offen offset:1024 sc1 lds
s_lshl_b32 s75,s51,13
s_add_u32 s56,s75,11542528
buffer_load_dword v23,v10,s[8:11],s56 offen sc1
s_add_u32 s64,s75,11534336
s_add_u32 s70,s64,4096
s_lshl_b32 s68,s51,5
s_add_u32 s68,s68,s47
s_lshl_b32 s68,s68,12
s_lshl_b32 s56,s46,10
s_add_u32 s68,s68,s56
s_add_u32 s68,s68,41943040
s_mov_b32 s54,0x80000000
s_mov_b32 s77,0
s_add_u32 s56,s18,s75
s_buffer_load_dword s19,s[8:11],s56
s_cmp_eq_u32 s51,63
s_cselect_b32 s76,1,s46
s_cmp_eq_u32 s76,0
s_cselect_b32 s76,1,0
v_mov_b64 v[96:97],0
v_mov_b64 v[98:99],0
v_mov_b64 v[100:101],0
v_mov_b64 v[102:103],0
v_mov_b64 v[104:105],0
v_mov_b64 v[106:107],0
v_mov_b64 v[108:109],0
v_mov_b64 v[110:111],0
v_mov_b64 v[112:113],0
v_mov_b64 v[114:115],0
v_mov_b64 v[116:117],0
v_mov_b64 v[118:119],0
buffer_load_dwordx4 v[88:91],v13,s[8:11],s64 offen
buffer_load_dwordx4 v[88:91],v13,s[8:11],s70 offen
s_waitcnt vmcnt(19)
v_swap_b32 v25,v28
v_swap_b32 v26,v32
v_swap_b32 v27,v36
v_swap_b32 v30,v33
v_swap_b32 v31,v37
v_swap_b32 v35,v38
ds_write_b128 v93,v[24:27] offset:4096
ds_write_b128 v94,v[28:31] offset:4096
ds_write_b128 v93,v[32:35] offset:4224
ds_write_b128 v94,v[36:39] offset:4224
s_waitcnt vmcnt(15)
v_swap_b32 v41,v44
v_swap_b32 v42,v48
v_swap_b32 v43,v52
v_swap_b32 v46,v49
v_swap_b32 v47,v53
v_swap_b32 v51,v54
ds_write_b128 v93,v[40:43] offset:5120
ds_write_b128 v94,v[44:47] offset:5120
ds_write_b128 v93,v[48:51] offset:5248
ds_write_b128 v94,v[52:55] offset:5248
s_waitcnt vmcnt(11)
v_swap_b32 v57,v60
v_swap_b32 v58,v64
v_swap_b32 v59,v68
v_swap_b32 v62,v65
v_swap_b32 v63,v69
v_swap_b32 v67,v70
ds_write_b128 v93,v[56:59] offset:6144
ds_write_b128 v94,v[60:63] offset:6144
ds_write_b128 v93,v[64:67] offset:6272
ds_write_b128 v94,v[68:71] offset:6272
s_waitcnt vmcnt(7)
v_swap_b32 v73,v76
v_swap_b32 v74,v80
v_swap_b32 v75,v84
v_swap_b32 v78,v81
v_swap_b32 v79,v85
v_swap_b32 v83,v86
ds_write_b128 v93,v[72:75] offset:7168
ds_write_b128 v94,v[76:79] offset:7168
ds_write_b128 v93,v[80:83] offset:7296
ds_write_b128 v94,v[84:87] offset:7296
s_waitcnt vmcnt(0) lgkmcnt(0)
s_barrier
v_add_u32 v55,131072,v0
ds_read_b128 v[56:59],v55 offset:0
ds_read_b128 v[60:63],v55 offset:4096
ds_read_b128 v[64:67],v55 offset:1024
ds_read_b128 v[68:71],v55 offset:5120
ds_read_b128 v[72:75],v55 offset:2048
ds_read_b128 v[76:79],v55 offset:6144
ds_read_b128 v[80:83],v55 offset:3072
ds_read_b128 v[84:87],v55 offset:7168
v_add_u32 v123,s73,v55
ds_read_b128 v[88:91],v123 offset:8192
ds_read_b128 v[92:95],v123 offset:9216
v_xor_b32 v120,1024,v12
v_xor_b32 v121,2048,v12
v_xor_b32 v122,3072,v12
buffer_load_dwordx4 v[24:27],v13,s[8:11],s64 offen sc1
buffer_load_dwordx4 v[24:27],v13,s[8:11],s64 offen sc1
L_chain_164:
L_cpa_165:
buffer_load_dwordx4 v[24:27],v13,s[8:11],s64 offen sc1
s_sub_u32 s49,s49,1
s_cbranch_scc1 L_abort
s_waitcnt vmcnt(2)
v_max3_u32 v123,v24,v25,v26
v_max_u32 v123,v27,v123
v_cmp_le_u32 vcc,s72,v123
ds_write_b128 v12,v[24:27] offset:0
s_cbranch_vccnz L_cpa_165
L_cgo_168:
v_smfmac_f32_16x16x64_bf16 v[96:99],v[24:27],a[0:7],v2
buffer_load_dwordx4 v[40:43],v13,s[8:11],s70 offen sc1
v_smfmac_f32_16x16x64_bf16 v[100:103],v[24:27],a[128:135],v2
s_waitcnt lgkmcnt(0)
s_barrier
ds_read_b128 v[28:31],v120 offset:0
v_smfmac_f32_16x16x64_bf16 v[104:107],v[24:27],a[8:15],v2
ds_read_b128 v[32:35],v121 offset:0
v_smfmac_f32_16x16x64_bf16 v[108:111],v[24:27],a[136:143],v2
ds_read_b128 v[36:39],v122 offset:0
v_smfmac_f32_16x16x64_bf16 v[112:115],v[24:27],v[128:135],v2
v_smfmac_f32_16x16x64_bf16 v[116:119],v[24:27],v[136:143],v2
s_waitcnt lgkmcnt(2)
v_smfmac_f32_16x16x64_bf16 v[96:99],v[28:31],a[16:23],v2
s_add_u32 m0,s73,131072
v_smfmac_f32_16x16x64_bf16 v[100:103],v[28:31],a[144:151],v2
s_add_u32 s57,s67,8192
v_smfmac_f32_16x16x64_bf16 v[104:107],v[28:31],a[24:31],v2
s_cmp_lt_u32 s19,s76
s_cbranch_scc1 L_ckw_157
L_ckb_158:
v_smfmac_f32_16x16x64_bf16 v[108:111],v[28:31],a[152:159],v2
s_waitcnt vmcnt(0) lgkmcnt(1)
v_smfmac_f32_16x16x64_bf16 v[96:99],v[32:35],a[32:39],v2
ds_write_b128 v12,v[40:43] offset:4096
v_max3_u32 v123,v40,v41,v42
v_smfmac_f32_16x16x64_bf16 v[100:103],v[32:35],a[160:167],v2
v_max_u32 v123,v43,v123
v_smfmac_f32_16x16x64_bf16 v[104:107],v[32:35],a[40:47],v2
v_cmp_le_u32 vcc,s72,v123
v_smfmac_f32_16x16x64_bf16 v[108:111],v[32:35],a[168:175],v2
v_smfmac_f32_16x16x64_bf16 v[112:115],v[28:31],v[144:151],v2
s_cbranch_vccnz L_cpb_171
L_cback_173:
s_waitcnt lgkmcnt(0)
s_barrier
v_smfmac_f32_16x16x64_bf16 v[96:99],v[36:39],a[48:55],v2
buffer_store_dwordx4 v[124:127],v0,s[8:11],s54 offen sc1
v_smfmac_f32_16x16x64_bf16 v[100:103],v[36:39],a[176:183],v2
ds_read_b128 v[44:47],v120 offset:4096
v_smfmac_f32_16x16x64_bf16 v[104:107],v[36:39],a[56:63],v2
buffer_load_dwordx4 v0,s[8:11],s67 offen sc1 lds
v_smfmac_f32_16x16x64_bf16 v[108:111],v[36:39],a[184:191],v2
ds_read_b128 v[48:51],v121 offset:4096
v_smfmac_f32_16x16x64_bf16 v[96:99],v[40:43],a[64:71],v2
buffer_load_dwordx4 v0,s[8:11],s67 offen offset:1024 sc1 lds
s_add_u32 m0,s73,139264
v_smfmac_f32_16x16x64_bf16 v[100:103],v[40:43],a[192:199],v2
ds_read_b128 v[52:55],v122 offset:4096
v_smfmac_f32_16x16x64_bf16 v[104:107],v[40:43],a[72:79],v2
buffer_load_dwordx4 v0,s[8:11],s57 offen sc1 lds
s_add_u32 s67,s67,786432
v_smfmac_f32_16x16x64_bf16 v[108:111],v[40:43],a[200:207],v2
s_waitcnt lgkmcnt(2)
v_smfmac_f32_16x16x64_bf16 v[96:99],v[44:47],a[80:87],v2
buffer_load_dwordx4 v0,s[8:11],s57 offen offset:1024 sc1 lds
v_smfmac_f32_16x16x64_bf16 v[100:103],v[44:47],a[208:215],v2
s_waitcnt lgkmcnt(1)
v_smfmac_f32_16x16x64_bf16 v[96:99],v[48:51],a[96:103],v2
buffer_load_dword v23,v22,s[8:11],s75 offen sc1
v_smfmac_f32_16x16x64_bf16 v[100:103],v[48:51],a[224:231],v2
s_waitcnt lgkmcnt(0)
v_smfmac_f32_16x16x64_bf16 v[96:99],v[52:55],a[112:119],v2
v_smfmac_f32_16x16x64_bf16 v[100:103],v[52:55],a[240:247],v2
v_smfmac_f32_16x16x64_bf16 v[104:107],v[44:47],a[88:95],v2
v_smfmac_f32_16x16x64_bf16 v[108:111],v[44:47],a[216:223],v2
v_smfmac_f32_16x16x64_bf16 v[104:107],v[48:51],a[104:111],v2
v_add_f32 v96,v96,v98
v_smfmac_f32_16x16x64_bf16 v[108:111],v[48:51],a[232:239],v2
v_add_f32 v97,v97,v99
v_smfmac_f32_16x16x64_bf16 v[104:107],v[52:55],a[120:127],v2
v_cvt_pk_bf16_f32 v120,v96,v97
v_smfmac_f32_16x16x64_bf16 v[108:111],v[52:55],a[248:255],v2
v_add_f32 v100,v100,v102
v_smfmac_f32_16x16x64_bf16 v[116:119],v[28:31],v[152:159],v2
v_add_f32 v101,v101,v103
v_smfmac_f32_16x16x64_bf16 v[112:115],v[32:35],v[160:167],v2
v_cvt_pk_bf16_f32 v121,v100,v101
v_add_f32 v104,v104,v106
v_add_f32 v105,v105,v107
v_cvt_pk_bf16_f32 v122,v104,v105
v_add_f32 v108,v108,v110
v_add_f32 v109,v109,v111
v_cvt_pk_bf16_f32 v123,v108,v109
ds_write_b128 v4,v[120:123]
v_smfmac_f32_16x16x64_bf16 v[116:119],v[32:35],v[168:175],v2
s_mov_b32 s54,s68
s_add_u32 s68,s68,131072
v_mov_b32 v125,0
v_smfmac_f32_16x16x64_bf16 v[112:115],v[36:39],v[176:183],v2
s_cmp_eq_u32 s51,63
s_cbranch_scc1 L_cend_167
v_smfmac_f32_16x16x64_bf16 v[116:119],v[36:39],v[184:191],v2
v_smfmac_f32_16x16x64_bf16 v[112:115],v[40:43],v[192:199],v2
s_waitcnt lgkmcnt(0)
s_barrier
ds_read_b64_tr_b16 v[96:97],v5 offset:0
ds_read_b64_tr_b16 v[98:99],v6 offset:0
v_smfmac_f32_16x16x64_bf16 v[116:119],v[40:43],v[200:207],v2
ds_read_b64_tr_b16 v[100:101],v5 offset:1024
v_smfmac_f32_16x16x64_bf16 v[112:115],v[44:47],v[208:215],v2
ds_read_b64_tr_b16 v[102:103],v6 offset:1024
v_smfmac_f32_16x16x64_bf16 v[116:119],v[44:47],v[216:223],v2
ds_read_b64_tr_b16 v[104:105],v5 offset:2048
v_smfmac_f32_16x16x64_bf16 v[112:115],v[48:51],v[224:231],v2
ds_read_b64_tr_b16 v[106:107],v6 offset:2048
s_waitcnt lgkmcnt(4)
v_mfma_f32_16x16x32_bf16 v[24:27],v[56:59],v[96:99],0
ds_read_b64_tr_b16 v[108:109],v5 offset:3072
v_mfma_f32_16x16x32_bf16 v[28:31],v[60:63],v[96:99],0
ds_read_b64_tr_b16 v[110:111],v6 offset:3072
v_mfma_f32_16x16x32_bf16 v[32:35],v[96:99],v[96:99],0
ds_read_b128 v[40:43],v11 offset:12288
s_waitcnt lgkmcnt(5)
v_mfma_f32_16x16x32_bf16 v[24:27],v[64:67],v[100:103],v[24:27]
ds_read_b128 v[56:59],v11 offset:0
v_mfma_f32_16x16x32_bf16 v[28:31],v[68:71],v[100:103],v[28:31]
ds_read_b128 v[60:63],v11 offset:1024
v_mfma_f32_16x16x32_bf16 v[32:35],v[100:103],v[100:103],v[32:35]
ds_read_b128 v[96:99],v11 offset:8192
s_waitcnt lgkmcnt(6)
v_mfma_f32_16x16x32_bf16 v[24:27],v[72:75],v[104:107],v[24:27]
ds_read_b128 v[64:67],v11 offset:2048
v_mfma_f32_16x16x32_bf16 v[28:31],v[76:79],v[104:107],v[28:31]
ds_read_b128 v[68:71],v11 offset:3072
v_mfma_f32_16x16x32_bf16 v[32:35],v[104:107],v[104:107],v[32:35]
ds_read_b128 v[100:103],v11 offset:9216
s_waitcnt lgkmcnt(7)
v_mfma_f32_16x16x32_bf16 v[24:27],v[80:83],v[108:111],v[24:27]
ds_read_b128 v[72:75],v11 offset:4096
v_mfma_f32_16x16x32_bf16 v[28:31],v[84:87],v[108:111],v[28:31]
ds_read_b128 v[76:79],v11 offset:5120
v_mfma_f32_16x16x32_bf16 v[32:35],v[108:111],v[108:111],v[32:35]
ds_read_b128 v[104:107],v11 offset:10240
v_smfmac_f32_16x16x64_bf16 v[116:119],v[48:51],v[232:239],v2
ds_read_b128 v[80:83],v11 offset:6144
v_smfmac_f32_16x16x64_bf16 v[112:115],v[52:55],v[240:247],v2
ds_read_b128 v[84:87],v11 offset:7168
v_smfmac_f32_16x16x64_bf16 v[116:119],v[52:55],v[248:255],v2
ds_read_b128 v[108:111],v11 offset:11264
v_max3_f32 v126,v24,v25,v26
v_max3_f32 v127,v27,v28,v29
v_max3_f32 v126,v30,v31,v126
v_max3_f32 v127,v34,v35,v127
v_max_f32 v126,v126,v127
v_max_f32 v127,v126,v127
v_pk_mul_f32 v[34:35],v[34:35],v[0:1] op_sel:[0,1]
v_pk_mul_f32 v[24:25],v[24:25],v[0:1] op_sel:[0,1]
v_permlane16_swap_b32 v126,v127
v_max_f32 v126,v126,v127
v_max_f32 v127,v126,v127
v_pk_mul_f32 v[26:27],v[26:27],v[0:1] op_sel:[0,1]
v_pk_mul_f32 v[28:29],v[28:29],v[0:1] op_sel:[0,1]
v_permlane32_swap_b32 v126,v127
v_max_f32 v126,v126,v127
v_mul_f32 v126,v1,v126
v_pk_mul_f32 v[30:31],v[30:31],v[0:1] op_sel:[0,1]
v_pk_add_f32 v[34:35],v[34:35],v[126:127] op_sel_hi:[1,0] neg_lo:[0,1] neg_hi:[0,1]
v_pk_add_f32 v[112:113],v[112:113],v[114:115]
v_pk_add_f32 v[116:117],v[116:117],v[118:119]
v_pk_add_f32 v[24:25],v[24:25],v[126:127] op_sel_hi:[1,0] neg_lo:[0,1] neg_hi:[0,1]
v_pk_add_f32 v[26:27],v[26:27],v[126:127] op_sel_hi:[1,0] neg_lo:[0,1] neg_hi:[0,1]
v_pk_add_f32 v[28:29],v[28:29],v[126:127] op_sel_hi:[1,0] neg_lo:[0,1] neg_hi:[0,1]
v_pk_add_f32 v[30:31],v[30:31],v[126:127] op_sel_hi:[1,0] neg_lo:[0,1] neg_hi:[0,1]
v_exp_f32 v34,v34
v_exp_f32 v35,v35
v_cvt_pk_bf16_f32 v126,v112,v113
v_cvt_pk_bf16_f32 v124,v34,v35
v_cvt_pk_bf16_f32 v127,v116,v117
v_cvt_pk_bf16_f32 v36,v116,v117
v_mfma_f32_16x16x16_bf16 v[32:35],v[14:15],v[124:125],0
ds_read_b128 v[44:47],v11 offset:13312
v_exp_f32 v24,v24
v_mfma_f32_16x16x16_bf16 v[112:115],v[126:127],v[124:125],0
ds_read_b128 v[48:51],v11 offset:14336
v_exp_f32 v25,v25
v_mfma_f32_16x16x16_bf16 v[116:119],v[36:37],v[124:125],0
ds_read_b128 v[52:55],v11 offset:15360
v_exp_f32 v26,v26
v_exp_f32 v27,v27
v_cvt_pk_bf16_f32 v120,v24,v25
v_exp_f32 v28,v28
v_exp_f32 v29,v29
v_cvt_pk_bf16_f32 v121,v26,v27
v_exp_f32 v30,v30
v_exp_f32 v31,v31
v_cvt_pk_bf16_f32 v122,v28,v29
v_cvt_pk_bf16_f32 v123,v30,v31
s_add_u32 s75,s75,8192
s_add_u32 s51,s51,1
v_mfma_f32_16x16x32_bf16 v[32:35],v[14:17],v[120:123],v[32:35]
v_mfma_f32_16x16x32_bf16 v[112:115],v[88:91],v[120:123],v[112:115]
ds_read_b128 v[88:91],v11 offset:16384
v_mfma_f32_16x16x32_bf16 v[116:119],v[92:95],v[120:123],v[116:119]
ds_read_b128 v[92:95],v11 offset:17408
v_rcp_f32 v32,v32
v_mov_b64 v[24:25],-1
v_mov_b64 v[26:27],-1
s_add_u32 s64,s75,11534336
s_add_u32 s70,s64,4096
v_pk_mul_f32 v[112:113],v[112:113],v[32:33] op_sel_hi:[1,0]
v_pk_mul_f32 v[114:115],v[114:115],v[32:33] op_sel_hi:[1,0]
v_pk_mul_f32 v[116:117],v[116:117],v[32:33] op_sel_hi:[1,0]
v_pk_mul_f32 v[118:119],v[118:119],v[32:33] op_sel_hi:[1,0]
v_cvt_pk_bf16_f32 v120,v112,v116
v_cvt_pk_bf16_f32 v121,v113,v117
v_cvt_pk_bf16_f32 v122,v114,v118
v_cvt_pk_bf16_f32 v123,v115,v119
ds_write_b128 v7,v[120:123]
buffer_store_dwordx4 v[24:27],v0,s[8:11],s69 offen
buffer_store_dwordx4 v[24:27],v0,s[8:11],s69 offen offset:1024
v_mov_b64 v[112:113],0
v_mov_b64 v[114:115],0
v_mov_b64 v[116:117],0
v_mov_b64 v[118:119],0
s_waitcnt lgkmcnt(0)
s_barrier
ds_read_b128 v[24:27],v8 offset:0
ds_read_b128 v[28:31],v8 offset:512
ds_read_b128 v[32:35],v8 offset:1024
ds_read_b128 v[36:39],v8 offset:1536
v_mov_b64 v[120:121],0
v_mov_b64 v[122:123],0
s_add_u32 s57,s65,65536
s_add_u32 s58,s65,131072
s_add_u32 s59,s65,196608
s_add_u32 s56,s18,s75
s_waitcnt lgkmcnt(3)
v_smfmac_f32_16x16x64_bf16 v[112:115],v[24:27],v[56:63],v3
ds_read_b128 v[56:59],v11 offset:18432
s_waitcnt lgkmcnt(3)
v_smfmac_f32_16x16x64_bf16 v[112:115],v[28:31],v[64:71],v3
ds_read_b128 v[60:63],v11 offset:19456
s_waitcnt lgkmcnt(3)
v_smfmac_f32_16x16x64_bf16 v[112:115],v[32:35],v[72:79],v3
ds_read_b128 v[64:67],v11 offset:20480
s_waitcnt lgkmcnt(3)
v_smfmac_f32_16x16x64_bf16 v[112:115],v[36:39],v[80:87],v3
ds_read_b128 v[68:71],v11 offset:21504
v_smfmac_f32_16x16x64_bf16 v[116:119],v[24:27],v[96:103],v3
ds_read_b128 v[72:75],v11 offset:22528
v_smfmac_f32_16x16x64_bf16 v[116:119],v[28:31],v[104:111],v3
ds_read_b128 v[76:79],v11 offset:23552
v_cvt_pk_bf16_f32 v112,v112,v113
v_smfmac_f32_16x16x64_bf16 v[116:119],v[32:35],v[40:47],v3
ds_read_b128 v[80:83],v11 offset:24576
v_cvt_pk_bf16_f32 v113,v114,v115
buffer_store_dwordx2 v[112:113],v9,s[8:11],s65 offen
v_smfmac_f32_16x16x64_bf16 v[116:119],v[36:39],v[48:55],v3
ds_read_b128 v[84:87],v11 offset:25600
v_mov_b64 v[112:113],0
v_smfmac_f32_16x16x64_bf16 v[120:123],v[24:27],v[88:95],v3
ds_read_b128 v[96:99],v11 offset:26624
ds_read_b128 v[100:103],v11 offset:27648
v_mov_b64 v[114:115],0
s_waitcnt lgkmcnt(8)
v_smfmac_f32_16x16x64_bf16 v[120:123],v[28:31],v[56:63],v3
ds_read_b128 v[104:107],v11 offset:28672
v_cvt_pk_bf16_f32 v116,v116,v117
s_waitcnt lgkmcnt(7)
v_smfmac_f32_16x16x64_bf16 v[120:123],v[32:35],v[64:71],v3
ds_read_b128 v[108:111],v11 offset:29696
ds_read_b128 v[40:43],v11 offset:30720
v_cvt_pk_bf16_f32 v117,v118,v119
buffer_store_dwordx2 v[116:117],v9,s[8:11],s57 offen
s_waitcnt lgkmcnt(7)
v_smfmac_f32_16x16x64_bf16 v[120:123],v[36:39],v[72:79],v3
ds_read_b128 v[44:47],v11 offset:31744
v_add_u32 v52,s50,v5
s_waitcnt lgkmcnt(6)
v_smfmac_f32_16x16x64_bf16 v[112:115],v[24:27],v[80:87],v3
v_add_u32 v54,s50,v6
s_waitcnt lgkmcnt(4)
v_smfmac_f32_16x16x64_bf16 v[112:115],v[28:31],v[96:103],v3
ds_read_b64_tr_b16 v[52:53],v52
v_cvt_pk_bf16_f32 v120,v120,v121
s_waitcnt lgkmcnt(3)
v_smfmac_f32_16x16x64_bf16 v[112:115],v[32:35],v[104:111],v3
ds_read_b64_tr_b16 v[54:55],v54
v_cvt_pk_bf16_f32 v121,v122,v123
buffer_store_dwordx2 v[120:121],v9,s[8:11],s58 offen
s_waitcnt lgkmcnt(2)
v_smfmac_f32_16x16x64_bf16 v[112:115],v[36:39],v[40:47],v3
v_mov_b64 v[116:117],0
v_mov_b64 v[118:119],0
s_xor_b32 s65,s65,262144
v_mov_b32_dpp v124,v126 quad_perm:[2,3,2,3] row_mask:0xf bank_mask:0xf
v_mov_b32_dpp v125,v127 quad_perm:[2,3,2,3] row_mask:0xf bank_mask:0xf
s_mov_b32 vcc_lo,0xcccccccc
s_mov_b32 vcc_hi,0xcccccccc
s_nop 0
v_cvt_pk_bf16_f32 v112,v112,v113
v_cvt_pk_bf16_f32 v113,v114,v115
buffer_store_dwordx2 v[112:113],v9,s[8:11],s59 offen
s_waitcnt lgkmcnt(0)
s_buffer_load_dword s19,s[8:11],s56
v_cndmask_b32 v124,v124,v52,vcc
v_cndmask_b32 v125,v125,v53,vcc
v_cndmask_b32 v126,v126,v54,vcc
v_cndmask_b32 v127,v127,v55,vcc
s_cmp_lt_u32 s46,2
s_waitcnt vmcnt(3)
s_cbranch_scc1 L_crg_174
s_cmp_eq_u32 s46,2
s_waitcnt vmcnt(1)
s_cbranch_scc1 L_crg_174
s_waitcnt vmcnt(0)
L_crg_174:
buffer_load_dwordx4 v[32:35],v0,s[8:11],s66 offen offset:0 sc1
buffer_load_dwordx4 v[36:39],v0,s[8:11],s66 offen offset:1024 sc1
v_mov_b64 v[96:97],0
v_mov_b64 v[98:99],0
v_mov_b64 v[100:101],0
v_mov_b64 v[102:103],0
v_mov_b64 v[104:105],0
v_mov_b64 v[106:107],0
v_mov_b64 v[108:109],0
v_mov_b64 v[110:111],0
v_mov_b64 v[112:113],0
v_mov_b64 v[114:115],0
v_add_u32 v55,131072,v0
v_add_u32 v123,s73,v55
v_xor_b32 v120,1024,v12
v_xor_b32 v121,2048,v12
v_xor_b32 v122,3072,v12
buffer_load_dwordx4 v[44:47],v0,s[8:11],s66 offen offset:0 sc1
buffer_load_dwordx4 v[48:51],v0,s[8:11],s66 offen offset:1024 sc1
s_cmp_ge_u32 s51,63
s_cselect_b32 s76,0,1
s_cmp_eq_u32 s46,0
s_cselect_b32 s76,s76,0
s_waitcnt vmcnt(3)
v_mfma_f32_16x16x32_bf16 v[28:31],v[18:21],v[32:35],0
s_waitcnt vmcnt(2)
v_mfma_f32_16x16x32_bf16 v[28:31],v[18:21],v[36:39],v[28:31]
s_nop 7
v_cmp_u_f32 vcc,v28,v28
v_add_f32_dpp v52,v28,v28 row_ror:8 row_mask:0xf bank_mask:0x3
v_add_f32_dpp v53,v29,v29 row_ror:8 row_mask:0xf bank_mask:0x3
v_add_f32_dpp v52,v30,v30 row_ror:8 row_mask:0xf bank_mask:0xc
v_add_f32_dpp v53,v31,v31 row_ror:8 row_mask:0xf bank_mask:0xc
s_nop 0
v_add_f32_dpp v52,v52,v52 row_shl:4 row_mask:0xf bank_mask:0x5
v_add_f32_dpp v53,v53,v53 row_shl:4 row_mask:0xf bank_mask:0x5
s_cbranch_vccnz L_crp_169
L_cok_175:
v_cvt_pk_bf16_f32 v54,v52,v53
buffer_store_dword v54,v10,s[8:11],s64 offen
s_mov_b32 s69,s66
s_xor_b32 s66,s66,262144
s_barrier
ds_read_b128 v[56:59],v55 offset:0
ds_read_b128 v[60:63],v55 offset:4096
ds_read_b128 v[64:67],v55 offset:1024
buffer_load_dwordx4 v[24:27],v13,s[8:11],s64 offen sc1
ds_read_b128 v[68:71],v55 offset:5120
ds_read_b128 v[72:75],v55 offset:2048
ds_read_b128 v[76:79],v55 offset:6144
ds_read_b128 v[80:83],v55 offset:3072
buffer_load_dwordx4 v[24:27],v13,s[8:11],s64 offen sc1
ds_read_b128 v[84:87],v55 offset:7168
ds_read_b128 v[88:91],v123 offset:8192
ds_read_b128 v[92:95],v123 offset:9216
s_branch L_chain_164
L_cpb_171:
buffer_load_dwordx4 v[40:43],v13,s[8:11],s70 offen sc1
s_sub_u32 s49,s49,1
s_cbranch_scc1 L_abort
s_waitcnt vmcnt(0)
v_max3_u32 v123,v40,v41,v42
v_max_u32 v123,v43,v123
v_cmp_le_u32 vcc,s72,v123
s_cbranch_vccnz L_cpb_171
ds_write_b128 v12,v[40:43] offset:4096
s_branch L_cback_173
L_crp_169:
buffer_load_dwordx4 v[32:35],v0,s[8:11],s66 offen offset:0 sc1
buffer_load_dwordx4 v[36:39],v0,s[8:11],s66 offen offset:1024 sc1
s_sub_u32 s49,s49,1
s_cbranch_scc1 L_abort
s_waitcnt vmcnt(3)
v_mfma_f32_16x16x32_bf16 v[28:31],v[18:21],v[44:47],0
s_waitcnt vmcnt(2)
v_mfma_f32_16x16x32_bf16 v[28:31],v[18:21],v[48:51],v[28:31]
s_nop 7
v_cmp_u_f32 vcc,v28,v28
v_add_f32_dpp v52,v28,v28 row_ror:8 row_mask:0xf bank_mask:0x3
v_add_f32_dpp v53,v29,v29 row_ror:8 row_mask:0xf bank_mask:0x3
v_add_f32_dpp v52,v30,v30 row_ror:8 row_mask:0xf bank_mask:0xc
v_add_f32_dpp v53,v31,v31 row_ror:8 row_mask:0xf bank_mask:0xc
s_nop 0
v_add_f32_dpp v52,v52,v52 row_shl:4 row_mask:0xf bank_mask:0x5
v_add_f32_dpp v53,v53,v53 row_shl:4 row_mask:0xf bank_mask:0x5
s_cbranch_vccz L_cok_175
buffer_load_dwordx4 v[44:47],v0,s[8:11],s66 offen offset:0 sc1
buffer_load_dwordx4 v[48:51],v0,s[8:11],s66 offen offset:1024 sc1
s_sub_u32 s49,s49,1
s_cbranch_scc1 L_abort
s_waitcnt vmcnt(3)
v_mfma_f32_16x16x32_bf16 v[28:31],v[18:21],v[32:35],0
s_waitcnt vmcnt(2)
v_mfma_f32_16x16x32_bf16 v[28:31],v[18:21],v[36:39],v[28:31]
s_nop 7
v_cmp_u_f32 vcc,v28,v28
v_add_f32_dpp v52,v28,v28 row_ror:8 row_mask:0xf bank_mask:0x3
v_add_f32_dpp v53,v29,v29 row_ror:8 row_mask:0xf bank_mask:0x3
v_add_f32_dpp v52,v30,v30 row_ror:8 row_mask:0xf bank_mask:0xc
v_add_f32_dpp v53,v31,v31 row_ror:8 row_mask:0xf bank_mask:0xc
s_nop 0
v_add_f32_dpp v52,v52,v52 row_shl:4 row_mask:0xf bank_mask:0x5
v_add_f32_dpp v53,v53,v53 row_shl:4 row_mask:0xf bank_mask:0x5
s_cbranch_vccz L_cok_175
s_branch L_crp_169
L_ckw_157:
s_add_u32 s59,s18,s75
L_ww_176:
s_sleep 1
buffer_load_dword v23,off,s[8:11],s59 sc1
s_sub_u32 s49,s49,1
s_cbranch_scc1 L_abort
s_waitcnt vmcnt(0)
v_readfirstlane_b32 s76,v23
s_cmp_eq_u32 s76,0
s_cbranch_scc1 L_ww_176
L_wwd_177:
s_branch L_ckb_158
L_cend_167:
v_smfmac_f32_16x16x64_bf16 v[116:119],v[36:39],v[184:191],v2
v_smfmac_f32_16x16x64_bf16 v[112:115],v[40:43],v[192:199],v2
v_smfmac_f32_16x16x64_bf16 v[116:119],v[40:43],v[200:207],v2
v_smfmac_f32_16x16x64_bf16 v[112:115],v[44:47],v[208:215],v2
v_smfmac_f32_16x16x64_bf16 v[116:119],v[44:47],v[216:223],v2
v_smfmac_f32_16x16x64_bf16 v[112:115],v[48:51],v[224:231],v2
v_smfmac_f32_16x16x64_bf16 v[116:119],v[48:51],v[232:239],v2
v_smfmac_f32_16x16x64_bf16 v[112:115],v[52:55],v[240:247],v2
v_smfmac_f32_16x16x64_bf16 v[116:119],v[52:55],v[248:255],v2
s_waitcnt lgkmcnt(0)
s_nop 2
v_pk_add_f32 v[112:113],v[112:113],v[114:115]
s_nop 2
v_pk_add_f32 v[116:117],v[116:117],v[118:119]
v_cvt_pk_bf16_f32 v126,v112,v113
v_cvt_pk_bf16_f32 v127,v116,v117
v_add_u32 v52,s50,v5
v_add_u32 v54,s50,v6
ds_read_b64_tr_b16 v[52:53],v52
ds_read_b64_tr_b16 v[54:55],v54
v_mov_b32_dpp v124,v126 quad_perm:[2,3,2,3] row_mask:0xf bank_mask:0xf
v_mov_b32_dpp v125,v127 quad_perm:[2,3,2,3] row_mask:0xf bank_mask:0xf
s_mov_b32 vcc_lo,0xcccccccc
s_mov_b32 vcc_hi,0xcccccccc
s_waitcnt lgkmcnt(0)
v_cndmask_b32 v124,v124,v52,vcc
v_cndmask_b32 v125,v125,v53,vcc
v_cndmask_b32 v126,v126,v54,vcc
v_cndmask_b32 v127,v127,v55,vcc
buffer_store_dwordx4 v[124:127],v0,s[8:11],s54 offen sc1
s_mov_b32 s51,64
s_waitcnt vmcnt(0)
s_barrier
s_nop 11
v_lshrrev_b32 v1,4,v0
s_mov_b32 s53,0
s_branch L_rb_7
L_rc1_151:
v_and_b32 v120,15,v1
v_lshrrev_b32 v121,4,v1
v_and_b32 v122,2,v1
v_cmp_eq_u32 vcc,0,v122
v_mov_b32 v2,0xeeee
v_mov_b32 v123,0x4444
v_cndmask_b32 v2,v2,v123,vcc
v_and_b32 v122,1,v1
v_cmp_eq_u32 vcc,0,v122
v_mov_b32 v3,0xdddd
v_mov_b32 v123,0x8888
v_cndmask_b32 v3,v3,v123,vcc
v_lshrrev_b32 v122,1,v120
v_bfe_u32 v123,v120,2,1
v_xor_b32 v123,v123,v122
v_lshlrev_b32 v4,7,v123
v_and_b32 v123,1,v120
v_lshl_add_u32 v4,v123,6,v4
v_xor_b32 v123,v121,v122
v_and_b32 v123,3,v123
v_lshl_add_u32 v4,v123,4,v4
s_lshl_b32 s56,s46,10
s_add_u32 s56,s56,147456
v_add_u32 v4,s56,v4
v_lshlrev_b32 v122,1,v121
v_add_u32 v122,0,v122
v_and_b32 v123,1,v121
v_xor_b32 v123,v123,v122
v_lshlrev_b32 v5,7,v123
v_bfe_u32 v123,v120,3,1
v_lshl_add_u32 v5,v123,6,v5
v_xor_b32 v123,v120,v122
v_and_b32 v123,3,v123
v_lshl_add_u32 v5,v123,4,v5
v_bfe_u32 v123,v120,2,1
v_lshl_add_u32 v5,v123,3,v5
v_add_u32 v5,147456,v5
v_lshlrev_b32 v122,1,v121
v_add_u32 v122,1,v122
v_and_b32 v123,1,v121
v_xor_b32 v123,v123,v122
v_lshlrev_b32 v6,7,v123
v_bfe_u32 v123,v120,3,1
v_lshl_add_u32 v6,v123,6,v6
v_xor_b32 v123,v120,v122
v_and_b32 v123,3,v123
v_lshl_add_u32 v6,v123,4,v6
v_bfe_u32 v123,v120,2,1
v_lshl_add_u32 v6,v123,3,v6
v_add_u32 v6,147456,v6
v_lshlrev_b32 v7,7,v121
v_lshrrev_b32 v122,1,v120
v_lshl_add_u32 v8,v122,4,v7
v_add_u32 v8,151552,v8
v_lshrrev_b32 v122,2,v120
v_lshl_add_u32 v7,v122,5,v7
v_and_b32 v122,1,v120
v_lshl_add_u32 v7,v122,4,v7
v_and_b32 v122,2,v120
v_cmp_eq_u32 vcc,0,v122
s_lshl_b32 s56,s46,9
v_mov_b32 v122,2048
v_mov_b32 v123,s56
v_cndmask_b32 v122,v122,v123,vcc
v_add_u32 v7,v122,v7
v_add_u32 v7,151552,v7
v_lshrrev_b32 v122,3,v1
v_lshlrev_b32 v9,11,v122
v_and_b32 v122,7,v1
v_lshl_add_u32 v9,v122,3,v9
s_lshl_b32 s56,s46,14
s_lshl_b32 s57,s47,6
s_add_u32 s56,s56,s57
v_add_u32 v9,s56,v9
s_lshl_b32 s71,s46,5
s_add_u32 s71,s71,s47
s_bfe_u32 s56,s71,0x10003
s_lshl_b32 s56,s56,11
s_and_b32 s57,s71,1
s_lshl_b32 s57,s57,10
s_add_u32 s56,s56,s57
s_bfe_u32 s57,s71,0x10002
s_lshl_b32 s57,s57,9
s_add_u32 s56,s56,s57
s_bfe_u32 s57,s71,0x10001
s_lshl_b32 s57,s57,6
s_add_u32 s56,s56,s57
s_bfe_u32 s57,s71,0x10004
s_lshl_b32 s57,s57,8
s_add_u32 s56,s56,s57
s_bfe_u32 s57,s71,0x10005
s_lshl_b32 s57,s57,7
s_add_u32 s56,s56,s57
s_bfe_u32 s57,s71,0x10006
s_lshl_b32 s57,s57,12
s_add_u32 s56,s56,s57
v_and_b32 v122,3,v120
v_lshlrev_b32 v10,2,v122
v_bfe_u32 v122,v120,3,1
v_lshl_add_u32 v10,v122,4,v10
v_and_b32 v122,1,v121
v_lshl_add_u32 v10,v122,5,v10
v_add_u32 v10,s56,v10
v_and_b32 v123,36,v1
v_mov_b32 v122,0x80000000
v_cmp_eq_u32 vcc,0,v123
s_nop 1
v_cndmask_b32 v10,v122,v10,vcc
s_lshl_b32 s71,s71,11
s_lshl_b32 s73,s46,11
s_mov_b32 s72,0xffc00000
s_mov_b32 s74,0
v_and_b32 v11,1,v121
v_xor_b32 v11,v11,v120
v_and_b32 v11,3,v11
v_lshrrev_b32 v122,2,v120
v_lshl_add_u32 v11,v11,2,v122
v_lshl_add_u32 v11,v121,4,v11
v_lshlrev_b32 v11,4,v11
s_lshl_b32 s56,s46,15
v_add_u32 v11,s56,v11
v_lshrrev_b32 v13,3,v1
v_lshlrev_b32 v13,9,v13
v_and_b32 v122,7,v1
v_lshl_add_u32 v13,v122,4,v13
v_and_b32 v122,15,v1
v_and_b32 v123,1,v1
v_lshlrev_b32 v123,4,v123
v_mov_b32 v124,0x3f80
v_lshlrev_b32 v124,v123,v124
v_lshrrev_b32 v122,1,v122
v_cmp_eq_u32 vcc,0,v122
s_nop 1
v_cndmask_b32 v18,0,v124,vcc
v_cmp_eq_u32 vcc,1,v122
s_nop 1
v_cndmask_b32 v19,0,v124,vcc
v_cmp_eq_u32 vcc,2,v122
s_nop 1
v_cndmask_b32 v20,0,v124,vcc
v_cmp_eq_u32 vcc,3,v122
s_nop 1
v_cndmask_b32 v21,0,v124,vcc
s_and_b32 s56,s46,1
s_lshl_b32 s56,s56,8
s_and_b32 s57,s46,2
s_lshl_b32 s57,s57,6
s_add_u32 s56,s56,s57
v_add_u32 v13,s56,v13
s_add_u32 s56,s50,155648
v_add_u32 v12,s56,v0
v_mov_b64 v[14:15],s[28:29]
v_mov_b64 v[16:17],s[28:29]
v_add_u32 v22,12599296,v10
s_lshl_b32 s18,s47,2
s_add_u32 s18,s18,10494080
v_mov_b32 v1,s80
s_mov_b32 s65,15728640
s_add_u32 s66,s71,15728640
s_add_u32 s69,s71,15990784
s_mov_b32 s30,0x40000000
s_mov_b32 s51,0
buffer_load_dwordx4 v[88:91],v0,s[8:11],s66 offen offset:0
buffer_load_dwordx4 v[88:91],v0,s[8:11],s66 offen offset:1024
buffer_load_dwordx4 v[88:91],v0,s[8:11],s69 offen offset:0
buffer_load_dwordx4 v[88:91],v0,s[8:11],s69 offen offset:1024
s_waitcnt vmcnt(0)
L_cst_181:
s_cmp_lg_u32 s46,0
s_cbranch_scc1 L_csw_186
s_lshl_b32 s59,s51,13
s_lshl2_add_u32 s59,s47,s59
s_add_u32 s59,s59,10485888
L_ww_187:
s_sleep 1
buffer_load_dword v122,off,s[8:11],s59 sc1
s_sub_u32 s49,s49,1
s_cbranch_scc1 L_abort
s_waitcnt vmcnt(0)
v_readfirstlane_b32 s61,v122
s_cmp_eq_u32 s61,0
s_cbranch_scc1 L_ww_187
L_wwd_188:
L_csw_186:
s_waitcnt lgkmcnt(0)
s_barrier
s_lshl_b32 s56,s51,5
s_add_u32 s56,s56,s47
s_mul_i32 s56,s56,24576
s_add_u32 s56,s56,150994944
s_add_u32 s67,s56,s73
s_add_u32 m0,s73,131072
s_add_u32 s57,s67,8192
buffer_load_dwordx4 v0,s[8:11],s67 offen sc1 lds
buffer_load_dwordx4 v0,s[8:11],s67 offen offset:1024 sc1 lds
s_add_u32 m0,s73,139264
s_add_u32 s67,s67,786432
buffer_load_dwordx4 v0,s[8:11],s57 offen sc1 lds
buffer_load_dwordx4 v0,s[8:11],s57 offen offset:1024 sc1 lds
s_lshl_b32 s75,s51,13
s_add_u32 s56,s75,12591104
buffer_load_dword v23,v10,s[8:11],s56 offen sc1
s_add_u32 s64,s75,12582912
s_add_u32 s70,s64,4096
s_lshl_b32 s68,s51,5
s_add_u32 s68,s68,s47
s_lshl_b32 s68,s68,12
s_lshl_b32 s56,s46,10
s_add_u32 s68,s68,s56
s_add_u32 s68,s68,58720256
s_mov_b32 s54,0x80000000
s_mov_b32 s77,0
s_add_u32 s56,s18,s75
s_buffer_load_dword s19,s[8:11],s56
s_cmp_eq_u32 s51,63
s_cselect_b32 s76,1,s46
s_cmp_eq_u32 s76,0
s_cselect_b32 s76,1,0
v_mov_b64 v[96:97],0
v_mov_b64 v[98:99],0
v_mov_b64 v[100:101],0
v_mov_b64 v[102:103],0
v_mov_b64 v[104:105],0
v_mov_b64 v[106:107],0
v_mov_b64 v[108:109],0
v_mov_b64 v[110:111],0
v_mov_b64 v[112:113],0
v_mov_b64 v[114:115],0
v_mov_b64 v[116:117],0
v_mov_b64 v[118:119],0
s_waitcnt vmcnt(0) lgkmcnt(0)
s_barrier
v_add_u32 v55,131072,v0
ds_read_b128 v[56:59],v55 offset:0
ds_read_b128 v[60:63],v55 offset:4096
ds_read_b128 v[64:67],v55 offset:1024
ds_read_b128 v[68:71],v55 offset:5120
ds_read_b128 v[72:75],v55 offset:2048
ds_read_b128 v[76:79],v55 offset:6144
ds_read_b128 v[80:83],v55 offset:3072
ds_read_b128 v[84:87],v55 offset:7168
v_add_u32 v123,s73,v55
ds_read_b128 v[88:91],v123 offset:8192
ds_read_b128 v[92:95],v123 offset:9216
v_xor_b32 v120,1024,v12
v_xor_b32 v121,2048,v12
v_xor_b32 v122,3072,v12
buffer_load_dwordx4 v[24:27],v13,s[8:11],s64 offen sc1
buffer_load_dwordx4 v[24:27],v13,s[8:11],s64 offen sc1
L_chain_189:
L_cpa_190:
buffer_load_dwordx4 v[24:27],v13,s[8:11],s64 offen sc1
s_sub_u32 s49,s49,1
s_cbranch_scc1 L_abort
s_waitcnt vmcnt(2)
v_max3_u32 v123,v24,v25,v26
v_max_u32 v123,v27,v123
v_cmp_le_u32 vcc,s72,v123
ds_write_b128 v12,v[24:27] offset:0
s_cbranch_vccnz L_cpa_190
L_cgo_193:
v_smfmac_f32_16x16x64_bf16 v[96:99],v[24:27],a[0:7],v2
buffer_load_dwordx4 v[40:43],v13,s[8:11],s70 offen sc1
v_smfmac_f32_16x16x64_bf16 v[100:103],v[24:27],a[128:135],v2
s_waitcnt lgkmcnt(0)
s_barrier
ds_read_b128 v[28:31],v120 offset:0
v_smfmac_f32_16x16x64_bf16 v[104:107],v[24:27],a[8:15],v2
ds_read_b128 v[32:35],v121 offset:0
v_smfmac_f32_16x16x64_bf16 v[108:111],v[24:27],a[136:143],v2
ds_read_b128 v[36:39],v122 offset:0
v_smfmac_f32_16x16x64_bf16 v[112:115],v[24:27],v[128:135],v2
v_smfmac_f32_16x16x64_bf16 v[116:119],v[24:27],v[136:143],v2
s_waitcnt lgkmcnt(2)
v_smfmac_f32_16x16x64_bf16 v[96:99],v[28:31],a[16:23],v2
s_add_u32 m0,s73,131072
v_smfmac_f32_16x16x64_bf16 v[100:103],v[28:31],a[144:151],v2
s_add_u32 s57,s67,8192
v_smfmac_f32_16x16x64_bf16 v[104:107],v[28:31],a[24:31],v2
s_cmp_lt_u32 s19,s76
s_cbranch_scc1 L_ckw_182
L_ckb_183:
v_smfmac_f32_16x16x64_bf16 v[108:111],v[28:31],a[152:159],v2
s_waitcnt vmcnt(0) lgkmcnt(1)
v_smfmac_f32_16x16x64_bf16 v[96:99],v[32:35],a[32:39],v2
ds_write_b128 v12,v[40:43] offset:4096
v_max3_u32 v123,v40,v41,v42
v_smfmac_f32_16x16x64_bf16 v[100:103],v[32:35],a[160:167],v2
v_max_u32 v123,v43,v123
v_smfmac_f32_16x16x64_bf16 v[104:107],v[32:35],a[40:47],v2
v_cmp_le_u32 vcc,s72,v123
v_smfmac_f32_16x16x64_bf16 v[108:111],v[32:35],a[168:175],v2
v_smfmac_f32_16x16x64_bf16 v[112:115],v[28:31],v[144:151],v2
s_cbranch_vccnz L_cpb_196
L_cback_198:
s_waitcnt lgkmcnt(0)
s_barrier
v_smfmac_f32_16x16x64_bf16 v[96:99],v[36:39],a[48:55],v2
buffer_store_dword v54,v10,s[8:11],s30 offen sc1
v_smfmac_f32_16x16x64_bf16 v[100:103],v[36:39],a[176:183],v2
ds_read_b128 v[44:47],v120 offset:4096
v_smfmac_f32_16x16x64_bf16 v[104:107],v[36:39],a[56:63],v2
buffer_store_dwordx4 v[124:127],v0,s[8:11],s54 offen sc1
v_smfmac_f32_16x16x64_bf16 v[108:111],v[36:39],a[184:191],v2
ds_read_b128 v[48:51],v121 offset:4096
v_smfmac_f32_16x16x64_bf16 v[96:99],v[40:43],a[64:71],v2
buffer_load_dwordx4 v0,s[8:11],s67 offen sc1 lds
v_smfmac_f32_16x16x64_bf16 v[100:103],v[40:43],a[192:199],v2
ds_read_b128 v[52:55],v122 offset:4096
v_smfmac_f32_16x16x64_bf16 v[104:107],v[40:43],a[72:79],v2
buffer_load_dwordx4 v0,s[8:11],s67 offen offset:1024 sc1 lds
s_add_u32 m0,s73,139264
v_smfmac_f32_16x16x64_bf16 v[108:111],v[40:43],a[200:207],v2
s_waitcnt lgkmcnt(2)
v_smfmac_f32_16x16x64_bf16 v[96:99],v[44:47],a[80:87],v2
buffer_load_dwordx4 v0,s[8:11],s57 offen sc1 lds
s_add_u32 s67,s67,786432
v_smfmac_f32_16x16x64_bf16 v[100:103],v[44:47],a[208:215],v2
s_waitcnt lgkmcnt(1)
v_smfmac_f32_16x16x64_bf16 v[96:99],v[48:51],a[96:103],v2
buffer_load_dwordx4 v0,s[8:11],s57 offen offset:1024 sc1 lds
v_smfmac_f32_16x16x64_bf16 v[100:103],v[48:51],a[224:231],v2
s_waitcnt lgkmcnt(0)
v_smfmac_f32_16x16x64_bf16 v[96:99],v[52:55],a[112:119],v2
buffer_load_dword v23,v22,s[8:11],s75 offen sc1
v_smfmac_f32_16x16x64_bf16 v[100:103],v[52:55],a[240:247],v2
v_smfmac_f32_16x16x64_bf16 v[104:107],v[44:47],a[88:95],v2
v_smfmac_f32_16x16x64_bf16 v[108:111],v[44:47],a[216:223],v2
v_smfmac_f32_16x16x64_bf16 v[104:107],v[48:51],a[104:111],v2
v_add_f32 v96,v96,v98
v_smfmac_f32_16x16x64_bf16 v[108:111],v[48:51],a[232:239],v2
v_add_f32 v97,v97,v99
v_smfmac_f32_16x16x64_bf16 v[104:107],v[52:55],a[120:127],v2
v_cvt_pk_bf16_f32 v120,v96,v97
v_smfmac_f32_16x16x64_bf16 v[108:111],v[52:55],a[248:255],v2
v_add_f32 v100,v100,v102
v_smfmac_f32_16x16x64_bf16 v[116:119],v[28:31],v[152:159],v2
v_add_f32 v101,v101,v103
v_smfmac_f32_16x16x64_bf16 v[112:115],v[32:35],v[160:167],v2
v_cvt_pk_bf16_f32 v121,v100,v101
v_add_f32 v104,v104,v106
v_add_f32 v105,v105,v107
v_cvt_pk_bf16_f32 v122,v104,v105
v_add_f32 v108,v108,v110
v_add_f32 v109,v109,v111
v_cvt_pk_bf16_f32 v123,v108,v109
ds_write_b128 v4,v[120:123]
v_smfmac_f32_16x16x64_bf16 v[116:119],v[32:35],v[168:175],v2
s_mov_b32 s54,s68
s_add_u32 s68,s68,131072
v_mov_b32 v125,0
v_smfmac_f32_16x16x64_bf16 v[112:115],v[36:39],v[176:183],v2
s_cmp_eq_u32 s51,63
s_cbranch_scc1 L_cend_192
v_smfmac_f32_16x16x64_bf16 v[116:119],v[36:39],v[184:191],v2
v_smfmac_f32_16x16x64_bf16 v[112:115],v[40:43],v[192:199],v2
s_waitcnt lgkmcnt(0)
s_barrier
ds_read_b64_tr_b16 v[96:97],v5 offset:0
ds_read_b64_tr_b16 v[98:99],v6 offset:0
v_smfmac_f32_16x16x64_bf16 v[116:119],v[40:43],v[200:207],v2
ds_read_b64_tr_b16 v[100:101],v5 offset:1024
v_smfmac_f32_16x16x64_bf16 v[112:115],v[44:47],v[208:215],v2
ds_read_b64_tr_b16 v[102:103],v6 offset:1024
v_smfmac_f32_16x16x64_bf16 v[116:119],v[44:47],v[216:223],v2
ds_read_b64_tr_b16 v[104:105],v5 offset:2048
v_smfmac_f32_16x16x64_bf16 v[112:115],v[48:51],v[224:231],v2
ds_read_b64_tr_b16 v[106:107],v6 offset:2048
s_waitcnt lgkmcnt(4)
v_mfma_f32_16x16x32_bf16 v[24:27],v[56:59],v[96:99],0
ds_read_b64_tr_b16 v[108:109],v5 offset:3072
v_mfma_f32_16x16x32_bf16 v[28:31],v[60:63],v[96:99],0
ds_read_b64_tr_b16 v[110:111],v6 offset:3072
v_mfma_f32_16x16x32_bf16 v[32:35],v[96:99],v[96:99],0
ds_read_b128 v[40:43],v11 offset:12288
s_waitcnt lgkmcnt(5)
v_mfma_f32_16x16x32_bf16 v[24:27],v[64:67],v[100:103],v[24:27]
ds_read_b128 v[56:59],v11 offset:0
v_mfma_f32_16x16x32_bf16 v[28:31],v[68:71],v[100:103],v[28:31]
ds_read_b128 v[60:63],v11 offset:1024
v_mfma_f32_16x16x32_bf16 v[32:35],v[100:103],v[100:103],v[32:35]
ds_read_b128 v[96:99],v11 offset:8192
s_waitcnt lgkmcnt(6)
v_mfma_f32_16x16x32_bf16 v[24:27],v[72:75],v[104:107],v[24:27]
ds_read_b128 v[64:67],v11 offset:2048
v_mfma_f32_16x16x32_bf16 v[28:31],v[76:79],v[104:107],v[28:31]
ds_read_b128 v[68:71],v11 offset:3072
v_mfma_f32_16x16x32_bf16 v[32:35],v[104:107],v[104:107],v[32:35]
ds_read_b128 v[100:103],v11 offset:9216
s_waitcnt lgkmcnt(7)
v_mfma_f32_16x16x32_bf16 v[24:27],v[80:83],v[108:111],v[24:27]
ds_read_b128 v[72:75],v11 offset:4096
v_mfma_f32_16x16x32_bf16 v[28:31],v[84:87],v[108:111],v[28:31]
ds_read_b128 v[76:79],v11 offset:5120
v_mfma_f32_16x16x32_bf16 v[32:35],v[108:111],v[108:111],v[32:35]
ds_read_b128 v[104:107],v11 offset:10240
v_smfmac_f32_16x16x64_bf16 v[116:119],v[48:51],v[232:239],v2
ds_read_b128 v[80:83],v11 offset:6144
v_smfmac_f32_16x16x64_bf16 v[112:115],v[52:55],v[240:247],v2
ds_read_b128 v[84:87],v11 offset:7168
v_smfmac_f32_16x16x64_bf16 v[116:119],v[52:55],v[248:255],v2
ds_read_b128 v[108:111],v11 offset:11264
v_max3_f32 v126,v24,v25,v26
v_max3_f32 v127,v27,v28,v29
v_max3_f32 v126,v30,v31,v126
v_max3_f32 v127,v34,v35,v127
v_max_f32 v126,v126,v127
v_max_f32 v127,v126,v127
v_pk_mul_f32 v[34:35],v[34:35],v[0:1] op_sel:[0,1]
v_pk_mul_f32 v[24:25],v[24:25],v[0:1] op_sel:[0,1]
v_permlane16_swap_b32 v126,v127
v_max_f32 v126,v126,v127
v_max_f32 v127,v126,v127
v_pk_mul_f32 v[26:27],v[26:27],v[0:1] op_sel:[0,1]
v_pk_mul_f32 v[28:29],v[28:29],v[0:1] op_sel:[0,1]
v_permlane32_swap_b32 v126,v127
v_max_f32 v126,v126,v127
v_mul_f32 v126,v1,v126
v_pk_mul_f32 v[30:31],v[30:31],v[0:1] op_sel:[0,1]
v_pk_add_f32 v[34:35],v[34:35],v[126:127] op_sel_hi:[1,0] neg_lo:[0,1] neg_hi:[0,1]
v_pk_add_f32 v[112:113],v[112:113],v[114:115]
v_pk_add_f32 v[116:117],v[116:117],v[118:119]
v_pk_add_f32 v[24:25],v[24:25],v[126:127] op_sel_hi:[1,0] neg_lo:[0,1] neg_hi:[0,1]
v_pk_add_f32 v[26:27],v[26:27],v[126:127] op_sel_hi:[1,0] neg_lo:[0,1] neg_hi:[0,1]
v_pk_add_f32 v[28:29],v[28:29],v[126:127] op_sel_hi:[1,0] neg_lo:[0,1] neg_hi:[0,1]
v_pk_add_f32 v[30:31],v[30:31],v[126:127] op_sel_hi:[1,0] neg_lo:[0,1] neg_hi:[0,1]
v_exp_f32 v34,v34
v_exp_f32 v35,v35
v_cvt_pk_bf16_f32 v126,v112,v113
v_cvt_pk_bf16_f32 v124,v34,v35
v_cvt_pk_bf16_f32 v127,v116,v117
v_cvt_pk_bf16_f32 v36,v116,v117
v_mfma_f32_16x16x16_bf16 v[32:35],v[14:15],v[124:125],0
ds_read_b128 v[44:47],v11 offset:13312
v_exp_f32 v24,v24
v_mfma_f32_16x16x16_bf16 v[112:115],v[126:127],v[124:125],0
ds_read_b128 v[48:51],v11 offset:14336
v_exp_f32 v25,v25
v_mfma_f32_16x16x16_bf16 v[116:119],v[36:37],v[124:125],0
ds_read_b128 v[52:55],v11 offset:15360
v_exp_f32 v26,v26
v_exp_f32 v27,v27
v_cvt_pk_bf16_f32 v120,v24,v25
v_exp_f32 v28,v28
v_exp_f32 v29,v29
v_cvt_pk_bf16_f32 v121,v26,v27
v_exp_f32 v30,v30
v_exp_f32 v31,v31
v_cvt_pk_bf16_f32 v122,v28,v29
v_cvt_pk_bf16_f32 v123,v30,v31
s_add_u32 s75,s75,8192
s_add_u32 s51,s51,1
v_mfma_f32_16x16x32_bf16 v[32:35],v[14:17],v[120:123],v[32:35]
v_mfma_f32_16x16x32_bf16 v[112:115],v[88:91],v[120:123],v[112:115]
ds_read_b128 v[88:91],v11 offset:16384
v_mfma_f32_16x16x32_bf16 v[116:119],v[92:95],v[120:123],v[116:119]
ds_read_b128 v[92:95],v11 offset:17408
v_rcp_f32 v32,v32
v_mov_b64 v[24:25],-1
v_mov_b64 v[26:27],-1
s_add_u32 s64,s75,12582912
s_add_u32 s70,s64,4096
v_pk_mul_f32 v[112:113],v[112:113],v[32:33] op_sel_hi:[1,0]
v_pk_mul_f32 v[114:115],v[114:115],v[32:33] op_sel_hi:[1,0]
v_pk_mul_f32 v[116:117],v[116:117],v[32:33] op_sel_hi:[1,0]
v_pk_mul_f32 v[118:119],v[118:119],v[32:33] op_sel_hi:[1,0]
v_cvt_pk_bf16_f32 v120,v112,v116
v_cvt_pk_bf16_f32 v121,v113,v117
v_cvt_pk_bf16_f32 v122,v114,v118
v_cvt_pk_bf16_f32 v123,v115,v119
ds_write_b128 v7,v[120:123]
buffer_store_dwordx4 v[24:27],v0,s[8:11],s69 offen
buffer_store_dwordx4 v[24:27],v0,s[8:11],s69 offen offset:1024
v_mov_b64 v[112:113],0
v_mov_b64 v[114:115],0
v_mov_b64 v[116:117],0
v_mov_b64 v[118:119],0
s_waitcnt lgkmcnt(0)
s_barrier
ds_read_b128 v[24:27],v8 offset:0
ds_read_b128 v[28:31],v8 offset:512
ds_read_b128 v[32:35],v8 offset:1024
ds_read_b128 v[36:39],v8 offset:1536
v_mov_b64 v[120:121],0
v_mov_b64 v[122:123],0
s_add_u32 s57,s65,65536
s_add_u32 s58,s65,131072
s_add_u32 s59,s65,196608
s_add_u32 s56,s18,s75
s_add_u32 s30,s75,17825792
s_waitcnt lgkmcnt(3)
v_smfmac_f32_16x16x64_bf16 v[112:115],v[24:27],v[56:63],v3
ds_read_b128 v[56:59],v11 offset:18432
s_waitcnt lgkmcnt(3)
v_smfmac_f32_16x16x64_bf16 v[112:115],v[28:31],v[64:71],v3
ds_read_b128 v[60:63],v11 offset:19456
s_waitcnt lgkmcnt(3)
v_smfmac_f32_16x16x64_bf16 v[112:115],v[32:35],v[72:79],v3
ds_read_b128 v[64:67],v11 offset:20480
s_waitcnt lgkmcnt(3)
v_smfmac_f32_16x16x64_bf16 v[112:115],v[36:39],v[80:87],v3
ds_read_b128 v[68:71],v11 offset:21504
v_smfmac_f32_16x16x64_bf16 v[116:119],v[24:27],v[96:103],v3
ds_read_b128 v[72:75],v11 offset:22528
v_smfmac_f32_16x16x64_bf16 v[116:119],v[28:31],v[104:111],v3
ds_read_b128 v[76:79],v11 offset:23552
v_cvt_pk_bf16_f32 v112,v112,v113
v_smfmac_f32_16x16x64_bf16 v[116:119],v[32:35],v[40:47],v3
ds_read_b128 v[80:83],v11 offset:24576
v_cvt_pk_bf16_f32 v113,v114,v115
buffer_store_dwordx2 v[112:113],v9,s[8:11],s65 offen
v_smfmac_f32_16x16x64_bf16 v[116:119],v[36:39],v[48:55],v3
ds_read_b128 v[84:87],v11 offset:25600
v_mov_b64 v[112:113],0
v_smfmac_f32_16x16x64_bf16 v[120:123],v[24:27],v[88:95],v3
ds_read_b128 v[96:99],v11 offset:26624
ds_read_b128 v[100:103],v11 offset:27648
v_mov_b64 v[114:115],0
s_waitcnt lgkmcnt(8)
v_smfmac_f32_16x16x64_bf16 v[120:123],v[28:31],v[56:63],v3
ds_read_b128 v[104:107],v11 offset:28672
v_cvt_pk_bf16_f32 v116,v116,v117
s_waitcnt lgkmcnt(7)
v_smfmac_f32_16x16x64_bf16 v[120:123],v[32:35],v[64:71],v3
ds_read_b128 v[108:111],v11 offset:29696
ds_read_b128 v[40:43],v11 offset:30720
v_cvt_pk_bf16_f32 v117,v118,v119
buffer_store_dwordx2 v[116:117],v9,s[8:11],s57 offen
s_waitcnt lgkmcnt(7)
v_smfmac_f32_16x16x64_bf16 v[120:123],v[36:39],v[72:79],v3
ds_read_b128 v[44:47],v11 offset:31744
v_add_u32 v52,s50,v5
s_waitcnt lgkmcnt(6)
v_smfmac_f32_16x16x64_bf16 v[112:115],v[24:27],v[80:87],v3
v_add_u32 v54,s50,v6
s_waitcnt lgkmcnt(4)
v_smfmac_f32_16x16x64_bf16 v[112:115],v[28:31],v[96:103],v3
ds_read_b64_tr_b16 v[52:53],v52
v_cvt_pk_bf16_f32 v120,v120,v121
s_waitcnt lgkmcnt(3)
v_smfmac_f32_16x16x64_bf16 v[112:115],v[32:35],v[104:111],v3
ds_read_b64_tr_b16 v[54:55],v54
v_cvt_pk_bf16_f32 v121,v122,v123
buffer_store_dwordx2 v[120:121],v9,s[8:11],s58 offen
s_waitcnt lgkmcnt(2)
v_smfmac_f32_16x16x64_bf16 v[112:115],v[36:39],v[40:47],v3
v_mov_b64 v[116:117],0
v_mov_b64 v[118:119],0
s_xor_b32 s65,s65,262144
v_mov_b32_dpp v124,v126 quad_perm:[2,3,2,3] row_mask:0xf bank_mask:0xf
v_mov_b32_dpp v125,v127 quad_perm:[2,3,2,3] row_mask:0xf bank_mask:0xf
s_mov_b32 vcc_lo,0xcccccccc
s_mov_b32 vcc_hi,0xcccccccc
s_nop 0
v_cvt_pk_bf16_f32 v112,v112,v113
v_cvt_pk_bf16_f32 v113,v114,v115
buffer_store_dwordx2 v[112:113],v9,s[8:11],s59 offen
s_waitcnt lgkmcnt(0)
s_buffer_load_dword s19,s[8:11],s56
v_cndmask_b32 v124,v124,v52,vcc
v_cndmask_b32 v125,v125,v53,vcc
v_cndmask_b32 v126,v126,v54,vcc
v_cndmask_b32 v127,v127,v55,vcc
s_cmp_lt_u32 s46,2
s_waitcnt vmcnt(3)
s_cbranch_scc1 L_crg_199
s_cmp_eq_u32 s46,2
s_waitcnt vmcnt(1)
s_cbranch_scc1 L_crg_199
s_waitcnt vmcnt(0)
L_crg_199:
buffer_load_dwordx4 v[32:35],v0,s[8:11],s66 offen offset:0 sc1
buffer_load_dwordx4 v[36:39],v0,s[8:11],s66 offen offset:1024 sc1
v_mov_b64 v[96:97],0
v_mov_b64 v[98:99],0
v_mov_b64 v[100:101],0
v_mov_b64 v[102:103],0
v_mov_b64 v[104:105],0
v_mov_b64 v[106:107],0
v_mov_b64 v[108:109],0
v_mov_b64 v[110:111],0
v_mov_b64 v[112:113],0
v_mov_b64 v[114:115],0
v_add_u32 v55,131072,v0
v_add_u32 v123,s73,v55
v_xor_b32 v120,1024,v12
v_xor_b32 v121,2048,v12
v_xor_b32 v122,3072,v12
buffer_load_dwordx4 v[44:47],v0,s[8:11],s66 offen offset:0 sc1
buffer_load_dwordx4 v[48:51],v0,s[8:11],s66 offen offset:1024 sc1
s_cmp_ge_u32 s51,63
s_cselect_b32 s76,0,1
s_cmp_eq_u32 s46,0
s_cselect_b32 s76,s76,0
s_waitcnt vmcnt(3)
v_mfma_f32_16x16x32_bf16 v[28:31],v[18:21],v[32:35],0
s_waitcnt vmcnt(2)
v_mfma_f32_16x16x32_bf16 v[28:31],v[18:21],v[36:39],v[28:31]
s_nop 7
v_cmp_u_f32 vcc,v28,v28
v_add_f32_dpp v52,v28,v28 row_ror:8 row_mask:0xf bank_mask:0x3
v_add_f32_dpp v53,v29,v29 row_ror:8 row_mask:0xf bank_mask:0x3
v_add_f32_dpp v52,v30,v30 row_ror:8 row_mask:0xf bank_mask:0xc
v_add_f32_dpp v53,v31,v31 row_ror:8 row_mask:0xf bank_mask:0xc
s_nop 0
v_add_f32_dpp v52,v52,v52 row_shl:4 row_mask:0xf bank_mask:0x5
v_add_f32_dpp v53,v53,v53 row_shl:4 row_mask:0xf bank_mask:0x5
s_cbranch_vccnz L_crp_194
L_cok_200:
v_cvt_pk_bf16_f32 v54,v52,v53
buffer_store_dword v54,v10,s[8:11],s64 offen
s_mov_b32 s69,s66
s_xor_b32 s66,s66,262144
s_barrier
ds_read_b128 v[56:59],v55 offset:0
ds_read_b128 v[60:63],v55 offset:4096
ds_read_b128 v[64:67],v55 offset:1024
buffer_load_dwordx4 v[24:27],v13,s[8:11],s64 offen sc1
ds_read_b128 v[68:71],v55 offset:5120
ds_read_b128 v[72:75],v55 offset:2048
ds_read_b128 v[76:79],v55 offset:6144
ds_read_b128 v[80:83],v55 offset:3072
buffer_load_dwordx4 v[24:27],v13,s[8:11],s64 offen sc1
ds_read_b128 v[84:87],v55 offset:7168
ds_read_b128 v[88:91],v123 offset:8192
ds_read_b128 v[92:95],v123 offset:9216
s_branch L_chain_189
L_cpb_196:
buffer_load_dwordx4 v[40:43],v13,s[8:11],s70 offen sc1
s_sub_u32 s49,s49,1
s_cbranch_scc1 L_abort
s_waitcnt vmcnt(0)
v_max3_u32 v123,v40,v41,v42
v_max_u32 v123,v43,v123
v_cmp_le_u32 vcc,s72,v123
s_cbranch_vccnz L_cpb_196
ds_write_b128 v12,v[40:43] offset:4096
s_branch L_cback_198
L_crp_194:
buffer_load_dwordx4 v[32:35],v0,s[8:11],s66 offen offset:0 sc1
buffer_load_dwordx4 v[36:39],v0,s[8:11],s66 offen offset:1024 sc1
s_sub_u32 s49,s49,1
s_cbranch_scc1 L_abort
s_waitcnt vmcnt(3)
v_mfma_f32_16x16x32_bf16 v[28:31],v[18:21],v[44:47],0
s_waitcnt vmcnt(2)
v_mfma_f32_16x16x32_bf16 v[28:31],v[18:21],v[48:51],v[28:31]
s_nop 7
v_cmp_u_f32 vcc,v28,v28
v_add_f32_dpp v52,v28,v28 row_ror:8 row_mask:0xf bank_mask:0x3
v_add_f32_dpp v53,v29,v29 row_ror:8 row_mask:0xf bank_mask:0x3
v_add_f32_dpp v52,v30,v30 row_ror:8 row_mask:0xf bank_mask:0xc
v_add_f32_dpp v53,v31,v31 row_ror:8 row_mask:0xf bank_mask:0xc
s_nop 0
v_add_f32_dpp v52,v52,v52 row_shl:4 row_mask:0xf bank_mask:0x5
v_add_f32_dpp v53,v53,v53 row_shl:4 row_mask:0xf bank_mask:0x5
s_cbranch_vccz L_cok_200
buffer_load_dwordx4 v[44:47],v0,s[8:11],s66 offen offset:0 sc1
buffer_load_dwordx4 v[48:51],v0,s[8:11],s66 offen offset:1024 sc1
s_sub_u32 s49,s49,1
s_cbranch_scc1 L_abort
s_waitcnt vmcnt(3)
v_mfma_f32_16x16x32_bf16 v[28:31],v[18:21],v[32:35],0
s_waitcnt vmcnt(2)
v_mfma_f32_16x16x32_bf16 v[28:31],v[18:21],v[36:39],v[28:31]
s_nop 7
v_cmp_u_f32 vcc,v28,v28
v_add_f32_dpp v52,v28,v28 row_ror:8 row_mask:0xf bank_mask:0x3
v_add_f32_dpp v53,v29,v29 row_ror:8 row_mask:0xf bank_mask:0x3
v_add_f32_dpp v52,v30,v30 row_ror:8 row_mask:0xf bank_mask:0xc
v_add_f32_dpp v53,v31,v31 row_ror:8 row_mask:0xf bank_mask:0xc
s_nop 0
v_add_f32_dpp v52,v52,v52 row_shl:4 row_mask:0xf bank_mask:0x5
v_add_f32_dpp v53,v53,v53 row_shl:4 row_mask:0xf bank_mask:0x5
s_cbranch_vccz L_cok_200
s_branch L_crp_194
L_ckw_182:
s_add_u32 s59,s18,s75
L_ww_201:
s_sleep 1
buffer_load_dword v23,off,s[8:11],s59 sc1
s_sub_u32 s49,s49,1
s_cbranch_scc1 L_abort
s_waitcnt vmcnt(0)
v_readfirstlane_b32 s76,v23
s_cmp_eq_u32 s76,0
s_cbranch_scc1 L_ww_201
L_wwd_202:
s_branch L_ckb_183
L_cend_192:
v_smfmac_f32_16x16x64_bf16 v[116:119],v[36:39],v[184:191],v2
v_smfmac_f32_16x16x64_bf16 v[112:115],v[40:43],v[192:199],v2
v_smfmac_f32_16x16x64_bf16 v[116:119],v[40:43],v[200:207],v2
v_smfmac_f32_16x16x64_bf16 v[112:115],v[44:47],v[208:215],v2
v_smfmac_f32_16x16x64_bf16 v[116:119],v[44:47],v[216:223],v2
v_smfmac_f32_16x16x64_bf16 v[112:115],v[48:51],v[224:231],v2
v_smfmac_f32_16x16x64_bf16 v[116:119],v[48:51],v[232:239],v2
v_smfmac_f32_16x16x64_bf16 v[112:115],v[52:55],v[240:247],v2
v_smfmac_f32_16x16x64_bf16 v[116:119],v[52:55],v[248:255],v2
s_waitcnt lgkmcnt(0)
s_nop 2
v_pk_add_f32 v[112:113],v[112:113],v[114:115]
s_nop 2
v_pk_add_f32 v[116:117],v[116:117],v[118:119]
v_cvt_pk_bf16_f32 v126,v112,v113
v_cvt_pk_bf16_f32 v127,v116,v117
v_add_u32 v52,s50,v5
v_add_u32 v54,s50,v6
ds_read_b64_tr_b16 v[52:53],v52
ds_read_b64_tr_b16 v[54:55],v54
v_mov_b32_dpp v124,v126 quad_perm:[2,3,2,3] row_mask:0xf bank_mask:0xf
v_mov_b32_dpp v125,v127 quad_perm:[2,3,2,3] row_mask:0xf bank_mask:0xf
s_mov_b32 vcc_lo,0xcccccccc
s_mov_b32 vcc_hi,0xcccccccc
s_waitcnt lgkmcnt(0)
v_cndmask_b32 v124,v124,v52,vcc
v_cndmask_b32 v125,v125,v53,vcc
v_cndmask_b32 v126,v126,v54,vcc
v_cndmask_b32 v127,v127,v55,vcc
buffer_store_dwordx4 v[124:127],v0,s[8:11],s54 offen sc1
s_mov_b32 s51,64
s_waitcnt vmcnt(0)
s_barrier
s_nop 11
v_lshrrev_b32 v1,4,v0
s_endpgm
L_rc2_152:
v_and_b32 v120,15,v1
v_lshrrev_b32 v121,4,v1
v_and_b32 v122,2,v1
v_cmp_eq_u32 vcc,0,v122
v_mov_b32 v2,0xeeee
v_mov_b32 v123,0x4444
v_cndmask_b32 v2,v2,v123,vcc
v_and_b32 v122,1,v1
v_cmp_eq_u32 vcc,0,v122
v_mov_b32 v3,0xdddd
v_mov_b32 v123,0x8888
v_cndmask_b32 v3,v3,v123,vcc
v_lshrrev_b32 v122,1,v120
v_bfe_u32 v123,v120,2,1
v_xor_b32 v123,v123,v122
v_lshlrev_b32 v4,7,v123
v_and_b32 v123,1,v120
v_lshl_add_u32 v4,v123,6,v4
v_xor_b32 v123,v121,v122
v_and_b32 v123,3,v123
v_lshl_add_u32 v4,v123,4,v4
s_lshl_b32 s56,s46,10
s_add_u32 s56,s56,147456
v_add_u32 v4,s56,v4
v_lshlrev_b32 v122,1,v121
v_add_u32 v122,0,v122
v_and_b32 v123,1,v121
v_xor_b32 v123,v123,v122
v_lshlrev_b32 v5,7,v123
v_bfe_u32 v123,v120,3,1
v_lshl_add_u32 v5,v123,6,v5
v_xor_b32 v123,v120,v122
v_and_b32 v123,3,v123
v_lshl_add_u32 v5,v123,4,v5
v_bfe_u32 v123,v120,2,1
v_lshl_add_u32 v5,v123,3,v5
v_add_u32 v5,147456,v5
v_lshlrev_b32 v122,1,v121
v_add_u32 v122,1,v122
v_and_b32 v123,1,v121
v_xor_b32 v123,v123,v122
v_lshlrev_b32 v6,7,v123
v_bfe_u32 v123,v120,3,1
v_lshl_add_u32 v6,v123,6,v6
v_xor_b32 v123,v120,v122
v_and_b32 v123,3,v123
v_lshl_add_u32 v6,v123,4,v6
v_bfe_u32 v123,v120,2,1
v_lshl_add_u32 v6,v123,3,v6
v_add_u32 v6,147456,v6
v_lshlrev_b32 v7,7,v121
v_lshrrev_b32 v122,1,v120
v_lshl_add_u32 v8,v122,4,v7
v_add_u32 v8,151552,v8
v_lshrrev_b32 v122,2,v120
v_lshl_add_u32 v7,v122,5,v7
v_and_b32 v122,1,v120
v_lshl_add_u32 v7,v122,4,v7
v_and_b32 v122,2,v120
v_cmp_eq_u32 vcc,0,v122
s_lshl_b32 s56,s46,9
v_mov_b32 v122,2048
v_mov_b32 v123,s56
v_cndmask_b32 v122,v122,v123,vcc
v_add_u32 v7,v122,v7
v_add_u32 v7,151552,v7
v_lshrrev_b32 v122,3,v1
v_lshlrev_b32 v9,11,v122
v_and_b32 v122,7,v1
v_lshl_add_u32 v9,v122,3,v9
s_lshl_b32 s56,s46,14
s_lshl_b32 s57,s47,6
s_add_u32 s56,s56,s57
v_add_u32 v9,s56,v9
s_lshl_b32 s71,s46,5
s_add_u32 s71,s71,s47
s_bfe_u32 s56,s71,0x10003
s_lshl_b32 s56,s56,11
s_and_b32 s57,s71,1
s_lshl_b32 s57,s57,10
s_add_u32 s56,s56,s57
s_bfe_u32 s57,s71,0x10002
s_lshl_b32 s57,s57,9
s_add_u32 s56,s56,s57
s_bfe_u32 s57,s71,0x10001
s_lshl_b32 s57,s57,6
s_add_u32 s56,s56,s57
s_bfe_u32 s57,s71,0x10004
s_lshl_b32 s57,s57,8
s_add_u32 s56,s56,s57
s_bfe_u32 s57,s71,0x10005
s_lshl_b32 s57,s57,7
s_add_u32 s56,s56,s57
s_bfe_u32 s57,s71,0x10006
s_lshl_b32 s57,s57,12
s_add_u32 s56,s56,s57
v_and_b32 v122,3,v120
v_lshlrev_b32 v10,2,v122
v_bfe_u32 v122,v120,3,1
v_lshl_add_u32 v10,v122,4,v10
v_and_b32 v122,1,v121
v_lshl_add_u32 v10,v122,5,v10
v_add_u32 v10,s56,v10
v_and_b32 v123,36,v1
v_mov_b32 v122,0x80000000
v_cmp_eq_u32 vcc,0,v123
s_nop 1
v_cndmask_b32 v10,v122,v10,vcc
s_lshl_b32 s71,s71,11
s_lshl_b32 s73,s46,11
s_mov_b32 s72,0xffc00000
s_mov_b32 s74,0
v_and_b32 v11,1,v121
v_xor_b32 v11,v11,v120
v_and_b32 v11,3,v11
v_lshrrev_b32 v122,2,v120
v_lshl_add_u32 v11,v11,2,v122
v_lshl_add_u32 v11,v121,4,v11
v_lshlrev_b32 v11,4,v11
s_lshl_b32 s56,s46,15
v_add_u32 v11,s56,v11
v_lshrrev_b32 v13,3,v1
v_lshlrev_b32 v13,9,v13
v_and_b32 v122,7,v1
v_lshl_add_u32 v13,v122,4,v13
v_and_b32 v122,15,v1
v_and_b32 v123,1,v1
v_lshlrev_b32 v123,4,v123
v_mov_b32 v124,0x3f80
v_lshlrev_b32 v124,v123,v124
v_lshrrev_b32 v122,1,v122
v_cmp_eq_u32 vcc,0,v122
s_nop 1
v_cndmask_b32 v18,0,v124,vcc
v_cmp_eq_u32 vcc,1,v122
s_nop 1
v_cndmask_b32 v19,0,v124,vcc
v_cmp_eq_u32 vcc,2,v122
s_nop 1
v_cndmask_b32 v20,0,v124,vcc
v_cmp_eq_u32 vcc,3,v122
s_nop 1
v_cndmask_b32 v21,0,v124,vcc
s_and_b32 s56,s46,1
s_lshl_b32 s56,s56,8
s_and_b32 s57,s46,2
s_lshl_b32 s57,s57,6
s_add_u32 s56,s56,s57
v_add_u32 v13,s56,v13
s_add_u32 s56,s50,155648
v_add_u32 v12,s56,v0
v_mov_b64 v[14:15],s[28:29]
v_mov_b64 v[16:17],s[28:29]
v_add_u32 v22,13647872,v10
s_lshl_b32 s18,s47,2
s_add_u32 s18,s18,10494080
v_mov_b32 v1,s80
s_mov_b32 s65,16777216
s_add_u32 s66,s71,16777216
s_add_u32 s69,s71,17039360
s_mov_b32 s30,0x40000000
s_mov_b32 s51,0
v_lshrrev_b32 v120,2,v0
v_add_u32 v120,10510464,v120
v_or_b32 v120,s52,v120
s_mov_b64 vcc,-1
s_mov_b32 vcc_lo,0
v_cndmask_b32 v22,v22,v120,vcc
s_or_b32 s56,s52,10495616
v_writelane_b32 v22,s56,4
s_or_b32 s56,s47,s46
s_mov_b32 s56,10486784
s_cmov_b32 s56,0x80000000
v_writelane_b32 v22,s56,5
s_mov_b32 s30,0
s_mov_b32 s31,0
buffer_load_dwordx4 v[88:91],v0,s[8:11],s66 offen offset:0
buffer_load_dwordx4 v[88:91],v0,s[8:11],s66 offen offset:1024
buffer_load_dwordx4 v[88:91],v0,s[8:11],s69 offen offset:0
buffer_load_dwordx4 v[88:91],v0,s[8:11],s69 offen offset:1024
s_waitcnt vmcnt(0)
L_cst_206:
s_cmp_lg_u32 s46,0
s_cbranch_scc1 L_csw_211
s_andn2_b32 s61,0x7ff,s30
s_lshr_b32 s61,s61,5
s_add_u32 s61,s61,2
s_add_u32 s60,s31,1
s_min_u32 s60,s60,63
s_cmp_gt_u32 s60,s61
s_cselect_b32 s60,s31,s60
s_sub_u32 s61,s60,s31
s_lshl_b32 s61,s61,13
s_lshl_b32 s59,s31,13
s_add_u32 s59,s59,10486016
v_lshrrev_b32 v121,2,v0
v_and_b32 v121,127,v121
v_lshrrev_b32 v120,9,v0
v_mul_u32_u24 v120,s61,v120
v_add_u32 v121,v120,v121
L_ckk_212:
s_sleep 1
buffer_load_dword v120,v121,s[8:11],s59 offen sc1
s_sub_u32 s49,s49,1
s_cbranch_scc1 L_abort
s_waitcnt vmcnt(0)
v_cmp_eq_u32 vcc,0,v120
s_cbranch_vccnz L_ckk_212
v_max_u32_dpp v120,v120,v120 row_ror:8 row_mask:0xf bank_mask:0xf
s_nop 1
v_max_u32_dpp v120,v120,v120 row_ror:4 row_mask:0xf bank_mask:0xf
s_nop 1
v_max_u32_dpp v120,v120,v120 row_ror:2 row_mask:0xf bank_mask:0xf
s_nop 1
v_max_u32_dpp v120,v120,v120 row_ror:1 row_mask:0xf bank_mask:0xf
v_mov_b32 v121,v120
s_nop 1
v_permlane16_swap_b32 v120,v121
v_max_u32 v120,v120,v121
v_mov_b32 v121,v120
s_nop 1
v_permlane32_swap_b32 v120,v121
v_max_u32 v120,v120,v121
s_nop 0
v_readfirstlane_b32 s61,v120
s_max_u32 s30,s30,s61
s_add_u32 s31,s60,1
s_andn2_b32 s51,0x7ff,s30
s_lshr_b32 s51,s51,5
s_add_u32 s61,s51,2
s_min_u32 s61,s61,63
s_cmp_le_u32 s31,s61
s_cbranch_scc1 L_cst_206
v_mov_b32 v120,0
v_mov_b32 v121,s30
ds_write_b32 v8,v120 offset:2560
ds_write_b32 v8,v121 offset:3072
s_lshl_b32 s59,s51,13
s_lshl2_add_u32 s59,s47,s59
s_add_u32 s59,s59,10485888
L_ww_213:
s_sleep 1
buffer_load_dword v122,off,s[8:11],s59 sc1
s_sub_u32 s49,s49,1
s_cbranch_scc1 L_abort
s_waitcnt vmcnt(0)
v_readfirstlane_b32 s61,v122
s_cmp_eq_u32 s61,0
s_cbranch_scc1 L_ww_213
L_wwd_214:
L_csw_211:
s_waitcnt lgkmcnt(0)
s_barrier
ds_read_b32 v120,v8 offset:3072
s_waitcnt lgkmcnt(0)
v_readfirstlane_b32 s30,v120
s_andn2_b32 s51,0x7ff,s30
s_lshr_b32 s51,s51,5
s_lshl_b32 s56,s51,5
s_add_u32 s56,s56,s47
s_mul_i32 s56,s56,24576
s_add_u32 s56,s56,150994944
s_add_u32 s67,s56,s73
s_add_u32 m0,s73,131072
s_add_u32 s57,s67,8192
buffer_load_dwordx4 v0,s[8:11],s67 offen sc1 lds
buffer_load_dwordx4 v0,s[8:11],s67 offen offset:1024 sc1 lds
s_add_u32 m0,s73,139264
s_add_u32 s67,s67,786432
buffer_load_dwordx4 v0,s[8:11],s57 offen sc1 lds
buffer_load_dwordx4 v0,s[8:11],s57 offen offset:1024 sc1 lds
s_lshl_b32 s75,s51,13
s_add_u32 s56,s75,13639680
buffer_load_dword v23,v10,s[8:11],s56 offen sc1
s_add_u32 s64,s75,17825792
s_add_u32 s70,s64,4096
s_lshl_b32 s68,s51,5
s_add_u32 s68,s68,s47
s_lshl_b32 s68,s68,12
s_lshl_b32 s56,s46,10
s_add_u32 s68,s68,s56
s_add_u32 s68,s68,75497472
s_mov_b32 s54,0x80000000
s_mov_b32 s77,0
s_add_u32 s56,s18,s75
s_buffer_load_dword s19,s[8:11],s56
s_cmp_eq_u32 s51,63
s_cselect_b32 s76,1,s46
s_cmp_eq_u32 s76,0
s_cselect_b32 s76,1,0
v_mov_b64 v[96:97],0
v_mov_b64 v[98:99],0
v_mov_b64 v[100:101],0
v_mov_b64 v[102:103],0
v_mov_b64 v[104:105],0
v_mov_b64 v[106:107],0
v_mov_b64 v[108:109],0
v_mov_b64 v[110:111],0
v_mov_b64 v[112:113],0
v_mov_b64 v[114:115],0
v_mov_b64 v[116:117],0
v_mov_b64 v[118:119],0
v_lshrrev_b32 v56,8,v0
v_lshlrev_b32 v56,5,v56
v_bfe_u32 v57,v0,5,1
v_lshl_add_u32 v56,v57,2,v56
s_lshl_b32 s56,s46,7
s_add_u32 s56,s56,155648
v_add_u32 v56,s56,v56
v_xor_b32 v57,128,v56
v_xor_b32 v58,256,v56
v_xor_b32 v59,384,v56
s_andn2_b32 s56,31,s30
s_lshr_b32 s57,s56,4
s_lshl_b32 s58,s57,12
s_and_b32 s59,s56,15
s_lshl4_add_u32 s58,s59,s58
s_add_u32 s58,s58,s50
s_add_u32 s58,s58,131072
v_bfe_u32 v60,v0,6,2
v_lshlrev_b32 v60,8,v60
v_bfe_u32 v61,v0,4,2
v_lshl_add_u32 v60,v61,2,v60
v_add_u32 v60,s58,v60
s_lshr_b32 s58,s59,2
s_lshl_b32 s58,s58,8
s_lshl3_add_u32 s58,s57,s58
s_and_b32 s59,s56,3
s_lshl1_add_u32 s58,s59,s58
s_add_u32 s58,s58,s73
s_add_u32 s58,s58,139264
v_and_b32 v61,255,v0
v_add_u32 v61,s58,v61
s_cmp_lg_u32 s46,0
s_cbranch_scc1 L_chd_216
s_lshl_b32 s59,s51,10
s_add_u32 s59,s59,11337728
L_chp_215:
buffer_load_dwordx4 v[120:123],v0,s[8:11],s59 offen sc1
s_sub_u32 s49,s49,1
s_cbranch_scc1 L_abort
s_waitcnt vmcnt(0)
v_max3_u32 v124,v120,v121,v122
v_max_u32 v124,v123,v124
v_cmp_eq_u32 vcc,-1,v124
s_cbranch_vccnz L_chp_215
ds_write_b128 v12,v[120:123]
L_chd_216:
s_waitcnt vmcnt(0) lgkmcnt(0)
s_barrier
ds_read2_b32 v[24:25],v56 offset0:0 offset1:2
ds_read2_b32 v[26:27],v56 offset0:4 offset1:6
ds_read2_b32 v[28:29],v57 offset0:0 offset1:2
ds_read2_b32 v[30:31],v57 offset0:4 offset1:6
ds_read2_b32 v[32:33],v58 offset0:0 offset1:2
ds_read2_b32 v[34:35],v58 offset0:4 offset1:6
ds_read2_b32 v[36:37],v59 offset0:0 offset1:2
ds_read2_b32 v[38:39],v59 offset0:4 offset1:6
s_waitcnt lgkmcnt(4)
ds_read2_b32 v[40:41],v56 offset0:128 offset1:130
ds_read2_b32 v[42:43],v56 offset0:132 offset1:134
ds_read2_b32 v[44:45],v57 offset0:128 offset1:130
ds_read2_b32 v[46:47],v57 offset0:132 offset1:134
ds_read2_b32 v[48:49],v58 offset0:128 offset1:130
ds_read2_b32 v[50:51],v58 offset0:132 offset1:134
ds_read2_b32 v[52:53],v59 offset0:128 offset1:130
ds_read2_b32 v[54:55],v59 offset0:132 offset1:134
s_waitcnt lgkmcnt(12)
v_smfmac_f32_16x16x64_bf16 v[100:103],v[24:27],a[128:135],v2
v_smfmac_f32_16x16x64_bf16 v[112:115],v[24:27],v[128:135],v2
v_smfmac_f32_16x16x64_bf16 v[108:111],v[24:27],a[136:143],v2
v_smfmac_f32_16x16x64_bf16 v[116:119],v[24:27],v[136:143],v2
s_waitcnt lgkmcnt(12)
v_smfmac_f32_16x16x64_bf16 v[100:103],v[28:31],a[144:151],v2
v_smfmac_f32_16x16x64_bf16 v[112:115],v[28:31],v[144:151],v2
v_smfmac_f32_16x16x64_bf16 v[108:111],v[28:31],a[152:159],v2
v_smfmac_f32_16x16x64_bf16 v[116:119],v[28:31],v[152:159],v2
s_waitcnt lgkmcnt(10)
v_smfmac_f32_16x16x64_bf16 v[100:103],v[32:35],a[160:167],v2
v_smfmac_f32_16x16x64_bf16 v[112:115],v[32:35],v[160:167],v2
v_smfmac_f32_16x16x64_bf16 v[108:111],v[32:35],a[168:175],v2
v_smfmac_f32_16x16x64_bf16 v[116:119],v[32:35],v[168:175],v2
s_waitcnt lgkmcnt(8)
v_smfmac_f32_16x16x64_bf16 v[100:103],v[36:39],a[176:183],v2
v_smfmac_f32_16x16x64_bf16 v[112:115],v[36:39],v[176:183],v2
v_smfmac_f32_16x16x64_bf16 v[108:111],v[36:39],a[184:191],v2
v_smfmac_f32_16x16x64_bf16 v[116:119],v[36:39],v[184:191],v2
s_waitcnt lgkmcnt(6)
v_smfmac_f32_16x16x64_bf16 v[100:103],v[40:43],a[192:199],v2
v_smfmac_f32_16x16x64_bf16 v[112:115],v[40:43],v[192:199],v2
v_smfmac_f32_16x16x64_bf16 v[108:111],v[40:43],a[200:207],v2
v_smfmac_f32_16x16x64_bf16 v[116:119],v[40:43],v[200:207],v2
s_waitcnt lgkmcnt(4)
v_smfmac_f32_16x16x64_bf16 v[100:103],v[44:47],a[208:215],v2
v_smfmac_f32_16x16x64_bf16 v[112:115],v[44:47],v[208:215],v2
v_smfmac_f32_16x16x64_bf16 v[108:111],v[44:47],a[216:223],v2
v_smfmac_f32_16x16x64_bf16 v[116:119],v[44:47],v[216:223],v2
s_waitcnt lgkmcnt(2)
v_smfmac_f32_16x16x64_bf16 v[100:103],v[48:51],a[224:231],v2
v_smfmac_f32_16x16x64_bf16 v[112:115],v[48:51],v[224:231],v2
v_smfmac_f32_16x16x64_bf16 v[108:111],v[48:51],a[232:239],v2
v_smfmac_f32_16x16x64_bf16 v[116:119],v[48:51],v[232:239],v2
s_waitcnt lgkmcnt(0)
v_smfmac_f32_16x16x64_bf16 v[100:103],v[52:55],a[240:247],v2
v_smfmac_f32_16x16x64_bf16 v[112:115],v[52:55],v[240:247],v2
v_smfmac_f32_16x16x64_bf16 v[108:111],v[52:55],a[248:255],v2
v_smfmac_f32_16x16x64_bf16 v[116:119],v[52:55],v[248:255],v2
v_add_f32 v100,v100,v102
v_add_f32 v112,v112,v114
s_nop 1
v_add_f32 v108,v108,v110
s_nop 2
v_add_f32 v116,v116,v118
v_cvt_pk_bf16_f32 v120,v100,v108
v_cvt_pk_bf16_f32 v121,v112,v116
ds_write_b32 v60,v120
ds_write_b16 v61,v121
ds_write_b16_d16_hi v61,v121 offset:1024
v_mov_b64 v[96:97],0
v_mov_b64 v[98:99],0
v_mov_b64 v[100:101],0
v_mov_b64 v[102:103],0
v_mov_b64 v[104:105],0
v_mov_b64 v[106:107],0
v_mov_b64 v[108:109],0
v_mov_b64 v[110:111],0
v_mov_b64 v[112:113],0
v_mov_b64 v[114:115],0
v_mov_b64 v[116:117],0
v_mov_b64 v[118:119],0
s_waitcnt vmcnt(0) lgkmcnt(0)
s_barrier
v_add_u32 v55,131072,v0
ds_read_b128 v[56:59],v55 offset:0
ds_read_b128 v[60:63],v55 offset:4096
ds_read_b128 v[64:67],v55 offset:1024
ds_read_b128 v[68:71],v55 offset:5120
ds_read_b128 v[72:75],v55 offset:2048
ds_read_b128 v[76:79],v55 offset:6144
ds_read_b128 v[80:83],v55 offset:3072
ds_read_b128 v[84:87],v55 offset:7168
v_add_u32 v123,s73,v55
ds_read_b128 v[88:91],v123 offset:8192
ds_read_b128 v[92:95],v123 offset:9216
v_xor_b32 v120,1024,v12
v_xor_b32 v121,2048,v12
v_xor_b32 v122,3072,v12
buffer_load_dwordx4 v[24:27],v13,s[8:11],s64 offen sc1
buffer_load_dwordx4 v[24:27],v13,s[8:11],s64 offen sc1
L_chain_217:
L_cpa_218:
buffer_load_dwordx4 v[24:27],v13,s[8:11],s64 offen sc1
s_sub_u32 s49,s49,1
s_cbranch_scc1 L_abort
s_waitcnt vmcnt(2)
v_max3_u32 v123,v24,v25,v26
v_max_u32 v123,v27,v123
v_cmp_le_u32 vcc,s72,v123
ds_write_b128 v12,v[24:27] offset:0
s_cbranch_vccnz L_cpa_218
L_cgo_221:
v_smfmac_f32_16x16x64_bf16 v[96:99],v[24:27],a[0:7],v2
buffer_load_dwordx4 v[40:43],v13,s[8:11],s70 offen sc1
v_smfmac_f32_16x16x64_bf16 v[100:103],v[24:27],a[128:135],v2
s_waitcnt lgkmcnt(0)
s_barrier
ds_read_b128 v[28:31],v120 offset:0
v_smfmac_f32_16x16x64_bf16 v[104:107],v[24:27],a[8:15],v2
ds_read_b128 v[32:35],v121 offset:0
v_smfmac_f32_16x16x64_bf16 v[108:111],v[24:27],a[136:143],v2
ds_read_b128 v[36:39],v122 offset:0
v_smfmac_f32_16x16x64_bf16 v[112:115],v[24:27],v[128:135],v2
v_smfmac_f32_16x16x64_bf16 v[116:119],v[24:27],v[136:143],v2
s_waitcnt lgkmcnt(2)
v_smfmac_f32_16x16x64_bf16 v[96:99],v[28:31],a[16:23],v2
s_add_u32 m0,s73,131072
v_smfmac_f32_16x16x64_bf16 v[100:103],v[28:31],a[144:151],v2
s_add_u32 s57,s67,8192
v_smfmac_f32_16x16x64_bf16 v[104:107],v[28:31],a[24:31],v2
s_cmp_lt_u32 s19,s76
s_cbranch_scc1 L_ckw_207
L_ckb_208:
v_smfmac_f32_16x16x64_bf16 v[108:111],v[28:31],a[152:159],v2
s_waitcnt vmcnt(0) lgkmcnt(1)
v_smfmac_f32_16x16x64_bf16 v[96:99],v[32:35],a[32:39],v2
ds_write_b128 v12,v[40:43] offset:4096
v_max3_u32 v123,v40,v41,v42
v_smfmac_f32_16x16x64_bf16 v[100:103],v[32:35],a[160:167],v2
v_max_u32 v123,v43,v123
v_smfmac_f32_16x16x64_bf16 v[104:107],v[32:35],a[40:47],v2
v_cmp_le_u32 vcc,s72,v123
v_smfmac_f32_16x16x64_bf16 v[108:111],v[32:35],a[168:175],v2
v_smfmac_f32_16x16x64_bf16 v[112:115],v[28:31],v[144:151],v2
s_cbranch_vccnz L_cpb_224
L_cback_226:
s_waitcnt lgkmcnt(0)
s_barrier
v_smfmac_f32_16x16x64_bf16 v[96:99],v[36:39],a[48:55],v2
buffer_store_dwordx4 v[124:127],v0,s[8:11],s54 offen sc1
v_smfmac_f32_16x16x64_bf16 v[100:103],v[36:39],a[176:183],v2
ds_read_b128 v[44:47],v120 offset:4096
v_smfmac_f32_16x16x64_bf16 v[104:107],v[36:39],a[56:63],v2
buffer_load_dwordx4 v0,s[8:11],s67 offen sc1 lds
v_smfmac_f32_16x16x64_bf16 v[108:111],v[36:39],a[184:191],v2
ds_read_b128 v[48:51],v121 offset:4096
v_smfmac_f32_16x16x64_bf16 v[96:99],v[40:43],a[64:71],v2
buffer_load_dwordx4 v0,s[8:11],s67 offen offset:1024 sc1 lds
s_add_u32 m0,s73,139264
v_smfmac_f32_16x16x64_bf16 v[100:103],v[40:43],a[192:199],v2
ds_read_b128 v[52:55],v122 offset:4096
v_smfmac_f32_16x16x64_bf16 v[104:107],v[40:43],a[72:79],v2
buffer_load_dwordx4 v0,s[8:11],s57 offen sc1 lds
s_add_u32 s67,s67,786432
v_smfmac_f32_16x16x64_bf16 v[108:111],v[40:43],a[200:207],v2
ds_read_b32 v123,v8 offset:2560
s_waitcnt lgkmcnt(3)
v_smfmac_f32_16x16x64_bf16 v[96:99],v[44:47],a[80:87],v2
buffer_load_dwordx4 v0,s[8:11],s57 offen offset:1024 sc1 lds
v_smfmac_f32_16x16x64_bf16 v[100:103],v[44:47],a[208:215],v2
s_waitcnt lgkmcnt(2)
v_smfmac_f32_16x16x64_bf16 v[96:99],v[48:51],a[96:103],v2
buffer_load_dword v23,v22,s[8:11],s75 offen sc1
v_smfmac_f32_16x16x64_bf16 v[100:103],v[48:51],a[224:231],v2
s_waitcnt lgkmcnt(0)
v_smfmac_f32_16x16x64_bf16 v[96:99],v[52:55],a[112:119],v2
v_smfmac_f32_16x16x64_bf16 v[100:103],v[52:55],a[240:247],v2
v_readfirstlane_b32 s58,v123
v_smfmac_f32_16x16x64_bf16 v[104:107],v[44:47],a[88:95],v2
v_smfmac_f32_16x16x64_bf16 v[108:111],v[44:47],a[216:223],v2
s_cmp_lg_u32 s58,0
s_cbranch_scc1 L_cjump_210
v_smfmac_f32_16x16x64_bf16 v[104:107],v[48:51],a[104:111],v2
v_add_f32 v96,v96,v98
v_smfmac_f32_16x16x64_bf16 v[108:111],v[48:51],a[232:239],v2
v_add_f32 v97,v97,v99
v_smfmac_f32_16x16x64_bf16 v[104:107],v[52:55],a[120:127],v2
v_cvt_pk_bf16_f32 v120,v96,v97
v_smfmac_f32_16x16x64_bf16 v[108:111],v[52:55],a[248:255],v2
v_add_f32 v100,v100,v102
v_smfmac_f32_16x16x64_bf16 v[116:119],v[28:31],v[152:159],v2
v_add_f32 v101,v101,v103
v_smfmac_f32_16x16x64_bf16 v[112:115],v[32:35],v[160:167],v2
v_cvt_pk_bf16_f32 v121,v100,v101
v_add_f32 v104,v104,v106
v_add_f32 v105,v105,v107
v_cvt_pk_bf16_f32 v122,v104,v105
v_add_f32 v108,v108,v110
v_add_f32 v109,v109,v111
v_cvt_pk_bf16_f32 v123,v108,v109
ds_write_b128 v4,v[120:123]
v_smfmac_f32_16x16x64_bf16 v[116:119],v[32:35],v[168:175],v2
s_mov_b32 s54,s68
s_add_u32 s68,s68,131072
v_mov_b32 v125,0
v_smfmac_f32_16x16x64_bf16 v[112:115],v[36:39],v[176:183],v2
s_cmp_eq_u32 s51,63
s_cbranch_scc1 L_cend_220
v_smfmac_f32_16x16x64_bf16 v[116:119],v[36:39],v[184:191],v2
v_smfmac_f32_16x16x64_bf16 v[112:115],v[40:43],v[192:199],v2
s_waitcnt lgkmcnt(0)
s_barrier
ds_read_b64_tr_b16 v[96:97],v5 offset:0
ds_read_b64_tr_b16 v[98:99],v6 offset:0
v_smfmac_f32_16x16x64_bf16 v[116:119],v[40:43],v[200:207],v2
ds_read_b64_tr_b16 v[100:101],v5 offset:1024
v_smfmac_f32_16x16x64_bf16 v[112:115],v[44:47],v[208:215],v2
ds_read_b64_tr_b16 v[102:103],v6 offset:1024
v_smfmac_f32_16x16x64_bf16 v[116:119],v[44:47],v[216:223],v2
ds_read_b64_tr_b16 v[104:105],v5 offset:2048
v_smfmac_f32_16x16x64_bf16 v[112:115],v[48:51],v[224:231],v2
ds_read_b64_tr_b16 v[106:107],v6 offset:2048
s_waitcnt lgkmcnt(4)
v_mfma_f32_16x16x32_bf16 v[24:27],v[56:59],v[96:99],0
ds_read_b64_tr_b16 v[108:109],v5 offset:3072
v_mfma_f32_16x16x32_bf16 v[28:31],v[60:63],v[96:99],0
ds_read_b64_tr_b16 v[110:111],v6 offset:3072
v_mfma_f32_16x16x32_bf16 v[32:35],v[96:99],v[96:99],0
ds_read_b128 v[40:43],v11 offset:12288
s_waitcnt lgkmcnt(5)
v_mfma_f32_16x16x32_bf16 v[24:27],v[64:67],v[100:103],v[24:27]
ds_read_b128 v[56:59],v11 offset:0
v_mfma_f32_16x16x32_bf16 v[28:31],v[68:71],v[100:103],v[28:31]
ds_read_b128 v[60:63],v11 offset:1024
v_mfma_f32_16x16x32_bf16 v[32:35],v[100:103],v[100:103],v[32:35]
ds_read_b128 v[96:99],v11 offset:8192
s_waitcnt lgkmcnt(6)
v_mfma_f32_16x16x32_bf16 v[24:27],v[72:75],v[104:107],v[24:27]
ds_read_b128 v[64:67],v11 offset:2048
v_mfma_f32_16x16x32_bf16 v[28:31],v[76:79],v[104:107],v[28:31]
ds_read_b128 v[68:71],v11 offset:3072
v_mfma_f32_16x16x32_bf16 v[32:35],v[104:107],v[104:107],v[32:35]
ds_read_b128 v[100:103],v11 offset:9216
s_waitcnt lgkmcnt(7)
v_mfma_f32_16x16x32_bf16 v[24:27],v[80:83],v[108:111],v[24:27]
ds_read_b128 v[72:75],v11 offset:4096
v_mfma_f32_16x16x32_bf16 v[28:31],v[84:87],v[108:111],v[28:31]
ds_read_b128 v[76:79],v11 offset:5120
v_mfma_f32_16x16x32_bf16 v[32:35],v[108:111],v[108:111],v[32:35]
ds_read_b128 v[104:107],v11 offset:10240
v_smfmac_f32_16x16x64_bf16 v[116:119],v[48:51],v[232:239],v2
ds_read_b128 v[80:83],v11 offset:6144
v_smfmac_f32_16x16x64_bf16 v[112:115],v[52:55],v[240:247],v2
ds_read_b128 v[84:87],v11 offset:7168
v_smfmac_f32_16x16x64_bf16 v[116:119],v[52:55],v[248:255],v2
ds_read_b128 v[108:111],v11 offset:11264
v_max3_f32 v126,v24,v25,v26
v_max3_f32 v127,v27,v28,v29
v_max3_f32 v126,v30,v31,v126
v_max3_f32 v127,v34,v35,v127
v_max_f32 v126,v126,v127
v_max_f32 v127,v126,v127
v_pk_mul_f32 v[34:35],v[34:35],v[0:1] op_sel:[0,1]
v_pk_mul_f32 v[24:25],v[24:25],v[0:1] op_sel:[0,1]
v_permlane16_swap_b32 v126,v127
v_max_f32 v126,v126,v127
v_max_f32 v127,v126,v127
v_pk_mul_f32 v[26:27],v[26:27],v[0:1] op_sel:[0,1]
v_pk_mul_f32 v[28:29],v[28:29],v[0:1] op_sel:[0,1]
v_permlane32_swap_b32 v126,v127
v_max_f32 v126,v126,v127
v_mul_f32 v126,v1,v126
v_pk_mul_f32 v[30:31],v[30:31],v[0:1] op_sel:[0,1]
v_pk_add_f32 v[34:35],v[34:35],v[126:127] op_sel_hi:[1,0] neg_lo:[0,1] neg_hi:[0,1]
v_pk_add_f32 v[112:113],v[112:113],v[114:115]
v_pk_add_f32 v[116:117],v[116:117],v[118:119]
v_pk_add_f32 v[24:25],v[24:25],v[126:127] op_sel_hi:[1,0] neg_lo:[0,1] neg_hi:[0,1]
v_pk_add_f32 v[26:27],v[26:27],v[126:127] op_sel_hi:[1,0] neg_lo:[0,1] neg_hi:[0,1]
v_pk_add_f32 v[28:29],v[28:29],v[126:127] op_sel_hi:[1,0] neg_lo:[0,1] neg_hi:[0,1]
v_pk_add_f32 v[30:31],v[30:31],v[126:127] op_sel_hi:[1,0] neg_lo:[0,1] neg_hi:[0,1]
v_exp_f32 v34,v34
v_exp_f32 v35,v35
v_cvt_pk_bf16_f32 v126,v112,v113
v_cvt_pk_bf16_f32 v124,v34,v35
v_cvt_pk_bf16_f32 v127,v116,v117
v_cvt_pk_bf16_f32 v36,v116,v117
v_mfma_f32_16x16x16_bf16 v[32:35],v[14:15],v[124:125],0
ds_read_b128 v[44:47],v11 offset:13312
v_exp_f32 v24,v24
v_mfma_f32_16x16x16_bf16 v[112:115],v[126:127],v[124:125],0
ds_read_b128 v[48:51],v11 offset:14336
v_exp_f32 v25,v25
v_mfma_f32_16x16x16_bf16 v[116:119],v[36:37],v[124:125],0
ds_read_b128 v[52:55],v11 offset:15360
v_exp_f32 v26,v26
v_exp_f32 v27,v27
v_cvt_pk_bf16_f32 v120,v24,v25
v_exp_f32 v28,v28
v_exp_f32 v29,v29
v_cvt_pk_bf16_f32 v121,v26,v27
v_exp_f32 v30,v30
v_exp_f32 v31,v31
v_cvt_pk_bf16_f32 v122,v28,v29
v_cvt_pk_bf16_f32 v123,v30,v31
s_add_u32 s75,s75,8192
s_add_u32 s51,s51,1
v_mfma_f32_16x16x32_bf16 v[32:35],v[14:17],v[120:123],v[32:35]
v_mfma_f32_16x16x32_bf16 v[112:115],v[88:91],v[120:123],v[112:115]
ds_read_b128 v[88:91],v11 offset:16384
v_mfma_f32_16x16x32_bf16 v[116:119],v[92:95],v[120:123],v[116:119]
ds_read_b128 v[92:95],v11 offset:17408
v_rcp_f32 v32,v32
v_mov_b64 v[24:25],-1
v_mov_b64 v[26:27],-1
s_add_u32 s64,s75,13631488
s_add_u32 s70,s64,4096
v_pk_mul_f32 v[112:113],v[112:113],v[32:33] op_sel_hi:[1,0]
v_pk_mul_f32 v[114:115],v[114:115],v[32:33] op_sel_hi:[1,0]
v_pk_mul_f32 v[116:117],v[116:117],v[32:33] op_sel_hi:[1,0]
v_pk_mul_f32 v[118:119],v[118:119],v[32:33] op_sel_hi:[1,0]
v_cvt_pk_bf16_f32 v120,v112,v116
v_cvt_pk_bf16_f32 v121,v113,v117
v_cvt_pk_bf16_f32 v122,v114,v118
v_cvt_pk_bf16_f32 v123,v115,v119
ds_write_b128 v7,v[120:123]
buffer_store_dwordx4 v[24:27],v0,s[8:11],s69 offen
buffer_store_dwordx4 v[24:27],v0,s[8:11],s69 offen offset:1024
v_mov_b64 v[112:113],0
v_mov_b64 v[114:115],0
v_mov_b64 v[116:117],0
v_mov_b64 v[118:119],0
s_waitcnt lgkmcnt(0)
s_barrier
ds_read_b128 v[24:27],v8 offset:0
ds_read_b128 v[28:31],v8 offset:512
ds_read_b128 v[32:35],v8 offset:1024
ds_read_b128 v[36:39],v8 offset:1536
v_mov_b64 v[120:121],0
v_mov_b64 v[122:123],0
s_add_u32 s57,s65,65536
s_add_u32 s58,s65,131072
s_add_u32 s59,s65,196608
s_add_u32 s56,s18,s75
s_waitcnt lgkmcnt(3)
v_smfmac_f32_16x16x64_bf16 v[112:115],v[24:27],v[56:63],v3
ds_read_b128 v[56:59],v11 offset:18432
s_waitcnt lgkmcnt(3)
v_smfmac_f32_16x16x64_bf16 v[112:115],v[28:31],v[64:71],v3
ds_read_b128 v[60:63],v11 offset:19456
s_waitcnt lgkmcnt(3)
v_smfmac_f32_16x16x64_bf16 v[112:115],v[32:35],v[72:79],v3
ds_read_b128 v[64:67],v11 offset:20480
s_waitcnt lgkmcnt(3)
v_smfmac_f32_16x16x64_bf16 v[112:115],v[36:39],v[80:87],v3
ds_read_b128 v[68:71],v11 offset:21504
v_smfmac_f32_16x16x64_bf16 v[116:119],v[24:27],v[96:103],v3
ds_read_b128 v[72:75],v11 offset:22528
v_smfmac_f32_16x16x64_bf16 v[116:119],v[28:31],v[104:111],v3
ds_read_b128 v[76:79],v11 offset:23552
v_cvt_pk_bf16_f32 v112,v112,v113
v_smfmac_f32_16x16x64_bf16 v[116:119],v[32:35],v[40:47],v3
ds_read_b128 v[80:83],v11 offset:24576
v_cvt_pk_bf16_f32 v113,v114,v115
buffer_store_dwordx2 v[112:113],v9,s[8:11],s65 offen
v_smfmac_f32_16x16x64_bf16 v[116:119],v[36:39],v[48:55],v3
ds_read_b128 v[84:87],v11 offset:25600
v_mov_b64 v[112:113],0
v_smfmac_f32_16x16x64_bf16 v[120:123],v[24:27],v[88:95],v3
ds_read_b128 v[96:99],v11 offset:26624
ds_read_b128 v[100:103],v11 offset:27648
v_mov_b64 v[114:115],0
s_waitcnt lgkmcnt(8)
v_smfmac_f32_16x16x64_bf16 v[120:123],v[28:31],v[56:63],v3
ds_read_b128 v[104:107],v11 offset:28672
v_cvt_pk_bf16_f32 v116,v116,v117
s_waitcnt lgkmcnt(7)
v_smfmac_f32_16x16x64_bf16 v[120:123],v[32:35],v[64:71],v3
ds_read_b128 v[108:111],v11 offset:29696
ds_read_b128 v[40:43],v11 offset:30720
v_cvt_pk_bf16_f32 v117,v118,v119
buffer_store_dwordx2 v[116:117],v9,s[8:11],s57 offen
s_waitcnt lgkmcnt(7)
v_smfmac_f32_16x16x64_bf16 v[120:123],v[36:39],v[72:79],v3
ds_read_b128 v[44:47],v11 offset:31744
v_add_u32 v52,s50,v5
s_waitcnt lgkmcnt(6)
v_smfmac_f32_16x16x64_bf16 v[112:115],v[24:27],v[80:87],v3
v_add_u32 v54,s50,v6
s_waitcnt lgkmcnt(4)
v_smfmac_f32_16x16x64_bf16 v[112:115],v[28:31],v[96:103],v3
ds_read_b64_tr_b16 v[52:53],v52
v_cvt_pk_bf16_f32 v120,v120,v121
s_waitcnt lgkmcnt(3)
v_smfmac_f32_16x16x64_bf16 v[112:115],v[32:35],v[104:111],v3
ds_read_b64_tr_b16 v[54:55],v54
v_cvt_pk_bf16_f32 v121,v122,v123
buffer_store_dwordx2 v[120:121],v9,s[8:11],s58 offen
s_waitcnt lgkmcnt(2)
v_smfmac_f32_16x16x64_bf16 v[112:115],v[36:39],v[40:47],v3
v_mov_b64 v[116:117],0
v_mov_b64 v[118:119],0
s_xor_b32 s65,s65,262144
v_mov_b32_dpp v124,v126 quad_perm:[2,3,2,3] row_mask:0xf bank_mask:0xf
v_mov_b32_dpp v125,v127 quad_perm:[2,3,2,3] row_mask:0xf bank_mask:0xf
s_mov_b32 vcc_lo,0xcccccccc
s_mov_b32 vcc_hi,0xcccccccc
s_nop 0
v_cvt_pk_bf16_f32 v112,v112,v113
v_cvt_pk_bf16_f32 v113,v114,v115
buffer_store_dwordx2 v[112:113],v9,s[8:11],s59 offen
s_waitcnt lgkmcnt(0)
s_buffer_load_dword s19,s[8:11],s56
v_cndmask_b32 v124,v124,v52,vcc
v_cndmask_b32 v125,v125,v53,vcc
v_cndmask_b32 v126,v126,v54,vcc
v_cndmask_b32 v127,v127,v55,vcc
s_cmp_lt_u32 s46,2
s_waitcnt vmcnt(3)
s_cbranch_scc1 L_crg_227
s_cmp_eq_u32 s46,2
s_waitcnt vmcnt(1)
s_cbranch_scc1 L_crg_227
s_waitcnt vmcnt(0)
L_crg_227:
buffer_load_dwordx4 v[32:35],v0,s[8:11],s66 offen offset:0 sc1
buffer_load_dwordx4 v[36:39],v0,s[8:11],s66 offen offset:1024 sc1
v_mov_b64 v[96:97],0
v_mov_b64 v[98:99],0
v_mov_b64 v[100:101],0
v_mov_b64 v[102:103],0
v_mov_b64 v[104:105],0
v_mov_b64 v[106:107],0
v_mov_b64 v[108:109],0
v_mov_b64 v[110:111],0
v_mov_b64 v[112:113],0
v_mov_b64 v[114:115],0
v_add_u32 v55,131072,v0
v_add_u32 v123,s73,v55
v_xor_b32 v120,1024,v12
v_xor_b32 v121,2048,v12
v_xor_b32 v122,3072,v12
buffer_load_dwordx4 v[44:47],v0,s[8:11],s66 offen offset:0 sc1
buffer_load_dwordx4 v[48:51],v0,s[8:11],s66 offen offset:1024 sc1
s_cmp_ge_u32 s51,63
s_cselect_b32 s76,0,1
v_readlane_b32 s56,v23,5
v_readlane_b32 s20,v23,4
v_add_u32 v23,-1,v23
v_cmp_le_u32 vcc,s30,v23
s_cmp_gt_u32 s51,61
s_cselect_b32 s77,0,vcc_hi
s_cmp_gt_u32 s20,s30
s_cselect_b32 s77,1,s77
s_cmp_lg_u32 s77,0
s_cselect_b32 s76,2,s76
s_cmp_gt_u32 s56,s30
s_cbranch_scc1 L_cld_203
L_clb_204:
s_cmp_eq_u32 s46,0
s_cselect_b32 s76,s76,0
s_waitcnt vmcnt(3)
v_mfma_f32_16x16x32_bf16 v[28:31],v[18:21],v[32:35],0
s_waitcnt vmcnt(2)
v_mfma_f32_16x16x32_bf16 v[28:31],v[18:21],v[36:39],v[28:31]
s_nop 7
v_cmp_u_f32 vcc,v28,v28
v_add_f32_dpp v52,v28,v28 row_ror:8 row_mask:0xf bank_mask:0x3
v_add_f32_dpp v53,v29,v29 row_ror:8 row_mask:0xf bank_mask:0x3
v_add_f32_dpp v52,v30,v30 row_ror:8 row_mask:0xf bank_mask:0xc
v_add_f32_dpp v53,v31,v31 row_ror:8 row_mask:0xf bank_mask:0xc
s_nop 0
v_add_f32_dpp v52,v52,v52 row_shl:4 row_mask:0xf bank_mask:0x5
v_add_f32_dpp v53,v53,v53 row_shl:4 row_mask:0xf bank_mask:0x5
s_cbranch_vccnz L_crp_222
L_cok_228:
v_cvt_pk_bf16_f32 v54,v52,v53
buffer_store_dword v54,v10,s[8:11],s64 offen
s_mov_b32 s69,s66
s_xor_b32 s66,s66,262144
s_barrier
ds_read_b128 v[56:59],v55 offset:0
ds_read_b128 v[60:63],v55 offset:4096
ds_read_b128 v[64:67],v55 offset:1024
buffer_load_dwordx4 v[24:27],v13,s[8:11],s64 offen sc1
ds_read_b128 v[68:71],v55 offset:5120
ds_read_b128 v[72:75],v55 offset:2048
ds_read_b128 v[76:79],v55 offset:6144
ds_read_b128 v[80:83],v55 offset:3072
buffer_load_dwordx4 v[24:27],v13,s[8:11],s64 offen sc1
ds_read_b128 v[84:87],v55 offset:7168
ds_read_b128 v[88:91],v123 offset:8192
ds_read_b128 v[92:95],v123 offset:9216
s_branch L_chain_217
L_cpb_224:
buffer_load_dwordx4 v[40:43],v13,s[8:11],s70 offen sc1
s_sub_u32 s49,s49,1
s_cbranch_scc1 L_abort
s_waitcnt vmcnt(0)
v_max3_u32 v123,v40,v41,v42
v_max_u32 v123,v43,v123
v_cmp_le_u32 vcc,s72,v123
s_cbranch_vccnz L_cpb_224
ds_write_b128 v12,v[40:43] offset:4096
s_branch L_cback_226
L_crp_222:
buffer_load_dwordx4 v[32:35],v0,s[8:11],s66 offen offset:0 sc1
buffer_load_dwordx4 v[36:39],v0,s[8:11],s66 offen offset:1024 sc1
s_sub_u32 s49,s49,1
s_cbranch_scc1 L_abort
s_waitcnt vmcnt(3)
v_mfma_f32_16x16x32_bf16 v[28:31],v[18:21],v[44:47],0
s_waitcnt vmcnt(2)
v_mfma_f32_16x16x32_bf16 v[28:31],v[18:21],v[48:51],v[28:31]
s_nop 7
v_cmp_u_f32 vcc,v28,v28
v_add_f32_dpp v52,v28,v28 row_ror:8 row_mask:0xf bank_mask:0x3
v_add_f32_dpp v53,v29,v29 row_ror:8 row_mask:0xf bank_mask:0x3
v_add_f32_dpp v52,v30,v30 row_ror:8 row_mask:0xf bank_mask:0xc
v_add_f32_dpp v53,v31,v31 row_ror:8 row_mask:0xf bank_mask:0xc
s_nop 0
v_add_f32_dpp v52,v52,v52 row_shl:4 row_mask:0xf bank_mask:0x5
v_add_f32_dpp v53,v53,v53 row_shl:4 row_mask:0xf bank_mask:0x5
s_cbranch_vccz L_cok_228
buffer_load_dwordx4 v[44:47],v0,s[8:11],s66 offen offset:0 sc1
buffer_load_dwordx4 v[48:51],v0,s[8:11],s66 offen offset:1024 sc1
s_sub_u32 s49,s49,1
s_cbranch_scc1 L_abort
s_waitcnt vmcnt(3)
v_mfma_f32_16x16x32_bf16 v[28:31],v[18:21],v[32:35],0
s_waitcnt vmcnt(2)
v_mfma_f32_16x16x32_bf16 v[28:31],v[18:21],v[36:39],v[28:31]
s_nop 7
v_cmp_u_f32 vcc,v28,v28
v_add_f32_dpp v52,v28,v28 row_ror:8 row_mask:0xf bank_mask:0x3
v_add_f32_dpp v53,v29,v29 row_ror:8 row_mask:0xf bank_mask:0x3
v_add_f32_dpp v52,v30,v30 row_ror:8 row_mask:0xf bank_mask:0xc
v_add_f32_dpp v53,v31,v31 row_ror:8 row_mask:0xf bank_mask:0xc
s_nop 0
v_add_f32_dpp v52,v52,v52 row_shl:4 row_mask:0xf bank_mask:0x5
v_add_f32_dpp v53,v53,v53 row_shl:4 row_mask:0xf bank_mask:0x5
s_cbranch_vccz L_cok_228
s_branch L_crp_222
L_ckw_207:
s_cmp_eq_u32 s77,0
s_cbranch_scc1 L_cjw_209
s_cmp_gt_u32 s20,s30
s_cbranch_scc1 L_cjs_205
s_add_u32 s31,s51,2
s_lshl_b32 s59,s31,13
s_add_u32 s59,s59,10486016
v_lshrrev_b32 v45,2,v0
v_and_b32 v45,127,v45
L_ckk_229:
s_sleep 1
buffer_load_dword v44,v45,s[8:11],s59 offen sc1
s_sub_u32 s49,s49,1
s_cbranch_scc1 L_abort
s_waitcnt vmcnt(0)
v_cmp_eq_u32 vcc,0,v44
s_cbranch_vccnz L_ckk_229
v_cmp_lt_u32 vcc,s30,v44
s_cbranch_vccz L_cjw_209
v_max_u32_dpp v44,v44,v44 row_ror:8 row_mask:0xf bank_mask:0xf
s_nop 1
v_max_u32_dpp v44,v44,v44 row_ror:4 row_mask:0xf bank_mask:0xf
s_nop 1
v_max_u32_dpp v44,v44,v44 row_ror:2 row_mask:0xf bank_mask:0xf
s_nop 1
v_max_u32_dpp v44,v44,v44 row_ror:1 row_mask:0xf bank_mask:0xf
v_mov_b32 v45,v44
s_nop 1
v_permlane16_swap_b32 v44,v45
v_max_u32 v44,v44,v45
v_mov_b32 v45,v44
s_nop 1
v_permlane32_swap_b32 v44,v45
v_max_u32 v44,v44,v45
s_nop 0
v_readfirstlane_b32 s20,v44
L_cjs_205:
s_mov_b32 s30,s20
s_andn2_b32 s31,0x7ff,s20
s_lshr_b32 s31,s31,5
s_add_u32 s31,s31,1
s_min_u32 s31,s31,63
ds_write_b32 v8,v2 offset:2560
s_waitcnt lgkmcnt(0)
s_branch L_ckb_208
L_cld_203:
v_mov_b32 v23,s56
s_add_u32 s56,s75,10495616
buffer_store_dword v23,off,s[8:11],s56
s_waitcnt vmcnt(0)
s_branch L_clb_204
L_cjw_209:
s_cmp_lg_u32 s19,0
s_cbranch_scc1 L_ckb_208
s_add_u32 s59,s18,s75
L_ww_230:
s_sleep 1
buffer_load_dword v23,off,s[8:11],s59 sc1
s_sub_u32 s49,s49,1
s_cbranch_scc1 L_abort
s_waitcnt vmcnt(0)
v_readfirstlane_b32 s76,v23
s_cmp_eq_u32 s76,0
s_cbranch_scc1 L_ww_230
L_wwd_231:
s_branch L_ckb_208
L_cjump_210:
s_waitcnt vmcnt(0) lgkmcnt(0)
s_barrier
s_branch L_cst_206
L_cend_220:
v_smfmac_f32_16x16x64_bf16 v[116:119],v[36:39],v[184:191],v2
v_smfmac_f32_16x16x64_bf16 v[112:115],v[40:43],v[192:199],v2
v_smfmac_f32_16x16x64_bf16 v[116:119],v[40:43],v[200:207],v2
v_smfmac_f32_16x16x64_bf16 v[112:115],v[44:47],v[208:215],v2
v_smfmac_f32_16x16x64_bf16 v[116:119],v[44:47],v[216:223],v2
v_smfmac_f32_16x16x64_bf16 v[112:115],v[48:51],v[224:231],v2
v_smfmac_f32_16x16x64_bf16 v[116:119],v[48:51],v[232:239],v2
v_smfmac_f32_16x16x64_bf16 v[112:115],v[52:55],v[240:247],v2
v_smfmac_f32_16x16x64_bf16 v[116:119],v[52:55],v[248:255],v2
s_waitcnt lgkmcnt(0)
s_nop 2
v_pk_add_f32 v[112:113],v[112:113],v[114:115]
s_nop 2
v_pk_add_f32 v[116:117],v[116:117],v[118:119]
v_cvt_pk_bf16_f32 v126,v112,v113
v_cvt_pk_bf16_f32 v127,v116,v117
v_add_u32 v52,s50,v5
v_add_u32 v54,s50,v6
ds_read_b64_tr_b16 v[52:53],v52
ds_read_b64_tr_b16 v[54:55],v54
v_mov_b32_dpp v124,v126 quad_perm:[2,3,2,3] row_mask:0xf bank_mask:0xf
v_mov_b32_dpp v125,v127 quad_perm:[2,3,2,3] row_mask:0xf bank_mask:0xf
s_mov_b32 vcc_lo,0xcccccccc
s_mov_b32 vcc_hi,0xcccccccc
s_waitcnt lgkmcnt(0)
v_cndmask_b32 v124,v124,v52,vcc
v_cndmask_b32 v125,v125,v53,vcc
v_cndmask_b32 v126,v126,v54,vcc
v_cndmask_b32 v127,v127,v55,vcc
buffer_store_dwordx4 v[124:127],v0,s[8:11],s54 offen sc1
s_mov_b32 s51,64
s_waitcnt vmcnt(0)
s_barrier
s_nop 11
v_lshrrev_b32 v1,4,v0
s_endpgm
L_abort2:
s_endpgm
L_wc:
s_nop 11
s_cmp_eq_u32 s48,1
s_cbranch_scc1 L_rc1_232
s_cmp_eq_u32 s48,2
s_cbranch_scc1 L_rc2_233
v_and_b32 v120,15,v1
v_lshrrev_b32 v121,4,v1
v_and_b32 v122,2,v1
v_cmp_eq_u32 vcc,0,v122
v_mov_b32 v2,0xeeee
v_mov_b32 v123,0x4444
v_cndmask_b32 v2,v2,v123,vcc
v_and_b32 v122,1,v1
v_cmp_eq_u32 vcc,0,v122
v_mov_b32 v3,0xdddd
v_mov_b32 v123,0x8888
v_cndmask_b32 v3,v3,v123,vcc
v_lshrrev_b32 v122,1,v120
v_bfe_u32 v123,v120,2,1
v_xor_b32 v123,v123,v122
v_lshlrev_b32 v4,7,v123
v_and_b32 v123,1,v120
v_lshl_add_u32 v4,v123,6,v4
v_xor_b32 v123,v121,v122
v_and_b32 v123,3,v123
v_lshl_add_u32 v4,v123,4,v4
s_lshl_b32 s56,s46,10
s_add_u32 s56,s56,147456
v_add_u32 v4,s56,v4
v_lshlrev_b32 v122,1,v121
v_add_u32 v122,0,v122
v_and_b32 v123,1,v121
v_xor_b32 v123,v123,v122
v_lshlrev_b32 v5,7,v123
v_bfe_u32 v123,v120,3,1
v_lshl_add_u32 v5,v123,6,v5
v_xor_b32 v123,v120,v122
v_and_b32 v123,3,v123
v_lshl_add_u32 v5,v123,4,v5
v_bfe_u32 v123,v120,2,1
v_lshl_add_u32 v5,v123,3,v5
v_add_u32 v5,147456,v5
v_lshlrev_b32 v122,1,v121
v_add_u32 v122,1,v122
v_and_b32 v123,1,v121
v_xor_b32 v123,v123,v122
v_lshlrev_b32 v6,7,v123
v_bfe_u32 v123,v120,3,1
v_lshl_add_u32 v6,v123,6,v6
v_xor_b32 v123,v120,v122
v_and_b32 v123,3,v123
v_lshl_add_u32 v6,v123,4,v6
v_bfe_u32 v123,v120,2,1
v_lshl_add_u32 v6,v123,3,v6
v_add_u32 v6,147456,v6
v_lshlrev_b32 v7,7,v121
v_lshrrev_b32 v122,1,v120
v_lshl_add_u32 v8,v122,4,v7
v_add_u32 v8,151552,v8
v_lshrrev_b32 v122,2,v120
v_lshl_add_u32 v7,v122,5,v7
v_and_b32 v122,1,v120
v_lshl_add_u32 v7,v122,4,v7
v_and_b32 v122,2,v120
v_cmp_eq_u32 vcc,0,v122
s_lshl_b32 s56,s46,9
v_mov_b32 v122,2048
v_mov_b32 v123,s56
v_cndmask_b32 v122,v122,v123,vcc
v_add_u32 v7,v122,v7
v_add_u32 v7,151552,v7
v_lshrrev_b32 v122,3,v1
v_lshlrev_b32 v9,11,v122
v_and_b32 v122,7,v1
v_lshl_add_u32 v9,v122,3,v9
s_lshl_b32 s56,s46,14
s_lshl_b32 s57,s47,6
s_add_u32 s56,s56,s57
v_add_u32 v9,s56,v9
s_lshl_b32 s71,s46,5
s_add_u32 s71,s71,s47
s_bfe_u32 s56,s71,0x10003
s_lshl_b32 s56,s56,11
s_and_b32 s57,s71,1
s_lshl_b32 s57,s57,10
s_add_u32 s56,s56,s57
s_bfe_u32 s57,s71,0x10002
s_lshl_b32 s57,s57,9
s_add_u32 s56,s56,s57
s_bfe_u32 s57,s71,0x10001
s_lshl_b32 s57,s57,6
s_add_u32 s56,s56,s57
s_bfe_u32 s57,s71,0x10004
s_lshl_b32 s57,s57,8
s_add_u32 s56,s56,s57
s_bfe_u32 s57,s71,0x10005
s_lshl_b32 s57,s57,7
s_add_u32 s56,s56,s57
s_bfe_u32 s57,s71,0x10006
s_lshl_b32 s57,s57,12
s_add_u32 s56,s56,s57
v_and_b32 v122,3,v120
v_lshlrev_b32 v10,2,v122
v_bfe_u32 v122,v120,3,1
v_lshl_add_u32 v10,v122,4,v10
v_and_b32 v122,1,v121
v_lshl_add_u32 v10,v122,5,v10
v_add_u32 v10,s56,v10
v_and_b32 v123,36,v1
v_mov_b32 v122,0x80000000
v_cmp_eq_u32 vcc,0,v123
s_nop 1
v_cndmask_b32 v10,v122,v10,vcc
s_lshl_b32 s71,s71,11
s_lshl_b32 s73,s46,11
s_mov_b32 s72,0xffc00000
s_mov_b32 s74,0
v_and_b32 v11,1,v121
v_xor_b32 v11,v11,v120
v_and_b32 v11,3,v11
v_lshrrev_b32 v122,2,v120
v_lshl_add_u32 v11,v11,2,v122
v_lshl_add_u32 v11,v121,4,v11
v_lshlrev_b32 v11,4,v11
s_lshl_b32 s56,s46,15
v_add_u32 v11,s56,v11
v_lshrrev_b32 v13,3,v1
v_lshlrev_b32 v13,9,v13
v_and_b32 v122,7,v1
v_lshl_add_u32 v13,v122,4,v13
v_and_b32 v122,15,v1
v_and_b32 v123,1,v1
v_lshlrev_b32 v123,4,v123
v_mov_b32 v124,0x3f80
v_lshlrev_b32 v124,v123,v124
v_lshrrev_b32 v122,1,v122
v_cmp_eq_u32 vcc,0,v122
s_nop 1
v_cndmask_b32 v18,0,v124,vcc
v_cmp_eq_u32 vcc,1,v122
s_nop 1
v_cndmask_b32 v19,0,v124,vcc
v_cmp_eq_u32 vcc,2,v122
s_nop 1
v_cndmask_b32 v20,0,v124,vcc
v_cmp_eq_u32 vcc,3,v122
s_nop 1
v_cndmask_b32 v21,0,v124,vcc
s_and_b32 s56,s46,1
s_lshl_b32 s56,s56,8
s_and_b32 s57,s46,2
s_lshl_b32 s57,s57,6
s_add_u32 s56,s56,s57
v_add_u32 v13,s56,v13
s_add_u32 s56,s50,155648
v_add_u32 v12,s56,v0
v_mov_b64 v[14:15],s[28:29]
v_mov_b64 v[16:17],s[28:29]
v_add_u32 v22,11550720,v10
s_lshl_b32 s18,s47,2
s_add_u32 s18,s18,10493952
v_mov_b32 v1,s80
s_mov_b32 s65,14680064
s_add_u32 s66,s71,14680064
s_add_u32 s69,s71,14942208
s_mov_b32 s30,0x40000000
s_mov_b32 s51,0
L_cst_237:
s_cmp_lg_u32 s46,0
s_cbranch_scc1 L_csw_242
s_lshl_b32 s59,s51,13
s_lshl2_add_u32 s59,s47,s59
s_add_u32 s59,s59,10485760
s_buffer_load_dword s61,s[8:11],s59
s_waitcnt lgkmcnt(0)
s_cmp_lg_u32 s61,0
s_cbranch_scc1 L_wwd_244
L_ww_243:
s_sleep 1
buffer_load_dword v122,off,s[8:11],s59 sc1
s_sub_u32 s49,s49,1
s_cbranch_scc1 L_abort2
s_waitcnt vmcnt(0)
v_readfirstlane_b32 s61,v122
s_cmp_eq_u32 s61,0
s_cbranch_scc1 L_ww_243
L_wwd_244:
L_csw_242:
s_waitcnt lgkmcnt(0)
s_barrier
s_lshl_b32 s56,s51,5
s_add_u32 s56,s56,s47
s_mul_i32 s56,s56,24576
s_add_u32 s56,s56,100663296
s_add_u32 s67,s56,s73
s_add_u32 m0,s73,131072
s_add_u32 s57,s67,8192
buffer_load_dwordx4 v0,s[8:11],s67 offen sc1 lds
buffer_load_dwordx4 v0,s[8:11],s67 offen offset:1024 sc1 lds
s_add_u32 m0,s73,139264
s_add_u32 s67,s67,786432
buffer_load_dwordx4 v0,s[8:11],s57 offen sc1 lds
buffer_load_dwordx4 v0,s[8:11],s57 offen offset:1024 sc1 lds
s_lshl_b32 s75,s51,13
s_add_u32 s56,s75,11542528
buffer_load_dword v23,v10,s[8:11],s56 offen sc1
s_add_u32 s64,s75,11534336
s_add_u32 s70,s64,4096
s_lshl_b32 s68,s51,5
s_add_u32 s68,s68,s47
s_lshl_b32 s68,s68,12
s_lshl_b32 s56,s46,10
s_add_u32 s68,s68,s56
s_add_u32 s68,s68,41943040
s_mov_b32 s54,0x80000000
s_mov_b32 s77,0
s_add_u32 s56,s18,s75
s_buffer_load_dword s19,s[8:11],s56
s_cmp_eq_u32 s51,63
s_cselect_b32 s76,1,s46
s_cmp_eq_u32 s76,0
s_cselect_b32 s76,1,0
v_mov_b64 v[96:97],0
v_mov_b64 v[98:99],0
v_mov_b64 v[100:101],0
v_mov_b64 v[102:103],0
v_mov_b64 v[104:105],0
v_mov_b64 v[106:107],0
v_mov_b64 v[108:109],0
v_mov_b64 v[110:111],0
v_mov_b64 v[112:113],0
v_mov_b64 v[114:115],0
v_mov_b64 v[116:117],0
v_mov_b64 v[118:119],0
buffer_load_dwordx4 v[88:91],v13,s[8:11],s64 offen
buffer_load_dwordx4 v[88:91],v13,s[8:11],s70 offen
s_waitcnt vmcnt(19)
v_swap_b32 v25,v28
v_swap_b32 v26,v32
v_swap_b32 v27,v36
v_swap_b32 v30,v33
v_swap_b32 v31,v37
v_swap_b32 v35,v38
ds_write_b128 v93,v[24:27] offset:4096
ds_write_b128 v94,v[28:31] offset:4096
ds_write_b128 v93,v[32:35] offset:4224
ds_write_b128 v94,v[36:39] offset:4224
s_waitcnt vmcnt(15)
v_swap_b32 v41,v44
v_swap_b32 v42,v48
v_swap_b32 v43,v52
v_swap_b32 v46,v49
v_swap_b32 v47,v53
v_swap_b32 v51,v54
ds_write_b128 v93,v[40:43] offset:5120
ds_write_b128 v94,v[44:47] offset:5120
ds_write_b128 v93,v[48:51] offset:5248
ds_write_b128 v94,v[52:55] offset:5248
s_waitcnt vmcnt(11)
v_swap_b32 v57,v60
v_swap_b32 v58,v64
v_swap_b32 v59,v68
v_swap_b32 v62,v65
v_swap_b32 v63,v69
v_swap_b32 v67,v70
ds_write_b128 v93,v[56:59] offset:6144
ds_write_b128 v94,v[60:63] offset:6144
ds_write_b128 v93,v[64:67] offset:6272
ds_write_b128 v94,v[68:71] offset:6272
s_waitcnt vmcnt(7)
v_swap_b32 v73,v76
v_swap_b32 v74,v80
v_swap_b32 v75,v84
v_swap_b32 v78,v81
v_swap_b32 v79,v85
v_swap_b32 v83,v86
ds_write_b128 v93,v[72:75] offset:7168
ds_write_b128 v94,v[76:79] offset:7168
ds_write_b128 v93,v[80:83] offset:7296
ds_write_b128 v94,v[84:87] offset:7296
s_waitcnt vmcnt(0) lgkmcnt(0)
s_barrier
v_add_u32 v55,131072,v0
ds_read_b128 v[56:59],v55 offset:0
ds_read_b128 v[60:63],v55 offset:4096
ds_read_b128 v[64:67],v55 offset:1024
ds_read_b128 v[68:71],v55 offset:5120
ds_read_b128 v[72:75],v55 offset:2048
ds_read_b128 v[76:79],v55 offset:6144
ds_read_b128 v[80:83],v55 offset:3072
ds_read_b128 v[84:87],v55 offset:7168
v_add_u32 v123,s73,v55
ds_read_b128 v[88:91],v123 offset:8192
ds_read_b128 v[92:95],v123 offset:9216
v_xor_b32 v120,1024,v12
v_xor_b32 v121,2048,v12
v_xor_b32 v122,3072,v12
buffer_load_dwordx4 v[24:27],v13,s[8:11],s64 offen sc1
buffer_load_dwordx4 v[24:27],v13,s[8:11],s64 offen sc1
L_chain_245:
L_cpa_246:
buffer_load_dwordx4 v[24:27],v13,s[8:11],s64 offen sc1
s_sub_u32 s49,s49,1
s_cbranch_scc1 L_abort2
s_waitcnt vmcnt(2)
v_max3_u32 v123,v24,v25,v26
v_max_u32 v123,v27,v123
v_cmp_le_u32 vcc,s72,v123
ds_write_b128 v12,v[24:27] offset:0
s_cbranch_vccnz L_cpa_246
L_cgo_249:
v_smfmac_f32_16x16x64_bf16 v[96:99],v[24:27],a[0:7],v2
buffer_load_dwordx4 v[40:43],v13,s[8:11],s70 offen sc1
v_smfmac_f32_16x16x64_bf16 v[100:103],v[24:27],a[128:135],v2
s_waitcnt lgkmcnt(0)
s_barrier
ds_read_b128 v[28:31],v120 offset:0
v_smfmac_f32_16x16x64_bf16 v[104:107],v[24:27],a[8:15],v2
ds_read_b128 v[32:35],v121 offset:0
v_smfmac_f32_16x16x64_bf16 v[108:111],v[24:27],a[136:143],v2
ds_read_b128 v[36:39],v122 offset:0
v_smfmac_f32_16x16x64_bf16 v[112:115],v[24:27],v[128:135],v2
v_smfmac_f32_16x16x64_bf16 v[116:119],v[24:27],v[136:143],v2
s_waitcnt lgkmcnt(2)
v_smfmac_f32_16x16x64_bf16 v[96:99],v[28:31],a[16:23],v2
s_add_u32 m0,s73,131072
v_smfmac_f32_16x16x64_bf16 v[100:103],v[28:31],a[144:151],v2
s_add_u32 s57,s67,8192
v_smfmac_f32_16x16x64_bf16 v[104:107],v[28:31],a[24:31],v2
s_cmp_lt_u32 s19,s76
s_cbranch_scc1 L_ckw_238
L_ckb_239:
v_smfmac_f32_16x16x64_bf16 v[108:111],v[28:31],a[152:159],v2
s_waitcnt vmcnt(0) lgkmcnt(1)
v_smfmac_f32_16x16x64_bf16 v[96:99],v[32:35],a[32:39],v2
ds_write_b128 v12,v[40:43] offset:4096
v_max3_u32 v123,v40,v41,v42
v_smfmac_f32_16x16x64_bf16 v[100:103],v[32:35],a[160:167],v2
v_max_u32 v123,v43,v123
v_smfmac_f32_16x16x64_bf16 v[104:107],v[32:35],a[40:47],v2
v_cmp_le_u32 vcc,s72,v123
v_smfmac_f32_16x16x64_bf16 v[108:111],v[32:35],a[168:175],v2
v_smfmac_f32_16x16x64_bf16 v[112:115],v[28:31],v[144:151],v2
s_cbranch_vccnz L_cpb_252
L_cback_254:
s_waitcnt lgkmcnt(0)
s_barrier
v_smfmac_f32_16x16x64_bf16 v[96:99],v[36:39],a[48:55],v2
buffer_store_dwordx4 v[124:127],v0,s[8:11],s54 offen sc1
v_smfmac_f32_16x16x64_bf16 v[100:103],v[36:39],a[176:183],v2
ds_read_b128 v[44:47],v120 offset:4096
v_smfmac_f32_16x16x64_bf16 v[104:107],v[36:39],a[56:63],v2
buffer_load_dwordx4 v0,s[8:11],s67 offen sc1 lds
v_smfmac_f32_16x16x64_bf16 v[108:111],v[36:39],a[184:191],v2
ds_read_b128 v[48:51],v121 offset:4096
v_smfmac_f32_16x16x64_bf16 v[96:99],v[40:43],a[64:71],v2
buffer_load_dwordx4 v0,s[8:11],s67 offen offset:1024 sc1 lds
s_add_u32 m0,s73,139264
v_smfmac_f32_16x16x64_bf16 v[100:103],v[40:43],a[192:199],v2
ds_read_b128 v[52:55],v122 offset:4096
v_smfmac_f32_16x16x64_bf16 v[104:107],v[40:43],a[72:79],v2
buffer_load_dwordx4 v0,s[8:11],s57 offen sc1 lds
s_add_u32 s67,s67,786432
v_smfmac_f32_16x16x64_bf16 v[108:111],v[40:43],a[200:207],v2
s_waitcnt lgkmcnt(2)
v_smfmac_f32_16x16x64_bf16 v[96:99],v[44:47],a[80:87],v2
buffer_load_dwordx4 v0,s[8:11],s57 offen offset:1024 sc1 lds
v_smfmac_f32_16x16x64_bf16 v[100:103],v[44:47],a[208:215],v2
s_waitcnt lgkmcnt(1)
v_smfmac_f32_16x16x64_bf16 v[96:99],v[48:51],a[96:103],v2
buffer_load_dword v23,v22,s[8:11],s75 offen sc1
v_smfmac_f32_16x16x64_bf16 v[100:103],v[48:51],a[224:231],v2
s_waitcnt lgkmcnt(0)
v_smfmac_f32_16x16x64_bf16 v[96:99],v[52:55],a[112:119],v2
v_smfmac_f32_16x16x64_bf16 v[100:103],v[52:55],a[240:247],v2
v_smfmac_f32_16x16x64_bf16 v[104:107],v[44:47],a[88:95],v2
v_smfmac_f32_16x16x64_bf16 v[108:111],v[44:47],a[216:223],v2
v_smfmac_f32_16x16x64_bf16 v[104:107],v[48:51],a[104:111],v2
v_add_f32 v96,v96,v98
v_smfmac_f32_16x16x64_bf16 v[108:111],v[48:51],a[232:239],v2
v_add_f32 v97,v97,v99
v_smfmac_f32_16x16x64_bf16 v[104:107],v[52:55],a[120:127],v2
v_cvt_pk_bf16_f32 v120,v96,v97
v_smfmac_f32_16x16x64_bf16 v[108:111],v[52:55],a[248:255],v2
v_add_f32 v100,v100,v102
v_smfmac_f32_16x16x64_bf16 v[116:119],v[28:31],v[152:159],v2
v_add_f32 v101,v101,v103
v_smfmac_f32_16x16x64_bf16 v[112:115],v[32:35],v[160:167],v2
v_cvt_pk_bf16_f32 v121,v100,v101
v_add_f32 v104,v104,v106
v_add_f32 v105,v105,v107
v_cvt_pk_bf16_f32 v122,v104,v105
v_add_f32 v108,v108,v110
v_add_f32 v109,v109,v111
v_cvt_pk_bf16_f32 v123,v108,v109
ds_write_b128 v4,v[120:123]
v_smfmac_f32_16x16x64_bf16 v[116:119],v[32:35],v[168:175],v2
s_mov_b32 s54,s68
s_add_u32 s68,s68,131072
v_mov_b32 v125,0
v_smfmac_f32_16x16x64_bf16 v[112:115],v[36:39],v[176:183],v2
s_cmp_eq_u32 s51,63
s_cbranch_scc1 L_cend_248
v_smfmac_f32_16x16x64_bf16 v[116:119],v[36:39],v[184:191],v2
v_smfmac_f32_16x16x64_bf16 v[112:115],v[40:43],v[192:199],v2
s_waitcnt lgkmcnt(0)
s_barrier
ds_read_b64_tr_b16 v[96:97],v5 offset:0
ds_read_b64_tr_b16 v[98:99],v6 offset:0
v_smfmac_f32_16x16x64_bf16 v[116:119],v[40:43],v[200:207],v2
ds_read_b64_tr_b16 v[100:101],v5 offset:1024
v_smfmac_f32_16x16x64_bf16 v[112:115],v[44:47],v[208:215],v2
ds_read_b64_tr_b16 v[102:103],v6 offset:1024
v_smfmac_f32_16x16x64_bf16 v[116:119],v[44:47],v[216:223],v2
ds_read_b64_tr_b16 v[104:105],v5 offset:2048
v_smfmac_f32_16x16x64_bf16 v[112:115],v[48:51],v[224:231],v2
ds_read_b64_tr_b16 v[106:107],v6 offset:2048
s_waitcnt lgkmcnt(4)
v_mfma_f32_16x16x32_bf16 v[24:27],v[56:59],v[96:99],0
ds_read_b64_tr_b16 v[108:109],v5 offset:3072
v_mfma_f32_16x16x32_bf16 v[28:31],v[60:63],v[96:99],0
ds_read_b64_tr_b16 v[110:111],v6 offset:3072
v_mfma_f32_16x16x32_bf16 v[32:35],v[96:99],v[96:99],0
ds_read_b128 v[40:43],v11 offset:12288
s_waitcnt lgkmcnt(5)
v_mfma_f32_16x16x32_bf16 v[24:27],v[64:67],v[100:103],v[24:27]
ds_read_b128 v[56:59],v11 offset:0
v_mfma_f32_16x16x32_bf16 v[28:31],v[68:71],v[100:103],v[28:31]
ds_read_b128 v[60:63],v11 offset:1024
v_mfma_f32_16x16x32_bf16 v[32:35],v[100:103],v[100:103],v[32:35]
ds_read_b128 v[96:99],v11 offset:8192
s_waitcnt lgkmcnt(6)
v_mfma_f32_16x16x32_bf16 v[24:27],v[72:75],v[104:107],v[24:27]
ds_read_b128 v[64:67],v11 offset:2048
v_mfma_f32_16x16x32_bf16 v[28:31],v[76:79],v[104:107],v[28:31]
ds_read_b128 v[68:71],v11 offset:3072
v_mfma_f32_16x16x32_bf16 v[32:35],v[104:107],v[104:107],v[32:35]
ds_read_b128 v[100:103],v11 offset:9216
s_waitcnt lgkmcnt(7)
v_mfma_f32_16x16x32_bf16 v[24:27],v[80:83],v[108:111],v[24:27]
ds_read_b128 v[72:75],v11 offset:4096
v_mfma_f32_16x16x32_bf16 v[28:31],v[84:87],v[108:111],v[28:31]
ds_read_b128 v[76:79],v11 offset:5120
v_mfma_f32_16x16x32_bf16 v[32:35],v[108:111],v[108:111],v[32:35]
ds_read_b128 v[104:107],v11 offset:10240
v_smfmac_f32_16x16x64_bf16 v[116:119],v[48:51],v[232:239],v2
ds_read_b128 v[80:83],v11 offset:6144
v_smfmac_f32_16x16x64_bf16 v[112:115],v[52:55],v[240:247],v2
ds_read_b128 v[84:87],v11 offset:7168
v_smfmac_f32_16x16x64_bf16 v[116:119],v[52:55],v[248:255],v2
ds_read_b128 v[108:111],v11 offset:11264
v_max3_f32 v126,v24,v25,v26
v_max3_f32 v127,v27,v28,v29
v_max3_f32 v126,v30,v31,v126
v_max3_f32 v127,v34,v35,v127
v_max_f32 v126,v126,v127
v_max_f32 v127,v126,v127
v_pk_mul_f32 v[34:35],v[34:35],v[0:1] op_sel:[0,1]
v_pk_mul_f32 v[24:25],v[24:25],v[0:1] op_sel:[0,1]
v_permlane16_swap_b32 v126,v127
v_max_f32 v126,v126,v127
v_max_f32 v127,v126,v127
v_pk_mul_f32 v[26:27],v[26:27],v[0:1] op_sel:[0,1]
v_pk_mul_f32 v[28:29],v[28:29],v[0:1] op_sel:[0,1]
v_permlane32_swap_b32 v126,v127
v_max_f32 v126,v126,v127
v_mul_f32 v126,v1,v126
v_pk_mul_f32 v[30:31],v[30:31],v[0:1] op_sel:[0,1]
v_pk_add_f32 v[34:35],v[34:35],v[126:127] op_sel_hi:[1,0] neg_lo:[0,1] neg_hi:[0,1]
v_pk_add_f32 v[112:113],v[112:113],v[114:115]
v_pk_add_f32 v[116:117],v[116:117],v[118:119]
v_pk_add_f32 v[24:25],v[24:25],v[126:127] op_sel_hi:[1,0] neg_lo:[0,1] neg_hi:[0,1]
v_pk_add_f32 v[26:27],v[26:27],v[126:127] op_sel_hi:[1,0] neg_lo:[0,1] neg_hi:[0,1]
v_pk_add_f32 v[28:29],v[28:29],v[126:127] op_sel_hi:[1,0] neg_lo:[0,1] neg_hi:[0,1]
v_pk_add_f32 v[30:31],v[30:31],v[126:127] op_sel_hi:[1,0] neg_lo:[0,1] neg_hi:[0,1]
v_exp_f32 v34,v34
v_exp_f32 v35,v35
v_cvt_pk_bf16_f32 v126,v112,v113
v_cvt_pk_bf16_f32 v124,v34,v35
v_cvt_pk_bf16_f32 v127,v116,v117
v_cvt_pk_bf16_f32 v36,v116,v117
v_mfma_f32_16x16x16_bf16 v[32:35],v[14:15],v[124:125],0
ds_read_b128 v[44:47],v11 offset:13312
v_exp_f32 v24,v24
v_mfma_f32_16x16x16_bf16 v[112:115],v[126:127],v[124:125],0
ds_read_b128 v[48:51],v11 offset:14336
v_exp_f32 v25,v25
v_mfma_f32_16x16x16_bf16 v[116:119],v[36:37],v[124:125],0
ds_read_b128 v[52:55],v11 offset:15360
v_exp_f32 v26,v26
v_exp_f32 v27,v27
v_cvt_pk_bf16_f32 v120,v24,v25
v_exp_f32 v28,v28
v_exp_f32 v29,v29
v_cvt_pk_bf16_f32 v121,v26,v27
v_exp_f32 v30,v30
v_exp_f32 v31,v31
v_cvt_pk_bf16_f32 v122,v28,v29
v_cvt_pk_bf16_f32 v123,v30,v31
s_add_u32 s75,s75,8192
s_add_u32 s51,s51,1
v_mfma_f32_16x16x32_bf16 v[32:35],v[14:17],v[120:123],v[32:35]
v_mfma_f32_16x16x32_bf16 v[112:115],v[88:91],v[120:123],v[112:115]
ds_read_b128 v[88:91],v11 offset:16384
v_mfma_f32_16x16x32_bf16 v[116:119],v[92:95],v[120:123],v[116:119]
ds_read_b128 v[92:95],v11 offset:17408
v_rcp_f32 v32,v32
v_mov_b64 v[24:25],-1
v_mov_b64 v[26:27],-1
s_add_u32 s64,s75,11534336
s_add_u32 s70,s64,4096
v_pk_mul_f32 v[112:113],v[112:113],v[32:33] op_sel_hi:[1,0]
v_pk_mul_f32 v[114:115],v[114:115],v[32:33] op_sel_hi:[1,0]
v_pk_mul_f32 v[116:117],v[116:117],v[32:33] op_sel_hi:[1,0]
v_pk_mul_f32 v[118:119],v[118:119],v[32:33] op_sel_hi:[1,0]
v_cvt_pk_bf16_f32 v120,v112,v116
v_cvt_pk_bf16_f32 v121,v113,v117
v_cvt_pk_bf16_f32 v122,v114,v118
v_cvt_pk_bf16_f32 v123,v115,v119
ds_write_b128 v7,v[120:123]
buffer_store_dwordx4 v[24:27],v0,s[8:11],s69 offen sc1
buffer_store_dwordx4 v[24:27],v0,s[8:11],s69 offen offset:1024 sc1
v_mov_b64 v[112:113],0
v_mov_b64 v[114:115],0
v_mov_b64 v[116:117],0
v_mov_b64 v[118:119],0
s_waitcnt lgkmcnt(0)
s_barrier
ds_read_b128 v[24:27],v8 offset:0
ds_read_b128 v[28:31],v8 offset:512
ds_read_b128 v[32:35],v8 offset:1024
ds_read_b128 v[36:39],v8 offset:1536
v_mov_b64 v[120:121],0
v_mov_b64 v[122:123],0
s_add_u32 s57,s65,65536
s_add_u32 s58,s65,131072
s_add_u32 s59,s65,196608
s_add_u32 s56,s18,s75
s_waitcnt lgkmcnt(3)
v_smfmac_f32_16x16x64_bf16 v[112:115],v[24:27],v[56:63],v3
ds_read_b128 v[56:59],v11 offset:18432
s_waitcnt lgkmcnt(3)
v_smfmac_f32_16x16x64_bf16 v[112:115],v[28:31],v[64:71],v3
ds_read_b128 v[60:63],v11 offset:19456
s_waitcnt lgkmcnt(3)
v_smfmac_f32_16x16x64_bf16 v[112:115],v[32:35],v[72:79],v3
ds_read_b128 v[64:67],v11 offset:20480
s_waitcnt lgkmcnt(3)
v_smfmac_f32_16x16x64_bf16 v[112:115],v[36:39],v[80:87],v3
ds_read_b128 v[68:71],v11 offset:21504
v_smfmac_f32_16x16x64_bf16 v[116:119],v[24:27],v[96:103],v3
ds_read_b128 v[72:75],v11 offset:22528
v_smfmac_f32_16x16x64_bf16 v[116:119],v[28:31],v[104:111],v3
ds_read_b128 v[76:79],v11 offset:23552
v_cvt_pk_bf16_f32 v112,v112,v113
v_smfmac_f32_16x16x64_bf16 v[116:119],v[32:35],v[40:47],v3
ds_read_b128 v[80:83],v11 offset:24576
v_cvt_pk_bf16_f32 v113,v114,v115
buffer_store_dwordx2 v[112:113],v9,s[8:11],s65 offen sc1
v_smfmac_f32_16x16x64_bf16 v[116:119],v[36:39],v[48:55],v3
ds_read_b128 v[84:87],v11 offset:25600
v_mov_b64 v[112:113],0
v_smfmac_f32_16x16x64_bf16 v[120:123],v[24:27],v[88:95],v3
ds_read_b128 v[96:99],v11 offset:26624
ds_read_b128 v[100:103],v11 offset:27648
v_mov_b64 v[114:115],0
s_waitcnt lgkmcnt(8)
v_smfmac_f32_16x16x64_bf16 v[120:123],v[28:31],v[56:63],v3
ds_read_b128 v[104:107],v11 offset:28672
v_cvt_pk_bf16_f32 v116,v116,v117
s_waitcnt lgkmcnt(7)
v_smfmac_f32_16x16x64_bf16 v[120:123],v[32:35],v[64:71],v3
ds_read_b128 v[108:111],v11 offset:29696
ds_read_b128 v[40:43],v11 offset:30720
v_cvt_pk_bf16_f32 v117,v118,v119
buffer_store_dwordx2 v[116:117],v9,s[8:11],s57 offen sc1
s_waitcnt lgkmcnt(7)
v_smfmac_f32_16x16x64_bf16 v[120:123],v[36:39],v[72:79],v3
ds_read_b128 v[44:47],v11 offset:31744
v_add_u32 v52,s50,v5
s_waitcnt lgkmcnt(6)
v_smfmac_f32_16x16x64_bf16 v[112:115],v[24:27],v[80:87],v3
v_add_u32 v54,s50,v6
s_waitcnt lgkmcnt(4)
v_smfmac_f32_16x16x64_bf16 v[112:115],v[28:31],v[96:103],v3
ds_read_b64_tr_b16 v[52:53],v52
v_cvt_pk_bf16_f32 v120,v120,v121
s_waitcnt lgkmcnt(3)
v_smfmac_f32_16x16x64_bf16 v[112:115],v[32:35],v[104:111],v3
ds_read_b64_tr_b16 v[54:55],v54
v_cvt_pk_bf16_f32 v121,v122,v123
buffer_store_dwordx2 v[120:121],v9,s[8:11],s58 offen sc1
s_waitcnt lgkmcnt(2)
v_smfmac_f32_16x16x64_bf16 v[112:115],v[36:39],v[40:47],v3
v_mov_b64 v[116:117],0
v_mov_b64 v[118:119],0
s_xor_b32 s65,s65,262144
v_mov_b32_dpp v124,v126 quad_perm:[2,3,2,3] row_mask:0xf bank_mask:0xf
v_mov_b32_dpp v125,v127 quad_perm:[2,3,2,3] row_mask:0xf bank_mask:0xf
s_mov_b32 vcc_lo,0xcccccccc
s_mov_b32 vcc_hi,0xcccccccc
s_nop 0
v_cvt_pk_bf16_f32 v112,v112,v113
v_cvt_pk_bf16_f32 v113,v114,v115
buffer_store_dwordx2 v[112:113],v9,s[8:11],s59 offen sc1
s_waitcnt lgkmcnt(0)
s_buffer_load_dword s19,s[8:11],s56
v_cndmask_b32 v124,v124,v52,vcc
v_cndmask_b32 v125,v125,v53,vcc
v_cndmask_b32 v126,v126,v54,vcc
v_cndmask_b32 v127,v127,v55,vcc
s_cmp_lt_u32 s46,2
s_waitcnt vmcnt(3)
s_cbranch_scc1 L_crg_255
s_cmp_eq_u32 s46,2
s_waitcnt vmcnt(1)
s_cbranch_scc1 L_crg_255
s_waitcnt vmcnt(0)
L_crg_255:
buffer_load_dwordx4 v[32:35],v0,s[8:11],s66 offen offset:0 sc1
buffer_load_dwordx4 v[36:39],v0,s[8:11],s66 offen offset:1024 sc1
v_mov_b64 v[96:97],0
v_mov_b64 v[98:99],0
v_mov_b64 v[100:101],0
v_mov_b64 v[102:103],0
v_mov_b64 v[104:105],0
v_mov_b64 v[106:107],0
v_mov_b64 v[108:109],0
v_mov_b64 v[110:111],0
v_mov_b64 v[112:113],0
v_mov_b64 v[114:115],0
v_add_u32 v55,131072,v0
v_add_u32 v123,s73,v55
v_xor_b32 v120,1024,v12
v_xor_b32 v121,2048,v12
v_xor_b32 v122,3072,v12
buffer_load_dwordx4 v[44:47],v0,s[8:11],s66 offen offset:0 sc1
buffer_load_dwordx4 v[48:51],v0,s[8:11],s66 offen offset:1024 sc1
s_cmp_ge_u32 s51,63
s_cselect_b32 s76,0,1
s_cmp_eq_u32 s46,0
s_cselect_b32 s76,s76,0
s_waitcnt vmcnt(3)
v_mfma_f32_16x16x32_bf16 v[28:31],v[18:21],v[32:35],0
s_waitcnt vmcnt(2)
v_mfma_f32_16x16x32_bf16 v[28:31],v[18:21],v[36:39],v[28:31]
s_nop 7
v_cmp_u_f32 vcc,v28,v28
v_add_f32_dpp v52,v28,v28 row_ror:8 row_mask:0xf bank_mask:0x3
v_add_f32_dpp v53,v29,v29 row_ror:8 row_mask:0xf bank_mask:0x3
v_add_f32_dpp v52,v30,v30 row_ror:8 row_mask:0xf bank_mask:0xc
v_add_f32_dpp v53,v31,v31 row_ror:8 row_mask:0xf bank_mask:0xc
s_nop 0
v_add_f32_dpp v52,v52,v52 row_shl:4 row_mask:0xf bank_mask:0x5
v_add_f32_dpp v53,v53,v53 row_shl:4 row_mask:0xf bank_mask:0x5
s_cbranch_vccnz L_crp_250
L_cok_256:
v_cvt_pk_bf16_f32 v54,v52,v53
buffer_store_dword v54,v10,s[8:11],s64 offen sc1
s_mov_b32 s69,s66
s_xor_b32 s66,s66,262144
s_barrier
ds_read_b128 v[56:59],v55 offset:0
ds_read_b128 v[60:63],v55 offset:4096
ds_read_b128 v[64:67],v55 offset:1024
buffer_load_dwordx4 v[24:27],v13,s[8:11],s64 offen sc1
ds_read_b128 v[68:71],v55 offset:5120
ds_read_b128 v[72:75],v55 offset:2048
ds_read_b128 v[76:79],v55 offset:6144
ds_read_b128 v[80:83],v55 offset:3072
buffer_load_dwordx4 v[24:27],v13,s[8:11],s64 offen sc1
ds_read_b128 v[84:87],v55 offset:7168
ds_read_b128 v[88:91],v123 offset:8192
ds_read_b128 v[92:95],v123 offset:9216
s_branch L_chain_245
L_cpb_252:
buffer_load_dwordx4 v[40:43],v13,s[8:11],s70 offen sc1
s_sub_u32 s49,s49,1
s_cbranch_scc1 L_abort2
s_waitcnt vmcnt(0)
v_max3_u32 v123,v40,v41,v42
v_max_u32 v123,v43,v123
v_cmp_le_u32 vcc,s72,v123
s_cbranch_vccnz L_cpb_252
ds_write_b128 v12,v[40:43] offset:4096
s_branch L_cback_254
L_crp_250:
buffer_load_dwordx4 v[32:35],v0,s[8:11],s66 offen offset:0 sc1
buffer_load_dwordx4 v[36:39],v0,s[8:11],s66 offen offset:1024 sc1
s_sub_u32 s49,s49,1
s_cbranch_scc1 L_abort2
s_waitcnt vmcnt(3)
v_mfma_f32_16x16x32_bf16 v[28:31],v[18:21],v[44:47],0
s_waitcnt vmcnt(2)
v_mfma_f32_16x16x32_bf16 v[28:31],v[18:21],v[48:51],v[28:31]
s_nop 7
v_cmp_u_f32 vcc,v28,v28
v_add_f32_dpp v52,v28,v28 row_ror:8 row_mask:0xf bank_mask:0x3
v_add_f32_dpp v53,v29,v29 row_ror:8 row_mask:0xf bank_mask:0x3
v_add_f32_dpp v52,v30,v30 row_ror:8 row_mask:0xf bank_mask:0xc
v_add_f32_dpp v53,v31,v31 row_ror:8 row_mask:0xf bank_mask:0xc
s_nop 0
v_add_f32_dpp v52,v52,v52 row_shl:4 row_mask:0xf bank_mask:0x5
v_add_f32_dpp v53,v53,v53 row_shl:4 row_mask:0xf bank_mask:0x5
s_cbranch_vccz L_cok_256
buffer_load_dwordx4 v[44:47],v0,s[8:11],s66 offen offset:0 sc1
buffer_load_dwordx4 v[48:51],v0,s[8:11],s66 offen offset:1024 sc1
s_sub_u32 s49,s49,1
s_cbranch_scc1 L_abort2
s_waitcnt vmcnt(3)
v_mfma_f32_16x16x32_bf16 v[28:31],v[18:21],v[32:35],0
s_waitcnt vmcnt(2)
v_mfma_f32_16x16x32_bf16 v[28:31],v[18:21],v[36:39],v[28:31]
s_nop 7
v_cmp_u_f32 vcc,v28,v28
v_add_f32_dpp v52,v28,v28 row_ror:8 row_mask:0xf bank_mask:0x3
v_add_f32_dpp v53,v29,v29 row_ror:8 row_mask:0xf bank_mask:0x3
v_add_f32_dpp v52,v30,v30 row_ror:8 row_mask:0xf bank_mask:0xc
v_add_f32_dpp v53,v31,v31 row_ror:8 row_mask:0xf bank_mask:0xc
s_nop 0
v_add_f32_dpp v52,v52,v52 row_shl:4 row_mask:0xf bank_mask:0x5
v_add_f32_dpp v53,v53,v53 row_shl:4 row_mask:0xf bank_mask:0x5
s_cbranch_vccz L_cok_256
s_branch L_crp_250
L_ckw_238:
s_add_u32 s59,s18,s75
L_ww_257:
s_sleep 1
buffer_load_dword v23,off,s[8:11],s59 sc1
s_sub_u32 s49,s49,1
s_cbranch_scc1 L_abort2
s_waitcnt vmcnt(0)
v_readfirstlane_b32 s76,v23
s_cmp_eq_u32 s76,0
s_cbranch_scc1 L_ww_257
L_wwd_258:
s_branch L_ckb_239
L_cend_248:
v_smfmac_f32_16x16x64_bf16 v[116:119],v[36:39],v[184:191],v2
v_smfmac_f32_16x16x64_bf16 v[112:115],v[40:43],v[192:199],v2
v_smfmac_f32_16x16x64_bf16 v[116:119],v[40:43],v[200:207],v2
v_smfmac_f32_16x16x64_bf16 v[112:115],v[44:47],v[208:215],v2
v_smfmac_f32_16x16x64_bf16 v[116:119],v[44:47],v[216:223],v2
v_smfmac_f32_16x16x64_bf16 v[112:115],v[48:51],v[224:231],v2
v_smfmac_f32_16x16x64_bf16 v[116:119],v[48:51],v[232:239],v2
v_smfmac_f32_16x16x64_bf16 v[112:115],v[52:55],v[240:247],v2
v_smfmac_f32_16x16x64_bf16 v[116:119],v[52:55],v[248:255],v2
s_waitcnt lgkmcnt(0)
s_nop 2
v_pk_add_f32 v[112:113],v[112:113],v[114:115]
s_nop 2
v_pk_add_f32 v[116:117],v[116:117],v[118:119]
v_cvt_pk_bf16_f32 v126,v112,v113
v_cvt_pk_bf16_f32 v127,v116,v117
v_add_u32 v52,s50,v5
v_add_u32 v54,s50,v6
ds_read_b64_tr_b16 v[52:53],v52
ds_read_b64_tr_b16 v[54:55],v54
v_mov_b32_dpp v124,v126 quad_perm:[2,3,2,3] row_mask:0xf bank_mask:0xf
v_mov_b32_dpp v125,v127 quad_perm:[2,3,2,3] row_mask:0xf bank_mask:0xf
s_mov_b32 vcc_lo,0xcccccccc
s_mov_b32 vcc_hi,0xcccccccc
s_waitcnt lgkmcnt(0)
v_cndmask_b32 v124,v124,v52,vcc
v_cndmask_b32 v125,v125,v53,vcc
v_cndmask_b32 v126,v126,v54,vcc
v_cndmask_b32 v127,v127,v55,vcc
buffer_store_dwordx4 v[124:127],v0,s[8:11],s54 offen sc1
s_mov_b32 s51,64
s_waitcnt vmcnt(0)
s_barrier
s_nop 11
v_lshrrev_b32 v1,4,v0
s_mov_b32 s53,0
s_branch L_rb_7
L_rc1_232:
v_and_b32 v120,15,v1
v_lshrrev_b32 v121,4,v1
v_and_b32 v122,2,v1
v_cmp_eq_u32 vcc,0,v122
v_mov_b32 v2,0xeeee
v_mov_b32 v123,0x4444
v_cndmask_b32 v2,v2,v123,vcc
v_and_b32 v122,1,v1
v_cmp_eq_u32 vcc,0,v122
v_mov_b32 v3,0xdddd
v_mov_b32 v123,0x8888
v_cndmask_b32 v3,v3,v123,vcc
v_lshrrev_b32 v122,1,v120
v_bfe_u32 v123,v120,2,1
v_xor_b32 v123,v123,v122
v_lshlrev_b32 v4,7,v123
v_and_b32 v123,1,v120
v_lshl_add_u32 v4,v123,6,v4
v_xor_b32 v123,v121,v122
v_and_b32 v123,3,v123
v_lshl_add_u32 v4,v123,4,v4
s_lshl_b32 s56,s46,10
s_add_u32 s56,s56,147456
v_add_u32 v4,s56,v4
v_lshlrev_b32 v122,1,v121
v_add_u32 v122,0,v122
v_and_b32 v123,1,v121
v_xor_b32 v123,v123,v122
v_lshlrev_b32 v5,7,v123
v_bfe_u32 v123,v120,3,1
v_lshl_add_u32 v5,v123,6,v5
v_xor_b32 v123,v120,v122
v_and_b32 v123,3,v123
v_lshl_add_u32 v5,v123,4,v5
v_bfe_u32 v123,v120,2,1
v_lshl_add_u32 v5,v123,3,v5
v_add_u32 v5,147456,v5
v_lshlrev_b32 v122,1,v121
v_add_u32 v122,1,v122
v_and_b32 v123,1,v121
v_xor_b32 v123,v123,v122
v_lshlrev_b32 v6,7,v123
v_bfe_u32 v123,v120,3,1
v_lshl_add_u32 v6,v123,6,v6
v_xor_b32 v123,v120,v122
v_and_b32 v123,3,v123
v_lshl_add_u32 v6,v123,4,v6
v_bfe_u32 v123,v120,2,1
v_lshl_add_u32 v6,v123,3,v6
v_add_u32 v6,147456,v6
v_lshlrev_b32 v7,7,v121
v_lshrrev_b32 v122,1,v120
v_lshl_add_u32 v8,v122,4,v7
v_add_u32 v8,151552,v8
v_lshrrev_b32 v122,2,v120
v_lshl_add_u32 v7,v122,5,v7
v_and_b32 v122,1,v120
v_lshl_add_u32 v7,v122,4,v7
v_and_b32 v122,2,v120
v_cmp_eq_u32 vcc,0,v122
s_lshl_b32 s56,s46,9
v_mov_b32 v122,2048
v_mov_b32 v123,s56
v_cndmask_b32 v122,v122,v123,vcc
v_add_u32 v7,v122,v7
v_add_u32 v7,151552,v7
v_lshrrev_b32 v122,3,v1
v_lshlrev_b32 v9,11,v122
v_and_b32 v122,7,v1
v_lshl_add_u32 v9,v122,3,v9
s_lshl_b32 s56,s46,14
s_lshl_b32 s57,s47,6
s_add_u32 s56,s56,s57
v_add_u32 v9,s56,v9
s_lshl_b32 s71,s46,5
s_add_u32 s71,s71,s47
s_bfe_u32 s56,s71,0x10003
s_lshl_b32 s56,s56,11
s_and_b32 s57,s71,1
s_lshl_b32 s57,s57,10
s_add_u32 s56,s56,s57
s_bfe_u32 s57,s71,0x10002
s_lshl_b32 s57,s57,9
s_add_u32 s56,s56,s57
s_bfe_u32 s57,s71,0x10001
s_lshl_b32 s57,s57,6
s_add_u32 s56,s56,s57
s_bfe_u32 s57,s71,0x10004
s_lshl_b32 s57,s57,8
s_add_u32 s56,s56,s57
s_bfe_u32 s57,s71,0x10005
s_lshl_b32 s57,s57,7
s_add_u32 s56,s56,s57
s_bfe_u32 s57,s71,0x10006
s_lshl_b32 s57,s57,12
s_add_u32 s56,s56,s57
v_and_b32 v122,3,v120
v_lshlrev_b32 v10,2,v122
v_bfe_u32 v122,v120,3,1
v_lshl_add_u32 v10,v122,4,v10
v_and_b32 v122,1,v121
v_lshl_add_u32 v10,v122,5,v10
v_add_u32 v10,s56,v10
v_and_b32 v123,36,v1
v_mov_b32 v122,0x80000000
v_cmp_eq_u32 vcc,0,v123
s_nop 1
v_cndmask_b32 v10,v122,v10,vcc
s_lshl_b32 s71,s71,11
s_lshl_b32 s73,s46,11
s_mov_b32 s72,0xffc00000
s_mov_b32 s74,0
v_and_b32 v11,1,v121
v_xor_b32 v11,v11,v120
v_and_b32 v11,3,v11
v_lshrrev_b32 v122,2,v120
v_lshl_add_u32 v11,v11,2,v122
v_lshl_add_u32 v11,v121,4,v11
v_lshlrev_b32 v11,4,v11
s_lshl_b32 s56,s46,15
v_add_u32 v11,s56,v11
v_lshrrev_b32 v13,3,v1
v_lshlrev_b32 v13,9,v13
v_and_b32 v122,7,v1
v_lshl_add_u32 v13,v122,4,v13
v_and_b32 v122,15,v1
v_and_b32 v123,1,v1
v_lshlrev_b32 v123,4,v123
v_mov_b32 v124,0x3f80
v_lshlrev_b32 v124,v123,v124
v_lshrrev_b32 v122,1,v122
v_cmp_eq_u32 vcc,0,v122
s_nop 1
v_cndmask_b32 v18,0,v124,vcc
v_cmp_eq_u32 vcc,1,v122
s_nop 1
v_cndmask_b32 v19,0,v124,vcc
v_cmp_eq_u32 vcc,2,v122
s_nop 1
v_cndmask_b32 v20,0,v124,vcc
v_cmp_eq_u32 vcc,3,v122
s_nop 1
v_cndmask_b32 v21,0,v124,vcc
s_and_b32 s56,s46,1
s_lshl_b32 s56,s56,8
s_and_b32 s57,s46,2
s_lshl_b32 s57,s57,6
s_add_u32 s56,s56,s57
v_add_u32 v13,s56,v13
s_add_u32 s56,s50,155648
v_add_u32 v12,s56,v0
v_mov_b64 v[14:15],s[28:29]
v_mov_b64 v[16:17],s[28:29]
v_add_u32 v22,12599296,v10
s_lshl_b32 s18,s47,2
s_add_u32 s18,s18,10494080
v_mov_b32 v1,s80
s_mov_b32 s65,15728640
s_add_u32 s66,s71,15728640
s_add_u32 s69,s71,15990784
s_mov_b32 s30,0x40000000
s_mov_b32 s51,0
L_cst_262:
s_cmp_lg_u32 s46,0
s_cbranch_scc1 L_csw_267
s_lshl_b32 s59,s51,13
s_lshl2_add_u32 s59,s47,s59
s_add_u32 s59,s59,10485888
L_ww_268:
s_sleep 1
buffer_load_dword v122,off,s[8:11],s59 sc1
s_sub_u32 s49,s49,1
s_cbranch_scc1 L_abort2
s_waitcnt vmcnt(0)
v_readfirstlane_b32 s61,v122
s_cmp_eq_u32 s61,0
s_cbranch_scc1 L_ww_268
L_wwd_269:
L_csw_267:
s_waitcnt lgkmcnt(0)
s_barrier
s_lshl_b32 s56,s51,5
s_add_u32 s56,s56,s47
s_mul_i32 s56,s56,24576
s_add_u32 s56,s56,150994944
s_add_u32 s67,s56,s73
s_add_u32 m0,s73,131072
s_add_u32 s57,s67,8192
buffer_load_dwordx4 v0,s[8:11],s67 offen sc1 lds
buffer_load_dwordx4 v0,s[8:11],s67 offen offset:1024 sc1 lds
s_add_u32 m0,s73,139264
s_add_u32 s67,s67,786432
buffer_load_dwordx4 v0,s[8:11],s57 offen sc1 lds
buffer_load_dwordx4 v0,s[8:11],s57 offen offset:1024 sc1 lds
s_lshl_b32 s75,s51,13
s_add_u32 s56,s75,12591104
buffer_load_dword v23,v10,s[8:11],s56 offen sc1
s_add_u32 s64,s75,12582912
s_add_u32 s70,s64,4096
s_lshl_b32 s68,s51,5
s_add_u32 s68,s68,s47
s_lshl_b32 s68,s68,12
s_lshl_b32 s56,s46,10
s_add_u32 s68,s68,s56
s_add_u32 s68,s68,58720256
s_mov_b32 s54,0x80000000
s_mov_b32 s77,0
s_add_u32 s56,s18,s75
s_buffer_load_dword s19,s[8:11],s56
s_cmp_eq_u32 s51,63
s_cselect_b32 s76,1,s46
s_cmp_eq_u32 s76,0
s_cselect_b32 s76,1,0
v_mov_b64 v[96:97],0
v_mov_b64 v[98:99],0
v_mov_b64 v[100:101],0
v_mov_b64 v[102:103],0
v_mov_b64 v[104:105],0
v_mov_b64 v[106:107],0
v_mov_b64 v[108:109],0
v_mov_b64 v[110:111],0
v_mov_b64 v[112:113],0
v_mov_b64 v[114:115],0
v_mov_b64 v[116:117],0
v_mov_b64 v[118:119],0
s_waitcnt vmcnt(0) lgkmcnt(0)
s_barrier
v_add_u32 v55,131072,v0
ds_read_b128 v[56:59],v55 offset:0
ds_read_b128 v[60:63],v55 offset:4096
ds_read_b128 v[64:67],v55 offset:1024
ds_read_b128 v[68:71],v55 offset:5120
ds_read_b128 v[72:75],v55 offset:2048
ds_read_b128 v[76:79],v55 offset:6144
ds_read_b128 v[80:83],v55 offset:3072
ds_read_b128 v[84:87],v55 offset:7168
v_add_u32 v123,s73,v55
ds_read_b128 v[88:91],v123 offset:8192
ds_read_b128 v[92:95],v123 offset:9216
v_xor_b32 v120,1024,v12
v_xor_b32 v121,2048,v12
v_xor_b32 v122,3072,v12
buffer_load_dwordx4 v[24:27],v13,s[8:11],s64 offen sc1
buffer_load_dwordx4 v[24:27],v13,s[8:11],s64 offen sc1
L_chain_270:
L_cpa_271:
buffer_load_dwordx4 v[24:27],v13,s[8:11],s64 offen sc1
s_sub_u32 s49,s49,1
s_cbranch_scc1 L_abort2
s_waitcnt vmcnt(2)
v_max3_u32 v123,v24,v25,v26
v_max_u32 v123,v27,v123
v_cmp_le_u32 vcc,s72,v123
ds_write_b128 v12,v[24:27] offset:0
s_cbranch_vccnz L_cpa_271
L_cgo_274:
v_smfmac_f32_16x16x64_bf16 v[96:99],v[24:27],a[0:7],v2
buffer_load_dwordx4 v[40:43],v13,s[8:11],s70 offen sc1
v_smfmac_f32_16x16x64_bf16 v[100:103],v[24:27],a[128:135],v2
s_waitcnt lgkmcnt(0)
s_barrier
ds_read_b128 v[28:31],v120 offset:0
v_smfmac_f32_16x16x64_bf16 v[104:107],v[24:27],a[8:15],v2
ds_read_b128 v[32:35],v121 offset:0
v_smfmac_f32_16x16x64_bf16 v[108:111],v[24:27],a[136:143],v2
ds_read_b128 v[36:39],v122 offset:0
v_smfmac_f32_16x16x64_bf16 v[112:115],v[24:27],v[128:135],v2
v_smfmac_f32_16x16x64_bf16 v[116:119],v[24:27],v[136:143],v2
s_waitcnt lgkmcnt(2)
v_smfmac_f32_16x16x64_bf16 v[96:99],v[28:31],a[16:23],v2
s_add_u32 m0,s73,131072
v_smfmac_f32_16x16x64_bf16 v[100:103],v[28:31],a[144:151],v2
s_add_u32 s57,s67,8192
v_smfmac_f32_16x16x64_bf16 v[104:107],v[28:31],a[24:31],v2
s_cmp_lt_u32 s19,s76
s_cbranch_scc1 L_ckw_263
L_ckb_264:
v_smfmac_f32_16x16x64_bf16 v[108:111],v[28:31],a[152:159],v2
s_waitcnt vmcnt(0) lgkmcnt(1)
v_smfmac_f32_16x16x64_bf16 v[96:99],v[32:35],a[32:39],v2
ds_write_b128 v12,v[40:43] offset:4096
v_max3_u32 v123,v40,v41,v42
v_smfmac_f32_16x16x64_bf16 v[100:103],v[32:35],a[160:167],v2
v_max_u32 v123,v43,v123
v_smfmac_f32_16x16x64_bf16 v[104:107],v[32:35],a[40:47],v2
v_cmp_le_u32 vcc,s72,v123
v_smfmac_f32_16x16x64_bf16 v[108:111],v[32:35],a[168:175],v2
v_smfmac_f32_16x16x64_bf16 v[112:115],v[28:31],v[144:151],v2
s_cbranch_vccnz L_cpb_277
L_cback_279:
s_waitcnt lgkmcnt(0)
s_barrier
v_smfmac_f32_16x16x64_bf16 v[96:99],v[36:39],a[48:55],v2
buffer_store_dword v54,v10,s[8:11],s30 offen sc1
v_smfmac_f32_16x16x64_bf16 v[100:103],v[36:39],a[176:183],v2
ds_read_b128 v[44:47],v120 offset:4096
v_smfmac_f32_16x16x64_bf16 v[104:107],v[36:39],a[56:63],v2
buffer_store_dwordx4 v[124:127],v0,s[8:11],s54 offen sc1
v_smfmac_f32_16x16x64_bf16 v[108:111],v[36:39],a[184:191],v2
ds_read_b128 v[48:51],v121 offset:4096
v_smfmac_f32_16x16x64_bf16 v[96:99],v[40:43],a[64:71],v2
buffer_load_dwordx4 v0,s[8:11],s67 offen sc1 lds
v_smfmac_f32_16x16x64_bf16 v[100:103],v[40:43],a[192:199],v2
ds_read_b128 v[52:55],v122 offset:4096
v_smfmac_f32_16x16x64_bf16 v[104:107],v[40:43],a[72:79],v2
buffer_load_dwordx4 v0,s[8:11],s67 offen offset:1024 sc1 lds
s_add_u32 m0,s73,139264
v_smfmac_f32_16x16x64_bf16 v[108:111],v[40:43],a[200:207],v2
s_waitcnt lgkmcnt(2)
v_smfmac_f32_16x16x64_bf16 v[96:99],v[44:47],a[80:87],v2
buffer_load_dwordx4 v0,s[8:11],s57 offen sc1 lds
s_add_u32 s67,s67,786432
v_smfmac_f32_16x16x64_bf16 v[100:103],v[44:47],a[208:215],v2
s_waitcnt lgkmcnt(1)
v_smfmac_f32_16x16x64_bf16 v[96:99],v[48:51],a[96:103],v2
buffer_load_dwordx4 v0,s[8:11],s57 offen offset:1024 sc1 lds
v_smfmac_f32_16x16x64_bf16 v[100:103],v[48:51],a[224:231],v2
s_waitcnt lgkmcnt(0)
v_smfmac_f32_16x16x64_bf16 v[96:99],v[52:55],a[112:119],v2
buffer_load_dword v23,v22,s[8:11],s75 offen sc1
v_smfmac_f32_16x16x64_bf16 v[100:103],v[52:55],a[240:247],v2
v_smfmac_f32_16x16x64_bf16 v[104:107],v[44:47],a[88:95],v2
v_smfmac_f32_16x16x64_bf16 v[108:111],v[44:47],a[216:223],v2
v_smfmac_f32_16x16x64_bf16 v[104:107],v[48:51],a[104:111],v2
v_add_f32 v96,v96,v98
v_smfmac_f32_16x16x64_bf16 v[108:111],v[48:51],a[232:239],v2
v_add_f32 v97,v97,v99
v_smfmac_f32_16x16x64_bf16 v[104:107],v[52:55],a[120:127],v2
v_cvt_pk_bf16_f32 v120,v96,v97
v_smfmac_f32_16x16x64_bf16 v[108:111],v[52:55],a[248:255],v2
v_add_f32 v100,v100,v102
v_smfmac_f32_16x16x64_bf16 v[116:119],v[28:31],v[152:159],v2
v_add_f32 v101,v101,v103
v_smfmac_f32_16x16x64_bf16 v[112:115],v[32:35],v[160:167],v2
v_cvt_pk_bf16_f32 v121,v100,v101
v_add_f32 v104,v104,v106
v_add_f32 v105,v105,v107
v_cvt_pk_bf16_f32 v122,v104,v105
v_add_f32 v108,v108,v110
v_add_f32 v109,v109,v111
v_cvt_pk_bf16_f32 v123,v108,v109
ds_write_b128 v4,v[120:123]
v_smfmac_f32_16x16x64_bf16 v[116:119],v[32:35],v[168:175],v2
s_mov_b32 s54,s68
s_add_u32 s68,s68,131072
v_mov_b32 v125,0
v_smfmac_f32_16x16x64_bf16 v[112:115],v[36:39],v[176:183],v2
s_cmp_eq_u32 s51,63
s_cbranch_scc1 L_cend_273
v_smfmac_f32_16x16x64_bf16 v[116:119],v[36:39],v[184:191],v2
v_smfmac_f32_16x16x64_bf16 v[112:115],v[40:43],v[192:199],v2
s_waitcnt lgkmcnt(0)
s_barrier
ds_read_b64_tr_b16 v[96:97],v5 offset:0
ds_read_b64_tr_b16 v[98:99],v6 offset:0
v_smfmac_f32_16x16x64_bf16 v[116:119],v[40:43],v[200:207],v2
ds_read_b64_tr_b16 v[100:101],v5 offset:1024
v_smfmac_f32_16x16x64_bf16 v[112:115],v[44:47],v[208:215],v2
ds_read_b64_tr_b16 v[102:103],v6 offset:1024
v_smfmac_f32_16x16x64_bf16 v[116:119],v[44:47],v[216:223],v2
ds_read_b64_tr_b16 v[104:105],v5 offset:2048
v_smfmac_f32_16x16x64_bf16 v[112:115],v[48:51],v[224:231],v2
ds_read_b64_tr_b16 v[106:107],v6 offset:2048
s_waitcnt lgkmcnt(4)
v_mfma_f32_16x16x32_bf16 v[24:27],v[56:59],v[96:99],0
ds_read_b64_tr_b16 v[108:109],v5 offset:3072
v_mfma_f32_16x16x32_bf16 v[28:31],v[60:63],v[96:99],0
ds_read_b64_tr_b16 v[110:111],v6 offset:3072
v_mfma_f32_16x16x32_bf16 v[32:35],v[96:99],v[96:99],0
ds_read_b128 v[40:43],v11 offset:12288
s_waitcnt lgkmcnt(5)
v_mfma_f32_16x16x32_bf16 v[24:27],v[64:67],v[100:103],v[24:27]
ds_read_b128 v[56:59],v11 offset:0
v_mfma_f32_16x16x32_bf16 v[28:31],v[68:71],v[100:103],v[28:31]
ds_read_b128 v[60:63],v11 offset:1024
v_mfma_f32_16x16x32_bf16 v[32:35],v[100:103],v[100:103],v[32:35]
ds_read_b128 v[96:99],v11 offset:8192
s_waitcnt lgkmcnt(6)
v_mfma_f32_16x16x32_bf16 v[24:27],v[72:75],v[104:107],v[24:27]
ds_read_b128 v[64:67],v11 offset:2048
v_mfma_f32_16x16x32_bf16 v[28:31],v[76:79],v[104:107],v[28:31]
ds_read_b128 v[68:71],v11 offset:3072
v_mfma_f32_16x16x32_bf16 v[32:35],v[104:107],v[104:107],v[32:35]
ds_read_b128 v[100:103],v11 offset:9216
s_waitcnt lgkmcnt(7)
v_mfma_f32_16x16x32_bf16 v[24:27],v[80:83],v[108:111],v[24:27]
ds_read_b128 v[72:75],v11 offset:4096
v_mfma_f32_16x16x32_bf16 v[28:31],v[84:87],v[108:111],v[28:31]
ds_read_b128 v[76:79],v11 offset:5120
v_mfma_f32_16x16x32_bf16 v[32:35],v[108:111],v[108:111],v[32:35]
ds_read_b128 v[104:107],v11 offset:10240
v_smfmac_f32_16x16x64_bf16 v[116:119],v[48:51],v[232:239],v2
ds_read_b128 v[80:83],v11 offset:6144
v_smfmac_f32_16x16x64_bf16 v[112:115],v[52:55],v[240:247],v2
ds_read_b128 v[84:87],v11 offset:7168
v_smfmac_f32_16x16x64_bf16 v[116:119],v[52:55],v[248:255],v2
ds_read_b128 v[108:111],v11 offset:11264
v_max3_f32 v126,v24,v25,v26
v_max3_f32 v127,v27,v28,v29
v_max3_f32 v126,v30,v31,v126
v_max3_f32 v127,v34,v35,v127
v_max_f32 v126,v126,v127
v_max_f32 v127,v126,v127
v_pk_mul_f32 v[34:35],v[34:35],v[0:1] op_sel:[0,1]
v_pk_mul_f32 v[24:25],v[24:25],v[0:1] op_sel:[0,1]
v_permlane16_swap_b32 v126,v127
v_max_f32 v126,v126,v127
v_max_f32 v127,v126,v127
v_pk_mul_f32 v[26:27],v[26:27],v[0:1] op_sel:[0,1]
v_pk_mul_f32 v[28:29],v[28:29],v[0:1] op_sel:[0,1]
v_permlane32_swap_b32 v126,v127
v_max_f32 v126,v126,v127
v_mul_f32 v126,v1,v126
v_pk_mul_f32 v[30:31],v[30:31],v[0:1] op_sel:[0,1]
v_pk_add_f32 v[34:35],v[34:35],v[126:127] op_sel_hi:[1,0] neg_lo:[0,1] neg_hi:[0,1]
v_pk_add_f32 v[112:113],v[112:113],v[114:115]
v_pk_add_f32 v[116:117],v[116:117],v[118:119]
v_pk_add_f32 v[24:25],v[24:25],v[126:127] op_sel_hi:[1,0] neg_lo:[0,1] neg_hi:[0,1]
v_pk_add_f32 v[26:27],v[26:27],v[126:127] op_sel_hi:[1,0] neg_lo:[0,1] neg_hi:[0,1]
v_pk_add_f32 v[28:29],v[28:29],v[126:127] op_sel_hi:[1,0] neg_lo:[0,1] neg_hi:[0,1]
v_pk_add_f32 v[30:31],v[30:31],v[126:127] op_sel_hi:[1,0] neg_lo:[0,1] neg_hi:[0,1]
v_exp_f32 v34,v34
v_exp_f32 v35,v35
v_cvt_pk_bf16_f32 v126,v112,v113
v_cvt_pk_bf16_f32 v124,v34,v35
v_cvt_pk_bf16_f32 v127,v116,v117
v_cvt_pk_bf16_f32 v36,v116,v117
v_mfma_f32_16x16x16_bf16 v[32:35],v[14:15],v[124:125],0
ds_read_b128 v[44:47],v11 offset:13312
v_exp_f32 v24,v24
v_mfma_f32_16x16x16_bf16 v[112:115],v[126:127],v[124:125],0
ds_read_b128 v[48:51],v11 offset:14336
v_exp_f32 v25,v25
v_mfma_f32_16x16x16_bf16 v[116:119],v[36:37],v[124:125],0
ds_read_b128 v[52:55],v11 offset:15360
v_exp_f32 v26,v26
v_exp_f32 v27,v27
v_cvt_pk_bf16_f32 v120,v24,v25
v_exp_f32 v28,v28
v_exp_f32 v29,v29
v_cvt_pk_bf16_f32 v121,v26,v27
v_exp_f32 v30,v30
v_exp_f32 v31,v31
v_cvt_pk_bf16_f32 v122,v28,v29
v_cvt_pk_bf16_f32 v123,v30,v31
s_add_u32 s75,s75,8192
s_add_u32 s51,s51,1
v_mfma_f32_16x16x32_bf16 v[32:35],v[14:17],v[120:123],v[32:35]
v_mfma_f32_16x16x32_bf16 v[112:115],v[88:91],v[120:123],v[112:115]
ds_read_b128 v[88:91],v11 offset:16384
v_mfma_f32_16x16x32_bf16 v[116:119],v[92:95],v[120:123],v[116:119]
ds_read_b128 v[92:95],v11 offset:17408
v_rcp_f32 v32,v32
v_mov_b64 v[24:25],-1
v_mov_b64 v[26:27],-1
s_add_u32 s64,s75,12582912
s_add_u32 s70,s64,4096
v_pk_mul_f32 v[112:113],v[112:113],v[32:33] op_sel_hi:[1,0]
v_pk_mul_f32 v[114:115],v[114:115],v[32:33] op_sel_hi:[1,0]
v_pk_mul_f32 v[116:117],v[116:117],v[32:33] op_sel_hi:[1,0]
v_pk_mul_f32 v[118:119],v[118:119],v[32:33] op_sel_hi:[1,0]
v_cvt_pk_bf16_f32 v120,v112,v116
v_cvt_pk_bf16_f32 v121,v113,v117
v_cvt_pk_bf16_f32 v122,v114,v118
v_cvt_pk_bf16_f32 v123,v115,v119
ds_write_b128 v7,v[120:123]
buffer_store_dwordx4 v[24:27],v0,s[8:11],s69 offen sc1
buffer_store_dwordx4 v[24:27],v0,s[8:11],s69 offen offset:1024 sc1
v_mov_b64 v[112:113],0
v_mov_b64 v[114:115],0
v_mov_b64 v[116:117],0
v_mov_b64 v[118:119],0
s_waitcnt lgkmcnt(0)
s_barrier
ds_read_b128 v[24:27],v8 offset:0
ds_read_b128 v[28:31],v8 offset:512
ds_read_b128 v[32:35],v8 offset:1024
ds_read_b128 v[36:39],v8 offset:1536
v_mov_b64 v[120:121],0
v_mov_b64 v[122:123],0
s_add_u32 s57,s65,65536
s_add_u32 s58,s65,131072
s_add_u32 s59,s65,196608
s_add_u32 s56,s18,s75
s_add_u32 s30,s75,17825792
s_waitcnt lgkmcnt(3)
v_smfmac_f32_16x16x64_bf16 v[112:115],v[24:27],v[56:63],v3
ds_read_b128 v[56:59],v11 offset:18432
s_waitcnt lgkmcnt(3)
v_smfmac_f32_16x16x64_bf16 v[112:115],v[28:31],v[64:71],v3
ds_read_b128 v[60:63],v11 offset:19456
s_waitcnt lgkmcnt(3)
v_smfmac_f32_16x16x64_bf16 v[112:115],v[32:35],v[72:79],v3
ds_read_b128 v[64:67],v11 offset:20480
s_waitcnt lgkmcnt(3)
v_smfmac_f32_16x16x64_bf16 v[112:115],v[36:39],v[80:87],v3
ds_read_b128 v[68:71],v11 offset:21504
v_smfmac_f32_16x16x64_bf16 v[116:119],v[24:27],v[96:103],v3
ds_read_b128 v[72:75],v11 offset:22528
v_smfmac_f32_16x16x64_bf16 v[116:119],v[28:31],v[104:111],v3
ds_read_b128 v[76:79],v11 offset:23552
v_cvt_pk_bf16_f32 v112,v112,v113
v_smfmac_f32_16x16x64_bf16 v[116:119],v[32:35],v[40:47],v3
ds_read_b128 v[80:83],v11 offset:24576
v_cvt_pk_bf16_f32 v113,v114,v115
buffer_store_dwordx2 v[112:113],v9,s[8:11],s65 offen sc1
v_smfmac_f32_16x16x64_bf16 v[116:119],v[36:39],v[48:55],v3
ds_read_b128 v[84:87],v11 offset:25600
v_mov_b64 v[112:113],0
v_smfmac_f32_16x16x64_bf16 v[120:123],v[24:27],v[88:95],v3
ds_read_b128 v[96:99],v11 offset:26624
ds_read_b128 v[100:103],v11 offset:27648
v_mov_b64 v[114:115],0
s_waitcnt lgkmcnt(8)
v_smfmac_f32_16x16x64_bf16 v[120:123],v[28:31],v[56:63],v3
ds_read_b128 v[104:107],v11 offset:28672
v_cvt_pk_bf16_f32 v116,v116,v117
s_waitcnt lgkmcnt(7)
v_smfmac_f32_16x16x64_bf16 v[120:123],v[32:35],v[64:71],v3
ds_read_b128 v[108:111],v11 offset:29696
ds_read_b128 v[40:43],v11 offset:30720
v_cvt_pk_bf16_f32 v117,v118,v119
buffer_store_dwordx2 v[116:117],v9,s[8:11],s57 offen sc1
s_waitcnt lgkmcnt(7)
v_smfmac_f32_16x16x64_bf16 v[120:123],v[36:39],v[72:79],v3
ds_read_b128 v[44:47],v11 offset:31744
v_add_u32 v52,s50,v5
s_waitcnt lgkmcnt(6)
v_smfmac_f32_16x16x64_bf16 v[112:115],v[24:27],v[80:87],v3
v_add_u32 v54,s50,v6
s_waitcnt lgkmcnt(4)
v_smfmac_f32_16x16x64_bf16 v[112:115],v[28:31],v[96:103],v3
ds_read_b64_tr_b16 v[52:53],v52
v_cvt_pk_bf16_f32 v120,v120,v121
s_waitcnt lgkmcnt(3)
v_smfmac_f32_16x16x64_bf16 v[112:115],v[32:35],v[104:111],v3
ds_read_b64_tr_b16 v[54:55],v54
v_cvt_pk_bf16_f32 v121,v122,v123
buffer_store_dwordx2 v[120:121],v9,s[8:11],s58 offen sc1
s_waitcnt lgkmcnt(2)
v_smfmac_f32_16x16x64_bf16 v[112:115],v[36:39],v[40:47],v3
v_mov_b64 v[116:117],0
v_mov_b64 v[118:119],0
s_xor_b32 s65,s65,262144
v_mov_b32_dpp v124,v126 quad_perm:[2,3,2,3] row_mask:0xf bank_mask:0xf
v_mov_b32_dpp v125,v127 quad_perm:[2,3,2,3] row_mask:0xf bank_mask:0xf
s_mov_b32 vcc_lo,0xcccccccc
s_mov_b32 vcc_hi,0xcccccccc
s_nop 0
v_cvt_pk_bf16_f32 v112,v112,v113
v_cvt_pk_bf16_f32 v113,v114,v115
buffer_store_dwordx2 v[112:113],v9,s[8:11],s59 offen sc1
s_waitcnt lgkmcnt(0)
s_buffer_load_dword s19,s[8:11],s56
v_cndmask_b32 v124,v124,v52,vcc
v_cndmask_b32 v125,v125,v53,vcc
v_cndmask_b32 v126,v126,v54,vcc
v_cndmask_b32 v127,v127,v55,vcc
s_cmp_lt_u32 s46,2
s_waitcnt vmcnt(3)
s_cbranch_scc1 L_crg_280
s_cmp_eq_u32 s46,2
s_waitcnt vmcnt(1)
s_cbranch_scc1 L_crg_280
s_waitcnt vmcnt(0)
L_crg_280:
buffer_load_dwordx4 v[32:35],v0,s[8:11],s66 offen offset:0 sc1
buffer_load_dwordx4 v[36:39],v0,s[8:11],s66 offen offset:1024 sc1
v_mov_b64 v[96:97],0
v_mov_b64 v[98:99],0
v_mov_b64 v[100:101],0
v_mov_b64 v[102:103],0
v_mov_b64 v[104:105],0
v_mov_b64 v[106:107],0
v_mov_b64 v[108:109],0
v_mov_b64 v[110:111],0
v_mov_b64 v[112:113],0
v_mov_b64 v[114:115],0
v_add_u32 v55,131072,v0
v_add_u32 v123,s73,v55
v_xor_b32 v120,1024,v12
v_xor_b32 v121,2048,v12
v_xor_b32 v122,3072,v12
buffer_load_dwordx4 v[44:47],v0,s[8:11],s66 offen offset:0 sc1
buffer_load_dwordx4 v[48:51],v0,s[8:11],s66 offen offset:1024 sc1
s_cmp_ge_u32 s51,63
s_cselect_b32 s76,0,1
s_cmp_eq_u32 s46,0
s_cselect_b32 s76,s76,0
s_waitcnt vmcnt(3)
v_mfma_f32_16x16x32_bf16 v[28:31],v[18:21],v[32:35],0
s_waitcnt vmcnt(2)
v_mfma_f32_16x16x32_bf16 v[28:31],v[18:21],v[36:39],v[28:31]
s_nop 7
v_cmp_u_f32 vcc,v28,v28
v_add_f32_dpp v52,v28,v28 row_ror:8 row_mask:0xf bank_mask:0x3
v_add_f32_dpp v53,v29,v29 row_ror:8 row_mask:0xf bank_mask:0x3
v_add_f32_dpp v52,v30,v30 row_ror:8 row_mask:0xf bank_mask:0xc
v_add_f32_dpp v53,v31,v31 row_ror:8 row_mask:0xf bank_mask:0xc
s_nop 0
v_add_f32_dpp v52,v52,v52 row_shl:4 row_mask:0xf bank_mask:0x5
v_add_f32_dpp v53,v53,v53 row_shl:4 row_mask:0xf bank_mask:0x5
s_cbranch_vccnz L_crp_275
L_cok_281:
v_cvt_pk_bf16_f32 v54,v52,v53
buffer_store_dword v54,v10,s[8:11],s64 offen sc1
s_mov_b32 s69,s66
s_xor_b32 s66,s66,262144
s_barrier
ds_read_b128 v[56:59],v55 offset:0
ds_read_b128 v[60:63],v55 offset:4096
ds_read_b128 v[64:67],v55 offset:1024
buffer_load_dwordx4 v[24:27],v13,s[8:11],s64 offen sc1
ds_read_b128 v[68:71],v55 offset:5120
ds_read_b128 v[72:75],v55 offset:2048
ds_read_b128 v[76:79],v55 offset:6144
ds_read_b128 v[80:83],v55 offset:3072
buffer_load_dwordx4 v[24:27],v13,s[8:11],s64 offen sc1
ds_read_b128 v[84:87],v55 offset:7168
ds_read_b128 v[88:91],v123 offset:8192
ds_read_b128 v[92:95],v123 offset:9216
s_branch L_chain_270
L_cpb_277:
buffer_load_dwordx4 v[40:43],v13,s[8:11],s70 offen sc1
s_sub_u32 s49,s49,1
s_cbranch_scc1 L_abort2
s_waitcnt vmcnt(0)
v_max3_u32 v123,v40,v41,v42
v_max_u32 v123,v43,v123
v_cmp_le_u32 vcc,s72,v123
s_cbranch_vccnz L_cpb_277
ds_write_b128 v12,v[40:43] offset:4096
s_branch L_cback_279
L_crp_275:
buffer_load_dwordx4 v[32:35],v0,s[8:11],s66 offen offset:0 sc1
buffer_load_dwordx4 v[36:39],v0,s[8:11],s66 offen offset:1024 sc1
s_sub_u32 s49,s49,1
s_cbranch_scc1 L_abort2
s_waitcnt vmcnt(3)
v_mfma_f32_16x16x32_bf16 v[28:31],v[18:21],v[44:47],0
s_waitcnt vmcnt(2)
v_mfma_f32_16x16x32_bf16 v[28:31],v[18:21],v[48:51],v[28:31]
s_nop 7
v_cmp_u_f32 vcc,v28,v28
v_add_f32_dpp v52,v28,v28 row_ror:8 row_mask:0xf bank_mask:0x3
v_add_f32_dpp v53,v29,v29 row_ror:8 row_mask:0xf bank_mask:0x3
v_add_f32_dpp v52,v30,v30 row_ror:8 row_mask:0xf bank_mask:0xc
v_add_f32_dpp v53,v31,v31 row_ror:8 row_mask:0xf bank_mask:0xc
s_nop 0
v_add_f32_dpp v52,v52,v52 row_shl:4 row_mask:0xf bank_mask:0x5
v_add_f32_dpp v53,v53,v53 row_shl:4 row_mask:0xf bank_mask:0x5
s_cbranch_vccz L_cok_281
buffer_load_dwordx4 v[44:47],v0,s[8:11],s66 offen offset:0 sc1
buffer_load_dwordx4 v[48:51],v0,s[8:11],s66 offen offset:1024 sc1
s_sub_u32 s49,s49,1
s_cbranch_scc1 L_abort2
s_waitcnt vmcnt(3)
v_mfma_f32_16x16x32_bf16 v[28:31],v[18:21],v[32:35],0
s_waitcnt vmcnt(2)
v_mfma_f32_16x16x32_bf16 v[28:31],v[18:21],v[36:39],v[28:31]
s_nop 7
v_cmp_u_f32 vcc,v28,v28
v_add_f32_dpp v52,v28,v28 row_ror:8 row_mask:0xf bank_mask:0x3
v_add_f32_dpp v53,v29,v29 row_ror:8 row_mask:0xf bank_mask:0x3
v_add_f32_dpp v52,v30,v30 row_ror:8 row_mask:0xf bank_mask:0xc
v_add_f32_dpp v53,v31,v31 row_ror:8 row_mask:0xf bank_mask:0xc
s_nop 0
v_add_f32_dpp v52,v52,v52 row_shl:4 row_mask:0xf bank_mask:0x5
v_add_f32_dpp v53,v53,v53 row_shl:4 row_mask:0xf bank_mask:0x5
s_cbranch_vccz L_cok_281
s_branch L_crp_275
L_ckw_263:
s_add_u32 s59,s18,s75
L_ww_282:
s_sleep 1
buffer_load_dword v23,off,s[8:11],s59 sc1
s_sub_u32 s49,s49,1
s_cbranch_scc1 L_abort2
s_waitcnt vmcnt(0)
v_readfirstlane_b32 s76,v23
s_cmp_eq_u32 s76,0
s_cbranch_scc1 L_ww_282
L_wwd_283:
s_branch L_ckb_264
L_cend_273:
v_smfmac_f32_16x16x64_bf16 v[116:119],v[36:39],v[184:191],v2
v_smfmac_f32_16x16x64_bf16 v[112:115],v[40:43],v[192:199],v2
v_smfmac_f32_16x16x64_bf16 v[116:119],v[40:43],v[200:207],v2
v_smfmac_f32_16x16x64_bf16 v[112:115],v[44:47],v[208:215],v2
v_smfmac_f32_16x16x64_bf16 v[116:119],v[44:47],v[216:223],v2
v_smfmac_f32_16x16x64_bf16 v[112:115],v[48:51],v[224:231],v2
v_smfmac_f32_16x16x64_bf16 v[116:119],v[48:51],v[232:239],v2
v_smfmac_f32_16x16x64_bf16 v[112:115],v[52:55],v[240:247],v2
v_smfmac_f32_16x16x64_bf16 v[116:119],v[52:55],v[248:255],v2
s_waitcnt lgkmcnt(0)
s_nop 2
v_pk_add_f32 v[112:113],v[112:113],v[114:115]
s_nop 2
v_pk_add_f32 v[116:117],v[116:117],v[118:119]
v_cvt_pk_bf16_f32 v126,v112,v113
v_cvt_pk_bf16_f32 v127,v116,v117
v_add_u32 v52,s50,v5
v_add_u32 v54,s50,v6
ds_read_b64_tr_b16 v[52:53],v52
ds_read_b64_tr_b16 v[54:55],v54
v_mov_b32_dpp v124,v126 quad_perm:[2,3,2,3] row_mask:0xf bank_mask:0xf
v_mov_b32_dpp v125,v127 quad_perm:[2,3,2,3] row_mask:0xf bank_mask:0xf
s_mov_b32 vcc_lo,0xcccccccc
s_mov_b32 vcc_hi,0xcccccccc
s_waitcnt lgkmcnt(0)
v_cndmask_b32 v124,v124,v52,vcc
v_cndmask_b32 v125,v125,v53,vcc
v_cndmask_b32 v126,v126,v54,vcc
v_cndmask_b32 v127,v127,v55,vcc
buffer_store_dwordx4 v[124:127],v0,s[8:11],s54 offen sc1
s_mov_b32 s51,64
s_waitcnt vmcnt(0)
s_barrier
s_nop 11
v_lshrrev_b32 v1,4,v0
s_endpgm
L_rc2_233:
v_and_b32 v120,15,v1
v_lshrrev_b32 v121,4,v1
v_and_b32 v122,2,v1
v_cmp_eq_u32 vcc,0,v122
v_mov_b32 v2,0xeeee
v_mov_b32 v123,0x4444
v_cndmask_b32 v2,v2,v123,vcc
v_and_b32 v122,1,v1
v_cmp_eq_u32 vcc,0,v122
v_mov_b32 v3,0xdddd
v_mov_b32 v123,0x8888
v_cndmask_b32 v3,v3,v123,vcc
v_lshrrev_b32 v122,1,v120
v_bfe_u32 v123,v120,2,1
v_xor_b32 v123,v123,v122
v_lshlrev_b32 v4,7,v123
v_and_b32 v123,1,v120
v_lshl_add_u32 v4,v123,6,v4
v_xor_b32 v123,v121,v122
v_and_b32 v123,3,v123
v_lshl_add_u32 v4,v123,4,v4
s_lshl_b32 s56,s46,10
s_add_u32 s56,s56,147456
v_add_u32 v4,s56,v4
v_lshlrev_b32 v122,1,v121
v_add_u32 v122,0,v122
v_and_b32 v123,1,v121
v_xor_b32 v123,v123,v122
v_lshlrev_b32 v5,7,v123
v_bfe_u32 v123,v120,3,1
v_lshl_add_u32 v5,v123,6,v5
v_xor_b32 v123,v120,v122
v_and_b32 v123,3,v123
v_lshl_add_u32 v5,v123,4,v5
v_bfe_u32 v123,v120,2,1
v_lshl_add_u32 v5,v123,3,v5
v_add_u32 v5,147456,v5
v_lshlrev_b32 v122,1,v121
v_add_u32 v122,1,v122
v_and_b32 v123,1,v121
v_xor_b32 v123,v123,v122
v_lshlrev_b32 v6,7,v123
v_bfe_u32 v123,v120,3,1
v_lshl_add_u32 v6,v123,6,v6
v_xor_b32 v123,v120,v122
v_and_b32 v123,3,v123
v_lshl_add_u32 v6,v123,4,v6
v_bfe_u32 v123,v120,2,1
v_lshl_add_u32 v6,v123,3,v6
v_add_u32 v6,147456,v6
v_lshlrev_b32 v7,7,v121
v_lshrrev_b32 v122,1,v120
v_lshl_add_u32 v8,v122,4,v7
v_add_u32 v8,151552,v8
v_lshrrev_b32 v122,2,v120
v_lshl_add_u32 v7,v122,5,v7
v_and_b32 v122,1,v120
v_lshl_add_u32 v7,v122,4,v7
v_and_b32 v122,2,v120
v_cmp_eq_u32 vcc,0,v122
s_lshl_b32 s56,s46,9
v_mov_b32 v122,2048
v_mov_b32 v123,s56
v_cndmask_b32 v122,v122,v123,vcc
v_add_u32 v7,v122,v7
v_add_u32 v7,151552,v7
v_lshrrev_b32 v122,3,v1
v_lshlrev_b32 v9,11,v122
v_and_b32 v122,7,v1
v_lshl_add_u32 v9,v122,3,v9
s_lshl_b32 s56,s46,14
s_lshl_b32 s57,s47,6
s_add_u32 s56,s56,s57
v_add_u32 v9,s56,v9
s_lshl_b32 s71,s46,5
s_add_u32 s71,s71,s47
s_bfe_u32 s56,s71,0x10003
s_lshl_b32 s56,s56,11
s_and_b32 s57,s71,1
s_lshl_b32 s57,s57,10
s_add_u32 s56,s56,s57
s_bfe_u32 s57,s71,0x10002
s_lshl_b32 s57,s57,9
s_add_u32 s56,s56,s57
s_bfe_u32 s57,s71,0x10001
s_lshl_b32 s57,s57,6
s_add_u32 s56,s56,s57
s_bfe_u32 s57,s71,0x10004
s_lshl_b32 s57,s57,8
s_add_u32 s56,s56,s57
s_bfe_u32 s57,s71,0x10005
s_lshl_b32 s57,s57,7
s_add_u32 s56,s56,s57
s_bfe_u32 s57,s71,0x10006
s_lshl_b32 s57,s57,12
s_add_u32 s56,s56,s57
v_and_b32 v122,3,v120
v_lshlrev_b32 v10,2,v122
v_bfe_u32 v122,v120,3,1
v_lshl_add_u32 v10,v122,4,v10
v_and_b32 v122,1,v121
v_lshl_add_u32 v10,v122,5,v10
v_add_u32 v10,s56,v10
v_and_b32 v123,36,v1
v_mov_b32 v122,0x80000000
v_cmp_eq_u32 vcc,0,v123
s_nop 1
v_cndmask_b32 v10,v122,v10,vcc
s_lshl_b32 s71,s71,11
s_lshl_b32 s73,s46,11
s_mov_b32 s72,0xffc00000
s_mov_b32 s74,0
v_and_b32 v11,1,v121
v_xor_b32 v11,v11,v120
v_and_b32 v11,3,v11
v_lshrrev_b32 v122,2,v120
v_lshl_add_u32 v11,v11,2,v122
v_lshl_add_u32 v11,v121,4,v11
v_lshlrev_b32 v11,4,v11
s_lshl_b32 s56,s46,15
v_add_u32 v11,s56,v11
v_lshrrev_b32 v13,3,v1
v_lshlrev_b32 v13,9,v13
v_and_b32 v122,7,v1
v_lshl_add_u32 v13,v122,4,v13
v_and_b32 v122,15,v1
v_and_b32 v123,1,v1
v_lshlrev_b32 v123,4,v123
v_mov_b32 v124,0x3f80
v_lshlrev_b32 v124,v123,v124
v_lshrrev_b32 v122,1,v122
v_cmp_eq_u32 vcc,0,v122
s_nop 1
v_cndmask_b32 v18,0,v124,vcc
v_cmp_eq_u32 vcc,1,v122
s_nop 1
v_cndmask_b32 v19,0,v124,vcc
v_cmp_eq_u32 vcc,2,v122
s_nop 1
v_cndmask_b32 v20,0,v124,vcc
v_cmp_eq_u32 vcc,3,v122
s_nop 1
v_cndmask_b32 v21,0,v124,vcc
s_and_b32 s56,s46,1
s_lshl_b32 s56,s56,8
s_and_b32 s57,s46,2
s_lshl_b32 s57,s57,6
s_add_u32 s56,s56,s57
v_add_u32 v13,s56,v13
s_add_u32 s56,s50,155648
v_add_u32 v12,s56,v0
v_mov_b64 v[14:15],s[28:29]
v_mov_b64 v[16:17],s[28:29]
v_add_u32 v22,13647872,v10
s_lshl_b32 s18,s47,2
s_add_u32 s18,s18,10494080
v_mov_b32 v1,s80
s_mov_b32 s65,16777216
s_add_u32 s66,s71,16777216
s_add_u32 s69,s71,17039360
s_mov_b32 s30,0x40000000
s_mov_b32 s51,0
v_lshrrev_b32 v120,2,v0
v_add_u32 v120,10510464,v120
v_or_b32 v120,s52,v120
s_mov_b64 vcc,-1
s_mov_b32 vcc_lo,0
v_cndmask_b32 v22,v22,v120,vcc
s_or_b32 s56,s52,10495616
v_writelane_b32 v22,s56,4
s_or_b32 s56,s47,s46
s_mov_b32 s56,10486784
s_cmov_b32 s56,0x80000000
v_writelane_b32 v22,s56,5
s_mov_b32 s30,0
s_mov_b32 s31,0
L_cst_287:
s_cmp_lg_u32 s46,0
s_cbranch_scc1 L_csw_292
s_andn2_b32 s61,0x7ff,s30
s_lshr_b32 s61,s61,5
s_add_u32 s61,s61,2
s_add_u32 s60,s31,1
s_min_u32 s60,s60,63
s_cmp_gt_u32 s60,s61
s_cselect_b32 s60,s31,s60
s_sub_u32 s61,s60,s31
s_lshl_b32 s61,s61,13
s_lshl_b32 s59,s31,13
s_add_u32 s59,s59,10486016
v_lshrrev_b32 v121,2,v0
v_and_b32 v121,127,v121
v_lshrrev_b32 v120,9,v0
v_mul_u32_u24 v120,s61,v120
v_add_u32 v121,v120,v121
L_ckk_293:
s_sleep 1
buffer_load_dword v120,v121,s[8:11],s59 offen sc1
s_sub_u32 s49,s49,1
s_cbranch_scc1 L_abort2
s_waitcnt vmcnt(0)
v_cmp_eq_u32 vcc,0,v120
s_cbranch_vccnz L_ckk_293
v_max_u32_dpp v120,v120,v120 row_ror:8 row_mask:0xf bank_mask:0xf
s_nop 1
v_max_u32_dpp v120,v120,v120 row_ror:4 row_mask:0xf bank_mask:0xf
s_nop 1
v_max_u32_dpp v120,v120,v120 row_ror:2 row_mask:0xf bank_mask:0xf
s_nop 1
v_max_u32_dpp v120,v120,v120 row_ror:1 row_mask:0xf bank_mask:0xf
v_mov_b32 v121,v120
s_nop 1
v_permlane16_swap_b32 v120,v121
v_max_u32 v120,v120,v121
v_mov_b32 v121,v120
s_nop 1
v_permlane32_swap_b32 v120,v121
v_max_u32 v120,v120,v121
s_nop 0
v_readfirstlane_b32 s61,v120
s_max_u32 s30,s30,s61
s_add_u32 s31,s60,1
s_andn2_b32 s51,0x7ff,s30
s_lshr_b32 s51,s51,5
s_add_u32 s61,s51,2
s_min_u32 s61,s61,63
s_cmp_le_u32 s31,s61
s_cbranch_scc1 L_cst_287
v_mov_b32 v120,0
v_mov_b32 v121,s30
ds_write_b32 v8,v120 offset:2560
ds_write_b32 v8,v121 offset:3072
s_lshl_b32 s59,s51,13
s_lshl2_add_u32 s59,s47,s59
s_add_u32 s59,s59,10485888
L_ww_294:
s_sleep 1
buffer_load_dword v122,off,s[8:11],s59 sc1
s_sub_u32 s49,s49,1
s_cbranch_scc1 L_abort2
s_waitcnt vmcnt(0)
v_readfirstlane_b32 s61,v122
s_cmp_eq_u32 s61,0
s_cbranch_scc1 L_ww_294
L_wwd_295:
L_csw_292:
s_waitcnt lgkmcnt(0)
s_barrier
ds_read_b32 v120,v8 offset:3072
s_waitcnt lgkmcnt(0)
v_readfirstlane_b32 s30,v120
s_andn2_b32 s51,0x7ff,s30
s_lshr_b32 s51,s51,5
s_lshl_b32 s56,s51,5
s_add_u32 s56,s56,s47
s_mul_i32 s56,s56,24576
s_add_u32 s56,s56,150994944
s_add_u32 s67,s56,s73
s_add_u32 m0,s73,131072
s_add_u32 s57,s67,8192
buffer_load_dwordx4 v0,s[8:11],s67 offen sc1 lds
buffer_load_dwordx4 v0,s[8:11],s67 offen offset:1024 sc1 lds
s_add_u32 m0,s73,139264
s_add_u32 s67,s67,786432
buffer_load_dwordx4 v0,s[8:11],s57 offen sc1 lds
buffer_load_dwordx4 v0,s[8:11],s57 offen offset:1024 sc1 lds
s_lshl_b32 s75,s51,13
s_add_u32 s56,s75,13639680
buffer_load_dword v23,v10,s[8:11],s56 offen sc1
s_add_u32 s64,s75,17825792
s_add_u32 s70,s64,4096
s_lshl_b32 s68,s51,5
s_add_u32 s68,s68,s47
s_lshl_b32 s68,s68,12
s_lshl_b32 s56,s46,10
s_add_u32 s68,s68,s56
s_add_u32 s68,s68,75497472
s_mov_b32 s54,0x80000000
s_mov_b32 s77,0
s_add_u32 s56,s18,s75
s_buffer_load_dword s19,s[8:11],s56
s_cmp_eq_u32 s51,63
s_cselect_b32 s76,1,s46
s_cmp_eq_u32 s76,0
s_cselect_b32 s76,1,0
v_mov_b64 v[96:97],0
v_mov_b64 v[98:99],0
v_mov_b64 v[100:101],0
v_mov_b64 v[102:103],0
v_mov_b64 v[104:105],0
v_mov_b64 v[106:107],0
v_mov_b64 v[108:109],0
v_mov_b64 v[110:111],0
v_mov_b64 v[112:113],0
v_mov_b64 v[114:115],0
v_mov_b64 v[116:117],0
v_mov_b64 v[118:119],0
v_lshrrev_b32 v56,8,v0
v_lshlrev_b32 v56,5,v56
v_bfe_u32 v57,v0,5,1
v_lshl_add_u32 v56,v57,2,v56
s_lshl_b32 s56,s46,7
s_add_u32 s56,s56,155648
v_add_u32 v56,s56,v56
v_xor_b32 v57,128,v56
v_xor_b32 v58,256,v56
v_xor_b32 v59,384,v56
s_andn2_b32 s56,31,s30
s_lshr_b32 s57,s56,4
s_lshl_b32 s58,s57,12
s_and_b32 s59,s56,15
s_lshl4_add_u32 s58,s59,s58
s_add_u32 s58,s58,s50
s_add_u32 s58,s58,131072
v_bfe_u32 v60,v0,6,2
v_lshlrev_b32 v60,8,v60
v_bfe_u32 v61,v0,4,2
v_lshl_add_u32 v60,v61,2,v60
v_add_u32 v60,s58,v60
s_lshr_b32 s58,s59,2
s_lshl_b32 s58,s58,8
s_lshl3_add_u32 s58,s57,s58
s_and_b32 s59,s56,3
s_lshl1_add_u32 s58,s59,s58
s_add_u32 s58,s58,s73
s_add_u32 s58,s58,139264
v_and_b32 v61,255,v0
v_add_u32 v61,s58,v61
s_cmp_lg_u32 s46,0
s_cbranch_scc1 L_chd_297
s_lshl_b32 s59,s51,10
s_add_u32 s59,s59,11337728
L_chp_296:
buffer_load_dwordx4 v[120:123],v0,s[8:11],s59 offen sc1
s_sub_u32 s49,s49,1
s_cbranch_scc1 L_abort2
s_waitcnt vmcnt(0)
v_max3_u32 v124,v120,v121,v122
v_max_u32 v124,v123,v124
v_cmp_eq_u32 vcc,-1,v124
s_cbranch_vccnz L_chp_296
ds_write_b128 v12,v[120:123]
L_chd_297:
s_waitcnt vmcnt(0) lgkmcnt(0)
s_barrier
ds_read2_b32 v[24:25],v56 offset0:0 offset1:2
ds_read2_b32 v[26:27],v56 offset0:4 offset1:6
ds_read2_b32 v[28:29],v57 offset0:0 offset1:2
ds_read2_b32 v[30:31],v57 offset0:4 offset1:6
ds_read2_b32 v[32:33],v58 offset0:0 offset1:2
ds_read2_b32 v[34:35],v58 offset0:4 offset1:6
ds_read2_b32 v[36:37],v59 offset0:0 offset1:2
ds_read2_b32 v[38:39],v59 offset0:4 offset1:6
s_waitcnt lgkmcnt(4)
ds_read2_b32 v[40:41],v56 offset0:128 offset1:130
ds_read2_b32 v[42:43],v56 offset0:132 offset1:134
ds_read2_b32 v[44:45],v57 offset0:128 offset1:130
ds_read2_b32 v[46:47],v57 offset0:132 offset1:134
ds_read2_b32 v[48:49],v58 offset0:128 offset1:130
ds_read2_b32 v[50:51],v58 offset0:132 offset1:134
ds_read2_b32 v[52:53],v59 offset0:128 offset1:130
ds_read2_b32 v[54:55],v59 offset0:132 offset1:134
s_waitcnt lgkmcnt(12)
v_smfmac_f32_16x16x64_bf16 v[100:103],v[24:27],a[128:135],v2
v_smfmac_f32_16x16x64_bf16 v[112:115],v[24:27],v[128:135],v2
v_smfmac_f32_16x16x64_bf16 v[108:111],v[24:27],a[136:143],v2
v_smfmac_f32_16x16x64_bf16 v[116:119],v[24:27],v[136:143],v2
s_waitcnt lgkmcnt(12)
v_smfmac_f32_16x16x64_bf16 v[100:103],v[28:31],a[144:151],v2
v_smfmac_f32_16x16x64_bf16 v[112:115],v[28:31],v[144:151],v2
v_smfmac_f32_16x16x64_bf16 v[108:111],v[28:31],a[152:159],v2
v_smfmac_f32_16x16x64_bf16 v[116:119],v[28:31],v[152:159],v2
s_waitcnt lgkmcnt(10)
v_smfmac_f32_16x16x64_bf16 v[100:103],v[32:35],a[160:167],v2
v_smfmac_f32_16x16x64_bf16 v[112:115],v[32:35],v[160:167],v2
v_smfmac_f32_16x16x64_bf16 v[108:111],v[32:35],a[168:175],v2
v_smfmac_f32_16x16x64_bf16 v[116:119],v[32:35],v[168:175],v2
s_waitcnt lgkmcnt(8)
v_smfmac_f32_16x16x64_bf16 v[100:103],v[36:39],a[176:183],v2
v_smfmac_f32_16x16x64_bf16 v[112:115],v[36:39],v[176:183],v2
v_smfmac_f32_16x16x64_bf16 v[108:111],v[36:39],a[184:191],v2
v_smfmac_f32_16x16x64_bf16 v[116:119],v[36:39],v[184:191],v2
s_waitcnt lgkmcnt(6)
v_smfmac_f32_16x16x64_bf16 v[100:103],v[40:43],a[192:199],v2
v_smfmac_f32_16x16x64_bf16 v[112:115],v[40:43],v[192:199],v2
v_smfmac_f32_16x16x64_bf16 v[108:111],v[40:43],a[200:207],v2
v_smfmac_f32_16x16x64_bf16 v[116:119],v[40:43],v[200:207],v2
s_waitcnt lgkmcnt(4)
v_smfmac_f32_16x16x64_bf16 v[100:103],v[44:47],a[208:215],v2
v_smfmac_f32_16x16x64_bf16 v[112:115],v[44:47],v[208:215],v2
v_smfmac_f32_16x16x64_bf16 v[108:111],v[44:47],a[216:223],v2
v_smfmac_f32_16x16x64_bf16 v[116:119],v[44:47],v[216:223],v2
s_waitcnt lgkmcnt(2)
v_smfmac_f32_16x16x64_bf16 v[100:103],v[48:51],a[224:231],v2
v_smfmac_f32_16x16x64_bf16 v[112:115],v[48:51],v[224:231],v2
v_smfmac_f32_16x16x64_bf16 v[108:111],v[48:51],a[232:239],v2
v_smfmac_f32_16x16x64_bf16 v[116:119],v[48:51],v[232:239],v2
s_waitcnt lgkmcnt(0)
v_smfmac_f32_16x16x64_bf16 v[100:103],v[52:55],a[240:247],v2
v_smfmac_f32_16x16x64_bf16 v[112:115],v[52:55],v[240:247],v2
v_smfmac_f32_16x16x64_bf16 v[108:111],v[52:55],a[248:255],v2
v_smfmac_f32_16x16x64_bf16 v[116:119],v[52:55],v[248:255],v2
v_add_f32 v100,v100,v102
v_add_f32 v112,v112,v114
s_nop 1
v_add_f32 v108,v108,v110
s_nop 2
v_add_f32 v116,v116,v118
v_cvt_pk_bf16_f32 v120,v100,v108
v_cvt_pk_bf16_f32 v121,v112,v116
ds_write_b32 v60,v120
ds_write_b16 v61,v121
ds_write_b16_d16_hi v61,v121 offset:1024
v_mov_b64 v[96:97],0
v_mov_b64 v[98:99],0
v_mov_b64 v[100:101],0
v_mov_b64 v[102:103],0
v_mov_b64 v[104:105],0
v_mov_b64 v[106:107],0
v_mov_b64 v[108:109],0
v_mov_b64 v[110:111],0
v_mov_b64 v[112:113],0
v_mov_b64 v[114:115],0
v_mov_b64 v[116:117],0
v_mov_b64 v[118:119],0
s_waitcnt vmcnt(0) lgkmcnt(0)
s_barrier
v_add_u32 v55,131072,v0
ds_read_b128 v[56:59],v55 offset:0
ds_read_b128 v[60:63],v55 offset:4096
ds_read_b128 v[64:67],v55 offset:1024
ds_read_b128 v[68:71],v55 offset:5120
ds_read_b128 v[72:75],v55 offset:2048
ds_read_b128 v[76:79],v55 offset:6144
ds_read_b128 v[80:83],v55 offset:3072
ds_read_b128 v[84:87],v55 offset:7168
v_add_u32 v123,s73,v55
ds_read_b128 v[88:91],v123 offset:8192
ds_read_b128 v[92:95],v123 offset:9216
v_xor_b32 v120,1024,v12
v_xor_b32 v121,2048,v12
v_xor_b32 v122,3072,v12
buffer_load_dwordx4 v[24:27],v13,s[8:11],s64 offen sc1
buffer_load_dwordx4 v[24:27],v13,s[8:11],s64 offen sc1
L_chain_298:
L_cpa_299:
buffer_load_dwordx4 v[24:27],v13,s[8:11],s64 offen sc1
s_sub_u32 s49,s49,1
s_cbranch_scc1 L_abort2
s_waitcnt vmcnt(2)
v_max3_u32 v123,v24,v25,v26
v_max_u32 v123,v27,v123
v_cmp_le_u32 vcc,s72,v123
ds_write_b128 v12,v[24:27] offset:0
s_cbranch_vccnz L_cpa_299
L_cgo_302:
v_smfmac_f32_16x16x64_bf16 v[96:99],v[24:27],a[0:7],v2
buffer_load_dwordx4 v[40:43],v13,s[8:11],s70 offen sc1
v_smfmac_f32_16x16x64_bf16 v[100:103],v[24:27],a[128:135],v2
s_waitcnt lgkmcnt(0)
s_barrier
ds_read_b128 v[28:31],v120 offset:0
v_smfmac_f32_16x16x64_bf16 v[104:107],v[24:27],a[8:15],v2
ds_read_b128 v[32:35],v121 offset:0
v_smfmac_f32_16x16x64_bf16 v[108:111],v[24:27],a[136:143],v2
ds_read_b128 v[36:39],v122 offset:0
v_smfmac_f32_16x16x64_bf16 v[112:115],v[24:27],v[128:135],v2
v_smfmac_f32_16x16x64_bf16 v[116:119],v[24:27],v[136:143],v2
s_waitcnt lgkmcnt(2)
v_smfmac_f32_16x16x64_bf16 v[96:99],v[28:31],a[16:23],v2
s_add_u32 m0,s73,131072
v_smfmac_f32_16x16x64_bf16 v[100:103],v[28:31],a[144:151],v2
s_add_u32 s57,s67,8192
v_smfmac_f32_16x16x64_bf16 v[104:107],v[28:31],a[24:31],v2
s_cmp_lt_u32 s19,s76
s_cbranch_scc1 L_ckw_288
L_ckb_289:
v_smfmac_f32_16x16x64_bf16 v[108:111],v[28:31],a[152:159],v2
s_waitcnt vmcnt(0) lgkmcnt(1)
v_smfmac_f32_16x16x64_bf16 v[96:99],v[32:35],a[32:39],v2
ds_write_b128 v12,v[40:43] offset:4096
v_max3_u32 v123,v40,v41,v42
v_smfmac_f32_16x16x64_bf16 v[100:103],v[32:35],a[160:167],v2
v_max_u32 v123,v43,v123
v_smfmac_f32_16x16x64_bf16 v[104:107],v[32:35],a[40:47],v2
v_cmp_le_u32 vcc,s72,v123
v_smfmac_f32_16x16x64_bf16 v[108:111],v[32:35],a[168:175],v2
v_smfmac_f32_16x16x64_bf16 v[112:115],v[28:31],v[144:151],v2
s_cbranch_vccnz L_cpb_305
L_cback_307:
s_waitcnt lgkmcnt(0)
s_barrier
v_smfmac_f32_16x16x64_bf16 v[96:99],v[36:39],a[48:55],v2
buffer_store_dwordx4 v[124:127],v0,s[8:11],s54 offen sc1
v_smfmac_f32_16x16x64_bf16 v[100:103],v[36:39],a[176:183],v2
ds_read_b128 v[44:47],v120 offset:4096
v_smfmac_f32_16x16x64_bf16 v[104:107],v[36:39],a[56:63],v2
buffer_load_dwordx4 v0,s[8:11],s67 offen sc1 lds
v_smfmac_f32_16x16x64_bf16 v[108:111],v[36:39],a[184:191],v2
ds_read_b128 v[48:51],v121 offset:4096
v_smfmac_f32_16x16x64_bf16 v[96:99],v[40:43],a[64:71],v2
buffer_load_dwordx4 v0,s[8:11],s67 offen offset:1024 sc1 lds
s_add_u32 m0,s73,139264
v_smfmac_f32_16x16x64_bf16 v[100:103],v[40:43],a[192:199],v2
ds_read_b128 v[52:55],v122 offset:4096
v_smfmac_f32_16x16x64_bf16 v[104:107],v[40:43],a[72:79],v2
buffer_load_dwordx4 v0,s[8:11],s57 offen sc1 lds
s_add_u32 s67,s67,786432
v_smfmac_f32_16x16x64_bf16 v[108:111],v[40:43],a[200:207],v2
ds_read_b32 v123,v8 offset:2560
s_waitcnt lgkmcnt(3)
v_smfmac_f32_16x16x64_bf16 v[96:99],v[44:47],a[80:87],v2
buffer_load_dwordx4 v0,s[8:11],s57 offen offset:1024 sc1 lds
v_smfmac_f32_16x16x64_bf16 v[100:103],v[44:47],a[208:215],v2
s_waitcnt lgkmcnt(2)
v_smfmac_f32_16x16x64_bf16 v[96:99],v[48:51],a[96:103],v2
buffer_load_dword v23,v22,s[8:11],s75 offen sc1
v_smfmac_f32_16x16x64_bf16 v[100:103],v[48:51],a[224:231],v2
s_waitcnt lgkmcnt(0)
v_smfmac_f32_16x16x64_bf16 v[96:99],v[52:55],a[112:119],v2
v_smfmac_f32_16x16x64_bf16 v[100:103],v[52:55],a[240:247],v2
v_readfirstlane_b32 s58,v123
v_smfmac_f32_16x16x64_bf16 v[104:107],v[44:47],a[88:95],v2
v_smfmac_f32_16x16x64_bf16 v[108:111],v[44:47],a[216:223],v2
s_cmp_lg_u32 s58,0
s_cbranch_scc1 L_cjump_291
v_smfmac_f32_16x16x64_bf16 v[104:107],v[48:51],a[104:111],v2
v_add_f32 v96,v96,v98
v_smfmac_f32_16x16x64_bf16 v[108:111],v[48:51],a[232:239],v2
v_add_f32 v97,v97,v99
v_smfmac_f32_16x16x64_bf16 v[104:107],v[52:55],a[120:127],v2
v_cvt_pk_bf16_f32 v120,v96,v97
v_smfmac_f32_16x16x64_bf16 v[108:111],v[52:55],a[248:255],v2
v_add_f32 v100,v100,v102
v_smfmac_f32_16x16x64_bf16 v[116:119],v[28:31],v[152:159],v2
v_add_f32 v101,v101,v103
v_smfmac_f32_16x16x64_bf16 v[112:115],v[32:35],v[160:167],v2
v_cvt_pk_bf16_f32 v121,v100,v101
v_add_f32 v104,v104,v106
v_add_f32 v105,v105,v107
v_cvt_pk_bf16_f32 v122,v104,v105
v_add_f32 v108,v108,v110
v_add_f32 v109,v109,v111
v_cvt_pk_bf16_f32 v123,v108,v109
ds_write_b128 v4,v[120:123]
v_smfmac_f32_16x16x64_bf16 v[116:119],v[32:35],v[168:175],v2
s_mov_b32 s54,s68
s_add_u32 s68,s68,131072
v_mov_b32 v125,0
v_smfmac_f32_16x16x64_bf16 v[112:115],v[36:39],v[176:183],v2
s_cmp_eq_u32 s51,63
s_cbranch_scc1 L_cend_301
v_smfmac_f32_16x16x64_bf16 v[116:119],v[36:39],v[184:191],v2
v_smfmac_f32_16x16x64_bf16 v[112:115],v[40:43],v[192:199],v2
s_waitcnt lgkmcnt(0)
s_barrier
ds_read_b64_tr_b16 v[96:97],v5 offset:0
ds_read_b64_tr_b16 v[98:99],v6 offset:0
v_smfmac_f32_16x16x64_bf16 v[116:119],v[40:43],v[200:207],v2
ds_read_b64_tr_b16 v[100:101],v5 offset:1024
v_smfmac_f32_16x16x64_bf16 v[112:115],v[44:47],v[208:215],v2
ds_read_b64_tr_b16 v[102:103],v6 offset:1024
v_smfmac_f32_16x16x64_bf16 v[116:119],v[44:47],v[216:223],v2
ds_read_b64_tr_b16 v[104:105],v5 offset:2048
v_smfmac_f32_16x16x64_bf16 v[112:115],v[48:51],v[224:231],v2
ds_read_b64_tr_b16 v[106:107],v6 offset:2048
s_waitcnt lgkmcnt(4)
v_mfma_f32_16x16x32_bf16 v[24:27],v[56:59],v[96:99],0
ds_read_b64_tr_b16 v[108:109],v5 offset:3072
v_mfma_f32_16x16x32_bf16 v[28:31],v[60:63],v[96:99],0
ds_read_b64_tr_b16 v[110:111],v6 offset:3072
v_mfma_f32_16x16x32_bf16 v[32:35],v[96:99],v[96:99],0
ds_read_b128 v[40:43],v11 offset:12288
s_waitcnt lgkmcnt(5)
v_mfma_f32_16x16x32_bf16 v[24:27],v[64:67],v[100:103],v[24:27]
ds_read_b128 v[56:59],v11 offset:0
v_mfma_f32_16x16x32_bf16 v[28:31],v[68:71],v[100:103],v[28:31]
ds_read_b128 v[60:63],v11 offset:1024
v_mfma_f32_16x16x32_bf16 v[32:35],v[100:103],v[100:103],v[32:35]
ds_read_b128 v[96:99],v11 offset:8192
s_waitcnt lgkmcnt(6)
v_mfma_f32_16x16x32_bf16 v[24:27],v[72:75],v[104:107],v[24:27]
ds_read_b128 v[64:67],v11 offset:2048
v_mfma_f32_16x16x32_bf16 v[28:31],v[76:79],v[104:107],v[28:31]
ds_read_b128 v[68:71],v11 offset:3072
v_mfma_f32_16x16x32_bf16 v[32:35],v[104:107],v[104:107],v[32:35]
ds_read_b128 v[100:103],v11 offset:9216
s_waitcnt lgkmcnt(7)
v_mfma_f32_16x16x32_bf16 v[24:27],v[80:83],v[108:111],v[24:27]
ds_read_b128 v[72:75],v11 offset:4096
v_mfma_f32_16x16x32_bf16 v[28:31],v[84:87],v[108:111],v[28:31]
ds_read_b128 v[76:79],v11 offset:5120
v_mfma_f32_16x16x32_bf16 v[32:35],v[108:111],v[108:111],v[32:35]
ds_read_b128 v[104:107],v11 offset:10240
v_smfmac_f32_16x16x64_bf16 v[116:119],v[48:51],v[232:239],v2
ds_read_b128 v[80:83],v11 offset:6144
v_smfmac_f32_16x16x64_bf16 v[112:115],v[52:55],v[240:247],v2
ds_read_b128 v[84:87],v11 offset:7168
v_smfmac_f32_16x16x64_bf16 v[116:119],v[52:55],v[248:255],v2
ds_read_b128 v[108:111],v11 offset:11264
v_max3_f32 v126,v24,v25,v26
v_max3_f32 v127,v27,v28,v29
v_max3_f32 v126,v30,v31,v126
v_max3_f32 v127,v34,v35,v127
v_max_f32 v126,v126,v127
v_max_f32 v127,v126,v127
v_pk_mul_f32 v[34:35],v[34:35],v[0:1] op_sel:[0,1]
v_pk_mul_f32 v[24:25],v[24:25],v[0:1] op_sel:[0,1]
v_permlane16_swap_b32 v126,v127
v_max_f32 v126,v126,v127
v_max_f32 v127,v126,v127
v_pk_mul_f32 v[26:27],v[26:27],v[0:1] op_sel:[0,1]
v_pk_mul_f32 v[28:29],v[28:29],v[0:1] op_sel:[0,1]
v_permlane32_swap_b32 v126,v127
v_max_f32 v126,v126,v127
v_mul_f32 v126,v1,v126
v_pk_mul_f32 v[30:31],v[30:31],v[0:1] op_sel:[0,1]
v_pk_add_f32 v[34:35],v[34:35],v[126:127] op_sel_hi:[1,0] neg_lo:[0,1] neg_hi:[0,1]
v_pk_add_f32 v[112:113],v[112:113],v[114:115]
v_pk_add_f32 v[116:117],v[116:117],v[118:119]
v_pk_add_f32 v[24:25],v[24:25],v[126:127] op_sel_hi:[1,0] neg_lo:[0,1] neg_hi:[0,1]
v_pk_add_f32 v[26:27],v[26:27],v[126:127] op_sel_hi:[1,0] neg_lo:[0,1] neg_hi:[0,1]
v_pk_add_f32 v[28:29],v[28:29],v[126:127] op_sel_hi:[1,0] neg_lo:[0,1] neg_hi:[0,1]
v_pk_add_f32 v[30:31],v[30:31],v[126:127] op_sel_hi:[1,0] neg_lo:[0,1] neg_hi:[0,1]
v_exp_f32 v34,v34
v_exp_f32 v35,v35
v_cvt_pk_bf16_f32 v126,v112,v113
v_cvt_pk_bf16_f32 v124,v34,v35
v_cvt_pk_bf16_f32 v127,v116,v117
v_cvt_pk_bf16_f32 v36,v116,v117
v_mfma_f32_16x16x16_bf16 v[32:35],v[14:15],v[124:125],0
ds_read_b128 v[44:47],v11 offset:13312
v_exp_f32 v24,v24
v_mfma_f32_16x16x16_bf16 v[112:115],v[126:127],v[124:125],0
ds_read_b128 v[48:51],v11 offset:14336
v_exp_f32 v25,v25
v_mfma_f32_16x16x16_bf16 v[116:119],v[36:37],v[124:125],0
ds_read_b128 v[52:55],v11 offset:15360
v_exp_f32 v26,v26
v_exp_f32 v27,v27
v_cvt_pk_bf16_f32 v120,v24,v25
v_exp_f32 v28,v28
v_exp_f32 v29,v29
v_cvt_pk_bf16_f32 v121,v26,v27
v_exp_f32 v30,v30
v_exp_f32 v31,v31
v_cvt_pk_bf16_f32 v122,v28,v29
v_cvt_pk_bf16_f32 v123,v30,v31
s_add_u32 s75,s75,8192
s_add_u32 s51,s51,1
v_mfma_f32_16x16x32_bf16 v[32:35],v[14:17],v[120:123],v[32:35]
v_mfma_f32_16x16x32_bf16 v[112:115],v[88:91],v[120:123],v[112:115]
ds_read_b128 v[88:91],v11 offset:16384
v_mfma_f32_16x16x32_bf16 v[116:119],v[92:95],v[120:123],v[116:119]
ds_read_b128 v[92:95],v11 offset:17408
v_rcp_f32 v32,v32
v_mov_b64 v[24:25],-1
v_mov_b64 v[26:27],-1
s_add_u32 s64,s75,13631488
s_add_u32 s70,s64,4096
v_pk_mul_f32 v[112:113],v[112:113],v[32:33] op_sel_hi:[1,0]
v_pk_mul_f32 v[114:115],v[114:115],v[32:33] op_sel_hi:[1,0]
v_pk_mul_f32 v[116:117],v[116:117],v[32:33] op_sel_hi:[1,0]
v_pk_mul_f32 v[118:119],v[118:119],v[32:33] op_sel_hi:[1,0]
v_cvt_pk_bf16_f32 v120,v112,v116
v_cvt_pk_bf16_f32 v121,v113,v117
v_cvt_pk_bf16_f32 v122,v114,v118
v_cvt_pk_bf16_f32 v123,v115,v119
ds_write_b128 v7,v[120:123]
buffer_store_dwordx4 v[24:27],v0,s[8:11],s69 offen sc1
buffer_store_dwordx4 v[24:27],v0,s[8:11],s69 offen offset:1024 sc1
v_mov_b64 v[112:113],0
v_mov_b64 v[114:115],0
v_mov_b64 v[116:117],0
v_mov_b64 v[118:119],0
s_waitcnt lgkmcnt(0)
s_barrier
ds_read_b128 v[24:27],v8 offset:0
ds_read_b128 v[28:31],v8 offset:512
ds_read_b128 v[32:35],v8 offset:1024
ds_read_b128 v[36:39],v8 offset:1536
v_mov_b64 v[120:121],0
v_mov_b64 v[122:123],0
s_add_u32 s57,s65,65536
s_add_u32 s58,s65,131072
s_add_u32 s59,s65,196608
s_add_u32 s56,s18,s75
s_waitcnt lgkmcnt(3)
v_smfmac_f32_16x16x64_bf16 v[112:115],v[24:27],v[56:63],v3
ds_read_b128 v[56:59],v11 offset:18432
s_waitcnt lgkmcnt(3)
v_smfmac_f32_16x16x64_bf16 v[112:115],v[28:31],v[64:71],v3
ds_read_b128 v[60:63],v11 offset:19456
s_waitcnt lgkmcnt(3)
v_smfmac_f32_16x16x64_bf16 v[112:115],v[32:35],v[72:79],v3
ds_read_b128 v[64:67],v11 offset:20480
s_waitcnt lgkmcnt(3)
v_smfmac_f32_16x16x64_bf16 v[112:115],v[36:39],v[80:87],v3
ds_read_b128 v[68:71],v11 offset:21504
v_smfmac_f32_16x16x64_bf16 v[116:119],v[24:27],v[96:103],v3
ds_read_b128 v[72:75],v11 offset:22528
v_smfmac_f32_16x16x64_bf16 v[116:119],v[28:31],v[104:111],v3
ds_read_b128 v[76:79],v11 offset:23552
v_cvt_pk_bf16_f32 v112,v112,v113
v_smfmac_f32_16x16x64_bf16 v[116:119],v[32:35],v[40:47],v3
ds_read_b128 v[80:83],v11 offset:24576
v_cvt_pk_bf16_f32 v113,v114,v115
buffer_store_dwordx2 v[112:113],v9,s[8:11],s65 offen sc1
v_smfmac_f32_16x16x64_bf16 v[116:119],v[36:39],v[48:55],v3
ds_read_b128 v[84:87],v11 offset:25600
v_mov_b64 v[112:113],0
v_smfmac_f32_16x16x64_bf16 v[120:123],v[24:27],v[88:95],v3
ds_read_b128 v[96:99],v11 offset:26624
ds_read_b128 v[100:103],v11 offset:27648
v_mov_b64 v[114:115],0
s_waitcnt lgkmcnt(8)
v_smfmac_f32_16x16x64_bf16 v[120:123],v[28:31],v[56:63],v3
ds_read_b128 v[104:107],v11 offset:28672
v_cvt_pk_bf16_f32 v116,v116,v117
s_waitcnt lgkmcnt(7)
v_smfmac_f32_16x16x64_bf16 v[120:123],v[32:35],v[64:71],v3
ds_read_b128 v[108:111],v11 offset:29696
ds_read_b128 v[40:43],v11 offset:30720
v_cvt_pk_bf16_f32 v117,v118,v119
buffer_store_dwordx2 v[116:117],v9,s[8:11],s57 offen sc1
s_waitcnt lgkmcnt(7)
v_smfmac_f32_16x16x64_bf16 v[120:123],v[36:39],v[72:79],v3
ds_read_b128 v[44:47],v11 offset:31744
v_add_u32 v52,s50,v5
s_waitcnt lgkmcnt(6)
v_smfmac_f32_16x16x64_bf16 v[112:115],v[24:27],v[80:87],v3
v_add_u32 v54,s50,v6
s_waitcnt lgkmcnt(4)
v_smfmac_f32_16x16x64_bf16 v[112:115],v[28:31],v[96:103],v3
ds_read_b64_tr_b16 v[52:53],v52
v_cvt_pk_bf16_f32 v120,v120,v121
s_waitcnt lgkmcnt(3)
v_smfmac_f32_16x16x64_bf16 v[112:115],v[32:35],v[104:111],v3
ds_read_b64_tr_b16 v[54:55],v54
v_cvt_pk_bf16_f32 v121,v122,v123
buffer_store_dwordx2 v[120:121],v9,s[8:11],s58 offen sc1
s_waitcnt lgkmcnt(2)
v_smfmac_f32_16x16x64_bf16 v[112:115],v[36:39],v[40:47],v3
v_mov_b64 v[116:117],0
v_mov_b64 v[118:119],0
s_xor_b32 s65,s65,262144
v_mov_b32_dpp v124,v126 quad_perm:[2,3,2,3] row_mask:0xf bank_mask:0xf
v_mov_b32_dpp v125,v127 quad_perm:[2,3,2,3] row_mask:0xf bank_mask:0xf
s_mov_b32 vcc_lo,0xcccccccc
s_mov_b32 vcc_hi,0xcccccccc
s_nop 0
v_cvt_pk_bf16_f32 v112,v112,v113
v_cvt_pk_bf16_f32 v113,v114,v115
buffer_store_dwordx2 v[112:113],v9,s[8:11],s59 offen sc1
s_waitcnt lgkmcnt(0)
s_buffer_load_dword s19,s[8:11],s56
v_cndmask_b32 v124,v124,v52,vcc
v_cndmask_b32 v125,v125,v53,vcc
v_cndmask_b32 v126,v126,v54,vcc
v_cndmask_b32 v127,v127,v55,vcc
s_cmp_lt_u32 s46,2
s_waitcnt vmcnt(3)
s_cbranch_scc1 L_crg_308
s_cmp_eq_u32 s46,2
s_waitcnt vmcnt(1)
s_cbranch_scc1 L_crg_308
s_waitcnt vmcnt(0)
L_crg_308:
buffer_load_dwordx4 v[32:35],v0,s[8:11],s66 offen offset:0 sc1
buffer_load_dwordx4 v[36:39],v0,s[8:11],s66 offen offset:1024 sc1
v_mov_b64 v[96:97],0
v_mov_b64 v[98:99],0
v_mov_b64 v[100:101],0
v_mov_b64 v[102:103],0
v_mov_b64 v[104:105],0
v_mov_b64 v[106:107],0
v_mov_b64 v[108:109],0
v_mov_b64 v[110:111],0
v_mov_b64 v[112:113],0
v_mov_b64 v[114:115],0
v_add_u32 v55,131072,v0
v_add_u32 v123,s73,v55
v_xor_b32 v120,1024,v12
v_xor_b32 v121,2048,v12
v_xor_b32 v122,3072,v12
buffer_load_dwordx4 v[44:47],v0,s[8:11],s66 offen offset:0 sc1
buffer_load_dwordx4 v[48:51],v0,s[8:11],s66 offen offset:1024 sc1
s_cmp_ge_u32 s51,63
s_cselect_b32 s76,0,1
v_readlane_b32 s56,v23,5
v_readlane_b32 s20,v23,4
v_add_u32 v23,-1,v23
v_cmp_le_u32 vcc,s30,v23
s_cmp_gt_u32 s51,61
s_cselect_b32 s77,0,vcc_hi
s_cmp_gt_u32 s20,s30
s_cselect_b32 s77,1,s77
s_cmp_lg_u32 s77,0
s_cselect_b32 s76,2,s76
s_cmp_gt_u32 s56,s30
s_cbranch_scc1 L_cld_284
L_clb_285:
s_cmp_eq_u32 s46,0
s_cselect_b32 s76,s76,0
s_waitcnt vmcnt(3)
v_mfma_f32_16x16x32_bf16 v[28:31],v[18:21],v[32:35],0
s_waitcnt vmcnt(2)
v_mfma_f32_16x16x32_bf16 v[28:31],v[18:21],v[36:39],v[28:31]
s_nop 7
v_cmp_u_f32 vcc,v28,v28
v_add_f32_dpp v52,v28,v28 row_ror:8 row_mask:0xf bank_mask:0x3
v_add_f32_dpp v53,v29,v29 row_ror:8 row_mask:0xf bank_mask:0x3
v_add_f32_dpp v52,v30,v30 row_ror:8 row_mask:0xf bank_mask:0xc
v_add_f32_dpp v53,v31,v31 row_ror:8 row_mask:0xf bank_mask:0xc
s_nop 0
v_add_f32_dpp v52,v52,v52 row_shl:4 row_mask:0xf bank_mask:0x5
v_add_f32_dpp v53,v53,v53 row_shl:4 row_mask:0xf bank_mask:0x5
s_cbranch_vccnz L_crp_303
L_cok_309:
v_cvt_pk_bf16_f32 v54,v52,v53
buffer_store_dword v54,v10,s[8:11],s64 offen sc1
s_mov_b32 s69,s66
s_xor_b32 s66,s66,262144
s_barrier
ds_read_b128 v[56:59],v55 offset:0
ds_read_b128 v[60:63],v55 offset:4096
ds_read_b128 v[64:67],v55 offset:1024
buffer_load_dwordx4 v[24:27],v13,s[8:11],s64 offen sc1
ds_read_b128 v[68:71],v55 offset:5120
ds_read_b128 v[72:75],v55 offset:2048
ds_read_b128 v[76:79],v55 offset:6144
ds_read_b128 v[80:83],v55 offset:3072
buffer_load_dwordx4 v[24:27],v13,s[8:11],s64 offen sc1
ds_read_b128 v[84:87],v55 offset:7168
ds_read_b128 v[88:91],v123 offset:8192
ds_read_b128 v[92:95],v123 offset:9216
s_branch L_chain_298
L_cpb_305:
buffer_load_dwordx4 v[40:43],v13,s[8:11],s70 offen sc1
s_sub_u32 s49,s49,1
s_cbranch_scc1 L_abort2
s_waitcnt vmcnt(0)
v_max3_u32 v123,v40,v41,v42
v_max_u32 v123,v43,v123
v_cmp_le_u32 vcc,s72,v123
s_cbranch_vccnz L_cpb_305
ds_write_b128 v12,v[40:43] offset:4096
s_branch L_cback_307
L_crp_303:
buffer_load_dwordx4 v[32:35],v0,s[8:11],s66 offen offset:0 sc1
buffer_load_dwordx4 v[36:39],v0,s[8:11],s66 offen offset:1024 sc1
s_sub_u32 s49,s49,1
s_cbranch_scc1 L_abort2
s_waitcnt vmcnt(3)
v_mfma_f32_16x16x32_bf16 v[28:31],v[18:21],v[44:47],0
s_waitcnt vmcnt(2)
v_mfma_f32_16x16x32_bf16 v[28:31],v[18:21],v[48:51],v[28:31]
s_nop 7
v_cmp_u_f32 vcc,v28,v28
v_add_f32_dpp v52,v28,v28 row_ror:8 row_mask:0xf bank_mask:0x3
v_add_f32_dpp v53,v29,v29 row_ror:8 row_mask:0xf bank_mask:0x3
v_add_f32_dpp v52,v30,v30 row_ror:8 row_mask:0xf bank_mask:0xc
v_add_f32_dpp v53,v31,v31 row_ror:8 row_mask:0xf bank_mask:0xc
s_nop 0
v_add_f32_dpp v52,v52,v52 row_shl:4 row_mask:0xf bank_mask:0x5
v_add_f32_dpp v53,v53,v53 row_shl:4 row_mask:0xf bank_mask:0x5
s_cbranch_vccz L_cok_309
buffer_load_dwordx4 v[44:47],v0,s[8:11],s66 offen offset:0 sc1
buffer_load_dwordx4 v[48:51],v0,s[8:11],s66 offen offset:1024 sc1
s_sub_u32 s49,s49,1
s_cbranch_scc1 L_abort2
s_waitcnt vmcnt(3)
v_mfma_f32_16x16x32_bf16 v[28:31],v[18:21],v[32:35],0
s_waitcnt vmcnt(2)
v_mfma_f32_16x16x32_bf16 v[28:31],v[18:21],v[36:39],v[28:31]
s_nop 7
v_cmp_u_f32 vcc,v28,v28
v_add_f32_dpp v52,v28,v28 row_ror:8 row_mask:0xf bank_mask:0x3
v_add_f32_dpp v53,v29,v29 row_ror:8 row_mask:0xf bank_mask:0x3
v_add_f32_dpp v52,v30,v30 row_ror:8 row_mask:0xf bank_mask:0xc
v_add_f32_dpp v53,v31,v31 row_ror:8 row_mask:0xf bank_mask:0xc
s_nop 0
v_add_f32_dpp v52,v52,v52 row_shl:4 row_mask:0xf bank_mask:0x5
v_add_f32_dpp v53,v53,v53 row_shl:4 row_mask:0xf bank_mask:0x5
s_cbranch_vccz L_cok_309
s_branch L_crp_303
L_ckw_288:
s_cmp_eq_u32 s77,0
s_cbranch_scc1 L_cjw_290
s_cmp_gt_u32 s20,s30
s_cbranch_scc1 L_cjs_286
s_add_u32 s31,s51,2
s_lshl_b32 s59,s31,13
s_add_u32 s59,s59,10486016
v_lshrrev_b32 v45,2,v0
v_and_b32 v45,127,v45
L_ckk_310:
s_sleep 1
buffer_load_dword v44,v45,s[8:11],s59 offen sc1
s_sub_u32 s49,s49,1
s_cbranch_scc1 L_abort2
s_waitcnt vmcnt(0)
v_cmp_eq_u32 vcc,0,v44
s_cbranch_vccnz L_ckk_310
v_cmp_lt_u32 vcc,s30,v44
s_cbranch_vccz L_cjw_290
v_max_u32_dpp v44,v44,v44 row_ror:8 row_mask:0xf bank_mask:0xf
s_nop 1
v_max_u32_dpp v44,v44,v44 row_ror:4 row_mask:0xf bank_mask:0xf
s_nop 1
v_max_u32_dpp v44,v44,v44 row_ror:2 row_mask:0xf bank_mask:0xf
s_nop 1
v_max_u32_dpp v44,v44,v44 row_ror:1 row_mask:0xf bank_mask:0xf
v_mov_b32 v45,v44
s_nop 1
v_permlane16_swap_b32 v44,v45
v_max_u32 v44,v44,v45
v_mov_b32 v45,v44
s_nop 1
v_permlane32_swap_b32 v44,v45
v_max_u32 v44,v44,v45
s_nop 0
v_readfirstlane_b32 s20,v44
L_cjs_286:
s_mov_b32 s30,s20
s_andn2_b32 s31,0x7ff,s20
s_lshr_b32 s31,s31,5
s_add_u32 s31,s31,1
s_min_u32 s31,s31,63
ds_write_b32 v8,v2 offset:2560
s_waitcnt lgkmcnt(0)
s_branch L_ckb_289
L_cld_284:
v_mov_b32 v23,s56
s_add_u32 s56,s75,10495616
buffer_store_dword v23,off,s[8:11],s56 sc1
s_waitcnt vmcnt(0)
s_branch L_clb_285
L_cjw_290:
s_cmp_lg_u32 s19,0
s_cbranch_scc1 L_ckb_289
s_add_u32 s59,s18,s75
L_ww_311:
s_sleep 1
buffer_load_dword v23,off,s[8:11],s59 sc1
s_sub_u32 s49,s49,1
s_cbranch_scc1 L_abort2
s_waitcnt vmcnt(0)
v_readfirstlane_b32 s76,v23
s_cmp_eq_u32 s76,0
s_cbranch_scc1 L_ww_311
L_wwd_312:
s_branch L_ckb_289
L_cjump_291:
s_waitcnt vmcnt(0) lgkmcnt(0)
s_barrier
s_branch L_cst_287
L_cend_301:
v_smfmac_f32_16x16x64_bf16 v[116:119],v[36:39],v[184:191],v2
v_smfmac_f32_16x16x64_bf16 v[112:115],v[40:43],v[192:199],v2
v_smfmac_f32_16x16x64_bf16 v[116:119],v[40:43],v[200:207],v2
v_smfmac_f32_16x16x64_bf16 v[112:115],v[44:47],v[208:215],v2
v_smfmac_f32_16x16x64_bf16 v[116:119],v[44:47],v[216:223],v2
v_smfmac_f32_16x16x64_bf16 v[112:115],v[48:51],v[224:231],v2
v_smfmac_f32_16x16x64_bf16 v[116:119],v[48:51],v[232:239],v2
v_smfmac_f32_16x16x64_bf16 v[112:115],v[52:55],v[240:247],v2
v_smfmac_f32_16x16x64_bf16 v[116:119],v[52:55],v[248:255],v2
s_waitcnt lgkmcnt(0)
s_nop 2
v_pk_add_f32 v[112:113],v[112:113],v[114:115]
s_nop 2
v_pk_add_f32 v[116:117],v[116:117],v[118:119]
v_cvt_pk_bf16_f32 v126,v112,v113
v_cvt_pk_bf16_f32 v127,v116,v117
v_add_u32 v52,s50,v5
v_add_u32 v54,s50,v6
ds_read_b64_tr_b16 v[52:53],v52
ds_read_b64_tr_b16 v[54:55],v54
v_mov_b32_dpp v124,v126 quad_perm:[2,3,2,3] row_mask:0xf bank_mask:0xf
v_mov_b32_dpp v125,v127 quad_perm:[2,3,2,3] row_mask:0xf bank_mask:0xf
s_mov_b32 vcc_lo,0xcccccccc
s_mov_b32 vcc_hi,0xcccccccc
s_waitcnt lgkmcnt(0)
v_cndmask_b32 v124,v124,v52,vcc
v_cndmask_b32 v125,v125,v53,vcc
v_cndmask_b32 v126,v126,v54,vcc
v_cndmask_b32 v127,v127,v55,vcc
buffer_store_dwordx4 v[124:127],v0,s[8:11],s54 offen sc1
s_mov_b32 s51,64
s_waitcnt vmcnt(0)
s_barrier
s_nop 11
v_lshrrev_b32 v1,4,v0
s_endpgm
L_wa:
s_nop 11
v_and_b32 v238,15,v1
v_and_b32 v239,1,v1
v_lshlrev_b32 v239,4,v239
v_mov_b32 v240,0x3f80
v_lshlrev_b32 v240,v239,v240
v_lshrrev_b32 v238,1,v238
v_cmp_eq_u32 vcc,0,v238
s_nop 1
v_cndmask_b32 v156,0,v240,vcc
v_cmp_eq_u32 vcc,1,v238
s_nop 1
v_cndmask_b32 v157,0,v240,vcc
v_cmp_eq_u32 vcc,2,v238
s_nop 1
v_cndmask_b32 v158,0,v240,vcc
v_cmp_eq_u32 vcc,3,v238
s_nop 1
v_cndmask_b32 v159,0,v240,vcc
s_mov_b32 s4,s32
s_mov_b32 s5,s33
s_mov_b32 s6,1024
s_mov_b32 s7,0x20000
buffer_load_dwordx4 v[224:227],v0,s[4:7],0 offen
v_and_b32 v238,15,v1
v_lshrrev_b32 v239,4,v1
v_lshlrev_b32 v240,2,v239
v_mov_b32 v241,0xf149f2ca
s_and_b32 s56,s46,1
s_lshl_b32 s56,s56,4
v_add_u32 v242,s56,v238
v_add_u32 v243,0,v240
v_cmp_gt_u32 vcc,v243,v242
s_nop 1
v_cndmask_b32 v8,0,v241,vcc
v_add_u32 v243,1,v240
v_cmp_gt_u32 vcc,v243,v242
s_nop 1
v_cndmask_b32 v9,0,v241,vcc
v_add_u32 v243,2,v240
v_cmp_gt_u32 vcc,v243,v242
s_nop 1
v_cndmask_b32 v10,0,v241,vcc
v_add_u32 v243,3,v240
v_cmp_gt_u32 vcc,v243,v242
s_nop 1
v_cndmask_b32 v11,0,v241,vcc
v_add_u32 v243,16,v240
v_cmp_gt_u32 vcc,v243,v242
s_nop 1
v_cndmask_b32 v12,0,v241,vcc
v_add_u32 v243,17,v240
v_cmp_gt_u32 vcc,v243,v242
s_nop 1
v_cndmask_b32 v13,0,v241,vcc
v_add_u32 v243,18,v240
v_cmp_gt_u32 vcc,v243,v242
s_nop 1
v_cndmask_b32 v14,0,v241,vcc
v_add_u32 v243,19,v240
v_cmp_gt_u32 vcc,v243,v242
s_nop 1
v_cndmask_b32 v15,0,v241,vcc
v_mov_b32 v152,s80
v_mov_b32 v145,0
v_mov_b32 v146,0
s_lshl_b32 s56,s46,12
s_add_u32 s56,s56,131072
v_add_u32 v3,s56,v0
v_add_u32 v4,131072,v0
s_lshl_b32 s56,s46,8
v_lshlrev_b32 v7,4,v238
v_add_u32 v7,s56,v7
v_lshl_add_u32 v5,v239,16,v7
v_lshlrev_b32 v6,1,v7
v_lshl_add_u32 v7,v239,10,v7
v_and_b32 v243,1,v239
v_lshl_add_u32 v6,v243,4,v6
v_lshrrev_b32 v243,1,v239
v_lshl_add_u32 v6,v243,12,v6
v_add_u32 v6,147456,v6
v_lshlrev_b32 v16,2,v1
v_lshlrev_b32 v21,3,v238
s_and_b32 s68,s47,15
s_lshl_b32 s56,s68,10
v_add_u32 v5,s56,v5
s_lshl_b32 s56,s68,15
v_add_u32 v7,s56,v7
s_lshl_b32 s69,s54,20
s_add_u32 s69,s69,20971520
s_lshl_b32 s87,s54,13
s_add_u32 s87,s87,10486272
s_lshl4_add_u32 s74,s68,s87
s_lshl2_add_u32 s74,s46,s74
s_lshl_b32 s68,s68,1
s_lshr_b32 s56,s46,1
s_add_u32 s68,s68,s56
s_mov_b32 s66,0
s_mov_b32 s67,0
s_mov_b32 s73,0x80000000
s_mov_b32 s75,0
s_mov_b32 s37,0
s_mov_b32 s42,4294966272
s_mov_b32 s43,4294967295
s_mov_b64 s[38:39],0
s_sub_u32 s36,s54,12
s_and_b32 s36,s36,3
s_mov_b32 s12,s40
s_mov_b32 s13,s41
s_mov_b32 s14,2097152
s_mov_b32 s15,0x20000
s_and_b32 s29,s46,1
s_mul_i32 s28,s29,12288
s_lshl_b32 s29,s29,11
s_and_b32 s56,s50,2048
s_lshl_b32 s56,s56,4
s_add_u32 s56,s56,65536
s_add_u32 s40,s56,s28
s_add_u32 s41,s56,s29
v_add_u32 v21,10487168,v21
v_mov_b32 v244,v21
s_and_b32 s56,s50,2048
s_add_u32 s56,s56,147456
v_lshlrev_b32 v23,5,v1
v_add_u32 v23,s56,v23
v_and_b32 v253,32,v0
v_lshrrev_b32 v245,2,v253
v_add_u32 v253,v253,v245
v_sub_u32 v253,v0,v253
v_add_u32 v253,8,v253
v_mov_b32 v254,0x80000000
s_mov_b32 s56,1408
v_writelane_b32 v254,s56,0
s_mov_b32 s56,256
v_writelane_b32 v254,s56,1
s_mov_b32 s56,1280
v_writelane_b32 v254,s56,2
v_mov_b32 v245,155648
s_lshl_b32 s56,s46,2
v_add_u32 v247,s56,v245
s_waitcnt vmcnt(0)
v_lshlrev_b32 v228,16,v224
v_and_b32 v229,0xffff0000,v224
v_lshlrev_b32 v230,16,v225
v_and_b32 v231,0xffff0000,v225
v_lshlrev_b32 v232,16,v226
v_and_b32 v233,0xffff0000,v226
v_lshlrev_b32 v234,16,v227
v_and_b32 v235,0xffff0000,v227
v_mul_f32 v255,v228,v228
v_fma_f32 v255,v229,v229,v255
v_fma_f32 v255,v230,v230,v255
v_fma_f32 v255,v231,v231,v255
v_fma_f32 v255,v232,v232,v255
v_fma_f32 v255,v233,v233,v255
v_fma_f32 v255,v234,v234,v255
v_fma_f32 v255,v235,v235,v255
s_nop 1
v_add_f32_dpp v255,v255,v255 row_ror:8 row_mask:0xf bank_mask:0xf
s_nop 1
v_add_f32_dpp v255,v255,v255 row_ror:4 row_mask:0xf bank_mask:0xf
s_nop 1
v_add_f32_dpp v255,v255,v255 row_ror:2 row_mask:0xf bank_mask:0xf
s_nop 1
v_add_f32_dpp v255,v255,v255 row_ror:1 row_mask:0xf bank_mask:0xf
v_mov_b32 v238,v255
s_nop 1
v_permlane16_swap_b32 v255,v238
v_add_f32 v255,v255,v238
v_mov_b32 v238,v255
s_nop 1
v_permlane32_swap_b32 v255,v238
v_add_f32 v255,v255,v238
v_sqrt_f32 v255,v255
v_sub_u32 v238,68,v1
v_cvt_f32_u32 v238,v238
v_log_f32 v238,v238
v_mov_b32 v239,0x3ff9999a
v_fmac_f32 v239,0x3e632166,v238
v_mul_f32 v255,v255,v239
v_or_b32 v255,0x80000000,v255
s_cmp_lt_u32 s54,2
s_cbranch_scc1 L_aa_313
s_sub_u32 s77,s54,2
s_mov_b32 s30,0
s_mov_b32 s86,1536
s_lshl_b32 s56,s77,5
s_add_u32 s56,s56,s68
s_mul_i32 s70,s56,24576
s_lshl_b32 s71,s56,12
s_lshl_b32 s59,s77,13
s_lshl2_add_u32 s59,s68,s59
s_add_u32 s59,s59,10485760
s_buffer_load_dword s32,s[8:11],s59
s_mov_b32 s33,1
s_add_u32 s70,s70,100663296
s_add_u32 s71,s71,41943040
v_mov_b32 v19,s59
s_branch L_aa_321
L_aa_327:
s_bitcmp1_b32 s46,0
s_cbranch_scc1 L_av_328
ds_read_b128 v[24:27],v4 offset:0
ds_read_b128 v[28:31],v4 offset:1024
s_min_u32 s56,s32,s33
s_cmp_lt_u32 s77,64
s_cselect_b32 s56,s56,0
s_cmp_eq_u32 s56,0
s_cselect_b32 s72,0x80000000,0
v_mov_b32 v248,s72
s_or_b32 s64,s70,s72
s_or_b32 s65,s71,s72
s_cmp_lt_u32 s30,s31
s_cselect_b32 s65,0x80000000,s65
s_add_u32 s64,s64,s28
s_add_u32 s65,s65,s29
s_xor_b32 s58,s67,s40
s_xor_b32 s57,s67,s41
s_add_u32 m0,s58,0
s_waitcnt lgkmcnt(1)
v_mfma_f32_16x16x32_bf16 v[160:163],v[24:27],a[0:3],0
buffer_load_dwordx4 v0,s[8:11],s64 offen offset:0 sc1 lds
v_mfma_f32_16x16x32_bf16 v[164:167],v[24:27],a[4:7],0
ds_read_b128 v[32:35],v4 offset:2048
v_lshlrev_b32 v88,16,v224
v_mfma_f32_16x16x32_bf16 v[168:171],v[24:27],a[8:11],0
ds_read_b128 v[36:39],v4 offset:3072
v_and_b32 v89,0xffff0000,v224
v_mfma_f32_16x16x32_bf16 v[172:175],v[24:27],a[12:15],0
ds_read_b128 v[40:43],v4 offset:8192
v_lshlrev_b32 v90,16,v225
v_mfma_f32_16x16x32_bf16 v[176:179],v[24:27],a[16:19],0
buffer_load_dwordx4 v0,s[8:11],s64 offen offset:1024 sc1 lds
v_mfma_f32_16x16x32_bf16 v[180:183],v[24:27],a[20:23],0
ds_read_b128 v[44:47],v4 offset:9216
v_and_b32 v91,0xffff0000,v225
v_mfma_f32_16x16x32_bf16 v[184:187],v[24:27],a[24:27],0
ds_read_b128 v[48:51],v4 offset:10240
s_waitcnt vmcnt(9)
v_mfma_f32_16x16x32_bf16 v[188:191],v[24:27],a[28:31],0
ds_read_b128 v[52:55],v4 offset:11264
v_mfma_f32_16x16x32_bf16 v[128:131],v[156:159],v[192:195],0
ds_write_b32 v247,v248
v_lshlrev_b32 v92,16,v226
s_waitcnt lgkmcnt(7)
v_mfma_f32_16x16x32_bf16 v[160:163],v[28:31],a[32:35],v[160:163]
buffer_load_dwordx4 v0,s[8:11],s64 offen offset:2048 sc1 lds
v_mfma_f32_16x16x32_bf16 v[164:167],v[28:31],a[36:39],v[164:167]
ds_read_b128 v[56:59],v4 offset:4096
s_waitcnt vmcnt(9)
v_mfma_f32_16x16x32_bf16 v[168:171],v[28:31],a[40:43],v[168:171]
ds_read_b128 v[60:63],v4 offset:5120
v_mfma_f32_16x16x32_bf16 v[128:131],v[156:159],v[196:199],v[128:131]
ds_read_b128 v[64:67],v4 offset:6144
v_and_b32 v93,0xffff0000,v226
v_mfma_f32_16x16x32_bf16 v[172:175],v[28:31],a[44:47],v[172:175]
ds_read_b128 v[68:71],v4 offset:7168
s_waitcnt vmcnt(8)
v_mfma_f32_16x16x32_bf16 v[176:179],v[28:31],a[48:51],v[176:179]
buffer_load_dwordx4 v0,s[8:11],s64 offen offset:3072 sc1 lds
v_mfma_f32_16x16x32_bf16 v[180:183],v[28:31],a[52:55],v[180:183]
ds_read_b128 v[72:75],v4 offset:12288
v_mfma_f32_16x16x32_bf16 v[128:131],v[156:159],v[200:203],v[128:131]
ds_read_b128 v[76:79],v4 offset:13312
v_lshlrev_b32 v94,16,v227
v_mfma_f32_16x16x32_bf16 v[184:187],v[28:31],a[56:59],v[184:187]
ds_read_b128 v[80:83],v4 offset:14336
s_waitcnt vmcnt(8)
v_mfma_f32_16x16x32_bf16 v[188:191],v[28:31],a[60:63],v[188:191]
ds_read_b128 v[84:87],v4 offset:15360
v_mfma_f32_16x16x32_bf16 v[128:131],v[156:159],v[204:207],v[128:131]
v_and_b32 v95,0xffff0000,v227
v_readfirstlane_b32 s22,v246
s_waitcnt lgkmcnt(14)
v_mfma_f32_16x16x32_bf16 v[160:163],v[32:35],a[64:67],v[160:163]
s_waitcnt vmcnt(7)
v_mfma_f32_16x16x32_bf16 v[132:135],v[156:159],v[208:211],0
s_add_u32 m0,s58,4096
s_add_u32 s64,s64,4096
s_cmp_eq_u32 s22,0
s_cbranch_scc1 L_ag_329
L_agb_330:
v_mfma_f32_16x16x32_bf16 v[164:167],v[32:35],a[68:71],v[164:167]
buffer_load_dwordx4 v0,s[8:11],s64 offen offset:0 sc1 lds
v_mfma_f32_16x16x32_bf16 v[168:171],v[32:35],a[72:75],v[168:171]
s_waitcnt vmcnt(7)
v_mfma_f32_16x16x32_bf16 v[132:135],v[156:159],v[212:215],v[132:135]
s_lshl_b32 s18,s26,5
s_add_u32 s18,s18,s68
s_lshl_b32 s19,s18,10
v_mfma_f32_16x16x32_bf16 v[172:175],v[32:35],a[76:79],v[172:175]
s_waitcnt vmcnt(6)
v_mfma_f32_16x16x32_bf16 v[132:135],v[156:159],v[216:219],v[132:135]
s_add_u32 s20,s19,6291456
s_lshl_b32 s23,s51,5
s_add_u32 s23,s23,s68
v_mfma_f32_16x16x32_bf16 v[176:179],v[32:35],a[80:83],v[176:179]
ds_write_b128 v6,v[128:131]
v_mfma_f32_16x16x32_bf16 v[180:183],v[32:35],a[84:87],v[180:183]
buffer_load_dwordx4 v0,s[8:11],s64 offen offset:1024 sc1 lds
v_mfma_f32_16x16x32_bf16 v[184:187],v[32:35],a[88:91],v[184:187]
s_waitcnt vmcnt(6)
v_mfma_f32_16x16x32_bf16 v[132:135],v[156:159],v[220:223],v[132:135]
s_lshl_b32 s24,s23,10
s_lshl_b32 s25,s51,10
s_add_u32 s25,s25,2883584
v_mfma_f32_16x16x32_bf16 v[188:191],v[32:35],a[92:95],v[188:191]
s_cmp_eq_u32 s23,s55
s_cselect_b32 s25,s25,s24
s_add_u32 s25,s25,8388608
s_waitcnt lgkmcnt(14)
v_mfma_f32_16x16x32_bf16 v[160:163],v[36:39],a[96:99],v[160:163]
s_mov_b32 s6,268435456
s_cmp_eq_u32 s31,0
s_cselect_b32 s25,s24,s25
s_cselect_b64 s[4:5],s[16:17],s[44:45]
s_cmov_b32 s6,2097152
v_mfma_f32_16x16x32_bf16 v[164:167],v[36:39],a[100:103],v[164:167]
ds_write_b128 v6,v[132:135] offset:2048
v_mfma_f32_16x16x32_bf16 v[168:171],v[36:39],a[104:107],v[168:171]
buffer_load_dwordx4 v0,s[8:11],s64 offen offset:2048 sc1 lds
v_mfma_f32_16x16x32_bf16 v[172:175],v[36:39],a[108:111],v[172:175]
buffer_load_dwordx4 v[224:227],v0,s[4:7],s25 offen sc1
v_mfma_f32_16x16x32_bf16 v[176:179],v[36:39],a[112:115],v[176:179]
s_lshr_b32 s24,s55,5
s_cmp_lt_u32 s51,s24
s_cselect_b32 s24,1,2
v_mfma_f32_16x16x32_bf16 v[180:183],v[36:39],a[116:119],v[180:183]
v_mov_b32 v252,s24
s_lshl2_add_u32 s25,s51,11018240
v_mfma_f32_16x16x32_bf16 v[184:187],v[36:39],a[120:123],v[184:187]
buffer_load_dwordx4 v0,s[8:11],s64 offen offset:3072 sc1 lds
v_mfma_f32_16x16x32_bf16 v[188:191],v[36:39],a[124:127],v[188:191]
s_waitcnt lgkmcnt(0)
s_barrier
s_lshl_b32 s24,s68,16
s_waitcnt lgkmcnt(14)
v_mfma_f32_16x16x32_bf16 v[160:163],v[40:43],a[128:131],v[160:163]
ds_read_b128 v[96:99],v23
s_add_u32 s24,s24,s31
v_mfma_f32_16x16x32_bf16 v[164:167],v[40:43],a[132:135],v[164:167]
ds_read_b128 v[100:103],v23 offset:16
s_add_u32 s24,s24,s86
v_mfma_f32_16x16x32_bf16 v[168:171],v[40:43],a[136:139],v[168:171]
ds_read_b128 v[248:251],v245
s_add_u32 m0,s58,8192
s_add_u32 s64,s64,4096
v_mfma_f32_16x16x32_bf16 v[172:175],v[40:43],a[140:143],v[172:175]
buffer_load_dwordx4 v0,s[8:11],s64 offen offset:0 sc1 lds
s_cmp_eq_u32 s24,1537
s_cselect_b32 s25,s25,0x80000000
v_mfma_f32_16x16x32_bf16 v[176:179],v[40:43],a[144:147],v[176:179]
buffer_store_dword v252,off,s[8:11],s25 sc1
s_bitcmp1_b64 s[38:39],s51
s_cselect_b32 s24,128,0
v_mfma_f32_16x16x32_bf16 v[180:183],v[40:43],a[148:151],v[180:183]
buffer_store_dword v20,off,s[8:11],s73 sc1
s_lshl_b32 s23,s51,13
v_mfma_f32_16x16x32_bf16 v[184:187],v[40:43],a[152:155],v[184:187]
s_lshl2_add_u32 s23,s68,s23
s_add_u32 s23,s23,10487168
s_add_u32 s23,s23,s24
s_mov_b32 s73,0x80000000
v_mfma_f32_16x16x32_bf16 v[188:191],v[40:43],a[156:159],v[188:191]
buffer_load_dwordx4 v0,s[8:11],s64 offen offset:1024 sc1 lds
v_mfma_f32_16x16x32_bf16 v[160:163],v[44:47],a[160:163],v[160:163]
buffer_load_dword v246,off,s[8:11],s23 sc1
v_lshrrev_b32 v244,4,v1
v_mfma_f32_16x16x32_bf16 v[164:167],v[44:47],a[164:167],v[164:167]
s_waitcnt lgkmcnt(0)
v_or3_b32 v248,v248,v249,v250
v_or_b32 v248,v248,v251
s_sub_u32 s23,s77,8
v_mfma_f32_16x16x32_bf16 v[168:171],v[44:47],a[168:171],v[168:171]
v_readfirstlane_b32 s72,v248
v_add_u32 v244,s23,v244
v_max_i32 v244,0,v244
v_mfma_f32_16x16x32_bf16 v[172:175],v[44:47],a[172:175],v[172:175]
buffer_load_dwordx4 v0,s[8:11],s64 offen offset:2048 sc1 lds
v_lshl_add_u32 v244,v244,13,v21
v_mfma_f32_16x16x32_bf16 v[176:179],v[44:47],a[176:179],v[176:179]
buffer_load_dwordx2 v[242:243],v244,s[8:11],0 offen sc1
s_waitcnt lgkmcnt(1)
v_mfma_f32_16x16x32_bf16 v[180:183],v[44:47],a[180:183],v[180:183]
v_cvt_pk_bf16_f32 v104,v96,v97
v_cvt_pk_bf16_f32 v105,v98,v99
v_cvt_pk_bf16_f32 v106,v100,v101
v_mfma_f32_16x16x32_bf16 v[184:187],v[44:47],a[184:187],v[184:187]
v_cvt_pk_bf16_f32 v107,v102,v103
v_lshlrev_b32 v96,16,v104
v_and_b32 v97,0xffff0000,v104
v_mfma_f32_16x16x32_bf16 v[188:191],v[44:47],a[188:191],v[188:191]
buffer_load_dwordx4 v0,s[8:11],s64 offen offset:3072 sc1 lds
v_lshlrev_b32 v98,16,v105
v_mfma_f32_16x16x32_bf16 v[160:163],v[48:51],a[192:195],v[160:163]
v_and_b32 v99,0xffff0000,v105
v_lshlrev_b32 v100,16,v106
v_and_b32 v101,0xffff0000,v106
v_mfma_f32_16x16x32_bf16 v[164:167],v[48:51],a[196:199],v[164:167]
v_lshlrev_b32 v102,16,v107
v_and_b32 v103,0xffff0000,v107
v_add_f32 v88,v88,v96
v_mfma_f32_16x16x32_bf16 v[168:171],v[48:51],a[200:203],v[168:171]
v_add_f32 v89,v89,v97
v_add_f32 v90,v90,v98
v_add_f32 v91,v91,v99
v_mfma_f32_16x16x32_bf16 v[172:175],v[48:51],a[204:207],v[172:175]
s_add_u32 m0,s57,24576
v_add_f32 v92,v92,v100
v_add_f32 v93,v93,v101
v_add_f32 v94,v94,v102
v_mfma_f32_16x16x32_bf16 v[176:179],v[48:51],a[208:211],v[176:179]
buffer_load_dwordx4 v0,s[8:11],s65 offen offset:0 sc1 lds
v_add_f32 v95,v95,v103
v_mfma_f32_16x16x32_bf16 v[180:183],v[48:51],a[212:215],v[180:183]
v_cvt_pk_bf16_f32 v104,v88,v89
v_cvt_pk_bf16_f32 v105,v90,v91
v_cvt_pk_bf16_f32 v106,v92,v93
v_mfma_f32_16x16x32_bf16 v[184:187],v[48:51],a[216:219],v[184:187]
v_cvt_pk_bf16_f32 v107,v94,v95
v_mfma_f32_16x16x32_bf16 v[188:191],v[48:51],a[220:223],v[188:191]
buffer_store_dwordx4 v[104:107],v0,s[8:11],s20 offen sc1
v_lshlrev_b32 v88,16,v104
v_mfma_f32_16x16x32_bf16 v[160:163],v[52:55],a[224:227],v[160:163]
buffer_load_dwordx4 v0,s[8:11],s65 offen offset:1024 sc1 lds
v_and_b32 v89,0xffff0000,v104
v_mfma_f32_16x16x32_bf16 v[164:167],v[52:55],a[228:231],v[164:167]
v_lshlrev_b32 v90,16,v105
v_and_b32 v91,0xffff0000,v105
v_lshlrev_b32 v92,16,v106
v_mfma_f32_16x16x32_bf16 v[168:171],v[52:55],a[232:235],v[168:171]
v_and_b32 v93,0xffff0000,v106
v_lshlrev_b32 v94,16,v107
v_and_b32 v95,0xffff0000,v107
v_mfma_f32_16x16x32_bf16 v[172:175],v[52:55],a[236:239],v[172:175]
v_readfirstlane_b32 s78,v88
v_mfma_f32_16x16x32_bf16 v[176:179],v[52:55],a[240:243],v[176:179]
s_nop 0
v_add_f32 v120,v88,-s78
v_add_f32 v121,v89,-s78
v_add_f32 v122,v90,-s78
v_mfma_f32_16x16x32_bf16 v[180:183],v[52:55],a[244:247],v[180:183]
v_add_f32 v123,v91,-s78
v_add_f32 v124,v92,-s78
v_add_f32 v125,v93,-s78
v_mfma_f32_16x16x32_bf16 v[184:187],v[52:55],a[248:251],v[184:187]
v_add_f32 v126,v94,-s78
v_add_f32 v127,v95,-s78
v_add_f32 v128,v120,v122
v_mfma_f32_16x16x32_bf16 v[188:191],v[52:55],a[252:255],v[188:191]
v_add_f32 v129,v121,v123
v_mul_f32 v130,v120,v120
v_mul_f32 v131,v121,v121
v_mfma_f32_16x16x32_bf16 v[192:195],v[56:59],a[0:3],0
v_add_f32 v132,v124,v126
v_add_f32 v133,v125,v127
v_fma_f32 v130,v122,v122,v130
v_mfma_f32_16x16x32_bf16 v[196:199],v[56:59],a[4:7],0
v_fma_f32 v131,v123,v123,v131
v_add_f32 v128,v128,v132
v_add_f32 v129,v129,v133
v_mfma_f32_16x16x32_bf16 v[200:203],v[56:59],a[8:11],0
v_fma_f32 v130,v124,v124,v130
v_fma_f32 v131,v125,v125,v131
v_add_f32 v128,v128,v129
v_mfma_f32_16x16x32_bf16 v[204:207],v[56:59],a[12:15],0
v_fma_f32 v130,v126,v126,v130
v_fma_f32 v131,v127,v127,v131
v_add_f32 v130,v130,v131
v_mfma_f32_16x16x32_bf16 v[208:211],v[56:59],a[16:19],0
s_nop 0
v_permlane32_swap_b32 v128,v130
v_add_f32 v128,v128,v130
v_cvt_pk_bf16_f32 v24,v160,v164
v_mfma_f32_16x16x32_bf16 v[212:215],v[56:59],a[20:23],0
v_add_f32_dpp v128,v128,v128 row_ror:8 row_mask:0xf bank_mask:0xf
v_cvt_pk_bf16_f32 v25,v168,v172
v_cvt_pk_bf16_f32 v26,v176,v180
v_mfma_f32_16x16x32_bf16 v[216:219],v[56:59],a[24:27],0
v_add_f32_dpp v128,v128,v128 row_ror:4 row_mask:0xf bank_mask:0xf
v_cvt_pk_bf16_f32 v27,v184,v188
v_cvt_pk_bf16_f32 v28,v161,v165
v_mfma_f32_16x16x32_bf16 v[220:223],v[56:59],a[28:31],0
v_add_f32_dpp v128,v128,v128 row_ror:2 row_mask:0xf bank_mask:0xf
v_cvt_pk_bf16_f32 v29,v169,v173
v_cvt_pk_bf16_f32 v30,v177,v181
v_mfma_f32_16x16x32_bf16 v[192:195],v[60:63],a[32:35],v[192:195]
v_add_f32_dpp v128,v128,v128 row_ror:1 row_mask:0xf bank_mask:0xf
v_mov_b32 v130,v128
v_cvt_pk_bf16_f32 v31,v185,v189
v_mfma_f32_16x16x32_bf16 v[196:199],v[60:63],a[36:39],v[196:199]
v_permlane16_swap_b32 v128,v130
v_add_f32 v128,v128,v130
v_mul_f32 v128,0x3b000000,v128
v_mfma_f32_16x16x32_bf16 v[200:203],v[60:63],a[40:43],v[200:203]
v_mov_b32 v130,v128
v_cvt_pk_bf16_f32 v32,v162,v166
v_cvt_pk_bf16_f32 v33,v170,v174
v_mfma_f32_16x16x32_bf16 v[204:207],v[60:63],a[44:47],v[204:207]
v_permlane32_swap_b32 v128,v130
v_fma_f32 v130,-v128,v128,v130
v_add_f32 v128,s78,v128
v_mfma_f32_16x16x32_bf16 v[208:211],v[60:63],a[48:51],v[208:211]
v_max_f32 v130,0,v130
v_cvt_pk_bf16_f32 v130,v128,v130
v_lshlrev_b32 v128,16,v130
v_mfma_f32_16x16x32_bf16 v[212:215],v[60:63],a[52:55],v[212:215]
v_and_b32 v130,0xffff0000,v130
v_add_f32 v130,0x3727c5ac,v130
v_cvt_pk_bf16_f32 v130,v130,v130
v_mfma_f32_16x16x32_bf16 v[216:219],v[60:63],a[56:59],v[216:219]
v_and_b32 v130,0xffff0000,v130
v_sqrt_f32 v130,v130
v_add_f32 v120,v88,-v128
v_mfma_f32_16x16x32_bf16 v[220:223],v[60:63],a[60:63],v[220:223]
v_add_f32 v121,v89,-v128
v_add_f32 v122,v90,-v128
v_add_f32 v123,v91,-v128
v_mfma_f32_16x16x32_bf16 v[192:195],v[64:67],a[64:67],v[192:195]
v_add_f32 v124,v92,-v128
v_add_f32 v125,v93,-v128
v_add_f32 v126,v94,-v128
v_mfma_f32_16x16x32_bf16 v[196:199],v[64:67],a[68:71],v[196:199]
v_add_f32 v127,v95,-v128
v_cvt_pk_bf16_f32 v130,v130,v130
v_and_b32 v130,0xffff0000,v130
v_mfma_f32_16x16x32_bf16 v[200:203],v[64:67],a[72:75],v[200:203]
v_rcp_f32 v130,v130
v_cvt_pk_bf16_f32 v108,v120,v121
v_cvt_pk_bf16_f32 v109,v122,v123
v_mfma_f32_16x16x32_bf16 v[204:207],v[64:67],a[76:79],v[204:207]
v_cvt_pk_bf16_f32 v110,v124,v125
v_cvt_pk_bf16_f32 v111,v126,v127
v_lshlrev_b32 v120,16,v108
v_mfma_f32_16x16x32_bf16 v[208:211],v[64:67],a[80:83],v[208:211]
v_cvt_pk_bf16_f32 v34,v178,v182
v_cvt_pk_bf16_f32 v35,v186,v190
v_cvt_pk_bf16_f32 v36,v163,v167
v_mfma_f32_16x16x32_bf16 v[212:215],v[64:67],a[84:87],v[212:215]
v_cvt_pk_bf16_f32 v37,v171,v175
v_cvt_pk_bf16_f32 v38,v179,v183
v_cvt_pk_bf16_f32 v39,v187,v191
v_mfma_f32_16x16x32_bf16 v[216:219],v[64:67],a[88:91],v[216:219]
v_and_b32 v121,0xffff0000,v108
v_lshlrev_b32 v122,16,v109
v_and_b32 v123,0xffff0000,v109
v_mfma_f32_16x16x32_bf16 v[220:223],v[64:67],a[92:95],v[220:223]
v_lshlrev_b32 v124,16,v110
v_and_b32 v125,0xffff0000,v110
v_lshlrev_b32 v126,16,v111
v_mfma_f32_16x16x32_bf16 v[192:195],v[68:71],a[96:99],v[192:195]
v_and_b32 v127,0xffff0000,v111
v_mul_f32 v120,v120,v130
v_mul_f32 v121,v121,v130
v_mfma_f32_16x16x32_bf16 v[196:199],v[68:71],a[100:103],v[196:199]
v_mul_f32 v122,v122,v130
v_mul_f32 v123,v123,v130
v_mul_f32 v124,v124,v130
v_mfma_f32_16x16x32_bf16 v[200:203],v[68:71],a[104:107],v[200:203]
v_mul_f32 v125,v125,v130
v_mul_f32 v126,v126,v130
v_mul_f32 v127,v127,v130
v_mfma_f32_16x16x32_bf16 v[204:207],v[68:71],a[108:111],v[204:207]
v_cvt_pk_bf16_f32 v108,v120,v121
v_cvt_pk_bf16_f32 v109,v122,v123
v_cvt_pk_bf16_f32 v110,v124,v125
v_mfma_f32_16x16x32_bf16 v[208:211],v[68:71],a[112:115],v[208:211]
s_add_u32 s62,s69,0
v_cvt_pk_bf16_f32 v111,v126,v127
v_lshlrev_b32 v112,16,v108
v_and_b32 v113,0xffff0000,v108
v_mfma_f32_16x16x32_bf16 v[212:215],v[68:71],a[116:119],v[212:215]
buffer_store_dwordx4 v[24:27],v5,s[8:11],s62 offen sc1
v_lshlrev_b32 v114,16,v109
v_mfma_f32_16x16x32_bf16 v[216:219],v[68:71],a[120:123],v[216:219]
v_and_b32 v115,0xffff0000,v109
v_lshlrev_b32 v116,16,v110
v_and_b32 v117,0xffff0000,v110
v_mfma_f32_16x16x32_bf16 v[220:223],v[68:71],a[124:127],v[220:223]
v_lshlrev_b32 v118,16,v111
v_and_b32 v119,0xffff0000,v111
v_add_f32 v88,v88,v112
v_mfma_f32_16x16x32_bf16 v[192:195],v[72:75],a[128:131],v[192:195]
s_add_u32 s62,s69,16384
v_add_f32 v89,v89,v113
v_add_f32 v90,v90,v114
v_add_f32 v91,v91,v115
v_mfma_f32_16x16x32_bf16 v[196:199],v[72:75],a[132:135],v[196:199]
buffer_store_dwordx4 v[28:31],v5,s[8:11],s62 offen sc1
v_add_f32 v92,v92,v116
v_mfma_f32_16x16x32_bf16 v[200:203],v[72:75],a[136:139],v[200:203]
v_add_f32 v93,v93,v117
v_add_f32 v94,v94,v118
v_add_f32 v95,v95,v119
v_mfma_f32_16x16x32_bf16 v[204:207],v[72:75],a[140:143],v[204:207]
v_cvt_pk_bf16_f32 v96,v88,v89
v_cvt_pk_bf16_f32 v97,v90,v91
v_cvt_pk_bf16_f32 v98,v92,v93
v_mfma_f32_16x16x32_bf16 v[208:211],v[72:75],a[144:147],v[208:211]
s_add_u32 s62,s69,32768
v_cvt_pk_bf16_f32 v99,v94,v95
v_mfma_f32_16x16x32_bf16 v[212:215],v[72:75],a[148:151],v[212:215]
buffer_store_dwordx4 v[32:35],v5,s[8:11],s62 offen sc1
v_mfma_f32_16x16x32_bf16 v[216:219],v[72:75],a[152:155],v[216:219]
buffer_store_dwordx4 v[96:99],v0,s[12:15],s19 offen sc1
v_mul_f32 v236,v112,v228
v_mfma_f32_16x16x32_bf16 v[220:223],v[72:75],a[156:159],v[220:223]
v_mul_f32 v237,v113,v229
v_fma_f32 v236,v114,v230,v236
v_fma_f32 v237,v115,v231,v237
v_mfma_f32_16x16x32_bf16 v[192:195],v[76:79],a[160:163],v[192:195]
s_add_u32 s62,s69,49152
v_fma_f32 v236,v116,v232,v236
v_fma_f32 v237,v117,v233,v237
v_fma_f32 v236,v118,v234,v236
v_mfma_f32_16x16x32_bf16 v[196:199],v[76:79],a[164:167],v[196:199]
buffer_store_dwordx4 v[36:39],v5,s[8:11],s62 offen sc1
v_fma_f32 v237,v119,v235,v237
v_mfma_f32_16x16x32_bf16 v[200:203],v[76:79],a[168:171],v[200:203]
v_add_f32 v236,v236,v237
v_mfma_f32_16x16x32_bf16 v[204:207],v[76:79],a[172:175],v[204:207]
s_nop 0
v_add_f32_dpp v236,v236,v236 row_ror:8 row_mask:0xf bank_mask:0xf
v_mfma_f32_16x16x32_bf16 v[208:211],v[76:79],a[176:179],v[208:211]
s_nop 0
v_add_f32_dpp v236,v236,v236 row_ror:4 row_mask:0xf bank_mask:0xf
v_mfma_f32_16x16x32_bf16 v[212:215],v[76:79],a[180:183],v[212:215]
s_nop 0
v_add_f32_dpp v236,v236,v236 row_ror:2 row_mask:0xf bank_mask:0xf
v_mfma_f32_16x16x32_bf16 v[216:219],v[76:79],a[184:187],v[216:219]
s_nop 0
v_add_f32_dpp v236,v236,v236 row_ror:1 row_mask:0xf bank_mask:0xf
v_mov_b32 v237,v236
v_mfma_f32_16x16x32_bf16 v[220:223],v[76:79],a[188:191],v[220:223]
s_nop 0
v_permlane16_swap_b32 v236,v237
v_add_f32 v236,v236,v237
v_mov_b32 v237,v236
v_mfma_f32_16x16x32_bf16 v[192:195],v[80:83],a[192:195],v[192:195]
s_nop 0
v_permlane32_swap_b32 v236,v237
v_add_f32 v236,v236,v237
v_cvt_pk_bf16_f32 v236,v236,v236
v_mfma_f32_16x16x32_bf16 v[196:199],v[80:83],a[196:199],v[196:199]
v_and_b32 v236,0xffff0000,v236
v_ashrrev_i32 v237,31,v236
v_or_b32 v237,0x80000000,v237
v_mfma_f32_16x16x32_bf16 v[192:195],v[84:87],a[224:227],v[192:195]
v_xor_b32 v236,v236,v237
v_and_b32 v236,0xffff0000,v236
s_sub_u32 s20,4095,s18
v_mfma_f32_16x16x32_bf16 v[196:199],v[84:87],a[228:231],v[196:199]
v_or_b32 v20,s20,v236
s_lshl_b32 s73,s26,13
s_lshl2_add_u32 s73,s68,s73
v_mfma_f32_16x16x32_bf16 v[200:203],v[80:83],a[200:203],v[200:203]
s_add_u32 s73,s73,10485760
s_add_u32 s73,s73,s86
v_mfma_f32_16x16x32_bf16 v[204:207],v[80:83],a[204:207],v[204:207]
v_cvt_pk_bf16_f32 v40,v192,v196
v_cvt_pk_bf16_f32 v44,v193,v197
v_cvt_pk_bf16_f32 v48,v194,v198
v_mfma_f32_16x16x32_bf16 v[200:203],v[84:87],a[232:235],v[200:203]
v_cvt_pk_bf16_f32 v52,v195,v199
v_mfma_f32_16x16x32_bf16 v[204:207],v[84:87],a[236:239],v[204:207]
v_mfma_f32_16x16x32_bf16 v[208:211],v[80:83],a[208:211],v[208:211]
v_mfma_f32_16x16x32_bf16 v[212:215],v[80:83],a[212:215],v[212:215]
v_mfma_f32_16x16x32_bf16 v[208:211],v[84:87],a[240:243],v[208:211]
v_mfma_f32_16x16x32_bf16 v[212:215],v[84:87],a[244:247],v[212:215]
v_cvt_pk_bf16_f32 v41,v200,v204
v_cvt_pk_bf16_f32 v45,v201,v205
v_cvt_pk_bf16_f32 v49,v202,v206
v_mfma_f32_16x16x32_bf16 v[216:219],v[80:83],a[216:219],v[216:219]
v_cvt_pk_bf16_f32 v53,v203,v207
v_mfma_f32_16x16x32_bf16 v[220:223],v[80:83],a[220:223],v[220:223]
v_cvt_pk_bf16_f32 v42,v208,v212
v_cvt_pk_bf16_f32 v46,v209,v213
v_cvt_pk_bf16_f32 v50,v210,v214
v_mfma_f32_16x16x32_bf16 v[216:219],v[84:87],a[248:251],v[216:219]
v_cvt_pk_bf16_f32 v54,v211,v215
v_mfma_f32_16x16x32_bf16 v[220:223],v[84:87],a[252:255],v[220:223]
s_nop 7
v_cvt_pk_bf16_f32 v43,v216,v220
s_add_u32 s62,s69,262144
buffer_store_dwordx4 v[40:43],v5,s[8:11],s62 offen sc1
v_cvt_pk_bf16_f32 v47,v217,v221
s_add_u32 s62,s69,278528
buffer_store_dwordx4 v[44:47],v5,s[8:11],s62 offen sc1
v_cvt_pk_bf16_f32 v51,v218,v222
s_add_u32 s62,s69,294912
buffer_store_dwordx4 v[48:51],v5,s[8:11],s62 offen sc1
v_cvt_pk_bf16_f32 v55,v219,v223
s_add_u32 s62,s69,311296
buffer_store_dwordx4 v[52:55],v5,s[8:11],s62 offen sc1
s_cmp_lg_u32 s72,0
s_cbranch_scc1 L_aa_316
s_waitcnt vmcnt(9)
s_branch L_aa_326
L_av_328:
ds_read_b128 v[24:27],v4 offset:0
ds_read_b128 v[28:31],v4 offset:1024
s_min_u32 s56,s32,s33
s_cmp_lt_u32 s77,64
s_cselect_b32 s56,s56,0
s_cmp_eq_u32 s56,0
s_cselect_b32 s72,0x80000000,0
v_mov_b32 v248,s72
s_or_b32 s64,s70,s72
s_or_b32 s65,s71,s72
s_cmp_lt_u32 s30,s31
s_cselect_b32 s65,0x80000000,s65
s_add_u32 s64,s64,s28
s_add_u32 s65,s65,s29
s_xor_b32 s58,s67,s40
s_xor_b32 s57,s67,s41
s_add_u32 m0,s58,0
s_waitcnt lgkmcnt(1)
v_mfma_f32_16x16x32_bf16 v[160:163],v[24:27],a[0:3],0
buffer_load_dwordx4 v0,s[8:11],s64 offen offset:0 sc1 lds
v_mfma_f32_16x16x32_bf16 v[164:167],v[24:27],a[4:7],0
ds_read_b128 v[32:35],v4 offset:2048
s_lshl_b32 s23,s51,5
v_mfma_f32_16x16x32_bf16 v[168:171],v[24:27],a[8:11],0
ds_read_b128 v[36:39],v4 offset:3072
s_add_u32 s23,s23,s68
v_mfma_f32_16x16x32_bf16 v[172:175],v[24:27],a[12:15],0
ds_read_b128 v[40:43],v4 offset:8192
s_lshl_b32 s24,s23,10
v_mfma_f32_16x16x32_bf16 v[176:179],v[24:27],a[16:19],0
buffer_load_dwordx4 v0,s[8:11],s64 offen offset:1024 sc1 lds
v_mfma_f32_16x16x32_bf16 v[180:183],v[24:27],a[20:23],0
ds_read_b128 v[44:47],v4 offset:9216
s_lshl_b32 s25,s51,10
v_mfma_f32_16x16x32_bf16 v[184:187],v[24:27],a[24:27],0
ds_read_b128 v[48:51],v4 offset:10240
s_waitcnt vmcnt(9)
v_mfma_f32_16x16x32_bf16 v[188:191],v[24:27],a[28:31],0
ds_read_b128 v[52:55],v4 offset:11264
v_mfma_f32_16x16x32_bf16 v[128:131],v[156:159],v[192:195],0
ds_write_b32 v247,v248
s_add_u32 s25,s25,2883584
s_waitcnt lgkmcnt(7)
v_mfma_f32_16x16x32_bf16 v[160:163],v[28:31],a[32:35],v[160:163]
buffer_load_dwordx4 v0,s[8:11],s64 offen offset:2048 sc1 lds
v_mfma_f32_16x16x32_bf16 v[164:167],v[28:31],a[36:39],v[164:167]
ds_read_b128 v[56:59],v4 offset:4096
s_waitcnt vmcnt(9)
v_mfma_f32_16x16x32_bf16 v[168:171],v[28:31],a[40:43],v[168:171]
ds_read_b128 v[60:63],v4 offset:5120
v_mfma_f32_16x16x32_bf16 v[128:131],v[156:159],v[196:199],v[128:131]
ds_read_b128 v[64:67],v4 offset:6144
s_cmp_eq_u32 s23,s55
s_cselect_b32 s25,s25,s24
v_mfma_f32_16x16x32_bf16 v[172:175],v[28:31],a[44:47],v[172:175]
ds_read_b128 v[68:71],v4 offset:7168
s_waitcnt vmcnt(8)
v_mfma_f32_16x16x32_bf16 v[176:179],v[28:31],a[48:51],v[176:179]
buffer_load_dwordx4 v0,s[8:11],s64 offen offset:3072 sc1 lds
v_mfma_f32_16x16x32_bf16 v[180:183],v[28:31],a[52:55],v[180:183]
ds_read_b128 v[72:75],v4 offset:12288
v_mfma_f32_16x16x32_bf16 v[128:131],v[156:159],v[200:203],v[128:131]
ds_read_b128 v[76:79],v4 offset:13312
s_add_u32 s25,s25,8388608
v_mfma_f32_16x16x32_bf16 v[184:187],v[28:31],a[56:59],v[184:187]
ds_read_b128 v[80:83],v4 offset:14336
s_waitcnt vmcnt(8)
v_mfma_f32_16x16x32_bf16 v[188:191],v[28:31],a[60:63],v[188:191]
ds_read_b128 v[84:87],v4 offset:15360
v_mfma_f32_16x16x32_bf16 v[128:131],v[156:159],v[204:207],v[128:131]
s_mov_b32 s6,268435456
s_cmp_eq_u32 s31,0
s_cselect_b32 s25,s24,s25
s_cselect_b64 s[4:5],s[16:17],s[44:45]
s_cmov_b32 s6,2097152
s_waitcnt lgkmcnt(14)
v_mfma_f32_16x16x32_bf16 v[160:163],v[32:35],a[64:67],v[160:163]
buffer_load_dwordx4 v[224:227],v0,s[4:7],s25 offen sc1
v_mfma_f32_16x16x32_bf16 v[164:167],v[32:35],a[68:71],v[164:167]
s_waitcnt vmcnt(8)
v_mfma_f32_16x16x32_bf16 v[132:135],v[156:159],v[208:211],0
s_add_u32 m0,s58,4096
s_add_u32 s64,s64,4096
s_lshr_b32 s24,s55,5
v_mfma_f32_16x16x32_bf16 v[168:171],v[32:35],a[72:75],v[168:171]
buffer_load_dwordx4 v0,s[8:11],s64 offen offset:0 sc1 lds
v_mfma_f32_16x16x32_bf16 v[172:175],v[32:35],a[76:79],v[172:175]
s_waitcnt vmcnt(8)
v_mfma_f32_16x16x32_bf16 v[132:135],v[156:159],v[212:215],v[132:135]
s_cmp_lt_u32 s51,s24
s_cselect_b32 s24,1,2
v_mov_b32 v252,s24
v_mfma_f32_16x16x32_bf16 v[176:179],v[32:35],a[80:83],v[176:179]
s_waitcnt vmcnt(7)
v_mfma_f32_16x16x32_bf16 v[132:135],v[156:159],v[216:219],v[132:135]
s_lshl2_add_u32 s25,s51,11018240
s_lshl_b32 s24,s68,16
s_add_u32 s24,s24,s31
v_mfma_f32_16x16x32_bf16 v[180:183],v[32:35],a[84:87],v[180:183]
ds_write_b128 v6,v[128:131]
v_mfma_f32_16x16x32_bf16 v[184:187],v[32:35],a[88:91],v[184:187]
buffer_load_dwordx4 v0,s[8:11],s64 offen offset:1024 sc1 lds
v_mfma_f32_16x16x32_bf16 v[188:191],v[32:35],a[92:95],v[188:191]
s_waitcnt vmcnt(7)
v_mfma_f32_16x16x32_bf16 v[132:135],v[156:159],v[220:223],v[132:135]
s_add_u32 s24,s24,s86
s_cmp_eq_u32 s24,1537
s_cselect_b32 s25,s25,0x80000000
s_waitcnt lgkmcnt(14)
v_mfma_f32_16x16x32_bf16 v[160:163],v[36:39],a[96:99],v[160:163]
buffer_store_dword v252,off,s[8:11],s25 sc1
v_mfma_f32_16x16x32_bf16 v[164:167],v[36:39],a[100:103],v[164:167]
s_bitcmp1_b64 s[38:39],s51
s_cselect_b32 s24,128,0
s_lshl_b32 s23,s51,13
v_mfma_f32_16x16x32_bf16 v[168:171],v[36:39],a[104:107],v[168:171]
ds_write_b128 v6,v[132:135] offset:2048
v_mfma_f32_16x16x32_bf16 v[172:175],v[36:39],a[108:111],v[172:175]
buffer_load_dwordx4 v0,s[8:11],s64 offen offset:2048 sc1 lds
v_mfma_f32_16x16x32_bf16 v[176:179],v[36:39],a[112:115],v[176:179]
s_lshl2_add_u32 s23,s68,s23
s_add_u32 s23,s23,10487168
s_add_u32 s23,s23,s24
v_mfma_f32_16x16x32_bf16 v[180:183],v[36:39],a[116:119],v[180:183]
buffer_load_dword v246,off,s[8:11],s23 sc1
v_mfma_f32_16x16x32_bf16 v[184:187],v[36:39],a[120:123],v[184:187]
v_lshrrev_b32 v244,4,v1
s_sub_u32 s23,s77,8
v_mfma_f32_16x16x32_bf16 v[188:191],v[36:39],a[124:127],v[188:191]
buffer_load_dwordx4 v0,s[8:11],s64 offen offset:3072 sc1 lds
s_waitcnt lgkmcnt(14)
v_mfma_f32_16x16x32_bf16 v[160:163],v[40:43],a[128:131],v[160:163]
s_waitcnt lgkmcnt(0)
s_barrier
v_add_u32 v244,s23,v244
v_mfma_f32_16x16x32_bf16 v[164:167],v[40:43],a[132:135],v[164:167]
ds_read_b128 v[248:251],v245
v_max_i32 v244,0,v244
v_mfma_f32_16x16x32_bf16 v[168:171],v[40:43],a[136:139],v[168:171]
buffer_store_dword v20,off,s[8:11],s73 sc1
v_mfma_f32_16x16x32_bf16 v[172:175],v[40:43],a[140:143],v[172:175]
s_add_u32 m0,s58,8192
s_add_u32 s64,s64,4096
v_lshl_add_u32 v244,v244,13,v21
v_mfma_f32_16x16x32_bf16 v[176:179],v[40:43],a[144:147],v[176:179]
buffer_load_dwordx4 v0,s[8:11],s64 offen offset:0 sc1 lds
v_mfma_f32_16x16x32_bf16 v[180:183],v[40:43],a[148:151],v[180:183]
buffer_load_dwordx2 v[242:243],v244,s[8:11],0 offen sc1
v_mfma_f32_16x16x32_bf16 v[184:187],v[40:43],a[152:155],v[184:187]
s_mov_b32 s73,0x80000000
v_mfma_f32_16x16x32_bf16 v[188:191],v[40:43],a[156:159],v[188:191]
s_waitcnt lgkmcnt(0)
v_or3_b32 v248,v248,v249,v250
v_or_b32 v248,v248,v251
v_mfma_f32_16x16x32_bf16 v[160:163],v[44:47],a[160:163],v[160:163]
buffer_load_dwordx4 v0,s[8:11],s64 offen offset:1024 sc1 lds
v_mfma_f32_16x16x32_bf16 v[164:167],v[44:47],a[164:167],v[164:167]
v_mfma_f32_16x16x32_bf16 v[168:171],v[44:47],a[168:171],v[168:171]
v_readfirstlane_b32 s72,v248
v_mfma_f32_16x16x32_bf16 v[172:175],v[44:47],a[172:175],v[172:175]
v_mfma_f32_16x16x32_bf16 v[176:179],v[44:47],a[176:179],v[176:179]
buffer_load_dwordx4 v0,s[8:11],s64 offen offset:2048 sc1 lds
v_mfma_f32_16x16x32_bf16 v[180:183],v[44:47],a[180:183],v[180:183]
v_mfma_f32_16x16x32_bf16 v[184:187],v[44:47],a[184:187],v[184:187]
v_mfma_f32_16x16x32_bf16 v[188:191],v[44:47],a[188:191],v[188:191]
v_mfma_f32_16x16x32_bf16 v[160:163],v[48:51],a[192:195],v[160:163]
buffer_load_dwordx4 v0,s[8:11],s64 offen offset:3072 sc1 lds
v_mfma_f32_16x16x32_bf16 v[164:167],v[48:51],a[196:199],v[164:167]
v_mfma_f32_16x16x32_bf16 v[168:171],v[48:51],a[200:203],v[168:171]
v_mfma_f32_16x16x32_bf16 v[172:175],v[48:51],a[204:207],v[172:175]
v_mfma_f32_16x16x32_bf16 v[176:179],v[48:51],a[208:211],v[176:179]
s_add_u32 m0,s57,24576
v_mfma_f32_16x16x32_bf16 v[180:183],v[48:51],a[212:215],v[180:183]
buffer_load_dwordx4 v0,s[8:11],s65 offen offset:0 sc1 lds
v_mfma_f32_16x16x32_bf16 v[184:187],v[48:51],a[216:219],v[184:187]
v_mfma_f32_16x16x32_bf16 v[188:191],v[48:51],a[220:223],v[188:191]
v_mfma_f32_16x16x32_bf16 v[160:163],v[52:55],a[224:227],v[160:163]
v_mfma_f32_16x16x32_bf16 v[164:167],v[52:55],a[228:231],v[164:167]
buffer_load_dwordx4 v0,s[8:11],s65 offen offset:1024 sc1 lds
v_mfma_f32_16x16x32_bf16 v[168:171],v[52:55],a[232:235],v[168:171]
v_mfma_f32_16x16x32_bf16 v[172:175],v[52:55],a[236:239],v[172:175]
v_mfma_f32_16x16x32_bf16 v[176:179],v[52:55],a[240:243],v[176:179]
v_mfma_f32_16x16x32_bf16 v[180:183],v[52:55],a[244:247],v[180:183]
v_mfma_f32_16x16x32_bf16 v[184:187],v[52:55],a[248:251],v[184:187]
v_mfma_f32_16x16x32_bf16 v[188:191],v[52:55],a[252:255],v[188:191]
v_mfma_f32_16x16x32_bf16 v[192:195],v[56:59],a[0:3],0
v_mfma_f32_16x16x32_bf16 v[196:199],v[56:59],a[4:7],0
v_mfma_f32_16x16x32_bf16 v[200:203],v[56:59],a[8:11],0
v_cvt_pk_bf16_f32 v24,v160,v164
v_cvt_pk_bf16_f32 v25,v168,v172
v_mfma_f32_16x16x32_bf16 v[204:207],v[56:59],a[12:15],0
v_cvt_pk_bf16_f32 v26,v176,v180
v_cvt_pk_bf16_f32 v27,v184,v188
v_mfma_f32_16x16x32_bf16 v[208:211],v[56:59],a[16:19],0
v_cvt_pk_bf16_f32 v28,v161,v165
v_cvt_pk_bf16_f32 v29,v169,v173
v_mfma_f32_16x16x32_bf16 v[212:215],v[56:59],a[20:23],0
v_cvt_pk_bf16_f32 v30,v177,v181
v_cvt_pk_bf16_f32 v31,v185,v189
v_mfma_f32_16x16x32_bf16 v[216:219],v[56:59],a[24:27],0
v_cvt_pk_bf16_f32 v32,v162,v166
v_cvt_pk_bf16_f32 v33,v170,v174
v_mfma_f32_16x16x32_bf16 v[220:223],v[56:59],a[28:31],0
v_cvt_pk_bf16_f32 v34,v178,v182
v_cvt_pk_bf16_f32 v35,v186,v190
v_mfma_f32_16x16x32_bf16 v[192:195],v[60:63],a[32:35],v[192:195]
v_cvt_pk_bf16_f32 v36,v163,v167
v_cvt_pk_bf16_f32 v37,v171,v175
v_mfma_f32_16x16x32_bf16 v[196:199],v[60:63],a[36:39],v[196:199]
v_cvt_pk_bf16_f32 v38,v179,v183
v_cvt_pk_bf16_f32 v39,v187,v191
v_mfma_f32_16x16x32_bf16 v[200:203],v[60:63],a[40:43],v[200:203]
v_mfma_f32_16x16x32_bf16 v[204:207],v[60:63],a[44:47],v[204:207]
v_mfma_f32_16x16x32_bf16 v[208:211],v[60:63],a[48:51],v[208:211]
v_mfma_f32_16x16x32_bf16 v[212:215],v[60:63],a[52:55],v[212:215]
v_mfma_f32_16x16x32_bf16 v[216:219],v[60:63],a[56:59],v[216:219]
v_mfma_f32_16x16x32_bf16 v[220:223],v[60:63],a[60:63],v[220:223]
v_mfma_f32_16x16x32_bf16 v[192:195],v[64:67],a[64:67],v[192:195]
v_mfma_f32_16x16x32_bf16 v[196:199],v[64:67],a[68:71],v[196:199]
v_mfma_f32_16x16x32_bf16 v[200:203],v[64:67],a[72:75],v[200:203]
v_mfma_f32_16x16x32_bf16 v[204:207],v[64:67],a[76:79],v[204:207]
v_mfma_f32_16x16x32_bf16 v[208:211],v[64:67],a[80:83],v[208:211]
v_mfma_f32_16x16x32_bf16 v[212:215],v[64:67],a[84:87],v[212:215]
v_mfma_f32_16x16x32_bf16 v[216:219],v[64:67],a[88:91],v[216:219]
v_mfma_f32_16x16x32_bf16 v[220:223],v[64:67],a[92:95],v[220:223]
v_mfma_f32_16x16x32_bf16 v[192:195],v[68:71],a[96:99],v[192:195]
v_mfma_f32_16x16x32_bf16 v[196:199],v[68:71],a[100:103],v[196:199]
v_mfma_f32_16x16x32_bf16 v[200:203],v[68:71],a[104:107],v[200:203]
v_mfma_f32_16x16x32_bf16 v[204:207],v[68:71],a[108:111],v[204:207]
v_mfma_f32_16x16x32_bf16 v[208:211],v[68:71],a[112:115],v[208:211]
s_add_u32 s62,s69,0
v_mfma_f32_16x16x32_bf16 v[212:215],v[68:71],a[116:119],v[212:215]
buffer_store_dwordx4 v[24:27],v5,s[8:11],s62 offen sc1
v_mfma_f32_16x16x32_bf16 v[216:219],v[68:71],a[120:123],v[216:219]
v_mfma_f32_16x16x32_bf16 v[220:223],v[68:71],a[124:127],v[220:223]
v_mfma_f32_16x16x32_bf16 v[192:195],v[72:75],a[128:131],v[192:195]
v_mfma_f32_16x16x32_bf16 v[196:199],v[72:75],a[132:135],v[196:199]
s_add_u32 s62,s69,16384
v_mfma_f32_16x16x32_bf16 v[200:203],v[72:75],a[136:139],v[200:203]
buffer_store_dwordx4 v[28:31],v5,s[8:11],s62 offen sc1
v_mfma_f32_16x16x32_bf16 v[204:207],v[72:75],a[140:143],v[204:207]
v_mfma_f32_16x16x32_bf16 v[208:211],v[72:75],a[144:147],v[208:211]
v_mfma_f32_16x16x32_bf16 v[212:215],v[72:75],a[148:151],v[212:215]
v_mfma_f32_16x16x32_bf16 v[216:219],v[72:75],a[152:155],v[216:219]
s_add_u32 s62,s69,32768
v_mfma_f32_16x16x32_bf16 v[220:223],v[72:75],a[156:159],v[220:223]
buffer_store_dwordx4 v[32:35],v5,s[8:11],s62 offen sc1
v_mfma_f32_16x16x32_bf16 v[192:195],v[76:79],a[160:163],v[192:195]
v_mfma_f32_16x16x32_bf16 v[196:199],v[76:79],a[164:167],v[196:199]
v_mfma_f32_16x16x32_bf16 v[200:203],v[76:79],a[168:171],v[200:203]
v_mfma_f32_16x16x32_bf16 v[204:207],v[76:79],a[172:175],v[204:207]
s_add_u32 s62,s69,49152
v_mfma_f32_16x16x32_bf16 v[208:211],v[76:79],a[176:179],v[208:211]
buffer_store_dwordx4 v[36:39],v5,s[8:11],s62 offen sc1
v_mfma_f32_16x16x32_bf16 v[212:215],v[76:79],a[180:183],v[212:215]
v_mfma_f32_16x16x32_bf16 v[216:219],v[76:79],a[184:187],v[216:219]
v_mfma_f32_16x16x32_bf16 v[220:223],v[76:79],a[188:191],v[220:223]
v_mfma_f32_16x16x32_bf16 v[192:195],v[80:83],a[192:195],v[192:195]
v_mfma_f32_16x16x32_bf16 v[196:199],v[80:83],a[196:199],v[196:199]
v_mfma_f32_16x16x32_bf16 v[192:195],v[84:87],a[224:227],v[192:195]
v_mfma_f32_16x16x32_bf16 v[196:199],v[84:87],a[228:231],v[196:199]
v_mfma_f32_16x16x32_bf16 v[200:203],v[80:83],a[200:203],v[200:203]
v_mfma_f32_16x16x32_bf16 v[204:207],v[80:83],a[204:207],v[204:207]
v_mfma_f32_16x16x32_bf16 v[200:203],v[84:87],a[232:235],v[200:203]
v_mfma_f32_16x16x32_bf16 v[204:207],v[84:87],a[236:239],v[204:207]
v_cvt_pk_bf16_f32 v40,v192,v196
v_cvt_pk_bf16_f32 v44,v193,v197
v_cvt_pk_bf16_f32 v48,v194,v198
v_mfma_f32_16x16x32_bf16 v[208:211],v[80:83],a[208:211],v[208:211]
v_cvt_pk_bf16_f32 v52,v195,v199
v_mfma_f32_16x16x32_bf16 v[212:215],v[80:83],a[212:215],v[212:215]
v_cvt_pk_bf16_f32 v41,v200,v204
v_cvt_pk_bf16_f32 v45,v201,v205
v_cvt_pk_bf16_f32 v49,v202,v206
v_mfma_f32_16x16x32_bf16 v[208:211],v[84:87],a[240:243],v[208:211]
v_cvt_pk_bf16_f32 v53,v203,v207
v_mfma_f32_16x16x32_bf16 v[212:215],v[84:87],a[244:247],v[212:215]
v_mfma_f32_16x16x32_bf16 v[216:219],v[80:83],a[216:219],v[216:219]
v_mfma_f32_16x16x32_bf16 v[220:223],v[80:83],a[220:223],v[220:223]
v_mfma_f32_16x16x32_bf16 v[216:219],v[84:87],a[248:251],v[216:219]
v_mfma_f32_16x16x32_bf16 v[220:223],v[84:87],a[252:255],v[220:223]
v_cvt_pk_bf16_f32 v42,v208,v212
v_cvt_pk_bf16_f32 v46,v209,v213
v_cvt_pk_bf16_f32 v50,v210,v214
v_cvt_pk_bf16_f32 v54,v211,v215
s_nop 3
v_cvt_pk_bf16_f32 v43,v216,v220
s_add_u32 s62,s69,262144
buffer_store_dwordx4 v[40:43],v5,s[8:11],s62 offen sc1
v_cvt_pk_bf16_f32 v47,v217,v221
s_add_u32 s62,s69,278528
buffer_store_dwordx4 v[44:47],v5,s[8:11],s62 offen sc1
v_cvt_pk_bf16_f32 v51,v218,v222
s_add_u32 s62,s69,294912
buffer_store_dwordx4 v[48:51],v5,s[8:11],s62 offen sc1
v_cvt_pk_bf16_f32 v55,v219,v223
s_add_u32 s62,s69,311296
buffer_store_dwordx4 v[52:55],v5,s[8:11],s62 offen sc1
s_cmp_lg_u32 s72,0
s_cbranch_scc1 L_aa_316
s_waitcnt vmcnt(8)
s_branch L_aa_326
L_av_331:
s_bitcmp1_b32 s46,0
s_cbranch_scc1 L_av_332
ds_read_b128 v[24:27],v4 offset:0
ds_read_b128 v[28:31],v4 offset:1024
s_min_u32 s56,s32,s33
s_cmp_lt_u32 s77,64
s_cselect_b32 s56,s56,0
s_cmp_eq_u32 s56,0
s_cselect_b32 s72,0x80000000,0
v_mov_b32 v248,s72
s_or_b32 s64,s70,s72
s_or_b32 s65,s71,s72
s_cmp_lt_u32 s30,s31
s_cselect_b32 s65,0x80000000,s65
s_add_u32 s64,s64,s28
s_add_u32 s65,s65,s29
s_xor_b32 s58,s67,s40
s_xor_b32 s57,s67,s41
s_add_u32 m0,s58,0
s_waitcnt lgkmcnt(1)
v_mfma_f32_16x16x32_bf16 v[160:163],v[24:27],a[0:3],0
buffer_load_dwordx4 v0,s[8:11],s64 offen offset:0 sc1 lds
v_mfma_f32_16x16x32_bf16 v[164:167],v[24:27],a[4:7],0
ds_read_b128 v[32:35],v4 offset:2048
v_lshlrev_b32 v88,16,v224
v_mfma_f32_16x16x32_bf16 v[168:171],v[24:27],a[8:11],0
ds_read_b128 v[36:39],v4 offset:3072
v_and_b32 v89,0xffff0000,v224
v_mfma_f32_16x16x32_bf16 v[172:175],v[24:27],a[12:15],0
ds_read_b128 v[40:43],v4 offset:8192
v_lshlrev_b32 v90,16,v225
v_mfma_f32_16x16x32_bf16 v[176:179],v[24:27],a[16:19],0
buffer_load_dwordx4 v0,s[8:11],s64 offen offset:1024 sc1 lds
v_mfma_f32_16x16x32_bf16 v[180:183],v[24:27],a[20:23],0
ds_read_b128 v[44:47],v4 offset:9216
v_and_b32 v91,0xffff0000,v225
v_mfma_f32_16x16x32_bf16 v[184:187],v[24:27],a[24:27],0
ds_read_b128 v[48:51],v4 offset:10240
s_waitcnt vmcnt(9)
v_mfma_f32_16x16x32_bf16 v[188:191],v[24:27],a[28:31],0
ds_read_b128 v[52:55],v4 offset:11264
v_mfma_f32_16x16x32_bf16 v[128:131],v[156:159],v[192:195],0
ds_write_b32 v247,v248
v_lshlrev_b32 v92,16,v226
s_waitcnt lgkmcnt(7)
v_mfma_f32_16x16x32_bf16 v[160:163],v[28:31],a[32:35],v[160:163]
buffer_load_dwordx4 v0,s[8:11],s64 offen offset:2048 sc1 lds
v_mfma_f32_16x16x32_bf16 v[164:167],v[28:31],a[36:39],v[164:167]
ds_read_b128 v[56:59],v4 offset:4096
s_waitcnt vmcnt(9)
v_mfma_f32_16x16x32_bf16 v[168:171],v[28:31],a[40:43],v[168:171]
ds_read_b128 v[60:63],v4 offset:5120
v_mfma_f32_16x16x32_bf16 v[128:131],v[156:159],v[196:199],v[128:131]
ds_read_b128 v[64:67],v4 offset:6144
v_and_b32 v93,0xffff0000,v226
v_mfma_f32_16x16x32_bf16 v[172:175],v[28:31],a[44:47],v[172:175]
ds_read_b128 v[68:71],v4 offset:7168
s_waitcnt vmcnt(8)
v_mfma_f32_16x16x32_bf16 v[176:179],v[28:31],a[48:51],v[176:179]
buffer_load_dwordx4 v0,s[8:11],s64 offen offset:3072 sc1 lds
v_mfma_f32_16x16x32_bf16 v[180:183],v[28:31],a[52:55],v[180:183]
ds_read_b128 v[72:75],v4 offset:12288
v_mfma_f32_16x16x32_bf16 v[128:131],v[156:159],v[200:203],v[128:131]
ds_read_b128 v[76:79],v4 offset:13312
v_lshlrev_b32 v94,16,v227
v_mfma_f32_16x16x32_bf16 v[184:187],v[28:31],a[56:59],v[184:187]
ds_read_b128 v[80:83],v4 offset:14336
s_waitcnt vmcnt(8)
v_mfma_f32_16x16x32_bf16 v[188:191],v[28:31],a[60:63],v[188:191]
ds_read_b128 v[84:87],v4 offset:15360
v_mfma_f32_16x16x32_bf16 v[128:131],v[156:159],v[204:207],v[128:131]
v_and_b32 v95,0xffff0000,v227
s_lshl_b32 s18,s26,5
s_waitcnt lgkmcnt(14)
v_mfma_f32_16x16x32_bf16 v[160:163],v[32:35],a[64:67],v[160:163]
s_waitcnt vmcnt(7)
v_mfma_f32_16x16x32_bf16 v[132:135],v[156:159],v[208:211],0
s_add_u32 m0,s58,4096
s_add_u32 s64,s64,4096
s_add_u32 s18,s18,s68
v_mfma_f32_16x16x32_bf16 v[164:167],v[32:35],a[68:71],v[164:167]
buffer_load_dwordx4 v0,s[8:11],s64 offen offset:0 sc1 lds
v_mfma_f32_16x16x32_bf16 v[168:171],v[32:35],a[72:75],v[168:171]
s_waitcnt vmcnt(7)
v_mfma_f32_16x16x32_bf16 v[132:135],v[156:159],v[212:215],v[132:135]
s_lshl_b32 s19,s18,10
s_add_u32 s20,s19,8388608
s_lshl_b32 s23,s51,5
v_mfma_f32_16x16x32_bf16 v[172:175],v[32:35],a[76:79],v[172:175]
s_waitcnt vmcnt(6)
v_mfma_f32_16x16x32_bf16 v[132:135],v[156:159],v[216:219],v[132:135]
s_add_u32 s23,s23,s68
s_lshl_b32 s24,s23,10
s_lshl_b32 s25,s51,10
v_mfma_f32_16x16x32_bf16 v[176:179],v[32:35],a[80:83],v[176:179]
ds_write_b128 v6,v[128:131]
v_mfma_f32_16x16x32_bf16 v[180:183],v[32:35],a[84:87],v[180:183]
buffer_load_dwordx4 v0,s[8:11],s64 offen offset:1024 sc1 lds
v_mfma_f32_16x16x32_bf16 v[184:187],v[32:35],a[88:91],v[184:187]
s_waitcnt vmcnt(6)
v_mfma_f32_16x16x32_bf16 v[132:135],v[156:159],v[220:223],v[132:135]
s_add_u32 s25,s25,2883584
s_cmp_eq_u32 s23,s55
s_cselect_b32 s25,s25,s24
v_mfma_f32_16x16x32_bf16 v[188:191],v[32:35],a[92:95],v[188:191]
s_add_u32 s25,s25,8388608
s_mov_b32 s6,268435456
s_cmp_eq_u32 s31,0
s_cselect_b32 s25,s24,s25
s_cselect_b64 s[4:5],s[16:17],s[44:45]
s_cmov_b32 s6,2097152
s_waitcnt lgkmcnt(14)
v_mfma_f32_16x16x32_bf16 v[160:163],v[36:39],a[96:99],v[160:163]
buffer_load_dwordx4 v[224:227],v0,s[4:7],s25 offen sc1
v_mfma_f32_16x16x32_bf16 v[164:167],v[36:39],a[100:103],v[164:167]
ds_write_b128 v6,v[132:135] offset:2048
v_mfma_f32_16x16x32_bf16 v[168:171],v[36:39],a[104:107],v[168:171]
buffer_load_dwordx4 v0,s[8:11],s64 offen offset:2048 sc1 lds
v_mfma_f32_16x16x32_bf16 v[172:175],v[36:39],a[108:111],v[172:175]
s_lshr_b32 s24,s55,5
s_cmp_lt_u32 s51,s24
s_cselect_b32 s24,1,2
v_mfma_f32_16x16x32_bf16 v[176:179],v[36:39],a[112:115],v[176:179]
v_mov_b32 v252,s24
s_lshl2_add_u32 s25,s51,11018240
v_mfma_f32_16x16x32_bf16 v[180:183],v[36:39],a[116:119],v[180:183]
s_lshl_b32 s24,s68,16
s_add_u32 s24,s24,s31
s_add_u32 s24,s24,s86
v_mfma_f32_16x16x32_bf16 v[184:187],v[36:39],a[120:123],v[184:187]
buffer_load_dwordx4 v0,s[8:11],s64 offen offset:3072 sc1 lds
v_mfma_f32_16x16x32_bf16 v[188:191],v[36:39],a[124:127],v[188:191]
s_waitcnt lgkmcnt(0)
s_barrier
s_cmp_eq_u32 s24,1537
s_cselect_b32 s25,s25,0x80000000
s_waitcnt lgkmcnt(14)
v_mfma_f32_16x16x32_bf16 v[160:163],v[40:43],a[128:131],v[160:163]
ds_read_b128 v[96:99],v23
v_mfma_f32_16x16x32_bf16 v[164:167],v[40:43],a[132:135],v[164:167]
ds_read_b128 v[100:103],v23 offset:16
v_mfma_f32_16x16x32_bf16 v[168:171],v[40:43],a[136:139],v[168:171]
buffer_store_dword v20,off,s[8:11],s73 sc1
s_add_u32 m0,s58,8192
s_add_u32 s64,s64,4096
s_mov_b32 s73,0x80000000
v_mfma_f32_16x16x32_bf16 v[172:175],v[40:43],a[140:143],v[172:175]
buffer_load_dwordx4 v0,s[8:11],s64 offen offset:0 sc1 lds
v_mfma_f32_16x16x32_bf16 v[176:179],v[40:43],a[144:147],v[176:179]
ds_read_b128 v[248:251],v245
v_mfma_f32_16x16x32_bf16 v[180:183],v[40:43],a[148:151],v[180:183]
buffer_store_dword v252,off,s[8:11],s25 sc1
s_bitcmp1_b64 s[38:39],s51
s_cselect_b32 s24,128,0
s_lshl_b32 s23,s51,13
v_mfma_f32_16x16x32_bf16 v[184:187],v[40:43],a[152:155],v[184:187]
s_lshl2_add_u32 s23,s68,s23
s_add_u32 s23,s23,10487168
s_add_u32 s23,s23,s24
v_mfma_f32_16x16x32_bf16 v[188:191],v[40:43],a[156:159],v[188:191]
buffer_load_dwordx4 v0,s[8:11],s64 offen offset:1024 sc1 lds
s_waitcnt lgkmcnt(1)
v_cvt_pk_bf16_f32 v104,v96,v97
v_cvt_pk_bf16_f32 v105,v98,v99
v_mfma_f32_16x16x32_bf16 v[160:163],v[44:47],a[160:163],v[160:163]
buffer_load_dword v246,off,s[8:11],s23 sc1
v_cvt_pk_bf16_f32 v106,v100,v101
v_cvt_pk_bf16_f32 v107,v102,v103
v_lshlrev_b32 v96,16,v104
v_mfma_f32_16x16x32_bf16 v[164:167],v[44:47],a[164:167],v[164:167]
v_and_b32 v97,0xffff0000,v104
v_lshlrev_b32 v98,16,v105
v_and_b32 v99,0xffff0000,v105
v_lshlrev_b32 v100,16,v106
v_and_b32 v101,0xffff0000,v106
v_mfma_f32_16x16x32_bf16 v[168:171],v[44:47],a[168:171],v[168:171]
s_waitcnt lgkmcnt(0)
v_lshlrev_b32 v102,16,v107
v_and_b32 v103,0xffff0000,v107
v_add_f32 v88,v88,v96
v_add_f32 v89,v89,v97
v_add_f32 v90,v90,v98
v_mfma_f32_16x16x32_bf16 v[172:175],v[44:47],a[172:175],v[172:175]
buffer_load_dwordx4 v0,s[8:11],s64 offen offset:2048 sc1 lds
v_add_f32 v91,v91,v99
v_add_f32 v92,v92,v100
v_add_f32 v93,v93,v101
v_mfma_f32_16x16x32_bf16 v[176:179],v[44:47],a[176:179],v[176:179]
v_add_f32 v94,v94,v102
v_add_f32 v95,v95,v103
v_cvt_pk_bf16_f32 v104,v88,v89
v_cvt_pk_bf16_f32 v105,v90,v91
v_cvt_pk_bf16_f32 v106,v92,v93
v_mfma_f32_16x16x32_bf16 v[180:183],v[44:47],a[180:183],v[180:183]
v_cvt_pk_bf16_f32 v107,v94,v95
v_lshlrev_b32 v88,16,v104
v_and_b32 v89,0xffff0000,v104
v_lshlrev_b32 v90,16,v105
v_and_b32 v91,0xffff0000,v105
v_mfma_f32_16x16x32_bf16 v[184:187],v[44:47],a[184:187],v[184:187]
v_lshlrev_b32 v92,16,v106
v_and_b32 v93,0xffff0000,v106
v_lshlrev_b32 v94,16,v107
v_and_b32 v95,0xffff0000,v107
v_readfirstlane_b32 s78,v88
v_mfma_f32_16x16x32_bf16 v[188:191],v[44:47],a[188:191],v[188:191]
buffer_load_dwordx4 v0,s[8:11],s64 offen offset:3072 sc1 lds
v_add_f32 v120,v88,-s78
v_add_f32 v121,v89,-s78
v_add_f32 v122,v90,-s78
v_mfma_f32_16x16x32_bf16 v[160:163],v[48:51],a[192:195],v[160:163]
v_add_f32 v123,v91,-s78
v_add_f32 v124,v92,-s78
v_add_f32 v125,v93,-s78
v_add_f32 v126,v94,-s78
v_add_f32 v127,v95,-s78
v_mfma_f32_16x16x32_bf16 v[164:167],v[48:51],a[196:199],v[164:167]
v_add_f32 v128,v120,v122
v_add_f32 v129,v121,v123
v_mul_f32 v130,v120,v120
v_mul_f32 v131,v121,v121
v_add_f32 v132,v124,v126
v_mfma_f32_16x16x32_bf16 v[168:171],v[48:51],a[200:203],v[168:171]
v_add_f32 v133,v125,v127
v_fma_f32 v130,v122,v122,v130
v_fma_f32 v131,v123,v123,v131
v_add_f32 v128,v128,v132
v_add_f32 v129,v129,v133
v_mfma_f32_16x16x32_bf16 v[172:175],v[48:51],a[204:207],v[172:175]
v_fma_f32 v130,v124,v124,v130
v_fma_f32 v131,v125,v125,v131
v_add_f32 v128,v128,v129
v_fma_f32 v130,v126,v126,v130
v_fma_f32 v131,v127,v127,v131
v_mfma_f32_16x16x32_bf16 v[176:179],v[48:51],a[208:211],v[176:179]
v_add_f32 v130,v130,v131
v_or3_b32 v248,v248,v249,v250
v_or_b32 v248,v248,v251
v_permlane32_swap_b32 v128,v130
v_add_f32 v128,v128,v130
v_mfma_f32_16x16x32_bf16 v[180:183],v[48:51],a[212:215],v[180:183]
s_nop 0
v_add_f32_dpp v128,v128,v128 row_ror:8 row_mask:0xf bank_mask:0xf
v_lshrrev_b32 v244,4,v1
s_sub_u32 s23,s77,8
v_add_f32_dpp v128,v128,v128 row_ror:4 row_mask:0xf bank_mask:0xf
v_add_u32 v244,s23,v244
v_mfma_f32_16x16x32_bf16 v[184:187],v[48:51],a[216:219],v[184:187]
v_add_f32_dpp v128,v128,v128 row_ror:2 row_mask:0xf bank_mask:0xf
v_readfirstlane_b32 s72,v248
v_max_i32 v244,0,v244
v_add_f32_dpp v128,v128,v128 row_ror:1 row_mask:0xf bank_mask:0xf
v_mov_b32 v130,v128
v_mfma_f32_16x16x32_bf16 v[188:191],v[48:51],a[220:223],v[188:191]
s_nop 0
v_permlane16_swap_b32 v128,v130
v_add_f32 v128,v128,v130
v_mul_f32 v128,0x3b000000,v128
v_mov_b32 v130,v128
v_lshl_add_u32 v244,v244,13,v21
v_mfma_f32_16x16x32_bf16 v[160:163],v[52:55],a[224:227],v[160:163]
buffer_load_dwordx2 v[242:243],v244,s[8:11],0 offen sc1
v_permlane32_swap_b32 v128,v130
v_fma_f32 v130,-v128,v128,v130
v_add_f32 v128,s78,v128
v_mfma_f32_16x16x32_bf16 v[164:167],v[52:55],a[228:231],v[164:167]
v_max_f32 v130,0,v130
v_cvt_pk_bf16_f32 v130,v128,v130
v_lshlrev_b32 v128,16,v130
v_and_b32 v130,0xffff0000,v130
v_add_f32 v130,0x3727c5ac,v130
v_mfma_f32_16x16x32_bf16 v[168:171],v[52:55],a[232:235],v[168:171]
v_cvt_pk_bf16_f32 v130,v130,v130
v_and_b32 v130,0xffff0000,v130
v_sqrt_f32 v130,v130
v_add_f32 v120,v88,-v128
v_add_f32 v121,v89,-v128
v_mfma_f32_16x16x32_bf16 v[172:175],v[52:55],a[236:239],v[172:175]
v_add_f32 v122,v90,-v128
v_add_f32 v123,v91,-v128
v_add_f32 v124,v92,-v128
v_add_f32 v125,v93,-v128
v_add_f32 v126,v94,-v128
v_mfma_f32_16x16x32_bf16 v[176:179],v[52:55],a[240:243],v[176:179]
v_add_f32 v127,v95,-v128
v_cvt_pk_bf16_f32 v130,v130,v130
v_and_b32 v130,0xffff0000,v130
v_rcp_f32 v130,v130
v_cvt_pk_bf16_f32 v108,v120,v121
v_mfma_f32_16x16x32_bf16 v[180:183],v[52:55],a[244:247],v[180:183]
v_cvt_pk_bf16_f32 v109,v122,v123
v_cvt_pk_bf16_f32 v110,v124,v125
v_cvt_pk_bf16_f32 v111,v126,v127
v_lshlrev_b32 v120,16,v108
v_and_b32 v121,0xffff0000,v108
v_mfma_f32_16x16x32_bf16 v[184:187],v[52:55],a[248:251],v[184:187]
v_lshlrev_b32 v122,16,v109
v_and_b32 v123,0xffff0000,v109
v_lshlrev_b32 v124,16,v110
v_and_b32 v125,0xffff0000,v110
v_lshlrev_b32 v126,16,v111
v_mfma_f32_16x16x32_bf16 v[188:191],v[52:55],a[252:255],v[188:191]
v_and_b32 v127,0xffff0000,v111
v_mul_f32 v120,v120,v130
v_mul_f32 v121,v121,v130
v_mul_f32 v122,v122,v130
v_mul_f32 v123,v123,v130
v_mfma_f32_16x16x32_bf16 v[192:195],v[56:59],a[0:3],0
v_mul_f32 v124,v124,v130
v_mul_f32 v125,v125,v130
v_mul_f32 v126,v126,v130
v_mul_f32 v127,v127,v130
v_cvt_pk_bf16_f32 v108,v120,v121
v_mfma_f32_16x16x32_bf16 v[196:199],v[56:59],a[4:7],0
v_cvt_pk_bf16_f32 v109,v122,v123
v_cvt_pk_bf16_f32 v110,v124,v125
v_cvt_pk_bf16_f32 v111,v126,v127
v_lshlrev_b32 v112,16,v108
v_and_b32 v113,0xffff0000,v108
v_mfma_f32_16x16x32_bf16 v[200:203],v[56:59],a[8:11],0
v_lshlrev_b32 v114,16,v109
v_and_b32 v115,0xffff0000,v109
v_lshlrev_b32 v116,16,v110
v_and_b32 v117,0xffff0000,v110
v_lshlrev_b32 v118,16,v111
v_mfma_f32_16x16x32_bf16 v[204:207],v[56:59],a[12:15],0
v_and_b32 v119,0xffff0000,v111
v_add_f32 v88,v88,v112
v_add_f32 v89,v89,v113
v_add_f32 v90,v90,v114
v_add_f32 v91,v91,v115
v_mfma_f32_16x16x32_bf16 v[208:211],v[56:59],a[16:19],0
v_add_f32 v92,v92,v116
v_add_f32 v93,v93,v117
v_add_f32 v94,v94,v118
v_add_f32 v95,v95,v119
v_cvt_pk_bf16_f32 v96,v88,v89
v_mfma_f32_16x16x32_bf16 v[212:215],v[56:59],a[20:23],0
v_cvt_pk_bf16_f32 v97,v90,v91
v_cvt_pk_bf16_f32 v98,v92,v93
v_cvt_pk_bf16_f32 v99,v94,v95
v_cvt_pk_bf16_f32 v24,v160,v164
v_cvt_pk_bf16_f32 v25,v168,v172
v_mfma_f32_16x16x32_bf16 v[216:219],v[56:59],a[24:27],0
buffer_store_dwordx4 v[96:99],v0,s[8:11],s20 offen sc1
v_lshlrev_b32 v88,16,v96
v_and_b32 v89,0xffff0000,v96
v_lshlrev_b32 v90,16,v97
v_mfma_f32_16x16x32_bf16 v[220:223],v[56:59],a[28:31],0
v_and_b32 v91,0xffff0000,v97
v_lshlrev_b32 v92,16,v98
v_and_b32 v93,0xffff0000,v98
v_lshlrev_b32 v94,16,v99
v_and_b32 v95,0xffff0000,v99
v_mfma_f32_16x16x32_bf16 v[192:195],v[60:63],a[32:35],v[192:195]
v_readfirstlane_b32 s78,v88
v_cvt_pk_bf16_f32 v26,v176,v180
v_cvt_pk_bf16_f32 v27,v184,v188
v_add_f32 v120,v88,-s78
v_add_f32 v121,v89,-s78
v_mfma_f32_16x16x32_bf16 v[196:199],v[60:63],a[36:39],v[196:199]
v_add_f32 v122,v90,-s78
v_add_f32 v123,v91,-s78
v_add_f32 v124,v92,-s78
v_add_f32 v125,v93,-s78
v_add_f32 v126,v94,-s78
v_mfma_f32_16x16x32_bf16 v[200:203],v[60:63],a[40:43],v[200:203]
v_add_f32 v127,v95,-s78
v_add_f32 v128,v120,v122
v_add_f32 v129,v121,v123
v_mul_f32 v130,v120,v120
v_mul_f32 v131,v121,v121
v_mfma_f32_16x16x32_bf16 v[204:207],v[60:63],a[44:47],v[204:207]
v_add_f32 v132,v124,v126
v_add_f32 v133,v125,v127
v_fma_f32 v130,v122,v122,v130
v_fma_f32 v131,v123,v123,v131
v_add_f32 v128,v128,v132
v_mfma_f32_16x16x32_bf16 v[208:211],v[60:63],a[48:51],v[208:211]
v_add_f32 v129,v129,v133
v_fma_f32 v130,v124,v124,v130
v_fma_f32 v131,v125,v125,v131
v_add_f32 v128,v128,v129
v_fma_f32 v130,v126,v126,v130
v_mfma_f32_16x16x32_bf16 v[212:215],v[60:63],a[52:55],v[212:215]
v_fma_f32 v131,v127,v127,v131
v_add_f32 v130,v130,v131
v_cvt_pk_bf16_f32 v28,v161,v165
v_cvt_pk_bf16_f32 v29,v169,v173
v_permlane32_swap_b32 v128,v130
v_mfma_f32_16x16x32_bf16 v[216:219],v[60:63],a[56:59],v[216:219]
v_add_f32 v128,v128,v130
v_cvt_pk_bf16_f32 v30,v177,v181
v_cvt_pk_bf16_f32 v31,v185,v189
v_add_f32_dpp v128,v128,v128 row_ror:8 row_mask:0xf bank_mask:0xf
v_cvt_pk_bf16_f32 v32,v162,v166
v_mfma_f32_16x16x32_bf16 v[220:223],v[60:63],a[60:63],v[220:223]
v_add_f32_dpp v128,v128,v128 row_ror:4 row_mask:0xf bank_mask:0xf
v_cvt_pk_bf16_f32 v33,v170,v174
v_cvt_pk_bf16_f32 v34,v178,v182
v_add_f32_dpp v128,v128,v128 row_ror:2 row_mask:0xf bank_mask:0xf
v_cvt_pk_bf16_f32 v35,v186,v190
v_mfma_f32_16x16x32_bf16 v[192:195],v[64:67],a[64:67],v[192:195]
v_add_f32_dpp v128,v128,v128 row_ror:1 row_mask:0xf bank_mask:0xf
v_mov_b32 v130,v128
v_cvt_pk_bf16_f32 v36,v163,v167
v_cvt_pk_bf16_f32 v37,v171,v175
v_permlane16_swap_b32 v128,v130
v_mfma_f32_16x16x32_bf16 v[196:199],v[64:67],a[68:71],v[196:199]
v_add_f32 v128,v128,v130
v_mul_f32 v128,0x3b000000,v128
v_mov_b32 v130,v128
v_cvt_pk_bf16_f32 v38,v179,v183
v_cvt_pk_bf16_f32 v39,v187,v191
v_mfma_f32_16x16x32_bf16 v[200:203],v[64:67],a[72:75],v[200:203]
v_permlane32_swap_b32 v128,v130
v_fma_f32 v130,-v128,v128,v130
v_add_f32 v128,s78,v128
v_max_f32 v130,0,v130
v_cvt_pk_bf16_f32 v130,v128,v130
v_mfma_f32_16x16x32_bf16 v[204:207],v[64:67],a[76:79],v[204:207]
v_lshlrev_b32 v128,16,v130
v_and_b32 v130,0xffff0000,v130
v_add_f32 v130,0x3727c5ac,v130
v_cvt_pk_bf16_f32 v130,v130,v130
v_and_b32 v130,0xffff0000,v130
v_mfma_f32_16x16x32_bf16 v[208:211],v[64:67],a[80:83],v[208:211]
v_sqrt_f32 v130,v130
v_add_f32 v120,v88,-v128
v_add_f32 v121,v89,-v128
v_add_f32 v122,v90,-v128
v_add_f32 v123,v91,-v128
v_mfma_f32_16x16x32_bf16 v[212:215],v[64:67],a[84:87],v[212:215]
v_add_f32 v124,v92,-v128
v_add_f32 v125,v93,-v128
v_add_f32 v126,v94,-v128
v_add_f32 v127,v95,-v128
v_cvt_pk_bf16_f32 v130,v130,v130
v_mfma_f32_16x16x32_bf16 v[216:219],v[64:67],a[88:91],v[216:219]
v_and_b32 v130,0xffff0000,v130
v_rcp_f32 v130,v130
v_cvt_pk_bf16_f32 v100,v120,v121
v_cvt_pk_bf16_f32 v101,v122,v123
v_cvt_pk_bf16_f32 v102,v124,v125
v_mfma_f32_16x16x32_bf16 v[220:223],v[64:67],a[92:95],v[220:223]
v_cvt_pk_bf16_f32 v103,v126,v127
v_lshlrev_b32 v120,16,v100
v_and_b32 v121,0xffff0000,v100
v_lshlrev_b32 v122,16,v101
v_and_b32 v123,0xffff0000,v101
v_mfma_f32_16x16x32_bf16 v[192:195],v[68:71],a[96:99],v[192:195]
v_lshlrev_b32 v124,16,v102
v_and_b32 v125,0xffff0000,v102
v_lshlrev_b32 v126,16,v103
v_and_b32 v127,0xffff0000,v103
v_mul_f32 v120,v120,v130
v_mfma_f32_16x16x32_bf16 v[196:199],v[68:71],a[100:103],v[196:199]
v_mul_f32 v121,v121,v130
v_mul_f32 v122,v122,v130
v_mul_f32 v123,v123,v130
v_mul_f32 v124,v124,v130
v_mul_f32 v125,v125,v130
v_mfma_f32_16x16x32_bf16 v[200:203],v[68:71],a[104:107],v[200:203]
v_mul_f32 v126,v126,v130
v_mul_f32 v127,v127,v130
v_cvt_pk_bf16_f32 v100,v120,v121
v_cvt_pk_bf16_f32 v101,v122,v123
v_cvt_pk_bf16_f32 v102,v124,v125
v_mfma_f32_16x16x32_bf16 v[204:207],v[68:71],a[108:111],v[204:207]
v_cvt_pk_bf16_f32 v103,v126,v127
s_add_u32 s20,s19,2097152
v_mfma_f32_16x16x32_bf16 v[208:211],v[68:71],a[112:115],v[208:211]
buffer_store_dwordx4 v[100:103],v0,s[8:11],s20 offen sc1
v_mov_b32 v20,1
s_lshl_b32 s73,s26,13
s_lshl2_add_u32 s73,s68,s73
v_mfma_f32_16x16x32_bf16 v[212:215],v[68:71],a[116:119],v[212:215]
s_add_u32 s73,s73,10487552
s_add_u32 s62,s69,0
v_mfma_f32_16x16x32_bf16 v[216:219],v[68:71],a[120:123],v[216:219]
buffer_store_dwordx4 v[24:27],v5,s[8:11],s62 offen sc1
v_mfma_f32_16x16x32_bf16 v[220:223],v[68:71],a[124:127],v[220:223]
v_mfma_f32_16x16x32_bf16 v[192:195],v[72:75],a[128:131],v[192:195]
v_mfma_f32_16x16x32_bf16 v[196:199],v[72:75],a[132:135],v[196:199]
v_mfma_f32_16x16x32_bf16 v[200:203],v[72:75],a[136:139],v[200:203]
s_add_u32 s62,s69,16384
v_mfma_f32_16x16x32_bf16 v[204:207],v[72:75],a[140:143],v[204:207]
buffer_store_dwordx4 v[28:31],v5,s[8:11],s62 offen sc1
v_mfma_f32_16x16x32_bf16 v[208:211],v[72:75],a[144:147],v[208:211]
v_mfma_f32_16x16x32_bf16 v[212:215],v[72:75],a[148:151],v[212:215]
v_mfma_f32_16x16x32_bf16 v[216:219],v[72:75],a[152:155],v[216:219]
v_mfma_f32_16x16x32_bf16 v[220:223],v[72:75],a[156:159],v[220:223]
s_add_u32 s62,s69,32768
v_mfma_f32_16x16x32_bf16 v[192:195],v[76:79],a[160:163],v[192:195]
buffer_store_dwordx4 v[32:35],v5,s[8:11],s62 offen sc1
v_mfma_f32_16x16x32_bf16 v[196:199],v[76:79],a[164:167],v[196:199]
v_mfma_f32_16x16x32_bf16 v[200:203],v[76:79],a[168:171],v[200:203]
v_mfma_f32_16x16x32_bf16 v[204:207],v[76:79],a[172:175],v[204:207]
v_mfma_f32_16x16x32_bf16 v[208:211],v[76:79],a[176:179],v[208:211]
s_add_u32 s62,s69,49152
v_mfma_f32_16x16x32_bf16 v[212:215],v[76:79],a[180:183],v[212:215]
buffer_store_dwordx4 v[36:39],v5,s[8:11],s62 offen sc1
v_mfma_f32_16x16x32_bf16 v[216:219],v[76:79],a[184:187],v[216:219]
v_mfma_f32_16x16x32_bf16 v[220:223],v[76:79],a[188:191],v[220:223]
v_mfma_f32_16x16x32_bf16 v[192:195],v[80:83],a[192:195],v[192:195]
v_mfma_f32_16x16x32_bf16 v[196:199],v[80:83],a[196:199],v[196:199]
v_mfma_f32_16x16x32_bf16 v[192:195],v[84:87],a[224:227],v[192:195]
v_mfma_f32_16x16x32_bf16 v[196:199],v[84:87],a[228:231],v[196:199]
v_mfma_f32_16x16x32_bf16 v[200:203],v[80:83],a[200:203],v[200:203]
v_mfma_f32_16x16x32_bf16 v[204:207],v[80:83],a[204:207],v[204:207]
v_mfma_f32_16x16x32_bf16 v[200:203],v[84:87],a[232:235],v[200:203]
v_mfma_f32_16x16x32_bf16 v[204:207],v[84:87],a[236:239],v[204:207]
v_cvt_pk_bf16_f32 v40,v192,v196
v_cvt_pk_bf16_f32 v44,v193,v197
v_mfma_f32_16x16x32_bf16 v[208:211],v[80:83],a[208:211],v[208:211]
v_cvt_pk_bf16_f32 v48,v194,v198
v_cvt_pk_bf16_f32 v52,v195,v199
v_mfma_f32_16x16x32_bf16 v[212:215],v[80:83],a[212:215],v[212:215]
v_cvt_pk_bf16_f32 v41,v200,v204
v_cvt_pk_bf16_f32 v45,v201,v205
v_mfma_f32_16x16x32_bf16 v[208:211],v[84:87],a[240:243],v[208:211]
v_cvt_pk_bf16_f32 v49,v202,v206
v_cvt_pk_bf16_f32 v53,v203,v207
v_mfma_f32_16x16x32_bf16 v[212:215],v[84:87],a[244:247],v[212:215]
v_mfma_f32_16x16x32_bf16 v[216:219],v[80:83],a[216:219],v[216:219]
v_mfma_f32_16x16x32_bf16 v[220:223],v[80:83],a[220:223],v[220:223]
v_mfma_f32_16x16x32_bf16 v[216:219],v[84:87],a[248:251],v[216:219]
v_mfma_f32_16x16x32_bf16 v[220:223],v[84:87],a[252:255],v[220:223]
v_cvt_pk_bf16_f32 v42,v208,v212
v_cvt_pk_bf16_f32 v46,v209,v213
v_cvt_pk_bf16_f32 v50,v210,v214
v_cvt_pk_bf16_f32 v54,v211,v215
s_nop 3
v_cvt_pk_bf16_f32 v43,v216,v220
s_add_u32 s62,s69,262144
buffer_store_dwordx4 v[40:43],v5,s[8:11],s62 offen sc1
v_cvt_pk_bf16_f32 v47,v217,v221
s_add_u32 s62,s69,278528
buffer_store_dwordx4 v[44:47],v5,s[8:11],s62 offen sc1
v_cvt_pk_bf16_f32 v51,v218,v222
s_add_u32 s62,s69,294912
buffer_store_dwordx4 v[48:51],v5,s[8:11],s62 offen sc1
v_cvt_pk_bf16_f32 v55,v219,v223
s_add_u32 s62,s69,311296
buffer_store_dwordx4 v[52:55],v5,s[8:11],s62 offen sc1
s_waitcnt vmcnt(8)
buffer_store_dword v20,off,s[8:11],s73 sc1
s_mov_b32 s73,0x80000000
s_cmp_lg_u32 s72,0
s_cbranch_scc1 L_aa_316
s_waitcnt vmcnt(12)
s_branch L_aa_326
L_av_332:
ds_read_b128 v[24:27],v4 offset:0
ds_read_b128 v[28:31],v4 offset:1024
s_min_u32 s56,s32,s33
s_cmp_lt_u32 s77,64
s_cselect_b32 s56,s56,0
s_cmp_eq_u32 s56,0
s_cselect_b32 s72,0x80000000,0
v_mov_b32 v248,s72
s_or_b32 s64,s70,s72
s_or_b32 s65,s71,s72
s_cmp_lt_u32 s30,s31
s_cselect_b32 s65,0x80000000,s65
s_add_u32 s64,s64,s28
s_add_u32 s65,s65,s29
s_xor_b32 s58,s67,s40
s_xor_b32 s57,s67,s41
s_add_u32 m0,s58,0
s_waitcnt lgkmcnt(1)
v_mfma_f32_16x16x32_bf16 v[160:163],v[24:27],a[0:3],0
buffer_load_dwordx4 v0,s[8:11],s64 offen offset:0 sc1 lds
v_mfma_f32_16x16x32_bf16 v[164:167],v[24:27],a[4:7],0
ds_read_b128 v[32:35],v4 offset:2048
v_lshlrev_b32 v88,16,v224
v_mfma_f32_16x16x32_bf16 v[168:171],v[24:27],a[8:11],0
ds_read_b128 v[36:39],v4 offset:3072
v_and_b32 v89,0xffff0000,v224
v_mfma_f32_16x16x32_bf16 v[172:175],v[24:27],a[12:15],0
ds_read_b128 v[40:43],v4 offset:8192
v_lshlrev_b32 v90,16,v225
v_mfma_f32_16x16x32_bf16 v[176:179],v[24:27],a[16:19],0
buffer_load_dwordx4 v0,s[8:11],s64 offen offset:1024 sc1 lds
v_mfma_f32_16x16x32_bf16 v[180:183],v[24:27],a[20:23],0
ds_read_b128 v[44:47],v4 offset:9216
v_and_b32 v91,0xffff0000,v225
v_mfma_f32_16x16x32_bf16 v[184:187],v[24:27],a[24:27],0
ds_read_b128 v[48:51],v4 offset:10240
s_waitcnt vmcnt(9)
v_mfma_f32_16x16x32_bf16 v[188:191],v[24:27],a[28:31],0
ds_read_b128 v[52:55],v4 offset:11264
v_mfma_f32_16x16x32_bf16 v[128:131],v[156:159],v[192:195],0
ds_write_b32 v247,v248
v_lshlrev_b32 v92,16,v226
s_waitcnt lgkmcnt(7)
v_mfma_f32_16x16x32_bf16 v[160:163],v[28:31],a[32:35],v[160:163]
buffer_load_dwordx4 v0,s[8:11],s64 offen offset:2048 sc1 lds
v_mfma_f32_16x16x32_bf16 v[164:167],v[28:31],a[36:39],v[164:167]
ds_read_b128 v[56:59],v4 offset:4096
s_waitcnt vmcnt(9)
v_mfma_f32_16x16x32_bf16 v[168:171],v[28:31],a[40:43],v[168:171]
ds_read_b128 v[60:63],v4 offset:5120
v_mfma_f32_16x16x32_bf16 v[128:131],v[156:159],v[196:199],v[128:131]
ds_read_b128 v[64:67],v4 offset:6144
v_and_b32 v93,0xffff0000,v226
v_mfma_f32_16x16x32_bf16 v[172:175],v[28:31],a[44:47],v[172:175]
ds_read_b128 v[68:71],v4 offset:7168
s_waitcnt vmcnt(8)
v_mfma_f32_16x16x32_bf16 v[176:179],v[28:31],a[48:51],v[176:179]
buffer_load_dwordx4 v0,s[8:11],s64 offen offset:3072 sc1 lds
v_mfma_f32_16x16x32_bf16 v[180:183],v[28:31],a[52:55],v[180:183]
ds_read_b128 v[72:75],v4 offset:12288
v_mfma_f32_16x16x32_bf16 v[128:131],v[156:159],v[200:203],v[128:131]
ds_read_b128 v[76:79],v4 offset:13312
v_lshlrev_b32 v94,16,v227
v_mfma_f32_16x16x32_bf16 v[184:187],v[28:31],a[56:59],v[184:187]
ds_read_b128 v[80:83],v4 offset:14336
s_waitcnt vmcnt(8)
v_mfma_f32_16x16x32_bf16 v[188:191],v[28:31],a[60:63],v[188:191]
ds_read_b128 v[84:87],v4 offset:15360
v_mfma_f32_16x16x32_bf16 v[128:131],v[156:159],v[204:207],v[128:131]
v_and_b32 v95,0xffff0000,v227
s_lshl_b32 s18,s26,5
s_waitcnt lgkmcnt(14)
v_mfma_f32_16x16x32_bf16 v[160:163],v[32:35],a[64:67],v[160:163]
s_waitcnt vmcnt(7)
v_mfma_f32_16x16x32_bf16 v[132:135],v[156:159],v[208:211],0
s_add_u32 m0,s58,4096
s_add_u32 s64,s64,4096
s_add_u32 s18,s18,s68
v_mfma_f32_16x16x32_bf16 v[164:167],v[32:35],a[68:71],v[164:167]
buffer_load_dwordx4 v0,s[8:11],s64 offen offset:0 sc1 lds
v_mfma_f32_16x16x32_bf16 v[168:171],v[32:35],a[72:75],v[168:171]
s_waitcnt vmcnt(7)
v_mfma_f32_16x16x32_bf16 v[132:135],v[156:159],v[212:215],v[132:135]
s_lshl_b32 s19,s18,10
s_add_u32 s20,s19,4194304
s_lshl_b32 s23,s51,5
v_mfma_f32_16x16x32_bf16 v[172:175],v[32:35],a[76:79],v[172:175]
s_waitcnt vmcnt(6)
v_mfma_f32_16x16x32_bf16 v[132:135],v[156:159],v[216:219],v[132:135]
s_add_u32 s23,s23,s68
s_lshl_b32 s24,s23,10
s_lshl_b32 s25,s51,10
v_mfma_f32_16x16x32_bf16 v[176:179],v[32:35],a[80:83],v[176:179]
ds_write_b128 v6,v[128:131]
v_mfma_f32_16x16x32_bf16 v[180:183],v[32:35],a[84:87],v[180:183]
buffer_load_dwordx4 v0,s[8:11],s64 offen offset:1024 sc1 lds
v_mfma_f32_16x16x32_bf16 v[184:187],v[32:35],a[88:91],v[184:187]
s_waitcnt vmcnt(6)
v_mfma_f32_16x16x32_bf16 v[132:135],v[156:159],v[220:223],v[132:135]
s_add_u32 s25,s25,2883584
s_cmp_eq_u32 s23,s55
s_cselect_b32 s25,s25,s24
v_mfma_f32_16x16x32_bf16 v[188:191],v[32:35],a[92:95],v[188:191]
s_add_u32 s25,s25,8388608
s_mov_b32 s6,268435456
s_cmp_eq_u32 s31,0
s_cselect_b32 s25,s24,s25
s_cselect_b64 s[4:5],s[16:17],s[44:45]
s_cmov_b32 s6,2097152
s_waitcnt lgkmcnt(14)
v_mfma_f32_16x16x32_bf16 v[160:163],v[36:39],a[96:99],v[160:163]
buffer_load_dwordx4 v[224:227],v0,s[4:7],s25 offen sc1
v_mfma_f32_16x16x32_bf16 v[164:167],v[36:39],a[100:103],v[164:167]
ds_write_b128 v6,v[132:135] offset:2048
v_mfma_f32_16x16x32_bf16 v[168:171],v[36:39],a[104:107],v[168:171]
buffer_load_dwordx4 v0,s[8:11],s64 offen offset:2048 sc1 lds
v_mfma_f32_16x16x32_bf16 v[172:175],v[36:39],a[108:111],v[172:175]
s_lshr_b32 s24,s55,5
s_cmp_lt_u32 s51,s24
s_cselect_b32 s24,1,2
v_mfma_f32_16x16x32_bf16 v[176:179],v[36:39],a[112:115],v[176:179]
v_mov_b32 v252,s24
s_lshl2_add_u32 s25,s51,11018240
v_mfma_f32_16x16x32_bf16 v[180:183],v[36:39],a[116:119],v[180:183]
s_lshl_b32 s24,s68,16
s_add_u32 s24,s24,s31
s_add_u32 s24,s24,s86
v_mfma_f32_16x16x32_bf16 v[184:187],v[36:39],a[120:123],v[184:187]
buffer_load_dwordx4 v0,s[8:11],s64 offen offset:3072 sc1 lds
v_mfma_f32_16x16x32_bf16 v[188:191],v[36:39],a[124:127],v[188:191]
s_waitcnt lgkmcnt(0)
s_barrier
s_cmp_eq_u32 s24,1537
s_cselect_b32 s25,s25,0x80000000
s_waitcnt lgkmcnt(14)
v_mfma_f32_16x16x32_bf16 v[160:163],v[40:43],a[128:131],v[160:163]
ds_read_b128 v[96:99],v23
v_mfma_f32_16x16x32_bf16 v[164:167],v[40:43],a[132:135],v[164:167]
ds_read_b128 v[100:103],v23 offset:16
v_mfma_f32_16x16x32_bf16 v[168:171],v[40:43],a[136:139],v[168:171]
buffer_store_dword v20,off,s[8:11],s73 sc1
s_add_u32 m0,s58,8192
s_add_u32 s64,s64,4096
s_mov_b32 s73,0x80000000
v_mfma_f32_16x16x32_bf16 v[172:175],v[40:43],a[140:143],v[172:175]
buffer_load_dwordx4 v0,s[8:11],s64 offen offset:0 sc1 lds
v_mfma_f32_16x16x32_bf16 v[176:179],v[40:43],a[144:147],v[176:179]
ds_read_b128 v[248:251],v245
v_mfma_f32_16x16x32_bf16 v[180:183],v[40:43],a[148:151],v[180:183]
buffer_store_dword v252,off,s[8:11],s25 sc1
s_bitcmp1_b64 s[38:39],s51
s_cselect_b32 s24,128,0
s_lshl_b32 s23,s51,13
v_mfma_f32_16x16x32_bf16 v[184:187],v[40:43],a[152:155],v[184:187]
s_lshl2_add_u32 s23,s68,s23
s_add_u32 s23,s23,10487168
s_add_u32 s23,s23,s24
v_mfma_f32_16x16x32_bf16 v[188:191],v[40:43],a[156:159],v[188:191]
buffer_load_dwordx4 v0,s[8:11],s64 offen offset:1024 sc1 lds
s_waitcnt lgkmcnt(1)
v_cvt_pk_bf16_f32 v104,v96,v97
v_cvt_pk_bf16_f32 v105,v98,v99
v_mfma_f32_16x16x32_bf16 v[160:163],v[44:47],a[160:163],v[160:163]
buffer_load_dword v246,off,s[8:11],s23 sc1
v_cvt_pk_bf16_f32 v106,v100,v101
v_cvt_pk_bf16_f32 v107,v102,v103
v_lshlrev_b32 v96,16,v104
v_mfma_f32_16x16x32_bf16 v[164:167],v[44:47],a[164:167],v[164:167]
v_and_b32 v97,0xffff0000,v104
v_lshlrev_b32 v98,16,v105
v_and_b32 v99,0xffff0000,v105
v_lshlrev_b32 v100,16,v106
v_and_b32 v101,0xffff0000,v106
v_mfma_f32_16x16x32_bf16 v[168:171],v[44:47],a[168:171],v[168:171]
s_waitcnt lgkmcnt(0)
v_lshlrev_b32 v102,16,v107
v_and_b32 v103,0xffff0000,v107
v_add_f32 v88,v88,v96
v_add_f32 v89,v89,v97
v_add_f32 v90,v90,v98
v_mfma_f32_16x16x32_bf16 v[172:175],v[44:47],a[172:175],v[172:175]
buffer_load_dwordx4 v0,s[8:11],s64 offen offset:2048 sc1 lds
v_add_f32 v91,v91,v99
v_add_f32 v92,v92,v100
v_add_f32 v93,v93,v101
v_mfma_f32_16x16x32_bf16 v[176:179],v[44:47],a[176:179],v[176:179]
v_add_f32 v94,v94,v102
v_add_f32 v95,v95,v103
v_cvt_pk_bf16_f32 v104,v88,v89
v_cvt_pk_bf16_f32 v105,v90,v91
v_cvt_pk_bf16_f32 v106,v92,v93
v_mfma_f32_16x16x32_bf16 v[180:183],v[44:47],a[180:183],v[180:183]
v_cvt_pk_bf16_f32 v107,v94,v95
v_or3_b32 v248,v248,v249,v250
v_or_b32 v248,v248,v251
v_lshrrev_b32 v244,4,v1
s_sub_u32 s23,s77,8
v_mfma_f32_16x16x32_bf16 v[184:187],v[44:47],a[184:187],v[184:187]
buffer_store_dwordx4 v[104:107],v0,s[8:11],s20 offen sc1
v_lshlrev_b32 v88,16,v104
v_and_b32 v89,0xffff0000,v104
v_lshlrev_b32 v90,16,v105
v_mfma_f32_16x16x32_bf16 v[188:191],v[44:47],a[188:191],v[188:191]
buffer_load_dwordx4 v0,s[8:11],s64 offen offset:3072 sc1 lds
v_and_b32 v91,0xffff0000,v105
v_lshlrev_b32 v92,16,v106
v_and_b32 v93,0xffff0000,v106
v_mfma_f32_16x16x32_bf16 v[160:163],v[48:51],a[192:195],v[160:163]
v_lshlrev_b32 v94,16,v107
v_and_b32 v95,0xffff0000,v107
v_readfirstlane_b32 s78,v88
v_readfirstlane_b32 s72,v248
v_add_u32 v244,s23,v244
v_mfma_f32_16x16x32_bf16 v[164:167],v[48:51],a[196:199],v[164:167]
v_add_f32 v120,v88,-s78
v_add_f32 v121,v89,-s78
v_add_f32 v122,v90,-s78
v_add_f32 v123,v91,-s78
v_add_f32 v124,v92,-s78
v_mfma_f32_16x16x32_bf16 v[168:171],v[48:51],a[200:203],v[168:171]
v_add_f32 v125,v93,-s78
v_add_f32 v126,v94,-s78
v_add_f32 v127,v95,-s78
v_add_f32 v128,v120,v122
v_add_f32 v129,v121,v123
v_mfma_f32_16x16x32_bf16 v[172:175],v[48:51],a[204:207],v[172:175]
v_mul_f32 v130,v120,v120
v_mul_f32 v131,v121,v121
v_add_f32 v132,v124,v126
v_add_f32 v133,v125,v127
v_fma_f32 v130,v122,v122,v130
v_mfma_f32_16x16x32_bf16 v[176:179],v[48:51],a[208:211],v[176:179]
v_fma_f32 v131,v123,v123,v131
v_add_f32 v128,v128,v132
v_add_f32 v129,v129,v133
v_fma_f32 v130,v124,v124,v130
v_fma_f32 v131,v125,v125,v131
v_mfma_f32_16x16x32_bf16 v[180:183],v[48:51],a[212:215],v[180:183]
v_add_f32 v128,v128,v129
v_fma_f32 v130,v126,v126,v130
v_fma_f32 v131,v127,v127,v131
v_add_f32 v130,v130,v131
v_max_i32 v244,0,v244
v_mfma_f32_16x16x32_bf16 v[184:187],v[48:51],a[216:219],v[184:187]
v_permlane32_swap_b32 v128,v130
v_add_f32 v128,v128,v130
v_lshl_add_u32 v244,v244,13,v21
v_mfma_f32_16x16x32_bf16 v[188:191],v[48:51],a[220:223],v[188:191]
buffer_load_dwordx2 v[242:243],v244,s[8:11],0 offen sc1
v_add_f32_dpp v128,v128,v128 row_ror:8 row_mask:0xf bank_mask:0xf
v_mfma_f32_16x16x32_bf16 v[160:163],v[52:55],a[224:227],v[160:163]
s_nop 0
v_add_f32_dpp v128,v128,v128 row_ror:4 row_mask:0xf bank_mask:0xf
v_mfma_f32_16x16x32_bf16 v[164:167],v[52:55],a[228:231],v[164:167]
s_nop 0
v_add_f32_dpp v128,v128,v128 row_ror:2 row_mask:0xf bank_mask:0xf
v_mfma_f32_16x16x32_bf16 v[168:171],v[52:55],a[232:235],v[168:171]
s_nop 0
v_add_f32_dpp v128,v128,v128 row_ror:1 row_mask:0xf bank_mask:0xf
v_mov_b32 v130,v128
v_mfma_f32_16x16x32_bf16 v[172:175],v[52:55],a[236:239],v[172:175]
s_nop 0
v_permlane16_swap_b32 v128,v130
v_add_f32 v128,v128,v130
v_mul_f32 v128,0x3b000000,v128
v_mov_b32 v130,v128
v_mfma_f32_16x16x32_bf16 v[176:179],v[52:55],a[240:243],v[176:179]
s_nop 0
v_permlane32_swap_b32 v128,v130
v_fma_f32 v130,-v128,v128,v130
v_add_f32 v128,s78,v128
v_max_f32 v130,0,v130
v_cvt_pk_bf16_f32 v130,v128,v130
v_mfma_f32_16x16x32_bf16 v[180:183],v[52:55],a[244:247],v[180:183]
v_lshlrev_b32 v128,16,v130
v_and_b32 v130,0xffff0000,v130
v_add_f32 v130,0x3727c5ac,v130
v_cvt_pk_bf16_f32 v130,v130,v130
v_and_b32 v130,0xffff0000,v130
v_mfma_f32_16x16x32_bf16 v[184:187],v[52:55],a[248:251],v[184:187]
v_sqrt_f32 v130,v130
v_add_f32 v120,v88,-v128
v_add_f32 v121,v89,-v128
v_add_f32 v122,v90,-v128
v_add_f32 v123,v91,-v128
v_mfma_f32_16x16x32_bf16 v[188:191],v[52:55],a[252:255],v[188:191]
v_add_f32 v124,v92,-v128
v_add_f32 v125,v93,-v128
v_add_f32 v126,v94,-v128
v_add_f32 v127,v95,-v128
v_cvt_pk_bf16_f32 v130,v130,v130
v_mfma_f32_16x16x32_bf16 v[192:195],v[56:59],a[0:3],0
v_and_b32 v130,0xffff0000,v130
v_rcp_f32 v130,v130
v_cvt_pk_bf16_f32 v108,v120,v121
v_cvt_pk_bf16_f32 v109,v122,v123
v_cvt_pk_bf16_f32 v110,v124,v125
v_mfma_f32_16x16x32_bf16 v[196:199],v[56:59],a[4:7],0
v_cvt_pk_bf16_f32 v111,v126,v127
v_lshlrev_b32 v120,16,v108
v_and_b32 v121,0xffff0000,v108
v_lshlrev_b32 v122,16,v109
v_and_b32 v123,0xffff0000,v109
v_mfma_f32_16x16x32_bf16 v[200:203],v[56:59],a[8:11],0
v_lshlrev_b32 v124,16,v110
v_and_b32 v125,0xffff0000,v110
v_lshlrev_b32 v126,16,v111
v_and_b32 v127,0xffff0000,v111
v_mul_f32 v120,v120,v130
v_mfma_f32_16x16x32_bf16 v[204:207],v[56:59],a[12:15],0
v_mul_f32 v121,v121,v130
v_mul_f32 v122,v122,v130
v_mul_f32 v123,v123,v130
v_mul_f32 v124,v124,v130
v_mul_f32 v125,v125,v130
v_mfma_f32_16x16x32_bf16 v[208:211],v[56:59],a[16:19],0
v_mul_f32 v126,v126,v130
v_mul_f32 v127,v127,v130
v_cvt_pk_bf16_f32 v108,v120,v121
v_cvt_pk_bf16_f32 v109,v122,v123
v_cvt_pk_bf16_f32 v110,v124,v125
v_mfma_f32_16x16x32_bf16 v[212:215],v[56:59],a[20:23],0
v_cvt_pk_bf16_f32 v111,v126,v127
v_lshlrev_b32 v112,16,v108
v_and_b32 v113,0xffff0000,v108
v_lshlrev_b32 v114,16,v109
v_and_b32 v115,0xffff0000,v109
v_mfma_f32_16x16x32_bf16 v[216:219],v[56:59],a[24:27],0
v_lshlrev_b32 v116,16,v110
v_and_b32 v117,0xffff0000,v110
v_lshlrev_b32 v118,16,v111
v_and_b32 v119,0xffff0000,v111
v_mul_f32 v236,v112,v228
v_mfma_f32_16x16x32_bf16 v[220:223],v[56:59],a[28:31],0
v_mul_f32 v237,v113,v229
v_fma_f32 v236,v114,v230,v236
v_fma_f32 v237,v115,v231,v237
v_fma_f32 v236,v116,v232,v236
v_fma_f32 v237,v117,v233,v237
v_mfma_f32_16x16x32_bf16 v[192:195],v[60:63],a[32:35],v[192:195]
v_fma_f32 v236,v118,v234,v236
v_fma_f32 v237,v119,v235,v237
v_add_f32 v236,v236,v237
v_cvt_pk_bf16_f32 v24,v160,v164
v_cvt_pk_bf16_f32 v25,v168,v172
v_mfma_f32_16x16x32_bf16 v[196:199],v[60:63],a[36:39],v[196:199]
v_add_f32_dpp v236,v236,v236 row_ror:8 row_mask:0xf bank_mask:0xf
v_cvt_pk_bf16_f32 v26,v176,v180
v_cvt_pk_bf16_f32 v27,v184,v188
v_add_f32_dpp v236,v236,v236 row_ror:4 row_mask:0xf bank_mask:0xf
v_cvt_pk_bf16_f32 v28,v161,v165
v_mfma_f32_16x16x32_bf16 v[200:203],v[60:63],a[40:43],v[200:203]
v_add_f32_dpp v236,v236,v236 row_ror:2 row_mask:0xf bank_mask:0xf
v_cvt_pk_bf16_f32 v29,v169,v173
v_cvt_pk_bf16_f32 v30,v177,v181
v_add_f32_dpp v236,v236,v236 row_ror:1 row_mask:0xf bank_mask:0xf
v_mov_b32 v237,v236
v_mfma_f32_16x16x32_bf16 v[204:207],v[60:63],a[44:47],v[204:207]
s_nop 0
v_permlane16_swap_b32 v236,v237
v_add_f32 v236,v236,v237
v_mov_b32 v237,v236
v_cvt_pk_bf16_f32 v31,v185,v189
v_cvt_pk_bf16_f32 v32,v162,v166
v_mfma_f32_16x16x32_bf16 v[208:211],v[60:63],a[48:51],v[208:211]
v_permlane32_swap_b32 v236,v237
v_add_f32 v236,v236,v237
v_cvt_pk_bf16_f32 v236,v236,v236
v_and_b32 v236,0xffff0000,v236
v_ashrrev_i32 v237,31,v236
v_mfma_f32_16x16x32_bf16 v[212:215],v[60:63],a[52:55],v[212:215]
v_or_b32 v237,0x80000000,v237
v_xor_b32 v236,v236,v237
v_and_b32 v236,0xffff0000,v236
s_sub_u32 s20,4095,s18
v_or_b32 v20,s20,v236
v_mfma_f32_16x16x32_bf16 v[216:219],v[60:63],a[56:59],v[216:219]
s_lshl_b32 s20,s26,13
s_lshl2_add_u32 s20,s68,s20
s_add_u32 s20,s20,10485760
v_mfma_f32_16x16x32_bf16 v[220:223],v[60:63],a[60:63],v[220:223]
buffer_store_dword v20,v254,s[8:11],s20 offen sc1
v_mfma_f32_16x16x32_bf16 v[192:195],v[64:67],a[64:67],v[192:195]
v_cvt_pk_bf16_f32 v33,v170,v174
v_cvt_pk_bf16_f32 v34,v178,v182
v_mfma_f32_16x16x32_bf16 v[196:199],v[64:67],a[68:71],v[196:199]
v_cvt_pk_bf16_f32 v35,v186,v190
v_cvt_pk_bf16_f32 v36,v163,v167
v_mfma_f32_16x16x32_bf16 v[200:203],v[64:67],a[72:75],v[200:203]
v_cvt_pk_bf16_f32 v37,v171,v175
v_cvt_pk_bf16_f32 v38,v179,v183
v_mfma_f32_16x16x32_bf16 v[204:207],v[64:67],a[76:79],v[204:207]
v_cvt_pk_bf16_f32 v39,v187,v191
v_mfma_f32_16x16x32_bf16 v[208:211],v[64:67],a[80:83],v[208:211]
v_mfma_f32_16x16x32_bf16 v[212:215],v[64:67],a[84:87],v[212:215]
v_mfma_f32_16x16x32_bf16 v[216:219],v[64:67],a[88:91],v[216:219]
v_mfma_f32_16x16x32_bf16 v[220:223],v[64:67],a[92:95],v[220:223]
v_mfma_f32_16x16x32_bf16 v[192:195],v[68:71],a[96:99],v[192:195]
v_mfma_f32_16x16x32_bf16 v[196:199],v[68:71],a[100:103],v[196:199]
v_mfma_f32_16x16x32_bf16 v[200:203],v[68:71],a[104:107],v[200:203]
v_mfma_f32_16x16x32_bf16 v[204:207],v[68:71],a[108:111],v[204:207]
v_mfma_f32_16x16x32_bf16 v[208:211],v[68:71],a[112:115],v[208:211]
s_add_u32 s62,s69,0
v_mfma_f32_16x16x32_bf16 v[212:215],v[68:71],a[116:119],v[212:215]
buffer_store_dwordx4 v[24:27],v5,s[8:11],s62 offen sc1
v_mfma_f32_16x16x32_bf16 v[216:219],v[68:71],a[120:123],v[216:219]
v_mfma_f32_16x16x32_bf16 v[220:223],v[68:71],a[124:127],v[220:223]
v_mfma_f32_16x16x32_bf16 v[192:195],v[72:75],a[128:131],v[192:195]
v_mfma_f32_16x16x32_bf16 v[196:199],v[72:75],a[132:135],v[196:199]
s_add_u32 s62,s69,16384
v_mfma_f32_16x16x32_bf16 v[200:203],v[72:75],a[136:139],v[200:203]
buffer_store_dwordx4 v[28:31],v5,s[8:11],s62 offen sc1
v_mfma_f32_16x16x32_bf16 v[204:207],v[72:75],a[140:143],v[204:207]
v_mfma_f32_16x16x32_bf16 v[208:211],v[72:75],a[144:147],v[208:211]
v_mfma_f32_16x16x32_bf16 v[212:215],v[72:75],a[148:151],v[212:215]
v_mfma_f32_16x16x32_bf16 v[216:219],v[72:75],a[152:155],v[216:219]
s_add_u32 s62,s69,32768
v_mfma_f32_16x16x32_bf16 v[220:223],v[72:75],a[156:159],v[220:223]
buffer_store_dwordx4 v[32:35],v5,s[8:11],s62 offen sc1
v_mfma_f32_16x16x32_bf16 v[192:195],v[76:79],a[160:163],v[192:195]
v_mfma_f32_16x16x32_bf16 v[196:199],v[76:79],a[164:167],v[196:199]
v_mfma_f32_16x16x32_bf16 v[200:203],v[76:79],a[168:171],v[200:203]
v_mfma_f32_16x16x32_bf16 v[204:207],v[76:79],a[172:175],v[204:207]
s_add_u32 s62,s69,49152
v_mfma_f32_16x16x32_bf16 v[208:211],v[76:79],a[176:179],v[208:211]
buffer_store_dwordx4 v[36:39],v5,s[8:11],s62 offen sc1
v_mfma_f32_16x16x32_bf16 v[212:215],v[76:79],a[180:183],v[212:215]
v_mfma_f32_16x16x32_bf16 v[216:219],v[76:79],a[184:187],v[216:219]
v_mfma_f32_16x16x32_bf16 v[220:223],v[76:79],a[188:191],v[220:223]
v_mfma_f32_16x16x32_bf16 v[192:195],v[80:83],a[192:195],v[192:195]
v_mfma_f32_16x16x32_bf16 v[196:199],v[80:83],a[196:199],v[196:199]
v_mfma_f32_16x16x32_bf16 v[192:195],v[84:87],a[224:227],v[192:195]
v_mfma_f32_16x16x32_bf16 v[196:199],v[84:87],a[228:231],v[196:199]
v_mfma_f32_16x16x32_bf16 v[200:203],v[80:83],a[200:203],v[200:203]
v_mfma_f32_16x16x32_bf16 v[204:207],v[80:83],a[204:207],v[204:207]
v_mfma_f32_16x16x32_bf16 v[200:203],v[84:87],a[232:235],v[200:203]
v_mfma_f32_16x16x32_bf16 v[204:207],v[84:87],a[236:239],v[204:207]
v_cvt_pk_bf16_f32 v40,v192,v196
v_cvt_pk_bf16_f32 v44,v193,v197
v_mfma_f32_16x16x32_bf16 v[208:211],v[80:83],a[208:211],v[208:211]
v_cvt_pk_bf16_f32 v48,v194,v198
v_cvt_pk_bf16_f32 v52,v195,v199
v_mfma_f32_16x16x32_bf16 v[212:215],v[80:83],a[212:215],v[212:215]
v_cvt_pk_bf16_f32 v41,v200,v204
v_cvt_pk_bf16_f32 v45,v201,v205
v_mfma_f32_16x16x32_bf16 v[208:211],v[84:87],a[240:243],v[208:211]
v_cvt_pk_bf16_f32 v49,v202,v206
v_cvt_pk_bf16_f32 v53,v203,v207
v_mfma_f32_16x16x32_bf16 v[212:215],v[84:87],a[244:247],v[212:215]
v_mfma_f32_16x16x32_bf16 v[216:219],v[80:83],a[216:219],v[216:219]
v_mfma_f32_16x16x32_bf16 v[220:223],v[80:83],a[220:223],v[220:223]
v_mfma_f32_16x16x32_bf16 v[216:219],v[84:87],a[248:251],v[216:219]
v_mfma_f32_16x16x32_bf16 v[220:223],v[84:87],a[252:255],v[220:223]
v_cvt_pk_bf16_f32 v42,v208,v212
v_cvt_pk_bf16_f32 v46,v209,v213
v_cvt_pk_bf16_f32 v50,v210,v214
v_cvt_pk_bf16_f32 v54,v211,v215
s_nop 3
v_cvt_pk_bf16_f32 v43,v216,v220
s_add_u32 s62,s69,262144
buffer_store_dwordx4 v[40:43],v5,s[8:11],s62 offen sc1
v_cvt_pk_bf16_f32 v47,v217,v221
s_add_u32 s62,s69,278528
buffer_store_dwordx4 v[44:47],v5,s[8:11],s62 offen sc1
v_cvt_pk_bf16_f32 v51,v218,v222
s_add_u32 s62,s69,294912
buffer_store_dwordx4 v[48:51],v5,s[8:11],s62 offen sc1
v_cvt_pk_bf16_f32 v55,v219,v223
s_add_u32 s62,s69,311296
buffer_store_dwordx4 v[52:55],v5,s[8:11],s62 offen sc1
s_cmp_lg_u32 s72,0
s_cbranch_scc1 L_aa_316
s_waitcnt vmcnt(10)
s_branch L_aa_326
L_aa_314:
ds_read_b128 v[24:27],v4 offset:0
ds_read_b128 v[28:31],v4 offset:1024
s_min_u32 s56,s32,s33
s_cmp_lt_u32 s77,64
s_cselect_b32 s56,s56,0
s_cmp_eq_u32 s56,0
s_cselect_b32 s72,0x80000000,0
v_mov_b32 v248,s72
s_or_b32 s64,s70,s72
s_or_b32 s65,s71,s72
s_cmp_lt_u32 s30,s31
s_cselect_b32 s65,0x80000000,s65
s_add_u32 s64,s64,s28
s_add_u32 s65,s65,s29
s_xor_b32 s58,s67,s40
s_xor_b32 s57,s67,s41
s_add_u32 m0,s58,0
s_waitcnt lgkmcnt(1)
v_mfma_f32_16x16x32_bf16 v[160:163],v[24:27],a[0:3],0
buffer_load_dwordx4 v0,s[8:11],s64 offen offset:0 sc1 lds
v_mfma_f32_16x16x32_bf16 v[164:167],v[24:27],a[4:7],0
ds_read_b128 v[32:35],v4 offset:2048
s_lshl_b32 s23,s51,5
v_mfma_f32_16x16x32_bf16 v[168:171],v[24:27],a[8:11],0
ds_read_b128 v[36:39],v4 offset:3072
s_add_u32 s23,s23,s68
v_mfma_f32_16x16x32_bf16 v[172:175],v[24:27],a[12:15],0
ds_read_b128 v[40:43],v4 offset:8192
s_lshl_b32 s24,s23,10
v_mfma_f32_16x16x32_bf16 v[176:179],v[24:27],a[16:19],0
buffer_load_dwordx4 v0,s[8:11],s64 offen offset:1024 sc1 lds
v_mfma_f32_16x16x32_bf16 v[180:183],v[24:27],a[20:23],0
ds_read_b128 v[44:47],v4 offset:9216
s_lshl_b32 s25,s51,10
v_mfma_f32_16x16x32_bf16 v[184:187],v[24:27],a[24:27],0
ds_read_b128 v[48:51],v4 offset:10240
s_add_u32 s25,s25,2883584
v_mfma_f32_16x16x32_bf16 v[188:191],v[24:27],a[28:31],0
ds_read_b128 v[52:55],v4 offset:11264
s_cmp_eq_u32 s23,s55
s_cselect_b32 s25,s25,s24
s_waitcnt lgkmcnt(6)
v_mfma_f32_16x16x32_bf16 v[160:163],v[28:31],a[32:35],v[160:163]
buffer_load_dwordx4 v0,s[8:11],s64 offen offset:2048 sc1 lds
v_mfma_f32_16x16x32_bf16 v[164:167],v[28:31],a[36:39],v[164:167]
ds_write_b32 v247,v248
s_add_u32 s25,s25,8388608
v_mfma_f32_16x16x32_bf16 v[168:171],v[28:31],a[40:43],v[168:171]
ds_read_b128 v[56:59],v4 offset:4096
s_mov_b32 s6,268435456
v_mfma_f32_16x16x32_bf16 v[172:175],v[28:31],a[44:47],v[172:175]
ds_read_b128 v[60:63],v4 offset:5120
s_cmp_eq_u32 s31,0
s_cselect_b32 s25,s24,s25
s_cselect_b64 s[4:5],s[16:17],s[44:45]
s_cmov_b32 s6,2097152
v_mfma_f32_16x16x32_bf16 v[176:179],v[28:31],a[48:51],v[176:179]
buffer_load_dwordx4 v0,s[8:11],s64 offen offset:3072 sc1 lds
v_mfma_f32_16x16x32_bf16 v[180:183],v[28:31],a[52:55],v[180:183]
ds_read_b128 v[64:67],v4 offset:6144
v_mfma_f32_16x16x32_bf16 v[184:187],v[28:31],a[56:59],v[184:187]
ds_read_b128 v[68:71],v4 offset:7168
v_mfma_f32_16x16x32_bf16 v[188:191],v[28:31],a[60:63],v[188:191]
ds_read_b128 v[72:75],v4 offset:12288
s_waitcnt lgkmcnt(11)
v_mfma_f32_16x16x32_bf16 v[160:163],v[32:35],a[64:67],v[160:163]
ds_read_b128 v[76:79],v4 offset:13312
s_add_u32 m0,s58,4096
v_mfma_f32_16x16x32_bf16 v[164:167],v[32:35],a[68:71],v[164:167]
ds_read_b128 v[80:83],v4 offset:14336
s_add_u32 s64,s64,4096
v_mfma_f32_16x16x32_bf16 v[168:171],v[32:35],a[72:75],v[168:171]
buffer_load_dwordx4 v0,s[8:11],s64 offen offset:0 sc1 lds
v_mfma_f32_16x16x32_bf16 v[172:175],v[32:35],a[76:79],v[172:175]
ds_read_b128 v[84:87],v4 offset:15360
v_mfma_f32_16x16x32_bf16 v[176:179],v[32:35],a[80:83],v[176:179]
buffer_load_dwordx4 v[224:227],v0,s[4:7],s25 offen sc1
v_mfma_f32_16x16x32_bf16 v[180:183],v[32:35],a[84:87],v[180:183]
s_lshr_b32 s24,s55,5
s_cmp_lt_u32 s51,s24
s_cselect_b32 s24,1,2
v_mfma_f32_16x16x32_bf16 v[184:187],v[32:35],a[88:91],v[184:187]
buffer_load_dwordx4 v0,s[8:11],s64 offen offset:1024 sc1 lds
v_mfma_f32_16x16x32_bf16 v[188:191],v[32:35],a[92:95],v[188:191]
v_mov_b32 v252,s24
s_lshl2_add_u32 s25,s51,11018240
s_waitcnt lgkmcnt(13)
v_mfma_f32_16x16x32_bf16 v[160:163],v[36:39],a[96:99],v[160:163]
s_waitcnt lgkmcnt(0)
s_barrier
s_lshl_b32 s24,s68,16
v_mfma_f32_16x16x32_bf16 v[164:167],v[36:39],a[100:103],v[164:167]
ds_read_b128 v[248:251],v245
s_add_u32 s24,s24,s31
v_mfma_f32_16x16x32_bf16 v[168:171],v[36:39],a[104:107],v[168:171]
buffer_load_dwordx4 v0,s[8:11],s64 offen offset:2048 sc1 lds
v_mfma_f32_16x16x32_bf16 v[172:175],v[36:39],a[108:111],v[172:175]
s_add_u32 s24,s24,s86
s_cmp_eq_u32 s24,1537
s_cselect_b32 s25,s25,0x80000000
v_mfma_f32_16x16x32_bf16 v[176:179],v[36:39],a[112:115],v[176:179]
buffer_store_dword v252,off,s[8:11],s25 sc1
v_mfma_f32_16x16x32_bf16 v[180:183],v[36:39],a[116:119],v[180:183]
s_bitcmp1_b64 s[38:39],s51
s_cselect_b32 s24,128,0
s_lshl_b32 s23,s51,13
v_mfma_f32_16x16x32_bf16 v[184:187],v[36:39],a[120:123],v[184:187]
buffer_load_dwordx4 v0,s[8:11],s64 offen offset:3072 sc1 lds
v_mfma_f32_16x16x32_bf16 v[188:191],v[36:39],a[124:127],v[188:191]
s_waitcnt lgkmcnt(0)
v_or3_b32 v248,v248,v249,v250
v_or_b32 v248,v248,v251
v_mfma_f32_16x16x32_bf16 v[160:163],v[40:43],a[128:131],v[160:163]
s_lshl2_add_u32 s23,s68,s23
s_add_u32 s23,s23,10487168
s_add_u32 s23,s23,s24
v_mfma_f32_16x16x32_bf16 v[164:167],v[40:43],a[132:135],v[164:167]
buffer_load_dword v246,off,s[8:11],s23 sc1
v_mfma_f32_16x16x32_bf16 v[168:171],v[40:43],a[136:139],v[168:171]
s_add_u32 m0,s58,8192
s_add_u32 s64,s64,4096
v_readfirstlane_b32 s72,v248
v_mfma_f32_16x16x32_bf16 v[172:175],v[40:43],a[140:143],v[172:175]
buffer_load_dwordx4 v0,s[8:11],s64 offen offset:0 sc1 lds
v_mfma_f32_16x16x32_bf16 v[176:179],v[40:43],a[144:147],v[176:179]
s_waitcnt vmcnt(12)
v_lshrrev_b32 v244,4,v1
s_sub_u32 s23,s77,8
v_mfma_f32_16x16x32_bf16 v[180:183],v[40:43],a[148:151],v[180:183]
buffer_store_dword v20,off,s[8:11],s73 sc1
v_mfma_f32_16x16x32_bf16 v[184:187],v[40:43],a[152:155],v[184:187]
s_mov_b32 s73,0x80000000
v_add_u32 v244,s23,v244
v_max_i32 v244,0,v244
v_mfma_f32_16x16x32_bf16 v[188:191],v[40:43],a[156:159],v[188:191]
buffer_load_dwordx4 v0,s[8:11],s64 offen offset:1024 sc1 lds
v_mfma_f32_16x16x32_bf16 v[160:163],v[44:47],a[160:163],v[160:163]
v_lshl_add_u32 v244,v244,13,v21
v_mfma_f32_16x16x32_bf16 v[164:167],v[44:47],a[164:167],v[164:167]
buffer_load_dwordx2 v[242:243],v244,s[8:11],0 offen sc1
v_mfma_f32_16x16x32_bf16 v[168:171],v[44:47],a[168:171],v[168:171]
v_mfma_f32_16x16x32_bf16 v[172:175],v[44:47],a[172:175],v[172:175]
buffer_load_dwordx4 v0,s[8:11],s64 offen offset:2048 sc1 lds
v_mfma_f32_16x16x32_bf16 v[176:179],v[44:47],a[176:179],v[176:179]
v_mfma_f32_16x16x32_bf16 v[180:183],v[44:47],a[180:183],v[180:183]
v_mfma_f32_16x16x32_bf16 v[184:187],v[44:47],a[184:187],v[184:187]
v_mfma_f32_16x16x32_bf16 v[188:191],v[44:47],a[188:191],v[188:191]
buffer_load_dwordx4 v0,s[8:11],s64 offen offset:3072 sc1 lds
v_mfma_f32_16x16x32_bf16 v[160:163],v[48:51],a[192:195],v[160:163]
v_mfma_f32_16x16x32_bf16 v[164:167],v[48:51],a[196:199],v[164:167]
v_mfma_f32_16x16x32_bf16 v[168:171],v[48:51],a[200:203],v[168:171]
v_mfma_f32_16x16x32_bf16 v[172:175],v[48:51],a[204:207],v[172:175]
s_add_u32 m0,s57,24576
v_mfma_f32_16x16x32_bf16 v[176:179],v[48:51],a[208:211],v[176:179]
buffer_load_dwordx4 v0,s[8:11],s65 offen offset:0 sc1 lds
v_mfma_f32_16x16x32_bf16 v[180:183],v[48:51],a[212:215],v[180:183]
v_mfma_f32_16x16x32_bf16 v[184:187],v[48:51],a[216:219],v[184:187]
v_mfma_f32_16x16x32_bf16 v[188:191],v[48:51],a[220:223],v[188:191]
v_mfma_f32_16x16x32_bf16 v[160:163],v[52:55],a[224:227],v[160:163]
buffer_load_dwordx4 v0,s[8:11],s65 offen offset:1024 sc1 lds
v_mfma_f32_16x16x32_bf16 v[164:167],v[52:55],a[228:231],v[164:167]
v_mfma_f32_16x16x32_bf16 v[168:171],v[52:55],a[232:235],v[168:171]
v_mfma_f32_16x16x32_bf16 v[172:175],v[52:55],a[236:239],v[172:175]
v_mfma_f32_16x16x32_bf16 v[176:179],v[52:55],a[240:243],v[176:179]
v_mfma_f32_16x16x32_bf16 v[180:183],v[52:55],a[244:247],v[180:183]
v_mfma_f32_16x16x32_bf16 v[184:187],v[52:55],a[248:251],v[184:187]
v_mfma_f32_16x16x32_bf16 v[188:191],v[52:55],a[252:255],v[188:191]
v_mfma_f32_16x16x32_bf16 v[192:195],v[56:59],a[0:3],0
v_mfma_f32_16x16x32_bf16 v[196:199],v[56:59],a[4:7],0
v_mfma_f32_16x16x32_bf16 v[200:203],v[56:59],a[8:11],0
v_cvt_pk_bf16_f32 v24,v160,v164
v_cvt_pk_bf16_f32 v25,v168,v172
v_mfma_f32_16x16x32_bf16 v[204:207],v[56:59],a[12:15],0
v_cvt_pk_bf16_f32 v26,v176,v180
v_cvt_pk_bf16_f32 v27,v184,v188
v_mfma_f32_16x16x32_bf16 v[208:211],v[56:59],a[16:19],0
v_cvt_pk_bf16_f32 v28,v161,v165
v_cvt_pk_bf16_f32 v29,v169,v173
v_mfma_f32_16x16x32_bf16 v[212:215],v[56:59],a[20:23],0
v_cvt_pk_bf16_f32 v30,v177,v181
v_cvt_pk_bf16_f32 v31,v185,v189
v_mfma_f32_16x16x32_bf16 v[216:219],v[56:59],a[24:27],0
v_cvt_pk_bf16_f32 v32,v162,v166
v_cvt_pk_bf16_f32 v33,v170,v174
v_mfma_f32_16x16x32_bf16 v[220:223],v[56:59],a[28:31],0
v_cvt_pk_bf16_f32 v34,v178,v182
v_cvt_pk_bf16_f32 v35,v186,v190
v_mfma_f32_16x16x32_bf16 v[192:195],v[60:63],a[32:35],v[192:195]
v_cvt_pk_bf16_f32 v36,v163,v167
v_cvt_pk_bf16_f32 v37,v171,v175
v_mfma_f32_16x16x32_bf16 v[196:199],v[60:63],a[36:39],v[196:199]
v_cvt_pk_bf16_f32 v38,v179,v183
v_cvt_pk_bf16_f32 v39,v187,v191
v_mfma_f32_16x16x32_bf16 v[200:203],v[60:63],a[40:43],v[200:203]
v_mfma_f32_16x16x32_bf16 v[204:207],v[60:63],a[44:47],v[204:207]
v_mfma_f32_16x16x32_bf16 v[208:211],v[60:63],a[48:51],v[208:211]
v_mfma_f32_16x16x32_bf16 v[212:215],v[60:63],a[52:55],v[212:215]
v_mfma_f32_16x16x32_bf16 v[216:219],v[60:63],a[56:59],v[216:219]
v_mfma_f32_16x16x32_bf16 v[220:223],v[60:63],a[60:63],v[220:223]
v_mfma_f32_16x16x32_bf16 v[192:195],v[64:67],a[64:67],v[192:195]
v_mfma_f32_16x16x32_bf16 v[196:199],v[64:67],a[68:71],v[196:199]
v_mfma_f32_16x16x32_bf16 v[200:203],v[64:67],a[72:75],v[200:203]
v_mfma_f32_16x16x32_bf16 v[204:207],v[64:67],a[76:79],v[204:207]
v_mfma_f32_16x16x32_bf16 v[208:211],v[64:67],a[80:83],v[208:211]
v_mfma_f32_16x16x32_bf16 v[212:215],v[64:67],a[84:87],v[212:215]
v_mfma_f32_16x16x32_bf16 v[216:219],v[64:67],a[88:91],v[216:219]
v_mfma_f32_16x16x32_bf16 v[220:223],v[64:67],a[92:95],v[220:223]
v_mfma_f32_16x16x32_bf16 v[192:195],v[68:71],a[96:99],v[192:195]
v_mfma_f32_16x16x32_bf16 v[196:199],v[68:71],a[100:103],v[196:199]
v_mfma_f32_16x16x32_bf16 v[200:203],v[68:71],a[104:107],v[200:203]
v_mfma_f32_16x16x32_bf16 v[204:207],v[68:71],a[108:111],v[204:207]
v_mfma_f32_16x16x32_bf16 v[208:211],v[68:71],a[112:115],v[208:211]
s_add_u32 s62,s69,0
v_mfma_f32_16x16x32_bf16 v[212:215],v[68:71],a[116:119],v[212:215]
buffer_store_dwordx4 v[24:27],v5,s[8:11],s62 offen sc1
v_mfma_f32_16x16x32_bf16 v[216:219],v[68:71],a[120:123],v[216:219]
v_mfma_f32_16x16x32_bf16 v[220:223],v[68:71],a[124:127],v[220:223]
v_mfma_f32_16x16x32_bf16 v[192:195],v[72:75],a[128:131],v[192:195]
v_mfma_f32_16x16x32_bf16 v[196:199],v[72:75],a[132:135],v[196:199]
s_add_u32 s62,s69,16384
v_mfma_f32_16x16x32_bf16 v[200:203],v[72:75],a[136:139],v[200:203]
buffer_store_dwordx4 v[28:31],v5,s[8:11],s62 offen sc1
v_mfma_f32_16x16x32_bf16 v[204:207],v[72:75],a[140:143],v[204:207]
v_mfma_f32_16x16x32_bf16 v[208:211],v[72:75],a[144:147],v[208:211]
v_mfma_f32_16x16x32_bf16 v[212:215],v[72:75],a[148:151],v[212:215]
v_mfma_f32_16x16x32_bf16 v[216:219],v[72:75],a[152:155],v[216:219]
s_add_u32 s62,s69,32768
v_mfma_f32_16x16x32_bf16 v[220:223],v[72:75],a[156:159],v[220:223]
buffer_store_dwordx4 v[32:35],v5,s[8:11],s62 offen sc1
v_mfma_f32_16x16x32_bf16 v[192:195],v[76:79],a[160:163],v[192:195]
v_mfma_f32_16x16x32_bf16 v[196:199],v[76:79],a[164:167],v[196:199]
v_mfma_f32_16x16x32_bf16 v[200:203],v[76:79],a[168:171],v[200:203]
v_mfma_f32_16x16x32_bf16 v[204:207],v[76:79],a[172:175],v[204:207]
s_add_u32 s62,s69,49152
v_mfma_f32_16x16x32_bf16 v[208:211],v[76:79],a[176:179],v[208:211]
buffer_store_dwordx4 v[36:39],v5,s[8:11],s62 offen sc1
v_mfma_f32_16x16x32_bf16 v[212:215],v[76:79],a[180:183],v[212:215]
v_mfma_f32_16x16x32_bf16 v[216:219],v[76:79],a[184:187],v[216:219]
v_mfma_f32_16x16x32_bf16 v[220:223],v[76:79],a[188:191],v[220:223]
v_mfma_f32_16x16x32_bf16 v[192:195],v[80:83],a[192:195],v[192:195]
v_mfma_f32_16x16x32_bf16 v[196:199],v[80:83],a[196:199],v[196:199]
v_mfma_f32_16x16x32_bf16 v[192:195],v[84:87],a[224:227],v[192:195]
v_mfma_f32_16x16x32_bf16 v[196:199],v[84:87],a[228:231],v[196:199]
v_mfma_f32_16x16x32_bf16 v[200:203],v[80:83],a[200:203],v[200:203]
v_mfma_f32_16x16x32_bf16 v[204:207],v[80:83],a[204:207],v[204:207]
v_mfma_f32_16x16x32_bf16 v[200:203],v[84:87],a[232:235],v[200:203]
v_mfma_f32_16x16x32_bf16 v[204:207],v[84:87],a[236:239],v[204:207]
v_cvt_pk_bf16_f32 v40,v192,v196
v_cvt_pk_bf16_f32 v44,v193,v197
v_cvt_pk_bf16_f32 v48,v194,v198
v_mfma_f32_16x16x32_bf16 v[208:211],v[80:83],a[208:211],v[208:211]
v_cvt_pk_bf16_f32 v52,v195,v199
v_mfma_f32_16x16x32_bf16 v[212:215],v[80:83],a[212:215],v[212:215]
v_cvt_pk_bf16_f32 v41,v200,v204
v_cvt_pk_bf16_f32 v45,v201,v205
v_cvt_pk_bf16_f32 v49,v202,v206
v_mfma_f32_16x16x32_bf16 v[208:211],v[84:87],a[240:243],v[208:211]
v_cvt_pk_bf16_f32 v53,v203,v207
v_mfma_f32_16x16x32_bf16 v[212:215],v[84:87],a[244:247],v[212:215]
v_mfma_f32_16x16x32_bf16 v[216:219],v[80:83],a[216:219],v[216:219]
v_mfma_f32_16x16x32_bf16 v[220:223],v[80:83],a[220:223],v[220:223]
v_mfma_f32_16x16x32_bf16 v[216:219],v[84:87],a[248:251],v[216:219]
v_mfma_f32_16x16x32_bf16 v[220:223],v[84:87],a[252:255],v[220:223]
v_cvt_pk_bf16_f32 v42,v208,v212
v_cvt_pk_bf16_f32 v46,v209,v213
v_cvt_pk_bf16_f32 v50,v210,v214
v_cvt_pk_bf16_f32 v54,v211,v215
s_nop 3
v_cvt_pk_bf16_f32 v43,v216,v220
s_add_u32 s62,s69,262144
buffer_store_dwordx4 v[40:43],v5,s[8:11],s62 offen sc1
v_cvt_pk_bf16_f32 v47,v217,v221
s_add_u32 s62,s69,278528
buffer_store_dwordx4 v[44:47],v5,s[8:11],s62 offen sc1
v_cvt_pk_bf16_f32 v51,v218,v222
s_add_u32 s62,s69,294912
buffer_store_dwordx4 v[48:51],v5,s[8:11],s62 offen sc1
v_cvt_pk_bf16_f32 v55,v219,v223
s_add_u32 s62,s69,311296
buffer_store_dwordx4 v[52:55],v5,s[8:11],s62 offen sc1
s_cmp_lg_u32 s72,0
s_cbranch_scc1 L_aa_316
s_waitcnt vmcnt(8)
L_aa_326:
s_barrier
s_cmp_lt_u32 s30,s31
s_cbranch_scc1 L_ao_333
s_xor_b32 s67,s67,65536
s_and_b32 s56,s50,2048
s_lshl_b32 s56,s56,4
s_add_u32 s56,s56,s67
v_add_u32 v2,s56,v0
v_add_u32 v239,s56,v253
s_and_b32 s56,s50,1024
s_lshl_b32 s56,s56,2
v_add_u32 v238,s56,v2
s_mov_b32 s76,s71
s_mov_b32 s53,s77
ds_read_b128 v[24:27],v238 offset:16384
ds_read_b128 v[40:43],v2 offset:0
ds_read_b128 v[56:59],v2 offset:4096
ds_read_b128 v[28:31],v238 offset:17408
ds_read_b128 v[44:47],v2 offset:1024
ds_read_b128 v[60:63],v2 offset:5120
ds_read_b128 v[32:35],v238 offset:18432
ds_read_b128 v[48:51],v2 offset:2048
ds_read_b128 v[64:67],v2 offset:6144
ds_read_b128 v[36:39],v238 offset:19456
ds_read_b128 v[52:55],v2 offset:3072
ds_read_b128 v[68:71],v2 offset:7168
s_waitcnt lgkmcnt(9)
v_mfma_f32_16x16x32_bf16 v[128:131],v[40:43],v[24:27],v[8:11]
ds_read_b128 v[72:75],v2 offset:24576
v_mfma_f32_16x16x32_bf16 v[132:135],v[56:59],v[24:27],v[12:15]
ds_read_b128 v[76:79],v2 offset:25600
s_waitcnt lgkmcnt(8)
v_mfma_f32_16x16x32_bf16 v[128:131],v[44:47],v[28:31],v[128:131]
ds_read_b128 v[80:83],v2 offset:26624
v_mfma_f32_16x16x32_bf16 v[132:135],v[60:63],v[28:31],v[132:135]
ds_read_b128 v[84:87],v2 offset:27648
s_waitcnt lgkmcnt(7)
v_mfma_f32_16x16x32_bf16 v[128:131],v[48:51],v[32:35],v[128:131]
ds_read_b64 v[120:121],v239 offset:24576
v_mfma_f32_16x16x32_bf16 v[132:135],v[64:67],v[32:35],v[132:135]
ds_read_b64 v[122:123],v239 offset:25600
s_waitcnt lgkmcnt(6)
v_mfma_f32_16x16x32_bf16 v[128:131],v[52:55],v[36:39],v[128:131]
ds_read_b64 v[124:125],v239 offset:26624
v_mfma_f32_16x16x32_bf16 v[132:135],v[68:71],v[36:39],v[132:135]
ds_read_b64 v[126:127],v239 offset:27648
s_waitcnt lgkmcnt(4)
v_mfma_f32_16x16x32_bf16 v[136:139],v[72:75],v[24:27],0
ds_read_b128 v[88:91],v2 offset:8192
ds_read_b128 v[92:95],v2 offset:9216
v_mfma_f32_16x16x32_bf16 v[136:139],v[76:79],v[28:31],v[136:139]
ds_read_b128 v[96:99],v2 offset:10240
ds_read_b128 v[100:103],v2 offset:11264
v_mfma_f32_16x16x32_bf16 v[136:139],v[80:83],v[32:35],v[136:139]
ds_read_b128 v[104:107],v2 offset:12288
ds_read_b128 v[108:111],v2 offset:13312
v_mfma_f32_16x16x32_bf16 v[136:139],v[84:87],v[36:39],v[136:139]
ds_read_b128 v[112:115],v2 offset:14336
ds_read_b128 v[116:119],v2 offset:15360
s_cmp_eq_u32 s30,0
s_cbranch_scc1 L_aa_315
v_max3_u32 v238,v72,v73,v74
v_max3_u32 v238,v74,v75,v238
v_max3_u32 v238,v76,v77,v238
v_max3_u32 v238,v78,v79,v238
v_max3_u32 v238,v80,v81,v238
v_max3_u32 v238,v82,v83,v238
v_max3_u32 v238,v84,v85,v238
v_max3_u32 v238,v86,v87,v238
s_waitcnt lgkmcnt(8)
v_max3_u32 v238,v120,v121,v238
v_max3_u32 v238,v122,v123,v238
v_max3_u32 v238,v124,v125,v238
v_max3_u32 v238,v126,v127,v238
v_cmp_eq_u32 vcc,-1,v238
s_cmp_lg_u64 vcc,0
s_cselect_b32 s27,1,0
s_andn2_b32 s57,s27,s31
s_add_u32 s66,s66,4
s_bfe_u32 s56,s66,0x10002
s_bitset0_b32 s37,s56
s_lshl_b32 s56,s57,s56
s_or_b32 s37,s37,s56
s_or_b32 s56,s37,s66
v_mov_b32 v22,s56
s_xor_b32 s69,s69,524288
s_waitcnt vmcnt(0) lgkmcnt(0)
buffer_store_dword v22,off,s[8:11],s74 sc1
s_cmp_lg_u32 s86,1536
s_cbranch_scc1 L_ae_336
s_mov_b32 s77,s35
s_mov_b32 s30,0
s_lshl_b32 s56,s77,5
s_add_u32 s56,s56,s68
s_mul_i32 s70,s56,24576
s_lshl_b32 s71,s56,12
s_lshl_b32 s59,s77,13
s_lshl2_add_u32 s59,s68,s59
s_add_u32 s59,s59,10485760
s_buffer_load_dword s32,s[8:11],s59
s_mov_b32 s33,1
s_add_u32 s70,s70,100663296
s_add_u32 s71,s71,41943040
v_mov_b32 v19,s59
s_branch L_af_337
L_ae_336:
s_ff1_i32_b64 s77,s[84:85]
s_bitset0_b64 s[84:85],s77
s_min_u32 s77,s77,64
s_lshr_b32 s61,s55,5
s_lshl_b32 s56,s77,5
s_add_u32 s56,s56,s68
s_mul_i32 s70,s56,24576
s_lshl_b32 s71,s56,12
s_lshl_b32 s59,s77,13
s_lshl2_add_u32 s59,s68,s59
s_add_u32 s59,s59,10486144
s_cmp_lt_u32 s77,s61
s_cselect_b32 s57,0,16777216
s_mov_b32 s60,s59
s_buffer_load_dword s33,s[8:11],s60
s_add_u32 s71,s71,s57
s_add_u32 s71,s71,58720256
s_cmp_eq_u32 s77,s61
s_cselect_b32 s57,50331648,0
s_cselect_b32 s58,1536,0
s_add_u32 s59,s59,s58
s_buffer_load_dword s32,s[8:11],s59
s_add_u32 s70,s70,s57
s_add_u32 s70,s70,150994944
v_mov_b32 v19,s59
v_writelane_b32 v19,s60,1
L_af_337:
s_cmp_ge_u32 s53,60
s_cbranch_scc1 L_a4_338
L_a4_339:
s_and_b32 s27,s27,s31
s_cbranch_scc1 L_ac_341
L_acb_342:
v_max3_f32 v238,v128,v129,v130
v_max3_f32 v239,v131,v132,v133
v_max3_f32 v238,v134,v135,v238
v_max3_f32 v239,v138,v139,v239
v_max_f32 v238,v238,v239
v_max_f32 v239,v238,v239
v_pk_mul_f32 v[128:129],v[128:129],v[152:153] op_sel_hi:[1,0]
v_pk_mul_f32 v[130:131],v[130:131],v[152:153] op_sel_hi:[1,0]
v_permlane16_swap_b32 v238,v239
v_max_f32 v238,v238,v239
v_max_f32 v239,v238,v239
v_pk_mul_f32 v[132:133],v[132:133],v[152:153] op_sel_hi:[1,0]
v_pk_mul_f32 v[134:135],v[134:135],v[152:153] op_sel_hi:[1,0]
v_permlane32_swap_b32 v238,v239
v_max_f32 v238,v238,v239
v_mul_f32 v238,v152,v238
v_pk_mul_f32 v[138:139],v[138:139],v[152:153] op_sel_hi:[1,0]
buffer_load_dword v17,v16,s[8:11],s87 offen sc1
v_pk_add_f32 v[128:129],v[128:129],v[238:239] op_sel_hi:[1,0] neg_lo:[0,1] neg_hi:[0,1]
v_pk_add_f32 v[130:131],v[130:131],v[238:239] op_sel_hi:[1,0] neg_lo:[0,1] neg_hi:[0,1]
v_pk_add_f32 v[132:133],v[132:133],v[238:239] op_sel_hi:[1,0] neg_lo:[0,1] neg_hi:[0,1]
v_pk_add_f32 v[134:135],v[134:135],v[238:239] op_sel_hi:[1,0] neg_lo:[0,1] neg_hi:[0,1]
v_pk_add_f32 v[138:139],v[138:139],v[238:239] op_sel_hi:[1,0] neg_lo:[0,1] neg_hi:[0,1]
v_exp_f32 v128,v128
v_exp_f32 v129,v129
v_exp_f32 v130,v130
v_exp_f32 v131,v131
v_exp_f32 v132,v132
v_exp_f32 v133,v133
v_exp_f32 v134,v134
v_exp_f32 v135,v135
v_exp_f32 v138,v138
v_exp_f32 v139,v139
v_pk_add_f32 v[148:149],v[128:129],v[130:131]
v_pk_add_f32 v[150:151],v[132:133],v[134:135]
v_pk_add_f32 v[148:149],v[148:149],v[138:139]
v_pk_add_f32 v[148:149],v[148:149],v[150:151]
v_add_f32 v150,v148,v149
v_add_f32 v151,v148,v149
s_nop 1
v_permlane16_swap_b32 v150,v151
v_add_f32 v148,v150,v151
v_add_f32 v149,v150,v151
s_nop 1
v_permlane32_swap_b32 v148,v149
v_add_f32 v148,v148,v149
v_rcp_f32 v148,v148
s_waitcnt vmcnt(0)
v_cmp_gt_u32 vcc,s66,v17
v_pk_mul_f32 v[138:139],v[138:139],v[148:149] op_sel_hi:[1,0]
v_pk_mul_f32 v[128:129],v[128:129],v[148:149] op_sel_hi:[1,0]
v_pk_mul_f32 v[130:131],v[130:131],v[148:149] op_sel_hi:[1,0]
v_pk_mul_f32 v[132:133],v[132:133],v[148:149] op_sel_hi:[1,0]
v_pk_mul_f32 v[134:135],v[134:135],v[148:149] op_sel_hi:[1,0]
s_cbranch_vccnz L_ap_344
L_apb_345:
s_xor_b32 s34,s69,524288
buffer_load_dwordx4 v[192:195],v7,s[8:11],s34 offen sc1
s_bfe_u32 s56,s66,0x10002
v_lshrrev_b32 v238,s56,v17
v_and_b32 v238,1,v238
v_cmp_ne_u32 vcc,0,v238
v_cvt_pk_bf16_f32 v144,v138,v139
v_cvt_pk_bf16_f32 v147,v138,v139
v_cvt_pk_bf16_f32 v140,v128,v129
v_cvt_pk_bf16_f32 v141,v130,v131
v_cvt_pk_bf16_f32 v142,v132,v133
v_cvt_pk_bf16_f32 v143,v134,v135
s_cbranch_vccnz L_ak_335
s_add_u32 s36,s36,4
v_mfma_f32_16x16x16_bf16 v[24:27],v[120:121],v[144:145],0
s_add_u32 s34,s34,4096
v_mfma_f32_16x16x16_bf16 v[28:31],v[120:121],v[146:147],0
buffer_load_dwordx4 v[196:199],v7,s[8:11],s34 offen sc1
v_mfma_f32_16x16x16_bf16 v[32:35],v[122:123],v[144:145],0
s_add_u32 s34,s34,4096
v_mfma_f32_16x16x16_bf16 v[36:39],v[122:123],v[146:147],0
buffer_load_dwordx4 v[200:203],v7,s[8:11],s34 offen sc1
v_mfma_f32_16x16x16_bf16 v[40:43],v[124:125],v[144:145],0
s_add_u32 s34,s34,4096
v_mfma_f32_16x16x16_bf16 v[44:47],v[124:125],v[146:147],0
buffer_load_dwordx4 v[204:207],v7,s[8:11],s34 offen sc1
v_mfma_f32_16x16x16_bf16 v[48:51],v[126:127],v[144:145],0
s_add_u32 s34,s34,4096
v_mfma_f32_16x16x16_bf16 v[52:55],v[126:127],v[146:147],0
buffer_load_dwordx4 v[208:211],v7,s[8:11],s34 offen sc1
v_mfma_f32_16x16x32_bf16 v[24:27],v[88:91],v[140:143],v[24:27]
s_add_u32 s34,s34,4096
v_mfma_f32_16x16x32_bf16 v[28:31],v[92:95],v[140:143],v[28:31]
buffer_load_dwordx4 v[212:215],v7,s[8:11],s34 offen sc1
v_mfma_f32_16x16x32_bf16 v[32:35],v[96:99],v[140:143],v[32:35]
s_add_u32 s34,s34,4096
v_mfma_f32_16x16x32_bf16 v[36:39],v[100:103],v[140:143],v[36:39]
buffer_load_dwordx4 v[216:219],v7,s[8:11],s34 offen sc1
v_cvt_pk_bf16_f32 v72,v24,v28
v_cvt_pk_bf16_f32 v73,v25,v29
v_mfma_f32_16x16x32_bf16 v[40:43],v[104:107],v[140:143],v[40:43]
s_add_u32 s34,s34,4096
v_cvt_pk_bf16_f32 v74,v26,v30
v_cvt_pk_bf16_f32 v75,v27,v31
v_mfma_f32_16x16x32_bf16 v[44:47],v[108:111],v[140:143],v[44:47]
ds_write_b128 v3,v[72:75] offset:0
v_cvt_pk_bf16_f32 v76,v32,v36
v_cvt_pk_bf16_f32 v77,v33,v37
v_mfma_f32_16x16x32_bf16 v[48:51],v[112:115],v[140:143],v[48:51]
buffer_load_dwordx4 v[220:223],v7,s[8:11],s34 offen sc1
v_cvt_pk_bf16_f32 v78,v34,v38
v_cvt_pk_bf16_f32 v79,v35,v39
v_mfma_f32_16x16x32_bf16 v[52:55],v[116:119],v[140:143],v[52:55]
ds_write_b128 v3,v[76:79] offset:1024
v_cvt_pk_bf16_f32 v80,v40,v44
v_cvt_pk_bf16_f32 v81,v41,v45
v_cvt_pk_bf16_f32 v82,v42,v46
v_cvt_pk_bf16_f32 v83,v43,v47
ds_write_b128 v3,v[80:83] offset:2048
s_nop 1
v_cvt_pk_bf16_f32 v84,v48,v52
v_cvt_pk_bf16_f32 v85,v49,v53
v_cvt_pk_bf16_f32 v86,v50,v54
v_cvt_pk_bf16_f32 v87,v51,v55
ds_write_b128 v3,v[84:87] offset:3072
s_cmp_eq_u32 s31,0
s_cbranch_scc1 L_ah_343
s_waitcnt lgkmcnt(0)
s_barrier
s_mov_b32 s26,s51
s_mov_b32 s51,s53
s_branch L_aa_327
L_ah_343:
s_cmp_ge_u32 s35,64
s_cbranch_scc1 L_a1_346
L_a2_347:
s_waitcnt lgkmcnt(0)
s_barrier
s_mov_b32 s26,s51
s_mov_b32 s51,s53
s_mov_b32 s31,1
s_branch L_av_331
L_ao_333:
s_xor_b32 s67,s67,65536
s_and_b32 s56,s50,2048
s_lshl_b32 s56,s56,4
s_add_u32 s56,s56,s67
v_add_u32 v2,s56,v0
v_add_u32 v239,s56,v253
s_and_b32 s56,s50,1024
s_lshl_b32 s56,s56,2
v_add_u32 v238,s56,v2
s_mov_b32 s76,s71
s_mov_b32 s53,s77
ds_read_b128 v[24:27],v238 offset:16384
ds_read_b128 v[40:43],v2 offset:0
ds_read_b128 v[56:59],v2 offset:4096
ds_read_b128 v[28:31],v238 offset:17408
ds_read_b128 v[44:47],v2 offset:1024
ds_read_b128 v[60:63],v2 offset:5120
ds_read_b128 v[32:35],v238 offset:18432
ds_read_b128 v[48:51],v2 offset:2048
ds_read_b128 v[64:67],v2 offset:6144
ds_read_b128 v[36:39],v238 offset:19456
ds_read_b128 v[52:55],v2 offset:3072
ds_read_b128 v[68:71],v2 offset:7168
buffer_load_dwordx4 v[72:75],v0,s[8:11],s76 offen offset:0 sc1
buffer_load_dwordx4 v[76:79],v0,s[8:11],s76 offen offset:1024 sc1
buffer_load_dwordx4 v[80:83],v0,s[8:11],s76 offen offset:2048 sc1
buffer_load_dwordx4 v[84:87],v0,s[8:11],s76 offen offset:3072 sc1
buffer_load_dwordx2 v[120:121],v253,s[8:11],s76 offen offset:0 sc1
buffer_load_dwordx2 v[122:123],v253,s[8:11],s76 offen offset:1024 sc1
buffer_load_dwordx2 v[124:125],v253,s[8:11],s76 offen offset:2048 sc1
buffer_load_dwordx2 v[126:127],v253,s[8:11],s76 offen offset:3072 sc1
s_waitcnt lgkmcnt(9)
v_mfma_f32_16x16x32_bf16 v[128:131],v[40:43],v[24:27],v[8:11]
ds_read_b128 v[88:91],v2 offset:8192
v_mfma_f32_16x16x32_bf16 v[132:135],v[56:59],v[24:27],v[12:15]
ds_read_b128 v[92:95],v2 offset:9216
s_waitcnt lgkmcnt(8)
v_mfma_f32_16x16x32_bf16 v[128:131],v[44:47],v[28:31],v[128:131]
ds_read_b128 v[96:99],v2 offset:10240
v_mfma_f32_16x16x32_bf16 v[132:135],v[60:63],v[28:31],v[132:135]
ds_read_b128 v[100:103],v2 offset:11264
s_waitcnt lgkmcnt(7)
v_mfma_f32_16x16x32_bf16 v[128:131],v[48:51],v[32:35],v[128:131]
ds_read_b128 v[104:107],v2 offset:12288
v_mfma_f32_16x16x32_bf16 v[132:135],v[64:67],v[32:35],v[132:135]
ds_read_b128 v[108:111],v2 offset:13312
s_waitcnt lgkmcnt(6)
v_mfma_f32_16x16x32_bf16 v[128:131],v[52:55],v[36:39],v[128:131]
ds_read_b128 v[112:115],v2 offset:14336
v_mfma_f32_16x16x32_bf16 v[132:135],v[68:71],v[36:39],v[132:135]
ds_read_b128 v[116:119],v2 offset:15360
s_add_u32 s66,s66,4
s_bfe_u32 s56,s66,0x10002
s_bitset0_b32 s37,s56
s_lshl_b32 s56,0,s56
s_or_b32 s37,s37,s56
s_or_b32 s56,s37,s66
v_mov_b32 v22,s56
s_xor_b32 s69,s69,524288
s_waitcnt vmcnt(8) lgkmcnt(0)
buffer_store_dword v22,off,s[8:11],s74 sc1
s_mov_b32 s26,s51
s_mov_b32 s27,3
s_branch L_aa_322
L_aa_315:
s_add_u32 s66,s66,4
s_bfe_u32 s56,s66,0x10002
s_bitset0_b32 s37,s56
s_lshl_b32 s56,0,s56
s_or_b32 s37,s37,s56
s_or_b32 s56,s37,s66
v_mov_b32 v22,s56
s_xor_b32 s69,s69,524288
s_waitcnt vmcnt(0) lgkmcnt(0)
buffer_store_dword v22,off,s[8:11],s74 sc1
L_aq_348:
buffer_load_dword v17,v16,s[8:11],s87 offen sc1
s_sub_u32 s49,s49,1
s_cbranch_scc1 L_abort2
s_waitcnt vmcnt(0)
v_cmp_gt_u32 vcc,s66,v17
s_cbranch_vccnz L_aq_348
s_xor_b32 s34,s69,524288
buffer_load_dwordx4 v[160:163],v7,s[8:11],s34 offen sc1
s_add_u32 s34,s34,4096
buffer_load_dwordx4 v[164:167],v7,s[8:11],s34 offen sc1
s_add_u32 s34,s34,4096
buffer_load_dwordx4 v[168:171],v7,s[8:11],s34 offen sc1
s_add_u32 s34,s34,4096
buffer_load_dwordx4 v[172:175],v7,s[8:11],s34 offen sc1
s_add_u32 s34,s34,4096
buffer_load_dwordx4 v[176:179],v7,s[8:11],s34 offen sc1
s_add_u32 s34,s34,4096
buffer_load_dwordx4 v[180:183],v7,s[8:11],s34 offen sc1
s_add_u32 s34,s34,4096
buffer_load_dwordx4 v[184:187],v7,s[8:11],s34 offen sc1
s_add_u32 s34,s34,4096
buffer_load_dwordx4 v[188:191],v7,s[8:11],s34 offen sc1
buffer_load_dwordx4 v[72:75],v0,s[8:11],s76 offen offset:0 sc1
buffer_load_dwordx4 v[76:79],v0,s[8:11],s76 offen offset:1024 sc1
buffer_load_dwordx4 v[80:83],v0,s[8:11],s76 offen offset:2048 sc1
buffer_load_dwordx4 v[84:87],v0,s[8:11],s76 offen offset:3072 sc1
buffer_load_dwordx2 v[120:121],v253,s[8:11],s76 offen offset:0 sc1
buffer_load_dwordx2 v[122:123],v253,s[8:11],s76 offen offset:1024 sc1
buffer_load_dwordx2 v[124:125],v253,s[8:11],s76 offen offset:2048 sc1
buffer_load_dwordx2 v[126:127],v253,s[8:11],s76 offen offset:3072 sc1
s_waitcnt vmcnt(15)
v_mfma_f32_16x16x32_bf16 v[192:195],v[156:159],v[160:163],0
s_waitcnt vmcnt(14)
v_mfma_f32_16x16x32_bf16 v[192:195],v[156:159],v[164:167],v[192:195]
s_waitcnt vmcnt(13)
v_mfma_f32_16x16x32_bf16 v[192:195],v[156:159],v[168:171],v[192:195]
s_waitcnt vmcnt(12)
v_mfma_f32_16x16x32_bf16 v[192:195],v[156:159],v[172:175],v[192:195]
s_waitcnt vmcnt(11)
v_mfma_f32_16x16x32_bf16 v[196:199],v[156:159],v[176:179],0
s_waitcnt vmcnt(10)
v_mfma_f32_16x16x32_bf16 v[196:199],v[156:159],v[180:183],v[196:199]
s_waitcnt vmcnt(9)
v_mfma_f32_16x16x32_bf16 v[196:199],v[156:159],v[184:187],v[196:199]
ds_write_b128 v6,v[192:195]
s_waitcnt vmcnt(8)
v_mfma_f32_16x16x32_bf16 v[196:199],v[156:159],v[188:191],v[196:199]
s_nop 7
ds_write_b128 v6,v[196:199] offset:2048
s_waitcnt lgkmcnt(0)
s_barrier
buffer_store_dword v20,off,s[8:11],s73 sc1
s_mov_b32 s73,0x80000000
s_mov_b32 s27,0
s_branch L_aa_318
L_aa_316:
s_add_u32 s56,s30,s86
s_cmp_lg_u32 s56,1537
s_cbranch_scc1 L_al_334
s_add_u32 s66,s66,4
s_bfe_u32 s56,s66,0x10002
s_bitset0_b32 s37,s56
s_lshl_b32 s56,1,s56
s_or_b32 s37,s37,s56
s_or_b32 s56,s37,s66
v_mov_b32 v22,s56
s_xor_b32 s69,s69,524288
s_waitcnt vmcnt(0) lgkmcnt(0)
buffer_store_dword v22,off,s[8:11],s74 sc1
s_cmp_lg_u32 s86,1536
s_cbranch_scc1 L_ae_349
s_mov_b32 s77,s35
s_mov_b32 s30,0
s_lshl_b32 s56,s77,5
s_add_u32 s56,s56,s68
s_mul_i32 s70,s56,24576
s_lshl_b32 s71,s56,12
s_lshl_b32 s59,s77,13
s_lshl2_add_u32 s59,s68,s59
s_add_u32 s59,s59,10485760
s_buffer_load_dword s32,s[8:11],s59
s_mov_b32 s33,1
s_add_u32 s70,s70,100663296
s_add_u32 s71,s71,41943040
v_mov_b32 v19,s59
s_branch L_af_350
L_ae_349:
s_ff1_i32_b64 s77,s[84:85]
s_bitset0_b64 s[84:85],s77
s_min_u32 s77,s77,64
s_lshr_b32 s61,s55,5
s_lshl_b32 s56,s77,5
s_add_u32 s56,s56,s68
s_mul_i32 s70,s56,24576
s_lshl_b32 s71,s56,12
s_lshl_b32 s59,s77,13
s_lshl2_add_u32 s59,s68,s59
s_add_u32 s59,s59,10486144
s_cmp_lt_u32 s77,s61
s_cselect_b32 s57,0,16777216
s_mov_b32 s60,s59
s_buffer_load_dword s33,s[8:11],s60
s_add_u32 s71,s71,s57
s_add_u32 s71,s71,58720256
s_cmp_eq_u32 s77,s61
s_cselect_b32 s57,50331648,0
s_cselect_b32 s58,1536,0
s_add_u32 s59,s59,s58
s_buffer_load_dword s32,s[8:11],s59
s_add_u32 s70,s70,s57
s_add_u32 s70,s70,150994944
v_mov_b32 v19,s59
v_writelane_b32 v19,s60,1
L_af_350:
s_branch L_ak_335
L_al_334:
s_add_u32 s66,s66,4
s_bfe_u32 s56,s66,0x10002
s_bitset0_b32 s37,s56
s_lshl_b32 s56,0,s56
s_or_b32 s37,s37,s56
s_or_b32 s56,s37,s66
v_mov_b32 v22,s56
s_xor_b32 s69,s69,524288
s_waitcnt vmcnt(0) lgkmcnt(0)
buffer_store_dword v22,off,s[8:11],s74 sc1
buffer_store_dword v20,off,s[8:11],s73 sc1
s_mov_b32 s73,0x80000000
L_ak_335:
L_aq_351:
buffer_load_dword v17,v16,s[8:11],s87 offen sc1
s_sub_u32 s49,s49,1
s_cbranch_scc1 L_abort2
s_waitcnt vmcnt(0)
v_cmp_gt_u32 vcc,s66,v17
s_cbranch_vccnz L_aq_351
s_xor_b32 s34,s69,524288
buffer_load_dwordx4 v[160:163],v7,s[8:11],s34 offen sc1
s_add_u32 s34,s34,4096
buffer_load_dwordx4 v[164:167],v7,s[8:11],s34 offen sc1
s_add_u32 s34,s34,4096
buffer_load_dwordx4 v[168:171],v7,s[8:11],s34 offen sc1
s_add_u32 s34,s34,4096
buffer_load_dwordx4 v[172:175],v7,s[8:11],s34 offen sc1
s_add_u32 s34,s34,4096
buffer_load_dwordx4 v[176:179],v7,s[8:11],s34 offen sc1
s_add_u32 s34,s34,4096
buffer_load_dwordx4 v[180:183],v7,s[8:11],s34 offen sc1
s_add_u32 s34,s34,4096
buffer_load_dwordx4 v[184:187],v7,s[8:11],s34 offen sc1
s_add_u32 s34,s34,4096
buffer_load_dwordx4 v[188:191],v7,s[8:11],s34 offen sc1
s_waitcnt vmcnt(7)
v_mfma_f32_16x16x32_bf16 v[192:195],v[156:159],v[160:163],0
s_waitcnt vmcnt(6)
v_mfma_f32_16x16x32_bf16 v[192:195],v[156:159],v[164:167],v[192:195]
s_waitcnt vmcnt(5)
v_mfma_f32_16x16x32_bf16 v[192:195],v[156:159],v[168:171],v[192:195]
s_waitcnt vmcnt(4)
v_mfma_f32_16x16x32_bf16 v[192:195],v[156:159],v[172:175],v[192:195]
s_waitcnt vmcnt(3)
v_mfma_f32_16x16x32_bf16 v[196:199],v[156:159],v[176:179],0
s_waitcnt vmcnt(2)
v_mfma_f32_16x16x32_bf16 v[196:199],v[156:159],v[180:183],v[196:199]
s_waitcnt vmcnt(1)
v_mfma_f32_16x16x32_bf16 v[196:199],v[156:159],v[184:187],v[196:199]
ds_write_b128 v6,v[192:195]
s_waitcnt vmcnt(0)
v_mfma_f32_16x16x32_bf16 v[196:199],v[156:159],v[188:191],v[196:199]
s_nop 7
ds_write_b128 v6,v[196:199] offset:2048
s_waitcnt lgkmcnt(0)
s_barrier
buffer_store_dword v20,off,s[8:11],s73 sc1
s_mov_b32 s73,0x80000000
s_mov_b32 s27,2
L_aa_318:
s_cmp_lg_u32 s31,0
s_cbranch_scc1 L_ar_354
s_bitcmp1_b32 s46,0
s_cbranch_scc1 L_ar_353
L_ar_352:
ds_read_b128 v[160:163],v23
ds_read_b128 v[164:167],v23 offset:16
v_lshlrev_b32 v200,16,v224
v_and_b32 v201,0xffff0000,v224
v_lshlrev_b32 v202,16,v225
v_and_b32 v203,0xffff0000,v225
v_lshlrev_b32 v204,16,v226
v_and_b32 v205,0xffff0000,v226
v_lshlrev_b32 v206,16,v227
v_and_b32 v207,0xffff0000,v227
s_lshl_b32 s18,s51,5
s_add_u32 s18,s18,s68
s_lshl_b32 s19,s18,10
s_add_u32 s20,s19,8388608
s_waitcnt lgkmcnt(0)
v_cvt_pk_bf16_f32 v168,v160,v161
v_cvt_pk_bf16_f32 v169,v162,v163
v_cvt_pk_bf16_f32 v170,v164,v165
v_cvt_pk_bf16_f32 v171,v166,v167
v_lshlrev_b32 v160,16,v168
v_and_b32 v161,0xffff0000,v168
v_lshlrev_b32 v162,16,v169
v_and_b32 v163,0xffff0000,v169
v_lshlrev_b32 v164,16,v170
v_and_b32 v165,0xffff0000,v170
v_lshlrev_b32 v166,16,v171
v_and_b32 v167,0xffff0000,v171
v_pk_add_f32 v[200:201],v[200:201],v[160:161]
v_pk_add_f32 v[202:203],v[202:203],v[162:163]
v_pk_add_f32 v[204:205],v[204:205],v[164:165]
v_pk_add_f32 v[206:207],v[206:207],v[166:167]
v_cvt_pk_bf16_f32 v168,v200,v201
v_cvt_pk_bf16_f32 v169,v202,v203
v_cvt_pk_bf16_f32 v170,v204,v205
v_cvt_pk_bf16_f32 v171,v206,v207
v_lshlrev_b32 v200,16,v168
v_and_b32 v201,0xffff0000,v168
v_lshlrev_b32 v202,16,v169
v_and_b32 v203,0xffff0000,v169
v_lshlrev_b32 v204,16,v170
v_and_b32 v205,0xffff0000,v170
v_lshlrev_b32 v206,16,v171
v_and_b32 v207,0xffff0000,v171
v_readfirstlane_b32 s78,v200
s_nop 1
v_pk_add_f32 v[184:185],v[200:201],s[78:79] op_sel_hi:[1,0] neg_lo:[0,1] neg_hi:[0,1]
v_pk_add_f32 v[186:187],v[202:203],s[78:79] op_sel_hi:[1,0] neg_lo:[0,1] neg_hi:[0,1]
v_pk_add_f32 v[188:189],v[204:205],s[78:79] op_sel_hi:[1,0] neg_lo:[0,1] neg_hi:[0,1]
v_pk_add_f32 v[190:191],v[206:207],s[78:79] op_sel_hi:[1,0] neg_lo:[0,1] neg_hi:[0,1]
v_pk_add_f32 v[192:193],v[184:185],v[186:187]
v_pk_mul_f32 v[194:195],v[184:185],v[184:185]
v_pk_add_f32 v[196:197],v[188:189],v[190:191]
v_pk_fma_f32 v[194:195],v[186:187],v[186:187],v[194:195]
v_pk_add_f32 v[192:193],v[192:193],v[196:197]
v_pk_fma_f32 v[194:195],v[188:189],v[188:189],v[194:195]
v_add_f32 v192,v192,v193
v_pk_fma_f32 v[194:195],v[190:191],v[190:191],v[194:195]
v_add_f32 v194,v194,v195
s_nop 1
v_permlane32_swap_b32 v192,v194
v_add_f32 v192,v192,v194
s_nop 1
v_add_f32_dpp v192,v192,v192 row_ror:8 row_mask:0xf bank_mask:0xf
s_nop 1
v_add_f32_dpp v192,v192,v192 row_ror:4 row_mask:0xf bank_mask:0xf
s_nop 1
v_add_f32_dpp v192,v192,v192 row_ror:2 row_mask:0xf bank_mask:0xf
s_nop 1
v_add_f32_dpp v192,v192,v192 row_ror:1 row_mask:0xf bank_mask:0xf
v_mov_b32 v194,v192
s_nop 1
v_permlane16_swap_b32 v192,v194
v_add_f32 v192,v192,v194
v_mul_f32 v192,0x3b000000,v192
v_mov_b32 v194,v192
s_nop 1
v_permlane32_swap_b32 v192,v194
v_fma_f32 v194,-v192,v192,v194
v_add_f32 v192,s78,v192
v_max_f32 v194,0,v194
v_cvt_pk_bf16_f32 v194,v192,v194
v_lshlrev_b32 v192,16,v194
v_and_b32 v194,0xffff0000,v194
v_add_f32 v194,0x3727c5ac,v194
v_cvt_pk_bf16_f32 v194,v194,v194
v_and_b32 v194,0xffff0000,v194
v_sqrt_f32 v194,v194
v_pk_add_f32 v[184:185],v[200:201],v[192:193] op_sel_hi:[1,0] neg_lo:[0,1] neg_hi:[0,1]
v_pk_add_f32 v[186:187],v[202:203],v[192:193] op_sel_hi:[1,0] neg_lo:[0,1] neg_hi:[0,1]
v_pk_add_f32 v[188:189],v[204:205],v[192:193] op_sel_hi:[1,0] neg_lo:[0,1] neg_hi:[0,1]
v_pk_add_f32 v[190:191],v[206:207],v[192:193] op_sel_hi:[1,0] neg_lo:[0,1] neg_hi:[0,1]
v_cvt_pk_bf16_f32 v194,v194,v194
v_and_b32 v194,0xffff0000,v194
v_rcp_f32 v194,v194
v_cvt_pk_bf16_f32 v172,v184,v185
v_cvt_pk_bf16_f32 v173,v186,v187
v_cvt_pk_bf16_f32 v174,v188,v189
v_cvt_pk_bf16_f32 v175,v190,v191
v_lshlrev_b32 v184,16,v172
v_and_b32 v185,0xffff0000,v172
v_lshlrev_b32 v186,16,v173
v_and_b32 v187,0xffff0000,v173
v_lshlrev_b32 v188,16,v174
v_and_b32 v189,0xffff0000,v174
v_lshlrev_b32 v190,16,v175
v_and_b32 v191,0xffff0000,v175
v_pk_mul_f32 v[184:185],v[184:185],v[194:195] op_sel_hi:[1,0]
v_pk_mul_f32 v[186:187],v[186:187],v[194:195] op_sel_hi:[1,0]
v_pk_mul_f32 v[188:189],v[188:189],v[194:195] op_sel_hi:[1,0]
v_pk_mul_f32 v[190:191],v[190:191],v[194:195] op_sel_hi:[1,0]
v_cvt_pk_bf16_f32 v172,v184,v185
v_cvt_pk_bf16_f32 v173,v186,v187
v_cvt_pk_bf16_f32 v174,v188,v189
v_cvt_pk_bf16_f32 v175,v190,v191
v_lshlrev_b32 v176,16,v172
v_and_b32 v177,0xffff0000,v172
v_lshlrev_b32 v178,16,v173
v_and_b32 v179,0xffff0000,v173
v_lshlrev_b32 v180,16,v174
v_and_b32 v181,0xffff0000,v174
v_lshlrev_b32 v182,16,v175
v_and_b32 v183,0xffff0000,v175
v_pk_add_f32 v[200:201],v[200:201],v[176:177]
v_pk_add_f32 v[202:203],v[202:203],v[178:179]
v_pk_add_f32 v[204:205],v[204:205],v[180:181]
v_pk_add_f32 v[206:207],v[206:207],v[182:183]
v_cvt_pk_bf16_f32 v160,v200,v201
v_cvt_pk_bf16_f32 v161,v202,v203
v_cvt_pk_bf16_f32 v162,v204,v205
v_cvt_pk_bf16_f32 v163,v206,v207
buffer_store_dwordx4 v[160:163],v0,s[8:11],s20 offen sc1
v_lshlrev_b32 v200,16,v160
v_and_b32 v201,0xffff0000,v160
v_lshlrev_b32 v202,16,v161
v_and_b32 v203,0xffff0000,v161
v_lshlrev_b32 v204,16,v162
v_and_b32 v205,0xffff0000,v162
v_lshlrev_b32 v206,16,v163
v_and_b32 v207,0xffff0000,v163
v_readfirstlane_b32 s78,v200
s_nop 1
v_pk_add_f32 v[184:185],v[200:201],s[78:79] op_sel_hi:[1,0] neg_lo:[0,1] neg_hi:[0,1]
v_pk_add_f32 v[186:187],v[202:203],s[78:79] op_sel_hi:[1,0] neg_lo:[0,1] neg_hi:[0,1]
v_pk_add_f32 v[188:189],v[204:205],s[78:79] op_sel_hi:[1,0] neg_lo:[0,1] neg_hi:[0,1]
v_pk_add_f32 v[190:191],v[206:207],s[78:79] op_sel_hi:[1,0] neg_lo:[0,1] neg_hi:[0,1]
v_pk_add_f32 v[192:193],v[184:185],v[186:187]
v_pk_mul_f32 v[194:195],v[184:185],v[184:185]
v_pk_add_f32 v[196:197],v[188:189],v[190:191]
v_pk_fma_f32 v[194:195],v[186:187],v[186:187],v[194:195]
v_pk_add_f32 v[192:193],v[192:193],v[196:197]
v_pk_fma_f32 v[194:195],v[188:189],v[188:189],v[194:195]
v_add_f32 v192,v192,v193
v_pk_fma_f32 v[194:195],v[190:191],v[190:191],v[194:195]
v_add_f32 v194,v194,v195
s_nop 1
v_permlane32_swap_b32 v192,v194
v_add_f32 v192,v192,v194
s_nop 1
v_add_f32_dpp v192,v192,v192 row_ror:8 row_mask:0xf bank_mask:0xf
s_nop 1
v_add_f32_dpp v192,v192,v192 row_ror:4 row_mask:0xf bank_mask:0xf
s_nop 1
v_add_f32_dpp v192,v192,v192 row_ror:2 row_mask:0xf bank_mask:0xf
s_nop 1
v_add_f32_dpp v192,v192,v192 row_ror:1 row_mask:0xf bank_mask:0xf
v_mov_b32 v194,v192
s_nop 1
v_permlane16_swap_b32 v192,v194
v_add_f32 v192,v192,v194
v_mul_f32 v192,0x3b000000,v192
v_mov_b32 v194,v192
s_nop 1
v_permlane32_swap_b32 v192,v194
v_fma_f32 v194,-v192,v192,v194
v_add_f32 v192,s78,v192
v_max_f32 v194,0,v194
v_cvt_pk_bf16_f32 v194,v192,v194
v_lshlrev_b32 v192,16,v194
v_and_b32 v194,0xffff0000,v194
v_add_f32 v194,0x3727c5ac,v194
v_cvt_pk_bf16_f32 v194,v194,v194
v_and_b32 v194,0xffff0000,v194
v_sqrt_f32 v194,v194
v_pk_add_f32 v[184:185],v[200:201],v[192:193] op_sel_hi:[1,0] neg_lo:[0,1] neg_hi:[0,1]
v_pk_add_f32 v[186:187],v[202:203],v[192:193] op_sel_hi:[1,0] neg_lo:[0,1] neg_hi:[0,1]
v_pk_add_f32 v[188:189],v[204:205],v[192:193] op_sel_hi:[1,0] neg_lo:[0,1] neg_hi:[0,1]
v_pk_add_f32 v[190:191],v[206:207],v[192:193] op_sel_hi:[1,0] neg_lo:[0,1] neg_hi:[0,1]
v_cvt_pk_bf16_f32 v194,v194,v194
v_and_b32 v194,0xffff0000,v194
v_rcp_f32 v194,v194
v_cvt_pk_bf16_f32 v164,v184,v185
v_cvt_pk_bf16_f32 v165,v186,v187
v_cvt_pk_bf16_f32 v166,v188,v189
v_cvt_pk_bf16_f32 v167,v190,v191
v_lshlrev_b32 v184,16,v164
v_and_b32 v185,0xffff0000,v164
v_lshlrev_b32 v186,16,v165
v_and_b32 v187,0xffff0000,v165
v_lshlrev_b32 v188,16,v166
v_and_b32 v189,0xffff0000,v166
v_lshlrev_b32 v190,16,v167
v_and_b32 v191,0xffff0000,v167
v_pk_mul_f32 v[184:185],v[184:185],v[194:195] op_sel_hi:[1,0]
v_pk_mul_f32 v[186:187],v[186:187],v[194:195] op_sel_hi:[1,0]
v_pk_mul_f32 v[188:189],v[188:189],v[194:195] op_sel_hi:[1,0]
v_pk_mul_f32 v[190:191],v[190:191],v[194:195] op_sel_hi:[1,0]
v_cvt_pk_bf16_f32 v164,v184,v185
v_cvt_pk_bf16_f32 v165,v186,v187
v_cvt_pk_bf16_f32 v166,v188,v189
v_cvt_pk_bf16_f32 v167,v190,v191
s_add_u32 s20,s19,2097152
buffer_store_dwordx4 v[164:167],v0,s[8:11],s20 offen sc1
v_mov_b32 v20,1
s_lshl_b32 s73,s51,13
s_lshl2_add_u32 s73,s68,s73
s_add_u32 s73,s73,10487552
s_branch L_aa_319
L_ar_353:
ds_read_b128 v[160:163],v23
ds_read_b128 v[164:167],v23 offset:16
v_lshlrev_b32 v200,16,v224
v_and_b32 v201,0xffff0000,v224
v_lshlrev_b32 v202,16,v225
v_and_b32 v203,0xffff0000,v225
v_lshlrev_b32 v204,16,v226
v_and_b32 v205,0xffff0000,v226
v_lshlrev_b32 v206,16,v227
v_and_b32 v207,0xffff0000,v227
s_lshl_b32 s18,s51,5
s_add_u32 s18,s18,s68
s_lshl_b32 s19,s18,10
s_add_u32 s20,s19,4194304
s_waitcnt lgkmcnt(0)
v_cvt_pk_bf16_f32 v168,v160,v161
v_cvt_pk_bf16_f32 v169,v162,v163
v_cvt_pk_bf16_f32 v170,v164,v165
v_cvt_pk_bf16_f32 v171,v166,v167
v_lshlrev_b32 v160,16,v168
v_and_b32 v161,0xffff0000,v168
v_lshlrev_b32 v162,16,v169
v_and_b32 v163,0xffff0000,v169
v_lshlrev_b32 v164,16,v170
v_and_b32 v165,0xffff0000,v170
v_lshlrev_b32 v166,16,v171
v_and_b32 v167,0xffff0000,v171
v_pk_add_f32 v[200:201],v[200:201],v[160:161]
v_pk_add_f32 v[202:203],v[202:203],v[162:163]
v_pk_add_f32 v[204:205],v[204:205],v[164:165]
v_pk_add_f32 v[206:207],v[206:207],v[166:167]
v_cvt_pk_bf16_f32 v168,v200,v201
v_cvt_pk_bf16_f32 v169,v202,v203
v_cvt_pk_bf16_f32 v170,v204,v205
v_cvt_pk_bf16_f32 v171,v206,v207
buffer_store_dwordx4 v[168:171],v0,s[8:11],s20 offen sc1
v_lshlrev_b32 v200,16,v168
v_and_b32 v201,0xffff0000,v168
v_lshlrev_b32 v202,16,v169
v_and_b32 v203,0xffff0000,v169
v_lshlrev_b32 v204,16,v170
v_and_b32 v205,0xffff0000,v170
v_lshlrev_b32 v206,16,v171
v_and_b32 v207,0xffff0000,v171
v_readfirstlane_b32 s78,v200
s_nop 1
v_pk_add_f32 v[184:185],v[200:201],s[78:79] op_sel_hi:[1,0] neg_lo:[0,1] neg_hi:[0,1]
v_pk_add_f32 v[186:187],v[202:203],s[78:79] op_sel_hi:[1,0] neg_lo:[0,1] neg_hi:[0,1]
v_pk_add_f32 v[188:189],v[204:205],s[78:79] op_sel_hi:[1,0] neg_lo:[0,1] neg_hi:[0,1]
v_pk_add_f32 v[190:191],v[206:207],s[78:79] op_sel_hi:[1,0] neg_lo:[0,1] neg_hi:[0,1]
v_pk_add_f32 v[192:193],v[184:185],v[186:187]
v_pk_mul_f32 v[194:195],v[184:185],v[184:185]
v_pk_add_f32 v[196:197],v[188:189],v[190:191]
v_pk_fma_f32 v[194:195],v[186:187],v[186:187],v[194:195]
v_pk_add_f32 v[192:193],v[192:193],v[196:197]
v_pk_fma_f32 v[194:195],v[188:189],v[188:189],v[194:195]
v_add_f32 v192,v192,v193
v_pk_fma_f32 v[194:195],v[190:191],v[190:191],v[194:195]
v_add_f32 v194,v194,v195
s_nop 1
v_permlane32_swap_b32 v192,v194
v_add_f32 v192,v192,v194
s_nop 1
v_add_f32_dpp v192,v192,v192 row_ror:8 row_mask:0xf bank_mask:0xf
s_nop 1
v_add_f32_dpp v192,v192,v192 row_ror:4 row_mask:0xf bank_mask:0xf
s_nop 1
v_add_f32_dpp v192,v192,v192 row_ror:2 row_mask:0xf bank_mask:0xf
s_nop 1
v_add_f32_dpp v192,v192,v192 row_ror:1 row_mask:0xf bank_mask:0xf
v_mov_b32 v194,v192
s_nop 1
v_permlane16_swap_b32 v192,v194
v_add_f32 v192,v192,v194
v_mul_f32 v192,0x3b000000,v192
v_mov_b32 v194,v192
s_nop 1
v_permlane32_swap_b32 v192,v194
v_fma_f32 v194,-v192,v192,v194
v_add_f32 v192,s78,v192
v_max_f32 v194,0,v194
v_cvt_pk_bf16_f32 v194,v192,v194
v_lshlrev_b32 v192,16,v194
v_and_b32 v194,0xffff0000,v194
v_add_f32 v194,0x3727c5ac,v194
v_cvt_pk_bf16_f32 v194,v194,v194
v_and_b32 v194,0xffff0000,v194
v_sqrt_f32 v194,v194
v_pk_add_f32 v[184:185],v[200:201],v[192:193] op_sel_hi:[1,0] neg_lo:[0,1] neg_hi:[0,1]
v_pk_add_f32 v[186:187],v[202:203],v[192:193] op_sel_hi:[1,0] neg_lo:[0,1] neg_hi:[0,1]
v_pk_add_f32 v[188:189],v[204:205],v[192:193] op_sel_hi:[1,0] neg_lo:[0,1] neg_hi:[0,1]
v_pk_add_f32 v[190:191],v[206:207],v[192:193] op_sel_hi:[1,0] neg_lo:[0,1] neg_hi:[0,1]
v_cvt_pk_bf16_f32 v194,v194,v194
v_and_b32 v194,0xffff0000,v194
v_rcp_f32 v194,v194
v_cvt_pk_bf16_f32 v172,v184,v185
v_cvt_pk_bf16_f32 v173,v186,v187
v_cvt_pk_bf16_f32 v174,v188,v189
v_cvt_pk_bf16_f32 v175,v190,v191
v_lshlrev_b32 v184,16,v172
v_and_b32 v185,0xffff0000,v172
v_lshlrev_b32 v186,16,v173
v_and_b32 v187,0xffff0000,v173
v_lshlrev_b32 v188,16,v174
v_and_b32 v189,0xffff0000,v174
v_lshlrev_b32 v190,16,v175
v_and_b32 v191,0xffff0000,v175
v_pk_mul_f32 v[184:185],v[184:185],v[194:195] op_sel_hi:[1,0]
v_pk_mul_f32 v[186:187],v[186:187],v[194:195] op_sel_hi:[1,0]
v_pk_mul_f32 v[188:189],v[188:189],v[194:195] op_sel_hi:[1,0]
v_pk_mul_f32 v[190:191],v[190:191],v[194:195] op_sel_hi:[1,0]
v_cvt_pk_bf16_f32 v172,v184,v185
v_cvt_pk_bf16_f32 v173,v186,v187
v_cvt_pk_bf16_f32 v174,v188,v189
v_cvt_pk_bf16_f32 v175,v190,v191
v_lshlrev_b32 v176,16,v172
v_and_b32 v177,0xffff0000,v172
v_lshlrev_b32 v178,16,v173
v_and_b32 v179,0xffff0000,v173
v_lshlrev_b32 v180,16,v174
v_and_b32 v181,0xffff0000,v174
v_lshlrev_b32 v182,16,v175
v_and_b32 v183,0xffff0000,v175
v_pk_mul_f32 v[236:237],v[176:177],v[228:229]
v_pk_fma_f32 v[236:237],v[178:179],v[230:231],v[236:237]
v_pk_fma_f32 v[236:237],v[180:181],v[232:233],v[236:237]
v_pk_fma_f32 v[236:237],v[182:183],v[234:235],v[236:237]
v_add_f32 v236,v236,v237
s_nop 1
v_add_f32_dpp v236,v236,v236 row_ror:8 row_mask:0xf bank_mask:0xf
s_nop 1
v_add_f32_dpp v236,v236,v236 row_ror:4 row_mask:0xf bank_mask:0xf
s_nop 1
v_add_f32_dpp v236,v236,v236 row_ror:2 row_mask:0xf bank_mask:0xf
s_nop 1
v_add_f32_dpp v236,v236,v236 row_ror:1 row_mask:0xf bank_mask:0xf
v_mov_b32 v237,v236
s_nop 1
v_permlane16_swap_b32 v236,v237
v_add_f32 v236,v236,v237
v_mov_b32 v237,v236
s_nop 1
v_permlane32_swap_b32 v236,v237
v_add_f32 v236,v236,v237
v_cvt_pk_bf16_f32 v236,v236,v236
v_and_b32 v236,0xffff0000,v236
v_ashrrev_i32 v237,31,v236
v_or_b32 v237,0x80000000,v237
v_xor_b32 v236,v236,v237
v_and_b32 v236,0xffff0000,v236
s_sub_u32 s20,4095,s18
v_or_b32 v20,s20,v236
s_lshl_b32 s20,s51,13
s_lshl2_add_u32 s20,s68,s20
s_add_u32 s20,s20,10485760
buffer_store_dword v20,v254,s[8:11],s20 offen sc1
s_branch L_aa_319
L_ar_354:
s_bitcmp1_b32 s46,0
s_cbranch_scc1 L_aa_319
ds_read_b128 v[160:163],v23
ds_read_b128 v[164:167],v23 offset:16
v_lshlrev_b32 v200,16,v224
v_and_b32 v201,0xffff0000,v224
v_lshlrev_b32 v202,16,v225
v_and_b32 v203,0xffff0000,v225
v_lshlrev_b32 v204,16,v226
v_and_b32 v205,0xffff0000,v226
v_lshlrev_b32 v206,16,v227
v_and_b32 v207,0xffff0000,v227
v_readfirstlane_b32 s22,v246
s_cmp_eq_u32 s22,0
s_cbranch_scc1 L_ag_355
L_agb_356:
s_lshl_b32 s18,s51,5
s_add_u32 s18,s18,s68
s_lshl_b32 s19,s18,10
s_add_u32 s20,s19,6291456
s_waitcnt lgkmcnt(0)
v_cvt_pk_bf16_f32 v168,v160,v161
v_cvt_pk_bf16_f32 v169,v162,v163
v_cvt_pk_bf16_f32 v170,v164,v165
v_cvt_pk_bf16_f32 v171,v166,v167
v_lshlrev_b32 v160,16,v168
v_and_b32 v161,0xffff0000,v168
v_lshlrev_b32 v162,16,v169
v_and_b32 v163,0xffff0000,v169
v_lshlrev_b32 v164,16,v170
v_and_b32 v165,0xffff0000,v170
v_lshlrev_b32 v166,16,v171
v_and_b32 v167,0xffff0000,v171
v_pk_add_f32 v[200:201],v[200:201],v[160:161]
v_pk_add_f32 v[202:203],v[202:203],v[162:163]
v_pk_add_f32 v[204:205],v[204:205],v[164:165]
v_pk_add_f32 v[206:207],v[206:207],v[166:167]
v_cvt_pk_bf16_f32 v168,v200,v201
v_cvt_pk_bf16_f32 v169,v202,v203
v_cvt_pk_bf16_f32 v170,v204,v205
v_cvt_pk_bf16_f32 v171,v206,v207
buffer_store_dwordx4 v[168:171],v0,s[8:11],s20 offen sc1
v_lshlrev_b32 v200,16,v168
v_and_b32 v201,0xffff0000,v168
v_lshlrev_b32 v202,16,v169
v_and_b32 v203,0xffff0000,v169
v_lshlrev_b32 v204,16,v170
v_and_b32 v205,0xffff0000,v170
v_lshlrev_b32 v206,16,v171
v_and_b32 v207,0xffff0000,v171
v_readfirstlane_b32 s78,v200
s_nop 1
v_pk_add_f32 v[184:185],v[200:201],s[78:79] op_sel_hi:[1,0] neg_lo:[0,1] neg_hi:[0,1]
v_pk_add_f32 v[186:187],v[202:203],s[78:79] op_sel_hi:[1,0] neg_lo:[0,1] neg_hi:[0,1]
v_pk_add_f32 v[188:189],v[204:205],s[78:79] op_sel_hi:[1,0] neg_lo:[0,1] neg_hi:[0,1]
v_pk_add_f32 v[190:191],v[206:207],s[78:79] op_sel_hi:[1,0] neg_lo:[0,1] neg_hi:[0,1]
v_pk_add_f32 v[192:193],v[184:185],v[186:187]
v_pk_mul_f32 v[194:195],v[184:185],v[184:185]
v_pk_add_f32 v[196:197],v[188:189],v[190:191]
v_pk_fma_f32 v[194:195],v[186:187],v[186:187],v[194:195]
v_pk_add_f32 v[192:193],v[192:193],v[196:197]
v_pk_fma_f32 v[194:195],v[188:189],v[188:189],v[194:195]
v_add_f32 v192,v192,v193
v_pk_fma_f32 v[194:195],v[190:191],v[190:191],v[194:195]
v_add_f32 v194,v194,v195
s_nop 1
v_permlane32_swap_b32 v192,v194
v_add_f32 v192,v192,v194
s_nop 1
v_add_f32_dpp v192,v192,v192 row_ror:8 row_mask:0xf bank_mask:0xf
s_nop 1
v_add_f32_dpp v192,v192,v192 row_ror:4 row_mask:0xf bank_mask:0xf
s_nop 1
v_add_f32_dpp v192,v192,v192 row_ror:2 row_mask:0xf bank_mask:0xf
s_nop 1
v_add_f32_dpp v192,v192,v192 row_ror:1 row_mask:0xf bank_mask:0xf
v_mov_b32 v194,v192
s_nop 1
v_permlane16_swap_b32 v192,v194
v_add_f32 v192,v192,v194
v_mul_f32 v192,0x3b000000,v192
v_mov_b32 v194,v192
s_nop 1
v_permlane32_swap_b32 v192,v194
v_fma_f32 v194,-v192,v192,v194
v_add_f32 v192,s78,v192
v_max_f32 v194,0,v194
v_cvt_pk_bf16_f32 v194,v192,v194
v_lshlrev_b32 v192,16,v194
v_and_b32 v194,0xffff0000,v194
v_add_f32 v194,0x3727c5ac,v194
v_cvt_pk_bf16_f32 v194,v194,v194
v_and_b32 v194,0xffff0000,v194
v_sqrt_f32 v194,v194
v_pk_add_f32 v[184:185],v[200:201],v[192:193] op_sel_hi:[1,0] neg_lo:[0,1] neg_hi:[0,1]
v_pk_add_f32 v[186:187],v[202:203],v[192:193] op_sel_hi:[1,0] neg_lo:[0,1] neg_hi:[0,1]
v_pk_add_f32 v[188:189],v[204:205],v[192:193] op_sel_hi:[1,0] neg_lo:[0,1] neg_hi:[0,1]
v_pk_add_f32 v[190:191],v[206:207],v[192:193] op_sel_hi:[1,0] neg_lo:[0,1] neg_hi:[0,1]
v_cvt_pk_bf16_f32 v194,v194,v194
v_and_b32 v194,0xffff0000,v194
v_rcp_f32 v194,v194
v_cvt_pk_bf16_f32 v172,v184,v185
v_cvt_pk_bf16_f32 v173,v186,v187
v_cvt_pk_bf16_f32 v174,v188,v189
v_cvt_pk_bf16_f32 v175,v190,v191
v_lshlrev_b32 v184,16,v172
v_and_b32 v185,0xffff0000,v172
v_lshlrev_b32 v186,16,v173
v_and_b32 v187,0xffff0000,v173
v_lshlrev_b32 v188,16,v174
v_and_b32 v189,0xffff0000,v174
v_lshlrev_b32 v190,16,v175
v_and_b32 v191,0xffff0000,v175
v_pk_mul_f32 v[184:185],v[184:185],v[194:195] op_sel_hi:[1,0]
v_pk_mul_f32 v[186:187],v[186:187],v[194:195] op_sel_hi:[1,0]
v_pk_mul_f32 v[188:189],v[188:189],v[194:195] op_sel_hi:[1,0]
v_pk_mul_f32 v[190:191],v[190:191],v[194:195] op_sel_hi:[1,0]
v_cvt_pk_bf16_f32 v172,v184,v185
v_cvt_pk_bf16_f32 v173,v186,v187
v_cvt_pk_bf16_f32 v174,v188,v189
v_cvt_pk_bf16_f32 v175,v190,v191
v_lshlrev_b32 v176,16,v172
v_and_b32 v177,0xffff0000,v172
v_lshlrev_b32 v178,16,v173
v_and_b32 v179,0xffff0000,v173
v_lshlrev_b32 v180,16,v174
v_and_b32 v181,0xffff0000,v174
v_lshlrev_b32 v182,16,v175
v_and_b32 v183,0xffff0000,v175
v_pk_add_f32 v[200:201],v[200:201],v[176:177]
v_pk_add_f32 v[202:203],v[202:203],v[178:179]
v_pk_add_f32 v[204:205],v[204:205],v[180:181]
v_pk_add_f32 v[206:207],v[206:207],v[182:183]
v_cvt_pk_bf16_f32 v160,v200,v201
v_cvt_pk_bf16_f32 v161,v202,v203
v_cvt_pk_bf16_f32 v162,v204,v205
v_cvt_pk_bf16_f32 v163,v206,v207
buffer_store_dwordx4 v[160:163],v0,s[12:15],s19 offen sc1
v_pk_mul_f32 v[236:237],v[176:177],v[228:229]
v_pk_fma_f32 v[236:237],v[178:179],v[230:231],v[236:237]
v_pk_fma_f32 v[236:237],v[180:181],v[232:233],v[236:237]
v_pk_fma_f32 v[236:237],v[182:183],v[234:235],v[236:237]
v_add_f32 v236,v236,v237
s_nop 1
v_add_f32_dpp v236,v236,v236 row_ror:8 row_mask:0xf bank_mask:0xf
s_nop 1
v_add_f32_dpp v236,v236,v236 row_ror:4 row_mask:0xf bank_mask:0xf
s_nop 1
v_add_f32_dpp v236,v236,v236 row_ror:2 row_mask:0xf bank_mask:0xf
s_nop 1
v_add_f32_dpp v236,v236,v236 row_ror:1 row_mask:0xf bank_mask:0xf
v_mov_b32 v237,v236
s_nop 1
v_permlane16_swap_b32 v236,v237
v_add_f32 v236,v236,v237
v_mov_b32 v237,v236
s_nop 1
v_permlane32_swap_b32 v236,v237
v_add_f32 v236,v236,v237
v_cvt_pk_bf16_f32 v236,v236,v236
v_and_b32 v236,0xffff0000,v236
v_ashrrev_i32 v237,31,v236
v_or_b32 v237,0x80000000,v237
v_xor_b32 v236,v236,v237
v_and_b32 v236,0xffff0000,v236
s_sub_u32 s20,4095,s18
v_or_b32 v20,s20,v236
s_lshl_b32 s73,s51,13
s_lshl2_add_u32 s73,s68,s73
s_add_u32 s73,s73,10485760
s_add_u32 s73,s73,s86
L_aa_319:
s_cmp_eq_u32 s27,1
s_cbranch_scc1 L_ad_357
s_cmp_eq_u32 s27,0
s_cbranch_scc1 L_aa_320
s_cmp_eq_u32 s27,4
s_cbranch_scc1 L_a4_340
s_cmp_ge_u32 s77,64
s_cbranch_scc1 L_aa_323
L_aa_321:
s_waitcnt vmcnt(0)
buffer_store_dword v20,off,s[8:11],s73 sc1
s_mov_b32 s73,0x80000000
v_mov_b32 v18,0
s_mov_b32 s27,0
L_aw_358:
v_cmp_eq_u32 vcc,0,v18
s_cbranch_vccz L_awd_359
buffer_load_dword v18,v19,s[8:11],0 offen sc1
s_sub_u32 s49,s49,1
s_cbranch_scc1 L_abort2
s_waitcnt vmcnt(0)
s_branch L_aw_358
L_awd_359:
L_a3_360:
s_mov_b32 s64,s70
s_mov_b32 s65,s71
s_add_u32 s64,s64,s28
s_add_u32 s65,s65,s29
s_xor_b32 s58,s67,s40
s_xor_b32 s57,s67,s41
s_add_u32 m0,s58,0
s_nop 0
buffer_load_dwordx4 v0,s[8:11],s64 offen offset:0 sc1 lds
buffer_load_dwordx4 v0,s[8:11],s64 offen offset:1024 sc1 lds
buffer_load_dwordx4 v0,s[8:11],s64 offen offset:2048 sc1 lds
buffer_load_dwordx4 v0,s[8:11],s64 offen offset:3072 sc1 lds
s_add_u32 m0,s58,4096
s_add_u32 s64,s64,4096
buffer_load_dwordx4 v0,s[8:11],s64 offen offset:0 sc1 lds
buffer_load_dwordx4 v0,s[8:11],s64 offen offset:1024 sc1 lds
buffer_load_dwordx4 v0,s[8:11],s64 offen offset:2048 sc1 lds
buffer_load_dwordx4 v0,s[8:11],s64 offen offset:3072 sc1 lds
s_add_u32 m0,s58,8192
s_add_u32 s64,s64,4096
buffer_load_dwordx4 v0,s[8:11],s64 offen offset:0 sc1 lds
buffer_load_dwordx4 v0,s[8:11],s64 offen offset:1024 sc1 lds
buffer_load_dwordx4 v0,s[8:11],s64 offen offset:2048 sc1 lds
buffer_load_dwordx4 v0,s[8:11],s64 offen offset:3072 sc1 lds
s_add_u32 m0,s57,24576
s_nop 0
buffer_load_dwordx4 v0,s[8:11],s65 offen offset:0 sc1 lds
buffer_load_dwordx4 v0,s[8:11],s65 offen offset:1024 sc1 lds
v_lshrrev_b32 v244,4,v1
s_sub_u32 s56,s77,8
v_add_u32 v244,s56,v244
v_max_i32 v244,0,v244
v_lshl_add_u32 v244,v244,13,v21
buffer_load_dwordx2 v[242:243],v244,s[8:11],0 offen sc1
s_waitcnt vmcnt(0) lgkmcnt(0)
s_barrier
s_xor_b32 s67,s67,65536
s_and_b32 s56,s50,2048
s_lshl_b32 s56,s56,4
s_add_u32 s56,s56,s67
v_add_u32 v2,s56,v0
v_add_u32 v239,s56,v253
s_and_b32 s56,s50,1024
s_lshl_b32 s56,s56,2
v_add_u32 v238,s56,v2
s_mov_b32 s76,s71
s_mov_b32 s53,s77
ds_read_b128 v[24:27],v238 offset:16384
ds_read_b128 v[40:43],v2 offset:0
ds_read_b128 v[56:59],v2 offset:4096
ds_read_b128 v[28:31],v238 offset:17408
ds_read_b128 v[44:47],v2 offset:1024
ds_read_b128 v[60:63],v2 offset:5120
ds_read_b128 v[32:35],v238 offset:18432
ds_read_b128 v[48:51],v2 offset:2048
ds_read_b128 v[64:67],v2 offset:6144
ds_read_b128 v[36:39],v238 offset:19456
ds_read_b128 v[52:55],v2 offset:3072
ds_read_b128 v[68:71],v2 offset:7168
s_waitcnt lgkmcnt(9)
v_mfma_f32_16x16x32_bf16 v[128:131],v[40:43],v[24:27],v[8:11]
ds_read_b128 v[72:75],v2 offset:24576
v_mfma_f32_16x16x32_bf16 v[132:135],v[56:59],v[24:27],v[12:15]
ds_read_b128 v[76:79],v2 offset:25600
s_waitcnt lgkmcnt(8)
v_mfma_f32_16x16x32_bf16 v[128:131],v[44:47],v[28:31],v[128:131]
ds_read_b128 v[80:83],v2 offset:26624
v_mfma_f32_16x16x32_bf16 v[132:135],v[60:63],v[28:31],v[132:135]
ds_read_b128 v[84:87],v2 offset:27648
s_waitcnt lgkmcnt(7)
v_mfma_f32_16x16x32_bf16 v[128:131],v[48:51],v[32:35],v[128:131]
ds_read_b64 v[120:121],v239 offset:24576
v_mfma_f32_16x16x32_bf16 v[132:135],v[64:67],v[32:35],v[132:135]
ds_read_b64 v[122:123],v239 offset:25600
s_waitcnt lgkmcnt(6)
v_mfma_f32_16x16x32_bf16 v[128:131],v[52:55],v[36:39],v[128:131]
ds_read_b64 v[124:125],v239 offset:26624
v_mfma_f32_16x16x32_bf16 v[132:135],v[68:71],v[36:39],v[132:135]
ds_read_b64 v[126:127],v239 offset:27648
s_waitcnt lgkmcnt(4)
v_mfma_f32_16x16x32_bf16 v[136:139],v[72:75],v[24:27],0
ds_read_b128 v[88:91],v2 offset:8192
ds_read_b128 v[92:95],v2 offset:9216
v_mfma_f32_16x16x32_bf16 v[136:139],v[76:79],v[28:31],v[136:139]
ds_read_b128 v[96:99],v2 offset:10240
ds_read_b128 v[100:103],v2 offset:11264
v_mfma_f32_16x16x32_bf16 v[136:139],v[80:83],v[32:35],v[136:139]
ds_read_b128 v[104:107],v2 offset:12288
ds_read_b128 v[108:111],v2 offset:13312
v_mfma_f32_16x16x32_bf16 v[136:139],v[84:87],v[36:39],v[136:139]
ds_read_b128 v[112:115],v2 offset:14336
ds_read_b128 v[116:119],v2 offset:15360
s_waitcnt lgkmcnt(0)
s_cmp_eq_u32 s30,0
s_cbranch_scc1 L_aa_322
s_cmp_lg_u32 s86,1536
s_cbranch_scc1 L_ae_361
s_mov_b32 s77,s35
s_mov_b32 s30,0
s_lshl_b32 s56,s77,5
s_add_u32 s56,s56,s68
s_mul_i32 s70,s56,24576
s_lshl_b32 s71,s56,12
s_lshl_b32 s59,s77,13
s_lshl2_add_u32 s59,s68,s59
s_add_u32 s59,s59,10485760
s_buffer_load_dword s32,s[8:11],s59
s_mov_b32 s33,1
s_add_u32 s70,s70,100663296
s_add_u32 s71,s71,41943040
v_mov_b32 v19,s59
s_branch L_af_362
L_ae_361:
s_ff1_i32_b64 s77,s[84:85]
s_bitset0_b64 s[84:85],s77
s_min_u32 s77,s77,64
s_lshr_b32 s61,s55,5
s_lshl_b32 s56,s77,5
s_add_u32 s56,s56,s68
s_mul_i32 s70,s56,24576
s_lshl_b32 s71,s56,12
s_lshl_b32 s59,s77,13
s_lshl2_add_u32 s59,s68,s59
s_add_u32 s59,s59,10486144
s_cmp_lt_u32 s77,s61
s_cselect_b32 s57,0,16777216
s_mov_b32 s60,s59
s_buffer_load_dword s33,s[8:11],s60
s_add_u32 s71,s71,s57
s_add_u32 s71,s71,58720256
s_cmp_eq_u32 s77,s61
s_cselect_b32 s57,50331648,0
s_cselect_b32 s58,1536,0
s_add_u32 s59,s59,s58
s_buffer_load_dword s32,s[8:11],s59
s_add_u32 s70,s70,s57
s_add_u32 s70,s70,150994944
v_mov_b32 v19,s59
v_writelane_b32 v19,s60,1
L_af_362:
L_a4_340:
s_waitcnt vmcnt(0)
buffer_store_dword v20,off,s[8:11],s73 sc1
s_mov_b32 s73,0x80000000
v_max3_u32 v238,v72,v73,v74
v_max3_u32 v238,v74,v75,v238
v_max3_u32 v238,v76,v77,v238
v_max3_u32 v238,v78,v79,v238
v_max3_u32 v238,v80,v81,v238
v_max3_u32 v238,v82,v83,v238
v_max3_u32 v238,v84,v85,v238
v_max3_u32 v238,v86,v87,v238
v_max3_u32 v238,v120,v121,v238
v_max3_u32 v238,v122,v123,v238
v_max3_u32 v238,v124,v125,v238
v_max3_u32 v238,v126,v127,v238
v_cmp_eq_u32 vcc,-1,v238
s_cbranch_vccnz L_ac_363
L_acb_364:
v_max3_f32 v238,v128,v129,v130
v_max3_f32 v239,v131,v132,v133
v_max3_f32 v238,v134,v135,v238
v_max3_f32 v239,v138,v139,v239
v_max_f32 v238,v238,v239
v_max_f32 v239,v238,v239
v_pk_mul_f32 v[128:129],v[128:129],v[152:153] op_sel_hi:[1,0]
v_pk_mul_f32 v[130:131],v[130:131],v[152:153] op_sel_hi:[1,0]
v_permlane16_swap_b32 v238,v239
v_max_f32 v238,v238,v239
v_max_f32 v239,v238,v239
v_pk_mul_f32 v[132:133],v[132:133],v[152:153] op_sel_hi:[1,0]
v_pk_mul_f32 v[134:135],v[134:135],v[152:153] op_sel_hi:[1,0]
v_permlane32_swap_b32 v238,v239
v_max_f32 v238,v238,v239
v_mul_f32 v238,v152,v238
v_pk_mul_f32 v[138:139],v[138:139],v[152:153] op_sel_hi:[1,0]
v_pk_add_f32 v[128:129],v[128:129],v[238:239] op_sel_hi:[1,0] neg_lo:[0,1] neg_hi:[0,1]
v_pk_add_f32 v[130:131],v[130:131],v[238:239] op_sel_hi:[1,0] neg_lo:[0,1] neg_hi:[0,1]
v_pk_add_f32 v[132:133],v[132:133],v[238:239] op_sel_hi:[1,0] neg_lo:[0,1] neg_hi:[0,1]
v_pk_add_f32 v[134:135],v[134:135],v[238:239] op_sel_hi:[1,0] neg_lo:[0,1] neg_hi:[0,1]
v_pk_add_f32 v[138:139],v[138:139],v[238:239] op_sel_hi:[1,0] neg_lo:[0,1] neg_hi:[0,1]
v_exp_f32 v128,v128
v_exp_f32 v129,v129
v_exp_f32 v130,v130
v_exp_f32 v131,v131
v_exp_f32 v132,v132
v_exp_f32 v133,v133
v_exp_f32 v134,v134
v_exp_f32 v135,v135
v_exp_f32 v138,v138
v_exp_f32 v139,v139
v_pk_add_f32 v[148:149],v[128:129],v[130:131]
v_pk_add_f32 v[150:151],v[132:133],v[134:135]
v_pk_add_f32 v[148:149],v[148:149],v[138:139]
v_pk_add_f32 v[148:149],v[148:149],v[150:151]
v_add_f32 v150,v148,v149
v_add_f32 v151,v148,v149
s_nop 1
v_permlane16_swap_b32 v150,v151
v_add_f32 v148,v150,v151
v_add_f32 v149,v150,v151
s_nop 1
v_permlane32_swap_b32 v148,v149
v_add_f32 v148,v148,v149
v_rcp_f32 v148,v148
s_nop 0
v_pk_mul_f32 v[138:139],v[138:139],v[148:149] op_sel_hi:[1,0]
v_pk_mul_f32 v[128:129],v[128:129],v[148:149] op_sel_hi:[1,0]
v_pk_mul_f32 v[130:131],v[130:131],v[148:149] op_sel_hi:[1,0]
v_pk_mul_f32 v[132:133],v[132:133],v[148:149] op_sel_hi:[1,0]
v_pk_mul_f32 v[134:135],v[134:135],v[148:149] op_sel_hi:[1,0]
v_cvt_pk_bf16_f32 v144,v138,v139
v_cvt_pk_bf16_f32 v147,v138,v139
s_nop 0
v_mfma_f32_16x16x16_bf16 v[24:27],v[120:121],v[144:145],0
v_cvt_pk_bf16_f32 v140,v128,v129
v_mfma_f32_16x16x16_bf16 v[28:31],v[120:121],v[146:147],0
v_cvt_pk_bf16_f32 v141,v130,v131
v_mfma_f32_16x16x16_bf16 v[32:35],v[122:123],v[144:145],0
v_cvt_pk_bf16_f32 v142,v132,v133
v_mfma_f32_16x16x16_bf16 v[36:39],v[122:123],v[146:147],0
v_cvt_pk_bf16_f32 v143,v134,v135
v_mfma_f32_16x16x16_bf16 v[40:43],v[124:125],v[144:145],0
v_mfma_f32_16x16x16_bf16 v[44:47],v[124:125],v[146:147],0
v_mfma_f32_16x16x16_bf16 v[48:51],v[126:127],v[144:145],0
v_mfma_f32_16x16x16_bf16 v[52:55],v[126:127],v[146:147],0
v_mfma_f32_16x16x32_bf16 v[24:27],v[88:91],v[140:143],v[24:27]
v_mfma_f32_16x16x32_bf16 v[28:31],v[92:95],v[140:143],v[28:31]
v_mfma_f32_16x16x32_bf16 v[32:35],v[96:99],v[140:143],v[32:35]
v_mfma_f32_16x16x32_bf16 v[36:39],v[100:103],v[140:143],v[36:39]
v_cvt_pk_bf16_f32 v72,v24,v28
v_cvt_pk_bf16_f32 v73,v25,v29
v_mfma_f32_16x16x32_bf16 v[40:43],v[104:107],v[140:143],v[40:43]
v_cvt_pk_bf16_f32 v74,v26,v30
v_cvt_pk_bf16_f32 v75,v27,v31
v_mfma_f32_16x16x32_bf16 v[44:47],v[108:111],v[140:143],v[44:47]
ds_write_b128 v3,v[72:75] offset:0
v_cvt_pk_bf16_f32 v76,v32,v36
v_cvt_pk_bf16_f32 v77,v33,v37
v_mfma_f32_16x16x32_bf16 v[48:51],v[112:115],v[140:143],v[48:51]
v_cvt_pk_bf16_f32 v78,v34,v38
v_cvt_pk_bf16_f32 v79,v35,v39
v_mfma_f32_16x16x32_bf16 v[52:55],v[116:119],v[140:143],v[52:55]
ds_write_b128 v3,v[76:79] offset:1024
v_cvt_pk_bf16_f32 v80,v40,v44
v_cvt_pk_bf16_f32 v81,v41,v45
v_cvt_pk_bf16_f32 v82,v42,v46
v_cvt_pk_bf16_f32 v83,v43,v47
ds_write_b128 v3,v[80:83] offset:2048
s_nop 1
v_cvt_pk_bf16_f32 v84,v48,v52
v_cvt_pk_bf16_f32 v85,v49,v53
v_cvt_pk_bf16_f32 v86,v50,v54
v_cvt_pk_bf16_f32 v87,v51,v55
ds_write_b128 v3,v[84:87] offset:3072
s_waitcnt lgkmcnt(0)
s_barrier
L_ad_357:
s_mov_b32 s51,s53
s_mov_b32 s31,1
s_branch L_aa_314
L_aa_320:
s_waitcnt vmcnt(0)
buffer_store_dword v20,off,s[8:11],s73 sc1
s_mov_b32 s73,0x80000000
L_aa_322:
s_mov_b32 s51,s53
s_mov_b32 s31,0
s_add_u32 s35,s53,4
s_cmp_lt_u32 s53,5
s_cbranch_scc1 L_ab_365
s_cmp_ge_u32 s53,62
s_cbranch_scc1 L_am_367
L_aw_368:
v_min_u32 v239,v242,v243
v_cmp_eq_u32 vcc,0,v239
s_cbranch_vccz L_awd_369
s_sleep 4
buffer_load_dwordx2 v[242:243],v244,s[8:11],0 offen sc1
s_sub_u32 s49,s49,1
s_cbranch_scc1 L_abort2
s_waitcnt vmcnt(0)
s_branch L_aw_368
L_awd_369:
v_max_u32 v242,v242,v243
s_nop 1
v_max_u32_dpp v242,v242,v242 row_ror:8 row_mask:0xf bank_mask:0xf
s_nop 1
v_max_u32_dpp v242,v242,v242 row_ror:4 row_mask:0xf bank_mask:0xf
s_nop 1
v_max_u32_dpp v242,v242,v242 row_ror:2 row_mask:0xf bank_mask:0xf
s_nop 1
v_max_u32_dpp v242,v242,v242 row_ror:1 row_mask:0xf bank_mask:0xf
v_mov_b32 v243,v242
s_nop 1
v_permlane16_swap_b32 v242,v243
v_max_u32 v242,v242,v243
v_mov_b32 v243,v242
s_nop 1
v_permlane32_swap_b32 v242,v243
v_max_u32 v242,v242,v243
s_nop 0
v_readfirstlane_b32 s56,v242
v_readlane_b32 s57,v255,s53
s_max_u32 s75,s75,s56
s_bitcmp0_b64 s[42:43],s53
s_cbranch_scc1 L_ab_365
s_mov_b32 s77,s36
s_and_b32 s55,s75,0x7ff
s_sub_u32 s55,2047,s55
s_cmp_lt_u32 s75,s57
s_cselect_b32 s55,4095,s55
s_lshr_b32 s61,s55,5
s_mov_b32 s30,1
s_lshl_b32 s56,s77,5
s_add_u32 s56,s56,s68
s_mul_i32 s70,s56,24576
s_lshl_b32 s71,s56,12
s_lshl_b32 s59,s77,13
s_lshl2_add_u32 s59,s68,s59
s_add_u32 s59,s59,10486144
s_cmp_lt_u32 s77,s61
s_cselect_b32 s57,0,16777216
s_mov_b32 s60,s59
s_add_u32 s71,s71,s57
s_add_u32 s71,s71,58720256
s_cmp_eq_u32 s77,s61
s_cselect_b32 s57,50331648,0
s_cselect_b32 s58,1536,0
s_add_u32 s59,s59,s58
s_add_u32 s70,s70,s57
s_add_u32 s70,s70,150994944
v_mov_b32 v19,s59
v_writelane_b32 v19,s60,1
s_branch L_aj_366
L_ab_365:
s_mov_b32 s77,s35
s_mov_b32 s30,0
s_lshl_b32 s56,s77,5
s_add_u32 s56,s56,s68
s_mul_i32 s70,s56,24576
s_lshl_b32 s71,s56,12
s_lshl_b32 s59,s77,13
s_lshl2_add_u32 s59,s68,s59
s_add_u32 s59,s59,10485760
s_mov_b32 s33,1
s_add_u32 s70,s70,100663296
s_add_u32 s71,s71,41943040
v_mov_b32 v19,s59
L_aj_366:
buffer_load_dword v18,v19,s[8:11],0 offen sc1
s_waitcnt vmcnt(2)
v_mfma_f32_16x16x32_bf16 v[136:139],v[72:75],v[24:27],0
v_max3_u32 v238,v72,v73,v74
v_max3_u32 v238,v74,v75,v238
v_mfma_f32_16x16x32_bf16 v[136:139],v[76:79],v[28:31],v[136:139]
v_max3_u32 v238,v76,v77,v238
v_max3_u32 v238,v78,v79,v238
v_mfma_f32_16x16x32_bf16 v[136:139],v[80:83],v[32:35],v[136:139]
v_max3_u32 v238,v80,v81,v238
v_max3_u32 v238,v82,v83,v238
v_mfma_f32_16x16x32_bf16 v[136:139],v[84:87],v[36:39],v[136:139]
v_max3_u32 v238,v84,v85,v238
v_max3_u32 v238,v86,v87,v238
v_max3_u32 v238,v120,v121,v238
v_max3_u32 v238,v122,v123,v238
v_max3_u32 v238,v124,v125,v238
v_max3_u32 v238,v126,v127,v238
v_cmp_eq_u32 vcc,-1,v238
s_cbranch_vccz L_aa_325
L_aa_324:
buffer_load_dwordx4 v[72:75],v0,s[8:11],s76 offen offset:0 sc1
buffer_load_dwordx4 v[76:79],v0,s[8:11],s76 offen offset:1024 sc1
buffer_load_dwordx4 v[80:83],v0,s[8:11],s76 offen offset:2048 sc1
buffer_load_dwordx4 v[84:87],v0,s[8:11],s76 offen offset:3072 sc1
buffer_load_dwordx2 v[120:121],v253,s[8:11],s76 offen offset:0 sc1
buffer_load_dwordx2 v[122:123],v253,s[8:11],s76 offen offset:1024 sc1
buffer_load_dwordx2 v[124:125],v253,s[8:11],s76 offen offset:2048 sc1
buffer_load_dwordx2 v[126:127],v253,s[8:11],s76 offen offset:3072 sc1
buffer_load_dword v18,v19,s[8:11],0 offen sc1
s_sub_u32 s49,s49,1
s_cbranch_scc1 L_abort2
s_waitcnt vmcnt(8)
v_mfma_f32_16x16x32_bf16 v[136:139],v[72:75],v[24:27],0
v_max3_u32 v238,v72,v73,v74
v_max3_u32 v238,v74,v75,v238
s_waitcnt vmcnt(7)
v_mfma_f32_16x16x32_bf16 v[136:139],v[76:79],v[28:31],v[136:139]
v_max3_u32 v238,v76,v77,v238
v_max3_u32 v238,v78,v79,v238
s_waitcnt vmcnt(6)
v_mfma_f32_16x16x32_bf16 v[136:139],v[80:83],v[32:35],v[136:139]
v_max3_u32 v238,v80,v81,v238
v_max3_u32 v238,v82,v83,v238
s_waitcnt vmcnt(5)
v_mfma_f32_16x16x32_bf16 v[136:139],v[84:87],v[36:39],v[136:139]
v_max3_u32 v238,v84,v85,v238
v_max3_u32 v238,v86,v87,v238
s_waitcnt vmcnt(1)
v_max3_u32 v238,v120,v121,v238
v_max3_u32 v238,v122,v123,v238
v_max3_u32 v238,v124,v125,v238
v_max3_u32 v238,v126,v127,v238
v_cmp_eq_u32 vcc,-1,v238
s_cbranch_vccnz L_aa_324
L_aa_325:
s_cmp_lg_u32 s27,3
s_cbranch_scc1 L_ai_370
v_max3_f32 v238,v128,v129,v130
v_max3_f32 v239,v131,v132,v133
v_max3_f32 v238,v134,v135,v238
v_max3_f32 v239,v138,v139,v239
v_max_f32 v238,v238,v239
v_max_f32 v239,v238,v239
v_pk_mul_f32 v[128:129],v[128:129],v[152:153] op_sel_hi:[1,0]
v_pk_mul_f32 v[130:131],v[130:131],v[152:153] op_sel_hi:[1,0]
v_permlane16_swap_b32 v238,v239
v_max_f32 v238,v238,v239
v_max_f32 v239,v238,v239
v_pk_mul_f32 v[132:133],v[132:133],v[152:153] op_sel_hi:[1,0]
v_pk_mul_f32 v[134:135],v[134:135],v[152:153] op_sel_hi:[1,0]
v_permlane32_swap_b32 v238,v239
v_max_f32 v238,v238,v239
v_mul_f32 v238,v152,v238
v_pk_mul_f32 v[138:139],v[138:139],v[152:153] op_sel_hi:[1,0]
buffer_load_dword v17,v16,s[8:11],s87 offen sc1
v_pk_add_f32 v[128:129],v[128:129],v[238:239] op_sel_hi:[1,0] neg_lo:[0,1] neg_hi:[0,1]
v_pk_add_f32 v[130:131],v[130:131],v[238:239] op_sel_hi:[1,0] neg_lo:[0,1] neg_hi:[0,1]
v_pk_add_f32 v[132:133],v[132:133],v[238:239] op_sel_hi:[1,0] neg_lo:[0,1] neg_hi:[0,1]
v_pk_add_f32 v[134:135],v[134:135],v[238:239] op_sel_hi:[1,0] neg_lo:[0,1] neg_hi:[0,1]
v_pk_add_f32 v[138:139],v[138:139],v[238:239] op_sel_hi:[1,0] neg_lo:[0,1] neg_hi:[0,1]
v_exp_f32 v128,v128
v_exp_f32 v129,v129
v_exp_f32 v130,v130
v_exp_f32 v131,v131
v_exp_f32 v132,v132
v_exp_f32 v133,v133
v_exp_f32 v134,v134
v_exp_f32 v135,v135
v_exp_f32 v138,v138
v_exp_f32 v139,v139
v_pk_add_f32 v[148:149],v[128:129],v[130:131]
v_pk_add_f32 v[150:151],v[132:133],v[134:135]
v_pk_add_f32 v[148:149],v[148:149],v[138:139]
v_pk_add_f32 v[148:149],v[148:149],v[150:151]
v_add_f32 v150,v148,v149
v_add_f32 v151,v148,v149
s_nop 1
v_permlane16_swap_b32 v150,v151
v_add_f32 v148,v150,v151
v_add_f32 v149,v150,v151
s_nop 1
v_permlane32_swap_b32 v148,v149
v_add_f32 v148,v148,v149
v_rcp_f32 v148,v148
s_waitcnt vmcnt(0)
v_cmp_gt_u32 vcc,s66,v17
v_pk_mul_f32 v[138:139],v[138:139],v[148:149] op_sel_hi:[1,0]
v_pk_mul_f32 v[128:129],v[128:129],v[148:149] op_sel_hi:[1,0]
v_pk_mul_f32 v[130:131],v[130:131],v[148:149] op_sel_hi:[1,0]
v_pk_mul_f32 v[132:133],v[132:133],v[148:149] op_sel_hi:[1,0]
v_pk_mul_f32 v[134:135],v[134:135],v[148:149] op_sel_hi:[1,0]
s_cbranch_vccnz L_ap_371
L_apb_372:
s_xor_b32 s34,s69,524288
buffer_load_dwordx4 v[192:195],v7,s[8:11],s34 offen sc1
v_cvt_pk_bf16_f32 v144,v138,v139
v_cvt_pk_bf16_f32 v147,v138,v139
s_nop 0
v_mfma_f32_16x16x16_bf16 v[24:27],v[120:121],v[144:145],0
s_add_u32 s34,s34,4096
v_cvt_pk_bf16_f32 v140,v128,v129
v_mfma_f32_16x16x16_bf16 v[28:31],v[120:121],v[146:147],0
buffer_load_dwordx4 v[196:199],v7,s[8:11],s34 offen sc1
v_cvt_pk_bf16_f32 v141,v130,v131
v_mfma_f32_16x16x16_bf16 v[32:35],v[122:123],v[144:145],0
s_add_u32 s34,s34,4096
v_cvt_pk_bf16_f32 v142,v132,v133
v_mfma_f32_16x16x16_bf16 v[36:39],v[122:123],v[146:147],0
buffer_load_dwordx4 v[200:203],v7,s[8:11],s34 offen sc1
v_cvt_pk_bf16_f32 v143,v134,v135
v_mfma_f32_16x16x16_bf16 v[40:43],v[124:125],v[144:145],0
s_add_u32 s34,s34,4096
v_mfma_f32_16x16x16_bf16 v[44:47],v[124:125],v[146:147],0
buffer_load_dwordx4 v[204:207],v7,s[8:11],s34 offen sc1
v_mfma_f32_16x16x16_bf16 v[48:51],v[126:127],v[144:145],0
s_add_u32 s34,s34,4096
v_mfma_f32_16x16x16_bf16 v[52:55],v[126:127],v[146:147],0
buffer_load_dwordx4 v[208:211],v7,s[8:11],s34 offen sc1
v_mfma_f32_16x16x32_bf16 v[24:27],v[88:91],v[140:143],v[24:27]
s_add_u32 s34,s34,4096
v_mfma_f32_16x16x32_bf16 v[28:31],v[92:95],v[140:143],v[28:31]
buffer_load_dwordx4 v[212:215],v7,s[8:11],s34 offen sc1
v_mfma_f32_16x16x32_bf16 v[32:35],v[96:99],v[140:143],v[32:35]
s_add_u32 s34,s34,4096
v_mfma_f32_16x16x32_bf16 v[36:39],v[100:103],v[140:143],v[36:39]
buffer_load_dwordx4 v[216:219],v7,s[8:11],s34 offen sc1
v_cvt_pk_bf16_f32 v72,v24,v28
v_cvt_pk_bf16_f32 v73,v25,v29
v_mfma_f32_16x16x32_bf16 v[40:43],v[104:107],v[140:143],v[40:43]
s_add_u32 s34,s34,4096
v_cvt_pk_bf16_f32 v74,v26,v30
v_cvt_pk_bf16_f32 v75,v27,v31
v_mfma_f32_16x16x32_bf16 v[44:47],v[108:111],v[140:143],v[44:47]
ds_write_b128 v3,v[72:75] offset:0
v_cvt_pk_bf16_f32 v76,v32,v36
v_cvt_pk_bf16_f32 v77,v33,v37
v_mfma_f32_16x16x32_bf16 v[48:51],v[112:115],v[140:143],v[48:51]
buffer_load_dwordx4 v[220:223],v7,s[8:11],s34 offen sc1
v_cvt_pk_bf16_f32 v78,v34,v38
v_cvt_pk_bf16_f32 v79,v35,v39
v_mfma_f32_16x16x32_bf16 v[52:55],v[116:119],v[140:143],v[52:55]
ds_write_b128 v3,v[76:79] offset:1024
v_cvt_pk_bf16_f32 v80,v40,v44
v_cvt_pk_bf16_f32 v81,v41,v45
v_cvt_pk_bf16_f32 v82,v42,v46
v_cvt_pk_bf16_f32 v83,v43,v47
ds_write_b128 v3,v[80:83] offset:2048
s_nop 1
v_cvt_pk_bf16_f32 v84,v48,v52
v_cvt_pk_bf16_f32 v85,v49,v53
v_cvt_pk_bf16_f32 v86,v50,v54
v_cvt_pk_bf16_f32 v87,v51,v55
ds_write_b128 v3,v[84:87] offset:3072
v_readlane_b32 s32,v18,0
v_readlane_b32 s33,v18,1
s_waitcnt lgkmcnt(0)
s_barrier
s_branch L_aa_327
L_ai_370:
v_max3_f32 v238,v128,v129,v130
v_max3_f32 v239,v131,v132,v133
v_max3_f32 v238,v134,v135,v238
v_max3_f32 v239,v138,v139,v239
v_max_f32 v238,v238,v239
v_max_f32 v239,v238,v239
v_pk_mul_f32 v[128:129],v[128:129],v[152:153] op_sel_hi:[1,0]
v_pk_mul_f32 v[130:131],v[130:131],v[152:153] op_sel_hi:[1,0]
v_permlane16_swap_b32 v238,v239
v_max_f32 v238,v238,v239
v_max_f32 v239,v238,v239
v_pk_mul_f32 v[132:133],v[132:133],v[152:153] op_sel_hi:[1,0]
v_pk_mul_f32 v[134:135],v[134:135],v[152:153] op_sel_hi:[1,0]
v_permlane32_swap_b32 v238,v239
v_max_f32 v238,v238,v239
v_mul_f32 v238,v152,v238
v_pk_mul_f32 v[138:139],v[138:139],v[152:153] op_sel_hi:[1,0]
v_pk_add_f32 v[128:129],v[128:129],v[238:239] op_sel_hi:[1,0] neg_lo:[0,1] neg_hi:[0,1]
v_pk_add_f32 v[130:131],v[130:131],v[238:239] op_sel_hi:[1,0] neg_lo:[0,1] neg_hi:[0,1]
v_pk_add_f32 v[132:133],v[132:133],v[238:239] op_sel_hi:[1,0] neg_lo:[0,1] neg_hi:[0,1]
v_pk_add_f32 v[134:135],v[134:135],v[238:239] op_sel_hi:[1,0] neg_lo:[0,1] neg_hi:[0,1]
v_pk_add_f32 v[138:139],v[138:139],v[238:239] op_sel_hi:[1,0] neg_lo:[0,1] neg_hi:[0,1]
v_exp_f32 v128,v128
v_exp_f32 v129,v129
v_exp_f32 v130,v130
v_exp_f32 v131,v131
v_exp_f32 v132,v132
v_exp_f32 v133,v133
v_exp_f32 v134,v134
v_exp_f32 v135,v135
v_exp_f32 v138,v138
v_exp_f32 v139,v139
v_pk_add_f32 v[148:149],v[128:129],v[130:131]
v_pk_add_f32 v[150:151],v[132:133],v[134:135]
v_pk_add_f32 v[148:149],v[148:149],v[138:139]
v_pk_add_f32 v[148:149],v[148:149],v[150:151]
v_add_f32 v150,v148,v149
v_add_f32 v151,v148,v149
s_nop 1
v_permlane16_swap_b32 v150,v151
v_add_f32 v148,v150,v151
v_add_f32 v149,v150,v151
s_nop 1
v_permlane32_swap_b32 v148,v149
v_add_f32 v148,v148,v149
v_rcp_f32 v148,v148
s_nop 0
v_pk_mul_f32 v[138:139],v[138:139],v[148:149] op_sel_hi:[1,0]
v_pk_mul_f32 v[128:129],v[128:129],v[148:149] op_sel_hi:[1,0]
v_pk_mul_f32 v[130:131],v[130:131],v[148:149] op_sel_hi:[1,0]
v_pk_mul_f32 v[132:133],v[132:133],v[148:149] op_sel_hi:[1,0]
v_pk_mul_f32 v[134:135],v[134:135],v[148:149] op_sel_hi:[1,0]
v_cvt_pk_bf16_f32 v144,v138,v139
v_cvt_pk_bf16_f32 v147,v138,v139
s_nop 0
v_mfma_f32_16x16x16_bf16 v[24:27],v[120:121],v[144:145],0
v_cvt_pk_bf16_f32 v140,v128,v129
v_mfma_f32_16x16x16_bf16 v[28:31],v[120:121],v[146:147],0
v_cvt_pk_bf16_f32 v141,v130,v131
v_mfma_f32_16x16x16_bf16 v[32:35],v[122:123],v[144:145],0
v_cvt_pk_bf16_f32 v142,v132,v133
v_mfma_f32_16x16x16_bf16 v[36:39],v[122:123],v[146:147],0
v_cvt_pk_bf16_f32 v143,v134,v135
v_mfma_f32_16x16x16_bf16 v[40:43],v[124:125],v[144:145],0
v_mfma_f32_16x16x16_bf16 v[44:47],v[124:125],v[146:147],0
v_mfma_f32_16x16x16_bf16 v[48:51],v[126:127],v[144:145],0
v_mfma_f32_16x16x16_bf16 v[52:55],v[126:127],v[146:147],0
v_mfma_f32_16x16x32_bf16 v[24:27],v[88:91],v[140:143],v[24:27]
v_mfma_f32_16x16x32_bf16 v[28:31],v[92:95],v[140:143],v[28:31]
v_mfma_f32_16x16x32_bf16 v[32:35],v[96:99],v[140:143],v[32:35]
v_mfma_f32_16x16x32_bf16 v[36:39],v[100:103],v[140:143],v[36:39]
v_cvt_pk_bf16_f32 v72,v24,v28
v_cvt_pk_bf16_f32 v73,v25,v29
v_mfma_f32_16x16x32_bf16 v[40:43],v[104:107],v[140:143],v[40:43]
v_cvt_pk_bf16_f32 v74,v26,v30
v_cvt_pk_bf16_f32 v75,v27,v31
v_mfma_f32_16x16x32_bf16 v[44:47],v[108:111],v[140:143],v[44:47]
ds_write_b128 v3,v[72:75] offset:0
v_cvt_pk_bf16_f32 v76,v32,v36
v_cvt_pk_bf16_f32 v77,v33,v37
v_mfma_f32_16x16x32_bf16 v[48:51],v[112:115],v[140:143],v[48:51]
v_cvt_pk_bf16_f32 v78,v34,v38
v_cvt_pk_bf16_f32 v79,v35,v39
v_mfma_f32_16x16x32_bf16 v[52:55],v[116:119],v[140:143],v[52:55]
ds_write_b128 v3,v[76:79] offset:1024
v_cvt_pk_bf16_f32 v80,v40,v44
v_cvt_pk_bf16_f32 v81,v41,v45
v_cvt_pk_bf16_f32 v82,v42,v46
v_cvt_pk_bf16_f32 v83,v43,v47
ds_write_b128 v3,v[80:83] offset:2048
s_nop 1
v_cvt_pk_bf16_f32 v84,v48,v52
v_cvt_pk_bf16_f32 v85,v49,v53
v_cvt_pk_bf16_f32 v86,v50,v54
v_cvt_pk_bf16_f32 v87,v51,v55
ds_write_b128 v3,v[84:87] offset:3072
s_waitcnt vmcnt(0)
v_readlane_b32 s32,v18,0
v_readlane_b32 s33,v18,1
s_waitcnt lgkmcnt(0)
s_barrier
s_branch L_aa_314
L_aa_323:
s_cmp_lg_u32 s86,1536
s_cbranch_scc1 L_az_373
s_cmp_ge_u32 s35,66
s_cbranch_scc1 L_aa_313
v_subrev_u32 v248,s36,v1
v_and_b32 v248,0x80000003,v248
v_cmp_eq_u32 vcc,0,v248
v_lshlrev_b32 v248,2,v1
v_mov_b32 v249,0x40000000
v_cndmask_b32 v248,v249,v248,vcc
v_mov_b32 v249,3
s_or_b32 s59,s68,s46
s_mov_b32 s59,11018240
s_cmov_b32 s59,0x80000000
buffer_store_dword v249,v248,s[8:11],s59 offen sc1
L_aa_313:
s_waitcnt vmcnt(0)
buffer_store_dword v20,off,s[8:11],s73 sc1
s_mov_b32 s73,0x80000000
v_lshlrev_b32 v238,2,v1
v_add_u32 v248,155712,v238
s_cmp_lg_u32 s46,0
s_cbranch_scc1 L_an_374
s_lshl_b32 s59,s54,13
s_add_u32 s59,s59,11026432
L_fp_375:
s_sleep 1
buffer_load_dword v239,v238,s[8:11],s59 offen sc1
s_sub_u32 s49,s49,1
s_cbranch_scc1 L_abort2
s_waitcnt vmcnt(0)
v_cmp_eq_u32 vcc,0,v239
s_cbranch_vccnz L_fp_375
ds_write_b32 v248,v239
s_waitcnt lgkmcnt(0)
L_an_374:
s_barrier
ds_read_b32 v239,v248
s_mov_b32 s86,768
s_mov_b32 s30,1
s_waitcnt lgkmcnt(0)
v_readfirstlane_b32 s55,v239
v_and_b32 v239,255,v239
s_lshr_b32 s55,s55,8
s_lshr_b32 s61,s55,5
v_cmp_ne_u32 s[38:39],3,v239
v_cmp_le_u32 vcc,s61,v1
s_nop 1
v_cndmask_b32 v238,1,2,vcc
v_cmp_ne_u32 s[84:85],v238,v239
s_bcnt1_i32_b64 s56,s[84:85]
s_nop 0
v_mbcnt_lo_u32_b32 v238,s84,0
v_mbcnt_hi_u32_b32 v238,s85,v238
s_mul_i32 s56,s56,12
s_add_u32 s56,s56,48
s_lshr_b32 s56,s56,7
s_lshl_b32 s56,s56,1
v_cmp_gt_u32 vcc,s56,v238
v_and_b32 v239,1,v238
v_and_b32 v238,3,v238
v_add_u32 v238,2,v238
v_cndmask_b32 v238,v238,v239,vcc
v_cmp_eq_u32 vcc,s54,v238
s_and_b64 s[84:85],s[84:85],vcc
s_ff1_i32_b64 s77,s[84:85]
s_bitset0_b64 s[84:85],s77
s_min_u32 s77,s77,64
s_lshl_b32 s56,s77,5
s_add_u32 s56,s56,s68
s_mul_i32 s70,s56,24576
s_lshl_b32 s71,s56,12
s_lshl_b32 s59,s77,13
s_lshl2_add_u32 s59,s68,s59
s_add_u32 s59,s59,10486144
s_cmp_lt_u32 s77,s61
s_cselect_b32 s57,0,16777216
s_mov_b32 s60,s59
s_buffer_load_dword s33,s[8:11],s60
s_add_u32 s71,s71,s57
s_add_u32 s71,s71,58720256
s_cmp_eq_u32 s77,s61
s_cselect_b32 s57,50331648,0
s_cselect_b32 s58,1536,0
s_add_u32 s59,s59,s58
s_buffer_load_dword s32,s[8:11],s59
s_add_u32 s70,s70,s57
s_add_u32 s70,s70,150994944
v_mov_b32 v19,s59
v_writelane_b32 v19,s60,1
s_cmp_ge_u32 s77,64
s_cbranch_scc1 L_az_373
s_cmp_eq_u32 s77,s61
s_cbranch_scc1 L_aa_321
s_mov_b32 s27,0
s_bitcmp1_b64 s[38:39],s77
s_cbranch_scc1 L_a3_360
s_branch L_aa_321
L_az_373:
s_waitcnt vmcnt(0)
buffer_store_dword v20,off,s[8:11],s73 sc1
s_mov_b32 s73,0x80000000
s_endpgm
L_ag_329:
s_lshl_b32 s21,s26,13
s_lshl2_add_u32 s21,s68,s21
s_add_u32 s21,s21,10487296
L_ww_376:
buffer_load_dword v246,off,s[8:11],s21 sc1
s_sub_u32 s49,s49,1
s_cbranch_scc1 L_abort2
s_waitcnt vmcnt(0)
v_readfirstlane_b32 s22,v246
s_cmp_eq_u32 s22,0
s_cbranch_scc1 L_ww_376
L_wwd_377:
s_branch L_agb_330
L_a4_338:
v_mov_b32 v248,s27
ds_write_b32 v247,v248 offset:16
s_waitcnt lgkmcnt(0)
s_barrier
ds_read_b128 v[248:251],v245 offset:16
s_waitcnt lgkmcnt(0)
v_or3_b32 v248,v248,v249,v250
v_or_b32 v248,v248,v251
v_cmp_ne_u32 vcc,0,v248
s_cbranch_vccz L_a4_339
L_aq_378:
buffer_load_dword v17,v16,s[8:11],s87 offen sc1
s_sub_u32 s49,s49,1
s_cbranch_scc1 L_abort2
s_waitcnt vmcnt(0)
v_cmp_gt_u32 vcc,s66,v17
s_cbranch_vccnz L_aq_378
s_xor_b32 s34,s69,524288
buffer_load_dwordx4 v[160:163],v7,s[8:11],s34 offen sc1
s_add_u32 s34,s34,4096
buffer_load_dwordx4 v[164:167],v7,s[8:11],s34 offen sc1
s_add_u32 s34,s34,4096
buffer_load_dwordx4 v[168:171],v7,s[8:11],s34 offen sc1
s_add_u32 s34,s34,4096
buffer_load_dwordx4 v[172:175],v7,s[8:11],s34 offen sc1
s_add_u32 s34,s34,4096
buffer_load_dwordx4 v[176:179],v7,s[8:11],s34 offen sc1
s_add_u32 s34,s34,4096
buffer_load_dwordx4 v[180:183],v7,s[8:11],s34 offen sc1
s_add_u32 s34,s34,4096
buffer_load_dwordx4 v[184:187],v7,s[8:11],s34 offen sc1
s_add_u32 s34,s34,4096
buffer_load_dwordx4 v[188:191],v7,s[8:11],s34 offen sc1
s_waitcnt vmcnt(7)
v_mfma_f32_16x16x32_bf16 v[192:195],v[156:159],v[160:163],0
s_waitcnt vmcnt(6)
v_mfma_f32_16x16x32_bf16 v[192:195],v[156:159],v[164:167],v[192:195]
s_waitcnt vmcnt(5)
v_mfma_f32_16x16x32_bf16 v[192:195],v[156:159],v[168:171],v[192:195]
s_waitcnt vmcnt(4)
v_mfma_f32_16x16x32_bf16 v[192:195],v[156:159],v[172:175],v[192:195]
s_waitcnt vmcnt(3)
v_mfma_f32_16x16x32_bf16 v[196:199],v[156:159],v[176:179],0
s_waitcnt vmcnt(2)
v_mfma_f32_16x16x32_bf16 v[196:199],v[156:159],v[180:183],v[196:199]
s_waitcnt vmcnt(1)
v_mfma_f32_16x16x32_bf16 v[196:199],v[156:159],v[184:187],v[196:199]
ds_write_b128 v6,v[192:195]
s_waitcnt vmcnt(0)
v_mfma_f32_16x16x32_bf16 v[196:199],v[156:159],v[188:191],v[196:199]
s_nop 7
ds_write_b128 v6,v[196:199] offset:2048
s_waitcnt lgkmcnt(0)
s_barrier
buffer_store_dword v20,off,s[8:11],s73 sc1
s_mov_b32 s73,0x80000000
s_mov_b32 s27,4
s_branch L_aa_318
L_ac_341:
buffer_store_dword v20,off,s[8:11],s73 sc1
s_mov_b32 s73,0x80000000
buffer_load_dwordx4 v[72:75],v0,s[8:11],s76 offen offset:0 sc1
buffer_load_dwordx4 v[76:79],v0,s[8:11],s76 offen offset:1024 sc1
buffer_load_dwordx4 v[80:83],v0,s[8:11],s76 offen offset:2048 sc1
buffer_load_dwordx4 v[84:87],v0,s[8:11],s76 offen offset:3072 sc1
buffer_load_dwordx2 v[120:121],v253,s[8:11],s76 offen offset:0 sc1
buffer_load_dwordx2 v[122:123],v253,s[8:11],s76 offen offset:1024 sc1
buffer_load_dwordx2 v[124:125],v253,s[8:11],s76 offen offset:2048 sc1
buffer_load_dwordx2 v[126:127],v253,s[8:11],s76 offen offset:3072 sc1
s_sub_u32 s49,s49,1
s_cbranch_scc1 L_abort2
s_waitcnt vmcnt(7)
v_mfma_f32_16x16x32_bf16 v[136:139],v[72:75],v[24:27],0
v_max3_u32 v238,v72,v73,v74
v_max3_u32 v238,v74,v75,v238
s_waitcnt vmcnt(6)
v_mfma_f32_16x16x32_bf16 v[136:139],v[76:79],v[28:31],v[136:139]
v_max3_u32 v238,v76,v77,v238
v_max3_u32 v238,v78,v79,v238
s_waitcnt vmcnt(5)
v_mfma_f32_16x16x32_bf16 v[136:139],v[80:83],v[32:35],v[136:139]
v_max3_u32 v238,v80,v81,v238
v_max3_u32 v238,v82,v83,v238
s_waitcnt vmcnt(4)
v_mfma_f32_16x16x32_bf16 v[136:139],v[84:87],v[36:39],v[136:139]
v_max3_u32 v238,v84,v85,v238
v_max3_u32 v238,v86,v87,v238
s_waitcnt vmcnt(0)
v_max3_u32 v238,v120,v121,v238
v_max3_u32 v238,v122,v123,v238
v_max3_u32 v238,v124,v125,v238
v_max3_u32 v238,v126,v127,v238
v_cmp_eq_u32 vcc,-1,v238
s_cbranch_vccnz L_ac_341
s_branch L_acb_342
L_ap_344:
L_aw_379:
v_cmp_gt_u32 vcc,s66,v17
s_cbranch_vccz L_awd_380
buffer_load_dword v17,v16,s[8:11],s87 offen sc1
s_sub_u32 s49,s49,1
s_cbranch_scc1 L_abort2
s_waitcnt vmcnt(0)
s_branch L_aw_379
L_awd_380:
s_branch L_apb_345
L_a1_346:
v_subrev_u32 v248,s36,v1
v_and_b32 v248,0x80000003,v248
v_cmp_eq_u32 vcc,0,v248
v_lshlrev_b32 v248,2,v1
v_mov_b32 v249,0x40000000
v_cndmask_b32 v248,v249,v248,vcc
v_mov_b32 v249,3
s_or_b32 s59,s68,s46
s_mov_b32 s59,11018240
s_cmov_b32 s59,0x80000000
buffer_store_dword v249,v248,s[8:11],s59 offen sc1
s_branch L_a2_347
L_ag_355:
s_lshl_b32 s21,s51,13
s_lshl2_add_u32 s21,s68,s21
s_add_u32 s21,s21,10487296
L_ww_381:
buffer_load_dword v246,off,s[8:11],s21 sc1
s_sub_u32 s49,s49,1
s_cbranch_scc1 L_abort2
s_waitcnt vmcnt(0)
v_readfirstlane_b32 s22,v246
s_cmp_eq_u32 s22,0
s_cbranch_scc1 L_ww_381
L_wwd_382:
s_branch L_agb_356
L_ac_363:
buffer_store_dword v20,off,s[8:11],s73 sc1
s_mov_b32 s73,0x80000000
buffer_load_dwordx4 v[72:75],v0,s[8:11],s76 offen offset:0 sc1
buffer_load_dwordx4 v[76:79],v0,s[8:11],s76 offen offset:1024 sc1
buffer_load_dwordx4 v[80:83],v0,s[8:11],s76 offen offset:2048 sc1
buffer_load_dwordx4 v[84:87],v0,s[8:11],s76 offen offset:3072 sc1
buffer_load_dwordx2 v[120:121],v253,s[8:11],s76 offen offset:0 sc1
buffer_load_dwordx2 v[122:123],v253,s[8:11],s76 offen offset:1024 sc1
buffer_load_dwordx2 v[124:125],v253,s[8:11],s76 offen offset:2048 sc1
buffer_load_dwordx2 v[126:127],v253,s[8:11],s76 offen offset:3072 sc1
s_sub_u32 s49,s49,1
s_cbranch_scc1 L_abort2
s_waitcnt vmcnt(7)
v_mfma_f32_16x16x32_bf16 v[136:139],v[72:75],v[24:27],0
v_max3_u32 v238,v72,v73,v74
v_max3_u32 v238,v74,v75,v238
s_waitcnt vmcnt(6)
v_mfma_f32_16x16x32_bf16 v[136:139],v[76:79],v[28:31],v[136:139]
v_max3_u32 v238,v76,v77,v238
v_max3_u32 v238,v78,v79,v238
s_waitcnt vmcnt(5)
v_mfma_f32_16x16x32_bf16 v[136:139],v[80:83],v[32:35],v[136:139]
v_max3_u32 v238,v80,v81,v238
v_max3_u32 v238,v82,v83,v238
s_waitcnt vmcnt(4)
v_mfma_f32_16x16x32_bf16 v[136:139],v[84:87],v[36:39],v[136:139]
v_max3_u32 v238,v84,v85,v238
v_max3_u32 v238,v86,v87,v238
s_waitcnt vmcnt(0)
v_max3_u32 v238,v120,v121,v238
v_max3_u32 v238,v122,v123,v238
v_max3_u32 v238,v124,v125,v238
v_max3_u32 v238,v126,v127,v238
v_cmp_eq_u32 vcc,-1,v238
s_cbranch_vccnz L_ac_363
s_branch L_acb_364
L_am_367:
v_subrev_u32 v248,s36,v1
v_and_b32 v248,0x80000003,v248
v_cmp_eq_u32 vcc,0,v248
v_lshlrev_b32 v248,2,v1
v_mov_b32 v249,0x40000000
v_cndmask_b32 v248,v249,v248,vcc
v_mov_b32 v249,3
s_or_b32 s59,s68,s46
s_mov_b32 s59,11018240
s_cmov_b32 s59,0x80000000
buffer_store_dword v249,v248,s[8:11],s59 offen sc1
s_branch L_ab_365
L_ap_371:
L_aw_383:
v_cmp_gt_u32 vcc,s66,v17
s_cbranch_vccz L_awd_384
buffer_load_dword v17,v16,s[8:11],s87 offen sc1
s_sub_u32 s49,s49,1
s_cbranch_scc1 L_abort2
s_waitcnt vmcnt(0)
s_branch L_aw_383
L_awd_384:
s_branch L_apb_372
s_endpgm
L_wm:
s_nop 11
v_and_b32 v120,15,v1
v_lshrrev_b32 v121,4,v1
v_mov_b32 v17,1
s_lshl_b32 s56,s46,15
v_add_u32 v18,s56,v0
s_lshl_b32 s56,s46,2
v_add_u32 v125,s56,v121
v_xor_b32 v126,v125,v120
v_lshlrev_b32 v126,4,v126
v_lshl_add_u32 v20,v125,10,v126
v_add_u32 v125,0,v121
v_xor_b32 v125,v125,v120
v_lshlrev_b32 v125,4,v125
v_lshl_add_u32 v125,v120,8,v125
v_add_u32 v4,131072,v125
v_add_u32 v125,4,v121
v_xor_b32 v125,v125,v120
v_lshlrev_b32 v125,4,v125
v_lshl_add_u32 v125,v120,8,v125
v_add_u32 v5,131072,v125
v_add_u32 v125,8,v121
v_xor_b32 v125,v125,v120
v_lshlrev_b32 v125,4,v125
v_lshl_add_u32 v125,v120,8,v125
v_add_u32 v6,131072,v125
v_add_u32 v125,12,v121
v_xor_b32 v125,v125,v120
v_lshlrev_b32 v125,4,v125
v_lshl_add_u32 v125,v120,8,v125
v_add_u32 v7,131072,v125
v_lshlrev_b32 v21,5,v120
v_and_b32 v125,1,v121
v_lshl_add_u32 v21,v125,4,v21
s_lshl_b32 s56,s46,9
v_lshrrev_b32 v125,1,v121
v_lshl_add_u32 v21,v125,11,v21
s_add_u32 s56,s56,155648
v_add_u32 v21,s56,v21
v_lshlrev_b32 v22,4,v120
v_lshl_add_u32 v22,v121,10,v22
s_lshl_b32 s56,s46,8
v_add_u32 v22,s56,v22
s_mov_b32 s54,0
s_mov_b32 s31,0
s_mov_b32 s53,6
s_mov_b32 s72,0x80000000
s_mov_b32 s73,0
s_mov_b32 s77,-1
s_mov_b32 s86,0
s_mov_b32 s19,0
s_mov_b32 s74,2948595712
s_mov_b32 s75,2863311530
v_and_b32 v23,15,v1
v_lshlrev_b32 v23,3,v23
v_lshrrev_b32 v16,4,v1
v_lshl_add_u32 v23,v16,13,v23
v_mov_b32 v19,159744
v_lshl_add_u32 v16,v16,2,v19
v_and_b32 v9,15,v1
v_lshrrev_b32 v10,4,v1
v_and_b32 v124,1,v1
v_lshlrev_b32 v124,4,v124
v_mov_b32 v125,0xffff
v_lshlrev_b32 v125,v124,v125
v_lshrrev_b32 v124,2,v9
v_cmp_eq_u32 vcc,0,v124
s_nop 1
v_cndmask_b32 v12,0,v125,vcc
v_cmp_eq_u32 vcc,1,v124
s_nop 1
v_cndmask_b32 v13,0,v125,vcc
v_and_b32 v124,2,v1
v_cmp_eq_u32 vcc,0,v124
v_mov_b32 v14,0xeeee
v_mov_b32 v124,0x4444
v_cndmask_b32 v14,v14,v124,vcc
v_lshlrev_b32 v11,14,v10
v_lshl_add_u32 v11,v9,4,v11
s_lshl_b32 s65,s51,15
s_add_u32 s65,s65,92274688
s_lshl_b32 s62,s47,10
s_add_u32 s62,s62,s65
s_lshl_b32 s63,s47,16
s_lshl_b32 s60,s46,8
s_add_u32 s63,s63,s60
s_mov_b32 s4,s38
s_mov_b32 s5,s39
s_mov_b32 s6,1835008
s_mov_b32 s7,0x20000
buffer_load_dwordx4 v[24:27],v11,s[4:7],s63 offen offset:0
buffer_load_dwordx4 v[28:31],v11,s[4:7],s63 offen offset:1024
buffer_load_dwordx4 v[32:35],v11,s[4:7],s63 offen offset:2048
buffer_load_dwordx4 v[36:39],v11,s[4:7],s63 offen offset:3072
s_add_u32 s63,s63,4096
buffer_load_dwordx4 v[40:43],v11,s[4:7],s63 offen offset:0
buffer_load_dwordx4 v[44:47],v11,s[4:7],s63 offen offset:1024
buffer_load_dwordx4 v[48:51],v11,s[4:7],s63 offen offset:2048
buffer_load_dwordx4 v[52:55],v11,s[4:7],s63 offen offset:3072
s_add_u32 s63,s63,4096
buffer_load_dwordx4 v[56:59],v11,s[4:7],s63 offen offset:0
buffer_load_dwordx4 v[60:63],v11,s[4:7],s63 offen offset:1024
buffer_load_dwordx4 v[64:67],v11,s[4:7],s63 offen offset:2048
buffer_load_dwordx4 v[68:71],v11,s[4:7],s63 offen offset:3072
s_add_u32 s63,s63,4096
buffer_load_dwordx4 v[72:75],v11,s[4:7],s63 offen offset:0
buffer_load_dwordx4 v[76:79],v11,s[4:7],s63 offen offset:1024
buffer_load_dwordx4 v[80:83],v11,s[4:7],s63 offen offset:2048
buffer_load_dwordx4 v[84:87],v11,s[4:7],s63 offen offset:3072
s_mov_b32 s4,s32
s_mov_b32 s5,s33
s_mov_b32 s6,1024
s_mov_b32 s7,0x20000
buffer_load_dwordx4 v[88:91],v0,s[4:7],0 offen
s_waitcnt vmcnt(0)
v_lshlrev_b32 v96,16,v88
v_and_b32 v97,0xffff0000,v88
v_lshlrev_b32 v98,16,v89
v_and_b32 v99,0xffff0000,v89
v_lshlrev_b32 v100,16,v90
v_and_b32 v101,0xffff0000,v90
v_lshlrev_b32 v102,16,v91
v_and_b32 v103,0xffff0000,v91
v_mul_f32 v88,v96,v96
v_fma_f32 v88,v97,v97,v88
v_fma_f32 v88,v98,v98,v88
v_fma_f32 v88,v99,v99,v88
v_fma_f32 v88,v100,v100,v88
v_fma_f32 v88,v101,v101,v88
v_fma_f32 v88,v102,v102,v88
v_fma_f32 v88,v103,v103,v88
s_nop 1
v_add_f32_dpp v88,v88,v88 row_ror:8 row_mask:0xf bank_mask:0xf
s_nop 1
v_add_f32_dpp v88,v88,v88 row_ror:4 row_mask:0xf bank_mask:0xf
s_nop 1
v_add_f32_dpp v88,v88,v88 row_ror:2 row_mask:0xf bank_mask:0xf
s_nop 1
v_add_f32_dpp v88,v88,v88 row_ror:1 row_mask:0xf bank_mask:0xf
v_mov_b32 v89,v88
s_nop 1
v_permlane16_swap_b32 v88,v89
v_add_f32 v88,v88,v89
v_mov_b32 v89,v88
s_nop 1
v_permlane32_swap_b32 v88,v89
v_add_f32 v88,v88,v89
v_sqrt_f32 v88,v88
s_nop 0
v_mul_f32 v88,0x40333333,v88
s_nop 0
v_readfirstlane_b32 s25,v88
s_bitset1_b32 s25,31
s_ff1_i32_b64 s30,s[74:75]
s_bitset0_b64 s[74:75],s30
s_min_u32 s30,s30,127
s_lshl_b32 s70,s30,15
s_add_u32 s70,s70,0
s_add_u32 s71,s70,16384
L_mo_389:
s_cmp_lg_u32 s19,0
s_cbranch_scc1 L_mo_390
s_add_u32 m0,s50,131072
s_nop 0
buffer_load_dwordx4 v20,s[8:11],s70 offen offset:0 sc1 lds
s_add_u32 m0,s50,135168
s_nop 0
buffer_load_dwordx4 v20,s[8:11],s71 offen offset:0 sc1 lds
s_add_u32 m0,s50,139008
s_nop 0
buffer_load_dwordx4 v20,s[8:11],s70 offen offset:256 sc1 lds
s_add_u32 m0,s50,143104
s_nop 0
buffer_load_dwordx4 v20,s[8:11],s71 offen offset:256 sc1 lds
s_add_u32 m0,s50,146944
s_nop 0
buffer_load_dwordx4 v20,s[8:11],s70 offen offset:512 sc1 lds
s_add_u32 m0,s50,151040
s_nop 0
buffer_load_dwordx4 v20,s[8:11],s71 offen offset:512 sc1 lds
s_mov_b32 s19,1
s_waitcnt vmcnt(0)
L_mo_390:
s_mov_b32 s51,s30
s_mov_b64 s[68:69],s[70:71]
s_ff1_i32_b64 s30,s[74:75]
s_bitset0_b64 s[74:75],s30
s_min_u32 s30,s30,127
s_lshl_b32 s70,s30,15
s_add_u32 s70,s70,0
s_add_u32 s71,s70,16384
s_lshl_b32 s76,s31,13
s_add_u32 s76,s76,10487040
s_lshl_b32 s58,s51,5
s_add_u32 s58,s58,s47
s_mul_i32 s58,s58,24576
s_add_u32 s58,s58,100663296
s_add_u32 s61,s58,s50
s_add_u32 s62,s61,4096
s_add_u32 s63,s61,16384
s_add_u32 s64,s61,20480
s_add_u32 s65,s61,s50
s_add_u32 s65,s65,8192
s_waitcnt vmcnt(12)
s_barrier
ds_read_b128 v[72:75],v4 offset:0
ds_read_b128 v[76:79],v4 offset:4096
ds_read_b128 v[80:83],v5 offset:0
ds_read_b128 v[84:87],v5 offset:4096
s_add_u32 m0,s50,154880
s_nop 0
buffer_load_dwordx4 v20,s[8:11],s68 offen offset:768 sc1 lds
s_add_u32 m0,s50,158976
s_nop 0
buffer_load_dwordx4 v20,s[8:11],s69 offen offset:768 sc1 lds
s_waitcnt lgkmcnt(2)
v_mfma_f32_16x16x32_bf16 v[40:43],a[128:131],v[72:75],0
ds_read_b128 v[108:111],v6 offset:0
v_mfma_f32_16x16x32_bf16 v[56:59],v[72:75],v[128:131],0
v_mfma_f32_16x16x32_bf16 v[24:27],a[0:3],v[72:75],0
ds_read_b128 v[112:115],v6 offset:4096
v_mfma_f32_16x16x32_bf16 v[44:47],a[128:131],v[76:79],0
v_mfma_f32_16x16x32_bf16 v[60:63],v[76:79],v[128:131],0
v_mfma_f32_16x16x32_bf16 v[28:31],a[0:3],v[76:79],0
v_mfma_f32_16x16x32_bf16 v[48:51],a[136:139],v[72:75],0
v_mfma_f32_16x16x32_bf16 v[64:67],v[72:75],v[136:139],0
v_mfma_f32_16x16x32_bf16 v[32:35],a[8:11],v[72:75],0
v_mfma_f32_16x16x32_bf16 v[52:55],a[136:139],v[76:79],0
v_mfma_f32_16x16x32_bf16 v[68:71],v[76:79],v[136:139],0
v_mfma_f32_16x16x32_bf16 v[36:39],a[8:11],v[76:79],0
s_waitcnt lgkmcnt(2)
v_mfma_f32_16x16x32_bf16 v[40:43],a[132:135],v[80:83],v[40:43]
ds_read_b128 v[72:75],v7 offset:0
v_mfma_f32_16x16x32_bf16 v[56:59],v[80:83],v[132:135],v[56:59]
v_mfma_f32_16x16x32_bf16 v[24:27],a[4:7],v[80:83],v[24:27]
ds_read_b128 v[76:79],v7 offset:4096
v_mfma_f32_16x16x32_bf16 v[44:47],a[132:135],v[84:87],v[44:47]
v_mfma_f32_16x16x32_bf16 v[60:63],v[84:87],v[132:135],v[60:63]
v_mfma_f32_16x16x32_bf16 v[28:31],a[4:7],v[84:87],v[28:31]
v_mfma_f32_16x16x32_bf16 v[48:51],a[140:143],v[80:83],v[48:51]
v_mfma_f32_16x16x32_bf16 v[64:67],v[80:83],v[140:143],v[64:67]
v_mfma_f32_16x16x32_bf16 v[32:35],a[12:15],v[80:83],v[32:35]
v_mfma_f32_16x16x32_bf16 v[52:55],a[140:143],v[84:87],v[52:55]
v_mfma_f32_16x16x32_bf16 v[68:71],v[84:87],v[140:143],v[68:71]
v_mfma_f32_16x16x32_bf16 v[36:39],a[12:15],v[84:87],v[36:39]
s_waitcnt vmcnt(12)
s_barrier
s_waitcnt lgkmcnt(2)
v_mfma_f32_16x16x32_bf16 v[40:43],a[144:147],v[108:111],v[40:43]
ds_read_b128 v[80:83],v4 offset:8192
v_mfma_f32_16x16x32_bf16 v[56:59],v[108:111],v[144:147],v[56:59]
v_mfma_f32_16x16x32_bf16 v[24:27],a[16:19],v[108:111],v[24:27]
ds_read_b128 v[84:87],v4 offset:12288
v_mfma_f32_16x16x32_bf16 v[44:47],a[144:147],v[112:115],v[44:47]
v_mfma_f32_16x16x32_bf16 v[60:63],v[112:115],v[144:147],v[60:63]
v_mfma_f32_16x16x32_bf16 v[28:31],a[16:19],v[112:115],v[28:31]
v_mfma_f32_16x16x32_bf16 v[48:51],a[152:155],v[108:111],v[48:51]
v_mfma_f32_16x16x32_bf16 v[64:67],v[108:111],v[152:155],v[64:67]
v_mfma_f32_16x16x32_bf16 v[32:35],a[24:27],v[108:111],v[32:35]
v_mfma_f32_16x16x32_bf16 v[52:55],a[152:155],v[112:115],v[52:55]
v_mfma_f32_16x16x32_bf16 v[68:71],v[112:115],v[152:155],v[68:71]
v_mfma_f32_16x16x32_bf16 v[36:39],a[24:27],v[112:115],v[36:39]
s_waitcnt lgkmcnt(2)
v_mfma_f32_16x16x32_bf16 v[40:43],a[148:151],v[72:75],v[40:43]
ds_read_b128 v[108:111],v5 offset:8192
v_mfma_f32_16x16x32_bf16 v[56:59],v[72:75],v[148:151],v[56:59]
v_mfma_f32_16x16x32_bf16 v[24:27],a[20:23],v[72:75],v[24:27]
ds_read_b128 v[112:115],v5 offset:12288
v_mfma_f32_16x16x32_bf16 v[44:47],a[148:151],v[76:79],v[44:47]
v_mfma_f32_16x16x32_bf16 v[60:63],v[76:79],v[148:151],v[60:63]
v_mfma_f32_16x16x32_bf16 v[28:31],a[20:23],v[76:79],v[28:31]
v_mfma_f32_16x16x32_bf16 v[48:51],a[156:159],v[72:75],v[48:51]
v_mfma_f32_16x16x32_bf16 v[64:67],v[72:75],v[156:159],v[64:67]
v_mfma_f32_16x16x32_bf16 v[32:35],a[28:31],v[72:75],v[32:35]
v_mfma_f32_16x16x32_bf16 v[52:55],a[156:159],v[76:79],v[52:55]
v_mfma_f32_16x16x32_bf16 v[68:71],v[76:79],v[156:159],v[68:71]
v_mfma_f32_16x16x32_bf16 v[36:39],a[28:31],v[76:79],v[36:39]
s_waitcnt lgkmcnt(2)
v_mfma_f32_16x16x32_bf16 v[40:43],a[160:163],v[80:83],v[40:43]
ds_read_b128 v[72:75],v6 offset:8192
v_mfma_f32_16x16x32_bf16 v[56:59],v[80:83],v[160:163],v[56:59]
v_mfma_f32_16x16x32_bf16 v[24:27],a[32:35],v[80:83],v[24:27]
ds_read_b128 v[76:79],v6 offset:12288
v_mfma_f32_16x16x32_bf16 v[44:47],a[160:163],v[84:87],v[44:47]
v_mfma_f32_16x16x32_bf16 v[60:63],v[84:87],v[160:163],v[60:63]
v_mfma_f32_16x16x32_bf16 v[28:31],a[32:35],v[84:87],v[28:31]
v_mfma_f32_16x16x32_bf16 v[48:51],a[168:171],v[80:83],v[48:51]
v_mfma_f32_16x16x32_bf16 v[64:67],v[80:83],v[168:171],v[64:67]
v_mfma_f32_16x16x32_bf16 v[32:35],a[40:43],v[80:83],v[32:35]
v_mfma_f32_16x16x32_bf16 v[52:55],a[168:171],v[84:87],v[52:55]
v_mfma_f32_16x16x32_bf16 v[68:71],v[84:87],v[168:171],v[68:71]
v_mfma_f32_16x16x32_bf16 v[36:39],a[40:43],v[84:87],v[36:39]
s_waitcnt lgkmcnt(2)
v_mfma_f32_16x16x32_bf16 v[40:43],a[164:167],v[108:111],v[40:43]
ds_read_b128 v[80:83],v7 offset:8192
v_mfma_f32_16x16x32_bf16 v[56:59],v[108:111],v[164:167],v[56:59]
v_mfma_f32_16x16x32_bf16 v[24:27],a[36:39],v[108:111],v[24:27]
ds_read_b128 v[84:87],v7 offset:12288
v_mfma_f32_16x16x32_bf16 v[44:47],a[164:167],v[112:115],v[44:47]
v_mfma_f32_16x16x32_bf16 v[60:63],v[112:115],v[164:167],v[60:63]
v_mfma_f32_16x16x32_bf16 v[28:31],a[36:39],v[112:115],v[28:31]
v_mfma_f32_16x16x32_bf16 v[48:51],a[172:175],v[108:111],v[48:51]
v_mfma_f32_16x16x32_bf16 v[64:67],v[108:111],v[172:175],v[64:67]
v_mfma_f32_16x16x32_bf16 v[32:35],a[44:47],v[108:111],v[32:35]
v_mfma_f32_16x16x32_bf16 v[52:55],a[172:175],v[112:115],v[52:55]
v_mfma_f32_16x16x32_bf16 v[68:71],v[112:115],v[172:175],v[68:71]
v_mfma_f32_16x16x32_bf16 v[36:39],a[44:47],v[112:115],v[36:39]
s_waitcnt vmcnt(10)
s_barrier
s_waitcnt lgkmcnt(2)
v_mfma_f32_16x16x32_bf16 v[40:43],a[176:179],v[72:75],v[40:43]
ds_read_b128 v[108:111],v4 offset:16384
v_mfma_f32_16x16x32_bf16 v[56:59],v[72:75],v[176:179],v[56:59]
v_mfma_f32_16x16x32_bf16 v[24:27],a[48:51],v[72:75],v[24:27]
ds_read_b128 v[112:115],v4 offset:20480
v_mfma_f32_16x16x32_bf16 v[44:47],a[176:179],v[76:79],v[44:47]
v_mfma_f32_16x16x32_bf16 v[60:63],v[76:79],v[176:179],v[60:63]
v_mfma_f32_16x16x32_bf16 v[28:31],a[48:51],v[76:79],v[28:31]
v_mfma_f32_16x16x32_bf16 v[48:51],a[184:187],v[72:75],v[48:51]
v_mfma_f32_16x16x32_bf16 v[64:67],v[72:75],v[184:187],v[64:67]
v_mfma_f32_16x16x32_bf16 v[32:35],a[56:59],v[72:75],v[32:35]
v_mfma_f32_16x16x32_bf16 v[52:55],a[184:187],v[76:79],v[52:55]
v_mfma_f32_16x16x32_bf16 v[68:71],v[76:79],v[184:187],v[68:71]
v_mfma_f32_16x16x32_bf16 v[36:39],a[56:59],v[76:79],v[36:39]
s_waitcnt vmcnt(2)
s_barrier
s_or_b32 s72,s72,s52
buffer_store_dword v17,off,s[8:11],s72 sc1
s_waitcnt lgkmcnt(2)
v_mfma_f32_16x16x32_bf16 v[40:43],a[180:183],v[80:83],v[40:43]
ds_read_b128 v[72:75],v5 offset:16384
v_mfma_f32_16x16x32_bf16 v[56:59],v[80:83],v[180:183],v[56:59]
v_mfma_f32_16x16x32_bf16 v[24:27],a[52:55],v[80:83],v[24:27]
ds_read_b128 v[76:79],v5 offset:20480
v_mfma_f32_16x16x32_bf16 v[44:47],a[180:183],v[84:87],v[44:47]
v_mfma_f32_16x16x32_bf16 v[60:63],v[84:87],v[180:183],v[60:63]
v_mfma_f32_16x16x32_bf16 v[28:31],a[52:55],v[84:87],v[28:31]
v_mfma_f32_16x16x32_bf16 v[48:51],a[188:191],v[80:83],v[48:51]
v_mfma_f32_16x16x32_bf16 v[64:67],v[80:83],v[188:191],v[64:67]
v_mfma_f32_16x16x32_bf16 v[32:35],a[60:63],v[80:83],v[32:35]
v_mfma_f32_16x16x32_bf16 v[52:55],a[188:191],v[84:87],v[52:55]
v_mfma_f32_16x16x32_bf16 v[68:71],v[84:87],v[188:191],v[68:71]
v_mfma_f32_16x16x32_bf16 v[36:39],a[60:63],v[84:87],v[36:39]
s_waitcnt lgkmcnt(2)
v_mfma_f32_16x16x32_bf16 v[40:43],a[192:195],v[108:111],v[40:43]
ds_read_b128 v[80:83],v6 offset:16384
v_mfma_f32_16x16x32_bf16 v[56:59],v[108:111],v[192:195],v[56:59]
v_mfma_f32_16x16x32_bf16 v[24:27],a[64:67],v[108:111],v[24:27]
ds_read_b128 v[84:87],v6 offset:20480
v_mfma_f32_16x16x32_bf16 v[44:47],a[192:195],v[112:115],v[44:47]
v_mfma_f32_16x16x32_bf16 v[60:63],v[112:115],v[192:195],v[60:63]
v_mfma_f32_16x16x32_bf16 v[28:31],a[64:67],v[112:115],v[28:31]
v_mfma_f32_16x16x32_bf16 v[48:51],a[200:203],v[108:111],v[48:51]
v_mfma_f32_16x16x32_bf16 v[64:67],v[108:111],v[200:203],v[64:67]
v_mfma_f32_16x16x32_bf16 v[32:35],a[72:75],v[108:111],v[32:35]
v_mfma_f32_16x16x32_bf16 v[52:55],a[200:203],v[112:115],v[52:55]
v_mfma_f32_16x16x32_bf16 v[68:71],v[112:115],v[200:203],v[68:71]
v_mfma_f32_16x16x32_bf16 v[36:39],a[72:75],v[112:115],v[36:39]
s_waitcnt lgkmcnt(2)
v_mfma_f32_16x16x32_bf16 v[40:43],a[196:199],v[72:75],v[40:43]
ds_read_b128 v[108:111],v7 offset:16384
v_mfma_f32_16x16x32_bf16 v[56:59],v[72:75],v[196:199],v[56:59]
v_mfma_f32_16x16x32_bf16 v[24:27],a[68:71],v[72:75],v[24:27]
ds_read_b128 v[112:115],v7 offset:20480
v_mfma_f32_16x16x32_bf16 v[44:47],a[196:199],v[76:79],v[44:47]
v_mfma_f32_16x16x32_bf16 v[60:63],v[76:79],v[196:199],v[60:63]
v_mfma_f32_16x16x32_bf16 v[28:31],a[68:71],v[76:79],v[28:31]
v_mfma_f32_16x16x32_bf16 v[48:51],a[204:207],v[72:75],v[48:51]
v_mfma_f32_16x16x32_bf16 v[64:67],v[72:75],v[204:207],v[64:67]
v_mfma_f32_16x16x32_bf16 v[32:35],a[76:79],v[72:75],v[32:35]
v_mfma_f32_16x16x32_bf16 v[52:55],a[204:207],v[76:79],v[52:55]
v_mfma_f32_16x16x32_bf16 v[68:71],v[76:79],v[204:207],v[68:71]
v_mfma_f32_16x16x32_bf16 v[36:39],a[76:79],v[76:79],v[36:39]
s_waitcnt vmcnt(1)
s_barrier
s_waitcnt lgkmcnt(2)
v_mfma_f32_16x16x32_bf16 v[40:43],a[208:211],v[80:83],v[40:43]
ds_read_b128 v[72:75],v4 offset:24576
v_mfma_f32_16x16x32_bf16 v[56:59],v[80:83],v[208:211],v[56:59]
v_mfma_f32_16x16x32_bf16 v[24:27],a[80:83],v[80:83],v[24:27]
ds_read_b128 v[76:79],v4 offset:28672
v_mfma_f32_16x16x32_bf16 v[44:47],a[208:211],v[84:87],v[44:47]
v_mfma_f32_16x16x32_bf16 v[60:63],v[84:87],v[208:211],v[60:63]
v_mfma_f32_16x16x32_bf16 v[28:31],a[80:83],v[84:87],v[28:31]
v_mfma_f32_16x16x32_bf16 v[48:51],a[216:219],v[80:83],v[48:51]
v_mfma_f32_16x16x32_bf16 v[64:67],v[80:83],v[216:219],v[64:67]
v_mfma_f32_16x16x32_bf16 v[32:35],a[88:91],v[80:83],v[32:35]
v_mfma_f32_16x16x32_bf16 v[52:55],a[216:219],v[84:87],v[52:55]
v_mfma_f32_16x16x32_bf16 v[68:71],v[84:87],v[216:219],v[68:71]
v_mfma_f32_16x16x32_bf16 v[36:39],a[88:91],v[84:87],v[36:39]
s_waitcnt lgkmcnt(2)
v_mfma_f32_16x16x32_bf16 v[40:43],a[212:215],v[108:111],v[40:43]
ds_read_b128 v[80:83],v5 offset:24576
v_mfma_f32_16x16x32_bf16 v[56:59],v[108:111],v[212:215],v[56:59]
v_mfma_f32_16x16x32_bf16 v[24:27],a[84:87],v[108:111],v[24:27]
ds_read_b128 v[84:87],v5 offset:28672
v_mfma_f32_16x16x32_bf16 v[44:47],a[212:215],v[112:115],v[44:47]
v_mfma_f32_16x16x32_bf16 v[60:63],v[112:115],v[212:215],v[60:63]
v_mfma_f32_16x16x32_bf16 v[28:31],a[84:87],v[112:115],v[28:31]
v_mfma_f32_16x16x32_bf16 v[48:51],a[220:223],v[108:111],v[48:51]
v_mfma_f32_16x16x32_bf16 v[64:67],v[108:111],v[220:223],v[64:67]
v_mfma_f32_16x16x32_bf16 v[32:35],a[92:95],v[108:111],v[32:35]
v_mfma_f32_16x16x32_bf16 v[52:55],a[220:223],v[112:115],v[52:55]
v_mfma_f32_16x16x32_bf16 v[68:71],v[112:115],v[220:223],v[68:71]
v_mfma_f32_16x16x32_bf16 v[36:39],a[92:95],v[112:115],v[36:39]
s_barrier
s_waitcnt lgkmcnt(2)
v_mfma_f32_16x16x32_bf16 v[40:43],a[224:227],v[72:75],v[40:43]
ds_read_b128 v[108:111],v6 offset:24576
v_mfma_f32_16x16x32_bf16 v[56:59],v[72:75],v[224:227],v[56:59]
s_add_u32 m0,s50,131072
v_mfma_f32_16x16x32_bf16 v[24:27],a[96:99],v[72:75],v[24:27]
ds_read_b128 v[112:115],v6 offset:28672
v_mfma_f32_16x16x32_bf16 v[44:47],a[224:227],v[76:79],v[44:47]
buffer_load_dwordx4 v20,s[8:11],s70 offen offset:0 sc1 lds
v_mfma_f32_16x16x32_bf16 v[60:63],v[76:79],v[224:227],v[60:63]
s_add_u32 m0,s50,135168
v_mfma_f32_16x16x32_bf16 v[28:31],a[96:99],v[76:79],v[28:31]
buffer_load_dwordx4 v20,s[8:11],s71 offen offset:0 sc1 lds
v_mfma_f32_16x16x32_bf16 v[48:51],a[232:235],v[72:75],v[48:51]
s_add_u32 m0,s50,139008
v_mfma_f32_16x16x32_bf16 v[64:67],v[72:75],v[232:235],v[64:67]
buffer_load_dwordx4 v20,s[8:11],s70 offen offset:256 sc1 lds
v_mfma_f32_16x16x32_bf16 v[32:35],a[104:107],v[72:75],v[32:35]
s_add_u32 m0,s50,143104
v_mfma_f32_16x16x32_bf16 v[52:55],a[232:235],v[76:79],v[52:55]
buffer_load_dwordx4 v20,s[8:11],s71 offen offset:256 sc1 lds
v_mfma_f32_16x16x32_bf16 v[68:71],v[76:79],v[232:235],v[68:71]
s_add_u32 m0,s50,146944
v_mfma_f32_16x16x32_bf16 v[36:39],a[104:107],v[76:79],v[36:39]
buffer_load_dwordx4 v20,s[8:11],s70 offen offset:512 sc1 lds
s_waitcnt lgkmcnt(2)
v_mfma_f32_16x16x32_bf16 v[40:43],a[228:231],v[80:83],v[40:43]
ds_read_b128 v[72:75],v7 offset:24576
v_mfma_f32_16x16x32_bf16 v[56:59],v[80:83],v[228:231],v[56:59]
s_add_u32 m0,s50,151040
v_mfma_f32_16x16x32_bf16 v[24:27],a[100:103],v[80:83],v[24:27]
ds_read_b128 v[76:79],v7 offset:28672
v_mfma_f32_16x16x32_bf16 v[44:47],a[228:231],v[84:87],v[44:47]
buffer_load_dwordx4 v20,s[8:11],s71 offen offset:512 sc1 lds
v_mfma_f32_16x16x32_bf16 v[60:63],v[84:87],v[228:231],v[60:63]
buffer_load_dwordx2 v[124:125],v23,s[8:11],s76 offen sc1
v_mfma_f32_16x16x32_bf16 v[28:31],a[100:103],v[84:87],v[28:31]
v_mfma_f32_16x16x32_bf16 v[48:51],a[236:239],v[80:83],v[48:51]
v_mfma_f32_16x16x32_bf16 v[64:67],v[80:83],v[236:239],v[64:67]
v_mfma_f32_16x16x32_bf16 v[32:35],a[108:111],v[80:83],v[32:35]
v_mfma_f32_16x16x32_bf16 v[52:55],a[236:239],v[84:87],v[52:55]
v_mfma_f32_16x16x32_bf16 v[68:71],v[84:87],v[236:239],v[68:71]
v_mfma_f32_16x16x32_bf16 v[36:39],a[108:111],v[84:87],v[36:39]
s_waitcnt lgkmcnt(2)
v_mfma_f32_16x16x32_bf16 v[40:43],a[240:243],v[108:111],v[40:43]
v_mfma_f32_16x16x32_bf16 v[56:59],v[108:111],v[240:243],v[56:59]
v_mfma_f32_16x16x32_bf16 v[24:27],a[112:115],v[108:111],v[24:27]
v_mfma_f32_16x16x32_bf16 v[44:47],a[240:243],v[112:115],v[44:47]
v_mfma_f32_16x16x32_bf16 v[60:63],v[112:115],v[240:243],v[60:63]
v_mfma_f32_16x16x32_bf16 v[28:31],a[112:115],v[112:115],v[28:31]
v_mfma_f32_16x16x32_bf16 v[48:51],a[248:251],v[108:111],v[48:51]
v_mfma_f32_16x16x32_bf16 v[64:67],v[108:111],v[248:251],v[64:67]
v_mfma_f32_16x16x32_bf16 v[32:35],a[120:123],v[108:111],v[32:35]
v_mfma_f32_16x16x32_bf16 v[52:55],a[248:251],v[112:115],v[52:55]
v_mfma_f32_16x16x32_bf16 v[68:71],v[112:115],v[248:251],v[68:71]
v_mfma_f32_16x16x32_bf16 v[36:39],a[120:123],v[112:115],v[36:39]
s_waitcnt lgkmcnt(0)
v_mfma_f32_16x16x32_bf16 v[40:43],a[244:247],v[72:75],v[40:43]
v_mfma_f32_16x16x32_bf16 v[56:59],v[72:75],v[244:247],v[56:59]
v_mfma_f32_16x16x32_bf16 v[24:27],a[116:119],v[72:75],v[24:27]
v_mfma_f32_16x16x32_bf16 v[44:47],a[244:247],v[76:79],v[44:47]
v_mfma_f32_16x16x32_bf16 v[60:63],v[76:79],v[244:247],v[60:63]
v_mfma_f32_16x16x32_bf16 v[28:31],a[116:119],v[76:79],v[28:31]
v_mfma_f32_16x16x32_bf16 v[48:51],a[252:255],v[72:75],v[48:51]
v_mfma_f32_16x16x32_bf16 v[64:67],v[72:75],v[252:255],v[64:67]
v_mfma_f32_16x16x32_bf16 v[32:35],a[124:127],v[72:75],v[32:35]
v_mfma_f32_16x16x32_bf16 v[52:55],a[252:255],v[76:79],v[52:55]
v_mfma_f32_16x16x32_bf16 v[68:71],v[76:79],v[252:255],v[68:71]
v_mfma_f32_16x16x32_bf16 v[36:39],a[124:127],v[76:79],v[36:39]
s_lshl_b32 s56,s51,5
s_add_u32 s56,s56,s47
s_lshl_b32 s56,s56,12
s_add_u32 s56,s56,s50
s_add_u32 s56,s56,41943040
v_mov_b64 v[120:121],-1
v_mov_b64 v[122:123],-1
buffer_store_dwordx4 v[120:123],v0,s[8:11],s56 offen sc1
v_cvt_pk_bf16_f32 v72,v40,v48
v_cvt_pk_bf16_f32 v73,v41,v49
v_cvt_pk_bf16_f32 v74,v42,v50
v_cvt_pk_bf16_f32 v75,v43,v51
buffer_store_dwordx4 v[72:75],v0,s[8:11],s61 offen sc1
v_cvt_pk_bf16_f32 v76,v44,v52
v_cvt_pk_bf16_f32 v77,v45,v53
v_cvt_pk_bf16_f32 v78,v46,v54
v_cvt_pk_bf16_f32 v79,v47,v55
buffer_store_dwordx4 v[76:79],v0,s[8:11],s62 offen sc1
v_cvt_pk_bf16_f32 v80,v56,v57
v_cvt_pk_bf16_f32 v81,v58,v59
v_cvt_pk_bf16_f32 v82,v60,v61
v_cvt_pk_bf16_f32 v83,v62,v63
buffer_store_dwordx4 v[80:83],v0,s[8:11],s65 offen offset:0 sc1
v_cvt_pk_bf16_f32 v84,v64,v65
v_cvt_pk_bf16_f32 v85,v66,v67
v_cvt_pk_bf16_f32 v86,v68,v69
v_cvt_pk_bf16_f32 v87,v70,v71
buffer_store_dwordx4 v[84:87],v0,s[8:11],s65 offen offset:1024 sc1
v_cvt_pk_bf16_f32 v108,v24,v32
v_cvt_pk_bf16_f32 v109,v25,v33
v_cvt_pk_bf16_f32 v110,v26,v34
v_cvt_pk_bf16_f32 v111,v27,v35
buffer_store_dwordx4 v[108:111],v0,s[8:11],s63 offen sc1
v_cvt_pk_bf16_f32 v112,v28,v36
v_cvt_pk_bf16_f32 v113,v29,v37
v_cvt_pk_bf16_f32 v114,v30,v38
v_cvt_pk_bf16_f32 v115,v31,v39
buffer_store_dwordx4 v[112:115],v0,s[8:11],s64 offen sc1
s_lshl_b32 s72,s51,13
s_lshl2_add_u32 s72,s47,s72
s_add_u32 s72,s72,10485760
s_sub_u32 s53,s53,1
s_cmp_gt_i32 s53,3
s_cbranch_scc1 L_mo_390
s_cmp_gt_i32 s53,0
s_cselect_b32 s87,1,3
s_mov_b32 s18,0
s_waitcnt vmcnt(7)
s_branch L_mo_395
L_mo_388:
s_mov_b32 s55,s22
s_mov_b32 s22,s23
s_mov_b32 s23,s24
s_mov_b32 s24,-1
v_mov_b32 v3,0
s_cmp_lg_u32 s55,-1
s_cbranch_scc1 L_mp_385
s_sub_u32 s56,s30,s31
s_cmp_gt_i32 s77,0
s_cselect_b32 s57,6,15
s_cmp_lg_u32 s86,0
s_cselect_b32 s57,9,s57
s_cmp_lt_i32 s56,s57
s_cbranch_scc1 L_mo_389
s_cmp_lt_i32 s56,30
s_cselect_b32 s87,s18,0
s_cmp_ge_u32 s31,8
s_cselect_b32 s56,1,s18
s_and_b32 s56,s56,s86
s_cselect_b32 s87,2,s87
s_mul_i32 s56,s87,s18
s_cmp_lg_u32 s56,0
s_cbranch_scc1 L_mo_393
s_mov_b32 s18,0
s_lshr_b32 s56,s72,31
s_or_b32 s56,s56,s87
s_cbranch_scc1 L_mo_399
s_waitcnt vmcnt(0)
s_barrier
s_or_b32 s72,s72,s52
buffer_store_dword v17,off,s[8:11],s72 sc1
s_mov_b32 s72,0x80000000
L_mo_399:
s_cmp_lg_u32 s46,0
s_cbranch_scc1 L_mo_397
s_lshl_b32 s76,s31,13
s_add_u32 s76,s76,10487040
s_lshl_b32 s57,s47,8
s_add_u32 s57,s57,s31
s_cmp_eq_u32 s57,63
s_mov_b32 s57,0x80000000
s_cmov_b32 s57,11018240
v_lshlrev_b32 v2,2,v1
L_mo_396:
buffer_load_dwordx2 v[124:125],v23,s[8:11],s76 offen sc1
buffer_load_dword v3,v2,s[8:11],s57 offen sc1
s_sub_u32 s49,s49,1
s_cbranch_scc1 L_abort2
s_waitcnt vmcnt(0)
L_mo_395:
v_min_u32 v123,v124,v125
v_max_u32 v125,v124,v125
v_cmp_eq_u32 vcc,0,v123
s_nop 1
v_cndmask_b32 v125,v125,-1,vcc
s_and_b32 s56,vcc_lo,0xffff
s_cbranch_scc0 L_mo_400
s_cmp_lg_u32 s87,0
s_cbranch_scc1 L_mo_400
s_mov_b32 s18,1
s_sleep 2
s_branch L_mo_396
L_mo_400:
v_max_u32_dpp v125,v125,v125 row_ror:8 row_mask:0xf bank_mask:0xf
s_nop 1
v_max_u32_dpp v125,v125,v125 row_ror:4 row_mask:0xf bank_mask:0xf
s_nop 1
v_max_u32_dpp v125,v125,v125 row_ror:2 row_mask:0xf bank_mask:0xf
s_nop 1
v_max_u32_dpp v125,v125,v125 row_ror:1 row_mask:0xf bank_mask:0xf
L_mo_397:
s_sub_u32 s49,s49,1
s_cbranch_scc1 L_abort2
v_mov_b32 v124,s18
s_barrier
s_cmp_lg_u32 s46,0
s_cbranch_scc1 L_mo_398
ds_write_b32 v16,v125
ds_write_b32 v19,v124 offset:16
s_waitcnt lgkmcnt(0)
L_mo_398:
s_barrier
ds_read_b128 v[120:123],v19
ds_read_b32 v124,v19 offset:16
s_waitcnt lgkmcnt(0)
v_readfirstlane_b32 s55,v120
v_readfirstlane_b32 s22,v121
v_readfirstlane_b32 s23,v122
v_readfirstlane_b32 s24,v123
v_readfirstlane_b32 s18,v124
s_cmp_lg_u32 s55,-1
s_cbranch_scc1 L_mp_385
L_mo_393:
s_mov_b32 s22,-1
s_cmp_eq_u32 s87,1
s_cbranch_scc1 L_mo_389
s_cmp_eq_u32 s87,2
s_cbranch_scc1 L_mo_394
s_branch L_mo_388
L_mp_385:
s_mov_b32 s53,0
s_sub_u32 s73,s73,1
s_max_i32 s73,s73,0
s_sub_u32 s77,s77,1
s_min_u32 s61,s73,2
s_cmp_lt_u32 s31,5
s_cselect_b32 s60,s25,0
s_cmp_lt_u32 s55,s60
s_cselect_b32 s61,2,s61
s_cmp_le_u32 s55,s54
s_cbranch_scc1 L_mr_386
s_mov_b32 s77,s61
s_mov_b32 s54,s55
s_mov_b32 s86,0
s_or_b32 s61,s47,s46
s_cbranch_scc1 L_mr_386
v_mov_b32 v120,s54
v_lshlrev_b32 v121,13,v1
s_mov_b32 s61,10486784
buffer_store_dword v120,v121,s[8:11],s61 offen sc1
L_mr_386:
s_cmp_lg_u32 s31,63
s_cbranch_scc1 L_mo_391
s_min_i32 s77,s77,0
s_or_b32 s61,s47,s46
s_cbranch_scc1 L_mo_391
s_mov_b32 s59,11018240
v_lshlrev_b32 v120,2,v1
v_mov_b32 v121,v3
v_cmp_eq_u32 vcc,0,v3
s_cbranch_vccz L_mg_387
L_fp_402:
s_sleep 0
buffer_load_dword v121,v120,s[8:11],s59 offen sc1
s_sub_u32 s49,s49,1
s_cbranch_scc1 L_abort2
s_waitcnt vmcnt(0)
v_cmp_eq_u32 vcc,0,v121
s_cbranch_vccnz L_fp_402
L_mg_387:
s_andn2_b32 s62,0x7ff,s54
v_lshl_or_b32 v121,s62,8,v121
s_add_u32 s59,s59,8192
buffer_store_dword v121,v120,s[8:11],s59 offen sc1
s_add_u32 s59,s59,8192
buffer_store_dword v121,v120,s[8:11],s59 offen sc1
s_add_u32 s59,s59,8192
buffer_store_dword v121,v120,s[8:11],s59 offen sc1
s_add_u32 s59,s59,8192
buffer_store_dword v121,v120,s[8:11],s59 offen sc1
s_add_u32 s59,s59,8192
buffer_store_dword v121,v120,s[8:11],s59 offen sc1
s_add_u32 s59,s59,8192
buffer_store_dword v121,v120,s[8:11],s59 offen sc1
L_mo_391:
s_add_u32 s31,s31,1
s_cmp_gt_i32 s77,0
s_cmov_b32 s18,0
s_cbranch_scc1 L_mo_388
s_cmp_lg_u32 s77,0
s_cbranch_scc1 L_mo_392
s_andn2_b32 s51,0x7ff,s54
s_lshr_b32 s51,s51,5
s_add_u32 s73,s73,2
s_mov_b32 s86,1
s_mov_b32 s19,0
s_mov_b32 s18,0
s_waitcnt vmcnt(8)
s_barrier
s_andn2_b32 s64,0x7ff,s54
s_lshl_b32 s56,s64,10
s_add_u32 s58,s56,4194304
buffer_load_dwordx4 v[88:91],v0,s[8:11],s58 offen sc1
v_and_b32 v9,15,v1
v_lshrrev_b32 v10,4,v1
v_and_b32 v124,1,v1
v_lshlrev_b32 v124,4,v124
v_mov_b32 v125,0xffff
v_lshlrev_b32 v125,v124,v125
v_lshrrev_b32 v124,2,v9
v_cmp_eq_u32 vcc,0,v124
s_nop 1
v_cndmask_b32 v12,0,v125,vcc
v_cmp_eq_u32 vcc,1,v124
s_nop 1
v_cndmask_b32 v13,0,v125,vcc
v_and_b32 v124,2,v1
v_cmp_eq_u32 vcc,0,v124
v_mov_b32 v14,0xeeee
v_mov_b32 v124,0x4444
v_cndmask_b32 v14,v14,v124,vcc
v_lshlrev_b32 v11,14,v10
v_lshl_add_u32 v11,v9,4,v11
s_lshl_b32 s65,s51,15
s_add_u32 s65,s65,92274688
s_lshl_b32 s62,s47,10
s_add_u32 s62,s62,s65
s_lshl_b32 s63,s47,16
s_lshl_b32 s60,s46,8
s_add_u32 s63,s63,s60
s_mov_b32 s4,s38
s_mov_b32 s5,s39
s_mov_b32 s6,1835008
s_mov_b32 s7,0x20000
s_lshl_b32 s57,s46,11
s_add_u32 s57,s57,139264
v_add_u32 v8,s57,v0
v_and_b32 v2,1,v10
v_lshrrev_b32 v3,1,v10
v_lshlrev_b32 v2,7,v2
v_lshl_add_u32 v2,v3,10,v2
s_lshl_b32 s59,s46,8
s_add_u32 s59,s57,s59
v_add_u32 v2,s59,v2
s_mov_b32 s60,0x01000100
s_mov_b32 s61,0x03020302
s_waitcnt vmcnt(0)
L_mx_403:
v_max3_u32 v124,v88,v89,v90
v_max_u32 v124,v91,v124
v_cmp_eq_u32 vcc,-1,v124
s_cbranch_vccz L_mxd_404
buffer_load_dwordx4 v[88:91],v0,s[8:11],s58 offen sc1
s_sub_u32 s49,s49,1
s_cbranch_scc1 L_abort2
s_waitcnt vmcnt(0)
s_branch L_mx_403
L_mxd_404:
buffer_load_dwordx4 v[24:27],v11,s[4:7],s63 offen offset:0
buffer_load_dwordx4 v[28:31],v11,s[4:7],s63 offen offset:1024
buffer_load_dwordx4 v[32:35],v11,s[4:7],s63 offen offset:2048
buffer_load_dwordx4 v[36:39],v11,s[4:7],s63 offen offset:3072
v_lshlrev_b32 v96,16,v88
v_and_b32 v97,0xffff0000,v88
v_lshlrev_b32 v98,16,v89
v_and_b32 v99,0xffff0000,v89
v_lshlrev_b32 v100,16,v90
v_and_b32 v101,0xffff0000,v90
v_lshlrev_b32 v102,16,v91
v_and_b32 v103,0xffff0000,v91
v_readfirstlane_b32 s78,v96
s_nop 1
v_pk_add_f32 v[108:109],v[96:97],s[78:79] op_sel_hi:[1,0] neg_lo:[0,1] neg_hi:[0,1]
v_pk_add_f32 v[110:111],v[98:99],s[78:79] op_sel_hi:[1,0] neg_lo:[0,1] neg_hi:[0,1]
v_pk_add_f32 v[112:113],v[100:101],s[78:79] op_sel_hi:[1,0] neg_lo:[0,1] neg_hi:[0,1]
v_pk_add_f32 v[114:115],v[102:103],s[78:79] op_sel_hi:[1,0] neg_lo:[0,1] neg_hi:[0,1]
v_pk_add_f32 v[116:117],v[108:109],v[110:111]
v_pk_mul_f32 v[118:119],v[108:109],v[108:109]
v_pk_add_f32 v[120:121],v[112:113],v[114:115]
v_pk_fma_f32 v[118:119],v[110:111],v[110:111],v[118:119]
v_pk_add_f32 v[116:117],v[116:117],v[120:121]
v_pk_fma_f32 v[118:119],v[112:113],v[112:113],v[118:119]
v_add_f32 v116,v116,v117
v_pk_fma_f32 v[118:119],v[114:115],v[114:115],v[118:119]
v_add_f32 v118,v118,v119
s_nop 1
v_permlane32_swap_b32 v116,v118
v_add_f32 v116,v116,v118
s_nop 1
v_add_f32_dpp v116,v116,v116 row_ror:8 row_mask:0xf bank_mask:0xf
s_nop 1
v_add_f32_dpp v116,v116,v116 row_ror:4 row_mask:0xf bank_mask:0xf
s_nop 1
v_add_f32_dpp v116,v116,v116 row_ror:2 row_mask:0xf bank_mask:0xf
s_nop 1
v_add_f32_dpp v116,v116,v116 row_ror:1 row_mask:0xf bank_mask:0xf
v_mov_b32 v118,v116
s_nop 1
v_permlane16_swap_b32 v116,v118
v_add_f32 v116,v116,v118
v_mul_f32 v116,0x3b000000,v116
v_mov_b32 v118,v116
s_nop 1
v_permlane32_swap_b32 v116,v118
v_fma_f32 v118,-v116,v116,v118
v_add_f32 v116,s78,v116
v_max_f32 v118,0,v118
v_cvt_pk_bf16_f32 v118,v116,v118
v_lshlrev_b32 v116,16,v118
v_and_b32 v118,0xffff0000,v118
v_add_f32 v118,0x3727c5ac,v118
v_cvt_pk_bf16_f32 v118,v118,v118
v_and_b32 v118,0xffff0000,v118
v_sqrt_f32 v118,v118
v_pk_add_f32 v[108:109],v[96:97],v[116:117] op_sel_hi:[1,0] neg_lo:[0,1] neg_hi:[0,1]
v_pk_add_f32 v[110:111],v[98:99],v[116:117] op_sel_hi:[1,0] neg_lo:[0,1] neg_hi:[0,1]
v_pk_add_f32 v[112:113],v[100:101],v[116:117] op_sel_hi:[1,0] neg_lo:[0,1] neg_hi:[0,1]
v_pk_add_f32 v[114:115],v[102:103],v[116:117] op_sel_hi:[1,0] neg_lo:[0,1] neg_hi:[0,1]
v_cvt_pk_bf16_f32 v118,v118,v118
v_and_b32 v118,0xffff0000,v118
v_rcp_f32 v118,v118
v_cvt_pk_bf16_f32 v104,v108,v109
v_cvt_pk_bf16_f32 v105,v110,v111
v_cvt_pk_bf16_f32 v106,v112,v113
v_cvt_pk_bf16_f32 v107,v114,v115
v_lshlrev_b32 v108,16,v104
v_and_b32 v109,0xffff0000,v104
v_lshlrev_b32 v110,16,v105
v_and_b32 v111,0xffff0000,v105
v_lshlrev_b32 v112,16,v106
v_and_b32 v113,0xffff0000,v106
v_lshlrev_b32 v114,16,v107
v_and_b32 v115,0xffff0000,v107
v_pk_mul_f32 v[108:109],v[108:109],v[118:119] op_sel_hi:[1,0]
v_pk_mul_f32 v[110:111],v[110:111],v[118:119] op_sel_hi:[1,0]
v_pk_mul_f32 v[112:113],v[112:113],v[118:119] op_sel_hi:[1,0]
v_pk_mul_f32 v[114:115],v[114:115],v[118:119] op_sel_hi:[1,0]
v_cvt_pk_bf16_f32 v104,v108,v109
v_cvt_pk_bf16_f32 v105,v110,v111
v_cvt_pk_bf16_f32 v106,v112,v113
v_cvt_pk_bf16_f32 v107,v114,v115
v_perm_b32 v88,v104,v104,s60
v_perm_b32 v89,v105,v105,s60
v_perm_b32 v90,v106,v106,s60
v_perm_b32 v91,v107,v107,s60
ds_write_b128 v8,v[88:91]
v_perm_b32 v92,v104,v104,s61
v_perm_b32 v93,v105,v105,s61
v_perm_b32 v94,v106,v106,s61
v_perm_b32 v95,v107,v107,s61
ds_write_b128 v8,v[92:95] offset:1024
s_mov_b32 s58,s57
ds_read_b128 v[88:91],v2 offset:0
ds_read_b128 v[92:95],v2 offset:64
ds_read_b128 v[108:111],v18 offset:0
ds_read_b128 v[112:115],v18 offset:1024
ds_read_b128 v[64:67],v18 offset:2048
ds_read_b128 v[68:71],v18 offset:3072
ds_read_b128 v[72:75],v18 offset:4096
ds_read_b128 v[76:79],v18 offset:5120
ds_read_b128 v[80:83],v18 offset:6144
ds_read_b128 v[84:87],v18 offset:7168
v_mov_b64 v[116:117],0
v_mov_b64 v[118:119],0
s_waitcnt lgkmcnt(8)
v_and_b32 v120,v12,v88
v_and_b32 v121,v13,v88
v_and_b32 v122,v12,v92
v_and_b32 v123,v13,v92
s_waitcnt lgkmcnt(6)
s_nop 0
v_smfmac_f32_16x16x64_bf16 v[116:119],v[120:123],v[108:115],v14
ds_read_b128 v[108:111],v18 offset:8192
ds_read_b128 v[112:115],v18 offset:9216
s_add_u32 s63,s63,4096
buffer_load_dwordx4 v[40:43],v11,s[4:7],s63 offen offset:0
v_and_b32 v124,v12,v89
v_and_b32 v125,v13,v89
v_and_b32 v126,v12,v93
v_and_b32 v127,v13,v93
s_waitcnt lgkmcnt(6)
s_nop 0
v_smfmac_f32_16x16x64_bf16 v[116:119],v[124:127],v[64:71],v14
ds_read_b128 v[64:67],v18 offset:10240
ds_read_b128 v[68:71],v18 offset:11264
buffer_load_dwordx4 v[44:47],v11,s[4:7],s63 offen offset:1024
v_and_b32 v120,v12,v90
v_and_b32 v121,v13,v90
v_and_b32 v122,v12,v94
v_and_b32 v123,v13,v94
s_waitcnt lgkmcnt(6)
s_nop 0
v_smfmac_f32_16x16x64_bf16 v[116:119],v[120:123],v[72:79],v14
ds_read_b128 v[72:75],v18 offset:12288
ds_read_b128 v[76:79],v18 offset:13312
buffer_load_dwordx4 v[48:51],v11,s[4:7],s63 offen offset:2048
v_and_b32 v124,v12,v91
v_and_b32 v125,v13,v91
v_and_b32 v126,v12,v95
v_and_b32 v127,v13,v95
ds_read_b128 v[88:91],v2 offset:16
ds_read_b128 v[92:95],v2 offset:80
s_waitcnt lgkmcnt(8)
v_smfmac_f32_16x16x64_bf16 v[116:119],v[124:127],v[80:87],v14
ds_read_b128 v[80:83],v18 offset:14336
ds_read_b128 v[84:87],v18 offset:15360
buffer_load_dwordx4 v[52:55],v11,s[4:7],s63 offen offset:3072
s_waitcnt lgkmcnt(2)
v_and_b32 v120,v12,v88
v_and_b32 v121,v13,v88
v_and_b32 v122,v12,v92
v_and_b32 v123,v13,v92
s_waitcnt lgkmcnt(8)
s_nop 0
v_smfmac_f32_16x16x64_bf16 v[116:119],v[120:123],v[108:115],v14
ds_read_b128 v[108:111],v18 offset:16384
ds_read_b128 v[112:115],v18 offset:17408
s_add_u32 s63,s63,4096
buffer_load_dwordx4 v[56:59],v11,s[4:7],s63 offen offset:0
v_and_b32 v124,v12,v89
v_and_b32 v125,v13,v89
v_and_b32 v126,v12,v93
v_and_b32 v127,v13,v93
s_waitcnt lgkmcnt(8)
s_nop 0
v_smfmac_f32_16x16x64_bf16 v[116:119],v[124:127],v[64:71],v14
ds_read_b128 v[64:67],v18 offset:18432
ds_read_b128 v[68:71],v18 offset:19456
buffer_load_dwordx4 v[60:63],v11,s[4:7],s63 offen offset:1024
v_and_b32 v120,v12,v90
v_and_b32 v121,v13,v90
v_and_b32 v122,v12,v94
v_and_b32 v123,v13,v94
s_waitcnt lgkmcnt(8)
s_nop 0
v_smfmac_f32_16x16x64_bf16 v[116:119],v[120:123],v[72:79],v14
ds_read_b128 v[72:75],v18 offset:20480
ds_read_b128 v[76:79],v18 offset:21504
v_and_b32 v124,v12,v91
v_and_b32 v125,v13,v91
v_and_b32 v126,v12,v95
v_and_b32 v127,v13,v95
ds_read_b128 v[88:91],v2 offset:32
ds_read_b128 v[92:95],v2 offset:96
s_waitcnt lgkmcnt(8)
v_smfmac_f32_16x16x64_bf16 v[116:119],v[124:127],v[80:87],v14
ds_read_b128 v[80:83],v18 offset:22528
ds_read_b128 v[84:87],v18 offset:23552
s_waitcnt lgkmcnt(2)
v_and_b32 v120,v12,v88
v_and_b32 v121,v13,v88
v_and_b32 v122,v12,v92
v_and_b32 v123,v13,v92
s_waitcnt lgkmcnt(8)
s_nop 0
v_smfmac_f32_16x16x64_bf16 v[116:119],v[120:123],v[108:115],v14
ds_read_b128 v[108:111],v18 offset:24576
ds_read_b128 v[112:115],v18 offset:25600
v_and_b32 v124,v12,v89
v_and_b32 v125,v13,v89
v_and_b32 v126,v12,v93
v_and_b32 v127,v13,v93
s_waitcnt lgkmcnt(8)
s_nop 0
v_smfmac_f32_16x16x64_bf16 v[116:119],v[124:127],v[64:71],v14
ds_read_b128 v[64:67],v18 offset:26624
ds_read_b128 v[68:71],v18 offset:27648
v_and_b32 v120,v12,v90
v_and_b32 v121,v13,v90
v_and_b32 v122,v12,v94
v_and_b32 v123,v13,v94
s_waitcnt lgkmcnt(8)
s_nop 0
v_smfmac_f32_16x16x64_bf16 v[116:119],v[120:123],v[72:79],v14
ds_read_b128 v[72:75],v18 offset:28672
ds_read_b128 v[76:79],v18 offset:29696
v_and_b32 v124,v12,v91
v_and_b32 v125,v13,v91
v_and_b32 v126,v12,v95
v_and_b32 v127,v13,v95
ds_read_b128 v[88:91],v2 offset:48
ds_read_b128 v[92:95],v2 offset:112
s_waitcnt lgkmcnt(8)
v_smfmac_f32_16x16x64_bf16 v[116:119],v[124:127],v[80:87],v14
ds_read_b128 v[80:83],v18 offset:30720
ds_read_b128 v[84:87],v18 offset:31744
s_waitcnt lgkmcnt(2)
v_and_b32 v120,v12,v88
v_and_b32 v121,v13,v88
v_and_b32 v122,v12,v92
v_and_b32 v123,v13,v92
s_waitcnt lgkmcnt(8)
s_nop 0
v_smfmac_f32_16x16x64_bf16 v[116:119],v[120:123],v[108:115],v14
v_and_b32 v124,v12,v89
v_and_b32 v125,v13,v89
v_and_b32 v126,v12,v93
v_and_b32 v127,v13,v93
s_waitcnt lgkmcnt(6)
s_nop 0
v_smfmac_f32_16x16x64_bf16 v[116:119],v[124:127],v[64:71],v14
buffer_load_dwordx4 v[64:67],v11,s[4:7],s63 offen offset:2048
buffer_load_dwordx4 v[68:71],v11,s[4:7],s63 offen offset:3072
v_and_b32 v120,v12,v90
v_and_b32 v121,v13,v90
v_and_b32 v122,v12,v94
v_and_b32 v123,v13,v94
s_waitcnt lgkmcnt(4)
s_nop 0
v_smfmac_f32_16x16x64_bf16 v[116:119],v[120:123],v[72:79],v14
s_add_u32 s63,s63,4096
buffer_load_dwordx4 v[72:75],v11,s[4:7],s63 offen offset:0
buffer_load_dwordx4 v[76:79],v11,s[4:7],s63 offen offset:1024
v_and_b32 v124,v12,v91
v_and_b32 v125,v13,v91
v_and_b32 v126,v12,v95
v_and_b32 v127,v13,v95
s_waitcnt lgkmcnt(0)
s_nop 0
v_smfmac_f32_16x16x64_bf16 v[116:119],v[124:127],v[80:87],v14
buffer_load_dwordx4 v[80:83],v11,s[4:7],s63 offen offset:2048
buffer_load_dwordx4 v[84:87],v11,s[4:7],s63 offen offset:3072
v_lshlrev_b32 v8,5,v9
v_and_b32 v124,1,v10
v_lshl_add_u32 v8,v124,4,v8
v_lshrrev_b32 v124,1,v10
v_lshl_add_u32 v8,v124,11,v8
s_lshl_b32 s60,s46,9
s_add_u32 s60,s60,147456
v_add_u32 v8,s60,v8
ds_write_b128 v8,v[116:119]
v_lshlrev_b32 v8,2,v1
v_add_u32 v8,147456,v8
v_and_b32 v2,1,v1
v_lshrrev_b32 v3,1,v1
v_lshlrev_b32 v3,2,v3
v_lshl_add_u32 v2,v2,7,v3
v_add_u32 v2,s58,v2
v_lshlrev_b32 v3,6,v10
v_add_u32 v3,s58,v3
s_waitcnt lgkmcnt(0)
s_barrier
ds_read2st64_b32 v[88:89],v8 offset0:0 offset1:1
ds_read2st64_b32 v[90:91],v8 offset0:2 offset1:3
ds_read2st64_b32 v[92:93],v8 offset0:4 offset1:5
ds_read2st64_b32 v[94:95],v8 offset0:6 offset1:7
s_waitcnt lgkmcnt(0)
v_pk_add_f32 v[88:89],v[88:89],v[90:91]
v_pk_add_f32 v[92:93],v[92:93],v[94:95]
v_pk_add_f32 v[88:89],v[88:89],v[92:93]
v_cvt_pk_bf16_f32 v88,v88,v88
v_and_b32 v88,0xffff0000,v88
v_cvt_pk_bf16_f32 v89,v89,v89
v_and_b32 v89,0xffff0000,v89
v_mul_f32 v90,0xbfb8aa3b,v88
v_exp_f32 v90,v90
s_nop 0
v_add_f32 v90,1.0,v90
v_rcp_f32 v90,v90
s_nop 0
v_mul_f32 v88,v88,v90
v_cvt_pk_bf16_f32 v88,v88,v88
v_and_b32 v88,0xffff0000,v88
v_mul_f32 v88,v88,v89
v_cvt_pk_bf16_f32 v88,v88,v88
ds_write_b32 v2,v88
ds_read_b128 v[88:91],v3
ds_read_b128 v[108:111],v3 offset:32
ds_read_b128 v[92:95],v3 offset:16
ds_read_b128 v[112:115],v3 offset:48
v_mov_b64 v[116:117],0
v_mov_b64 v[118:119],0
s_waitcnt vmcnt(0) lgkmcnt(0)
v_and_b32 v120,v12,v88
v_and_b32 v121,v13,v88
v_and_b32 v122,v12,v108
v_and_b32 v123,v13,v108
v_and_b32 v124,v12,v89
v_and_b32 v125,v13,v89
v_smfmac_f32_16x16x64_bf16 v[116:119],v[120:123],v[24:31],v14
v_and_b32 v126,v12,v109
v_and_b32 v127,v13,v109
v_and_b32 v120,v12,v90
v_and_b32 v121,v13,v90
v_smfmac_f32_16x16x64_bf16 v[116:119],v[124:127],v[32:39],v14
v_and_b32 v122,v12,v110
v_and_b32 v123,v13,v110
v_and_b32 v124,v12,v91
v_and_b32 v125,v13,v91
v_smfmac_f32_16x16x64_bf16 v[116:119],v[120:123],v[40:47],v14
v_and_b32 v126,v12,v111
v_and_b32 v127,v13,v111
v_and_b32 v120,v12,v92
v_and_b32 v121,v13,v92
v_smfmac_f32_16x16x64_bf16 v[116:119],v[124:127],v[48:55],v14
v_and_b32 v122,v12,v112
v_and_b32 v123,v13,v112
v_and_b32 v124,v12,v93
v_and_b32 v125,v13,v93
v_smfmac_f32_16x16x64_bf16 v[116:119],v[120:123],v[56:63],v14
v_and_b32 v126,v12,v113
v_and_b32 v127,v13,v113
v_and_b32 v120,v12,v94
v_and_b32 v121,v13,v94
v_smfmac_f32_16x16x64_bf16 v[116:119],v[124:127],v[64:71],v14
v_and_b32 v122,v12,v114
v_and_b32 v123,v13,v114
v_and_b32 v124,v12,v95
v_and_b32 v125,v13,v95
v_smfmac_f32_16x16x64_bf16 v[116:119],v[120:123],v[72:79],v14
v_and_b32 v126,v12,v115
v_and_b32 v127,v13,v115
s_nop 1
v_smfmac_f32_16x16x64_bf16 v[116:119],v[124:127],v[80:87],v14
v_lshlrev_b32 v8,4,v9
v_and_b32 v124,1,v10
v_lshl_add_u32 v8,v124,3,v8
v_and_b32 v124,2,v10
v_lshl_add_u32 v8,v124,30,v8
s_lshl_b32 s60,s46,8
s_add_u32 s59,s62,s60
s_nop 0
v_cvt_pk_bf16_f32 v88,v116,v117
v_cvt_pk_bf16_f32 v89,v118,v119
buffer_store_dwordx2 v[88:89],v8,s[8:11],s59 offen sc1
s_lshl_b32 s59,s51,13
s_lshl2_add_u32 s59,s47,s59
s_add_u32 s59,s59,10486912
s_waitcnt vmcnt(0)
s_barrier
s_or_b32 s59,s59,s52
buffer_store_dword v17,off,s[8:11],s59 sc1
s_lshl_b32 s59,s51,13
s_add_u32 s59,s59,10486912
v_and_b32 v124,31,v1
v_lshlrev_b32 v124,2,v124
L_fw_406:
buffer_load_dword v125,v124,s[8:11],s59 offen sc1
s_sub_u32 s49,s49,1
s_cbranch_scc1 L_abort2
s_waitcnt vmcnt(0)
v_cmp_eq_u32 vcc,0,v125
s_cbranch_vccnz L_fw_406
s_add_u32 s63,s65,0
buffer_load_dwordx4 v[24:27],v22,s[8:11],s63 offen sc1
s_add_u32 s63,s65,4096
buffer_load_dwordx4 v[28:31],v22,s[8:11],s63 offen sc1
s_add_u32 s63,s65,8192
buffer_load_dwordx4 v[32:35],v22,s[8:11],s63 offen sc1
s_add_u32 s63,s65,12288
buffer_load_dwordx4 v[36:39],v22,s[8:11],s63 offen sc1
s_add_u32 s63,s65,16384
buffer_load_dwordx4 v[40:43],v22,s[8:11],s63 offen sc1
s_add_u32 s63,s65,20480
buffer_load_dwordx4 v[44:47],v22,s[8:11],s63 offen sc1
s_add_u32 s63,s65,24576
buffer_load_dwordx4 v[48:51],v22,s[8:11],s63 offen sc1
s_add_u32 s63,s65,28672
buffer_load_dwordx4 v[52:55],v22,s[8:11],s63 offen sc1
v_and_b32 v64,15,v1
v_and_b32 v65,1,v1
v_lshlrev_b32 v65,4,v65
v_mov_b32 v66,0x3f80
v_lshlrev_b32 v66,v65,v66
v_lshrrev_b32 v64,1,v64
v_cmp_eq_u32 vcc,0,v64
s_nop 1
v_cndmask_b32 v56,0,v66,vcc
v_cmp_eq_u32 vcc,1,v64
s_nop 1
v_cndmask_b32 v57,0,v66,vcc
v_cmp_eq_u32 vcc,2,v64
s_nop 1
v_cndmask_b32 v58,0,v66,vcc
v_cmp_eq_u32 vcc,3,v64
s_nop 1
v_cndmask_b32 v59,0,v66,vcc
s_waitcnt vmcnt(7)
s_nop 0
v_mfma_f32_16x16x32_bf16 v[60:63],v[56:59],v[24:27],0
s_waitcnt vmcnt(6)
v_mfma_f32_16x16x32_bf16 v[60:63],v[56:59],v[28:31],v[60:63]
s_waitcnt vmcnt(5)
v_mfma_f32_16x16x32_bf16 v[60:63],v[56:59],v[32:35],v[60:63]
s_waitcnt vmcnt(4)
v_mfma_f32_16x16x32_bf16 v[60:63],v[56:59],v[36:39],v[60:63]
s_waitcnt vmcnt(3)
v_mfma_f32_16x16x32_bf16 v[60:63],v[56:59],v[40:43],v[60:63]
s_waitcnt vmcnt(2)
v_mfma_f32_16x16x32_bf16 v[60:63],v[56:59],v[44:47],v[60:63]
s_waitcnt vmcnt(1)
v_mfma_f32_16x16x32_bf16 v[60:63],v[56:59],v[48:51],v[60:63]
s_waitcnt vmcnt(0)
v_mfma_f32_16x16x32_bf16 v[60:63],v[56:59],v[52:55],v[60:63]
s_nop 7
ds_write_b128 v21,v[60:63]
s_waitcnt lgkmcnt(0)
s_barrier
s_cmp_lg_u32 s46,0
s_cbranch_scc1 L_moed_405
v_lshlrev_b32 v56,5,v1
v_add_u32 v56,155648,v56
ds_read_b128 v[24:27],v56
ds_read_b128 v[28:31],v56 offset:16
s_and_b32 s59,s54,0xffff0000
s_xor_b32 s60,s59,0x80000000
s_xor_b32 s61,s59,0xffff0000
s_cmp_lt_i32 s59,0
s_cselect_b32 s59,s60,s61
v_mov_b32 v56,s59
v_mul_f32 v56,0xbfb8aa3b,v56
v_exp_f32 v56,v56
s_nop 0
v_add_f32 v56,1.0,v56
v_rcp_f32 v56,v56
s_nop 0
v_cvt_pk_bf16_f32 v56,v56,v56
v_and_b32 v56,0xffff0000,v56
v_lshlrev_b32 v48,16,v104
v_and_b32 v49,0xffff0000,v104
v_lshlrev_b32 v50,16,v105
v_and_b32 v51,0xffff0000,v105
v_lshlrev_b32 v52,16,v106
v_and_b32 v53,0xffff0000,v106
v_lshlrev_b32 v54,16,v107
v_and_b32 v55,0xffff0000,v107
s_waitcnt lgkmcnt(0)
v_cvt_pk_bf16_f32 v40,v24,v25
v_cvt_pk_bf16_f32 v41,v26,v27
v_cvt_pk_bf16_f32 v42,v28,v29
v_cvt_pk_bf16_f32 v43,v30,v31
v_lshlrev_b32 v24,16,v40
v_and_b32 v25,0xffff0000,v40
v_lshlrev_b32 v26,16,v41
v_and_b32 v27,0xffff0000,v41
v_lshlrev_b32 v28,16,v42
v_and_b32 v29,0xffff0000,v42
v_lshlrev_b32 v30,16,v43
v_and_b32 v31,0xffff0000,v43
v_pk_mul_f32 v[24:25],v[24:25],v[56:57] op_sel_hi:[1,0]
v_pk_mul_f32 v[26:27],v[26:27],v[56:57] op_sel_hi:[1,0]
v_pk_mul_f32 v[28:29],v[28:29],v[56:57] op_sel_hi:[1,0]
v_pk_mul_f32 v[30:31],v[30:31],v[56:57] op_sel_hi:[1,0]
v_cvt_pk_bf16_f32 v40,v24,v25
v_cvt_pk_bf16_f32 v41,v26,v27
v_cvt_pk_bf16_f32 v42,v28,v29
v_cvt_pk_bf16_f32 v43,v30,v31
v_lshlrev_b32 v24,16,v40
v_and_b32 v25,0xffff0000,v40
v_lshlrev_b32 v26,16,v41
v_and_b32 v27,0xffff0000,v41
v_lshlrev_b32 v28,16,v42
v_and_b32 v29,0xffff0000,v42
v_lshlrev_b32 v30,16,v43
v_and_b32 v31,0xffff0000,v43
v_pk_add_f32 v[24:25],v[24:25],v[48:49]
v_pk_add_f32 v[26:27],v[26:27],v[50:51]
v_pk_add_f32 v[28:29],v[28:29],v[52:53]
v_pk_add_f32 v[30:31],v[30:31],v[54:55]
v_cvt_pk_bf16_f32 v40,v24,v25
v_cvt_pk_bf16_f32 v41,v26,v27
v_cvt_pk_bf16_f32 v42,v28,v29
v_cvt_pk_bf16_f32 v43,v30,v31
v_lshlrev_b32 v24,16,v40
v_and_b32 v25,0xffff0000,v40
v_lshlrev_b32 v26,16,v41
v_and_b32 v27,0xffff0000,v41
v_lshlrev_b32 v28,16,v42
v_and_b32 v29,0xffff0000,v42
v_lshlrev_b32 v30,16,v43
v_and_b32 v31,0xffff0000,v43
v_pk_add_f32 v[96:97],v[96:97],v[24:25]
v_pk_add_f32 v[98:99],v[98:99],v[26:27]
v_pk_add_f32 v[100:101],v[100:101],v[28:29]
v_pk_add_f32 v[102:103],v[102:103],v[30:31]
v_cvt_pk_bf16_f32 v80,v96,v97
v_cvt_pk_bf16_f32 v81,v98,v99
v_cvt_pk_bf16_f32 v82,v100,v101
v_cvt_pk_bf16_f32 v83,v102,v103
v_lshlrev_b32 v96,16,v80
v_and_b32 v97,0xffff0000,v80
v_lshlrev_b32 v98,16,v81
v_and_b32 v99,0xffff0000,v81
v_lshlrev_b32 v100,16,v82
v_and_b32 v101,0xffff0000,v82
v_lshlrev_b32 v102,16,v83
v_and_b32 v103,0xffff0000,v83
v_readfirstlane_b32 s78,v96
s_nop 1
v_pk_add_f32 v[58:59],v[96:97],s[78:79] op_sel_hi:[1,0] neg_lo:[0,1] neg_hi:[0,1]
v_pk_add_f32 v[60:61],v[98:99],s[78:79] op_sel_hi:[1,0] neg_lo:[0,1] neg_hi:[0,1]
v_pk_add_f32 v[62:63],v[100:101],s[78:79] op_sel_hi:[1,0] neg_lo:[0,1] neg_hi:[0,1]
v_pk_add_f32 v[64:65],v[102:103],s[78:79] op_sel_hi:[1,0] neg_lo:[0,1] neg_hi:[0,1]
v_pk_add_f32 v[66:67],v[58:59],v[60:61]
v_pk_mul_f32 v[68:69],v[58:59],v[58:59]
v_pk_add_f32 v[70:71],v[62:63],v[64:65]
v_pk_fma_f32 v[68:69],v[60:61],v[60:61],v[68:69]
v_pk_add_f32 v[66:67],v[66:67],v[70:71]
v_pk_fma_f32 v[68:69],v[62:63],v[62:63],v[68:69]
v_add_f32 v66,v66,v67
v_pk_fma_f32 v[68:69],v[64:65],v[64:65],v[68:69]
v_add_f32 v68,v68,v69
s_nop 1
v_permlane32_swap_b32 v66,v68
v_add_f32 v66,v66,v68
s_nop 1
v_add_f32_dpp v66,v66,v66 row_ror:8 row_mask:0xf bank_mask:0xf
s_nop 1
v_add_f32_dpp v66,v66,v66 row_ror:4 row_mask:0xf bank_mask:0xf
s_nop 1
v_add_f32_dpp v66,v66,v66 row_ror:2 row_mask:0xf bank_mask:0xf
s_nop 1
v_add_f32_dpp v66,v66,v66 row_ror:1 row_mask:0xf bank_mask:0xf
v_mov_b32 v68,v66
s_nop 1
v_permlane16_swap_b32 v66,v68
v_add_f32 v66,v66,v68
v_mul_f32 v66,0x3b000000,v66
v_mov_b32 v68,v66
s_nop 1
v_permlane32_swap_b32 v66,v68
v_fma_f32 v68,-v66,v66,v68
v_add_f32 v66,s78,v66
v_max_f32 v68,0,v68
v_cvt_pk_bf16_f32 v68,v66,v68
v_lshlrev_b32 v66,16,v68
v_and_b32 v68,0xffff0000,v68
v_add_f32 v68,0x3727c5ac,v68
v_cvt_pk_bf16_f32 v68,v68,v68
v_and_b32 v68,0xffff0000,v68
v_sqrt_f32 v68,v68
v_pk_add_f32 v[58:59],v[96:97],v[66:67] op_sel_hi:[1,0] neg_lo:[0,1] neg_hi:[0,1]
v_pk_add_f32 v[60:61],v[98:99],v[66:67] op_sel_hi:[1,0] neg_lo:[0,1] neg_hi:[0,1]
v_pk_add_f32 v[62:63],v[100:101],v[66:67] op_sel_hi:[1,0] neg_lo:[0,1] neg_hi:[0,1]
v_pk_add_f32 v[64:65],v[102:103],v[66:67] op_sel_hi:[1,0] neg_lo:[0,1] neg_hi:[0,1]
v_cvt_pk_bf16_f32 v68,v68,v68
v_and_b32 v68,0xffff0000,v68
v_rcp_f32 v68,v68
v_cvt_pk_bf16_f32 v84,v58,v59
v_cvt_pk_bf16_f32 v85,v60,v61
v_cvt_pk_bf16_f32 v86,v62,v63
v_cvt_pk_bf16_f32 v87,v64,v65
v_lshlrev_b32 v58,16,v84
v_and_b32 v59,0xffff0000,v84
v_lshlrev_b32 v60,16,v85
v_and_b32 v61,0xffff0000,v85
v_lshlrev_b32 v62,16,v86
v_and_b32 v63,0xffff0000,v86
v_lshlrev_b32 v64,16,v87
v_and_b32 v65,0xffff0000,v87
v_pk_mul_f32 v[58:59],v[58:59],v[68:69] op_sel_hi:[1,0]
v_pk_mul_f32 v[60:61],v[60:61],v[68:69] op_sel_hi:[1,0]
v_pk_mul_f32 v[62:63],v[62:63],v[68:69] op_sel_hi:[1,0]
v_pk_mul_f32 v[64:65],v[64:65],v[68:69] op_sel_hi:[1,0]
v_cvt_pk_bf16_f32 v84,v58,v59
v_cvt_pk_bf16_f32 v85,v60,v61
v_cvt_pk_bf16_f32 v86,v62,v63
v_cvt_pk_bf16_f32 v87,v64,v65
s_lshl_b32 s58,s51,10
s_add_u32 s58,s58,11272192
s_add_u32 s59,s58,65536
s_cmp_eq_u32 s47,0
s_cselect_b32 s59,s59,0x80000000
s_add_u32 s57,s56,98566144
buffer_store_dwordx4 v[84:87],v0,s[8:11],s59 offen sc1
buffer_store_dwordx4 v[80:83],v0,s[8:11],s58 offen sc1
buffer_store_dwordx4 v[84:87],v0,s[8:11],s57 offen sc1
L_moed_405:
s_barrier
L_mo_392:
s_mov_b32 s77,-1
s_cmp_lt_u32 s31,64
s_cbranch_scc1 L_mo_388
s_cmp_eq_u32 s86,0
s_cbranch_scc1 L_mo_401
L_mo_394:
s_andn2_b32 s51,0x7ff,s54
s_lshr_b32 s51,s51,5
s_andn2_b32 s56,31,s54
v_lshrrev_b32 v2,10,v20
v_add_u32 v3,16,v2
v_add_u32 v8,96468992,v20
v_cmp_eq_u32 vcc,s56,v2
s_nop 1
v_cndmask_b32 v2,v20,v8,vcc
v_cmp_eq_u32 vcc,s56,v3
s_nop 1
v_cndmask_b32 v3,v20,v8,vcc
s_waitcnt vmcnt(0)
s_lshl_b32 s59,s51,13
s_add_u32 s59,s59,10487552
s_cmp_lg_u32 s46,0
s_cbranch_scc1 L_fd_410
v_and_b32 v124,31,v1
v_lshlrev_b32 v124,2,v124
s_branch L_ff_411
L_fw_409:
s_sleep 2
L_ff_411:
buffer_load_dword v125,v124,s[8:11],s59 offen sc1
s_sub_u32 s49,s49,1
s_cbranch_scc1 L_abort2
s_waitcnt vmcnt(0)
v_cmp_eq_u32 vcc,0,v125
s_cbranch_vccnz L_fw_409
L_fd_410:
s_barrier
s_or_b32 s72,s72,s52
buffer_store_dword v17,off,s[8:11],s72 sc1
s_lshl_b32 s66,s51,15
s_add_u32 s66,s66,2097152
s_add_u32 s67,s66,16384
s_add_u32 m0,s50,131072
s_nop 0
buffer_load_dwordx4 v2,s[8:11],s66 offen offset:0 sc1 lds
s_add_u32 m0,s50,135168
s_nop 0
buffer_load_dwordx4 v3,s[8:11],s67 offen offset:0 sc1 lds
s_add_u32 m0,s50,139008
s_nop 0
buffer_load_dwordx4 v2,s[8:11],s66 offen offset:256 sc1 lds
s_add_u32 m0,s50,143104
s_nop 0
buffer_load_dwordx4 v3,s[8:11],s67 offen offset:256 sc1 lds
s_add_u32 m0,s50,146944
s_nop 0
buffer_load_dwordx4 v2,s[8:11],s66 offen offset:512 sc1 lds
s_add_u32 m0,s50,151040
s_nop 0
buffer_load_dwordx4 v3,s[8:11],s67 offen offset:512 sc1 lds
s_waitcnt vmcnt(4)
s_barrier
ds_read_b128 v[104:107],v4 offset:0
ds_read_b128 v[108:111],v4 offset:4096
ds_read_b128 v[112:115],v5 offset:0
ds_read_b128 v[116:119],v5 offset:4096
s_add_u32 m0,s50,154880
s_nop 0
buffer_load_dwordx4 v2,s[8:11],s66 offen offset:768 sc1 lds
s_add_u32 m0,s50,158976
s_nop 0
buffer_load_dwordx4 v3,s[8:11],s67 offen offset:768 sc1 lds
s_waitcnt lgkmcnt(2)
v_mfma_f32_16x16x32_bf16 v[24:27],a[128:131],v[104:107],0
ds_read_b128 v[120:123],v6 offset:0
v_mfma_f32_16x16x32_bf16 v[40:43],v[104:107],v[128:131],0
s_lshl_b32 s58,s51,5
v_mfma_f32_16x16x32_bf16 v[28:31],a[128:131],v[108:111],0
ds_read_b128 v[124:127],v6 offset:4096
v_mfma_f32_16x16x32_bf16 v[44:47],v[108:111],v[128:131],0
s_add_u32 s58,s58,s47
v_mfma_f32_16x16x32_bf16 v[32:35],a[136:139],v[104:107],0
s_mul_i32 s58,s58,24576
v_mfma_f32_16x16x32_bf16 v[48:51],v[104:107],v[136:139],0
s_add_u32 s58,s58,201326592
v_mfma_f32_16x16x32_bf16 v[36:39],a[136:139],v[108:111],0
s_add_u32 s61,s58,s50
v_mfma_f32_16x16x32_bf16 v[52:55],v[108:111],v[136:139],0
s_add_u32 s62,s61,4096
s_waitcnt lgkmcnt(2)
v_mfma_f32_16x16x32_bf16 v[24:27],a[132:135],v[112:115],v[24:27]
ds_read_b128 v[104:107],v7 offset:0
v_mfma_f32_16x16x32_bf16 v[40:43],v[112:115],v[132:135],v[40:43]
s_add_u32 s63,s61,16384
v_mfma_f32_16x16x32_bf16 v[28:31],a[132:135],v[116:119],v[28:31]
ds_read_b128 v[108:111],v7 offset:4096
v_mfma_f32_16x16x32_bf16 v[44:47],v[116:119],v[132:135],v[44:47]
s_add_u32 s64,s61,20480
v_mfma_f32_16x16x32_bf16 v[32:35],a[140:143],v[112:115],v[32:35]
s_add_u32 s65,s61,s50
v_mfma_f32_16x16x32_bf16 v[48:51],v[112:115],v[140:143],v[48:51]
s_add_u32 s65,s65,8192
v_mfma_f32_16x16x32_bf16 v[36:39],a[140:143],v[116:119],v[36:39]
v_mfma_f32_16x16x32_bf16 v[52:55],v[116:119],v[140:143],v[52:55]
s_waitcnt vmcnt(4)
s_barrier
s_waitcnt lgkmcnt(2)
v_mfma_f32_16x16x32_bf16 v[24:27],a[144:147],v[120:123],v[24:27]
ds_read_b128 v[112:115],v4 offset:8192
v_mfma_f32_16x16x32_bf16 v[40:43],v[120:123],v[144:147],v[40:43]
v_mfma_f32_16x16x32_bf16 v[28:31],a[144:147],v[124:127],v[28:31]
ds_read_b128 v[116:119],v4 offset:12288
v_mfma_f32_16x16x32_bf16 v[44:47],v[124:127],v[144:147],v[44:47]
v_mfma_f32_16x16x32_bf16 v[32:35],a[152:155],v[120:123],v[32:35]
v_mfma_f32_16x16x32_bf16 v[48:51],v[120:123],v[152:155],v[48:51]
v_mfma_f32_16x16x32_bf16 v[36:39],a[152:155],v[124:127],v[36:39]
v_mfma_f32_16x16x32_bf16 v[52:55],v[124:127],v[152:155],v[52:55]
s_waitcnt lgkmcnt(2)
v_mfma_f32_16x16x32_bf16 v[24:27],a[148:151],v[104:107],v[24:27]
ds_read_b128 v[120:123],v5 offset:8192
v_mfma_f32_16x16x32_bf16 v[40:43],v[104:107],v[148:151],v[40:43]
v_mfma_f32_16x16x32_bf16 v[28:31],a[148:151],v[108:111],v[28:31]
ds_read_b128 v[124:127],v5 offset:12288
v_mfma_f32_16x16x32_bf16 v[44:47],v[108:111],v[148:151],v[44:47]
v_mfma_f32_16x16x32_bf16 v[32:35],a[156:159],v[104:107],v[32:35]
v_mfma_f32_16x16x32_bf16 v[48:51],v[104:107],v[156:159],v[48:51]
v_mfma_f32_16x16x32_bf16 v[36:39],a[156:159],v[108:111],v[36:39]
v_mfma_f32_16x16x32_bf16 v[52:55],v[108:111],v[156:159],v[52:55]
s_waitcnt lgkmcnt(2)
v_mfma_f32_16x16x32_bf16 v[24:27],a[160:163],v[112:115],v[24:27]
ds_read_b128 v[104:107],v6 offset:8192
v_mfma_f32_16x16x32_bf16 v[40:43],v[112:115],v[160:163],v[40:43]
v_mfma_f32_16x16x32_bf16 v[28:31],a[160:163],v[116:119],v[28:31]
ds_read_b128 v[108:111],v6 offset:12288
v_mfma_f32_16x16x32_bf16 v[44:47],v[116:119],v[160:163],v[44:47]
v_mfma_f32_16x16x32_bf16 v[32:35],a[168:171],v[112:115],v[32:35]
v_mfma_f32_16x16x32_bf16 v[48:51],v[112:115],v[168:171],v[48:51]
v_mfma_f32_16x16x32_bf16 v[36:39],a[168:171],v[116:119],v[36:39]
v_mfma_f32_16x16x32_bf16 v[52:55],v[116:119],v[168:171],v[52:55]
s_waitcnt lgkmcnt(2)
v_mfma_f32_16x16x32_bf16 v[24:27],a[164:167],v[120:123],v[24:27]
ds_read_b128 v[112:115],v7 offset:8192
v_mfma_f32_16x16x32_bf16 v[40:43],v[120:123],v[164:167],v[40:43]
v_mfma_f32_16x16x32_bf16 v[28:31],a[164:167],v[124:127],v[28:31]
ds_read_b128 v[116:119],v7 offset:12288
v_mfma_f32_16x16x32_bf16 v[44:47],v[124:127],v[164:167],v[44:47]
v_mfma_f32_16x16x32_bf16 v[32:35],a[172:175],v[120:123],v[32:35]
v_mfma_f32_16x16x32_bf16 v[48:51],v[120:123],v[172:175],v[48:51]
v_mfma_f32_16x16x32_bf16 v[36:39],a[172:175],v[124:127],v[36:39]
v_mfma_f32_16x16x32_bf16 v[52:55],v[124:127],v[172:175],v[52:55]
s_waitcnt vmcnt(2)
s_barrier
s_waitcnt lgkmcnt(2)
v_mfma_f32_16x16x32_bf16 v[24:27],a[176:179],v[104:107],v[24:27]
ds_read_b128 v[120:123],v4 offset:16384
v_mfma_f32_16x16x32_bf16 v[40:43],v[104:107],v[176:179],v[40:43]
v_mfma_f32_16x16x32_bf16 v[28:31],a[176:179],v[108:111],v[28:31]
ds_read_b128 v[124:127],v4 offset:20480
v_mfma_f32_16x16x32_bf16 v[44:47],v[108:111],v[176:179],v[44:47]
v_mfma_f32_16x16x32_bf16 v[32:35],a[184:187],v[104:107],v[32:35]
v_mfma_f32_16x16x32_bf16 v[48:51],v[104:107],v[184:187],v[48:51]
v_mfma_f32_16x16x32_bf16 v[36:39],a[184:187],v[108:111],v[36:39]
v_mfma_f32_16x16x32_bf16 v[52:55],v[108:111],v[184:187],v[52:55]
s_waitcnt lgkmcnt(2)
v_mfma_f32_16x16x32_bf16 v[24:27],a[180:183],v[112:115],v[24:27]
ds_read_b128 v[104:107],v5 offset:16384
v_mfma_f32_16x16x32_bf16 v[40:43],v[112:115],v[180:183],v[40:43]
v_mfma_f32_16x16x32_bf16 v[28:31],a[180:183],v[116:119],v[28:31]
ds_read_b128 v[108:111],v5 offset:20480
v_mfma_f32_16x16x32_bf16 v[44:47],v[116:119],v[180:183],v[44:47]
v_mfma_f32_16x16x32_bf16 v[32:35],a[188:191],v[112:115],v[32:35]
v_mfma_f32_16x16x32_bf16 v[48:51],v[112:115],v[188:191],v[48:51]
v_mfma_f32_16x16x32_bf16 v[36:39],a[188:191],v[116:119],v[36:39]
v_mfma_f32_16x16x32_bf16 v[52:55],v[116:119],v[188:191],v[52:55]
s_waitcnt lgkmcnt(2)
v_mfma_f32_16x16x32_bf16 v[24:27],a[192:195],v[120:123],v[24:27]
ds_read_b128 v[112:115],v6 offset:16384
v_mfma_f32_16x16x32_bf16 v[40:43],v[120:123],v[192:195],v[40:43]
v_mfma_f32_16x16x32_bf16 v[28:31],a[192:195],v[124:127],v[28:31]
ds_read_b128 v[116:119],v6 offset:20480
v_mfma_f32_16x16x32_bf16 v[44:47],v[124:127],v[192:195],v[44:47]
v_mfma_f32_16x16x32_bf16 v[32:35],a[200:203],v[120:123],v[32:35]
v_mfma_f32_16x16x32_bf16 v[48:51],v[120:123],v[200:203],v[48:51]
v_mfma_f32_16x16x32_bf16 v[36:39],a[200:203],v[124:127],v[36:39]
v_mfma_f32_16x16x32_bf16 v[52:55],v[124:127],v[200:203],v[52:55]
s_waitcnt lgkmcnt(2)
v_mfma_f32_16x16x32_bf16 v[24:27],a[196:199],v[104:107],v[24:27]
ds_read_b128 v[120:123],v7 offset:16384
v_mfma_f32_16x16x32_bf16 v[40:43],v[104:107],v[196:199],v[40:43]
v_mfma_f32_16x16x32_bf16 v[28:31],a[196:199],v[108:111],v[28:31]
ds_read_b128 v[124:127],v7 offset:20480
v_mfma_f32_16x16x32_bf16 v[44:47],v[108:111],v[196:199],v[44:47]
v_mfma_f32_16x16x32_bf16 v[32:35],a[204:207],v[104:107],v[32:35]
v_mfma_f32_16x16x32_bf16 v[48:51],v[104:107],v[204:207],v[48:51]
v_mfma_f32_16x16x32_bf16 v[36:39],a[204:207],v[108:111],v[36:39]
v_mfma_f32_16x16x32_bf16 v[52:55],v[108:111],v[204:207],v[52:55]
s_waitcnt vmcnt(0)
s_barrier
s_waitcnt lgkmcnt(2)
v_mfma_f32_16x16x32_bf16 v[24:27],a[208:211],v[112:115],v[24:27]
ds_read_b128 v[104:107],v4 offset:24576
v_mfma_f32_16x16x32_bf16 v[40:43],v[112:115],v[208:211],v[40:43]
v_mfma_f32_16x16x32_bf16 v[28:31],a[208:211],v[116:119],v[28:31]
ds_read_b128 v[108:111],v4 offset:28672
v_mfma_f32_16x16x32_bf16 v[44:47],v[116:119],v[208:211],v[44:47]
v_mfma_f32_16x16x32_bf16 v[32:35],a[216:219],v[112:115],v[32:35]
v_mfma_f32_16x16x32_bf16 v[48:51],v[112:115],v[216:219],v[48:51]
v_mfma_f32_16x16x32_bf16 v[36:39],a[216:219],v[116:119],v[36:39]
v_mfma_f32_16x16x32_bf16 v[52:55],v[116:119],v[216:219],v[52:55]
s_waitcnt lgkmcnt(2)
v_mfma_f32_16x16x32_bf16 v[24:27],a[212:215],v[120:123],v[24:27]
ds_read_b128 v[112:115],v5 offset:24576
v_mfma_f32_16x16x32_bf16 v[40:43],v[120:123],v[212:215],v[40:43]
v_mfma_f32_16x16x32_bf16 v[28:31],a[212:215],v[124:127],v[28:31]
ds_read_b128 v[116:119],v5 offset:28672
v_mfma_f32_16x16x32_bf16 v[44:47],v[124:127],v[212:215],v[44:47]
v_mfma_f32_16x16x32_bf16 v[32:35],a[220:223],v[120:123],v[32:35]
v_mfma_f32_16x16x32_bf16 v[48:51],v[120:123],v[220:223],v[48:51]
v_mfma_f32_16x16x32_bf16 v[36:39],a[220:223],v[124:127],v[36:39]
v_mfma_f32_16x16x32_bf16 v[52:55],v[124:127],v[220:223],v[52:55]
s_waitcnt lgkmcnt(2)
v_mfma_f32_16x16x32_bf16 v[24:27],a[224:227],v[104:107],v[24:27]
ds_read_b128 v[120:123],v6 offset:24576
v_mfma_f32_16x16x32_bf16 v[40:43],v[104:107],v[224:227],v[40:43]
v_mfma_f32_16x16x32_bf16 v[28:31],a[224:227],v[108:111],v[28:31]
ds_read_b128 v[124:127],v6 offset:28672
v_mfma_f32_16x16x32_bf16 v[44:47],v[108:111],v[224:227],v[44:47]
v_mfma_f32_16x16x32_bf16 v[32:35],a[232:235],v[104:107],v[32:35]
v_mfma_f32_16x16x32_bf16 v[48:51],v[104:107],v[232:235],v[48:51]
v_mfma_f32_16x16x32_bf16 v[36:39],a[232:235],v[108:111],v[36:39]
v_mfma_f32_16x16x32_bf16 v[52:55],v[108:111],v[232:235],v[52:55]
s_waitcnt lgkmcnt(2)
v_mfma_f32_16x16x32_bf16 v[24:27],a[228:231],v[112:115],v[24:27]
ds_read_b128 v[104:107],v7 offset:24576
v_mfma_f32_16x16x32_bf16 v[40:43],v[112:115],v[228:231],v[40:43]
v_mfma_f32_16x16x32_bf16 v[28:31],a[228:231],v[116:119],v[28:31]
ds_read_b128 v[108:111],v7 offset:28672
v_mfma_f32_16x16x32_bf16 v[44:47],v[116:119],v[228:231],v[44:47]
v_mfma_f32_16x16x32_bf16 v[32:35],a[236:239],v[112:115],v[32:35]
v_mfma_f32_16x16x32_bf16 v[48:51],v[112:115],v[236:239],v[48:51]
v_mfma_f32_16x16x32_bf16 v[36:39],a[236:239],v[116:119],v[36:39]
v_mfma_f32_16x16x32_bf16 v[52:55],v[116:119],v[236:239],v[52:55]
s_waitcnt lgkmcnt(2)
v_mfma_f32_16x16x32_bf16 v[24:27],a[240:243],v[120:123],v[24:27]
ds_read_b128 v[112:115],v4 offset:0
v_mfma_f32_16x16x32_bf16 v[40:43],v[120:123],v[240:243],v[40:43]
v_mfma_f32_16x16x32_bf16 v[28:31],a[240:243],v[124:127],v[28:31]
ds_read_b128 v[116:119],v4 offset:4096
v_mfma_f32_16x16x32_bf16 v[44:47],v[124:127],v[240:243],v[44:47]
v_mfma_f32_16x16x32_bf16 v[32:35],a[248:251],v[120:123],v[32:35]
v_mfma_f32_16x16x32_bf16 v[48:51],v[120:123],v[248:251],v[48:51]
v_mfma_f32_16x16x32_bf16 v[36:39],a[248:251],v[124:127],v[36:39]
v_mfma_f32_16x16x32_bf16 v[52:55],v[124:127],v[248:251],v[52:55]
s_waitcnt lgkmcnt(2)
v_mfma_f32_16x16x32_bf16 v[24:27],a[244:247],v[104:107],v[24:27]
ds_read_b128 v[120:123],v5 offset:0
v_mfma_f32_16x16x32_bf16 v[40:43],v[104:107],v[244:247],v[40:43]
v_mfma_f32_16x16x32_bf16 v[28:31],a[244:247],v[108:111],v[28:31]
ds_read_b128 v[124:127],v5 offset:4096
v_mfma_f32_16x16x32_bf16 v[44:47],v[108:111],v[244:247],v[44:47]
v_mfma_f32_16x16x32_bf16 v[32:35],a[252:255],v[104:107],v[32:35]
v_mfma_f32_16x16x32_bf16 v[48:51],v[104:107],v[252:255],v[48:51]
v_mfma_f32_16x16x32_bf16 v[36:39],a[252:255],v[108:111],v[36:39]
v_mfma_f32_16x16x32_bf16 v[52:55],v[108:111],v[252:255],v[52:55]
s_waitcnt lgkmcnt(2)
v_mfma_f32_16x16x32_bf16 v[88:91],a[0:3],v[112:115],0
ds_read_b128 v[104:107],v6 offset:0
v_mfma_f32_16x16x32_bf16 v[92:95],a[0:3],v[116:119],0
v_mfma_f32_16x16x32_bf16 v[96:99],a[8:11],v[112:115],0
ds_read_b128 v[108:111],v6 offset:4096
v_cvt_pk_bf16_f32 v56,v24,v32
v_cvt_pk_bf16_f32 v57,v25,v33
v_mfma_f32_16x16x32_bf16 v[100:103],a[8:11],v[116:119],0
v_cvt_pk_bf16_f32 v58,v26,v34
v_cvt_pk_bf16_f32 v59,v27,v35
s_waitcnt lgkmcnt(2)
v_mfma_f32_16x16x32_bf16 v[88:91],a[4:7],v[120:123],v[88:91]
ds_read_b128 v[112:115],v7 offset:0
v_mfma_f32_16x16x32_bf16 v[92:95],a[4:7],v[124:127],v[92:95]
buffer_store_dwordx4 v[56:59],v0,s[8:11],s61 offen sc1
v_cvt_pk_bf16_f32 v60,v28,v36
v_cvt_pk_bf16_f32 v61,v29,v37
v_mfma_f32_16x16x32_bf16 v[96:99],a[12:15],v[120:123],v[96:99]
ds_read_b128 v[116:119],v7 offset:4096
v_cvt_pk_bf16_f32 v62,v30,v38
v_cvt_pk_bf16_f32 v63,v31,v39
v_mfma_f32_16x16x32_bf16 v[100:103],a[12:15],v[124:127],v[100:103]
buffer_store_dwordx4 v[60:63],v0,s[8:11],s62 offen sc1
v_cvt_pk_bf16_f32 v64,v40,v41
v_cvt_pk_bf16_f32 v65,v42,v43
s_waitcnt lgkmcnt(2)
v_mfma_f32_16x16x32_bf16 v[88:91],a[16:19],v[104:107],v[88:91]
ds_read_b128 v[120:123],v4 offset:8192
v_cvt_pk_bf16_f32 v66,v44,v45
v_cvt_pk_bf16_f32 v67,v46,v47
v_mfma_f32_16x16x32_bf16 v[92:95],a[16:19],v[108:111],v[92:95]
buffer_store_dwordx4 v[64:67],v0,s[8:11],s65 offen offset:0 sc1
v_cvt_pk_bf16_f32 v68,v48,v49
v_cvt_pk_bf16_f32 v69,v50,v51
v_mfma_f32_16x16x32_bf16 v[96:99],a[24:27],v[104:107],v[96:99]
ds_read_b128 v[124:127],v4 offset:12288
v_cvt_pk_bf16_f32 v70,v52,v53
v_cvt_pk_bf16_f32 v71,v54,v55
v_mfma_f32_16x16x32_bf16 v[100:103],a[24:27],v[108:111],v[100:103]
buffer_store_dwordx4 v[68:71],v0,s[8:11],s65 offen offset:1024 sc1
s_waitcnt lgkmcnt(2)
v_mfma_f32_16x16x32_bf16 v[88:91],a[20:23],v[112:115],v[88:91]
ds_read_b128 v[104:107],v5 offset:8192
v_mfma_f32_16x16x32_bf16 v[92:95],a[20:23],v[116:119],v[92:95]
v_mfma_f32_16x16x32_bf16 v[96:99],a[28:31],v[112:115],v[96:99]
ds_read_b128 v[108:111],v5 offset:12288
v_mfma_f32_16x16x32_bf16 v[100:103],a[28:31],v[116:119],v[100:103]
s_waitcnt lgkmcnt(2)
v_mfma_f32_16x16x32_bf16 v[88:91],a[32:35],v[120:123],v[88:91]
ds_read_b128 v[112:115],v6 offset:8192
v_mfma_f32_16x16x32_bf16 v[92:95],a[32:35],v[124:127],v[92:95]
v_mfma_f32_16x16x32_bf16 v[96:99],a[40:43],v[120:123],v[96:99]
ds_read_b128 v[116:119],v6 offset:12288
v_mfma_f32_16x16x32_bf16 v[100:103],a[40:43],v[124:127],v[100:103]
s_waitcnt lgkmcnt(2)
v_mfma_f32_16x16x32_bf16 v[88:91],a[36:39],v[104:107],v[88:91]
ds_read_b128 v[120:123],v7 offset:8192
v_mfma_f32_16x16x32_bf16 v[92:95],a[36:39],v[108:111],v[92:95]
v_mfma_f32_16x16x32_bf16 v[96:99],a[44:47],v[104:107],v[96:99]
ds_read_b128 v[124:127],v7 offset:12288
v_mfma_f32_16x16x32_bf16 v[100:103],a[44:47],v[108:111],v[100:103]
s_waitcnt lgkmcnt(2)
v_mfma_f32_16x16x32_bf16 v[88:91],a[48:51],v[112:115],v[88:91]
ds_read_b128 v[104:107],v4 offset:16384
v_mfma_f32_16x16x32_bf16 v[92:95],a[48:51],v[116:119],v[92:95]
v_mfma_f32_16x16x32_bf16 v[96:99],a[56:59],v[112:115],v[96:99]
ds_read_b128 v[108:111],v4 offset:20480
v_mfma_f32_16x16x32_bf16 v[100:103],a[56:59],v[116:119],v[100:103]
s_waitcnt lgkmcnt(2)
v_mfma_f32_16x16x32_bf16 v[88:91],a[52:55],v[120:123],v[88:91]
ds_read_b128 v[112:115],v5 offset:16384
v_mfma_f32_16x16x32_bf16 v[92:95],a[52:55],v[124:127],v[92:95]
v_mfma_f32_16x16x32_bf16 v[96:99],a[60:63],v[120:123],v[96:99]
ds_read_b128 v[116:119],v5 offset:20480
v_mfma_f32_16x16x32_bf16 v[100:103],a[60:63],v[124:127],v[100:103]
s_waitcnt lgkmcnt(2)
v_mfma_f32_16x16x32_bf16 v[88:91],a[64:67],v[104:107],v[88:91]
ds_read_b128 v[120:123],v6 offset:16384
v_mfma_f32_16x16x32_bf16 v[92:95],a[64:67],v[108:111],v[92:95]
v_mfma_f32_16x16x32_bf16 v[96:99],a[72:75],v[104:107],v[96:99]
ds_read_b128 v[124:127],v6 offset:20480
v_mfma_f32_16x16x32_bf16 v[100:103],a[72:75],v[108:111],v[100:103]
s_waitcnt lgkmcnt(2)
v_mfma_f32_16x16x32_bf16 v[88:91],a[68:71],v[112:115],v[88:91]
ds_read_b128 v[104:107],v7 offset:16384
v_mfma_f32_16x16x32_bf16 v[92:95],a[68:71],v[116:119],v[92:95]
v_mfma_f32_16x16x32_bf16 v[96:99],a[76:79],v[112:115],v[96:99]
ds_read_b128 v[108:111],v7 offset:20480
v_mfma_f32_16x16x32_bf16 v[100:103],a[76:79],v[116:119],v[100:103]
s_waitcnt lgkmcnt(2)
v_mfma_f32_16x16x32_bf16 v[88:91],a[80:83],v[120:123],v[88:91]
ds_read_b128 v[112:115],v4 offset:24576
v_mfma_f32_16x16x32_bf16 v[92:95],a[80:83],v[124:127],v[92:95]
v_mfma_f32_16x16x32_bf16 v[96:99],a[88:91],v[120:123],v[96:99]
ds_read_b128 v[116:119],v4 offset:28672
v_mfma_f32_16x16x32_bf16 v[100:103],a[88:91],v[124:127],v[100:103]
s_waitcnt lgkmcnt(2)
v_mfma_f32_16x16x32_bf16 v[88:91],a[84:87],v[104:107],v[88:91]
ds_read_b128 v[120:123],v5 offset:24576
v_mfma_f32_16x16x32_bf16 v[92:95],a[84:87],v[108:111],v[92:95]
v_mfma_f32_16x16x32_bf16 v[96:99],a[92:95],v[104:107],v[96:99]
ds_read_b128 v[124:127],v5 offset:28672
v_mfma_f32_16x16x32_bf16 v[100:103],a[92:95],v[108:111],v[100:103]
s_waitcnt lgkmcnt(2)
v_mfma_f32_16x16x32_bf16 v[88:91],a[96:99],v[112:115],v[88:91]
ds_read_b128 v[104:107],v6 offset:24576
v_mfma_f32_16x16x32_bf16 v[92:95],a[96:99],v[116:119],v[92:95]
v_mfma_f32_16x16x32_bf16 v[96:99],a[104:107],v[112:115],v[96:99]
ds_read_b128 v[108:111],v6 offset:28672
v_mfma_f32_16x16x32_bf16 v[100:103],a[104:107],v[116:119],v[100:103]
s_waitcnt lgkmcnt(2)
v_mfma_f32_16x16x32_bf16 v[88:91],a[100:103],v[120:123],v[88:91]
ds_read_b128 v[112:115],v7 offset:24576
v_mfma_f32_16x16x32_bf16 v[92:95],a[100:103],v[124:127],v[92:95]
v_mfma_f32_16x16x32_bf16 v[96:99],a[108:111],v[120:123],v[96:99]
ds_read_b128 v[116:119],v7 offset:28672
v_mfma_f32_16x16x32_bf16 v[100:103],a[108:111],v[124:127],v[100:103]
s_waitcnt lgkmcnt(2)
v_mfma_f32_16x16x32_bf16 v[88:91],a[112:115],v[104:107],v[88:91]
v_mfma_f32_16x16x32_bf16 v[92:95],a[112:115],v[108:111],v[92:95]
v_mfma_f32_16x16x32_bf16 v[96:99],a[120:123],v[104:107],v[96:99]
v_mfma_f32_16x16x32_bf16 v[100:103],a[120:123],v[108:111],v[100:103]
s_waitcnt lgkmcnt(0)
v_mfma_f32_16x16x32_bf16 v[88:91],a[116:119],v[112:115],v[88:91]
v_mfma_f32_16x16x32_bf16 v[92:95],a[116:119],v[116:119],v[92:95]
v_mfma_f32_16x16x32_bf16 v[96:99],a[124:127],v[112:115],v[96:99]
v_mfma_f32_16x16x32_bf16 v[100:103],a[124:127],v[116:119],v[100:103]
s_nop 3
v_cvt_pk_bf16_f32 v104,v88,v96
v_cvt_pk_bf16_f32 v105,v89,v97
v_cvt_pk_bf16_f32 v106,v90,v98
v_cvt_pk_bf16_f32 v107,v91,v99
v_cvt_pk_bf16_f32 v108,v92,v100
v_cvt_pk_bf16_f32 v109,v93,v101
v_cvt_pk_bf16_f32 v110,v94,v102
v_cvt_pk_bf16_f32 v111,v95,v103
buffer_store_dwordx4 v[104:107],v0,s[8:11],s63 offen sc1
buffer_store_dwordx4 v[108:111],v0,s[8:11],s64 offen sc1
s_waitcnt vmcnt(6)
s_barrier
s_add_u32 m0,s50,131072
s_nop 0
buffer_load_dwordx4 v20,s[8:11],s70 offen offset:0 sc1 lds
s_add_u32 m0,s50,135168
s_nop 0
buffer_load_dwordx4 v20,s[8:11],s71 offen offset:0 sc1 lds
s_add_u32 m0,s50,139008
s_nop 0
buffer_load_dwordx4 v20,s[8:11],s70 offen offset:256 sc1 lds
s_add_u32 m0,s50,143104
s_nop 0
buffer_load_dwordx4 v20,s[8:11],s71 offen offset:256 sc1 lds
s_add_u32 m0,s50,146944
s_nop 0
buffer_load_dwordx4 v20,s[8:11],s70 offen offset:512 sc1 lds
s_add_u32 m0,s50,151040
s_nop 0
buffer_load_dwordx4 v20,s[8:11],s71 offen offset:512 sc1 lds
s_lshl_b32 s59,s51,13
s_lshl2_add_u32 s59,s47,s59
s_add_u32 s59,s59,10487680
s_waitcnt vmcnt(0)
s_barrier
s_or_b32 s59,s59,s52
buffer_store_dword v17,off,s[8:11],s59 sc1
s_mov_b32 s72,0x80000000
s_mov_b32 s86,0
s_mov_b32 s19,1
s_mov_b32 s18,0
s_cmp_lt_u32 s31,64
s_cbranch_scc1 L_mo_388
L_mo_401:
s_mov_b32 s51,64
s_cmp_eq_u32 s47,31
s_cbranch_scc1 L_mf_412
v_and_b32 v9,15,v1
v_lshrrev_b32 v10,4,v1
v_and_b32 v124,1,v1
v_lshlrev_b32 v124,4,v124
v_mov_b32 v125,0xffff
v_lshlrev_b32 v125,v124,v125
v_lshrrev_b32 v124,2,v9
v_cmp_eq_u32 vcc,0,v124
s_nop 1
v_cndmask_b32 v12,0,v125,vcc
v_cmp_eq_u32 vcc,1,v124
s_nop 1
v_cndmask_b32 v13,0,v125,vcc
v_and_b32 v124,2,v1
v_cmp_eq_u32 vcc,0,v124
v_mov_b32 v14,0xeeee
v_mov_b32 v124,0x4444
v_cndmask_b32 v14,v14,v124,vcc
v_lshlrev_b32 v11,14,v10
v_lshl_add_u32 v11,v9,4,v11
s_lshl_b32 s65,s51,15
s_add_u32 s65,s65,92274688
s_lshl_b32 s62,s47,10
s_add_u32 s62,s62,s65
s_lshl_b32 s63,s47,16
s_lshl_b32 s60,s46,8
s_add_u32 s63,s63,s60
s_mov_b32 s4,s38
s_mov_b32 s5,s39
s_mov_b32 s6,1835008
s_mov_b32 s7,0x20000
buffer_load_dwordx4 v[24:27],v11,s[4:7],s63 offen offset:0
buffer_load_dwordx4 v[28:31],v11,s[4:7],s63 offen offset:1024
buffer_load_dwordx4 v[32:35],v11,s[4:7],s63 offen offset:2048
buffer_load_dwordx4 v[36:39],v11,s[4:7],s63 offen offset:3072
s_add_u32 s63,s63,4096
buffer_load_dwordx4 v[40:43],v11,s[4:7],s63 offen offset:0
buffer_load_dwordx4 v[44:47],v11,s[4:7],s63 offen offset:1024
buffer_load_dwordx4 v[48:51],v11,s[4:7],s63 offen offset:2048
buffer_load_dwordx4 v[52:55],v11,s[4:7],s63 offen offset:3072
s_add_u32 s63,s63,4096
buffer_load_dwordx4 v[56:59],v11,s[4:7],s63 offen offset:0
buffer_load_dwordx4 v[60:63],v11,s[4:7],s63 offen offset:1024
buffer_load_dwordx4 v[64:67],v11,s[4:7],s63 offen offset:2048
buffer_load_dwordx4 v[68:71],v11,s[4:7],s63 offen offset:3072
s_add_u32 s63,s63,4096
buffer_load_dwordx4 v[72:75],v11,s[4:7],s63 offen offset:0
buffer_load_dwordx4 v[76:79],v11,s[4:7],s63 offen offset:1024
buffer_load_dwordx4 v[80:83],v11,s[4:7],s63 offen offset:2048
buffer_load_dwordx4 v[84:87],v11,s[4:7],s63 offen offset:3072
ds_read_b128 a[0:3],v18 offset:0
ds_read_b128 a[4:7],v18 offset:1024
ds_read_b128 a[8:11],v18 offset:2048
ds_read_b128 a[12:15],v18 offset:3072
ds_read_b128 a[16:19],v18 offset:4096
ds_read_b128 a[20:23],v18 offset:5120
ds_read_b128 a[24:27],v18 offset:6144
ds_read_b128 a[28:31],v18 offset:7168
ds_read_b128 a[32:35],v18 offset:8192
ds_read_b128 a[36:39],v18 offset:9216
ds_read_b128 a[40:43],v18 offset:10240
ds_read_b128 a[44:47],v18 offset:11264
ds_read_b128 a[48:51],v18 offset:12288
ds_read_b128 a[52:55],v18 offset:13312
ds_read_b128 a[56:59],v18 offset:14336
ds_read_b128 a[60:63],v18 offset:15360
ds_read_b128 a[64:67],v18 offset:16384
ds_read_b128 a[68:71],v18 offset:17408
ds_read_b128 a[72:75],v18 offset:18432
ds_read_b128 a[76:79],v18 offset:19456
ds_read_b128 a[80:83],v18 offset:20480
ds_read_b128 a[84:87],v18 offset:21504
ds_read_b128 a[88:91],v18 offset:22528
ds_read_b128 a[92:95],v18 offset:23552
ds_read_b128 a[96:99],v18 offset:24576
ds_read_b128 a[100:103],v18 offset:25600
ds_read_b128 a[104:107],v18 offset:26624
ds_read_b128 a[108:111],v18 offset:27648
ds_read_b128 a[112:115],v18 offset:28672
ds_read_b128 a[116:119],v18 offset:29696
ds_read_b128 a[120:123],v18 offset:30720
ds_read_b128 a[124:127],v18 offset:31744
L_mf_413:
s_lshl_b32 s59,s51,13
s_lshl_b32 s61,s46,7
s_add_u32 s59,s59,s61
s_add_u32 s59,s59,10486272
L_ww_418:
s_sleep 1
buffer_load_dword v2,off,s[8:11],s59 sc1
s_sub_u32 s49,s49,1
s_cbranch_scc1 L_abort2
s_waitcnt vmcnt(0)
v_readfirstlane_b32 s55,v2
s_cmp_eq_u32 s55,0
s_cbranch_scc1 L_ww_418
L_wwd_419:
s_cmp_eq_u32 s55,1
s_cbranch_scc1 L_mf_414
s_barrier
s_andn2_b32 s64,0x7ff,s55
s_lshl_b32 s56,s64,10
s_add_u32 s58,s56,6291456
buffer_load_dwordx4 v[88:91],v0,s[8:11],s58 offen sc1
s_lshl_b32 s57,s46,11
s_add_u32 s57,s57,139264
v_add_u32 v8,s57,v0
v_and_b32 v2,1,v10
v_lshrrev_b32 v3,1,v10
v_lshlrev_b32 v2,7,v2
v_lshl_add_u32 v2,v3,10,v2
s_lshl_b32 s59,s46,8
s_add_u32 s59,s57,s59
v_add_u32 v2,s59,v2
s_mov_b32 s60,0x01000100
s_mov_b32 s61,0x03020302
s_waitcnt vmcnt(0)
v_lshlrev_b32 v96,16,v88
v_and_b32 v97,0xffff0000,v88
v_lshlrev_b32 v98,16,v89
v_and_b32 v99,0xffff0000,v89
v_lshlrev_b32 v100,16,v90
v_and_b32 v101,0xffff0000,v90
v_lshlrev_b32 v102,16,v91
v_and_b32 v103,0xffff0000,v91
v_readfirstlane_b32 s78,v96
s_nop 1
v_pk_add_f32 v[108:109],v[96:97],s[78:79] op_sel_hi:[1,0] neg_lo:[0,1] neg_hi:[0,1]
v_pk_add_f32 v[110:111],v[98:99],s[78:79] op_sel_hi:[1,0] neg_lo:[0,1] neg_hi:[0,1]
v_pk_add_f32 v[112:113],v[100:101],s[78:79] op_sel_hi:[1,0] neg_lo:[0,1] neg_hi:[0,1]
v_pk_add_f32 v[114:115],v[102:103],s[78:79] op_sel_hi:[1,0] neg_lo:[0,1] neg_hi:[0,1]
v_pk_add_f32 v[116:117],v[108:109],v[110:111]
v_pk_mul_f32 v[118:119],v[108:109],v[108:109]
v_pk_add_f32 v[120:121],v[112:113],v[114:115]
v_pk_fma_f32 v[118:119],v[110:111],v[110:111],v[118:119]
v_pk_add_f32 v[116:117],v[116:117],v[120:121]
v_pk_fma_f32 v[118:119],v[112:113],v[112:113],v[118:119]
v_add_f32 v116,v116,v117
v_pk_fma_f32 v[118:119],v[114:115],v[114:115],v[118:119]
v_add_f32 v118,v118,v119
s_nop 1
v_permlane32_swap_b32 v116,v118
v_add_f32 v116,v116,v118
s_nop 1
v_add_f32_dpp v116,v116,v116 row_ror:8 row_mask:0xf bank_mask:0xf
s_nop 1
v_add_f32_dpp v116,v116,v116 row_ror:4 row_mask:0xf bank_mask:0xf
s_nop 1
v_add_f32_dpp v116,v116,v116 row_ror:2 row_mask:0xf bank_mask:0xf
s_nop 1
v_add_f32_dpp v116,v116,v116 row_ror:1 row_mask:0xf bank_mask:0xf
v_mov_b32 v118,v116
s_nop 1
v_permlane16_swap_b32 v116,v118
v_add_f32 v116,v116,v118
v_mul_f32 v116,0x3b000000,v116
v_mov_b32 v118,v116
s_nop 1
v_permlane32_swap_b32 v116,v118
v_fma_f32 v118,-v116,v116,v118
v_add_f32 v116,s78,v116
v_max_f32 v118,0,v118
v_cvt_pk_bf16_f32 v118,v116,v118
v_lshlrev_b32 v116,16,v118
v_and_b32 v118,0xffff0000,v118
v_add_f32 v118,0x3727c5ac,v118
v_cvt_pk_bf16_f32 v118,v118,v118
v_and_b32 v118,0xffff0000,v118
v_sqrt_f32 v118,v118
v_pk_add_f32 v[108:109],v[96:97],v[116:117] op_sel_hi:[1,0] neg_lo:[0,1] neg_hi:[0,1]
v_pk_add_f32 v[110:111],v[98:99],v[116:117] op_sel_hi:[1,0] neg_lo:[0,1] neg_hi:[0,1]
v_pk_add_f32 v[112:113],v[100:101],v[116:117] op_sel_hi:[1,0] neg_lo:[0,1] neg_hi:[0,1]
v_pk_add_f32 v[114:115],v[102:103],v[116:117] op_sel_hi:[1,0] neg_lo:[0,1] neg_hi:[0,1]
v_cvt_pk_bf16_f32 v118,v118,v118
v_and_b32 v118,0xffff0000,v118
v_rcp_f32 v118,v118
v_cvt_pk_bf16_f32 v104,v108,v109
v_cvt_pk_bf16_f32 v105,v110,v111
v_cvt_pk_bf16_f32 v106,v112,v113
v_cvt_pk_bf16_f32 v107,v114,v115
v_lshlrev_b32 v108,16,v104
v_and_b32 v109,0xffff0000,v104
v_lshlrev_b32 v110,16,v105
v_and_b32 v111,0xffff0000,v105
v_lshlrev_b32 v112,16,v106
v_and_b32 v113,0xffff0000,v106
v_lshlrev_b32 v114,16,v107
v_and_b32 v115,0xffff0000,v107
v_pk_mul_f32 v[108:109],v[108:109],v[118:119] op_sel_hi:[1,0]
v_pk_mul_f32 v[110:111],v[110:111],v[118:119] op_sel_hi:[1,0]
v_pk_mul_f32 v[112:113],v[112:113],v[118:119] op_sel_hi:[1,0]
v_pk_mul_f32 v[114:115],v[114:115],v[118:119] op_sel_hi:[1,0]
v_cvt_pk_bf16_f32 v104,v108,v109
v_cvt_pk_bf16_f32 v105,v110,v111
v_cvt_pk_bf16_f32 v106,v112,v113
v_cvt_pk_bf16_f32 v107,v114,v115
v_perm_b32 v88,v104,v104,s60
v_perm_b32 v89,v105,v105,s60
v_perm_b32 v90,v106,v106,s60
v_perm_b32 v91,v107,v107,s60
ds_write_b128 v8,v[88:91]
v_perm_b32 v92,v104,v104,s61
v_perm_b32 v93,v105,v105,s61
v_perm_b32 v94,v106,v106,s61
v_perm_b32 v95,v107,v107,s61
ds_write_b128 v8,v[92:95] offset:1024
s_mov_b32 s58,s57
ds_read_b128 v[128:131],v2 offset:0
ds_read_b128 v[144:147],v2 offset:64
ds_read_b128 v[132:135],v2 offset:16
ds_read_b128 v[148:151],v2 offset:80
ds_read_b128 v[136:139],v2 offset:32
ds_read_b128 v[152:155],v2 offset:96
ds_read_b128 v[140:143],v2 offset:48
ds_read_b128 v[156:159],v2 offset:112
v_mov_b64 v[116:117],0
v_mov_b64 v[118:119],0
s_waitcnt lgkmcnt(6)
v_and_b32 v120,v12,v128
v_and_b32 v121,v13,v128
v_and_b32 v122,v12,v144
v_and_b32 v123,v13,v144
v_and_b32 v124,v12,v129
v_and_b32 v125,v13,v129
v_smfmac_f32_16x16x64_bf16 v[116:119],v[120:123],a[0:7],v14
v_and_b32 v126,v12,v145
v_and_b32 v127,v13,v145
v_and_b32 v120,v12,v130
v_and_b32 v121,v13,v130
v_smfmac_f32_16x16x64_bf16 v[116:119],v[124:127],a[8:15],v14
v_and_b32 v122,v12,v146
v_and_b32 v123,v13,v146
v_and_b32 v124,v12,v131
v_and_b32 v125,v13,v131
v_smfmac_f32_16x16x64_bf16 v[116:119],v[120:123],a[16:23],v14
v_and_b32 v126,v12,v147
v_and_b32 v127,v13,v147
s_waitcnt lgkmcnt(4)
v_and_b32 v120,v12,v132
v_and_b32 v121,v13,v132
v_smfmac_f32_16x16x64_bf16 v[116:119],v[124:127],a[24:31],v14
v_and_b32 v122,v12,v148
v_and_b32 v123,v13,v148
v_and_b32 v124,v12,v133
v_and_b32 v125,v13,v133
v_smfmac_f32_16x16x64_bf16 v[116:119],v[120:123],a[32:39],v14
v_and_b32 v126,v12,v149
v_and_b32 v127,v13,v149
v_and_b32 v120,v12,v134
v_and_b32 v121,v13,v134
v_smfmac_f32_16x16x64_bf16 v[116:119],v[124:127],a[40:47],v14
v_and_b32 v122,v12,v150
v_and_b32 v123,v13,v150
v_and_b32 v124,v12,v135
v_and_b32 v125,v13,v135
v_smfmac_f32_16x16x64_bf16 v[116:119],v[120:123],a[48:55],v14
v_and_b32 v126,v12,v151
v_and_b32 v127,v13,v151
s_waitcnt lgkmcnt(2)
v_and_b32 v120,v12,v136
v_and_b32 v121,v13,v136
v_smfmac_f32_16x16x64_bf16 v[116:119],v[124:127],a[56:63],v14
v_and_b32 v122,v12,v152
v_and_b32 v123,v13,v152
v_and_b32 v124,v12,v137
v_and_b32 v125,v13,v137
v_smfmac_f32_16x16x64_bf16 v[116:119],v[120:123],a[64:71],v14
v_and_b32 v126,v12,v153
v_and_b32 v127,v13,v153
v_and_b32 v120,v12,v138
v_and_b32 v121,v13,v138
v_smfmac_f32_16x16x64_bf16 v[116:119],v[124:127],a[72:79],v14
v_and_b32 v122,v12,v154
v_and_b32 v123,v13,v154
v_and_b32 v124,v12,v139
v_and_b32 v125,v13,v139
v_smfmac_f32_16x16x64_bf16 v[116:119],v[120:123],a[80:87],v14
v_and_b32 v126,v12,v155
v_and_b32 v127,v13,v155
s_waitcnt lgkmcnt(0)
v_and_b32 v120,v12,v140
v_and_b32 v121,v13,v140
v_smfmac_f32_16x16x64_bf16 v[116:119],v[124:127],a[88:95],v14
v_and_b32 v122,v12,v156
v_and_b32 v123,v13,v156
v_and_b32 v124,v12,v141
v_and_b32 v125,v13,v141
v_smfmac_f32_16x16x64_bf16 v[116:119],v[120:123],a[96:103],v14
v_and_b32 v126,v12,v157
v_and_b32 v127,v13,v157
v_and_b32 v120,v12,v142
v_and_b32 v121,v13,v142
v_smfmac_f32_16x16x64_bf16 v[116:119],v[124:127],a[104:111],v14
v_and_b32 v122,v12,v158
v_and_b32 v123,v13,v158
v_and_b32 v124,v12,v143
v_and_b32 v125,v13,v143
v_smfmac_f32_16x16x64_bf16 v[116:119],v[120:123],a[112:119],v14
v_and_b32 v126,v12,v159
v_and_b32 v127,v13,v159
s_nop 1
v_smfmac_f32_16x16x64_bf16 v[116:119],v[124:127],a[120:127],v14
v_lshlrev_b32 v8,5,v9
v_and_b32 v124,1,v10
v_lshl_add_u32 v8,v124,4,v8
v_lshrrev_b32 v124,1,v10
v_lshl_add_u32 v8,v124,11,v8
s_lshl_b32 s60,s46,9
s_add_u32 s60,s60,147456
v_add_u32 v8,s60,v8
ds_write_b128 v8,v[116:119]
v_lshlrev_b32 v8,2,v1
v_add_u32 v8,147456,v8
v_and_b32 v2,1,v1
v_lshrrev_b32 v3,1,v1
v_lshlrev_b32 v3,2,v3
v_lshl_add_u32 v2,v2,7,v3
v_add_u32 v2,s58,v2
v_lshlrev_b32 v3,6,v10
v_add_u32 v3,s58,v3
s_waitcnt lgkmcnt(0)
s_barrier
ds_read2st64_b32 v[88:89],v8 offset0:0 offset1:1
ds_read2st64_b32 v[90:91],v8 offset0:2 offset1:3
ds_read2st64_b32 v[92:93],v8 offset0:4 offset1:5
ds_read2st64_b32 v[94:95],v8 offset0:6 offset1:7
s_waitcnt lgkmcnt(0)
v_pk_add_f32 v[88:89],v[88:89],v[90:91]
v_pk_add_f32 v[92:93],v[92:93],v[94:95]
v_pk_add_f32 v[88:89],v[88:89],v[92:93]
v_cvt_pk_bf16_f32 v88,v88,v88
v_and_b32 v88,0xffff0000,v88
v_cvt_pk_bf16_f32 v89,v89,v89
v_and_b32 v89,0xffff0000,v89
v_mul_f32 v90,0xbfb8aa3b,v88
v_exp_f32 v90,v90
s_nop 0
v_add_f32 v90,1.0,v90
v_rcp_f32 v90,v90
s_nop 0
v_mul_f32 v88,v88,v90
v_cvt_pk_bf16_f32 v88,v88,v88
v_and_b32 v88,0xffff0000,v88
v_mul_f32 v88,v88,v89
v_cvt_pk_bf16_f32 v88,v88,v88
ds_write_b32 v2,v88
ds_read_b128 v[88:91],v3
ds_read_b128 v[108:111],v3 offset:32
ds_read_b128 v[92:95],v3 offset:16
ds_read_b128 v[112:115],v3 offset:48
v_mov_b64 v[116:117],0
v_mov_b64 v[118:119],0
s_waitcnt vmcnt(0) lgkmcnt(0)
v_and_b32 v120,v12,v88
v_and_b32 v121,v13,v88
v_and_b32 v122,v12,v108
v_and_b32 v123,v13,v108
v_and_b32 v124,v12,v89
v_and_b32 v125,v13,v89
v_smfmac_f32_16x16x64_bf16 v[116:119],v[120:123],v[24:31],v14
v_and_b32 v126,v12,v109
v_and_b32 v127,v13,v109
v_and_b32 v120,v12,v90
v_and_b32 v121,v13,v90
v_smfmac_f32_16x16x64_bf16 v[116:119],v[124:127],v[32:39],v14
v_and_b32 v122,v12,v110
v_and_b32 v123,v13,v110
v_and_b32 v124,v12,v91
v_and_b32 v125,v13,v91
v_smfmac_f32_16x16x64_bf16 v[116:119],v[120:123],v[40:47],v14
v_and_b32 v126,v12,v111
v_and_b32 v127,v13,v111
v_and_b32 v120,v12,v92
v_and_b32 v121,v13,v92
v_smfmac_f32_16x16x64_bf16 v[116:119],v[124:127],v[48:55],v14
v_and_b32 v122,v12,v112
v_and_b32 v123,v13,v112
v_and_b32 v124,v12,v93
v_and_b32 v125,v13,v93
v_smfmac_f32_16x16x64_bf16 v[116:119],v[120:123],v[56:63],v14
v_and_b32 v126,v12,v113
v_and_b32 v127,v13,v113
v_and_b32 v120,v12,v94
v_and_b32 v121,v13,v94
v_smfmac_f32_16x16x64_bf16 v[116:119],v[124:127],v[64:71],v14
v_and_b32 v122,v12,v114
v_and_b32 v123,v13,v114
v_and_b32 v124,v12,v95
v_and_b32 v125,v13,v95
v_smfmac_f32_16x16x64_bf16 v[116:119],v[120:123],v[72:79],v14
v_and_b32 v126,v12,v115
v_and_b32 v127,v13,v115
s_nop 1
v_smfmac_f32_16x16x64_bf16 v[116:119],v[124:127],v[80:87],v14
v_lshlrev_b32 v8,4,v9
v_and_b32 v124,1,v10
v_lshl_add_u32 v8,v124,3,v8
v_and_b32 v124,2,v10
v_lshl_add_u32 v8,v124,30,v8
s_lshl_b32 s60,s46,8
s_add_u32 s59,s62,s60
s_nop 0
v_cvt_pk_bf16_f32 v88,v116,v117
v_cvt_pk_bf16_f32 v89,v118,v119
buffer_store_dwordx2 v[88:89],v8,s[8:11],s59 offen sc1
s_lshl_b32 s59,s51,13
s_lshl2_add_u32 s59,s47,s59
s_add_u32 s59,s59,10486912
s_waitcnt vmcnt(0)
s_barrier
s_or_b32 s59,s59,s52
buffer_store_dword v17,off,s[8:11],s59 sc1
s_cmp_lg_u32 s47,0
s_cbranch_scc1 L_moed_420
s_lshl_b32 s59,s51,13
s_add_u32 s59,s59,10486912
v_and_b32 v124,31,v1
v_lshlrev_b32 v124,2,v124
L_fw_421:
buffer_load_dword v125,v124,s[8:11],s59 offen sc1
s_sub_u32 s49,s49,1
s_cbranch_scc1 L_abort2
s_waitcnt vmcnt(0)
v_cmp_eq_u32 vcc,0,v125
s_cbranch_vccnz L_fw_421
s_add_u32 s63,s65,0
buffer_load_dwordx4 v[168:171],v22,s[8:11],s63 offen sc1
s_add_u32 s63,s65,4096
buffer_load_dwordx4 v[172:175],v22,s[8:11],s63 offen sc1
s_add_u32 s63,s65,8192
buffer_load_dwordx4 v[176:179],v22,s[8:11],s63 offen sc1
s_add_u32 s63,s65,12288
buffer_load_dwordx4 v[180:183],v22,s[8:11],s63 offen sc1
s_add_u32 s63,s65,16384
buffer_load_dwordx4 v[184:187],v22,s[8:11],s63 offen sc1
s_add_u32 s63,s65,20480
buffer_load_dwordx4 v[188:191],v22,s[8:11],s63 offen sc1
s_add_u32 s63,s65,24576
buffer_load_dwordx4 v[192:195],v22,s[8:11],s63 offen sc1
s_add_u32 s63,s65,28672
buffer_load_dwordx4 v[196:199],v22,s[8:11],s63 offen sc1
v_and_b32 v208,15,v1
v_and_b32 v209,1,v1
v_lshlrev_b32 v209,4,v209
v_mov_b32 v210,0x3f80
v_lshlrev_b32 v210,v209,v210
v_lshrrev_b32 v208,1,v208
v_cmp_eq_u32 vcc,0,v208
s_nop 1
v_cndmask_b32 v200,0,v210,vcc
v_cmp_eq_u32 vcc,1,v208
s_nop 1
v_cndmask_b32 v201,0,v210,vcc
v_cmp_eq_u32 vcc,2,v208
s_nop 1
v_cndmask_b32 v202,0,v210,vcc
v_cmp_eq_u32 vcc,3,v208
s_nop 1
v_cndmask_b32 v203,0,v210,vcc
s_waitcnt vmcnt(7)
s_nop 0
v_mfma_f32_16x16x32_bf16 v[204:207],v[200:203],v[168:171],0
s_waitcnt vmcnt(6)
v_mfma_f32_16x16x32_bf16 v[204:207],v[200:203],v[172:175],v[204:207]
s_waitcnt vmcnt(5)
v_mfma_f32_16x16x32_bf16 v[204:207],v[200:203],v[176:179],v[204:207]
s_waitcnt vmcnt(4)
v_mfma_f32_16x16x32_bf16 v[204:207],v[200:203],v[180:183],v[204:207]
s_waitcnt vmcnt(3)
v_mfma_f32_16x16x32_bf16 v[204:207],v[200:203],v[184:187],v[204:207]
s_waitcnt vmcnt(2)
v_mfma_f32_16x16x32_bf16 v[204:207],v[200:203],v[188:191],v[204:207]
s_waitcnt vmcnt(1)
v_mfma_f32_16x16x32_bf16 v[204:207],v[200:203],v[192:195],v[204:207]
s_waitcnt vmcnt(0)
v_mfma_f32_16x16x32_bf16 v[204:207],v[200:203],v[196:199],v[204:207]
s_nop 7
ds_write_b128 v21,v[204:207]
s_waitcnt lgkmcnt(0)
s_barrier
s_cmp_lg_u32 s46,0
s_cbranch_scc1 L_moed_420
v_lshlrev_b32 v200,5,v1
v_add_u32 v200,155648,v200
ds_read_b128 v[168:171],v200
ds_read_b128 v[172:175],v200 offset:16
s_and_b32 s59,s55,0xffff0000
s_xor_b32 s60,s59,0x80000000
s_xor_b32 s61,s59,0xffff0000
s_cmp_lt_i32 s59,0
s_cselect_b32 s59,s60,s61
v_mov_b32 v200,s59
v_mul_f32 v200,0xbfb8aa3b,v200
v_exp_f32 v200,v200
s_nop 0
v_add_f32 v200,1.0,v200
v_rcp_f32 v200,v200
s_nop 0
v_cvt_pk_bf16_f32 v200,v200,v200
v_and_b32 v200,0xffff0000,v200
v_lshlrev_b32 v192,16,v104
v_and_b32 v193,0xffff0000,v104
v_lshlrev_b32 v194,16,v105
v_and_b32 v195,0xffff0000,v105
v_lshlrev_b32 v196,16,v106
v_and_b32 v197,0xffff0000,v106
v_lshlrev_b32 v198,16,v107
v_and_b32 v199,0xffff0000,v107
s_waitcnt lgkmcnt(0)
v_cvt_pk_bf16_f32 v184,v168,v169
v_cvt_pk_bf16_f32 v185,v170,v171
v_cvt_pk_bf16_f32 v186,v172,v173
v_cvt_pk_bf16_f32 v187,v174,v175
v_lshlrev_b32 v168,16,v184
v_and_b32 v169,0xffff0000,v184
v_lshlrev_b32 v170,16,v185
v_and_b32 v171,0xffff0000,v185
v_lshlrev_b32 v172,16,v186
v_and_b32 v173,0xffff0000,v186
v_lshlrev_b32 v174,16,v187
v_and_b32 v175,0xffff0000,v187
v_pk_mul_f32 v[168:169],v[168:169],v[200:201] op_sel_hi:[1,0]
v_pk_mul_f32 v[170:171],v[170:171],v[200:201] op_sel_hi:[1,0]
v_pk_mul_f32 v[172:173],v[172:173],v[200:201] op_sel_hi:[1,0]
v_pk_mul_f32 v[174:175],v[174:175],v[200:201] op_sel_hi:[1,0]
v_cvt_pk_bf16_f32 v184,v168,v169
v_cvt_pk_bf16_f32 v185,v170,v171
v_cvt_pk_bf16_f32 v186,v172,v173
v_cvt_pk_bf16_f32 v187,v174,v175
v_lshlrev_b32 v168,16,v184
v_and_b32 v169,0xffff0000,v184
v_lshlrev_b32 v170,16,v185
v_and_b32 v171,0xffff0000,v185
v_lshlrev_b32 v172,16,v186
v_and_b32 v173,0xffff0000,v186
v_lshlrev_b32 v174,16,v187
v_and_b32 v175,0xffff0000,v187
v_pk_add_f32 v[168:169],v[168:169],v[192:193]
v_pk_add_f32 v[170:171],v[170:171],v[194:195]
v_pk_add_f32 v[172:173],v[172:173],v[196:197]
v_pk_add_f32 v[174:175],v[174:175],v[198:199]
v_cvt_pk_bf16_f32 v184,v168,v169
v_cvt_pk_bf16_f32 v185,v170,v171
v_cvt_pk_bf16_f32 v186,v172,v173
v_cvt_pk_bf16_f32 v187,v174,v175
v_lshlrev_b32 v168,16,v184
v_and_b32 v169,0xffff0000,v184
v_lshlrev_b32 v170,16,v185
v_and_b32 v171,0xffff0000,v185
v_lshlrev_b32 v172,16,v186
v_and_b32 v173,0xffff0000,v186
v_lshlrev_b32 v174,16,v187
v_and_b32 v175,0xffff0000,v187
v_pk_add_f32 v[96:97],v[96:97],v[168:169]
v_pk_add_f32 v[98:99],v[98:99],v[170:171]
v_pk_add_f32 v[100:101],v[100:101],v[172:173]
v_pk_add_f32 v[102:103],v[102:103],v[174:175]
v_cvt_pk_bf16_f32 v160,v96,v97
v_cvt_pk_bf16_f32 v161,v98,v99
v_cvt_pk_bf16_f32 v162,v100,v101
v_cvt_pk_bf16_f32 v163,v102,v103
L_moed_420:
s_add_u32 s51,s51,1
s_add_u32 s62,s62,32768
s_add_u32 s65,s65,32768
s_branch L_mf_413
L_mf_414:
s_mov_b32 s4,s40
s_mov_b32 s5,s41
s_mov_b32 s6,2097152
s_mov_b32 s7,0x20000
s_or_b32 s61,s47,s46
s_cselect_b32 s56,0x80000000,s56
buffer_store_dwordx4 v[160:163],v0,s[4:7],s56 offen sc1
s_waitcnt vmcnt(0)
s_endpgm
L_mf_412:
s_cmp_lg_u32 s46,0
s_cbranch_scc1 L_mf_417
v_mov_b64 v[24:25],0
v_mov_b64 v[26:27],0
s_mov_b32 s56,94403584
buffer_store_dwordx4 v[24:27],v0,s[8:11],s56 offen sc1
s_mov_b32 s56,94436352
buffer_store_dwordx4 v[24:27],v0,s[8:11],s56 offen sc1
s_mov_b32 s56,94469120
buffer_store_dwordx4 v[24:27],v0,s[8:11],s56 offen sc1
s_mov_b32 s56,94501888
buffer_store_dwordx4 v[24:27],v0,s[8:11],s56 offen sc1
s_mov_b32 s56,94534656
buffer_store_dwordx4 v[24:27],v0,s[8:11],s56 offen sc1
s_mov_b32 s56,94567424
buffer_store_dwordx4 v[24:27],v0,s[8:11],s56 offen sc1
s_andn2_b32 s61,0x7ff,s54
s_lshr_b32 s61,s61,5
s_mov_b32 s59,11018240
v_lshlrev_b32 v2,2,v1
L_fp_424:
s_sleep 2
buffer_load_dword v3,v2,s[8:11],s59 offen sc1
s_sub_u32 s49,s49,1
s_cbranch_scc1 L_abort2
s_waitcnt vmcnt(0)
v_cmp_eq_u32 vcc,0,v3
s_cbranch_vccnz L_fp_424
v_cmp_le_u32 vcc,s61,v1
s_nop 1
v_cndmask_b32 v2,1,2,vcc
v_cmp_ne_u32 s[84:85],v2,v3
s_mov_b32 s56,11011324
buffer_store_dword v17,off,s[8:11],s56 sc1
s_mov_b32 s56,11019516
buffer_store_dword v17,off,s[8:11],s56 sc1
s_mov_b32 s56,11027708
buffer_store_dword v17,off,s[8:11],s56 sc1
s_mov_b32 s56,11035900
buffer_store_dword v17,off,s[8:11],s56 sc1
s_mov_b32 s56,11044092
buffer_store_dword v17,off,s[8:11],s56 sc1
s_mov_b32 s56,11052284
buffer_store_dword v17,off,s[8:11],s56 sc1
v_lshrrev_b32 v2,3,v1
v_and_b32 v3,0x70,v0
v_lshl_add_u32 v3,v2,13,v3
s_lshr_b64 s[20:21],s[84:85],0
v_lshrrev_b32 v60,v2,s20
v_and_b32 v60,1,v60
v_mul_u32_u24 v60,768,v60
v_sub_u32 v60,v3,v60
v_add_u32 v60,10487296,v60
s_lshr_b64 s[20:21],s[84:85],8
v_lshrrev_b32 v61,v2,s20
v_and_b32 v61,1,v61
v_mul_u32_u24 v61,768,v61
v_sub_u32 v61,v3,v61
v_add_u32 v61,10552832,v61
s_lshr_b64 s[20:21],s[84:85],16
v_lshrrev_b32 v62,v2,s20
v_and_b32 v62,1,v62
v_mul_u32_u24 v62,768,v62
v_sub_u32 v62,v3,v62
v_add_u32 v62,10618368,v62
s_lshr_b64 s[20:21],s[84:85],24
v_lshrrev_b32 v63,v2,s20
v_and_b32 v63,1,v63
v_mul_u32_u24 v63,768,v63
v_sub_u32 v63,v3,v63
v_add_u32 v63,10683904,v63
s_lshr_b64 s[20:21],s[84:85],32
v_lshrrev_b32 v64,v2,s20
v_and_b32 v64,1,v64
v_mul_u32_u24 v64,768,v64
v_sub_u32 v64,v3,v64
v_add_u32 v64,10749440,v64
s_lshr_b64 s[20:21],s[84:85],40
v_lshrrev_b32 v65,v2,s20
v_and_b32 v65,1,v65
v_mul_u32_u24 v65,768,v65
v_sub_u32 v65,v3,v65
v_add_u32 v65,10814976,v65
s_lshr_b64 s[20:21],s[84:85],48
v_lshrrev_b32 v66,v2,s20
v_and_b32 v66,1,v66
v_mul_u32_u24 v66,768,v66
v_sub_u32 v66,v3,v66
v_add_u32 v66,10880512,v66
s_lshr_b64 s[20:21],s[84:85],56
v_lshrrev_b32 v67,v2,s20
v_and_b32 v67,1,v67
v_mul_u32_u24 v67,768,v67
v_sub_u32 v67,v3,v67
v_add_u32 v67,10946048,v67
v_and_b32 v68,3,v1
v_lshlrev_b32 v68,7,v68
v_add_u32 v68,10486272,v68
v_and_b32 v69,31,v1
v_lshlrev_b32 v69,2,v69
v_add_u32 v69,10478720,v69
s_mov_b32 s66,0
s_mov_b32 s67,524288
L_mf_415:
buffer_load_dwordx4 v[24:27],v60,s[8:11],0 offen sc1
buffer_load_dwordx4 v[28:31],v61,s[8:11],0 offen sc1
buffer_load_dwordx4 v[32:35],v62,s[8:11],0 offen sc1
buffer_load_dwordx4 v[36:39],v63,s[8:11],0 offen sc1
buffer_load_dwordx4 v[40:43],v64,s[8:11],0 offen sc1
buffer_load_dwordx4 v[44:47],v65,s[8:11],0 offen sc1
buffer_load_dwordx4 v[48:51],v66,s[8:11],0 offen sc1
buffer_load_dwordx4 v[52:55],v67,s[8:11],0 offen sc1
buffer_load_dword v70,v69,s[8:11],s67 offen sc1
s_sub_u32 s49,s49,1
s_cbranch_scc1 L_abort2
s_mov_b32 s57,0
s_waitcnt vmcnt(8)
v_min3_u32 v56,v24,v25,v26
v_max3_u32 v57,v24,v25,v24
v_min_u32 v56,v27,v56
v_max3_u32 v57,v26,v27,v57
v_cmp_eq_u32 vcc,0,v56
s_bcnt1_i32_b64 s56,vcc
s_add_u32 s57,s57,s56
s_waitcnt vmcnt(7)
v_min3_u32 v56,v28,v29,v30
v_max3_u32 v57,v28,v29,v57
v_min_u32 v56,v31,v56
v_max3_u32 v57,v30,v31,v57
v_cmp_eq_u32 vcc,0,v56
s_bcnt1_i32_b64 s56,vcc
s_add_u32 s57,s57,s56
s_waitcnt vmcnt(6)
v_min3_u32 v56,v32,v33,v34
v_max3_u32 v57,v32,v33,v57
v_min_u32 v56,v35,v56
v_max3_u32 v57,v34,v35,v57
v_cmp_eq_u32 vcc,0,v56
s_bcnt1_i32_b64 s56,vcc
s_add_u32 s57,s57,s56
s_waitcnt vmcnt(5)
v_min3_u32 v56,v36,v37,v38
v_max3_u32 v57,v36,v37,v57
v_min_u32 v56,v39,v56
v_max3_u32 v57,v38,v39,v57
v_cmp_eq_u32 vcc,0,v56
s_bcnt1_i32_b64 s56,vcc
s_add_u32 s57,s57,s56
s_waitcnt vmcnt(4)
v_min3_u32 v56,v40,v41,v42
v_max3_u32 v57,v40,v41,v57
v_min_u32 v56,v43,v56
v_max3_u32 v57,v42,v43,v57
v_cmp_eq_u32 vcc,0,v56
s_bcnt1_i32_b64 s56,vcc
s_add_u32 s57,s57,s56
s_waitcnt vmcnt(3)
v_min3_u32 v56,v44,v45,v46
v_max3_u32 v57,v44,v45,v57
v_min_u32 v56,v47,v56
v_max3_u32 v57,v46,v47,v57
v_cmp_eq_u32 vcc,0,v56
s_bcnt1_i32_b64 s56,vcc
s_add_u32 s57,s57,s56
s_waitcnt vmcnt(2)
v_min3_u32 v56,v48,v49,v50
v_max3_u32 v57,v48,v49,v57
v_min_u32 v56,v51,v56
v_max3_u32 v57,v50,v51,v57
v_cmp_eq_u32 vcc,0,v56
s_bcnt1_i32_b64 s56,vcc
s_add_u32 s57,s57,s56
s_waitcnt vmcnt(1)
v_min3_u32 v56,v52,v53,v54
v_max3_u32 v57,v52,v53,v57
v_min_u32 v56,v55,v56
v_max3_u32 v57,v54,v55,v57
v_cmp_eq_u32 vcc,0,v56
s_bcnt1_i32_b64 s56,vcc
s_add_u32 s57,s57,s56
v_max_u32_dpp v57,v57,v57 row_ror:8 row_mask:0xf bank_mask:0xf
s_nop 1
v_max_u32_dpp v57,v57,v57 row_ror:4 row_mask:0xf bank_mask:0xf
s_nop 1
v_max_u32_dpp v57,v57,v57 row_ror:2 row_mask:0xf bank_mask:0xf
s_nop 1
v_max_u32_dpp v57,v57,v57 row_ror:1 row_mask:0xf bank_mask:0xf
v_mov_b32 v58,v57
s_nop 1
v_permlane16_swap_b32 v57,v58
v_max_u32 v57,v57,v58
v_mov_b32 v58,v57
s_nop 1
v_permlane32_swap_b32 v57,v58
v_max_u32 v57,v57,v58
s_nop 0
v_readfirstlane_b32 s55,v57
s_cmp_lg_u32 s55,s66
s_cbranch_scc1 L_mf_416
s_cmp_lg_u32 s57,0
s_cbranch_scc1 L_mf_415
v_mov_b32 v57,1
buffer_store_dword v57,v68,s[8:11],s67 offen sc1
L_mf_417:
s_waitcnt vmcnt(0)
s_endpgm
L_mf_416:
s_waitcnt vmcnt(0)
v_cmp_eq_u32 vcc,0,v70
s_cmp_eq_u32 s66,0
s_cselect_b32 s56,0,vcc_lo
s_cmp_gt_u32 s57,112
s_cselect_b32 s56,1,s56
s_cmp_ge_u32 s67,565248
s_cselect_b32 s56,1,s56
s_cmp_eq_u32 s57,0
s_cselect_b32 s56,0,s56
s_cmp_lg_u32 s56,0
s_cbranch_scc1 L_mf_415
buffer_store_dword v57,v68,s[8:11],s67 offen sc1
s_mov_b32 s66,s55
s_add_u32 s67,s67,8192
s_branch L_mf_415
s_endpgm
.section .rodata,"a"
.p2align 6
.amdhsa_kernel interleave_layers__memory_aug_recurrent_mem_tr__moe_arch_mod__prompt_kernel
  .amdhsa_next_free_vgpr 512
  .amdhsa_next_free_sgpr 102
  .amdhsa_accum_offset 256
  .amdhsa_group_segment_fixed_size 0
  .amdhsa_kernarg_size 120
  .amdhsa_user_sgpr_count 2
  .amdhsa_user_sgpr_kernarg_segment_ptr 1
  .amdhsa_system_sgpr_workgroup_id_x 1
  .amdhsa_float_denorm_mode_32 3
.end_amdhsa_kernel
```

```asm
; @launch grid=(256,1,1) block=(256,1,1) lds=163840
.amdgcn_target "amdgcn-amd-amdhsa--gfx950"
.text
.globl interleave_layers__memory_aug_recurrent_mem_tr__moe_arch_mod__prompt_kernel
.p2align 8
.type interleave_layers__memory_aug_recurrent_mem_tr__moe_arch_mod__prompt_kernel,@function
interleave_layers__memory_aug_recurrent_mem_tr__moe_arch_mod__prompt_kernel:
s_cmp_ge_u32 s2,256
s_cbranch_scc1 L_abort
s_load_dwordx16 s[16:31],s[0:1],0
s_load_dwordx8 s[32:39],s[0:1],64
s_load_dwordx4 s[40:43],s[0:1],96
s_load_dwordx2 s[44:45],s[0:1],112
v_lshrrev_b32 v2,6,v0
v_and_b32 v1,63,v0
v_readfirstlane_b32 s46,v2
v_lshlrev_b32 v0,4,v1
s_getreg_b32 s48,hwreg(HW_REG_XCC_ID)
s_and_b32 s48,s48,7
s_lshl_b32 s48,s48,2
s_lshr_b32 s48,1399931488,s48
s_and_b32 s48,s48,7
s_mov_b32 s49,100000
s_mov_b32 s80,0x3e0293ee
s_waitcnt lgkmcnt(0)
s_mov_b32 s8,s44
s_mov_b32 s9,s45
s_mov_b32 s10,268435456
s_mov_b32 s11,0x20000
s_mov_b32 s12,s42
s_mov_b32 s13,s43
s_mov_b32 s14,256
s_mov_b32 s15,0x20000
s_lshl_b32 s56,s48,2
s_lshr_b32 s56,2822958528,s56
s_and_b32 s56,s56,15
s_lshl_b32 s56,s56,4
v_mov_b32 v14,s56
v_mov_b32 v15,1
s_cmp_lg_u32 s46,0
s_cbranch_scc1 L_tk_1
s_cmp_ge_u32 s56,192
s_cbranch_scc1 L_tk_1
s_mov_b64 exec,1
buffer_atomic_add v15,v14,s[12:15],0 offen sc0
s_mov_b64 exec,-1
L_tk_1:
s_mov_b32 s4,s18
s_mov_b32 s5,s19
s_mov_b32 s6,8192
s_mov_b32 s7,0x20000
s_cmp_ge_u32 s2,2
s_cbranch_scc1 L_m0_2
s_lshl_b32 s56,s2,2
s_add_u32 s56,s56,s46
v_bfe_u32 v2,v1,2,2
v_and_b32 v3,1,v1
v_lshl_add_u32 v2,v2,1,v3
v_lshlrev_b32 v2,10,v2
v_lshrrev_b32 v3,4,v1
v_lshl_add_u32 v2,v3,5,v2
v_and_b32 v3,2,v1
v_lshl_add_u32 v2,v3,1,v2
s_lshl_b32 s57,s56,7
buffer_load_dword v64,v2,s[4:7],s57 offen offset:0
buffer_load_dword v65,v2,s[4:7],s57 offen offset:8
buffer_load_dword v66,v2,s[4:7],s57 offen offset:16
buffer_load_dword v67,v2,s[4:7],s57 offen offset:24
L_m0_2:
s_mov_b32 s4,s16
s_mov_b32 s5,s17
s_mov_b32 s6,2097152
s_mov_b32 s7,0x20000
s_lshl_b32 s56,s2,3
s_lshl_b32 s65,s46,1
s_add_u32 s56,s56,s65
s_lshl_b32 s65,s56,10
buffer_load_dwordx4 v[24:27],v0,s[4:7],s65 offen
buffer_load_dwordx4 v[28:31],v0,s[4:7],s65 offen offset:1024
s_lshl_b32 s56,s2,12
s_lshl_b32 s57,s46,10
s_add_u32 s56,s56,s57
v_add_u32 v2,s56,v0
v_mov_b32 v4,-1
v_mov_b32 v5,-1
v_mov_b32 v6,-1
v_mov_b32 v7,-1
v_mov_b32 v8,0
v_mov_b32 v9,0
v_mov_b32 v10,0
v_mov_b32 v11,0
v_cmp_gt_u32 vcc,524288,v2
v_mov_b32 v3,14155776
v_mov_b32 v12,11542528
v_cndmask_b32 v3,v3,v12,vcc
v_add_u32 v3,v3,v2
s_mov_b32 s56,0
buffer_store_dwordx4 v[4:7],v3,s[8:11],s56 offen sc1
s_mov_b32 s56,1048576
buffer_store_dwordx4 v[4:7],v3,s[8:11],s56 offen sc1
s_mov_b32 s56,2097152
buffer_store_dwordx4 v[4:7],v3,s[8:11],s56 offen sc1
s_mov_b32 s56,4194304
buffer_store_dwordx4 v[4:7],v2,s[8:11],s56 offen sc1
s_mov_b32 s56,5242880
buffer_store_dwordx4 v[4:7],v2,s[8:11],s56 offen sc1
v_add_u32 v3,17309696,v2
v_mov_b32 v12,0x80000000
v_cndmask_b32 v3,v3,v12,vcc
buffer_store_dwordx4 v[4:7],v3,s[8:11],0 offen sc1
v_cmp_gt_u32 vcc,147456,v2
v_lshrrev_b32 v3,11,v2
v_lshlrev_b32 v3,13,v3
v_and_b32 v13,0x7ff,v2
v_add_u32 v3,v3,v13
v_add_u32 v3,10485760,v3
v_cndmask_b32 v3,v12,v3,vcc
buffer_store_dwordx4 v[8:11],v3,s[8:11],0 offen sc1
v_add_u32 v3,11075584,v2
v_lshrrev_b32 v13,16,v2
v_cmp_eq_u32 vcc,4,v13
s_nop 1
v_cndmask_b32 v3,v12,v3,vcc
buffer_store_dwordx4 v[4:7],v3,s[8:11],0 offen sc1
s_cmp_lg_u32 s46,0
s_cbranch_scc1 L_tk_3
s_mov_b64 exec,1
s_sub_u32 s56,s48,1
s_cmp_gt_u32 s56,2
s_cbranch_scc1 L_tk_3x
s_waitcnt vmcnt(8)
buffer_atomic_add v15,v14,s[12:15],0 offen sc0
s_waitcnt vmcnt(0)
L_tk_3x:
v_mov_b32 v14,159744
s_waitcnt vmcnt(10)
ds_write_b32 v14,v15
s_mov_b64 exec,-1
s_waitcnt lgkmcnt(0)
L_tk_3:
s_barrier
v_mov_b32 v14,159744
ds_read_b32 v2,v14
s_waitcnt lgkmcnt(0)
v_readfirstlane_b32 s47,v2
s_mov_b32 s3,0
s_cmp_ge_u32 s47,32
s_cselect_b32 s53,0x10001,1
s_and_b32 s47,s47,31
s_lshl_b32 s50,s46,10
s_cmp_eq_u32 s46,0
s_cselect_b32 s52,0,0x80000000
s_mov_b32 s28,0x3f803f80
s_mov_b32 s29,0x3f803f80
s_mov_b32 s51,0
s_bfe_u32 s56,s48,0x10001
s_and_b32 s57,s48,1
s_add_u32 s58,s56,6
s_sub_u32 s59,5,s57
s_cmp_ge_u32 s47,16
s_cselect_b32 s58,s58,s59
s_cselect_b32 s57,s57,s56
s_and_b32 s59,s47,15
s_lshl4_add_u32 s57,s57,s59
s_cmp_ge_u32 s48,4
s_cselect_b32 s48,s58,s48
s_cselect_b32 s47,s57,s47
L_roles:
s_lshl_b32 s56,1,s48
s_and_b32 s56,s56,6
s_cbranch_scc0 L_x_10
s_cmp_eq_u32 s53,0
s_cbranch_scc1 L_m0_11
s_waitcnt vmcnt(8)
v_lshlrev_b32 v32,16,v24
v_and_b32 v33,0xffff0000,v24
v_lshlrev_b32 v34,16,v25
v_and_b32 v35,0xffff0000,v25
v_lshlrev_b32 v36,16,v26
v_and_b32 v37,0xffff0000,v26
v_lshlrev_b32 v38,16,v27
v_and_b32 v39,0xffff0000,v27
v_readfirstlane_b32 s78,v32
s_nop 1
v_pk_add_f32 v[48:49],v[32:33],s[78:79] op_sel_hi:[1,0] neg_lo:[0,1] neg_hi:[0,1]
v_pk_add_f32 v[50:51],v[34:35],s[78:79] op_sel_hi:[1,0] neg_lo:[0,1] neg_hi:[0,1]
v_pk_add_f32 v[52:53],v[36:37],s[78:79] op_sel_hi:[1,0] neg_lo:[0,1] neg_hi:[0,1]
v_pk_add_f32 v[54:55],v[38:39],s[78:79] op_sel_hi:[1,0] neg_lo:[0,1] neg_hi:[0,1]
v_pk_add_f32 v[56:57],v[48:49],v[50:51]
v_pk_mul_f32 v[58:59],v[48:49],v[48:49]
v_pk_add_f32 v[60:61],v[52:53],v[54:55]
v_pk_fma_f32 v[58:59],v[50:51],v[50:51],v[58:59]
v_pk_add_f32 v[56:57],v[56:57],v[60:61]
v_pk_fma_f32 v[58:59],v[52:53],v[52:53],v[58:59]
v_add_f32 v56,v56,v57
v_pk_fma_f32 v[58:59],v[54:55],v[54:55],v[58:59]
v_add_f32 v58,v58,v59
s_nop 1
v_permlane32_swap_b32 v56,v58
v_add_f32 v56,v56,v58
s_nop 1
v_add_f32_dpp v56,v56,v56 row_ror:8 row_mask:0xf bank_mask:0xf
s_nop 1
v_add_f32_dpp v56,v56,v56 row_ror:4 row_mask:0xf bank_mask:0xf
s_nop 1
v_add_f32_dpp v56,v56,v56 row_ror:2 row_mask:0xf bank_mask:0xf
s_nop 1
v_add_f32_dpp v56,v56,v56 row_ror:1 row_mask:0xf bank_mask:0xf
v_mov_b32 v58,v56
s_nop 1
v_permlane16_swap_b32 v56,v58
v_add_f32 v56,v56,v58
v_mul_f32 v56,0x3b000000,v56
v_mov_b32 v58,v56
s_nop 1
v_permlane32_swap_b32 v56,v58
v_fma_f32 v58,-v56,v56,v58
v_add_f32 v56,s78,v56
v_max_f32 v58,0,v58
v_cvt_pk_bf16_f32 v58,v56,v58
v_lshlrev_b32 v56,16,v58
v_and_b32 v58,0xffff0000,v58
v_add_f32 v58,0x3727c5ac,v58
v_cvt_pk_bf16_f32 v58,v58,v58
v_and_b32 v58,0xffff0000,v58
v_sqrt_f32 v58,v58
v_pk_add_f32 v[48:49],v[32:33],v[56:57] op_sel_hi:[1,0] neg_lo:[0,1] neg_hi:[0,1]
v_pk_add_f32 v[50:51],v[34:35],v[56:57] op_sel_hi:[1,0] neg_lo:[0,1] neg_hi:[0,1]
v_pk_add_f32 v[52:53],v[36:37],v[56:57] op_sel_hi:[1,0] neg_lo:[0,1] neg_hi:[0,1]
v_pk_add_f32 v[54:55],v[38:39],v[56:57] op_sel_hi:[1,0] neg_lo:[0,1] neg_hi:[0,1]
v_cvt_pk_bf16_f32 v58,v58,v58
v_and_b32 v58,0xffff0000,v58
v_rcp_f32 v58,v58
v_cvt_pk_bf16_f32 v40,v48,v49
v_cvt_pk_bf16_f32 v41,v50,v51
v_cvt_pk_bf16_f32 v42,v52,v53
v_cvt_pk_bf16_f32 v43,v54,v55
v_lshlrev_b32 v48,16,v40
v_and_b32 v49,0xffff0000,v40
v_lshlrev_b32 v50,16,v41
v_and_b32 v51,0xffff0000,v41
v_lshlrev_b32 v52,16,v42
v_and_b32 v53,0xffff0000,v42
v_lshlrev_b32 v54,16,v43
v_and_b32 v55,0xffff0000,v43
v_pk_mul_f32 v[48:49],v[48:49],v[58:59] op_sel_hi:[1,0]
v_pk_mul_f32 v[50:51],v[50:51],v[58:59] op_sel_hi:[1,0]
v_pk_mul_f32 v[52:53],v[52:53],v[58:59] op_sel_hi:[1,0]
v_pk_mul_f32 v[54:55],v[54:55],v[58:59] op_sel_hi:[1,0]
v_cvt_pk_bf16_f32 v40,v48,v49
v_cvt_pk_bf16_f32 v41,v50,v51
v_cvt_pk_bf16_f32 v42,v52,v53
v_cvt_pk_bf16_f32 v43,v54,v55
buffer_store_dwordx4 v[40:43],v0,s[8:11],s65 offen offset:0 sc1
v_lshlrev_b32 v32,16,v28
v_and_b32 v33,0xffff0000,v28
v_lshlrev_b32 v34,16,v29
v_and_b32 v35,0xffff0000,v29
v_lshlrev_b32 v36,16,v30
v_and_b32 v37,0xffff0000,v30
v_lshlrev_b32 v38,16,v31
v_and_b32 v39,0xffff0000,v31
v_readfirstlane_b32 s78,v32
s_nop 1
v_pk_add_f32 v[48:49],v[32:33],s[78:79] op_sel_hi:[1,0] neg_lo:[0,1] neg_hi:[0,1]
v_pk_add_f32 v[50:51],v[34:35],s[78:79] op_sel_hi:[1,0] neg_lo:[0,1] neg_hi:[0,1]
v_pk_add_f32 v[52:53],v[36:37],s[78:79] op_sel_hi:[1,0] neg_lo:[0,1] neg_hi:[0,1]
v_pk_add_f32 v[54:55],v[38:39],s[78:79] op_sel_hi:[1,0] neg_lo:[0,1] neg_hi:[0,1]
v_pk_add_f32 v[56:57],v[48:49],v[50:51]
v_pk_mul_f32 v[58:59],v[48:49],v[48:49]
v_pk_add_f32 v[60:61],v[52:53],v[54:55]
v_pk_fma_f32 v[58:59],v[50:51],v[50:51],v[58:59]
v_pk_add_f32 v[56:57],v[56:57],v[60:61]
v_pk_fma_f32 v[58:59],v[52:53],v[52:53],v[58:59]
v_add_f32 v56,v56,v57
v_pk_fma_f32 v[58:59],v[54:55],v[54:55],v[58:59]
v_add_f32 v58,v58,v59
s_nop 1
v_permlane32_swap_b32 v56,v58
v_add_f32 v56,v56,v58
s_nop 1
v_add_f32_dpp v56,v56,v56 row_ror:8 row_mask:0xf bank_mask:0xf
s_nop 1
v_add_f32_dpp v56,v56,v56 row_ror:4 row_mask:0xf bank_mask:0xf
s_nop 1
v_add_f32_dpp v56,v56,v56 row_ror:2 row_mask:0xf bank_mask:0xf
s_nop 1
v_add_f32_dpp v56,v56,v56 row_ror:1 row_mask:0xf bank_mask:0xf
v_mov_b32 v58,v56
s_nop 1
v_permlane16_swap_b32 v56,v58
v_add_f32 v56,v56,v58
v_mul_f32 v56,0x3b000000,v56
v_mov_b32 v58,v56
s_nop 1
v_permlane32_swap_b32 v56,v58
v_fma_f32 v58,-v56,v56,v58
v_add_f32 v56,s78,v56
v_max_f32 v58,0,v58
v_cvt_pk_bf16_f32 v58,v56,v58
v_lshlrev_b32 v56,16,v58
v_and_b32 v58,0xffff0000,v58
v_add_f32 v58,0x3727c5ac,v58
v_cvt_pk_bf16_f32 v58,v58,v58
v_and_b32 v58,0xffff0000,v58
v_sqrt_f32 v58,v58
v_pk_add_f32 v[48:49],v[32:33],v[56:57] op_sel_hi:[1,0] neg_lo:[0,1] neg_hi:[0,1]
v_pk_add_f32 v[50:51],v[34:35],v[56:57] op_sel_hi:[1,0] neg_lo:[0,1] neg_hi:[0,1]
v_pk_add_f32 v[52:53],v[36:37],v[56:57] op_sel_hi:[1,0] neg_lo:[0,1] neg_hi:[0,1]
v_pk_add_f32 v[54:55],v[38:39],v[56:57] op_sel_hi:[1,0] neg_lo:[0,1] neg_hi:[0,1]
v_cvt_pk_bf16_f32 v58,v58,v58
v_and_b32 v58,0xffff0000,v58
v_rcp_f32 v58,v58
v_cvt_pk_bf16_f32 v44,v48,v49
v_cvt_pk_bf16_f32 v45,v50,v51
v_cvt_pk_bf16_f32 v46,v52,v53
v_cvt_pk_bf16_f32 v47,v54,v55
v_lshlrev_b32 v48,16,v44
v_and_b32 v49,0xffff0000,v44
v_lshlrev_b32 v50,16,v45
v_and_b32 v51,0xffff0000,v45
v_lshlrev_b32 v52,16,v46
v_and_b32 v53,0xffff0000,v46
v_lshlrev_b32 v54,16,v47
v_and_b32 v55,0xffff0000,v47
v_pk_mul_f32 v[48:49],v[48:49],v[58:59] op_sel_hi:[1,0]
v_pk_mul_f32 v[50:51],v[50:51],v[58:59] op_sel_hi:[1,0]
v_pk_mul_f32 v[52:53],v[52:53],v[58:59] op_sel_hi:[1,0]
v_pk_mul_f32 v[54:55],v[54:55],v[58:59] op_sel_hi:[1,0]
v_cvt_pk_bf16_f32 v44,v48,v49
v_cvt_pk_bf16_f32 v45,v50,v51
v_cvt_pk_bf16_f32 v46,v52,v53
v_cvt_pk_bf16_f32 v47,v54,v55
buffer_store_dwordx4 v[44:47],v0,s[8:11],s65 offen offset:1024 sc1
s_cmp_ge_u32 s2,2
s_cbranch_scc1 L_m0_11
v_lshrrev_b32 v12,3,v1
v_lshlrev_b32 v12,9,v12
v_and_b32 v13,7,v1
v_lshl_add_u32 v12,v13,4,v12
s_lshl_b32 s66,s2,2
s_add_u32 s66,s66,s46
s_and_b32 s67,s66,1
s_lshl_b32 s67,s67,8
s_and_b32 s68,s66,2
s_lshl_b32 s68,s68,6
s_add_u32 s67,s67,s68
s_and_b32 s68,s66,4
s_lshl_b32 s68,s68,10
s_add_u32 s67,s67,s68
s_add_u32 s68,s67,11534336
buffer_store_dwordx4 v[64:67],v12,s[8:11],s68 offen sc1
s_add_u32 s68,s67,12582912
buffer_store_dwordx4 v[64:67],v12,s[8:11],s68 offen sc1
s_add_u32 s68,s67,17825792
buffer_store_dwordx4 v[64:67],v12,s[8:11],s68 offen sc1
L_m0_11:
s_waitcnt vmcnt(0)
s_barrier
s_cmp_lg_u32 s46,0
s_cbranch_scc1 L_ar_12
v_mov_b32 v8,240
v_mov_b32 v9,s53
s_mov_b64 exec,1
buffer_atomic_add v9,v8,s[12:15],0 offen
s_mov_b64 exec,-1
L_ar_12:
s_mov_b32 s53,0
v_mov_b32 v123,159744
s_cmp_lg_u32 s46,0
s_cbranch_scc1 L_gbd_14
v_mov_b32 v124,240
L_gb_13:
buffer_load_dword v125,v124,s[12:15],0 offen sc1
s_waitcnt vmcnt(0)
v_readfirstlane_b32 s56,v125
ds_write_b32 v123,v125
s_bitcmp1_b32 s56,8
s_cbranch_scc1 L_gbd_14
s_sleep 4
s_sub_u32 s49,s49,1
s_cmp_gt_i32 s49,0
s_cbranch_scc1 L_gb_13
s_branch L_abort
L_gbd_14:
s_waitcnt lgkmcnt(0)
s_barrier
ds_read_b32 v125,v123
s_waitcnt lgkmcnt(0)
v_readfirstlane_b32 s56,v125
s_barrier
s_lshr_b32 s56,s56,16
s_andn2_b32 s56,s56,s3
s_cbranch_scc1 L_spread
L_x_10:
s_cmp_ge_u32 s48,6
s_cbranch_scc1 L_ra_6
v_lshrrev_b32 v2,2,v1
v_lshrrev_b32 v3,5,v1
v_xor_b32 v2,v2,v3
v_lshlrev_b32 v2,13,v2
v_and_b32 v3,3,v1
v_lshl_add_u32 v2,v3,4,v2
v_and_b32 v3,15,v1
v_lshlrev_b32 v3,2,v3
v_lshrrev_b32 v4,4,v1
v_lshl_add_u32 v3,v4,9,v3
v_and_b32 v4,1,v4
v_lshl_add_u32 v3,v4,6,v3
s_lshl_b32 s59,s46,15
s_cmp_lt_u32 s48,3
s_cselect_b32 s63,s46,0
s_lshl_b32 s56,s63,12
s_add_u32 s56,s59,s56
v_add_u32 v3,s56,v3
v_xor_b32 v4,64,v3
s_lshl_b32 s58,s47,8
s_lshl_b32 s56,s46,6
s_add_u32 s58,s58,s56
s_mov_b32 s61,0x05040100
s_mov_b32 s62,0x07060302
s_mov_b32 s4,s22
s_mov_b32 s5,s23
s_mov_b32 s6,4194304
s_mov_b32 s7,0x20000
s_xor_b32 m0,s59,0
s_xor_b32 s60,s58,0
buffer_load_dwordx4 v2,s[4:7],s60 offen lds
s_add_u32 m0,m0,1024
s_add_u32 s60,s60,131072
buffer_load_dwordx4 v2,s[4:7],s60 offen lds
s_xor_b32 m0,s59,2048
s_xor_b32 s60,s58,262144
buffer_load_dwordx4 v2,s[4:7],s60 offen lds
s_add_u32 m0,m0,1024
s_add_u32 s60,s60,131072
buffer_load_dwordx4 v2,s[4:7],s60 offen lds
s_xor_b32 m0,s59,4096
s_xor_b32 s60,s58,524288
buffer_load_dwordx4 v2,s[4:7],s60 offen lds
s_add_u32 m0,m0,1024
s_add_u32 s60,s60,131072
buffer_load_dwordx4 v2,s[4:7],s60 offen lds
s_xor_b32 m0,s59,6144
s_xor_b32 s60,s58,786432
buffer_load_dwordx4 v2,s[4:7],s60 offen lds
s_add_u32 m0,m0,1024
s_add_u32 s60,s60,131072
buffer_load_dwordx4 v2,s[4:7],s60 offen lds
s_xor_b32 m0,s59,8192
s_xor_b32 s60,s58,1048576
buffer_load_dwordx4 v2,s[4:7],s60 offen lds
s_add_u32 m0,m0,1024
s_add_u32 s60,s60,131072
buffer_load_dwordx4 v2,s[4:7],s60 offen lds
s_xor_b32 m0,s59,10240
s_xor_b32 s60,s58,1310720
buffer_load_dwordx4 v2,s[4:7],s60 offen lds
s_add_u32 m0,m0,1024
s_add_u32 s60,s60,131072
buffer_load_dwordx4 v2,s[4:7],s60 offen lds
s_xor_b32 m0,s59,12288
s_xor_b32 s60,s58,1572864
buffer_load_dwordx4 v2,s[4:7],s60 offen lds
s_add_u32 m0,m0,1024
s_add_u32 s60,s60,131072
buffer_load_dwordx4 v2,s[4:7],s60 offen lds
s_xor_b32 m0,s59,14336
s_xor_b32 s60,s58,1835008
buffer_load_dwordx4 v2,s[4:7],s60 offen lds
s_add_u32 m0,m0,1024
s_add_u32 s60,s60,131072
buffer_load_dwordx4 v2,s[4:7],s60 offen lds
s_xor_b32 m0,s59,16384
s_xor_b32 s60,s58,2097152
buffer_load_dwordx4 v2,s[4:7],s60 offen lds
s_add_u32 m0,m0,1024
s_add_u32 s60,s60,131072
buffer_load_dwordx4 v2,s[4:7],s60 offen lds
s_xor_b32 m0,s59,18432
s_xor_b32 s60,s58,2359296
buffer_load_dwordx4 v2,s[4:7],s60 offen lds
s_add_u32 m0,m0,1024
s_add_u32 s60,s60,131072
buffer_load_dwordx4 v2,s[4:7],s60 offen lds
s_xor_b32 m0,s59,20480
s_xor_b32 s60,s58,2621440
buffer_load_dwordx4 v2,s[4:7],s60 offen lds
s_add_u32 m0,m0,1024
s_add_u32 s60,s60,131072
buffer_load_dwordx4 v2,s[4:7],s60 offen lds
s_xor_b32 m0,s59,22528
s_xor_b32 s60,s58,2883584
buffer_load_dwordx4 v2,s[4:7],s60 offen lds
s_add_u32 m0,m0,1024
s_add_u32 s60,s60,131072
buffer_load_dwordx4 v2,s[4:7],s60 offen lds
s_xor_b32 m0,s59,24576
s_xor_b32 s60,s58,3145728
buffer_load_dwordx4 v2,s[4:7],s60 offen lds
s_add_u32 m0,m0,1024
s_add_u32 s60,s60,131072
buffer_load_dwordx4 v2,s[4:7],s60 offen lds
s_xor_b32 m0,s59,26624
s_xor_b32 s60,s58,3407872
buffer_load_dwordx4 v2,s[4:7],s60 offen lds
s_add_u32 m0,m0,1024
s_add_u32 s60,s60,131072
buffer_load_dwordx4 v2,s[4:7],s60 offen lds
s_xor_b32 m0,s59,28672
s_xor_b32 s60,s58,3670016
buffer_load_dwordx4 v2,s[4:7],s60 offen lds
s_add_u32 m0,m0,1024
s_add_u32 s60,s60,131072
buffer_load_dwordx4 v2,s[4:7],s60 offen lds
s_xor_b32 m0,s59,30720
s_xor_b32 s60,s58,3932160
buffer_load_dwordx4 v2,s[4:7],s60 offen lds
s_add_u32 m0,m0,1024
s_add_u32 s60,s60,131072
buffer_load_dwordx4 v2,s[4:7],s60 offen lds
s_cmp_eq_u32 s53,0
s_cbranch_scc1 L_m0_15
s_waitcnt vmcnt(40)
v_lshlrev_b32 v32,16,v24
v_and_b32 v33,0xffff0000,v24
v_lshlrev_b32 v34,16,v25
v_and_b32 v35,0xffff0000,v25
v_lshlrev_b32 v36,16,v26
v_and_b32 v37,0xffff0000,v26
v_lshlrev_b32 v38,16,v27
v_and_b32 v39,0xffff0000,v27
v_readfirstlane_b32 s78,v32
s_nop 1
v_pk_add_f32 v[48:49],v[32:33],s[78:79] op_sel_hi:[1,0] neg_lo:[0,1] neg_hi:[0,1]
v_pk_add_f32 v[50:51],v[34:35],s[78:79] op_sel_hi:[1,0] neg_lo:[0,1] neg_hi:[0,1]
v_pk_add_f32 v[52:53],v[36:37],s[78:79] op_sel_hi:[1,0] neg_lo:[0,1] neg_hi:[0,1]
v_pk_add_f32 v[54:55],v[38:39],s[78:79] op_sel_hi:[1,0] neg_lo:[0,1] neg_hi:[0,1]
v_pk_add_f32 v[56:57],v[48:49],v[50:51]
v_pk_mul_f32 v[58:59],v[48:49],v[48:49]
v_pk_add_f32 v[60:61],v[52:53],v[54:55]
v_pk_fma_f32 v[58:59],v[50:51],v[50:51],v[58:59]
v_pk_add_f32 v[56:57],v[56:57],v[60:61]
v_pk_fma_f32 v[58:59],v[52:53],v[52:53],v[58:59]
v_add_f32 v56,v56,v57
v_pk_fma_f32 v[58:59],v[54:55],v[54:55],v[58:59]
v_add_f32 v58,v58,v59
s_nop 1
v_permlane32_swap_b32 v56,v58
v_add_f32 v56,v56,v58
s_nop 1
v_add_f32_dpp v56,v56,v56 row_ror:8 row_mask:0xf bank_mask:0xf
s_nop 1
v_add_f32_dpp v56,v56,v56 row_ror:4 row_mask:0xf bank_mask:0xf
s_nop 1
v_add_f32_dpp v56,v56,v56 row_ror:2 row_mask:0xf bank_mask:0xf
s_nop 1
v_add_f32_dpp v56,v56,v56 row_ror:1 row_mask:0xf bank_mask:0xf
v_mov_b32 v58,v56
s_nop 1
v_permlane16_swap_b32 v56,v58
v_add_f32 v56,v56,v58
v_mul_f32 v56,0x3b000000,v56
v_mov_b32 v58,v56
s_nop 1
v_permlane32_swap_b32 v56,v58
v_fma_f32 v58,-v56,v56,v58
v_add_f32 v56,s78,v56
v_max_f32 v58,0,v58
v_cvt_pk_bf16_f32 v58,v56,v58
v_lshlrev_b32 v56,16,v58
v_and_b32 v58,0xffff0000,v58
v_add_f32 v58,0x3727c5ac,v58
v_cvt_pk_bf16_f32 v58,v58,v58
v_and_b32 v58,0xffff0000,v58
v_sqrt_f32 v58,v58
v_pk_add_f32 v[48:49],v[32:33],v[56:57] op_sel_hi:[1,0] neg_lo:[0,1] neg_hi:[0,1]
v_pk_add_f32 v[50:51],v[34:35],v[56:57] op_sel_hi:[1,0] neg_lo:[0,1] neg_hi:[0,1]
v_pk_add_f32 v[52:53],v[36:37],v[56:57] op_sel_hi:[1,0] neg_lo:[0,1] neg_hi:[0,1]
v_pk_add_f32 v[54:55],v[38:39],v[56:57] op_sel_hi:[1,0] neg_lo:[0,1] neg_hi:[0,1]
v_cvt_pk_bf16_f32 v58,v58,v58
v_and_b32 v58,0xffff0000,v58
v_rcp_f32 v58,v58
v_cvt_pk_bf16_f32 v40,v48,v49
v_cvt_pk_bf16_f32 v41,v50,v51
v_cvt_pk_bf16_f32 v42,v52,v53
v_cvt_pk_bf16_f32 v43,v54,v55
v_lshlrev_b32 v48,16,v40
v_and_b32 v49,0xffff0000,v40
v_lshlrev_b32 v50,16,v41
v_and_b32 v51,0xffff0000,v41
v_lshlrev_b32 v52,16,v42
v_and_b32 v53,0xffff0000,v42
v_lshlrev_b32 v54,16,v43
v_and_b32 v55,0xffff0000,v43
v_pk_mul_f32 v[48:49],v[48:49],v[58:59] op_sel_hi:[1,0]
v_pk_mul_f32 v[50:51],v[50:51],v[58:59] op_sel_hi:[1,0]
v_pk_mul_f32 v[52:53],v[52:53],v[58:59] op_sel_hi:[1,0]
v_pk_mul_f32 v[54:55],v[54:55],v[58:59] op_sel_hi:[1,0]
v_cvt_pk_bf16_f32 v40,v48,v49
v_cvt_pk_bf16_f32 v41,v50,v51
v_cvt_pk_bf16_f32 v42,v52,v53
v_cvt_pk_bf16_f32 v43,v54,v55
buffer_store_dwordx4 v[40:43],v0,s[8:11],s65 offen offset:0 sc1
v_lshlrev_b32 v32,16,v28
v_and_b32 v33,0xffff0000,v28
v_lshlrev_b32 v34,16,v29
v_and_b32 v35,0xffff0000,v29
v_lshlrev_b32 v36,16,v30
v_and_b32 v37,0xffff0000,v30
v_lshlrev_b32 v38,16,v31
v_and_b32 v39,0xffff0000,v31
v_readfirstlane_b32 s78,v32
s_nop 1
v_pk_add_f32 v[48:49],v[32:33],s[78:79] op_sel_hi:[1,0] neg_lo:[0,1] neg_hi:[0,1]
v_pk_add_f32 v[50:51],v[34:35],s[78:79] op_sel_hi:[1,0] neg_lo:[0,1] neg_hi:[0,1]
v_pk_add_f32 v[52:53],v[36:37],s[78:79] op_sel_hi:[1,0] neg_lo:[0,1] neg_hi:[0,1]
v_pk_add_f32 v[54:55],v[38:39],s[78:79] op_sel_hi:[1,0] neg_lo:[0,1] neg_hi:[0,1]
v_pk_add_f32 v[56:57],v[48:49],v[50:51]
v_pk_mul_f32 v[58:59],v[48:49],v[48:49]
v_pk_add_f32 v[60:61],v[52:53],v[54:55]
v_pk_fma_f32 v[58:59],v[50:51],v[50:51],v[58:59]
v_pk_add_f32 v[56:57],v[56:57],v[60:61]
v_pk_fma_f32 v[58:59],v[52:53],v[52:53],v[58:59]
v_add_f32 v56,v56,v57
v_pk_fma_f32 v[58:59],v[54:55],v[54:55],v[58:59]
v_add_f32 v58,v58,v59
s_nop 1
v_permlane32_swap_b32 v56,v58
v_add_f32 v56,v56,v58
s_nop 1
v_add_f32_dpp v56,v56,v56 row_ror:8 row_mask:0xf bank_mask:0xf
s_nop 1
v_add_f32_dpp v56,v56,v56 row_ror:4 row_mask:0xf bank_mask:0xf
s_nop 1
v_add_f32_dpp v56,v56,v56 row_ror:2 row_mask:0xf bank_mask:0xf
s_nop 1
v_add_f32_dpp v56,v56,v56 row_ror:1 row_mask:0xf bank_mask:0xf
v_mov_b32 v58,v56
s_nop 1
v_permlane16_swap_b32 v56,v58
v_add_f32 v56,v56,v58
v_mul_f32 v56,0x3b000000,v56
v_mov_b32 v58,v56
s_nop 1
v_permlane32_swap_b32 v56,v58
v_fma_f32 v58,-v56,v56,v58
v_add_f32 v56,s78,v56
v_max_f32 v58,0,v58
v_cvt_pk_bf16_f32 v58,v56,v58
v_lshlrev_b32 v56,16,v58
v_and_b32 v58,0xffff0000,v58
v_add_f32 v58,0x3727c5ac,v58
v_cvt_pk_bf16_f32 v58,v58,v58
v_and_b32 v58,0xffff0000,v58
v_sqrt_f32 v58,v58
v_pk_add_f32 v[48:49],v[32:33],v[56:57] op_sel_hi:[1,0] neg_lo:[0,1] neg_hi:[0,1]
v_pk_add_f32 v[50:51],v[34:35],v[56:57] op_sel_hi:[1,0] neg_lo:[0,1] neg_hi:[0,1]
v_pk_add_f32 v[52:53],v[36:37],v[56:57] op_sel_hi:[1,0] neg_lo:[0,1] neg_hi:[0,1]
v_pk_add_f32 v[54:55],v[38:39],v[56:57] op_sel_hi:[1,0] neg_lo:[0,1] neg_hi:[0,1]
v_cvt_pk_bf16_f32 v58,v58,v58
v_and_b32 v58,0xffff0000,v58
v_rcp_f32 v58,v58
v_cvt_pk_bf16_f32 v44,v48,v49
v_cvt_pk_bf16_f32 v45,v50,v51
v_cvt_pk_bf16_f32 v46,v52,v53
v_cvt_pk_bf16_f32 v47,v54,v55
v_lshlrev_b32 v48,16,v44
v_and_b32 v49,0xffff0000,v44
v_lshlrev_b32 v50,16,v45
v_and_b32 v51,0xffff0000,v45
v_lshlrev_b32 v52,16,v46
v_and_b32 v53,0xffff0000,v46
v_lshlrev_b32 v54,16,v47
v_and_b32 v55,0xffff0000,v47
v_pk_mul_f32 v[48:49],v[48:49],v[58:59] op_sel_hi:[1,0]
v_pk_mul_f32 v[50:51],v[50:51],v[58:59] op_sel_hi:[1,0]
v_pk_mul_f32 v[52:53],v[52:53],v[58:59] op_sel_hi:[1,0]
v_pk_mul_f32 v[54:55],v[54:55],v[58:59] op_sel_hi:[1,0]
v_cvt_pk_bf16_f32 v44,v48,v49
v_cvt_pk_bf16_f32 v45,v50,v51
v_cvt_pk_bf16_f32 v46,v52,v53
v_cvt_pk_bf16_f32 v47,v54,v55
buffer_store_dwordx4 v[44:47],v0,s[8:11],s65 offen offset:1024 sc1
s_cmp_ge_u32 s2,2
s_cbranch_scc1 L_m0_15
v_lshrrev_b32 v12,3,v1
v_lshlrev_b32 v12,9,v12
v_and_b32 v13,7,v1
v_lshl_add_u32 v12,v13,4,v12
s_lshl_b32 s66,s2,2
s_add_u32 s66,s66,s46
s_and_b32 s67,s66,1
s_lshl_b32 s67,s67,8
s_and_b32 s68,s66,2
s_lshl_b32 s68,s68,6
s_add_u32 s67,s67,s68
s_and_b32 s68,s66,4
s_lshl_b32 s68,s68,10
s_add_u32 s67,s67,s68
s_add_u32 s68,s67,11534336
buffer_store_dwordx4 v[64:67],v12,s[8:11],s68 offen sc1
s_add_u32 s68,s67,12582912
buffer_store_dwordx4 v[64:67],v12,s[8:11],s68 offen sc1
s_add_u32 s68,s67,17825792
buffer_store_dwordx4 v[64:67],v12,s[8:11],s68 offen sc1
L_m0_15:
s_waitcnt vmcnt(16)
v_xor_b32 v5,0,v3
v_xor_b32 v6,0,v4
ds_read2_b32 v[96:97],v5 offset1:32
ds_read2_b32 v[100:101],v6 offset1:32
ds_read2_b32 v[98:99],v5 offset0:64 offset1:96
ds_read2_b32 v[102:103],v6 offset0:64 offset1:96
v_xor_b32 v5,2048,v3
v_xor_b32 v6,2048,v4
ds_read2_b32 v[104:105],v5 offset1:32
ds_read2_b32 v[108:109],v6 offset1:32
ds_read2_b32 v[106:107],v5 offset0:64 offset1:96
ds_read2_b32 v[110:111],v6 offset0:64 offset1:96
s_waitcnt lgkmcnt(4)
v_perm_b32 v112,v100,v96,s61
v_perm_b32 v113,v101,v97,s61
v_perm_b32 v114,v102,v98,s61
v_perm_b32 v115,v103,v99,s61
v_perm_b32 v116,v100,v96,s62
v_perm_b32 v117,v101,v97,s62
v_perm_b32 v118,v102,v98,s62
v_perm_b32 v119,v103,v99,s62
v_accvgpr_write_b32 a128,v112
v_accvgpr_write_b32 a129,v113
v_accvgpr_write_b32 a130,v114
v_accvgpr_write_b32 a131,v115
v_accvgpr_write_b32 a136,v116
v_accvgpr_write_b32 a137,v117
v_accvgpr_write_b32 a138,v118
v_accvgpr_write_b32 a139,v119
v_xor_b32 v5,4096,v3
v_xor_b32 v6,4096,v4
ds_read2_b32 v[96:97],v5 offset1:32
ds_read2_b32 v[100:101],v6 offset1:32
ds_read2_b32 v[98:99],v5 offset0:64 offset1:96
ds_read2_b32 v[102:103],v6 offset0:64 offset1:96
s_waitcnt lgkmcnt(4)
v_perm_b32 v112,v108,v104,s61
v_perm_b32 v113,v109,v105,s61
v_perm_b32 v114,v110,v106,s61
v_perm_b32 v115,v111,v107,s61
v_perm_b32 v116,v108,v104,s62
v_perm_b32 v117,v109,v105,s62
v_perm_b32 v118,v110,v106,s62
v_perm_b32 v119,v111,v107,s62
v_accvgpr_write_b32 a132,v112
v_accvgpr_write_b32 a133,v113
v_accvgpr_write_b32 a134,v114
v_accvgpr_write_b32 a135,v115
v_accvgpr_write_b32 a140,v116
v_accvgpr_write_b32 a141,v117
v_accvgpr_write_b32 a142,v118
v_accvgpr_write_b32 a143,v119
v_xor_b32 v5,6144,v3
v_xor_b32 v6,6144,v4
ds_read2_b32 v[104:105],v5 offset1:32
ds_read2_b32 v[108:109],v6 offset1:32
ds_read2_b32 v[106:107],v5 offset0:64 offset1:96
ds_read2_b32 v[110:111],v6 offset0:64 offset1:96
s_waitcnt lgkmcnt(4)
v_perm_b32 v112,v100,v96,s61
v_perm_b32 v113,v101,v97,s61
v_perm_b32 v114,v102,v98,s61
v_perm_b32 v115,v103,v99,s61
v_perm_b32 v116,v100,v96,s62
v_perm_b32 v117,v101,v97,s62
v_perm_b32 v118,v102,v98,s62
v_perm_b32 v119,v103,v99,s62
v_accvgpr_write_b32 a144,v112
v_accvgpr_write_b32 a145,v113
v_accvgpr_write_b32 a146,v114
v_accvgpr_write_b32 a147,v115
v_accvgpr_write_b32 a152,v116
v_accvgpr_write_b32 a153,v117
v_accvgpr_write_b32 a154,v118
v_accvgpr_write_b32 a155,v119
v_xor_b32 v5,8192,v3
v_xor_b32 v6,8192,v4
ds_read2_b32 v[96:97],v5 offset1:32
ds_read2_b32 v[100:101],v6 offset1:32
ds_read2_b32 v[98:99],v5 offset0:64 offset1:96
ds_read2_b32 v[102:103],v6 offset0:64 offset1:96
s_waitcnt lgkmcnt(4)
v_perm_b32 v112,v108,v104,s61
v_perm_b32 v113,v109,v105,s61
v_perm_b32 v114,v110,v106,s61
v_perm_b32 v115,v111,v107,s61
v_perm_b32 v116,v108,v104,s62
v_perm_b32 v117,v109,v105,s62
v_perm_b32 v118,v110,v106,s62
v_perm_b32 v119,v111,v107,s62
v_accvgpr_write_b32 a148,v112
v_accvgpr_write_b32 a149,v113
v_accvgpr_write_b32 a150,v114
v_accvgpr_write_b32 a151,v115
v_accvgpr_write_b32 a156,v116
v_accvgpr_write_b32 a157,v117
v_accvgpr_write_b32 a158,v118
v_accvgpr_write_b32 a159,v119
v_xor_b32 v5,10240,v3
v_xor_b32 v6,10240,v4
ds_read2_b32 v[104:105],v5 offset1:32
ds_read2_b32 v[108:109],v6 offset1:32
ds_read2_b32 v[106:107],v5 offset0:64 offset1:96
ds_read2_b32 v[110:111],v6 offset0:64 offset1:96
s_waitcnt lgkmcnt(4)
v_perm_b32 v112,v100,v96,s61
v_perm_b32 v113,v101,v97,s61
v_perm_b32 v114,v102,v98,s61
v_perm_b32 v115,v103,v99,s61
v_perm_b32 v116,v100,v96,s62
v_perm_b32 v117,v101,v97,s62
v_perm_b32 v118,v102,v98,s62
v_perm_b32 v119,v103,v99,s62
v_accvgpr_write_b32 a160,v112
v_accvgpr_write_b32 a161,v113
v_accvgpr_write_b32 a162,v114
v_accvgpr_write_b32 a163,v115
v_accvgpr_write_b32 a168,v116
v_accvgpr_write_b32 a169,v117
v_accvgpr_write_b32 a170,v118
v_accvgpr_write_b32 a171,v119
v_xor_b32 v5,12288,v3
v_xor_b32 v6,12288,v4
ds_read2_b32 v[96:97],v5 offset1:32
ds_read2_b32 v[100:101],v6 offset1:32
ds_read2_b32 v[98:99],v5 offset0:64 offset1:96
ds_read2_b32 v[102:103],v6 offset0:64 offset1:96
s_waitcnt lgkmcnt(4)
v_perm_b32 v112,v108,v104,s61
v_perm_b32 v113,v109,v105,s61
v_perm_b32 v114,v110,v106,s61
v_perm_b32 v115,v111,v107,s61
v_perm_b32 v116,v108,v104,s62
v_perm_b32 v117,v109,v105,s62
v_perm_b32 v118,v110,v106,s62
v_perm_b32 v119,v111,v107,s62
v_accvgpr_write_b32 a164,v112
v_accvgpr_write_b32 a165,v113
v_accvgpr_write_b32 a166,v114
v_accvgpr_write_b32 a167,v115
v_accvgpr_write_b32 a172,v116
v_accvgpr_write_b32 a173,v117
v_accvgpr_write_b32 a174,v118
v_accvgpr_write_b32 a175,v119
v_xor_b32 v5,14336,v3
v_xor_b32 v6,14336,v4
ds_read2_b32 v[104:105],v5 offset1:32
ds_read2_b32 v[108:109],v6 offset1:32
ds_read2_b32 v[106:107],v5 offset0:64 offset1:96
ds_read2_b32 v[110:111],v6 offset0:64 offset1:96
s_waitcnt lgkmcnt(4)
v_perm_b32 v112,v100,v96,s61
v_perm_b32 v113,v101,v97,s61
v_perm_b32 v114,v102,v98,s61
v_perm_b32 v115,v103,v99,s61
v_perm_b32 v116,v100,v96,s62
v_perm_b32 v117,v101,v97,s62
v_perm_b32 v118,v102,v98,s62
v_perm_b32 v119,v103,v99,s62
v_accvgpr_write_b32 a176,v112
v_accvgpr_write_b32 a177,v113
v_accvgpr_write_b32 a178,v114
v_accvgpr_write_b32 a179,v115
v_accvgpr_write_b32 a184,v116
v_accvgpr_write_b32 a185,v117
v_accvgpr_write_b32 a186,v118
v_accvgpr_write_b32 a187,v119
s_waitcnt lgkmcnt(0)
s_mov_b32 s4,s24
s_mov_b32 s5,s25
s_mov_b32 s6,4194304
s_mov_b32 s7,0x20000
s_xor_b32 m0,s59,0
s_xor_b32 s60,s58,0
buffer_load_dwordx4 v2,s[4:7],s60 offen lds
s_add_u32 m0,m0,1024
s_add_u32 s60,s60,131072
buffer_load_dwordx4 v2,s[4:7],s60 offen lds
s_xor_b32 m0,s59,2048
s_xor_b32 s60,s58,262144
buffer_load_dwordx4 v2,s[4:7],s60 offen lds
s_add_u32 m0,m0,1024
s_add_u32 s60,s60,131072
buffer_load_dwordx4 v2,s[4:7],s60 offen lds
s_xor_b32 m0,s59,4096
s_xor_b32 s60,s58,524288
buffer_load_dwordx4 v2,s[4:7],s60 offen lds
s_add_u32 m0,m0,1024
s_add_u32 s60,s60,131072
buffer_load_dwordx4 v2,s[4:7],s60 offen lds
s_xor_b32 m0,s59,6144
s_xor_b32 s60,s58,786432
buffer_load_dwordx4 v2,s[4:7],s60 offen lds
s_add_u32 m0,m0,1024
s_add_u32 s60,s60,131072
buffer_load_dwordx4 v2,s[4:7],s60 offen lds
s_xor_b32 m0,s59,8192
s_xor_b32 s60,s58,1048576
buffer_load_dwordx4 v2,s[4:7],s60 offen lds
s_add_u32 m0,m0,1024
s_add_u32 s60,s60,131072
buffer_load_dwordx4 v2,s[4:7],s60 offen lds
s_xor_b32 m0,s59,10240
s_xor_b32 s60,s58,1310720
buffer_load_dwordx4 v2,s[4:7],s60 offen lds
s_add_u32 m0,m0,1024
s_add_u32 s60,s60,131072
buffer_load_dwordx4 v2,s[4:7],s60 offen lds
s_xor_b32 m0,s59,12288
s_xor_b32 s60,s58,1572864
buffer_load_dwordx4 v2,s[4:7],s60 offen lds
s_add_u32 m0,m0,1024
s_add_u32 s60,s60,131072
buffer_load_dwordx4 v2,s[4:7],s60 offen lds
s_xor_b32 m0,s59,14336
s_xor_b32 s60,s58,1835008
buffer_load_dwordx4 v2,s[4:7],s60 offen lds
s_add_u32 m0,m0,1024
s_add_u32 s60,s60,131072
buffer_load_dwordx4 v2,s[4:7],s60 offen lds
v_perm_b32 v112,v108,v104,s61
v_perm_b32 v113,v109,v105,s61
v_perm_b32 v114,v110,v106,s61
v_perm_b32 v115,v111,v107,s61
v_perm_b32 v116,v108,v104,s62
v_perm_b32 v117,v109,v105,s62
v_perm_b32 v118,v110,v106,s62
v_perm_b32 v119,v111,v107,s62
v_accvgpr_write_b32 a180,v112
v_accvgpr_write_b32 a181,v113
v_accvgpr_write_b32 a182,v114
v_accvgpr_write_b32 a183,v115
v_accvgpr_write_b32 a188,v116
v_accvgpr_write_b32 a189,v117
v_accvgpr_write_b32 a190,v118
v_accvgpr_write_b32 a191,v119
s_waitcnt vmcnt(16)
s_barrier
s_cmp_lg_u32 s46,0
s_cbranch_scc1 L_ar_16
v_mov_b32 v8,240
v_mov_b32 v9,s53
s_mov_b64 exec,1
buffer_atomic_add v9,v8,s[12:15],0 offen
s_mov_b64 exec,-1
L_ar_16:
s_mov_b32 s53,0
v_xor_b32 v5,16384,v3
v_xor_b32 v6,16384,v4
ds_read2_b32 v[96:97],v5 offset1:32
ds_read2_b32 v[100:101],v6 offset1:32
ds_read2_b32 v[98:99],v5 offset0:64 offset1:96
ds_read2_b32 v[102:103],v6 offset0:64 offset1:96
v_xor_b32 v5,18432,v3
v_xor_b32 v6,18432,v4
ds_read2_b32 v[104:105],v5 offset1:32
ds_read2_b32 v[108:109],v6 offset1:32
ds_read2_b32 v[106:107],v5 offset0:64 offset1:96
ds_read2_b32 v[110:111],v6 offset0:64 offset1:96
s_waitcnt lgkmcnt(4)
v_perm_b32 v112,v100,v96,s61
v_perm_b32 v113,v101,v97,s61
v_perm_b32 v114,v102,v98,s61
v_perm_b32 v115,v103,v99,s61
v_perm_b32 v116,v100,v96,s62
v_perm_b32 v117,v101,v97,s62
v_perm_b32 v118,v102,v98,s62
v_perm_b32 v119,v103,v99,s62
v_accvgpr_write_b32 a192,v112
v_accvgpr_write_b32 a193,v113
v_accvgpr_write_b32 a194,v114
v_accvgpr_write_b32 a195,v115
v_accvgpr_write_b32 a200,v116
v_accvgpr_write_b32 a201,v117
v_accvgpr_write_b32 a202,v118
v_accvgpr_write_b32 a203,v119
v_xor_b32 v5,20480,v3
v_xor_b32 v6,20480,v4
ds_read2_b32 v[96:97],v5 offset1:32
ds_read2_b32 v[100:101],v6 offset1:32
ds_read2_b32 v[98:99],v5 offset0:64 offset1:96
ds_read2_b32 v[102:103],v6 offset0:64 offset1:96
s_waitcnt lgkmcnt(4)
v_perm_b32 v112,v108,v104,s61
v_perm_b32 v113,v109,v105,s61
v_perm_b32 v114,v110,v106,s61
v_perm_b32 v115,v111,v107,s61
v_perm_b32 v116,v108,v104,s62
v_perm_b32 v117,v109,v105,s62
v_perm_b32 v118,v110,v106,s62
v_perm_b32 v119,v111,v107,s62
v_accvgpr_write_b32 a196,v112
v_accvgpr_write_b32 a197,v113
v_accvgpr_write_b32 a198,v114
v_accvgpr_write_b32 a199,v115
v_accvgpr_write_b32 a204,v116
v_accvgpr_write_b32 a205,v117
v_accvgpr_write_b32 a206,v118
v_accvgpr_write_b32 a207,v119
v_xor_b32 v5,22528,v3
v_xor_b32 v6,22528,v4
ds_read2_b32 v[104:105],v5 offset1:32
ds_read2_b32 v[108:109],v6 offset1:32
ds_read2_b32 v[106:107],v5 offset0:64 offset1:96
ds_read2_b32 v[110:111],v6 offset0:64 offset1:96
s_waitcnt lgkmcnt(4)
v_perm_b32 v112,v100,v96,s61
v_perm_b32 v113,v101,v97,s61
v_perm_b32 v114,v102,v98,s61
v_perm_b32 v115,v103,v99,s61
v_perm_b32 v116,v100,v96,s62
v_perm_b32 v117,v101,v97,s62
v_perm_b32 v118,v102,v98,s62
v_perm_b32 v119,v103,v99,s62
v_accvgpr_write_b32 a208,v112
v_accvgpr_write_b32 a209,v113
v_accvgpr_write_b32 a210,v114
v_accvgpr_write_b32 a211,v115
v_accvgpr_write_b32 a216,v116
v_accvgpr_write_b32 a217,v117
v_accvgpr_write_b32 a218,v118
v_accvgpr_write_b32 a219,v119
v_xor_b32 v5,24576,v3
v_xor_b32 v6,24576,v4
ds_read2_b32 v[96:97],v5 offset1:32
ds_read2_b32 v[100:101],v6 offset1:32
ds_read2_b32 v[98:99],v5 offset0:64 offset1:96
ds_read2_b32 v[102:103],v6 offset0:64 offset1:96
s_waitcnt lgkmcnt(4)
v_perm_b32 v112,v108,v104,s61
v_perm_b32 v113,v109,v105,s61
v_perm_b32 v114,v110,v106,s61
v_perm_b32 v115,v111,v107,s61
v_perm_b32 v116,v108,v104,s62
v_perm_b32 v117,v109,v105,s62
v_perm_b32 v118,v110,v106,s62
v_perm_b32 v119,v111,v107,s62
v_accvgpr_write_b32 a212,v112
v_accvgpr_write_b32 a213,v113
v_accvgpr_write_b32 a214,v114
v_accvgpr_write_b32 a215,v115
v_accvgpr_write_b32 a220,v116
v_accvgpr_write_b32 a221,v117
v_accvgpr_write_b32 a222,v118
v_accvgpr_write_b32 a223,v119
v_xor_b32 v5,26624,v3
v_xor_b32 v6,26624,v4
ds_read2_b32 v[104:105],v5 offset1:32
ds_read2_b32 v[108:109],v6 offset1:32
ds_read2_b32 v[106:107],v5 offset0:64 offset1:96
ds_read2_b32 v[110:111],v6 offset0:64 offset1:96
s_waitcnt lgkmcnt(4)
v_perm_b32 v112,v100,v96,s61
v_perm_b32 v113,v101,v97,s61
v_perm_b32 v114,v102,v98,s61
v_perm_b32 v115,v103,v99,s61
v_perm_b32 v116,v100,v96,s62
v_perm_b32 v117,v101,v97,s62
v_perm_b32 v118,v102,v98,s62
v_perm_b32 v119,v103,v99,s62
v_accvgpr_write_b32 a224,v112
v_accvgpr_write_b32 a225,v113
v_accvgpr_write_b32 a226,v114
v_accvgpr_write_b32 a227,v115
v_accvgpr_write_b32 a232,v116
v_accvgpr_write_b32 a233,v117
v_accvgpr_write_b32 a234,v118
v_accvgpr_write_b32 a235,v119
v_xor_b32 v5,28672,v3
v_xor_b32 v6,28672,v4
ds_read2_b32 v[96:97],v5 offset1:32
ds_read2_b32 v[100:101],v6 offset1:32
ds_read2_b32 v[98:99],v5 offset0:64 offset1:96
ds_read2_b32 v[102:103],v6 offset0:64 offset1:96
s_waitcnt lgkmcnt(4)
v_perm_b32 v112,v108,v104,s61
v_perm_b32 v113,v109,v105,s61
v_perm_b32 v114,v110,v106,s61
v_perm_b32 v115,v111,v107,s61
v_perm_b32 v116,v108,v104,s62
v_perm_b32 v117,v109,v105,s62
v_perm_b32 v118,v110,v106,s62
v_perm_b32 v119,v111,v107,s62
v_accvgpr_write_b32 a228,v112
v_accvgpr_write_b32 a229,v113
v_accvgpr_write_b32 a230,v114
v_accvgpr_write_b32 a231,v115
v_accvgpr_write_b32 a236,v116
v_accvgpr_write_b32 a237,v117
v_accvgpr_write_b32 a238,v118
v_accvgpr_write_b32 a239,v119
v_xor_b32 v5,30720,v3
v_xor_b32 v6,30720,v4
ds_read2_b32 v[104:105],v5 offset1:32
ds_read2_b32 v[108:109],v6 offset1:32
ds_read2_b32 v[106:107],v5 offset0:64 offset1:96
ds_read2_b32 v[110:111],v6 offset0:64 offset1:96
s_waitcnt lgkmcnt(4)
v_perm_b32 v112,v100,v96,s61
v_perm_b32 v113,v101,v97,s61
v_perm_b32 v114,v102,v98,s61
v_perm_b32 v115,v103,v99,s61
v_perm_b32 v116,v100,v96,s62
v_perm_b32 v117,v101,v97,s62
v_perm_b32 v118,v102,v98,s62
v_perm_b32 v119,v103,v99,s62
v_accvgpr_write_b32 a240,v112
v_accvgpr_write_b32 a241,v113
v_accvgpr_write_b32 a242,v114
v_accvgpr_write_b32 a243,v115
v_accvgpr_write_b32 a248,v116
v_accvgpr_write_b32 a249,v117
v_accvgpr_write_b32 a250,v118
v_accvgpr_write_b32 a251,v119
s_waitcnt lgkmcnt(0)
s_xor_b32 m0,s59,16384
s_xor_b32 s60,s58,2097152
buffer_load_dwordx4 v2,s[4:7],s60 offen lds
s_add_u32 m0,m0,1024
s_add_u32 s60,s60,131072
buffer_load_dwordx4 v2,s[4:7],s60 offen lds
s_xor_b32 m0,s59,18432
s_xor_b32 s60,s58,2359296
buffer_load_dwordx4 v2,s[4:7],s60 offen lds
s_add_u32 m0,m0,1024
s_add_u32 s60,s60,131072
buffer_load_dwordx4 v2,s[4:7],s60 offen lds
s_xor_b32 m0,s59,20480
s_xor_b32 s60,s58,2621440
buffer_load_dwordx4 v2,s[4:7],s60 offen lds
s_add_u32 m0,m0,1024
s_add_u32 s60,s60,131072
buffer_load_dwordx4 v2,s[4:7],s60 offen lds
s_xor_b32 m0,s59,22528
s_xor_b32 s60,s58,2883584
buffer_load_dwordx4 v2,s[4:7],s60 offen lds
s_add_u32 m0,m0,1024
s_add_u32 s60,s60,131072
buffer_load_dwordx4 v2,s[4:7],s60 offen lds
s_xor_b32 m0,s59,24576
s_xor_b32 s60,s58,3145728
buffer_load_dwordx4 v2,s[4:7],s60 offen lds
s_add_u32 m0,m0,1024
s_add_u32 s60,s60,131072
buffer_load_dwordx4 v2,s[4:7],s60 offen lds
s_xor_b32 m0,s59,26624
s_xor_b32 s60,s58,3407872
buffer_load_dwordx4 v2,s[4:7],s60 offen lds
s_add_u32 m0,m0,1024
s_add_u32 s60,s60,131072
buffer_load_dwordx4 v2,s[4:7],s60 offen lds
s_xor_b32 m0,s59,28672
s_xor_b32 s60,s58,3670016
buffer_load_dwordx4 v2,s[4:7],s60 offen lds
s_add_u32 m0,m0,1024
s_add_u32 s60,s60,131072
buffer_load_dwordx4 v2,s[4:7],s60 offen lds
s_xor_b32 m0,s59,30720
s_xor_b32 s60,s58,3932160
buffer_load_dwordx4 v2,s[4:7],s60 offen lds
s_add_u32 m0,m0,1024
s_add_u32 s60,s60,131072
buffer_load_dwordx4 v2,s[4:7],s60 offen lds
v_perm_b32 v112,v108,v104,s61
v_perm_b32 v113,v109,v105,s61
v_perm_b32 v114,v110,v106,s61
v_perm_b32 v115,v111,v107,s61
v_perm_b32 v116,v108,v104,s62
v_perm_b32 v117,v109,v105,s62
v_perm_b32 v118,v110,v106,s62
v_perm_b32 v119,v111,v107,s62
v_accvgpr_write_b32 a244,v112
v_accvgpr_write_b32 a245,v113
v_accvgpr_write_b32 a246,v114
v_accvgpr_write_b32 a247,v115
v_accvgpr_write_b32 a252,v116
v_accvgpr_write_b32 a253,v117
v_accvgpr_write_b32 a254,v118
v_accvgpr_write_b32 a255,v119
s_waitcnt vmcnt(16)
v_xor_b32 v5,0,v3
v_xor_b32 v6,0,v4
ds_read2_b32 v[96:97],v5 offset1:32
ds_read2_b32 v[100:101],v6 offset1:32
ds_read2_b32 v[98:99],v5 offset0:64 offset1:96
ds_read2_b32 v[102:103],v6 offset0:64 offset1:96
v_xor_b32 v5,2048,v3
v_xor_b32 v6,2048,v4
ds_read2_b32 v[104:105],v5 offset1:32
ds_read2_b32 v[108:109],v6 offset1:32
ds_read2_b32 v[106:107],v5 offset0:64 offset1:96
ds_read2_b32 v[110:111],v6 offset0:64 offset1:96
s_waitcnt lgkmcnt(4)
v_perm_b32 v128,v100,v96,s61
v_perm_b32 v129,v101,v97,s61
v_perm_b32 v130,v102,v98,s61
v_perm_b32 v131,v103,v99,s61
v_perm_b32 v136,v100,v96,s62
v_perm_b32 v137,v101,v97,s62
v_perm_b32 v138,v102,v98,s62
v_perm_b32 v139,v103,v99,s62
v_xor_b32 v5,4096,v3
v_xor_b32 v6,4096,v4
ds_read2_b32 v[96:97],v5 offset1:32
ds_read2_b32 v[100:101],v6 offset1:32
ds_read2_b32 v[98:99],v5 offset0:64 offset1:96
ds_read2_b32 v[102:103],v6 offset0:64 offset1:96
s_waitcnt lgkmcnt(4)
v_perm_b32 v132,v108,v104,s61
v_perm_b32 v133,v109,v105,s61
v_perm_b32 v134,v110,v106,s61
v_perm_b32 v135,v111,v107,s61
v_perm_b32 v140,v108,v104,s62
v_perm_b32 v141,v109,v105,s62
v_perm_b32 v142,v110,v106,s62
v_perm_b32 v143,v111,v107,s62
v_xor_b32 v5,6144,v3
v_xor_b32 v6,6144,v4
ds_read2_b32 v[104:105],v5 offset1:32
ds_read2_b32 v[108:109],v6 offset1:32
ds_read2_b32 v[106:107],v5 offset0:64 offset1:96
ds_read2_b32 v[110:111],v6 offset0:64 offset1:96
s_waitcnt lgkmcnt(4)
v_perm_b32 v144,v100,v96,s61
v_perm_b32 v145,v101,v97,s61
v_perm_b32 v146,v102,v98,s61
v_perm_b32 v147,v103,v99,s61
v_perm_b32 v152,v100,v96,s62
v_perm_b32 v153,v101,v97,s62
v_perm_b32 v154,v102,v98,s62
v_perm_b32 v155,v103,v99,s62
v_xor_b32 v5,8192,v3
v_xor_b32 v6,8192,v4
ds_read2_b32 v[96:97],v5 offset1:32
ds_read2_b32 v[100:101],v6 offset1:32
ds_read2_b32 v[98:99],v5 offset0:64 offset1:96
ds_read2_b32 v[102:103],v6 offset0:64 offset1:96
s_waitcnt lgkmcnt(4)
v_perm_b32 v148,v108,v104,s61
v_perm_b32 v149,v109,v105,s61
v_perm_b32 v150,v110,v106,s61
v_perm_b32 v151,v111,v107,s61
v_perm_b32 v156,v108,v104,s62
v_perm_b32 v157,v109,v105,s62
v_perm_b32 v158,v110,v106,s62
v_perm_b32 v159,v111,v107,s62
v_xor_b32 v5,10240,v3
v_xor_b32 v6,10240,v4
ds_read2_b32 v[104:105],v5 offset1:32
ds_read2_b32 v[108:109],v6 offset1:32
ds_read2_b32 v[106:107],v5 offset0:64 offset1:96
ds_read2_b32 v[110:111],v6 offset0:64 offset1:96
s_waitcnt lgkmcnt(4)
v_perm_b32 v160,v100,v96,s61
v_perm_b32 v161,v101,v97,s61
v_perm_b32 v162,v102,v98,s61
v_perm_b32 v163,v103,v99,s61
v_perm_b32 v168,v100,v96,s62
v_perm_b32 v169,v101,v97,s62
v_perm_b32 v170,v102,v98,s62
v_perm_b32 v171,v103,v99,s62
v_xor_b32 v5,12288,v3
v_xor_b32 v6,12288,v4
ds_read2_b32 v[96:97],v5 offset1:32
ds_read2_b32 v[100:101],v6 offset1:32
ds_read2_b32 v[98:99],v5 offset0:64 offset1:96
ds_read2_b32 v[102:103],v6 offset0:64 offset1:96
s_waitcnt lgkmcnt(4)
v_perm_b32 v164,v108,v104,s61
v_perm_b32 v165,v109,v105,s61
v_perm_b32 v166,v110,v106,s61
v_perm_b32 v167,v111,v107,s61
v_perm_b32 v172,v108,v104,s62
v_perm_b32 v173,v109,v105,s62
v_perm_b32 v174,v110,v106,s62
v_perm_b32 v175,v111,v107,s62
v_xor_b32 v5,14336,v3
v_xor_b32 v6,14336,v4
ds_read2_b32 v[104:105],v5 offset1:32
ds_read2_b32 v[108:109],v6 offset1:32
ds_read2_b32 v[106:107],v5 offset0:64 offset1:96
ds_read2_b32 v[110:111],v6 offset0:64 offset1:96
s_waitcnt lgkmcnt(4)
v_perm_b32 v176,v100,v96,s61
v_perm_b32 v177,v101,v97,s61
v_perm_b32 v178,v102,v98,s61
v_perm_b32 v179,v103,v99,s61
v_perm_b32 v184,v100,v96,s62
v_perm_b32 v185,v101,v97,s62
v_perm_b32 v186,v102,v98,s62
v_perm_b32 v187,v103,v99,s62
s_waitcnt lgkmcnt(0)
s_mov_b32 s4,s20
s_mov_b32 s5,s21
s_mov_b32 s6,4194304
s_mov_b32 s7,0x20000
s_xor_b32 m0,s59,0
s_xor_b32 s60,s58,0
buffer_load_dwordx4 v2,s[4:7],s60 offen lds
s_add_u32 m0,m0,1024
s_add_u32 s60,s60,131072
buffer_load_dwordx4 v2,s[4:7],s60 offen lds
s_xor_b32 m0,s59,2048
s_xor_b32 s60,s58,262144
buffer_load_dwordx4 v2,s[4:7],s60 offen lds
s_add_u32 m0,m0,1024
s_add_u32 s60,s60,131072
buffer_load_dwordx4 v2,s[4:7],s60 offen lds
s_xor_b32 m0,s59,4096
s_xor_b32 s60,s58,524288
buffer_load_dwordx4 v2,s[4:7],s60 offen lds
s_add_u32 m0,m0,1024
s_add_u32 s60,s60,131072
buffer_load_dwordx4 v2,s[4:7],s60 offen lds
s_xor_b32 m0,s59,6144
s_xor_b32 s60,s58,786432
buffer_load_dwordx4 v2,s[4:7],s60 offen lds
s_add_u32 m0,m0,1024
s_add_u32 s60,s60,131072
buffer_load_dwordx4 v2,s[4:7],s60 offen lds
s_xor_b32 m0,s59,8192
s_xor_b32 s60,s58,1048576
buffer_load_dwordx4 v2,s[4:7],s60 offen lds
s_add_u32 m0,m0,1024
s_add_u32 s60,s60,131072
buffer_load_dwordx4 v2,s[4:7],s60 offen lds
s_xor_b32 m0,s59,10240
s_xor_b32 s60,s58,1310720
buffer_load_dwordx4 v2,s[4:7],s60 offen lds
s_add_u32 m0,m0,1024
s_add_u32 s60,s60,131072
buffer_load_dwordx4 v2,s[4:7],s60 offen lds
s_xor_b32 m0,s59,12288
s_xor_b32 s60,s58,1572864
buffer_load_dwordx4 v2,s[4:7],s60 offen lds
s_add_u32 m0,m0,1024
s_add_u32 s60,s60,131072
buffer_load_dwordx4 v2,s[4:7],s60 offen lds
s_xor_b32 m0,s59,14336
s_xor_b32 s60,s58,1835008
buffer_load_dwordx4 v2,s[4:7],s60 offen lds
s_add_u32 m0,m0,1024
s_add_u32 s60,s60,131072
buffer_load_dwordx4 v2,s[4:7],s60 offen lds
v_perm_b32 v180,v108,v104,s61
v_perm_b32 v181,v109,v105,s61
v_perm_b32 v182,v110,v106,s61
v_perm_b32 v183,v111,v107,s61
v_perm_b32 v188,v108,v104,s62
v_perm_b32 v189,v109,v105,s62
v_perm_b32 v190,v110,v106,s62
v_perm_b32 v191,v111,v107,s62
s_waitcnt vmcnt(16)
v_xor_b32 v5,16384,v3
v_xor_b32 v6,16384,v4
ds_read2_b32 v[96:97],v5 offset1:32
ds_read2_b32 v[100:101],v6 offset1:32
ds_read2_b32 v[98:99],v5 offset0:64 offset1:96
ds_read2_b32 v[102:103],v6 offset0:64 offset1:96
v_xor_b32 v5,18432,v3
v_xor_b32 v6,18432,v4
ds_read2_b32 v[104:105],v5 offset1:32
ds_read2_b32 v[108:109],v6 offset1:32
ds_read2_b32 v[106:107],v5 offset0:64 offset1:96
ds_read2_b32 v[110:111],v6 offset0:64 offset1:96
s_waitcnt lgkmcnt(4)
v_perm_b32 v192,v100,v96,s61
v_perm_b32 v193,v101,v97,s61
v_perm_b32 v194,v102,v98,s61
v_perm_b32 v195,v103,v99,s61
v_perm_b32 v200,v100,v96,s62
v_perm_b32 v201,v101,v97,s62
v_perm_b32 v202,v102,v98,s62
v_perm_b32 v203,v103,v99,s62
v_xor_b32 v5,20480,v3
v_xor_b32 v6,20480,v4
ds_read2_b32 v[96:97],v5 offset1:32
ds_read2_b32 v[100:101],v6 offset1:32
ds_read2_b32 v[98:99],v5 offset0:64 offset1:96
ds_read2_b32 v[102:103],v6 offset0:64 offset1:96
s_waitcnt lgkmcnt(4)
v_perm_b32 v196,v108,v104,s61
v_perm_b32 v197,v109,v105,s61
v_perm_b32 v198,v110,v106,s61
v_perm_b32 v199,v111,v107,s61
v_perm_b32 v204,v108,v104,s62
v_perm_b32 v205,v109,v105,s62
v_perm_b32 v206,v110,v106,s62
v_perm_b32 v207,v111,v107,s62
v_xor_b32 v5,22528,v3
v_xor_b32 v6,22528,v4
ds_read2_b32 v[104:105],v5 offset1:32
ds_read2_b32 v[108:109],v6 offset1:32
ds_read2_b32 v[106:107],v5 offset0:64 offset1:96
ds_read2_b32 v[110:111],v6 offset0:64 offset1:96
s_waitcnt lgkmcnt(4)
v_perm_b32 v208,v100,v96,s61
v_perm_b32 v209,v101,v97,s61
v_perm_b32 v210,v102,v98,s61
v_perm_b32 v211,v103,v99,s61
v_perm_b32 v216,v100,v96,s62
v_perm_b32 v217,v101,v97,s62
v_perm_b32 v218,v102,v98,s62
v_perm_b32 v219,v103,v99,s62
v_xor_b32 v5,24576,v3
v_xor_b32 v6,24576,v4
ds_read2_b32 v[96:97],v5 offset1:32
ds_read2_b32 v[100:101],v6 offset1:32
ds_read2_b32 v[98:99],v5 offset0:64 offset1:96
ds_read2_b32 v[102:103],v6 offset0:64 offset1:96
s_waitcnt lgkmcnt(4)
v_perm_b32 v212,v108,v104,s61
v_perm_b32 v213,v109,v105,s61
v_perm_b32 v214,v110,v106,s61
v_perm_b32 v215,v111,v107,s61
v_perm_b32 v220,v108,v104,s62
v_perm_b32 v221,v109,v105,s62
v_perm_b32 v222,v110,v106,s62
v_perm_b32 v223,v111,v107,s62
v_xor_b32 v5,26624,v3
v_xor_b32 v6,26624,v4
ds_read2_b32 v[104:105],v5 offset1:32
ds_read2_b32 v[108:109],v6 offset1:32
ds_read2_b32 v[106:107],v5 offset0:64 offset1:96
ds_read2_b32 v[110:111],v6 offset0:64 offset1:96
s_waitcnt lgkmcnt(4)
v_perm_b32 v224,v100,v96,s61
v_perm_b32 v225,v101,v97,s61
v_perm_b32 v226,v102,v98,s61
v_perm_b32 v227,v103,v99,s61
v_perm_b32 v232,v100,v96,s62
v_perm_b32 v233,v101,v97,s62
v_perm_b32 v234,v102,v98,s62
v_perm_b32 v235,v103,v99,s62
v_xor_b32 v5,28672,v3
v_xor_b32 v6,28672,v4
ds_read2_b32 v[96:97],v5 offset1:32
ds_read2_b32 v[100:101],v6 offset1:32
ds_read2_b32 v[98:99],v5 offset0:64 offset1:96
ds_read2_b32 v[102:103],v6 offset0:64 offset1:96
s_waitcnt lgkmcnt(4)
v_perm_b32 v228,v108,v104,s61
v_perm_b32 v229,v109,v105,s61
v_perm_b32 v230,v110,v106,s61
v_perm_b32 v231,v111,v107,s61
v_perm_b32 v236,v108,v104,s62
v_perm_b32 v237,v109,v105,s62
v_perm_b32 v238,v110,v106,s62
v_perm_b32 v239,v111,v107,s62
v_xor_b32 v5,30720,v3
v_xor_b32 v6,30720,v4
ds_read2_b32 v[104:105],v5 offset1:32
ds_read2_b32 v[108:109],v6 offset1:32
ds_read2_b32 v[106:107],v5 offset0:64 offset1:96
ds_read2_b32 v[110:111],v6 offset0:64 offset1:96
s_waitcnt lgkmcnt(4)
v_perm_b32 v240,v100,v96,s61
v_perm_b32 v241,v101,v97,s61
v_perm_b32 v242,v102,v98,s61
v_perm_b32 v243,v103,v99,s61
v_perm_b32 v248,v100,v96,s62
v_perm_b32 v249,v101,v97,s62
v_perm_b32 v250,v102,v98,s62
v_perm_b32 v251,v103,v99,s62
s_waitcnt lgkmcnt(0)
s_xor_b32 m0,s59,16384
s_xor_b32 s60,s58,2097152
buffer_load_dwordx4 v2,s[4:7],s60 offen lds
s_add_u32 m0,m0,1024
s_add_u32 s60,s60,131072
buffer_load_dwordx4 v2,s[4:7],s60 offen lds
s_xor_b32 m0,s59,18432
s_xor_b32 s60,s58,2359296
buffer_load_dwordx4 v2,s[4:7],s60 offen lds
s_add_u32 m0,m0,1024
s_add_u32 s60,s60,131072
buffer_load_dwordx4 v2,s[4:7],s60 offen lds
s_xor_b32 m0,s59,20480
s_xor_b32 s60,s58,2621440
buffer_load_dwordx4 v2,s[4:7],s60 offen lds
s_add_u32 m0,m0,1024
s_add_u32 s60,s60,131072
buffer_load_dwordx4 v2,s[4:7],s60 offen lds
s_xor_b32 m0,s59,22528
s_xor_b32 s60,s58,2883584
buffer_load_dwordx4 v2,s[4:7],s60 offen lds
s_add_u32 m0,m0,1024
s_add_u32 s60,s60,131072
buffer_load_dwordx4 v2,s[4:7],s60 offen lds
s_xor_b32 m0,s59,24576
s_xor_b32 s60,s58,3145728
buffer_load_dwordx4 v2,s[4:7],s60 offen lds
s_add_u32 m0,m0,1024
s_add_u32 s60,s60,131072
buffer_load_dwordx4 v2,s[4:7],s60 offen lds
s_xor_b32 m0,s59,26624
s_xor_b32 s60,s58,3407872
buffer_load_dwordx4 v2,s[4:7],s60 offen lds
s_add_u32 m0,m0,1024
s_add_u32 s60,s60,131072
buffer_load_dwordx4 v2,s[4:7],s60 offen lds
s_xor_b32 m0,s59,28672
s_xor_b32 s60,s58,3670016
buffer_load_dwordx4 v2,s[4:7],s60 offen lds
s_add_u32 m0,m0,1024
s_add_u32 s60,s60,131072
buffer_load_dwordx4 v2,s[4:7],s60 offen lds
s_xor_b32 m0,s59,30720
s_xor_b32 s60,s58,3932160
buffer_load_dwordx4 v2,s[4:7],s60 offen lds
s_add_u32 m0,m0,1024
s_add_u32 s60,s60,131072
buffer_load_dwordx4 v2,s[4:7],s60 offen lds
v_perm_b32 v244,v108,v104,s61
v_perm_b32 v245,v109,v105,s61
v_perm_b32 v246,v110,v106,s61
v_perm_b32 v247,v111,v107,s61
v_perm_b32 v252,v108,v104,s62
v_perm_b32 v253,v109,v105,s62
v_perm_b32 v254,v110,v106,s62
v_perm_b32 v255,v111,v107,s62
s_waitcnt vmcnt(16)
v_xor_b32 v5,0,v3
v_xor_b32 v6,0,v4
ds_read2_b32 v[96:97],v5 offset1:32
ds_read2_b32 v[100:101],v6 offset1:32
ds_read2_b32 v[98:99],v5 offset0:64 offset1:96
ds_read2_b32 v[102:103],v6 offset0:64 offset1:96
v_xor_b32 v5,2048,v3
v_xor_b32 v6,2048,v4
ds_read2_b32 v[104:105],v5 offset1:32
ds_read2_b32 v[108:109],v6 offset1:32
ds_read2_b32 v[106:107],v5 offset0:64 offset1:96
ds_read2_b32 v[110:111],v6 offset0:64 offset1:96
s_waitcnt lgkmcnt(4)
v_perm_b32 v112,v100,v96,s61
v_perm_b32 v113,v101,v97,s61
v_perm_b32 v114,v102,v98,s61
v_perm_b32 v115,v103,v99,s61
v_perm_b32 v116,v100,v96,s62
v_perm_b32 v117,v101,v97,s62
v_perm_b32 v118,v102,v98,s62
v_perm_b32 v119,v103,v99,s62
v_accvgpr_write_b32 a0,v112
v_accvgpr_write_b32 a1,v113
v_accvgpr_write_b32 a2,v114
v_accvgpr_write_b32 a3,v115
v_accvgpr_write_b32 a8,v116
v_accvgpr_write_b32 a9,v117
v_accvgpr_write_b32 a10,v118
v_accvgpr_write_b32 a11,v119
v_xor_b32 v5,4096,v3
v_xor_b32 v6,4096,v4
ds_read2_b32 v[96:97],v5 offset1:32
ds_read2_b32 v[100:101],v6 offset1:32
ds_read2_b32 v[98:99],v5 offset0:64 offset1:96
ds_read2_b32 v[102:103],v6 offset0:64 offset1:96
s_waitcnt lgkmcnt(4)
v_perm_b32 v112,v108,v104,s61
v_perm_b32 v113,v109,v105,s61
v_perm_b32 v114,v110,v106,s61
v_perm_b32 v115,v111,v107,s61
v_perm_b32 v116,v108,v104,s62
v_perm_b32 v117,v109,v105,s62
v_perm_b32 v118,v110,v106,s62
v_perm_b32 v119,v111,v107,s62
v_accvgpr_write_b32 a4,v112
v_accvgpr_write_b32 a5,v113
v_accvgpr_write_b32 a6,v114
v_accvgpr_write_b32 a7,v115
v_accvgpr_write_b32 a12,v116
v_accvgpr_write_b32 a13,v117
v_accvgpr_write_b32 a14,v118
v_accvgpr_write_b32 a15,v119
v_xor_b32 v5,6144,v3
v_xor_b32 v6,6144,v4
ds_read2_b32 v[104:105],v5 offset1:32
ds_read2_b32 v[108:109],v6 offset1:32
ds_read2_b32 v[106:107],v5 offset0:64 offset1:96
ds_read2_b32 v[110:111],v6 offset0:64 offset1:96
s_waitcnt lgkmcnt(4)
v_perm_b32 v112,v100,v96,s61
v_perm_b32 v113,v101,v97,s61
v_perm_b32 v114,v102,v98,s61
v_perm_b32 v115,v103,v99,s61
v_perm_b32 v116,v100,v96,s62
v_perm_b32 v117,v101,v97,s62
v_perm_b32 v118,v102,v98,s62
v_perm_b32 v119,v103,v99,s62
v_accvgpr_write_b32 a16,v112
v_accvgpr_write_b32 a17,v113
v_accvgpr_write_b32 a18,v114
v_accvgpr_write_b32 a19,v115
v_accvgpr_write_b32 a24,v116
v_accvgpr_write_b32 a25,v117
v_accvgpr_write_b32 a26,v118
v_accvgpr_write_b32 a27,v119
v_xor_b32 v5,8192,v3
v_xor_b32 v6,8192,v4
ds_read2_b32 v[96:97],v5 offset1:32
ds_read2_b32 v[100:101],v6 offset1:32
ds_read2_b32 v[98:99],v5 offset0:64 offset1:96
ds_read2_b32 v[102:103],v6 offset0:64 offset1:96
s_waitcnt lgkmcnt(4)
v_perm_b32 v112,v108,v104,s61
v_perm_b32 v113,v109,v105,s61
v_perm_b32 v114,v110,v106,s61
v_perm_b32 v115,v111,v107,s61
v_perm_b32 v116,v108,v104,s62
v_perm_b32 v117,v109,v105,s62
v_perm_b32 v118,v110,v106,s62
v_perm_b32 v119,v111,v107,s62
v_accvgpr_write_b32 a20,v112
v_accvgpr_write_b32 a21,v113
v_accvgpr_write_b32 a22,v114
v_accvgpr_write_b32 a23,v115
v_accvgpr_write_b32 a28,v116
v_accvgpr_write_b32 a29,v117
v_accvgpr_write_b32 a30,v118
v_accvgpr_write_b32 a31,v119
v_xor_b32 v5,10240,v3
v_xor_b32 v6,10240,v4
ds_read2_b32 v[104:105],v5 offset1:32
ds_read2_b32 v[108:109],v6 offset1:32
ds_read2_b32 v[106:107],v5 offset0:64 offset1:96
ds_read2_b32 v[110:111],v6 offset0:64 offset1:96
s_waitcnt lgkmcnt(4)
v_perm_b32 v112,v100,v96,s61
v_perm_b32 v113,v101,v97,s61
v_perm_b32 v114,v102,v98,s61
v_perm_b32 v115,v103,v99,s61
v_perm_b32 v116,v100,v96,s62
v_perm_b32 v117,v101,v97,s62
v_perm_b32 v118,v102,v98,s62
v_perm_b32 v119,v103,v99,s62
v_accvgpr_write_b32 a32,v112
v_accvgpr_write_b32 a33,v113
v_accvgpr_write_b32 a34,v114
v_accvgpr_write_b32 a35,v115
v_accvgpr_write_b32 a40,v116
v_accvgpr_write_b32 a41,v117
v_accvgpr_write_b32 a42,v118
v_accvgpr_write_b32 a43,v119
v_xor_b32 v5,12288,v3
v_xor_b32 v6,12288,v4
ds_read2_b32 v[96:97],v5 offset1:32
ds_read2_b32 v[100:101],v6 offset1:32
ds_read2_b32 v[98:99],v5 offset0:64 offset1:96
ds_read2_b32 v[102:103],v6 offset0:64 offset1:96
s_waitcnt lgkmcnt(4)
v_perm_b32 v112,v108,v104,s61
v_perm_b32 v113,v109,v105,s61
v_perm_b32 v114,v110,v106,s61
v_perm_b32 v115,v111,v107,s61
v_perm_b32 v116,v108,v104,s62
v_perm_b32 v117,v109,v105,s62
v_perm_b32 v118,v110,v106,s62
v_perm_b32 v119,v111,v107,s62
v_accvgpr_write_b32 a36,v112
v_accvgpr_write_b32 a37,v113
v_accvgpr_write_b32 a38,v114
v_accvgpr_write_b32 a39,v115
v_accvgpr_write_b32 a44,v116
v_accvgpr_write_b32 a45,v117
v_accvgpr_write_b32 a46,v118
v_accvgpr_write_b32 a47,v119
v_xor_b32 v5,14336,v3
v_xor_b32 v6,14336,v4
ds_read2_b32 v[104:105],v5 offset1:32
ds_read2_b32 v[108:109],v6 offset1:32
ds_read2_b32 v[106:107],v5 offset0:64 offset1:96
ds_read2_b32 v[110:111],v6 offset0:64 offset1:96
s_waitcnt lgkmcnt(4)
v_perm_b32 v112,v100,v96,s61
v_perm_b32 v113,v101,v97,s61
v_perm_b32 v114,v102,v98,s61
v_perm_b32 v115,v103,v99,s61
v_perm_b32 v116,v100,v96,s62
v_perm_b32 v117,v101,v97,s62
v_perm_b32 v118,v102,v98,s62
v_perm_b32 v119,v103,v99,s62
v_accvgpr_write_b32 a48,v112
v_accvgpr_write_b32 a49,v113
v_accvgpr_write_b32 a50,v114
v_accvgpr_write_b32 a51,v115
v_accvgpr_write_b32 a56,v116
v_accvgpr_write_b32 a57,v117
v_accvgpr_write_b32 a58,v118
v_accvgpr_write_b32 a59,v119
s_waitcnt lgkmcnt(0)
v_perm_b32 v112,v108,v104,s61
v_perm_b32 v113,v109,v105,s61
v_perm_b32 v114,v110,v106,s61
v_perm_b32 v115,v111,v107,s61
v_perm_b32 v116,v108,v104,s62
v_perm_b32 v117,v109,v105,s62
v_perm_b32 v118,v110,v106,s62
v_perm_b32 v119,v111,v107,s62
v_accvgpr_write_b32 a52,v112
v_accvgpr_write_b32 a53,v113
v_accvgpr_write_b32 a54,v114
v_accvgpr_write_b32 a55,v115
v_accvgpr_write_b32 a60,v116
v_accvgpr_write_b32 a61,v117
v_accvgpr_write_b32 a62,v118
v_accvgpr_write_b32 a63,v119
s_mov_b32 s4,s26
s_mov_b32 s5,s27
s_mov_b32 s6,4194304
s_mov_b32 s7,0x20000
v_and_b32 v92,3,v1
v_lshlrev_b32 v93,4,v92
v_bfe_u32 v94,v1,2,2
v_lshl_add_u32 v92,v94,12,v93
v_lshl_add_u32 v93,v94,8,v93
v_and_b32 v94,1,v94
v_lshl_add_u32 v93,v94,6,v93
v_lshrrev_b32 v94,4,v1
v_lshl_add_u32 v92,v94,8,v92
v_lshl_add_u32 v93,v94,13,v93
s_lshl_b32 s56,s46,15
v_add_u32 v93,s56,v93
v_xor_b32 v94,64,v93
s_lshl_b32 s56,s47,17
s_lshl_b32 s57,s46,6
s_add_u32 s56,s56,s57
v_add_u32 v92,s56,v92
s_cmp_ge_u32 s48,3
s_cbranch_scc1 L_lw_17
s_mov_b32 s56,0
buffer_load_dwordx4 v[24:27],v92,s[4:7],s56 offen offset:0
buffer_load_dwordx4 v[28:31],v92,s[4:7],s56 offen offset:1024
buffer_load_dwordx4 v[32:35],v92,s[4:7],s56 offen offset:2048
buffer_load_dwordx4 v[36:39],v92,s[4:7],s56 offen offset:3072
s_mov_b32 s56,16384
buffer_load_dwordx4 v[40:43],v92,s[4:7],s56 offen offset:0
buffer_load_dwordx4 v[44:47],v92,s[4:7],s56 offen offset:1024
buffer_load_dwordx4 v[48:51],v92,s[4:7],s56 offen offset:2048
buffer_load_dwordx4 v[52:55],v92,s[4:7],s56 offen offset:3072
s_mov_b32 s56,32768
buffer_load_dwordx4 v[56:59],v92,s[4:7],s56 offen offset:0
buffer_load_dwordx4 v[60:63],v92,s[4:7],s56 offen offset:1024
buffer_load_dwordx4 v[64:67],v92,s[4:7],s56 offen offset:2048
buffer_load_dwordx4 v[68:71],v92,s[4:7],s56 offen offset:3072
s_mov_b32 s56,49152
buffer_load_dwordx4 v[72:75],v92,s[4:7],s56 offen offset:0
buffer_load_dwordx4 v[76:79],v92,s[4:7],s56 offen offset:1024
buffer_load_dwordx4 v[80:83],v92,s[4:7],s56 offen offset:2048
buffer_load_dwordx4 v[84:87],v92,s[4:7],s56 offen offset:3072
s_waitcnt vmcnt(16)
s_branch L_lj_18
L_lw_17:
s_waitcnt vmcnt(0)
L_lj_18:
v_xor_b32 v5,16384,v3
v_xor_b32 v6,16384,v4
ds_read2_b32 v[96:97],v5 offset1:32
ds_read2_b32 v[100:101],v6 offset1:32
ds_read2_b32 v[98:99],v5 offset0:64 offset1:96
ds_read2_b32 v[102:103],v6 offset0:64 offset1:96
v_xor_b32 v5,18432,v3
v_xor_b32 v6,18432,v4
ds_read2_b32 v[104:105],v5 offset1:32
ds_read2_b32 v[108:109],v6 offset1:32
ds_read2_b32 v[106:107],v5 offset0:64 offset1:96
ds_read2_b32 v[110:111],v6 offset0:64 offset1:96
s_waitcnt lgkmcnt(4)
v_perm_b32 v112,v100,v96,s61
v_perm_b32 v113,v101,v97,s61
v_perm_b32 v114,v102,v98,s61
v_perm_b32 v115,v103,v99,s61
v_perm_b32 v116,v100,v96,s62
v_perm_b32 v117,v101,v97,s62
v_perm_b32 v118,v102,v98,s62
v_perm_b32 v119,v103,v99,s62
v_accvgpr_write_b32 a64,v112
v_accvgpr_write_b32 a65,v113
v_accvgpr_write_b32 a66,v114
v_accvgpr_write_b32 a67,v115
v_accvgpr_write_b32 a72,v116
v_accvgpr_write_b32 a73,v117
v_accvgpr_write_b32 a74,v118
v_accvgpr_write_b32 a75,v119
v_xor_b32 v5,20480,v3
v_xor_b32 v6,20480,v4
ds_read2_b32 v[96:97],v5 offset1:32
ds_read2_b32 v[100:101],v6 offset1:32
ds_read2_b32 v[98:99],v5 offset0:64 offset1:96
ds_read2_b32 v[102:103],v6 offset0:64 offset1:96
s_waitcnt lgkmcnt(4)
v_perm_b32 v112,v108,v104,s61
v_perm_b32 v113,v109,v105,s61
v_perm_b32 v114,v110,v106,s61
v_perm_b32 v115,v111,v107,s61
v_perm_b32 v116,v108,v104,s62
v_perm_b32 v117,v109,v105,s62
v_perm_b32 v118,v110,v106,s62
v_perm_b32 v119,v111,v107,s62
v_accvgpr_write_b32 a68,v112
v_accvgpr_write_b32 a69,v113
v_accvgpr_write_b32 a70,v114
v_accvgpr_write_b32 a71,v115
v_accvgpr_write_b32 a76,v116
v_accvgpr_write_b32 a77,v117
v_accvgpr_write_b32 a78,v118
v_accvgpr_write_b32 a79,v119
v_xor_b32 v5,22528,v3
v_xor_b32 v6,22528,v4
ds_read2_b32 v[104:105],v5 offset1:32
ds_read2_b32 v[108:109],v6 offset1:32
ds_read2_b32 v[106:107],v5 offset0:64 offset1:96
ds_read2_b32 v[110:111],v6 offset0:64 offset1:96
s_waitcnt lgkmcnt(4)
v_perm_b32 v112,v100,v96,s61
v_perm_b32 v113,v101,v97,s61
v_perm_b32 v114,v102,v98,s61
v_perm_b32 v115,v103,v99,s61
v_perm_b32 v116,v100,v96,s62
v_perm_b32 v117,v101,v97,s62
v_perm_b32 v118,v102,v98,s62
v_perm_b32 v119,v103,v99,s62
v_accvgpr_write_b32 a80,v112
v_accvgpr_write_b32 a81,v113
v_accvgpr_write_b32 a82,v114
v_accvgpr_write_b32 a83,v115
v_accvgpr_write_b32 a88,v116
v_accvgpr_write_b32 a89,v117
v_accvgpr_write_b32 a90,v118
v_accvgpr_write_b32 a91,v119
v_xor_b32 v5,24576,v3
v_xor_b32 v6,24576,v4
ds_read2_b32 v[96:97],v5 offset1:32
ds_read2_b32 v[100:101],v6 offset1:32
ds_read2_b32 v[98:99],v5 offset0:64 offset1:96
ds_read2_b32 v[102:103],v6 offset0:64 offset1:96
s_waitcnt lgkmcnt(4)
v_perm_b32 v112,v108,v104,s61
v_perm_b32 v113,v109,v105,s61
v_perm_b32 v114,v110,v106,s61
v_perm_b32 v115,v111,v107,s61
v_perm_b32 v116,v108,v104,s62
v_perm_b32 v117,v109,v105,s62
v_perm_b32 v118,v110,v106,s62
v_perm_b32 v119,v111,v107,s62
v_accvgpr_write_b32 a84,v112
v_accvgpr_write_b32 a85,v113
v_accvgpr_write_b32 a86,v114
v_accvgpr_write_b32 a87,v115
v_accvgpr_write_b32 a92,v116
v_accvgpr_write_b32 a93,v117
v_accvgpr_write_b32 a94,v118
v_accvgpr_write_b32 a95,v119
v_xor_b32 v5,26624,v3
v_xor_b32 v6,26624,v4
ds_read2_b32 v[104:105],v5 offset1:32
ds_read2_b32 v[108:109],v6 offset1:32
ds_read2_b32 v[106:107],v5 offset0:64 offset1:96
ds_read2_b32 v[110:111],v6 offset0:64 offset1:96
s_waitcnt lgkmcnt(4)
v_perm_b32 v112,v100,v96,s61
v_perm_b32 v113,v101,v97,s61
v_perm_b32 v114,v102,v98,s61
v_perm_b32 v115,v103,v99,s61
v_perm_b32 v116,v100,v96,s62
v_perm_b32 v117,v101,v97,s62
v_perm_b32 v118,v102,v98,s62
v_perm_b32 v119,v103,v99,s62
v_accvgpr_write_b32 a96,v112
v_accvgpr_write_b32 a97,v113
v_accvgpr_write_b32 a98,v114
v_accvgpr_write_b32 a99,v115
v_accvgpr_write_b32 a104,v116
v_accvgpr_write_b32 a105,v117
v_accvgpr_write_b32 a106,v118
v_accvgpr_write_b32 a107,v119
v_xor_b32 v5,28672,v3
v_xor_b32 v6,28672,v4
ds_read2_b32 v[96:97],v5 offset1:32
ds_read2_b32 v[100:101],v6 offset1:32
ds_read2_b32 v[98:99],v5 offset0:64 offset1:96
ds_read2_b32 v[102:103],v6 offset0:64 offset1:96
s_waitcnt lgkmcnt(4)
v_perm_b32 v112,v108,v104,s61
v_perm_b32 v113,v109,v105,s61
v_perm_b32 v114,v110,v106,s61
v_perm_b32 v115,v111,v107,s61
v_perm_b32 v116,v108,v104,s62
v_perm_b32 v117,v109,v105,s62
v_perm_b32 v118,v110,v106,s62
v_perm_b32 v119,v111,v107,s62
v_accvgpr_write_b32 a100,v112
v_accvgpr_write_b32 a101,v113
v_accvgpr_write_b32 a102,v114
v_accvgpr_write_b32 a103,v115
v_accvgpr_write_b32 a108,v116
v_accvgpr_write_b32 a109,v117
v_accvgpr_write_b32 a110,v118
v_accvgpr_write_b32 a111,v119
v_xor_b32 v5,30720,v3
v_xor_b32 v6,30720,v4
ds_read2_b32 v[104:105],v5 offset1:32
ds_read2_b32 v[108:109],v6 offset1:32
ds_read2_b32 v[106:107],v5 offset0:64 offset1:96
ds_read2_b32 v[110:111],v6 offset0:64 offset1:96
s_waitcnt lgkmcnt(4)
v_perm_b32 v112,v100,v96,s61
v_perm_b32 v113,v101,v97,s61
v_perm_b32 v114,v102,v98,s61
v_perm_b32 v115,v103,v99,s61
v_perm_b32 v116,v100,v96,s62
v_perm_b32 v117,v101,v97,s62
v_perm_b32 v118,v102,v98,s62
v_perm_b32 v119,v103,v99,s62
v_accvgpr_write_b32 a112,v112
v_accvgpr_write_b32 a113,v113
v_accvgpr_write_b32 a114,v114
v_accvgpr_write_b32 a115,v115
v_accvgpr_write_b32 a120,v116
v_accvgpr_write_b32 a121,v117
v_accvgpr_write_b32 a122,v118
v_accvgpr_write_b32 a123,v119
s_waitcnt lgkmcnt(0)
v_perm_b32 v112,v108,v104,s61
v_perm_b32 v113,v109,v105,s61
v_perm_b32 v114,v110,v106,s61
v_perm_b32 v115,v111,v107,s61
v_perm_b32 v116,v108,v104,s62
v_perm_b32 v117,v109,v105,s62
v_perm_b32 v118,v110,v106,s62
v_perm_b32 v119,v111,v107,s62
v_accvgpr_write_b32 a116,v112
v_accvgpr_write_b32 a117,v113
v_accvgpr_write_b32 a118,v114
v_accvgpr_write_b32 a119,v115
v_accvgpr_write_b32 a124,v116
v_accvgpr_write_b32 a125,v117
v_accvgpr_write_b32 a126,v118
v_accvgpr_write_b32 a127,v119
s_cmp_lt_u32 s48,3
s_cbranch_scc1 L_rch_4
s_cmp_eq_u32 s48,3
s_cbranch_scc1 L_rm_5
v_mov_b32 v123,159744
s_cmp_lg_u32 s46,0
s_cbranch_scc1 L_gbd_20
v_mov_b32 v124,240
L_gb_19:
buffer_load_dword v125,v124,s[12:15],0 offen sc1
s_waitcnt vmcnt(0)
v_readfirstlane_b32 s56,v125
ds_write_b32 v123,v125
s_bitcmp1_b32 s56,8
s_cbranch_scc1 L_gbd_20
s_sleep 4
s_sub_u32 s49,s49,1
s_cmp_gt_i32 s49,0
s_cbranch_scc1 L_gb_19
s_branch L_abort
L_gbd_20:
s_waitcnt lgkmcnt(0)
s_barrier
ds_read_b32 v125,v123
s_waitcnt lgkmcnt(0)
v_readfirstlane_b32 s56,v125
s_barrier
s_lshr_b32 s56,s56,16
s_andn2_b32 s56,s56,s3
s_cbranch_scc1 L_spread
v_and_b32 v120,15,v1
v_lshrrev_b32 v121,4,v1
v_mov_b32 v17,1
s_lshl_b32 s56,s46,15
v_add_u32 v18,s56,v0
s_lshl_b32 s56,s46,2
v_add_u32 v125,s56,v121
v_xor_b32 v126,v125,v120
v_lshlrev_b32 v126,4,v126
v_lshl_add_u32 v20,v125,10,v126
v_add_u32 v125,0,v121
v_xor_b32 v125,v125,v120
v_lshlrev_b32 v125,4,v125
v_lshl_add_u32 v125,v120,8,v125
v_add_u32 v4,65536,v125
v_add_u32 v125,4,v121
v_xor_b32 v125,v125,v120
v_lshlrev_b32 v125,4,v125
v_lshl_add_u32 v125,v120,8,v125
v_add_u32 v5,65536,v125
v_add_u32 v125,8,v121
v_xor_b32 v125,v125,v120
v_lshlrev_b32 v125,4,v125
v_lshl_add_u32 v125,v120,8,v125
v_add_u32 v6,65536,v125
v_add_u32 v125,12,v121
v_xor_b32 v125,v125,v120
v_lshlrev_b32 v125,4,v125
v_lshl_add_u32 v125,v120,8,v125
v_add_u32 v7,65536,v125
v_lshlrev_b32 v21,5,v120
v_and_b32 v125,1,v121
v_lshl_add_u32 v21,v125,4,v21
s_lshl_b32 s56,s46,9
v_lshrrev_b32 v125,1,v121
v_lshl_add_u32 v21,v125,11,v21
s_add_u32 s56,s56,155648
v_add_u32 v21,s56,v21
v_lshlrev_b32 v22,4,v120
v_lshl_add_u32 v22,v121,10,v22
s_lshl_b32 s56,s46,8
v_add_u32 v22,s56,v22
s_sub_u32 s54,s48,4
s_cmp_eq_u32 s54,0
s_mov_b32 s72,1073752746
s_mov_b32 s73,1145324612
s_cmov_b32 s72,268440917
s_cmov_b32 s73,286331153
s_mov_b32 s70,0x80000000
s_mov_b32 s53,7
s_mov_b32 s74,s50
s_xor_b32 s75,s74,32768
v_and_b32 v23,31,v1
v_lshlrev_b32 v23,2,v23
v_mov_b32 v19,s50
v_mov_b32 v16,0
s_ff1_i32_b64 s55,s[72:73]
s_bitset0_b64 s[72:73],s55
s_min_u32 s55,s55,127
s_lshl_b32 s68,s55,15
s_add_u32 s68,s68,0
s_add_u32 s69,s68,16384
s_add_u32 m0,s75,65536
s_nop 0
buffer_load_dwordx4 v20,s[8:11],s68 offen offset:0 sc1 lds
s_add_u32 m0,s75,69632
s_nop 0
buffer_load_dwordx4 v20,s[8:11],s69 offen offset:0 sc1 lds
s_add_u32 m0,s75,73472
s_nop 0
buffer_load_dwordx4 v20,s[8:11],s68 offen offset:256 sc1 lds
s_add_u32 m0,s75,77568
s_nop 0
buffer_load_dwordx4 v20,s[8:11],s69 offen offset:256 sc1 lds
s_add_u32 m0,s75,81408
s_nop 0
buffer_load_dwordx4 v20,s[8:11],s68 offen offset:512 sc1 lds
s_add_u32 m0,s75,85504
s_nop 0
buffer_load_dwordx4 v20,s[8:11],s69 offen offset:512 sc1 lds
s_add_u32 m0,s75,89344
s_nop 0
buffer_load_dwordx4 v20,s[8:11],s68 offen offset:768 sc1 lds
s_add_u32 m0,s75,93440
s_nop 0
buffer_load_dwordx4 v20,s[8:11],s69 offen offset:768 sc1 lds
s_waitcnt vmcnt(0)
s_barrier
L_p_21:
s_mov_b32 s75,s74
s_xor_b32 s74,s74,32768
v_xor_b32 v4,32768,v4
v_xor_b32 v5,32768,v5
v_xor_b32 v6,32768,v6
v_xor_b32 v7,32768,v7
ds_read_b128 v[104:107],v4 offset:0
ds_read_b128 v[108:111],v4 offset:4096
ds_read_b128 v[112:115],v5 offset:0
ds_read_b128 v[116:119],v5 offset:4096
s_waitcnt lgkmcnt(2)
v_mfma_f32_16x16x32_bf16 v[24:27],a[128:131],v[104:107],0
ds_read_b128 v[120:123],v6 offset:0
v_mfma_f32_16x16x32_bf16 v[40:43],v[104:107],v[128:131],0
s_mov_b32 s51,s55
v_mfma_f32_16x16x32_bf16 v[28:31],a[128:131],v[108:111],0
ds_read_b128 v[124:127],v6 offset:4096
v_mfma_f32_16x16x32_bf16 v[44:47],v[108:111],v[128:131],0
s_mov_b32 s77,0
v_mfma_f32_16x16x32_bf16 v[32:35],a[136:139],v[104:107],0
s_sub_u32 s53,s53,1
v_mfma_f32_16x16x32_bf16 v[48:51],v[104:107],v[136:139],0
s_ff1_i32_b64 s55,s[72:73]
v_mfma_f32_16x16x32_bf16 v[36:39],a[136:139],v[108:111],0
s_bitset0_b64 s[72:73],s55
v_mfma_f32_16x16x32_bf16 v[52:55],v[108:111],v[136:139],0
s_min_u32 s55,s55,127
s_waitcnt lgkmcnt(2)
v_mfma_f32_16x16x32_bf16 v[24:27],a[132:135],v[112:115],v[24:27]
ds_read_b128 v[104:107],v7 offset:0
v_mfma_f32_16x16x32_bf16 v[40:43],v[112:115],v[132:135],v[40:43]
s_lshl_b32 s58,s51,5
v_mfma_f32_16x16x32_bf16 v[28:31],a[132:135],v[116:119],v[28:31]
ds_read_b128 v[108:111],v7 offset:4096
v_mfma_f32_16x16x32_bf16 v[44:47],v[116:119],v[132:135],v[44:47]
s_add_u32 s58,s58,s47
v_mfma_f32_16x16x32_bf16 v[32:35],a[140:143],v[112:115],v[32:35]
s_mul_i32 s58,s58,24576
v_mfma_f32_16x16x32_bf16 v[48:51],v[112:115],v[140:143],v[48:51]
s_add_u32 s58,s58,100663296
v_mfma_f32_16x16x32_bf16 v[36:39],a[140:143],v[116:119],v[36:39]
s_add_u32 s61,s58,s50
v_mfma_f32_16x16x32_bf16 v[52:55],v[116:119],v[140:143],v[52:55]
s_add_u32 s62,s61,4096
s_waitcnt lgkmcnt(2)
v_mfma_f32_16x16x32_bf16 v[24:27],a[144:147],v[120:123],v[24:27]
ds_read_b128 v[112:115],v4 offset:8192
v_mfma_f32_16x16x32_bf16 v[40:43],v[120:123],v[144:147],v[40:43]
s_add_u32 s63,s61,16384
v_mfma_f32_16x16x32_bf16 v[28:31],a[144:147],v[124:127],v[28:31]
ds_read_b128 v[116:119],v4 offset:12288
v_mfma_f32_16x16x32_bf16 v[44:47],v[124:127],v[144:147],v[44:47]
s_add_u32 s64,s61,20480
v_mfma_f32_16x16x32_bf16 v[32:35],a[152:155],v[120:123],v[32:35]
s_add_u32 s65,s61,s50
v_mfma_f32_16x16x32_bf16 v[48:51],v[120:123],v[152:155],v[48:51]
s_add_u32 s65,s65,8192
v_mfma_f32_16x16x32_bf16 v[36:39],a[152:155],v[124:127],v[36:39]
v_mfma_f32_16x16x32_bf16 v[52:55],v[124:127],v[152:155],v[52:55]
s_waitcnt lgkmcnt(2)
v_mfma_f32_16x16x32_bf16 v[24:27],a[148:151],v[104:107],v[24:27]
ds_read_b128 v[120:123],v5 offset:8192
v_mfma_f32_16x16x32_bf16 v[40:43],v[104:107],v[148:151],v[40:43]
v_mfma_f32_16x16x32_bf16 v[28:31],a[148:151],v[108:111],v[28:31]
ds_read_b128 v[124:127],v5 offset:12288
v_mfma_f32_16x16x32_bf16 v[44:47],v[108:111],v[148:151],v[44:47]
v_mfma_f32_16x16x32_bf16 v[32:35],a[156:159],v[104:107],v[32:35]
v_mfma_f32_16x16x32_bf16 v[48:51],v[104:107],v[156:159],v[48:51]
v_mfma_f32_16x16x32_bf16 v[36:39],a[156:159],v[108:111],v[36:39]
v_mfma_f32_16x16x32_bf16 v[52:55],v[108:111],v[156:159],v[52:55]
s_waitcnt lgkmcnt(2)
v_mfma_f32_16x16x32_bf16 v[24:27],a[160:163],v[112:115],v[24:27]
ds_read_b128 v[104:107],v6 offset:8192
v_mfma_f32_16x16x32_bf16 v[40:43],v[112:115],v[160:163],v[40:43]
v_mfma_f32_16x16x32_bf16 v[28:31],a[160:163],v[116:119],v[28:31]
ds_read_b128 v[108:111],v6 offset:12288
v_mfma_f32_16x16x32_bf16 v[44:47],v[116:119],v[160:163],v[44:47]
v_mfma_f32_16x16x32_bf16 v[32:35],a[168:171],v[112:115],v[32:35]
v_mfma_f32_16x16x32_bf16 v[48:51],v[112:115],v[168:171],v[48:51]
v_mfma_f32_16x16x32_bf16 v[36:39],a[168:171],v[116:119],v[36:39]
v_mfma_f32_16x16x32_bf16 v[52:55],v[116:119],v[168:171],v[52:55]
s_waitcnt lgkmcnt(2)
v_mfma_f32_16x16x32_bf16 v[24:27],a[164:167],v[120:123],v[24:27]
ds_read_b128 v[112:115],v7 offset:8192
v_mfma_f32_16x16x32_bf16 v[40:43],v[120:123],v[164:167],v[40:43]
s_lshl_b32 s56,s54,13
v_mfma_f32_16x16x32_bf16 v[28:31],a[164:167],v[124:127],v[28:31]
ds_read_b128 v[116:119],v7 offset:12288
v_mfma_f32_16x16x32_bf16 v[44:47],v[124:127],v[164:167],v[44:47]
s_add_u32 s56,s56,10487552
v_mfma_f32_16x16x32_bf16 v[32:35],a[172:175],v[120:123],v[32:35]
s_or_b32 s56,s56,s52
v_mfma_f32_16x16x32_bf16 v[48:51],v[120:123],v[172:175],v[48:51]
buffer_load_dword v76,v23,s[8:11],s56 offen sc1
v_mfma_f32_16x16x32_bf16 v[36:39],a[172:175],v[124:127],v[36:39]
v_mfma_f32_16x16x32_bf16 v[52:55],v[124:127],v[172:175],v[52:55]
s_waitcnt lgkmcnt(2)
v_mfma_f32_16x16x32_bf16 v[24:27],a[176:179],v[104:107],v[24:27]
ds_read_b128 v[120:123],v4 offset:16384
v_mfma_f32_16x16x32_bf16 v[40:43],v[104:107],v[176:179],v[40:43]
v_mfma_f32_16x16x32_bf16 v[28:31],a[176:179],v[108:111],v[28:31]
ds_read_b128 v[124:127],v4 offset:20480
v_mfma_f32_16x16x32_bf16 v[44:47],v[108:111],v[176:179],v[44:47]
v_mfma_f32_16x16x32_bf16 v[32:35],a[184:187],v[104:107],v[32:35]
v_mfma_f32_16x16x32_bf16 v[48:51],v[104:107],v[184:187],v[48:51]
v_mfma_f32_16x16x32_bf16 v[36:39],a[184:187],v[108:111],v[36:39]
v_mfma_f32_16x16x32_bf16 v[52:55],v[108:111],v[184:187],v[52:55]
s_waitcnt lgkmcnt(2)
v_mfma_f32_16x16x32_bf16 v[24:27],a[180:183],v[112:115],v[24:27]
ds_read_b128 v[104:107],v5 offset:16384
v_mfma_f32_16x16x32_bf16 v[40:43],v[112:115],v[180:183],v[40:43]
v_mfma_f32_16x16x32_bf16 v[28:31],a[180:183],v[116:119],v[28:31]
ds_read_b128 v[108:111],v5 offset:20480
v_mfma_f32_16x16x32_bf16 v[44:47],v[116:119],v[180:183],v[44:47]
v_mfma_f32_16x16x32_bf16 v[32:35],a[188:191],v[112:115],v[32:35]
v_mfma_f32_16x16x32_bf16 v[48:51],v[112:115],v[188:191],v[48:51]
v_mfma_f32_16x16x32_bf16 v[36:39],a[188:191],v[116:119],v[36:39]
v_mfma_f32_16x16x32_bf16 v[52:55],v[116:119],v[188:191],v[52:55]
s_waitcnt lgkmcnt(2)
v_mfma_f32_16x16x32_bf16 v[24:27],a[192:195],v[120:123],v[24:27]
ds_read_b128 v[112:115],v6 offset:16384
v_mfma_f32_16x16x32_bf16 v[40:43],v[120:123],v[192:195],v[40:43]
v_mfma_f32_16x16x32_bf16 v[28:31],a[192:195],v[124:127],v[28:31]
ds_read_b128 v[116:119],v6 offset:20480
v_mfma_f32_16x16x32_bf16 v[44:47],v[124:127],v[192:195],v[44:47]
v_mfma_f32_16x16x32_bf16 v[32:35],a[200:203],v[120:123],v[32:35]
v_mfma_f32_16x16x32_bf16 v[48:51],v[120:123],v[200:203],v[48:51]
v_mfma_f32_16x16x32_bf16 v[36:39],a[200:203],v[124:127],v[36:39]
v_mfma_f32_16x16x32_bf16 v[52:55],v[124:127],v[200:203],v[52:55]
s_waitcnt lgkmcnt(2)
v_mfma_f32_16x16x32_bf16 v[24:27],a[196:199],v[104:107],v[24:27]
ds_read_b128 v[120:123],v7 offset:16384
v_mfma_f32_16x16x32_bf16 v[40:43],v[104:107],v[196:199],v[40:43]
s_waitcnt vmcnt(0)
v_mfma_f32_16x16x32_bf16 v[28:31],a[196:199],v[108:111],v[28:31]
ds_read_b128 v[124:127],v7 offset:20480
v_mfma_f32_16x16x32_bf16 v[44:47],v[108:111],v[196:199],v[44:47]
v_cmp_eq_u32 vcc,0,v76
v_mfma_f32_16x16x32_bf16 v[32:35],a[204:207],v[104:107],v[32:35]
s_nop 0
v_mov_b32 v76,vcc_lo
v_mfma_f32_16x16x32_bf16 v[48:51],v[104:107],v[204:207],v[48:51]
ds_write_b32 v19,v76
v_mfma_f32_16x16x32_bf16 v[36:39],a[204:207],v[108:111],v[36:39]
v_mfma_f32_16x16x32_bf16 v[52:55],v[108:111],v[204:207],v[52:55]
s_waitcnt vmcnt(0) lgkmcnt(0)
s_barrier
s_or_b32 s70,s70,s52
buffer_store_dword v17,off,s[8:11],s70 sc1
ds_read_b32 v76,v16
v_mfma_f32_16x16x32_bf16 v[24:27],a[208:211],v[112:115],v[24:27]
ds_read_b128 v[104:107],v4 offset:24576
v_mfma_f32_16x16x32_bf16 v[40:43],v[112:115],v[208:211],v[40:43]
s_lshl_b32 s56,s51,5
s_add_u32 s56,s56,s47
s_lshl_b32 s56,s56,12
v_mfma_f32_16x16x32_bf16 v[28:31],a[208:211],v[116:119],v[28:31]
ds_read_b128 v[108:111],v4 offset:28672
v_mfma_f32_16x16x32_bf16 v[44:47],v[116:119],v[208:211],v[44:47]
s_add_u32 s56,s56,s50
s_add_u32 s56,s56,41943040
v_mfma_f32_16x16x32_bf16 v[32:35],a[216:219],v[112:115],v[32:35]
v_mov_b64 v[72:73],-1
v_mov_b64 v[74:75],-1
v_mfma_f32_16x16x32_bf16 v[48:51],v[112:115],v[216:219],v[48:51]
buffer_store_dwordx4 v[72:75],v0,s[8:11],s56 offen sc1
v_mfma_f32_16x16x32_bf16 v[36:39],a[216:219],v[116:119],v[36:39]
v_mfma_f32_16x16x32_bf16 v[52:55],v[116:119],v[216:219],v[52:55]
s_waitcnt lgkmcnt(2)
v_mfma_f32_16x16x32_bf16 v[24:27],a[212:215],v[120:123],v[24:27]
ds_read_b128 v[112:115],v5 offset:24576
v_mfma_f32_16x16x32_bf16 v[40:43],v[120:123],v[212:215],v[40:43]
v_readfirstlane_b32 s57,v76
v_mfma_f32_16x16x32_bf16 v[28:31],a[212:215],v[124:127],v[28:31]
ds_read_b128 v[116:119],v5 offset:28672
v_mfma_f32_16x16x32_bf16 v[44:47],v[124:127],v[212:215],v[44:47]
s_sub_u32 s59,s55,s54
s_cmp_lt_i32 s59,44
s_cselect_b32 s76,2,0
v_mfma_f32_16x16x32_bf16 v[32:35],a[220:223],v[120:123],v[32:35]
s_cmp_gt_i32 s53,0
s_cselect_b32 s76,s76,0
v_mfma_f32_16x16x32_bf16 v[48:51],v[120:123],v[220:223],v[48:51]
s_cmp_eq_u32 s57,0
s_cselect_b32 s76,1,s76
v_mfma_f32_16x16x32_bf16 v[36:39],a[220:223],v[124:127],v[36:39]
s_cmp_lt_i32 s59,12
s_cselect_b32 s76,2,s76
s_add_u32 s57,s54,64
v_mfma_f32_16x16x32_bf16 v[52:55],v[124:127],v[220:223],v[52:55]
s_cmp_eq_u32 s76,1
s_cselect_b32 s68,s57,s55
s_lshl_b32 s68,s68,15
s_waitcnt lgkmcnt(2)
v_mfma_f32_16x16x32_bf16 v[24:27],a[224:227],v[104:107],v[24:27]
ds_read_b128 v[120:123],v6 offset:24576
v_mfma_f32_16x16x32_bf16 v[40:43],v[104:107],v[224:227],v[40:43]
s_cmp_eq_u32 s76,0
s_cselect_b32 s68,0x80000000,s68
s_add_u32 s69,s68,16384
v_mfma_f32_16x16x32_bf16 v[28:31],a[224:227],v[108:111],v[28:31]
ds_read_b128 v[124:127],v6 offset:28672
v_mfma_f32_16x16x32_bf16 v[44:47],v[108:111],v[224:227],v[44:47]
s_add_u32 m0,s75,65536
v_mfma_f32_16x16x32_bf16 v[32:35],a[232:235],v[104:107],v[32:35]
buffer_load_dwordx4 v20,s[8:11],s68 offen offset:0 sc1 lds
v_mfma_f32_16x16x32_bf16 v[48:51],v[104:107],v[232:235],v[48:51]
s_add_u32 m0,s75,69632
v_mfma_f32_16x16x32_bf16 v[36:39],a[232:235],v[108:111],v[36:39]
buffer_load_dwordx4 v20,s[8:11],s69 offen offset:0 sc1 lds
v_mfma_f32_16x16x32_bf16 v[52:55],v[108:111],v[232:235],v[52:55]
s_add_u32 m0,s75,73472
s_waitcnt lgkmcnt(2)
v_mfma_f32_16x16x32_bf16 v[24:27],a[228:231],v[112:115],v[24:27]
ds_read_b128 v[104:107],v7 offset:24576
v_mfma_f32_16x16x32_bf16 v[40:43],v[112:115],v[228:231],v[40:43]
buffer_load_dwordx4 v20,s[8:11],s68 offen offset:256 sc1 lds
v_mfma_f32_16x16x32_bf16 v[28:31],a[228:231],v[116:119],v[28:31]
ds_read_b128 v[108:111],v7 offset:28672
v_mfma_f32_16x16x32_bf16 v[44:47],v[116:119],v[228:231],v[44:47]
s_add_u32 m0,s75,77568
v_mfma_f32_16x16x32_bf16 v[32:35],a[236:239],v[112:115],v[32:35]
buffer_load_dwordx4 v20,s[8:11],s69 offen offset:256 sc1 lds
v_mfma_f32_16x16x32_bf16 v[48:51],v[112:115],v[236:239],v[48:51]
s_add_u32 m0,s75,81408
v_mfma_f32_16x16x32_bf16 v[36:39],a[236:239],v[116:119],v[36:39]
buffer_load_dwordx4 v20,s[8:11],s68 offen offset:512 sc1 lds
v_mfma_f32_16x16x32_bf16 v[52:55],v[116:119],v[236:239],v[52:55]
s_add_u32 m0,s75,85504
s_waitcnt lgkmcnt(2)
v_mfma_f32_16x16x32_bf16 v[24:27],a[240:243],v[120:123],v[24:27]
ds_read_b128 v[112:115],v4 offset:0
v_mfma_f32_16x16x32_bf16 v[40:43],v[120:123],v[240:243],v[40:43]
buffer_load_dwordx4 v20,s[8:11],s69 offen offset:512 sc1 lds
v_mfma_f32_16x16x32_bf16 v[28:31],a[240:243],v[124:127],v[28:31]
ds_read_b128 v[116:119],v4 offset:4096
v_mfma_f32_16x16x32_bf16 v[44:47],v[124:127],v[240:243],v[44:47]
s_add_u32 m0,s75,89344
v_mfma_f32_16x16x32_bf16 v[32:35],a[248:251],v[120:123],v[32:35]
buffer_load_dwordx4 v20,s[8:11],s68 offen offset:768 sc1 lds
v_mfma_f32_16x16x32_bf16 v[48:51],v[120:123],v[248:251],v[48:51]
s_add_u32 m0,s75,93440
v_mfma_f32_16x16x32_bf16 v[36:39],a[248:251],v[124:127],v[36:39]
buffer_load_dwordx4 v20,s[8:11],s69 offen offset:768 sc1 lds
v_mfma_f32_16x16x32_bf16 v[52:55],v[124:127],v[248:251],v[52:55]
s_waitcnt lgkmcnt(2)
v_mfma_f32_16x16x32_bf16 v[24:27],a[244:247],v[104:107],v[24:27]
ds_read_b128 v[120:123],v5 offset:0
v_mfma_f32_16x16x32_bf16 v[40:43],v[104:107],v[244:247],v[40:43]
v_mfma_f32_16x16x32_bf16 v[28:31],a[244:247],v[108:111],v[28:31]
ds_read_b128 v[124:127],v5 offset:4096
v_mfma_f32_16x16x32_bf16 v[44:47],v[108:111],v[244:247],v[44:47]
v_mfma_f32_16x16x32_bf16 v[32:35],a[252:255],v[104:107],v[32:35]
v_mfma_f32_16x16x32_bf16 v[48:51],v[104:107],v[252:255],v[48:51]
v_mfma_f32_16x16x32_bf16 v[36:39],a[252:255],v[108:111],v[36:39]
v_mfma_f32_16x16x32_bf16 v[52:55],v[108:111],v[252:255],v[52:55]
s_waitcnt lgkmcnt(2)
v_mfma_f32_16x16x32_bf16 v[88:91],a[0:3],v[112:115],0
ds_read_b128 v[104:107],v6 offset:0
v_mfma_f32_16x16x32_bf16 v[92:95],a[0:3],v[116:119],0
v_mfma_f32_16x16x32_bf16 v[96:99],a[8:11],v[112:115],0
ds_read_b128 v[108:111],v6 offset:4096
v_cvt_pk_bf16_f32 v56,v24,v32
v_cvt_pk_bf16_f32 v57,v25,v33
v_mfma_f32_16x16x32_bf16 v[100:103],a[8:11],v[116:119],0
v_cvt_pk_bf16_f32 v58,v26,v34
v_cvt_pk_bf16_f32 v59,v27,v35
s_waitcnt lgkmcnt(2)
v_mfma_f32_16x16x32_bf16 v[88:91],a[4:7],v[120:123],v[88:91]
ds_read_b128 v[112:115],v7 offset:0
v_mfma_f32_16x16x32_bf16 v[92:95],a[4:7],v[124:127],v[92:95]
buffer_store_dwordx4 v[56:59],v0,s[8:11],s61 offen sc1
v_cvt_pk_bf16_f32 v60,v28,v36
v_cvt_pk_bf16_f32 v61,v29,v37
v_mfma_f32_16x16x32_bf16 v[96:99],a[12:15],v[120:123],v[96:99]
ds_read_b128 v[116:119],v7 offset:4096
v_cvt_pk_bf16_f32 v62,v30,v38
v_cvt_pk_bf16_f32 v63,v31,v39
v_mfma_f32_16x16x32_bf16 v[100:103],a[12:15],v[124:127],v[100:103]
buffer_store_dwordx4 v[60:63],v0,s[8:11],s62 offen sc1
v_cvt_pk_bf16_f32 v64,v40,v41
v_cvt_pk_bf16_f32 v65,v42,v43
s_waitcnt lgkmcnt(2)
v_mfma_f32_16x16x32_bf16 v[88:91],a[16:19],v[104:107],v[88:91]
ds_read_b128 v[120:123],v4 offset:8192
v_cvt_pk_bf16_f32 v66,v44,v45
v_cvt_pk_bf16_f32 v67,v46,v47
v_mfma_f32_16x16x32_bf16 v[92:95],a[16:19],v[108:111],v[92:95]
buffer_store_dwordx4 v[64:67],v0,s[8:11],s65 offen offset:0 sc1
v_cvt_pk_bf16_f32 v68,v48,v49
v_cvt_pk_bf16_f32 v69,v50,v51
v_mfma_f32_16x16x32_bf16 v[96:99],a[24:27],v[104:107],v[96:99]
ds_read_b128 v[124:127],v4 offset:12288
v_cvt_pk_bf16_f32 v70,v52,v53
v_cvt_pk_bf16_f32 v71,v54,v55
v_mfma_f32_16x16x32_bf16 v[100:103],a[24:27],v[108:111],v[100:103]
buffer_store_dwordx4 v[68:71],v0,s[8:11],s65 offen offset:1024 sc1
s_waitcnt lgkmcnt(2)
v_mfma_f32_16x16x32_bf16 v[88:91],a[20:23],v[112:115],v[88:91]
ds_read_b128 v[104:107],v5 offset:8192
v_mfma_f32_16x16x32_bf16 v[92:95],a[20:23],v[116:119],v[92:95]
v_mfma_f32_16x16x32_bf16 v[96:99],a[28:31],v[112:115],v[96:99]
ds_read_b128 v[108:111],v5 offset:12288
v_mfma_f32_16x16x32_bf16 v[100:103],a[28:31],v[116:119],v[100:103]
s_waitcnt lgkmcnt(2)
v_mfma_f32_16x16x32_bf16 v[88:91],a[32:35],v[120:123],v[88:91]
ds_read_b128 v[112:115],v6 offset:8192
v_mfma_f32_16x16x32_bf16 v[92:95],a[32:35],v[124:127],v[92:95]
v_mfma_f32_16x16x32_bf16 v[96:99],a[40:43],v[120:123],v[96:99]
ds_read_b128 v[116:119],v6 offset:12288
v_mfma_f32_16x16x32_bf16 v[100:103],a[40:43],v[124:127],v[100:103]
s_waitcnt lgkmcnt(2)
v_mfma_f32_16x16x32_bf16 v[88:91],a[36:39],v[104:107],v[88:91]
ds_read_b128 v[120:123],v7 offset:8192
v_mfma_f32_16x16x32_bf16 v[92:95],a[36:39],v[108:111],v[92:95]
s_lshl_b32 s56,s54,13
v_mfma_f32_16x16x32_bf16 v[96:99],a[44:47],v[104:107],v[96:99]
ds_read_b128 v[124:127],v7 offset:12288
v_mfma_f32_16x16x32_bf16 v[100:103],a[44:47],v[108:111],v[100:103]
s_add_u32 s56,s56,10487552
s_waitcnt lgkmcnt(2)
v_mfma_f32_16x16x32_bf16 v[88:91],a[48:51],v[112:115],v[88:91]
ds_read_b128 v[104:107],v4 offset:16384
v_mfma_f32_16x16x32_bf16 v[92:95],a[48:51],v[116:119],v[92:95]
s_or_b32 s56,s56,s52
v_mfma_f32_16x16x32_bf16 v[96:99],a[56:59],v[112:115],v[96:99]
ds_read_b128 v[108:111],v4 offset:20480
v_mfma_f32_16x16x32_bf16 v[100:103],a[56:59],v[116:119],v[100:103]
buffer_load_dword v76,v23,s[8:11],s56 offen sc1
s_waitcnt lgkmcnt(2)
v_mfma_f32_16x16x32_bf16 v[88:91],a[52:55],v[120:123],v[88:91]
ds_read_b128 v[112:115],v5 offset:16384
v_mfma_f32_16x16x32_bf16 v[92:95],a[52:55],v[124:127],v[92:95]
v_mfma_f32_16x16x32_bf16 v[96:99],a[60:63],v[120:123],v[96:99]
ds_read_b128 v[116:119],v5 offset:20480
v_mfma_f32_16x16x32_bf16 v[100:103],a[60:63],v[124:127],v[100:103]
s_waitcnt lgkmcnt(2)
v_mfma_f32_16x16x32_bf16 v[88:91],a[64:67],v[104:107],v[88:91]
ds_read_b128 v[120:123],v6 offset:16384
v_mfma_f32_16x16x32_bf16 v[92:95],a[64:67],v[108:111],v[92:95]
v_mfma_f32_16x16x32_bf16 v[96:99],a[72:75],v[104:107],v[96:99]
ds_read_b128 v[124:127],v6 offset:20480
v_mfma_f32_16x16x32_bf16 v[100:103],a[72:75],v[108:111],v[100:103]
s_waitcnt lgkmcnt(2)
v_mfma_f32_16x16x32_bf16 v[88:91],a[68:71],v[112:115],v[88:91]
ds_read_b128 v[104:107],v7 offset:16384
v_mfma_f32_16x16x32_bf16 v[92:95],a[68:71],v[116:119],v[92:95]
v_mfma_f32_16x16x32_bf16 v[96:99],a[76:79],v[112:115],v[96:99]
ds_read_b128 v[108:111],v7 offset:20480
v_mfma_f32_16x16x32_bf16 v[100:103],a[76:79],v[116:119],v[100:103]
s_waitcnt lgkmcnt(2)
v_mfma_f32_16x16x32_bf16 v[88:91],a[80:83],v[120:123],v[88:91]
ds_read_b128 v[112:115],v4 offset:24576
v_mfma_f32_16x16x32_bf16 v[92:95],a[80:83],v[124:127],v[92:95]
v_mfma_f32_16x16x32_bf16 v[96:99],a[88:91],v[120:123],v[96:99]
ds_read_b128 v[116:119],v4 offset:28672
v_mfma_f32_16x16x32_bf16 v[100:103],a[88:91],v[124:127],v[100:103]
s_waitcnt lgkmcnt(2)
v_mfma_f32_16x16x32_bf16 v[88:91],a[84:87],v[104:107],v[88:91]
ds_read_b128 v[120:123],v5 offset:24576
v_mfma_f32_16x16x32_bf16 v[92:95],a[84:87],v[108:111],v[92:95]
v_mfma_f32_16x16x32_bf16 v[96:99],a[92:95],v[104:107],v[96:99]
ds_read_b128 v[124:127],v5 offset:28672
v_mfma_f32_16x16x32_bf16 v[100:103],a[92:95],v[108:111],v[100:103]
s_waitcnt lgkmcnt(2)
v_mfma_f32_16x16x32_bf16 v[88:91],a[96:99],v[112:115],v[88:91]
ds_read_b128 v[104:107],v6 offset:24576
v_mfma_f32_16x16x32_bf16 v[92:95],a[96:99],v[116:119],v[92:95]
v_mfma_f32_16x16x32_bf16 v[96:99],a[104:107],v[112:115],v[96:99]
ds_read_b128 v[108:111],v6 offset:28672
v_mfma_f32_16x16x32_bf16 v[100:103],a[104:107],v[116:119],v[100:103]
s_waitcnt lgkmcnt(2)
v_mfma_f32_16x16x32_bf16 v[88:91],a[100:103],v[120:123],v[88:91]
ds_read_b128 v[112:115],v7 offset:24576
v_mfma_f32_16x16x32_bf16 v[92:95],a[100:103],v[124:127],v[92:95]
v_mfma_f32_16x16x32_bf16 v[96:99],a[108:111],v[120:123],v[96:99]
ds_read_b128 v[116:119],v7 offset:28672
v_mfma_f32_16x16x32_bf16 v[100:103],a[108:111],v[124:127],v[100:103]
s_waitcnt lgkmcnt(2)
v_mfma_f32_16x16x32_bf16 v[88:91],a[112:115],v[104:107],v[88:91]
v_mfma_f32_16x16x32_bf16 v[92:95],a[112:115],v[108:111],v[92:95]
v_mfma_f32_16x16x32_bf16 v[96:99],a[120:123],v[104:107],v[96:99]
v_mfma_f32_16x16x32_bf16 v[100:103],a[120:123],v[108:111],v[100:103]
s_waitcnt lgkmcnt(0)
v_mfma_f32_16x16x32_bf16 v[88:91],a[116:119],v[112:115],v[88:91]
v_mfma_f32_16x16x32_bf16 v[92:95],a[116:119],v[116:119],v[92:95]
v_mfma_f32_16x16x32_bf16 v[96:99],a[124:127],v[112:115],v[96:99]
v_mfma_f32_16x16x32_bf16 v[100:103],a[124:127],v[116:119],v[100:103]
s_nop 3
v_cvt_pk_bf16_f32 v104,v88,v96
v_cvt_pk_bf16_f32 v105,v89,v97
v_cvt_pk_bf16_f32 v106,v90,v98
v_cvt_pk_bf16_f32 v107,v91,v99
v_cvt_pk_bf16_f32 v108,v92,v100
v_cvt_pk_bf16_f32 v109,v93,v101
v_cvt_pk_bf16_f32 v110,v94,v102
v_cvt_pk_bf16_f32 v111,v95,v103
buffer_store_dwordx4 v[104:107],v0,s[8:11],s63 offen sc1
buffer_store_dwordx4 v[108:111],v0,s[8:11],s64 offen sc1
s_waitcnt vmcnt(7)
s_barrier
s_lshl_b32 s70,s51,13
s_lshl2_add_u32 s70,s47,s70
s_add_u32 s70,s70,10485760
s_cmp_ge_u32 s51,2
s_cbranch_scc1 L_p_23
s_waitcnt vmcnt(0)
s_barrier
s_or_b32 s70,s70,s52
buffer_store_dword v17,off,s[8:11],s70 sc1
L_p_23:
s_cmp_eq_u32 s76,2
s_cbranch_scc1 L_p_21
s_mov_b32 s53,0
s_mov_b32 s51,s54
s_add_u32 s54,s54,2
s_cmp_eq_u32 s76,1
s_cbranch_scc1 L_p_22
s_cmp_lg_u32 s77,0
s_waitcnt vmcnt(3)
s_cbranch_scc1 L_p_25
s_waitcnt vmcnt(2)
L_p_25:
v_cmp_eq_u32 vcc,0,v76
s_nop 1
v_mov_b32 v76,vcc_lo
ds_write_b32 v19,v76
s_lshl_b32 s66,s51,15
s_add_u32 s66,s66,2097152
s_add_u32 s67,s66,16384
s_waitcnt lgkmcnt(0)
s_barrier
ds_read_b32 v76,v16
s_waitcnt lgkmcnt(0)
v_cmp_eq_u32 vcc,0,v76
s_cbranch_vccnz L_p_26
s_waitcnt vmcnt(0)
s_barrier
s_or_b32 s70,s70,s52
buffer_store_dword v17,off,s[8:11],s70 sc1
s_mov_b32 s70,0x80000000
s_mov_b32 s53,1
s_cmp_ge_u32 s51,64
s_cbranch_scc1 L_p_24
s_lshl_b32 s59,s51,13
s_add_u32 s59,s59,10487552
s_cmp_lg_u32 s46,0
s_cbranch_scc1 L_fd_28
v_and_b32 v124,31,v1
v_lshlrev_b32 v124,2,v124
s_branch L_ff_29
L_fw_27:
s_sleep 2
L_ff_29:
buffer_load_dword v125,v124,s[8:11],s59 offen sc1
s_sub_u32 s49,s49,1
s_cbranch_scc1 L_abort
s_waitcnt vmcnt(0)
v_cmp_eq_u32 vcc,0,v125
s_cbranch_vccnz L_fw_27
L_fd_28:
s_barrier
L_p_26:
s_add_u32 m0,s74,65536
s_nop 0
buffer_load_dwordx4 v20,s[8:11],s66 offen offset:0 sc1 lds
s_add_u32 m0,s74,69632
s_nop 0
buffer_load_dwordx4 v20,s[8:11],s67 offen offset:0 sc1 lds
s_add_u32 m0,s74,73472
s_nop 0
buffer_load_dwordx4 v20,s[8:11],s66 offen offset:256 sc1 lds
s_add_u32 m0,s74,77568
s_nop 0
buffer_load_dwordx4 v20,s[8:11],s67 offen offset:256 sc1 lds
s_add_u32 m0,s74,81408
s_nop 0
buffer_load_dwordx4 v20,s[8:11],s66 offen offset:512 sc1 lds
s_add_u32 m0,s74,85504
s_nop 0
buffer_load_dwordx4 v20,s[8:11],s67 offen offset:512 sc1 lds
s_add_u32 m0,s74,89344
s_nop 0
buffer_load_dwordx4 v20,s[8:11],s66 offen offset:768 sc1 lds
s_add_u32 m0,s74,93440
s_nop 0
buffer_load_dwordx4 v20,s[8:11],s67 offen offset:768 sc1 lds
s_lshl_b32 s56,s54,13
s_add_u32 s56,s56,10487552
s_or_b32 s56,s56,s52
buffer_load_dword v76,v23,s[8:11],s56 offen sc1
s_waitcnt vmcnt(7)
s_barrier
ds_read_b128 v[104:107],v4 offset:0
ds_read_b128 v[108:111],v4 offset:4096
ds_read_b128 v[112:115],v5 offset:0
ds_read_b128 v[116:119],v5 offset:4096
s_waitcnt lgkmcnt(2)
v_mfma_f32_16x16x32_bf16 v[24:27],a[128:131],v[104:107],0
ds_read_b128 v[120:123],v6 offset:0
v_mfma_f32_16x16x32_bf16 v[40:43],v[104:107],v[128:131],0
s_lshl_b32 s58,s51,5
v_mfma_f32_16x16x32_bf16 v[28:31],a[128:131],v[108:111],0
ds_read_b128 v[124:127],v6 offset:4096
v_mfma_f32_16x16x32_bf16 v[44:47],v[108:111],v[128:131],0
s_add_u32 s58,s58,s47
v_mfma_f32_16x16x32_bf16 v[32:35],a[136:139],v[104:107],0
s_mul_i32 s58,s58,24576
v_mfma_f32_16x16x32_bf16 v[48:51],v[104:107],v[136:139],0
s_add_u32 s58,s58,150994944
v_mfma_f32_16x16x32_bf16 v[36:39],a[136:139],v[108:111],0
s_add_u32 s61,s58,s50
v_mfma_f32_16x16x32_bf16 v[52:55],v[108:111],v[136:139],0
s_add_u32 s62,s61,4096
s_waitcnt lgkmcnt(2)
v_mfma_f32_16x16x32_bf16 v[24:27],a[132:135],v[112:115],v[24:27]
ds_read_b128 v[104:107],v7 offset:0
v_mfma_f32_16x16x32_bf16 v[40:43],v[112:115],v[132:135],v[40:43]
s_add_u32 s63,s61,16384
v_mfma_f32_16x16x32_bf16 v[28:31],a[132:135],v[116:119],v[28:31]
ds_read_b128 v[108:111],v7 offset:4096
v_mfma_f32_16x16x32_bf16 v[44:47],v[116:119],v[132:135],v[44:47]
s_add_u32 s64,s61,20480
v_mfma_f32_16x16x32_bf16 v[32:35],a[140:143],v[112:115],v[32:35]
s_add_u32 s65,s61,s50
v_mfma_f32_16x16x32_bf16 v[48:51],v[112:115],v[140:143],v[48:51]
s_add_u32 s65,s65,8192
v_mfma_f32_16x16x32_bf16 v[36:39],a[140:143],v[116:119],v[36:39]
v_mfma_f32_16x16x32_bf16 v[52:55],v[116:119],v[140:143],v[52:55]
s_waitcnt vmcnt(5)
s_barrier
s_waitcnt lgkmcnt(2)
v_mfma_f32_16x16x32_bf16 v[24:27],a[144:147],v[120:123],v[24:27]
ds_read_b128 v[112:115],v4 offset:8192
v_mfma_f32_16x16x32_bf16 v[40:43],v[120:123],v[144:147],v[40:43]
v_mfma_f32_16x16x32_bf16 v[28:31],a[144:147],v[124:127],v[28:31]
ds_read_b128 v[116:119],v4 offset:12288
v_mfma_f32_16x16x32_bf16 v[44:47],v[124:127],v[144:147],v[44:47]
v_mfma_f32_16x16x32_bf16 v[32:35],a[152:155],v[120:123],v[32:35]
v_mfma_f32_16x16x32_bf16 v[48:51],v[120:123],v[152:155],v[48:51]
v_mfma_f32_16x16x32_bf16 v[36:39],a[152:155],v[124:127],v[36:39]
v_mfma_f32_16x16x32_bf16 v[52:55],v[124:127],v[152:155],v[52:55]
s_waitcnt lgkmcnt(2)
v_mfma_f32_16x16x32_bf16 v[24:27],a[148:151],v[104:107],v[24:27]
ds_read_b128 v[120:123],v5 offset:8192
v_mfma_f32_16x16x32_bf16 v[40:43],v[104:107],v[148:151],v[40:43]
v_mfma_f32_16x16x32_bf16 v[28:31],a[148:151],v[108:111],v[28:31]
ds_read_b128 v[124:127],v5 offset:12288
v_mfma_f32_16x16x32_bf16 v[44:47],v[108:111],v[148:151],v[44:47]
v_mfma_f32_16x16x32_bf16 v[32:35],a[156:159],v[104:107],v[32:35]
v_mfma_f32_16x16x32_bf16 v[48:51],v[104:107],v[156:159],v[48:51]
v_mfma_f32_16x16x32_bf16 v[36:39],a[156:159],v[108:111],v[36:39]
v_mfma_f32_16x16x32_bf16 v[52:55],v[108:111],v[156:159],v[52:55]
s_waitcnt lgkmcnt(2)
v_mfma_f32_16x16x32_bf16 v[24:27],a[160:163],v[112:115],v[24:27]
ds_read_b128 v[104:107],v6 offset:8192
v_mfma_f32_16x16x32_bf16 v[40:43],v[112:115],v[160:163],v[40:43]
v_mfma_f32_16x16x32_bf16 v[28:31],a[160:163],v[116:119],v[28:31]
ds_read_b128 v[108:111],v6 offset:12288
v_mfma_f32_16x16x32_bf16 v[44:47],v[116:119],v[160:163],v[44:47]
v_mfma_f32_16x16x32_bf16 v[32:35],a[168:171],v[112:115],v[32:35]
v_mfma_f32_16x16x32_bf16 v[48:51],v[112:115],v[168:171],v[48:51]
v_mfma_f32_16x16x32_bf16 v[36:39],a[168:171],v[116:119],v[36:39]
v_mfma_f32_16x16x32_bf16 v[52:55],v[116:119],v[168:171],v[52:55]
s_waitcnt lgkmcnt(2)
v_mfma_f32_16x16x32_bf16 v[24:27],a[164:167],v[120:123],v[24:27]
ds_read_b128 v[112:115],v7 offset:8192
v_mfma_f32_16x16x32_bf16 v[40:43],v[120:123],v[164:167],v[40:43]
v_mfma_f32_16x16x32_bf16 v[28:31],a[164:167],v[124:127],v[28:31]
ds_read_b128 v[116:119],v7 offset:12288
v_mfma_f32_16x16x32_bf16 v[44:47],v[124:127],v[164:167],v[44:47]
v_mfma_f32_16x16x32_bf16 v[32:35],a[172:175],v[120:123],v[32:35]
v_mfma_f32_16x16x32_bf16 v[48:51],v[120:123],v[172:175],v[48:51]
v_mfma_f32_16x16x32_bf16 v[36:39],a[172:175],v[124:127],v[36:39]
v_mfma_f32_16x16x32_bf16 v[52:55],v[124:127],v[172:175],v[52:55]
s_waitcnt vmcnt(3)
s_barrier
s_waitcnt lgkmcnt(2)
v_mfma_f32_16x16x32_bf16 v[24:27],a[176:179],v[104:107],v[24:27]
ds_read_b128 v[120:123],v4 offset:16384
v_mfma_f32_16x16x32_bf16 v[40:43],v[104:107],v[176:179],v[40:43]
v_mfma_f32_16x16x32_bf16 v[28:31],a[176:179],v[108:111],v[28:31]
ds_read_b128 v[124:127],v4 offset:20480
v_mfma_f32_16x16x32_bf16 v[44:47],v[108:111],v[176:179],v[44:47]
v_mfma_f32_16x16x32_bf16 v[32:35],a[184:187],v[104:107],v[32:35]
v_mfma_f32_16x16x32_bf16 v[48:51],v[104:107],v[184:187],v[48:51]
v_mfma_f32_16x16x32_bf16 v[36:39],a[184:187],v[108:111],v[36:39]
v_mfma_f32_16x16x32_bf16 v[52:55],v[108:111],v[184:187],v[52:55]
s_waitcnt lgkmcnt(2)
v_mfma_f32_16x16x32_bf16 v[24:27],a[180:183],v[112:115],v[24:27]
ds_read_b128 v[104:107],v5 offset:16384
v_mfma_f32_16x16x32_bf16 v[40:43],v[112:115],v[180:183],v[40:43]
v_mfma_f32_16x16x32_bf16 v[28:31],a[180:183],v[116:119],v[28:31]
ds_read_b128 v[108:111],v5 offset:20480
v_mfma_f32_16x16x32_bf16 v[44:47],v[116:119],v[180:183],v[44:47]
v_mfma_f32_16x16x32_bf16 v[32:35],a[188:191],v[112:115],v[32:35]
v_mfma_f32_16x16x32_bf16 v[48:51],v[112:115],v[188:191],v[48:51]
v_mfma_f32_16x16x32_bf16 v[36:39],a[188:191],v[116:119],v[36:39]
v_mfma_f32_16x16x32_bf16 v[52:55],v[116:119],v[188:191],v[52:55]
s_waitcnt lgkmcnt(2)
v_mfma_f32_16x16x32_bf16 v[24:27],a[192:195],v[120:123],v[24:27]
ds_read_b128 v[112:115],v6 offset:16384
v_mfma_f32_16x16x32_bf16 v[40:43],v[120:123],v[192:195],v[40:43]
v_mfma_f32_16x16x32_bf16 v[28:31],a[192:195],v[124:127],v[28:31]
ds_read_b128 v[116:119],v6 offset:20480
v_mfma_f32_16x16x32_bf16 v[44:47],v[124:127],v[192:195],v[44:47]
v_mfma_f32_16x16x32_bf16 v[32:35],a[200:203],v[120:123],v[32:35]
v_mfma_f32_16x16x32_bf16 v[48:51],v[120:123],v[200:203],v[48:51]
v_mfma_f32_16x16x32_bf16 v[36:39],a[200:203],v[124:127],v[36:39]
v_mfma_f32_16x16x32_bf16 v[52:55],v[124:127],v[200:203],v[52:55]
s_waitcnt lgkmcnt(2)
v_mfma_f32_16x16x32_bf16 v[24:27],a[196:199],v[104:107],v[24:27]
ds_read_b128 v[120:123],v7 offset:16384
v_mfma_f32_16x16x32_bf16 v[40:43],v[104:107],v[196:199],v[40:43]
s_waitcnt vmcnt(0)
v_mfma_f32_16x16x32_bf16 v[28:31],a[196:199],v[108:111],v[28:31]
ds_read_b128 v[124:127],v7 offset:20480
v_mfma_f32_16x16x32_bf16 v[44:47],v[108:111],v[196:199],v[44:47]
v_cmp_eq_u32 vcc,0,v76
v_mfma_f32_16x16x32_bf16 v[32:35],a[204:207],v[104:107],v[32:35]
s_nop 0
v_mov_b32 v76,vcc_lo
v_mfma_f32_16x16x32_bf16 v[48:51],v[104:107],v[204:207],v[48:51]
ds_write_b32 v19,v76
v_mfma_f32_16x16x32_bf16 v[36:39],a[204:207],v[108:111],v[36:39]
v_mfma_f32_16x16x32_bf16 v[52:55],v[108:111],v[204:207],v[52:55]
s_waitcnt vmcnt(0) lgkmcnt(0)
s_barrier
s_or_b32 s70,s70,s52
buffer_store_dword v17,off,s[8:11],s70 sc1
ds_read_b32 v76,v16
v_mfma_f32_16x16x32_bf16 v[24:27],a[208:211],v[112:115],v[24:27]
ds_read_b128 v[104:107],v4 offset:24576
v_mfma_f32_16x16x32_bf16 v[40:43],v[112:115],v[208:211],v[40:43]
s_lshl_b32 s56,s51,5
s_add_u32 s56,s56,s47
s_lshl_b32 s56,s56,12
v_mfma_f32_16x16x32_bf16 v[28:31],a[208:211],v[116:119],v[28:31]
ds_read_b128 v[108:111],v4 offset:28672
v_mfma_f32_16x16x32_bf16 v[44:47],v[116:119],v[208:211],v[44:47]
s_add_u32 s56,s56,s50
s_add_u32 s56,s56,58720256
v_mfma_f32_16x16x32_bf16 v[32:35],a[216:219],v[112:115],v[32:35]
v_mov_b64 v[72:73],-1
v_mov_b64 v[74:75],-1
v_mfma_f32_16x16x32_bf16 v[48:51],v[112:115],v[216:219],v[48:51]
buffer_store_dwordx4 v[72:75],v0,s[8:11],s56 offen sc1
v_mfma_f32_16x16x32_bf16 v[36:39],a[216:219],v[116:119],v[36:39]
s_add_u32 s56,s56,16777216
v_mfma_f32_16x16x32_bf16 v[52:55],v[116:119],v[216:219],v[52:55]
buffer_store_dwordx4 v[72:75],v0,s[8:11],s56 offen sc1
s_waitcnt lgkmcnt(2)
v_mfma_f32_16x16x32_bf16 v[24:27],a[212:215],v[120:123],v[24:27]
ds_read_b128 v[112:115],v5 offset:24576
v_mfma_f32_16x16x32_bf16 v[40:43],v[120:123],v[212:215],v[40:43]
v_readfirstlane_b32 s57,v76
v_mfma_f32_16x16x32_bf16 v[28:31],a[212:215],v[124:127],v[28:31]
ds_read_b128 v[116:119],v5 offset:28672
v_mfma_f32_16x16x32_bf16 v[44:47],v[124:127],v[212:215],v[44:47]
s_sub_u32 s59,s55,s54
s_cmp_lt_i32 s59,44
s_cselect_b32 s76,2,0
v_mfma_f32_16x16x32_bf16 v[32:35],a[220:223],v[120:123],v[32:35]
s_cmp_gt_i32 s53,0
s_cselect_b32 s76,s76,0
v_mfma_f32_16x16x32_bf16 v[48:51],v[120:123],v[220:223],v[48:51]
s_cmp_eq_u32 s57,0
s_cselect_b32 s76,1,s76
v_mfma_f32_16x16x32_bf16 v[36:39],a[220:223],v[124:127],v[36:39]
s_cmp_lt_i32 s59,12
s_cselect_b32 s76,2,s76
s_add_u32 s57,s54,64
v_mfma_f32_16x16x32_bf16 v[52:55],v[124:127],v[220:223],v[52:55]
s_cmp_eq_u32 s76,1
s_cselect_b32 s68,s57,s55
s_lshl_b32 s68,s68,15
s_waitcnt lgkmcnt(2)
v_mfma_f32_16x16x32_bf16 v[24:27],a[224:227],v[104:107],v[24:27]
ds_read_b128 v[120:123],v6 offset:24576
v_mfma_f32_16x16x32_bf16 v[40:43],v[104:107],v[224:227],v[40:43]
s_cmp_eq_u32 s76,0
s_cselect_b32 s68,0x80000000,s68
s_add_u32 s69,s68,16384
v_mfma_f32_16x16x32_bf16 v[28:31],a[224:227],v[108:111],v[28:31]
ds_read_b128 v[124:127],v6 offset:28672
v_mfma_f32_16x16x32_bf16 v[44:47],v[108:111],v[224:227],v[44:47]
s_add_u32 m0,s75,65536
v_mfma_f32_16x16x32_bf16 v[32:35],a[232:235],v[104:107],v[32:35]
buffer_load_dwordx4 v20,s[8:11],s68 offen offset:0 sc1 lds
v_mfma_f32_16x16x32_bf16 v[48:51],v[104:107],v[232:235],v[48:51]
s_add_u32 m0,s75,69632
v_mfma_f32_16x16x32_bf16 v[36:39],a[232:235],v[108:111],v[36:39]
buffer_load_dwordx4 v20,s[8:11],s69 offen offset:0 sc1 lds
v_mfma_f32_16x16x32_bf16 v[52:55],v[108:111],v[232:235],v[52:55]
s_add_u32 m0,s75,73472
s_waitcnt lgkmcnt(2)
v_mfma_f32_16x16x32_bf16 v[24:27],a[228:231],v[112:115],v[24:27]
ds_read_b128 v[104:107],v7 offset:24576
v_mfma_f32_16x16x32_bf16 v[40:43],v[112:115],v[228:231],v[40:43]
buffer_load_dwordx4 v20,s[8:11],s68 offen offset:256 sc1 lds
v_mfma_f32_16x16x32_bf16 v[28:31],a[228:231],v[116:119],v[28:31]
ds_read_b128 v[108:111],v7 offset:28672
v_mfma_f32_16x16x32_bf16 v[44:47],v[116:119],v[228:231],v[44:47]
s_add_u32 m0,s75,77568
v_mfma_f32_16x16x32_bf16 v[32:35],a[236:239],v[112:115],v[32:35]
buffer_load_dwordx4 v20,s[8:11],s69 offen offset:256 sc1 lds
v_mfma_f32_16x16x32_bf16 v[48:51],v[112:115],v[236:239],v[48:51]
s_add_u32 m0,s75,81408
v_mfma_f32_16x16x32_bf16 v[36:39],a[236:239],v[116:119],v[36:39]
buffer_load_dwordx4 v20,s[8:11],s68 offen offset:512 sc1 lds
v_mfma_f32_16x16x32_bf16 v[52:55],v[116:119],v[236:239],v[52:55]
s_add_u32 m0,s75,85504
s_waitcnt lgkmcnt(2)
v_mfma_f32_16x16x32_bf16 v[24:27],a[240:243],v[120:123],v[24:27]
ds_read_b128 v[112:115],v4 offset:0
v_mfma_f32_16x16x32_bf16 v[40:43],v[120:123],v[240:243],v[40:43]
buffer_load_dwordx4 v20,s[8:11],s69 offen offset:512 sc1 lds
v_mfma_f32_16x16x32_bf16 v[28:31],a[240:243],v[124:127],v[28:31]
ds_read_b128 v[116:119],v4 offset:4096
v_mfma_f32_16x16x32_bf16 v[44:47],v[124:127],v[240:243],v[44:47]
s_add_u32 m0,s75,89344
v_mfma_f32_16x16x32_bf16 v[32:35],a[248:251],v[120:123],v[32:35]
buffer_load_dwordx4 v20,s[8:11],s68 offen offset:768 sc1 lds
v_mfma_f32_16x16x32_bf16 v[48:51],v[120:123],v[248:251],v[48:51]
s_add_u32 m0,s75,93440
v_mfma_f32_16x16x32_bf16 v[36:39],a[248:251],v[124:127],v[36:39]
buffer_load_dwordx4 v20,s[8:11],s69 offen offset:768 sc1 lds
v_mfma_f32_16x16x32_bf16 v[52:55],v[124:127],v[248:251],v[52:55]
s_waitcnt lgkmcnt(2)
v_mfma_f32_16x16x32_bf16 v[24:27],a[244:247],v[104:107],v[24:27]
ds_read_b128 v[120:123],v5 offset:0
v_mfma_f32_16x16x32_bf16 v[40:43],v[104:107],v[244:247],v[40:43]
v_mfma_f32_16x16x32_bf16 v[28:31],a[244:247],v[108:111],v[28:31]
ds_read_b128 v[124:127],v5 offset:4096
v_mfma_f32_16x16x32_bf16 v[44:47],v[108:111],v[244:247],v[44:47]
v_mfma_f32_16x16x32_bf16 v[32:35],a[252:255],v[104:107],v[32:35]
v_mfma_f32_16x16x32_bf16 v[48:51],v[104:107],v[252:255],v[48:51]
v_mfma_f32_16x16x32_bf16 v[36:39],a[252:255],v[108:111],v[36:39]
v_mfma_f32_16x16x32_bf16 v[52:55],v[108:111],v[252:255],v[52:55]
s_waitcnt lgkmcnt(2)
v_mfma_f32_16x16x32_bf16 v[88:91],a[0:3],v[112:115],0
ds_read_b128 v[104:107],v6 offset:0
v_mfma_f32_16x16x32_bf16 v[92:95],a[0:3],v[116:119],0
v_mfma_f32_16x16x32_bf16 v[96:99],a[8:11],v[112:115],0
ds_read_b128 v[108:111],v6 offset:4096
v_cvt_pk_bf16_f32 v56,v24,v32
v_cvt_pk_bf16_f32 v57,v25,v33
v_mfma_f32_16x16x32_bf16 v[100:103],a[8:11],v[116:119],0
v_cvt_pk_bf16_f32 v58,v26,v34
v_cvt_pk_bf16_f32 v59,v27,v35
s_waitcnt lgkmcnt(2)
v_mfma_f32_16x16x32_bf16 v[88:91],a[4:7],v[120:123],v[88:91]
ds_read_b128 v[112:115],v7 offset:0
v_mfma_f32_16x16x32_bf16 v[92:95],a[4:7],v[124:127],v[92:95]
buffer_store_dwordx4 v[56:59],v0,s[8:11],s61 offen sc1
v_cvt_pk_bf16_f32 v60,v28,v36
v_cvt_pk_bf16_f32 v61,v29,v37
v_mfma_f32_16x16x32_bf16 v[96:99],a[12:15],v[120:123],v[96:99]
ds_read_b128 v[116:119],v7 offset:4096
v_cvt_pk_bf16_f32 v62,v30,v38
v_cvt_pk_bf16_f32 v63,v31,v39
v_mfma_f32_16x16x32_bf16 v[100:103],a[12:15],v[124:127],v[100:103]
buffer_store_dwordx4 v[60:63],v0,s[8:11],s62 offen sc1
v_cvt_pk_bf16_f32 v64,v40,v41
v_cvt_pk_bf16_f32 v65,v42,v43
s_waitcnt lgkmcnt(2)
v_mfma_f32_16x16x32_bf16 v[88:91],a[16:19],v[104:107],v[88:91]
ds_read_b128 v[120:123],v4 offset:8192
v_cvt_pk_bf16_f32 v66,v44,v45
v_cvt_pk_bf16_f32 v67,v46,v47
v_mfma_f32_16x16x32_bf16 v[92:95],a[16:19],v[108:111],v[92:95]
buffer_store_dwordx4 v[64:67],v0,s[8:11],s65 offen offset:0 sc1
v_cvt_pk_bf16_f32 v68,v48,v49
v_cvt_pk_bf16_f32 v69,v50,v51
v_mfma_f32_16x16x32_bf16 v[96:99],a[24:27],v[104:107],v[96:99]
ds_read_b128 v[124:127],v4 offset:12288
v_cvt_pk_bf16_f32 v70,v52,v53
v_cvt_pk_bf16_f32 v71,v54,v55
v_mfma_f32_16x16x32_bf16 v[100:103],a[24:27],v[108:111],v[100:103]
buffer_store_dwordx4 v[68:71],v0,s[8:11],s65 offen offset:1024 sc1
s_waitcnt lgkmcnt(2)
v_mfma_f32_16x16x32_bf16 v[88:91],a[20:23],v[112:115],v[88:91]
ds_read_b128 v[104:107],v5 offset:8192
v_mfma_f32_16x16x32_bf16 v[92:95],a[20:23],v[116:119],v[92:95]
v_mfma_f32_16x16x32_bf16 v[96:99],a[28:31],v[112:115],v[96:99]
ds_read_b128 v[108:111],v5 offset:12288
v_mfma_f32_16x16x32_bf16 v[100:103],a[28:31],v[116:119],v[100:103]
s_waitcnt lgkmcnt(2)
v_mfma_f32_16x16x32_bf16 v[88:91],a[32:35],v[120:123],v[88:91]
ds_read_b128 v[112:115],v6 offset:8192
v_mfma_f32_16x16x32_bf16 v[92:95],a[32:35],v[124:127],v[92:95]
v_mfma_f32_16x16x32_bf16 v[96:99],a[40:43],v[120:123],v[96:99]
ds_read_b128 v[116:119],v6 offset:12288
v_mfma_f32_16x16x32_bf16 v[100:103],a[40:43],v[124:127],v[100:103]
s_waitcnt lgkmcnt(2)
v_mfma_f32_16x16x32_bf16 v[88:91],a[36:39],v[104:107],v[88:91]
ds_read_b128 v[120:123],v7 offset:8192
v_mfma_f32_16x16x32_bf16 v[92:95],a[36:39],v[108:111],v[92:95]
s_lshl_b32 s56,s54,13
v_mfma_f32_16x16x32_bf16 v[96:99],a[44:47],v[104:107],v[96:99]
ds_read_b128 v[124:127],v7 offset:12288
v_mfma_f32_16x16x32_bf16 v[100:103],a[44:47],v[108:111],v[100:103]
s_add_u32 s56,s56,10487552
s_waitcnt lgkmcnt(2)
v_mfma_f32_16x16x32_bf16 v[88:91],a[48:51],v[112:115],v[88:91]
ds_read_b128 v[104:107],v4 offset:16384
v_mfma_f32_16x16x32_bf16 v[92:95],a[48:51],v[116:119],v[92:95]
s_or_b32 s56,s56,s52
v_mfma_f32_16x16x32_bf16 v[96:99],a[56:59],v[112:115],v[96:99]
ds_read_b128 v[108:111],v4 offset:20480
v_mfma_f32_16x16x32_bf16 v[100:103],a[56:59],v[116:119],v[100:103]
buffer_load_dword v76,v23,s[8:11],s56 offen sc1
s_waitcnt lgkmcnt(2)
v_mfma_f32_16x16x32_bf16 v[88:91],a[52:55],v[120:123],v[88:91]
ds_read_b128 v[112:115],v5 offset:16384
v_mfma_f32_16x16x32_bf16 v[92:95],a[52:55],v[124:127],v[92:95]
v_mfma_f32_16x16x32_bf16 v[96:99],a[60:63],v[120:123],v[96:99]
ds_read_b128 v[116:119],v5 offset:20480
v_mfma_f32_16x16x32_bf16 v[100:103],a[60:63],v[124:127],v[100:103]
s_waitcnt lgkmcnt(2)
v_mfma_f32_16x16x32_bf16 v[88:91],a[64:67],v[104:107],v[88:91]
ds_read_b128 v[120:123],v6 offset:16384
v_mfma_f32_16x16x32_bf16 v[92:95],a[64:67],v[108:111],v[92:95]
v_mfma_f32_16x16x32_bf16 v[96:99],a[72:75],v[104:107],v[96:99]
ds_read_b128 v[124:127],v6 offset:20480
v_mfma_f32_16x16x32_bf16 v[100:103],a[72:75],v[108:111],v[100:103]
s_waitcnt lgkmcnt(2)
v_mfma_f32_16x16x32_bf16 v[88:91],a[68:71],v[112:115],v[88:91]
ds_read_b128 v[104:107],v7 offset:16384
v_mfma_f32_16x16x32_bf16 v[92:95],a[68:71],v[116:119],v[92:95]
v_mfma_f32_16x16x32_bf16 v[96:99],a[76:79],v[112:115],v[96:99]
ds_read_b128 v[108:111],v7 offset:20480
v_mfma_f32_16x16x32_bf16 v[100:103],a[76:79],v[116:119],v[100:103]
s_waitcnt lgkmcnt(2)
v_mfma_f32_16x16x32_bf16 v[88:91],a[80:83],v[120:123],v[88:91]
ds_read_b128 v[112:115],v4 offset:24576
v_mfma_f32_16x16x32_bf16 v[92:95],a[80:83],v[124:127],v[92:95]
v_mfma_f32_16x16x32_bf16 v[96:99],a[88:91],v[120:123],v[96:99]
ds_read_b128 v[116:119],v4 offset:28672
v_mfma_f32_16x16x32_bf16 v[100:103],a[88:91],v[124:127],v[100:103]
s_waitcnt lgkmcnt(2)
v_mfma_f32_16x16x32_bf16 v[88:91],a[84:87],v[104:107],v[88:91]
ds_read_b128 v[120:123],v5 offset:24576
v_mfma_f32_16x16x32_bf16 v[92:95],a[84:87],v[108:111],v[92:95]
v_mfma_f32_16x16x32_bf16 v[96:99],a[92:95],v[104:107],v[96:99]
ds_read_b128 v[124:127],v5 offset:28672
v_mfma_f32_16x16x32_bf16 v[100:103],a[92:95],v[108:111],v[100:103]
s_waitcnt lgkmcnt(2)
v_mfma_f32_16x16x32_bf16 v[88:91],a[96:99],v[112:115],v[88:91]
ds_read_b128 v[104:107],v6 offset:24576
v_mfma_f32_16x16x32_bf16 v[92:95],a[96:99],v[116:119],v[92:95]
v_mfma_f32_16x16x32_bf16 v[96:99],a[104:107],v[112:115],v[96:99]
ds_read_b128 v[108:111],v6 offset:28672
v_mfma_f32_16x16x32_bf16 v[100:103],a[104:107],v[116:119],v[100:103]
s_waitcnt lgkmcnt(2)
v_mfma_f32_16x16x32_bf16 v[88:91],a[100:103],v[120:123],v[88:91]
ds_read_b128 v[112:115],v7 offset:24576
v_mfma_f32_16x16x32_bf16 v[92:95],a[100:103],v[124:127],v[92:95]
v_mfma_f32_16x16x32_bf16 v[96:99],a[108:111],v[120:123],v[96:99]
ds_read_b128 v[116:119],v7 offset:28672
v_mfma_f32_16x16x32_bf16 v[100:103],a[108:111],v[124:127],v[100:103]
s_waitcnt lgkmcnt(2)
v_mfma_f32_16x16x32_bf16 v[88:91],a[112:115],v[104:107],v[88:91]
v_mfma_f32_16x16x32_bf16 v[92:95],a[112:115],v[108:111],v[92:95]
v_mfma_f32_16x16x32_bf16 v[96:99],a[120:123],v[104:107],v[96:99]
v_mfma_f32_16x16x32_bf16 v[100:103],a[120:123],v[108:111],v[100:103]
s_waitcnt lgkmcnt(0)
v_mfma_f32_16x16x32_bf16 v[88:91],a[116:119],v[112:115],v[88:91]
v_mfma_f32_16x16x32_bf16 v[92:95],a[116:119],v[116:119],v[92:95]
v_mfma_f32_16x16x32_bf16 v[96:99],a[124:127],v[112:115],v[96:99]
v_mfma_f32_16x16x32_bf16 v[100:103],a[124:127],v[116:119],v[100:103]
s_nop 3
v_cvt_pk_bf16_f32 v104,v88,v96
v_cvt_pk_bf16_f32 v105,v89,v97
v_cvt_pk_bf16_f32 v106,v90,v98
v_cvt_pk_bf16_f32 v107,v91,v99
v_cvt_pk_bf16_f32 v108,v92,v100
v_cvt_pk_bf16_f32 v109,v93,v101
v_cvt_pk_bf16_f32 v110,v94,v102
v_cvt_pk_bf16_f32 v111,v95,v103
buffer_store_dwordx4 v[104:107],v0,s[8:11],s63 offen sc1
buffer_store_dwordx4 v[108:111],v0,s[8:11],s64 offen sc1
s_lshl_b32 s59,s51,13
s_lshl2_add_u32 s59,s47,s59
s_add_u32 s59,s59,10485888
s_waitcnt vmcnt(3)
s_barrier
s_or_b32 s59,s59,s52
buffer_store_dword v17,off,s[8:11],s59 sc1
s_mov_b32 s77,1
s_lshl_b32 s70,s51,13
s_lshl2_add_u32 s70,s47,s70
s_add_u32 s70,s70,10486144
s_branch L_p_23
L_p_22:
s_mov_b32 s75,s74
s_xor_b32 s74,s74,32768
v_xor_b32 v4,32768,v4
v_xor_b32 v5,32768,v5
v_xor_b32 v6,32768,v6
v_xor_b32 v7,32768,v7
ds_read_b128 v[104:107],v4 offset:0
ds_read_b128 v[108:111],v4 offset:4096
ds_read_b128 v[112:115],v5 offset:0
ds_read_b128 v[116:119],v5 offset:4096
s_waitcnt lgkmcnt(2)
v_mfma_f32_16x16x32_bf16 v[24:27],a[128:131],v[104:107],0
ds_read_b128 v[120:123],v6 offset:0
v_mfma_f32_16x16x32_bf16 v[40:43],v[104:107],v[128:131],0
s_lshl_b32 s58,s51,5
v_mfma_f32_16x16x32_bf16 v[28:31],a[128:131],v[108:111],0
ds_read_b128 v[124:127],v6 offset:4096
v_mfma_f32_16x16x32_bf16 v[44:47],v[108:111],v[128:131],0
s_add_u32 s58,s58,s47
v_mfma_f32_16x16x32_bf16 v[32:35],a[136:139],v[104:107],0
s_mul_i32 s58,s58,24576
v_mfma_f32_16x16x32_bf16 v[48:51],v[104:107],v[136:139],0
s_add_u32 s58,s58,150994944
v_mfma_f32_16x16x32_bf16 v[36:39],a[136:139],v[108:111],0
s_add_u32 s61,s58,s50
v_mfma_f32_16x16x32_bf16 v[52:55],v[108:111],v[136:139],0
s_add_u32 s62,s61,4096
s_waitcnt lgkmcnt(2)
v_mfma_f32_16x16x32_bf16 v[24:27],a[132:135],v[112:115],v[24:27]
ds_read_b128 v[104:107],v7 offset:0
v_mfma_f32_16x16x32_bf16 v[40:43],v[112:115],v[132:135],v[40:43]
s_add_u32 s63,s61,16384
v_mfma_f32_16x16x32_bf16 v[28:31],a[132:135],v[116:119],v[28:31]
ds_read_b128 v[108:111],v7 offset:4096
v_mfma_f32_16x16x32_bf16 v[44:47],v[116:119],v[132:135],v[44:47]
s_add_u32 s64,s61,20480
v_mfma_f32_16x16x32_bf16 v[32:35],a[140:143],v[112:115],v[32:35]
s_add_u32 s65,s61,s50
v_mfma_f32_16x16x32_bf16 v[48:51],v[112:115],v[140:143],v[48:51]
s_add_u32 s65,s65,8192
v_mfma_f32_16x16x32_bf16 v[36:39],a[140:143],v[116:119],v[36:39]
v_mfma_f32_16x16x32_bf16 v[52:55],v[116:119],v[140:143],v[52:55]
s_waitcnt lgkmcnt(2)
v_mfma_f32_16x16x32_bf16 v[24:27],a[144:147],v[120:123],v[24:27]
ds_read_b128 v[112:115],v4 offset:8192
v_mfma_f32_16x16x32_bf16 v[40:43],v[120:123],v[144:147],v[40:43]
v_mfma_f32_16x16x32_bf16 v[28:31],a[144:147],v[124:127],v[28:31]
ds_read_b128 v[116:119],v4 offset:12288
v_mfma_f32_16x16x32_bf16 v[44:47],v[124:127],v[144:147],v[44:47]
v_mfma_f32_16x16x32_bf16 v[32:35],a[152:155],v[120:123],v[32:35]
v_mfma_f32_16x16x32_bf16 v[48:51],v[120:123],v[152:155],v[48:51]
v_mfma_f32_16x16x32_bf16 v[36:39],a[152:155],v[124:127],v[36:39]
v_mfma_f32_16x16x32_bf16 v[52:55],v[124:127],v[152:155],v[52:55]
s_waitcnt lgkmcnt(2)
v_mfma_f32_16x16x32_bf16 v[24:27],a[148:151],v[104:107],v[24:27]
ds_read_b128 v[120:123],v5 offset:8192
v_mfma_f32_16x16x32_bf16 v[40:43],v[104:107],v[148:151],v[40:43]
v_mfma_f32_16x16x32_bf16 v[28:31],a[148:151],v[108:111],v[28:31]
ds_read_b128 v[124:127],v5 offset:12288
v_mfma_f32_16x16x32_bf16 v[44:47],v[108:111],v[148:151],v[44:47]
v_mfma_f32_16x16x32_bf16 v[32:35],a[156:159],v[104:107],v[32:35]
v_mfma_f32_16x16x32_bf16 v[48:51],v[104:107],v[156:159],v[48:51]
v_mfma_f32_16x16x32_bf16 v[36:39],a[156:159],v[108:111],v[36:39]
v_mfma_f32_16x16x32_bf16 v[52:55],v[108:111],v[156:159],v[52:55]
s_waitcnt lgkmcnt(2)
v_mfma_f32_16x16x32_bf16 v[24:27],a[160:163],v[112:115],v[24:27]
ds_read_b128 v[104:107],v6 offset:8192
v_mfma_f32_16x16x32_bf16 v[40:43],v[112:115],v[160:163],v[40:43]
v_mfma_f32_16x16x32_bf16 v[28:31],a[160:163],v[116:119],v[28:31]
ds_read_b128 v[108:111],v6 offset:12288
v_mfma_f32_16x16x32_bf16 v[44:47],v[116:119],v[160:163],v[44:47]
v_mfma_f32_16x16x32_bf16 v[32:35],a[168:171],v[112:115],v[32:35]
v_mfma_f32_16x16x32_bf16 v[48:51],v[112:115],v[168:171],v[48:51]
v_mfma_f32_16x16x32_bf16 v[36:39],a[168:171],v[116:119],v[36:39]
v_mfma_f32_16x16x32_bf16 v[52:55],v[116:119],v[168:171],v[52:55]
s_waitcnt lgkmcnt(2)
v_mfma_f32_16x16x32_bf16 v[24:27],a[164:167],v[120:123],v[24:27]
ds_read_b128 v[112:115],v7 offset:8192
v_mfma_f32_16x16x32_bf16 v[40:43],v[120:123],v[164:167],v[40:43]
s_lshl_b32 s56,s54,13
v_mfma_f32_16x16x32_bf16 v[28:31],a[164:167],v[124:127],v[28:31]
ds_read_b128 v[116:119],v7 offset:12288
v_mfma_f32_16x16x32_bf16 v[44:47],v[124:127],v[164:167],v[44:47]
s_add_u32 s56,s56,10487552
v_mfma_f32_16x16x32_bf16 v[32:35],a[172:175],v[120:123],v[32:35]
s_or_b32 s56,s56,s52
v_mfma_f32_16x16x32_bf16 v[48:51],v[120:123],v[172:175],v[48:51]
buffer_load_dword v76,v23,s[8:11],s56 offen sc1
v_mfma_f32_16x16x32_bf16 v[36:39],a[172:175],v[124:127],v[36:39]
v_mfma_f32_16x16x32_bf16 v[52:55],v[124:127],v[172:175],v[52:55]
s_waitcnt lgkmcnt(2)
v_mfma_f32_16x16x32_bf16 v[24:27],a[176:179],v[104:107],v[24:27]
ds_read_b128 v[120:123],v4 offset:16384
v_mfma_f32_16x16x32_bf16 v[40:43],v[104:107],v[176:179],v[40:43]
v_mfma_f32_16x16x32_bf16 v[28:31],a[176:179],v[108:111],v[28:31]
ds_read_b128 v[124:127],v4 offset:20480
v_mfma_f32_16x16x32_bf16 v[44:47],v[108:111],v[176:179],v[44:47]
v_mfma_f32_16x16x32_bf16 v[32:35],a[184:187],v[104:107],v[32:35]
v_mfma_f32_16x16x32_bf16 v[48:51],v[104:107],v[184:187],v[48:51]
v_mfma_f32_16x16x32_bf16 v[36:39],a[184:187],v[108:111],v[36:39]
v_mfma_f32_16x16x32_bf16 v[52:55],v[108:111],v[184:187],v[52:55]
s_waitcnt lgkmcnt(2)
v_mfma_f32_16x16x32_bf16 v[24:27],a[180:183],v[112:115],v[24:27]
ds_read_b128 v[104:107],v5 offset:16384
v_mfma_f32_16x16x32_bf16 v[40:43],v[112:115],v[180:183],v[40:43]
v_mfma_f32_16x16x32_bf16 v[28:31],a[180:183],v[116:119],v[28:31]
ds_read_b128 v[108:111],v5 offset:20480
v_mfma_f32_16x16x32_bf16 v[44:47],v[116:119],v[180:183],v[44:47]
v_mfma_f32_16x16x32_bf16 v[32:35],a[188:191],v[112:115],v[32:35]
v_mfma_f32_16x16x32_bf16 v[48:51],v[112:115],v[188:191],v[48:51]
v_mfma_f32_16x16x32_bf16 v[36:39],a[188:191],v[116:119],v[36:39]
v_mfma_f32_16x16x32_bf16 v[52:55],v[116:119],v[188:191],v[52:55]
s_waitcnt lgkmcnt(2)
v_mfma_f32_16x16x32_bf16 v[24:27],a[192:195],v[120:123],v[24:27]
ds_read_b128 v[112:115],v6 offset:16384
v_mfma_f32_16x16x32_bf16 v[40:43],v[120:123],v[192:195],v[40:43]
v_mfma_f32_16x16x32_bf16 v[28:31],a[192:195],v[124:127],v[28:31]
ds_read_b128 v[116:119],v6 offset:20480
v_mfma_f32_16x16x32_bf16 v[44:47],v[124:127],v[192:195],v[44:47]
v_mfma_f32_16x16x32_bf16 v[32:35],a[200:203],v[120:123],v[32:35]
v_mfma_f32_16x16x32_bf16 v[48:51],v[120:123],v[200:203],v[48:51]
v_mfma_f32_16x16x32_bf16 v[36:39],a[200:203],v[124:127],v[36:39]
v_mfma_f32_16x16x32_bf16 v[52:55],v[124:127],v[200:203],v[52:55]
s_waitcnt lgkmcnt(2)
v_mfma_f32_16x16x32_bf16 v[24:27],a[196:199],v[104:107],v[24:27]
ds_read_b128 v[120:123],v7 offset:16384
v_mfma_f32_16x16x32_bf16 v[40:43],v[104:107],v[196:199],v[40:43]
s_waitcnt vmcnt(0)
v_mfma_f32_16x16x32_bf16 v[28:31],a[196:199],v[108:111],v[28:31]
ds_read_b128 v[124:127],v7 offset:20480
v_mfma_f32_16x16x32_bf16 v[44:47],v[108:111],v[196:199],v[44:47]
v_cmp_eq_u32 vcc,0,v76
v_mfma_f32_16x16x32_bf16 v[32:35],a[204:207],v[104:107],v[32:35]
s_nop 0
v_mov_b32 v76,vcc_lo
v_mfma_f32_16x16x32_bf16 v[48:51],v[104:107],v[204:207],v[48:51]
ds_write_b32 v19,v76
v_mfma_f32_16x16x32_bf16 v[36:39],a[204:207],v[108:111],v[36:39]
v_mfma_f32_16x16x32_bf16 v[52:55],v[108:111],v[204:207],v[52:55]
s_waitcnt vmcnt(0) lgkmcnt(0)
s_barrier
s_or_b32 s70,s70,s52
buffer_store_dword v17,off,s[8:11],s70 sc1
ds_read_b32 v76,v16
v_mfma_f32_16x16x32_bf16 v[24:27],a[208:211],v[112:115],v[24:27]
ds_read_b128 v[104:107],v4 offset:24576
v_mfma_f32_16x16x32_bf16 v[40:43],v[112:115],v[208:211],v[40:43]
s_lshl_b32 s56,s51,5
s_add_u32 s56,s56,s47
s_lshl_b32 s56,s56,12
v_mfma_f32_16x16x32_bf16 v[28:31],a[208:211],v[116:119],v[28:31]
ds_read_b128 v[108:111],v4 offset:28672
v_mfma_f32_16x16x32_bf16 v[44:47],v[116:119],v[208:211],v[44:47]
s_add_u32 s56,s56,s50
s_add_u32 s56,s56,58720256
v_mfma_f32_16x16x32_bf16 v[32:35],a[216:219],v[112:115],v[32:35]
v_mov_b64 v[72:73],-1
v_mov_b64 v[74:75],-1
v_mfma_f32_16x16x32_bf16 v[48:51],v[112:115],v[216:219],v[48:51]
buffer_store_dwordx4 v[72:75],v0,s[8:11],s56 offen sc1
v_mfma_f32_16x16x32_bf16 v[36:39],a[216:219],v[116:119],v[36:39]
s_add_u32 s56,s56,16777216
v_mfma_f32_16x16x32_bf16 v[52:55],v[116:119],v[216:219],v[52:55]
buffer_store_dwordx4 v[72:75],v0,s[8:11],s56 offen sc1
s_waitcnt lgkmcnt(2)
v_mfma_f32_16x16x32_bf16 v[24:27],a[212:215],v[120:123],v[24:27]
ds_read_b128 v[112:115],v5 offset:24576
v_mfma_f32_16x16x32_bf16 v[40:43],v[120:123],v[212:215],v[40:43]
v_readfirstlane_b32 s57,v76
v_mfma_f32_16x16x32_bf16 v[28:31],a[212:215],v[124:127],v[28:31]
ds_read_b128 v[116:119],v5 offset:28672
v_mfma_f32_16x16x32_bf16 v[44:47],v[124:127],v[212:215],v[44:47]
s_sub_u32 s59,s55,s54
s_cmp_lt_i32 s59,44
s_cselect_b32 s76,2,0
v_mfma_f32_16x16x32_bf16 v[32:35],a[220:223],v[120:123],v[32:35]
s_cmp_gt_i32 s53,0
s_cselect_b32 s76,s76,0
v_mfma_f32_16x16x32_bf16 v[48:51],v[120:123],v[220:223],v[48:51]
s_cmp_eq_u32 s57,0
s_cselect_b32 s76,1,s76
v_mfma_f32_16x16x32_bf16 v[36:39],a[220:223],v[124:127],v[36:39]
s_cmp_lt_i32 s59,12
s_cselect_b32 s76,2,s76
s_add_u32 s57,s54,64
v_mfma_f32_16x16x32_bf16 v[52:55],v[124:127],v[220:223],v[52:55]
s_cmp_eq_u32 s76,1
s_cselect_b32 s68,s57,s55
s_lshl_b32 s68,s68,15
s_waitcnt lgkmcnt(2)
v_mfma_f32_16x16x32_bf16 v[24:27],a[224:227],v[104:107],v[24:27]
ds_read_b128 v[120:123],v6 offset:24576
v_mfma_f32_16x16x32_bf16 v[40:43],v[104:107],v[224:227],v[40:43]
s_cmp_eq_u32 s76,0
s_cselect_b32 s68,0x80000000,s68
s_add_u32 s69,s68,16384
v_mfma_f32_16x16x32_bf16 v[28:31],a[224:227],v[108:111],v[28:31]
ds_read_b128 v[124:127],v6 offset:28672
v_mfma_f32_16x16x32_bf16 v[44:47],v[108:111],v[224:227],v[44:47]
s_add_u32 m0,s75,65536
v_mfma_f32_16x16x32_bf16 v[32:35],a[232:235],v[104:107],v[32:35]
buffer_load_dwordx4 v20,s[8:11],s68 offen offset:0 sc1 lds
v_mfma_f32_16x16x32_bf16 v[48:51],v[104:107],v[232:235],v[48:51]
s_add_u32 m0,s75,69632
v_mfma_f32_16x16x32_bf16 v[36:39],a[232:235],v[108:111],v[36:39]
buffer_load_dwordx4 v20,s[8:11],s69 offen offset:0 sc1 lds
v_mfma_f32_16x16x32_bf16 v[52:55],v[108:111],v[232:235],v[52:55]
s_add_u32 m0,s75,73472
s_waitcnt lgkmcnt(2)
v_mfma_f32_16x16x32_bf16 v[24:27],a[228:231],v[112:115],v[24:27]
ds_read_b128 v[104:107],v7 offset:24576
v_mfma_f32_16x16x32_bf16 v[40:43],v[112:115],v[228:231],v[40:43]
buffer_load_dwordx4 v20,s[8:11],s68 offen offset:256 sc1 lds
v_mfma_f32_16x16x32_bf16 v[28:31],a[228:231],v[116:119],v[28:31]
ds_read_b128 v[108:111],v7 offset:28672
v_mfma_f32_16x16x32_bf16 v[44:47],v[116:119],v[228:231],v[44:47]
s_add_u32 m0,s75,77568
v_mfma_f32_16x16x32_bf16 v[32:35],a[236:239],v[112:115],v[32:35]
buffer_load_dwordx4 v20,s[8:11],s69 offen offset:256 sc1 lds
v_mfma_f32_16x16x32_bf16 v[48:51],v[112:115],v[236:239],v[48:51]
s_add_u32 m0,s75,81408
v_mfma_f32_16x16x32_bf16 v[36:39],a[236:239],v[116:119],v[36:39]
buffer_load_dwordx4 v20,s[8:11],s68 offen offset:512 sc1 lds
v_mfma_f32_16x16x32_bf16 v[52:55],v[116:119],v[236:239],v[52:55]
s_add_u32 m0,s75,85504
s_waitcnt lgkmcnt(2)
v_mfma_f32_16x16x32_bf16 v[24:27],a[240:243],v[120:123],v[24:27]
ds_read_b128 v[112:115],v4 offset:0
v_mfma_f32_16x16x32_bf16 v[40:43],v[120:123],v[240:243],v[40:43]
buffer_load_dwordx4 v20,s[8:11],s69 offen offset:512 sc1 lds
v_mfma_f32_16x16x32_bf16 v[28:31],a[240:243],v[124:127],v[28:31]
ds_read_b128 v[116:119],v4 offset:4096
v_mfma_f32_16x16x32_bf16 v[44:47],v[124:127],v[240:243],v[44:47]
s_add_u32 m0,s75,89344
v_mfma_f32_16x16x32_bf16 v[32:35],a[248:251],v[120:123],v[32:35]
buffer_load_dwordx4 v20,s[8:11],s68 offen offset:768 sc1 lds
v_mfma_f32_16x16x32_bf16 v[48:51],v[120:123],v[248:251],v[48:51]
s_add_u32 m0,s75,93440
v_mfma_f32_16x16x32_bf16 v[36:39],a[248:251],v[124:127],v[36:39]
buffer_load_dwordx4 v20,s[8:11],s69 offen offset:768 sc1 lds
v_mfma_f32_16x16x32_bf16 v[52:55],v[124:127],v[248:251],v[52:55]
s_waitcnt lgkmcnt(2)
v_mfma_f32_16x16x32_bf16 v[24:27],a[244:247],v[104:107],v[24:27]
ds_read_b128 v[120:123],v5 offset:0
v_mfma_f32_16x16x32_bf16 v[40:43],v[104:107],v[244:247],v[40:43]
v_mfma_f32_16x16x32_bf16 v[28:31],a[244:247],v[108:111],v[28:31]
ds_read_b128 v[124:127],v5 offset:4096
v_mfma_f32_16x16x32_bf16 v[44:47],v[108:111],v[244:247],v[44:47]
v_mfma_f32_16x16x32_bf16 v[32:35],a[252:255],v[104:107],v[32:35]
v_mfma_f32_16x16x32_bf16 v[48:51],v[104:107],v[252:255],v[48:51]
v_mfma_f32_16x16x32_bf16 v[36:39],a[252:255],v[108:111],v[36:39]
v_mfma_f32_16x16x32_bf16 v[52:55],v[108:111],v[252:255],v[52:55]
s_waitcnt lgkmcnt(2)
v_mfma_f32_16x16x32_bf16 v[88:91],a[0:3],v[112:115],0
ds_read_b128 v[104:107],v6 offset:0
v_mfma_f32_16x16x32_bf16 v[92:95],a[0:3],v[116:119],0
v_mfma_f32_16x16x32_bf16 v[96:99],a[8:11],v[112:115],0
ds_read_b128 v[108:111],v6 offset:4096
v_cvt_pk_bf16_f32 v56,v24,v32
v_cvt_pk_bf16_f32 v57,v25,v33
v_mfma_f32_16x16x32_bf16 v[100:103],a[8:11],v[116:119],0
v_cvt_pk_bf16_f32 v58,v26,v34
v_cvt_pk_bf16_f32 v59,v27,v35
s_waitcnt lgkmcnt(2)
v_mfma_f32_16x16x32_bf16 v[88:91],a[4:7],v[120:123],v[88:91]
ds_read_b128 v[112:115],v7 offset:0
v_mfma_f32_16x16x32_bf16 v[92:95],a[4:7],v[124:127],v[92:95]
buffer_store_dwordx4 v[56:59],v0,s[8:11],s61 offen sc1
v_cvt_pk_bf16_f32 v60,v28,v36
v_cvt_pk_bf16_f32 v61,v29,v37
v_mfma_f32_16x16x32_bf16 v[96:99],a[12:15],v[120:123],v[96:99]
ds_read_b128 v[116:119],v7 offset:4096
v_cvt_pk_bf16_f32 v62,v30,v38
v_cvt_pk_bf16_f32 v63,v31,v39
v_mfma_f32_16x16x32_bf16 v[100:103],a[12:15],v[124:127],v[100:103]
buffer_store_dwordx4 v[60:63],v0,s[8:11],s62 offen sc1
v_cvt_pk_bf16_f32 v64,v40,v41
v_cvt_pk_bf16_f32 v65,v42,v43
s_waitcnt lgkmcnt(2)
v_mfma_f32_16x16x32_bf16 v[88:91],a[16:19],v[104:107],v[88:91]
ds_read_b128 v[120:123],v4 offset:8192
v_cvt_pk_bf16_f32 v66,v44,v45
v_cvt_pk_bf16_f32 v67,v46,v47
v_mfma_f32_16x16x32_bf16 v[92:95],a[16:19],v[108:111],v[92:95]
buffer_store_dwordx4 v[64:67],v0,s[8:11],s65 offen offset:0 sc1
v_cvt_pk_bf16_f32 v68,v48,v49
v_cvt_pk_bf16_f32 v69,v50,v51
v_mfma_f32_16x16x32_bf16 v[96:99],a[24:27],v[104:107],v[96:99]
ds_read_b128 v[124:127],v4 offset:12288
v_cvt_pk_bf16_f32 v70,v52,v53
v_cvt_pk_bf16_f32 v71,v54,v55
v_mfma_f32_16x16x32_bf16 v[100:103],a[24:27],v[108:111],v[100:103]
buffer_store_dwordx4 v[68:71],v0,s[8:11],s65 offen offset:1024 sc1
s_waitcnt lgkmcnt(2)
v_mfma_f32_16x16x32_bf16 v[88:91],a[20:23],v[112:115],v[88:91]
ds_read_b128 v[104:107],v5 offset:8192
v_mfma_f32_16x16x32_bf16 v[92:95],a[20:23],v[116:119],v[92:95]
v_mfma_f32_16x16x32_bf16 v[96:99],a[28:31],v[112:115],v[96:99]
ds_read_b128 v[108:111],v5 offset:12288
v_mfma_f32_16x16x32_bf16 v[100:103],a[28:31],v[116:119],v[100:103]
s_waitcnt lgkmcnt(2)
v_mfma_f32_16x16x32_bf16 v[88:91],a[32:35],v[120:123],v[88:91]
ds_read_b128 v[112:115],v6 offset:8192
v_mfma_f32_16x16x32_bf16 v[92:95],a[32:35],v[124:127],v[92:95]
v_mfma_f32_16x16x32_bf16 v[96:99],a[40:43],v[120:123],v[96:99]
ds_read_b128 v[116:119],v6 offset:12288
v_mfma_f32_16x16x32_bf16 v[100:103],a[40:43],v[124:127],v[100:103]
s_waitcnt lgkmcnt(2)
v_mfma_f32_16x16x32_bf16 v[88:91],a[36:39],v[104:107],v[88:91]
ds_read_b128 v[120:123],v7 offset:8192
v_mfma_f32_16x16x32_bf16 v[92:95],a[36:39],v[108:111],v[92:95]
s_lshl_b32 s56,s54,13
v_mfma_f32_16x16x32_bf16 v[96:99],a[44:47],v[104:107],v[96:99]
ds_read_b128 v[124:127],v7 offset:12288
v_mfma_f32_16x16x32_bf16 v[100:103],a[44:47],v[108:111],v[100:103]
s_add_u32 s56,s56,10487552
s_waitcnt lgkmcnt(2)
v_mfma_f32_16x16x32_bf16 v[88:91],a[48:51],v[112:115],v[88:91]
ds_read_b128 v[104:107],v4 offset:16384
v_mfma_f32_16x16x32_bf16 v[92:95],a[48:51],v[116:119],v[92:95]
s_or_b32 s56,s56,s52
v_mfma_f32_16x16x32_bf16 v[96:99],a[56:59],v[112:115],v[96:99]
ds_read_b128 v[108:111],v4 offset:20480
v_mfma_f32_16x16x32_bf16 v[100:103],a[56:59],v[116:119],v[100:103]
buffer_load_dword v76,v23,s[8:11],s56 offen sc1
s_waitcnt lgkmcnt(2)
v_mfma_f32_16x16x32_bf16 v[88:91],a[52:55],v[120:123],v[88:91]
ds_read_b128 v[112:115],v5 offset:16384
v_mfma_f32_16x16x32_bf16 v[92:95],a[52:55],v[124:127],v[92:95]
v_mfma_f32_16x16x32_bf16 v[96:99],a[60:63],v[120:123],v[96:99]
ds_read_b128 v[116:119],v5 offset:20480
v_mfma_f32_16x16x32_bf16 v[100:103],a[60:63],v[124:127],v[100:103]
s_waitcnt lgkmcnt(2)
v_mfma_f32_16x16x32_bf16 v[88:91],a[64:67],v[104:107],v[88:91]
ds_read_b128 v[120:123],v6 offset:16384
v_mfma_f32_16x16x32_bf16 v[92:95],a[64:67],v[108:111],v[92:95]
v_mfma_f32_16x16x32_bf16 v[96:99],a[72:75],v[104:107],v[96:99]
ds_read_b128 v[124:127],v6 offset:20480
v_mfma_f32_16x16x32_bf16 v[100:103],a[72:75],v[108:111],v[100:103]
s_waitcnt lgkmcnt(2)
v_mfma_f32_16x16x32_bf16 v[88:91],a[68:71],v[112:115],v[88:91]
ds_read_b128 v[104:107],v7 offset:16384
v_mfma_f32_16x16x32_bf16 v[92:95],a[68:71],v[116:119],v[92:95]
v_mfma_f32_16x16x32_bf16 v[96:99],a[76:79],v[112:115],v[96:99]
ds_read_b128 v[108:111],v7 offset:20480
v_mfma_f32_16x16x32_bf16 v[100:103],a[76:79],v[116:119],v[100:103]
s_waitcnt lgkmcnt(2)
v_mfma_f32_16x16x32_bf16 v[88:91],a[80:83],v[120:123],v[88:91]
ds_read_b128 v[112:115],v4 offset:24576
v_mfma_f32_16x16x32_bf16 v[92:95],a[80:83],v[124:127],v[92:95]
v_mfma_f32_16x16x32_bf16 v[96:99],a[88:91],v[120:123],v[96:99]
ds_read_b128 v[116:119],v4 offset:28672
v_mfma_f32_16x16x32_bf16 v[100:103],a[88:91],v[124:127],v[100:103]
s_waitcnt lgkmcnt(2)
v_mfma_f32_16x16x32_bf16 v[88:91],a[84:87],v[104:107],v[88:91]
ds_read_b128 v[120:123],v5 offset:24576
v_mfma_f32_16x16x32_bf16 v[92:95],a[84:87],v[108:111],v[92:95]
v_mfma_f32_16x16x32_bf16 v[96:99],a[92:95],v[104:107],v[96:99]
ds_read_b128 v[124:127],v5 offset:28672
v_mfma_f32_16x16x32_bf16 v[100:103],a[92:95],v[108:111],v[100:103]
s_waitcnt lgkmcnt(2)
v_mfma_f32_16x16x32_bf16 v[88:91],a[96:99],v[112:115],v[88:91]
ds_read_b128 v[104:107],v6 offset:24576
v_mfma_f32_16x16x32_bf16 v[92:95],a[96:99],v[116:119],v[92:95]
v_mfma_f32_16x16x32_bf16 v[96:99],a[104:107],v[112:115],v[96:99]
ds_read_b128 v[108:111],v6 offset:28672
v_mfma_f32_16x16x32_bf16 v[100:103],a[104:107],v[116:119],v[100:103]
s_waitcnt lgkmcnt(2)
v_mfma_f32_16x16x32_bf16 v[88:91],a[100:103],v[120:123],v[88:91]
ds_read_b128 v[112:115],v7 offset:24576
v_mfma_f32_16x16x32_bf16 v[92:95],a[100:103],v[124:127],v[92:95]
v_mfma_f32_16x16x32_bf16 v[96:99],a[108:111],v[120:123],v[96:99]
ds_read_b128 v[116:119],v7 offset:28672
v_mfma_f32_16x16x32_bf16 v[100:103],a[108:111],v[124:127],v[100:103]
s_waitcnt lgkmcnt(2)
v_mfma_f32_16x16x32_bf16 v[88:91],a[112:115],v[104:107],v[88:91]
v_mfma_f32_16x16x32_bf16 v[92:95],a[112:115],v[108:111],v[92:95]
v_mfma_f32_16x16x32_bf16 v[96:99],a[120:123],v[104:107],v[96:99]
v_mfma_f32_16x16x32_bf16 v[100:103],a[120:123],v[108:111],v[100:103]
s_waitcnt lgkmcnt(0)
v_mfma_f32_16x16x32_bf16 v[88:91],a[116:119],v[112:115],v[88:91]
v_mfma_f32_16x16x32_bf16 v[92:95],a[116:119],v[116:119],v[92:95]
v_mfma_f32_16x16x32_bf16 v[96:99],a[124:127],v[112:115],v[96:99]
v_mfma_f32_16x16x32_bf16 v[100:103],a[124:127],v[116:119],v[100:103]
s_nop 3
v_cvt_pk_bf16_f32 v104,v88,v96
v_cvt_pk_bf16_f32 v105,v89,v97
v_cvt_pk_bf16_f32 v106,v90,v98
v_cvt_pk_bf16_f32 v107,v91,v99
v_cvt_pk_bf16_f32 v108,v92,v100
v_cvt_pk_bf16_f32 v109,v93,v101
v_cvt_pk_bf16_f32 v110,v94,v102
v_cvt_pk_bf16_f32 v111,v95,v103
buffer_store_dwordx4 v[104:107],v0,s[8:11],s63 offen sc1
buffer_store_dwordx4 v[108:111],v0,s[8:11],s64 offen sc1
s_lshl_b32 s59,s51,13
s_lshl2_add_u32 s59,s47,s59
s_add_u32 s59,s59,10485888
s_waitcnt vmcnt(3)
s_barrier
s_or_b32 s59,s59,s52
buffer_store_dword v17,off,s[8:11],s59 sc1
s_mov_b32 s77,1
s_lshl_b32 s70,s51,13
s_lshl2_add_u32 s70,s47,s70
s_add_u32 s70,s70,10486144
s_branch L_p_23
L_p_24:
s_endpgm
L_rm_5:
v_and_b32 v33,15,v1
v_lshrrev_b32 v34,4,v1
s_min_u32 s60,s47,27
s_lshl_b32 s60,s60,7
s_mul_i32 s59,s46,458752
s_add_u32 s60,s60,s59
v_mul_u32_u24 v36,114688,v34
v_and_b32 v35,7,v33
v_lshl_add_u32 v36,v35,4,v36
v_add_u32 v36,s60,v36
v_cmp_gt_u32 vcc,8,v33
v_mov_b32 v38,s36
v_mov_b32 v39,s37
v_mov_b32 v40,s34
v_mov_b32 v41,s35
v_cndmask_b32 v38,v38,v40,vcc
v_cndmask_b32 v39,v39,v41,vcc
v_add_co_u32 v38,vcc,v38,v36
s_nop 1
v_addc_co_u32 v39,vcc,0,v39,vcc
s_lshl_b32 s56,s46,15
v_add_u32 v37,s56,v0
global_load_dwordx4 v[44:47],v[38:39],off
v_add_co_u32 v38,vcc,3584,v38
s_nop 1
v_addc_co_u32 v39,vcc,0,v39,vcc
global_load_dwordx4 v[48:51],v[38:39],off
v_add_co_u32 v38,vcc,3584,v38
s_nop 1
v_addc_co_u32 v39,vcc,0,v39,vcc
global_load_dwordx4 v[52:55],v[38:39],off
v_add_co_u32 v38,vcc,3584,v38
s_nop 1
v_addc_co_u32 v39,vcc,0,v39,vcc
global_load_dwordx4 v[56:59],v[38:39],off
v_add_co_u32 v38,vcc,3584,v38
s_nop 1
v_addc_co_u32 v39,vcc,0,v39,vcc
global_load_dwordx4 v[60:63],v[38:39],off
v_add_co_u32 v38,vcc,3584,v38
s_nop 1
v_addc_co_u32 v39,vcc,0,v39,vcc
global_load_dwordx4 v[64:67],v[38:39],off
v_add_co_u32 v38,vcc,3584,v38
s_nop 1
v_addc_co_u32 v39,vcc,0,v39,vcc
global_load_dwordx4 v[68:71],v[38:39],off
v_add_co_u32 v38,vcc,3584,v38
s_nop 1
v_addc_co_u32 v39,vcc,0,v39,vcc
global_load_dwordx4 v[72:75],v[38:39],off
v_add_co_u32 v38,vcc,3584,v38
s_nop 1
v_addc_co_u32 v39,vcc,0,v39,vcc
global_load_dwordx4 v[76:79],v[38:39],off
v_add_co_u32 v38,vcc,3584,v38
s_nop 1
v_addc_co_u32 v39,vcc,0,v39,vcc
global_load_dwordx4 v[80:83],v[38:39],off
v_add_co_u32 v38,vcc,3584,v38
s_nop 1
v_addc_co_u32 v39,vcc,0,v39,vcc
global_load_dwordx4 v[84:87],v[38:39],off
v_add_co_u32 v38,vcc,3584,v38
s_nop 1
v_addc_co_u32 v39,vcc,0,v39,vcc
global_load_dwordx4 v[88:91],v[38:39],off
v_add_co_u32 v38,vcc,3584,v38
s_nop 1
v_addc_co_u32 v39,vcc,0,v39,vcc
global_load_dwordx4 v[92:95],v[38:39],off
v_add_co_u32 v38,vcc,3584,v38
s_nop 1
v_addc_co_u32 v39,vcc,0,v39,vcc
global_load_dwordx4 v[96:99],v[38:39],off
v_add_co_u32 v38,vcc,3584,v38
s_nop 1
v_addc_co_u32 v39,vcc,0,v39,vcc
global_load_dwordx4 v[100:103],v[38:39],off
v_add_co_u32 v38,vcc,3584,v38
s_nop 1
v_addc_co_u32 v39,vcc,0,v39,vcc
global_load_dwordx4 v[104:107],v[38:39],off
v_add_co_u32 v38,vcc,3584,v38
s_nop 1
v_addc_co_u32 v39,vcc,0,v39,vcc
s_waitcnt vmcnt(15)
ds_write_b128 v37,v[44:47] offset:0
s_waitcnt vmcnt(14)
ds_write_b128 v37,v[48:51] offset:1024
s_waitcnt vmcnt(13)
ds_write_b128 v37,v[52:55] offset:2048
s_waitcnt vmcnt(12)
ds_write_b128 v37,v[56:59] offset:3072
s_waitcnt vmcnt(11)
ds_write_b128 v37,v[60:63] offset:4096
s_waitcnt vmcnt(10)
ds_write_b128 v37,v[64:67] offset:5120
s_waitcnt vmcnt(9)
ds_write_b128 v37,v[68:71] offset:6144
s_waitcnt vmcnt(8)
ds_write_b128 v37,v[72:75] offset:7168
s_waitcnt lgkmcnt(0)
s_waitcnt vmcnt(7)
ds_write_b128 v37,v[76:79] offset:8192
s_waitcnt vmcnt(6)
ds_write_b128 v37,v[80:83] offset:9216
s_waitcnt vmcnt(5)
ds_write_b128 v37,v[84:87] offset:10240
s_waitcnt vmcnt(4)
ds_write_b128 v37,v[88:91] offset:11264
s_waitcnt vmcnt(3)
ds_write_b128 v37,v[92:95] offset:12288
s_waitcnt vmcnt(2)
ds_write_b128 v37,v[96:99] offset:13312
s_waitcnt vmcnt(1)
ds_write_b128 v37,v[100:103] offset:14336
s_waitcnt vmcnt(0)
ds_write_b128 v37,v[104:107] offset:15360
s_waitcnt lgkmcnt(0)
global_load_dwordx4 v[44:47],v[38:39],off
v_add_co_u32 v38,vcc,3584,v38
s_nop 1
v_addc_co_u32 v39,vcc,0,v39,vcc
global_load_dwordx4 v[48:51],v[38:39],off
v_add_co_u32 v38,vcc,3584,v38
s_nop 1
v_addc_co_u32 v39,vcc,0,v39,vcc
global_load_dwordx4 v[52:55],v[38:39],off
v_add_co_u32 v38,vcc,3584,v38
s_nop 1
v_addc_co_u32 v39,vcc,0,v39,vcc
global_load_dwordx4 v[56:59],v[38:39],off
v_add_co_u32 v38,vcc,3584,v38
s_nop 1
v_addc_co_u32 v39,vcc,0,v39,vcc
global_load_dwordx4 v[60:63],v[38:39],off
v_add_co_u32 v38,vcc,3584,v38
s_nop 1
v_addc_co_u32 v39,vcc,0,v39,vcc
global_load_dwordx4 v[64:67],v[38:39],off
v_add_co_u32 v38,vcc,3584,v38
s_nop 1
v_addc_co_u32 v39,vcc,0,v39,vcc
global_load_dwordx4 v[68:71],v[38:39],off
v_add_co_u32 v38,vcc,3584,v38
s_nop 1
v_addc_co_u32 v39,vcc,0,v39,vcc
global_load_dwordx4 v[72:75],v[38:39],off
v_add_co_u32 v38,vcc,3584,v38
s_nop 1
v_addc_co_u32 v39,vcc,0,v39,vcc
global_load_dwordx4 v[76:79],v[38:39],off
v_add_co_u32 v38,vcc,3584,v38
s_nop 1
v_addc_co_u32 v39,vcc,0,v39,vcc
global_load_dwordx4 v[80:83],v[38:39],off
v_add_co_u32 v38,vcc,3584,v38
s_nop 1
v_addc_co_u32 v39,vcc,0,v39,vcc
global_load_dwordx4 v[84:87],v[38:39],off
v_add_co_u32 v38,vcc,3584,v38
s_nop 1
v_addc_co_u32 v39,vcc,0,v39,vcc
global_load_dwordx4 v[88:91],v[38:39],off
v_add_co_u32 v38,vcc,3584,v38
s_nop 1
v_addc_co_u32 v39,vcc,0,v39,vcc
global_load_dwordx4 v[92:95],v[38:39],off
v_add_co_u32 v38,vcc,3584,v38
s_nop 1
v_addc_co_u32 v39,vcc,0,v39,vcc
global_load_dwordx4 v[96:99],v[38:39],off
v_add_co_u32 v38,vcc,3584,v38
s_nop 1
v_addc_co_u32 v39,vcc,0,v39,vcc
global_load_dwordx4 v[100:103],v[38:39],off
v_add_co_u32 v38,vcc,3584,v38
s_nop 1
v_addc_co_u32 v39,vcc,0,v39,vcc
global_load_dwordx4 v[104:107],v[38:39],off
v_add_co_u32 v38,vcc,3584,v38
s_nop 1
v_addc_co_u32 v39,vcc,0,v39,vcc
s_waitcnt vmcnt(15)
ds_write_b128 v37,v[44:47] offset:16384
s_waitcnt vmcnt(14)
ds_write_b128 v37,v[48:51] offset:17408
s_waitcnt vmcnt(13)
ds_write_b128 v37,v[52:55] offset:18432
s_waitcnt vmcnt(12)
ds_write_b128 v37,v[56:59] offset:19456
s_waitcnt vmcnt(11)
ds_write_b128 v37,v[60:63] offset:20480
s_waitcnt vmcnt(10)
ds_write_b128 v37,v[64:67] offset:21504
s_waitcnt vmcnt(9)
ds_write_b128 v37,v[68:71] offset:22528
s_waitcnt vmcnt(8)
ds_write_b128 v37,v[72:75] offset:23552
s_waitcnt lgkmcnt(0)
s_waitcnt vmcnt(7)
ds_write_b128 v37,v[76:79] offset:24576
s_waitcnt vmcnt(6)
ds_write_b128 v37,v[80:83] offset:25600
s_waitcnt vmcnt(5)
ds_write_b128 v37,v[84:87] offset:26624
s_waitcnt vmcnt(4)
ds_write_b128 v37,v[88:91] offset:27648
s_waitcnt vmcnt(3)
ds_write_b128 v37,v[92:95] offset:28672
s_waitcnt vmcnt(2)
ds_write_b128 v37,v[96:99] offset:29696
s_waitcnt vmcnt(1)
ds_write_b128 v37,v[100:103] offset:30720
s_waitcnt vmcnt(0)
ds_write_b128 v37,v[104:107] offset:31744
s_waitcnt lgkmcnt(0)
v_mov_b32 v123,159744
s_cmp_lg_u32 s46,0
s_cbranch_scc1 L_gbd_31
v_mov_b32 v124,240
L_gb_30:
buffer_load_dword v125,v124,s[12:15],0 offen sc1
s_waitcnt vmcnt(0)
v_readfirstlane_b32 s56,v125
ds_write_b32 v123,v125
s_bitcmp1_b32 s56,8
s_cbranch_scc1 L_gbd_31
s_sleep 4
s_sub_u32 s49,s49,1
s_cmp_gt_i32 s49,0
s_cbranch_scc1 L_gb_30
s_branch L_abort
L_gbd_31:
s_waitcnt lgkmcnt(0)
s_barrier
ds_read_b32 v125,v123
s_waitcnt lgkmcnt(0)
v_readfirstlane_b32 s56,v125
s_barrier
s_lshr_b32 s56,s56,16
s_andn2_b32 s56,s56,s3
s_cbranch_scc1 L_spread
s_cmp_lg_u32 s3,0
s_cbranch_scc1 L_wm
v_and_b32 v120,15,v1
v_lshrrev_b32 v121,4,v1
v_mov_b32 v17,1
s_lshl_b32 s56,s46,15
v_add_u32 v18,s56,v0
s_lshl_b32 s56,s46,2
v_add_u32 v125,s56,v121
v_xor_b32 v126,v125,v120
v_lshlrev_b32 v126,4,v126
v_lshl_add_u32 v20,v125,10,v126
v_add_u32 v125,0,v121
v_xor_b32 v125,v125,v120
v_lshlrev_b32 v125,4,v125
v_lshl_add_u32 v125,v120,8,v125
v_add_u32 v4,131072,v125
v_add_u32 v125,4,v121
v_xor_b32 v125,v125,v120
v_lshlrev_b32 v125,4,v125
v_lshl_add_u32 v125,v120,8,v125
v_add_u32 v5,131072,v125
v_add_u32 v125,8,v121
v_xor_b32 v125,v125,v120
v_lshlrev_b32 v125,4,v125
v_lshl_add_u32 v125,v120,8,v125
v_add_u32 v6,131072,v125
v_add_u32 v125,12,v121
v_xor_b32 v125,v125,v120
v_lshlrev_b32 v125,4,v125
v_lshl_add_u32 v125,v120,8,v125
v_add_u32 v7,131072,v125
v_lshlrev_b32 v21,5,v120
v_and_b32 v125,1,v121
v_lshl_add_u32 v21,v125,4,v21
s_lshl_b32 s56,s46,9
v_lshrrev_b32 v125,1,v121
v_lshl_add_u32 v21,v125,11,v21
s_add_u32 s56,s56,155648
v_add_u32 v21,s56,v21
v_lshlrev_b32 v22,4,v120
v_lshl_add_u32 v22,v121,10,v22
s_lshl_b32 s56,s46,8
v_add_u32 v22,s56,v22
s_mov_b32 s54,0
s_mov_b32 s31,0
s_mov_b32 s53,6
s_mov_b32 s72,0x80000000
s_mov_b32 s73,0
s_mov_b32 s77,-1
s_mov_b32 s86,0
s_mov_b32 s19,0
s_mov_b32 s74,2948595712
s_mov_b32 s75,2863311530
v_and_b32 v23,15,v1
v_lshlrev_b32 v23,3,v23
v_lshrrev_b32 v16,4,v1
v_lshl_add_u32 v23,v16,13,v23
v_mov_b32 v19,159744
v_lshl_add_u32 v16,v16,2,v19
v_and_b32 v9,15,v1
v_lshrrev_b32 v10,4,v1
v_and_b32 v124,1,v1
v_lshlrev_b32 v124,4,v124
v_mov_b32 v125,0xffff
v_lshlrev_b32 v125,v124,v125
v_lshrrev_b32 v124,2,v9
v_cmp_eq_u32 vcc,0,v124
s_nop 1
v_cndmask_b32 v12,0,v125,vcc
v_cmp_eq_u32 vcc,1,v124
s_nop 1
v_cndmask_b32 v13,0,v125,vcc
v_and_b32 v124,2,v1
v_cmp_eq_u32 vcc,0,v124
v_mov_b32 v14,0xeeee
v_mov_b32 v124,0x4444
v_cndmask_b32 v14,v14,v124,vcc
v_lshlrev_b32 v11,14,v10
v_lshl_add_u32 v11,v9,4,v11
s_lshl_b32 s65,s51,15
s_add_u32 s65,s65,92274688
s_lshl_b32 s62,s47,10
s_add_u32 s62,s62,s65
s_lshl_b32 s63,s47,16
s_lshl_b32 s60,s46,8
s_add_u32 s63,s63,s60
s_mov_b32 s4,s38
s_mov_b32 s5,s39
s_mov_b32 s6,1835008
s_mov_b32 s7,0x20000
buffer_load_dwordx4 v[24:27],v11,s[4:7],s63 offen offset:0
buffer_load_dwordx4 v[28:31],v11,s[4:7],s63 offen offset:1024
buffer_load_dwordx4 v[32:35],v11,s[4:7],s63 offen offset:2048
buffer_load_dwordx4 v[36:39],v11,s[4:7],s63 offen offset:3072
s_add_u32 s63,s63,4096
buffer_load_dwordx4 v[40:43],v11,s[4:7],s63 offen offset:0
buffer_load_dwordx4 v[44:47],v11,s[4:7],s63 offen offset:1024
buffer_load_dwordx4 v[48:51],v11,s[4:7],s63 offen offset:2048
buffer_load_dwordx4 v[52:55],v11,s[4:7],s63 offen offset:3072
s_add_u32 s63,s63,4096
buffer_load_dwordx4 v[56:59],v11,s[4:7],s63 offen offset:0
buffer_load_dwordx4 v[60:63],v11,s[4:7],s63 offen offset:1024
buffer_load_dwordx4 v[64:67],v11,s[4:7],s63 offen offset:2048
buffer_load_dwordx4 v[68:71],v11,s[4:7],s63 offen offset:3072
s_add_u32 s63,s63,4096
buffer_load_dwordx4 v[72:75],v11,s[4:7],s63 offen offset:0
buffer_load_dwordx4 v[76:79],v11,s[4:7],s63 offen offset:1024
buffer_load_dwordx4 v[80:83],v11,s[4:7],s63 offen offset:2048
buffer_load_dwordx4 v[84:87],v11,s[4:7],s63 offen offset:3072
s_mov_b32 s4,s32
s_mov_b32 s5,s33
s_mov_b32 s6,1024
s_mov_b32 s7,0x20000
buffer_load_dwordx4 v[88:91],v0,s[4:7],0 offen
s_waitcnt vmcnt(0)
v_lshlrev_b32 v96,16,v88
v_and_b32 v97,0xffff0000,v88
v_lshlrev_b32 v98,16,v89
v_and_b32 v99,0xffff0000,v89
v_lshlrev_b32 v100,16,v90
v_and_b32 v101,0xffff0000,v90
v_lshlrev_b32 v102,16,v91
v_and_b32 v103,0xffff0000,v91
v_mul_f32 v88,v96,v96
v_fma_f32 v88,v97,v97,v88
v_fma_f32 v88,v98,v98,v88
v_fma_f32 v88,v99,v99,v88
v_fma_f32 v88,v100,v100,v88
v_fma_f32 v88,v101,v101,v88
v_fma_f32 v88,v102,v102,v88
v_fma_f32 v88,v103,v103,v88
s_nop 1
v_add_f32_dpp v88,v88,v88 row_ror:8 row_mask:0xf bank_mask:0xf
s_nop 1
v_add_f32_dpp v88,v88,v88 row_ror:4 row_mask:0xf bank_mask:0xf
s_nop 1
v_add_f32_dpp v88,v88,v88 row_ror:2 row_mask:0xf bank_mask:0xf
s_nop 1
v_add_f32_dpp v88,v88,v88 row_ror:1 row_mask:0xf bank_mask:0xf
v_mov_b32 v89,v88
s_nop 1
v_permlane16_swap_b32 v88,v89
v_add_f32 v88,v88,v89
v_mov_b32 v89,v88
s_nop 1
v_permlane32_swap_b32 v88,v89
v_add_f32 v88,v88,v89
v_sqrt_f32 v88,v88
s_nop 0
v_mul_f32 v88,0x40333333,v88
s_nop 0
v_readfirstlane_b32 s25,v88
s_bitset1_b32 s25,31
s_ff1_i32_b64 s30,s[74:75]
s_bitset0_b64 s[74:75],s30
s_min_u32 s30,s30,127
s_lshl_b32 s70,s30,15
s_add_u32 s70,s70,0
s_add_u32 s71,s70,16384
L_mo_36:
s_cmp_lg_u32 s19,0
s_cbranch_scc1 L_mo_37
s_add_u32 m0,s50,131072
s_nop 0
buffer_load_dwordx4 v20,s[8:11],s70 offen offset:0 sc1 lds
s_add_u32 m0,s50,135168
s_nop 0
buffer_load_dwordx4 v20,s[8:11],s71 offen offset:0 sc1 lds
s_add_u32 m0,s50,139008
s_nop 0
buffer_load_dwordx4 v20,s[8:11],s70 offen offset:256 sc1 lds
s_add_u32 m0,s50,143104
s_nop 0
buffer_load_dwordx4 v20,s[8:11],s71 offen offset:256 sc1 lds
s_add_u32 m0,s50,146944
s_nop 0
buffer_load_dwordx4 v20,s[8:11],s70 offen offset:512 sc1 lds
s_add_u32 m0,s50,151040
s_nop 0
buffer_load_dwordx4 v20,s[8:11],s71 offen offset:512 sc1 lds
s_mov_b32 s19,1
s_waitcnt vmcnt(0)
L_mo_37:
s_mov_b32 s51,s30
s_mov_b64 s[68:69],s[70:71]
s_ff1_i32_b64 s30,s[74:75]
s_bitset0_b64 s[74:75],s30
s_min_u32 s30,s30,127
s_lshl_b32 s70,s30,15
s_add_u32 s70,s70,0
s_add_u32 s71,s70,16384
s_lshl_b32 s76,s31,13
s_add_u32 s76,s76,10487040
s_lshl_b32 s58,s51,5
s_add_u32 s58,s58,s47
s_mul_i32 s58,s58,24576
s_add_u32 s58,s58,100663296
s_add_u32 s61,s58,s50
s_add_u32 s62,s61,4096
s_add_u32 s63,s61,16384
s_add_u32 s64,s61,20480
s_add_u32 s65,s61,s50
s_add_u32 s65,s65,8192
s_waitcnt vmcnt(12)
s_barrier
ds_read_b128 v[72:75],v4 offset:0
ds_read_b128 v[76:79],v4 offset:4096
ds_read_b128 v[80:83],v5 offset:0
ds_read_b128 v[84:87],v5 offset:4096
s_add_u32 m0,s50,154880
s_nop 0
buffer_load_dwordx4 v20,s[8:11],s68 offen offset:768 sc1 lds
s_add_u32 m0,s50,158976
s_nop 0
buffer_load_dwordx4 v20,s[8:11],s69 offen offset:768 sc1 lds
s_waitcnt lgkmcnt(2)
v_mfma_f32_16x16x32_bf16 v[40:43],a[128:131],v[72:75],0
ds_read_b128 v[108:111],v6 offset:0
v_mfma_f32_16x16x32_bf16 v[56:59],v[72:75],v[128:131],0
v_mfma_f32_16x16x32_bf16 v[24:27],a[0:3],v[72:75],0
ds_read_b128 v[112:115],v6 offset:4096
v_mfma_f32_16x16x32_bf16 v[44:47],a[128:131],v[76:79],0
v_mfma_f32_16x16x32_bf16 v[60:63],v[76:79],v[128:131],0
v_mfma_f32_16x16x32_bf16 v[28:31],a[0:3],v[76:79],0
v_mfma_f32_16x16x32_bf16 v[48:51],a[136:139],v[72:75],0
v_mfma_f32_16x16x32_bf16 v[64:67],v[72:75],v[136:139],0
v_mfma_f32_16x16x32_bf16 v[32:35],a[8:11],v[72:75],0
v_mfma_f32_16x16x32_bf16 v[52:55],a[136:139],v[76:79],0
v_mfma_f32_16x16x32_bf16 v[68:71],v[76:79],v[136:139],0
v_mfma_f32_16x16x32_bf16 v[36:39],a[8:11],v[76:79],0
s_waitcnt lgkmcnt(2)
v_mfma_f32_16x16x32_bf16 v[40:43],a[132:135],v[80:83],v[40:43]
ds_read_b128 v[72:75],v7 offset:0
v_mfma_f32_16x16x32_bf16 v[56:59],v[80:83],v[132:135],v[56:59]
v_mfma_f32_16x16x32_bf16 v[24:27],a[4:7],v[80:83],v[24:27]
ds_read_b128 v[76:79],v7 offset:4096
v_mfma_f32_16x16x32_bf16 v[44:47],a[132:135],v[84:87],v[44:47]
v_mfma_f32_16x16x32_bf16 v[60:63],v[84:87],v[132:135],v[60:63]
v_mfma_f32_16x16x32_bf16 v[28:31],a[4:7],v[84:87],v[28:31]
v_mfma_f32_16x16x32_bf16 v[48:51],a[140:143],v[80:83],v[48:51]
v_mfma_f32_16x16x32_bf16 v[64:67],v[80:83],v[140:143],v[64:67]
v_mfma_f32_16x16x32_bf16 v[32:35],a[12:15],v[80:83],v[32:35]
v_mfma_f32_16x16x32_bf16 v[52:55],a[140:143],v[84:87],v[52:55]
v_mfma_f32_16x16x32_bf16 v[68:71],v[84:87],v[140:143],v[68:71]
v_mfma_f32_16x16x32_bf16 v[36:39],a[12:15],v[84:87],v[36:39]
s_waitcnt vmcnt(12)
s_barrier
s_waitcnt lgkmcnt(2)
v_mfma_f32_16x16x32_bf16 v[40:43],a[144:147],v[108:111],v[40:43]
ds_read_b128 v[80:83],v4 offset:8192
v_mfma_f32_16x16x32_bf16 v[56:59],v[108:111],v[144:147],v[56:59]
v_mfma_f32_16x16x32_bf16 v[24:27],a[16:19],v[108:111],v[24:27]
ds_read_b128 v[84:87],v4 offset:12288
v_mfma_f32_16x16x32_bf16 v[44:47],a[144:147],v[112:115],v[44:47]
v_mfma_f32_16x16x32_bf16 v[60:63],v[112:115],v[144:147],v[60:63]
v_mfma_f32_16x16x32_bf16 v[28:31],a[16:19],v[112:115],v[28:31]
v_mfma_f32_16x16x32_bf16 v[48:51],a[152:155],v[108:111],v[48:51]
v_mfma_f32_16x16x32_bf16 v[64:67],v[108:111],v[152:155],v[64:67]
v_mfma_f32_16x16x32_bf16 v[32:35],a[24:27],v[108:111],v[32:35]
v_mfma_f32_16x16x32_bf16 v[52:55],a[152:155],v[112:115],v[52:55]
v_mfma_f32_16x16x32_bf16 v[68:71],v[112:115],v[152:155],v[68:71]
v_mfma_f32_16x16x32_bf16 v[36:39],a[24:27],v[112:115],v[36:39]
s_waitcnt lgkmcnt(2)
v_mfma_f32_16x16x32_bf16 v[40:43],a[148:151],v[72:75],v[40:43]
ds_read_b128 v[108:111],v5 offset:8192
v_mfma_f32_16x16x32_bf16 v[56:59],v[72:75],v[148:151],v[56:59]
v_mfma_f32_16x16x32_bf16 v[24:27],a[20:23],v[72:75],v[24:27]
ds_read_b128 v[112:115],v5 offset:12288
v_mfma_f32_16x16x32_bf16 v[44:47],a[148:151],v[76:79],v[44:47]
v_mfma_f32_16x16x32_bf16 v[60:63],v[76:79],v[148:151],v[60:63]
v_mfma_f32_16x16x32_bf16 v[28:31],a[20:23],v[76:79],v[28:31]
v_mfma_f32_16x16x32_bf16 v[48:51],a[156:159],v[72:75],v[48:51]
v_mfma_f32_16x16x32_bf16 v[64:67],v[72:75],v[156:159],v[64:67]
v_mfma_f32_16x16x32_bf16 v[32:35],a[28:31],v[72:75],v[32:35]
v_mfma_f32_16x16x32_bf16 v[52:55],a[156:159],v[76:79],v[52:55]
v_mfma_f32_16x16x32_bf16 v[68:71],v[76:79],v[156:159],v[68:71]
v_mfma_f32_16x16x32_bf16 v[36:39],a[28:31],v[76:79],v[36:39]
s_waitcnt lgkmcnt(2)
v_mfma_f32_16x16x32_bf16 v[40:43],a[160:163],v[80:83],v[40:43]
ds_read_b128 v[72:75],v6 offset:8192
v_mfma_f32_16x16x32_bf16 v[56:59],v[80:83],v[160:163],v[56:59]
v_mfma_f32_16x16x32_bf16 v[24:27],a[32:35],v[80:83],v[24:27]
ds_read_b128 v[76:79],v6 offset:12288
v_mfma_f32_16x16x32_bf16 v[44:47],a[160:163],v[84:87],v[44:47]
v_mfma_f32_16x16x32_bf16 v[60:63],v[84:87],v[160:163],v[60:63]
v_mfma_f32_16x16x32_bf16 v[28:31],a[32:35],v[84:87],v[28:31]
v_mfma_f32_16x16x32_bf16 v[48:51],a[168:171],v[80:83],v[48:51]
v_mfma_f32_16x16x32_bf16 v[64:67],v[80:83],v[168:171],v[64:67]
v_mfma_f32_16x16x32_bf16 v[32:35],a[40:43],v[80:83],v[32:35]
v_mfma_f32_16x16x32_bf16 v[52:55],a[168:171],v[84:87],v[52:55]
v_mfma_f32_16x16x32_bf16 v[68:71],v[84:87],v[168:171],v[68:71]
v_mfma_f32_16x16x32_bf16 v[36:39],a[40:43],v[84:87],v[36:39]
s_waitcnt lgkmcnt(2)
v_mfma_f32_16x16x32_bf16 v[40:43],a[164:167],v[108:111],v[40:43]
ds_read_b128 v[80:83],v7 offset:8192
v_mfma_f32_16x16x32_bf16 v[56:59],v[108:111],v[164:167],v[56:59]
v_mfma_f32_16x16x32_bf16 v[24:27],a[36:39],v[108:111],v[24:27]
ds_read_b128 v[84:87],v7 offset:12288
v_mfma_f32_16x16x32_bf16 v[44:47],a[164:167],v[112:115],v[44:47]
v_mfma_f32_16x16x32_bf16 v[60:63],v[112:115],v[164:167],v[60:63]
v_mfma_f32_16x16x32_bf16 v[28:31],a[36:39],v[112:115],v[28:31]
v_mfma_f32_16x16x32_bf16 v[48:51],a[172:175],v[108:111],v[48:51]
v_mfma_f32_16x16x32_bf16 v[64:67],v[108:111],v[172:175],v[64:67]
v_mfma_f32_16x16x32_bf16 v[32:35],a[44:47],v[108:111],v[32:35]
v_mfma_f32_16x16x32_bf16 v[52:55],a[172:175],v[112:115],v[52:55]
v_mfma_f32_16x16x32_bf16 v[68:71],v[112:115],v[172:175],v[68:71]
v_mfma_f32_16x16x32_bf16 v[36:39],a[44:47],v[112:115],v[36:39]
s_waitcnt vmcnt(10)
s_barrier
s_waitcnt lgkmcnt(2)
v_mfma_f32_16x16x32_bf16 v[40:43],a[176:179],v[72:75],v[40:43]
ds_read_b128 v[108:111],v4 offset:16384
v_mfma_f32_16x16x32_bf16 v[56:59],v[72:75],v[176:179],v[56:59]
v_mfma_f32_16x16x32_bf16 v[24:27],a[48:51],v[72:75],v[24:27]
ds_read_b128 v[112:115],v4 offset:20480
v_mfma_f32_16x16x32_bf16 v[44:47],a[176:179],v[76:79],v[44:47]
v_mfma_f32_16x16x32_bf16 v[60:63],v[76:79],v[176:179],v[60:63]
v_mfma_f32_16x16x32_bf16 v[28:31],a[48:51],v[76:79],v[28:31]
v_mfma_f32_16x16x32_bf16 v[48:51],a[184:187],v[72:75],v[48:51]
v_mfma_f32_16x16x32_bf16 v[64:67],v[72:75],v[184:187],v[64:67]
v_mfma_f32_16x16x32_bf16 v[32:35],a[56:59],v[72:75],v[32:35]
v_mfma_f32_16x16x32_bf16 v[52:55],a[184:187],v[76:79],v[52:55]
v_mfma_f32_16x16x32_bf16 v[68:71],v[76:79],v[184:187],v[68:71]
v_mfma_f32_16x16x32_bf16 v[36:39],a[56:59],v[76:79],v[36:39]
s_waitcnt vmcnt(2)
s_barrier
s_or_b32 s72,s72,s52
buffer_store_dword v17,off,s[8:11],s72 sc1
s_waitcnt lgkmcnt(2)
v_mfma_f32_16x16x32_bf16 v[40:43],a[180:183],v[80:83],v[40:43]
ds_read_b128 v[72:75],v5 offset:16384
v_mfma_f32_16x16x32_bf16 v[56:59],v[80:83],v[180:183],v[56:59]
v_mfma_f32_16x16x32_bf16 v[24:27],a[52:55],v[80:83],v[24:27]
ds_read_b128 v[76:79],v5 offset:20480
v_mfma_f32_16x16x32_bf16 v[44:47],a[180:183],v[84:87],v[44:47]
v_mfma_f32_16x16x32_bf16 v[60:63],v[84:87],v[180:183],v[60:63]
v_mfma_f32_16x16x32_bf16 v[28:31],a[52:55],v[84:87],v[28:31]
v_mfma_f32_16x16x32_bf16 v[48:51],a[188:191],v[80:83],v[48:51]
v_mfma_f32_16x16x32_bf16 v[64:67],v[80:83],v[188:191],v[64:67]
v_mfma_f32_16x16x32_bf16 v[32:35],a[60:63],v[80:83],v[32:35]
v_mfma_f32_16x16x32_bf16 v[52:55],a[188:191],v[84:87],v[52:55]
v_mfma_f32_16x16x32_bf16 v[68:71],v[84:87],v[188:191],v[68:71]
v_mfma_f32_16x16x32_bf16 v[36:39],a[60:63],v[84:87],v[36:39]
s_waitcnt lgkmcnt(2)
v_mfma_f32_16x16x32_bf16 v[40:43],a[192:195],v[108:111],v[40:43]
ds_read_b128 v[80:83],v6 offset:16384
v_mfma_f32_16x16x32_bf16 v[56:59],v[108:111],v[192:195],v[56:59]
v_mfma_f32_16x16x32_bf16 v[24:27],a[64:67],v[108:111],v[24:27]
ds_read_b128 v[84:87],v6 offset:20480
v_mfma_f32_16x16x32_bf16 v[44:47],a[192:195],v[112:115],v[44:47]
v_mfma_f32_16x16x32_bf16 v[60:63],v[112:115],v[192:195],v[60:63]
v_mfma_f32_16x16x32_bf16 v[28:31],a[64:67],v[112:115],v[28:31]
v_mfma_f32_16x16x32_bf16 v[48:51],a[200:203],v[108:111],v[48:51]
v_mfma_f32_16x16x32_bf16 v[64:67],v[108:111],v[200:203],v[64:67]
v_mfma_f32_16x16x32_bf16 v[32:35],a[72:75],v[108:111],v[32:35]
v_mfma_f32_16x16x32_bf16 v[52:55],a[200:203],v[112:115],v[52:55]
v_mfma_f32_16x16x32_bf16 v[68:71],v[112:115],v[200:203],v[68:71]
v_mfma_f32_16x16x32_bf16 v[36:39],a[72:75],v[112:115],v[36:39]
s_waitcnt lgkmcnt(2)
v_mfma_f32_16x16x32_bf16 v[40:43],a[196:199],v[72:75],v[40:43]
ds_read_b128 v[108:111],v7 offset:16384
v_mfma_f32_16x16x32_bf16 v[56:59],v[72:75],v[196:199],v[56:59]
v_mfma_f32_16x16x32_bf16 v[24:27],a[68:71],v[72:75],v[24:27]
ds_read_b128 v[112:115],v7 offset:20480
v_mfma_f32_16x16x32_bf16 v[44:47],a[196:199],v[76:79],v[44:47]
v_mfma_f32_16x16x32_bf16 v[60:63],v[76:79],v[196:199],v[60:63]
v_mfma_f32_16x16x32_bf16 v[28:31],a[68:71],v[76:79],v[28:31]
v_mfma_f32_16x16x32_bf16 v[48:51],a[204:207],v[72:75],v[48:51]
v_mfma_f32_16x16x32_bf16 v[64:67],v[72:75],v[204:207],v[64:67]
v_mfma_f32_16x16x32_bf16 v[32:35],a[76:79],v[72:75],v[32:35]
v_mfma_f32_16x16x32_bf16 v[52:55],a[204:207],v[76:79],v[52:55]
v_mfma_f32_16x16x32_bf16 v[68:71],v[76:79],v[204:207],v[68:71]
v_mfma_f32_16x16x32_bf16 v[36:39],a[76:79],v[76:79],v[36:39]
s_waitcnt vmcnt(1)
s_barrier
s_waitcnt lgkmcnt(2)
v_mfma_f32_16x16x32_bf16 v[40:43],a[208:211],v[80:83],v[40:43]
ds_read_b128 v[72:75],v4 offset:24576
v_mfma_f32_16x16x32_bf16 v[56:59],v[80:83],v[208:211],v[56:59]
v_mfma_f32_16x16x32_bf16 v[24:27],a[80:83],v[80:83],v[24:27]
ds_read_b128 v[76:79],v4 offset:28672
v_mfma_f32_16x16x32_bf16 v[44:47],a[208:211],v[84:87],v[44:47]
v_mfma_f32_16x16x32_bf16 v[60:63],v[84:87],v[208:211],v[60:63]
v_mfma_f32_16x16x32_bf16 v[28:31],a[80:83],v[84:87],v[28:31]
v_mfma_f32_16x16x32_bf16 v[48:51],a[216:219],v[80:83],v[48:51]
v_mfma_f32_16x16x32_bf16 v[64:67],v[80:83],v[216:219],v[64:67]
v_mfma_f32_16x16x32_bf16 v[32:35],a[88:91],v[80:83],v[32:35]
v_mfma_f32_16x16x32_bf16 v[52:55],a[216:219],v[84:87],v[52:55]
v_mfma_f32_16x16x32_bf16 v[68:71],v[84:87],v[216:219],v[68:71]
v_mfma_f32_16x16x32_bf16 v[36:39],a[88:91],v[84:87],v[36:39]
s_waitcnt lgkmcnt(2)
v_mfma_f32_16x16x32_bf16 v[40:43],a[212:215],v[108:111],v[40:43]
ds_read_b128 v[80:83],v5 offset:24576
v_mfma_f32_16x16x32_bf16 v[56:59],v[108:111],v[212:215],v[56:59]
v_mfma_f32_16x16x32_bf16 v[24:27],a[84:87],v[108:111],v[24:27]
ds_read_b128 v[84:87],v5 offset:28672
v_mfma_f32_16x16x32_bf16 v[44:47],a[212:215],v[112:115],v[44:47]
v_mfma_f32_16x16x32_bf16 v[60:63],v[112:115],v[212:215],v[60:63]
v_mfma_f32_16x16x32_bf16 v[28:31],a[84:87],v[112:115],v[28:31]
v_mfma_f32_16x16x32_bf16 v[48:51],a[220:223],v[108:111],v[48:51]
v_mfma_f32_16x16x32_bf16 v[64:67],v[108:111],v[220:223],v[64:67]
v_mfma_f32_16x16x32_bf16 v[32:35],a[92:95],v[108:111],v[32:35]
v_mfma_f32_16x16x32_bf16 v[52:55],a[220:223],v[112:115],v[52:55]
v_mfma_f32_16x16x32_bf16 v[68:71],v[112:115],v[220:223],v[68:71]
v_mfma_f32_16x16x32_bf16 v[36:39],a[92:95],v[112:115],v[36:39]
s_barrier
s_waitcnt lgkmcnt(2)
v_mfma_f32_16x16x32_bf16 v[40:43],a[224:227],v[72:75],v[40:43]
ds_read_b128 v[108:111],v6 offset:24576
v_mfma_f32_16x16x32_bf16 v[56:59],v[72:75],v[224:227],v[56:59]
s_add_u32 m0,s50,131072
v_mfma_f32_16x16x32_bf16 v[24:27],a[96:99],v[72:75],v[24:27]
ds_read_b128 v[112:115],v6 offset:28672
v_mfma_f32_16x16x32_bf16 v[44:47],a[224:227],v[76:79],v[44:47]
buffer_load_dwordx4 v20,s[8:11],s70 offen offset:0 sc1 lds
v_mfma_f32_16x16x32_bf16 v[60:63],v[76:79],v[224:227],v[60:63]
s_add_u32 m0,s50,135168
v_mfma_f32_16x16x32_bf16 v[28:31],a[96:99],v[76:79],v[28:31]
buffer_load_dwordx4 v20,s[8:11],s71 offen offset:0 sc1 lds
v_mfma_f32_16x16x32_bf16 v[48:51],a[232:235],v[72:75],v[48:51]
s_add_u32 m0,s50,139008
v_mfma_f32_16x16x32_bf16 v[64:67],v[72:75],v[232:235],v[64:67]
buffer_load_dwordx4 v20,s[8:11],s70 offen offset:256 sc1 lds
v_mfma_f32_16x16x32_bf16 v[32:35],a[104:107],v[72:75],v[32:35]
s_add_u32 m0,s50,143104
v_mfma_f32_16x16x32_bf16 v[52:55],a[232:235],v[76:79],v[52:55]
buffer_load_dwordx4 v20,s[8:11],s71 offen offset:256 sc1 lds
v_mfma_f32_16x16x32_bf16 v[68:71],v[76:79],v[232:235],v[68:71]
s_add_u32 m0,s50,146944
v_mfma_f32_16x16x32_bf16 v[36:39],a[104:107],v[76:79],v[36:39]
buffer_load_dwordx4 v20,s[8:11],s70 offen offset:512 sc1 lds
s_waitcnt lgkmcnt(2)
v_mfma_f32_16x16x32_bf16 v[40:43],a[228:231],v[80:83],v[40:43]
ds_read_b128 v[72:75],v7 offset:24576
v_mfma_f32_16x16x32_bf16 v[56:59],v[80:83],v[228:231],v[56:59]
s_add_u32 m0,s50,151040
v_mfma_f32_16x16x32_bf16 v[24:27],a[100:103],v[80:83],v[24:27]
ds_read_b128 v[76:79],v7 offset:28672
v_mfma_f32_16x16x32_bf16 v[44:47],a[228:231],v[84:87],v[44:47]
buffer_load_dwordx4 v20,s[8:11],s71 offen offset:512 sc1 lds
v_mfma_f32_16x16x32_bf16 v[60:63],v[84:87],v[228:231],v[60:63]
buffer_load_dwordx2 v[124:125],v23,s[8:11],s76 offen sc1
v_mfma_f32_16x16x32_bf16 v[28:31],a[100:103],v[84:87],v[28:31]
v_mfma_f32_16x16x32_bf16 v[48:51],a[236:239],v[80:83],v[48:51]
v_mfma_f32_16x16x32_bf16 v[64:67],v[80:83],v[236:239],v[64:67]
v_mfma_f32_16x16x32_bf16 v[32:35],a[108:111],v[80:83],v[32:35]
v_mfma_f32_16x16x32_bf16 v[52:55],a[236:239],v[84:87],v[52:55]
v_mfma_f32_16x16x32_bf16 v[68:71],v[84:87],v[236:239],v[68:71]
v_mfma_f32_16x16x32_bf16 v[36:39],a[108:111],v[84:87],v[36:39]
s_waitcnt lgkmcnt(2)
v_mfma_f32_16x16x32_bf16 v[40:43],a[240:243],v[108:111],v[40:43]
v_mfma_f32_16x16x32_bf16 v[56:59],v[108:111],v[240:243],v[56:59]
v_mfma_f32_16x16x32_bf16 v[24:27],a[112:115],v[108:111],v[24:27]
v_mfma_f32_16x16x32_bf16 v[44:47],a[240:243],v[112:115],v[44:47]
v_mfma_f32_16x16x32_bf16 v[60:63],v[112:115],v[240:243],v[60:63]
v_mfma_f32_16x16x32_bf16 v[28:31],a[112:115],v[112:115],v[28:31]
v_mfma_f32_16x16x32_bf16 v[48:51],a[248:251],v[108:111],v[48:51]
v_mfma_f32_16x16x32_bf16 v[64:67],v[108:111],v[248:251],v[64:67]
v_mfma_f32_16x16x32_bf16 v[32:35],a[120:123],v[108:111],v[32:35]
v_mfma_f32_16x16x32_bf16 v[52:55],a[248:251],v[112:115],v[52:55]
v_mfma_f32_16x16x32_bf16 v[68:71],v[112:115],v[248:251],v[68:71]
v_mfma_f32_16x16x32_bf16 v[36:39],a[120:123],v[112:115],v[36:39]
s_waitcnt lgkmcnt(0)
v_mfma_f32_16x16x32_bf16 v[40:43],a[244:247],v[72:75],v[40:43]
v_mfma_f32_16x16x32_bf16 v[56:59],v[72:75],v[244:247],v[56:59]
v_mfma_f32_16x16x32_bf16 v[24:27],a[116:119],v[72:75],v[24:27]
v_mfma_f32_16x16x32_bf16 v[44:47],a[244:247],v[76:79],v[44:47]
v_mfma_f32_16x16x32_bf16 v[60:63],v[76:79],v[244:247],v[60:63]
v_mfma_f32_16x16x32_bf16 v[28:31],a[116:119],v[76:79],v[28:31]
v_mfma_f32_16x16x32_bf16 v[48:51],a[252:255],v[72:75],v[48:51]
v_mfma_f32_16x16x32_bf16 v[64:67],v[72:75],v[252:255],v[64:67]
v_mfma_f32_16x16x32_bf16 v[32:35],a[124:127],v[72:75],v[32:35]
v_mfma_f32_16x16x32_bf16 v[52:55],a[252:255],v[76:79],v[52:55]
v_mfma_f32_16x16x32_bf16 v[68:71],v[76:79],v[252:255],v[68:71]
v_mfma_f32_16x16x32_bf16 v[36:39],a[124:127],v[76:79],v[36:39]
s_lshl_b32 s56,s51,5
s_add_u32 s56,s56,s47
s_lshl_b32 s56,s56,12
s_add_u32 s56,s56,s50
s_add_u32 s56,s56,41943040
v_mov_b64 v[120:121],-1
v_mov_b64 v[122:123],-1
buffer_store_dwordx4 v[120:123],v0,s[8:11],s56 offen sc1
v_cvt_pk_bf16_f32 v72,v40,v48
v_cvt_pk_bf16_f32 v73,v41,v49
v_cvt_pk_bf16_f32 v74,v42,v50
v_cvt_pk_bf16_f32 v75,v43,v51
buffer_store_dwordx4 v[72:75],v0,s[8:11],s61 offen sc1
v_cvt_pk_bf16_f32 v76,v44,v52
v_cvt_pk_bf16_f32 v77,v45,v53
v_cvt_pk_bf16_f32 v78,v46,v54
v_cvt_pk_bf16_f32 v79,v47,v55
buffer_store_dwordx4 v[76:79],v0,s[8:11],s62 offen sc1
v_cvt_pk_bf16_f32 v80,v56,v57
v_cvt_pk_bf16_f32 v81,v58,v59
v_cvt_pk_bf16_f32 v82,v60,v61
v_cvt_pk_bf16_f32 v83,v62,v63
buffer_store_dwordx4 v[80:83],v0,s[8:11],s65 offen offset:0 sc1
v_cvt_pk_bf16_f32 v84,v64,v65
v_cvt_pk_bf16_f32 v85,v66,v67
v_cvt_pk_bf16_f32 v86,v68,v69
v_cvt_pk_bf16_f32 v87,v70,v71
buffer_store_dwordx4 v[84:87],v0,s[8:11],s65 offen offset:1024 sc1
v_cvt_pk_bf16_f32 v108,v24,v32
v_cvt_pk_bf16_f32 v109,v25,v33
v_cvt_pk_bf16_f32 v110,v26,v34
v_cvt_pk_bf16_f32 v111,v27,v35
buffer_store_dwordx4 v[108:111],v0,s[8:11],s63 offen sc1
v_cvt_pk_bf16_f32 v112,v28,v36
v_cvt_pk_bf16_f32 v113,v29,v37
v_cvt_pk_bf16_f32 v114,v30,v38
v_cvt_pk_bf16_f32 v115,v31,v39
buffer_store_dwordx4 v[112:115],v0,s[8:11],s64 offen sc1
s_lshl_b32 s72,s51,13
s_lshl2_add_u32 s72,s47,s72
s_add_u32 s72,s72,10485760
s_sub_u32 s53,s53,1
s_cmp_gt_i32 s53,3
s_cbranch_scc1 L_mo_37
s_cmp_gt_i32 s53,0
s_cselect_b32 s87,1,3
s_mov_b32 s18,0
s_waitcnt vmcnt(7)
s_branch L_mo_42
L_mo_35:
s_mov_b32 s55,s22
s_mov_b32 s22,s23
s_mov_b32 s23,s24
s_mov_b32 s24,-1
v_mov_b32 v3,0
s_cmp_lg_u32 s55,-1
s_cbranch_scc1 L_mp_32
s_sub_u32 s56,s30,s31
s_cmp_gt_i32 s77,0
s_cselect_b32 s57,6,20
s_cmp_lg_u32 s86,0
s_cselect_b32 s57,9,s57
s_cmp_lt_i32 s56,s57
s_cbranch_scc1 L_mo_36
s_cmp_lt_i32 s56,30
s_cselect_b32 s87,s18,0
s_cmp_ge_u32 s31,8
s_cselect_b32 s56,1,s18
s_and_b32 s56,s56,s86
s_cselect_b32 s87,2,s87
s_mul_i32 s56,s87,s18
s_cmp_lg_u32 s56,0
s_cbranch_scc1 L_mo_40
s_mov_b32 s18,0
s_lshr_b32 s56,s72,31
s_or_b32 s56,s56,s87
s_cbranch_scc1 L_mo_46
s_waitcnt vmcnt(0)
s_barrier
s_or_b32 s72,s72,s52
buffer_store_dword v17,off,s[8:11],s72 sc1
s_mov_b32 s72,0x80000000
L_mo_46:
s_cmp_lg_u32 s46,0
s_cbranch_scc1 L_mo_44
s_lshl_b32 s76,s31,13
s_add_u32 s76,s76,10487040
s_lshl_b32 s57,s47,8
s_add_u32 s57,s57,s31
s_cmp_eq_u32 s57,63
s_mov_b32 s57,0x80000000
s_cmov_b32 s57,11018240
v_lshlrev_b32 v2,2,v1
L_mo_43:
buffer_load_dwordx2 v[124:125],v23,s[8:11],s76 offen sc1
buffer_load_dword v3,v2,s[8:11],s57 offen sc1
s_sub_u32 s49,s49,1
s_cbranch_scc1 L_abort
s_waitcnt vmcnt(0)
L_mo_42:
v_min_u32 v123,v124,v125
v_max_u32 v125,v124,v125
v_cmp_eq_u32 vcc,0,v123
s_nop 1
v_cndmask_b32 v125,v125,-1,vcc
s_and_b32 s56,vcc_lo,0xffff
s_cbranch_scc0 L_mo_47
s_cmp_lg_u32 s87,0
s_cbranch_scc1 L_mo_47
s_mov_b32 s18,1
s_sleep 2
s_branch L_mo_43
L_mo_47:
v_max_u32_dpp v125,v125,v125 row_ror:8 row_mask:0xf bank_mask:0xf
s_nop 1
v_max_u32_dpp v125,v125,v125 row_ror:4 row_mask:0xf bank_mask:0xf
s_nop 1
v_max_u32_dpp v125,v125,v125 row_ror:2 row_mask:0xf bank_mask:0xf
s_nop 1
v_max_u32_dpp v125,v125,v125 row_ror:1 row_mask:0xf bank_mask:0xf
L_mo_44:
s_sub_u32 s49,s49,1
s_cbranch_scc1 L_abort
v_mov_b32 v124,s18
s_barrier
s_cmp_lg_u32 s46,0
s_cbranch_scc1 L_mo_45
ds_write_b32 v16,v125
ds_write_b32 v19,v124 offset:16
s_waitcnt lgkmcnt(0)
L_mo_45:
s_barrier
ds_read_b128 v[120:123],v19
ds_read_b32 v124,v19 offset:16
s_waitcnt lgkmcnt(0)
v_readfirstlane_b32 s55,v120
v_readfirstlane_b32 s22,v121
v_readfirstlane_b32 s23,v122
v_readfirstlane_b32 s24,v123
v_readfirstlane_b32 s18,v124
s_cmp_lg_u32 s55,-1
s_cbranch_scc1 L_mp_32
L_mo_40:
s_mov_b32 s22,-1
s_cmp_eq_u32 s87,1
s_cbranch_scc1 L_mo_36
s_cmp_eq_u32 s87,2
s_cbranch_scc1 L_mo_41
s_branch L_mo_35
L_mp_32:
s_mov_b32 s53,0
s_sub_u32 s73,s73,1
s_max_i32 s73,s73,0
s_sub_u32 s77,s77,1
s_min_u32 s61,s73,2
s_cmp_lt_u32 s31,5
s_cselect_b32 s60,s25,0
s_cmp_lt_u32 s55,s60
s_cselect_b32 s61,2,s61
s_cmp_le_u32 s55,s54
s_cbranch_scc1 L_mr_33
s_mov_b32 s77,s61
s_mov_b32 s54,s55
s_mov_b32 s86,0
s_or_b32 s61,s47,s46
s_cbranch_scc1 L_mr_33
v_mov_b32 v120,s54
v_lshlrev_b32 v121,13,v1
s_mov_b32 s61,10486784
buffer_store_dword v120,v121,s[8:11],s61 offen sc1
L_mr_33:
s_cmp_lg_u32 s31,63
s_cbranch_scc1 L_mo_38
s_min_i32 s77,s77,0
s_or_b32 s61,s47,s46
s_cbranch_scc1 L_mo_38
s_mov_b32 s59,11018240
v_lshlrev_b32 v120,2,v1
v_mov_b32 v121,v3
v_cmp_eq_u32 vcc,0,v3
s_cbranch_vccz L_mg_34
L_fp_49:
s_sleep 0
buffer_load_dword v121,v120,s[8:11],s59 offen sc1
s_sub_u32 s49,s49,1
s_cbranch_scc1 L_abort
s_waitcnt vmcnt(0)
v_cmp_eq_u32 vcc,0,v121
s_cbranch_vccnz L_fp_49
L_mg_34:
s_andn2_b32 s62,0x7ff,s54
v_lshl_or_b32 v121,s62,8,v121
s_add_u32 s59,s59,8192
buffer_store_dword v121,v120,s[8:11],s59 offen sc1
s_add_u32 s59,s59,8192
buffer_store_dword v121,v120,s[8:11],s59 offen sc1
s_add_u32 s59,s59,8192
buffer_store_dword v121,v120,s[8:11],s59 offen sc1
s_add_u32 s59,s59,8192
buffer_store_dword v121,v120,s[8:11],s59 offen sc1
s_add_u32 s59,s59,8192
buffer_store_dword v121,v120,s[8:11],s59 offen sc1
s_add_u32 s59,s59,8192
buffer_store_dword v121,v120,s[8:11],s59 offen sc1
L_mo_38:
s_add_u32 s31,s31,1
s_cmp_gt_i32 s77,0
s_cmov_b32 s18,0
s_cbranch_scc1 L_mo_35
s_cmp_lg_u32 s77,0
s_cbranch_scc1 L_mo_39
s_andn2_b32 s51,0x7ff,s54
s_lshr_b32 s51,s51,5
s_add_u32 s73,s73,2
s_mov_b32 s86,1
s_mov_b32 s19,0
s_mov_b32 s18,0
s_waitcnt vmcnt(8)
s_barrier
s_andn2_b32 s64,0x7ff,s54
s_lshl_b32 s56,s64,10
s_add_u32 s58,s56,4194304
buffer_load_dwordx4 v[88:91],v0,s[8:11],s58 offen sc1
v_and_b32 v9,15,v1
v_lshrrev_b32 v10,4,v1
v_and_b32 v124,1,v1
v_lshlrev_b32 v124,4,v124
v_mov_b32 v125,0xffff
v_lshlrev_b32 v125,v124,v125
v_lshrrev_b32 v124,2,v9
v_cmp_eq_u32 vcc,0,v124
s_nop 1
v_cndmask_b32 v12,0,v125,vcc
v_cmp_eq_u32 vcc,1,v124
s_nop 1
v_cndmask_b32 v13,0,v125,vcc
v_and_b32 v124,2,v1
v_cmp_eq_u32 vcc,0,v124
v_mov_b32 v14,0xeeee
v_mov_b32 v124,0x4444
v_cndmask_b32 v14,v14,v124,vcc
v_lshlrev_b32 v11,14,v10
v_lshl_add_u32 v11,v9,4,v11
s_lshl_b32 s65,s51,15
s_add_u32 s65,s65,92274688
s_lshl_b32 s62,s47,10
s_add_u32 s62,s62,s65
s_lshl_b32 s63,s47,16
s_lshl_b32 s60,s46,8
s_add_u32 s63,s63,s60
s_mov_b32 s4,s38
s_mov_b32 s5,s39
s_mov_b32 s6,1835008
s_mov_b32 s7,0x20000
s_lshl_b32 s57,s46,11
s_add_u32 s57,s57,139264
v_add_u32 v8,s57,v0
v_and_b32 v2,1,v10
v_lshrrev_b32 v3,1,v10
v_lshlrev_b32 v2,7,v2
v_lshl_add_u32 v2,v3,10,v2
s_lshl_b32 s59,s46,8
s_add_u32 s59,s57,s59
v_add_u32 v2,s59,v2
s_mov_b32 s60,0x01000100
s_mov_b32 s61,0x03020302
s_waitcnt vmcnt(0)
L_mx_50:
v_max3_u32 v124,v88,v89,v90
v_max_u32 v124,v91,v124
v_cmp_eq_u32 vcc,-1,v124
s_cbranch_vccz L_mxd_51
buffer_load_dwordx4 v[88:91],v0,s[8:11],s58 offen sc1
s_sub_u32 s49,s49,1
s_cbranch_scc1 L_abort
s_waitcnt vmcnt(0)
s_branch L_mx_50
L_mxd_51:
buffer_load_dwordx4 v[24:27],v11,s[4:7],s63 offen offset:0
buffer_load_dwordx4 v[28:31],v11,s[4:7],s63 offen offset:1024
buffer_load_dwordx4 v[32:35],v11,s[4:7],s63 offen offset:2048
buffer_load_dwordx4 v[36:39],v11,s[4:7],s63 offen offset:3072
v_lshlrev_b32 v96,16,v88
v_and_b32 v97,0xffff0000,v88
v_lshlrev_b32 v98,16,v89
v_and_b32 v99,0xffff0000,v89
v_lshlrev_b32 v100,16,v90
v_and_b32 v101,0xffff0000,v90
v_lshlrev_b32 v102,16,v91
v_and_b32 v103,0xffff0000,v91
v_readfirstlane_b32 s78,v96
s_nop 1
v_pk_add_f32 v[108:109],v[96:97],s[78:79] op_sel_hi:[1,0] neg_lo:[0,1] neg_hi:[0,1]
v_pk_add_f32 v[110:111],v[98:99],s[78:79] op_sel_hi:[1,0] neg_lo:[0,1] neg_hi:[0,1]
v_pk_add_f32 v[112:113],v[100:101],s[78:79] op_sel_hi:[1,0] neg_lo:[0,1] neg_hi:[0,1]
v_pk_add_f32 v[114:115],v[102:103],s[78:79] op_sel_hi:[1,0] neg_lo:[0,1] neg_hi:[0,1]
v_pk_add_f32 v[116:117],v[108:109],v[110:111]
v_pk_mul_f32 v[118:119],v[108:109],v[108:109]
v_pk_add_f32 v[120:121],v[112:113],v[114:115]
v_pk_fma_f32 v[118:119],v[110:111],v[110:111],v[118:119]
v_pk_add_f32 v[116:117],v[116:117],v[120:121]
v_pk_fma_f32 v[118:119],v[112:113],v[112:113],v[118:119]
v_add_f32 v116,v116,v117
v_pk_fma_f32 v[118:119],v[114:115],v[114:115],v[118:119]
v_add_f32 v118,v118,v119
s_nop 1
v_permlane32_swap_b32 v116,v118
v_add_f32 v116,v116,v118
s_nop 1
v_add_f32_dpp v116,v116,v116 row_ror:8 row_mask:0xf bank_mask:0xf
s_nop 1
v_add_f32_dpp v116,v116,v116 row_ror:4 row_mask:0xf bank_mask:0xf
s_nop 1
v_add_f32_dpp v116,v116,v116 row_ror:2 row_mask:0xf bank_mask:0xf
s_nop 1
v_add_f32_dpp v116,v116,v116 row_ror:1 row_mask:0xf bank_mask:0xf
v_mov_b32 v118,v116
s_nop 1
v_permlane16_swap_b32 v116,v118
v_add_f32 v116,v116,v118
v_mul_f32 v116,0x3b000000,v116
v_mov_b32 v118,v116
s_nop 1
v_permlane32_swap_b32 v116,v118
v_fma_f32 v118,-v116,v116,v118
v_add_f32 v116,s78,v116
v_max_f32 v118,0,v118
v_cvt_pk_bf16_f32 v118,v116,v118
v_lshlrev_b32 v116,16,v118
v_and_b32 v118,0xffff0000,v118
v_add_f32 v118,0x3727c5ac,v118
v_cvt_pk_bf16_f32 v118,v118,v118
v_and_b32 v118,0xffff0000,v118
v_sqrt_f32 v118,v118
v_pk_add_f32 v[108:109],v[96:97],v[116:117] op_sel_hi:[1,0] neg_lo:[0,1] neg_hi:[0,1]
v_pk_add_f32 v[110:111],v[98:99],v[116:117] op_sel_hi:[1,0] neg_lo:[0,1] neg_hi:[0,1]
v_pk_add_f32 v[112:113],v[100:101],v[116:117] op_sel_hi:[1,0] neg_lo:[0,1] neg_hi:[0,1]
v_pk_add_f32 v[114:115],v[102:103],v[116:117] op_sel_hi:[1,0] neg_lo:[0,1] neg_hi:[0,1]
v_cvt_pk_bf16_f32 v118,v118,v118
v_and_b32 v118,0xffff0000,v118
v_rcp_f32 v118,v118
v_cvt_pk_bf16_f32 v104,v108,v109
v_cvt_pk_bf16_f32 v105,v110,v111
v_cvt_pk_bf16_f32 v106,v112,v113
v_cvt_pk_bf16_f32 v107,v114,v115
v_lshlrev_b32 v108,16,v104
v_and_b32 v109,0xffff0000,v104
v_lshlrev_b32 v110,16,v105
v_and_b32 v111,0xffff0000,v105
v_lshlrev_b32 v112,16,v106
v_and_b32 v113,0xffff0000,v106
v_lshlrev_b32 v114,16,v107
v_and_b32 v115,0xffff0000,v107
v_pk_mul_f32 v[108:109],v[108:109],v[118:119] op_sel_hi:[1,0]
v_pk_mul_f32 v[110:111],v[110:111],v[118:119] op_sel_hi:[1,0]
v_pk_mul_f32 v[112:113],v[112:113],v[118:119] op_sel_hi:[1,0]
v_pk_mul_f32 v[114:115],v[114:115],v[118:119] op_sel_hi:[1,0]
v_cvt_pk_bf16_f32 v104,v108,v109
v_cvt_pk_bf16_f32 v105,v110,v111
v_cvt_pk_bf16_f32 v106,v112,v113
v_cvt_pk_bf16_f32 v107,v114,v115
v_perm_b32 v88,v104,v104,s60
v_perm_b32 v89,v105,v105,s60
v_perm_b32 v90,v106,v106,s60
v_perm_b32 v91,v107,v107,s60
ds_write_b128 v8,v[88:91]
v_perm_b32 v92,v104,v104,s61
v_perm_b32 v93,v105,v105,s61
v_perm_b32 v94,v106,v106,s61
v_perm_b32 v95,v107,v107,s61
ds_write_b128 v8,v[92:95] offset:1024
s_mov_b32 s58,s57
ds_read_b128 v[88:91],v2 offset:0
ds_read_b128 v[92:95],v2 offset:64
ds_read_b128 v[108:111],v18 offset:0
ds_read_b128 v[112:115],v18 offset:1024
ds_read_b128 v[64:67],v18 offset:2048
ds_read_b128 v[68:71],v18 offset:3072
ds_read_b128 v[72:75],v18 offset:4096
ds_read_b128 v[76:79],v18 offset:5120
ds_read_b128 v[80:83],v18 offset:6144
ds_read_b128 v[84:87],v18 offset:7168
v_mov_b64 v[116:117],0
v_mov_b64 v[118:119],0
s_waitcnt lgkmcnt(8)
v_and_b32 v120,v12,v88
v_and_b32 v121,v13,v88
v_and_b32 v122,v12,v92
v_and_b32 v123,v13,v92
s_waitcnt lgkmcnt(6)
s_nop 0
v_smfmac_f32_16x16x64_bf16 v[116:119],v[120:123],v[108:115],v14
ds_read_b128 v[108:111],v18 offset:8192
ds_read_b128 v[112:115],v18 offset:9216
s_add_u32 s63,s63,4096
buffer_load_dwordx4 v[40:43],v11,s[4:7],s63 offen offset:0
v_and_b32 v124,v12,v89
v_and_b32 v125,v13,v89
v_and_b32 v126,v12,v93
v_and_b32 v127,v13,v93
s_waitcnt lgkmcnt(6)
s_nop 0
v_smfmac_f32_16x16x64_bf16 v[116:119],v[124:127],v[64:71],v14
ds_read_b128 v[64:67],v18 offset:10240
ds_read_b128 v[68:71],v18 offset:11264
buffer_load_dwordx4 v[44:47],v11,s[4:7],s63 offen offset:1024
v_and_b32 v120,v12,v90
v_and_b32 v121,v13,v90
v_and_b32 v122,v12,v94
v_and_b32 v123,v13,v94
s_waitcnt lgkmcnt(6)
s_nop 0
v_smfmac_f32_16x16x64_bf16 v[116:119],v[120:123],v[72:79],v14
ds_read_b128 v[72:75],v18 offset:12288
ds_read_b128 v[76:79],v18 offset:13312
buffer_load_dwordx4 v[48:51],v11,s[4:7],s63 offen offset:2048
v_and_b32 v124,v12,v91
v_and_b32 v125,v13,v91
v_and_b32 v126,v12,v95
v_and_b32 v127,v13,v95
ds_read_b128 v[88:91],v2 offset:16
ds_read_b128 v[92:95],v2 offset:80
s_waitcnt lgkmcnt(8)
v_smfmac_f32_16x16x64_bf16 v[116:119],v[124:127],v[80:87],v14
ds_read_b128 v[80:83],v18 offset:14336
ds_read_b128 v[84:87],v18 offset:15360
buffer_load_dwordx4 v[52:55],v11,s[4:7],s63 offen offset:3072
s_waitcnt lgkmcnt(2)
v_and_b32 v120,v12,v88
v_and_b32 v121,v13,v88
v_and_b32 v122,v12,v92
v_and_b32 v123,v13,v92
s_waitcnt lgkmcnt(8)
s_nop 0
v_smfmac_f32_16x16x64_bf16 v[116:119],v[120:123],v[108:115],v14
ds_read_b128 v[108:111],v18 offset:16384
ds_read_b128 v[112:115],v18 offset:17408
s_add_u32 s63,s63,4096
buffer_load_dwordx4 v[56:59],v11,s[4:7],s63 offen offset:0
v_and_b32 v124,v12,v89
v_and_b32 v125,v13,v89
v_and_b32 v126,v12,v93
v_and_b32 v127,v13,v93
s_waitcnt lgkmcnt(8)
s_nop 0
v_smfmac_f32_16x16x64_bf16 v[116:119],v[124:127],v[64:71],v14
ds_read_b128 v[64:67],v18 offset:18432
ds_read_b128 v[68:71],v18 offset:19456
buffer_load_dwordx4 v[60:63],v11,s[4:7],s63 offen offset:1024
v_and_b32 v120,v12,v90
v_and_b32 v121,v13,v90
v_and_b32 v122,v12,v94
v_and_b32 v123,v13,v94
s_waitcnt lgkmcnt(8)
s_nop 0
v_smfmac_f32_16x16x64_bf16 v[116:119],v[120:123],v[72:79],v14
ds_read_b128 v[72:75],v18 offset:20480
ds_read_b128 v[76:79],v18 offset:21504
buffer_load_dword v15,v0,s[8:11],s62 offen
v_and_b32 v124,v12,v91
v_and_b32 v125,v13,v91
v_and_b32 v126,v12,v95
v_and_b32 v127,v13,v95
ds_read_b128 v[88:91],v2 offset:32
ds_read_b128 v[92:95],v2 offset:96
s_waitcnt lgkmcnt(8)
v_smfmac_f32_16x16x64_bf16 v[116:119],v[124:127],v[80:87],v14
ds_read_b128 v[80:83],v18 offset:22528
ds_read_b128 v[84:87],v18 offset:23552
s_waitcnt lgkmcnt(2)
v_and_b32 v120,v12,v88
v_and_b32 v121,v13,v88
v_and_b32 v122,v12,v92
v_and_b32 v123,v13,v92
s_waitcnt lgkmcnt(8)
s_nop 0
v_smfmac_f32_16x16x64_bf16 v[116:119],v[120:123],v[108:115],v14
ds_read_b128 v[108:111],v18 offset:24576
ds_read_b128 v[112:115],v18 offset:25600
v_and_b32 v124,v12,v89
v_and_b32 v125,v13,v89
v_and_b32 v126,v12,v93
v_and_b32 v127,v13,v93
s_waitcnt lgkmcnt(8)
s_nop 0
v_smfmac_f32_16x16x64_bf16 v[116:119],v[124:127],v[64:71],v14
ds_read_b128 v[64:67],v18 offset:26624
ds_read_b128 v[68:71],v18 offset:27648
v_and_b32 v120,v12,v90
v_and_b32 v121,v13,v90
v_and_b32 v122,v12,v94
v_and_b32 v123,v13,v94
s_waitcnt lgkmcnt(8)
s_nop 0
v_smfmac_f32_16x16x64_bf16 v[116:119],v[120:123],v[72:79],v14
ds_read_b128 v[72:75],v18 offset:28672
ds_read_b128 v[76:79],v18 offset:29696
v_and_b32 v124,v12,v91
v_and_b32 v125,v13,v91
v_and_b32 v126,v12,v95
v_and_b32 v127,v13,v95
ds_read_b128 v[88:91],v2 offset:48
ds_read_b128 v[92:95],v2 offset:112
s_waitcnt lgkmcnt(8)
v_smfmac_f32_16x16x64_bf16 v[116:119],v[124:127],v[80:87],v14
ds_read_b128 v[80:83],v18 offset:30720
ds_read_b128 v[84:87],v18 offset:31744
s_waitcnt lgkmcnt(2)
v_and_b32 v120,v12,v88
v_and_b32 v121,v13,v88
v_and_b32 v122,v12,v92
v_and_b32 v123,v13,v92
s_waitcnt lgkmcnt(8)
s_nop 0
v_smfmac_f32_16x16x64_bf16 v[116:119],v[120:123],v[108:115],v14
v_and_b32 v124,v12,v89
v_and_b32 v125,v13,v89
v_and_b32 v126,v12,v93
v_and_b32 v127,v13,v93
s_waitcnt lgkmcnt(6)
s_nop 0
v_smfmac_f32_16x16x64_bf16 v[116:119],v[124:127],v[64:71],v14
buffer_load_dwordx4 v[64:67],v11,s[4:7],s63 offen offset:2048
buffer_load_dwordx4 v[68:71],v11,s[4:7],s63 offen offset:3072
v_and_b32 v120,v12,v90
v_and_b32 v121,v13,v90
v_and_b32 v122,v12,v94
v_and_b32 v123,v13,v94
s_waitcnt lgkmcnt(4)
s_nop 0
v_smfmac_f32_16x16x64_bf16 v[116:119],v[120:123],v[72:79],v14
s_add_u32 s63,s63,4096
buffer_load_dwordx4 v[72:75],v11,s[4:7],s63 offen offset:0
buffer_load_dwordx4 v[76:79],v11,s[4:7],s63 offen offset:1024
v_and_b32 v124,v12,v91
v_and_b32 v125,v13,v91
v_and_b32 v126,v12,v95
v_and_b32 v127,v13,v95
s_waitcnt lgkmcnt(0)
s_nop 0
v_smfmac_f32_16x16x64_bf16 v[116:119],v[124:127],v[80:87],v14
buffer_load_dwordx4 v[80:83],v11,s[4:7],s63 offen offset:2048
buffer_load_dwordx4 v[84:87],v11,s[4:7],s63 offen offset:3072
v_lshlrev_b32 v8,5,v9
v_and_b32 v124,1,v10
v_lshl_add_u32 v8,v124,4,v8
v_lshrrev_b32 v124,1,v10
v_lshl_add_u32 v8,v124,11,v8
s_lshl_b32 s60,s46,9
s_add_u32 s60,s60,147456
v_add_u32 v8,s60,v8
ds_write_b128 v8,v[116:119]
v_lshlrev_b32 v8,2,v1
v_add_u32 v8,147456,v8
v_and_b32 v2,1,v1
v_lshrrev_b32 v3,1,v1
v_lshlrev_b32 v3,2,v3
v_lshl_add_u32 v2,v2,7,v3
v_add_u32 v2,s58,v2
v_lshlrev_b32 v3,6,v10
v_add_u32 v3,s58,v3
s_waitcnt lgkmcnt(0)
s_barrier
ds_read2st64_b32 v[88:89],v8 offset0:0 offset1:1
ds_read2st64_b32 v[90:91],v8 offset0:2 offset1:3
ds_read2st64_b32 v[92:93],v8 offset0:4 offset1:5
ds_read2st64_b32 v[94:95],v8 offset0:6 offset1:7
s_waitcnt lgkmcnt(0)
v_pk_add_f32 v[88:89],v[88:89],v[90:91]
v_pk_add_f32 v[92:93],v[92:93],v[94:95]
v_pk_add_f32 v[88:89],v[88:89],v[92:93]
v_cvt_pk_bf16_f32 v88,v88,v88
v_and_b32 v88,0xffff0000,v88
v_cvt_pk_bf16_f32 v89,v89,v89
v_and_b32 v89,0xffff0000,v89
v_mul_f32 v90,0xbfb8aa3b,v88
v_exp_f32 v90,v90
s_nop 0
v_add_f32 v90,1.0,v90
v_rcp_f32 v90,v90
s_nop 0
v_mul_f32 v88,v88,v90
v_cvt_pk_bf16_f32 v88,v88,v88
v_and_b32 v88,0xffff0000,v88
v_mul_f32 v88,v88,v89
v_cvt_pk_bf16_f32 v88,v88,v88
ds_write_b32 v2,v88
ds_read_b128 v[88:91],v3
ds_read_b128 v[108:111],v3 offset:32
ds_read_b128 v[92:95],v3 offset:16
ds_read_b128 v[112:115],v3 offset:48
v_mov_b64 v[116:117],0
v_mov_b64 v[118:119],0
s_waitcnt vmcnt(0) lgkmcnt(0)
v_and_b32 v120,v12,v88
v_and_b32 v121,v13,v88
v_and_b32 v122,v12,v108
v_and_b32 v123,v13,v108
v_and_b32 v124,v12,v89
v_and_b32 v125,v13,v89
v_smfmac_f32_16x16x64_bf16 v[116:119],v[120:123],v[24:31],v14
v_and_b32 v126,v12,v109
v_and_b32 v127,v13,v109
v_and_b32 v120,v12,v90
v_and_b32 v121,v13,v90
v_smfmac_f32_16x16x64_bf16 v[116:119],v[124:127],v[32:39],v14
v_and_b32 v122,v12,v110
v_and_b32 v123,v13,v110
v_and_b32 v124,v12,v91
v_and_b32 v125,v13,v91
v_smfmac_f32_16x16x64_bf16 v[116:119],v[120:123],v[40:47],v14
v_and_b32 v126,v12,v111
v_and_b32 v127,v13,v111
v_and_b32 v120,v12,v92
v_and_b32 v121,v13,v92
v_smfmac_f32_16x16x64_bf16 v[116:119],v[124:127],v[48:55],v14
v_and_b32 v122,v12,v112
v_and_b32 v123,v13,v112
v_and_b32 v124,v12,v93
v_and_b32 v125,v13,v93
v_smfmac_f32_16x16x64_bf16 v[116:119],v[120:123],v[56:63],v14
v_and_b32 v126,v12,v113
v_and_b32 v127,v13,v113
v_and_b32 v120,v12,v94
v_and_b32 v121,v13,v94
v_smfmac_f32_16x16x64_bf16 v[116:119],v[124:127],v[64:71],v14
v_and_b32 v122,v12,v114
v_and_b32 v123,v13,v114
v_and_b32 v124,v12,v95
v_and_b32 v125,v13,v95
v_smfmac_f32_16x16x64_bf16 v[116:119],v[120:123],v[72:79],v14
v_and_b32 v126,v12,v115
v_and_b32 v127,v13,v115
s_nop 1
v_smfmac_f32_16x16x64_bf16 v[116:119],v[124:127],v[80:87],v14
v_lshlrev_b32 v8,4,v9
v_and_b32 v124,1,v10
v_lshl_add_u32 v8,v124,3,v8
v_and_b32 v124,2,v10
v_lshl_add_u32 v8,v124,30,v8
s_lshl_b32 s60,s46,8
s_add_u32 s59,s62,s60
s_nop 0
v_cvt_pk_bf16_f32 v88,v116,v117
v_cvt_pk_bf16_f32 v89,v118,v119
buffer_store_dwordx2 v[88:89],v8,s[8:11],s59 offen
s_lshl_b32 s59,s51,13
s_lshl2_add_u32 s59,s47,s59
s_add_u32 s59,s59,10486912
s_waitcnt vmcnt(0)
s_barrier
s_or_b32 s59,s59,s52
buffer_store_dword v17,off,s[8:11],s59
s_lshl_b32 s59,s51,13
s_add_u32 s59,s59,10486912
v_and_b32 v124,31,v1
v_lshlrev_b32 v124,2,v124
L_fw_53:
buffer_load_dword v125,v124,s[8:11],s59 offen sc1
s_sub_u32 s49,s49,1
s_cbranch_scc1 L_abort
s_waitcnt vmcnt(0)
v_cmp_eq_u32 vcc,0,v125
s_cbranch_vccnz L_fw_53
s_add_u32 s63,s65,0
buffer_load_dwordx4 v[24:27],v22,s[8:11],s63 offen sc1
s_add_u32 s63,s65,4096
buffer_load_dwordx4 v[28:31],v22,s[8:11],s63 offen sc1
s_add_u32 s63,s65,8192
buffer_load_dwordx4 v[32:35],v22,s[8:11],s63 offen sc1
s_add_u32 s63,s65,12288
buffer_load_dwordx4 v[36:39],v22,s[8:11],s63 offen sc1
s_add_u32 s63,s65,16384
buffer_load_dwordx4 v[40:43],v22,s[8:11],s63 offen sc1
s_add_u32 s63,s65,20480
buffer_load_dwordx4 v[44:47],v22,s[8:11],s63 offen sc1
s_add_u32 s63,s65,24576
buffer_load_dwordx4 v[48:51],v22,s[8:11],s63 offen sc1
s_add_u32 s63,s65,28672
buffer_load_dwordx4 v[52:55],v22,s[8:11],s63 offen sc1
v_and_b32 v64,15,v1
v_and_b32 v65,1,v1
v_lshlrev_b32 v65,4,v65
v_mov_b32 v66,0x3f80
v_lshlrev_b32 v66,v65,v66
v_lshrrev_b32 v64,1,v64
v_cmp_eq_u32 vcc,0,v64
s_nop 1
v_cndmask_b32 v56,0,v66,vcc
v_cmp_eq_u32 vcc,1,v64
s_nop 1
v_cndmask_b32 v57,0,v66,vcc
v_cmp_eq_u32 vcc,2,v64
s_nop 1
v_cndmask_b32 v58,0,v66,vcc
v_cmp_eq_u32 vcc,3,v64
s_nop 1
v_cndmask_b32 v59,0,v66,vcc
s_waitcnt vmcnt(7)
s_nop 0
v_mfma_f32_16x16x32_bf16 v[60:63],v[56:59],v[24:27],0
s_waitcnt vmcnt(6)
v_mfma_f32_16x16x32_bf16 v[60:63],v[56:59],v[28:31],v[60:63]
s_waitcnt vmcnt(5)
v_mfma_f32_16x16x32_bf16 v[60:63],v[56:59],v[32:35],v[60:63]
s_waitcnt vmcnt(4)
v_mfma_f32_16x16x32_bf16 v[60:63],v[56:59],v[36:39],v[60:63]
s_waitcnt vmcnt(3)
v_mfma_f32_16x16x32_bf16 v[60:63],v[56:59],v[40:43],v[60:63]
s_waitcnt vmcnt(2)
v_mfma_f32_16x16x32_bf16 v[60:63],v[56:59],v[44:47],v[60:63]
s_waitcnt vmcnt(1)
v_mfma_f32_16x16x32_bf16 v[60:63],v[56:59],v[48:51],v[60:63]
s_waitcnt vmcnt(0)
v_mfma_f32_16x16x32_bf16 v[60:63],v[56:59],v[52:55],v[60:63]
s_nop 7
ds_write_b128 v21,v[60:63]
s_waitcnt lgkmcnt(0)
s_barrier
s_cmp_lg_u32 s46,0
s_cbranch_scc1 L_moed_52
v_lshlrev_b32 v56,5,v1
v_add_u32 v56,155648,v56
ds_read_b128 v[24:27],v56
ds_read_b128 v[28:31],v56 offset:16
s_and_b32 s59,s54,0xffff0000
s_xor_b32 s60,s59,0x80000000
s_xor_b32 s61,s59,0xffff0000
s_cmp_lt_i32 s59,0
s_cselect_b32 s59,s60,s61
v_mov_b32 v56,s59
v_mul_f32 v56,0xbfb8aa3b,v56
v_exp_f32 v56,v56
s_nop 0
v_add_f32 v56,1.0,v56
v_rcp_f32 v56,v56
s_nop 0
v_cvt_pk_bf16_f32 v56,v56,v56
v_and_b32 v56,0xffff0000,v56
v_lshlrev_b32 v48,16,v104
v_and_b32 v49,0xffff0000,v104
v_lshlrev_b32 v50,16,v105
v_and_b32 v51,0xffff0000,v105
v_lshlrev_b32 v52,16,v106
v_and_b32 v53,0xffff0000,v106
v_lshlrev_b32 v54,16,v107
v_and_b32 v55,0xffff0000,v107
s_waitcnt lgkmcnt(0)
v_cvt_pk_bf16_f32 v40,v24,v25
v_cvt_pk_bf16_f32 v41,v26,v27
v_cvt_pk_bf16_f32 v42,v28,v29
v_cvt_pk_bf16_f32 v43,v30,v31
v_lshlrev_b32 v24,16,v40
v_and_b32 v25,0xffff0000,v40
v_lshlrev_b32 v26,16,v41
v_and_b32 v27,0xffff0000,v41
v_lshlrev_b32 v28,16,v42
v_and_b32 v29,0xffff0000,v42
v_lshlrev_b32 v30,16,v43
v_and_b32 v31,0xffff0000,v43
v_pk_mul_f32 v[24:25],v[24:25],v[56:57] op_sel_hi:[1,0]
v_pk_mul_f32 v[26:27],v[26:27],v[56:57] op_sel_hi:[1,0]
v_pk_mul_f32 v[28:29],v[28:29],v[56:57] op_sel_hi:[1,0]
v_pk_mul_f32 v[30:31],v[30:31],v[56:57] op_sel_hi:[1,0]
v_cvt_pk_bf16_f32 v40,v24,v25
v_cvt_pk_bf16_f32 v41,v26,v27
v_cvt_pk_bf16_f32 v42,v28,v29
v_cvt_pk_bf16_f32 v43,v30,v31
v_lshlrev_b32 v24,16,v40
v_and_b32 v25,0xffff0000,v40
v_lshlrev_b32 v26,16,v41
v_and_b32 v27,0xffff0000,v41
v_lshlrev_b32 v28,16,v42
v_and_b32 v29,0xffff0000,v42
v_lshlrev_b32 v30,16,v43
v_and_b32 v31,0xffff0000,v43
v_pk_add_f32 v[24:25],v[24:25],v[48:49]
v_pk_add_f32 v[26:27],v[26:27],v[50:51]
v_pk_add_f32 v[28:29],v[28:29],v[52:53]
v_pk_add_f32 v[30:31],v[30:31],v[54:55]
v_cvt_pk_bf16_f32 v40,v24,v25
v_cvt_pk_bf16_f32 v41,v26,v27
v_cvt_pk_bf16_f32 v42,v28,v29
v_cvt_pk_bf16_f32 v43,v30,v31
v_lshlrev_b32 v24,16,v40
v_and_b32 v25,0xffff0000,v40
v_lshlrev_b32 v26,16,v41
v_and_b32 v27,0xffff0000,v41
v_lshlrev_b32 v28,16,v42
v_and_b32 v29,0xffff0000,v42
v_lshlrev_b32 v30,16,v43
v_and_b32 v31,0xffff0000,v43
v_pk_add_f32 v[96:97],v[96:97],v[24:25]
v_pk_add_f32 v[98:99],v[98:99],v[26:27]
v_pk_add_f32 v[100:101],v[100:101],v[28:29]
v_pk_add_f32 v[102:103],v[102:103],v[30:31]
v_cvt_pk_bf16_f32 v80,v96,v97
v_cvt_pk_bf16_f32 v81,v98,v99
v_cvt_pk_bf16_f32 v82,v100,v101
v_cvt_pk_bf16_f32 v83,v102,v103
v_lshlrev_b32 v96,16,v80
v_and_b32 v97,0xffff0000,v80
v_lshlrev_b32 v98,16,v81
v_and_b32 v99,0xffff0000,v81
v_lshlrev_b32 v100,16,v82
v_and_b32 v101,0xffff0000,v82
v_lshlrev_b32 v102,16,v83
v_and_b32 v103,0xffff0000,v83
v_readfirstlane_b32 s78,v96
s_nop 1
v_pk_add_f32 v[58:59],v[96:97],s[78:79] op_sel_hi:[1,0] neg_lo:[0,1] neg_hi:[0,1]
v_pk_add_f32 v[60:61],v[98:99],s[78:79] op_sel_hi:[1,0] neg_lo:[0,1] neg_hi:[0,1]
v_pk_add_f32 v[62:63],v[100:101],s[78:79] op_sel_hi:[1,0] neg_lo:[0,1] neg_hi:[0,1]
v_pk_add_f32 v[64:65],v[102:103],s[78:79] op_sel_hi:[1,0] neg_lo:[0,1] neg_hi:[0,1]
v_pk_add_f32 v[66:67],v[58:59],v[60:61]
v_pk_mul_f32 v[68:69],v[58:59],v[58:59]
v_pk_add_f32 v[70:71],v[62:63],v[64:65]
v_pk_fma_f32 v[68:69],v[60:61],v[60:61],v[68:69]
v_pk_add_f32 v[66:67],v[66:67],v[70:71]
v_pk_fma_f32 v[68:69],v[62:63],v[62:63],v[68:69]
v_add_f32 v66,v66,v67
v_pk_fma_f32 v[68:69],v[64:65],v[64:65],v[68:69]
v_add_f32 v68,v68,v69
s_nop 1
v_permlane32_swap_b32 v66,v68
v_add_f32 v66,v66,v68
s_nop 1
v_add_f32_dpp v66,v66,v66 row_ror:8 row_mask:0xf bank_mask:0xf
s_nop 1
v_add_f32_dpp v66,v66,v66 row_ror:4 row_mask:0xf bank_mask:0xf
s_nop 1
v_add_f32_dpp v66,v66,v66 row_ror:2 row_mask:0xf bank_mask:0xf
s_nop 1
v_add_f32_dpp v66,v66,v66 row_ror:1 row_mask:0xf bank_mask:0xf
v_mov_b32 v68,v66
s_nop 1
v_permlane16_swap_b32 v66,v68
v_add_f32 v66,v66,v68
v_mul_f32 v66,0x3b000000,v66
v_mov_b32 v68,v66
s_nop 1
v_permlane32_swap_b32 v66,v68
v_fma_f32 v68,-v66,v66,v68
v_add_f32 v66,s78,v66
v_max_f32 v68,0,v68
v_cvt_pk_bf16_f32 v68,v66,v68
v_lshlrev_b32 v66,16,v68
v_and_b32 v68,0xffff0000,v68
v_add_f32 v68,0x3727c5ac,v68
v_cvt_pk_bf16_f32 v68,v68,v68
v_and_b32 v68,0xffff0000,v68
v_sqrt_f32 v68,v68
v_pk_add_f32 v[58:59],v[96:97],v[66:67] op_sel_hi:[1,0] neg_lo:[0,1] neg_hi:[0,1]
v_pk_add_f32 v[60:61],v[98:99],v[66:67] op_sel_hi:[1,0] neg_lo:[0,1] neg_hi:[0,1]
v_pk_add_f32 v[62:63],v[100:101],v[66:67] op_sel_hi:[1,0] neg_lo:[0,1] neg_hi:[0,1]
v_pk_add_f32 v[64:65],v[102:103],v[66:67] op_sel_hi:[1,0] neg_lo:[0,1] neg_hi:[0,1]
v_cvt_pk_bf16_f32 v68,v68,v68
v_and_b32 v68,0xffff0000,v68
v_rcp_f32 v68,v68
v_cvt_pk_bf16_f32 v84,v58,v59
v_cvt_pk_bf16_f32 v85,v60,v61
v_cvt_pk_bf16_f32 v86,v62,v63
v_cvt_pk_bf16_f32 v87,v64,v65
v_lshlrev_b32 v58,16,v84
v_and_b32 v59,0xffff0000,v84
v_lshlrev_b32 v60,16,v85
v_and_b32 v61,0xffff0000,v85
v_lshlrev_b32 v62,16,v86
v_and_b32 v63,0xffff0000,v86
v_lshlrev_b32 v64,16,v87
v_and_b32 v65,0xffff0000,v87
v_pk_mul_f32 v[58:59],v[58:59],v[68:69] op_sel_hi:[1,0]
v_pk_mul_f32 v[60:61],v[60:61],v[68:69] op_sel_hi:[1,0]
v_pk_mul_f32 v[62:63],v[62:63],v[68:69] op_sel_hi:[1,0]
v_pk_mul_f32 v[64:65],v[64:65],v[68:69] op_sel_hi:[1,0]
v_cvt_pk_bf16_f32 v84,v58,v59
v_cvt_pk_bf16_f32 v85,v60,v61
v_cvt_pk_bf16_f32 v86,v62,v63
v_cvt_pk_bf16_f32 v87,v64,v65
s_lshl_b32 s58,s51,10
s_add_u32 s58,s58,11272192
s_add_u32 s59,s58,65536
s_cmp_eq_u32 s47,0
s_cselect_b32 s59,s59,0x80000000
s_add_u32 s57,s56,98566144
buffer_store_dwordx4 v[84:87],v0,s[8:11],s59 offen sc1
buffer_store_dwordx4 v[80:83],v0,s[8:11],s58 offen sc1
buffer_store_dwordx4 v[84:87],v0,s[8:11],s57 offen sc1
L_moed_52:
s_barrier
L_mo_39:
s_mov_b32 s77,-1
s_cmp_lt_u32 s31,64
s_cbranch_scc1 L_mo_35
s_cmp_eq_u32 s86,0
s_cbranch_scc1 L_mo_48
L_mo_41:
s_andn2_b32 s51,0x7ff,s54
s_lshr_b32 s51,s51,5
s_andn2_b32 s56,31,s54
v_lshrrev_b32 v2,10,v20
v_add_u32 v3,16,v2
v_add_u32 v8,96468992,v20
v_cmp_eq_u32 vcc,s56,v2
s_nop 1
v_cndmask_b32 v2,v20,v8,vcc
v_cmp_eq_u32 vcc,s56,v3
s_nop 1
v_cndmask_b32 v3,v20,v8,vcc
s_waitcnt vmcnt(0)
s_lshl_b32 s59,s51,13
s_add_u32 s59,s59,10487552
s_cmp_lg_u32 s46,0
s_cbranch_scc1 L_fd_57
v_and_b32 v124,31,v1
v_lshlrev_b32 v124,2,v124
s_branch L_ff_58
L_fw_56:
s_sleep 2
L_ff_58:
buffer_load_dword v125,v124,s[8:11],s59 offen sc1
s_sub_u32 s49,s49,1
s_cbranch_scc1 L_abort
s_waitcnt vmcnt(0)
v_cmp_eq_u32 vcc,0,v125
s_cbranch_vccnz L_fw_56
L_fd_57:
s_barrier
s_or_b32 s72,s72,s52
buffer_store_dword v17,off,s[8:11],s72 sc1
s_lshl_b32 s66,s51,15
s_add_u32 s66,s66,2097152
s_add_u32 s67,s66,16384
s_add_u32 m0,s50,131072
s_nop 0
buffer_load_dwordx4 v2,s[8:11],s66 offen offset:0 sc1 lds
s_add_u32 m0,s50,135168
s_nop 0
buffer_load_dwordx4 v3,s[8:11],s67 offen offset:0 sc1 lds
s_add_u32 m0,s50,139008
s_nop 0
buffer_load_dwordx4 v2,s[8:11],s66 offen offset:256 sc1 lds
s_add_u32 m0,s50,143104
s_nop 0
buffer_load_dwordx4 v3,s[8:11],s67 offen offset:256 sc1 lds
s_add_u32 m0,s50,146944
s_nop 0
buffer_load_dwordx4 v2,s[8:11],s66 offen offset:512 sc1 lds
s_add_u32 m0,s50,151040
s_nop 0
buffer_load_dwordx4 v3,s[8:11],s67 offen offset:512 sc1 lds
s_waitcnt vmcnt(4)
s_barrier
ds_read_b128 v[104:107],v4 offset:0
ds_read_b128 v[108:111],v4 offset:4096
ds_read_b128 v[112:115],v5 offset:0
ds_read_b128 v[116:119],v5 offset:4096
s_add_u32 m0,s50,154880
s_nop 0
buffer_load_dwordx4 v2,s[8:11],s66 offen offset:768 sc1 lds
s_add_u32 m0,s50,158976
s_nop 0
buffer_load_dwordx4 v3,s[8:11],s67 offen offset:768 sc1 lds
s_waitcnt lgkmcnt(2)
v_mfma_f32_16x16x32_bf16 v[24:27],a[128:131],v[104:107],0
ds_read_b128 v[120:123],v6 offset:0
v_mfma_f32_16x16x32_bf16 v[40:43],v[104:107],v[128:131],0
s_lshl_b32 s58,s51,5
v_mfma_f32_16x16x32_bf16 v[28:31],a[128:131],v[108:111],0
ds_read_b128 v[124:127],v6 offset:4096
v_mfma_f32_16x16x32_bf16 v[44:47],v[108:111],v[128:131],0
s_add_u32 s58,s58,s47
v_mfma_f32_16x16x32_bf16 v[32:35],a[136:139],v[104:107],0
s_mul_i32 s58,s58,24576
v_mfma_f32_16x16x32_bf16 v[48:51],v[104:107],v[136:139],0
s_add_u32 s58,s58,201326592
v_mfma_f32_16x16x32_bf16 v[36:39],a[136:139],v[108:111],0
s_add_u32 s61,s58,s50
v_mfma_f32_16x16x32_bf16 v[52:55],v[108:111],v[136:139],0
s_add_u32 s62,s61,4096
s_waitcnt lgkmcnt(2)
v_mfma_f32_16x16x32_bf16 v[24:27],a[132:135],v[112:115],v[24:27]
ds_read_b128 v[104:107],v7 offset:0
v_mfma_f32_16x16x32_bf16 v[40:43],v[112:115],v[132:135],v[40:43]
s_add_u32 s63,s61,16384
v_mfma_f32_16x16x32_bf16 v[28:31],a[132:135],v[116:119],v[28:31]
ds_read_b128 v[108:111],v7 offset:4096
v_mfma_f32_16x16x32_bf16 v[44:47],v[116:119],v[132:135],v[44:47]
s_add_u32 s64,s61,20480
v_mfma_f32_16x16x32_bf16 v[32:35],a[140:143],v[112:115],v[32:35]
s_add_u32 s65,s61,s50
v_mfma_f32_16x16x32_bf16 v[48:51],v[112:115],v[140:143],v[48:51]
s_add_u32 s65,s65,8192
v_mfma_f32_16x16x32_bf16 v[36:39],a[140:143],v[116:119],v[36:39]
v_mfma_f32_16x16x32_bf16 v[52:55],v[116:119],v[140:143],v[52:55]
s_waitcnt vmcnt(4)
s_barrier
s_waitcnt lgkmcnt(2)
v_mfma_f32_16x16x32_bf16 v[24:27],a[144:147],v[120:123],v[24:27]
ds_read_b128 v[112:115],v4 offset:8192
v_mfma_f32_16x16x32_bf16 v[40:43],v[120:123],v[144:147],v[40:43]
v_mfma_f32_16x16x32_bf16 v[28:31],a[144:147],v[124:127],v[28:31]
ds_read_b128 v[116:119],v4 offset:12288
v_mfma_f32_16x16x32_bf16 v[44:47],v[124:127],v[144:147],v[44:47]
v_mfma_f32_16x16x32_bf16 v[32:35],a[152:155],v[120:123],v[32:35]
v_mfma_f32_16x16x32_bf16 v[48:51],v[120:123],v[152:155],v[48:51]
v_mfma_f32_16x16x32_bf16 v[36:39],a[152:155],v[124:127],v[36:39]
v_mfma_f32_16x16x32_bf16 v[52:55],v[124:127],v[152:155],v[52:55]
s_waitcnt lgkmcnt(2)
v_mfma_f32_16x16x32_bf16 v[24:27],a[148:151],v[104:107],v[24:27]
ds_read_b128 v[120:123],v5 offset:8192
v_mfma_f32_16x16x32_bf16 v[40:43],v[104:107],v[148:151],v[40:43]
v_mfma_f32_16x16x32_bf16 v[28:31],a[148:151],v[108:111],v[28:31]
ds_read_b128 v[124:127],v5 offset:12288
v_mfma_f32_16x16x32_bf16 v[44:47],v[108:111],v[148:151],v[44:47]
v_mfma_f32_16x16x32_bf16 v[32:35],a[156:159],v[104:107],v[32:35]
v_mfma_f32_16x16x32_bf16 v[48:51],v[104:107],v[156:159],v[48:51]
v_mfma_f32_16x16x32_bf16 v[36:39],a[156:159],v[108:111],v[36:39]
v_mfma_f32_16x16x32_bf16 v[52:55],v[108:111],v[156:159],v[52:55]
s_waitcnt lgkmcnt(2)
v_mfma_f32_16x16x32_bf16 v[24:27],a[160:163],v[112:115],v[24:27]
ds_read_b128 v[104:107],v6 offset:8192
v_mfma_f32_16x16x32_bf16 v[40:43],v[112:115],v[160:163],v[40:43]
v_mfma_f32_16x16x32_bf16 v[28:31],a[160:163],v[116:119],v[28:31]
ds_read_b128 v[108:111],v6 offset:12288
v_mfma_f32_16x16x32_bf16 v[44:47],v[116:119],v[160:163],v[44:47]
v_mfma_f32_16x16x32_bf16 v[32:35],a[168:171],v[112:115],v[32:35]
v_mfma_f32_16x16x32_bf16 v[48:51],v[112:115],v[168:171],v[48:51]
v_mfma_f32_16x16x32_bf16 v[36:39],a[168:171],v[116:119],v[36:39]
v_mfma_f32_16x16x32_bf16 v[52:55],v[116:119],v[168:171],v[52:55]
s_waitcnt lgkmcnt(2)
v_mfma_f32_16x16x32_bf16 v[24:27],a[164:167],v[120:123],v[24:27]
ds_read_b128 v[112:115],v7 offset:8192
v_mfma_f32_16x16x32_bf16 v[40:43],v[120:123],v[164:167],v[40:43]
v_mfma_f32_16x16x32_bf16 v[28:31],a[164:167],v[124:127],v[28:31]
ds_read_b128 v[116:119],v7 offset:12288
v_mfma_f32_16x16x32_bf16 v[44:47],v[124:127],v[164:167],v[44:47]
v_mfma_f32_16x16x32_bf16 v[32:35],a[172:175],v[120:123],v[32:35]
v_mfma_f32_16x16x32_bf16 v[48:51],v[120:123],v[172:175],v[48:51]
v_mfma_f32_16x16x32_bf16 v[36:39],a[172:175],v[124:127],v[36:39]
v_mfma_f32_16x16x32_bf16 v[52:55],v[124:127],v[172:175],v[52:55]
s_waitcnt vmcnt(2)
s_barrier
s_waitcnt lgkmcnt(2)
v_mfma_f32_16x16x32_bf16 v[24:27],a[176:179],v[104:107],v[24:27]
ds_read_b128 v[120:123],v4 offset:16384
v_mfma_f32_16x16x32_bf16 v[40:43],v[104:107],v[176:179],v[40:43]
v_mfma_f32_16x16x32_bf16 v[28:31],a[176:179],v[108:111],v[28:31]
ds_read_b128 v[124:127],v4 offset:20480
v_mfma_f32_16x16x32_bf16 v[44:47],v[108:111],v[176:179],v[44:47]
v_mfma_f32_16x16x32_bf16 v[32:35],a[184:187],v[104:107],v[32:35]
v_mfma_f32_16x16x32_bf16 v[48:51],v[104:107],v[184:187],v[48:51]
v_mfma_f32_16x16x32_bf16 v[36:39],a[184:187],v[108:111],v[36:39]
v_mfma_f32_16x16x32_bf16 v[52:55],v[108:111],v[184:187],v[52:55]
s_waitcnt lgkmcnt(2)
v_mfma_f32_16x16x32_bf16 v[24:27],a[180:183],v[112:115],v[24:27]
ds_read_b128 v[104:107],v5 offset:16384
v_mfma_f32_16x16x32_bf16 v[40:43],v[112:115],v[180:183],v[40:43]
v_mfma_f32_16x16x32_bf16 v[28:31],a[180:183],v[116:119],v[28:31]
ds_read_b128 v[108:111],v5 offset:20480
v_mfma_f32_16x16x32_bf16 v[44:47],v[116:119],v[180:183],v[44:47]
v_mfma_f32_16x16x32_bf16 v[32:35],a[188:191],v[112:115],v[32:35]
v_mfma_f32_16x16x32_bf16 v[48:51],v[112:115],v[188:191],v[48:51]
v_mfma_f32_16x16x32_bf16 v[36:39],a[188:191],v[116:119],v[36:39]
v_mfma_f32_16x16x32_bf16 v[52:55],v[116:119],v[188:191],v[52:55]
s_waitcnt lgkmcnt(2)
v_mfma_f32_16x16x32_bf16 v[24:27],a[192:195],v[120:123],v[24:27]
ds_read_b128 v[112:115],v6 offset:16384
v_mfma_f32_16x16x32_bf16 v[40:43],v[120:123],v[192:195],v[40:43]
v_mfma_f32_16x16x32_bf16 v[28:31],a[192:195],v[124:127],v[28:31]
ds_read_b128 v[116:119],v6 offset:20480
v_mfma_f32_16x16x32_bf16 v[44:47],v[124:127],v[192:195],v[44:47]
v_mfma_f32_16x16x32_bf16 v[32:35],a[200:203],v[120:123],v[32:35]
v_mfma_f32_16x16x32_bf16 v[48:51],v[120:123],v[200:203],v[48:51]
v_mfma_f32_16x16x32_bf16 v[36:39],a[200:203],v[124:127],v[36:39]
v_mfma_f32_16x16x32_bf16 v[52:55],v[124:127],v[200:203],v[52:55]
s_waitcnt lgkmcnt(2)
v_mfma_f32_16x16x32_bf16 v[24:27],a[196:199],v[104:107],v[24:27]
ds_read_b128 v[120:123],v7 offset:16384
v_mfma_f32_16x16x32_bf16 v[40:43],v[104:107],v[196:199],v[40:43]
v_mfma_f32_16x16x32_bf16 v[28:31],a[196:199],v[108:111],v[28:31]
ds_read_b128 v[124:127],v7 offset:20480
v_mfma_f32_16x16x32_bf16 v[44:47],v[108:111],v[196:199],v[44:47]
v_mfma_f32_16x16x32_bf16 v[32:35],a[204:207],v[104:107],v[32:35]
v_mfma_f32_16x16x32_bf16 v[48:51],v[104:107],v[204:207],v[48:51]
v_mfma_f32_16x16x32_bf16 v[36:39],a[204:207],v[108:111],v[36:39]
v_mfma_f32_16x16x32_bf16 v[52:55],v[108:111],v[204:207],v[52:55]
s_waitcnt vmcnt(0)
s_barrier
s_waitcnt lgkmcnt(2)
v_mfma_f32_16x16x32_bf16 v[24:27],a[208:211],v[112:115],v[24:27]
ds_read_b128 v[104:107],v4 offset:24576
v_mfma_f32_16x16x32_bf16 v[40:43],v[112:115],v[208:211],v[40:43]
v_mfma_f32_16x16x32_bf16 v[28:31],a[208:211],v[116:119],v[28:31]
ds_read_b128 v[108:111],v4 offset:28672
v_mfma_f32_16x16x32_bf16 v[44:47],v[116:119],v[208:211],v[44:47]
v_mfma_f32_16x16x32_bf16 v[32:35],a[216:219],v[112:115],v[32:35]
v_mfma_f32_16x16x32_bf16 v[48:51],v[112:115],v[216:219],v[48:51]
v_mfma_f32_16x16x32_bf16 v[36:39],a[216:219],v[116:119],v[36:39]
v_mfma_f32_16x16x32_bf16 v[52:55],v[116:119],v[216:219],v[52:55]
s_waitcnt lgkmcnt(2)
v_mfma_f32_16x16x32_bf16 v[24:27],a[212:215],v[120:123],v[24:27]
ds_read_b128 v[112:115],v5 offset:24576
v_mfma_f32_16x16x32_bf16 v[40:43],v[120:123],v[212:215],v[40:43]
v_mfma_f32_16x16x32_bf16 v[28:31],a[212:215],v[124:127],v[28:31]
ds_read_b128 v[116:119],v5 offset:28672
v_mfma_f32_16x16x32_bf16 v[44:47],v[124:127],v[212:215],v[44:47]
v_mfma_f32_16x16x32_bf16 v[32:35],a[220:223],v[120:123],v[32:35]
v_mfma_f32_16x16x32_bf16 v[48:51],v[120:123],v[220:223],v[48:51]
v_mfma_f32_16x16x32_bf16 v[36:39],a[220:223],v[124:127],v[36:39]
v_mfma_f32_16x16x32_bf16 v[52:55],v[124:127],v[220:223],v[52:55]
s_waitcnt lgkmcnt(2)
v_mfma_f32_16x16x32_bf16 v[24:27],a[224:227],v[104:107],v[24:27]
ds_read_b128 v[120:123],v6 offset:24576
v_mfma_f32_16x16x32_bf16 v[40:43],v[104:107],v[224:227],v[40:43]
v_mfma_f32_16x16x32_bf16 v[28:31],a[224:227],v[108:111],v[28:31]
ds_read_b128 v[124:127],v6 offset:28672
v_mfma_f32_16x16x32_bf16 v[44:47],v[108:111],v[224:227],v[44:47]
v_mfma_f32_16x16x32_bf16 v[32:35],a[232:235],v[104:107],v[32:35]
v_mfma_f32_16x16x32_bf16 v[48:51],v[104:107],v[232:235],v[48:51]
v_mfma_f32_16x16x32_bf16 v[36:39],a[232:235],v[108:111],v[36:39]
v_mfma_f32_16x16x32_bf16 v[52:55],v[108:111],v[232:235],v[52:55]
s_waitcnt lgkmcnt(2)
v_mfma_f32_16x16x32_bf16 v[24:27],a[228:231],v[112:115],v[24:27]
ds_read_b128 v[104:107],v7 offset:24576
v_mfma_f32_16x16x32_bf16 v[40:43],v[112:115],v[228:231],v[40:43]
v_mfma_f32_16x16x32_bf16 v[28:31],a[228:231],v[116:119],v[28:31]
ds_read_b128 v[108:111],v7 offset:28672
v_mfma_f32_16x16x32_bf16 v[44:47],v[116:119],v[228:231],v[44:47]
v_mfma_f32_16x16x32_bf16 v[32:35],a[236:239],v[112:115],v[32:35]
v_mfma_f32_16x16x32_bf16 v[48:51],v[112:115],v[236:239],v[48:51]
v_mfma_f32_16x16x32_bf16 v[36:39],a[236:239],v[116:119],v[36:39]
v_mfma_f32_16x16x32_bf16 v[52:55],v[116:119],v[236:239],v[52:55]
s_waitcnt lgkmcnt(2)
v_mfma_f32_16x16x32_bf16 v[24:27],a[240:243],v[120:123],v[24:27]
ds_read_b128 v[112:115],v4 offset:0
v_mfma_f32_16x16x32_bf16 v[40:43],v[120:123],v[240:243],v[40:43]
v_mfma_f32_16x16x32_bf16 v[28:31],a[240:243],v[124:127],v[28:31]
ds_read_b128 v[116:119],v4 offset:4096
v_mfma_f32_16x16x32_bf16 v[44:47],v[124:127],v[240:243],v[44:47]
v_mfma_f32_16x16x32_bf16 v[32:35],a[248:251],v[120:123],v[32:35]
v_mfma_f32_16x16x32_bf16 v[48:51],v[120:123],v[248:251],v[48:51]
v_mfma_f32_16x16x32_bf16 v[36:39],a[248:251],v[124:127],v[36:39]
v_mfma_f32_16x16x32_bf16 v[52:55],v[124:127],v[248:251],v[52:55]
s_waitcnt lgkmcnt(2)
v_mfma_f32_16x16x32_bf16 v[24:27],a[244:247],v[104:107],v[24:27]
ds_read_b128 v[120:123],v5 offset:0
v_mfma_f32_16x16x32_bf16 v[40:43],v[104:107],v[244:247],v[40:43]
v_mfma_f32_16x16x32_bf16 v[28:31],a[244:247],v[108:111],v[28:31]
ds_read_b128 v[124:127],v5 offset:4096
v_mfma_f32_16x16x32_bf16 v[44:47],v[108:111],v[244:247],v[44:47]
v_mfma_f32_16x16x32_bf16 v[32:35],a[252:255],v[104:107],v[32:35]
v_mfma_f32_16x16x32_bf16 v[48:51],v[104:107],v[252:255],v[48:51]
v_mfma_f32_16x16x32_bf16 v[36:39],a[252:255],v[108:111],v[36:39]
v_mfma_f32_16x16x32_bf16 v[52:55],v[108:111],v[252:255],v[52:55]
s_waitcnt lgkmcnt(2)
v_mfma_f32_16x16x32_bf16 v[88:91],a[0:3],v[112:115],0
ds_read_b128 v[104:107],v6 offset:0
v_mfma_f32_16x16x32_bf16 v[92:95],a[0:3],v[116:119],0
v_mfma_f32_16x16x32_bf16 v[96:99],a[8:11],v[112:115],0
ds_read_b128 v[108:111],v6 offset:4096
v_cvt_pk_bf16_f32 v56,v24,v32
v_cvt_pk_bf16_f32 v57,v25,v33
v_mfma_f32_16x16x32_bf16 v[100:103],a[8:11],v[116:119],0
v_cvt_pk_bf16_f32 v58,v26,v34
v_cvt_pk_bf16_f32 v59,v27,v35
s_waitcnt lgkmcnt(2)
v_mfma_f32_16x16x32_bf16 v[88:91],a[4:7],v[120:123],v[88:91]
ds_read_b128 v[112:115],v7 offset:0
v_mfma_f32_16x16x32_bf16 v[92:95],a[4:7],v[124:127],v[92:95]
buffer_store_dwordx4 v[56:59],v0,s[8:11],s61 offen sc1
v_cvt_pk_bf16_f32 v60,v28,v36
v_cvt_pk_bf16_f32 v61,v29,v37
v_mfma_f32_16x16x32_bf16 v[96:99],a[12:15],v[120:123],v[96:99]
ds_read_b128 v[116:119],v7 offset:4096
v_cvt_pk_bf16_f32 v62,v30,v38
v_cvt_pk_bf16_f32 v63,v31,v39
v_mfma_f32_16x16x32_bf16 v[100:103],a[12:15],v[124:127],v[100:103]
buffer_store_dwordx4 v[60:63],v0,s[8:11],s62 offen sc1
v_cvt_pk_bf16_f32 v64,v40,v41
v_cvt_pk_bf16_f32 v65,v42,v43
s_waitcnt lgkmcnt(2)
v_mfma_f32_16x16x32_bf16 v[88:91],a[16:19],v[104:107],v[88:91]
ds_read_b128 v[120:123],v4 offset:8192
v_cvt_pk_bf16_f32 v66,v44,v45
v_cvt_pk_bf16_f32 v67,v46,v47
v_mfma_f32_16x16x32_bf16 v[92:95],a[16:19],v[108:111],v[92:95]
buffer_store_dwordx4 v[64:67],v0,s[8:11],s65 offen offset:0 sc1
v_cvt_pk_bf16_f32 v68,v48,v49
v_cvt_pk_bf16_f32 v69,v50,v51
v_mfma_f32_16x16x32_bf16 v[96:99],a[24:27],v[104:107],v[96:99]
ds_read_b128 v[124:127],v4 offset:12288
v_cvt_pk_bf16_f32 v70,v52,v53
v_cvt_pk_bf16_f32 v71,v54,v55
v_mfma_f32_16x16x32_bf16 v[100:103],a[24:27],v[108:111],v[100:103]
buffer_store_dwordx4 v[68:71],v0,s[8:11],s65 offen offset:1024 sc1
s_waitcnt lgkmcnt(2)
v_mfma_f32_16x16x32_bf16 v[88:91],a[20:23],v[112:115],v[88:91]
ds_read_b128 v[104:107],v5 offset:8192
v_mfma_f32_16x16x32_bf16 v[92:95],a[20:23],v[116:119],v[92:95]
v_mfma_f32_16x16x32_bf16 v[96:99],a[28:31],v[112:115],v[96:99]
ds_read_b128 v[108:111],v5 offset:12288
v_mfma_f32_16x16x32_bf16 v[100:103],a[28:31],v[116:119],v[100:103]
s_waitcnt lgkmcnt(2)
v_mfma_f32_16x16x32_bf16 v[88:91],a[32:35],v[120:123],v[88:91]
ds_read_b128 v[112:115],v6 offset:8192
v_mfma_f32_16x16x32_bf16 v[92:95],a[32:35],v[124:127],v[92:95]
v_mfma_f32_16x16x32_bf16 v[96:99],a[40:43],v[120:123],v[96:99]
ds_read_b128 v[116:119],v6 offset:12288
v_mfma_f32_16x16x32_bf16 v[100:103],a[40:43],v[124:127],v[100:103]
s_waitcnt lgkmcnt(2)
v_mfma_f32_16x16x32_bf16 v[88:91],a[36:39],v[104:107],v[88:91]
ds_read_b128 v[120:123],v7 offset:8192
v_mfma_f32_16x16x32_bf16 v[92:95],a[36:39],v[108:111],v[92:95]
v_mfma_f32_16x16x32_bf16 v[96:99],a[44:47],v[104:107],v[96:99]
ds_read_b128 v[124:127],v7 offset:12288
v_mfma_f32_16x16x32_bf16 v[100:103],a[44:47],v[108:111],v[100:103]
s_waitcnt lgkmcnt(2)
v_mfma_f32_16x16x32_bf16 v[88:91],a[48:51],v[112:115],v[88:91]
ds_read_b128 v[104:107],v4 offset:16384
v_mfma_f32_16x16x32_bf16 v[92:95],a[48:51],v[116:119],v[92:95]
v_mfma_f32_16x16x32_bf16 v[96:99],a[56:59],v[112:115],v[96:99]
ds_read_b128 v[108:111],v4 offset:20480
v_mfma_f32_16x16x32_bf16 v[100:103],a[56:59],v[116:119],v[100:103]
s_waitcnt lgkmcnt(2)
v_mfma_f32_16x16x32_bf16 v[88:91],a[52:55],v[120:123],v[88:91]
ds_read_b128 v[112:115],v5 offset:16384
v_mfma_f32_16x16x32_bf16 v[92:95],a[52:55],v[124:127],v[92:95]
v_mfma_f32_16x16x32_bf16 v[96:99],a[60:63],v[120:123],v[96:99]
ds_read_b128 v[116:119],v5 offset:20480
v_mfma_f32_16x16x32_bf16 v[100:103],a[60:63],v[124:127],v[100:103]
s_waitcnt lgkmcnt(2)
v_mfma_f32_16x16x32_bf16 v[88:91],a[64:67],v[104:107],v[88:91]
ds_read_b128 v[120:123],v6 offset:16384
v_mfma_f32_16x16x32_bf16 v[92:95],a[64:67],v[108:111],v[92:95]
v_mfma_f32_16x16x32_bf16 v[96:99],a[72:75],v[104:107],v[96:99]
ds_read_b128 v[124:127],v6 offset:20480
v_mfma_f32_16x16x32_bf16 v[100:103],a[72:75],v[108:111],v[100:103]
s_waitcnt lgkmcnt(2)
v_mfma_f32_16x16x32_bf16 v[88:91],a[68:71],v[112:115],v[88:91]
ds_read_b128 v[104:107],v7 offset:16384
v_mfma_f32_16x16x32_bf16 v[92:95],a[68:71],v[116:119],v[92:95]
v_mfma_f32_16x16x32_bf16 v[96:99],a[76:79],v[112:115],v[96:99]
ds_read_b128 v[108:111],v7 offset:20480
v_mfma_f32_16x16x32_bf16 v[100:103],a[76:79],v[116:119],v[100:103]
s_waitcnt lgkmcnt(2)
v_mfma_f32_16x16x32_bf16 v[88:91],a[80:83],v[120:123],v[88:91]
ds_read_b128 v[112:115],v4 offset:24576
v_mfma_f32_16x16x32_bf16 v[92:95],a[80:83],v[124:127],v[92:95]
v_mfma_f32_16x16x32_bf16 v[96:99],a[88:91],v[120:123],v[96:99]
ds_read_b128 v[116:119],v4 offset:28672
v_mfma_f32_16x16x32_bf16 v[100:103],a[88:91],v[124:127],v[100:103]
s_waitcnt lgkmcnt(2)
v_mfma_f32_16x16x32_bf16 v[88:91],a[84:87],v[104:107],v[88:91]
ds_read_b128 v[120:123],v5 offset:24576
v_mfma_f32_16x16x32_bf16 v[92:95],a[84:87],v[108:111],v[92:95]
v_mfma_f32_16x16x32_bf16 v[96:99],a[92:95],v[104:107],v[96:99]
ds_read_b128 v[124:127],v5 offset:28672
v_mfma_f32_16x16x32_bf16 v[100:103],a[92:95],v[108:111],v[100:103]
s_waitcnt lgkmcnt(2)
v_mfma_f32_16x16x32_bf16 v[88:91],a[96:99],v[112:115],v[88:91]
ds_read_b128 v[104:107],v6 offset:24576
v_mfma_f32_16x16x32_bf16 v[92:95],a[96:99],v[116:119],v[92:95]
v_mfma_f32_16x16x32_bf16 v[96:99],a[104:107],v[112:115],v[96:99]
ds_read_b128 v[108:111],v6 offset:28672
v_mfma_f32_16x16x32_bf16 v[100:103],a[104:107],v[116:119],v[100:103]
s_waitcnt lgkmcnt(2)
v_mfma_f32_16x16x32_bf16 v[88:91],a[100:103],v[120:123],v[88:91]
ds_read_b128 v[112:115],v7 offset:24576
v_mfma_f32_16x16x32_bf16 v[92:95],a[100:103],v[124:127],v[92:95]
v_mfma_f32_16x16x32_bf16 v[96:99],a[108:111],v[120:123],v[96:99]
ds_read_b128 v[116:119],v7 offset:28672
v_mfma_f32_16x16x32_bf16 v[100:103],a[108:111],v[124:127],v[100:103]
s_waitcnt lgkmcnt(2)
v_mfma_f32_16x16x32_bf16 v[88:91],a[112:115],v[104:107],v[88:91]
v_mfma_f32_16x16x32_bf16 v[92:95],a[112:115],v[108:111],v[92:95]
v_mfma_f32_16x16x32_bf16 v[96:99],a[120:123],v[104:107],v[96:99]
v_mfma_f32_16x16x32_bf16 v[100:103],a[120:123],v[108:111],v[100:103]
s_waitcnt lgkmcnt(0)
v_mfma_f32_16x16x32_bf16 v[88:91],a[116:119],v[112:115],v[88:91]
v_mfma_f32_16x16x32_bf16 v[92:95],a[116:119],v[116:119],v[92:95]
v_mfma_f32_16x16x32_bf16 v[96:99],a[124:127],v[112:115],v[96:99]
v_mfma_f32_16x16x32_bf16 v[100:103],a[124:127],v[116:119],v[100:103]
s_nop 3
v_cvt_pk_bf16_f32 v104,v88,v96
v_cvt_pk_bf16_f32 v105,v89,v97
v_cvt_pk_bf16_f32 v106,v90,v98
v_cvt_pk_bf16_f32 v107,v91,v99
v_cvt_pk_bf16_f32 v108,v92,v100
v_cvt_pk_bf16_f32 v109,v93,v101
v_cvt_pk_bf16_f32 v110,v94,v102
v_cvt_pk_bf16_f32 v111,v95,v103
buffer_store_dwordx4 v[104:107],v0,s[8:11],s63 offen sc1
buffer_store_dwordx4 v[108:111],v0,s[8:11],s64 offen sc1
s_waitcnt vmcnt(6)
s_barrier
s_add_u32 m0,s50,131072
s_nop 0
buffer_load_dwordx4 v20,s[8:11],s70 offen offset:0 sc1 lds
s_add_u32 m0,s50,135168
s_nop 0
buffer_load_dwordx4 v20,s[8:11],s71 offen offset:0 sc1 lds
s_add_u32 m0,s50,139008
s_nop 0
buffer_load_dwordx4 v20,s[8:11],s70 offen offset:256 sc1 lds
s_add_u32 m0,s50,143104
s_nop 0
buffer_load_dwordx4 v20,s[8:11],s71 offen offset:256 sc1 lds
s_add_u32 m0,s50,146944
s_nop 0
buffer_load_dwordx4 v20,s[8:11],s70 offen offset:512 sc1 lds
s_add_u32 m0,s50,151040
s_nop 0
buffer_load_dwordx4 v20,s[8:11],s71 offen offset:512 sc1 lds
s_lshl_b32 s59,s51,13
s_lshl2_add_u32 s59,s47,s59
s_add_u32 s59,s59,10487680
s_waitcnt vmcnt(0)
s_barrier
s_or_b32 s59,s59,s52
buffer_store_dword v17,off,s[8:11],s59 sc1
s_mov_b32 s72,0x80000000
s_mov_b32 s86,0
s_mov_b32 s19,1
s_mov_b32 s18,0
s_cmp_lt_u32 s31,64
s_cbranch_scc1 L_mo_35
L_mo_48:
s_mov_b32 s51,64
s_cmp_eq_u32 s47,31
s_cbranch_scc1 L_mf_59
v_and_b32 v9,15,v1
v_lshrrev_b32 v10,4,v1
v_and_b32 v124,1,v1
v_lshlrev_b32 v124,4,v124
v_mov_b32 v125,0xffff
v_lshlrev_b32 v125,v124,v125
v_lshrrev_b32 v124,2,v9
v_cmp_eq_u32 vcc,0,v124
s_nop 1
v_cndmask_b32 v12,0,v125,vcc
v_cmp_eq_u32 vcc,1,v124
s_nop 1
v_cndmask_b32 v13,0,v125,vcc
v_and_b32 v124,2,v1
v_cmp_eq_u32 vcc,0,v124
v_mov_b32 v14,0xeeee
v_mov_b32 v124,0x4444
v_cndmask_b32 v14,v14,v124,vcc
v_lshlrev_b32 v11,14,v10
v_lshl_add_u32 v11,v9,4,v11
s_lshl_b32 s65,s51,15
s_add_u32 s65,s65,92274688
s_lshl_b32 s62,s47,10
s_add_u32 s62,s62,s65
s_lshl_b32 s63,s47,16
s_lshl_b32 s60,s46,8
s_add_u32 s63,s63,s60
s_mov_b32 s4,s38
s_mov_b32 s5,s39
s_mov_b32 s6,1835008
s_mov_b32 s7,0x20000
buffer_load_dwordx4 v[24:27],v11,s[4:7],s63 offen offset:0
buffer_load_dwordx4 v[28:31],v11,s[4:7],s63 offen offset:1024
buffer_load_dwordx4 v[32:35],v11,s[4:7],s63 offen offset:2048
buffer_load_dwordx4 v[36:39],v11,s[4:7],s63 offen offset:3072
s_add_u32 s63,s63,4096
buffer_load_dwordx4 v[40:43],v11,s[4:7],s63 offen offset:0
buffer_load_dwordx4 v[44:47],v11,s[4:7],s63 offen offset:1024
buffer_load_dwordx4 v[48:51],v11,s[4:7],s63 offen offset:2048
buffer_load_dwordx4 v[52:55],v11,s[4:7],s63 offen offset:3072
s_add_u32 s63,s63,4096
buffer_load_dwordx4 v[56:59],v11,s[4:7],s63 offen offset:0
buffer_load_dwordx4 v[60:63],v11,s[4:7],s63 offen offset:1024
buffer_load_dwordx4 v[64:67],v11,s[4:7],s63 offen offset:2048
buffer_load_dwordx4 v[68:71],v11,s[4:7],s63 offen offset:3072
s_add_u32 s63,s63,4096
buffer_load_dwordx4 v[72:75],v11,s[4:7],s63 offen offset:0
buffer_load_dwordx4 v[76:79],v11,s[4:7],s63 offen offset:1024
buffer_load_dwordx4 v[80:83],v11,s[4:7],s63 offen offset:2048
buffer_load_dwordx4 v[84:87],v11,s[4:7],s63 offen offset:3072
buffer_load_dword v15,v0,s[8:11],s62 offen
ds_read_b128 a[0:3],v18 offset:0
ds_read_b128 a[4:7],v18 offset:1024
ds_read_b128 a[8:11],v18 offset:2048
ds_read_b128 a[12:15],v18 offset:3072
ds_read_b128 a[16:19],v18 offset:4096
ds_read_b128 a[20:23],v18 offset:5120
ds_read_b128 a[24:27],v18 offset:6144
ds_read_b128 a[28:31],v18 offset:7168
ds_read_b128 a[32:35],v18 offset:8192
ds_read_b128 a[36:39],v18 offset:9216
ds_read_b128 a[40:43],v18 offset:10240
ds_read_b128 a[44:47],v18 offset:11264
ds_read_b128 a[48:51],v18 offset:12288
ds_read_b128 a[52:55],v18 offset:13312
ds_read_b128 a[56:59],v18 offset:14336
ds_read_b128 a[60:63],v18 offset:15360
ds_read_b128 a[64:67],v18 offset:16384
ds_read_b128 a[68:71],v18 offset:17408
ds_read_b128 a[72:75],v18 offset:18432
ds_read_b128 a[76:79],v18 offset:19456
ds_read_b128 a[80:83],v18 offset:20480
ds_read_b128 a[84:87],v18 offset:21504
ds_read_b128 a[88:91],v18 offset:22528
ds_read_b128 a[92:95],v18 offset:23552
ds_read_b128 a[96:99],v18 offset:24576
ds_read_b128 a[100:103],v18 offset:25600
ds_read_b128 a[104:107],v18 offset:26624
ds_read_b128 a[108:111],v18 offset:27648
ds_read_b128 a[112:115],v18 offset:28672
ds_read_b128 a[116:119],v18 offset:29696
ds_read_b128 a[120:123],v18 offset:30720
ds_read_b128 a[124:127],v18 offset:31744
s_add_u32 s59,s62,32768
buffer_load_dword v15,v0,s[8:11],s59 offen
s_add_u32 s59,s62,65536
buffer_load_dword v15,v0,s[8:11],s59 offen
s_add_u32 s59,s62,98304
buffer_load_dword v15,v0,s[8:11],s59 offen
s_add_u32 s59,s62,131072
buffer_load_dword v15,v0,s[8:11],s59 offen
s_add_u32 s59,s62,163840
buffer_load_dword v15,v0,s[8:11],s59 offen
L_mf_60:
s_lshl_b32 s59,s51,13
s_lshl_b32 s61,s46,7
s_add_u32 s59,s59,s61
s_add_u32 s59,s59,10486272
L_ww_65:
s_sleep 1
buffer_load_dword v2,off,s[8:11],s59 sc1
s_sub_u32 s49,s49,1
s_cbranch_scc1 L_abort
s_waitcnt vmcnt(0)
v_readfirstlane_b32 s55,v2
s_cmp_eq_u32 s55,0
s_cbranch_scc1 L_ww_65
L_wwd_66:
s_cmp_eq_u32 s55,1
s_cbranch_scc1 L_mf_61
s_barrier
s_andn2_b32 s64,0x7ff,s55
s_lshl_b32 s56,s64,10
s_add_u32 s58,s56,6291456
buffer_load_dwordx4 v[88:91],v0,s[8:11],s58 offen sc1
s_lshl_b32 s57,s46,11
s_add_u32 s57,s57,139264
v_add_u32 v8,s57,v0
v_and_b32 v2,1,v10
v_lshrrev_b32 v3,1,v10
v_lshlrev_b32 v2,7,v2
v_lshl_add_u32 v2,v3,10,v2
s_lshl_b32 s59,s46,8
s_add_u32 s59,s57,s59
v_add_u32 v2,s59,v2
s_mov_b32 s60,0x01000100
s_mov_b32 s61,0x03020302
s_waitcnt vmcnt(0)
v_lshlrev_b32 v96,16,v88
v_and_b32 v97,0xffff0000,v88
v_lshlrev_b32 v98,16,v89
v_and_b32 v99,0xffff0000,v89
v_lshlrev_b32 v100,16,v90
v_and_b32 v101,0xffff0000,v90
v_lshlrev_b32 v102,16,v91
v_and_b32 v103,0xffff0000,v91
v_readfirstlane_b32 s78,v96
s_nop 1
v_pk_add_f32 v[108:109],v[96:97],s[78:79] op_sel_hi:[1,0] neg_lo:[0,1] neg_hi:[0,1]
v_pk_add_f32 v[110:111],v[98:99],s[78:79] op_sel_hi:[1,0] neg_lo:[0,1] neg_hi:[0,1]
v_pk_add_f32 v[112:113],v[100:101],s[78:79] op_sel_hi:[1,0] neg_lo:[0,1] neg_hi:[0,1]
v_pk_add_f32 v[114:115],v[102:103],s[78:79] op_sel_hi:[1,0] neg_lo:[0,1] neg_hi:[0,1]
v_pk_add_f32 v[116:117],v[108:109],v[110:111]
v_pk_mul_f32 v[118:119],v[108:109],v[108:109]
v_pk_add_f32 v[120:121],v[112:113],v[114:115]
v_pk_fma_f32 v[118:119],v[110:111],v[110:111],v[118:119]
v_pk_add_f32 v[116:117],v[116:117],v[120:121]
v_pk_fma_f32 v[118:119],v[112:113],v[112:113],v[118:119]
v_add_f32 v116,v116,v117
v_pk_fma_f32 v[118:119],v[114:115],v[114:115],v[118:119]
v_add_f32 v118,v118,v119
s_nop 1
v_permlane32_swap_b32 v116,v118
v_add_f32 v116,v116,v118
s_nop 1
v_add_f32_dpp v116,v116,v116 row_ror:8 row_mask:0xf bank_mask:0xf
s_nop 1
v_add_f32_dpp v116,v116,v116 row_ror:4 row_mask:0xf bank_mask:0xf
s_nop 1
v_add_f32_dpp v116,v116,v116 row_ror:2 row_mask:0xf bank_mask:0xf
s_nop 1
v_add_f32_dpp v116,v116,v116 row_ror:1 row_mask:0xf bank_mask:0xf
v_mov_b32 v118,v116
s_nop 1
v_permlane16_swap_b32 v116,v118
v_add_f32 v116,v116,v118
v_mul_f32 v116,0x3b000000,v116
v_mov_b32 v118,v116
s_nop 1
v_permlane32_swap_b32 v116,v118
v_fma_f32 v118,-v116,v116,v118
v_add_f32 v116,s78,v116
v_max_f32 v118,0,v118
v_cvt_pk_bf16_f32 v118,v116,v118
v_lshlrev_b32 v116,16,v118
v_and_b32 v118,0xffff0000,v118
v_add_f32 v118,0x3727c5ac,v118
v_cvt_pk_bf16_f32 v118,v118,v118
v_and_b32 v118,0xffff0000,v118
v_sqrt_f32 v118,v118
v_pk_add_f32 v[108:109],v[96:97],v[116:117] op_sel_hi:[1,0] neg_lo:[0,1] neg_hi:[0,1]
v_pk_add_f32 v[110:111],v[98:99],v[116:117] op_sel_hi:[1,0] neg_lo:[0,1] neg_hi:[0,1]
v_pk_add_f32 v[112:113],v[100:101],v[116:117] op_sel_hi:[1,0] neg_lo:[0,1] neg_hi:[0,1]
v_pk_add_f32 v[114:115],v[102:103],v[116:117] op_sel_hi:[1,0] neg_lo:[0,1] neg_hi:[0,1]
v_cvt_pk_bf16_f32 v118,v118,v118
v_and_b32 v118,0xffff0000,v118
v_rcp_f32 v118,v118
v_cvt_pk_bf16_f32 v104,v108,v109
v_cvt_pk_bf16_f32 v105,v110,v111
v_cvt_pk_bf16_f32 v106,v112,v113
v_cvt_pk_bf16_f32 v107,v114,v115
v_lshlrev_b32 v108,16,v104
v_and_b32 v109,0xffff0000,v104
v_lshlrev_b32 v110,16,v105
v_and_b32 v111,0xffff0000,v105
v_lshlrev_b32 v112,16,v106
v_and_b32 v113,0xffff0000,v106
v_lshlrev_b32 v114,16,v107
v_and_b32 v115,0xffff0000,v107
v_pk_mul_f32 v[108:109],v[108:109],v[118:119] op_sel_hi:[1,0]
v_pk_mul_f32 v[110:111],v[110:111],v[118:119] op_sel_hi:[1,0]
v_pk_mul_f32 v[112:113],v[112:113],v[118:119] op_sel_hi:[1,0]
v_pk_mul_f32 v[114:115],v[114:115],v[118:119] op_sel_hi:[1,0]
v_cvt_pk_bf16_f32 v104,v108,v109
v_cvt_pk_bf16_f32 v105,v110,v111
v_cvt_pk_bf16_f32 v106,v112,v113
v_cvt_pk_bf16_f32 v107,v114,v115
v_perm_b32 v88,v104,v104,s60
v_perm_b32 v89,v105,v105,s60
v_perm_b32 v90,v106,v106,s60
v_perm_b32 v91,v107,v107,s60
ds_write_b128 v8,v[88:91]
v_perm_b32 v92,v104,v104,s61
v_perm_b32 v93,v105,v105,s61
v_perm_b32 v94,v106,v106,s61
v_perm_b32 v95,v107,v107,s61
ds_write_b128 v8,v[92:95] offset:1024
s_mov_b32 s58,s57
ds_read_b128 v[128:131],v2 offset:0
ds_read_b128 v[144:147],v2 offset:64
ds_read_b128 v[132:135],v2 offset:16
ds_read_b128 v[148:151],v2 offset:80
ds_read_b128 v[136:139],v2 offset:32
ds_read_b128 v[152:155],v2 offset:96
ds_read_b128 v[140:143],v2 offset:48
ds_read_b128 v[156:159],v2 offset:112
v_mov_b64 v[116:117],0
v_mov_b64 v[118:119],0
s_waitcnt lgkmcnt(6)
v_and_b32 v120,v12,v128
v_and_b32 v121,v13,v128
v_and_b32 v122,v12,v144
v_and_b32 v123,v13,v144
v_and_b32 v124,v12,v129
v_and_b32 v125,v13,v129
v_smfmac_f32_16x16x64_bf16 v[116:119],v[120:123],a[0:7],v14
v_and_b32 v126,v12,v145
v_and_b32 v127,v13,v145
v_and_b32 v120,v12,v130
v_and_b32 v121,v13,v130
v_smfmac_f32_16x16x64_bf16 v[116:119],v[124:127],a[8:15],v14
v_and_b32 v122,v12,v146
v_and_b32 v123,v13,v146
v_and_b32 v124,v12,v131
v_and_b32 v125,v13,v131
v_smfmac_f32_16x16x64_bf16 v[116:119],v[120:123],a[16:23],v14
v_and_b32 v126,v12,v147
v_and_b32 v127,v13,v147
s_waitcnt lgkmcnt(4)
v_and_b32 v120,v12,v132
v_and_b32 v121,v13,v132
v_smfmac_f32_16x16x64_bf16 v[116:119],v[124:127],a[24:31],v14
v_and_b32 v122,v12,v148
v_and_b32 v123,v13,v148
v_and_b32 v124,v12,v133
v_and_b32 v125,v13,v133
v_smfmac_f32_16x16x64_bf16 v[116:119],v[120:123],a[32:39],v14
v_and_b32 v126,v12,v149
v_and_b32 v127,v13,v149
v_and_b32 v120,v12,v134
v_and_b32 v121,v13,v134
v_smfmac_f32_16x16x64_bf16 v[116:119],v[124:127],a[40:47],v14
v_and_b32 v122,v12,v150
v_and_b32 v123,v13,v150
v_and_b32 v124,v12,v135
v_and_b32 v125,v13,v135
v_smfmac_f32_16x16x64_bf16 v[116:119],v[120:123],a[48:55],v14
v_and_b32 v126,v12,v151
v_and_b32 v127,v13,v151
s_waitcnt lgkmcnt(2)
v_and_b32 v120,v12,v136
v_and_b32 v121,v13,v136
v_smfmac_f32_16x16x64_bf16 v[116:119],v[124:127],a[56:63],v14
v_and_b32 v122,v12,v152
v_and_b32 v123,v13,v152
v_and_b32 v124,v12,v137
v_and_b32 v125,v13,v137
v_smfmac_f32_16x16x64_bf16 v[116:119],v[120:123],a[64:71],v14
v_and_b32 v126,v12,v153
v_and_b32 v127,v13,v153
v_and_b32 v120,v12,v138
v_and_b32 v121,v13,v138
v_smfmac_f32_16x16x64_bf16 v[116:119],v[124:127],a[72:79],v14
v_and_b32 v122,v12,v154
v_and_b32 v123,v13,v154
v_and_b32 v124,v12,v139
v_and_b32 v125,v13,v139
v_smfmac_f32_16x16x64_bf16 v[116:119],v[120:123],a[80:87],v14
v_and_b32 v126,v12,v155
v_and_b32 v127,v13,v155
s_waitcnt lgkmcnt(0)
v_and_b32 v120,v12,v140
v_and_b32 v121,v13,v140
v_smfmac_f32_16x16x64_bf16 v[116:119],v[124:127],a[88:95],v14
v_and_b32 v122,v12,v156
v_and_b32 v123,v13,v156
v_and_b32 v124,v12,v141
v_and_b32 v125,v13,v141
v_smfmac_f32_16x16x64_bf16 v[116:119],v[120:123],a[96:103],v14
v_and_b32 v126,v12,v157
v_and_b32 v127,v13,v157
v_and_b32 v120,v12,v142
v_and_b32 v121,v13,v142
v_smfmac_f32_16x16x64_bf16 v[116:119],v[124:127],a[104:111],v14
v_and_b32 v122,v12,v158
v_and_b32 v123,v13,v158
v_and_b32 v124,v12,v143
v_and_b32 v125,v13,v143
v_smfmac_f32_16x16x64_bf16 v[116:119],v[120:123],a[112:119],v14
v_and_b32 v126,v12,v159
v_and_b32 v127,v13,v159
s_nop 1
v_smfmac_f32_16x16x64_bf16 v[116:119],v[124:127],a[120:127],v14
v_lshlrev_b32 v8,5,v9
v_and_b32 v124,1,v10
v_lshl_add_u32 v8,v124,4,v8
v_lshrrev_b32 v124,1,v10
v_lshl_add_u32 v8,v124,11,v8
s_lshl_b32 s60,s46,9
s_add_u32 s60,s60,147456
v_add_u32 v8,s60,v8
ds_write_b128 v8,v[116:119]
v_lshlrev_b32 v8,2,v1
v_add_u32 v8,147456,v8
v_and_b32 v2,1,v1
v_lshrrev_b32 v3,1,v1
v_lshlrev_b32 v3,2,v3
v_lshl_add_u32 v2,v2,7,v3
v_add_u32 v2,s58,v2
v_lshlrev_b32 v3,6,v10
v_add_u32 v3,s58,v3
s_waitcnt lgkmcnt(0)
s_barrier
ds_read2st64_b32 v[88:89],v8 offset0:0 offset1:1
ds_read2st64_b32 v[90:91],v8 offset0:2 offset1:3
ds_read2st64_b32 v[92:93],v8 offset0:4 offset1:5
ds_read2st64_b32 v[94:95],v8 offset0:6 offset1:7
s_waitcnt lgkmcnt(0)
v_pk_add_f32 v[88:89],v[88:89],v[90:91]
v_pk_add_f32 v[92:93],v[92:93],v[94:95]
v_pk_add_f32 v[88:89],v[88:89],v[92:93]
v_cvt_pk_bf16_f32 v88,v88,v88
v_and_b32 v88,0xffff0000,v88
v_cvt_pk_bf16_f32 v89,v89,v89
v_and_b32 v89,0xffff0000,v89
v_mul_f32 v90,0xbfb8aa3b,v88
v_exp_f32 v90,v90
s_nop 0
v_add_f32 v90,1.0,v90
v_rcp_f32 v90,v90
s_nop 0
v_mul_f32 v88,v88,v90
v_cvt_pk_bf16_f32 v88,v88,v88
v_and_b32 v88,0xffff0000,v88
v_mul_f32 v88,v88,v89
v_cvt_pk_bf16_f32 v88,v88,v88
ds_write_b32 v2,v88
ds_read_b128 v[88:91],v3
ds_read_b128 v[108:111],v3 offset:32
ds_read_b128 v[92:95],v3 offset:16
ds_read_b128 v[112:115],v3 offset:48
v_mov_b64 v[116:117],0
v_mov_b64 v[118:119],0
s_waitcnt vmcnt(0) lgkmcnt(0)
v_and_b32 v120,v12,v88
v_and_b32 v121,v13,v88
v_and_b32 v122,v12,v108
v_and_b32 v123,v13,v108
v_and_b32 v124,v12,v89
v_and_b32 v125,v13,v89
v_smfmac_f32_16x16x64_bf16 v[116:119],v[120:123],v[24:31],v14
v_and_b32 v126,v12,v109
v_and_b32 v127,v13,v109
v_and_b32 v120,v12,v90
v_and_b32 v121,v13,v90
v_smfmac_f32_16x16x64_bf16 v[116:119],v[124:127],v[32:39],v14
v_and_b32 v122,v12,v110
v_and_b32 v123,v13,v110
v_and_b32 v124,v12,v91
v_and_b32 v125,v13,v91
v_smfmac_f32_16x16x64_bf16 v[116:119],v[120:123],v[40:47],v14
v_and_b32 v126,v12,v111
v_and_b32 v127,v13,v111
v_and_b32 v120,v12,v92
v_and_b32 v121,v13,v92
v_smfmac_f32_16x16x64_bf16 v[116:119],v[124:127],v[48:55],v14
v_and_b32 v122,v12,v112
v_and_b32 v123,v13,v112
v_and_b32 v124,v12,v93
v_and_b32 v125,v13,v93
v_smfmac_f32_16x16x64_bf16 v[116:119],v[120:123],v[56:63],v14
v_and_b32 v126,v12,v113
v_and_b32 v127,v13,v113
v_and_b32 v120,v12,v94
v_and_b32 v121,v13,v94
v_smfmac_f32_16x16x64_bf16 v[116:119],v[124:127],v[64:71],v14
v_and_b32 v122,v12,v114
v_and_b32 v123,v13,v114
v_and_b32 v124,v12,v95
v_and_b32 v125,v13,v95
v_smfmac_f32_16x16x64_bf16 v[116:119],v[120:123],v[72:79],v14
v_and_b32 v126,v12,v115
v_and_b32 v127,v13,v115
s_nop 1
v_smfmac_f32_16x16x64_bf16 v[116:119],v[124:127],v[80:87],v14
v_lshlrev_b32 v8,4,v9
v_and_b32 v124,1,v10
v_lshl_add_u32 v8,v124,3,v8
v_and_b32 v124,2,v10
v_lshl_add_u32 v8,v124,30,v8
s_lshl_b32 s60,s46,8
s_add_u32 s59,s62,s60
s_nop 0
v_cvt_pk_bf16_f32 v88,v116,v117
v_cvt_pk_bf16_f32 v89,v118,v119
buffer_store_dwordx2 v[88:89],v8,s[8:11],s59 offen
s_lshl_b32 s59,s51,13
s_lshl2_add_u32 s59,s47,s59
s_add_u32 s59,s59,10486912
s_waitcnt vmcnt(0)
s_barrier
s_or_b32 s59,s59,s52
buffer_store_dword v17,off,s[8:11],s59
s_cmp_lg_u32 s47,0
s_cbranch_scc1 L_moed_67
s_lshl_b32 s59,s51,13
s_add_u32 s59,s59,10486912
v_and_b32 v124,31,v1
v_lshlrev_b32 v124,2,v124
L_fw_68:
buffer_load_dword v125,v124,s[8:11],s59 offen sc1
s_sub_u32 s49,s49,1
s_cbranch_scc1 L_abort
s_waitcnt vmcnt(0)
v_cmp_eq_u32 vcc,0,v125
s_cbranch_vccnz L_fw_68
s_add_u32 s63,s65,0
buffer_load_dwordx4 v[168:171],v22,s[8:11],s63 offen sc1
s_add_u32 s63,s65,4096
buffer_load_dwordx4 v[172:175],v22,s[8:11],s63 offen sc1
s_add_u32 s63,s65,8192
buffer_load_dwordx4 v[176:179],v22,s[8:11],s63 offen sc1
s_add_u32 s63,s65,12288
buffer_load_dwordx4 v[180:183],v22,s[8:11],s63 offen sc1
s_add_u32 s63,s65,16384
buffer_load_dwordx4 v[184:187],v22,s[8:11],s63 offen sc1
s_add_u32 s63,s65,20480
buffer_load_dwordx4 v[188:191],v22,s[8:11],s63 offen sc1
s_add_u32 s63,s65,24576
buffer_load_dwordx4 v[192:195],v22,s[8:11],s63 offen sc1
s_add_u32 s63,s65,28672
buffer_load_dwordx4 v[196:199],v22,s[8:11],s63 offen sc1
v_and_b32 v208,15,v1
v_and_b32 v209,1,v1
v_lshlrev_b32 v209,4,v209
v_mov_b32 v210,0x3f80
v_lshlrev_b32 v210,v209,v210
v_lshrrev_b32 v208,1,v208
v_cmp_eq_u32 vcc,0,v208
s_nop 1
v_cndmask_b32 v200,0,v210,vcc
v_cmp_eq_u32 vcc,1,v208
s_nop 1
v_cndmask_b32 v201,0,v210,vcc
v_cmp_eq_u32 vcc,2,v208
s_nop 1
v_cndmask_b32 v202,0,v210,vcc
v_cmp_eq_u32 vcc,3,v208
s_nop 1
v_cndmask_b32 v203,0,v210,vcc
s_waitcnt vmcnt(7)
s_nop 0
v_mfma_f32_16x16x32_bf16 v[204:207],v[200:203],v[168:171],0
s_waitcnt vmcnt(6)
v_mfma_f32_16x16x32_bf16 v[204:207],v[200:203],v[172:175],v[204:207]
s_waitcnt vmcnt(5)
v_mfma_f32_16x16x32_bf16 v[204:207],v[200:203],v[176:179],v[204:207]
s_waitcnt vmcnt(4)
v_mfma_f32_16x16x32_bf16 v[204:207],v[200:203],v[180:183],v[204:207]
s_waitcnt vmcnt(3)
v_mfma_f32_16x16x32_bf16 v[204:207],v[200:203],v[184:187],v[204:207]
s_waitcnt vmcnt(2)
v_mfma_f32_16x16x32_bf16 v[204:207],v[200:203],v[188:191],v[204:207]
s_waitcnt vmcnt(1)
v_mfma_f32_16x16x32_bf16 v[204:207],v[200:203],v[192:195],v[204:207]
s_waitcnt vmcnt(0)
v_mfma_f32_16x16x32_bf16 v[204:207],v[200:203],v[196:199],v[204:207]
s_nop 7
ds_write_b128 v21,v[204:207]
s_waitcnt lgkmcnt(0)
s_barrier
s_cmp_lg_u32 s46,0
s_cbranch_scc1 L_moed_67
v_lshlrev_b32 v200,5,v1
v_add_u32 v200,155648,v200
ds_read_b128 v[168:171],v200
ds_read_b128 v[172:175],v200 offset:16
s_and_b32 s59,s55,0xffff0000
s_xor_b32 s60,s59,0x80000000
s_xor_b32 s61,s59,0xffff0000
s_cmp_lt_i32 s59,0
s_cselect_b32 s59,s60,s61
v_mov_b32 v200,s59
v_mul_f32 v200,0xbfb8aa3b,v200
v_exp_f32 v200,v200
s_nop 0
v_add_f32 v200,1.0,v200
v_rcp_f32 v200,v200
s_nop 0
v_cvt_pk_bf16_f32 v200,v200,v200
v_and_b32 v200,0xffff0000,v200
v_lshlrev_b32 v192,16,v104
v_and_b32 v193,0xffff0000,v104
v_lshlrev_b32 v194,16,v105
v_and_b32 v195,0xffff0000,v105
v_lshlrev_b32 v196,16,v106
v_and_b32 v197,0xffff0000,v106
v_lshlrev_b32 v198,16,v107
v_and_b32 v199,0xffff0000,v107
s_waitcnt lgkmcnt(0)
v_cvt_pk_bf16_f32 v184,v168,v169
v_cvt_pk_bf16_f32 v185,v170,v171
v_cvt_pk_bf16_f32 v186,v172,v173
v_cvt_pk_bf16_f32 v187,v174,v175
v_lshlrev_b32 v168,16,v184
v_and_b32 v169,0xffff0000,v184
v_lshlrev_b32 v170,16,v185
v_and_b32 v171,0xffff0000,v185
v_lshlrev_b32 v172,16,v186
v_and_b32 v173,0xffff0000,v186
v_lshlrev_b32 v174,16,v187
v_and_b32 v175,0xffff0000,v187
v_pk_mul_f32 v[168:169],v[168:169],v[200:201] op_sel_hi:[1,0]
v_pk_mul_f32 v[170:171],v[170:171],v[200:201] op_sel_hi:[1,0]
v_pk_mul_f32 v[172:173],v[172:173],v[200:201] op_sel_hi:[1,0]
v_pk_mul_f32 v[174:175],v[174:175],v[200:201] op_sel_hi:[1,0]
v_cvt_pk_bf16_f32 v184,v168,v169
v_cvt_pk_bf16_f32 v185,v170,v171
v_cvt_pk_bf16_f32 v186,v172,v173
v_cvt_pk_bf16_f32 v187,v174,v175
v_lshlrev_b32 v168,16,v184
v_and_b32 v169,0xffff0000,v184
v_lshlrev_b32 v170,16,v185
v_and_b32 v171,0xffff0000,v185
v_lshlrev_b32 v172,16,v186
v_and_b32 v173,0xffff0000,v186
v_lshlrev_b32 v174,16,v187
v_and_b32 v175,0xffff0000,v187
v_pk_add_f32 v[168:169],v[168:169],v[192:193]
v_pk_add_f32 v[170:171],v[170:171],v[194:195]
v_pk_add_f32 v[172:173],v[172:173],v[196:197]
v_pk_add_f32 v[174:175],v[174:175],v[198:199]
v_cvt_pk_bf16_f32 v184,v168,v169
v_cvt_pk_bf16_f32 v185,v170,v171
v_cvt_pk_bf16_f32 v186,v172,v173
v_cvt_pk_bf16_f32 v187,v174,v175
v_lshlrev_b32 v168,16,v184
v_and_b32 v169,0xffff0000,v184
v_lshlrev_b32 v170,16,v185
v_and_b32 v171,0xffff0000,v185
v_lshlrev_b32 v172,16,v186
v_and_b32 v173,0xffff0000,v186
v_lshlrev_b32 v174,16,v187
v_and_b32 v175,0xffff0000,v187
v_pk_add_f32 v[96:97],v[96:97],v[168:169]
v_pk_add_f32 v[98:99],v[98:99],v[170:171]
v_pk_add_f32 v[100:101],v[100:101],v[172:173]
v_pk_add_f32 v[102:103],v[102:103],v[174:175]
v_cvt_pk_bf16_f32 v160,v96,v97
v_cvt_pk_bf16_f32 v161,v98,v99
v_cvt_pk_bf16_f32 v162,v100,v101
v_cvt_pk_bf16_f32 v163,v102,v103
L_moed_67:
s_add_u32 s51,s51,1
s_add_u32 s62,s62,32768
s_add_u32 s65,s65,32768
s_branch L_mf_60
L_mf_61:
s_mov_b32 s4,s40
s_mov_b32 s5,s41
s_mov_b32 s6,2097152
s_mov_b32 s7,0x20000
s_or_b32 s61,s47,s46
s_cselect_b32 s56,0x80000000,s56
buffer_store_dwordx4 v[160:163],v0,s[4:7],s56 offen sc1
s_waitcnt vmcnt(0)
s_endpgm
L_mf_59:
s_cmp_lg_u32 s46,0
s_cbranch_scc1 L_mf_64
v_mov_b64 v[24:25],0
v_mov_b64 v[26:27],0
s_mov_b32 s56,94403584
buffer_store_dwordx4 v[24:27],v0,s[8:11],s56 offen
s_mov_b32 s56,94436352
buffer_store_dwordx4 v[24:27],v0,s[8:11],s56 offen
s_mov_b32 s56,94469120
buffer_store_dwordx4 v[24:27],v0,s[8:11],s56 offen
s_mov_b32 s56,94501888
buffer_store_dwordx4 v[24:27],v0,s[8:11],s56 offen
s_mov_b32 s56,94534656
buffer_store_dwordx4 v[24:27],v0,s[8:11],s56 offen
s_mov_b32 s56,94567424
buffer_store_dwordx4 v[24:27],v0,s[8:11],s56 offen
s_andn2_b32 s61,0x7ff,s54
s_lshr_b32 s61,s61,5
s_mov_b32 s59,11018240
v_lshlrev_b32 v2,2,v1
L_fp_71:
s_sleep 2
buffer_load_dword v3,v2,s[8:11],s59 offen sc1
s_sub_u32 s49,s49,1
s_cbranch_scc1 L_abort
s_waitcnt vmcnt(0)
v_cmp_eq_u32 vcc,0,v3
s_cbranch_vccnz L_fp_71
v_cmp_le_u32 vcc,s61,v1
s_nop 1
v_cndmask_b32 v2,1,2,vcc
v_cmp_ne_u32 s[84:85],v2,v3
s_mov_b32 s56,11011324
buffer_store_dword v17,off,s[8:11],s56
s_mov_b32 s56,11019516
buffer_store_dword v17,off,s[8:11],s56
s_mov_b32 s56,11027708
buffer_store_dword v17,off,s[8:11],s56
s_mov_b32 s56,11035900
buffer_store_dword v17,off,s[8:11],s56
s_mov_b32 s56,11044092
buffer_store_dword v17,off,s[8:11],s56
s_mov_b32 s56,11052284
buffer_store_dword v17,off,s[8:11],s56
v_lshrrev_b32 v2,3,v1
v_and_b32 v3,0x70,v0
v_lshl_add_u32 v3,v2,13,v3
s_lshr_b64 s[20:21],s[84:85],0
v_lshrrev_b32 v60,v2,s20
v_and_b32 v60,1,v60
v_mul_u32_u24 v60,768,v60
v_sub_u32 v60,v3,v60
v_add_u32 v60,10487296,v60
s_lshr_b64 s[20:21],s[84:85],8
v_lshrrev_b32 v61,v2,s20
v_and_b32 v61,1,v61
v_mul_u32_u24 v61,768,v61
v_sub_u32 v61,v3,v61
v_add_u32 v61,10552832,v61
s_lshr_b64 s[20:21],s[84:85],16
v_lshrrev_b32 v62,v2,s20
v_and_b32 v62,1,v62
v_mul_u32_u24 v62,768,v62
v_sub_u32 v62,v3,v62
v_add_u32 v62,10618368,v62
s_lshr_b64 s[20:21],s[84:85],24
v_lshrrev_b32 v63,v2,s20
v_and_b32 v63,1,v63
v_mul_u32_u24 v63,768,v63
v_sub_u32 v63,v3,v63
v_add_u32 v63,10683904,v63
s_lshr_b64 s[20:21],s[84:85],32
v_lshrrev_b32 v64,v2,s20
v_and_b32 v64,1,v64
v_mul_u32_u24 v64,768,v64
v_sub_u32 v64,v3,v64
v_add_u32 v64,10749440,v64
s_lshr_b64 s[20:21],s[84:85],40
v_lshrrev_b32 v65,v2,s20
v_and_b32 v65,1,v65
v_mul_u32_u24 v65,768,v65
v_sub_u32 v65,v3,v65
v_add_u32 v65,10814976,v65
s_lshr_b64 s[20:21],s[84:85],48
v_lshrrev_b32 v66,v2,s20
v_and_b32 v66,1,v66
v_mul_u32_u24 v66,768,v66
v_sub_u32 v66,v3,v66
v_add_u32 v66,10880512,v66
s_lshr_b64 s[20:21],s[84:85],56
v_lshrrev_b32 v67,v2,s20
v_and_b32 v67,1,v67
v_mul_u32_u24 v67,768,v67
v_sub_u32 v67,v3,v67
v_add_u32 v67,10946048,v67
v_and_b32 v68,3,v1
v_lshlrev_b32 v68,7,v68
v_add_u32 v68,10486272,v68
v_and_b32 v69,31,v1
v_lshlrev_b32 v69,2,v69
v_add_u32 v69,10478720,v69
s_mov_b32 s66,0
s_mov_b32 s67,524288
v_mov_b32 v57,0
s_mov_b32 s58,1
L_mf_62:
s_sub_u32 s49,s49,1
s_cbranch_scc1 L_abort
s_mov_b32 s57,0
s_cmp_lg_u32 s58,0
s_cbranch_scc1 L_ms_72
buffer_load_dwordx4 v[52:55],v67,s[8:11],0 offen sc1
buffer_load_dword v70,v69,s[8:11],s67 offen sc1
s_branch L_mj_73
L_ms_72:
buffer_load_dwordx4 v[24:27],v60,s[8:11],0 offen sc1
buffer_load_dwordx4 v[28:31],v61,s[8:11],0 offen sc1
buffer_load_dwordx4 v[32:35],v62,s[8:11],0 offen sc1
buffer_load_dwordx4 v[36:39],v63,s[8:11],0 offen sc1
buffer_load_dwordx4 v[40:43],v64,s[8:11],0 offen sc1
buffer_load_dwordx4 v[44:47],v65,s[8:11],0 offen sc1
buffer_load_dwordx4 v[48:51],v66,s[8:11],0 offen sc1
buffer_load_dwordx4 v[52:55],v67,s[8:11],0 offen sc1
buffer_load_dword v70,v69,s[8:11],s67 offen sc1
s_waitcnt vmcnt(8)
v_min3_u32 v56,v24,v25,v26
v_max3_u32 v57,v24,v25,v57
v_min_u32 v56,v27,v56
v_max3_u32 v57,v26,v27,v57
v_cmp_eq_u32 vcc,0,v56
s_bcnt1_i32_b64 s56,vcc
s_add_u32 s57,s57,s56
s_waitcnt vmcnt(7)
v_min3_u32 v56,v28,v29,v30
v_max3_u32 v57,v28,v29,v57
v_min_u32 v56,v31,v56
v_max3_u32 v57,v30,v31,v57
v_cmp_eq_u32 vcc,0,v56
s_bcnt1_i32_b64 s56,vcc
s_add_u32 s57,s57,s56
s_waitcnt vmcnt(6)
v_min3_u32 v56,v32,v33,v34
v_max3_u32 v57,v32,v33,v57
v_min_u32 v56,v35,v56
v_max3_u32 v57,v34,v35,v57
v_cmp_eq_u32 vcc,0,v56
s_bcnt1_i32_b64 s56,vcc
s_add_u32 s57,s57,s56
s_waitcnt vmcnt(5)
v_min3_u32 v56,v36,v37,v38
v_max3_u32 v57,v36,v37,v57
v_min_u32 v56,v39,v56
v_max3_u32 v57,v38,v39,v57
v_cmp_eq_u32 vcc,0,v56
s_bcnt1_i32_b64 s56,vcc
s_add_u32 s57,s57,s56
s_waitcnt vmcnt(4)
v_min3_u32 v56,v40,v41,v42
v_max3_u32 v57,v40,v41,v57
v_min_u32 v56,v43,v56
v_max3_u32 v57,v42,v43,v57
v_cmp_eq_u32 vcc,0,v56
s_bcnt1_i32_b64 s56,vcc
s_add_u32 s57,s57,s56
s_waitcnt vmcnt(3)
v_min3_u32 v56,v44,v45,v46
v_max3_u32 v57,v44,v45,v57
v_min_u32 v56,v47,v56
v_max3_u32 v57,v46,v47,v57
v_cmp_eq_u32 vcc,0,v56
s_bcnt1_i32_b64 s56,vcc
s_add_u32 s57,s57,s56
s_waitcnt vmcnt(2)
v_min3_u32 v56,v48,v49,v50
v_max3_u32 v57,v48,v49,v57
v_min_u32 v56,v51,v56
v_max3_u32 v57,v50,v51,v57
v_cmp_eq_u32 vcc,0,v56
s_bcnt1_i32_b64 s56,vcc
s_add_u32 s57,s57,s56
s_mov_b32 s58,s57
L_mj_73:
s_waitcnt vmcnt(1)
v_min3_u32 v56,v52,v53,v54
v_max3_u32 v57,v52,v53,v57
v_min_u32 v56,v55,v56
v_max3_u32 v57,v54,v55,v57
v_cmp_eq_u32 vcc,0,v56
s_bcnt1_i32_b64 s56,vcc
s_add_u32 s57,s57,s56
v_max_u32_dpp v57,v57,v57 row_ror:8 row_mask:0xf bank_mask:0xf
s_nop 1
v_max_u32_dpp v57,v57,v57 row_ror:4 row_mask:0xf bank_mask:0xf
s_nop 1
v_max_u32_dpp v57,v57,v57 row_ror:2 row_mask:0xf bank_mask:0xf
s_nop 1
v_max_u32_dpp v57,v57,v57 row_ror:1 row_mask:0xf bank_mask:0xf
v_mov_b32 v58,v57
s_nop 1
v_permlane16_swap_b32 v57,v58
v_max_u32 v57,v57,v58
v_mov_b32 v58,v57
s_nop 1
v_permlane32_swap_b32 v57,v58
v_max_u32 v57,v57,v58
s_nop 0
v_readfirstlane_b32 s55,v57
s_cmp_lg_u32 s55,s66
s_cbranch_scc1 L_mf_63
s_cmp_lg_u32 s57,0
s_cbranch_scc1 L_mf_62
v_mov_b32 v57,1
buffer_store_dword v57,v68,s[8:11],s67 offen
L_mf_64:
s_waitcnt vmcnt(0)
s_endpgm
L_mf_63:
s_waitcnt vmcnt(0)
v_cmp_eq_u32 vcc,0,v70
s_cmp_eq_u32 s66,0
s_cselect_b32 s56,0,vcc_lo
s_cmp_gt_u32 s57,112
s_cselect_b32 s56,1,s56
s_cmp_ge_u32 s67,565248
s_cselect_b32 s56,1,s56
s_cmp_eq_u32 s57,0
s_cselect_b32 s56,0,s56
s_cmp_lg_u32 s56,0
s_cbranch_scc1 L_mf_62
buffer_store_dword v57,v68,s[8:11],s67 offen
s_mov_b32 s66,s55
s_add_u32 s67,s67,8192
s_branch L_mf_62
s_endpgm
L_abort:
s_endpgm
L_spread:
s_mov_b32 s3,-1
s_lshr_b32 s48,s2,5
s_and_b32 s47,s2,31
s_branch L_roles
L_ra_6:
s_and_b32 s56,s48,1
s_lshl_b32 s56,s56,12
s_add_u32 s56,s56,s50
s_and_b32 s57,s47,15
s_lshl_b32 s57,s57,13
s_add_u32 s56,s56,s57
s_mov_b32 s4,s22
s_mov_b32 s5,s23
s_mov_b32 s6,4194304
s_mov_b32 s7,0x20000
s_add_u32 s57,s56,0
buffer_load_dwordx4 v[72:75],v0,s[4:7],s57 offen
s_add_u32 s57,s56,131072
buffer_load_dwordx4 v[72:75],v0,s[4:7],s57 offen
s_add_u32 s57,s56,262144
buffer_load_dwordx4 v[72:75],v0,s[4:7],s57 offen
s_add_u32 s57,s56,393216
buffer_load_dwordx4 v[72:75],v0,s[4:7],s57 offen
s_add_u32 s57,s56,524288
buffer_load_dwordx4 v[72:75],v0,s[4:7],s57 offen
s_add_u32 s57,s56,655360
buffer_load_dwordx4 v[72:75],v0,s[4:7],s57 offen
s_add_u32 s57,s56,786432
buffer_load_dwordx4 v[72:75],v0,s[4:7],s57 offen
s_add_u32 s57,s56,917504
buffer_load_dwordx4 v[72:75],v0,s[4:7],s57 offen
s_add_u32 s57,s56,1048576
buffer_load_dwordx4 v[72:75],v0,s[4:7],s57 offen
s_add_u32 s57,s56,1179648
buffer_load_dwordx4 v[72:75],v0,s[4:7],s57 offen
s_cmp_eq_u32 s53,0
s_cbranch_scc1 L_m0_74
s_waitcnt vmcnt(18)
v_lshlrev_b32 v32,16,v24
v_and_b32 v33,0xffff0000,v24
v_lshlrev_b32 v34,16,v25
v_and_b32 v35,0xffff0000,v25
v_lshlrev_b32 v36,16,v26
v_and_b32 v37,0xffff0000,v26
v_lshlrev_b32 v38,16,v27
v_and_b32 v39,0xffff0000,v27
v_readfirstlane_b32 s78,v32
s_nop 1
v_pk_add_f32 v[48:49],v[32:33],s[78:79] op_sel_hi:[1,0] neg_lo:[0,1] neg_hi:[0,1]
v_pk_add_f32 v[50:51],v[34:35],s[78:79] op_sel_hi:[1,0] neg_lo:[0,1] neg_hi:[0,1]
v_pk_add_f32 v[52:53],v[36:37],s[78:79] op_sel_hi:[1,0] neg_lo:[0,1] neg_hi:[0,1]
v_pk_add_f32 v[54:55],v[38:39],s[78:79] op_sel_hi:[1,0] neg_lo:[0,1] neg_hi:[0,1]
v_pk_add_f32 v[56:57],v[48:49],v[50:51]
v_pk_mul_f32 v[58:59],v[48:49],v[48:49]
v_pk_add_f32 v[60:61],v[52:53],v[54:55]
v_pk_fma_f32 v[58:59],v[50:51],v[50:51],v[58:59]
v_pk_add_f32 v[56:57],v[56:57],v[60:61]
v_pk_fma_f32 v[58:59],v[52:53],v[52:53],v[58:59]
v_add_f32 v56,v56,v57
v_pk_fma_f32 v[58:59],v[54:55],v[54:55],v[58:59]
v_add_f32 v58,v58,v59
s_nop 1
v_permlane32_swap_b32 v56,v58
v_add_f32 v56,v56,v58
s_nop 1
v_add_f32_dpp v56,v56,v56 row_ror:8 row_mask:0xf bank_mask:0xf
s_nop 1
v_add_f32_dpp v56,v56,v56 row_ror:4 row_mask:0xf bank_mask:0xf
s_nop 1
v_add_f32_dpp v56,v56,v56 row_ror:2 row_mask:0xf bank_mask:0xf
s_nop 1
v_add_f32_dpp v56,v56,v56 row_ror:1 row_mask:0xf bank_mask:0xf
v_mov_b32 v58,v56
s_nop 1
v_permlane16_swap_b32 v56,v58
v_add_f32 v56,v56,v58
v_mul_f32 v56,0x3b000000,v56
v_mov_b32 v58,v56
s_nop 1
v_permlane32_swap_b32 v56,v58
v_fma_f32 v58,-v56,v56,v58
v_add_f32 v56,s78,v56
v_max_f32 v58,0,v58
v_cvt_pk_bf16_f32 v58,v56,v58
v_lshlrev_b32 v56,16,v58
v_and_b32 v58,0xffff0000,v58
v_add_f32 v58,0x3727c5ac,v58
v_cvt_pk_bf16_f32 v58,v58,v58
v_and_b32 v58,0xffff0000,v58
v_sqrt_f32 v58,v58
v_pk_add_f32 v[48:49],v[32:33],v[56:57] op_sel_hi:[1,0] neg_lo:[0,1] neg_hi:[0,1]
v_pk_add_f32 v[50:51],v[34:35],v[56:57] op_sel_hi:[1,0] neg_lo:[0,1] neg_hi:[0,1]
v_pk_add_f32 v[52:53],v[36:37],v[56:57] op_sel_hi:[1,0] neg_lo:[0,1] neg_hi:[0,1]
v_pk_add_f32 v[54:55],v[38:39],v[56:57] op_sel_hi:[1,0] neg_lo:[0,1] neg_hi:[0,1]
v_cvt_pk_bf16_f32 v58,v58,v58
v_and_b32 v58,0xffff0000,v58
v_rcp_f32 v58,v58
v_cvt_pk_bf16_f32 v40,v48,v49
v_cvt_pk_bf16_f32 v41,v50,v51
v_cvt_pk_bf16_f32 v42,v52,v53
v_cvt_pk_bf16_f32 v43,v54,v55
v_lshlrev_b32 v48,16,v40
v_and_b32 v49,0xffff0000,v40
v_lshlrev_b32 v50,16,v41
v_and_b32 v51,0xffff0000,v41
v_lshlrev_b32 v52,16,v42
v_and_b32 v53,0xffff0000,v42
v_lshlrev_b32 v54,16,v43
v_and_b32 v55,0xffff0000,v43
v_pk_mul_f32 v[48:49],v[48:49],v[58:59] op_sel_hi:[1,0]
v_pk_mul_f32 v[50:51],v[50:51],v[58:59] op_sel_hi:[1,0]
v_pk_mul_f32 v[52:53],v[52:53],v[58:59] op_sel_hi:[1,0]
v_pk_mul_f32 v[54:55],v[54:55],v[58:59] op_sel_hi:[1,0]
v_cvt_pk_bf16_f32 v40,v48,v49
v_cvt_pk_bf16_f32 v41,v50,v51
v_cvt_pk_bf16_f32 v42,v52,v53
v_cvt_pk_bf16_f32 v43,v54,v55
buffer_store_dwordx4 v[40:43],v0,s[8:11],s65 offen offset:0 sc1
v_lshlrev_b32 v32,16,v28
v_and_b32 v33,0xffff0000,v28
v_lshlrev_b32 v34,16,v29
v_and_b32 v35,0xffff0000,v29
v_lshlrev_b32 v36,16,v30
v_and_b32 v37,0xffff0000,v30
v_lshlrev_b32 v38,16,v31
v_and_b32 v39,0xffff0000,v31
v_readfirstlane_b32 s78,v32
s_nop 1
v_pk_add_f32 v[48:49],v[32:33],s[78:79] op_sel_hi:[1,0] neg_lo:[0,1] neg_hi:[0,1]
v_pk_add_f32 v[50:51],v[34:35],s[78:79] op_sel_hi:[1,0] neg_lo:[0,1] neg_hi:[0,1]
v_pk_add_f32 v[52:53],v[36:37],s[78:79] op_sel_hi:[1,0] neg_lo:[0,1] neg_hi:[0,1]
v_pk_add_f32 v[54:55],v[38:39],s[78:79] op_sel_hi:[1,0] neg_lo:[0,1] neg_hi:[0,1]
v_pk_add_f32 v[56:57],v[48:49],v[50:51]
v_pk_mul_f32 v[58:59],v[48:49],v[48:49]
v_pk_add_f32 v[60:61],v[52:53],v[54:55]
v_pk_fma_f32 v[58:59],v[50:51],v[50:51],v[58:59]
v_pk_add_f32 v[56:57],v[56:57],v[60:61]
v_pk_fma_f32 v[58:59],v[52:53],v[52:53],v[58:59]
v_add_f32 v56,v56,v57
v_pk_fma_f32 v[58:59],v[54:55],v[54:55],v[58:59]
v_add_f32 v58,v58,v59
s_nop 1
v_permlane32_swap_b32 v56,v58
v_add_f32 v56,v56,v58
s_nop 1
v_add_f32_dpp v56,v56,v56 row_ror:8 row_mask:0xf bank_mask:0xf
s_nop 1
v_add_f32_dpp v56,v56,v56 row_ror:4 row_mask:0xf bank_mask:0xf
s_nop 1
v_add_f32_dpp v56,v56,v56 row_ror:2 row_mask:0xf bank_mask:0xf
s_nop 1
v_add_f32_dpp v56,v56,v56 row_ror:1 row_mask:0xf bank_mask:0xf
v_mov_b32 v58,v56
s_nop 1
v_permlane16_swap_b32 v56,v58
v_add_f32 v56,v56,v58
v_mul_f32 v56,0x3b000000,v56
v_mov_b32 v58,v56
s_nop 1
v_permlane32_swap_b32 v56,v58
v_fma_f32 v58,-v56,v56,v58
v_add_f32 v56,s78,v56
v_max_f32 v58,0,v58
v_cvt_pk_bf16_f32 v58,v56,v58
v_lshlrev_b32 v56,16,v58
v_and_b32 v58,0xffff0000,v58
v_add_f32 v58,0x3727c5ac,v58
v_cvt_pk_bf16_f32 v58,v58,v58
v_and_b32 v58,0xffff0000,v58
v_sqrt_f32 v58,v58
v_pk_add_f32 v[48:49],v[32:33],v[56:57] op_sel_hi:[1,0] neg_lo:[0,1] neg_hi:[0,1]
v_pk_add_f32 v[50:51],v[34:35],v[56:57] op_sel_hi:[1,0] neg_lo:[0,1] neg_hi:[0,1]
v_pk_add_f32 v[52:53],v[36:37],v[56:57] op_sel_hi:[1,0] neg_lo:[0,1] neg_hi:[0,1]
v_pk_add_f32 v[54:55],v[38:39],v[56:57] op_sel_hi:[1,0] neg_lo:[0,1] neg_hi:[0,1]
v_cvt_pk_bf16_f32 v58,v58,v58
v_and_b32 v58,0xffff0000,v58
v_rcp_f32 v58,v58
v_cvt_pk_bf16_f32 v44,v48,v49
v_cvt_pk_bf16_f32 v45,v50,v51
v_cvt_pk_bf16_f32 v46,v52,v53
v_cvt_pk_bf16_f32 v47,v54,v55
v_lshlrev_b32 v48,16,v44
v_and_b32 v49,0xffff0000,v44
v_lshlrev_b32 v50,16,v45
v_and_b32 v51,0xffff0000,v45
v_lshlrev_b32 v52,16,v46
v_and_b32 v53,0xffff0000,v46
v_lshlrev_b32 v54,16,v47
v_and_b32 v55,0xffff0000,v47
v_pk_mul_f32 v[48:49],v[48:49],v[58:59] op_sel_hi:[1,0]
v_pk_mul_f32 v[50:51],v[50:51],v[58:59] op_sel_hi:[1,0]
v_pk_mul_f32 v[52:53],v[52:53],v[58:59] op_sel_hi:[1,0]
v_pk_mul_f32 v[54:55],v[54:55],v[58:59] op_sel_hi:[1,0]
v_cvt_pk_bf16_f32 v44,v48,v49
v_cvt_pk_bf16_f32 v45,v50,v51
v_cvt_pk_bf16_f32 v46,v52,v53
v_cvt_pk_bf16_f32 v47,v54,v55
buffer_store_dwordx4 v[44:47],v0,s[8:11],s65 offen offset:1024 sc1
s_cmp_ge_u32 s2,2
s_cbranch_scc1 L_m0_74
v_lshrrev_b32 v12,3,v1
v_lshlrev_b32 v12,9,v12
v_and_b32 v13,7,v1
v_lshl_add_u32 v12,v13,4,v12
s_lshl_b32 s66,s2,2
s_add_u32 s66,s66,s46
s_and_b32 s67,s66,1
s_lshl_b32 s67,s67,8
s_and_b32 s68,s66,2
s_lshl_b32 s68,s68,6
s_add_u32 s67,s67,s68
s_and_b32 s68,s66,4
s_lshl_b32 s68,s68,10
s_add_u32 s67,s67,s68
s_add_u32 s68,s67,11534336
buffer_store_dwordx4 v[64:67],v12,s[8:11],s68 offen sc1
s_add_u32 s68,s67,12582912
buffer_store_dwordx4 v[64:67],v12,s[8:11],s68 offen sc1
s_add_u32 s68,s67,17825792
buffer_store_dwordx4 v[64:67],v12,s[8:11],s68 offen sc1
L_m0_74:
s_waitcnt vmcnt(9)
s_add_u32 s57,s56,1310720
buffer_load_dwordx4 v[72:75],v0,s[4:7],s57 offen
s_waitcnt vmcnt(9)
s_add_u32 s57,s56,1441792
buffer_load_dwordx4 v[72:75],v0,s[4:7],s57 offen
s_waitcnt vmcnt(9)
s_add_u32 s57,s56,1572864
buffer_load_dwordx4 v[72:75],v0,s[4:7],s57 offen
s_waitcnt vmcnt(9)
s_add_u32 s57,s56,1703936
buffer_load_dwordx4 v[72:75],v0,s[4:7],s57 offen
s_waitcnt vmcnt(9)
s_add_u32 s57,s56,1835008
buffer_load_dwordx4 v[72:75],v0,s[4:7],s57 offen
s_waitcnt vmcnt(9)
s_add_u32 s57,s56,1966080
buffer_load_dwordx4 v[72:75],v0,s[4:7],s57 offen
s_waitcnt vmcnt(9)
s_add_u32 s57,s56,2097152
buffer_load_dwordx4 v[72:75],v0,s[4:7],s57 offen
s_waitcnt vmcnt(9)
s_add_u32 s57,s56,2228224
buffer_load_dwordx4 v[72:75],v0,s[4:7],s57 offen
s_waitcnt vmcnt(9)
s_add_u32 s57,s56,2359296
buffer_load_dwordx4 v[72:75],v0,s[4:7],s57 offen
s_waitcnt vmcnt(9)
s_add_u32 s57,s56,2490368
buffer_load_dwordx4 v[72:75],v0,s[4:7],s57 offen
s_waitcnt vmcnt(9)
s_add_u32 s57,s56,2621440
buffer_load_dwordx4 v[72:75],v0,s[4:7],s57 offen
s_barrier
s_cmp_lg_u32 s46,0
s_cbranch_scc1 L_ar_75
v_mov_b32 v8,240
v_mov_b32 v9,s53
s_mov_b64 exec,1
buffer_atomic_add v9,v8,s[12:15],0 offen
s_mov_b64 exec,-1
L_ar_75:
s_mov_b32 s53,0
s_waitcnt vmcnt(9)
s_add_u32 s57,s56,2752512
buffer_load_dwordx4 v[72:75],v0,s[4:7],s57 offen
s_waitcnt vmcnt(9)
s_add_u32 s57,s56,2883584
buffer_load_dwordx4 v[72:75],v0,s[4:7],s57 offen
s_waitcnt vmcnt(9)
s_add_u32 s57,s56,3014656
buffer_load_dwordx4 v[72:75],v0,s[4:7],s57 offen
s_waitcnt vmcnt(9)
s_add_u32 s57,s56,3145728
buffer_load_dwordx4 v[72:75],v0,s[4:7],s57 offen
s_waitcnt vmcnt(9)
s_add_u32 s57,s56,3276800
buffer_load_dwordx4 v[72:75],v0,s[4:7],s57 offen
s_waitcnt vmcnt(9)
s_add_u32 s57,s56,3407872
buffer_load_dwordx4 v[72:75],v0,s[4:7],s57 offen
s_waitcnt vmcnt(9)
s_add_u32 s57,s56,3538944
buffer_load_dwordx4 v[72:75],v0,s[4:7],s57 offen
s_waitcnt vmcnt(9)
s_add_u32 s57,s56,3670016
buffer_load_dwordx4 v[72:75],v0,s[4:7],s57 offen
s_waitcnt vmcnt(9)
s_add_u32 s57,s56,3801088
buffer_load_dwordx4 v[72:75],v0,s[4:7],s57 offen
s_waitcnt vmcnt(9)
s_add_u32 s57,s56,3932160
buffer_load_dwordx4 v[72:75],v0,s[4:7],s57 offen
s_waitcnt vmcnt(9)
s_add_u32 s57,s56,4063232
buffer_load_dwordx4 v[72:75],v0,s[4:7],s57 offen
s_mov_b32 s4,s24
s_mov_b32 s5,s25
s_mov_b32 s6,4194304
s_mov_b32 s7,0x20000
s_waitcnt vmcnt(9)
s_add_u32 s57,s56,0
buffer_load_dwordx4 v[72:75],v0,s[4:7],s57 offen
s_waitcnt vmcnt(9)
s_add_u32 s57,s56,131072
buffer_load_dwordx4 v[72:75],v0,s[4:7],s57 offen
s_waitcnt vmcnt(9)
s_add_u32 s57,s56,262144
buffer_load_dwordx4 v[72:75],v0,s[4:7],s57 offen
s_waitcnt vmcnt(9)
s_add_u32 s57,s56,393216
buffer_load_dwordx4 v[72:75],v0,s[4:7],s57 offen
s_waitcnt vmcnt(9)
s_add_u32 s57,s56,524288
buffer_load_dwordx4 v[72:75],v0,s[4:7],s57 offen
s_waitcnt vmcnt(9)
s_add_u32 s57,s56,655360
buffer_load_dwordx4 v[72:75],v0,s[4:7],s57 offen
s_waitcnt vmcnt(9)
s_add_u32 s57,s56,786432
buffer_load_dwordx4 v[72:75],v0,s[4:7],s57 offen
s_waitcnt vmcnt(9)
s_add_u32 s57,s56,917504
buffer_load_dwordx4 v[72:75],v0,s[4:7],s57 offen
s_waitcnt vmcnt(9)
s_add_u32 s57,s56,1048576
buffer_load_dwordx4 v[72:75],v0,s[4:7],s57 offen
s_waitcnt vmcnt(9)
s_add_u32 s57,s56,1179648
buffer_load_dwordx4 v[72:75],v0,s[4:7],s57 offen
s_waitcnt vmcnt(9)
s_add_u32 s57,s56,1310720
buffer_load_dwordx4 v[72:75],v0,s[4:7],s57 offen
s_waitcnt vmcnt(9)
s_add_u32 s57,s56,1441792
buffer_load_dwordx4 v[72:75],v0,s[4:7],s57 offen
s_waitcnt vmcnt(9)
s_add_u32 s57,s56,1572864
buffer_load_dwordx4 v[72:75],v0,s[4:7],s57 offen
s_waitcnt vmcnt(9)
s_add_u32 s57,s56,1703936
buffer_load_dwordx4 v[72:75],v0,s[4:7],s57 offen
s_waitcnt vmcnt(9)
s_add_u32 s57,s56,1835008
buffer_load_dwordx4 v[72:75],v0,s[4:7],s57 offen
s_waitcnt vmcnt(9)
s_add_u32 s57,s56,1966080
buffer_load_dwordx4 v[72:75],v0,s[4:7],s57 offen
s_waitcnt vmcnt(9)
s_add_u32 s57,s56,2097152
buffer_load_dwordx4 v[72:75],v0,s[4:7],s57 offen
s_waitcnt vmcnt(9)
s_add_u32 s57,s56,2228224
buffer_load_dwordx4 v[72:75],v0,s[4:7],s57 offen
s_waitcnt vmcnt(9)
s_add_u32 s57,s56,2359296
buffer_load_dwordx4 v[72:75],v0,s[4:7],s57 offen
s_waitcnt vmcnt(9)
s_add_u32 s57,s56,2490368
buffer_load_dwordx4 v[72:75],v0,s[4:7],s57 offen
s_waitcnt vmcnt(9)
s_add_u32 s57,s56,2621440
buffer_load_dwordx4 v[72:75],v0,s[4:7],s57 offen
s_waitcnt vmcnt(9)
s_add_u32 s57,s56,2752512
buffer_load_dwordx4 v[72:75],v0,s[4:7],s57 offen
s_waitcnt vmcnt(9)
s_add_u32 s57,s56,2883584
buffer_load_dwordx4 v[72:75],v0,s[4:7],s57 offen
s_waitcnt vmcnt(9)
s_add_u32 s57,s56,3014656
buffer_load_dwordx4 v[72:75],v0,s[4:7],s57 offen
s_waitcnt vmcnt(9)
s_add_u32 s57,s56,3145728
buffer_load_dwordx4 v[72:75],v0,s[4:7],s57 offen
s_waitcnt vmcnt(9)
s_add_u32 s57,s56,3276800
buffer_load_dwordx4 v[72:75],v0,s[4:7],s57 offen
s_waitcnt vmcnt(9)
s_add_u32 s57,s56,3407872
buffer_load_dwordx4 v[72:75],v0,s[4:7],s57 offen
s_waitcnt vmcnt(9)
s_add_u32 s57,s56,3538944
buffer_load_dwordx4 v[72:75],v0,s[4:7],s57 offen
s_waitcnt vmcnt(9)
s_add_u32 s57,s56,3670016
buffer_load_dwordx4 v[72:75],v0,s[4:7],s57 offen
s_waitcnt vmcnt(9)
s_add_u32 s57,s56,3801088
buffer_load_dwordx4 v[72:75],v0,s[4:7],s57 offen
s_waitcnt vmcnt(9)
s_add_u32 s57,s56,3932160
buffer_load_dwordx4 v[72:75],v0,s[4:7],s57 offen
s_waitcnt vmcnt(9)
s_add_u32 s57,s56,4063232
buffer_load_dwordx4 v[72:75],v0,s[4:7],s57 offen
s_mov_b32 s4,s20
s_mov_b32 s5,s21
s_mov_b32 s6,4194304
s_mov_b32 s7,0x20000
s_waitcnt vmcnt(9)
s_add_u32 s57,s56,0
buffer_load_dwordx4 v[72:75],v0,s[4:7],s57 offen
s_waitcnt vmcnt(9)
s_add_u32 s57,s56,131072
buffer_load_dwordx4 v[72:75],v0,s[4:7],s57 offen
s_waitcnt vmcnt(9)
s_add_u32 s57,s56,262144
buffer_load_dwordx4 v[72:75],v0,s[4:7],s57 offen
s_waitcnt vmcnt(9)
s_add_u32 s57,s56,393216
buffer_load_dwordx4 v[72:75],v0,s[4:7],s57 offen
s_waitcnt vmcnt(9)
s_add_u32 s57,s56,524288
buffer_load_dwordx4 v[72:75],v0,s[4:7],s57 offen
s_waitcnt vmcnt(9)
s_add_u32 s57,s56,655360
buffer_load_dwordx4 v[72:75],v0,s[4:7],s57 offen
s_waitcnt vmcnt(9)
s_add_u32 s57,s56,786432
buffer_load_dwordx4 v[72:75],v0,s[4:7],s57 offen
s_waitcnt vmcnt(9)
s_add_u32 s57,s56,917504
buffer_load_dwordx4 v[72:75],v0,s[4:7],s57 offen
s_waitcnt vmcnt(9)
s_add_u32 s57,s56,1048576
buffer_load_dwordx4 v[72:75],v0,s[4:7],s57 offen
s_waitcnt vmcnt(9)
s_add_u32 s57,s56,1179648
buffer_load_dwordx4 v[72:75],v0,s[4:7],s57 offen
s_waitcnt vmcnt(9)
s_add_u32 s57,s56,1310720
buffer_load_dwordx4 v[72:75],v0,s[4:7],s57 offen
s_waitcnt vmcnt(9)
s_add_u32 s57,s56,1441792
buffer_load_dwordx4 v[72:75],v0,s[4:7],s57 offen
s_waitcnt vmcnt(9)
s_add_u32 s57,s56,1572864
buffer_load_dwordx4 v[72:75],v0,s[4:7],s57 offen
s_waitcnt vmcnt(9)
s_add_u32 s57,s56,1703936
buffer_load_dwordx4 v[72:75],v0,s[4:7],s57 offen
s_waitcnt vmcnt(9)
s_add_u32 s57,s56,1835008
buffer_load_dwordx4 v[72:75],v0,s[4:7],s57 offen
s_waitcnt vmcnt(9)
s_add_u32 s57,s56,1966080
buffer_load_dwordx4 v[72:75],v0,s[4:7],s57 offen
s_waitcnt vmcnt(9)
s_add_u32 s57,s56,2097152
buffer_load_dwordx4 v[72:75],v0,s[4:7],s57 offen
s_waitcnt vmcnt(9)
s_add_u32 s57,s56,2228224
buffer_load_dwordx4 v[72:75],v0,s[4:7],s57 offen
s_waitcnt vmcnt(9)
s_add_u32 s57,s56,2359296
buffer_load_dwordx4 v[72:75],v0,s[4:7],s57 offen
s_waitcnt vmcnt(9)
s_add_u32 s57,s56,2490368
buffer_load_dwordx4 v[72:75],v0,s[4:7],s57 offen
s_waitcnt vmcnt(9)
s_add_u32 s57,s56,2621440
buffer_load_dwordx4 v[72:75],v0,s[4:7],s57 offen
s_waitcnt vmcnt(9)
s_add_u32 s57,s56,2752512
buffer_load_dwordx4 v[72:75],v0,s[4:7],s57 offen
s_waitcnt vmcnt(9)
s_add_u32 s57,s56,2883584
buffer_load_dwordx4 v[72:75],v0,s[4:7],s57 offen
s_waitcnt vmcnt(9)
s_add_u32 s57,s56,3014656
buffer_load_dwordx4 v[72:75],v0,s[4:7],s57 offen
s_waitcnt vmcnt(9)
s_add_u32 s57,s56,3145728
buffer_load_dwordx4 v[72:75],v0,s[4:7],s57 offen
s_waitcnt vmcnt(9)
s_add_u32 s57,s56,3276800
buffer_load_dwordx4 v[72:75],v0,s[4:7],s57 offen
s_waitcnt vmcnt(9)
s_add_u32 s57,s56,3407872
buffer_load_dwordx4 v[72:75],v0,s[4:7],s57 offen
s_waitcnt vmcnt(9)
s_add_u32 s57,s56,3538944
buffer_load_dwordx4 v[72:75],v0,s[4:7],s57 offen
s_waitcnt vmcnt(9)
s_add_u32 s57,s56,3670016
buffer_load_dwordx4 v[72:75],v0,s[4:7],s57 offen
s_waitcnt vmcnt(9)
s_add_u32 s57,s56,3801088
buffer_load_dwordx4 v[72:75],v0,s[4:7],s57 offen
s_waitcnt vmcnt(9)
s_add_u32 s57,s56,3932160
buffer_load_dwordx4 v[72:75],v0,s[4:7],s57 offen
s_waitcnt vmcnt(9)
s_add_u32 s57,s56,4063232
buffer_load_dwordx4 v[72:75],v0,s[4:7],s57 offen
L_rb_7:
s_mov_b32 s4,s26
s_mov_b32 s5,s27
s_mov_b32 s6,4194304
s_mov_b32 s7,0x20000
v_and_b32 v2,15,v1
v_lshlrev_b32 v2,4,v2
v_lshrrev_b32 v3,4,v1
v_lshl_add_u32 v2,v3,13,v2
s_and_b32 s56,s47,15
s_lshl_b32 s56,s56,18
s_lshl_b32 s57,s46,8
s_add_u32 s56,s56,s57
s_mov_b32 s61,0x05040100
s_mov_b32 s62,0x07060302
s_add_u32 s57,s56,0
buffer_load_dwordx4 v[24:27],v2,s[4:7],s57 offen offset:0
buffer_load_dwordx4 v[28:31],v2,s[4:7],s57 offen offset:1024
buffer_load_dwordx4 v[32:35],v2,s[4:7],s57 offen offset:2048
buffer_load_dwordx4 v[36:39],v2,s[4:7],s57 offen offset:3072
s_add_u32 s57,s56,4096
buffer_load_dwordx4 v[40:43],v2,s[4:7],s57 offen offset:0
buffer_load_dwordx4 v[44:47],v2,s[4:7],s57 offen offset:1024
buffer_load_dwordx4 v[48:51],v2,s[4:7],s57 offen offset:2048
buffer_load_dwordx4 v[52:55],v2,s[4:7],s57 offen offset:3072
s_add_u32 s57,s56,32768
buffer_load_dwordx4 v[56:59],v2,s[4:7],s57 offen offset:0
buffer_load_dwordx4 v[60:63],v2,s[4:7],s57 offen offset:1024
buffer_load_dwordx4 v[64:67],v2,s[4:7],s57 offen offset:2048
buffer_load_dwordx4 v[68:71],v2,s[4:7],s57 offen offset:3072
s_add_u32 s57,s56,36864
buffer_load_dwordx4 v[72:75],v2,s[4:7],s57 offen offset:0
buffer_load_dwordx4 v[76:79],v2,s[4:7],s57 offen offset:1024
buffer_load_dwordx4 v[80:83],v2,s[4:7],s57 offen offset:2048
buffer_load_dwordx4 v[84:87],v2,s[4:7],s57 offen offset:3072
s_add_u32 s57,s56,65536
buffer_load_dwordx4 v[88:91],v2,s[4:7],s57 offen offset:0
buffer_load_dwordx4 v[92:95],v2,s[4:7],s57 offen offset:1024
buffer_load_dwordx4 v[96:99],v2,s[4:7],s57 offen offset:2048
buffer_load_dwordx4 v[100:103],v2,s[4:7],s57 offen offset:3072
s_add_u32 s57,s56,69632
buffer_load_dwordx4 v[104:107],v2,s[4:7],s57 offen offset:0
buffer_load_dwordx4 v[108:111],v2,s[4:7],s57 offen offset:1024
buffer_load_dwordx4 v[112:115],v2,s[4:7],s57 offen offset:2048
buffer_load_dwordx4 v[116:119],v2,s[4:7],s57 offen offset:3072
s_add_u32 s57,s56,98304
buffer_load_dwordx4 v[120:123],v2,s[4:7],s57 offen offset:0
buffer_load_dwordx4 v[124:127],v2,s[4:7],s57 offen offset:1024
buffer_load_dwordx4 v[128:131],v2,s[4:7],s57 offen offset:2048
buffer_load_dwordx4 v[132:135],v2,s[4:7],s57 offen offset:3072
s_add_u32 s57,s56,102400
buffer_load_dwordx4 v[136:139],v2,s[4:7],s57 offen offset:0
buffer_load_dwordx4 v[140:143],v2,s[4:7],s57 offen offset:1024
buffer_load_dwordx4 v[144:147],v2,s[4:7],s57 offen offset:2048
buffer_load_dwordx4 v[148:151],v2,s[4:7],s57 offen offset:3072
s_add_u32 s57,s56,131072
buffer_load_dwordx4 v[152:155],v2,s[4:7],s57 offen offset:0
buffer_load_dwordx4 v[156:159],v2,s[4:7],s57 offen offset:1024
buffer_load_dwordx4 v[160:163],v2,s[4:7],s57 offen offset:2048
buffer_load_dwordx4 v[164:167],v2,s[4:7],s57 offen offset:3072
s_add_u32 s57,s56,135168
buffer_load_dwordx4 v[168:171],v2,s[4:7],s57 offen offset:0
buffer_load_dwordx4 v[172:175],v2,s[4:7],s57 offen offset:1024
buffer_load_dwordx4 v[176:179],v2,s[4:7],s57 offen offset:2048
buffer_load_dwordx4 v[180:183],v2,s[4:7],s57 offen offset:3072
s_add_u32 s57,s56,163840
buffer_load_dwordx4 v[184:187],v2,s[4:7],s57 offen offset:0
buffer_load_dwordx4 v[188:191],v2,s[4:7],s57 offen offset:1024
buffer_load_dwordx4 v[192:195],v2,s[4:7],s57 offen offset:2048
buffer_load_dwordx4 v[196:199],v2,s[4:7],s57 offen offset:3072
s_add_u32 s57,s56,167936
buffer_load_dwordx4 v[200:203],v2,s[4:7],s57 offen offset:0
buffer_load_dwordx4 v[204:207],v2,s[4:7],s57 offen offset:1024
buffer_load_dwordx4 v[208:211],v2,s[4:7],s57 offen offset:2048
buffer_load_dwordx4 v[212:215],v2,s[4:7],s57 offen offset:3072
s_waitcnt vmcnt(40)
v_perm_b32 v216,v28,v24,s61
v_perm_b32 v217,v36,v32,s61
v_perm_b32 v218,v44,v40,s61
v_perm_b32 v219,v52,v48,s61
v_accvgpr_write_b32 a0,v216
v_accvgpr_write_b32 a1,v217
v_accvgpr_write_b32 a2,v218
v_accvgpr_write_b32 a3,v219
v_perm_b32 v216,v28,v24,s62
v_perm_b32 v217,v36,v32,s62
v_perm_b32 v218,v44,v40,s62
v_perm_b32 v219,v52,v48,s62
v_accvgpr_write_b32 a4,v216
v_accvgpr_write_b32 a5,v217
v_accvgpr_write_b32 a6,v218
v_accvgpr_write_b32 a7,v219
v_perm_b32 v216,v29,v25,s61
v_perm_b32 v217,v37,v33,s61
v_perm_b32 v218,v45,v41,s61
v_perm_b32 v219,v53,v49,s61
v_accvgpr_write_b32 a8,v216
v_accvgpr_write_b32 a9,v217
v_accvgpr_write_b32 a10,v218
v_accvgpr_write_b32 a11,v219
v_perm_b32 v216,v29,v25,s62
v_perm_b32 v217,v37,v33,s62
v_perm_b32 v218,v45,v41,s62
v_perm_b32 v219,v53,v49,s62
v_accvgpr_write_b32 a12,v216
v_accvgpr_write_b32 a13,v217
v_accvgpr_write_b32 a14,v218
v_accvgpr_write_b32 a15,v219
v_perm_b32 v216,v30,v26,s61
v_perm_b32 v217,v38,v34,s61
v_perm_b32 v218,v46,v42,s61
v_perm_b32 v219,v54,v50,s61
v_accvgpr_write_b32 a16,v216
v_accvgpr_write_b32 a17,v217
v_accvgpr_write_b32 a18,v218
v_accvgpr_write_b32 a19,v219
v_perm_b32 v216,v30,v26,s62
v_perm_b32 v217,v38,v34,s62
v_perm_b32 v218,v46,v42,s62
v_perm_b32 v219,v54,v50,s62
v_accvgpr_write_b32 a20,v216
v_accvgpr_write_b32 a21,v217
v_accvgpr_write_b32 a22,v218
v_accvgpr_write_b32 a23,v219
v_perm_b32 v216,v31,v27,s61
v_perm_b32 v217,v39,v35,s61
v_perm_b32 v218,v47,v43,s61
v_perm_b32 v219,v55,v51,s61
v_accvgpr_write_b32 a24,v216
v_accvgpr_write_b32 a25,v217
v_accvgpr_write_b32 a26,v218
v_accvgpr_write_b32 a27,v219
v_perm_b32 v216,v31,v27,s62
v_perm_b32 v217,v39,v35,s62
v_perm_b32 v218,v47,v43,s62
v_perm_b32 v219,v55,v51,s62
v_accvgpr_write_b32 a28,v216
v_accvgpr_write_b32 a29,v217
v_accvgpr_write_b32 a30,v218
v_accvgpr_write_b32 a31,v219
s_add_u32 s57,s56,196608
buffer_load_dwordx4 v[24:27],v2,s[4:7],s57 offen offset:0
buffer_load_dwordx4 v[28:31],v2,s[4:7],s57 offen offset:1024
buffer_load_dwordx4 v[32:35],v2,s[4:7],s57 offen offset:2048
buffer_load_dwordx4 v[36:39],v2,s[4:7],s57 offen offset:3072
s_add_u32 s57,s56,200704
buffer_load_dwordx4 v[40:43],v2,s[4:7],s57 offen offset:0
buffer_load_dwordx4 v[44:47],v2,s[4:7],s57 offen offset:1024
buffer_load_dwordx4 v[48:51],v2,s[4:7],s57 offen offset:2048
buffer_load_dwordx4 v[52:55],v2,s[4:7],s57 offen offset:3072
s_barrier
s_cmp_lg_u32 s46,0
s_cbranch_scc1 L_ar_76
v_mov_b32 v8,240
v_mov_b32 v9,s53
s_mov_b64 exec,1
buffer_atomic_add v9,v8,s[12:15],0 offen
s_mov_b64 exec,-1
L_ar_76:
s_mov_b32 s53,0
s_waitcnt vmcnt(40)
v_perm_b32 v216,v60,v56,s61
v_perm_b32 v217,v68,v64,s61
v_perm_b32 v218,v76,v72,s61
v_perm_b32 v219,v84,v80,s61
v_accvgpr_write_b32 a32,v216
v_accvgpr_write_b32 a33,v217
v_accvgpr_write_b32 a34,v218
v_accvgpr_write_b32 a35,v219
v_perm_b32 v216,v60,v56,s62
v_perm_b32 v217,v68,v64,s62
v_perm_b32 v218,v76,v72,s62
v_perm_b32 v219,v84,v80,s62
v_accvgpr_write_b32 a36,v216
v_accvgpr_write_b32 a37,v217
v_accvgpr_write_b32 a38,v218
v_accvgpr_write_b32 a39,v219
v_perm_b32 v216,v61,v57,s61
v_perm_b32 v217,v69,v65,s61
v_perm_b32 v218,v77,v73,s61
v_perm_b32 v219,v85,v81,s61
v_accvgpr_write_b32 a40,v216
v_accvgpr_write_b32 a41,v217
v_accvgpr_write_b32 a42,v218
v_accvgpr_write_b32 a43,v219
v_perm_b32 v216,v61,v57,s62
v_perm_b32 v217,v69,v65,s62
v_perm_b32 v218,v77,v73,s62
v_perm_b32 v219,v85,v81,s62
v_accvgpr_write_b32 a44,v216
v_accvgpr_write_b32 a45,v217
v_accvgpr_write_b32 a46,v218
v_accvgpr_write_b32 a47,v219
v_perm_b32 v216,v62,v58,s61
v_perm_b32 v217,v70,v66,s61
v_perm_b32 v218,v78,v74,s61
v_perm_b32 v219,v86,v82,s61
v_accvgpr_write_b32 a48,v216
v_accvgpr_write_b32 a49,v217
v_accvgpr_write_b32 a50,v218
v_accvgpr_write_b32 a51,v219
v_perm_b32 v216,v62,v58,s62
v_perm_b32 v217,v70,v66,s62
v_perm_b32 v218,v78,v74,s62
v_perm_b32 v219,v86,v82,s62
v_accvgpr_write_b32 a52,v216
v_accvgpr_write_b32 a53,v217
v_accvgpr_write_b32 a54,v218
v_accvgpr_write_b32 a55,v219
v_perm_b32 v216,v63,v59,s61
v_perm_b32 v217,v71,v67,s61
v_perm_b32 v218,v79,v75,s61
v_perm_b32 v219,v87,v83,s61
v_accvgpr_write_b32 a56,v216
v_accvgpr_write_b32 a57,v217
v_accvgpr_write_b32 a58,v218
v_accvgpr_write_b32 a59,v219
v_perm_b32 v216,v63,v59,s62
v_perm_b32 v217,v71,v67,s62
v_perm_b32 v218,v79,v75,s62
v_perm_b32 v219,v87,v83,s62
v_accvgpr_write_b32 a60,v216
v_accvgpr_write_b32 a61,v217
v_accvgpr_write_b32 a62,v218
v_accvgpr_write_b32 a63,v219
s_add_u32 s57,s56,229376
buffer_load_dwordx4 v[56:59],v2,s[4:7],s57 offen offset:0
buffer_load_dwordx4 v[60:63],v2,s[4:7],s57 offen offset:1024
buffer_load_dwordx4 v[64:67],v2,s[4:7],s57 offen offset:2048
buffer_load_dwordx4 v[68:71],v2,s[4:7],s57 offen offset:3072
s_add_u32 s57,s56,233472
buffer_load_dwordx4 v[72:75],v2,s[4:7],s57 offen offset:0
buffer_load_dwordx4 v[76:79],v2,s[4:7],s57 offen offset:1024
buffer_load_dwordx4 v[80:83],v2,s[4:7],s57 offen offset:2048
buffer_load_dwordx4 v[84:87],v2,s[4:7],s57 offen offset:3072
s_waitcnt vmcnt(40)
v_perm_b32 v216,v92,v88,s61
v_perm_b32 v217,v100,v96,s61
v_perm_b32 v218,v108,v104,s61
v_perm_b32 v219,v116,v112,s61
v_accvgpr_write_b32 a64,v216
v_accvgpr_write_b32 a65,v217
v_accvgpr_write_b32 a66,v218
v_accvgpr_write_b32 a67,v219
v_perm_b32 v216,v92,v88,s62
v_perm_b32 v217,v100,v96,s62
v_perm_b32 v218,v108,v104,s62
v_perm_b32 v219,v116,v112,s62
v_accvgpr_write_b32 a68,v216
v_accvgpr_write_b32 a69,v217
v_accvgpr_write_b32 a70,v218
v_accvgpr_write_b32 a71,v219
v_perm_b32 v216,v93,v89,s61
v_perm_b32 v217,v101,v97,s61
v_perm_b32 v218,v109,v105,s61
v_perm_b32 v219,v117,v113,s61
v_accvgpr_write_b32 a72,v216
v_accvgpr_write_b32 a73,v217
v_accvgpr_write_b32 a74,v218
v_accvgpr_write_b32 a75,v219
v_perm_b32 v216,v93,v89,s62
v_perm_b32 v217,v101,v97,s62
v_perm_b32 v218,v109,v105,s62
v_perm_b32 v219,v117,v113,s62
v_accvgpr_write_b32 a76,v216
v_accvgpr_write_b32 a77,v217
v_accvgpr_write_b32 a78,v218
v_accvgpr_write_b32 a79,v219
v_perm_b32 v216,v94,v90,s61
v_perm_b32 v217,v102,v98,s61
v_perm_b32 v218,v110,v106,s61
v_perm_b32 v219,v118,v114,s61
v_accvgpr_write_b32 a80,v216
v_accvgpr_write_b32 a81,v217
v_accvgpr_write_b32 a82,v218
v_accvgpr_write_b32 a83,v219
v_perm_b32 v216,v94,v90,s62
v_perm_b32 v217,v102,v98,s62
v_perm_b32 v218,v110,v106,s62
v_perm_b32 v219,v118,v114,s62
v_accvgpr_write_b32 a84,v216
v_accvgpr_write_b32 a85,v217
v_accvgpr_write_b32 a86,v218
v_accvgpr_write_b32 a87,v219
v_perm_b32 v216,v95,v91,s61
v_perm_b32 v217,v103,v99,s61
v_perm_b32 v218,v111,v107,s61
v_perm_b32 v219,v119,v115,s61
v_accvgpr_write_b32 a88,v216
v_accvgpr_write_b32 a89,v217
v_accvgpr_write_b32 a90,v218
v_accvgpr_write_b32 a91,v219
v_perm_b32 v216,v95,v91,s62
v_perm_b32 v217,v103,v99,s62
v_perm_b32 v218,v111,v107,s62
v_perm_b32 v219,v119,v115,s62
v_accvgpr_write_b32 a92,v216
v_accvgpr_write_b32 a93,v217
v_accvgpr_write_b32 a94,v218
v_accvgpr_write_b32 a95,v219
s_waitcnt vmcnt(32)
v_perm_b32 v216,v124,v120,s61
v_perm_b32 v217,v132,v128,s61
v_perm_b32 v218,v140,v136,s61
v_perm_b32 v219,v148,v144,s61
v_accvgpr_write_b32 a96,v216
v_accvgpr_write_b32 a97,v217
v_accvgpr_write_b32 a98,v218
v_accvgpr_write_b32 a99,v219
v_perm_b32 v216,v124,v120,s62
v_perm_b32 v217,v132,v128,s62
v_perm_b32 v218,v140,v136,s62
v_perm_b32 v219,v148,v144,s62
v_accvgpr_write_b32 a100,v216
v_accvgpr_write_b32 a101,v217
v_accvgpr_write_b32 a102,v218
v_accvgpr_write_b32 a103,v219
v_perm_b32 v216,v125,v121,s61
v_perm_b32 v217,v133,v129,s61
v_perm_b32 v218,v141,v137,s61
v_perm_b32 v219,v149,v145,s61
v_accvgpr_write_b32 a104,v216
v_accvgpr_write_b32 a105,v217
v_accvgpr_write_b32 a106,v218
v_accvgpr_write_b32 a107,v219
v_perm_b32 v216,v125,v121,s62
v_perm_b32 v217,v133,v129,s62
v_perm_b32 v218,v141,v137,s62
v_perm_b32 v219,v149,v145,s62
v_accvgpr_write_b32 a108,v216
v_accvgpr_write_b32 a109,v217
v_accvgpr_write_b32 a110,v218
v_accvgpr_write_b32 a111,v219
v_perm_b32 v216,v126,v122,s61
v_perm_b32 v217,v134,v130,s61
v_perm_b32 v218,v142,v138,s61
v_perm_b32 v219,v150,v146,s61
v_accvgpr_write_b32 a112,v216
v_accvgpr_write_b32 a113,v217
v_accvgpr_write_b32 a114,v218
v_accvgpr_write_b32 a115,v219
v_perm_b32 v216,v126,v122,s62
v_perm_b32 v217,v134,v130,s62
v_perm_b32 v218,v142,v138,s62
v_perm_b32 v219,v150,v146,s62
v_accvgpr_write_b32 a116,v216
v_accvgpr_write_b32 a117,v217
v_accvgpr_write_b32 a118,v218
v_accvgpr_write_b32 a119,v219
v_perm_b32 v216,v127,v123,s61
v_perm_b32 v217,v135,v131,s61
v_perm_b32 v218,v143,v139,s61
v_perm_b32 v219,v151,v147,s61
v_accvgpr_write_b32 a120,v216
v_accvgpr_write_b32 a121,v217
v_accvgpr_write_b32 a122,v218
v_accvgpr_write_b32 a123,v219
v_perm_b32 v216,v127,v123,s62
v_perm_b32 v217,v135,v131,s62
v_perm_b32 v218,v143,v139,s62
v_perm_b32 v219,v151,v147,s62
v_accvgpr_write_b32 a124,v216
v_accvgpr_write_b32 a125,v217
v_accvgpr_write_b32 a126,v218
v_accvgpr_write_b32 a127,v219
s_waitcnt vmcnt(24)
v_perm_b32 v216,v156,v152,s61
v_perm_b32 v217,v164,v160,s61
v_perm_b32 v218,v172,v168,s61
v_perm_b32 v219,v180,v176,s61
v_accvgpr_write_b32 a128,v216
v_accvgpr_write_b32 a129,v217
v_accvgpr_write_b32 a130,v218
v_accvgpr_write_b32 a131,v219
v_perm_b32 v216,v156,v152,s62
v_perm_b32 v217,v164,v160,s62
v_perm_b32 v218,v172,v168,s62
v_perm_b32 v219,v180,v176,s62
v_accvgpr_write_b32 a132,v216
v_accvgpr_write_b32 a133,v217
v_accvgpr_write_b32 a134,v218
v_accvgpr_write_b32 a135,v219
v_perm_b32 v216,v157,v153,s61
v_perm_b32 v217,v165,v161,s61
v_perm_b32 v218,v173,v169,s61
v_perm_b32 v219,v181,v177,s61
v_accvgpr_write_b32 a136,v216
v_accvgpr_write_b32 a137,v217
v_accvgpr_write_b32 a138,v218
v_accvgpr_write_b32 a139,v219
v_perm_b32 v216,v157,v153,s62
v_perm_b32 v217,v165,v161,s62
v_perm_b32 v218,v173,v169,s62
v_perm_b32 v219,v181,v177,s62
v_accvgpr_write_b32 a140,v216
v_accvgpr_write_b32 a141,v217
v_accvgpr_write_b32 a142,v218
v_accvgpr_write_b32 a143,v219
v_perm_b32 v216,v158,v154,s61
v_perm_b32 v217,v166,v162,s61
v_perm_b32 v218,v174,v170,s61
v_perm_b32 v219,v182,v178,s61
v_accvgpr_write_b32 a144,v216
v_accvgpr_write_b32 a145,v217
v_accvgpr_write_b32 a146,v218
v_accvgpr_write_b32 a147,v219
v_perm_b32 v216,v158,v154,s62
v_perm_b32 v217,v166,v162,s62
v_perm_b32 v218,v174,v170,s62
v_perm_b32 v219,v182,v178,s62
v_accvgpr_write_b32 a148,v216
v_accvgpr_write_b32 a149,v217
v_accvgpr_write_b32 a150,v218
v_accvgpr_write_b32 a151,v219
v_perm_b32 v216,v159,v155,s61
v_perm_b32 v217,v167,v163,s61
v_perm_b32 v218,v175,v171,s61
v_perm_b32 v219,v183,v179,s61
v_accvgpr_write_b32 a152,v216
v_accvgpr_write_b32 a153,v217
v_accvgpr_write_b32 a154,v218
v_accvgpr_write_b32 a155,v219
v_perm_b32 v216,v159,v155,s62
v_perm_b32 v217,v167,v163,s62
v_perm_b32 v218,v175,v171,s62
v_perm_b32 v219,v183,v179,s62
v_accvgpr_write_b32 a156,v216
v_accvgpr_write_b32 a157,v217
v_accvgpr_write_b32 a158,v218
v_accvgpr_write_b32 a159,v219
s_waitcnt vmcnt(16)
v_perm_b32 v216,v188,v184,s61
v_perm_b32 v217,v196,v192,s61
v_perm_b32 v218,v204,v200,s61
v_perm_b32 v219,v212,v208,s61
v_accvgpr_write_b32 a160,v216
v_accvgpr_write_b32 a161,v217
v_accvgpr_write_b32 a162,v218
v_accvgpr_write_b32 a163,v219
v_perm_b32 v216,v188,v184,s62
v_perm_b32 v217,v196,v192,s62
v_perm_b32 v218,v204,v200,s62
v_perm_b32 v219,v212,v208,s62
v_accvgpr_write_b32 a164,v216
v_accvgpr_write_b32 a165,v217
v_accvgpr_write_b32 a166,v218
v_accvgpr_write_b32 a167,v219
v_perm_b32 v216,v189,v185,s61
v_perm_b32 v217,v197,v193,s61
v_perm_b32 v218,v205,v201,s61
v_perm_b32 v219,v213,v209,s61
v_accvgpr_write_b32 a168,v216
v_accvgpr_write_b32 a169,v217
v_accvgpr_write_b32 a170,v218
v_accvgpr_write_b32 a171,v219
v_perm_b32 v216,v189,v185,s62
v_perm_b32 v217,v197,v193,s62
v_perm_b32 v218,v205,v201,s62
v_perm_b32 v219,v213,v209,s62
v_accvgpr_write_b32 a172,v216
v_accvgpr_write_b32 a173,v217
v_accvgpr_write_b32 a174,v218
v_accvgpr_write_b32 a175,v219
v_perm_b32 v216,v190,v186,s61
v_perm_b32 v217,v198,v194,s61
v_perm_b32 v218,v206,v202,s61
v_perm_b32 v219,v214,v210,s61
v_accvgpr_write_b32 a176,v216
v_accvgpr_write_b32 a177,v217
v_accvgpr_write_b32 a178,v218
v_accvgpr_write_b32 a179,v219
v_perm_b32 v216,v190,v186,s62
v_perm_b32 v217,v198,v194,s62
v_perm_b32 v218,v206,v202,s62
v_perm_b32 v219,v214,v210,s62
v_accvgpr_write_b32 a180,v216
v_accvgpr_write_b32 a181,v217
v_accvgpr_write_b32 a182,v218
v_accvgpr_write_b32 a183,v219
v_perm_b32 v216,v191,v187,s61
v_perm_b32 v217,v199,v195,s61
v_perm_b32 v218,v207,v203,s61
v_perm_b32 v219,v215,v211,s61
v_accvgpr_write_b32 a184,v216
v_accvgpr_write_b32 a185,v217
v_accvgpr_write_b32 a186,v218
v_accvgpr_write_b32 a187,v219
v_perm_b32 v216,v191,v187,s62
v_perm_b32 v217,v199,v195,s62
v_perm_b32 v218,v207,v203,s62
v_perm_b32 v219,v215,v211,s62
v_accvgpr_write_b32 a188,v216
v_accvgpr_write_b32 a189,v217
v_accvgpr_write_b32 a190,v218
v_accvgpr_write_b32 a191,v219
s_waitcnt vmcnt(8)
v_perm_b32 v216,v28,v24,s61
v_perm_b32 v217,v36,v32,s61
v_perm_b32 v218,v44,v40,s61
v_perm_b32 v219,v52,v48,s61
v_accvgpr_write_b32 a192,v216
v_accvgpr_write_b32 a193,v217
v_accvgpr_write_b32 a194,v218
v_accvgpr_write_b32 a195,v219
v_perm_b32 v216,v28,v24,s62
v_perm_b32 v217,v36,v32,s62
v_perm_b32 v218,v44,v40,s62
v_perm_b32 v219,v52,v48,s62
v_accvgpr_write_b32 a196,v216
v_accvgpr_write_b32 a197,v217
v_accvgpr_write_b32 a198,v218
v_accvgpr_write_b32 a199,v219
v_perm_b32 v216,v29,v25,s61
v_perm_b32 v217,v37,v33,s61
v_perm_b32 v218,v45,v41,s61
v_perm_b32 v219,v53,v49,s61
v_accvgpr_write_b32 a200,v216
v_accvgpr_write_b32 a201,v217
v_accvgpr_write_b32 a202,v218
v_accvgpr_write_b32 a203,v219
v_perm_b32 v216,v29,v25,s62
v_perm_b32 v217,v37,v33,s62
v_perm_b32 v218,v45,v41,s62
v_perm_b32 v219,v53,v49,s62
v_accvgpr_write_b32 a204,v216
v_accvgpr_write_b32 a205,v217
v_accvgpr_write_b32 a206,v218
v_accvgpr_write_b32 a207,v219
v_perm_b32 v216,v30,v26,s61
v_perm_b32 v217,v38,v34,s61
v_perm_b32 v218,v46,v42,s61
v_perm_b32 v219,v54,v50,s61
v_accvgpr_write_b32 a208,v216
v_accvgpr_write_b32 a209,v217
v_accvgpr_write_b32 a210,v218
v_accvgpr_write_b32 a211,v219
v_perm_b32 v216,v30,v26,s62
v_perm_b32 v217,v38,v34,s62
v_perm_b32 v218,v46,v42,s62
v_perm_b32 v219,v54,v50,s62
v_accvgpr_write_b32 a212,v216
v_accvgpr_write_b32 a213,v217
v_accvgpr_write_b32 a214,v218
v_accvgpr_write_b32 a215,v219
v_perm_b32 v216,v31,v27,s61
v_perm_b32 v217,v39,v35,s61
v_perm_b32 v218,v47,v43,s61
v_perm_b32 v219,v55,v51,s61
v_accvgpr_write_b32 a216,v216
v_accvgpr_write_b32 a217,v217
v_accvgpr_write_b32 a218,v218
v_accvgpr_write_b32 a219,v219
v_perm_b32 v216,v31,v27,s62
v_perm_b32 v217,v39,v35,s62
v_perm_b32 v218,v47,v43,s62
v_perm_b32 v219,v55,v51,s62
v_accvgpr_write_b32 a220,v216
v_accvgpr_write_b32 a221,v217
v_accvgpr_write_b32 a222,v218
v_accvgpr_write_b32 a223,v219
s_waitcnt vmcnt(0)
v_perm_b32 v216,v60,v56,s61
v_perm_b32 v217,v68,v64,s61
v_perm_b32 v218,v76,v72,s61
v_perm_b32 v219,v84,v80,s61
v_accvgpr_write_b32 a224,v216
v_accvgpr_write_b32 a225,v217
v_accvgpr_write_b32 a226,v218
v_accvgpr_write_b32 a227,v219
v_perm_b32 v216,v60,v56,s62
v_perm_b32 v217,v68,v64,s62
v_perm_b32 v218,v76,v72,s62
v_perm_b32 v219,v84,v80,s62
v_accvgpr_write_b32 a228,v216
v_accvgpr_write_b32 a229,v217
v_accvgpr_write_b32 a230,v218
v_accvgpr_write_b32 a231,v219
v_perm_b32 v216,v61,v57,s61
v_perm_b32 v217,v69,v65,s61
v_perm_b32 v218,v77,v73,s61
v_perm_b32 v219,v85,v81,s61
v_accvgpr_write_b32 a232,v216
v_accvgpr_write_b32 a233,v217
v_accvgpr_write_b32 a234,v218
v_accvgpr_write_b32 a235,v219
v_perm_b32 v216,v61,v57,s62
v_perm_b32 v217,v69,v65,s62
v_perm_b32 v218,v77,v73,s62
v_perm_b32 v219,v85,v81,s62
v_accvgpr_write_b32 a236,v216
v_accvgpr_write_b32 a237,v217
v_accvgpr_write_b32 a238,v218
v_accvgpr_write_b32 a239,v219
v_perm_b32 v216,v62,v58,s61
v_perm_b32 v217,v70,v66,s61
v_perm_b32 v218,v78,v74,s61
v_perm_b32 v219,v86,v82,s61
v_accvgpr_write_b32 a240,v216
v_accvgpr_write_b32 a241,v217
v_accvgpr_write_b32 a242,v218
v_accvgpr_write_b32 a243,v219
v_perm_b32 v216,v62,v58,s62
v_perm_b32 v217,v70,v66,s62
v_perm_b32 v218,v78,v74,s62
v_perm_b32 v219,v86,v82,s62
v_accvgpr_write_b32 a244,v216
v_accvgpr_write_b32 a245,v217
v_accvgpr_write_b32 a246,v218
v_accvgpr_write_b32 a247,v219
v_perm_b32 v216,v63,v59,s61
v_perm_b32 v217,v71,v67,s61
v_perm_b32 v218,v79,v75,s61
v_perm_b32 v219,v87,v83,s61
v_accvgpr_write_b32 a248,v216
v_accvgpr_write_b32 a249,v217
v_accvgpr_write_b32 a250,v218
v_accvgpr_write_b32 a251,v219
v_perm_b32 v216,v63,v59,s62
v_perm_b32 v217,v71,v67,s62
v_perm_b32 v218,v79,v75,s62
v_perm_b32 v219,v87,v83,s62
v_accvgpr_write_b32 a252,v216
v_accvgpr_write_b32 a253,v217
v_accvgpr_write_b32 a254,v218
v_accvgpr_write_b32 a255,v219
v_mov_b32 v123,159744
s_cmp_lg_u32 s46,0
s_cbranch_scc1 L_gbd_78
v_mov_b32 v124,240
L_gb_77:
buffer_load_dword v125,v124,s[12:15],0 offen sc1
s_waitcnt vmcnt(0)
v_readfirstlane_b32 s56,v125
ds_write_b32 v123,v125
s_bitcmp1_b32 s56,8
s_cbranch_scc1 L_gbd_78
s_sleep 4
s_sub_u32 s49,s49,1
s_cmp_gt_i32 s49,0
s_cbranch_scc1 L_gb_77
s_branch L_abort
L_gbd_78:
s_waitcnt lgkmcnt(0)
s_barrier
ds_read_b32 v125,v123
s_waitcnt lgkmcnt(0)
v_readfirstlane_b32 s56,v125
s_barrier
s_lshr_b32 s56,s56,16
s_andn2_b32 s56,s56,s3
s_cbranch_scc1 L_spread
s_max_u32 s54,s48,5
s_sub_u32 s54,s54,5
s_lshl_b32 s54,s54,1
s_lshr_b32 s56,s47,4
s_add_u32 s54,s54,s56
s_cmp_lg_u32 s3,0
s_cbranch_scc1 L_wa
v_and_b32 v238,15,v1
v_and_b32 v239,1,v1
v_lshlrev_b32 v239,4,v239
v_mov_b32 v240,0x3f80
v_lshlrev_b32 v240,v239,v240
v_lshrrev_b32 v238,1,v238
v_cmp_eq_u32 vcc,0,v238
s_nop 1
v_cndmask_b32 v156,0,v240,vcc
v_cmp_eq_u32 vcc,1,v238
s_nop 1
v_cndmask_b32 v157,0,v240,vcc
v_cmp_eq_u32 vcc,2,v238
s_nop 1
v_cndmask_b32 v158,0,v240,vcc
v_cmp_eq_u32 vcc,3,v238
s_nop 1
v_cndmask_b32 v159,0,v240,vcc
s_mov_b32 s4,s32
s_mov_b32 s5,s33
s_mov_b32 s6,1024
s_mov_b32 s7,0x20000
buffer_load_dwordx4 v[224:227],v0,s[4:7],0 offen
v_and_b32 v238,15,v1
v_lshrrev_b32 v239,4,v1
v_lshlrev_b32 v240,2,v239
v_mov_b32 v241,0xf149f2ca
s_and_b32 s56,s46,1
s_lshl_b32 s56,s56,4
v_add_u32 v242,s56,v238
v_add_u32 v243,0,v240
v_cmp_gt_u32 vcc,v243,v242
s_nop 1
v_cndmask_b32 v8,0,v241,vcc
v_add_u32 v243,1,v240
v_cmp_gt_u32 vcc,v243,v242
s_nop 1
v_cndmask_b32 v9,0,v241,vcc
v_add_u32 v243,2,v240
v_cmp_gt_u32 vcc,v243,v242
s_nop 1
v_cndmask_b32 v10,0,v241,vcc
v_add_u32 v243,3,v240
v_cmp_gt_u32 vcc,v243,v242
s_nop 1
v_cndmask_b32 v11,0,v241,vcc
v_add_u32 v243,16,v240
v_cmp_gt_u32 vcc,v243,v242
s_nop 1
v_cndmask_b32 v12,0,v241,vcc
v_add_u32 v243,17,v240
v_cmp_gt_u32 vcc,v243,v242
s_nop 1
v_cndmask_b32 v13,0,v241,vcc
v_add_u32 v243,18,v240
v_cmp_gt_u32 vcc,v243,v242
s_nop 1
v_cndmask_b32 v14,0,v241,vcc
v_add_u32 v243,19,v240
v_cmp_gt_u32 vcc,v243,v242
s_nop 1
v_cndmask_b32 v15,0,v241,vcc
v_mov_b32 v152,s80
v_mov_b32 v145,0
v_mov_b32 v146,0
s_lshl_b32 s56,s46,12
s_add_u32 s56,s56,131072
v_add_u32 v3,s56,v0
v_add_u32 v4,131072,v0
s_lshl_b32 s56,s46,8
v_lshlrev_b32 v7,4,v238
v_add_u32 v7,s56,v7
v_lshl_add_u32 v5,v239,16,v7
v_lshlrev_b32 v6,1,v7
v_lshl_add_u32 v7,v239,10,v7
v_and_b32 v243,1,v239
v_lshl_add_u32 v6,v243,4,v6
v_lshrrev_b32 v243,1,v239
v_lshl_add_u32 v6,v243,12,v6
v_add_u32 v6,147456,v6
v_lshlrev_b32 v16,2,v1
v_lshlrev_b32 v21,3,v238
s_and_b32 s68,s47,15
s_lshl_b32 s56,s68,10
v_add_u32 v5,s56,v5
s_lshl_b32 s56,s68,15
v_add_u32 v7,s56,v7
s_lshl_b32 s69,s54,20
s_add_u32 s69,s69,20971520
s_lshl_b32 s87,s54,13
s_add_u32 s87,s87,10486272
s_lshl4_add_u32 s74,s68,s87
s_lshl2_add_u32 s74,s46,s74
s_lshl_b32 s68,s68,1
s_lshr_b32 s56,s46,1
s_add_u32 s68,s68,s56
s_mov_b32 s66,0
s_mov_b32 s67,0
s_mov_b32 s73,0x80000000
s_mov_b32 s75,0
s_mov_b32 s37,0
s_mov_b32 s42,4294966272
s_mov_b32 s43,4294967295
s_mov_b64 s[38:39],0
s_sub_u32 s36,s54,12
s_and_b32 s36,s36,3
s_mov_b32 s12,s40
s_mov_b32 s13,s41
s_mov_b32 s14,2097152
s_mov_b32 s15,0x20000
s_and_b32 s29,s46,1
s_mul_i32 s28,s29,12288
s_lshl_b32 s29,s29,11
s_and_b32 s56,s50,2048
s_lshl_b32 s56,s56,4
s_add_u32 s56,s56,65536
s_add_u32 s40,s56,s28
s_add_u32 s41,s56,s29
v_add_u32 v21,10487168,v21
v_mov_b32 v244,v21
s_and_b32 s56,s50,2048
s_add_u32 s56,s56,147456
v_lshlrev_b32 v23,5,v1
v_add_u32 v23,s56,v23
v_and_b32 v253,32,v0
v_lshrrev_b32 v245,2,v253
v_add_u32 v253,v253,v245
v_sub_u32 v253,v0,v253
v_add_u32 v253,8,v253
v_mov_b32 v254,0x80000000
s_mov_b32 s56,1408
v_writelane_b32 v254,s56,0
s_mov_b32 s56,256
v_writelane_b32 v254,s56,1
s_mov_b32 s56,1280
v_writelane_b32 v254,s56,2
v_mov_b32 v245,155648
s_lshl_b32 s56,s46,2
v_add_u32 v247,s56,v245
s_waitcnt vmcnt(0)
v_lshlrev_b32 v228,16,v224
v_and_b32 v229,0xffff0000,v224
v_lshlrev_b32 v230,16,v225
v_and_b32 v231,0xffff0000,v225
v_lshlrev_b32 v232,16,v226
v_and_b32 v233,0xffff0000,v226
v_lshlrev_b32 v234,16,v227
v_and_b32 v235,0xffff0000,v227
v_mul_f32 v255,v228,v228
v_fma_f32 v255,v229,v229,v255
v_fma_f32 v255,v230,v230,v255
v_fma_f32 v255,v231,v231,v255
v_fma_f32 v255,v232,v232,v255
v_fma_f32 v255,v233,v233,v255
v_fma_f32 v255,v234,v234,v255
v_fma_f32 v255,v235,v235,v255
s_nop 1
v_add_f32_dpp v255,v255,v255 row_ror:8 row_mask:0xf bank_mask:0xf
s_nop 1
v_add_f32_dpp v255,v255,v255 row_ror:4 row_mask:0xf bank_mask:0xf
s_nop 1
v_add_f32_dpp v255,v255,v255 row_ror:2 row_mask:0xf bank_mask:0xf
s_nop 1
v_add_f32_dpp v255,v255,v255 row_ror:1 row_mask:0xf bank_mask:0xf
v_mov_b32 v238,v255
s_nop 1
v_permlane16_swap_b32 v255,v238
v_add_f32 v255,v255,v238
v_mov_b32 v238,v255
s_nop 1
v_permlane32_swap_b32 v255,v238
v_add_f32 v255,v255,v238
v_sqrt_f32 v255,v255
v_sub_u32 v238,67,v1
v_cvt_f32_u32 v238,v238
v_log_f32 v238,v238
v_mov_b32 v239,0x3ff9999a
v_fmac_f32 v239,0x3e632166,v238
v_mul_f32 v255,v255,v239
v_or_b32 v255,0x80000000,v255
s_xor_b32 s34,s69,524288
buffer_load_dwordx4 v[160:163],v7,s[8:11],s34 offen
s_add_u32 s34,s34,4096
buffer_load_dwordx4 v[164:167],v7,s[8:11],s34 offen
s_add_u32 s34,s34,4096
buffer_load_dwordx4 v[168:171],v7,s[8:11],s34 offen
s_add_u32 s34,s34,4096
buffer_load_dwordx4 v[172:175],v7,s[8:11],s34 offen
s_add_u32 s34,s34,4096
buffer_load_dwordx4 v[176:179],v7,s[8:11],s34 offen
s_add_u32 s34,s34,4096
buffer_load_dwordx4 v[180:183],v7,s[8:11],s34 offen
s_add_u32 s34,s34,4096
buffer_load_dwordx4 v[184:187],v7,s[8:11],s34 offen
s_add_u32 s34,s34,4096
buffer_load_dwordx4 v[188:191],v7,s[8:11],s34 offen
s_xor_b32 s69,s69,524288
s_xor_b32 s34,s69,524288
buffer_load_dwordx4 v[160:163],v7,s[8:11],s34 offen
s_add_u32 s34,s34,4096
buffer_load_dwordx4 v[164:167],v7,s[8:11],s34 offen
s_add_u32 s34,s34,4096
buffer_load_dwordx4 v[168:171],v7,s[8:11],s34 offen
s_add_u32 s34,s34,4096
buffer_load_dwordx4 v[172:175],v7,s[8:11],s34 offen
s_add_u32 s34,s34,4096
buffer_load_dwordx4 v[176:179],v7,s[8:11],s34 offen
s_add_u32 s34,s34,4096
buffer_load_dwordx4 v[180:183],v7,s[8:11],s34 offen
s_add_u32 s34,s34,4096
buffer_load_dwordx4 v[184:187],v7,s[8:11],s34 offen
s_add_u32 s34,s34,4096
buffer_load_dwordx4 v[188:191],v7,s[8:11],s34 offen
s_xor_b32 s69,s69,524288
s_cmp_lt_u32 s54,2
s_cbranch_scc1 L_aa_79
s_sub_u32 s77,s54,2
s_mov_b32 s30,0
s_mov_b32 s86,1536
s_lshl_b32 s56,s77,5
s_add_u32 s56,s56,s68
s_mul_i32 s70,s56,24576
s_lshl_b32 s71,s56,12
s_lshl_b32 s59,s77,13
s_lshl2_add_u32 s59,s68,s59
s_add_u32 s59,s59,10485760
s_buffer_load_dword s32,s[8:11],s59
s_mov_b32 s33,1
s_add_u32 s70,s70,100663296
s_add_u32 s71,s71,41943040
v_mov_b32 v19,s59
s_branch L_aa_87
L_aa_93:
s_bitcmp1_b32 s46,0
s_cbranch_scc1 L_av_94
ds_read_b128 v[24:27],v4 offset:0
ds_read_b128 v[28:31],v4 offset:1024
s_min_u32 s56,s32,s33
s_cmp_lt_u32 s77,64
s_cselect_b32 s56,s56,0
s_cmp_eq_u32 s56,0
s_cselect_b32 s72,0x80000000,0
v_mov_b32 v248,s72
s_or_b32 s64,s70,s72
s_or_b32 s65,s71,s72
s_cmp_lt_u32 s30,s31
s_cselect_b32 s65,0x80000000,s65
s_add_u32 s64,s64,s28
s_add_u32 s65,s65,s29
s_xor_b32 s58,s67,s40
s_xor_b32 s57,s67,s41
s_add_u32 m0,s58,0
s_waitcnt lgkmcnt(1)
v_mfma_f32_16x16x32_bf16 v[160:163],v[24:27],a[0:3],0
buffer_load_dwordx4 v0,s[8:11],s64 offen offset:0 sc1 lds
v_mfma_f32_16x16x32_bf16 v[164:167],v[24:27],a[4:7],0
ds_read_b128 v[32:35],v4 offset:2048
v_lshlrev_b32 v88,16,v224
v_mfma_f32_16x16x32_bf16 v[168:171],v[24:27],a[8:11],0
ds_read_b128 v[36:39],v4 offset:3072
v_and_b32 v89,0xffff0000,v224
v_mfma_f32_16x16x32_bf16 v[172:175],v[24:27],a[12:15],0
ds_read_b128 v[40:43],v4 offset:8192
v_lshlrev_b32 v90,16,v225
v_mfma_f32_16x16x32_bf16 v[176:179],v[24:27],a[16:19],0
buffer_load_dwordx4 v0,s[8:11],s64 offen offset:1024 sc1 lds
v_mfma_f32_16x16x32_bf16 v[180:183],v[24:27],a[20:23],0
ds_read_b128 v[44:47],v4 offset:9216
v_and_b32 v91,0xffff0000,v225
v_mfma_f32_16x16x32_bf16 v[184:187],v[24:27],a[24:27],0
ds_read_b128 v[48:51],v4 offset:10240
s_waitcnt vmcnt(9)
v_mfma_f32_16x16x32_bf16 v[188:191],v[24:27],a[28:31],0
ds_read_b128 v[52:55],v4 offset:11264
v_mfma_f32_16x16x32_bf16 v[128:131],v[156:159],v[192:195],0
ds_write_b32 v247,v248
v_lshlrev_b32 v92,16,v226
s_waitcnt lgkmcnt(7)
v_mfma_f32_16x16x32_bf16 v[160:163],v[28:31],a[32:35],v[160:163]
buffer_load_dwordx4 v0,s[8:11],s64 offen offset:2048 sc1 lds
v_mfma_f32_16x16x32_bf16 v[164:167],v[28:31],a[36:39],v[164:167]
ds_read_b128 v[56:59],v4 offset:4096
s_waitcnt vmcnt(9)
v_mfma_f32_16x16x32_bf16 v[168:171],v[28:31],a[40:43],v[168:171]
ds_read_b128 v[60:63],v4 offset:5120
v_mfma_f32_16x16x32_bf16 v[128:131],v[156:159],v[196:199],v[128:131]
ds_read_b128 v[64:67],v4 offset:6144
v_and_b32 v93,0xffff0000,v226
v_mfma_f32_16x16x32_bf16 v[172:175],v[28:31],a[44:47],v[172:175]
ds_read_b128 v[68:71],v4 offset:7168
s_waitcnt vmcnt(8)
v_mfma_f32_16x16x32_bf16 v[176:179],v[28:31],a[48:51],v[176:179]
buffer_load_dwordx4 v0,s[8:11],s64 offen offset:3072 sc1 lds
v_mfma_f32_16x16x32_bf16 v[180:183],v[28:31],a[52:55],v[180:183]
ds_read_b128 v[72:75],v4 offset:12288
v_mfma_f32_16x16x32_bf16 v[128:131],v[156:159],v[200:203],v[128:131]
ds_read_b128 v[76:79],v4 offset:13312
v_lshlrev_b32 v94,16,v227
v_mfma_f32_16x16x32_bf16 v[184:187],v[28:31],a[56:59],v[184:187]
ds_read_b128 v[80:83],v4 offset:14336
s_waitcnt vmcnt(8)
v_mfma_f32_16x16x32_bf16 v[188:191],v[28:31],a[60:63],v[188:191]
ds_read_b128 v[84:87],v4 offset:15360
v_mfma_f32_16x16x32_bf16 v[128:131],v[156:159],v[204:207],v[128:131]
v_and_b32 v95,0xffff0000,v227
v_readfirstlane_b32 s22,v246
s_waitcnt lgkmcnt(14)
v_mfma_f32_16x16x32_bf16 v[160:163],v[32:35],a[64:67],v[160:163]
s_waitcnt vmcnt(7)
v_mfma_f32_16x16x32_bf16 v[132:135],v[156:159],v[208:211],0
s_add_u32 m0,s58,4096
s_add_u32 s64,s64,4096
s_cmp_eq_u32 s22,0
s_cbranch_scc1 L_ag_95
L_agb_96:
v_mfma_f32_16x16x32_bf16 v[164:167],v[32:35],a[68:71],v[164:167]
buffer_load_dwordx4 v0,s[8:11],s64 offen offset:0 sc1 lds
v_mfma_f32_16x16x32_bf16 v[168:171],v[32:35],a[72:75],v[168:171]
s_waitcnt vmcnt(7)
v_mfma_f32_16x16x32_bf16 v[132:135],v[156:159],v[212:215],v[132:135]
s_lshl_b32 s18,s26,5
s_add_u32 s18,s18,s68
s_lshl_b32 s19,s18,10
v_mfma_f32_16x16x32_bf16 v[172:175],v[32:35],a[76:79],v[172:175]
s_waitcnt vmcnt(6)
v_mfma_f32_16x16x32_bf16 v[132:135],v[156:159],v[216:219],v[132:135]
s_add_u32 s20,s19,6291456
s_lshl_b32 s23,s51,5
s_add_u32 s23,s23,s68
v_mfma_f32_16x16x32_bf16 v[176:179],v[32:35],a[80:83],v[176:179]
ds_write_b128 v6,v[128:131]
v_mfma_f32_16x16x32_bf16 v[180:183],v[32:35],a[84:87],v[180:183]
buffer_load_dwordx4 v0,s[8:11],s64 offen offset:1024 sc1 lds
v_mfma_f32_16x16x32_bf16 v[184:187],v[32:35],a[88:91],v[184:187]
s_waitcnt vmcnt(6)
v_mfma_f32_16x16x32_bf16 v[132:135],v[156:159],v[220:223],v[132:135]
s_lshl_b32 s24,s23,10
s_lshl_b32 s25,s51,10
s_add_u32 s25,s25,2883584
v_mfma_f32_16x16x32_bf16 v[188:191],v[32:35],a[92:95],v[188:191]
s_cmp_eq_u32 s23,s55
s_cselect_b32 s25,s25,s24
s_add_u32 s25,s25,8388608
s_waitcnt lgkmcnt(14)
v_mfma_f32_16x16x32_bf16 v[160:163],v[36:39],a[96:99],v[160:163]
s_mov_b32 s6,268435456
s_cmp_eq_u32 s31,0
s_cselect_b32 s25,s24,s25
s_cselect_b64 s[4:5],s[16:17],s[44:45]
s_cmov_b32 s6,2097152
v_mfma_f32_16x16x32_bf16 v[164:167],v[36:39],a[100:103],v[164:167]
ds_write_b128 v6,v[132:135] offset:2048
v_mfma_f32_16x16x32_bf16 v[168:171],v[36:39],a[104:107],v[168:171]
buffer_load_dwordx4 v0,s[8:11],s64 offen offset:2048 sc1 lds
v_mfma_f32_16x16x32_bf16 v[172:175],v[36:39],a[108:111],v[172:175]
buffer_load_dwordx4 v[224:227],v0,s[4:7],s25 offen sc1
v_mfma_f32_16x16x32_bf16 v[176:179],v[36:39],a[112:115],v[176:179]
s_lshr_b32 s24,s55,5
s_cmp_lt_u32 s51,s24
s_cselect_b32 s24,1,2
v_mfma_f32_16x16x32_bf16 v[180:183],v[36:39],a[116:119],v[180:183]
v_mov_b32 v252,s24
s_lshl2_add_u32 s25,s51,11018240
v_mfma_f32_16x16x32_bf16 v[184:187],v[36:39],a[120:123],v[184:187]
buffer_load_dwordx4 v0,s[8:11],s64 offen offset:3072 sc1 lds
v_mfma_f32_16x16x32_bf16 v[188:191],v[36:39],a[124:127],v[188:191]
s_waitcnt lgkmcnt(0)
s_barrier
s_lshl_b32 s24,s68,16
s_waitcnt lgkmcnt(14)
v_mfma_f32_16x16x32_bf16 v[160:163],v[40:43],a[128:131],v[160:163]
ds_read_b128 v[96:99],v23
s_add_u32 s24,s24,s31
v_mfma_f32_16x16x32_bf16 v[164:167],v[40:43],a[132:135],v[164:167]
ds_read_b128 v[100:103],v23 offset:16
s_add_u32 s24,s24,s86
v_mfma_f32_16x16x32_bf16 v[168:171],v[40:43],a[136:139],v[168:171]
ds_read_b128 v[248:251],v245
s_add_u32 m0,s58,8192
s_add_u32 s64,s64,4096
v_mfma_f32_16x16x32_bf16 v[172:175],v[40:43],a[140:143],v[172:175]
buffer_load_dwordx4 v0,s[8:11],s64 offen offset:0 sc1 lds
s_cmp_eq_u32 s24,1537
s_cselect_b32 s25,s25,0x80000000
v_mfma_f32_16x16x32_bf16 v[176:179],v[40:43],a[144:147],v[176:179]
buffer_store_dword v252,off,s[8:11],s25 sc1
s_bitcmp1_b64 s[38:39],s51
s_cselect_b32 s24,128,0
v_mfma_f32_16x16x32_bf16 v[180:183],v[40:43],a[148:151],v[180:183]
buffer_store_dword v20,off,s[8:11],s73 sc1
s_lshl_b32 s23,s51,13
v_mfma_f32_16x16x32_bf16 v[184:187],v[40:43],a[152:155],v[184:187]
s_lshl2_add_u32 s23,s68,s23
s_add_u32 s23,s23,10487168
s_add_u32 s23,s23,s24
s_mov_b32 s73,0x80000000
v_mfma_f32_16x16x32_bf16 v[188:191],v[40:43],a[156:159],v[188:191]
buffer_load_dwordx4 v0,s[8:11],s64 offen offset:1024 sc1 lds
v_mfma_f32_16x16x32_bf16 v[160:163],v[44:47],a[160:163],v[160:163]
buffer_load_dword v246,off,s[8:11],s23 sc1
v_lshrrev_b32 v244,4,v1
v_mfma_f32_16x16x32_bf16 v[164:167],v[44:47],a[164:167],v[164:167]
s_waitcnt lgkmcnt(0)
v_or3_b32 v248,v248,v249,v250
v_or_b32 v248,v248,v251
s_sub_u32 s23,s77,7
v_mfma_f32_16x16x32_bf16 v[168:171],v[44:47],a[168:171],v[168:171]
v_readfirstlane_b32 s72,v248
v_add_u32 v244,s23,v244
v_max_i32 v244,0,v244
v_mfma_f32_16x16x32_bf16 v[172:175],v[44:47],a[172:175],v[172:175]
buffer_load_dwordx4 v0,s[8:11],s64 offen offset:2048 sc1 lds
v_lshl_add_u32 v244,v244,13,v21
v_mfma_f32_16x16x32_bf16 v[176:179],v[44:47],a[176:179],v[176:179]
buffer_load_dwordx2 v[242:243],v244,s[8:11],0 offen sc1
s_waitcnt lgkmcnt(1)
v_mfma_f32_16x16x32_bf16 v[180:183],v[44:47],a[180:183],v[180:183]
v_cvt_pk_bf16_f32 v104,v96,v97
v_cvt_pk_bf16_f32 v105,v98,v99
v_cvt_pk_bf16_f32 v106,v100,v101
v_mfma_f32_16x16x32_bf16 v[184:187],v[44:47],a[184:187],v[184:187]
v_cvt_pk_bf16_f32 v107,v102,v103
v_lshlrev_b32 v96,16,v104
v_and_b32 v97,0xffff0000,v104
v_mfma_f32_16x16x32_bf16 v[188:191],v[44:47],a[188:191],v[188:191]
buffer_load_dwordx4 v0,s[8:11],s64 offen offset:3072 sc1 lds
v_lshlrev_b32 v98,16,v105
v_mfma_f32_16x16x32_bf16 v[160:163],v[48:51],a[192:195],v[160:163]
v_and_b32 v99,0xffff0000,v105
v_lshlrev_b32 v100,16,v106
v_and_b32 v101,0xffff0000,v106
v_mfma_f32_16x16x32_bf16 v[164:167],v[48:51],a[196:199],v[164:167]
v_lshlrev_b32 v102,16,v107
v_and_b32 v103,0xffff0000,v107
v_add_f32 v88,v88,v96
v_mfma_f32_16x16x32_bf16 v[168:171],v[48:51],a[200:203],v[168:171]
v_add_f32 v89,v89,v97
v_add_f32 v90,v90,v98
v_add_f32 v91,v91,v99
v_mfma_f32_16x16x32_bf16 v[172:175],v[48:51],a[204:207],v[172:175]
s_add_u32 m0,s57,24576
v_add_f32 v92,v92,v100
v_add_f32 v93,v93,v101
v_add_f32 v94,v94,v102
v_mfma_f32_16x16x32_bf16 v[176:179],v[48:51],a[208:211],v[176:179]
buffer_load_dwordx4 v0,s[8:11],s65 offen offset:0 sc1 lds
v_add_f32 v95,v95,v103
v_mfma_f32_16x16x32_bf16 v[180:183],v[48:51],a[212:215],v[180:183]
v_cvt_pk_bf16_f32 v104,v88,v89
v_cvt_pk_bf16_f32 v105,v90,v91
v_cvt_pk_bf16_f32 v106,v92,v93
v_mfma_f32_16x16x32_bf16 v[184:187],v[48:51],a[216:219],v[184:187]
v_cvt_pk_bf16_f32 v107,v94,v95
v_mfma_f32_16x16x32_bf16 v[188:191],v[48:51],a[220:223],v[188:191]
buffer_store_dwordx4 v[104:107],v0,s[8:11],s20 offen sc1
v_lshlrev_b32 v88,16,v104
v_mfma_f32_16x16x32_bf16 v[160:163],v[52:55],a[224:227],v[160:163]
buffer_load_dwordx4 v0,s[8:11],s65 offen offset:1024 sc1 lds
v_and_b32 v89,0xffff0000,v104
v_mfma_f32_16x16x32_bf16 v[164:167],v[52:55],a[228:231],v[164:167]
v_lshlrev_b32 v90,16,v105
v_and_b32 v91,0xffff0000,v105
v_lshlrev_b32 v92,16,v106
v_mfma_f32_16x16x32_bf16 v[168:171],v[52:55],a[232:235],v[168:171]
v_and_b32 v93,0xffff0000,v106
v_lshlrev_b32 v94,16,v107
v_and_b32 v95,0xffff0000,v107
v_mfma_f32_16x16x32_bf16 v[172:175],v[52:55],a[236:239],v[172:175]
v_readfirstlane_b32 s78,v88
v_mfma_f32_16x16x32_bf16 v[176:179],v[52:55],a[240:243],v[176:179]
s_nop 0
v_add_f32 v120,v88,-s78
v_add_f32 v121,v89,-s78
v_add_f32 v122,v90,-s78
v_mfma_f32_16x16x32_bf16 v[180:183],v[52:55],a[244:247],v[180:183]
v_add_f32 v123,v91,-s78
v_add_f32 v124,v92,-s78
v_add_f32 v125,v93,-s78
v_mfma_f32_16x16x32_bf16 v[184:187],v[52:55],a[248:251],v[184:187]
v_add_f32 v126,v94,-s78
v_add_f32 v127,v95,-s78
v_add_f32 v128,v120,v122
v_mfma_f32_16x16x32_bf16 v[188:191],v[52:55],a[252:255],v[188:191]
v_add_f32 v129,v121,v123
v_mul_f32 v130,v120,v120
v_mul_f32 v131,v121,v121
v_mfma_f32_16x16x32_bf16 v[192:195],v[56:59],a[0:3],0
v_add_f32 v132,v124,v126
v_add_f32 v133,v125,v127
v_fma_f32 v130,v122,v122,v130
v_mfma_f32_16x16x32_bf16 v[196:199],v[56:59],a[4:7],0
v_fma_f32 v131,v123,v123,v131
v_add_f32 v128,v128,v132
v_add_f32 v129,v129,v133
v_mfma_f32_16x16x32_bf16 v[200:203],v[56:59],a[8:11],0
v_fma_f32 v130,v124,v124,v130
v_fma_f32 v131,v125,v125,v131
v_add_f32 v128,v128,v129
v_mfma_f32_16x16x32_bf16 v[204:207],v[56:59],a[12:15],0
v_fma_f32 v130,v126,v126,v130
v_fma_f32 v131,v127,v127,v131
v_add_f32 v130,v130,v131
v_mfma_f32_16x16x32_bf16 v[208:211],v[56:59],a[16:19],0
s_nop 0
v_permlane32_swap_b32 v128,v130
v_add_f32 v128,v128,v130
v_cvt_pk_bf16_f32 v24,v160,v164
v_mfma_f32_16x16x32_bf16 v[212:215],v[56:59],a[20:23],0
v_add_f32_dpp v128,v128,v128 row_ror:8 row_mask:0xf bank_mask:0xf
v_cvt_pk_bf16_f32 v25,v168,v172
v_cvt_pk_bf16_f32 v26,v176,v180
v_mfma_f32_16x16x32_bf16 v[216:219],v[56:59],a[24:27],0
v_add_f32_dpp v128,v128,v128 row_ror:4 row_mask:0xf bank_mask:0xf
v_cvt_pk_bf16_f32 v27,v184,v188
v_cvt_pk_bf16_f32 v28,v161,v165
v_mfma_f32_16x16x32_bf16 v[220:223],v[56:59],a[28:31],0
v_add_f32_dpp v128,v128,v128 row_ror:2 row_mask:0xf bank_mask:0xf
v_cvt_pk_bf16_f32 v29,v169,v173
v_cvt_pk_bf16_f32 v30,v177,v181
v_mfma_f32_16x16x32_bf16 v[192:195],v[60:63],a[32:35],v[192:195]
v_add_f32_dpp v128,v128,v128 row_ror:1 row_mask:0xf bank_mask:0xf
v_mov_b32 v130,v128
v_cvt_pk_bf16_f32 v31,v185,v189
v_mfma_f32_16x16x32_bf16 v[196:199],v[60:63],a[36:39],v[196:199]
v_permlane16_swap_b32 v128,v130
v_add_f32 v128,v128,v130
v_mul_f32 v128,0x3b000000,v128
v_mfma_f32_16x16x32_bf16 v[200:203],v[60:63],a[40:43],v[200:203]
v_mov_b32 v130,v128
v_cvt_pk_bf16_f32 v32,v162,v166
v_cvt_pk_bf16_f32 v33,v170,v174
v_mfma_f32_16x16x32_bf16 v[204:207],v[60:63],a[44:47],v[204:207]
v_permlane32_swap_b32 v128,v130
v_fma_f32 v130,-v128,v128,v130
v_add_f32 v128,s78,v128
v_mfma_f32_16x16x32_bf16 v[208:211],v[60:63],a[48:51],v[208:211]
v_max_f32 v130,0,v130
v_cvt_pk_bf16_f32 v130,v128,v130
v_lshlrev_b32 v128,16,v130
v_mfma_f32_16x16x32_bf16 v[212:215],v[60:63],a[52:55],v[212:215]
v_and_b32 v130,0xffff0000,v130
v_add_f32 v130,0x3727c5ac,v130
v_cvt_pk_bf16_f32 v130,v130,v130
v_mfma_f32_16x16x32_bf16 v[216:219],v[60:63],a[56:59],v[216:219]
v_and_b32 v130,0xffff0000,v130
v_sqrt_f32 v130,v130
v_add_f32 v120,v88,-v128
v_mfma_f32_16x16x32_bf16 v[220:223],v[60:63],a[60:63],v[220:223]
v_add_f32 v121,v89,-v128
v_add_f32 v122,v90,-v128
v_add_f32 v123,v91,-v128
v_mfma_f32_16x16x32_bf16 v[192:195],v[64:67],a[64:67],v[192:195]
v_add_f32 v124,v92,-v128
v_add_f32 v125,v93,-v128
v_add_f32 v126,v94,-v128
v_mfma_f32_16x16x32_bf16 v[196:199],v[64:67],a[68:71],v[196:199]
v_add_f32 v127,v95,-v128
v_cvt_pk_bf16_f32 v130,v130,v130
v_and_b32 v130,0xffff0000,v130
v_mfma_f32_16x16x32_bf16 v[200:203],v[64:67],a[72:75],v[200:203]
v_rcp_f32 v130,v130
v_cvt_pk_bf16_f32 v108,v120,v121
v_cvt_pk_bf16_f32 v109,v122,v123
v_mfma_f32_16x16x32_bf16 v[204:207],v[64:67],a[76:79],v[204:207]
v_cvt_pk_bf16_f32 v110,v124,v125
v_cvt_pk_bf16_f32 v111,v126,v127
v_lshlrev_b32 v120,16,v108
v_mfma_f32_16x16x32_bf16 v[208:211],v[64:67],a[80:83],v[208:211]
v_cvt_pk_bf16_f32 v34,v178,v182
v_cvt_pk_bf16_f32 v35,v186,v190
v_cvt_pk_bf16_f32 v36,v163,v167
v_mfma_f32_16x16x32_bf16 v[212:215],v[64:67],a[84:87],v[212:215]
v_cvt_pk_bf16_f32 v37,v171,v175
v_cvt_pk_bf16_f32 v38,v179,v183
v_cvt_pk_bf16_f32 v39,v187,v191
v_mfma_f32_16x16x32_bf16 v[216:219],v[64:67],a[88:91],v[216:219]
v_and_b32 v121,0xffff0000,v108
v_lshlrev_b32 v122,16,v109
v_and_b32 v123,0xffff0000,v109
v_mfma_f32_16x16x32_bf16 v[220:223],v[64:67],a[92:95],v[220:223]
v_lshlrev_b32 v124,16,v110
v_and_b32 v125,0xffff0000,v110
v_lshlrev_b32 v126,16,v111
v_mfma_f32_16x16x32_bf16 v[192:195],v[68:71],a[96:99],v[192:195]
v_and_b32 v127,0xffff0000,v111
v_mul_f32 v120,v120,v130
v_mul_f32 v121,v121,v130
v_mfma_f32_16x16x32_bf16 v[196:199],v[68:71],a[100:103],v[196:199]
v_mul_f32 v122,v122,v130
v_mul_f32 v123,v123,v130
v_mul_f32 v124,v124,v130
v_mfma_f32_16x16x32_bf16 v[200:203],v[68:71],a[104:107],v[200:203]
v_mul_f32 v125,v125,v130
v_mul_f32 v126,v126,v130
v_mul_f32 v127,v127,v130
v_mfma_f32_16x16x32_bf16 v[204:207],v[68:71],a[108:111],v[204:207]
v_cvt_pk_bf16_f32 v108,v120,v121
v_cvt_pk_bf16_f32 v109,v122,v123
v_cvt_pk_bf16_f32 v110,v124,v125
v_mfma_f32_16x16x32_bf16 v[208:211],v[68:71],a[112:115],v[208:211]
s_add_u32 s62,s69,0
v_cvt_pk_bf16_f32 v111,v126,v127
v_lshlrev_b32 v112,16,v108
v_and_b32 v113,0xffff0000,v108
v_mfma_f32_16x16x32_bf16 v[212:215],v[68:71],a[116:119],v[212:215]
buffer_store_dwordx4 v[24:27],v5,s[8:11],s62 offen
v_lshlrev_b32 v114,16,v109
v_mfma_f32_16x16x32_bf16 v[216:219],v[68:71],a[120:123],v[216:219]
v_and_b32 v115,0xffff0000,v109
v_lshlrev_b32 v116,16,v110
v_and_b32 v117,0xffff0000,v110
v_mfma_f32_16x16x32_bf16 v[220:223],v[68:71],a[124:127],v[220:223]
v_lshlrev_b32 v118,16,v111
v_and_b32 v119,0xffff0000,v111
v_add_f32 v88,v88,v112
v_mfma_f32_16x16x32_bf16 v[192:195],v[72:75],a[128:131],v[192:195]
s_add_u32 s62,s69,16384
v_add_f32 v89,v89,v113
v_add_f32 v90,v90,v114
v_add_f32 v91,v91,v115
v_mfma_f32_16x16x32_bf16 v[196:199],v[72:75],a[132:135],v[196:199]
buffer_store_dwordx4 v[28:31],v5,s[8:11],s62 offen
v_add_f32 v92,v92,v116
v_mfma_f32_16x16x32_bf16 v[200:203],v[72:75],a[136:139],v[200:203]
v_add_f32 v93,v93,v117
v_add_f32 v94,v94,v118
v_add_f32 v95,v95,v119
v_mfma_f32_16x16x32_bf16 v[204:207],v[72:75],a[140:143],v[204:207]
v_cvt_pk_bf16_f32 v96,v88,v89
v_cvt_pk_bf16_f32 v97,v90,v91
v_cvt_pk_bf16_f32 v98,v92,v93
v_mfma_f32_16x16x32_bf16 v[208:211],v[72:75],a[144:147],v[208:211]
s_add_u32 s62,s69,32768
v_cvt_pk_bf16_f32 v99,v94,v95
v_mfma_f32_16x16x32_bf16 v[212:215],v[72:75],a[148:151],v[212:215]
buffer_store_dwordx4 v[32:35],v5,s[8:11],s62 offen
v_mfma_f32_16x16x32_bf16 v[216:219],v[72:75],a[152:155],v[216:219]
buffer_store_dwordx4 v[96:99],v0,s[12:15],s19 offen sc1
v_mul_f32 v236,v112,v228
v_mfma_f32_16x16x32_bf16 v[220:223],v[72:75],a[156:159],v[220:223]
v_mul_f32 v237,v113,v229
v_fma_f32 v236,v114,v230,v236
v_fma_f32 v237,v115,v231,v237
v_mfma_f32_16x16x32_bf16 v[192:195],v[76:79],a[160:163],v[192:195]
s_add_u32 s62,s69,49152
v_fma_f32 v236,v116,v232,v236
v_fma_f32 v237,v117,v233,v237
v_fma_f32 v236,v118,v234,v236
v_mfma_f32_16x16x32_bf16 v[196:199],v[76:79],a[164:167],v[196:199]
buffer_store_dwordx4 v[36:39],v5,s[8:11],s62 offen
v_fma_f32 v237,v119,v235,v237
v_mfma_f32_16x16x32_bf16 v[200:203],v[76:79],a[168:171],v[200:203]
v_add_f32 v236,v236,v237
v_mfma_f32_16x16x32_bf16 v[204:207],v[76:79],a[172:175],v[204:207]
s_nop 0
v_add_f32_dpp v236,v236,v236 row_ror:8 row_mask:0xf bank_mask:0xf
v_mfma_f32_16x16x32_bf16 v[208:211],v[76:79],a[176:179],v[208:211]
s_nop 0
v_add_f32_dpp v236,v236,v236 row_ror:4 row_mask:0xf bank_mask:0xf
v_mfma_f32_16x16x32_bf16 v[212:215],v[76:79],a[180:183],v[212:215]
s_nop 0
v_add_f32_dpp v236,v236,v236 row_ror:2 row_mask:0xf bank_mask:0xf
v_mfma_f32_16x16x32_bf16 v[216:219],v[76:79],a[184:187],v[216:219]
s_nop 0
v_add_f32_dpp v236,v236,v236 row_ror:1 row_mask:0xf bank_mask:0xf
v_mov_b32 v237,v236
v_mfma_f32_16x16x32_bf16 v[220:223],v[76:79],a[188:191],v[220:223]
s_nop 0
v_permlane16_swap_b32 v236,v237
v_add_f32 v236,v236,v237
v_mov_b32 v237,v236
v_mfma_f32_16x16x32_bf16 v[192:195],v[80:83],a[192:195],v[192:195]
s_nop 0
v_permlane32_swap_b32 v236,v237
v_add_f32 v236,v236,v237
v_cvt_pk_bf16_f32 v236,v236,v236
v_mfma_f32_16x16x32_bf16 v[196:199],v[80:83],a[196:199],v[196:199]
v_and_b32 v236,0xffff0000,v236
v_ashrrev_i32 v237,31,v236
v_or_b32 v237,0x80000000,v237
v_mfma_f32_16x16x32_bf16 v[192:195],v[84:87],a[224:227],v[192:195]
v_xor_b32 v236,v236,v237
v_and_b32 v236,0xffff0000,v236
s_sub_u32 s20,4095,s18
v_mfma_f32_16x16x32_bf16 v[196:199],v[84:87],a[228:231],v[196:199]
v_or_b32 v20,s20,v236
s_lshl_b32 s73,s26,13
s_lshl2_add_u32 s73,s68,s73
v_mfma_f32_16x16x32_bf16 v[200:203],v[80:83],a[200:203],v[200:203]
s_add_u32 s73,s73,10485760
s_add_u32 s73,s73,s86
v_mfma_f32_16x16x32_bf16 v[204:207],v[80:83],a[204:207],v[204:207]
v_cvt_pk_bf16_f32 v40,v192,v196
v_cvt_pk_bf16_f32 v44,v193,v197
v_cvt_pk_bf16_f32 v48,v194,v198
v_mfma_f32_16x16x32_bf16 v[200:203],v[84:87],a[232:235],v[200:203]
v_cvt_pk_bf16_f32 v52,v195,v199
v_mfma_f32_16x16x32_bf16 v[204:207],v[84:87],a[236:239],v[204:207]
v_mfma_f32_16x16x32_bf16 v[208:211],v[80:83],a[208:211],v[208:211]
v_mfma_f32_16x16x32_bf16 v[212:215],v[80:83],a[212:215],v[212:215]
v_mfma_f32_16x16x32_bf16 v[208:211],v[84:87],a[240:243],v[208:211]
v_mfma_f32_16x16x32_bf16 v[212:215],v[84:87],a[244:247],v[212:215]
v_cvt_pk_bf16_f32 v41,v200,v204
v_cvt_pk_bf16_f32 v45,v201,v205
v_cvt_pk_bf16_f32 v49,v202,v206
v_mfma_f32_16x16x32_bf16 v[216:219],v[80:83],a[216:219],v[216:219]
v_cvt_pk_bf16_f32 v53,v203,v207
v_mfma_f32_16x16x32_bf16 v[220:223],v[80:83],a[220:223],v[220:223]
v_cvt_pk_bf16_f32 v42,v208,v212
v_cvt_pk_bf16_f32 v46,v209,v213
v_cvt_pk_bf16_f32 v50,v210,v214
v_mfma_f32_16x16x32_bf16 v[216:219],v[84:87],a[248:251],v[216:219]
v_cvt_pk_bf16_f32 v54,v211,v215
v_mfma_f32_16x16x32_bf16 v[220:223],v[84:87],a[252:255],v[220:223]
s_nop 7
v_cvt_pk_bf16_f32 v43,v216,v220
s_add_u32 s62,s69,262144
buffer_store_dwordx4 v[40:43],v5,s[8:11],s62 offen
v_cvt_pk_bf16_f32 v47,v217,v221
s_add_u32 s62,s69,278528
buffer_store_dwordx4 v[44:47],v5,s[8:11],s62 offen
v_cvt_pk_bf16_f32 v51,v218,v222
s_add_u32 s62,s69,294912
buffer_store_dwordx4 v[48:51],v5,s[8:11],s62 offen
v_cvt_pk_bf16_f32 v55,v219,v223
s_add_u32 s62,s69,311296
buffer_store_dwordx4 v[52:55],v5,s[8:11],s62 offen
s_cmp_lg_u32 s72,0
s_cbranch_scc1 L_aa_82
s_waitcnt vmcnt(9)
s_branch L_aa_92
L_av_94:
ds_read_b128 v[24:27],v4 offset:0
ds_read_b128 v[28:31],v4 offset:1024
s_min_u32 s56,s32,s33
s_cmp_lt_u32 s77,64
s_cselect_b32 s56,s56,0
s_cmp_eq_u32 s56,0
s_cselect_b32 s72,0x80000000,0
v_mov_b32 v248,s72
s_or_b32 s64,s70,s72
s_or_b32 s65,s71,s72
s_cmp_lt_u32 s30,s31
s_cselect_b32 s65,0x80000000,s65
s_add_u32 s64,s64,s28
s_add_u32 s65,s65,s29
s_xor_b32 s58,s67,s40
s_xor_b32 s57,s67,s41
s_add_u32 m0,s58,0
s_waitcnt lgkmcnt(1)
v_mfma_f32_16x16x32_bf16 v[160:163],v[24:27],a[0:3],0
buffer_load_dwordx4 v0,s[8:11],s64 offen offset:0 sc1 lds
v_mfma_f32_16x16x32_bf16 v[164:167],v[24:27],a[4:7],0
ds_read_b128 v[32:35],v4 offset:2048
s_lshl_b32 s23,s51,5
v_mfma_f32_16x16x32_bf16 v[168:171],v[24:27],a[8:11],0
ds_read_b128 v[36:39],v4 offset:3072
s_add_u32 s23,s23,s68
v_mfma_f32_16x16x32_bf16 v[172:175],v[24:27],a[12:15],0
ds_read_b128 v[40:43],v4 offset:8192
s_lshl_b32 s24,s23,10
v_mfma_f32_16x16x32_bf16 v[176:179],v[24:27],a[16:19],0
buffer_load_dwordx4 v0,s[8:11],s64 offen offset:1024 sc1 lds
v_mfma_f32_16x16x32_bf16 v[180:183],v[24:27],a[20:23],0
ds_read_b128 v[44:47],v4 offset:9216
s_lshl_b32 s25,s51,10
v_mfma_f32_16x16x32_bf16 v[184:187],v[24:27],a[24:27],0
ds_read_b128 v[48:51],v4 offset:10240
s_waitcnt vmcnt(9)
v_mfma_f32_16x16x32_bf16 v[188:191],v[24:27],a[28:31],0
ds_read_b128 v[52:55],v4 offset:11264
v_mfma_f32_16x16x32_bf16 v[128:131],v[156:159],v[192:195],0
ds_write_b32 v247,v248
s_add_u32 s25,s25,2883584
s_waitcnt lgkmcnt(7)
v_mfma_f32_16x16x32_bf16 v[160:163],v[28:31],a[32:35],v[160:163]
buffer_load_dwordx4 v0,s[8:11],s64 offen offset:2048 sc1 lds
v_mfma_f32_16x16x32_bf16 v[164:167],v[28:31],a[36:39],v[164:167]
ds_read_b128 v[56:59],v4 offset:4096
s_waitcnt vmcnt(9)
v_mfma_f32_16x16x32_bf16 v[168:171],v[28:31],a[40:43],v[168:171]
ds_read_b128 v[60:63],v4 offset:5120
v_mfma_f32_16x16x32_bf16 v[128:131],v[156:159],v[196:199],v[128:131]
ds_read_b128 v[64:67],v4 offset:6144
s_cmp_eq_u32 s23,s55
s_cselect_b32 s25,s25,s24
v_mfma_f32_16x16x32_bf16 v[172:175],v[28:31],a[44:47],v[172:175]
ds_read_b128 v[68:71],v4 offset:7168
s_waitcnt vmcnt(8)
v_mfma_f32_16x16x32_bf16 v[176:179],v[28:31],a[48:51],v[176:179]
buffer_load_dwordx4 v0,s[8:11],s64 offen offset:3072 sc1 lds
v_mfma_f32_16x16x32_bf16 v[180:183],v[28:31],a[52:55],v[180:183]
ds_read_b128 v[72:75],v4 offset:12288
v_mfma_f32_16x16x32_bf16 v[128:131],v[156:159],v[200:203],v[128:131]
ds_read_b128 v[76:79],v4 offset:13312
s_add_u32 s25,s25,8388608
v_mfma_f32_16x16x32_bf16 v[184:187],v[28:31],a[56:59],v[184:187]
ds_read_b128 v[80:83],v4 offset:14336
s_waitcnt vmcnt(8)
v_mfma_f32_16x16x32_bf16 v[188:191],v[28:31],a[60:63],v[188:191]
ds_read_b128 v[84:87],v4 offset:15360
v_mfma_f32_16x16x32_bf16 v[128:131],v[156:159],v[204:207],v[128:131]
s_mov_b32 s6,268435456
s_cmp_eq_u32 s31,0
s_cselect_b32 s25,s24,s25
s_cselect_b64 s[4:5],s[16:17],s[44:45]
s_cmov_b32 s6,2097152
s_waitcnt lgkmcnt(14)
v_mfma_f32_16x16x32_bf16 v[160:163],v[32:35],a[64:67],v[160:163]
buffer_load_dwordx4 v[224:227],v0,s[4:7],s25 offen sc1
v_mfma_f32_16x16x32_bf16 v[164:167],v[32:35],a[68:71],v[164:167]
s_waitcnt vmcnt(8)
v_mfma_f32_16x16x32_bf16 v[132:135],v[156:159],v[208:211],0
s_add_u32 m0,s58,4096
s_add_u32 s64,s64,4096
s_lshr_b32 s24,s55,5
v_mfma_f32_16x16x32_bf16 v[168:171],v[32:35],a[72:75],v[168:171]
buffer_load_dwordx4 v0,s[8:11],s64 offen offset:0 sc1 lds
v_mfma_f32_16x16x32_bf16 v[172:175],v[32:35],a[76:79],v[172:175]
s_waitcnt vmcnt(8)
v_mfma_f32_16x16x32_bf16 v[132:135],v[156:159],v[212:215],v[132:135]
s_cmp_lt_u32 s51,s24
s_cselect_b32 s24,1,2
v_mov_b32 v252,s24
v_mfma_f32_16x16x32_bf16 v[176:179],v[32:35],a[80:83],v[176:179]
s_waitcnt vmcnt(7)
v_mfma_f32_16x16x32_bf16 v[132:135],v[156:159],v[216:219],v[132:135]
s_lshl2_add_u32 s25,s51,11018240
s_lshl_b32 s24,s68,16
s_add_u32 s24,s24,s31
v_mfma_f32_16x16x32_bf16 v[180:183],v[32:35],a[84:87],v[180:183]
ds_write_b128 v6,v[128:131]
v_mfma_f32_16x16x32_bf16 v[184:187],v[32:35],a[88:91],v[184:187]
buffer_load_dwordx4 v0,s[8:11],s64 offen offset:1024 sc1 lds
v_mfma_f32_16x16x32_bf16 v[188:191],v[32:35],a[92:95],v[188:191]
s_waitcnt vmcnt(7)
v_mfma_f32_16x16x32_bf16 v[132:135],v[156:159],v[220:223],v[132:135]
s_add_u32 s24,s24,s86
s_cmp_eq_u32 s24,1537
s_cselect_b32 s25,s25,0x80000000
s_waitcnt lgkmcnt(14)
v_mfma_f32_16x16x32_bf16 v[160:163],v[36:39],a[96:99],v[160:163]
buffer_store_dword v252,off,s[8:11],s25 sc1
v_mfma_f32_16x16x32_bf16 v[164:167],v[36:39],a[100:103],v[164:167]
s_bitcmp1_b64 s[38:39],s51
s_cselect_b32 s24,128,0
s_lshl_b32 s23,s51,13
v_mfma_f32_16x16x32_bf16 v[168:171],v[36:39],a[104:107],v[168:171]
ds_write_b128 v6,v[132:135] offset:2048
v_mfma_f32_16x16x32_bf16 v[172:175],v[36:39],a[108:111],v[172:175]
buffer_load_dwordx4 v0,s[8:11],s64 offen offset:2048 sc1 lds
v_mfma_f32_16x16x32_bf16 v[176:179],v[36:39],a[112:115],v[176:179]
s_lshl2_add_u32 s23,s68,s23
s_add_u32 s23,s23,10487168
s_add_u32 s23,s23,s24
v_mfma_f32_16x16x32_bf16 v[180:183],v[36:39],a[116:119],v[180:183]
buffer_load_dword v246,off,s[8:11],s23 sc1
v_mfma_f32_16x16x32_bf16 v[184:187],v[36:39],a[120:123],v[184:187]
v_lshrrev_b32 v244,4,v1
s_sub_u32 s23,s77,7
v_mfma_f32_16x16x32_bf16 v[188:191],v[36:39],a[124:127],v[188:191]
buffer_load_dwordx4 v0,s[8:11],s64 offen offset:3072 sc1 lds
s_waitcnt lgkmcnt(14)
v_mfma_f32_16x16x32_bf16 v[160:163],v[40:43],a[128:131],v[160:163]
s_waitcnt lgkmcnt(0)
s_barrier
v_add_u32 v244,s23,v244
v_mfma_f32_16x16x32_bf16 v[164:167],v[40:43],a[132:135],v[164:167]
ds_read_b128 v[248:251],v245
v_max_i32 v244,0,v244
v_mfma_f32_16x16x32_bf16 v[168:171],v[40:43],a[136:139],v[168:171]
buffer_store_dword v20,off,s[8:11],s73 sc1
v_mfma_f32_16x16x32_bf16 v[172:175],v[40:43],a[140:143],v[172:175]
s_add_u32 m0,s58,8192
s_add_u32 s64,s64,4096
v_lshl_add_u32 v244,v244,13,v21
v_mfma_f32_16x16x32_bf16 v[176:179],v[40:43],a[144:147],v[176:179]
buffer_load_dwordx4 v0,s[8:11],s64 offen offset:0 sc1 lds
v_mfma_f32_16x16x32_bf16 v[180:183],v[40:43],a[148:151],v[180:183]
buffer_load_dwordx2 v[242:243],v244,s[8:11],0 offen sc1
v_mfma_f32_16x16x32_bf16 v[184:187],v[40:43],a[152:155],v[184:187]
s_mov_b32 s73,0x80000000
v_mfma_f32_16x16x32_bf16 v[188:191],v[40:43],a[156:159],v[188:191]
s_waitcnt lgkmcnt(0)
v_or3_b32 v248,v248,v249,v250
v_or_b32 v248,v248,v251
v_mfma_f32_16x16x32_bf16 v[160:163],v[44:47],a[160:163],v[160:163]
buffer_load_dwordx4 v0,s[8:11],s64 offen offset:1024 sc1 lds
v_mfma_f32_16x16x32_bf16 v[164:167],v[44:47],a[164:167],v[164:167]
v_mfma_f32_16x16x32_bf16 v[168:171],v[44:47],a[168:171],v[168:171]
v_readfirstlane_b32 s72,v248
v_mfma_f32_16x16x32_bf16 v[172:175],v[44:47],a[172:175],v[172:175]
v_mfma_f32_16x16x32_bf16 v[176:179],v[44:47],a[176:179],v[176:179]
buffer_load_dwordx4 v0,s[8:11],s64 offen offset:2048 sc1 lds
v_mfma_f32_16x16x32_bf16 v[180:183],v[44:47],a[180:183],v[180:183]
v_mfma_f32_16x16x32_bf16 v[184:187],v[44:47],a[184:187],v[184:187]
v_mfma_f32_16x16x32_bf16 v[188:191],v[44:47],a[188:191],v[188:191]
v_mfma_f32_16x16x32_bf16 v[160:163],v[48:51],a[192:195],v[160:163]
buffer_load_dwordx4 v0,s[8:11],s64 offen offset:3072 sc1 lds
v_mfma_f32_16x16x32_bf16 v[164:167],v[48:51],a[196:199],v[164:167]
v_mfma_f32_16x16x32_bf16 v[168:171],v[48:51],a[200:203],v[168:171]
v_mfma_f32_16x16x32_bf16 v[172:175],v[48:51],a[204:207],v[172:175]
v_mfma_f32_16x16x32_bf16 v[176:179],v[48:51],a[208:211],v[176:179]
s_add_u32 m0,s57,24576
v_mfma_f32_16x16x32_bf16 v[180:183],v[48:51],a[212:215],v[180:183]
buffer_load_dwordx4 v0,s[8:11],s65 offen offset:0 sc1 lds
v_mfma_f32_16x16x32_bf16 v[184:187],v[48:51],a[216:219],v[184:187]
v_mfma_f32_16x16x32_bf16 v[188:191],v[48:51],a[220:223],v[188:191]
v_mfma_f32_16x16x32_bf16 v[160:163],v[52:55],a[224:227],v[160:163]
v_mfma_f32_16x16x32_bf16 v[164:167],v[52:55],a[228:231],v[164:167]
buffer_load_dwordx4 v0,s[8:11],s65 offen offset:1024 sc1 lds
v_mfma_f32_16x16x32_bf16 v[168:171],v[52:55],a[232:235],v[168:171]
v_mfma_f32_16x16x32_bf16 v[172:175],v[52:55],a[236:239],v[172:175]
v_mfma_f32_16x16x32_bf16 v[176:179],v[52:55],a[240:243],v[176:179]
v_mfma_f32_16x16x32_bf16 v[180:183],v[52:55],a[244:247],v[180:183]
v_mfma_f32_16x16x32_bf16 v[184:187],v[52:55],a[248:251],v[184:187]
v_mfma_f32_16x16x32_bf16 v[188:191],v[52:55],a[252:255],v[188:191]
v_mfma_f32_16x16x32_bf16 v[192:195],v[56:59],a[0:3],0
v_mfma_f32_16x16x32_bf16 v[196:199],v[56:59],a[4:7],0
v_mfma_f32_16x16x32_bf16 v[200:203],v[56:59],a[8:11],0
v_cvt_pk_bf16_f32 v24,v160,v164
v_cvt_pk_bf16_f32 v25,v168,v172
v_mfma_f32_16x16x32_bf16 v[204:207],v[56:59],a[12:15],0
v_cvt_pk_bf16_f32 v26,v176,v180
v_cvt_pk_bf16_f32 v27,v184,v188
v_mfma_f32_16x16x32_bf16 v[208:211],v[56:59],a[16:19],0
v_cvt_pk_bf16_f32 v28,v161,v165
v_cvt_pk_bf16_f32 v29,v169,v173
v_mfma_f32_16x16x32_bf16 v[212:215],v[56:59],a[20:23],0
v_cvt_pk_bf16_f32 v30,v177,v181
v_cvt_pk_bf16_f32 v31,v185,v189
v_mfma_f32_16x16x32_bf16 v[216:219],v[56:59],a[24:27],0
v_cvt_pk_bf16_f32 v32,v162,v166
v_cvt_pk_bf16_f32 v33,v170,v174
v_mfma_f32_16x16x32_bf16 v[220:223],v[56:59],a[28:31],0
v_cvt_pk_bf16_f32 v34,v178,v182
v_cvt_pk_bf16_f32 v35,v186,v190
v_mfma_f32_16x16x32_bf16 v[192:195],v[60:63],a[32:35],v[192:195]
v_cvt_pk_bf16_f32 v36,v163,v167
v_cvt_pk_bf16_f32 v37,v171,v175
v_mfma_f32_16x16x32_bf16 v[196:199],v[60:63],a[36:39],v[196:199]
v_cvt_pk_bf16_f32 v38,v179,v183
v_cvt_pk_bf16_f32 v39,v187,v191
v_mfma_f32_16x16x32_bf16 v[200:203],v[60:63],a[40:43],v[200:203]
v_mfma_f32_16x16x32_bf16 v[204:207],v[60:63],a[44:47],v[204:207]
v_mfma_f32_16x16x32_bf16 v[208:211],v[60:63],a[48:51],v[208:211]
v_mfma_f32_16x16x32_bf16 v[212:215],v[60:63],a[52:55],v[212:215]
v_mfma_f32_16x16x32_bf16 v[216:219],v[60:63],a[56:59],v[216:219]
v_mfma_f32_16x16x32_bf16 v[220:223],v[60:63],a[60:63],v[220:223]
v_mfma_f32_16x16x32_bf16 v[192:195],v[64:67],a[64:67],v[192:195]
v_mfma_f32_16x16x32_bf16 v[196:199],v[64:67],a[68:71],v[196:199]
v_mfma_f32_16x16x32_bf16 v[200:203],v[64:67],a[72:75],v[200:203]
v_mfma_f32_16x16x32_bf16 v[204:207],v[64:67],a[76:79],v[204:207]
v_mfma_f32_16x16x32_bf16 v[208:211],v[64:67],a[80:83],v[208:211]
v_mfma_f32_16x16x32_bf16 v[212:215],v[64:67],a[84:87],v[212:215]
v_mfma_f32_16x16x32_bf16 v[216:219],v[64:67],a[88:91],v[216:219]
v_mfma_f32_16x16x32_bf16 v[220:223],v[64:67],a[92:95],v[220:223]
v_mfma_f32_16x16x32_bf16 v[192:195],v[68:71],a[96:99],v[192:195]
v_mfma_f32_16x16x32_bf16 v[196:199],v[68:71],a[100:103],v[196:199]
v_mfma_f32_16x16x32_bf16 v[200:203],v[68:71],a[104:107],v[200:203]
v_mfma_f32_16x16x32_bf16 v[204:207],v[68:71],a[108:111],v[204:207]
v_mfma_f32_16x16x32_bf16 v[208:211],v[68:71],a[112:115],v[208:211]
s_add_u32 s62,s69,0
v_mfma_f32_16x16x32_bf16 v[212:215],v[68:71],a[116:119],v[212:215]
buffer_store_dwordx4 v[24:27],v5,s[8:11],s62 offen
v_mfma_f32_16x16x32_bf16 v[216:219],v[68:71],a[120:123],v[216:219]
v_mfma_f32_16x16x32_bf16 v[220:223],v[68:71],a[124:127],v[220:223]
v_mfma_f32_16x16x32_bf16 v[192:195],v[72:75],a[128:131],v[192:195]
v_mfma_f32_16x16x32_bf16 v[196:199],v[72:75],a[132:135],v[196:199]
s_add_u32 s62,s69,16384
v_mfma_f32_16x16x32_bf16 v[200:203],v[72:75],a[136:139],v[200:203]
buffer_store_dwordx4 v[28:31],v5,s[8:11],s62 offen
v_mfma_f32_16x16x32_bf16 v[204:207],v[72:75],a[140:143],v[204:207]
v_mfma_f32_16x16x32_bf16 v[208:211],v[72:75],a[144:147],v[208:211]
v_mfma_f32_16x16x32_bf16 v[212:215],v[72:75],a[148:151],v[212:215]
v_mfma_f32_16x16x32_bf16 v[216:219],v[72:75],a[152:155],v[216:219]
s_add_u32 s62,s69,32768
v_mfma_f32_16x16x32_bf16 v[220:223],v[72:75],a[156:159],v[220:223]
buffer_store_dwordx4 v[32:35],v5,s[8:11],s62 offen
v_mfma_f32_16x16x32_bf16 v[192:195],v[76:79],a[160:163],v[192:195]
v_mfma_f32_16x16x32_bf16 v[196:199],v[76:79],a[164:167],v[196:199]
v_mfma_f32_16x16x32_bf16 v[200:203],v[76:79],a[168:171],v[200:203]
v_mfma_f32_16x16x32_bf16 v[204:207],v[76:79],a[172:175],v[204:207]
s_add_u32 s62,s69,49152
v_mfma_f32_16x16x32_bf16 v[208:211],v[76:79],a[176:179],v[208:211]
buffer_store_dwordx4 v[36:39],v5,s[8:11],s62 offen
v_mfma_f32_16x16x32_bf16 v[212:215],v[76:79],a[180:183],v[212:215]
v_mfma_f32_16x16x32_bf16 v[216:219],v[76:79],a[184:187],v[216:219]
v_mfma_f32_16x16x32_bf16 v[220:223],v[76:79],a[188:191],v[220:223]
v_mfma_f32_16x16x32_bf16 v[192:195],v[80:83],a[192:195],v[192:195]
v_mfma_f32_16x16x32_bf16 v[196:199],v[80:83],a[196:199],v[196:199]
v_mfma_f32_16x16x32_bf16 v[192:195],v[84:87],a[224:227],v[192:195]
v_mfma_f32_16x16x32_bf16 v[196:199],v[84:87],a[228:231],v[196:199]
v_mfma_f32_16x16x32_bf16 v[200:203],v[80:83],a[200:203],v[200:203]
v_mfma_f32_16x16x32_bf16 v[204:207],v[80:83],a[204:207],v[204:207]
v_mfma_f32_16x16x32_bf16 v[200:203],v[84:87],a[232:235],v[200:203]
v_mfma_f32_16x16x32_bf16 v[204:207],v[84:87],a[236:239],v[204:207]
v_cvt_pk_bf16_f32 v40,v192,v196
v_cvt_pk_bf16_f32 v44,v193,v197
v_cvt_pk_bf16_f32 v48,v194,v198
v_mfma_f32_16x16x32_bf16 v[208:211],v[80:83],a[208:211],v[208:211]
v_cvt_pk_bf16_f32 v52,v195,v199
v_mfma_f32_16x16x32_bf16 v[212:215],v[80:83],a[212:215],v[212:215]
v_cvt_pk_bf16_f32 v41,v200,v204
v_cvt_pk_bf16_f32 v45,v201,v205
v_cvt_pk_bf16_f32 v49,v202,v206
v_mfma_f32_16x16x32_bf16 v[208:211],v[84:87],a[240:243],v[208:211]
v_cvt_pk_bf16_f32 v53,v203,v207
v_mfma_f32_16x16x32_bf16 v[212:215],v[84:87],a[244:247],v[212:215]
v_mfma_f32_16x16x32_bf16 v[216:219],v[80:83],a[216:219],v[216:219]
v_mfma_f32_16x16x32_bf16 v[220:223],v[80:83],a[220:223],v[220:223]
v_mfma_f32_16x16x32_bf16 v[216:219],v[84:87],a[248:251],v[216:219]
v_mfma_f32_16x16x32_bf16 v[220:223],v[84:87],a[252:255],v[220:223]
v_cvt_pk_bf16_f32 v42,v208,v212
v_cvt_pk_bf16_f32 v46,v209,v213
v_cvt_pk_bf16_f32 v50,v210,v214
v_cvt_pk_bf16_f32 v54,v211,v215
s_nop 3
v_cvt_pk_bf16_f32 v43,v216,v220
s_add_u32 s62,s69,262144
buffer_store_dwordx4 v[40:43],v5,s[8:11],s62 offen
v_cvt_pk_bf16_f32 v47,v217,v221
s_add_u32 s62,s69,278528
buffer_store_dwordx4 v[44:47],v5,s[8:11],s62 offen
v_cvt_pk_bf16_f32 v51,v218,v222
s_add_u32 s62,s69,294912
buffer_store_dwordx4 v[48:51],v5,s[8:11],s62 offen
v_cvt_pk_bf16_f32 v55,v219,v223
s_add_u32 s62,s69,311296
buffer_store_dwordx4 v[52:55],v5,s[8:11],s62 offen
s_cmp_lg_u32 s72,0
s_cbranch_scc1 L_aa_82
s_waitcnt vmcnt(8)
s_branch L_aa_92
L_aa_80:
ds_read_b128 v[24:27],v4 offset:0
ds_read_b128 v[28:31],v4 offset:1024
s_min_u32 s56,s32,s33
s_cmp_lt_u32 s77,64
s_cselect_b32 s56,s56,0
s_cmp_eq_u32 s56,0
s_cselect_b32 s72,0x80000000,0
v_mov_b32 v248,s72
s_or_b32 s64,s70,s72
s_or_b32 s65,s71,s72
s_cmp_lt_u32 s30,s31
s_cselect_b32 s65,0x80000000,s65
s_add_u32 s64,s64,s28
s_add_u32 s65,s65,s29
s_xor_b32 s58,s67,s40
s_xor_b32 s57,s67,s41
s_add_u32 m0,s58,0
s_waitcnt lgkmcnt(1)
v_mfma_f32_16x16x32_bf16 v[160:163],v[24:27],a[0:3],0
buffer_load_dwordx4 v0,s[8:11],s64 offen offset:0 sc1 lds
v_mfma_f32_16x16x32_bf16 v[164:167],v[24:27],a[4:7],0
ds_read_b128 v[32:35],v4 offset:2048
s_lshl_b32 s23,s51,5
v_mfma_f32_16x16x32_bf16 v[168:171],v[24:27],a[8:11],0
ds_read_b128 v[36:39],v4 offset:3072
s_add_u32 s23,s23,s68
v_mfma_f32_16x16x32_bf16 v[172:175],v[24:27],a[12:15],0
ds_read_b128 v[40:43],v4 offset:8192
s_lshl_b32 s24,s23,10
v_mfma_f32_16x16x32_bf16 v[176:179],v[24:27],a[16:19],0
buffer_load_dwordx4 v0,s[8:11],s64 offen offset:1024 sc1 lds
v_mfma_f32_16x16x32_bf16 v[180:183],v[24:27],a[20:23],0
ds_read_b128 v[44:47],v4 offset:9216
s_lshl_b32 s25,s51,10
v_mfma_f32_16x16x32_bf16 v[184:187],v[24:27],a[24:27],0
ds_read_b128 v[48:51],v4 offset:10240
s_add_u32 s25,s25,2883584
v_mfma_f32_16x16x32_bf16 v[188:191],v[24:27],a[28:31],0
ds_read_b128 v[52:55],v4 offset:11264
s_cmp_eq_u32 s23,s55
s_cselect_b32 s25,s25,s24
s_waitcnt lgkmcnt(6)
v_mfma_f32_16x16x32_bf16 v[160:163],v[28:31],a[32:35],v[160:163]
buffer_load_dwordx4 v0,s[8:11],s64 offen offset:2048 sc1 lds
v_mfma_f32_16x16x32_bf16 v[164:167],v[28:31],a[36:39],v[164:167]
ds_write_b32 v247,v248
s_add_u32 s25,s25,8388608
v_mfma_f32_16x16x32_bf16 v[168:171],v[28:31],a[40:43],v[168:171]
ds_read_b128 v[56:59],v4 offset:4096
s_mov_b32 s6,268435456
v_mfma_f32_16x16x32_bf16 v[172:175],v[28:31],a[44:47],v[172:175]
ds_read_b128 v[60:63],v4 offset:5120
s_cmp_eq_u32 s31,0
s_cselect_b32 s25,s24,s25
s_cselect_b64 s[4:5],s[16:17],s[44:45]
s_cmov_b32 s6,2097152
v_mfma_f32_16x16x32_bf16 v[176:179],v[28:31],a[48:51],v[176:179]
buffer_load_dwordx4 v0,s[8:11],s64 offen offset:3072 sc1 lds
v_mfma_f32_16x16x32_bf16 v[180:183],v[28:31],a[52:55],v[180:183]
ds_read_b128 v[64:67],v4 offset:6144
v_mfma_f32_16x16x32_bf16 v[184:187],v[28:31],a[56:59],v[184:187]
ds_read_b128 v[68:71],v4 offset:7168
v_mfma_f32_16x16x32_bf16 v[188:191],v[28:31],a[60:63],v[188:191]
ds_read_b128 v[72:75],v4 offset:12288
s_waitcnt lgkmcnt(11)
v_mfma_f32_16x16x32_bf16 v[160:163],v[32:35],a[64:67],v[160:163]
ds_read_b128 v[76:79],v4 offset:13312
s_add_u32 m0,s58,4096
v_mfma_f32_16x16x32_bf16 v[164:167],v[32:35],a[68:71],v[164:167]
ds_read_b128 v[80:83],v4 offset:14336
s_add_u32 s64,s64,4096
v_mfma_f32_16x16x32_bf16 v[168:171],v[32:35],a[72:75],v[168:171]
buffer_load_dwordx4 v0,s[8:11],s64 offen offset:0 sc1 lds
v_mfma_f32_16x16x32_bf16 v[172:175],v[32:35],a[76:79],v[172:175]
ds_read_b128 v[84:87],v4 offset:15360
v_mfma_f32_16x16x32_bf16 v[176:179],v[32:35],a[80:83],v[176:179]
buffer_load_dwordx4 v[224:227],v0,s[4:7],s25 offen sc1
v_mfma_f32_16x16x32_bf16 v[180:183],v[32:35],a[84:87],v[180:183]
s_lshr_b32 s24,s55,5
s_cmp_lt_u32 s51,s24
s_cselect_b32 s24,1,2
v_mfma_f32_16x16x32_bf16 v[184:187],v[32:35],a[88:91],v[184:187]
buffer_load_dwordx4 v0,s[8:11],s64 offen offset:1024 sc1 lds
v_mfma_f32_16x16x32_bf16 v[188:191],v[32:35],a[92:95],v[188:191]
v_mov_b32 v252,s24
s_lshl2_add_u32 s25,s51,11018240
s_waitcnt lgkmcnt(13)
v_mfma_f32_16x16x32_bf16 v[160:163],v[36:39],a[96:99],v[160:163]
s_waitcnt lgkmcnt(0)
s_barrier
s_lshl_b32 s24,s68,16
v_mfma_f32_16x16x32_bf16 v[164:167],v[36:39],a[100:103],v[164:167]
ds_read_b128 v[248:251],v245
s_add_u32 s24,s24,s31
v_mfma_f32_16x16x32_bf16 v[168:171],v[36:39],a[104:107],v[168:171]
buffer_load_dwordx4 v0,s[8:11],s64 offen offset:2048 sc1 lds
v_mfma_f32_16x16x32_bf16 v[172:175],v[36:39],a[108:111],v[172:175]
s_add_u32 s24,s24,s86
s_cmp_eq_u32 s24,1537
s_cselect_b32 s25,s25,0x80000000
v_mfma_f32_16x16x32_bf16 v[176:179],v[36:39],a[112:115],v[176:179]
buffer_store_dword v252,off,s[8:11],s25 sc1
v_mfma_f32_16x16x32_bf16 v[180:183],v[36:39],a[116:119],v[180:183]
s_bitcmp1_b64 s[38:39],s51
s_cselect_b32 s24,128,0
s_lshl_b32 s23,s51,13
v_mfma_f32_16x16x32_bf16 v[184:187],v[36:39],a[120:123],v[184:187]
buffer_load_dwordx4 v0,s[8:11],s64 offen offset:3072 sc1 lds
v_mfma_f32_16x16x32_bf16 v[188:191],v[36:39],a[124:127],v[188:191]
s_waitcnt lgkmcnt(0)
v_or3_b32 v248,v248,v249,v250
v_or_b32 v248,v248,v251
v_mfma_f32_16x16x32_bf16 v[160:163],v[40:43],a[128:131],v[160:163]
s_lshl2_add_u32 s23,s68,s23
s_add_u32 s23,s23,10487168
s_add_u32 s23,s23,s24
v_mfma_f32_16x16x32_bf16 v[164:167],v[40:43],a[132:135],v[164:167]
buffer_load_dword v246,off,s[8:11],s23 sc1
v_mfma_f32_16x16x32_bf16 v[168:171],v[40:43],a[136:139],v[168:171]
s_add_u32 m0,s58,8192
s_add_u32 s64,s64,4096
v_readfirstlane_b32 s72,v248
v_mfma_f32_16x16x32_bf16 v[172:175],v[40:43],a[140:143],v[172:175]
buffer_load_dwordx4 v0,s[8:11],s64 offen offset:0 sc1 lds
v_mfma_f32_16x16x32_bf16 v[176:179],v[40:43],a[144:147],v[176:179]
s_waitcnt vmcnt(12)
v_lshrrev_b32 v244,4,v1
s_sub_u32 s23,s77,7
v_mfma_f32_16x16x32_bf16 v[180:183],v[40:43],a[148:151],v[180:183]
buffer_store_dword v20,off,s[8:11],s73 sc1
v_mfma_f32_16x16x32_bf16 v[184:187],v[40:43],a[152:155],v[184:187]
s_mov_b32 s73,0x80000000
v_add_u32 v244,s23,v244
v_max_i32 v244,0,v244
v_mfma_f32_16x16x32_bf16 v[188:191],v[40:43],a[156:159],v[188:191]
buffer_load_dwordx4 v0,s[8:11],s64 offen offset:1024 sc1 lds
v_mfma_f32_16x16x32_bf16 v[160:163],v[44:47],a[160:163],v[160:163]
v_lshl_add_u32 v244,v244,13,v21
v_mfma_f32_16x16x32_bf16 v[164:167],v[44:47],a[164:167],v[164:167]
buffer_load_dwordx2 v[242:243],v244,s[8:11],0 offen sc1
v_mfma_f32_16x16x32_bf16 v[168:171],v[44:47],a[168:171],v[168:171]
v_mfma_f32_16x16x32_bf16 v[172:175],v[44:47],a[172:175],v[172:175]
buffer_load_dwordx4 v0,s[8:11],s64 offen offset:2048 sc1 lds
v_mfma_f32_16x16x32_bf16 v[176:179],v[44:47],a[176:179],v[176:179]
v_mfma_f32_16x16x32_bf16 v[180:183],v[44:47],a[180:183],v[180:183]
v_mfma_f32_16x16x32_bf16 v[184:187],v[44:47],a[184:187],v[184:187]
v_mfma_f32_16x16x32_bf16 v[188:191],v[44:47],a[188:191],v[188:191]
buffer_load_dwordx4 v0,s[8:11],s64 offen offset:3072 sc1 lds
v_mfma_f32_16x16x32_bf16 v[160:163],v[48:51],a[192:195],v[160:163]
v_mfma_f32_16x16x32_bf16 v[164:167],v[48:51],a[196:199],v[164:167]
v_mfma_f32_16x16x32_bf16 v[168:171],v[48:51],a[200:203],v[168:171]
v_mfma_f32_16x16x32_bf16 v[172:175],v[48:51],a[204:207],v[172:175]
s_add_u32 m0,s57,24576
v_mfma_f32_16x16x32_bf16 v[176:179],v[48:51],a[208:211],v[176:179]
buffer_load_dwordx4 v0,s[8:11],s65 offen offset:0 sc1 lds
v_mfma_f32_16x16x32_bf16 v[180:183],v[48:51],a[212:215],v[180:183]
v_mfma_f32_16x16x32_bf16 v[184:187],v[48:51],a[216:219],v[184:187]
v_mfma_f32_16x16x32_bf16 v[188:191],v[48:51],a[220:223],v[188:191]
v_mfma_f32_16x16x32_bf16 v[160:163],v[52:55],a[224:227],v[160:163]
buffer_load_dwordx4 v0,s[8:11],s65 offen offset:1024 sc1 lds
v_mfma_f32_16x16x32_bf16 v[164:167],v[52:55],a[228:231],v[164:167]
v_mfma_f32_16x16x32_bf16 v[168:171],v[52:55],a[232:235],v[168:171]
v_mfma_f32_16x16x32_bf16 v[172:175],v[52:55],a[236:239],v[172:175]
v_mfma_f32_16x16x32_bf16 v[176:179],v[52:55],a[240:243],v[176:179]
v_mfma_f32_16x16x32_bf16 v[180:183],v[52:55],a[244:247],v[180:183]
v_mfma_f32_16x16x32_bf16 v[184:187],v[52:55],a[248:251],v[184:187]
v_mfma_f32_16x16x32_bf16 v[188:191],v[52:55],a[252:255],v[188:191]
v_mfma_f32_16x16x32_bf16 v[192:195],v[56:59],a[0:3],0
v_mfma_f32_16x16x32_bf16 v[196:199],v[56:59],a[4:7],0
v_mfma_f32_16x16x32_bf16 v[200:203],v[56:59],a[8:11],0
v_cvt_pk_bf16_f32 v24,v160,v164
v_cvt_pk_bf16_f32 v25,v168,v172
v_mfma_f32_16x16x32_bf16 v[204:207],v[56:59],a[12:15],0
v_cvt_pk_bf16_f32 v26,v176,v180
v_cvt_pk_bf16_f32 v27,v184,v188
v_mfma_f32_16x16x32_bf16 v[208:211],v[56:59],a[16:19],0
v_cvt_pk_bf16_f32 v28,v161,v165
v_cvt_pk_bf16_f32 v29,v169,v173
v_mfma_f32_16x16x32_bf16 v[212:215],v[56:59],a[20:23],0
v_cvt_pk_bf16_f32 v30,v177,v181
v_cvt_pk_bf16_f32 v31,v185,v189
v_mfma_f32_16x16x32_bf16 v[216:219],v[56:59],a[24:27],0
v_cvt_pk_bf16_f32 v32,v162,v166
v_cvt_pk_bf16_f32 v33,v170,v174
v_mfma_f32_16x16x32_bf16 v[220:223],v[56:59],a[28:31],0
v_cvt_pk_bf16_f32 v34,v178,v182
v_cvt_pk_bf16_f32 v35,v186,v190
v_mfma_f32_16x16x32_bf16 v[192:195],v[60:63],a[32:35],v[192:195]
v_cvt_pk_bf16_f32 v36,v163,v167
v_cvt_pk_bf16_f32 v37,v171,v175
v_mfma_f32_16x16x32_bf16 v[196:199],v[60:63],a[36:39],v[196:199]
v_cvt_pk_bf16_f32 v38,v179,v183
v_cvt_pk_bf16_f32 v39,v187,v191
v_mfma_f32_16x16x32_bf16 v[200:203],v[60:63],a[40:43],v[200:203]
v_mfma_f32_16x16x32_bf16 v[204:207],v[60:63],a[44:47],v[204:207]
v_mfma_f32_16x16x32_bf16 v[208:211],v[60:63],a[48:51],v[208:211]
v_mfma_f32_16x16x32_bf16 v[212:215],v[60:63],a[52:55],v[212:215]
v_mfma_f32_16x16x32_bf16 v[216:219],v[60:63],a[56:59],v[216:219]
v_mfma_f32_16x16x32_bf16 v[220:223],v[60:63],a[60:63],v[220:223]
v_mfma_f32_16x16x32_bf16 v[192:195],v[64:67],a[64:67],v[192:195]
v_mfma_f32_16x16x32_bf16 v[196:199],v[64:67],a[68:71],v[196:199]
v_mfma_f32_16x16x32_bf16 v[200:203],v[64:67],a[72:75],v[200:203]
v_mfma_f32_16x16x32_bf16 v[204:207],v[64:67],a[76:79],v[204:207]
v_mfma_f32_16x16x32_bf16 v[208:211],v[64:67],a[80:83],v[208:211]
v_mfma_f32_16x16x32_bf16 v[212:215],v[64:67],a[84:87],v[212:215]
v_mfma_f32_16x16x32_bf16 v[216:219],v[64:67],a[88:91],v[216:219]
v_mfma_f32_16x16x32_bf16 v[220:223],v[64:67],a[92:95],v[220:223]
v_mfma_f32_16x16x32_bf16 v[192:195],v[68:71],a[96:99],v[192:195]
v_mfma_f32_16x16x32_bf16 v[196:199],v[68:71],a[100:103],v[196:199]
v_mfma_f32_16x16x32_bf16 v[200:203],v[68:71],a[104:107],v[200:203]
v_mfma_f32_16x16x32_bf16 v[204:207],v[68:71],a[108:111],v[204:207]
v_mfma_f32_16x16x32_bf16 v[208:211],v[68:71],a[112:115],v[208:211]
s_add_u32 s62,s69,0
v_mfma_f32_16x16x32_bf16 v[212:215],v[68:71],a[116:119],v[212:215]
buffer_store_dwordx4 v[24:27],v5,s[8:11],s62 offen
v_mfma_f32_16x16x32_bf16 v[216:219],v[68:71],a[120:123],v[216:219]
v_mfma_f32_16x16x32_bf16 v[220:223],v[68:71],a[124:127],v[220:223]
v_mfma_f32_16x16x32_bf16 v[192:195],v[72:75],a[128:131],v[192:195]
v_mfma_f32_16x16x32_bf16 v[196:199],v[72:75],a[132:135],v[196:199]
s_add_u32 s62,s69,16384
v_mfma_f32_16x16x32_bf16 v[200:203],v[72:75],a[136:139],v[200:203]
buffer_store_dwordx4 v[28:31],v5,s[8:11],s62 offen
v_mfma_f32_16x16x32_bf16 v[204:207],v[72:75],a[140:143],v[204:207]
v_mfma_f32_16x16x32_bf16 v[208:211],v[72:75],a[144:147],v[208:211]
v_mfma_f32_16x16x32_bf16 v[212:215],v[72:75],a[148:151],v[212:215]
v_mfma_f32_16x16x32_bf16 v[216:219],v[72:75],a[152:155],v[216:219]
s_add_u32 s62,s69,32768
v_mfma_f32_16x16x32_bf16 v[220:223],v[72:75],a[156:159],v[220:223]
buffer_store_dwordx4 v[32:35],v5,s[8:11],s62 offen
v_mfma_f32_16x16x32_bf16 v[192:195],v[76:79],a[160:163],v[192:195]
v_mfma_f32_16x16x32_bf16 v[196:199],v[76:79],a[164:167],v[196:199]
v_mfma_f32_16x16x32_bf16 v[200:203],v[76:79],a[168:171],v[200:203]
v_mfma_f32_16x16x32_bf16 v[204:207],v[76:79],a[172:175],v[204:207]
s_add_u32 s62,s69,49152
v_mfma_f32_16x16x32_bf16 v[208:211],v[76:79],a[176:179],v[208:211]
buffer_store_dwordx4 v[36:39],v5,s[8:11],s62 offen
v_mfma_f32_16x16x32_bf16 v[212:215],v[76:79],a[180:183],v[212:215]
v_mfma_f32_16x16x32_bf16 v[216:219],v[76:79],a[184:187],v[216:219]
v_mfma_f32_16x16x32_bf16 v[220:223],v[76:79],a[188:191],v[220:223]
v_mfma_f32_16x16x32_bf16 v[192:195],v[80:83],a[192:195],v[192:195]
v_mfma_f32_16x16x32_bf16 v[196:199],v[80:83],a[196:199],v[196:199]
v_mfma_f32_16x16x32_bf16 v[192:195],v[84:87],a[224:227],v[192:195]
v_mfma_f32_16x16x32_bf16 v[196:199],v[84:87],a[228:231],v[196:199]
v_mfma_f32_16x16x32_bf16 v[200:203],v[80:83],a[200:203],v[200:203]
v_mfma_f32_16x16x32_bf16 v[204:207],v[80:83],a[204:207],v[204:207]
v_mfma_f32_16x16x32_bf16 v[200:203],v[84:87],a[232:235],v[200:203]
v_mfma_f32_16x16x32_bf16 v[204:207],v[84:87],a[236:239],v[204:207]
v_cvt_pk_bf16_f32 v40,v192,v196
v_cvt_pk_bf16_f32 v44,v193,v197
v_cvt_pk_bf16_f32 v48,v194,v198
v_mfma_f32_16x16x32_bf16 v[208:211],v[80:83],a[208:211],v[208:211]
v_cvt_pk_bf16_f32 v52,v195,v199
v_mfma_f32_16x16x32_bf16 v[212:215],v[80:83],a[212:215],v[212:215]
v_cvt_pk_bf16_f32 v41,v200,v204
v_cvt_pk_bf16_f32 v45,v201,v205
v_cvt_pk_bf16_f32 v49,v202,v206
v_mfma_f32_16x16x32_bf16 v[208:211],v[84:87],a[240:243],v[208:211]
v_cvt_pk_bf16_f32 v53,v203,v207
v_mfma_f32_16x16x32_bf16 v[212:215],v[84:87],a[244:247],v[212:215]
v_mfma_f32_16x16x32_bf16 v[216:219],v[80:83],a[216:219],v[216:219]
v_mfma_f32_16x16x32_bf16 v[220:223],v[80:83],a[220:223],v[220:223]
v_mfma_f32_16x16x32_bf16 v[216:219],v[84:87],a[248:251],v[216:219]
v_mfma_f32_16x16x32_bf16 v[220:223],v[84:87],a[252:255],v[220:223]
v_cvt_pk_bf16_f32 v42,v208,v212
v_cvt_pk_bf16_f32 v46,v209,v213
v_cvt_pk_bf16_f32 v50,v210,v214
v_cvt_pk_bf16_f32 v54,v211,v215
s_nop 3
v_cvt_pk_bf16_f32 v43,v216,v220
s_add_u32 s62,s69,262144
buffer_store_dwordx4 v[40:43],v5,s[8:11],s62 offen
v_cvt_pk_bf16_f32 v47,v217,v221
s_add_u32 s62,s69,278528
buffer_store_dwordx4 v[44:47],v5,s[8:11],s62 offen
v_cvt_pk_bf16_f32 v51,v218,v222
s_add_u32 s62,s69,294912
buffer_store_dwordx4 v[48:51],v5,s[8:11],s62 offen
v_cvt_pk_bf16_f32 v55,v219,v223
s_add_u32 s62,s69,311296
buffer_store_dwordx4 v[52:55],v5,s[8:11],s62 offen
s_cmp_lg_u32 s72,0
s_cbranch_scc1 L_aa_82
s_waitcnt vmcnt(8)
L_aa_92:
s_barrier
s_cmp_lt_u32 s30,s31
s_cbranch_scc1 L_ao_99
s_xor_b32 s67,s67,65536
s_and_b32 s56,s50,2048
s_lshl_b32 s56,s56,4
s_add_u32 s56,s56,s67
v_add_u32 v2,s56,v0
s_and_b32 s56,s50,1024
s_lshl_b32 s56,s56,2
v_add_u32 v238,s56,v2
s_mov_b32 s76,s71
s_mov_b32 s53,s77
ds_read_b128 v[24:27],v238 offset:16384
ds_read_b128 v[40:43],v2 offset:0
ds_read_b128 v[56:59],v2 offset:4096
ds_read_b128 v[28:31],v238 offset:17408
ds_read_b128 v[44:47],v2 offset:1024
ds_read_b128 v[60:63],v2 offset:5120
ds_read_b128 v[32:35],v238 offset:18432
ds_read_b128 v[48:51],v2 offset:2048
ds_read_b128 v[64:67],v2 offset:6144
ds_read_b128 v[36:39],v238 offset:19456
ds_read_b128 v[52:55],v2 offset:3072
ds_read_b128 v[68:71],v2 offset:7168
s_waitcnt lgkmcnt(9)
v_mfma_f32_16x16x32_bf16 v[128:131],v[40:43],v[24:27],v[8:11]
ds_read_b128 v[72:75],v2 offset:24576
v_mfma_f32_16x16x32_bf16 v[132:135],v[56:59],v[24:27],v[12:15]
ds_read_b128 v[76:79],v2 offset:25600
s_waitcnt lgkmcnt(8)
v_mfma_f32_16x16x32_bf16 v[128:131],v[44:47],v[28:31],v[128:131]
ds_read_b128 v[80:83],v2 offset:26624
v_mfma_f32_16x16x32_bf16 v[132:135],v[60:63],v[28:31],v[132:135]
ds_read_b128 v[84:87],v2 offset:27648
s_waitcnt lgkmcnt(7)
v_mfma_f32_16x16x32_bf16 v[128:131],v[48:51],v[32:35],v[128:131]
ds_read_b128 v[88:91],v2 offset:8192
v_mfma_f32_16x16x32_bf16 v[132:135],v[64:67],v[32:35],v[132:135]
ds_read_b128 v[92:95],v2 offset:9216
s_waitcnt lgkmcnt(6)
v_mfma_f32_16x16x32_bf16 v[128:131],v[52:55],v[36:39],v[128:131]
ds_read_b128 v[96:99],v2 offset:10240
v_mfma_f32_16x16x32_bf16 v[132:135],v[68:71],v[36:39],v[132:135]
ds_read_b128 v[100:103],v2 offset:11264
s_waitcnt lgkmcnt(4)
s_mov_b32 vcc_lo,0x33333333
s_mov_b32 vcc_hi,0x33333333
v_mfma_f32_16x16x32_bf16 v[136:139],v[72:75],v[24:27],0
ds_read_b128 v[104:107],v2 offset:12288
v_max3_u32 v238,v72,v73,v74
v_max3_u32 v238,v74,v75,v238
v_cndmask_b32_dpp v120,v72,v74,vcc quad_perm:[0,1,0,1] row_mask:0xf bank_mask:0xf
v_cndmask_b32_dpp v121,v73,v75,vcc quad_perm:[0,1,0,1] row_mask:0xf bank_mask:0xf
v_mfma_f32_16x16x32_bf16 v[136:139],v[76:79],v[28:31],v[136:139]
ds_read_b128 v[108:111],v2 offset:13312
v_max3_u32 v238,v76,v77,v238
v_max3_u32 v238,v78,v79,v238
v_cndmask_b32_dpp v122,v76,v78,vcc quad_perm:[0,1,0,1] row_mask:0xf bank_mask:0xf
v_cndmask_b32_dpp v123,v77,v79,vcc quad_perm:[0,1,0,1] row_mask:0xf bank_mask:0xf
v_mfma_f32_16x16x32_bf16 v[136:139],v[80:83],v[32:35],v[136:139]
ds_read_b128 v[112:115],v2 offset:14336
v_max3_u32 v238,v80,v81,v238
v_max3_u32 v238,v82,v83,v238
v_cndmask_b32_dpp v124,v80,v82,vcc quad_perm:[0,1,0,1] row_mask:0xf bank_mask:0xf
v_cndmask_b32_dpp v125,v81,v83,vcc quad_perm:[0,1,0,1] row_mask:0xf bank_mask:0xf
v_mfma_f32_16x16x32_bf16 v[136:139],v[84:87],v[36:39],v[136:139]
ds_read_b128 v[116:119],v2 offset:15360
v_max3_u32 v238,v84,v85,v238
v_max3_u32 v238,v86,v87,v238
v_cndmask_b32_dpp v126,v84,v86,vcc quad_perm:[0,1,0,1] row_mask:0xf bank_mask:0xf
v_cndmask_b32_dpp v127,v85,v87,vcc quad_perm:[0,1,0,1] row_mask:0xf bank_mask:0xf
v_cmp_eq_u32 vcc,-1,v238
s_cmp_eq_u32 s30,0
s_cbranch_scc1 L_aa_81
s_cmp_lg_u64 vcc,0
s_cselect_b32 s27,1,0
s_andn2_b32 s57,s27,s31
s_add_u32 s66,s66,4
s_bfe_u32 s56,s66,0x10002
s_bitset0_b32 s37,s56
s_lshl_b32 s56,s57,s56
s_or_b32 s37,s37,s56
s_or_b32 s56,s37,s66
v_mov_b32 v22,s56
s_xor_b32 s69,s69,524288
s_waitcnt vmcnt(0) lgkmcnt(0)
buffer_store_dword v22,off,s[8:11],s74
s_cmp_lg_u32 s86,1536
s_cbranch_scc1 L_ae_102
s_mov_b32 s77,s35
s_mov_b32 s30,0
s_lshl_b32 s56,s77,5
s_add_u32 s56,s56,s68
s_mul_i32 s70,s56,24576
s_lshl_b32 s71,s56,12
s_lshl_b32 s59,s77,13
s_lshl2_add_u32 s59,s68,s59
s_add_u32 s59,s59,10485760
s_buffer_load_dword s32,s[8:11],s59
s_mov_b32 s33,1
s_add_u32 s70,s70,100663296
s_add_u32 s71,s71,41943040
v_mov_b32 v19,s59
s_branch L_af_103
L_ae_102:
s_ff1_i32_b64 s77,s[84:85]
s_bitset0_b64 s[84:85],s77
s_min_u32 s77,s77,64
s_lshr_b32 s61,s55,5
s_lshl_b32 s56,s77,5
s_add_u32 s56,s56,s68
s_mul_i32 s70,s56,24576
s_lshl_b32 s71,s56,12
s_lshl_b32 s59,s77,13
s_lshl2_add_u32 s59,s68,s59
s_add_u32 s59,s59,10486144
s_cmp_lt_u32 s77,s61
s_cselect_b32 s57,0,16777216
s_mov_b32 s60,s59
s_buffer_load_dword s33,s[8:11],s60
s_add_u32 s71,s71,s57
s_add_u32 s71,s71,58720256
s_cmp_eq_u32 s77,s61
s_cselect_b32 s57,50331648,0
s_cselect_b32 s58,1536,0
s_add_u32 s59,s59,s58
s_buffer_load_dword s32,s[8:11],s59
s_add_u32 s70,s70,s57
s_add_u32 s70,s70,150994944
v_mov_b32 v19,s59
v_writelane_b32 v19,s60,1
L_af_103:
s_cmp_ge_u32 s53,60
s_cbranch_scc1 L_a4_104
L_a4_105:
s_and_b32 s27,s27,s31
s_cbranch_scc1 L_ac_107
L_acb_108:
v_max3_f32 v238,v128,v129,v130
v_max3_f32 v239,v131,v132,v133
v_max3_f32 v238,v134,v135,v238
v_max3_f32 v239,v138,v139,v239
v_max_f32 v238,v238,v239
v_max_f32 v239,v238,v239
v_pk_mul_f32 v[128:129],v[128:129],v[152:153] op_sel_hi:[1,0]
v_pk_mul_f32 v[130:131],v[130:131],v[152:153] op_sel_hi:[1,0]
v_permlane16_swap_b32 v238,v239
v_max_f32 v238,v238,v239
v_max_f32 v239,v238,v239
v_pk_mul_f32 v[132:133],v[132:133],v[152:153] op_sel_hi:[1,0]
v_pk_mul_f32 v[134:135],v[134:135],v[152:153] op_sel_hi:[1,0]
v_permlane32_swap_b32 v238,v239
v_max_f32 v238,v238,v239
v_mul_f32 v238,v152,v238
v_pk_mul_f32 v[138:139],v[138:139],v[152:153] op_sel_hi:[1,0]
buffer_load_dword v17,v16,s[8:11],s87 offen sc1
v_pk_add_f32 v[128:129],v[128:129],v[238:239] op_sel_hi:[1,0] neg_lo:[0,1] neg_hi:[0,1]
v_pk_add_f32 v[130:131],v[130:131],v[238:239] op_sel_hi:[1,0] neg_lo:[0,1] neg_hi:[0,1]
v_pk_add_f32 v[132:133],v[132:133],v[238:239] op_sel_hi:[1,0] neg_lo:[0,1] neg_hi:[0,1]
v_pk_add_f32 v[134:135],v[134:135],v[238:239] op_sel_hi:[1,0] neg_lo:[0,1] neg_hi:[0,1]
v_pk_add_f32 v[138:139],v[138:139],v[238:239] op_sel_hi:[1,0] neg_lo:[0,1] neg_hi:[0,1]
v_exp_f32 v128,v128
v_exp_f32 v129,v129
v_exp_f32 v130,v130
v_exp_f32 v131,v131
v_exp_f32 v132,v132
v_exp_f32 v133,v133
v_exp_f32 v134,v134
v_exp_f32 v135,v135
v_exp_f32 v138,v138
v_exp_f32 v139,v139
v_pk_add_f32 v[148:149],v[128:129],v[130:131]
v_pk_add_f32 v[150:151],v[132:133],v[134:135]
v_pk_add_f32 v[148:149],v[148:149],v[138:139]
v_pk_add_f32 v[148:149],v[148:149],v[150:151]
v_add_f32 v150,v148,v149
v_add_f32 v151,v148,v149
s_nop 1
v_permlane16_swap_b32 v150,v151
v_add_f32 v148,v150,v151
v_add_f32 v149,v150,v151
s_nop 1
v_permlane32_swap_b32 v148,v149
v_add_f32 v148,v148,v149
v_rcp_f32 v148,v148
s_waitcnt vmcnt(0)
v_cmp_gt_u32 vcc,s66,v17
v_pk_mul_f32 v[138:139],v[138:139],v[148:149] op_sel_hi:[1,0]
v_pk_mul_f32 v[128:129],v[128:129],v[148:149] op_sel_hi:[1,0]
v_pk_mul_f32 v[130:131],v[130:131],v[148:149] op_sel_hi:[1,0]
v_pk_mul_f32 v[132:133],v[132:133],v[148:149] op_sel_hi:[1,0]
v_pk_mul_f32 v[134:135],v[134:135],v[148:149] op_sel_hi:[1,0]
s_cbranch_vccnz L_ap_110
L_apb_111:
s_xor_b32 s34,s69,524288
buffer_load_dwordx4 v[192:195],v7,s[8:11],s34 offen sc1
s_bfe_u32 s56,s66,0x10002
v_lshrrev_b32 v238,s56,v17
v_and_b32 v238,1,v238
v_cmp_ne_u32 vcc,0,v238
v_cvt_pk_bf16_f32 v144,v138,v139
v_cvt_pk_bf16_f32 v147,v138,v139
v_cvt_pk_bf16_f32 v140,v128,v129
v_cvt_pk_bf16_f32 v141,v130,v131
v_cvt_pk_bf16_f32 v142,v132,v133
v_cvt_pk_bf16_f32 v143,v134,v135
s_cbranch_vccnz L_ak_101
s_add_u32 s36,s36,4
v_mfma_f32_16x16x16_bf16 v[24:27],v[120:121],v[144:145],0
s_add_u32 s34,s34,4096
v_mfma_f32_16x16x16_bf16 v[28:31],v[120:121],v[146:147],0
buffer_load_dwordx4 v[196:199],v7,s[8:11],s34 offen sc1
v_mfma_f32_16x16x16_bf16 v[32:35],v[122:123],v[144:145],0
s_add_u32 s34,s34,4096
v_mfma_f32_16x16x16_bf16 v[36:39],v[122:123],v[146:147],0
buffer_load_dwordx4 v[200:203],v7,s[8:11],s34 offen sc1
v_mfma_f32_16x16x16_bf16 v[40:43],v[124:125],v[144:145],0
s_add_u32 s34,s34,4096
v_mfma_f32_16x16x16_bf16 v[44:47],v[124:125],v[146:147],0
buffer_load_dwordx4 v[204:207],v7,s[8:11],s34 offen sc1
v_mfma_f32_16x16x16_bf16 v[48:51],v[126:127],v[144:145],0
s_add_u32 s34,s34,4096
v_mfma_f32_16x16x16_bf16 v[52:55],v[126:127],v[146:147],0
buffer_load_dwordx4 v[208:211],v7,s[8:11],s34 offen sc1
v_mfma_f32_16x16x32_bf16 v[24:27],v[88:91],v[140:143],v[24:27]
s_add_u32 s34,s34,4096
v_mfma_f32_16x16x32_bf16 v[28:31],v[92:95],v[140:143],v[28:31]
buffer_load_dwordx4 v[212:215],v7,s[8:11],s34 offen sc1
v_mfma_f32_16x16x32_bf16 v[32:35],v[96:99],v[140:143],v[32:35]
s_add_u32 s34,s34,4096
v_mfma_f32_16x16x32_bf16 v[36:39],v[100:103],v[140:143],v[36:39]
buffer_load_dwordx4 v[216:219],v7,s[8:11],s34 offen sc1
v_cvt_pk_bf16_f32 v72,v24,v28
v_cvt_pk_bf16_f32 v73,v25,v29
v_mfma_f32_16x16x32_bf16 v[40:43],v[104:107],v[140:143],v[40:43]
s_add_u32 s34,s34,4096
v_cvt_pk_bf16_f32 v74,v26,v30
v_cvt_pk_bf16_f32 v75,v27,v31
v_mfma_f32_16x16x32_bf16 v[44:47],v[108:111],v[140:143],v[44:47]
ds_write_b128 v3,v[72:75] offset:0
v_cvt_pk_bf16_f32 v76,v32,v36
v_cvt_pk_bf16_f32 v77,v33,v37
v_mfma_f32_16x16x32_bf16 v[48:51],v[112:115],v[140:143],v[48:51]
buffer_load_dwordx4 v[220:223],v7,s[8:11],s34 offen sc1
v_cvt_pk_bf16_f32 v78,v34,v38
v_cvt_pk_bf16_f32 v79,v35,v39
v_mfma_f32_16x16x32_bf16 v[52:55],v[116:119],v[140:143],v[52:55]
ds_write_b128 v3,v[76:79] offset:1024
v_cvt_pk_bf16_f32 v80,v40,v44
v_cvt_pk_bf16_f32 v81,v41,v45
v_cvt_pk_bf16_f32 v82,v42,v46
v_cvt_pk_bf16_f32 v83,v43,v47
ds_write_b128 v3,v[80:83] offset:2048
s_nop 1
v_cvt_pk_bf16_f32 v84,v48,v52
v_cvt_pk_bf16_f32 v85,v49,v53
v_cvt_pk_bf16_f32 v86,v50,v54
v_cvt_pk_bf16_f32 v87,v51,v55
ds_write_b128 v3,v[84:87] offset:3072
s_cmp_eq_u32 s31,0
s_cbranch_scc1 L_ah_109
s_waitcnt lgkmcnt(0)
s_barrier
s_mov_b32 s26,s51
s_mov_b32 s51,s53
s_branch L_aa_93
L_ah_109:
s_cmp_ge_u32 s35,64
s_cbranch_scc1 L_a1_112
L_a2_113:
s_waitcnt vmcnt(7)
v_mfma_f32_16x16x32_bf16 v[160:163],v[156:159],v[192:195],0
s_waitcnt vmcnt(6)
v_mfma_f32_16x16x32_bf16 v[160:163],v[156:159],v[196:199],v[160:163]
s_waitcnt vmcnt(5)
v_mfma_f32_16x16x32_bf16 v[160:163],v[156:159],v[200:203],v[160:163]
s_waitcnt vmcnt(4)
v_mfma_f32_16x16x32_bf16 v[160:163],v[156:159],v[204:207],v[160:163]
s_waitcnt vmcnt(3)
v_mfma_f32_16x16x32_bf16 v[164:167],v[156:159],v[208:211],0
s_waitcnt vmcnt(2)
v_mfma_f32_16x16x32_bf16 v[164:167],v[156:159],v[212:215],v[164:167]
s_waitcnt vmcnt(1)
v_mfma_f32_16x16x32_bf16 v[164:167],v[156:159],v[216:219],v[164:167]
ds_write_b128 v6,v[160:163]
s_waitcnt vmcnt(0)
v_mfma_f32_16x16x32_bf16 v[164:167],v[156:159],v[220:223],v[164:167]
s_nop 7
ds_write_b128 v6,v[164:167] offset:2048
s_waitcnt lgkmcnt(0)
s_barrier
buffer_store_dword v20,off,s[8:11],s73 sc1
s_mov_b32 s73,0x80000000
s_mov_b32 s27,1
s_branch L_aa_84
L_ao_99:
s_xor_b32 s67,s67,65536
s_and_b32 s56,s50,2048
s_lshl_b32 s56,s56,4
s_add_u32 s56,s56,s67
v_add_u32 v2,s56,v0
s_and_b32 s56,s50,1024
s_lshl_b32 s56,s56,2
v_add_u32 v238,s56,v2
s_mov_b32 s76,s71
s_mov_b32 s53,s77
ds_read_b128 v[24:27],v238 offset:16384
ds_read_b128 v[40:43],v2 offset:0
ds_read_b128 v[56:59],v2 offset:4096
ds_read_b128 v[28:31],v238 offset:17408
ds_read_b128 v[44:47],v2 offset:1024
ds_read_b128 v[60:63],v2 offset:5120
ds_read_b128 v[32:35],v238 offset:18432
ds_read_b128 v[48:51],v2 offset:2048
ds_read_b128 v[64:67],v2 offset:6144
ds_read_b128 v[36:39],v238 offset:19456
ds_read_b128 v[52:55],v2 offset:3072
ds_read_b128 v[68:71],v2 offset:7168
buffer_load_dwordx4 v[72:75],v0,s[8:11],s76 offen offset:0 sc1
buffer_load_dwordx4 v[76:79],v0,s[8:11],s76 offen offset:1024 sc1
buffer_load_dwordx4 v[80:83],v0,s[8:11],s76 offen offset:2048 sc1
buffer_load_dwordx4 v[84:87],v0,s[8:11],s76 offen offset:3072 sc1
s_waitcnt lgkmcnt(9)
v_mfma_f32_16x16x32_bf16 v[128:131],v[40:43],v[24:27],v[8:11]
ds_read_b128 v[88:91],v2 offset:8192
v_mfma_f32_16x16x32_bf16 v[132:135],v[56:59],v[24:27],v[12:15]
ds_read_b128 v[92:95],v2 offset:9216
s_waitcnt lgkmcnt(8)
v_mfma_f32_16x16x32_bf16 v[128:131],v[44:47],v[28:31],v[128:131]
ds_read_b128 v[96:99],v2 offset:10240
v_mfma_f32_16x16x32_bf16 v[132:135],v[60:63],v[28:31],v[132:135]
ds_read_b128 v[100:103],v2 offset:11264
s_waitcnt lgkmcnt(7)
v_mfma_f32_16x16x32_bf16 v[128:131],v[48:51],v[32:35],v[128:131]
ds_read_b128 v[104:107],v2 offset:12288
v_mfma_f32_16x16x32_bf16 v[132:135],v[64:67],v[32:35],v[132:135]
ds_read_b128 v[108:111],v2 offset:13312
s_waitcnt lgkmcnt(6)
v_mfma_f32_16x16x32_bf16 v[128:131],v[52:55],v[36:39],v[128:131]
ds_read_b128 v[112:115],v2 offset:14336
v_mfma_f32_16x16x32_bf16 v[132:135],v[68:71],v[36:39],v[132:135]
ds_read_b128 v[116:119],v2 offset:15360
s_add_u32 s66,s66,4
s_bfe_u32 s56,s66,0x10002
s_bitset0_b32 s37,s56
s_lshl_b32 s56,0,s56
s_or_b32 s37,s37,s56
s_or_b32 s56,s37,s66
v_mov_b32 v22,s56
s_xor_b32 s69,s69,524288
s_waitcnt vmcnt(4) lgkmcnt(0)
buffer_store_dword v22,off,s[8:11],s74
s_mov_b32 s26,s51
s_mov_b32 s27,3
s_branch L_aa_88
L_aa_81:
s_add_u32 s66,s66,4
s_bfe_u32 s56,s66,0x10002
s_bitset0_b32 s37,s56
s_lshl_b32 s56,0,s56
s_or_b32 s37,s37,s56
s_or_b32 s56,s37,s66
v_mov_b32 v22,s56
s_xor_b32 s69,s69,524288
s_waitcnt vmcnt(0) lgkmcnt(0)
buffer_store_dword v22,off,s[8:11],s74
L_aq_114:
buffer_load_dword v17,v16,s[8:11],s87 offen sc1
s_sub_u32 s49,s49,1
s_cbranch_scc1 L_abort
s_waitcnt vmcnt(0)
v_cmp_gt_u32 vcc,s66,v17
s_cbranch_vccnz L_aq_114
s_xor_b32 s34,s69,524288
buffer_load_dwordx4 v[160:163],v7,s[8:11],s34 offen sc1
s_add_u32 s34,s34,4096
buffer_load_dwordx4 v[164:167],v7,s[8:11],s34 offen sc1
s_add_u32 s34,s34,4096
buffer_load_dwordx4 v[168:171],v7,s[8:11],s34 offen sc1
s_add_u32 s34,s34,4096
buffer_load_dwordx4 v[172:175],v7,s[8:11],s34 offen sc1
s_add_u32 s34,s34,4096
buffer_load_dwordx4 v[176:179],v7,s[8:11],s34 offen sc1
s_add_u32 s34,s34,4096
buffer_load_dwordx4 v[180:183],v7,s[8:11],s34 offen sc1
s_add_u32 s34,s34,4096
buffer_load_dwordx4 v[184:187],v7,s[8:11],s34 offen sc1
s_add_u32 s34,s34,4096
buffer_load_dwordx4 v[188:191],v7,s[8:11],s34 offen sc1
buffer_load_dwordx4 v[72:75],v0,s[8:11],s76 offen offset:0 sc1
buffer_load_dwordx4 v[76:79],v0,s[8:11],s76 offen offset:1024 sc1
buffer_load_dwordx4 v[80:83],v0,s[8:11],s76 offen offset:2048 sc1
buffer_load_dwordx4 v[84:87],v0,s[8:11],s76 offen offset:3072 sc1
s_waitcnt vmcnt(11)
v_mfma_f32_16x16x32_bf16 v[192:195],v[156:159],v[160:163],0
s_waitcnt vmcnt(10)
v_mfma_f32_16x16x32_bf16 v[192:195],v[156:159],v[164:167],v[192:195]
s_waitcnt vmcnt(9)
v_mfma_f32_16x16x32_bf16 v[192:195],v[156:159],v[168:171],v[192:195]
s_waitcnt vmcnt(8)
v_mfma_f32_16x16x32_bf16 v[192:195],v[156:159],v[172:175],v[192:195]
s_waitcnt vmcnt(7)
v_mfma_f32_16x16x32_bf16 v[196:199],v[156:159],v[176:179],0
s_waitcnt vmcnt(6)
v_mfma_f32_16x16x32_bf16 v[196:199],v[156:159],v[180:183],v[196:199]
s_waitcnt vmcnt(5)
v_mfma_f32_16x16x32_bf16 v[196:199],v[156:159],v[184:187],v[196:199]
ds_write_b128 v6,v[192:195]
s_waitcnt vmcnt(4)
v_mfma_f32_16x16x32_bf16 v[196:199],v[156:159],v[188:191],v[196:199]
s_nop 7
ds_write_b128 v6,v[196:199] offset:2048
s_waitcnt lgkmcnt(0)
s_barrier
buffer_store_dword v20,off,s[8:11],s73 sc1
s_mov_b32 s73,0x80000000
s_mov_b32 s27,0
s_branch L_aa_84
L_aa_82:
s_add_u32 s56,s30,s86
s_cmp_lg_u32 s56,1537
s_cbranch_scc1 L_al_100
s_add_u32 s66,s66,4
s_bfe_u32 s56,s66,0x10002
s_bitset0_b32 s37,s56
s_lshl_b32 s56,1,s56
s_or_b32 s37,s37,s56
s_or_b32 s56,s37,s66
v_mov_b32 v22,s56
s_xor_b32 s69,s69,524288
s_waitcnt vmcnt(0) lgkmcnt(0)
buffer_store_dword v22,off,s[8:11],s74
s_cmp_lg_u32 s86,1536
s_cbranch_scc1 L_ae_115
s_mov_b32 s77,s35
s_mov_b32 s30,0
s_lshl_b32 s56,s77,5
s_add_u32 s56,s56,s68
s_mul_i32 s70,s56,24576
s_lshl_b32 s71,s56,12
s_lshl_b32 s59,s77,13
s_lshl2_add_u32 s59,s68,s59
s_add_u32 s59,s59,10485760
s_buffer_load_dword s32,s[8:11],s59
s_mov_b32 s33,1
s_add_u32 s70,s70,100663296
s_add_u32 s71,s71,41943040
v_mov_b32 v19,s59
s_branch L_af_116
L_ae_115:
s_ff1_i32_b64 s77,s[84:85]
s_bitset0_b64 s[84:85],s77
s_min_u32 s77,s77,64
s_lshr_b32 s61,s55,5
s_lshl_b32 s56,s77,5
s_add_u32 s56,s56,s68
s_mul_i32 s70,s56,24576
s_lshl_b32 s71,s56,12
s_lshl_b32 s59,s77,13
s_lshl2_add_u32 s59,s68,s59
s_add_u32 s59,s59,10486144
s_cmp_lt_u32 s77,s61
s_cselect_b32 s57,0,16777216
s_mov_b32 s60,s59
s_buffer_load_dword s33,s[8:11],s60
s_add_u32 s71,s71,s57
s_add_u32 s71,s71,58720256
s_cmp_eq_u32 s77,s61
s_cselect_b32 s57,50331648,0
s_cselect_b32 s58,1536,0
s_add_u32 s59,s59,s58
s_buffer_load_dword s32,s[8:11],s59
s_add_u32 s70,s70,s57
s_add_u32 s70,s70,150994944
v_mov_b32 v19,s59
v_writelane_b32 v19,s60,1
L_af_116:
s_branch L_ak_101
L_al_100:
s_add_u32 s66,s66,4
s_bfe_u32 s56,s66,0x10002
s_bitset0_b32 s37,s56
s_lshl_b32 s56,0,s56
s_or_b32 s37,s37,s56
s_or_b32 s56,s37,s66
v_mov_b32 v22,s56
s_xor_b32 s69,s69,524288
s_waitcnt vmcnt(0) lgkmcnt(0)
buffer_store_dword v22,off,s[8:11],s74
buffer_store_dword v20,off,s[8:11],s73 sc1
s_mov_b32 s73,0x80000000
L_ak_101:
L_aq_117:
buffer_load_dword v17,v16,s[8:11],s87 offen sc1
s_sub_u32 s49,s49,1
s_cbranch_scc1 L_abort
s_waitcnt vmcnt(0)
v_cmp_gt_u32 vcc,s66,v17
s_cbranch_vccnz L_aq_117
s_xor_b32 s34,s69,524288
buffer_load_dwordx4 v[160:163],v7,s[8:11],s34 offen sc1
s_add_u32 s34,s34,4096
buffer_load_dwordx4 v[164:167],v7,s[8:11],s34 offen sc1
s_add_u32 s34,s34,4096
buffer_load_dwordx4 v[168:171],v7,s[8:11],s34 offen sc1
s_add_u32 s34,s34,4096
buffer_load_dwordx4 v[172:175],v7,s[8:11],s34 offen sc1
s_add_u32 s34,s34,4096
buffer_load_dwordx4 v[176:179],v7,s[8:11],s34 offen sc1
s_add_u32 s34,s34,4096
buffer_load_dwordx4 v[180:183],v7,s[8:11],s34 offen sc1
s_add_u32 s34,s34,4096
buffer_load_dwordx4 v[184:187],v7,s[8:11],s34 offen sc1
s_add_u32 s34,s34,4096
buffer_load_dwordx4 v[188:191],v7,s[8:11],s34 offen sc1
s_waitcnt vmcnt(7)
v_mfma_f32_16x16x32_bf16 v[192:195],v[156:159],v[160:163],0
s_waitcnt vmcnt(6)
v_mfma_f32_16x16x32_bf16 v[192:195],v[156:159],v[164:167],v[192:195]
s_waitcnt vmcnt(5)
v_mfma_f32_16x16x32_bf16 v[192:195],v[156:159],v[168:171],v[192:195]
s_waitcnt vmcnt(4)
v_mfma_f32_16x16x32_bf16 v[192:195],v[156:159],v[172:175],v[192:195]
s_waitcnt vmcnt(3)
v_mfma_f32_16x16x32_bf16 v[196:199],v[156:159],v[176:179],0
s_waitcnt vmcnt(2)
v_mfma_f32_16x16x32_bf16 v[196:199],v[156:159],v[180:183],v[196:199]
s_waitcnt vmcnt(1)
v_mfma_f32_16x16x32_bf16 v[196:199],v[156:159],v[184:187],v[196:199]
ds_write_b128 v6,v[192:195]
s_waitcnt vmcnt(0)
v_mfma_f32_16x16x32_bf16 v[196:199],v[156:159],v[188:191],v[196:199]
s_nop 7
ds_write_b128 v6,v[196:199] offset:2048
s_waitcnt lgkmcnt(0)
s_barrier
buffer_store_dword v20,off,s[8:11],s73 sc1
s_mov_b32 s73,0x80000000
s_mov_b32 s27,2
L_aa_84:
s_cmp_lg_u32 s31,0
s_cbranch_scc1 L_ar_120
s_bitcmp1_b32 s46,0
s_cbranch_scc1 L_ar_119
L_ar_118:
ds_read_b128 v[160:163],v23
ds_read_b128 v[164:167],v23 offset:16
v_lshlrev_b32 v200,16,v224
v_and_b32 v201,0xffff0000,v224
v_lshlrev_b32 v202,16,v225
v_and_b32 v203,0xffff0000,v225
v_lshlrev_b32 v204,16,v226
v_and_b32 v205,0xffff0000,v226
v_lshlrev_b32 v206,16,v227
v_and_b32 v207,0xffff0000,v227
s_lshl_b32 s18,s51,5
s_add_u32 s18,s18,s68
s_lshl_b32 s19,s18,10
s_add_u32 s20,s19,8388608
s_waitcnt lgkmcnt(0)
v_cvt_pk_bf16_f32 v168,v160,v161
v_cvt_pk_bf16_f32 v169,v162,v163
v_cvt_pk_bf16_f32 v170,v164,v165
v_cvt_pk_bf16_f32 v171,v166,v167
v_lshlrev_b32 v160,16,v168
v_and_b32 v161,0xffff0000,v168
v_lshlrev_b32 v162,16,v169
v_and_b32 v163,0xffff0000,v169
v_lshlrev_b32 v164,16,v170
v_and_b32 v165,0xffff0000,v170
v_lshlrev_b32 v166,16,v171
v_and_b32 v167,0xffff0000,v171
v_pk_add_f32 v[200:201],v[200:201],v[160:161]
v_pk_add_f32 v[202:203],v[202:203],v[162:163]
v_pk_add_f32 v[204:205],v[204:205],v[164:165]
v_pk_add_f32 v[206:207],v[206:207],v[166:167]
v_cvt_pk_bf16_f32 v168,v200,v201
v_cvt_pk_bf16_f32 v169,v202,v203
v_cvt_pk_bf16_f32 v170,v204,v205
v_cvt_pk_bf16_f32 v171,v206,v207
v_lshlrev_b32 v200,16,v168
v_and_b32 v201,0xffff0000,v168
v_lshlrev_b32 v202,16,v169
v_and_b32 v203,0xffff0000,v169
v_lshlrev_b32 v204,16,v170
v_and_b32 v205,0xffff0000,v170
v_lshlrev_b32 v206,16,v171
v_and_b32 v207,0xffff0000,v171
v_readfirstlane_b32 s78,v200
s_nop 1
v_pk_add_f32 v[184:185],v[200:201],s[78:79] op_sel_hi:[1,0] neg_lo:[0,1] neg_hi:[0,1]
v_pk_add_f32 v[186:187],v[202:203],s[78:79] op_sel_hi:[1,0] neg_lo:[0,1] neg_hi:[0,1]
v_pk_add_f32 v[188:189],v[204:205],s[78:79] op_sel_hi:[1,0] neg_lo:[0,1] neg_hi:[0,1]
v_pk_add_f32 v[190:191],v[206:207],s[78:79] op_sel_hi:[1,0] neg_lo:[0,1] neg_hi:[0,1]
v_pk_add_f32 v[192:193],v[184:185],v[186:187]
v_pk_mul_f32 v[194:195],v[184:185],v[184:185]
v_pk_add_f32 v[196:197],v[188:189],v[190:191]
v_pk_fma_f32 v[194:195],v[186:187],v[186:187],v[194:195]
v_pk_add_f32 v[192:193],v[192:193],v[196:197]
v_pk_fma_f32 v[194:195],v[188:189],v[188:189],v[194:195]
v_add_f32 v192,v192,v193
v_pk_fma_f32 v[194:195],v[190:191],v[190:191],v[194:195]
v_add_f32 v194,v194,v195
s_nop 1
v_permlane32_swap_b32 v192,v194
v_add_f32 v192,v192,v194
s_nop 1
v_add_f32_dpp v192,v192,v192 row_ror:8 row_mask:0xf bank_mask:0xf
s_nop 1
v_add_f32_dpp v192,v192,v192 row_ror:4 row_mask:0xf bank_mask:0xf
s_nop 1
v_add_f32_dpp v192,v192,v192 row_ror:2 row_mask:0xf bank_mask:0xf
s_nop 1
v_add_f32_dpp v192,v192,v192 row_ror:1 row_mask:0xf bank_mask:0xf
v_mov_b32 v194,v192
s_nop 1
v_permlane16_swap_b32 v192,v194
v_add_f32 v192,v192,v194
v_mul_f32 v192,0x3b000000,v192
v_mov_b32 v194,v192
s_nop 1
v_permlane32_swap_b32 v192,v194
v_fma_f32 v194,-v192,v192,v194
v_add_f32 v192,s78,v192
v_max_f32 v194,0,v194
v_cvt_pk_bf16_f32 v194,v192,v194
v_lshlrev_b32 v192,16,v194
v_and_b32 v194,0xffff0000,v194
v_add_f32 v194,0x3727c5ac,v194
v_cvt_pk_bf16_f32 v194,v194,v194
v_and_b32 v194,0xffff0000,v194
v_sqrt_f32 v194,v194
v_pk_add_f32 v[184:185],v[200:201],v[192:193] op_sel_hi:[1,0] neg_lo:[0,1] neg_hi:[0,1]
v_pk_add_f32 v[186:187],v[202:203],v[192:193] op_sel_hi:[1,0] neg_lo:[0,1] neg_hi:[0,1]
v_pk_add_f32 v[188:189],v[204:205],v[192:193] op_sel_hi:[1,0] neg_lo:[0,1] neg_hi:[0,1]
v_pk_add_f32 v[190:191],v[206:207],v[192:193] op_sel_hi:[1,0] neg_lo:[0,1] neg_hi:[0,1]
v_cvt_pk_bf16_f32 v194,v194,v194
v_and_b32 v194,0xffff0000,v194
v_rcp_f32 v194,v194
v_cvt_pk_bf16_f32 v172,v184,v185
v_cvt_pk_bf16_f32 v173,v186,v187
v_cvt_pk_bf16_f32 v174,v188,v189
v_cvt_pk_bf16_f32 v175,v190,v191
v_lshlrev_b32 v184,16,v172
v_and_b32 v185,0xffff0000,v172
v_lshlrev_b32 v186,16,v173
v_and_b32 v187,0xffff0000,v173
v_lshlrev_b32 v188,16,v174
v_and_b32 v189,0xffff0000,v174
v_lshlrev_b32 v190,16,v175
v_and_b32 v191,0xffff0000,v175
v_pk_mul_f32 v[184:185],v[184:185],v[194:195] op_sel_hi:[1,0]
v_pk_mul_f32 v[186:187],v[186:187],v[194:195] op_sel_hi:[1,0]
v_pk_mul_f32 v[188:189],v[188:189],v[194:195] op_sel_hi:[1,0]
v_pk_mul_f32 v[190:191],v[190:191],v[194:195] op_sel_hi:[1,0]
v_cvt_pk_bf16_f32 v172,v184,v185
v_cvt_pk_bf16_f32 v173,v186,v187
v_cvt_pk_bf16_f32 v174,v188,v189
v_cvt_pk_bf16_f32 v175,v190,v191
v_lshlrev_b32 v176,16,v172
v_and_b32 v177,0xffff0000,v172
v_lshlrev_b32 v178,16,v173
v_and_b32 v179,0xffff0000,v173
v_lshlrev_b32 v180,16,v174
v_and_b32 v181,0xffff0000,v174
v_lshlrev_b32 v182,16,v175
v_and_b32 v183,0xffff0000,v175
v_pk_add_f32 v[200:201],v[200:201],v[176:177]
v_pk_add_f32 v[202:203],v[202:203],v[178:179]
v_pk_add_f32 v[204:205],v[204:205],v[180:181]
v_pk_add_f32 v[206:207],v[206:207],v[182:183]
v_cvt_pk_bf16_f32 v160,v200,v201
v_cvt_pk_bf16_f32 v161,v202,v203
v_cvt_pk_bf16_f32 v162,v204,v205
v_cvt_pk_bf16_f32 v163,v206,v207
buffer_store_dwordx4 v[160:163],v0,s[8:11],s20 offen sc1
v_lshlrev_b32 v200,16,v160
v_and_b32 v201,0xffff0000,v160
v_lshlrev_b32 v202,16,v161
v_and_b32 v203,0xffff0000,v161
v_lshlrev_b32 v204,16,v162
v_and_b32 v205,0xffff0000,v162
v_lshlrev_b32 v206,16,v163
v_and_b32 v207,0xffff0000,v163
v_readfirstlane_b32 s78,v200
s_nop 1
v_pk_add_f32 v[184:185],v[200:201],s[78:79] op_sel_hi:[1,0] neg_lo:[0,1] neg_hi:[0,1]
v_pk_add_f32 v[186:187],v[202:203],s[78:79] op_sel_hi:[1,0] neg_lo:[0,1] neg_hi:[0,1]
v_pk_add_f32 v[188:189],v[204:205],s[78:79] op_sel_hi:[1,0] neg_lo:[0,1] neg_hi:[0,1]
v_pk_add_f32 v[190:191],v[206:207],s[78:79] op_sel_hi:[1,0] neg_lo:[0,1] neg_hi:[0,1]
v_pk_add_f32 v[192:193],v[184:185],v[186:187]
v_pk_mul_f32 v[194:195],v[184:185],v[184:185]
v_pk_add_f32 v[196:197],v[188:189],v[190:191]
v_pk_fma_f32 v[194:195],v[186:187],v[186:187],v[194:195]
v_pk_add_f32 v[192:193],v[192:193],v[196:197]
v_pk_fma_f32 v[194:195],v[188:189],v[188:189],v[194:195]
v_add_f32 v192,v192,v193
v_pk_fma_f32 v[194:195],v[190:191],v[190:191],v[194:195]
v_add_f32 v194,v194,v195
s_nop 1
v_permlane32_swap_b32 v192,v194
v_add_f32 v192,v192,v194
s_nop 1
v_add_f32_dpp v192,v192,v192 row_ror:8 row_mask:0xf bank_mask:0xf
s_nop 1
v_add_f32_dpp v192,v192,v192 row_ror:4 row_mask:0xf bank_mask:0xf
s_nop 1
v_add_f32_dpp v192,v192,v192 row_ror:2 row_mask:0xf bank_mask:0xf
s_nop 1
v_add_f32_dpp v192,v192,v192 row_ror:1 row_mask:0xf bank_mask:0xf
v_mov_b32 v194,v192
s_nop 1
v_permlane16_swap_b32 v192,v194
v_add_f32 v192,v192,v194
v_mul_f32 v192,0x3b000000,v192
v_mov_b32 v194,v192
s_nop 1
v_permlane32_swap_b32 v192,v194
v_fma_f32 v194,-v192,v192,v194
v_add_f32 v192,s78,v192
v_max_f32 v194,0,v194
v_cvt_pk_bf16_f32 v194,v192,v194
v_lshlrev_b32 v192,16,v194
v_and_b32 v194,0xffff0000,v194
v_add_f32 v194,0x3727c5ac,v194
v_cvt_pk_bf16_f32 v194,v194,v194
v_and_b32 v194,0xffff0000,v194
v_sqrt_f32 v194,v194
v_pk_add_f32 v[184:185],v[200:201],v[192:193] op_sel_hi:[1,0] neg_lo:[0,1] neg_hi:[0,1]
v_pk_add_f32 v[186:187],v[202:203],v[192:193] op_sel_hi:[1,0] neg_lo:[0,1] neg_hi:[0,1]
v_pk_add_f32 v[188:189],v[204:205],v[192:193] op_sel_hi:[1,0] neg_lo:[0,1] neg_hi:[0,1]
v_pk_add_f32 v[190:191],v[206:207],v[192:193] op_sel_hi:[1,0] neg_lo:[0,1] neg_hi:[0,1]
v_cvt_pk_bf16_f32 v194,v194,v194
v_and_b32 v194,0xffff0000,v194
v_rcp_f32 v194,v194
v_cvt_pk_bf16_f32 v164,v184,v185
v_cvt_pk_bf16_f32 v165,v186,v187
v_cvt_pk_bf16_f32 v166,v188,v189
v_cvt_pk_bf16_f32 v167,v190,v191
v_lshlrev_b32 v184,16,v164
v_and_b32 v185,0xffff0000,v164
v_lshlrev_b32 v186,16,v165
v_and_b32 v187,0xffff0000,v165
v_lshlrev_b32 v188,16,v166
v_and_b32 v189,0xffff0000,v166
v_lshlrev_b32 v190,16,v167
v_and_b32 v191,0xffff0000,v167
v_pk_mul_f32 v[184:185],v[184:185],v[194:195] op_sel_hi:[1,0]
v_pk_mul_f32 v[186:187],v[186:187],v[194:195] op_sel_hi:[1,0]
v_pk_mul_f32 v[188:189],v[188:189],v[194:195] op_sel_hi:[1,0]
v_pk_mul_f32 v[190:191],v[190:191],v[194:195] op_sel_hi:[1,0]
v_cvt_pk_bf16_f32 v164,v184,v185
v_cvt_pk_bf16_f32 v165,v186,v187
v_cvt_pk_bf16_f32 v166,v188,v189
v_cvt_pk_bf16_f32 v167,v190,v191
s_add_u32 s20,s19,2097152
buffer_store_dwordx4 v[164:167],v0,s[8:11],s20 offen sc1
v_mov_b32 v20,1
s_lshl_b32 s73,s51,13
s_lshl2_add_u32 s73,s68,s73
s_add_u32 s73,s73,10487552
s_branch L_aa_85
L_ar_119:
ds_read_b128 v[160:163],v23
ds_read_b128 v[164:167],v23 offset:16
v_lshlrev_b32 v200,16,v224
v_and_b32 v201,0xffff0000,v224
v_lshlrev_b32 v202,16,v225
v_and_b32 v203,0xffff0000,v225
v_lshlrev_b32 v204,16,v226
v_and_b32 v205,0xffff0000,v226
v_lshlrev_b32 v206,16,v227
v_and_b32 v207,0xffff0000,v227
s_lshl_b32 s18,s51,5
s_add_u32 s18,s18,s68
s_lshl_b32 s19,s18,10
s_add_u32 s20,s19,4194304
s_waitcnt lgkmcnt(0)
v_cvt_pk_bf16_f32 v168,v160,v161
v_cvt_pk_bf16_f32 v169,v162,v163
v_cvt_pk_bf16_f32 v170,v164,v165
v_cvt_pk_bf16_f32 v171,v166,v167
v_lshlrev_b32 v160,16,v168
v_and_b32 v161,0xffff0000,v168
v_lshlrev_b32 v162,16,v169
v_and_b32 v163,0xffff0000,v169
v_lshlrev_b32 v164,16,v170
v_and_b32 v165,0xffff0000,v170
v_lshlrev_b32 v166,16,v171
v_and_b32 v167,0xffff0000,v171
v_pk_add_f32 v[200:201],v[200:201],v[160:161]
v_pk_add_f32 v[202:203],v[202:203],v[162:163]
v_pk_add_f32 v[204:205],v[204:205],v[164:165]
v_pk_add_f32 v[206:207],v[206:207],v[166:167]
v_cvt_pk_bf16_f32 v168,v200,v201
v_cvt_pk_bf16_f32 v169,v202,v203
v_cvt_pk_bf16_f32 v170,v204,v205
v_cvt_pk_bf16_f32 v171,v206,v207
buffer_store_dwordx4 v[168:171],v0,s[8:11],s20 offen sc1
v_lshlrev_b32 v200,16,v168
v_and_b32 v201,0xffff0000,v168
v_lshlrev_b32 v202,16,v169
v_and_b32 v203,0xffff0000,v169
v_lshlrev_b32 v204,16,v170
v_and_b32 v205,0xffff0000,v170
v_lshlrev_b32 v206,16,v171
v_and_b32 v207,0xffff0000,v171
v_readfirstlane_b32 s78,v200
s_nop 1
v_pk_add_f32 v[184:185],v[200:201],s[78:79] op_sel_hi:[1,0] neg_lo:[0,1] neg_hi:[0,1]
v_pk_add_f32 v[186:187],v[202:203],s[78:79] op_sel_hi:[1,0] neg_lo:[0,1] neg_hi:[0,1]
v_pk_add_f32 v[188:189],v[204:205],s[78:79] op_sel_hi:[1,0] neg_lo:[0,1] neg_hi:[0,1]
v_pk_add_f32 v[190:191],v[206:207],s[78:79] op_sel_hi:[1,0] neg_lo:[0,1] neg_hi:[0,1]
v_pk_add_f32 v[192:193],v[184:185],v[186:187]
v_pk_mul_f32 v[194:195],v[184:185],v[184:185]
v_pk_add_f32 v[196:197],v[188:189],v[190:191]
v_pk_fma_f32 v[194:195],v[186:187],v[186:187],v[194:195]
v_pk_add_f32 v[192:193],v[192:193],v[196:197]
v_pk_fma_f32 v[194:195],v[188:189],v[188:189],v[194:195]
v_add_f32 v192,v192,v193
v_pk_fma_f32 v[194:195],v[190:191],v[190:191],v[194:195]
v_add_f32 v194,v194,v195
s_nop 1
v_permlane32_swap_b32 v192,v194
v_add_f32 v192,v192,v194
s_nop 1
v_add_f32_dpp v192,v192,v192 row_ror:8 row_mask:0xf bank_mask:0xf
s_nop 1
v_add_f32_dpp v192,v192,v192 row_ror:4 row_mask:0xf bank_mask:0xf
s_nop 1
v_add_f32_dpp v192,v192,v192 row_ror:2 row_mask:0xf bank_mask:0xf
s_nop 1
v_add_f32_dpp v192,v192,v192 row_ror:1 row_mask:0xf bank_mask:0xf
v_mov_b32 v194,v192
s_nop 1
v_permlane16_swap_b32 v192,v194
v_add_f32 v192,v192,v194
v_mul_f32 v192,0x3b000000,v192
v_mov_b32 v194,v192
s_nop 1
v_permlane32_swap_b32 v192,v194
v_fma_f32 v194,-v192,v192,v194
v_add_f32 v192,s78,v192
v_max_f32 v194,0,v194
v_cvt_pk_bf16_f32 v194,v192,v194
v_lshlrev_b32 v192,16,v194
v_and_b32 v194,0xffff0000,v194
v_add_f32 v194,0x3727c5ac,v194
v_cvt_pk_bf16_f32 v194,v194,v194
v_and_b32 v194,0xffff0000,v194
v_sqrt_f32 v194,v194
v_pk_add_f32 v[184:185],v[200:201],v[192:193] op_sel_hi:[1,0] neg_lo:[0,1] neg_hi:[0,1]
v_pk_add_f32 v[186:187],v[202:203],v[192:193] op_sel_hi:[1,0] neg_lo:[0,1] neg_hi:[0,1]
v_pk_add_f32 v[188:189],v[204:205],v[192:193] op_sel_hi:[1,0] neg_lo:[0,1] neg_hi:[0,1]
v_pk_add_f32 v[190:191],v[206:207],v[192:193] op_sel_hi:[1,0] neg_lo:[0,1] neg_hi:[0,1]
v_cvt_pk_bf16_f32 v194,v194,v194
v_and_b32 v194,0xffff0000,v194
v_rcp_f32 v194,v194
v_cvt_pk_bf16_f32 v172,v184,v185
v_cvt_pk_bf16_f32 v173,v186,v187
v_cvt_pk_bf16_f32 v174,v188,v189
v_cvt_pk_bf16_f32 v175,v190,v191
v_lshlrev_b32 v184,16,v172
v_and_b32 v185,0xffff0000,v172
v_lshlrev_b32 v186,16,v173
v_and_b32 v187,0xffff0000,v173
v_lshlrev_b32 v188,16,v174
v_and_b32 v189,0xffff0000,v174
v_lshlrev_b32 v190,16,v175
v_and_b32 v191,0xffff0000,v175
v_pk_mul_f32 v[184:185],v[184:185],v[194:195] op_sel_hi:[1,0]
v_pk_mul_f32 v[186:187],v[186:187],v[194:195] op_sel_hi:[1,0]
v_pk_mul_f32 v[188:189],v[188:189],v[194:195] op_sel_hi:[1,0]
v_pk_mul_f32 v[190:191],v[190:191],v[194:195] op_sel_hi:[1,0]
v_cvt_pk_bf16_f32 v172,v184,v185
v_cvt_pk_bf16_f32 v173,v186,v187
v_cvt_pk_bf16_f32 v174,v188,v189
v_cvt_pk_bf16_f32 v175,v190,v191
v_lshlrev_b32 v176,16,v172
v_and_b32 v177,0xffff0000,v172
v_lshlrev_b32 v178,16,v173
v_and_b32 v179,0xffff0000,v173
v_lshlrev_b32 v180,16,v174
v_and_b32 v181,0xffff0000,v174
v_lshlrev_b32 v182,16,v175
v_and_b32 v183,0xffff0000,v175
v_pk_mul_f32 v[236:237],v[176:177],v[228:229]
v_pk_fma_f32 v[236:237],v[178:179],v[230:231],v[236:237]
v_pk_fma_f32 v[236:237],v[180:181],v[232:233],v[236:237]
v_pk_fma_f32 v[236:237],v[182:183],v[234:235],v[236:237]
v_add_f32 v236,v236,v237
s_nop 1
v_add_f32_dpp v236,v236,v236 row_ror:8 row_mask:0xf bank_mask:0xf
s_nop 1
v_add_f32_dpp v236,v236,v236 row_ror:4 row_mask:0xf bank_mask:0xf
s_nop 1
v_add_f32_dpp v236,v236,v236 row_ror:2 row_mask:0xf bank_mask:0xf
s_nop 1
v_add_f32_dpp v236,v236,v236 row_ror:1 row_mask:0xf bank_mask:0xf
v_mov_b32 v237,v236
s_nop 1
v_permlane16_swap_b32 v236,v237
v_add_f32 v236,v236,v237
v_mov_b32 v237,v236
s_nop 1
v_permlane32_swap_b32 v236,v237
v_add_f32 v236,v236,v237
v_cvt_pk_bf16_f32 v236,v236,v236
v_and_b32 v236,0xffff0000,v236
v_ashrrev_i32 v237,31,v236
v_or_b32 v237,0x80000000,v237
v_xor_b32 v236,v236,v237
v_and_b32 v236,0xffff0000,v236
s_sub_u32 s20,4095,s18
v_or_b32 v20,s20,v236
s_lshl_b32 s20,s51,13
s_lshl2_add_u32 s20,s68,s20
s_add_u32 s20,s20,10485760
buffer_store_dword v20,v254,s[8:11],s20 offen sc1
s_branch L_aa_85
L_ar_120:
s_bitcmp1_b32 s46,0
s_cbranch_scc1 L_aa_85
ds_read_b128 v[160:163],v23
ds_read_b128 v[164:167],v23 offset:16
v_lshlrev_b32 v200,16,v224
v_and_b32 v201,0xffff0000,v224
v_lshlrev_b32 v202,16,v225
v_and_b32 v203,0xffff0000,v225
v_lshlrev_b32 v204,16,v226
v_and_b32 v205,0xffff0000,v226
v_lshlrev_b32 v206,16,v227
v_and_b32 v207,0xffff0000,v227
v_readfirstlane_b32 s22,v246
s_cmp_eq_u32 s22,0
s_cbranch_scc1 L_ag_121
L_agb_122:
s_lshl_b32 s18,s51,5
s_add_u32 s18,s18,s68
s_lshl_b32 s19,s18,10
s_add_u32 s20,s19,6291456
s_waitcnt lgkmcnt(0)
v_cvt_pk_bf16_f32 v168,v160,v161
v_cvt_pk_bf16_f32 v169,v162,v163
v_cvt_pk_bf16_f32 v170,v164,v165
v_cvt_pk_bf16_f32 v171,v166,v167
v_lshlrev_b32 v160,16,v168
v_and_b32 v161,0xffff0000,v168
v_lshlrev_b32 v162,16,v169
v_and_b32 v163,0xffff0000,v169
v_lshlrev_b32 v164,16,v170
v_and_b32 v165,0xffff0000,v170
v_lshlrev_b32 v166,16,v171
v_and_b32 v167,0xffff0000,v171
v_pk_add_f32 v[200:201],v[200:201],v[160:161]
v_pk_add_f32 v[202:203],v[202:203],v[162:163]
v_pk_add_f32 v[204:205],v[204:205],v[164:165]
v_pk_add_f32 v[206:207],v[206:207],v[166:167]
v_cvt_pk_bf16_f32 v168,v200,v201
v_cvt_pk_bf16_f32 v169,v202,v203
v_cvt_pk_bf16_f32 v170,v204,v205
v_cvt_pk_bf16_f32 v171,v206,v207
buffer_store_dwordx4 v[168:171],v0,s[8:11],s20 offen sc1
v_lshlrev_b32 v200,16,v168
v_and_b32 v201,0xffff0000,v168
v_lshlrev_b32 v202,16,v169
v_and_b32 v203,0xffff0000,v169
v_lshlrev_b32 v204,16,v170
v_and_b32 v205,0xffff0000,v170
v_lshlrev_b32 v206,16,v171
v_and_b32 v207,0xffff0000,v171
v_readfirstlane_b32 s78,v200
s_nop 1
v_pk_add_f32 v[184:185],v[200:201],s[78:79] op_sel_hi:[1,0] neg_lo:[0,1] neg_hi:[0,1]
v_pk_add_f32 v[186:187],v[202:203],s[78:79] op_sel_hi:[1,0] neg_lo:[0,1] neg_hi:[0,1]
v_pk_add_f32 v[188:189],v[204:205],s[78:79] op_sel_hi:[1,0] neg_lo:[0,1] neg_hi:[0,1]
v_pk_add_f32 v[190:191],v[206:207],s[78:79] op_sel_hi:[1,0] neg_lo:[0,1] neg_hi:[0,1]
v_pk_add_f32 v[192:193],v[184:185],v[186:187]
v_pk_mul_f32 v[194:195],v[184:185],v[184:185]
v_pk_add_f32 v[196:197],v[188:189],v[190:191]
v_pk_fma_f32 v[194:195],v[186:187],v[186:187],v[194:195]
v_pk_add_f32 v[192:193],v[192:193],v[196:197]
v_pk_fma_f32 v[194:195],v[188:189],v[188:189],v[194:195]
v_add_f32 v192,v192,v193
v_pk_fma_f32 v[194:195],v[190:191],v[190:191],v[194:195]
v_add_f32 v194,v194,v195
s_nop 1
v_permlane32_swap_b32 v192,v194
v_add_f32 v192,v192,v194
s_nop 1
v_add_f32_dpp v192,v192,v192 row_ror:8 row_mask:0xf bank_mask:0xf
s_nop 1
v_add_f32_dpp v192,v192,v192 row_ror:4 row_mask:0xf bank_mask:0xf
s_nop 1
v_add_f32_dpp v192,v192,v192 row_ror:2 row_mask:0xf bank_mask:0xf
s_nop 1
v_add_f32_dpp v192,v192,v192 row_ror:1 row_mask:0xf bank_mask:0xf
v_mov_b32 v194,v192
s_nop 1
v_permlane16_swap_b32 v192,v194
v_add_f32 v192,v192,v194
v_mul_f32 v192,0x3b000000,v192
v_mov_b32 v194,v192
s_nop 1
v_permlane32_swap_b32 v192,v194
v_fma_f32 v194,-v192,v192,v194
v_add_f32 v192,s78,v192
v_max_f32 v194,0,v194
v_cvt_pk_bf16_f32 v194,v192,v194
v_lshlrev_b32 v192,16,v194
v_and_b32 v194,0xffff0000,v194
v_add_f32 v194,0x3727c5ac,v194
v_cvt_pk_bf16_f32 v194,v194,v194
v_and_b32 v194,0xffff0000,v194
v_sqrt_f32 v194,v194
v_pk_add_f32 v[184:185],v[200:201],v[192:193] op_sel_hi:[1,0] neg_lo:[0,1] neg_hi:[0,1]
v_pk_add_f32 v[186:187],v[202:203],v[192:193] op_sel_hi:[1,0] neg_lo:[0,1] neg_hi:[0,1]
v_pk_add_f32 v[188:189],v[204:205],v[192:193] op_sel_hi:[1,0] neg_lo:[0,1] neg_hi:[0,1]
v_pk_add_f32 v[190:191],v[206:207],v[192:193] op_sel_hi:[1,0] neg_lo:[0,1] neg_hi:[0,1]
v_cvt_pk_bf16_f32 v194,v194,v194
v_and_b32 v194,0xffff0000,v194
v_rcp_f32 v194,v194
v_cvt_pk_bf16_f32 v172,v184,v185
v_cvt_pk_bf16_f32 v173,v186,v187
v_cvt_pk_bf16_f32 v174,v188,v189
v_cvt_pk_bf16_f32 v175,v190,v191
v_lshlrev_b32 v184,16,v172
v_and_b32 v185,0xffff0000,v172
v_lshlrev_b32 v186,16,v173
v_and_b32 v187,0xffff0000,v173
v_lshlrev_b32 v188,16,v174
v_and_b32 v189,0xffff0000,v174
v_lshlrev_b32 v190,16,v175
v_and_b32 v191,0xffff0000,v175
v_pk_mul_f32 v[184:185],v[184:185],v[194:195] op_sel_hi:[1,0]
v_pk_mul_f32 v[186:187],v[186:187],v[194:195] op_sel_hi:[1,0]
v_pk_mul_f32 v[188:189],v[188:189],v[194:195] op_sel_hi:[1,0]
v_pk_mul_f32 v[190:191],v[190:191],v[194:195] op_sel_hi:[1,0]
v_cvt_pk_bf16_f32 v172,v184,v185
v_cvt_pk_bf16_f32 v173,v186,v187
v_cvt_pk_bf16_f32 v174,v188,v189
v_cvt_pk_bf16_f32 v175,v190,v191
v_lshlrev_b32 v176,16,v172
v_and_b32 v177,0xffff0000,v172
v_lshlrev_b32 v178,16,v173
v_and_b32 v179,0xffff0000,v173
v_lshlrev_b32 v180,16,v174
v_and_b32 v181,0xffff0000,v174
v_lshlrev_b32 v182,16,v175
v_and_b32 v183,0xffff0000,v175
v_pk_add_f32 v[200:201],v[200:201],v[176:177]
v_pk_add_f32 v[202:203],v[202:203],v[178:179]
v_pk_add_f32 v[204:205],v[204:205],v[180:181]
v_pk_add_f32 v[206:207],v[206:207],v[182:183]
v_cvt_pk_bf16_f32 v160,v200,v201
v_cvt_pk_bf16_f32 v161,v202,v203
v_cvt_pk_bf16_f32 v162,v204,v205
v_cvt_pk_bf16_f32 v163,v206,v207
buffer_store_dwordx4 v[160:163],v0,s[12:15],s19 offen sc1
v_pk_mul_f32 v[236:237],v[176:177],v[228:229]
v_pk_fma_f32 v[236:237],v[178:179],v[230:231],v[236:237]
v_pk_fma_f32 v[236:237],v[180:181],v[232:233],v[236:237]
v_pk_fma_f32 v[236:237],v[182:183],v[234:235],v[236:237]
v_add_f32 v236,v236,v237
s_nop 1
v_add_f32_dpp v236,v236,v236 row_ror:8 row_mask:0xf bank_mask:0xf
s_nop 1
v_add_f32_dpp v236,v236,v236 row_ror:4 row_mask:0xf bank_mask:0xf
s_nop 1
v_add_f32_dpp v236,v236,v236 row_ror:2 row_mask:0xf bank_mask:0xf
s_nop 1
v_add_f32_dpp v236,v236,v236 row_ror:1 row_mask:0xf bank_mask:0xf
v_mov_b32 v237,v236
s_nop 1
v_permlane16_swap_b32 v236,v237
v_add_f32 v236,v236,v237
v_mov_b32 v237,v236
s_nop 1
v_permlane32_swap_b32 v236,v237
v_add_f32 v236,v236,v237
v_cvt_pk_bf16_f32 v236,v236,v236
v_and_b32 v236,0xffff0000,v236
v_ashrrev_i32 v237,31,v236
v_or_b32 v237,0x80000000,v237
v_xor_b32 v236,v236,v237
v_and_b32 v236,0xffff0000,v236
s_sub_u32 s20,4095,s18
v_or_b32 v20,s20,v236
s_lshl_b32 s73,s51,13
s_lshl2_add_u32 s73,s68,s73
s_add_u32 s73,s73,10485760
s_add_u32 s73,s73,s86
L_aa_85:
s_cmp_eq_u32 s27,1
s_cbranch_scc1 L_ad_123
s_cmp_eq_u32 s27,0
s_cbranch_scc1 L_aa_86
s_cmp_eq_u32 s27,4
s_cbranch_scc1 L_a4_106
s_cmp_ge_u32 s77,64
s_cbranch_scc1 L_aa_89
L_aa_87:
s_waitcnt vmcnt(0)
buffer_store_dword v20,off,s[8:11],s73 sc1
s_mov_b32 s73,0x80000000
v_mov_b32 v18,0
s_mov_b32 s27,0
L_aw_124:
v_cmp_eq_u32 vcc,0,v18
s_cbranch_vccz L_awd_125
buffer_load_dword v18,v19,s[8:11],0 offen sc1
s_sub_u32 s49,s49,1
s_cbranch_scc1 L_abort
s_waitcnt vmcnt(0)
s_branch L_aw_124
L_awd_125:
L_a3_126:
s_mov_b32 s64,s70
s_mov_b32 s65,s71
s_add_u32 s64,s64,s28
s_add_u32 s65,s65,s29
s_xor_b32 s58,s67,s40
s_xor_b32 s57,s67,s41
s_add_u32 m0,s58,0
s_nop 0
buffer_load_dwordx4 v0,s[8:11],s64 offen offset:0 sc1 lds
buffer_load_dwordx4 v0,s[8:11],s64 offen offset:1024 sc1 lds
buffer_load_dwordx4 v0,s[8:11],s64 offen offset:2048 sc1 lds
buffer_load_dwordx4 v0,s[8:11],s64 offen offset:3072 sc1 lds
s_add_u32 m0,s58,4096
s_add_u32 s64,s64,4096
buffer_load_dwordx4 v0,s[8:11],s64 offen offset:0 sc1 lds
buffer_load_dwordx4 v0,s[8:11],s64 offen offset:1024 sc1 lds
buffer_load_dwordx4 v0,s[8:11],s64 offen offset:2048 sc1 lds
buffer_load_dwordx4 v0,s[8:11],s64 offen offset:3072 sc1 lds
s_add_u32 m0,s58,8192
s_add_u32 s64,s64,4096
buffer_load_dwordx4 v0,s[8:11],s64 offen offset:0 sc1 lds
buffer_load_dwordx4 v0,s[8:11],s64 offen offset:1024 sc1 lds
buffer_load_dwordx4 v0,s[8:11],s64 offen offset:2048 sc1 lds
buffer_load_dwordx4 v0,s[8:11],s64 offen offset:3072 sc1 lds
s_add_u32 m0,s57,24576
s_nop 0
buffer_load_dwordx4 v0,s[8:11],s65 offen offset:0 sc1 lds
buffer_load_dwordx4 v0,s[8:11],s65 offen offset:1024 sc1 lds
v_lshrrev_b32 v244,4,v1
s_sub_u32 s56,s77,7
v_add_u32 v244,s56,v244
v_max_i32 v244,0,v244
v_lshl_add_u32 v244,v244,13,v21
buffer_load_dwordx2 v[242:243],v244,s[8:11],0 offen sc1
s_waitcnt vmcnt(0) lgkmcnt(0)
s_barrier
s_xor_b32 s67,s67,65536
s_and_b32 s56,s50,2048
s_lshl_b32 s56,s56,4
s_add_u32 s56,s56,s67
v_add_u32 v2,s56,v0
s_and_b32 s56,s50,1024
s_lshl_b32 s56,s56,2
v_add_u32 v238,s56,v2
s_mov_b32 s76,s71
s_mov_b32 s53,s77
ds_read_b128 v[24:27],v238 offset:16384
ds_read_b128 v[40:43],v2 offset:0
ds_read_b128 v[56:59],v2 offset:4096
ds_read_b128 v[28:31],v238 offset:17408
ds_read_b128 v[44:47],v2 offset:1024
ds_read_b128 v[60:63],v2 offset:5120
ds_read_b128 v[32:35],v238 offset:18432
ds_read_b128 v[48:51],v2 offset:2048
ds_read_b128 v[64:67],v2 offset:6144
ds_read_b128 v[36:39],v238 offset:19456
ds_read_b128 v[52:55],v2 offset:3072
ds_read_b128 v[68:71],v2 offset:7168
s_waitcnt lgkmcnt(9)
v_mfma_f32_16x16x32_bf16 v[128:131],v[40:43],v[24:27],v[8:11]
ds_read_b128 v[72:75],v2 offset:24576
v_mfma_f32_16x16x32_bf16 v[132:135],v[56:59],v[24:27],v[12:15]
ds_read_b128 v[76:79],v2 offset:25600
s_waitcnt lgkmcnt(8)
v_mfma_f32_16x16x32_bf16 v[128:131],v[44:47],v[28:31],v[128:131]
ds_read_b128 v[80:83],v2 offset:26624
v_mfma_f32_16x16x32_bf16 v[132:135],v[60:63],v[28:31],v[132:135]
ds_read_b128 v[84:87],v2 offset:27648
s_waitcnt lgkmcnt(7)
v_mfma_f32_16x16x32_bf16 v[128:131],v[48:51],v[32:35],v[128:131]
ds_read_b128 v[88:91],v2 offset:8192
v_mfma_f32_16x16x32_bf16 v[132:135],v[64:67],v[32:35],v[132:135]
ds_read_b128 v[92:95],v2 offset:9216
s_waitcnt lgkmcnt(6)
v_mfma_f32_16x16x32_bf16 v[128:131],v[52:55],v[36:39],v[128:131]
ds_read_b128 v[96:99],v2 offset:10240
v_mfma_f32_16x16x32_bf16 v[132:135],v[68:71],v[36:39],v[132:135]
ds_read_b128 v[100:103],v2 offset:11264
s_waitcnt lgkmcnt(4)
s_mov_b32 vcc_lo,0x33333333
s_mov_b32 vcc_hi,0x33333333
v_mfma_f32_16x16x32_bf16 v[136:139],v[72:75],v[24:27],0
ds_read_b128 v[104:107],v2 offset:12288
v_max3_u32 v238,v72,v73,v74
v_max3_u32 v238,v74,v75,v238
v_cndmask_b32_dpp v120,v72,v74,vcc quad_perm:[0,1,0,1] row_mask:0xf bank_mask:0xf
v_cndmask_b32_dpp v121,v73,v75,vcc quad_perm:[0,1,0,1] row_mask:0xf bank_mask:0xf
v_mfma_f32_16x16x32_bf16 v[136:139],v[76:79],v[28:31],v[136:139]
ds_read_b128 v[108:111],v2 offset:13312
v_max3_u32 v238,v76,v77,v238
v_max3_u32 v238,v78,v79,v238
v_cndmask_b32_dpp v122,v76,v78,vcc quad_perm:[0,1,0,1] row_mask:0xf bank_mask:0xf
v_cndmask_b32_dpp v123,v77,v79,vcc quad_perm:[0,1,0,1] row_mask:0xf bank_mask:0xf
v_mfma_f32_16x16x32_bf16 v[136:139],v[80:83],v[32:35],v[136:139]
ds_read_b128 v[112:115],v2 offset:14336
v_max3_u32 v238,v80,v81,v238
v_max3_u32 v238,v82,v83,v238
v_cndmask_b32_dpp v124,v80,v82,vcc quad_perm:[0,1,0,1] row_mask:0xf bank_mask:0xf
v_cndmask_b32_dpp v125,v81,v83,vcc quad_perm:[0,1,0,1] row_mask:0xf bank_mask:0xf
v_mfma_f32_16x16x32_bf16 v[136:139],v[84:87],v[36:39],v[136:139]
ds_read_b128 v[116:119],v2 offset:15360
v_max3_u32 v238,v84,v85,v238
v_max3_u32 v238,v86,v87,v238
v_cndmask_b32_dpp v126,v84,v86,vcc quad_perm:[0,1,0,1] row_mask:0xf bank_mask:0xf
v_cndmask_b32_dpp v127,v85,v87,vcc quad_perm:[0,1,0,1] row_mask:0xf bank_mask:0xf
v_cmp_eq_u32 vcc,-1,v238
s_waitcnt lgkmcnt(0)
s_cmp_eq_u32 s30,0
s_cbranch_scc1 L_aa_88
s_cmp_lg_u32 s86,1536
s_cbranch_scc1 L_ae_127
s_mov_b32 s77,s35
s_mov_b32 s30,0
s_lshl_b32 s56,s77,5
s_add_u32 s56,s56,s68
s_mul_i32 s70,s56,24576
s_lshl_b32 s71,s56,12
s_lshl_b32 s59,s77,13
s_lshl2_add_u32 s59,s68,s59
s_add_u32 s59,s59,10485760
s_buffer_load_dword s32,s[8:11],s59
s_mov_b32 s33,1
s_add_u32 s70,s70,100663296
s_add_u32 s71,s71,41943040
v_mov_b32 v19,s59
s_branch L_af_128
L_ae_127:
s_ff1_i32_b64 s77,s[84:85]
s_bitset0_b64 s[84:85],s77
s_min_u32 s77,s77,64
s_lshr_b32 s61,s55,5
s_lshl_b32 s56,s77,5
s_add_u32 s56,s56,s68
s_mul_i32 s70,s56,24576
s_lshl_b32 s71,s56,12
s_lshl_b32 s59,s77,13
s_lshl2_add_u32 s59,s68,s59
s_add_u32 s59,s59,10486144
s_cmp_lt_u32 s77,s61
s_cselect_b32 s57,0,16777216
s_mov_b32 s60,s59
s_buffer_load_dword s33,s[8:11],s60
s_add_u32 s71,s71,s57
s_add_u32 s71,s71,58720256
s_cmp_eq_u32 s77,s61
s_cselect_b32 s57,50331648,0
s_cselect_b32 s58,1536,0
s_add_u32 s59,s59,s58
s_buffer_load_dword s32,s[8:11],s59
s_add_u32 s70,s70,s57
s_add_u32 s70,s70,150994944
v_mov_b32 v19,s59
v_writelane_b32 v19,s60,1
L_af_128:
L_a4_106:
s_waitcnt vmcnt(0)
buffer_store_dword v20,off,s[8:11],s73 sc1
s_mov_b32 s73,0x80000000
v_max3_u32 v238,v72,v73,v74
v_max3_u32 v238,v74,v75,v238
v_max3_u32 v238,v76,v77,v238
v_max3_u32 v238,v78,v79,v238
v_max3_u32 v238,v80,v81,v238
v_max3_u32 v238,v82,v83,v238
v_max3_u32 v238,v84,v85,v238
v_max3_u32 v238,v86,v87,v238
v_cmp_eq_u32 vcc,-1,v238
s_cbranch_vccnz L_ac_129
L_acb_130:
v_max3_f32 v238,v128,v129,v130
v_max3_f32 v239,v131,v132,v133
v_max3_f32 v238,v134,v135,v238
v_max3_f32 v239,v138,v139,v239
v_max_f32 v238,v238,v239
v_max_f32 v239,v238,v239
v_pk_mul_f32 v[128:129],v[128:129],v[152:153] op_sel_hi:[1,0]
v_pk_mul_f32 v[130:131],v[130:131],v[152:153] op_sel_hi:[1,0]
v_permlane16_swap_b32 v238,v239
v_max_f32 v238,v238,v239
v_max_f32 v239,v238,v239
v_pk_mul_f32 v[132:133],v[132:133],v[152:153] op_sel_hi:[1,0]
v_pk_mul_f32 v[134:135],v[134:135],v[152:153] op_sel_hi:[1,0]
v_permlane32_swap_b32 v238,v239
v_max_f32 v238,v238,v239
v_mul_f32 v238,v152,v238
v_pk_mul_f32 v[138:139],v[138:139],v[152:153] op_sel_hi:[1,0]
v_pk_add_f32 v[128:129],v[128:129],v[238:239] op_sel_hi:[1,0] neg_lo:[0,1] neg_hi:[0,1]
v_pk_add_f32 v[130:131],v[130:131],v[238:239] op_sel_hi:[1,0] neg_lo:[0,1] neg_hi:[0,1]
v_pk_add_f32 v[132:133],v[132:133],v[238:239] op_sel_hi:[1,0] neg_lo:[0,1] neg_hi:[0,1]
v_pk_add_f32 v[134:135],v[134:135],v[238:239] op_sel_hi:[1,0] neg_lo:[0,1] neg_hi:[0,1]
v_pk_add_f32 v[138:139],v[138:139],v[238:239] op_sel_hi:[1,0] neg_lo:[0,1] neg_hi:[0,1]
v_exp_f32 v128,v128
v_exp_f32 v129,v129
v_exp_f32 v130,v130
v_exp_f32 v131,v131
v_exp_f32 v132,v132
v_exp_f32 v133,v133
v_exp_f32 v134,v134
v_exp_f32 v135,v135
v_exp_f32 v138,v138
v_exp_f32 v139,v139
v_pk_add_f32 v[148:149],v[128:129],v[130:131]
v_pk_add_f32 v[150:151],v[132:133],v[134:135]
v_pk_add_f32 v[148:149],v[148:149],v[138:139]
v_pk_add_f32 v[148:149],v[148:149],v[150:151]
v_add_f32 v150,v148,v149
v_add_f32 v151,v148,v149
s_nop 1
v_permlane16_swap_b32 v150,v151
v_add_f32 v148,v150,v151
v_add_f32 v149,v150,v151
s_nop 1
v_permlane32_swap_b32 v148,v149
v_add_f32 v148,v148,v149
v_rcp_f32 v148,v148
s_nop 0
v_pk_mul_f32 v[138:139],v[138:139],v[148:149] op_sel_hi:[1,0]
v_pk_mul_f32 v[128:129],v[128:129],v[148:149] op_sel_hi:[1,0]
v_pk_mul_f32 v[130:131],v[130:131],v[148:149] op_sel_hi:[1,0]
v_pk_mul_f32 v[132:133],v[132:133],v[148:149] op_sel_hi:[1,0]
v_pk_mul_f32 v[134:135],v[134:135],v[148:149] op_sel_hi:[1,0]
v_cvt_pk_bf16_f32 v144,v138,v139
v_cvt_pk_bf16_f32 v147,v138,v139
s_nop 0
v_mfma_f32_16x16x16_bf16 v[24:27],v[120:121],v[144:145],0
v_cvt_pk_bf16_f32 v140,v128,v129
v_mfma_f32_16x16x16_bf16 v[28:31],v[120:121],v[146:147],0
v_cvt_pk_bf16_f32 v141,v130,v131
v_mfma_f32_16x16x16_bf16 v[32:35],v[122:123],v[144:145],0
v_cvt_pk_bf16_f32 v142,v132,v133
v_mfma_f32_16x16x16_bf16 v[36:39],v[122:123],v[146:147],0
v_cvt_pk_bf16_f32 v143,v134,v135
v_mfma_f32_16x16x16_bf16 v[40:43],v[124:125],v[144:145],0
v_mfma_f32_16x16x16_bf16 v[44:47],v[124:125],v[146:147],0
v_mfma_f32_16x16x16_bf16 v[48:51],v[126:127],v[144:145],0
v_mfma_f32_16x16x16_bf16 v[52:55],v[126:127],v[146:147],0
v_mfma_f32_16x16x32_bf16 v[24:27],v[88:91],v[140:143],v[24:27]
v_mfma_f32_16x16x32_bf16 v[28:31],v[92:95],v[140:143],v[28:31]
v_mfma_f32_16x16x32_bf16 v[32:35],v[96:99],v[140:143],v[32:35]
v_mfma_f32_16x16x32_bf16 v[36:39],v[100:103],v[140:143],v[36:39]
v_cvt_pk_bf16_f32 v72,v24,v28
v_cvt_pk_bf16_f32 v73,v25,v29
v_mfma_f32_16x16x32_bf16 v[40:43],v[104:107],v[140:143],v[40:43]
v_cvt_pk_bf16_f32 v74,v26,v30
v_cvt_pk_bf16_f32 v75,v27,v31
v_mfma_f32_16x16x32_bf16 v[44:47],v[108:111],v[140:143],v[44:47]
ds_write_b128 v3,v[72:75] offset:0
v_cvt_pk_bf16_f32 v76,v32,v36
v_cvt_pk_bf16_f32 v77,v33,v37
v_mfma_f32_16x16x32_bf16 v[48:51],v[112:115],v[140:143],v[48:51]
v_cvt_pk_bf16_f32 v78,v34,v38
v_cvt_pk_bf16_f32 v79,v35,v39
v_mfma_f32_16x16x32_bf16 v[52:55],v[116:119],v[140:143],v[52:55]
ds_write_b128 v3,v[76:79] offset:1024
v_cvt_pk_bf16_f32 v80,v40,v44
v_cvt_pk_bf16_f32 v81,v41,v45
v_cvt_pk_bf16_f32 v82,v42,v46
v_cvt_pk_bf16_f32 v83,v43,v47
ds_write_b128 v3,v[80:83] offset:2048
s_nop 1
v_cvt_pk_bf16_f32 v84,v48,v52
v_cvt_pk_bf16_f32 v85,v49,v53
v_cvt_pk_bf16_f32 v86,v50,v54
v_cvt_pk_bf16_f32 v87,v51,v55
ds_write_b128 v3,v[84:87] offset:3072
s_waitcnt lgkmcnt(0)
s_barrier
L_ad_123:
s_mov_b32 s51,s53
s_mov_b32 s31,1
s_branch L_aa_80
L_aa_86:
s_waitcnt vmcnt(0)
buffer_store_dword v20,off,s[8:11],s73 sc1
s_mov_b32 s73,0x80000000
L_aa_88:
s_mov_b32 s51,s53
s_mov_b32 s31,0
s_add_u32 s35,s53,4
s_cmp_lt_u32 s53,4
s_cbranch_scc1 L_ab_131
s_cmp_ge_u32 s53,63
s_cbranch_scc1 L_am_133
L_aw_134:
v_min_u32 v239,v242,v243
v_cmp_eq_u32 vcc,0,v239
s_cbranch_vccz L_awd_135
s_sleep 4
buffer_load_dwordx2 v[242:243],v244,s[8:11],0 offen sc1
s_sub_u32 s49,s49,1
s_cbranch_scc1 L_abort
s_waitcnt vmcnt(0)
s_branch L_aw_134
L_awd_135:
v_max_u32 v242,v242,v243
s_nop 1
v_max_u32_dpp v242,v242,v242 row_ror:8 row_mask:0xf bank_mask:0xf
s_nop 1
v_max_u32_dpp v242,v242,v242 row_ror:4 row_mask:0xf bank_mask:0xf
s_nop 1
v_max_u32_dpp v242,v242,v242 row_ror:2 row_mask:0xf bank_mask:0xf
s_nop 1
v_max_u32_dpp v242,v242,v242 row_ror:1 row_mask:0xf bank_mask:0xf
v_mov_b32 v243,v242
s_nop 1
v_permlane16_swap_b32 v242,v243
v_max_u32 v242,v242,v243
v_mov_b32 v243,v242
s_nop 1
v_permlane32_swap_b32 v242,v243
v_max_u32 v242,v242,v243
s_nop 0
v_readfirstlane_b32 s56,v242
v_readlane_b32 s57,v255,s53
s_max_u32 s75,s75,s56
s_bitcmp0_b64 s[42:43],s53
s_cbranch_scc1 L_ab_131
s_mov_b32 s77,s36
s_and_b32 s55,s75,0x7ff
s_sub_u32 s55,2047,s55
s_cmp_lt_u32 s75,s57
s_cselect_b32 s55,4095,s55
s_lshr_b32 s61,s55,5
s_mov_b32 s30,1
s_lshl_b32 s56,s77,5
s_add_u32 s56,s56,s68
s_mul_i32 s70,s56,24576
s_lshl_b32 s71,s56,12
s_lshl_b32 s59,s77,13
s_lshl2_add_u32 s59,s68,s59
s_add_u32 s59,s59,10486144
s_cmp_lt_u32 s77,s61
s_cselect_b32 s57,0,16777216
s_mov_b32 s60,s59
s_add_u32 s71,s71,s57
s_add_u32 s71,s71,58720256
s_cmp_eq_u32 s77,s61
s_cselect_b32 s57,50331648,0
s_cselect_b32 s58,1536,0
s_add_u32 s59,s59,s58
s_add_u32 s70,s70,s57
s_add_u32 s70,s70,150994944
v_mov_b32 v19,s59
v_writelane_b32 v19,s60,1
s_branch L_aj_132
L_ab_131:
s_mov_b32 s77,s35
s_mov_b32 s30,0
s_lshl_b32 s56,s77,5
s_add_u32 s56,s56,s68
s_mul_i32 s70,s56,24576
s_lshl_b32 s71,s56,12
s_lshl_b32 s59,s77,13
s_lshl2_add_u32 s59,s68,s59
s_add_u32 s59,s59,10485760
s_mov_b32 s33,1
s_add_u32 s70,s70,100663296
s_add_u32 s71,s71,41943040
v_mov_b32 v19,s59
L_aj_132:
buffer_load_dword v18,v19,s[8:11],0 offen sc1
s_waitcnt vmcnt(2)
s_mov_b32 vcc_lo,0x33333333
s_mov_b32 vcc_hi,0x33333333
v_mfma_f32_16x16x32_bf16 v[136:139],v[72:75],v[24:27],0
v_max3_u32 v238,v72,v73,v74
v_max3_u32 v238,v74,v75,v238
v_cndmask_b32_dpp v120,v72,v74,vcc quad_perm:[0,1,0,1] row_mask:0xf bank_mask:0xf
v_cndmask_b32_dpp v121,v73,v75,vcc quad_perm:[0,1,0,1] row_mask:0xf bank_mask:0xf
v_mfma_f32_16x16x32_bf16 v[136:139],v[76:79],v[28:31],v[136:139]
v_max3_u32 v238,v76,v77,v238
v_max3_u32 v238,v78,v79,v238
v_cndmask_b32_dpp v122,v76,v78,vcc quad_perm:[0,1,0,1] row_mask:0xf bank_mask:0xf
v_cndmask_b32_dpp v123,v77,v79,vcc quad_perm:[0,1,0,1] row_mask:0xf bank_mask:0xf
v_mfma_f32_16x16x32_bf16 v[136:139],v[80:83],v[32:35],v[136:139]
v_max3_u32 v238,v80,v81,v238
v_max3_u32 v238,v82,v83,v238
v_cndmask_b32_dpp v124,v80,v82,vcc quad_perm:[0,1,0,1] row_mask:0xf bank_mask:0xf
v_cndmask_b32_dpp v125,v81,v83,vcc quad_perm:[0,1,0,1] row_mask:0xf bank_mask:0xf
v_mfma_f32_16x16x32_bf16 v[136:139],v[84:87],v[36:39],v[136:139]
v_max3_u32 v238,v84,v85,v238
v_max3_u32 v238,v86,v87,v238
v_cndmask_b32_dpp v126,v84,v86,vcc quad_perm:[0,1,0,1] row_mask:0xf bank_mask:0xf
v_cndmask_b32_dpp v127,v85,v87,vcc quad_perm:[0,1,0,1] row_mask:0xf bank_mask:0xf
v_cmp_eq_u32 vcc,-1,v238
s_cbranch_vccz L_aa_91
L_aa_90:
buffer_load_dwordx4 v[72:75],v0,s[8:11],s76 offen offset:0 sc1
buffer_load_dwordx4 v[76:79],v0,s[8:11],s76 offen offset:1024 sc1
buffer_load_dwordx4 v[80:83],v0,s[8:11],s76 offen offset:2048 sc1
buffer_load_dwordx4 v[84:87],v0,s[8:11],s76 offen offset:3072 sc1
buffer_load_dword v18,v19,s[8:11],0 offen sc1
s_sub_u32 s49,s49,1
s_cbranch_scc1 L_abort
s_mov_b32 vcc_lo,0x33333333
s_mov_b32 vcc_hi,0x33333333
s_waitcnt vmcnt(4)
v_mfma_f32_16x16x32_bf16 v[136:139],v[72:75],v[24:27],0
v_max3_u32 v238,v72,v73,v74
v_max3_u32 v238,v74,v75,v238
v_cndmask_b32_dpp v120,v72,v74,vcc quad_perm:[0,1,0,1] row_mask:0xf bank_mask:0xf
v_cndmask_b32_dpp v121,v73,v75,vcc quad_perm:[0,1,0,1] row_mask:0xf bank_mask:0xf
s_waitcnt vmcnt(3)
v_mfma_f32_16x16x32_bf16 v[136:139],v[76:79],v[28:31],v[136:139]
v_max3_u32 v238,v76,v77,v238
v_max3_u32 v238,v78,v79,v238
v_cndmask_b32_dpp v122,v76,v78,vcc quad_perm:[0,1,0,1] row_mask:0xf bank_mask:0xf
v_cndmask_b32_dpp v123,v77,v79,vcc quad_perm:[0,1,0,1] row_mask:0xf bank_mask:0xf
s_waitcnt vmcnt(2)
v_mfma_f32_16x16x32_bf16 v[136:139],v[80:83],v[32:35],v[136:139]
v_max3_u32 v238,v80,v81,v238
v_max3_u32 v238,v82,v83,v238
v_cndmask_b32_dpp v124,v80,v82,vcc quad_perm:[0,1,0,1] row_mask:0xf bank_mask:0xf
v_cndmask_b32_dpp v125,v81,v83,vcc quad_perm:[0,1,0,1] row_mask:0xf bank_mask:0xf
s_waitcnt vmcnt(1)
v_mfma_f32_16x16x32_bf16 v[136:139],v[84:87],v[36:39],v[136:139]
v_max3_u32 v238,v84,v85,v238
v_max3_u32 v238,v86,v87,v238
v_cndmask_b32_dpp v126,v84,v86,vcc quad_perm:[0,1,0,1] row_mask:0xf bank_mask:0xf
v_cndmask_b32_dpp v127,v85,v87,vcc quad_perm:[0,1,0,1] row_mask:0xf bank_mask:0xf
v_cmp_eq_u32 vcc,-1,v238
s_cbranch_vccnz L_aa_90
L_aa_91:
s_cmp_lg_u32 s27,3
s_cbranch_scc1 L_ai_136
v_max3_f32 v238,v128,v129,v130
v_max3_f32 v239,v131,v132,v133
v_max3_f32 v238,v134,v135,v238
v_max3_f32 v239,v138,v139,v239
v_max_f32 v238,v238,v239
v_max_f32 v239,v238,v239
v_pk_mul_f32 v[128:129],v[128:129],v[152:153] op_sel_hi:[1,0]
v_pk_mul_f32 v[130:131],v[130:131],v[152:153] op_sel_hi:[1,0]
v_permlane16_swap_b32 v238,v239
v_max_f32 v238,v238,v239
v_max_f32 v239,v238,v239
v_pk_mul_f32 v[132:133],v[132:133],v[152:153] op_sel_hi:[1,0]
v_pk_mul_f32 v[134:135],v[134:135],v[152:153] op_sel_hi:[1,0]
v_permlane32_swap_b32 v238,v239
v_max_f32 v238,v238,v239
v_mul_f32 v238,v152,v238
v_pk_mul_f32 v[138:139],v[138:139],v[152:153] op_sel_hi:[1,0]
buffer_load_dword v17,v16,s[8:11],s87 offen sc1
v_pk_add_f32 v[128:129],v[128:129],v[238:239] op_sel_hi:[1,0] neg_lo:[0,1] neg_hi:[0,1]
v_pk_add_f32 v[130:131],v[130:131],v[238:239] op_sel_hi:[1,0] neg_lo:[0,1] neg_hi:[0,1]
v_pk_add_f32 v[132:133],v[132:133],v[238:239] op_sel_hi:[1,0] neg_lo:[0,1] neg_hi:[0,1]
v_pk_add_f32 v[134:135],v[134:135],v[238:239] op_sel_hi:[1,0] neg_lo:[0,1] neg_hi:[0,1]
v_pk_add_f32 v[138:139],v[138:139],v[238:239] op_sel_hi:[1,0] neg_lo:[0,1] neg_hi:[0,1]
v_exp_f32 v128,v128
v_exp_f32 v129,v129
v_exp_f32 v130,v130
v_exp_f32 v131,v131
v_exp_f32 v132,v132
v_exp_f32 v133,v133
v_exp_f32 v134,v134
v_exp_f32 v135,v135
v_exp_f32 v138,v138
v_exp_f32 v139,v139
v_pk_add_f32 v[148:149],v[128:129],v[130:131]
v_pk_add_f32 v[150:151],v[132:133],v[134:135]
v_pk_add_f32 v[148:149],v[148:149],v[138:139]
v_pk_add_f32 v[148:149],v[148:149],v[150:151]
v_add_f32 v150,v148,v149
v_add_f32 v151,v148,v149
s_nop 1
v_permlane16_swap_b32 v150,v151
v_add_f32 v148,v150,v151
v_add_f32 v149,v150,v151
s_nop 1
v_permlane32_swap_b32 v148,v149
v_add_f32 v148,v148,v149
v_rcp_f32 v148,v148
s_waitcnt vmcnt(0)
v_cmp_gt_u32 vcc,s66,v17
v_pk_mul_f32 v[138:139],v[138:139],v[148:149] op_sel_hi:[1,0]
v_pk_mul_f32 v[128:129],v[128:129],v[148:149] op_sel_hi:[1,0]
v_pk_mul_f32 v[130:131],v[130:131],v[148:149] op_sel_hi:[1,0]
v_pk_mul_f32 v[132:133],v[132:133],v[148:149] op_sel_hi:[1,0]
v_pk_mul_f32 v[134:135],v[134:135],v[148:149] op_sel_hi:[1,0]
s_cbranch_vccnz L_ap_137
L_apb_138:
s_xor_b32 s34,s69,524288
buffer_load_dwordx4 v[192:195],v7,s[8:11],s34 offen sc1
v_cvt_pk_bf16_f32 v144,v138,v139
v_cvt_pk_bf16_f32 v147,v138,v139
s_nop 0
v_mfma_f32_16x16x16_bf16 v[24:27],v[120:121],v[144:145],0
s_add_u32 s34,s34,4096
v_cvt_pk_bf16_f32 v140,v128,v129
v_mfma_f32_16x16x16_bf16 v[28:31],v[120:121],v[146:147],0
buffer_load_dwordx4 v[196:199],v7,s[8:11],s34 offen sc1
v_cvt_pk_bf16_f32 v141,v130,v131
v_mfma_f32_16x16x16_bf16 v[32:35],v[122:123],v[144:145],0
s_add_u32 s34,s34,4096
v_cvt_pk_bf16_f32 v142,v132,v133
v_mfma_f32_16x16x16_bf16 v[36:39],v[122:123],v[146:147],0
buffer_load_dwordx4 v[200:203],v7,s[8:11],s34 offen sc1
v_cvt_pk_bf16_f32 v143,v134,v135
v_mfma_f32_16x16x16_bf16 v[40:43],v[124:125],v[144:145],0
s_add_u32 s34,s34,4096
v_mfma_f32_16x16x16_bf16 v[44:47],v[124:125],v[146:147],0
buffer_load_dwordx4 v[204:207],v7,s[8:11],s34 offen sc1
v_mfma_f32_16x16x16_bf16 v[48:51],v[126:127],v[144:145],0
s_add_u32 s34,s34,4096
v_mfma_f32_16x16x16_bf16 v[52:55],v[126:127],v[146:147],0
buffer_load_dwordx4 v[208:211],v7,s[8:11],s34 offen sc1
v_mfma_f32_16x16x32_bf16 v[24:27],v[88:91],v[140:143],v[24:27]
s_add_u32 s34,s34,4096
v_mfma_f32_16x16x32_bf16 v[28:31],v[92:95],v[140:143],v[28:31]
buffer_load_dwordx4 v[212:215],v7,s[8:11],s34 offen sc1
v_mfma_f32_16x16x32_bf16 v[32:35],v[96:99],v[140:143],v[32:35]
s_add_u32 s34,s34,4096
v_mfma_f32_16x16x32_bf16 v[36:39],v[100:103],v[140:143],v[36:39]
buffer_load_dwordx4 v[216:219],v7,s[8:11],s34 offen sc1
v_cvt_pk_bf16_f32 v72,v24,v28
v_cvt_pk_bf16_f32 v73,v25,v29
v_mfma_f32_16x16x32_bf16 v[40:43],v[104:107],v[140:143],v[40:43]
s_add_u32 s34,s34,4096
v_cvt_pk_bf16_f32 v74,v26,v30
v_cvt_pk_bf16_f32 v75,v27,v31
v_mfma_f32_16x16x32_bf16 v[44:47],v[108:111],v[140:143],v[44:47]
ds_write_b128 v3,v[72:75] offset:0
v_cvt_pk_bf16_f32 v76,v32,v36
v_cvt_pk_bf16_f32 v77,v33,v37
v_mfma_f32_16x16x32_bf16 v[48:51],v[112:115],v[140:143],v[48:51]
buffer_load_dwordx4 v[220:223],v7,s[8:11],s34 offen sc1
v_cvt_pk_bf16_f32 v78,v34,v38
v_cvt_pk_bf16_f32 v79,v35,v39
v_mfma_f32_16x16x32_bf16 v[52:55],v[116:119],v[140:143],v[52:55]
ds_write_b128 v3,v[76:79] offset:1024
v_cvt_pk_bf16_f32 v80,v40,v44
v_cvt_pk_bf16_f32 v81,v41,v45
v_cvt_pk_bf16_f32 v82,v42,v46
v_cvt_pk_bf16_f32 v83,v43,v47
ds_write_b128 v3,v[80:83] offset:2048
s_nop 1
v_cvt_pk_bf16_f32 v84,v48,v52
v_cvt_pk_bf16_f32 v85,v49,v53
v_cvt_pk_bf16_f32 v86,v50,v54
v_cvt_pk_bf16_f32 v87,v51,v55
ds_write_b128 v3,v[84:87] offset:3072
v_readlane_b32 s32,v18,0
v_readlane_b32 s33,v18,1
s_waitcnt lgkmcnt(0)
s_barrier
s_branch L_aa_93
L_ai_136:
v_max3_f32 v238,v128,v129,v130
v_max3_f32 v239,v131,v132,v133
v_max3_f32 v238,v134,v135,v238
v_max3_f32 v239,v138,v139,v239
v_max_f32 v238,v238,v239
v_max_f32 v239,v238,v239
v_pk_mul_f32 v[128:129],v[128:129],v[152:153] op_sel_hi:[1,0]
v_pk_mul_f32 v[130:131],v[130:131],v[152:153] op_sel_hi:[1,0]
v_permlane16_swap_b32 v238,v239
v_max_f32 v238,v238,v239
v_max_f32 v239,v238,v239
v_pk_mul_f32 v[132:133],v[132:133],v[152:153] op_sel_hi:[1,0]
v_pk_mul_f32 v[134:135],v[134:135],v[152:153] op_sel_hi:[1,0]
v_permlane32_swap_b32 v238,v239
v_max_f32 v238,v238,v239
v_mul_f32 v238,v152,v238
v_pk_mul_f32 v[138:139],v[138:139],v[152:153] op_sel_hi:[1,0]
v_pk_add_f32 v[128:129],v[128:129],v[238:239] op_sel_hi:[1,0] neg_lo:[0,1] neg_hi:[0,1]
v_pk_add_f32 v[130:131],v[130:131],v[238:239] op_sel_hi:[1,0] neg_lo:[0,1] neg_hi:[0,1]
v_pk_add_f32 v[132:133],v[132:133],v[238:239] op_sel_hi:[1,0] neg_lo:[0,1] neg_hi:[0,1]
v_pk_add_f32 v[134:135],v[134:135],v[238:239] op_sel_hi:[1,0] neg_lo:[0,1] neg_hi:[0,1]
v_pk_add_f32 v[138:139],v[138:139],v[238:239] op_sel_hi:[1,0] neg_lo:[0,1] neg_hi:[0,1]
v_exp_f32 v128,v128
v_exp_f32 v129,v129
v_exp_f32 v130,v130
v_exp_f32 v131,v131
v_exp_f32 v132,v132
v_exp_f32 v133,v133
v_exp_f32 v134,v134
v_exp_f32 v135,v135
v_exp_f32 v138,v138
v_exp_f32 v139,v139
v_pk_add_f32 v[148:149],v[128:129],v[130:131]
v_pk_add_f32 v[150:151],v[132:133],v[134:135]
v_pk_add_f32 v[148:149],v[148:149],v[138:139]
v_pk_add_f32 v[148:149],v[148:149],v[150:151]
v_add_f32 v150,v148,v149
v_add_f32 v151,v148,v149
s_nop 1
v_permlane16_swap_b32 v150,v151
v_add_f32 v148,v150,v151
v_add_f32 v149,v150,v151
s_nop 1
v_permlane32_swap_b32 v148,v149
v_add_f32 v148,v148,v149
v_rcp_f32 v148,v148
s_nop 0
v_pk_mul_f32 v[138:139],v[138:139],v[148:149] op_sel_hi:[1,0]
v_pk_mul_f32 v[128:129],v[128:129],v[148:149] op_sel_hi:[1,0]
v_pk_mul_f32 v[130:131],v[130:131],v[148:149] op_sel_hi:[1,0]
v_pk_mul_f32 v[132:133],v[132:133],v[148:149] op_sel_hi:[1,0]
v_pk_mul_f32 v[134:135],v[134:135],v[148:149] op_sel_hi:[1,0]
v_cvt_pk_bf16_f32 v144,v138,v139
v_cvt_pk_bf16_f32 v147,v138,v139
s_nop 0
v_mfma_f32_16x16x16_bf16 v[24:27],v[120:121],v[144:145],0
v_cvt_pk_bf16_f32 v140,v128,v129
v_mfma_f32_16x16x16_bf16 v[28:31],v[120:121],v[146:147],0
v_cvt_pk_bf16_f32 v141,v130,v131
v_mfma_f32_16x16x16_bf16 v[32:35],v[122:123],v[144:145],0
v_cvt_pk_bf16_f32 v142,v132,v133
v_mfma_f32_16x16x16_bf16 v[36:39],v[122:123],v[146:147],0
v_cvt_pk_bf16_f32 v143,v134,v135
v_mfma_f32_16x16x16_bf16 v[40:43],v[124:125],v[144:145],0
v_mfma_f32_16x16x16_bf16 v[44:47],v[124:125],v[146:147],0
v_mfma_f32_16x16x16_bf16 v[48:51],v[126:127],v[144:145],0
v_mfma_f32_16x16x16_bf16 v[52:55],v[126:127],v[146:147],0
v_mfma_f32_16x16x32_bf16 v[24:27],v[88:91],v[140:143],v[24:27]
v_mfma_f32_16x16x32_bf16 v[28:31],v[92:95],v[140:143],v[28:31]
v_mfma_f32_16x16x32_bf16 v[32:35],v[96:99],v[140:143],v[32:35]
v_mfma_f32_16x16x32_bf16 v[36:39],v[100:103],v[140:143],v[36:39]
v_cvt_pk_bf16_f32 v72,v24,v28
v_cvt_pk_bf16_f32 v73,v25,v29
v_mfma_f32_16x16x32_bf16 v[40:43],v[104:107],v[140:143],v[40:43]
v_cvt_pk_bf16_f32 v74,v26,v30
v_cvt_pk_bf16_f32 v75,v27,v31
v_mfma_f32_16x16x32_bf16 v[44:47],v[108:111],v[140:143],v[44:47]
ds_write_b128 v3,v[72:75] offset:0
v_cvt_pk_bf16_f32 v76,v32,v36
v_cvt_pk_bf16_f32 v77,v33,v37
v_mfma_f32_16x16x32_bf16 v[48:51],v[112:115],v[140:143],v[48:51]
v_cvt_pk_bf16_f32 v78,v34,v38
v_cvt_pk_bf16_f32 v79,v35,v39
v_mfma_f32_16x16x32_bf16 v[52:55],v[116:119],v[140:143],v[52:55]
ds_write_b128 v3,v[76:79] offset:1024
v_cvt_pk_bf16_f32 v80,v40,v44
v_cvt_pk_bf16_f32 v81,v41,v45
v_cvt_pk_bf16_f32 v82,v42,v46
v_cvt_pk_bf16_f32 v83,v43,v47
ds_write_b128 v3,v[80:83] offset:2048
s_nop 1
v_cvt_pk_bf16_f32 v84,v48,v52
v_cvt_pk_bf16_f32 v85,v49,v53
v_cvt_pk_bf16_f32 v86,v50,v54
v_cvt_pk_bf16_f32 v87,v51,v55
ds_write_b128 v3,v[84:87] offset:3072
s_waitcnt vmcnt(0)
v_readlane_b32 s32,v18,0
v_readlane_b32 s33,v18,1
s_waitcnt lgkmcnt(0)
s_barrier
s_branch L_aa_80
L_aa_89:
s_cmp_lg_u32 s86,1536
s_cbranch_scc1 L_az_139
s_cmp_ge_u32 s35,67
s_cbranch_scc1 L_aa_79
v_subrev_u32 v248,s36,v1
v_and_b32 v248,0x80000003,v248
v_cmp_eq_u32 vcc,0,v248
v_lshlrev_b32 v248,2,v1
v_mov_b32 v249,0x40000000
v_cndmask_b32 v248,v249,v248,vcc
v_mov_b32 v249,3
s_or_b32 s59,s68,s46
s_mov_b32 s59,11018240
s_cmov_b32 s59,0x80000000
buffer_store_dword v249,v248,s[8:11],s59 offen sc1
L_aa_79:
s_waitcnt vmcnt(0)
buffer_store_dword v20,off,s[8:11],s73 sc1
s_mov_b32 s73,0x80000000
v_lshlrev_b32 v238,2,v1
v_add_u32 v248,155712,v238
s_cmp_lg_u32 s46,0
s_cbranch_scc1 L_an_140
s_lshl_b32 s59,s54,13
s_add_u32 s59,s59,11026432
L_fp_141:
s_sleep 1
buffer_load_dword v239,v238,s[8:11],s59 offen sc1
s_sub_u32 s49,s49,1
s_cbranch_scc1 L_abort
s_waitcnt vmcnt(0)
v_cmp_eq_u32 vcc,0,v239
s_cbranch_vccnz L_fp_141
ds_write_b32 v248,v239
s_waitcnt lgkmcnt(0)
L_an_140:
s_barrier
ds_read_b32 v239,v248
s_mov_b32 s86,768
s_mov_b32 s30,1
s_waitcnt lgkmcnt(0)
v_readfirstlane_b32 s55,v239
v_and_b32 v239,255,v239
s_lshr_b32 s55,s55,8
s_lshr_b32 s61,s55,5
v_cmp_ne_u32 s[38:39],3,v239
v_cmp_le_u32 vcc,s61,v1
s_nop 1
v_cndmask_b32 v238,1,2,vcc
v_cmp_ne_u32 s[84:85],v238,v239
s_bcnt1_i32_b64 s56,s[84:85]
s_nop 0
v_mbcnt_lo_u32_b32 v238,s84,0
v_mbcnt_hi_u32_b32 v238,s85,v238
s_mul_i32 s56,s56,15
s_add_u32 s56,s56,130
s_lshr_b32 s56,s56,7
s_lshl_b32 s56,s56,1
v_cmp_gt_u32 vcc,s56,v238
v_and_b32 v239,1,v238
v_and_b32 v238,3,v238
v_add_u32 v238,2,v238
v_cndmask_b32 v238,v238,v239,vcc
v_cmp_eq_u32 vcc,s54,v238
s_and_b64 s[84:85],s[84:85],vcc
s_ff1_i32_b64 s77,s[84:85]
s_bitset0_b64 s[84:85],s77
s_min_u32 s77,s77,64
s_lshl_b32 s56,s77,5
s_add_u32 s56,s56,s68
s_mul_i32 s70,s56,24576
s_lshl_b32 s71,s56,12
s_lshl_b32 s59,s77,13
s_lshl2_add_u32 s59,s68,s59
s_add_u32 s59,s59,10486144
s_cmp_lt_u32 s77,s61
s_cselect_b32 s57,0,16777216
s_mov_b32 s60,s59
s_buffer_load_dword s33,s[8:11],s60
s_add_u32 s71,s71,s57
s_add_u32 s71,s71,58720256
s_cmp_eq_u32 s77,s61
s_cselect_b32 s57,50331648,0
s_cselect_b32 s58,1536,0
s_add_u32 s59,s59,s58
s_buffer_load_dword s32,s[8:11],s59
s_add_u32 s70,s70,s57
s_add_u32 s70,s70,150994944
v_mov_b32 v19,s59
v_writelane_b32 v19,s60,1
s_cmp_ge_u32 s77,64
s_cbranch_scc1 L_az_139
s_cmp_eq_u32 s77,s61
s_cbranch_scc1 L_aa_87
s_mov_b32 s27,0
s_bitcmp1_b64 s[38:39],s77
s_cbranch_scc1 L_a3_126
s_branch L_aa_87
L_az_139:
s_waitcnt vmcnt(0)
buffer_store_dword v20,off,s[8:11],s73 sc1
s_mov_b32 s73,0x80000000
s_endpgm
L_ag_95:
s_lshl_b32 s21,s26,13
s_lshl2_add_u32 s21,s68,s21
s_add_u32 s21,s21,10487296
L_ww_142:
buffer_load_dword v246,off,s[8:11],s21 sc1
s_sub_u32 s49,s49,1
s_cbranch_scc1 L_abort
s_waitcnt vmcnt(0)
v_readfirstlane_b32 s22,v246
s_cmp_eq_u32 s22,0
s_cbranch_scc1 L_ww_142
L_wwd_143:
s_branch L_agb_96
L_a4_104:
v_mov_b32 v248,s27
ds_write_b32 v247,v248 offset:16
s_waitcnt lgkmcnt(0)
s_barrier
ds_read_b128 v[248:251],v245 offset:16
s_waitcnt lgkmcnt(0)
v_or3_b32 v248,v248,v249,v250
v_or_b32 v248,v248,v251
v_cmp_ne_u32 vcc,0,v248
s_cbranch_vccz L_a4_105
L_aq_144:
buffer_load_dword v17,v16,s[8:11],s87 offen sc1
s_sub_u32 s49,s49,1
s_cbranch_scc1 L_abort
s_waitcnt vmcnt(0)
v_cmp_gt_u32 vcc,s66,v17
s_cbranch_vccnz L_aq_144
s_xor_b32 s34,s69,524288
buffer_load_dwordx4 v[160:163],v7,s[8:11],s34 offen sc1
s_add_u32 s34,s34,4096
buffer_load_dwordx4 v[164:167],v7,s[8:11],s34 offen sc1
s_add_u32 s34,s34,4096
buffer_load_dwordx4 v[168:171],v7,s[8:11],s34 offen sc1
s_add_u32 s34,s34,4096
buffer_load_dwordx4 v[172:175],v7,s[8:11],s34 offen sc1
s_add_u32 s34,s34,4096
buffer_load_dwordx4 v[176:179],v7,s[8:11],s34 offen sc1
s_add_u32 s34,s34,4096
buffer_load_dwordx4 v[180:183],v7,s[8:11],s34 offen sc1
s_add_u32 s34,s34,4096
buffer_load_dwordx4 v[184:187],v7,s[8:11],s34 offen sc1
s_add_u32 s34,s34,4096
buffer_load_dwordx4 v[188:191],v7,s[8:11],s34 offen sc1
s_waitcnt vmcnt(7)
v_mfma_f32_16x16x32_bf16 v[192:195],v[156:159],v[160:163],0
s_waitcnt vmcnt(6)
v_mfma_f32_16x16x32_bf16 v[192:195],v[156:159],v[164:167],v[192:195]
s_waitcnt vmcnt(5)
v_mfma_f32_16x16x32_bf16 v[192:195],v[156:159],v[168:171],v[192:195]
s_waitcnt vmcnt(4)
v_mfma_f32_16x16x32_bf16 v[192:195],v[156:159],v[172:175],v[192:195]
s_waitcnt vmcnt(3)
v_mfma_f32_16x16x32_bf16 v[196:199],v[156:159],v[176:179],0
s_waitcnt vmcnt(2)
v_mfma_f32_16x16x32_bf16 v[196:199],v[156:159],v[180:183],v[196:199]
s_waitcnt vmcnt(1)
v_mfma_f32_16x16x32_bf16 v[196:199],v[156:159],v[184:187],v[196:199]
ds_write_b128 v6,v[192:195]
s_waitcnt vmcnt(0)
v_mfma_f32_16x16x32_bf16 v[196:199],v[156:159],v[188:191],v[196:199]
s_nop 7
ds_write_b128 v6,v[196:199] offset:2048
s_waitcnt lgkmcnt(0)
s_barrier
buffer_store_dword v20,off,s[8:11],s73 sc1
s_mov_b32 s73,0x80000000
s_mov_b32 s27,4
s_branch L_aa_84
L_ac_107:
buffer_store_dword v20,off,s[8:11],s73 sc1
s_mov_b32 s73,0x80000000
buffer_load_dwordx4 v[72:75],v0,s[8:11],s76 offen offset:0 sc1
buffer_load_dwordx4 v[76:79],v0,s[8:11],s76 offen offset:1024 sc1
buffer_load_dwordx4 v[80:83],v0,s[8:11],s76 offen offset:2048 sc1
buffer_load_dwordx4 v[84:87],v0,s[8:11],s76 offen offset:3072 sc1
s_sub_u32 s49,s49,1
s_cbranch_scc1 L_abort
s_mov_b32 vcc_lo,0x33333333
s_mov_b32 vcc_hi,0x33333333
s_waitcnt vmcnt(3)
v_mfma_f32_16x16x32_bf16 v[136:139],v[72:75],v[24:27],0
v_max3_u32 v238,v72,v73,v74
v_max3_u32 v238,v74,v75,v238
v_cndmask_b32_dpp v120,v72,v74,vcc quad_perm:[0,1,0,1] row_mask:0xf bank_mask:0xf
v_cndmask_b32_dpp v121,v73,v75,vcc quad_perm:[0,1,0,1] row_mask:0xf bank_mask:0xf
s_waitcnt vmcnt(2)
v_mfma_f32_16x16x32_bf16 v[136:139],v[76:79],v[28:31],v[136:139]
v_max3_u32 v238,v76,v77,v238
v_max3_u32 v238,v78,v79,v238
v_cndmask_b32_dpp v122,v76,v78,vcc quad_perm:[0,1,0,1] row_mask:0xf bank_mask:0xf
v_cndmask_b32_dpp v123,v77,v79,vcc quad_perm:[0,1,0,1] row_mask:0xf bank_mask:0xf
s_waitcnt vmcnt(1)
v_mfma_f32_16x16x32_bf16 v[136:139],v[80:83],v[32:35],v[136:139]
v_max3_u32 v238,v80,v81,v238
v_max3_u32 v238,v82,v83,v238
v_cndmask_b32_dpp v124,v80,v82,vcc quad_perm:[0,1,0,1] row_mask:0xf bank_mask:0xf
v_cndmask_b32_dpp v125,v81,v83,vcc quad_perm:[0,1,0,1] row_mask:0xf bank_mask:0xf
s_waitcnt vmcnt(0)
v_mfma_f32_16x16x32_bf16 v[136:139],v[84:87],v[36:39],v[136:139]
v_max3_u32 v238,v84,v85,v238
v_max3_u32 v238,v86,v87,v238
v_cndmask_b32_dpp v126,v84,v86,vcc quad_perm:[0,1,0,1] row_mask:0xf bank_mask:0xf
v_cndmask_b32_dpp v127,v85,v87,vcc quad_perm:[0,1,0,1] row_mask:0xf bank_mask:0xf
v_cmp_eq_u32 vcc,-1,v238
s_cbranch_vccnz L_ac_107
s_branch L_acb_108
L_ap_110:
L_aw_145:
v_cmp_gt_u32 vcc,s66,v17
s_cbranch_vccz L_awd_146
buffer_load_dword v17,v16,s[8:11],s87 offen sc1
s_sub_u32 s49,s49,1
s_cbranch_scc1 L_abort
s_waitcnt vmcnt(0)
s_branch L_aw_145
L_awd_146:
s_branch L_apb_111
L_a1_112:
v_subrev_u32 v248,s36,v1
v_and_b32 v248,0x80000003,v248
v_cmp_eq_u32 vcc,0,v248
v_lshlrev_b32 v248,2,v1
v_mov_b32 v249,0x40000000
v_cndmask_b32 v248,v249,v248,vcc
v_mov_b32 v249,3
s_or_b32 s59,s68,s46
s_mov_b32 s59,11018240
s_cmov_b32 s59,0x80000000
buffer_store_dword v249,v248,s[8:11],s59 offen sc1
s_branch L_a2_113
L_ag_121:
s_lshl_b32 s21,s51,13
s_lshl2_add_u32 s21,s68,s21
s_add_u32 s21,s21,10487296
L_ww_147:
buffer_load_dword v246,off,s[8:11],s21 sc1
s_sub_u32 s49,s49,1
s_cbranch_scc1 L_abort
s_waitcnt vmcnt(0)
v_readfirstlane_b32 s22,v246
s_cmp_eq_u32 s22,0
s_cbranch_scc1 L_ww_147
L_wwd_148:
s_branch L_agb_122
L_ac_129:
buffer_store_dword v20,off,s[8:11],s73 sc1
s_mov_b32 s73,0x80000000
buffer_load_dwordx4 v[72:75],v0,s[8:11],s76 offen offset:0 sc1
buffer_load_dwordx4 v[76:79],v0,s[8:11],s76 offen offset:1024 sc1
buffer_load_dwordx4 v[80:83],v0,s[8:11],s76 offen offset:2048 sc1
buffer_load_dwordx4 v[84:87],v0,s[8:11],s76 offen offset:3072 sc1
s_sub_u32 s49,s49,1
s_cbranch_scc1 L_abort
s_mov_b32 vcc_lo,0x33333333
s_mov_b32 vcc_hi,0x33333333
s_waitcnt vmcnt(3)
v_mfma_f32_16x16x32_bf16 v[136:139],v[72:75],v[24:27],0
v_max3_u32 v238,v72,v73,v74
v_max3_u32 v238,v74,v75,v238
v_cndmask_b32_dpp v120,v72,v74,vcc quad_perm:[0,1,0,1] row_mask:0xf bank_mask:0xf
v_cndmask_b32_dpp v121,v73,v75,vcc quad_perm:[0,1,0,1] row_mask:0xf bank_mask:0xf
s_waitcnt vmcnt(2)
v_mfma_f32_16x16x32_bf16 v[136:139],v[76:79],v[28:31],v[136:139]
v_max3_u32 v238,v76,v77,v238
v_max3_u32 v238,v78,v79,v238
v_cndmask_b32_dpp v122,v76,v78,vcc quad_perm:[0,1,0,1] row_mask:0xf bank_mask:0xf
v_cndmask_b32_dpp v123,v77,v79,vcc quad_perm:[0,1,0,1] row_mask:0xf bank_mask:0xf
s_waitcnt vmcnt(1)
v_mfma_f32_16x16x32_bf16 v[136:139],v[80:83],v[32:35],v[136:139]
v_max3_u32 v238,v80,v81,v238
v_max3_u32 v238,v82,v83,v238
v_cndmask_b32_dpp v124,v80,v82,vcc quad_perm:[0,1,0,1] row_mask:0xf bank_mask:0xf
v_cndmask_b32_dpp v125,v81,v83,vcc quad_perm:[0,1,0,1] row_mask:0xf bank_mask:0xf
s_waitcnt vmcnt(0)
v_mfma_f32_16x16x32_bf16 v[136:139],v[84:87],v[36:39],v[136:139]
v_max3_u32 v238,v84,v85,v238
v_max3_u32 v238,v86,v87,v238
v_cndmask_b32_dpp v126,v84,v86,vcc quad_perm:[0,1,0,1] row_mask:0xf bank_mask:0xf
v_cndmask_b32_dpp v127,v85,v87,vcc quad_perm:[0,1,0,1] row_mask:0xf bank_mask:0xf
v_cmp_eq_u32 vcc,-1,v238
s_cbranch_vccnz L_ac_129
s_branch L_acb_130
L_am_133:
v_subrev_u32 v248,s36,v1
v_and_b32 v248,0x80000003,v248
v_cmp_eq_u32 vcc,0,v248
v_lshlrev_b32 v248,2,v1
v_mov_b32 v249,0x40000000
v_cndmask_b32 v248,v249,v248,vcc
v_mov_b32 v249,3
s_or_b32 s59,s68,s46
s_mov_b32 s59,11018240
s_cmov_b32 s59,0x80000000
buffer_store_dword v249,v248,s[8:11],s59 offen sc1
s_branch L_ab_131
L_ap_137:
L_aw_149:
v_cmp_gt_u32 vcc,s66,v17
s_cbranch_vccz L_awd_150
buffer_load_dword v17,v16,s[8:11],s87 offen sc1
s_sub_u32 s49,s49,1
s_cbranch_scc1 L_abort
s_waitcnt vmcnt(0)
s_branch L_aw_149
L_awd_150:
s_branch L_apb_138
s_endpgm
L_rch_4:
s_waitcnt vmcnt(12)
v_swap_b32 v25,v28
v_swap_b32 v26,v32
v_swap_b32 v27,v36
v_swap_b32 v30,v33
v_swap_b32 v31,v37
v_swap_b32 v35,v38
ds_write_b128 v93,v[24:27] offset:0
ds_write_b128 v94,v[28:31] offset:0
ds_write_b128 v93,v[32:35] offset:128
ds_write_b128 v94,v[36:39] offset:128
s_waitcnt lgkmcnt(0)
s_mov_b32 s56,65536
buffer_load_dwordx4 v[24:27],v92,s[4:7],s56 offen offset:0
buffer_load_dwordx4 v[28:31],v92,s[4:7],s56 offen offset:1024
buffer_load_dwordx4 v[32:35],v92,s[4:7],s56 offen offset:2048
buffer_load_dwordx4 v[36:39],v92,s[4:7],s56 offen offset:3072
s_waitcnt vmcnt(12)
v_swap_b32 v41,v44
v_swap_b32 v42,v48
v_swap_b32 v43,v52
v_swap_b32 v46,v49
v_swap_b32 v47,v53
v_swap_b32 v51,v54
ds_write_b128 v93,v[40:43] offset:1024
ds_write_b128 v94,v[44:47] offset:1024
ds_write_b128 v93,v[48:51] offset:1152
ds_write_b128 v94,v[52:55] offset:1152
s_waitcnt lgkmcnt(0)
s_mov_b32 s56,81920
buffer_load_dwordx4 v[40:43],v92,s[4:7],s56 offen offset:0
buffer_load_dwordx4 v[44:47],v92,s[4:7],s56 offen offset:1024
buffer_load_dwordx4 v[48:51],v92,s[4:7],s56 offen offset:2048
buffer_load_dwordx4 v[52:55],v92,s[4:7],s56 offen offset:3072
s_waitcnt vmcnt(12)
v_swap_b32 v57,v60
v_swap_b32 v58,v64
v_swap_b32 v59,v68
v_swap_b32 v62,v65
v_swap_b32 v63,v69
v_swap_b32 v67,v70
ds_write_b128 v93,v[56:59] offset:2048
ds_write_b128 v94,v[60:63] offset:2048
ds_write_b128 v93,v[64:67] offset:2176
ds_write_b128 v94,v[68:71] offset:2176
s_waitcnt lgkmcnt(0)
s_mov_b32 s56,98304
buffer_load_dwordx4 v[56:59],v92,s[4:7],s56 offen offset:0
buffer_load_dwordx4 v[60:63],v92,s[4:7],s56 offen offset:1024
buffer_load_dwordx4 v[64:67],v92,s[4:7],s56 offen offset:2048
buffer_load_dwordx4 v[68:71],v92,s[4:7],s56 offen offset:3072
s_waitcnt vmcnt(12)
v_swap_b32 v73,v76
v_swap_b32 v74,v80
v_swap_b32 v75,v84
v_swap_b32 v78,v81
v_swap_b32 v79,v85
v_swap_b32 v83,v86
ds_write_b128 v93,v[72:75] offset:3072
ds_write_b128 v94,v[76:79] offset:3072
ds_write_b128 v93,v[80:83] offset:3200
ds_write_b128 v94,v[84:87] offset:3200
s_waitcnt lgkmcnt(0)
s_mov_b32 s56,114688
buffer_load_dwordx4 v[72:75],v92,s[4:7],s56 offen offset:0
buffer_load_dwordx4 v[76:79],v92,s[4:7],s56 offen offset:1024
buffer_load_dwordx4 v[80:83],v92,s[4:7],s56 offen offset:2048
buffer_load_dwordx4 v[84:87],v92,s[4:7],s56 offen offset:3072
s_cmp_eq_u32 s48,0
s_cbranch_scc1 L_rs_151
s_waitcnt vmcnt(12)
v_swap_b32 v25,v28
v_swap_b32 v26,v32
v_swap_b32 v27,v36
v_swap_b32 v30,v33
v_swap_b32 v31,v37
v_swap_b32 v35,v38
ds_write_b128 v93,v[24:27] offset:4096
ds_write_b128 v94,v[28:31] offset:4096
ds_write_b128 v93,v[32:35] offset:4224
ds_write_b128 v94,v[36:39] offset:4224
s_waitcnt vmcnt(8)
v_swap_b32 v41,v44
v_swap_b32 v42,v48
v_swap_b32 v43,v52
v_swap_b32 v46,v49
v_swap_b32 v47,v53
v_swap_b32 v51,v54
ds_write_b128 v93,v[40:43] offset:5120
ds_write_b128 v94,v[44:47] offset:5120
ds_write_b128 v93,v[48:51] offset:5248
ds_write_b128 v94,v[52:55] offset:5248
s_waitcnt vmcnt(4)
v_swap_b32 v57,v60
v_swap_b32 v58,v64
v_swap_b32 v59,v68
v_swap_b32 v62,v65
v_swap_b32 v63,v69
v_swap_b32 v67,v70
ds_write_b128 v93,v[56:59] offset:6144
ds_write_b128 v94,v[60:63] offset:6144
ds_write_b128 v93,v[64:67] offset:6272
ds_write_b128 v94,v[68:71] offset:6272
s_waitcnt vmcnt(0)
v_swap_b32 v73,v76
v_swap_b32 v74,v80
v_swap_b32 v75,v84
v_swap_b32 v78,v81
v_swap_b32 v79,v85
v_swap_b32 v83,v86
ds_write_b128 v93,v[72:75] offset:7168
ds_write_b128 v94,v[76:79] offset:7168
ds_write_b128 v93,v[80:83] offset:7296
ds_write_b128 v94,v[84:87] offset:7296
L_rs_151:
v_mov_b32 v123,159744
s_cmp_lg_u32 s46,0
s_cbranch_scc1 L_gbd_153
v_mov_b32 v124,240
s_buffer_load_dword s56,s[12:15],240
s_waitcnt lgkmcnt(0)
v_mov_b32 v125,s56
ds_write_b32 v123,v125
s_bitcmp1_b32 s56,8
s_cbranch_scc1 L_gbd_153
L_gb_152:
buffer_load_dword v125,v124,s[12:15],0 offen sc1
s_waitcnt vmcnt(0)
v_readfirstlane_b32 s56,v125
ds_write_b32 v123,v125
s_bitcmp1_b32 s56,8
s_cbranch_scc1 L_gbd_153
s_sleep 4
s_sub_u32 s49,s49,1
s_cmp_gt_i32 s49,0
s_cbranch_scc1 L_gb_152
s_branch L_abort
L_gbd_153:
s_waitcnt lgkmcnt(0)
s_barrier
ds_read_b32 v125,v123
s_waitcnt lgkmcnt(0)
v_readfirstlane_b32 s56,v125
s_barrier
s_lshr_b32 s56,s56,16
s_andn2_b32 s56,s56,s3
s_cbranch_scc1 L_spread
s_cmp_eq_u32 s48,0
s_cbranch_scc1 L_chd_154
v_and_b32 v120,15,v1
v_lshrrev_b32 v121,4,v1
v_mov_b32 v17,1
s_lshl_b32 s56,s46,2
v_add_u32 v125,s56,v121
v_xor_b32 v126,v125,v120
v_lshlrev_b32 v126,4,v126
v_lshl_add_u32 v20,v125,10,v126
s_lshl_b32 s56,s46,1
s_xor_b32 s56,s56,0
s_and_b32 s57,s56,3
s_lshl_b32 s57,s57,2
s_lshr_b32 s56,s56,2
s_lshl_b32 s56,s56,13
s_add_u32 s56,s56,131072
v_add_u32 v125,s57,v121
v_xor_b32 v125,v125,v120
v_lshlrev_b32 v125,4,v125
v_lshl_add_u32 v125,v120,8,v125
v_add_u32 v4,s56,v125
s_lshl_b32 s56,s46,1
s_xor_b32 s56,s56,1
s_and_b32 s57,s56,3
s_lshl_b32 s57,s57,2
s_lshr_b32 s56,s56,2
s_lshl_b32 s56,s56,13
s_add_u32 s56,s56,131072
v_add_u32 v125,s57,v121
v_xor_b32 v125,v125,v120
v_lshlrev_b32 v125,4,v125
v_lshl_add_u32 v125,v120,8,v125
v_add_u32 v5,s56,v125
s_lshl_b32 s56,s46,1
s_xor_b32 s56,s56,2
s_and_b32 s57,s56,3
s_lshl_b32 s57,s57,2
s_lshr_b32 s56,s56,2
s_lshl_b32 s56,s56,13
s_add_u32 s56,s56,131072
v_add_u32 v125,s57,v121
v_xor_b32 v125,v125,v120
v_lshlrev_b32 v125,4,v125
v_lshl_add_u32 v125,v120,8,v125
v_add_u32 v6,s56,v125
s_lshl_b32 s56,s46,1
s_xor_b32 s56,s56,3
s_and_b32 s57,s56,3
s_lshl_b32 s57,s57,2
s_lshr_b32 s56,s56,2
s_lshl_b32 s56,s56,13
s_add_u32 s56,s56,131072
v_add_u32 v125,s57,v121
v_xor_b32 v125,v125,v120
v_lshlrev_b32 v125,4,v125
v_lshl_add_u32 v125,v120,8,v125
v_add_u32 v7,s56,v125
s_lshl_b32 s56,s46,1
s_xor_b32 s56,s56,4
s_and_b32 s57,s56,3
s_lshl_b32 s57,s57,2
s_lshr_b32 s56,s56,2
s_lshl_b32 s56,s56,13
s_add_u32 s56,s56,131072
v_add_u32 v125,s57,v121
v_xor_b32 v125,v125,v120
v_lshlrev_b32 v125,4,v125
v_lshl_add_u32 v125,v120,8,v125
v_add_u32 v8,s56,v125
s_lshl_b32 s56,s46,1
s_xor_b32 s56,s56,5
s_and_b32 s57,s56,3
s_lshl_b32 s57,s57,2
s_lshr_b32 s56,s56,2
s_lshl_b32 s56,s56,13
s_add_u32 s56,s56,131072
v_add_u32 v125,s57,v121
v_xor_b32 v125,v125,v120
v_lshlrev_b32 v125,4,v125
v_lshl_add_u32 v125,v120,8,v125
v_add_u32 v9,s56,v125
s_lshl_b32 s56,s46,1
s_xor_b32 s56,s56,6
s_and_b32 s57,s56,3
s_lshl_b32 s57,s57,2
s_lshr_b32 s56,s56,2
s_lshl_b32 s56,s56,13
s_add_u32 s56,s56,131072
v_add_u32 v125,s57,v121
v_xor_b32 v125,v125,v120
v_lshlrev_b32 v125,4,v125
v_lshl_add_u32 v125,v120,8,v125
v_add_u32 v10,s56,v125
s_lshl_b32 s56,s46,1
s_xor_b32 s56,s56,7
s_and_b32 s57,s56,3
s_lshl_b32 s57,s57,2
s_lshr_b32 s56,s56,2
s_lshl_b32 s56,s56,13
s_add_u32 s56,s56,131072
v_add_u32 v125,s57,v121
v_xor_b32 v125,v125,v120
v_lshlrev_b32 v125,4,v125
v_lshl_add_u32 v125,v120,8,v125
v_add_u32 v11,s56,v125
s_cmp_eq_u32 s48,1
s_cselect_b32 s51,14,17
s_cselect_b32 s53,3,5
s_mov_b32 s72,0x80000000
s_lshl_b32 s70,s51,15
s_add_u32 s70,s70,0
s_add_u32 s71,s70,16384
s_add_u32 m0,s50,131072
s_nop 0
buffer_load_dwordx4 v20,s[8:11],s70 offen offset:0 sc1 lds
s_add_u32 m0,s50,135168
s_nop 0
buffer_load_dwordx4 v20,s[8:11],s71 offen offset:0 sc1 lds
s_add_u32 m0,s50,139008
s_nop 0
buffer_load_dwordx4 v20,s[8:11],s70 offen offset:256 sc1 lds
s_add_u32 m0,s50,143104
s_nop 0
buffer_load_dwordx4 v20,s[8:11],s71 offen offset:256 sc1 lds
s_waitcnt vmcnt(0)
L_chl_155:
s_mov_b64 s[68:69],s[70:71]
s_add_u32 s70,s70,32768
s_add_u32 s71,s71,32768
s_lshl_b32 s58,s51,5
s_add_u32 s58,s58,s47
s_mul_i32 s58,s58,24576
s_add_u32 s58,s58,100663296
s_add_u32 s61,s58,s50
s_add_u32 s62,s61,4096
s_add_u32 s63,s61,16384
s_add_u32 s64,s61,20480
s_add_u32 s65,s61,s50
s_add_u32 s65,s65,8192
s_waitcnt vmcnt(7)
s_barrier
ds_read_b128 v[72:75],v4 offset:0
ds_read_b128 v[76:79],v4 offset:4096
ds_read_b128 v[80:83],v5 offset:0
ds_read_b128 v[84:87],v5 offset:4096
s_add_u32 m0,s50,146944
s_nop 0
buffer_load_dwordx4 v20,s[8:11],s68 offen offset:512 sc1 lds
s_add_u32 m0,s50,151040
s_nop 0
buffer_load_dwordx4 v20,s[8:11],s69 offen offset:512 sc1 lds
s_add_u32 m0,s50,154880
s_nop 0
buffer_load_dwordx4 v20,s[8:11],s68 offen offset:768 sc1 lds
s_add_u32 m0,s50,158976
s_nop 0
buffer_load_dwordx4 v20,s[8:11],s69 offen offset:768 sc1 lds
s_waitcnt lgkmcnt(2)
v_mfma_f32_16x16x32_bf16 v[40:43],a[128:131],v[72:75],0
ds_read_b128 v[108:111],v6 offset:0
v_mfma_f32_16x16x32_bf16 v[56:59],v[72:75],v[128:131],0
v_mfma_f32_16x16x32_bf16 v[24:27],a[0:3],v[72:75],0
ds_read_b128 v[112:115],v6 offset:4096
v_mfma_f32_16x16x32_bf16 v[44:47],a[128:131],v[76:79],0
v_mfma_f32_16x16x32_bf16 v[60:63],v[76:79],v[128:131],0
v_mfma_f32_16x16x32_bf16 v[28:31],a[0:3],v[76:79],0
v_mfma_f32_16x16x32_bf16 v[48:51],a[136:139],v[72:75],0
v_mfma_f32_16x16x32_bf16 v[64:67],v[72:75],v[136:139],0
v_mfma_f32_16x16x32_bf16 v[32:35],a[8:11],v[72:75],0
v_mfma_f32_16x16x32_bf16 v[52:55],a[136:139],v[76:79],0
v_mfma_f32_16x16x32_bf16 v[68:71],v[76:79],v[136:139],0
v_mfma_f32_16x16x32_bf16 v[36:39],a[8:11],v[76:79],0
s_waitcnt lgkmcnt(2)
v_mfma_f32_16x16x32_bf16 v[40:43],a[132:135],v[80:83],v[40:43]
ds_read_b128 v[72:75],v7 offset:0
v_mfma_f32_16x16x32_bf16 v[56:59],v[80:83],v[132:135],v[56:59]
v_mfma_f32_16x16x32_bf16 v[24:27],a[4:7],v[80:83],v[24:27]
ds_read_b128 v[76:79],v7 offset:4096
v_mfma_f32_16x16x32_bf16 v[44:47],a[132:135],v[84:87],v[44:47]
v_mfma_f32_16x16x32_bf16 v[60:63],v[84:87],v[132:135],v[60:63]
v_mfma_f32_16x16x32_bf16 v[28:31],a[4:7],v[84:87],v[28:31]
v_mfma_f32_16x16x32_bf16 v[48:51],a[140:143],v[80:83],v[48:51]
v_mfma_f32_16x16x32_bf16 v[64:67],v[80:83],v[140:143],v[64:67]
v_mfma_f32_16x16x32_bf16 v[32:35],a[12:15],v[80:83],v[32:35]
v_mfma_f32_16x16x32_bf16 v[52:55],a[140:143],v[84:87],v[52:55]
v_mfma_f32_16x16x32_bf16 v[68:71],v[84:87],v[140:143],v[68:71]
v_mfma_f32_16x16x32_bf16 v[36:39],a[12:15],v[84:87],v[36:39]
s_waitcnt lgkmcnt(2)
v_mfma_f32_16x16x32_bf16 v[40:43],a[144:147],v[108:111],v[40:43]
ds_read_b128 v[80:83],v8 offset:0
v_mfma_f32_16x16x32_bf16 v[56:59],v[108:111],v[144:147],v[56:59]
v_mfma_f32_16x16x32_bf16 v[24:27],a[16:19],v[108:111],v[24:27]
ds_read_b128 v[84:87],v8 offset:4096
v_mfma_f32_16x16x32_bf16 v[44:47],a[144:147],v[112:115],v[44:47]
v_mfma_f32_16x16x32_bf16 v[60:63],v[112:115],v[144:147],v[60:63]
v_mfma_f32_16x16x32_bf16 v[28:31],a[16:19],v[112:115],v[28:31]
v_mfma_f32_16x16x32_bf16 v[48:51],a[152:155],v[108:111],v[48:51]
v_mfma_f32_16x16x32_bf16 v[64:67],v[108:111],v[152:155],v[64:67]
v_mfma_f32_16x16x32_bf16 v[32:35],a[24:27],v[108:111],v[32:35]
v_mfma_f32_16x16x32_bf16 v[52:55],a[152:155],v[112:115],v[52:55]
v_mfma_f32_16x16x32_bf16 v[68:71],v[112:115],v[152:155],v[68:71]
v_mfma_f32_16x16x32_bf16 v[36:39],a[24:27],v[112:115],v[36:39]
s_waitcnt lgkmcnt(2)
v_mfma_f32_16x16x32_bf16 v[40:43],a[148:151],v[72:75],v[40:43]
ds_read_b128 v[108:111],v9 offset:0
v_mfma_f32_16x16x32_bf16 v[56:59],v[72:75],v[148:151],v[56:59]
v_mfma_f32_16x16x32_bf16 v[24:27],a[20:23],v[72:75],v[24:27]
ds_read_b128 v[112:115],v9 offset:4096
v_mfma_f32_16x16x32_bf16 v[44:47],a[148:151],v[76:79],v[44:47]
v_mfma_f32_16x16x32_bf16 v[60:63],v[76:79],v[148:151],v[60:63]
v_mfma_f32_16x16x32_bf16 v[28:31],a[20:23],v[76:79],v[28:31]
v_mfma_f32_16x16x32_bf16 v[48:51],a[156:159],v[72:75],v[48:51]
v_mfma_f32_16x16x32_bf16 v[64:67],v[72:75],v[156:159],v[64:67]
v_mfma_f32_16x16x32_bf16 v[32:35],a[28:31],v[72:75],v[32:35]
v_mfma_f32_16x16x32_bf16 v[52:55],a[156:159],v[76:79],v[52:55]
v_mfma_f32_16x16x32_bf16 v[68:71],v[76:79],v[156:159],v[68:71]
v_mfma_f32_16x16x32_bf16 v[36:39],a[28:31],v[76:79],v[36:39]
s_waitcnt lgkmcnt(2)
v_mfma_f32_16x16x32_bf16 v[40:43],a[160:163],v[80:83],v[40:43]
ds_read_b128 v[72:75],v10 offset:0
v_mfma_f32_16x16x32_bf16 v[56:59],v[80:83],v[160:163],v[56:59]
v_mfma_f32_16x16x32_bf16 v[24:27],a[32:35],v[80:83],v[24:27]
ds_read_b128 v[76:79],v10 offset:4096
v_mfma_f32_16x16x32_bf16 v[44:47],a[160:163],v[84:87],v[44:47]
v_mfma_f32_16x16x32_bf16 v[60:63],v[84:87],v[160:163],v[60:63]
v_mfma_f32_16x16x32_bf16 v[28:31],a[32:35],v[84:87],v[28:31]
v_mfma_f32_16x16x32_bf16 v[48:51],a[168:171],v[80:83],v[48:51]
v_mfma_f32_16x16x32_bf16 v[64:67],v[80:83],v[168:171],v[64:67]
v_mfma_f32_16x16x32_bf16 v[32:35],a[40:43],v[80:83],v[32:35]
v_mfma_f32_16x16x32_bf16 v[52:55],a[168:171],v[84:87],v[52:55]
v_mfma_f32_16x16x32_bf16 v[68:71],v[84:87],v[168:171],v[68:71]
v_mfma_f32_16x16x32_bf16 v[36:39],a[40:43],v[84:87],v[36:39]
s_waitcnt lgkmcnt(2)
v_mfma_f32_16x16x32_bf16 v[40:43],a[164:167],v[108:111],v[40:43]
ds_read_b128 v[80:83],v11 offset:0
v_mfma_f32_16x16x32_bf16 v[56:59],v[108:111],v[164:167],v[56:59]
v_mfma_f32_16x16x32_bf16 v[24:27],a[36:39],v[108:111],v[24:27]
ds_read_b128 v[84:87],v11 offset:4096
v_mfma_f32_16x16x32_bf16 v[44:47],a[164:167],v[112:115],v[44:47]
v_mfma_f32_16x16x32_bf16 v[60:63],v[112:115],v[164:167],v[60:63]
v_mfma_f32_16x16x32_bf16 v[28:31],a[36:39],v[112:115],v[28:31]
v_mfma_f32_16x16x32_bf16 v[48:51],a[172:175],v[108:111],v[48:51]
v_mfma_f32_16x16x32_bf16 v[64:67],v[108:111],v[172:175],v[64:67]
v_mfma_f32_16x16x32_bf16 v[32:35],a[44:47],v[108:111],v[32:35]
v_mfma_f32_16x16x32_bf16 v[52:55],a[172:175],v[112:115],v[52:55]
v_mfma_f32_16x16x32_bf16 v[68:71],v[112:115],v[172:175],v[68:71]
v_mfma_f32_16x16x32_bf16 v[36:39],a[44:47],v[112:115],v[36:39]
s_waitcnt vmcnt(0)
s_barrier
s_or_b32 s72,s72,s52
buffer_store_dword v17,off,s[8:11],s72 sc1
s_waitcnt lgkmcnt(2)
v_mfma_f32_16x16x32_bf16 v[40:43],a[176:179],v[72:75],v[40:43]
ds_read_b128 v[108:111],v4 offset:16384
v_mfma_f32_16x16x32_bf16 v[56:59],v[72:75],v[176:179],v[56:59]
v_mfma_f32_16x16x32_bf16 v[24:27],a[48:51],v[72:75],v[24:27]
ds_read_b128 v[112:115],v4 offset:20480
v_mfma_f32_16x16x32_bf16 v[44:47],a[176:179],v[76:79],v[44:47]
v_mfma_f32_16x16x32_bf16 v[60:63],v[76:79],v[176:179],v[60:63]
v_mfma_f32_16x16x32_bf16 v[28:31],a[48:51],v[76:79],v[28:31]
v_mfma_f32_16x16x32_bf16 v[48:51],a[184:187],v[72:75],v[48:51]
v_mfma_f32_16x16x32_bf16 v[64:67],v[72:75],v[184:187],v[64:67]
v_mfma_f32_16x16x32_bf16 v[32:35],a[56:59],v[72:75],v[32:35]
v_mfma_f32_16x16x32_bf16 v[52:55],a[184:187],v[76:79],v[52:55]
v_mfma_f32_16x16x32_bf16 v[68:71],v[76:79],v[184:187],v[68:71]
v_mfma_f32_16x16x32_bf16 v[36:39],a[56:59],v[76:79],v[36:39]
s_waitcnt lgkmcnt(2)
v_mfma_f32_16x16x32_bf16 v[40:43],a[180:183],v[80:83],v[40:43]
ds_read_b128 v[72:75],v5 offset:16384
v_mfma_f32_16x16x32_bf16 v[56:59],v[80:83],v[180:183],v[56:59]
v_mfma_f32_16x16x32_bf16 v[24:27],a[52:55],v[80:83],v[24:27]
ds_read_b128 v[76:79],v5 offset:20480
v_mfma_f32_16x16x32_bf16 v[44:47],a[180:183],v[84:87],v[44:47]
v_mfma_f32_16x16x32_bf16 v[60:63],v[84:87],v[180:183],v[60:63]
v_mfma_f32_16x16x32_bf16 v[28:31],a[52:55],v[84:87],v[28:31]
v_mfma_f32_16x16x32_bf16 v[48:51],a[188:191],v[80:83],v[48:51]
v_mfma_f32_16x16x32_bf16 v[64:67],v[80:83],v[188:191],v[64:67]
v_mfma_f32_16x16x32_bf16 v[32:35],a[60:63],v[80:83],v[32:35]
v_mfma_f32_16x16x32_bf16 v[52:55],a[188:191],v[84:87],v[52:55]
v_mfma_f32_16x16x32_bf16 v[68:71],v[84:87],v[188:191],v[68:71]
v_mfma_f32_16x16x32_bf16 v[36:39],a[60:63],v[84:87],v[36:39]
s_waitcnt lgkmcnt(2)
v_mfma_f32_16x16x32_bf16 v[40:43],a[192:195],v[108:111],v[40:43]
ds_read_b128 v[80:83],v6 offset:16384
v_mfma_f32_16x16x32_bf16 v[56:59],v[108:111],v[192:195],v[56:59]
v_mfma_f32_16x16x32_bf16 v[24:27],a[64:67],v[108:111],v[24:27]
ds_read_b128 v[84:87],v6 offset:20480
v_mfma_f32_16x16x32_bf16 v[44:47],a[192:195],v[112:115],v[44:47]
v_mfma_f32_16x16x32_bf16 v[60:63],v[112:115],v[192:195],v[60:63]
v_mfma_f32_16x16x32_bf16 v[28:31],a[64:67],v[112:115],v[28:31]
v_mfma_f32_16x16x32_bf16 v[48:51],a[200:203],v[108:111],v[48:51]
v_mfma_f32_16x16x32_bf16 v[64:67],v[108:111],v[200:203],v[64:67]
v_mfma_f32_16x16x32_bf16 v[32:35],a[72:75],v[108:111],v[32:35]
v_mfma_f32_16x16x32_bf16 v[52:55],a[200:203],v[112:115],v[52:55]
v_mfma_f32_16x16x32_bf16 v[68:71],v[112:115],v[200:203],v[68:71]
v_mfma_f32_16x16x32_bf16 v[36:39],a[72:75],v[112:115],v[36:39]
s_waitcnt lgkmcnt(2)
v_mfma_f32_16x16x32_bf16 v[40:43],a[196:199],v[72:75],v[40:43]
ds_read_b128 v[108:111],v7 offset:16384
v_mfma_f32_16x16x32_bf16 v[56:59],v[72:75],v[196:199],v[56:59]
v_mfma_f32_16x16x32_bf16 v[24:27],a[68:71],v[72:75],v[24:27]
ds_read_b128 v[112:115],v7 offset:20480
v_mfma_f32_16x16x32_bf16 v[44:47],a[196:199],v[76:79],v[44:47]
v_mfma_f32_16x16x32_bf16 v[60:63],v[76:79],v[196:199],v[60:63]
v_mfma_f32_16x16x32_bf16 v[28:31],a[68:71],v[76:79],v[28:31]
v_mfma_f32_16x16x32_bf16 v[48:51],a[204:207],v[72:75],v[48:51]
v_mfma_f32_16x16x32_bf16 v[64:67],v[72:75],v[204:207],v[64:67]
v_mfma_f32_16x16x32_bf16 v[32:35],a[76:79],v[72:75],v[32:35]
v_mfma_f32_16x16x32_bf16 v[52:55],a[204:207],v[76:79],v[52:55]
v_mfma_f32_16x16x32_bf16 v[68:71],v[76:79],v[204:207],v[68:71]
v_mfma_f32_16x16x32_bf16 v[36:39],a[76:79],v[76:79],v[36:39]
s_waitcnt lgkmcnt(2)
v_mfma_f32_16x16x32_bf16 v[40:43],a[208:211],v[80:83],v[40:43]
ds_read_b128 v[72:75],v8 offset:16384
v_mfma_f32_16x16x32_bf16 v[56:59],v[80:83],v[208:211],v[56:59]
v_mfma_f32_16x16x32_bf16 v[24:27],a[80:83],v[80:83],v[24:27]
ds_read_b128 v[76:79],v8 offset:20480
v_mfma_f32_16x16x32_bf16 v[44:47],a[208:211],v[84:87],v[44:47]
v_mfma_f32_16x16x32_bf16 v[60:63],v[84:87],v[208:211],v[60:63]
v_mfma_f32_16x16x32_bf16 v[28:31],a[80:83],v[84:87],v[28:31]
v_mfma_f32_16x16x32_bf16 v[48:51],a[216:219],v[80:83],v[48:51]
v_mfma_f32_16x16x32_bf16 v[64:67],v[80:83],v[216:219],v[64:67]
v_mfma_f32_16x16x32_bf16 v[32:35],a[88:91],v[80:83],v[32:35]
v_mfma_f32_16x16x32_bf16 v[52:55],a[216:219],v[84:87],v[52:55]
v_mfma_f32_16x16x32_bf16 v[68:71],v[84:87],v[216:219],v[68:71]
v_mfma_f32_16x16x32_bf16 v[36:39],a[88:91],v[84:87],v[36:39]
s_waitcnt lgkmcnt(2)
v_mfma_f32_16x16x32_bf16 v[40:43],a[212:215],v[108:111],v[40:43]
ds_read_b128 v[80:83],v9 offset:16384
v_mfma_f32_16x16x32_bf16 v[56:59],v[108:111],v[212:215],v[56:59]
v_mfma_f32_16x16x32_bf16 v[24:27],a[84:87],v[108:111],v[24:27]
ds_read_b128 v[84:87],v9 offset:20480
v_mfma_f32_16x16x32_bf16 v[44:47],a[212:215],v[112:115],v[44:47]
v_mfma_f32_16x16x32_bf16 v[60:63],v[112:115],v[212:215],v[60:63]
v_mfma_f32_16x16x32_bf16 v[28:31],a[84:87],v[112:115],v[28:31]
v_mfma_f32_16x16x32_bf16 v[48:51],a[220:223],v[108:111],v[48:51]
v_mfma_f32_16x16x32_bf16 v[64:67],v[108:111],v[220:223],v[64:67]
v_mfma_f32_16x16x32_bf16 v[32:35],a[92:95],v[108:111],v[32:35]
v_mfma_f32_16x16x32_bf16 v[52:55],a[220:223],v[112:115],v[52:55]
v_mfma_f32_16x16x32_bf16 v[68:71],v[112:115],v[220:223],v[68:71]
v_mfma_f32_16x16x32_bf16 v[36:39],a[92:95],v[112:115],v[36:39]
s_barrier
s_waitcnt lgkmcnt(2)
v_mfma_f32_16x16x32_bf16 v[40:43],a[224:227],v[72:75],v[40:43]
ds_read_b128 v[108:111],v10 offset:16384
v_mfma_f32_16x16x32_bf16 v[56:59],v[72:75],v[224:227],v[56:59]
s_add_u32 m0,s50,131072
v_mfma_f32_16x16x32_bf16 v[24:27],a[96:99],v[72:75],v[24:27]
ds_read_b128 v[112:115],v10 offset:20480
v_mfma_f32_16x16x32_bf16 v[44:47],a[224:227],v[76:79],v[44:47]
buffer_load_dwordx4 v20,s[8:11],s70 offen offset:0 sc1 lds
v_mfma_f32_16x16x32_bf16 v[60:63],v[76:79],v[224:227],v[60:63]
s_add_u32 m0,s50,135168
v_mfma_f32_16x16x32_bf16 v[28:31],a[96:99],v[76:79],v[28:31]
buffer_load_dwordx4 v20,s[8:11],s71 offen offset:0 sc1 lds
v_mfma_f32_16x16x32_bf16 v[48:51],a[232:235],v[72:75],v[48:51]
s_add_u32 m0,s50,139008
v_mfma_f32_16x16x32_bf16 v[64:67],v[72:75],v[232:235],v[64:67]
buffer_load_dwordx4 v20,s[8:11],s70 offen offset:256 sc1 lds
v_mfma_f32_16x16x32_bf16 v[32:35],a[104:107],v[72:75],v[32:35]
s_add_u32 m0,s50,143104
v_mfma_f32_16x16x32_bf16 v[52:55],a[232:235],v[76:79],v[52:55]
buffer_load_dwordx4 v20,s[8:11],s71 offen offset:256 sc1 lds
v_mfma_f32_16x16x32_bf16 v[68:71],v[76:79],v[232:235],v[68:71]
v_mfma_f32_16x16x32_bf16 v[36:39],a[104:107],v[76:79],v[36:39]
s_waitcnt lgkmcnt(2)
v_mfma_f32_16x16x32_bf16 v[40:43],a[228:231],v[80:83],v[40:43]
ds_read_b128 v[72:75],v11 offset:16384
v_mfma_f32_16x16x32_bf16 v[56:59],v[80:83],v[228:231],v[56:59]
v_mfma_f32_16x16x32_bf16 v[24:27],a[100:103],v[80:83],v[24:27]
ds_read_b128 v[76:79],v11 offset:20480
v_mfma_f32_16x16x32_bf16 v[44:47],a[228:231],v[84:87],v[44:47]
v_mfma_f32_16x16x32_bf16 v[60:63],v[84:87],v[228:231],v[60:63]
v_mfma_f32_16x16x32_bf16 v[28:31],a[100:103],v[84:87],v[28:31]
v_mfma_f32_16x16x32_bf16 v[48:51],a[236:239],v[80:83],v[48:51]
v_mfma_f32_16x16x32_bf16 v[64:67],v[80:83],v[236:239],v[64:67]
v_mfma_f32_16x16x32_bf16 v[32:35],a[108:111],v[80:83],v[32:35]
v_mfma_f32_16x16x32_bf16 v[52:55],a[236:239],v[84:87],v[52:55]
v_mfma_f32_16x16x32_bf16 v[68:71],v[84:87],v[236:239],v[68:71]
v_mfma_f32_16x16x32_bf16 v[36:39],a[108:111],v[84:87],v[36:39]
s_waitcnt lgkmcnt(2)
v_mfma_f32_16x16x32_bf16 v[40:43],a[240:243],v[108:111],v[40:43]
v_mfma_f32_16x16x32_bf16 v[56:59],v[108:111],v[240:243],v[56:59]
v_mfma_f32_16x16x32_bf16 v[24:27],a[112:115],v[108:111],v[24:27]
v_mfma_f32_16x16x32_bf16 v[44:47],a[240:243],v[112:115],v[44:47]
v_mfma_f32_16x16x32_bf16 v[60:63],v[112:115],v[240:243],v[60:63]
v_mfma_f32_16x16x32_bf16 v[28:31],a[112:115],v[112:115],v[28:31]
v_mfma_f32_16x16x32_bf16 v[48:51],a[248:251],v[108:111],v[48:51]
v_mfma_f32_16x16x32_bf16 v[64:67],v[108:111],v[248:251],v[64:67]
v_mfma_f32_16x16x32_bf16 v[32:35],a[120:123],v[108:111],v[32:35]
v_mfma_f32_16x16x32_bf16 v[52:55],a[248:251],v[112:115],v[52:55]
v_mfma_f32_16x16x32_bf16 v[68:71],v[112:115],v[248:251],v[68:71]
v_mfma_f32_16x16x32_bf16 v[36:39],a[120:123],v[112:115],v[36:39]
s_waitcnt lgkmcnt(0)
v_mfma_f32_16x16x32_bf16 v[40:43],a[244:247],v[72:75],v[40:43]
v_mfma_f32_16x16x32_bf16 v[56:59],v[72:75],v[244:247],v[56:59]
v_mfma_f32_16x16x32_bf16 v[24:27],a[116:119],v[72:75],v[24:27]
v_mfma_f32_16x16x32_bf16 v[44:47],a[244:247],v[76:79],v[44:47]
v_mfma_f32_16x16x32_bf16 v[60:63],v[76:79],v[244:247],v[60:63]
v_mfma_f32_16x16x32_bf16 v[28:31],a[116:119],v[76:79],v[28:31]
v_mfma_f32_16x16x32_bf16 v[48:51],a[252:255],v[72:75],v[48:51]
v_mfma_f32_16x16x32_bf16 v[64:67],v[72:75],v[252:255],v[64:67]
v_mfma_f32_16x16x32_bf16 v[32:35],a[124:127],v[72:75],v[32:35]
v_mfma_f32_16x16x32_bf16 v[52:55],a[252:255],v[76:79],v[52:55]
v_mfma_f32_16x16x32_bf16 v[68:71],v[76:79],v[252:255],v[68:71]
v_mfma_f32_16x16x32_bf16 v[36:39],a[124:127],v[76:79],v[36:39]
s_lshl_b32 s56,s51,5
s_add_u32 s56,s56,s47
s_lshl_b32 s56,s56,12
s_add_u32 s56,s56,s50
s_add_u32 s56,s56,41943040
v_mov_b64 v[120:121],-1
v_mov_b64 v[122:123],-1
buffer_store_dwordx4 v[120:123],v0,s[8:11],s56 offen sc1
v_cvt_pk_bf16_f32 v72,v40,v48
v_cvt_pk_bf16_f32 v73,v41,v49
v_cvt_pk_bf16_f32 v74,v42,v50
v_cvt_pk_bf16_f32 v75,v43,v51
buffer_store_dwordx4 v[72:75],v0,s[8:11],s61 offen sc1
v_cvt_pk_bf16_f32 v76,v44,v52
v_cvt_pk_bf16_f32 v77,v45,v53
v_cvt_pk_bf16_f32 v78,v46,v54
v_cvt_pk_bf16_f32 v79,v47,v55
buffer_store_dwordx4 v[76:79],v0,s[8:11],s62 offen sc1
v_cvt_pk_bf16_f32 v80,v56,v57
v_cvt_pk_bf16_f32 v81,v58,v59
v_cvt_pk_bf16_f32 v82,v60,v61
v_cvt_pk_bf16_f32 v83,v62,v63
buffer_store_dwordx4 v[80:83],v0,s[8:11],s65 offen offset:0 sc1
v_cvt_pk_bf16_f32 v84,v64,v65
v_cvt_pk_bf16_f32 v85,v66,v67
v_cvt_pk_bf16_f32 v86,v68,v69
v_cvt_pk_bf16_f32 v87,v70,v71
buffer_store_dwordx4 v[84:87],v0,s[8:11],s65 offen offset:1024 sc1
v_cvt_pk_bf16_f32 v108,v24,v32
v_cvt_pk_bf16_f32 v109,v25,v33
v_cvt_pk_bf16_f32 v110,v26,v34
v_cvt_pk_bf16_f32 v111,v27,v35
buffer_store_dwordx4 v[108:111],v0,s[8:11],s63 offen sc1
v_cvt_pk_bf16_f32 v112,v28,v36
v_cvt_pk_bf16_f32 v113,v29,v37
v_cvt_pk_bf16_f32 v114,v30,v38
v_cvt_pk_bf16_f32 v115,v31,v39
buffer_store_dwordx4 v[112:115],v0,s[8:11],s64 offen sc1
s_lshl_b32 s72,s51,13
s_lshl2_add_u32 s72,s47,s72
s_add_u32 s72,s72,10485760
s_add_u32 s51,s51,1
s_sub_u32 s53,s53,1
s_cmp_gt_u32 s53,0
s_cbranch_scc1 L_chl_155
s_waitcnt vmcnt(0)
s_barrier
s_or_b32 s72,s72,s52
buffer_store_dword v17,off,s[8:11],s72 sc1
L_chd_154:
s_cmp_lg_u32 s3,0
s_cbranch_scc1 L_wc
s_cmp_eq_u32 s48,1
s_cbranch_scc1 L_rc1_156
s_cmp_eq_u32 s48,2
s_cbranch_scc1 L_rc2_157
v_and_b32 v120,15,v1
v_lshrrev_b32 v121,4,v1
v_and_b32 v122,2,v1
v_cmp_eq_u32 vcc,0,v122
v_mov_b32 v2,0xeeee
v_mov_b32 v123,0x4444
v_cndmask_b32 v2,v2,v123,vcc
v_and_b32 v122,1,v1
v_cmp_eq_u32 vcc,0,v122
v_mov_b32 v3,0xdddd
v_mov_b32 v123,0x8888
v_cndmask_b32 v3,v3,v123,vcc
v_lshrrev_b32 v122,1,v120
v_bfe_u32 v123,v120,2,1
v_xor_b32 v123,v123,v122
v_lshlrev_b32 v4,7,v123
v_and_b32 v123,1,v120
v_lshl_add_u32 v4,v123,6,v4
v_xor_b32 v123,v121,v122
v_and_b32 v123,3,v123
v_lshl_add_u32 v4,v123,4,v4
s_lshl_b32 s56,s46,10
s_add_u32 s56,s56,147456
v_add_u32 v4,s56,v4
v_lshlrev_b32 v122,1,v121
v_add_u32 v122,0,v122
v_and_b32 v123,1,v121
v_xor_b32 v123,v123,v122
v_lshlrev_b32 v5,7,v123
v_bfe_u32 v123,v120,3,1
v_lshl_add_u32 v5,v123,6,v5
v_xor_b32 v123,v120,v122
v_and_b32 v123,3,v123
v_lshl_add_u32 v5,v123,4,v5
v_bfe_u32 v123,v120,2,1
v_lshl_add_u32 v5,v123,3,v5
v_add_u32 v5,147456,v5
v_lshlrev_b32 v122,1,v121
v_add_u32 v122,1,v122
v_and_b32 v123,1,v121
v_xor_b32 v123,v123,v122
v_lshlrev_b32 v6,7,v123
v_bfe_u32 v123,v120,3,1
v_lshl_add_u32 v6,v123,6,v6
v_xor_b32 v123,v120,v122
v_and_b32 v123,3,v123
v_lshl_add_u32 v6,v123,4,v6
v_bfe_u32 v123,v120,2,1
v_lshl_add_u32 v6,v123,3,v6
v_add_u32 v6,147456,v6
v_lshlrev_b32 v7,7,v121
v_lshrrev_b32 v122,1,v120
v_lshl_add_u32 v8,v122,4,v7
v_add_u32 v8,151552,v8
v_lshrrev_b32 v122,2,v120
v_lshl_add_u32 v7,v122,5,v7
v_and_b32 v122,1,v120
v_lshl_add_u32 v7,v122,4,v7
v_and_b32 v122,2,v120
v_cmp_eq_u32 vcc,0,v122
s_lshl_b32 s56,s46,9
v_mov_b32 v122,2048
v_mov_b32 v123,s56
v_cndmask_b32 v122,v122,v123,vcc
v_add_u32 v7,v122,v7
v_add_u32 v7,151552,v7
v_lshrrev_b32 v122,3,v1
v_lshlrev_b32 v9,11,v122
v_and_b32 v122,7,v1
v_lshl_add_u32 v9,v122,3,v9
s_lshl_b32 s56,s46,14
s_lshl_b32 s57,s47,6
s_add_u32 s56,s56,s57
v_add_u32 v9,s56,v9
s_lshl_b32 s71,s46,5
s_add_u32 s71,s71,s47
s_bfe_u32 s56,s71,0x10003
s_lshl_b32 s56,s56,11
s_and_b32 s57,s71,1
s_lshl_b32 s57,s57,10
s_add_u32 s56,s56,s57
s_bfe_u32 s57,s71,0x10002
s_lshl_b32 s57,s57,9
s_add_u32 s56,s56,s57
s_bfe_u32 s57,s71,0x10001
s_lshl_b32 s57,s57,6
s_add_u32 s56,s56,s57
s_bfe_u32 s57,s71,0x10004
s_lshl_b32 s57,s57,8
s_add_u32 s56,s56,s57
s_bfe_u32 s57,s71,0x10005
s_lshl_b32 s57,s57,7
s_add_u32 s56,s56,s57
s_bfe_u32 s57,s71,0x10006
s_lshl_b32 s57,s57,12
s_add_u32 s56,s56,s57
v_and_b32 v122,3,v120
v_lshlrev_b32 v10,2,v122
v_bfe_u32 v122,v120,3,1
v_lshl_add_u32 v10,v122,4,v10
v_and_b32 v122,1,v121
v_lshl_add_u32 v10,v122,5,v10
v_add_u32 v10,s56,v10
v_and_b32 v123,36,v1
v_mov_b32 v122,0x80000000
v_cmp_eq_u32 vcc,0,v123
s_nop 1
v_cndmask_b32 v10,v122,v10,vcc
s_lshl_b32 s71,s71,11
s_lshl_b32 s73,s46,11
s_mov_b32 s72,0xffc00000
s_mov_b32 s74,0
v_and_b32 v11,1,v121
v_xor_b32 v11,v11,v120
v_and_b32 v11,3,v11
v_lshrrev_b32 v122,2,v120
v_lshl_add_u32 v11,v11,2,v122
v_lshl_add_u32 v11,v121,4,v11
v_lshlrev_b32 v11,4,v11
s_lshl_b32 s56,s46,15
v_add_u32 v11,s56,v11
v_lshrrev_b32 v13,3,v1
v_lshlrev_b32 v13,9,v13
v_and_b32 v122,7,v1
v_lshl_add_u32 v13,v122,4,v13
v_and_b32 v122,15,v1
v_and_b32 v123,1,v1
v_lshlrev_b32 v123,4,v123
v_mov_b32 v124,0x3f80
v_lshlrev_b32 v124,v123,v124
v_lshrrev_b32 v122,1,v122
v_cmp_eq_u32 vcc,0,v122
s_nop 1
v_cndmask_b32 v18,0,v124,vcc
v_cmp_eq_u32 vcc,1,v122
s_nop 1
v_cndmask_b32 v19,0,v124,vcc
v_cmp_eq_u32 vcc,2,v122
s_nop 1
v_cndmask_b32 v20,0,v124,vcc
v_cmp_eq_u32 vcc,3,v122
s_nop 1
v_cndmask_b32 v21,0,v124,vcc
s_and_b32 s56,s46,1
s_lshl_b32 s56,s56,8
s_and_b32 s57,s46,2
s_lshl_b32 s57,s57,6
s_add_u32 s56,s56,s57
v_add_u32 v13,s56,v13
s_add_u32 s56,s50,155648
v_add_u32 v12,s56,v0
v_mov_b64 v[14:15],s[28:29]
v_mov_b64 v[16:17],s[28:29]
v_add_u32 v22,11550720,v10
s_lshl_b32 s18,s47,2
s_add_u32 s18,s18,10493952
v_mov_b32 v1,s80
s_mov_b32 s65,14680064
s_add_u32 s66,s71,14680064
s_add_u32 s69,s71,14942208
s_mov_b32 s30,0x40000000
s_mov_b32 s51,0
buffer_load_dwordx4 v[88:91],v0,s[8:11],s66 offen offset:0
buffer_load_dwordx4 v[88:91],v0,s[8:11],s66 offen offset:1024
buffer_load_dwordx4 v[88:91],v0,s[8:11],s69 offen offset:0
buffer_load_dwordx4 v[88:91],v0,s[8:11],s69 offen offset:1024
L_cst_161:
s_cmp_lg_u32 s46,0
s_cbranch_scc1 L_csw_166
s_lshl_b32 s59,s51,13
s_lshl2_add_u32 s59,s47,s59
s_add_u32 s59,s59,10485760
s_buffer_load_dword s61,s[8:11],s59
s_waitcnt lgkmcnt(0)
s_cmp_lg_u32 s61,0
s_cbranch_scc1 L_wwd_168
L_ww_167:
s_sleep 1
buffer_load_dword v122,off,s[8:11],s59 sc1
s_sub_u32 s49,s49,1
s_cbranch_scc1 L_abort
s_waitcnt vmcnt(0)
v_readfirstlane_b32 s61,v122
s_cmp_eq_u32 s61,0
s_cbranch_scc1 L_ww_167
L_wwd_168:
L_csw_166:
s_waitcnt lgkmcnt(0)
s_barrier
s_lshl_b32 s56,s51,5
s_add_u32 s56,s56,s47
s_mul_i32 s56,s56,24576
s_add_u32 s56,s56,100663296
s_add_u32 s67,s56,s73
s_add_u32 m0,s73,131072
s_add_u32 s57,s67,8192
buffer_load_dwordx4 v0,s[8:11],s67 offen sc1 lds
buffer_load_dwordx4 v0,s[8:11],s67 offen offset:1024 sc1 lds
s_add_u32 m0,s73,139264
s_add_u32 s67,s67,786432
buffer_load_dwordx4 v0,s[8:11],s57 offen sc1 lds
buffer_load_dwordx4 v0,s[8:11],s57 offen offset:1024 sc1 lds
s_lshl_b32 s75,s51,13
s_add_u32 s56,s75,11542528
buffer_load_dword v23,v10,s[8:11],s56 offen sc1
s_add_u32 s64,s75,11534336
s_add_u32 s70,s64,4096
s_lshl_b32 s68,s51,5
s_add_u32 s68,s68,s47
s_lshl_b32 s68,s68,12
s_lshl_b32 s56,s46,10
s_add_u32 s68,s68,s56
s_add_u32 s68,s68,41943040
s_mov_b32 s54,0x80000000
s_mov_b32 s77,0
s_add_u32 s56,s18,s75
s_buffer_load_dword s19,s[8:11],s56
s_cmp_eq_u32 s51,63
s_cselect_b32 s76,1,s46
s_cmp_eq_u32 s76,0
s_cselect_b32 s76,1,0
v_mov_b64 v[96:97],0
v_mov_b64 v[98:99],0
v_mov_b64 v[100:101],0
v_mov_b64 v[102:103],0
v_mov_b64 v[104:105],0
v_mov_b64 v[106:107],0
v_mov_b64 v[108:109],0
v_mov_b64 v[110:111],0
v_mov_b64 v[112:113],0
v_mov_b64 v[114:115],0
v_mov_b64 v[116:117],0
v_mov_b64 v[118:119],0
buffer_load_dwordx4 v[88:91],v13,s[8:11],s64 offen
buffer_load_dwordx4 v[88:91],v13,s[8:11],s70 offen
s_waitcnt vmcnt(19)
v_swap_b32 v25,v28
v_swap_b32 v26,v32
v_swap_b32 v27,v36
v_swap_b32 v30,v33
v_swap_b32 v31,v37
v_swap_b32 v35,v38
ds_write_b128 v93,v[24:27] offset:4096
ds_write_b128 v94,v[28:31] offset:4096
ds_write_b128 v93,v[32:35] offset:4224
ds_write_b128 v94,v[36:39] offset:4224
s_waitcnt vmcnt(15)
v_swap_b32 v41,v44
v_swap_b32 v42,v48
v_swap_b32 v43,v52
v_swap_b32 v46,v49
v_swap_b32 v47,v53
v_swap_b32 v51,v54
ds_write_b128 v93,v[40:43] offset:5120
ds_write_b128 v94,v[44:47] offset:5120
ds_write_b128 v93,v[48:51] offset:5248
ds_write_b128 v94,v[52:55] offset:5248
s_waitcnt vmcnt(11)
v_swap_b32 v57,v60
v_swap_b32 v58,v64
v_swap_b32 v59,v68
v_swap_b32 v62,v65
v_swap_b32 v63,v69
v_swap_b32 v67,v70
ds_write_b128 v93,v[56:59] offset:6144
ds_write_b128 v94,v[60:63] offset:6144
ds_write_b128 v93,v[64:67] offset:6272
ds_write_b128 v94,v[68:71] offset:6272
s_waitcnt vmcnt(7)
v_swap_b32 v73,v76
v_swap_b32 v74,v80
v_swap_b32 v75,v84
v_swap_b32 v78,v81
v_swap_b32 v79,v85
v_swap_b32 v83,v86
ds_write_b128 v93,v[72:75] offset:7168
ds_write_b128 v94,v[76:79] offset:7168
ds_write_b128 v93,v[80:83] offset:7296
ds_write_b128 v94,v[84:87] offset:7296
s_waitcnt vmcnt(0) lgkmcnt(0)
s_barrier
v_add_u32 v55,131072,v0
ds_read_b128 v[56:59],v55 offset:0
ds_read_b128 v[60:63],v55 offset:4096
ds_read_b128 v[64:67],v55 offset:1024
ds_read_b128 v[68:71],v55 offset:5120
ds_read_b128 v[72:75],v55 offset:2048
ds_read_b128 v[76:79],v55 offset:6144
ds_read_b128 v[80:83],v55 offset:3072
ds_read_b128 v[84:87],v55 offset:7168
v_add_u32 v123,s73,v55
ds_read_b128 v[88:91],v123 offset:8192
ds_read_b128 v[92:95],v123 offset:9216
v_xor_b32 v120,1024,v12
v_xor_b32 v121,2048,v12
v_xor_b32 v122,3072,v12
buffer_load_dwordx4 v[24:27],v13,s[8:11],s64 offen sc1
buffer_load_dwordx4 v[24:27],v13,s[8:11],s64 offen sc1
L_chain_169:
L_cpa_170:
buffer_load_dwordx4 v[24:27],v13,s[8:11],s64 offen sc1
s_sub_u32 s49,s49,1
s_cbranch_scc1 L_abort
s_waitcnt vmcnt(2)
v_max3_u32 v123,v24,v25,v26
v_max_u32 v123,v27,v123
v_cmp_le_u32 vcc,s72,v123
ds_write_b128 v12,v[24:27] offset:0
s_cbranch_vccnz L_cpa_170
L_cgo_173:
v_smfmac_f32_16x16x64_bf16 v[96:99],v[24:27],a[0:7],v2
buffer_load_dwordx4 v[40:43],v13,s[8:11],s70 offen sc1
v_smfmac_f32_16x16x64_bf16 v[100:103],v[24:27],a[128:135],v2
s_waitcnt lgkmcnt(0)
s_barrier
ds_read_b128 v[28:31],v120 offset:0
v_smfmac_f32_16x16x64_bf16 v[104:107],v[24:27],a[8:15],v2
ds_read_b128 v[32:35],v121 offset:0
v_smfmac_f32_16x16x64_bf16 v[108:111],v[24:27],a[136:143],v2
ds_read_b128 v[36:39],v122 offset:0
v_smfmac_f32_16x16x64_bf16 v[112:115],v[24:27],v[128:135],v2
v_smfmac_f32_16x16x64_bf16 v[116:119],v[24:27],v[136:143],v2
s_waitcnt lgkmcnt(2)
v_smfmac_f32_16x16x64_bf16 v[96:99],v[28:31],a[16:23],v2
s_add_u32 m0,s73,131072
v_smfmac_f32_16x16x64_bf16 v[100:103],v[28:31],a[144:151],v2
s_add_u32 s57,s67,8192
v_smfmac_f32_16x16x64_bf16 v[104:107],v[28:31],a[24:31],v2
s_cmp_lt_u32 s19,s76
s_cbranch_scc1 L_ckw_162
L_ckb_163:
v_smfmac_f32_16x16x64_bf16 v[108:111],v[28:31],a[152:159],v2
s_waitcnt vmcnt(0) lgkmcnt(1)
v_smfmac_f32_16x16x64_bf16 v[96:99],v[32:35],a[32:39],v2
ds_write_b128 v12,v[40:43] offset:4096
v_max3_u32 v123,v40,v41,v42
v_smfmac_f32_16x16x64_bf16 v[100:103],v[32:35],a[160:167],v2
v_max_u32 v123,v43,v123
v_smfmac_f32_16x16x64_bf16 v[104:107],v[32:35],a[40:47],v2
v_cmp_le_u32 vcc,s72,v123
v_smfmac_f32_16x16x64_bf16 v[108:111],v[32:35],a[168:175],v2
v_smfmac_f32_16x16x64_bf16 v[112:115],v[28:31],v[144:151],v2
s_cbranch_vccnz L_cpb_176
L_cback_178:
s_waitcnt lgkmcnt(0)
s_barrier
v_smfmac_f32_16x16x64_bf16 v[96:99],v[36:39],a[48:55],v2
buffer_store_dwordx4 v[124:127],v0,s[8:11],s54 offen sc1
v_smfmac_f32_16x16x64_bf16 v[100:103],v[36:39],a[176:183],v2
ds_read_b128 v[44:47],v120 offset:4096
v_smfmac_f32_16x16x64_bf16 v[104:107],v[36:39],a[56:63],v2
buffer_load_dwordx4 v0,s[8:11],s67 offen sc1 lds
v_smfmac_f32_16x16x64_bf16 v[108:111],v[36:39],a[184:191],v2
ds_read_b128 v[48:51],v121 offset:4096
v_smfmac_f32_16x16x64_bf16 v[96:99],v[40:43],a[64:71],v2
buffer_load_dwordx4 v0,s[8:11],s67 offen offset:1024 sc1 lds
s_add_u32 m0,s73,139264
v_smfmac_f32_16x16x64_bf16 v[100:103],v[40:43],a[192:199],v2
ds_read_b128 v[52:55],v122 offset:4096
v_smfmac_f32_16x16x64_bf16 v[104:107],v[40:43],a[72:79],v2
buffer_load_dwordx4 v0,s[8:11],s57 offen sc1 lds
s_add_u32 s67,s67,786432
v_smfmac_f32_16x16x64_bf16 v[108:111],v[40:43],a[200:207],v2
s_waitcnt lgkmcnt(2)
v_smfmac_f32_16x16x64_bf16 v[96:99],v[44:47],a[80:87],v2
buffer_load_dwordx4 v0,s[8:11],s57 offen offset:1024 sc1 lds
v_smfmac_f32_16x16x64_bf16 v[100:103],v[44:47],a[208:215],v2
s_waitcnt lgkmcnt(1)
v_smfmac_f32_16x16x64_bf16 v[96:99],v[48:51],a[96:103],v2
buffer_load_dword v23,v22,s[8:11],s75 offen sc1
v_smfmac_f32_16x16x64_bf16 v[100:103],v[48:51],a[224:231],v2
s_waitcnt lgkmcnt(0)
v_smfmac_f32_16x16x64_bf16 v[96:99],v[52:55],a[112:119],v2
v_smfmac_f32_16x16x64_bf16 v[100:103],v[52:55],a[240:247],v2
v_smfmac_f32_16x16x64_bf16 v[104:107],v[44:47],a[88:95],v2
v_smfmac_f32_16x16x64_bf16 v[108:111],v[44:47],a[216:223],v2
v_smfmac_f32_16x16x64_bf16 v[104:107],v[48:51],a[104:111],v2
v_add_f32 v96,v96,v98
v_smfmac_f32_16x16x64_bf16 v[108:111],v[48:51],a[232:239],v2
v_add_f32 v97,v97,v99
v_smfmac_f32_16x16x64_bf16 v[104:107],v[52:55],a[120:127],v2
v_cvt_pk_bf16_f32 v120,v96,v97
v_smfmac_f32_16x16x64_bf16 v[108:111],v[52:55],a[248:255],v2
v_add_f32 v100,v100,v102
v_smfmac_f32_16x16x64_bf16 v[116:119],v[28:31],v[152:159],v2
v_add_f32 v101,v101,v103
v_smfmac_f32_16x16x64_bf16 v[112:115],v[32:35],v[160:167],v2
v_cvt_pk_bf16_f32 v121,v100,v101
v_add_f32 v104,v104,v106
v_add_f32 v105,v105,v107
v_cvt_pk_bf16_f32 v122,v104,v105
v_add_f32 v108,v108,v110
v_add_f32 v109,v109,v111
v_cvt_pk_bf16_f32 v123,v108,v109
ds_write_b128 v4,v[120:123]
v_smfmac_f32_16x16x64_bf16 v[116:119],v[32:35],v[168:175],v2
s_mov_b32 s54,s68
s_add_u32 s68,s68,131072
v_mov_b32 v125,0
v_smfmac_f32_16x16x64_bf16 v[112:115],v[36:39],v[176:183],v2
s_cmp_eq_u32 s51,63
s_cbranch_scc1 L_cend_172
v_smfmac_f32_16x16x64_bf16 v[116:119],v[36:39],v[184:191],v2
v_smfmac_f32_16x16x64_bf16 v[112:115],v[40:43],v[192:199],v2
s_waitcnt lgkmcnt(0)
s_barrier
ds_read_b64_tr_b16 v[96:97],v5 offset:0
ds_read_b64_tr_b16 v[98:99],v6 offset:0
v_smfmac_f32_16x16x64_bf16 v[116:119],v[40:43],v[200:207],v2
ds_read_b64_tr_b16 v[100:101],v5 offset:1024
v_smfmac_f32_16x16x64_bf16 v[112:115],v[44:47],v[208:215],v2
ds_read_b64_tr_b16 v[102:103],v6 offset:1024
v_smfmac_f32_16x16x64_bf16 v[116:119],v[44:47],v[216:223],v2
ds_read_b64_tr_b16 v[104:105],v5 offset:2048
v_smfmac_f32_16x16x64_bf16 v[112:115],v[48:51],v[224:231],v2
ds_read_b64_tr_b16 v[106:107],v6 offset:2048
s_waitcnt lgkmcnt(4)
v_mfma_f32_16x16x32_bf16 v[24:27],v[56:59],v[96:99],0
ds_read_b64_tr_b16 v[108:109],v5 offset:3072
v_mfma_f32_16x16x32_bf16 v[28:31],v[60:63],v[96:99],0
ds_read_b64_tr_b16 v[110:111],v6 offset:3072
v_mfma_f32_16x16x32_bf16 v[32:35],v[96:99],v[96:99],0
ds_read_b128 v[40:43],v11 offset:12288
s_waitcnt lgkmcnt(5)
v_mfma_f32_16x16x32_bf16 v[24:27],v[64:67],v[100:103],v[24:27]
ds_read_b128 v[56:59],v11 offset:0
v_mfma_f32_16x16x32_bf16 v[28:31],v[68:71],v[100:103],v[28:31]
ds_read_b128 v[60:63],v11 offset:1024
v_mfma_f32_16x16x32_bf16 v[32:35],v[100:103],v[100:103],v[32:35]
ds_read_b128 v[96:99],v11 offset:8192
s_waitcnt lgkmcnt(6)
v_mfma_f32_16x16x32_bf16 v[24:27],v[72:75],v[104:107],v[24:27]
ds_read_b128 v[64:67],v11 offset:2048
v_mfma_f32_16x16x32_bf16 v[28:31],v[76:79],v[104:107],v[28:31]
ds_read_b128 v[68:71],v11 offset:3072
v_mfma_f32_16x16x32_bf16 v[32:35],v[104:107],v[104:107],v[32:35]
ds_read_b128 v[100:103],v11 offset:9216
s_waitcnt lgkmcnt(7)
v_mfma_f32_16x16x32_bf16 v[24:27],v[80:83],v[108:111],v[24:27]
ds_read_b128 v[72:75],v11 offset:4096
v_mfma_f32_16x16x32_bf16 v[28:31],v[84:87],v[108:111],v[28:31]
ds_read_b128 v[76:79],v11 offset:5120
v_mfma_f32_16x16x32_bf16 v[32:35],v[108:111],v[108:111],v[32:35]
ds_read_b128 v[104:107],v11 offset:10240
v_smfmac_f32_16x16x64_bf16 v[116:119],v[48:51],v[232:239],v2
ds_read_b128 v[80:83],v11 offset:6144
v_smfmac_f32_16x16x64_bf16 v[112:115],v[52:55],v[240:247],v2
ds_read_b128 v[84:87],v11 offset:7168
v_smfmac_f32_16x16x64_bf16 v[116:119],v[52:55],v[248:255],v2
ds_read_b128 v[108:111],v11 offset:11264
v_max3_f32 v126,v24,v25,v26
v_max3_f32 v127,v27,v28,v29
v_max3_f32 v126,v30,v31,v126
v_max3_f32 v127,v34,v35,v127
v_max_f32 v126,v126,v127
v_max_f32 v127,v126,v127
v_pk_mul_f32 v[34:35],v[34:35],v[0:1] op_sel:[0,1]
v_pk_mul_f32 v[24:25],v[24:25],v[0:1] op_sel:[0,1]
v_permlane16_swap_b32 v126,v127
v_max_f32 v126,v126,v127
v_max_f32 v127,v126,v127
v_pk_mul_f32 v[26:27],v[26:27],v[0:1] op_sel:[0,1]
v_pk_mul_f32 v[28:29],v[28:29],v[0:1] op_sel:[0,1]
v_permlane32_swap_b32 v126,v127
v_max_f32 v126,v126,v127
v_mul_f32 v126,v1,v126
v_pk_mul_f32 v[30:31],v[30:31],v[0:1] op_sel:[0,1]
v_pk_add_f32 v[34:35],v[34:35],v[126:127] op_sel_hi:[1,0] neg_lo:[0,1] neg_hi:[0,1]
v_pk_add_f32 v[112:113],v[112:113],v[114:115]
v_pk_add_f32 v[116:117],v[116:117],v[118:119]
v_pk_add_f32 v[24:25],v[24:25],v[126:127] op_sel_hi:[1,0] neg_lo:[0,1] neg_hi:[0,1]
v_pk_add_f32 v[26:27],v[26:27],v[126:127] op_sel_hi:[1,0] neg_lo:[0,1] neg_hi:[0,1]
v_pk_add_f32 v[28:29],v[28:29],v[126:127] op_sel_hi:[1,0] neg_lo:[0,1] neg_hi:[0,1]
v_pk_add_f32 v[30:31],v[30:31],v[126:127] op_sel_hi:[1,0] neg_lo:[0,1] neg_hi:[0,1]
v_exp_f32 v34,v34
v_exp_f32 v35,v35
v_cvt_pk_bf16_f32 v126,v112,v113
v_cvt_pk_bf16_f32 v124,v34,v35
v_cvt_pk_bf16_f32 v127,v116,v117
v_cvt_pk_bf16_f32 v36,v116,v117
v_mfma_f32_16x16x16_bf16 v[32:35],v[14:15],v[124:125],0
ds_read_b128 v[44:47],v11 offset:13312
v_exp_f32 v24,v24
v_mfma_f32_16x16x16_bf16 v[112:115],v[126:127],v[124:125],0
ds_read_b128 v[48:51],v11 offset:14336
v_exp_f32 v25,v25
v_mfma_f32_16x16x16_bf16 v[116:119],v[36:37],v[124:125],0
ds_read_b128 v[52:55],v11 offset:15360
v_exp_f32 v26,v26
v_exp_f32 v27,v27
v_cvt_pk_bf16_f32 v120,v24,v25
v_exp_f32 v28,v28
v_exp_f32 v29,v29
v_cvt_pk_bf16_f32 v121,v26,v27
v_exp_f32 v30,v30
v_exp_f32 v31,v31
v_cvt_pk_bf16_f32 v122,v28,v29
v_cvt_pk_bf16_f32 v123,v30,v31
s_add_u32 s75,s75,8192
s_add_u32 s51,s51,1
v_mfma_f32_16x16x32_bf16 v[32:35],v[14:17],v[120:123],v[32:35]
v_mfma_f32_16x16x32_bf16 v[112:115],v[88:91],v[120:123],v[112:115]
ds_read_b128 v[88:91],v11 offset:16384
v_mfma_f32_16x16x32_bf16 v[116:119],v[92:95],v[120:123],v[116:119]
ds_read_b128 v[92:95],v11 offset:17408
v_rcp_f32 v32,v32
v_mov_b64 v[24:25],-1
v_mov_b64 v[26:27],-1
s_add_u32 s64,s75,11534336
s_add_u32 s70,s64,4096
v_pk_mul_f32 v[112:113],v[112:113],v[32:33] op_sel_hi:[1,0]
v_pk_mul_f32 v[114:115],v[114:115],v[32:33] op_sel_hi:[1,0]
v_pk_mul_f32 v[116:117],v[116:117],v[32:33] op_sel_hi:[1,0]
v_pk_mul_f32 v[118:119],v[118:119],v[32:33] op_sel_hi:[1,0]
v_cvt_pk_bf16_f32 v120,v112,v116
v_cvt_pk_bf16_f32 v121,v113,v117
v_cvt_pk_bf16_f32 v122,v114,v118
v_cvt_pk_bf16_f32 v123,v115,v119
ds_write_b128 v7,v[120:123]
buffer_store_dwordx4 v[24:27],v0,s[8:11],s69 offen
buffer_store_dwordx4 v[24:27],v0,s[8:11],s69 offen offset:1024
v_mov_b64 v[112:113],0
v_mov_b64 v[114:115],0
v_mov_b64 v[116:117],0
v_mov_b64 v[118:119],0
s_waitcnt lgkmcnt(0)
s_barrier
ds_read_b128 v[24:27],v8 offset:0
ds_read_b128 v[28:31],v8 offset:512
ds_read_b128 v[32:35],v8 offset:1024
ds_read_b128 v[36:39],v8 offset:1536
v_mov_b64 v[120:121],0
v_mov_b64 v[122:123],0
s_add_u32 s57,s65,65536
s_add_u32 s58,s65,131072
s_add_u32 s59,s65,196608
s_add_u32 s56,s18,s75
s_waitcnt lgkmcnt(3)
v_smfmac_f32_16x16x64_bf16 v[112:115],v[24:27],v[56:63],v3
ds_read_b128 v[56:59],v11 offset:18432
s_waitcnt lgkmcnt(3)
v_smfmac_f32_16x16x64_bf16 v[112:115],v[28:31],v[64:71],v3
ds_read_b128 v[60:63],v11 offset:19456
s_waitcnt lgkmcnt(3)
v_smfmac_f32_16x16x64_bf16 v[112:115],v[32:35],v[72:79],v3
ds_read_b128 v[64:67],v11 offset:20480
s_waitcnt lgkmcnt(3)
v_smfmac_f32_16x16x64_bf16 v[112:115],v[36:39],v[80:87],v3
ds_read_b128 v[68:71],v11 offset:21504
v_smfmac_f32_16x16x64_bf16 v[116:119],v[24:27],v[96:103],v3
ds_read_b128 v[72:75],v11 offset:22528
v_smfmac_f32_16x16x64_bf16 v[116:119],v[28:31],v[104:111],v3
ds_read_b128 v[76:79],v11 offset:23552
v_cvt_pk_bf16_f32 v112,v112,v113
v_smfmac_f32_16x16x64_bf16 v[116:119],v[32:35],v[40:47],v3
ds_read_b128 v[80:83],v11 offset:24576
v_cvt_pk_bf16_f32 v113,v114,v115
buffer_store_dwordx2 v[112:113],v9,s[8:11],s65 offen
v_smfmac_f32_16x16x64_bf16 v[116:119],v[36:39],v[48:55],v3
ds_read_b128 v[84:87],v11 offset:25600
v_mov_b64 v[112:113],0
v_smfmac_f32_16x16x64_bf16 v[120:123],v[24:27],v[88:95],v3
ds_read_b128 v[96:99],v11 offset:26624
ds_read_b128 v[100:103],v11 offset:27648
v_mov_b64 v[114:115],0
s_waitcnt lgkmcnt(8)
v_smfmac_f32_16x16x64_bf16 v[120:123],v[28:31],v[56:63],v3
ds_read_b128 v[104:107],v11 offset:28672
v_cvt_pk_bf16_f32 v116,v116,v117
s_waitcnt lgkmcnt(7)
v_smfmac_f32_16x16x64_bf16 v[120:123],v[32:35],v[64:71],v3
ds_read_b128 v[108:111],v11 offset:29696
ds_read_b128 v[40:43],v11 offset:30720
v_cvt_pk_bf16_f32 v117,v118,v119
buffer_store_dwordx2 v[116:117],v9,s[8:11],s57 offen
s_waitcnt lgkmcnt(7)
v_smfmac_f32_16x16x64_bf16 v[120:123],v[36:39],v[72:79],v3
ds_read_b128 v[44:47],v11 offset:31744
v_add_u32 v52,s50,v5
s_waitcnt lgkmcnt(6)
v_smfmac_f32_16x16x64_bf16 v[112:115],v[24:27],v[80:87],v3
v_add_u32 v54,s50,v6
s_waitcnt lgkmcnt(4)
v_smfmac_f32_16x16x64_bf16 v[112:115],v[28:31],v[96:103],v3
ds_read_b64_tr_b16 v[52:53],v52
v_cvt_pk_bf16_f32 v120,v120,v121
s_waitcnt lgkmcnt(3)
v_smfmac_f32_16x16x64_bf16 v[112:115],v[32:35],v[104:111],v3
ds_read_b64_tr_b16 v[54:55],v54
v_cvt_pk_bf16_f32 v121,v122,v123
buffer_store_dwordx2 v[120:121],v9,s[8:11],s58 offen
s_waitcnt lgkmcnt(2)
v_smfmac_f32_16x16x64_bf16 v[112:115],v[36:39],v[40:47],v3
v_mov_b64 v[116:117],0
v_mov_b64 v[118:119],0
s_xor_b32 s65,s65,262144
v_mov_b32_dpp v124,v126 quad_perm:[2,3,2,3] row_mask:0xf bank_mask:0xf
v_mov_b32_dpp v125,v127 quad_perm:[2,3,2,3] row_mask:0xf bank_mask:0xf
s_mov_b32 vcc_lo,0xcccccccc
s_mov_b32 vcc_hi,0xcccccccc
s_nop 0
v_cvt_pk_bf16_f32 v112,v112,v113
v_cvt_pk_bf16_f32 v113,v114,v115
buffer_store_dwordx2 v[112:113],v9,s[8:11],s59 offen
s_waitcnt lgkmcnt(0)
s_buffer_load_dword s19,s[8:11],s56
v_cndmask_b32 v124,v124,v52,vcc
v_cndmask_b32 v125,v125,v53,vcc
v_cndmask_b32 v126,v126,v54,vcc
v_cndmask_b32 v127,v127,v55,vcc
s_cmp_lt_u32 s46,2
s_waitcnt vmcnt(3)
s_cbranch_scc1 L_crg_179
s_cmp_eq_u32 s46,2
s_waitcnt vmcnt(1)
s_cbranch_scc1 L_crg_179
s_waitcnt vmcnt(0)
L_crg_179:
buffer_load_dwordx4 v[32:35],v0,s[8:11],s66 offen offset:0 sc1
buffer_load_dwordx4 v[36:39],v0,s[8:11],s66 offen offset:1024 sc1
v_mov_b64 v[96:97],0
v_mov_b64 v[98:99],0
v_mov_b64 v[100:101],0
v_mov_b64 v[102:103],0
v_mov_b64 v[104:105],0
v_mov_b64 v[106:107],0
v_mov_b64 v[108:109],0
v_mov_b64 v[110:111],0
v_mov_b64 v[112:113],0
v_mov_b64 v[114:115],0
v_add_u32 v55,131072,v0
v_add_u32 v123,s73,v55
v_xor_b32 v120,1024,v12
v_xor_b32 v121,2048,v12
v_xor_b32 v122,3072,v12
buffer_load_dwordx4 v[44:47],v0,s[8:11],s66 offen offset:0 sc1
buffer_load_dwordx4 v[48:51],v0,s[8:11],s66 offen offset:1024 sc1
s_cmp_ge_u32 s51,63
s_cselect_b32 s76,0,1
s_cmp_eq_u32 s46,0
s_cselect_b32 s76,s76,0
s_waitcnt vmcnt(3)
v_mfma_f32_16x16x32_bf16 v[28:31],v[18:21],v[32:35],0
s_waitcnt vmcnt(2)
v_mfma_f32_16x16x32_bf16 v[28:31],v[18:21],v[36:39],v[28:31]
s_nop 7
v_cmp_u_f32 vcc,v28,v28
v_add_f32_dpp v52,v28,v28 row_ror:8 row_mask:0xf bank_mask:0x3
v_add_f32_dpp v53,v29,v29 row_ror:8 row_mask:0xf bank_mask:0x3
v_add_f32_dpp v52,v30,v30 row_ror:8 row_mask:0xf bank_mask:0xc
v_add_f32_dpp v53,v31,v31 row_ror:8 row_mask:0xf bank_mask:0xc
s_nop 0
v_add_f32_dpp v52,v52,v52 row_shl:4 row_mask:0xf bank_mask:0x5
v_add_f32_dpp v53,v53,v53 row_shl:4 row_mask:0xf bank_mask:0x5
s_cbranch_vccnz L_crp_174
L_cok_180:
v_cvt_pk_bf16_f32 v54,v52,v53
buffer_store_dword v54,v10,s[8:11],s64 offen
s_mov_b32 s69,s66
s_xor_b32 s66,s66,262144
s_barrier
ds_read_b128 v[56:59],v55 offset:0
ds_read_b128 v[60:63],v55 offset:4096
ds_read_b128 v[64:67],v55 offset:1024
buffer_load_dwordx4 v[24:27],v13,s[8:11],s64 offen sc1
ds_read_b128 v[68:71],v55 offset:5120
ds_read_b128 v[72:75],v55 offset:2048
ds_read_b128 v[76:79],v55 offset:6144
ds_read_b128 v[80:83],v55 offset:3072
buffer_load_dwordx4 v[24:27],v13,s[8:11],s64 offen sc1
ds_read_b128 v[84:87],v55 offset:7168
ds_read_b128 v[88:91],v123 offset:8192
ds_read_b128 v[92:95],v123 offset:9216
s_branch L_chain_169
L_cpb_176:
buffer_load_dwordx4 v[40:43],v13,s[8:11],s70 offen sc1
s_sub_u32 s49,s49,1
s_cbranch_scc1 L_abort
s_waitcnt vmcnt(0)
v_max3_u32 v123,v40,v41,v42
v_max_u32 v123,v43,v123
v_cmp_le_u32 vcc,s72,v123
s_cbranch_vccnz L_cpb_176
ds_write_b128 v12,v[40:43] offset:4096
s_branch L_cback_178
L_crp_174:
buffer_load_dwordx4 v[32:35],v0,s[8:11],s66 offen offset:0 sc1
buffer_load_dwordx4 v[36:39],v0,s[8:11],s66 offen offset:1024 sc1
s_sub_u32 s49,s49,1
s_cbranch_scc1 L_abort
s_waitcnt vmcnt(3)
v_mfma_f32_16x16x32_bf16 v[28:31],v[18:21],v[44:47],0
s_waitcnt vmcnt(2)
v_mfma_f32_16x16x32_bf16 v[28:31],v[18:21],v[48:51],v[28:31]
s_nop 7
v_cmp_u_f32 vcc,v28,v28
v_add_f32_dpp v52,v28,v28 row_ror:8 row_mask:0xf bank_mask:0x3
v_add_f32_dpp v53,v29,v29 row_ror:8 row_mask:0xf bank_mask:0x3
v_add_f32_dpp v52,v30,v30 row_ror:8 row_mask:0xf bank_mask:0xc
v_add_f32_dpp v53,v31,v31 row_ror:8 row_mask:0xf bank_mask:0xc
s_nop 0
v_add_f32_dpp v52,v52,v52 row_shl:4 row_mask:0xf bank_mask:0x5
v_add_f32_dpp v53,v53,v53 row_shl:4 row_mask:0xf bank_mask:0x5
s_cbranch_vccz L_cok_180
buffer_load_dwordx4 v[44:47],v0,s[8:11],s66 offen offset:0 sc1
buffer_load_dwordx4 v[48:51],v0,s[8:11],s66 offen offset:1024 sc1
s_sub_u32 s49,s49,1
s_cbranch_scc1 L_abort
s_waitcnt vmcnt(3)
v_mfma_f32_16x16x32_bf16 v[28:31],v[18:21],v[32:35],0
s_waitcnt vmcnt(2)
v_mfma_f32_16x16x32_bf16 v[28:31],v[18:21],v[36:39],v[28:31]
s_nop 7
v_cmp_u_f32 vcc,v28,v28
v_add_f32_dpp v52,v28,v28 row_ror:8 row_mask:0xf bank_mask:0x3
v_add_f32_dpp v53,v29,v29 row_ror:8 row_mask:0xf bank_mask:0x3
v_add_f32_dpp v52,v30,v30 row_ror:8 row_mask:0xf bank_mask:0xc
v_add_f32_dpp v53,v31,v31 row_ror:8 row_mask:0xf bank_mask:0xc
s_nop 0
v_add_f32_dpp v52,v52,v52 row_shl:4 row_mask:0xf bank_mask:0x5
v_add_f32_dpp v53,v53,v53 row_shl:4 row_mask:0xf bank_mask:0x5
s_cbranch_vccz L_cok_180
s_branch L_crp_174
L_ckw_162:
s_add_u32 s59,s18,s75
L_ww_181:
s_sleep 1
buffer_load_dword v23,off,s[8:11],s59 sc1
s_sub_u32 s49,s49,1
s_cbranch_scc1 L_abort
s_waitcnt vmcnt(0)
v_readfirstlane_b32 s76,v23
s_cmp_eq_u32 s76,0
s_cbranch_scc1 L_ww_181
L_wwd_182:
s_branch L_ckb_163
L_cend_172:
v_smfmac_f32_16x16x64_bf16 v[116:119],v[36:39],v[184:191],v2
v_smfmac_f32_16x16x64_bf16 v[112:115],v[40:43],v[192:199],v2
v_smfmac_f32_16x16x64_bf16 v[116:119],v[40:43],v[200:207],v2
v_smfmac_f32_16x16x64_bf16 v[112:115],v[44:47],v[208:215],v2
v_smfmac_f32_16x16x64_bf16 v[116:119],v[44:47],v[216:223],v2
v_smfmac_f32_16x16x64_bf16 v[112:115],v[48:51],v[224:231],v2
v_smfmac_f32_16x16x64_bf16 v[116:119],v[48:51],v[232:239],v2
v_smfmac_f32_16x16x64_bf16 v[112:115],v[52:55],v[240:247],v2
v_smfmac_f32_16x16x64_bf16 v[116:119],v[52:55],v[248:255],v2
s_waitcnt lgkmcnt(0)
s_nop 2
v_pk_add_f32 v[112:113],v[112:113],v[114:115]
s_nop 2
v_pk_add_f32 v[116:117],v[116:117],v[118:119]
v_cvt_pk_bf16_f32 v126,v112,v113
v_cvt_pk_bf16_f32 v127,v116,v117
v_add_u32 v52,s50,v5
v_add_u32 v54,s50,v6
ds_read_b64_tr_b16 v[52:53],v52
ds_read_b64_tr_b16 v[54:55],v54
v_mov_b32_dpp v124,v126 quad_perm:[2,3,2,3] row_mask:0xf bank_mask:0xf
v_mov_b32_dpp v125,v127 quad_perm:[2,3,2,3] row_mask:0xf bank_mask:0xf
s_mov_b32 vcc_lo,0xcccccccc
s_mov_b32 vcc_hi,0xcccccccc
s_waitcnt lgkmcnt(0)
v_cndmask_b32 v124,v124,v52,vcc
v_cndmask_b32 v125,v125,v53,vcc
v_cndmask_b32 v126,v126,v54,vcc
v_cndmask_b32 v127,v127,v55,vcc
buffer_store_dwordx4 v[124:127],v0,s[8:11],s54 offen sc1
s_mov_b32 s51,64
s_waitcnt vmcnt(0)
s_barrier
s_nop 11
v_lshrrev_b32 v1,4,v0
s_mov_b32 s53,0
s_branch L_rb_7
L_rc1_156:
v_and_b32 v120,15,v1
v_lshrrev_b32 v121,4,v1
v_and_b32 v122,2,v1
v_cmp_eq_u32 vcc,0,v122
v_mov_b32 v2,0xeeee
v_mov_b32 v123,0x4444
v_cndmask_b32 v2,v2,v123,vcc
v_and_b32 v122,1,v1
v_cmp_eq_u32 vcc,0,v122
v_mov_b32 v3,0xdddd
v_mov_b32 v123,0x8888
v_cndmask_b32 v3,v3,v123,vcc
v_lshrrev_b32 v122,1,v120
v_bfe_u32 v123,v120,2,1
v_xor_b32 v123,v123,v122
v_lshlrev_b32 v4,7,v123
v_and_b32 v123,1,v120
v_lshl_add_u32 v4,v123,6,v4
v_xor_b32 v123,v121,v122
v_and_b32 v123,3,v123
v_lshl_add_u32 v4,v123,4,v4
s_lshl_b32 s56,s46,10
s_add_u32 s56,s56,147456
v_add_u32 v4,s56,v4
v_lshlrev_b32 v122,1,v121
v_add_u32 v122,0,v122
v_and_b32 v123,1,v121
v_xor_b32 v123,v123,v122
v_lshlrev_b32 v5,7,v123
v_bfe_u32 v123,v120,3,1
v_lshl_add_u32 v5,v123,6,v5
v_xor_b32 v123,v120,v122
v_and_b32 v123,3,v123
v_lshl_add_u32 v5,v123,4,v5
v_bfe_u32 v123,v120,2,1
v_lshl_add_u32 v5,v123,3,v5
v_add_u32 v5,147456,v5
v_lshlrev_b32 v122,1,v121
v_add_u32 v122,1,v122
v_and_b32 v123,1,v121
v_xor_b32 v123,v123,v122
v_lshlrev_b32 v6,7,v123
v_bfe_u32 v123,v120,3,1
v_lshl_add_u32 v6,v123,6,v6
v_xor_b32 v123,v120,v122
v_and_b32 v123,3,v123
v_lshl_add_u32 v6,v123,4,v6
v_bfe_u32 v123,v120,2,1
v_lshl_add_u32 v6,v123,3,v6
v_add_u32 v6,147456,v6
v_lshlrev_b32 v7,7,v121
v_lshrrev_b32 v122,1,v120
v_lshl_add_u32 v8,v122,4,v7
v_add_u32 v8,151552,v8
v_lshrrev_b32 v122,2,v120
v_lshl_add_u32 v7,v122,5,v7
v_and_b32 v122,1,v120
v_lshl_add_u32 v7,v122,4,v7
v_and_b32 v122,2,v120
v_cmp_eq_u32 vcc,0,v122
s_lshl_b32 s56,s46,9
v_mov_b32 v122,2048
v_mov_b32 v123,s56
v_cndmask_b32 v122,v122,v123,vcc
v_add_u32 v7,v122,v7
v_add_u32 v7,151552,v7
v_lshrrev_b32 v122,3,v1
v_lshlrev_b32 v9,11,v122
v_and_b32 v122,7,v1
v_lshl_add_u32 v9,v122,3,v9
s_lshl_b32 s56,s46,14
s_lshl_b32 s57,s47,6
s_add_u32 s56,s56,s57
v_add_u32 v9,s56,v9
s_lshl_b32 s71,s46,5
s_add_u32 s71,s71,s47
s_bfe_u32 s56,s71,0x10003
s_lshl_b32 s56,s56,11
s_and_b32 s57,s71,1
s_lshl_b32 s57,s57,10
s_add_u32 s56,s56,s57
s_bfe_u32 s57,s71,0x10002
s_lshl_b32 s57,s57,9
s_add_u32 s56,s56,s57
s_bfe_u32 s57,s71,0x10001
s_lshl_b32 s57,s57,6
s_add_u32 s56,s56,s57
s_bfe_u32 s57,s71,0x10004
s_lshl_b32 s57,s57,8
s_add_u32 s56,s56,s57
s_bfe_u32 s57,s71,0x10005
s_lshl_b32 s57,s57,7
s_add_u32 s56,s56,s57
s_bfe_u32 s57,s71,0x10006
s_lshl_b32 s57,s57,12
s_add_u32 s56,s56,s57
v_and_b32 v122,3,v120
v_lshlrev_b32 v10,2,v122
v_bfe_u32 v122,v120,3,1
v_lshl_add_u32 v10,v122,4,v10
v_and_b32 v122,1,v121
v_lshl_add_u32 v10,v122,5,v10
v_add_u32 v10,s56,v10
v_and_b32 v123,36,v1
v_mov_b32 v122,0x80000000
v_cmp_eq_u32 vcc,0,v123
s_nop 1
v_cndmask_b32 v10,v122,v10,vcc
s_lshl_b32 s71,s71,11
s_lshl_b32 s73,s46,11
s_mov_b32 s72,0xffc00000
s_mov_b32 s74,0
v_and_b32 v11,1,v121
v_xor_b32 v11,v11,v120
v_and_b32 v11,3,v11
v_lshrrev_b32 v122,2,v120
v_lshl_add_u32 v11,v11,2,v122
v_lshl_add_u32 v11,v121,4,v11
v_lshlrev_b32 v11,4,v11
s_lshl_b32 s56,s46,15
v_add_u32 v11,s56,v11
v_lshrrev_b32 v13,3,v1
v_lshlrev_b32 v13,9,v13
v_and_b32 v122,7,v1
v_lshl_add_u32 v13,v122,4,v13
v_and_b32 v122,15,v1
v_and_b32 v123,1,v1
v_lshlrev_b32 v123,4,v123
v_mov_b32 v124,0x3f80
v_lshlrev_b32 v124,v123,v124
v_lshrrev_b32 v122,1,v122
v_cmp_eq_u32 vcc,0,v122
s_nop 1
v_cndmask_b32 v18,0,v124,vcc
v_cmp_eq_u32 vcc,1,v122
s_nop 1
v_cndmask_b32 v19,0,v124,vcc
v_cmp_eq_u32 vcc,2,v122
s_nop 1
v_cndmask_b32 v20,0,v124,vcc
v_cmp_eq_u32 vcc,3,v122
s_nop 1
v_cndmask_b32 v21,0,v124,vcc
s_and_b32 s56,s46,1
s_lshl_b32 s56,s56,8
s_and_b32 s57,s46,2
s_lshl_b32 s57,s57,6
s_add_u32 s56,s56,s57
v_add_u32 v13,s56,v13
s_add_u32 s56,s50,155648
v_add_u32 v12,s56,v0
v_mov_b64 v[14:15],s[28:29]
v_mov_b64 v[16:17],s[28:29]
v_add_u32 v22,12599296,v10
s_lshl_b32 s18,s47,2
s_add_u32 s18,s18,10494080
v_mov_b32 v1,s80
s_mov_b32 s65,15728640
s_add_u32 s66,s71,15728640
s_add_u32 s69,s71,15990784
s_mov_b32 s30,0x40000000
s_mov_b32 s51,0
buffer_load_dwordx4 v[88:91],v0,s[8:11],s66 offen offset:0
buffer_load_dwordx4 v[88:91],v0,s[8:11],s66 offen offset:1024
buffer_load_dwordx4 v[88:91],v0,s[8:11],s69 offen offset:0
buffer_load_dwordx4 v[88:91],v0,s[8:11],s69 offen offset:1024
s_waitcnt vmcnt(0)
L_cst_186:
s_cmp_lg_u32 s46,0
s_cbranch_scc1 L_csw_191
s_lshl_b32 s59,s51,13
s_lshl2_add_u32 s59,s47,s59
s_add_u32 s59,s59,10485888
L_ww_192:
s_sleep 1
buffer_load_dword v122,off,s[8:11],s59 sc1
s_sub_u32 s49,s49,1
s_cbranch_scc1 L_abort
s_waitcnt vmcnt(0)
v_readfirstlane_b32 s61,v122
s_cmp_eq_u32 s61,0
s_cbranch_scc1 L_ww_192
L_wwd_193:
L_csw_191:
s_waitcnt lgkmcnt(0)
s_barrier
s_lshl_b32 s56,s51,5
s_add_u32 s56,s56,s47
s_mul_i32 s56,s56,24576
s_add_u32 s56,s56,150994944
s_add_u32 s67,s56,s73
s_add_u32 m0,s73,131072
s_add_u32 s57,s67,8192
buffer_load_dwordx4 v0,s[8:11],s67 offen sc1 lds
buffer_load_dwordx4 v0,s[8:11],s67 offen offset:1024 sc1 lds
s_add_u32 m0,s73,139264
s_add_u32 s67,s67,786432
buffer_load_dwordx4 v0,s[8:11],s57 offen sc1 lds
buffer_load_dwordx4 v0,s[8:11],s57 offen offset:1024 sc1 lds
s_lshl_b32 s75,s51,13
s_add_u32 s56,s75,12591104
buffer_load_dword v23,v10,s[8:11],s56 offen sc1
s_add_u32 s64,s75,12582912
s_add_u32 s70,s64,4096
s_lshl_b32 s68,s51,5
s_add_u32 s68,s68,s47
s_lshl_b32 s68,s68,12
s_lshl_b32 s56,s46,10
s_add_u32 s68,s68,s56
s_add_u32 s68,s68,58720256
s_mov_b32 s54,0x80000000
s_mov_b32 s77,0
s_add_u32 s56,s18,s75
s_buffer_load_dword s19,s[8:11],s56
s_cmp_eq_u32 s51,63
s_cselect_b32 s76,1,s46
s_cmp_eq_u32 s76,0
s_cselect_b32 s76,1,0
v_mov_b64 v[96:97],0
v_mov_b64 v[98:99],0
v_mov_b64 v[100:101],0
v_mov_b64 v[102:103],0
v_mov_b64 v[104:105],0
v_mov_b64 v[106:107],0
v_mov_b64 v[108:109],0
v_mov_b64 v[110:111],0
v_mov_b64 v[112:113],0
v_mov_b64 v[114:115],0
v_mov_b64 v[116:117],0
v_mov_b64 v[118:119],0
s_waitcnt vmcnt(0) lgkmcnt(0)
s_barrier
v_add_u32 v55,131072,v0
ds_read_b128 v[56:59],v55 offset:0
ds_read_b128 v[60:63],v55 offset:4096
ds_read_b128 v[64:67],v55 offset:1024
ds_read_b128 v[68:71],v55 offset:5120
ds_read_b128 v[72:75],v55 offset:2048
ds_read_b128 v[76:79],v55 offset:6144
ds_read_b128 v[80:83],v55 offset:3072
ds_read_b128 v[84:87],v55 offset:7168
v_add_u32 v123,s73,v55
ds_read_b128 v[88:91],v123 offset:8192
ds_read_b128 v[92:95],v123 offset:9216
v_xor_b32 v120,1024,v12
v_xor_b32 v121,2048,v12
v_xor_b32 v122,3072,v12
buffer_load_dwordx4 v[24:27],v13,s[8:11],s64 offen sc1
buffer_load_dwordx4 v[24:27],v13,s[8:11],s64 offen sc1
L_chain_194:
L_cpa_195:
buffer_load_dwordx4 v[24:27],v13,s[8:11],s64 offen sc1
s_sub_u32 s49,s49,1
s_cbranch_scc1 L_abort
s_waitcnt vmcnt(2)
v_max3_u32 v123,v24,v25,v26
v_max_u32 v123,v27,v123
v_cmp_le_u32 vcc,s72,v123
ds_write_b128 v12,v[24:27] offset:0
s_cbranch_vccnz L_cpa_195
L_cgo_198:
v_smfmac_f32_16x16x64_bf16 v[96:99],v[24:27],a[0:7],v2
buffer_load_dwordx4 v[40:43],v13,s[8:11],s70 offen sc1
v_smfmac_f32_16x16x64_bf16 v[100:103],v[24:27],a[128:135],v2
s_waitcnt lgkmcnt(0)
s_barrier
ds_read_b128 v[28:31],v120 offset:0
v_smfmac_f32_16x16x64_bf16 v[104:107],v[24:27],a[8:15],v2
ds_read_b128 v[32:35],v121 offset:0
v_smfmac_f32_16x16x64_bf16 v[108:111],v[24:27],a[136:143],v2
ds_read_b128 v[36:39],v122 offset:0
v_smfmac_f32_16x16x64_bf16 v[112:115],v[24:27],v[128:135],v2
v_smfmac_f32_16x16x64_bf16 v[116:119],v[24:27],v[136:143],v2
s_waitcnt lgkmcnt(2)
v_smfmac_f32_16x16x64_bf16 v[96:99],v[28:31],a[16:23],v2
s_add_u32 m0,s73,131072
v_smfmac_f32_16x16x64_bf16 v[100:103],v[28:31],a[144:151],v2
s_add_u32 s57,s67,8192
v_smfmac_f32_16x16x64_bf16 v[104:107],v[28:31],a[24:31],v2
s_cmp_lt_u32 s19,s76
s_cbranch_scc1 L_ckw_187
L_ckb_188:
v_smfmac_f32_16x16x64_bf16 v[108:111],v[28:31],a[152:159],v2
s_waitcnt vmcnt(0) lgkmcnt(1)
v_smfmac_f32_16x16x64_bf16 v[96:99],v[32:35],a[32:39],v2
ds_write_b128 v12,v[40:43] offset:4096
v_max3_u32 v123,v40,v41,v42
v_smfmac_f32_16x16x64_bf16 v[100:103],v[32:35],a[160:167],v2
v_max_u32 v123,v43,v123
v_smfmac_f32_16x16x64_bf16 v[104:107],v[32:35],a[40:47],v2
v_cmp_le_u32 vcc,s72,v123
v_smfmac_f32_16x16x64_bf16 v[108:111],v[32:35],a[168:175],v2
v_smfmac_f32_16x16x64_bf16 v[112:115],v[28:31],v[144:151],v2
s_cbranch_vccnz L_cpb_201
L_cback_203:
s_waitcnt lgkmcnt(0)
s_barrier
v_smfmac_f32_16x16x64_bf16 v[96:99],v[36:39],a[48:55],v2
buffer_store_dword v54,v10,s[8:11],s30 offen sc1
v_smfmac_f32_16x16x64_bf16 v[100:103],v[36:39],a[176:183],v2
ds_read_b128 v[44:47],v120 offset:4096
v_smfmac_f32_16x16x64_bf16 v[104:107],v[36:39],a[56:63],v2
buffer_store_dwordx4 v[124:127],v0,s[8:11],s54 offen sc1
v_smfmac_f32_16x16x64_bf16 v[108:111],v[36:39],a[184:191],v2
ds_read_b128 v[48:51],v121 offset:4096
v_smfmac_f32_16x16x64_bf16 v[96:99],v[40:43],a[64:71],v2
buffer_load_dwordx4 v0,s[8:11],s67 offen sc1 lds
v_smfmac_f32_16x16x64_bf16 v[100:103],v[40:43],a[192:199],v2
ds_read_b128 v[52:55],v122 offset:4096
v_smfmac_f32_16x16x64_bf16 v[104:107],v[40:43],a[72:79],v2
buffer_load_dwordx4 v0,s[8:11],s67 offen offset:1024 sc1 lds
s_add_u32 m0,s73,139264
v_smfmac_f32_16x16x64_bf16 v[108:111],v[40:43],a[200:207],v2
s_waitcnt lgkmcnt(2)
v_smfmac_f32_16x16x64_bf16 v[96:99],v[44:47],a[80:87],v2
buffer_load_dwordx4 v0,s[8:11],s57 offen sc1 lds
s_add_u32 s67,s67,786432
v_smfmac_f32_16x16x64_bf16 v[100:103],v[44:47],a[208:215],v2
s_waitcnt lgkmcnt(1)
v_smfmac_f32_16x16x64_bf16 v[96:99],v[48:51],a[96:103],v2
buffer_load_dwordx4 v0,s[8:11],s57 offen offset:1024 sc1 lds
v_smfmac_f32_16x16x64_bf16 v[100:103],v[48:51],a[224:231],v2
s_waitcnt lgkmcnt(0)
v_smfmac_f32_16x16x64_bf16 v[96:99],v[52:55],a[112:119],v2
buffer_load_dword v23,v22,s[8:11],s75 offen sc1
v_smfmac_f32_16x16x64_bf16 v[100:103],v[52:55],a[240:247],v2
v_smfmac_f32_16x16x64_bf16 v[104:107],v[44:47],a[88:95],v2
v_smfmac_f32_16x16x64_bf16 v[108:111],v[44:47],a[216:223],v2
v_smfmac_f32_16x16x64_bf16 v[104:107],v[48:51],a[104:111],v2
v_add_f32 v96,v96,v98
v_smfmac_f32_16x16x64_bf16 v[108:111],v[48:51],a[232:239],v2
v_add_f32 v97,v97,v99
v_smfmac_f32_16x16x64_bf16 v[104:107],v[52:55],a[120:127],v2
v_cvt_pk_bf16_f32 v120,v96,v97
v_smfmac_f32_16x16x64_bf16 v[108:111],v[52:55],a[248:255],v2
v_add_f32 v100,v100,v102
v_smfmac_f32_16x16x64_bf16 v[116:119],v[28:31],v[152:159],v2
v_add_f32 v101,v101,v103
v_smfmac_f32_16x16x64_bf16 v[112:115],v[32:35],v[160:167],v2
v_cvt_pk_bf16_f32 v121,v100,v101
v_add_f32 v104,v104,v106
v_add_f32 v105,v105,v107
v_cvt_pk_bf16_f32 v122,v104,v105
v_add_f32 v108,v108,v110
v_add_f32 v109,v109,v111
v_cvt_pk_bf16_f32 v123,v108,v109
ds_write_b128 v4,v[120:123]
v_smfmac_f32_16x16x64_bf16 v[116:119],v[32:35],v[168:175],v2
s_mov_b32 s54,s68
s_add_u32 s68,s68,131072
v_mov_b32 v125,0
v_smfmac_f32_16x16x64_bf16 v[112:115],v[36:39],v[176:183],v2
s_cmp_eq_u32 s51,63
s_cbranch_scc1 L_cend_197
v_smfmac_f32_16x16x64_bf16 v[116:119],v[36:39],v[184:191],v2
v_smfmac_f32_16x16x64_bf16 v[112:115],v[40:43],v[192:199],v2
s_waitcnt lgkmcnt(0)
s_barrier
ds_read_b64_tr_b16 v[96:97],v5 offset:0
ds_read_b64_tr_b16 v[98:99],v6 offset:0
v_smfmac_f32_16x16x64_bf16 v[116:119],v[40:43],v[200:207],v2
ds_read_b64_tr_b16 v[100:101],v5 offset:1024
v_smfmac_f32_16x16x64_bf16 v[112:115],v[44:47],v[208:215],v2
ds_read_b64_tr_b16 v[102:103],v6 offset:1024
v_smfmac_f32_16x16x64_bf16 v[116:119],v[44:47],v[216:223],v2
ds_read_b64_tr_b16 v[104:105],v5 offset:2048
v_smfmac_f32_16x16x64_bf16 v[112:115],v[48:51],v[224:231],v2
ds_read_b64_tr_b16 v[106:107],v6 offset:2048
s_waitcnt lgkmcnt(4)
v_mfma_f32_16x16x32_bf16 v[24:27],v[56:59],v[96:99],0
ds_read_b64_tr_b16 v[108:109],v5 offset:3072
v_mfma_f32_16x16x32_bf16 v[28:31],v[60:63],v[96:99],0
ds_read_b64_tr_b16 v[110:111],v6 offset:3072
v_mfma_f32_16x16x32_bf16 v[32:35],v[96:99],v[96:99],0
ds_read_b128 v[40:43],v11 offset:12288
s_waitcnt lgkmcnt(5)
v_mfma_f32_16x16x32_bf16 v[24:27],v[64:67],v[100:103],v[24:27]
ds_read_b128 v[56:59],v11 offset:0
v_mfma_f32_16x16x32_bf16 v[28:31],v[68:71],v[100:103],v[28:31]
ds_read_b128 v[60:63],v11 offset:1024
v_mfma_f32_16x16x32_bf16 v[32:35],v[100:103],v[100:103],v[32:35]
ds_read_b128 v[96:99],v11 offset:8192
s_waitcnt lgkmcnt(6)
v_mfma_f32_16x16x32_bf16 v[24:27],v[72:75],v[104:107],v[24:27]
ds_read_b128 v[64:67],v11 offset:2048
v_mfma_f32_16x16x32_bf16 v[28:31],v[76:79],v[104:107],v[28:31]
ds_read_b128 v[68:71],v11 offset:3072
v_mfma_f32_16x16x32_bf16 v[32:35],v[104:107],v[104:107],v[32:35]
ds_read_b128 v[100:103],v11 offset:9216
s_waitcnt lgkmcnt(7)
v_mfma_f32_16x16x32_bf16 v[24:27],v[80:83],v[108:111],v[24:27]
ds_read_b128 v[72:75],v11 offset:4096
v_mfma_f32_16x16x32_bf16 v[28:31],v[84:87],v[108:111],v[28:31]
ds_read_b128 v[76:79],v11 offset:5120
v_mfma_f32_16x16x32_bf16 v[32:35],v[108:111],v[108:111],v[32:35]
ds_read_b128 v[104:107],v11 offset:10240
v_smfmac_f32_16x16x64_bf16 v[116:119],v[48:51],v[232:239],v2
ds_read_b128 v[80:83],v11 offset:6144
v_smfmac_f32_16x16x64_bf16 v[112:115],v[52:55],v[240:247],v2
ds_read_b128 v[84:87],v11 offset:7168
v_smfmac_f32_16x16x64_bf16 v[116:119],v[52:55],v[248:255],v2
ds_read_b128 v[108:111],v11 offset:11264
v_max3_f32 v126,v24,v25,v26
v_max3_f32 v127,v27,v28,v29
v_max3_f32 v126,v30,v31,v126
v_max3_f32 v127,v34,v35,v127
v_max_f32 v126,v126,v127
v_max_f32 v127,v126,v127
v_pk_mul_f32 v[34:35],v[34:35],v[0:1] op_sel:[0,1]
v_pk_mul_f32 v[24:25],v[24:25],v[0:1] op_sel:[0,1]
v_permlane16_swap_b32 v126,v127
v_max_f32 v126,v126,v127
v_max_f32 v127,v126,v127
v_pk_mul_f32 v[26:27],v[26:27],v[0:1] op_sel:[0,1]
v_pk_mul_f32 v[28:29],v[28:29],v[0:1] op_sel:[0,1]
v_permlane32_swap_b32 v126,v127
v_max_f32 v126,v126,v127
v_mul_f32 v126,v1,v126
v_pk_mul_f32 v[30:31],v[30:31],v[0:1] op_sel:[0,1]
v_pk_add_f32 v[34:35],v[34:35],v[126:127] op_sel_hi:[1,0] neg_lo:[0,1] neg_hi:[0,1]
v_pk_add_f32 v[112:113],v[112:113],v[114:115]
v_pk_add_f32 v[116:117],v[116:117],v[118:119]
v_pk_add_f32 v[24:25],v[24:25],v[126:127] op_sel_hi:[1,0] neg_lo:[0,1] neg_hi:[0,1]
v_pk_add_f32 v[26:27],v[26:27],v[126:127] op_sel_hi:[1,0] neg_lo:[0,1] neg_hi:[0,1]
v_pk_add_f32 v[28:29],v[28:29],v[126:127] op_sel_hi:[1,0] neg_lo:[0,1] neg_hi:[0,1]
v_pk_add_f32 v[30:31],v[30:31],v[126:127] op_sel_hi:[1,0] neg_lo:[0,1] neg_hi:[0,1]
v_exp_f32 v34,v34
v_exp_f32 v35,v35
v_cvt_pk_bf16_f32 v126,v112,v113
v_cvt_pk_bf16_f32 v124,v34,v35
v_cvt_pk_bf16_f32 v127,v116,v117
v_cvt_pk_bf16_f32 v36,v116,v117
v_mfma_f32_16x16x16_bf16 v[32:35],v[14:15],v[124:125],0
ds_read_b128 v[44:47],v11 offset:13312
v_exp_f32 v24,v24
v_mfma_f32_16x16x16_bf16 v[112:115],v[126:127],v[124:125],0
ds_read_b128 v[48:51],v11 offset:14336
v_exp_f32 v25,v25
v_mfma_f32_16x16x16_bf16 v[116:119],v[36:37],v[124:125],0
ds_read_b128 v[52:55],v11 offset:15360
v_exp_f32 v26,v26
v_exp_f32 v27,v27
v_cvt_pk_bf16_f32 v120,v24,v25
v_exp_f32 v28,v28
v_exp_f32 v29,v29
v_cvt_pk_bf16_f32 v121,v26,v27
v_exp_f32 v30,v30
v_exp_f32 v31,v31
v_cvt_pk_bf16_f32 v122,v28,v29
v_cvt_pk_bf16_f32 v123,v30,v31
s_add_u32 s75,s75,8192
s_add_u32 s51,s51,1
v_mfma_f32_16x16x32_bf16 v[32:35],v[14:17],v[120:123],v[32:35]
v_mfma_f32_16x16x32_bf16 v[112:115],v[88:91],v[120:123],v[112:115]
ds_read_b128 v[88:91],v11 offset:16384
v_mfma_f32_16x16x32_bf16 v[116:119],v[92:95],v[120:123],v[116:119]
ds_read_b128 v[92:95],v11 offset:17408
v_rcp_f32 v32,v32
v_mov_b64 v[24:25],-1
v_mov_b64 v[26:27],-1
s_add_u32 s64,s75,12582912
s_add_u32 s70,s64,4096
v_pk_mul_f32 v[112:113],v[112:113],v[32:33] op_sel_hi:[1,0]
v_pk_mul_f32 v[114:115],v[114:115],v[32:33] op_sel_hi:[1,0]
v_pk_mul_f32 v[116:117],v[116:117],v[32:33] op_sel_hi:[1,0]
v_pk_mul_f32 v[118:119],v[118:119],v[32:33] op_sel_hi:[1,0]
v_cvt_pk_bf16_f32 v120,v112,v116
v_cvt_pk_bf16_f32 v121,v113,v117
v_cvt_pk_bf16_f32 v122,v114,v118
v_cvt_pk_bf16_f32 v123,v115,v119
ds_write_b128 v7,v[120:123]
buffer_store_dwordx4 v[24:27],v0,s[8:11],s69 offen
buffer_store_dwordx4 v[24:27],v0,s[8:11],s69 offen offset:1024
v_mov_b64 v[112:113],0
v_mov_b64 v[114:115],0
v_mov_b64 v[116:117],0
v_mov_b64 v[118:119],0
s_waitcnt lgkmcnt(0)
s_barrier
ds_read_b128 v[24:27],v8 offset:0
ds_read_b128 v[28:31],v8 offset:512
ds_read_b128 v[32:35],v8 offset:1024
ds_read_b128 v[36:39],v8 offset:1536
v_mov_b64 v[120:121],0
v_mov_b64 v[122:123],0
s_add_u32 s57,s65,65536
s_add_u32 s58,s65,131072
s_add_u32 s59,s65,196608
s_add_u32 s56,s18,s75
s_add_u32 s30,s75,17825792
s_waitcnt lgkmcnt(3)
v_smfmac_f32_16x16x64_bf16 v[112:115],v[24:27],v[56:63],v3
ds_read_b128 v[56:59],v11 offset:18432
s_waitcnt lgkmcnt(3)
v_smfmac_f32_16x16x64_bf16 v[112:115],v[28:31],v[64:71],v3
ds_read_b128 v[60:63],v11 offset:19456
s_waitcnt lgkmcnt(3)
v_smfmac_f32_16x16x64_bf16 v[112:115],v[32:35],v[72:79],v3
ds_read_b128 v[64:67],v11 offset:20480
s_waitcnt lgkmcnt(3)
v_smfmac_f32_16x16x64_bf16 v[112:115],v[36:39],v[80:87],v3
ds_read_b128 v[68:71],v11 offset:21504
v_smfmac_f32_16x16x64_bf16 v[116:119],v[24:27],v[96:103],v3
ds_read_b128 v[72:75],v11 offset:22528
v_smfmac_f32_16x16x64_bf16 v[116:119],v[28:31],v[104:111],v3
ds_read_b128 v[76:79],v11 offset:23552
v_cvt_pk_bf16_f32 v112,v112,v113
v_smfmac_f32_16x16x64_bf16 v[116:119],v[32:35],v[40:47],v3
ds_read_b128 v[80:83],v11 offset:24576
v_cvt_pk_bf16_f32 v113,v114,v115
buffer_store_dwordx2 v[112:113],v9,s[8:11],s65 offen
v_smfmac_f32_16x16x64_bf16 v[116:119],v[36:39],v[48:55],v3
ds_read_b128 v[84:87],v11 offset:25600
v_mov_b64 v[112:113],0
v_smfmac_f32_16x16x64_bf16 v[120:123],v[24:27],v[88:95],v3
ds_read_b128 v[96:99],v11 offset:26624
ds_read_b128 v[100:103],v11 offset:27648
v_mov_b64 v[114:115],0
s_waitcnt lgkmcnt(8)
v_smfmac_f32_16x16x64_bf16 v[120:123],v[28:31],v[56:63],v3
ds_read_b128 v[104:107],v11 offset:28672
v_cvt_pk_bf16_f32 v116,v116,v117
s_waitcnt lgkmcnt(7)
v_smfmac_f32_16x16x64_bf16 v[120:123],v[32:35],v[64:71],v3
ds_read_b128 v[108:111],v11 offset:29696
ds_read_b128 v[40:43],v11 offset:30720
v_cvt_pk_bf16_f32 v117,v118,v119
buffer_store_dwordx2 v[116:117],v9,s[8:11],s57 offen
s_waitcnt lgkmcnt(7)
v_smfmac_f32_16x16x64_bf16 v[120:123],v[36:39],v[72:79],v3
ds_read_b128 v[44:47],v11 offset:31744
v_add_u32 v52,s50,v5
s_waitcnt lgkmcnt(6)
v_smfmac_f32_16x16x64_bf16 v[112:115],v[24:27],v[80:87],v3
v_add_u32 v54,s50,v6
s_waitcnt lgkmcnt(4)
v_smfmac_f32_16x16x64_bf16 v[112:115],v[28:31],v[96:103],v3
ds_read_b64_tr_b16 v[52:53],v52
v_cvt_pk_bf16_f32 v120,v120,v121
s_waitcnt lgkmcnt(3)
v_smfmac_f32_16x16x64_bf16 v[112:115],v[32:35],v[104:111],v3
ds_read_b64_tr_b16 v[54:55],v54
v_cvt_pk_bf16_f32 v121,v122,v123
buffer_store_dwordx2 v[120:121],v9,s[8:11],s58 offen
s_waitcnt lgkmcnt(2)
v_smfmac_f32_16x16x64_bf16 v[112:115],v[36:39],v[40:47],v3
v_mov_b64 v[116:117],0
v_mov_b64 v[118:119],0
s_xor_b32 s65,s65,262144
v_mov_b32_dpp v124,v126 quad_perm:[2,3,2,3] row_mask:0xf bank_mask:0xf
v_mov_b32_dpp v125,v127 quad_perm:[2,3,2,3] row_mask:0xf bank_mask:0xf
s_mov_b32 vcc_lo,0xcccccccc
s_mov_b32 vcc_hi,0xcccccccc
s_nop 0
v_cvt_pk_bf16_f32 v112,v112,v113
v_cvt_pk_bf16_f32 v113,v114,v115
buffer_store_dwordx2 v[112:113],v9,s[8:11],s59 offen
s_waitcnt lgkmcnt(0)
s_buffer_load_dword s19,s[8:11],s56
v_cndmask_b32 v124,v124,v52,vcc
v_cndmask_b32 v125,v125,v53,vcc
v_cndmask_b32 v126,v126,v54,vcc
v_cndmask_b32 v127,v127,v55,vcc
s_cmp_lt_u32 s46,2
s_waitcnt vmcnt(3)
s_cbranch_scc1 L_crg_204
s_cmp_eq_u32 s46,2
s_waitcnt vmcnt(1)
s_cbranch_scc1 L_crg_204
s_waitcnt vmcnt(0)
L_crg_204:
buffer_load_dwordx4 v[32:35],v0,s[8:11],s66 offen offset:0 sc1
buffer_load_dwordx4 v[36:39],v0,s[8:11],s66 offen offset:1024 sc1
v_mov_b64 v[96:97],0
v_mov_b64 v[98:99],0
v_mov_b64 v[100:101],0
v_mov_b64 v[102:103],0
v_mov_b64 v[104:105],0
v_mov_b64 v[106:107],0
v_mov_b64 v[108:109],0
v_mov_b64 v[110:111],0
v_mov_b64 v[112:113],0
v_mov_b64 v[114:115],0
v_add_u32 v55,131072,v0
v_add_u32 v123,s73,v55
v_xor_b32 v120,1024,v12
v_xor_b32 v121,2048,v12
v_xor_b32 v122,3072,v12
buffer_load_dwordx4 v[44:47],v0,s[8:11],s66 offen offset:0 sc1
buffer_load_dwordx4 v[48:51],v0,s[8:11],s66 offen offset:1024 sc1
s_cmp_ge_u32 s51,63
s_cselect_b32 s76,0,1
s_cmp_eq_u32 s46,0
s_cselect_b32 s76,s76,0
s_waitcnt vmcnt(3)
v_mfma_f32_16x16x32_bf16 v[28:31],v[18:21],v[32:35],0
s_waitcnt vmcnt(2)
v_mfma_f32_16x16x32_bf16 v[28:31],v[18:21],v[36:39],v[28:31]
s_nop 7
v_cmp_u_f32 vcc,v28,v28
v_add_f32_dpp v52,v28,v28 row_ror:8 row_mask:0xf bank_mask:0x3
v_add_f32_dpp v53,v29,v29 row_ror:8 row_mask:0xf bank_mask:0x3
v_add_f32_dpp v52,v30,v30 row_ror:8 row_mask:0xf bank_mask:0xc
v_add_f32_dpp v53,v31,v31 row_ror:8 row_mask:0xf bank_mask:0xc
s_nop 0
v_add_f32_dpp v52,v52,v52 row_shl:4 row_mask:0xf bank_mask:0x5
v_add_f32_dpp v53,v53,v53 row_shl:4 row_mask:0xf bank_mask:0x5
s_cbranch_vccnz L_crp_199
L_cok_205:
v_cvt_pk_bf16_f32 v54,v52,v53
buffer_store_dword v54,v10,s[8:11],s64 offen
s_mov_b32 s69,s66
s_xor_b32 s66,s66,262144
s_barrier
ds_read_b128 v[56:59],v55 offset:0
ds_read_b128 v[60:63],v55 offset:4096
ds_read_b128 v[64:67],v55 offset:1024
buffer_load_dwordx4 v[24:27],v13,s[8:11],s64 offen sc1
ds_read_b128 v[68:71],v55 offset:5120
ds_read_b128 v[72:75],v55 offset:2048
ds_read_b128 v[76:79],v55 offset:6144
ds_read_b128 v[80:83],v55 offset:3072
buffer_load_dwordx4 v[24:27],v13,s[8:11],s64 offen sc1
ds_read_b128 v[84:87],v55 offset:7168
ds_read_b128 v[88:91],v123 offset:8192
ds_read_b128 v[92:95],v123 offset:9216
s_branch L_chain_194
L_cpb_201:
buffer_load_dwordx4 v[40:43],v13,s[8:11],s70 offen sc1
s_sub_u32 s49,s49,1
s_cbranch_scc1 L_abort
s_waitcnt vmcnt(0)
v_max3_u32 v123,v40,v41,v42
v_max_u32 v123,v43,v123
v_cmp_le_u32 vcc,s72,v123
s_cbranch_vccnz L_cpb_201
ds_write_b128 v12,v[40:43] offset:4096
s_branch L_cback_203
L_crp_199:
buffer_load_dwordx4 v[32:35],v0,s[8:11],s66 offen offset:0 sc1
buffer_load_dwordx4 v[36:39],v0,s[8:11],s66 offen offset:1024 sc1
s_sub_u32 s49,s49,1
s_cbranch_scc1 L_abort
s_waitcnt vmcnt(3)
v_mfma_f32_16x16x32_bf16 v[28:31],v[18:21],v[44:47],0
s_waitcnt vmcnt(2)
v_mfma_f32_16x16x32_bf16 v[28:31],v[18:21],v[48:51],v[28:31]
s_nop 7
v_cmp_u_f32 vcc,v28,v28
v_add_f32_dpp v52,v28,v28 row_ror:8 row_mask:0xf bank_mask:0x3
v_add_f32_dpp v53,v29,v29 row_ror:8 row_mask:0xf bank_mask:0x3
v_add_f32_dpp v52,v30,v30 row_ror:8 row_mask:0xf bank_mask:0xc
v_add_f32_dpp v53,v31,v31 row_ror:8 row_mask:0xf bank_mask:0xc
s_nop 0
v_add_f32_dpp v52,v52,v52 row_shl:4 row_mask:0xf bank_mask:0x5
v_add_f32_dpp v53,v53,v53 row_shl:4 row_mask:0xf bank_mask:0x5
s_cbranch_vccz L_cok_205
buffer_load_dwordx4 v[44:47],v0,s[8:11],s66 offen offset:0 sc1
buffer_load_dwordx4 v[48:51],v0,s[8:11],s66 offen offset:1024 sc1
s_sub_u32 s49,s49,1
s_cbranch_scc1 L_abort
s_waitcnt vmcnt(3)
v_mfma_f32_16x16x32_bf16 v[28:31],v[18:21],v[32:35],0
s_waitcnt vmcnt(2)
v_mfma_f32_16x16x32_bf16 v[28:31],v[18:21],v[36:39],v[28:31]
s_nop 7
v_cmp_u_f32 vcc,v28,v28
v_add_f32_dpp v52,v28,v28 row_ror:8 row_mask:0xf bank_mask:0x3
v_add_f32_dpp v53,v29,v29 row_ror:8 row_mask:0xf bank_mask:0x3
v_add_f32_dpp v52,v30,v30 row_ror:8 row_mask:0xf bank_mask:0xc
v_add_f32_dpp v53,v31,v31 row_ror:8 row_mask:0xf bank_mask:0xc
s_nop 0
v_add_f32_dpp v52,v52,v52 row_shl:4 row_mask:0xf bank_mask:0x5
v_add_f32_dpp v53,v53,v53 row_shl:4 row_mask:0xf bank_mask:0x5
s_cbranch_vccz L_cok_205
s_branch L_crp_199
L_ckw_187:
s_add_u32 s59,s18,s75
L_ww_206:
s_sleep 1
buffer_load_dword v23,off,s[8:11],s59 sc1
s_sub_u32 s49,s49,1
s_cbranch_scc1 L_abort
s_waitcnt vmcnt(0)
v_readfirstlane_b32 s76,v23
s_cmp_eq_u32 s76,0
s_cbranch_scc1 L_ww_206
L_wwd_207:
s_branch L_ckb_188
L_cend_197:
v_smfmac_f32_16x16x64_bf16 v[116:119],v[36:39],v[184:191],v2
v_smfmac_f32_16x16x64_bf16 v[112:115],v[40:43],v[192:199],v2
v_smfmac_f32_16x16x64_bf16 v[116:119],v[40:43],v[200:207],v2
v_smfmac_f32_16x16x64_bf16 v[112:115],v[44:47],v[208:215],v2
v_smfmac_f32_16x16x64_bf16 v[116:119],v[44:47],v[216:223],v2
v_smfmac_f32_16x16x64_bf16 v[112:115],v[48:51],v[224:231],v2
v_smfmac_f32_16x16x64_bf16 v[116:119],v[48:51],v[232:239],v2
v_smfmac_f32_16x16x64_bf16 v[112:115],v[52:55],v[240:247],v2
v_smfmac_f32_16x16x64_bf16 v[116:119],v[52:55],v[248:255],v2
s_waitcnt lgkmcnt(0)
s_nop 2
v_pk_add_f32 v[112:113],v[112:113],v[114:115]
s_nop 2
v_pk_add_f32 v[116:117],v[116:117],v[118:119]
v_cvt_pk_bf16_f32 v126,v112,v113
v_cvt_pk_bf16_f32 v127,v116,v117
v_add_u32 v52,s50,v5
v_add_u32 v54,s50,v6
ds_read_b64_tr_b16 v[52:53],v52
ds_read_b64_tr_b16 v[54:55],v54
v_mov_b32_dpp v124,v126 quad_perm:[2,3,2,3] row_mask:0xf bank_mask:0xf
v_mov_b32_dpp v125,v127 quad_perm:[2,3,2,3] row_mask:0xf bank_mask:0xf
s_mov_b32 vcc_lo,0xcccccccc
s_mov_b32 vcc_hi,0xcccccccc
s_waitcnt lgkmcnt(0)
v_cndmask_b32 v124,v124,v52,vcc
v_cndmask_b32 v125,v125,v53,vcc
v_cndmask_b32 v126,v126,v54,vcc
v_cndmask_b32 v127,v127,v55,vcc
buffer_store_dwordx4 v[124:127],v0,s[8:11],s54 offen sc1
s_mov_b32 s51,64
s_waitcnt vmcnt(0)
s_barrier
s_nop 11
v_lshrrev_b32 v1,4,v0
s_endpgm
L_rc2_157:
v_and_b32 v120,15,v1
v_lshrrev_b32 v121,4,v1
v_and_b32 v122,2,v1
v_cmp_eq_u32 vcc,0,v122
v_mov_b32 v2,0xeeee
v_mov_b32 v123,0x4444
v_cndmask_b32 v2,v2,v123,vcc
v_and_b32 v122,1,v1
v_cmp_eq_u32 vcc,0,v122
v_mov_b32 v3,0xdddd
v_mov_b32 v123,0x8888
v_cndmask_b32 v3,v3,v123,vcc
v_lshrrev_b32 v122,1,v120
v_bfe_u32 v123,v120,2,1
v_xor_b32 v123,v123,v122
v_lshlrev_b32 v4,7,v123
v_and_b32 v123,1,v120
v_lshl_add_u32 v4,v123,6,v4
v_xor_b32 v123,v121,v122
v_and_b32 v123,3,v123
v_lshl_add_u32 v4,v123,4,v4
s_lshl_b32 s56,s46,10
s_add_u32 s56,s56,147456
v_add_u32 v4,s56,v4
v_lshlrev_b32 v122,1,v121
v_add_u32 v122,0,v122
v_and_b32 v123,1,v121
v_xor_b32 v123,v123,v122
v_lshlrev_b32 v5,7,v123
v_bfe_u32 v123,v120,3,1
v_lshl_add_u32 v5,v123,6,v5
v_xor_b32 v123,v120,v122
v_and_b32 v123,3,v123
v_lshl_add_u32 v5,v123,4,v5
v_bfe_u32 v123,v120,2,1
v_lshl_add_u32 v5,v123,3,v5
v_add_u32 v5,147456,v5
v_lshlrev_b32 v122,1,v121
v_add_u32 v122,1,v122
v_and_b32 v123,1,v121
v_xor_b32 v123,v123,v122
v_lshlrev_b32 v6,7,v123
v_bfe_u32 v123,v120,3,1
v_lshl_add_u32 v6,v123,6,v6
v_xor_b32 v123,v120,v122
v_and_b32 v123,3,v123
v_lshl_add_u32 v6,v123,4,v6
v_bfe_u32 v123,v120,2,1
v_lshl_add_u32 v6,v123,3,v6
v_add_u32 v6,147456,v6
v_lshlrev_b32 v7,7,v121
v_lshrrev_b32 v122,1,v120
v_lshl_add_u32 v8,v122,4,v7
v_add_u32 v8,151552,v8
v_lshrrev_b32 v122,2,v120
v_lshl_add_u32 v7,v122,5,v7
v_and_b32 v122,1,v120
v_lshl_add_u32 v7,v122,4,v7
v_and_b32 v122,2,v120
v_cmp_eq_u32 vcc,0,v122
s_lshl_b32 s56,s46,9
v_mov_b32 v122,2048
v_mov_b32 v123,s56
v_cndmask_b32 v122,v122,v123,vcc
v_add_u32 v7,v122,v7
v_add_u32 v7,151552,v7
v_lshrrev_b32 v122,3,v1
v_lshlrev_b32 v9,11,v122
v_and_b32 v122,7,v1
v_lshl_add_u32 v9,v122,3,v9
s_lshl_b32 s56,s46,14
s_lshl_b32 s57,s47,6
s_add_u32 s56,s56,s57
v_add_u32 v9,s56,v9
s_lshl_b32 s71,s46,5
s_add_u32 s71,s71,s47
s_bfe_u32 s56,s71,0x10003
s_lshl_b32 s56,s56,11
s_and_b32 s57,s71,1
s_lshl_b32 s57,s57,10
s_add_u32 s56,s56,s57
s_bfe_u32 s57,s71,0x10002
s_lshl_b32 s57,s57,9
s_add_u32 s56,s56,s57
s_bfe_u32 s57,s71,0x10001
s_lshl_b32 s57,s57,6
s_add_u32 s56,s56,s57
s_bfe_u32 s57,s71,0x10004
s_lshl_b32 s57,s57,8
s_add_u32 s56,s56,s57
s_bfe_u32 s57,s71,0x10005
s_lshl_b32 s57,s57,7
s_add_u32 s56,s56,s57
s_bfe_u32 s57,s71,0x10006
s_lshl_b32 s57,s57,12
s_add_u32 s56,s56,s57
v_and_b32 v122,3,v120
v_lshlrev_b32 v10,2,v122
v_bfe_u32 v122,v120,3,1
v_lshl_add_u32 v10,v122,4,v10
v_and_b32 v122,1,v121
v_lshl_add_u32 v10,v122,5,v10
v_add_u32 v10,s56,v10
v_and_b32 v123,36,v1
v_mov_b32 v122,0x80000000
v_cmp_eq_u32 vcc,0,v123
s_nop 1
v_cndmask_b32 v10,v122,v10,vcc
s_lshl_b32 s71,s71,11
s_lshl_b32 s73,s46,11
s_mov_b32 s72,0xffc00000
s_mov_b32 s74,0
v_and_b32 v11,1,v121
v_xor_b32 v11,v11,v120
v_and_b32 v11,3,v11
v_lshrrev_b32 v122,2,v120
v_lshl_add_u32 v11,v11,2,v122
v_lshl_add_u32 v11,v121,4,v11
v_lshlrev_b32 v11,4,v11
s_lshl_b32 s56,s46,15
v_add_u32 v11,s56,v11
v_lshrrev_b32 v13,3,v1
v_lshlrev_b32 v13,9,v13
v_and_b32 v122,7,v1
v_lshl_add_u32 v13,v122,4,v13
v_and_b32 v122,15,v1
v_and_b32 v123,1,v1
v_lshlrev_b32 v123,4,v123
v_mov_b32 v124,0x3f80
v_lshlrev_b32 v124,v123,v124
v_lshrrev_b32 v122,1,v122
v_cmp_eq_u32 vcc,0,v122
s_nop 1
v_cndmask_b32 v18,0,v124,vcc
v_cmp_eq_u32 vcc,1,v122
s_nop 1
v_cndmask_b32 v19,0,v124,vcc
v_cmp_eq_u32 vcc,2,v122
s_nop 1
v_cndmask_b32 v20,0,v124,vcc
v_cmp_eq_u32 vcc,3,v122
s_nop 1
v_cndmask_b32 v21,0,v124,vcc
s_and_b32 s56,s46,1
s_lshl_b32 s56,s56,8
s_and_b32 s57,s46,2
s_lshl_b32 s57,s57,6
s_add_u32 s56,s56,s57
v_add_u32 v13,s56,v13
s_add_u32 s56,s50,155648
v_add_u32 v12,s56,v0
v_mov_b64 v[14:15],s[28:29]
v_mov_b64 v[16:17],s[28:29]
v_add_u32 v22,13647872,v10
s_lshl_b32 s18,s47,2
s_add_u32 s18,s18,10494080
v_mov_b32 v1,s80
s_mov_b32 s65,16777216
s_add_u32 s66,s71,16777216
s_add_u32 s69,s71,17039360
s_mov_b32 s30,0x40000000
s_mov_b32 s51,0
v_lshrrev_b32 v120,2,v0
v_add_u32 v120,10510464,v120
v_or_b32 v120,s52,v120
s_mov_b64 vcc,-1
s_mov_b32 vcc_lo,0
v_cndmask_b32 v22,v22,v120,vcc
s_or_b32 s56,s52,10495616
v_writelane_b32 v22,s56,4
s_or_b32 s56,s47,s46
s_mov_b32 s56,10486784
s_cmov_b32 s56,0x80000000
v_writelane_b32 v22,s56,5
s_mov_b32 s30,0
s_mov_b32 s31,0
buffer_load_dwordx4 v[88:91],v0,s[8:11],s66 offen offset:0
buffer_load_dwordx4 v[88:91],v0,s[8:11],s66 offen offset:1024
buffer_load_dwordx4 v[88:91],v0,s[8:11],s69 offen offset:0
buffer_load_dwordx4 v[88:91],v0,s[8:11],s69 offen offset:1024
s_waitcnt vmcnt(0)
L_cst_211:
s_cmp_lg_u32 s46,0
s_cbranch_scc1 L_csw_216
s_andn2_b32 s61,0x7ff,s30
s_lshr_b32 s61,s61,5
s_add_u32 s61,s61,2
s_add_u32 s60,s31,1
s_min_u32 s60,s60,63
s_cmp_gt_u32 s60,s61
s_cselect_b32 s60,s31,s60
s_sub_u32 s61,s60,s31
s_lshl_b32 s61,s61,13
s_lshl_b32 s59,s31,13
s_add_u32 s59,s59,10486016
v_lshrrev_b32 v121,2,v0
v_and_b32 v121,127,v121
v_lshrrev_b32 v120,9,v0
v_mul_u32_u24 v120,s61,v120
v_add_u32 v121,v120,v121
L_ckk_217:
s_sleep 1
buffer_load_dword v120,v121,s[8:11],s59 offen sc1
s_sub_u32 s49,s49,1
s_cbranch_scc1 L_abort
s_waitcnt vmcnt(0)
v_cmp_eq_u32 vcc,0,v120
s_cbranch_vccnz L_ckk_217
v_max_u32_dpp v120,v120,v120 row_ror:8 row_mask:0xf bank_mask:0xf
s_nop 1
v_max_u32_dpp v120,v120,v120 row_ror:4 row_mask:0xf bank_mask:0xf
s_nop 1
v_max_u32_dpp v120,v120,v120 row_ror:2 row_mask:0xf bank_mask:0xf
s_nop 1
v_max_u32_dpp v120,v120,v120 row_ror:1 row_mask:0xf bank_mask:0xf
v_mov_b32 v121,v120
s_nop 1
v_permlane16_swap_b32 v120,v121
v_max_u32 v120,v120,v121
v_mov_b32 v121,v120
s_nop 1
v_permlane32_swap_b32 v120,v121
v_max_u32 v120,v120,v121
s_nop 0
v_readfirstlane_b32 s61,v120
s_max_u32 s30,s30,s61
s_add_u32 s31,s60,1
s_andn2_b32 s51,0x7ff,s30
s_lshr_b32 s51,s51,5
s_add_u32 s61,s51,2
s_min_u32 s61,s61,63
s_cmp_le_u32 s31,s61
s_cbranch_scc1 L_cst_211
v_mov_b32 v120,0
v_mov_b32 v121,s30
ds_write_b32 v8,v120 offset:2560
ds_write_b32 v8,v121 offset:3072
s_lshl_b32 s59,s51,13
s_lshl2_add_u32 s59,s47,s59
s_add_u32 s59,s59,10485888
L_ww_218:
s_sleep 1
buffer_load_dword v122,off,s[8:11],s59 sc1
s_sub_u32 s49,s49,1
s_cbranch_scc1 L_abort
s_waitcnt vmcnt(0)
v_readfirstlane_b32 s61,v122
s_cmp_eq_u32 s61,0
s_cbranch_scc1 L_ww_218
L_wwd_219:
L_csw_216:
s_waitcnt lgkmcnt(0)
s_barrier
ds_read_b32 v120,v8 offset:3072
s_waitcnt lgkmcnt(0)
v_readfirstlane_b32 s30,v120
s_andn2_b32 s51,0x7ff,s30
s_lshr_b32 s51,s51,5
s_lshl_b32 s56,s51,5
s_add_u32 s56,s56,s47
s_mul_i32 s56,s56,24576
s_add_u32 s56,s56,150994944
s_add_u32 s67,s56,s73
s_add_u32 m0,s73,131072
s_add_u32 s57,s67,8192
buffer_load_dwordx4 v0,s[8:11],s67 offen sc1 lds
buffer_load_dwordx4 v0,s[8:11],s67 offen offset:1024 sc1 lds
s_add_u32 m0,s73,139264
s_add_u32 s67,s67,786432
buffer_load_dwordx4 v0,s[8:11],s57 offen sc1 lds
buffer_load_dwordx4 v0,s[8:11],s57 offen offset:1024 sc1 lds
s_lshl_b32 s75,s51,13
s_add_u32 s56,s75,13639680
buffer_load_dword v23,v10,s[8:11],s56 offen sc1
s_add_u32 s64,s75,17825792
s_add_u32 s70,s64,4096
s_lshl_b32 s68,s51,5
s_add_u32 s68,s68,s47
s_lshl_b32 s68,s68,12
s_lshl_b32 s56,s46,10
s_add_u32 s68,s68,s56
s_add_u32 s68,s68,75497472
s_mov_b32 s54,0x80000000
s_mov_b32 s77,0
s_add_u32 s56,s18,s75
s_buffer_load_dword s19,s[8:11],s56
s_cmp_eq_u32 s51,63
s_cselect_b32 s76,1,s46
s_cmp_eq_u32 s76,0
s_cselect_b32 s76,1,0
v_mov_b64 v[96:97],0
v_mov_b64 v[98:99],0
v_mov_b64 v[100:101],0
v_mov_b64 v[102:103],0
v_mov_b64 v[104:105],0
v_mov_b64 v[106:107],0
v_mov_b64 v[108:109],0
v_mov_b64 v[110:111],0
v_mov_b64 v[112:113],0
v_mov_b64 v[114:115],0
v_mov_b64 v[116:117],0
v_mov_b64 v[118:119],0
v_lshrrev_b32 v56,8,v0
v_lshlrev_b32 v56,5,v56
v_bfe_u32 v57,v0,5,1
v_lshl_add_u32 v56,v57,2,v56
s_lshl_b32 s56,s46,7
s_add_u32 s56,s56,155648
v_add_u32 v56,s56,v56
v_xor_b32 v57,128,v56
v_xor_b32 v58,256,v56
v_xor_b32 v59,384,v56
s_andn2_b32 s56,31,s30
s_lshr_b32 s57,s56,4
s_lshl_b32 s58,s57,12
s_and_b32 s59,s56,15
s_lshl4_add_u32 s58,s59,s58
s_add_u32 s58,s58,s50
s_add_u32 s58,s58,131072
v_bfe_u32 v60,v0,6,2
v_lshlrev_b32 v60,8,v60
v_bfe_u32 v61,v0,4,2
v_lshl_add_u32 v60,v61,2,v60
v_add_u32 v60,s58,v60
s_lshr_b32 s58,s59,2
s_lshl_b32 s58,s58,8
s_lshl3_add_u32 s58,s57,s58
s_and_b32 s59,s56,3
s_lshl1_add_u32 s58,s59,s58
s_add_u32 s58,s58,s73
s_add_u32 s58,s58,139264
v_and_b32 v61,255,v0
v_add_u32 v61,s58,v61
s_cmp_lg_u32 s46,0
s_cbranch_scc1 L_chd_221
s_lshl_b32 s59,s51,10
s_add_u32 s59,s59,11337728
L_chp_220:
buffer_load_dwordx4 v[120:123],v0,s[8:11],s59 offen sc1
s_sub_u32 s49,s49,1
s_cbranch_scc1 L_abort
s_waitcnt vmcnt(0)
v_max3_u32 v124,v120,v121,v122
v_max_u32 v124,v123,v124
v_cmp_eq_u32 vcc,-1,v124
s_cbranch_vccnz L_chp_220
ds_write_b128 v12,v[120:123]
L_chd_221:
s_waitcnt vmcnt(0) lgkmcnt(0)
s_barrier
ds_read2_b32 v[24:25],v56 offset0:0 offset1:2
ds_read2_b32 v[26:27],v56 offset0:4 offset1:6
ds_read2_b32 v[28:29],v57 offset0:0 offset1:2
ds_read2_b32 v[30:31],v57 offset0:4 offset1:6
ds_read2_b32 v[32:33],v58 offset0:0 offset1:2
ds_read2_b32 v[34:35],v58 offset0:4 offset1:6
ds_read2_b32 v[36:37],v59 offset0:0 offset1:2
ds_read2_b32 v[38:39],v59 offset0:4 offset1:6
s_waitcnt lgkmcnt(4)
ds_read2_b32 v[40:41],v56 offset0:128 offset1:130
ds_read2_b32 v[42:43],v56 offset0:132 offset1:134
ds_read2_b32 v[44:45],v57 offset0:128 offset1:130
ds_read2_b32 v[46:47],v57 offset0:132 offset1:134
ds_read2_b32 v[48:49],v58 offset0:128 offset1:130
ds_read2_b32 v[50:51],v58 offset0:132 offset1:134
ds_read2_b32 v[52:53],v59 offset0:128 offset1:130
ds_read2_b32 v[54:55],v59 offset0:132 offset1:134
s_waitcnt lgkmcnt(12)
v_smfmac_f32_16x16x64_bf16 v[100:103],v[24:27],a[128:135],v2
v_smfmac_f32_16x16x64_bf16 v[112:115],v[24:27],v[128:135],v2
v_smfmac_f32_16x16x64_bf16 v[108:111],v[24:27],a[136:143],v2
v_smfmac_f32_16x16x64_bf16 v[116:119],v[24:27],v[136:143],v2
s_waitcnt lgkmcnt(12)
v_smfmac_f32_16x16x64_bf16 v[100:103],v[28:31],a[144:151],v2
v_smfmac_f32_16x16x64_bf16 v[112:115],v[28:31],v[144:151],v2
v_smfmac_f32_16x16x64_bf16 v[108:111],v[28:31],a[152:159],v2
v_smfmac_f32_16x16x64_bf16 v[116:119],v[28:31],v[152:159],v2
s_waitcnt lgkmcnt(10)
v_smfmac_f32_16x16x64_bf16 v[100:103],v[32:35],a[160:167],v2
v_smfmac_f32_16x16x64_bf16 v[112:115],v[32:35],v[160:167],v2
v_smfmac_f32_16x16x64_bf16 v[108:111],v[32:35],a[168:175],v2
v_smfmac_f32_16x16x64_bf16 v[116:119],v[32:35],v[168:175],v2
s_waitcnt lgkmcnt(8)
v_smfmac_f32_16x16x64_bf16 v[100:103],v[36:39],a[176:183],v2
v_smfmac_f32_16x16x64_bf16 v[112:115],v[36:39],v[176:183],v2
v_smfmac_f32_16x16x64_bf16 v[108:111],v[36:39],a[184:191],v2
v_smfmac_f32_16x16x64_bf16 v[116:119],v[36:39],v[184:191],v2
s_waitcnt lgkmcnt(6)
v_smfmac_f32_16x16x64_bf16 v[100:103],v[40:43],a[192:199],v2
v_smfmac_f32_16x16x64_bf16 v[112:115],v[40:43],v[192:199],v2
v_smfmac_f32_16x16x64_bf16 v[108:111],v[40:43],a[200:207],v2
v_smfmac_f32_16x16x64_bf16 v[116:119],v[40:43],v[200:207],v2
s_waitcnt lgkmcnt(4)
v_smfmac_f32_16x16x64_bf16 v[100:103],v[44:47],a[208:215],v2
v_smfmac_f32_16x16x64_bf16 v[112:115],v[44:47],v[208:215],v2
v_smfmac_f32_16x16x64_bf16 v[108:111],v[44:47],a[216:223],v2
v_smfmac_f32_16x16x64_bf16 v[116:119],v[44:47],v[216:223],v2
s_waitcnt lgkmcnt(2)
v_smfmac_f32_16x16x64_bf16 v[100:103],v[48:51],a[224:231],v2
v_smfmac_f32_16x16x64_bf16 v[112:115],v[48:51],v[224:231],v2
v_smfmac_f32_16x16x64_bf16 v[108:111],v[48:51],a[232:239],v2
v_smfmac_f32_16x16x64_bf16 v[116:119],v[48:51],v[232:239],v2
s_waitcnt lgkmcnt(0)
v_smfmac_f32_16x16x64_bf16 v[100:103],v[52:55],a[240:247],v2
v_smfmac_f32_16x16x64_bf16 v[112:115],v[52:55],v[240:247],v2
v_smfmac_f32_16x16x64_bf16 v[108:111],v[52:55],a[248:255],v2
v_smfmac_f32_16x16x64_bf16 v[116:119],v[52:55],v[248:255],v2
v_add_f32 v100,v100,v102
v_add_f32 v112,v112,v114
s_nop 1
v_add_f32 v108,v108,v110
s_nop 2
v_add_f32 v116,v116,v118
v_cvt_pk_bf16_f32 v120,v100,v108
v_cvt_pk_bf16_f32 v121,v112,v116
ds_write_b32 v60,v120
ds_write_b16 v61,v121
ds_write_b16_d16_hi v61,v121 offset:1024
v_mov_b64 v[96:97],0
v_mov_b64 v[98:99],0
v_mov_b64 v[100:101],0
v_mov_b64 v[102:103],0
v_mov_b64 v[104:105],0
v_mov_b64 v[106:107],0
v_mov_b64 v[108:109],0
v_mov_b64 v[110:111],0
v_mov_b64 v[112:113],0
v_mov_b64 v[114:115],0
v_mov_b64 v[116:117],0
v_mov_b64 v[118:119],0
s_waitcnt vmcnt(0) lgkmcnt(0)
s_barrier
v_add_u32 v55,131072,v0
ds_read_b128 v[56:59],v55 offset:0
ds_read_b128 v[60:63],v55 offset:4096
ds_read_b128 v[64:67],v55 offset:1024
ds_read_b128 v[68:71],v55 offset:5120
ds_read_b128 v[72:75],v55 offset:2048
ds_read_b128 v[76:79],v55 offset:6144
ds_read_b128 v[80:83],v55 offset:3072
ds_read_b128 v[84:87],v55 offset:7168
v_add_u32 v123,s73,v55
ds_read_b128 v[88:91],v123 offset:8192
ds_read_b128 v[92:95],v123 offset:9216
v_xor_b32 v120,1024,v12
v_xor_b32 v121,2048,v12
v_xor_b32 v122,3072,v12
buffer_load_dwordx4 v[24:27],v13,s[8:11],s64 offen sc1
buffer_load_dwordx4 v[24:27],v13,s[8:11],s64 offen sc1
L_chain_222:
L_cpa_223:
buffer_load_dwordx4 v[24:27],v13,s[8:11],s64 offen sc1
s_sub_u32 s49,s49,1
s_cbranch_scc1 L_abort
s_waitcnt vmcnt(2)
v_max3_u32 v123,v24,v25,v26
v_max_u32 v123,v27,v123
v_cmp_le_u32 vcc,s72,v123
ds_write_b128 v12,v[24:27] offset:0
s_cbranch_vccnz L_cpa_223
L_cgo_226:
v_smfmac_f32_16x16x64_bf16 v[96:99],v[24:27],a[0:7],v2
buffer_load_dwordx4 v[40:43],v13,s[8:11],s70 offen sc1
v_smfmac_f32_16x16x64_bf16 v[100:103],v[24:27],a[128:135],v2
s_waitcnt lgkmcnt(0)
s_barrier
ds_read_b128 v[28:31],v120 offset:0
v_smfmac_f32_16x16x64_bf16 v[104:107],v[24:27],a[8:15],v2
ds_read_b128 v[32:35],v121 offset:0
v_smfmac_f32_16x16x64_bf16 v[108:111],v[24:27],a[136:143],v2
ds_read_b128 v[36:39],v122 offset:0
v_smfmac_f32_16x16x64_bf16 v[112:115],v[24:27],v[128:135],v2
v_smfmac_f32_16x16x64_bf16 v[116:119],v[24:27],v[136:143],v2
s_waitcnt lgkmcnt(2)
v_smfmac_f32_16x16x64_bf16 v[96:99],v[28:31],a[16:23],v2
s_add_u32 m0,s73,131072
v_smfmac_f32_16x16x64_bf16 v[100:103],v[28:31],a[144:151],v2
s_add_u32 s57,s67,8192
v_smfmac_f32_16x16x64_bf16 v[104:107],v[28:31],a[24:31],v2
s_cmp_lt_u32 s19,s76
s_cbranch_scc1 L_ckw_212
L_ckb_213:
v_smfmac_f32_16x16x64_bf16 v[108:111],v[28:31],a[152:159],v2
s_waitcnt vmcnt(0) lgkmcnt(1)
v_smfmac_f32_16x16x64_bf16 v[96:99],v[32:35],a[32:39],v2
ds_write_b128 v12,v[40:43] offset:4096
v_max3_u32 v123,v40,v41,v42
v_smfmac_f32_16x16x64_bf16 v[100:103],v[32:35],a[160:167],v2
v_max_u32 v123,v43,v123
v_smfmac_f32_16x16x64_bf16 v[104:107],v[32:35],a[40:47],v2
v_cmp_le_u32 vcc,s72,v123
v_smfmac_f32_16x16x64_bf16 v[108:111],v[32:35],a[168:175],v2
v_smfmac_f32_16x16x64_bf16 v[112:115],v[28:31],v[144:151],v2
s_cbranch_vccnz L_cpb_229
L_cback_231:
s_waitcnt lgkmcnt(0)
s_barrier
v_smfmac_f32_16x16x64_bf16 v[96:99],v[36:39],a[48:55],v2
buffer_store_dwordx4 v[124:127],v0,s[8:11],s54 offen sc1
v_smfmac_f32_16x16x64_bf16 v[100:103],v[36:39],a[176:183],v2
ds_read_b128 v[44:47],v120 offset:4096
v_smfmac_f32_16x16x64_bf16 v[104:107],v[36:39],a[56:63],v2
buffer_load_dwordx4 v0,s[8:11],s67 offen sc1 lds
v_smfmac_f32_16x16x64_bf16 v[108:111],v[36:39],a[184:191],v2
ds_read_b128 v[48:51],v121 offset:4096
v_smfmac_f32_16x16x64_bf16 v[96:99],v[40:43],a[64:71],v2
buffer_load_dwordx4 v0,s[8:11],s67 offen offset:1024 sc1 lds
s_add_u32 m0,s73,139264
v_smfmac_f32_16x16x64_bf16 v[100:103],v[40:43],a[192:199],v2
ds_read_b128 v[52:55],v122 offset:4096
v_smfmac_f32_16x16x64_bf16 v[104:107],v[40:43],a[72:79],v2
buffer_load_dwordx4 v0,s[8:11],s57 offen sc1 lds
s_add_u32 s67,s67,786432
v_smfmac_f32_16x16x64_bf16 v[108:111],v[40:43],a[200:207],v2
ds_read_b32 v123,v8 offset:2560
s_waitcnt lgkmcnt(3)
v_smfmac_f32_16x16x64_bf16 v[96:99],v[44:47],a[80:87],v2
buffer_load_dwordx4 v0,s[8:11],s57 offen offset:1024 sc1 lds
v_smfmac_f32_16x16x64_bf16 v[100:103],v[44:47],a[208:215],v2
s_waitcnt lgkmcnt(2)
v_smfmac_f32_16x16x64_bf16 v[96:99],v[48:51],a[96:103],v2
buffer_load_dword v23,v22,s[8:11],s75 offen sc1
v_smfmac_f32_16x16x64_bf16 v[100:103],v[48:51],a[224:231],v2
s_waitcnt lgkmcnt(0)
v_smfmac_f32_16x16x64_bf16 v[96:99],v[52:55],a[112:119],v2
v_smfmac_f32_16x16x64_bf16 v[100:103],v[52:55],a[240:247],v2
v_readfirstlane_b32 s58,v123
v_smfmac_f32_16x16x64_bf16 v[104:107],v[44:47],a[88:95],v2
v_smfmac_f32_16x16x64_bf16 v[108:111],v[44:47],a[216:223],v2
s_cmp_lg_u32 s58,0
s_cbranch_scc1 L_cjump_215
v_smfmac_f32_16x16x64_bf16 v[104:107],v[48:51],a[104:111],v2
v_add_f32 v96,v96,v98
v_smfmac_f32_16x16x64_bf16 v[108:111],v[48:51],a[232:239],v2
v_add_f32 v97,v97,v99
v_smfmac_f32_16x16x64_bf16 v[104:107],v[52:55],a[120:127],v2
v_cvt_pk_bf16_f32 v120,v96,v97
v_smfmac_f32_16x16x64_bf16 v[108:111],v[52:55],a[248:255],v2
v_add_f32 v100,v100,v102
v_smfmac_f32_16x16x64_bf16 v[116:119],v[28:31],v[152:159],v2
v_add_f32 v101,v101,v103
v_smfmac_f32_16x16x64_bf16 v[112:115],v[32:35],v[160:167],v2
v_cvt_pk_bf16_f32 v121,v100,v101
v_add_f32 v104,v104,v106
v_add_f32 v105,v105,v107
v_cvt_pk_bf16_f32 v122,v104,v105
v_add_f32 v108,v108,v110
v_add_f32 v109,v109,v111
v_cvt_pk_bf16_f32 v123,v108,v109
ds_write_b128 v4,v[120:123]
v_smfmac_f32_16x16x64_bf16 v[116:119],v[32:35],v[168:175],v2
s_mov_b32 s54,s68
s_add_u32 s68,s68,131072
v_mov_b32 v125,0
v_smfmac_f32_16x16x64_bf16 v[112:115],v[36:39],v[176:183],v2
s_cmp_eq_u32 s51,63
s_cbranch_scc1 L_cend_225
v_smfmac_f32_16x16x64_bf16 v[116:119],v[36:39],v[184:191],v2
v_smfmac_f32_16x16x64_bf16 v[112:115],v[40:43],v[192:199],v2
s_waitcnt lgkmcnt(0)
s_barrier
ds_read_b64_tr_b16 v[96:97],v5 offset:0
ds_read_b64_tr_b16 v[98:99],v6 offset:0
v_smfmac_f32_16x16x64_bf16 v[116:119],v[40:43],v[200:207],v2
ds_read_b64_tr_b16 v[100:101],v5 offset:1024
v_smfmac_f32_16x16x64_bf16 v[112:115],v[44:47],v[208:215],v2
ds_read_b64_tr_b16 v[102:103],v6 offset:1024
v_smfmac_f32_16x16x64_bf16 v[116:119],v[44:47],v[216:223],v2
ds_read_b64_tr_b16 v[104:105],v5 offset:2048
v_smfmac_f32_16x16x64_bf16 v[112:115],v[48:51],v[224:231],v2
ds_read_b64_tr_b16 v[106:107],v6 offset:2048
s_waitcnt lgkmcnt(4)
v_mfma_f32_16x16x32_bf16 v[24:27],v[56:59],v[96:99],0
ds_read_b64_tr_b16 v[108:109],v5 offset:3072
v_mfma_f32_16x16x32_bf16 v[28:31],v[60:63],v[96:99],0
ds_read_b64_tr_b16 v[110:111],v6 offset:3072
v_mfma_f32_16x16x32_bf16 v[32:35],v[96:99],v[96:99],0
ds_read_b128 v[40:43],v11 offset:12288
s_waitcnt lgkmcnt(5)
v_mfma_f32_16x16x32_bf16 v[24:27],v[64:67],v[100:103],v[24:27]
ds_read_b128 v[56:59],v11 offset:0
v_mfma_f32_16x16x32_bf16 v[28:31],v[68:71],v[100:103],v[28:31]
ds_read_b128 v[60:63],v11 offset:1024
v_mfma_f32_16x16x32_bf16 v[32:35],v[100:103],v[100:103],v[32:35]
ds_read_b128 v[96:99],v11 offset:8192
s_waitcnt lgkmcnt(6)
v_mfma_f32_16x16x32_bf16 v[24:27],v[72:75],v[104:107],v[24:27]
ds_read_b128 v[64:67],v11 offset:2048
v_mfma_f32_16x16x32_bf16 v[28:31],v[76:79],v[104:107],v[28:31]
ds_read_b128 v[68:71],v11 offset:3072
v_mfma_f32_16x16x32_bf16 v[32:35],v[104:107],v[104:107],v[32:35]
ds_read_b128 v[100:103],v11 offset:9216
s_waitcnt lgkmcnt(7)
v_mfma_f32_16x16x32_bf16 v[24:27],v[80:83],v[108:111],v[24:27]
ds_read_b128 v[72:75],v11 offset:4096
v_mfma_f32_16x16x32_bf16 v[28:31],v[84:87],v[108:111],v[28:31]
ds_read_b128 v[76:79],v11 offset:5120
v_mfma_f32_16x16x32_bf16 v[32:35],v[108:111],v[108:111],v[32:35]
ds_read_b128 v[104:107],v11 offset:10240
v_smfmac_f32_16x16x64_bf16 v[116:119],v[48:51],v[232:239],v2
ds_read_b128 v[80:83],v11 offset:6144
v_smfmac_f32_16x16x64_bf16 v[112:115],v[52:55],v[240:247],v2
ds_read_b128 v[84:87],v11 offset:7168
v_smfmac_f32_16x16x64_bf16 v[116:119],v[52:55],v[248:255],v2
ds_read_b128 v[108:111],v11 offset:11264
v_max3_f32 v126,v24,v25,v26
v_max3_f32 v127,v27,v28,v29
v_max3_f32 v126,v30,v31,v126
v_max3_f32 v127,v34,v35,v127
v_max_f32 v126,v126,v127
v_max_f32 v127,v126,v127
v_pk_mul_f32 v[34:35],v[34:35],v[0:1] op_sel:[0,1]
v_pk_mul_f32 v[24:25],v[24:25],v[0:1] op_sel:[0,1]
v_permlane16_swap_b32 v126,v127
v_max_f32 v126,v126,v127
v_max_f32 v127,v126,v127
v_pk_mul_f32 v[26:27],v[26:27],v[0:1] op_sel:[0,1]
v_pk_mul_f32 v[28:29],v[28:29],v[0:1] op_sel:[0,1]
v_permlane32_swap_b32 v126,v127
v_max_f32 v126,v126,v127
v_mul_f32 v126,v1,v126
v_pk_mul_f32 v[30:31],v[30:31],v[0:1] op_sel:[0,1]
v_pk_add_f32 v[34:35],v[34:35],v[126:127] op_sel_hi:[1,0] neg_lo:[0,1] neg_hi:[0,1]
v_pk_add_f32 v[112:113],v[112:113],v[114:115]
v_pk_add_f32 v[116:117],v[116:117],v[118:119]
v_pk_add_f32 v[24:25],v[24:25],v[126:127] op_sel_hi:[1,0] neg_lo:[0,1] neg_hi:[0,1]
v_pk_add_f32 v[26:27],v[26:27],v[126:127] op_sel_hi:[1,0] neg_lo:[0,1] neg_hi:[0,1]
v_pk_add_f32 v[28:29],v[28:29],v[126:127] op_sel_hi:[1,0] neg_lo:[0,1] neg_hi:[0,1]
v_pk_add_f32 v[30:31],v[30:31],v[126:127] op_sel_hi:[1,0] neg_lo:[0,1] neg_hi:[0,1]
v_exp_f32 v34,v34
v_exp_f32 v35,v35
v_cvt_pk_bf16_f32 v126,v112,v113
v_cvt_pk_bf16_f32 v124,v34,v35
v_cvt_pk_bf16_f32 v127,v116,v117
v_cvt_pk_bf16_f32 v36,v116,v117
v_mfma_f32_16x16x16_bf16 v[32:35],v[14:15],v[124:125],0
ds_read_b128 v[44:47],v11 offset:13312
v_exp_f32 v24,v24
v_mfma_f32_16x16x16_bf16 v[112:115],v[126:127],v[124:125],0
ds_read_b128 v[48:51],v11 offset:14336
v_exp_f32 v25,v25
v_mfma_f32_16x16x16_bf16 v[116:119],v[36:37],v[124:125],0
ds_read_b128 v[52:55],v11 offset:15360
v_exp_f32 v26,v26
v_exp_f32 v27,v27
v_cvt_pk_bf16_f32 v120,v24,v25
v_exp_f32 v28,v28
v_exp_f32 v29,v29
v_cvt_pk_bf16_f32 v121,v26,v27
v_exp_f32 v30,v30
v_exp_f32 v31,v31
v_cvt_pk_bf16_f32 v122,v28,v29
v_cvt_pk_bf16_f32 v123,v30,v31
s_add_u32 s75,s75,8192
s_add_u32 s51,s51,1
v_mfma_f32_16x16x32_bf16 v[32:35],v[14:17],v[120:123],v[32:35]
v_mfma_f32_16x16x32_bf16 v[112:115],v[88:91],v[120:123],v[112:115]
ds_read_b128 v[88:91],v11 offset:16384
v_mfma_f32_16x16x32_bf16 v[116:119],v[92:95],v[120:123],v[116:119]
ds_read_b128 v[92:95],v11 offset:17408
v_rcp_f32 v32,v32
v_mov_b64 v[24:25],-1
v_mov_b64 v[26:27],-1
s_add_u32 s64,s75,13631488
s_add_u32 s70,s64,4096
v_pk_mul_f32 v[112:113],v[112:113],v[32:33] op_sel_hi:[1,0]
v_pk_mul_f32 v[114:115],v[114:115],v[32:33] op_sel_hi:[1,0]
v_pk_mul_f32 v[116:117],v[116:117],v[32:33] op_sel_hi:[1,0]
v_pk_mul_f32 v[118:119],v[118:119],v[32:33] op_sel_hi:[1,0]
v_cvt_pk_bf16_f32 v120,v112,v116
v_cvt_pk_bf16_f32 v121,v113,v117
v_cvt_pk_bf16_f32 v122,v114,v118
v_cvt_pk_bf16_f32 v123,v115,v119
ds_write_b128 v7,v[120:123]
buffer_store_dwordx4 v[24:27],v0,s[8:11],s69 offen
buffer_store_dwordx4 v[24:27],v0,s[8:11],s69 offen offset:1024
v_mov_b64 v[112:113],0
v_mov_b64 v[114:115],0
v_mov_b64 v[116:117],0
v_mov_b64 v[118:119],0
s_waitcnt lgkmcnt(0)
s_barrier
ds_read_b128 v[24:27],v8 offset:0
ds_read_b128 v[28:31],v8 offset:512
ds_read_b128 v[32:35],v8 offset:1024
ds_read_b128 v[36:39],v8 offset:1536
v_mov_b64 v[120:121],0
v_mov_b64 v[122:123],0
s_add_u32 s57,s65,65536
s_add_u32 s58,s65,131072
s_add_u32 s59,s65,196608
s_add_u32 s56,s18,s75
s_waitcnt lgkmcnt(3)
v_smfmac_f32_16x16x64_bf16 v[112:115],v[24:27],v[56:63],v3
ds_read_b128 v[56:59],v11 offset:18432
s_waitcnt lgkmcnt(3)
v_smfmac_f32_16x16x64_bf16 v[112:115],v[28:31],v[64:71],v3
ds_read_b128 v[60:63],v11 offset:19456
s_waitcnt lgkmcnt(3)
v_smfmac_f32_16x16x64_bf16 v[112:115],v[32:35],v[72:79],v3
ds_read_b128 v[64:67],v11 offset:20480
s_waitcnt lgkmcnt(3)
v_smfmac_f32_16x16x64_bf16 v[112:115],v[36:39],v[80:87],v3
ds_read_b128 v[68:71],v11 offset:21504
v_smfmac_f32_16x16x64_bf16 v[116:119],v[24:27],v[96:103],v3
ds_read_b128 v[72:75],v11 offset:22528
v_smfmac_f32_16x16x64_bf16 v[116:119],v[28:31],v[104:111],v3
ds_read_b128 v[76:79],v11 offset:23552
v_cvt_pk_bf16_f32 v112,v112,v113
v_smfmac_f32_16x16x64_bf16 v[116:119],v[32:35],v[40:47],v3
ds_read_b128 v[80:83],v11 offset:24576
v_cvt_pk_bf16_f32 v113,v114,v115
buffer_store_dwordx2 v[112:113],v9,s[8:11],s65 offen
v_smfmac_f32_16x16x64_bf16 v[116:119],v[36:39],v[48:55],v3
ds_read_b128 v[84:87],v11 offset:25600
v_mov_b64 v[112:113],0
v_smfmac_f32_16x16x64_bf16 v[120:123],v[24:27],v[88:95],v3
ds_read_b128 v[96:99],v11 offset:26624
ds_read_b128 v[100:103],v11 offset:27648
v_mov_b64 v[114:115],0
s_waitcnt lgkmcnt(8)
v_smfmac_f32_16x16x64_bf16 v[120:123],v[28:31],v[56:63],v3
ds_read_b128 v[104:107],v11 offset:28672
v_cvt_pk_bf16_f32 v116,v116,v117
s_waitcnt lgkmcnt(7)
v_smfmac_f32_16x16x64_bf16 v[120:123],v[32:35],v[64:71],v3
ds_read_b128 v[108:111],v11 offset:29696
ds_read_b128 v[40:43],v11 offset:30720
v_cvt_pk_bf16_f32 v117,v118,v119
buffer_store_dwordx2 v[116:117],v9,s[8:11],s57 offen
s_waitcnt lgkmcnt(7)
v_smfmac_f32_16x16x64_bf16 v[120:123],v[36:39],v[72:79],v3
ds_read_b128 v[44:47],v11 offset:31744
v_add_u32 v52,s50,v5
s_waitcnt lgkmcnt(6)
v_smfmac_f32_16x16x64_bf16 v[112:115],v[24:27],v[80:87],v3
v_add_u32 v54,s50,v6
s_waitcnt lgkmcnt(4)
v_smfmac_f32_16x16x64_bf16 v[112:115],v[28:31],v[96:103],v3
ds_read_b64_tr_b16 v[52:53],v52
v_cvt_pk_bf16_f32 v120,v120,v121
s_waitcnt lgkmcnt(3)
v_smfmac_f32_16x16x64_bf16 v[112:115],v[32:35],v[104:111],v3
ds_read_b64_tr_b16 v[54:55],v54
v_cvt_pk_bf16_f32 v121,v122,v123
buffer_store_dwordx2 v[120:121],v9,s[8:11],s58 offen
s_waitcnt lgkmcnt(2)
v_smfmac_f32_16x16x64_bf16 v[112:115],v[36:39],v[40:47],v3
v_mov_b64 v[116:117],0
v_mov_b64 v[118:119],0
s_xor_b32 s65,s65,262144
v_mov_b32_dpp v124,v126 quad_perm:[2,3,2,3] row_mask:0xf bank_mask:0xf
v_mov_b32_dpp v125,v127 quad_perm:[2,3,2,3] row_mask:0xf bank_mask:0xf
s_mov_b32 vcc_lo,0xcccccccc
s_mov_b32 vcc_hi,0xcccccccc
s_nop 0
v_cvt_pk_bf16_f32 v112,v112,v113
v_cvt_pk_bf16_f32 v113,v114,v115
buffer_store_dwordx2 v[112:113],v9,s[8:11],s59 offen
s_waitcnt lgkmcnt(0)
s_buffer_load_dword s19,s[8:11],s56
v_cndmask_b32 v124,v124,v52,vcc
v_cndmask_b32 v125,v125,v53,vcc
v_cndmask_b32 v126,v126,v54,vcc
v_cndmask_b32 v127,v127,v55,vcc
s_cmp_lt_u32 s46,2
s_waitcnt vmcnt(3)
s_cbranch_scc1 L_crg_232
s_cmp_eq_u32 s46,2
s_waitcnt vmcnt(1)
s_cbranch_scc1 L_crg_232
s_waitcnt vmcnt(0)
L_crg_232:
buffer_load_dwordx4 v[32:35],v0,s[8:11],s66 offen offset:0 sc1
buffer_load_dwordx4 v[36:39],v0,s[8:11],s66 offen offset:1024 sc1
v_mov_b64 v[96:97],0
v_mov_b64 v[98:99],0
v_mov_b64 v[100:101],0
v_mov_b64 v[102:103],0
v_mov_b64 v[104:105],0
v_mov_b64 v[106:107],0
v_mov_b64 v[108:109],0
v_mov_b64 v[110:111],0
v_mov_b64 v[112:113],0
v_mov_b64 v[114:115],0
v_add_u32 v55,131072,v0
v_add_u32 v123,s73,v55
v_xor_b32 v120,1024,v12
v_xor_b32 v121,2048,v12
v_xor_b32 v122,3072,v12
buffer_load_dwordx4 v[44:47],v0,s[8:11],s66 offen offset:0 sc1
buffer_load_dwordx4 v[48:51],v0,s[8:11],s66 offen offset:1024 sc1
s_cmp_ge_u32 s51,63
s_cselect_b32 s76,0,1
v_readlane_b32 s56,v23,5
v_readlane_b32 s20,v23,4
v_add_u32 v23,-1,v23
v_cmp_le_u32 vcc,s30,v23
s_cmp_gt_u32 s51,61
s_cselect_b32 s77,0,vcc_hi
s_cmp_gt_u32 s20,s30
s_cselect_b32 s77,1,s77
s_cmp_lg_u32 s77,0
s_cselect_b32 s76,2,s76
s_cmp_gt_u32 s56,s30
s_cbranch_scc1 L_cld_208
L_clb_209:
s_cmp_eq_u32 s46,0
s_cselect_b32 s76,s76,0
s_waitcnt vmcnt(3)
v_mfma_f32_16x16x32_bf16 v[28:31],v[18:21],v[32:35],0
s_waitcnt vmcnt(2)
v_mfma_f32_16x16x32_bf16 v[28:31],v[18:21],v[36:39],v[28:31]
s_nop 7
v_cmp_u_f32 vcc,v28,v28
v_add_f32_dpp v52,v28,v28 row_ror:8 row_mask:0xf bank_mask:0x3
v_add_f32_dpp v53,v29,v29 row_ror:8 row_mask:0xf bank_mask:0x3
v_add_f32_dpp v52,v30,v30 row_ror:8 row_mask:0xf bank_mask:0xc
v_add_f32_dpp v53,v31,v31 row_ror:8 row_mask:0xf bank_mask:0xc
s_nop 0
v_add_f32_dpp v52,v52,v52 row_shl:4 row_mask:0xf bank_mask:0x5
v_add_f32_dpp v53,v53,v53 row_shl:4 row_mask:0xf bank_mask:0x5
s_cbranch_vccnz L_crp_227
L_cok_233:
v_cvt_pk_bf16_f32 v54,v52,v53
buffer_store_dword v54,v10,s[8:11],s64 offen
s_mov_b32 s69,s66
s_xor_b32 s66,s66,262144
s_barrier
ds_read_b128 v[56:59],v55 offset:0
ds_read_b128 v[60:63],v55 offset:4096
ds_read_b128 v[64:67],v55 offset:1024
buffer_load_dwordx4 v[24:27],v13,s[8:11],s64 offen sc1
ds_read_b128 v[68:71],v55 offset:5120
ds_read_b128 v[72:75],v55 offset:2048
ds_read_b128 v[76:79],v55 offset:6144
ds_read_b128 v[80:83],v55 offset:3072
buffer_load_dwordx4 v[24:27],v13,s[8:11],s64 offen sc1
ds_read_b128 v[84:87],v55 offset:7168
ds_read_b128 v[88:91],v123 offset:8192
ds_read_b128 v[92:95],v123 offset:9216
s_branch L_chain_222
L_cpb_229:
buffer_load_dwordx4 v[40:43],v13,s[8:11],s70 offen sc1
s_sub_u32 s49,s49,1
s_cbranch_scc1 L_abort
s_waitcnt vmcnt(0)
v_max3_u32 v123,v40,v41,v42
v_max_u32 v123,v43,v123
v_cmp_le_u32 vcc,s72,v123
s_cbranch_vccnz L_cpb_229
ds_write_b128 v12,v[40:43] offset:4096
s_branch L_cback_231
L_crp_227:
buffer_load_dwordx4 v[32:35],v0,s[8:11],s66 offen offset:0 sc1
buffer_load_dwordx4 v[36:39],v0,s[8:11],s66 offen offset:1024 sc1
s_sub_u32 s49,s49,1
s_cbranch_scc1 L_abort
s_waitcnt vmcnt(3)
v_mfma_f32_16x16x32_bf16 v[28:31],v[18:21],v[44:47],0
s_waitcnt vmcnt(2)
v_mfma_f32_16x16x32_bf16 v[28:31],v[18:21],v[48:51],v[28:31]
s_nop 7
v_cmp_u_f32 vcc,v28,v28
v_add_f32_dpp v52,v28,v28 row_ror:8 row_mask:0xf bank_mask:0x3
v_add_f32_dpp v53,v29,v29 row_ror:8 row_mask:0xf bank_mask:0x3
v_add_f32_dpp v52,v30,v30 row_ror:8 row_mask:0xf bank_mask:0xc
v_add_f32_dpp v53,v31,v31 row_ror:8 row_mask:0xf bank_mask:0xc
s_nop 0
v_add_f32_dpp v52,v52,v52 row_shl:4 row_mask:0xf bank_mask:0x5
v_add_f32_dpp v53,v53,v53 row_shl:4 row_mask:0xf bank_mask:0x5
s_cbranch_vccz L_cok_233
buffer_load_dwordx4 v[44:47],v0,s[8:11],s66 offen offset:0 sc1
buffer_load_dwordx4 v[48:51],v0,s[8:11],s66 offen offset:1024 sc1
s_sub_u32 s49,s49,1
s_cbranch_scc1 L_abort
s_waitcnt vmcnt(3)
v_mfma_f32_16x16x32_bf16 v[28:31],v[18:21],v[32:35],0
s_waitcnt vmcnt(2)
v_mfma_f32_16x16x32_bf16 v[28:31],v[18:21],v[36:39],v[28:31]
s_nop 7
v_cmp_u_f32 vcc,v28,v28
v_add_f32_dpp v52,v28,v28 row_ror:8 row_mask:0xf bank_mask:0x3
v_add_f32_dpp v53,v29,v29 row_ror:8 row_mask:0xf bank_mask:0x3
v_add_f32_dpp v52,v30,v30 row_ror:8 row_mask:0xf bank_mask:0xc
v_add_f32_dpp v53,v31,v31 row_ror:8 row_mask:0xf bank_mask:0xc
s_nop 0
v_add_f32_dpp v52,v52,v52 row_shl:4 row_mask:0xf bank_mask:0x5
v_add_f32_dpp v53,v53,v53 row_shl:4 row_mask:0xf bank_mask:0x5
s_cbranch_vccz L_cok_233
s_branch L_crp_227
L_ckw_212:
s_cmp_eq_u32 s77,0
s_cbranch_scc1 L_cjw_214
s_cmp_gt_u32 s20,s30
s_cbranch_scc1 L_cjs_210
s_add_u32 s31,s51,2
s_lshl_b32 s59,s31,13
s_add_u32 s59,s59,10486016
v_lshrrev_b32 v45,2,v0
v_and_b32 v45,127,v45
L_ckk_234:
s_sleep 1
buffer_load_dword v44,v45,s[8:11],s59 offen sc1
s_sub_u32 s49,s49,1
s_cbranch_scc1 L_abort
s_waitcnt vmcnt(0)
v_cmp_eq_u32 vcc,0,v44
s_cbranch_vccnz L_ckk_234
v_cmp_lt_u32 vcc,s30,v44
s_cbranch_vccz L_cjw_214
v_max_u32_dpp v44,v44,v44 row_ror:8 row_mask:0xf bank_mask:0xf
s_nop 1
v_max_u32_dpp v44,v44,v44 row_ror:4 row_mask:0xf bank_mask:0xf
s_nop 1
v_max_u32_dpp v44,v44,v44 row_ror:2 row_mask:0xf bank_mask:0xf
s_nop 1
v_max_u32_dpp v44,v44,v44 row_ror:1 row_mask:0xf bank_mask:0xf
v_mov_b32 v45,v44
s_nop 1
v_permlane16_swap_b32 v44,v45
v_max_u32 v44,v44,v45
v_mov_b32 v45,v44
s_nop 1
v_permlane32_swap_b32 v44,v45
v_max_u32 v44,v44,v45
s_nop 0
v_readfirstlane_b32 s20,v44
L_cjs_210:
s_mov_b32 s30,s20
s_andn2_b32 s31,0x7ff,s20
s_lshr_b32 s31,s31,5
s_add_u32 s31,s31,1
s_min_u32 s31,s31,63
ds_write_b32 v8,v2 offset:2560
s_waitcnt lgkmcnt(0)
s_branch L_ckb_213
L_cld_208:
v_mov_b32 v23,s56
s_add_u32 s56,s75,10495616
buffer_store_dword v23,off,s[8:11],s56
s_waitcnt vmcnt(0)
s_branch L_clb_209
L_cjw_214:
s_cmp_lg_u32 s19,0
s_cbranch_scc1 L_ckb_213
s_add_u32 s59,s18,s75
L_ww_235:
s_sleep 1
buffer_load_dword v23,off,s[8:11],s59 sc1
s_sub_u32 s49,s49,1
s_cbranch_scc1 L_abort
s_waitcnt vmcnt(0)
v_readfirstlane_b32 s76,v23
s_cmp_eq_u32 s76,0
s_cbranch_scc1 L_ww_235
L_wwd_236:
s_branch L_ckb_213
L_cjump_215:
s_waitcnt vmcnt(0) lgkmcnt(0)
s_barrier
s_branch L_cst_211
L_cend_225:
v_smfmac_f32_16x16x64_bf16 v[116:119],v[36:39],v[184:191],v2
v_smfmac_f32_16x16x64_bf16 v[112:115],v[40:43],v[192:199],v2
v_smfmac_f32_16x16x64_bf16 v[116:119],v[40:43],v[200:207],v2
v_smfmac_f32_16x16x64_bf16 v[112:115],v[44:47],v[208:215],v2
v_smfmac_f32_16x16x64_bf16 v[116:119],v[44:47],v[216:223],v2
v_smfmac_f32_16x16x64_bf16 v[112:115],v[48:51],v[224:231],v2
v_smfmac_f32_16x16x64_bf16 v[116:119],v[48:51],v[232:239],v2
v_smfmac_f32_16x16x64_bf16 v[112:115],v[52:55],v[240:247],v2
v_smfmac_f32_16x16x64_bf16 v[116:119],v[52:55],v[248:255],v2
s_waitcnt lgkmcnt(0)
s_nop 2
v_pk_add_f32 v[112:113],v[112:113],v[114:115]
s_nop 2
v_pk_add_f32 v[116:117],v[116:117],v[118:119]
v_cvt_pk_bf16_f32 v126,v112,v113
v_cvt_pk_bf16_f32 v127,v116,v117
v_add_u32 v52,s50,v5
v_add_u32 v54,s50,v6
ds_read_b64_tr_b16 v[52:53],v52
ds_read_b64_tr_b16 v[54:55],v54
v_mov_b32_dpp v124,v126 quad_perm:[2,3,2,3] row_mask:0xf bank_mask:0xf
v_mov_b32_dpp v125,v127 quad_perm:[2,3,2,3] row_mask:0xf bank_mask:0xf
s_mov_b32 vcc_lo,0xcccccccc
s_mov_b32 vcc_hi,0xcccccccc
s_waitcnt lgkmcnt(0)
v_cndmask_b32 v124,v124,v52,vcc
v_cndmask_b32 v125,v125,v53,vcc
v_cndmask_b32 v126,v126,v54,vcc
v_cndmask_b32 v127,v127,v55,vcc
buffer_store_dwordx4 v[124:127],v0,s[8:11],s54 offen sc1
s_mov_b32 s51,64
s_waitcnt vmcnt(0)
s_barrier
s_nop 11
v_lshrrev_b32 v1,4,v0
s_endpgm
L_abort2:
s_endpgm
L_wc:
s_nop 11
s_cmp_eq_u32 s48,1
s_cbranch_scc1 L_rc1_237
s_cmp_eq_u32 s48,2
s_cbranch_scc1 L_rc2_238
v_and_b32 v120,15,v1
v_lshrrev_b32 v121,4,v1
v_and_b32 v122,2,v1
v_cmp_eq_u32 vcc,0,v122
v_mov_b32 v2,0xeeee
v_mov_b32 v123,0x4444
v_cndmask_b32 v2,v2,v123,vcc
v_and_b32 v122,1,v1
v_cmp_eq_u32 vcc,0,v122
v_mov_b32 v3,0xdddd
v_mov_b32 v123,0x8888
v_cndmask_b32 v3,v3,v123,vcc
v_lshrrev_b32 v122,1,v120
v_bfe_u32 v123,v120,2,1
v_xor_b32 v123,v123,v122
v_lshlrev_b32 v4,7,v123
v_and_b32 v123,1,v120
v_lshl_add_u32 v4,v123,6,v4
v_xor_b32 v123,v121,v122
v_and_b32 v123,3,v123
v_lshl_add_u32 v4,v123,4,v4
s_lshl_b32 s56,s46,10
s_add_u32 s56,s56,147456
v_add_u32 v4,s56,v4
v_lshlrev_b32 v122,1,v121
v_add_u32 v122,0,v122
v_and_b32 v123,1,v121
v_xor_b32 v123,v123,v122
v_lshlrev_b32 v5,7,v123
v_bfe_u32 v123,v120,3,1
v_lshl_add_u32 v5,v123,6,v5
v_xor_b32 v123,v120,v122
v_and_b32 v123,3,v123
v_lshl_add_u32 v5,v123,4,v5
v_bfe_u32 v123,v120,2,1
v_lshl_add_u32 v5,v123,3,v5
v_add_u32 v5,147456,v5
v_lshlrev_b32 v122,1,v121
v_add_u32 v122,1,v122
v_and_b32 v123,1,v121
v_xor_b32 v123,v123,v122
v_lshlrev_b32 v6,7,v123
v_bfe_u32 v123,v120,3,1
v_lshl_add_u32 v6,v123,6,v6
v_xor_b32 v123,v120,v122
v_and_b32 v123,3,v123
v_lshl_add_u32 v6,v123,4,v6
v_bfe_u32 v123,v120,2,1
v_lshl_add_u32 v6,v123,3,v6
v_add_u32 v6,147456,v6
v_lshlrev_b32 v7,7,v121
v_lshrrev_b32 v122,1,v120
v_lshl_add_u32 v8,v122,4,v7
v_add_u32 v8,151552,v8
v_lshrrev_b32 v122,2,v120
v_lshl_add_u32 v7,v122,5,v7
v_and_b32 v122,1,v120
v_lshl_add_u32 v7,v122,4,v7
v_and_b32 v122,2,v120
v_cmp_eq_u32 vcc,0,v122
s_lshl_b32 s56,s46,9
v_mov_b32 v122,2048
v_mov_b32 v123,s56
v_cndmask_b32 v122,v122,v123,vcc
v_add_u32 v7,v122,v7
v_add_u32 v7,151552,v7
v_lshrrev_b32 v122,3,v1
v_lshlrev_b32 v9,11,v122
v_and_b32 v122,7,v1
v_lshl_add_u32 v9,v122,3,v9
s_lshl_b32 s56,s46,14
s_lshl_b32 s57,s47,6
s_add_u32 s56,s56,s57
v_add_u32 v9,s56,v9
s_lshl_b32 s71,s46,5
s_add_u32 s71,s71,s47
s_bfe_u32 s56,s71,0x10003
s_lshl_b32 s56,s56,11
s_and_b32 s57,s71,1
s_lshl_b32 s57,s57,10
s_add_u32 s56,s56,s57
s_bfe_u32 s57,s71,0x10002
s_lshl_b32 s57,s57,9
s_add_u32 s56,s56,s57
s_bfe_u32 s57,s71,0x10001
s_lshl_b32 s57,s57,6
s_add_u32 s56,s56,s57
s_bfe_u32 s57,s71,0x10004
s_lshl_b32 s57,s57,8
s_add_u32 s56,s56,s57
s_bfe_u32 s57,s71,0x10005
s_lshl_b32 s57,s57,7
s_add_u32 s56,s56,s57
s_bfe_u32 s57,s71,0x10006
s_lshl_b32 s57,s57,12
s_add_u32 s56,s56,s57
v_and_b32 v122,3,v120
v_lshlrev_b32 v10,2,v122
v_bfe_u32 v122,v120,3,1
v_lshl_add_u32 v10,v122,4,v10
v_and_b32 v122,1,v121
v_lshl_add_u32 v10,v122,5,v10
v_add_u32 v10,s56,v10
v_and_b32 v123,36,v1
v_mov_b32 v122,0x80000000
v_cmp_eq_u32 vcc,0,v123
s_nop 1
v_cndmask_b32 v10,v122,v10,vcc
s_lshl_b32 s71,s71,11
s_lshl_b32 s73,s46,11
s_mov_b32 s72,0xffc00000
s_mov_b32 s74,0
v_and_b32 v11,1,v121
v_xor_b32 v11,v11,v120
v_and_b32 v11,3,v11
v_lshrrev_b32 v122,2,v120
v_lshl_add_u32 v11,v11,2,v122
v_lshl_add_u32 v11,v121,4,v11
v_lshlrev_b32 v11,4,v11
s_lshl_b32 s56,s46,15
v_add_u32 v11,s56,v11
v_lshrrev_b32 v13,3,v1
v_lshlrev_b32 v13,9,v13
v_and_b32 v122,7,v1
v_lshl_add_u32 v13,v122,4,v13
v_and_b32 v122,15,v1
v_and_b32 v123,1,v1
v_lshlrev_b32 v123,4,v123
v_mov_b32 v124,0x3f80
v_lshlrev_b32 v124,v123,v124
v_lshrrev_b32 v122,1,v122
v_cmp_eq_u32 vcc,0,v122
s_nop 1
v_cndmask_b32 v18,0,v124,vcc
v_cmp_eq_u32 vcc,1,v122
s_nop 1
v_cndmask_b32 v19,0,v124,vcc
v_cmp_eq_u32 vcc,2,v122
s_nop 1
v_cndmask_b32 v20,0,v124,vcc
v_cmp_eq_u32 vcc,3,v122
s_nop 1
v_cndmask_b32 v21,0,v124,vcc
s_and_b32 s56,s46,1
s_lshl_b32 s56,s56,8
s_and_b32 s57,s46,2
s_lshl_b32 s57,s57,6
s_add_u32 s56,s56,s57
v_add_u32 v13,s56,v13
s_add_u32 s56,s50,155648
v_add_u32 v12,s56,v0
v_mov_b64 v[14:15],s[28:29]
v_mov_b64 v[16:17],s[28:29]
v_add_u32 v22,11550720,v10
s_lshl_b32 s18,s47,2
s_add_u32 s18,s18,10493952
v_mov_b32 v1,s80
s_mov_b32 s65,14680064
s_add_u32 s66,s71,14680064
s_add_u32 s69,s71,14942208
s_mov_b32 s30,0x40000000
s_mov_b32 s51,0
L_cst_242:
s_cmp_lg_u32 s46,0
s_cbranch_scc1 L_csw_247
s_lshl_b32 s59,s51,13
s_lshl2_add_u32 s59,s47,s59
s_add_u32 s59,s59,10485760
s_buffer_load_dword s61,s[8:11],s59
s_waitcnt lgkmcnt(0)
s_cmp_lg_u32 s61,0
s_cbranch_scc1 L_wwd_249
L_ww_248:
s_sleep 1
buffer_load_dword v122,off,s[8:11],s59 sc1
s_sub_u32 s49,s49,1
s_cbranch_scc1 L_abort2
s_waitcnt vmcnt(0)
v_readfirstlane_b32 s61,v122
s_cmp_eq_u32 s61,0
s_cbranch_scc1 L_ww_248
L_wwd_249:
L_csw_247:
s_waitcnt lgkmcnt(0)
s_barrier
s_lshl_b32 s56,s51,5
s_add_u32 s56,s56,s47
s_mul_i32 s56,s56,24576
s_add_u32 s56,s56,100663296
s_add_u32 s67,s56,s73
s_add_u32 m0,s73,131072
s_add_u32 s57,s67,8192
buffer_load_dwordx4 v0,s[8:11],s67 offen sc1 lds
buffer_load_dwordx4 v0,s[8:11],s67 offen offset:1024 sc1 lds
s_add_u32 m0,s73,139264
s_add_u32 s67,s67,786432
buffer_load_dwordx4 v0,s[8:11],s57 offen sc1 lds
buffer_load_dwordx4 v0,s[8:11],s57 offen offset:1024 sc1 lds
s_lshl_b32 s75,s51,13
s_add_u32 s56,s75,11542528
buffer_load_dword v23,v10,s[8:11],s56 offen sc1
s_add_u32 s64,s75,11534336
s_add_u32 s70,s64,4096
s_lshl_b32 s68,s51,5
s_add_u32 s68,s68,s47
s_lshl_b32 s68,s68,12
s_lshl_b32 s56,s46,10
s_add_u32 s68,s68,s56
s_add_u32 s68,s68,41943040
s_mov_b32 s54,0x80000000
s_mov_b32 s77,0
s_add_u32 s56,s18,s75
s_buffer_load_dword s19,s[8:11],s56
s_cmp_eq_u32 s51,63
s_cselect_b32 s76,1,s46
s_cmp_eq_u32 s76,0
s_cselect_b32 s76,1,0
v_mov_b64 v[96:97],0
v_mov_b64 v[98:99],0
v_mov_b64 v[100:101],0
v_mov_b64 v[102:103],0
v_mov_b64 v[104:105],0
v_mov_b64 v[106:107],0
v_mov_b64 v[108:109],0
v_mov_b64 v[110:111],0
v_mov_b64 v[112:113],0
v_mov_b64 v[114:115],0
v_mov_b64 v[116:117],0
v_mov_b64 v[118:119],0
buffer_load_dwordx4 v[88:91],v13,s[8:11],s64 offen
buffer_load_dwordx4 v[88:91],v13,s[8:11],s70 offen
s_waitcnt vmcnt(19)
v_swap_b32 v25,v28
v_swap_b32 v26,v32
v_swap_b32 v27,v36
v_swap_b32 v30,v33
v_swap_b32 v31,v37
v_swap_b32 v35,v38
ds_write_b128 v93,v[24:27] offset:4096
ds_write_b128 v94,v[28:31] offset:4096
ds_write_b128 v93,v[32:35] offset:4224
ds_write_b128 v94,v[36:39] offset:4224
s_waitcnt vmcnt(15)
v_swap_b32 v41,v44
v_swap_b32 v42,v48
v_swap_b32 v43,v52
v_swap_b32 v46,v49
v_swap_b32 v47,v53
v_swap_b32 v51,v54
ds_write_b128 v93,v[40:43] offset:5120
ds_write_b128 v94,v[44:47] offset:5120
ds_write_b128 v93,v[48:51] offset:5248
ds_write_b128 v94,v[52:55] offset:5248
s_waitcnt vmcnt(11)
v_swap_b32 v57,v60
v_swap_b32 v58,v64
v_swap_b32 v59,v68
v_swap_b32 v62,v65
v_swap_b32 v63,v69
v_swap_b32 v67,v70
ds_write_b128 v93,v[56:59] offset:6144
ds_write_b128 v94,v[60:63] offset:6144
ds_write_b128 v93,v[64:67] offset:6272
ds_write_b128 v94,v[68:71] offset:6272
s_waitcnt vmcnt(7)
v_swap_b32 v73,v76
v_swap_b32 v74,v80
v_swap_b32 v75,v84
v_swap_b32 v78,v81
v_swap_b32 v79,v85
v_swap_b32 v83,v86
ds_write_b128 v93,v[72:75] offset:7168
ds_write_b128 v94,v[76:79] offset:7168
ds_write_b128 v93,v[80:83] offset:7296
ds_write_b128 v94,v[84:87] offset:7296
s_waitcnt vmcnt(0) lgkmcnt(0)
s_barrier
v_add_u32 v55,131072,v0
ds_read_b128 v[56:59],v55 offset:0
ds_read_b128 v[60:63],v55 offset:4096
ds_read_b128 v[64:67],v55 offset:1024
ds_read_b128 v[68:71],v55 offset:5120
ds_read_b128 v[72:75],v55 offset:2048
ds_read_b128 v[76:79],v55 offset:6144
ds_read_b128 v[80:83],v55 offset:3072
ds_read_b128 v[84:87],v55 offset:7168
v_add_u32 v123,s73,v55
ds_read_b128 v[88:91],v123 offset:8192
ds_read_b128 v[92:95],v123 offset:9216
v_xor_b32 v120,1024,v12
v_xor_b32 v121,2048,v12
v_xor_b32 v122,3072,v12
buffer_load_dwordx4 v[24:27],v13,s[8:11],s64 offen sc1
buffer_load_dwordx4 v[24:27],v13,s[8:11],s64 offen sc1
L_chain_250:
L_cpa_251:
buffer_load_dwordx4 v[24:27],v13,s[8:11],s64 offen sc1
s_sub_u32 s49,s49,1
s_cbranch_scc1 L_abort2
s_waitcnt vmcnt(2)
v_max3_u32 v123,v24,v25,v26
v_max_u32 v123,v27,v123
v_cmp_le_u32 vcc,s72,v123
ds_write_b128 v12,v[24:27] offset:0
s_cbranch_vccnz L_cpa_251
L_cgo_254:
v_smfmac_f32_16x16x64_bf16 v[96:99],v[24:27],a[0:7],v2
buffer_load_dwordx4 v[40:43],v13,s[8:11],s70 offen sc1
v_smfmac_f32_16x16x64_bf16 v[100:103],v[24:27],a[128:135],v2
s_waitcnt lgkmcnt(0)
s_barrier
ds_read_b128 v[28:31],v120 offset:0
v_smfmac_f32_16x16x64_bf16 v[104:107],v[24:27],a[8:15],v2
ds_read_b128 v[32:35],v121 offset:0
v_smfmac_f32_16x16x64_bf16 v[108:111],v[24:27],a[136:143],v2
ds_read_b128 v[36:39],v122 offset:0
v_smfmac_f32_16x16x64_bf16 v[112:115],v[24:27],v[128:135],v2
v_smfmac_f32_16x16x64_bf16 v[116:119],v[24:27],v[136:143],v2
s_waitcnt lgkmcnt(2)
v_smfmac_f32_16x16x64_bf16 v[96:99],v[28:31],a[16:23],v2
s_add_u32 m0,s73,131072
v_smfmac_f32_16x16x64_bf16 v[100:103],v[28:31],a[144:151],v2
s_add_u32 s57,s67,8192
v_smfmac_f32_16x16x64_bf16 v[104:107],v[28:31],a[24:31],v2
s_cmp_lt_u32 s19,s76
s_cbranch_scc1 L_ckw_243
L_ckb_244:
v_smfmac_f32_16x16x64_bf16 v[108:111],v[28:31],a[152:159],v2
s_waitcnt vmcnt(0) lgkmcnt(1)
v_smfmac_f32_16x16x64_bf16 v[96:99],v[32:35],a[32:39],v2
ds_write_b128 v12,v[40:43] offset:4096
v_max3_u32 v123,v40,v41,v42
v_smfmac_f32_16x16x64_bf16 v[100:103],v[32:35],a[160:167],v2
v_max_u32 v123,v43,v123
v_smfmac_f32_16x16x64_bf16 v[104:107],v[32:35],a[40:47],v2
v_cmp_le_u32 vcc,s72,v123
v_smfmac_f32_16x16x64_bf16 v[108:111],v[32:35],a[168:175],v2
v_smfmac_f32_16x16x64_bf16 v[112:115],v[28:31],v[144:151],v2
s_cbranch_vccnz L_cpb_257
L_cback_259:
s_waitcnt lgkmcnt(0)
s_barrier
v_smfmac_f32_16x16x64_bf16 v[96:99],v[36:39],a[48:55],v2
buffer_store_dwordx4 v[124:127],v0,s[8:11],s54 offen sc1
v_smfmac_f32_16x16x64_bf16 v[100:103],v[36:39],a[176:183],v2
ds_read_b128 v[44:47],v120 offset:4096
v_smfmac_f32_16x16x64_bf16 v[104:107],v[36:39],a[56:63],v2
buffer_load_dwordx4 v0,s[8:11],s67 offen sc1 lds
v_smfmac_f32_16x16x64_bf16 v[108:111],v[36:39],a[184:191],v2
ds_read_b128 v[48:51],v121 offset:4096
v_smfmac_f32_16x16x64_bf16 v[96:99],v[40:43],a[64:71],v2
buffer_load_dwordx4 v0,s[8:11],s67 offen offset:1024 sc1 lds
s_add_u32 m0,s73,139264
v_smfmac_f32_16x16x64_bf16 v[100:103],v[40:43],a[192:199],v2
ds_read_b128 v[52:55],v122 offset:4096
v_smfmac_f32_16x16x64_bf16 v[104:107],v[40:43],a[72:79],v2
buffer_load_dwordx4 v0,s[8:11],s57 offen sc1 lds
s_add_u32 s67,s67,786432
v_smfmac_f32_16x16x64_bf16 v[108:111],v[40:43],a[200:207],v2
s_waitcnt lgkmcnt(2)
v_smfmac_f32_16x16x64_bf16 v[96:99],v[44:47],a[80:87],v2
buffer_load_dwordx4 v0,s[8:11],s57 offen offset:1024 sc1 lds
v_smfmac_f32_16x16x64_bf16 v[100:103],v[44:47],a[208:215],v2
s_waitcnt lgkmcnt(1)
v_smfmac_f32_16x16x64_bf16 v[96:99],v[48:51],a[96:103],v2
buffer_load_dword v23,v22,s[8:11],s75 offen sc1
v_smfmac_f32_16x16x64_bf16 v[100:103],v[48:51],a[224:231],v2
s_waitcnt lgkmcnt(0)
v_smfmac_f32_16x16x64_bf16 v[96:99],v[52:55],a[112:119],v2
v_smfmac_f32_16x16x64_bf16 v[100:103],v[52:55],a[240:247],v2
v_smfmac_f32_16x16x64_bf16 v[104:107],v[44:47],a[88:95],v2
v_smfmac_f32_16x16x64_bf16 v[108:111],v[44:47],a[216:223],v2
v_smfmac_f32_16x16x64_bf16 v[104:107],v[48:51],a[104:111],v2
v_add_f32 v96,v96,v98
v_smfmac_f32_16x16x64_bf16 v[108:111],v[48:51],a[232:239],v2
v_add_f32 v97,v97,v99
v_smfmac_f32_16x16x64_bf16 v[104:107],v[52:55],a[120:127],v2
v_cvt_pk_bf16_f32 v120,v96,v97
v_smfmac_f32_16x16x64_bf16 v[108:111],v[52:55],a[248:255],v2
v_add_f32 v100,v100,v102
v_smfmac_f32_16x16x64_bf16 v[116:119],v[28:31],v[152:159],v2
v_add_f32 v101,v101,v103
v_smfmac_f32_16x16x64_bf16 v[112:115],v[32:35],v[160:167],v2
v_cvt_pk_bf16_f32 v121,v100,v101
v_add_f32 v104,v104,v106
v_add_f32 v105,v105,v107
v_cvt_pk_bf16_f32 v122,v104,v105
v_add_f32 v108,v108,v110
v_add_f32 v109,v109,v111
v_cvt_pk_bf16_f32 v123,v108,v109
ds_write_b128 v4,v[120:123]
v_smfmac_f32_16x16x64_bf16 v[116:119],v[32:35],v[168:175],v2
s_mov_b32 s54,s68
s_add_u32 s68,s68,131072
v_mov_b32 v125,0
v_smfmac_f32_16x16x64_bf16 v[112:115],v[36:39],v[176:183],v2
s_cmp_eq_u32 s51,63
s_cbranch_scc1 L_cend_253
v_smfmac_f32_16x16x64_bf16 v[116:119],v[36:39],v[184:191],v2
v_smfmac_f32_16x16x64_bf16 v[112:115],v[40:43],v[192:199],v2
s_waitcnt lgkmcnt(0)
s_barrier
ds_read_b64_tr_b16 v[96:97],v5 offset:0
ds_read_b64_tr_b16 v[98:99],v6 offset:0
v_smfmac_f32_16x16x64_bf16 v[116:119],v[40:43],v[200:207],v2
ds_read_b64_tr_b16 v[100:101],v5 offset:1024
v_smfmac_f32_16x16x64_bf16 v[112:115],v[44:47],v[208:215],v2
ds_read_b64_tr_b16 v[102:103],v6 offset:1024
v_smfmac_f32_16x16x64_bf16 v[116:119],v[44:47],v[216:223],v2
ds_read_b64_tr_b16 v[104:105],v5 offset:2048
v_smfmac_f32_16x16x64_bf16 v[112:115],v[48:51],v[224:231],v2
ds_read_b64_tr_b16 v[106:107],v6 offset:2048
s_waitcnt lgkmcnt(4)
v_mfma_f32_16x16x32_bf16 v[24:27],v[56:59],v[96:99],0
ds_read_b64_tr_b16 v[108:109],v5 offset:3072
v_mfma_f32_16x16x32_bf16 v[28:31],v[60:63],v[96:99],0
ds_read_b64_tr_b16 v[110:111],v6 offset:3072
v_mfma_f32_16x16x32_bf16 v[32:35],v[96:99],v[96:99],0
ds_read_b128 v[40:43],v11 offset:12288
s_waitcnt lgkmcnt(5)
v_mfma_f32_16x16x32_bf16 v[24:27],v[64:67],v[100:103],v[24:27]
ds_read_b128 v[56:59],v11 offset:0
v_mfma_f32_16x16x32_bf16 v[28:31],v[68:71],v[100:103],v[28:31]
ds_read_b128 v[60:63],v11 offset:1024
v_mfma_f32_16x16x32_bf16 v[32:35],v[100:103],v[100:103],v[32:35]
ds_read_b128 v[96:99],v11 offset:8192
s_waitcnt lgkmcnt(6)
v_mfma_f32_16x16x32_bf16 v[24:27],v[72:75],v[104:107],v[24:27]
ds_read_b128 v[64:67],v11 offset:2048
v_mfma_f32_16x16x32_bf16 v[28:31],v[76:79],v[104:107],v[28:31]
ds_read_b128 v[68:71],v11 offset:3072
v_mfma_f32_16x16x32_bf16 v[32:35],v[104:107],v[104:107],v[32:35]
ds_read_b128 v[100:103],v11 offset:9216
s_waitcnt lgkmcnt(7)
v_mfma_f32_16x16x32_bf16 v[24:27],v[80:83],v[108:111],v[24:27]
ds_read_b128 v[72:75],v11 offset:4096
v_mfma_f32_16x16x32_bf16 v[28:31],v[84:87],v[108:111],v[28:31]
ds_read_b128 v[76:79],v11 offset:5120
v_mfma_f32_16x16x32_bf16 v[32:35],v[108:111],v[108:111],v[32:35]
ds_read_b128 v[104:107],v11 offset:10240
v_smfmac_f32_16x16x64_bf16 v[116:119],v[48:51],v[232:239],v2
ds_read_b128 v[80:83],v11 offset:6144
v_smfmac_f32_16x16x64_bf16 v[112:115],v[52:55],v[240:247],v2
ds_read_b128 v[84:87],v11 offset:7168
v_smfmac_f32_16x16x64_bf16 v[116:119],v[52:55],v[248:255],v2
ds_read_b128 v[108:111],v11 offset:11264
v_max3_f32 v126,v24,v25,v26
v_max3_f32 v127,v27,v28,v29
v_max3_f32 v126,v30,v31,v126
v_max3_f32 v127,v34,v35,v127
v_max_f32 v126,v126,v127
v_max_f32 v127,v126,v127
v_pk_mul_f32 v[34:35],v[34:35],v[0:1] op_sel:[0,1]
v_pk_mul_f32 v[24:25],v[24:25],v[0:1] op_sel:[0,1]
v_permlane16_swap_b32 v126,v127
v_max_f32 v126,v126,v127
v_max_f32 v127,v126,v127
v_pk_mul_f32 v[26:27],v[26:27],v[0:1] op_sel:[0,1]
v_pk_mul_f32 v[28:29],v[28:29],v[0:1] op_sel:[0,1]
v_permlane32_swap_b32 v126,v127
v_max_f32 v126,v126,v127
v_mul_f32 v126,v1,v126
v_pk_mul_f32 v[30:31],v[30:31],v[0:1] op_sel:[0,1]
v_pk_add_f32 v[34:35],v[34:35],v[126:127] op_sel_hi:[1,0] neg_lo:[0,1] neg_hi:[0,1]
v_pk_add_f32 v[112:113],v[112:113],v[114:115]
v_pk_add_f32 v[116:117],v[116:117],v[118:119]
v_pk_add_f32 v[24:25],v[24:25],v[126:127] op_sel_hi:[1,0] neg_lo:[0,1] neg_hi:[0,1]
v_pk_add_f32 v[26:27],v[26:27],v[126:127] op_sel_hi:[1,0] neg_lo:[0,1] neg_hi:[0,1]
v_pk_add_f32 v[28:29],v[28:29],v[126:127] op_sel_hi:[1,0] neg_lo:[0,1] neg_hi:[0,1]
v_pk_add_f32 v[30:31],v[30:31],v[126:127] op_sel_hi:[1,0] neg_lo:[0,1] neg_hi:[0,1]
v_exp_f32 v34,v34
v_exp_f32 v35,v35
v_cvt_pk_bf16_f32 v126,v112,v113
v_cvt_pk_bf16_f32 v124,v34,v35
v_cvt_pk_bf16_f32 v127,v116,v117
v_cvt_pk_bf16_f32 v36,v116,v117
v_mfma_f32_16x16x16_bf16 v[32:35],v[14:15],v[124:125],0
ds_read_b128 v[44:47],v11 offset:13312
v_exp_f32 v24,v24
v_mfma_f32_16x16x16_bf16 v[112:115],v[126:127],v[124:125],0
ds_read_b128 v[48:51],v11 offset:14336
v_exp_f32 v25,v25
v_mfma_f32_16x16x16_bf16 v[116:119],v[36:37],v[124:125],0
ds_read_b128 v[52:55],v11 offset:15360
v_exp_f32 v26,v26
v_exp_f32 v27,v27
v_cvt_pk_bf16_f32 v120,v24,v25
v_exp_f32 v28,v28
v_exp_f32 v29,v29
v_cvt_pk_bf16_f32 v121,v26,v27
v_exp_f32 v30,v30
v_exp_f32 v31,v31
v_cvt_pk_bf16_f32 v122,v28,v29
v_cvt_pk_bf16_f32 v123,v30,v31
s_add_u32 s75,s75,8192
s_add_u32 s51,s51,1
v_mfma_f32_16x16x32_bf16 v[32:35],v[14:17],v[120:123],v[32:35]
v_mfma_f32_16x16x32_bf16 v[112:115],v[88:91],v[120:123],v[112:115]
ds_read_b128 v[88:91],v11 offset:16384
v_mfma_f32_16x16x32_bf16 v[116:119],v[92:95],v[120:123],v[116:119]
ds_read_b128 v[92:95],v11 offset:17408
v_rcp_f32 v32,v32
v_mov_b64 v[24:25],-1
v_mov_b64 v[26:27],-1
s_add_u32 s64,s75,11534336
s_add_u32 s70,s64,4096
v_pk_mul_f32 v[112:113],v[112:113],v[32:33] op_sel_hi:[1,0]
v_pk_mul_f32 v[114:115],v[114:115],v[32:33] op_sel_hi:[1,0]
v_pk_mul_f32 v[116:117],v[116:117],v[32:33] op_sel_hi:[1,0]
v_pk_mul_f32 v[118:119],v[118:119],v[32:33] op_sel_hi:[1,0]
v_cvt_pk_bf16_f32 v120,v112,v116
v_cvt_pk_bf16_f32 v121,v113,v117
v_cvt_pk_bf16_f32 v122,v114,v118
v_cvt_pk_bf16_f32 v123,v115,v119
ds_write_b128 v7,v[120:123]
buffer_store_dwordx4 v[24:27],v0,s[8:11],s69 offen sc1
buffer_store_dwordx4 v[24:27],v0,s[8:11],s69 offen offset:1024 sc1
v_mov_b64 v[112:113],0
v_mov_b64 v[114:115],0
v_mov_b64 v[116:117],0
v_mov_b64 v[118:119],0
s_waitcnt lgkmcnt(0)
s_barrier
ds_read_b128 v[24:27],v8 offset:0
ds_read_b128 v[28:31],v8 offset:512
ds_read_b128 v[32:35],v8 offset:1024
ds_read_b128 v[36:39],v8 offset:1536
v_mov_b64 v[120:121],0
v_mov_b64 v[122:123],0
s_add_u32 s57,s65,65536
s_add_u32 s58,s65,131072
s_add_u32 s59,s65,196608
s_add_u32 s56,s18,s75
s_waitcnt lgkmcnt(3)
v_smfmac_f32_16x16x64_bf16 v[112:115],v[24:27],v[56:63],v3
ds_read_b128 v[56:59],v11 offset:18432
s_waitcnt lgkmcnt(3)
v_smfmac_f32_16x16x64_bf16 v[112:115],v[28:31],v[64:71],v3
ds_read_b128 v[60:63],v11 offset:19456
s_waitcnt lgkmcnt(3)
v_smfmac_f32_16x16x64_bf16 v[112:115],v[32:35],v[72:79],v3
ds_read_b128 v[64:67],v11 offset:20480
s_waitcnt lgkmcnt(3)
v_smfmac_f32_16x16x64_bf16 v[112:115],v[36:39],v[80:87],v3
ds_read_b128 v[68:71],v11 offset:21504
v_smfmac_f32_16x16x64_bf16 v[116:119],v[24:27],v[96:103],v3
ds_read_b128 v[72:75],v11 offset:22528
v_smfmac_f32_16x16x64_bf16 v[116:119],v[28:31],v[104:111],v3
ds_read_b128 v[76:79],v11 offset:23552
v_cvt_pk_bf16_f32 v112,v112,v113
v_smfmac_f32_16x16x64_bf16 v[116:119],v[32:35],v[40:47],v3
ds_read_b128 v[80:83],v11 offset:24576
v_cvt_pk_bf16_f32 v113,v114,v115
buffer_store_dwordx2 v[112:113],v9,s[8:11],s65 offen sc1
v_smfmac_f32_16x16x64_bf16 v[116:119],v[36:39],v[48:55],v3
ds_read_b128 v[84:87],v11 offset:25600
v_mov_b64 v[112:113],0
v_smfmac_f32_16x16x64_bf16 v[120:123],v[24:27],v[88:95],v3
ds_read_b128 v[96:99],v11 offset:26624
ds_read_b128 v[100:103],v11 offset:27648
v_mov_b64 v[114:115],0
s_waitcnt lgkmcnt(8)
v_smfmac_f32_16x16x64_bf16 v[120:123],v[28:31],v[56:63],v3
ds_read_b128 v[104:107],v11 offset:28672
v_cvt_pk_bf16_f32 v116,v116,v117
s_waitcnt lgkmcnt(7)
v_smfmac_f32_16x16x64_bf16 v[120:123],v[32:35],v[64:71],v3
ds_read_b128 v[108:111],v11 offset:29696
ds_read_b128 v[40:43],v11 offset:30720
v_cvt_pk_bf16_f32 v117,v118,v119
buffer_store_dwordx2 v[116:117],v9,s[8:11],s57 offen sc1
s_waitcnt lgkmcnt(7)
v_smfmac_f32_16x16x64_bf16 v[120:123],v[36:39],v[72:79],v3
ds_read_b128 v[44:47],v11 offset:31744
v_add_u32 v52,s50,v5
s_waitcnt lgkmcnt(6)
v_smfmac_f32_16x16x64_bf16 v[112:115],v[24:27],v[80:87],v3
v_add_u32 v54,s50,v6
s_waitcnt lgkmcnt(4)
v_smfmac_f32_16x16x64_bf16 v[112:115],v[28:31],v[96:103],v3
ds_read_b64_tr_b16 v[52:53],v52
v_cvt_pk_bf16_f32 v120,v120,v121
s_waitcnt lgkmcnt(3)
v_smfmac_f32_16x16x64_bf16 v[112:115],v[32:35],v[104:111],v3
ds_read_b64_tr_b16 v[54:55],v54
v_cvt_pk_bf16_f32 v121,v122,v123
buffer_store_dwordx2 v[120:121],v9,s[8:11],s58 offen sc1
s_waitcnt lgkmcnt(2)
v_smfmac_f32_16x16x64_bf16 v[112:115],v[36:39],v[40:47],v3
v_mov_b64 v[116:117],0
v_mov_b64 v[118:119],0
s_xor_b32 s65,s65,262144
v_mov_b32_dpp v124,v126 quad_perm:[2,3,2,3] row_mask:0xf bank_mask:0xf
v_mov_b32_dpp v125,v127 quad_perm:[2,3,2,3] row_mask:0xf bank_mask:0xf
s_mov_b32 vcc_lo,0xcccccccc
s_mov_b32 vcc_hi,0xcccccccc
s_nop 0
v_cvt_pk_bf16_f32 v112,v112,v113
v_cvt_pk_bf16_f32 v113,v114,v115
buffer_store_dwordx2 v[112:113],v9,s[8:11],s59 offen sc1
s_waitcnt lgkmcnt(0)
s_buffer_load_dword s19,s[8:11],s56
v_cndmask_b32 v124,v124,v52,vcc
v_cndmask_b32 v125,v125,v53,vcc
v_cndmask_b32 v126,v126,v54,vcc
v_cndmask_b32 v127,v127,v55,vcc
s_cmp_lt_u32 s46,2
s_waitcnt vmcnt(3)
s_cbranch_scc1 L_crg_260
s_cmp_eq_u32 s46,2
s_waitcnt vmcnt(1)
s_cbranch_scc1 L_crg_260
s_waitcnt vmcnt(0)
L_crg_260:
buffer_load_dwordx4 v[32:35],v0,s[8:11],s66 offen offset:0 sc1
buffer_load_dwordx4 v[36:39],v0,s[8:11],s66 offen offset:1024 sc1
v_mov_b64 v[96:97],0
v_mov_b64 v[98:99],0
v_mov_b64 v[100:101],0
v_mov_b64 v[102:103],0
v_mov_b64 v[104:105],0
v_mov_b64 v[106:107],0
v_mov_b64 v[108:109],0
v_mov_b64 v[110:111],0
v_mov_b64 v[112:113],0
v_mov_b64 v[114:115],0
v_add_u32 v55,131072,v0
v_add_u32 v123,s73,v55
v_xor_b32 v120,1024,v12
v_xor_b32 v121,2048,v12
v_xor_b32 v122,3072,v12
buffer_load_dwordx4 v[44:47],v0,s[8:11],s66 offen offset:0 sc1
buffer_load_dwordx4 v[48:51],v0,s[8:11],s66 offen offset:1024 sc1
s_cmp_ge_u32 s51,63
s_cselect_b32 s76,0,1
s_cmp_eq_u32 s46,0
s_cselect_b32 s76,s76,0
s_waitcnt vmcnt(3)
v_mfma_f32_16x16x32_bf16 v[28:31],v[18:21],v[32:35],0
s_waitcnt vmcnt(2)
v_mfma_f32_16x16x32_bf16 v[28:31],v[18:21],v[36:39],v[28:31]
s_nop 7
v_cmp_u_f32 vcc,v28,v28
v_add_f32_dpp v52,v28,v28 row_ror:8 row_mask:0xf bank_mask:0x3
v_add_f32_dpp v53,v29,v29 row_ror:8 row_mask:0xf bank_mask:0x3
v_add_f32_dpp v52,v30,v30 row_ror:8 row_mask:0xf bank_mask:0xc
v_add_f32_dpp v53,v31,v31 row_ror:8 row_mask:0xf bank_mask:0xc
s_nop 0
v_add_f32_dpp v52,v52,v52 row_shl:4 row_mask:0xf bank_mask:0x5
v_add_f32_dpp v53,v53,v53 row_shl:4 row_mask:0xf bank_mask:0x5
s_cbranch_vccnz L_crp_255
L_cok_261:
v_cvt_pk_bf16_f32 v54,v52,v53
buffer_store_dword v54,v10,s[8:11],s64 offen sc1
s_mov_b32 s69,s66
s_xor_b32 s66,s66,262144
s_barrier
ds_read_b128 v[56:59],v55 offset:0
ds_read_b128 v[60:63],v55 offset:4096
ds_read_b128 v[64:67],v55 offset:1024
buffer_load_dwordx4 v[24:27],v13,s[8:11],s64 offen sc1
ds_read_b128 v[68:71],v55 offset:5120
ds_read_b128 v[72:75],v55 offset:2048
ds_read_b128 v[76:79],v55 offset:6144
ds_read_b128 v[80:83],v55 offset:3072
buffer_load_dwordx4 v[24:27],v13,s[8:11],s64 offen sc1
ds_read_b128 v[84:87],v55 offset:7168
ds_read_b128 v[88:91],v123 offset:8192
ds_read_b128 v[92:95],v123 offset:9216
s_branch L_chain_250
L_cpb_257:
buffer_load_dwordx4 v[40:43],v13,s[8:11],s70 offen sc1
s_sub_u32 s49,s49,1
s_cbranch_scc1 L_abort2
s_waitcnt vmcnt(0)
v_max3_u32 v123,v40,v41,v42
v_max_u32 v123,v43,v123
v_cmp_le_u32 vcc,s72,v123
s_cbranch_vccnz L_cpb_257
ds_write_b128 v12,v[40:43] offset:4096
s_branch L_cback_259
L_crp_255:
buffer_load_dwordx4 v[32:35],v0,s[8:11],s66 offen offset:0 sc1
buffer_load_dwordx4 v[36:39],v0,s[8:11],s66 offen offset:1024 sc1
s_sub_u32 s49,s49,1
s_cbranch_scc1 L_abort2
s_waitcnt vmcnt(3)
v_mfma_f32_16x16x32_bf16 v[28:31],v[18:21],v[44:47],0
s_waitcnt vmcnt(2)
v_mfma_f32_16x16x32_bf16 v[28:31],v[18:21],v[48:51],v[28:31]
s_nop 7
v_cmp_u_f32 vcc,v28,v28
v_add_f32_dpp v52,v28,v28 row_ror:8 row_mask:0xf bank_mask:0x3
v_add_f32_dpp v53,v29,v29 row_ror:8 row_mask:0xf bank_mask:0x3
v_add_f32_dpp v52,v30,v30 row_ror:8 row_mask:0xf bank_mask:0xc
v_add_f32_dpp v53,v31,v31 row_ror:8 row_mask:0xf bank_mask:0xc
s_nop 0
v_add_f32_dpp v52,v52,v52 row_shl:4 row_mask:0xf bank_mask:0x5
v_add_f32_dpp v53,v53,v53 row_shl:4 row_mask:0xf bank_mask:0x5
s_cbranch_vccz L_cok_261
buffer_load_dwordx4 v[44:47],v0,s[8:11],s66 offen offset:0 sc1
buffer_load_dwordx4 v[48:51],v0,s[8:11],s66 offen offset:1024 sc1
s_sub_u32 s49,s49,1
s_cbranch_scc1 L_abort2
s_waitcnt vmcnt(3)
v_mfma_f32_16x16x32_bf16 v[28:31],v[18:21],v[32:35],0
s_waitcnt vmcnt(2)
v_mfma_f32_16x16x32_bf16 v[28:31],v[18:21],v[36:39],v[28:31]
s_nop 7
v_cmp_u_f32 vcc,v28,v28
v_add_f32_dpp v52,v28,v28 row_ror:8 row_mask:0xf bank_mask:0x3
v_add_f32_dpp v53,v29,v29 row_ror:8 row_mask:0xf bank_mask:0x3
v_add_f32_dpp v52,v30,v30 row_ror:8 row_mask:0xf bank_mask:0xc
v_add_f32_dpp v53,v31,v31 row_ror:8 row_mask:0xf bank_mask:0xc
s_nop 0
v_add_f32_dpp v52,v52,v52 row_shl:4 row_mask:0xf bank_mask:0x5
v_add_f32_dpp v53,v53,v53 row_shl:4 row_mask:0xf bank_mask:0x5
s_cbranch_vccz L_cok_261
s_branch L_crp_255
L_ckw_243:
s_add_u32 s59,s18,s75
L_ww_262:
s_sleep 1
buffer_load_dword v23,off,s[8:11],s59 sc1
s_sub_u32 s49,s49,1
s_cbranch_scc1 L_abort2
s_waitcnt vmcnt(0)
v_readfirstlane_b32 s76,v23
s_cmp_eq_u32 s76,0
s_cbranch_scc1 L_ww_262
L_wwd_263:
s_branch L_ckb_244
L_cend_253:
v_smfmac_f32_16x16x64_bf16 v[116:119],v[36:39],v[184:191],v2
v_smfmac_f32_16x16x64_bf16 v[112:115],v[40:43],v[192:199],v2
v_smfmac_f32_16x16x64_bf16 v[116:119],v[40:43],v[200:207],v2
v_smfmac_f32_16x16x64_bf16 v[112:115],v[44:47],v[208:215],v2
v_smfmac_f32_16x16x64_bf16 v[116:119],v[44:47],v[216:223],v2
v_smfmac_f32_16x16x64_bf16 v[112:115],v[48:51],v[224:231],v2
v_smfmac_f32_16x16x64_bf16 v[116:119],v[48:51],v[232:239],v2
v_smfmac_f32_16x16x64_bf16 v[112:115],v[52:55],v[240:247],v2
v_smfmac_f32_16x16x64_bf16 v[116:119],v[52:55],v[248:255],v2
s_waitcnt lgkmcnt(0)
s_nop 2
v_pk_add_f32 v[112:113],v[112:113],v[114:115]
s_nop 2
v_pk_add_f32 v[116:117],v[116:117],v[118:119]
v_cvt_pk_bf16_f32 v126,v112,v113
v_cvt_pk_bf16_f32 v127,v116,v117
v_add_u32 v52,s50,v5
v_add_u32 v54,s50,v6
ds_read_b64_tr_b16 v[52:53],v52
ds_read_b64_tr_b16 v[54:55],v54
v_mov_b32_dpp v124,v126 quad_perm:[2,3,2,3] row_mask:0xf bank_mask:0xf
v_mov_b32_dpp v125,v127 quad_perm:[2,3,2,3] row_mask:0xf bank_mask:0xf
s_mov_b32 vcc_lo,0xcccccccc
s_mov_b32 vcc_hi,0xcccccccc
s_waitcnt lgkmcnt(0)
v_cndmask_b32 v124,v124,v52,vcc
v_cndmask_b32 v125,v125,v53,vcc
v_cndmask_b32 v126,v126,v54,vcc
v_cndmask_b32 v127,v127,v55,vcc
buffer_store_dwordx4 v[124:127],v0,s[8:11],s54 offen sc1
s_mov_b32 s51,64
s_waitcnt vmcnt(0)
s_barrier
s_nop 11
v_lshrrev_b32 v1,4,v0
s_mov_b32 s53,0
s_branch L_rb_7
L_rc1_237:
v_and_b32 v120,15,v1
v_lshrrev_b32 v121,4,v1
v_and_b32 v122,2,v1
v_cmp_eq_u32 vcc,0,v122
v_mov_b32 v2,0xeeee
v_mov_b32 v123,0x4444
v_cndmask_b32 v2,v2,v123,vcc
v_and_b32 v122,1,v1
v_cmp_eq_u32 vcc,0,v122
v_mov_b32 v3,0xdddd
v_mov_b32 v123,0x8888
v_cndmask_b32 v3,v3,v123,vcc
v_lshrrev_b32 v122,1,v120
v_bfe_u32 v123,v120,2,1
v_xor_b32 v123,v123,v122
v_lshlrev_b32 v4,7,v123
v_and_b32 v123,1,v120
v_lshl_add_u32 v4,v123,6,v4
v_xor_b32 v123,v121,v122
v_and_b32 v123,3,v123
v_lshl_add_u32 v4,v123,4,v4
s_lshl_b32 s56,s46,10
s_add_u32 s56,s56,147456
v_add_u32 v4,s56,v4
v_lshlrev_b32 v122,1,v121
v_add_u32 v122,0,v122
v_and_b32 v123,1,v121
v_xor_b32 v123,v123,v122
v_lshlrev_b32 v5,7,v123
v_bfe_u32 v123,v120,3,1
v_lshl_add_u32 v5,v123,6,v5
v_xor_b32 v123,v120,v122
v_and_b32 v123,3,v123
v_lshl_add_u32 v5,v123,4,v5
v_bfe_u32 v123,v120,2,1
v_lshl_add_u32 v5,v123,3,v5
v_add_u32 v5,147456,v5
v_lshlrev_b32 v122,1,v121
v_add_u32 v122,1,v122
v_and_b32 v123,1,v121
v_xor_b32 v123,v123,v122
v_lshlrev_b32 v6,7,v123
v_bfe_u32 v123,v120,3,1
v_lshl_add_u32 v6,v123,6,v6
v_xor_b32 v123,v120,v122
v_and_b32 v123,3,v123
v_lshl_add_u32 v6,v123,4,v6
v_bfe_u32 v123,v120,2,1
v_lshl_add_u32 v6,v123,3,v6
v_add_u32 v6,147456,v6
v_lshlrev_b32 v7,7,v121
v_lshrrev_b32 v122,1,v120
v_lshl_add_u32 v8,v122,4,v7
v_add_u32 v8,151552,v8
v_lshrrev_b32 v122,2,v120
v_lshl_add_u32 v7,v122,5,v7
v_and_b32 v122,1,v120
v_lshl_add_u32 v7,v122,4,v7
v_and_b32 v122,2,v120
v_cmp_eq_u32 vcc,0,v122
s_lshl_b32 s56,s46,9
v_mov_b32 v122,2048
v_mov_b32 v123,s56
v_cndmask_b32 v122,v122,v123,vcc
v_add_u32 v7,v122,v7
v_add_u32 v7,151552,v7
v_lshrrev_b32 v122,3,v1
v_lshlrev_b32 v9,11,v122
v_and_b32 v122,7,v1
v_lshl_add_u32 v9,v122,3,v9
s_lshl_b32 s56,s46,14
s_lshl_b32 s57,s47,6
s_add_u32 s56,s56,s57
v_add_u32 v9,s56,v9
s_lshl_b32 s71,s46,5
s_add_u32 s71,s71,s47
s_bfe_u32 s56,s71,0x10003
s_lshl_b32 s56,s56,11
s_and_b32 s57,s71,1
s_lshl_b32 s57,s57,10
s_add_u32 s56,s56,s57
s_bfe_u32 s57,s71,0x10002
s_lshl_b32 s57,s57,9
s_add_u32 s56,s56,s57
s_bfe_u32 s57,s71,0x10001
s_lshl_b32 s57,s57,6
s_add_u32 s56,s56,s57
s_bfe_u32 s57,s71,0x10004
s_lshl_b32 s57,s57,8
s_add_u32 s56,s56,s57
s_bfe_u32 s57,s71,0x10005
s_lshl_b32 s57,s57,7
s_add_u32 s56,s56,s57
s_bfe_u32 s57,s71,0x10006
s_lshl_b32 s57,s57,12
s_add_u32 s56,s56,s57
v_and_b32 v122,3,v120
v_lshlrev_b32 v10,2,v122
v_bfe_u32 v122,v120,3,1
v_lshl_add_u32 v10,v122,4,v10
v_and_b32 v122,1,v121
v_lshl_add_u32 v10,v122,5,v10
v_add_u32 v10,s56,v10
v_and_b32 v123,36,v1
v_mov_b32 v122,0x80000000
v_cmp_eq_u32 vcc,0,v123
s_nop 1
v_cndmask_b32 v10,v122,v10,vcc
s_lshl_b32 s71,s71,11
s_lshl_b32 s73,s46,11
s_mov_b32 s72,0xffc00000
s_mov_b32 s74,0
v_and_b32 v11,1,v121
v_xor_b32 v11,v11,v120
v_and_b32 v11,3,v11
v_lshrrev_b32 v122,2,v120
v_lshl_add_u32 v11,v11,2,v122
v_lshl_add_u32 v11,v121,4,v11
v_lshlrev_b32 v11,4,v11
s_lshl_b32 s56,s46,15
v_add_u32 v11,s56,v11
v_lshrrev_b32 v13,3,v1
v_lshlrev_b32 v13,9,v13
v_and_b32 v122,7,v1
v_lshl_add_u32 v13,v122,4,v13
v_and_b32 v122,15,v1
v_and_b32 v123,1,v1
v_lshlrev_b32 v123,4,v123
v_mov_b32 v124,0x3f80
v_lshlrev_b32 v124,v123,v124
v_lshrrev_b32 v122,1,v122
v_cmp_eq_u32 vcc,0,v122
s_nop 1
v_cndmask_b32 v18,0,v124,vcc
v_cmp_eq_u32 vcc,1,v122
s_nop 1
v_cndmask_b32 v19,0,v124,vcc
v_cmp_eq_u32 vcc,2,v122
s_nop 1
v_cndmask_b32 v20,0,v124,vcc
v_cmp_eq_u32 vcc,3,v122
s_nop 1
v_cndmask_b32 v21,0,v124,vcc
s_and_b32 s56,s46,1
s_lshl_b32 s56,s56,8
s_and_b32 s57,s46,2
s_lshl_b32 s57,s57,6
s_add_u32 s56,s56,s57
v_add_u32 v13,s56,v13
s_add_u32 s56,s50,155648
v_add_u32 v12,s56,v0
v_mov_b64 v[14:15],s[28:29]
v_mov_b64 v[16:17],s[28:29]
v_add_u32 v22,12599296,v10
s_lshl_b32 s18,s47,2
s_add_u32 s18,s18,10494080
v_mov_b32 v1,s80
s_mov_b32 s65,15728640
s_add_u32 s66,s71,15728640
s_add_u32 s69,s71,15990784
s_mov_b32 s30,0x40000000
s_mov_b32 s51,0
L_cst_267:
s_cmp_lg_u32 s46,0
s_cbranch_scc1 L_csw_272
s_lshl_b32 s59,s51,13
s_lshl2_add_u32 s59,s47,s59
s_add_u32 s59,s59,10485888
L_ww_273:
s_sleep 1
buffer_load_dword v122,off,s[8:11],s59 sc1
s_sub_u32 s49,s49,1
s_cbranch_scc1 L_abort2
s_waitcnt vmcnt(0)
v_readfirstlane_b32 s61,v122
s_cmp_eq_u32 s61,0
s_cbranch_scc1 L_ww_273
L_wwd_274:
L_csw_272:
s_waitcnt lgkmcnt(0)
s_barrier
s_lshl_b32 s56,s51,5
s_add_u32 s56,s56,s47
s_mul_i32 s56,s56,24576
s_add_u32 s56,s56,150994944
s_add_u32 s67,s56,s73
s_add_u32 m0,s73,131072
s_add_u32 s57,s67,8192
buffer_load_dwordx4 v0,s[8:11],s67 offen sc1 lds
buffer_load_dwordx4 v0,s[8:11],s67 offen offset:1024 sc1 lds
s_add_u32 m0,s73,139264
s_add_u32 s67,s67,786432
buffer_load_dwordx4 v0,s[8:11],s57 offen sc1 lds
buffer_load_dwordx4 v0,s[8:11],s57 offen offset:1024 sc1 lds
s_lshl_b32 s75,s51,13
s_add_u32 s56,s75,12591104
buffer_load_dword v23,v10,s[8:11],s56 offen sc1
s_add_u32 s64,s75,12582912
s_add_u32 s70,s64,4096
s_lshl_b32 s68,s51,5
s_add_u32 s68,s68,s47
s_lshl_b32 s68,s68,12
s_lshl_b32 s56,s46,10
s_add_u32 s68,s68,s56
s_add_u32 s68,s68,58720256
s_mov_b32 s54,0x80000000
s_mov_b32 s77,0
s_add_u32 s56,s18,s75
s_buffer_load_dword s19,s[8:11],s56
s_cmp_eq_u32 s51,63
s_cselect_b32 s76,1,s46
s_cmp_eq_u32 s76,0
s_cselect_b32 s76,1,0
v_mov_b64 v[96:97],0
v_mov_b64 v[98:99],0
v_mov_b64 v[100:101],0
v_mov_b64 v[102:103],0
v_mov_b64 v[104:105],0
v_mov_b64 v[106:107],0
v_mov_b64 v[108:109],0
v_mov_b64 v[110:111],0
v_mov_b64 v[112:113],0
v_mov_b64 v[114:115],0
v_mov_b64 v[116:117],0
v_mov_b64 v[118:119],0
s_waitcnt vmcnt(0) lgkmcnt(0)
s_barrier
v_add_u32 v55,131072,v0
ds_read_b128 v[56:59],v55 offset:0
ds_read_b128 v[60:63],v55 offset:4096
ds_read_b128 v[64:67],v55 offset:1024
ds_read_b128 v[68:71],v55 offset:5120
ds_read_b128 v[72:75],v55 offset:2048
ds_read_b128 v[76:79],v55 offset:6144
ds_read_b128 v[80:83],v55 offset:3072
ds_read_b128 v[84:87],v55 offset:7168
v_add_u32 v123,s73,v55
ds_read_b128 v[88:91],v123 offset:8192
ds_read_b128 v[92:95],v123 offset:9216
v_xor_b32 v120,1024,v12
v_xor_b32 v121,2048,v12
v_xor_b32 v122,3072,v12
buffer_load_dwordx4 v[24:27],v13,s[8:11],s64 offen sc1
buffer_load_dwordx4 v[24:27],v13,s[8:11],s64 offen sc1
L_chain_275:
L_cpa_276:
buffer_load_dwordx4 v[24:27],v13,s[8:11],s64 offen sc1
s_sub_u32 s49,s49,1
s_cbranch_scc1 L_abort2
s_waitcnt vmcnt(2)
v_max3_u32 v123,v24,v25,v26
v_max_u32 v123,v27,v123
v_cmp_le_u32 vcc,s72,v123
ds_write_b128 v12,v[24:27] offset:0
s_cbranch_vccnz L_cpa_276
L_cgo_279:
v_smfmac_f32_16x16x64_bf16 v[96:99],v[24:27],a[0:7],v2
buffer_load_dwordx4 v[40:43],v13,s[8:11],s70 offen sc1
v_smfmac_f32_16x16x64_bf16 v[100:103],v[24:27],a[128:135],v2
s_waitcnt lgkmcnt(0)
s_barrier
ds_read_b128 v[28:31],v120 offset:0
v_smfmac_f32_16x16x64_bf16 v[104:107],v[24:27],a[8:15],v2
ds_read_b128 v[32:35],v121 offset:0
v_smfmac_f32_16x16x64_bf16 v[108:111],v[24:27],a[136:143],v2
ds_read_b128 v[36:39],v122 offset:0
v_smfmac_f32_16x16x64_bf16 v[112:115],v[24:27],v[128:135],v2
v_smfmac_f32_16x16x64_bf16 v[116:119],v[24:27],v[136:143],v2
s_waitcnt lgkmcnt(2)
v_smfmac_f32_16x16x64_bf16 v[96:99],v[28:31],a[16:23],v2
s_add_u32 m0,s73,131072
v_smfmac_f32_16x16x64_bf16 v[100:103],v[28:31],a[144:151],v2
s_add_u32 s57,s67,8192
v_smfmac_f32_16x16x64_bf16 v[104:107],v[28:31],a[24:31],v2
s_cmp_lt_u32 s19,s76
s_cbranch_scc1 L_ckw_268
L_ckb_269:
v_smfmac_f32_16x16x64_bf16 v[108:111],v[28:31],a[152:159],v2
s_waitcnt vmcnt(0) lgkmcnt(1)
v_smfmac_f32_16x16x64_bf16 v[96:99],v[32:35],a[32:39],v2
ds_write_b128 v12,v[40:43] offset:4096
v_max3_u32 v123,v40,v41,v42
v_smfmac_f32_16x16x64_bf16 v[100:103],v[32:35],a[160:167],v2
v_max_u32 v123,v43,v123
v_smfmac_f32_16x16x64_bf16 v[104:107],v[32:35],a[40:47],v2
v_cmp_le_u32 vcc,s72,v123
v_smfmac_f32_16x16x64_bf16 v[108:111],v[32:35],a[168:175],v2
v_smfmac_f32_16x16x64_bf16 v[112:115],v[28:31],v[144:151],v2
s_cbranch_vccnz L_cpb_282
L_cback_284:
s_waitcnt lgkmcnt(0)
s_barrier
v_smfmac_f32_16x16x64_bf16 v[96:99],v[36:39],a[48:55],v2
buffer_store_dword v54,v10,s[8:11],s30 offen sc1
v_smfmac_f32_16x16x64_bf16 v[100:103],v[36:39],a[176:183],v2
ds_read_b128 v[44:47],v120 offset:4096
v_smfmac_f32_16x16x64_bf16 v[104:107],v[36:39],a[56:63],v2
buffer_store_dwordx4 v[124:127],v0,s[8:11],s54 offen sc1
v_smfmac_f32_16x16x64_bf16 v[108:111],v[36:39],a[184:191],v2
ds_read_b128 v[48:51],v121 offset:4096
v_smfmac_f32_16x16x64_bf16 v[96:99],v[40:43],a[64:71],v2
buffer_load_dwordx4 v0,s[8:11],s67 offen sc1 lds
v_smfmac_f32_16x16x64_bf16 v[100:103],v[40:43],a[192:199],v2
ds_read_b128 v[52:55],v122 offset:4096
v_smfmac_f32_16x16x64_bf16 v[104:107],v[40:43],a[72:79],v2
buffer_load_dwordx4 v0,s[8:11],s67 offen offset:1024 sc1 lds
s_add_u32 m0,s73,139264
v_smfmac_f32_16x16x64_bf16 v[108:111],v[40:43],a[200:207],v2
s_waitcnt lgkmcnt(2)
v_smfmac_f32_16x16x64_bf16 v[96:99],v[44:47],a[80:87],v2
buffer_load_dwordx4 v0,s[8:11],s57 offen sc1 lds
s_add_u32 s67,s67,786432
v_smfmac_f32_16x16x64_bf16 v[100:103],v[44:47],a[208:215],v2
s_waitcnt lgkmcnt(1)
v_smfmac_f32_16x16x64_bf16 v[96:99],v[48:51],a[96:103],v2
buffer_load_dwordx4 v0,s[8:11],s57 offen offset:1024 sc1 lds
v_smfmac_f32_16x16x64_bf16 v[100:103],v[48:51],a[224:231],v2
s_waitcnt lgkmcnt(0)
v_smfmac_f32_16x16x64_bf16 v[96:99],v[52:55],a[112:119],v2
buffer_load_dword v23,v22,s[8:11],s75 offen sc1
v_smfmac_f32_16x16x64_bf16 v[100:103],v[52:55],a[240:247],v2
v_smfmac_f32_16x16x64_bf16 v[104:107],v[44:47],a[88:95],v2
v_smfmac_f32_16x16x64_bf16 v[108:111],v[44:47],a[216:223],v2
v_smfmac_f32_16x16x64_bf16 v[104:107],v[48:51],a[104:111],v2
v_add_f32 v96,v96,v98
v_smfmac_f32_16x16x64_bf16 v[108:111],v[48:51],a[232:239],v2
v_add_f32 v97,v97,v99
v_smfmac_f32_16x16x64_bf16 v[104:107],v[52:55],a[120:127],v2
v_cvt_pk_bf16_f32 v120,v96,v97
v_smfmac_f32_16x16x64_bf16 v[108:111],v[52:55],a[248:255],v2
v_add_f32 v100,v100,v102
v_smfmac_f32_16x16x64_bf16 v[116:119],v[28:31],v[152:159],v2
v_add_f32 v101,v101,v103
v_smfmac_f32_16x16x64_bf16 v[112:115],v[32:35],v[160:167],v2
v_cvt_pk_bf16_f32 v121,v100,v101
v_add_f32 v104,v104,v106
v_add_f32 v105,v105,v107
v_cvt_pk_bf16_f32 v122,v104,v105
v_add_f32 v108,v108,v110
v_add_f32 v109,v109,v111
v_cvt_pk_bf16_f32 v123,v108,v109
ds_write_b128 v4,v[120:123]
v_smfmac_f32_16x16x64_bf16 v[116:119],v[32:35],v[168:175],v2
s_mov_b32 s54,s68
s_add_u32 s68,s68,131072
v_mov_b32 v125,0
v_smfmac_f32_16x16x64_bf16 v[112:115],v[36:39],v[176:183],v2
s_cmp_eq_u32 s51,63
s_cbranch_scc1 L_cend_278
v_smfmac_f32_16x16x64_bf16 v[116:119],v[36:39],v[184:191],v2
v_smfmac_f32_16x16x64_bf16 v[112:115],v[40:43],v[192:199],v2
s_waitcnt lgkmcnt(0)
s_barrier
ds_read_b64_tr_b16 v[96:97],v5 offset:0
ds_read_b64_tr_b16 v[98:99],v6 offset:0
v_smfmac_f32_16x16x64_bf16 v[116:119],v[40:43],v[200:207],v2
ds_read_b64_tr_b16 v[100:101],v5 offset:1024
v_smfmac_f32_16x16x64_bf16 v[112:115],v[44:47],v[208:215],v2
ds_read_b64_tr_b16 v[102:103],v6 offset:1024
v_smfmac_f32_16x16x64_bf16 v[116:119],v[44:47],v[216:223],v2
ds_read_b64_tr_b16 v[104:105],v5 offset:2048
v_smfmac_f32_16x16x64_bf16 v[112:115],v[48:51],v[224:231],v2
ds_read_b64_tr_b16 v[106:107],v6 offset:2048
s_waitcnt lgkmcnt(4)
v_mfma_f32_16x16x32_bf16 v[24:27],v[56:59],v[96:99],0
ds_read_b64_tr_b16 v[108:109],v5 offset:3072
v_mfma_f32_16x16x32_bf16 v[28:31],v[60:63],v[96:99],0
ds_read_b64_tr_b16 v[110:111],v6 offset:3072
v_mfma_f32_16x16x32_bf16 v[32:35],v[96:99],v[96:99],0
ds_read_b128 v[40:43],v11 offset:12288
s_waitcnt lgkmcnt(5)
v_mfma_f32_16x16x32_bf16 v[24:27],v[64:67],v[100:103],v[24:27]
ds_read_b128 v[56:59],v11 offset:0
v_mfma_f32_16x16x32_bf16 v[28:31],v[68:71],v[100:103],v[28:31]
ds_read_b128 v[60:63],v11 offset:1024
v_mfma_f32_16x16x32_bf16 v[32:35],v[100:103],v[100:103],v[32:35]
ds_read_b128 v[96:99],v11 offset:8192
s_waitcnt lgkmcnt(6)
v_mfma_f32_16x16x32_bf16 v[24:27],v[72:75],v[104:107],v[24:27]
ds_read_b128 v[64:67],v11 offset:2048
v_mfma_f32_16x16x32_bf16 v[28:31],v[76:79],v[104:107],v[28:31]
ds_read_b128 v[68:71],v11 offset:3072
v_mfma_f32_16x16x32_bf16 v[32:35],v[104:107],v[104:107],v[32:35]
ds_read_b128 v[100:103],v11 offset:9216
s_waitcnt lgkmcnt(7)
v_mfma_f32_16x16x32_bf16 v[24:27],v[80:83],v[108:111],v[24:27]
ds_read_b128 v[72:75],v11 offset:4096
v_mfma_f32_16x16x32_bf16 v[28:31],v[84:87],v[108:111],v[28:31]
ds_read_b128 v[76:79],v11 offset:5120
v_mfma_f32_16x16x32_bf16 v[32:35],v[108:111],v[108:111],v[32:35]
ds_read_b128 v[104:107],v11 offset:10240
v_smfmac_f32_16x16x64_bf16 v[116:119],v[48:51],v[232:239],v2
ds_read_b128 v[80:83],v11 offset:6144
v_smfmac_f32_16x16x64_bf16 v[112:115],v[52:55],v[240:247],v2
ds_read_b128 v[84:87],v11 offset:7168
v_smfmac_f32_16x16x64_bf16 v[116:119],v[52:55],v[248:255],v2
ds_read_b128 v[108:111],v11 offset:11264
v_max3_f32 v126,v24,v25,v26
v_max3_f32 v127,v27,v28,v29
v_max3_f32 v126,v30,v31,v126
v_max3_f32 v127,v34,v35,v127
v_max_f32 v126,v126,v127
v_max_f32 v127,v126,v127
v_pk_mul_f32 v[34:35],v[34:35],v[0:1] op_sel:[0,1]
v_pk_mul_f32 v[24:25],v[24:25],v[0:1] op_sel:[0,1]
v_permlane16_swap_b32 v126,v127
v_max_f32 v126,v126,v127
v_max_f32 v127,v126,v127
v_pk_mul_f32 v[26:27],v[26:27],v[0:1] op_sel:[0,1]
v_pk_mul_f32 v[28:29],v[28:29],v[0:1] op_sel:[0,1]
v_permlane32_swap_b32 v126,v127
v_max_f32 v126,v126,v127
v_mul_f32 v126,v1,v126
v_pk_mul_f32 v[30:31],v[30:31],v[0:1] op_sel:[0,1]
v_pk_add_f32 v[34:35],v[34:35],v[126:127] op_sel_hi:[1,0] neg_lo:[0,1] neg_hi:[0,1]
v_pk_add_f32 v[112:113],v[112:113],v[114:115]
v_pk_add_f32 v[116:117],v[116:117],v[118:119]
v_pk_add_f32 v[24:25],v[24:25],v[126:127] op_sel_hi:[1,0] neg_lo:[0,1] neg_hi:[0,1]
v_pk_add_f32 v[26:27],v[26:27],v[126:127] op_sel_hi:[1,0] neg_lo:[0,1] neg_hi:[0,1]
v_pk_add_f32 v[28:29],v[28:29],v[126:127] op_sel_hi:[1,0] neg_lo:[0,1] neg_hi:[0,1]
v_pk_add_f32 v[30:31],v[30:31],v[126:127] op_sel_hi:[1,0] neg_lo:[0,1] neg_hi:[0,1]
v_exp_f32 v34,v34
v_exp_f32 v35,v35
v_cvt_pk_bf16_f32 v126,v112,v113
v_cvt_pk_bf16_f32 v124,v34,v35
v_cvt_pk_bf16_f32 v127,v116,v117
v_cvt_pk_bf16_f32 v36,v116,v117
v_mfma_f32_16x16x16_bf16 v[32:35],v[14:15],v[124:125],0
ds_read_b128 v[44:47],v11 offset:13312
v_exp_f32 v24,v24
v_mfma_f32_16x16x16_bf16 v[112:115],v[126:127],v[124:125],0
ds_read_b128 v[48:51],v11 offset:14336
v_exp_f32 v25,v25
v_mfma_f32_16x16x16_bf16 v[116:119],v[36:37],v[124:125],0
ds_read_b128 v[52:55],v11 offset:15360
v_exp_f32 v26,v26
v_exp_f32 v27,v27
v_cvt_pk_bf16_f32 v120,v24,v25
v_exp_f32 v28,v28
v_exp_f32 v29,v29
v_cvt_pk_bf16_f32 v121,v26,v27
v_exp_f32 v30,v30
v_exp_f32 v31,v31
v_cvt_pk_bf16_f32 v122,v28,v29
v_cvt_pk_bf16_f32 v123,v30,v31
s_add_u32 s75,s75,8192
s_add_u32 s51,s51,1
v_mfma_f32_16x16x32_bf16 v[32:35],v[14:17],v[120:123],v[32:35]
v_mfma_f32_16x16x32_bf16 v[112:115],v[88:91],v[120:123],v[112:115]
ds_read_b128 v[88:91],v11 offset:16384
v_mfma_f32_16x16x32_bf16 v[116:119],v[92:95],v[120:123],v[116:119]
ds_read_b128 v[92:95],v11 offset:17408
v_rcp_f32 v32,v32
v_mov_b64 v[24:25],-1
v_mov_b64 v[26:27],-1
s_add_u32 s64,s75,12582912
s_add_u32 s70,s64,4096
v_pk_mul_f32 v[112:113],v[112:113],v[32:33] op_sel_hi:[1,0]
v_pk_mul_f32 v[114:115],v[114:115],v[32:33] op_sel_hi:[1,0]
v_pk_mul_f32 v[116:117],v[116:117],v[32:33] op_sel_hi:[1,0]
v_pk_mul_f32 v[118:119],v[118:119],v[32:33] op_sel_hi:[1,0]
v_cvt_pk_bf16_f32 v120,v112,v116
v_cvt_pk_bf16_f32 v121,v113,v117
v_cvt_pk_bf16_f32 v122,v114,v118
v_cvt_pk_bf16_f32 v123,v115,v119
ds_write_b128 v7,v[120:123]
buffer_store_dwordx4 v[24:27],v0,s[8:11],s69 offen sc1
buffer_store_dwordx4 v[24:27],v0,s[8:11],s69 offen offset:1024 sc1
v_mov_b64 v[112:113],0
v_mov_b64 v[114:115],0
v_mov_b64 v[116:117],0
v_mov_b64 v[118:119],0
s_waitcnt lgkmcnt(0)
s_barrier
ds_read_b128 v[24:27],v8 offset:0
ds_read_b128 v[28:31],v8 offset:512
ds_read_b128 v[32:35],v8 offset:1024
ds_read_b128 v[36:39],v8 offset:1536
v_mov_b64 v[120:121],0
v_mov_b64 v[122:123],0
s_add_u32 s57,s65,65536
s_add_u32 s58,s65,131072
s_add_u32 s59,s65,196608
s_add_u32 s56,s18,s75
s_add_u32 s30,s75,17825792
s_waitcnt lgkmcnt(3)
v_smfmac_f32_16x16x64_bf16 v[112:115],v[24:27],v[56:63],v3
ds_read_b128 v[56:59],v11 offset:18432
s_waitcnt lgkmcnt(3)
v_smfmac_f32_16x16x64_bf16 v[112:115],v[28:31],v[64:71],v3
ds_read_b128 v[60:63],v11 offset:19456
s_waitcnt lgkmcnt(3)
v_smfmac_f32_16x16x64_bf16 v[112:115],v[32:35],v[72:79],v3
ds_read_b128 v[64:67],v11 offset:20480
s_waitcnt lgkmcnt(3)
v_smfmac_f32_16x16x64_bf16 v[112:115],v[36:39],v[80:87],v3
ds_read_b128 v[68:71],v11 offset:21504
v_smfmac_f32_16x16x64_bf16 v[116:119],v[24:27],v[96:103],v3
ds_read_b128 v[72:75],v11 offset:22528
v_smfmac_f32_16x16x64_bf16 v[116:119],v[28:31],v[104:111],v3
ds_read_b128 v[76:79],v11 offset:23552
v_cvt_pk_bf16_f32 v112,v112,v113
v_smfmac_f32_16x16x64_bf16 v[116:119],v[32:35],v[40:47],v3
ds_read_b128 v[80:83],v11 offset:24576
v_cvt_pk_bf16_f32 v113,v114,v115
buffer_store_dwordx2 v[112:113],v9,s[8:11],s65 offen sc1
v_smfmac_f32_16x16x64_bf16 v[116:119],v[36:39],v[48:55],v3
ds_read_b128 v[84:87],v11 offset:25600
v_mov_b64 v[112:113],0
v_smfmac_f32_16x16x64_bf16 v[120:123],v[24:27],v[88:95],v3
ds_read_b128 v[96:99],v11 offset:26624
ds_read_b128 v[100:103],v11 offset:27648
v_mov_b64 v[114:115],0
s_waitcnt lgkmcnt(8)
v_smfmac_f32_16x16x64_bf16 v[120:123],v[28:31],v[56:63],v3
ds_read_b128 v[104:107],v11 offset:28672
v_cvt_pk_bf16_f32 v116,v116,v117
s_waitcnt lgkmcnt(7)
v_smfmac_f32_16x16x64_bf16 v[120:123],v[32:35],v[64:71],v3
ds_read_b128 v[108:111],v11 offset:29696
ds_read_b128 v[40:43],v11 offset:30720
v_cvt_pk_bf16_f32 v117,v118,v119
buffer_store_dwordx2 v[116:117],v9,s[8:11],s57 offen sc1
s_waitcnt lgkmcnt(7)
v_smfmac_f32_16x16x64_bf16 v[120:123],v[36:39],v[72:79],v3
ds_read_b128 v[44:47],v11 offset:31744
v_add_u32 v52,s50,v5
s_waitcnt lgkmcnt(6)
v_smfmac_f32_16x16x64_bf16 v[112:115],v[24:27],v[80:87],v3
v_add_u32 v54,s50,v6
s_waitcnt lgkmcnt(4)
v_smfmac_f32_16x16x64_bf16 v[112:115],v[28:31],v[96:103],v3
ds_read_b64_tr_b16 v[52:53],v52
v_cvt_pk_bf16_f32 v120,v120,v121
s_waitcnt lgkmcnt(3)
v_smfmac_f32_16x16x64_bf16 v[112:115],v[32:35],v[104:111],v3
ds_read_b64_tr_b16 v[54:55],v54
v_cvt_pk_bf16_f32 v121,v122,v123
buffer_store_dwordx2 v[120:121],v9,s[8:11],s58 offen sc1
s_waitcnt lgkmcnt(2)
v_smfmac_f32_16x16x64_bf16 v[112:115],v[36:39],v[40:47],v3
v_mov_b64 v[116:117],0
v_mov_b64 v[118:119],0
s_xor_b32 s65,s65,262144
v_mov_b32_dpp v124,v126 quad_perm:[2,3,2,3] row_mask:0xf bank_mask:0xf
v_mov_b32_dpp v125,v127 quad_perm:[2,3,2,3] row_mask:0xf bank_mask:0xf
s_mov_b32 vcc_lo,0xcccccccc
s_mov_b32 vcc_hi,0xcccccccc
s_nop 0
v_cvt_pk_bf16_f32 v112,v112,v113
v_cvt_pk_bf16_f32 v113,v114,v115
buffer_store_dwordx2 v[112:113],v9,s[8:11],s59 offen sc1
s_waitcnt lgkmcnt(0)
s_buffer_load_dword s19,s[8:11],s56
v_cndmask_b32 v124,v124,v52,vcc
v_cndmask_b32 v125,v125,v53,vcc
v_cndmask_b32 v126,v126,v54,vcc
v_cndmask_b32 v127,v127,v55,vcc
s_cmp_lt_u32 s46,2
s_waitcnt vmcnt(3)
s_cbranch_scc1 L_crg_285
s_cmp_eq_u32 s46,2
s_waitcnt vmcnt(1)
s_cbranch_scc1 L_crg_285
s_waitcnt vmcnt(0)
L_crg_285:
buffer_load_dwordx4 v[32:35],v0,s[8:11],s66 offen offset:0 sc1
buffer_load_dwordx4 v[36:39],v0,s[8:11],s66 offen offset:1024 sc1
v_mov_b64 v[96:97],0
v_mov_b64 v[98:99],0
v_mov_b64 v[100:101],0
v_mov_b64 v[102:103],0
v_mov_b64 v[104:105],0
v_mov_b64 v[106:107],0
v_mov_b64 v[108:109],0
v_mov_b64 v[110:111],0
v_mov_b64 v[112:113],0
v_mov_b64 v[114:115],0
v_add_u32 v55,131072,v0
v_add_u32 v123,s73,v55
v_xor_b32 v120,1024,v12
v_xor_b32 v121,2048,v12
v_xor_b32 v122,3072,v12
buffer_load_dwordx4 v[44:47],v0,s[8:11],s66 offen offset:0 sc1
buffer_load_dwordx4 v[48:51],v0,s[8:11],s66 offen offset:1024 sc1
s_cmp_ge_u32 s51,63
s_cselect_b32 s76,0,1
s_cmp_eq_u32 s46,0
s_cselect_b32 s76,s76,0
s_waitcnt vmcnt(3)
v_mfma_f32_16x16x32_bf16 v[28:31],v[18:21],v[32:35],0
s_waitcnt vmcnt(2)
v_mfma_f32_16x16x32_bf16 v[28:31],v[18:21],v[36:39],v[28:31]
s_nop 7
v_cmp_u_f32 vcc,v28,v28
v_add_f32_dpp v52,v28,v28 row_ror:8 row_mask:0xf bank_mask:0x3
v_add_f32_dpp v53,v29,v29 row_ror:8 row_mask:0xf bank_mask:0x3
v_add_f32_dpp v52,v30,v30 row_ror:8 row_mask:0xf bank_mask:0xc
v_add_f32_dpp v53,v31,v31 row_ror:8 row_mask:0xf bank_mask:0xc
s_nop 0
v_add_f32_dpp v52,v52,v52 row_shl:4 row_mask:0xf bank_mask:0x5
v_add_f32_dpp v53,v53,v53 row_shl:4 row_mask:0xf bank_mask:0x5
s_cbranch_vccnz L_crp_280
L_cok_286:
v_cvt_pk_bf16_f32 v54,v52,v53
buffer_store_dword v54,v10,s[8:11],s64 offen sc1
s_mov_b32 s69,s66
s_xor_b32 s66,s66,262144
s_barrier
ds_read_b128 v[56:59],v55 offset:0
ds_read_b128 v[60:63],v55 offset:4096
ds_read_b128 v[64:67],v55 offset:1024
buffer_load_dwordx4 v[24:27],v13,s[8:11],s64 offen sc1
ds_read_b128 v[68:71],v55 offset:5120
ds_read_b128 v[72:75],v55 offset:2048
ds_read_b128 v[76:79],v55 offset:6144
ds_read_b128 v[80:83],v55 offset:3072
buffer_load_dwordx4 v[24:27],v13,s[8:11],s64 offen sc1
ds_read_b128 v[84:87],v55 offset:7168
ds_read_b128 v[88:91],v123 offset:8192
ds_read_b128 v[92:95],v123 offset:9216
s_branch L_chain_275
L_cpb_282:
buffer_load_dwordx4 v[40:43],v13,s[8:11],s70 offen sc1
s_sub_u32 s49,s49,1
s_cbranch_scc1 L_abort2
s_waitcnt vmcnt(0)
v_max3_u32 v123,v40,v41,v42
v_max_u32 v123,v43,v123
v_cmp_le_u32 vcc,s72,v123
s_cbranch_vccnz L_cpb_282
ds_write_b128 v12,v[40:43] offset:4096
s_branch L_cback_284
L_crp_280:
buffer_load_dwordx4 v[32:35],v0,s[8:11],s66 offen offset:0 sc1
buffer_load_dwordx4 v[36:39],v0,s[8:11],s66 offen offset:1024 sc1
s_sub_u32 s49,s49,1
s_cbranch_scc1 L_abort2
s_waitcnt vmcnt(3)
v_mfma_f32_16x16x32_bf16 v[28:31],v[18:21],v[44:47],0
s_waitcnt vmcnt(2)
v_mfma_f32_16x16x32_bf16 v[28:31],v[18:21],v[48:51],v[28:31]
s_nop 7
v_cmp_u_f32 vcc,v28,v28
v_add_f32_dpp v52,v28,v28 row_ror:8 row_mask:0xf bank_mask:0x3
v_add_f32_dpp v53,v29,v29 row_ror:8 row_mask:0xf bank_mask:0x3
v_add_f32_dpp v52,v30,v30 row_ror:8 row_mask:0xf bank_mask:0xc
v_add_f32_dpp v53,v31,v31 row_ror:8 row_mask:0xf bank_mask:0xc
s_nop 0
v_add_f32_dpp v52,v52,v52 row_shl:4 row_mask:0xf bank_mask:0x5
v_add_f32_dpp v53,v53,v53 row_shl:4 row_mask:0xf bank_mask:0x5
s_cbranch_vccz L_cok_286
buffer_load_dwordx4 v[44:47],v0,s[8:11],s66 offen offset:0 sc1
buffer_load_dwordx4 v[48:51],v0,s[8:11],s66 offen offset:1024 sc1
s_sub_u32 s49,s49,1
s_cbranch_scc1 L_abort2
s_waitcnt vmcnt(3)
v_mfma_f32_16x16x32_bf16 v[28:31],v[18:21],v[32:35],0
s_waitcnt vmcnt(2)
v_mfma_f32_16x16x32_bf16 v[28:31],v[18:21],v[36:39],v[28:31]
s_nop 7
v_cmp_u_f32 vcc,v28,v28
v_add_f32_dpp v52,v28,v28 row_ror:8 row_mask:0xf bank_mask:0x3
v_add_f32_dpp v53,v29,v29 row_ror:8 row_mask:0xf bank_mask:0x3
v_add_f32_dpp v52,v30,v30 row_ror:8 row_mask:0xf bank_mask:0xc
v_add_f32_dpp v53,v31,v31 row_ror:8 row_mask:0xf bank_mask:0xc
s_nop 0
v_add_f32_dpp v52,v52,v52 row_shl:4 row_mask:0xf bank_mask:0x5
v_add_f32_dpp v53,v53,v53 row_shl:4 row_mask:0xf bank_mask:0x5
s_cbranch_vccz L_cok_286
s_branch L_crp_280
L_ckw_268:
s_add_u32 s59,s18,s75
L_ww_287:
s_sleep 1
buffer_load_dword v23,off,s[8:11],s59 sc1
s_sub_u32 s49,s49,1
s_cbranch_scc1 L_abort2
s_waitcnt vmcnt(0)
v_readfirstlane_b32 s76,v23
s_cmp_eq_u32 s76,0
s_cbranch_scc1 L_ww_287
L_wwd_288:
s_branch L_ckb_269
L_cend_278:
v_smfmac_f32_16x16x64_bf16 v[116:119],v[36:39],v[184:191],v2
v_smfmac_f32_16x16x64_bf16 v[112:115],v[40:43],v[192:199],v2
v_smfmac_f32_16x16x64_bf16 v[116:119],v[40:43],v[200:207],v2
v_smfmac_f32_16x16x64_bf16 v[112:115],v[44:47],v[208:215],v2
v_smfmac_f32_16x16x64_bf16 v[116:119],v[44:47],v[216:223],v2
v_smfmac_f32_16x16x64_bf16 v[112:115],v[48:51],v[224:231],v2
v_smfmac_f32_16x16x64_bf16 v[116:119],v[48:51],v[232:239],v2
v_smfmac_f32_16x16x64_bf16 v[112:115],v[52:55],v[240:247],v2
v_smfmac_f32_16x16x64_bf16 v[116:119],v[52:55],v[248:255],v2
s_waitcnt lgkmcnt(0)
s_nop 2
v_pk_add_f32 v[112:113],v[112:113],v[114:115]
s_nop 2
v_pk_add_f32 v[116:117],v[116:117],v[118:119]
v_cvt_pk_bf16_f32 v126,v112,v113
v_cvt_pk_bf16_f32 v127,v116,v117
v_add_u32 v52,s50,v5
v_add_u32 v54,s50,v6
ds_read_b64_tr_b16 v[52:53],v52
ds_read_b64_tr_b16 v[54:55],v54
v_mov_b32_dpp v124,v126 quad_perm:[2,3,2,3] row_mask:0xf bank_mask:0xf
v_mov_b32_dpp v125,v127 quad_perm:[2,3,2,3] row_mask:0xf bank_mask:0xf
s_mov_b32 vcc_lo,0xcccccccc
s_mov_b32 vcc_hi,0xcccccccc
s_waitcnt lgkmcnt(0)
v_cndmask_b32 v124,v124,v52,vcc
v_cndmask_b32 v125,v125,v53,vcc
v_cndmask_b32 v126,v126,v54,vcc
v_cndmask_b32 v127,v127,v55,vcc
buffer_store_dwordx4 v[124:127],v0,s[8:11],s54 offen sc1
s_mov_b32 s51,64
s_waitcnt vmcnt(0)
s_barrier
s_nop 11
v_lshrrev_b32 v1,4,v0
s_endpgm
L_rc2_238:
v_and_b32 v120,15,v1
v_lshrrev_b32 v121,4,v1
v_and_b32 v122,2,v1
v_cmp_eq_u32 vcc,0,v122
v_mov_b32 v2,0xeeee
v_mov_b32 v123,0x4444
v_cndmask_b32 v2,v2,v123,vcc
v_and_b32 v122,1,v1
v_cmp_eq_u32 vcc,0,v122
v_mov_b32 v3,0xdddd
v_mov_b32 v123,0x8888
v_cndmask_b32 v3,v3,v123,vcc
v_lshrrev_b32 v122,1,v120
v_bfe_u32 v123,v120,2,1
v_xor_b32 v123,v123,v122
v_lshlrev_b32 v4,7,v123
v_and_b32 v123,1,v120
v_lshl_add_u32 v4,v123,6,v4
v_xor_b32 v123,v121,v122
v_and_b32 v123,3,v123
v_lshl_add_u32 v4,v123,4,v4
s_lshl_b32 s56,s46,10
s_add_u32 s56,s56,147456
v_add_u32 v4,s56,v4
v_lshlrev_b32 v122,1,v121
v_add_u32 v122,0,v122
v_and_b32 v123,1,v121
v_xor_b32 v123,v123,v122
v_lshlrev_b32 v5,7,v123
v_bfe_u32 v123,v120,3,1
v_lshl_add_u32 v5,v123,6,v5
v_xor_b32 v123,v120,v122
v_and_b32 v123,3,v123
v_lshl_add_u32 v5,v123,4,v5
v_bfe_u32 v123,v120,2,1
v_lshl_add_u32 v5,v123,3,v5
v_add_u32 v5,147456,v5
v_lshlrev_b32 v122,1,v121
v_add_u32 v122,1,v122
v_and_b32 v123,1,v121
v_xor_b32 v123,v123,v122
v_lshlrev_b32 v6,7,v123
v_bfe_u32 v123,v120,3,1
v_lshl_add_u32 v6,v123,6,v6
v_xor_b32 v123,v120,v122
v_and_b32 v123,3,v123
v_lshl_add_u32 v6,v123,4,v6
v_bfe_u32 v123,v120,2,1
v_lshl_add_u32 v6,v123,3,v6
v_add_u32 v6,147456,v6
v_lshlrev_b32 v7,7,v121
v_lshrrev_b32 v122,1,v120
v_lshl_add_u32 v8,v122,4,v7
v_add_u32 v8,151552,v8
v_lshrrev_b32 v122,2,v120
v_lshl_add_u32 v7,v122,5,v7
v_and_b32 v122,1,v120
v_lshl_add_u32 v7,v122,4,v7
v_and_b32 v122,2,v120
v_cmp_eq_u32 vcc,0,v122
s_lshl_b32 s56,s46,9
v_mov_b32 v122,2048
v_mov_b32 v123,s56
v_cndmask_b32 v122,v122,v123,vcc
v_add_u32 v7,v122,v7
v_add_u32 v7,151552,v7
v_lshrrev_b32 v122,3,v1
v_lshlrev_b32 v9,11,v122
v_and_b32 v122,7,v1
v_lshl_add_u32 v9,v122,3,v9
s_lshl_b32 s56,s46,14
s_lshl_b32 s57,s47,6
s_add_u32 s56,s56,s57
v_add_u32 v9,s56,v9
s_lshl_b32 s71,s46,5
s_add_u32 s71,s71,s47
s_bfe_u32 s56,s71,0x10003
s_lshl_b32 s56,s56,11
s_and_b32 s57,s71,1
s_lshl_b32 s57,s57,10
s_add_u32 s56,s56,s57
s_bfe_u32 s57,s71,0x10002
s_lshl_b32 s57,s57,9
s_add_u32 s56,s56,s57
s_bfe_u32 s57,s71,0x10001
s_lshl_b32 s57,s57,6
s_add_u32 s56,s56,s57
s_bfe_u32 s57,s71,0x10004
s_lshl_b32 s57,s57,8
s_add_u32 s56,s56,s57
s_bfe_u32 s57,s71,0x10005
s_lshl_b32 s57,s57,7
s_add_u32 s56,s56,s57
s_bfe_u32 s57,s71,0x10006
s_lshl_b32 s57,s57,12
s_add_u32 s56,s56,s57
v_and_b32 v122,3,v120
v_lshlrev_b32 v10,2,v122
v_bfe_u32 v122,v120,3,1
v_lshl_add_u32 v10,v122,4,v10
v_and_b32 v122,1,v121
v_lshl_add_u32 v10,v122,5,v10
v_add_u32 v10,s56,v10
v_and_b32 v123,36,v1
v_mov_b32 v122,0x80000000
v_cmp_eq_u32 vcc,0,v123
s_nop 1
v_cndmask_b32 v10,v122,v10,vcc
s_lshl_b32 s71,s71,11
s_lshl_b32 s73,s46,11
s_mov_b32 s72,0xffc00000
s_mov_b32 s74,0
v_and_b32 v11,1,v121
v_xor_b32 v11,v11,v120
v_and_b32 v11,3,v11
v_lshrrev_b32 v122,2,v120
v_lshl_add_u32 v11,v11,2,v122
v_lshl_add_u32 v11,v121,4,v11
v_lshlrev_b32 v11,4,v11
s_lshl_b32 s56,s46,15
v_add_u32 v11,s56,v11
v_lshrrev_b32 v13,3,v1
v_lshlrev_b32 v13,9,v13
v_and_b32 v122,7,v1
v_lshl_add_u32 v13,v122,4,v13
v_and_b32 v122,15,v1
v_and_b32 v123,1,v1
v_lshlrev_b32 v123,4,v123
v_mov_b32 v124,0x3f80
v_lshlrev_b32 v124,v123,v124
v_lshrrev_b32 v122,1,v122
v_cmp_eq_u32 vcc,0,v122
s_nop 1
v_cndmask_b32 v18,0,v124,vcc
v_cmp_eq_u32 vcc,1,v122
s_nop 1
v_cndmask_b32 v19,0,v124,vcc
v_cmp_eq_u32 vcc,2,v122
s_nop 1
v_cndmask_b32 v20,0,v124,vcc
v_cmp_eq_u32 vcc,3,v122
s_nop 1
v_cndmask_b32 v21,0,v124,vcc
s_and_b32 s56,s46,1
s_lshl_b32 s56,s56,8
s_and_b32 s57,s46,2
s_lshl_b32 s57,s57,6
s_add_u32 s56,s56,s57
v_add_u32 v13,s56,v13
s_add_u32 s56,s50,155648
v_add_u32 v12,s56,v0
v_mov_b64 v[14:15],s[28:29]
v_mov_b64 v[16:17],s[28:29]
v_add_u32 v22,13647872,v10
s_lshl_b32 s18,s47,2
s_add_u32 s18,s18,10494080
v_mov_b32 v1,s80
s_mov_b32 s65,16777216
s_add_u32 s66,s71,16777216
s_add_u32 s69,s71,17039360
s_mov_b32 s30,0x40000000
s_mov_b32 s51,0
v_lshrrev_b32 v120,2,v0
v_add_u32 v120,10510464,v120
v_or_b32 v120,s52,v120
s_mov_b64 vcc,-1
s_mov_b32 vcc_lo,0
v_cndmask_b32 v22,v22,v120,vcc
s_or_b32 s56,s52,10495616
v_writelane_b32 v22,s56,4
s_or_b32 s56,s47,s46
s_mov_b32 s56,10486784
s_cmov_b32 s56,0x80000000
v_writelane_b32 v22,s56,5
s_mov_b32 s30,0
s_mov_b32 s31,0
L_cst_292:
s_cmp_lg_u32 s46,0
s_cbranch_scc1 L_csw_297
s_andn2_b32 s61,0x7ff,s30
s_lshr_b32 s61,s61,5
s_add_u32 s61,s61,2
s_add_u32 s60,s31,1
s_min_u32 s60,s60,63
s_cmp_gt_u32 s60,s61
s_cselect_b32 s60,s31,s60
s_sub_u32 s61,s60,s31
s_lshl_b32 s61,s61,13
s_lshl_b32 s59,s31,13
s_add_u32 s59,s59,10486016
v_lshrrev_b32 v121,2,v0
v_and_b32 v121,127,v121
v_lshrrev_b32 v120,9,v0
v_mul_u32_u24 v120,s61,v120
v_add_u32 v121,v120,v121
L_ckk_298:
s_sleep 1
buffer_load_dword v120,v121,s[8:11],s59 offen sc1
s_sub_u32 s49,s49,1
s_cbranch_scc1 L_abort2
s_waitcnt vmcnt(0)
v_cmp_eq_u32 vcc,0,v120
s_cbranch_vccnz L_ckk_298
v_max_u32_dpp v120,v120,v120 row_ror:8 row_mask:0xf bank_mask:0xf
s_nop 1
v_max_u32_dpp v120,v120,v120 row_ror:4 row_mask:0xf bank_mask:0xf
s_nop 1
v_max_u32_dpp v120,v120,v120 row_ror:2 row_mask:0xf bank_mask:0xf
s_nop 1
v_max_u32_dpp v120,v120,v120 row_ror:1 row_mask:0xf bank_mask:0xf
v_mov_b32 v121,v120
s_nop 1
v_permlane16_swap_b32 v120,v121
v_max_u32 v120,v120,v121
v_mov_b32 v121,v120
s_nop 1
v_permlane32_swap_b32 v120,v121
v_max_u32 v120,v120,v121
s_nop 0
v_readfirstlane_b32 s61,v120
s_max_u32 s30,s30,s61
s_add_u32 s31,s60,1
s_andn2_b32 s51,0x7ff,s30
s_lshr_b32 s51,s51,5
s_add_u32 s61,s51,2
s_min_u32 s61,s61,63
s_cmp_le_u32 s31,s61
s_cbranch_scc1 L_cst_292
v_mov_b32 v120,0
v_mov_b32 v121,s30
ds_write_b32 v8,v120 offset:2560
ds_write_b32 v8,v121 offset:3072
s_lshl_b32 s59,s51,13
s_lshl2_add_u32 s59,s47,s59
s_add_u32 s59,s59,10485888
L_ww_299:
s_sleep 1
buffer_load_dword v122,off,s[8:11],s59 sc1
s_sub_u32 s49,s49,1
s_cbranch_scc1 L_abort2
s_waitcnt vmcnt(0)
v_readfirstlane_b32 s61,v122
s_cmp_eq_u32 s61,0
s_cbranch_scc1 L_ww_299
L_wwd_300:
L_csw_297:
s_waitcnt lgkmcnt(0)
s_barrier
ds_read_b32 v120,v8 offset:3072
s_waitcnt lgkmcnt(0)
v_readfirstlane_b32 s30,v120
s_andn2_b32 s51,0x7ff,s30
s_lshr_b32 s51,s51,5
s_lshl_b32 s56,s51,5
s_add_u32 s56,s56,s47
s_mul_i32 s56,s56,24576
s_add_u32 s56,s56,150994944
s_add_u32 s67,s56,s73
s_add_u32 m0,s73,131072
s_add_u32 s57,s67,8192
buffer_load_dwordx4 v0,s[8:11],s67 offen sc1 lds
buffer_load_dwordx4 v0,s[8:11],s67 offen offset:1024 sc1 lds
s_add_u32 m0,s73,139264
s_add_u32 s67,s67,786432
buffer_load_dwordx4 v0,s[8:11],s57 offen sc1 lds
buffer_load_dwordx4 v0,s[8:11],s57 offen offset:1024 sc1 lds
s_lshl_b32 s75,s51,13
s_add_u32 s56,s75,13639680
buffer_load_dword v23,v10,s[8:11],s56 offen sc1
s_add_u32 s64,s75,17825792
s_add_u32 s70,s64,4096
s_lshl_b32 s68,s51,5
s_add_u32 s68,s68,s47
s_lshl_b32 s68,s68,12
s_lshl_b32 s56,s46,10
s_add_u32 s68,s68,s56
s_add_u32 s68,s68,75497472
s_mov_b32 s54,0x80000000
s_mov_b32 s77,0
s_add_u32 s56,s18,s75
s_buffer_load_dword s19,s[8:11],s56
s_cmp_eq_u32 s51,63
s_cselect_b32 s76,1,s46
s_cmp_eq_u32 s76,0
s_cselect_b32 s76,1,0
v_mov_b64 v[96:97],0
v_mov_b64 v[98:99],0
v_mov_b64 v[100:101],0
v_mov_b64 v[102:103],0
v_mov_b64 v[104:105],0
v_mov_b64 v[106:107],0
v_mov_b64 v[108:109],0
v_mov_b64 v[110:111],0
v_mov_b64 v[112:113],0
v_mov_b64 v[114:115],0
v_mov_b64 v[116:117],0
v_mov_b64 v[118:119],0
v_lshrrev_b32 v56,8,v0
v_lshlrev_b32 v56,5,v56
v_bfe_u32 v57,v0,5,1
v_lshl_add_u32 v56,v57,2,v56
s_lshl_b32 s56,s46,7
s_add_u32 s56,s56,155648
v_add_u32 v56,s56,v56
v_xor_b32 v57,128,v56
v_xor_b32 v58,256,v56
v_xor_b32 v59,384,v56
s_andn2_b32 s56,31,s30
s_lshr_b32 s57,s56,4
s_lshl_b32 s58,s57,12
s_and_b32 s59,s56,15
s_lshl4_add_u32 s58,s59,s58
s_add_u32 s58,s58,s50
s_add_u32 s58,s58,131072
v_bfe_u32 v60,v0,6,2
v_lshlrev_b32 v60,8,v60
v_bfe_u32 v61,v0,4,2
v_lshl_add_u32 v60,v61,2,v60
v_add_u32 v60,s58,v60
s_lshr_b32 s58,s59,2
s_lshl_b32 s58,s58,8
s_lshl3_add_u32 s58,s57,s58
s_and_b32 s59,s56,3
s_lshl1_add_u32 s58,s59,s58
s_add_u32 s58,s58,s73
s_add_u32 s58,s58,139264
v_and_b32 v61,255,v0
v_add_u32 v61,s58,v61
s_cmp_lg_u32 s46,0
s_cbranch_scc1 L_chd_302
s_lshl_b32 s59,s51,10
s_add_u32 s59,s59,11337728
L_chp_301:
buffer_load_dwordx4 v[120:123],v0,s[8:11],s59 offen sc1
s_sub_u32 s49,s49,1
s_cbranch_scc1 L_abort2
s_waitcnt vmcnt(0)
v_max3_u32 v124,v120,v121,v122
v_max_u32 v124,v123,v124
v_cmp_eq_u32 vcc,-1,v124
s_cbranch_vccnz L_chp_301
ds_write_b128 v12,v[120:123]
L_chd_302:
s_waitcnt vmcnt(0) lgkmcnt(0)
s_barrier
ds_read2_b32 v[24:25],v56 offset0:0 offset1:2
ds_read2_b32 v[26:27],v56 offset0:4 offset1:6
ds_read2_b32 v[28:29],v57 offset0:0 offset1:2
ds_read2_b32 v[30:31],v57 offset0:4 offset1:6
ds_read2_b32 v[32:33],v58 offset0:0 offset1:2
ds_read2_b32 v[34:35],v58 offset0:4 offset1:6
ds_read2_b32 v[36:37],v59 offset0:0 offset1:2
ds_read2_b32 v[38:39],v59 offset0:4 offset1:6
s_waitcnt lgkmcnt(4)
ds_read2_b32 v[40:41],v56 offset0:128 offset1:130
ds_read2_b32 v[42:43],v56 offset0:132 offset1:134
ds_read2_b32 v[44:45],v57 offset0:128 offset1:130
ds_read2_b32 v[46:47],v57 offset0:132 offset1:134
ds_read2_b32 v[48:49],v58 offset0:128 offset1:130
ds_read2_b32 v[50:51],v58 offset0:132 offset1:134
ds_read2_b32 v[52:53],v59 offset0:128 offset1:130
ds_read2_b32 v[54:55],v59 offset0:132 offset1:134
s_waitcnt lgkmcnt(12)
v_smfmac_f32_16x16x64_bf16 v[100:103],v[24:27],a[128:135],v2
v_smfmac_f32_16x16x64_bf16 v[112:115],v[24:27],v[128:135],v2
v_smfmac_f32_16x16x64_bf16 v[108:111],v[24:27],a[136:143],v2
v_smfmac_f32_16x16x64_bf16 v[116:119],v[24:27],v[136:143],v2
s_waitcnt lgkmcnt(12)
v_smfmac_f32_16x16x64_bf16 v[100:103],v[28:31],a[144:151],v2
v_smfmac_f32_16x16x64_bf16 v[112:115],v[28:31],v[144:151],v2
v_smfmac_f32_16x16x64_bf16 v[108:111],v[28:31],a[152:159],v2
v_smfmac_f32_16x16x64_bf16 v[116:119],v[28:31],v[152:159],v2
s_waitcnt lgkmcnt(10)
v_smfmac_f32_16x16x64_bf16 v[100:103],v[32:35],a[160:167],v2
v_smfmac_f32_16x16x64_bf16 v[112:115],v[32:35],v[160:167],v2
v_smfmac_f32_16x16x64_bf16 v[108:111],v[32:35],a[168:175],v2
v_smfmac_f32_16x16x64_bf16 v[116:119],v[32:35],v[168:175],v2
s_waitcnt lgkmcnt(8)
v_smfmac_f32_16x16x64_bf16 v[100:103],v[36:39],a[176:183],v2
v_smfmac_f32_16x16x64_bf16 v[112:115],v[36:39],v[176:183],v2
v_smfmac_f32_16x16x64_bf16 v[108:111],v[36:39],a[184:191],v2
v_smfmac_f32_16x16x64_bf16 v[116:119],v[36:39],v[184:191],v2
s_waitcnt lgkmcnt(6)
v_smfmac_f32_16x16x64_bf16 v[100:103],v[40:43],a[192:199],v2
v_smfmac_f32_16x16x64_bf16 v[112:115],v[40:43],v[192:199],v2
v_smfmac_f32_16x16x64_bf16 v[108:111],v[40:43],a[200:207],v2
v_smfmac_f32_16x16x64_bf16 v[116:119],v[40:43],v[200:207],v2
s_waitcnt lgkmcnt(4)
v_smfmac_f32_16x16x64_bf16 v[100:103],v[44:47],a[208:215],v2
v_smfmac_f32_16x16x64_bf16 v[112:115],v[44:47],v[208:215],v2
v_smfmac_f32_16x16x64_bf16 v[108:111],v[44:47],a[216:223],v2
v_smfmac_f32_16x16x64_bf16 v[116:119],v[44:47],v[216:223],v2
s_waitcnt lgkmcnt(2)
v_smfmac_f32_16x16x64_bf16 v[100:103],v[48:51],a[224:231],v2
v_smfmac_f32_16x16x64_bf16 v[112:115],v[48:51],v[224:231],v2
v_smfmac_f32_16x16x64_bf16 v[108:111],v[48:51],a[232:239],v2
v_smfmac_f32_16x16x64_bf16 v[116:119],v[48:51],v[232:239],v2
s_waitcnt lgkmcnt(0)
v_smfmac_f32_16x16x64_bf16 v[100:103],v[52:55],a[240:247],v2
v_smfmac_f32_16x16x64_bf16 v[112:115],v[52:55],v[240:247],v2
v_smfmac_f32_16x16x64_bf16 v[108:111],v[52:55],a[248:255],v2
v_smfmac_f32_16x16x64_bf16 v[116:119],v[52:55],v[248:255],v2
v_add_f32 v100,v100,v102
v_add_f32 v112,v112,v114
s_nop 1
v_add_f32 v108,v108,v110
s_nop 2
v_add_f32 v116,v116,v118
v_cvt_pk_bf16_f32 v120,v100,v108
v_cvt_pk_bf16_f32 v121,v112,v116
ds_write_b32 v60,v120
ds_write_b16 v61,v121
ds_write_b16_d16_hi v61,v121 offset:1024
v_mov_b64 v[96:97],0
v_mov_b64 v[98:99],0
v_mov_b64 v[100:101],0
v_mov_b64 v[102:103],0
v_mov_b64 v[104:105],0
v_mov_b64 v[106:107],0
v_mov_b64 v[108:109],0
v_mov_b64 v[110:111],0
v_mov_b64 v[112:113],0
v_mov_b64 v[114:115],0
v_mov_b64 v[116:117],0
v_mov_b64 v[118:119],0
s_waitcnt vmcnt(0) lgkmcnt(0)
s_barrier
v_add_u32 v55,131072,v0
ds_read_b128 v[56:59],v55 offset:0
ds_read_b128 v[60:63],v55 offset:4096
ds_read_b128 v[64:67],v55 offset:1024
ds_read_b128 v[68:71],v55 offset:5120
ds_read_b128 v[72:75],v55 offset:2048
ds_read_b128 v[76:79],v55 offset:6144
ds_read_b128 v[80:83],v55 offset:3072
ds_read_b128 v[84:87],v55 offset:7168
v_add_u32 v123,s73,v55
ds_read_b128 v[88:91],v123 offset:8192
ds_read_b128 v[92:95],v123 offset:9216
v_xor_b32 v120,1024,v12
v_xor_b32 v121,2048,v12
v_xor_b32 v122,3072,v12
buffer_load_dwordx4 v[24:27],v13,s[8:11],s64 offen sc1
buffer_load_dwordx4 v[24:27],v13,s[8:11],s64 offen sc1
L_chain_303:
L_cpa_304:
buffer_load_dwordx4 v[24:27],v13,s[8:11],s64 offen sc1
s_sub_u32 s49,s49,1
s_cbranch_scc1 L_abort2
s_waitcnt vmcnt(2)
v_max3_u32 v123,v24,v25,v26
v_max_u32 v123,v27,v123
v_cmp_le_u32 vcc,s72,v123
ds_write_b128 v12,v[24:27] offset:0
s_cbranch_vccnz L_cpa_304
L_cgo_307:
v_smfmac_f32_16x16x64_bf16 v[96:99],v[24:27],a[0:7],v2
buffer_load_dwordx4 v[40:43],v13,s[8:11],s70 offen sc1
v_smfmac_f32_16x16x64_bf16 v[100:103],v[24:27],a[128:135],v2
s_waitcnt lgkmcnt(0)
s_barrier
ds_read_b128 v[28:31],v120 offset:0
v_smfmac_f32_16x16x64_bf16 v[104:107],v[24:27],a[8:15],v2
ds_read_b128 v[32:35],v121 offset:0
v_smfmac_f32_16x16x64_bf16 v[108:111],v[24:27],a[136:143],v2
ds_read_b128 v[36:39],v122 offset:0
v_smfmac_f32_16x16x64_bf16 v[112:115],v[24:27],v[128:135],v2
v_smfmac_f32_16x16x64_bf16 v[116:119],v[24:27],v[136:143],v2
s_waitcnt lgkmcnt(2)
v_smfmac_f32_16x16x64_bf16 v[96:99],v[28:31],a[16:23],v2
s_add_u32 m0,s73,131072
v_smfmac_f32_16x16x64_bf16 v[100:103],v[28:31],a[144:151],v2
s_add_u32 s57,s67,8192
v_smfmac_f32_16x16x64_bf16 v[104:107],v[28:31],a[24:31],v2
s_cmp_lt_u32 s19,s76
s_cbranch_scc1 L_ckw_293
L_ckb_294:
v_smfmac_f32_16x16x64_bf16 v[108:111],v[28:31],a[152:159],v2
s_waitcnt vmcnt(0) lgkmcnt(1)
v_smfmac_f32_16x16x64_bf16 v[96:99],v[32:35],a[32:39],v2
ds_write_b128 v12,v[40:43] offset:4096
v_max3_u32 v123,v40,v41,v42
v_smfmac_f32_16x16x64_bf16 v[100:103],v[32:35],a[160:167],v2
v_max_u32 v123,v43,v123
v_smfmac_f32_16x16x64_bf16 v[104:107],v[32:35],a[40:47],v2
v_cmp_le_u32 vcc,s72,v123
v_smfmac_f32_16x16x64_bf16 v[108:111],v[32:35],a[168:175],v2
v_smfmac_f32_16x16x64_bf16 v[112:115],v[28:31],v[144:151],v2
s_cbranch_vccnz L_cpb_310
L_cback_312:
s_waitcnt lgkmcnt(0)
s_barrier
v_smfmac_f32_16x16x64_bf16 v[96:99],v[36:39],a[48:55],v2
buffer_store_dwordx4 v[124:127],v0,s[8:11],s54 offen sc1
v_smfmac_f32_16x16x64_bf16 v[100:103],v[36:39],a[176:183],v2
ds_read_b128 v[44:47],v120 offset:4096
v_smfmac_f32_16x16x64_bf16 v[104:107],v[36:39],a[56:63],v2
buffer_load_dwordx4 v0,s[8:11],s67 offen sc1 lds
v_smfmac_f32_16x16x64_bf16 v[108:111],v[36:39],a[184:191],v2
ds_read_b128 v[48:51],v121 offset:4096
v_smfmac_f32_16x16x64_bf16 v[96:99],v[40:43],a[64:71],v2
buffer_load_dwordx4 v0,s[8:11],s67 offen offset:1024 sc1 lds
s_add_u32 m0,s73,139264
v_smfmac_f32_16x16x64_bf16 v[100:103],v[40:43],a[192:199],v2
ds_read_b128 v[52:55],v122 offset:4096
v_smfmac_f32_16x16x64_bf16 v[104:107],v[40:43],a[72:79],v2
buffer_load_dwordx4 v0,s[8:11],s57 offen sc1 lds
s_add_u32 s67,s67,786432
v_smfmac_f32_16x16x64_bf16 v[108:111],v[40:43],a[200:207],v2
ds_read_b32 v123,v8 offset:2560
s_waitcnt lgkmcnt(3)
v_smfmac_f32_16x16x64_bf16 v[96:99],v[44:47],a[80:87],v2
buffer_load_dwordx4 v0,s[8:11],s57 offen offset:1024 sc1 lds
v_smfmac_f32_16x16x64_bf16 v[100:103],v[44:47],a[208:215],v2
s_waitcnt lgkmcnt(2)
v_smfmac_f32_16x16x64_bf16 v[96:99],v[48:51],a[96:103],v2
buffer_load_dword v23,v22,s[8:11],s75 offen sc1
v_smfmac_f32_16x16x64_bf16 v[100:103],v[48:51],a[224:231],v2
s_waitcnt lgkmcnt(0)
v_smfmac_f32_16x16x64_bf16 v[96:99],v[52:55],a[112:119],v2
v_smfmac_f32_16x16x64_bf16 v[100:103],v[52:55],a[240:247],v2
v_readfirstlane_b32 s58,v123
v_smfmac_f32_16x16x64_bf16 v[104:107],v[44:47],a[88:95],v2
v_smfmac_f32_16x16x64_bf16 v[108:111],v[44:47],a[216:223],v2
s_cmp_lg_u32 s58,0
s_cbranch_scc1 L_cjump_296
v_smfmac_f32_16x16x64_bf16 v[104:107],v[48:51],a[104:111],v2
v_add_f32 v96,v96,v98
v_smfmac_f32_16x16x64_bf16 v[108:111],v[48:51],a[232:239],v2
v_add_f32 v97,v97,v99
v_smfmac_f32_16x16x64_bf16 v[104:107],v[52:55],a[120:127],v2
v_cvt_pk_bf16_f32 v120,v96,v97
v_smfmac_f32_16x16x64_bf16 v[108:111],v[52:55],a[248:255],v2
v_add_f32 v100,v100,v102
v_smfmac_f32_16x16x64_bf16 v[116:119],v[28:31],v[152:159],v2
v_add_f32 v101,v101,v103
v_smfmac_f32_16x16x64_bf16 v[112:115],v[32:35],v[160:167],v2
v_cvt_pk_bf16_f32 v121,v100,v101
v_add_f32 v104,v104,v106
v_add_f32 v105,v105,v107
v_cvt_pk_bf16_f32 v122,v104,v105
v_add_f32 v108,v108,v110
v_add_f32 v109,v109,v111
v_cvt_pk_bf16_f32 v123,v108,v109
ds_write_b128 v4,v[120:123]
v_smfmac_f32_16x16x64_bf16 v[116:119],v[32:35],v[168:175],v2
s_mov_b32 s54,s68
s_add_u32 s68,s68,131072
v_mov_b32 v125,0
v_smfmac_f32_16x16x64_bf16 v[112:115],v[36:39],v[176:183],v2
s_cmp_eq_u32 s51,63
s_cbranch_scc1 L_cend_306
v_smfmac_f32_16x16x64_bf16 v[116:119],v[36:39],v[184:191],v2
v_smfmac_f32_16x16x64_bf16 v[112:115],v[40:43],v[192:199],v2
s_waitcnt lgkmcnt(0)
s_barrier
ds_read_b64_tr_b16 v[96:97],v5 offset:0
ds_read_b64_tr_b16 v[98:99],v6 offset:0
v_smfmac_f32_16x16x64_bf16 v[116:119],v[40:43],v[200:207],v2
ds_read_b64_tr_b16 v[100:101],v5 offset:1024
v_smfmac_f32_16x16x64_bf16 v[112:115],v[44:47],v[208:215],v2
ds_read_b64_tr_b16 v[102:103],v6 offset:1024
v_smfmac_f32_16x16x64_bf16 v[116:119],v[44:47],v[216:223],v2
ds_read_b64_tr_b16 v[104:105],v5 offset:2048
v_smfmac_f32_16x16x64_bf16 v[112:115],v[48:51],v[224:231],v2
ds_read_b64_tr_b16 v[106:107],v6 offset:2048
s_waitcnt lgkmcnt(4)
v_mfma_f32_16x16x32_bf16 v[24:27],v[56:59],v[96:99],0
ds_read_b64_tr_b16 v[108:109],v5 offset:3072
v_mfma_f32_16x16x32_bf16 v[28:31],v[60:63],v[96:99],0
ds_read_b64_tr_b16 v[110:111],v6 offset:3072
v_mfma_f32_16x16x32_bf16 v[32:35],v[96:99],v[96:99],0
ds_read_b128 v[40:43],v11 offset:12288
s_waitcnt lgkmcnt(5)
v_mfma_f32_16x16x32_bf16 v[24:27],v[64:67],v[100:103],v[24:27]
ds_read_b128 v[56:59],v11 offset:0
v_mfma_f32_16x16x32_bf16 v[28:31],v[68:71],v[100:103],v[28:31]
ds_read_b128 v[60:63],v11 offset:1024
v_mfma_f32_16x16x32_bf16 v[32:35],v[100:103],v[100:103],v[32:35]
ds_read_b128 v[96:99],v11 offset:8192
s_waitcnt lgkmcnt(6)
v_mfma_f32_16x16x32_bf16 v[24:27],v[72:75],v[104:107],v[24:27]
ds_read_b128 v[64:67],v11 offset:2048
v_mfma_f32_16x16x32_bf16 v[28:31],v[76:79],v[104:107],v[28:31]
ds_read_b128 v[68:71],v11 offset:3072
v_mfma_f32_16x16x32_bf16 v[32:35],v[104:107],v[104:107],v[32:35]
ds_read_b128 v[100:103],v11 offset:9216
s_waitcnt lgkmcnt(7)
v_mfma_f32_16x16x32_bf16 v[24:27],v[80:83],v[108:111],v[24:27]
ds_read_b128 v[72:75],v11 offset:4096
v_mfma_f32_16x16x32_bf16 v[28:31],v[84:87],v[108:111],v[28:31]
ds_read_b128 v[76:79],v11 offset:5120
v_mfma_f32_16x16x32_bf16 v[32:35],v[108:111],v[108:111],v[32:35]
ds_read_b128 v[104:107],v11 offset:10240
v_smfmac_f32_16x16x64_bf16 v[116:119],v[48:51],v[232:239],v2
ds_read_b128 v[80:83],v11 offset:6144
v_smfmac_f32_16x16x64_bf16 v[112:115],v[52:55],v[240:247],v2
ds_read_b128 v[84:87],v11 offset:7168
v_smfmac_f32_16x16x64_bf16 v[116:119],v[52:55],v[248:255],v2
ds_read_b128 v[108:111],v11 offset:11264
v_max3_f32 v126,v24,v25,v26
v_max3_f32 v127,v27,v28,v29
v_max3_f32 v126,v30,v31,v126
v_max3_f32 v127,v34,v35,v127
v_max_f32 v126,v126,v127
v_max_f32 v127,v126,v127
v_pk_mul_f32 v[34:35],v[34:35],v[0:1] op_sel:[0,1]
v_pk_mul_f32 v[24:25],v[24:25],v[0:1] op_sel:[0,1]
v_permlane16_swap_b32 v126,v127
v_max_f32 v126,v126,v127
v_max_f32 v127,v126,v127
v_pk_mul_f32 v[26:27],v[26:27],v[0:1] op_sel:[0,1]
v_pk_mul_f32 v[28:29],v[28:29],v[0:1] op_sel:[0,1]
v_permlane32_swap_b32 v126,v127
v_max_f32 v126,v126,v127
v_mul_f32 v126,v1,v126
v_pk_mul_f32 v[30:31],v[30:31],v[0:1] op_sel:[0,1]
v_pk_add_f32 v[34:35],v[34:35],v[126:127] op_sel_hi:[1,0] neg_lo:[0,1] neg_hi:[0,1]
v_pk_add_f32 v[112:113],v[112:113],v[114:115]
v_pk_add_f32 v[116:117],v[116:117],v[118:119]
v_pk_add_f32 v[24:25],v[24:25],v[126:127] op_sel_hi:[1,0] neg_lo:[0,1] neg_hi:[0,1]
v_pk_add_f32 v[26:27],v[26:27],v[126:127] op_sel_hi:[1,0] neg_lo:[0,1] neg_hi:[0,1]
v_pk_add_f32 v[28:29],v[28:29],v[126:127] op_sel_hi:[1,0] neg_lo:[0,1] neg_hi:[0,1]
v_pk_add_f32 v[30:31],v[30:31],v[126:127] op_sel_hi:[1,0] neg_lo:[0,1] neg_hi:[0,1]
v_exp_f32 v34,v34
v_exp_f32 v35,v35
v_cvt_pk_bf16_f32 v126,v112,v113
v_cvt_pk_bf16_f32 v124,v34,v35
v_cvt_pk_bf16_f32 v127,v116,v117
v_cvt_pk_bf16_f32 v36,v116,v117
v_mfma_f32_16x16x16_bf16 v[32:35],v[14:15],v[124:125],0
ds_read_b128 v[44:47],v11 offset:13312
v_exp_f32 v24,v24
v_mfma_f32_16x16x16_bf16 v[112:115],v[126:127],v[124:125],0
ds_read_b128 v[48:51],v11 offset:14336
v_exp_f32 v25,v25
v_mfma_f32_16x16x16_bf16 v[116:119],v[36:37],v[124:125],0
ds_read_b128 v[52:55],v11 offset:15360
v_exp_f32 v26,v26
v_exp_f32 v27,v27
v_cvt_pk_bf16_f32 v120,v24,v25
v_exp_f32 v28,v28
v_exp_f32 v29,v29
v_cvt_pk_bf16_f32 v121,v26,v27
v_exp_f32 v30,v30
v_exp_f32 v31,v31
v_cvt_pk_bf16_f32 v122,v28,v29
v_cvt_pk_bf16_f32 v123,v30,v31
s_add_u32 s75,s75,8192
s_add_u32 s51,s51,1
v_mfma_f32_16x16x32_bf16 v[32:35],v[14:17],v[120:123],v[32:35]
v_mfma_f32_16x16x32_bf16 v[112:115],v[88:91],v[120:123],v[112:115]
ds_read_b128 v[88:91],v11 offset:16384
v_mfma_f32_16x16x32_bf16 v[116:119],v[92:95],v[120:123],v[116:119]
ds_read_b128 v[92:95],v11 offset:17408
v_rcp_f32 v32,v32
v_mov_b64 v[24:25],-1
v_mov_b64 v[26:27],-1
s_add_u32 s64,s75,13631488
s_add_u32 s70,s64,4096
v_pk_mul_f32 v[112:113],v[112:113],v[32:33] op_sel_hi:[1,0]
v_pk_mul_f32 v[114:115],v[114:115],v[32:33] op_sel_hi:[1,0]
v_pk_mul_f32 v[116:117],v[116:117],v[32:33] op_sel_hi:[1,0]
v_pk_mul_f32 v[118:119],v[118:119],v[32:33] op_sel_hi:[1,0]
v_cvt_pk_bf16_f32 v120,v112,v116
v_cvt_pk_bf16_f32 v121,v113,v117
v_cvt_pk_bf16_f32 v122,v114,v118
v_cvt_pk_bf16_f32 v123,v115,v119
ds_write_b128 v7,v[120:123]
buffer_store_dwordx4 v[24:27],v0,s[8:11],s69 offen sc1
buffer_store_dwordx4 v[24:27],v0,s[8:11],s69 offen offset:1024 sc1
v_mov_b64 v[112:113],0
v_mov_b64 v[114:115],0
v_mov_b64 v[116:117],0
v_mov_b64 v[118:119],0
s_waitcnt lgkmcnt(0)
s_barrier
ds_read_b128 v[24:27],v8 offset:0
ds_read_b128 v[28:31],v8 offset:512
ds_read_b128 v[32:35],v8 offset:1024
ds_read_b128 v[36:39],v8 offset:1536
v_mov_b64 v[120:121],0
v_mov_b64 v[122:123],0
s_add_u32 s57,s65,65536
s_add_u32 s58,s65,131072
s_add_u32 s59,s65,196608
s_add_u32 s56,s18,s75
s_waitcnt lgkmcnt(3)
v_smfmac_f32_16x16x64_bf16 v[112:115],v[24:27],v[56:63],v3
ds_read_b128 v[56:59],v11 offset:18432
s_waitcnt lgkmcnt(3)
v_smfmac_f32_16x16x64_bf16 v[112:115],v[28:31],v[64:71],v3
ds_read_b128 v[60:63],v11 offset:19456
s_waitcnt lgkmcnt(3)
v_smfmac_f32_16x16x64_bf16 v[112:115],v[32:35],v[72:79],v3
ds_read_b128 v[64:67],v11 offset:20480
s_waitcnt lgkmcnt(3)
v_smfmac_f32_16x16x64_bf16 v[112:115],v[36:39],v[80:87],v3
ds_read_b128 v[68:71],v11 offset:21504
v_smfmac_f32_16x16x64_bf16 v[116:119],v[24:27],v[96:103],v3
ds_read_b128 v[72:75],v11 offset:22528
v_smfmac_f32_16x16x64_bf16 v[116:119],v[28:31],v[104:111],v3
ds_read_b128 v[76:79],v11 offset:23552
v_cvt_pk_bf16_f32 v112,v112,v113
v_smfmac_f32_16x16x64_bf16 v[116:119],v[32:35],v[40:47],v3
ds_read_b128 v[80:83],v11 offset:24576
v_cvt_pk_bf16_f32 v113,v114,v115
buffer_store_dwordx2 v[112:113],v9,s[8:11],s65 offen sc1
v_smfmac_f32_16x16x64_bf16 v[116:119],v[36:39],v[48:55],v3
ds_read_b128 v[84:87],v11 offset:25600
v_mov_b64 v[112:113],0
v_smfmac_f32_16x16x64_bf16 v[120:123],v[24:27],v[88:95],v3
ds_read_b128 v[96:99],v11 offset:26624
ds_read_b128 v[100:103],v11 offset:27648
v_mov_b64 v[114:115],0
s_waitcnt lgkmcnt(8)
v_smfmac_f32_16x16x64_bf16 v[120:123],v[28:31],v[56:63],v3
ds_read_b128 v[104:107],v11 offset:28672
v_cvt_pk_bf16_f32 v116,v116,v117
s_waitcnt lgkmcnt(7)
v_smfmac_f32_16x16x64_bf16 v[120:123],v[32:35],v[64:71],v3
ds_read_b128 v[108:111],v11 offset:29696
ds_read_b128 v[40:43],v11 offset:30720
v_cvt_pk_bf16_f32 v117,v118,v119
buffer_store_dwordx2 v[116:117],v9,s[8:11],s57 offen sc1
s_waitcnt lgkmcnt(7)
v_smfmac_f32_16x16x64_bf16 v[120:123],v[36:39],v[72:79],v3
ds_read_b128 v[44:47],v11 offset:31744
v_add_u32 v52,s50,v5
s_waitcnt lgkmcnt(6)
v_smfmac_f32_16x16x64_bf16 v[112:115],v[24:27],v[80:87],v3
v_add_u32 v54,s50,v6
s_waitcnt lgkmcnt(4)
v_smfmac_f32_16x16x64_bf16 v[112:115],v[28:31],v[96:103],v3
ds_read_b64_tr_b16 v[52:53],v52
v_cvt_pk_bf16_f32 v120,v120,v121
s_waitcnt lgkmcnt(3)
v_smfmac_f32_16x16x64_bf16 v[112:115],v[32:35],v[104:111],v3
ds_read_b64_tr_b16 v[54:55],v54
v_cvt_pk_bf16_f32 v121,v122,v123
buffer_store_dwordx2 v[120:121],v9,s[8:11],s58 offen sc1
s_waitcnt lgkmcnt(2)
v_smfmac_f32_16x16x64_bf16 v[112:115],v[36:39],v[40:47],v3
v_mov_b64 v[116:117],0
v_mov_b64 v[118:119],0
s_xor_b32 s65,s65,262144
v_mov_b32_dpp v124,v126 quad_perm:[2,3,2,3] row_mask:0xf bank_mask:0xf
v_mov_b32_dpp v125,v127 quad_perm:[2,3,2,3] row_mask:0xf bank_mask:0xf
s_mov_b32 vcc_lo,0xcccccccc
s_mov_b32 vcc_hi,0xcccccccc
s_nop 0
v_cvt_pk_bf16_f32 v112,v112,v113
v_cvt_pk_bf16_f32 v113,v114,v115
buffer_store_dwordx2 v[112:113],v9,s[8:11],s59 offen sc1
s_waitcnt lgkmcnt(0)
s_buffer_load_dword s19,s[8:11],s56
v_cndmask_b32 v124,v124,v52,vcc
v_cndmask_b32 v125,v125,v53,vcc
v_cndmask_b32 v126,v126,v54,vcc
v_cndmask_b32 v127,v127,v55,vcc
s_cmp_lt_u32 s46,2
s_waitcnt vmcnt(3)
s_cbranch_scc1 L_crg_313
s_cmp_eq_u32 s46,2
s_waitcnt vmcnt(1)
s_cbranch_scc1 L_crg_313
s_waitcnt vmcnt(0)
L_crg_313:
buffer_load_dwordx4 v[32:35],v0,s[8:11],s66 offen offset:0 sc1
buffer_load_dwordx4 v[36:39],v0,s[8:11],s66 offen offset:1024 sc1
v_mov_b64 v[96:97],0
v_mov_b64 v[98:99],0
v_mov_b64 v[100:101],0
v_mov_b64 v[102:103],0
v_mov_b64 v[104:105],0
v_mov_b64 v[106:107],0
v_mov_b64 v[108:109],0
v_mov_b64 v[110:111],0
v_mov_b64 v[112:113],0
v_mov_b64 v[114:115],0
v_add_u32 v55,131072,v0
v_add_u32 v123,s73,v55
v_xor_b32 v120,1024,v12
v_xor_b32 v121,2048,v12
v_xor_b32 v122,3072,v12
buffer_load_dwordx4 v[44:47],v0,s[8:11],s66 offen offset:0 sc1
buffer_load_dwordx4 v[48:51],v0,s[8:11],s66 offen offset:1024 sc1
s_cmp_ge_u32 s51,63
s_cselect_b32 s76,0,1
v_readlane_b32 s56,v23,5
v_readlane_b32 s20,v23,4
v_add_u32 v23,-1,v23
v_cmp_le_u32 vcc,s30,v23
s_cmp_gt_u32 s51,61
s_cselect_b32 s77,0,vcc_hi
s_cmp_gt_u32 s20,s30
s_cselect_b32 s77,1,s77
s_cmp_lg_u32 s77,0
s_cselect_b32 s76,2,s76
s_cmp_gt_u32 s56,s30
s_cbranch_scc1 L_cld_289
L_clb_290:
s_cmp_eq_u32 s46,0
s_cselect_b32 s76,s76,0
s_waitcnt vmcnt(3)
v_mfma_f32_16x16x32_bf16 v[28:31],v[18:21],v[32:35],0
s_waitcnt vmcnt(2)
v_mfma_f32_16x16x32_bf16 v[28:31],v[18:21],v[36:39],v[28:31]
s_nop 7
v_cmp_u_f32 vcc,v28,v28
v_add_f32_dpp v52,v28,v28 row_ror:8 row_mask:0xf bank_mask:0x3
v_add_f32_dpp v53,v29,v29 row_ror:8 row_mask:0xf bank_mask:0x3
v_add_f32_dpp v52,v30,v30 row_ror:8 row_mask:0xf bank_mask:0xc
v_add_f32_dpp v53,v31,v31 row_ror:8 row_mask:0xf bank_mask:0xc
s_nop 0
v_add_f32_dpp v52,v52,v52 row_shl:4 row_mask:0xf bank_mask:0x5
v_add_f32_dpp v53,v53,v53 row_shl:4 row_mask:0xf bank_mask:0x5
s_cbranch_vccnz L_crp_308
L_cok_314:
v_cvt_pk_bf16_f32 v54,v52,v53
buffer_store_dword v54,v10,s[8:11],s64 offen sc1
s_mov_b32 s69,s66
s_xor_b32 s66,s66,262144
s_barrier
ds_read_b128 v[56:59],v55 offset:0
ds_read_b128 v[60:63],v55 offset:4096
ds_read_b128 v[64:67],v55 offset:1024
buffer_load_dwordx4 v[24:27],v13,s[8:11],s64 offen sc1
ds_read_b128 v[68:71],v55 offset:5120
ds_read_b128 v[72:75],v55 offset:2048
ds_read_b128 v[76:79],v55 offset:6144
ds_read_b128 v[80:83],v55 offset:3072
buffer_load_dwordx4 v[24:27],v13,s[8:11],s64 offen sc1
ds_read_b128 v[84:87],v55 offset:7168
ds_read_b128 v[88:91],v123 offset:8192
ds_read_b128 v[92:95],v123 offset:9216
s_branch L_chain_303
L_cpb_310:
buffer_load_dwordx4 v[40:43],v13,s[8:11],s70 offen sc1
s_sub_u32 s49,s49,1
s_cbranch_scc1 L_abort2
s_waitcnt vmcnt(0)
v_max3_u32 v123,v40,v41,v42
v_max_u32 v123,v43,v123
v_cmp_le_u32 vcc,s72,v123
s_cbranch_vccnz L_cpb_310
ds_write_b128 v12,v[40:43] offset:4096
s_branch L_cback_312
L_crp_308:
buffer_load_dwordx4 v[32:35],v0,s[8:11],s66 offen offset:0 sc1
buffer_load_dwordx4 v[36:39],v0,s[8:11],s66 offen offset:1024 sc1
s_sub_u32 s49,s49,1
s_cbranch_scc1 L_abort2
s_waitcnt vmcnt(3)
v_mfma_f32_16x16x32_bf16 v[28:31],v[18:21],v[44:47],0
s_waitcnt vmcnt(2)
v_mfma_f32_16x16x32_bf16 v[28:31],v[18:21],v[48:51],v[28:31]
s_nop 7
v_cmp_u_f32 vcc,v28,v28
v_add_f32_dpp v52,v28,v28 row_ror:8 row_mask:0xf bank_mask:0x3
v_add_f32_dpp v53,v29,v29 row_ror:8 row_mask:0xf bank_mask:0x3
v_add_f32_dpp v52,v30,v30 row_ror:8 row_mask:0xf bank_mask:0xc
v_add_f32_dpp v53,v31,v31 row_ror:8 row_mask:0xf bank_mask:0xc
s_nop 0
v_add_f32_dpp v52,v52,v52 row_shl:4 row_mask:0xf bank_mask:0x5
v_add_f32_dpp v53,v53,v53 row_shl:4 row_mask:0xf bank_mask:0x5
s_cbranch_vccz L_cok_314
buffer_load_dwordx4 v[44:47],v0,s[8:11],s66 offen offset:0 sc1
buffer_load_dwordx4 v[48:51],v0,s[8:11],s66 offen offset:1024 sc1
s_sub_u32 s49,s49,1
s_cbranch_scc1 L_abort2
s_waitcnt vmcnt(3)
v_mfma_f32_16x16x32_bf16 v[28:31],v[18:21],v[32:35],0
s_waitcnt vmcnt(2)
v_mfma_f32_16x16x32_bf16 v[28:31],v[18:21],v[36:39],v[28:31]
s_nop 7
v_cmp_u_f32 vcc,v28,v28
v_add_f32_dpp v52,v28,v28 row_ror:8 row_mask:0xf bank_mask:0x3
v_add_f32_dpp v53,v29,v29 row_ror:8 row_mask:0xf bank_mask:0x3
v_add_f32_dpp v52,v30,v30 row_ror:8 row_mask:0xf bank_mask:0xc
v_add_f32_dpp v53,v31,v31 row_ror:8 row_mask:0xf bank_mask:0xc
s_nop 0
v_add_f32_dpp v52,v52,v52 row_shl:4 row_mask:0xf bank_mask:0x5
v_add_f32_dpp v53,v53,v53 row_shl:4 row_mask:0xf bank_mask:0x5
s_cbranch_vccz L_cok_314
s_branch L_crp_308
L_ckw_293:
s_cmp_eq_u32 s77,0
s_cbranch_scc1 L_cjw_295
s_cmp_gt_u32 s20,s30
s_cbranch_scc1 L_cjs_291
s_add_u32 s31,s51,2
s_lshl_b32 s59,s31,13
s_add_u32 s59,s59,10486016
v_lshrrev_b32 v45,2,v0
v_and_b32 v45,127,v45
L_ckk_315:
s_sleep 1
buffer_load_dword v44,v45,s[8:11],s59 offen sc1
s_sub_u32 s49,s49,1
s_cbranch_scc1 L_abort2
s_waitcnt vmcnt(0)
v_cmp_eq_u32 vcc,0,v44
s_cbranch_vccnz L_ckk_315
v_cmp_lt_u32 vcc,s30,v44
s_cbranch_vccz L_cjw_295
v_max_u32_dpp v44,v44,v44 row_ror:8 row_mask:0xf bank_mask:0xf
s_nop 1
v_max_u32_dpp v44,v44,v44 row_ror:4 row_mask:0xf bank_mask:0xf
s_nop 1
v_max_u32_dpp v44,v44,v44 row_ror:2 row_mask:0xf bank_mask:0xf
s_nop 1
v_max_u32_dpp v44,v44,v44 row_ror:1 row_mask:0xf bank_mask:0xf
v_mov_b32 v45,v44
s_nop 1
v_permlane16_swap_b32 v44,v45
v_max_u32 v44,v44,v45
v_mov_b32 v45,v44
s_nop 1
v_permlane32_swap_b32 v44,v45
v_max_u32 v44,v44,v45
s_nop 0
v_readfirstlane_b32 s20,v44
L_cjs_291:
s_mov_b32 s30,s20
s_andn2_b32 s31,0x7ff,s20
s_lshr_b32 s31,s31,5
s_add_u32 s31,s31,1
s_min_u32 s31,s31,63
ds_write_b32 v8,v2 offset:2560
s_waitcnt lgkmcnt(0)
s_branch L_ckb_294
L_cld_289:
v_mov_b32 v23,s56
s_add_u32 s56,s75,10495616
buffer_store_dword v23,off,s[8:11],s56 sc1
s_waitcnt vmcnt(0)
s_branch L_clb_290
L_cjw_295:
s_cmp_lg_u32 s19,0
s_cbranch_scc1 L_ckb_294
s_add_u32 s59,s18,s75
L_ww_316:
s_sleep 1
buffer_load_dword v23,off,s[8:11],s59 sc1
s_sub_u32 s49,s49,1
s_cbranch_scc1 L_abort2
s_waitcnt vmcnt(0)
v_readfirstlane_b32 s76,v23
s_cmp_eq_u32 s76,0
s_cbranch_scc1 L_ww_316
L_wwd_317:
s_branch L_ckb_294
L_cjump_296:
s_waitcnt vmcnt(0) lgkmcnt(0)
s_barrier
s_branch L_cst_292
L_cend_306:
v_smfmac_f32_16x16x64_bf16 v[116:119],v[36:39],v[184:191],v2
v_smfmac_f32_16x16x64_bf16 v[112:115],v[40:43],v[192:199],v2
v_smfmac_f32_16x16x64_bf16 v[116:119],v[40:43],v[200:207],v2
v_smfmac_f32_16x16x64_bf16 v[112:115],v[44:47],v[208:215],v2
v_smfmac_f32_16x16x64_bf16 v[116:119],v[44:47],v[216:223],v2
v_smfmac_f32_16x16x64_bf16 v[112:115],v[48:51],v[224:231],v2
v_smfmac_f32_16x16x64_bf16 v[116:119],v[48:51],v[232:239],v2
v_smfmac_f32_16x16x64_bf16 v[112:115],v[52:55],v[240:247],v2
v_smfmac_f32_16x16x64_bf16 v[116:119],v[52:55],v[248:255],v2
s_waitcnt lgkmcnt(0)
s_nop 2
v_pk_add_f32 v[112:113],v[112:113],v[114:115]
s_nop 2
v_pk_add_f32 v[116:117],v[116:117],v[118:119]
v_cvt_pk_bf16_f32 v126,v112,v113
v_cvt_pk_bf16_f32 v127,v116,v117
v_add_u32 v52,s50,v5
v_add_u32 v54,s50,v6
ds_read_b64_tr_b16 v[52:53],v52
ds_read_b64_tr_b16 v[54:55],v54
v_mov_b32_dpp v124,v126 quad_perm:[2,3,2,3] row_mask:0xf bank_mask:0xf
v_mov_b32_dpp v125,v127 quad_perm:[2,3,2,3] row_mask:0xf bank_mask:0xf
s_mov_b32 vcc_lo,0xcccccccc
s_mov_b32 vcc_hi,0xcccccccc
s_waitcnt lgkmcnt(0)
v_cndmask_b32 v124,v124,v52,vcc
v_cndmask_b32 v125,v125,v53,vcc
v_cndmask_b32 v126,v126,v54,vcc
v_cndmask_b32 v127,v127,v55,vcc
buffer_store_dwordx4 v[124:127],v0,s[8:11],s54 offen sc1
s_mov_b32 s51,64
s_waitcnt vmcnt(0)
s_barrier
s_nop 11
v_lshrrev_b32 v1,4,v0
s_endpgm
L_wa:
s_nop 11
v_and_b32 v238,15,v1
v_and_b32 v239,1,v1
v_lshlrev_b32 v239,4,v239
v_mov_b32 v240,0x3f80
v_lshlrev_b32 v240,v239,v240
v_lshrrev_b32 v238,1,v238
v_cmp_eq_u32 vcc,0,v238
s_nop 1
v_cndmask_b32 v156,0,v240,vcc
v_cmp_eq_u32 vcc,1,v238
s_nop 1
v_cndmask_b32 v157,0,v240,vcc
v_cmp_eq_u32 vcc,2,v238
s_nop 1
v_cndmask_b32 v158,0,v240,vcc
v_cmp_eq_u32 vcc,3,v238
s_nop 1
v_cndmask_b32 v159,0,v240,vcc
s_mov_b32 s4,s32
s_mov_b32 s5,s33
s_mov_b32 s6,1024
s_mov_b32 s7,0x20000
buffer_load_dwordx4 v[224:227],v0,s[4:7],0 offen
v_and_b32 v238,15,v1
v_lshrrev_b32 v239,4,v1
v_lshlrev_b32 v240,2,v239
v_mov_b32 v241,0xf149f2ca
s_and_b32 s56,s46,1
s_lshl_b32 s56,s56,4
v_add_u32 v242,s56,v238
v_add_u32 v243,0,v240
v_cmp_gt_u32 vcc,v243,v242
s_nop 1
v_cndmask_b32 v8,0,v241,vcc
v_add_u32 v243,1,v240
v_cmp_gt_u32 vcc,v243,v242
s_nop 1
v_cndmask_b32 v9,0,v241,vcc
v_add_u32 v243,2,v240
v_cmp_gt_u32 vcc,v243,v242
s_nop 1
v_cndmask_b32 v10,0,v241,vcc
v_add_u32 v243,3,v240
v_cmp_gt_u32 vcc,v243,v242
s_nop 1
v_cndmask_b32 v11,0,v241,vcc
v_add_u32 v243,16,v240
v_cmp_gt_u32 vcc,v243,v242
s_nop 1
v_cndmask_b32 v12,0,v241,vcc
v_add_u32 v243,17,v240
v_cmp_gt_u32 vcc,v243,v242
s_nop 1
v_cndmask_b32 v13,0,v241,vcc
v_add_u32 v243,18,v240
v_cmp_gt_u32 vcc,v243,v242
s_nop 1
v_cndmask_b32 v14,0,v241,vcc
v_add_u32 v243,19,v240
v_cmp_gt_u32 vcc,v243,v242
s_nop 1
v_cndmask_b32 v15,0,v241,vcc
v_mov_b32 v152,s80
v_mov_b32 v145,0
v_mov_b32 v146,0
s_lshl_b32 s56,s46,12
s_add_u32 s56,s56,131072
v_add_u32 v3,s56,v0
v_add_u32 v4,131072,v0
s_lshl_b32 s56,s46,8
v_lshlrev_b32 v7,4,v238
v_add_u32 v7,s56,v7
v_lshl_add_u32 v5,v239,16,v7
v_lshlrev_b32 v6,1,v7
v_lshl_add_u32 v7,v239,10,v7
v_and_b32 v243,1,v239
v_lshl_add_u32 v6,v243,4,v6
v_lshrrev_b32 v243,1,v239
v_lshl_add_u32 v6,v243,12,v6
v_add_u32 v6,147456,v6
v_lshlrev_b32 v16,2,v1
v_lshlrev_b32 v21,3,v238
s_and_b32 s68,s47,15
s_lshl_b32 s56,s68,10
v_add_u32 v5,s56,v5
s_lshl_b32 s56,s68,15
v_add_u32 v7,s56,v7
s_lshl_b32 s69,s54,20
s_add_u32 s69,s69,20971520
s_lshl_b32 s87,s54,13
s_add_u32 s87,s87,10486272
s_lshl4_add_u32 s74,s68,s87
s_lshl2_add_u32 s74,s46,s74
s_lshl_b32 s68,s68,1
s_lshr_b32 s56,s46,1
s_add_u32 s68,s68,s56
s_mov_b32 s66,0
s_mov_b32 s67,0
s_mov_b32 s73,0x80000000
s_mov_b32 s75,0
s_mov_b32 s37,0
s_mov_b32 s42,4294966272
s_mov_b32 s43,4294967295
s_mov_b64 s[38:39],0
s_sub_u32 s36,s54,12
s_and_b32 s36,s36,3
s_mov_b32 s12,s40
s_mov_b32 s13,s41
s_mov_b32 s14,2097152
s_mov_b32 s15,0x20000
s_and_b32 s29,s46,1
s_mul_i32 s28,s29,12288
s_lshl_b32 s29,s29,11
s_and_b32 s56,s50,2048
s_lshl_b32 s56,s56,4
s_add_u32 s56,s56,65536
s_add_u32 s40,s56,s28
s_add_u32 s41,s56,s29
v_add_u32 v21,10487168,v21
v_mov_b32 v244,v21
s_and_b32 s56,s50,2048
s_add_u32 s56,s56,147456
v_lshlrev_b32 v23,5,v1
v_add_u32 v23,s56,v23
v_and_b32 v253,32,v0
v_lshrrev_b32 v245,2,v253
v_add_u32 v253,v253,v245
v_sub_u32 v253,v0,v253
v_add_u32 v253,8,v253
v_mov_b32 v254,0x80000000
s_mov_b32 s56,1408
v_writelane_b32 v254,s56,0
s_mov_b32 s56,256
v_writelane_b32 v254,s56,1
s_mov_b32 s56,1280
v_writelane_b32 v254,s56,2
v_mov_b32 v245,155648
s_lshl_b32 s56,s46,2
v_add_u32 v247,s56,v245
s_waitcnt vmcnt(0)
v_lshlrev_b32 v228,16,v224
v_and_b32 v229,0xffff0000,v224
v_lshlrev_b32 v230,16,v225
v_and_b32 v231,0xffff0000,v225
v_lshlrev_b32 v232,16,v226
v_and_b32 v233,0xffff0000,v226
v_lshlrev_b32 v234,16,v227
v_and_b32 v235,0xffff0000,v227
v_mul_f32 v255,v228,v228
v_fma_f32 v255,v229,v229,v255
v_fma_f32 v255,v230,v230,v255
v_fma_f32 v255,v231,v231,v255
v_fma_f32 v255,v232,v232,v255
v_fma_f32 v255,v233,v233,v255
v_fma_f32 v255,v234,v234,v255
v_fma_f32 v255,v235,v235,v255
s_nop 1
v_add_f32_dpp v255,v255,v255 row_ror:8 row_mask:0xf bank_mask:0xf
s_nop 1
v_add_f32_dpp v255,v255,v255 row_ror:4 row_mask:0xf bank_mask:0xf
s_nop 1
v_add_f32_dpp v255,v255,v255 row_ror:2 row_mask:0xf bank_mask:0xf
s_nop 1
v_add_f32_dpp v255,v255,v255 row_ror:1 row_mask:0xf bank_mask:0xf
v_mov_b32 v238,v255
s_nop 1
v_permlane16_swap_b32 v255,v238
v_add_f32 v255,v255,v238
v_mov_b32 v238,v255
s_nop 1
v_permlane32_swap_b32 v255,v238
v_add_f32 v255,v255,v238
v_sqrt_f32 v255,v255
v_sub_u32 v238,67,v1
v_cvt_f32_u32 v238,v238
v_log_f32 v238,v238
v_mov_b32 v239,0x3ff9999a
v_fmac_f32 v239,0x3e632166,v238
v_mul_f32 v255,v255,v239
v_or_b32 v255,0x80000000,v255
s_cmp_lt_u32 s54,2
s_cbranch_scc1 L_aa_318
s_sub_u32 s77,s54,2
s_mov_b32 s30,0
s_mov_b32 s86,1536
s_lshl_b32 s56,s77,5
s_add_u32 s56,s56,s68
s_mul_i32 s70,s56,24576
s_lshl_b32 s71,s56,12
s_lshl_b32 s59,s77,13
s_lshl2_add_u32 s59,s68,s59
s_add_u32 s59,s59,10485760
s_buffer_load_dword s32,s[8:11],s59
s_mov_b32 s33,1
s_add_u32 s70,s70,100663296
s_add_u32 s71,s71,41943040
v_mov_b32 v19,s59
s_branch L_aa_326
L_aa_332:
s_bitcmp1_b32 s46,0
s_cbranch_scc1 L_av_333
ds_read_b128 v[24:27],v4 offset:0
ds_read_b128 v[28:31],v4 offset:1024
s_min_u32 s56,s32,s33
s_cmp_lt_u32 s77,64
s_cselect_b32 s56,s56,0
s_cmp_eq_u32 s56,0
s_cselect_b32 s72,0x80000000,0
v_mov_b32 v248,s72
s_or_b32 s64,s70,s72
s_or_b32 s65,s71,s72
s_cmp_lt_u32 s30,s31
s_cselect_b32 s65,0x80000000,s65
s_add_u32 s64,s64,s28
s_add_u32 s65,s65,s29
s_xor_b32 s58,s67,s40
s_xor_b32 s57,s67,s41
s_add_u32 m0,s58,0
s_waitcnt lgkmcnt(1)
v_mfma_f32_16x16x32_bf16 v[160:163],v[24:27],a[0:3],0
buffer_load_dwordx4 v0,s[8:11],s64 offen offset:0 sc1 lds
v_mfma_f32_16x16x32_bf16 v[164:167],v[24:27],a[4:7],0
ds_read_b128 v[32:35],v4 offset:2048
v_lshlrev_b32 v88,16,v224
v_mfma_f32_16x16x32_bf16 v[168:171],v[24:27],a[8:11],0
ds_read_b128 v[36:39],v4 offset:3072
v_and_b32 v89,0xffff0000,v224
v_mfma_f32_16x16x32_bf16 v[172:175],v[24:27],a[12:15],0
ds_read_b128 v[40:43],v4 offset:8192
v_lshlrev_b32 v90,16,v225
v_mfma_f32_16x16x32_bf16 v[176:179],v[24:27],a[16:19],0
buffer_load_dwordx4 v0,s[8:11],s64 offen offset:1024 sc1 lds
v_mfma_f32_16x16x32_bf16 v[180:183],v[24:27],a[20:23],0
ds_read_b128 v[44:47],v4 offset:9216
v_and_b32 v91,0xffff0000,v225
v_mfma_f32_16x16x32_bf16 v[184:187],v[24:27],a[24:27],0
ds_read_b128 v[48:51],v4 offset:10240
s_waitcnt vmcnt(9)
v_mfma_f32_16x16x32_bf16 v[188:191],v[24:27],a[28:31],0
ds_read_b128 v[52:55],v4 offset:11264
v_mfma_f32_16x16x32_bf16 v[128:131],v[156:159],v[192:195],0
ds_write_b32 v247,v248
v_lshlrev_b32 v92,16,v226
s_waitcnt lgkmcnt(7)
v_mfma_f32_16x16x32_bf16 v[160:163],v[28:31],a[32:35],v[160:163]
buffer_load_dwordx4 v0,s[8:11],s64 offen offset:2048 sc1 lds
v_mfma_f32_16x16x32_bf16 v[164:167],v[28:31],a[36:39],v[164:167]
ds_read_b128 v[56:59],v4 offset:4096
s_waitcnt vmcnt(9)
v_mfma_f32_16x16x32_bf16 v[168:171],v[28:31],a[40:43],v[168:171]
ds_read_b128 v[60:63],v4 offset:5120
v_mfma_f32_16x16x32_bf16 v[128:131],v[156:159],v[196:199],v[128:131]
ds_read_b128 v[64:67],v4 offset:6144
v_and_b32 v93,0xffff0000,v226
v_mfma_f32_16x16x32_bf16 v[172:175],v[28:31],a[44:47],v[172:175]
ds_read_b128 v[68:71],v4 offset:7168
s_waitcnt vmcnt(8)
v_mfma_f32_16x16x32_bf16 v[176:179],v[28:31],a[48:51],v[176:179]
buffer_load_dwordx4 v0,s[8:11],s64 offen offset:3072 sc1 lds
v_mfma_f32_16x16x32_bf16 v[180:183],v[28:31],a[52:55],v[180:183]
ds_read_b128 v[72:75],v4 offset:12288
v_mfma_f32_16x16x32_bf16 v[128:131],v[156:159],v[200:203],v[128:131]
ds_read_b128 v[76:79],v4 offset:13312
v_lshlrev_b32 v94,16,v227
v_mfma_f32_16x16x32_bf16 v[184:187],v[28:31],a[56:59],v[184:187]
ds_read_b128 v[80:83],v4 offset:14336
s_waitcnt vmcnt(8)
v_mfma_f32_16x16x32_bf16 v[188:191],v[28:31],a[60:63],v[188:191]
ds_read_b128 v[84:87],v4 offset:15360
v_mfma_f32_16x16x32_bf16 v[128:131],v[156:159],v[204:207],v[128:131]
v_and_b32 v95,0xffff0000,v227
v_readfirstlane_b32 s22,v246
s_waitcnt lgkmcnt(14)
v_mfma_f32_16x16x32_bf16 v[160:163],v[32:35],a[64:67],v[160:163]
s_waitcnt vmcnt(7)
v_mfma_f32_16x16x32_bf16 v[132:135],v[156:159],v[208:211],0
s_add_u32 m0,s58,4096
s_add_u32 s64,s64,4096
s_cmp_eq_u32 s22,0
s_cbranch_scc1 L_ag_334
L_agb_335:
v_mfma_f32_16x16x32_bf16 v[164:167],v[32:35],a[68:71],v[164:167]
buffer_load_dwordx4 v0,s[8:11],s64 offen offset:0 sc1 lds
v_mfma_f32_16x16x32_bf16 v[168:171],v[32:35],a[72:75],v[168:171]
s_waitcnt vmcnt(7)
v_mfma_f32_16x16x32_bf16 v[132:135],v[156:159],v[212:215],v[132:135]
s_lshl_b32 s18,s26,5
s_add_u32 s18,s18,s68
s_lshl_b32 s19,s18,10
v_mfma_f32_16x16x32_bf16 v[172:175],v[32:35],a[76:79],v[172:175]
s_waitcnt vmcnt(6)
v_mfma_f32_16x16x32_bf16 v[132:135],v[156:159],v[216:219],v[132:135]
s_add_u32 s20,s19,6291456
s_lshl_b32 s23,s51,5
s_add_u32 s23,s23,s68
v_mfma_f32_16x16x32_bf16 v[176:179],v[32:35],a[80:83],v[176:179]
ds_write_b128 v6,v[128:131]
v_mfma_f32_16x16x32_bf16 v[180:183],v[32:35],a[84:87],v[180:183]
buffer_load_dwordx4 v0,s[8:11],s64 offen offset:1024 sc1 lds
v_mfma_f32_16x16x32_bf16 v[184:187],v[32:35],a[88:91],v[184:187]
s_waitcnt vmcnt(6)
v_mfma_f32_16x16x32_bf16 v[132:135],v[156:159],v[220:223],v[132:135]
s_lshl_b32 s24,s23,10
s_lshl_b32 s25,s51,10
s_add_u32 s25,s25,2883584
v_mfma_f32_16x16x32_bf16 v[188:191],v[32:35],a[92:95],v[188:191]
s_cmp_eq_u32 s23,s55
s_cselect_b32 s25,s25,s24
s_add_u32 s25,s25,8388608
s_waitcnt lgkmcnt(14)
v_mfma_f32_16x16x32_bf16 v[160:163],v[36:39],a[96:99],v[160:163]
s_mov_b32 s6,268435456
s_cmp_eq_u32 s31,0
s_cselect_b32 s25,s24,s25
s_cselect_b64 s[4:5],s[16:17],s[44:45]
s_cmov_b32 s6,2097152
v_mfma_f32_16x16x32_bf16 v[164:167],v[36:39],a[100:103],v[164:167]
ds_write_b128 v6,v[132:135] offset:2048
v_mfma_f32_16x16x32_bf16 v[168:171],v[36:39],a[104:107],v[168:171]
buffer_load_dwordx4 v0,s[8:11],s64 offen offset:2048 sc1 lds
v_mfma_f32_16x16x32_bf16 v[172:175],v[36:39],a[108:111],v[172:175]
buffer_load_dwordx4 v[224:227],v0,s[4:7],s25 offen sc1
v_mfma_f32_16x16x32_bf16 v[176:179],v[36:39],a[112:115],v[176:179]
s_lshr_b32 s24,s55,5
s_cmp_lt_u32 s51,s24
s_cselect_b32 s24,1,2
v_mfma_f32_16x16x32_bf16 v[180:183],v[36:39],a[116:119],v[180:183]
v_mov_b32 v252,s24
s_lshl2_add_u32 s25,s51,11018240
v_mfma_f32_16x16x32_bf16 v[184:187],v[36:39],a[120:123],v[184:187]
buffer_load_dwordx4 v0,s[8:11],s64 offen offset:3072 sc1 lds
v_mfma_f32_16x16x32_bf16 v[188:191],v[36:39],a[124:127],v[188:191]
s_waitcnt lgkmcnt(0)
s_barrier
s_lshl_b32 s24,s68,16
s_waitcnt lgkmcnt(14)
v_mfma_f32_16x16x32_bf16 v[160:163],v[40:43],a[128:131],v[160:163]
ds_read_b128 v[96:99],v23
s_add_u32 s24,s24,s31
v_mfma_f32_16x16x32_bf16 v[164:167],v[40:43],a[132:135],v[164:167]
ds_read_b128 v[100:103],v23 offset:16
s_add_u32 s24,s24,s86
v_mfma_f32_16x16x32_bf16 v[168:171],v[40:43],a[136:139],v[168:171]
ds_read_b128 v[248:251],v245
s_add_u32 m0,s58,8192
s_add_u32 s64,s64,4096
v_mfma_f32_16x16x32_bf16 v[172:175],v[40:43],a[140:143],v[172:175]
buffer_load_dwordx4 v0,s[8:11],s64 offen offset:0 sc1 lds
s_cmp_eq_u32 s24,1537
s_cselect_b32 s25,s25,0x80000000
v_mfma_f32_16x16x32_bf16 v[176:179],v[40:43],a[144:147],v[176:179]
buffer_store_dword v252,off,s[8:11],s25 sc1
s_bitcmp1_b64 s[38:39],s51
s_cselect_b32 s24,128,0
v_mfma_f32_16x16x32_bf16 v[180:183],v[40:43],a[148:151],v[180:183]
buffer_store_dword v20,off,s[8:11],s73 sc1
s_lshl_b32 s23,s51,13
v_mfma_f32_16x16x32_bf16 v[184:187],v[40:43],a[152:155],v[184:187]
s_lshl2_add_u32 s23,s68,s23
s_add_u32 s23,s23,10487168
s_add_u32 s23,s23,s24
s_mov_b32 s73,0x80000000
v_mfma_f32_16x16x32_bf16 v[188:191],v[40:43],a[156:159],v[188:191]
buffer_load_dwordx4 v0,s[8:11],s64 offen offset:1024 sc1 lds
v_mfma_f32_16x16x32_bf16 v[160:163],v[44:47],a[160:163],v[160:163]
buffer_load_dword v246,off,s[8:11],s23 sc1
v_lshrrev_b32 v244,4,v1
v_mfma_f32_16x16x32_bf16 v[164:167],v[44:47],a[164:167],v[164:167]
s_waitcnt lgkmcnt(0)
v_or3_b32 v248,v248,v249,v250
v_or_b32 v248,v248,v251
s_sub_u32 s23,s77,7
v_mfma_f32_16x16x32_bf16 v[168:171],v[44:47],a[168:171],v[168:171]
v_readfirstlane_b32 s72,v248
v_add_u32 v244,s23,v244
v_max_i32 v244,0,v244
v_mfma_f32_16x16x32_bf16 v[172:175],v[44:47],a[172:175],v[172:175]
buffer_load_dwordx4 v0,s[8:11],s64 offen offset:2048 sc1 lds
v_lshl_add_u32 v244,v244,13,v21
v_mfma_f32_16x16x32_bf16 v[176:179],v[44:47],a[176:179],v[176:179]
buffer_load_dwordx2 v[242:243],v244,s[8:11],0 offen sc1
s_waitcnt lgkmcnt(1)
v_mfma_f32_16x16x32_bf16 v[180:183],v[44:47],a[180:183],v[180:183]
v_cvt_pk_bf16_f32 v104,v96,v97
v_cvt_pk_bf16_f32 v105,v98,v99
v_cvt_pk_bf16_f32 v106,v100,v101
v_mfma_f32_16x16x32_bf16 v[184:187],v[44:47],a[184:187],v[184:187]
v_cvt_pk_bf16_f32 v107,v102,v103
v_lshlrev_b32 v96,16,v104
v_and_b32 v97,0xffff0000,v104
v_mfma_f32_16x16x32_bf16 v[188:191],v[44:47],a[188:191],v[188:191]
buffer_load_dwordx4 v0,s[8:11],s64 offen offset:3072 sc1 lds
v_lshlrev_b32 v98,16,v105
v_mfma_f32_16x16x32_bf16 v[160:163],v[48:51],a[192:195],v[160:163]
v_and_b32 v99,0xffff0000,v105
v_lshlrev_b32 v100,16,v106
v_and_b32 v101,0xffff0000,v106
v_mfma_f32_16x16x32_bf16 v[164:167],v[48:51],a[196:199],v[164:167]
v_lshlrev_b32 v102,16,v107
v_and_b32 v103,0xffff0000,v107
v_add_f32 v88,v88,v96
v_mfma_f32_16x16x32_bf16 v[168:171],v[48:51],a[200:203],v[168:171]
v_add_f32 v89,v89,v97
v_add_f32 v90,v90,v98
v_add_f32 v91,v91,v99
v_mfma_f32_16x16x32_bf16 v[172:175],v[48:51],a[204:207],v[172:175]
s_add_u32 m0,s57,24576
v_add_f32 v92,v92,v100
v_add_f32 v93,v93,v101
v_add_f32 v94,v94,v102
v_mfma_f32_16x16x32_bf16 v[176:179],v[48:51],a[208:211],v[176:179]
buffer_load_dwordx4 v0,s[8:11],s65 offen offset:0 sc1 lds
v_add_f32 v95,v95,v103
v_mfma_f32_16x16x32_bf16 v[180:183],v[48:51],a[212:215],v[180:183]
v_cvt_pk_bf16_f32 v104,v88,v89
v_cvt_pk_bf16_f32 v105,v90,v91
v_cvt_pk_bf16_f32 v106,v92,v93
v_mfma_f32_16x16x32_bf16 v[184:187],v[48:51],a[216:219],v[184:187]
v_cvt_pk_bf16_f32 v107,v94,v95
v_mfma_f32_16x16x32_bf16 v[188:191],v[48:51],a[220:223],v[188:191]
buffer_store_dwordx4 v[104:107],v0,s[8:11],s20 offen sc1
v_lshlrev_b32 v88,16,v104
v_mfma_f32_16x16x32_bf16 v[160:163],v[52:55],a[224:227],v[160:163]
buffer_load_dwordx4 v0,s[8:11],s65 offen offset:1024 sc1 lds
v_and_b32 v89,0xffff0000,v104
v_mfma_f32_16x16x32_bf16 v[164:167],v[52:55],a[228:231],v[164:167]
v_lshlrev_b32 v90,16,v105
v_and_b32 v91,0xffff0000,v105
v_lshlrev_b32 v92,16,v106
v_mfma_f32_16x16x32_bf16 v[168:171],v[52:55],a[232:235],v[168:171]
v_and_b32 v93,0xffff0000,v106
v_lshlrev_b32 v94,16,v107
v_and_b32 v95,0xffff0000,v107
v_mfma_f32_16x16x32_bf16 v[172:175],v[52:55],a[236:239],v[172:175]
v_readfirstlane_b32 s78,v88
v_mfma_f32_16x16x32_bf16 v[176:179],v[52:55],a[240:243],v[176:179]
s_nop 0
v_add_f32 v120,v88,-s78
v_add_f32 v121,v89,-s78
v_add_f32 v122,v90,-s78
v_mfma_f32_16x16x32_bf16 v[180:183],v[52:55],a[244:247],v[180:183]
v_add_f32 v123,v91,-s78
v_add_f32 v124,v92,-s78
v_add_f32 v125,v93,-s78
v_mfma_f32_16x16x32_bf16 v[184:187],v[52:55],a[248:251],v[184:187]
v_add_f32 v126,v94,-s78
v_add_f32 v127,v95,-s78
v_add_f32 v128,v120,v122
v_mfma_f32_16x16x32_bf16 v[188:191],v[52:55],a[252:255],v[188:191]
v_add_f32 v129,v121,v123
v_mul_f32 v130,v120,v120
v_mul_f32 v131,v121,v121
v_mfma_f32_16x16x32_bf16 v[192:195],v[56:59],a[0:3],0
v_add_f32 v132,v124,v126
v_add_f32 v133,v125,v127
v_fma_f32 v130,v122,v122,v130
v_mfma_f32_16x16x32_bf16 v[196:199],v[56:59],a[4:7],0
v_fma_f32 v131,v123,v123,v131
v_add_f32 v128,v128,v132
v_add_f32 v129,v129,v133
v_mfma_f32_16x16x32_bf16 v[200:203],v[56:59],a[8:11],0
v_fma_f32 v130,v124,v124,v130
v_fma_f32 v131,v125,v125,v131
v_add_f32 v128,v128,v129
v_mfma_f32_16x16x32_bf16 v[204:207],v[56:59],a[12:15],0
v_fma_f32 v130,v126,v126,v130
v_fma_f32 v131,v127,v127,v131
v_add_f32 v130,v130,v131
v_mfma_f32_16x16x32_bf16 v[208:211],v[56:59],a[16:19],0
s_nop 0
v_permlane32_swap_b32 v128,v130
v_add_f32 v128,v128,v130
v_cvt_pk_bf16_f32 v24,v160,v164
v_mfma_f32_16x16x32_bf16 v[212:215],v[56:59],a[20:23],0
v_add_f32_dpp v128,v128,v128 row_ror:8 row_mask:0xf bank_mask:0xf
v_cvt_pk_bf16_f32 v25,v168,v172
v_cvt_pk_bf16_f32 v26,v176,v180
v_mfma_f32_16x16x32_bf16 v[216:219],v[56:59],a[24:27],0
v_add_f32_dpp v128,v128,v128 row_ror:4 row_mask:0xf bank_mask:0xf
v_cvt_pk_bf16_f32 v27,v184,v188
v_cvt_pk_bf16_f32 v28,v161,v165
v_mfma_f32_16x16x32_bf16 v[220:223],v[56:59],a[28:31],0
v_add_f32_dpp v128,v128,v128 row_ror:2 row_mask:0xf bank_mask:0xf
v_cvt_pk_bf16_f32 v29,v169,v173
v_cvt_pk_bf16_f32 v30,v177,v181
v_mfma_f32_16x16x32_bf16 v[192:195],v[60:63],a[32:35],v[192:195]
v_add_f32_dpp v128,v128,v128 row_ror:1 row_mask:0xf bank_mask:0xf
v_mov_b32 v130,v128
v_cvt_pk_bf16_f32 v31,v185,v189
v_mfma_f32_16x16x32_bf16 v[196:199],v[60:63],a[36:39],v[196:199]
v_permlane16_swap_b32 v128,v130
v_add_f32 v128,v128,v130
v_mul_f32 v128,0x3b000000,v128
v_mfma_f32_16x16x32_bf16 v[200:203],v[60:63],a[40:43],v[200:203]
v_mov_b32 v130,v128
v_cvt_pk_bf16_f32 v32,v162,v166
v_cvt_pk_bf16_f32 v33,v170,v174
v_mfma_f32_16x16x32_bf16 v[204:207],v[60:63],a[44:47],v[204:207]
v_permlane32_swap_b32 v128,v130
v_fma_f32 v130,-v128,v128,v130
v_add_f32 v128,s78,v128
v_mfma_f32_16x16x32_bf16 v[208:211],v[60:63],a[48:51],v[208:211]
v_max_f32 v130,0,v130
v_cvt_pk_bf16_f32 v130,v128,v130
v_lshlrev_b32 v128,16,v130
v_mfma_f32_16x16x32_bf16 v[212:215],v[60:63],a[52:55],v[212:215]
v_and_b32 v130,0xffff0000,v130
v_add_f32 v130,0x3727c5ac,v130
v_cvt_pk_bf16_f32 v130,v130,v130
v_mfma_f32_16x16x32_bf16 v[216:219],v[60:63],a[56:59],v[216:219]
v_and_b32 v130,0xffff0000,v130
v_sqrt_f32 v130,v130
v_add_f32 v120,v88,-v128
v_mfma_f32_16x16x32_bf16 v[220:223],v[60:63],a[60:63],v[220:223]
v_add_f32 v121,v89,-v128
v_add_f32 v122,v90,-v128
v_add_f32 v123,v91,-v128
v_mfma_f32_16x16x32_bf16 v[192:195],v[64:67],a[64:67],v[192:195]
v_add_f32 v124,v92,-v128
v_add_f32 v125,v93,-v128
v_add_f32 v126,v94,-v128
v_mfma_f32_16x16x32_bf16 v[196:199],v[64:67],a[68:71],v[196:199]
v_add_f32 v127,v95,-v128
v_cvt_pk_bf16_f32 v130,v130,v130
v_and_b32 v130,0xffff0000,v130
v_mfma_f32_16x16x32_bf16 v[200:203],v[64:67],a[72:75],v[200:203]
v_rcp_f32 v130,v130
v_cvt_pk_bf16_f32 v108,v120,v121
v_cvt_pk_bf16_f32 v109,v122,v123
v_mfma_f32_16x16x32_bf16 v[204:207],v[64:67],a[76:79],v[204:207]
v_cvt_pk_bf16_f32 v110,v124,v125
v_cvt_pk_bf16_f32 v111,v126,v127
v_lshlrev_b32 v120,16,v108
v_mfma_f32_16x16x32_bf16 v[208:211],v[64:67],a[80:83],v[208:211]
v_cvt_pk_bf16_f32 v34,v178,v182
v_cvt_pk_bf16_f32 v35,v186,v190
v_cvt_pk_bf16_f32 v36,v163,v167
v_mfma_f32_16x16x32_bf16 v[212:215],v[64:67],a[84:87],v[212:215]
v_cvt_pk_bf16_f32 v37,v171,v175
v_cvt_pk_bf16_f32 v38,v179,v183
v_cvt_pk_bf16_f32 v39,v187,v191
v_mfma_f32_16x16x32_bf16 v[216:219],v[64:67],a[88:91],v[216:219]
v_and_b32 v121,0xffff0000,v108
v_lshlrev_b32 v122,16,v109
v_and_b32 v123,0xffff0000,v109
v_mfma_f32_16x16x32_bf16 v[220:223],v[64:67],a[92:95],v[220:223]
v_lshlrev_b32 v124,16,v110
v_and_b32 v125,0xffff0000,v110
v_lshlrev_b32 v126,16,v111
v_mfma_f32_16x16x32_bf16 v[192:195],v[68:71],a[96:99],v[192:195]
v_and_b32 v127,0xffff0000,v111
v_mul_f32 v120,v120,v130
v_mul_f32 v121,v121,v130
v_mfma_f32_16x16x32_bf16 v[196:199],v[68:71],a[100:103],v[196:199]
v_mul_f32 v122,v122,v130
v_mul_f32 v123,v123,v130
v_mul_f32 v124,v124,v130
v_mfma_f32_16x16x32_bf16 v[200:203],v[68:71],a[104:107],v[200:203]
v_mul_f32 v125,v125,v130
v_mul_f32 v126,v126,v130
v_mul_f32 v127,v127,v130
v_mfma_f32_16x16x32_bf16 v[204:207],v[68:71],a[108:111],v[204:207]
v_cvt_pk_bf16_f32 v108,v120,v121
v_cvt_pk_bf16_f32 v109,v122,v123
v_cvt_pk_bf16_f32 v110,v124,v125
v_mfma_f32_16x16x32_bf16 v[208:211],v[68:71],a[112:115],v[208:211]
s_add_u32 s62,s69,0
v_cvt_pk_bf16_f32 v111,v126,v127
v_lshlrev_b32 v112,16,v108
v_and_b32 v113,0xffff0000,v108
v_mfma_f32_16x16x32_bf16 v[212:215],v[68:71],a[116:119],v[212:215]
buffer_store_dwordx4 v[24:27],v5,s[8:11],s62 offen sc1
v_lshlrev_b32 v114,16,v109
v_mfma_f32_16x16x32_bf16 v[216:219],v[68:71],a[120:123],v[216:219]
v_and_b32 v115,0xffff0000,v109
v_lshlrev_b32 v116,16,v110
v_and_b32 v117,0xffff0000,v110
v_mfma_f32_16x16x32_bf16 v[220:223],v[68:71],a[124:127],v[220:223]
v_lshlrev_b32 v118,16,v111
v_and_b32 v119,0xffff0000,v111
v_add_f32 v88,v88,v112
v_mfma_f32_16x16x32_bf16 v[192:195],v[72:75],a[128:131],v[192:195]
s_add_u32 s62,s69,16384
v_add_f32 v89,v89,v113
v_add_f32 v90,v90,v114
v_add_f32 v91,v91,v115
v_mfma_f32_16x16x32_bf16 v[196:199],v[72:75],a[132:135],v[196:199]
buffer_store_dwordx4 v[28:31],v5,s[8:11],s62 offen sc1
v_add_f32 v92,v92,v116
v_mfma_f32_16x16x32_bf16 v[200:203],v[72:75],a[136:139],v[200:203]
v_add_f32 v93,v93,v117
v_add_f32 v94,v94,v118
v_add_f32 v95,v95,v119
v_mfma_f32_16x16x32_bf16 v[204:207],v[72:75],a[140:143],v[204:207]
v_cvt_pk_bf16_f32 v96,v88,v89
v_cvt_pk_bf16_f32 v97,v90,v91
v_cvt_pk_bf16_f32 v98,v92,v93
v_mfma_f32_16x16x32_bf16 v[208:211],v[72:75],a[144:147],v[208:211]
s_add_u32 s62,s69,32768
v_cvt_pk_bf16_f32 v99,v94,v95
v_mfma_f32_16x16x32_bf16 v[212:215],v[72:75],a[148:151],v[212:215]
buffer_store_dwordx4 v[32:35],v5,s[8:11],s62 offen sc1
v_mfma_f32_16x16x32_bf16 v[216:219],v[72:75],a[152:155],v[216:219]
buffer_store_dwordx4 v[96:99],v0,s[12:15],s19 offen sc1
v_mul_f32 v236,v112,v228
v_mfma_f32_16x16x32_bf16 v[220:223],v[72:75],a[156:159],v[220:223]
v_mul_f32 v237,v113,v229
v_fma_f32 v236,v114,v230,v236
v_fma_f32 v237,v115,v231,v237
v_mfma_f32_16x16x32_bf16 v[192:195],v[76:79],a[160:163],v[192:195]
s_add_u32 s62,s69,49152
v_fma_f32 v236,v116,v232,v236
v_fma_f32 v237,v117,v233,v237
v_fma_f32 v236,v118,v234,v236
v_mfma_f32_16x16x32_bf16 v[196:199],v[76:79],a[164:167],v[196:199]
buffer_store_dwordx4 v[36:39],v5,s[8:11],s62 offen sc1
v_fma_f32 v237,v119,v235,v237
v_mfma_f32_16x16x32_bf16 v[200:203],v[76:79],a[168:171],v[200:203]
v_add_f32 v236,v236,v237
v_mfma_f32_16x16x32_bf16 v[204:207],v[76:79],a[172:175],v[204:207]
s_nop 0
v_add_f32_dpp v236,v236,v236 row_ror:8 row_mask:0xf bank_mask:0xf
v_mfma_f32_16x16x32_bf16 v[208:211],v[76:79],a[176:179],v[208:211]
s_nop 0
v_add_f32_dpp v236,v236,v236 row_ror:4 row_mask:0xf bank_mask:0xf
v_mfma_f32_16x16x32_bf16 v[212:215],v[76:79],a[180:183],v[212:215]
s_nop 0
v_add_f32_dpp v236,v236,v236 row_ror:2 row_mask:0xf bank_mask:0xf
v_mfma_f32_16x16x32_bf16 v[216:219],v[76:79],a[184:187],v[216:219]
s_nop 0
v_add_f32_dpp v236,v236,v236 row_ror:1 row_mask:0xf bank_mask:0xf
v_mov_b32 v237,v236
v_mfma_f32_16x16x32_bf16 v[220:223],v[76:79],a[188:191],v[220:223]
s_nop 0
v_permlane16_swap_b32 v236,v237
v_add_f32 v236,v236,v237
v_mov_b32 v237,v236
v_mfma_f32_16x16x32_bf16 v[192:195],v[80:83],a[192:195],v[192:195]
s_nop 0
v_permlane32_swap_b32 v236,v237
v_add_f32 v236,v236,v237
v_cvt_pk_bf16_f32 v236,v236,v236
v_mfma_f32_16x16x32_bf16 v[196:199],v[80:83],a[196:199],v[196:199]
v_and_b32 v236,0xffff0000,v236
v_ashrrev_i32 v237,31,v236
v_or_b32 v237,0x80000000,v237
v_mfma_f32_16x16x32_bf16 v[192:195],v[84:87],a[224:227],v[192:195]
v_xor_b32 v236,v236,v237
v_and_b32 v236,0xffff0000,v236
s_sub_u32 s20,4095,s18
v_mfma_f32_16x16x32_bf16 v[196:199],v[84:87],a[228:231],v[196:199]
v_or_b32 v20,s20,v236
s_lshl_b32 s73,s26,13
s_lshl2_add_u32 s73,s68,s73
v_mfma_f32_16x16x32_bf16 v[200:203],v[80:83],a[200:203],v[200:203]
s_add_u32 s73,s73,10485760
s_add_u32 s73,s73,s86
v_mfma_f32_16x16x32_bf16 v[204:207],v[80:83],a[204:207],v[204:207]
v_cvt_pk_bf16_f32 v40,v192,v196
v_cvt_pk_bf16_f32 v44,v193,v197
v_cvt_pk_bf16_f32 v48,v194,v198
v_mfma_f32_16x16x32_bf16 v[200:203],v[84:87],a[232:235],v[200:203]
v_cvt_pk_bf16_f32 v52,v195,v199
v_mfma_f32_16x16x32_bf16 v[204:207],v[84:87],a[236:239],v[204:207]
v_mfma_f32_16x16x32_bf16 v[208:211],v[80:83],a[208:211],v[208:211]
v_mfma_f32_16x16x32_bf16 v[212:215],v[80:83],a[212:215],v[212:215]
v_mfma_f32_16x16x32_bf16 v[208:211],v[84:87],a[240:243],v[208:211]
v_mfma_f32_16x16x32_bf16 v[212:215],v[84:87],a[244:247],v[212:215]
v_cvt_pk_bf16_f32 v41,v200,v204
v_cvt_pk_bf16_f32 v45,v201,v205
v_cvt_pk_bf16_f32 v49,v202,v206
v_mfma_f32_16x16x32_bf16 v[216:219],v[80:83],a[216:219],v[216:219]
v_cvt_pk_bf16_f32 v53,v203,v207
v_mfma_f32_16x16x32_bf16 v[220:223],v[80:83],a[220:223],v[220:223]
v_cvt_pk_bf16_f32 v42,v208,v212
v_cvt_pk_bf16_f32 v46,v209,v213
v_cvt_pk_bf16_f32 v50,v210,v214
v_mfma_f32_16x16x32_bf16 v[216:219],v[84:87],a[248:251],v[216:219]
v_cvt_pk_bf16_f32 v54,v211,v215
v_mfma_f32_16x16x32_bf16 v[220:223],v[84:87],a[252:255],v[220:223]
s_nop 7
v_cvt_pk_bf16_f32 v43,v216,v220
s_add_u32 s62,s69,262144
buffer_store_dwordx4 v[40:43],v5,s[8:11],s62 offen sc1
v_cvt_pk_bf16_f32 v47,v217,v221
s_add_u32 s62,s69,278528
buffer_store_dwordx4 v[44:47],v5,s[8:11],s62 offen sc1
v_cvt_pk_bf16_f32 v51,v218,v222
s_add_u32 s62,s69,294912
buffer_store_dwordx4 v[48:51],v5,s[8:11],s62 offen sc1
v_cvt_pk_bf16_f32 v55,v219,v223
s_add_u32 s62,s69,311296
buffer_store_dwordx4 v[52:55],v5,s[8:11],s62 offen sc1
s_cmp_lg_u32 s72,0
s_cbranch_scc1 L_aa_321
s_waitcnt vmcnt(9)
s_branch L_aa_331
L_av_333:
ds_read_b128 v[24:27],v4 offset:0
ds_read_b128 v[28:31],v4 offset:1024
s_min_u32 s56,s32,s33
s_cmp_lt_u32 s77,64
s_cselect_b32 s56,s56,0
s_cmp_eq_u32 s56,0
s_cselect_b32 s72,0x80000000,0
v_mov_b32 v248,s72
s_or_b32 s64,s70,s72
s_or_b32 s65,s71,s72
s_cmp_lt_u32 s30,s31
s_cselect_b32 s65,0x80000000,s65
s_add_u32 s64,s64,s28
s_add_u32 s65,s65,s29
s_xor_b32 s58,s67,s40
s_xor_b32 s57,s67,s41
s_add_u32 m0,s58,0
s_waitcnt lgkmcnt(1)
v_mfma_f32_16x16x32_bf16 v[160:163],v[24:27],a[0:3],0
buffer_load_dwordx4 v0,s[8:11],s64 offen offset:0 sc1 lds
v_mfma_f32_16x16x32_bf16 v[164:167],v[24:27],a[4:7],0
ds_read_b128 v[32:35],v4 offset:2048
s_lshl_b32 s23,s51,5
v_mfma_f32_16x16x32_bf16 v[168:171],v[24:27],a[8:11],0
ds_read_b128 v[36:39],v4 offset:3072
s_add_u32 s23,s23,s68
v_mfma_f32_16x16x32_bf16 v[172:175],v[24:27],a[12:15],0
ds_read_b128 v[40:43],v4 offset:8192
s_lshl_b32 s24,s23,10
v_mfma_f32_16x16x32_bf16 v[176:179],v[24:27],a[16:19],0
buffer_load_dwordx4 v0,s[8:11],s64 offen offset:1024 sc1 lds
v_mfma_f32_16x16x32_bf16 v[180:183],v[24:27],a[20:23],0
ds_read_b128 v[44:47],v4 offset:9216
s_lshl_b32 s25,s51,10
v_mfma_f32_16x16x32_bf16 v[184:187],v[24:27],a[24:27],0
ds_read_b128 v[48:51],v4 offset:10240
s_waitcnt vmcnt(9)
v_mfma_f32_16x16x32_bf16 v[188:191],v[24:27],a[28:31],0
ds_read_b128 v[52:55],v4 offset:11264
v_mfma_f32_16x16x32_bf16 v[128:131],v[156:159],v[192:195],0
ds_write_b32 v247,v248
s_add_u32 s25,s25,2883584
s_waitcnt lgkmcnt(7)
v_mfma_f32_16x16x32_bf16 v[160:163],v[28:31],a[32:35],v[160:163]
buffer_load_dwordx4 v0,s[8:11],s64 offen offset:2048 sc1 lds
v_mfma_f32_16x16x32_bf16 v[164:167],v[28:31],a[36:39],v[164:167]
ds_read_b128 v[56:59],v4 offset:4096
s_waitcnt vmcnt(9)
v_mfma_f32_16x16x32_bf16 v[168:171],v[28:31],a[40:43],v[168:171]
ds_read_b128 v[60:63],v4 offset:5120
v_mfma_f32_16x16x32_bf16 v[128:131],v[156:159],v[196:199],v[128:131]
ds_read_b128 v[64:67],v4 offset:6144
s_cmp_eq_u32 s23,s55
s_cselect_b32 s25,s25,s24
v_mfma_f32_16x16x32_bf16 v[172:175],v[28:31],a[44:47],v[172:175]
ds_read_b128 v[68:71],v4 offset:7168
s_waitcnt vmcnt(8)
v_mfma_f32_16x16x32_bf16 v[176:179],v[28:31],a[48:51],v[176:179]
buffer_load_dwordx4 v0,s[8:11],s64 offen offset:3072 sc1 lds
v_mfma_f32_16x16x32_bf16 v[180:183],v[28:31],a[52:55],v[180:183]
ds_read_b128 v[72:75],v4 offset:12288
v_mfma_f32_16x16x32_bf16 v[128:131],v[156:159],v[200:203],v[128:131]
ds_read_b128 v[76:79],v4 offset:13312
s_add_u32 s25,s25,8388608
v_mfma_f32_16x16x32_bf16 v[184:187],v[28:31],a[56:59],v[184:187]
ds_read_b128 v[80:83],v4 offset:14336
s_waitcnt vmcnt(8)
v_mfma_f32_16x16x32_bf16 v[188:191],v[28:31],a[60:63],v[188:191]
ds_read_b128 v[84:87],v4 offset:15360
v_mfma_f32_16x16x32_bf16 v[128:131],v[156:159],v[204:207],v[128:131]
s_mov_b32 s6,268435456
s_cmp_eq_u32 s31,0
s_cselect_b32 s25,s24,s25
s_cselect_b64 s[4:5],s[16:17],s[44:45]
s_cmov_b32 s6,2097152
s_waitcnt lgkmcnt(14)
v_mfma_f32_16x16x32_bf16 v[160:163],v[32:35],a[64:67],v[160:163]
buffer_load_dwordx4 v[224:227],v0,s[4:7],s25 offen sc1
v_mfma_f32_16x16x32_bf16 v[164:167],v[32:35],a[68:71],v[164:167]
s_waitcnt vmcnt(8)
v_mfma_f32_16x16x32_bf16 v[132:135],v[156:159],v[208:211],0
s_add_u32 m0,s58,4096
s_add_u32 s64,s64,4096
s_lshr_b32 s24,s55,5
v_mfma_f32_16x16x32_bf16 v[168:171],v[32:35],a[72:75],v[168:171]
buffer_load_dwordx4 v0,s[8:11],s64 offen offset:0 sc1 lds
v_mfma_f32_16x16x32_bf16 v[172:175],v[32:35],a[76:79],v[172:175]
s_waitcnt vmcnt(8)
v_mfma_f32_16x16x32_bf16 v[132:135],v[156:159],v[212:215],v[132:135]
s_cmp_lt_u32 s51,s24
s_cselect_b32 s24,1,2
v_mov_b32 v252,s24
v_mfma_f32_16x16x32_bf16 v[176:179],v[32:35],a[80:83],v[176:179]
s_waitcnt vmcnt(7)
v_mfma_f32_16x16x32_bf16 v[132:135],v[156:159],v[216:219],v[132:135]
s_lshl2_add_u32 s25,s51,11018240
s_lshl_b32 s24,s68,16
s_add_u32 s24,s24,s31
v_mfma_f32_16x16x32_bf16 v[180:183],v[32:35],a[84:87],v[180:183]
ds_write_b128 v6,v[128:131]
v_mfma_f32_16x16x32_bf16 v[184:187],v[32:35],a[88:91],v[184:187]
buffer_load_dwordx4 v0,s[8:11],s64 offen offset:1024 sc1 lds
v_mfma_f32_16x16x32_bf16 v[188:191],v[32:35],a[92:95],v[188:191]
s_waitcnt vmcnt(7)
v_mfma_f32_16x16x32_bf16 v[132:135],v[156:159],v[220:223],v[132:135]
s_add_u32 s24,s24,s86
s_cmp_eq_u32 s24,1537
s_cselect_b32 s25,s25,0x80000000
s_waitcnt lgkmcnt(14)
v_mfma_f32_16x16x32_bf16 v[160:163],v[36:39],a[96:99],v[160:163]
buffer_store_dword v252,off,s[8:11],s25 sc1
v_mfma_f32_16x16x32_bf16 v[164:167],v[36:39],a[100:103],v[164:167]
s_bitcmp1_b64 s[38:39],s51
s_cselect_b32 s24,128,0
s_lshl_b32 s23,s51,13
v_mfma_f32_16x16x32_bf16 v[168:171],v[36:39],a[104:107],v[168:171]
ds_write_b128 v6,v[132:135] offset:2048
v_mfma_f32_16x16x32_bf16 v[172:175],v[36:39],a[108:111],v[172:175]
buffer_load_dwordx4 v0,s[8:11],s64 offen offset:2048 sc1 lds
v_mfma_f32_16x16x32_bf16 v[176:179],v[36:39],a[112:115],v[176:179]
s_lshl2_add_u32 s23,s68,s23
s_add_u32 s23,s23,10487168
s_add_u32 s23,s23,s24
v_mfma_f32_16x16x32_bf16 v[180:183],v[36:39],a[116:119],v[180:183]
buffer_load_dword v246,off,s[8:11],s23 sc1
v_mfma_f32_16x16x32_bf16 v[184:187],v[36:39],a[120:123],v[184:187]
v_lshrrev_b32 v244,4,v1
s_sub_u32 s23,s77,7
v_mfma_f32_16x16x32_bf16 v[188:191],v[36:39],a[124:127],v[188:191]
buffer_load_dwordx4 v0,s[8:11],s64 offen offset:3072 sc1 lds
s_waitcnt lgkmcnt(14)
v_mfma_f32_16x16x32_bf16 v[160:163],v[40:43],a[128:131],v[160:163]
s_waitcnt lgkmcnt(0)
s_barrier
v_add_u32 v244,s23,v244
v_mfma_f32_16x16x32_bf16 v[164:167],v[40:43],a[132:135],v[164:167]
ds_read_b128 v[248:251],v245
v_max_i32 v244,0,v244
v_mfma_f32_16x16x32_bf16 v[168:171],v[40:43],a[136:139],v[168:171]
buffer_store_dword v20,off,s[8:11],s73 sc1
v_mfma_f32_16x16x32_bf16 v[172:175],v[40:43],a[140:143],v[172:175]
s_add_u32 m0,s58,8192
s_add_u32 s64,s64,4096
v_lshl_add_u32 v244,v244,13,v21
v_mfma_f32_16x16x32_bf16 v[176:179],v[40:43],a[144:147],v[176:179]
buffer_load_dwordx4 v0,s[8:11],s64 offen offset:0 sc1 lds
v_mfma_f32_16x16x32_bf16 v[180:183],v[40:43],a[148:151],v[180:183]
buffer_load_dwordx2 v[242:243],v244,s[8:11],0 offen sc1
v_mfma_f32_16x16x32_bf16 v[184:187],v[40:43],a[152:155],v[184:187]
s_mov_b32 s73,0x80000000
v_mfma_f32_16x16x32_bf16 v[188:191],v[40:43],a[156:159],v[188:191]
s_waitcnt lgkmcnt(0)
v_or3_b32 v248,v248,v249,v250
v_or_b32 v248,v248,v251
v_mfma_f32_16x16x32_bf16 v[160:163],v[44:47],a[160:163],v[160:163]
buffer_load_dwordx4 v0,s[8:11],s64 offen offset:1024 sc1 lds
v_mfma_f32_16x16x32_bf16 v[164:167],v[44:47],a[164:167],v[164:167]
v_mfma_f32_16x16x32_bf16 v[168:171],v[44:47],a[168:171],v[168:171]
v_readfirstlane_b32 s72,v248
v_mfma_f32_16x16x32_bf16 v[172:175],v[44:47],a[172:175],v[172:175]
v_mfma_f32_16x16x32_bf16 v[176:179],v[44:47],a[176:179],v[176:179]
buffer_load_dwordx4 v0,s[8:11],s64 offen offset:2048 sc1 lds
v_mfma_f32_16x16x32_bf16 v[180:183],v[44:47],a[180:183],v[180:183]
v_mfma_f32_16x16x32_bf16 v[184:187],v[44:47],a[184:187],v[184:187]
v_mfma_f32_16x16x32_bf16 v[188:191],v[44:47],a[188:191],v[188:191]
v_mfma_f32_16x16x32_bf16 v[160:163],v[48:51],a[192:195],v[160:163]
buffer_load_dwordx4 v0,s[8:11],s64 offen offset:3072 sc1 lds
v_mfma_f32_16x16x32_bf16 v[164:167],v[48:51],a[196:199],v[164:167]
v_mfma_f32_16x16x32_bf16 v[168:171],v[48:51],a[200:203],v[168:171]
v_mfma_f32_16x16x32_bf16 v[172:175],v[48:51],a[204:207],v[172:175]
v_mfma_f32_16x16x32_bf16 v[176:179],v[48:51],a[208:211],v[176:179]
s_add_u32 m0,s57,24576
v_mfma_f32_16x16x32_bf16 v[180:183],v[48:51],a[212:215],v[180:183]
buffer_load_dwordx4 v0,s[8:11],s65 offen offset:0 sc1 lds
v_mfma_f32_16x16x32_bf16 v[184:187],v[48:51],a[216:219],v[184:187]
v_mfma_f32_16x16x32_bf16 v[188:191],v[48:51],a[220:223],v[188:191]
v_mfma_f32_16x16x32_bf16 v[160:163],v[52:55],a[224:227],v[160:163]
v_mfma_f32_16x16x32_bf16 v[164:167],v[52:55],a[228:231],v[164:167]
buffer_load_dwordx4 v0,s[8:11],s65 offen offset:1024 sc1 lds
v_mfma_f32_16x16x32_bf16 v[168:171],v[52:55],a[232:235],v[168:171]
v_mfma_f32_16x16x32_bf16 v[172:175],v[52:55],a[236:239],v[172:175]
v_mfma_f32_16x16x32_bf16 v[176:179],v[52:55],a[240:243],v[176:179]
v_mfma_f32_16x16x32_bf16 v[180:183],v[52:55],a[244:247],v[180:183]
v_mfma_f32_16x16x32_bf16 v[184:187],v[52:55],a[248:251],v[184:187]
v_mfma_f32_16x16x32_bf16 v[188:191],v[52:55],a[252:255],v[188:191]
v_mfma_f32_16x16x32_bf16 v[192:195],v[56:59],a[0:3],0
v_mfma_f32_16x16x32_bf16 v[196:199],v[56:59],a[4:7],0
v_mfma_f32_16x16x32_bf16 v[200:203],v[56:59],a[8:11],0
v_cvt_pk_bf16_f32 v24,v160,v164
v_cvt_pk_bf16_f32 v25,v168,v172
v_mfma_f32_16x16x32_bf16 v[204:207],v[56:59],a[12:15],0
v_cvt_pk_bf16_f32 v26,v176,v180
v_cvt_pk_bf16_f32 v27,v184,v188
v_mfma_f32_16x16x32_bf16 v[208:211],v[56:59],a[16:19],0
v_cvt_pk_bf16_f32 v28,v161,v165
v_cvt_pk_bf16_f32 v29,v169,v173
v_mfma_f32_16x16x32_bf16 v[212:215],v[56:59],a[20:23],0
v_cvt_pk_bf16_f32 v30,v177,v181
v_cvt_pk_bf16_f32 v31,v185,v189
v_mfma_f32_16x16x32_bf16 v[216:219],v[56:59],a[24:27],0
v_cvt_pk_bf16_f32 v32,v162,v166
v_cvt_pk_bf16_f32 v33,v170,v174
v_mfma_f32_16x16x32_bf16 v[220:223],v[56:59],a[28:31],0
v_cvt_pk_bf16_f32 v34,v178,v182
v_cvt_pk_bf16_f32 v35,v186,v190
v_mfma_f32_16x16x32_bf16 v[192:195],v[60:63],a[32:35],v[192:195]
v_cvt_pk_bf16_f32 v36,v163,v167
v_cvt_pk_bf16_f32 v37,v171,v175
v_mfma_f32_16x16x32_bf16 v[196:199],v[60:63],a[36:39],v[196:199]
v_cvt_pk_bf16_f32 v38,v179,v183
v_cvt_pk_bf16_f32 v39,v187,v191
v_mfma_f32_16x16x32_bf16 v[200:203],v[60:63],a[40:43],v[200:203]
v_mfma_f32_16x16x32_bf16 v[204:207],v[60:63],a[44:47],v[204:207]
v_mfma_f32_16x16x32_bf16 v[208:211],v[60:63],a[48:51],v[208:211]
v_mfma_f32_16x16x32_bf16 v[212:215],v[60:63],a[52:55],v[212:215]
v_mfma_f32_16x16x32_bf16 v[216:219],v[60:63],a[56:59],v[216:219]
v_mfma_f32_16x16x32_bf16 v[220:223],v[60:63],a[60:63],v[220:223]
v_mfma_f32_16x16x32_bf16 v[192:195],v[64:67],a[64:67],v[192:195]
v_mfma_f32_16x16x32_bf16 v[196:199],v[64:67],a[68:71],v[196:199]
v_mfma_f32_16x16x32_bf16 v[200:203],v[64:67],a[72:75],v[200:203]
v_mfma_f32_16x16x32_bf16 v[204:207],v[64:67],a[76:79],v[204:207]
v_mfma_f32_16x16x32_bf16 v[208:211],v[64:67],a[80:83],v[208:211]
v_mfma_f32_16x16x32_bf16 v[212:215],v[64:67],a[84:87],v[212:215]
v_mfma_f32_16x16x32_bf16 v[216:219],v[64:67],a[88:91],v[216:219]
v_mfma_f32_16x16x32_bf16 v[220:223],v[64:67],a[92:95],v[220:223]
v_mfma_f32_16x16x32_bf16 v[192:195],v[68:71],a[96:99],v[192:195]
v_mfma_f32_16x16x32_bf16 v[196:199],v[68:71],a[100:103],v[196:199]
v_mfma_f32_16x16x32_bf16 v[200:203],v[68:71],a[104:107],v[200:203]
v_mfma_f32_16x16x32_bf16 v[204:207],v[68:71],a[108:111],v[204:207]
v_mfma_f32_16x16x32_bf16 v[208:211],v[68:71],a[112:115],v[208:211]
s_add_u32 s62,s69,0
v_mfma_f32_16x16x32_bf16 v[212:215],v[68:71],a[116:119],v[212:215]
buffer_store_dwordx4 v[24:27],v5,s[8:11],s62 offen sc1
v_mfma_f32_16x16x32_bf16 v[216:219],v[68:71],a[120:123],v[216:219]
v_mfma_f32_16x16x32_bf16 v[220:223],v[68:71],a[124:127],v[220:223]
v_mfma_f32_16x16x32_bf16 v[192:195],v[72:75],a[128:131],v[192:195]
v_mfma_f32_16x16x32_bf16 v[196:199],v[72:75],a[132:135],v[196:199]
s_add_u32 s62,s69,16384
v_mfma_f32_16x16x32_bf16 v[200:203],v[72:75],a[136:139],v[200:203]
buffer_store_dwordx4 v[28:31],v5,s[8:11],s62 offen sc1
v_mfma_f32_16x16x32_bf16 v[204:207],v[72:75],a[140:143],v[204:207]
v_mfma_f32_16x16x32_bf16 v[208:211],v[72:75],a[144:147],v[208:211]
v_mfma_f32_16x16x32_bf16 v[212:215],v[72:75],a[148:151],v[212:215]
v_mfma_f32_16x16x32_bf16 v[216:219],v[72:75],a[152:155],v[216:219]
s_add_u32 s62,s69,32768
v_mfma_f32_16x16x32_bf16 v[220:223],v[72:75],a[156:159],v[220:223]
buffer_store_dwordx4 v[32:35],v5,s[8:11],s62 offen sc1
v_mfma_f32_16x16x32_bf16 v[192:195],v[76:79],a[160:163],v[192:195]
v_mfma_f32_16x16x32_bf16 v[196:199],v[76:79],a[164:167],v[196:199]
v_mfma_f32_16x16x32_bf16 v[200:203],v[76:79],a[168:171],v[200:203]
v_mfma_f32_16x16x32_bf16 v[204:207],v[76:79],a[172:175],v[204:207]
s_add_u32 s62,s69,49152
v_mfma_f32_16x16x32_bf16 v[208:211],v[76:79],a[176:179],v[208:211]
buffer_store_dwordx4 v[36:39],v5,s[8:11],s62 offen sc1
v_mfma_f32_16x16x32_bf16 v[212:215],v[76:79],a[180:183],v[212:215]
v_mfma_f32_16x16x32_bf16 v[216:219],v[76:79],a[184:187],v[216:219]
v_mfma_f32_16x16x32_bf16 v[220:223],v[76:79],a[188:191],v[220:223]
v_mfma_f32_16x16x32_bf16 v[192:195],v[80:83],a[192:195],v[192:195]
v_mfma_f32_16x16x32_bf16 v[196:199],v[80:83],a[196:199],v[196:199]
v_mfma_f32_16x16x32_bf16 v[192:195],v[84:87],a[224:227],v[192:195]
v_mfma_f32_16x16x32_bf16 v[196:199],v[84:87],a[228:231],v[196:199]
v_mfma_f32_16x16x32_bf16 v[200:203],v[80:83],a[200:203],v[200:203]
v_mfma_f32_16x16x32_bf16 v[204:207],v[80:83],a[204:207],v[204:207]
v_mfma_f32_16x16x32_bf16 v[200:203],v[84:87],a[232:235],v[200:203]
v_mfma_f32_16x16x32_bf16 v[204:207],v[84:87],a[236:239],v[204:207]
v_cvt_pk_bf16_f32 v40,v192,v196
v_cvt_pk_bf16_f32 v44,v193,v197
v_cvt_pk_bf16_f32 v48,v194,v198
v_mfma_f32_16x16x32_bf16 v[208:211],v[80:83],a[208:211],v[208:211]
v_cvt_pk_bf16_f32 v52,v195,v199
v_mfma_f32_16x16x32_bf16 v[212:215],v[80:83],a[212:215],v[212:215]
v_cvt_pk_bf16_f32 v41,v200,v204
v_cvt_pk_bf16_f32 v45,v201,v205
v_cvt_pk_bf16_f32 v49,v202,v206
v_mfma_f32_16x16x32_bf16 v[208:211],v[84:87],a[240:243],v[208:211]
v_cvt_pk_bf16_f32 v53,v203,v207
v_mfma_f32_16x16x32_bf16 v[212:215],v[84:87],a[244:247],v[212:215]
v_mfma_f32_16x16x32_bf16 v[216:219],v[80:83],a[216:219],v[216:219]
v_mfma_f32_16x16x32_bf16 v[220:223],v[80:83],a[220:223],v[220:223]
v_mfma_f32_16x16x32_bf16 v[216:219],v[84:87],a[248:251],v[216:219]
v_mfma_f32_16x16x32_bf16 v[220:223],v[84:87],a[252:255],v[220:223]
v_cvt_pk_bf16_f32 v42,v208,v212
v_cvt_pk_bf16_f32 v46,v209,v213
v_cvt_pk_bf16_f32 v50,v210,v214
v_cvt_pk_bf16_f32 v54,v211,v215
s_nop 3
v_cvt_pk_bf16_f32 v43,v216,v220
s_add_u32 s62,s69,262144
buffer_store_dwordx4 v[40:43],v5,s[8:11],s62 offen sc1
v_cvt_pk_bf16_f32 v47,v217,v221
s_add_u32 s62,s69,278528
buffer_store_dwordx4 v[44:47],v5,s[8:11],s62 offen sc1
v_cvt_pk_bf16_f32 v51,v218,v222
s_add_u32 s62,s69,294912
buffer_store_dwordx4 v[48:51],v5,s[8:11],s62 offen sc1
v_cvt_pk_bf16_f32 v55,v219,v223
s_add_u32 s62,s69,311296
buffer_store_dwordx4 v[52:55],v5,s[8:11],s62 offen sc1
s_cmp_lg_u32 s72,0
s_cbranch_scc1 L_aa_321
s_waitcnt vmcnt(8)
s_branch L_aa_331
L_aa_319:
ds_read_b128 v[24:27],v4 offset:0
ds_read_b128 v[28:31],v4 offset:1024
s_min_u32 s56,s32,s33
s_cmp_lt_u32 s77,64
s_cselect_b32 s56,s56,0
s_cmp_eq_u32 s56,0
s_cselect_b32 s72,0x80000000,0
v_mov_b32 v248,s72
s_or_b32 s64,s70,s72
s_or_b32 s65,s71,s72
s_cmp_lt_u32 s30,s31
s_cselect_b32 s65,0x80000000,s65
s_add_u32 s64,s64,s28
s_add_u32 s65,s65,s29
s_xor_b32 s58,s67,s40
s_xor_b32 s57,s67,s41
s_add_u32 m0,s58,0
s_waitcnt lgkmcnt(1)
v_mfma_f32_16x16x32_bf16 v[160:163],v[24:27],a[0:3],0
buffer_load_dwordx4 v0,s[8:11],s64 offen offset:0 sc1 lds
v_mfma_f32_16x16x32_bf16 v[164:167],v[24:27],a[4:7],0
ds_read_b128 v[32:35],v4 offset:2048
s_lshl_b32 s23,s51,5
v_mfma_f32_16x16x32_bf16 v[168:171],v[24:27],a[8:11],0
ds_read_b128 v[36:39],v4 offset:3072
s_add_u32 s23,s23,s68
v_mfma_f32_16x16x32_bf16 v[172:175],v[24:27],a[12:15],0
ds_read_b128 v[40:43],v4 offset:8192
s_lshl_b32 s24,s23,10
v_mfma_f32_16x16x32_bf16 v[176:179],v[24:27],a[16:19],0
buffer_load_dwordx4 v0,s[8:11],s64 offen offset:1024 sc1 lds
v_mfma_f32_16x16x32_bf16 v[180:183],v[24:27],a[20:23],0
ds_read_b128 v[44:47],v4 offset:9216
s_lshl_b32 s25,s51,10
v_mfma_f32_16x16x32_bf16 v[184:187],v[24:27],a[24:27],0
ds_read_b128 v[48:51],v4 offset:10240
s_add_u32 s25,s25,2883584
v_mfma_f32_16x16x32_bf16 v[188:191],v[24:27],a[28:31],0
ds_read_b128 v[52:55],v4 offset:11264
s_cmp_eq_u32 s23,s55
s_cselect_b32 s25,s25,s24
s_waitcnt lgkmcnt(6)
v_mfma_f32_16x16x32_bf16 v[160:163],v[28:31],a[32:35],v[160:163]
buffer_load_dwordx4 v0,s[8:11],s64 offen offset:2048 sc1 lds
v_mfma_f32_16x16x32_bf16 v[164:167],v[28:31],a[36:39],v[164:167]
ds_write_b32 v247,v248
s_add_u32 s25,s25,8388608
v_mfma_f32_16x16x32_bf16 v[168:171],v[28:31],a[40:43],v[168:171]
ds_read_b128 v[56:59],v4 offset:4096
s_mov_b32 s6,268435456
v_mfma_f32_16x16x32_bf16 v[172:175],v[28:31],a[44:47],v[172:175]
ds_read_b128 v[60:63],v4 offset:5120
s_cmp_eq_u32 s31,0
s_cselect_b32 s25,s24,s25
s_cselect_b64 s[4:5],s[16:17],s[44:45]
s_cmov_b32 s6,2097152
v_mfma_f32_16x16x32_bf16 v[176:179],v[28:31],a[48:51],v[176:179]
buffer_load_dwordx4 v0,s[8:11],s64 offen offset:3072 sc1 lds
v_mfma_f32_16x16x32_bf16 v[180:183],v[28:31],a[52:55],v[180:183]
ds_read_b128 v[64:67],v4 offset:6144
v_mfma_f32_16x16x32_bf16 v[184:187],v[28:31],a[56:59],v[184:187]
ds_read_b128 v[68:71],v4 offset:7168
v_mfma_f32_16x16x32_bf16 v[188:191],v[28:31],a[60:63],v[188:191]
ds_read_b128 v[72:75],v4 offset:12288
s_waitcnt lgkmcnt(11)
v_mfma_f32_16x16x32_bf16 v[160:163],v[32:35],a[64:67],v[160:163]
ds_read_b128 v[76:79],v4 offset:13312
s_add_u32 m0,s58,4096
v_mfma_f32_16x16x32_bf16 v[164:167],v[32:35],a[68:71],v[164:167]
ds_read_b128 v[80:83],v4 offset:14336
s_add_u32 s64,s64,4096
v_mfma_f32_16x16x32_bf16 v[168:171],v[32:35],a[72:75],v[168:171]
buffer_load_dwordx4 v0,s[8:11],s64 offen offset:0 sc1 lds
v_mfma_f32_16x16x32_bf16 v[172:175],v[32:35],a[76:79],v[172:175]
ds_read_b128 v[84:87],v4 offset:15360
v_mfma_f32_16x16x32_bf16 v[176:179],v[32:35],a[80:83],v[176:179]
buffer_load_dwordx4 v[224:227],v0,s[4:7],s25 offen sc1
v_mfma_f32_16x16x32_bf16 v[180:183],v[32:35],a[84:87],v[180:183]
s_lshr_b32 s24,s55,5
s_cmp_lt_u32 s51,s24
s_cselect_b32 s24,1,2
v_mfma_f32_16x16x32_bf16 v[184:187],v[32:35],a[88:91],v[184:187]
buffer_load_dwordx4 v0,s[8:11],s64 offen offset:1024 sc1 lds
v_mfma_f32_16x16x32_bf16 v[188:191],v[32:35],a[92:95],v[188:191]
v_mov_b32 v252,s24
s_lshl2_add_u32 s25,s51,11018240
s_waitcnt lgkmcnt(13)
v_mfma_f32_16x16x32_bf16 v[160:163],v[36:39],a[96:99],v[160:163]
s_waitcnt lgkmcnt(0)
s_barrier
s_lshl_b32 s24,s68,16
v_mfma_f32_16x16x32_bf16 v[164:167],v[36:39],a[100:103],v[164:167]
ds_read_b128 v[248:251],v245
s_add_u32 s24,s24,s31
v_mfma_f32_16x16x32_bf16 v[168:171],v[36:39],a[104:107],v[168:171]
buffer_load_dwordx4 v0,s[8:11],s64 offen offset:2048 sc1 lds
v_mfma_f32_16x16x32_bf16 v[172:175],v[36:39],a[108:111],v[172:175]
s_add_u32 s24,s24,s86
s_cmp_eq_u32 s24,1537
s_cselect_b32 s25,s25,0x80000000
v_mfma_f32_16x16x32_bf16 v[176:179],v[36:39],a[112:115],v[176:179]
buffer_store_dword v252,off,s[8:11],s25 sc1
v_mfma_f32_16x16x32_bf16 v[180:183],v[36:39],a[116:119],v[180:183]
s_bitcmp1_b64 s[38:39],s51
s_cselect_b32 s24,128,0
s_lshl_b32 s23,s51,13
v_mfma_f32_16x16x32_bf16 v[184:187],v[36:39],a[120:123],v[184:187]
buffer_load_dwordx4 v0,s[8:11],s64 offen offset:3072 sc1 lds
v_mfma_f32_16x16x32_bf16 v[188:191],v[36:39],a[124:127],v[188:191]
s_waitcnt lgkmcnt(0)
v_or3_b32 v248,v248,v249,v250
v_or_b32 v248,v248,v251
v_mfma_f32_16x16x32_bf16 v[160:163],v[40:43],a[128:131],v[160:163]
s_lshl2_add_u32 s23,s68,s23
s_add_u32 s23,s23,10487168
s_add_u32 s23,s23,s24
v_mfma_f32_16x16x32_bf16 v[164:167],v[40:43],a[132:135],v[164:167]
buffer_load_dword v246,off,s[8:11],s23 sc1
v_mfma_f32_16x16x32_bf16 v[168:171],v[40:43],a[136:139],v[168:171]
s_add_u32 m0,s58,8192
s_add_u32 s64,s64,4096
v_readfirstlane_b32 s72,v248
v_mfma_f32_16x16x32_bf16 v[172:175],v[40:43],a[140:143],v[172:175]
buffer_load_dwordx4 v0,s[8:11],s64 offen offset:0 sc1 lds
v_mfma_f32_16x16x32_bf16 v[176:179],v[40:43],a[144:147],v[176:179]
s_waitcnt vmcnt(12)
v_lshrrev_b32 v244,4,v1
s_sub_u32 s23,s77,7
v_mfma_f32_16x16x32_bf16 v[180:183],v[40:43],a[148:151],v[180:183]
buffer_store_dword v20,off,s[8:11],s73 sc1
v_mfma_f32_16x16x32_bf16 v[184:187],v[40:43],a[152:155],v[184:187]
s_mov_b32 s73,0x80000000
v_add_u32 v244,s23,v244
v_max_i32 v244,0,v244
v_mfma_f32_16x16x32_bf16 v[188:191],v[40:43],a[156:159],v[188:191]
buffer_load_dwordx4 v0,s[8:11],s64 offen offset:1024 sc1 lds
v_mfma_f32_16x16x32_bf16 v[160:163],v[44:47],a[160:163],v[160:163]
v_lshl_add_u32 v244,v244,13,v21
v_mfma_f32_16x16x32_bf16 v[164:167],v[44:47],a[164:167],v[164:167]
buffer_load_dwordx2 v[242:243],v244,s[8:11],0 offen sc1
v_mfma_f32_16x16x32_bf16 v[168:171],v[44:47],a[168:171],v[168:171]
v_mfma_f32_16x16x32_bf16 v[172:175],v[44:47],a[172:175],v[172:175]
buffer_load_dwordx4 v0,s[8:11],s64 offen offset:2048 sc1 lds
v_mfma_f32_16x16x32_bf16 v[176:179],v[44:47],a[176:179],v[176:179]
v_mfma_f32_16x16x32_bf16 v[180:183],v[44:47],a[180:183],v[180:183]
v_mfma_f32_16x16x32_bf16 v[184:187],v[44:47],a[184:187],v[184:187]
v_mfma_f32_16x16x32_bf16 v[188:191],v[44:47],a[188:191],v[188:191]
buffer_load_dwordx4 v0,s[8:11],s64 offen offset:3072 sc1 lds
v_mfma_f32_16x16x32_bf16 v[160:163],v[48:51],a[192:195],v[160:163]
v_mfma_f32_16x16x32_bf16 v[164:167],v[48:51],a[196:199],v[164:167]
v_mfma_f32_16x16x32_bf16 v[168:171],v[48:51],a[200:203],v[168:171]
v_mfma_f32_16x16x32_bf16 v[172:175],v[48:51],a[204:207],v[172:175]
s_add_u32 m0,s57,24576
v_mfma_f32_16x16x32_bf16 v[176:179],v[48:51],a[208:211],v[176:179]
buffer_load_dwordx4 v0,s[8:11],s65 offen offset:0 sc1 lds
v_mfma_f32_16x16x32_bf16 v[180:183],v[48:51],a[212:215],v[180:183]
v_mfma_f32_16x16x32_bf16 v[184:187],v[48:51],a[216:219],v[184:187]
v_mfma_f32_16x16x32_bf16 v[188:191],v[48:51],a[220:223],v[188:191]
v_mfma_f32_16x16x32_bf16 v[160:163],v[52:55],a[224:227],v[160:163]
buffer_load_dwordx4 v0,s[8:11],s65 offen offset:1024 sc1 lds
v_mfma_f32_16x16x32_bf16 v[164:167],v[52:55],a[228:231],v[164:167]
v_mfma_f32_16x16x32_bf16 v[168:171],v[52:55],a[232:235],v[168:171]
v_mfma_f32_16x16x32_bf16 v[172:175],v[52:55],a[236:239],v[172:175]
v_mfma_f32_16x16x32_bf16 v[176:179],v[52:55],a[240:243],v[176:179]
v_mfma_f32_16x16x32_bf16 v[180:183],v[52:55],a[244:247],v[180:183]
v_mfma_f32_16x16x32_bf16 v[184:187],v[52:55],a[248:251],v[184:187]
v_mfma_f32_16x16x32_bf16 v[188:191],v[52:55],a[252:255],v[188:191]
v_mfma_f32_16x16x32_bf16 v[192:195],v[56:59],a[0:3],0
v_mfma_f32_16x16x32_bf16 v[196:199],v[56:59],a[4:7],0
v_mfma_f32_16x16x32_bf16 v[200:203],v[56:59],a[8:11],0
v_cvt_pk_bf16_f32 v24,v160,v164
v_cvt_pk_bf16_f32 v25,v168,v172
v_mfma_f32_16x16x32_bf16 v[204:207],v[56:59],a[12:15],0
v_cvt_pk_bf16_f32 v26,v176,v180
v_cvt_pk_bf16_f32 v27,v184,v188
v_mfma_f32_16x16x32_bf16 v[208:211],v[56:59],a[16:19],0
v_cvt_pk_bf16_f32 v28,v161,v165
v_cvt_pk_bf16_f32 v29,v169,v173
v_mfma_f32_16x16x32_bf16 v[212:215],v[56:59],a[20:23],0
v_cvt_pk_bf16_f32 v30,v177,v181
v_cvt_pk_bf16_f32 v31,v185,v189
v_mfma_f32_16x16x32_bf16 v[216:219],v[56:59],a[24:27],0
v_cvt_pk_bf16_f32 v32,v162,v166
v_cvt_pk_bf16_f32 v33,v170,v174
v_mfma_f32_16x16x32_bf16 v[220:223],v[56:59],a[28:31],0
v_cvt_pk_bf16_f32 v34,v178,v182
v_cvt_pk_bf16_f32 v35,v186,v190
v_mfma_f32_16x16x32_bf16 v[192:195],v[60:63],a[32:35],v[192:195]
v_cvt_pk_bf16_f32 v36,v163,v167
v_cvt_pk_bf16_f32 v37,v171,v175
v_mfma_f32_16x16x32_bf16 v[196:199],v[60:63],a[36:39],v[196:199]
v_cvt_pk_bf16_f32 v38,v179,v183
v_cvt_pk_bf16_f32 v39,v187,v191
v_mfma_f32_16x16x32_bf16 v[200:203],v[60:63],a[40:43],v[200:203]
v_mfma_f32_16x16x32_bf16 v[204:207],v[60:63],a[44:47],v[204:207]
v_mfma_f32_16x16x32_bf16 v[208:211],v[60:63],a[48:51],v[208:211]
v_mfma_f32_16x16x32_bf16 v[212:215],v[60:63],a[52:55],v[212:215]
v_mfma_f32_16x16x32_bf16 v[216:219],v[60:63],a[56:59],v[216:219]
v_mfma_f32_16x16x32_bf16 v[220:223],v[60:63],a[60:63],v[220:223]
v_mfma_f32_16x16x32_bf16 v[192:195],v[64:67],a[64:67],v[192:195]
v_mfma_f32_16x16x32_bf16 v[196:199],v[64:67],a[68:71],v[196:199]
v_mfma_f32_16x16x32_bf16 v[200:203],v[64:67],a[72:75],v[200:203]
v_mfma_f32_16x16x32_bf16 v[204:207],v[64:67],a[76:79],v[204:207]
v_mfma_f32_16x16x32_bf16 v[208:211],v[64:67],a[80:83],v[208:211]
v_mfma_f32_16x16x32_bf16 v[212:215],v[64:67],a[84:87],v[212:215]
v_mfma_f32_16x16x32_bf16 v[216:219],v[64:67],a[88:91],v[216:219]
v_mfma_f32_16x16x32_bf16 v[220:223],v[64:67],a[92:95],v[220:223]
v_mfma_f32_16x16x32_bf16 v[192:195],v[68:71],a[96:99],v[192:195]
v_mfma_f32_16x16x32_bf16 v[196:199],v[68:71],a[100:103],v[196:199]
v_mfma_f32_16x16x32_bf16 v[200:203],v[68:71],a[104:107],v[200:203]
v_mfma_f32_16x16x32_bf16 v[204:207],v[68:71],a[108:111],v[204:207]
v_mfma_f32_16x16x32_bf16 v[208:211],v[68:71],a[112:115],v[208:211]
s_add_u32 s62,s69,0
v_mfma_f32_16x16x32_bf16 v[212:215],v[68:71],a[116:119],v[212:215]
buffer_store_dwordx4 v[24:27],v5,s[8:11],s62 offen sc1
v_mfma_f32_16x16x32_bf16 v[216:219],v[68:71],a[120:123],v[216:219]
v_mfma_f32_16x16x32_bf16 v[220:223],v[68:71],a[124:127],v[220:223]
v_mfma_f32_16x16x32_bf16 v[192:195],v[72:75],a[128:131],v[192:195]
v_mfma_f32_16x16x32_bf16 v[196:199],v[72:75],a[132:135],v[196:199]
s_add_u32 s62,s69,16384
v_mfma_f32_16x16x32_bf16 v[200:203],v[72:75],a[136:139],v[200:203]
buffer_store_dwordx4 v[28:31],v5,s[8:11],s62 offen sc1
v_mfma_f32_16x16x32_bf16 v[204:207],v[72:75],a[140:143],v[204:207]
v_mfma_f32_16x16x32_bf16 v[208:211],v[72:75],a[144:147],v[208:211]
v_mfma_f32_16x16x32_bf16 v[212:215],v[72:75],a[148:151],v[212:215]
v_mfma_f32_16x16x32_bf16 v[216:219],v[72:75],a[152:155],v[216:219]
s_add_u32 s62,s69,32768
v_mfma_f32_16x16x32_bf16 v[220:223],v[72:75],a[156:159],v[220:223]
buffer_store_dwordx4 v[32:35],v5,s[8:11],s62 offen sc1
v_mfma_f32_16x16x32_bf16 v[192:195],v[76:79],a[160:163],v[192:195]
v_mfma_f32_16x16x32_bf16 v[196:199],v[76:79],a[164:167],v[196:199]
v_mfma_f32_16x16x32_bf16 v[200:203],v[76:79],a[168:171],v[200:203]
v_mfma_f32_16x16x32_bf16 v[204:207],v[76:79],a[172:175],v[204:207]
s_add_u32 s62,s69,49152
v_mfma_f32_16x16x32_bf16 v[208:211],v[76:79],a[176:179],v[208:211]
buffer_store_dwordx4 v[36:39],v5,s[8:11],s62 offen sc1
v_mfma_f32_16x16x32_bf16 v[212:215],v[76:79],a[180:183],v[212:215]
v_mfma_f32_16x16x32_bf16 v[216:219],v[76:79],a[184:187],v[216:219]
v_mfma_f32_16x16x32_bf16 v[220:223],v[76:79],a[188:191],v[220:223]
v_mfma_f32_16x16x32_bf16 v[192:195],v[80:83],a[192:195],v[192:195]
v_mfma_f32_16x16x32_bf16 v[196:199],v[80:83],a[196:199],v[196:199]
v_mfma_f32_16x16x32_bf16 v[192:195],v[84:87],a[224:227],v[192:195]
v_mfma_f32_16x16x32_bf16 v[196:199],v[84:87],a[228:231],v[196:199]
v_mfma_f32_16x16x32_bf16 v[200:203],v[80:83],a[200:203],v[200:203]
v_mfma_f32_16x16x32_bf16 v[204:207],v[80:83],a[204:207],v[204:207]
v_mfma_f32_16x16x32_bf16 v[200:203],v[84:87],a[232:235],v[200:203]
v_mfma_f32_16x16x32_bf16 v[204:207],v[84:87],a[236:239],v[204:207]
v_cvt_pk_bf16_f32 v40,v192,v196
v_cvt_pk_bf16_f32 v44,v193,v197
v_cvt_pk_bf16_f32 v48,v194,v198
v_mfma_f32_16x16x32_bf16 v[208:211],v[80:83],a[208:211],v[208:211]
v_cvt_pk_bf16_f32 v52,v195,v199
v_mfma_f32_16x16x32_bf16 v[212:215],v[80:83],a[212:215],v[212:215]
v_cvt_pk_bf16_f32 v41,v200,v204
v_cvt_pk_bf16_f32 v45,v201,v205
v_cvt_pk_bf16_f32 v49,v202,v206
v_mfma_f32_16x16x32_bf16 v[208:211],v[84:87],a[240:243],v[208:211]
v_cvt_pk_bf16_f32 v53,v203,v207
v_mfma_f32_16x16x32_bf16 v[212:215],v[84:87],a[244:247],v[212:215]
v_mfma_f32_16x16x32_bf16 v[216:219],v[80:83],a[216:219],v[216:219]
v_mfma_f32_16x16x32_bf16 v[220:223],v[80:83],a[220:223],v[220:223]
v_mfma_f32_16x16x32_bf16 v[216:219],v[84:87],a[248:251],v[216:219]
v_mfma_f32_16x16x32_bf16 v[220:223],v[84:87],a[252:255],v[220:223]
v_cvt_pk_bf16_f32 v42,v208,v212
v_cvt_pk_bf16_f32 v46,v209,v213
v_cvt_pk_bf16_f32 v50,v210,v214
v_cvt_pk_bf16_f32 v54,v211,v215
s_nop 3
v_cvt_pk_bf16_f32 v43,v216,v220
s_add_u32 s62,s69,262144
buffer_store_dwordx4 v[40:43],v5,s[8:11],s62 offen sc1
v_cvt_pk_bf16_f32 v47,v217,v221
s_add_u32 s62,s69,278528
buffer_store_dwordx4 v[44:47],v5,s[8:11],s62 offen sc1
v_cvt_pk_bf16_f32 v51,v218,v222
s_add_u32 s62,s69,294912
buffer_store_dwordx4 v[48:51],v5,s[8:11],s62 offen sc1
v_cvt_pk_bf16_f32 v55,v219,v223
s_add_u32 s62,s69,311296
buffer_store_dwordx4 v[52:55],v5,s[8:11],s62 offen sc1
s_cmp_lg_u32 s72,0
s_cbranch_scc1 L_aa_321
s_waitcnt vmcnt(8)
L_aa_331:
s_barrier
s_cmp_lt_u32 s30,s31
s_cbranch_scc1 L_ao_338
s_xor_b32 s67,s67,65536
s_and_b32 s56,s50,2048
s_lshl_b32 s56,s56,4
s_add_u32 s56,s56,s67
v_add_u32 v2,s56,v0
s_and_b32 s56,s50,1024
s_lshl_b32 s56,s56,2
v_add_u32 v238,s56,v2
s_mov_b32 s76,s71
s_mov_b32 s53,s77
ds_read_b128 v[24:27],v238 offset:16384
ds_read_b128 v[40:43],v2 offset:0
ds_read_b128 v[56:59],v2 offset:4096
ds_read_b128 v[28:31],v238 offset:17408
ds_read_b128 v[44:47],v2 offset:1024
ds_read_b128 v[60:63],v2 offset:5120
ds_read_b128 v[32:35],v238 offset:18432
ds_read_b128 v[48:51],v2 offset:2048
ds_read_b128 v[64:67],v2 offset:6144
ds_read_b128 v[36:39],v238 offset:19456
ds_read_b128 v[52:55],v2 offset:3072
ds_read_b128 v[68:71],v2 offset:7168
s_waitcnt lgkmcnt(9)
v_mfma_f32_16x16x32_bf16 v[128:131],v[40:43],v[24:27],v[8:11]
ds_read_b128 v[72:75],v2 offset:24576
v_mfma_f32_16x16x32_bf16 v[132:135],v[56:59],v[24:27],v[12:15]
ds_read_b128 v[76:79],v2 offset:25600
s_waitcnt lgkmcnt(8)
v_mfma_f32_16x16x32_bf16 v[128:131],v[44:47],v[28:31],v[128:131]
ds_read_b128 v[80:83],v2 offset:26624
v_mfma_f32_16x16x32_bf16 v[132:135],v[60:63],v[28:31],v[132:135]
ds_read_b128 v[84:87],v2 offset:27648
s_waitcnt lgkmcnt(7)
v_mfma_f32_16x16x32_bf16 v[128:131],v[48:51],v[32:35],v[128:131]
ds_read_b128 v[88:91],v2 offset:8192
v_mfma_f32_16x16x32_bf16 v[132:135],v[64:67],v[32:35],v[132:135]
ds_read_b128 v[92:95],v2 offset:9216
s_waitcnt lgkmcnt(6)
v_mfma_f32_16x16x32_bf16 v[128:131],v[52:55],v[36:39],v[128:131]
ds_read_b128 v[96:99],v2 offset:10240
v_mfma_f32_16x16x32_bf16 v[132:135],v[68:71],v[36:39],v[132:135]
ds_read_b128 v[100:103],v2 offset:11264
s_waitcnt lgkmcnt(4)
s_mov_b32 vcc_lo,0x33333333
s_mov_b32 vcc_hi,0x33333333
v_mfma_f32_16x16x32_bf16 v[136:139],v[72:75],v[24:27],0
ds_read_b128 v[104:107],v2 offset:12288
v_max3_u32 v238,v72,v73,v74
v_max3_u32 v238,v74,v75,v238
v_cndmask_b32_dpp v120,v72,v74,vcc quad_perm:[0,1,0,1] row_mask:0xf bank_mask:0xf
v_cndmask_b32_dpp v121,v73,v75,vcc quad_perm:[0,1,0,1] row_mask:0xf bank_mask:0xf
v_mfma_f32_16x16x32_bf16 v[136:139],v[76:79],v[28:31],v[136:139]
ds_read_b128 v[108:111],v2 offset:13312
v_max3_u32 v238,v76,v77,v238
v_max3_u32 v238,v78,v79,v238
v_cndmask_b32_dpp v122,v76,v78,vcc quad_perm:[0,1,0,1] row_mask:0xf bank_mask:0xf
v_cndmask_b32_dpp v123,v77,v79,vcc quad_perm:[0,1,0,1] row_mask:0xf bank_mask:0xf
v_mfma_f32_16x16x32_bf16 v[136:139],v[80:83],v[32:35],v[136:139]
ds_read_b128 v[112:115],v2 offset:14336
v_max3_u32 v238,v80,v81,v238
v_max3_u32 v238,v82,v83,v238
v_cndmask_b32_dpp v124,v80,v82,vcc quad_perm:[0,1,0,1] row_mask:0xf bank_mask:0xf
v_cndmask_b32_dpp v125,v81,v83,vcc quad_perm:[0,1,0,1] row_mask:0xf bank_mask:0xf
v_mfma_f32_16x16x32_bf16 v[136:139],v[84:87],v[36:39],v[136:139]
ds_read_b128 v[116:119],v2 offset:15360
v_max3_u32 v238,v84,v85,v238
v_max3_u32 v238,v86,v87,v238
v_cndmask_b32_dpp v126,v84,v86,vcc quad_perm:[0,1,0,1] row_mask:0xf bank_mask:0xf
v_cndmask_b32_dpp v127,v85,v87,vcc quad_perm:[0,1,0,1] row_mask:0xf bank_mask:0xf
v_cmp_eq_u32 vcc,-1,v238
s_cmp_eq_u32 s30,0
s_cbranch_scc1 L_aa_320
s_cmp_lg_u64 vcc,0
s_cselect_b32 s27,1,0
s_andn2_b32 s57,s27,s31
s_add_u32 s66,s66,4
s_bfe_u32 s56,s66,0x10002
s_bitset0_b32 s37,s56
s_lshl_b32 s56,s57,s56
s_or_b32 s37,s37,s56
s_or_b32 s56,s37,s66
v_mov_b32 v22,s56
s_xor_b32 s69,s69,524288
s_waitcnt vmcnt(0) lgkmcnt(0)
buffer_store_dword v22,off,s[8:11],s74 sc1
s_cmp_lg_u32 s86,1536
s_cbranch_scc1 L_ae_341
s_mov_b32 s77,s35
s_mov_b32 s30,0
s_lshl_b32 s56,s77,5
s_add_u32 s56,s56,s68
s_mul_i32 s70,s56,24576
s_lshl_b32 s71,s56,12
s_lshl_b32 s59,s77,13
s_lshl2_add_u32 s59,s68,s59
s_add_u32 s59,s59,10485760
s_buffer_load_dword s32,s[8:11],s59
s_mov_b32 s33,1
s_add_u32 s70,s70,100663296
s_add_u32 s71,s71,41943040
v_mov_b32 v19,s59
s_branch L_af_342
L_ae_341:
s_ff1_i32_b64 s77,s[84:85]
s_bitset0_b64 s[84:85],s77
s_min_u32 s77,s77,64
s_lshr_b32 s61,s55,5
s_lshl_b32 s56,s77,5
s_add_u32 s56,s56,s68
s_mul_i32 s70,s56,24576
s_lshl_b32 s71,s56,12
s_lshl_b32 s59,s77,13
s_lshl2_add_u32 s59,s68,s59
s_add_u32 s59,s59,10486144
s_cmp_lt_u32 s77,s61
s_cselect_b32 s57,0,16777216
s_mov_b32 s60,s59
s_buffer_load_dword s33,s[8:11],s60
s_add_u32 s71,s71,s57
s_add_u32 s71,s71,58720256
s_cmp_eq_u32 s77,s61
s_cselect_b32 s57,50331648,0
s_cselect_b32 s58,1536,0
s_add_u32 s59,s59,s58
s_buffer_load_dword s32,s[8:11],s59
s_add_u32 s70,s70,s57
s_add_u32 s70,s70,150994944
v_mov_b32 v19,s59
v_writelane_b32 v19,s60,1
L_af_342:
s_cmp_ge_u32 s53,60
s_cbranch_scc1 L_a4_343
L_a4_344:
s_and_b32 s27,s27,s31
s_cbranch_scc1 L_ac_346
L_acb_347:
v_max3_f32 v238,v128,v129,v130
v_max3_f32 v239,v131,v132,v133
v_max3_f32 v238,v134,v135,v238
v_max3_f32 v239,v138,v139,v239
v_max_f32 v238,v238,v239
v_max_f32 v239,v238,v239
v_pk_mul_f32 v[128:129],v[128:129],v[152:153] op_sel_hi:[1,0]
v_pk_mul_f32 v[130:131],v[130:131],v[152:153] op_sel_hi:[1,0]
v_permlane16_swap_b32 v238,v239
v_max_f32 v238,v238,v239
v_max_f32 v239,v238,v239
v_pk_mul_f32 v[132:133],v[132:133],v[152:153] op_sel_hi:[1,0]
v_pk_mul_f32 v[134:135],v[134:135],v[152:153] op_sel_hi:[1,0]
v_permlane32_swap_b32 v238,v239
v_max_f32 v238,v238,v239
v_mul_f32 v238,v152,v238
v_pk_mul_f32 v[138:139],v[138:139],v[152:153] op_sel_hi:[1,0]
buffer_load_dword v17,v16,s[8:11],s87 offen sc1
v_pk_add_f32 v[128:129],v[128:129],v[238:239] op_sel_hi:[1,0] neg_lo:[0,1] neg_hi:[0,1]
v_pk_add_f32 v[130:131],v[130:131],v[238:239] op_sel_hi:[1,0] neg_lo:[0,1] neg_hi:[0,1]
v_pk_add_f32 v[132:133],v[132:133],v[238:239] op_sel_hi:[1,0] neg_lo:[0,1] neg_hi:[0,1]
v_pk_add_f32 v[134:135],v[134:135],v[238:239] op_sel_hi:[1,0] neg_lo:[0,1] neg_hi:[0,1]
v_pk_add_f32 v[138:139],v[138:139],v[238:239] op_sel_hi:[1,0] neg_lo:[0,1] neg_hi:[0,1]
v_exp_f32 v128,v128
v_exp_f32 v129,v129
v_exp_f32 v130,v130
v_exp_f32 v131,v131
v_exp_f32 v132,v132
v_exp_f32 v133,v133
v_exp_f32 v134,v134
v_exp_f32 v135,v135
v_exp_f32 v138,v138
v_exp_f32 v139,v139
v_pk_add_f32 v[148:149],v[128:129],v[130:131]
v_pk_add_f32 v[150:151],v[132:133],v[134:135]
v_pk_add_f32 v[148:149],v[148:149],v[138:139]
v_pk_add_f32 v[148:149],v[148:149],v[150:151]
v_add_f32 v150,v148,v149
v_add_f32 v151,v148,v149
s_nop 1
v_permlane16_swap_b32 v150,v151
v_add_f32 v148,v150,v151
v_add_f32 v149,v150,v151
s_nop 1
v_permlane32_swap_b32 v148,v149
v_add_f32 v148,v148,v149
v_rcp_f32 v148,v148
s_waitcnt vmcnt(0)
v_cmp_gt_u32 vcc,s66,v17
v_pk_mul_f32 v[138:139],v[138:139],v[148:149] op_sel_hi:[1,0]
v_pk_mul_f32 v[128:129],v[128:129],v[148:149] op_sel_hi:[1,0]
v_pk_mul_f32 v[130:131],v[130:131],v[148:149] op_sel_hi:[1,0]
v_pk_mul_f32 v[132:133],v[132:133],v[148:149] op_sel_hi:[1,0]
v_pk_mul_f32 v[134:135],v[134:135],v[148:149] op_sel_hi:[1,0]
s_cbranch_vccnz L_ap_349
L_apb_350:
s_xor_b32 s34,s69,524288
buffer_load_dwordx4 v[192:195],v7,s[8:11],s34 offen sc1
s_bfe_u32 s56,s66,0x10002
v_lshrrev_b32 v238,s56,v17
v_and_b32 v238,1,v238
v_cmp_ne_u32 vcc,0,v238
v_cvt_pk_bf16_f32 v144,v138,v139
v_cvt_pk_bf16_f32 v147,v138,v139
v_cvt_pk_bf16_f32 v140,v128,v129
v_cvt_pk_bf16_f32 v141,v130,v131
v_cvt_pk_bf16_f32 v142,v132,v133
v_cvt_pk_bf16_f32 v143,v134,v135
s_cbranch_vccnz L_ak_340
s_add_u32 s36,s36,4
v_mfma_f32_16x16x16_bf16 v[24:27],v[120:121],v[144:145],0
s_add_u32 s34,s34,4096
v_mfma_f32_16x16x16_bf16 v[28:31],v[120:121],v[146:147],0
buffer_load_dwordx4 v[196:199],v7,s[8:11],s34 offen sc1
v_mfma_f32_16x16x16_bf16 v[32:35],v[122:123],v[144:145],0
s_add_u32 s34,s34,4096
v_mfma_f32_16x16x16_bf16 v[36:39],v[122:123],v[146:147],0
buffer_load_dwordx4 v[200:203],v7,s[8:11],s34 offen sc1
v_mfma_f32_16x16x16_bf16 v[40:43],v[124:125],v[144:145],0
s_add_u32 s34,s34,4096
v_mfma_f32_16x16x16_bf16 v[44:47],v[124:125],v[146:147],0
buffer_load_dwordx4 v[204:207],v7,s[8:11],s34 offen sc1
v_mfma_f32_16x16x16_bf16 v[48:51],v[126:127],v[144:145],0
s_add_u32 s34,s34,4096
v_mfma_f32_16x16x16_bf16 v[52:55],v[126:127],v[146:147],0
buffer_load_dwordx4 v[208:211],v7,s[8:11],s34 offen sc1
v_mfma_f32_16x16x32_bf16 v[24:27],v[88:91],v[140:143],v[24:27]
s_add_u32 s34,s34,4096
v_mfma_f32_16x16x32_bf16 v[28:31],v[92:95],v[140:143],v[28:31]
buffer_load_dwordx4 v[212:215],v7,s[8:11],s34 offen sc1
v_mfma_f32_16x16x32_bf16 v[32:35],v[96:99],v[140:143],v[32:35]
s_add_u32 s34,s34,4096
v_mfma_f32_16x16x32_bf16 v[36:39],v[100:103],v[140:143],v[36:39]
buffer_load_dwordx4 v[216:219],v7,s[8:11],s34 offen sc1
v_cvt_pk_bf16_f32 v72,v24,v28
v_cvt_pk_bf16_f32 v73,v25,v29
v_mfma_f32_16x16x32_bf16 v[40:43],v[104:107],v[140:143],v[40:43]
s_add_u32 s34,s34,4096
v_cvt_pk_bf16_f32 v74,v26,v30
v_cvt_pk_bf16_f32 v75,v27,v31
v_mfma_f32_16x16x32_bf16 v[44:47],v[108:111],v[140:143],v[44:47]
ds_write_b128 v3,v[72:75] offset:0
v_cvt_pk_bf16_f32 v76,v32,v36
v_cvt_pk_bf16_f32 v77,v33,v37
v_mfma_f32_16x16x32_bf16 v[48:51],v[112:115],v[140:143],v[48:51]
buffer_load_dwordx4 v[220:223],v7,s[8:11],s34 offen sc1
v_cvt_pk_bf16_f32 v78,v34,v38
v_cvt_pk_bf16_f32 v79,v35,v39
v_mfma_f32_16x16x32_bf16 v[52:55],v[116:119],v[140:143],v[52:55]
ds_write_b128 v3,v[76:79] offset:1024
v_cvt_pk_bf16_f32 v80,v40,v44
v_cvt_pk_bf16_f32 v81,v41,v45
v_cvt_pk_bf16_f32 v82,v42,v46
v_cvt_pk_bf16_f32 v83,v43,v47
ds_write_b128 v3,v[80:83] offset:2048
s_nop 1
v_cvt_pk_bf16_f32 v84,v48,v52
v_cvt_pk_bf16_f32 v85,v49,v53
v_cvt_pk_bf16_f32 v86,v50,v54
v_cvt_pk_bf16_f32 v87,v51,v55
ds_write_b128 v3,v[84:87] offset:3072
s_cmp_eq_u32 s31,0
s_cbranch_scc1 L_ah_348
s_waitcnt lgkmcnt(0)
s_barrier
s_mov_b32 s26,s51
s_mov_b32 s51,s53
s_branch L_aa_332
L_ah_348:
s_cmp_ge_u32 s35,64
s_cbranch_scc1 L_a1_351
L_a2_352:
s_waitcnt vmcnt(7)
v_mfma_f32_16x16x32_bf16 v[160:163],v[156:159],v[192:195],0
s_waitcnt vmcnt(6)
v_mfma_f32_16x16x32_bf16 v[160:163],v[156:159],v[196:199],v[160:163]
s_waitcnt vmcnt(5)
v_mfma_f32_16x16x32_bf16 v[160:163],v[156:159],v[200:203],v[160:163]
s_waitcnt vmcnt(4)
v_mfma_f32_16x16x32_bf16 v[160:163],v[156:159],v[204:207],v[160:163]
s_waitcnt vmcnt(3)
v_mfma_f32_16x16x32_bf16 v[164:167],v[156:159],v[208:211],0
s_waitcnt vmcnt(2)
v_mfma_f32_16x16x32_bf16 v[164:167],v[156:159],v[212:215],v[164:167]
s_waitcnt vmcnt(1)
v_mfma_f32_16x16x32_bf16 v[164:167],v[156:159],v[216:219],v[164:167]
ds_write_b128 v6,v[160:163]
s_waitcnt vmcnt(0)
v_mfma_f32_16x16x32_bf16 v[164:167],v[156:159],v[220:223],v[164:167]
s_nop 7
ds_write_b128 v6,v[164:167] offset:2048
s_waitcnt lgkmcnt(0)
s_barrier
buffer_store_dword v20,off,s[8:11],s73 sc1
s_mov_b32 s73,0x80000000
s_mov_b32 s27,1
s_branch L_aa_323
L_ao_338:
s_xor_b32 s67,s67,65536
s_and_b32 s56,s50,2048
s_lshl_b32 s56,s56,4
s_add_u32 s56,s56,s67
v_add_u32 v2,s56,v0
s_and_b32 s56,s50,1024
s_lshl_b32 s56,s56,2
v_add_u32 v238,s56,v2
s_mov_b32 s76,s71
s_mov_b32 s53,s77
ds_read_b128 v[24:27],v238 offset:16384
ds_read_b128 v[40:43],v2 offset:0
ds_read_b128 v[56:59],v2 offset:4096
ds_read_b128 v[28:31],v238 offset:17408
ds_read_b128 v[44:47],v2 offset:1024
ds_read_b128 v[60:63],v2 offset:5120
ds_read_b128 v[32:35],v238 offset:18432
ds_read_b128 v[48:51],v2 offset:2048
ds_read_b128 v[64:67],v2 offset:6144
ds_read_b128 v[36:39],v238 offset:19456
ds_read_b128 v[52:55],v2 offset:3072
ds_read_b128 v[68:71],v2 offset:7168
buffer_load_dwordx4 v[72:75],v0,s[8:11],s76 offen offset:0 sc1
buffer_load_dwordx4 v[76:79],v0,s[8:11],s76 offen offset:1024 sc1
buffer_load_dwordx4 v[80:83],v0,s[8:11],s76 offen offset:2048 sc1
buffer_load_dwordx4 v[84:87],v0,s[8:11],s76 offen offset:3072 sc1
s_waitcnt lgkmcnt(9)
v_mfma_f32_16x16x32_bf16 v[128:131],v[40:43],v[24:27],v[8:11]
ds_read_b128 v[88:91],v2 offset:8192
v_mfma_f32_16x16x32_bf16 v[132:135],v[56:59],v[24:27],v[12:15]
ds_read_b128 v[92:95],v2 offset:9216
s_waitcnt lgkmcnt(8)
v_mfma_f32_16x16x32_bf16 v[128:131],v[44:47],v[28:31],v[128:131]
ds_read_b128 v[96:99],v2 offset:10240
v_mfma_f32_16x16x32_bf16 v[132:135],v[60:63],v[28:31],v[132:135]
ds_read_b128 v[100:103],v2 offset:11264
s_waitcnt lgkmcnt(7)
v_mfma_f32_16x16x32_bf16 v[128:131],v[48:51],v[32:35],v[128:131]
ds_read_b128 v[104:107],v2 offset:12288
v_mfma_f32_16x16x32_bf16 v[132:135],v[64:67],v[32:35],v[132:135]
ds_read_b128 v[108:111],v2 offset:13312
s_waitcnt lgkmcnt(6)
v_mfma_f32_16x16x32_bf16 v[128:131],v[52:55],v[36:39],v[128:131]
ds_read_b128 v[112:115],v2 offset:14336
v_mfma_f32_16x16x32_bf16 v[132:135],v[68:71],v[36:39],v[132:135]
ds_read_b128 v[116:119],v2 offset:15360
s_add_u32 s66,s66,4
s_bfe_u32 s56,s66,0x10002
s_bitset0_b32 s37,s56
s_lshl_b32 s56,0,s56
s_or_b32 s37,s37,s56
s_or_b32 s56,s37,s66
v_mov_b32 v22,s56
s_xor_b32 s69,s69,524288
s_waitcnt vmcnt(4) lgkmcnt(0)
buffer_store_dword v22,off,s[8:11],s74 sc1
s_mov_b32 s26,s51
s_mov_b32 s27,3
s_branch L_aa_327
L_aa_320:
s_add_u32 s66,s66,4
s_bfe_u32 s56,s66,0x10002
s_bitset0_b32 s37,s56
s_lshl_b32 s56,0,s56
s_or_b32 s37,s37,s56
s_or_b32 s56,s37,s66
v_mov_b32 v22,s56
s_xor_b32 s69,s69,524288
s_waitcnt vmcnt(0) lgkmcnt(0)
buffer_store_dword v22,off,s[8:11],s74 sc1
L_aq_353:
buffer_load_dword v17,v16,s[8:11],s87 offen sc1
s_sub_u32 s49,s49,1
s_cbranch_scc1 L_abort2
s_waitcnt vmcnt(0)
v_cmp_gt_u32 vcc,s66,v17
s_cbranch_vccnz L_aq_353
s_xor_b32 s34,s69,524288
buffer_load_dwordx4 v[160:163],v7,s[8:11],s34 offen sc1
s_add_u32 s34,s34,4096
buffer_load_dwordx4 v[164:167],v7,s[8:11],s34 offen sc1
s_add_u32 s34,s34,4096
buffer_load_dwordx4 v[168:171],v7,s[8:11],s34 offen sc1
s_add_u32 s34,s34,4096
buffer_load_dwordx4 v[172:175],v7,s[8:11],s34 offen sc1
s_add_u32 s34,s34,4096
buffer_load_dwordx4 v[176:179],v7,s[8:11],s34 offen sc1
s_add_u32 s34,s34,4096
buffer_load_dwordx4 v[180:183],v7,s[8:11],s34 offen sc1
s_add_u32 s34,s34,4096
buffer_load_dwordx4 v[184:187],v7,s[8:11],s34 offen sc1
s_add_u32 s34,s34,4096
buffer_load_dwordx4 v[188:191],v7,s[8:11],s34 offen sc1
buffer_load_dwordx4 v[72:75],v0,s[8:11],s76 offen offset:0 sc1
buffer_load_dwordx4 v[76:79],v0,s[8:11],s76 offen offset:1024 sc1
buffer_load_dwordx4 v[80:83],v0,s[8:11],s76 offen offset:2048 sc1
buffer_load_dwordx4 v[84:87],v0,s[8:11],s76 offen offset:3072 sc1
s_waitcnt vmcnt(11)
v_mfma_f32_16x16x32_bf16 v[192:195],v[156:159],v[160:163],0
s_waitcnt vmcnt(10)
v_mfma_f32_16x16x32_bf16 v[192:195],v[156:159],v[164:167],v[192:195]
s_waitcnt vmcnt(9)
v_mfma_f32_16x16x32_bf16 v[192:195],v[156:159],v[168:171],v[192:195]
s_waitcnt vmcnt(8)
v_mfma_f32_16x16x32_bf16 v[192:195],v[156:159],v[172:175],v[192:195]
s_waitcnt vmcnt(7)
v_mfma_f32_16x16x32_bf16 v[196:199],v[156:159],v[176:179],0
s_waitcnt vmcnt(6)
v_mfma_f32_16x16x32_bf16 v[196:199],v[156:159],v[180:183],v[196:199]
s_waitcnt vmcnt(5)
v_mfma_f32_16x16x32_bf16 v[196:199],v[156:159],v[184:187],v[196:199]
ds_write_b128 v6,v[192:195]
s_waitcnt vmcnt(4)
v_mfma_f32_16x16x32_bf16 v[196:199],v[156:159],v[188:191],v[196:199]
s_nop 7
ds_write_b128 v6,v[196:199] offset:2048
s_waitcnt lgkmcnt(0)
s_barrier
buffer_store_dword v20,off,s[8:11],s73 sc1
s_mov_b32 s73,0x80000000
s_mov_b32 s27,0
s_branch L_aa_323
L_aa_321:
s_add_u32 s56,s30,s86
s_cmp_lg_u32 s56,1537
s_cbranch_scc1 L_al_339
s_add_u32 s66,s66,4
s_bfe_u32 s56,s66,0x10002
s_bitset0_b32 s37,s56
s_lshl_b32 s56,1,s56
s_or_b32 s37,s37,s56
s_or_b32 s56,s37,s66
v_mov_b32 v22,s56
s_xor_b32 s69,s69,524288
s_waitcnt vmcnt(0) lgkmcnt(0)
buffer_store_dword v22,off,s[8:11],s74 sc1
s_cmp_lg_u32 s86,1536
s_cbranch_scc1 L_ae_354
s_mov_b32 s77,s35
s_mov_b32 s30,0
s_lshl_b32 s56,s77,5
s_add_u32 s56,s56,s68
s_mul_i32 s70,s56,24576
s_lshl_b32 s71,s56,12
s_lshl_b32 s59,s77,13
s_lshl2_add_u32 s59,s68,s59
s_add_u32 s59,s59,10485760
s_buffer_load_dword s32,s[8:11],s59
s_mov_b32 s33,1
s_add_u32 s70,s70,100663296
s_add_u32 s71,s71,41943040
v_mov_b32 v19,s59
s_branch L_af_355
L_ae_354:
s_ff1_i32_b64 s77,s[84:85]
s_bitset0_b64 s[84:85],s77
s_min_u32 s77,s77,64
s_lshr_b32 s61,s55,5
s_lshl_b32 s56,s77,5
s_add_u32 s56,s56,s68
s_mul_i32 s70,s56,24576
s_lshl_b32 s71,s56,12
s_lshl_b32 s59,s77,13
s_lshl2_add_u32 s59,s68,s59
s_add_u32 s59,s59,10486144
s_cmp_lt_u32 s77,s61
s_cselect_b32 s57,0,16777216
s_mov_b32 s60,s59
s_buffer_load_dword s33,s[8:11],s60
s_add_u32 s71,s71,s57
s_add_u32 s71,s71,58720256
s_cmp_eq_u32 s77,s61
s_cselect_b32 s57,50331648,0
s_cselect_b32 s58,1536,0
s_add_u32 s59,s59,s58
s_buffer_load_dword s32,s[8:11],s59
s_add_u32 s70,s70,s57
s_add_u32 s70,s70,150994944
v_mov_b32 v19,s59
v_writelane_b32 v19,s60,1
L_af_355:
s_branch L_ak_340
L_al_339:
s_add_u32 s66,s66,4
s_bfe_u32 s56,s66,0x10002
s_bitset0_b32 s37,s56
s_lshl_b32 s56,0,s56
s_or_b32 s37,s37,s56
s_or_b32 s56,s37,s66
v_mov_b32 v22,s56
s_xor_b32 s69,s69,524288
s_waitcnt vmcnt(0) lgkmcnt(0)
buffer_store_dword v22,off,s[8:11],s74 sc1
buffer_store_dword v20,off,s[8:11],s73 sc1
s_mov_b32 s73,0x80000000
L_ak_340:
L_aq_356:
buffer_load_dword v17,v16,s[8:11],s87 offen sc1
s_sub_u32 s49,s49,1
s_cbranch_scc1 L_abort2
s_waitcnt vmcnt(0)
v_cmp_gt_u32 vcc,s66,v17
s_cbranch_vccnz L_aq_356
s_xor_b32 s34,s69,524288
buffer_load_dwordx4 v[160:163],v7,s[8:11],s34 offen sc1
s_add_u32 s34,s34,4096
buffer_load_dwordx4 v[164:167],v7,s[8:11],s34 offen sc1
s_add_u32 s34,s34,4096
buffer_load_dwordx4 v[168:171],v7,s[8:11],s34 offen sc1
s_add_u32 s34,s34,4096
buffer_load_dwordx4 v[172:175],v7,s[8:11],s34 offen sc1
s_add_u32 s34,s34,4096
buffer_load_dwordx4 v[176:179],v7,s[8:11],s34 offen sc1
s_add_u32 s34,s34,4096
buffer_load_dwordx4 v[180:183],v7,s[8:11],s34 offen sc1
s_add_u32 s34,s34,4096
buffer_load_dwordx4 v[184:187],v7,s[8:11],s34 offen sc1
s_add_u32 s34,s34,4096
buffer_load_dwordx4 v[188:191],v7,s[8:11],s34 offen sc1
s_waitcnt vmcnt(7)
v_mfma_f32_16x16x32_bf16 v[192:195],v[156:159],v[160:163],0
s_waitcnt vmcnt(6)
v_mfma_f32_16x16x32_bf16 v[192:195],v[156:159],v[164:167],v[192:195]
s_waitcnt vmcnt(5)
v_mfma_f32_16x16x32_bf16 v[192:195],v[156:159],v[168:171],v[192:195]
s_waitcnt vmcnt(4)
v_mfma_f32_16x16x32_bf16 v[192:195],v[156:159],v[172:175],v[192:195]
s_waitcnt vmcnt(3)
v_mfma_f32_16x16x32_bf16 v[196:199],v[156:159],v[176:179],0
s_waitcnt vmcnt(2)
v_mfma_f32_16x16x32_bf16 v[196:199],v[156:159],v[180:183],v[196:199]
s_waitcnt vmcnt(1)
v_mfma_f32_16x16x32_bf16 v[196:199],v[156:159],v[184:187],v[196:199]
ds_write_b128 v6,v[192:195]
s_waitcnt vmcnt(0)
v_mfma_f32_16x16x32_bf16 v[196:199],v[156:159],v[188:191],v[196:199]
s_nop 7
ds_write_b128 v6,v[196:199] offset:2048
s_waitcnt lgkmcnt(0)
s_barrier
buffer_store_dword v20,off,s[8:11],s73 sc1
s_mov_b32 s73,0x80000000
s_mov_b32 s27,2
L_aa_323:
s_cmp_lg_u32 s31,0
s_cbranch_scc1 L_ar_359
s_bitcmp1_b32 s46,0
s_cbranch_scc1 L_ar_358
L_ar_357:
ds_read_b128 v[160:163],v23
ds_read_b128 v[164:167],v23 offset:16
v_lshlrev_b32 v200,16,v224
v_and_b32 v201,0xffff0000,v224
v_lshlrev_b32 v202,16,v225
v_and_b32 v203,0xffff0000,v225
v_lshlrev_b32 v204,16,v226
v_and_b32 v205,0xffff0000,v226
v_lshlrev_b32 v206,16,v227
v_and_b32 v207,0xffff0000,v227
s_lshl_b32 s18,s51,5
s_add_u32 s18,s18,s68
s_lshl_b32 s19,s18,10
s_add_u32 s20,s19,8388608
s_waitcnt lgkmcnt(0)
v_cvt_pk_bf16_f32 v168,v160,v161
v_cvt_pk_bf16_f32 v169,v162,v163
v_cvt_pk_bf16_f32 v170,v164,v165
v_cvt_pk_bf16_f32 v171,v166,v167
v_lshlrev_b32 v160,16,v168
v_and_b32 v161,0xffff0000,v168
v_lshlrev_b32 v162,16,v169
v_and_b32 v163,0xffff0000,v169
v_lshlrev_b32 v164,16,v170
v_and_b32 v165,0xffff0000,v170
v_lshlrev_b32 v166,16,v171
v_and_b32 v167,0xffff0000,v171
v_pk_add_f32 v[200:201],v[200:201],v[160:161]
v_pk_add_f32 v[202:203],v[202:203],v[162:163]
v_pk_add_f32 v[204:205],v[204:205],v[164:165]
v_pk_add_f32 v[206:207],v[206:207],v[166:167]
v_cvt_pk_bf16_f32 v168,v200,v201
v_cvt_pk_bf16_f32 v169,v202,v203
v_cvt_pk_bf16_f32 v170,v204,v205
v_cvt_pk_bf16_f32 v171,v206,v207
v_lshlrev_b32 v200,16,v168
v_and_b32 v201,0xffff0000,v168
v_lshlrev_b32 v202,16,v169
v_and_b32 v203,0xffff0000,v169
v_lshlrev_b32 v204,16,v170
v_and_b32 v205,0xffff0000,v170
v_lshlrev_b32 v206,16,v171
v_and_b32 v207,0xffff0000,v171
v_readfirstlane_b32 s78,v200
s_nop 1
v_pk_add_f32 v[184:185],v[200:201],s[78:79] op_sel_hi:[1,0] neg_lo:[0,1] neg_hi:[0,1]
v_pk_add_f32 v[186:187],v[202:203],s[78:79] op_sel_hi:[1,0] neg_lo:[0,1] neg_hi:[0,1]
v_pk_add_f32 v[188:189],v[204:205],s[78:79] op_sel_hi:[1,0] neg_lo:[0,1] neg_hi:[0,1]
v_pk_add_f32 v[190:191],v[206:207],s[78:79] op_sel_hi:[1,0] neg_lo:[0,1] neg_hi:[0,1]
v_pk_add_f32 v[192:193],v[184:185],v[186:187]
v_pk_mul_f32 v[194:195],v[184:185],v[184:185]
v_pk_add_f32 v[196:197],v[188:189],v[190:191]
v_pk_fma_f32 v[194:195],v[186:187],v[186:187],v[194:195]
v_pk_add_f32 v[192:193],v[192:193],v[196:197]
v_pk_fma_f32 v[194:195],v[188:189],v[188:189],v[194:195]
v_add_f32 v192,v192,v193
v_pk_fma_f32 v[194:195],v[190:191],v[190:191],v[194:195]
v_add_f32 v194,v194,v195
s_nop 1
v_permlane32_swap_b32 v192,v194
v_add_f32 v192,v192,v194
s_nop 1
v_add_f32_dpp v192,v192,v192 row_ror:8 row_mask:0xf bank_mask:0xf
s_nop 1
v_add_f32_dpp v192,v192,v192 row_ror:4 row_mask:0xf bank_mask:0xf
s_nop 1
v_add_f32_dpp v192,v192,v192 row_ror:2 row_mask:0xf bank_mask:0xf
s_nop 1
v_add_f32_dpp v192,v192,v192 row_ror:1 row_mask:0xf bank_mask:0xf
v_mov_b32 v194,v192
s_nop 1
v_permlane16_swap_b32 v192,v194
v_add_f32 v192,v192,v194
v_mul_f32 v192,0x3b000000,v192
v_mov_b32 v194,v192
s_nop 1
v_permlane32_swap_b32 v192,v194
v_fma_f32 v194,-v192,v192,v194
v_add_f32 v192,s78,v192
v_max_f32 v194,0,v194
v_cvt_pk_bf16_f32 v194,v192,v194
v_lshlrev_b32 v192,16,v194
v_and_b32 v194,0xffff0000,v194
v_add_f32 v194,0x3727c5ac,v194
v_cvt_pk_bf16_f32 v194,v194,v194
v_and_b32 v194,0xffff0000,v194
v_sqrt_f32 v194,v194
v_pk_add_f32 v[184:185],v[200:201],v[192:193] op_sel_hi:[1,0] neg_lo:[0,1] neg_hi:[0,1]
v_pk_add_f32 v[186:187],v[202:203],v[192:193] op_sel_hi:[1,0] neg_lo:[0,1] neg_hi:[0,1]
v_pk_add_f32 v[188:189],v[204:205],v[192:193] op_sel_hi:[1,0] neg_lo:[0,1] neg_hi:[0,1]
v_pk_add_f32 v[190:191],v[206:207],v[192:193] op_sel_hi:[1,0] neg_lo:[0,1] neg_hi:[0,1]
v_cvt_pk_bf16_f32 v194,v194,v194
v_and_b32 v194,0xffff0000,v194
v_rcp_f32 v194,v194
v_cvt_pk_bf16_f32 v172,v184,v185
v_cvt_pk_bf16_f32 v173,v186,v187
v_cvt_pk_bf16_f32 v174,v188,v189
v_cvt_pk_bf16_f32 v175,v190,v191
v_lshlrev_b32 v184,16,v172
v_and_b32 v185,0xffff0000,v172
v_lshlrev_b32 v186,16,v173
v_and_b32 v187,0xffff0000,v173
v_lshlrev_b32 v188,16,v174
v_and_b32 v189,0xffff0000,v174
v_lshlrev_b32 v190,16,v175
v_and_b32 v191,0xffff0000,v175
v_pk_mul_f32 v[184:185],v[184:185],v[194:195] op_sel_hi:[1,0]
v_pk_mul_f32 v[186:187],v[186:187],v[194:195] op_sel_hi:[1,0]
v_pk_mul_f32 v[188:189],v[188:189],v[194:195] op_sel_hi:[1,0]
v_pk_mul_f32 v[190:191],v[190:191],v[194:195] op_sel_hi:[1,0]
v_cvt_pk_bf16_f32 v172,v184,v185
v_cvt_pk_bf16_f32 v173,v186,v187
v_cvt_pk_bf16_f32 v174,v188,v189
v_cvt_pk_bf16_f32 v175,v190,v191
v_lshlrev_b32 v176,16,v172
v_and_b32 v177,0xffff0000,v172
v_lshlrev_b32 v178,16,v173
v_and_b32 v179,0xffff0000,v173
v_lshlrev_b32 v180,16,v174
v_and_b32 v181,0xffff0000,v174
v_lshlrev_b32 v182,16,v175
v_and_b32 v183,0xffff0000,v175
v_pk_add_f32 v[200:201],v[200:201],v[176:177]
v_pk_add_f32 v[202:203],v[202:203],v[178:179]
v_pk_add_f32 v[204:205],v[204:205],v[180:181]
v_pk_add_f32 v[206:207],v[206:207],v[182:183]
v_cvt_pk_bf16_f32 v160,v200,v201
v_cvt_pk_bf16_f32 v161,v202,v203
v_cvt_pk_bf16_f32 v162,v204,v205
v_cvt_pk_bf16_f32 v163,v206,v207
buffer_store_dwordx4 v[160:163],v0,s[8:11],s20 offen sc1
v_lshlrev_b32 v200,16,v160
v_and_b32 v201,0xffff0000,v160
v_lshlrev_b32 v202,16,v161
v_and_b32 v203,0xffff0000,v161
v_lshlrev_b32 v204,16,v162
v_and_b32 v205,0xffff0000,v162
v_lshlrev_b32 v206,16,v163
v_and_b32 v207,0xffff0000,v163
v_readfirstlane_b32 s78,v200
s_nop 1
v_pk_add_f32 v[184:185],v[200:201],s[78:79] op_sel_hi:[1,0] neg_lo:[0,1] neg_hi:[0,1]
v_pk_add_f32 v[186:187],v[202:203],s[78:79] op_sel_hi:[1,0] neg_lo:[0,1] neg_hi:[0,1]
v_pk_add_f32 v[188:189],v[204:205],s[78:79] op_sel_hi:[1,0] neg_lo:[0,1] neg_hi:[0,1]
v_pk_add_f32 v[190:191],v[206:207],s[78:79] op_sel_hi:[1,0] neg_lo:[0,1] neg_hi:[0,1]
v_pk_add_f32 v[192:193],v[184:185],v[186:187]
v_pk_mul_f32 v[194:195],v[184:185],v[184:185]
v_pk_add_f32 v[196:197],v[188:189],v[190:191]
v_pk_fma_f32 v[194:195],v[186:187],v[186:187],v[194:195]
v_pk_add_f32 v[192:193],v[192:193],v[196:197]
v_pk_fma_f32 v[194:195],v[188:189],v[188:189],v[194:195]
v_add_f32 v192,v192,v193
v_pk_fma_f32 v[194:195],v[190:191],v[190:191],v[194:195]
v_add_f32 v194,v194,v195
s_nop 1
v_permlane32_swap_b32 v192,v194
v_add_f32 v192,v192,v194
s_nop 1
v_add_f32_dpp v192,v192,v192 row_ror:8 row_mask:0xf bank_mask:0xf
s_nop 1
v_add_f32_dpp v192,v192,v192 row_ror:4 row_mask:0xf bank_mask:0xf
s_nop 1
v_add_f32_dpp v192,v192,v192 row_ror:2 row_mask:0xf bank_mask:0xf
s_nop 1
v_add_f32_dpp v192,v192,v192 row_ror:1 row_mask:0xf bank_mask:0xf
v_mov_b32 v194,v192
s_nop 1
v_permlane16_swap_b32 v192,v194
v_add_f32 v192,v192,v194
v_mul_f32 v192,0x3b000000,v192
v_mov_b32 v194,v192
s_nop 1
v_permlane32_swap_b32 v192,v194
v_fma_f32 v194,-v192,v192,v194
v_add_f32 v192,s78,v192
v_max_f32 v194,0,v194
v_cvt_pk_bf16_f32 v194,v192,v194
v_lshlrev_b32 v192,16,v194
v_and_b32 v194,0xffff0000,v194
v_add_f32 v194,0x3727c5ac,v194
v_cvt_pk_bf16_f32 v194,v194,v194
v_and_b32 v194,0xffff0000,v194
v_sqrt_f32 v194,v194
v_pk_add_f32 v[184:185],v[200:201],v[192:193] op_sel_hi:[1,0] neg_lo:[0,1] neg_hi:[0,1]
v_pk_add_f32 v[186:187],v[202:203],v[192:193] op_sel_hi:[1,0] neg_lo:[0,1] neg_hi:[0,1]
v_pk_add_f32 v[188:189],v[204:205],v[192:193] op_sel_hi:[1,0] neg_lo:[0,1] neg_hi:[0,1]
v_pk_add_f32 v[190:191],v[206:207],v[192:193] op_sel_hi:[1,0] neg_lo:[0,1] neg_hi:[0,1]
v_cvt_pk_bf16_f32 v194,v194,v194
v_and_b32 v194,0xffff0000,v194
v_rcp_f32 v194,v194
v_cvt_pk_bf16_f32 v164,v184,v185
v_cvt_pk_bf16_f32 v165,v186,v187
v_cvt_pk_bf16_f32 v166,v188,v189
v_cvt_pk_bf16_f32 v167,v190,v191
v_lshlrev_b32 v184,16,v164
v_and_b32 v185,0xffff0000,v164
v_lshlrev_b32 v186,16,v165
v_and_b32 v187,0xffff0000,v165
v_lshlrev_b32 v188,16,v166
v_and_b32 v189,0xffff0000,v166
v_lshlrev_b32 v190,16,v167
v_and_b32 v191,0xffff0000,v167
v_pk_mul_f32 v[184:185],v[184:185],v[194:195] op_sel_hi:[1,0]
v_pk_mul_f32 v[186:187],v[186:187],v[194:195] op_sel_hi:[1,0]
v_pk_mul_f32 v[188:189],v[188:189],v[194:195] op_sel_hi:[1,0]
v_pk_mul_f32 v[190:191],v[190:191],v[194:195] op_sel_hi:[1,0]
v_cvt_pk_bf16_f32 v164,v184,v185
v_cvt_pk_bf16_f32 v165,v186,v187
v_cvt_pk_bf16_f32 v166,v188,v189
v_cvt_pk_bf16_f32 v167,v190,v191
s_add_u32 s20,s19,2097152
buffer_store_dwordx4 v[164:167],v0,s[8:11],s20 offen sc1
v_mov_b32 v20,1
s_lshl_b32 s73,s51,13
s_lshl2_add_u32 s73,s68,s73
s_add_u32 s73,s73,10487552
s_branch L_aa_324
L_ar_358:
ds_read_b128 v[160:163],v23
ds_read_b128 v[164:167],v23 offset:16
v_lshlrev_b32 v200,16,v224
v_and_b32 v201,0xffff0000,v224
v_lshlrev_b32 v202,16,v225
v_and_b32 v203,0xffff0000,v225
v_lshlrev_b32 v204,16,v226
v_and_b32 v205,0xffff0000,v226
v_lshlrev_b32 v206,16,v227
v_and_b32 v207,0xffff0000,v227
s_lshl_b32 s18,s51,5
s_add_u32 s18,s18,s68
s_lshl_b32 s19,s18,10
s_add_u32 s20,s19,4194304
s_waitcnt lgkmcnt(0)
v_cvt_pk_bf16_f32 v168,v160,v161
v_cvt_pk_bf16_f32 v169,v162,v163
v_cvt_pk_bf16_f32 v170,v164,v165
v_cvt_pk_bf16_f32 v171,v166,v167
v_lshlrev_b32 v160,16,v168
v_and_b32 v161,0xffff0000,v168
v_lshlrev_b32 v162,16,v169
v_and_b32 v163,0xffff0000,v169
v_lshlrev_b32 v164,16,v170
v_and_b32 v165,0xffff0000,v170
v_lshlrev_b32 v166,16,v171
v_and_b32 v167,0xffff0000,v171
v_pk_add_f32 v[200:201],v[200:201],v[160:161]
v_pk_add_f32 v[202:203],v[202:203],v[162:163]
v_pk_add_f32 v[204:205],v[204:205],v[164:165]
v_pk_add_f32 v[206:207],v[206:207],v[166:167]
v_cvt_pk_bf16_f32 v168,v200,v201
v_cvt_pk_bf16_f32 v169,v202,v203
v_cvt_pk_bf16_f32 v170,v204,v205
v_cvt_pk_bf16_f32 v171,v206,v207
buffer_store_dwordx4 v[168:171],v0,s[8:11],s20 offen sc1
v_lshlrev_b32 v200,16,v168
v_and_b32 v201,0xffff0000,v168
v_lshlrev_b32 v202,16,v169
v_and_b32 v203,0xffff0000,v169
v_lshlrev_b32 v204,16,v170
v_and_b32 v205,0xffff0000,v170
v_lshlrev_b32 v206,16,v171
v_and_b32 v207,0xffff0000,v171
v_readfirstlane_b32 s78,v200
s_nop 1
v_pk_add_f32 v[184:185],v[200:201],s[78:79] op_sel_hi:[1,0] neg_lo:[0,1] neg_hi:[0,1]
v_pk_add_f32 v[186:187],v[202:203],s[78:79] op_sel_hi:[1,0] neg_lo:[0,1] neg_hi:[0,1]
v_pk_add_f32 v[188:189],v[204:205],s[78:79] op_sel_hi:[1,0] neg_lo:[0,1] neg_hi:[0,1]
v_pk_add_f32 v[190:191],v[206:207],s[78:79] op_sel_hi:[1,0] neg_lo:[0,1] neg_hi:[0,1]
v_pk_add_f32 v[192:193],v[184:185],v[186:187]
v_pk_mul_f32 v[194:195],v[184:185],v[184:185]
v_pk_add_f32 v[196:197],v[188:189],v[190:191]
v_pk_fma_f32 v[194:195],v[186:187],v[186:187],v[194:195]
v_pk_add_f32 v[192:193],v[192:193],v[196:197]
v_pk_fma_f32 v[194:195],v[188:189],v[188:189],v[194:195]
v_add_f32 v192,v192,v193
v_pk_fma_f32 v[194:195],v[190:191],v[190:191],v[194:195]
v_add_f32 v194,v194,v195
s_nop 1
v_permlane32_swap_b32 v192,v194
v_add_f32 v192,v192,v194
s_nop 1
v_add_f32_dpp v192,v192,v192 row_ror:8 row_mask:0xf bank_mask:0xf
s_nop 1
v_add_f32_dpp v192,v192,v192 row_ror:4 row_mask:0xf bank_mask:0xf
s_nop 1
v_add_f32_dpp v192,v192,v192 row_ror:2 row_mask:0xf bank_mask:0xf
s_nop 1
v_add_f32_dpp v192,v192,v192 row_ror:1 row_mask:0xf bank_mask:0xf
v_mov_b32 v194,v192
s_nop 1
v_permlane16_swap_b32 v192,v194
v_add_f32 v192,v192,v194
v_mul_f32 v192,0x3b000000,v192
v_mov_b32 v194,v192
s_nop 1
v_permlane32_swap_b32 v192,v194
v_fma_f32 v194,-v192,v192,v194
v_add_f32 v192,s78,v192
v_max_f32 v194,0,v194
v_cvt_pk_bf16_f32 v194,v192,v194
v_lshlrev_b32 v192,16,v194
v_and_b32 v194,0xffff0000,v194
v_add_f32 v194,0x3727c5ac,v194
v_cvt_pk_bf16_f32 v194,v194,v194
v_and_b32 v194,0xffff0000,v194
v_sqrt_f32 v194,v194
v_pk_add_f32 v[184:185],v[200:201],v[192:193] op_sel_hi:[1,0] neg_lo:[0,1] neg_hi:[0,1]
v_pk_add_f32 v[186:187],v[202:203],v[192:193] op_sel_hi:[1,0] neg_lo:[0,1] neg_hi:[0,1]
v_pk_add_f32 v[188:189],v[204:205],v[192:193] op_sel_hi:[1,0] neg_lo:[0,1] neg_hi:[0,1]
v_pk_add_f32 v[190:191],v[206:207],v[192:193] op_sel_hi:[1,0] neg_lo:[0,1] neg_hi:[0,1]
v_cvt_pk_bf16_f32 v194,v194,v194
v_and_b32 v194,0xffff0000,v194
v_rcp_f32 v194,v194
v_cvt_pk_bf16_f32 v172,v184,v185
v_cvt_pk_bf16_f32 v173,v186,v187
v_cvt_pk_bf16_f32 v174,v188,v189
v_cvt_pk_bf16_f32 v175,v190,v191
v_lshlrev_b32 v184,16,v172
v_and_b32 v185,0xffff0000,v172
v_lshlrev_b32 v186,16,v173
v_and_b32 v187,0xffff0000,v173
v_lshlrev_b32 v188,16,v174
v_and_b32 v189,0xffff0000,v174
v_lshlrev_b32 v190,16,v175
v_and_b32 v191,0xffff0000,v175
v_pk_mul_f32 v[184:185],v[184:185],v[194:195] op_sel_hi:[1,0]
v_pk_mul_f32 v[186:187],v[186:187],v[194:195] op_sel_hi:[1,0]
v_pk_mul_f32 v[188:189],v[188:189],v[194:195] op_sel_hi:[1,0]
v_pk_mul_f32 v[190:191],v[190:191],v[194:195] op_sel_hi:[1,0]
v_cvt_pk_bf16_f32 v172,v184,v185
v_cvt_pk_bf16_f32 v173,v186,v187
v_cvt_pk_bf16_f32 v174,v188,v189
v_cvt_pk_bf16_f32 v175,v190,v191
v_lshlrev_b32 v176,16,v172
v_and_b32 v177,0xffff0000,v172
v_lshlrev_b32 v178,16,v173
v_and_b32 v179,0xffff0000,v173
v_lshlrev_b32 v180,16,v174
v_and_b32 v181,0xffff0000,v174
v_lshlrev_b32 v182,16,v175
v_and_b32 v183,0xffff0000,v175
v_pk_mul_f32 v[236:237],v[176:177],v[228:229]
v_pk_fma_f32 v[236:237],v[178:179],v[230:231],v[236:237]
v_pk_fma_f32 v[236:237],v[180:181],v[232:233],v[236:237]
v_pk_fma_f32 v[236:237],v[182:183],v[234:235],v[236:237]
v_add_f32 v236,v236,v237
s_nop 1
v_add_f32_dpp v236,v236,v236 row_ror:8 row_mask:0xf bank_mask:0xf
s_nop 1
v_add_f32_dpp v236,v236,v236 row_ror:4 row_mask:0xf bank_mask:0xf
s_nop 1
v_add_f32_dpp v236,v236,v236 row_ror:2 row_mask:0xf bank_mask:0xf
s_nop 1
v_add_f32_dpp v236,v236,v236 row_ror:1 row_mask:0xf bank_mask:0xf
v_mov_b32 v237,v236
s_nop 1
v_permlane16_swap_b32 v236,v237
v_add_f32 v236,v236,v237
v_mov_b32 v237,v236
s_nop 1
v_permlane32_swap_b32 v236,v237
v_add_f32 v236,v236,v237
v_cvt_pk_bf16_f32 v236,v236,v236
v_and_b32 v236,0xffff0000,v236
v_ashrrev_i32 v237,31,v236
v_or_b32 v237,0x80000000,v237
v_xor_b32 v236,v236,v237
v_and_b32 v236,0xffff0000,v236
s_sub_u32 s20,4095,s18
v_or_b32 v20,s20,v236
s_lshl_b32 s20,s51,13
s_lshl2_add_u32 s20,s68,s20
s_add_u32 s20,s20,10485760
buffer_store_dword v20,v254,s[8:11],s20 offen sc1
s_branch L_aa_324
L_ar_359:
s_bitcmp1_b32 s46,0
s_cbranch_scc1 L_aa_324
ds_read_b128 v[160:163],v23
ds_read_b128 v[164:167],v23 offset:16
v_lshlrev_b32 v200,16,v224
v_and_b32 v201,0xffff0000,v224
v_lshlrev_b32 v202,16,v225
v_and_b32 v203,0xffff0000,v225
v_lshlrev_b32 v204,16,v226
v_and_b32 v205,0xffff0000,v226
v_lshlrev_b32 v206,16,v227
v_and_b32 v207,0xffff0000,v227
v_readfirstlane_b32 s22,v246
s_cmp_eq_u32 s22,0
s_cbranch_scc1 L_ag_360
L_agb_361:
s_lshl_b32 s18,s51,5
s_add_u32 s18,s18,s68
s_lshl_b32 s19,s18,10
s_add_u32 s20,s19,6291456
s_waitcnt lgkmcnt(0)
v_cvt_pk_bf16_f32 v168,v160,v161
v_cvt_pk_bf16_f32 v169,v162,v163
v_cvt_pk_bf16_f32 v170,v164,v165
v_cvt_pk_bf16_f32 v171,v166,v167
v_lshlrev_b32 v160,16,v168
v_and_b32 v161,0xffff0000,v168
v_lshlrev_b32 v162,16,v169
v_and_b32 v163,0xffff0000,v169
v_lshlrev_b32 v164,16,v170
v_and_b32 v165,0xffff0000,v170
v_lshlrev_b32 v166,16,v171
v_and_b32 v167,0xffff0000,v171
v_pk_add_f32 v[200:201],v[200:201],v[160:161]
v_pk_add_f32 v[202:203],v[202:203],v[162:163]
v_pk_add_f32 v[204:205],v[204:205],v[164:165]
v_pk_add_f32 v[206:207],v[206:207],v[166:167]
v_cvt_pk_bf16_f32 v168,v200,v201
v_cvt_pk_bf16_f32 v169,v202,v203
v_cvt_pk_bf16_f32 v170,v204,v205
v_cvt_pk_bf16_f32 v171,v206,v207
buffer_store_dwordx4 v[168:171],v0,s[8:11],s20 offen sc1
v_lshlrev_b32 v200,16,v168
v_and_b32 v201,0xffff0000,v168
v_lshlrev_b32 v202,16,v169
v_and_b32 v203,0xffff0000,v169
v_lshlrev_b32 v204,16,v170
v_and_b32 v205,0xffff0000,v170
v_lshlrev_b32 v206,16,v171
v_and_b32 v207,0xffff0000,v171
v_readfirstlane_b32 s78,v200
s_nop 1
v_pk_add_f32 v[184:185],v[200:201],s[78:79] op_sel_hi:[1,0] neg_lo:[0,1] neg_hi:[0,1]
v_pk_add_f32 v[186:187],v[202:203],s[78:79] op_sel_hi:[1,0] neg_lo:[0,1] neg_hi:[0,1]
v_pk_add_f32 v[188:189],v[204:205],s[78:79] op_sel_hi:[1,0] neg_lo:[0,1] neg_hi:[0,1]
v_pk_add_f32 v[190:191],v[206:207],s[78:79] op_sel_hi:[1,0] neg_lo:[0,1] neg_hi:[0,1]
v_pk_add_f32 v[192:193],v[184:185],v[186:187]
v_pk_mul_f32 v[194:195],v[184:185],v[184:185]
v_pk_add_f32 v[196:197],v[188:189],v[190:191]
v_pk_fma_f32 v[194:195],v[186:187],v[186:187],v[194:195]
v_pk_add_f32 v[192:193],v[192:193],v[196:197]
v_pk_fma_f32 v[194:195],v[188:189],v[188:189],v[194:195]
v_add_f32 v192,v192,v193
v_pk_fma_f32 v[194:195],v[190:191],v[190:191],v[194:195]
v_add_f32 v194,v194,v195
s_nop 1
v_permlane32_swap_b32 v192,v194
v_add_f32 v192,v192,v194
s_nop 1
v_add_f32_dpp v192,v192,v192 row_ror:8 row_mask:0xf bank_mask:0xf
s_nop 1
v_add_f32_dpp v192,v192,v192 row_ror:4 row_mask:0xf bank_mask:0xf
s_nop 1
v_add_f32_dpp v192,v192,v192 row_ror:2 row_mask:0xf bank_mask:0xf
s_nop 1
v_add_f32_dpp v192,v192,v192 row_ror:1 row_mask:0xf bank_mask:0xf
v_mov_b32 v194,v192
s_nop 1
v_permlane16_swap_b32 v192,v194
v_add_f32 v192,v192,v194
v_mul_f32 v192,0x3b000000,v192
v_mov_b32 v194,v192
s_nop 1
v_permlane32_swap_b32 v192,v194
v_fma_f32 v194,-v192,v192,v194
v_add_f32 v192,s78,v192
v_max_f32 v194,0,v194
v_cvt_pk_bf16_f32 v194,v192,v194
v_lshlrev_b32 v192,16,v194
v_and_b32 v194,0xffff0000,v194
v_add_f32 v194,0x3727c5ac,v194
v_cvt_pk_bf16_f32 v194,v194,v194
v_and_b32 v194,0xffff0000,v194
v_sqrt_f32 v194,v194
v_pk_add_f32 v[184:185],v[200:201],v[192:193] op_sel_hi:[1,0] neg_lo:[0,1] neg_hi:[0,1]
v_pk_add_f32 v[186:187],v[202:203],v[192:193] op_sel_hi:[1,0] neg_lo:[0,1] neg_hi:[0,1]
v_pk_add_f32 v[188:189],v[204:205],v[192:193] op_sel_hi:[1,0] neg_lo:[0,1] neg_hi:[0,1]
v_pk_add_f32 v[190:191],v[206:207],v[192:193] op_sel_hi:[1,0] neg_lo:[0,1] neg_hi:[0,1]
v_cvt_pk_bf16_f32 v194,v194,v194
v_and_b32 v194,0xffff0000,v194
v_rcp_f32 v194,v194
v_cvt_pk_bf16_f32 v172,v184,v185
v_cvt_pk_bf16_f32 v173,v186,v187
v_cvt_pk_bf16_f32 v174,v188,v189
v_cvt_pk_bf16_f32 v175,v190,v191
v_lshlrev_b32 v184,16,v172
v_and_b32 v185,0xffff0000,v172
v_lshlrev_b32 v186,16,v173
v_and_b32 v187,0xffff0000,v173
v_lshlrev_b32 v188,16,v174
v_and_b32 v189,0xffff0000,v174
v_lshlrev_b32 v190,16,v175
v_and_b32 v191,0xffff0000,v175
v_pk_mul_f32 v[184:185],v[184:185],v[194:195] op_sel_hi:[1,0]
v_pk_mul_f32 v[186:187],v[186:187],v[194:195] op_sel_hi:[1,0]
v_pk_mul_f32 v[188:189],v[188:189],v[194:195] op_sel_hi:[1,0]
v_pk_mul_f32 v[190:191],v[190:191],v[194:195] op_sel_hi:[1,0]
v_cvt_pk_bf16_f32 v172,v184,v185
v_cvt_pk_bf16_f32 v173,v186,v187
v_cvt_pk_bf16_f32 v174,v188,v189
v_cvt_pk_bf16_f32 v175,v190,v191
v_lshlrev_b32 v176,16,v172
v_and_b32 v177,0xffff0000,v172
v_lshlrev_b32 v178,16,v173
v_and_b32 v179,0xffff0000,v173
v_lshlrev_b32 v180,16,v174
v_and_b32 v181,0xffff0000,v174
v_lshlrev_b32 v182,16,v175
v_and_b32 v183,0xffff0000,v175
v_pk_add_f32 v[200:201],v[200:201],v[176:177]
v_pk_add_f32 v[202:203],v[202:203],v[178:179]
v_pk_add_f32 v[204:205],v[204:205],v[180:181]
v_pk_add_f32 v[206:207],v[206:207],v[182:183]
v_cvt_pk_bf16_f32 v160,v200,v201
v_cvt_pk_bf16_f32 v161,v202,v203
v_cvt_pk_bf16_f32 v162,v204,v205
v_cvt_pk_bf16_f32 v163,v206,v207
buffer_store_dwordx4 v[160:163],v0,s[12:15],s19 offen sc1
v_pk_mul_f32 v[236:237],v[176:177],v[228:229]
v_pk_fma_f32 v[236:237],v[178:179],v[230:231],v[236:237]
v_pk_fma_f32 v[236:237],v[180:181],v[232:233],v[236:237]
v_pk_fma_f32 v[236:237],v[182:183],v[234:235],v[236:237]
v_add_f32 v236,v236,v237
s_nop 1
v_add_f32_dpp v236,v236,v236 row_ror:8 row_mask:0xf bank_mask:0xf
s_nop 1
v_add_f32_dpp v236,v236,v236 row_ror:4 row_mask:0xf bank_mask:0xf
s_nop 1
v_add_f32_dpp v236,v236,v236 row_ror:2 row_mask:0xf bank_mask:0xf
s_nop 1
v_add_f32_dpp v236,v236,v236 row_ror:1 row_mask:0xf bank_mask:0xf
v_mov_b32 v237,v236
s_nop 1
v_permlane16_swap_b32 v236,v237
v_add_f32 v236,v236,v237
v_mov_b32 v237,v236
s_nop 1
v_permlane32_swap_b32 v236,v237
v_add_f32 v236,v236,v237
v_cvt_pk_bf16_f32 v236,v236,v236
v_and_b32 v236,0xffff0000,v236
v_ashrrev_i32 v237,31,v236
v_or_b32 v237,0x80000000,v237
v_xor_b32 v236,v236,v237
v_and_b32 v236,0xffff0000,v236
s_sub_u32 s20,4095,s18
v_or_b32 v20,s20,v236
s_lshl_b32 s73,s51,13
s_lshl2_add_u32 s73,s68,s73
s_add_u32 s73,s73,10485760
s_add_u32 s73,s73,s86
L_aa_324:
s_cmp_eq_u32 s27,1
s_cbranch_scc1 L_ad_362
s_cmp_eq_u32 s27,0
s_cbranch_scc1 L_aa_325
s_cmp_eq_u32 s27,4
s_cbranch_scc1 L_a4_345
s_cmp_ge_u32 s77,64
s_cbranch_scc1 L_aa_328
L_aa_326:
s_waitcnt vmcnt(0)
buffer_store_dword v20,off,s[8:11],s73 sc1
s_mov_b32 s73,0x80000000
v_mov_b32 v18,0
s_mov_b32 s27,0
L_aw_363:
v_cmp_eq_u32 vcc,0,v18
s_cbranch_vccz L_awd_364
buffer_load_dword v18,v19,s[8:11],0 offen sc1
s_sub_u32 s49,s49,1
s_cbranch_scc1 L_abort2
s_waitcnt vmcnt(0)
s_branch L_aw_363
L_awd_364:
L_a3_365:
s_mov_b32 s64,s70
s_mov_b32 s65,s71
s_add_u32 s64,s64,s28
s_add_u32 s65,s65,s29
s_xor_b32 s58,s67,s40
s_xor_b32 s57,s67,s41
s_add_u32 m0,s58,0
s_nop 0
buffer_load_dwordx4 v0,s[8:11],s64 offen offset:0 sc1 lds
buffer_load_dwordx4 v0,s[8:11],s64 offen offset:1024 sc1 lds
buffer_load_dwordx4 v0,s[8:11],s64 offen offset:2048 sc1 lds
buffer_load_dwordx4 v0,s[8:11],s64 offen offset:3072 sc1 lds
s_add_u32 m0,s58,4096
s_add_u32 s64,s64,4096
buffer_load_dwordx4 v0,s[8:11],s64 offen offset:0 sc1 lds
buffer_load_dwordx4 v0,s[8:11],s64 offen offset:1024 sc1 lds
buffer_load_dwordx4 v0,s[8:11],s64 offen offset:2048 sc1 lds
buffer_load_dwordx4 v0,s[8:11],s64 offen offset:3072 sc1 lds
s_add_u32 m0,s58,8192
s_add_u32 s64,s64,4096
buffer_load_dwordx4 v0,s[8:11],s64 offen offset:0 sc1 lds
buffer_load_dwordx4 v0,s[8:11],s64 offen offset:1024 sc1 lds
buffer_load_dwordx4 v0,s[8:11],s64 offen offset:2048 sc1 lds
buffer_load_dwordx4 v0,s[8:11],s64 offen offset:3072 sc1 lds
s_add_u32 m0,s57,24576
s_nop 0
buffer_load_dwordx4 v0,s[8:11],s65 offen offset:0 sc1 lds
buffer_load_dwordx4 v0,s[8:11],s65 offen offset:1024 sc1 lds
v_lshrrev_b32 v244,4,v1
s_sub_u32 s56,s77,7
v_add_u32 v244,s56,v244
v_max_i32 v244,0,v244
v_lshl_add_u32 v244,v244,13,v21
buffer_load_dwordx2 v[242:243],v244,s[8:11],0 offen sc1
s_waitcnt vmcnt(0) lgkmcnt(0)
s_barrier
s_xor_b32 s67,s67,65536
s_and_b32 s56,s50,2048
s_lshl_b32 s56,s56,4
s_add_u32 s56,s56,s67
v_add_u32 v2,s56,v0
s_and_b32 s56,s50,1024
s_lshl_b32 s56,s56,2
v_add_u32 v238,s56,v2
s_mov_b32 s76,s71
s_mov_b32 s53,s77
ds_read_b128 v[24:27],v238 offset:16384
ds_read_b128 v[40:43],v2 offset:0
ds_read_b128 v[56:59],v2 offset:4096
ds_read_b128 v[28:31],v238 offset:17408
ds_read_b128 v[44:47],v2 offset:1024
ds_read_b128 v[60:63],v2 offset:5120
ds_read_b128 v[32:35],v238 offset:18432
ds_read_b128 v[48:51],v2 offset:2048
ds_read_b128 v[64:67],v2 offset:6144
ds_read_b128 v[36:39],v238 offset:19456
ds_read_b128 v[52:55],v2 offset:3072
ds_read_b128 v[68:71],v2 offset:7168
s_waitcnt lgkmcnt(9)
v_mfma_f32_16x16x32_bf16 v[128:131],v[40:43],v[24:27],v[8:11]
ds_read_b128 v[72:75],v2 offset:24576
v_mfma_f32_16x16x32_bf16 v[132:135],v[56:59],v[24:27],v[12:15]
ds_read_b128 v[76:79],v2 offset:25600
s_waitcnt lgkmcnt(8)
v_mfma_f32_16x16x32_bf16 v[128:131],v[44:47],v[28:31],v[128:131]
ds_read_b128 v[80:83],v2 offset:26624
v_mfma_f32_16x16x32_bf16 v[132:135],v[60:63],v[28:31],v[132:135]
ds_read_b128 v[84:87],v2 offset:27648
s_waitcnt lgkmcnt(7)
v_mfma_f32_16x16x32_bf16 v[128:131],v[48:51],v[32:35],v[128:131]
ds_read_b128 v[88:91],v2 offset:8192
v_mfma_f32_16x16x32_bf16 v[132:135],v[64:67],v[32:35],v[132:135]
ds_read_b128 v[92:95],v2 offset:9216
s_waitcnt lgkmcnt(6)
v_mfma_f32_16x16x32_bf16 v[128:131],v[52:55],v[36:39],v[128:131]
ds_read_b128 v[96:99],v2 offset:10240
v_mfma_f32_16x16x32_bf16 v[132:135],v[68:71],v[36:39],v[132:135]
ds_read_b128 v[100:103],v2 offset:11264
s_waitcnt lgkmcnt(4)
s_mov_b32 vcc_lo,0x33333333
s_mov_b32 vcc_hi,0x33333333
v_mfma_f32_16x16x32_bf16 v[136:139],v[72:75],v[24:27],0
ds_read_b128 v[104:107],v2 offset:12288
v_max3_u32 v238,v72,v73,v74
v_max3_u32 v238,v74,v75,v238
v_cndmask_b32_dpp v120,v72,v74,vcc quad_perm:[0,1,0,1] row_mask:0xf bank_mask:0xf
v_cndmask_b32_dpp v121,v73,v75,vcc quad_perm:[0,1,0,1] row_mask:0xf bank_mask:0xf
v_mfma_f32_16x16x32_bf16 v[136:139],v[76:79],v[28:31],v[136:139]
ds_read_b128 v[108:111],v2 offset:13312
v_max3_u32 v238,v76,v77,v238
v_max3_u32 v238,v78,v79,v238
v_cndmask_b32_dpp v122,v76,v78,vcc quad_perm:[0,1,0,1] row_mask:0xf bank_mask:0xf
v_cndmask_b32_dpp v123,v77,v79,vcc quad_perm:[0,1,0,1] row_mask:0xf bank_mask:0xf
v_mfma_f32_16x16x32_bf16 v[136:139],v[80:83],v[32:35],v[136:139]
ds_read_b128 v[112:115],v2 offset:14336
v_max3_u32 v238,v80,v81,v238
v_max3_u32 v238,v82,v83,v238
v_cndmask_b32_dpp v124,v80,v82,vcc quad_perm:[0,1,0,1] row_mask:0xf bank_mask:0xf
v_cndmask_b32_dpp v125,v81,v83,vcc quad_perm:[0,1,0,1] row_mask:0xf bank_mask:0xf
v_mfma_f32_16x16x32_bf16 v[136:139],v[84:87],v[36:39],v[136:139]
ds_read_b128 v[116:119],v2 offset:15360
v_max3_u32 v238,v84,v85,v238
v_max3_u32 v238,v86,v87,v238
v_cndmask_b32_dpp v126,v84,v86,vcc quad_perm:[0,1,0,1] row_mask:0xf bank_mask:0xf
v_cndmask_b32_dpp v127,v85,v87,vcc quad_perm:[0,1,0,1] row_mask:0xf bank_mask:0xf
v_cmp_eq_u32 vcc,-1,v238
s_waitcnt lgkmcnt(0)
s_cmp_eq_u32 s30,0
s_cbranch_scc1 L_aa_327
s_cmp_lg_u32 s86,1536
s_cbranch_scc1 L_ae_366
s_mov_b32 s77,s35
s_mov_b32 s30,0
s_lshl_b32 s56,s77,5
s_add_u32 s56,s56,s68
s_mul_i32 s70,s56,24576
s_lshl_b32 s71,s56,12
s_lshl_b32 s59,s77,13
s_lshl2_add_u32 s59,s68,s59
s_add_u32 s59,s59,10485760
s_buffer_load_dword s32,s[8:11],s59
s_mov_b32 s33,1
s_add_u32 s70,s70,100663296
s_add_u32 s71,s71,41943040
v_mov_b32 v19,s59
s_branch L_af_367
L_ae_366:
s_ff1_i32_b64 s77,s[84:85]
s_bitset0_b64 s[84:85],s77
s_min_u32 s77,s77,64
s_lshr_b32 s61,s55,5
s_lshl_b32 s56,s77,5
s_add_u32 s56,s56,s68
s_mul_i32 s70,s56,24576
s_lshl_b32 s71,s56,12
s_lshl_b32 s59,s77,13
s_lshl2_add_u32 s59,s68,s59
s_add_u32 s59,s59,10486144
s_cmp_lt_u32 s77,s61
s_cselect_b32 s57,0,16777216
s_mov_b32 s60,s59
s_buffer_load_dword s33,s[8:11],s60
s_add_u32 s71,s71,s57
s_add_u32 s71,s71,58720256
s_cmp_eq_u32 s77,s61
s_cselect_b32 s57,50331648,0
s_cselect_b32 s58,1536,0
s_add_u32 s59,s59,s58
s_buffer_load_dword s32,s[8:11],s59
s_add_u32 s70,s70,s57
s_add_u32 s70,s70,150994944
v_mov_b32 v19,s59
v_writelane_b32 v19,s60,1
L_af_367:
L_a4_345:
s_waitcnt vmcnt(0)
buffer_store_dword v20,off,s[8:11],s73 sc1
s_mov_b32 s73,0x80000000
v_max3_u32 v238,v72,v73,v74
v_max3_u32 v238,v74,v75,v238
v_max3_u32 v238,v76,v77,v238
v_max3_u32 v238,v78,v79,v238
v_max3_u32 v238,v80,v81,v238
v_max3_u32 v238,v82,v83,v238
v_max3_u32 v238,v84,v85,v238
v_max3_u32 v238,v86,v87,v238
v_cmp_eq_u32 vcc,-1,v238
s_cbranch_vccnz L_ac_368
L_acb_369:
v_max3_f32 v238,v128,v129,v130
v_max3_f32 v239,v131,v132,v133
v_max3_f32 v238,v134,v135,v238
v_max3_f32 v239,v138,v139,v239
v_max_f32 v238,v238,v239
v_max_f32 v239,v238,v239
v_pk_mul_f32 v[128:129],v[128:129],v[152:153] op_sel_hi:[1,0]
v_pk_mul_f32 v[130:131],v[130:131],v[152:153] op_sel_hi:[1,0]
v_permlane16_swap_b32 v238,v239
v_max_f32 v238,v238,v239
v_max_f32 v239,v238,v239
v_pk_mul_f32 v[132:133],v[132:133],v[152:153] op_sel_hi:[1,0]
v_pk_mul_f32 v[134:135],v[134:135],v[152:153] op_sel_hi:[1,0]
v_permlane32_swap_b32 v238,v239
v_max_f32 v238,v238,v239
v_mul_f32 v238,v152,v238
v_pk_mul_f32 v[138:139],v[138:139],v[152:153] op_sel_hi:[1,0]
v_pk_add_f32 v[128:129],v[128:129],v[238:239] op_sel_hi:[1,0] neg_lo:[0,1] neg_hi:[0,1]
v_pk_add_f32 v[130:131],v[130:131],v[238:239] op_sel_hi:[1,0] neg_lo:[0,1] neg_hi:[0,1]
v_pk_add_f32 v[132:133],v[132:133],v[238:239] op_sel_hi:[1,0] neg_lo:[0,1] neg_hi:[0,1]
v_pk_add_f32 v[134:135],v[134:135],v[238:239] op_sel_hi:[1,0] neg_lo:[0,1] neg_hi:[0,1]
v_pk_add_f32 v[138:139],v[138:139],v[238:239] op_sel_hi:[1,0] neg_lo:[0,1] neg_hi:[0,1]
v_exp_f32 v128,v128
v_exp_f32 v129,v129
v_exp_f32 v130,v130
v_exp_f32 v131,v131
v_exp_f32 v132,v132
v_exp_f32 v133,v133
v_exp_f32 v134,v134
v_exp_f32 v135,v135
v_exp_f32 v138,v138
v_exp_f32 v139,v139
v_pk_add_f32 v[148:149],v[128:129],v[130:131]
v_pk_add_f32 v[150:151],v[132:133],v[134:135]
v_pk_add_f32 v[148:149],v[148:149],v[138:139]
v_pk_add_f32 v[148:149],v[148:149],v[150:151]
v_add_f32 v150,v148,v149
v_add_f32 v151,v148,v149
s_nop 1
v_permlane16_swap_b32 v150,v151
v_add_f32 v148,v150,v151
v_add_f32 v149,v150,v151
s_nop 1
v_permlane32_swap_b32 v148,v149
v_add_f32 v148,v148,v149
v_rcp_f32 v148,v148
s_nop 0
v_pk_mul_f32 v[138:139],v[138:139],v[148:149] op_sel_hi:[1,0]
v_pk_mul_f32 v[128:129],v[128:129],v[148:149] op_sel_hi:[1,0]
v_pk_mul_f32 v[130:131],v[130:131],v[148:149] op_sel_hi:[1,0]
v_pk_mul_f32 v[132:133],v[132:133],v[148:149] op_sel_hi:[1,0]
v_pk_mul_f32 v[134:135],v[134:135],v[148:149] op_sel_hi:[1,0]
v_cvt_pk_bf16_f32 v144,v138,v139
v_cvt_pk_bf16_f32 v147,v138,v139
s_nop 0
v_mfma_f32_16x16x16_bf16 v[24:27],v[120:121],v[144:145],0
v_cvt_pk_bf16_f32 v140,v128,v129
v_mfma_f32_16x16x16_bf16 v[28:31],v[120:121],v[146:147],0
v_cvt_pk_bf16_f32 v141,v130,v131
v_mfma_f32_16x16x16_bf16 v[32:35],v[122:123],v[144:145],0
v_cvt_pk_bf16_f32 v142,v132,v133
v_mfma_f32_16x16x16_bf16 v[36:39],v[122:123],v[146:147],0
v_cvt_pk_bf16_f32 v143,v134,v135
v_mfma_f32_16x16x16_bf16 v[40:43],v[124:125],v[144:145],0
v_mfma_f32_16x16x16_bf16 v[44:47],v[124:125],v[146:147],0
v_mfma_f32_16x16x16_bf16 v[48:51],v[126:127],v[144:145],0
v_mfma_f32_16x16x16_bf16 v[52:55],v[126:127],v[146:147],0
v_mfma_f32_16x16x32_bf16 v[24:27],v[88:91],v[140:143],v[24:27]
v_mfma_f32_16x16x32_bf16 v[28:31],v[92:95],v[140:143],v[28:31]
v_mfma_f32_16x16x32_bf16 v[32:35],v[96:99],v[140:143],v[32:35]
v_mfma_f32_16x16x32_bf16 v[36:39],v[100:103],v[140:143],v[36:39]
v_cvt_pk_bf16_f32 v72,v24,v28
v_cvt_pk_bf16_f32 v73,v25,v29
v_mfma_f32_16x16x32_bf16 v[40:43],v[104:107],v[140:143],v[40:43]
v_cvt_pk_bf16_f32 v74,v26,v30
v_cvt_pk_bf16_f32 v75,v27,v31
v_mfma_f32_16x16x32_bf16 v[44:47],v[108:111],v[140:143],v[44:47]
ds_write_b128 v3,v[72:75] offset:0
v_cvt_pk_bf16_f32 v76,v32,v36
v_cvt_pk_bf16_f32 v77,v33,v37
v_mfma_f32_16x16x32_bf16 v[48:51],v[112:115],v[140:143],v[48:51]
v_cvt_pk_bf16_f32 v78,v34,v38
v_cvt_pk_bf16_f32 v79,v35,v39
v_mfma_f32_16x16x32_bf16 v[52:55],v[116:119],v[140:143],v[52:55]
ds_write_b128 v3,v[76:79] offset:1024
v_cvt_pk_bf16_f32 v80,v40,v44
v_cvt_pk_bf16_f32 v81,v41,v45
v_cvt_pk_bf16_f32 v82,v42,v46
v_cvt_pk_bf16_f32 v83,v43,v47
ds_write_b128 v3,v[80:83] offset:2048
s_nop 1
v_cvt_pk_bf16_f32 v84,v48,v52
v_cvt_pk_bf16_f32 v85,v49,v53
v_cvt_pk_bf16_f32 v86,v50,v54
v_cvt_pk_bf16_f32 v87,v51,v55
ds_write_b128 v3,v[84:87] offset:3072
s_waitcnt lgkmcnt(0)
s_barrier
L_ad_362:
s_mov_b32 s51,s53
s_mov_b32 s31,1
s_branch L_aa_319
L_aa_325:
s_waitcnt vmcnt(0)
buffer_store_dword v20,off,s[8:11],s73 sc1
s_mov_b32 s73,0x80000000
L_aa_327:
s_mov_b32 s51,s53
s_mov_b32 s31,0
s_add_u32 s35,s53,4
s_cmp_lt_u32 s53,4
s_cbranch_scc1 L_ab_370
s_cmp_ge_u32 s53,63
s_cbranch_scc1 L_am_372
L_aw_373:
v_min_u32 v239,v242,v243
v_cmp_eq_u32 vcc,0,v239
s_cbranch_vccz L_awd_374
s_sleep 4
buffer_load_dwordx2 v[242:243],v244,s[8:11],0 offen sc1
s_sub_u32 s49,s49,1
s_cbranch_scc1 L_abort2
s_waitcnt vmcnt(0)
s_branch L_aw_373
L_awd_374:
v_max_u32 v242,v242,v243
s_nop 1
v_max_u32_dpp v242,v242,v242 row_ror:8 row_mask:0xf bank_mask:0xf
s_nop 1
v_max_u32_dpp v242,v242,v242 row_ror:4 row_mask:0xf bank_mask:0xf
s_nop 1
v_max_u32_dpp v242,v242,v242 row_ror:2 row_mask:0xf bank_mask:0xf
s_nop 1
v_max_u32_dpp v242,v242,v242 row_ror:1 row_mask:0xf bank_mask:0xf
v_mov_b32 v243,v242
s_nop 1
v_permlane16_swap_b32 v242,v243
v_max_u32 v242,v242,v243
v_mov_b32 v243,v242
s_nop 1
v_permlane32_swap_b32 v242,v243
v_max_u32 v242,v242,v243
s_nop 0
v_readfirstlane_b32 s56,v242
v_readlane_b32 s57,v255,s53
s_max_u32 s75,s75,s56
s_bitcmp0_b64 s[42:43],s53
s_cbranch_scc1 L_ab_370
s_mov_b32 s77,s36
s_and_b32 s55,s75,0x7ff
s_sub_u32 s55,2047,s55
s_cmp_lt_u32 s75,s57
s_cselect_b32 s55,4095,s55
s_lshr_b32 s61,s55,5
s_mov_b32 s30,1
s_lshl_b32 s56,s77,5
s_add_u32 s56,s56,s68
s_mul_i32 s70,s56,24576
s_lshl_b32 s71,s56,12
s_lshl_b32 s59,s77,13
s_lshl2_add_u32 s59,s68,s59
s_add_u32 s59,s59,10486144
s_cmp_lt_u32 s77,s61
s_cselect_b32 s57,0,16777216
s_mov_b32 s60,s59
s_add_u32 s71,s71,s57
s_add_u32 s71,s71,58720256
s_cmp_eq_u32 s77,s61
s_cselect_b32 s57,50331648,0
s_cselect_b32 s58,1536,0
s_add_u32 s59,s59,s58
s_add_u32 s70,s70,s57
s_add_u32 s70,s70,150994944
v_mov_b32 v19,s59
v_writelane_b32 v19,s60,1
s_branch L_aj_371
L_ab_370:
s_mov_b32 s77,s35
s_mov_b32 s30,0
s_lshl_b32 s56,s77,5
s_add_u32 s56,s56,s68
s_mul_i32 s70,s56,24576
s_lshl_b32 s71,s56,12
s_lshl_b32 s59,s77,13
s_lshl2_add_u32 s59,s68,s59
s_add_u32 s59,s59,10485760
s_mov_b32 s33,1
s_add_u32 s70,s70,100663296
s_add_u32 s71,s71,41943040
v_mov_b32 v19,s59
L_aj_371:
buffer_load_dword v18,v19,s[8:11],0 offen sc1
s_waitcnt vmcnt(2)
s_mov_b32 vcc_lo,0x33333333
s_mov_b32 vcc_hi,0x33333333
v_mfma_f32_16x16x32_bf16 v[136:139],v[72:75],v[24:27],0
v_max3_u32 v238,v72,v73,v74
v_max3_u32 v238,v74,v75,v238
v_cndmask_b32_dpp v120,v72,v74,vcc quad_perm:[0,1,0,1] row_mask:0xf bank_mask:0xf
v_cndmask_b32_dpp v121,v73,v75,vcc quad_perm:[0,1,0,1] row_mask:0xf bank_mask:0xf
v_mfma_f32_16x16x32_bf16 v[136:139],v[76:79],v[28:31],v[136:139]
v_max3_u32 v238,v76,v77,v238
v_max3_u32 v238,v78,v79,v238
v_cndmask_b32_dpp v122,v76,v78,vcc quad_perm:[0,1,0,1] row_mask:0xf bank_mask:0xf
v_cndmask_b32_dpp v123,v77,v79,vcc quad_perm:[0,1,0,1] row_mask:0xf bank_mask:0xf
v_mfma_f32_16x16x32_bf16 v[136:139],v[80:83],v[32:35],v[136:139]
v_max3_u32 v238,v80,v81,v238
v_max3_u32 v238,v82,v83,v238
v_cndmask_b32_dpp v124,v80,v82,vcc quad_perm:[0,1,0,1] row_mask:0xf bank_mask:0xf
v_cndmask_b32_dpp v125,v81,v83,vcc quad_perm:[0,1,0,1] row_mask:0xf bank_mask:0xf
v_mfma_f32_16x16x32_bf16 v[136:139],v[84:87],v[36:39],v[136:139]
v_max3_u32 v238,v84,v85,v238
v_max3_u32 v238,v86,v87,v238
v_cndmask_b32_dpp v126,v84,v86,vcc quad_perm:[0,1,0,1] row_mask:0xf bank_mask:0xf
v_cndmask_b32_dpp v127,v85,v87,vcc quad_perm:[0,1,0,1] row_mask:0xf bank_mask:0xf
v_cmp_eq_u32 vcc,-1,v238
s_cbranch_vccz L_aa_330
L_aa_329:
buffer_load_dwordx4 v[72:75],v0,s[8:11],s76 offen offset:0 sc1
buffer_load_dwordx4 v[76:79],v0,s[8:11],s76 offen offset:1024 sc1
buffer_load_dwordx4 v[80:83],v0,s[8:11],s76 offen offset:2048 sc1
buffer_load_dwordx4 v[84:87],v0,s[8:11],s76 offen offset:3072 sc1
buffer_load_dword v18,v19,s[8:11],0 offen sc1
s_sub_u32 s49,s49,1
s_cbranch_scc1 L_abort2
s_mov_b32 vcc_lo,0x33333333
s_mov_b32 vcc_hi,0x33333333
s_waitcnt vmcnt(4)
v_mfma_f32_16x16x32_bf16 v[136:139],v[72:75],v[24:27],0
v_max3_u32 v238,v72,v73,v74
v_max3_u32 v238,v74,v75,v238
v_cndmask_b32_dpp v120,v72,v74,vcc quad_perm:[0,1,0,1] row_mask:0xf bank_mask:0xf
v_cndmask_b32_dpp v121,v73,v75,vcc quad_perm:[0,1,0,1] row_mask:0xf bank_mask:0xf
s_waitcnt vmcnt(3)
v_mfma_f32_16x16x32_bf16 v[136:139],v[76:79],v[28:31],v[136:139]
v_max3_u32 v238,v76,v77,v238
v_max3_u32 v238,v78,v79,v238
v_cndmask_b32_dpp v122,v76,v78,vcc quad_perm:[0,1,0,1] row_mask:0xf bank_mask:0xf
v_cndmask_b32_dpp v123,v77,v79,vcc quad_perm:[0,1,0,1] row_mask:0xf bank_mask:0xf
s_waitcnt vmcnt(2)
v_mfma_f32_16x16x32_bf16 v[136:139],v[80:83],v[32:35],v[136:139]
v_max3_u32 v238,v80,v81,v238
v_max3_u32 v238,v82,v83,v238
v_cndmask_b32_dpp v124,v80,v82,vcc quad_perm:[0,1,0,1] row_mask:0xf bank_mask:0xf
v_cndmask_b32_dpp v125,v81,v83,vcc quad_perm:[0,1,0,1] row_mask:0xf bank_mask:0xf
s_waitcnt vmcnt(1)
v_mfma_f32_16x16x32_bf16 v[136:139],v[84:87],v[36:39],v[136:139]
v_max3_u32 v238,v84,v85,v238
v_max3_u32 v238,v86,v87,v238
v_cndmask_b32_dpp v126,v84,v86,vcc quad_perm:[0,1,0,1] row_mask:0xf bank_mask:0xf
v_cndmask_b32_dpp v127,v85,v87,vcc quad_perm:[0,1,0,1] row_mask:0xf bank_mask:0xf
v_cmp_eq_u32 vcc,-1,v238
s_cbranch_vccnz L_aa_329
L_aa_330:
s_cmp_lg_u32 s27,3
s_cbranch_scc1 L_ai_375
v_max3_f32 v238,v128,v129,v130
v_max3_f32 v239,v131,v132,v133
v_max3_f32 v238,v134,v135,v238
v_max3_f32 v239,v138,v139,v239
v_max_f32 v238,v238,v239
v_max_f32 v239,v238,v239
v_pk_mul_f32 v[128:129],v[128:129],v[152:153] op_sel_hi:[1,0]
v_pk_mul_f32 v[130:131],v[130:131],v[152:153] op_sel_hi:[1,0]
v_permlane16_swap_b32 v238,v239
v_max_f32 v238,v238,v239
v_max_f32 v239,v238,v239
v_pk_mul_f32 v[132:133],v[132:133],v[152:153] op_sel_hi:[1,0]
v_pk_mul_f32 v[134:135],v[134:135],v[152:153] op_sel_hi:[1,0]
v_permlane32_swap_b32 v238,v239
v_max_f32 v238,v238,v239
v_mul_f32 v238,v152,v238
v_pk_mul_f32 v[138:139],v[138:139],v[152:153] op_sel_hi:[1,0]
buffer_load_dword v17,v16,s[8:11],s87 offen sc1
v_pk_add_f32 v[128:129],v[128:129],v[238:239] op_sel_hi:[1,0] neg_lo:[0,1] neg_hi:[0,1]
v_pk_add_f32 v[130:131],v[130:131],v[238:239] op_sel_hi:[1,0] neg_lo:[0,1] neg_hi:[0,1]
v_pk_add_f32 v[132:133],v[132:133],v[238:239] op_sel_hi:[1,0] neg_lo:[0,1] neg_hi:[0,1]
v_pk_add_f32 v[134:135],v[134:135],v[238:239] op_sel_hi:[1,0] neg_lo:[0,1] neg_hi:[0,1]
v_pk_add_f32 v[138:139],v[138:139],v[238:239] op_sel_hi:[1,0] neg_lo:[0,1] neg_hi:[0,1]
v_exp_f32 v128,v128
v_exp_f32 v129,v129
v_exp_f32 v130,v130
v_exp_f32 v131,v131
v_exp_f32 v132,v132
v_exp_f32 v133,v133
v_exp_f32 v134,v134
v_exp_f32 v135,v135
v_exp_f32 v138,v138
v_exp_f32 v139,v139
v_pk_add_f32 v[148:149],v[128:129],v[130:131]
v_pk_add_f32 v[150:151],v[132:133],v[134:135]
v_pk_add_f32 v[148:149],v[148:149],v[138:139]
v_pk_add_f32 v[148:149],v[148:149],v[150:151]
v_add_f32 v150,v148,v149
v_add_f32 v151,v148,v149
s_nop 1
v_permlane16_swap_b32 v150,v151
v_add_f32 v148,v150,v151
v_add_f32 v149,v150,v151
s_nop 1
v_permlane32_swap_b32 v148,v149
v_add_f32 v148,v148,v149
v_rcp_f32 v148,v148
s_waitcnt vmcnt(0)
v_cmp_gt_u32 vcc,s66,v17
v_pk_mul_f32 v[138:139],v[138:139],v[148:149] op_sel_hi:[1,0]
v_pk_mul_f32 v[128:129],v[128:129],v[148:149] op_sel_hi:[1,0]
v_pk_mul_f32 v[130:131],v[130:131],v[148:149] op_sel_hi:[1,0]
v_pk_mul_f32 v[132:133],v[132:133],v[148:149] op_sel_hi:[1,0]
v_pk_mul_f32 v[134:135],v[134:135],v[148:149] op_sel_hi:[1,0]
s_cbranch_vccnz L_ap_376
L_apb_377:
s_xor_b32 s34,s69,524288
buffer_load_dwordx4 v[192:195],v7,s[8:11],s34 offen sc1
v_cvt_pk_bf16_f32 v144,v138,v139
v_cvt_pk_bf16_f32 v147,v138,v139
s_nop 0
v_mfma_f32_16x16x16_bf16 v[24:27],v[120:121],v[144:145],0
s_add_u32 s34,s34,4096
v_cvt_pk_bf16_f32 v140,v128,v129
v_mfma_f32_16x16x16_bf16 v[28:31],v[120:121],v[146:147],0
buffer_load_dwordx4 v[196:199],v7,s[8:11],s34 offen sc1
v_cvt_pk_bf16_f32 v141,v130,v131
v_mfma_f32_16x16x16_bf16 v[32:35],v[122:123],v[144:145],0
s_add_u32 s34,s34,4096
v_cvt_pk_bf16_f32 v142,v132,v133
v_mfma_f32_16x16x16_bf16 v[36:39],v[122:123],v[146:147],0
buffer_load_dwordx4 v[200:203],v7,s[8:11],s34 offen sc1
v_cvt_pk_bf16_f32 v143,v134,v135
v_mfma_f32_16x16x16_bf16 v[40:43],v[124:125],v[144:145],0
s_add_u32 s34,s34,4096
v_mfma_f32_16x16x16_bf16 v[44:47],v[124:125],v[146:147],0
buffer_load_dwordx4 v[204:207],v7,s[8:11],s34 offen sc1
v_mfma_f32_16x16x16_bf16 v[48:51],v[126:127],v[144:145],0
s_add_u32 s34,s34,4096
v_mfma_f32_16x16x16_bf16 v[52:55],v[126:127],v[146:147],0
buffer_load_dwordx4 v[208:211],v7,s[8:11],s34 offen sc1
v_mfma_f32_16x16x32_bf16 v[24:27],v[88:91],v[140:143],v[24:27]
s_add_u32 s34,s34,4096
v_mfma_f32_16x16x32_bf16 v[28:31],v[92:95],v[140:143],v[28:31]
buffer_load_dwordx4 v[212:215],v7,s[8:11],s34 offen sc1
v_mfma_f32_16x16x32_bf16 v[32:35],v[96:99],v[140:143],v[32:35]
s_add_u32 s34,s34,4096
v_mfma_f32_16x16x32_bf16 v[36:39],v[100:103],v[140:143],v[36:39]
buffer_load_dwordx4 v[216:219],v7,s[8:11],s34 offen sc1
v_cvt_pk_bf16_f32 v72,v24,v28
v_cvt_pk_bf16_f32 v73,v25,v29
v_mfma_f32_16x16x32_bf16 v[40:43],v[104:107],v[140:143],v[40:43]
s_add_u32 s34,s34,4096
v_cvt_pk_bf16_f32 v74,v26,v30
v_cvt_pk_bf16_f32 v75,v27,v31
v_mfma_f32_16x16x32_bf16 v[44:47],v[108:111],v[140:143],v[44:47]
ds_write_b128 v3,v[72:75] offset:0
v_cvt_pk_bf16_f32 v76,v32,v36
v_cvt_pk_bf16_f32 v77,v33,v37
v_mfma_f32_16x16x32_bf16 v[48:51],v[112:115],v[140:143],v[48:51]
buffer_load_dwordx4 v[220:223],v7,s[8:11],s34 offen sc1
v_cvt_pk_bf16_f32 v78,v34,v38
v_cvt_pk_bf16_f32 v79,v35,v39
v_mfma_f32_16x16x32_bf16 v[52:55],v[116:119],v[140:143],v[52:55]
ds_write_b128 v3,v[76:79] offset:1024
v_cvt_pk_bf16_f32 v80,v40,v44
v_cvt_pk_bf16_f32 v81,v41,v45
v_cvt_pk_bf16_f32 v82,v42,v46
v_cvt_pk_bf16_f32 v83,v43,v47
ds_write_b128 v3,v[80:83] offset:2048
s_nop 1
v_cvt_pk_bf16_f32 v84,v48,v52
v_cvt_pk_bf16_f32 v85,v49,v53
v_cvt_pk_bf16_f32 v86,v50,v54
v_cvt_pk_bf16_f32 v87,v51,v55
ds_write_b128 v3,v[84:87] offset:3072
v_readlane_b32 s32,v18,0
v_readlane_b32 s33,v18,1
s_waitcnt lgkmcnt(0)
s_barrier
s_branch L_aa_332
L_ai_375:
v_max3_f32 v238,v128,v129,v130
v_max3_f32 v239,v131,v132,v133
v_max3_f32 v238,v134,v135,v238
v_max3_f32 v239,v138,v139,v239
v_max_f32 v238,v238,v239
v_max_f32 v239,v238,v239
v_pk_mul_f32 v[128:129],v[128:129],v[152:153] op_sel_hi:[1,0]
v_pk_mul_f32 v[130:131],v[130:131],v[152:153] op_sel_hi:[1,0]
v_permlane16_swap_b32 v238,v239
v_max_f32 v238,v238,v239
v_max_f32 v239,v238,v239
v_pk_mul_f32 v[132:133],v[132:133],v[152:153] op_sel_hi:[1,0]
v_pk_mul_f32 v[134:135],v[134:135],v[152:153] op_sel_hi:[1,0]
v_permlane32_swap_b32 v238,v239
v_max_f32 v238,v238,v239
v_mul_f32 v238,v152,v238
v_pk_mul_f32 v[138:139],v[138:139],v[152:153] op_sel_hi:[1,0]
v_pk_add_f32 v[128:129],v[128:129],v[238:239] op_sel_hi:[1,0] neg_lo:[0,1] neg_hi:[0,1]
v_pk_add_f32 v[130:131],v[130:131],v[238:239] op_sel_hi:[1,0] neg_lo:[0,1] neg_hi:[0,1]
v_pk_add_f32 v[132:133],v[132:133],v[238:239] op_sel_hi:[1,0] neg_lo:[0,1] neg_hi:[0,1]
v_pk_add_f32 v[134:135],v[134:135],v[238:239] op_sel_hi:[1,0] neg_lo:[0,1] neg_hi:[0,1]
v_pk_add_f32 v[138:139],v[138:139],v[238:239] op_sel_hi:[1,0] neg_lo:[0,1] neg_hi:[0,1]
v_exp_f32 v128,v128
v_exp_f32 v129,v129
v_exp_f32 v130,v130
v_exp_f32 v131,v131
v_exp_f32 v132,v132
v_exp_f32 v133,v133
v_exp_f32 v134,v134
v_exp_f32 v135,v135
v_exp_f32 v138,v138
v_exp_f32 v139,v139
v_pk_add_f32 v[148:149],v[128:129],v[130:131]
v_pk_add_f32 v[150:151],v[132:133],v[134:135]
v_pk_add_f32 v[148:149],v[148:149],v[138:139]
v_pk_add_f32 v[148:149],v[148:149],v[150:151]
v_add_f32 v150,v148,v149
v_add_f32 v151,v148,v149
s_nop 1
v_permlane16_swap_b32 v150,v151
v_add_f32 v148,v150,v151
v_add_f32 v149,v150,v151
s_nop 1
v_permlane32_swap_b32 v148,v149
v_add_f32 v148,v148,v149
v_rcp_f32 v148,v148
s_nop 0
v_pk_mul_f32 v[138:139],v[138:139],v[148:149] op_sel_hi:[1,0]
v_pk_mul_f32 v[128:129],v[128:129],v[148:149] op_sel_hi:[1,0]
v_pk_mul_f32 v[130:131],v[130:131],v[148:149] op_sel_hi:[1,0]
v_pk_mul_f32 v[132:133],v[132:133],v[148:149] op_sel_hi:[1,0]
v_pk_mul_f32 v[134:135],v[134:135],v[148:149] op_sel_hi:[1,0]
v_cvt_pk_bf16_f32 v144,v138,v139
v_cvt_pk_bf16_f32 v147,v138,v139
s_nop 0
v_mfma_f32_16x16x16_bf16 v[24:27],v[120:121],v[144:145],0
v_cvt_pk_bf16_f32 v140,v128,v129
v_mfma_f32_16x16x16_bf16 v[28:31],v[120:121],v[146:147],0
v_cvt_pk_bf16_f32 v141,v130,v131
v_mfma_f32_16x16x16_bf16 v[32:35],v[122:123],v[144:145],0
v_cvt_pk_bf16_f32 v142,v132,v133
v_mfma_f32_16x16x16_bf16 v[36:39],v[122:123],v[146:147],0
v_cvt_pk_bf16_f32 v143,v134,v135
v_mfma_f32_16x16x16_bf16 v[40:43],v[124:125],v[144:145],0
v_mfma_f32_16x16x16_bf16 v[44:47],v[124:125],v[146:147],0
v_mfma_f32_16x16x16_bf16 v[48:51],v[126:127],v[144:145],0
v_mfma_f32_16x16x16_bf16 v[52:55],v[126:127],v[146:147],0
v_mfma_f32_16x16x32_bf16 v[24:27],v[88:91],v[140:143],v[24:27]
v_mfma_f32_16x16x32_bf16 v[28:31],v[92:95],v[140:143],v[28:31]
v_mfma_f32_16x16x32_bf16 v[32:35],v[96:99],v[140:143],v[32:35]
v_mfma_f32_16x16x32_bf16 v[36:39],v[100:103],v[140:143],v[36:39]
v_cvt_pk_bf16_f32 v72,v24,v28
v_cvt_pk_bf16_f32 v73,v25,v29
v_mfma_f32_16x16x32_bf16 v[40:43],v[104:107],v[140:143],v[40:43]
v_cvt_pk_bf16_f32 v74,v26,v30
v_cvt_pk_bf16_f32 v75,v27,v31
v_mfma_f32_16x16x32_bf16 v[44:47],v[108:111],v[140:143],v[44:47]
ds_write_b128 v3,v[72:75] offset:0
v_cvt_pk_bf16_f32 v76,v32,v36
v_cvt_pk_bf16_f32 v77,v33,v37
v_mfma_f32_16x16x32_bf16 v[48:51],v[112:115],v[140:143],v[48:51]
v_cvt_pk_bf16_f32 v78,v34,v38
v_cvt_pk_bf16_f32 v79,v35,v39
v_mfma_f32_16x16x32_bf16 v[52:55],v[116:119],v[140:143],v[52:55]
ds_write_b128 v3,v[76:79] offset:1024
v_cvt_pk_bf16_f32 v80,v40,v44
v_cvt_pk_bf16_f32 v81,v41,v45
v_cvt_pk_bf16_f32 v82,v42,v46
v_cvt_pk_bf16_f32 v83,v43,v47
ds_write_b128 v3,v[80:83] offset:2048
s_nop 1
v_cvt_pk_bf16_f32 v84,v48,v52
v_cvt_pk_bf16_f32 v85,v49,v53
v_cvt_pk_bf16_f32 v86,v50,v54
v_cvt_pk_bf16_f32 v87,v51,v55
ds_write_b128 v3,v[84:87] offset:3072
s_waitcnt vmcnt(0)
v_readlane_b32 s32,v18,0
v_readlane_b32 s33,v18,1
s_waitcnt lgkmcnt(0)
s_barrier
s_branch L_aa_319
L_aa_328:
s_cmp_lg_u32 s86,1536
s_cbranch_scc1 L_az_378
s_cmp_ge_u32 s35,67
s_cbranch_scc1 L_aa_318
v_subrev_u32 v248,s36,v1
v_and_b32 v248,0x80000003,v248
v_cmp_eq_u32 vcc,0,v248
v_lshlrev_b32 v248,2,v1
v_mov_b32 v249,0x40000000
v_cndmask_b32 v248,v249,v248,vcc
v_mov_b32 v249,3
s_or_b32 s59,s68,s46
s_mov_b32 s59,11018240
s_cmov_b32 s59,0x80000000
buffer_store_dword v249,v248,s[8:11],s59 offen sc1
L_aa_318:
s_waitcnt vmcnt(0)
buffer_store_dword v20,off,s[8:11],s73 sc1
s_mov_b32 s73,0x80000000
v_lshlrev_b32 v238,2,v1
v_add_u32 v248,155712,v238
s_cmp_lg_u32 s46,0
s_cbranch_scc1 L_an_379
s_lshl_b32 s59,s54,13
s_add_u32 s59,s59,11026432
L_fp_380:
s_sleep 1
buffer_load_dword v239,v238,s[8:11],s59 offen sc1
s_sub_u32 s49,s49,1
s_cbranch_scc1 L_abort2
s_waitcnt vmcnt(0)
v_cmp_eq_u32 vcc,0,v239
s_cbranch_vccnz L_fp_380
ds_write_b32 v248,v239
s_waitcnt lgkmcnt(0)
L_an_379:
s_barrier
ds_read_b32 v239,v248
s_mov_b32 s86,768
s_mov_b32 s30,1
s_waitcnt lgkmcnt(0)
v_readfirstlane_b32 s55,v239
v_and_b32 v239,255,v239
s_lshr_b32 s55,s55,8
s_lshr_b32 s61,s55,5
v_cmp_ne_u32 s[38:39],3,v239
v_cmp_le_u32 vcc,s61,v1
s_nop 1
v_cndmask_b32 v238,1,2,vcc
v_cmp_ne_u32 s[84:85],v238,v239
s_bcnt1_i32_b64 s56,s[84:85]
s_nop 0
v_mbcnt_lo_u32_b32 v238,s84,0
v_mbcnt_hi_u32_b32 v238,s85,v238
s_mul_i32 s56,s56,15
s_add_u32 s56,s56,130
s_lshr_b32 s56,s56,7
s_lshl_b32 s56,s56,1
v_cmp_gt_u32 vcc,s56,v238
v_and_b32 v239,1,v238
v_and_b32 v238,3,v238
v_add_u32 v238,2,v238
v_cndmask_b32 v238,v238,v239,vcc
v_cmp_eq_u32 vcc,s54,v238
s_and_b64 s[84:85],s[84:85],vcc
s_ff1_i32_b64 s77,s[84:85]
s_bitset0_b64 s[84:85],s77
s_min_u32 s77,s77,64
s_lshl_b32 s56,s77,5
s_add_u32 s56,s56,s68
s_mul_i32 s70,s56,24576
s_lshl_b32 s71,s56,12
s_lshl_b32 s59,s77,13
s_lshl2_add_u32 s59,s68,s59
s_add_u32 s59,s59,10486144
s_cmp_lt_u32 s77,s61
s_cselect_b32 s57,0,16777216
s_mov_b32 s60,s59
s_buffer_load_dword s33,s[8:11],s60
s_add_u32 s71,s71,s57
s_add_u32 s71,s71,58720256
s_cmp_eq_u32 s77,s61
s_cselect_b32 s57,50331648,0
s_cselect_b32 s58,1536,0
s_add_u32 s59,s59,s58
s_buffer_load_dword s32,s[8:11],s59
s_add_u32 s70,s70,s57
s_add_u32 s70,s70,150994944
v_mov_b32 v19,s59
v_writelane_b32 v19,s60,1
s_cmp_ge_u32 s77,64
s_cbranch_scc1 L_az_378
s_cmp_eq_u32 s77,s61
s_cbranch_scc1 L_aa_326
s_mov_b32 s27,0
s_bitcmp1_b64 s[38:39],s77
s_cbranch_scc1 L_a3_365
s_branch L_aa_326
L_az_378:
s_waitcnt vmcnt(0)
buffer_store_dword v20,off,s[8:11],s73 sc1
s_mov_b32 s73,0x80000000
s_endpgm
L_ag_334:
s_lshl_b32 s21,s26,13
s_lshl2_add_u32 s21,s68,s21
s_add_u32 s21,s21,10487296
L_ww_381:
buffer_load_dword v246,off,s[8:11],s21 sc1
s_sub_u32 s49,s49,1
s_cbranch_scc1 L_abort2
s_waitcnt vmcnt(0)
v_readfirstlane_b32 s22,v246
s_cmp_eq_u32 s22,0
s_cbranch_scc1 L_ww_381
L_wwd_382:
s_branch L_agb_335
L_a4_343:
v_mov_b32 v248,s27
ds_write_b32 v247,v248 offset:16
s_waitcnt lgkmcnt(0)
s_barrier
ds_read_b128 v[248:251],v245 offset:16
s_waitcnt lgkmcnt(0)
v_or3_b32 v248,v248,v249,v250
v_or_b32 v248,v248,v251
v_cmp_ne_u32 vcc,0,v248
s_cbranch_vccz L_a4_344
L_aq_383:
buffer_load_dword v17,v16,s[8:11],s87 offen sc1
s_sub_u32 s49,s49,1
s_cbranch_scc1 L_abort2
s_waitcnt vmcnt(0)
v_cmp_gt_u32 vcc,s66,v17
s_cbranch_vccnz L_aq_383
s_xor_b32 s34,s69,524288
buffer_load_dwordx4 v[160:163],v7,s[8:11],s34 offen sc1
s_add_u32 s34,s34,4096
buffer_load_dwordx4 v[164:167],v7,s[8:11],s34 offen sc1
s_add_u32 s34,s34,4096
buffer_load_dwordx4 v[168:171],v7,s[8:11],s34 offen sc1
s_add_u32 s34,s34,4096
buffer_load_dwordx4 v[172:175],v7,s[8:11],s34 offen sc1
s_add_u32 s34,s34,4096
buffer_load_dwordx4 v[176:179],v7,s[8:11],s34 offen sc1
s_add_u32 s34,s34,4096
buffer_load_dwordx4 v[180:183],v7,s[8:11],s34 offen sc1
s_add_u32 s34,s34,4096
buffer_load_dwordx4 v[184:187],v7,s[8:11],s34 offen sc1
s_add_u32 s34,s34,4096
buffer_load_dwordx4 v[188:191],v7,s[8:11],s34 offen sc1
s_waitcnt vmcnt(7)
v_mfma_f32_16x16x32_bf16 v[192:195],v[156:159],v[160:163],0
s_waitcnt vmcnt(6)
v_mfma_f32_16x16x32_bf16 v[192:195],v[156:159],v[164:167],v[192:195]
s_waitcnt vmcnt(5)
v_mfma_f32_16x16x32_bf16 v[192:195],v[156:159],v[168:171],v[192:195]
s_waitcnt vmcnt(4)
v_mfma_f32_16x16x32_bf16 v[192:195],v[156:159],v[172:175],v[192:195]
s_waitcnt vmcnt(3)
v_mfma_f32_16x16x32_bf16 v[196:199],v[156:159],v[176:179],0
s_waitcnt vmcnt(2)
v_mfma_f32_16x16x32_bf16 v[196:199],v[156:159],v[180:183],v[196:199]
s_waitcnt vmcnt(1)
v_mfma_f32_16x16x32_bf16 v[196:199],v[156:159],v[184:187],v[196:199]
ds_write_b128 v6,v[192:195]
s_waitcnt vmcnt(0)
v_mfma_f32_16x16x32_bf16 v[196:199],v[156:159],v[188:191],v[196:199]
s_nop 7
ds_write_b128 v6,v[196:199] offset:2048
s_waitcnt lgkmcnt(0)
s_barrier
buffer_store_dword v20,off,s[8:11],s73 sc1
s_mov_b32 s73,0x80000000
s_mov_b32 s27,4
s_branch L_aa_323
L_ac_346:
buffer_store_dword v20,off,s[8:11],s73 sc1
s_mov_b32 s73,0x80000000
buffer_load_dwordx4 v[72:75],v0,s[8:11],s76 offen offset:0 sc1
buffer_load_dwordx4 v[76:79],v0,s[8:11],s76 offen offset:1024 sc1
buffer_load_dwordx4 v[80:83],v0,s[8:11],s76 offen offset:2048 sc1
buffer_load_dwordx4 v[84:87],v0,s[8:11],s76 offen offset:3072 sc1
s_sub_u32 s49,s49,1
s_cbranch_scc1 L_abort2
s_mov_b32 vcc_lo,0x33333333
s_mov_b32 vcc_hi,0x33333333
s_waitcnt vmcnt(3)
v_mfma_f32_16x16x32_bf16 v[136:139],v[72:75],v[24:27],0
v_max3_u32 v238,v72,v73,v74
v_max3_u32 v238,v74,v75,v238
v_cndmask_b32_dpp v120,v72,v74,vcc quad_perm:[0,1,0,1] row_mask:0xf bank_mask:0xf
v_cndmask_b32_dpp v121,v73,v75,vcc quad_perm:[0,1,0,1] row_mask:0xf bank_mask:0xf
s_waitcnt vmcnt(2)
v_mfma_f32_16x16x32_bf16 v[136:139],v[76:79],v[28:31],v[136:139]
v_max3_u32 v238,v76,v77,v238
v_max3_u32 v238,v78,v79,v238
v_cndmask_b32_dpp v122,v76,v78,vcc quad_perm:[0,1,0,1] row_mask:0xf bank_mask:0xf
v_cndmask_b32_dpp v123,v77,v79,vcc quad_perm:[0,1,0,1] row_mask:0xf bank_mask:0xf
s_waitcnt vmcnt(1)
v_mfma_f32_16x16x32_bf16 v[136:139],v[80:83],v[32:35],v[136:139]
v_max3_u32 v238,v80,v81,v238
v_max3_u32 v238,v82,v83,v238
v_cndmask_b32_dpp v124,v80,v82,vcc quad_perm:[0,1,0,1] row_mask:0xf bank_mask:0xf
v_cndmask_b32_dpp v125,v81,v83,vcc quad_perm:[0,1,0,1] row_mask:0xf bank_mask:0xf
s_waitcnt vmcnt(0)
v_mfma_f32_16x16x32_bf16 v[136:139],v[84:87],v[36:39],v[136:139]
v_max3_u32 v238,v84,v85,v238
v_max3_u32 v238,v86,v87,v238
v_cndmask_b32_dpp v126,v84,v86,vcc quad_perm:[0,1,0,1] row_mask:0xf bank_mask:0xf
v_cndmask_b32_dpp v127,v85,v87,vcc quad_perm:[0,1,0,1] row_mask:0xf bank_mask:0xf
v_cmp_eq_u32 vcc,-1,v238
s_cbranch_vccnz L_ac_346
s_branch L_acb_347
L_ap_349:
L_aw_384:
v_cmp_gt_u32 vcc,s66,v17
s_cbranch_vccz L_awd_385
buffer_load_dword v17,v16,s[8:11],s87 offen sc1
s_sub_u32 s49,s49,1
s_cbranch_scc1 L_abort2
s_waitcnt vmcnt(0)
s_branch L_aw_384
L_awd_385:
s_branch L_apb_350
L_a1_351:
v_subrev_u32 v248,s36,v1
v_and_b32 v248,0x80000003,v248
v_cmp_eq_u32 vcc,0,v248
v_lshlrev_b32 v248,2,v1
v_mov_b32 v249,0x40000000
v_cndmask_b32 v248,v249,v248,vcc
v_mov_b32 v249,3
s_or_b32 s59,s68,s46
s_mov_b32 s59,11018240
s_cmov_b32 s59,0x80000000
buffer_store_dword v249,v248,s[8:11],s59 offen sc1
s_branch L_a2_352
L_ag_360:
s_lshl_b32 s21,s51,13
s_lshl2_add_u32 s21,s68,s21
s_add_u32 s21,s21,10487296
L_ww_386:
buffer_load_dword v246,off,s[8:11],s21 sc1
s_sub_u32 s49,s49,1
s_cbranch_scc1 L_abort2
s_waitcnt vmcnt(0)
v_readfirstlane_b32 s22,v246
s_cmp_eq_u32 s22,0
s_cbranch_scc1 L_ww_386
L_wwd_387:
s_branch L_agb_361
L_ac_368:
buffer_store_dword v20,off,s[8:11],s73 sc1
s_mov_b32 s73,0x80000000
buffer_load_dwordx4 v[72:75],v0,s[8:11],s76 offen offset:0 sc1
buffer_load_dwordx4 v[76:79],v0,s[8:11],s76 offen offset:1024 sc1
buffer_load_dwordx4 v[80:83],v0,s[8:11],s76 offen offset:2048 sc1
buffer_load_dwordx4 v[84:87],v0,s[8:11],s76 offen offset:3072 sc1
s_sub_u32 s49,s49,1
s_cbranch_scc1 L_abort2
s_mov_b32 vcc_lo,0x33333333
s_mov_b32 vcc_hi,0x33333333
s_waitcnt vmcnt(3)
v_mfma_f32_16x16x32_bf16 v[136:139],v[72:75],v[24:27],0
v_max3_u32 v238,v72,v73,v74
v_max3_u32 v238,v74,v75,v238
v_cndmask_b32_dpp v120,v72,v74,vcc quad_perm:[0,1,0,1] row_mask:0xf bank_mask:0xf
v_cndmask_b32_dpp v121,v73,v75,vcc quad_perm:[0,1,0,1] row_mask:0xf bank_mask:0xf
s_waitcnt vmcnt(2)
v_mfma_f32_16x16x32_bf16 v[136:139],v[76:79],v[28:31],v[136:139]
v_max3_u32 v238,v76,v77,v238
v_max3_u32 v238,v78,v79,v238
v_cndmask_b32_dpp v122,v76,v78,vcc quad_perm:[0,1,0,1] row_mask:0xf bank_mask:0xf
v_cndmask_b32_dpp v123,v77,v79,vcc quad_perm:[0,1,0,1] row_mask:0xf bank_mask:0xf
s_waitcnt vmcnt(1)
v_mfma_f32_16x16x32_bf16 v[136:139],v[80:83],v[32:35],v[136:139]
v_max3_u32 v238,v80,v81,v238
v_max3_u32 v238,v82,v83,v238
v_cndmask_b32_dpp v124,v80,v82,vcc quad_perm:[0,1,0,1] row_mask:0xf bank_mask:0xf
v_cndmask_b32_dpp v125,v81,v83,vcc quad_perm:[0,1,0,1] row_mask:0xf bank_mask:0xf
s_waitcnt vmcnt(0)
v_mfma_f32_16x16x32_bf16 v[136:139],v[84:87],v[36:39],v[136:139]
v_max3_u32 v238,v84,v85,v238
v_max3_u32 v238,v86,v87,v238
v_cndmask_b32_dpp v126,v84,v86,vcc quad_perm:[0,1,0,1] row_mask:0xf bank_mask:0xf
v_cndmask_b32_dpp v127,v85,v87,vcc quad_perm:[0,1,0,1] row_mask:0xf bank_mask:0xf
v_cmp_eq_u32 vcc,-1,v238
s_cbranch_vccnz L_ac_368
s_branch L_acb_369
L_am_372:
v_subrev_u32 v248,s36,v1
v_and_b32 v248,0x80000003,v248
v_cmp_eq_u32 vcc,0,v248
v_lshlrev_b32 v248,2,v1
v_mov_b32 v249,0x40000000
v_cndmask_b32 v248,v249,v248,vcc
v_mov_b32 v249,3
s_or_b32 s59,s68,s46
s_mov_b32 s59,11018240
s_cmov_b32 s59,0x80000000
buffer_store_dword v249,v248,s[8:11],s59 offen sc1
s_branch L_ab_370
L_ap_376:
L_aw_388:
v_cmp_gt_u32 vcc,s66,v17
s_cbranch_vccz L_awd_389
buffer_load_dword v17,v16,s[8:11],s87 offen sc1
s_sub_u32 s49,s49,1
s_cbranch_scc1 L_abort2
s_waitcnt vmcnt(0)
s_branch L_aw_388
L_awd_389:
s_branch L_apb_377
s_endpgm
L_wm:
s_nop 11
v_and_b32 v120,15,v1
v_lshrrev_b32 v121,4,v1
v_mov_b32 v17,1
s_lshl_b32 s56,s46,15
v_add_u32 v18,s56,v0
s_lshl_b32 s56,s46,2
v_add_u32 v125,s56,v121
v_xor_b32 v126,v125,v120
v_lshlrev_b32 v126,4,v126
v_lshl_add_u32 v20,v125,10,v126
v_add_u32 v125,0,v121
v_xor_b32 v125,v125,v120
v_lshlrev_b32 v125,4,v125
v_lshl_add_u32 v125,v120,8,v125
v_add_u32 v4,131072,v125
v_add_u32 v125,4,v121
v_xor_b32 v125,v125,v120
v_lshlrev_b32 v125,4,v125
v_lshl_add_u32 v125,v120,8,v125
v_add_u32 v5,131072,v125
v_add_u32 v125,8,v121
v_xor_b32 v125,v125,v120
v_lshlrev_b32 v125,4,v125
v_lshl_add_u32 v125,v120,8,v125
v_add_u32 v6,131072,v125
v_add_u32 v125,12,v121
v_xor_b32 v125,v125,v120
v_lshlrev_b32 v125,4,v125
v_lshl_add_u32 v125,v120,8,v125
v_add_u32 v7,131072,v125
v_lshlrev_b32 v21,5,v120
v_and_b32 v125,1,v121
v_lshl_add_u32 v21,v125,4,v21
s_lshl_b32 s56,s46,9
v_lshrrev_b32 v125,1,v121
v_lshl_add_u32 v21,v125,11,v21
s_add_u32 s56,s56,155648
v_add_u32 v21,s56,v21
v_lshlrev_b32 v22,4,v120
v_lshl_add_u32 v22,v121,10,v22
s_lshl_b32 s56,s46,8
v_add_u32 v22,s56,v22
s_mov_b32 s54,0
s_mov_b32 s31,0
s_mov_b32 s53,6
s_mov_b32 s72,0x80000000
s_mov_b32 s73,0
s_mov_b32 s77,-1
s_mov_b32 s86,0
s_mov_b32 s19,0
s_mov_b32 s74,2948595712
s_mov_b32 s75,2863311530
v_and_b32 v23,15,v1
v_lshlrev_b32 v23,3,v23
v_lshrrev_b32 v16,4,v1
v_lshl_add_u32 v23,v16,13,v23
v_mov_b32 v19,159744
v_lshl_add_u32 v16,v16,2,v19
v_and_b32 v9,15,v1
v_lshrrev_b32 v10,4,v1
v_and_b32 v124,1,v1
v_lshlrev_b32 v124,4,v124
v_mov_b32 v125,0xffff
v_lshlrev_b32 v125,v124,v125
v_lshrrev_b32 v124,2,v9
v_cmp_eq_u32 vcc,0,v124
s_nop 1
v_cndmask_b32 v12,0,v125,vcc
v_cmp_eq_u32 vcc,1,v124
s_nop 1
v_cndmask_b32 v13,0,v125,vcc
v_and_b32 v124,2,v1
v_cmp_eq_u32 vcc,0,v124
v_mov_b32 v14,0xeeee
v_mov_b32 v124,0x4444
v_cndmask_b32 v14,v14,v124,vcc
v_lshlrev_b32 v11,14,v10
v_lshl_add_u32 v11,v9,4,v11
s_lshl_b32 s65,s51,15
s_add_u32 s65,s65,92274688
s_lshl_b32 s62,s47,10
s_add_u32 s62,s62,s65
s_lshl_b32 s63,s47,16
s_lshl_b32 s60,s46,8
s_add_u32 s63,s63,s60
s_mov_b32 s4,s38
s_mov_b32 s5,s39
s_mov_b32 s6,1835008
s_mov_b32 s7,0x20000
buffer_load_dwordx4 v[24:27],v11,s[4:7],s63 offen offset:0
buffer_load_dwordx4 v[28:31],v11,s[4:7],s63 offen offset:1024
buffer_load_dwordx4 v[32:35],v11,s[4:7],s63 offen offset:2048
buffer_load_dwordx4 v[36:39],v11,s[4:7],s63 offen offset:3072
s_add_u32 s63,s63,4096
buffer_load_dwordx4 v[40:43],v11,s[4:7],s63 offen offset:0
buffer_load_dwordx4 v[44:47],v11,s[4:7],s63 offen offset:1024
buffer_load_dwordx4 v[48:51],v11,s[4:7],s63 offen offset:2048
buffer_load_dwordx4 v[52:55],v11,s[4:7],s63 offen offset:3072
s_add_u32 s63,s63,4096
buffer_load_dwordx4 v[56:59],v11,s[4:7],s63 offen offset:0
buffer_load_dwordx4 v[60:63],v11,s[4:7],s63 offen offset:1024
buffer_load_dwordx4 v[64:67],v11,s[4:7],s63 offen offset:2048
buffer_load_dwordx4 v[68:71],v11,s[4:7],s63 offen offset:3072
s_add_u32 s63,s63,4096
buffer_load_dwordx4 v[72:75],v11,s[4:7],s63 offen offset:0
buffer_load_dwordx4 v[76:79],v11,s[4:7],s63 offen offset:1024
buffer_load_dwordx4 v[80:83],v11,s[4:7],s63 offen offset:2048
buffer_load_dwordx4 v[84:87],v11,s[4:7],s63 offen offset:3072
s_mov_b32 s4,s32
s_mov_b32 s5,s33
s_mov_b32 s6,1024
s_mov_b32 s7,0x20000
buffer_load_dwordx4 v[88:91],v0,s[4:7],0 offen
s_waitcnt vmcnt(0)
v_lshlrev_b32 v96,16,v88
v_and_b32 v97,0xffff0000,v88
v_lshlrev_b32 v98,16,v89
v_and_b32 v99,0xffff0000,v89
v_lshlrev_b32 v100,16,v90
v_and_b32 v101,0xffff0000,v90
v_lshlrev_b32 v102,16,v91
v_and_b32 v103,0xffff0000,v91
v_mul_f32 v88,v96,v96
v_fma_f32 v88,v97,v97,v88
v_fma_f32 v88,v98,v98,v88
v_fma_f32 v88,v99,v99,v88
v_fma_f32 v88,v100,v100,v88
v_fma_f32 v88,v101,v101,v88
v_fma_f32 v88,v102,v102,v88
v_fma_f32 v88,v103,v103,v88
s_nop 1
v_add_f32_dpp v88,v88,v88 row_ror:8 row_mask:0xf bank_mask:0xf
s_nop 1
v_add_f32_dpp v88,v88,v88 row_ror:4 row_mask:0xf bank_mask:0xf
s_nop 1
v_add_f32_dpp v88,v88,v88 row_ror:2 row_mask:0xf bank_mask:0xf
s_nop 1
v_add_f32_dpp v88,v88,v88 row_ror:1 row_mask:0xf bank_mask:0xf
v_mov_b32 v89,v88
s_nop 1
v_permlane16_swap_b32 v88,v89
v_add_f32 v88,v88,v89
v_mov_b32 v89,v88
s_nop 1
v_permlane32_swap_b32 v88,v89
v_add_f32 v88,v88,v89
v_sqrt_f32 v88,v88
s_nop 0
v_mul_f32 v88,0x40333333,v88
s_nop 0
v_readfirstlane_b32 s25,v88
s_bitset1_b32 s25,31
s_ff1_i32_b64 s30,s[74:75]
s_bitset0_b64 s[74:75],s30
s_min_u32 s30,s30,127
s_lshl_b32 s70,s30,15
s_add_u32 s70,s70,0
s_add_u32 s71,s70,16384
L_mo_394:
s_cmp_lg_u32 s19,0
s_cbranch_scc1 L_mo_395
s_add_u32 m0,s50,131072
s_nop 0
buffer_load_dwordx4 v20,s[8:11],s70 offen offset:0 sc1 lds
s_add_u32 m0,s50,135168
s_nop 0
buffer_load_dwordx4 v20,s[8:11],s71 offen offset:0 sc1 lds
s_add_u32 m0,s50,139008
s_nop 0
buffer_load_dwordx4 v20,s[8:11],s70 offen offset:256 sc1 lds
s_add_u32 m0,s50,143104
s_nop 0
buffer_load_dwordx4 v20,s[8:11],s71 offen offset:256 sc1 lds
s_add_u32 m0,s50,146944
s_nop 0
buffer_load_dwordx4 v20,s[8:11],s70 offen offset:512 sc1 lds
s_add_u32 m0,s50,151040
s_nop 0
buffer_load_dwordx4 v20,s[8:11],s71 offen offset:512 sc1 lds
s_mov_b32 s19,1
s_waitcnt vmcnt(0)
L_mo_395:
s_mov_b32 s51,s30
s_mov_b64 s[68:69],s[70:71]
s_ff1_i32_b64 s30,s[74:75]
s_bitset0_b64 s[74:75],s30
s_min_u32 s30,s30,127
s_lshl_b32 s70,s30,15
s_add_u32 s70,s70,0
s_add_u32 s71,s70,16384
s_lshl_b32 s76,s31,13
s_add_u32 s76,s76,10487040
s_lshl_b32 s58,s51,5
s_add_u32 s58,s58,s47
s_mul_i32 s58,s58,24576
s_add_u32 s58,s58,100663296
s_add_u32 s61,s58,s50
s_add_u32 s62,s61,4096
s_add_u32 s63,s61,16384
s_add_u32 s64,s61,20480
s_add_u32 s65,s61,s50
s_add_u32 s65,s65,8192
s_waitcnt vmcnt(12)
s_barrier
ds_read_b128 v[72:75],v4 offset:0
ds_read_b128 v[76:79],v4 offset:4096
ds_read_b128 v[80:83],v5 offset:0
ds_read_b128 v[84:87],v5 offset:4096
s_add_u32 m0,s50,154880
s_nop 0
buffer_load_dwordx4 v20,s[8:11],s68 offen offset:768 sc1 lds
s_add_u32 m0,s50,158976
s_nop 0
buffer_load_dwordx4 v20,s[8:11],s69 offen offset:768 sc1 lds
s_waitcnt lgkmcnt(2)
v_mfma_f32_16x16x32_bf16 v[40:43],a[128:131],v[72:75],0
ds_read_b128 v[108:111],v6 offset:0
v_mfma_f32_16x16x32_bf16 v[56:59],v[72:75],v[128:131],0
v_mfma_f32_16x16x32_bf16 v[24:27],a[0:3],v[72:75],0
ds_read_b128 v[112:115],v6 offset:4096
v_mfma_f32_16x16x32_bf16 v[44:47],a[128:131],v[76:79],0
v_mfma_f32_16x16x32_bf16 v[60:63],v[76:79],v[128:131],0
v_mfma_f32_16x16x32_bf16 v[28:31],a[0:3],v[76:79],0
v_mfma_f32_16x16x32_bf16 v[48:51],a[136:139],v[72:75],0
v_mfma_f32_16x16x32_bf16 v[64:67],v[72:75],v[136:139],0
v_mfma_f32_16x16x32_bf16 v[32:35],a[8:11],v[72:75],0
v_mfma_f32_16x16x32_bf16 v[52:55],a[136:139],v[76:79],0
v_mfma_f32_16x16x32_bf16 v[68:71],v[76:79],v[136:139],0
v_mfma_f32_16x16x32_bf16 v[36:39],a[8:11],v[76:79],0
s_waitcnt lgkmcnt(2)
v_mfma_f32_16x16x32_bf16 v[40:43],a[132:135],v[80:83],v[40:43]
ds_read_b128 v[72:75],v7 offset:0
v_mfma_f32_16x16x32_bf16 v[56:59],v[80:83],v[132:135],v[56:59]
v_mfma_f32_16x16x32_bf16 v[24:27],a[4:7],v[80:83],v[24:27]
ds_read_b128 v[76:79],v7 offset:4096
v_mfma_f32_16x16x32_bf16 v[44:47],a[132:135],v[84:87],v[44:47]
v_mfma_f32_16x16x32_bf16 v[60:63],v[84:87],v[132:135],v[60:63]
v_mfma_f32_16x16x32_bf16 v[28:31],a[4:7],v[84:87],v[28:31]
v_mfma_f32_16x16x32_bf16 v[48:51],a[140:143],v[80:83],v[48:51]
v_mfma_f32_16x16x32_bf16 v[64:67],v[80:83],v[140:143],v[64:67]
v_mfma_f32_16x16x32_bf16 v[32:35],a[12:15],v[80:83],v[32:35]
v_mfma_f32_16x16x32_bf16 v[52:55],a[140:143],v[84:87],v[52:55]
v_mfma_f32_16x16x32_bf16 v[68:71],v[84:87],v[140:143],v[68:71]
v_mfma_f32_16x16x32_bf16 v[36:39],a[12:15],v[84:87],v[36:39]
s_waitcnt vmcnt(12)
s_barrier
s_waitcnt lgkmcnt(2)
v_mfma_f32_16x16x32_bf16 v[40:43],a[144:147],v[108:111],v[40:43]
ds_read_b128 v[80:83],v4 offset:8192
v_mfma_f32_16x16x32_bf16 v[56:59],v[108:111],v[144:147],v[56:59]
v_mfma_f32_16x16x32_bf16 v[24:27],a[16:19],v[108:111],v[24:27]
ds_read_b128 v[84:87],v4 offset:12288
v_mfma_f32_16x16x32_bf16 v[44:47],a[144:147],v[112:115],v[44:47]
v_mfma_f32_16x16x32_bf16 v[60:63],v[112:115],v[144:147],v[60:63]
v_mfma_f32_16x16x32_bf16 v[28:31],a[16:19],v[112:115],v[28:31]
v_mfma_f32_16x16x32_bf16 v[48:51],a[152:155],v[108:111],v[48:51]
v_mfma_f32_16x16x32_bf16 v[64:67],v[108:111],v[152:155],v[64:67]
v_mfma_f32_16x16x32_bf16 v[32:35],a[24:27],v[108:111],v[32:35]
v_mfma_f32_16x16x32_bf16 v[52:55],a[152:155],v[112:115],v[52:55]
v_mfma_f32_16x16x32_bf16 v[68:71],v[112:115],v[152:155],v[68:71]
v_mfma_f32_16x16x32_bf16 v[36:39],a[24:27],v[112:115],v[36:39]
s_waitcnt lgkmcnt(2)
v_mfma_f32_16x16x32_bf16 v[40:43],a[148:151],v[72:75],v[40:43]
ds_read_b128 v[108:111],v5 offset:8192
v_mfma_f32_16x16x32_bf16 v[56:59],v[72:75],v[148:151],v[56:59]
v_mfma_f32_16x16x32_bf16 v[24:27],a[20:23],v[72:75],v[24:27]
ds_read_b128 v[112:115],v5 offset:12288
v_mfma_f32_16x16x32_bf16 v[44:47],a[148:151],v[76:79],v[44:47]
v_mfma_f32_16x16x32_bf16 v[60:63],v[76:79],v[148:151],v[60:63]
v_mfma_f32_16x16x32_bf16 v[28:31],a[20:23],v[76:79],v[28:31]
v_mfma_f32_16x16x32_bf16 v[48:51],a[156:159],v[72:75],v[48:51]
v_mfma_f32_16x16x32_bf16 v[64:67],v[72:75],v[156:159],v[64:67]
v_mfma_f32_16x16x32_bf16 v[32:35],a[28:31],v[72:75],v[32:35]
v_mfma_f32_16x16x32_bf16 v[52:55],a[156:159],v[76:79],v[52:55]
v_mfma_f32_16x16x32_bf16 v[68:71],v[76:79],v[156:159],v[68:71]
v_mfma_f32_16x16x32_bf16 v[36:39],a[28:31],v[76:79],v[36:39]
s_waitcnt lgkmcnt(2)
v_mfma_f32_16x16x32_bf16 v[40:43],a[160:163],v[80:83],v[40:43]
ds_read_b128 v[72:75],v6 offset:8192
v_mfma_f32_16x16x32_bf16 v[56:59],v[80:83],v[160:163],v[56:59]
v_mfma_f32_16x16x32_bf16 v[24:27],a[32:35],v[80:83],v[24:27]
ds_read_b128 v[76:79],v6 offset:12288
v_mfma_f32_16x16x32_bf16 v[44:47],a[160:163],v[84:87],v[44:47]
v_mfma_f32_16x16x32_bf16 v[60:63],v[84:87],v[160:163],v[60:63]
v_mfma_f32_16x16x32_bf16 v[28:31],a[32:35],v[84:87],v[28:31]
v_mfma_f32_16x16x32_bf16 v[48:51],a[168:171],v[80:83],v[48:51]
v_mfma_f32_16x16x32_bf16 v[64:67],v[80:83],v[168:171],v[64:67]
v_mfma_f32_16x16x32_bf16 v[32:35],a[40:43],v[80:83],v[32:35]
v_mfma_f32_16x16x32_bf16 v[52:55],a[168:171],v[84:87],v[52:55]
v_mfma_f32_16x16x32_bf16 v[68:71],v[84:87],v[168:171],v[68:71]
v_mfma_f32_16x16x32_bf16 v[36:39],a[40:43],v[84:87],v[36:39]
s_waitcnt lgkmcnt(2)
v_mfma_f32_16x16x32_bf16 v[40:43],a[164:167],v[108:111],v[40:43]
ds_read_b128 v[80:83],v7 offset:8192
v_mfma_f32_16x16x32_bf16 v[56:59],v[108:111],v[164:167],v[56:59]
v_mfma_f32_16x16x32_bf16 v[24:27],a[36:39],v[108:111],v[24:27]
ds_read_b128 v[84:87],v7 offset:12288
v_mfma_f32_16x16x32_bf16 v[44:47],a[164:167],v[112:115],v[44:47]
v_mfma_f32_16x16x32_bf16 v[60:63],v[112:115],v[164:167],v[60:63]
v_mfma_f32_16x16x32_bf16 v[28:31],a[36:39],v[112:115],v[28:31]
v_mfma_f32_16x16x32_bf16 v[48:51],a[172:175],v[108:111],v[48:51]
v_mfma_f32_16x16x32_bf16 v[64:67],v[108:111],v[172:175],v[64:67]
v_mfma_f32_16x16x32_bf16 v[32:35],a[44:47],v[108:111],v[32:35]
v_mfma_f32_16x16x32_bf16 v[52:55],a[172:175],v[112:115],v[52:55]
v_mfma_f32_16x16x32_bf16 v[68:71],v[112:115],v[172:175],v[68:71]
v_mfma_f32_16x16x32_bf16 v[36:39],a[44:47],v[112:115],v[36:39]
s_waitcnt vmcnt(10)
s_barrier
s_waitcnt lgkmcnt(2)
v_mfma_f32_16x16x32_bf16 v[40:43],a[176:179],v[72:75],v[40:43]
ds_read_b128 v[108:111],v4 offset:16384
v_mfma_f32_16x16x32_bf16 v[56:59],v[72:75],v[176:179],v[56:59]
v_mfma_f32_16x16x32_bf16 v[24:27],a[48:51],v[72:75],v[24:27]
ds_read_b128 v[112:115],v4 offset:20480
v_mfma_f32_16x16x32_bf16 v[44:47],a[176:179],v[76:79],v[44:47]
v_mfma_f32_16x16x32_bf16 v[60:63],v[76:79],v[176:179],v[60:63]
v_mfma_f32_16x16x32_bf16 v[28:31],a[48:51],v[76:79],v[28:31]
v_mfma_f32_16x16x32_bf16 v[48:51],a[184:187],v[72:75],v[48:51]
v_mfma_f32_16x16x32_bf16 v[64:67],v[72:75],v[184:187],v[64:67]
v_mfma_f32_16x16x32_bf16 v[32:35],a[56:59],v[72:75],v[32:35]
v_mfma_f32_16x16x32_bf16 v[52:55],a[184:187],v[76:79],v[52:55]
v_mfma_f32_16x16x32_bf16 v[68:71],v[76:79],v[184:187],v[68:71]
v_mfma_f32_16x16x32_bf16 v[36:39],a[56:59],v[76:79],v[36:39]
s_waitcnt vmcnt(2)
s_barrier
s_or_b32 s72,s72,s52
buffer_store_dword v17,off,s[8:11],s72 sc1
s_waitcnt lgkmcnt(2)
v_mfma_f32_16x16x32_bf16 v[40:43],a[180:183],v[80:83],v[40:43]
ds_read_b128 v[72:75],v5 offset:16384
v_mfma_f32_16x16x32_bf16 v[56:59],v[80:83],v[180:183],v[56:59]
v_mfma_f32_16x16x32_bf16 v[24:27],a[52:55],v[80:83],v[24:27]
ds_read_b128 v[76:79],v5 offset:20480
v_mfma_f32_16x16x32_bf16 v[44:47],a[180:183],v[84:87],v[44:47]
v_mfma_f32_16x16x32_bf16 v[60:63],v[84:87],v[180:183],v[60:63]
v_mfma_f32_16x16x32_bf16 v[28:31],a[52:55],v[84:87],v[28:31]
v_mfma_f32_16x16x32_bf16 v[48:51],a[188:191],v[80:83],v[48:51]
v_mfma_f32_16x16x32_bf16 v[64:67],v[80:83],v[188:191],v[64:67]
v_mfma_f32_16x16x32_bf16 v[32:35],a[60:63],v[80:83],v[32:35]
v_mfma_f32_16x16x32_bf16 v[52:55],a[188:191],v[84:87],v[52:55]
v_mfma_f32_16x16x32_bf16 v[68:71],v[84:87],v[188:191],v[68:71]
v_mfma_f32_16x16x32_bf16 v[36:39],a[60:63],v[84:87],v[36:39]
s_waitcnt lgkmcnt(2)
v_mfma_f32_16x16x32_bf16 v[40:43],a[192:195],v[108:111],v[40:43]
ds_read_b128 v[80:83],v6 offset:16384
v_mfma_f32_16x16x32_bf16 v[56:59],v[108:111],v[192:195],v[56:59]
v_mfma_f32_16x16x32_bf16 v[24:27],a[64:67],v[108:111],v[24:27]
ds_read_b128 v[84:87],v6 offset:20480
v_mfma_f32_16x16x32_bf16 v[44:47],a[192:195],v[112:115],v[44:47]
v_mfma_f32_16x16x32_bf16 v[60:63],v[112:115],v[192:195],v[60:63]
v_mfma_f32_16x16x32_bf16 v[28:31],a[64:67],v[112:115],v[28:31]
v_mfma_f32_16x16x32_bf16 v[48:51],a[200:203],v[108:111],v[48:51]
v_mfma_f32_16x16x32_bf16 v[64:67],v[108:111],v[200:203],v[64:67]
v_mfma_f32_16x16x32_bf16 v[32:35],a[72:75],v[108:111],v[32:35]
v_mfma_f32_16x16x32_bf16 v[52:55],a[200:203],v[112:115],v[52:55]
v_mfma_f32_16x16x32_bf16 v[68:71],v[112:115],v[200:203],v[68:71]
v_mfma_f32_16x16x32_bf16 v[36:39],a[72:75],v[112:115],v[36:39]
s_waitcnt lgkmcnt(2)
v_mfma_f32_16x16x32_bf16 v[40:43],a[196:199],v[72:75],v[40:43]
ds_read_b128 v[108:111],v7 offset:16384
v_mfma_f32_16x16x32_bf16 v[56:59],v[72:75],v[196:199],v[56:59]
v_mfma_f32_16x16x32_bf16 v[24:27],a[68:71],v[72:75],v[24:27]
ds_read_b128 v[112:115],v7 offset:20480
v_mfma_f32_16x16x32_bf16 v[44:47],a[196:199],v[76:79],v[44:47]
v_mfma_f32_16x16x32_bf16 v[60:63],v[76:79],v[196:199],v[60:63]
v_mfma_f32_16x16x32_bf16 v[28:31],a[68:71],v[76:79],v[28:31]
v_mfma_f32_16x16x32_bf16 v[48:51],a[204:207],v[72:75],v[48:51]
v_mfma_f32_16x16x32_bf16 v[64:67],v[72:75],v[204:207],v[64:67]
v_mfma_f32_16x16x32_bf16 v[32:35],a[76:79],v[72:75],v[32:35]
v_mfma_f32_16x16x32_bf16 v[52:55],a[204:207],v[76:79],v[52:55]
v_mfma_f32_16x16x32_bf16 v[68:71],v[76:79],v[204:207],v[68:71]
v_mfma_f32_16x16x32_bf16 v[36:39],a[76:79],v[76:79],v[36:39]
s_waitcnt vmcnt(1)
s_barrier
s_waitcnt lgkmcnt(2)
v_mfma_f32_16x16x32_bf16 v[40:43],a[208:211],v[80:83],v[40:43]
ds_read_b128 v[72:75],v4 offset:24576
v_mfma_f32_16x16x32_bf16 v[56:59],v[80:83],v[208:211],v[56:59]
v_mfma_f32_16x16x32_bf16 v[24:27],a[80:83],v[80:83],v[24:27]
ds_read_b128 v[76:79],v4 offset:28672
v_mfma_f32_16x16x32_bf16 v[44:47],a[208:211],v[84:87],v[44:47]
v_mfma_f32_16x16x32_bf16 v[60:63],v[84:87],v[208:211],v[60:63]
v_mfma_f32_16x16x32_bf16 v[28:31],a[80:83],v[84:87],v[28:31]
v_mfma_f32_16x16x32_bf16 v[48:51],a[216:219],v[80:83],v[48:51]
v_mfma_f32_16x16x32_bf16 v[64:67],v[80:83],v[216:219],v[64:67]
v_mfma_f32_16x16x32_bf16 v[32:35],a[88:91],v[80:83],v[32:35]
v_mfma_f32_16x16x32_bf16 v[52:55],a[216:219],v[84:87],v[52:55]
v_mfma_f32_16x16x32_bf16 v[68:71],v[84:87],v[216:219],v[68:71]
v_mfma_f32_16x16x32_bf16 v[36:39],a[88:91],v[84:87],v[36:39]
s_waitcnt lgkmcnt(2)
v_mfma_f32_16x16x32_bf16 v[40:43],a[212:215],v[108:111],v[40:43]
ds_read_b128 v[80:83],v5 offset:24576
v_mfma_f32_16x16x32_bf16 v[56:59],v[108:111],v[212:215],v[56:59]
v_mfma_f32_16x16x32_bf16 v[24:27],a[84:87],v[108:111],v[24:27]
ds_read_b128 v[84:87],v5 offset:28672
v_mfma_f32_16x16x32_bf16 v[44:47],a[212:215],v[112:115],v[44:47]
v_mfma_f32_16x16x32_bf16 v[60:63],v[112:115],v[212:215],v[60:63]
v_mfma_f32_16x16x32_bf16 v[28:31],a[84:87],v[112:115],v[28:31]
v_mfma_f32_16x16x32_bf16 v[48:51],a[220:223],v[108:111],v[48:51]
v_mfma_f32_16x16x32_bf16 v[64:67],v[108:111],v[220:223],v[64:67]
v_mfma_f32_16x16x32_bf16 v[32:35],a[92:95],v[108:111],v[32:35]
v_mfma_f32_16x16x32_bf16 v[52:55],a[220:223],v[112:115],v[52:55]
v_mfma_f32_16x16x32_bf16 v[68:71],v[112:115],v[220:223],v[68:71]
v_mfma_f32_16x16x32_bf16 v[36:39],a[92:95],v[112:115],v[36:39]
s_barrier
s_waitcnt lgkmcnt(2)
v_mfma_f32_16x16x32_bf16 v[40:43],a[224:227],v[72:75],v[40:43]
ds_read_b128 v[108:111],v6 offset:24576
v_mfma_f32_16x16x32_bf16 v[56:59],v[72:75],v[224:227],v[56:59]
s_add_u32 m0,s50,131072
v_mfma_f32_16x16x32_bf16 v[24:27],a[96:99],v[72:75],v[24:27]
ds_read_b128 v[112:115],v6 offset:28672
v_mfma_f32_16x16x32_bf16 v[44:47],a[224:227],v[76:79],v[44:47]
buffer_load_dwordx4 v20,s[8:11],s70 offen offset:0 sc1 lds
v_mfma_f32_16x16x32_bf16 v[60:63],v[76:79],v[224:227],v[60:63]
s_add_u32 m0,s50,135168
v_mfma_f32_16x16x32_bf16 v[28:31],a[96:99],v[76:79],v[28:31]
buffer_load_dwordx4 v20,s[8:11],s71 offen offset:0 sc1 lds
v_mfma_f32_16x16x32_bf16 v[48:51],a[232:235],v[72:75],v[48:51]
s_add_u32 m0,s50,139008
v_mfma_f32_16x16x32_bf16 v[64:67],v[72:75],v[232:235],v[64:67]
buffer_load_dwordx4 v20,s[8:11],s70 offen offset:256 sc1 lds
v_mfma_f32_16x16x32_bf16 v[32:35],a[104:107],v[72:75],v[32:35]
s_add_u32 m0,s50,143104
v_mfma_f32_16x16x32_bf16 v[52:55],a[232:235],v[76:79],v[52:55]
buffer_load_dwordx4 v20,s[8:11],s71 offen offset:256 sc1 lds
v_mfma_f32_16x16x32_bf16 v[68:71],v[76:79],v[232:235],v[68:71]
s_add_u32 m0,s50,146944
v_mfma_f32_16x16x32_bf16 v[36:39],a[104:107],v[76:79],v[36:39]
buffer_load_dwordx4 v20,s[8:11],s70 offen offset:512 sc1 lds
s_waitcnt lgkmcnt(2)
v_mfma_f32_16x16x32_bf16 v[40:43],a[228:231],v[80:83],v[40:43]
ds_read_b128 v[72:75],v7 offset:24576
v_mfma_f32_16x16x32_bf16 v[56:59],v[80:83],v[228:231],v[56:59]
s_add_u32 m0,s50,151040
v_mfma_f32_16x16x32_bf16 v[24:27],a[100:103],v[80:83],v[24:27]
ds_read_b128 v[76:79],v7 offset:28672
v_mfma_f32_16x16x32_bf16 v[44:47],a[228:231],v[84:87],v[44:47]
buffer_load_dwordx4 v20,s[8:11],s71 offen offset:512 sc1 lds
v_mfma_f32_16x16x32_bf16 v[60:63],v[84:87],v[228:231],v[60:63]
buffer_load_dwordx2 v[124:125],v23,s[8:11],s76 offen sc1
v_mfma_f32_16x16x32_bf16 v[28:31],a[100:103],v[84:87],v[28:31]
v_mfma_f32_16x16x32_bf16 v[48:51],a[236:239],v[80:83],v[48:51]
v_mfma_f32_16x16x32_bf16 v[64:67],v[80:83],v[236:239],v[64:67]
v_mfma_f32_16x16x32_bf16 v[32:35],a[108:111],v[80:83],v[32:35]
v_mfma_f32_16x16x32_bf16 v[52:55],a[236:239],v[84:87],v[52:55]
v_mfma_f32_16x16x32_bf16 v[68:71],v[84:87],v[236:239],v[68:71]
v_mfma_f32_16x16x32_bf16 v[36:39],a[108:111],v[84:87],v[36:39]
s_waitcnt lgkmcnt(2)
v_mfma_f32_16x16x32_bf16 v[40:43],a[240:243],v[108:111],v[40:43]
v_mfma_f32_16x16x32_bf16 v[56:59],v[108:111],v[240:243],v[56:59]
v_mfma_f32_16x16x32_bf16 v[24:27],a[112:115],v[108:111],v[24:27]
v_mfma_f32_16x16x32_bf16 v[44:47],a[240:243],v[112:115],v[44:47]
v_mfma_f32_16x16x32_bf16 v[60:63],v[112:115],v[240:243],v[60:63]
v_mfma_f32_16x16x32_bf16 v[28:31],a[112:115],v[112:115],v[28:31]
v_mfma_f32_16x16x32_bf16 v[48:51],a[248:251],v[108:111],v[48:51]
v_mfma_f32_16x16x32_bf16 v[64:67],v[108:111],v[248:251],v[64:67]
v_mfma_f32_16x16x32_bf16 v[32:35],a[120:123],v[108:111],v[32:35]
v_mfma_f32_16x16x32_bf16 v[52:55],a[248:251],v[112:115],v[52:55]
v_mfma_f32_16x16x32_bf16 v[68:71],v[112:115],v[248:251],v[68:71]
v_mfma_f32_16x16x32_bf16 v[36:39],a[120:123],v[112:115],v[36:39]
s_waitcnt lgkmcnt(0)
v_mfma_f32_16x16x32_bf16 v[40:43],a[244:247],v[72:75],v[40:43]
v_mfma_f32_16x16x32_bf16 v[56:59],v[72:75],v[244:247],v[56:59]
v_mfma_f32_16x16x32_bf16 v[24:27],a[116:119],v[72:75],v[24:27]
v_mfma_f32_16x16x32_bf16 v[44:47],a[244:247],v[76:79],v[44:47]
v_mfma_f32_16x16x32_bf16 v[60:63],v[76:79],v[244:247],v[60:63]
v_mfma_f32_16x16x32_bf16 v[28:31],a[116:119],v[76:79],v[28:31]
v_mfma_f32_16x16x32_bf16 v[48:51],a[252:255],v[72:75],v[48:51]
v_mfma_f32_16x16x32_bf16 v[64:67],v[72:75],v[252:255],v[64:67]
v_mfma_f32_16x16x32_bf16 v[32:35],a[124:127],v[72:75],v[32:35]
v_mfma_f32_16x16x32_bf16 v[52:55],a[252:255],v[76:79],v[52:55]
v_mfma_f32_16x16x32_bf16 v[68:71],v[76:79],v[252:255],v[68:71]
v_mfma_f32_16x16x32_bf16 v[36:39],a[124:127],v[76:79],v[36:39]
s_lshl_b32 s56,s51,5
s_add_u32 s56,s56,s47
s_lshl_b32 s56,s56,12
s_add_u32 s56,s56,s50
s_add_u32 s56,s56,41943040
v_mov_b64 v[120:121],-1
v_mov_b64 v[122:123],-1
buffer_store_dwordx4 v[120:123],v0,s[8:11],s56 offen sc1
v_cvt_pk_bf16_f32 v72,v40,v48
v_cvt_pk_bf16_f32 v73,v41,v49
v_cvt_pk_bf16_f32 v74,v42,v50
v_cvt_pk_bf16_f32 v75,v43,v51
buffer_store_dwordx4 v[72:75],v0,s[8:11],s61 offen sc1
v_cvt_pk_bf16_f32 v76,v44,v52
v_cvt_pk_bf16_f32 v77,v45,v53
v_cvt_pk_bf16_f32 v78,v46,v54
v_cvt_pk_bf16_f32 v79,v47,v55
buffer_store_dwordx4 v[76:79],v0,s[8:11],s62 offen sc1
v_cvt_pk_bf16_f32 v80,v56,v57
v_cvt_pk_bf16_f32 v81,v58,v59
v_cvt_pk_bf16_f32 v82,v60,v61
v_cvt_pk_bf16_f32 v83,v62,v63
buffer_store_dwordx4 v[80:83],v0,s[8:11],s65 offen offset:0 sc1
v_cvt_pk_bf16_f32 v84,v64,v65
v_cvt_pk_bf16_f32 v85,v66,v67
v_cvt_pk_bf16_f32 v86,v68,v69
v_cvt_pk_bf16_f32 v87,v70,v71
buffer_store_dwordx4 v[84:87],v0,s[8:11],s65 offen offset:1024 sc1
v_cvt_pk_bf16_f32 v108,v24,v32
v_cvt_pk_bf16_f32 v109,v25,v33
v_cvt_pk_bf16_f32 v110,v26,v34
v_cvt_pk_bf16_f32 v111,v27,v35
buffer_store_dwordx4 v[108:111],v0,s[8:11],s63 offen sc1
v_cvt_pk_bf16_f32 v112,v28,v36
v_cvt_pk_bf16_f32 v113,v29,v37
v_cvt_pk_bf16_f32 v114,v30,v38
v_cvt_pk_bf16_f32 v115,v31,v39
buffer_store_dwordx4 v[112:115],v0,s[8:11],s64 offen sc1
s_lshl_b32 s72,s51,13
s_lshl2_add_u32 s72,s47,s72
s_add_u32 s72,s72,10485760
s_sub_u32 s53,s53,1
s_cmp_gt_i32 s53,3
s_cbranch_scc1 L_mo_395
s_cmp_gt_i32 s53,0
s_cselect_b32 s87,1,3
s_mov_b32 s18,0
s_waitcnt vmcnt(7)
s_branch L_mo_400
L_mo_393:
s_mov_b32 s55,s22
s_mov_b32 s22,s23
s_mov_b32 s23,s24
s_mov_b32 s24,-1
v_mov_b32 v3,0
s_cmp_lg_u32 s55,-1
s_cbranch_scc1 L_mp_390
s_sub_u32 s56,s30,s31
s_cmp_gt_i32 s77,0
s_cselect_b32 s57,6,20
s_cmp_lg_u32 s86,0
s_cselect_b32 s57,9,s57
s_cmp_lt_i32 s56,s57
s_cbranch_scc1 L_mo_394
s_cmp_lt_i32 s56,30
s_cselect_b32 s87,s18,0
s_cmp_ge_u32 s31,8
s_cselect_b32 s56,1,s18
s_and_b32 s56,s56,s86
s_cselect_b32 s87,2,s87
s_mul_i32 s56,s87,s18
s_cmp_lg_u32 s56,0
s_cbranch_scc1 L_mo_398
s_mov_b32 s18,0
s_lshr_b32 s56,s72,31
s_or_b32 s56,s56,s87
s_cbranch_scc1 L_mo_404
s_waitcnt vmcnt(0)
s_barrier
s_or_b32 s72,s72,s52
buffer_store_dword v17,off,s[8:11],s72 sc1
s_mov_b32 s72,0x80000000
L_mo_404:
s_cmp_lg_u32 s46,0
s_cbranch_scc1 L_mo_402
s_lshl_b32 s76,s31,13
s_add_u32 s76,s76,10487040
s_lshl_b32 s57,s47,8
s_add_u32 s57,s57,s31
s_cmp_eq_u32 s57,63
s_mov_b32 s57,0x80000000
s_cmov_b32 s57,11018240
v_lshlrev_b32 v2,2,v1
L_mo_401:
buffer_load_dwordx2 v[124:125],v23,s[8:11],s76 offen sc1
buffer_load_dword v3,v2,s[8:11],s57 offen sc1
s_sub_u32 s49,s49,1
s_cbranch_scc1 L_abort2
s_waitcnt vmcnt(0)
L_mo_400:
v_min_u32 v123,v124,v125
v_max_u32 v125,v124,v125
v_cmp_eq_u32 vcc,0,v123
s_nop 1
v_cndmask_b32 v125,v125,-1,vcc
s_and_b32 s56,vcc_lo,0xffff
s_cbranch_scc0 L_mo_405
s_cmp_lg_u32 s87,0
s_cbranch_scc1 L_mo_405
s_mov_b32 s18,1
s_sleep 2
s_branch L_mo_401
L_mo_405:
v_max_u32_dpp v125,v125,v125 row_ror:8 row_mask:0xf bank_mask:0xf
s_nop 1
v_max_u32_dpp v125,v125,v125 row_ror:4 row_mask:0xf bank_mask:0xf
s_nop 1
v_max_u32_dpp v125,v125,v125 row_ror:2 row_mask:0xf bank_mask:0xf
s_nop 1
v_max_u32_dpp v125,v125,v125 row_ror:1 row_mask:0xf bank_mask:0xf
L_mo_402:
s_sub_u32 s49,s49,1
s_cbranch_scc1 L_abort2
v_mov_b32 v124,s18
s_barrier
s_cmp_lg_u32 s46,0
s_cbranch_scc1 L_mo_403
ds_write_b32 v16,v125
ds_write_b32 v19,v124 offset:16
s_waitcnt lgkmcnt(0)
L_mo_403:
s_barrier
ds_read_b128 v[120:123],v19
ds_read_b32 v124,v19 offset:16
s_waitcnt lgkmcnt(0)
v_readfirstlane_b32 s55,v120
v_readfirstlane_b32 s22,v121
v_readfirstlane_b32 s23,v122
v_readfirstlane_b32 s24,v123
v_readfirstlane_b32 s18,v124
s_cmp_lg_u32 s55,-1
s_cbranch_scc1 L_mp_390
L_mo_398:
s_mov_b32 s22,-1
s_cmp_eq_u32 s87,1
s_cbranch_scc1 L_mo_394
s_cmp_eq_u32 s87,2
s_cbranch_scc1 L_mo_399
s_branch L_mo_393
L_mp_390:
s_mov_b32 s53,0
s_sub_u32 s73,s73,1
s_max_i32 s73,s73,0
s_sub_u32 s77,s77,1
s_min_u32 s61,s73,2
s_cmp_lt_u32 s31,5
s_cselect_b32 s60,s25,0
s_cmp_lt_u32 s55,s60
s_cselect_b32 s61,2,s61
s_cmp_le_u32 s55,s54
s_cbranch_scc1 L_mr_391
s_mov_b32 s77,s61
s_mov_b32 s54,s55
s_mov_b32 s86,0
s_or_b32 s61,s47,s46
s_cbranch_scc1 L_mr_391
v_mov_b32 v120,s54
v_lshlrev_b32 v121,13,v1
s_mov_b32 s61,10486784
buffer_store_dword v120,v121,s[8:11],s61 offen sc1
L_mr_391:
s_cmp_lg_u32 s31,63
s_cbranch_scc1 L_mo_396
s_min_i32 s77,s77,0
s_or_b32 s61,s47,s46
s_cbranch_scc1 L_mo_396
s_mov_b32 s59,11018240
v_lshlrev_b32 v120,2,v1
v_mov_b32 v121,v3
v_cmp_eq_u32 vcc,0,v3
s_cbranch_vccz L_mg_392
L_fp_407:
s_sleep 0
buffer_load_dword v121,v120,s[8:11],s59 offen sc1
s_sub_u32 s49,s49,1
s_cbranch_scc1 L_abort2
s_waitcnt vmcnt(0)
v_cmp_eq_u32 vcc,0,v121
s_cbranch_vccnz L_fp_407
L_mg_392:
s_andn2_b32 s62,0x7ff,s54
v_lshl_or_b32 v121,s62,8,v121
s_add_u32 s59,s59,8192
buffer_store_dword v121,v120,s[8:11],s59 offen sc1
s_add_u32 s59,s59,8192
buffer_store_dword v121,v120,s[8:11],s59 offen sc1
s_add_u32 s59,s59,8192
buffer_store_dword v121,v120,s[8:11],s59 offen sc1
s_add_u32 s59,s59,8192
buffer_store_dword v121,v120,s[8:11],s59 offen sc1
s_add_u32 s59,s59,8192
buffer_store_dword v121,v120,s[8:11],s59 offen sc1
s_add_u32 s59,s59,8192
buffer_store_dword v121,v120,s[8:11],s59 offen sc1
L_mo_396:
s_add_u32 s31,s31,1
s_cmp_gt_i32 s77,0
s_cmov_b32 s18,0
s_cbranch_scc1 L_mo_393
s_cmp_lg_u32 s77,0
s_cbranch_scc1 L_mo_397
s_andn2_b32 s51,0x7ff,s54
s_lshr_b32 s51,s51,5
s_add_u32 s73,s73,2
s_mov_b32 s86,1
s_mov_b32 s19,0
s_mov_b32 s18,0
s_waitcnt vmcnt(8)
s_barrier
s_andn2_b32 s64,0x7ff,s54
s_lshl_b32 s56,s64,10
s_add_u32 s58,s56,4194304
buffer_load_dwordx4 v[88:91],v0,s[8:11],s58 offen sc1
v_and_b32 v9,15,v1
v_lshrrev_b32 v10,4,v1
v_and_b32 v124,1,v1
v_lshlrev_b32 v124,4,v124
v_mov_b32 v125,0xffff
v_lshlrev_b32 v125,v124,v125
v_lshrrev_b32 v124,2,v9
v_cmp_eq_u32 vcc,0,v124
s_nop 1
v_cndmask_b32 v12,0,v125,vcc
v_cmp_eq_u32 vcc,1,v124
s_nop 1
v_cndmask_b32 v13,0,v125,vcc
v_and_b32 v124,2,v1
v_cmp_eq_u32 vcc,0,v124
v_mov_b32 v14,0xeeee
v_mov_b32 v124,0x4444
v_cndmask_b32 v14,v14,v124,vcc
v_lshlrev_b32 v11,14,v10
v_lshl_add_u32 v11,v9,4,v11
s_lshl_b32 s65,s51,15
s_add_u32 s65,s65,92274688
s_lshl_b32 s62,s47,10
s_add_u32 s62,s62,s65
s_lshl_b32 s63,s47,16
s_lshl_b32 s60,s46,8
s_add_u32 s63,s63,s60
s_mov_b32 s4,s38
s_mov_b32 s5,s39
s_mov_b32 s6,1835008
s_mov_b32 s7,0x20000
s_lshl_b32 s57,s46,11
s_add_u32 s57,s57,139264
v_add_u32 v8,s57,v0
v_and_b32 v2,1,v10
v_lshrrev_b32 v3,1,v10
v_lshlrev_b32 v2,7,v2
v_lshl_add_u32 v2,v3,10,v2
s_lshl_b32 s59,s46,8
s_add_u32 s59,s57,s59
v_add_u32 v2,s59,v2
s_mov_b32 s60,0x01000100
s_mov_b32 s61,0x03020302
s_waitcnt vmcnt(0)
L_mx_408:
v_max3_u32 v124,v88,v89,v90
v_max_u32 v124,v91,v124
v_cmp_eq_u32 vcc,-1,v124
s_cbranch_vccz L_mxd_409
buffer_load_dwordx4 v[88:91],v0,s[8:11],s58 offen sc1
s_sub_u32 s49,s49,1
s_cbranch_scc1 L_abort2
s_waitcnt vmcnt(0)
s_branch L_mx_408
L_mxd_409:
buffer_load_dwordx4 v[24:27],v11,s[4:7],s63 offen offset:0
buffer_load_dwordx4 v[28:31],v11,s[4:7],s63 offen offset:1024
buffer_load_dwordx4 v[32:35],v11,s[4:7],s63 offen offset:2048
buffer_load_dwordx4 v[36:39],v11,s[4:7],s63 offen offset:3072
v_lshlrev_b32 v96,16,v88
v_and_b32 v97,0xffff0000,v88
v_lshlrev_b32 v98,16,v89
v_and_b32 v99,0xffff0000,v89
v_lshlrev_b32 v100,16,v90
v_and_b32 v101,0xffff0000,v90
v_lshlrev_b32 v102,16,v91
v_and_b32 v103,0xffff0000,v91
v_readfirstlane_b32 s78,v96
s_nop 1
v_pk_add_f32 v[108:109],v[96:97],s[78:79] op_sel_hi:[1,0] neg_lo:[0,1] neg_hi:[0,1]
v_pk_add_f32 v[110:111],v[98:99],s[78:79] op_sel_hi:[1,0] neg_lo:[0,1] neg_hi:[0,1]
v_pk_add_f32 v[112:113],v[100:101],s[78:79] op_sel_hi:[1,0] neg_lo:[0,1] neg_hi:[0,1]
v_pk_add_f32 v[114:115],v[102:103],s[78:79] op_sel_hi:[1,0] neg_lo:[0,1] neg_hi:[0,1]
v_pk_add_f32 v[116:117],v[108:109],v[110:111]
v_pk_mul_f32 v[118:119],v[108:109],v[108:109]
v_pk_add_f32 v[120:121],v[112:113],v[114:115]
v_pk_fma_f32 v[118:119],v[110:111],v[110:111],v[118:119]
v_pk_add_f32 v[116:117],v[116:117],v[120:121]
v_pk_fma_f32 v[118:119],v[112:113],v[112:113],v[118:119]
v_add_f32 v116,v116,v117
v_pk_fma_f32 v[118:119],v[114:115],v[114:115],v[118:119]
v_add_f32 v118,v118,v119
s_nop 1
v_permlane32_swap_b32 v116,v118
v_add_f32 v116,v116,v118
s_nop 1
v_add_f32_dpp v116,v116,v116 row_ror:8 row_mask:0xf bank_mask:0xf
s_nop 1
v_add_f32_dpp v116,v116,v116 row_ror:4 row_mask:0xf bank_mask:0xf
s_nop 1
v_add_f32_dpp v116,v116,v116 row_ror:2 row_mask:0xf bank_mask:0xf
s_nop 1
v_add_f32_dpp v116,v116,v116 row_ror:1 row_mask:0xf bank_mask:0xf
v_mov_b32 v118,v116
s_nop 1
v_permlane16_swap_b32 v116,v118
v_add_f32 v116,v116,v118
v_mul_f32 v116,0x3b000000,v116
v_mov_b32 v118,v116
s_nop 1
v_permlane32_swap_b32 v116,v118
v_fma_f32 v118,-v116,v116,v118
v_add_f32 v116,s78,v116
v_max_f32 v118,0,v118
v_cvt_pk_bf16_f32 v118,v116,v118
v_lshlrev_b32 v116,16,v118
v_and_b32 v118,0xffff0000,v118
v_add_f32 v118,0x3727c5ac,v118
v_cvt_pk_bf16_f32 v118,v118,v118
v_and_b32 v118,0xffff0000,v118
v_sqrt_f32 v118,v118
v_pk_add_f32 v[108:109],v[96:97],v[116:117] op_sel_hi:[1,0] neg_lo:[0,1] neg_hi:[0,1]
v_pk_add_f32 v[110:111],v[98:99],v[116:117] op_sel_hi:[1,0] neg_lo:[0,1] neg_hi:[0,1]
v_pk_add_f32 v[112:113],v[100:101],v[116:117] op_sel_hi:[1,0] neg_lo:[0,1] neg_hi:[0,1]
v_pk_add_f32 v[114:115],v[102:103],v[116:117] op_sel_hi:[1,0] neg_lo:[0,1] neg_hi:[0,1]
v_cvt_pk_bf16_f32 v118,v118,v118
v_and_b32 v118,0xffff0000,v118
v_rcp_f32 v118,v118
v_cvt_pk_bf16_f32 v104,v108,v109
v_cvt_pk_bf16_f32 v105,v110,v111
v_cvt_pk_bf16_f32 v106,v112,v113
v_cvt_pk_bf16_f32 v107,v114,v115
v_lshlrev_b32 v108,16,v104
v_and_b32 v109,0xffff0000,v104
v_lshlrev_b32 v110,16,v105
v_and_b32 v111,0xffff0000,v105
v_lshlrev_b32 v112,16,v106
v_and_b32 v113,0xffff0000,v106
v_lshlrev_b32 v114,16,v107
v_and_b32 v115,0xffff0000,v107
v_pk_mul_f32 v[108:109],v[108:109],v[118:119] op_sel_hi:[1,0]
v_pk_mul_f32 v[110:111],v[110:111],v[118:119] op_sel_hi:[1,0]
v_pk_mul_f32 v[112:113],v[112:113],v[118:119] op_sel_hi:[1,0]
v_pk_mul_f32 v[114:115],v[114:115],v[118:119] op_sel_hi:[1,0]
v_cvt_pk_bf16_f32 v104,v108,v109
v_cvt_pk_bf16_f32 v105,v110,v111
v_cvt_pk_bf16_f32 v106,v112,v113
v_cvt_pk_bf16_f32 v107,v114,v115
v_perm_b32 v88,v104,v104,s60
v_perm_b32 v89,v105,v105,s60
v_perm_b32 v90,v106,v106,s60
v_perm_b32 v91,v107,v107,s60
ds_write_b128 v8,v[88:91]
v_perm_b32 v92,v104,v104,s61
v_perm_b32 v93,v105,v105,s61
v_perm_b32 v94,v106,v106,s61
v_perm_b32 v95,v107,v107,s61
ds_write_b128 v8,v[92:95] offset:1024
s_mov_b32 s58,s57
ds_read_b128 v[88:91],v2 offset:0
ds_read_b128 v[92:95],v2 offset:64
ds_read_b128 v[108:111],v18 offset:0
ds_read_b128 v[112:115],v18 offset:1024
ds_read_b128 v[64:67],v18 offset:2048
ds_read_b128 v[68:71],v18 offset:3072
ds_read_b128 v[72:75],v18 offset:4096
ds_read_b128 v[76:79],v18 offset:5120
ds_read_b128 v[80:83],v18 offset:6144
ds_read_b128 v[84:87],v18 offset:7168
v_mov_b64 v[116:117],0
v_mov_b64 v[118:119],0
s_waitcnt lgkmcnt(8)
v_and_b32 v120,v12,v88
v_and_b32 v121,v13,v88
v_and_b32 v122,v12,v92
v_and_b32 v123,v13,v92
s_waitcnt lgkmcnt(6)
s_nop 0
v_smfmac_f32_16x16x64_bf16 v[116:119],v[120:123],v[108:115],v14
ds_read_b128 v[108:111],v18 offset:8192
ds_read_b128 v[112:115],v18 offset:9216
s_add_u32 s63,s63,4096
buffer_load_dwordx4 v[40:43],v11,s[4:7],s63 offen offset:0
v_and_b32 v124,v12,v89
v_and_b32 v125,v13,v89
v_and_b32 v126,v12,v93
v_and_b32 v127,v13,v93
s_waitcnt lgkmcnt(6)
s_nop 0
v_smfmac_f32_16x16x64_bf16 v[116:119],v[124:127],v[64:71],v14
ds_read_b128 v[64:67],v18 offset:10240
ds_read_b128 v[68:71],v18 offset:11264
buffer_load_dwordx4 v[44:47],v11,s[4:7],s63 offen offset:1024
v_and_b32 v120,v12,v90
v_and_b32 v121,v13,v90
v_and_b32 v122,v12,v94
v_and_b32 v123,v13,v94
s_waitcnt lgkmcnt(6)
s_nop 0
v_smfmac_f32_16x16x64_bf16 v[116:119],v[120:123],v[72:79],v14
ds_read_b128 v[72:75],v18 offset:12288
ds_read_b128 v[76:79],v18 offset:13312
buffer_load_dwordx4 v[48:51],v11,s[4:7],s63 offen offset:2048
v_and_b32 v124,v12,v91
v_and_b32 v125,v13,v91
v_and_b32 v126,v12,v95
v_and_b32 v127,v13,v95
ds_read_b128 v[88:91],v2 offset:16
ds_read_b128 v[92:95],v2 offset:80
s_waitcnt lgkmcnt(8)
v_smfmac_f32_16x16x64_bf16 v[116:119],v[124:127],v[80:87],v14
ds_read_b128 v[80:83],v18 offset:14336
ds_read_b128 v[84:87],v18 offset:15360
buffer_load_dwordx4 v[52:55],v11,s[4:7],s63 offen offset:3072
s_waitcnt lgkmcnt(2)
v_and_b32 v120,v12,v88
v_and_b32 v121,v13,v88
v_and_b32 v122,v12,v92
v_and_b32 v123,v13,v92
s_waitcnt lgkmcnt(8)
s_nop 0
v_smfmac_f32_16x16x64_bf16 v[116:119],v[120:123],v[108:115],v14
ds_read_b128 v[108:111],v18 offset:16384
ds_read_b128 v[112:115],v18 offset:17408
s_add_u32 s63,s63,4096
buffer_load_dwordx4 v[56:59],v11,s[4:7],s63 offen offset:0
v_and_b32 v124,v12,v89
v_and_b32 v125,v13,v89
v_and_b32 v126,v12,v93
v_and_b32 v127,v13,v93
s_waitcnt lgkmcnt(8)
s_nop 0
v_smfmac_f32_16x16x64_bf16 v[116:119],v[124:127],v[64:71],v14
ds_read_b128 v[64:67],v18 offset:18432
ds_read_b128 v[68:71],v18 offset:19456
buffer_load_dwordx4 v[60:63],v11,s[4:7],s63 offen offset:1024
v_and_b32 v120,v12,v90
v_and_b32 v121,v13,v90
v_and_b32 v122,v12,v94
v_and_b32 v123,v13,v94
s_waitcnt lgkmcnt(8)
s_nop 0
v_smfmac_f32_16x16x64_bf16 v[116:119],v[120:123],v[72:79],v14
ds_read_b128 v[72:75],v18 offset:20480
ds_read_b128 v[76:79],v18 offset:21504
v_and_b32 v124,v12,v91
v_and_b32 v125,v13,v91
v_and_b32 v126,v12,v95
v_and_b32 v127,v13,v95
ds_read_b128 v[88:91],v2 offset:32
ds_read_b128 v[92:95],v2 offset:96
s_waitcnt lgkmcnt(8)
v_smfmac_f32_16x16x64_bf16 v[116:119],v[124:127],v[80:87],v14
ds_read_b128 v[80:83],v18 offset:22528
ds_read_b128 v[84:87],v18 offset:23552
s_waitcnt lgkmcnt(2)
v_and_b32 v120,v12,v88
v_and_b32 v121,v13,v88
v_and_b32 v122,v12,v92
v_and_b32 v123,v13,v92
s_waitcnt lgkmcnt(8)
s_nop 0
v_smfmac_f32_16x16x64_bf16 v[116:119],v[120:123],v[108:115],v14
ds_read_b128 v[108:111],v18 offset:24576
ds_read_b128 v[112:115],v18 offset:25600
v_and_b32 v124,v12,v89
v_and_b32 v125,v13,v89
v_and_b32 v126,v12,v93
v_and_b32 v127,v13,v93
s_waitcnt lgkmcnt(8)
s_nop 0
v_smfmac_f32_16x16x64_bf16 v[116:119],v[124:127],v[64:71],v14
ds_read_b128 v[64:67],v18 offset:26624
ds_read_b128 v[68:71],v18 offset:27648
v_and_b32 v120,v12,v90
v_and_b32 v121,v13,v90
v_and_b32 v122,v12,v94
v_and_b32 v123,v13,v94
s_waitcnt lgkmcnt(8)
s_nop 0
v_smfmac_f32_16x16x64_bf16 v[116:119],v[120:123],v[72:79],v14
ds_read_b128 v[72:75],v18 offset:28672
ds_read_b128 v[76:79],v18 offset:29696
v_and_b32 v124,v12,v91
v_and_b32 v125,v13,v91
v_and_b32 v126,v12,v95
v_and_b32 v127,v13,v95
ds_read_b128 v[88:91],v2 offset:48
ds_read_b128 v[92:95],v2 offset:112
s_waitcnt lgkmcnt(8)
v_smfmac_f32_16x16x64_bf16 v[116:119],v[124:127],v[80:87],v14
ds_read_b128 v[80:83],v18 offset:30720
ds_read_b128 v[84:87],v18 offset:31744
s_waitcnt lgkmcnt(2)
v_and_b32 v120,v12,v88
v_and_b32 v121,v13,v88
v_and_b32 v122,v12,v92
v_and_b32 v123,v13,v92
s_waitcnt lgkmcnt(8)
s_nop 0
v_smfmac_f32_16x16x64_bf16 v[116:119],v[120:123],v[108:115],v14
v_and_b32 v124,v12,v89
v_and_b32 v125,v13,v89
v_and_b32 v126,v12,v93
v_and_b32 v127,v13,v93
s_waitcnt lgkmcnt(6)
s_nop 0
v_smfmac_f32_16x16x64_bf16 v[116:119],v[124:127],v[64:71],v14
buffer_load_dwordx4 v[64:67],v11,s[4:7],s63 offen offset:2048
buffer_load_dwordx4 v[68:71],v11,s[4:7],s63 offen offset:3072
v_and_b32 v120,v12,v90
v_and_b32 v121,v13,v90
v_and_b32 v122,v12,v94
v_and_b32 v123,v13,v94
s_waitcnt lgkmcnt(4)
s_nop 0
v_smfmac_f32_16x16x64_bf16 v[116:119],v[120:123],v[72:79],v14
s_add_u32 s63,s63,4096
buffer_load_dwordx4 v[72:75],v11,s[4:7],s63 offen offset:0
buffer_load_dwordx4 v[76:79],v11,s[4:7],s63 offen offset:1024
v_and_b32 v124,v12,v91
v_and_b32 v125,v13,v91
v_and_b32 v126,v12,v95
v_and_b32 v127,v13,v95
s_waitcnt lgkmcnt(0)
s_nop 0
v_smfmac_f32_16x16x64_bf16 v[116:119],v[124:127],v[80:87],v14
buffer_load_dwordx4 v[80:83],v11,s[4:7],s63 offen offset:2048
buffer_load_dwordx4 v[84:87],v11,s[4:7],s63 offen offset:3072
v_lshlrev_b32 v8,5,v9
v_and_b32 v124,1,v10
v_lshl_add_u32 v8,v124,4,v8
v_lshrrev_b32 v124,1,v10
v_lshl_add_u32 v8,v124,11,v8
s_lshl_b32 s60,s46,9
s_add_u32 s60,s60,147456
v_add_u32 v8,s60,v8
ds_write_b128 v8,v[116:119]
v_lshlrev_b32 v8,2,v1
v_add_u32 v8,147456,v8
v_and_b32 v2,1,v1
v_lshrrev_b32 v3,1,v1
v_lshlrev_b32 v3,2,v3
v_lshl_add_u32 v2,v2,7,v3
v_add_u32 v2,s58,v2
v_lshlrev_b32 v3,6,v10
v_add_u32 v3,s58,v3
s_waitcnt lgkmcnt(0)
s_barrier
ds_read2st64_b32 v[88:89],v8 offset0:0 offset1:1
ds_read2st64_b32 v[90:91],v8 offset0:2 offset1:3
ds_read2st64_b32 v[92:93],v8 offset0:4 offset1:5
ds_read2st64_b32 v[94:95],v8 offset0:6 offset1:7
s_waitcnt lgkmcnt(0)
v_pk_add_f32 v[88:89],v[88:89],v[90:91]
v_pk_add_f32 v[92:93],v[92:93],v[94:95]
v_pk_add_f32 v[88:89],v[88:89],v[92:93]
v_cvt_pk_bf16_f32 v88,v88,v88
v_and_b32 v88,0xffff0000,v88
v_cvt_pk_bf16_f32 v89,v89,v89
v_and_b32 v89,0xffff0000,v89
v_mul_f32 v90,0xbfb8aa3b,v88
v_exp_f32 v90,v90
s_nop 0
v_add_f32 v90,1.0,v90
v_rcp_f32 v90,v90
s_nop 0
v_mul_f32 v88,v88,v90
v_cvt_pk_bf16_f32 v88,v88,v88
v_and_b32 v88,0xffff0000,v88
v_mul_f32 v88,v88,v89
v_cvt_pk_bf16_f32 v88,v88,v88
ds_write_b32 v2,v88
ds_read_b128 v[88:91],v3
ds_read_b128 v[108:111],v3 offset:32
ds_read_b128 v[92:95],v3 offset:16
ds_read_b128 v[112:115],v3 offset:48
v_mov_b64 v[116:117],0
v_mov_b64 v[118:119],0
s_waitcnt vmcnt(0) lgkmcnt(0)
v_and_b32 v120,v12,v88
v_and_b32 v121,v13,v88
v_and_b32 v122,v12,v108
v_and_b32 v123,v13,v108
v_and_b32 v124,v12,v89
v_and_b32 v125,v13,v89
v_smfmac_f32_16x16x64_bf16 v[116:119],v[120:123],v[24:31],v14
v_and_b32 v126,v12,v109
v_and_b32 v127,v13,v109
v_and_b32 v120,v12,v90
v_and_b32 v121,v13,v90
v_smfmac_f32_16x16x64_bf16 v[116:119],v[124:127],v[32:39],v14
v_and_b32 v122,v12,v110
v_and_b32 v123,v13,v110
v_and_b32 v124,v12,v91
v_and_b32 v125,v13,v91
v_smfmac_f32_16x16x64_bf16 v[116:119],v[120:123],v[40:47],v14
v_and_b32 v126,v12,v111
v_and_b32 v127,v13,v111
v_and_b32 v120,v12,v92
v_and_b32 v121,v13,v92
v_smfmac_f32_16x16x64_bf16 v[116:119],v[124:127],v[48:55],v14
v_and_b32 v122,v12,v112
v_and_b32 v123,v13,v112
v_and_b32 v124,v12,v93
v_and_b32 v125,v13,v93
v_smfmac_f32_16x16x64_bf16 v[116:119],v[120:123],v[56:63],v14
v_and_b32 v126,v12,v113
v_and_b32 v127,v13,v113
v_and_b32 v120,v12,v94
v_and_b32 v121,v13,v94
v_smfmac_f32_16x16x64_bf16 v[116:119],v[124:127],v[64:71],v14
v_and_b32 v122,v12,v114
v_and_b32 v123,v13,v114
v_and_b32 v124,v12,v95
v_and_b32 v125,v13,v95
v_smfmac_f32_16x16x64_bf16 v[116:119],v[120:123],v[72:79],v14
v_and_b32 v126,v12,v115
v_and_b32 v127,v13,v115
s_nop 1
v_smfmac_f32_16x16x64_bf16 v[116:119],v[124:127],v[80:87],v14
v_lshlrev_b32 v8,4,v9
v_and_b32 v124,1,v10
v_lshl_add_u32 v8,v124,3,v8
v_and_b32 v124,2,v10
v_lshl_add_u32 v8,v124,30,v8
s_lshl_b32 s60,s46,8
s_add_u32 s59,s62,s60
s_nop 0
v_cvt_pk_bf16_f32 v88,v116,v117
v_cvt_pk_bf16_f32 v89,v118,v119
buffer_store_dwordx2 v[88:89],v8,s[8:11],s59 offen sc1
s_lshl_b32 s59,s51,13
s_lshl2_add_u32 s59,s47,s59
s_add_u32 s59,s59,10486912
s_waitcnt vmcnt(0)
s_barrier
s_or_b32 s59,s59,s52
buffer_store_dword v17,off,s[8:11],s59 sc1
s_lshl_b32 s59,s51,13
s_add_u32 s59,s59,10486912
v_and_b32 v124,31,v1
v_lshlrev_b32 v124,2,v124
L_fw_411:
buffer_load_dword v125,v124,s[8:11],s59 offen sc1
s_sub_u32 s49,s49,1
s_cbranch_scc1 L_abort2
s_waitcnt vmcnt(0)
v_cmp_eq_u32 vcc,0,v125
s_cbranch_vccnz L_fw_411
s_add_u32 s63,s65,0
buffer_load_dwordx4 v[24:27],v22,s[8:11],s63 offen sc1
s_add_u32 s63,s65,4096
buffer_load_dwordx4 v[28:31],v22,s[8:11],s63 offen sc1
s_add_u32 s63,s65,8192
buffer_load_dwordx4 v[32:35],v22,s[8:11],s63 offen sc1
s_add_u32 s63,s65,12288
buffer_load_dwordx4 v[36:39],v22,s[8:11],s63 offen sc1
s_add_u32 s63,s65,16384
buffer_load_dwordx4 v[40:43],v22,s[8:11],s63 offen sc1
s_add_u32 s63,s65,20480
buffer_load_dwordx4 v[44:47],v22,s[8:11],s63 offen sc1
s_add_u32 s63,s65,24576
buffer_load_dwordx4 v[48:51],v22,s[8:11],s63 offen sc1
s_add_u32 s63,s65,28672
buffer_load_dwordx4 v[52:55],v22,s[8:11],s63 offen sc1
v_and_b32 v64,15,v1
v_and_b32 v65,1,v1
v_lshlrev_b32 v65,4,v65
v_mov_b32 v66,0x3f80
v_lshlrev_b32 v66,v65,v66
v_lshrrev_b32 v64,1,v64
v_cmp_eq_u32 vcc,0,v64
s_nop 1
v_cndmask_b32 v56,0,v66,vcc
v_cmp_eq_u32 vcc,1,v64
s_nop 1
v_cndmask_b32 v57,0,v66,vcc
v_cmp_eq_u32 vcc,2,v64
s_nop 1
v_cndmask_b32 v58,0,v66,vcc
v_cmp_eq_u32 vcc,3,v64
s_nop 1
v_cndmask_b32 v59,0,v66,vcc
s_waitcnt vmcnt(7)
s_nop 0
v_mfma_f32_16x16x32_bf16 v[60:63],v[56:59],v[24:27],0
s_waitcnt vmcnt(6)
v_mfma_f32_16x16x32_bf16 v[60:63],v[56:59],v[28:31],v[60:63]
s_waitcnt vmcnt(5)
v_mfma_f32_16x16x32_bf16 v[60:63],v[56:59],v[32:35],v[60:63]
s_waitcnt vmcnt(4)
v_mfma_f32_16x16x32_bf16 v[60:63],v[56:59],v[36:39],v[60:63]
s_waitcnt vmcnt(3)
v_mfma_f32_16x16x32_bf16 v[60:63],v[56:59],v[40:43],v[60:63]
s_waitcnt vmcnt(2)
v_mfma_f32_16x16x32_bf16 v[60:63],v[56:59],v[44:47],v[60:63]
s_waitcnt vmcnt(1)
v_mfma_f32_16x16x32_bf16 v[60:63],v[56:59],v[48:51],v[60:63]
s_waitcnt vmcnt(0)
v_mfma_f32_16x16x32_bf16 v[60:63],v[56:59],v[52:55],v[60:63]
s_nop 7
ds_write_b128 v21,v[60:63]
s_waitcnt lgkmcnt(0)
s_barrier
s_cmp_lg_u32 s46,0
s_cbranch_scc1 L_moed_410
v_lshlrev_b32 v56,5,v1
v_add_u32 v56,155648,v56
ds_read_b128 v[24:27],v56
ds_read_b128 v[28:31],v56 offset:16
s_and_b32 s59,s54,0xffff0000
s_xor_b32 s60,s59,0x80000000
s_xor_b32 s61,s59,0xffff0000
s_cmp_lt_i32 s59,0
s_cselect_b32 s59,s60,s61
v_mov_b32 v56,s59
v_mul_f32 v56,0xbfb8aa3b,v56
v_exp_f32 v56,v56
s_nop 0
v_add_f32 v56,1.0,v56
v_rcp_f32 v56,v56
s_nop 0
v_cvt_pk_bf16_f32 v56,v56,v56
v_and_b32 v56,0xffff0000,v56
v_lshlrev_b32 v48,16,v104
v_and_b32 v49,0xffff0000,v104
v_lshlrev_b32 v50,16,v105
v_and_b32 v51,0xffff0000,v105
v_lshlrev_b32 v52,16,v106
v_and_b32 v53,0xffff0000,v106
v_lshlrev_b32 v54,16,v107
v_and_b32 v55,0xffff0000,v107
s_waitcnt lgkmcnt(0)
v_cvt_pk_bf16_f32 v40,v24,v25
v_cvt_pk_bf16_f32 v41,v26,v27
v_cvt_pk_bf16_f32 v42,v28,v29
v_cvt_pk_bf16_f32 v43,v30,v31
v_lshlrev_b32 v24,16,v40
v_and_b32 v25,0xffff0000,v40
v_lshlrev_b32 v26,16,v41
v_and_b32 v27,0xffff0000,v41
v_lshlrev_b32 v28,16,v42
v_and_b32 v29,0xffff0000,v42
v_lshlrev_b32 v30,16,v43
v_and_b32 v31,0xffff0000,v43
v_pk_mul_f32 v[24:25],v[24:25],v[56:57] op_sel_hi:[1,0]
v_pk_mul_f32 v[26:27],v[26:27],v[56:57] op_sel_hi:[1,0]
v_pk_mul_f32 v[28:29],v[28:29],v[56:57] op_sel_hi:[1,0]
v_pk_mul_f32 v[30:31],v[30:31],v[56:57] op_sel_hi:[1,0]
v_cvt_pk_bf16_f32 v40,v24,v25
v_cvt_pk_bf16_f32 v41,v26,v27
v_cvt_pk_bf16_f32 v42,v28,v29
v_cvt_pk_bf16_f32 v43,v30,v31
v_lshlrev_b32 v24,16,v40
v_and_b32 v25,0xffff0000,v40
v_lshlrev_b32 v26,16,v41
v_and_b32 v27,0xffff0000,v41
v_lshlrev_b32 v28,16,v42
v_and_b32 v29,0xffff0000,v42
v_lshlrev_b32 v30,16,v43
v_and_b32 v31,0xffff0000,v43
v_pk_add_f32 v[24:25],v[24:25],v[48:49]
v_pk_add_f32 v[26:27],v[26:27],v[50:51]
v_pk_add_f32 v[28:29],v[28:29],v[52:53]
v_pk_add_f32 v[30:31],v[30:31],v[54:55]
v_cvt_pk_bf16_f32 v40,v24,v25
v_cvt_pk_bf16_f32 v41,v26,v27
v_cvt_pk_bf16_f32 v42,v28,v29
v_cvt_pk_bf16_f32 v43,v30,v31
v_lshlrev_b32 v24,16,v40
v_and_b32 v25,0xffff0000,v40
v_lshlrev_b32 v26,16,v41
v_and_b32 v27,0xffff0000,v41
v_lshlrev_b32 v28,16,v42
v_and_b32 v29,0xffff0000,v42
v_lshlrev_b32 v30,16,v43
v_and_b32 v31,0xffff0000,v43
v_pk_add_f32 v[96:97],v[96:97],v[24:25]
v_pk_add_f32 v[98:99],v[98:99],v[26:27]
v_pk_add_f32 v[100:101],v[100:101],v[28:29]
v_pk_add_f32 v[102:103],v[102:103],v[30:31]
v_cvt_pk_bf16_f32 v80,v96,v97
v_cvt_pk_bf16_f32 v81,v98,v99
v_cvt_pk_bf16_f32 v82,v100,v101
v_cvt_pk_bf16_f32 v83,v102,v103
v_lshlrev_b32 v96,16,v80
v_and_b32 v97,0xffff0000,v80
v_lshlrev_b32 v98,16,v81
v_and_b32 v99,0xffff0000,v81
v_lshlrev_b32 v100,16,v82
v_and_b32 v101,0xffff0000,v82
v_lshlrev_b32 v102,16,v83
v_and_b32 v103,0xffff0000,v83
v_readfirstlane_b32 s78,v96
s_nop 1
v_pk_add_f32 v[58:59],v[96:97],s[78:79] op_sel_hi:[1,0] neg_lo:[0,1] neg_hi:[0,1]
v_pk_add_f32 v[60:61],v[98:99],s[78:79] op_sel_hi:[1,0] neg_lo:[0,1] neg_hi:[0,1]
v_pk_add_f32 v[62:63],v[100:101],s[78:79] op_sel_hi:[1,0] neg_lo:[0,1] neg_hi:[0,1]
v_pk_add_f32 v[64:65],v[102:103],s[78:79] op_sel_hi:[1,0] neg_lo:[0,1] neg_hi:[0,1]
v_pk_add_f32 v[66:67],v[58:59],v[60:61]
v_pk_mul_f32 v[68:69],v[58:59],v[58:59]
v_pk_add_f32 v[70:71],v[62:63],v[64:65]
v_pk_fma_f32 v[68:69],v[60:61],v[60:61],v[68:69]
v_pk_add_f32 v[66:67],v[66:67],v[70:71]
v_pk_fma_f32 v[68:69],v[62:63],v[62:63],v[68:69]
v_add_f32 v66,v66,v67
v_pk_fma_f32 v[68:69],v[64:65],v[64:65],v[68:69]
v_add_f32 v68,v68,v69
s_nop 1
v_permlane32_swap_b32 v66,v68
v_add_f32 v66,v66,v68
s_nop 1
v_add_f32_dpp v66,v66,v66 row_ror:8 row_mask:0xf bank_mask:0xf
s_nop 1
v_add_f32_dpp v66,v66,v66 row_ror:4 row_mask:0xf bank_mask:0xf
s_nop 1
v_add_f32_dpp v66,v66,v66 row_ror:2 row_mask:0xf bank_mask:0xf
s_nop 1
v_add_f32_dpp v66,v66,v66 row_ror:1 row_mask:0xf bank_mask:0xf
v_mov_b32 v68,v66
s_nop 1
v_permlane16_swap_b32 v66,v68
v_add_f32 v66,v66,v68
v_mul_f32 v66,0x3b000000,v66
v_mov_b32 v68,v66
s_nop 1
v_permlane32_swap_b32 v66,v68
v_fma_f32 v68,-v66,v66,v68
v_add_f32 v66,s78,v66
v_max_f32 v68,0,v68
v_cvt_pk_bf16_f32 v68,v66,v68
v_lshlrev_b32 v66,16,v68
v_and_b32 v68,0xffff0000,v68
v_add_f32 v68,0x3727c5ac,v68
v_cvt_pk_bf16_f32 v68,v68,v68
v_and_b32 v68,0xffff0000,v68
v_sqrt_f32 v68,v68
v_pk_add_f32 v[58:59],v[96:97],v[66:67] op_sel_hi:[1,0] neg_lo:[0,1] neg_hi:[0,1]
v_pk_add_f32 v[60:61],v[98:99],v[66:67] op_sel_hi:[1,0] neg_lo:[0,1] neg_hi:[0,1]
v_pk_add_f32 v[62:63],v[100:101],v[66:67] op_sel_hi:[1,0] neg_lo:[0,1] neg_hi:[0,1]
v_pk_add_f32 v[64:65],v[102:103],v[66:67] op_sel_hi:[1,0] neg_lo:[0,1] neg_hi:[0,1]
v_cvt_pk_bf16_f32 v68,v68,v68
v_and_b32 v68,0xffff0000,v68
v_rcp_f32 v68,v68
v_cvt_pk_bf16_f32 v84,v58,v59
v_cvt_pk_bf16_f32 v85,v60,v61
v_cvt_pk_bf16_f32 v86,v62,v63
v_cvt_pk_bf16_f32 v87,v64,v65
v_lshlrev_b32 v58,16,v84
v_and_b32 v59,0xffff0000,v84
v_lshlrev_b32 v60,16,v85
v_and_b32 v61,0xffff0000,v85
v_lshlrev_b32 v62,16,v86
v_and_b32 v63,0xffff0000,v86
v_lshlrev_b32 v64,16,v87
v_and_b32 v65,0xffff0000,v87
v_pk_mul_f32 v[58:59],v[58:59],v[68:69] op_sel_hi:[1,0]
v_pk_mul_f32 v[60:61],v[60:61],v[68:69] op_sel_hi:[1,0]
v_pk_mul_f32 v[62:63],v[62:63],v[68:69] op_sel_hi:[1,0]
v_pk_mul_f32 v[64:65],v[64:65],v[68:69] op_sel_hi:[1,0]
v_cvt_pk_bf16_f32 v84,v58,v59
v_cvt_pk_bf16_f32 v85,v60,v61
v_cvt_pk_bf16_f32 v86,v62,v63
v_cvt_pk_bf16_f32 v87,v64,v65
s_lshl_b32 s58,s51,10
s_add_u32 s58,s58,11272192
s_add_u32 s59,s58,65536
s_cmp_eq_u32 s47,0
s_cselect_b32 s59,s59,0x80000000
s_add_u32 s57,s56,98566144
buffer_store_dwordx4 v[84:87],v0,s[8:11],s59 offen sc1
buffer_store_dwordx4 v[80:83],v0,s[8:11],s58 offen sc1
buffer_store_dwordx4 v[84:87],v0,s[8:11],s57 offen sc1
L_moed_410:
s_barrier
L_mo_397:
s_mov_b32 s77,-1
s_cmp_lt_u32 s31,64
s_cbranch_scc1 L_mo_393
s_cmp_eq_u32 s86,0
s_cbranch_scc1 L_mo_406
L_mo_399:
s_andn2_b32 s51,0x7ff,s54
s_lshr_b32 s51,s51,5
s_andn2_b32 s56,31,s54
v_lshrrev_b32 v2,10,v20
v_add_u32 v3,16,v2
v_add_u32 v8,96468992,v20
v_cmp_eq_u32 vcc,s56,v2
s_nop 1
v_cndmask_b32 v2,v20,v8,vcc
v_cmp_eq_u32 vcc,s56,v3
s_nop 1
v_cndmask_b32 v3,v20,v8,vcc
s_waitcnt vmcnt(0)
s_lshl_b32 s59,s51,13
s_add_u32 s59,s59,10487552
s_cmp_lg_u32 s46,0
s_cbranch_scc1 L_fd_415
v_and_b32 v124,31,v1
v_lshlrev_b32 v124,2,v124
s_branch L_ff_416
L_fw_414:
s_sleep 2
L_ff_416:
buffer_load_dword v125,v124,s[8:11],s59 offen sc1
s_sub_u32 s49,s49,1
s_cbranch_scc1 L_abort2
s_waitcnt vmcnt(0)
v_cmp_eq_u32 vcc,0,v125
s_cbranch_vccnz L_fw_414
L_fd_415:
s_barrier
s_or_b32 s72,s72,s52
buffer_store_dword v17,off,s[8:11],s72 sc1
s_lshl_b32 s66,s51,15
s_add_u32 s66,s66,2097152
s_add_u32 s67,s66,16384
s_add_u32 m0,s50,131072
s_nop 0
buffer_load_dwordx4 v2,s[8:11],s66 offen offset:0 sc1 lds
s_add_u32 m0,s50,135168
s_nop 0
buffer_load_dwordx4 v3,s[8:11],s67 offen offset:0 sc1 lds
s_add_u32 m0,s50,139008
s_nop 0
buffer_load_dwordx4 v2,s[8:11],s66 offen offset:256 sc1 lds
s_add_u32 m0,s50,143104
s_nop 0
buffer_load_dwordx4 v3,s[8:11],s67 offen offset:256 sc1 lds
s_add_u32 m0,s50,146944
s_nop 0
buffer_load_dwordx4 v2,s[8:11],s66 offen offset:512 sc1 lds
s_add_u32 m0,s50,151040
s_nop 0
buffer_load_dwordx4 v3,s[8:11],s67 offen offset:512 sc1 lds
s_waitcnt vmcnt(4)
s_barrier
ds_read_b128 v[104:107],v4 offset:0
ds_read_b128 v[108:111],v4 offset:4096
ds_read_b128 v[112:115],v5 offset:0
ds_read_b128 v[116:119],v5 offset:4096
s_add_u32 m0,s50,154880
s_nop 0
buffer_load_dwordx4 v2,s[8:11],s66 offen offset:768 sc1 lds
s_add_u32 m0,s50,158976
s_nop 0
buffer_load_dwordx4 v3,s[8:11],s67 offen offset:768 sc1 lds
s_waitcnt lgkmcnt(2)
v_mfma_f32_16x16x32_bf16 v[24:27],a[128:131],v[104:107],0
ds_read_b128 v[120:123],v6 offset:0
v_mfma_f32_16x16x32_bf16 v[40:43],v[104:107],v[128:131],0
s_lshl_b32 s58,s51,5
v_mfma_f32_16x16x32_bf16 v[28:31],a[128:131],v[108:111],0
ds_read_b128 v[124:127],v6 offset:4096
v_mfma_f32_16x16x32_bf16 v[44:47],v[108:111],v[128:131],0
s_add_u32 s58,s58,s47
v_mfma_f32_16x16x32_bf16 v[32:35],a[136:139],v[104:107],0
s_mul_i32 s58,s58,24576
v_mfma_f32_16x16x32_bf16 v[48:51],v[104:107],v[136:139],0
s_add_u32 s58,s58,201326592
v_mfma_f32_16x16x32_bf16 v[36:39],a[136:139],v[108:111],0
s_add_u32 s61,s58,s50
v_mfma_f32_16x16x32_bf16 v[52:55],v[108:111],v[136:139],0
s_add_u32 s62,s61,4096
s_waitcnt lgkmcnt(2)
v_mfma_f32_16x16x32_bf16 v[24:27],a[132:135],v[112:115],v[24:27]
ds_read_b128 v[104:107],v7 offset:0
v_mfma_f32_16x16x32_bf16 v[40:43],v[112:115],v[132:135],v[40:43]
s_add_u32 s63,s61,16384
v_mfma_f32_16x16x32_bf16 v[28:31],a[132:135],v[116:119],v[28:31]
ds_read_b128 v[108:111],v7 offset:4096
v_mfma_f32_16x16x32_bf16 v[44:47],v[116:119],v[132:135],v[44:47]
s_add_u32 s64,s61,20480
v_mfma_f32_16x16x32_bf16 v[32:35],a[140:143],v[112:115],v[32:35]
s_add_u32 s65,s61,s50
v_mfma_f32_16x16x32_bf16 v[48:51],v[112:115],v[140:143],v[48:51]
s_add_u32 s65,s65,8192
v_mfma_f32_16x16x32_bf16 v[36:39],a[140:143],v[116:119],v[36:39]
v_mfma_f32_16x16x32_bf16 v[52:55],v[116:119],v[140:143],v[52:55]
s_waitcnt vmcnt(4)
s_barrier
s_waitcnt lgkmcnt(2)
v_mfma_f32_16x16x32_bf16 v[24:27],a[144:147],v[120:123],v[24:27]
ds_read_b128 v[112:115],v4 offset:8192
v_mfma_f32_16x16x32_bf16 v[40:43],v[120:123],v[144:147],v[40:43]
v_mfma_f32_16x16x32_bf16 v[28:31],a[144:147],v[124:127],v[28:31]
ds_read_b128 v[116:119],v4 offset:12288
v_mfma_f32_16x16x32_bf16 v[44:47],v[124:127],v[144:147],v[44:47]
v_mfma_f32_16x16x32_bf16 v[32:35],a[152:155],v[120:123],v[32:35]
v_mfma_f32_16x16x32_bf16 v[48:51],v[120:123],v[152:155],v[48:51]
v_mfma_f32_16x16x32_bf16 v[36:39],a[152:155],v[124:127],v[36:39]
v_mfma_f32_16x16x32_bf16 v[52:55],v[124:127],v[152:155],v[52:55]
s_waitcnt lgkmcnt(2)
v_mfma_f32_16x16x32_bf16 v[24:27],a[148:151],v[104:107],v[24:27]
ds_read_b128 v[120:123],v5 offset:8192
v_mfma_f32_16x16x32_bf16 v[40:43],v[104:107],v[148:151],v[40:43]
v_mfma_f32_16x16x32_bf16 v[28:31],a[148:151],v[108:111],v[28:31]
ds_read_b128 v[124:127],v5 offset:12288
v_mfma_f32_16x16x32_bf16 v[44:47],v[108:111],v[148:151],v[44:47]
v_mfma_f32_16x16x32_bf16 v[32:35],a[156:159],v[104:107],v[32:35]
v_mfma_f32_16x16x32_bf16 v[48:51],v[104:107],v[156:159],v[48:51]
v_mfma_f32_16x16x32_bf16 v[36:39],a[156:159],v[108:111],v[36:39]
v_mfma_f32_16x16x32_bf16 v[52:55],v[108:111],v[156:159],v[52:55]
s_waitcnt lgkmcnt(2)
v_mfma_f32_16x16x32_bf16 v[24:27],a[160:163],v[112:115],v[24:27]
ds_read_b128 v[104:107],v6 offset:8192
v_mfma_f32_16x16x32_bf16 v[40:43],v[112:115],v[160:163],v[40:43]
v_mfma_f32_16x16x32_bf16 v[28:31],a[160:163],v[116:119],v[28:31]
ds_read_b128 v[108:111],v6 offset:12288
v_mfma_f32_16x16x32_bf16 v[44:47],v[116:119],v[160:163],v[44:47]
v_mfma_f32_16x16x32_bf16 v[32:35],a[168:171],v[112:115],v[32:35]
v_mfma_f32_16x16x32_bf16 v[48:51],v[112:115],v[168:171],v[48:51]
v_mfma_f32_16x16x32_bf16 v[36:39],a[168:171],v[116:119],v[36:39]
v_mfma_f32_16x16x32_bf16 v[52:55],v[116:119],v[168:171],v[52:55]
s_waitcnt lgkmcnt(2)
v_mfma_f32_16x16x32_bf16 v[24:27],a[164:167],v[120:123],v[24:27]
ds_read_b128 v[112:115],v7 offset:8192
v_mfma_f32_16x16x32_bf16 v[40:43],v[120:123],v[164:167],v[40:43]
v_mfma_f32_16x16x32_bf16 v[28:31],a[164:167],v[124:127],v[28:31]
ds_read_b128 v[116:119],v7 offset:12288
v_mfma_f32_16x16x32_bf16 v[44:47],v[124:127],v[164:167],v[44:47]
v_mfma_f32_16x16x32_bf16 v[32:35],a[172:175],v[120:123],v[32:35]
v_mfma_f32_16x16x32_bf16 v[48:51],v[120:123],v[172:175],v[48:51]
v_mfma_f32_16x16x32_bf16 v[36:39],a[172:175],v[124:127],v[36:39]
v_mfma_f32_16x16x32_bf16 v[52:55],v[124:127],v[172:175],v[52:55]
s_waitcnt vmcnt(2)
s_barrier
s_waitcnt lgkmcnt(2)
v_mfma_f32_16x16x32_bf16 v[24:27],a[176:179],v[104:107],v[24:27]
ds_read_b128 v[120:123],v4 offset:16384
v_mfma_f32_16x16x32_bf16 v[40:43],v[104:107],v[176:179],v[40:43]
v_mfma_f32_16x16x32_bf16 v[28:31],a[176:179],v[108:111],v[28:31]
ds_read_b128 v[124:127],v4 offset:20480
v_mfma_f32_16x16x32_bf16 v[44:47],v[108:111],v[176:179],v[44:47]
v_mfma_f32_16x16x32_bf16 v[32:35],a[184:187],v[104:107],v[32:35]
v_mfma_f32_16x16x32_bf16 v[48:51],v[104:107],v[184:187],v[48:51]
v_mfma_f32_16x16x32_bf16 v[36:39],a[184:187],v[108:111],v[36:39]
v_mfma_f32_16x16x32_bf16 v[52:55],v[108:111],v[184:187],v[52:55]
s_waitcnt lgkmcnt(2)
v_mfma_f32_16x16x32_bf16 v[24:27],a[180:183],v[112:115],v[24:27]
ds_read_b128 v[104:107],v5 offset:16384
v_mfma_f32_16x16x32_bf16 v[40:43],v[112:115],v[180:183],v[40:43]
v_mfma_f32_16x16x32_bf16 v[28:31],a[180:183],v[116:119],v[28:31]
ds_read_b128 v[108:111],v5 offset:20480
v_mfma_f32_16x16x32_bf16 v[44:47],v[116:119],v[180:183],v[44:47]
v_mfma_f32_16x16x32_bf16 v[32:35],a[188:191],v[112:115],v[32:35]
v_mfma_f32_16x16x32_bf16 v[48:51],v[112:115],v[188:191],v[48:51]
v_mfma_f32_16x16x32_bf16 v[36:39],a[188:191],v[116:119],v[36:39]
v_mfma_f32_16x16x32_bf16 v[52:55],v[116:119],v[188:191],v[52:55]
s_waitcnt lgkmcnt(2)
v_mfma_f32_16x16x32_bf16 v[24:27],a[192:195],v[120:123],v[24:27]
ds_read_b128 v[112:115],v6 offset:16384
v_mfma_f32_16x16x32_bf16 v[40:43],v[120:123],v[192:195],v[40:43]
v_mfma_f32_16x16x32_bf16 v[28:31],a[192:195],v[124:127],v[28:31]
ds_read_b128 v[116:119],v6 offset:20480
v_mfma_f32_16x16x32_bf16 v[44:47],v[124:127],v[192:195],v[44:47]
v_mfma_f32_16x16x32_bf16 v[32:35],a[200:203],v[120:123],v[32:35]
v_mfma_f32_16x16x32_bf16 v[48:51],v[120:123],v[200:203],v[48:51]
v_mfma_f32_16x16x32_bf16 v[36:39],a[200:203],v[124:127],v[36:39]
v_mfma_f32_16x16x32_bf16 v[52:55],v[124:127],v[200:203],v[52:55]
s_waitcnt lgkmcnt(2)
v_mfma_f32_16x16x32_bf16 v[24:27],a[196:199],v[104:107],v[24:27]
ds_read_b128 v[120:123],v7 offset:16384
v_mfma_f32_16x16x32_bf16 v[40:43],v[104:107],v[196:199],v[40:43]
v_mfma_f32_16x16x32_bf16 v[28:31],a[196:199],v[108:111],v[28:31]
ds_read_b128 v[124:127],v7 offset:20480
v_mfma_f32_16x16x32_bf16 v[44:47],v[108:111],v[196:199],v[44:47]
v_mfma_f32_16x16x32_bf16 v[32:35],a[204:207],v[104:107],v[32:35]
v_mfma_f32_16x16x32_bf16 v[48:51],v[104:107],v[204:207],v[48:51]
v_mfma_f32_16x16x32_bf16 v[36:39],a[204:207],v[108:111],v[36:39]
v_mfma_f32_16x16x32_bf16 v[52:55],v[108:111],v[204:207],v[52:55]
s_waitcnt vmcnt(0)
s_barrier
s_waitcnt lgkmcnt(2)
v_mfma_f32_16x16x32_bf16 v[24:27],a[208:211],v[112:115],v[24:27]
ds_read_b128 v[104:107],v4 offset:24576
v_mfma_f32_16x16x32_bf16 v[40:43],v[112:115],v[208:211],v[40:43]
v_mfma_f32_16x16x32_bf16 v[28:31],a[208:211],v[116:119],v[28:31]
ds_read_b128 v[108:111],v4 offset:28672
v_mfma_f32_16x16x32_bf16 v[44:47],v[116:119],v[208:211],v[44:47]
v_mfma_f32_16x16x32_bf16 v[32:35],a[216:219],v[112:115],v[32:35]
v_mfma_f32_16x16x32_bf16 v[48:51],v[112:115],v[216:219],v[48:51]
v_mfma_f32_16x16x32_bf16 v[36:39],a[216:219],v[116:119],v[36:39]
v_mfma_f32_16x16x32_bf16 v[52:55],v[116:119],v[216:219],v[52:55]
s_waitcnt lgkmcnt(2)
v_mfma_f32_16x16x32_bf16 v[24:27],a[212:215],v[120:123],v[24:27]
ds_read_b128 v[112:115],v5 offset:24576
v_mfma_f32_16x16x32_bf16 v[40:43],v[120:123],v[212:215],v[40:43]
v_mfma_f32_16x16x32_bf16 v[28:31],a[212:215],v[124:127],v[28:31]
ds_read_b128 v[116:119],v5 offset:28672
v_mfma_f32_16x16x32_bf16 v[44:47],v[124:127],v[212:215],v[44:47]
v_mfma_f32_16x16x32_bf16 v[32:35],a[220:223],v[120:123],v[32:35]
v_mfma_f32_16x16x32_bf16 v[48:51],v[120:123],v[220:223],v[48:51]
v_mfma_f32_16x16x32_bf16 v[36:39],a[220:223],v[124:127],v[36:39]
v_mfma_f32_16x16x32_bf16 v[52:55],v[124:127],v[220:223],v[52:55]
s_waitcnt lgkmcnt(2)
v_mfma_f32_16x16x32_bf16 v[24:27],a[224:227],v[104:107],v[24:27]
ds_read_b128 v[120:123],v6 offset:24576
v_mfma_f32_16x16x32_bf16 v[40:43],v[104:107],v[224:227],v[40:43]
v_mfma_f32_16x16x32_bf16 v[28:31],a[224:227],v[108:111],v[28:31]
ds_read_b128 v[124:127],v6 offset:28672
v_mfma_f32_16x16x32_bf16 v[44:47],v[108:111],v[224:227],v[44:47]
v_mfma_f32_16x16x32_bf16 v[32:35],a[232:235],v[104:107],v[32:35]
v_mfma_f32_16x16x32_bf16 v[48:51],v[104:107],v[232:235],v[48:51]
v_mfma_f32_16x16x32_bf16 v[36:39],a[232:235],v[108:111],v[36:39]
v_mfma_f32_16x16x32_bf16 v[52:55],v[108:111],v[232:235],v[52:55]
s_waitcnt lgkmcnt(2)
v_mfma_f32_16x16x32_bf16 v[24:27],a[228:231],v[112:115],v[24:27]
ds_read_b128 v[104:107],v7 offset:24576
v_mfma_f32_16x16x32_bf16 v[40:43],v[112:115],v[228:231],v[40:43]
v_mfma_f32_16x16x32_bf16 v[28:31],a[228:231],v[116:119],v[28:31]
ds_read_b128 v[108:111],v7 offset:28672
v_mfma_f32_16x16x32_bf16 v[44:47],v[116:119],v[228:231],v[44:47]
v_mfma_f32_16x16x32_bf16 v[32:35],a[236:239],v[112:115],v[32:35]
v_mfma_f32_16x16x32_bf16 v[48:51],v[112:115],v[236:239],v[48:51]
v_mfma_f32_16x16x32_bf16 v[36:39],a[236:239],v[116:119],v[36:39]
v_mfma_f32_16x16x32_bf16 v[52:55],v[116:119],v[236:239],v[52:55]
s_waitcnt lgkmcnt(2)
v_mfma_f32_16x16x32_bf16 v[24:27],a[240:243],v[120:123],v[24:27]
ds_read_b128 v[112:115],v4 offset:0
v_mfma_f32_16x16x32_bf16 v[40:43],v[120:123],v[240:243],v[40:43]
v_mfma_f32_16x16x32_bf16 v[28:31],a[240:243],v[124:127],v[28:31]
ds_read_b128 v[116:119],v4 offset:4096
v_mfma_f32_16x16x32_bf16 v[44:47],v[124:127],v[240:243],v[44:47]
v_mfma_f32_16x16x32_bf16 v[32:35],a[248:251],v[120:123],v[32:35]
v_mfma_f32_16x16x32_bf16 v[48:51],v[120:123],v[248:251],v[48:51]
v_mfma_f32_16x16x32_bf16 v[36:39],a[248:251],v[124:127],v[36:39]
v_mfma_f32_16x16x32_bf16 v[52:55],v[124:127],v[248:251],v[52:55]
s_waitcnt lgkmcnt(2)
v_mfma_f32_16x16x32_bf16 v[24:27],a[244:247],v[104:107],v[24:27]
ds_read_b128 v[120:123],v5 offset:0
v_mfma_f32_16x16x32_bf16 v[40:43],v[104:107],v[244:247],v[40:43]
v_mfma_f32_16x16x32_bf16 v[28:31],a[244:247],v[108:111],v[28:31]
ds_read_b128 v[124:127],v5 offset:4096
v_mfma_f32_16x16x32_bf16 v[44:47],v[108:111],v[244:247],v[44:47]
v_mfma_f32_16x16x32_bf16 v[32:35],a[252:255],v[104:107],v[32:35]
v_mfma_f32_16x16x32_bf16 v[48:51],v[104:107],v[252:255],v[48:51]
v_mfma_f32_16x16x32_bf16 v[36:39],a[252:255],v[108:111],v[36:39]
v_mfma_f32_16x16x32_bf16 v[52:55],v[108:111],v[252:255],v[52:55]
s_waitcnt lgkmcnt(2)
v_mfma_f32_16x16x32_bf16 v[88:91],a[0:3],v[112:115],0
ds_read_b128 v[104:107],v6 offset:0
v_mfma_f32_16x16x32_bf16 v[92:95],a[0:3],v[116:119],0
v_mfma_f32_16x16x32_bf16 v[96:99],a[8:11],v[112:115],0
ds_read_b128 v[108:111],v6 offset:4096
v_cvt_pk_bf16_f32 v56,v24,v32
v_cvt_pk_bf16_f32 v57,v25,v33
v_mfma_f32_16x16x32_bf16 v[100:103],a[8:11],v[116:119],0
v_cvt_pk_bf16_f32 v58,v26,v34
v_cvt_pk_bf16_f32 v59,v27,v35
s_waitcnt lgkmcnt(2)
v_mfma_f32_16x16x32_bf16 v[88:91],a[4:7],v[120:123],v[88:91]
ds_read_b128 v[112:115],v7 offset:0
v_mfma_f32_16x16x32_bf16 v[92:95],a[4:7],v[124:127],v[92:95]
buffer_store_dwordx4 v[56:59],v0,s[8:11],s61 offen sc1
v_cvt_pk_bf16_f32 v60,v28,v36
v_cvt_pk_bf16_f32 v61,v29,v37
v_mfma_f32_16x16x32_bf16 v[96:99],a[12:15],v[120:123],v[96:99]
ds_read_b128 v[116:119],v7 offset:4096
v_cvt_pk_bf16_f32 v62,v30,v38
v_cvt_pk_bf16_f32 v63,v31,v39
v_mfma_f32_16x16x32_bf16 v[100:103],a[12:15],v[124:127],v[100:103]
buffer_store_dwordx4 v[60:63],v0,s[8:11],s62 offen sc1
v_cvt_pk_bf16_f32 v64,v40,v41
v_cvt_pk_bf16_f32 v65,v42,v43
s_waitcnt lgkmcnt(2)
v_mfma_f32_16x16x32_bf16 v[88:91],a[16:19],v[104:107],v[88:91]
ds_read_b128 v[120:123],v4 offset:8192
v_cvt_pk_bf16_f32 v66,v44,v45
v_cvt_pk_bf16_f32 v67,v46,v47
v_mfma_f32_16x16x32_bf16 v[92:95],a[16:19],v[108:111],v[92:95]
buffer_store_dwordx4 v[64:67],v0,s[8:11],s65 offen offset:0 sc1
v_cvt_pk_bf16_f32 v68,v48,v49
v_cvt_pk_bf16_f32 v69,v50,v51
v_mfma_f32_16x16x32_bf16 v[96:99],a[24:27],v[104:107],v[96:99]
ds_read_b128 v[124:127],v4 offset:12288
v_cvt_pk_bf16_f32 v70,v52,v53
v_cvt_pk_bf16_f32 v71,v54,v55
v_mfma_f32_16x16x32_bf16 v[100:103],a[24:27],v[108:111],v[100:103]
buffer_store_dwordx4 v[68:71],v0,s[8:11],s65 offen offset:1024 sc1
s_waitcnt lgkmcnt(2)
v_mfma_f32_16x16x32_bf16 v[88:91],a[20:23],v[112:115],v[88:91]
ds_read_b128 v[104:107],v5 offset:8192
v_mfma_f32_16x16x32_bf16 v[92:95],a[20:23],v[116:119],v[92:95]
v_mfma_f32_16x16x32_bf16 v[96:99],a[28:31],v[112:115],v[96:99]
ds_read_b128 v[108:111],v5 offset:12288
v_mfma_f32_16x16x32_bf16 v[100:103],a[28:31],v[116:119],v[100:103]
s_waitcnt lgkmcnt(2)
v_mfma_f32_16x16x32_bf16 v[88:91],a[32:35],v[120:123],v[88:91]
ds_read_b128 v[112:115],v6 offset:8192
v_mfma_f32_16x16x32_bf16 v[92:95],a[32:35],v[124:127],v[92:95]
v_mfma_f32_16x16x32_bf16 v[96:99],a[40:43],v[120:123],v[96:99]
ds_read_b128 v[116:119],v6 offset:12288
v_mfma_f32_16x16x32_bf16 v[100:103],a[40:43],v[124:127],v[100:103]
s_waitcnt lgkmcnt(2)
v_mfma_f32_16x16x32_bf16 v[88:91],a[36:39],v[104:107],v[88:91]
ds_read_b128 v[120:123],v7 offset:8192
v_mfma_f32_16x16x32_bf16 v[92:95],a[36:39],v[108:111],v[92:95]
v_mfma_f32_16x16x32_bf16 v[96:99],a[44:47],v[104:107],v[96:99]
ds_read_b128 v[124:127],v7 offset:12288
v_mfma_f32_16x16x32_bf16 v[100:103],a[44:47],v[108:111],v[100:103]
s_waitcnt lgkmcnt(2)
v_mfma_f32_16x16x32_bf16 v[88:91],a[48:51],v[112:115],v[88:91]
ds_read_b128 v[104:107],v4 offset:16384
v_mfma_f32_16x16x32_bf16 v[92:95],a[48:51],v[116:119],v[92:95]
v_mfma_f32_16x16x32_bf16 v[96:99],a[56:59],v[112:115],v[96:99]
ds_read_b128 v[108:111],v4 offset:20480
v_mfma_f32_16x16x32_bf16 v[100:103],a[56:59],v[116:119],v[100:103]
s_waitcnt lgkmcnt(2)
v_mfma_f32_16x16x32_bf16 v[88:91],a[52:55],v[120:123],v[88:91]
ds_read_b128 v[112:115],v5 offset:16384
v_mfma_f32_16x16x32_bf16 v[92:95],a[52:55],v[124:127],v[92:95]
v_mfma_f32_16x16x32_bf16 v[96:99],a[60:63],v[120:123],v[96:99]
ds_read_b128 v[116:119],v5 offset:20480
v_mfma_f32_16x16x32_bf16 v[100:103],a[60:63],v[124:127],v[100:103]
s_waitcnt lgkmcnt(2)
v_mfma_f32_16x16x32_bf16 v[88:91],a[64:67],v[104:107],v[88:91]
ds_read_b128 v[120:123],v6 offset:16384
v_mfma_f32_16x16x32_bf16 v[92:95],a[64:67],v[108:111],v[92:95]
v_mfma_f32_16x16x32_bf16 v[96:99],a[72:75],v[104:107],v[96:99]
ds_read_b128 v[124:127],v6 offset:20480
v_mfma_f32_16x16x32_bf16 v[100:103],a[72:75],v[108:111],v[100:103]
s_waitcnt lgkmcnt(2)
v_mfma_f32_16x16x32_bf16 v[88:91],a[68:71],v[112:115],v[88:91]
ds_read_b128 v[104:107],v7 offset:16384
v_mfma_f32_16x16x32_bf16 v[92:95],a[68:71],v[116:119],v[92:95]
v_mfma_f32_16x16x32_bf16 v[96:99],a[76:79],v[112:115],v[96:99]
ds_read_b128 v[108:111],v7 offset:20480
v_mfma_f32_16x16x32_bf16 v[100:103],a[76:79],v[116:119],v[100:103]
s_waitcnt lgkmcnt(2)
v_mfma_f32_16x16x32_bf16 v[88:91],a[80:83],v[120:123],v[88:91]
ds_read_b128 v[112:115],v4 offset:24576
v_mfma_f32_16x16x32_bf16 v[92:95],a[80:83],v[124:127],v[92:95]
v_mfma_f32_16x16x32_bf16 v[96:99],a[88:91],v[120:123],v[96:99]
ds_read_b128 v[116:119],v4 offset:28672
v_mfma_f32_16x16x32_bf16 v[100:103],a[88:91],v[124:127],v[100:103]
s_waitcnt lgkmcnt(2)
v_mfma_f32_16x16x32_bf16 v[88:91],a[84:87],v[104:107],v[88:91]
ds_read_b128 v[120:123],v5 offset:24576
v_mfma_f32_16x16x32_bf16 v[92:95],a[84:87],v[108:111],v[92:95]
v_mfma_f32_16x16x32_bf16 v[96:99],a[92:95],v[104:107],v[96:99]
ds_read_b128 v[124:127],v5 offset:28672
v_mfma_f32_16x16x32_bf16 v[100:103],a[92:95],v[108:111],v[100:103]
s_waitcnt lgkmcnt(2)
v_mfma_f32_16x16x32_bf16 v[88:91],a[96:99],v[112:115],v[88:91]
ds_read_b128 v[104:107],v6 offset:24576
v_mfma_f32_16x16x32_bf16 v[92:95],a[96:99],v[116:119],v[92:95]
v_mfma_f32_16x16x32_bf16 v[96:99],a[104:107],v[112:115],v[96:99]
ds_read_b128 v[108:111],v6 offset:28672
v_mfma_f32_16x16x32_bf16 v[100:103],a[104:107],v[116:119],v[100:103]
s_waitcnt lgkmcnt(2)
v_mfma_f32_16x16x32_bf16 v[88:91],a[100:103],v[120:123],v[88:91]
ds_read_b128 v[112:115],v7 offset:24576
v_mfma_f32_16x16x32_bf16 v[92:95],a[100:103],v[124:127],v[92:95]
v_mfma_f32_16x16x32_bf16 v[96:99],a[108:111],v[120:123],v[96:99]
ds_read_b128 v[116:119],v7 offset:28672
v_mfma_f32_16x16x32_bf16 v[100:103],a[108:111],v[124:127],v[100:103]
s_waitcnt lgkmcnt(2)
v_mfma_f32_16x16x32_bf16 v[88:91],a[112:115],v[104:107],v[88:91]
v_mfma_f32_16x16x32_bf16 v[92:95],a[112:115],v[108:111],v[92:95]
v_mfma_f32_16x16x32_bf16 v[96:99],a[120:123],v[104:107],v[96:99]
v_mfma_f32_16x16x32_bf16 v[100:103],a[120:123],v[108:111],v[100:103]
s_waitcnt lgkmcnt(0)
v_mfma_f32_16x16x32_bf16 v[88:91],a[116:119],v[112:115],v[88:91]
v_mfma_f32_16x16x32_bf16 v[92:95],a[116:119],v[116:119],v[92:95]
v_mfma_f32_16x16x32_bf16 v[96:99],a[124:127],v[112:115],v[96:99]
v_mfma_f32_16x16x32_bf16 v[100:103],a[124:127],v[116:119],v[100:103]
s_nop 3
v_cvt_pk_bf16_f32 v104,v88,v96
v_cvt_pk_bf16_f32 v105,v89,v97
v_cvt_pk_bf16_f32 v106,v90,v98
v_cvt_pk_bf16_f32 v107,v91,v99
v_cvt_pk_bf16_f32 v108,v92,v100
v_cvt_pk_bf16_f32 v109,v93,v101
v_cvt_pk_bf16_f32 v110,v94,v102
v_cvt_pk_bf16_f32 v111,v95,v103
buffer_store_dwordx4 v[104:107],v0,s[8:11],s63 offen sc1
buffer_store_dwordx4 v[108:111],v0,s[8:11],s64 offen sc1
s_waitcnt vmcnt(6)
s_barrier
s_add_u32 m0,s50,131072
s_nop 0
buffer_load_dwordx4 v20,s[8:11],s70 offen offset:0 sc1 lds
s_add_u32 m0,s50,135168
s_nop 0
buffer_load_dwordx4 v20,s[8:11],s71 offen offset:0 sc1 lds
s_add_u32 m0,s50,139008
s_nop 0
buffer_load_dwordx4 v20,s[8:11],s70 offen offset:256 sc1 lds
s_add_u32 m0,s50,143104
s_nop 0
buffer_load_dwordx4 v20,s[8:11],s71 offen offset:256 sc1 lds
s_add_u32 m0,s50,146944
s_nop 0
buffer_load_dwordx4 v20,s[8:11],s70 offen offset:512 sc1 lds
s_add_u32 m0,s50,151040
s_nop 0
buffer_load_dwordx4 v20,s[8:11],s71 offen offset:512 sc1 lds
s_lshl_b32 s59,s51,13
s_lshl2_add_u32 s59,s47,s59
s_add_u32 s59,s59,10487680
s_waitcnt vmcnt(0)
s_barrier
s_or_b32 s59,s59,s52
buffer_store_dword v17,off,s[8:11],s59 sc1
s_mov_b32 s72,0x80000000
s_mov_b32 s86,0
s_mov_b32 s19,1
s_mov_b32 s18,0
s_cmp_lt_u32 s31,64
s_cbranch_scc1 L_mo_393
L_mo_406:
s_mov_b32 s51,64
s_cmp_eq_u32 s47,31
s_cbranch_scc1 L_mf_417
v_and_b32 v9,15,v1
v_lshrrev_b32 v10,4,v1
v_and_b32 v124,1,v1
v_lshlrev_b32 v124,4,v124
v_mov_b32 v125,0xffff
v_lshlrev_b32 v125,v124,v125
v_lshrrev_b32 v124,2,v9
v_cmp_eq_u32 vcc,0,v124
s_nop 1
v_cndmask_b32 v12,0,v125,vcc
v_cmp_eq_u32 vcc,1,v124
s_nop 1
v_cndmask_b32 v13,0,v125,vcc
v_and_b32 v124,2,v1
v_cmp_eq_u32 vcc,0,v124
v_mov_b32 v14,0xeeee
v_mov_b32 v124,0x4444
v_cndmask_b32 v14,v14,v124,vcc
v_lshlrev_b32 v11,14,v10
v_lshl_add_u32 v11,v9,4,v11
s_lshl_b32 s65,s51,15
s_add_u32 s65,s65,92274688
s_lshl_b32 s62,s47,10
s_add_u32 s62,s62,s65
s_lshl_b32 s63,s47,16
s_lshl_b32 s60,s46,8
s_add_u32 s63,s63,s60
s_mov_b32 s4,s38
s_mov_b32 s5,s39
s_mov_b32 s6,1835008
s_mov_b32 s7,0x20000
buffer_load_dwordx4 v[24:27],v11,s[4:7],s63 offen offset:0
buffer_load_dwordx4 v[28:31],v11,s[4:7],s63 offen offset:1024
buffer_load_dwordx4 v[32:35],v11,s[4:7],s63 offen offset:2048
buffer_load_dwordx4 v[36:39],v11,s[4:7],s63 offen offset:3072
s_add_u32 s63,s63,4096
buffer_load_dwordx4 v[40:43],v11,s[4:7],s63 offen offset:0
buffer_load_dwordx4 v[44:47],v11,s[4:7],s63 offen offset:1024
buffer_load_dwordx4 v[48:51],v11,s[4:7],s63 offen offset:2048
buffer_load_dwordx4 v[52:55],v11,s[4:7],s63 offen offset:3072
s_add_u32 s63,s63,4096
buffer_load_dwordx4 v[56:59],v11,s[4:7],s63 offen offset:0
buffer_load_dwordx4 v[60:63],v11,s[4:7],s63 offen offset:1024
buffer_load_dwordx4 v[64:67],v11,s[4:7],s63 offen offset:2048
buffer_load_dwordx4 v[68:71],v11,s[4:7],s63 offen offset:3072
s_add_u32 s63,s63,4096
buffer_load_dwordx4 v[72:75],v11,s[4:7],s63 offen offset:0
buffer_load_dwordx4 v[76:79],v11,s[4:7],s63 offen offset:1024
buffer_load_dwordx4 v[80:83],v11,s[4:7],s63 offen offset:2048
buffer_load_dwordx4 v[84:87],v11,s[4:7],s63 offen offset:3072
ds_read_b128 a[0:3],v18 offset:0
ds_read_b128 a[4:7],v18 offset:1024
ds_read_b128 a[8:11],v18 offset:2048
ds_read_b128 a[12:15],v18 offset:3072
ds_read_b128 a[16:19],v18 offset:4096
ds_read_b128 a[20:23],v18 offset:5120
ds_read_b128 a[24:27],v18 offset:6144
ds_read_b128 a[28:31],v18 offset:7168
ds_read_b128 a[32:35],v18 offset:8192
ds_read_b128 a[36:39],v18 offset:9216
ds_read_b128 a[40:43],v18 offset:10240
ds_read_b128 a[44:47],v18 offset:11264
ds_read_b128 a[48:51],v18 offset:12288
ds_read_b128 a[52:55],v18 offset:13312
ds_read_b128 a[56:59],v18 offset:14336
ds_read_b128 a[60:63],v18 offset:15360
ds_read_b128 a[64:67],v18 offset:16384
ds_read_b128 a[68:71],v18 offset:17408
ds_read_b128 a[72:75],v18 offset:18432
ds_read_b128 a[76:79],v18 offset:19456
ds_read_b128 a[80:83],v18 offset:20480
ds_read_b128 a[84:87],v18 offset:21504
ds_read_b128 a[88:91],v18 offset:22528
ds_read_b128 a[92:95],v18 offset:23552
ds_read_b128 a[96:99],v18 offset:24576
ds_read_b128 a[100:103],v18 offset:25600
ds_read_b128 a[104:107],v18 offset:26624
ds_read_b128 a[108:111],v18 offset:27648
ds_read_b128 a[112:115],v18 offset:28672
ds_read_b128 a[116:119],v18 offset:29696
ds_read_b128 a[120:123],v18 offset:30720
ds_read_b128 a[124:127],v18 offset:31744
L_mf_418:
s_lshl_b32 s59,s51,13
s_lshl_b32 s61,s46,7
s_add_u32 s59,s59,s61
s_add_u32 s59,s59,10486272
L_ww_423:
s_sleep 1
buffer_load_dword v2,off,s[8:11],s59 sc1
s_sub_u32 s49,s49,1
s_cbranch_scc1 L_abort2
s_waitcnt vmcnt(0)
v_readfirstlane_b32 s55,v2
s_cmp_eq_u32 s55,0
s_cbranch_scc1 L_ww_423
L_wwd_424:
s_cmp_eq_u32 s55,1
s_cbranch_scc1 L_mf_419
s_barrier
s_andn2_b32 s64,0x7ff,s55
s_lshl_b32 s56,s64,10
s_add_u32 s58,s56,6291456
buffer_load_dwordx4 v[88:91],v0,s[8:11],s58 offen sc1
s_lshl_b32 s57,s46,11
s_add_u32 s57,s57,139264
v_add_u32 v8,s57,v0
v_and_b32 v2,1,v10
v_lshrrev_b32 v3,1,v10
v_lshlrev_b32 v2,7,v2
v_lshl_add_u32 v2,v3,10,v2
s_lshl_b32 s59,s46,8
s_add_u32 s59,s57,s59
v_add_u32 v2,s59,v2
s_mov_b32 s60,0x01000100
s_mov_b32 s61,0x03020302
s_waitcnt vmcnt(0)
v_lshlrev_b32 v96,16,v88
v_and_b32 v97,0xffff0000,v88
v_lshlrev_b32 v98,16,v89
v_and_b32 v99,0xffff0000,v89
v_lshlrev_b32 v100,16,v90
v_and_b32 v101,0xffff0000,v90
v_lshlrev_b32 v102,16,v91
v_and_b32 v103,0xffff0000,v91
v_readfirstlane_b32 s78,v96
s_nop 1
v_pk_add_f32 v[108:109],v[96:97],s[78:79] op_sel_hi:[1,0] neg_lo:[0,1] neg_hi:[0,1]
v_pk_add_f32 v[110:111],v[98:99],s[78:79] op_sel_hi:[1,0] neg_lo:[0,1] neg_hi:[0,1]
v_pk_add_f32 v[112:113],v[100:101],s[78:79] op_sel_hi:[1,0] neg_lo:[0,1] neg_hi:[0,1]
v_pk_add_f32 v[114:115],v[102:103],s[78:79] op_sel_hi:[1,0] neg_lo:[0,1] neg_hi:[0,1]
v_pk_add_f32 v[116:117],v[108:109],v[110:111]
v_pk_mul_f32 v[118:119],v[108:109],v[108:109]
v_pk_add_f32 v[120:121],v[112:113],v[114:115]
v_pk_fma_f32 v[118:119],v[110:111],v[110:111],v[118:119]
v_pk_add_f32 v[116:117],v[116:117],v[120:121]
v_pk_fma_f32 v[118:119],v[112:113],v[112:113],v[118:119]
v_add_f32 v116,v116,v117
v_pk_fma_f32 v[118:119],v[114:115],v[114:115],v[118:119]
v_add_f32 v118,v118,v119
s_nop 1
v_permlane32_swap_b32 v116,v118
v_add_f32 v116,v116,v118
s_nop 1
v_add_f32_dpp v116,v116,v116 row_ror:8 row_mask:0xf bank_mask:0xf
s_nop 1
v_add_f32_dpp v116,v116,v116 row_ror:4 row_mask:0xf bank_mask:0xf
s_nop 1
v_add_f32_dpp v116,v116,v116 row_ror:2 row_mask:0xf bank_mask:0xf
s_nop 1
v_add_f32_dpp v116,v116,v116 row_ror:1 row_mask:0xf bank_mask:0xf
v_mov_b32 v118,v116
s_nop 1
v_permlane16_swap_b32 v116,v118
v_add_f32 v116,v116,v118
v_mul_f32 v116,0x3b000000,v116
v_mov_b32 v118,v116
s_nop 1
v_permlane32_swap_b32 v116,v118
v_fma_f32 v118,-v116,v116,v118
v_add_f32 v116,s78,v116
v_max_f32 v118,0,v118
v_cvt_pk_bf16_f32 v118,v116,v118
v_lshlrev_b32 v116,16,v118
v_and_b32 v118,0xffff0000,v118
v_add_f32 v118,0x3727c5ac,v118
v_cvt_pk_bf16_f32 v118,v118,v118
v_and_b32 v118,0xffff0000,v118
v_sqrt_f32 v118,v118
v_pk_add_f32 v[108:109],v[96:97],v[116:117] op_sel_hi:[1,0] neg_lo:[0,1] neg_hi:[0,1]
v_pk_add_f32 v[110:111],v[98:99],v[116:117] op_sel_hi:[1,0] neg_lo:[0,1] neg_hi:[0,1]
v_pk_add_f32 v[112:113],v[100:101],v[116:117] op_sel_hi:[1,0] neg_lo:[0,1] neg_hi:[0,1]
v_pk_add_f32 v[114:115],v[102:103],v[116:117] op_sel_hi:[1,0] neg_lo:[0,1] neg_hi:[0,1]
v_cvt_pk_bf16_f32 v118,v118,v118
v_and_b32 v118,0xffff0000,v118
v_rcp_f32 v118,v118
v_cvt_pk_bf16_f32 v104,v108,v109
v_cvt_pk_bf16_f32 v105,v110,v111
v_cvt_pk_bf16_f32 v106,v112,v113
v_cvt_pk_bf16_f32 v107,v114,v115
v_lshlrev_b32 v108,16,v104
v_and_b32 v109,0xffff0000,v104
v_lshlrev_b32 v110,16,v105
v_and_b32 v111,0xffff0000,v105
v_lshlrev_b32 v112,16,v106
v_and_b32 v113,0xffff0000,v106
v_lshlrev_b32 v114,16,v107
v_and_b32 v115,0xffff0000,v107
v_pk_mul_f32 v[108:109],v[108:109],v[118:119] op_sel_hi:[1,0]
v_pk_mul_f32 v[110:111],v[110:111],v[118:119] op_sel_hi:[1,0]
v_pk_mul_f32 v[112:113],v[112:113],v[118:119] op_sel_hi:[1,0]
v_pk_mul_f32 v[114:115],v[114:115],v[118:119] op_sel_hi:[1,0]
v_cvt_pk_bf16_f32 v104,v108,v109
v_cvt_pk_bf16_f32 v105,v110,v111
v_cvt_pk_bf16_f32 v106,v112,v113
v_cvt_pk_bf16_f32 v107,v114,v115
v_perm_b32 v88,v104,v104,s60
v_perm_b32 v89,v105,v105,s60
v_perm_b32 v90,v106,v106,s60
v_perm_b32 v91,v107,v107,s60
ds_write_b128 v8,v[88:91]
v_perm_b32 v92,v104,v104,s61
v_perm_b32 v93,v105,v105,s61
v_perm_b32 v94,v106,v106,s61
v_perm_b32 v95,v107,v107,s61
ds_write_b128 v8,v[92:95] offset:1024
s_mov_b32 s58,s57
ds_read_b128 v[128:131],v2 offset:0
ds_read_b128 v[144:147],v2 offset:64
ds_read_b128 v[132:135],v2 offset:16
ds_read_b128 v[148:151],v2 offset:80
ds_read_b128 v[136:139],v2 offset:32
ds_read_b128 v[152:155],v2 offset:96
ds_read_b128 v[140:143],v2 offset:48
ds_read_b128 v[156:159],v2 offset:112
v_mov_b64 v[116:117],0
v_mov_b64 v[118:119],0
s_waitcnt lgkmcnt(6)
v_and_b32 v120,v12,v128
v_and_b32 v121,v13,v128
v_and_b32 v122,v12,v144
v_and_b32 v123,v13,v144
v_and_b32 v124,v12,v129
v_and_b32 v125,v13,v129
v_smfmac_f32_16x16x64_bf16 v[116:119],v[120:123],a[0:7],v14
v_and_b32 v126,v12,v145
v_and_b32 v127,v13,v145
v_and_b32 v120,v12,v130
v_and_b32 v121,v13,v130
v_smfmac_f32_16x16x64_bf16 v[116:119],v[124:127],a[8:15],v14
v_and_b32 v122,v12,v146
v_and_b32 v123,v13,v146
v_and_b32 v124,v12,v131
v_and_b32 v125,v13,v131
v_smfmac_f32_16x16x64_bf16 v[116:119],v[120:123],a[16:23],v14
v_and_b32 v126,v12,v147
v_and_b32 v127,v13,v147
s_waitcnt lgkmcnt(4)
v_and_b32 v120,v12,v132
v_and_b32 v121,v13,v132
v_smfmac_f32_16x16x64_bf16 v[116:119],v[124:127],a[24:31],v14
v_and_b32 v122,v12,v148
v_and_b32 v123,v13,v148
v_and_b32 v124,v12,v133
v_and_b32 v125,v13,v133
v_smfmac_f32_16x16x64_bf16 v[116:119],v[120:123],a[32:39],v14
v_and_b32 v126,v12,v149
v_and_b32 v127,v13,v149
v_and_b32 v120,v12,v134
v_and_b32 v121,v13,v134
v_smfmac_f32_16x16x64_bf16 v[116:119],v[124:127],a[40:47],v14
v_and_b32 v122,v12,v150
v_and_b32 v123,v13,v150
v_and_b32 v124,v12,v135
v_and_b32 v125,v13,v135
v_smfmac_f32_16x16x64_bf16 v[116:119],v[120:123],a[48:55],v14
v_and_b32 v126,v12,v151
v_and_b32 v127,v13,v151
s_waitcnt lgkmcnt(2)
v_and_b32 v120,v12,v136
v_and_b32 v121,v13,v136
v_smfmac_f32_16x16x64_bf16 v[116:119],v[124:127],a[56:63],v14
v_and_b32 v122,v12,v152
v_and_b32 v123,v13,v152
v_and_b32 v124,v12,v137
v_and_b32 v125,v13,v137
v_smfmac_f32_16x16x64_bf16 v[116:119],v[120:123],a[64:71],v14
v_and_b32 v126,v12,v153
v_and_b32 v127,v13,v153
v_and_b32 v120,v12,v138
v_and_b32 v121,v13,v138
v_smfmac_f32_16x16x64_bf16 v[116:119],v[124:127],a[72:79],v14
v_and_b32 v122,v12,v154
v_and_b32 v123,v13,v154
v_and_b32 v124,v12,v139
v_and_b32 v125,v13,v139
v_smfmac_f32_16x16x64_bf16 v[116:119],v[120:123],a[80:87],v14
v_and_b32 v126,v12,v155
v_and_b32 v127,v13,v155
s_waitcnt lgkmcnt(0)
v_and_b32 v120,v12,v140
v_and_b32 v121,v13,v140
v_smfmac_f32_16x16x64_bf16 v[116:119],v[124:127],a[88:95],v14
v_and_b32 v122,v12,v156
v_and_b32 v123,v13,v156
v_and_b32 v124,v12,v141
v_and_b32 v125,v13,v141
v_smfmac_f32_16x16x64_bf16 v[116:119],v[120:123],a[96:103],v14
v_and_b32 v126,v12,v157
v_and_b32 v127,v13,v157
v_and_b32 v120,v12,v142
v_and_b32 v121,v13,v142
v_smfmac_f32_16x16x64_bf16 v[116:119],v[124:127],a[104:111],v14
v_and_b32 v122,v12,v158
v_and_b32 v123,v13,v158
v_and_b32 v124,v12,v143
v_and_b32 v125,v13,v143
v_smfmac_f32_16x16x64_bf16 v[116:119],v[120:123],a[112:119],v14
v_and_b32 v126,v12,v159
v_and_b32 v127,v13,v159
s_nop 1
v_smfmac_f32_16x16x64_bf16 v[116:119],v[124:127],a[120:127],v14
v_lshlrev_b32 v8,5,v9
v_and_b32 v124,1,v10
v_lshl_add_u32 v8,v124,4,v8
v_lshrrev_b32 v124,1,v10
v_lshl_add_u32 v8,v124,11,v8
s_lshl_b32 s60,s46,9
s_add_u32 s60,s60,147456
v_add_u32 v8,s60,v8
ds_write_b128 v8,v[116:119]
v_lshlrev_b32 v8,2,v1
v_add_u32 v8,147456,v8
v_and_b32 v2,1,v1
v_lshrrev_b32 v3,1,v1
v_lshlrev_b32 v3,2,v3
v_lshl_add_u32 v2,v2,7,v3
v_add_u32 v2,s58,v2
v_lshlrev_b32 v3,6,v10
v_add_u32 v3,s58,v3
s_waitcnt lgkmcnt(0)
s_barrier
ds_read2st64_b32 v[88:89],v8 offset0:0 offset1:1
ds_read2st64_b32 v[90:91],v8 offset0:2 offset1:3
ds_read2st64_b32 v[92:93],v8 offset0:4 offset1:5
ds_read2st64_b32 v[94:95],v8 offset0:6 offset1:7
s_waitcnt lgkmcnt(0)
v_pk_add_f32 v[88:89],v[88:89],v[90:91]
v_pk_add_f32 v[92:93],v[92:93],v[94:95]
v_pk_add_f32 v[88:89],v[88:89],v[92:93]
v_cvt_pk_bf16_f32 v88,v88,v88
v_and_b32 v88,0xffff0000,v88
v_cvt_pk_bf16_f32 v89,v89,v89
v_and_b32 v89,0xffff0000,v89
v_mul_f32 v90,0xbfb8aa3b,v88
v_exp_f32 v90,v90
s_nop 0
v_add_f32 v90,1.0,v90
v_rcp_f32 v90,v90
s_nop 0
v_mul_f32 v88,v88,v90
v_cvt_pk_bf16_f32 v88,v88,v88
v_and_b32 v88,0xffff0000,v88
v_mul_f32 v88,v88,v89
v_cvt_pk_bf16_f32 v88,v88,v88
ds_write_b32 v2,v88
ds_read_b128 v[88:91],v3
ds_read_b128 v[108:111],v3 offset:32
ds_read_b128 v[92:95],v3 offset:16
ds_read_b128 v[112:115],v3 offset:48
v_mov_b64 v[116:117],0
v_mov_b64 v[118:119],0
s_waitcnt vmcnt(0) lgkmcnt(0)
v_and_b32 v120,v12,v88
v_and_b32 v121,v13,v88
v_and_b32 v122,v12,v108
v_and_b32 v123,v13,v108
v_and_b32 v124,v12,v89
v_and_b32 v125,v13,v89
v_smfmac_f32_16x16x64_bf16 v[116:119],v[120:123],v[24:31],v14
v_and_b32 v126,v12,v109
v_and_b32 v127,v13,v109
v_and_b32 v120,v12,v90
v_and_b32 v121,v13,v90
v_smfmac_f32_16x16x64_bf16 v[116:119],v[124:127],v[32:39],v14
v_and_b32 v122,v12,v110
v_and_b32 v123,v13,v110
v_and_b32 v124,v12,v91
v_and_b32 v125,v13,v91
v_smfmac_f32_16x16x64_bf16 v[116:119],v[120:123],v[40:47],v14
v_and_b32 v126,v12,v111
v_and_b32 v127,v13,v111
v_and_b32 v120,v12,v92
v_and_b32 v121,v13,v92
v_smfmac_f32_16x16x64_bf16 v[116:119],v[124:127],v[48:55],v14
v_and_b32 v122,v12,v112
v_and_b32 v123,v13,v112
v_and_b32 v124,v12,v93
v_and_b32 v125,v13,v93
v_smfmac_f32_16x16x64_bf16 v[116:119],v[120:123],v[56:63],v14
v_and_b32 v126,v12,v113
v_and_b32 v127,v13,v113
v_and_b32 v120,v12,v94
v_and_b32 v121,v13,v94
v_smfmac_f32_16x16x64_bf16 v[116:119],v[124:127],v[64:71],v14
v_and_b32 v122,v12,v114
v_and_b32 v123,v13,v114
v_and_b32 v124,v12,v95
v_and_b32 v125,v13,v95
v_smfmac_f32_16x16x64_bf16 v[116:119],v[120:123],v[72:79],v14
v_and_b32 v126,v12,v115
v_and_b32 v127,v13,v115
s_nop 1
v_smfmac_f32_16x16x64_bf16 v[116:119],v[124:127],v[80:87],v14
v_lshlrev_b32 v8,4,v9
v_and_b32 v124,1,v10
v_lshl_add_u32 v8,v124,3,v8
v_and_b32 v124,2,v10
v_lshl_add_u32 v8,v124,30,v8
s_lshl_b32 s60,s46,8
s_add_u32 s59,s62,s60
s_nop 0
v_cvt_pk_bf16_f32 v88,v116,v117
v_cvt_pk_bf16_f32 v89,v118,v119
buffer_store_dwordx2 v[88:89],v8,s[8:11],s59 offen sc1
s_lshl_b32 s59,s51,13
s_lshl2_add_u32 s59,s47,s59
s_add_u32 s59,s59,10486912
s_waitcnt vmcnt(0)
s_barrier
s_or_b32 s59,s59,s52
buffer_store_dword v17,off,s[8:11],s59 sc1
s_cmp_lg_u32 s47,0
s_cbranch_scc1 L_moed_425
s_lshl_b32 s59,s51,13
s_add_u32 s59,s59,10486912
v_and_b32 v124,31,v1
v_lshlrev_b32 v124,2,v124
L_fw_426:
buffer_load_dword v125,v124,s[8:11],s59 offen sc1
s_sub_u32 s49,s49,1
s_cbranch_scc1 L_abort2
s_waitcnt vmcnt(0)
v_cmp_eq_u32 vcc,0,v125
s_cbranch_vccnz L_fw_426
s_add_u32 s63,s65,0
buffer_load_dwordx4 v[168:171],v22,s[8:11],s63 offen sc1
s_add_u32 s63,s65,4096
buffer_load_dwordx4 v[172:175],v22,s[8:11],s63 offen sc1
s_add_u32 s63,s65,8192
buffer_load_dwordx4 v[176:179],v22,s[8:11],s63 offen sc1
s_add_u32 s63,s65,12288
buffer_load_dwordx4 v[180:183],v22,s[8:11],s63 offen sc1
s_add_u32 s63,s65,16384
buffer_load_dwordx4 v[184:187],v22,s[8:11],s63 offen sc1
s_add_u32 s63,s65,20480
buffer_load_dwordx4 v[188:191],v22,s[8:11],s63 offen sc1
s_add_u32 s63,s65,24576
buffer_load_dwordx4 v[192:195],v22,s[8:11],s63 offen sc1
s_add_u32 s63,s65,28672
buffer_load_dwordx4 v[196:199],v22,s[8:11],s63 offen sc1
v_and_b32 v208,15,v1
v_and_b32 v209,1,v1
v_lshlrev_b32 v209,4,v209
v_mov_b32 v210,0x3f80
v_lshlrev_b32 v210,v209,v210
v_lshrrev_b32 v208,1,v208
v_cmp_eq_u32 vcc,0,v208
s_nop 1
v_cndmask_b32 v200,0,v210,vcc
v_cmp_eq_u32 vcc,1,v208
s_nop 1
v_cndmask_b32 v201,0,v210,vcc
v_cmp_eq_u32 vcc,2,v208
s_nop 1
v_cndmask_b32 v202,0,v210,vcc
v_cmp_eq_u32 vcc,3,v208
s_nop 1
v_cndmask_b32 v203,0,v210,vcc
s_waitcnt vmcnt(7)
s_nop 0
v_mfma_f32_16x16x32_bf16 v[204:207],v[200:203],v[168:171],0
s_waitcnt vmcnt(6)
v_mfma_f32_16x16x32_bf16 v[204:207],v[200:203],v[172:175],v[204:207]
s_waitcnt vmcnt(5)
v_mfma_f32_16x16x32_bf16 v[204:207],v[200:203],v[176:179],v[204:207]
s_waitcnt vmcnt(4)
v_mfma_f32_16x16x32_bf16 v[204:207],v[200:203],v[180:183],v[204:207]
s_waitcnt vmcnt(3)
v_mfma_f32_16x16x32_bf16 v[204:207],v[200:203],v[184:187],v[204:207]
s_waitcnt vmcnt(2)
v_mfma_f32_16x16x32_bf16 v[204:207],v[200:203],v[188:191],v[204:207]
s_waitcnt vmcnt(1)
v_mfma_f32_16x16x32_bf16 v[204:207],v[200:203],v[192:195],v[204:207]
s_waitcnt vmcnt(0)
v_mfma_f32_16x16x32_bf16 v[204:207],v[200:203],v[196:199],v[204:207]
s_nop 7
ds_write_b128 v21,v[204:207]
s_waitcnt lgkmcnt(0)
s_barrier
s_cmp_lg_u32 s46,0
s_cbranch_scc1 L_moed_425
v_lshlrev_b32 v200,5,v1
v_add_u32 v200,155648,v200
ds_read_b128 v[168:171],v200
ds_read_b128 v[172:175],v200 offset:16
s_and_b32 s59,s55,0xffff0000
s_xor_b32 s60,s59,0x80000000
s_xor_b32 s61,s59,0xffff0000
s_cmp_lt_i32 s59,0
s_cselect_b32 s59,s60,s61
v_mov_b32 v200,s59
v_mul_f32 v200,0xbfb8aa3b,v200
v_exp_f32 v200,v200
s_nop 0
v_add_f32 v200,1.0,v200
v_rcp_f32 v200,v200
s_nop 0
v_cvt_pk_bf16_f32 v200,v200,v200
v_and_b32 v200,0xffff0000,v200
v_lshlrev_b32 v192,16,v104
v_and_b32 v193,0xffff0000,v104
v_lshlrev_b32 v194,16,v105
v_and_b32 v195,0xffff0000,v105
v_lshlrev_b32 v196,16,v106
v_and_b32 v197,0xffff0000,v106
v_lshlrev_b32 v198,16,v107
v_and_b32 v199,0xffff0000,v107
s_waitcnt lgkmcnt(0)
v_cvt_pk_bf16_f32 v184,v168,v169
v_cvt_pk_bf16_f32 v185,v170,v171
v_cvt_pk_bf16_f32 v186,v172,v173
v_cvt_pk_bf16_f32 v187,v174,v175
v_lshlrev_b32 v168,16,v184
v_and_b32 v169,0xffff0000,v184
v_lshlrev_b32 v170,16,v185
v_and_b32 v171,0xffff0000,v185
v_lshlrev_b32 v172,16,v186
v_and_b32 v173,0xffff0000,v186
v_lshlrev_b32 v174,16,v187
v_and_b32 v175,0xffff0000,v187
v_pk_mul_f32 v[168:169],v[168:169],v[200:201] op_sel_hi:[1,0]
v_pk_mul_f32 v[170:171],v[170:171],v[200:201] op_sel_hi:[1,0]
v_pk_mul_f32 v[172:173],v[172:173],v[200:201] op_sel_hi:[1,0]
v_pk_mul_f32 v[174:175],v[174:175],v[200:201] op_sel_hi:[1,0]
v_cvt_pk_bf16_f32 v184,v168,v169
v_cvt_pk_bf16_f32 v185,v170,v171
v_cvt_pk_bf16_f32 v186,v172,v173
v_cvt_pk_bf16_f32 v187,v174,v175
v_lshlrev_b32 v168,16,v184
v_and_b32 v169,0xffff0000,v184
v_lshlrev_b32 v170,16,v185
v_and_b32 v171,0xffff0000,v185
v_lshlrev_b32 v172,16,v186
v_and_b32 v173,0xffff0000,v186
v_lshlrev_b32 v174,16,v187
v_and_b32 v175,0xffff0000,v187
v_pk_add_f32 v[168:169],v[168:169],v[192:193]
v_pk_add_f32 v[170:171],v[170:171],v[194:195]
v_pk_add_f32 v[172:173],v[172:173],v[196:197]
v_pk_add_f32 v[174:175],v[174:175],v[198:199]
v_cvt_pk_bf16_f32 v184,v168,v169
v_cvt_pk_bf16_f32 v185,v170,v171
v_cvt_pk_bf16_f32 v186,v172,v173
v_cvt_pk_bf16_f32 v187,v174,v175
v_lshlrev_b32 v168,16,v184
v_and_b32 v169,0xffff0000,v184
v_lshlrev_b32 v170,16,v185
v_and_b32 v171,0xffff0000,v185
v_lshlrev_b32 v172,16,v186
v_and_b32 v173,0xffff0000,v186
v_lshlrev_b32 v174,16,v187
v_and_b32 v175,0xffff0000,v187
v_pk_add_f32 v[96:97],v[96:97],v[168:169]
v_pk_add_f32 v[98:99],v[98:99],v[170:171]
v_pk_add_f32 v[100:101],v[100:101],v[172:173]
v_pk_add_f32 v[102:103],v[102:103],v[174:175]
v_cvt_pk_bf16_f32 v160,v96,v97
v_cvt_pk_bf16_f32 v161,v98,v99
v_cvt_pk_bf16_f32 v162,v100,v101
v_cvt_pk_bf16_f32 v163,v102,v103
L_moed_425:
s_add_u32 s51,s51,1
s_add_u32 s62,s62,32768
s_add_u32 s65,s65,32768
s_branch L_mf_418
L_mf_419:
s_mov_b32 s4,s40
s_mov_b32 s5,s41
s_mov_b32 s6,2097152
s_mov_b32 s7,0x20000
s_or_b32 s61,s47,s46
s_cselect_b32 s56,0x80000000,s56
buffer_store_dwordx4 v[160:163],v0,s[4:7],s56 offen sc1
s_waitcnt vmcnt(0)
s_endpgm
L_mf_417:
s_cmp_lg_u32 s46,0
s_cbranch_scc1 L_mf_422
v_mov_b64 v[24:25],0
v_mov_b64 v[26:27],0
s_mov_b32 s56,94403584
buffer_store_dwordx4 v[24:27],v0,s[8:11],s56 offen sc1
s_mov_b32 s56,94436352
buffer_store_dwordx4 v[24:27],v0,s[8:11],s56 offen sc1
s_mov_b32 s56,94469120
buffer_store_dwordx4 v[24:27],v0,s[8:11],s56 offen sc1
s_mov_b32 s56,94501888
buffer_store_dwordx4 v[24:27],v0,s[8:11],s56 offen sc1
s_mov_b32 s56,94534656
buffer_store_dwordx4 v[24:27],v0,s[8:11],s56 offen sc1
s_mov_b32 s56,94567424
buffer_store_dwordx4 v[24:27],v0,s[8:11],s56 offen sc1
s_andn2_b32 s61,0x7ff,s54
s_lshr_b32 s61,s61,5
s_mov_b32 s59,11018240
v_lshlrev_b32 v2,2,v1
L_fp_429:
s_sleep 2
buffer_load_dword v3,v2,s[8:11],s59 offen sc1
s_sub_u32 s49,s49,1
s_cbranch_scc1 L_abort2
s_waitcnt vmcnt(0)
v_cmp_eq_u32 vcc,0,v3
s_cbranch_vccnz L_fp_429
v_cmp_le_u32 vcc,s61,v1
s_nop 1
v_cndmask_b32 v2,1,2,vcc
v_cmp_ne_u32 s[84:85],v2,v3
s_mov_b32 s56,11011324
buffer_store_dword v17,off,s[8:11],s56 sc1
s_mov_b32 s56,11019516
buffer_store_dword v17,off,s[8:11],s56 sc1
s_mov_b32 s56,11027708
buffer_store_dword v17,off,s[8:11],s56 sc1
s_mov_b32 s56,11035900
buffer_store_dword v17,off,s[8:11],s56 sc1
s_mov_b32 s56,11044092
buffer_store_dword v17,off,s[8:11],s56 sc1
s_mov_b32 s56,11052284
buffer_store_dword v17,off,s[8:11],s56 sc1
v_lshrrev_b32 v2,3,v1
v_and_b32 v3,0x70,v0
v_lshl_add_u32 v3,v2,13,v3
s_lshr_b64 s[20:21],s[84:85],0
v_lshrrev_b32 v60,v2,s20
v_and_b32 v60,1,v60
v_mul_u32_u24 v60,768,v60
v_sub_u32 v60,v3,v60
v_add_u32 v60,10487296,v60
s_lshr_b64 s[20:21],s[84:85],8
v_lshrrev_b32 v61,v2,s20
v_and_b32 v61,1,v61
v_mul_u32_u24 v61,768,v61
v_sub_u32 v61,v3,v61
v_add_u32 v61,10552832,v61
s_lshr_b64 s[20:21],s[84:85],16
v_lshrrev_b32 v62,v2,s20
v_and_b32 v62,1,v62
v_mul_u32_u24 v62,768,v62
v_sub_u32 v62,v3,v62
v_add_u32 v62,10618368,v62
s_lshr_b64 s[20:21],s[84:85],24
v_lshrrev_b32 v63,v2,s20
v_and_b32 v63,1,v63
v_mul_u32_u24 v63,768,v63
v_sub_u32 v63,v3,v63
v_add_u32 v63,10683904,v63
s_lshr_b64 s[20:21],s[84:85],32
v_lshrrev_b32 v64,v2,s20
v_and_b32 v64,1,v64
v_mul_u32_u24 v64,768,v64
v_sub_u32 v64,v3,v64
v_add_u32 v64,10749440,v64
s_lshr_b64 s[20:21],s[84:85],40
v_lshrrev_b32 v65,v2,s20
v_and_b32 v65,1,v65
v_mul_u32_u24 v65,768,v65
v_sub_u32 v65,v3,v65
v_add_u32 v65,10814976,v65
s_lshr_b64 s[20:21],s[84:85],48
v_lshrrev_b32 v66,v2,s20
v_and_b32 v66,1,v66
v_mul_u32_u24 v66,768,v66
v_sub_u32 v66,v3,v66
v_add_u32 v66,10880512,v66
s_lshr_b64 s[20:21],s[84:85],56
v_lshrrev_b32 v67,v2,s20
v_and_b32 v67,1,v67
v_mul_u32_u24 v67,768,v67
v_sub_u32 v67,v3,v67
v_add_u32 v67,10946048,v67
v_and_b32 v68,3,v1
v_lshlrev_b32 v68,7,v68
v_add_u32 v68,10486272,v68
v_and_b32 v69,31,v1
v_lshlrev_b32 v69,2,v69
v_add_u32 v69,10478720,v69
s_mov_b32 s66,0
s_mov_b32 s67,524288
v_mov_b32 v57,0
s_mov_b32 s58,1
L_mf_420:
s_sub_u32 s49,s49,1
s_cbranch_scc1 L_abort2
s_mov_b32 s57,0
s_cmp_lg_u32 s58,0
s_cbranch_scc1 L_ms_430
buffer_load_dwordx4 v[52:55],v67,s[8:11],0 offen sc1
buffer_load_dword v70,v69,s[8:11],s67 offen sc1
s_branch L_mj_431
L_ms_430:
buffer_load_dwordx4 v[24:27],v60,s[8:11],0 offen sc1
buffer_load_dwordx4 v[28:31],v61,s[8:11],0 offen sc1
buffer_load_dwordx4 v[32:35],v62,s[8:11],0 offen sc1
buffer_load_dwordx4 v[36:39],v63,s[8:11],0 offen sc1
buffer_load_dwordx4 v[40:43],v64,s[8:11],0 offen sc1
buffer_load_dwordx4 v[44:47],v65,s[8:11],0 offen sc1
buffer_load_dwordx4 v[48:51],v66,s[8:11],0 offen sc1
buffer_load_dwordx4 v[52:55],v67,s[8:11],0 offen sc1
buffer_load_dword v70,v69,s[8:11],s67 offen sc1
s_waitcnt vmcnt(8)
v_min3_u32 v56,v24,v25,v26
v_max3_u32 v57,v24,v25,v57
v_min_u32 v56,v27,v56
v_max3_u32 v57,v26,v27,v57
v_cmp_eq_u32 vcc,0,v56
s_bcnt1_i32_b64 s56,vcc
s_add_u32 s57,s57,s56
s_waitcnt vmcnt(7)
v_min3_u32 v56,v28,v29,v30
v_max3_u32 v57,v28,v29,v57
v_min_u32 v56,v31,v56
v_max3_u32 v57,v30,v31,v57
v_cmp_eq_u32 vcc,0,v56
s_bcnt1_i32_b64 s56,vcc
s_add_u32 s57,s57,s56
s_waitcnt vmcnt(6)
v_min3_u32 v56,v32,v33,v34
v_max3_u32 v57,v32,v33,v57
v_min_u32 v56,v35,v56
v_max3_u32 v57,v34,v35,v57
v_cmp_eq_u32 vcc,0,v56
s_bcnt1_i32_b64 s56,vcc
s_add_u32 s57,s57,s56
s_waitcnt vmcnt(5)
v_min3_u32 v56,v36,v37,v38
v_max3_u32 v57,v36,v37,v57
v_min_u32 v56,v39,v56
v_max3_u32 v57,v38,v39,v57
v_cmp_eq_u32 vcc,0,v56
s_bcnt1_i32_b64 s56,vcc
s_add_u32 s57,s57,s56
s_waitcnt vmcnt(4)
v_min3_u32 v56,v40,v41,v42
v_max3_u32 v57,v40,v41,v57
v_min_u32 v56,v43,v56
v_max3_u32 v57,v42,v43,v57
v_cmp_eq_u32 vcc,0,v56
s_bcnt1_i32_b64 s56,vcc
s_add_u32 s57,s57,s56
s_waitcnt vmcnt(3)
v_min3_u32 v56,v44,v45,v46
v_max3_u32 v57,v44,v45,v57
v_min_u32 v56,v47,v56
v_max3_u32 v57,v46,v47,v57
v_cmp_eq_u32 vcc,0,v56
s_bcnt1_i32_b64 s56,vcc
s_add_u32 s57,s57,s56
s_waitcnt vmcnt(2)
v_min3_u32 v56,v48,v49,v50
v_max3_u32 v57,v48,v49,v57
v_min_u32 v56,v51,v56
v_max3_u32 v57,v50,v51,v57
v_cmp_eq_u32 vcc,0,v56
s_bcnt1_i32_b64 s56,vcc
s_add_u32 s57,s57,s56
s_mov_b32 s58,s57
L_mj_431:
s_waitcnt vmcnt(1)
v_min3_u32 v56,v52,v53,v54
v_max3_u32 v57,v52,v53,v57
v_min_u32 v56,v55,v56
v_max3_u32 v57,v54,v55,v57
v_cmp_eq_u32 vcc,0,v56
s_bcnt1_i32_b64 s56,vcc
s_add_u32 s57,s57,s56
v_max_u32_dpp v57,v57,v57 row_ror:8 row_mask:0xf bank_mask:0xf
s_nop 1
v_max_u32_dpp v57,v57,v57 row_ror:4 row_mask:0xf bank_mask:0xf
s_nop 1
v_max_u32_dpp v57,v57,v57 row_ror:2 row_mask:0xf bank_mask:0xf
s_nop 1
v_max_u32_dpp v57,v57,v57 row_ror:1 row_mask:0xf bank_mask:0xf
v_mov_b32 v58,v57
s_nop 1
v_permlane16_swap_b32 v57,v58
v_max_u32 v57,v57,v58
v_mov_b32 v58,v57
s_nop 1
v_permlane32_swap_b32 v57,v58
v_max_u32 v57,v57,v58
s_nop 0
v_readfirstlane_b32 s55,v57
s_cmp_lg_u32 s55,s66
s_cbranch_scc1 L_mf_421
s_cmp_lg_u32 s57,0
s_cbranch_scc1 L_mf_420
v_mov_b32 v57,1
buffer_store_dword v57,v68,s[8:11],s67 offen sc1
L_mf_422:
s_waitcnt vmcnt(0)
s_endpgm
L_mf_421:
s_waitcnt vmcnt(0)
v_cmp_eq_u32 vcc,0,v70
s_cmp_eq_u32 s66,0
s_cselect_b32 s56,0,vcc_lo
s_cmp_gt_u32 s57,112
s_cselect_b32 s56,1,s56
s_cmp_ge_u32 s67,565248
s_cselect_b32 s56,1,s56
s_cmp_eq_u32 s57,0
s_cselect_b32 s56,0,s56
s_cmp_lg_u32 s56,0
s_cbranch_scc1 L_mf_420
buffer_store_dword v57,v68,s[8:11],s67 offen sc1
s_mov_b32 s66,s55
s_add_u32 s67,s67,8192
s_branch L_mf_420
s_endpgm
.section .rodata,"a"
.p2align 6
.amdhsa_kernel interleave_layers__memory_aug_recurrent_mem_tr__moe_arch_mod__prompt_kernel
  .amdhsa_next_free_vgpr 512
  .amdhsa_next_free_sgpr 102
  .amdhsa_accum_offset 256
  .amdhsa_group_segment_fixed_size 0
  .amdhsa_kernarg_size 120
  .amdhsa_user_sgpr_count 2
  .amdhsa_user_sgpr_kernarg_segment_ptr 1
  .amdhsa_system_sgpr_workgroup_id_x 1
  .amdhsa_float_denorm_mode_32 3
.end_amdhsa_kernel
```

```asm
; @launch grid=(256,1,1) block=(256,1,1) lds=163840
.amdgcn_target "amdgcn-amd-amdhsa--gfx950"
.text
.globl interleave_layers__memory_aug_recurrent_mem_tr__moe_arch_mod__prompt_kernel
.p2align 8
.type interleave_layers__memory_aug_recurrent_mem_tr__moe_arch_mod__prompt_kernel,@function
interleave_layers__memory_aug_recurrent_mem_tr__moe_arch_mod__prompt_kernel:
s_cmp_ge_u32 s2,256
s_cbranch_scc1 L_abort
s_load_dwordx16 s[16:31],s[0:1],0
s_load_dwordx8 s[32:39],s[0:1],64
s_load_dwordx4 s[40:43],s[0:1],96
s_load_dwordx2 s[44:45],s[0:1],112
v_lshrrev_b32 v2,6,v0
v_and_b32 v1,63,v0
v_readfirstlane_b32 s46,v2
v_lshlrev_b32 v0,4,v1
s_getreg_b32 s48,hwreg(HW_REG_XCC_ID)
s_and_b32 s48,s48,7
s_lshl_b32 s48,s48,2
s_lshr_b32 s48,1399931488,s48
s_and_b32 s48,s48,7
s_mov_b32 s49,100000
s_mov_b32 s80,0x3e0293ee
s_waitcnt lgkmcnt(0)
s_mov_b32 s8,s44
s_mov_b32 s9,s45
s_mov_b32 s10,268435456
s_mov_b32 s11,0x20000
s_mov_b32 s12,s42
s_mov_b32 s13,s43
s_mov_b32 s14,256
s_mov_b32 s15,0x20000
s_lshl_b32 s56,s48,2
s_lshr_b32 s56,2822958528,s56
s_and_b32 s56,s56,15
s_lshl_b32 s56,s56,4
v_mov_b32 v14,s56
v_mov_b32 v15,1
s_cmp_lg_u32 s46,0
s_cbranch_scc1 L_tk_1
s_cmp_ge_u32 s56,192
s_cbranch_scc1 L_tk_1
s_mov_b64 exec,1
buffer_atomic_add v15,v14,s[12:15],0 offen sc0
s_mov_b64 exec,-1
L_tk_1:
s_mov_b32 s4,s18
s_mov_b32 s5,s19
s_mov_b32 s6,8192
s_mov_b32 s7,0x20000
s_cmp_ge_u32 s2,2
s_cbranch_scc1 L_m0_2
s_lshl_b32 s56,s2,2
s_add_u32 s56,s56,s46
v_bfe_u32 v2,v1,2,2
v_and_b32 v3,1,v1
v_lshl_add_u32 v2,v2,1,v3
v_lshlrev_b32 v2,10,v2
v_lshrrev_b32 v3,4,v1
v_lshl_add_u32 v2,v3,5,v2
v_and_b32 v3,2,v1
v_lshl_add_u32 v2,v3,1,v2
s_lshl_b32 s57,s56,7
buffer_load_dword v64,v2,s[4:7],s57 offen offset:0
buffer_load_dword v65,v2,s[4:7],s57 offen offset:8
buffer_load_dword v66,v2,s[4:7],s57 offen offset:16
buffer_load_dword v67,v2,s[4:7],s57 offen offset:24
L_m0_2:
s_mov_b32 s4,s16
s_mov_b32 s5,s17
s_mov_b32 s6,2097152
s_mov_b32 s7,0x20000
s_lshl_b32 s56,s2,3
s_lshl_b32 s65,s46,1
s_add_u32 s56,s56,s65
s_lshl_b32 s65,s56,10
buffer_load_dwordx4 v[24:27],v0,s[4:7],s65 offen
buffer_load_dwordx4 v[28:31],v0,s[4:7],s65 offen offset:1024
s_lshl_b32 s56,s2,12
s_lshl_b32 s57,s46,10
s_add_u32 s56,s56,s57
v_add_u32 v2,s56,v0
v_mov_b32 v4,-1
v_mov_b32 v5,-1
v_mov_b32 v6,-1
v_mov_b32 v7,-1
v_mov_b32 v8,0
v_mov_b32 v9,0
v_mov_b32 v10,0
v_mov_b32 v11,0
v_cmp_gt_u32 vcc,524288,v2
v_mov_b32 v3,14155776
v_mov_b32 v12,11542528
v_cndmask_b32 v3,v3,v12,vcc
v_add_u32 v3,v3,v2
s_mov_b32 s56,0
buffer_store_dwordx4 v[4:7],v3,s[8:11],s56 offen sc1
s_mov_b32 s56,1048576
buffer_store_dwordx4 v[4:7],v3,s[8:11],s56 offen sc1
s_mov_b32 s56,2097152
buffer_store_dwordx4 v[4:7],v3,s[8:11],s56 offen sc1
s_mov_b32 s56,4194304
buffer_store_dwordx4 v[4:7],v2,s[8:11],s56 offen sc1
s_mov_b32 s56,5242880
buffer_store_dwordx4 v[4:7],v2,s[8:11],s56 offen sc1
v_add_u32 v3,17309696,v2
v_mov_b32 v12,0x80000000
v_cndmask_b32 v3,v3,v12,vcc
buffer_store_dwordx4 v[4:7],v3,s[8:11],0 offen sc1
v_cmp_gt_u32 vcc,147456,v2
v_lshrrev_b32 v3,11,v2
v_lshlrev_b32 v3,13,v3
v_and_b32 v13,0x7ff,v2
v_add_u32 v3,v3,v13
v_add_u32 v3,10485760,v3
v_cndmask_b32 v3,v12,v3,vcc
buffer_store_dwordx4 v[8:11],v3,s[8:11],0 offen sc1
v_add_u32 v3,11075584,v2
v_lshrrev_b32 v13,16,v2
v_cmp_eq_u32 vcc,4,v13
s_nop 1
v_cndmask_b32 v3,v12,v3,vcc
buffer_store_dwordx4 v[4:7],v3,s[8:11],0 offen sc1
s_cmp_lg_u32 s46,0
s_cbranch_scc1 L_tk_3
s_mov_b64 exec,1
s_sub_u32 s56,s48,1
s_cmp_gt_u32 s56,2
s_cbranch_scc1 L_tk_3x
s_waitcnt vmcnt(8)
buffer_atomic_add v15,v14,s[12:15],0 offen sc0
s_waitcnt vmcnt(0)
L_tk_3x:
v_mov_b32 v14,159744
s_waitcnt vmcnt(10)
ds_write_b32 v14,v15
s_mov_b64 exec,-1
s_waitcnt lgkmcnt(0)
L_tk_3:
s_barrier
v_mov_b32 v14,159744
ds_read_b32 v2,v14
s_waitcnt lgkmcnt(0)
v_readfirstlane_b32 s47,v2
s_mov_b32 s3,0
s_cmp_ge_u32 s47,32
s_cselect_b32 s53,0x10001,1
s_and_b32 s47,s47,31
s_lshl_b32 s50,s46,10
s_cmp_eq_u32 s46,0
s_cselect_b32 s52,0,0x80000000
s_mov_b32 s28,0x3f803f80
s_mov_b32 s29,0x3f803f80
s_mov_b32 s51,0
s_bfe_u32 s56,s48,0x10001
s_and_b32 s57,s48,1
s_add_u32 s58,s56,6
s_sub_u32 s59,5,s57
s_cmp_ge_u32 s47,16
s_cselect_b32 s58,s58,s59
s_cselect_b32 s57,s57,s56
s_and_b32 s59,s47,15
s_lshl4_add_u32 s57,s57,s59
s_cmp_ge_u32 s48,4
s_cselect_b32 s48,s58,s48
s_cselect_b32 s47,s57,s47
L_roles:
s_lshl_b32 s56,1,s48
s_and_b32 s56,s56,6
s_cbranch_scc0 L_x_10
s_cmp_eq_u32 s53,0
s_cbranch_scc1 L_m0_11
s_waitcnt vmcnt(8)
v_lshlrev_b32 v32,16,v24
v_and_b32 v33,0xffff0000,v24
v_lshlrev_b32 v34,16,v25
v_and_b32 v35,0xffff0000,v25
v_lshlrev_b32 v36,16,v26
v_and_b32 v37,0xffff0000,v26
v_lshlrev_b32 v38,16,v27
v_and_b32 v39,0xffff0000,v27
v_readfirstlane_b32 s78,v32
s_nop 1
v_pk_add_f32 v[48:49],v[32:33],s[78:79] op_sel_hi:[1,0] neg_lo:[0,1] neg_hi:[0,1]
v_pk_add_f32 v[50:51],v[34:35],s[78:79] op_sel_hi:[1,0] neg_lo:[0,1] neg_hi:[0,1]
v_pk_add_f32 v[52:53],v[36:37],s[78:79] op_sel_hi:[1,0] neg_lo:[0,1] neg_hi:[0,1]
v_pk_add_f32 v[54:55],v[38:39],s[78:79] op_sel_hi:[1,0] neg_lo:[0,1] neg_hi:[0,1]
v_pk_add_f32 v[56:57],v[48:49],v[50:51]
v_pk_mul_f32 v[58:59],v[48:49],v[48:49]
v_pk_add_f32 v[60:61],v[52:53],v[54:55]
v_pk_fma_f32 v[58:59],v[50:51],v[50:51],v[58:59]
v_pk_add_f32 v[56:57],v[56:57],v[60:61]
v_pk_fma_f32 v[58:59],v[52:53],v[52:53],v[58:59]
v_add_f32 v56,v56,v57
v_pk_fma_f32 v[58:59],v[54:55],v[54:55],v[58:59]
v_add_f32 v58,v58,v59
s_nop 1
v_permlane32_swap_b32 v56,v58
v_add_f32 v56,v56,v58
s_nop 1
v_add_f32_dpp v56,v56,v56 row_ror:8 row_mask:0xf bank_mask:0xf
s_nop 1
v_add_f32_dpp v56,v56,v56 row_ror:4 row_mask:0xf bank_mask:0xf
s_nop 1
v_add_f32_dpp v56,v56,v56 row_ror:2 row_mask:0xf bank_mask:0xf
s_nop 1
v_add_f32_dpp v56,v56,v56 row_ror:1 row_mask:0xf bank_mask:0xf
v_mov_b32 v58,v56
s_nop 1
v_permlane16_swap_b32 v56,v58
v_add_f32 v56,v56,v58
v_mul_f32 v56,0x3b000000,v56
v_mov_b32 v58,v56
s_nop 1
v_permlane32_swap_b32 v56,v58
v_fma_f32 v58,-v56,v56,v58
v_add_f32 v56,s78,v56
v_max_f32 v58,0,v58
v_cvt_pk_bf16_f32 v58,v56,v58
v_lshlrev_b32 v56,16,v58
v_and_b32 v58,0xffff0000,v58
v_add_f32 v58,0x3727c5ac,v58
v_cvt_pk_bf16_f32 v58,v58,v58
v_and_b32 v58,0xffff0000,v58
v_sqrt_f32 v58,v58
v_pk_add_f32 v[48:49],v[32:33],v[56:57] op_sel_hi:[1,0] neg_lo:[0,1] neg_hi:[0,1]
v_pk_add_f32 v[50:51],v[34:35],v[56:57] op_sel_hi:[1,0] neg_lo:[0,1] neg_hi:[0,1]
v_pk_add_f32 v[52:53],v[36:37],v[56:57] op_sel_hi:[1,0] neg_lo:[0,1] neg_hi:[0,1]
v_pk_add_f32 v[54:55],v[38:39],v[56:57] op_sel_hi:[1,0] neg_lo:[0,1] neg_hi:[0,1]
v_cvt_pk_bf16_f32 v58,v58,v58
v_and_b32 v58,0xffff0000,v58
v_rcp_f32 v58,v58
v_cvt_pk_bf16_f32 v40,v48,v49
v_cvt_pk_bf16_f32 v41,v50,v51
v_cvt_pk_bf16_f32 v42,v52,v53
v_cvt_pk_bf16_f32 v43,v54,v55
v_lshlrev_b32 v48,16,v40
v_and_b32 v49,0xffff0000,v40
v_lshlrev_b32 v50,16,v41
v_and_b32 v51,0xffff0000,v41
v_lshlrev_b32 v52,16,v42
v_and_b32 v53,0xffff0000,v42
v_lshlrev_b32 v54,16,v43
v_and_b32 v55,0xffff0000,v43
v_pk_mul_f32 v[48:49],v[48:49],v[58:59] op_sel_hi:[1,0]
v_pk_mul_f32 v[50:51],v[50:51],v[58:59] op_sel_hi:[1,0]
v_pk_mul_f32 v[52:53],v[52:53],v[58:59] op_sel_hi:[1,0]
v_pk_mul_f32 v[54:55],v[54:55],v[58:59] op_sel_hi:[1,0]
v_cvt_pk_bf16_f32 v40,v48,v49
v_cvt_pk_bf16_f32 v41,v50,v51
v_cvt_pk_bf16_f32 v42,v52,v53
v_cvt_pk_bf16_f32 v43,v54,v55
buffer_store_dwordx4 v[40:43],v0,s[8:11],s65 offen offset:0 sc1
v_lshlrev_b32 v32,16,v28
v_and_b32 v33,0xffff0000,v28
v_lshlrev_b32 v34,16,v29
v_and_b32 v35,0xffff0000,v29
v_lshlrev_b32 v36,16,v30
v_and_b32 v37,0xffff0000,v30
v_lshlrev_b32 v38,16,v31
v_and_b32 v39,0xffff0000,v31
v_readfirstlane_b32 s78,v32
s_nop 1
v_pk_add_f32 v[48:49],v[32:33],s[78:79] op_sel_hi:[1,0] neg_lo:[0,1] neg_hi:[0,1]
v_pk_add_f32 v[50:51],v[34:35],s[78:79] op_sel_hi:[1,0] neg_lo:[0,1] neg_hi:[0,1]
v_pk_add_f32 v[52:53],v[36:37],s[78:79] op_sel_hi:[1,0] neg_lo:[0,1] neg_hi:[0,1]
v_pk_add_f32 v[54:55],v[38:39],s[78:79] op_sel_hi:[1,0] neg_lo:[0,1] neg_hi:[0,1]
v_pk_add_f32 v[56:57],v[48:49],v[50:51]
v_pk_mul_f32 v[58:59],v[48:49],v[48:49]
v_pk_add_f32 v[60:61],v[52:53],v[54:55]
v_pk_fma_f32 v[58:59],v[50:51],v[50:51],v[58:59]
v_pk_add_f32 v[56:57],v[56:57],v[60:61]
v_pk_fma_f32 v[58:59],v[52:53],v[52:53],v[58:59]
v_add_f32 v56,v56,v57
v_pk_fma_f32 v[58:59],v[54:55],v[54:55],v[58:59]
v_add_f32 v58,v58,v59
s_nop 1
v_permlane32_swap_b32 v56,v58
v_add_f32 v56,v56,v58
s_nop 1
v_add_f32_dpp v56,v56,v56 row_ror:8 row_mask:0xf bank_mask:0xf
s_nop 1
v_add_f32_dpp v56,v56,v56 row_ror:4 row_mask:0xf bank_mask:0xf
s_nop 1
v_add_f32_dpp v56,v56,v56 row_ror:2 row_mask:0xf bank_mask:0xf
s_nop 1
v_add_f32_dpp v56,v56,v56 row_ror:1 row_mask:0xf bank_mask:0xf
v_mov_b32 v58,v56
s_nop 1
v_permlane16_swap_b32 v56,v58
v_add_f32 v56,v56,v58
v_mul_f32 v56,0x3b000000,v56
v_mov_b32 v58,v56
s_nop 1
v_permlane32_swap_b32 v56,v58
v_fma_f32 v58,-v56,v56,v58
v_add_f32 v56,s78,v56
v_max_f32 v58,0,v58
v_cvt_pk_bf16_f32 v58,v56,v58
v_lshlrev_b32 v56,16,v58
v_and_b32 v58,0xffff0000,v58
v_add_f32 v58,0x3727c5ac,v58
v_cvt_pk_bf16_f32 v58,v58,v58
v_and_b32 v58,0xffff0000,v58
v_sqrt_f32 v58,v58
v_pk_add_f32 v[48:49],v[32:33],v[56:57] op_sel_hi:[1,0] neg_lo:[0,1] neg_hi:[0,1]
v_pk_add_f32 v[50:51],v[34:35],v[56:57] op_sel_hi:[1,0] neg_lo:[0,1] neg_hi:[0,1]
v_pk_add_f32 v[52:53],v[36:37],v[56:57] op_sel_hi:[1,0] neg_lo:[0,1] neg_hi:[0,1]
v_pk_add_f32 v[54:55],v[38:39],v[56:57] op_sel_hi:[1,0] neg_lo:[0,1] neg_hi:[0,1]
v_cvt_pk_bf16_f32 v58,v58,v58
v_and_b32 v58,0xffff0000,v58
v_rcp_f32 v58,v58
v_cvt_pk_bf16_f32 v44,v48,v49
v_cvt_pk_bf16_f32 v45,v50,v51
v_cvt_pk_bf16_f32 v46,v52,v53
v_cvt_pk_bf16_f32 v47,v54,v55
v_lshlrev_b32 v48,16,v44
v_and_b32 v49,0xffff0000,v44
v_lshlrev_b32 v50,16,v45
v_and_b32 v51,0xffff0000,v45
v_lshlrev_b32 v52,16,v46
v_and_b32 v53,0xffff0000,v46
v_lshlrev_b32 v54,16,v47
v_and_b32 v55,0xffff0000,v47
v_pk_mul_f32 v[48:49],v[48:49],v[58:59] op_sel_hi:[1,0]
v_pk_mul_f32 v[50:51],v[50:51],v[58:59] op_sel_hi:[1,0]
v_pk_mul_f32 v[52:53],v[52:53],v[58:59] op_sel_hi:[1,0]
v_pk_mul_f32 v[54:55],v[54:55],v[58:59] op_sel_hi:[1,0]
v_cvt_pk_bf16_f32 v44,v48,v49
v_cvt_pk_bf16_f32 v45,v50,v51
v_cvt_pk_bf16_f32 v46,v52,v53
v_cvt_pk_bf16_f32 v47,v54,v55
buffer_store_dwordx4 v[44:47],v0,s[8:11],s65 offen offset:1024 sc1
s_cmp_ge_u32 s2,2
s_cbranch_scc1 L_m0_11
v_lshrrev_b32 v12,3,v1
v_lshlrev_b32 v12,9,v12
v_and_b32 v13,7,v1
v_lshl_add_u32 v12,v13,4,v12
s_lshl_b32 s66,s2,2
s_add_u32 s66,s66,s46
s_and_b32 s67,s66,1
s_lshl_b32 s67,s67,8
s_and_b32 s68,s66,2
s_lshl_b32 s68,s68,6
s_add_u32 s67,s67,s68
s_and_b32 s68,s66,4
s_lshl_b32 s68,s68,10
s_add_u32 s67,s67,s68
s_add_u32 s68,s67,11534336
buffer_store_dwordx4 v[64:67],v12,s[8:11],s68 offen sc1
s_add_u32 s68,s67,12582912
buffer_store_dwordx4 v[64:67],v12,s[8:11],s68 offen sc1
s_add_u32 s68,s67,17825792
buffer_store_dwordx4 v[64:67],v12,s[8:11],s68 offen sc1
L_m0_11:
s_waitcnt vmcnt(0)
s_barrier
s_cmp_lg_u32 s46,0
s_cbranch_scc1 L_ar_12
v_mov_b32 v8,240
v_mov_b32 v9,s53
s_mov_b64 exec,1
buffer_atomic_add v9,v8,s[12:15],0 offen
s_mov_b64 exec,-1
L_ar_12:
s_mov_b32 s53,0
v_mov_b32 v123,159744
s_cmp_lg_u32 s46,0
s_cbranch_scc1 L_gbd_14
v_mov_b32 v124,240
L_gb_13:
buffer_load_dword v125,v124,s[12:15],0 offen sc1
s_waitcnt vmcnt(0)
v_readfirstlane_b32 s56,v125
ds_write_b32 v123,v125
s_bitcmp1_b32 s56,8
s_cbranch_scc1 L_gbd_14
s_sleep 4
s_sub_u32 s49,s49,1
s_cmp_gt_i32 s49,0
s_cbranch_scc1 L_gb_13
s_branch L_abort
L_gbd_14:
s_waitcnt lgkmcnt(0)
s_barrier
ds_read_b32 v125,v123
s_waitcnt lgkmcnt(0)
v_readfirstlane_b32 s56,v125
s_barrier
s_lshr_b32 s56,s56,16
s_andn2_b32 s56,s56,s3
s_cbranch_scc1 L_spread
L_x_10:
s_cmp_ge_u32 s48,6
s_cbranch_scc1 L_ra_6
v_lshrrev_b32 v2,2,v1
v_lshrrev_b32 v3,5,v1
v_xor_b32 v2,v2,v3
v_lshlrev_b32 v2,13,v2
v_and_b32 v3,3,v1
v_lshl_add_u32 v2,v3,4,v2
v_and_b32 v3,15,v1
v_lshlrev_b32 v3,2,v3
v_lshrrev_b32 v4,4,v1
v_lshl_add_u32 v3,v4,9,v3
v_and_b32 v4,1,v4
v_lshl_add_u32 v3,v4,6,v3
s_lshl_b32 s59,s46,15
s_cmp_lt_u32 s48,3
s_cselect_b32 s63,s46,0
s_lshl_b32 s56,s63,12
s_add_u32 s56,s59,s56
v_add_u32 v3,s56,v3
v_xor_b32 v4,64,v3
s_lshl_b32 s58,s47,8
s_lshl_b32 s56,s46,6
s_add_u32 s58,s58,s56
s_mov_b32 s61,0x05040100
s_mov_b32 s62,0x07060302
s_mov_b32 s4,s22
s_mov_b32 s5,s23
s_mov_b32 s6,4194304
s_mov_b32 s7,0x20000
s_xor_b32 m0,s59,0
s_xor_b32 s60,s58,0
buffer_load_dwordx4 v2,s[4:7],s60 offen lds
s_add_u32 m0,m0,1024
s_add_u32 s60,s60,131072
buffer_load_dwordx4 v2,s[4:7],s60 offen lds
s_xor_b32 m0,s59,2048
s_xor_b32 s60,s58,262144
buffer_load_dwordx4 v2,s[4:7],s60 offen lds
s_add_u32 m0,m0,1024
s_add_u32 s60,s60,131072
buffer_load_dwordx4 v2,s[4:7],s60 offen lds
s_xor_b32 m0,s59,4096
s_xor_b32 s60,s58,524288
buffer_load_dwordx4 v2,s[4:7],s60 offen lds
s_add_u32 m0,m0,1024
s_add_u32 s60,s60,131072
buffer_load_dwordx4 v2,s[4:7],s60 offen lds
s_xor_b32 m0,s59,6144
s_xor_b32 s60,s58,786432
buffer_load_dwordx4 v2,s[4:7],s60 offen lds
s_add_u32 m0,m0,1024
s_add_u32 s60,s60,131072
buffer_load_dwordx4 v2,s[4:7],s60 offen lds
s_xor_b32 m0,s59,8192
s_xor_b32 s60,s58,1048576
buffer_load_dwordx4 v2,s[4:7],s60 offen lds
s_add_u32 m0,m0,1024
s_add_u32 s60,s60,131072
buffer_load_dwordx4 v2,s[4:7],s60 offen lds
s_xor_b32 m0,s59,10240
s_xor_b32 s60,s58,1310720
buffer_load_dwordx4 v2,s[4:7],s60 offen lds
s_add_u32 m0,m0,1024
s_add_u32 s60,s60,131072
buffer_load_dwordx4 v2,s[4:7],s60 offen lds
s_xor_b32 m0,s59,12288
s_xor_b32 s60,s58,1572864
buffer_load_dwordx4 v2,s[4:7],s60 offen lds
s_add_u32 m0,m0,1024
s_add_u32 s60,s60,131072
buffer_load_dwordx4 v2,s[4:7],s60 offen lds
s_xor_b32 m0,s59,14336
s_xor_b32 s60,s58,1835008
buffer_load_dwordx4 v2,s[4:7],s60 offen lds
s_add_u32 m0,m0,1024
s_add_u32 s60,s60,131072
buffer_load_dwordx4 v2,s[4:7],s60 offen lds
s_xor_b32 m0,s59,16384
s_xor_b32 s60,s58,2097152
buffer_load_dwordx4 v2,s[4:7],s60 offen lds
s_add_u32 m0,m0,1024
s_add_u32 s60,s60,131072
buffer_load_dwordx4 v2,s[4:7],s60 offen lds
s_xor_b32 m0,s59,18432
s_xor_b32 s60,s58,2359296
buffer_load_dwordx4 v2,s[4:7],s60 offen lds
s_add_u32 m0,m0,1024
s_add_u32 s60,s60,131072
buffer_load_dwordx4 v2,s[4:7],s60 offen lds
s_xor_b32 m0,s59,20480
s_xor_b32 s60,s58,2621440
buffer_load_dwordx4 v2,s[4:7],s60 offen lds
s_add_u32 m0,m0,1024
s_add_u32 s60,s60,131072
buffer_load_dwordx4 v2,s[4:7],s60 offen lds
s_xor_b32 m0,s59,22528
s_xor_b32 s60,s58,2883584
buffer_load_dwordx4 v2,s[4:7],s60 offen lds
s_add_u32 m0,m0,1024
s_add_u32 s60,s60,131072
buffer_load_dwordx4 v2,s[4:7],s60 offen lds
s_xor_b32 m0,s59,24576
s_xor_b32 s60,s58,3145728
buffer_load_dwordx4 v2,s[4:7],s60 offen lds
s_add_u32 m0,m0,1024
s_add_u32 s60,s60,131072
buffer_load_dwordx4 v2,s[4:7],s60 offen lds
s_xor_b32 m0,s59,26624
s_xor_b32 s60,s58,3407872
buffer_load_dwordx4 v2,s[4:7],s60 offen lds
s_add_u32 m0,m0,1024
s_add_u32 s60,s60,131072
buffer_load_dwordx4 v2,s[4:7],s60 offen lds
s_xor_b32 m0,s59,28672
s_xor_b32 s60,s58,3670016
buffer_load_dwordx4 v2,s[4:7],s60 offen lds
s_add_u32 m0,m0,1024
s_add_u32 s60,s60,131072
buffer_load_dwordx4 v2,s[4:7],s60 offen lds
s_xor_b32 m0,s59,30720
s_xor_b32 s60,s58,3932160
buffer_load_dwordx4 v2,s[4:7],s60 offen lds
s_add_u32 m0,m0,1024
s_add_u32 s60,s60,131072
buffer_load_dwordx4 v2,s[4:7],s60 offen lds
s_cmp_eq_u32 s53,0
s_cbranch_scc1 L_m0_15
s_waitcnt vmcnt(40)
v_lshlrev_b32 v32,16,v24
v_and_b32 v33,0xffff0000,v24
v_lshlrev_b32 v34,16,v25
v_and_b32 v35,0xffff0000,v25
v_lshlrev_b32 v36,16,v26
v_and_b32 v37,0xffff0000,v26
v_lshlrev_b32 v38,16,v27
v_and_b32 v39,0xffff0000,v27
v_readfirstlane_b32 s78,v32
s_nop 1
v_pk_add_f32 v[48:49],v[32:33],s[78:79] op_sel_hi:[1,0] neg_lo:[0,1] neg_hi:[0,1]
v_pk_add_f32 v[50:51],v[34:35],s[78:79] op_sel_hi:[1,0] neg_lo:[0,1] neg_hi:[0,1]
v_pk_add_f32 v[52:53],v[36:37],s[78:79] op_sel_hi:[1,0] neg_lo:[0,1] neg_hi:[0,1]
v_pk_add_f32 v[54:55],v[38:39],s[78:79] op_sel_hi:[1,0] neg_lo:[0,1] neg_hi:[0,1]
v_pk_add_f32 v[56:57],v[48:49],v[50:51]
v_pk_mul_f32 v[58:59],v[48:49],v[48:49]
v_pk_add_f32 v[60:61],v[52:53],v[54:55]
v_pk_fma_f32 v[58:59],v[50:51],v[50:51],v[58:59]
v_pk_add_f32 v[56:57],v[56:57],v[60:61]
v_pk_fma_f32 v[58:59],v[52:53],v[52:53],v[58:59]
v_add_f32 v56,v56,v57
v_pk_fma_f32 v[58:59],v[54:55],v[54:55],v[58:59]
v_add_f32 v58,v58,v59
s_nop 1
v_permlane32_swap_b32 v56,v58
v_add_f32 v56,v56,v58
s_nop 1
v_add_f32_dpp v56,v56,v56 row_ror:8 row_mask:0xf bank_mask:0xf
s_nop 1
v_add_f32_dpp v56,v56,v56 row_ror:4 row_mask:0xf bank_mask:0xf
s_nop 1
v_add_f32_dpp v56,v56,v56 row_ror:2 row_mask:0xf bank_mask:0xf
s_nop 1
v_add_f32_dpp v56,v56,v56 row_ror:1 row_mask:0xf bank_mask:0xf
v_mov_b32 v58,v56
s_nop 1
v_permlane16_swap_b32 v56,v58
v_add_f32 v56,v56,v58
v_mul_f32 v56,0x3b000000,v56
v_mov_b32 v58,v56
s_nop 1
v_permlane32_swap_b32 v56,v58
v_fma_f32 v58,-v56,v56,v58
v_add_f32 v56,s78,v56
v_max_f32 v58,0,v58
v_cvt_pk_bf16_f32 v58,v56,v58
v_lshlrev_b32 v56,16,v58
v_and_b32 v58,0xffff0000,v58
v_add_f32 v58,0x3727c5ac,v58
v_cvt_pk_bf16_f32 v58,v58,v58
v_and_b32 v58,0xffff0000,v58
v_sqrt_f32 v58,v58
v_pk_add_f32 v[48:49],v[32:33],v[56:57] op_sel_hi:[1,0] neg_lo:[0,1] neg_hi:[0,1]
v_pk_add_f32 v[50:51],v[34:35],v[56:57] op_sel_hi:[1,0] neg_lo:[0,1] neg_hi:[0,1]
v_pk_add_f32 v[52:53],v[36:37],v[56:57] op_sel_hi:[1,0] neg_lo:[0,1] neg_hi:[0,1]
v_pk_add_f32 v[54:55],v[38:39],v[56:57] op_sel_hi:[1,0] neg_lo:[0,1] neg_hi:[0,1]
v_cvt_pk_bf16_f32 v58,v58,v58
v_and_b32 v58,0xffff0000,v58
v_rcp_f32 v58,v58
v_cvt_pk_bf16_f32 v40,v48,v49
v_cvt_pk_bf16_f32 v41,v50,v51
v_cvt_pk_bf16_f32 v42,v52,v53
v_cvt_pk_bf16_f32 v43,v54,v55
v_lshlrev_b32 v48,16,v40
v_and_b32 v49,0xffff0000,v40
v_lshlrev_b32 v50,16,v41
v_and_b32 v51,0xffff0000,v41
v_lshlrev_b32 v52,16,v42
v_and_b32 v53,0xffff0000,v42
v_lshlrev_b32 v54,16,v43
v_and_b32 v55,0xffff0000,v43
v_pk_mul_f32 v[48:49],v[48:49],v[58:59] op_sel_hi:[1,0]
v_pk_mul_f32 v[50:51],v[50:51],v[58:59] op_sel_hi:[1,0]
v_pk_mul_f32 v[52:53],v[52:53],v[58:59] op_sel_hi:[1,0]
v_pk_mul_f32 v[54:55],v[54:55],v[58:59] op_sel_hi:[1,0]
v_cvt_pk_bf16_f32 v40,v48,v49
v_cvt_pk_bf16_f32 v41,v50,v51
v_cvt_pk_bf16_f32 v42,v52,v53
v_cvt_pk_bf16_f32 v43,v54,v55
buffer_store_dwordx4 v[40:43],v0,s[8:11],s65 offen offset:0 sc1
v_lshlrev_b32 v32,16,v28
v_and_b32 v33,0xffff0000,v28
v_lshlrev_b32 v34,16,v29
v_and_b32 v35,0xffff0000,v29
v_lshlrev_b32 v36,16,v30
v_and_b32 v37,0xffff0000,v30
v_lshlrev_b32 v38,16,v31
v_and_b32 v39,0xffff0000,v31
v_readfirstlane_b32 s78,v32
s_nop 1
v_pk_add_f32 v[48:49],v[32:33],s[78:79] op_sel_hi:[1,0] neg_lo:[0,1] neg_hi:[0,1]
v_pk_add_f32 v[50:51],v[34:35],s[78:79] op_sel_hi:[1,0] neg_lo:[0,1] neg_hi:[0,1]
v_pk_add_f32 v[52:53],v[36:37],s[78:79] op_sel_hi:[1,0] neg_lo:[0,1] neg_hi:[0,1]
v_pk_add_f32 v[54:55],v[38:39],s[78:79] op_sel_hi:[1,0] neg_lo:[0,1] neg_hi:[0,1]
v_pk_add_f32 v[56:57],v[48:49],v[50:51]
v_pk_mul_f32 v[58:59],v[48:49],v[48:49]
v_pk_add_f32 v[60:61],v[52:53],v[54:55]
v_pk_fma_f32 v[58:59],v[50:51],v[50:51],v[58:59]
v_pk_add_f32 v[56:57],v[56:57],v[60:61]
v_pk_fma_f32 v[58:59],v[52:53],v[52:53],v[58:59]
v_add_f32 v56,v56,v57
v_pk_fma_f32 v[58:59],v[54:55],v[54:55],v[58:59]
v_add_f32 v58,v58,v59
s_nop 1
v_permlane32_swap_b32 v56,v58
v_add_f32 v56,v56,v58
s_nop 1
v_add_f32_dpp v56,v56,v56 row_ror:8 row_mask:0xf bank_mask:0xf
s_nop 1
v_add_f32_dpp v56,v56,v56 row_ror:4 row_mask:0xf bank_mask:0xf
s_nop 1
v_add_f32_dpp v56,v56,v56 row_ror:2 row_mask:0xf bank_mask:0xf
s_nop 1
v_add_f32_dpp v56,v56,v56 row_ror:1 row_mask:0xf bank_mask:0xf
v_mov_b32 v58,v56
s_nop 1
v_permlane16_swap_b32 v56,v58
v_add_f32 v56,v56,v58
v_mul_f32 v56,0x3b000000,v56
v_mov_b32 v58,v56
s_nop 1
v_permlane32_swap_b32 v56,v58
v_fma_f32 v58,-v56,v56,v58
v_add_f32 v56,s78,v56
v_max_f32 v58,0,v58
v_cvt_pk_bf16_f32 v58,v56,v58
v_lshlrev_b32 v56,16,v58
v_and_b32 v58,0xffff0000,v58
v_add_f32 v58,0x3727c5ac,v58
v_cvt_pk_bf16_f32 v58,v58,v58
v_and_b32 v58,0xffff0000,v58
v_sqrt_f32 v58,v58
v_pk_add_f32 v[48:49],v[32:33],v[56:57] op_sel_hi:[1,0] neg_lo:[0,1] neg_hi:[0,1]
v_pk_add_f32 v[50:51],v[34:35],v[56:57] op_sel_hi:[1,0] neg_lo:[0,1] neg_hi:[0,1]
v_pk_add_f32 v[52:53],v[36:37],v[56:57] op_sel_hi:[1,0] neg_lo:[0,1] neg_hi:[0,1]
v_pk_add_f32 v[54:55],v[38:39],v[56:57] op_sel_hi:[1,0] neg_lo:[0,1] neg_hi:[0,1]
v_cvt_pk_bf16_f32 v58,v58,v58
v_and_b32 v58,0xffff0000,v58
v_rcp_f32 v58,v58
v_cvt_pk_bf16_f32 v44,v48,v49
v_cvt_pk_bf16_f32 v45,v50,v51
v_cvt_pk_bf16_f32 v46,v52,v53
v_cvt_pk_bf16_f32 v47,v54,v55
v_lshlrev_b32 v48,16,v44
v_and_b32 v49,0xffff0000,v44
v_lshlrev_b32 v50,16,v45
v_and_b32 v51,0xffff0000,v45
v_lshlrev_b32 v52,16,v46
v_and_b32 v53,0xffff0000,v46
v_lshlrev_b32 v54,16,v47
v_and_b32 v55,0xffff0000,v47
v_pk_mul_f32 v[48:49],v[48:49],v[58:59] op_sel_hi:[1,0]
v_pk_mul_f32 v[50:51],v[50:51],v[58:59] op_sel_hi:[1,0]
v_pk_mul_f32 v[52:53],v[52:53],v[58:59] op_sel_hi:[1,0]
v_pk_mul_f32 v[54:55],v[54:55],v[58:59] op_sel_hi:[1,0]
v_cvt_pk_bf16_f32 v44,v48,v49
v_cvt_pk_bf16_f32 v45,v50,v51
v_cvt_pk_bf16_f32 v46,v52,v53
v_cvt_pk_bf16_f32 v47,v54,v55
buffer_store_dwordx4 v[44:47],v0,s[8:11],s65 offen offset:1024 sc1
s_cmp_ge_u32 s2,2
s_cbranch_scc1 L_m0_15
v_lshrrev_b32 v12,3,v1
v_lshlrev_b32 v12,9,v12
v_and_b32 v13,7,v1
v_lshl_add_u32 v12,v13,4,v12
s_lshl_b32 s66,s2,2
s_add_u32 s66,s66,s46
s_and_b32 s67,s66,1
s_lshl_b32 s67,s67,8
s_and_b32 s68,s66,2
s_lshl_b32 s68,s68,6
s_add_u32 s67,s67,s68
s_and_b32 s68,s66,4
s_lshl_b32 s68,s68,10
s_add_u32 s67,s67,s68
s_add_u32 s68,s67,11534336
buffer_store_dwordx4 v[64:67],v12,s[8:11],s68 offen sc1
s_add_u32 s68,s67,12582912
buffer_store_dwordx4 v[64:67],v12,s[8:11],s68 offen sc1
s_add_u32 s68,s67,17825792
buffer_store_dwordx4 v[64:67],v12,s[8:11],s68 offen sc1
L_m0_15:
s_waitcnt vmcnt(16)
v_xor_b32 v5,0,v3
v_xor_b32 v6,0,v4
ds_read2_b32 v[96:97],v5 offset1:32
ds_read2_b32 v[100:101],v6 offset1:32
ds_read2_b32 v[98:99],v5 offset0:64 offset1:96
ds_read2_b32 v[102:103],v6 offset0:64 offset1:96
v_xor_b32 v5,2048,v3
v_xor_b32 v6,2048,v4
ds_read2_b32 v[104:105],v5 offset1:32
ds_read2_b32 v[108:109],v6 offset1:32
ds_read2_b32 v[106:107],v5 offset0:64 offset1:96
ds_read2_b32 v[110:111],v6 offset0:64 offset1:96
s_waitcnt lgkmcnt(4)
v_perm_b32 v112,v100,v96,s61
v_perm_b32 v113,v101,v97,s61
v_perm_b32 v114,v102,v98,s61
v_perm_b32 v115,v103,v99,s61
v_perm_b32 v116,v100,v96,s62
v_perm_b32 v117,v101,v97,s62
v_perm_b32 v118,v102,v98,s62
v_perm_b32 v119,v103,v99,s62
v_accvgpr_write_b32 a128,v112
v_accvgpr_write_b32 a129,v113
v_accvgpr_write_b32 a130,v114
v_accvgpr_write_b32 a131,v115
v_accvgpr_write_b32 a136,v116
v_accvgpr_write_b32 a137,v117
v_accvgpr_write_b32 a138,v118
v_accvgpr_write_b32 a139,v119
v_xor_b32 v5,4096,v3
v_xor_b32 v6,4096,v4
ds_read2_b32 v[96:97],v5 offset1:32
ds_read2_b32 v[100:101],v6 offset1:32
ds_read2_b32 v[98:99],v5 offset0:64 offset1:96
ds_read2_b32 v[102:103],v6 offset0:64 offset1:96
s_waitcnt lgkmcnt(4)
v_perm_b32 v112,v108,v104,s61
v_perm_b32 v113,v109,v105,s61
v_perm_b32 v114,v110,v106,s61
v_perm_b32 v115,v111,v107,s61
v_perm_b32 v116,v108,v104,s62
v_perm_b32 v117,v109,v105,s62
v_perm_b32 v118,v110,v106,s62
v_perm_b32 v119,v111,v107,s62
v_accvgpr_write_b32 a132,v112
v_accvgpr_write_b32 a133,v113
v_accvgpr_write_b32 a134,v114
v_accvgpr_write_b32 a135,v115
v_accvgpr_write_b32 a140,v116
v_accvgpr_write_b32 a141,v117
v_accvgpr_write_b32 a142,v118
v_accvgpr_write_b32 a143,v119
v_xor_b32 v5,6144,v3
v_xor_b32 v6,6144,v4
ds_read2_b32 v[104:105],v5 offset1:32
ds_read2_b32 v[108:109],v6 offset1:32
ds_read2_b32 v[106:107],v5 offset0:64 offset1:96
ds_read2_b32 v[110:111],v6 offset0:64 offset1:96
s_waitcnt lgkmcnt(4)
v_perm_b32 v112,v100,v96,s61
v_perm_b32 v113,v101,v97,s61
v_perm_b32 v114,v102,v98,s61
v_perm_b32 v115,v103,v99,s61
v_perm_b32 v116,v100,v96,s62
v_perm_b32 v117,v101,v97,s62
v_perm_b32 v118,v102,v98,s62
v_perm_b32 v119,v103,v99,s62
v_accvgpr_write_b32 a144,v112
v_accvgpr_write_b32 a145,v113
v_accvgpr_write_b32 a146,v114
v_accvgpr_write_b32 a147,v115
v_accvgpr_write_b32 a152,v116
v_accvgpr_write_b32 a153,v117
v_accvgpr_write_b32 a154,v118
v_accvgpr_write_b32 a155,v119
v_xor_b32 v5,8192,v3
v_xor_b32 v6,8192,v4
ds_read2_b32 v[96:97],v5 offset1:32
ds_read2_b32 v[100:101],v6 offset1:32
ds_read2_b32 v[98:99],v5 offset0:64 offset1:96
ds_read2_b32 v[102:103],v6 offset0:64 offset1:96
s_waitcnt lgkmcnt(4)
v_perm_b32 v112,v108,v104,s61
v_perm_b32 v113,v109,v105,s61
v_perm_b32 v114,v110,v106,s61
v_perm_b32 v115,v111,v107,s61
v_perm_b32 v116,v108,v104,s62
v_perm_b32 v117,v109,v105,s62
v_perm_b32 v118,v110,v106,s62
v_perm_b32 v119,v111,v107,s62
v_accvgpr_write_b32 a148,v112
v_accvgpr_write_b32 a149,v113
v_accvgpr_write_b32 a150,v114
v_accvgpr_write_b32 a151,v115
v_accvgpr_write_b32 a156,v116
v_accvgpr_write_b32 a157,v117
v_accvgpr_write_b32 a158,v118
v_accvgpr_write_b32 a159,v119
v_xor_b32 v5,10240,v3
v_xor_b32 v6,10240,v4
ds_read2_b32 v[104:105],v5 offset1:32
ds_read2_b32 v[108:109],v6 offset1:32
ds_read2_b32 v[106:107],v5 offset0:64 offset1:96
ds_read2_b32 v[110:111],v6 offset0:64 offset1:96
s_waitcnt lgkmcnt(4)
v_perm_b32 v112,v100,v96,s61
v_perm_b32 v113,v101,v97,s61
v_perm_b32 v114,v102,v98,s61
v_perm_b32 v115,v103,v99,s61
v_perm_b32 v116,v100,v96,s62
v_perm_b32 v117,v101,v97,s62
v_perm_b32 v118,v102,v98,s62
v_perm_b32 v119,v103,v99,s62
v_accvgpr_write_b32 a160,v112
v_accvgpr_write_b32 a161,v113
v_accvgpr_write_b32 a162,v114
v_accvgpr_write_b32 a163,v115
v_accvgpr_write_b32 a168,v116
v_accvgpr_write_b32 a169,v117
v_accvgpr_write_b32 a170,v118
v_accvgpr_write_b32 a171,v119
v_xor_b32 v5,12288,v3
v_xor_b32 v6,12288,v4
ds_read2_b32 v[96:97],v5 offset1:32
ds_read2_b32 v[100:101],v6 offset1:32
ds_read2_b32 v[98:99],v5 offset0:64 offset1:96
ds_read2_b32 v[102:103],v6 offset0:64 offset1:96
s_waitcnt lgkmcnt(4)
v_perm_b32 v112,v108,v104,s61
v_perm_b32 v113,v109,v105,s61
v_perm_b32 v114,v110,v106,s61
v_perm_b32 v115,v111,v107,s61
v_perm_b32 v116,v108,v104,s62
v_perm_b32 v117,v109,v105,s62
v_perm_b32 v118,v110,v106,s62
v_perm_b32 v119,v111,v107,s62
v_accvgpr_write_b32 a164,v112
v_accvgpr_write_b32 a165,v113
v_accvgpr_write_b32 a166,v114
v_accvgpr_write_b32 a167,v115
v_accvgpr_write_b32 a172,v116
v_accvgpr_write_b32 a173,v117
v_accvgpr_write_b32 a174,v118
v_accvgpr_write_b32 a175,v119
v_xor_b32 v5,14336,v3
v_xor_b32 v6,14336,v4
ds_read2_b32 v[104:105],v5 offset1:32
ds_read2_b32 v[108:109],v6 offset1:32
ds_read2_b32 v[106:107],v5 offset0:64 offset1:96
ds_read2_b32 v[110:111],v6 offset0:64 offset1:96
s_waitcnt lgkmcnt(4)
v_perm_b32 v112,v100,v96,s61
v_perm_b32 v113,v101,v97,s61
v_perm_b32 v114,v102,v98,s61
v_perm_b32 v115,v103,v99,s61
v_perm_b32 v116,v100,v96,s62
v_perm_b32 v117,v101,v97,s62
v_perm_b32 v118,v102,v98,s62
v_perm_b32 v119,v103,v99,s62
v_accvgpr_write_b32 a176,v112
v_accvgpr_write_b32 a177,v113
v_accvgpr_write_b32 a178,v114
v_accvgpr_write_b32 a179,v115
v_accvgpr_write_b32 a184,v116
v_accvgpr_write_b32 a185,v117
v_accvgpr_write_b32 a186,v118
v_accvgpr_write_b32 a187,v119
s_waitcnt lgkmcnt(0)
s_mov_b32 s4,s24
s_mov_b32 s5,s25
s_mov_b32 s6,4194304
s_mov_b32 s7,0x20000
s_xor_b32 m0,s59,0
s_xor_b32 s60,s58,0
buffer_load_dwordx4 v2,s[4:7],s60 offen lds
s_add_u32 m0,m0,1024
s_add_u32 s60,s60,131072
buffer_load_dwordx4 v2,s[4:7],s60 offen lds
s_xor_b32 m0,s59,2048
s_xor_b32 s60,s58,262144
buffer_load_dwordx4 v2,s[4:7],s60 offen lds
s_add_u32 m0,m0,1024
s_add_u32 s60,s60,131072
buffer_load_dwordx4 v2,s[4:7],s60 offen lds
s_xor_b32 m0,s59,4096
s_xor_b32 s60,s58,524288
buffer_load_dwordx4 v2,s[4:7],s60 offen lds
s_add_u32 m0,m0,1024
s_add_u32 s60,s60,131072
buffer_load_dwordx4 v2,s[4:7],s60 offen lds
s_xor_b32 m0,s59,6144
s_xor_b32 s60,s58,786432
buffer_load_dwordx4 v2,s[4:7],s60 offen lds
s_add_u32 m0,m0,1024
s_add_u32 s60,s60,131072
buffer_load_dwordx4 v2,s[4:7],s60 offen lds
s_xor_b32 m0,s59,8192
s_xor_b32 s60,s58,1048576
buffer_load_dwordx4 v2,s[4:7],s60 offen lds
s_add_u32 m0,m0,1024
s_add_u32 s60,s60,131072
buffer_load_dwordx4 v2,s[4:7],s60 offen lds
s_xor_b32 m0,s59,10240
s_xor_b32 s60,s58,1310720
buffer_load_dwordx4 v2,s[4:7],s60 offen lds
s_add_u32 m0,m0,1024
s_add_u32 s60,s60,131072
buffer_load_dwordx4 v2,s[4:7],s60 offen lds
s_xor_b32 m0,s59,12288
s_xor_b32 s60,s58,1572864
buffer_load_dwordx4 v2,s[4:7],s60 offen lds
s_add_u32 m0,m0,1024
s_add_u32 s60,s60,131072
buffer_load_dwordx4 v2,s[4:7],s60 offen lds
s_xor_b32 m0,s59,14336
s_xor_b32 s60,s58,1835008
buffer_load_dwordx4 v2,s[4:7],s60 offen lds
s_add_u32 m0,m0,1024
s_add_u32 s60,s60,131072
buffer_load_dwordx4 v2,s[4:7],s60 offen lds
v_perm_b32 v112,v108,v104,s61
v_perm_b32 v113,v109,v105,s61
v_perm_b32 v114,v110,v106,s61
v_perm_b32 v115,v111,v107,s61
v_perm_b32 v116,v108,v104,s62
v_perm_b32 v117,v109,v105,s62
v_perm_b32 v118,v110,v106,s62
v_perm_b32 v119,v111,v107,s62
v_accvgpr_write_b32 a180,v112
v_accvgpr_write_b32 a181,v113
v_accvgpr_write_b32 a182,v114
v_accvgpr_write_b32 a183,v115
v_accvgpr_write_b32 a188,v116
v_accvgpr_write_b32 a189,v117
v_accvgpr_write_b32 a190,v118
v_accvgpr_write_b32 a191,v119
s_waitcnt vmcnt(16)
s_barrier
s_cmp_lg_u32 s46,0
s_cbranch_scc1 L_ar_16
v_mov_b32 v8,240
v_mov_b32 v9,s53
s_mov_b64 exec,1
buffer_atomic_add v9,v8,s[12:15],0 offen
s_mov_b64 exec,-1
L_ar_16:
s_mov_b32 s53,0
v_xor_b32 v5,16384,v3
v_xor_b32 v6,16384,v4
ds_read2_b32 v[96:97],v5 offset1:32
ds_read2_b32 v[100:101],v6 offset1:32
ds_read2_b32 v[98:99],v5 offset0:64 offset1:96
ds_read2_b32 v[102:103],v6 offset0:64 offset1:96
v_xor_b32 v5,18432,v3
v_xor_b32 v6,18432,v4
ds_read2_b32 v[104:105],v5 offset1:32
ds_read2_b32 v[108:109],v6 offset1:32
ds_read2_b32 v[106:107],v5 offset0:64 offset1:96
ds_read2_b32 v[110:111],v6 offset0:64 offset1:96
s_waitcnt lgkmcnt(4)
v_perm_b32 v112,v100,v96,s61
v_perm_b32 v113,v101,v97,s61
v_perm_b32 v114,v102,v98,s61
v_perm_b32 v115,v103,v99,s61
v_perm_b32 v116,v100,v96,s62
v_perm_b32 v117,v101,v97,s62
v_perm_b32 v118,v102,v98,s62
v_perm_b32 v119,v103,v99,s62
v_accvgpr_write_b32 a192,v112
v_accvgpr_write_b32 a193,v113
v_accvgpr_write_b32 a194,v114
v_accvgpr_write_b32 a195,v115
v_accvgpr_write_b32 a200,v116
v_accvgpr_write_b32 a201,v117
v_accvgpr_write_b32 a202,v118
v_accvgpr_write_b32 a203,v119
v_xor_b32 v5,20480,v3
v_xor_b32 v6,20480,v4
ds_read2_b32 v[96:97],v5 offset1:32
ds_read2_b32 v[100:101],v6 offset1:32
ds_read2_b32 v[98:99],v5 offset0:64 offset1:96
ds_read2_b32 v[102:103],v6 offset0:64 offset1:96
s_waitcnt lgkmcnt(4)
v_perm_b32 v112,v108,v104,s61
v_perm_b32 v113,v109,v105,s61
v_perm_b32 v114,v110,v106,s61
v_perm_b32 v115,v111,v107,s61
v_perm_b32 v116,v108,v104,s62
v_perm_b32 v117,v109,v105,s62
v_perm_b32 v118,v110,v106,s62
v_perm_b32 v119,v111,v107,s62
v_accvgpr_write_b32 a196,v112
v_accvgpr_write_b32 a197,v113
v_accvgpr_write_b32 a198,v114
v_accvgpr_write_b32 a199,v115
v_accvgpr_write_b32 a204,v116
v_accvgpr_write_b32 a205,v117
v_accvgpr_write_b32 a206,v118
v_accvgpr_write_b32 a207,v119
v_xor_b32 v5,22528,v3
v_xor_b32 v6,22528,v4
ds_read2_b32 v[104:105],v5 offset1:32
ds_read2_b32 v[108:109],v6 offset1:32
ds_read2_b32 v[106:107],v5 offset0:64 offset1:96
ds_read2_b32 v[110:111],v6 offset0:64 offset1:96
s_waitcnt lgkmcnt(4)
v_perm_b32 v112,v100,v96,s61
v_perm_b32 v113,v101,v97,s61
v_perm_b32 v114,v102,v98,s61
v_perm_b32 v115,v103,v99,s61
v_perm_b32 v116,v100,v96,s62
v_perm_b32 v117,v101,v97,s62
v_perm_b32 v118,v102,v98,s62
v_perm_b32 v119,v103,v99,s62
v_accvgpr_write_b32 a208,v112
v_accvgpr_write_b32 a209,v113
v_accvgpr_write_b32 a210,v114
v_accvgpr_write_b32 a211,v115
v_accvgpr_write_b32 a216,v116
v_accvgpr_write_b32 a217,v117
v_accvgpr_write_b32 a218,v118
v_accvgpr_write_b32 a219,v119
v_xor_b32 v5,24576,v3
v_xor_b32 v6,24576,v4
ds_read2_b32 v[96:97],v5 offset1:32
ds_read2_b32 v[100:101],v6 offset1:32
ds_read2_b32 v[98:99],v5 offset0:64 offset1:96
ds_read2_b32 v[102:103],v6 offset0:64 offset1:96
s_waitcnt lgkmcnt(4)
v_perm_b32 v112,v108,v104,s61
v_perm_b32 v113,v109,v105,s61
v_perm_b32 v114,v110,v106,s61
v_perm_b32 v115,v111,v107,s61
v_perm_b32 v116,v108,v104,s62
v_perm_b32 v117,v109,v105,s62
v_perm_b32 v118,v110,v106,s62
v_perm_b32 v119,v111,v107,s62
v_accvgpr_write_b32 a212,v112
v_accvgpr_write_b32 a213,v113
v_accvgpr_write_b32 a214,v114
v_accvgpr_write_b32 a215,v115
v_accvgpr_write_b32 a220,v116
v_accvgpr_write_b32 a221,v117
v_accvgpr_write_b32 a222,v118
v_accvgpr_write_b32 a223,v119
v_xor_b32 v5,26624,v3
v_xor_b32 v6,26624,v4
ds_read2_b32 v[104:105],v5 offset1:32
ds_read2_b32 v[108:109],v6 offset1:32
ds_read2_b32 v[106:107],v5 offset0:64 offset1:96
ds_read2_b32 v[110:111],v6 offset0:64 offset1:96
s_waitcnt lgkmcnt(4)
v_perm_b32 v112,v100,v96,s61
v_perm_b32 v113,v101,v97,s61
v_perm_b32 v114,v102,v98,s61
v_perm_b32 v115,v103,v99,s61
v_perm_b32 v116,v100,v96,s62
v_perm_b32 v117,v101,v97,s62
v_perm_b32 v118,v102,v98,s62
v_perm_b32 v119,v103,v99,s62
v_accvgpr_write_b32 a224,v112
v_accvgpr_write_b32 a225,v113
v_accvgpr_write_b32 a226,v114
v_accvgpr_write_b32 a227,v115
v_accvgpr_write_b32 a232,v116
v_accvgpr_write_b32 a233,v117
v_accvgpr_write_b32 a234,v118
v_accvgpr_write_b32 a235,v119
v_xor_b32 v5,28672,v3
v_xor_b32 v6,28672,v4
ds_read2_b32 v[96:97],v5 offset1:32
ds_read2_b32 v[100:101],v6 offset1:32
ds_read2_b32 v[98:99],v5 offset0:64 offset1:96
ds_read2_b32 v[102:103],v6 offset0:64 offset1:96
s_waitcnt lgkmcnt(4)
v_perm_b32 v112,v108,v104,s61
v_perm_b32 v113,v109,v105,s61
v_perm_b32 v114,v110,v106,s61
v_perm_b32 v115,v111,v107,s61
v_perm_b32 v116,v108,v104,s62
v_perm_b32 v117,v109,v105,s62
v_perm_b32 v118,v110,v106,s62
v_perm_b32 v119,v111,v107,s62
v_accvgpr_write_b32 a228,v112
v_accvgpr_write_b32 a229,v113
v_accvgpr_write_b32 a230,v114
v_accvgpr_write_b32 a231,v115
v_accvgpr_write_b32 a236,v116
v_accvgpr_write_b32 a237,v117
v_accvgpr_write_b32 a238,v118
v_accvgpr_write_b32 a239,v119
v_xor_b32 v5,30720,v3
v_xor_b32 v6,30720,v4
ds_read2_b32 v[104:105],v5 offset1:32
ds_read2_b32 v[108:109],v6 offset1:32
ds_read2_b32 v[106:107],v5 offset0:64 offset1:96
ds_read2_b32 v[110:111],v6 offset0:64 offset1:96
s_waitcnt lgkmcnt(4)
v_perm_b32 v112,v100,v96,s61
v_perm_b32 v113,v101,v97,s61
v_perm_b32 v114,v102,v98,s61
v_perm_b32 v115,v103,v99,s61
v_perm_b32 v116,v100,v96,s62
v_perm_b32 v117,v101,v97,s62
v_perm_b32 v118,v102,v98,s62
v_perm_b32 v119,v103,v99,s62
v_accvgpr_write_b32 a240,v112
v_accvgpr_write_b32 a241,v113
v_accvgpr_write_b32 a242,v114
v_accvgpr_write_b32 a243,v115
v_accvgpr_write_b32 a248,v116
v_accvgpr_write_b32 a249,v117
v_accvgpr_write_b32 a250,v118
v_accvgpr_write_b32 a251,v119
s_waitcnt lgkmcnt(0)
s_xor_b32 m0,s59,16384
s_xor_b32 s60,s58,2097152
buffer_load_dwordx4 v2,s[4:7],s60 offen lds
s_add_u32 m0,m0,1024
s_add_u32 s60,s60,131072
buffer_load_dwordx4 v2,s[4:7],s60 offen lds
s_xor_b32 m0,s59,18432
s_xor_b32 s60,s58,2359296
buffer_load_dwordx4 v2,s[4:7],s60 offen lds
s_add_u32 m0,m0,1024
s_add_u32 s60,s60,131072
buffer_load_dwordx4 v2,s[4:7],s60 offen lds
s_xor_b32 m0,s59,20480
s_xor_b32 s60,s58,2621440
buffer_load_dwordx4 v2,s[4:7],s60 offen lds
s_add_u32 m0,m0,1024
s_add_u32 s60,s60,131072
buffer_load_dwordx4 v2,s[4:7],s60 offen lds
s_xor_b32 m0,s59,22528
s_xor_b32 s60,s58,2883584
buffer_load_dwordx4 v2,s[4:7],s60 offen lds
s_add_u32 m0,m0,1024
s_add_u32 s60,s60,131072
buffer_load_dwordx4 v2,s[4:7],s60 offen lds
s_xor_b32 m0,s59,24576
s_xor_b32 s60,s58,3145728
buffer_load_dwordx4 v2,s[4:7],s60 offen lds
s_add_u32 m0,m0,1024
s_add_u32 s60,s60,131072
buffer_load_dwordx4 v2,s[4:7],s60 offen lds
s_xor_b32 m0,s59,26624
s_xor_b32 s60,s58,3407872
buffer_load_dwordx4 v2,s[4:7],s60 offen lds
s_add_u32 m0,m0,1024
s_add_u32 s60,s60,131072
buffer_load_dwordx4 v2,s[4:7],s60 offen lds
s_xor_b32 m0,s59,28672
s_xor_b32 s60,s58,3670016
buffer_load_dwordx4 v2,s[4:7],s60 offen lds
s_add_u32 m0,m0,1024
s_add_u32 s60,s60,131072
buffer_load_dwordx4 v2,s[4:7],s60 offen lds
s_xor_b32 m0,s59,30720
s_xor_b32 s60,s58,3932160
buffer_load_dwordx4 v2,s[4:7],s60 offen lds
s_add_u32 m0,m0,1024
s_add_u32 s60,s60,131072
buffer_load_dwordx4 v2,s[4:7],s60 offen lds
v_perm_b32 v112,v108,v104,s61
v_perm_b32 v113,v109,v105,s61
v_perm_b32 v114,v110,v106,s61
v_perm_b32 v115,v111,v107,s61
v_perm_b32 v116,v108,v104,s62
v_perm_b32 v117,v109,v105,s62
v_perm_b32 v118,v110,v106,s62
v_perm_b32 v119,v111,v107,s62
v_accvgpr_write_b32 a244,v112
v_accvgpr_write_b32 a245,v113
v_accvgpr_write_b32 a246,v114
v_accvgpr_write_b32 a247,v115
v_accvgpr_write_b32 a252,v116
v_accvgpr_write_b32 a253,v117
v_accvgpr_write_b32 a254,v118
v_accvgpr_write_b32 a255,v119
s_waitcnt vmcnt(16)
v_xor_b32 v5,0,v3
v_xor_b32 v6,0,v4
ds_read2_b32 v[96:97],v5 offset1:32
ds_read2_b32 v[100:101],v6 offset1:32
ds_read2_b32 v[98:99],v5 offset0:64 offset1:96
ds_read2_b32 v[102:103],v6 offset0:64 offset1:96
v_xor_b32 v5,2048,v3
v_xor_b32 v6,2048,v4
ds_read2_b32 v[104:105],v5 offset1:32
ds_read2_b32 v[108:109],v6 offset1:32
ds_read2_b32 v[106:107],v5 offset0:64 offset1:96
ds_read2_b32 v[110:111],v6 offset0:64 offset1:96
s_waitcnt lgkmcnt(4)
v_perm_b32 v128,v100,v96,s61
v_perm_b32 v129,v101,v97,s61
v_perm_b32 v130,v102,v98,s61
v_perm_b32 v131,v103,v99,s61
v_perm_b32 v136,v100,v96,s62
v_perm_b32 v137,v101,v97,s62
v_perm_b32 v138,v102,v98,s62
v_perm_b32 v139,v103,v99,s62
v_xor_b32 v5,4096,v3
v_xor_b32 v6,4096,v4
ds_read2_b32 v[96:97],v5 offset1:32
ds_read2_b32 v[100:101],v6 offset1:32
ds_read2_b32 v[98:99],v5 offset0:64 offset1:96
ds_read2_b32 v[102:103],v6 offset0:64 offset1:96
s_waitcnt lgkmcnt(4)
v_perm_b32 v132,v108,v104,s61
v_perm_b32 v133,v109,v105,s61
v_perm_b32 v134,v110,v106,s61
v_perm_b32 v135,v111,v107,s61
v_perm_b32 v140,v108,v104,s62
v_perm_b32 v141,v109,v105,s62
v_perm_b32 v142,v110,v106,s62
v_perm_b32 v143,v111,v107,s62
v_xor_b32 v5,6144,v3
v_xor_b32 v6,6144,v4
ds_read2_b32 v[104:105],v5 offset1:32
ds_read2_b32 v[108:109],v6 offset1:32
ds_read2_b32 v[106:107],v5 offset0:64 offset1:96
ds_read2_b32 v[110:111],v6 offset0:64 offset1:96
s_waitcnt lgkmcnt(4)
v_perm_b32 v144,v100,v96,s61
v_perm_b32 v145,v101,v97,s61
v_perm_b32 v146,v102,v98,s61
v_perm_b32 v147,v103,v99,s61
v_perm_b32 v152,v100,v96,s62
v_perm_b32 v153,v101,v97,s62
v_perm_b32 v154,v102,v98,s62
v_perm_b32 v155,v103,v99,s62
v_xor_b32 v5,8192,v3
v_xor_b32 v6,8192,v4
ds_read2_b32 v[96:97],v5 offset1:32
ds_read2_b32 v[100:101],v6 offset1:32
ds_read2_b32 v[98:99],v5 offset0:64 offset1:96
ds_read2_b32 v[102:103],v6 offset0:64 offset1:96
s_waitcnt lgkmcnt(4)
v_perm_b32 v148,v108,v104,s61
v_perm_b32 v149,v109,v105,s61
v_perm_b32 v150,v110,v106,s61
v_perm_b32 v151,v111,v107,s61
v_perm_b32 v156,v108,v104,s62
v_perm_b32 v157,v109,v105,s62
v_perm_b32 v158,v110,v106,s62
v_perm_b32 v159,v111,v107,s62
v_xor_b32 v5,10240,v3
v_xor_b32 v6,10240,v4
ds_read2_b32 v[104:105],v5 offset1:32
ds_read2_b32 v[108:109],v6 offset1:32
ds_read2_b32 v[106:107],v5 offset0:64 offset1:96
ds_read2_b32 v[110:111],v6 offset0:64 offset1:96
s_waitcnt lgkmcnt(4)
v_perm_b32 v160,v100,v96,s61
v_perm_b32 v161,v101,v97,s61
v_perm_b32 v162,v102,v98,s61
v_perm_b32 v163,v103,v99,s61
v_perm_b32 v168,v100,v96,s62
v_perm_b32 v169,v101,v97,s62
v_perm_b32 v170,v102,v98,s62
v_perm_b32 v171,v103,v99,s62
v_xor_b32 v5,12288,v3
v_xor_b32 v6,12288,v4
ds_read2_b32 v[96:97],v5 offset1:32
ds_read2_b32 v[100:101],v6 offset1:32
ds_read2_b32 v[98:99],v5 offset0:64 offset1:96
ds_read2_b32 v[102:103],v6 offset0:64 offset1:96
s_waitcnt lgkmcnt(4)
v_perm_b32 v164,v108,v104,s61
v_perm_b32 v165,v109,v105,s61
v_perm_b32 v166,v110,v106,s61
v_perm_b32 v167,v111,v107,s61
v_perm_b32 v172,v108,v104,s62
v_perm_b32 v173,v109,v105,s62
v_perm_b32 v174,v110,v106,s62
v_perm_b32 v175,v111,v107,s62
v_xor_b32 v5,14336,v3
v_xor_b32 v6,14336,v4
ds_read2_b32 v[104:105],v5 offset1:32
ds_read2_b32 v[108:109],v6 offset1:32
ds_read2_b32 v[106:107],v5 offset0:64 offset1:96
ds_read2_b32 v[110:111],v6 offset0:64 offset1:96
s_waitcnt lgkmcnt(4)
v_perm_b32 v176,v100,v96,s61
v_perm_b32 v177,v101,v97,s61
v_perm_b32 v178,v102,v98,s61
v_perm_b32 v179,v103,v99,s61
v_perm_b32 v184,v100,v96,s62
v_perm_b32 v185,v101,v97,s62
v_perm_b32 v186,v102,v98,s62
v_perm_b32 v187,v103,v99,s62
s_waitcnt lgkmcnt(0)
s_mov_b32 s4,s20
s_mov_b32 s5,s21
s_mov_b32 s6,4194304
s_mov_b32 s7,0x20000
s_xor_b32 m0,s59,0
s_xor_b32 s60,s58,0
buffer_load_dwordx4 v2,s[4:7],s60 offen lds
s_add_u32 m0,m0,1024
s_add_u32 s60,s60,131072
buffer_load_dwordx4 v2,s[4:7],s60 offen lds
s_xor_b32 m0,s59,2048
s_xor_b32 s60,s58,262144
buffer_load_dwordx4 v2,s[4:7],s60 offen lds
s_add_u32 m0,m0,1024
s_add_u32 s60,s60,131072
buffer_load_dwordx4 v2,s[4:7],s60 offen lds
s_xor_b32 m0,s59,4096
s_xor_b32 s60,s58,524288
buffer_load_dwordx4 v2,s[4:7],s60 offen lds
s_add_u32 m0,m0,1024
s_add_u32 s60,s60,131072
buffer_load_dwordx4 v2,s[4:7],s60 offen lds
s_xor_b32 m0,s59,6144
s_xor_b32 s60,s58,786432
buffer_load_dwordx4 v2,s[4:7],s60 offen lds
s_add_u32 m0,m0,1024
s_add_u32 s60,s60,131072
buffer_load_dwordx4 v2,s[4:7],s60 offen lds
s_xor_b32 m0,s59,8192
s_xor_b32 s60,s58,1048576
buffer_load_dwordx4 v2,s[4:7],s60 offen lds
s_add_u32 m0,m0,1024
s_add_u32 s60,s60,131072
buffer_load_dwordx4 v2,s[4:7],s60 offen lds
s_xor_b32 m0,s59,10240
s_xor_b32 s60,s58,1310720
buffer_load_dwordx4 v2,s[4:7],s60 offen lds
s_add_u32 m0,m0,1024
s_add_u32 s60,s60,131072
buffer_load_dwordx4 v2,s[4:7],s60 offen lds
s_xor_b32 m0,s59,12288
s_xor_b32 s60,s58,1572864
buffer_load_dwordx4 v2,s[4:7],s60 offen lds
s_add_u32 m0,m0,1024
s_add_u32 s60,s60,131072
buffer_load_dwordx4 v2,s[4:7],s60 offen lds
s_xor_b32 m0,s59,14336
s_xor_b32 s60,s58,1835008
buffer_load_dwordx4 v2,s[4:7],s60 offen lds
s_add_u32 m0,m0,1024
s_add_u32 s60,s60,131072
buffer_load_dwordx4 v2,s[4:7],s60 offen lds
v_perm_b32 v180,v108,v104,s61
v_perm_b32 v181,v109,v105,s61
v_perm_b32 v182,v110,v106,s61
v_perm_b32 v183,v111,v107,s61
v_perm_b32 v188,v108,v104,s62
v_perm_b32 v189,v109,v105,s62
v_perm_b32 v190,v110,v106,s62
v_perm_b32 v191,v111,v107,s62
s_waitcnt vmcnt(16)
v_xor_b32 v5,16384,v3
v_xor_b32 v6,16384,v4
ds_read2_b32 v[96:97],v5 offset1:32
ds_read2_b32 v[100:101],v6 offset1:32
ds_read2_b32 v[98:99],v5 offset0:64 offset1:96
ds_read2_b32 v[102:103],v6 offset0:64 offset1:96
v_xor_b32 v5,18432,v3
v_xor_b32 v6,18432,v4
ds_read2_b32 v[104:105],v5 offset1:32
ds_read2_b32 v[108:109],v6 offset1:32
ds_read2_b32 v[106:107],v5 offset0:64 offset1:96
ds_read2_b32 v[110:111],v6 offset0:64 offset1:96
s_waitcnt lgkmcnt(4)
v_perm_b32 v192,v100,v96,s61
v_perm_b32 v193,v101,v97,s61
v_perm_b32 v194,v102,v98,s61
v_perm_b32 v195,v103,v99,s61
v_perm_b32 v200,v100,v96,s62
v_perm_b32 v201,v101,v97,s62
v_perm_b32 v202,v102,v98,s62
v_perm_b32 v203,v103,v99,s62
v_xor_b32 v5,20480,v3
v_xor_b32 v6,20480,v4
ds_read2_b32 v[96:97],v5 offset1:32
ds_read2_b32 v[100:101],v6 offset1:32
ds_read2_b32 v[98:99],v5 offset0:64 offset1:96
ds_read2_b32 v[102:103],v6 offset0:64 offset1:96
s_waitcnt lgkmcnt(4)
v_perm_b32 v196,v108,v104,s61
v_perm_b32 v197,v109,v105,s61
v_perm_b32 v198,v110,v106,s61
v_perm_b32 v199,v111,v107,s61
v_perm_b32 v204,v108,v104,s62
v_perm_b32 v205,v109,v105,s62
v_perm_b32 v206,v110,v106,s62
v_perm_b32 v207,v111,v107,s62
v_xor_b32 v5,22528,v3
v_xor_b32 v6,22528,v4
ds_read2_b32 v[104:105],v5 offset1:32
ds_read2_b32 v[108:109],v6 offset1:32
ds_read2_b32 v[106:107],v5 offset0:64 offset1:96
ds_read2_b32 v[110:111],v6 offset0:64 offset1:96
s_waitcnt lgkmcnt(4)
v_perm_b32 v208,v100,v96,s61
v_perm_b32 v209,v101,v97,s61
v_perm_b32 v210,v102,v98,s61
v_perm_b32 v211,v103,v99,s61
v_perm_b32 v216,v100,v96,s62
v_perm_b32 v217,v101,v97,s62
v_perm_b32 v218,v102,v98,s62
v_perm_b32 v219,v103,v99,s62
v_xor_b32 v5,24576,v3
v_xor_b32 v6,24576,v4
ds_read2_b32 v[96:97],v5 offset1:32
ds_read2_b32 v[100:101],v6 offset1:32
ds_read2_b32 v[98:99],v5 offset0:64 offset1:96
ds_read2_b32 v[102:103],v6 offset0:64 offset1:96
s_waitcnt lgkmcnt(4)
v_perm_b32 v212,v108,v104,s61
v_perm_b32 v213,v109,v105,s61
v_perm_b32 v214,v110,v106,s61
v_perm_b32 v215,v111,v107,s61
v_perm_b32 v220,v108,v104,s62
v_perm_b32 v221,v109,v105,s62
v_perm_b32 v222,v110,v106,s62
v_perm_b32 v223,v111,v107,s62
v_xor_b32 v5,26624,v3
v_xor_b32 v6,26624,v4
ds_read2_b32 v[104:105],v5 offset1:32
ds_read2_b32 v[108:109],v6 offset1:32
ds_read2_b32 v[106:107],v5 offset0:64 offset1:96
ds_read2_b32 v[110:111],v6 offset0:64 offset1:96
s_waitcnt lgkmcnt(4)
v_perm_b32 v224,v100,v96,s61
v_perm_b32 v225,v101,v97,s61
v_perm_b32 v226,v102,v98,s61
v_perm_b32 v227,v103,v99,s61
v_perm_b32 v232,v100,v96,s62
v_perm_b32 v233,v101,v97,s62
v_perm_b32 v234,v102,v98,s62
v_perm_b32 v235,v103,v99,s62
v_xor_b32 v5,28672,v3
v_xor_b32 v6,28672,v4
ds_read2_b32 v[96:97],v5 offset1:32
ds_read2_b32 v[100:101],v6 offset1:32
ds_read2_b32 v[98:99],v5 offset0:64 offset1:96
ds_read2_b32 v[102:103],v6 offset0:64 offset1:96
s_waitcnt lgkmcnt(4)
v_perm_b32 v228,v108,v104,s61
v_perm_b32 v229,v109,v105,s61
v_perm_b32 v230,v110,v106,s61
v_perm_b32 v231,v111,v107,s61
v_perm_b32 v236,v108,v104,s62
v_perm_b32 v237,v109,v105,s62
v_perm_b32 v238,v110,v106,s62
v_perm_b32 v239,v111,v107,s62
v_xor_b32 v5,30720,v3
v_xor_b32 v6,30720,v4
ds_read2_b32 v[104:105],v5 offset1:32
ds_read2_b32 v[108:109],v6 offset1:32
ds_read2_b32 v[106:107],v5 offset0:64 offset1:96
ds_read2_b32 v[110:111],v6 offset0:64 offset1:96
s_waitcnt lgkmcnt(4)
v_perm_b32 v240,v100,v96,s61
v_perm_b32 v241,v101,v97,s61
v_perm_b32 v242,v102,v98,s61
v_perm_b32 v243,v103,v99,s61
v_perm_b32 v248,v100,v96,s62
v_perm_b32 v249,v101,v97,s62
v_perm_b32 v250,v102,v98,s62
v_perm_b32 v251,v103,v99,s62
s_waitcnt lgkmcnt(0)
s_xor_b32 m0,s59,16384
s_xor_b32 s60,s58,2097152
buffer_load_dwordx4 v2,s[4:7],s60 offen lds
s_add_u32 m0,m0,1024
s_add_u32 s60,s60,131072
buffer_load_dwordx4 v2,s[4:7],s60 offen lds
s_xor_b32 m0,s59,18432
s_xor_b32 s60,s58,2359296
buffer_load_dwordx4 v2,s[4:7],s60 offen lds
s_add_u32 m0,m0,1024
s_add_u32 s60,s60,131072
buffer_load_dwordx4 v2,s[4:7],s60 offen lds
s_xor_b32 m0,s59,20480
s_xor_b32 s60,s58,2621440
buffer_load_dwordx4 v2,s[4:7],s60 offen lds
s_add_u32 m0,m0,1024
s_add_u32 s60,s60,131072
buffer_load_dwordx4 v2,s[4:7],s60 offen lds
s_xor_b32 m0,s59,22528
s_xor_b32 s60,s58,2883584
buffer_load_dwordx4 v2,s[4:7],s60 offen lds
s_add_u32 m0,m0,1024
s_add_u32 s60,s60,131072
buffer_load_dwordx4 v2,s[4:7],s60 offen lds
s_xor_b32 m0,s59,24576
s_xor_b32 s60,s58,3145728
buffer_load_dwordx4 v2,s[4:7],s60 offen lds
s_add_u32 m0,m0,1024
s_add_u32 s60,s60,131072
buffer_load_dwordx4 v2,s[4:7],s60 offen lds
s_xor_b32 m0,s59,26624
s_xor_b32 s60,s58,3407872
buffer_load_dwordx4 v2,s[4:7],s60 offen lds
s_add_u32 m0,m0,1024
s_add_u32 s60,s60,131072
buffer_load_dwordx4 v2,s[4:7],s60 offen lds
s_xor_b32 m0,s59,28672
s_xor_b32 s60,s58,3670016
buffer_load_dwordx4 v2,s[4:7],s60 offen lds
s_add_u32 m0,m0,1024
s_add_u32 s60,s60,131072
buffer_load_dwordx4 v2,s[4:7],s60 offen lds
s_xor_b32 m0,s59,30720
s_xor_b32 s60,s58,3932160
buffer_load_dwordx4 v2,s[4:7],s60 offen lds
s_add_u32 m0,m0,1024
s_add_u32 s60,s60,131072
buffer_load_dwordx4 v2,s[4:7],s60 offen lds
v_perm_b32 v244,v108,v104,s61
v_perm_b32 v245,v109,v105,s61
v_perm_b32 v246,v110,v106,s61
v_perm_b32 v247,v111,v107,s61
v_perm_b32 v252,v108,v104,s62
v_perm_b32 v253,v109,v105,s62
v_perm_b32 v254,v110,v106,s62
v_perm_b32 v255,v111,v107,s62
s_waitcnt vmcnt(16)
v_xor_b32 v5,0,v3
v_xor_b32 v6,0,v4
ds_read2_b32 v[96:97],v5 offset1:32
ds_read2_b32 v[100:101],v6 offset1:32
ds_read2_b32 v[98:99],v5 offset0:64 offset1:96
ds_read2_b32 v[102:103],v6 offset0:64 offset1:96
v_xor_b32 v5,2048,v3
v_xor_b32 v6,2048,v4
ds_read2_b32 v[104:105],v5 offset1:32
ds_read2_b32 v[108:109],v6 offset1:32
ds_read2_b32 v[106:107],v5 offset0:64 offset1:96
ds_read2_b32 v[110:111],v6 offset0:64 offset1:96
s_waitcnt lgkmcnt(4)
v_perm_b32 v112,v100,v96,s61
v_perm_b32 v113,v101,v97,s61
v_perm_b32 v114,v102,v98,s61
v_perm_b32 v115,v103,v99,s61
v_perm_b32 v116,v100,v96,s62
v_perm_b32 v117,v101,v97,s62
v_perm_b32 v118,v102,v98,s62
v_perm_b32 v119,v103,v99,s62
v_accvgpr_write_b32 a0,v112
v_accvgpr_write_b32 a1,v113
v_accvgpr_write_b32 a2,v114
v_accvgpr_write_b32 a3,v115
v_accvgpr_write_b32 a8,v116
v_accvgpr_write_b32 a9,v117
v_accvgpr_write_b32 a10,v118
v_accvgpr_write_b32 a11,v119
v_xor_b32 v5,4096,v3
v_xor_b32 v6,4096,v4
ds_read2_b32 v[96:97],v5 offset1:32
ds_read2_b32 v[100:101],v6 offset1:32
ds_read2_b32 v[98:99],v5 offset0:64 offset1:96
ds_read2_b32 v[102:103],v6 offset0:64 offset1:96
s_waitcnt lgkmcnt(4)
v_perm_b32 v112,v108,v104,s61
v_perm_b32 v113,v109,v105,s61
v_perm_b32 v114,v110,v106,s61
v_perm_b32 v115,v111,v107,s61
v_perm_b32 v116,v108,v104,s62
v_perm_b32 v117,v109,v105,s62
v_perm_b32 v118,v110,v106,s62
v_perm_b32 v119,v111,v107,s62
v_accvgpr_write_b32 a4,v112
v_accvgpr_write_b32 a5,v113
v_accvgpr_write_b32 a6,v114
v_accvgpr_write_b32 a7,v115
v_accvgpr_write_b32 a12,v116
v_accvgpr_write_b32 a13,v117
v_accvgpr_write_b32 a14,v118
v_accvgpr_write_b32 a15,v119
v_xor_b32 v5,6144,v3
v_xor_b32 v6,6144,v4
ds_read2_b32 v[104:105],v5 offset1:32
ds_read2_b32 v[108:109],v6 offset1:32
ds_read2_b32 v[106:107],v5 offset0:64 offset1:96
ds_read2_b32 v[110:111],v6 offset0:64 offset1:96
s_waitcnt lgkmcnt(4)
v_perm_b32 v112,v100,v96,s61
v_perm_b32 v113,v101,v97,s61
v_perm_b32 v114,v102,v98,s61
v_perm_b32 v115,v103,v99,s61
v_perm_b32 v116,v100,v96,s62
v_perm_b32 v117,v101,v97,s62
v_perm_b32 v118,v102,v98,s62
v_perm_b32 v119,v103,v99,s62
v_accvgpr_write_b32 a16,v112
v_accvgpr_write_b32 a17,v113
v_accvgpr_write_b32 a18,v114
v_accvgpr_write_b32 a19,v115
v_accvgpr_write_b32 a24,v116
v_accvgpr_write_b32 a25,v117
v_accvgpr_write_b32 a26,v118
v_accvgpr_write_b32 a27,v119
v_xor_b32 v5,8192,v3
v_xor_b32 v6,8192,v4
ds_read2_b32 v[96:97],v5 offset1:32
ds_read2_b32 v[100:101],v6 offset1:32
ds_read2_b32 v[98:99],v5 offset0:64 offset1:96
ds_read2_b32 v[102:103],v6 offset0:64 offset1:96
s_waitcnt lgkmcnt(4)
v_perm_b32 v112,v108,v104,s61
v_perm_b32 v113,v109,v105,s61
v_perm_b32 v114,v110,v106,s61
v_perm_b32 v115,v111,v107,s61
v_perm_b32 v116,v108,v104,s62
v_perm_b32 v117,v109,v105,s62
v_perm_b32 v118,v110,v106,s62
v_perm_b32 v119,v111,v107,s62
v_accvgpr_write_b32 a20,v112
v_accvgpr_write_b32 a21,v113
v_accvgpr_write_b32 a22,v114
v_accvgpr_write_b32 a23,v115
v_accvgpr_write_b32 a28,v116
v_accvgpr_write_b32 a29,v117
v_accvgpr_write_b32 a30,v118
v_accvgpr_write_b32 a31,v119
v_xor_b32 v5,10240,v3
v_xor_b32 v6,10240,v4
ds_read2_b32 v[104:105],v5 offset1:32
ds_read2_b32 v[108:109],v6 offset1:32
ds_read2_b32 v[106:107],v5 offset0:64 offset1:96
ds_read2_b32 v[110:111],v6 offset0:64 offset1:96
s_waitcnt lgkmcnt(4)
v_perm_b32 v112,v100,v96,s61
v_perm_b32 v113,v101,v97,s61
v_perm_b32 v114,v102,v98,s61
v_perm_b32 v115,v103,v99,s61
v_perm_b32 v116,v100,v96,s62
v_perm_b32 v117,v101,v97,s62
v_perm_b32 v118,v102,v98,s62
v_perm_b32 v119,v103,v99,s62
v_accvgpr_write_b32 a32,v112
v_accvgpr_write_b32 a33,v113
v_accvgpr_write_b32 a34,v114
v_accvgpr_write_b32 a35,v115
v_accvgpr_write_b32 a40,v116
v_accvgpr_write_b32 a41,v117
v_accvgpr_write_b32 a42,v118
v_accvgpr_write_b32 a43,v119
v_xor_b32 v5,12288,v3
v_xor_b32 v6,12288,v4
ds_read2_b32 v[96:97],v5 offset1:32
ds_read2_b32 v[100:101],v6 offset1:32
ds_read2_b32 v[98:99],v5 offset0:64 offset1:96
ds_read2_b32 v[102:103],v6 offset0:64 offset1:96
s_waitcnt lgkmcnt(4)
v_perm_b32 v112,v108,v104,s61
v_perm_b32 v113,v109,v105,s61
v_perm_b32 v114,v110,v106,s61
v_perm_b32 v115,v111,v107,s61
v_perm_b32 v116,v108,v104,s62
v_perm_b32 v117,v109,v105,s62
v_perm_b32 v118,v110,v106,s62
v_perm_b32 v119,v111,v107,s62
v_accvgpr_write_b32 a36,v112
v_accvgpr_write_b32 a37,v113
v_accvgpr_write_b32 a38,v114
v_accvgpr_write_b32 a39,v115
v_accvgpr_write_b32 a44,v116
v_accvgpr_write_b32 a45,v117
v_accvgpr_write_b32 a46,v118
v_accvgpr_write_b32 a47,v119
v_xor_b32 v5,14336,v3
v_xor_b32 v6,14336,v4
ds_read2_b32 v[104:105],v5 offset1:32
ds_read2_b32 v[108:109],v6 offset1:32
ds_read2_b32 v[106:107],v5 offset0:64 offset1:96
ds_read2_b32 v[110:111],v6 offset0:64 offset1:96
s_waitcnt lgkmcnt(4)
v_perm_b32 v112,v100,v96,s61
v_perm_b32 v113,v101,v97,s61
v_perm_b32 v114,v102,v98,s61
v_perm_b32 v115,v103,v99,s61
v_perm_b32 v116,v100,v96,s62
v_perm_b32 v117,v101,v97,s62
v_perm_b32 v118,v102,v98,s62
v_perm_b32 v119,v103,v99,s62
v_accvgpr_write_b32 a48,v112
v_accvgpr_write_b32 a49,v113
v_accvgpr_write_b32 a50,v114
v_accvgpr_write_b32 a51,v115
v_accvgpr_write_b32 a56,v116
v_accvgpr_write_b32 a57,v117
v_accvgpr_write_b32 a58,v118
v_accvgpr_write_b32 a59,v119
s_waitcnt lgkmcnt(0)
v_perm_b32 v112,v108,v104,s61
v_perm_b32 v113,v109,v105,s61
v_perm_b32 v114,v110,v106,s61
v_perm_b32 v115,v111,v107,s61
v_perm_b32 v116,v108,v104,s62
v_perm_b32 v117,v109,v105,s62
v_perm_b32 v118,v110,v106,s62
v_perm_b32 v119,v111,v107,s62
v_accvgpr_write_b32 a52,v112
v_accvgpr_write_b32 a53,v113
v_accvgpr_write_b32 a54,v114
v_accvgpr_write_b32 a55,v115
v_accvgpr_write_b32 a60,v116
v_accvgpr_write_b32 a61,v117
v_accvgpr_write_b32 a62,v118
v_accvgpr_write_b32 a63,v119
s_mov_b32 s4,s26
s_mov_b32 s5,s27
s_mov_b32 s6,4194304
s_mov_b32 s7,0x20000
v_and_b32 v92,3,v1
v_lshlrev_b32 v93,4,v92
v_bfe_u32 v94,v1,2,2
v_lshl_add_u32 v92,v94,12,v93
v_lshl_add_u32 v93,v94,8,v93
v_and_b32 v94,1,v94
v_lshl_add_u32 v93,v94,6,v93
v_lshrrev_b32 v94,4,v1
v_lshl_add_u32 v92,v94,8,v92
v_lshl_add_u32 v93,v94,13,v93
s_lshl_b32 s56,s46,15
v_add_u32 v93,s56,v93
v_xor_b32 v94,64,v93
s_lshl_b32 s56,s47,17
s_lshl_b32 s57,s46,6
s_add_u32 s56,s56,s57
v_add_u32 v92,s56,v92
s_cmp_ge_u32 s48,3
s_cbranch_scc1 L_lw_17
s_mov_b32 s56,0
buffer_load_dwordx4 v[24:27],v92,s[4:7],s56 offen offset:0
buffer_load_dwordx4 v[28:31],v92,s[4:7],s56 offen offset:1024
buffer_load_dwordx4 v[32:35],v92,s[4:7],s56 offen offset:2048
buffer_load_dwordx4 v[36:39],v92,s[4:7],s56 offen offset:3072
s_mov_b32 s56,16384
buffer_load_dwordx4 v[40:43],v92,s[4:7],s56 offen offset:0
buffer_load_dwordx4 v[44:47],v92,s[4:7],s56 offen offset:1024
buffer_load_dwordx4 v[48:51],v92,s[4:7],s56 offen offset:2048
buffer_load_dwordx4 v[52:55],v92,s[4:7],s56 offen offset:3072
s_mov_b32 s56,32768
buffer_load_dwordx4 v[56:59],v92,s[4:7],s56 offen offset:0
buffer_load_dwordx4 v[60:63],v92,s[4:7],s56 offen offset:1024
buffer_load_dwordx4 v[64:67],v92,s[4:7],s56 offen offset:2048
buffer_load_dwordx4 v[68:71],v92,s[4:7],s56 offen offset:3072
s_mov_b32 s56,49152
buffer_load_dwordx4 v[72:75],v92,s[4:7],s56 offen offset:0
buffer_load_dwordx4 v[76:79],v92,s[4:7],s56 offen offset:1024
buffer_load_dwordx4 v[80:83],v92,s[4:7],s56 offen offset:2048
buffer_load_dwordx4 v[84:87],v92,s[4:7],s56 offen offset:3072
s_waitcnt vmcnt(16)
s_branch L_lj_18
L_lw_17:
s_waitcnt vmcnt(0)
L_lj_18:
v_xor_b32 v5,16384,v3
v_xor_b32 v6,16384,v4
ds_read2_b32 v[96:97],v5 offset1:32
ds_read2_b32 v[100:101],v6 offset1:32
ds_read2_b32 v[98:99],v5 offset0:64 offset1:96
ds_read2_b32 v[102:103],v6 offset0:64 offset1:96
v_xor_b32 v5,18432,v3
v_xor_b32 v6,18432,v4
ds_read2_b32 v[104:105],v5 offset1:32
ds_read2_b32 v[108:109],v6 offset1:32
ds_read2_b32 v[106:107],v5 offset0:64 offset1:96
ds_read2_b32 v[110:111],v6 offset0:64 offset1:96
s_waitcnt lgkmcnt(4)
v_perm_b32 v112,v100,v96,s61
v_perm_b32 v113,v101,v97,s61
v_perm_b32 v114,v102,v98,s61
v_perm_b32 v115,v103,v99,s61
v_perm_b32 v116,v100,v96,s62
v_perm_b32 v117,v101,v97,s62
v_perm_b32 v118,v102,v98,s62
v_perm_b32 v119,v103,v99,s62
v_accvgpr_write_b32 a64,v112
v_accvgpr_write_b32 a65,v113
v_accvgpr_write_b32 a66,v114
v_accvgpr_write_b32 a67,v115
v_accvgpr_write_b32 a72,v116
v_accvgpr_write_b32 a73,v117
v_accvgpr_write_b32 a74,v118
v_accvgpr_write_b32 a75,v119
v_xor_b32 v5,20480,v3
v_xor_b32 v6,20480,v4
ds_read2_b32 v[96:97],v5 offset1:32
ds_read2_b32 v[100:101],v6 offset1:32
ds_read2_b32 v[98:99],v5 offset0:64 offset1:96
ds_read2_b32 v[102:103],v6 offset0:64 offset1:96
s_waitcnt lgkmcnt(4)
v_perm_b32 v112,v108,v104,s61
v_perm_b32 v113,v109,v105,s61
v_perm_b32 v114,v110,v106,s61
v_perm_b32 v115,v111,v107,s61
v_perm_b32 v116,v108,v104,s62
v_perm_b32 v117,v109,v105,s62
v_perm_b32 v118,v110,v106,s62
v_perm_b32 v119,v111,v107,s62
v_accvgpr_write_b32 a68,v112
v_accvgpr_write_b32 a69,v113
v_accvgpr_write_b32 a70,v114
v_accvgpr_write_b32 a71,v115
v_accvgpr_write_b32 a76,v116
v_accvgpr_write_b32 a77,v117
v_accvgpr_write_b32 a78,v118
v_accvgpr_write_b32 a79,v119
v_xor_b32 v5,22528,v3
v_xor_b32 v6,22528,v4
ds_read2_b32 v[104:105],v5 offset1:32
ds_read2_b32 v[108:109],v6 offset1:32
ds_read2_b32 v[106:107],v5 offset0:64 offset1:96
ds_read2_b32 v[110:111],v6 offset0:64 offset1:96
s_waitcnt lgkmcnt(4)
v_perm_b32 v112,v100,v96,s61
v_perm_b32 v113,v101,v97,s61
v_perm_b32 v114,v102,v98,s61
v_perm_b32 v115,v103,v99,s61
v_perm_b32 v116,v100,v96,s62
v_perm_b32 v117,v101,v97,s62
v_perm_b32 v118,v102,v98,s62
v_perm_b32 v119,v103,v99,s62
v_accvgpr_write_b32 a80,v112
v_accvgpr_write_b32 a81,v113
v_accvgpr_write_b32 a82,v114
v_accvgpr_write_b32 a83,v115
v_accvgpr_write_b32 a88,v116
v_accvgpr_write_b32 a89,v117
v_accvgpr_write_b32 a90,v118
v_accvgpr_write_b32 a91,v119
v_xor_b32 v5,24576,v3
v_xor_b32 v6,24576,v4
ds_read2_b32 v[96:97],v5 offset1:32
ds_read2_b32 v[100:101],v6 offset1:32
ds_read2_b32 v[98:99],v5 offset0:64 offset1:96
ds_read2_b32 v[102:103],v6 offset0:64 offset1:96
s_waitcnt lgkmcnt(4)
v_perm_b32 v112,v108,v104,s61
v_perm_b32 v113,v109,v105,s61
v_perm_b32 v114,v110,v106,s61
v_perm_b32 v115,v111,v107,s61
v_perm_b32 v116,v108,v104,s62
v_perm_b32 v117,v109,v105,s62
v_perm_b32 v118,v110,v106,s62
v_perm_b32 v119,v111,v107,s62
v_accvgpr_write_b32 a84,v112
v_accvgpr_write_b32 a85,v113
v_accvgpr_write_b32 a86,v114
v_accvgpr_write_b32 a87,v115
v_accvgpr_write_b32 a92,v116
v_accvgpr_write_b32 a93,v117
v_accvgpr_write_b32 a94,v118
v_accvgpr_write_b32 a95,v119
v_xor_b32 v5,26624,v3
v_xor_b32 v6,26624,v4
ds_read2_b32 v[104:105],v5 offset1:32
ds_read2_b32 v[108:109],v6 offset1:32
ds_read2_b32 v[106:107],v5 offset0:64 offset1:96
ds_read2_b32 v[110:111],v6 offset0:64 offset1:96
s_waitcnt lgkmcnt(4)
v_perm_b32 v112,v100,v96,s61
v_perm_b32 v113,v101,v97,s61
v_perm_b32 v114,v102,v98,s61
v_perm_b32 v115,v103,v99,s61
v_perm_b32 v116,v100,v96,s62
v_perm_b32 v117,v101,v97,s62
v_perm_b32 v118,v102,v98,s62
v_perm_b32 v119,v103,v99,s62
v_accvgpr_write_b32 a96,v112
v_accvgpr_write_b32 a97,v113
v_accvgpr_write_b32 a98,v114
v_accvgpr_write_b32 a99,v115
v_accvgpr_write_b32 a104,v116
v_accvgpr_write_b32 a105,v117
v_accvgpr_write_b32 a106,v118
v_accvgpr_write_b32 a107,v119
v_xor_b32 v5,28672,v3
v_xor_b32 v6,28672,v4
ds_read2_b32 v[96:97],v5 offset1:32
ds_read2_b32 v[100:101],v6 offset1:32
ds_read2_b32 v[98:99],v5 offset0:64 offset1:96
ds_read2_b32 v[102:103],v6 offset0:64 offset1:96
s_waitcnt lgkmcnt(4)
v_perm_b32 v112,v108,v104,s61
v_perm_b32 v113,v109,v105,s61
v_perm_b32 v114,v110,v106,s61
v_perm_b32 v115,v111,v107,s61
v_perm_b32 v116,v108,v104,s62
v_perm_b32 v117,v109,v105,s62
v_perm_b32 v118,v110,v106,s62
v_perm_b32 v119,v111,v107,s62
v_accvgpr_write_b32 a100,v112
v_accvgpr_write_b32 a101,v113
v_accvgpr_write_b32 a102,v114
v_accvgpr_write_b32 a103,v115
v_accvgpr_write_b32 a108,v116
v_accvgpr_write_b32 a109,v117
v_accvgpr_write_b32 a110,v118
v_accvgpr_write_b32 a111,v119
v_xor_b32 v5,30720,v3
v_xor_b32 v6,30720,v4
ds_read2_b32 v[104:105],v5 offset1:32
ds_read2_b32 v[108:109],v6 offset1:32
ds_read2_b32 v[106:107],v5 offset0:64 offset1:96
ds_read2_b32 v[110:111],v6 offset0:64 offset1:96
s_waitcnt lgkmcnt(4)
v_perm_b32 v112,v100,v96,s61
v_perm_b32 v113,v101,v97,s61
v_perm_b32 v114,v102,v98,s61
v_perm_b32 v115,v103,v99,s61
v_perm_b32 v116,v100,v96,s62
v_perm_b32 v117,v101,v97,s62
v_perm_b32 v118,v102,v98,s62
v_perm_b32 v119,v103,v99,s62
v_accvgpr_write_b32 a112,v112
v_accvgpr_write_b32 a113,v113
v_accvgpr_write_b32 a114,v114
v_accvgpr_write_b32 a115,v115
v_accvgpr_write_b32 a120,v116
v_accvgpr_write_b32 a121,v117
v_accvgpr_write_b32 a122,v118
v_accvgpr_write_b32 a123,v119
s_waitcnt lgkmcnt(0)
v_perm_b32 v112,v108,v104,s61
v_perm_b32 v113,v109,v105,s61
v_perm_b32 v114,v110,v106,s61
v_perm_b32 v115,v111,v107,s61
v_perm_b32 v116,v108,v104,s62
v_perm_b32 v117,v109,v105,s62
v_perm_b32 v118,v110,v106,s62
v_perm_b32 v119,v111,v107,s62
v_accvgpr_write_b32 a116,v112
v_accvgpr_write_b32 a117,v113
v_accvgpr_write_b32 a118,v114
v_accvgpr_write_b32 a119,v115
v_accvgpr_write_b32 a124,v116
v_accvgpr_write_b32 a125,v117
v_accvgpr_write_b32 a126,v118
v_accvgpr_write_b32 a127,v119
s_cmp_lt_u32 s48,3
s_cbranch_scc1 L_rch_4
s_cmp_eq_u32 s48,3
s_cbranch_scc1 L_rm_5
v_mov_b32 v123,159744
s_cmp_lg_u32 s46,0
s_cbranch_scc1 L_gbd_20
v_mov_b32 v124,240
L_gb_19:
buffer_load_dword v125,v124,s[12:15],0 offen sc1
s_waitcnt vmcnt(0)
v_readfirstlane_b32 s56,v125
ds_write_b32 v123,v125
s_bitcmp1_b32 s56,8
s_cbranch_scc1 L_gbd_20
s_sleep 4
s_sub_u32 s49,s49,1
s_cmp_gt_i32 s49,0
s_cbranch_scc1 L_gb_19
s_branch L_abort
L_gbd_20:
s_waitcnt lgkmcnt(0)
s_barrier
ds_read_b32 v125,v123
s_waitcnt lgkmcnt(0)
v_readfirstlane_b32 s56,v125
s_barrier
s_lshr_b32 s56,s56,16
s_andn2_b32 s56,s56,s3
s_cbranch_scc1 L_spread
v_and_b32 v120,15,v1
v_lshrrev_b32 v121,4,v1
v_mov_b32 v17,1
s_lshl_b32 s56,s46,15
v_add_u32 v18,s56,v0
s_lshl_b32 s56,s46,2
v_add_u32 v125,s56,v121
v_xor_b32 v126,v125,v120
v_lshlrev_b32 v126,4,v126
v_lshl_add_u32 v20,v125,10,v126
v_add_u32 v125,0,v121
v_xor_b32 v125,v125,v120
v_lshlrev_b32 v125,4,v125
v_lshl_add_u32 v125,v120,8,v125
v_add_u32 v4,65536,v125
v_add_u32 v125,4,v121
v_xor_b32 v125,v125,v120
v_lshlrev_b32 v125,4,v125
v_lshl_add_u32 v125,v120,8,v125
v_add_u32 v5,65536,v125
v_add_u32 v125,8,v121
v_xor_b32 v125,v125,v120
v_lshlrev_b32 v125,4,v125
v_lshl_add_u32 v125,v120,8,v125
v_add_u32 v6,65536,v125
v_add_u32 v125,12,v121
v_xor_b32 v125,v125,v120
v_lshlrev_b32 v125,4,v125
v_lshl_add_u32 v125,v120,8,v125
v_add_u32 v7,65536,v125
v_lshlrev_b32 v21,5,v120
v_and_b32 v125,1,v121
v_lshl_add_u32 v21,v125,4,v21
s_lshl_b32 s56,s46,9
v_lshrrev_b32 v125,1,v121
v_lshl_add_u32 v21,v125,11,v21
s_add_u32 s56,s56,155648
v_add_u32 v21,s56,v21
v_lshlrev_b32 v22,4,v120
v_lshl_add_u32 v22,v121,10,v22
s_lshl_b32 s56,s46,8
v_add_u32 v22,s56,v22
s_sub_u32 s54,s48,4
s_cmp_eq_u32 s54,0
s_mov_b32 s72,1073752746
s_mov_b32 s73,1145324612
s_cmov_b32 s72,268440917
s_cmov_b32 s73,286331153
s_mov_b32 s70,0x80000000
s_mov_b32 s53,7
s_mov_b32 s74,s50
s_xor_b32 s75,s74,32768
v_and_b32 v23,31,v1
v_lshlrev_b32 v23,2,v23
v_mov_b32 v19,s50
v_mov_b32 v16,0
s_ff1_i32_b64 s55,s[72:73]
s_bitset0_b64 s[72:73],s55
s_min_u32 s55,s55,127
s_lshl_b32 s68,s55,15
s_add_u32 s68,s68,0
s_add_u32 s69,s68,16384
s_add_u32 m0,s75,65536
s_nop 0
buffer_load_dwordx4 v20,s[8:11],s68 offen offset:0 sc1 lds
s_add_u32 m0,s75,69632
s_nop 0
buffer_load_dwordx4 v20,s[8:11],s69 offen offset:0 sc1 lds
s_add_u32 m0,s75,73472
s_nop 0
buffer_load_dwordx4 v20,s[8:11],s68 offen offset:256 sc1 lds
s_add_u32 m0,s75,77568
s_nop 0
buffer_load_dwordx4 v20,s[8:11],s69 offen offset:256 sc1 lds
s_add_u32 m0,s75,81408
s_nop 0
buffer_load_dwordx4 v20,s[8:11],s68 offen offset:512 sc1 lds
s_add_u32 m0,s75,85504
s_nop 0
buffer_load_dwordx4 v20,s[8:11],s69 offen offset:512 sc1 lds
s_add_u32 m0,s75,89344
s_nop 0
buffer_load_dwordx4 v20,s[8:11],s68 offen offset:768 sc1 lds
s_add_u32 m0,s75,93440
s_nop 0
buffer_load_dwordx4 v20,s[8:11],s69 offen offset:768 sc1 lds
s_waitcnt vmcnt(0)
s_barrier
L_p_21:
s_mov_b32 s75,s74
s_xor_b32 s74,s74,32768
v_xor_b32 v4,32768,v4
v_xor_b32 v5,32768,v5
v_xor_b32 v6,32768,v6
v_xor_b32 v7,32768,v7
ds_read_b128 v[104:107],v4 offset:0
ds_read_b128 v[108:111],v4 offset:4096
ds_read_b128 v[112:115],v5 offset:0
ds_read_b128 v[116:119],v5 offset:4096
s_waitcnt lgkmcnt(2)
v_mfma_f32_16x16x32_bf16 v[24:27],a[128:131],v[104:107],0
ds_read_b128 v[120:123],v6 offset:0
v_mfma_f32_16x16x32_bf16 v[40:43],v[104:107],v[128:131],0
s_mov_b32 s51,s55
v_mfma_f32_16x16x32_bf16 v[28:31],a[128:131],v[108:111],0
ds_read_b128 v[124:127],v6 offset:4096
v_mfma_f32_16x16x32_bf16 v[44:47],v[108:111],v[128:131],0
s_mov_b32 s77,0
v_mfma_f32_16x16x32_bf16 v[32:35],a[136:139],v[104:107],0
s_sub_u32 s53,s53,1
v_mfma_f32_16x16x32_bf16 v[48:51],v[104:107],v[136:139],0
s_ff1_i32_b64 s55,s[72:73]
v_mfma_f32_16x16x32_bf16 v[36:39],a[136:139],v[108:111],0
s_bitset0_b64 s[72:73],s55
v_mfma_f32_16x16x32_bf16 v[52:55],v[108:111],v[136:139],0
s_min_u32 s55,s55,127
s_waitcnt lgkmcnt(2)
v_mfma_f32_16x16x32_bf16 v[24:27],a[132:135],v[112:115],v[24:27]
ds_read_b128 v[104:107],v7 offset:0
v_mfma_f32_16x16x32_bf16 v[40:43],v[112:115],v[132:135],v[40:43]
s_lshl_b32 s58,s51,5
v_mfma_f32_16x16x32_bf16 v[28:31],a[132:135],v[116:119],v[28:31]
ds_read_b128 v[108:111],v7 offset:4096
v_mfma_f32_16x16x32_bf16 v[44:47],v[116:119],v[132:135],v[44:47]
s_add_u32 s58,s58,s47
v_mfma_f32_16x16x32_bf16 v[32:35],a[140:143],v[112:115],v[32:35]
s_mul_i32 s58,s58,24576
v_mfma_f32_16x16x32_bf16 v[48:51],v[112:115],v[140:143],v[48:51]
s_add_u32 s58,s58,100663296
v_mfma_f32_16x16x32_bf16 v[36:39],a[140:143],v[116:119],v[36:39]
s_add_u32 s61,s58,s50
v_mfma_f32_16x16x32_bf16 v[52:55],v[116:119],v[140:143],v[52:55]
s_add_u32 s62,s61,4096
s_waitcnt lgkmcnt(2)
v_mfma_f32_16x16x32_bf16 v[24:27],a[144:147],v[120:123],v[24:27]
ds_read_b128 v[112:115],v4 offset:8192
v_mfma_f32_16x16x32_bf16 v[40:43],v[120:123],v[144:147],v[40:43]
s_add_u32 s63,s61,16384
v_mfma_f32_16x16x32_bf16 v[28:31],a[144:147],v[124:127],v[28:31]
ds_read_b128 v[116:119],v4 offset:12288
v_mfma_f32_16x16x32_bf16 v[44:47],v[124:127],v[144:147],v[44:47]
s_add_u32 s64,s61,20480
v_mfma_f32_16x16x32_bf16 v[32:35],a[152:155],v[120:123],v[32:35]
s_add_u32 s65,s61,s50
v_mfma_f32_16x16x32_bf16 v[48:51],v[120:123],v[152:155],v[48:51]
s_add_u32 s65,s65,8192
v_mfma_f32_16x16x32_bf16 v[36:39],a[152:155],v[124:127],v[36:39]
v_mfma_f32_16x16x32_bf16 v[52:55],v[124:127],v[152:155],v[52:55]
s_waitcnt lgkmcnt(2)
v_mfma_f32_16x16x32_bf16 v[24:27],a[148:151],v[104:107],v[24:27]
ds_read_b128 v[120:123],v5 offset:8192
v_mfma_f32_16x16x32_bf16 v[40:43],v[104:107],v[148:151],v[40:43]
v_mfma_f32_16x16x32_bf16 v[28:31],a[148:151],v[108:111],v[28:31]
ds_read_b128 v[124:127],v5 offset:12288
v_mfma_f32_16x16x32_bf16 v[44:47],v[108:111],v[148:151],v[44:47]
v_mfma_f32_16x16x32_bf16 v[32:35],a[156:159],v[104:107],v[32:35]
v_mfma_f32_16x16x32_bf16 v[48:51],v[104:107],v[156:159],v[48:51]
v_mfma_f32_16x16x32_bf16 v[36:39],a[156:159],v[108:111],v[36:39]
v_mfma_f32_16x16x32_bf16 v[52:55],v[108:111],v[156:159],v[52:55]
s_waitcnt lgkmcnt(2)
v_mfma_f32_16x16x32_bf16 v[24:27],a[160:163],v[112:115],v[24:27]
ds_read_b128 v[104:107],v6 offset:8192
v_mfma_f32_16x16x32_bf16 v[40:43],v[112:115],v[160:163],v[40:43]
s_lshl_b32 s56,s54,13
v_mfma_f32_16x16x32_bf16 v[28:31],a[160:163],v[116:119],v[28:31]
ds_read_b128 v[108:111],v6 offset:12288
v_mfma_f32_16x16x32_bf16 v[44:47],v[116:119],v[160:163],v[44:47]
s_add_u32 s56,s56,10487552
v_mfma_f32_16x16x32_bf16 v[32:35],a[168:171],v[112:115],v[32:35]
s_or_b32 s56,s56,s52
v_mfma_f32_16x16x32_bf16 v[48:51],v[112:115],v[168:171],v[48:51]
buffer_load_dword v76,v23,s[8:11],s56 offen sc1
v_mfma_f32_16x16x32_bf16 v[36:39],a[168:171],v[116:119],v[36:39]
v_mfma_f32_16x16x32_bf16 v[52:55],v[116:119],v[168:171],v[52:55]
s_waitcnt lgkmcnt(2)
v_mfma_f32_16x16x32_bf16 v[24:27],a[164:167],v[120:123],v[24:27]
ds_read_b128 v[112:115],v7 offset:8192
v_mfma_f32_16x16x32_bf16 v[40:43],v[120:123],v[164:167],v[40:43]
v_mfma_f32_16x16x32_bf16 v[28:31],a[164:167],v[124:127],v[28:31]
ds_read_b128 v[116:119],v7 offset:12288
v_mfma_f32_16x16x32_bf16 v[44:47],v[124:127],v[164:167],v[44:47]
v_mfma_f32_16x16x32_bf16 v[32:35],a[172:175],v[120:123],v[32:35]
v_mfma_f32_16x16x32_bf16 v[48:51],v[120:123],v[172:175],v[48:51]
v_mfma_f32_16x16x32_bf16 v[36:39],a[172:175],v[124:127],v[36:39]
v_mfma_f32_16x16x32_bf16 v[52:55],v[124:127],v[172:175],v[52:55]
s_waitcnt lgkmcnt(2)
v_mfma_f32_16x16x32_bf16 v[24:27],a[176:179],v[104:107],v[24:27]
ds_read_b128 v[120:123],v4 offset:16384
v_mfma_f32_16x16x32_bf16 v[40:43],v[104:107],v[176:179],v[40:43]
v_mfma_f32_16x16x32_bf16 v[28:31],a[176:179],v[108:111],v[28:31]
ds_read_b128 v[124:127],v4 offset:20480
v_mfma_f32_16x16x32_bf16 v[44:47],v[108:111],v[176:179],v[44:47]
v_mfma_f32_16x16x32_bf16 v[32:35],a[184:187],v[104:107],v[32:35]
v_mfma_f32_16x16x32_bf16 v[48:51],v[104:107],v[184:187],v[48:51]
v_mfma_f32_16x16x32_bf16 v[36:39],a[184:187],v[108:111],v[36:39]
v_mfma_f32_16x16x32_bf16 v[52:55],v[108:111],v[184:187],v[52:55]
s_waitcnt lgkmcnt(2)
v_mfma_f32_16x16x32_bf16 v[24:27],a[180:183],v[112:115],v[24:27]
ds_read_b128 v[104:107],v5 offset:16384
v_mfma_f32_16x16x32_bf16 v[40:43],v[112:115],v[180:183],v[40:43]
v_mfma_f32_16x16x32_bf16 v[28:31],a[180:183],v[116:119],v[28:31]
ds_read_b128 v[108:111],v5 offset:20480
v_mfma_f32_16x16x32_bf16 v[44:47],v[116:119],v[180:183],v[44:47]
v_mfma_f32_16x16x32_bf16 v[32:35],a[188:191],v[112:115],v[32:35]
v_mfma_f32_16x16x32_bf16 v[48:51],v[112:115],v[188:191],v[48:51]
v_mfma_f32_16x16x32_bf16 v[36:39],a[188:191],v[116:119],v[36:39]
v_mfma_f32_16x16x32_bf16 v[52:55],v[116:119],v[188:191],v[52:55]
s_waitcnt lgkmcnt(2)
v_mfma_f32_16x16x32_bf16 v[24:27],a[192:195],v[120:123],v[24:27]
ds_read_b128 v[112:115],v6 offset:16384
v_mfma_f32_16x16x32_bf16 v[40:43],v[120:123],v[192:195],v[40:43]
v_mfma_f32_16x16x32_bf16 v[28:31],a[192:195],v[124:127],v[28:31]
ds_read_b128 v[116:119],v6 offset:20480
v_mfma_f32_16x16x32_bf16 v[44:47],v[124:127],v[192:195],v[44:47]
v_mfma_f32_16x16x32_bf16 v[32:35],a[200:203],v[120:123],v[32:35]
v_mfma_f32_16x16x32_bf16 v[48:51],v[120:123],v[200:203],v[48:51]
v_mfma_f32_16x16x32_bf16 v[36:39],a[200:203],v[124:127],v[36:39]
v_mfma_f32_16x16x32_bf16 v[52:55],v[124:127],v[200:203],v[52:55]
s_waitcnt lgkmcnt(2)
v_mfma_f32_16x16x32_bf16 v[24:27],a[196:199],v[104:107],v[24:27]
ds_read_b128 v[120:123],v7 offset:16384
v_mfma_f32_16x16x32_bf16 v[40:43],v[104:107],v[196:199],v[40:43]
s_waitcnt vmcnt(0)
v_mfma_f32_16x16x32_bf16 v[28:31],a[196:199],v[108:111],v[28:31]
ds_read_b128 v[124:127],v7 offset:20480
v_mfma_f32_16x16x32_bf16 v[44:47],v[108:111],v[196:199],v[44:47]
v_cmp_eq_u32 vcc,0,v76
v_mfma_f32_16x16x32_bf16 v[32:35],a[204:207],v[104:107],v[32:35]
s_nop 0
v_mov_b32 v76,vcc_lo
v_mfma_f32_16x16x32_bf16 v[48:51],v[104:107],v[204:207],v[48:51]
ds_write_b32 v19,v76
v_mfma_f32_16x16x32_bf16 v[36:39],a[204:207],v[108:111],v[36:39]
v_mfma_f32_16x16x32_bf16 v[52:55],v[108:111],v[204:207],v[52:55]
s_waitcnt vmcnt(0) lgkmcnt(0)
s_barrier
s_or_b32 s70,s70,s52
buffer_store_dword v17,off,s[8:11],s70 sc1
ds_read_b32 v76,v16
v_mfma_f32_16x16x32_bf16 v[24:27],a[208:211],v[112:115],v[24:27]
ds_read_b128 v[104:107],v4 offset:24576
v_mfma_f32_16x16x32_bf16 v[40:43],v[112:115],v[208:211],v[40:43]
s_lshl_b32 s56,s51,5
s_add_u32 s56,s56,s47
s_lshl_b32 s56,s56,12
v_mfma_f32_16x16x32_bf16 v[28:31],a[208:211],v[116:119],v[28:31]
ds_read_b128 v[108:111],v4 offset:28672
v_mfma_f32_16x16x32_bf16 v[44:47],v[116:119],v[208:211],v[44:47]
s_add_u32 s56,s56,s50
s_add_u32 s56,s56,41943040
v_mfma_f32_16x16x32_bf16 v[32:35],a[216:219],v[112:115],v[32:35]
v_mov_b64 v[72:73],-1
v_mov_b64 v[74:75],-1
v_mfma_f32_16x16x32_bf16 v[48:51],v[112:115],v[216:219],v[48:51]
buffer_store_dwordx4 v[72:75],v0,s[8:11],s56 offen sc1
v_mfma_f32_16x16x32_bf16 v[36:39],a[216:219],v[116:119],v[36:39]
v_mfma_f32_16x16x32_bf16 v[52:55],v[116:119],v[216:219],v[52:55]
s_waitcnt lgkmcnt(2)
v_mfma_f32_16x16x32_bf16 v[24:27],a[212:215],v[120:123],v[24:27]
ds_read_b128 v[112:115],v5 offset:24576
v_mfma_f32_16x16x32_bf16 v[40:43],v[120:123],v[212:215],v[40:43]
v_readfirstlane_b32 s57,v76
v_mfma_f32_16x16x32_bf16 v[28:31],a[212:215],v[124:127],v[28:31]
ds_read_b128 v[116:119],v5 offset:28672
v_mfma_f32_16x16x32_bf16 v[44:47],v[124:127],v[212:215],v[44:47]
s_sub_u32 s59,s55,s54
s_cmp_lt_i32 s59,44
s_cselect_b32 s76,2,0
v_mfma_f32_16x16x32_bf16 v[32:35],a[220:223],v[120:123],v[32:35]
s_cmp_gt_i32 s53,0
s_cselect_b32 s76,s76,0
v_mfma_f32_16x16x32_bf16 v[48:51],v[120:123],v[220:223],v[48:51]
s_cmp_eq_u32 s57,0
s_cselect_b32 s76,1,s76
v_mfma_f32_16x16x32_bf16 v[36:39],a[220:223],v[124:127],v[36:39]
s_cmp_lt_i32 s59,12
s_cselect_b32 s76,2,s76
s_add_u32 s57,s54,64
v_mfma_f32_16x16x32_bf16 v[52:55],v[124:127],v[220:223],v[52:55]
s_cmp_eq_u32 s76,1
s_cselect_b32 s68,s57,s55
s_lshl_b32 s68,s68,15
s_waitcnt lgkmcnt(2)
v_mfma_f32_16x16x32_bf16 v[24:27],a[224:227],v[104:107],v[24:27]
ds_read_b128 v[120:123],v6 offset:24576
v_mfma_f32_16x16x32_bf16 v[40:43],v[104:107],v[224:227],v[40:43]
s_cmp_eq_u32 s76,0
s_cselect_b32 s68,0x80000000,s68
s_add_u32 s69,s68,16384
v_mfma_f32_16x16x32_bf16 v[28:31],a[224:227],v[108:111],v[28:31]
ds_read_b128 v[124:127],v6 offset:28672
v_mfma_f32_16x16x32_bf16 v[44:47],v[108:111],v[224:227],v[44:47]
s_add_u32 m0,s75,65536
v_mfma_f32_16x16x32_bf16 v[32:35],a[232:235],v[104:107],v[32:35]
buffer_load_dwordx4 v20,s[8:11],s68 offen offset:0 sc1 lds
v_mfma_f32_16x16x32_bf16 v[48:51],v[104:107],v[232:235],v[48:51]
s_add_u32 m0,s75,69632
v_mfma_f32_16x16x32_bf16 v[36:39],a[232:235],v[108:111],v[36:39]
buffer_load_dwordx4 v20,s[8:11],s69 offen offset:0 sc1 lds
v_mfma_f32_16x16x32_bf16 v[52:55],v[108:111],v[232:235],v[52:55]
s_add_u32 m0,s75,73472
s_waitcnt lgkmcnt(2)
v_mfma_f32_16x16x32_bf16 v[24:27],a[228:231],v[112:115],v[24:27]
ds_read_b128 v[104:107],v7 offset:24576
v_mfma_f32_16x16x32_bf16 v[40:43],v[112:115],v[228:231],v[40:43]
buffer_load_dwordx4 v20,s[8:11],s68 offen offset:256 sc1 lds
v_mfma_f32_16x16x32_bf16 v[28:31],a[228:231],v[116:119],v[28:31]
ds_read_b128 v[108:111],v7 offset:28672
v_mfma_f32_16x16x32_bf16 v[44:47],v[116:119],v[228:231],v[44:47]
s_add_u32 m0,s75,77568
v_mfma_f32_16x16x32_bf16 v[32:35],a[236:239],v[112:115],v[32:35]
buffer_load_dwordx4 v20,s[8:11],s69 offen offset:256 sc1 lds
v_mfma_f32_16x16x32_bf16 v[48:51],v[112:115],v[236:239],v[48:51]
s_add_u32 m0,s75,81408
v_mfma_f32_16x16x32_bf16 v[36:39],a[236:239],v[116:119],v[36:39]
buffer_load_dwordx4 v20,s[8:11],s68 offen offset:512 sc1 lds
v_mfma_f32_16x16x32_bf16 v[52:55],v[116:119],v[236:239],v[52:55]
s_add_u32 m0,s75,85504
s_waitcnt lgkmcnt(2)
v_mfma_f32_16x16x32_bf16 v[24:27],a[240:243],v[120:123],v[24:27]
ds_read_b128 v[112:115],v4 offset:0
v_mfma_f32_16x16x32_bf16 v[40:43],v[120:123],v[240:243],v[40:43]
buffer_load_dwordx4 v20,s[8:11],s69 offen offset:512 sc1 lds
v_mfma_f32_16x16x32_bf16 v[28:31],a[240:243],v[124:127],v[28:31]
ds_read_b128 v[116:119],v4 offset:4096
v_mfma_f32_16x16x32_bf16 v[44:47],v[124:127],v[240:243],v[44:47]
s_add_u32 m0,s75,89344
v_mfma_f32_16x16x32_bf16 v[32:35],a[248:251],v[120:123],v[32:35]
buffer_load_dwordx4 v20,s[8:11],s68 offen offset:768 sc1 lds
v_mfma_f32_16x16x32_bf16 v[48:51],v[120:123],v[248:251],v[48:51]
s_add_u32 m0,s75,93440
v_mfma_f32_16x16x32_bf16 v[36:39],a[248:251],v[124:127],v[36:39]
buffer_load_dwordx4 v20,s[8:11],s69 offen offset:768 sc1 lds
v_mfma_f32_16x16x32_bf16 v[52:55],v[124:127],v[248:251],v[52:55]
s_waitcnt lgkmcnt(2)
v_mfma_f32_16x16x32_bf16 v[24:27],a[244:247],v[104:107],v[24:27]
ds_read_b128 v[120:123],v5 offset:0
v_mfma_f32_16x16x32_bf16 v[40:43],v[104:107],v[244:247],v[40:43]
v_mfma_f32_16x16x32_bf16 v[28:31],a[244:247],v[108:111],v[28:31]
ds_read_b128 v[124:127],v5 offset:4096
v_mfma_f32_16x16x32_bf16 v[44:47],v[108:111],v[244:247],v[44:47]
v_mfma_f32_16x16x32_bf16 v[32:35],a[252:255],v[104:107],v[32:35]
v_mfma_f32_16x16x32_bf16 v[48:51],v[104:107],v[252:255],v[48:51]
v_mfma_f32_16x16x32_bf16 v[36:39],a[252:255],v[108:111],v[36:39]
v_mfma_f32_16x16x32_bf16 v[52:55],v[108:111],v[252:255],v[52:55]
s_waitcnt lgkmcnt(2)
v_mfma_f32_16x16x32_bf16 v[88:91],a[0:3],v[112:115],0
ds_read_b128 v[104:107],v6 offset:0
v_mfma_f32_16x16x32_bf16 v[92:95],a[0:3],v[116:119],0
v_mfma_f32_16x16x32_bf16 v[96:99],a[8:11],v[112:115],0
ds_read_b128 v[108:111],v6 offset:4096
v_cvt_pk_bf16_f32 v56,v24,v32
v_cvt_pk_bf16_f32 v57,v25,v33
v_mfma_f32_16x16x32_bf16 v[100:103],a[8:11],v[116:119],0
v_cvt_pk_bf16_f32 v58,v26,v34
v_cvt_pk_bf16_f32 v59,v27,v35
s_waitcnt lgkmcnt(2)
v_mfma_f32_16x16x32_bf16 v[88:91],a[4:7],v[120:123],v[88:91]
ds_read_b128 v[112:115],v7 offset:0
v_mfma_f32_16x16x32_bf16 v[92:95],a[4:7],v[124:127],v[92:95]
buffer_store_dwordx4 v[56:59],v0,s[8:11],s61 offen sc1
v_cvt_pk_bf16_f32 v60,v28,v36
v_cvt_pk_bf16_f32 v61,v29,v37
v_mfma_f32_16x16x32_bf16 v[96:99],a[12:15],v[120:123],v[96:99]
ds_read_b128 v[116:119],v7 offset:4096
v_cvt_pk_bf16_f32 v62,v30,v38
v_cvt_pk_bf16_f32 v63,v31,v39
v_mfma_f32_16x16x32_bf16 v[100:103],a[12:15],v[124:127],v[100:103]
buffer_store_dwordx4 v[60:63],v0,s[8:11],s62 offen sc1
v_cvt_pk_bf16_f32 v64,v40,v41
v_cvt_pk_bf16_f32 v65,v42,v43
s_waitcnt lgkmcnt(2)
v_mfma_f32_16x16x32_bf16 v[88:91],a[16:19],v[104:107],v[88:91]
ds_read_b128 v[120:123],v4 offset:8192
v_cvt_pk_bf16_f32 v66,v44,v45
v_cvt_pk_bf16_f32 v67,v46,v47
v_mfma_f32_16x16x32_bf16 v[92:95],a[16:19],v[108:111],v[92:95]
buffer_store_dwordx4 v[64:67],v0,s[8:11],s65 offen offset:0 sc1
v_cvt_pk_bf16_f32 v68,v48,v49
v_cvt_pk_bf16_f32 v69,v50,v51
v_mfma_f32_16x16x32_bf16 v[96:99],a[24:27],v[104:107],v[96:99]
ds_read_b128 v[124:127],v4 offset:12288
v_cvt_pk_bf16_f32 v70,v52,v53
v_cvt_pk_bf16_f32 v71,v54,v55
v_mfma_f32_16x16x32_bf16 v[100:103],a[24:27],v[108:111],v[100:103]
buffer_store_dwordx4 v[68:71],v0,s[8:11],s65 offen offset:1024 sc1
s_waitcnt lgkmcnt(2)
v_mfma_f32_16x16x32_bf16 v[88:91],a[20:23],v[112:115],v[88:91]
ds_read_b128 v[104:107],v5 offset:8192
v_mfma_f32_16x16x32_bf16 v[92:95],a[20:23],v[116:119],v[92:95]
v_mfma_f32_16x16x32_bf16 v[96:99],a[28:31],v[112:115],v[96:99]
ds_read_b128 v[108:111],v5 offset:12288
v_mfma_f32_16x16x32_bf16 v[100:103],a[28:31],v[116:119],v[100:103]
s_waitcnt lgkmcnt(2)
v_mfma_f32_16x16x32_bf16 v[88:91],a[32:35],v[120:123],v[88:91]
ds_read_b128 v[112:115],v6 offset:8192
v_mfma_f32_16x16x32_bf16 v[92:95],a[32:35],v[124:127],v[92:95]
v_mfma_f32_16x16x32_bf16 v[96:99],a[40:43],v[120:123],v[96:99]
ds_read_b128 v[116:119],v6 offset:12288
v_mfma_f32_16x16x32_bf16 v[100:103],a[40:43],v[124:127],v[100:103]
s_waitcnt lgkmcnt(2)
v_mfma_f32_16x16x32_bf16 v[88:91],a[36:39],v[104:107],v[88:91]
ds_read_b128 v[120:123],v7 offset:8192
v_mfma_f32_16x16x32_bf16 v[92:95],a[36:39],v[108:111],v[92:95]
v_mfma_f32_16x16x32_bf16 v[96:99],a[44:47],v[104:107],v[96:99]
ds_read_b128 v[124:127],v7 offset:12288
v_mfma_f32_16x16x32_bf16 v[100:103],a[44:47],v[108:111],v[100:103]
s_waitcnt lgkmcnt(2)
v_mfma_f32_16x16x32_bf16 v[88:91],a[48:51],v[112:115],v[88:91]
ds_read_b128 v[104:107],v4 offset:16384
v_mfma_f32_16x16x32_bf16 v[92:95],a[48:51],v[116:119],v[92:95]
s_lshl_b32 s56,s54,13
v_mfma_f32_16x16x32_bf16 v[96:99],a[56:59],v[112:115],v[96:99]
ds_read_b128 v[108:111],v4 offset:20480
v_mfma_f32_16x16x32_bf16 v[100:103],a[56:59],v[116:119],v[100:103]
s_add_u32 s56,s56,10487552
s_waitcnt lgkmcnt(2)
v_mfma_f32_16x16x32_bf16 v[88:91],a[52:55],v[120:123],v[88:91]
ds_read_b128 v[112:115],v5 offset:16384
v_mfma_f32_16x16x32_bf16 v[92:95],a[52:55],v[124:127],v[92:95]
s_or_b32 s56,s56,s52
v_mfma_f32_16x16x32_bf16 v[96:99],a[60:63],v[120:123],v[96:99]
ds_read_b128 v[116:119],v5 offset:20480
v_mfma_f32_16x16x32_bf16 v[100:103],a[60:63],v[124:127],v[100:103]
buffer_load_dword v76,v23,s[8:11],s56 offen sc1
s_waitcnt lgkmcnt(2)
v_mfma_f32_16x16x32_bf16 v[88:91],a[64:67],v[104:107],v[88:91]
ds_read_b128 v[120:123],v6 offset:16384
v_mfma_f32_16x16x32_bf16 v[92:95],a[64:67],v[108:111],v[92:95]
v_mfma_f32_16x16x32_bf16 v[96:99],a[72:75],v[104:107],v[96:99]
ds_read_b128 v[124:127],v6 offset:20480
v_mfma_f32_16x16x32_bf16 v[100:103],a[72:75],v[108:111],v[100:103]
s_waitcnt lgkmcnt(2)
v_mfma_f32_16x16x32_bf16 v[88:91],a[68:71],v[112:115],v[88:91]
ds_read_b128 v[104:107],v7 offset:16384
v_mfma_f32_16x16x32_bf16 v[92:95],a[68:71],v[116:119],v[92:95]
v_mfma_f32_16x16x32_bf16 v[96:99],a[76:79],v[112:115],v[96:99]
ds_read_b128 v[108:111],v7 offset:20480
v_mfma_f32_16x16x32_bf16 v[100:103],a[76:79],v[116:119],v[100:103]
s_waitcnt lgkmcnt(2)
v_mfma_f32_16x16x32_bf16 v[88:91],a[80:83],v[120:123],v[88:91]
ds_read_b128 v[112:115],v4 offset:24576
v_mfma_f32_16x16x32_bf16 v[92:95],a[80:83],v[124:127],v[92:95]
v_mfma_f32_16x16x32_bf16 v[96:99],a[88:91],v[120:123],v[96:99]
ds_read_b128 v[116:119],v4 offset:28672
v_mfma_f32_16x16x32_bf16 v[100:103],a[88:91],v[124:127],v[100:103]
s_waitcnt lgkmcnt(2)
v_mfma_f32_16x16x32_bf16 v[88:91],a[84:87],v[104:107],v[88:91]
ds_read_b128 v[120:123],v5 offset:24576
v_mfma_f32_16x16x32_bf16 v[92:95],a[84:87],v[108:111],v[92:95]
v_mfma_f32_16x16x32_bf16 v[96:99],a[92:95],v[104:107],v[96:99]
ds_read_b128 v[124:127],v5 offset:28672
v_mfma_f32_16x16x32_bf16 v[100:103],a[92:95],v[108:111],v[100:103]
s_waitcnt lgkmcnt(2)
v_mfma_f32_16x16x32_bf16 v[88:91],a[96:99],v[112:115],v[88:91]
ds_read_b128 v[104:107],v6 offset:24576
v_mfma_f32_16x16x32_bf16 v[92:95],a[96:99],v[116:119],v[92:95]
v_mfma_f32_16x16x32_bf16 v[96:99],a[104:107],v[112:115],v[96:99]
ds_read_b128 v[108:111],v6 offset:28672
v_mfma_f32_16x16x32_bf16 v[100:103],a[104:107],v[116:119],v[100:103]
s_waitcnt lgkmcnt(2)
v_mfma_f32_16x16x32_bf16 v[88:91],a[100:103],v[120:123],v[88:91]
ds_read_b128 v[112:115],v7 offset:24576
v_mfma_f32_16x16x32_bf16 v[92:95],a[100:103],v[124:127],v[92:95]
v_mfma_f32_16x16x32_bf16 v[96:99],a[108:111],v[120:123],v[96:99]
ds_read_b128 v[116:119],v7 offset:28672
v_mfma_f32_16x16x32_bf16 v[100:103],a[108:111],v[124:127],v[100:103]
s_waitcnt lgkmcnt(2)
v_mfma_f32_16x16x32_bf16 v[88:91],a[112:115],v[104:107],v[88:91]
v_mfma_f32_16x16x32_bf16 v[92:95],a[112:115],v[108:111],v[92:95]
v_mfma_f32_16x16x32_bf16 v[96:99],a[120:123],v[104:107],v[96:99]
v_mfma_f32_16x16x32_bf16 v[100:103],a[120:123],v[108:111],v[100:103]
s_waitcnt lgkmcnt(0)
v_mfma_f32_16x16x32_bf16 v[88:91],a[116:119],v[112:115],v[88:91]
v_mfma_f32_16x16x32_bf16 v[92:95],a[116:119],v[116:119],v[92:95]
v_mfma_f32_16x16x32_bf16 v[96:99],a[124:127],v[112:115],v[96:99]
v_mfma_f32_16x16x32_bf16 v[100:103],a[124:127],v[116:119],v[100:103]
s_nop 3
v_cvt_pk_bf16_f32 v104,v88,v96
v_cvt_pk_bf16_f32 v105,v89,v97
v_cvt_pk_bf16_f32 v106,v90,v98
v_cvt_pk_bf16_f32 v107,v91,v99
v_cvt_pk_bf16_f32 v108,v92,v100
v_cvt_pk_bf16_f32 v109,v93,v101
v_cvt_pk_bf16_f32 v110,v94,v102
v_cvt_pk_bf16_f32 v111,v95,v103
buffer_store_dwordx4 v[104:107],v0,s[8:11],s63 offen sc1
buffer_store_dwordx4 v[108:111],v0,s[8:11],s64 offen sc1
s_waitcnt vmcnt(7)
s_barrier
s_lshl_b32 s70,s51,13
s_lshl2_add_u32 s70,s47,s70
s_add_u32 s70,s70,10485760
s_cmp_ge_u32 s51,2
s_cbranch_scc1 L_p_23
s_waitcnt vmcnt(0)
s_barrier
s_or_b32 s70,s70,s52
buffer_store_dword v17,off,s[8:11],s70 sc1
L_p_23:
s_cmp_eq_u32 s76,2
s_cbranch_scc1 L_p_21
s_mov_b32 s53,0
s_mov_b32 s51,s54
s_add_u32 s54,s54,2
s_cmp_eq_u32 s76,1
s_cbranch_scc1 L_p_22
s_cmp_lg_u32 s77,0
s_waitcnt vmcnt(3)
s_cbranch_scc1 L_p_25
s_waitcnt vmcnt(2)
L_p_25:
v_cmp_eq_u32 vcc,0,v76
s_nop 1
v_mov_b32 v76,vcc_lo
ds_write_b32 v19,v76
s_lshl_b32 s66,s51,15
s_add_u32 s66,s66,2097152
s_add_u32 s67,s66,16384
s_waitcnt lgkmcnt(0)
s_barrier
ds_read_b32 v76,v16
s_waitcnt lgkmcnt(0)
v_cmp_eq_u32 vcc,0,v76
s_cbranch_vccnz L_p_26
s_waitcnt vmcnt(0)
s_barrier
s_or_b32 s70,s70,s52
buffer_store_dword v17,off,s[8:11],s70 sc1
s_mov_b32 s70,0x80000000
s_mov_b32 s53,1
s_cmp_ge_u32 s51,64
s_cbranch_scc1 L_p_24
s_lshl_b32 s59,s51,13
s_add_u32 s59,s59,10487552
s_cmp_lg_u32 s46,0
s_cbranch_scc1 L_fd_28
v_and_b32 v124,31,v1
v_lshlrev_b32 v124,2,v124
s_branch L_ff_29
L_fw_27:
s_sleep 1
L_ff_29:
buffer_load_dword v125,v124,s[8:11],s59 offen sc1
s_sub_u32 s49,s49,1
s_cbranch_scc1 L_abort
s_waitcnt vmcnt(0)
v_cmp_eq_u32 vcc,0,v125
s_cbranch_vccnz L_fw_27
L_fd_28:
s_barrier
L_p_26:
s_add_u32 m0,s74,65536
s_nop 0
buffer_load_dwordx4 v20,s[8:11],s66 offen offset:0 sc1 lds
s_add_u32 m0,s74,69632
s_nop 0
buffer_load_dwordx4 v20,s[8:11],s67 offen offset:0 sc1 lds
s_add_u32 m0,s74,73472
s_nop 0
buffer_load_dwordx4 v20,s[8:11],s66 offen offset:256 sc1 lds
s_add_u32 m0,s74,77568
s_nop 0
buffer_load_dwordx4 v20,s[8:11],s67 offen offset:256 sc1 lds
s_add_u32 m0,s74,81408
s_nop 0
buffer_load_dwordx4 v20,s[8:11],s66 offen offset:512 sc1 lds
s_add_u32 m0,s74,85504
s_nop 0
buffer_load_dwordx4 v20,s[8:11],s67 offen offset:512 sc1 lds
s_add_u32 m0,s74,89344
s_nop 0
buffer_load_dwordx4 v20,s[8:11],s66 offen offset:768 sc1 lds
s_add_u32 m0,s74,93440
s_nop 0
buffer_load_dwordx4 v20,s[8:11],s67 offen offset:768 sc1 lds
s_lshl_b32 s56,s54,13
s_add_u32 s56,s56,10487552
s_or_b32 s56,s56,s52
buffer_load_dword v76,v23,s[8:11],s56 offen sc1
s_waitcnt vmcnt(7)
s_barrier
ds_read_b128 v[104:107],v4 offset:0
ds_read_b128 v[108:111],v4 offset:4096
ds_read_b128 v[112:115],v5 offset:0
ds_read_b128 v[116:119],v5 offset:4096
s_waitcnt lgkmcnt(2)
v_mfma_f32_16x16x32_bf16 v[24:27],a[128:131],v[104:107],0
ds_read_b128 v[120:123],v6 offset:0
v_mfma_f32_16x16x32_bf16 v[40:43],v[104:107],v[128:131],0
s_lshl_b32 s58,s51,5
v_mfma_f32_16x16x32_bf16 v[28:31],a[128:131],v[108:111],0
ds_read_b128 v[124:127],v6 offset:4096
v_mfma_f32_16x16x32_bf16 v[44:47],v[108:111],v[128:131],0
s_add_u32 s58,s58,s47
v_mfma_f32_16x16x32_bf16 v[32:35],a[136:139],v[104:107],0
s_mul_i32 s58,s58,24576
v_mfma_f32_16x16x32_bf16 v[48:51],v[104:107],v[136:139],0
s_add_u32 s58,s58,150994944
v_mfma_f32_16x16x32_bf16 v[36:39],a[136:139],v[108:111],0
s_add_u32 s61,s58,s50
v_mfma_f32_16x16x32_bf16 v[52:55],v[108:111],v[136:139],0
s_add_u32 s62,s61,4096
s_waitcnt lgkmcnt(2)
v_mfma_f32_16x16x32_bf16 v[24:27],a[132:135],v[112:115],v[24:27]
ds_read_b128 v[104:107],v7 offset:0
v_mfma_f32_16x16x32_bf16 v[40:43],v[112:115],v[132:135],v[40:43]
s_add_u32 s63,s61,16384
v_mfma_f32_16x16x32_bf16 v[28:31],a[132:135],v[116:119],v[28:31]
ds_read_b128 v[108:111],v7 offset:4096
v_mfma_f32_16x16x32_bf16 v[44:47],v[116:119],v[132:135],v[44:47]
s_add_u32 s64,s61,20480
v_mfma_f32_16x16x32_bf16 v[32:35],a[140:143],v[112:115],v[32:35]
s_add_u32 s65,s61,s50
v_mfma_f32_16x16x32_bf16 v[48:51],v[112:115],v[140:143],v[48:51]
s_add_u32 s65,s65,8192
v_mfma_f32_16x16x32_bf16 v[36:39],a[140:143],v[116:119],v[36:39]
v_mfma_f32_16x16x32_bf16 v[52:55],v[116:119],v[140:143],v[52:55]
s_waitcnt vmcnt(5)
s_barrier
s_waitcnt lgkmcnt(2)
v_mfma_f32_16x16x32_bf16 v[24:27],a[144:147],v[120:123],v[24:27]
ds_read_b128 v[112:115],v4 offset:8192
v_mfma_f32_16x16x32_bf16 v[40:43],v[120:123],v[144:147],v[40:43]
v_mfma_f32_16x16x32_bf16 v[28:31],a[144:147],v[124:127],v[28:31]
ds_read_b128 v[116:119],v4 offset:12288
v_mfma_f32_16x16x32_bf16 v[44:47],v[124:127],v[144:147],v[44:47]
v_mfma_f32_16x16x32_bf16 v[32:35],a[152:155],v[120:123],v[32:35]
v_mfma_f32_16x16x32_bf16 v[48:51],v[120:123],v[152:155],v[48:51]
v_mfma_f32_16x16x32_bf16 v[36:39],a[152:155],v[124:127],v[36:39]
v_mfma_f32_16x16x32_bf16 v[52:55],v[124:127],v[152:155],v[52:55]
s_waitcnt lgkmcnt(2)
v_mfma_f32_16x16x32_bf16 v[24:27],a[148:151],v[104:107],v[24:27]
ds_read_b128 v[120:123],v5 offset:8192
v_mfma_f32_16x16x32_bf16 v[40:43],v[104:107],v[148:151],v[40:43]
v_mfma_f32_16x16x32_bf16 v[28:31],a[148:151],v[108:111],v[28:31]
ds_read_b128 v[124:127],v5 offset:12288
v_mfma_f32_16x16x32_bf16 v[44:47],v[108:111],v[148:151],v[44:47]
v_mfma_f32_16x16x32_bf16 v[32:35],a[156:159],v[104:107],v[32:35]
v_mfma_f32_16x16x32_bf16 v[48:51],v[104:107],v[156:159],v[48:51]
v_mfma_f32_16x16x32_bf16 v[36:39],a[156:159],v[108:111],v[36:39]
v_mfma_f32_16x16x32_bf16 v[52:55],v[108:111],v[156:159],v[52:55]
s_waitcnt lgkmcnt(2)
v_mfma_f32_16x16x32_bf16 v[24:27],a[160:163],v[112:115],v[24:27]
ds_read_b128 v[104:107],v6 offset:8192
v_mfma_f32_16x16x32_bf16 v[40:43],v[112:115],v[160:163],v[40:43]
v_mfma_f32_16x16x32_bf16 v[28:31],a[160:163],v[116:119],v[28:31]
ds_read_b128 v[108:111],v6 offset:12288
v_mfma_f32_16x16x32_bf16 v[44:47],v[116:119],v[160:163],v[44:47]
v_mfma_f32_16x16x32_bf16 v[32:35],a[168:171],v[112:115],v[32:35]
v_mfma_f32_16x16x32_bf16 v[48:51],v[112:115],v[168:171],v[48:51]
v_mfma_f32_16x16x32_bf16 v[36:39],a[168:171],v[116:119],v[36:39]
v_mfma_f32_16x16x32_bf16 v[52:55],v[116:119],v[168:171],v[52:55]
s_waitcnt lgkmcnt(2)
v_mfma_f32_16x16x32_bf16 v[24:27],a[164:167],v[120:123],v[24:27]
ds_read_b128 v[112:115],v7 offset:8192
v_mfma_f32_16x16x32_bf16 v[40:43],v[120:123],v[164:167],v[40:43]
v_mfma_f32_16x16x32_bf16 v[28:31],a[164:167],v[124:127],v[28:31]
ds_read_b128 v[116:119],v7 offset:12288
v_mfma_f32_16x16x32_bf16 v[44:47],v[124:127],v[164:167],v[44:47]
v_mfma_f32_16x16x32_bf16 v[32:35],a[172:175],v[120:123],v[32:35]
v_mfma_f32_16x16x32_bf16 v[48:51],v[120:123],v[172:175],v[48:51]
v_mfma_f32_16x16x32_bf16 v[36:39],a[172:175],v[124:127],v[36:39]
v_mfma_f32_16x16x32_bf16 v[52:55],v[124:127],v[172:175],v[52:55]
s_waitcnt vmcnt(3)
s_barrier
s_waitcnt lgkmcnt(2)
v_mfma_f32_16x16x32_bf16 v[24:27],a[176:179],v[104:107],v[24:27]
ds_read_b128 v[120:123],v4 offset:16384
v_mfma_f32_16x16x32_bf16 v[40:43],v[104:107],v[176:179],v[40:43]
v_mfma_f32_16x16x32_bf16 v[28:31],a[176:179],v[108:111],v[28:31]
ds_read_b128 v[124:127],v4 offset:20480
v_mfma_f32_16x16x32_bf16 v[44:47],v[108:111],v[176:179],v[44:47]
v_mfma_f32_16x16x32_bf16 v[32:35],a[184:187],v[104:107],v[32:35]
v_mfma_f32_16x16x32_bf16 v[48:51],v[104:107],v[184:187],v[48:51]
v_mfma_f32_16x16x32_bf16 v[36:39],a[184:187],v[108:111],v[36:39]
v_mfma_f32_16x16x32_bf16 v[52:55],v[108:111],v[184:187],v[52:55]
s_waitcnt lgkmcnt(2)
v_mfma_f32_16x16x32_bf16 v[24:27],a[180:183],v[112:115],v[24:27]
ds_read_b128 v[104:107],v5 offset:16384
v_mfma_f32_16x16x32_bf16 v[40:43],v[112:115],v[180:183],v[40:43]
v_mfma_f32_16x16x32_bf16 v[28:31],a[180:183],v[116:119],v[28:31]
ds_read_b128 v[108:111],v5 offset:20480
v_mfma_f32_16x16x32_bf16 v[44:47],v[116:119],v[180:183],v[44:47]
v_mfma_f32_16x16x32_bf16 v[32:35],a[188:191],v[112:115],v[32:35]
v_mfma_f32_16x16x32_bf16 v[48:51],v[112:115],v[188:191],v[48:51]
v_mfma_f32_16x16x32_bf16 v[36:39],a[188:191],v[116:119],v[36:39]
v_mfma_f32_16x16x32_bf16 v[52:55],v[116:119],v[188:191],v[52:55]
s_waitcnt lgkmcnt(2)
v_mfma_f32_16x16x32_bf16 v[24:27],a[192:195],v[120:123],v[24:27]
ds_read_b128 v[112:115],v6 offset:16384
v_mfma_f32_16x16x32_bf16 v[40:43],v[120:123],v[192:195],v[40:43]
v_mfma_f32_16x16x32_bf16 v[28:31],a[192:195],v[124:127],v[28:31]
ds_read_b128 v[116:119],v6 offset:20480
v_mfma_f32_16x16x32_bf16 v[44:47],v[124:127],v[192:195],v[44:47]
v_mfma_f32_16x16x32_bf16 v[32:35],a[200:203],v[120:123],v[32:35]
v_mfma_f32_16x16x32_bf16 v[48:51],v[120:123],v[200:203],v[48:51]
v_mfma_f32_16x16x32_bf16 v[36:39],a[200:203],v[124:127],v[36:39]
v_mfma_f32_16x16x32_bf16 v[52:55],v[124:127],v[200:203],v[52:55]
s_waitcnt lgkmcnt(2)
v_mfma_f32_16x16x32_bf16 v[24:27],a[196:199],v[104:107],v[24:27]
ds_read_b128 v[120:123],v7 offset:16384
v_mfma_f32_16x16x32_bf16 v[40:43],v[104:107],v[196:199],v[40:43]
s_waitcnt vmcnt(0)
v_mfma_f32_16x16x32_bf16 v[28:31],a[196:199],v[108:111],v[28:31]
ds_read_b128 v[124:127],v7 offset:20480
v_mfma_f32_16x16x32_bf16 v[44:47],v[108:111],v[196:199],v[44:47]
v_cmp_eq_u32 vcc,0,v76
v_mfma_f32_16x16x32_bf16 v[32:35],a[204:207],v[104:107],v[32:35]
s_nop 0
v_mov_b32 v76,vcc_lo
v_mfma_f32_16x16x32_bf16 v[48:51],v[104:107],v[204:207],v[48:51]
ds_write_b32 v19,v76
v_mfma_f32_16x16x32_bf16 v[36:39],a[204:207],v[108:111],v[36:39]
v_mfma_f32_16x16x32_bf16 v[52:55],v[108:111],v[204:207],v[52:55]
s_waitcnt vmcnt(0) lgkmcnt(0)
s_barrier
s_or_b32 s70,s70,s52
buffer_store_dword v17,off,s[8:11],s70 sc1
ds_read_b32 v76,v16
v_mfma_f32_16x16x32_bf16 v[24:27],a[208:211],v[112:115],v[24:27]
ds_read_b128 v[104:107],v4 offset:24576
v_mfma_f32_16x16x32_bf16 v[40:43],v[112:115],v[208:211],v[40:43]
s_lshl_b32 s56,s51,5
s_add_u32 s56,s56,s47
s_lshl_b32 s56,s56,12
v_mfma_f32_16x16x32_bf16 v[28:31],a[208:211],v[116:119],v[28:31]
ds_read_b128 v[108:111],v4 offset:28672
v_mfma_f32_16x16x32_bf16 v[44:47],v[116:119],v[208:211],v[44:47]
s_add_u32 s56,s56,s50
s_add_u32 s56,s56,58720256
v_mfma_f32_16x16x32_bf16 v[32:35],a[216:219],v[112:115],v[32:35]
v_mov_b64 v[72:73],-1
v_mov_b64 v[74:75],-1
v_mfma_f32_16x16x32_bf16 v[48:51],v[112:115],v[216:219],v[48:51]
buffer_store_dwordx4 v[72:75],v0,s[8:11],s56 offen sc1
v_mfma_f32_16x16x32_bf16 v[36:39],a[216:219],v[116:119],v[36:39]
s_add_u32 s56,s56,16777216
v_mfma_f32_16x16x32_bf16 v[52:55],v[116:119],v[216:219],v[52:55]
buffer_store_dwordx4 v[72:75],v0,s[8:11],s56 offen sc1
s_waitcnt lgkmcnt(2)
v_mfma_f32_16x16x32_bf16 v[24:27],a[212:215],v[120:123],v[24:27]
ds_read_b128 v[112:115],v5 offset:24576
v_mfma_f32_16x16x32_bf16 v[40:43],v[120:123],v[212:215],v[40:43]
v_readfirstlane_b32 s57,v76
v_mfma_f32_16x16x32_bf16 v[28:31],a[212:215],v[124:127],v[28:31]
ds_read_b128 v[116:119],v5 offset:28672
v_mfma_f32_16x16x32_bf16 v[44:47],v[124:127],v[212:215],v[44:47]
s_sub_u32 s59,s55,s54
s_cmp_lt_i32 s59,44
s_cselect_b32 s76,2,0
v_mfma_f32_16x16x32_bf16 v[32:35],a[220:223],v[120:123],v[32:35]
s_cmp_gt_i32 s53,0
s_cselect_b32 s76,s76,0
v_mfma_f32_16x16x32_bf16 v[48:51],v[120:123],v[220:223],v[48:51]
s_cmp_eq_u32 s57,0
s_cselect_b32 s76,1,s76
v_mfma_f32_16x16x32_bf16 v[36:39],a[220:223],v[124:127],v[36:39]
s_cmp_lt_i32 s59,12
s_cselect_b32 s76,2,s76
s_add_u32 s57,s54,64
v_mfma_f32_16x16x32_bf16 v[52:55],v[124:127],v[220:223],v[52:55]
s_cmp_eq_u32 s76,1
s_cselect_b32 s68,s57,s55
s_lshl_b32 s68,s68,15
s_waitcnt lgkmcnt(2)
v_mfma_f32_16x16x32_bf16 v[24:27],a[224:227],v[104:107],v[24:27]
ds_read_b128 v[120:123],v6 offset:24576
v_mfma_f32_16x16x32_bf16 v[40:43],v[104:107],v[224:227],v[40:43]
s_cmp_eq_u32 s76,0
s_cselect_b32 s68,0x80000000,s68
s_add_u32 s69,s68,16384
v_mfma_f32_16x16x32_bf16 v[28:31],a[224:227],v[108:111],v[28:31]
ds_read_b128 v[124:127],v6 offset:28672
v_mfma_f32_16x16x32_bf16 v[44:47],v[108:111],v[224:227],v[44:47]
s_add_u32 m0,s75,65536
v_mfma_f32_16x16x32_bf16 v[32:35],a[232:235],v[104:107],v[32:35]
buffer_load_dwordx4 v20,s[8:11],s68 offen offset:0 sc1 lds
v_mfma_f32_16x16x32_bf16 v[48:51],v[104:107],v[232:235],v[48:51]
s_add_u32 m0,s75,69632
v_mfma_f32_16x16x32_bf16 v[36:39],a[232:235],v[108:111],v[36:39]
buffer_load_dwordx4 v20,s[8:11],s69 offen offset:0 sc1 lds
v_mfma_f32_16x16x32_bf16 v[52:55],v[108:111],v[232:235],v[52:55]
s_add_u32 m0,s75,73472
s_waitcnt lgkmcnt(2)
v_mfma_f32_16x16x32_bf16 v[24:27],a[228:231],v[112:115],v[24:27]
ds_read_b128 v[104:107],v7 offset:24576
v_mfma_f32_16x16x32_bf16 v[40:43],v[112:115],v[228:231],v[40:43]
buffer_load_dwordx4 v20,s[8:11],s68 offen offset:256 sc1 lds
v_mfma_f32_16x16x32_bf16 v[28:31],a[228:231],v[116:119],v[28:31]
ds_read_b128 v[108:111],v7 offset:28672
v_mfma_f32_16x16x32_bf16 v[44:47],v[116:119],v[228:231],v[44:47]
s_add_u32 m0,s75,77568
v_mfma_f32_16x16x32_bf16 v[32:35],a[236:239],v[112:115],v[32:35]
buffer_load_dwordx4 v20,s[8:11],s69 offen offset:256 sc1 lds
v_mfma_f32_16x16x32_bf16 v[48:51],v[112:115],v[236:239],v[48:51]
s_add_u32 m0,s75,81408
v_mfma_f32_16x16x32_bf16 v[36:39],a[236:239],v[116:119],v[36:39]
buffer_load_dwordx4 v20,s[8:11],s68 offen offset:512 sc1 lds
v_mfma_f32_16x16x32_bf16 v[52:55],v[116:119],v[236:239],v[52:55]
s_add_u32 m0,s75,85504
s_waitcnt lgkmcnt(2)
v_mfma_f32_16x16x32_bf16 v[24:27],a[240:243],v[120:123],v[24:27]
ds_read_b128 v[112:115],v4 offset:0
v_mfma_f32_16x16x32_bf16 v[40:43],v[120:123],v[240:243],v[40:43]
buffer_load_dwordx4 v20,s[8:11],s69 offen offset:512 sc1 lds
v_mfma_f32_16x16x32_bf16 v[28:31],a[240:243],v[124:127],v[28:31]
ds_read_b128 v[116:119],v4 offset:4096
v_mfma_f32_16x16x32_bf16 v[44:47],v[124:127],v[240:243],v[44:47]
s_add_u32 m0,s75,89344
v_mfma_f32_16x16x32_bf16 v[32:35],a[248:251],v[120:123],v[32:35]
buffer_load_dwordx4 v20,s[8:11],s68 offen offset:768 sc1 lds
v_mfma_f32_16x16x32_bf16 v[48:51],v[120:123],v[248:251],v[48:51]
s_add_u32 m0,s75,93440
v_mfma_f32_16x16x32_bf16 v[36:39],a[248:251],v[124:127],v[36:39]
buffer_load_dwordx4 v20,s[8:11],s69 offen offset:768 sc1 lds
v_mfma_f32_16x16x32_bf16 v[52:55],v[124:127],v[248:251],v[52:55]
s_waitcnt lgkmcnt(2)
v_mfma_f32_16x16x32_bf16 v[24:27],a[244:247],v[104:107],v[24:27]
ds_read_b128 v[120:123],v5 offset:0
v_mfma_f32_16x16x32_bf16 v[40:43],v[104:107],v[244:247],v[40:43]
v_mfma_f32_16x16x32_bf16 v[28:31],a[244:247],v[108:111],v[28:31]
ds_read_b128 v[124:127],v5 offset:4096
v_mfma_f32_16x16x32_bf16 v[44:47],v[108:111],v[244:247],v[44:47]
v_mfma_f32_16x16x32_bf16 v[32:35],a[252:255],v[104:107],v[32:35]
v_mfma_f32_16x16x32_bf16 v[48:51],v[104:107],v[252:255],v[48:51]
v_mfma_f32_16x16x32_bf16 v[36:39],a[252:255],v[108:111],v[36:39]
v_mfma_f32_16x16x32_bf16 v[52:55],v[108:111],v[252:255],v[52:55]
s_waitcnt lgkmcnt(2)
v_mfma_f32_16x16x32_bf16 v[88:91],a[0:3],v[112:115],0
ds_read_b128 v[104:107],v6 offset:0
v_mfma_f32_16x16x32_bf16 v[92:95],a[0:3],v[116:119],0
v_mfma_f32_16x16x32_bf16 v[96:99],a[8:11],v[112:115],0
ds_read_b128 v[108:111],v6 offset:4096
v_cvt_pk_bf16_f32 v56,v24,v32
v_cvt_pk_bf16_f32 v57,v25,v33
v_mfma_f32_16x16x32_bf16 v[100:103],a[8:11],v[116:119],0
v_cvt_pk_bf16_f32 v58,v26,v34
v_cvt_pk_bf16_f32 v59,v27,v35
s_waitcnt lgkmcnt(2)
v_mfma_f32_16x16x32_bf16 v[88:91],a[4:7],v[120:123],v[88:91]
ds_read_b128 v[112:115],v7 offset:0
v_mfma_f32_16x16x32_bf16 v[92:95],a[4:7],v[124:127],v[92:95]
buffer_store_dwordx4 v[56:59],v0,s[8:11],s61 offen sc1
v_cvt_pk_bf16_f32 v60,v28,v36
v_cvt_pk_bf16_f32 v61,v29,v37
v_mfma_f32_16x16x32_bf16 v[96:99],a[12:15],v[120:123],v[96:99]
ds_read_b128 v[116:119],v7 offset:4096
v_cvt_pk_bf16_f32 v62,v30,v38
v_cvt_pk_bf16_f32 v63,v31,v39
v_mfma_f32_16x16x32_bf16 v[100:103],a[12:15],v[124:127],v[100:103]
buffer_store_dwordx4 v[60:63],v0,s[8:11],s62 offen sc1
v_cvt_pk_bf16_f32 v64,v40,v41
v_cvt_pk_bf16_f32 v65,v42,v43
s_waitcnt lgkmcnt(2)
v_mfma_f32_16x16x32_bf16 v[88:91],a[16:19],v[104:107],v[88:91]
ds_read_b128 v[120:123],v4 offset:8192
v_cvt_pk_bf16_f32 v66,v44,v45
v_cvt_pk_bf16_f32 v67,v46,v47
v_mfma_f32_16x16x32_bf16 v[92:95],a[16:19],v[108:111],v[92:95]
buffer_store_dwordx4 v[64:67],v0,s[8:11],s65 offen offset:0 sc1
v_cvt_pk_bf16_f32 v68,v48,v49
v_cvt_pk_bf16_f32 v69,v50,v51
v_mfma_f32_16x16x32_bf16 v[96:99],a[24:27],v[104:107],v[96:99]
ds_read_b128 v[124:127],v4 offset:12288
v_cvt_pk_bf16_f32 v70,v52,v53
v_cvt_pk_bf16_f32 v71,v54,v55
v_mfma_f32_16x16x32_bf16 v[100:103],a[24:27],v[108:111],v[100:103]
buffer_store_dwordx4 v[68:71],v0,s[8:11],s65 offen offset:1024 sc1
s_waitcnt lgkmcnt(2)
v_mfma_f32_16x16x32_bf16 v[88:91],a[20:23],v[112:115],v[88:91]
ds_read_b128 v[104:107],v5 offset:8192
v_mfma_f32_16x16x32_bf16 v[92:95],a[20:23],v[116:119],v[92:95]
v_mfma_f32_16x16x32_bf16 v[96:99],a[28:31],v[112:115],v[96:99]
ds_read_b128 v[108:111],v5 offset:12288
v_mfma_f32_16x16x32_bf16 v[100:103],a[28:31],v[116:119],v[100:103]
s_waitcnt lgkmcnt(2)
v_mfma_f32_16x16x32_bf16 v[88:91],a[32:35],v[120:123],v[88:91]
ds_read_b128 v[112:115],v6 offset:8192
v_mfma_f32_16x16x32_bf16 v[92:95],a[32:35],v[124:127],v[92:95]
v_mfma_f32_16x16x32_bf16 v[96:99],a[40:43],v[120:123],v[96:99]
ds_read_b128 v[116:119],v6 offset:12288
v_mfma_f32_16x16x32_bf16 v[100:103],a[40:43],v[124:127],v[100:103]
s_waitcnt lgkmcnt(2)
v_mfma_f32_16x16x32_bf16 v[88:91],a[36:39],v[104:107],v[88:91]
ds_read_b128 v[120:123],v7 offset:8192
v_mfma_f32_16x16x32_bf16 v[92:95],a[36:39],v[108:111],v[92:95]
v_mfma_f32_16x16x32_bf16 v[96:99],a[44:47],v[104:107],v[96:99]
ds_read_b128 v[124:127],v7 offset:12288
v_mfma_f32_16x16x32_bf16 v[100:103],a[44:47],v[108:111],v[100:103]
s_waitcnt lgkmcnt(2)
v_mfma_f32_16x16x32_bf16 v[88:91],a[48:51],v[112:115],v[88:91]
ds_read_b128 v[104:107],v4 offset:16384
v_mfma_f32_16x16x32_bf16 v[92:95],a[48:51],v[116:119],v[92:95]
s_lshl_b32 s56,s54,13
v_mfma_f32_16x16x32_bf16 v[96:99],a[56:59],v[112:115],v[96:99]
ds_read_b128 v[108:111],v4 offset:20480
v_mfma_f32_16x16x32_bf16 v[100:103],a[56:59],v[116:119],v[100:103]
s_add_u32 s56,s56,10487552
s_waitcnt lgkmcnt(2)
v_mfma_f32_16x16x32_bf16 v[88:91],a[52:55],v[120:123],v[88:91]
ds_read_b128 v[112:115],v5 offset:16384
v_mfma_f32_16x16x32_bf16 v[92:95],a[52:55],v[124:127],v[92:95]
s_or_b32 s56,s56,s52
v_mfma_f32_16x16x32_bf16 v[96:99],a[60:63],v[120:123],v[96:99]
ds_read_b128 v[116:119],v5 offset:20480
v_mfma_f32_16x16x32_bf16 v[100:103],a[60:63],v[124:127],v[100:103]
buffer_load_dword v76,v23,s[8:11],s56 offen sc1
s_waitcnt lgkmcnt(2)
v_mfma_f32_16x16x32_bf16 v[88:91],a[64:67],v[104:107],v[88:91]
ds_read_b128 v[120:123],v6 offset:16384
v_mfma_f32_16x16x32_bf16 v[92:95],a[64:67],v[108:111],v[92:95]
v_mfma_f32_16x16x32_bf16 v[96:99],a[72:75],v[104:107],v[96:99]
ds_read_b128 v[124:127],v6 offset:20480
v_mfma_f32_16x16x32_bf16 v[100:103],a[72:75],v[108:111],v[100:103]
s_waitcnt lgkmcnt(2)
v_mfma_f32_16x16x32_bf16 v[88:91],a[68:71],v[112:115],v[88:91]
ds_read_b128 v[104:107],v7 offset:16384
v_mfma_f32_16x16x32_bf16 v[92:95],a[68:71],v[116:119],v[92:95]
v_mfma_f32_16x16x32_bf16 v[96:99],a[76:79],v[112:115],v[96:99]
ds_read_b128 v[108:111],v7 offset:20480
v_mfma_f32_16x16x32_bf16 v[100:103],a[76:79],v[116:119],v[100:103]
s_waitcnt lgkmcnt(2)
v_mfma_f32_16x16x32_bf16 v[88:91],a[80:83],v[120:123],v[88:91]
ds_read_b128 v[112:115],v4 offset:24576
v_mfma_f32_16x16x32_bf16 v[92:95],a[80:83],v[124:127],v[92:95]
v_mfma_f32_16x16x32_bf16 v[96:99],a[88:91],v[120:123],v[96:99]
ds_read_b128 v[116:119],v4 offset:28672
v_mfma_f32_16x16x32_bf16 v[100:103],a[88:91],v[124:127],v[100:103]
s_waitcnt lgkmcnt(2)
v_mfma_f32_16x16x32_bf16 v[88:91],a[84:87],v[104:107],v[88:91]
ds_read_b128 v[120:123],v5 offset:24576
v_mfma_f32_16x16x32_bf16 v[92:95],a[84:87],v[108:111],v[92:95]
v_mfma_f32_16x16x32_bf16 v[96:99],a[92:95],v[104:107],v[96:99]
ds_read_b128 v[124:127],v5 offset:28672
v_mfma_f32_16x16x32_bf16 v[100:103],a[92:95],v[108:111],v[100:103]
s_waitcnt lgkmcnt(2)
v_mfma_f32_16x16x32_bf16 v[88:91],a[96:99],v[112:115],v[88:91]
ds_read_b128 v[104:107],v6 offset:24576
v_mfma_f32_16x16x32_bf16 v[92:95],a[96:99],v[116:119],v[92:95]
v_mfma_f32_16x16x32_bf16 v[96:99],a[104:107],v[112:115],v[96:99]
ds_read_b128 v[108:111],v6 offset:28672
v_mfma_f32_16x16x32_bf16 v[100:103],a[104:107],v[116:119],v[100:103]
s_waitcnt lgkmcnt(2)
v_mfma_f32_16x16x32_bf16 v[88:91],a[100:103],v[120:123],v[88:91]
ds_read_b128 v[112:115],v7 offset:24576
v_mfma_f32_16x16x32_bf16 v[92:95],a[100:103],v[124:127],v[92:95]
v_mfma_f32_16x16x32_bf16 v[96:99],a[108:111],v[120:123],v[96:99]
ds_read_b128 v[116:119],v7 offset:28672
v_mfma_f32_16x16x32_bf16 v[100:103],a[108:111],v[124:127],v[100:103]
s_waitcnt lgkmcnt(2)
v_mfma_f32_16x16x32_bf16 v[88:91],a[112:115],v[104:107],v[88:91]
v_mfma_f32_16x16x32_bf16 v[92:95],a[112:115],v[108:111],v[92:95]
v_mfma_f32_16x16x32_bf16 v[96:99],a[120:123],v[104:107],v[96:99]
v_mfma_f32_16x16x32_bf16 v[100:103],a[120:123],v[108:111],v[100:103]
s_waitcnt lgkmcnt(0)
v_mfma_f32_16x16x32_bf16 v[88:91],a[116:119],v[112:115],v[88:91]
v_mfma_f32_16x16x32_bf16 v[92:95],a[116:119],v[116:119],v[92:95]
v_mfma_f32_16x16x32_bf16 v[96:99],a[124:127],v[112:115],v[96:99]
v_mfma_f32_16x16x32_bf16 v[100:103],a[124:127],v[116:119],v[100:103]
s_nop 3
v_cvt_pk_bf16_f32 v104,v88,v96
v_cvt_pk_bf16_f32 v105,v89,v97
v_cvt_pk_bf16_f32 v106,v90,v98
v_cvt_pk_bf16_f32 v107,v91,v99
v_cvt_pk_bf16_f32 v108,v92,v100
v_cvt_pk_bf16_f32 v109,v93,v101
v_cvt_pk_bf16_f32 v110,v94,v102
v_cvt_pk_bf16_f32 v111,v95,v103
buffer_store_dwordx4 v[104:107],v0,s[8:11],s63 offen sc1
buffer_store_dwordx4 v[108:111],v0,s[8:11],s64 offen sc1
s_lshl_b32 s59,s51,13
s_lshl2_add_u32 s59,s47,s59
s_add_u32 s59,s59,10485888
s_waitcnt vmcnt(3)
s_barrier
s_or_b32 s59,s59,s52
buffer_store_dword v17,off,s[8:11],s59 sc1
s_mov_b32 s77,1
s_lshl_b32 s70,s51,13
s_lshl2_add_u32 s70,s47,s70
s_add_u32 s70,s70,10486144
s_branch L_p_23
L_p_22:
s_mov_b32 s75,s74
s_xor_b32 s74,s74,32768
v_xor_b32 v4,32768,v4
v_xor_b32 v5,32768,v5
v_xor_b32 v6,32768,v6
v_xor_b32 v7,32768,v7
ds_read_b128 v[104:107],v4 offset:0
ds_read_b128 v[108:111],v4 offset:4096
ds_read_b128 v[112:115],v5 offset:0
ds_read_b128 v[116:119],v5 offset:4096
s_waitcnt lgkmcnt(2)
v_mfma_f32_16x16x32_bf16 v[24:27],a[128:131],v[104:107],0
ds_read_b128 v[120:123],v6 offset:0
v_mfma_f32_16x16x32_bf16 v[40:43],v[104:107],v[128:131],0
s_lshl_b32 s58,s51,5
v_mfma_f32_16x16x32_bf16 v[28:31],a[128:131],v[108:111],0
ds_read_b128 v[124:127],v6 offset:4096
v_mfma_f32_16x16x32_bf16 v[44:47],v[108:111],v[128:131],0
s_add_u32 s58,s58,s47
v_mfma_f32_16x16x32_bf16 v[32:35],a[136:139],v[104:107],0
s_mul_i32 s58,s58,24576
v_mfma_f32_16x16x32_bf16 v[48:51],v[104:107],v[136:139],0
s_add_u32 s58,s58,150994944
v_mfma_f32_16x16x32_bf16 v[36:39],a[136:139],v[108:111],0
s_add_u32 s61,s58,s50
v_mfma_f32_16x16x32_bf16 v[52:55],v[108:111],v[136:139],0
s_add_u32 s62,s61,4096
s_waitcnt lgkmcnt(2)
v_mfma_f32_16x16x32_bf16 v[24:27],a[132:135],v[112:115],v[24:27]
ds_read_b128 v[104:107],v7 offset:0
v_mfma_f32_16x16x32_bf16 v[40:43],v[112:115],v[132:135],v[40:43]
s_add_u32 s63,s61,16384
v_mfma_f32_16x16x32_bf16 v[28:31],a[132:135],v[116:119],v[28:31]
ds_read_b128 v[108:111],v7 offset:4096
v_mfma_f32_16x16x32_bf16 v[44:47],v[116:119],v[132:135],v[44:47]
s_add_u32 s64,s61,20480
v_mfma_f32_16x16x32_bf16 v[32:35],a[140:143],v[112:115],v[32:35]
s_add_u32 s65,s61,s50
v_mfma_f32_16x16x32_bf16 v[48:51],v[112:115],v[140:143],v[48:51]
s_add_u32 s65,s65,8192
v_mfma_f32_16x16x32_bf16 v[36:39],a[140:143],v[116:119],v[36:39]
v_mfma_f32_16x16x32_bf16 v[52:55],v[116:119],v[140:143],v[52:55]
s_waitcnt lgkmcnt(2)
v_mfma_f32_16x16x32_bf16 v[24:27],a[144:147],v[120:123],v[24:27]
ds_read_b128 v[112:115],v4 offset:8192
v_mfma_f32_16x16x32_bf16 v[40:43],v[120:123],v[144:147],v[40:43]
v_mfma_f32_16x16x32_bf16 v[28:31],a[144:147],v[124:127],v[28:31]
ds_read_b128 v[116:119],v4 offset:12288
v_mfma_f32_16x16x32_bf16 v[44:47],v[124:127],v[144:147],v[44:47]
v_mfma_f32_16x16x32_bf16 v[32:35],a[152:155],v[120:123],v[32:35]
v_mfma_f32_16x16x32_bf16 v[48:51],v[120:123],v[152:155],v[48:51]
v_mfma_f32_16x16x32_bf16 v[36:39],a[152:155],v[124:127],v[36:39]
v_mfma_f32_16x16x32_bf16 v[52:55],v[124:127],v[152:155],v[52:55]
s_waitcnt lgkmcnt(2)
v_mfma_f32_16x16x32_bf16 v[24:27],a[148:151],v[104:107],v[24:27]
ds_read_b128 v[120:123],v5 offset:8192
v_mfma_f32_16x16x32_bf16 v[40:43],v[104:107],v[148:151],v[40:43]
v_mfma_f32_16x16x32_bf16 v[28:31],a[148:151],v[108:111],v[28:31]
ds_read_b128 v[124:127],v5 offset:12288
v_mfma_f32_16x16x32_bf16 v[44:47],v[108:111],v[148:151],v[44:47]
v_mfma_f32_16x16x32_bf16 v[32:35],a[156:159],v[104:107],v[32:35]
v_mfma_f32_16x16x32_bf16 v[48:51],v[104:107],v[156:159],v[48:51]
v_mfma_f32_16x16x32_bf16 v[36:39],a[156:159],v[108:111],v[36:39]
v_mfma_f32_16x16x32_bf16 v[52:55],v[108:111],v[156:159],v[52:55]
s_waitcnt lgkmcnt(2)
v_mfma_f32_16x16x32_bf16 v[24:27],a[160:163],v[112:115],v[24:27]
ds_read_b128 v[104:107],v6 offset:8192
v_mfma_f32_16x16x32_bf16 v[40:43],v[112:115],v[160:163],v[40:43]
s_lshl_b32 s56,s54,13
v_mfma_f32_16x16x32_bf16 v[28:31],a[160:163],v[116:119],v[28:31]
ds_read_b128 v[108:111],v6 offset:12288
v_mfma_f32_16x16x32_bf16 v[44:47],v[116:119],v[160:163],v[44:47]
s_add_u32 s56,s56,10487552
v_mfma_f32_16x16x32_bf16 v[32:35],a[168:171],v[112:115],v[32:35]
s_or_b32 s56,s56,s52
v_mfma_f32_16x16x32_bf16 v[48:51],v[112:115],v[168:171],v[48:51]
buffer_load_dword v76,v23,s[8:11],s56 offen sc1
v_mfma_f32_16x16x32_bf16 v[36:39],a[168:171],v[116:119],v[36:39]
v_mfma_f32_16x16x32_bf16 v[52:55],v[116:119],v[168:171],v[52:55]
s_waitcnt lgkmcnt(2)
v_mfma_f32_16x16x32_bf16 v[24:27],a[164:167],v[120:123],v[24:27]
ds_read_b128 v[112:115],v7 offset:8192
v_mfma_f32_16x16x32_bf16 v[40:43],v[120:123],v[164:167],v[40:43]
v_mfma_f32_16x16x32_bf16 v[28:31],a[164:167],v[124:127],v[28:31]
ds_read_b128 v[116:119],v7 offset:12288
v_mfma_f32_16x16x32_bf16 v[44:47],v[124:127],v[164:167],v[44:47]
v_mfma_f32_16x16x32_bf16 v[32:35],a[172:175],v[120:123],v[32:35]
v_mfma_f32_16x16x32_bf16 v[48:51],v[120:123],v[172:175],v[48:51]
v_mfma_f32_16x16x32_bf16 v[36:39],a[172:175],v[124:127],v[36:39]
v_mfma_f32_16x16x32_bf16 v[52:55],v[124:127],v[172:175],v[52:55]
s_waitcnt lgkmcnt(2)
v_mfma_f32_16x16x32_bf16 v[24:27],a[176:179],v[104:107],v[24:27]
ds_read_b128 v[120:123],v4 offset:16384
v_mfma_f32_16x16x32_bf16 v[40:43],v[104:107],v[176:179],v[40:43]
v_mfma_f32_16x16x32_bf16 v[28:31],a[176:179],v[108:111],v[28:31]
ds_read_b128 v[124:127],v4 offset:20480
v_mfma_f32_16x16x32_bf16 v[44:47],v[108:111],v[176:179],v[44:47]
v_mfma_f32_16x16x32_bf16 v[32:35],a[184:187],v[104:107],v[32:35]
v_mfma_f32_16x16x32_bf16 v[48:51],v[104:107],v[184:187],v[48:51]
v_mfma_f32_16x16x32_bf16 v[36:39],a[184:187],v[108:111],v[36:39]
v_mfma_f32_16x16x32_bf16 v[52:55],v[108:111],v[184:187],v[52:55]
s_waitcnt lgkmcnt(2)
v_mfma_f32_16x16x32_bf16 v[24:27],a[180:183],v[112:115],v[24:27]
ds_read_b128 v[104:107],v5 offset:16384
v_mfma_f32_16x16x32_bf16 v[40:43],v[112:115],v[180:183],v[40:43]
v_mfma_f32_16x16x32_bf16 v[28:31],a[180:183],v[116:119],v[28:31]
ds_read_b128 v[108:111],v5 offset:20480
v_mfma_f32_16x16x32_bf16 v[44:47],v[116:119],v[180:183],v[44:47]
v_mfma_f32_16x16x32_bf16 v[32:35],a[188:191],v[112:115],v[32:35]
v_mfma_f32_16x16x32_bf16 v[48:51],v[112:115],v[188:191],v[48:51]
v_mfma_f32_16x16x32_bf16 v[36:39],a[188:191],v[116:119],v[36:39]
v_mfma_f32_16x16x32_bf16 v[52:55],v[116:119],v[188:191],v[52:55]
s_waitcnt lgkmcnt(2)
v_mfma_f32_16x16x32_bf16 v[24:27],a[192:195],v[120:123],v[24:27]
ds_read_b128 v[112:115],v6 offset:16384
v_mfma_f32_16x16x32_bf16 v[40:43],v[120:123],v[192:195],v[40:43]
v_mfma_f32_16x16x32_bf16 v[28:31],a[192:195],v[124:127],v[28:31]
ds_read_b128 v[116:119],v6 offset:20480
v_mfma_f32_16x16x32_bf16 v[44:47],v[124:127],v[192:195],v[44:47]
v_mfma_f32_16x16x32_bf16 v[32:35],a[200:203],v[120:123],v[32:35]
v_mfma_f32_16x16x32_bf16 v[48:51],v[120:123],v[200:203],v[48:51]
v_mfma_f32_16x16x32_bf16 v[36:39],a[200:203],v[124:127],v[36:39]
v_mfma_f32_16x16x32_bf16 v[52:55],v[124:127],v[200:203],v[52:55]
s_waitcnt lgkmcnt(2)
v_mfma_f32_16x16x32_bf16 v[24:27],a[196:199],v[104:107],v[24:27]
ds_read_b128 v[120:123],v7 offset:16384
v_mfma_f32_16x16x32_bf16 v[40:43],v[104:107],v[196:199],v[40:43]
s_waitcnt vmcnt(0)
v_mfma_f32_16x16x32_bf16 v[28:31],a[196:199],v[108:111],v[28:31]
ds_read_b128 v[124:127],v7 offset:20480
v_mfma_f32_16x16x32_bf16 v[44:47],v[108:111],v[196:199],v[44:47]
v_cmp_eq_u32 vcc,0,v76
v_mfma_f32_16x16x32_bf16 v[32:35],a[204:207],v[104:107],v[32:35]
s_nop 0
v_mov_b32 v76,vcc_lo
v_mfma_f32_16x16x32_bf16 v[48:51],v[104:107],v[204:207],v[48:51]
ds_write_b32 v19,v76
v_mfma_f32_16x16x32_bf16 v[36:39],a[204:207],v[108:111],v[36:39]
v_mfma_f32_16x16x32_bf16 v[52:55],v[108:111],v[204:207],v[52:55]
s_waitcnt vmcnt(0) lgkmcnt(0)
s_barrier
s_or_b32 s70,s70,s52
buffer_store_dword v17,off,s[8:11],s70 sc1
ds_read_b32 v76,v16
v_mfma_f32_16x16x32_bf16 v[24:27],a[208:211],v[112:115],v[24:27]
ds_read_b128 v[104:107],v4 offset:24576
v_mfma_f32_16x16x32_bf16 v[40:43],v[112:115],v[208:211],v[40:43]
s_lshl_b32 s56,s51,5
s_add_u32 s56,s56,s47
s_lshl_b32 s56,s56,12
v_mfma_f32_16x16x32_bf16 v[28:31],a[208:211],v[116:119],v[28:31]
ds_read_b128 v[108:111],v4 offset:28672
v_mfma_f32_16x16x32_bf16 v[44:47],v[116:119],v[208:211],v[44:47]
s_add_u32 s56,s56,s50
s_add_u32 s56,s56,58720256
v_mfma_f32_16x16x32_bf16 v[32:35],a[216:219],v[112:115],v[32:35]
v_mov_b64 v[72:73],-1
v_mov_b64 v[74:75],-1
v_mfma_f32_16x16x32_bf16 v[48:51],v[112:115],v[216:219],v[48:51]
buffer_store_dwordx4 v[72:75],v0,s[8:11],s56 offen sc1
v_mfma_f32_16x16x32_bf16 v[36:39],a[216:219],v[116:119],v[36:39]
s_add_u32 s56,s56,16777216
v_mfma_f32_16x16x32_bf16 v[52:55],v[116:119],v[216:219],v[52:55]
buffer_store_dwordx4 v[72:75],v0,s[8:11],s56 offen sc1
s_waitcnt lgkmcnt(2)
v_mfma_f32_16x16x32_bf16 v[24:27],a[212:215],v[120:123],v[24:27]
ds_read_b128 v[112:115],v5 offset:24576
v_mfma_f32_16x16x32_bf16 v[40:43],v[120:123],v[212:215],v[40:43]
v_readfirstlane_b32 s57,v76
v_mfma_f32_16x16x32_bf16 v[28:31],a[212:215],v[124:127],v[28:31]
ds_read_b128 v[116:119],v5 offset:28672
v_mfma_f32_16x16x32_bf16 v[44:47],v[124:127],v[212:215],v[44:47]
s_sub_u32 s59,s55,s54
s_cmp_lt_i32 s59,44
s_cselect_b32 s76,2,0
v_mfma_f32_16x16x32_bf16 v[32:35],a[220:223],v[120:123],v[32:35]
s_cmp_gt_i32 s53,0
s_cselect_b32 s76,s76,0
v_mfma_f32_16x16x32_bf16 v[48:51],v[120:123],v[220:223],v[48:51]
s_cmp_eq_u32 s57,0
s_cselect_b32 s76,1,s76
v_mfma_f32_16x16x32_bf16 v[36:39],a[220:223],v[124:127],v[36:39]
s_cmp_lt_i32 s59,12
s_cselect_b32 s76,2,s76
s_add_u32 s57,s54,64
v_mfma_f32_16x16x32_bf16 v[52:55],v[124:127],v[220:223],v[52:55]
s_cmp_eq_u32 s76,1
s_cselect_b32 s68,s57,s55
s_lshl_b32 s68,s68,15
s_waitcnt lgkmcnt(2)
v_mfma_f32_16x16x32_bf16 v[24:27],a[224:227],v[104:107],v[24:27]
ds_read_b128 v[120:123],v6 offset:24576
v_mfma_f32_16x16x32_bf16 v[40:43],v[104:107],v[224:227],v[40:43]
s_cmp_eq_u32 s76,0
s_cselect_b32 s68,0x80000000,s68
s_add_u32 s69,s68,16384
v_mfma_f32_16x16x32_bf16 v[28:31],a[224:227],v[108:111],v[28:31]
ds_read_b128 v[124:127],v6 offset:28672
v_mfma_f32_16x16x32_bf16 v[44:47],v[108:111],v[224:227],v[44:47]
s_add_u32 m0,s75,65536
v_mfma_f32_16x16x32_bf16 v[32:35],a[232:235],v[104:107],v[32:35]
buffer_load_dwordx4 v20,s[8:11],s68 offen offset:0 sc1 lds
v_mfma_f32_16x16x32_bf16 v[48:51],v[104:107],v[232:235],v[48:51]
s_add_u32 m0,s75,69632
v_mfma_f32_16x16x32_bf16 v[36:39],a[232:235],v[108:111],v[36:39]
buffer_load_dwordx4 v20,s[8:11],s69 offen offset:0 sc1 lds
v_mfma_f32_16x16x32_bf16 v[52:55],v[108:111],v[232:235],v[52:55]
s_add_u32 m0,s75,73472
s_waitcnt lgkmcnt(2)
v_mfma_f32_16x16x32_bf16 v[24:27],a[228:231],v[112:115],v[24:27]
ds_read_b128 v[104:107],v7 offset:24576
v_mfma_f32_16x16x32_bf16 v[40:43],v[112:115],v[228:231],v[40:43]
buffer_load_dwordx4 v20,s[8:11],s68 offen offset:256 sc1 lds
v_mfma_f32_16x16x32_bf16 v[28:31],a[228:231],v[116:119],v[28:31]
ds_read_b128 v[108:111],v7 offset:28672
v_mfma_f32_16x16x32_bf16 v[44:47],v[116:119],v[228:231],v[44:47]
s_add_u32 m0,s75,77568
v_mfma_f32_16x16x32_bf16 v[32:35],a[236:239],v[112:115],v[32:35]
buffer_load_dwordx4 v20,s[8:11],s69 offen offset:256 sc1 lds
v_mfma_f32_16x16x32_bf16 v[48:51],v[112:115],v[236:239],v[48:51]
s_add_u32 m0,s75,81408
v_mfma_f32_16x16x32_bf16 v[36:39],a[236:239],v[116:119],v[36:39]
buffer_load_dwordx4 v20,s[8:11],s68 offen offset:512 sc1 lds
v_mfma_f32_16x16x32_bf16 v[52:55],v[116:119],v[236:239],v[52:55]
s_add_u32 m0,s75,85504
s_waitcnt lgkmcnt(2)
v_mfma_f32_16x16x32_bf16 v[24:27],a[240:243],v[120:123],v[24:27]
ds_read_b128 v[112:115],v4 offset:0
v_mfma_f32_16x16x32_bf16 v[40:43],v[120:123],v[240:243],v[40:43]
buffer_load_dwordx4 v20,s[8:11],s69 offen offset:512 sc1 lds
v_mfma_f32_16x16x32_bf16 v[28:31],a[240:243],v[124:127],v[28:31]
ds_read_b128 v[116:119],v4 offset:4096
v_mfma_f32_16x16x32_bf16 v[44:47],v[124:127],v[240:243],v[44:47]
s_add_u32 m0,s75,89344
v_mfma_f32_16x16x32_bf16 v[32:35],a[248:251],v[120:123],v[32:35]
buffer_load_dwordx4 v20,s[8:11],s68 offen offset:768 sc1 lds
v_mfma_f32_16x16x32_bf16 v[48:51],v[120:123],v[248:251],v[48:51]
s_add_u32 m0,s75,93440
v_mfma_f32_16x16x32_bf16 v[36:39],a[248:251],v[124:127],v[36:39]
buffer_load_dwordx4 v20,s[8:11],s69 offen offset:768 sc1 lds
v_mfma_f32_16x16x32_bf16 v[52:55],v[124:127],v[248:251],v[52:55]
s_waitcnt lgkmcnt(2)
v_mfma_f32_16x16x32_bf16 v[24:27],a[244:247],v[104:107],v[24:27]
ds_read_b128 v[120:123],v5 offset:0
v_mfma_f32_16x16x32_bf16 v[40:43],v[104:107],v[244:247],v[40:43]
v_mfma_f32_16x16x32_bf16 v[28:31],a[244:247],v[108:111],v[28:31]
ds_read_b128 v[124:127],v5 offset:4096
v_mfma_f32_16x16x32_bf16 v[44:47],v[108:111],v[244:247],v[44:47]
v_mfma_f32_16x16x32_bf16 v[32:35],a[252:255],v[104:107],v[32:35]
v_mfma_f32_16x16x32_bf16 v[48:51],v[104:107],v[252:255],v[48:51]
v_mfma_f32_16x16x32_bf16 v[36:39],a[252:255],v[108:111],v[36:39]
v_mfma_f32_16x16x32_bf16 v[52:55],v[108:111],v[252:255],v[52:55]
s_waitcnt lgkmcnt(2)
v_mfma_f32_16x16x32_bf16 v[88:91],a[0:3],v[112:115],0
ds_read_b128 v[104:107],v6 offset:0
v_mfma_f32_16x16x32_bf16 v[92:95],a[0:3],v[116:119],0
v_mfma_f32_16x16x32_bf16 v[96:99],a[8:11],v[112:115],0
ds_read_b128 v[108:111],v6 offset:4096
v_cvt_pk_bf16_f32 v56,v24,v32
v_cvt_pk_bf16_f32 v57,v25,v33
v_mfma_f32_16x16x32_bf16 v[100:103],a[8:11],v[116:119],0
v_cvt_pk_bf16_f32 v58,v26,v34
v_cvt_pk_bf16_f32 v59,v27,v35
s_waitcnt lgkmcnt(2)
v_mfma_f32_16x16x32_bf16 v[88:91],a[4:7],v[120:123],v[88:91]
ds_read_b128 v[112:115],v7 offset:0
v_mfma_f32_16x16x32_bf16 v[92:95],a[4:7],v[124:127],v[92:95]
buffer_store_dwordx4 v[56:59],v0,s[8:11],s61 offen sc1
v_cvt_pk_bf16_f32 v60,v28,v36
v_cvt_pk_bf16_f32 v61,v29,v37
v_mfma_f32_16x16x32_bf16 v[96:99],a[12:15],v[120:123],v[96:99]
ds_read_b128 v[116:119],v7 offset:4096
v_cvt_pk_bf16_f32 v62,v30,v38
v_cvt_pk_bf16_f32 v63,v31,v39
v_mfma_f32_16x16x32_bf16 v[100:103],a[12:15],v[124:127],v[100:103]
buffer_store_dwordx4 v[60:63],v0,s[8:11],s62 offen sc1
v_cvt_pk_bf16_f32 v64,v40,v41
v_cvt_pk_bf16_f32 v65,v42,v43
s_waitcnt lgkmcnt(2)
v_mfma_f32_16x16x32_bf16 v[88:91],a[16:19],v[104:107],v[88:91]
ds_read_b128 v[120:123],v4 offset:8192
v_cvt_pk_bf16_f32 v66,v44,v45
v_cvt_pk_bf16_f32 v67,v46,v47
v_mfma_f32_16x16x32_bf16 v[92:95],a[16:19],v[108:111],v[92:95]
buffer_store_dwordx4 v[64:67],v0,s[8:11],s65 offen offset:0 sc1
v_cvt_pk_bf16_f32 v68,v48,v49
v_cvt_pk_bf16_f32 v69,v50,v51
v_mfma_f32_16x16x32_bf16 v[96:99],a[24:27],v[104:107],v[96:99]
ds_read_b128 v[124:127],v4 offset:12288
v_cvt_pk_bf16_f32 v70,v52,v53
v_cvt_pk_bf16_f32 v71,v54,v55
v_mfma_f32_16x16x32_bf16 v[100:103],a[24:27],v[108:111],v[100:103]
buffer_store_dwordx4 v[68:71],v0,s[8:11],s65 offen offset:1024 sc1
s_waitcnt lgkmcnt(2)
v_mfma_f32_16x16x32_bf16 v[88:91],a[20:23],v[112:115],v[88:91]
ds_read_b128 v[104:107],v5 offset:8192
v_mfma_f32_16x16x32_bf16 v[92:95],a[20:23],v[116:119],v[92:95]
v_mfma_f32_16x16x32_bf16 v[96:99],a[28:31],v[112:115],v[96:99]
ds_read_b128 v[108:111],v5 offset:12288
v_mfma_f32_16x16x32_bf16 v[100:103],a[28:31],v[116:119],v[100:103]
s_waitcnt lgkmcnt(2)
v_mfma_f32_16x16x32_bf16 v[88:91],a[32:35],v[120:123],v[88:91]
ds_read_b128 v[112:115],v6 offset:8192
v_mfma_f32_16x16x32_bf16 v[92:95],a[32:35],v[124:127],v[92:95]
v_mfma_f32_16x16x32_bf16 v[96:99],a[40:43],v[120:123],v[96:99]
ds_read_b128 v[116:119],v6 offset:12288
v_mfma_f32_16x16x32_bf16 v[100:103],a[40:43],v[124:127],v[100:103]
s_waitcnt lgkmcnt(2)
v_mfma_f32_16x16x32_bf16 v[88:91],a[36:39],v[104:107],v[88:91]
ds_read_b128 v[120:123],v7 offset:8192
v_mfma_f32_16x16x32_bf16 v[92:95],a[36:39],v[108:111],v[92:95]
v_mfma_f32_16x16x32_bf16 v[96:99],a[44:47],v[104:107],v[96:99]
ds_read_b128 v[124:127],v7 offset:12288
v_mfma_f32_16x16x32_bf16 v[100:103],a[44:47],v[108:111],v[100:103]
s_waitcnt lgkmcnt(2)
v_mfma_f32_16x16x32_bf16 v[88:91],a[48:51],v[112:115],v[88:91]
ds_read_b128 v[104:107],v4 offset:16384
v_mfma_f32_16x16x32_bf16 v[92:95],a[48:51],v[116:119],v[92:95]
s_lshl_b32 s56,s54,13
v_mfma_f32_16x16x32_bf16 v[96:99],a[56:59],v[112:115],v[96:99]
ds_read_b128 v[108:111],v4 offset:20480
v_mfma_f32_16x16x32_bf16 v[100:103],a[56:59],v[116:119],v[100:103]
s_add_u32 s56,s56,10487552
s_waitcnt lgkmcnt(2)
v_mfma_f32_16x16x32_bf16 v[88:91],a[52:55],v[120:123],v[88:91]
ds_read_b128 v[112:115],v5 offset:16384
v_mfma_f32_16x16x32_bf16 v[92:95],a[52:55],v[124:127],v[92:95]
s_or_b32 s56,s56,s52
v_mfma_f32_16x16x32_bf16 v[96:99],a[60:63],v[120:123],v[96:99]
ds_read_b128 v[116:119],v5 offset:20480
v_mfma_f32_16x16x32_bf16 v[100:103],a[60:63],v[124:127],v[100:103]
buffer_load_dword v76,v23,s[8:11],s56 offen sc1
s_waitcnt lgkmcnt(2)
v_mfma_f32_16x16x32_bf16 v[88:91],a[64:67],v[104:107],v[88:91]
ds_read_b128 v[120:123],v6 offset:16384
v_mfma_f32_16x16x32_bf16 v[92:95],a[64:67],v[108:111],v[92:95]
v_mfma_f32_16x16x32_bf16 v[96:99],a[72:75],v[104:107],v[96:99]
ds_read_b128 v[124:127],v6 offset:20480
v_mfma_f32_16x16x32_bf16 v[100:103],a[72:75],v[108:111],v[100:103]
s_waitcnt lgkmcnt(2)
v_mfma_f32_16x16x32_bf16 v[88:91],a[68:71],v[112:115],v[88:91]
ds_read_b128 v[104:107],v7 offset:16384
v_mfma_f32_16x16x32_bf16 v[92:95],a[68:71],v[116:119],v[92:95]
v_mfma_f32_16x16x32_bf16 v[96:99],a[76:79],v[112:115],v[96:99]
ds_read_b128 v[108:111],v7 offset:20480
v_mfma_f32_16x16x32_bf16 v[100:103],a[76:79],v[116:119],v[100:103]
s_waitcnt lgkmcnt(2)
v_mfma_f32_16x16x32_bf16 v[88:91],a[80:83],v[120:123],v[88:91]
ds_read_b128 v[112:115],v4 offset:24576
v_mfma_f32_16x16x32_bf16 v[92:95],a[80:83],v[124:127],v[92:95]
v_mfma_f32_16x16x32_bf16 v[96:99],a[88:91],v[120:123],v[96:99]
ds_read_b128 v[116:119],v4 offset:28672
v_mfma_f32_16x16x32_bf16 v[100:103],a[88:91],v[124:127],v[100:103]
s_waitcnt lgkmcnt(2)
v_mfma_f32_16x16x32_bf16 v[88:91],a[84:87],v[104:107],v[88:91]
ds_read_b128 v[120:123],v5 offset:24576
v_mfma_f32_16x16x32_bf16 v[92:95],a[84:87],v[108:111],v[92:95]
v_mfma_f32_16x16x32_bf16 v[96:99],a[92:95],v[104:107],v[96:99]
ds_read_b128 v[124:127],v5 offset:28672
v_mfma_f32_16x16x32_bf16 v[100:103],a[92:95],v[108:111],v[100:103]
s_waitcnt lgkmcnt(2)
v_mfma_f32_16x16x32_bf16 v[88:91],a[96:99],v[112:115],v[88:91]
ds_read_b128 v[104:107],v6 offset:24576
v_mfma_f32_16x16x32_bf16 v[92:95],a[96:99],v[116:119],v[92:95]
v_mfma_f32_16x16x32_bf16 v[96:99],a[104:107],v[112:115],v[96:99]
ds_read_b128 v[108:111],v6 offset:28672
v_mfma_f32_16x16x32_bf16 v[100:103],a[104:107],v[116:119],v[100:103]
s_waitcnt lgkmcnt(2)
v_mfma_f32_16x16x32_bf16 v[88:91],a[100:103],v[120:123],v[88:91]
ds_read_b128 v[112:115],v7 offset:24576
v_mfma_f32_16x16x32_bf16 v[92:95],a[100:103],v[124:127],v[92:95]
v_mfma_f32_16x16x32_bf16 v[96:99],a[108:111],v[120:123],v[96:99]
ds_read_b128 v[116:119],v7 offset:28672
v_mfma_f32_16x16x32_bf16 v[100:103],a[108:111],v[124:127],v[100:103]
s_waitcnt lgkmcnt(2)
v_mfma_f32_16x16x32_bf16 v[88:91],a[112:115],v[104:107],v[88:91]
v_mfma_f32_16x16x32_bf16 v[92:95],a[112:115],v[108:111],v[92:95]
v_mfma_f32_16x16x32_bf16 v[96:99],a[120:123],v[104:107],v[96:99]
v_mfma_f32_16x16x32_bf16 v[100:103],a[120:123],v[108:111],v[100:103]
s_waitcnt lgkmcnt(0)
v_mfma_f32_16x16x32_bf16 v[88:91],a[116:119],v[112:115],v[88:91]
v_mfma_f32_16x16x32_bf16 v[92:95],a[116:119],v[116:119],v[92:95]
v_mfma_f32_16x16x32_bf16 v[96:99],a[124:127],v[112:115],v[96:99]
v_mfma_f32_16x16x32_bf16 v[100:103],a[124:127],v[116:119],v[100:103]
s_nop 3
v_cvt_pk_bf16_f32 v104,v88,v96
v_cvt_pk_bf16_f32 v105,v89,v97
v_cvt_pk_bf16_f32 v106,v90,v98
v_cvt_pk_bf16_f32 v107,v91,v99
v_cvt_pk_bf16_f32 v108,v92,v100
v_cvt_pk_bf16_f32 v109,v93,v101
v_cvt_pk_bf16_f32 v110,v94,v102
v_cvt_pk_bf16_f32 v111,v95,v103
buffer_store_dwordx4 v[104:107],v0,s[8:11],s63 offen sc1
buffer_store_dwordx4 v[108:111],v0,s[8:11],s64 offen sc1
s_lshl_b32 s59,s51,13
s_lshl2_add_u32 s59,s47,s59
s_add_u32 s59,s59,10485888
s_waitcnt vmcnt(3)
s_barrier
s_or_b32 s59,s59,s52
buffer_store_dword v17,off,s[8:11],s59 sc1
s_mov_b32 s77,1
s_lshl_b32 s70,s51,13
s_lshl2_add_u32 s70,s47,s70
s_add_u32 s70,s70,10486144
s_branch L_p_23
L_p_24:
s_endpgm
L_rm_5:
v_and_b32 v33,15,v1
v_lshrrev_b32 v34,4,v1
s_min_u32 s60,s47,27
s_lshl_b32 s60,s60,7
s_mul_i32 s59,s46,458752
s_add_u32 s60,s60,s59
v_mul_u32_u24 v36,114688,v34
v_and_b32 v35,7,v33
v_lshl_add_u32 v36,v35,4,v36
v_add_u32 v36,s60,v36
v_cmp_gt_u32 vcc,8,v33
v_mov_b32 v38,s36
v_mov_b32 v39,s37
v_mov_b32 v40,s34
v_mov_b32 v41,s35
v_cndmask_b32 v38,v38,v40,vcc
v_cndmask_b32 v39,v39,v41,vcc
v_add_co_u32 v38,vcc,v38,v36
s_nop 1
v_addc_co_u32 v39,vcc,0,v39,vcc
s_lshl_b32 s56,s46,15
v_add_u32 v37,s56,v0
global_load_dwordx4 v[44:47],v[38:39],off
v_add_co_u32 v38,vcc,3584,v38
s_nop 1
v_addc_co_u32 v39,vcc,0,v39,vcc
global_load_dwordx4 v[48:51],v[38:39],off
v_add_co_u32 v38,vcc,3584,v38
s_nop 1
v_addc_co_u32 v39,vcc,0,v39,vcc
global_load_dwordx4 v[52:55],v[38:39],off
v_add_co_u32 v38,vcc,3584,v38
s_nop 1
v_addc_co_u32 v39,vcc,0,v39,vcc
global_load_dwordx4 v[56:59],v[38:39],off
v_add_co_u32 v38,vcc,3584,v38
s_nop 1
v_addc_co_u32 v39,vcc,0,v39,vcc
global_load_dwordx4 v[60:63],v[38:39],off
v_add_co_u32 v38,vcc,3584,v38
s_nop 1
v_addc_co_u32 v39,vcc,0,v39,vcc
global_load_dwordx4 v[64:67],v[38:39],off
v_add_co_u32 v38,vcc,3584,v38
s_nop 1
v_addc_co_u32 v39,vcc,0,v39,vcc
global_load_dwordx4 v[68:71],v[38:39],off
v_add_co_u32 v38,vcc,3584,v38
s_nop 1
v_addc_co_u32 v39,vcc,0,v39,vcc
global_load_dwordx4 v[72:75],v[38:39],off
v_add_co_u32 v38,vcc,3584,v38
s_nop 1
v_addc_co_u32 v39,vcc,0,v39,vcc
global_load_dwordx4 v[76:79],v[38:39],off
v_add_co_u32 v38,vcc,3584,v38
s_nop 1
v_addc_co_u32 v39,vcc,0,v39,vcc
global_load_dwordx4 v[80:83],v[38:39],off
v_add_co_u32 v38,vcc,3584,v38
s_nop 1
v_addc_co_u32 v39,vcc,0,v39,vcc
global_load_dwordx4 v[84:87],v[38:39],off
v_add_co_u32 v38,vcc,3584,v38
s_nop 1
v_addc_co_u32 v39,vcc,0,v39,vcc
global_load_dwordx4 v[88:91],v[38:39],off
v_add_co_u32 v38,vcc,3584,v38
s_nop 1
v_addc_co_u32 v39,vcc,0,v39,vcc
global_load_dwordx4 v[92:95],v[38:39],off
v_add_co_u32 v38,vcc,3584,v38
s_nop 1
v_addc_co_u32 v39,vcc,0,v39,vcc
global_load_dwordx4 v[96:99],v[38:39],off
v_add_co_u32 v38,vcc,3584,v38
s_nop 1
v_addc_co_u32 v39,vcc,0,v39,vcc
global_load_dwordx4 v[100:103],v[38:39],off
v_add_co_u32 v38,vcc,3584,v38
s_nop 1
v_addc_co_u32 v39,vcc,0,v39,vcc
global_load_dwordx4 v[104:107],v[38:39],off
v_add_co_u32 v38,vcc,3584,v38
s_nop 1
v_addc_co_u32 v39,vcc,0,v39,vcc
s_waitcnt vmcnt(15)
ds_write_b128 v37,v[44:47] offset:0
s_waitcnt vmcnt(14)
ds_write_b128 v37,v[48:51] offset:1024
s_waitcnt vmcnt(13)
ds_write_b128 v37,v[52:55] offset:2048
s_waitcnt vmcnt(12)
ds_write_b128 v37,v[56:59] offset:3072
s_waitcnt vmcnt(11)
ds_write_b128 v37,v[60:63] offset:4096
s_waitcnt vmcnt(10)
ds_write_b128 v37,v[64:67] offset:5120
s_waitcnt vmcnt(9)
ds_write_b128 v37,v[68:71] offset:6144
s_waitcnt vmcnt(8)
ds_write_b128 v37,v[72:75] offset:7168
s_waitcnt lgkmcnt(0)
s_waitcnt vmcnt(7)
ds_write_b128 v37,v[76:79] offset:8192
s_waitcnt vmcnt(6)
ds_write_b128 v37,v[80:83] offset:9216
s_waitcnt vmcnt(5)
ds_write_b128 v37,v[84:87] offset:10240
s_waitcnt vmcnt(4)
ds_write_b128 v37,v[88:91] offset:11264
s_waitcnt vmcnt(3)
ds_write_b128 v37,v[92:95] offset:12288
s_waitcnt vmcnt(2)
ds_write_b128 v37,v[96:99] offset:13312
s_waitcnt vmcnt(1)
ds_write_b128 v37,v[100:103] offset:14336
s_waitcnt vmcnt(0)
ds_write_b128 v37,v[104:107] offset:15360
s_waitcnt lgkmcnt(0)
global_load_dwordx4 v[44:47],v[38:39],off
v_add_co_u32 v38,vcc,3584,v38
s_nop 1
v_addc_co_u32 v39,vcc,0,v39,vcc
global_load_dwordx4 v[48:51],v[38:39],off
v_add_co_u32 v38,vcc,3584,v38
s_nop 1
v_addc_co_u32 v39,vcc,0,v39,vcc
global_load_dwordx4 v[52:55],v[38:39],off
v_add_co_u32 v38,vcc,3584,v38
s_nop 1
v_addc_co_u32 v39,vcc,0,v39,vcc
global_load_dwordx4 v[56:59],v[38:39],off
v_add_co_u32 v38,vcc,3584,v38
s_nop 1
v_addc_co_u32 v39,vcc,0,v39,vcc
global_load_dwordx4 v[60:63],v[38:39],off
v_add_co_u32 v38,vcc,3584,v38
s_nop 1
v_addc_co_u32 v39,vcc,0,v39,vcc
global_load_dwordx4 v[64:67],v[38:39],off
v_add_co_u32 v38,vcc,3584,v38
s_nop 1
v_addc_co_u32 v39,vcc,0,v39,vcc
global_load_dwordx4 v[68:71],v[38:39],off
v_add_co_u32 v38,vcc,3584,v38
s_nop 1
v_addc_co_u32 v39,vcc,0,v39,vcc
global_load_dwordx4 v[72:75],v[38:39],off
v_add_co_u32 v38,vcc,3584,v38
s_nop 1
v_addc_co_u32 v39,vcc,0,v39,vcc
global_load_dwordx4 v[76:79],v[38:39],off
v_add_co_u32 v38,vcc,3584,v38
s_nop 1
v_addc_co_u32 v39,vcc,0,v39,vcc
global_load_dwordx4 v[80:83],v[38:39],off
v_add_co_u32 v38,vcc,3584,v38
s_nop 1
v_addc_co_u32 v39,vcc,0,v39,vcc
global_load_dwordx4 v[84:87],v[38:39],off
v_add_co_u32 v38,vcc,3584,v38
s_nop 1
v_addc_co_u32 v39,vcc,0,v39,vcc
global_load_dwordx4 v[88:91],v[38:39],off
v_add_co_u32 v38,vcc,3584,v38
s_nop 1
v_addc_co_u32 v39,vcc,0,v39,vcc
global_load_dwordx4 v[92:95],v[38:39],off
v_add_co_u32 v38,vcc,3584,v38
s_nop 1
v_addc_co_u32 v39,vcc,0,v39,vcc
global_load_dwordx4 v[96:99],v[38:39],off
v_add_co_u32 v38,vcc,3584,v38
s_nop 1
v_addc_co_u32 v39,vcc,0,v39,vcc
global_load_dwordx4 v[100:103],v[38:39],off
v_add_co_u32 v38,vcc,3584,v38
s_nop 1
v_addc_co_u32 v39,vcc,0,v39,vcc
global_load_dwordx4 v[104:107],v[38:39],off
v_add_co_u32 v38,vcc,3584,v38
s_nop 1
v_addc_co_u32 v39,vcc,0,v39,vcc
s_waitcnt vmcnt(15)
ds_write_b128 v37,v[44:47] offset:16384
s_waitcnt vmcnt(14)
ds_write_b128 v37,v[48:51] offset:17408
s_waitcnt vmcnt(13)
ds_write_b128 v37,v[52:55] offset:18432
s_waitcnt vmcnt(12)
ds_write_b128 v37,v[56:59] offset:19456
s_waitcnt vmcnt(11)
ds_write_b128 v37,v[60:63] offset:20480
s_waitcnt vmcnt(10)
ds_write_b128 v37,v[64:67] offset:21504
s_waitcnt vmcnt(9)
ds_write_b128 v37,v[68:71] offset:22528
s_waitcnt vmcnt(8)
ds_write_b128 v37,v[72:75] offset:23552
s_waitcnt lgkmcnt(0)
s_waitcnt vmcnt(7)
ds_write_b128 v37,v[76:79] offset:24576
s_waitcnt vmcnt(6)
ds_write_b128 v37,v[80:83] offset:25600
s_waitcnt vmcnt(5)
ds_write_b128 v37,v[84:87] offset:26624
s_waitcnt vmcnt(4)
ds_write_b128 v37,v[88:91] offset:27648
s_waitcnt vmcnt(3)
ds_write_b128 v37,v[92:95] offset:28672
s_waitcnt vmcnt(2)
ds_write_b128 v37,v[96:99] offset:29696
s_waitcnt vmcnt(1)
ds_write_b128 v37,v[100:103] offset:30720
s_waitcnt vmcnt(0)
ds_write_b128 v37,v[104:107] offset:31744
s_waitcnt lgkmcnt(0)
v_mov_b32 v123,159744
s_cmp_lg_u32 s46,0
s_cbranch_scc1 L_gbd_31
v_mov_b32 v124,240
L_gb_30:
buffer_load_dword v125,v124,s[12:15],0 offen sc1
s_waitcnt vmcnt(0)
v_readfirstlane_b32 s56,v125
ds_write_b32 v123,v125
s_bitcmp1_b32 s56,8
s_cbranch_scc1 L_gbd_31
s_sleep 4
s_sub_u32 s49,s49,1
s_cmp_gt_i32 s49,0
s_cbranch_scc1 L_gb_30
s_branch L_abort
L_gbd_31:
s_waitcnt lgkmcnt(0)
s_barrier
ds_read_b32 v125,v123
s_waitcnt lgkmcnt(0)
v_readfirstlane_b32 s56,v125
s_barrier
s_lshr_b32 s56,s56,16
s_andn2_b32 s56,s56,s3
s_cbranch_scc1 L_spread
s_cmp_lg_u32 s3,0
s_cbranch_scc1 L_wm
v_and_b32 v120,15,v1
v_lshrrev_b32 v121,4,v1
v_mov_b32 v17,1
s_lshl_b32 s56,s46,15
v_add_u32 v18,s56,v0
s_lshl_b32 s56,s46,2
v_add_u32 v125,s56,v121
v_xor_b32 v126,v125,v120
v_lshlrev_b32 v126,4,v126
v_lshl_add_u32 v20,v125,10,v126
v_add_u32 v125,0,v121
v_xor_b32 v125,v125,v120
v_lshlrev_b32 v125,4,v125
v_lshl_add_u32 v125,v120,8,v125
v_add_u32 v4,131072,v125
v_add_u32 v125,4,v121
v_xor_b32 v125,v125,v120
v_lshlrev_b32 v125,4,v125
v_lshl_add_u32 v125,v120,8,v125
v_add_u32 v5,131072,v125
v_add_u32 v125,8,v121
v_xor_b32 v125,v125,v120
v_lshlrev_b32 v125,4,v125
v_lshl_add_u32 v125,v120,8,v125
v_add_u32 v6,131072,v125
v_add_u32 v125,12,v121
v_xor_b32 v125,v125,v120
v_lshlrev_b32 v125,4,v125
v_lshl_add_u32 v125,v120,8,v125
v_add_u32 v7,131072,v125
v_lshlrev_b32 v21,5,v120
v_and_b32 v125,1,v121
v_lshl_add_u32 v21,v125,4,v21
s_lshl_b32 s56,s46,9
v_lshrrev_b32 v125,1,v121
v_lshl_add_u32 v21,v125,11,v21
s_add_u32 s56,s56,155648
v_add_u32 v21,s56,v21
v_lshlrev_b32 v22,4,v120
v_lshl_add_u32 v22,v121,10,v22
s_lshl_b32 s56,s46,8
v_add_u32 v22,s56,v22
s_mov_b32 s54,0
s_mov_b32 s31,0
s_mov_b32 s53,6
s_mov_b32 s72,0x80000000
s_mov_b32 s73,0
s_mov_b32 s77,-1
s_mov_b32 s86,0
s_mov_b32 s19,0
s_mov_b32 s74,2948595712
s_mov_b32 s75,2863311530
v_and_b32 v23,15,v1
v_lshlrev_b32 v23,3,v23
v_lshrrev_b32 v16,4,v1
v_lshl_add_u32 v23,v16,13,v23
v_mov_b32 v19,159744
v_lshl_add_u32 v16,v16,2,v19
v_and_b32 v9,15,v1
v_lshrrev_b32 v10,4,v1
v_and_b32 v124,1,v1
v_lshlrev_b32 v124,4,v124
v_mov_b32 v125,0xffff
v_lshlrev_b32 v125,v124,v125
v_lshrrev_b32 v124,2,v9
v_cmp_eq_u32 vcc,0,v124
s_nop 1
v_cndmask_b32 v12,0,v125,vcc
v_cmp_eq_u32 vcc,1,v124
s_nop 1
v_cndmask_b32 v13,0,v125,vcc
v_and_b32 v124,2,v1
v_cmp_eq_u32 vcc,0,v124
v_mov_b32 v14,0xeeee
v_mov_b32 v124,0x4444
v_cndmask_b32 v14,v14,v124,vcc
v_lshlrev_b32 v11,14,v10
v_lshl_add_u32 v11,v9,4,v11
s_lshl_b32 s65,s51,15
s_add_u32 s65,s65,92274688
s_lshl_b32 s62,s47,10
s_add_u32 s62,s62,s65
s_lshl_b32 s63,s47,16
s_lshl_b32 s60,s46,8
s_add_u32 s63,s63,s60
s_mov_b32 s4,s38
s_mov_b32 s5,s39
s_mov_b32 s6,1835008
s_mov_b32 s7,0x20000
buffer_load_dwordx4 v[24:27],v11,s[4:7],s63 offen offset:0
buffer_load_dwordx4 v[28:31],v11,s[4:7],s63 offen offset:1024
buffer_load_dwordx4 v[32:35],v11,s[4:7],s63 offen offset:2048
buffer_load_dwordx4 v[36:39],v11,s[4:7],s63 offen offset:3072
s_add_u32 s63,s63,4096
buffer_load_dwordx4 v[40:43],v11,s[4:7],s63 offen offset:0
buffer_load_dwordx4 v[44:47],v11,s[4:7],s63 offen offset:1024
buffer_load_dwordx4 v[48:51],v11,s[4:7],s63 offen offset:2048
buffer_load_dwordx4 v[52:55],v11,s[4:7],s63 offen offset:3072
s_add_u32 s63,s63,4096
buffer_load_dwordx4 v[56:59],v11,s[4:7],s63 offen offset:0
buffer_load_dwordx4 v[60:63],v11,s[4:7],s63 offen offset:1024
buffer_load_dwordx4 v[64:67],v11,s[4:7],s63 offen offset:2048
buffer_load_dwordx4 v[68:71],v11,s[4:7],s63 offen offset:3072
s_add_u32 s63,s63,4096
buffer_load_dwordx4 v[72:75],v11,s[4:7],s63 offen offset:0
buffer_load_dwordx4 v[76:79],v11,s[4:7],s63 offen offset:1024
buffer_load_dwordx4 v[80:83],v11,s[4:7],s63 offen offset:2048
buffer_load_dwordx4 v[84:87],v11,s[4:7],s63 offen offset:3072
s_mov_b32 s4,s32
s_mov_b32 s5,s33
s_mov_b32 s6,1024
s_mov_b32 s7,0x20000
buffer_load_dwordx4 v[88:91],v0,s[4:7],0 offen
s_waitcnt vmcnt(0)
v_lshlrev_b32 v96,16,v88
v_and_b32 v97,0xffff0000,v88
v_lshlrev_b32 v98,16,v89
v_and_b32 v99,0xffff0000,v89
v_lshlrev_b32 v100,16,v90
v_and_b32 v101,0xffff0000,v90
v_lshlrev_b32 v102,16,v91
v_and_b32 v103,0xffff0000,v91
v_mul_f32 v88,v96,v96
v_fma_f32 v88,v97,v97,v88
v_fma_f32 v88,v98,v98,v88
v_fma_f32 v88,v99,v99,v88
v_fma_f32 v88,v100,v100,v88
v_fma_f32 v88,v101,v101,v88
v_fma_f32 v88,v102,v102,v88
v_fma_f32 v88,v103,v103,v88
s_nop 1
v_add_f32_dpp v88,v88,v88 row_ror:8 row_mask:0xf bank_mask:0xf
s_nop 1
v_add_f32_dpp v88,v88,v88 row_ror:4 row_mask:0xf bank_mask:0xf
s_nop 1
v_add_f32_dpp v88,v88,v88 row_ror:2 row_mask:0xf bank_mask:0xf
s_nop 1
v_add_f32_dpp v88,v88,v88 row_ror:1 row_mask:0xf bank_mask:0xf
v_mov_b32 v89,v88
s_nop 1
v_permlane16_swap_b32 v88,v89
v_add_f32 v88,v88,v89
v_mov_b32 v89,v88
s_nop 1
v_permlane32_swap_b32 v88,v89
v_add_f32 v88,v88,v89
v_sqrt_f32 v88,v88
s_nop 0
v_mul_f32 v88,0x40333333,v88
s_nop 0
v_readfirstlane_b32 s25,v88
s_bitset1_b32 s25,31
s_ff1_i32_b64 s30,s[74:75]
s_bitset0_b64 s[74:75],s30
s_min_u32 s30,s30,127
s_lshl_b32 s70,s30,15
s_add_u32 s70,s70,0
s_add_u32 s71,s70,16384
L_mo_36:
s_cmp_lg_u32 s19,0
s_cbranch_scc1 L_mo_37
s_add_u32 m0,s50,131072
s_nop 0
buffer_load_dwordx4 v20,s[8:11],s70 offen offset:0 sc1 lds
s_add_u32 m0,s50,135168
s_nop 0
buffer_load_dwordx4 v20,s[8:11],s71 offen offset:0 sc1 lds
s_add_u32 m0,s50,139008
s_nop 0
buffer_load_dwordx4 v20,s[8:11],s70 offen offset:256 sc1 lds
s_add_u32 m0,s50,143104
s_nop 0
buffer_load_dwordx4 v20,s[8:11],s71 offen offset:256 sc1 lds
s_add_u32 m0,s50,146944
s_nop 0
buffer_load_dwordx4 v20,s[8:11],s70 offen offset:512 sc1 lds
s_add_u32 m0,s50,151040
s_nop 0
buffer_load_dwordx4 v20,s[8:11],s71 offen offset:512 sc1 lds
s_mov_b32 s19,1
s_waitcnt vmcnt(0)
L_mo_37:
s_mov_b32 s51,s30
s_mov_b64 s[68:69],s[70:71]
s_ff1_i32_b64 s30,s[74:75]
s_bitset0_b64 s[74:75],s30
s_min_u32 s30,s30,127
s_lshl_b32 s70,s30,15
s_add_u32 s70,s70,0
s_add_u32 s71,s70,16384
s_lshl_b32 s76,s31,13
s_add_u32 s76,s76,10487040
s_lshl_b32 s58,s51,5
s_add_u32 s58,s58,s47
s_mul_i32 s58,s58,24576
s_add_u32 s58,s58,100663296
s_add_u32 s61,s58,s50
s_add_u32 s62,s61,4096
s_add_u32 s63,s61,16384
s_add_u32 s64,s61,20480
s_add_u32 s65,s61,s50
s_add_u32 s65,s65,8192
s_waitcnt vmcnt(12)
s_barrier
ds_read_b128 v[72:75],v4 offset:0
ds_read_b128 v[76:79],v4 offset:4096
ds_read_b128 v[80:83],v5 offset:0
ds_read_b128 v[84:87],v5 offset:4096
s_add_u32 m0,s50,154880
s_nop 0
buffer_load_dwordx4 v20,s[8:11],s68 offen offset:768 sc1 lds
s_add_u32 m0,s50,158976
s_nop 0
buffer_load_dwordx4 v20,s[8:11],s69 offen offset:768 sc1 lds
s_waitcnt lgkmcnt(2)
v_mfma_f32_16x16x32_bf16 v[40:43],a[128:131],v[72:75],0
ds_read_b128 v[108:111],v6 offset:0
v_mfma_f32_16x16x32_bf16 v[56:59],v[72:75],v[128:131],0
v_mfma_f32_16x16x32_bf16 v[24:27],a[0:3],v[72:75],0
ds_read_b128 v[112:115],v6 offset:4096
v_mfma_f32_16x16x32_bf16 v[44:47],a[128:131],v[76:79],0
v_mfma_f32_16x16x32_bf16 v[60:63],v[76:79],v[128:131],0
v_mfma_f32_16x16x32_bf16 v[28:31],a[0:3],v[76:79],0
v_mfma_f32_16x16x32_bf16 v[48:51],a[136:139],v[72:75],0
v_mfma_f32_16x16x32_bf16 v[64:67],v[72:75],v[136:139],0
v_mfma_f32_16x16x32_bf16 v[32:35],a[8:11],v[72:75],0
v_mfma_f32_16x16x32_bf16 v[52:55],a[136:139],v[76:79],0
v_mfma_f32_16x16x32_bf16 v[68:71],v[76:79],v[136:139],0
v_mfma_f32_16x16x32_bf16 v[36:39],a[8:11],v[76:79],0
s_waitcnt lgkmcnt(2)
v_mfma_f32_16x16x32_bf16 v[40:43],a[132:135],v[80:83],v[40:43]
ds_read_b128 v[72:75],v7 offset:0
v_mfma_f32_16x16x32_bf16 v[56:59],v[80:83],v[132:135],v[56:59]
v_mfma_f32_16x16x32_bf16 v[24:27],a[4:7],v[80:83],v[24:27]
ds_read_b128 v[76:79],v7 offset:4096
v_mfma_f32_16x16x32_bf16 v[44:47],a[132:135],v[84:87],v[44:47]
v_mfma_f32_16x16x32_bf16 v[60:63],v[84:87],v[132:135],v[60:63]
v_mfma_f32_16x16x32_bf16 v[28:31],a[4:7],v[84:87],v[28:31]
v_mfma_f32_16x16x32_bf16 v[48:51],a[140:143],v[80:83],v[48:51]
v_mfma_f32_16x16x32_bf16 v[64:67],v[80:83],v[140:143],v[64:67]
v_mfma_f32_16x16x32_bf16 v[32:35],a[12:15],v[80:83],v[32:35]
v_mfma_f32_16x16x32_bf16 v[52:55],a[140:143],v[84:87],v[52:55]
v_mfma_f32_16x16x32_bf16 v[68:71],v[84:87],v[140:143],v[68:71]
v_mfma_f32_16x16x32_bf16 v[36:39],a[12:15],v[84:87],v[36:39]
s_waitcnt vmcnt(12)
s_barrier
s_waitcnt lgkmcnt(2)
v_mfma_f32_16x16x32_bf16 v[40:43],a[144:147],v[108:111],v[40:43]
ds_read_b128 v[80:83],v4 offset:8192
v_mfma_f32_16x16x32_bf16 v[56:59],v[108:111],v[144:147],v[56:59]
v_mfma_f32_16x16x32_bf16 v[24:27],a[16:19],v[108:111],v[24:27]
ds_read_b128 v[84:87],v4 offset:12288
v_mfma_f32_16x16x32_bf16 v[44:47],a[144:147],v[112:115],v[44:47]
v_mfma_f32_16x16x32_bf16 v[60:63],v[112:115],v[144:147],v[60:63]
v_mfma_f32_16x16x32_bf16 v[28:31],a[16:19],v[112:115],v[28:31]
v_mfma_f32_16x16x32_bf16 v[48:51],a[152:155],v[108:111],v[48:51]
v_mfma_f32_16x16x32_bf16 v[64:67],v[108:111],v[152:155],v[64:67]
v_mfma_f32_16x16x32_bf16 v[32:35],a[24:27],v[108:111],v[32:35]
v_mfma_f32_16x16x32_bf16 v[52:55],a[152:155],v[112:115],v[52:55]
v_mfma_f32_16x16x32_bf16 v[68:71],v[112:115],v[152:155],v[68:71]
v_mfma_f32_16x16x32_bf16 v[36:39],a[24:27],v[112:115],v[36:39]
s_waitcnt lgkmcnt(2)
v_mfma_f32_16x16x32_bf16 v[40:43],a[148:151],v[72:75],v[40:43]
ds_read_b128 v[108:111],v5 offset:8192
v_mfma_f32_16x16x32_bf16 v[56:59],v[72:75],v[148:151],v[56:59]
v_mfma_f32_16x16x32_bf16 v[24:27],a[20:23],v[72:75],v[24:27]
ds_read_b128 v[112:115],v5 offset:12288
v_mfma_f32_16x16x32_bf16 v[44:47],a[148:151],v[76:79],v[44:47]
v_mfma_f32_16x16x32_bf16 v[60:63],v[76:79],v[148:151],v[60:63]
v_mfma_f32_16x16x32_bf16 v[28:31],a[20:23],v[76:79],v[28:31]
v_mfma_f32_16x16x32_bf16 v[48:51],a[156:159],v[72:75],v[48:51]
v_mfma_f32_16x16x32_bf16 v[64:67],v[72:75],v[156:159],v[64:67]
v_mfma_f32_16x16x32_bf16 v[32:35],a[28:31],v[72:75],v[32:35]
v_mfma_f32_16x16x32_bf16 v[52:55],a[156:159],v[76:79],v[52:55]
v_mfma_f32_16x16x32_bf16 v[68:71],v[76:79],v[156:159],v[68:71]
v_mfma_f32_16x16x32_bf16 v[36:39],a[28:31],v[76:79],v[36:39]
s_waitcnt lgkmcnt(2)
v_mfma_f32_16x16x32_bf16 v[40:43],a[160:163],v[80:83],v[40:43]
ds_read_b128 v[72:75],v6 offset:8192
v_mfma_f32_16x16x32_bf16 v[56:59],v[80:83],v[160:163],v[56:59]
v_mfma_f32_16x16x32_bf16 v[24:27],a[32:35],v[80:83],v[24:27]
ds_read_b128 v[76:79],v6 offset:12288
v_mfma_f32_16x16x32_bf16 v[44:47],a[160:163],v[84:87],v[44:47]
v_mfma_f32_16x16x32_bf16 v[60:63],v[84:87],v[160:163],v[60:63]
v_mfma_f32_16x16x32_bf16 v[28:31],a[32:35],v[84:87],v[28:31]
v_mfma_f32_16x16x32_bf16 v[48:51],a[168:171],v[80:83],v[48:51]
v_mfma_f32_16x16x32_bf16 v[64:67],v[80:83],v[168:171],v[64:67]
v_mfma_f32_16x16x32_bf16 v[32:35],a[40:43],v[80:83],v[32:35]
v_mfma_f32_16x16x32_bf16 v[52:55],a[168:171],v[84:87],v[52:55]
v_mfma_f32_16x16x32_bf16 v[68:71],v[84:87],v[168:171],v[68:71]
v_mfma_f32_16x16x32_bf16 v[36:39],a[40:43],v[84:87],v[36:39]
s_waitcnt lgkmcnt(2)
v_mfma_f32_16x16x32_bf16 v[40:43],a[164:167],v[108:111],v[40:43]
ds_read_b128 v[80:83],v7 offset:8192
v_mfma_f32_16x16x32_bf16 v[56:59],v[108:111],v[164:167],v[56:59]
v_mfma_f32_16x16x32_bf16 v[24:27],a[36:39],v[108:111],v[24:27]
ds_read_b128 v[84:87],v7 offset:12288
v_mfma_f32_16x16x32_bf16 v[44:47],a[164:167],v[112:115],v[44:47]
v_mfma_f32_16x16x32_bf16 v[60:63],v[112:115],v[164:167],v[60:63]
v_mfma_f32_16x16x32_bf16 v[28:31],a[36:39],v[112:115],v[28:31]
v_mfma_f32_16x16x32_bf16 v[48:51],a[172:175],v[108:111],v[48:51]
v_mfma_f32_16x16x32_bf16 v[64:67],v[108:111],v[172:175],v[64:67]
v_mfma_f32_16x16x32_bf16 v[32:35],a[44:47],v[108:111],v[32:35]
v_mfma_f32_16x16x32_bf16 v[52:55],a[172:175],v[112:115],v[52:55]
v_mfma_f32_16x16x32_bf16 v[68:71],v[112:115],v[172:175],v[68:71]
v_mfma_f32_16x16x32_bf16 v[36:39],a[44:47],v[112:115],v[36:39]
s_waitcnt vmcnt(10)
s_barrier
s_waitcnt lgkmcnt(2)
v_mfma_f32_16x16x32_bf16 v[40:43],a[176:179],v[72:75],v[40:43]
ds_read_b128 v[108:111],v4 offset:16384
v_mfma_f32_16x16x32_bf16 v[56:59],v[72:75],v[176:179],v[56:59]
v_mfma_f32_16x16x32_bf16 v[24:27],a[48:51],v[72:75],v[24:27]
ds_read_b128 v[112:115],v4 offset:20480
v_mfma_f32_16x16x32_bf16 v[44:47],a[176:179],v[76:79],v[44:47]
v_mfma_f32_16x16x32_bf16 v[60:63],v[76:79],v[176:179],v[60:63]
v_mfma_f32_16x16x32_bf16 v[28:31],a[48:51],v[76:79],v[28:31]
v_mfma_f32_16x16x32_bf16 v[48:51],a[184:187],v[72:75],v[48:51]
v_mfma_f32_16x16x32_bf16 v[64:67],v[72:75],v[184:187],v[64:67]
v_mfma_f32_16x16x32_bf16 v[32:35],a[56:59],v[72:75],v[32:35]
v_mfma_f32_16x16x32_bf16 v[52:55],a[184:187],v[76:79],v[52:55]
v_mfma_f32_16x16x32_bf16 v[68:71],v[76:79],v[184:187],v[68:71]
v_mfma_f32_16x16x32_bf16 v[36:39],a[56:59],v[76:79],v[36:39]
s_waitcnt vmcnt(2)
s_barrier
s_or_b32 s72,s72,s52
buffer_store_dword v17,off,s[8:11],s72 sc1
s_waitcnt lgkmcnt(2)
v_mfma_f32_16x16x32_bf16 v[40:43],a[180:183],v[80:83],v[40:43]
ds_read_b128 v[72:75],v5 offset:16384
v_mfma_f32_16x16x32_bf16 v[56:59],v[80:83],v[180:183],v[56:59]
v_mfma_f32_16x16x32_bf16 v[24:27],a[52:55],v[80:83],v[24:27]
ds_read_b128 v[76:79],v5 offset:20480
v_mfma_f32_16x16x32_bf16 v[44:47],a[180:183],v[84:87],v[44:47]
v_mfma_f32_16x16x32_bf16 v[60:63],v[84:87],v[180:183],v[60:63]
v_mfma_f32_16x16x32_bf16 v[28:31],a[52:55],v[84:87],v[28:31]
v_mfma_f32_16x16x32_bf16 v[48:51],a[188:191],v[80:83],v[48:51]
v_mfma_f32_16x16x32_bf16 v[64:67],v[80:83],v[188:191],v[64:67]
v_mfma_f32_16x16x32_bf16 v[32:35],a[60:63],v[80:83],v[32:35]
v_mfma_f32_16x16x32_bf16 v[52:55],a[188:191],v[84:87],v[52:55]
v_mfma_f32_16x16x32_bf16 v[68:71],v[84:87],v[188:191],v[68:71]
v_mfma_f32_16x16x32_bf16 v[36:39],a[60:63],v[84:87],v[36:39]
s_waitcnt lgkmcnt(2)
v_mfma_f32_16x16x32_bf16 v[40:43],a[192:195],v[108:111],v[40:43]
ds_read_b128 v[80:83],v6 offset:16384
v_mfma_f32_16x16x32_bf16 v[56:59],v[108:111],v[192:195],v[56:59]
v_mfma_f32_16x16x32_bf16 v[24:27],a[64:67],v[108:111],v[24:27]
ds_read_b128 v[84:87],v6 offset:20480
v_mfma_f32_16x16x32_bf16 v[44:47],a[192:195],v[112:115],v[44:47]
v_mfma_f32_16x16x32_bf16 v[60:63],v[112:115],v[192:195],v[60:63]
v_mfma_f32_16x16x32_bf16 v[28:31],a[64:67],v[112:115],v[28:31]
v_mfma_f32_16x16x32_bf16 v[48:51],a[200:203],v[108:111],v[48:51]
v_mfma_f32_16x16x32_bf16 v[64:67],v[108:111],v[200:203],v[64:67]
v_mfma_f32_16x16x32_bf16 v[32:35],a[72:75],v[108:111],v[32:35]
v_mfma_f32_16x16x32_bf16 v[52:55],a[200:203],v[112:115],v[52:55]
v_mfma_f32_16x16x32_bf16 v[68:71],v[112:115],v[200:203],v[68:71]
v_mfma_f32_16x16x32_bf16 v[36:39],a[72:75],v[112:115],v[36:39]
s_waitcnt lgkmcnt(2)
v_mfma_f32_16x16x32_bf16 v[40:43],a[196:199],v[72:75],v[40:43]
ds_read_b128 v[108:111],v7 offset:16384
v_mfma_f32_16x16x32_bf16 v[56:59],v[72:75],v[196:199],v[56:59]
v_mfma_f32_16x16x32_bf16 v[24:27],a[68:71],v[72:75],v[24:27]
ds_read_b128 v[112:115],v7 offset:20480
v_mfma_f32_16x16x32_bf16 v[44:47],a[196:199],v[76:79],v[44:47]
v_mfma_f32_16x16x32_bf16 v[60:63],v[76:79],v[196:199],v[60:63]
v_mfma_f32_16x16x32_bf16 v[28:31],a[68:71],v[76:79],v[28:31]
v_mfma_f32_16x16x32_bf16 v[48:51],a[204:207],v[72:75],v[48:51]
v_mfma_f32_16x16x32_bf16 v[64:67],v[72:75],v[204:207],v[64:67]
v_mfma_f32_16x16x32_bf16 v[32:35],a[76:79],v[72:75],v[32:35]
v_mfma_f32_16x16x32_bf16 v[52:55],a[204:207],v[76:79],v[52:55]
v_mfma_f32_16x16x32_bf16 v[68:71],v[76:79],v[204:207],v[68:71]
v_mfma_f32_16x16x32_bf16 v[36:39],a[76:79],v[76:79],v[36:39]
s_waitcnt vmcnt(1)
s_barrier
s_waitcnt lgkmcnt(2)
v_mfma_f32_16x16x32_bf16 v[40:43],a[208:211],v[80:83],v[40:43]
ds_read_b128 v[72:75],v4 offset:24576
v_mfma_f32_16x16x32_bf16 v[56:59],v[80:83],v[208:211],v[56:59]
v_mfma_f32_16x16x32_bf16 v[24:27],a[80:83],v[80:83],v[24:27]
ds_read_b128 v[76:79],v4 offset:28672
v_mfma_f32_16x16x32_bf16 v[44:47],a[208:211],v[84:87],v[44:47]
v_mfma_f32_16x16x32_bf16 v[60:63],v[84:87],v[208:211],v[60:63]
v_mfma_f32_16x16x32_bf16 v[28:31],a[80:83],v[84:87],v[28:31]
v_mfma_f32_16x16x32_bf16 v[48:51],a[216:219],v[80:83],v[48:51]
v_mfma_f32_16x16x32_bf16 v[64:67],v[80:83],v[216:219],v[64:67]
v_mfma_f32_16x16x32_bf16 v[32:35],a[88:91],v[80:83],v[32:35]
v_mfma_f32_16x16x32_bf16 v[52:55],a[216:219],v[84:87],v[52:55]
v_mfma_f32_16x16x32_bf16 v[68:71],v[84:87],v[216:219],v[68:71]
v_mfma_f32_16x16x32_bf16 v[36:39],a[88:91],v[84:87],v[36:39]
s_waitcnt lgkmcnt(2)
v_mfma_f32_16x16x32_bf16 v[40:43],a[212:215],v[108:111],v[40:43]
ds_read_b128 v[80:83],v5 offset:24576
v_mfma_f32_16x16x32_bf16 v[56:59],v[108:111],v[212:215],v[56:59]
v_mfma_f32_16x16x32_bf16 v[24:27],a[84:87],v[108:111],v[24:27]
ds_read_b128 v[84:87],v5 offset:28672
v_mfma_f32_16x16x32_bf16 v[44:47],a[212:215],v[112:115],v[44:47]
v_mfma_f32_16x16x32_bf16 v[60:63],v[112:115],v[212:215],v[60:63]
v_mfma_f32_16x16x32_bf16 v[28:31],a[84:87],v[112:115],v[28:31]
v_mfma_f32_16x16x32_bf16 v[48:51],a[220:223],v[108:111],v[48:51]
v_mfma_f32_16x16x32_bf16 v[64:67],v[108:111],v[220:223],v[64:67]
v_mfma_f32_16x16x32_bf16 v[32:35],a[92:95],v[108:111],v[32:35]
v_mfma_f32_16x16x32_bf16 v[52:55],a[220:223],v[112:115],v[52:55]
v_mfma_f32_16x16x32_bf16 v[68:71],v[112:115],v[220:223],v[68:71]
v_mfma_f32_16x16x32_bf16 v[36:39],a[92:95],v[112:115],v[36:39]
s_barrier
s_waitcnt lgkmcnt(2)
v_mfma_f32_16x16x32_bf16 v[40:43],a[224:227],v[72:75],v[40:43]
ds_read_b128 v[108:111],v6 offset:24576
v_mfma_f32_16x16x32_bf16 v[56:59],v[72:75],v[224:227],v[56:59]
s_add_u32 m0,s50,131072
v_mfma_f32_16x16x32_bf16 v[24:27],a[96:99],v[72:75],v[24:27]
ds_read_b128 v[112:115],v6 offset:28672
v_mfma_f32_16x16x32_bf16 v[44:47],a[224:227],v[76:79],v[44:47]
buffer_load_dwordx4 v20,s[8:11],s70 offen offset:0 sc1 lds
v_mfma_f32_16x16x32_bf16 v[60:63],v[76:79],v[224:227],v[60:63]
s_add_u32 m0,s50,135168
v_mfma_f32_16x16x32_bf16 v[28:31],a[96:99],v[76:79],v[28:31]
buffer_load_dwordx4 v20,s[8:11],s71 offen offset:0 sc1 lds
v_mfma_f32_16x16x32_bf16 v[48:51],a[232:235],v[72:75],v[48:51]
s_add_u32 m0,s50,139008
v_mfma_f32_16x16x32_bf16 v[64:67],v[72:75],v[232:235],v[64:67]
buffer_load_dwordx4 v20,s[8:11],s70 offen offset:256 sc1 lds
v_mfma_f32_16x16x32_bf16 v[32:35],a[104:107],v[72:75],v[32:35]
s_add_u32 m0,s50,143104
v_mfma_f32_16x16x32_bf16 v[52:55],a[232:235],v[76:79],v[52:55]
buffer_load_dwordx4 v20,s[8:11],s71 offen offset:256 sc1 lds
v_mfma_f32_16x16x32_bf16 v[68:71],v[76:79],v[232:235],v[68:71]
s_add_u32 m0,s50,146944
v_mfma_f32_16x16x32_bf16 v[36:39],a[104:107],v[76:79],v[36:39]
buffer_load_dwordx4 v20,s[8:11],s70 offen offset:512 sc1 lds
s_waitcnt lgkmcnt(2)
v_mfma_f32_16x16x32_bf16 v[40:43],a[228:231],v[80:83],v[40:43]
ds_read_b128 v[72:75],v7 offset:24576
v_mfma_f32_16x16x32_bf16 v[56:59],v[80:83],v[228:231],v[56:59]
s_add_u32 m0,s50,151040
v_mfma_f32_16x16x32_bf16 v[24:27],a[100:103],v[80:83],v[24:27]
ds_read_b128 v[76:79],v7 offset:28672
v_mfma_f32_16x16x32_bf16 v[44:47],a[228:231],v[84:87],v[44:47]
buffer_load_dwordx4 v20,s[8:11],s71 offen offset:512 sc1 lds
v_mfma_f32_16x16x32_bf16 v[60:63],v[84:87],v[228:231],v[60:63]
buffer_load_dwordx2 v[124:125],v23,s[8:11],s76 offen sc1
v_mfma_f32_16x16x32_bf16 v[28:31],a[100:103],v[84:87],v[28:31]
v_mfma_f32_16x16x32_bf16 v[48:51],a[236:239],v[80:83],v[48:51]
v_mfma_f32_16x16x32_bf16 v[64:67],v[80:83],v[236:239],v[64:67]
v_mfma_f32_16x16x32_bf16 v[32:35],a[108:111],v[80:83],v[32:35]
v_mfma_f32_16x16x32_bf16 v[52:55],a[236:239],v[84:87],v[52:55]
v_mfma_f32_16x16x32_bf16 v[68:71],v[84:87],v[236:239],v[68:71]
v_mfma_f32_16x16x32_bf16 v[36:39],a[108:111],v[84:87],v[36:39]
s_waitcnt lgkmcnt(2)
v_mfma_f32_16x16x32_bf16 v[40:43],a[240:243],v[108:111],v[40:43]
v_mfma_f32_16x16x32_bf16 v[56:59],v[108:111],v[240:243],v[56:59]
v_mfma_f32_16x16x32_bf16 v[24:27],a[112:115],v[108:111],v[24:27]
v_mfma_f32_16x16x32_bf16 v[44:47],a[240:243],v[112:115],v[44:47]
v_mfma_f32_16x16x32_bf16 v[60:63],v[112:115],v[240:243],v[60:63]
v_mfma_f32_16x16x32_bf16 v[28:31],a[112:115],v[112:115],v[28:31]
v_mfma_f32_16x16x32_bf16 v[48:51],a[248:251],v[108:111],v[48:51]
v_mfma_f32_16x16x32_bf16 v[64:67],v[108:111],v[248:251],v[64:67]
v_mfma_f32_16x16x32_bf16 v[32:35],a[120:123],v[108:111],v[32:35]
v_mfma_f32_16x16x32_bf16 v[52:55],a[248:251],v[112:115],v[52:55]
v_mfma_f32_16x16x32_bf16 v[68:71],v[112:115],v[248:251],v[68:71]
v_mfma_f32_16x16x32_bf16 v[36:39],a[120:123],v[112:115],v[36:39]
s_waitcnt lgkmcnt(0)
v_mfma_f32_16x16x32_bf16 v[40:43],a[244:247],v[72:75],v[40:43]
v_mfma_f32_16x16x32_bf16 v[56:59],v[72:75],v[244:247],v[56:59]
v_mfma_f32_16x16x32_bf16 v[24:27],a[116:119],v[72:75],v[24:27]
v_mfma_f32_16x16x32_bf16 v[44:47],a[244:247],v[76:79],v[44:47]
v_mfma_f32_16x16x32_bf16 v[60:63],v[76:79],v[244:247],v[60:63]
v_mfma_f32_16x16x32_bf16 v[28:31],a[116:119],v[76:79],v[28:31]
v_mfma_f32_16x16x32_bf16 v[48:51],a[252:255],v[72:75],v[48:51]
v_mfma_f32_16x16x32_bf16 v[64:67],v[72:75],v[252:255],v[64:67]
v_mfma_f32_16x16x32_bf16 v[32:35],a[124:127],v[72:75],v[32:35]
v_mfma_f32_16x16x32_bf16 v[52:55],a[252:255],v[76:79],v[52:55]
v_mfma_f32_16x16x32_bf16 v[68:71],v[76:79],v[252:255],v[68:71]
v_mfma_f32_16x16x32_bf16 v[36:39],a[124:127],v[76:79],v[36:39]
s_lshl_b32 s56,s51,5
s_add_u32 s56,s56,s47
s_lshl_b32 s56,s56,12
s_add_u32 s56,s56,s50
s_add_u32 s56,s56,41943040
v_mov_b64 v[120:121],-1
v_mov_b64 v[122:123],-1
buffer_store_dwordx4 v[120:123],v0,s[8:11],s56 offen sc1
v_cvt_pk_bf16_f32 v72,v40,v48
v_cvt_pk_bf16_f32 v73,v41,v49
v_cvt_pk_bf16_f32 v74,v42,v50
v_cvt_pk_bf16_f32 v75,v43,v51
buffer_store_dwordx4 v[72:75],v0,s[8:11],s61 offen sc1
v_cvt_pk_bf16_f32 v76,v44,v52
v_cvt_pk_bf16_f32 v77,v45,v53
v_cvt_pk_bf16_f32 v78,v46,v54
v_cvt_pk_bf16_f32 v79,v47,v55
buffer_store_dwordx4 v[76:79],v0,s[8:11],s62 offen sc1
v_cvt_pk_bf16_f32 v80,v56,v57
v_cvt_pk_bf16_f32 v81,v58,v59
v_cvt_pk_bf16_f32 v82,v60,v61
v_cvt_pk_bf16_f32 v83,v62,v63
buffer_store_dwordx4 v[80:83],v0,s[8:11],s65 offen offset:0 sc1
v_cvt_pk_bf16_f32 v84,v64,v65
v_cvt_pk_bf16_f32 v85,v66,v67
v_cvt_pk_bf16_f32 v86,v68,v69
v_cvt_pk_bf16_f32 v87,v70,v71
buffer_store_dwordx4 v[84:87],v0,s[8:11],s65 offen offset:1024 sc1
v_cvt_pk_bf16_f32 v108,v24,v32
v_cvt_pk_bf16_f32 v109,v25,v33
v_cvt_pk_bf16_f32 v110,v26,v34
v_cvt_pk_bf16_f32 v111,v27,v35
buffer_store_dwordx4 v[108:111],v0,s[8:11],s63 offen sc1
v_cvt_pk_bf16_f32 v112,v28,v36
v_cvt_pk_bf16_f32 v113,v29,v37
v_cvt_pk_bf16_f32 v114,v30,v38
v_cvt_pk_bf16_f32 v115,v31,v39
buffer_store_dwordx4 v[112:115],v0,s[8:11],s64 offen sc1
s_lshl_b32 s72,s51,13
s_lshl2_add_u32 s72,s47,s72
s_add_u32 s72,s72,10485760
s_sub_u32 s53,s53,1
s_cmp_gt_i32 s53,3
s_cbranch_scc1 L_mo_37
s_cmp_gt_i32 s53,0
s_cselect_b32 s87,1,3
s_mov_b32 s18,0
s_waitcnt vmcnt(7)
s_branch L_mo_42
L_mo_35:
s_mov_b32 s55,s22
s_mov_b32 s22,s23
s_mov_b32 s23,s24
s_mov_b32 s24,-1
v_mov_b32 v3,0
s_cmp_lg_u32 s55,-1
s_cbranch_scc1 L_mp_32
s_sub_u32 s56,s30,s31
s_cmp_gt_i32 s77,0
s_cselect_b32 s57,6,20
s_cmp_lg_u32 s86,0
s_cselect_b32 s57,9,s57
s_cmp_lt_i32 s56,s57
s_cbranch_scc1 L_mo_36
s_cmp_lt_i32 s56,30
s_cselect_b32 s87,s18,0
s_cmp_ge_u32 s31,8
s_cselect_b32 s56,1,s18
s_and_b32 s56,s56,s86
s_cselect_b32 s87,2,s87
s_mul_i32 s56,s87,s18
s_cmp_lg_u32 s56,0
s_cbranch_scc1 L_mo_40
s_mov_b32 s18,0
s_lshr_b32 s56,s72,31
s_or_b32 s56,s56,s87
s_cbranch_scc1 L_mo_46
s_waitcnt vmcnt(0)
s_barrier
s_or_b32 s72,s72,s52
buffer_store_dword v17,off,s[8:11],s72 sc1
s_mov_b32 s72,0x80000000
L_mo_46:
s_cmp_lg_u32 s46,0
s_cbranch_scc1 L_mo_44
s_lshl_b32 s76,s31,13
s_add_u32 s76,s76,10487040
s_lshl_b32 s57,s47,8
s_add_u32 s57,s57,s31
s_cmp_eq_u32 s57,63
s_mov_b32 s57,0x80000000
s_cmov_b32 s57,11018240
v_lshlrev_b32 v2,2,v1
L_mo_43:
buffer_load_dwordx2 v[124:125],v23,s[8:11],s76 offen sc1
buffer_load_dword v3,v2,s[8:11],s57 offen sc1
s_sub_u32 s49,s49,1
s_cbranch_scc1 L_abort
s_waitcnt vmcnt(0)
L_mo_42:
v_min_u32 v123,v124,v125
v_max_u32 v125,v124,v125
v_cmp_eq_u32 vcc,0,v123
s_nop 1
v_cndmask_b32 v125,v125,-1,vcc
s_and_b32 s56,vcc_lo,0xffff
s_cbranch_scc0 L_mo_47
s_cmp_lg_u32 s87,0
s_cbranch_scc1 L_mo_47
s_mov_b32 s18,1
s_sleep 2
s_branch L_mo_43
L_mo_47:
v_max_u32_dpp v125,v125,v125 row_ror:8 row_mask:0xf bank_mask:0xf
s_nop 1
v_max_u32_dpp v125,v125,v125 row_ror:4 row_mask:0xf bank_mask:0xf
s_nop 1
v_max_u32_dpp v125,v125,v125 row_ror:2 row_mask:0xf bank_mask:0xf
s_nop 1
v_max_u32_dpp v125,v125,v125 row_ror:1 row_mask:0xf bank_mask:0xf
L_mo_44:
s_sub_u32 s49,s49,1
s_cbranch_scc1 L_abort
v_mov_b32 v124,s18
s_barrier
s_cmp_lg_u32 s46,0
s_cbranch_scc1 L_mo_45
ds_write_b32 v16,v125
ds_write_b32 v19,v124 offset:16
s_waitcnt lgkmcnt(0)
L_mo_45:
s_barrier
ds_read_b128 v[120:123],v19
ds_read_b32 v124,v19 offset:16
s_waitcnt lgkmcnt(0)
v_readfirstlane_b32 s55,v120
v_readfirstlane_b32 s22,v121
v_readfirstlane_b32 s23,v122
v_readfirstlane_b32 s24,v123
v_readfirstlane_b32 s18,v124
s_cmp_lg_u32 s55,-1
s_cbranch_scc1 L_mp_32
L_mo_40:
s_mov_b32 s22,-1
s_cmp_eq_u32 s87,1
s_cbranch_scc1 L_mo_36
s_cmp_eq_u32 s87,2
s_cbranch_scc1 L_mo_41
s_branch L_mo_35
L_mp_32:
s_mov_b32 s53,0
s_sub_u32 s73,s73,1
s_max_i32 s73,s73,0
s_sub_u32 s77,s77,1
s_min_u32 s61,s73,2
s_cmp_lt_u32 s31,5
s_cselect_b32 s60,s25,0
s_cmp_lt_u32 s55,s60
s_cselect_b32 s61,2,s61
s_cmp_le_u32 s55,s54
s_cbranch_scc1 L_mr_33
s_mov_b32 s77,s61
s_mov_b32 s54,s55
s_mov_b32 s86,0
s_or_b32 s61,s47,s46
s_cbranch_scc1 L_mr_33
v_mov_b32 v120,s54
v_lshlrev_b32 v121,13,v1
s_mov_b32 s61,10486784
buffer_store_dword v120,v121,s[8:11],s61 offen sc1
L_mr_33:
s_cmp_lg_u32 s31,63
s_cbranch_scc1 L_mo_38
s_min_i32 s77,s77,0
s_or_b32 s61,s47,s46
s_cbranch_scc1 L_mo_38
s_mov_b32 s59,11018240
v_lshlrev_b32 v120,2,v1
v_mov_b32 v121,v3
v_cmp_eq_u32 vcc,0,v3
s_cbranch_vccz L_mg_34
L_fp_49:
s_sleep 0
buffer_load_dword v121,v120,s[8:11],s59 offen sc1
s_sub_u32 s49,s49,1
s_cbranch_scc1 L_abort
s_waitcnt vmcnt(0)
v_cmp_eq_u32 vcc,0,v121
s_cbranch_vccnz L_fp_49
L_mg_34:
s_andn2_b32 s62,0x7ff,s54
v_lshl_or_b32 v121,s62,8,v121
s_add_u32 s59,s59,8192
buffer_store_dword v121,v120,s[8:11],s59 offen sc1
s_add_u32 s59,s59,8192
buffer_store_dword v121,v120,s[8:11],s59 offen sc1
s_add_u32 s59,s59,8192
buffer_store_dword v121,v120,s[8:11],s59 offen sc1
s_add_u32 s59,s59,8192
buffer_store_dword v121,v120,s[8:11],s59 offen sc1
s_add_u32 s59,s59,8192
buffer_store_dword v121,v120,s[8:11],s59 offen sc1
s_add_u32 s59,s59,8192
buffer_store_dword v121,v120,s[8:11],s59 offen sc1
L_mo_38:
s_add_u32 s31,s31,1
s_cmp_gt_i32 s77,0
s_cmov_b32 s18,0
s_cbranch_scc1 L_mo_35
s_cmp_lg_u32 s77,0
s_cbranch_scc1 L_mo_39
s_andn2_b32 s51,0x7ff,s54
s_lshr_b32 s51,s51,5
s_add_u32 s73,s73,2
s_mov_b32 s86,1
s_mov_b32 s19,0
s_mov_b32 s18,0
s_waitcnt vmcnt(8)
s_barrier
s_andn2_b32 s64,0x7ff,s54
s_lshl_b32 s56,s64,10
s_add_u32 s58,s56,4194304
buffer_load_dwordx4 v[88:91],v0,s[8:11],s58 offen sc1
v_and_b32 v9,15,v1
v_lshrrev_b32 v10,4,v1
v_and_b32 v124,1,v1
v_lshlrev_b32 v124,4,v124
v_mov_b32 v125,0xffff
v_lshlrev_b32 v125,v124,v125
v_lshrrev_b32 v124,2,v9
v_cmp_eq_u32 vcc,0,v124
s_nop 1
v_cndmask_b32 v12,0,v125,vcc
v_cmp_eq_u32 vcc,1,v124
s_nop 1
v_cndmask_b32 v13,0,v125,vcc
v_and_b32 v124,2,v1
v_cmp_eq_u32 vcc,0,v124
v_mov_b32 v14,0xeeee
v_mov_b32 v124,0x4444
v_cndmask_b32 v14,v14,v124,vcc
v_lshlrev_b32 v11,14,v10
v_lshl_add_u32 v11,v9,4,v11
s_lshl_b32 s65,s51,15
s_add_u32 s65,s65,92274688
s_lshl_b32 s62,s47,10
s_add_u32 s62,s62,s65
s_lshl_b32 s63,s47,16
s_lshl_b32 s60,s46,8
s_add_u32 s63,s63,s60
s_mov_b32 s4,s38
s_mov_b32 s5,s39
s_mov_b32 s6,1835008
s_mov_b32 s7,0x20000
s_lshl_b32 s57,s46,11
s_add_u32 s57,s57,139264
v_add_u32 v8,s57,v0
v_and_b32 v2,1,v10
v_lshrrev_b32 v3,1,v10
v_lshlrev_b32 v2,7,v2
v_lshl_add_u32 v2,v3,10,v2
s_lshl_b32 s59,s46,8
s_add_u32 s59,s57,s59
v_add_u32 v2,s59,v2
s_mov_b32 s60,0x01000100
s_mov_b32 s61,0x03020302
s_waitcnt vmcnt(0)
L_mx_50:
v_max3_u32 v124,v88,v89,v90
v_max_u32 v124,v91,v124
v_cmp_eq_u32 vcc,-1,v124
s_cbranch_vccz L_mxd_51
buffer_load_dwordx4 v[88:91],v0,s[8:11],s58 offen sc1
s_sub_u32 s49,s49,1
s_cbranch_scc1 L_abort
s_waitcnt vmcnt(0)
s_branch L_mx_50
L_mxd_51:
buffer_load_dwordx4 v[24:27],v11,s[4:7],s63 offen offset:0
buffer_load_dwordx4 v[28:31],v11,s[4:7],s63 offen offset:1024
buffer_load_dwordx4 v[32:35],v11,s[4:7],s63 offen offset:2048
buffer_load_dwordx4 v[36:39],v11,s[4:7],s63 offen offset:3072
v_lshlrev_b32 v96,16,v88
v_and_b32 v97,0xffff0000,v88
v_lshlrev_b32 v98,16,v89
v_and_b32 v99,0xffff0000,v89
v_lshlrev_b32 v100,16,v90
v_and_b32 v101,0xffff0000,v90
v_lshlrev_b32 v102,16,v91
v_and_b32 v103,0xffff0000,v91
v_readfirstlane_b32 s78,v96
s_nop 1
v_pk_add_f32 v[108:109],v[96:97],s[78:79] op_sel_hi:[1,0] neg_lo:[0,1] neg_hi:[0,1]
v_pk_add_f32 v[110:111],v[98:99],s[78:79] op_sel_hi:[1,0] neg_lo:[0,1] neg_hi:[0,1]
v_pk_add_f32 v[112:113],v[100:101],s[78:79] op_sel_hi:[1,0] neg_lo:[0,1] neg_hi:[0,1]
v_pk_add_f32 v[114:115],v[102:103],s[78:79] op_sel_hi:[1,0] neg_lo:[0,1] neg_hi:[0,1]
v_pk_add_f32 v[116:117],v[108:109],v[110:111]
v_pk_mul_f32 v[118:119],v[108:109],v[108:109]
v_pk_add_f32 v[120:121],v[112:113],v[114:115]
v_pk_fma_f32 v[118:119],v[110:111],v[110:111],v[118:119]
v_pk_add_f32 v[116:117],v[116:117],v[120:121]
v_pk_fma_f32 v[118:119],v[112:113],v[112:113],v[118:119]
v_add_f32 v116,v116,v117
v_pk_fma_f32 v[118:119],v[114:115],v[114:115],v[118:119]
v_add_f32 v118,v118,v119
s_nop 1
v_permlane32_swap_b32 v116,v118
v_add_f32 v116,v116,v118
s_nop 1
v_add_f32_dpp v116,v116,v116 row_ror:8 row_mask:0xf bank_mask:0xf
s_nop 1
v_add_f32_dpp v116,v116,v116 row_ror:4 row_mask:0xf bank_mask:0xf
s_nop 1
v_add_f32_dpp v116,v116,v116 row_ror:2 row_mask:0xf bank_mask:0xf
s_nop 1
v_add_f32_dpp v116,v116,v116 row_ror:1 row_mask:0xf bank_mask:0xf
v_mov_b32 v118,v116
s_nop 1
v_permlane16_swap_b32 v116,v118
v_add_f32 v116,v116,v118
v_mul_f32 v116,0x3b000000,v116
v_mov_b32 v118,v116
s_nop 1
v_permlane32_swap_b32 v116,v118
v_fma_f32 v118,-v116,v116,v118
v_add_f32 v116,s78,v116
v_max_f32 v118,0,v118
v_cvt_pk_bf16_f32 v118,v116,v118
v_lshlrev_b32 v116,16,v118
v_and_b32 v118,0xffff0000,v118
v_add_f32 v118,0x3727c5ac,v118
v_cvt_pk_bf16_f32 v118,v118,v118
v_and_b32 v118,0xffff0000,v118
v_sqrt_f32 v118,v118
v_pk_add_f32 v[108:109],v[96:97],v[116:117] op_sel_hi:[1,0] neg_lo:[0,1] neg_hi:[0,1]
v_pk_add_f32 v[110:111],v[98:99],v[116:117] op_sel_hi:[1,0] neg_lo:[0,1] neg_hi:[0,1]
v_pk_add_f32 v[112:113],v[100:101],v[116:117] op_sel_hi:[1,0] neg_lo:[0,1] neg_hi:[0,1]
v_pk_add_f32 v[114:115],v[102:103],v[116:117] op_sel_hi:[1,0] neg_lo:[0,1] neg_hi:[0,1]
v_cvt_pk_bf16_f32 v118,v118,v118
v_and_b32 v118,0xffff0000,v118
v_rcp_f32 v118,v118
v_cvt_pk_bf16_f32 v104,v108,v109
v_cvt_pk_bf16_f32 v105,v110,v111
v_cvt_pk_bf16_f32 v106,v112,v113
v_cvt_pk_bf16_f32 v107,v114,v115
v_lshlrev_b32 v108,16,v104
v_and_b32 v109,0xffff0000,v104
v_lshlrev_b32 v110,16,v105
v_and_b32 v111,0xffff0000,v105
v_lshlrev_b32 v112,16,v106
v_and_b32 v113,0xffff0000,v106
v_lshlrev_b32 v114,16,v107
v_and_b32 v115,0xffff0000,v107
v_pk_mul_f32 v[108:109],v[108:109],v[118:119] op_sel_hi:[1,0]
v_pk_mul_f32 v[110:111],v[110:111],v[118:119] op_sel_hi:[1,0]
v_pk_mul_f32 v[112:113],v[112:113],v[118:119] op_sel_hi:[1,0]
v_pk_mul_f32 v[114:115],v[114:115],v[118:119] op_sel_hi:[1,0]
v_cvt_pk_bf16_f32 v104,v108,v109
v_cvt_pk_bf16_f32 v105,v110,v111
v_cvt_pk_bf16_f32 v106,v112,v113
v_cvt_pk_bf16_f32 v107,v114,v115
v_perm_b32 v88,v104,v104,s60
v_perm_b32 v89,v105,v105,s60
v_perm_b32 v90,v106,v106,s60
v_perm_b32 v91,v107,v107,s60
ds_write_b128 v8,v[88:91]
v_perm_b32 v92,v104,v104,s61
v_perm_b32 v93,v105,v105,s61
v_perm_b32 v94,v106,v106,s61
v_perm_b32 v95,v107,v107,s61
ds_write_b128 v8,v[92:95] offset:1024
s_mov_b32 s58,s57
ds_read_b128 v[88:91],v2 offset:0
ds_read_b128 v[92:95],v2 offset:64
ds_read_b128 v[108:111],v18 offset:0
ds_read_b128 v[112:115],v18 offset:1024
ds_read_b128 v[64:67],v18 offset:2048
ds_read_b128 v[68:71],v18 offset:3072
ds_read_b128 v[72:75],v18 offset:4096
ds_read_b128 v[76:79],v18 offset:5120
ds_read_b128 v[80:83],v18 offset:6144
ds_read_b128 v[84:87],v18 offset:7168
v_mov_b64 v[116:117],0
v_mov_b64 v[118:119],0
s_waitcnt lgkmcnt(8)
v_and_b32 v120,v12,v88
v_and_b32 v121,v13,v88
v_and_b32 v122,v12,v92
v_and_b32 v123,v13,v92
s_waitcnt lgkmcnt(6)
s_nop 0
v_smfmac_f32_16x16x64_bf16 v[116:119],v[120:123],v[108:115],v14
ds_read_b128 v[108:111],v18 offset:8192
ds_read_b128 v[112:115],v18 offset:9216
s_add_u32 s63,s63,4096
buffer_load_dwordx4 v[40:43],v11,s[4:7],s63 offen offset:0
v_and_b32 v124,v12,v89
v_and_b32 v125,v13,v89
v_and_b32 v126,v12,v93
v_and_b32 v127,v13,v93
s_waitcnt lgkmcnt(6)
s_nop 0
v_smfmac_f32_16x16x64_bf16 v[116:119],v[124:127],v[64:71],v14
ds_read_b128 v[64:67],v18 offset:10240
ds_read_b128 v[68:71],v18 offset:11264
buffer_load_dwordx4 v[44:47],v11,s[4:7],s63 offen offset:1024
v_and_b32 v120,v12,v90
v_and_b32 v121,v13,v90
v_and_b32 v122,v12,v94
v_and_b32 v123,v13,v94
s_waitcnt lgkmcnt(6)
s_nop 0
v_smfmac_f32_16x16x64_bf16 v[116:119],v[120:123],v[72:79],v14
ds_read_b128 v[72:75],v18 offset:12288
ds_read_b128 v[76:79],v18 offset:13312
buffer_load_dwordx4 v[48:51],v11,s[4:7],s63 offen offset:2048
v_and_b32 v124,v12,v91
v_and_b32 v125,v13,v91
v_and_b32 v126,v12,v95
v_and_b32 v127,v13,v95
ds_read_b128 v[88:91],v2 offset:16
ds_read_b128 v[92:95],v2 offset:80
s_waitcnt lgkmcnt(8)
v_smfmac_f32_16x16x64_bf16 v[116:119],v[124:127],v[80:87],v14
ds_read_b128 v[80:83],v18 offset:14336
ds_read_b128 v[84:87],v18 offset:15360
buffer_load_dwordx4 v[52:55],v11,s[4:7],s63 offen offset:3072
s_waitcnt lgkmcnt(2)
v_and_b32 v120,v12,v88
v_and_b32 v121,v13,v88
v_and_b32 v122,v12,v92
v_and_b32 v123,v13,v92
s_waitcnt lgkmcnt(8)
s_nop 0
v_smfmac_f32_16x16x64_bf16 v[116:119],v[120:123],v[108:115],v14
ds_read_b128 v[108:111],v18 offset:16384
ds_read_b128 v[112:115],v18 offset:17408
s_add_u32 s63,s63,4096
buffer_load_dwordx4 v[56:59],v11,s[4:7],s63 offen offset:0
v_and_b32 v124,v12,v89
v_and_b32 v125,v13,v89
v_and_b32 v126,v12,v93
v_and_b32 v127,v13,v93
s_waitcnt lgkmcnt(8)
s_nop 0
v_smfmac_f32_16x16x64_bf16 v[116:119],v[124:127],v[64:71],v14
ds_read_b128 v[64:67],v18 offset:18432
ds_read_b128 v[68:71],v18 offset:19456
buffer_load_dwordx4 v[60:63],v11,s[4:7],s63 offen offset:1024
v_and_b32 v120,v12,v90
v_and_b32 v121,v13,v90
v_and_b32 v122,v12,v94
v_and_b32 v123,v13,v94
s_waitcnt lgkmcnt(8)
s_nop 0
v_smfmac_f32_16x16x64_bf16 v[116:119],v[120:123],v[72:79],v14
ds_read_b128 v[72:75],v18 offset:20480
ds_read_b128 v[76:79],v18 offset:21504
buffer_load_dword v15,v0,s[8:11],s62 offen
v_and_b32 v124,v12,v91
v_and_b32 v125,v13,v91
v_and_b32 v126,v12,v95
v_and_b32 v127,v13,v95
ds_read_b128 v[88:91],v2 offset:32
ds_read_b128 v[92:95],v2 offset:96
s_waitcnt lgkmcnt(8)
v_smfmac_f32_16x16x64_bf16 v[116:119],v[124:127],v[80:87],v14
ds_read_b128 v[80:83],v18 offset:22528
ds_read_b128 v[84:87],v18 offset:23552
s_waitcnt lgkmcnt(2)
v_and_b32 v120,v12,v88
v_and_b32 v121,v13,v88
v_and_b32 v122,v12,v92
v_and_b32 v123,v13,v92
s_waitcnt lgkmcnt(8)
s_nop 0
v_smfmac_f32_16x16x64_bf16 v[116:119],v[120:123],v[108:115],v14
ds_read_b128 v[108:111],v18 offset:24576
ds_read_b128 v[112:115],v18 offset:25600
v_and_b32 v124,v12,v89
v_and_b32 v125,v13,v89
v_and_b32 v126,v12,v93
v_and_b32 v127,v13,v93
s_waitcnt lgkmcnt(8)
s_nop 0
v_smfmac_f32_16x16x64_bf16 v[116:119],v[124:127],v[64:71],v14
ds_read_b128 v[64:67],v18 offset:26624
ds_read_b128 v[68:71],v18 offset:27648
v_and_b32 v120,v12,v90
v_and_b32 v121,v13,v90
v_and_b32 v122,v12,v94
v_and_b32 v123,v13,v94
s_waitcnt lgkmcnt(8)
s_nop 0
v_smfmac_f32_16x16x64_bf16 v[116:119],v[120:123],v[72:79],v14
ds_read_b128 v[72:75],v18 offset:28672
ds_read_b128 v[76:79],v18 offset:29696
v_and_b32 v124,v12,v91
v_and_b32 v125,v13,v91
v_and_b32 v126,v12,v95
v_and_b32 v127,v13,v95
ds_read_b128 v[88:91],v2 offset:48
ds_read_b128 v[92:95],v2 offset:112
s_waitcnt lgkmcnt(8)
v_smfmac_f32_16x16x64_bf16 v[116:119],v[124:127],v[80:87],v14
ds_read_b128 v[80:83],v18 offset:30720
ds_read_b128 v[84:87],v18 offset:31744
s_waitcnt lgkmcnt(2)
v_and_b32 v120,v12,v88
v_and_b32 v121,v13,v88
v_and_b32 v122,v12,v92
v_and_b32 v123,v13,v92
s_waitcnt lgkmcnt(8)
s_nop 0
v_smfmac_f32_16x16x64_bf16 v[116:119],v[120:123],v[108:115],v14
v_and_b32 v124,v12,v89
v_and_b32 v125,v13,v89
v_and_b32 v126,v12,v93
v_and_b32 v127,v13,v93
s_waitcnt lgkmcnt(6)
s_nop 0
v_smfmac_f32_16x16x64_bf16 v[116:119],v[124:127],v[64:71],v14
buffer_load_dwordx4 v[64:67],v11,s[4:7],s63 offen offset:2048
buffer_load_dwordx4 v[68:71],v11,s[4:7],s63 offen offset:3072
v_and_b32 v120,v12,v90
v_and_b32 v121,v13,v90
v_and_b32 v122,v12,v94
v_and_b32 v123,v13,v94
s_waitcnt lgkmcnt(4)
s_nop 0
v_smfmac_f32_16x16x64_bf16 v[116:119],v[120:123],v[72:79],v14
s_add_u32 s63,s63,4096
buffer_load_dwordx4 v[72:75],v11,s[4:7],s63 offen offset:0
buffer_load_dwordx4 v[76:79],v11,s[4:7],s63 offen offset:1024
v_and_b32 v124,v12,v91
v_and_b32 v125,v13,v91
v_and_b32 v126,v12,v95
v_and_b32 v127,v13,v95
s_waitcnt lgkmcnt(0)
s_nop 0
v_smfmac_f32_16x16x64_bf16 v[116:119],v[124:127],v[80:87],v14
buffer_load_dwordx4 v[80:83],v11,s[4:7],s63 offen offset:2048
buffer_load_dwordx4 v[84:87],v11,s[4:7],s63 offen offset:3072
v_lshlrev_b32 v8,5,v9
v_and_b32 v124,1,v10
v_lshl_add_u32 v8,v124,4,v8
v_lshrrev_b32 v124,1,v10
v_lshl_add_u32 v8,v124,11,v8
s_lshl_b32 s60,s46,9
s_add_u32 s60,s60,147456
v_add_u32 v8,s60,v8
ds_write_b128 v8,v[116:119]
v_lshlrev_b32 v8,2,v1
v_add_u32 v8,147456,v8
v_and_b32 v2,1,v1
v_lshrrev_b32 v3,1,v1
v_lshlrev_b32 v3,2,v3
v_lshl_add_u32 v2,v2,7,v3
v_add_u32 v2,s58,v2
v_lshlrev_b32 v3,6,v10
v_add_u32 v3,s58,v3
s_waitcnt lgkmcnt(0)
s_barrier
ds_read2st64_b32 v[88:89],v8 offset0:0 offset1:1
ds_read2st64_b32 v[90:91],v8 offset0:2 offset1:3
ds_read2st64_b32 v[92:93],v8 offset0:4 offset1:5
ds_read2st64_b32 v[94:95],v8 offset0:6 offset1:7
s_waitcnt lgkmcnt(0)
v_pk_add_f32 v[88:89],v[88:89],v[90:91]
v_pk_add_f32 v[92:93],v[92:93],v[94:95]
v_pk_add_f32 v[88:89],v[88:89],v[92:93]
v_cvt_pk_bf16_f32 v88,v88,v88
v_and_b32 v88,0xffff0000,v88
v_cvt_pk_bf16_f32 v89,v89,v89
v_and_b32 v89,0xffff0000,v89
v_mul_f32 v90,0xbfb8aa3b,v88
v_exp_f32 v90,v90
s_nop 0
v_add_f32 v90,1.0,v90
v_rcp_f32 v90,v90
s_nop 0
v_mul_f32 v88,v88,v90
v_cvt_pk_bf16_f32 v88,v88,v88
v_and_b32 v88,0xffff0000,v88
v_mul_f32 v88,v88,v89
v_cvt_pk_bf16_f32 v88,v88,v88
ds_write_b32 v2,v88
ds_read_b128 v[88:91],v3
ds_read_b128 v[108:111],v3 offset:32
ds_read_b128 v[92:95],v3 offset:16
ds_read_b128 v[112:115],v3 offset:48
v_mov_b64 v[116:117],0
v_mov_b64 v[118:119],0
s_waitcnt vmcnt(0) lgkmcnt(0)
v_and_b32 v120,v12,v88
v_and_b32 v121,v13,v88
v_and_b32 v122,v12,v108
v_and_b32 v123,v13,v108
v_and_b32 v124,v12,v89
v_and_b32 v125,v13,v89
v_smfmac_f32_16x16x64_bf16 v[116:119],v[120:123],v[24:31],v14
v_and_b32 v126,v12,v109
v_and_b32 v127,v13,v109
v_and_b32 v120,v12,v90
v_and_b32 v121,v13,v90
v_smfmac_f32_16x16x64_bf16 v[116:119],v[124:127],v[32:39],v14
v_and_b32 v122,v12,v110
v_and_b32 v123,v13,v110
v_and_b32 v124,v12,v91
v_and_b32 v125,v13,v91
v_smfmac_f32_16x16x64_bf16 v[116:119],v[120:123],v[40:47],v14
v_and_b32 v126,v12,v111
v_and_b32 v127,v13,v111
v_and_b32 v120,v12,v92
v_and_b32 v121,v13,v92
v_smfmac_f32_16x16x64_bf16 v[116:119],v[124:127],v[48:55],v14
v_and_b32 v122,v12,v112
v_and_b32 v123,v13,v112
v_and_b32 v124,v12,v93
v_and_b32 v125,v13,v93
v_smfmac_f32_16x16x64_bf16 v[116:119],v[120:123],v[56:63],v14
v_and_b32 v126,v12,v113
v_and_b32 v127,v13,v113
v_and_b32 v120,v12,v94
v_and_b32 v121,v13,v94
v_smfmac_f32_16x16x64_bf16 v[116:119],v[124:127],v[64:71],v14
v_and_b32 v122,v12,v114
v_and_b32 v123,v13,v114
v_and_b32 v124,v12,v95
v_and_b32 v125,v13,v95
v_smfmac_f32_16x16x64_bf16 v[116:119],v[120:123],v[72:79],v14
v_and_b32 v126,v12,v115
v_and_b32 v127,v13,v115
s_nop 1
v_smfmac_f32_16x16x64_bf16 v[116:119],v[124:127],v[80:87],v14
v_lshlrev_b32 v8,4,v9
v_and_b32 v124,1,v10
v_lshl_add_u32 v8,v124,3,v8
v_and_b32 v124,2,v10
v_lshl_add_u32 v8,v124,30,v8
s_lshl_b32 s60,s46,8
s_add_u32 s59,s62,s60
s_nop 0
v_cvt_pk_bf16_f32 v88,v116,v117
v_cvt_pk_bf16_f32 v89,v118,v119
buffer_store_dwordx2 v[88:89],v8,s[8:11],s59 offen
s_lshl_b32 s59,s51,13
s_lshl2_add_u32 s59,s47,s59
s_add_u32 s59,s59,10486912
s_waitcnt vmcnt(0)
s_barrier
s_or_b32 s59,s59,s52
buffer_store_dword v17,off,s[8:11],s59
s_lshl_b32 s59,s51,13
s_add_u32 s59,s59,10486912
v_and_b32 v124,31,v1
v_lshlrev_b32 v124,2,v124
L_fw_53:
buffer_load_dword v125,v124,s[8:11],s59 offen sc1
s_sub_u32 s49,s49,1
s_cbranch_scc1 L_abort
s_waitcnt vmcnt(0)
v_cmp_eq_u32 vcc,0,v125
s_cbranch_vccnz L_fw_53
s_add_u32 s63,s65,0
buffer_load_dwordx4 v[24:27],v22,s[8:11],s63 offen sc1
s_add_u32 s63,s65,4096
buffer_load_dwordx4 v[28:31],v22,s[8:11],s63 offen sc1
s_add_u32 s63,s65,8192
buffer_load_dwordx4 v[32:35],v22,s[8:11],s63 offen sc1
s_add_u32 s63,s65,12288
buffer_load_dwordx4 v[36:39],v22,s[8:11],s63 offen sc1
s_add_u32 s63,s65,16384
buffer_load_dwordx4 v[40:43],v22,s[8:11],s63 offen sc1
s_add_u32 s63,s65,20480
buffer_load_dwordx4 v[44:47],v22,s[8:11],s63 offen sc1
s_add_u32 s63,s65,24576
buffer_load_dwordx4 v[48:51],v22,s[8:11],s63 offen sc1
s_add_u32 s63,s65,28672
buffer_load_dwordx4 v[52:55],v22,s[8:11],s63 offen sc1
v_and_b32 v64,15,v1
v_and_b32 v65,1,v1
v_lshlrev_b32 v65,4,v65
v_mov_b32 v66,0x3f80
v_lshlrev_b32 v66,v65,v66
v_lshrrev_b32 v64,1,v64
v_cmp_eq_u32 vcc,0,v64
s_nop 1
v_cndmask_b32 v56,0,v66,vcc
v_cmp_eq_u32 vcc,1,v64
s_nop 1
v_cndmask_b32 v57,0,v66,vcc
v_cmp_eq_u32 vcc,2,v64
s_nop 1
v_cndmask_b32 v58,0,v66,vcc
v_cmp_eq_u32 vcc,3,v64
s_nop 1
v_cndmask_b32 v59,0,v66,vcc
s_waitcnt vmcnt(7)
s_nop 0
v_mfma_f32_16x16x32_bf16 v[60:63],v[56:59],v[24:27],0
s_waitcnt vmcnt(6)
v_mfma_f32_16x16x32_bf16 v[60:63],v[56:59],v[28:31],v[60:63]
s_waitcnt vmcnt(5)
v_mfma_f32_16x16x32_bf16 v[60:63],v[56:59],v[32:35],v[60:63]
s_waitcnt vmcnt(4)
v_mfma_f32_16x16x32_bf16 v[60:63],v[56:59],v[36:39],v[60:63]
s_waitcnt vmcnt(3)
v_mfma_f32_16x16x32_bf16 v[60:63],v[56:59],v[40:43],v[60:63]
s_waitcnt vmcnt(2)
v_mfma_f32_16x16x32_bf16 v[60:63],v[56:59],v[44:47],v[60:63]
s_waitcnt vmcnt(1)
v_mfma_f32_16x16x32_bf16 v[60:63],v[56:59],v[48:51],v[60:63]
s_waitcnt vmcnt(0)
v_mfma_f32_16x16x32_bf16 v[60:63],v[56:59],v[52:55],v[60:63]
s_nop 7
ds_write_b128 v21,v[60:63]
s_waitcnt lgkmcnt(0)
s_barrier
s_cmp_lg_u32 s46,0
s_cbranch_scc1 L_moed_52
v_lshlrev_b32 v56,5,v1
v_add_u32 v56,155648,v56
ds_read_b128 v[24:27],v56
ds_read_b128 v[28:31],v56 offset:16
s_and_b32 s59,s54,0xffff0000
s_xor_b32 s60,s59,0x80000000
s_xor_b32 s61,s59,0xffff0000
s_cmp_lt_i32 s59,0
s_cselect_b32 s59,s60,s61
v_mov_b32 v56,s59
v_mul_f32 v56,0xbfb8aa3b,v56
v_exp_f32 v56,v56
s_nop 0
v_add_f32 v56,1.0,v56
v_rcp_f32 v56,v56
s_nop 0
v_cvt_pk_bf16_f32 v56,v56,v56
v_and_b32 v56,0xffff0000,v56
v_lshlrev_b32 v48,16,v104
v_and_b32 v49,0xffff0000,v104
v_lshlrev_b32 v50,16,v105
v_and_b32 v51,0xffff0000,v105
v_lshlrev_b32 v52,16,v106
v_and_b32 v53,0xffff0000,v106
v_lshlrev_b32 v54,16,v107
v_and_b32 v55,0xffff0000,v107
s_waitcnt lgkmcnt(0)
v_cvt_pk_bf16_f32 v40,v24,v25
v_cvt_pk_bf16_f32 v41,v26,v27
v_cvt_pk_bf16_f32 v42,v28,v29
v_cvt_pk_bf16_f32 v43,v30,v31
v_lshlrev_b32 v24,16,v40
v_and_b32 v25,0xffff0000,v40
v_lshlrev_b32 v26,16,v41
v_and_b32 v27,0xffff0000,v41
v_lshlrev_b32 v28,16,v42
v_and_b32 v29,0xffff0000,v42
v_lshlrev_b32 v30,16,v43
v_and_b32 v31,0xffff0000,v43
v_pk_mul_f32 v[24:25],v[24:25],v[56:57] op_sel_hi:[1,0]
v_pk_mul_f32 v[26:27],v[26:27],v[56:57] op_sel_hi:[1,0]
v_pk_mul_f32 v[28:29],v[28:29],v[56:57] op_sel_hi:[1,0]
v_pk_mul_f32 v[30:31],v[30:31],v[56:57] op_sel_hi:[1,0]
v_cvt_pk_bf16_f32 v40,v24,v25
v_cvt_pk_bf16_f32 v41,v26,v27
v_cvt_pk_bf16_f32 v42,v28,v29
v_cvt_pk_bf16_f32 v43,v30,v31
v_lshlrev_b32 v24,16,v40
v_and_b32 v25,0xffff0000,v40
v_lshlrev_b32 v26,16,v41
v_and_b32 v27,0xffff0000,v41
v_lshlrev_b32 v28,16,v42
v_and_b32 v29,0xffff0000,v42
v_lshlrev_b32 v30,16,v43
v_and_b32 v31,0xffff0000,v43
v_pk_add_f32 v[24:25],v[24:25],v[48:49]
v_pk_add_f32 v[26:27],v[26:27],v[50:51]
v_pk_add_f32 v[28:29],v[28:29],v[52:53]
v_pk_add_f32 v[30:31],v[30:31],v[54:55]
v_cvt_pk_bf16_f32 v40,v24,v25
v_cvt_pk_bf16_f32 v41,v26,v27
v_cvt_pk_bf16_f32 v42,v28,v29
v_cvt_pk_bf16_f32 v43,v30,v31
v_lshlrev_b32 v24,16,v40
v_and_b32 v25,0xffff0000,v40
v_lshlrev_b32 v26,16,v41
v_and_b32 v27,0xffff0000,v41
v_lshlrev_b32 v28,16,v42
v_and_b32 v29,0xffff0000,v42
v_lshlrev_b32 v30,16,v43
v_and_b32 v31,0xffff0000,v43
v_pk_add_f32 v[96:97],v[96:97],v[24:25]
v_pk_add_f32 v[98:99],v[98:99],v[26:27]
v_pk_add_f32 v[100:101],v[100:101],v[28:29]
v_pk_add_f32 v[102:103],v[102:103],v[30:31]
v_cvt_pk_bf16_f32 v80,v96,v97
v_cvt_pk_bf16_f32 v81,v98,v99
v_cvt_pk_bf16_f32 v82,v100,v101
v_cvt_pk_bf16_f32 v83,v102,v103
v_lshlrev_b32 v96,16,v80
v_and_b32 v97,0xffff0000,v80
v_lshlrev_b32 v98,16,v81
v_and_b32 v99,0xffff0000,v81
v_lshlrev_b32 v100,16,v82
v_and_b32 v101,0xffff0000,v82
v_lshlrev_b32 v102,16,v83
v_and_b32 v103,0xffff0000,v83
v_readfirstlane_b32 s78,v96
s_nop 1
v_pk_add_f32 v[58:59],v[96:97],s[78:79] op_sel_hi:[1,0] neg_lo:[0,1] neg_hi:[0,1]
v_pk_add_f32 v[60:61],v[98:99],s[78:79] op_sel_hi:[1,0] neg_lo:[0,1] neg_hi:[0,1]
v_pk_add_f32 v[62:63],v[100:101],s[78:79] op_sel_hi:[1,0] neg_lo:[0,1] neg_hi:[0,1]
v_pk_add_f32 v[64:65],v[102:103],s[78:79] op_sel_hi:[1,0] neg_lo:[0,1] neg_hi:[0,1]
v_pk_add_f32 v[66:67],v[58:59],v[60:61]
v_pk_mul_f32 v[68:69],v[58:59],v[58:59]
v_pk_add_f32 v[70:71],v[62:63],v[64:65]
v_pk_fma_f32 v[68:69],v[60:61],v[60:61],v[68:69]
v_pk_add_f32 v[66:67],v[66:67],v[70:71]
v_pk_fma_f32 v[68:69],v[62:63],v[62:63],v[68:69]
v_add_f32 v66,v66,v67
v_pk_fma_f32 v[68:69],v[64:65],v[64:65],v[68:69]
v_add_f32 v68,v68,v69
s_nop 1
v_permlane32_swap_b32 v66,v68
v_add_f32 v66,v66,v68
s_nop 1
v_add_f32_dpp v66,v66,v66 row_ror:8 row_mask:0xf bank_mask:0xf
s_nop 1
v_add_f32_dpp v66,v66,v66 row_ror:4 row_mask:0xf bank_mask:0xf
s_nop 1
v_add_f32_dpp v66,v66,v66 row_ror:2 row_mask:0xf bank_mask:0xf
s_nop 1
v_add_f32_dpp v66,v66,v66 row_ror:1 row_mask:0xf bank_mask:0xf
v_mov_b32 v68,v66
s_nop 1
v_permlane16_swap_b32 v66,v68
v_add_f32 v66,v66,v68
v_mul_f32 v66,0x3b000000,v66
v_mov_b32 v68,v66
s_nop 1
v_permlane32_swap_b32 v66,v68
v_fma_f32 v68,-v66,v66,v68
v_add_f32 v66,s78,v66
v_max_f32 v68,0,v68
v_cvt_pk_bf16_f32 v68,v66,v68
v_lshlrev_b32 v66,16,v68
v_and_b32 v68,0xffff0000,v68
v_add_f32 v68,0x3727c5ac,v68
v_cvt_pk_bf16_f32 v68,v68,v68
v_and_b32 v68,0xffff0000,v68
v_sqrt_f32 v68,v68
v_pk_add_f32 v[58:59],v[96:97],v[66:67] op_sel_hi:[1,0] neg_lo:[0,1] neg_hi:[0,1]
v_pk_add_f32 v[60:61],v[98:99],v[66:67] op_sel_hi:[1,0] neg_lo:[0,1] neg_hi:[0,1]
v_pk_add_f32 v[62:63],v[100:101],v[66:67] op_sel_hi:[1,0] neg_lo:[0,1] neg_hi:[0,1]
v_pk_add_f32 v[64:65],v[102:103],v[66:67] op_sel_hi:[1,0] neg_lo:[0,1] neg_hi:[0,1]
v_cvt_pk_bf16_f32 v68,v68,v68
v_and_b32 v68,0xffff0000,v68
v_rcp_f32 v68,v68
v_cvt_pk_bf16_f32 v84,v58,v59
v_cvt_pk_bf16_f32 v85,v60,v61
v_cvt_pk_bf16_f32 v86,v62,v63
v_cvt_pk_bf16_f32 v87,v64,v65
v_lshlrev_b32 v58,16,v84
v_and_b32 v59,0xffff0000,v84
v_lshlrev_b32 v60,16,v85
v_and_b32 v61,0xffff0000,v85
v_lshlrev_b32 v62,16,v86
v_and_b32 v63,0xffff0000,v86
v_lshlrev_b32 v64,16,v87
v_and_b32 v65,0xffff0000,v87
v_pk_mul_f32 v[58:59],v[58:59],v[68:69] op_sel_hi:[1,0]
v_pk_mul_f32 v[60:61],v[60:61],v[68:69] op_sel_hi:[1,0]
v_pk_mul_f32 v[62:63],v[62:63],v[68:69] op_sel_hi:[1,0]
v_pk_mul_f32 v[64:65],v[64:65],v[68:69] op_sel_hi:[1,0]
v_cvt_pk_bf16_f32 v84,v58,v59
v_cvt_pk_bf16_f32 v85,v60,v61
v_cvt_pk_bf16_f32 v86,v62,v63
v_cvt_pk_bf16_f32 v87,v64,v65
s_lshl_b32 s58,s51,10
s_add_u32 s58,s58,11272192
s_add_u32 s59,s58,65536
s_cmp_eq_u32 s47,0
s_cselect_b32 s59,s59,0x80000000
s_add_u32 s57,s56,98566144
buffer_store_dwordx4 v[84:87],v0,s[8:11],s59 offen sc1
buffer_store_dwordx4 v[80:83],v0,s[8:11],s58 offen sc1
buffer_store_dwordx4 v[84:87],v0,s[8:11],s57 offen sc1
L_moed_52:
s_barrier
L_mo_39:
s_mov_b32 s77,-1
s_cmp_lt_u32 s31,64
s_cbranch_scc1 L_mo_35
s_cmp_eq_u32 s86,0
s_cbranch_scc1 L_mo_48
L_mo_41:
s_andn2_b32 s51,0x7ff,s54
s_lshr_b32 s51,s51,5
s_andn2_b32 s56,31,s54
v_lshrrev_b32 v2,10,v20
v_add_u32 v3,16,v2
v_add_u32 v8,96468992,v20
v_cmp_eq_u32 vcc,s56,v2
s_nop 1
v_cndmask_b32 v2,v20,v8,vcc
v_cmp_eq_u32 vcc,s56,v3
s_nop 1
v_cndmask_b32 v3,v20,v8,vcc
s_waitcnt vmcnt(0)
s_lshl_b32 s59,s51,13
s_add_u32 s59,s59,10487552
s_cmp_lg_u32 s46,0
s_cbranch_scc1 L_fd_57
v_and_b32 v124,31,v1
v_lshlrev_b32 v124,2,v124
s_branch L_ff_58
L_fw_56:
s_sleep 2
L_ff_58:
buffer_load_dword v125,v124,s[8:11],s59 offen sc1
s_sub_u32 s49,s49,1
s_cbranch_scc1 L_abort
s_waitcnt vmcnt(0)
v_cmp_eq_u32 vcc,0,v125
s_cbranch_vccnz L_fw_56
L_fd_57:
s_barrier
s_or_b32 s72,s72,s52
buffer_store_dword v17,off,s[8:11],s72 sc1
s_lshl_b32 s66,s51,15
s_add_u32 s66,s66,2097152
s_add_u32 s67,s66,16384
s_add_u32 m0,s50,131072
s_nop 0
buffer_load_dwordx4 v2,s[8:11],s66 offen offset:0 sc1 lds
s_add_u32 m0,s50,135168
s_nop 0
buffer_load_dwordx4 v3,s[8:11],s67 offen offset:0 sc1 lds
s_add_u32 m0,s50,139008
s_nop 0
buffer_load_dwordx4 v2,s[8:11],s66 offen offset:256 sc1 lds
s_add_u32 m0,s50,143104
s_nop 0
buffer_load_dwordx4 v3,s[8:11],s67 offen offset:256 sc1 lds
s_add_u32 m0,s50,146944
s_nop 0
buffer_load_dwordx4 v2,s[8:11],s66 offen offset:512 sc1 lds
s_add_u32 m0,s50,151040
s_nop 0
buffer_load_dwordx4 v3,s[8:11],s67 offen offset:512 sc1 lds
s_waitcnt vmcnt(4)
s_barrier
ds_read_b128 v[104:107],v4 offset:0
ds_read_b128 v[108:111],v4 offset:4096
ds_read_b128 v[112:115],v5 offset:0
ds_read_b128 v[116:119],v5 offset:4096
s_add_u32 m0,s50,154880
s_nop 0
buffer_load_dwordx4 v2,s[8:11],s66 offen offset:768 sc1 lds
s_add_u32 m0,s50,158976
s_nop 0
buffer_load_dwordx4 v3,s[8:11],s67 offen offset:768 sc1 lds
s_waitcnt lgkmcnt(2)
v_mfma_f32_16x16x32_bf16 v[24:27],a[128:131],v[104:107],0
ds_read_b128 v[120:123],v6 offset:0
v_mfma_f32_16x16x32_bf16 v[40:43],v[104:107],v[128:131],0
s_lshl_b32 s58,s51,5
v_mfma_f32_16x16x32_bf16 v[28:31],a[128:131],v[108:111],0
ds_read_b128 v[124:127],v6 offset:4096
v_mfma_f32_16x16x32_bf16 v[44:47],v[108:111],v[128:131],0
s_add_u32 s58,s58,s47
v_mfma_f32_16x16x32_bf16 v[32:35],a[136:139],v[104:107],0
s_mul_i32 s58,s58,24576
v_mfma_f32_16x16x32_bf16 v[48:51],v[104:107],v[136:139],0
s_add_u32 s58,s58,201326592
v_mfma_f32_16x16x32_bf16 v[36:39],a[136:139],v[108:111],0
s_add_u32 s61,s58,s50
v_mfma_f32_16x16x32_bf16 v[52:55],v[108:111],v[136:139],0
s_add_u32 s62,s61,4096
s_waitcnt lgkmcnt(2)
v_mfma_f32_16x16x32_bf16 v[24:27],a[132:135],v[112:115],v[24:27]
ds_read_b128 v[104:107],v7 offset:0
v_mfma_f32_16x16x32_bf16 v[40:43],v[112:115],v[132:135],v[40:43]
s_add_u32 s63,s61,16384
v_mfma_f32_16x16x32_bf16 v[28:31],a[132:135],v[116:119],v[28:31]
ds_read_b128 v[108:111],v7 offset:4096
v_mfma_f32_16x16x32_bf16 v[44:47],v[116:119],v[132:135],v[44:47]
s_add_u32 s64,s61,20480
v_mfma_f32_16x16x32_bf16 v[32:35],a[140:143],v[112:115],v[32:35]
s_add_u32 s65,s61,s50
v_mfma_f32_16x16x32_bf16 v[48:51],v[112:115],v[140:143],v[48:51]
s_add_u32 s65,s65,8192
v_mfma_f32_16x16x32_bf16 v[36:39],a[140:143],v[116:119],v[36:39]
v_mfma_f32_16x16x32_bf16 v[52:55],v[116:119],v[140:143],v[52:55]
s_waitcnt vmcnt(4)
s_barrier
s_waitcnt lgkmcnt(2)
v_mfma_f32_16x16x32_bf16 v[24:27],a[144:147],v[120:123],v[24:27]
ds_read_b128 v[112:115],v4 offset:8192
v_mfma_f32_16x16x32_bf16 v[40:43],v[120:123],v[144:147],v[40:43]
v_mfma_f32_16x16x32_bf16 v[28:31],a[144:147],v[124:127],v[28:31]
ds_read_b128 v[116:119],v4 offset:12288
v_mfma_f32_16x16x32_bf16 v[44:47],v[124:127],v[144:147],v[44:47]
v_mfma_f32_16x16x32_bf16 v[32:35],a[152:155],v[120:123],v[32:35]
v_mfma_f32_16x16x32_bf16 v[48:51],v[120:123],v[152:155],v[48:51]
v_mfma_f32_16x16x32_bf16 v[36:39],a[152:155],v[124:127],v[36:39]
v_mfma_f32_16x16x32_bf16 v[52:55],v[124:127],v[152:155],v[52:55]
s_waitcnt lgkmcnt(2)
v_mfma_f32_16x16x32_bf16 v[24:27],a[148:151],v[104:107],v[24:27]
ds_read_b128 v[120:123],v5 offset:8192
v_mfma_f32_16x16x32_bf16 v[40:43],v[104:107],v[148:151],v[40:43]
v_mfma_f32_16x16x32_bf16 v[28:31],a[148:151],v[108:111],v[28:31]
ds_read_b128 v[124:127],v5 offset:12288
v_mfma_f32_16x16x32_bf16 v[44:47],v[108:111],v[148:151],v[44:47]
v_mfma_f32_16x16x32_bf16 v[32:35],a[156:159],v[104:107],v[32:35]
v_mfma_f32_16x16x32_bf16 v[48:51],v[104:107],v[156:159],v[48:51]
v_mfma_f32_16x16x32_bf16 v[36:39],a[156:159],v[108:111],v[36:39]
v_mfma_f32_16x16x32_bf16 v[52:55],v[108:111],v[156:159],v[52:55]
s_waitcnt lgkmcnt(2)
v_mfma_f32_16x16x32_bf16 v[24:27],a[160:163],v[112:115],v[24:27]
ds_read_b128 v[104:107],v6 offset:8192
v_mfma_f32_16x16x32_bf16 v[40:43],v[112:115],v[160:163],v[40:43]
v_mfma_f32_16x16x32_bf16 v[28:31],a[160:163],v[116:119],v[28:31]
ds_read_b128 v[108:111],v6 offset:12288
v_mfma_f32_16x16x32_bf16 v[44:47],v[116:119],v[160:163],v[44:47]
v_mfma_f32_16x16x32_bf16 v[32:35],a[168:171],v[112:115],v[32:35]
v_mfma_f32_16x16x32_bf16 v[48:51],v[112:115],v[168:171],v[48:51]
v_mfma_f32_16x16x32_bf16 v[36:39],a[168:171],v[116:119],v[36:39]
v_mfma_f32_16x16x32_bf16 v[52:55],v[116:119],v[168:171],v[52:55]
s_waitcnt lgkmcnt(2)
v_mfma_f32_16x16x32_bf16 v[24:27],a[164:167],v[120:123],v[24:27]
ds_read_b128 v[112:115],v7 offset:8192
v_mfma_f32_16x16x32_bf16 v[40:43],v[120:123],v[164:167],v[40:43]
v_mfma_f32_16x16x32_bf16 v[28:31],a[164:167],v[124:127],v[28:31]
ds_read_b128 v[116:119],v7 offset:12288
v_mfma_f32_16x16x32_bf16 v[44:47],v[124:127],v[164:167],v[44:47]
v_mfma_f32_16x16x32_bf16 v[32:35],a[172:175],v[120:123],v[32:35]
v_mfma_f32_16x16x32_bf16 v[48:51],v[120:123],v[172:175],v[48:51]
v_mfma_f32_16x16x32_bf16 v[36:39],a[172:175],v[124:127],v[36:39]
v_mfma_f32_16x16x32_bf16 v[52:55],v[124:127],v[172:175],v[52:55]
s_waitcnt vmcnt(2)
s_barrier
s_waitcnt lgkmcnt(2)
v_mfma_f32_16x16x32_bf16 v[24:27],a[176:179],v[104:107],v[24:27]
ds_read_b128 v[120:123],v4 offset:16384
v_mfma_f32_16x16x32_bf16 v[40:43],v[104:107],v[176:179],v[40:43]
v_mfma_f32_16x16x32_bf16 v[28:31],a[176:179],v[108:111],v[28:31]
ds_read_b128 v[124:127],v4 offset:20480
v_mfma_f32_16x16x32_bf16 v[44:47],v[108:111],v[176:179],v[44:47]
v_mfma_f32_16x16x32_bf16 v[32:35],a[184:187],v[104:107],v[32:35]
v_mfma_f32_16x16x32_bf16 v[48:51],v[104:107],v[184:187],v[48:51]
v_mfma_f32_16x16x32_bf16 v[36:39],a[184:187],v[108:111],v[36:39]
v_mfma_f32_16x16x32_bf16 v[52:55],v[108:111],v[184:187],v[52:55]
s_waitcnt lgkmcnt(2)
v_mfma_f32_16x16x32_bf16 v[24:27],a[180:183],v[112:115],v[24:27]
ds_read_b128 v[104:107],v5 offset:16384
v_mfma_f32_16x16x32_bf16 v[40:43],v[112:115],v[180:183],v[40:43]
v_mfma_f32_16x16x32_bf16 v[28:31],a[180:183],v[116:119],v[28:31]
ds_read_b128 v[108:111],v5 offset:20480
v_mfma_f32_16x16x32_bf16 v[44:47],v[116:119],v[180:183],v[44:47]
v_mfma_f32_16x16x32_bf16 v[32:35],a[188:191],v[112:115],v[32:35]
v_mfma_f32_16x16x32_bf16 v[48:51],v[112:115],v[188:191],v[48:51]
v_mfma_f32_16x16x32_bf16 v[36:39],a[188:191],v[116:119],v[36:39]
v_mfma_f32_16x16x32_bf16 v[52:55],v[116:119],v[188:191],v[52:55]
s_waitcnt lgkmcnt(2)
v_mfma_f32_16x16x32_bf16 v[24:27],a[192:195],v[120:123],v[24:27]
ds_read_b128 v[112:115],v6 offset:16384
v_mfma_f32_16x16x32_bf16 v[40:43],v[120:123],v[192:195],v[40:43]
v_mfma_f32_16x16x32_bf16 v[28:31],a[192:195],v[124:127],v[28:31]
ds_read_b128 v[116:119],v6 offset:20480
v_mfma_f32_16x16x32_bf16 v[44:47],v[124:127],v[192:195],v[44:47]
v_mfma_f32_16x16x32_bf16 v[32:35],a[200:203],v[120:123],v[32:35]
v_mfma_f32_16x16x32_bf16 v[48:51],v[120:123],v[200:203],v[48:51]
v_mfma_f32_16x16x32_bf16 v[36:39],a[200:203],v[124:127],v[36:39]
v_mfma_f32_16x16x32_bf16 v[52:55],v[124:127],v[200:203],v[52:55]
s_waitcnt lgkmcnt(2)
v_mfma_f32_16x16x32_bf16 v[24:27],a[196:199],v[104:107],v[24:27]
ds_read_b128 v[120:123],v7 offset:16384
v_mfma_f32_16x16x32_bf16 v[40:43],v[104:107],v[196:199],v[40:43]
v_mfma_f32_16x16x32_bf16 v[28:31],a[196:199],v[108:111],v[28:31]
ds_read_b128 v[124:127],v7 offset:20480
v_mfma_f32_16x16x32_bf16 v[44:47],v[108:111],v[196:199],v[44:47]
v_mfma_f32_16x16x32_bf16 v[32:35],a[204:207],v[104:107],v[32:35]
v_mfma_f32_16x16x32_bf16 v[48:51],v[104:107],v[204:207],v[48:51]
v_mfma_f32_16x16x32_bf16 v[36:39],a[204:207],v[108:111],v[36:39]
v_mfma_f32_16x16x32_bf16 v[52:55],v[108:111],v[204:207],v[52:55]
s_waitcnt vmcnt(0)
s_barrier
s_waitcnt lgkmcnt(2)
v_mfma_f32_16x16x32_bf16 v[24:27],a[208:211],v[112:115],v[24:27]
ds_read_b128 v[104:107],v4 offset:24576
v_mfma_f32_16x16x32_bf16 v[40:43],v[112:115],v[208:211],v[40:43]
v_mfma_f32_16x16x32_bf16 v[28:31],a[208:211],v[116:119],v[28:31]
ds_read_b128 v[108:111],v4 offset:28672
v_mfma_f32_16x16x32_bf16 v[44:47],v[116:119],v[208:211],v[44:47]
v_mfma_f32_16x16x32_bf16 v[32:35],a[216:219],v[112:115],v[32:35]
v_mfma_f32_16x16x32_bf16 v[48:51],v[112:115],v[216:219],v[48:51]
v_mfma_f32_16x16x32_bf16 v[36:39],a[216:219],v[116:119],v[36:39]
v_mfma_f32_16x16x32_bf16 v[52:55],v[116:119],v[216:219],v[52:55]
s_waitcnt lgkmcnt(2)
v_mfma_f32_16x16x32_bf16 v[24:27],a[212:215],v[120:123],v[24:27]
ds_read_b128 v[112:115],v5 offset:24576
v_mfma_f32_16x16x32_bf16 v[40:43],v[120:123],v[212:215],v[40:43]
v_mfma_f32_16x16x32_bf16 v[28:31],a[212:215],v[124:127],v[28:31]
ds_read_b128 v[116:119],v5 offset:28672
v_mfma_f32_16x16x32_bf16 v[44:47],v[124:127],v[212:215],v[44:47]
v_mfma_f32_16x16x32_bf16 v[32:35],a[220:223],v[120:123],v[32:35]
v_mfma_f32_16x16x32_bf16 v[48:51],v[120:123],v[220:223],v[48:51]
v_mfma_f32_16x16x32_bf16 v[36:39],a[220:223],v[124:127],v[36:39]
v_mfma_f32_16x16x32_bf16 v[52:55],v[124:127],v[220:223],v[52:55]
s_waitcnt lgkmcnt(2)
v_mfma_f32_16x16x32_bf16 v[24:27],a[224:227],v[104:107],v[24:27]
ds_read_b128 v[120:123],v6 offset:24576
v_mfma_f32_16x16x32_bf16 v[40:43],v[104:107],v[224:227],v[40:43]
v_mfma_f32_16x16x32_bf16 v[28:31],a[224:227],v[108:111],v[28:31]
ds_read_b128 v[124:127],v6 offset:28672
v_mfma_f32_16x16x32_bf16 v[44:47],v[108:111],v[224:227],v[44:47]
v_mfma_f32_16x16x32_bf16 v[32:35],a[232:235],v[104:107],v[32:35]
v_mfma_f32_16x16x32_bf16 v[48:51],v[104:107],v[232:235],v[48:51]
v_mfma_f32_16x16x32_bf16 v[36:39],a[232:235],v[108:111],v[36:39]
v_mfma_f32_16x16x32_bf16 v[52:55],v[108:111],v[232:235],v[52:55]
s_waitcnt lgkmcnt(2)
v_mfma_f32_16x16x32_bf16 v[24:27],a[228:231],v[112:115],v[24:27]
ds_read_b128 v[104:107],v7 offset:24576
v_mfma_f32_16x16x32_bf16 v[40:43],v[112:115],v[228:231],v[40:43]
v_mfma_f32_16x16x32_bf16 v[28:31],a[228:231],v[116:119],v[28:31]
ds_read_b128 v[108:111],v7 offset:28672
v_mfma_f32_16x16x32_bf16 v[44:47],v[116:119],v[228:231],v[44:47]
v_mfma_f32_16x16x32_bf16 v[32:35],a[236:239],v[112:115],v[32:35]
v_mfma_f32_16x16x32_bf16 v[48:51],v[112:115],v[236:239],v[48:51]
v_mfma_f32_16x16x32_bf16 v[36:39],a[236:239],v[116:119],v[36:39]
v_mfma_f32_16x16x32_bf16 v[52:55],v[116:119],v[236:239],v[52:55]
s_waitcnt lgkmcnt(2)
v_mfma_f32_16x16x32_bf16 v[24:27],a[240:243],v[120:123],v[24:27]
ds_read_b128 v[112:115],v4 offset:0
v_mfma_f32_16x16x32_bf16 v[40:43],v[120:123],v[240:243],v[40:43]
v_mfma_f32_16x16x32_bf16 v[28:31],a[240:243],v[124:127],v[28:31]
ds_read_b128 v[116:119],v4 offset:4096
v_mfma_f32_16x16x32_bf16 v[44:47],v[124:127],v[240:243],v[44:47]
v_mfma_f32_16x16x32_bf16 v[32:35],a[248:251],v[120:123],v[32:35]
v_mfma_f32_16x16x32_bf16 v[48:51],v[120:123],v[248:251],v[48:51]
v_mfma_f32_16x16x32_bf16 v[36:39],a[248:251],v[124:127],v[36:39]
v_mfma_f32_16x16x32_bf16 v[52:55],v[124:127],v[248:251],v[52:55]
s_waitcnt lgkmcnt(2)
v_mfma_f32_16x16x32_bf16 v[24:27],a[244:247],v[104:107],v[24:27]
ds_read_b128 v[120:123],v5 offset:0
v_mfma_f32_16x16x32_bf16 v[40:43],v[104:107],v[244:247],v[40:43]
v_mfma_f32_16x16x32_bf16 v[28:31],a[244:247],v[108:111],v[28:31]
ds_read_b128 v[124:127],v5 offset:4096
v_mfma_f32_16x16x32_bf16 v[44:47],v[108:111],v[244:247],v[44:47]
v_mfma_f32_16x16x32_bf16 v[32:35],a[252:255],v[104:107],v[32:35]
v_mfma_f32_16x16x32_bf16 v[48:51],v[104:107],v[252:255],v[48:51]
v_mfma_f32_16x16x32_bf16 v[36:39],a[252:255],v[108:111],v[36:39]
v_mfma_f32_16x16x32_bf16 v[52:55],v[108:111],v[252:255],v[52:55]
s_waitcnt lgkmcnt(2)
v_mfma_f32_16x16x32_bf16 v[88:91],a[0:3],v[112:115],0
ds_read_b128 v[104:107],v6 offset:0
v_mfma_f32_16x16x32_bf16 v[92:95],a[0:3],v[116:119],0
v_mfma_f32_16x16x32_bf16 v[96:99],a[8:11],v[112:115],0
ds_read_b128 v[108:111],v6 offset:4096
v_cvt_pk_bf16_f32 v56,v24,v32
v_cvt_pk_bf16_f32 v57,v25,v33
v_mfma_f32_16x16x32_bf16 v[100:103],a[8:11],v[116:119],0
v_cvt_pk_bf16_f32 v58,v26,v34
v_cvt_pk_bf16_f32 v59,v27,v35
s_waitcnt lgkmcnt(2)
v_mfma_f32_16x16x32_bf16 v[88:91],a[4:7],v[120:123],v[88:91]
ds_read_b128 v[112:115],v7 offset:0
v_mfma_f32_16x16x32_bf16 v[92:95],a[4:7],v[124:127],v[92:95]
buffer_store_dwordx4 v[56:59],v0,s[8:11],s61 offen sc1
v_cvt_pk_bf16_f32 v60,v28,v36
v_cvt_pk_bf16_f32 v61,v29,v37
v_mfma_f32_16x16x32_bf16 v[96:99],a[12:15],v[120:123],v[96:99]
ds_read_b128 v[116:119],v7 offset:4096
v_cvt_pk_bf16_f32 v62,v30,v38
v_cvt_pk_bf16_f32 v63,v31,v39
v_mfma_f32_16x16x32_bf16 v[100:103],a[12:15],v[124:127],v[100:103]
buffer_store_dwordx4 v[60:63],v0,s[8:11],s62 offen sc1
v_cvt_pk_bf16_f32 v64,v40,v41
v_cvt_pk_bf16_f32 v65,v42,v43
s_waitcnt lgkmcnt(2)
v_mfma_f32_16x16x32_bf16 v[88:91],a[16:19],v[104:107],v[88:91]
ds_read_b128 v[120:123],v4 offset:8192
v_cvt_pk_bf16_f32 v66,v44,v45
v_cvt_pk_bf16_f32 v67,v46,v47
v_mfma_f32_16x16x32_bf16 v[92:95],a[16:19],v[108:111],v[92:95]
buffer_store_dwordx4 v[64:67],v0,s[8:11],s65 offen offset:0 sc1
v_cvt_pk_bf16_f32 v68,v48,v49
v_cvt_pk_bf16_f32 v69,v50,v51
v_mfma_f32_16x16x32_bf16 v[96:99],a[24:27],v[104:107],v[96:99]
ds_read_b128 v[124:127],v4 offset:12288
v_cvt_pk_bf16_f32 v70,v52,v53
v_cvt_pk_bf16_f32 v71,v54,v55
v_mfma_f32_16x16x32_bf16 v[100:103],a[24:27],v[108:111],v[100:103]
buffer_store_dwordx4 v[68:71],v0,s[8:11],s65 offen offset:1024 sc1
s_waitcnt lgkmcnt(2)
v_mfma_f32_16x16x32_bf16 v[88:91],a[20:23],v[112:115],v[88:91]
ds_read_b128 v[104:107],v5 offset:8192
v_mfma_f32_16x16x32_bf16 v[92:95],a[20:23],v[116:119],v[92:95]
v_mfma_f32_16x16x32_bf16 v[96:99],a[28:31],v[112:115],v[96:99]
ds_read_b128 v[108:111],v5 offset:12288
v_mfma_f32_16x16x32_bf16 v[100:103],a[28:31],v[116:119],v[100:103]
s_waitcnt lgkmcnt(2)
v_mfma_f32_16x16x32_bf16 v[88:91],a[32:35],v[120:123],v[88:91]
ds_read_b128 v[112:115],v6 offset:8192
v_mfma_f32_16x16x32_bf16 v[92:95],a[32:35],v[124:127],v[92:95]
v_mfma_f32_16x16x32_bf16 v[96:99],a[40:43],v[120:123],v[96:99]
ds_read_b128 v[116:119],v6 offset:12288
v_mfma_f32_16x16x32_bf16 v[100:103],a[40:43],v[124:127],v[100:103]
s_waitcnt lgkmcnt(2)
v_mfma_f32_16x16x32_bf16 v[88:91],a[36:39],v[104:107],v[88:91]
ds_read_b128 v[120:123],v7 offset:8192
v_mfma_f32_16x16x32_bf16 v[92:95],a[36:39],v[108:111],v[92:95]
v_mfma_f32_16x16x32_bf16 v[96:99],a[44:47],v[104:107],v[96:99]
ds_read_b128 v[124:127],v7 offset:12288
v_mfma_f32_16x16x32_bf16 v[100:103],a[44:47],v[108:111],v[100:103]
s_waitcnt lgkmcnt(2)
v_mfma_f32_16x16x32_bf16 v[88:91],a[48:51],v[112:115],v[88:91]
ds_read_b128 v[104:107],v4 offset:16384
v_mfma_f32_16x16x32_bf16 v[92:95],a[48:51],v[116:119],v[92:95]
v_mfma_f32_16x16x32_bf16 v[96:99],a[56:59],v[112:115],v[96:99]
ds_read_b128 v[108:111],v4 offset:20480
v_mfma_f32_16x16x32_bf16 v[100:103],a[56:59],v[116:119],v[100:103]
s_waitcnt lgkmcnt(2)
v_mfma_f32_16x16x32_bf16 v[88:91],a[52:55],v[120:123],v[88:91]
ds_read_b128 v[112:115],v5 offset:16384
v_mfma_f32_16x16x32_bf16 v[92:95],a[52:55],v[124:127],v[92:95]
v_mfma_f32_16x16x32_bf16 v[96:99],a[60:63],v[120:123],v[96:99]
ds_read_b128 v[116:119],v5 offset:20480
v_mfma_f32_16x16x32_bf16 v[100:103],a[60:63],v[124:127],v[100:103]
s_waitcnt lgkmcnt(2)
v_mfma_f32_16x16x32_bf16 v[88:91],a[64:67],v[104:107],v[88:91]
ds_read_b128 v[120:123],v6 offset:16384
v_mfma_f32_16x16x32_bf16 v[92:95],a[64:67],v[108:111],v[92:95]
v_mfma_f32_16x16x32_bf16 v[96:99],a[72:75],v[104:107],v[96:99]
ds_read_b128 v[124:127],v6 offset:20480
v_mfma_f32_16x16x32_bf16 v[100:103],a[72:75],v[108:111],v[100:103]
s_waitcnt lgkmcnt(2)
v_mfma_f32_16x16x32_bf16 v[88:91],a[68:71],v[112:115],v[88:91]
ds_read_b128 v[104:107],v7 offset:16384
v_mfma_f32_16x16x32_bf16 v[92:95],a[68:71],v[116:119],v[92:95]
v_mfma_f32_16x16x32_bf16 v[96:99],a[76:79],v[112:115],v[96:99]
ds_read_b128 v[108:111],v7 offset:20480
v_mfma_f32_16x16x32_bf16 v[100:103],a[76:79],v[116:119],v[100:103]
s_waitcnt lgkmcnt(2)
v_mfma_f32_16x16x32_bf16 v[88:91],a[80:83],v[120:123],v[88:91]
ds_read_b128 v[112:115],v4 offset:24576
v_mfma_f32_16x16x32_bf16 v[92:95],a[80:83],v[124:127],v[92:95]
v_mfma_f32_16x16x32_bf16 v[96:99],a[88:91],v[120:123],v[96:99]
ds_read_b128 v[116:119],v4 offset:28672
v_mfma_f32_16x16x32_bf16 v[100:103],a[88:91],v[124:127],v[100:103]
s_waitcnt lgkmcnt(2)
v_mfma_f32_16x16x32_bf16 v[88:91],a[84:87],v[104:107],v[88:91]
ds_read_b128 v[120:123],v5 offset:24576
v_mfma_f32_16x16x32_bf16 v[92:95],a[84:87],v[108:111],v[92:95]
v_mfma_f32_16x16x32_bf16 v[96:99],a[92:95],v[104:107],v[96:99]
ds_read_b128 v[124:127],v5 offset:28672
v_mfma_f32_16x16x32_bf16 v[100:103],a[92:95],v[108:111],v[100:103]
s_waitcnt lgkmcnt(2)
v_mfma_f32_16x16x32_bf16 v[88:91],a[96:99],v[112:115],v[88:91]
ds_read_b128 v[104:107],v6 offset:24576
v_mfma_f32_16x16x32_bf16 v[92:95],a[96:99],v[116:119],v[92:95]
v_mfma_f32_16x16x32_bf16 v[96:99],a[104:107],v[112:115],v[96:99]
ds_read_b128 v[108:111],v6 offset:28672
v_mfma_f32_16x16x32_bf16 v[100:103],a[104:107],v[116:119],v[100:103]
s_waitcnt lgkmcnt(2)
v_mfma_f32_16x16x32_bf16 v[88:91],a[100:103],v[120:123],v[88:91]
ds_read_b128 v[112:115],v7 offset:24576
v_mfma_f32_16x16x32_bf16 v[92:95],a[100:103],v[124:127],v[92:95]
v_mfma_f32_16x16x32_bf16 v[96:99],a[108:111],v[120:123],v[96:99]
ds_read_b128 v[116:119],v7 offset:28672
v_mfma_f32_16x16x32_bf16 v[100:103],a[108:111],v[124:127],v[100:103]
s_waitcnt lgkmcnt(2)
v_mfma_f32_16x16x32_bf16 v[88:91],a[112:115],v[104:107],v[88:91]
v_mfma_f32_16x16x32_bf16 v[92:95],a[112:115],v[108:111],v[92:95]
v_mfma_f32_16x16x32_bf16 v[96:99],a[120:123],v[104:107],v[96:99]
v_mfma_f32_16x16x32_bf16 v[100:103],a[120:123],v[108:111],v[100:103]
s_waitcnt lgkmcnt(0)
v_mfma_f32_16x16x32_bf16 v[88:91],a[116:119],v[112:115],v[88:91]
v_mfma_f32_16x16x32_bf16 v[92:95],a[116:119],v[116:119],v[92:95]
v_mfma_f32_16x16x32_bf16 v[96:99],a[124:127],v[112:115],v[96:99]
v_mfma_f32_16x16x32_bf16 v[100:103],a[124:127],v[116:119],v[100:103]
s_nop 3
v_cvt_pk_bf16_f32 v104,v88,v96
v_cvt_pk_bf16_f32 v105,v89,v97
v_cvt_pk_bf16_f32 v106,v90,v98
v_cvt_pk_bf16_f32 v107,v91,v99
v_cvt_pk_bf16_f32 v108,v92,v100
v_cvt_pk_bf16_f32 v109,v93,v101
v_cvt_pk_bf16_f32 v110,v94,v102
v_cvt_pk_bf16_f32 v111,v95,v103
buffer_store_dwordx4 v[104:107],v0,s[8:11],s63 offen sc1
buffer_store_dwordx4 v[108:111],v0,s[8:11],s64 offen sc1
s_waitcnt vmcnt(6)
s_barrier
s_add_u32 m0,s50,131072
s_nop 0
buffer_load_dwordx4 v20,s[8:11],s70 offen offset:0 sc1 lds
s_add_u32 m0,s50,135168
s_nop 0
buffer_load_dwordx4 v20,s[8:11],s71 offen offset:0 sc1 lds
s_add_u32 m0,s50,139008
s_nop 0
buffer_load_dwordx4 v20,s[8:11],s70 offen offset:256 sc1 lds
s_add_u32 m0,s50,143104
s_nop 0
buffer_load_dwordx4 v20,s[8:11],s71 offen offset:256 sc1 lds
s_add_u32 m0,s50,146944
s_nop 0
buffer_load_dwordx4 v20,s[8:11],s70 offen offset:512 sc1 lds
s_add_u32 m0,s50,151040
s_nop 0
buffer_load_dwordx4 v20,s[8:11],s71 offen offset:512 sc1 lds
s_lshl_b32 s59,s51,13
s_lshl2_add_u32 s59,s47,s59
s_add_u32 s59,s59,10487680
s_waitcnt vmcnt(0)
s_barrier
s_or_b32 s59,s59,s52
buffer_store_dword v17,off,s[8:11],s59 sc1
s_mov_b32 s72,0x80000000
s_mov_b32 s86,0
s_mov_b32 s19,1
s_mov_b32 s18,0
s_cmp_lt_u32 s31,64
s_cbranch_scc1 L_mo_35
L_mo_48:
s_mov_b32 s51,64
s_cmp_eq_u32 s47,31
s_cbranch_scc1 L_mf_59
v_and_b32 v9,15,v1
v_lshrrev_b32 v10,4,v1
v_and_b32 v124,1,v1
v_lshlrev_b32 v124,4,v124
v_mov_b32 v125,0xffff
v_lshlrev_b32 v125,v124,v125
v_lshrrev_b32 v124,2,v9
v_cmp_eq_u32 vcc,0,v124
s_nop 1
v_cndmask_b32 v12,0,v125,vcc
v_cmp_eq_u32 vcc,1,v124
s_nop 1
v_cndmask_b32 v13,0,v125,vcc
v_and_b32 v124,2,v1
v_cmp_eq_u32 vcc,0,v124
v_mov_b32 v14,0xeeee
v_mov_b32 v124,0x4444
v_cndmask_b32 v14,v14,v124,vcc
v_lshlrev_b32 v11,14,v10
v_lshl_add_u32 v11,v9,4,v11
s_lshl_b32 s65,s51,15
s_add_u32 s65,s65,92274688
s_lshl_b32 s62,s47,10
s_add_u32 s62,s62,s65
s_lshl_b32 s63,s47,16
s_lshl_b32 s60,s46,8
s_add_u32 s63,s63,s60
s_mov_b32 s4,s38
s_mov_b32 s5,s39
s_mov_b32 s6,1835008
s_mov_b32 s7,0x20000
buffer_load_dwordx4 v[24:27],v11,s[4:7],s63 offen offset:0
buffer_load_dwordx4 v[28:31],v11,s[4:7],s63 offen offset:1024
buffer_load_dwordx4 v[32:35],v11,s[4:7],s63 offen offset:2048
buffer_load_dwordx4 v[36:39],v11,s[4:7],s63 offen offset:3072
s_add_u32 s63,s63,4096
buffer_load_dwordx4 v[40:43],v11,s[4:7],s63 offen offset:0
buffer_load_dwordx4 v[44:47],v11,s[4:7],s63 offen offset:1024
buffer_load_dwordx4 v[48:51],v11,s[4:7],s63 offen offset:2048
buffer_load_dwordx4 v[52:55],v11,s[4:7],s63 offen offset:3072
s_add_u32 s63,s63,4096
buffer_load_dwordx4 v[56:59],v11,s[4:7],s63 offen offset:0
buffer_load_dwordx4 v[60:63],v11,s[4:7],s63 offen offset:1024
buffer_load_dwordx4 v[64:67],v11,s[4:7],s63 offen offset:2048
buffer_load_dwordx4 v[68:71],v11,s[4:7],s63 offen offset:3072
s_add_u32 s63,s63,4096
buffer_load_dwordx4 v[72:75],v11,s[4:7],s63 offen offset:0
buffer_load_dwordx4 v[76:79],v11,s[4:7],s63 offen offset:1024
buffer_load_dwordx4 v[80:83],v11,s[4:7],s63 offen offset:2048
buffer_load_dwordx4 v[84:87],v11,s[4:7],s63 offen offset:3072
buffer_load_dword v15,v0,s[8:11],s62 offen
ds_read_b128 a[0:3],v18 offset:0
ds_read_b128 a[4:7],v18 offset:1024
ds_read_b128 a[8:11],v18 offset:2048
ds_read_b128 a[12:15],v18 offset:3072
ds_read_b128 a[16:19],v18 offset:4096
ds_read_b128 a[20:23],v18 offset:5120
ds_read_b128 a[24:27],v18 offset:6144
ds_read_b128 a[28:31],v18 offset:7168
ds_read_b128 a[32:35],v18 offset:8192
ds_read_b128 a[36:39],v18 offset:9216
ds_read_b128 a[40:43],v18 offset:10240
ds_read_b128 a[44:47],v18 offset:11264
ds_read_b128 a[48:51],v18 offset:12288
ds_read_b128 a[52:55],v18 offset:13312
ds_read_b128 a[56:59],v18 offset:14336
ds_read_b128 a[60:63],v18 offset:15360
ds_read_b128 a[64:67],v18 offset:16384
ds_read_b128 a[68:71],v18 offset:17408
ds_read_b128 a[72:75],v18 offset:18432
ds_read_b128 a[76:79],v18 offset:19456
ds_read_b128 a[80:83],v18 offset:20480
ds_read_b128 a[84:87],v18 offset:21504
ds_read_b128 a[88:91],v18 offset:22528
ds_read_b128 a[92:95],v18 offset:23552
ds_read_b128 a[96:99],v18 offset:24576
ds_read_b128 a[100:103],v18 offset:25600
ds_read_b128 a[104:107],v18 offset:26624
ds_read_b128 a[108:111],v18 offset:27648
ds_read_b128 a[112:115],v18 offset:28672
ds_read_b128 a[116:119],v18 offset:29696
ds_read_b128 a[120:123],v18 offset:30720
ds_read_b128 a[124:127],v18 offset:31744
s_add_u32 s59,s62,32768
buffer_load_dword v15,v0,s[8:11],s59 offen
s_add_u32 s59,s62,65536
buffer_load_dword v15,v0,s[8:11],s59 offen
s_add_u32 s59,s62,98304
buffer_load_dword v15,v0,s[8:11],s59 offen
s_add_u32 s59,s62,131072
buffer_load_dword v15,v0,s[8:11],s59 offen
s_add_u32 s59,s62,163840
buffer_load_dword v15,v0,s[8:11],s59 offen
L_mf_60:
s_lshl_b32 s59,s51,13
s_lshl_b32 s61,s46,7
s_add_u32 s59,s59,s61
s_add_u32 s59,s59,10486272
L_ww_65:
s_sleep 1
buffer_load_dword v2,off,s[8:11],s59 sc1
s_sub_u32 s49,s49,1
s_cbranch_scc1 L_abort
s_waitcnt vmcnt(0)
v_readfirstlane_b32 s55,v2
s_cmp_eq_u32 s55,0
s_cbranch_scc1 L_ww_65
L_wwd_66:
s_cmp_eq_u32 s55,1
s_cbranch_scc1 L_mf_61
s_barrier
s_andn2_b32 s64,0x7ff,s55
s_lshl_b32 s56,s64,10
s_add_u32 s58,s56,6291456
buffer_load_dwordx4 v[88:91],v0,s[8:11],s58 offen sc1
s_lshl_b32 s57,s46,11
s_add_u32 s57,s57,139264
v_add_u32 v8,s57,v0
v_and_b32 v2,1,v10
v_lshrrev_b32 v3,1,v10
v_lshlrev_b32 v2,7,v2
v_lshl_add_u32 v2,v3,10,v2
s_lshl_b32 s59,s46,8
s_add_u32 s59,s57,s59
v_add_u32 v2,s59,v2
s_mov_b32 s60,0x01000100
s_mov_b32 s61,0x03020302
s_waitcnt vmcnt(0)
v_lshlrev_b32 v96,16,v88
v_and_b32 v97,0xffff0000,v88
v_lshlrev_b32 v98,16,v89
v_and_b32 v99,0xffff0000,v89
v_lshlrev_b32 v100,16,v90
v_and_b32 v101,0xffff0000,v90
v_lshlrev_b32 v102,16,v91
v_and_b32 v103,0xffff0000,v91
v_readfirstlane_b32 s78,v96
s_nop 1
v_pk_add_f32 v[108:109],v[96:97],s[78:79] op_sel_hi:[1,0] neg_lo:[0,1] neg_hi:[0,1]
v_pk_add_f32 v[110:111],v[98:99],s[78:79] op_sel_hi:[1,0] neg_lo:[0,1] neg_hi:[0,1]
v_pk_add_f32 v[112:113],v[100:101],s[78:79] op_sel_hi:[1,0] neg_lo:[0,1] neg_hi:[0,1]
v_pk_add_f32 v[114:115],v[102:103],s[78:79] op_sel_hi:[1,0] neg_lo:[0,1] neg_hi:[0,1]
v_pk_add_f32 v[116:117],v[108:109],v[110:111]
v_pk_mul_f32 v[118:119],v[108:109],v[108:109]
v_pk_add_f32 v[120:121],v[112:113],v[114:115]
v_pk_fma_f32 v[118:119],v[110:111],v[110:111],v[118:119]
v_pk_add_f32 v[116:117],v[116:117],v[120:121]
v_pk_fma_f32 v[118:119],v[112:113],v[112:113],v[118:119]
v_add_f32 v116,v116,v117
v_pk_fma_f32 v[118:119],v[114:115],v[114:115],v[118:119]
v_add_f32 v118,v118,v119
s_nop 1
v_permlane32_swap_b32 v116,v118
v_add_f32 v116,v116,v118
s_nop 1
v_add_f32_dpp v116,v116,v116 row_ror:8 row_mask:0xf bank_mask:0xf
s_nop 1
v_add_f32_dpp v116,v116,v116 row_ror:4 row_mask:0xf bank_mask:0xf
s_nop 1
v_add_f32_dpp v116,v116,v116 row_ror:2 row_mask:0xf bank_mask:0xf
s_nop 1
v_add_f32_dpp v116,v116,v116 row_ror:1 row_mask:0xf bank_mask:0xf
v_mov_b32 v118,v116
s_nop 1
v_permlane16_swap_b32 v116,v118
v_add_f32 v116,v116,v118
v_mul_f32 v116,0x3b000000,v116
v_mov_b32 v118,v116
s_nop 1
v_permlane32_swap_b32 v116,v118
v_fma_f32 v118,-v116,v116,v118
v_add_f32 v116,s78,v116
v_max_f32 v118,0,v118
v_cvt_pk_bf16_f32 v118,v116,v118
v_lshlrev_b32 v116,16,v118
v_and_b32 v118,0xffff0000,v118
v_add_f32 v118,0x3727c5ac,v118
v_cvt_pk_bf16_f32 v118,v118,v118
v_and_b32 v118,0xffff0000,v118
v_sqrt_f32 v118,v118
v_pk_add_f32 v[108:109],v[96:97],v[116:117] op_sel_hi:[1,0] neg_lo:[0,1] neg_hi:[0,1]
v_pk_add_f32 v[110:111],v[98:99],v[116:117] op_sel_hi:[1,0] neg_lo:[0,1] neg_hi:[0,1]
v_pk_add_f32 v[112:113],v[100:101],v[116:117] op_sel_hi:[1,0] neg_lo:[0,1] neg_hi:[0,1]
v_pk_add_f32 v[114:115],v[102:103],v[116:117] op_sel_hi:[1,0] neg_lo:[0,1] neg_hi:[0,1]
v_cvt_pk_bf16_f32 v118,v118,v118
v_and_b32 v118,0xffff0000,v118
v_rcp_f32 v118,v118
v_cvt_pk_bf16_f32 v104,v108,v109
v_cvt_pk_bf16_f32 v105,v110,v111
v_cvt_pk_bf16_f32 v106,v112,v113
v_cvt_pk_bf16_f32 v107,v114,v115
v_lshlrev_b32 v108,16,v104
v_and_b32 v109,0xffff0000,v104
v_lshlrev_b32 v110,16,v105
v_and_b32 v111,0xffff0000,v105
v_lshlrev_b32 v112,16,v106
v_and_b32 v113,0xffff0000,v106
v_lshlrev_b32 v114,16,v107
v_and_b32 v115,0xffff0000,v107
v_pk_mul_f32 v[108:109],v[108:109],v[118:119] op_sel_hi:[1,0]
v_pk_mul_f32 v[110:111],v[110:111],v[118:119] op_sel_hi:[1,0]
v_pk_mul_f32 v[112:113],v[112:113],v[118:119] op_sel_hi:[1,0]
v_pk_mul_f32 v[114:115],v[114:115],v[118:119] op_sel_hi:[1,0]
v_cvt_pk_bf16_f32 v104,v108,v109
v_cvt_pk_bf16_f32 v105,v110,v111
v_cvt_pk_bf16_f32 v106,v112,v113
v_cvt_pk_bf16_f32 v107,v114,v115
v_perm_b32 v88,v104,v104,s60
v_perm_b32 v89,v105,v105,s60
v_perm_b32 v90,v106,v106,s60
v_perm_b32 v91,v107,v107,s60
ds_write_b128 v8,v[88:91]
v_perm_b32 v92,v104,v104,s61
v_perm_b32 v93,v105,v105,s61
v_perm_b32 v94,v106,v106,s61
v_perm_b32 v95,v107,v107,s61
ds_write_b128 v8,v[92:95] offset:1024
s_mov_b32 s58,s57
ds_read_b128 v[128:131],v2 offset:0
ds_read_b128 v[144:147],v2 offset:64
ds_read_b128 v[132:135],v2 offset:16
ds_read_b128 v[148:151],v2 offset:80
ds_read_b128 v[136:139],v2 offset:32
ds_read_b128 v[152:155],v2 offset:96
ds_read_b128 v[140:143],v2 offset:48
ds_read_b128 v[156:159],v2 offset:112
v_mov_b64 v[116:117],0
v_mov_b64 v[118:119],0
s_waitcnt lgkmcnt(6)
v_and_b32 v120,v12,v128
v_and_b32 v121,v13,v128
v_and_b32 v122,v12,v144
v_and_b32 v123,v13,v144
v_and_b32 v124,v12,v129
v_and_b32 v125,v13,v129
v_smfmac_f32_16x16x64_bf16 v[116:119],v[120:123],a[0:7],v14
v_and_b32 v126,v12,v145
v_and_b32 v127,v13,v145
v_and_b32 v120,v12,v130
v_and_b32 v121,v13,v130
v_smfmac_f32_16x16x64_bf16 v[116:119],v[124:127],a[8:15],v14
v_and_b32 v122,v12,v146
v_and_b32 v123,v13,v146
v_and_b32 v124,v12,v131
v_and_b32 v125,v13,v131
v_smfmac_f32_16x16x64_bf16 v[116:119],v[120:123],a[16:23],v14
v_and_b32 v126,v12,v147
v_and_b32 v127,v13,v147
s_waitcnt lgkmcnt(4)
v_and_b32 v120,v12,v132
v_and_b32 v121,v13,v132
v_smfmac_f32_16x16x64_bf16 v[116:119],v[124:127],a[24:31],v14
v_and_b32 v122,v12,v148
v_and_b32 v123,v13,v148
v_and_b32 v124,v12,v133
v_and_b32 v125,v13,v133
v_smfmac_f32_16x16x64_bf16 v[116:119],v[120:123],a[32:39],v14
v_and_b32 v126,v12,v149
v_and_b32 v127,v13,v149
v_and_b32 v120,v12,v134
v_and_b32 v121,v13,v134
v_smfmac_f32_16x16x64_bf16 v[116:119],v[124:127],a[40:47],v14
v_and_b32 v122,v12,v150
v_and_b32 v123,v13,v150
v_and_b32 v124,v12,v135
v_and_b32 v125,v13,v135
v_smfmac_f32_16x16x64_bf16 v[116:119],v[120:123],a[48:55],v14
v_and_b32 v126,v12,v151
v_and_b32 v127,v13,v151
s_waitcnt lgkmcnt(2)
v_and_b32 v120,v12,v136
v_and_b32 v121,v13,v136
v_smfmac_f32_16x16x64_bf16 v[116:119],v[124:127],a[56:63],v14
v_and_b32 v122,v12,v152
v_and_b32 v123,v13,v152
v_and_b32 v124,v12,v137
v_and_b32 v125,v13,v137
v_smfmac_f32_16x16x64_bf16 v[116:119],v[120:123],a[64:71],v14
v_and_b32 v126,v12,v153
v_and_b32 v127,v13,v153
v_and_b32 v120,v12,v138
v_and_b32 v121,v13,v138
v_smfmac_f32_16x16x64_bf16 v[116:119],v[124:127],a[72:79],v14
v_and_b32 v122,v12,v154
v_and_b32 v123,v13,v154
v_and_b32 v124,v12,v139
v_and_b32 v125,v13,v139
v_smfmac_f32_16x16x64_bf16 v[116:119],v[120:123],a[80:87],v14
v_and_b32 v126,v12,v155
v_and_b32 v127,v13,v155
s_waitcnt lgkmcnt(0)
v_and_b32 v120,v12,v140
v_and_b32 v121,v13,v140
v_smfmac_f32_16x16x64_bf16 v[116:119],v[124:127],a[88:95],v14
v_and_b32 v122,v12,v156
v_and_b32 v123,v13,v156
v_and_b32 v124,v12,v141
v_and_b32 v125,v13,v141
v_smfmac_f32_16x16x64_bf16 v[116:119],v[120:123],a[96:103],v14
v_and_b32 v126,v12,v157
v_and_b32 v127,v13,v157
v_and_b32 v120,v12,v142
v_and_b32 v121,v13,v142
v_smfmac_f32_16x16x64_bf16 v[116:119],v[124:127],a[104:111],v14
v_and_b32 v122,v12,v158
v_and_b32 v123,v13,v158
v_and_b32 v124,v12,v143
v_and_b32 v125,v13,v143
v_smfmac_f32_16x16x64_bf16 v[116:119],v[120:123],a[112:119],v14
v_and_b32 v126,v12,v159
v_and_b32 v127,v13,v159
s_nop 1
v_smfmac_f32_16x16x64_bf16 v[116:119],v[124:127],a[120:127],v14
v_lshlrev_b32 v8,5,v9
v_and_b32 v124,1,v10
v_lshl_add_u32 v8,v124,4,v8
v_lshrrev_b32 v124,1,v10
v_lshl_add_u32 v8,v124,11,v8
s_lshl_b32 s60,s46,9
s_add_u32 s60,s60,147456
v_add_u32 v8,s60,v8
ds_write_b128 v8,v[116:119]
v_lshlrev_b32 v8,2,v1
v_add_u32 v8,147456,v8
v_and_b32 v2,1,v1
v_lshrrev_b32 v3,1,v1
v_lshlrev_b32 v3,2,v3
v_lshl_add_u32 v2,v2,7,v3
v_add_u32 v2,s58,v2
v_lshlrev_b32 v3,6,v10
v_add_u32 v3,s58,v3
s_waitcnt lgkmcnt(0)
s_barrier
ds_read2st64_b32 v[88:89],v8 offset0:0 offset1:1
ds_read2st64_b32 v[90:91],v8 offset0:2 offset1:3
ds_read2st64_b32 v[92:93],v8 offset0:4 offset1:5
ds_read2st64_b32 v[94:95],v8 offset0:6 offset1:7
s_waitcnt lgkmcnt(0)
v_pk_add_f32 v[88:89],v[88:89],v[90:91]
v_pk_add_f32 v[92:93],v[92:93],v[94:95]
v_pk_add_f32 v[88:89],v[88:89],v[92:93]
v_cvt_pk_bf16_f32 v88,v88,v88
v_and_b32 v88,0xffff0000,v88
v_cvt_pk_bf16_f32 v89,v89,v89
v_and_b32 v89,0xffff0000,v89
v_mul_f32 v90,0xbfb8aa3b,v88
v_exp_f32 v90,v90
s_nop 0
v_add_f32 v90,1.0,v90
v_rcp_f32 v90,v90
s_nop 0
v_mul_f32 v88,v88,v90
v_cvt_pk_bf16_f32 v88,v88,v88
v_and_b32 v88,0xffff0000,v88
v_mul_f32 v88,v88,v89
v_cvt_pk_bf16_f32 v88,v88,v88
ds_write_b32 v2,v88
ds_read_b128 v[88:91],v3
ds_read_b128 v[108:111],v3 offset:32
ds_read_b128 v[92:95],v3 offset:16
ds_read_b128 v[112:115],v3 offset:48
v_mov_b64 v[116:117],0
v_mov_b64 v[118:119],0
s_waitcnt vmcnt(0) lgkmcnt(0)
v_and_b32 v120,v12,v88
v_and_b32 v121,v13,v88
v_and_b32 v122,v12,v108
v_and_b32 v123,v13,v108
v_and_b32 v124,v12,v89
v_and_b32 v125,v13,v89
v_smfmac_f32_16x16x64_bf16 v[116:119],v[120:123],v[24:31],v14
v_and_b32 v126,v12,v109
v_and_b32 v127,v13,v109
v_and_b32 v120,v12,v90
v_and_b32 v121,v13,v90
v_smfmac_f32_16x16x64_bf16 v[116:119],v[124:127],v[32:39],v14
v_and_b32 v122,v12,v110
v_and_b32 v123,v13,v110
v_and_b32 v124,v12,v91
v_and_b32 v125,v13,v91
v_smfmac_f32_16x16x64_bf16 v[116:119],v[120:123],v[40:47],v14
v_and_b32 v126,v12,v111
v_and_b32 v127,v13,v111
v_and_b32 v120,v12,v92
v_and_b32 v121,v13,v92
v_smfmac_f32_16x16x64_bf16 v[116:119],v[124:127],v[48:55],v14
v_and_b32 v122,v12,v112
v_and_b32 v123,v13,v112
v_and_b32 v124,v12,v93
v_and_b32 v125,v13,v93
v_smfmac_f32_16x16x64_bf16 v[116:119],v[120:123],v[56:63],v14
v_and_b32 v126,v12,v113
v_and_b32 v127,v13,v113
v_and_b32 v120,v12,v94
v_and_b32 v121,v13,v94
v_smfmac_f32_16x16x64_bf16 v[116:119],v[124:127],v[64:71],v14
v_and_b32 v122,v12,v114
v_and_b32 v123,v13,v114
v_and_b32 v124,v12,v95
v_and_b32 v125,v13,v95
v_smfmac_f32_16x16x64_bf16 v[116:119],v[120:123],v[72:79],v14
v_and_b32 v126,v12,v115
v_and_b32 v127,v13,v115
s_nop 1
v_smfmac_f32_16x16x64_bf16 v[116:119],v[124:127],v[80:87],v14
v_lshlrev_b32 v8,4,v9
v_and_b32 v124,1,v10
v_lshl_add_u32 v8,v124,3,v8
v_and_b32 v124,2,v10
v_lshl_add_u32 v8,v124,30,v8
s_lshl_b32 s60,s46,8
s_add_u32 s59,s62,s60
s_nop 0
v_cvt_pk_bf16_f32 v88,v116,v117
v_cvt_pk_bf16_f32 v89,v118,v119
buffer_store_dwordx2 v[88:89],v8,s[8:11],s59 offen
s_lshl_b32 s59,s51,13
s_lshl2_add_u32 s59,s47,s59
s_add_u32 s59,s59,10486912
s_waitcnt vmcnt(0)
s_barrier
s_or_b32 s59,s59,s52
buffer_store_dword v17,off,s[8:11],s59
s_cmp_lg_u32 s47,0
s_cbranch_scc1 L_moed_67
s_lshl_b32 s59,s51,13
s_add_u32 s59,s59,10486912
v_and_b32 v124,31,v1
v_lshlrev_b32 v124,2,v124
L_fw_68:
buffer_load_dword v125,v124,s[8:11],s59 offen sc1
s_sub_u32 s49,s49,1
s_cbranch_scc1 L_abort
s_waitcnt vmcnt(0)
v_cmp_eq_u32 vcc,0,v125
s_cbranch_vccnz L_fw_68
s_add_u32 s63,s65,0
buffer_load_dwordx4 v[168:171],v22,s[8:11],s63 offen sc1
s_add_u32 s63,s65,4096
buffer_load_dwordx4 v[172:175],v22,s[8:11],s63 offen sc1
s_add_u32 s63,s65,8192
buffer_load_dwordx4 v[176:179],v22,s[8:11],s63 offen sc1
s_add_u32 s63,s65,12288
buffer_load_dwordx4 v[180:183],v22,s[8:11],s63 offen sc1
s_add_u32 s63,s65,16384
buffer_load_dwordx4 v[184:187],v22,s[8:11],s63 offen sc1
s_add_u32 s63,s65,20480
buffer_load_dwordx4 v[188:191],v22,s[8:11],s63 offen sc1
s_add_u32 s63,s65,24576
buffer_load_dwordx4 v[192:195],v22,s[8:11],s63 offen sc1
s_add_u32 s63,s65,28672
buffer_load_dwordx4 v[196:199],v22,s[8:11],s63 offen sc1
v_and_b32 v208,15,v1
v_and_b32 v209,1,v1
v_lshlrev_b32 v209,4,v209
v_mov_b32 v210,0x3f80
v_lshlrev_b32 v210,v209,v210
v_lshrrev_b32 v208,1,v208
v_cmp_eq_u32 vcc,0,v208
s_nop 1
v_cndmask_b32 v200,0,v210,vcc
v_cmp_eq_u32 vcc,1,v208
s_nop 1
v_cndmask_b32 v201,0,v210,vcc
v_cmp_eq_u32 vcc,2,v208
s_nop 1
v_cndmask_b32 v202,0,v210,vcc
v_cmp_eq_u32 vcc,3,v208
s_nop 1
v_cndmask_b32 v203,0,v210,vcc
s_waitcnt vmcnt(7)
s_nop 0
v_mfma_f32_16x16x32_bf16 v[204:207],v[200:203],v[168:171],0
s_waitcnt vmcnt(6)
v_mfma_f32_16x16x32_bf16 v[204:207],v[200:203],v[172:175],v[204:207]
s_waitcnt vmcnt(5)
v_mfma_f32_16x16x32_bf16 v[204:207],v[200:203],v[176:179],v[204:207]
s_waitcnt vmcnt(4)
v_mfma_f32_16x16x32_bf16 v[204:207],v[200:203],v[180:183],v[204:207]
s_waitcnt vmcnt(3)
v_mfma_f32_16x16x32_bf16 v[204:207],v[200:203],v[184:187],v[204:207]
s_waitcnt vmcnt(2)
v_mfma_f32_16x16x32_bf16 v[204:207],v[200:203],v[188:191],v[204:207]
s_waitcnt vmcnt(1)
v_mfma_f32_16x16x32_bf16 v[204:207],v[200:203],v[192:195],v[204:207]
s_waitcnt vmcnt(0)
v_mfma_f32_16x16x32_bf16 v[204:207],v[200:203],v[196:199],v[204:207]
s_nop 7
ds_write_b128 v21,v[204:207]
s_waitcnt lgkmcnt(0)
s_barrier
s_cmp_lg_u32 s46,0
s_cbranch_scc1 L_moed_67
v_lshlrev_b32 v200,5,v1
v_add_u32 v200,155648,v200
ds_read_b128 v[168:171],v200
ds_read_b128 v[172:175],v200 offset:16
s_and_b32 s59,s55,0xffff0000
s_xor_b32 s60,s59,0x80000000
s_xor_b32 s61,s59,0xffff0000
s_cmp_lt_i32 s59,0
s_cselect_b32 s59,s60,s61
v_mov_b32 v200,s59
v_mul_f32 v200,0xbfb8aa3b,v200
v_exp_f32 v200,v200
s_nop 0
v_add_f32 v200,1.0,v200
v_rcp_f32 v200,v200
s_nop 0
v_cvt_pk_bf16_f32 v200,v200,v200
v_and_b32 v200,0xffff0000,v200
v_lshlrev_b32 v192,16,v104
v_and_b32 v193,0xffff0000,v104
v_lshlrev_b32 v194,16,v105
v_and_b32 v195,0xffff0000,v105
v_lshlrev_b32 v196,16,v106
v_and_b32 v197,0xffff0000,v106
v_lshlrev_b32 v198,16,v107
v_and_b32 v199,0xffff0000,v107
s_waitcnt lgkmcnt(0)
v_cvt_pk_bf16_f32 v184,v168,v169
v_cvt_pk_bf16_f32 v185,v170,v171
v_cvt_pk_bf16_f32 v186,v172,v173
v_cvt_pk_bf16_f32 v187,v174,v175
v_lshlrev_b32 v168,16,v184
v_and_b32 v169,0xffff0000,v184
v_lshlrev_b32 v170,16,v185
v_and_b32 v171,0xffff0000,v185
v_lshlrev_b32 v172,16,v186
v_and_b32 v173,0xffff0000,v186
v_lshlrev_b32 v174,16,v187
v_and_b32 v175,0xffff0000,v187
v_pk_mul_f32 v[168:169],v[168:169],v[200:201] op_sel_hi:[1,0]
v_pk_mul_f32 v[170:171],v[170:171],v[200:201] op_sel_hi:[1,0]
v_pk_mul_f32 v[172:173],v[172:173],v[200:201] op_sel_hi:[1,0]
v_pk_mul_f32 v[174:175],v[174:175],v[200:201] op_sel_hi:[1,0]
v_cvt_pk_bf16_f32 v184,v168,v169
v_cvt_pk_bf16_f32 v185,v170,v171
v_cvt_pk_bf16_f32 v186,v172,v173
v_cvt_pk_bf16_f32 v187,v174,v175
v_lshlrev_b32 v168,16,v184
v_and_b32 v169,0xffff0000,v184
v_lshlrev_b32 v170,16,v185
v_and_b32 v171,0xffff0000,v185
v_lshlrev_b32 v172,16,v186
v_and_b32 v173,0xffff0000,v186
v_lshlrev_b32 v174,16,v187
v_and_b32 v175,0xffff0000,v187
v_pk_add_f32 v[168:169],v[168:169],v[192:193]
v_pk_add_f32 v[170:171],v[170:171],v[194:195]
v_pk_add_f32 v[172:173],v[172:173],v[196:197]
v_pk_add_f32 v[174:175],v[174:175],v[198:199]
v_cvt_pk_bf16_f32 v184,v168,v169
v_cvt_pk_bf16_f32 v185,v170,v171
v_cvt_pk_bf16_f32 v186,v172,v173
v_cvt_pk_bf16_f32 v187,v174,v175
v_lshlrev_b32 v168,16,v184
v_and_b32 v169,0xffff0000,v184
v_lshlrev_b32 v170,16,v185
v_and_b32 v171,0xffff0000,v185
v_lshlrev_b32 v172,16,v186
v_and_b32 v173,0xffff0000,v186
v_lshlrev_b32 v174,16,v187
v_and_b32 v175,0xffff0000,v187
v_pk_add_f32 v[96:97],v[96:97],v[168:169]
v_pk_add_f32 v[98:99],v[98:99],v[170:171]
v_pk_add_f32 v[100:101],v[100:101],v[172:173]
v_pk_add_f32 v[102:103],v[102:103],v[174:175]
v_cvt_pk_bf16_f32 v160,v96,v97
v_cvt_pk_bf16_f32 v161,v98,v99
v_cvt_pk_bf16_f32 v162,v100,v101
v_cvt_pk_bf16_f32 v163,v102,v103
L_moed_67:
s_add_u32 s51,s51,1
s_add_u32 s62,s62,32768
s_add_u32 s65,s65,32768
s_branch L_mf_60
L_mf_61:
s_mov_b32 s4,s40
s_mov_b32 s5,s41
s_mov_b32 s6,2097152
s_mov_b32 s7,0x20000
s_or_b32 s61,s47,s46
s_cselect_b32 s56,0x80000000,s56
buffer_store_dwordx4 v[160:163],v0,s[4:7],s56 offen sc1
s_waitcnt vmcnt(0)
s_endpgm
L_mf_59:
s_cmp_lg_u32 s46,0
s_cbranch_scc1 L_mf_64
v_mov_b64 v[24:25],0
v_mov_b64 v[26:27],0
s_mov_b32 s56,94403584
buffer_store_dwordx4 v[24:27],v0,s[8:11],s56 offen
s_mov_b32 s56,94436352
buffer_store_dwordx4 v[24:27],v0,s[8:11],s56 offen
s_mov_b32 s56,94469120
buffer_store_dwordx4 v[24:27],v0,s[8:11],s56 offen
s_mov_b32 s56,94501888
buffer_store_dwordx4 v[24:27],v0,s[8:11],s56 offen
s_mov_b32 s56,94534656
buffer_store_dwordx4 v[24:27],v0,s[8:11],s56 offen
s_mov_b32 s56,94567424
buffer_store_dwordx4 v[24:27],v0,s[8:11],s56 offen
s_andn2_b32 s61,0x7ff,s54
s_lshr_b32 s61,s61,5
s_mov_b32 s59,11018240
v_lshlrev_b32 v2,2,v1
L_fp_71:
s_sleep 2
buffer_load_dword v3,v2,s[8:11],s59 offen sc1
s_sub_u32 s49,s49,1
s_cbranch_scc1 L_abort
s_waitcnt vmcnt(0)
v_cmp_eq_u32 vcc,0,v3
s_cbranch_vccnz L_fp_71
v_cmp_le_u32 vcc,s61,v1
s_nop 1
v_cndmask_b32 v2,1,2,vcc
v_cmp_ne_u32 s[84:85],v2,v3
s_mov_b32 s56,11011324
buffer_store_dword v17,off,s[8:11],s56
s_mov_b32 s56,11019516
buffer_store_dword v17,off,s[8:11],s56
s_mov_b32 s56,11027708
buffer_store_dword v17,off,s[8:11],s56
s_mov_b32 s56,11035900
buffer_store_dword v17,off,s[8:11],s56
s_mov_b32 s56,11044092
buffer_store_dword v17,off,s[8:11],s56
s_mov_b32 s56,11052284
buffer_store_dword v17,off,s[8:11],s56
v_lshrrev_b32 v2,3,v1
v_and_b32 v3,0x70,v0
v_lshl_add_u32 v3,v2,13,v3
s_lshr_b64 s[20:21],s[84:85],0
v_lshrrev_b32 v60,v2,s20
v_and_b32 v60,1,v60
v_mul_u32_u24 v60,768,v60
v_sub_u32 v60,v3,v60
v_add_u32 v60,10487296,v60
s_lshr_b64 s[20:21],s[84:85],8
v_lshrrev_b32 v61,v2,s20
v_and_b32 v61,1,v61
v_mul_u32_u24 v61,768,v61
v_sub_u32 v61,v3,v61
v_add_u32 v61,10552832,v61
s_lshr_b64 s[20:21],s[84:85],16
v_lshrrev_b32 v62,v2,s20
v_and_b32 v62,1,v62
v_mul_u32_u24 v62,768,v62
v_sub_u32 v62,v3,v62
v_add_u32 v62,10618368,v62
s_lshr_b64 s[20:21],s[84:85],24
v_lshrrev_b32 v63,v2,s20
v_and_b32 v63,1,v63
v_mul_u32_u24 v63,768,v63
v_sub_u32 v63,v3,v63
v_add_u32 v63,10683904,v63
s_lshr_b64 s[20:21],s[84:85],32
v_lshrrev_b32 v64,v2,s20
v_and_b32 v64,1,v64
v_mul_u32_u24 v64,768,v64
v_sub_u32 v64,v3,v64
v_add_u32 v64,10749440,v64
s_lshr_b64 s[20:21],s[84:85],40
v_lshrrev_b32 v65,v2,s20
v_and_b32 v65,1,v65
v_mul_u32_u24 v65,768,v65
v_sub_u32 v65,v3,v65
v_add_u32 v65,10814976,v65
s_lshr_b64 s[20:21],s[84:85],48
v_lshrrev_b32 v66,v2,s20
v_and_b32 v66,1,v66
v_mul_u32_u24 v66,768,v66
v_sub_u32 v66,v3,v66
v_add_u32 v66,10880512,v66
s_lshr_b64 s[20:21],s[84:85],56
v_lshrrev_b32 v67,v2,s20
v_and_b32 v67,1,v67
v_mul_u32_u24 v67,768,v67
v_sub_u32 v67,v3,v67
v_add_u32 v67,10946048,v67
v_and_b32 v68,3,v1
v_lshlrev_b32 v68,7,v68
v_add_u32 v68,10486272,v68
v_and_b32 v69,31,v1
v_lshlrev_b32 v69,2,v69
v_add_u32 v69,10478720,v69
s_mov_b32 s66,0
s_mov_b32 s67,524288
v_mov_b32 v57,0
s_mov_b32 s58,1
L_mf_62:
s_sub_u32 s49,s49,1
s_cbranch_scc1 L_abort
s_mov_b32 s57,0
s_cmp_lg_u32 s58,0
s_cbranch_scc1 L_ms_72
buffer_load_dwordx4 v[52:55],v67,s[8:11],0 offen sc1
buffer_load_dword v70,v69,s[8:11],s67 offen sc1
s_branch L_mj_73
L_ms_72:
buffer_load_dwordx4 v[24:27],v60,s[8:11],0 offen sc1
buffer_load_dwordx4 v[28:31],v61,s[8:11],0 offen sc1
buffer_load_dwordx4 v[32:35],v62,s[8:11],0 offen sc1
buffer_load_dwordx4 v[36:39],v63,s[8:11],0 offen sc1
buffer_load_dwordx4 v[40:43],v64,s[8:11],0 offen sc1
buffer_load_dwordx4 v[44:47],v65,s[8:11],0 offen sc1
buffer_load_dwordx4 v[48:51],v66,s[8:11],0 offen sc1
buffer_load_dwordx4 v[52:55],v67,s[8:11],0 offen sc1
buffer_load_dword v70,v69,s[8:11],s67 offen sc1
s_waitcnt vmcnt(8)
v_min3_u32 v56,v24,v25,v26
v_max3_u32 v57,v24,v25,v57
v_min_u32 v56,v27,v56
v_max3_u32 v57,v26,v27,v57
v_cmp_eq_u32 vcc,0,v56
s_bcnt1_i32_b64 s56,vcc
s_add_u32 s57,s57,s56
s_waitcnt vmcnt(7)
v_min3_u32 v56,v28,v29,v30
v_max3_u32 v57,v28,v29,v57
v_min_u32 v56,v31,v56
v_max3_u32 v57,v30,v31,v57
v_cmp_eq_u32 vcc,0,v56
s_bcnt1_i32_b64 s56,vcc
s_add_u32 s57,s57,s56
s_waitcnt vmcnt(6)
v_min3_u32 v56,v32,v33,v34
v_max3_u32 v57,v32,v33,v57
v_min_u32 v56,v35,v56
v_max3_u32 v57,v34,v35,v57
v_cmp_eq_u32 vcc,0,v56
s_bcnt1_i32_b64 s56,vcc
s_add_u32 s57,s57,s56
s_waitcnt vmcnt(5)
v_min3_u32 v56,v36,v37,v38
v_max3_u32 v57,v36,v37,v57
v_min_u32 v56,v39,v56
v_max3_u32 v57,v38,v39,v57
v_cmp_eq_u32 vcc,0,v56
s_bcnt1_i32_b64 s56,vcc
s_add_u32 s57,s57,s56
s_waitcnt vmcnt(4)
v_min3_u32 v56,v40,v41,v42
v_max3_u32 v57,v40,v41,v57
v_min_u32 v56,v43,v56
v_max3_u32 v57,v42,v43,v57
v_cmp_eq_u32 vcc,0,v56
s_bcnt1_i32_b64 s56,vcc
s_add_u32 s57,s57,s56
s_waitcnt vmcnt(3)
v_min3_u32 v56,v44,v45,v46
v_max3_u32 v57,v44,v45,v57
v_min_u32 v56,v47,v56
v_max3_u32 v57,v46,v47,v57
v_cmp_eq_u32 vcc,0,v56
s_bcnt1_i32_b64 s56,vcc
s_add_u32 s57,s57,s56
s_waitcnt vmcnt(2)
v_min3_u32 v56,v48,v49,v50
v_max3_u32 v57,v48,v49,v57
v_min_u32 v56,v51,v56
v_max3_u32 v57,v50,v51,v57
v_cmp_eq_u32 vcc,0,v56
s_bcnt1_i32_b64 s56,vcc
s_add_u32 s57,s57,s56
s_mov_b32 s58,s57
L_mj_73:
s_waitcnt vmcnt(1)
v_min3_u32 v56,v52,v53,v54
v_max3_u32 v57,v52,v53,v57
v_min_u32 v56,v55,v56
v_max3_u32 v57,v54,v55,v57
v_cmp_eq_u32 vcc,0,v56
s_bcnt1_i32_b64 s56,vcc
s_add_u32 s57,s57,s56
v_max_u32_dpp v57,v57,v57 row_ror:8 row_mask:0xf bank_mask:0xf
s_nop 1
v_max_u32_dpp v57,v57,v57 row_ror:4 row_mask:0xf bank_mask:0xf
s_nop 1
v_max_u32_dpp v57,v57,v57 row_ror:2 row_mask:0xf bank_mask:0xf
s_nop 1
v_max_u32_dpp v57,v57,v57 row_ror:1 row_mask:0xf bank_mask:0xf
v_mov_b32 v58,v57
s_nop 1
v_permlane16_swap_b32 v57,v58
v_max_u32 v57,v57,v58
v_mov_b32 v58,v57
s_nop 1
v_permlane32_swap_b32 v57,v58
v_max_u32 v57,v57,v58
s_nop 0
v_readfirstlane_b32 s55,v57
s_cmp_lg_u32 s55,s66
s_cbranch_scc1 L_mf_63
s_cmp_lg_u32 s57,0
s_cbranch_scc1 L_mf_62
v_mov_b32 v57,1
buffer_store_dword v57,v68,s[8:11],s67 offen
L_mf_64:
s_waitcnt vmcnt(0)
s_endpgm
L_mf_63:
s_waitcnt vmcnt(0)
v_cmp_eq_u32 vcc,0,v70
s_cmp_eq_u32 s66,0
s_cselect_b32 s56,0,vcc_lo
s_cmp_gt_u32 s57,112
s_cselect_b32 s56,1,s56
s_cmp_ge_u32 s67,565248
s_cselect_b32 s56,1,s56
s_cmp_eq_u32 s57,0
s_cselect_b32 s56,0,s56
s_cmp_lg_u32 s56,0
s_cbranch_scc1 L_mf_62
buffer_store_dword v57,v68,s[8:11],s67 offen
s_mov_b32 s66,s55
s_add_u32 s67,s67,8192
s_branch L_mf_62
s_endpgm
L_abort:
s_endpgm
L_spread:
s_mov_b32 s3,-1
s_lshr_b32 s48,s2,5
s_and_b32 s47,s2,31
s_branch L_roles
L_ra_6:
s_and_b32 s56,s48,1
s_lshl_b32 s56,s56,12
s_add_u32 s56,s56,s50
s_and_b32 s57,s47,15
s_lshl_b32 s57,s57,13
s_add_u32 s56,s56,s57
s_mov_b32 s4,s22
s_mov_b32 s5,s23
s_mov_b32 s6,4194304
s_mov_b32 s7,0x20000
s_add_u32 s57,s56,0
buffer_load_dwordx4 v[72:75],v0,s[4:7],s57 offen
s_add_u32 s57,s56,131072
buffer_load_dwordx4 v[72:75],v0,s[4:7],s57 offen
s_add_u32 s57,s56,262144
buffer_load_dwordx4 v[72:75],v0,s[4:7],s57 offen
s_add_u32 s57,s56,393216
buffer_load_dwordx4 v[72:75],v0,s[4:7],s57 offen
s_add_u32 s57,s56,524288
buffer_load_dwordx4 v[72:75],v0,s[4:7],s57 offen
s_add_u32 s57,s56,655360
buffer_load_dwordx4 v[72:75],v0,s[4:7],s57 offen
s_add_u32 s57,s56,786432
buffer_load_dwordx4 v[72:75],v0,s[4:7],s57 offen
s_add_u32 s57,s56,917504
buffer_load_dwordx4 v[72:75],v0,s[4:7],s57 offen
s_cmp_eq_u32 s53,0
s_cbranch_scc1 L_m0_74
s_waitcnt vmcnt(16)
v_lshlrev_b32 v32,16,v24
v_and_b32 v33,0xffff0000,v24
v_lshlrev_b32 v34,16,v25
v_and_b32 v35,0xffff0000,v25
v_lshlrev_b32 v36,16,v26
v_and_b32 v37,0xffff0000,v26
v_lshlrev_b32 v38,16,v27
v_and_b32 v39,0xffff0000,v27
v_readfirstlane_b32 s78,v32
s_nop 1
v_pk_add_f32 v[48:49],v[32:33],s[78:79] op_sel_hi:[1,0] neg_lo:[0,1] neg_hi:[0,1]
v_pk_add_f32 v[50:51],v[34:35],s[78:79] op_sel_hi:[1,0] neg_lo:[0,1] neg_hi:[0,1]
v_pk_add_f32 v[52:53],v[36:37],s[78:79] op_sel_hi:[1,0] neg_lo:[0,1] neg_hi:[0,1]
v_pk_add_f32 v[54:55],v[38:39],s[78:79] op_sel_hi:[1,0] neg_lo:[0,1] neg_hi:[0,1]
v_pk_add_f32 v[56:57],v[48:49],v[50:51]
v_pk_mul_f32 v[58:59],v[48:49],v[48:49]
v_pk_add_f32 v[60:61],v[52:53],v[54:55]
v_pk_fma_f32 v[58:59],v[50:51],v[50:51],v[58:59]
v_pk_add_f32 v[56:57],v[56:57],v[60:61]
v_pk_fma_f32 v[58:59],v[52:53],v[52:53],v[58:59]
v_add_f32 v56,v56,v57
v_pk_fma_f32 v[58:59],v[54:55],v[54:55],v[58:59]
v_add_f32 v58,v58,v59
s_nop 1
v_permlane32_swap_b32 v56,v58
v_add_f32 v56,v56,v58
s_nop 1
v_add_f32_dpp v56,v56,v56 row_ror:8 row_mask:0xf bank_mask:0xf
s_nop 1
v_add_f32_dpp v56,v56,v56 row_ror:4 row_mask:0xf bank_mask:0xf
s_nop 1
v_add_f32_dpp v56,v56,v56 row_ror:2 row_mask:0xf bank_mask:0xf
s_nop 1
v_add_f32_dpp v56,v56,v56 row_ror:1 row_mask:0xf bank_mask:0xf
v_mov_b32 v58,v56
s_nop 1
v_permlane16_swap_b32 v56,v58
v_add_f32 v56,v56,v58
v_mul_f32 v56,0x3b000000,v56
v_mov_b32 v58,v56
s_nop 1
v_permlane32_swap_b32 v56,v58
v_fma_f32 v58,-v56,v56,v58
v_add_f32 v56,s78,v56
v_max_f32 v58,0,v58
v_cvt_pk_bf16_f32 v58,v56,v58
v_lshlrev_b32 v56,16,v58
v_and_b32 v58,0xffff0000,v58
v_add_f32 v58,0x3727c5ac,v58
v_cvt_pk_bf16_f32 v58,v58,v58
v_and_b32 v58,0xffff0000,v58
v_sqrt_f32 v58,v58
v_pk_add_f32 v[48:49],v[32:33],v[56:57] op_sel_hi:[1,0] neg_lo:[0,1] neg_hi:[0,1]
v_pk_add_f32 v[50:51],v[34:35],v[56:57] op_sel_hi:[1,0] neg_lo:[0,1] neg_hi:[0,1]
v_pk_add_f32 v[52:53],v[36:37],v[56:57] op_sel_hi:[1,0] neg_lo:[0,1] neg_hi:[0,1]
v_pk_add_f32 v[54:55],v[38:39],v[56:57] op_sel_hi:[1,0] neg_lo:[0,1] neg_hi:[0,1]
v_cvt_pk_bf16_f32 v58,v58,v58
v_and_b32 v58,0xffff0000,v58
v_rcp_f32 v58,v58
v_cvt_pk_bf16_f32 v40,v48,v49
v_cvt_pk_bf16_f32 v41,v50,v51
v_cvt_pk_bf16_f32 v42,v52,v53
v_cvt_pk_bf16_f32 v43,v54,v55
v_lshlrev_b32 v48,16,v40
v_and_b32 v49,0xffff0000,v40
v_lshlrev_b32 v50,16,v41
v_and_b32 v51,0xffff0000,v41
v_lshlrev_b32 v52,16,v42
v_and_b32 v53,0xffff0000,v42
v_lshlrev_b32 v54,16,v43
v_and_b32 v55,0xffff0000,v43
v_pk_mul_f32 v[48:49],v[48:49],v[58:59] op_sel_hi:[1,0]
v_pk_mul_f32 v[50:51],v[50:51],v[58:59] op_sel_hi:[1,0]
v_pk_mul_f32 v[52:53],v[52:53],v[58:59] op_sel_hi:[1,0]
v_pk_mul_f32 v[54:55],v[54:55],v[58:59] op_sel_hi:[1,0]
v_cvt_pk_bf16_f32 v40,v48,v49
v_cvt_pk_bf16_f32 v41,v50,v51
v_cvt_pk_bf16_f32 v42,v52,v53
v_cvt_pk_bf16_f32 v43,v54,v55
buffer_store_dwordx4 v[40:43],v0,s[8:11],s65 offen offset:0 sc1
v_lshlrev_b32 v32,16,v28
v_and_b32 v33,0xffff0000,v28
v_lshlrev_b32 v34,16,v29
v_and_b32 v35,0xffff0000,v29
v_lshlrev_b32 v36,16,v30
v_and_b32 v37,0xffff0000,v30
v_lshlrev_b32 v38,16,v31
v_and_b32 v39,0xffff0000,v31
v_readfirstlane_b32 s78,v32
s_nop 1
v_pk_add_f32 v[48:49],v[32:33],s[78:79] op_sel_hi:[1,0] neg_lo:[0,1] neg_hi:[0,1]
v_pk_add_f32 v[50:51],v[34:35],s[78:79] op_sel_hi:[1,0] neg_lo:[0,1] neg_hi:[0,1]
v_pk_add_f32 v[52:53],v[36:37],s[78:79] op_sel_hi:[1,0] neg_lo:[0,1] neg_hi:[0,1]
v_pk_add_f32 v[54:55],v[38:39],s[78:79] op_sel_hi:[1,0] neg_lo:[0,1] neg_hi:[0,1]
v_pk_add_f32 v[56:57],v[48:49],v[50:51]
v_pk_mul_f32 v[58:59],v[48:49],v[48:49]
v_pk_add_f32 v[60:61],v[52:53],v[54:55]
v_pk_fma_f32 v[58:59],v[50:51],v[50:51],v[58:59]
v_pk_add_f32 v[56:57],v[56:57],v[60:61]
v_pk_fma_f32 v[58:59],v[52:53],v[52:53],v[58:59]
v_add_f32 v56,v56,v57
v_pk_fma_f32 v[58:59],v[54:55],v[54:55],v[58:59]
v_add_f32 v58,v58,v59
s_nop 1
v_permlane32_swap_b32 v56,v58
v_add_f32 v56,v56,v58
s_nop 1
v_add_f32_dpp v56,v56,v56 row_ror:8 row_mask:0xf bank_mask:0xf
s_nop 1
v_add_f32_dpp v56,v56,v56 row_ror:4 row_mask:0xf bank_mask:0xf
s_nop 1
v_add_f32_dpp v56,v56,v56 row_ror:2 row_mask:0xf bank_mask:0xf
s_nop 1
v_add_f32_dpp v56,v56,v56 row_ror:1 row_mask:0xf bank_mask:0xf
v_mov_b32 v58,v56
s_nop 1
v_permlane16_swap_b32 v56,v58
v_add_f32 v56,v56,v58
v_mul_f32 v56,0x3b000000,v56
v_mov_b32 v58,v56
s_nop 1
v_permlane32_swap_b32 v56,v58
v_fma_f32 v58,-v56,v56,v58
v_add_f32 v56,s78,v56
v_max_f32 v58,0,v58
v_cvt_pk_bf16_f32 v58,v56,v58
v_lshlrev_b32 v56,16,v58
v_and_b32 v58,0xffff0000,v58
v_add_f32 v58,0x3727c5ac,v58
v_cvt_pk_bf16_f32 v58,v58,v58
v_and_b32 v58,0xffff0000,v58
v_sqrt_f32 v58,v58
v_pk_add_f32 v[48:49],v[32:33],v[56:57] op_sel_hi:[1,0] neg_lo:[0,1] neg_hi:[0,1]
v_pk_add_f32 v[50:51],v[34:35],v[56:57] op_sel_hi:[1,0] neg_lo:[0,1] neg_hi:[0,1]
v_pk_add_f32 v[52:53],v[36:37],v[56:57] op_sel_hi:[1,0] neg_lo:[0,1] neg_hi:[0,1]
v_pk_add_f32 v[54:55],v[38:39],v[56:57] op_sel_hi:[1,0] neg_lo:[0,1] neg_hi:[0,1]
v_cvt_pk_bf16_f32 v58,v58,v58
v_and_b32 v58,0xffff0000,v58
v_rcp_f32 v58,v58
v_cvt_pk_bf16_f32 v44,v48,v49
v_cvt_pk_bf16_f32 v45,v50,v51
v_cvt_pk_bf16_f32 v46,v52,v53
v_cvt_pk_bf16_f32 v47,v54,v55
v_lshlrev_b32 v48,16,v44
v_and_b32 v49,0xffff0000,v44
v_lshlrev_b32 v50,16,v45
v_and_b32 v51,0xffff0000,v45
v_lshlrev_b32 v52,16,v46
v_and_b32 v53,0xffff0000,v46
v_lshlrev_b32 v54,16,v47
v_and_b32 v55,0xffff0000,v47
v_pk_mul_f32 v[48:49],v[48:49],v[58:59] op_sel_hi:[1,0]
v_pk_mul_f32 v[50:51],v[50:51],v[58:59] op_sel_hi:[1,0]
v_pk_mul_f32 v[52:53],v[52:53],v[58:59] op_sel_hi:[1,0]
v_pk_mul_f32 v[54:55],v[54:55],v[58:59] op_sel_hi:[1,0]
v_cvt_pk_bf16_f32 v44,v48,v49
v_cvt_pk_bf16_f32 v45,v50,v51
v_cvt_pk_bf16_f32 v46,v52,v53
v_cvt_pk_bf16_f32 v47,v54,v55
buffer_store_dwordx4 v[44:47],v0,s[8:11],s65 offen offset:1024 sc1
s_cmp_ge_u32 s2,2
s_cbranch_scc1 L_m0_74
v_lshrrev_b32 v12,3,v1
v_lshlrev_b32 v12,9,v12
v_and_b32 v13,7,v1
v_lshl_add_u32 v12,v13,4,v12
s_lshl_b32 s66,s2,2
s_add_u32 s66,s66,s46
s_and_b32 s67,s66,1
s_lshl_b32 s67,s67,8
s_and_b32 s68,s66,2
s_lshl_b32 s68,s68,6
s_add_u32 s67,s67,s68
s_and_b32 s68,s66,4
s_lshl_b32 s68,s68,10
s_add_u32 s67,s67,s68
s_add_u32 s68,s67,11534336
buffer_store_dwordx4 v[64:67],v12,s[8:11],s68 offen sc1
s_add_u32 s68,s67,12582912
buffer_store_dwordx4 v[64:67],v12,s[8:11],s68 offen sc1
s_add_u32 s68,s67,17825792
buffer_store_dwordx4 v[64:67],v12,s[8:11],s68 offen sc1
L_m0_74:
s_waitcnt vmcnt(7)
s_add_u32 s57,s56,1048576
buffer_load_dwordx4 v[72:75],v0,s[4:7],s57 offen
s_waitcnt vmcnt(7)
s_add_u32 s57,s56,1179648
buffer_load_dwordx4 v[72:75],v0,s[4:7],s57 offen
s_waitcnt vmcnt(7)
s_add_u32 s57,s56,1310720
buffer_load_dwordx4 v[72:75],v0,s[4:7],s57 offen
s_waitcnt vmcnt(7)
s_add_u32 s57,s56,1441792
buffer_load_dwordx4 v[72:75],v0,s[4:7],s57 offen
s_waitcnt vmcnt(7)
s_add_u32 s57,s56,1572864
buffer_load_dwordx4 v[72:75],v0,s[4:7],s57 offen
s_waitcnt vmcnt(7)
s_add_u32 s57,s56,1703936
buffer_load_dwordx4 v[72:75],v0,s[4:7],s57 offen
s_waitcnt vmcnt(7)
s_add_u32 s57,s56,1835008
buffer_load_dwordx4 v[72:75],v0,s[4:7],s57 offen
s_waitcnt vmcnt(7)
s_add_u32 s57,s56,1966080
buffer_load_dwordx4 v[72:75],v0,s[4:7],s57 offen
s_waitcnt vmcnt(7)
s_add_u32 s57,s56,2097152
buffer_load_dwordx4 v[72:75],v0,s[4:7],s57 offen
s_barrier
s_cmp_lg_u32 s46,0
s_cbranch_scc1 L_ar_75
v_mov_b32 v8,240
v_mov_b32 v9,s53
s_mov_b64 exec,1
buffer_atomic_add v9,v8,s[12:15],0 offen
s_mov_b64 exec,-1
L_ar_75:
s_mov_b32 s53,0
s_waitcnt vmcnt(7)
s_add_u32 s57,s56,2228224
buffer_load_dwordx4 v[72:75],v0,s[4:7],s57 offen
s_waitcnt vmcnt(7)
s_add_u32 s57,s56,2359296
buffer_load_dwordx4 v[72:75],v0,s[4:7],s57 offen
s_waitcnt vmcnt(7)
s_add_u32 s57,s56,2490368
buffer_load_dwordx4 v[72:75],v0,s[4:7],s57 offen
s_waitcnt vmcnt(7)
s_add_u32 s57,s56,2621440
buffer_load_dwordx4 v[72:75],v0,s[4:7],s57 offen
s_waitcnt vmcnt(7)
s_add_u32 s57,s56,2752512
buffer_load_dwordx4 v[72:75],v0,s[4:7],s57 offen
s_waitcnt vmcnt(7)
s_add_u32 s57,s56,2883584
buffer_load_dwordx4 v[72:75],v0,s[4:7],s57 offen
s_waitcnt vmcnt(7)
s_add_u32 s57,s56,3014656
buffer_load_dwordx4 v[72:75],v0,s[4:7],s57 offen
s_waitcnt vmcnt(7)
s_add_u32 s57,s56,3145728
buffer_load_dwordx4 v[72:75],v0,s[4:7],s57 offen
s_waitcnt vmcnt(7)
s_add_u32 s57,s56,3276800
buffer_load_dwordx4 v[72:75],v0,s[4:7],s57 offen
s_waitcnt vmcnt(7)
s_add_u32 s57,s56,3407872
buffer_load_dwordx4 v[72:75],v0,s[4:7],s57 offen
s_waitcnt vmcnt(7)
s_add_u32 s57,s56,3538944
buffer_load_dwordx4 v[72:75],v0,s[4:7],s57 offen
s_waitcnt vmcnt(7)
s_add_u32 s57,s56,3670016
buffer_load_dwordx4 v[72:75],v0,s[4:7],s57 offen
s_waitcnt vmcnt(7)
s_add_u32 s57,s56,3801088
buffer_load_dwordx4 v[72:75],v0,s[4:7],s57 offen
s_waitcnt vmcnt(7)
s_add_u32 s57,s56,3932160
buffer_load_dwordx4 v[72:75],v0,s[4:7],s57 offen
s_waitcnt vmcnt(7)
s_add_u32 s57,s56,4063232
buffer_load_dwordx4 v[72:75],v0,s[4:7],s57 offen
s_mov_b32 s4,s24
s_mov_b32 s5,s25
s_mov_b32 s6,4194304
s_mov_b32 s7,0x20000
s_waitcnt vmcnt(7)
s_add_u32 s57,s56,0
buffer_load_dwordx4 v[72:75],v0,s[4:7],s57 offen
s_waitcnt vmcnt(7)
s_add_u32 s57,s56,131072
buffer_load_dwordx4 v[72:75],v0,s[4:7],s57 offen
s_waitcnt vmcnt(7)
s_add_u32 s57,s56,262144
buffer_load_dwordx4 v[72:75],v0,s[4:7],s57 offen
s_waitcnt vmcnt(7)
s_add_u32 s57,s56,393216
buffer_load_dwordx4 v[72:75],v0,s[4:7],s57 offen
s_waitcnt vmcnt(7)
s_add_u32 s57,s56,524288
buffer_load_dwordx4 v[72:75],v0,s[4:7],s57 offen
s_waitcnt vmcnt(7)
s_add_u32 s57,s56,655360
buffer_load_dwordx4 v[72:75],v0,s[4:7],s57 offen
s_waitcnt vmcnt(7)
s_add_u32 s57,s56,786432
buffer_load_dwordx4 v[72:75],v0,s[4:7],s57 offen
s_waitcnt vmcnt(7)
s_add_u32 s57,s56,917504
buffer_load_dwordx4 v[72:75],v0,s[4:7],s57 offen
s_waitcnt vmcnt(7)
s_add_u32 s57,s56,1048576
buffer_load_dwordx4 v[72:75],v0,s[4:7],s57 offen
s_waitcnt vmcnt(7)
s_add_u32 s57,s56,1179648
buffer_load_dwordx4 v[72:75],v0,s[4:7],s57 offen
s_waitcnt vmcnt(7)
s_add_u32 s57,s56,1310720
buffer_load_dwordx4 v[72:75],v0,s[4:7],s57 offen
s_waitcnt vmcnt(7)
s_add_u32 s57,s56,1441792
buffer_load_dwordx4 v[72:75],v0,s[4:7],s57 offen
s_waitcnt vmcnt(7)
s_add_u32 s57,s56,1572864
buffer_load_dwordx4 v[72:75],v0,s[4:7],s57 offen
s_waitcnt vmcnt(7)
s_add_u32 s57,s56,1703936
buffer_load_dwordx4 v[72:75],v0,s[4:7],s57 offen
s_waitcnt vmcnt(7)
s_add_u32 s57,s56,1835008
buffer_load_dwordx4 v[72:75],v0,s[4:7],s57 offen
s_waitcnt vmcnt(7)
s_add_u32 s57,s56,1966080
buffer_load_dwordx4 v[72:75],v0,s[4:7],s57 offen
s_waitcnt vmcnt(7)
s_add_u32 s57,s56,2097152
buffer_load_dwordx4 v[72:75],v0,s[4:7],s57 offen
s_waitcnt vmcnt(7)
s_add_u32 s57,s56,2228224
buffer_load_dwordx4 v[72:75],v0,s[4:7],s57 offen
s_waitcnt vmcnt(7)
s_add_u32 s57,s56,2359296
buffer_load_dwordx4 v[72:75],v0,s[4:7],s57 offen
s_waitcnt vmcnt(7)
s_add_u32 s57,s56,2490368
buffer_load_dwordx4 v[72:75],v0,s[4:7],s57 offen
s_waitcnt vmcnt(7)
s_add_u32 s57,s56,2621440
buffer_load_dwordx4 v[72:75],v0,s[4:7],s57 offen
s_waitcnt vmcnt(7)
s_add_u32 s57,s56,2752512
buffer_load_dwordx4 v[72:75],v0,s[4:7],s57 offen
s_waitcnt vmcnt(7)
s_add_u32 s57,s56,2883584
buffer_load_dwordx4 v[72:75],v0,s[4:7],s57 offen
s_waitcnt vmcnt(7)
s_add_u32 s57,s56,3014656
buffer_load_dwordx4 v[72:75],v0,s[4:7],s57 offen
s_waitcnt vmcnt(7)
s_add_u32 s57,s56,3145728
buffer_load_dwordx4 v[72:75],v0,s[4:7],s57 offen
s_waitcnt vmcnt(7)
s_add_u32 s57,s56,3276800
buffer_load_dwordx4 v[72:75],v0,s[4:7],s57 offen
s_waitcnt vmcnt(7)
s_add_u32 s57,s56,3407872
buffer_load_dwordx4 v[72:75],v0,s[4:7],s57 offen
s_waitcnt vmcnt(7)
s_add_u32 s57,s56,3538944
buffer_load_dwordx4 v[72:75],v0,s[4:7],s57 offen
s_waitcnt vmcnt(7)
s_add_u32 s57,s56,3670016
buffer_load_dwordx4 v[72:75],v0,s[4:7],s57 offen
s_waitcnt vmcnt(7)
s_add_u32 s57,s56,3801088
buffer_load_dwordx4 v[72:75],v0,s[4:7],s57 offen
s_waitcnt vmcnt(7)
s_add_u32 s57,s56,3932160
buffer_load_dwordx4 v[72:75],v0,s[4:7],s57 offen
s_waitcnt vmcnt(7)
s_add_u32 s57,s56,4063232
buffer_load_dwordx4 v[72:75],v0,s[4:7],s57 offen
s_mov_b32 s4,s20
s_mov_b32 s5,s21
s_mov_b32 s6,4194304
s_mov_b32 s7,0x20000
s_waitcnt vmcnt(7)
s_add_u32 s57,s56,0
buffer_load_dwordx4 v[72:75],v0,s[4:7],s57 offen
s_waitcnt vmcnt(7)
s_add_u32 s57,s56,131072
buffer_load_dwordx4 v[72:75],v0,s[4:7],s57 offen
s_waitcnt vmcnt(7)
s_add_u32 s57,s56,262144
buffer_load_dwordx4 v[72:75],v0,s[4:7],s57 offen
s_waitcnt vmcnt(7)
s_add_u32 s57,s56,393216
buffer_load_dwordx4 v[72:75],v0,s[4:7],s57 offen
s_waitcnt vmcnt(7)
s_add_u32 s57,s56,524288
buffer_load_dwordx4 v[72:75],v0,s[4:7],s57 offen
s_waitcnt vmcnt(7)
s_add_u32 s57,s56,655360
buffer_load_dwordx4 v[72:75],v0,s[4:7],s57 offen
s_waitcnt vmcnt(7)
s_add_u32 s57,s56,786432
buffer_load_dwordx4 v[72:75],v0,s[4:7],s57 offen
s_waitcnt vmcnt(7)
s_add_u32 s57,s56,917504
buffer_load_dwordx4 v[72:75],v0,s[4:7],s57 offen
s_waitcnt vmcnt(7)
s_add_u32 s57,s56,1048576
buffer_load_dwordx4 v[72:75],v0,s[4:7],s57 offen
s_waitcnt vmcnt(7)
s_add_u32 s57,s56,1179648
buffer_load_dwordx4 v[72:75],v0,s[4:7],s57 offen
s_waitcnt vmcnt(7)
s_add_u32 s57,s56,1310720
buffer_load_dwordx4 v[72:75],v0,s[4:7],s57 offen
s_waitcnt vmcnt(7)
s_add_u32 s57,s56,1441792
buffer_load_dwordx4 v[72:75],v0,s[4:7],s57 offen
s_waitcnt vmcnt(7)
s_add_u32 s57,s56,1572864
buffer_load_dwordx4 v[72:75],v0,s[4:7],s57 offen
s_waitcnt vmcnt(7)
s_add_u32 s57,s56,1703936
buffer_load_dwordx4 v[72:75],v0,s[4:7],s57 offen
s_waitcnt vmcnt(7)
s_add_u32 s57,s56,1835008
buffer_load_dwordx4 v[72:75],v0,s[4:7],s57 offen
s_waitcnt vmcnt(7)
s_add_u32 s57,s56,1966080
buffer_load_dwordx4 v[72:75],v0,s[4:7],s57 offen
s_waitcnt vmcnt(7)
s_add_u32 s57,s56,2097152
buffer_load_dwordx4 v[72:75],v0,s[4:7],s57 offen
s_waitcnt vmcnt(7)
s_add_u32 s57,s56,2228224
buffer_load_dwordx4 v[72:75],v0,s[4:7],s57 offen
s_waitcnt vmcnt(7)
s_add_u32 s57,s56,2359296
buffer_load_dwordx4 v[72:75],v0,s[4:7],s57 offen
s_waitcnt vmcnt(7)
s_add_u32 s57,s56,2490368
buffer_load_dwordx4 v[72:75],v0,s[4:7],s57 offen
s_waitcnt vmcnt(7)
s_add_u32 s57,s56,2621440
buffer_load_dwordx4 v[72:75],v0,s[4:7],s57 offen
s_waitcnt vmcnt(7)
s_add_u32 s57,s56,2752512
buffer_load_dwordx4 v[72:75],v0,s[4:7],s57 offen
s_waitcnt vmcnt(7)
s_add_u32 s57,s56,2883584
buffer_load_dwordx4 v[72:75],v0,s[4:7],s57 offen
s_waitcnt vmcnt(7)
s_add_u32 s57,s56,3014656
buffer_load_dwordx4 v[72:75],v0,s[4:7],s57 offen
s_waitcnt vmcnt(7)
s_add_u32 s57,s56,3145728
buffer_load_dwordx4 v[72:75],v0,s[4:7],s57 offen
s_waitcnt vmcnt(7)
s_add_u32 s57,s56,3276800
buffer_load_dwordx4 v[72:75],v0,s[4:7],s57 offen
s_waitcnt vmcnt(7)
s_add_u32 s57,s56,3407872
buffer_load_dwordx4 v[72:75],v0,s[4:7],s57 offen
s_waitcnt vmcnt(7)
s_add_u32 s57,s56,3538944
buffer_load_dwordx4 v[72:75],v0,s[4:7],s57 offen
s_waitcnt vmcnt(7)
s_add_u32 s57,s56,3670016
buffer_load_dwordx4 v[72:75],v0,s[4:7],s57 offen
s_waitcnt vmcnt(7)
s_add_u32 s57,s56,3801088
buffer_load_dwordx4 v[72:75],v0,s[4:7],s57 offen
s_waitcnt vmcnt(7)
s_add_u32 s57,s56,3932160
buffer_load_dwordx4 v[72:75],v0,s[4:7],s57 offen
s_waitcnt vmcnt(7)
s_add_u32 s57,s56,4063232
buffer_load_dwordx4 v[72:75],v0,s[4:7],s57 offen
L_rb_7:
s_mov_b32 s4,s26
s_mov_b32 s5,s27
s_mov_b32 s6,4194304
s_mov_b32 s7,0x20000
v_and_b32 v2,15,v1
v_lshlrev_b32 v2,4,v2
v_lshrrev_b32 v3,4,v1
v_lshl_add_u32 v2,v3,13,v2
s_and_b32 s56,s47,15
s_lshl_b32 s56,s56,18
s_lshl_b32 s57,s46,8
s_add_u32 s56,s56,s57
s_mov_b32 s61,0x05040100
s_mov_b32 s62,0x07060302
s_add_u32 s57,s56,0
buffer_load_dwordx4 v[24:27],v2,s[4:7],s57 offen offset:0
buffer_load_dwordx4 v[28:31],v2,s[4:7],s57 offen offset:1024
buffer_load_dwordx4 v[32:35],v2,s[4:7],s57 offen offset:2048
buffer_load_dwordx4 v[36:39],v2,s[4:7],s57 offen offset:3072
s_add_u32 s57,s56,4096
buffer_load_dwordx4 v[40:43],v2,s[4:7],s57 offen offset:0
buffer_load_dwordx4 v[44:47],v2,s[4:7],s57 offen offset:1024
buffer_load_dwordx4 v[48:51],v2,s[4:7],s57 offen offset:2048
buffer_load_dwordx4 v[52:55],v2,s[4:7],s57 offen offset:3072
s_add_u32 s57,s56,32768
buffer_load_dwordx4 v[56:59],v2,s[4:7],s57 offen offset:0
buffer_load_dwordx4 v[60:63],v2,s[4:7],s57 offen offset:1024
buffer_load_dwordx4 v[64:67],v2,s[4:7],s57 offen offset:2048
buffer_load_dwordx4 v[68:71],v2,s[4:7],s57 offen offset:3072
s_add_u32 s57,s56,36864
buffer_load_dwordx4 v[72:75],v2,s[4:7],s57 offen offset:0
buffer_load_dwordx4 v[76:79],v2,s[4:7],s57 offen offset:1024
buffer_load_dwordx4 v[80:83],v2,s[4:7],s57 offen offset:2048
buffer_load_dwordx4 v[84:87],v2,s[4:7],s57 offen offset:3072
s_add_u32 s57,s56,65536
buffer_load_dwordx4 v[88:91],v2,s[4:7],s57 offen offset:0
buffer_load_dwordx4 v[92:95],v2,s[4:7],s57 offen offset:1024
buffer_load_dwordx4 v[96:99],v2,s[4:7],s57 offen offset:2048
buffer_load_dwordx4 v[100:103],v2,s[4:7],s57 offen offset:3072
s_add_u32 s57,s56,69632
buffer_load_dwordx4 v[104:107],v2,s[4:7],s57 offen offset:0
buffer_load_dwordx4 v[108:111],v2,s[4:7],s57 offen offset:1024
buffer_load_dwordx4 v[112:115],v2,s[4:7],s57 offen offset:2048
buffer_load_dwordx4 v[116:119],v2,s[4:7],s57 offen offset:3072
s_add_u32 s57,s56,98304
buffer_load_dwordx4 v[120:123],v2,s[4:7],s57 offen offset:0
buffer_load_dwordx4 v[124:127],v2,s[4:7],s57 offen offset:1024
buffer_load_dwordx4 v[128:131],v2,s[4:7],s57 offen offset:2048
buffer_load_dwordx4 v[132:135],v2,s[4:7],s57 offen offset:3072
s_add_u32 s57,s56,102400
buffer_load_dwordx4 v[136:139],v2,s[4:7],s57 offen offset:0
buffer_load_dwordx4 v[140:143],v2,s[4:7],s57 offen offset:1024
buffer_load_dwordx4 v[144:147],v2,s[4:7],s57 offen offset:2048
buffer_load_dwordx4 v[148:151],v2,s[4:7],s57 offen offset:3072
s_add_u32 s57,s56,131072
buffer_load_dwordx4 v[152:155],v2,s[4:7],s57 offen offset:0
buffer_load_dwordx4 v[156:159],v2,s[4:7],s57 offen offset:1024
buffer_load_dwordx4 v[160:163],v2,s[4:7],s57 offen offset:2048
buffer_load_dwordx4 v[164:167],v2,s[4:7],s57 offen offset:3072
s_add_u32 s57,s56,135168
buffer_load_dwordx4 v[168:171],v2,s[4:7],s57 offen offset:0
buffer_load_dwordx4 v[172:175],v2,s[4:7],s57 offen offset:1024
buffer_load_dwordx4 v[176:179],v2,s[4:7],s57 offen offset:2048
buffer_load_dwordx4 v[180:183],v2,s[4:7],s57 offen offset:3072
s_add_u32 s57,s56,163840
buffer_load_dwordx4 v[184:187],v2,s[4:7],s57 offen offset:0
buffer_load_dwordx4 v[188:191],v2,s[4:7],s57 offen offset:1024
buffer_load_dwordx4 v[192:195],v2,s[4:7],s57 offen offset:2048
buffer_load_dwordx4 v[196:199],v2,s[4:7],s57 offen offset:3072
s_add_u32 s57,s56,167936
buffer_load_dwordx4 v[200:203],v2,s[4:7],s57 offen offset:0
buffer_load_dwordx4 v[204:207],v2,s[4:7],s57 offen offset:1024
buffer_load_dwordx4 v[208:211],v2,s[4:7],s57 offen offset:2048
buffer_load_dwordx4 v[212:215],v2,s[4:7],s57 offen offset:3072
s_waitcnt vmcnt(40)
v_perm_b32 v216,v28,v24,s61
v_perm_b32 v217,v36,v32,s61
v_perm_b32 v218,v44,v40,s61
v_perm_b32 v219,v52,v48,s61
v_accvgpr_write_b32 a0,v216
v_accvgpr_write_b32 a1,v217
v_accvgpr_write_b32 a2,v218
v_accvgpr_write_b32 a3,v219
v_perm_b32 v216,v28,v24,s62
v_perm_b32 v217,v36,v32,s62
v_perm_b32 v218,v44,v40,s62
v_perm_b32 v219,v52,v48,s62
v_accvgpr_write_b32 a4,v216
v_accvgpr_write_b32 a5,v217
v_accvgpr_write_b32 a6,v218
v_accvgpr_write_b32 a7,v219
v_perm_b32 v216,v29,v25,s61
v_perm_b32 v217,v37,v33,s61
v_perm_b32 v218,v45,v41,s61
v_perm_b32 v219,v53,v49,s61
v_accvgpr_write_b32 a8,v216
v_accvgpr_write_b32 a9,v217
v_accvgpr_write_b32 a10,v218
v_accvgpr_write_b32 a11,v219
v_perm_b32 v216,v29,v25,s62
v_perm_b32 v217,v37,v33,s62
v_perm_b32 v218,v45,v41,s62
v_perm_b32 v219,v53,v49,s62
v_accvgpr_write_b32 a12,v216
v_accvgpr_write_b32 a13,v217
v_accvgpr_write_b32 a14,v218
v_accvgpr_write_b32 a15,v219
v_perm_b32 v216,v30,v26,s61
v_perm_b32 v217,v38,v34,s61
v_perm_b32 v218,v46,v42,s61
v_perm_b32 v219,v54,v50,s61
v_accvgpr_write_b32 a16,v216
v_accvgpr_write_b32 a17,v217
v_accvgpr_write_b32 a18,v218
v_accvgpr_write_b32 a19,v219
v_perm_b32 v216,v30,v26,s62
v_perm_b32 v217,v38,v34,s62
v_perm_b32 v218,v46,v42,s62
v_perm_b32 v219,v54,v50,s62
v_accvgpr_write_b32 a20,v216
v_accvgpr_write_b32 a21,v217
v_accvgpr_write_b32 a22,v218
v_accvgpr_write_b32 a23,v219
v_perm_b32 v216,v31,v27,s61
v_perm_b32 v217,v39,v35,s61
v_perm_b32 v218,v47,v43,s61
v_perm_b32 v219,v55,v51,s61
v_accvgpr_write_b32 a24,v216
v_accvgpr_write_b32 a25,v217
v_accvgpr_write_b32 a26,v218
v_accvgpr_write_b32 a27,v219
v_perm_b32 v216,v31,v27,s62
v_perm_b32 v217,v39,v35,s62
v_perm_b32 v218,v47,v43,s62
v_perm_b32 v219,v55,v51,s62
v_accvgpr_write_b32 a28,v216
v_accvgpr_write_b32 a29,v217
v_accvgpr_write_b32 a30,v218
v_accvgpr_write_b32 a31,v219
s_add_u32 s57,s56,196608
buffer_load_dwordx4 v[24:27],v2,s[4:7],s57 offen offset:0
buffer_load_dwordx4 v[28:31],v2,s[4:7],s57 offen offset:1024
buffer_load_dwordx4 v[32:35],v2,s[4:7],s57 offen offset:2048
buffer_load_dwordx4 v[36:39],v2,s[4:7],s57 offen offset:3072
s_add_u32 s57,s56,200704
buffer_load_dwordx4 v[40:43],v2,s[4:7],s57 offen offset:0
buffer_load_dwordx4 v[44:47],v2,s[4:7],s57 offen offset:1024
buffer_load_dwordx4 v[48:51],v2,s[4:7],s57 offen offset:2048
buffer_load_dwordx4 v[52:55],v2,s[4:7],s57 offen offset:3072
s_barrier
s_cmp_lg_u32 s46,0
s_cbranch_scc1 L_ar_76
v_mov_b32 v8,240
v_mov_b32 v9,s53
s_mov_b64 exec,1
buffer_atomic_add v9,v8,s[12:15],0 offen
s_mov_b64 exec,-1
L_ar_76:
s_mov_b32 s53,0
s_waitcnt vmcnt(40)
v_perm_b32 v216,v60,v56,s61
v_perm_b32 v217,v68,v64,s61
v_perm_b32 v218,v76,v72,s61
v_perm_b32 v219,v84,v80,s61
v_accvgpr_write_b32 a32,v216
v_accvgpr_write_b32 a33,v217
v_accvgpr_write_b32 a34,v218
v_accvgpr_write_b32 a35,v219
v_perm_b32 v216,v60,v56,s62
v_perm_b32 v217,v68,v64,s62
v_perm_b32 v218,v76,v72,s62
v_perm_b32 v219,v84,v80,s62
v_accvgpr_write_b32 a36,v216
v_accvgpr_write_b32 a37,v217
v_accvgpr_write_b32 a38,v218
v_accvgpr_write_b32 a39,v219
v_perm_b32 v216,v61,v57,s61
v_perm_b32 v217,v69,v65,s61
v_perm_b32 v218,v77,v73,s61
v_perm_b32 v219,v85,v81,s61
v_accvgpr_write_b32 a40,v216
v_accvgpr_write_b32 a41,v217
v_accvgpr_write_b32 a42,v218
v_accvgpr_write_b32 a43,v219
v_perm_b32 v216,v61,v57,s62
v_perm_b32 v217,v69,v65,s62
v_perm_b32 v218,v77,v73,s62
v_perm_b32 v219,v85,v81,s62
v_accvgpr_write_b32 a44,v216
v_accvgpr_write_b32 a45,v217
v_accvgpr_write_b32 a46,v218
v_accvgpr_write_b32 a47,v219
v_perm_b32 v216,v62,v58,s61
v_perm_b32 v217,v70,v66,s61
v_perm_b32 v218,v78,v74,s61
v_perm_b32 v219,v86,v82,s61
v_accvgpr_write_b32 a48,v216
v_accvgpr_write_b32 a49,v217
v_accvgpr_write_b32 a50,v218
v_accvgpr_write_b32 a51,v219
v_perm_b32 v216,v62,v58,s62
v_perm_b32 v217,v70,v66,s62
v_perm_b32 v218,v78,v74,s62
v_perm_b32 v219,v86,v82,s62
v_accvgpr_write_b32 a52,v216
v_accvgpr_write_b32 a53,v217
v_accvgpr_write_b32 a54,v218
v_accvgpr_write_b32 a55,v219
v_perm_b32 v216,v63,v59,s61
v_perm_b32 v217,v71,v67,s61
v_perm_b32 v218,v79,v75,s61
v_perm_b32 v219,v87,v83,s61
v_accvgpr_write_b32 a56,v216
v_accvgpr_write_b32 a57,v217
v_accvgpr_write_b32 a58,v218
v_accvgpr_write_b32 a59,v219
v_perm_b32 v216,v63,v59,s62
v_perm_b32 v217,v71,v67,s62
v_perm_b32 v218,v79,v75,s62
v_perm_b32 v219,v87,v83,s62
v_accvgpr_write_b32 a60,v216
v_accvgpr_write_b32 a61,v217
v_accvgpr_write_b32 a62,v218
v_accvgpr_write_b32 a63,v219
s_add_u32 s57,s56,229376
buffer_load_dwordx4 v[56:59],v2,s[4:7],s57 offen offset:0
buffer_load_dwordx4 v[60:63],v2,s[4:7],s57 offen offset:1024
buffer_load_dwordx4 v[64:67],v2,s[4:7],s57 offen offset:2048
buffer_load_dwordx4 v[68:71],v2,s[4:7],s57 offen offset:3072
s_add_u32 s57,s56,233472
buffer_load_dwordx4 v[72:75],v2,s[4:7],s57 offen offset:0
buffer_load_dwordx4 v[76:79],v2,s[4:7],s57 offen offset:1024
buffer_load_dwordx4 v[80:83],v2,s[4:7],s57 offen offset:2048
buffer_load_dwordx4 v[84:87],v2,s[4:7],s57 offen offset:3072
s_waitcnt vmcnt(40)
v_perm_b32 v216,v92,v88,s61
v_perm_b32 v217,v100,v96,s61
v_perm_b32 v218,v108,v104,s61
v_perm_b32 v219,v116,v112,s61
v_accvgpr_write_b32 a64,v216
v_accvgpr_write_b32 a65,v217
v_accvgpr_write_b32 a66,v218
v_accvgpr_write_b32 a67,v219
v_perm_b32 v216,v92,v88,s62
v_perm_b32 v217,v100,v96,s62
v_perm_b32 v218,v108,v104,s62
v_perm_b32 v219,v116,v112,s62
v_accvgpr_write_b32 a68,v216
v_accvgpr_write_b32 a69,v217
v_accvgpr_write_b32 a70,v218
v_accvgpr_write_b32 a71,v219
v_perm_b32 v216,v93,v89,s61
v_perm_b32 v217,v101,v97,s61
v_perm_b32 v218,v109,v105,s61
v_perm_b32 v219,v117,v113,s61
v_accvgpr_write_b32 a72,v216
v_accvgpr_write_b32 a73,v217
v_accvgpr_write_b32 a74,v218
v_accvgpr_write_b32 a75,v219
v_perm_b32 v216,v93,v89,s62
v_perm_b32 v217,v101,v97,s62
v_perm_b32 v218,v109,v105,s62
v_perm_b32 v219,v117,v113,s62
v_accvgpr_write_b32 a76,v216
v_accvgpr_write_b32 a77,v217
v_accvgpr_write_b32 a78,v218
v_accvgpr_write_b32 a79,v219
v_perm_b32 v216,v94,v90,s61
v_perm_b32 v217,v102,v98,s61
v_perm_b32 v218,v110,v106,s61
v_perm_b32 v219,v118,v114,s61
v_accvgpr_write_b32 a80,v216
v_accvgpr_write_b32 a81,v217
v_accvgpr_write_b32 a82,v218
v_accvgpr_write_b32 a83,v219
v_perm_b32 v216,v94,v90,s62
v_perm_b32 v217,v102,v98,s62
v_perm_b32 v218,v110,v106,s62
v_perm_b32 v219,v118,v114,s62
v_accvgpr_write_b32 a84,v216
v_accvgpr_write_b32 a85,v217
v_accvgpr_write_b32 a86,v218
v_accvgpr_write_b32 a87,v219
v_perm_b32 v216,v95,v91,s61
v_perm_b32 v217,v103,v99,s61
v_perm_b32 v218,v111,v107,s61
v_perm_b32 v219,v119,v115,s61
v_accvgpr_write_b32 a88,v216
v_accvgpr_write_b32 a89,v217
v_accvgpr_write_b32 a90,v218
v_accvgpr_write_b32 a91,v219
v_perm_b32 v216,v95,v91,s62
v_perm_b32 v217,v103,v99,s62
v_perm_b32 v218,v111,v107,s62
v_perm_b32 v219,v119,v115,s62
v_accvgpr_write_b32 a92,v216
v_accvgpr_write_b32 a93,v217
v_accvgpr_write_b32 a94,v218
v_accvgpr_write_b32 a95,v219
s_waitcnt vmcnt(32)
v_perm_b32 v216,v124,v120,s61
v_perm_b32 v217,v132,v128,s61
v_perm_b32 v218,v140,v136,s61
v_perm_b32 v219,v148,v144,s61
v_accvgpr_write_b32 a96,v216
v_accvgpr_write_b32 a97,v217
v_accvgpr_write_b32 a98,v218
v_accvgpr_write_b32 a99,v219
v_perm_b32 v216,v124,v120,s62
v_perm_b32 v217,v132,v128,s62
v_perm_b32 v218,v140,v136,s62
v_perm_b32 v219,v148,v144,s62
v_accvgpr_write_b32 a100,v216
v_accvgpr_write_b32 a101,v217
v_accvgpr_write_b32 a102,v218
v_accvgpr_write_b32 a103,v219
v_perm_b32 v216,v125,v121,s61
v_perm_b32 v217,v133,v129,s61
v_perm_b32 v218,v141,v137,s61
v_perm_b32 v219,v149,v145,s61
v_accvgpr_write_b32 a104,v216
v_accvgpr_write_b32 a105,v217
v_accvgpr_write_b32 a106,v218
v_accvgpr_write_b32 a107,v219
v_perm_b32 v216,v125,v121,s62
v_perm_b32 v217,v133,v129,s62
v_perm_b32 v218,v141,v137,s62
v_perm_b32 v219,v149,v145,s62
v_accvgpr_write_b32 a108,v216
v_accvgpr_write_b32 a109,v217
v_accvgpr_write_b32 a110,v218
v_accvgpr_write_b32 a111,v219
v_perm_b32 v216,v126,v122,s61
v_perm_b32 v217,v134,v130,s61
v_perm_b32 v218,v142,v138,s61
v_perm_b32 v219,v150,v146,s61
v_accvgpr_write_b32 a112,v216
v_accvgpr_write_b32 a113,v217
v_accvgpr_write_b32 a114,v218
v_accvgpr_write_b32 a115,v219
v_perm_b32 v216,v126,v122,s62
v_perm_b32 v217,v134,v130,s62
v_perm_b32 v218,v142,v138,s62
v_perm_b32 v219,v150,v146,s62
v_accvgpr_write_b32 a116,v216
v_accvgpr_write_b32 a117,v217
v_accvgpr_write_b32 a118,v218
v_accvgpr_write_b32 a119,v219
v_perm_b32 v216,v127,v123,s61
v_perm_b32 v217,v135,v131,s61
v_perm_b32 v218,v143,v139,s61
v_perm_b32 v219,v151,v147,s61
v_accvgpr_write_b32 a120,v216
v_accvgpr_write_b32 a121,v217
v_accvgpr_write_b32 a122,v218
v_accvgpr_write_b32 a123,v219
v_perm_b32 v216,v127,v123,s62
v_perm_b32 v217,v135,v131,s62
v_perm_b32 v218,v143,v139,s62
v_perm_b32 v219,v151,v147,s62
v_accvgpr_write_b32 a124,v216
v_accvgpr_write_b32 a125,v217
v_accvgpr_write_b32 a126,v218
v_accvgpr_write_b32 a127,v219
s_waitcnt vmcnt(24)
v_perm_b32 v216,v156,v152,s61
v_perm_b32 v217,v164,v160,s61
v_perm_b32 v218,v172,v168,s61
v_perm_b32 v219,v180,v176,s61
v_accvgpr_write_b32 a128,v216
v_accvgpr_write_b32 a129,v217
v_accvgpr_write_b32 a130,v218
v_accvgpr_write_b32 a131,v219
v_perm_b32 v216,v156,v152,s62
v_perm_b32 v217,v164,v160,s62
v_perm_b32 v218,v172,v168,s62
v_perm_b32 v219,v180,v176,s62
v_accvgpr_write_b32 a132,v216
v_accvgpr_write_b32 a133,v217
v_accvgpr_write_b32 a134,v218
v_accvgpr_write_b32 a135,v219
v_perm_b32 v216,v157,v153,s61
v_perm_b32 v217,v165,v161,s61
v_perm_b32 v218,v173,v169,s61
v_perm_b32 v219,v181,v177,s61
v_accvgpr_write_b32 a136,v216
v_accvgpr_write_b32 a137,v217
v_accvgpr_write_b32 a138,v218
v_accvgpr_write_b32 a139,v219
v_perm_b32 v216,v157,v153,s62
v_perm_b32 v217,v165,v161,s62
v_perm_b32 v218,v173,v169,s62
v_perm_b32 v219,v181,v177,s62
v_accvgpr_write_b32 a140,v216
v_accvgpr_write_b32 a141,v217
v_accvgpr_write_b32 a142,v218
v_accvgpr_write_b32 a143,v219
v_perm_b32 v216,v158,v154,s61
v_perm_b32 v217,v166,v162,s61
v_perm_b32 v218,v174,v170,s61
v_perm_b32 v219,v182,v178,s61
v_accvgpr_write_b32 a144,v216
v_accvgpr_write_b32 a145,v217
v_accvgpr_write_b32 a146,v218
v_accvgpr_write_b32 a147,v219
v_perm_b32 v216,v158,v154,s62
v_perm_b32 v217,v166,v162,s62
v_perm_b32 v218,v174,v170,s62
v_perm_b32 v219,v182,v178,s62
v_accvgpr_write_b32 a148,v216
v_accvgpr_write_b32 a149,v217
v_accvgpr_write_b32 a150,v218
v_accvgpr_write_b32 a151,v219
v_perm_b32 v216,v159,v155,s61
v_perm_b32 v217,v167,v163,s61
v_perm_b32 v218,v175,v171,s61
v_perm_b32 v219,v183,v179,s61
v_accvgpr_write_b32 a152,v216
v_accvgpr_write_b32 a153,v217
v_accvgpr_write_b32 a154,v218
v_accvgpr_write_b32 a155,v219
v_perm_b32 v216,v159,v155,s62
v_perm_b32 v217,v167,v163,s62
v_perm_b32 v218,v175,v171,s62
v_perm_b32 v219,v183,v179,s62
v_accvgpr_write_b32 a156,v216
v_accvgpr_write_b32 a157,v217
v_accvgpr_write_b32 a158,v218
v_accvgpr_write_b32 a159,v219
s_waitcnt vmcnt(16)
v_perm_b32 v216,v188,v184,s61
v_perm_b32 v217,v196,v192,s61
v_perm_b32 v218,v204,v200,s61
v_perm_b32 v219,v212,v208,s61
v_accvgpr_write_b32 a160,v216
v_accvgpr_write_b32 a161,v217
v_accvgpr_write_b32 a162,v218
v_accvgpr_write_b32 a163,v219
v_perm_b32 v216,v188,v184,s62
v_perm_b32 v217,v196,v192,s62
v_perm_b32 v218,v204,v200,s62
v_perm_b32 v219,v212,v208,s62
v_accvgpr_write_b32 a164,v216
v_accvgpr_write_b32 a165,v217
v_accvgpr_write_b32 a166,v218
v_accvgpr_write_b32 a167,v219
v_perm_b32 v216,v189,v185,s61
v_perm_b32 v217,v197,v193,s61
v_perm_b32 v218,v205,v201,s61
v_perm_b32 v219,v213,v209,s61
v_accvgpr_write_b32 a168,v216
v_accvgpr_write_b32 a169,v217
v_accvgpr_write_b32 a170,v218
v_accvgpr_write_b32 a171,v219
v_perm_b32 v216,v189,v185,s62
v_perm_b32 v217,v197,v193,s62
v_perm_b32 v218,v205,v201,s62
v_perm_b32 v219,v213,v209,s62
v_accvgpr_write_b32 a172,v216
v_accvgpr_write_b32 a173,v217
v_accvgpr_write_b32 a174,v218
v_accvgpr_write_b32 a175,v219
v_perm_b32 v216,v190,v186,s61
v_perm_b32 v217,v198,v194,s61
v_perm_b32 v218,v206,v202,s61
v_perm_b32 v219,v214,v210,s61
v_accvgpr_write_b32 a176,v216
v_accvgpr_write_b32 a177,v217
v_accvgpr_write_b32 a178,v218
v_accvgpr_write_b32 a179,v219
v_perm_b32 v216,v190,v186,s62
v_perm_b32 v217,v198,v194,s62
v_perm_b32 v218,v206,v202,s62
v_perm_b32 v219,v214,v210,s62
v_accvgpr_write_b32 a180,v216
v_accvgpr_write_b32 a181,v217
v_accvgpr_write_b32 a182,v218
v_accvgpr_write_b32 a183,v219
v_perm_b32 v216,v191,v187,s61
v_perm_b32 v217,v199,v195,s61
v_perm_b32 v218,v207,v203,s61
v_perm_b32 v219,v215,v211,s61
v_accvgpr_write_b32 a184,v216
v_accvgpr_write_b32 a185,v217
v_accvgpr_write_b32 a186,v218
v_accvgpr_write_b32 a187,v219
v_perm_b32 v216,v191,v187,s62
v_perm_b32 v217,v199,v195,s62
v_perm_b32 v218,v207,v203,s62
v_perm_b32 v219,v215,v211,s62
v_accvgpr_write_b32 a188,v216
v_accvgpr_write_b32 a189,v217
v_accvgpr_write_b32 a190,v218
v_accvgpr_write_b32 a191,v219
s_waitcnt vmcnt(8)
v_perm_b32 v216,v28,v24,s61
v_perm_b32 v217,v36,v32,s61
v_perm_b32 v218,v44,v40,s61
v_perm_b32 v219,v52,v48,s61
v_accvgpr_write_b32 a192,v216
v_accvgpr_write_b32 a193,v217
v_accvgpr_write_b32 a194,v218
v_accvgpr_write_b32 a195,v219
v_perm_b32 v216,v28,v24,s62
v_perm_b32 v217,v36,v32,s62
v_perm_b32 v218,v44,v40,s62
v_perm_b32 v219,v52,v48,s62
v_accvgpr_write_b32 a196,v216
v_accvgpr_write_b32 a197,v217
v_accvgpr_write_b32 a198,v218
v_accvgpr_write_b32 a199,v219
v_perm_b32 v216,v29,v25,s61
v_perm_b32 v217,v37,v33,s61
v_perm_b32 v218,v45,v41,s61
v_perm_b32 v219,v53,v49,s61
v_accvgpr_write_b32 a200,v216
v_accvgpr_write_b32 a201,v217
v_accvgpr_write_b32 a202,v218
v_accvgpr_write_b32 a203,v219
v_perm_b32 v216,v29,v25,s62
v_perm_b32 v217,v37,v33,s62
v_perm_b32 v218,v45,v41,s62
v_perm_b32 v219,v53,v49,s62
v_accvgpr_write_b32 a204,v216
v_accvgpr_write_b32 a205,v217
v_accvgpr_write_b32 a206,v218
v_accvgpr_write_b32 a207,v219
v_perm_b32 v216,v30,v26,s61
v_perm_b32 v217,v38,v34,s61
v_perm_b32 v218,v46,v42,s61
v_perm_b32 v219,v54,v50,s61
v_accvgpr_write_b32 a208,v216
v_accvgpr_write_b32 a209,v217
v_accvgpr_write_b32 a210,v218
v_accvgpr_write_b32 a211,v219
v_perm_b32 v216,v30,v26,s62
v_perm_b32 v217,v38,v34,s62
v_perm_b32 v218,v46,v42,s62
v_perm_b32 v219,v54,v50,s62
v_accvgpr_write_b32 a212,v216
v_accvgpr_write_b32 a213,v217
v_accvgpr_write_b32 a214,v218
v_accvgpr_write_b32 a215,v219
v_perm_b32 v216,v31,v27,s61
v_perm_b32 v217,v39,v35,s61
v_perm_b32 v218,v47,v43,s61
v_perm_b32 v219,v55,v51,s61
v_accvgpr_write_b32 a216,v216
v_accvgpr_write_b32 a217,v217
v_accvgpr_write_b32 a218,v218
v_accvgpr_write_b32 a219,v219
v_perm_b32 v216,v31,v27,s62
v_perm_b32 v217,v39,v35,s62
v_perm_b32 v218,v47,v43,s62
v_perm_b32 v219,v55,v51,s62
v_accvgpr_write_b32 a220,v216
v_accvgpr_write_b32 a221,v217
v_accvgpr_write_b32 a222,v218
v_accvgpr_write_b32 a223,v219
s_waitcnt vmcnt(0)
v_perm_b32 v216,v60,v56,s61
v_perm_b32 v217,v68,v64,s61
v_perm_b32 v218,v76,v72,s61
v_perm_b32 v219,v84,v80,s61
v_accvgpr_write_b32 a224,v216
v_accvgpr_write_b32 a225,v217
v_accvgpr_write_b32 a226,v218
v_accvgpr_write_b32 a227,v219
v_perm_b32 v216,v60,v56,s62
v_perm_b32 v217,v68,v64,s62
v_perm_b32 v218,v76,v72,s62
v_perm_b32 v219,v84,v80,s62
v_accvgpr_write_b32 a228,v216
v_accvgpr_write_b32 a229,v217
v_accvgpr_write_b32 a230,v218
v_accvgpr_write_b32 a231,v219
v_perm_b32 v216,v61,v57,s61
v_perm_b32 v217,v69,v65,s61
v_perm_b32 v218,v77,v73,s61
v_perm_b32 v219,v85,v81,s61
v_accvgpr_write_b32 a232,v216
v_accvgpr_write_b32 a233,v217
v_accvgpr_write_b32 a234,v218
v_accvgpr_write_b32 a235,v219
v_perm_b32 v216,v61,v57,s62
v_perm_b32 v217,v69,v65,s62
v_perm_b32 v218,v77,v73,s62
v_perm_b32 v219,v85,v81,s62
v_accvgpr_write_b32 a236,v216
v_accvgpr_write_b32 a237,v217
v_accvgpr_write_b32 a238,v218
v_accvgpr_write_b32 a239,v219
v_perm_b32 v216,v62,v58,s61
v_perm_b32 v217,v70,v66,s61
v_perm_b32 v218,v78,v74,s61
v_perm_b32 v219,v86,v82,s61
v_accvgpr_write_b32 a240,v216
v_accvgpr_write_b32 a241,v217
v_accvgpr_write_b32 a242,v218
v_accvgpr_write_b32 a243,v219
v_perm_b32 v216,v62,v58,s62
v_perm_b32 v217,v70,v66,s62
v_perm_b32 v218,v78,v74,s62
v_perm_b32 v219,v86,v82,s62
v_accvgpr_write_b32 a244,v216
v_accvgpr_write_b32 a245,v217
v_accvgpr_write_b32 a246,v218
v_accvgpr_write_b32 a247,v219
v_perm_b32 v216,v63,v59,s61
v_perm_b32 v217,v71,v67,s61
v_perm_b32 v218,v79,v75,s61
v_perm_b32 v219,v87,v83,s61
v_accvgpr_write_b32 a248,v216
v_accvgpr_write_b32 a249,v217
v_accvgpr_write_b32 a250,v218
v_accvgpr_write_b32 a251,v219
v_perm_b32 v216,v63,v59,s62
v_perm_b32 v217,v71,v67,s62
v_perm_b32 v218,v79,v75,s62
v_perm_b32 v219,v87,v83,s62
v_accvgpr_write_b32 a252,v216
v_accvgpr_write_b32 a253,v217
v_accvgpr_write_b32 a254,v218
v_accvgpr_write_b32 a255,v219
v_mov_b32 v123,159744
s_cmp_lg_u32 s46,0
s_cbranch_scc1 L_gbd_78
v_mov_b32 v124,240
L_gb_77:
buffer_load_dword v125,v124,s[12:15],0 offen sc1
s_waitcnt vmcnt(0)
v_readfirstlane_b32 s56,v125
ds_write_b32 v123,v125
s_bitcmp1_b32 s56,8
s_cbranch_scc1 L_gbd_78
s_sleep 4
s_sub_u32 s49,s49,1
s_cmp_gt_i32 s49,0
s_cbranch_scc1 L_gb_77
s_branch L_abort
L_gbd_78:
s_waitcnt lgkmcnt(0)
s_barrier
ds_read_b32 v125,v123
s_waitcnt lgkmcnt(0)
v_readfirstlane_b32 s56,v125
s_barrier
s_lshr_b32 s56,s56,16
s_andn2_b32 s56,s56,s3
s_cbranch_scc1 L_spread
s_max_u32 s54,s48,5
s_sub_u32 s54,s54,5
s_lshl_b32 s54,s54,1
s_lshr_b32 s56,s47,4
s_add_u32 s54,s54,s56
s_cmp_lg_u32 s3,0
s_cbranch_scc1 L_wa
v_and_b32 v238,15,v1
v_and_b32 v239,1,v1
v_lshlrev_b32 v239,4,v239
v_mov_b32 v240,0x3f80
v_lshlrev_b32 v240,v239,v240
v_lshrrev_b32 v238,1,v238
v_cmp_eq_u32 vcc,0,v238
s_nop 1
v_cndmask_b32 v156,0,v240,vcc
v_cmp_eq_u32 vcc,1,v238
s_nop 1
v_cndmask_b32 v157,0,v240,vcc
v_cmp_eq_u32 vcc,2,v238
s_nop 1
v_cndmask_b32 v158,0,v240,vcc
v_cmp_eq_u32 vcc,3,v238
s_nop 1
v_cndmask_b32 v159,0,v240,vcc
s_mov_b32 s4,s32
s_mov_b32 s5,s33
s_mov_b32 s6,1024
s_mov_b32 s7,0x20000
buffer_load_dwordx4 v[224:227],v0,s[4:7],0 offen
v_and_b32 v238,15,v1
v_lshrrev_b32 v239,4,v1
v_lshlrev_b32 v240,2,v239
v_mov_b32 v241,0xf149f2ca
s_and_b32 s56,s46,1
s_lshl_b32 s56,s56,4
v_add_u32 v242,s56,v238
v_add_u32 v243,0,v240
v_cmp_gt_u32 vcc,v243,v242
s_nop 1
v_cndmask_b32 v8,0,v241,vcc
v_add_u32 v243,1,v240
v_cmp_gt_u32 vcc,v243,v242
s_nop 1
v_cndmask_b32 v9,0,v241,vcc
v_add_u32 v243,2,v240
v_cmp_gt_u32 vcc,v243,v242
s_nop 1
v_cndmask_b32 v10,0,v241,vcc
v_add_u32 v243,3,v240
v_cmp_gt_u32 vcc,v243,v242
s_nop 1
v_cndmask_b32 v11,0,v241,vcc
v_add_u32 v243,16,v240
v_cmp_gt_u32 vcc,v243,v242
s_nop 1
v_cndmask_b32 v12,0,v241,vcc
v_add_u32 v243,17,v240
v_cmp_gt_u32 vcc,v243,v242
s_nop 1
v_cndmask_b32 v13,0,v241,vcc
v_add_u32 v243,18,v240
v_cmp_gt_u32 vcc,v243,v242
s_nop 1
v_cndmask_b32 v14,0,v241,vcc
v_add_u32 v243,19,v240
v_cmp_gt_u32 vcc,v243,v242
s_nop 1
v_cndmask_b32 v15,0,v241,vcc
v_mov_b32 v152,s80
v_mov_b32 v145,0
v_mov_b32 v146,0
s_lshl_b32 s56,s46,12
s_add_u32 s56,s56,131072
v_add_u32 v3,s56,v0
v_add_u32 v4,131072,v0
s_lshl_b32 s56,s46,8
v_lshlrev_b32 v7,4,v238
v_add_u32 v7,s56,v7
v_lshl_add_u32 v5,v239,16,v7
v_lshlrev_b32 v6,1,v7
v_lshl_add_u32 v7,v239,10,v7
v_and_b32 v243,1,v239
v_lshl_add_u32 v6,v243,4,v6
v_lshrrev_b32 v243,1,v239
v_lshl_add_u32 v6,v243,12,v6
v_add_u32 v6,147456,v6
v_lshlrev_b32 v16,2,v1
v_lshlrev_b32 v21,3,v238
s_and_b32 s68,s47,15
s_lshl_b32 s56,s68,10
v_add_u32 v5,s56,v5
s_lshl_b32 s56,s68,15
v_add_u32 v7,s56,v7
s_lshl_b32 s69,s54,20
s_add_u32 s69,s69,20971520
s_lshl_b32 s87,s54,13
s_add_u32 s87,s87,10486272
s_lshl4_add_u32 s74,s68,s87
s_lshl2_add_u32 s74,s46,s74
s_lshl_b32 s68,s68,1
s_lshr_b32 s56,s46,1
s_add_u32 s68,s68,s56
s_mov_b32 s66,0
s_mov_b32 s67,0
s_mov_b32 s73,0x80000000
s_mov_b32 s75,0
s_mov_b32 s37,0
s_mov_b32 s42,4294966272
s_mov_b32 s43,4294967295
s_mov_b64 s[38:39],0
s_sub_u32 s36,s54,12
s_and_b32 s36,s36,3
s_mov_b32 s12,s40
s_mov_b32 s13,s41
s_mov_b32 s14,2097152
s_mov_b32 s15,0x20000
s_and_b32 s29,s46,1
s_mul_i32 s28,s29,12288
s_lshl_b32 s29,s29,11
s_and_b32 s56,s50,2048
s_lshl_b32 s56,s56,4
s_add_u32 s56,s56,65536
s_add_u32 s40,s56,s28
s_add_u32 s41,s56,s29
v_add_u32 v21,10487168,v21
v_mov_b32 v244,v21
s_and_b32 s56,s50,2048
s_add_u32 s56,s56,147456
v_lshlrev_b32 v23,5,v1
v_add_u32 v23,s56,v23
v_and_b32 v253,32,v0
v_lshrrev_b32 v245,2,v253
v_add_u32 v253,v253,v245
v_sub_u32 v253,v0,v253
v_add_u32 v253,8,v253
v_mov_b32 v254,0x80000000
s_mov_b32 s56,1408
v_writelane_b32 v254,s56,0
s_mov_b32 s56,256
v_writelane_b32 v254,s56,1
s_mov_b32 s56,1280
v_writelane_b32 v254,s56,2
v_mov_b32 v245,155648
s_lshl_b32 s56,s46,2
v_add_u32 v247,s56,v245
s_waitcnt vmcnt(0)
v_lshlrev_b32 v228,16,v224
v_and_b32 v229,0xffff0000,v224
v_lshlrev_b32 v230,16,v225
v_and_b32 v231,0xffff0000,v225
v_lshlrev_b32 v232,16,v226
v_and_b32 v233,0xffff0000,v226
v_lshlrev_b32 v234,16,v227
v_and_b32 v235,0xffff0000,v227
v_mul_f32 v255,v228,v228
v_fma_f32 v255,v229,v229,v255
v_fma_f32 v255,v230,v230,v255
v_fma_f32 v255,v231,v231,v255
v_fma_f32 v255,v232,v232,v255
v_fma_f32 v255,v233,v233,v255
v_fma_f32 v255,v234,v234,v255
v_fma_f32 v255,v235,v235,v255
s_nop 1
v_add_f32_dpp v255,v255,v255 row_ror:8 row_mask:0xf bank_mask:0xf
s_nop 1
v_add_f32_dpp v255,v255,v255 row_ror:4 row_mask:0xf bank_mask:0xf
s_nop 1
v_add_f32_dpp v255,v255,v255 row_ror:2 row_mask:0xf bank_mask:0xf
s_nop 1
v_add_f32_dpp v255,v255,v255 row_ror:1 row_mask:0xf bank_mask:0xf
v_mov_b32 v238,v255
s_nop 1
v_permlane16_swap_b32 v255,v238
v_add_f32 v255,v255,v238
v_mov_b32 v238,v255
s_nop 1
v_permlane32_swap_b32 v255,v238
v_add_f32 v255,v255,v238
v_sqrt_f32 v255,v255
v_sub_u32 v238,67,v1
v_cvt_f32_u32 v238,v238
v_log_f32 v238,v238
v_mov_b32 v239,0x3ff9999a
v_fmac_f32 v239,0x3e632166,v238
v_mul_f32 v255,v255,v239
v_or_b32 v255,0x80000000,v255
s_xor_b32 s34,s69,524288
buffer_load_dwordx4 v[160:163],v7,s[8:11],s34 offen
s_add_u32 s34,s34,4096
buffer_load_dwordx4 v[164:167],v7,s[8:11],s34 offen
s_add_u32 s34,s34,4096
buffer_load_dwordx4 v[168:171],v7,s[8:11],s34 offen
s_add_u32 s34,s34,4096
buffer_load_dwordx4 v[172:175],v7,s[8:11],s34 offen
s_add_u32 s34,s34,4096
buffer_load_dwordx4 v[176:179],v7,s[8:11],s34 offen
s_add_u32 s34,s34,4096
buffer_load_dwordx4 v[180:183],v7,s[8:11],s34 offen
s_add_u32 s34,s34,4096
buffer_load_dwordx4 v[184:187],v7,s[8:11],s34 offen
s_add_u32 s34,s34,4096
buffer_load_dwordx4 v[188:191],v7,s[8:11],s34 offen
s_xor_b32 s69,s69,524288
s_xor_b32 s34,s69,524288
buffer_load_dwordx4 v[160:163],v7,s[8:11],s34 offen
s_add_u32 s34,s34,4096
buffer_load_dwordx4 v[164:167],v7,s[8:11],s34 offen
s_add_u32 s34,s34,4096
buffer_load_dwordx4 v[168:171],v7,s[8:11],s34 offen
s_add_u32 s34,s34,4096
buffer_load_dwordx4 v[172:175],v7,s[8:11],s34 offen
s_add_u32 s34,s34,4096
buffer_load_dwordx4 v[176:179],v7,s[8:11],s34 offen
s_add_u32 s34,s34,4096
buffer_load_dwordx4 v[180:183],v7,s[8:11],s34 offen
s_add_u32 s34,s34,4096
buffer_load_dwordx4 v[184:187],v7,s[8:11],s34 offen
s_add_u32 s34,s34,4096
buffer_load_dwordx4 v[188:191],v7,s[8:11],s34 offen
s_xor_b32 s69,s69,524288
s_cmp_lt_u32 s54,2
s_cbranch_scc1 L_aa_79
s_sub_u32 s77,s54,2
s_mov_b32 s30,0
s_mov_b32 s86,1536
s_lshl_b32 s56,s77,5
s_add_u32 s56,s56,s68
s_mul_i32 s70,s56,24576
s_lshl_b32 s71,s56,12
s_lshl_b32 s59,s77,13
s_lshl2_add_u32 s59,s68,s59
s_add_u32 s59,s59,10485760
s_buffer_load_dword s32,s[8:11],s59
s_mov_b32 s33,1
s_add_u32 s70,s70,100663296
s_add_u32 s71,s71,41943040
v_mov_b32 v19,s59
s_branch L_aa_87
L_aa_93:
s_bitcmp1_b32 s46,0
s_cbranch_scc1 L_av_94
ds_read_b128 v[24:27],v4 offset:0
ds_read_b128 v[28:31],v4 offset:1024
s_min_u32 s56,s32,s33
s_cmp_lt_u32 s77,64
s_cselect_b32 s56,s56,0
s_cmp_eq_u32 s56,0
s_cselect_b32 s72,0x80000000,0
v_mov_b32 v248,s72
s_or_b32 s64,s70,s72
s_or_b32 s65,s71,s72
s_cmp_lt_u32 s30,s31
s_cselect_b32 s65,0x80000000,s65
s_add_u32 s64,s64,s28
s_add_u32 s65,s65,s29
s_xor_b32 s58,s67,s40
s_xor_b32 s57,s67,s41
s_add_u32 m0,s58,0
s_waitcnt lgkmcnt(1)
v_mfma_f32_16x16x32_bf16 v[160:163],v[24:27],a[0:3],0
buffer_load_dwordx4 v0,s[8:11],s64 offen offset:0 sc1 lds
v_mfma_f32_16x16x32_bf16 v[164:167],v[24:27],a[4:7],0
ds_read_b128 v[32:35],v4 offset:2048
v_lshlrev_b32 v88,16,v224
v_mfma_f32_16x16x32_bf16 v[168:171],v[24:27],a[8:11],0
ds_read_b128 v[36:39],v4 offset:3072
v_and_b32 v89,0xffff0000,v224
v_mfma_f32_16x16x32_bf16 v[172:175],v[24:27],a[12:15],0
ds_read_b128 v[40:43],v4 offset:8192
v_lshlrev_b32 v90,16,v225
v_mfma_f32_16x16x32_bf16 v[176:179],v[24:27],a[16:19],0
ds_read_b128 v[44:47],v4 offset:9216
v_and_b32 v91,0xffff0000,v225
v_mfma_f32_16x16x32_bf16 v[180:183],v[24:27],a[20:23],0
buffer_load_dwordx4 v0,s[8:11],s64 offen offset:1024 sc1 lds
v_mfma_f32_16x16x32_bf16 v[184:187],v[24:27],a[24:27],0
ds_read_b128 v[48:51],v4 offset:10240
s_waitcnt vmcnt(9)
v_mfma_f32_16x16x32_bf16 v[188:191],v[24:27],a[28:31],0
ds_read_b128 v[52:55],v4 offset:11264
v_mfma_f32_16x16x32_bf16 v[128:131],v[156:159],v[192:195],0
ds_write_b32 v247,v248
v_lshlrev_b32 v92,16,v226
s_waitcnt lgkmcnt(7)
v_mfma_f32_16x16x32_bf16 v[160:163],v[28:31],a[32:35],v[160:163]
ds_read_b128 v[56:59],v4 offset:4096
s_waitcnt vmcnt(8)
v_mfma_f32_16x16x32_bf16 v[164:167],v[28:31],a[36:39],v[164:167]
ds_read_b128 v[60:63],v4 offset:5120
v_mfma_f32_16x16x32_bf16 v[128:131],v[156:159],v[196:199],v[128:131]
ds_read_b128 v[64:67],v4 offset:6144
v_and_b32 v93,0xffff0000,v226
v_mfma_f32_16x16x32_bf16 v[168:171],v[28:31],a[40:43],v[168:171]
buffer_load_dwordx4 v0,s[8:11],s64 offen offset:2048 sc1 lds
v_mfma_f32_16x16x32_bf16 v[172:175],v[28:31],a[44:47],v[172:175]
ds_read_b128 v[68:71],v4 offset:7168
s_waitcnt vmcnt(8)
v_mfma_f32_16x16x32_bf16 v[176:179],v[28:31],a[48:51],v[176:179]
ds_read_b128 v[72:75],v4 offset:12288
v_mfma_f32_16x16x32_bf16 v[128:131],v[156:159],v[200:203],v[128:131]
ds_read_b128 v[76:79],v4 offset:13312
v_lshlrev_b32 v94,16,v227
v_mfma_f32_16x16x32_bf16 v[180:183],v[28:31],a[52:55],v[180:183]
ds_read_b128 v[80:83],v4 offset:14336
s_waitcnt vmcnt(7)
v_mfma_f32_16x16x32_bf16 v[184:187],v[28:31],a[56:59],v[184:187]
ds_read_b128 v[84:87],v4 offset:15360
v_mfma_f32_16x16x32_bf16 v[128:131],v[156:159],v[204:207],v[128:131]
v_and_b32 v95,0xffff0000,v227
v_readfirstlane_b32 s22,v246
v_mfma_f32_16x16x32_bf16 v[188:191],v[28:31],a[60:63],v[188:191]
buffer_load_dwordx4 v0,s[8:11],s64 offen offset:3072 sc1 lds
s_waitcnt lgkmcnt(14)
v_mfma_f32_16x16x32_bf16 v[160:163],v[32:35],a[64:67],v[160:163]
s_waitcnt vmcnt(7)
v_mfma_f32_16x16x32_bf16 v[132:135],v[156:159],v[208:211],0
s_cmp_eq_u32 s22,0
s_cbranch_scc1 L_ag_95
L_agb_96:
v_mfma_f32_16x16x32_bf16 v[164:167],v[32:35],a[68:71],v[164:167]
s_waitcnt vmcnt(6)
v_mfma_f32_16x16x32_bf16 v[132:135],v[156:159],v[212:215],v[132:135]
s_lshl_b32 s18,s26,5
s_add_u32 s18,s18,s68
s_lshl_b32 s19,s18,10
v_mfma_f32_16x16x32_bf16 v[168:171],v[32:35],a[72:75],v[168:171]
s_waitcnt vmcnt(5)
v_mfma_f32_16x16x32_bf16 v[132:135],v[156:159],v[216:219],v[132:135]
s_add_u32 s20,s19,6291456
s_lshl_b32 s23,s51,5
s_add_u32 s23,s23,s68
v_mfma_f32_16x16x32_bf16 v[172:175],v[32:35],a[76:79],v[172:175]
ds_write_b128 v6,v[128:131]
v_mfma_f32_16x16x32_bf16 v[176:179],v[32:35],a[80:83],v[176:179]
s_waitcnt vmcnt(4)
v_mfma_f32_16x16x32_bf16 v[132:135],v[156:159],v[220:223],v[132:135]
s_add_u32 m0,s58,4096
s_add_u32 s64,s64,4096
s_lshl_b32 s24,s23,10
v_mfma_f32_16x16x32_bf16 v[180:183],v[32:35],a[84:87],v[180:183]
buffer_load_dwordx4 v0,s[8:11],s64 offen offset:0 sc1 lds
v_mfma_f32_16x16x32_bf16 v[184:187],v[32:35],a[88:91],v[184:187]
s_lshl_b32 s25,s51,10
s_add_u32 s25,s25,2883584
s_cmp_eq_u32 s23,s55
s_cselect_b32 s25,s25,s24
v_mfma_f32_16x16x32_bf16 v[188:191],v[32:35],a[92:95],v[188:191]
ds_write_b128 v6,v[132:135] offset:2048
s_waitcnt lgkmcnt(15)
v_mfma_f32_16x16x32_bf16 v[160:163],v[36:39],a[96:99],v[160:163]
s_add_u32 s25,s25,8388608
s_mov_b32 s6,268435456
s_cmp_eq_u32 s31,0
s_cselect_b32 s25,s24,s25
s_cselect_b64 s[4:5],s[16:17],s[44:45]
s_cmov_b32 s6,2097152
v_mfma_f32_16x16x32_bf16 v[164:167],v[36:39],a[100:103],v[164:167]
buffer_load_dwordx4 v[224:227],v0,s[4:7],s25 offen sc1
v_mfma_f32_16x16x32_bf16 v[168:171],v[36:39],a[104:107],v[168:171]
buffer_load_dwordx4 v0,s[8:11],s64 offen offset:1024 sc1 lds
v_mfma_f32_16x16x32_bf16 v[172:175],v[36:39],a[108:111],v[172:175]
s_lshr_b32 s24,s55,5
s_cmp_lt_u32 s51,s24
s_cselect_b32 s24,1,2
v_mfma_f32_16x16x32_bf16 v[176:179],v[36:39],a[112:115],v[176:179]
s_waitcnt lgkmcnt(0)
s_barrier
v_mov_b32 v252,s24
v_mfma_f32_16x16x32_bf16 v[180:183],v[36:39],a[116:119],v[180:183]
ds_read_b128 v[96:99],v23
s_lshl2_add_u32 s25,s51,11018240
v_mfma_f32_16x16x32_bf16 v[184:187],v[36:39],a[120:123],v[184:187]
ds_read_b128 v[100:103],v23 offset:16
s_lshl_b32 s24,s68,16
v_mfma_f32_16x16x32_bf16 v[188:191],v[36:39],a[124:127],v[188:191]
buffer_load_dwordx4 v0,s[8:11],s64 offen offset:2048 sc1 lds
s_add_u32 s24,s24,s31
v_mfma_f32_16x16x32_bf16 v[160:163],v[40:43],a[128:131],v[160:163]
ds_read_b128 v[248:251],v245
s_add_u32 s24,s24,s86
s_cmp_eq_u32 s24,1537
s_cselect_b32 s25,s25,0x80000000
v_mfma_f32_16x16x32_bf16 v[164:167],v[40:43],a[132:135],v[164:167]
buffer_store_dword v252,off,s[8:11],s25 sc1
s_bitcmp1_b64 s[38:39],s51
s_cselect_b32 s24,128,0
v_mfma_f32_16x16x32_bf16 v[168:171],v[40:43],a[136:139],v[168:171]
buffer_store_dword v20,off,s[8:11],s73 sc1
s_lshl_b32 s23,s51,13
v_mfma_f32_16x16x32_bf16 v[172:175],v[40:43],a[140:143],v[172:175]
s_lshl2_add_u32 s23,s68,s23
s_add_u32 s23,s23,10487168
s_add_u32 s23,s23,s24
s_mov_b32 s73,0x80000000
v_mfma_f32_16x16x32_bf16 v[176:179],v[40:43],a[144:147],v[176:179]
buffer_load_dwordx4 v0,s[8:11],s64 offen offset:3072 sc1 lds
v_mfma_f32_16x16x32_bf16 v[180:183],v[40:43],a[148:151],v[180:183]
buffer_load_dword v246,off,s[8:11],s23 sc1
v_lshrrev_b32 v244,4,v1
v_mfma_f32_16x16x32_bf16 v[184:187],v[40:43],a[152:155],v[184:187]
s_waitcnt lgkmcnt(0)
v_or3_b32 v248,v248,v249,v250
v_or_b32 v248,v248,v251
s_sub_u32 s23,s77,7
v_mfma_f32_16x16x32_bf16 v[188:191],v[40:43],a[156:159],v[188:191]
v_readfirstlane_b32 s72,v248
v_add_u32 v244,s23,v244
v_max_i32 v244,0,v244
v_mfma_f32_16x16x32_bf16 v[160:163],v[44:47],a[160:163],v[160:163]
s_waitcnt lgkmcnt(1)
v_lshl_add_u32 v244,v244,13,v21
v_cvt_pk_bf16_f32 v104,v96,v97
v_cvt_pk_bf16_f32 v105,v98,v99
v_mfma_f32_16x16x32_bf16 v[164:167],v[44:47],a[164:167],v[164:167]
buffer_load_dwordx2 v[242:243],v244,s[8:11],0 offen sc1
s_add_u32 m0,s58,8192
v_mfma_f32_16x16x32_bf16 v[168:171],v[44:47],a[168:171],v[168:171]
s_add_u32 s64,s64,4096
v_cvt_pk_bf16_f32 v106,v100,v101
v_cvt_pk_bf16_f32 v107,v102,v103
v_lshlrev_b32 v96,16,v104
v_mfma_f32_16x16x32_bf16 v[172:175],v[44:47],a[172:175],v[172:175]
buffer_load_dwordx4 v0,s[8:11],s64 offen offset:0 sc1 lds
v_and_b32 v97,0xffff0000,v104
v_mfma_f32_16x16x32_bf16 v[176:179],v[44:47],a[176:179],v[176:179]
v_lshlrev_b32 v98,16,v105
v_and_b32 v99,0xffff0000,v105
v_lshlrev_b32 v100,16,v106
v_mfma_f32_16x16x32_bf16 v[180:183],v[44:47],a[180:183],v[180:183]
v_and_b32 v101,0xffff0000,v106
v_lshlrev_b32 v102,16,v107
v_and_b32 v103,0xffff0000,v107
v_mfma_f32_16x16x32_bf16 v[184:187],v[44:47],a[184:187],v[184:187]
v_add_f32 v88,v88,v96
v_add_f32 v89,v89,v97
v_add_f32 v90,v90,v98
v_mfma_f32_16x16x32_bf16 v[188:191],v[44:47],a[188:191],v[188:191]
v_add_f32 v91,v91,v99
v_add_f32 v92,v92,v100
v_add_f32 v93,v93,v101
v_mfma_f32_16x16x32_bf16 v[160:163],v[48:51],a[192:195],v[160:163]
buffer_load_dwordx4 v0,s[8:11],s64 offen offset:1024 sc1 lds
v_add_f32 v94,v94,v102
v_mfma_f32_16x16x32_bf16 v[164:167],v[48:51],a[196:199],v[164:167]
v_add_f32 v95,v95,v103
v_cvt_pk_bf16_f32 v104,v88,v89
v_cvt_pk_bf16_f32 v105,v90,v91
v_mfma_f32_16x16x32_bf16 v[168:171],v[48:51],a[200:203],v[168:171]
v_cvt_pk_bf16_f32 v106,v92,v93
v_cvt_pk_bf16_f32 v107,v94,v95
v_mfma_f32_16x16x32_bf16 v[172:175],v[48:51],a[204:207],v[172:175]
buffer_store_dwordx4 v[104:107],v0,s[8:11],s20 offen sc1
v_lshlrev_b32 v88,16,v104
v_mfma_f32_16x16x32_bf16 v[176:179],v[48:51],a[208:211],v[176:179]
v_and_b32 v89,0xffff0000,v104
v_lshlrev_b32 v90,16,v105
v_and_b32 v91,0xffff0000,v105
v_mfma_f32_16x16x32_bf16 v[180:183],v[48:51],a[212:215],v[180:183]
buffer_load_dwordx4 v0,s[8:11],s64 offen offset:2048 sc1 lds
v_lshlrev_b32 v92,16,v106
v_mfma_f32_16x16x32_bf16 v[184:187],v[48:51],a[216:219],v[184:187]
v_and_b32 v93,0xffff0000,v106
v_lshlrev_b32 v94,16,v107
v_and_b32 v95,0xffff0000,v107
v_mfma_f32_16x16x32_bf16 v[188:191],v[48:51],a[220:223],v[188:191]
v_readfirstlane_b32 s78,v88
v_mfma_f32_16x16x32_bf16 v[160:163],v[52:55],a[224:227],v[160:163]
s_nop 0
v_add_f32 v120,v88,-s78
v_add_f32 v121,v89,-s78
v_add_f32 v122,v90,-s78
v_mfma_f32_16x16x32_bf16 v[164:167],v[52:55],a[228:231],v[164:167]
v_add_f32 v123,v91,-s78
v_add_f32 v124,v92,-s78
v_add_f32 v125,v93,-s78
v_mfma_f32_16x16x32_bf16 v[168:171],v[52:55],a[232:235],v[168:171]
buffer_load_dwordx4 v0,s[8:11],s64 offen offset:3072 sc1 lds
v_add_f32 v126,v94,-s78
v_mfma_f32_16x16x32_bf16 v[172:175],v[52:55],a[236:239],v[172:175]
v_add_f32 v127,v95,-s78
v_add_f32 v128,v120,v122
v_add_f32 v129,v121,v123
v_mfma_f32_16x16x32_bf16 v[176:179],v[52:55],a[240:243],v[176:179]
v_mul_f32 v130,v120,v120
v_mul_f32 v131,v121,v121
v_add_f32 v132,v124,v126
v_mfma_f32_16x16x32_bf16 v[180:183],v[52:55],a[244:247],v[180:183]
v_add_f32 v133,v125,v127
v_fma_f32 v130,v122,v122,v130
v_fma_f32 v131,v123,v123,v131
v_mfma_f32_16x16x32_bf16 v[184:187],v[52:55],a[248:251],v[184:187]
v_add_f32 v128,v128,v132
v_add_f32 v129,v129,v133
v_fma_f32 v130,v124,v124,v130
v_mfma_f32_16x16x32_bf16 v[188:191],v[52:55],a[252:255],v[188:191]
s_add_u32 m0,s57,24576
v_fma_f32 v131,v125,v125,v131
v_add_f32 v128,v128,v129
v_fma_f32 v130,v126,v126,v130
v_mfma_f32_16x16x32_bf16 v[192:195],v[56:59],a[0:3],0
buffer_load_dwordx4 v0,s[8:11],s65 offen offset:0 sc1 lds
v_fma_f32 v131,v127,v127,v131
v_mfma_f32_16x16x32_bf16 v[196:199],v[56:59],a[4:7],0
v_add_f32 v130,v130,v131
v_mfma_f32_16x16x32_bf16 v[200:203],v[56:59],a[8:11],0
s_nop 0
v_permlane32_swap_b32 v128,v130
v_add_f32 v128,v128,v130
v_cvt_pk_bf16_f32 v24,v160,v164
v_mfma_f32_16x16x32_bf16 v[204:207],v[56:59],a[12:15],0
v_add_f32_dpp v128,v128,v128 row_ror:8 row_mask:0xf bank_mask:0xf
v_cvt_pk_bf16_f32 v25,v168,v172
v_cvt_pk_bf16_f32 v26,v176,v180
v_mfma_f32_16x16x32_bf16 v[208:211],v[56:59],a[16:19],0
v_add_f32_dpp v128,v128,v128 row_ror:4 row_mask:0xf bank_mask:0xf
v_cvt_pk_bf16_f32 v27,v184,v188
v_cvt_pk_bf16_f32 v28,v161,v165
v_mfma_f32_16x16x32_bf16 v[212:215],v[56:59],a[20:23],0
buffer_load_dwordx4 v0,s[8:11],s65 offen offset:1024 sc1 lds
v_add_f32_dpp v128,v128,v128 row_ror:2 row_mask:0xf bank_mask:0xf
v_mfma_f32_16x16x32_bf16 v[216:219],v[56:59],a[24:27],0
s_nop 0
v_add_f32_dpp v128,v128,v128 row_ror:1 row_mask:0xf bank_mask:0xf
v_mov_b32 v130,v128
v_cvt_pk_bf16_f32 v29,v169,v173
v_mfma_f32_16x16x32_bf16 v[220:223],v[56:59],a[28:31],0
v_permlane16_swap_b32 v128,v130
v_add_f32 v128,v128,v130
v_mul_f32 v128,0x3b000000,v128
v_mfma_f32_16x16x32_bf16 v[192:195],v[60:63],a[32:35],v[192:195]
v_mov_b32 v130,v128
v_cvt_pk_bf16_f32 v30,v177,v181
v_cvt_pk_bf16_f32 v31,v185,v189
v_mfma_f32_16x16x32_bf16 v[196:199],v[60:63],a[36:39],v[196:199]
v_permlane32_swap_b32 v128,v130
v_fma_f32 v130,-v128,v128,v130
v_add_f32 v128,s78,v128
v_mfma_f32_16x16x32_bf16 v[200:203],v[60:63],a[40:43],v[200:203]
v_max_f32 v130,0,v130
v_cvt_pk_bf16_f32 v130,v128,v130
v_lshlrev_b32 v128,16,v130
v_mfma_f32_16x16x32_bf16 v[204:207],v[60:63],a[44:47],v[204:207]
v_and_b32 v130,0xffff0000,v130
v_add_f32 v130,0x3727c5ac,v130
v_cvt_pk_bf16_f32 v130,v130,v130
v_mfma_f32_16x16x32_bf16 v[208:211],v[60:63],a[48:51],v[208:211]
v_and_b32 v130,0xffff0000,v130
v_sqrt_f32 v130,v130
v_add_f32 v120,v88,-v128
v_mfma_f32_16x16x32_bf16 v[212:215],v[60:63],a[52:55],v[212:215]
v_add_f32 v121,v89,-v128
v_add_f32 v122,v90,-v128
v_add_f32 v123,v91,-v128
v_mfma_f32_16x16x32_bf16 v[216:219],v[60:63],a[56:59],v[216:219]
v_add_f32 v124,v92,-v128
v_add_f32 v125,v93,-v128
v_add_f32 v126,v94,-v128
v_mfma_f32_16x16x32_bf16 v[220:223],v[60:63],a[60:63],v[220:223]
v_add_f32 v127,v95,-v128
v_cvt_pk_bf16_f32 v130,v130,v130
v_and_b32 v130,0xffff0000,v130
v_mfma_f32_16x16x32_bf16 v[192:195],v[64:67],a[64:67],v[192:195]
v_rcp_f32 v130,v130
v_cvt_pk_bf16_f32 v108,v120,v121
v_cvt_pk_bf16_f32 v109,v122,v123
v_mfma_f32_16x16x32_bf16 v[196:199],v[64:67],a[68:71],v[196:199]
v_cvt_pk_bf16_f32 v110,v124,v125
v_cvt_pk_bf16_f32 v111,v126,v127
v_lshlrev_b32 v120,16,v108
v_mfma_f32_16x16x32_bf16 v[200:203],v[64:67],a[72:75],v[200:203]
v_and_b32 v121,0xffff0000,v108
v_lshlrev_b32 v122,16,v109
v_and_b32 v123,0xffff0000,v109
v_mfma_f32_16x16x32_bf16 v[204:207],v[64:67],a[76:79],v[204:207]
v_lshlrev_b32 v124,16,v110
v_and_b32 v125,0xffff0000,v110
v_lshlrev_b32 v126,16,v111
v_mfma_f32_16x16x32_bf16 v[208:211],v[64:67],a[80:83],v[208:211]
v_cvt_pk_bf16_f32 v32,v162,v166
v_cvt_pk_bf16_f32 v33,v170,v174
v_cvt_pk_bf16_f32 v34,v178,v182
v_mfma_f32_16x16x32_bf16 v[212:215],v[64:67],a[84:87],v[212:215]
v_cvt_pk_bf16_f32 v35,v186,v190
v_cvt_pk_bf16_f32 v36,v163,v167
v_cvt_pk_bf16_f32 v37,v171,v175
v_mfma_f32_16x16x32_bf16 v[216:219],v[64:67],a[88:91],v[216:219]
v_cvt_pk_bf16_f32 v38,v179,v183
v_cvt_pk_bf16_f32 v39,v187,v191
v_and_b32 v127,0xffff0000,v111
v_mfma_f32_16x16x32_bf16 v[220:223],v[64:67],a[92:95],v[220:223]
v_mul_f32 v120,v120,v130
v_mul_f32 v121,v121,v130
v_mul_f32 v122,v122,v130
v_mfma_f32_16x16x32_bf16 v[192:195],v[68:71],a[96:99],v[192:195]
v_mul_f32 v123,v123,v130
v_mul_f32 v124,v124,v130
v_mul_f32 v125,v125,v130
v_mfma_f32_16x16x32_bf16 v[196:199],v[68:71],a[100:103],v[196:199]
v_mul_f32 v126,v126,v130
v_mul_f32 v127,v127,v130
v_cvt_pk_bf16_f32 v108,v120,v121
v_mfma_f32_16x16x32_bf16 v[200:203],v[68:71],a[104:107],v[200:203]
v_cvt_pk_bf16_f32 v109,v122,v123
v_cvt_pk_bf16_f32 v110,v124,v125
v_cvt_pk_bf16_f32 v111,v126,v127
v_mfma_f32_16x16x32_bf16 v[204:207],v[68:71],a[108:111],v[204:207]
v_lshlrev_b32 v112,16,v108
v_and_b32 v113,0xffff0000,v108
v_lshlrev_b32 v114,16,v109
v_mfma_f32_16x16x32_bf16 v[208:211],v[68:71],a[112:115],v[208:211]
s_add_u32 s62,s69,0
v_and_b32 v115,0xffff0000,v109
v_lshlrev_b32 v116,16,v110
v_and_b32 v117,0xffff0000,v110
v_mfma_f32_16x16x32_bf16 v[212:215],v[68:71],a[116:119],v[212:215]
buffer_store_dwordx4 v[24:27],v5,s[8:11],s62 offen
v_lshlrev_b32 v118,16,v111
v_mfma_f32_16x16x32_bf16 v[216:219],v[68:71],a[120:123],v[216:219]
v_and_b32 v119,0xffff0000,v111
v_add_f32 v88,v88,v112
v_add_f32 v89,v89,v113
v_mfma_f32_16x16x32_bf16 v[220:223],v[68:71],a[124:127],v[220:223]
v_add_f32 v90,v90,v114
v_add_f32 v91,v91,v115
v_add_f32 v92,v92,v116
v_mfma_f32_16x16x32_bf16 v[192:195],v[72:75],a[128:131],v[192:195]
s_add_u32 s62,s69,16384
v_add_f32 v93,v93,v117
v_add_f32 v94,v94,v118
v_add_f32 v95,v95,v119
v_mfma_f32_16x16x32_bf16 v[196:199],v[72:75],a[132:135],v[196:199]
buffer_store_dwordx4 v[28:31],v5,s[8:11],s62 offen
v_cvt_pk_bf16_f32 v96,v88,v89
v_mfma_f32_16x16x32_bf16 v[200:203],v[72:75],a[136:139],v[200:203]
v_cvt_pk_bf16_f32 v97,v90,v91
v_cvt_pk_bf16_f32 v98,v92,v93
v_cvt_pk_bf16_f32 v99,v94,v95
v_mfma_f32_16x16x32_bf16 v[204:207],v[72:75],a[140:143],v[204:207]
buffer_store_dwordx4 v[96:99],v0,s[12:15],s19 offen sc1
v_mul_f32 v236,v112,v228
v_mfma_f32_16x16x32_bf16 v[208:211],v[72:75],a[144:147],v[208:211]
s_add_u32 s62,s69,32768
v_mul_f32 v237,v113,v229
v_fma_f32 v236,v114,v230,v236
v_fma_f32 v237,v115,v231,v237
v_mfma_f32_16x16x32_bf16 v[212:215],v[72:75],a[148:151],v[212:215]
buffer_store_dwordx4 v[32:35],v5,s[8:11],s62 offen
v_fma_f32 v236,v116,v232,v236
v_mfma_f32_16x16x32_bf16 v[216:219],v[72:75],a[152:155],v[216:219]
v_fma_f32 v237,v117,v233,v237
v_fma_f32 v236,v118,v234,v236
v_fma_f32 v237,v119,v235,v237
v_mfma_f32_16x16x32_bf16 v[220:223],v[72:75],a[156:159],v[220:223]
v_add_f32 v236,v236,v237
v_mfma_f32_16x16x32_bf16 v[192:195],v[76:79],a[160:163],v[192:195]
s_add_u32 s62,s69,49152
v_add_f32_dpp v236,v236,v236 row_ror:8 row_mask:0xf bank_mask:0xf
v_mfma_f32_16x16x32_bf16 v[196:199],v[76:79],a[164:167],v[196:199]
buffer_store_dwordx4 v[36:39],v5,s[8:11],s62 offen
v_add_f32_dpp v236,v236,v236 row_ror:4 row_mask:0xf bank_mask:0xf
v_mfma_f32_16x16x32_bf16 v[200:203],v[76:79],a[168:171],v[200:203]
s_nop 0
v_add_f32_dpp v236,v236,v236 row_ror:2 row_mask:0xf bank_mask:0xf
v_mfma_f32_16x16x32_bf16 v[204:207],v[76:79],a[172:175],v[204:207]
s_nop 0
v_add_f32_dpp v236,v236,v236 row_ror:1 row_mask:0xf bank_mask:0xf
v_mov_b32 v237,v236
v_mfma_f32_16x16x32_bf16 v[208:211],v[76:79],a[176:179],v[208:211]
s_nop 0
v_permlane16_swap_b32 v236,v237
v_add_f32 v236,v236,v237
v_mov_b32 v237,v236
v_mfma_f32_16x16x32_bf16 v[212:215],v[76:79],a[180:183],v[212:215]
s_nop 0
v_permlane32_swap_b32 v236,v237
v_add_f32 v236,v236,v237
v_cvt_pk_bf16_f32 v236,v236,v236
v_mfma_f32_16x16x32_bf16 v[216:219],v[76:79],a[184:187],v[216:219]
v_and_b32 v236,0xffff0000,v236
v_ashrrev_i32 v237,31,v236
v_or_b32 v237,0x80000000,v237
v_mfma_f32_16x16x32_bf16 v[220:223],v[76:79],a[188:191],v[220:223]
v_xor_b32 v236,v236,v237
v_and_b32 v236,0xffff0000,v236
s_sub_u32 s20,4095,s18
v_mfma_f32_16x16x32_bf16 v[192:195],v[80:83],a[192:195],v[192:195]
v_or_b32 v20,s20,v236
s_lshl_b32 s73,s26,13
s_lshl2_add_u32 s73,s68,s73
v_mfma_f32_16x16x32_bf16 v[196:199],v[80:83],a[196:199],v[196:199]
s_add_u32 s73,s73,10485760
s_add_u32 s73,s73,s86
v_mfma_f32_16x16x32_bf16 v[192:195],v[84:87],a[224:227],v[192:195]
v_mfma_f32_16x16x32_bf16 v[196:199],v[84:87],a[228:231],v[196:199]
v_mfma_f32_16x16x32_bf16 v[200:203],v[80:83],a[200:203],v[200:203]
v_mfma_f32_16x16x32_bf16 v[204:207],v[80:83],a[204:207],v[204:207]
v_mfma_f32_16x16x32_bf16 v[200:203],v[84:87],a[232:235],v[200:203]
v_mfma_f32_16x16x32_bf16 v[204:207],v[84:87],a[236:239],v[204:207]
v_cvt_pk_bf16_f32 v40,v192,v196
v_cvt_pk_bf16_f32 v44,v193,v197
v_cvt_pk_bf16_f32 v48,v194,v198
v_mfma_f32_16x16x32_bf16 v[208:211],v[80:83],a[208:211],v[208:211]
v_cvt_pk_bf16_f32 v52,v195,v199
v_mfma_f32_16x16x32_bf16 v[212:215],v[80:83],a[212:215],v[212:215]
v_cvt_pk_bf16_f32 v41,v200,v204
v_cvt_pk_bf16_f32 v45,v201,v205
v_cvt_pk_bf16_f32 v49,v202,v206
v_mfma_f32_16x16x32_bf16 v[208:211],v[84:87],a[240:243],v[208:211]
v_cvt_pk_bf16_f32 v53,v203,v207
v_mfma_f32_16x16x32_bf16 v[212:215],v[84:87],a[244:247],v[212:215]
v_mfma_f32_16x16x32_bf16 v[216:219],v[80:83],a[216:219],v[216:219]
v_mfma_f32_16x16x32_bf16 v[220:223],v[80:83],a[220:223],v[220:223]
v_mfma_f32_16x16x32_bf16 v[216:219],v[84:87],a[248:251],v[216:219]
v_mfma_f32_16x16x32_bf16 v[220:223],v[84:87],a[252:255],v[220:223]
v_cvt_pk_bf16_f32 v42,v208,v212
v_cvt_pk_bf16_f32 v46,v209,v213
v_cvt_pk_bf16_f32 v50,v210,v214
v_cvt_pk_bf16_f32 v54,v211,v215
s_nop 3
v_cvt_pk_bf16_f32 v43,v216,v220
s_add_u32 s62,s69,262144
buffer_store_dwordx4 v[40:43],v5,s[8:11],s62 offen
v_cvt_pk_bf16_f32 v47,v217,v221
s_add_u32 s62,s69,278528
buffer_store_dwordx4 v[44:47],v5,s[8:11],s62 offen
v_cvt_pk_bf16_f32 v51,v218,v222
s_add_u32 s62,s69,294912
buffer_store_dwordx4 v[48:51],v5,s[8:11],s62 offen
v_cvt_pk_bf16_f32 v55,v219,v223
s_add_u32 s62,s69,311296
buffer_store_dwordx4 v[52:55],v5,s[8:11],s62 offen
s_cmp_lg_u32 s72,0
s_cbranch_scc1 L_aa_82
s_waitcnt vmcnt(9)
s_branch L_aa_92
L_av_94:
ds_read_b128 v[24:27],v4 offset:0
ds_read_b128 v[28:31],v4 offset:1024
s_min_u32 s56,s32,s33
s_cmp_lt_u32 s77,64
s_cselect_b32 s56,s56,0
s_cmp_eq_u32 s56,0
s_cselect_b32 s72,0x80000000,0
v_mov_b32 v248,s72
s_or_b32 s64,s70,s72
s_or_b32 s65,s71,s72
s_cmp_lt_u32 s30,s31
s_cselect_b32 s65,0x80000000,s65
s_add_u32 s64,s64,s28
s_add_u32 s65,s65,s29
s_xor_b32 s58,s67,s40
s_xor_b32 s57,s67,s41
s_add_u32 m0,s58,0
s_waitcnt lgkmcnt(1)
v_mfma_f32_16x16x32_bf16 v[160:163],v[24:27],a[0:3],0
buffer_load_dwordx4 v0,s[8:11],s64 offen offset:0 sc1 lds
v_mfma_f32_16x16x32_bf16 v[164:167],v[24:27],a[4:7],0
ds_read_b128 v[32:35],v4 offset:2048
s_lshl_b32 s23,s51,5
v_mfma_f32_16x16x32_bf16 v[168:171],v[24:27],a[8:11],0
ds_read_b128 v[36:39],v4 offset:3072
s_add_u32 s23,s23,s68
v_mfma_f32_16x16x32_bf16 v[172:175],v[24:27],a[12:15],0
ds_read_b128 v[40:43],v4 offset:8192
s_lshl_b32 s24,s23,10
v_mfma_f32_16x16x32_bf16 v[176:179],v[24:27],a[16:19],0
ds_read_b128 v[44:47],v4 offset:9216
s_lshl_b32 s25,s51,10
v_mfma_f32_16x16x32_bf16 v[180:183],v[24:27],a[20:23],0
buffer_load_dwordx4 v0,s[8:11],s64 offen offset:1024 sc1 lds
v_mfma_f32_16x16x32_bf16 v[184:187],v[24:27],a[24:27],0
ds_read_b128 v[48:51],v4 offset:10240
s_waitcnt vmcnt(9)
v_mfma_f32_16x16x32_bf16 v[188:191],v[24:27],a[28:31],0
ds_read_b128 v[52:55],v4 offset:11264
v_mfma_f32_16x16x32_bf16 v[128:131],v[156:159],v[192:195],0
ds_write_b32 v247,v248
s_add_u32 s25,s25,2883584
s_waitcnt lgkmcnt(7)
v_mfma_f32_16x16x32_bf16 v[160:163],v[28:31],a[32:35],v[160:163]
ds_read_b128 v[56:59],v4 offset:4096
s_waitcnt vmcnt(8)
v_mfma_f32_16x16x32_bf16 v[164:167],v[28:31],a[36:39],v[164:167]
ds_read_b128 v[60:63],v4 offset:5120
v_mfma_f32_16x16x32_bf16 v[128:131],v[156:159],v[196:199],v[128:131]
ds_read_b128 v[64:67],v4 offset:6144
s_cmp_eq_u32 s23,s55
s_cselect_b32 s25,s25,s24
v_mfma_f32_16x16x32_bf16 v[168:171],v[28:31],a[40:43],v[168:171]
buffer_load_dwordx4 v0,s[8:11],s64 offen offset:2048 sc1 lds
v_mfma_f32_16x16x32_bf16 v[172:175],v[28:31],a[44:47],v[172:175]
ds_read_b128 v[68:71],v4 offset:7168
s_waitcnt vmcnt(8)
v_mfma_f32_16x16x32_bf16 v[176:179],v[28:31],a[48:51],v[176:179]
ds_read_b128 v[72:75],v4 offset:12288
v_mfma_f32_16x16x32_bf16 v[128:131],v[156:159],v[200:203],v[128:131]
ds_read_b128 v[76:79],v4 offset:13312
s_add_u32 s25,s25,8388608
v_mfma_f32_16x16x32_bf16 v[180:183],v[28:31],a[52:55],v[180:183]
ds_read_b128 v[80:83],v4 offset:14336
s_waitcnt vmcnt(7)
v_mfma_f32_16x16x32_bf16 v[184:187],v[28:31],a[56:59],v[184:187]
ds_read_b128 v[84:87],v4 offset:15360
v_mfma_f32_16x16x32_bf16 v[128:131],v[156:159],v[204:207],v[128:131]
s_mov_b32 s6,268435456
s_cmp_eq_u32 s31,0
s_cselect_b32 s25,s24,s25
s_cselect_b64 s[4:5],s[16:17],s[44:45]
s_cmov_b32 s6,2097152
v_mfma_f32_16x16x32_bf16 v[188:191],v[28:31],a[60:63],v[188:191]
buffer_load_dwordx4 v0,s[8:11],s64 offen offset:3072 sc1 lds
s_waitcnt lgkmcnt(14)
v_mfma_f32_16x16x32_bf16 v[160:163],v[32:35],a[64:67],v[160:163]
buffer_load_dwordx4 v[224:227],v0,s[4:7],s25 offen sc1
v_mfma_f32_16x16x32_bf16 v[164:167],v[32:35],a[68:71],v[164:167]
s_waitcnt vmcnt(8)
v_mfma_f32_16x16x32_bf16 v[132:135],v[156:159],v[208:211],0
s_lshr_b32 s24,s55,5
s_cmp_lt_u32 s51,s24
s_cselect_b32 s24,1,2
v_mfma_f32_16x16x32_bf16 v[168:171],v[32:35],a[72:75],v[168:171]
s_waitcnt vmcnt(7)
v_mfma_f32_16x16x32_bf16 v[132:135],v[156:159],v[212:215],v[132:135]
v_mov_b32 v252,s24
s_lshl2_add_u32 s25,s51,11018240
v_mfma_f32_16x16x32_bf16 v[172:175],v[32:35],a[76:79],v[172:175]
s_waitcnt vmcnt(6)
v_mfma_f32_16x16x32_bf16 v[132:135],v[156:159],v[216:219],v[132:135]
s_lshl_b32 s24,s68,16
s_add_u32 s24,s24,s31
s_add_u32 s24,s24,s86
v_mfma_f32_16x16x32_bf16 v[176:179],v[32:35],a[80:83],v[176:179]
ds_write_b128 v6,v[128:131]
v_mfma_f32_16x16x32_bf16 v[180:183],v[32:35],a[84:87],v[180:183]
s_waitcnt vmcnt(5)
v_mfma_f32_16x16x32_bf16 v[132:135],v[156:159],v[220:223],v[132:135]
s_add_u32 m0,s58,4096
s_add_u32 s64,s64,4096
s_cmp_eq_u32 s24,1537
s_cselect_b32 s25,s25,0x80000000
v_mfma_f32_16x16x32_bf16 v[184:187],v[32:35],a[88:91],v[184:187]
buffer_load_dwordx4 v0,s[8:11],s64 offen offset:0 sc1 lds
v_mfma_f32_16x16x32_bf16 v[188:191],v[32:35],a[92:95],v[188:191]
buffer_store_dword v252,off,s[8:11],s25 sc1
s_waitcnt lgkmcnt(14)
v_mfma_f32_16x16x32_bf16 v[160:163],v[36:39],a[96:99],v[160:163]
ds_write_b128 v6,v[132:135] offset:2048
v_mfma_f32_16x16x32_bf16 v[164:167],v[36:39],a[100:103],v[164:167]
s_bitcmp1_b64 s[38:39],s51
s_cselect_b32 s24,128,0
s_lshl_b32 s23,s51,13
v_mfma_f32_16x16x32_bf16 v[168:171],v[36:39],a[104:107],v[168:171]
s_lshl2_add_u32 s23,s68,s23
s_add_u32 s23,s23,10487168
s_add_u32 s23,s23,s24
v_mfma_f32_16x16x32_bf16 v[172:175],v[36:39],a[108:111],v[172:175]
buffer_load_dwordx4 v0,s[8:11],s64 offen offset:1024 sc1 lds
v_mfma_f32_16x16x32_bf16 v[176:179],v[36:39],a[112:115],v[176:179]
buffer_load_dword v246,off,s[8:11],s23 sc1
v_mfma_f32_16x16x32_bf16 v[180:183],v[36:39],a[116:119],v[180:183]
s_waitcnt lgkmcnt(0)
s_barrier
v_lshrrev_b32 v244,4,v1
v_mfma_f32_16x16x32_bf16 v[184:187],v[36:39],a[120:123],v[184:187]
ds_read_b128 v[248:251],v245
s_sub_u32 s23,s77,7
v_mfma_f32_16x16x32_bf16 v[188:191],v[36:39],a[124:127],v[188:191]
buffer_store_dword v20,off,s[8:11],s73 sc1
v_mfma_f32_16x16x32_bf16 v[160:163],v[40:43],a[128:131],v[160:163]
buffer_load_dwordx4 v0,s[8:11],s64 offen offset:2048 sc1 lds
v_mfma_f32_16x16x32_bf16 v[164:167],v[40:43],a[132:135],v[164:167]
s_mov_b32 s73,0x80000000
v_add_u32 v244,s23,v244
v_max_i32 v244,0,v244
v_mfma_f32_16x16x32_bf16 v[168:171],v[40:43],a[136:139],v[168:171]
v_lshl_add_u32 v244,v244,13,v21
v_mfma_f32_16x16x32_bf16 v[172:175],v[40:43],a[140:143],v[172:175]
buffer_load_dwordx2 v[242:243],v244,s[8:11],0 offen sc1
v_mfma_f32_16x16x32_bf16 v[176:179],v[40:43],a[144:147],v[176:179]
s_waitcnt lgkmcnt(0)
v_or3_b32 v248,v248,v249,v250
v_or_b32 v248,v248,v251
v_mfma_f32_16x16x32_bf16 v[180:183],v[40:43],a[148:151],v[180:183]
buffer_load_dwordx4 v0,s[8:11],s64 offen offset:3072 sc1 lds
v_mfma_f32_16x16x32_bf16 v[184:187],v[40:43],a[152:155],v[184:187]
v_mfma_f32_16x16x32_bf16 v[188:191],v[40:43],a[156:159],v[188:191]
v_readfirstlane_b32 s72,v248
v_mfma_f32_16x16x32_bf16 v[160:163],v[44:47],a[160:163],v[160:163]
v_mfma_f32_16x16x32_bf16 v[164:167],v[44:47],a[164:167],v[164:167]
v_mfma_f32_16x16x32_bf16 v[168:171],v[44:47],a[168:171],v[168:171]
s_add_u32 m0,s58,8192
s_add_u32 s64,s64,4096
v_mfma_f32_16x16x32_bf16 v[172:175],v[44:47],a[172:175],v[172:175]
buffer_load_dwordx4 v0,s[8:11],s64 offen offset:0 sc1 lds
v_mfma_f32_16x16x32_bf16 v[176:179],v[44:47],a[176:179],v[176:179]
v_mfma_f32_16x16x32_bf16 v[180:183],v[44:47],a[180:183],v[180:183]
v_mfma_f32_16x16x32_bf16 v[184:187],v[44:47],a[184:187],v[184:187]
v_mfma_f32_16x16x32_bf16 v[188:191],v[44:47],a[188:191],v[188:191]
v_mfma_f32_16x16x32_bf16 v[160:163],v[48:51],a[192:195],v[160:163]
buffer_load_dwordx4 v0,s[8:11],s64 offen offset:1024 sc1 lds
v_mfma_f32_16x16x32_bf16 v[164:167],v[48:51],a[196:199],v[164:167]
v_mfma_f32_16x16x32_bf16 v[168:171],v[48:51],a[200:203],v[168:171]
v_mfma_f32_16x16x32_bf16 v[172:175],v[48:51],a[204:207],v[172:175]
v_mfma_f32_16x16x32_bf16 v[176:179],v[48:51],a[208:211],v[176:179]
v_mfma_f32_16x16x32_bf16 v[180:183],v[48:51],a[212:215],v[180:183]
buffer_load_dwordx4 v0,s[8:11],s64 offen offset:2048 sc1 lds
v_mfma_f32_16x16x32_bf16 v[184:187],v[48:51],a[216:219],v[184:187]
v_mfma_f32_16x16x32_bf16 v[188:191],v[48:51],a[220:223],v[188:191]
v_mfma_f32_16x16x32_bf16 v[160:163],v[52:55],a[224:227],v[160:163]
v_mfma_f32_16x16x32_bf16 v[164:167],v[52:55],a[228:231],v[164:167]
v_mfma_f32_16x16x32_bf16 v[168:171],v[52:55],a[232:235],v[168:171]
buffer_load_dwordx4 v0,s[8:11],s64 offen offset:3072 sc1 lds
v_mfma_f32_16x16x32_bf16 v[172:175],v[52:55],a[236:239],v[172:175]
v_mfma_f32_16x16x32_bf16 v[176:179],v[52:55],a[240:243],v[176:179]
v_mfma_f32_16x16x32_bf16 v[180:183],v[52:55],a[244:247],v[180:183]
v_mfma_f32_16x16x32_bf16 v[184:187],v[52:55],a[248:251],v[184:187]
v_mfma_f32_16x16x32_bf16 v[188:191],v[52:55],a[252:255],v[188:191]
s_add_u32 m0,s57,24576
v_mfma_f32_16x16x32_bf16 v[192:195],v[56:59],a[0:3],0
buffer_load_dwordx4 v0,s[8:11],s65 offen offset:0 sc1 lds
v_mfma_f32_16x16x32_bf16 v[196:199],v[56:59],a[4:7],0
v_mfma_f32_16x16x32_bf16 v[200:203],v[56:59],a[8:11],0
v_cvt_pk_bf16_f32 v24,v160,v164
v_cvt_pk_bf16_f32 v25,v168,v172
v_mfma_f32_16x16x32_bf16 v[204:207],v[56:59],a[12:15],0
v_cvt_pk_bf16_f32 v26,v176,v180
v_cvt_pk_bf16_f32 v27,v184,v188
v_mfma_f32_16x16x32_bf16 v[208:211],v[56:59],a[16:19],0
v_cvt_pk_bf16_f32 v28,v161,v165
v_cvt_pk_bf16_f32 v29,v169,v173
v_mfma_f32_16x16x32_bf16 v[212:215],v[56:59],a[20:23],0
buffer_load_dwordx4 v0,s[8:11],s65 offen offset:1024 sc1 lds
v_mfma_f32_16x16x32_bf16 v[216:219],v[56:59],a[24:27],0
v_cvt_pk_bf16_f32 v30,v177,v181
v_cvt_pk_bf16_f32 v31,v185,v189
v_mfma_f32_16x16x32_bf16 v[220:223],v[56:59],a[28:31],0
v_cvt_pk_bf16_f32 v32,v162,v166
v_cvt_pk_bf16_f32 v33,v170,v174
v_mfma_f32_16x16x32_bf16 v[192:195],v[60:63],a[32:35],v[192:195]
v_cvt_pk_bf16_f32 v34,v178,v182
v_cvt_pk_bf16_f32 v35,v186,v190
v_mfma_f32_16x16x32_bf16 v[196:199],v[60:63],a[36:39],v[196:199]
v_cvt_pk_bf16_f32 v36,v163,v167
v_cvt_pk_bf16_f32 v37,v171,v175
v_mfma_f32_16x16x32_bf16 v[200:203],v[60:63],a[40:43],v[200:203]
v_cvt_pk_bf16_f32 v38,v179,v183
v_cvt_pk_bf16_f32 v39,v187,v191
v_mfma_f32_16x16x32_bf16 v[204:207],v[60:63],a[44:47],v[204:207]
v_mfma_f32_16x16x32_bf16 v[208:211],v[60:63],a[48:51],v[208:211]
v_mfma_f32_16x16x32_bf16 v[212:215],v[60:63],a[52:55],v[212:215]
v_mfma_f32_16x16x32_bf16 v[216:219],v[60:63],a[56:59],v[216:219]
v_mfma_f32_16x16x32_bf16 v[220:223],v[60:63],a[60:63],v[220:223]
v_mfma_f32_16x16x32_bf16 v[192:195],v[64:67],a[64:67],v[192:195]
v_mfma_f32_16x16x32_bf16 v[196:199],v[64:67],a[68:71],v[196:199]
v_mfma_f32_16x16x32_bf16 v[200:203],v[64:67],a[72:75],v[200:203]
v_mfma_f32_16x16x32_bf16 v[204:207],v[64:67],a[76:79],v[204:207]
v_mfma_f32_16x16x32_bf16 v[208:211],v[64:67],a[80:83],v[208:211]
v_mfma_f32_16x16x32_bf16 v[212:215],v[64:67],a[84:87],v[212:215]
v_mfma_f32_16x16x32_bf16 v[216:219],v[64:67],a[88:91],v[216:219]
v_mfma_f32_16x16x32_bf16 v[220:223],v[64:67],a[92:95],v[220:223]
v_mfma_f32_16x16x32_bf16 v[192:195],v[68:71],a[96:99],v[192:195]
v_mfma_f32_16x16x32_bf16 v[196:199],v[68:71],a[100:103],v[196:199]
v_mfma_f32_16x16x32_bf16 v[200:203],v[68:71],a[104:107],v[200:203]
v_mfma_f32_16x16x32_bf16 v[204:207],v[68:71],a[108:111],v[204:207]
v_mfma_f32_16x16x32_bf16 v[208:211],v[68:71],a[112:115],v[208:211]
s_add_u32 s62,s69,0
v_mfma_f32_16x16x32_bf16 v[212:215],v[68:71],a[116:119],v[212:215]
buffer_store_dwordx4 v[24:27],v5,s[8:11],s62 offen
v_mfma_f32_16x16x32_bf16 v[216:219],v[68:71],a[120:123],v[216:219]
v_mfma_f32_16x16x32_bf16 v[220:223],v[68:71],a[124:127],v[220:223]
v_mfma_f32_16x16x32_bf16 v[192:195],v[72:75],a[128:131],v[192:195]
v_mfma_f32_16x16x32_bf16 v[196:199],v[72:75],a[132:135],v[196:199]
s_add_u32 s62,s69,16384
v_mfma_f32_16x16x32_bf16 v[200:203],v[72:75],a[136:139],v[200:203]
buffer_store_dwordx4 v[28:31],v5,s[8:11],s62 offen
v_mfma_f32_16x16x32_bf16 v[204:207],v[72:75],a[140:143],v[204:207]
v_mfma_f32_16x16x32_bf16 v[208:211],v[72:75],a[144:147],v[208:211]
v_mfma_f32_16x16x32_bf16 v[212:215],v[72:75],a[148:151],v[212:215]
v_mfma_f32_16x16x32_bf16 v[216:219],v[72:75],a[152:155],v[216:219]
s_add_u32 s62,s69,32768
v_mfma_f32_16x16x32_bf16 v[220:223],v[72:75],a[156:159],v[220:223]
buffer_store_dwordx4 v[32:35],v5,s[8:11],s62 offen
v_mfma_f32_16x16x32_bf16 v[192:195],v[76:79],a[160:163],v[192:195]
v_mfma_f32_16x16x32_bf16 v[196:199],v[76:79],a[164:167],v[196:199]
v_mfma_f32_16x16x32_bf16 v[200:203],v[76:79],a[168:171],v[200:203]
v_mfma_f32_16x16x32_bf16 v[204:207],v[76:79],a[172:175],v[204:207]
s_add_u32 s62,s69,49152
v_mfma_f32_16x16x32_bf16 v[208:211],v[76:79],a[176:179],v[208:211]
buffer_store_dwordx4 v[36:39],v5,s[8:11],s62 offen
v_mfma_f32_16x16x32_bf16 v[212:215],v[76:79],a[180:183],v[212:215]
v_mfma_f32_16x16x32_bf16 v[216:219],v[76:79],a[184:187],v[216:219]
v_mfma_f32_16x16x32_bf16 v[220:223],v[76:79],a[188:191],v[220:223]
v_mfma_f32_16x16x32_bf16 v[192:195],v[80:83],a[192:195],v[192:195]
v_mfma_f32_16x16x32_bf16 v[196:199],v[80:83],a[196:199],v[196:199]
v_mfma_f32_16x16x32_bf16 v[192:195],v[84:87],a[224:227],v[192:195]
v_mfma_f32_16x16x32_bf16 v[196:199],v[84:87],a[228:231],v[196:199]
v_mfma_f32_16x16x32_bf16 v[200:203],v[80:83],a[200:203],v[200:203]
v_mfma_f32_16x16x32_bf16 v[204:207],v[80:83],a[204:207],v[204:207]
v_mfma_f32_16x16x32_bf16 v[200:203],v[84:87],a[232:235],v[200:203]
v_mfma_f32_16x16x32_bf16 v[204:207],v[84:87],a[236:239],v[204:207]
v_cvt_pk_bf16_f32 v40,v192,v196
v_cvt_pk_bf16_f32 v44,v193,v197
v_cvt_pk_bf16_f32 v48,v194,v198
v_mfma_f32_16x16x32_bf16 v[208:211],v[80:83],a[208:211],v[208:211]
v_cvt_pk_bf16_f32 v52,v195,v199
v_mfma_f32_16x16x32_bf16 v[212:215],v[80:83],a[212:215],v[212:215]
v_cvt_pk_bf16_f32 v41,v200,v204
v_cvt_pk_bf16_f32 v45,v201,v205
v_cvt_pk_bf16_f32 v49,v202,v206
v_mfma_f32_16x16x32_bf16 v[208:211],v[84:87],a[240:243],v[208:211]
v_cvt_pk_bf16_f32 v53,v203,v207
v_mfma_f32_16x16x32_bf16 v[212:215],v[84:87],a[244:247],v[212:215]
v_mfma_f32_16x16x32_bf16 v[216:219],v[80:83],a[216:219],v[216:219]
v_mfma_f32_16x16x32_bf16 v[220:223],v[80:83],a[220:223],v[220:223]
v_mfma_f32_16x16x32_bf16 v[216:219],v[84:87],a[248:251],v[216:219]
v_mfma_f32_16x16x32_bf16 v[220:223],v[84:87],a[252:255],v[220:223]
v_cvt_pk_bf16_f32 v42,v208,v212
v_cvt_pk_bf16_f32 v46,v209,v213
v_cvt_pk_bf16_f32 v50,v210,v214
v_cvt_pk_bf16_f32 v54,v211,v215
s_nop 3
v_cvt_pk_bf16_f32 v43,v216,v220
s_add_u32 s62,s69,262144
buffer_store_dwordx4 v[40:43],v5,s[8:11],s62 offen
v_cvt_pk_bf16_f32 v47,v217,v221
s_add_u32 s62,s69,278528
buffer_store_dwordx4 v[44:47],v5,s[8:11],s62 offen
v_cvt_pk_bf16_f32 v51,v218,v222
s_add_u32 s62,s69,294912
buffer_store_dwordx4 v[48:51],v5,s[8:11],s62 offen
v_cvt_pk_bf16_f32 v55,v219,v223
s_add_u32 s62,s69,311296
buffer_store_dwordx4 v[52:55],v5,s[8:11],s62 offen
s_cmp_lg_u32 s72,0
s_cbranch_scc1 L_aa_82
s_waitcnt vmcnt(8)
s_branch L_aa_92
L_aa_80:
ds_read_b128 v[24:27],v4 offset:0
ds_read_b128 v[28:31],v4 offset:1024
s_min_u32 s56,s32,s33
s_cmp_lt_u32 s77,64
s_cselect_b32 s56,s56,0
s_cmp_eq_u32 s56,0
s_cselect_b32 s72,0x80000000,0
v_mov_b32 v248,s72
s_or_b32 s64,s70,s72
s_or_b32 s65,s71,s72
s_cmp_lt_u32 s30,s31
s_cselect_b32 s65,0x80000000,s65
s_add_u32 s64,s64,s28
s_add_u32 s65,s65,s29
s_xor_b32 s58,s67,s40
s_xor_b32 s57,s67,s41
s_add_u32 m0,s58,0
s_waitcnt lgkmcnt(1)
v_mfma_f32_16x16x32_bf16 v[160:163],v[24:27],a[0:3],0
buffer_load_dwordx4 v0,s[8:11],s64 offen offset:0 sc1 lds
v_mfma_f32_16x16x32_bf16 v[164:167],v[24:27],a[4:7],0
ds_read_b128 v[32:35],v4 offset:2048
s_lshl_b32 s23,s51,5
v_mfma_f32_16x16x32_bf16 v[168:171],v[24:27],a[8:11],0
ds_read_b128 v[36:39],v4 offset:3072
s_add_u32 s23,s23,s68
v_mfma_f32_16x16x32_bf16 v[172:175],v[24:27],a[12:15],0
ds_read_b128 v[40:43],v4 offset:8192
s_lshl_b32 s24,s23,10
v_mfma_f32_16x16x32_bf16 v[176:179],v[24:27],a[16:19],0
ds_read_b128 v[44:47],v4 offset:9216
s_lshl_b32 s25,s51,10
v_mfma_f32_16x16x32_bf16 v[180:183],v[24:27],a[20:23],0
buffer_load_dwordx4 v0,s[8:11],s64 offen offset:1024 sc1 lds
v_mfma_f32_16x16x32_bf16 v[184:187],v[24:27],a[24:27],0
ds_read_b128 v[48:51],v4 offset:10240
s_add_u32 s25,s25,2883584
v_mfma_f32_16x16x32_bf16 v[188:191],v[24:27],a[28:31],0
ds_read_b128 v[52:55],v4 offset:11264
s_cmp_eq_u32 s23,s55
s_cselect_b32 s25,s25,s24
s_waitcnt lgkmcnt(6)
v_mfma_f32_16x16x32_bf16 v[160:163],v[28:31],a[32:35],v[160:163]
ds_write_b32 v247,v248
s_add_u32 s25,s25,8388608
v_mfma_f32_16x16x32_bf16 v[164:167],v[28:31],a[36:39],v[164:167]
ds_read_b128 v[56:59],v4 offset:4096
s_mov_b32 s6,268435456
v_mfma_f32_16x16x32_bf16 v[168:171],v[28:31],a[40:43],v[168:171]
buffer_load_dwordx4 v0,s[8:11],s64 offen offset:2048 sc1 lds
v_mfma_f32_16x16x32_bf16 v[172:175],v[28:31],a[44:47],v[172:175]
ds_read_b128 v[60:63],v4 offset:5120
s_cmp_eq_u32 s31,0
s_cselect_b32 s25,s24,s25
s_cselect_b64 s[4:5],s[16:17],s[44:45]
s_cmov_b32 s6,2097152
v_mfma_f32_16x16x32_bf16 v[176:179],v[28:31],a[48:51],v[176:179]
ds_read_b128 v[64:67],v4 offset:6144
v_mfma_f32_16x16x32_bf16 v[180:183],v[28:31],a[52:55],v[180:183]
ds_read_b128 v[68:71],v4 offset:7168
v_mfma_f32_16x16x32_bf16 v[184:187],v[28:31],a[56:59],v[184:187]
ds_read_b128 v[72:75],v4 offset:12288
v_mfma_f32_16x16x32_bf16 v[188:191],v[28:31],a[60:63],v[188:191]
buffer_load_dwordx4 v0,s[8:11],s64 offen offset:3072 sc1 lds
s_waitcnt lgkmcnt(11)
v_mfma_f32_16x16x32_bf16 v[160:163],v[32:35],a[64:67],v[160:163]
ds_read_b128 v[76:79],v4 offset:13312
v_mfma_f32_16x16x32_bf16 v[164:167],v[32:35],a[68:71],v[164:167]
ds_read_b128 v[80:83],v4 offset:14336
v_mfma_f32_16x16x32_bf16 v[168:171],v[32:35],a[72:75],v[168:171]
ds_read_b128 v[84:87],v4 offset:15360
v_mfma_f32_16x16x32_bf16 v[172:175],v[32:35],a[76:79],v[172:175]
buffer_load_dwordx4 v[224:227],v0,s[4:7],s25 offen sc1
v_mfma_f32_16x16x32_bf16 v[176:179],v[32:35],a[80:83],v[176:179]
s_add_u32 m0,s58,4096
s_add_u32 s64,s64,4096
s_lshr_b32 s24,s55,5
v_mfma_f32_16x16x32_bf16 v[180:183],v[32:35],a[84:87],v[180:183]
buffer_load_dwordx4 v0,s[8:11],s64 offen offset:0 sc1 lds
v_mfma_f32_16x16x32_bf16 v[184:187],v[32:35],a[88:91],v[184:187]
s_cmp_lt_u32 s51,s24
s_cselect_b32 s24,1,2
v_mov_b32 v252,s24
v_mfma_f32_16x16x32_bf16 v[188:191],v[32:35],a[92:95],v[188:191]
s_waitcnt lgkmcnt(0)
s_barrier
s_lshl2_add_u32 s25,s51,11018240
v_mfma_f32_16x16x32_bf16 v[160:163],v[36:39],a[96:99],v[160:163]
ds_read_b128 v[248:251],v245
s_lshl_b32 s24,s68,16
v_mfma_f32_16x16x32_bf16 v[164:167],v[36:39],a[100:103],v[164:167]
s_add_u32 s24,s24,s31
s_add_u32 s24,s24,s86
s_cmp_eq_u32 s24,1537
s_cselect_b32 s25,s25,0x80000000
v_mfma_f32_16x16x32_bf16 v[168:171],v[36:39],a[104:107],v[168:171]
buffer_load_dwordx4 v0,s[8:11],s64 offen offset:1024 sc1 lds
v_mfma_f32_16x16x32_bf16 v[172:175],v[36:39],a[108:111],v[172:175]
buffer_store_dword v252,off,s[8:11],s25 sc1
v_mfma_f32_16x16x32_bf16 v[176:179],v[36:39],a[112:115],v[176:179]
s_bitcmp1_b64 s[38:39],s51
s_cselect_b32 s24,128,0
s_lshl_b32 s23,s51,13
v_mfma_f32_16x16x32_bf16 v[180:183],v[36:39],a[116:119],v[180:183]
s_lshl2_add_u32 s23,s68,s23
s_add_u32 s23,s23,10487168
s_add_u32 s23,s23,s24
v_mfma_f32_16x16x32_bf16 v[184:187],v[36:39],a[120:123],v[184:187]
buffer_load_dword v246,off,s[8:11],s23 sc1
v_mfma_f32_16x16x32_bf16 v[188:191],v[36:39],a[124:127],v[188:191]
buffer_load_dwordx4 v0,s[8:11],s64 offen offset:2048 sc1 lds
v_mfma_f32_16x16x32_bf16 v[160:163],v[40:43],a[128:131],v[160:163]
s_waitcnt lgkmcnt(0)
v_or3_b32 v248,v248,v249,v250
v_or_b32 v248,v248,v251
v_mfma_f32_16x16x32_bf16 v[164:167],v[40:43],a[132:135],v[164:167]
v_lshrrev_b32 v244,4,v1
s_sub_u32 s23,s77,7
v_mfma_f32_16x16x32_bf16 v[168:171],v[40:43],a[136:139],v[168:171]
v_readfirstlane_b32 s72,v248
v_add_u32 v244,s23,v244
v_mfma_f32_16x16x32_bf16 v[172:175],v[40:43],a[140:143],v[172:175]
v_max_i32 v244,0,v244
v_lshl_add_u32 v244,v244,13,v21
v_mfma_f32_16x16x32_bf16 v[176:179],v[40:43],a[144:147],v[176:179]
buffer_load_dwordx4 v0,s[8:11],s64 offen offset:3072 sc1 lds
v_mfma_f32_16x16x32_bf16 v[180:183],v[40:43],a[148:151],v[180:183]
buffer_load_dwordx2 v[242:243],v244,s[8:11],0 offen sc1
v_mfma_f32_16x16x32_bf16 v[184:187],v[40:43],a[152:155],v[184:187]
s_waitcnt vmcnt(12)
v_mfma_f32_16x16x32_bf16 v[188:191],v[40:43],a[156:159],v[188:191]
buffer_store_dword v20,off,s[8:11],s73 sc1
v_mfma_f32_16x16x32_bf16 v[160:163],v[44:47],a[160:163],v[160:163]
s_mov_b32 s73,0x80000000
v_mfma_f32_16x16x32_bf16 v[164:167],v[44:47],a[164:167],v[164:167]
s_add_u32 m0,s58,8192
s_add_u32 s64,s64,4096
v_mfma_f32_16x16x32_bf16 v[168:171],v[44:47],a[168:171],v[168:171]
buffer_load_dwordx4 v0,s[8:11],s64 offen offset:0 sc1 lds
v_mfma_f32_16x16x32_bf16 v[172:175],v[44:47],a[172:175],v[172:175]
v_mfma_f32_16x16x32_bf16 v[176:179],v[44:47],a[176:179],v[176:179]
v_mfma_f32_16x16x32_bf16 v[180:183],v[44:47],a[180:183],v[180:183]
v_mfma_f32_16x16x32_bf16 v[184:187],v[44:47],a[184:187],v[184:187]
v_mfma_f32_16x16x32_bf16 v[188:191],v[44:47],a[188:191],v[188:191]
buffer_load_dwordx4 v0,s[8:11],s64 offen offset:1024 sc1 lds
v_mfma_f32_16x16x32_bf16 v[160:163],v[48:51],a[192:195],v[160:163]
v_mfma_f32_16x16x32_bf16 v[164:167],v[48:51],a[196:199],v[164:167]
v_mfma_f32_16x16x32_bf16 v[168:171],v[48:51],a[200:203],v[168:171]
v_mfma_f32_16x16x32_bf16 v[172:175],v[48:51],a[204:207],v[172:175]
v_mfma_f32_16x16x32_bf16 v[176:179],v[48:51],a[208:211],v[176:179]
buffer_load_dwordx4 v0,s[8:11],s64 offen offset:2048 sc1 lds
v_mfma_f32_16x16x32_bf16 v[180:183],v[48:51],a[212:215],v[180:183]
v_mfma_f32_16x16x32_bf16 v[184:187],v[48:51],a[216:219],v[184:187]
v_mfma_f32_16x16x32_bf16 v[188:191],v[48:51],a[220:223],v[188:191]
v_mfma_f32_16x16x32_bf16 v[160:163],v[52:55],a[224:227],v[160:163]
v_mfma_f32_16x16x32_bf16 v[164:167],v[52:55],a[228:231],v[164:167]
buffer_load_dwordx4 v0,s[8:11],s64 offen offset:3072 sc1 lds
v_mfma_f32_16x16x32_bf16 v[168:171],v[52:55],a[232:235],v[168:171]
v_mfma_f32_16x16x32_bf16 v[172:175],v[52:55],a[236:239],v[172:175]
v_mfma_f32_16x16x32_bf16 v[176:179],v[52:55],a[240:243],v[176:179]
v_mfma_f32_16x16x32_bf16 v[180:183],v[52:55],a[244:247],v[180:183]
v_mfma_f32_16x16x32_bf16 v[184:187],v[52:55],a[248:251],v[184:187]
s_add_u32 m0,s57,24576
v_mfma_f32_16x16x32_bf16 v[188:191],v[52:55],a[252:255],v[188:191]
buffer_load_dwordx4 v0,s[8:11],s65 offen offset:0 sc1 lds
v_mfma_f32_16x16x32_bf16 v[192:195],v[56:59],a[0:3],0
v_mfma_f32_16x16x32_bf16 v[196:199],v[56:59],a[4:7],0
v_mfma_f32_16x16x32_bf16 v[200:203],v[56:59],a[8:11],0
v_cvt_pk_bf16_f32 v24,v160,v164
v_cvt_pk_bf16_f32 v25,v168,v172
v_mfma_f32_16x16x32_bf16 v[204:207],v[56:59],a[12:15],0
v_cvt_pk_bf16_f32 v26,v176,v180
v_cvt_pk_bf16_f32 v27,v184,v188
v_mfma_f32_16x16x32_bf16 v[208:211],v[56:59],a[16:19],0
buffer_load_dwordx4 v0,s[8:11],s65 offen offset:1024 sc1 lds
v_mfma_f32_16x16x32_bf16 v[212:215],v[56:59],a[20:23],0
v_cvt_pk_bf16_f32 v28,v161,v165
v_cvt_pk_bf16_f32 v29,v169,v173
v_mfma_f32_16x16x32_bf16 v[216:219],v[56:59],a[24:27],0
v_cvt_pk_bf16_f32 v30,v177,v181
v_cvt_pk_bf16_f32 v31,v185,v189
v_mfma_f32_16x16x32_bf16 v[220:223],v[56:59],a[28:31],0
v_cvt_pk_bf16_f32 v32,v162,v166
v_cvt_pk_bf16_f32 v33,v170,v174
v_mfma_f32_16x16x32_bf16 v[192:195],v[60:63],a[32:35],v[192:195]
v_cvt_pk_bf16_f32 v34,v178,v182
v_cvt_pk_bf16_f32 v35,v186,v190
v_mfma_f32_16x16x32_bf16 v[196:199],v[60:63],a[36:39],v[196:199]
v_cvt_pk_bf16_f32 v36,v163,v167
v_cvt_pk_bf16_f32 v37,v171,v175
v_mfma_f32_16x16x32_bf16 v[200:203],v[60:63],a[40:43],v[200:203]
v_cvt_pk_bf16_f32 v38,v179,v183
v_cvt_pk_bf16_f32 v39,v187,v191
v_mfma_f32_16x16x32_bf16 v[204:207],v[60:63],a[44:47],v[204:207]
v_mfma_f32_16x16x32_bf16 v[208:211],v[60:63],a[48:51],v[208:211]
v_mfma_f32_16x16x32_bf16 v[212:215],v[60:63],a[52:55],v[212:215]
v_mfma_f32_16x16x32_bf16 v[216:219],v[60:63],a[56:59],v[216:219]
v_mfma_f32_16x16x32_bf16 v[220:223],v[60:63],a[60:63],v[220:223]
v_mfma_f32_16x16x32_bf16 v[192:195],v[64:67],a[64:67],v[192:195]
v_mfma_f32_16x16x32_bf16 v[196:199],v[64:67],a[68:71],v[196:199]
v_mfma_f32_16x16x32_bf16 v[200:203],v[64:67],a[72:75],v[200:203]
v_mfma_f32_16x16x32_bf16 v[204:207],v[64:67],a[76:79],v[204:207]
v_mfma_f32_16x16x32_bf16 v[208:211],v[64:67],a[80:83],v[208:211]
v_mfma_f32_16x16x32_bf16 v[212:215],v[64:67],a[84:87],v[212:215]
v_mfma_f32_16x16x32_bf16 v[216:219],v[64:67],a[88:91],v[216:219]
v_mfma_f32_16x16x32_bf16 v[220:223],v[64:67],a[92:95],v[220:223]
v_mfma_f32_16x16x32_bf16 v[192:195],v[68:71],a[96:99],v[192:195]
v_mfma_f32_16x16x32_bf16 v[196:199],v[68:71],a[100:103],v[196:199]
v_mfma_f32_16x16x32_bf16 v[200:203],v[68:71],a[104:107],v[200:203]
v_mfma_f32_16x16x32_bf16 v[204:207],v[68:71],a[108:111],v[204:207]
v_mfma_f32_16x16x32_bf16 v[208:211],v[68:71],a[112:115],v[208:211]
s_add_u32 s62,s69,0
v_mfma_f32_16x16x32_bf16 v[212:215],v[68:71],a[116:119],v[212:215]
buffer_store_dwordx4 v[24:27],v5,s[8:11],s62 offen
v_mfma_f32_16x16x32_bf16 v[216:219],v[68:71],a[120:123],v[216:219]
v_mfma_f32_16x16x32_bf16 v[220:223],v[68:71],a[124:127],v[220:223]
v_mfma_f32_16x16x32_bf16 v[192:195],v[72:75],a[128:131],v[192:195]
v_mfma_f32_16x16x32_bf16 v[196:199],v[72:75],a[132:135],v[196:199]
s_add_u32 s62,s69,16384
v_mfma_f32_16x16x32_bf16 v[200:203],v[72:75],a[136:139],v[200:203]
buffer_store_dwordx4 v[28:31],v5,s[8:11],s62 offen
v_mfma_f32_16x16x32_bf16 v[204:207],v[72:75],a[140:143],v[204:207]
v_mfma_f32_16x16x32_bf16 v[208:211],v[72:75],a[144:147],v[208:211]
v_mfma_f32_16x16x32_bf16 v[212:215],v[72:75],a[148:151],v[212:215]
v_mfma_f32_16x16x32_bf16 v[216:219],v[72:75],a[152:155],v[216:219]
s_add_u32 s62,s69,32768
v_mfma_f32_16x16x32_bf16 v[220:223],v[72:75],a[156:159],v[220:223]
buffer_store_dwordx4 v[32:35],v5,s[8:11],s62 offen
v_mfma_f32_16x16x32_bf16 v[192:195],v[76:79],a[160:163],v[192:195]
v_mfma_f32_16x16x32_bf16 v[196:199],v[76:79],a[164:167],v[196:199]
v_mfma_f32_16x16x32_bf16 v[200:203],v[76:79],a[168:171],v[200:203]
v_mfma_f32_16x16x32_bf16 v[204:207],v[76:79],a[172:175],v[204:207]
s_add_u32 s62,s69,49152
v_mfma_f32_16x16x32_bf16 v[208:211],v[76:79],a[176:179],v[208:211]
buffer_store_dwordx4 v[36:39],v5,s[8:11],s62 offen
v_mfma_f32_16x16x32_bf16 v[212:215],v[76:79],a[180:183],v[212:215]
v_mfma_f32_16x16x32_bf16 v[216:219],v[76:79],a[184:187],v[216:219]
v_mfma_f32_16x16x32_bf16 v[220:223],v[76:79],a[188:191],v[220:223]
v_mfma_f32_16x16x32_bf16 v[192:195],v[80:83],a[192:195],v[192:195]
v_mfma_f32_16x16x32_bf16 v[196:199],v[80:83],a[196:199],v[196:199]
v_mfma_f32_16x16x32_bf16 v[192:195],v[84:87],a[224:227],v[192:195]
v_mfma_f32_16x16x32_bf16 v[196:199],v[84:87],a[228:231],v[196:199]
v_mfma_f32_16x16x32_bf16 v[200:203],v[80:83],a[200:203],v[200:203]
v_mfma_f32_16x16x32_bf16 v[204:207],v[80:83],a[204:207],v[204:207]
v_mfma_f32_16x16x32_bf16 v[200:203],v[84:87],a[232:235],v[200:203]
v_mfma_f32_16x16x32_bf16 v[204:207],v[84:87],a[236:239],v[204:207]
v_cvt_pk_bf16_f32 v40,v192,v196
v_cvt_pk_bf16_f32 v44,v193,v197
v_cvt_pk_bf16_f32 v48,v194,v198
v_mfma_f32_16x16x32_bf16 v[208:211],v[80:83],a[208:211],v[208:211]
v_cvt_pk_bf16_f32 v52,v195,v199
v_mfma_f32_16x16x32_bf16 v[212:215],v[80:83],a[212:215],v[212:215]
v_cvt_pk_bf16_f32 v41,v200,v204
v_cvt_pk_bf16_f32 v45,v201,v205
v_cvt_pk_bf16_f32 v49,v202,v206
v_mfma_f32_16x16x32_bf16 v[208:211],v[84:87],a[240:243],v[208:211]
v_cvt_pk_bf16_f32 v53,v203,v207
v_mfma_f32_16x16x32_bf16 v[212:215],v[84:87],a[244:247],v[212:215]
v_mfma_f32_16x16x32_bf16 v[216:219],v[80:83],a[216:219],v[216:219]
v_mfma_f32_16x16x32_bf16 v[220:223],v[80:83],a[220:223],v[220:223]
v_mfma_f32_16x16x32_bf16 v[216:219],v[84:87],a[248:251],v[216:219]
v_mfma_f32_16x16x32_bf16 v[220:223],v[84:87],a[252:255],v[220:223]
v_cvt_pk_bf16_f32 v42,v208,v212
v_cvt_pk_bf16_f32 v46,v209,v213
v_cvt_pk_bf16_f32 v50,v210,v214
v_cvt_pk_bf16_f32 v54,v211,v215
s_nop 3
v_cvt_pk_bf16_f32 v43,v216,v220
s_add_u32 s62,s69,262144
buffer_store_dwordx4 v[40:43],v5,s[8:11],s62 offen
v_cvt_pk_bf16_f32 v47,v217,v221
s_add_u32 s62,s69,278528
buffer_store_dwordx4 v[44:47],v5,s[8:11],s62 offen
v_cvt_pk_bf16_f32 v51,v218,v222
s_add_u32 s62,s69,294912
buffer_store_dwordx4 v[48:51],v5,s[8:11],s62 offen
v_cvt_pk_bf16_f32 v55,v219,v223
s_add_u32 s62,s69,311296
buffer_store_dwordx4 v[52:55],v5,s[8:11],s62 offen
s_cmp_lg_u32 s72,0
s_cbranch_scc1 L_aa_82
s_waitcnt vmcnt(8)
L_aa_92:
s_barrier
s_cmp_lt_u32 s30,s31
s_cbranch_scc1 L_ao_99
s_xor_b32 s67,s67,65536
s_and_b32 s56,s50,2048
s_lshl_b32 s56,s56,4
s_add_u32 s56,s56,s67
v_add_u32 v2,s56,v0
s_and_b32 s56,s50,1024
s_lshl_b32 s56,s56,2
v_add_u32 v238,s56,v2
s_mov_b32 s76,s71
s_mov_b32 s53,s77
ds_read_b128 v[24:27],v238 offset:16384
ds_read_b128 v[40:43],v2 offset:0
ds_read_b128 v[56:59],v2 offset:4096
ds_read_b128 v[28:31],v238 offset:17408
ds_read_b128 v[44:47],v2 offset:1024
ds_read_b128 v[60:63],v2 offset:5120
ds_read_b128 v[32:35],v238 offset:18432
ds_read_b128 v[48:51],v2 offset:2048
ds_read_b128 v[64:67],v2 offset:6144
ds_read_b128 v[36:39],v238 offset:19456
ds_read_b128 v[52:55],v2 offset:3072
ds_read_b128 v[68:71],v2 offset:7168
s_waitcnt lgkmcnt(9)
v_mfma_f32_16x16x32_bf16 v[128:131],v[40:43],v[24:27],v[8:11]
ds_read_b128 v[72:75],v2 offset:24576
v_mfma_f32_16x16x32_bf16 v[132:135],v[56:59],v[24:27],v[12:15]
ds_read_b128 v[76:79],v2 offset:25600
s_waitcnt lgkmcnt(8)
v_mfma_f32_16x16x32_bf16 v[128:131],v[44:47],v[28:31],v[128:131]
ds_read_b128 v[80:83],v2 offset:26624
v_mfma_f32_16x16x32_bf16 v[132:135],v[60:63],v[28:31],v[132:135]
ds_read_b128 v[84:87],v2 offset:27648
s_waitcnt lgkmcnt(7)
v_mfma_f32_16x16x32_bf16 v[128:131],v[48:51],v[32:35],v[128:131]
ds_read_b128 v[88:91],v2 offset:8192
v_mfma_f32_16x16x32_bf16 v[132:135],v[64:67],v[32:35],v[132:135]
ds_read_b128 v[92:95],v2 offset:9216
s_waitcnt lgkmcnt(6)
v_mfma_f32_16x16x32_bf16 v[128:131],v[52:55],v[36:39],v[128:131]
ds_read_b128 v[96:99],v2 offset:10240
v_mfma_f32_16x16x32_bf16 v[132:135],v[68:71],v[36:39],v[132:135]
ds_read_b128 v[100:103],v2 offset:11264
s_waitcnt lgkmcnt(4)
s_mov_b32 vcc_lo,0x33333333
s_mov_b32 vcc_hi,0x33333333
v_mfma_f32_16x16x32_bf16 v[136:139],v[72:75],v[24:27],0
ds_read_b128 v[104:107],v2 offset:12288
v_max3_u32 v238,v72,v73,v74
v_max3_u32 v238,v74,v75,v238
v_cndmask_b32_dpp v120,v72,v74,vcc quad_perm:[0,1,0,1] row_mask:0xf bank_mask:0xf
v_cndmask_b32_dpp v121,v73,v75,vcc quad_perm:[0,1,0,1] row_mask:0xf bank_mask:0xf
v_mfma_f32_16x16x32_bf16 v[136:139],v[76:79],v[28:31],v[136:139]
ds_read_b128 v[108:111],v2 offset:13312
v_max3_u32 v238,v76,v77,v238
v_max3_u32 v238,v78,v79,v238
v_cndmask_b32_dpp v122,v76,v78,vcc quad_perm:[0,1,0,1] row_mask:0xf bank_mask:0xf
v_cndmask_b32_dpp v123,v77,v79,vcc quad_perm:[0,1,0,1] row_mask:0xf bank_mask:0xf
v_mfma_f32_16x16x32_bf16 v[136:139],v[80:83],v[32:35],v[136:139]
ds_read_b128 v[112:115],v2 offset:14336
v_max3_u32 v238,v80,v81,v238
v_max3_u32 v238,v82,v83,v238
v_cndmask_b32_dpp v124,v80,v82,vcc quad_perm:[0,1,0,1] row_mask:0xf bank_mask:0xf
v_cndmask_b32_dpp v125,v81,v83,vcc quad_perm:[0,1,0,1] row_mask:0xf bank_mask:0xf
v_mfma_f32_16x16x32_bf16 v[136:139],v[84:87],v[36:39],v[136:139]
ds_read_b128 v[116:119],v2 offset:15360
v_max3_u32 v238,v84,v85,v238
v_max3_u32 v238,v86,v87,v238
v_cndmask_b32_dpp v126,v84,v86,vcc quad_perm:[0,1,0,1] row_mask:0xf bank_mask:0xf
v_cndmask_b32_dpp v127,v85,v87,vcc quad_perm:[0,1,0,1] row_mask:0xf bank_mask:0xf
v_cmp_eq_u32 vcc,-1,v238
s_cmp_eq_u32 s30,0
s_cbranch_scc1 L_aa_81
s_cmp_lg_u64 vcc,0
s_cselect_b32 s27,1,0
s_andn2_b32 s57,s27,s31
s_add_u32 s66,s66,4
s_bfe_u32 s56,s66,0x10002
s_bitset0_b32 s37,s56
s_lshl_b32 s56,s57,s56
s_or_b32 s37,s37,s56
s_or_b32 s56,s37,s66
v_mov_b32 v22,s56
s_xor_b32 s69,s69,524288
s_waitcnt vmcnt(0) lgkmcnt(0)
buffer_store_dword v22,off,s[8:11],s74
s_cmp_lg_u32 s86,1536
s_cbranch_scc1 L_ae_102
s_mov_b32 s77,s35
s_mov_b32 s30,0
s_lshl_b32 s56,s77,5
s_add_u32 s56,s56,s68
s_mul_i32 s70,s56,24576
s_lshl_b32 s71,s56,12
s_lshl_b32 s59,s77,13
s_lshl2_add_u32 s59,s68,s59
s_add_u32 s59,s59,10485760
s_buffer_load_dword s32,s[8:11],s59
s_mov_b32 s33,1
s_add_u32 s70,s70,100663296
s_add_u32 s71,s71,41943040
v_mov_b32 v19,s59
s_branch L_af_103
L_ae_102:
s_ff1_i32_b64 s77,s[84:85]
s_bitset0_b64 s[84:85],s77
s_min_u32 s77,s77,64
s_lshr_b32 s61,s55,5
s_lshl_b32 s56,s77,5
s_add_u32 s56,s56,s68
s_mul_i32 s70,s56,24576
s_lshl_b32 s71,s56,12
s_lshl_b32 s59,s77,13
s_lshl2_add_u32 s59,s68,s59
s_add_u32 s59,s59,10486144
s_cmp_lt_u32 s77,s61
s_cselect_b32 s57,0,16777216
s_mov_b32 s60,s59
s_buffer_load_dword s33,s[8:11],s60
s_add_u32 s71,s71,s57
s_add_u32 s71,s71,58720256
s_cmp_eq_u32 s77,s61
s_cselect_b32 s57,50331648,0
s_cselect_b32 s58,1536,0
s_add_u32 s59,s59,s58
s_buffer_load_dword s32,s[8:11],s59
s_add_u32 s70,s70,s57
s_add_u32 s70,s70,150994944
v_mov_b32 v19,s59
v_writelane_b32 v19,s60,1
L_af_103:
s_cmp_ge_u32 s53,60
s_cbranch_scc1 L_a4_104
L_a4_105:
s_and_b32 s27,s27,s31
s_cbranch_scc1 L_ac_107
L_acb_108:
v_max3_f32 v238,v128,v129,v130
v_max3_f32 v239,v131,v132,v133
v_max3_f32 v238,v134,v135,v238
v_max3_f32 v239,v138,v139,v239
v_max_f32 v238,v238,v239
v_max_f32 v239,v238,v239
v_pk_mul_f32 v[128:129],v[128:129],v[152:153] op_sel_hi:[1,0]
v_pk_mul_f32 v[130:131],v[130:131],v[152:153] op_sel_hi:[1,0]
v_permlane16_swap_b32 v238,v239
v_max_f32 v238,v238,v239
v_max_f32 v239,v238,v239
v_pk_mul_f32 v[132:133],v[132:133],v[152:153] op_sel_hi:[1,0]
v_pk_mul_f32 v[134:135],v[134:135],v[152:153] op_sel_hi:[1,0]
v_permlane32_swap_b32 v238,v239
v_max_f32 v238,v238,v239
v_mul_f32 v238,v152,v238
v_pk_mul_f32 v[138:139],v[138:139],v[152:153] op_sel_hi:[1,0]
buffer_load_dword v17,v16,s[8:11],s87 offen sc1
v_pk_add_f32 v[128:129],v[128:129],v[238:239] op_sel_hi:[1,0] neg_lo:[0,1] neg_hi:[0,1]
v_pk_add_f32 v[130:131],v[130:131],v[238:239] op_sel_hi:[1,0] neg_lo:[0,1] neg_hi:[0,1]
v_pk_add_f32 v[132:133],v[132:133],v[238:239] op_sel_hi:[1,0] neg_lo:[0,1] neg_hi:[0,1]
v_pk_add_f32 v[134:135],v[134:135],v[238:239] op_sel_hi:[1,0] neg_lo:[0,1] neg_hi:[0,1]
v_pk_add_f32 v[138:139],v[138:139],v[238:239] op_sel_hi:[1,0] neg_lo:[0,1] neg_hi:[0,1]
v_exp_f32 v128,v128
v_exp_f32 v129,v129
v_exp_f32 v130,v130
v_exp_f32 v131,v131
v_exp_f32 v132,v132
v_exp_f32 v133,v133
v_exp_f32 v134,v134
v_exp_f32 v135,v135
v_exp_f32 v138,v138
v_exp_f32 v139,v139
v_pk_add_f32 v[148:149],v[128:129],v[130:131]
v_pk_add_f32 v[150:151],v[132:133],v[134:135]
v_pk_add_f32 v[148:149],v[148:149],v[138:139]
v_pk_add_f32 v[148:149],v[148:149],v[150:151]
v_add_f32 v150,v148,v149
v_add_f32 v151,v148,v149
s_nop 1
v_permlane16_swap_b32 v150,v151
v_add_f32 v148,v150,v151
v_add_f32 v149,v150,v151
s_nop 1
v_permlane32_swap_b32 v148,v149
v_add_f32 v148,v148,v149
v_rcp_f32 v148,v148
s_waitcnt vmcnt(0)
v_cmp_gt_u32 vcc,s66,v17
v_pk_mul_f32 v[138:139],v[138:139],v[148:149] op_sel_hi:[1,0]
v_pk_mul_f32 v[128:129],v[128:129],v[148:149] op_sel_hi:[1,0]
v_pk_mul_f32 v[130:131],v[130:131],v[148:149] op_sel_hi:[1,0]
v_pk_mul_f32 v[132:133],v[132:133],v[148:149] op_sel_hi:[1,0]
v_pk_mul_f32 v[134:135],v[134:135],v[148:149] op_sel_hi:[1,0]
s_cbranch_vccnz L_ap_110
L_apb_111:
s_xor_b32 s34,s69,524288
buffer_load_dwordx4 v[192:195],v7,s[8:11],s34 offen sc1
s_bfe_u32 s56,s66,0x10002
v_lshrrev_b32 v238,s56,v17
v_and_b32 v238,1,v238
v_cmp_ne_u32 vcc,0,v238
v_cvt_pk_bf16_f32 v144,v138,v139
v_cvt_pk_bf16_f32 v147,v138,v139
v_cvt_pk_bf16_f32 v140,v128,v129
v_cvt_pk_bf16_f32 v141,v130,v131
v_cvt_pk_bf16_f32 v142,v132,v133
v_cvt_pk_bf16_f32 v143,v134,v135
s_cbranch_vccnz L_ak_101
s_add_u32 s36,s36,4
v_mfma_f32_16x16x16_bf16 v[24:27],v[120:121],v[144:145],0
s_add_u32 s34,s34,4096
v_mfma_f32_16x16x16_bf16 v[28:31],v[120:121],v[146:147],0
buffer_load_dwordx4 v[196:199],v7,s[8:11],s34 offen sc1
v_mfma_f32_16x16x16_bf16 v[32:35],v[122:123],v[144:145],0
s_add_u32 s34,s34,4096
v_mfma_f32_16x16x16_bf16 v[36:39],v[122:123],v[146:147],0
buffer_load_dwordx4 v[200:203],v7,s[8:11],s34 offen sc1
v_mfma_f32_16x16x16_bf16 v[40:43],v[124:125],v[144:145],0
s_add_u32 s34,s34,4096
v_mfma_f32_16x16x16_bf16 v[44:47],v[124:125],v[146:147],0
buffer_load_dwordx4 v[204:207],v7,s[8:11],s34 offen sc1
v_mfma_f32_16x16x16_bf16 v[48:51],v[126:127],v[144:145],0
s_add_u32 s34,s34,4096
v_mfma_f32_16x16x16_bf16 v[52:55],v[126:127],v[146:147],0
buffer_load_dwordx4 v[208:211],v7,s[8:11],s34 offen sc1
v_mfma_f32_16x16x32_bf16 v[24:27],v[88:91],v[140:143],v[24:27]
s_add_u32 s34,s34,4096
v_mfma_f32_16x16x32_bf16 v[28:31],v[92:95],v[140:143],v[28:31]
buffer_load_dwordx4 v[212:215],v7,s[8:11],s34 offen sc1
v_mfma_f32_16x16x32_bf16 v[32:35],v[96:99],v[140:143],v[32:35]
s_add_u32 s34,s34,4096
v_mfma_f32_16x16x32_bf16 v[36:39],v[100:103],v[140:143],v[36:39]
buffer_load_dwordx4 v[216:219],v7,s[8:11],s34 offen sc1
v_cvt_pk_bf16_f32 v72,v24,v28
v_cvt_pk_bf16_f32 v73,v25,v29
v_mfma_f32_16x16x32_bf16 v[40:43],v[104:107],v[140:143],v[40:43]
s_add_u32 s34,s34,4096
v_cvt_pk_bf16_f32 v74,v26,v30
v_cvt_pk_bf16_f32 v75,v27,v31
v_mfma_f32_16x16x32_bf16 v[44:47],v[108:111],v[140:143],v[44:47]
ds_write_b128 v3,v[72:75] offset:0
v_cvt_pk_bf16_f32 v76,v32,v36
v_cvt_pk_bf16_f32 v77,v33,v37
v_mfma_f32_16x16x32_bf16 v[48:51],v[112:115],v[140:143],v[48:51]
buffer_load_dwordx4 v[220:223],v7,s[8:11],s34 offen sc1
v_cvt_pk_bf16_f32 v78,v34,v38
v_cvt_pk_bf16_f32 v79,v35,v39
v_mfma_f32_16x16x32_bf16 v[52:55],v[116:119],v[140:143],v[52:55]
ds_write_b128 v3,v[76:79] offset:1024
v_cvt_pk_bf16_f32 v80,v40,v44
v_cvt_pk_bf16_f32 v81,v41,v45
v_cvt_pk_bf16_f32 v82,v42,v46
v_cvt_pk_bf16_f32 v83,v43,v47
ds_write_b128 v3,v[80:83] offset:2048
s_nop 1
v_cvt_pk_bf16_f32 v84,v48,v52
v_cvt_pk_bf16_f32 v85,v49,v53
v_cvt_pk_bf16_f32 v86,v50,v54
v_cvt_pk_bf16_f32 v87,v51,v55
ds_write_b128 v3,v[84:87] offset:3072
s_cmp_eq_u32 s31,0
s_cbranch_scc1 L_ah_109
s_waitcnt lgkmcnt(0)
s_barrier
s_mov_b32 s26,s51
s_mov_b32 s51,s53
s_branch L_aa_93
L_ah_109:
s_cmp_ge_u32 s35,64
s_cbranch_scc1 L_a1_112
L_a2_113:
s_waitcnt vmcnt(7)
v_mfma_f32_16x16x32_bf16 v[160:163],v[156:159],v[192:195],0
s_waitcnt vmcnt(6)
v_mfma_f32_16x16x32_bf16 v[160:163],v[156:159],v[196:199],v[160:163]
s_waitcnt vmcnt(5)
v_mfma_f32_16x16x32_bf16 v[160:163],v[156:159],v[200:203],v[160:163]
s_waitcnt vmcnt(4)
v_mfma_f32_16x16x32_bf16 v[160:163],v[156:159],v[204:207],v[160:163]
s_waitcnt vmcnt(3)
v_mfma_f32_16x16x32_bf16 v[164:167],v[156:159],v[208:211],0
s_waitcnt vmcnt(2)
v_mfma_f32_16x16x32_bf16 v[164:167],v[156:159],v[212:215],v[164:167]
s_waitcnt vmcnt(1)
v_mfma_f32_16x16x32_bf16 v[164:167],v[156:159],v[216:219],v[164:167]
ds_write_b128 v6,v[160:163]
s_waitcnt vmcnt(0)
v_mfma_f32_16x16x32_bf16 v[164:167],v[156:159],v[220:223],v[164:167]
s_nop 7
ds_write_b128 v6,v[164:167] offset:2048
s_waitcnt lgkmcnt(0)
s_barrier
buffer_store_dword v20,off,s[8:11],s73 sc1
s_mov_b32 s73,0x80000000
s_mov_b32 s27,1
s_branch L_aa_84
L_ao_99:
s_xor_b32 s67,s67,65536
s_and_b32 s56,s50,2048
s_lshl_b32 s56,s56,4
s_add_u32 s56,s56,s67
v_add_u32 v2,s56,v0
s_and_b32 s56,s50,1024
s_lshl_b32 s56,s56,2
v_add_u32 v238,s56,v2
s_mov_b32 s76,s71
s_mov_b32 s53,s77
ds_read_b128 v[24:27],v238 offset:16384
ds_read_b128 v[40:43],v2 offset:0
ds_read_b128 v[56:59],v2 offset:4096
ds_read_b128 v[28:31],v238 offset:17408
ds_read_b128 v[44:47],v2 offset:1024
ds_read_b128 v[60:63],v2 offset:5120
ds_read_b128 v[32:35],v238 offset:18432
ds_read_b128 v[48:51],v2 offset:2048
ds_read_b128 v[64:67],v2 offset:6144
ds_read_b128 v[36:39],v238 offset:19456
ds_read_b128 v[52:55],v2 offset:3072
ds_read_b128 v[68:71],v2 offset:7168
buffer_load_dwordx4 v[72:75],v0,s[8:11],s76 offen offset:0 sc1
buffer_load_dwordx4 v[76:79],v0,s[8:11],s76 offen offset:1024 sc1
buffer_load_dwordx4 v[80:83],v0,s[8:11],s76 offen offset:2048 sc1
buffer_load_dwordx4 v[84:87],v0,s[8:11],s76 offen offset:3072 sc1
s_waitcnt lgkmcnt(9)
v_mfma_f32_16x16x32_bf16 v[128:131],v[40:43],v[24:27],v[8:11]
ds_read_b128 v[88:91],v2 offset:8192
v_mfma_f32_16x16x32_bf16 v[132:135],v[56:59],v[24:27],v[12:15]
ds_read_b128 v[92:95],v2 offset:9216
s_waitcnt lgkmcnt(8)
v_mfma_f32_16x16x32_bf16 v[128:131],v[44:47],v[28:31],v[128:131]
ds_read_b128 v[96:99],v2 offset:10240
v_mfma_f32_16x16x32_bf16 v[132:135],v[60:63],v[28:31],v[132:135]
ds_read_b128 v[100:103],v2 offset:11264
s_waitcnt lgkmcnt(7)
v_mfma_f32_16x16x32_bf16 v[128:131],v[48:51],v[32:35],v[128:131]
ds_read_b128 v[104:107],v2 offset:12288
v_mfma_f32_16x16x32_bf16 v[132:135],v[64:67],v[32:35],v[132:135]
ds_read_b128 v[108:111],v2 offset:13312
s_waitcnt lgkmcnt(6)
v_mfma_f32_16x16x32_bf16 v[128:131],v[52:55],v[36:39],v[128:131]
ds_read_b128 v[112:115],v2 offset:14336
v_mfma_f32_16x16x32_bf16 v[132:135],v[68:71],v[36:39],v[132:135]
ds_read_b128 v[116:119],v2 offset:15360
s_add_u32 s66,s66,4
s_bfe_u32 s56,s66,0x10002
s_bitset0_b32 s37,s56
s_lshl_b32 s56,0,s56
s_or_b32 s37,s37,s56
s_or_b32 s56,s37,s66
v_mov_b32 v22,s56
s_xor_b32 s69,s69,524288
s_waitcnt vmcnt(4) lgkmcnt(0)
buffer_store_dword v22,off,s[8:11],s74
s_mov_b32 s26,s51
s_mov_b32 s27,3
s_branch L_aa_88
L_aa_81:
s_add_u32 s66,s66,4
s_bfe_u32 s56,s66,0x10002
s_bitset0_b32 s37,s56
s_lshl_b32 s56,0,s56
s_or_b32 s37,s37,s56
s_or_b32 s56,s37,s66
v_mov_b32 v22,s56
s_xor_b32 s69,s69,524288
s_waitcnt vmcnt(0) lgkmcnt(0)
buffer_store_dword v22,off,s[8:11],s74
L_aq_114:
buffer_load_dword v17,v16,s[8:11],s87 offen sc1
s_sub_u32 s49,s49,1
s_cbranch_scc1 L_abort
s_waitcnt vmcnt(0)
v_cmp_gt_u32 vcc,s66,v17
s_cbranch_vccnz L_aq_114
s_xor_b32 s34,s69,524288
buffer_load_dwordx4 v[160:163],v7,s[8:11],s34 offen sc1
s_add_u32 s34,s34,4096
buffer_load_dwordx4 v[164:167],v7,s[8:11],s34 offen sc1
s_add_u32 s34,s34,4096
buffer_load_dwordx4 v[168:171],v7,s[8:11],s34 offen sc1
s_add_u32 s34,s34,4096
buffer_load_dwordx4 v[172:175],v7,s[8:11],s34 offen sc1
s_add_u32 s34,s34,4096
buffer_load_dwordx4 v[176:179],v7,s[8:11],s34 offen sc1
s_add_u32 s34,s34,4096
buffer_load_dwordx4 v[180:183],v7,s[8:11],s34 offen sc1
s_add_u32 s34,s34,4096
buffer_load_dwordx4 v[184:187],v7,s[8:11],s34 offen sc1
s_add_u32 s34,s34,4096
buffer_load_dwordx4 v[188:191],v7,s[8:11],s34 offen sc1
buffer_load_dwordx4 v[72:75],v0,s[8:11],s76 offen offset:0 sc1
buffer_load_dwordx4 v[76:79],v0,s[8:11],s76 offen offset:1024 sc1
buffer_load_dwordx4 v[80:83],v0,s[8:11],s76 offen offset:2048 sc1
buffer_load_dwordx4 v[84:87],v0,s[8:11],s76 offen offset:3072 sc1
s_waitcnt vmcnt(11)
v_mfma_f32_16x16x32_bf16 v[192:195],v[156:159],v[160:163],0
s_waitcnt vmcnt(10)
v_mfma_f32_16x16x32_bf16 v[192:195],v[156:159],v[164:167],v[192:195]
s_waitcnt vmcnt(9)
v_mfma_f32_16x16x32_bf16 v[192:195],v[156:159],v[168:171],v[192:195]
s_waitcnt vmcnt(8)
v_mfma_f32_16x16x32_bf16 v[192:195],v[156:159],v[172:175],v[192:195]
s_waitcnt vmcnt(7)
v_mfma_f32_16x16x32_bf16 v[196:199],v[156:159],v[176:179],0
s_waitcnt vmcnt(6)
v_mfma_f32_16x16x32_bf16 v[196:199],v[156:159],v[180:183],v[196:199]
s_waitcnt vmcnt(5)
v_mfma_f32_16x16x32_bf16 v[196:199],v[156:159],v[184:187],v[196:199]
ds_write_b128 v6,v[192:195]
s_waitcnt vmcnt(4)
v_mfma_f32_16x16x32_bf16 v[196:199],v[156:159],v[188:191],v[196:199]
s_nop 7
ds_write_b128 v6,v[196:199] offset:2048
s_waitcnt lgkmcnt(0)
s_barrier
buffer_store_dword v20,off,s[8:11],s73 sc1
s_mov_b32 s73,0x80000000
s_mov_b32 s27,0
s_branch L_aa_84
L_aa_82:
s_add_u32 s56,s30,s86
s_cmp_lg_u32 s56,1537
s_cbranch_scc1 L_al_100
s_add_u32 s66,s66,4
s_bfe_u32 s56,s66,0x10002
s_bitset0_b32 s37,s56
s_lshl_b32 s56,1,s56
s_or_b32 s37,s37,s56
s_or_b32 s56,s37,s66
v_mov_b32 v22,s56
s_xor_b32 s69,s69,524288
s_waitcnt vmcnt(0) lgkmcnt(0)
buffer_store_dword v22,off,s[8:11],s74
s_cmp_lg_u32 s86,1536
s_cbranch_scc1 L_ae_115
s_mov_b32 s77,s35
s_mov_b32 s30,0
s_lshl_b32 s56,s77,5
s_add_u32 s56,s56,s68
s_mul_i32 s70,s56,24576
s_lshl_b32 s71,s56,12
s_lshl_b32 s59,s77,13
s_lshl2_add_u32 s59,s68,s59
s_add_u32 s59,s59,10485760
s_buffer_load_dword s32,s[8:11],s59
s_mov_b32 s33,1
s_add_u32 s70,s70,100663296
s_add_u32 s71,s71,41943040
v_mov_b32 v19,s59
s_branch L_af_116
L_ae_115:
s_ff1_i32_b64 s77,s[84:85]
s_bitset0_b64 s[84:85],s77
s_min_u32 s77,s77,64
s_lshr_b32 s61,s55,5
s_lshl_b32 s56,s77,5
s_add_u32 s56,s56,s68
s_mul_i32 s70,s56,24576
s_lshl_b32 s71,s56,12
s_lshl_b32 s59,s77,13
s_lshl2_add_u32 s59,s68,s59
s_add_u32 s59,s59,10486144
s_cmp_lt_u32 s77,s61
s_cselect_b32 s57,0,16777216
s_mov_b32 s60,s59
s_buffer_load_dword s33,s[8:11],s60
s_add_u32 s71,s71,s57
s_add_u32 s71,s71,58720256
s_cmp_eq_u32 s77,s61
s_cselect_b32 s57,50331648,0
s_cselect_b32 s58,1536,0
s_add_u32 s59,s59,s58
s_buffer_load_dword s32,s[8:11],s59
s_add_u32 s70,s70,s57
s_add_u32 s70,s70,150994944
v_mov_b32 v19,s59
v_writelane_b32 v19,s60,1
L_af_116:
s_branch L_ak_101
L_al_100:
s_add_u32 s66,s66,4
s_bfe_u32 s56,s66,0x10002
s_bitset0_b32 s37,s56
s_lshl_b32 s56,0,s56
s_or_b32 s37,s37,s56
s_or_b32 s56,s37,s66
v_mov_b32 v22,s56
s_xor_b32 s69,s69,524288
s_waitcnt vmcnt(0) lgkmcnt(0)
buffer_store_dword v22,off,s[8:11],s74
buffer_store_dword v20,off,s[8:11],s73 sc1
s_mov_b32 s73,0x80000000
L_ak_101:
L_aq_117:
buffer_load_dword v17,v16,s[8:11],s87 offen sc1
s_sub_u32 s49,s49,1
s_cbranch_scc1 L_abort
s_waitcnt vmcnt(0)
v_cmp_gt_u32 vcc,s66,v17
s_cbranch_vccnz L_aq_117
s_xor_b32 s34,s69,524288
buffer_load_dwordx4 v[160:163],v7,s[8:11],s34 offen sc1
s_add_u32 s34,s34,4096
buffer_load_dwordx4 v[164:167],v7,s[8:11],s34 offen sc1
s_add_u32 s34,s34,4096
buffer_load_dwordx4 v[168:171],v7,s[8:11],s34 offen sc1
s_add_u32 s34,s34,4096
buffer_load_dwordx4 v[172:175],v7,s[8:11],s34 offen sc1
s_add_u32 s34,s34,4096
buffer_load_dwordx4 v[176:179],v7,s[8:11],s34 offen sc1
s_add_u32 s34,s34,4096
buffer_load_dwordx4 v[180:183],v7,s[8:11],s34 offen sc1
s_add_u32 s34,s34,4096
buffer_load_dwordx4 v[184:187],v7,s[8:11],s34 offen sc1
s_add_u32 s34,s34,4096
buffer_load_dwordx4 v[188:191],v7,s[8:11],s34 offen sc1
s_waitcnt vmcnt(7)
v_mfma_f32_16x16x32_bf16 v[192:195],v[156:159],v[160:163],0
s_waitcnt vmcnt(6)
v_mfma_f32_16x16x32_bf16 v[192:195],v[156:159],v[164:167],v[192:195]
s_waitcnt vmcnt(5)
v_mfma_f32_16x16x32_bf16 v[192:195],v[156:159],v[168:171],v[192:195]
s_waitcnt vmcnt(4)
v_mfma_f32_16x16x32_bf16 v[192:195],v[156:159],v[172:175],v[192:195]
s_waitcnt vmcnt(3)
v_mfma_f32_16x16x32_bf16 v[196:199],v[156:159],v[176:179],0
s_waitcnt vmcnt(2)
v_mfma_f32_16x16x32_bf16 v[196:199],v[156:159],v[180:183],v[196:199]
s_waitcnt vmcnt(1)
v_mfma_f32_16x16x32_bf16 v[196:199],v[156:159],v[184:187],v[196:199]
ds_write_b128 v6,v[192:195]
s_waitcnt vmcnt(0)
v_mfma_f32_16x16x32_bf16 v[196:199],v[156:159],v[188:191],v[196:199]
s_nop 7
ds_write_b128 v6,v[196:199] offset:2048
s_waitcnt lgkmcnt(0)
s_barrier
buffer_store_dword v20,off,s[8:11],s73 sc1
s_mov_b32 s73,0x80000000
s_mov_b32 s27,2
L_aa_84:
s_cmp_lg_u32 s31,0
s_cbranch_scc1 L_ar_120
s_bitcmp1_b32 s46,0
s_cbranch_scc1 L_ar_119
L_ar_118:
ds_read_b128 v[160:163],v23
ds_read_b128 v[164:167],v23 offset:16
v_lshlrev_b32 v200,16,v224
v_and_b32 v201,0xffff0000,v224
v_lshlrev_b32 v202,16,v225
v_and_b32 v203,0xffff0000,v225
v_lshlrev_b32 v204,16,v226
v_and_b32 v205,0xffff0000,v226
v_lshlrev_b32 v206,16,v227
v_and_b32 v207,0xffff0000,v227
s_lshl_b32 s18,s51,5
s_add_u32 s18,s18,s68
s_lshl_b32 s19,s18,10
s_add_u32 s20,s19,8388608
s_waitcnt lgkmcnt(0)
v_cvt_pk_bf16_f32 v168,v160,v161
v_cvt_pk_bf16_f32 v169,v162,v163
v_cvt_pk_bf16_f32 v170,v164,v165
v_cvt_pk_bf16_f32 v171,v166,v167
v_lshlrev_b32 v160,16,v168
v_and_b32 v161,0xffff0000,v168
v_lshlrev_b32 v162,16,v169
v_and_b32 v163,0xffff0000,v169
v_lshlrev_b32 v164,16,v170
v_and_b32 v165,0xffff0000,v170
v_lshlrev_b32 v166,16,v171
v_and_b32 v167,0xffff0000,v171
v_pk_add_f32 v[200:201],v[200:201],v[160:161]
v_pk_add_f32 v[202:203],v[202:203],v[162:163]
v_pk_add_f32 v[204:205],v[204:205],v[164:165]
v_pk_add_f32 v[206:207],v[206:207],v[166:167]
v_cvt_pk_bf16_f32 v168,v200,v201
v_cvt_pk_bf16_f32 v169,v202,v203
v_cvt_pk_bf16_f32 v170,v204,v205
v_cvt_pk_bf16_f32 v171,v206,v207
v_lshlrev_b32 v200,16,v168
v_and_b32 v201,0xffff0000,v168
v_lshlrev_b32 v202,16,v169
v_and_b32 v203,0xffff0000,v169
v_lshlrev_b32 v204,16,v170
v_and_b32 v205,0xffff0000,v170
v_lshlrev_b32 v206,16,v171
v_and_b32 v207,0xffff0000,v171
v_readfirstlane_b32 s78,v200
s_nop 1
v_pk_add_f32 v[184:185],v[200:201],s[78:79] op_sel_hi:[1,0] neg_lo:[0,1] neg_hi:[0,1]
v_pk_add_f32 v[186:187],v[202:203],s[78:79] op_sel_hi:[1,0] neg_lo:[0,1] neg_hi:[0,1]
v_pk_add_f32 v[188:189],v[204:205],s[78:79] op_sel_hi:[1,0] neg_lo:[0,1] neg_hi:[0,1]
v_pk_add_f32 v[190:191],v[206:207],s[78:79] op_sel_hi:[1,0] neg_lo:[0,1] neg_hi:[0,1]
v_pk_add_f32 v[192:193],v[184:185],v[186:187]
v_pk_mul_f32 v[194:195],v[184:185],v[184:185]
v_pk_add_f32 v[196:197],v[188:189],v[190:191]
v_pk_fma_f32 v[194:195],v[186:187],v[186:187],v[194:195]
v_pk_add_f32 v[192:193],v[192:193],v[196:197]
v_pk_fma_f32 v[194:195],v[188:189],v[188:189],v[194:195]
v_add_f32 v192,v192,v193
v_pk_fma_f32 v[194:195],v[190:191],v[190:191],v[194:195]
v_add_f32 v194,v194,v195
s_nop 1
v_permlane32_swap_b32 v192,v194
v_add_f32 v192,v192,v194
s_nop 1
v_add_f32_dpp v192,v192,v192 row_ror:8 row_mask:0xf bank_mask:0xf
s_nop 1
v_add_f32_dpp v192,v192,v192 row_ror:4 row_mask:0xf bank_mask:0xf
s_nop 1
v_add_f32_dpp v192,v192,v192 row_ror:2 row_mask:0xf bank_mask:0xf
s_nop 1
v_add_f32_dpp v192,v192,v192 row_ror:1 row_mask:0xf bank_mask:0xf
v_mov_b32 v194,v192
s_nop 1
v_permlane16_swap_b32 v192,v194
v_add_f32 v192,v192,v194
v_mul_f32 v192,0x3b000000,v192
v_mov_b32 v194,v192
s_nop 1
v_permlane32_swap_b32 v192,v194
v_fma_f32 v194,-v192,v192,v194
v_add_f32 v192,s78,v192
v_max_f32 v194,0,v194
v_cvt_pk_bf16_f32 v194,v192,v194
v_lshlrev_b32 v192,16,v194
v_and_b32 v194,0xffff0000,v194
v_add_f32 v194,0x3727c5ac,v194
v_cvt_pk_bf16_f32 v194,v194,v194
v_and_b32 v194,0xffff0000,v194
v_sqrt_f32 v194,v194
v_pk_add_f32 v[184:185],v[200:201],v[192:193] op_sel_hi:[1,0] neg_lo:[0,1] neg_hi:[0,1]
v_pk_add_f32 v[186:187],v[202:203],v[192:193] op_sel_hi:[1,0] neg_lo:[0,1] neg_hi:[0,1]
v_pk_add_f32 v[188:189],v[204:205],v[192:193] op_sel_hi:[1,0] neg_lo:[0,1] neg_hi:[0,1]
v_pk_add_f32 v[190:191],v[206:207],v[192:193] op_sel_hi:[1,0] neg_lo:[0,1] neg_hi:[0,1]
v_cvt_pk_bf16_f32 v194,v194,v194
v_and_b32 v194,0xffff0000,v194
v_rcp_f32 v194,v194
v_cvt_pk_bf16_f32 v172,v184,v185
v_cvt_pk_bf16_f32 v173,v186,v187
v_cvt_pk_bf16_f32 v174,v188,v189
v_cvt_pk_bf16_f32 v175,v190,v191
v_lshlrev_b32 v184,16,v172
v_and_b32 v185,0xffff0000,v172
v_lshlrev_b32 v186,16,v173
v_and_b32 v187,0xffff0000,v173
v_lshlrev_b32 v188,16,v174
v_and_b32 v189,0xffff0000,v174
v_lshlrev_b32 v190,16,v175
v_and_b32 v191,0xffff0000,v175
v_pk_mul_f32 v[184:185],v[184:185],v[194:195] op_sel_hi:[1,0]
v_pk_mul_f32 v[186:187],v[186:187],v[194:195] op_sel_hi:[1,0]
v_pk_mul_f32 v[188:189],v[188:189],v[194:195] op_sel_hi:[1,0]
v_pk_mul_f32 v[190:191],v[190:191],v[194:195] op_sel_hi:[1,0]
v_cvt_pk_bf16_f32 v172,v184,v185
v_cvt_pk_bf16_f32 v173,v186,v187
v_cvt_pk_bf16_f32 v174,v188,v189
v_cvt_pk_bf16_f32 v175,v190,v191
v_lshlrev_b32 v176,16,v172
v_and_b32 v177,0xffff0000,v172
v_lshlrev_b32 v178,16,v173
v_and_b32 v179,0xffff0000,v173
v_lshlrev_b32 v180,16,v174
v_and_b32 v181,0xffff0000,v174
v_lshlrev_b32 v182,16,v175
v_and_b32 v183,0xffff0000,v175
v_pk_add_f32 v[200:201],v[200:201],v[176:177]
v_pk_add_f32 v[202:203],v[202:203],v[178:179]
v_pk_add_f32 v[204:205],v[204:205],v[180:181]
v_pk_add_f32 v[206:207],v[206:207],v[182:183]
v_cvt_pk_bf16_f32 v160,v200,v201
v_cvt_pk_bf16_f32 v161,v202,v203
v_cvt_pk_bf16_f32 v162,v204,v205
v_cvt_pk_bf16_f32 v163,v206,v207
buffer_store_dwordx4 v[160:163],v0,s[8:11],s20 offen sc1
v_lshlrev_b32 v200,16,v160
v_and_b32 v201,0xffff0000,v160
v_lshlrev_b32 v202,16,v161
v_and_b32 v203,0xffff0000,v161
v_lshlrev_b32 v204,16,v162
v_and_b32 v205,0xffff0000,v162
v_lshlrev_b32 v206,16,v163
v_and_b32 v207,0xffff0000,v163
v_readfirstlane_b32 s78,v200
s_nop 1
v_pk_add_f32 v[184:185],v[200:201],s[78:79] op_sel_hi:[1,0] neg_lo:[0,1] neg_hi:[0,1]
v_pk_add_f32 v[186:187],v[202:203],s[78:79] op_sel_hi:[1,0] neg_lo:[0,1] neg_hi:[0,1]
v_pk_add_f32 v[188:189],v[204:205],s[78:79] op_sel_hi:[1,0] neg_lo:[0,1] neg_hi:[0,1]
v_pk_add_f32 v[190:191],v[206:207],s[78:79] op_sel_hi:[1,0] neg_lo:[0,1] neg_hi:[0,1]
v_pk_add_f32 v[192:193],v[184:185],v[186:187]
v_pk_mul_f32 v[194:195],v[184:185],v[184:185]
v_pk_add_f32 v[196:197],v[188:189],v[190:191]
v_pk_fma_f32 v[194:195],v[186:187],v[186:187],v[194:195]
v_pk_add_f32 v[192:193],v[192:193],v[196:197]
v_pk_fma_f32 v[194:195],v[188:189],v[188:189],v[194:195]
v_add_f32 v192,v192,v193
v_pk_fma_f32 v[194:195],v[190:191],v[190:191],v[194:195]
v_add_f32 v194,v194,v195
s_nop 1
v_permlane32_swap_b32 v192,v194
v_add_f32 v192,v192,v194
s_nop 1
v_add_f32_dpp v192,v192,v192 row_ror:8 row_mask:0xf bank_mask:0xf
s_nop 1
v_add_f32_dpp v192,v192,v192 row_ror:4 row_mask:0xf bank_mask:0xf
s_nop 1
v_add_f32_dpp v192,v192,v192 row_ror:2 row_mask:0xf bank_mask:0xf
s_nop 1
v_add_f32_dpp v192,v192,v192 row_ror:1 row_mask:0xf bank_mask:0xf
v_mov_b32 v194,v192
s_nop 1
v_permlane16_swap_b32 v192,v194
v_add_f32 v192,v192,v194
v_mul_f32 v192,0x3b000000,v192
v_mov_b32 v194,v192
s_nop 1
v_permlane32_swap_b32 v192,v194
v_fma_f32 v194,-v192,v192,v194
v_add_f32 v192,s78,v192
v_max_f32 v194,0,v194
v_cvt_pk_bf16_f32 v194,v192,v194
v_lshlrev_b32 v192,16,v194
v_and_b32 v194,0xffff0000,v194
v_add_f32 v194,0x3727c5ac,v194
v_cvt_pk_bf16_f32 v194,v194,v194
v_and_b32 v194,0xffff0000,v194
v_sqrt_f32 v194,v194
v_pk_add_f32 v[184:185],v[200:201],v[192:193] op_sel_hi:[1,0] neg_lo:[0,1] neg_hi:[0,1]
v_pk_add_f32 v[186:187],v[202:203],v[192:193] op_sel_hi:[1,0] neg_lo:[0,1] neg_hi:[0,1]
v_pk_add_f32 v[188:189],v[204:205],v[192:193] op_sel_hi:[1,0] neg_lo:[0,1] neg_hi:[0,1]
v_pk_add_f32 v[190:191],v[206:207],v[192:193] op_sel_hi:[1,0] neg_lo:[0,1] neg_hi:[0,1]
v_cvt_pk_bf16_f32 v194,v194,v194
v_and_b32 v194,0xffff0000,v194
v_rcp_f32 v194,v194
v_cvt_pk_bf16_f32 v164,v184,v185
v_cvt_pk_bf16_f32 v165,v186,v187
v_cvt_pk_bf16_f32 v166,v188,v189
v_cvt_pk_bf16_f32 v167,v190,v191
v_lshlrev_b32 v184,16,v164
v_and_b32 v185,0xffff0000,v164
v_lshlrev_b32 v186,16,v165
v_and_b32 v187,0xffff0000,v165
v_lshlrev_b32 v188,16,v166
v_and_b32 v189,0xffff0000,v166
v_lshlrev_b32 v190,16,v167
v_and_b32 v191,0xffff0000,v167
v_pk_mul_f32 v[184:185],v[184:185],v[194:195] op_sel_hi:[1,0]
v_pk_mul_f32 v[186:187],v[186:187],v[194:195] op_sel_hi:[1,0]
v_pk_mul_f32 v[188:189],v[188:189],v[194:195] op_sel_hi:[1,0]
v_pk_mul_f32 v[190:191],v[190:191],v[194:195] op_sel_hi:[1,0]
v_cvt_pk_bf16_f32 v164,v184,v185
v_cvt_pk_bf16_f32 v165,v186,v187
v_cvt_pk_bf16_f32 v166,v188,v189
v_cvt_pk_bf16_f32 v167,v190,v191
s_add_u32 s20,s19,2097152
buffer_store_dwordx4 v[164:167],v0,s[8:11],s20 offen sc1
v_mov_b32 v20,1
s_lshl_b32 s73,s51,13
s_lshl2_add_u32 s73,s68,s73
s_add_u32 s73,s73,10487552
s_branch L_aa_85
L_ar_119:
ds_read_b128 v[160:163],v23
ds_read_b128 v[164:167],v23 offset:16
v_lshlrev_b32 v200,16,v224
v_and_b32 v201,0xffff0000,v224
v_lshlrev_b32 v202,16,v225
v_and_b32 v203,0xffff0000,v225
v_lshlrev_b32 v204,16,v226
v_and_b32 v205,0xffff0000,v226
v_lshlrev_b32 v206,16,v227
v_and_b32 v207,0xffff0000,v227
s_lshl_b32 s18,s51,5
s_add_u32 s18,s18,s68
s_lshl_b32 s19,s18,10
s_add_u32 s20,s19,4194304
s_waitcnt lgkmcnt(0)
v_cvt_pk_bf16_f32 v168,v160,v161
v_cvt_pk_bf16_f32 v169,v162,v163
v_cvt_pk_bf16_f32 v170,v164,v165
v_cvt_pk_bf16_f32 v171,v166,v167
v_lshlrev_b32 v160,16,v168
v_and_b32 v161,0xffff0000,v168
v_lshlrev_b32 v162,16,v169
v_and_b32 v163,0xffff0000,v169
v_lshlrev_b32 v164,16,v170
v_and_b32 v165,0xffff0000,v170
v_lshlrev_b32 v166,16,v171
v_and_b32 v167,0xffff0000,v171
v_pk_add_f32 v[200:201],v[200:201],v[160:161]
v_pk_add_f32 v[202:203],v[202:203],v[162:163]
v_pk_add_f32 v[204:205],v[204:205],v[164:165]
v_pk_add_f32 v[206:207],v[206:207],v[166:167]
v_cvt_pk_bf16_f32 v168,v200,v201
v_cvt_pk_bf16_f32 v169,v202,v203
v_cvt_pk_bf16_f32 v170,v204,v205
v_cvt_pk_bf16_f32 v171,v206,v207
buffer_store_dwordx4 v[168:171],v0,s[8:11],s20 offen sc1
v_lshlrev_b32 v200,16,v168
v_and_b32 v201,0xffff0000,v168
v_lshlrev_b32 v202,16,v169
v_and_b32 v203,0xffff0000,v169
v_lshlrev_b32 v204,16,v170
v_and_b32 v205,0xffff0000,v170
v_lshlrev_b32 v206,16,v171
v_and_b32 v207,0xffff0000,v171
v_readfirstlane_b32 s78,v200
s_nop 1
v_pk_add_f32 v[184:185],v[200:201],s[78:79] op_sel_hi:[1,0] neg_lo:[0,1] neg_hi:[0,1]
v_pk_add_f32 v[186:187],v[202:203],s[78:79] op_sel_hi:[1,0] neg_lo:[0,1] neg_hi:[0,1]
v_pk_add_f32 v[188:189],v[204:205],s[78:79] op_sel_hi:[1,0] neg_lo:[0,1] neg_hi:[0,1]
v_pk_add_f32 v[190:191],v[206:207],s[78:79] op_sel_hi:[1,0] neg_lo:[0,1] neg_hi:[0,1]
v_pk_add_f32 v[192:193],v[184:185],v[186:187]
v_pk_mul_f32 v[194:195],v[184:185],v[184:185]
v_pk_add_f32 v[196:197],v[188:189],v[190:191]
v_pk_fma_f32 v[194:195],v[186:187],v[186:187],v[194:195]
v_pk_add_f32 v[192:193],v[192:193],v[196:197]
v_pk_fma_f32 v[194:195],v[188:189],v[188:189],v[194:195]
v_add_f32 v192,v192,v193
v_pk_fma_f32 v[194:195],v[190:191],v[190:191],v[194:195]
v_add_f32 v194,v194,v195
s_nop 1
v_permlane32_swap_b32 v192,v194
v_add_f32 v192,v192,v194
s_nop 1
v_add_f32_dpp v192,v192,v192 row_ror:8 row_mask:0xf bank_mask:0xf
s_nop 1
v_add_f32_dpp v192,v192,v192 row_ror:4 row_mask:0xf bank_mask:0xf
s_nop 1
v_add_f32_dpp v192,v192,v192 row_ror:2 row_mask:0xf bank_mask:0xf
s_nop 1
v_add_f32_dpp v192,v192,v192 row_ror:1 row_mask:0xf bank_mask:0xf
v_mov_b32 v194,v192
s_nop 1
v_permlane16_swap_b32 v192,v194
v_add_f32 v192,v192,v194
v_mul_f32 v192,0x3b000000,v192
v_mov_b32 v194,v192
s_nop 1
v_permlane32_swap_b32 v192,v194
v_fma_f32 v194,-v192,v192,v194
v_add_f32 v192,s78,v192
v_max_f32 v194,0,v194
v_cvt_pk_bf16_f32 v194,v192,v194
v_lshlrev_b32 v192,16,v194
v_and_b32 v194,0xffff0000,v194
v_add_f32 v194,0x3727c5ac,v194
v_cvt_pk_bf16_f32 v194,v194,v194
v_and_b32 v194,0xffff0000,v194
v_sqrt_f32 v194,v194
v_pk_add_f32 v[184:185],v[200:201],v[192:193] op_sel_hi:[1,0] neg_lo:[0,1] neg_hi:[0,1]
v_pk_add_f32 v[186:187],v[202:203],v[192:193] op_sel_hi:[1,0] neg_lo:[0,1] neg_hi:[0,1]
v_pk_add_f32 v[188:189],v[204:205],v[192:193] op_sel_hi:[1,0] neg_lo:[0,1] neg_hi:[0,1]
v_pk_add_f32 v[190:191],v[206:207],v[192:193] op_sel_hi:[1,0] neg_lo:[0,1] neg_hi:[0,1]
v_cvt_pk_bf16_f32 v194,v194,v194
v_and_b32 v194,0xffff0000,v194
v_rcp_f32 v194,v194
v_cvt_pk_bf16_f32 v172,v184,v185
v_cvt_pk_bf16_f32 v173,v186,v187
v_cvt_pk_bf16_f32 v174,v188,v189
v_cvt_pk_bf16_f32 v175,v190,v191
v_lshlrev_b32 v184,16,v172
v_and_b32 v185,0xffff0000,v172
v_lshlrev_b32 v186,16,v173
v_and_b32 v187,0xffff0000,v173
v_lshlrev_b32 v188,16,v174
v_and_b32 v189,0xffff0000,v174
v_lshlrev_b32 v190,16,v175
v_and_b32 v191,0xffff0000,v175
v_pk_mul_f32 v[184:185],v[184:185],v[194:195] op_sel_hi:[1,0]
v_pk_mul_f32 v[186:187],v[186:187],v[194:195] op_sel_hi:[1,0]
v_pk_mul_f32 v[188:189],v[188:189],v[194:195] op_sel_hi:[1,0]
v_pk_mul_f32 v[190:191],v[190:191],v[194:195] op_sel_hi:[1,0]
v_cvt_pk_bf16_f32 v172,v184,v185
v_cvt_pk_bf16_f32 v173,v186,v187
v_cvt_pk_bf16_f32 v174,v188,v189
v_cvt_pk_bf16_f32 v175,v190,v191
v_lshlrev_b32 v176,16,v172
v_and_b32 v177,0xffff0000,v172
v_lshlrev_b32 v178,16,v173
v_and_b32 v179,0xffff0000,v173
v_lshlrev_b32 v180,16,v174
v_and_b32 v181,0xffff0000,v174
v_lshlrev_b32 v182,16,v175
v_and_b32 v183,0xffff0000,v175
v_pk_mul_f32 v[236:237],v[176:177],v[228:229]
v_pk_fma_f32 v[236:237],v[178:179],v[230:231],v[236:237]
v_pk_fma_f32 v[236:237],v[180:181],v[232:233],v[236:237]
v_pk_fma_f32 v[236:237],v[182:183],v[234:235],v[236:237]
v_add_f32 v236,v236,v237
s_nop 1
v_add_f32_dpp v236,v236,v236 row_ror:8 row_mask:0xf bank_mask:0xf
s_nop 1
v_add_f32_dpp v236,v236,v236 row_ror:4 row_mask:0xf bank_mask:0xf
s_nop 1
v_add_f32_dpp v236,v236,v236 row_ror:2 row_mask:0xf bank_mask:0xf
s_nop 1
v_add_f32_dpp v236,v236,v236 row_ror:1 row_mask:0xf bank_mask:0xf
v_mov_b32 v237,v236
s_nop 1
v_permlane16_swap_b32 v236,v237
v_add_f32 v236,v236,v237
v_mov_b32 v237,v236
s_nop 1
v_permlane32_swap_b32 v236,v237
v_add_f32 v236,v236,v237
v_cvt_pk_bf16_f32 v236,v236,v236
v_and_b32 v236,0xffff0000,v236
v_ashrrev_i32 v237,31,v236
v_or_b32 v237,0x80000000,v237
v_xor_b32 v236,v236,v237
v_and_b32 v236,0xffff0000,v236
s_sub_u32 s20,4095,s18
v_or_b32 v20,s20,v236
s_lshl_b32 s20,s51,13
s_lshl2_add_u32 s20,s68,s20
s_add_u32 s20,s20,10485760
buffer_store_dword v20,v254,s[8:11],s20 offen sc1
s_branch L_aa_85
L_ar_120:
s_bitcmp1_b32 s46,0
s_cbranch_scc1 L_aa_85
ds_read_b128 v[160:163],v23
ds_read_b128 v[164:167],v23 offset:16
v_lshlrev_b32 v200,16,v224
v_and_b32 v201,0xffff0000,v224
v_lshlrev_b32 v202,16,v225
v_and_b32 v203,0xffff0000,v225
v_lshlrev_b32 v204,16,v226
v_and_b32 v205,0xffff0000,v226
v_lshlrev_b32 v206,16,v227
v_and_b32 v207,0xffff0000,v227
v_readfirstlane_b32 s22,v246
s_cmp_eq_u32 s22,0
s_cbranch_scc1 L_ag_121
L_agb_122:
s_lshl_b32 s18,s51,5
s_add_u32 s18,s18,s68
s_lshl_b32 s19,s18,10
s_add_u32 s20,s19,6291456
s_waitcnt lgkmcnt(0)
v_cvt_pk_bf16_f32 v168,v160,v161
v_cvt_pk_bf16_f32 v169,v162,v163
v_cvt_pk_bf16_f32 v170,v164,v165
v_cvt_pk_bf16_f32 v171,v166,v167
v_lshlrev_b32 v160,16,v168
v_and_b32 v161,0xffff0000,v168
v_lshlrev_b32 v162,16,v169
v_and_b32 v163,0xffff0000,v169
v_lshlrev_b32 v164,16,v170
v_and_b32 v165,0xffff0000,v170
v_lshlrev_b32 v166,16,v171
v_and_b32 v167,0xffff0000,v171
v_pk_add_f32 v[200:201],v[200:201],v[160:161]
v_pk_add_f32 v[202:203],v[202:203],v[162:163]
v_pk_add_f32 v[204:205],v[204:205],v[164:165]
v_pk_add_f32 v[206:207],v[206:207],v[166:167]
v_cvt_pk_bf16_f32 v168,v200,v201
v_cvt_pk_bf16_f32 v169,v202,v203
v_cvt_pk_bf16_f32 v170,v204,v205
v_cvt_pk_bf16_f32 v171,v206,v207
buffer_store_dwordx4 v[168:171],v0,s[8:11],s20 offen sc1
v_lshlrev_b32 v200,16,v168
v_and_b32 v201,0xffff0000,v168
v_lshlrev_b32 v202,16,v169
v_and_b32 v203,0xffff0000,v169
v_lshlrev_b32 v204,16,v170
v_and_b32 v205,0xffff0000,v170
v_lshlrev_b32 v206,16,v171
v_and_b32 v207,0xffff0000,v171
v_readfirstlane_b32 s78,v200
s_nop 1
v_pk_add_f32 v[184:185],v[200:201],s[78:79] op_sel_hi:[1,0] neg_lo:[0,1] neg_hi:[0,1]
v_pk_add_f32 v[186:187],v[202:203],s[78:79] op_sel_hi:[1,0] neg_lo:[0,1] neg_hi:[0,1]
v_pk_add_f32 v[188:189],v[204:205],s[78:79] op_sel_hi:[1,0] neg_lo:[0,1] neg_hi:[0,1]
v_pk_add_f32 v[190:191],v[206:207],s[78:79] op_sel_hi:[1,0] neg_lo:[0,1] neg_hi:[0,1]
v_pk_add_f32 v[192:193],v[184:185],v[186:187]
v_pk_mul_f32 v[194:195],v[184:185],v[184:185]
v_pk_add_f32 v[196:197],v[188:189],v[190:191]
v_pk_fma_f32 v[194:195],v[186:187],v[186:187],v[194:195]
v_pk_add_f32 v[192:193],v[192:193],v[196:197]
v_pk_fma_f32 v[194:195],v[188:189],v[188:189],v[194:195]
v_add_f32 v192,v192,v193
v_pk_fma_f32 v[194:195],v[190:191],v[190:191],v[194:195]
v_add_f32 v194,v194,v195
s_nop 1
v_permlane32_swap_b32 v192,v194
v_add_f32 v192,v192,v194
s_nop 1
v_add_f32_dpp v192,v192,v192 row_ror:8 row_mask:0xf bank_mask:0xf
s_nop 1
v_add_f32_dpp v192,v192,v192 row_ror:4 row_mask:0xf bank_mask:0xf
s_nop 1
v_add_f32_dpp v192,v192,v192 row_ror:2 row_mask:0xf bank_mask:0xf
s_nop 1
v_add_f32_dpp v192,v192,v192 row_ror:1 row_mask:0xf bank_mask:0xf
v_mov_b32 v194,v192
s_nop 1
v_permlane16_swap_b32 v192,v194
v_add_f32 v192,v192,v194
v_mul_f32 v192,0x3b000000,v192
v_mov_b32 v194,v192
s_nop 1
v_permlane32_swap_b32 v192,v194
v_fma_f32 v194,-v192,v192,v194
v_add_f32 v192,s78,v192
v_max_f32 v194,0,v194
v_cvt_pk_bf16_f32 v194,v192,v194
v_lshlrev_b32 v192,16,v194
v_and_b32 v194,0xffff0000,v194
v_add_f32 v194,0x3727c5ac,v194
v_cvt_pk_bf16_f32 v194,v194,v194
v_and_b32 v194,0xffff0000,v194
v_sqrt_f32 v194,v194
v_pk_add_f32 v[184:185],v[200:201],v[192:193] op_sel_hi:[1,0] neg_lo:[0,1] neg_hi:[0,1]
v_pk_add_f32 v[186:187],v[202:203],v[192:193] op_sel_hi:[1,0] neg_lo:[0,1] neg_hi:[0,1]
v_pk_add_f32 v[188:189],v[204:205],v[192:193] op_sel_hi:[1,0] neg_lo:[0,1] neg_hi:[0,1]
v_pk_add_f32 v[190:191],v[206:207],v[192:193] op_sel_hi:[1,0] neg_lo:[0,1] neg_hi:[0,1]
v_cvt_pk_bf16_f32 v194,v194,v194
v_and_b32 v194,0xffff0000,v194
v_rcp_f32 v194,v194
v_cvt_pk_bf16_f32 v172,v184,v185
v_cvt_pk_bf16_f32 v173,v186,v187
v_cvt_pk_bf16_f32 v174,v188,v189
v_cvt_pk_bf16_f32 v175,v190,v191
v_lshlrev_b32 v184,16,v172
v_and_b32 v185,0xffff0000,v172
v_lshlrev_b32 v186,16,v173
v_and_b32 v187,0xffff0000,v173
v_lshlrev_b32 v188,16,v174
v_and_b32 v189,0xffff0000,v174
v_lshlrev_b32 v190,16,v175
v_and_b32 v191,0xffff0000,v175
v_pk_mul_f32 v[184:185],v[184:185],v[194:195] op_sel_hi:[1,0]
v_pk_mul_f32 v[186:187],v[186:187],v[194:195] op_sel_hi:[1,0]
v_pk_mul_f32 v[188:189],v[188:189],v[194:195] op_sel_hi:[1,0]
v_pk_mul_f32 v[190:191],v[190:191],v[194:195] op_sel_hi:[1,0]
v_cvt_pk_bf16_f32 v172,v184,v185
v_cvt_pk_bf16_f32 v173,v186,v187
v_cvt_pk_bf16_f32 v174,v188,v189
v_cvt_pk_bf16_f32 v175,v190,v191
v_lshlrev_b32 v176,16,v172
v_and_b32 v177,0xffff0000,v172
v_lshlrev_b32 v178,16,v173
v_and_b32 v179,0xffff0000,v173
v_lshlrev_b32 v180,16,v174
v_and_b32 v181,0xffff0000,v174
v_lshlrev_b32 v182,16,v175
v_and_b32 v183,0xffff0000,v175
v_pk_add_f32 v[200:201],v[200:201],v[176:177]
v_pk_add_f32 v[202:203],v[202:203],v[178:179]
v_pk_add_f32 v[204:205],v[204:205],v[180:181]
v_pk_add_f32 v[206:207],v[206:207],v[182:183]
v_cvt_pk_bf16_f32 v160,v200,v201
v_cvt_pk_bf16_f32 v161,v202,v203
v_cvt_pk_bf16_f32 v162,v204,v205
v_cvt_pk_bf16_f32 v163,v206,v207
buffer_store_dwordx4 v[160:163],v0,s[12:15],s19 offen sc1
v_pk_mul_f32 v[236:237],v[176:177],v[228:229]
v_pk_fma_f32 v[236:237],v[178:179],v[230:231],v[236:237]
v_pk_fma_f32 v[236:237],v[180:181],v[232:233],v[236:237]
v_pk_fma_f32 v[236:237],v[182:183],v[234:235],v[236:237]
v_add_f32 v236,v236,v237
s_nop 1
v_add_f32_dpp v236,v236,v236 row_ror:8 row_mask:0xf bank_mask:0xf
s_nop 1
v_add_f32_dpp v236,v236,v236 row_ror:4 row_mask:0xf bank_mask:0xf
s_nop 1
v_add_f32_dpp v236,v236,v236 row_ror:2 row_mask:0xf bank_mask:0xf
s_nop 1
v_add_f32_dpp v236,v236,v236 row_ror:1 row_mask:0xf bank_mask:0xf
v_mov_b32 v237,v236
s_nop 1
v_permlane16_swap_b32 v236,v237
v_add_f32 v236,v236,v237
v_mov_b32 v237,v236
s_nop 1
v_permlane32_swap_b32 v236,v237
v_add_f32 v236,v236,v237
v_cvt_pk_bf16_f32 v236,v236,v236
v_and_b32 v236,0xffff0000,v236
v_ashrrev_i32 v237,31,v236
v_or_b32 v237,0x80000000,v237
v_xor_b32 v236,v236,v237
v_and_b32 v236,0xffff0000,v236
s_sub_u32 s20,4095,s18
v_or_b32 v20,s20,v236
s_lshl_b32 s73,s51,13
s_lshl2_add_u32 s73,s68,s73
s_add_u32 s73,s73,10485760
s_add_u32 s73,s73,s86
L_aa_85:
s_cmp_eq_u32 s27,1
s_cbranch_scc1 L_ad_123
s_cmp_eq_u32 s27,0
s_cbranch_scc1 L_aa_86
s_cmp_eq_u32 s27,4
s_cbranch_scc1 L_a4_106
s_cmp_ge_u32 s77,64
s_cbranch_scc1 L_aa_89
L_aa_87:
s_waitcnt vmcnt(0)
buffer_store_dword v20,off,s[8:11],s73 sc1
s_mov_b32 s73,0x80000000
v_mov_b32 v18,0
s_mov_b32 s27,0
L_aw_124:
v_cmp_eq_u32 vcc,0,v18
s_cbranch_vccz L_awd_125
buffer_load_dword v18,v19,s[8:11],0 offen sc1
s_sub_u32 s49,s49,1
s_cbranch_scc1 L_abort
s_waitcnt vmcnt(0)
s_branch L_aw_124
L_awd_125:
L_a3_126:
s_mov_b32 s64,s70
s_mov_b32 s65,s71
s_add_u32 s64,s64,s28
s_add_u32 s65,s65,s29
s_xor_b32 s58,s67,s40
s_xor_b32 s57,s67,s41
s_add_u32 m0,s58,0
s_nop 0
buffer_load_dwordx4 v0,s[8:11],s64 offen offset:0 sc1 lds
buffer_load_dwordx4 v0,s[8:11],s64 offen offset:1024 sc1 lds
buffer_load_dwordx4 v0,s[8:11],s64 offen offset:2048 sc1 lds
buffer_load_dwordx4 v0,s[8:11],s64 offen offset:3072 sc1 lds
s_add_u32 m0,s58,4096
s_add_u32 s64,s64,4096
buffer_load_dwordx4 v0,s[8:11],s64 offen offset:0 sc1 lds
buffer_load_dwordx4 v0,s[8:11],s64 offen offset:1024 sc1 lds
buffer_load_dwordx4 v0,s[8:11],s64 offen offset:2048 sc1 lds
buffer_load_dwordx4 v0,s[8:11],s64 offen offset:3072 sc1 lds
s_add_u32 m0,s58,8192
s_add_u32 s64,s64,4096
buffer_load_dwordx4 v0,s[8:11],s64 offen offset:0 sc1 lds
buffer_load_dwordx4 v0,s[8:11],s64 offen offset:1024 sc1 lds
buffer_load_dwordx4 v0,s[8:11],s64 offen offset:2048 sc1 lds
buffer_load_dwordx4 v0,s[8:11],s64 offen offset:3072 sc1 lds
s_add_u32 m0,s57,24576
s_nop 0
buffer_load_dwordx4 v0,s[8:11],s65 offen offset:0 sc1 lds
buffer_load_dwordx4 v0,s[8:11],s65 offen offset:1024 sc1 lds
v_lshrrev_b32 v244,4,v1
s_sub_u32 s56,s77,7
v_add_u32 v244,s56,v244
v_max_i32 v244,0,v244
v_lshl_add_u32 v244,v244,13,v21
buffer_load_dwordx2 v[242:243],v244,s[8:11],0 offen sc1
s_waitcnt vmcnt(0) lgkmcnt(0)
s_barrier
s_xor_b32 s67,s67,65536
s_and_b32 s56,s50,2048
s_lshl_b32 s56,s56,4
s_add_u32 s56,s56,s67
v_add_u32 v2,s56,v0
s_and_b32 s56,s50,1024
s_lshl_b32 s56,s56,2
v_add_u32 v238,s56,v2
s_mov_b32 s76,s71
s_mov_b32 s53,s77
ds_read_b128 v[24:27],v238 offset:16384
ds_read_b128 v[40:43],v2 offset:0
ds_read_b128 v[56:59],v2 offset:4096
ds_read_b128 v[28:31],v238 offset:17408
ds_read_b128 v[44:47],v2 offset:1024
ds_read_b128 v[60:63],v2 offset:5120
ds_read_b128 v[32:35],v238 offset:18432
ds_read_b128 v[48:51],v2 offset:2048
ds_read_b128 v[64:67],v2 offset:6144
ds_read_b128 v[36:39],v238 offset:19456
ds_read_b128 v[52:55],v2 offset:3072
ds_read_b128 v[68:71],v2 offset:7168
s_waitcnt lgkmcnt(9)
v_mfma_f32_16x16x32_bf16 v[128:131],v[40:43],v[24:27],v[8:11]
ds_read_b128 v[72:75],v2 offset:24576
v_mfma_f32_16x16x32_bf16 v[132:135],v[56:59],v[24:27],v[12:15]
ds_read_b128 v[76:79],v2 offset:25600
s_waitcnt lgkmcnt(8)
v_mfma_f32_16x16x32_bf16 v[128:131],v[44:47],v[28:31],v[128:131]
ds_read_b128 v[80:83],v2 offset:26624
v_mfma_f32_16x16x32_bf16 v[132:135],v[60:63],v[28:31],v[132:135]
ds_read_b128 v[84:87],v2 offset:27648
s_waitcnt lgkmcnt(7)
v_mfma_f32_16x16x32_bf16 v[128:131],v[48:51],v[32:35],v[128:131]
ds_read_b128 v[88:91],v2 offset:8192
v_mfma_f32_16x16x32_bf16 v[132:135],v[64:67],v[32:35],v[132:135]
ds_read_b128 v[92:95],v2 offset:9216
s_waitcnt lgkmcnt(6)
v_mfma_f32_16x16x32_bf16 v[128:131],v[52:55],v[36:39],v[128:131]
ds_read_b128 v[96:99],v2 offset:10240
v_mfma_f32_16x16x32_bf16 v[132:135],v[68:71],v[36:39],v[132:135]
ds_read_b128 v[100:103],v2 offset:11264
s_waitcnt lgkmcnt(4)
s_mov_b32 vcc_lo,0x33333333
s_mov_b32 vcc_hi,0x33333333
v_mfma_f32_16x16x32_bf16 v[136:139],v[72:75],v[24:27],0
ds_read_b128 v[104:107],v2 offset:12288
v_max3_u32 v238,v72,v73,v74
v_max3_u32 v238,v74,v75,v238
v_cndmask_b32_dpp v120,v72,v74,vcc quad_perm:[0,1,0,1] row_mask:0xf bank_mask:0xf
v_cndmask_b32_dpp v121,v73,v75,vcc quad_perm:[0,1,0,1] row_mask:0xf bank_mask:0xf
v_mfma_f32_16x16x32_bf16 v[136:139],v[76:79],v[28:31],v[136:139]
ds_read_b128 v[108:111],v2 offset:13312
v_max3_u32 v238,v76,v77,v238
v_max3_u32 v238,v78,v79,v238
v_cndmask_b32_dpp v122,v76,v78,vcc quad_perm:[0,1,0,1] row_mask:0xf bank_mask:0xf
v_cndmask_b32_dpp v123,v77,v79,vcc quad_perm:[0,1,0,1] row_mask:0xf bank_mask:0xf
v_mfma_f32_16x16x32_bf16 v[136:139],v[80:83],v[32:35],v[136:139]
ds_read_b128 v[112:115],v2 offset:14336
v_max3_u32 v238,v80,v81,v238
v_max3_u32 v238,v82,v83,v238
v_cndmask_b32_dpp v124,v80,v82,vcc quad_perm:[0,1,0,1] row_mask:0xf bank_mask:0xf
v_cndmask_b32_dpp v125,v81,v83,vcc quad_perm:[0,1,0,1] row_mask:0xf bank_mask:0xf
v_mfma_f32_16x16x32_bf16 v[136:139],v[84:87],v[36:39],v[136:139]
ds_read_b128 v[116:119],v2 offset:15360
v_max3_u32 v238,v84,v85,v238
v_max3_u32 v238,v86,v87,v238
v_cndmask_b32_dpp v126,v84,v86,vcc quad_perm:[0,1,0,1] row_mask:0xf bank_mask:0xf
v_cndmask_b32_dpp v127,v85,v87,vcc quad_perm:[0,1,0,1] row_mask:0xf bank_mask:0xf
v_cmp_eq_u32 vcc,-1,v238
s_waitcnt lgkmcnt(0)
s_cmp_eq_u32 s30,0
s_cbranch_scc1 L_aa_88
s_cmp_lg_u32 s86,1536
s_cbranch_scc1 L_ae_127
s_mov_b32 s77,s35
s_mov_b32 s30,0
s_lshl_b32 s56,s77,5
s_add_u32 s56,s56,s68
s_mul_i32 s70,s56,24576
s_lshl_b32 s71,s56,12
s_lshl_b32 s59,s77,13
s_lshl2_add_u32 s59,s68,s59
s_add_u32 s59,s59,10485760
s_buffer_load_dword s32,s[8:11],s59
s_mov_b32 s33,1
s_add_u32 s70,s70,100663296
s_add_u32 s71,s71,41943040
v_mov_b32 v19,s59
s_branch L_af_128
L_ae_127:
s_ff1_i32_b64 s77,s[84:85]
s_bitset0_b64 s[84:85],s77
s_min_u32 s77,s77,64
s_lshr_b32 s61,s55,5
s_lshl_b32 s56,s77,5
s_add_u32 s56,s56,s68
s_mul_i32 s70,s56,24576
s_lshl_b32 s71,s56,12
s_lshl_b32 s59,s77,13
s_lshl2_add_u32 s59,s68,s59
s_add_u32 s59,s59,10486144
s_cmp_lt_u32 s77,s61
s_cselect_b32 s57,0,16777216
s_mov_b32 s60,s59
s_buffer_load_dword s33,s[8:11],s60
s_add_u32 s71,s71,s57
s_add_u32 s71,s71,58720256
s_cmp_eq_u32 s77,s61
s_cselect_b32 s57,50331648,0
s_cselect_b32 s58,1536,0
s_add_u32 s59,s59,s58
s_buffer_load_dword s32,s[8:11],s59
s_add_u32 s70,s70,s57
s_add_u32 s70,s70,150994944
v_mov_b32 v19,s59
v_writelane_b32 v19,s60,1
L_af_128:
L_a4_106:
s_waitcnt vmcnt(0)
buffer_store_dword v20,off,s[8:11],s73 sc1
s_mov_b32 s73,0x80000000
v_max3_u32 v238,v72,v73,v74
v_max3_u32 v238,v74,v75,v238
v_max3_u32 v238,v76,v77,v238
v_max3_u32 v238,v78,v79,v238
v_max3_u32 v238,v80,v81,v238
v_max3_u32 v238,v82,v83,v238
v_max3_u32 v238,v84,v85,v238
v_max3_u32 v238,v86,v87,v238
v_cmp_eq_u32 vcc,-1,v238
s_cbranch_vccnz L_ac_129
L_acb_130:
v_max3_f32 v238,v128,v129,v130
v_max3_f32 v239,v131,v132,v133
v_max3_f32 v238,v134,v135,v238
v_max3_f32 v239,v138,v139,v239
v_max_f32 v238,v238,v239
v_max_f32 v239,v238,v239
v_pk_mul_f32 v[128:129],v[128:129],v[152:153] op_sel_hi:[1,0]
v_pk_mul_f32 v[130:131],v[130:131],v[152:153] op_sel_hi:[1,0]
v_permlane16_swap_b32 v238,v239
v_max_f32 v238,v238,v239
v_max_f32 v239,v238,v239
v_pk_mul_f32 v[132:133],v[132:133],v[152:153] op_sel_hi:[1,0]
v_pk_mul_f32 v[134:135],v[134:135],v[152:153] op_sel_hi:[1,0]
v_permlane32_swap_b32 v238,v239
v_max_f32 v238,v238,v239
v_mul_f32 v238,v152,v238
v_pk_mul_f32 v[138:139],v[138:139],v[152:153] op_sel_hi:[1,0]
v_pk_add_f32 v[128:129],v[128:129],v[238:239] op_sel_hi:[1,0] neg_lo:[0,1] neg_hi:[0,1]
v_pk_add_f32 v[130:131],v[130:131],v[238:239] op_sel_hi:[1,0] neg_lo:[0,1] neg_hi:[0,1]
v_pk_add_f32 v[132:133],v[132:133],v[238:239] op_sel_hi:[1,0] neg_lo:[0,1] neg_hi:[0,1]
v_pk_add_f32 v[134:135],v[134:135],v[238:239] op_sel_hi:[1,0] neg_lo:[0,1] neg_hi:[0,1]
v_pk_add_f32 v[138:139],v[138:139],v[238:239] op_sel_hi:[1,0] neg_lo:[0,1] neg_hi:[0,1]
v_exp_f32 v128,v128
v_exp_f32 v129,v129
v_exp_f32 v130,v130
v_exp_f32 v131,v131
v_exp_f32 v132,v132
v_exp_f32 v133,v133
v_exp_f32 v134,v134
v_exp_f32 v135,v135
v_exp_f32 v138,v138
v_exp_f32 v139,v139
v_pk_add_f32 v[148:149],v[128:129],v[130:131]
v_pk_add_f32 v[150:151],v[132:133],v[134:135]
v_pk_add_f32 v[148:149],v[148:149],v[138:139]
v_pk_add_f32 v[148:149],v[148:149],v[150:151]
v_add_f32 v150,v148,v149
v_add_f32 v151,v148,v149
s_nop 1
v_permlane16_swap_b32 v150,v151
v_add_f32 v148,v150,v151
v_add_f32 v149,v150,v151
s_nop 1
v_permlane32_swap_b32 v148,v149
v_add_f32 v148,v148,v149
v_rcp_f32 v148,v148
s_nop 0
v_pk_mul_f32 v[138:139],v[138:139],v[148:149] op_sel_hi:[1,0]
v_pk_mul_f32 v[128:129],v[128:129],v[148:149] op_sel_hi:[1,0]
v_pk_mul_f32 v[130:131],v[130:131],v[148:149] op_sel_hi:[1,0]
v_pk_mul_f32 v[132:133],v[132:133],v[148:149] op_sel_hi:[1,0]
v_pk_mul_f32 v[134:135],v[134:135],v[148:149] op_sel_hi:[1,0]
v_cvt_pk_bf16_f32 v144,v138,v139
v_cvt_pk_bf16_f32 v147,v138,v139
s_nop 0
v_mfma_f32_16x16x16_bf16 v[24:27],v[120:121],v[144:145],0
v_cvt_pk_bf16_f32 v140,v128,v129
v_mfma_f32_16x16x16_bf16 v[28:31],v[120:121],v[146:147],0
v_cvt_pk_bf16_f32 v141,v130,v131
v_mfma_f32_16x16x16_bf16 v[32:35],v[122:123],v[144:145],0
v_cvt_pk_bf16_f32 v142,v132,v133
v_mfma_f32_16x16x16_bf16 v[36:39],v[122:123],v[146:147],0
v_cvt_pk_bf16_f32 v143,v134,v135
v_mfma_f32_16x16x16_bf16 v[40:43],v[124:125],v[144:145],0
v_mfma_f32_16x16x16_bf16 v[44:47],v[124:125],v[146:147],0
v_mfma_f32_16x16x16_bf16 v[48:51],v[126:127],v[144:145],0
v_mfma_f32_16x16x16_bf16 v[52:55],v[126:127],v[146:147],0
v_mfma_f32_16x16x32_bf16 v[24:27],v[88:91],v[140:143],v[24:27]
v_mfma_f32_16x16x32_bf16 v[28:31],v[92:95],v[140:143],v[28:31]
v_mfma_f32_16x16x32_bf16 v[32:35],v[96:99],v[140:143],v[32:35]
v_mfma_f32_16x16x32_bf16 v[36:39],v[100:103],v[140:143],v[36:39]
v_cvt_pk_bf16_f32 v72,v24,v28
v_cvt_pk_bf16_f32 v73,v25,v29
v_mfma_f32_16x16x32_bf16 v[40:43],v[104:107],v[140:143],v[40:43]
v_cvt_pk_bf16_f32 v74,v26,v30
v_cvt_pk_bf16_f32 v75,v27,v31
v_mfma_f32_16x16x32_bf16 v[44:47],v[108:111],v[140:143],v[44:47]
ds_write_b128 v3,v[72:75] offset:0
v_cvt_pk_bf16_f32 v76,v32,v36
v_cvt_pk_bf16_f32 v77,v33,v37
v_mfma_f32_16x16x32_bf16 v[48:51],v[112:115],v[140:143],v[48:51]
v_cvt_pk_bf16_f32 v78,v34,v38
v_cvt_pk_bf16_f32 v79,v35,v39
v_mfma_f32_16x16x32_bf16 v[52:55],v[116:119],v[140:143],v[52:55]
ds_write_b128 v3,v[76:79] offset:1024
v_cvt_pk_bf16_f32 v80,v40,v44
v_cvt_pk_bf16_f32 v81,v41,v45
v_cvt_pk_bf16_f32 v82,v42,v46
v_cvt_pk_bf16_f32 v83,v43,v47
ds_write_b128 v3,v[80:83] offset:2048
s_nop 1
v_cvt_pk_bf16_f32 v84,v48,v52
v_cvt_pk_bf16_f32 v85,v49,v53
v_cvt_pk_bf16_f32 v86,v50,v54
v_cvt_pk_bf16_f32 v87,v51,v55
ds_write_b128 v3,v[84:87] offset:3072
s_waitcnt lgkmcnt(0)
s_barrier
L_ad_123:
s_mov_b32 s51,s53
s_mov_b32 s31,1
s_branch L_aa_80
L_aa_86:
s_waitcnt vmcnt(0)
buffer_store_dword v20,off,s[8:11],s73 sc1
s_mov_b32 s73,0x80000000
L_aa_88:
s_mov_b32 s51,s53
s_mov_b32 s31,0
s_add_u32 s35,s53,4
s_cmp_lt_u32 s53,4
s_cbranch_scc1 L_ab_131
s_cmp_ge_u32 s53,63
s_cbranch_scc1 L_am_133
L_aw_134:
v_min_u32 v239,v242,v243
v_cmp_eq_u32 vcc,0,v239
s_cbranch_vccz L_awd_135
s_sleep 4
buffer_load_dwordx2 v[242:243],v244,s[8:11],0 offen sc1
s_sub_u32 s49,s49,1
s_cbranch_scc1 L_abort
s_waitcnt vmcnt(0)
s_branch L_aw_134
L_awd_135:
v_max_u32 v242,v242,v243
s_nop 1
v_max_u32_dpp v242,v242,v242 row_ror:8 row_mask:0xf bank_mask:0xf
s_nop 1
v_max_u32_dpp v242,v242,v242 row_ror:4 row_mask:0xf bank_mask:0xf
s_nop 1
v_max_u32_dpp v242,v242,v242 row_ror:2 row_mask:0xf bank_mask:0xf
s_nop 1
v_max_u32_dpp v242,v242,v242 row_ror:1 row_mask:0xf bank_mask:0xf
v_mov_b32 v243,v242
s_nop 1
v_permlane16_swap_b32 v242,v243
v_max_u32 v242,v242,v243
v_mov_b32 v243,v242
s_nop 1
v_permlane32_swap_b32 v242,v243
v_max_u32 v242,v242,v243
s_nop 0
v_readfirstlane_b32 s56,v242
v_readlane_b32 s57,v255,s53
s_max_u32 s75,s75,s56
s_bitcmp0_b64 s[42:43],s53
s_cbranch_scc1 L_ab_131
s_mov_b32 s77,s36
s_and_b32 s55,s75,0x7ff
s_sub_u32 s55,2047,s55
s_cmp_lt_u32 s75,s57
s_cselect_b32 s55,4095,s55
s_lshr_b32 s61,s55,5
s_mov_b32 s30,1
s_lshl_b32 s56,s77,5
s_add_u32 s56,s56,s68
s_mul_i32 s70,s56,24576
s_lshl_b32 s71,s56,12
s_lshl_b32 s59,s77,13
s_lshl2_add_u32 s59,s68,s59
s_add_u32 s59,s59,10486144
s_cmp_lt_u32 s77,s61
s_cselect_b32 s57,0,16777216
s_mov_b32 s60,s59
s_add_u32 s71,s71,s57
s_add_u32 s71,s71,58720256
s_cmp_eq_u32 s77,s61
s_cselect_b32 s57,50331648,0
s_cselect_b32 s58,1536,0
s_add_u32 s59,s59,s58
s_add_u32 s70,s70,s57
s_add_u32 s70,s70,150994944
v_mov_b32 v19,s59
v_writelane_b32 v19,s60,1
s_branch L_aj_132
L_ab_131:
s_mov_b32 s77,s35
s_mov_b32 s30,0
s_lshl_b32 s56,s77,5
s_add_u32 s56,s56,s68
s_mul_i32 s70,s56,24576
s_lshl_b32 s71,s56,12
s_lshl_b32 s59,s77,13
s_lshl2_add_u32 s59,s68,s59
s_add_u32 s59,s59,10485760
s_mov_b32 s33,1
s_add_u32 s70,s70,100663296
s_add_u32 s71,s71,41943040
v_mov_b32 v19,s59
L_aj_132:
buffer_load_dword v18,v19,s[8:11],0 offen sc1
s_waitcnt vmcnt(2)
s_mov_b32 vcc_lo,0x33333333
s_mov_b32 vcc_hi,0x33333333
v_mfma_f32_16x16x32_bf16 v[136:139],v[72:75],v[24:27],0
v_max3_u32 v238,v72,v73,v74
v_max3_u32 v238,v74,v75,v238
v_cndmask_b32_dpp v120,v72,v74,vcc quad_perm:[0,1,0,1] row_mask:0xf bank_mask:0xf
v_cndmask_b32_dpp v121,v73,v75,vcc quad_perm:[0,1,0,1] row_mask:0xf bank_mask:0xf
v_mfma_f32_16x16x32_bf16 v[136:139],v[76:79],v[28:31],v[136:139]
v_max3_u32 v238,v76,v77,v238
v_max3_u32 v238,v78,v79,v238
v_cndmask_b32_dpp v122,v76,v78,vcc quad_perm:[0,1,0,1] row_mask:0xf bank_mask:0xf
v_cndmask_b32_dpp v123,v77,v79,vcc quad_perm:[0,1,0,1] row_mask:0xf bank_mask:0xf
v_mfma_f32_16x16x32_bf16 v[136:139],v[80:83],v[32:35],v[136:139]
v_max3_u32 v238,v80,v81,v238
v_max3_u32 v238,v82,v83,v238
v_cndmask_b32_dpp v124,v80,v82,vcc quad_perm:[0,1,0,1] row_mask:0xf bank_mask:0xf
v_cndmask_b32_dpp v125,v81,v83,vcc quad_perm:[0,1,0,1] row_mask:0xf bank_mask:0xf
v_mfma_f32_16x16x32_bf16 v[136:139],v[84:87],v[36:39],v[136:139]
v_max3_u32 v238,v84,v85,v238
v_max3_u32 v238,v86,v87,v238
v_cndmask_b32_dpp v126,v84,v86,vcc quad_perm:[0,1,0,1] row_mask:0xf bank_mask:0xf
v_cndmask_b32_dpp v127,v85,v87,vcc quad_perm:[0,1,0,1] row_mask:0xf bank_mask:0xf
v_cmp_eq_u32 vcc,-1,v238
s_cbranch_vccz L_aa_91
L_aa_90:
buffer_load_dwordx4 v[72:75],v0,s[8:11],s76 offen offset:0 sc1
buffer_load_dwordx4 v[76:79],v0,s[8:11],s76 offen offset:1024 sc1
buffer_load_dwordx4 v[80:83],v0,s[8:11],s76 offen offset:2048 sc1
buffer_load_dwordx4 v[84:87],v0,s[8:11],s76 offen offset:3072 sc1
buffer_load_dword v18,v19,s[8:11],0 offen sc1
s_sub_u32 s49,s49,1
s_cbranch_scc1 L_abort
s_mov_b32 vcc_lo,0x33333333
s_mov_b32 vcc_hi,0x33333333
s_waitcnt vmcnt(4)
v_mfma_f32_16x16x32_bf16 v[136:139],v[72:75],v[24:27],0
v_max3_u32 v238,v72,v73,v74
v_max3_u32 v238,v74,v75,v238
v_cndmask_b32_dpp v120,v72,v74,vcc quad_perm:[0,1,0,1] row_mask:0xf bank_mask:0xf
v_cndmask_b32_dpp v121,v73,v75,vcc quad_perm:[0,1,0,1] row_mask:0xf bank_mask:0xf
s_waitcnt vmcnt(3)
v_mfma_f32_16x16x32_bf16 v[136:139],v[76:79],v[28:31],v[136:139]
v_max3_u32 v238,v76,v77,v238
v_max3_u32 v238,v78,v79,v238
v_cndmask_b32_dpp v122,v76,v78,vcc quad_perm:[0,1,0,1] row_mask:0xf bank_mask:0xf
v_cndmask_b32_dpp v123,v77,v79,vcc quad_perm:[0,1,0,1] row_mask:0xf bank_mask:0xf
s_waitcnt vmcnt(2)
v_mfma_f32_16x16x32_bf16 v[136:139],v[80:83],v[32:35],v[136:139]
v_max3_u32 v238,v80,v81,v238
v_max3_u32 v238,v82,v83,v238
v_cndmask_b32_dpp v124,v80,v82,vcc quad_perm:[0,1,0,1] row_mask:0xf bank_mask:0xf
v_cndmask_b32_dpp v125,v81,v83,vcc quad_perm:[0,1,0,1] row_mask:0xf bank_mask:0xf
s_waitcnt vmcnt(1)
v_mfma_f32_16x16x32_bf16 v[136:139],v[84:87],v[36:39],v[136:139]
v_max3_u32 v238,v84,v85,v238
v_max3_u32 v238,v86,v87,v238
v_cndmask_b32_dpp v126,v84,v86,vcc quad_perm:[0,1,0,1] row_mask:0xf bank_mask:0xf
v_cndmask_b32_dpp v127,v85,v87,vcc quad_perm:[0,1,0,1] row_mask:0xf bank_mask:0xf
v_cmp_eq_u32 vcc,-1,v238
s_cbranch_vccnz L_aa_90
L_aa_91:
s_cmp_lg_u32 s27,3
s_cbranch_scc1 L_ai_136
v_max3_f32 v238,v128,v129,v130
v_max3_f32 v239,v131,v132,v133
v_max3_f32 v238,v134,v135,v238
v_max3_f32 v239,v138,v139,v239
v_max_f32 v238,v238,v239
v_max_f32 v239,v238,v239
v_pk_mul_f32 v[128:129],v[128:129],v[152:153] op_sel_hi:[1,0]
v_pk_mul_f32 v[130:131],v[130:131],v[152:153] op_sel_hi:[1,0]
v_permlane16_swap_b32 v238,v239
v_max_f32 v238,v238,v239
v_max_f32 v239,v238,v239
v_pk_mul_f32 v[132:133],v[132:133],v[152:153] op_sel_hi:[1,0]
v_pk_mul_f32 v[134:135],v[134:135],v[152:153] op_sel_hi:[1,0]
v_permlane32_swap_b32 v238,v239
v_max_f32 v238,v238,v239
v_mul_f32 v238,v152,v238
v_pk_mul_f32 v[138:139],v[138:139],v[152:153] op_sel_hi:[1,0]
buffer_load_dword v17,v16,s[8:11],s87 offen sc1
v_pk_add_f32 v[128:129],v[128:129],v[238:239] op_sel_hi:[1,0] neg_lo:[0,1] neg_hi:[0,1]
v_pk_add_f32 v[130:131],v[130:131],v[238:239] op_sel_hi:[1,0] neg_lo:[0,1] neg_hi:[0,1]
v_pk_add_f32 v[132:133],v[132:133],v[238:239] op_sel_hi:[1,0] neg_lo:[0,1] neg_hi:[0,1]
v_pk_add_f32 v[134:135],v[134:135],v[238:239] op_sel_hi:[1,0] neg_lo:[0,1] neg_hi:[0,1]
v_pk_add_f32 v[138:139],v[138:139],v[238:239] op_sel_hi:[1,0] neg_lo:[0,1] neg_hi:[0,1]
v_exp_f32 v128,v128
v_exp_f32 v129,v129
v_exp_f32 v130,v130
v_exp_f32 v131,v131
v_exp_f32 v132,v132
v_exp_f32 v133,v133
v_exp_f32 v134,v134
v_exp_f32 v135,v135
v_exp_f32 v138,v138
v_exp_f32 v139,v139
v_pk_add_f32 v[148:149],v[128:129],v[130:131]
v_pk_add_f32 v[150:151],v[132:133],v[134:135]
v_pk_add_f32 v[148:149],v[148:149],v[138:139]
v_pk_add_f32 v[148:149],v[148:149],v[150:151]
v_add_f32 v150,v148,v149
v_add_f32 v151,v148,v149
s_nop 1
v_permlane16_swap_b32 v150,v151
v_add_f32 v148,v150,v151
v_add_f32 v149,v150,v151
s_nop 1
v_permlane32_swap_b32 v148,v149
v_add_f32 v148,v148,v149
v_rcp_f32 v148,v148
s_waitcnt vmcnt(0)
v_cmp_gt_u32 vcc,s66,v17
v_pk_mul_f32 v[138:139],v[138:139],v[148:149] op_sel_hi:[1,0]
v_pk_mul_f32 v[128:129],v[128:129],v[148:149] op_sel_hi:[1,0]
v_pk_mul_f32 v[130:131],v[130:131],v[148:149] op_sel_hi:[1,0]
v_pk_mul_f32 v[132:133],v[132:133],v[148:149] op_sel_hi:[1,0]
v_pk_mul_f32 v[134:135],v[134:135],v[148:149] op_sel_hi:[1,0]
s_cbranch_vccnz L_ap_137
L_apb_138:
s_xor_b32 s34,s69,524288
buffer_load_dwordx4 v[192:195],v7,s[8:11],s34 offen sc1
v_cvt_pk_bf16_f32 v144,v138,v139
v_cvt_pk_bf16_f32 v147,v138,v139
s_nop 0
v_mfma_f32_16x16x16_bf16 v[24:27],v[120:121],v[144:145],0
s_add_u32 s34,s34,4096
v_cvt_pk_bf16_f32 v140,v128,v129
v_mfma_f32_16x16x16_bf16 v[28:31],v[120:121],v[146:147],0
buffer_load_dwordx4 v[196:199],v7,s[8:11],s34 offen sc1
v_cvt_pk_bf16_f32 v141,v130,v131
v_mfma_f32_16x16x16_bf16 v[32:35],v[122:123],v[144:145],0
s_add_u32 s34,s34,4096
v_cvt_pk_bf16_f32 v142,v132,v133
v_mfma_f32_16x16x16_bf16 v[36:39],v[122:123],v[146:147],0
buffer_load_dwordx4 v[200:203],v7,s[8:11],s34 offen sc1
v_cvt_pk_bf16_f32 v143,v134,v135
v_mfma_f32_16x16x16_bf16 v[40:43],v[124:125],v[144:145],0
s_add_u32 s34,s34,4096
v_mfma_f32_16x16x16_bf16 v[44:47],v[124:125],v[146:147],0
buffer_load_dwordx4 v[204:207],v7,s[8:11],s34 offen sc1
v_mfma_f32_16x16x16_bf16 v[48:51],v[126:127],v[144:145],0
s_add_u32 s34,s34,4096
v_mfma_f32_16x16x16_bf16 v[52:55],v[126:127],v[146:147],0
buffer_load_dwordx4 v[208:211],v7,s[8:11],s34 offen sc1
v_mfma_f32_16x16x32_bf16 v[24:27],v[88:91],v[140:143],v[24:27]
s_add_u32 s34,s34,4096
v_mfma_f32_16x16x32_bf16 v[28:31],v[92:95],v[140:143],v[28:31]
buffer_load_dwordx4 v[212:215],v7,s[8:11],s34 offen sc1
v_mfma_f32_16x16x32_bf16 v[32:35],v[96:99],v[140:143],v[32:35]
s_add_u32 s34,s34,4096
v_mfma_f32_16x16x32_bf16 v[36:39],v[100:103],v[140:143],v[36:39]
buffer_load_dwordx4 v[216:219],v7,s[8:11],s34 offen sc1
v_cvt_pk_bf16_f32 v72,v24,v28
v_cvt_pk_bf16_f32 v73,v25,v29
v_mfma_f32_16x16x32_bf16 v[40:43],v[104:107],v[140:143],v[40:43]
s_add_u32 s34,s34,4096
v_cvt_pk_bf16_f32 v74,v26,v30
v_cvt_pk_bf16_f32 v75,v27,v31
v_mfma_f32_16x16x32_bf16 v[44:47],v[108:111],v[140:143],v[44:47]
ds_write_b128 v3,v[72:75] offset:0
v_cvt_pk_bf16_f32 v76,v32,v36
v_cvt_pk_bf16_f32 v77,v33,v37
v_mfma_f32_16x16x32_bf16 v[48:51],v[112:115],v[140:143],v[48:51]
buffer_load_dwordx4 v[220:223],v7,s[8:11],s34 offen sc1
v_cvt_pk_bf16_f32 v78,v34,v38
v_cvt_pk_bf16_f32 v79,v35,v39
v_mfma_f32_16x16x32_bf16 v[52:55],v[116:119],v[140:143],v[52:55]
ds_write_b128 v3,v[76:79] offset:1024
v_cvt_pk_bf16_f32 v80,v40,v44
v_cvt_pk_bf16_f32 v81,v41,v45
v_cvt_pk_bf16_f32 v82,v42,v46
v_cvt_pk_bf16_f32 v83,v43,v47
ds_write_b128 v3,v[80:83] offset:2048
s_nop 1
v_cvt_pk_bf16_f32 v84,v48,v52
v_cvt_pk_bf16_f32 v85,v49,v53
v_cvt_pk_bf16_f32 v86,v50,v54
v_cvt_pk_bf16_f32 v87,v51,v55
ds_write_b128 v3,v[84:87] offset:3072
v_readlane_b32 s32,v18,0
v_readlane_b32 s33,v18,1
s_waitcnt lgkmcnt(0)
s_barrier
s_branch L_aa_93
L_ai_136:
v_max3_f32 v238,v128,v129,v130
v_max3_f32 v239,v131,v132,v133
v_max3_f32 v238,v134,v135,v238
v_max3_f32 v239,v138,v139,v239
v_max_f32 v238,v238,v239
v_max_f32 v239,v238,v239
v_pk_mul_f32 v[128:129],v[128:129],v[152:153] op_sel_hi:[1,0]
v_pk_mul_f32 v[130:131],v[130:131],v[152:153] op_sel_hi:[1,0]
v_permlane16_swap_b32 v238,v239
v_max_f32 v238,v238,v239
v_max_f32 v239,v238,v239
v_pk_mul_f32 v[132:133],v[132:133],v[152:153] op_sel_hi:[1,0]
v_pk_mul_f32 v[134:135],v[134:135],v[152:153] op_sel_hi:[1,0]
v_permlane32_swap_b32 v238,v239
v_max_f32 v238,v238,v239
v_mul_f32 v238,v152,v238
v_pk_mul_f32 v[138:139],v[138:139],v[152:153] op_sel_hi:[1,0]
v_pk_add_f32 v[128:129],v[128:129],v[238:239] op_sel_hi:[1,0] neg_lo:[0,1] neg_hi:[0,1]
v_pk_add_f32 v[130:131],v[130:131],v[238:239] op_sel_hi:[1,0] neg_lo:[0,1] neg_hi:[0,1]
v_pk_add_f32 v[132:133],v[132:133],v[238:239] op_sel_hi:[1,0] neg_lo:[0,1] neg_hi:[0,1]
v_pk_add_f32 v[134:135],v[134:135],v[238:239] op_sel_hi:[1,0] neg_lo:[0,1] neg_hi:[0,1]
v_pk_add_f32 v[138:139],v[138:139],v[238:239] op_sel_hi:[1,0] neg_lo:[0,1] neg_hi:[0,1]
v_exp_f32 v128,v128
v_exp_f32 v129,v129
v_exp_f32 v130,v130
v_exp_f32 v131,v131
v_exp_f32 v132,v132
v_exp_f32 v133,v133
v_exp_f32 v134,v134
v_exp_f32 v135,v135
v_exp_f32 v138,v138
v_exp_f32 v139,v139
v_pk_add_f32 v[148:149],v[128:129],v[130:131]
v_pk_add_f32 v[150:151],v[132:133],v[134:135]
v_pk_add_f32 v[148:149],v[148:149],v[138:139]
v_pk_add_f32 v[148:149],v[148:149],v[150:151]
v_add_f32 v150,v148,v149
v_add_f32 v151,v148,v149
s_nop 1
v_permlane16_swap_b32 v150,v151
v_add_f32 v148,v150,v151
v_add_f32 v149,v150,v151
s_nop 1
v_permlane32_swap_b32 v148,v149
v_add_f32 v148,v148,v149
v_rcp_f32 v148,v148
s_nop 0
v_pk_mul_f32 v[138:139],v[138:139],v[148:149] op_sel_hi:[1,0]
v_pk_mul_f32 v[128:129],v[128:129],v[148:149] op_sel_hi:[1,0]
v_pk_mul_f32 v[130:131],v[130:131],v[148:149] op_sel_hi:[1,0]
v_pk_mul_f32 v[132:133],v[132:133],v[148:149] op_sel_hi:[1,0]
v_pk_mul_f32 v[134:135],v[134:135],v[148:149] op_sel_hi:[1,0]
v_cvt_pk_bf16_f32 v144,v138,v139
v_cvt_pk_bf16_f32 v147,v138,v139
s_nop 0
v_mfma_f32_16x16x16_bf16 v[24:27],v[120:121],v[144:145],0
v_cvt_pk_bf16_f32 v140,v128,v129
v_mfma_f32_16x16x16_bf16 v[28:31],v[120:121],v[146:147],0
v_cvt_pk_bf16_f32 v141,v130,v131
v_mfma_f32_16x16x16_bf16 v[32:35],v[122:123],v[144:145],0
v_cvt_pk_bf16_f32 v142,v132,v133
v_mfma_f32_16x16x16_bf16 v[36:39],v[122:123],v[146:147],0
v_cvt_pk_bf16_f32 v143,v134,v135
v_mfma_f32_16x16x16_bf16 v[40:43],v[124:125],v[144:145],0
v_mfma_f32_16x16x16_bf16 v[44:47],v[124:125],v[146:147],0
v_mfma_f32_16x16x16_bf16 v[48:51],v[126:127],v[144:145],0
v_mfma_f32_16x16x16_bf16 v[52:55],v[126:127],v[146:147],0
v_mfma_f32_16x16x32_bf16 v[24:27],v[88:91],v[140:143],v[24:27]
v_mfma_f32_16x16x32_bf16 v[28:31],v[92:95],v[140:143],v[28:31]
v_mfma_f32_16x16x32_bf16 v[32:35],v[96:99],v[140:143],v[32:35]
v_mfma_f32_16x16x32_bf16 v[36:39],v[100:103],v[140:143],v[36:39]
v_cvt_pk_bf16_f32 v72,v24,v28
v_cvt_pk_bf16_f32 v73,v25,v29
v_mfma_f32_16x16x32_bf16 v[40:43],v[104:107],v[140:143],v[40:43]
v_cvt_pk_bf16_f32 v74,v26,v30
v_cvt_pk_bf16_f32 v75,v27,v31
v_mfma_f32_16x16x32_bf16 v[44:47],v[108:111],v[140:143],v[44:47]
ds_write_b128 v3,v[72:75] offset:0
v_cvt_pk_bf16_f32 v76,v32,v36
v_cvt_pk_bf16_f32 v77,v33,v37
v_mfma_f32_16x16x32_bf16 v[48:51],v[112:115],v[140:143],v[48:51]
v_cvt_pk_bf16_f32 v78,v34,v38
v_cvt_pk_bf16_f32 v79,v35,v39
v_mfma_f32_16x16x32_bf16 v[52:55],v[116:119],v[140:143],v[52:55]
ds_write_b128 v3,v[76:79] offset:1024
v_cvt_pk_bf16_f32 v80,v40,v44
v_cvt_pk_bf16_f32 v81,v41,v45
v_cvt_pk_bf16_f32 v82,v42,v46
v_cvt_pk_bf16_f32 v83,v43,v47
ds_write_b128 v3,v[80:83] offset:2048
s_nop 1
v_cvt_pk_bf16_f32 v84,v48,v52
v_cvt_pk_bf16_f32 v85,v49,v53
v_cvt_pk_bf16_f32 v86,v50,v54
v_cvt_pk_bf16_f32 v87,v51,v55
ds_write_b128 v3,v[84:87] offset:3072
s_waitcnt vmcnt(0)
v_readlane_b32 s32,v18,0
v_readlane_b32 s33,v18,1
s_waitcnt lgkmcnt(0)
s_barrier
s_branch L_aa_80
L_aa_89:
s_cmp_lg_u32 s86,1536
s_cbranch_scc1 L_az_139
s_cmp_ge_u32 s35,67
s_cbranch_scc1 L_aa_79
v_subrev_u32 v248,s36,v1
v_and_b32 v248,0x80000003,v248
v_cmp_eq_u32 vcc,0,v248
v_lshlrev_b32 v248,2,v1
v_mov_b32 v249,0x40000000
v_cndmask_b32 v248,v249,v248,vcc
v_mov_b32 v249,3
s_or_b32 s59,s68,s46
s_mov_b32 s59,11018240
s_cmov_b32 s59,0x80000000
buffer_store_dword v249,v248,s[8:11],s59 offen sc1
L_aa_79:
s_waitcnt vmcnt(0)
buffer_store_dword v20,off,s[8:11],s73 sc1
s_mov_b32 s73,0x80000000
v_lshlrev_b32 v238,2,v1
v_add_u32 v248,155712,v238
s_cmp_lg_u32 s46,0
s_cbranch_scc1 L_an_140
s_lshl_b32 s59,s54,13
s_add_u32 s59,s59,11026432
L_fp_141:
s_sleep 1
buffer_load_dword v239,v238,s[8:11],s59 offen sc1
s_sub_u32 s49,s49,1
s_cbranch_scc1 L_abort
s_waitcnt vmcnt(0)
v_cmp_eq_u32 vcc,0,v239
s_cbranch_vccnz L_fp_141
ds_write_b32 v248,v239
s_waitcnt lgkmcnt(0)
L_an_140:
s_barrier
ds_read_b32 v239,v248
s_mov_b32 s86,768
s_mov_b32 s30,1
s_waitcnt lgkmcnt(0)
v_readfirstlane_b32 s55,v239
v_and_b32 v239,255,v239
s_lshr_b32 s55,s55,8
s_lshr_b32 s61,s55,5
v_cmp_ne_u32 s[38:39],3,v239
v_cmp_le_u32 vcc,s61,v1
s_nop 1
v_cndmask_b32 v238,1,2,vcc
v_cmp_ne_u32 s[84:85],v238,v239
s_bcnt1_i32_b64 s56,s[84:85]
s_nop 0
v_mbcnt_lo_u32_b32 v238,s84,0
v_mbcnt_hi_u32_b32 v238,s85,v238
s_mul_i32 s56,s56,15
s_add_u32 s56,s56,130
s_lshr_b32 s56,s56,7
s_lshl_b32 s56,s56,1
v_cmp_gt_u32 vcc,s56,v238
v_and_b32 v239,1,v238
v_and_b32 v238,3,v238
v_add_u32 v238,2,v238
v_cndmask_b32 v238,v238,v239,vcc
v_cmp_eq_u32 vcc,s54,v238
s_and_b64 s[84:85],s[84:85],vcc
s_ff1_i32_b64 s77,s[84:85]
s_bitset0_b64 s[84:85],s77
s_min_u32 s77,s77,64
s_lshl_b32 s56,s77,5
s_add_u32 s56,s56,s68
s_mul_i32 s70,s56,24576
s_lshl_b32 s71,s56,12
s_lshl_b32 s59,s77,13
s_lshl2_add_u32 s59,s68,s59
s_add_u32 s59,s59,10486144
s_cmp_lt_u32 s77,s61
s_cselect_b32 s57,0,16777216
s_mov_b32 s60,s59
s_buffer_load_dword s33,s[8:11],s60
s_add_u32 s71,s71,s57
s_add_u32 s71,s71,58720256
s_cmp_eq_u32 s77,s61
s_cselect_b32 s57,50331648,0
s_cselect_b32 s58,1536,0
s_add_u32 s59,s59,s58
s_buffer_load_dword s32,s[8:11],s59
s_add_u32 s70,s70,s57
s_add_u32 s70,s70,150994944
v_mov_b32 v19,s59
v_writelane_b32 v19,s60,1
s_cmp_ge_u32 s77,64
s_cbranch_scc1 L_az_139
s_cmp_eq_u32 s77,s61
s_cbranch_scc1 L_aa_87
s_mov_b32 s27,0
s_bitcmp1_b64 s[38:39],s77
s_cbranch_scc1 L_a3_126
s_branch L_aa_87
L_az_139:
s_waitcnt vmcnt(0)
buffer_store_dword v20,off,s[8:11],s73 sc1
s_mov_b32 s73,0x80000000
s_endpgm
L_ag_95:
s_lshl_b32 s21,s26,13
s_lshl2_add_u32 s21,s68,s21
s_add_u32 s21,s21,10487296
L_ww_142:
buffer_load_dword v246,off,s[8:11],s21 sc1
s_sub_u32 s49,s49,1
s_cbranch_scc1 L_abort
s_waitcnt vmcnt(0)
v_readfirstlane_b32 s22,v246
s_cmp_eq_u32 s22,0
s_cbranch_scc1 L_ww_142
L_wwd_143:
s_branch L_agb_96
L_a4_104:
v_mov_b32 v248,s27
ds_write_b32 v247,v248 offset:16
s_waitcnt lgkmcnt(0)
s_barrier
ds_read_b128 v[248:251],v245 offset:16
s_waitcnt lgkmcnt(0)
v_or3_b32 v248,v248,v249,v250
v_or_b32 v248,v248,v251
v_cmp_ne_u32 vcc,0,v248
s_cbranch_vccz L_a4_105
L_aq_144:
buffer_load_dword v17,v16,s[8:11],s87 offen sc1
s_sub_u32 s49,s49,1
s_cbranch_scc1 L_abort
s_waitcnt vmcnt(0)
v_cmp_gt_u32 vcc,s66,v17
s_cbranch_vccnz L_aq_144
s_xor_b32 s34,s69,524288
buffer_load_dwordx4 v[160:163],v7,s[8:11],s34 offen sc1
s_add_u32 s34,s34,4096
buffer_load_dwordx4 v[164:167],v7,s[8:11],s34 offen sc1
s_add_u32 s34,s34,4096
buffer_load_dwordx4 v[168:171],v7,s[8:11],s34 offen sc1
s_add_u32 s34,s34,4096
buffer_load_dwordx4 v[172:175],v7,s[8:11],s34 offen sc1
s_add_u32 s34,s34,4096
buffer_load_dwordx4 v[176:179],v7,s[8:11],s34 offen sc1
s_add_u32 s34,s34,4096
buffer_load_dwordx4 v[180:183],v7,s[8:11],s34 offen sc1
s_add_u32 s34,s34,4096
buffer_load_dwordx4 v[184:187],v7,s[8:11],s34 offen sc1
s_add_u32 s34,s34,4096
buffer_load_dwordx4 v[188:191],v7,s[8:11],s34 offen sc1
s_waitcnt vmcnt(7)
v_mfma_f32_16x16x32_bf16 v[192:195],v[156:159],v[160:163],0
s_waitcnt vmcnt(6)
v_mfma_f32_16x16x32_bf16 v[192:195],v[156:159],v[164:167],v[192:195]
s_waitcnt vmcnt(5)
v_mfma_f32_16x16x32_bf16 v[192:195],v[156:159],v[168:171],v[192:195]
s_waitcnt vmcnt(4)
v_mfma_f32_16x16x32_bf16 v[192:195],v[156:159],v[172:175],v[192:195]
s_waitcnt vmcnt(3)
v_mfma_f32_16x16x32_bf16 v[196:199],v[156:159],v[176:179],0
s_waitcnt vmcnt(2)
v_mfma_f32_16x16x32_bf16 v[196:199],v[156:159],v[180:183],v[196:199]
s_waitcnt vmcnt(1)
v_mfma_f32_16x16x32_bf16 v[196:199],v[156:159],v[184:187],v[196:199]
ds_write_b128 v6,v[192:195]
s_waitcnt vmcnt(0)
v_mfma_f32_16x16x32_bf16 v[196:199],v[156:159],v[188:191],v[196:199]
s_nop 7
ds_write_b128 v6,v[196:199] offset:2048
s_waitcnt lgkmcnt(0)
s_barrier
buffer_store_dword v20,off,s[8:11],s73 sc1
s_mov_b32 s73,0x80000000
s_mov_b32 s27,4
s_branch L_aa_84
L_ac_107:
buffer_store_dword v20,off,s[8:11],s73 sc1
s_mov_b32 s73,0x80000000
buffer_load_dwordx4 v[72:75],v0,s[8:11],s76 offen offset:0 sc1
buffer_load_dwordx4 v[76:79],v0,s[8:11],s76 offen offset:1024 sc1
buffer_load_dwordx4 v[80:83],v0,s[8:11],s76 offen offset:2048 sc1
buffer_load_dwordx4 v[84:87],v0,s[8:11],s76 offen offset:3072 sc1
s_sub_u32 s49,s49,1
s_cbranch_scc1 L_abort
s_mov_b32 vcc_lo,0x33333333
s_mov_b32 vcc_hi,0x33333333
s_waitcnt vmcnt(3)
v_mfma_f32_16x16x32_bf16 v[136:139],v[72:75],v[24:27],0
v_max3_u32 v238,v72,v73,v74
v_max3_u32 v238,v74,v75,v238
v_cndmask_b32_dpp v120,v72,v74,vcc quad_perm:[0,1,0,1] row_mask:0xf bank_mask:0xf
v_cndmask_b32_dpp v121,v73,v75,vcc quad_perm:[0,1,0,1] row_mask:0xf bank_mask:0xf
s_waitcnt vmcnt(2)
v_mfma_f32_16x16x32_bf16 v[136:139],v[76:79],v[28:31],v[136:139]
v_max3_u32 v238,v76,v77,v238
v_max3_u32 v238,v78,v79,v238
v_cndmask_b32_dpp v122,v76,v78,vcc quad_perm:[0,1,0,1] row_mask:0xf bank_mask:0xf
v_cndmask_b32_dpp v123,v77,v79,vcc quad_perm:[0,1,0,1] row_mask:0xf bank_mask:0xf
s_waitcnt vmcnt(1)
v_mfma_f32_16x16x32_bf16 v[136:139],v[80:83],v[32:35],v[136:139]
v_max3_u32 v238,v80,v81,v238
v_max3_u32 v238,v82,v83,v238
v_cndmask_b32_dpp v124,v80,v82,vcc quad_perm:[0,1,0,1] row_mask:0xf bank_mask:0xf
v_cndmask_b32_dpp v125,v81,v83,vcc quad_perm:[0,1,0,1] row_mask:0xf bank_mask:0xf
s_waitcnt vmcnt(0)
v_mfma_f32_16x16x32_bf16 v[136:139],v[84:87],v[36:39],v[136:139]
v_max3_u32 v238,v84,v85,v238
v_max3_u32 v238,v86,v87,v238
v_cndmask_b32_dpp v126,v84,v86,vcc quad_perm:[0,1,0,1] row_mask:0xf bank_mask:0xf
v_cndmask_b32_dpp v127,v85,v87,vcc quad_perm:[0,1,0,1] row_mask:0xf bank_mask:0xf
v_cmp_eq_u32 vcc,-1,v238
s_cbranch_vccnz L_ac_107
s_branch L_acb_108
L_ap_110:
L_aw_145:
v_cmp_gt_u32 vcc,s66,v17
s_cbranch_vccz L_awd_146
buffer_load_dword v17,v16,s[8:11],s87 offen sc1
s_sub_u32 s49,s49,1
s_cbranch_scc1 L_abort
s_waitcnt vmcnt(0)
s_branch L_aw_145
L_awd_146:
s_branch L_apb_111
L_a1_112:
v_subrev_u32 v248,s36,v1
v_and_b32 v248,0x80000003,v248
v_cmp_eq_u32 vcc,0,v248
v_lshlrev_b32 v248,2,v1
v_mov_b32 v249,0x40000000
v_cndmask_b32 v248,v249,v248,vcc
v_mov_b32 v249,3
s_or_b32 s59,s68,s46
s_mov_b32 s59,11018240
s_cmov_b32 s59,0x80000000
buffer_store_dword v249,v248,s[8:11],s59 offen sc1
s_branch L_a2_113
L_ag_121:
s_lshl_b32 s21,s51,13
s_lshl2_add_u32 s21,s68,s21
s_add_u32 s21,s21,10487296
L_ww_147:
buffer_load_dword v246,off,s[8:11],s21 sc1
s_sub_u32 s49,s49,1
s_cbranch_scc1 L_abort
s_waitcnt vmcnt(0)
v_readfirstlane_b32 s22,v246
s_cmp_eq_u32 s22,0
s_cbranch_scc1 L_ww_147
L_wwd_148:
s_branch L_agb_122
L_ac_129:
buffer_store_dword v20,off,s[8:11],s73 sc1
s_mov_b32 s73,0x80000000
buffer_load_dwordx4 v[72:75],v0,s[8:11],s76 offen offset:0 sc1
buffer_load_dwordx4 v[76:79],v0,s[8:11],s76 offen offset:1024 sc1
buffer_load_dwordx4 v[80:83],v0,s[8:11],s76 offen offset:2048 sc1
buffer_load_dwordx4 v[84:87],v0,s[8:11],s76 offen offset:3072 sc1
s_sub_u32 s49,s49,1
s_cbranch_scc1 L_abort
s_mov_b32 vcc_lo,0x33333333
s_mov_b32 vcc_hi,0x33333333
s_waitcnt vmcnt(3)
v_mfma_f32_16x16x32_bf16 v[136:139],v[72:75],v[24:27],0
v_max3_u32 v238,v72,v73,v74
v_max3_u32 v238,v74,v75,v238
v_cndmask_b32_dpp v120,v72,v74,vcc quad_perm:[0,1,0,1] row_mask:0xf bank_mask:0xf
v_cndmask_b32_dpp v121,v73,v75,vcc quad_perm:[0,1,0,1] row_mask:0xf bank_mask:0xf
s_waitcnt vmcnt(2)
v_mfma_f32_16x16x32_bf16 v[136:139],v[76:79],v[28:31],v[136:139]
v_max3_u32 v238,v76,v77,v238
v_max3_u32 v238,v78,v79,v238
v_cndmask_b32_dpp v122,v76,v78,vcc quad_perm:[0,1,0,1] row_mask:0xf bank_mask:0xf
v_cndmask_b32_dpp v123,v77,v79,vcc quad_perm:[0,1,0,1] row_mask:0xf bank_mask:0xf
s_waitcnt vmcnt(1)
v_mfma_f32_16x16x32_bf16 v[136:139],v[80:83],v[32:35],v[136:139]
v_max3_u32 v238,v80,v81,v238
v_max3_u32 v238,v82,v83,v238
v_cndmask_b32_dpp v124,v80,v82,vcc quad_perm:[0,1,0,1] row_mask:0xf bank_mask:0xf
v_cndmask_b32_dpp v125,v81,v83,vcc quad_perm:[0,1,0,1] row_mask:0xf bank_mask:0xf
s_waitcnt vmcnt(0)
v_mfma_f32_16x16x32_bf16 v[136:139],v[84:87],v[36:39],v[136:139]
v_max3_u32 v238,v84,v85,v238
v_max3_u32 v238,v86,v87,v238
v_cndmask_b32_dpp v126,v84,v86,vcc quad_perm:[0,1,0,1] row_mask:0xf bank_mask:0xf
v_cndmask_b32_dpp v127,v85,v87,vcc quad_perm:[0,1,0,1] row_mask:0xf bank_mask:0xf
v_cmp_eq_u32 vcc,-1,v238
s_cbranch_vccnz L_ac_129
s_branch L_acb_130
L_am_133:
v_subrev_u32 v248,s36,v1
v_and_b32 v248,0x80000003,v248
v_cmp_eq_u32 vcc,0,v248
v_lshlrev_b32 v248,2,v1
v_mov_b32 v249,0x40000000
v_cndmask_b32 v248,v249,v248,vcc
v_mov_b32 v249,3
s_or_b32 s59,s68,s46
s_mov_b32 s59,11018240
s_cmov_b32 s59,0x80000000
buffer_store_dword v249,v248,s[8:11],s59 offen sc1
s_branch L_ab_131
L_ap_137:
L_aw_149:
v_cmp_gt_u32 vcc,s66,v17
s_cbranch_vccz L_awd_150
buffer_load_dword v17,v16,s[8:11],s87 offen sc1
s_sub_u32 s49,s49,1
s_cbranch_scc1 L_abort
s_waitcnt vmcnt(0)
s_branch L_aw_149
L_awd_150:
s_branch L_apb_138
s_endpgm
L_rch_4:
s_waitcnt vmcnt(12)
v_swap_b32 v25,v28
v_swap_b32 v26,v32
v_swap_b32 v27,v36
v_swap_b32 v30,v33
v_swap_b32 v31,v37
v_swap_b32 v35,v38
ds_write_b128 v93,v[24:27] offset:0
ds_write_b128 v94,v[28:31] offset:0
ds_write_b128 v93,v[32:35] offset:128
ds_write_b128 v94,v[36:39] offset:128
s_waitcnt lgkmcnt(0)
s_mov_b32 s56,65536
buffer_load_dwordx4 v[24:27],v92,s[4:7],s56 offen offset:0
buffer_load_dwordx4 v[28:31],v92,s[4:7],s56 offen offset:1024
buffer_load_dwordx4 v[32:35],v92,s[4:7],s56 offen offset:2048
buffer_load_dwordx4 v[36:39],v92,s[4:7],s56 offen offset:3072
s_waitcnt vmcnt(12)
v_swap_b32 v41,v44
v_swap_b32 v42,v48
v_swap_b32 v43,v52
v_swap_b32 v46,v49
v_swap_b32 v47,v53
v_swap_b32 v51,v54
ds_write_b128 v93,v[40:43] offset:1024
ds_write_b128 v94,v[44:47] offset:1024
ds_write_b128 v93,v[48:51] offset:1152
ds_write_b128 v94,v[52:55] offset:1152
s_waitcnt lgkmcnt(0)
s_mov_b32 s56,81920
buffer_load_dwordx4 v[40:43],v92,s[4:7],s56 offen offset:0
buffer_load_dwordx4 v[44:47],v92,s[4:7],s56 offen offset:1024
buffer_load_dwordx4 v[48:51],v92,s[4:7],s56 offen offset:2048
buffer_load_dwordx4 v[52:55],v92,s[4:7],s56 offen offset:3072
s_waitcnt vmcnt(12)
v_swap_b32 v57,v60
v_swap_b32 v58,v64
v_swap_b32 v59,v68
v_swap_b32 v62,v65
v_swap_b32 v63,v69
v_swap_b32 v67,v70
ds_write_b128 v93,v[56:59] offset:2048
ds_write_b128 v94,v[60:63] offset:2048
ds_write_b128 v93,v[64:67] offset:2176
ds_write_b128 v94,v[68:71] offset:2176
s_waitcnt lgkmcnt(0)
s_mov_b32 s56,98304
buffer_load_dwordx4 v[56:59],v92,s[4:7],s56 offen offset:0
buffer_load_dwordx4 v[60:63],v92,s[4:7],s56 offen offset:1024
buffer_load_dwordx4 v[64:67],v92,s[4:7],s56 offen offset:2048
buffer_load_dwordx4 v[68:71],v92,s[4:7],s56 offen offset:3072
s_waitcnt vmcnt(12)
v_swap_b32 v73,v76
v_swap_b32 v74,v80
v_swap_b32 v75,v84
v_swap_b32 v78,v81
v_swap_b32 v79,v85
v_swap_b32 v83,v86
ds_write_b128 v93,v[72:75] offset:3072
ds_write_b128 v94,v[76:79] offset:3072
ds_write_b128 v93,v[80:83] offset:3200
ds_write_b128 v94,v[84:87] offset:3200
s_waitcnt lgkmcnt(0)
s_mov_b32 s56,114688
buffer_load_dwordx4 v[72:75],v92,s[4:7],s56 offen offset:0
buffer_load_dwordx4 v[76:79],v92,s[4:7],s56 offen offset:1024
buffer_load_dwordx4 v[80:83],v92,s[4:7],s56 offen offset:2048
buffer_load_dwordx4 v[84:87],v92,s[4:7],s56 offen offset:3072
s_cmp_eq_u32 s48,0
s_cbranch_scc1 L_rs_151
s_waitcnt vmcnt(12)
v_swap_b32 v25,v28
v_swap_b32 v26,v32
v_swap_b32 v27,v36
v_swap_b32 v30,v33
v_swap_b32 v31,v37
v_swap_b32 v35,v38
ds_write_b128 v93,v[24:27] offset:4096
ds_write_b128 v94,v[28:31] offset:4096
ds_write_b128 v93,v[32:35] offset:4224
ds_write_b128 v94,v[36:39] offset:4224
s_waitcnt vmcnt(8)
v_swap_b32 v41,v44
v_swap_b32 v42,v48
v_swap_b32 v43,v52
v_swap_b32 v46,v49
v_swap_b32 v47,v53
v_swap_b32 v51,v54
ds_write_b128 v93,v[40:43] offset:5120
ds_write_b128 v94,v[44:47] offset:5120
ds_write_b128 v93,v[48:51] offset:5248
ds_write_b128 v94,v[52:55] offset:5248
s_waitcnt vmcnt(4)
v_swap_b32 v57,v60
v_swap_b32 v58,v64
v_swap_b32 v59,v68
v_swap_b32 v62,v65
v_swap_b32 v63,v69
v_swap_b32 v67,v70
ds_write_b128 v93,v[56:59] offset:6144
ds_write_b128 v94,v[60:63] offset:6144
ds_write_b128 v93,v[64:67] offset:6272
ds_write_b128 v94,v[68:71] offset:6272
s_waitcnt vmcnt(0)
v_swap_b32 v73,v76
v_swap_b32 v74,v80
v_swap_b32 v75,v84
v_swap_b32 v78,v81
v_swap_b32 v79,v85
v_swap_b32 v83,v86
ds_write_b128 v93,v[72:75] offset:7168
ds_write_b128 v94,v[76:79] offset:7168
ds_write_b128 v93,v[80:83] offset:7296
ds_write_b128 v94,v[84:87] offset:7296
L_rs_151:
v_mov_b32 v123,159744
s_cmp_lg_u32 s46,0
s_cbranch_scc1 L_gbd_153
v_mov_b32 v124,240
s_buffer_load_dword s56,s[12:15],240
s_waitcnt lgkmcnt(0)
v_mov_b32 v125,s56
ds_write_b32 v123,v125
s_bitcmp1_b32 s56,8
s_cbranch_scc1 L_gbd_153
L_gb_152:
buffer_load_dword v125,v124,s[12:15],0 offen sc1
s_waitcnt vmcnt(0)
v_readfirstlane_b32 s56,v125
ds_write_b32 v123,v125
s_bitcmp1_b32 s56,8
s_cbranch_scc1 L_gbd_153
s_sleep 4
s_sub_u32 s49,s49,1
s_cmp_gt_i32 s49,0
s_cbranch_scc1 L_gb_152
s_branch L_abort
L_gbd_153:
s_waitcnt lgkmcnt(0)
s_barrier
ds_read_b32 v125,v123
s_waitcnt lgkmcnt(0)
v_readfirstlane_b32 s56,v125
s_barrier
s_lshr_b32 s56,s56,16
s_andn2_b32 s56,s56,s3
s_cbranch_scc1 L_spread
s_cmp_eq_u32 s48,0
s_cbranch_scc1 L_chd_154
v_and_b32 v120,15,v1
v_lshrrev_b32 v121,4,v1
v_mov_b32 v17,1
s_lshl_b32 s56,s46,2
v_add_u32 v125,s56,v121
v_xor_b32 v126,v125,v120
v_lshlrev_b32 v126,4,v126
v_lshl_add_u32 v20,v125,10,v126
s_lshl_b32 s56,s46,1
s_xor_b32 s56,s56,0
s_and_b32 s57,s56,3
s_lshl_b32 s57,s57,2
s_lshr_b32 s56,s56,2
s_lshl_b32 s56,s56,13
s_add_u32 s56,s56,131072
v_add_u32 v125,s57,v121
v_xor_b32 v125,v125,v120
v_lshlrev_b32 v125,4,v125
v_lshl_add_u32 v125,v120,8,v125
v_add_u32 v4,s56,v125
s_lshl_b32 s56,s46,1
s_xor_b32 s56,s56,1
s_and_b32 s57,s56,3
s_lshl_b32 s57,s57,2
s_lshr_b32 s56,s56,2
s_lshl_b32 s56,s56,13
s_add_u32 s56,s56,131072
v_add_u32 v125,s57,v121
v_xor_b32 v125,v125,v120
v_lshlrev_b32 v125,4,v125
v_lshl_add_u32 v125,v120,8,v125
v_add_u32 v5,s56,v125
s_lshl_b32 s56,s46,1
s_xor_b32 s56,s56,2
s_and_b32 s57,s56,3
s_lshl_b32 s57,s57,2
s_lshr_b32 s56,s56,2
s_lshl_b32 s56,s56,13
s_add_u32 s56,s56,131072
v_add_u32 v125,s57,v121
v_xor_b32 v125,v125,v120
v_lshlrev_b32 v125,4,v125
v_lshl_add_u32 v125,v120,8,v125
v_add_u32 v6,s56,v125
s_lshl_b32 s56,s46,1
s_xor_b32 s56,s56,3
s_and_b32 s57,s56,3
s_lshl_b32 s57,s57,2
s_lshr_b32 s56,s56,2
s_lshl_b32 s56,s56,13
s_add_u32 s56,s56,131072
v_add_u32 v125,s57,v121
v_xor_b32 v125,v125,v120
v_lshlrev_b32 v125,4,v125
v_lshl_add_u32 v125,v120,8,v125
v_add_u32 v7,s56,v125
s_lshl_b32 s56,s46,1
s_xor_b32 s56,s56,4
s_and_b32 s57,s56,3
s_lshl_b32 s57,s57,2
s_lshr_b32 s56,s56,2
s_lshl_b32 s56,s56,13
s_add_u32 s56,s56,131072
v_add_u32 v125,s57,v121
v_xor_b32 v125,v125,v120
v_lshlrev_b32 v125,4,v125
v_lshl_add_u32 v125,v120,8,v125
v_add_u32 v8,s56,v125
s_lshl_b32 s56,s46,1
s_xor_b32 s56,s56,5
s_and_b32 s57,s56,3
s_lshl_b32 s57,s57,2
s_lshr_b32 s56,s56,2
s_lshl_b32 s56,s56,13
s_add_u32 s56,s56,131072
v_add_u32 v125,s57,v121
v_xor_b32 v125,v125,v120
v_lshlrev_b32 v125,4,v125
v_lshl_add_u32 v125,v120,8,v125
v_add_u32 v9,s56,v125
s_lshl_b32 s56,s46,1
s_xor_b32 s56,s56,6
s_and_b32 s57,s56,3
s_lshl_b32 s57,s57,2
s_lshr_b32 s56,s56,2
s_lshl_b32 s56,s56,13
s_add_u32 s56,s56,131072
v_add_u32 v125,s57,v121
v_xor_b32 v125,v125,v120
v_lshlrev_b32 v125,4,v125
v_lshl_add_u32 v125,v120,8,v125
v_add_u32 v10,s56,v125
s_lshl_b32 s56,s46,1
s_xor_b32 s56,s56,7
s_and_b32 s57,s56,3
s_lshl_b32 s57,s57,2
s_lshr_b32 s56,s56,2
s_lshl_b32 s56,s56,13
s_add_u32 s56,s56,131072
v_add_u32 v125,s57,v121
v_xor_b32 v125,v125,v120
v_lshlrev_b32 v125,4,v125
v_lshl_add_u32 v125,v120,8,v125
v_add_u32 v11,s56,v125
s_cmp_eq_u32 s48,1
s_cselect_b32 s51,14,17
s_cselect_b32 s53,3,5
s_mov_b32 s72,0x80000000
s_lshl_b32 s70,s51,15
s_add_u32 s70,s70,0
s_add_u32 s71,s70,16384
s_add_u32 m0,s50,131072
s_nop 0
buffer_load_dwordx4 v20,s[8:11],s70 offen offset:0 sc1 lds
s_add_u32 m0,s50,135168
s_nop 0
buffer_load_dwordx4 v20,s[8:11],s71 offen offset:0 sc1 lds
s_add_u32 m0,s50,139008
s_nop 0
buffer_load_dwordx4 v20,s[8:11],s70 offen offset:256 sc1 lds
s_add_u32 m0,s50,143104
s_nop 0
buffer_load_dwordx4 v20,s[8:11],s71 offen offset:256 sc1 lds
s_waitcnt vmcnt(0)
L_chl_155:
s_mov_b64 s[68:69],s[70:71]
s_add_u32 s70,s70,32768
s_add_u32 s71,s71,32768
s_lshl_b32 s58,s51,5
s_add_u32 s58,s58,s47
s_mul_i32 s58,s58,24576
s_add_u32 s58,s58,100663296
s_add_u32 s61,s58,s50
s_add_u32 s62,s61,4096
s_add_u32 s63,s61,16384
s_add_u32 s64,s61,20480
s_add_u32 s65,s61,s50
s_add_u32 s65,s65,8192
s_waitcnt vmcnt(7)
s_barrier
ds_read_b128 v[72:75],v4 offset:0
ds_read_b128 v[76:79],v4 offset:4096
ds_read_b128 v[80:83],v5 offset:0
ds_read_b128 v[84:87],v5 offset:4096
s_add_u32 m0,s50,146944
s_nop 0
buffer_load_dwordx4 v20,s[8:11],s68 offen offset:512 sc1 lds
s_add_u32 m0,s50,151040
s_nop 0
buffer_load_dwordx4 v20,s[8:11],s69 offen offset:512 sc1 lds
s_add_u32 m0,s50,154880
s_nop 0
buffer_load_dwordx4 v20,s[8:11],s68 offen offset:768 sc1 lds
s_add_u32 m0,s50,158976
s_nop 0
buffer_load_dwordx4 v20,s[8:11],s69 offen offset:768 sc1 lds
s_waitcnt lgkmcnt(2)
v_mfma_f32_16x16x32_bf16 v[40:43],a[128:131],v[72:75],0
ds_read_b128 v[108:111],v6 offset:0
v_mfma_f32_16x16x32_bf16 v[56:59],v[72:75],v[128:131],0
v_mfma_f32_16x16x32_bf16 v[24:27],a[0:3],v[72:75],0
ds_read_b128 v[112:115],v6 offset:4096
v_mfma_f32_16x16x32_bf16 v[44:47],a[128:131],v[76:79],0
v_mfma_f32_16x16x32_bf16 v[60:63],v[76:79],v[128:131],0
v_mfma_f32_16x16x32_bf16 v[28:31],a[0:3],v[76:79],0
v_mfma_f32_16x16x32_bf16 v[48:51],a[136:139],v[72:75],0
v_mfma_f32_16x16x32_bf16 v[64:67],v[72:75],v[136:139],0
v_mfma_f32_16x16x32_bf16 v[32:35],a[8:11],v[72:75],0
v_mfma_f32_16x16x32_bf16 v[52:55],a[136:139],v[76:79],0
v_mfma_f32_16x16x32_bf16 v[68:71],v[76:79],v[136:139],0
v_mfma_f32_16x16x32_bf16 v[36:39],a[8:11],v[76:79],0
s_waitcnt lgkmcnt(2)
v_mfma_f32_16x16x32_bf16 v[40:43],a[132:135],v[80:83],v[40:43]
ds_read_b128 v[72:75],v7 offset:0
v_mfma_f32_16x16x32_bf16 v[56:59],v[80:83],v[132:135],v[56:59]
v_mfma_f32_16x16x32_bf16 v[24:27],a[4:7],v[80:83],v[24:27]
ds_read_b128 v[76:79],v7 offset:4096
v_mfma_f32_16x16x32_bf16 v[44:47],a[132:135],v[84:87],v[44:47]
v_mfma_f32_16x16x32_bf16 v[60:63],v[84:87],v[132:135],v[60:63]
v_mfma_f32_16x16x32_bf16 v[28:31],a[4:7],v[84:87],v[28:31]
v_mfma_f32_16x16x32_bf16 v[48:51],a[140:143],v[80:83],v[48:51]
v_mfma_f32_16x16x32_bf16 v[64:67],v[80:83],v[140:143],v[64:67]
v_mfma_f32_16x16x32_bf16 v[32:35],a[12:15],v[80:83],v[32:35]
v_mfma_f32_16x16x32_bf16 v[52:55],a[140:143],v[84:87],v[52:55]
v_mfma_f32_16x16x32_bf16 v[68:71],v[84:87],v[140:143],v[68:71]
v_mfma_f32_16x16x32_bf16 v[36:39],a[12:15],v[84:87],v[36:39]
s_waitcnt lgkmcnt(2)
v_mfma_f32_16x16x32_bf16 v[40:43],a[144:147],v[108:111],v[40:43]
ds_read_b128 v[80:83],v8 offset:0
v_mfma_f32_16x16x32_bf16 v[56:59],v[108:111],v[144:147],v[56:59]
v_mfma_f32_16x16x32_bf16 v[24:27],a[16:19],v[108:111],v[24:27]
ds_read_b128 v[84:87],v8 offset:4096
v_mfma_f32_16x16x32_bf16 v[44:47],a[144:147],v[112:115],v[44:47]
v_mfma_f32_16x16x32_bf16 v[60:63],v[112:115],v[144:147],v[60:63]
v_mfma_f32_16x16x32_bf16 v[28:31],a[16:19],v[112:115],v[28:31]
v_mfma_f32_16x16x32_bf16 v[48:51],a[152:155],v[108:111],v[48:51]
v_mfma_f32_16x16x32_bf16 v[64:67],v[108:111],v[152:155],v[64:67]
v_mfma_f32_16x16x32_bf16 v[32:35],a[24:27],v[108:111],v[32:35]
v_mfma_f32_16x16x32_bf16 v[52:55],a[152:155],v[112:115],v[52:55]
v_mfma_f32_16x16x32_bf16 v[68:71],v[112:115],v[152:155],v[68:71]
v_mfma_f32_16x16x32_bf16 v[36:39],a[24:27],v[112:115],v[36:39]
s_waitcnt lgkmcnt(2)
v_mfma_f32_16x16x32_bf16 v[40:43],a[148:151],v[72:75],v[40:43]
ds_read_b128 v[108:111],v9 offset:0
v_mfma_f32_16x16x32_bf16 v[56:59],v[72:75],v[148:151],v[56:59]
v_mfma_f32_16x16x32_bf16 v[24:27],a[20:23],v[72:75],v[24:27]
ds_read_b128 v[112:115],v9 offset:4096
v_mfma_f32_16x16x32_bf16 v[44:47],a[148:151],v[76:79],v[44:47]
v_mfma_f32_16x16x32_bf16 v[60:63],v[76:79],v[148:151],v[60:63]
v_mfma_f32_16x16x32_bf16 v[28:31],a[20:23],v[76:79],v[28:31]
v_mfma_f32_16x16x32_bf16 v[48:51],a[156:159],v[72:75],v[48:51]
v_mfma_f32_16x16x32_bf16 v[64:67],v[72:75],v[156:159],v[64:67]
v_mfma_f32_16x16x32_bf16 v[32:35],a[28:31],v[72:75],v[32:35]
v_mfma_f32_16x16x32_bf16 v[52:55],a[156:159],v[76:79],v[52:55]
v_mfma_f32_16x16x32_bf16 v[68:71],v[76:79],v[156:159],v[68:71]
v_mfma_f32_16x16x32_bf16 v[36:39],a[28:31],v[76:79],v[36:39]
s_waitcnt lgkmcnt(2)
v_mfma_f32_16x16x32_bf16 v[40:43],a[160:163],v[80:83],v[40:43]
ds_read_b128 v[72:75],v10 offset:0
v_mfma_f32_16x16x32_bf16 v[56:59],v[80:83],v[160:163],v[56:59]
v_mfma_f32_16x16x32_bf16 v[24:27],a[32:35],v[80:83],v[24:27]
ds_read_b128 v[76:79],v10 offset:4096
v_mfma_f32_16x16x32_bf16 v[44:47],a[160:163],v[84:87],v[44:47]
v_mfma_f32_16x16x32_bf16 v[60:63],v[84:87],v[160:163],v[60:63]
v_mfma_f32_16x16x32_bf16 v[28:31],a[32:35],v[84:87],v[28:31]
v_mfma_f32_16x16x32_bf16 v[48:51],a[168:171],v[80:83],v[48:51]
v_mfma_f32_16x16x32_bf16 v[64:67],v[80:83],v[168:171],v[64:67]
v_mfma_f32_16x16x32_bf16 v[32:35],a[40:43],v[80:83],v[32:35]
v_mfma_f32_16x16x32_bf16 v[52:55],a[168:171],v[84:87],v[52:55]
v_mfma_f32_16x16x32_bf16 v[68:71],v[84:87],v[168:171],v[68:71]
v_mfma_f32_16x16x32_bf16 v[36:39],a[40:43],v[84:87],v[36:39]
s_waitcnt lgkmcnt(2)
v_mfma_f32_16x16x32_bf16 v[40:43],a[164:167],v[108:111],v[40:43]
ds_read_b128 v[80:83],v11 offset:0
v_mfma_f32_16x16x32_bf16 v[56:59],v[108:111],v[164:167],v[56:59]
v_mfma_f32_16x16x32_bf16 v[24:27],a[36:39],v[108:111],v[24:27]
ds_read_b128 v[84:87],v11 offset:4096
v_mfma_f32_16x16x32_bf16 v[44:47],a[164:167],v[112:115],v[44:47]
v_mfma_f32_16x16x32_bf16 v[60:63],v[112:115],v[164:167],v[60:63]
v_mfma_f32_16x16x32_bf16 v[28:31],a[36:39],v[112:115],v[28:31]
v_mfma_f32_16x16x32_bf16 v[48:51],a[172:175],v[108:111],v[48:51]
v_mfma_f32_16x16x32_bf16 v[64:67],v[108:111],v[172:175],v[64:67]
v_mfma_f32_16x16x32_bf16 v[32:35],a[44:47],v[108:111],v[32:35]
v_mfma_f32_16x16x32_bf16 v[52:55],a[172:175],v[112:115],v[52:55]
v_mfma_f32_16x16x32_bf16 v[68:71],v[112:115],v[172:175],v[68:71]
v_mfma_f32_16x16x32_bf16 v[36:39],a[44:47],v[112:115],v[36:39]
s_waitcnt vmcnt(0)
s_barrier
s_or_b32 s72,s72,s52
buffer_store_dword v17,off,s[8:11],s72 sc1
s_waitcnt lgkmcnt(2)
v_mfma_f32_16x16x32_bf16 v[40:43],a[176:179],v[72:75],v[40:43]
ds_read_b128 v[108:111],v4 offset:16384
v_mfma_f32_16x16x32_bf16 v[56:59],v[72:75],v[176:179],v[56:59]
v_mfma_f32_16x16x32_bf16 v[24:27],a[48:51],v[72:75],v[24:27]
ds_read_b128 v[112:115],v4 offset:20480
v_mfma_f32_16x16x32_bf16 v[44:47],a[176:179],v[76:79],v[44:47]
v_mfma_f32_16x16x32_bf16 v[60:63],v[76:79],v[176:179],v[60:63]
v_mfma_f32_16x16x32_bf16 v[28:31],a[48:51],v[76:79],v[28:31]
v_mfma_f32_16x16x32_bf16 v[48:51],a[184:187],v[72:75],v[48:51]
v_mfma_f32_16x16x32_bf16 v[64:67],v[72:75],v[184:187],v[64:67]
v_mfma_f32_16x16x32_bf16 v[32:35],a[56:59],v[72:75],v[32:35]
v_mfma_f32_16x16x32_bf16 v[52:55],a[184:187],v[76:79],v[52:55]
v_mfma_f32_16x16x32_bf16 v[68:71],v[76:79],v[184:187],v[68:71]
v_mfma_f32_16x16x32_bf16 v[36:39],a[56:59],v[76:79],v[36:39]
s_waitcnt lgkmcnt(2)
v_mfma_f32_16x16x32_bf16 v[40:43],a[180:183],v[80:83],v[40:43]
ds_read_b128 v[72:75],v5 offset:16384
v_mfma_f32_16x16x32_bf16 v[56:59],v[80:83],v[180:183],v[56:59]
v_mfma_f32_16x16x32_bf16 v[24:27],a[52:55],v[80:83],v[24:27]
ds_read_b128 v[76:79],v5 offset:20480
v_mfma_f32_16x16x32_bf16 v[44:47],a[180:183],v[84:87],v[44:47]
v_mfma_f32_16x16x32_bf16 v[60:63],v[84:87],v[180:183],v[60:63]
v_mfma_f32_16x16x32_bf16 v[28:31],a[52:55],v[84:87],v[28:31]
v_mfma_f32_16x16x32_bf16 v[48:51],a[188:191],v[80:83],v[48:51]
v_mfma_f32_16x16x32_bf16 v[64:67],v[80:83],v[188:191],v[64:67]
v_mfma_f32_16x16x32_bf16 v[32:35],a[60:63],v[80:83],v[32:35]
v_mfma_f32_16x16x32_bf16 v[52:55],a[188:191],v[84:87],v[52:55]
v_mfma_f32_16x16x32_bf16 v[68:71],v[84:87],v[188:191],v[68:71]
v_mfma_f32_16x16x32_bf16 v[36:39],a[60:63],v[84:87],v[36:39]
s_waitcnt lgkmcnt(2)
v_mfma_f32_16x16x32_bf16 v[40:43],a[192:195],v[108:111],v[40:43]
ds_read_b128 v[80:83],v6 offset:16384
v_mfma_f32_16x16x32_bf16 v[56:59],v[108:111],v[192:195],v[56:59]
v_mfma_f32_16x16x32_bf16 v[24:27],a[64:67],v[108:111],v[24:27]
ds_read_b128 v[84:87],v6 offset:20480
v_mfma_f32_16x16x32_bf16 v[44:47],a[192:195],v[112:115],v[44:47]
v_mfma_f32_16x16x32_bf16 v[60:63],v[112:115],v[192:195],v[60:63]
v_mfma_f32_16x16x32_bf16 v[28:31],a[64:67],v[112:115],v[28:31]
v_mfma_f32_16x16x32_bf16 v[48:51],a[200:203],v[108:111],v[48:51]
v_mfma_f32_16x16x32_bf16 v[64:67],v[108:111],v[200:203],v[64:67]
v_mfma_f32_16x16x32_bf16 v[32:35],a[72:75],v[108:111],v[32:35]
v_mfma_f32_16x16x32_bf16 v[52:55],a[200:203],v[112:115],v[52:55]
v_mfma_f32_16x16x32_bf16 v[68:71],v[112:115],v[200:203],v[68:71]
v_mfma_f32_16x16x32_bf16 v[36:39],a[72:75],v[112:115],v[36:39]
s_waitcnt lgkmcnt(2)
v_mfma_f32_16x16x32_bf16 v[40:43],a[196:199],v[72:75],v[40:43]
ds_read_b128 v[108:111],v7 offset:16384
v_mfma_f32_16x16x32_bf16 v[56:59],v[72:75],v[196:199],v[56:59]
v_mfma_f32_16x16x32_bf16 v[24:27],a[68:71],v[72:75],v[24:27]
ds_read_b128 v[112:115],v7 offset:20480
v_mfma_f32_16x16x32_bf16 v[44:47],a[196:199],v[76:79],v[44:47]
v_mfma_f32_16x16x32_bf16 v[60:63],v[76:79],v[196:199],v[60:63]
v_mfma_f32_16x16x32_bf16 v[28:31],a[68:71],v[76:79],v[28:31]
v_mfma_f32_16x16x32_bf16 v[48:51],a[204:207],v[72:75],v[48:51]
v_mfma_f32_16x16x32_bf16 v[64:67],v[72:75],v[204:207],v[64:67]
v_mfma_f32_16x16x32_bf16 v[32:35],a[76:79],v[72:75],v[32:35]
v_mfma_f32_16x16x32_bf16 v[52:55],a[204:207],v[76:79],v[52:55]
v_mfma_f32_16x16x32_bf16 v[68:71],v[76:79],v[204:207],v[68:71]
v_mfma_f32_16x16x32_bf16 v[36:39],a[76:79],v[76:79],v[36:39]
s_waitcnt lgkmcnt(2)
v_mfma_f32_16x16x32_bf16 v[40:43],a[208:211],v[80:83],v[40:43]
ds_read_b128 v[72:75],v8 offset:16384
v_mfma_f32_16x16x32_bf16 v[56:59],v[80:83],v[208:211],v[56:59]
v_mfma_f32_16x16x32_bf16 v[24:27],a[80:83],v[80:83],v[24:27]
ds_read_b128 v[76:79],v8 offset:20480
v_mfma_f32_16x16x32_bf16 v[44:47],a[208:211],v[84:87],v[44:47]
v_mfma_f32_16x16x32_bf16 v[60:63],v[84:87],v[208:211],v[60:63]
v_mfma_f32_16x16x32_bf16 v[28:31],a[80:83],v[84:87],v[28:31]
v_mfma_f32_16x16x32_bf16 v[48:51],a[216:219],v[80:83],v[48:51]
v_mfma_f32_16x16x32_bf16 v[64:67],v[80:83],v[216:219],v[64:67]
v_mfma_f32_16x16x32_bf16 v[32:35],a[88:91],v[80:83],v[32:35]
v_mfma_f32_16x16x32_bf16 v[52:55],a[216:219],v[84:87],v[52:55]
v_mfma_f32_16x16x32_bf16 v[68:71],v[84:87],v[216:219],v[68:71]
v_mfma_f32_16x16x32_bf16 v[36:39],a[88:91],v[84:87],v[36:39]
s_waitcnt lgkmcnt(2)
v_mfma_f32_16x16x32_bf16 v[40:43],a[212:215],v[108:111],v[40:43]
ds_read_b128 v[80:83],v9 offset:16384
v_mfma_f32_16x16x32_bf16 v[56:59],v[108:111],v[212:215],v[56:59]
v_mfma_f32_16x16x32_bf16 v[24:27],a[84:87],v[108:111],v[24:27]
ds_read_b128 v[84:87],v9 offset:20480
v_mfma_f32_16x16x32_bf16 v[44:47],a[212:215],v[112:115],v[44:47]
v_mfma_f32_16x16x32_bf16 v[60:63],v[112:115],v[212:215],v[60:63]
v_mfma_f32_16x16x32_bf16 v[28:31],a[84:87],v[112:115],v[28:31]
v_mfma_f32_16x16x32_bf16 v[48:51],a[220:223],v[108:111],v[48:51]
v_mfma_f32_16x16x32_bf16 v[64:67],v[108:111],v[220:223],v[64:67]
v_mfma_f32_16x16x32_bf16 v[32:35],a[92:95],v[108:111],v[32:35]
v_mfma_f32_16x16x32_bf16 v[52:55],a[220:223],v[112:115],v[52:55]
v_mfma_f32_16x16x32_bf16 v[68:71],v[112:115],v[220:223],v[68:71]
v_mfma_f32_16x16x32_bf16 v[36:39],a[92:95],v[112:115],v[36:39]
s_barrier
s_waitcnt lgkmcnt(2)
v_mfma_f32_16x16x32_bf16 v[40:43],a[224:227],v[72:75],v[40:43]
ds_read_b128 v[108:111],v10 offset:16384
v_mfma_f32_16x16x32_bf16 v[56:59],v[72:75],v[224:227],v[56:59]
s_add_u32 m0,s50,131072
v_mfma_f32_16x16x32_bf16 v[24:27],a[96:99],v[72:75],v[24:27]
ds_read_b128 v[112:115],v10 offset:20480
v_mfma_f32_16x16x32_bf16 v[44:47],a[224:227],v[76:79],v[44:47]
buffer_load_dwordx4 v20,s[8:11],s70 offen offset:0 sc1 lds
v_mfma_f32_16x16x32_bf16 v[60:63],v[76:79],v[224:227],v[60:63]
s_add_u32 m0,s50,135168
v_mfma_f32_16x16x32_bf16 v[28:31],a[96:99],v[76:79],v[28:31]
buffer_load_dwordx4 v20,s[8:11],s71 offen offset:0 sc1 lds
v_mfma_f32_16x16x32_bf16 v[48:51],a[232:235],v[72:75],v[48:51]
s_add_u32 m0,s50,139008
v_mfma_f32_16x16x32_bf16 v[64:67],v[72:75],v[232:235],v[64:67]
buffer_load_dwordx4 v20,s[8:11],s70 offen offset:256 sc1 lds
v_mfma_f32_16x16x32_bf16 v[32:35],a[104:107],v[72:75],v[32:35]
s_add_u32 m0,s50,143104
v_mfma_f32_16x16x32_bf16 v[52:55],a[232:235],v[76:79],v[52:55]
buffer_load_dwordx4 v20,s[8:11],s71 offen offset:256 sc1 lds
v_mfma_f32_16x16x32_bf16 v[68:71],v[76:79],v[232:235],v[68:71]
v_mfma_f32_16x16x32_bf16 v[36:39],a[104:107],v[76:79],v[36:39]
s_waitcnt lgkmcnt(2)
v_mfma_f32_16x16x32_bf16 v[40:43],a[228:231],v[80:83],v[40:43]
ds_read_b128 v[72:75],v11 offset:16384
v_mfma_f32_16x16x32_bf16 v[56:59],v[80:83],v[228:231],v[56:59]
v_mfma_f32_16x16x32_bf16 v[24:27],a[100:103],v[80:83],v[24:27]
ds_read_b128 v[76:79],v11 offset:20480
v_mfma_f32_16x16x32_bf16 v[44:47],a[228:231],v[84:87],v[44:47]
v_mfma_f32_16x16x32_bf16 v[60:63],v[84:87],v[228:231],v[60:63]
v_mfma_f32_16x16x32_bf16 v[28:31],a[100:103],v[84:87],v[28:31]
v_mfma_f32_16x16x32_bf16 v[48:51],a[236:239],v[80:83],v[48:51]
v_mfma_f32_16x16x32_bf16 v[64:67],v[80:83],v[236:239],v[64:67]
v_mfma_f32_16x16x32_bf16 v[32:35],a[108:111],v[80:83],v[32:35]
v_mfma_f32_16x16x32_bf16 v[52:55],a[236:239],v[84:87],v[52:55]
v_mfma_f32_16x16x32_bf16 v[68:71],v[84:87],v[236:239],v[68:71]
v_mfma_f32_16x16x32_bf16 v[36:39],a[108:111],v[84:87],v[36:39]
s_waitcnt lgkmcnt(2)
v_mfma_f32_16x16x32_bf16 v[40:43],a[240:243],v[108:111],v[40:43]
v_mfma_f32_16x16x32_bf16 v[56:59],v[108:111],v[240:243],v[56:59]
v_mfma_f32_16x16x32_bf16 v[24:27],a[112:115],v[108:111],v[24:27]
v_mfma_f32_16x16x32_bf16 v[44:47],a[240:243],v[112:115],v[44:47]
v_mfma_f32_16x16x32_bf16 v[60:63],v[112:115],v[240:243],v[60:63]
v_mfma_f32_16x16x32_bf16 v[28:31],a[112:115],v[112:115],v[28:31]
v_mfma_f32_16x16x32_bf16 v[48:51],a[248:251],v[108:111],v[48:51]
v_mfma_f32_16x16x32_bf16 v[64:67],v[108:111],v[248:251],v[64:67]
v_mfma_f32_16x16x32_bf16 v[32:35],a[120:123],v[108:111],v[32:35]
v_mfma_f32_16x16x32_bf16 v[52:55],a[248:251],v[112:115],v[52:55]
v_mfma_f32_16x16x32_bf16 v[68:71],v[112:115],v[248:251],v[68:71]
v_mfma_f32_16x16x32_bf16 v[36:39],a[120:123],v[112:115],v[36:39]
s_waitcnt lgkmcnt(0)
v_mfma_f32_16x16x32_bf16 v[40:43],a[244:247],v[72:75],v[40:43]
v_mfma_f32_16x16x32_bf16 v[56:59],v[72:75],v[244:247],v[56:59]
v_mfma_f32_16x16x32_bf16 v[24:27],a[116:119],v[72:75],v[24:27]
v_mfma_f32_16x16x32_bf16 v[44:47],a[244:247],v[76:79],v[44:47]
v_mfma_f32_16x16x32_bf16 v[60:63],v[76:79],v[244:247],v[60:63]
v_mfma_f32_16x16x32_bf16 v[28:31],a[116:119],v[76:79],v[28:31]
v_mfma_f32_16x16x32_bf16 v[48:51],a[252:255],v[72:75],v[48:51]
v_mfma_f32_16x16x32_bf16 v[64:67],v[72:75],v[252:255],v[64:67]
v_mfma_f32_16x16x32_bf16 v[32:35],a[124:127],v[72:75],v[32:35]
v_mfma_f32_16x16x32_bf16 v[52:55],a[252:255],v[76:79],v[52:55]
v_mfma_f32_16x16x32_bf16 v[68:71],v[76:79],v[252:255],v[68:71]
v_mfma_f32_16x16x32_bf16 v[36:39],a[124:127],v[76:79],v[36:39]
s_lshl_b32 s56,s51,5
s_add_u32 s56,s56,s47
s_lshl_b32 s56,s56,12
s_add_u32 s56,s56,s50
s_add_u32 s56,s56,41943040
v_mov_b64 v[120:121],-1
v_mov_b64 v[122:123],-1
buffer_store_dwordx4 v[120:123],v0,s[8:11],s56 offen sc1
v_cvt_pk_bf16_f32 v72,v40,v48
v_cvt_pk_bf16_f32 v73,v41,v49
v_cvt_pk_bf16_f32 v74,v42,v50
v_cvt_pk_bf16_f32 v75,v43,v51
buffer_store_dwordx4 v[72:75],v0,s[8:11],s61 offen sc1
v_cvt_pk_bf16_f32 v76,v44,v52
v_cvt_pk_bf16_f32 v77,v45,v53
v_cvt_pk_bf16_f32 v78,v46,v54
v_cvt_pk_bf16_f32 v79,v47,v55
buffer_store_dwordx4 v[76:79],v0,s[8:11],s62 offen sc1
v_cvt_pk_bf16_f32 v80,v56,v57
v_cvt_pk_bf16_f32 v81,v58,v59
v_cvt_pk_bf16_f32 v82,v60,v61
v_cvt_pk_bf16_f32 v83,v62,v63
buffer_store_dwordx4 v[80:83],v0,s[8:11],s65 offen offset:0 sc1
v_cvt_pk_bf16_f32 v84,v64,v65
v_cvt_pk_bf16_f32 v85,v66,v67
v_cvt_pk_bf16_f32 v86,v68,v69
v_cvt_pk_bf16_f32 v87,v70,v71
buffer_store_dwordx4 v[84:87],v0,s[8:11],s65 offen offset:1024 sc1
v_cvt_pk_bf16_f32 v108,v24,v32
v_cvt_pk_bf16_f32 v109,v25,v33
v_cvt_pk_bf16_f32 v110,v26,v34
v_cvt_pk_bf16_f32 v111,v27,v35
buffer_store_dwordx4 v[108:111],v0,s[8:11],s63 offen sc1
v_cvt_pk_bf16_f32 v112,v28,v36
v_cvt_pk_bf16_f32 v113,v29,v37
v_cvt_pk_bf16_f32 v114,v30,v38
v_cvt_pk_bf16_f32 v115,v31,v39
buffer_store_dwordx4 v[112:115],v0,s[8:11],s64 offen sc1
s_lshl_b32 s72,s51,13
s_lshl2_add_u32 s72,s47,s72
s_add_u32 s72,s72,10485760
s_add_u32 s51,s51,1
s_sub_u32 s53,s53,1
s_cmp_gt_u32 s53,0
s_cbranch_scc1 L_chl_155
s_waitcnt vmcnt(0)
s_barrier
s_or_b32 s72,s72,s52
buffer_store_dword v17,off,s[8:11],s72 sc1
L_chd_154:
s_cmp_lg_u32 s3,0
s_cbranch_scc1 L_wc
s_cmp_eq_u32 s48,1
s_cbranch_scc1 L_rc1_156
s_cmp_eq_u32 s48,2
s_cbranch_scc1 L_rc2_157
v_and_b32 v120,15,v1
v_lshrrev_b32 v121,4,v1
v_and_b32 v122,2,v1
v_cmp_eq_u32 vcc,0,v122
v_mov_b32 v2,0xeeee
v_mov_b32 v123,0x4444
v_cndmask_b32 v2,v2,v123,vcc
v_and_b32 v122,1,v1
v_cmp_eq_u32 vcc,0,v122
v_mov_b32 v3,0xdddd
v_mov_b32 v123,0x8888
v_cndmask_b32 v3,v3,v123,vcc
v_lshrrev_b32 v122,1,v120
v_bfe_u32 v123,v120,2,1
v_xor_b32 v123,v123,v122
v_lshlrev_b32 v4,7,v123
v_and_b32 v123,1,v120
v_lshl_add_u32 v4,v123,6,v4
v_xor_b32 v123,v121,v122
v_and_b32 v123,3,v123
v_lshl_add_u32 v4,v123,4,v4
s_lshl_b32 s56,s46,10
s_add_u32 s56,s56,147456
v_add_u32 v4,s56,v4
v_lshlrev_b32 v122,1,v121
v_add_u32 v122,0,v122
v_and_b32 v123,1,v121
v_xor_b32 v123,v123,v122
v_lshlrev_b32 v5,7,v123
v_bfe_u32 v123,v120,3,1
v_lshl_add_u32 v5,v123,6,v5
v_xor_b32 v123,v120,v122
v_and_b32 v123,3,v123
v_lshl_add_u32 v5,v123,4,v5
v_bfe_u32 v123,v120,2,1
v_lshl_add_u32 v5,v123,3,v5
v_add_u32 v5,147456,v5
v_lshlrev_b32 v122,1,v121
v_add_u32 v122,1,v122
v_and_b32 v123,1,v121
v_xor_b32 v123,v123,v122
v_lshlrev_b32 v6,7,v123
v_bfe_u32 v123,v120,3,1
v_lshl_add_u32 v6,v123,6,v6
v_xor_b32 v123,v120,v122
v_and_b32 v123,3,v123
v_lshl_add_u32 v6,v123,4,v6
v_bfe_u32 v123,v120,2,1
v_lshl_add_u32 v6,v123,3,v6
v_add_u32 v6,147456,v6
v_lshlrev_b32 v7,7,v121
v_lshrrev_b32 v122,1,v120
v_lshl_add_u32 v8,v122,4,v7
v_add_u32 v8,151552,v8
v_lshrrev_b32 v122,2,v120
v_lshl_add_u32 v7,v122,5,v7
v_and_b32 v122,1,v120
v_lshl_add_u32 v7,v122,4,v7
v_and_b32 v122,2,v120
v_cmp_eq_u32 vcc,0,v122
s_lshl_b32 s56,s46,9
v_mov_b32 v122,2048
v_mov_b32 v123,s56
v_cndmask_b32 v122,v122,v123,vcc
v_add_u32 v7,v122,v7
v_add_u32 v7,151552,v7
v_lshrrev_b32 v122,3,v1
v_lshlrev_b32 v9,11,v122
v_and_b32 v122,7,v1
v_lshl_add_u32 v9,v122,3,v9
s_lshl_b32 s56,s46,14
s_lshl_b32 s57,s47,6
s_add_u32 s56,s56,s57
v_add_u32 v9,s56,v9
s_lshl_b32 s71,s46,5
s_add_u32 s71,s71,s47
s_bfe_u32 s56,s71,0x10003
s_lshl_b32 s56,s56,11
s_and_b32 s57,s71,1
s_lshl_b32 s57,s57,10
s_add_u32 s56,s56,s57
s_bfe_u32 s57,s71,0x10002
s_lshl_b32 s57,s57,9
s_add_u32 s56,s56,s57
s_bfe_u32 s57,s71,0x10001
s_lshl_b32 s57,s57,6
s_add_u32 s56,s56,s57
s_bfe_u32 s57,s71,0x10004
s_lshl_b32 s57,s57,8
s_add_u32 s56,s56,s57
s_bfe_u32 s57,s71,0x10005
s_lshl_b32 s57,s57,7
s_add_u32 s56,s56,s57
s_bfe_u32 s57,s71,0x10006
s_lshl_b32 s57,s57,12
s_add_u32 s56,s56,s57
v_and_b32 v122,3,v120
v_lshlrev_b32 v10,2,v122
v_bfe_u32 v122,v120,3,1
v_lshl_add_u32 v10,v122,4,v10
v_and_b32 v122,1,v121
v_lshl_add_u32 v10,v122,5,v10
v_add_u32 v10,s56,v10
v_and_b32 v123,36,v1
v_mov_b32 v122,0x80000000
v_cmp_eq_u32 vcc,0,v123
s_nop 1
v_cndmask_b32 v10,v122,v10,vcc
s_lshl_b32 s71,s71,11
s_lshl_b32 s73,s46,11
s_mov_b32 s72,0xffc00000
s_mov_b32 s74,0
v_and_b32 v11,1,v121
v_xor_b32 v11,v11,v120
v_and_b32 v11,3,v11
v_lshrrev_b32 v122,2,v120
v_lshl_add_u32 v11,v11,2,v122
v_lshl_add_u32 v11,v121,4,v11
v_lshlrev_b32 v11,4,v11
s_lshl_b32 s56,s46,15
v_add_u32 v11,s56,v11
v_lshrrev_b32 v13,3,v1
v_lshlrev_b32 v13,9,v13
v_and_b32 v122,7,v1
v_lshl_add_u32 v13,v122,4,v13
v_and_b32 v122,15,v1
v_and_b32 v123,1,v1
v_lshlrev_b32 v123,4,v123
v_mov_b32 v124,0x3f80
v_lshlrev_b32 v124,v123,v124
v_lshrrev_b32 v122,1,v122
v_cmp_eq_u32 vcc,0,v122
s_nop 1
v_cndmask_b32 v18,0,v124,vcc
v_cmp_eq_u32 vcc,1,v122
s_nop 1
v_cndmask_b32 v19,0,v124,vcc
v_cmp_eq_u32 vcc,2,v122
s_nop 1
v_cndmask_b32 v20,0,v124,vcc
v_cmp_eq_u32 vcc,3,v122
s_nop 1
v_cndmask_b32 v21,0,v124,vcc
s_and_b32 s56,s46,1
s_lshl_b32 s56,s56,8
s_and_b32 s57,s46,2
s_lshl_b32 s57,s57,6
s_add_u32 s56,s56,s57
v_add_u32 v13,s56,v13
s_add_u32 s56,s50,155648
v_add_u32 v12,s56,v0
v_mov_b64 v[14:15],s[28:29]
v_mov_b64 v[16:17],s[28:29]
v_add_u32 v22,11550720,v10
s_lshl_b32 s18,s47,2
s_add_u32 s18,s18,10493952
v_mov_b32 v1,s80
s_mov_b32 s65,14680064
s_add_u32 s66,s71,14680064
s_add_u32 s69,s71,14942208
s_mov_b32 s30,0x40000000
s_mov_b32 s51,0
buffer_load_dwordx4 v[88:91],v0,s[8:11],s66 offen offset:0
buffer_load_dwordx4 v[88:91],v0,s[8:11],s66 offen offset:1024
buffer_load_dwordx4 v[88:91],v0,s[8:11],s69 offen offset:0
buffer_load_dwordx4 v[88:91],v0,s[8:11],s69 offen offset:1024
L_cst_161:
s_cmp_lg_u32 s46,0
s_cbranch_scc1 L_csw_166
s_lshl_b32 s59,s51,13
s_lshl2_add_u32 s59,s47,s59
s_add_u32 s59,s59,10485760
s_buffer_load_dword s61,s[8:11],s59
s_waitcnt lgkmcnt(0)
s_cmp_lg_u32 s61,0
s_cbranch_scc1 L_wwd_168
L_ww_167:
s_sleep 1
buffer_load_dword v122,off,s[8:11],s59 sc1
s_sub_u32 s49,s49,1
s_cbranch_scc1 L_abort
s_waitcnt vmcnt(0)
v_readfirstlane_b32 s61,v122
s_cmp_eq_u32 s61,0
s_cbranch_scc1 L_ww_167
L_wwd_168:
L_csw_166:
s_waitcnt lgkmcnt(0)
s_barrier
s_lshl_b32 s56,s51,5
s_add_u32 s56,s56,s47
s_mul_i32 s56,s56,24576
s_add_u32 s56,s56,100663296
s_add_u32 s67,s56,s73
s_add_u32 m0,s73,131072
s_add_u32 s57,s67,8192
buffer_load_dwordx4 v0,s[8:11],s67 offen sc1 lds
buffer_load_dwordx4 v0,s[8:11],s67 offen offset:1024 sc1 lds
s_add_u32 m0,s73,139264
s_add_u32 s67,s67,786432
buffer_load_dwordx4 v0,s[8:11],s57 offen sc1 lds
buffer_load_dwordx4 v0,s[8:11],s57 offen offset:1024 sc1 lds
s_lshl_b32 s75,s51,13
s_add_u32 s56,s75,11542528
buffer_load_dword v23,v10,s[8:11],s56 offen sc1
s_add_u32 s64,s75,11534336
s_add_u32 s70,s64,4096
s_lshl_b32 s68,s51,5
s_add_u32 s68,s68,s47
s_lshl_b32 s68,s68,12
s_lshl_b32 s56,s46,10
s_add_u32 s68,s68,s56
s_add_u32 s68,s68,41943040
s_mov_b32 s54,0x80000000
s_mov_b32 s77,0
s_add_u32 s56,s18,s75
s_buffer_load_dword s19,s[8:11],s56
s_cmp_eq_u32 s51,63
s_cselect_b32 s76,1,s46
s_cmp_eq_u32 s76,0
s_cselect_b32 s76,1,0
v_mov_b64 v[96:97],0
v_mov_b64 v[98:99],0
v_mov_b64 v[100:101],0
v_mov_b64 v[102:103],0
v_mov_b64 v[104:105],0
v_mov_b64 v[106:107],0
v_mov_b64 v[108:109],0
v_mov_b64 v[110:111],0
v_mov_b64 v[112:113],0
v_mov_b64 v[114:115],0
v_mov_b64 v[116:117],0
v_mov_b64 v[118:119],0
buffer_load_dwordx4 v[88:91],v13,s[8:11],s64 offen
buffer_load_dwordx4 v[88:91],v13,s[8:11],s70 offen
s_waitcnt vmcnt(19)
v_swap_b32 v25,v28
v_swap_b32 v26,v32
v_swap_b32 v27,v36
v_swap_b32 v30,v33
v_swap_b32 v31,v37
v_swap_b32 v35,v38
ds_write_b128 v93,v[24:27] offset:4096
ds_write_b128 v94,v[28:31] offset:4096
ds_write_b128 v93,v[32:35] offset:4224
ds_write_b128 v94,v[36:39] offset:4224
s_waitcnt vmcnt(15)
v_swap_b32 v41,v44
v_swap_b32 v42,v48
v_swap_b32 v43,v52
v_swap_b32 v46,v49
v_swap_b32 v47,v53
v_swap_b32 v51,v54
ds_write_b128 v93,v[40:43] offset:5120
ds_write_b128 v94,v[44:47] offset:5120
ds_write_b128 v93,v[48:51] offset:5248
ds_write_b128 v94,v[52:55] offset:5248
s_waitcnt vmcnt(11)
v_swap_b32 v57,v60
v_swap_b32 v58,v64
v_swap_b32 v59,v68
v_swap_b32 v62,v65
v_swap_b32 v63,v69
v_swap_b32 v67,v70
ds_write_b128 v93,v[56:59] offset:6144
ds_write_b128 v94,v[60:63] offset:6144
ds_write_b128 v93,v[64:67] offset:6272
ds_write_b128 v94,v[68:71] offset:6272
s_waitcnt vmcnt(7)
v_swap_b32 v73,v76
v_swap_b32 v74,v80
v_swap_b32 v75,v84
v_swap_b32 v78,v81
v_swap_b32 v79,v85
v_swap_b32 v83,v86
ds_write_b128 v93,v[72:75] offset:7168
ds_write_b128 v94,v[76:79] offset:7168
ds_write_b128 v93,v[80:83] offset:7296
ds_write_b128 v94,v[84:87] offset:7296
s_waitcnt vmcnt(0) lgkmcnt(0)
s_barrier
v_add_u32 v55,131072,v0
ds_read_b128 v[56:59],v55 offset:0
ds_read_b128 v[60:63],v55 offset:4096
ds_read_b128 v[64:67],v55 offset:1024
ds_read_b128 v[68:71],v55 offset:5120
ds_read_b128 v[72:75],v55 offset:2048
ds_read_b128 v[76:79],v55 offset:6144
ds_read_b128 v[80:83],v55 offset:3072
ds_read_b128 v[84:87],v55 offset:7168
v_add_u32 v123,s73,v55
ds_read_b128 v[88:91],v123 offset:8192
ds_read_b128 v[92:95],v123 offset:9216
v_xor_b32 v120,1024,v12
v_xor_b32 v121,2048,v12
v_xor_b32 v122,3072,v12
buffer_load_dwordx4 v[24:27],v13,s[8:11],s64 offen sc1
buffer_load_dwordx4 v[24:27],v13,s[8:11],s64 offen sc1
.p2align 6
L_chain_169:
L_cpa_170:
buffer_load_dwordx4 v[24:27],v13,s[8:11],s64 offen sc1
s_sub_u32 s49,s49,1
s_cbranch_scc1 L_abort
s_waitcnt vmcnt(2)
v_max3_u32 v123,v24,v25,v26
v_max_u32 v123,v27,v123
v_cmp_le_u32 vcc,s72,v123
ds_write_b128 v12,v[24:27] offset:0
s_cbranch_vccnz L_cpa_170
L_cgo_173:
v_smfmac_f32_16x16x64_bf16 v[96:99],v[24:27],a[0:7],v2
buffer_load_dwordx4 v[40:43],v13,s[8:11],s70 offen sc1
s_waitcnt lgkmcnt(0)
s_barrier
ds_read_b128 v[28:31],v120 offset:0
v_smfmac_f32_16x16x64_bf16 v[100:103],v[24:27],a[128:135],v2
ds_read_b128 v[32:35],v121 offset:0
v_smfmac_f32_16x16x64_bf16 v[104:107],v[24:27],a[8:15],v2
ds_read_b128 v[36:39],v122 offset:0
v_smfmac_f32_16x16x64_bf16 v[108:111],v[24:27],a[136:143],v2
v_smfmac_f32_16x16x64_bf16 v[112:115],v[24:27],v[128:135],v2
v_smfmac_f32_16x16x64_bf16 v[116:119],v[24:27],v[136:143],v2
s_waitcnt lgkmcnt(2)
v_smfmac_f32_16x16x64_bf16 v[96:99],v[28:31],a[16:23],v2
s_add_u32 m0,s73,131072
v_smfmac_f32_16x16x64_bf16 v[100:103],v[28:31],a[144:151],v2
s_add_u32 s57,s67,8192
v_smfmac_f32_16x16x64_bf16 v[104:107],v[28:31],a[24:31],v2
s_cmp_lt_u32 s19,s76
s_cbranch_scc1 L_ckw_162
L_ckb_163:
v_smfmac_f32_16x16x64_bf16 v[108:111],v[28:31],a[152:159],v2
s_waitcnt vmcnt(0) lgkmcnt(1)
v_smfmac_f32_16x16x64_bf16 v[96:99],v[32:35],a[32:39],v2
ds_write_b128 v12,v[40:43] offset:4096
v_max3_u32 v123,v40,v41,v42
v_smfmac_f32_16x16x64_bf16 v[100:103],v[32:35],a[160:167],v2
v_max_u32 v123,v43,v123
v_smfmac_f32_16x16x64_bf16 v[104:107],v[32:35],a[40:47],v2
v_cmp_le_u32 vcc,s72,v123
v_smfmac_f32_16x16x64_bf16 v[108:111],v[32:35],a[168:175],v2
v_smfmac_f32_16x16x64_bf16 v[112:115],v[28:31],v[144:151],v2
s_cbranch_vccnz L_cpb_176
L_cback_178:
s_waitcnt lgkmcnt(0)
s_barrier
v_smfmac_f32_16x16x64_bf16 v[96:99],v[36:39],a[48:55],v2
buffer_load_dword v23,v22,s[8:11],s75 offen sc1
v_smfmac_f32_16x16x64_bf16 v[100:103],v[36:39],a[176:183],v2
ds_read_b128 v[44:47],v120 offset:4096
v_smfmac_f32_16x16x64_bf16 v[104:107],v[36:39],a[56:63],v2
buffer_load_dwordx4 v0,s[8:11],s67 offen sc1 lds
v_smfmac_f32_16x16x64_bf16 v[108:111],v[36:39],a[184:191],v2
ds_read_b128 v[48:51],v121 offset:4096
v_smfmac_f32_16x16x64_bf16 v[96:99],v[40:43],a[64:71],v2
buffer_store_dwordx4 v[124:127],v0,s[8:11],s54 offen sc1
v_smfmac_f32_16x16x64_bf16 v[100:103],v[40:43],a[192:199],v2
ds_read_b128 v[52:55],v122 offset:4096
v_smfmac_f32_16x16x64_bf16 v[104:107],v[40:43],a[72:79],v2
buffer_load_dwordx4 v0,s[8:11],s67 offen offset:1024 sc1 lds
s_add_u32 m0,s73,139264
v_smfmac_f32_16x16x64_bf16 v[108:111],v[40:43],a[200:207],v2
s_waitcnt lgkmcnt(2)
v_smfmac_f32_16x16x64_bf16 v[96:99],v[44:47],a[80:87],v2
buffer_load_dwordx4 v0,s[8:11],s57 offen sc1 lds
s_add_u32 s67,s67,786432
v_smfmac_f32_16x16x64_bf16 v[100:103],v[44:47],a[208:215],v2
s_waitcnt lgkmcnt(1)
v_smfmac_f32_16x16x64_bf16 v[96:99],v[48:51],a[96:103],v2
buffer_load_dwordx4 v0,s[8:11],s57 offen offset:1024 sc1 lds
v_smfmac_f32_16x16x64_bf16 v[100:103],v[48:51],a[224:231],v2
s_waitcnt lgkmcnt(0)
v_smfmac_f32_16x16x64_bf16 v[96:99],v[52:55],a[112:119],v2
v_smfmac_f32_16x16x64_bf16 v[100:103],v[52:55],a[240:247],v2
v_smfmac_f32_16x16x64_bf16 v[104:107],v[44:47],a[88:95],v2
v_smfmac_f32_16x16x64_bf16 v[108:111],v[44:47],a[216:223],v2
v_smfmac_f32_16x16x64_bf16 v[104:107],v[48:51],a[104:111],v2
v_add_f32 v96,v96,v98
v_smfmac_f32_16x16x64_bf16 v[108:111],v[48:51],a[232:239],v2
v_add_f32 v97,v97,v99
v_smfmac_f32_16x16x64_bf16 v[104:107],v[52:55],a[120:127],v2
v_cvt_pk_bf16_f32 v120,v96,v97
v_smfmac_f32_16x16x64_bf16 v[108:111],v[52:55],a[248:255],v2
v_add_f32 v100,v100,v102
v_smfmac_f32_16x16x64_bf16 v[116:119],v[28:31],v[152:159],v2
v_add_f32 v101,v101,v103
v_smfmac_f32_16x16x64_bf16 v[112:115],v[32:35],v[160:167],v2
v_cvt_pk_bf16_f32 v121,v100,v101
v_add_f32 v104,v104,v106
v_add_f32 v105,v105,v107
v_cvt_pk_bf16_f32 v122,v104,v105
v_add_f32 v108,v108,v110
v_add_f32 v109,v109,v111
v_cvt_pk_bf16_f32 v123,v108,v109
ds_write_b128 v4,v[120:123]
v_smfmac_f32_16x16x64_bf16 v[116:119],v[32:35],v[168:175],v2
s_mov_b32 s54,s68
s_add_u32 s68,s68,131072
v_mov_b32 v125,0
v_smfmac_f32_16x16x64_bf16 v[112:115],v[36:39],v[176:183],v2
s_cmp_eq_u32 s51,63
s_cbranch_scc1 L_cend_172
v_smfmac_f32_16x16x64_bf16 v[116:119],v[36:39],v[184:191],v2
s_waitcnt lgkmcnt(0)
s_barrier
ds_read_b64_tr_b16 v[96:97],v5 offset:0
v_smfmac_f32_16x16x64_bf16 v[112:115],v[40:43],v[192:199],v2
ds_read_b64_tr_b16 v[98:99],v6 offset:0
v_smfmac_f32_16x16x64_bf16 v[116:119],v[40:43],v[200:207],v2
ds_read_b64_tr_b16 v[100:101],v5 offset:1024
v_smfmac_f32_16x16x64_bf16 v[112:115],v[44:47],v[208:215],v2
ds_read_b64_tr_b16 v[102:103],v6 offset:1024
v_smfmac_f32_16x16x64_bf16 v[116:119],v[44:47],v[216:223],v2
ds_read_b64_tr_b16 v[104:105],v5 offset:2048
v_smfmac_f32_16x16x64_bf16 v[112:115],v[48:51],v[224:231],v2
ds_read_b64_tr_b16 v[106:107],v6 offset:2048
s_waitcnt lgkmcnt(4)
v_mfma_f32_16x16x32_bf16 v[24:27],v[56:59],v[96:99],0
ds_read_b64_tr_b16 v[108:109],v5 offset:3072
v_mfma_f32_16x16x32_bf16 v[28:31],v[60:63],v[96:99],0
ds_read_b64_tr_b16 v[110:111],v6 offset:3072
v_mfma_f32_16x16x32_bf16 v[32:35],v[96:99],v[96:99],0
ds_read_b128 v[40:43],v11 offset:12288
s_waitcnt lgkmcnt(5)
v_mfma_f32_16x16x32_bf16 v[24:27],v[64:67],v[100:103],v[24:27]
ds_read_b128 v[56:59],v11 offset:0
v_mfma_f32_16x16x32_bf16 v[28:31],v[68:71],v[100:103],v[28:31]
ds_read_b128 v[60:63],v11 offset:1024
v_mfma_f32_16x16x32_bf16 v[32:35],v[100:103],v[100:103],v[32:35]
ds_read_b128 v[96:99],v11 offset:8192
s_waitcnt lgkmcnt(6)
v_mfma_f32_16x16x32_bf16 v[24:27],v[72:75],v[104:107],v[24:27]
ds_read_b128 v[64:67],v11 offset:2048
v_mfma_f32_16x16x32_bf16 v[28:31],v[76:79],v[104:107],v[28:31]
ds_read_b128 v[68:71],v11 offset:3072
v_mfma_f32_16x16x32_bf16 v[32:35],v[104:107],v[104:107],v[32:35]
ds_read_b128 v[100:103],v11 offset:9216
s_waitcnt lgkmcnt(7)
v_mfma_f32_16x16x32_bf16 v[24:27],v[80:83],v[108:111],v[24:27]
ds_read_b128 v[72:75],v11 offset:4096
v_mfma_f32_16x16x32_bf16 v[28:31],v[84:87],v[108:111],v[28:31]
ds_read_b128 v[76:79],v11 offset:5120
v_mfma_f32_16x16x32_bf16 v[32:35],v[108:111],v[108:111],v[32:35]
ds_read_b128 v[104:107],v11 offset:10240
v_smfmac_f32_16x16x64_bf16 v[116:119],v[48:51],v[232:239],v2
ds_read_b128 v[80:83],v11 offset:6144
v_smfmac_f32_16x16x64_bf16 v[112:115],v[52:55],v[240:247],v2
ds_read_b128 v[84:87],v11 offset:7168
v_smfmac_f32_16x16x64_bf16 v[116:119],v[52:55],v[248:255],v2
ds_read_b128 v[108:111],v11 offset:11264
v_max3_f32 v126,v24,v25,v26
v_max3_f32 v127,v27,v28,v29
v_max3_f32 v126,v30,v31,v126
v_max3_f32 v127,v34,v35,v127
v_max_f32 v126,v126,v127
v_max_f32 v127,v126,v127
v_pk_mul_f32 v[34:35],v[34:35],v[0:1] op_sel:[0,1]
v_pk_mul_f32 v[24:25],v[24:25],v[0:1] op_sel:[0,1]
v_permlane16_swap_b32 v126,v127
v_max_f32 v126,v126,v127
v_max_f32 v127,v126,v127
v_pk_add_f32 v[112:113],v[112:113],v[114:115]
v_pk_add_f32 v[116:117],v[116:117],v[118:119]
v_permlane32_swap_b32 v126,v127
v_max_f32 v126,v126,v127
v_mul_f32 v126,v1,v126
v_pk_add_f32 v[34:35],v[34:35],v[126:127] op_sel_hi:[1,0] neg_lo:[0,1] neg_hi:[0,1]
v_pk_add_f32 v[24:25],v[24:25],v[126:127] op_sel_hi:[1,0] neg_lo:[0,1] neg_hi:[0,1]
v_pk_fma_f32 v[26:27],v[26:27],v[0:1],v[126:127] op_sel:[0,1,0] op_sel_hi:[1,1,0] neg_lo:[0,0,1] neg_hi:[0,0,1]
v_pk_fma_f32 v[28:29],v[28:29],v[0:1],v[126:127] op_sel:[0,1,0] op_sel_hi:[1,1,0] neg_lo:[0,0,1] neg_hi:[0,0,1]
v_pk_fma_f32 v[30:31],v[30:31],v[0:1],v[126:127] op_sel:[0,1,0] op_sel_hi:[1,1,0] neg_lo:[0,0,1] neg_hi:[0,0,1]
v_exp_f32 v34,v34
v_exp_f32 v35,v35
v_cvt_pk_bf16_f32 v126,v112,v113
v_cvt_pk_bf16_f32 v124,v34,v35
v_cvt_pk_bf16_f32 v127,v116,v117
v_cvt_pk_bf16_f32 v36,v116,v117
v_mfma_f32_16x16x16_bf16 v[32:35],v[14:15],v[124:125],0
ds_read_b128 v[44:47],v11 offset:13312
v_exp_f32 v24,v24
v_mfma_f32_16x16x16_bf16 v[112:115],v[126:127],v[124:125],0
ds_read_b128 v[48:51],v11 offset:14336
v_exp_f32 v25,v25
v_mfma_f32_16x16x16_bf16 v[116:119],v[36:37],v[124:125],0
ds_read_b128 v[52:55],v11 offset:15360
v_exp_f32 v26,v26
v_exp_f32 v27,v27
v_cvt_pk_bf16_f32 v120,v24,v25
v_exp_f32 v28,v28
v_exp_f32 v29,v29
v_cvt_pk_bf16_f32 v121,v26,v27
v_exp_f32 v30,v30
v_exp_f32 v31,v31
v_cvt_pk_bf16_f32 v122,v28,v29
v_cvt_pk_bf16_f32 v123,v30,v31
s_add_u32 s75,s75,8192
s_add_u32 s51,s51,1
v_mfma_f32_16x16x32_bf16 v[32:35],v[14:17],v[120:123],v[32:35]
v_mfma_f32_16x16x32_bf16 v[112:115],v[88:91],v[120:123],v[112:115]
ds_read_b128 v[88:91],v11 offset:16384
v_mfma_f32_16x16x32_bf16 v[116:119],v[92:95],v[120:123],v[116:119]
ds_read_b128 v[92:95],v11 offset:17408
v_rcp_f32 v32,v32
v_mov_b64 v[24:25],-1
v_mov_b64 v[26:27],-1
s_add_u32 s64,s75,11534336
s_add_u32 s70,s64,4096
v_pk_mul_f32 v[112:113],v[112:113],v[32:33] op_sel_hi:[1,0]
v_pk_mul_f32 v[114:115],v[114:115],v[32:33] op_sel_hi:[1,0]
v_pk_mul_f32 v[116:117],v[116:117],v[32:33] op_sel_hi:[1,0]
v_pk_mul_f32 v[118:119],v[118:119],v[32:33] op_sel_hi:[1,0]
v_cvt_pk_bf16_f32 v120,v112,v116
v_cvt_pk_bf16_f32 v121,v113,v117
v_cvt_pk_bf16_f32 v122,v114,v118
v_cvt_pk_bf16_f32 v123,v115,v119
ds_write_b128 v7,v[120:123]
buffer_store_dwordx4 v[24:27],v0,s[8:11],s69 offen
buffer_store_dwordx4 v[24:27],v0,s[8:11],s69 offen offset:1024
v_mov_b64 v[112:113],0
v_mov_b64 v[114:115],0
v_mov_b64 v[116:117],0
v_mov_b64 v[118:119],0
s_waitcnt lgkmcnt(0)
s_barrier
ds_read_b128 v[24:27],v8 offset:0
ds_read_b128 v[28:31],v8 offset:512
ds_read_b128 v[32:35],v8 offset:1024
ds_read_b128 v[36:39],v8 offset:1536
v_mov_b64 v[120:121],0
v_mov_b64 v[122:123],0
s_add_u32 s57,s65,65536
s_add_u32 s58,s65,131072
s_add_u32 s59,s65,196608
s_add_u32 s56,s18,s75
s_waitcnt lgkmcnt(3)
v_smfmac_f32_16x16x64_bf16 v[112:115],v[24:27],v[56:63],v3
ds_read_b128 v[56:59],v11 offset:18432
s_waitcnt lgkmcnt(3)
v_smfmac_f32_16x16x64_bf16 v[112:115],v[28:31],v[64:71],v3
ds_read_b128 v[60:63],v11 offset:19456
s_waitcnt lgkmcnt(3)
v_smfmac_f32_16x16x64_bf16 v[112:115],v[32:35],v[72:79],v3
ds_read_b128 v[64:67],v11 offset:20480
s_waitcnt lgkmcnt(3)
v_smfmac_f32_16x16x64_bf16 v[112:115],v[36:39],v[80:87],v3
ds_read_b128 v[68:71],v11 offset:21504
v_smfmac_f32_16x16x64_bf16 v[116:119],v[24:27],v[96:103],v3
ds_read_b128 v[72:75],v11 offset:22528
v_smfmac_f32_16x16x64_bf16 v[116:119],v[28:31],v[104:111],v3
ds_read_b128 v[76:79],v11 offset:23552
v_cvt_pk_bf16_f32 v112,v112,v113
v_smfmac_f32_16x16x64_bf16 v[116:119],v[32:35],v[40:47],v3
ds_read_b128 v[80:83],v11 offset:24576
v_cvt_pk_bf16_f32 v113,v114,v115
buffer_store_dwordx2 v[112:113],v9,s[8:11],s65 offen
v_smfmac_f32_16x16x64_bf16 v[116:119],v[36:39],v[48:55],v3
ds_read_b128 v[84:87],v11 offset:25600
v_mov_b64 v[112:113],0
v_smfmac_f32_16x16x64_bf16 v[120:123],v[24:27],v[88:95],v3
ds_read_b128 v[96:99],v11 offset:26624
ds_read_b128 v[100:103],v11 offset:27648
v_mov_b64 v[114:115],0
s_waitcnt lgkmcnt(8)
v_smfmac_f32_16x16x64_bf16 v[120:123],v[28:31],v[56:63],v3
ds_read_b128 v[104:107],v11 offset:28672
v_cvt_pk_bf16_f32 v116,v116,v117
s_waitcnt lgkmcnt(7)
v_smfmac_f32_16x16x64_bf16 v[120:123],v[32:35],v[64:71],v3
ds_read_b128 v[108:111],v11 offset:29696
ds_read_b128 v[40:43],v11 offset:30720
v_cvt_pk_bf16_f32 v117,v118,v119
buffer_store_dwordx2 v[116:117],v9,s[8:11],s57 offen
s_waitcnt lgkmcnt(7)
v_smfmac_f32_16x16x64_bf16 v[120:123],v[36:39],v[72:79],v3
ds_read_b128 v[44:47],v11 offset:31744
v_add_u32 v52,s50,v5
s_waitcnt lgkmcnt(6)
v_smfmac_f32_16x16x64_bf16 v[112:115],v[24:27],v[80:87],v3
v_add_u32 v54,s50,v6
s_waitcnt lgkmcnt(4)
v_smfmac_f32_16x16x64_bf16 v[112:115],v[28:31],v[96:103],v3
ds_read_b64_tr_b16 v[52:53],v52
v_cvt_pk_bf16_f32 v120,v120,v121
s_waitcnt lgkmcnt(3)
v_smfmac_f32_16x16x64_bf16 v[112:115],v[32:35],v[104:111],v3
ds_read_b64_tr_b16 v[54:55],v54
v_cvt_pk_bf16_f32 v121,v122,v123
buffer_store_dwordx2 v[120:121],v9,s[8:11],s58 offen
s_waitcnt lgkmcnt(2)
v_smfmac_f32_16x16x64_bf16 v[112:115],v[36:39],v[40:47],v3
v_mov_b64 v[116:117],0
v_mov_b64 v[118:119],0
s_xor_b32 s65,s65,262144
v_mov_b32_dpp v124,v126 quad_perm:[2,3,2,3] row_mask:0xf bank_mask:0xf
v_mov_b32_dpp v125,v127 quad_perm:[2,3,2,3] row_mask:0xf bank_mask:0xf
s_mov_b32 vcc_lo,0xcccccccc
s_mov_b32 vcc_hi,0xcccccccc
s_nop 0
v_cvt_pk_bf16_f32 v112,v112,v113
v_cvt_pk_bf16_f32 v113,v114,v115
buffer_store_dwordx2 v[112:113],v9,s[8:11],s59 offen
s_waitcnt lgkmcnt(0)
s_buffer_load_dword s19,s[8:11],s56
v_cndmask_b32 v124,v124,v52,vcc
v_cndmask_b32 v125,v125,v53,vcc
s_cmp_lt_u32 s46,2
s_waitcnt vmcnt(3)
s_cbranch_scc1 L_crg_179
s_cmp_eq_u32 s46,2
s_waitcnt vmcnt(1)
s_cbranch_scc1 L_crg_179
s_waitcnt vmcnt(0)
L_crg_179:
buffer_load_dwordx4 v[32:35],v0,s[8:11],s66 offen offset:0 sc1
buffer_load_dwordx4 v[36:39],v0,s[8:11],s66 offen offset:1024 sc1
v_cndmask_b32 v126,v126,v54,vcc
v_cndmask_b32 v127,v127,v55,vcc
v_mov_b64 v[96:97],0
v_mov_b64 v[98:99],0
v_mov_b64 v[100:101],0
v_mov_b64 v[102:103],0
v_mov_b64 v[104:105],0
v_mov_b64 v[106:107],0
v_mov_b64 v[108:109],0
v_mov_b64 v[110:111],0
v_mov_b64 v[112:113],0
v_mov_b64 v[114:115],0
v_add_u32 v55,131072,v0
v_add_u32 v123,s73,v55
v_xor_b32 v120,1024,v12
v_xor_b32 v121,2048,v12
v_xor_b32 v122,3072,v12
buffer_load_dwordx4 v[44:47],v0,s[8:11],s66 offen offset:0 sc1
buffer_load_dwordx4 v[48:51],v0,s[8:11],s66 offen offset:1024 sc1
s_cmp_ge_u32 s51,63
s_cselect_b32 s76,0,1
s_cmp_eq_u32 s46,0
s_cselect_b32 s76,s76,0
s_waitcnt vmcnt(3)
v_mfma_f32_16x16x32_bf16 v[28:31],v[18:21],v[32:35],0
s_waitcnt vmcnt(2)
v_mfma_f32_16x16x32_bf16 v[28:31],v[18:21],v[36:39],v[28:31]
s_nop 7
v_cmp_u_f32 vcc,v28,v28
v_add_f32_dpp v52,v28,v28 row_ror:8 row_mask:0xf bank_mask:0x3
v_add_f32_dpp v53,v29,v29 row_ror:8 row_mask:0xf bank_mask:0x3
v_add_f32_dpp v52,v30,v30 row_ror:8 row_mask:0xf bank_mask:0xc
v_add_f32_dpp v53,v31,v31 row_ror:8 row_mask:0xf bank_mask:0xc
s_cbranch_vccnz L_crp_174
L_cok_180:
v_add_f32_dpp v52,v52,v52 row_shl:4 row_mask:0xf bank_mask:0x5
v_add_f32_dpp v53,v53,v53 row_shl:4 row_mask:0xf bank_mask:0x5
v_cvt_pk_bf16_f32 v54,v52,v53
buffer_store_dword v54,v10,s[8:11],s64 offen
s_mov_b32 s69,s66
s_xor_b32 s66,s66,262144
s_barrier
ds_read_b128 v[56:59],v55 offset:0
ds_read_b128 v[60:63],v55 offset:4096
ds_read_b128 v[64:67],v55 offset:1024
buffer_load_dwordx4 v[24:27],v13,s[8:11],s64 offen sc1
ds_read_b128 v[68:71],v55 offset:5120
ds_read_b128 v[72:75],v55 offset:2048
ds_read_b128 v[76:79],v55 offset:6144
ds_read_b128 v[80:83],v55 offset:3072
buffer_load_dwordx4 v[24:27],v13,s[8:11],s64 offen sc1
ds_read_b128 v[84:87],v55 offset:7168
ds_read_b128 v[88:91],v123 offset:8192
ds_read_b128 v[92:95],v123 offset:9216
s_branch L_chain_169
L_cpb_176:
buffer_load_dwordx4 v[40:43],v13,s[8:11],s70 offen sc1
s_sub_u32 s49,s49,1
s_cbranch_scc1 L_abort
s_waitcnt vmcnt(0)
v_max3_u32 v123,v40,v41,v42
v_max_u32 v123,v43,v123
v_cmp_le_u32 vcc,s72,v123
s_cbranch_vccnz L_cpb_176
ds_write_b128 v12,v[40:43] offset:4096
s_branch L_cback_178
L_crp_174:
buffer_load_dwordx4 v[32:35],v0,s[8:11],s66 offen offset:0 sc1
buffer_load_dwordx4 v[36:39],v0,s[8:11],s66 offen offset:1024 sc1
s_sub_u32 s49,s49,1
s_cbranch_scc1 L_abort
s_waitcnt vmcnt(3)
v_mfma_f32_16x16x32_bf16 v[28:31],v[18:21],v[44:47],0
s_waitcnt vmcnt(2)
v_mfma_f32_16x16x32_bf16 v[28:31],v[18:21],v[48:51],v[28:31]
s_nop 7
v_cmp_u_f32 vcc,v28,v28
v_add_f32_dpp v52,v28,v28 row_ror:8 row_mask:0xf bank_mask:0x3
v_add_f32_dpp v53,v29,v29 row_ror:8 row_mask:0xf bank_mask:0x3
v_add_f32_dpp v52,v30,v30 row_ror:8 row_mask:0xf bank_mask:0xc
v_add_f32_dpp v53,v31,v31 row_ror:8 row_mask:0xf bank_mask:0xc
s_cbranch_vccz L_cok_180
buffer_load_dwordx4 v[44:47],v0,s[8:11],s66 offen offset:0 sc1
buffer_load_dwordx4 v[48:51],v0,s[8:11],s66 offen offset:1024 sc1
s_sub_u32 s49,s49,1
s_cbranch_scc1 L_abort
s_waitcnt vmcnt(3)
v_mfma_f32_16x16x32_bf16 v[28:31],v[18:21],v[32:35],0
s_waitcnt vmcnt(2)
v_mfma_f32_16x16x32_bf16 v[28:31],v[18:21],v[36:39],v[28:31]
s_nop 7
v_cmp_u_f32 vcc,v28,v28
v_add_f32_dpp v52,v28,v28 row_ror:8 row_mask:0xf bank_mask:0x3
v_add_f32_dpp v53,v29,v29 row_ror:8 row_mask:0xf bank_mask:0x3
v_add_f32_dpp v52,v30,v30 row_ror:8 row_mask:0xf bank_mask:0xc
v_add_f32_dpp v53,v31,v31 row_ror:8 row_mask:0xf bank_mask:0xc
s_cbranch_vccz L_cok_180
s_branch L_crp_174
L_ckw_162:
s_add_u32 s59,s18,s75
L_ww_181:
s_sleep 1
buffer_load_dword v23,off,s[8:11],s59 sc1
s_sub_u32 s49,s49,1
s_cbranch_scc1 L_abort
s_waitcnt vmcnt(0)
v_readfirstlane_b32 s76,v23
s_cmp_eq_u32 s76,0
s_cbranch_scc1 L_ww_181
L_wwd_182:
s_branch L_ckb_163
L_cend_172:
v_smfmac_f32_16x16x64_bf16 v[116:119],v[36:39],v[184:191],v2
v_smfmac_f32_16x16x64_bf16 v[112:115],v[40:43],v[192:199],v2
v_smfmac_f32_16x16x64_bf16 v[116:119],v[40:43],v[200:207],v2
v_smfmac_f32_16x16x64_bf16 v[112:115],v[44:47],v[208:215],v2
v_smfmac_f32_16x16x64_bf16 v[116:119],v[44:47],v[216:223],v2
v_smfmac_f32_16x16x64_bf16 v[112:115],v[48:51],v[224:231],v2
v_smfmac_f32_16x16x64_bf16 v[116:119],v[48:51],v[232:239],v2
v_smfmac_f32_16x16x64_bf16 v[112:115],v[52:55],v[240:247],v2
v_smfmac_f32_16x16x64_bf16 v[116:119],v[52:55],v[248:255],v2
s_waitcnt lgkmcnt(0)
s_nop 2
v_pk_add_f32 v[112:113],v[112:113],v[114:115]
s_nop 2
v_pk_add_f32 v[116:117],v[116:117],v[118:119]
v_cvt_pk_bf16_f32 v126,v112,v113
v_cvt_pk_bf16_f32 v127,v116,v117
v_add_u32 v52,s50,v5
v_add_u32 v54,s50,v6
ds_read_b64_tr_b16 v[52:53],v52
ds_read_b64_tr_b16 v[54:55],v54
v_mov_b32_dpp v124,v126 quad_perm:[2,3,2,3] row_mask:0xf bank_mask:0xf
v_mov_b32_dpp v125,v127 quad_perm:[2,3,2,3] row_mask:0xf bank_mask:0xf
s_mov_b32 vcc_lo,0xcccccccc
s_mov_b32 vcc_hi,0xcccccccc
s_waitcnt lgkmcnt(0)
v_cndmask_b32 v124,v124,v52,vcc
v_cndmask_b32 v125,v125,v53,vcc
v_cndmask_b32 v126,v126,v54,vcc
v_cndmask_b32 v127,v127,v55,vcc
buffer_store_dwordx4 v[124:127],v0,s[8:11],s54 offen sc1
s_mov_b32 s51,64
s_waitcnt vmcnt(0)
s_barrier
s_nop 11
v_lshrrev_b32 v1,4,v0
s_mov_b32 s53,0
s_branch L_rb_7
L_rc1_156:
v_and_b32 v120,15,v1
v_lshrrev_b32 v121,4,v1
v_and_b32 v122,2,v1
v_cmp_eq_u32 vcc,0,v122
v_mov_b32 v2,0xeeee
v_mov_b32 v123,0x4444
v_cndmask_b32 v2,v2,v123,vcc
v_and_b32 v122,1,v1
v_cmp_eq_u32 vcc,0,v122
v_mov_b32 v3,0xdddd
v_mov_b32 v123,0x8888
v_cndmask_b32 v3,v3,v123,vcc
v_lshrrev_b32 v122,1,v120
v_bfe_u32 v123,v120,2,1
v_xor_b32 v123,v123,v122
v_lshlrev_b32 v4,7,v123
v_and_b32 v123,1,v120
v_lshl_add_u32 v4,v123,6,v4
v_xor_b32 v123,v121,v122
v_and_b32 v123,3,v123
v_lshl_add_u32 v4,v123,4,v4
s_lshl_b32 s56,s46,10
s_add_u32 s56,s56,147456
v_add_u32 v4,s56,v4
v_lshlrev_b32 v122,1,v121
v_add_u32 v122,0,v122
v_and_b32 v123,1,v121
v_xor_b32 v123,v123,v122
v_lshlrev_b32 v5,7,v123
v_bfe_u32 v123,v120,3,1
v_lshl_add_u32 v5,v123,6,v5
v_xor_b32 v123,v120,v122
v_and_b32 v123,3,v123
v_lshl_add_u32 v5,v123,4,v5
v_bfe_u32 v123,v120,2,1
v_lshl_add_u32 v5,v123,3,v5
v_add_u32 v5,147456,v5
v_lshlrev_b32 v122,1,v121
v_add_u32 v122,1,v122
v_and_b32 v123,1,v121
v_xor_b32 v123,v123,v122
v_lshlrev_b32 v6,7,v123
v_bfe_u32 v123,v120,3,1
v_lshl_add_u32 v6,v123,6,v6
v_xor_b32 v123,v120,v122
v_and_b32 v123,3,v123
v_lshl_add_u32 v6,v123,4,v6
v_bfe_u32 v123,v120,2,1
v_lshl_add_u32 v6,v123,3,v6
v_add_u32 v6,147456,v6
v_lshlrev_b32 v7,7,v121
v_lshrrev_b32 v122,1,v120
v_lshl_add_u32 v8,v122,4,v7
v_add_u32 v8,151552,v8
v_lshrrev_b32 v122,2,v120
v_lshl_add_u32 v7,v122,5,v7
v_and_b32 v122,1,v120
v_lshl_add_u32 v7,v122,4,v7
v_and_b32 v122,2,v120
v_cmp_eq_u32 vcc,0,v122
s_lshl_b32 s56,s46,9
v_mov_b32 v122,2048
v_mov_b32 v123,s56
v_cndmask_b32 v122,v122,v123,vcc
v_add_u32 v7,v122,v7
v_add_u32 v7,151552,v7
v_lshrrev_b32 v122,3,v1
v_lshlrev_b32 v9,11,v122
v_and_b32 v122,7,v1
v_lshl_add_u32 v9,v122,3,v9
s_lshl_b32 s56,s46,14
s_lshl_b32 s57,s47,6
s_add_u32 s56,s56,s57
v_add_u32 v9,s56,v9
s_lshl_b32 s71,s46,5
s_add_u32 s71,s71,s47
s_bfe_u32 s56,s71,0x10003
s_lshl_b32 s56,s56,11
s_and_b32 s57,s71,1
s_lshl_b32 s57,s57,10
s_add_u32 s56,s56,s57
s_bfe_u32 s57,s71,0x10002
s_lshl_b32 s57,s57,9
s_add_u32 s56,s56,s57
s_bfe_u32 s57,s71,0x10001
s_lshl_b32 s57,s57,6
s_add_u32 s56,s56,s57
s_bfe_u32 s57,s71,0x10004
s_lshl_b32 s57,s57,8
s_add_u32 s56,s56,s57
s_bfe_u32 s57,s71,0x10005
s_lshl_b32 s57,s57,7
s_add_u32 s56,s56,s57
s_bfe_u32 s57,s71,0x10006
s_lshl_b32 s57,s57,12
s_add_u32 s56,s56,s57
v_and_b32 v122,3,v120
v_lshlrev_b32 v10,2,v122
v_bfe_u32 v122,v120,3,1
v_lshl_add_u32 v10,v122,4,v10
v_and_b32 v122,1,v121
v_lshl_add_u32 v10,v122,5,v10
v_add_u32 v10,s56,v10
v_and_b32 v123,36,v1
v_mov_b32 v122,0x80000000
v_cmp_eq_u32 vcc,0,v123
s_nop 1
v_cndmask_b32 v10,v122,v10,vcc
s_lshl_b32 s71,s71,11
s_lshl_b32 s73,s46,11
s_mov_b32 s72,0xffc00000
s_mov_b32 s74,0
v_and_b32 v11,1,v121
v_xor_b32 v11,v11,v120
v_and_b32 v11,3,v11
v_lshrrev_b32 v122,2,v120
v_lshl_add_u32 v11,v11,2,v122
v_lshl_add_u32 v11,v121,4,v11
v_lshlrev_b32 v11,4,v11
s_lshl_b32 s56,s46,15
v_add_u32 v11,s56,v11
v_lshrrev_b32 v13,3,v1
v_lshlrev_b32 v13,9,v13
v_and_b32 v122,7,v1
v_lshl_add_u32 v13,v122,4,v13
v_and_b32 v122,15,v1
v_and_b32 v123,1,v1
v_lshlrev_b32 v123,4,v123
v_mov_b32 v124,0x3f80
v_lshlrev_b32 v124,v123,v124
v_lshrrev_b32 v122,1,v122
v_cmp_eq_u32 vcc,0,v122
s_nop 1
v_cndmask_b32 v18,0,v124,vcc
v_cmp_eq_u32 vcc,1,v122
s_nop 1
v_cndmask_b32 v19,0,v124,vcc
v_cmp_eq_u32 vcc,2,v122
s_nop 1
v_cndmask_b32 v20,0,v124,vcc
v_cmp_eq_u32 vcc,3,v122
s_nop 1
v_cndmask_b32 v21,0,v124,vcc
s_and_b32 s56,s46,1
s_lshl_b32 s56,s56,8
s_and_b32 s57,s46,2
s_lshl_b32 s57,s57,6
s_add_u32 s56,s56,s57
v_add_u32 v13,s56,v13
s_add_u32 s56,s50,155648
v_add_u32 v12,s56,v0
v_mov_b64 v[14:15],s[28:29]
v_mov_b64 v[16:17],s[28:29]
v_add_u32 v22,12599296,v10
s_lshl_b32 s18,s47,2
s_add_u32 s18,s18,10494080
v_mov_b32 v1,s80
s_mov_b32 s65,15728640
s_add_u32 s66,s71,15728640
s_add_u32 s69,s71,15990784
s_mov_b32 s30,0x40000000
s_mov_b32 s51,0
buffer_load_dwordx4 v[88:91],v0,s[8:11],s66 offen offset:0
buffer_load_dwordx4 v[88:91],v0,s[8:11],s66 offen offset:1024
buffer_load_dwordx4 v[88:91],v0,s[8:11],s69 offen offset:0
buffer_load_dwordx4 v[88:91],v0,s[8:11],s69 offen offset:1024
s_waitcnt vmcnt(0)
L_cst_186:
s_cmp_lg_u32 s46,0
s_cbranch_scc1 L_csw_191
s_lshl_b32 s59,s51,13
s_lshl2_add_u32 s59,s47,s59
s_add_u32 s59,s59,10485888
L_ww_192:
s_sleep 1
buffer_load_dword v122,off,s[8:11],s59 sc1
s_sub_u32 s49,s49,1
s_cbranch_scc1 L_abort
s_waitcnt vmcnt(0)
v_readfirstlane_b32 s61,v122
s_cmp_eq_u32 s61,0
s_cbranch_scc1 L_ww_192
L_wwd_193:
L_csw_191:
s_waitcnt lgkmcnt(0)
s_barrier
s_lshl_b32 s56,s51,5
s_add_u32 s56,s56,s47
s_mul_i32 s56,s56,24576
s_add_u32 s56,s56,150994944
s_add_u32 s67,s56,s73
s_add_u32 m0,s73,131072
s_add_u32 s57,s67,8192
buffer_load_dwordx4 v0,s[8:11],s67 offen sc1 lds
buffer_load_dwordx4 v0,s[8:11],s67 offen offset:1024 sc1 lds
s_add_u32 m0,s73,139264
s_add_u32 s67,s67,786432
buffer_load_dwordx4 v0,s[8:11],s57 offen sc1 lds
buffer_load_dwordx4 v0,s[8:11],s57 offen offset:1024 sc1 lds
s_lshl_b32 s75,s51,13
s_add_u32 s56,s75,12591104
buffer_load_dword v23,v10,s[8:11],s56 offen sc1
s_add_u32 s64,s75,12582912
s_add_u32 s70,s64,4096
s_lshl_b32 s68,s51,5
s_add_u32 s68,s68,s47
s_lshl_b32 s68,s68,12
s_lshl_b32 s56,s46,10
s_add_u32 s68,s68,s56
s_add_u32 s68,s68,58720256
s_mov_b32 s54,0x80000000
s_mov_b32 s77,0
s_add_u32 s56,s18,s75
s_buffer_load_dword s19,s[8:11],s56
s_cmp_eq_u32 s51,63
s_cselect_b32 s76,1,s46
s_cmp_eq_u32 s76,0
s_cselect_b32 s76,1,0
v_mov_b64 v[96:97],0
v_mov_b64 v[98:99],0
v_mov_b64 v[100:101],0
v_mov_b64 v[102:103],0
v_mov_b64 v[104:105],0
v_mov_b64 v[106:107],0
v_mov_b64 v[108:109],0
v_mov_b64 v[110:111],0
v_mov_b64 v[112:113],0
v_mov_b64 v[114:115],0
v_mov_b64 v[116:117],0
v_mov_b64 v[118:119],0
s_waitcnt vmcnt(0) lgkmcnt(0)
s_barrier
v_add_u32 v55,131072,v0
ds_read_b128 v[56:59],v55 offset:0
ds_read_b128 v[60:63],v55 offset:4096
ds_read_b128 v[64:67],v55 offset:1024
ds_read_b128 v[68:71],v55 offset:5120
ds_read_b128 v[72:75],v55 offset:2048
ds_read_b128 v[76:79],v55 offset:6144
ds_read_b128 v[80:83],v55 offset:3072
ds_read_b128 v[84:87],v55 offset:7168
v_add_u32 v123,s73,v55
ds_read_b128 v[88:91],v123 offset:8192
ds_read_b128 v[92:95],v123 offset:9216
v_xor_b32 v120,1024,v12
v_xor_b32 v121,2048,v12
v_xor_b32 v122,3072,v12
buffer_load_dwordx4 v[24:27],v13,s[8:11],s64 offen sc1
buffer_load_dwordx4 v[24:27],v13,s[8:11],s64 offen sc1
.p2align 6
L_chain_194:
L_cpa_195:
buffer_load_dwordx4 v[24:27],v13,s[8:11],s64 offen sc1
s_sub_u32 s49,s49,1
s_cbranch_scc1 L_abort
s_waitcnt vmcnt(2)
v_max3_u32 v123,v24,v25,v26
v_max_u32 v123,v27,v123
v_cmp_le_u32 vcc,s72,v123
ds_write_b128 v12,v[24:27] offset:0
s_cbranch_vccnz L_cpa_195
L_cgo_198:
v_smfmac_f32_16x16x64_bf16 v[96:99],v[24:27],a[0:7],v2
buffer_load_dwordx4 v[40:43],v13,s[8:11],s70 offen sc1
s_waitcnt lgkmcnt(0)
s_barrier
ds_read_b128 v[28:31],v120 offset:0
v_smfmac_f32_16x16x64_bf16 v[100:103],v[24:27],a[128:135],v2
ds_read_b128 v[32:35],v121 offset:0
v_smfmac_f32_16x16x64_bf16 v[104:107],v[24:27],a[8:15],v2
ds_read_b128 v[36:39],v122 offset:0
v_smfmac_f32_16x16x64_bf16 v[108:111],v[24:27],a[136:143],v2
v_smfmac_f32_16x16x64_bf16 v[112:115],v[24:27],v[128:135],v2
v_smfmac_f32_16x16x64_bf16 v[116:119],v[24:27],v[136:143],v2
s_waitcnt lgkmcnt(2)
v_smfmac_f32_16x16x64_bf16 v[96:99],v[28:31],a[16:23],v2
s_add_u32 m0,s73,131072
v_smfmac_f32_16x16x64_bf16 v[100:103],v[28:31],a[144:151],v2
s_add_u32 s57,s67,8192
v_smfmac_f32_16x16x64_bf16 v[104:107],v[28:31],a[24:31],v2
s_cmp_lt_u32 s19,s76
s_cbranch_scc1 L_ckw_187
L_ckb_188:
v_smfmac_f32_16x16x64_bf16 v[108:111],v[28:31],a[152:159],v2
s_waitcnt vmcnt(0) lgkmcnt(1)
v_smfmac_f32_16x16x64_bf16 v[96:99],v[32:35],a[32:39],v2
ds_write_b128 v12,v[40:43] offset:4096
v_max3_u32 v123,v40,v41,v42
v_smfmac_f32_16x16x64_bf16 v[100:103],v[32:35],a[160:167],v2
v_max_u32 v123,v43,v123
v_smfmac_f32_16x16x64_bf16 v[104:107],v[32:35],a[40:47],v2
v_cmp_le_u32 vcc,s72,v123
v_smfmac_f32_16x16x64_bf16 v[108:111],v[32:35],a[168:175],v2
v_smfmac_f32_16x16x64_bf16 v[112:115],v[28:31],v[144:151],v2
s_cbranch_vccnz L_cpb_201
L_cback_203:
s_waitcnt lgkmcnt(0)
s_barrier
v_smfmac_f32_16x16x64_bf16 v[96:99],v[36:39],a[48:55],v2
buffer_store_dword v54,v10,s[8:11],s30 offen sc1
v_smfmac_f32_16x16x64_bf16 v[100:103],v[36:39],a[176:183],v2
ds_read_b128 v[44:47],v120 offset:4096
v_smfmac_f32_16x16x64_bf16 v[104:107],v[36:39],a[56:63],v2
buffer_load_dword v23,v22,s[8:11],s75 offen sc1
v_smfmac_f32_16x16x64_bf16 v[108:111],v[36:39],a[184:191],v2
ds_read_b128 v[48:51],v121 offset:4096
v_smfmac_f32_16x16x64_bf16 v[96:99],v[40:43],a[64:71],v2
buffer_load_dwordx4 v0,s[8:11],s67 offen sc1 lds
v_smfmac_f32_16x16x64_bf16 v[100:103],v[40:43],a[192:199],v2
ds_read_b128 v[52:55],v122 offset:4096
v_smfmac_f32_16x16x64_bf16 v[104:107],v[40:43],a[72:79],v2
buffer_store_dwordx4 v[124:127],v0,s[8:11],s54 offen sc1
v_smfmac_f32_16x16x64_bf16 v[108:111],v[40:43],a[200:207],v2
s_waitcnt lgkmcnt(2)
v_smfmac_f32_16x16x64_bf16 v[96:99],v[44:47],a[80:87],v2
buffer_load_dwordx4 v0,s[8:11],s67 offen offset:1024 sc1 lds
s_add_u32 m0,s73,139264
v_smfmac_f32_16x16x64_bf16 v[100:103],v[44:47],a[208:215],v2
s_waitcnt lgkmcnt(1)
v_smfmac_f32_16x16x64_bf16 v[96:99],v[48:51],a[96:103],v2
buffer_load_dwordx4 v0,s[8:11],s57 offen sc1 lds
s_add_u32 s67,s67,786432
v_smfmac_f32_16x16x64_bf16 v[100:103],v[48:51],a[224:231],v2
s_waitcnt lgkmcnt(0)
v_smfmac_f32_16x16x64_bf16 v[96:99],v[52:55],a[112:119],v2
buffer_load_dwordx4 v0,s[8:11],s57 offen offset:1024 sc1 lds
v_smfmac_f32_16x16x64_bf16 v[100:103],v[52:55],a[240:247],v2
v_smfmac_f32_16x16x64_bf16 v[104:107],v[44:47],a[88:95],v2
v_smfmac_f32_16x16x64_bf16 v[108:111],v[44:47],a[216:223],v2
v_smfmac_f32_16x16x64_bf16 v[104:107],v[48:51],a[104:111],v2
v_add_f32 v96,v96,v98
v_smfmac_f32_16x16x64_bf16 v[108:111],v[48:51],a[232:239],v2
v_add_f32 v97,v97,v99
v_smfmac_f32_16x16x64_bf16 v[104:107],v[52:55],a[120:127],v2
v_cvt_pk_bf16_f32 v120,v96,v97
v_smfmac_f32_16x16x64_bf16 v[108:111],v[52:55],a[248:255],v2
v_add_f32 v100,v100,v102
v_smfmac_f32_16x16x64_bf16 v[116:119],v[28:31],v[152:159],v2
v_add_f32 v101,v101,v103
v_smfmac_f32_16x16x64_bf16 v[112:115],v[32:35],v[160:167],v2
v_cvt_pk_bf16_f32 v121,v100,v101
v_add_f32 v104,v104,v106
v_add_f32 v105,v105,v107
v_cvt_pk_bf16_f32 v122,v104,v105
v_add_f32 v108,v108,v110
v_add_f32 v109,v109,v111
v_cvt_pk_bf16_f32 v123,v108,v109
ds_write_b128 v4,v[120:123]
v_smfmac_f32_16x16x64_bf16 v[116:119],v[32:35],v[168:175],v2
s_mov_b32 s54,s68
s_add_u32 s68,s68,131072
v_mov_b32 v125,0
v_smfmac_f32_16x16x64_bf16 v[112:115],v[36:39],v[176:183],v2
s_cmp_eq_u32 s51,63
s_cbranch_scc1 L_cend_197
v_smfmac_f32_16x16x64_bf16 v[116:119],v[36:39],v[184:191],v2
s_waitcnt lgkmcnt(0)
s_barrier
ds_read_b64_tr_b16 v[96:97],v5 offset:0
v_smfmac_f32_16x16x64_bf16 v[112:115],v[40:43],v[192:199],v2
ds_read_b64_tr_b16 v[98:99],v6 offset:0
v_smfmac_f32_16x16x64_bf16 v[116:119],v[40:43],v[200:207],v2
ds_read_b64_tr_b16 v[100:101],v5 offset:1024
v_smfmac_f32_16x16x64_bf16 v[112:115],v[44:47],v[208:215],v2
ds_read_b64_tr_b16 v[102:103],v6 offset:1024
v_smfmac_f32_16x16x64_bf16 v[116:119],v[44:47],v[216:223],v2
ds_read_b64_tr_b16 v[104:105],v5 offset:2048
v_smfmac_f32_16x16x64_bf16 v[112:115],v[48:51],v[224:231],v2
ds_read_b64_tr_b16 v[106:107],v6 offset:2048
s_waitcnt lgkmcnt(4)
v_mfma_f32_16x16x32_bf16 v[24:27],v[56:59],v[96:99],0
ds_read_b64_tr_b16 v[108:109],v5 offset:3072
v_mfma_f32_16x16x32_bf16 v[28:31],v[60:63],v[96:99],0
ds_read_b64_tr_b16 v[110:111],v6 offset:3072
v_mfma_f32_16x16x32_bf16 v[32:35],v[96:99],v[96:99],0
ds_read_b128 v[40:43],v11 offset:12288
s_waitcnt lgkmcnt(5)
v_mfma_f32_16x16x32_bf16 v[24:27],v[64:67],v[100:103],v[24:27]
ds_read_b128 v[56:59],v11 offset:0
v_mfma_f32_16x16x32_bf16 v[28:31],v[68:71],v[100:103],v[28:31]
ds_read_b128 v[60:63],v11 offset:1024
v_mfma_f32_16x16x32_bf16 v[32:35],v[100:103],v[100:103],v[32:35]
ds_read_b128 v[96:99],v11 offset:8192
s_waitcnt lgkmcnt(6)
v_mfma_f32_16x16x32_bf16 v[24:27],v[72:75],v[104:107],v[24:27]
ds_read_b128 v[64:67],v11 offset:2048
v_mfma_f32_16x16x32_bf16 v[28:31],v[76:79],v[104:107],v[28:31]
ds_read_b128 v[68:71],v11 offset:3072
v_mfma_f32_16x16x32_bf16 v[32:35],v[104:107],v[104:107],v[32:35]
ds_read_b128 v[100:103],v11 offset:9216
s_waitcnt lgkmcnt(7)
v_mfma_f32_16x16x32_bf16 v[24:27],v[80:83],v[108:111],v[24:27]
ds_read_b128 v[72:75],v11 offset:4096
v_mfma_f32_16x16x32_bf16 v[28:31],v[84:87],v[108:111],v[28:31]
ds_read_b128 v[76:79],v11 offset:5120
v_mfma_f32_16x16x32_bf16 v[32:35],v[108:111],v[108:111],v[32:35]
ds_read_b128 v[104:107],v11 offset:10240
v_smfmac_f32_16x16x64_bf16 v[116:119],v[48:51],v[232:239],v2
ds_read_b128 v[80:83],v11 offset:6144
v_smfmac_f32_16x16x64_bf16 v[112:115],v[52:55],v[240:247],v2
ds_read_b128 v[84:87],v11 offset:7168
v_smfmac_f32_16x16x64_bf16 v[116:119],v[52:55],v[248:255],v2
ds_read_b128 v[108:111],v11 offset:11264
v_max3_f32 v126,v24,v25,v26
v_max3_f32 v127,v27,v28,v29
v_max3_f32 v126,v30,v31,v126
v_max3_f32 v127,v34,v35,v127
v_max_f32 v126,v126,v127
v_max_f32 v127,v126,v127
v_pk_mul_f32 v[34:35],v[34:35],v[0:1] op_sel:[0,1]
v_pk_mul_f32 v[24:25],v[24:25],v[0:1] op_sel:[0,1]
v_permlane16_swap_b32 v126,v127
v_max_f32 v126,v126,v127
v_max_f32 v127,v126,v127
v_pk_add_f32 v[112:113],v[112:113],v[114:115]
v_pk_add_f32 v[116:117],v[116:117],v[118:119]
v_permlane32_swap_b32 v126,v127
v_max_f32 v126,v126,v127
v_mul_f32 v126,v1,v126
v_pk_add_f32 v[34:35],v[34:35],v[126:127] op_sel_hi:[1,0] neg_lo:[0,1] neg_hi:[0,1]
v_pk_add_f32 v[24:25],v[24:25],v[126:127] op_sel_hi:[1,0] neg_lo:[0,1] neg_hi:[0,1]
v_pk_fma_f32 v[26:27],v[26:27],v[0:1],v[126:127] op_sel:[0,1,0] op_sel_hi:[1,1,0] neg_lo:[0,0,1] neg_hi:[0,0,1]
v_pk_fma_f32 v[28:29],v[28:29],v[0:1],v[126:127] op_sel:[0,1,0] op_sel_hi:[1,1,0] neg_lo:[0,0,1] neg_hi:[0,0,1]
v_pk_fma_f32 v[30:31],v[30:31],v[0:1],v[126:127] op_sel:[0,1,0] op_sel_hi:[1,1,0] neg_lo:[0,0,1] neg_hi:[0,0,1]
v_exp_f32 v34,v34
v_exp_f32 v35,v35
v_cvt_pk_bf16_f32 v126,v112,v113
v_cvt_pk_bf16_f32 v124,v34,v35
v_cvt_pk_bf16_f32 v127,v116,v117
v_cvt_pk_bf16_f32 v36,v116,v117
v_mfma_f32_16x16x16_bf16 v[32:35],v[14:15],v[124:125],0
ds_read_b128 v[44:47],v11 offset:13312
v_exp_f32 v24,v24
v_mfma_f32_16x16x16_bf16 v[112:115],v[126:127],v[124:125],0
ds_read_b128 v[48:51],v11 offset:14336
v_exp_f32 v25,v25
v_mfma_f32_16x16x16_bf16 v[116:119],v[36:37],v[124:125],0
ds_read_b128 v[52:55],v11 offset:15360
v_exp_f32 v26,v26
v_exp_f32 v27,v27
v_cvt_pk_bf16_f32 v120,v24,v25
v_exp_f32 v28,v28
v_exp_f32 v29,v29
v_cvt_pk_bf16_f32 v121,v26,v27
v_exp_f32 v30,v30
v_exp_f32 v31,v31
v_cvt_pk_bf16_f32 v122,v28,v29
v_cvt_pk_bf16_f32 v123,v30,v31
s_add_u32 s75,s75,8192
s_add_u32 s51,s51,1
v_mfma_f32_16x16x32_bf16 v[32:35],v[14:17],v[120:123],v[32:35]
v_mfma_f32_16x16x32_bf16 v[112:115],v[88:91],v[120:123],v[112:115]
ds_read_b128 v[88:91],v11 offset:16384
v_mfma_f32_16x16x32_bf16 v[116:119],v[92:95],v[120:123],v[116:119]
ds_read_b128 v[92:95],v11 offset:17408
v_rcp_f32 v32,v32
v_mov_b64 v[24:25],-1
v_mov_b64 v[26:27],-1
s_add_u32 s64,s75,12582912
s_add_u32 s70,s64,4096
v_pk_mul_f32 v[112:113],v[112:113],v[32:33] op_sel_hi:[1,0]
v_pk_mul_f32 v[114:115],v[114:115],v[32:33] op_sel_hi:[1,0]
v_pk_mul_f32 v[116:117],v[116:117],v[32:33] op_sel_hi:[1,0]
v_pk_mul_f32 v[118:119],v[118:119],v[32:33] op_sel_hi:[1,0]
v_cvt_pk_bf16_f32 v120,v112,v116
v_cvt_pk_bf16_f32 v121,v113,v117
v_cvt_pk_bf16_f32 v122,v114,v118
v_cvt_pk_bf16_f32 v123,v115,v119
ds_write_b128 v7,v[120:123]
buffer_store_dwordx4 v[24:27],v0,s[8:11],s69 offen
buffer_store_dwordx4 v[24:27],v0,s[8:11],s69 offen offset:1024
v_mov_b64 v[112:113],0
v_mov_b64 v[114:115],0
v_mov_b64 v[116:117],0
v_mov_b64 v[118:119],0
s_waitcnt lgkmcnt(0)
s_barrier
ds_read_b128 v[24:27],v8 offset:0
ds_read_b128 v[28:31],v8 offset:512
ds_read_b128 v[32:35],v8 offset:1024
ds_read_b128 v[36:39],v8 offset:1536
v_mov_b64 v[120:121],0
v_mov_b64 v[122:123],0
s_add_u32 s57,s65,65536
s_add_u32 s58,s65,131072
s_add_u32 s59,s65,196608
s_add_u32 s56,s18,s75
s_add_u32 s30,s75,17825792
s_waitcnt lgkmcnt(3)
v_smfmac_f32_16x16x64_bf16 v[112:115],v[24:27],v[56:63],v3
ds_read_b128 v[56:59],v11 offset:18432
s_waitcnt lgkmcnt(3)
v_smfmac_f32_16x16x64_bf16 v[112:115],v[28:31],v[64:71],v3
ds_read_b128 v[60:63],v11 offset:19456
s_waitcnt lgkmcnt(3)
v_smfmac_f32_16x16x64_bf16 v[112:115],v[32:35],v[72:79],v3
ds_read_b128 v[64:67],v11 offset:20480
s_waitcnt lgkmcnt(3)
v_smfmac_f32_16x16x64_bf16 v[112:115],v[36:39],v[80:87],v3
ds_read_b128 v[68:71],v11 offset:21504
v_smfmac_f32_16x16x64_bf16 v[116:119],v[24:27],v[96:103],v3
ds_read_b128 v[72:75],v11 offset:22528
v_smfmac_f32_16x16x64_bf16 v[116:119],v[28:31],v[104:111],v3
ds_read_b128 v[76:79],v11 offset:23552
v_cvt_pk_bf16_f32 v112,v112,v113
v_smfmac_f32_16x16x64_bf16 v[116:119],v[32:35],v[40:47],v3
ds_read_b128 v[80:83],v11 offset:24576
v_cvt_pk_bf16_f32 v113,v114,v115
buffer_store_dwordx2 v[112:113],v9,s[8:11],s65 offen
v_smfmac_f32_16x16x64_bf16 v[116:119],v[36:39],v[48:55],v3
ds_read_b128 v[84:87],v11 offset:25600
v_mov_b64 v[112:113],0
v_smfmac_f32_16x16x64_bf16 v[120:123],v[24:27],v[88:95],v3
ds_read_b128 v[96:99],v11 offset:26624
ds_read_b128 v[100:103],v11 offset:27648
v_mov_b64 v[114:115],0
s_waitcnt lgkmcnt(8)
v_smfmac_f32_16x16x64_bf16 v[120:123],v[28:31],v[56:63],v3
ds_read_b128 v[104:107],v11 offset:28672
v_cvt_pk_bf16_f32 v116,v116,v117
s_waitcnt lgkmcnt(7)
v_smfmac_f32_16x16x64_bf16 v[120:123],v[32:35],v[64:71],v3
ds_read_b128 v[108:111],v11 offset:29696
ds_read_b128 v[40:43],v11 offset:30720
v_cvt_pk_bf16_f32 v117,v118,v119
buffer_store_dwordx2 v[116:117],v9,s[8:11],s57 offen
s_waitcnt lgkmcnt(7)
v_smfmac_f32_16x16x64_bf16 v[120:123],v[36:39],v[72:79],v3
ds_read_b128 v[44:47],v11 offset:31744
v_add_u32 v52,s50,v5
s_waitcnt lgkmcnt(6)
v_smfmac_f32_16x16x64_bf16 v[112:115],v[24:27],v[80:87],v3
v_add_u32 v54,s50,v6
s_waitcnt lgkmcnt(4)
v_smfmac_f32_16x16x64_bf16 v[112:115],v[28:31],v[96:103],v3
ds_read_b64_tr_b16 v[52:53],v52
v_cvt_pk_bf16_f32 v120,v120,v121
s_waitcnt lgkmcnt(3)
v_smfmac_f32_16x16x64_bf16 v[112:115],v[32:35],v[104:111],v3
ds_read_b64_tr_b16 v[54:55],v54
v_cvt_pk_bf16_f32 v121,v122,v123
buffer_store_dwordx2 v[120:121],v9,s[8:11],s58 offen
s_waitcnt lgkmcnt(2)
v_smfmac_f32_16x16x64_bf16 v[112:115],v[36:39],v[40:47],v3
v_mov_b64 v[116:117],0
v_mov_b64 v[118:119],0
s_xor_b32 s65,s65,262144
v_mov_b32_dpp v124,v126 quad_perm:[2,3,2,3] row_mask:0xf bank_mask:0xf
v_mov_b32_dpp v125,v127 quad_perm:[2,3,2,3] row_mask:0xf bank_mask:0xf
s_mov_b32 vcc_lo,0xcccccccc
s_mov_b32 vcc_hi,0xcccccccc
s_nop 0
v_cvt_pk_bf16_f32 v112,v112,v113
v_cvt_pk_bf16_f32 v113,v114,v115
buffer_store_dwordx2 v[112:113],v9,s[8:11],s59 offen
s_waitcnt lgkmcnt(0)
s_buffer_load_dword s19,s[8:11],s56
v_cndmask_b32 v124,v124,v52,vcc
v_cndmask_b32 v125,v125,v53,vcc
s_cmp_lt_u32 s46,2
s_waitcnt vmcnt(3)
s_cbranch_scc1 L_crg_204
s_cmp_eq_u32 s46,2
s_waitcnt vmcnt(1)
s_cbranch_scc1 L_crg_204
s_waitcnt vmcnt(0)
L_crg_204:
buffer_load_dwordx4 v[32:35],v0,s[8:11],s66 offen offset:0 sc1
buffer_load_dwordx4 v[36:39],v0,s[8:11],s66 offen offset:1024 sc1
v_cndmask_b32 v126,v126,v54,vcc
v_cndmask_b32 v127,v127,v55,vcc
v_mov_b64 v[96:97],0
v_mov_b64 v[98:99],0
v_mov_b64 v[100:101],0
v_mov_b64 v[102:103],0
v_mov_b64 v[104:105],0
v_mov_b64 v[106:107],0
v_mov_b64 v[108:109],0
v_mov_b64 v[110:111],0
v_mov_b64 v[112:113],0
v_mov_b64 v[114:115],0
v_add_u32 v55,131072,v0
v_add_u32 v123,s73,v55
v_xor_b32 v120,1024,v12
v_xor_b32 v121,2048,v12
v_xor_b32 v122,3072,v12
buffer_load_dwordx4 v[44:47],v0,s[8:11],s66 offen offset:0 sc1
buffer_load_dwordx4 v[48:51],v0,s[8:11],s66 offen offset:1024 sc1
s_cmp_ge_u32 s51,63
s_cselect_b32 s76,0,1
s_cmp_eq_u32 s46,0
s_cselect_b32 s76,s76,0
s_waitcnt vmcnt(3)
v_mfma_f32_16x16x32_bf16 v[28:31],v[18:21],v[32:35],0
s_waitcnt vmcnt(2)
v_mfma_f32_16x16x32_bf16 v[28:31],v[18:21],v[36:39],v[28:31]
s_nop 7
v_cmp_u_f32 vcc,v28,v28
v_add_f32_dpp v52,v28,v28 row_ror:8 row_mask:0xf bank_mask:0x3
v_add_f32_dpp v53,v29,v29 row_ror:8 row_mask:0xf bank_mask:0x3
v_add_f32_dpp v52,v30,v30 row_ror:8 row_mask:0xf bank_mask:0xc
v_add_f32_dpp v53,v31,v31 row_ror:8 row_mask:0xf bank_mask:0xc
s_cbranch_vccnz L_crp_199
L_cok_205:
v_add_f32_dpp v52,v52,v52 row_shl:4 row_mask:0xf bank_mask:0x5
v_add_f32_dpp v53,v53,v53 row_shl:4 row_mask:0xf bank_mask:0x5
v_cvt_pk_bf16_f32 v54,v52,v53
buffer_store_dword v54,v10,s[8:11],s64 offen
s_mov_b32 s69,s66
s_xor_b32 s66,s66,262144
s_barrier
ds_read_b128 v[56:59],v55 offset:0
ds_read_b128 v[60:63],v55 offset:4096
ds_read_b128 v[64:67],v55 offset:1024
buffer_load_dwordx4 v[24:27],v13,s[8:11],s64 offen sc1
ds_read_b128 v[68:71],v55 offset:5120
ds_read_b128 v[72:75],v55 offset:2048
ds_read_b128 v[76:79],v55 offset:6144
ds_read_b128 v[80:83],v55 offset:3072
buffer_load_dwordx4 v[24:27],v13,s[8:11],s64 offen sc1
ds_read_b128 v[84:87],v55 offset:7168
ds_read_b128 v[88:91],v123 offset:8192
ds_read_b128 v[92:95],v123 offset:9216
s_branch L_chain_194
L_cpb_201:
buffer_load_dwordx4 v[40:43],v13,s[8:11],s70 offen sc1
s_sub_u32 s49,s49,1
s_cbranch_scc1 L_abort
s_waitcnt vmcnt(0)
v_max3_u32 v123,v40,v41,v42
v_max_u32 v123,v43,v123
v_cmp_le_u32 vcc,s72,v123
s_cbranch_vccnz L_cpb_201
ds_write_b128 v12,v[40:43] offset:4096
s_branch L_cback_203
L_crp_199:
buffer_load_dwordx4 v[32:35],v0,s[8:11],s66 offen offset:0 sc1
buffer_load_dwordx4 v[36:39],v0,s[8:11],s66 offen offset:1024 sc1
s_sub_u32 s49,s49,1
s_cbranch_scc1 L_abort
s_waitcnt vmcnt(3)
v_mfma_f32_16x16x32_bf16 v[28:31],v[18:21],v[44:47],0
s_waitcnt vmcnt(2)
v_mfma_f32_16x16x32_bf16 v[28:31],v[18:21],v[48:51],v[28:31]
s_nop 7
v_cmp_u_f32 vcc,v28,v28
v_add_f32_dpp v52,v28,v28 row_ror:8 row_mask:0xf bank_mask:0x3
v_add_f32_dpp v53,v29,v29 row_ror:8 row_mask:0xf bank_mask:0x3
v_add_f32_dpp v52,v30,v30 row_ror:8 row_mask:0xf bank_mask:0xc
v_add_f32_dpp v53,v31,v31 row_ror:8 row_mask:0xf bank_mask:0xc
s_cbranch_vccz L_cok_205
buffer_load_dwordx4 v[44:47],v0,s[8:11],s66 offen offset:0 sc1
buffer_load_dwordx4 v[48:51],v0,s[8:11],s66 offen offset:1024 sc1
s_sub_u32 s49,s49,1
s_cbranch_scc1 L_abort
s_waitcnt vmcnt(3)
v_mfma_f32_16x16x32_bf16 v[28:31],v[18:21],v[32:35],0
s_waitcnt vmcnt(2)
v_mfma_f32_16x16x32_bf16 v[28:31],v[18:21],v[36:39],v[28:31]
s_nop 7
v_cmp_u_f32 vcc,v28,v28
v_add_f32_dpp v52,v28,v28 row_ror:8 row_mask:0xf bank_mask:0x3
v_add_f32_dpp v53,v29,v29 row_ror:8 row_mask:0xf bank_mask:0x3
v_add_f32_dpp v52,v30,v30 row_ror:8 row_mask:0xf bank_mask:0xc
v_add_f32_dpp v53,v31,v31 row_ror:8 row_mask:0xf bank_mask:0xc
s_cbranch_vccz L_cok_205
s_branch L_crp_199
L_ckw_187:
s_add_u32 s59,s18,s75
L_ww_206:
s_sleep 1
buffer_load_dword v23,off,s[8:11],s59 sc1
s_sub_u32 s49,s49,1
s_cbranch_scc1 L_abort
s_waitcnt vmcnt(0)
v_readfirstlane_b32 s76,v23
s_cmp_eq_u32 s76,0
s_cbranch_scc1 L_ww_206
L_wwd_207:
s_branch L_ckb_188
L_cend_197:
v_smfmac_f32_16x16x64_bf16 v[116:119],v[36:39],v[184:191],v2
v_smfmac_f32_16x16x64_bf16 v[112:115],v[40:43],v[192:199],v2
v_smfmac_f32_16x16x64_bf16 v[116:119],v[40:43],v[200:207],v2
v_smfmac_f32_16x16x64_bf16 v[112:115],v[44:47],v[208:215],v2
v_smfmac_f32_16x16x64_bf16 v[116:119],v[44:47],v[216:223],v2
v_smfmac_f32_16x16x64_bf16 v[112:115],v[48:51],v[224:231],v2
v_smfmac_f32_16x16x64_bf16 v[116:119],v[48:51],v[232:239],v2
v_smfmac_f32_16x16x64_bf16 v[112:115],v[52:55],v[240:247],v2
v_smfmac_f32_16x16x64_bf16 v[116:119],v[52:55],v[248:255],v2
s_waitcnt lgkmcnt(0)
s_nop 2
v_pk_add_f32 v[112:113],v[112:113],v[114:115]
s_nop 2
v_pk_add_f32 v[116:117],v[116:117],v[118:119]
v_cvt_pk_bf16_f32 v126,v112,v113
v_cvt_pk_bf16_f32 v127,v116,v117
v_add_u32 v52,s50,v5
v_add_u32 v54,s50,v6
ds_read_b64_tr_b16 v[52:53],v52
ds_read_b64_tr_b16 v[54:55],v54
v_mov_b32_dpp v124,v126 quad_perm:[2,3,2,3] row_mask:0xf bank_mask:0xf
v_mov_b32_dpp v125,v127 quad_perm:[2,3,2,3] row_mask:0xf bank_mask:0xf
s_mov_b32 vcc_lo,0xcccccccc
s_mov_b32 vcc_hi,0xcccccccc
s_waitcnt lgkmcnt(0)
v_cndmask_b32 v124,v124,v52,vcc
v_cndmask_b32 v125,v125,v53,vcc
v_cndmask_b32 v126,v126,v54,vcc
v_cndmask_b32 v127,v127,v55,vcc
buffer_store_dwordx4 v[124:127],v0,s[8:11],s54 offen sc1
s_mov_b32 s51,64
s_waitcnt vmcnt(0)
s_barrier
s_nop 11
v_lshrrev_b32 v1,4,v0
s_endpgm
L_rc2_157:
v_and_b32 v120,15,v1
v_lshrrev_b32 v121,4,v1
v_and_b32 v122,2,v1
v_cmp_eq_u32 vcc,0,v122
v_mov_b32 v2,0xeeee
v_mov_b32 v123,0x4444
v_cndmask_b32 v2,v2,v123,vcc
v_and_b32 v122,1,v1
v_cmp_eq_u32 vcc,0,v122
v_mov_b32 v3,0xdddd
v_mov_b32 v123,0x8888
v_cndmask_b32 v3,v3,v123,vcc
v_lshrrev_b32 v122,1,v120
v_bfe_u32 v123,v120,2,1
v_xor_b32 v123,v123,v122
v_lshlrev_b32 v4,7,v123
v_and_b32 v123,1,v120
v_lshl_add_u32 v4,v123,6,v4
v_xor_b32 v123,v121,v122
v_and_b32 v123,3,v123
v_lshl_add_u32 v4,v123,4,v4
s_lshl_b32 s56,s46,10
s_add_u32 s56,s56,147456
v_add_u32 v4,s56,v4
v_lshlrev_b32 v122,1,v121
v_add_u32 v122,0,v122
v_and_b32 v123,1,v121
v_xor_b32 v123,v123,v122
v_lshlrev_b32 v5,7,v123
v_bfe_u32 v123,v120,3,1
v_lshl_add_u32 v5,v123,6,v5
v_xor_b32 v123,v120,v122
v_and_b32 v123,3,v123
v_lshl_add_u32 v5,v123,4,v5
v_bfe_u32 v123,v120,2,1
v_lshl_add_u32 v5,v123,3,v5
v_add_u32 v5,147456,v5
v_lshlrev_b32 v122,1,v121
v_add_u32 v122,1,v122
v_and_b32 v123,1,v121
v_xor_b32 v123,v123,v122
v_lshlrev_b32 v6,7,v123
v_bfe_u32 v123,v120,3,1
v_lshl_add_u32 v6,v123,6,v6
v_xor_b32 v123,v120,v122
v_and_b32 v123,3,v123
v_lshl_add_u32 v6,v123,4,v6
v_bfe_u32 v123,v120,2,1
v_lshl_add_u32 v6,v123,3,v6
v_add_u32 v6,147456,v6
v_lshlrev_b32 v7,7,v121
v_lshrrev_b32 v122,1,v120
v_lshl_add_u32 v8,v122,4,v7
v_add_u32 v8,151552,v8
v_lshrrev_b32 v122,2,v120
v_lshl_add_u32 v7,v122,5,v7
v_and_b32 v122,1,v120
v_lshl_add_u32 v7,v122,4,v7
v_and_b32 v122,2,v120
v_cmp_eq_u32 vcc,0,v122
s_lshl_b32 s56,s46,9
v_mov_b32 v122,2048
v_mov_b32 v123,s56
v_cndmask_b32 v122,v122,v123,vcc
v_add_u32 v7,v122,v7
v_add_u32 v7,151552,v7
v_lshrrev_b32 v122,3,v1
v_lshlrev_b32 v9,11,v122
v_and_b32 v122,7,v1
v_lshl_add_u32 v9,v122,3,v9
s_lshl_b32 s56,s46,14
s_lshl_b32 s57,s47,6
s_add_u32 s56,s56,s57
v_add_u32 v9,s56,v9
s_lshl_b32 s71,s46,5
s_add_u32 s71,s71,s47
s_bfe_u32 s56,s71,0x10003
s_lshl_b32 s56,s56,11
s_and_b32 s57,s71,1
s_lshl_b32 s57,s57,10
s_add_u32 s56,s56,s57
s_bfe_u32 s57,s71,0x10002
s_lshl_b32 s57,s57,9
s_add_u32 s56,s56,s57
s_bfe_u32 s57,s71,0x10001
s_lshl_b32 s57,s57,6
s_add_u32 s56,s56,s57
s_bfe_u32 s57,s71,0x10004
s_lshl_b32 s57,s57,8
s_add_u32 s56,s56,s57
s_bfe_u32 s57,s71,0x10005
s_lshl_b32 s57,s57,7
s_add_u32 s56,s56,s57
s_bfe_u32 s57,s71,0x10006
s_lshl_b32 s57,s57,12
s_add_u32 s56,s56,s57
v_and_b32 v122,3,v120
v_lshlrev_b32 v10,2,v122
v_bfe_u32 v122,v120,3,1
v_lshl_add_u32 v10,v122,4,v10
v_and_b32 v122,1,v121
v_lshl_add_u32 v10,v122,5,v10
v_add_u32 v10,s56,v10
v_and_b32 v123,36,v1
v_mov_b32 v122,0x80000000
v_cmp_eq_u32 vcc,0,v123
s_nop 1
v_cndmask_b32 v10,v122,v10,vcc
s_lshl_b32 s71,s71,11
s_lshl_b32 s73,s46,11
s_mov_b32 s72,0xffc00000
s_mov_b32 s74,0
v_and_b32 v11,1,v121
v_xor_b32 v11,v11,v120
v_and_b32 v11,3,v11
v_lshrrev_b32 v122,2,v120
v_lshl_add_u32 v11,v11,2,v122
v_lshl_add_u32 v11,v121,4,v11
v_lshlrev_b32 v11,4,v11
s_lshl_b32 s56,s46,15
v_add_u32 v11,s56,v11
v_lshrrev_b32 v13,3,v1
v_lshlrev_b32 v13,9,v13
v_and_b32 v122,7,v1
v_lshl_add_u32 v13,v122,4,v13
v_and_b32 v122,15,v1
v_and_b32 v123,1,v1
v_lshlrev_b32 v123,4,v123
v_mov_b32 v124,0x3f80
v_lshlrev_b32 v124,v123,v124
v_lshrrev_b32 v122,1,v122
v_cmp_eq_u32 vcc,0,v122
s_nop 1
v_cndmask_b32 v18,0,v124,vcc
v_cmp_eq_u32 vcc,1,v122
s_nop 1
v_cndmask_b32 v19,0,v124,vcc
v_cmp_eq_u32 vcc,2,v122
s_nop 1
v_cndmask_b32 v20,0,v124,vcc
v_cmp_eq_u32 vcc,3,v122
s_nop 1
v_cndmask_b32 v21,0,v124,vcc
s_and_b32 s56,s46,1
s_lshl_b32 s56,s56,8
s_and_b32 s57,s46,2
s_lshl_b32 s57,s57,6
s_add_u32 s56,s56,s57
v_add_u32 v13,s56,v13
s_add_u32 s56,s50,155648
v_add_u32 v12,s56,v0
v_mov_b64 v[14:15],s[28:29]
v_mov_b64 v[16:17],s[28:29]
v_add_u32 v22,13647872,v10
s_lshl_b32 s18,s47,2
s_add_u32 s18,s18,10494080
v_mov_b32 v1,s80
s_mov_b32 s65,16777216
s_add_u32 s66,s71,16777216
s_add_u32 s69,s71,17039360
s_mov_b32 s30,0x40000000
s_mov_b32 s51,0
v_lshrrev_b32 v120,2,v0
v_add_u32 v120,10510464,v120
v_or_b32 v120,s52,v120
s_mov_b64 vcc,-1
s_mov_b32 vcc_lo,0
v_cndmask_b32 v22,v22,v120,vcc
s_or_b32 s56,s52,10495616
v_writelane_b32 v22,s56,4
s_or_b32 s56,s47,s46
s_mov_b32 s56,10486784
s_cmov_b32 s56,0x80000000
v_writelane_b32 v22,s56,5
s_mov_b32 s30,0
s_mov_b32 s31,0
buffer_load_dwordx4 v[88:91],v0,s[8:11],s66 offen offset:0
buffer_load_dwordx4 v[88:91],v0,s[8:11],s66 offen offset:1024
buffer_load_dwordx4 v[88:91],v0,s[8:11],s69 offen offset:0
buffer_load_dwordx4 v[88:91],v0,s[8:11],s69 offen offset:1024
s_waitcnt vmcnt(0)
L_cst_211:
s_cmp_lg_u32 s46,0
s_cbranch_scc1 L_csw_216
s_andn2_b32 s61,0x7ff,s30
s_lshr_b32 s61,s61,5
s_add_u32 s61,s61,2
s_add_u32 s60,s31,1
s_min_u32 s60,s60,63
s_cmp_gt_u32 s60,s61
s_cselect_b32 s60,s31,s60
s_sub_u32 s61,s60,s31
s_lshl_b32 s61,s61,13
s_lshl_b32 s59,s31,13
s_add_u32 s59,s59,10486016
v_lshrrev_b32 v121,2,v0
v_and_b32 v121,127,v121
v_lshrrev_b32 v120,9,v0
v_mul_u32_u24 v120,s61,v120
v_add_u32 v121,v120,v121
L_ckk_217:
s_sleep 1
buffer_load_dword v120,v121,s[8:11],s59 offen sc1
s_sub_u32 s49,s49,1
s_cbranch_scc1 L_abort
s_waitcnt vmcnt(0)
v_cmp_eq_u32 vcc,0,v120
s_cbranch_vccnz L_ckk_217
v_max_u32_dpp v120,v120,v120 row_ror:8 row_mask:0xf bank_mask:0xf
s_nop 1
v_max_u32_dpp v120,v120,v120 row_ror:4 row_mask:0xf bank_mask:0xf
s_nop 1
v_max_u32_dpp v120,v120,v120 row_ror:2 row_mask:0xf bank_mask:0xf
s_nop 1
v_max_u32_dpp v120,v120,v120 row_ror:1 row_mask:0xf bank_mask:0xf
v_mov_b32 v121,v120
s_nop 1
v_permlane16_swap_b32 v120,v121
v_max_u32 v120,v120,v121
v_mov_b32 v121,v120
s_nop 1
v_permlane32_swap_b32 v120,v121
v_max_u32 v120,v120,v121
s_nop 0
v_readfirstlane_b32 s61,v120
s_max_u32 s30,s30,s61
s_add_u32 s31,s60,1
s_andn2_b32 s51,0x7ff,s30
s_lshr_b32 s51,s51,5
s_add_u32 s61,s51,2
s_min_u32 s61,s61,63
s_cmp_le_u32 s31,s61
s_cbranch_scc1 L_cst_211
v_mov_b32 v120,0
v_mov_b32 v121,s30
ds_write_b32 v8,v120 offset:2560
ds_write_b32 v8,v121 offset:3072
s_lshl_b32 s59,s51,13
s_lshl2_add_u32 s59,s47,s59
s_add_u32 s59,s59,10485888
L_ww_218:
s_sleep 1
buffer_load_dword v122,off,s[8:11],s59 sc1
s_sub_u32 s49,s49,1
s_cbranch_scc1 L_abort
s_waitcnt vmcnt(0)
v_readfirstlane_b32 s61,v122
s_cmp_eq_u32 s61,0
s_cbranch_scc1 L_ww_218
L_wwd_219:
L_csw_216:
s_waitcnt lgkmcnt(0)
s_barrier
ds_read_b32 v120,v8 offset:3072
s_waitcnt lgkmcnt(0)
v_readfirstlane_b32 s30,v120
s_andn2_b32 s51,0x7ff,s30
s_lshr_b32 s51,s51,5
s_lshl_b32 s56,s51,5
s_add_u32 s56,s56,s47
s_mul_i32 s56,s56,24576
s_add_u32 s56,s56,150994944
s_add_u32 s67,s56,s73
s_add_u32 m0,s73,131072
s_add_u32 s57,s67,8192
buffer_load_dwordx4 v0,s[8:11],s67 offen sc1 lds
buffer_load_dwordx4 v0,s[8:11],s67 offen offset:1024 sc1 lds
s_add_u32 m0,s73,139264
s_add_u32 s67,s67,786432
buffer_load_dwordx4 v0,s[8:11],s57 offen sc1 lds
buffer_load_dwordx4 v0,s[8:11],s57 offen offset:1024 sc1 lds
s_lshl_b32 s75,s51,13
s_add_u32 s56,s75,13639680
buffer_load_dword v23,v10,s[8:11],s56 offen sc1
s_add_u32 s64,s75,17825792
s_add_u32 s70,s64,4096
s_lshl_b32 s68,s51,5
s_add_u32 s68,s68,s47
s_lshl_b32 s68,s68,12
s_lshl_b32 s56,s46,10
s_add_u32 s68,s68,s56
s_add_u32 s68,s68,75497472
s_mov_b32 s54,0x80000000
s_mov_b32 s77,0
s_add_u32 s56,s18,s75
s_buffer_load_dword s19,s[8:11],s56
s_cmp_eq_u32 s51,63
s_cselect_b32 s76,1,s46
s_cmp_eq_u32 s76,0
s_cselect_b32 s76,1,0
v_mov_b64 v[96:97],0
v_mov_b64 v[98:99],0
v_mov_b64 v[100:101],0
v_mov_b64 v[102:103],0
v_mov_b64 v[104:105],0
v_mov_b64 v[106:107],0
v_mov_b64 v[108:109],0
v_mov_b64 v[110:111],0
v_mov_b64 v[112:113],0
v_mov_b64 v[114:115],0
v_mov_b64 v[116:117],0
v_mov_b64 v[118:119],0
v_lshrrev_b32 v56,8,v0
v_lshlrev_b32 v56,5,v56
v_bfe_u32 v57,v0,5,1
v_lshl_add_u32 v56,v57,2,v56
s_lshl_b32 s56,s46,7
s_add_u32 s56,s56,155648
v_add_u32 v56,s56,v56
v_xor_b32 v57,128,v56
v_xor_b32 v58,256,v56
v_xor_b32 v59,384,v56
s_andn2_b32 s56,31,s30
s_lshr_b32 s57,s56,4
s_lshl_b32 s58,s57,12
s_and_b32 s59,s56,15
s_lshl4_add_u32 s58,s59,s58
s_add_u32 s58,s58,s50
s_add_u32 s58,s58,131072
v_bfe_u32 v60,v0,6,2
v_lshlrev_b32 v60,8,v60
v_bfe_u32 v61,v0,4,2
v_lshl_add_u32 v60,v61,2,v60
v_add_u32 v60,s58,v60
s_lshr_b32 s58,s59,2
s_lshl_b32 s58,s58,8
s_lshl3_add_u32 s58,s57,s58
s_and_b32 s59,s56,3
s_lshl1_add_u32 s58,s59,s58
s_add_u32 s58,s58,s73
s_add_u32 s58,s58,139264
v_and_b32 v61,255,v0
v_add_u32 v61,s58,v61
s_cmp_lg_u32 s46,0
s_cbranch_scc1 L_chd_221
s_lshl_b32 s59,s51,10
s_add_u32 s59,s59,11337728
L_chp_220:
buffer_load_dwordx4 v[120:123],v0,s[8:11],s59 offen sc1
s_sub_u32 s49,s49,1
s_cbranch_scc1 L_abort
s_waitcnt vmcnt(0)
v_max3_u32 v124,v120,v121,v122
v_max_u32 v124,v123,v124
v_cmp_eq_u32 vcc,-1,v124
s_cbranch_vccnz L_chp_220
ds_write_b128 v12,v[120:123]
L_chd_221:
s_waitcnt vmcnt(0) lgkmcnt(0)
s_barrier
ds_read2_b32 v[24:25],v56 offset0:0 offset1:2
ds_read2_b32 v[26:27],v56 offset0:4 offset1:6
ds_read2_b32 v[28:29],v57 offset0:0 offset1:2
ds_read2_b32 v[30:31],v57 offset0:4 offset1:6
ds_read2_b32 v[32:33],v58 offset0:0 offset1:2
ds_read2_b32 v[34:35],v58 offset0:4 offset1:6
ds_read2_b32 v[36:37],v59 offset0:0 offset1:2
ds_read2_b32 v[38:39],v59 offset0:4 offset1:6
s_waitcnt lgkmcnt(4)
ds_read2_b32 v[40:41],v56 offset0:128 offset1:130
ds_read2_b32 v[42:43],v56 offset0:132 offset1:134
ds_read2_b32 v[44:45],v57 offset0:128 offset1:130
ds_read2_b32 v[46:47],v57 offset0:132 offset1:134
ds_read2_b32 v[48:49],v58 offset0:128 offset1:130
ds_read2_b32 v[50:51],v58 offset0:132 offset1:134
ds_read2_b32 v[52:53],v59 offset0:128 offset1:130
ds_read2_b32 v[54:55],v59 offset0:132 offset1:134
s_waitcnt lgkmcnt(12)
v_smfmac_f32_16x16x64_bf16 v[100:103],v[24:27],a[128:135],v2
v_smfmac_f32_16x16x64_bf16 v[112:115],v[24:27],v[128:135],v2
v_smfmac_f32_16x16x64_bf16 v[108:111],v[24:27],a[136:143],v2
v_smfmac_f32_16x16x64_bf16 v[116:119],v[24:27],v[136:143],v2
s_waitcnt lgkmcnt(12)
v_smfmac_f32_16x16x64_bf16 v[100:103],v[28:31],a[144:151],v2
v_smfmac_f32_16x16x64_bf16 v[112:115],v[28:31],v[144:151],v2
v_smfmac_f32_16x16x64_bf16 v[108:111],v[28:31],a[152:159],v2
v_smfmac_f32_16x16x64_bf16 v[116:119],v[28:31],v[152:159],v2
s_waitcnt lgkmcnt(10)
v_smfmac_f32_16x16x64_bf16 v[100:103],v[32:35],a[160:167],v2
v_smfmac_f32_16x16x64_bf16 v[112:115],v[32:35],v[160:167],v2
v_smfmac_f32_16x16x64_bf16 v[108:111],v[32:35],a[168:175],v2
v_smfmac_f32_16x16x64_bf16 v[116:119],v[32:35],v[168:175],v2
s_waitcnt lgkmcnt(8)
v_smfmac_f32_16x16x64_bf16 v[100:103],v[36:39],a[176:183],v2
v_smfmac_f32_16x16x64_bf16 v[112:115],v[36:39],v[176:183],v2
v_smfmac_f32_16x16x64_bf16 v[108:111],v[36:39],a[184:191],v2
v_smfmac_f32_16x16x64_bf16 v[116:119],v[36:39],v[184:191],v2
s_waitcnt lgkmcnt(6)
v_smfmac_f32_16x16x64_bf16 v[100:103],v[40:43],a[192:199],v2
v_smfmac_f32_16x16x64_bf16 v[112:115],v[40:43],v[192:199],v2
v_smfmac_f32_16x16x64_bf16 v[108:111],v[40:43],a[200:207],v2
v_smfmac_f32_16x16x64_bf16 v[116:119],v[40:43],v[200:207],v2
s_waitcnt lgkmcnt(4)
v_smfmac_f32_16x16x64_bf16 v[100:103],v[44:47],a[208:215],v2
v_smfmac_f32_16x16x64_bf16 v[112:115],v[44:47],v[208:215],v2
v_smfmac_f32_16x16x64_bf16 v[108:111],v[44:47],a[216:223],v2
v_smfmac_f32_16x16x64_bf16 v[116:119],v[44:47],v[216:223],v2
s_waitcnt lgkmcnt(2)
v_smfmac_f32_16x16x64_bf16 v[100:103],v[48:51],a[224:231],v2
v_smfmac_f32_16x16x64_bf16 v[112:115],v[48:51],v[224:231],v2
v_smfmac_f32_16x16x64_bf16 v[108:111],v[48:51],a[232:239],v2
v_smfmac_f32_16x16x64_bf16 v[116:119],v[48:51],v[232:239],v2
s_waitcnt lgkmcnt(0)
v_smfmac_f32_16x16x64_bf16 v[100:103],v[52:55],a[240:247],v2
v_smfmac_f32_16x16x64_bf16 v[112:115],v[52:55],v[240:247],v2
v_smfmac_f32_16x16x64_bf16 v[108:111],v[52:55],a[248:255],v2
v_smfmac_f32_16x16x64_bf16 v[116:119],v[52:55],v[248:255],v2
v_add_f32 v100,v100,v102
v_add_f32 v112,v112,v114
s_nop 1
v_add_f32 v108,v108,v110
s_nop 2
v_add_f32 v116,v116,v118
v_cvt_pk_bf16_f32 v120,v100,v108
v_cvt_pk_bf16_f32 v121,v112,v116
ds_write_b32 v60,v120
ds_write_b16 v61,v121
ds_write_b16_d16_hi v61,v121 offset:1024
v_mov_b64 v[96:97],0
v_mov_b64 v[98:99],0
v_mov_b64 v[100:101],0
v_mov_b64 v[102:103],0
v_mov_b64 v[104:105],0
v_mov_b64 v[106:107],0
v_mov_b64 v[108:109],0
v_mov_b64 v[110:111],0
v_mov_b64 v[112:113],0
v_mov_b64 v[114:115],0
v_mov_b64 v[116:117],0
v_mov_b64 v[118:119],0
s_waitcnt vmcnt(0) lgkmcnt(0)
s_barrier
v_add_u32 v55,131072,v0
ds_read_b128 v[56:59],v55 offset:0
ds_read_b128 v[60:63],v55 offset:4096
ds_read_b128 v[64:67],v55 offset:1024
ds_read_b128 v[68:71],v55 offset:5120
ds_read_b128 v[72:75],v55 offset:2048
ds_read_b128 v[76:79],v55 offset:6144
ds_read_b128 v[80:83],v55 offset:3072
ds_read_b128 v[84:87],v55 offset:7168
v_add_u32 v123,s73,v55
ds_read_b128 v[88:91],v123 offset:8192
ds_read_b128 v[92:95],v123 offset:9216
v_xor_b32 v120,1024,v12
v_xor_b32 v121,2048,v12
v_xor_b32 v122,3072,v12
buffer_load_dwordx4 v[24:27],v13,s[8:11],s64 offen sc1
buffer_load_dwordx4 v[24:27],v13,s[8:11],s64 offen sc1
.p2align 6
L_chain_222:
L_cpa_223:
buffer_load_dwordx4 v[24:27],v13,s[8:11],s64 offen sc1
s_sub_u32 s49,s49,1
s_cbranch_scc1 L_abort
s_waitcnt vmcnt(2)
v_max3_u32 v123,v24,v25,v26
v_max_u32 v123,v27,v123
v_cmp_le_u32 vcc,s72,v123
ds_write_b128 v12,v[24:27] offset:0
s_cbranch_vccnz L_cpa_223
L_cgo_226:
v_smfmac_f32_16x16x64_bf16 v[96:99],v[24:27],a[0:7],v2
buffer_load_dwordx4 v[40:43],v13,s[8:11],s70 offen sc1
s_waitcnt lgkmcnt(0)
s_barrier
ds_read_b128 v[28:31],v120 offset:0
v_smfmac_f32_16x16x64_bf16 v[100:103],v[24:27],a[128:135],v2
ds_read_b128 v[32:35],v121 offset:0
v_smfmac_f32_16x16x64_bf16 v[104:107],v[24:27],a[8:15],v2
ds_read_b128 v[36:39],v122 offset:0
v_smfmac_f32_16x16x64_bf16 v[108:111],v[24:27],a[136:143],v2
v_smfmac_f32_16x16x64_bf16 v[112:115],v[24:27],v[128:135],v2
v_smfmac_f32_16x16x64_bf16 v[116:119],v[24:27],v[136:143],v2
s_waitcnt lgkmcnt(2)
v_smfmac_f32_16x16x64_bf16 v[96:99],v[28:31],a[16:23],v2
s_add_u32 m0,s73,131072
v_smfmac_f32_16x16x64_bf16 v[100:103],v[28:31],a[144:151],v2
s_add_u32 s57,s67,8192
v_smfmac_f32_16x16x64_bf16 v[104:107],v[28:31],a[24:31],v2
s_cmp_lt_u32 s19,s76
s_cbranch_scc1 L_ckw_212
L_ckb_213:
v_smfmac_f32_16x16x64_bf16 v[108:111],v[28:31],a[152:159],v2
s_waitcnt vmcnt(0) lgkmcnt(1)
v_smfmac_f32_16x16x64_bf16 v[96:99],v[32:35],a[32:39],v2
ds_write_b128 v12,v[40:43] offset:4096
v_max3_u32 v123,v40,v41,v42
v_smfmac_f32_16x16x64_bf16 v[100:103],v[32:35],a[160:167],v2
v_max_u32 v123,v43,v123
v_smfmac_f32_16x16x64_bf16 v[104:107],v[32:35],a[40:47],v2
v_cmp_le_u32 vcc,s72,v123
v_smfmac_f32_16x16x64_bf16 v[108:111],v[32:35],a[168:175],v2
v_smfmac_f32_16x16x64_bf16 v[112:115],v[28:31],v[144:151],v2
s_cbranch_vccnz L_cpb_229
L_cback_231:
s_waitcnt lgkmcnt(0)
s_barrier
v_smfmac_f32_16x16x64_bf16 v[96:99],v[36:39],a[48:55],v2
buffer_load_dword v23,v22,s[8:11],s75 offen sc1
v_smfmac_f32_16x16x64_bf16 v[100:103],v[36:39],a[176:183],v2
ds_read_b128 v[44:47],v120 offset:4096
v_smfmac_f32_16x16x64_bf16 v[104:107],v[36:39],a[56:63],v2
buffer_load_dwordx4 v0,s[8:11],s67 offen sc1 lds
v_smfmac_f32_16x16x64_bf16 v[108:111],v[36:39],a[184:191],v2
ds_read_b128 v[48:51],v121 offset:4096
v_smfmac_f32_16x16x64_bf16 v[96:99],v[40:43],a[64:71],v2
buffer_store_dwordx4 v[124:127],v0,s[8:11],s54 offen sc1
v_smfmac_f32_16x16x64_bf16 v[100:103],v[40:43],a[192:199],v2
ds_read_b128 v[52:55],v122 offset:4096
v_smfmac_f32_16x16x64_bf16 v[104:107],v[40:43],a[72:79],v2
buffer_load_dwordx4 v0,s[8:11],s67 offen offset:1024 sc1 lds
s_add_u32 m0,s73,139264
v_smfmac_f32_16x16x64_bf16 v[108:111],v[40:43],a[200:207],v2
ds_read_b32 v123,v8 offset:2560
s_waitcnt lgkmcnt(3)
v_smfmac_f32_16x16x64_bf16 v[96:99],v[44:47],a[80:87],v2
buffer_load_dwordx4 v0,s[8:11],s57 offen sc1 lds
s_add_u32 s67,s67,786432
v_smfmac_f32_16x16x64_bf16 v[100:103],v[44:47],a[208:215],v2
s_waitcnt lgkmcnt(2)
v_smfmac_f32_16x16x64_bf16 v[96:99],v[48:51],a[96:103],v2
buffer_load_dwordx4 v0,s[8:11],s57 offen offset:1024 sc1 lds
v_smfmac_f32_16x16x64_bf16 v[100:103],v[48:51],a[224:231],v2
s_waitcnt lgkmcnt(0)
v_smfmac_f32_16x16x64_bf16 v[96:99],v[52:55],a[112:119],v2
v_smfmac_f32_16x16x64_bf16 v[100:103],v[52:55],a[240:247],v2
v_readfirstlane_b32 s58,v123
v_smfmac_f32_16x16x64_bf16 v[104:107],v[44:47],a[88:95],v2
v_smfmac_f32_16x16x64_bf16 v[108:111],v[44:47],a[216:223],v2
s_cmp_lg_u32 s58,0
s_cbranch_scc1 L_cjump_215
v_smfmac_f32_16x16x64_bf16 v[104:107],v[48:51],a[104:111],v2
v_add_f32 v96,v96,v98
v_smfmac_f32_16x16x64_bf16 v[108:111],v[48:51],a[232:239],v2
v_add_f32 v97,v97,v99
v_smfmac_f32_16x16x64_bf16 v[104:107],v[52:55],a[120:127],v2
v_cvt_pk_bf16_f32 v120,v96,v97
v_smfmac_f32_16x16x64_bf16 v[108:111],v[52:55],a[248:255],v2
v_add_f32 v100,v100,v102
v_smfmac_f32_16x16x64_bf16 v[116:119],v[28:31],v[152:159],v2
v_add_f32 v101,v101,v103
v_smfmac_f32_16x16x64_bf16 v[112:115],v[32:35],v[160:167],v2
v_cvt_pk_bf16_f32 v121,v100,v101
v_add_f32 v104,v104,v106
v_add_f32 v105,v105,v107
v_cvt_pk_bf16_f32 v122,v104,v105
v_add_f32 v108,v108,v110
v_add_f32 v109,v109,v111
v_cvt_pk_bf16_f32 v123,v108,v109
ds_write_b128 v4,v[120:123]
v_smfmac_f32_16x16x64_bf16 v[116:119],v[32:35],v[168:175],v2
s_mov_b32 s54,s68
s_add_u32 s68,s68,131072
v_mov_b32 v125,0
v_smfmac_f32_16x16x64_bf16 v[112:115],v[36:39],v[176:183],v2
s_cmp_eq_u32 s51,63
s_cbranch_scc1 L_cend_225
v_smfmac_f32_16x16x64_bf16 v[116:119],v[36:39],v[184:191],v2
s_waitcnt lgkmcnt(0)
s_barrier
ds_read_b64_tr_b16 v[96:97],v5 offset:0
v_smfmac_f32_16x16x64_bf16 v[112:115],v[40:43],v[192:199],v2
ds_read_b64_tr_b16 v[98:99],v6 offset:0
v_smfmac_f32_16x16x64_bf16 v[116:119],v[40:43],v[200:207],v2
ds_read_b64_tr_b16 v[100:101],v5 offset:1024
v_smfmac_f32_16x16x64_bf16 v[112:115],v[44:47],v[208:215],v2
ds_read_b64_tr_b16 v[102:103],v6 offset:1024
v_smfmac_f32_16x16x64_bf16 v[116:119],v[44:47],v[216:223],v2
ds_read_b64_tr_b16 v[104:105],v5 offset:2048
v_smfmac_f32_16x16x64_bf16 v[112:115],v[48:51],v[224:231],v2
ds_read_b64_tr_b16 v[106:107],v6 offset:2048
s_waitcnt lgkmcnt(4)
v_mfma_f32_16x16x32_bf16 v[24:27],v[56:59],v[96:99],0
ds_read_b64_tr_b16 v[108:109],v5 offset:3072
v_mfma_f32_16x16x32_bf16 v[28:31],v[60:63],v[96:99],0
ds_read_b64_tr_b16 v[110:111],v6 offset:3072
v_mfma_f32_16x16x32_bf16 v[32:35],v[96:99],v[96:99],0
ds_read_b128 v[40:43],v11 offset:12288
s_waitcnt lgkmcnt(5)
v_mfma_f32_16x16x32_bf16 v[24:27],v[64:67],v[100:103],v[24:27]
ds_read_b128 v[56:59],v11 offset:0
v_mfma_f32_16x16x32_bf16 v[28:31],v[68:71],v[100:103],v[28:31]
ds_read_b128 v[60:63],v11 offset:1024
v_mfma_f32_16x16x32_bf16 v[32:35],v[100:103],v[100:103],v[32:35]
ds_read_b128 v[96:99],v11 offset:8192
s_waitcnt lgkmcnt(6)
v_mfma_f32_16x16x32_bf16 v[24:27],v[72:75],v[104:107],v[24:27]
ds_read_b128 v[64:67],v11 offset:2048
v_mfma_f32_16x16x32_bf16 v[28:31],v[76:79],v[104:107],v[28:31]
ds_read_b128 v[68:71],v11 offset:3072
v_mfma_f32_16x16x32_bf16 v[32:35],v[104:107],v[104:107],v[32:35]
ds_read_b128 v[100:103],v11 offset:9216
s_waitcnt lgkmcnt(7)
v_mfma_f32_16x16x32_bf16 v[24:27],v[80:83],v[108:111],v[24:27]
ds_read_b128 v[72:75],v11 offset:4096
v_mfma_f32_16x16x32_bf16 v[28:31],v[84:87],v[108:111],v[28:31]
ds_read_b128 v[76:79],v11 offset:5120
v_mfma_f32_16x16x32_bf16 v[32:35],v[108:111],v[108:111],v[32:35]
ds_read_b128 v[104:107],v11 offset:10240
v_smfmac_f32_16x16x64_bf16 v[116:119],v[48:51],v[232:239],v2
ds_read_b128 v[80:83],v11 offset:6144
v_smfmac_f32_16x16x64_bf16 v[112:115],v[52:55],v[240:247],v2
ds_read_b128 v[84:87],v11 offset:7168
v_smfmac_f32_16x16x64_bf16 v[116:119],v[52:55],v[248:255],v2
ds_read_b128 v[108:111],v11 offset:11264
v_max3_f32 v126,v24,v25,v26
v_max3_f32 v127,v27,v28,v29
v_max3_f32 v126,v30,v31,v126
v_max3_f32 v127,v34,v35,v127
v_max_f32 v126,v126,v127
v_max_f32 v127,v126,v127
v_pk_mul_f32 v[34:35],v[34:35],v[0:1] op_sel:[0,1]
v_pk_mul_f32 v[24:25],v[24:25],v[0:1] op_sel:[0,1]
v_permlane16_swap_b32 v126,v127
v_max_f32 v126,v126,v127
v_max_f32 v127,v126,v127
v_pk_add_f32 v[112:113],v[112:113],v[114:115]
v_pk_add_f32 v[116:117],v[116:117],v[118:119]
v_permlane32_swap_b32 v126,v127
v_max_f32 v126,v126,v127
v_mul_f32 v126,v1,v126
v_pk_add_f32 v[34:35],v[34:35],v[126:127] op_sel_hi:[1,0] neg_lo:[0,1] neg_hi:[0,1]
v_pk_add_f32 v[24:25],v[24:25],v[126:127] op_sel_hi:[1,0] neg_lo:[0,1] neg_hi:[0,1]
v_pk_fma_f32 v[26:27],v[26:27],v[0:1],v[126:127] op_sel:[0,1,0] op_sel_hi:[1,1,0] neg_lo:[0,0,1] neg_hi:[0,0,1]
v_pk_fma_f32 v[28:29],v[28:29],v[0:1],v[126:127] op_sel:[0,1,0] op_sel_hi:[1,1,0] neg_lo:[0,0,1] neg_hi:[0,0,1]
v_pk_fma_f32 v[30:31],v[30:31],v[0:1],v[126:127] op_sel:[0,1,0] op_sel_hi:[1,1,0] neg_lo:[0,0,1] neg_hi:[0,0,1]
v_exp_f32 v34,v34
v_exp_f32 v35,v35
v_cvt_pk_bf16_f32 v126,v112,v113
v_cvt_pk_bf16_f32 v124,v34,v35
v_cvt_pk_bf16_f32 v127,v116,v117
v_cvt_pk_bf16_f32 v36,v116,v117
v_mfma_f32_16x16x16_bf16 v[32:35],v[14:15],v[124:125],0
ds_read_b128 v[44:47],v11 offset:13312
v_exp_f32 v24,v24
v_mfma_f32_16x16x16_bf16 v[112:115],v[126:127],v[124:125],0
ds_read_b128 v[48:51],v11 offset:14336
v_exp_f32 v25,v25
v_mfma_f32_16x16x16_bf16 v[116:119],v[36:37],v[124:125],0
ds_read_b128 v[52:55],v11 offset:15360
v_exp_f32 v26,v26
v_exp_f32 v27,v27
v_cvt_pk_bf16_f32 v120,v24,v25
v_exp_f32 v28,v28
v_exp_f32 v29,v29
v_cvt_pk_bf16_f32 v121,v26,v27
v_exp_f32 v30,v30
v_exp_f32 v31,v31
v_cvt_pk_bf16_f32 v122,v28,v29
v_cvt_pk_bf16_f32 v123,v30,v31
s_add_u32 s75,s75,8192
s_add_u32 s51,s51,1
v_mfma_f32_16x16x32_bf16 v[32:35],v[14:17],v[120:123],v[32:35]
v_mfma_f32_16x16x32_bf16 v[112:115],v[88:91],v[120:123],v[112:115]
ds_read_b128 v[88:91],v11 offset:16384
v_mfma_f32_16x16x32_bf16 v[116:119],v[92:95],v[120:123],v[116:119]
ds_read_b128 v[92:95],v11 offset:17408
v_rcp_f32 v32,v32
v_mov_b64 v[24:25],-1
v_mov_b64 v[26:27],-1
s_add_u32 s64,s75,13631488
s_add_u32 s70,s64,4096
v_pk_mul_f32 v[112:113],v[112:113],v[32:33] op_sel_hi:[1,0]
v_pk_mul_f32 v[114:115],v[114:115],v[32:33] op_sel_hi:[1,0]
v_pk_mul_f32 v[116:117],v[116:117],v[32:33] op_sel_hi:[1,0]
v_pk_mul_f32 v[118:119],v[118:119],v[32:33] op_sel_hi:[1,0]
v_cvt_pk_bf16_f32 v120,v112,v116
v_cvt_pk_bf16_f32 v121,v113,v117
v_cvt_pk_bf16_f32 v122,v114,v118
v_cvt_pk_bf16_f32 v123,v115,v119
ds_write_b128 v7,v[120:123]
buffer_store_dwordx4 v[24:27],v0,s[8:11],s69 offen
buffer_store_dwordx4 v[24:27],v0,s[8:11],s69 offen offset:1024
v_mov_b64 v[112:113],0
v_mov_b64 v[114:115],0
v_mov_b64 v[116:117],0
v_mov_b64 v[118:119],0
s_waitcnt lgkmcnt(0)
s_barrier
ds_read_b128 v[24:27],v8 offset:0
ds_read_b128 v[28:31],v8 offset:512
ds_read_b128 v[32:35],v8 offset:1024
ds_read_b128 v[36:39],v8 offset:1536
v_mov_b64 v[120:121],0
v_mov_b64 v[122:123],0
s_add_u32 s57,s65,65536
s_add_u32 s58,s65,131072
s_add_u32 s59,s65,196608
s_add_u32 s56,s18,s75
s_waitcnt lgkmcnt(3)
v_smfmac_f32_16x16x64_bf16 v[112:115],v[24:27],v[56:63],v3
ds_read_b128 v[56:59],v11 offset:18432
s_waitcnt lgkmcnt(3)
v_smfmac_f32_16x16x64_bf16 v[112:115],v[28:31],v[64:71],v3
ds_read_b128 v[60:63],v11 offset:19456
s_waitcnt lgkmcnt(3)
v_smfmac_f32_16x16x64_bf16 v[112:115],v[32:35],v[72:79],v3
ds_read_b128 v[64:67],v11 offset:20480
s_waitcnt lgkmcnt(3)
v_smfmac_f32_16x16x64_bf16 v[112:115],v[36:39],v[80:87],v3
ds_read_b128 v[68:71],v11 offset:21504
v_smfmac_f32_16x16x64_bf16 v[116:119],v[24:27],v[96:103],v3
ds_read_b128 v[72:75],v11 offset:22528
v_smfmac_f32_16x16x64_bf16 v[116:119],v[28:31],v[104:111],v3
ds_read_b128 v[76:79],v11 offset:23552
v_cvt_pk_bf16_f32 v112,v112,v113
v_smfmac_f32_16x16x64_bf16 v[116:119],v[32:35],v[40:47],v3
ds_read_b128 v[80:83],v11 offset:24576
v_cvt_pk_bf16_f32 v113,v114,v115
buffer_store_dwordx2 v[112:113],v9,s[8:11],s65 offen
v_smfmac_f32_16x16x64_bf16 v[116:119],v[36:39],v[48:55],v3
ds_read_b128 v[84:87],v11 offset:25600
v_mov_b64 v[112:113],0
v_smfmac_f32_16x16x64_bf16 v[120:123],v[24:27],v[88:95],v3
ds_read_b128 v[96:99],v11 offset:26624
ds_read_b128 v[100:103],v11 offset:27648
v_mov_b64 v[114:115],0
s_waitcnt lgkmcnt(8)
v_smfmac_f32_16x16x64_bf16 v[120:123],v[28:31],v[56:63],v3
ds_read_b128 v[104:107],v11 offset:28672
v_cvt_pk_bf16_f32 v116,v116,v117
s_waitcnt lgkmcnt(7)
v_smfmac_f32_16x16x64_bf16 v[120:123],v[32:35],v[64:71],v3
ds_read_b128 v[108:111],v11 offset:29696
ds_read_b128 v[40:43],v11 offset:30720
v_cvt_pk_bf16_f32 v117,v118,v119
buffer_store_dwordx2 v[116:117],v9,s[8:11],s57 offen
s_waitcnt lgkmcnt(7)
v_smfmac_f32_16x16x64_bf16 v[120:123],v[36:39],v[72:79],v3
ds_read_b128 v[44:47],v11 offset:31744
v_add_u32 v52,s50,v5
s_waitcnt lgkmcnt(6)
v_smfmac_f32_16x16x64_bf16 v[112:115],v[24:27],v[80:87],v3
v_add_u32 v54,s50,v6
s_waitcnt lgkmcnt(4)
v_smfmac_f32_16x16x64_bf16 v[112:115],v[28:31],v[96:103],v3
ds_read_b64_tr_b16 v[52:53],v52
v_cvt_pk_bf16_f32 v120,v120,v121
s_waitcnt lgkmcnt(3)
v_smfmac_f32_16x16x64_bf16 v[112:115],v[32:35],v[104:111],v3
ds_read_b64_tr_b16 v[54:55],v54
v_cvt_pk_bf16_f32 v121,v122,v123
buffer_store_dwordx2 v[120:121],v9,s[8:11],s58 offen
s_waitcnt lgkmcnt(2)
v_smfmac_f32_16x16x64_bf16 v[112:115],v[36:39],v[40:47],v3
v_mov_b64 v[116:117],0
v_mov_b64 v[118:119],0
s_xor_b32 s65,s65,262144
v_mov_b32_dpp v124,v126 quad_perm:[2,3,2,3] row_mask:0xf bank_mask:0xf
v_mov_b32_dpp v125,v127 quad_perm:[2,3,2,3] row_mask:0xf bank_mask:0xf
s_mov_b32 vcc_lo,0xcccccccc
s_mov_b32 vcc_hi,0xcccccccc
s_nop 0
v_cvt_pk_bf16_f32 v112,v112,v113
v_cvt_pk_bf16_f32 v113,v114,v115
buffer_store_dwordx2 v[112:113],v9,s[8:11],s59 offen
s_waitcnt lgkmcnt(0)
s_buffer_load_dword s19,s[8:11],s56
v_cndmask_b32 v124,v124,v52,vcc
v_cndmask_b32 v125,v125,v53,vcc
s_cmp_lt_u32 s46,2
s_waitcnt vmcnt(3)
s_cbranch_scc1 L_crg_232
s_cmp_eq_u32 s46,2
s_waitcnt vmcnt(1)
s_cbranch_scc1 L_crg_232
s_waitcnt vmcnt(0)
L_crg_232:
buffer_load_dwordx4 v[32:35],v0,s[8:11],s66 offen offset:0 sc1
buffer_load_dwordx4 v[36:39],v0,s[8:11],s66 offen offset:1024 sc1
v_cndmask_b32 v126,v126,v54,vcc
v_cndmask_b32 v127,v127,v55,vcc
v_mov_b64 v[96:97],0
v_mov_b64 v[98:99],0
v_mov_b64 v[100:101],0
v_mov_b64 v[102:103],0
v_mov_b64 v[104:105],0
v_mov_b64 v[106:107],0
v_mov_b64 v[108:109],0
v_mov_b64 v[110:111],0
v_mov_b64 v[112:113],0
v_mov_b64 v[114:115],0
v_add_u32 v55,131072,v0
v_add_u32 v123,s73,v55
v_xor_b32 v120,1024,v12
v_xor_b32 v121,2048,v12
v_xor_b32 v122,3072,v12
buffer_load_dwordx4 v[44:47],v0,s[8:11],s66 offen offset:0 sc1
buffer_load_dwordx4 v[48:51],v0,s[8:11],s66 offen offset:1024 sc1
s_cmp_ge_u32 s51,63
s_cselect_b32 s76,0,1
v_readlane_b32 s56,v23,5
v_readlane_b32 s20,v23,4
v_add_u32 v23,-1,v23
v_cmp_le_u32 vcc,s30,v23
s_cmp_gt_u32 s51,61
s_cselect_b32 s77,0,vcc_hi
s_cmp_gt_u32 s20,s30
s_cselect_b32 s77,1,s77
s_cmp_lg_u32 s77,0
s_cselect_b32 s76,2,s76
s_cmp_gt_u32 s56,s30
s_cbranch_scc1 L_cld_208
L_clb_209:
s_cmp_eq_u32 s46,0
s_cselect_b32 s76,s76,0
s_waitcnt vmcnt(3)
v_mfma_f32_16x16x32_bf16 v[28:31],v[18:21],v[32:35],0
s_waitcnt vmcnt(2)
v_mfma_f32_16x16x32_bf16 v[28:31],v[18:21],v[36:39],v[28:31]
s_nop 7
v_cmp_u_f32 vcc,v28,v28
v_add_f32_dpp v52,v28,v28 row_ror:8 row_mask:0xf bank_mask:0x3
v_add_f32_dpp v53,v29,v29 row_ror:8 row_mask:0xf bank_mask:0x3
v_add_f32_dpp v52,v30,v30 row_ror:8 row_mask:0xf bank_mask:0xc
v_add_f32_dpp v53,v31,v31 row_ror:8 row_mask:0xf bank_mask:0xc
s_cbranch_vccnz L_crp_227
L_cok_233:
v_add_f32_dpp v52,v52,v52 row_shl:4 row_mask:0xf bank_mask:0x5
v_add_f32_dpp v53,v53,v53 row_shl:4 row_mask:0xf bank_mask:0x5
v_cvt_pk_bf16_f32 v54,v52,v53
buffer_store_dword v54,v10,s[8:11],s64 offen
s_mov_b32 s69,s66
s_xor_b32 s66,s66,262144
s_barrier
ds_read_b128 v[56:59],v55 offset:0
ds_read_b128 v[60:63],v55 offset:4096
ds_read_b128 v[64:67],v55 offset:1024
buffer_load_dwordx4 v[24:27],v13,s[8:11],s64 offen sc1
ds_read_b128 v[68:71],v55 offset:5120
ds_read_b128 v[72:75],v55 offset:2048
ds_read_b128 v[76:79],v55 offset:6144
ds_read_b128 v[80:83],v55 offset:3072
buffer_load_dwordx4 v[24:27],v13,s[8:11],s64 offen sc1
ds_read_b128 v[84:87],v55 offset:7168
ds_read_b128 v[88:91],v123 offset:8192
ds_read_b128 v[92:95],v123 offset:9216
s_branch L_chain_222
L_cpb_229:
buffer_load_dwordx4 v[40:43],v13,s[8:11],s70 offen sc1
s_sub_u32 s49,s49,1
s_cbranch_scc1 L_abort
s_waitcnt vmcnt(0)
v_max3_u32 v123,v40,v41,v42
v_max_u32 v123,v43,v123
v_cmp_le_u32 vcc,s72,v123
s_cbranch_vccnz L_cpb_229
ds_write_b128 v12,v[40:43] offset:4096
s_branch L_cback_231
L_crp_227:
buffer_load_dwordx4 v[32:35],v0,s[8:11],s66 offen offset:0 sc1
buffer_load_dwordx4 v[36:39],v0,s[8:11],s66 offen offset:1024 sc1
s_sub_u32 s49,s49,1
s_cbranch_scc1 L_abort
s_waitcnt vmcnt(3)
v_mfma_f32_16x16x32_bf16 v[28:31],v[18:21],v[44:47],0
s_waitcnt vmcnt(2)
v_mfma_f32_16x16x32_bf16 v[28:31],v[18:21],v[48:51],v[28:31]
s_nop 7
v_cmp_u_f32 vcc,v28,v28
v_add_f32_dpp v52,v28,v28 row_ror:8 row_mask:0xf bank_mask:0x3
v_add_f32_dpp v53,v29,v29 row_ror:8 row_mask:0xf bank_mask:0x3
v_add_f32_dpp v52,v30,v30 row_ror:8 row_mask:0xf bank_mask:0xc
v_add_f32_dpp v53,v31,v31 row_ror:8 row_mask:0xf bank_mask:0xc
s_cbranch_vccz L_cok_233
buffer_load_dwordx4 v[44:47],v0,s[8:11],s66 offen offset:0 sc1
buffer_load_dwordx4 v[48:51],v0,s[8:11],s66 offen offset:1024 sc1
s_sub_u32 s49,s49,1
s_cbranch_scc1 L_abort
s_waitcnt vmcnt(3)
v_mfma_f32_16x16x32_bf16 v[28:31],v[18:21],v[32:35],0
s_waitcnt vmcnt(2)
v_mfma_f32_16x16x32_bf16 v[28:31],v[18:21],v[36:39],v[28:31]
s_nop 7
v_cmp_u_f32 vcc,v28,v28
v_add_f32_dpp v52,v28,v28 row_ror:8 row_mask:0xf bank_mask:0x3
v_add_f32_dpp v53,v29,v29 row_ror:8 row_mask:0xf bank_mask:0x3
v_add_f32_dpp v52,v30,v30 row_ror:8 row_mask:0xf bank_mask:0xc
v_add_f32_dpp v53,v31,v31 row_ror:8 row_mask:0xf bank_mask:0xc
s_cbranch_vccz L_cok_233
s_branch L_crp_227
L_ckw_212:
s_cmp_eq_u32 s77,0
s_cbranch_scc1 L_cjw_214
s_cmp_gt_u32 s20,s30
s_cbranch_scc1 L_cjs_210
s_add_u32 s31,s51,2
s_lshl_b32 s59,s31,13
s_add_u32 s59,s59,10486016
v_lshrrev_b32 v45,2,v0
v_and_b32 v45,127,v45
L_ckk_234:
s_sleep 1
buffer_load_dword v44,v45,s[8:11],s59 offen sc1
s_sub_u32 s49,s49,1
s_cbranch_scc1 L_abort
s_waitcnt vmcnt(0)
v_cmp_eq_u32 vcc,0,v44
s_cbranch_vccnz L_ckk_234
v_cmp_lt_u32 vcc,s30,v44
s_cbranch_vccz L_cjw_214
v_max_u32_dpp v44,v44,v44 row_ror:8 row_mask:0xf bank_mask:0xf
s_nop 1
v_max_u32_dpp v44,v44,v44 row_ror:4 row_mask:0xf bank_mask:0xf
s_nop 1
v_max_u32_dpp v44,v44,v44 row_ror:2 row_mask:0xf bank_mask:0xf
s_nop 1
v_max_u32_dpp v44,v44,v44 row_ror:1 row_mask:0xf bank_mask:0xf
v_mov_b32 v45,v44
s_nop 1
v_permlane16_swap_b32 v44,v45
v_max_u32 v44,v44,v45
v_mov_b32 v45,v44
s_nop 1
v_permlane32_swap_b32 v44,v45
v_max_u32 v44,v44,v45
s_nop 0
v_readfirstlane_b32 s20,v44
L_cjs_210:
s_mov_b32 s30,s20
s_andn2_b32 s31,0x7ff,s20
s_lshr_b32 s31,s31,5
s_add_u32 s31,s31,1
s_min_u32 s31,s31,63
ds_write_b32 v8,v2 offset:2560
s_waitcnt lgkmcnt(0)
s_branch L_ckb_213
L_cld_208:
v_mov_b32 v23,s56
s_add_u32 s56,s75,10495616
buffer_store_dword v23,off,s[8:11],s56
s_waitcnt vmcnt(0)
s_branch L_clb_209
L_cjw_214:
s_cmp_lg_u32 s19,0
s_cbranch_scc1 L_ckb_213
s_add_u32 s59,s18,s75
L_ww_235:
s_sleep 1
buffer_load_dword v23,off,s[8:11],s59 sc1
s_sub_u32 s49,s49,1
s_cbranch_scc1 L_abort
s_waitcnt vmcnt(0)
v_readfirstlane_b32 s76,v23
s_cmp_eq_u32 s76,0
s_cbranch_scc1 L_ww_235
L_wwd_236:
s_branch L_ckb_213
L_cjump_215:
s_waitcnt vmcnt(0) lgkmcnt(0)
s_barrier
s_branch L_cst_211
L_cend_225:
v_smfmac_f32_16x16x64_bf16 v[116:119],v[36:39],v[184:191],v2
v_smfmac_f32_16x16x64_bf16 v[112:115],v[40:43],v[192:199],v2
v_smfmac_f32_16x16x64_bf16 v[116:119],v[40:43],v[200:207],v2
v_smfmac_f32_16x16x64_bf16 v[112:115],v[44:47],v[208:215],v2
v_smfmac_f32_16x16x64_bf16 v[116:119],v[44:47],v[216:223],v2
v_smfmac_f32_16x16x64_bf16 v[112:115],v[48:51],v[224:231],v2
v_smfmac_f32_16x16x64_bf16 v[116:119],v[48:51],v[232:239],v2
v_smfmac_f32_16x16x64_bf16 v[112:115],v[52:55],v[240:247],v2
v_smfmac_f32_16x16x64_bf16 v[116:119],v[52:55],v[248:255],v2
s_waitcnt lgkmcnt(0)
s_nop 2
v_pk_add_f32 v[112:113],v[112:113],v[114:115]
s_nop 2
v_pk_add_f32 v[116:117],v[116:117],v[118:119]
v_cvt_pk_bf16_f32 v126,v112,v113
v_cvt_pk_bf16_f32 v127,v116,v117
v_add_u32 v52,s50,v5
v_add_u32 v54,s50,v6
ds_read_b64_tr_b16 v[52:53],v52
ds_read_b64_tr_b16 v[54:55],v54
v_mov_b32_dpp v124,v126 quad_perm:[2,3,2,3] row_mask:0xf bank_mask:0xf
v_mov_b32_dpp v125,v127 quad_perm:[2,3,2,3] row_mask:0xf bank_mask:0xf
s_mov_b32 vcc_lo,0xcccccccc
s_mov_b32 vcc_hi,0xcccccccc
s_waitcnt lgkmcnt(0)
v_cndmask_b32 v124,v124,v52,vcc
v_cndmask_b32 v125,v125,v53,vcc
v_cndmask_b32 v126,v126,v54,vcc
v_cndmask_b32 v127,v127,v55,vcc
buffer_store_dwordx4 v[124:127],v0,s[8:11],s54 offen sc1
s_mov_b32 s51,64
s_waitcnt vmcnt(0)
s_barrier
s_nop 11
v_lshrrev_b32 v1,4,v0
s_endpgm
L_abort2:
s_endpgm
L_wc:
s_nop 11
s_cmp_eq_u32 s48,1
s_cbranch_scc1 L_rc1_237
s_cmp_eq_u32 s48,2
s_cbranch_scc1 L_rc2_238
v_and_b32 v120,15,v1
v_lshrrev_b32 v121,4,v1
v_and_b32 v122,2,v1
v_cmp_eq_u32 vcc,0,v122
v_mov_b32 v2,0xeeee
v_mov_b32 v123,0x4444
v_cndmask_b32 v2,v2,v123,vcc
v_and_b32 v122,1,v1
v_cmp_eq_u32 vcc,0,v122
v_mov_b32 v3,0xdddd
v_mov_b32 v123,0x8888
v_cndmask_b32 v3,v3,v123,vcc
v_lshrrev_b32 v122,1,v120
v_bfe_u32 v123,v120,2,1
v_xor_b32 v123,v123,v122
v_lshlrev_b32 v4,7,v123
v_and_b32 v123,1,v120
v_lshl_add_u32 v4,v123,6,v4
v_xor_b32 v123,v121,v122
v_and_b32 v123,3,v123
v_lshl_add_u32 v4,v123,4,v4
s_lshl_b32 s56,s46,10
s_add_u32 s56,s56,147456
v_add_u32 v4,s56,v4
v_lshlrev_b32 v122,1,v121
v_add_u32 v122,0,v122
v_and_b32 v123,1,v121
v_xor_b32 v123,v123,v122
v_lshlrev_b32 v5,7,v123
v_bfe_u32 v123,v120,3,1
v_lshl_add_u32 v5,v123,6,v5
v_xor_b32 v123,v120,v122
v_and_b32 v123,3,v123
v_lshl_add_u32 v5,v123,4,v5
v_bfe_u32 v123,v120,2,1
v_lshl_add_u32 v5,v123,3,v5
v_add_u32 v5,147456,v5
v_lshlrev_b32 v122,1,v121
v_add_u32 v122,1,v122
v_and_b32 v123,1,v121
v_xor_b32 v123,v123,v122
v_lshlrev_b32 v6,7,v123
v_bfe_u32 v123,v120,3,1
v_lshl_add_u32 v6,v123,6,v6
v_xor_b32 v123,v120,v122
v_and_b32 v123,3,v123
v_lshl_add_u32 v6,v123,4,v6
v_bfe_u32 v123,v120,2,1
v_lshl_add_u32 v6,v123,3,v6
v_add_u32 v6,147456,v6
v_lshlrev_b32 v7,7,v121
v_lshrrev_b32 v122,1,v120
v_lshl_add_u32 v8,v122,4,v7
v_add_u32 v8,151552,v8
v_lshrrev_b32 v122,2,v120
v_lshl_add_u32 v7,v122,5,v7
v_and_b32 v122,1,v120
v_lshl_add_u32 v7,v122,4,v7
v_and_b32 v122,2,v120
v_cmp_eq_u32 vcc,0,v122
s_lshl_b32 s56,s46,9
v_mov_b32 v122,2048
v_mov_b32 v123,s56
v_cndmask_b32 v122,v122,v123,vcc
v_add_u32 v7,v122,v7
v_add_u32 v7,151552,v7
v_lshrrev_b32 v122,3,v1
v_lshlrev_b32 v9,11,v122
v_and_b32 v122,7,v1
v_lshl_add_u32 v9,v122,3,v9
s_lshl_b32 s56,s46,14
s_lshl_b32 s57,s47,6
s_add_u32 s56,s56,s57
v_add_u32 v9,s56,v9
s_lshl_b32 s71,s46,5
s_add_u32 s71,s71,s47
s_bfe_u32 s56,s71,0x10003
s_lshl_b32 s56,s56,11
s_and_b32 s57,s71,1
s_lshl_b32 s57,s57,10
s_add_u32 s56,s56,s57
s_bfe_u32 s57,s71,0x10002
s_lshl_b32 s57,s57,9
s_add_u32 s56,s56,s57
s_bfe_u32 s57,s71,0x10001
s_lshl_b32 s57,s57,6
s_add_u32 s56,s56,s57
s_bfe_u32 s57,s71,0x10004
s_lshl_b32 s57,s57,8
s_add_u32 s56,s56,s57
s_bfe_u32 s57,s71,0x10005
s_lshl_b32 s57,s57,7
s_add_u32 s56,s56,s57
s_bfe_u32 s57,s71,0x10006
s_lshl_b32 s57,s57,12
s_add_u32 s56,s56,s57
v_and_b32 v122,3,v120
v_lshlrev_b32 v10,2,v122
v_bfe_u32 v122,v120,3,1
v_lshl_add_u32 v10,v122,4,v10
v_and_b32 v122,1,v121
v_lshl_add_u32 v10,v122,5,v10
v_add_u32 v10,s56,v10
v_and_b32 v123,36,v1
v_mov_b32 v122,0x80000000
v_cmp_eq_u32 vcc,0,v123
s_nop 1
v_cndmask_b32 v10,v122,v10,vcc
s_lshl_b32 s71,s71,11
s_lshl_b32 s73,s46,11
s_mov_b32 s72,0xffc00000
s_mov_b32 s74,0
v_and_b32 v11,1,v121
v_xor_b32 v11,v11,v120
v_and_b32 v11,3,v11
v_lshrrev_b32 v122,2,v120
v_lshl_add_u32 v11,v11,2,v122
v_lshl_add_u32 v11,v121,4,v11
v_lshlrev_b32 v11,4,v11
s_lshl_b32 s56,s46,15
v_add_u32 v11,s56,v11
v_lshrrev_b32 v13,3,v1
v_lshlrev_b32 v13,9,v13
v_and_b32 v122,7,v1
v_lshl_add_u32 v13,v122,4,v13
v_and_b32 v122,15,v1
v_and_b32 v123,1,v1
v_lshlrev_b32 v123,4,v123
v_mov_b32 v124,0x3f80
v_lshlrev_b32 v124,v123,v124
v_lshrrev_b32 v122,1,v122
v_cmp_eq_u32 vcc,0,v122
s_nop 1
v_cndmask_b32 v18,0,v124,vcc
v_cmp_eq_u32 vcc,1,v122
s_nop 1
v_cndmask_b32 v19,0,v124,vcc
v_cmp_eq_u32 vcc,2,v122
s_nop 1
v_cndmask_b32 v20,0,v124,vcc
v_cmp_eq_u32 vcc,3,v122
s_nop 1
v_cndmask_b32 v21,0,v124,vcc
s_and_b32 s56,s46,1
s_lshl_b32 s56,s56,8
s_and_b32 s57,s46,2
s_lshl_b32 s57,s57,6
s_add_u32 s56,s56,s57
v_add_u32 v13,s56,v13
s_add_u32 s56,s50,155648
v_add_u32 v12,s56,v0
v_mov_b64 v[14:15],s[28:29]
v_mov_b64 v[16:17],s[28:29]
v_add_u32 v22,11550720,v10
s_lshl_b32 s18,s47,2
s_add_u32 s18,s18,10493952
v_mov_b32 v1,s80
s_mov_b32 s65,14680064
s_add_u32 s66,s71,14680064
s_add_u32 s69,s71,14942208
s_mov_b32 s30,0x40000000
s_mov_b32 s51,0
L_cst_242:
s_cmp_lg_u32 s46,0
s_cbranch_scc1 L_csw_247
s_lshl_b32 s59,s51,13
s_lshl2_add_u32 s59,s47,s59
s_add_u32 s59,s59,10485760
s_buffer_load_dword s61,s[8:11],s59
s_waitcnt lgkmcnt(0)
s_cmp_lg_u32 s61,0
s_cbranch_scc1 L_wwd_249
L_ww_248:
s_sleep 1
buffer_load_dword v122,off,s[8:11],s59 sc1
s_sub_u32 s49,s49,1
s_cbranch_scc1 L_abort2
s_waitcnt vmcnt(0)
v_readfirstlane_b32 s61,v122
s_cmp_eq_u32 s61,0
s_cbranch_scc1 L_ww_248
L_wwd_249:
L_csw_247:
s_waitcnt lgkmcnt(0)
s_barrier
s_lshl_b32 s56,s51,5
s_add_u32 s56,s56,s47
s_mul_i32 s56,s56,24576
s_add_u32 s56,s56,100663296
s_add_u32 s67,s56,s73
s_add_u32 m0,s73,131072
s_add_u32 s57,s67,8192
buffer_load_dwordx4 v0,s[8:11],s67 offen sc1 lds
buffer_load_dwordx4 v0,s[8:11],s67 offen offset:1024 sc1 lds
s_add_u32 m0,s73,139264
s_add_u32 s67,s67,786432
buffer_load_dwordx4 v0,s[8:11],s57 offen sc1 lds
buffer_load_dwordx4 v0,s[8:11],s57 offen offset:1024 sc1 lds
s_lshl_b32 s75,s51,13
s_add_u32 s56,s75,11542528
buffer_load_dword v23,v10,s[8:11],s56 offen sc1
s_add_u32 s64,s75,11534336
s_add_u32 s70,s64,4096
s_lshl_b32 s68,s51,5
s_add_u32 s68,s68,s47
s_lshl_b32 s68,s68,12
s_lshl_b32 s56,s46,10
s_add_u32 s68,s68,s56
s_add_u32 s68,s68,41943040
s_mov_b32 s54,0x80000000
s_mov_b32 s77,0
s_add_u32 s56,s18,s75
s_buffer_load_dword s19,s[8:11],s56
s_cmp_eq_u32 s51,63
s_cselect_b32 s76,1,s46
s_cmp_eq_u32 s76,0
s_cselect_b32 s76,1,0
v_mov_b64 v[96:97],0
v_mov_b64 v[98:99],0
v_mov_b64 v[100:101],0
v_mov_b64 v[102:103],0
v_mov_b64 v[104:105],0
v_mov_b64 v[106:107],0
v_mov_b64 v[108:109],0
v_mov_b64 v[110:111],0
v_mov_b64 v[112:113],0
v_mov_b64 v[114:115],0
v_mov_b64 v[116:117],0
v_mov_b64 v[118:119],0
buffer_load_dwordx4 v[88:91],v13,s[8:11],s64 offen
buffer_load_dwordx4 v[88:91],v13,s[8:11],s70 offen
s_waitcnt vmcnt(19)
v_swap_b32 v25,v28
v_swap_b32 v26,v32
v_swap_b32 v27,v36
v_swap_b32 v30,v33
v_swap_b32 v31,v37
v_swap_b32 v35,v38
ds_write_b128 v93,v[24:27] offset:4096
ds_write_b128 v94,v[28:31] offset:4096
ds_write_b128 v93,v[32:35] offset:4224
ds_write_b128 v94,v[36:39] offset:4224
s_waitcnt vmcnt(15)
v_swap_b32 v41,v44
v_swap_b32 v42,v48
v_swap_b32 v43,v52
v_swap_b32 v46,v49
v_swap_b32 v47,v53
v_swap_b32 v51,v54
ds_write_b128 v93,v[40:43] offset:5120
ds_write_b128 v94,v[44:47] offset:5120
ds_write_b128 v93,v[48:51] offset:5248
ds_write_b128 v94,v[52:55] offset:5248
s_waitcnt vmcnt(11)
v_swap_b32 v57,v60
v_swap_b32 v58,v64
v_swap_b32 v59,v68
v_swap_b32 v62,v65
v_swap_b32 v63,v69
v_swap_b32 v67,v70
ds_write_b128 v93,v[56:59] offset:6144
ds_write_b128 v94,v[60:63] offset:6144
ds_write_b128 v93,v[64:67] offset:6272
ds_write_b128 v94,v[68:71] offset:6272
s_waitcnt vmcnt(7)
v_swap_b32 v73,v76
v_swap_b32 v74,v80
v_swap_b32 v75,v84
v_swap_b32 v78,v81
v_swap_b32 v79,v85
v_swap_b32 v83,v86
ds_write_b128 v93,v[72:75] offset:7168
ds_write_b128 v94,v[76:79] offset:7168
ds_write_b128 v93,v[80:83] offset:7296
ds_write_b128 v94,v[84:87] offset:7296
s_waitcnt vmcnt(0) lgkmcnt(0)
s_barrier
v_add_u32 v55,131072,v0
ds_read_b128 v[56:59],v55 offset:0
ds_read_b128 v[60:63],v55 offset:4096
ds_read_b128 v[64:67],v55 offset:1024
ds_read_b128 v[68:71],v55 offset:5120
ds_read_b128 v[72:75],v55 offset:2048
ds_read_b128 v[76:79],v55 offset:6144
ds_read_b128 v[80:83],v55 offset:3072
ds_read_b128 v[84:87],v55 offset:7168
v_add_u32 v123,s73,v55
ds_read_b128 v[88:91],v123 offset:8192
ds_read_b128 v[92:95],v123 offset:9216
v_xor_b32 v120,1024,v12
v_xor_b32 v121,2048,v12
v_xor_b32 v122,3072,v12
buffer_load_dwordx4 v[24:27],v13,s[8:11],s64 offen sc1
buffer_load_dwordx4 v[24:27],v13,s[8:11],s64 offen sc1
.p2align 6
L_chain_250:
L_cpa_251:
buffer_load_dwordx4 v[24:27],v13,s[8:11],s64 offen sc1
s_sub_u32 s49,s49,1
s_cbranch_scc1 L_abort2
s_waitcnt vmcnt(2)
v_max3_u32 v123,v24,v25,v26
v_max_u32 v123,v27,v123
v_cmp_le_u32 vcc,s72,v123
ds_write_b128 v12,v[24:27] offset:0
s_cbranch_vccnz L_cpa_251
L_cgo_254:
v_smfmac_f32_16x16x64_bf16 v[96:99],v[24:27],a[0:7],v2
buffer_load_dwordx4 v[40:43],v13,s[8:11],s70 offen sc1
s_waitcnt lgkmcnt(0)
s_barrier
ds_read_b128 v[28:31],v120 offset:0
v_smfmac_f32_16x16x64_bf16 v[100:103],v[24:27],a[128:135],v2
ds_read_b128 v[32:35],v121 offset:0
v_smfmac_f32_16x16x64_bf16 v[104:107],v[24:27],a[8:15],v2
ds_read_b128 v[36:39],v122 offset:0
v_smfmac_f32_16x16x64_bf16 v[108:111],v[24:27],a[136:143],v2
v_smfmac_f32_16x16x64_bf16 v[112:115],v[24:27],v[128:135],v2
v_smfmac_f32_16x16x64_bf16 v[116:119],v[24:27],v[136:143],v2
s_waitcnt lgkmcnt(2)
v_smfmac_f32_16x16x64_bf16 v[96:99],v[28:31],a[16:23],v2
s_add_u32 m0,s73,131072
v_smfmac_f32_16x16x64_bf16 v[100:103],v[28:31],a[144:151],v2
s_add_u32 s57,s67,8192
v_smfmac_f32_16x16x64_bf16 v[104:107],v[28:31],a[24:31],v2
s_cmp_lt_u32 s19,s76
s_cbranch_scc1 L_ckw_243
L_ckb_244:
v_smfmac_f32_16x16x64_bf16 v[108:111],v[28:31],a[152:159],v2
s_waitcnt vmcnt(0) lgkmcnt(1)
v_smfmac_f32_16x16x64_bf16 v[96:99],v[32:35],a[32:39],v2
ds_write_b128 v12,v[40:43] offset:4096
v_max3_u32 v123,v40,v41,v42
v_smfmac_f32_16x16x64_bf16 v[100:103],v[32:35],a[160:167],v2
v_max_u32 v123,v43,v123
v_smfmac_f32_16x16x64_bf16 v[104:107],v[32:35],a[40:47],v2
v_cmp_le_u32 vcc,s72,v123
v_smfmac_f32_16x16x64_bf16 v[108:111],v[32:35],a[168:175],v2
v_smfmac_f32_16x16x64_bf16 v[112:115],v[28:31],v[144:151],v2
s_cbranch_vccnz L_cpb_257
L_cback_259:
s_waitcnt lgkmcnt(0)
s_barrier
v_smfmac_f32_16x16x64_bf16 v[96:99],v[36:39],a[48:55],v2
buffer_load_dword v23,v22,s[8:11],s75 offen sc1
v_smfmac_f32_16x16x64_bf16 v[100:103],v[36:39],a[176:183],v2
ds_read_b128 v[44:47],v120 offset:4096
v_smfmac_f32_16x16x64_bf16 v[104:107],v[36:39],a[56:63],v2
buffer_load_dwordx4 v0,s[8:11],s67 offen sc1 lds
v_smfmac_f32_16x16x64_bf16 v[108:111],v[36:39],a[184:191],v2
ds_read_b128 v[48:51],v121 offset:4096
v_smfmac_f32_16x16x64_bf16 v[96:99],v[40:43],a[64:71],v2
buffer_store_dwordx4 v[124:127],v0,s[8:11],s54 offen sc1
v_smfmac_f32_16x16x64_bf16 v[100:103],v[40:43],a[192:199],v2
ds_read_b128 v[52:55],v122 offset:4096
v_smfmac_f32_16x16x64_bf16 v[104:107],v[40:43],a[72:79],v2
buffer_load_dwordx4 v0,s[8:11],s67 offen offset:1024 sc1 lds
s_add_u32 m0,s73,139264
v_smfmac_f32_16x16x64_bf16 v[108:111],v[40:43],a[200:207],v2
s_waitcnt lgkmcnt(2)
v_smfmac_f32_16x16x64_bf16 v[96:99],v[44:47],a[80:87],v2
buffer_load_dwordx4 v0,s[8:11],s57 offen sc1 lds
s_add_u32 s67,s67,786432
v_smfmac_f32_16x16x64_bf16 v[100:103],v[44:47],a[208:215],v2
s_waitcnt lgkmcnt(1)
v_smfmac_f32_16x16x64_bf16 v[96:99],v[48:51],a[96:103],v2
buffer_load_dwordx4 v0,s[8:11],s57 offen offset:1024 sc1 lds
v_smfmac_f32_16x16x64_bf16 v[100:103],v[48:51],a[224:231],v2
s_waitcnt lgkmcnt(0)
v_smfmac_f32_16x16x64_bf16 v[96:99],v[52:55],a[112:119],v2
v_smfmac_f32_16x16x64_bf16 v[100:103],v[52:55],a[240:247],v2
v_smfmac_f32_16x16x64_bf16 v[104:107],v[44:47],a[88:95],v2
v_smfmac_f32_16x16x64_bf16 v[108:111],v[44:47],a[216:223],v2
v_smfmac_f32_16x16x64_bf16 v[104:107],v[48:51],a[104:111],v2
v_add_f32 v96,v96,v98
v_smfmac_f32_16x16x64_bf16 v[108:111],v[48:51],a[232:239],v2
v_add_f32 v97,v97,v99
v_smfmac_f32_16x16x64_bf16 v[104:107],v[52:55],a[120:127],v2
v_cvt_pk_bf16_f32 v120,v96,v97
v_smfmac_f32_16x16x64_bf16 v[108:111],v[52:55],a[248:255],v2
v_add_f32 v100,v100,v102
v_smfmac_f32_16x16x64_bf16 v[116:119],v[28:31],v[152:159],v2
v_add_f32 v101,v101,v103
v_smfmac_f32_16x16x64_bf16 v[112:115],v[32:35],v[160:167],v2
v_cvt_pk_bf16_f32 v121,v100,v101
v_add_f32 v104,v104,v106
v_add_f32 v105,v105,v107
v_cvt_pk_bf16_f32 v122,v104,v105
v_add_f32 v108,v108,v110
v_add_f32 v109,v109,v111
v_cvt_pk_bf16_f32 v123,v108,v109
ds_write_b128 v4,v[120:123]
v_smfmac_f32_16x16x64_bf16 v[116:119],v[32:35],v[168:175],v2
s_mov_b32 s54,s68
s_add_u32 s68,s68,131072
v_mov_b32 v125,0
v_smfmac_f32_16x16x64_bf16 v[112:115],v[36:39],v[176:183],v2
s_cmp_eq_u32 s51,63
s_cbranch_scc1 L_cend_253
v_smfmac_f32_16x16x64_bf16 v[116:119],v[36:39],v[184:191],v2
s_waitcnt lgkmcnt(0)
s_barrier
ds_read_b64_tr_b16 v[96:97],v5 offset:0
v_smfmac_f32_16x16x64_bf16 v[112:115],v[40:43],v[192:199],v2
ds_read_b64_tr_b16 v[98:99],v6 offset:0
v_smfmac_f32_16x16x64_bf16 v[116:119],v[40:43],v[200:207],v2
ds_read_b64_tr_b16 v[100:101],v5 offset:1024
v_smfmac_f32_16x16x64_bf16 v[112:115],v[44:47],v[208:215],v2
ds_read_b64_tr_b16 v[102:103],v6 offset:1024
v_smfmac_f32_16x16x64_bf16 v[116:119],v[44:47],v[216:223],v2
ds_read_b64_tr_b16 v[104:105],v5 offset:2048
v_smfmac_f32_16x16x64_bf16 v[112:115],v[48:51],v[224:231],v2
ds_read_b64_tr_b16 v[106:107],v6 offset:2048
s_waitcnt lgkmcnt(4)
v_mfma_f32_16x16x32_bf16 v[24:27],v[56:59],v[96:99],0
ds_read_b64_tr_b16 v[108:109],v5 offset:3072
v_mfma_f32_16x16x32_bf16 v[28:31],v[60:63],v[96:99],0
ds_read_b64_tr_b16 v[110:111],v6 offset:3072
v_mfma_f32_16x16x32_bf16 v[32:35],v[96:99],v[96:99],0
ds_read_b128 v[40:43],v11 offset:12288
s_waitcnt lgkmcnt(5)
v_mfma_f32_16x16x32_bf16 v[24:27],v[64:67],v[100:103],v[24:27]
ds_read_b128 v[56:59],v11 offset:0
v_mfma_f32_16x16x32_bf16 v[28:31],v[68:71],v[100:103],v[28:31]
ds_read_b128 v[60:63],v11 offset:1024
v_mfma_f32_16x16x32_bf16 v[32:35],v[100:103],v[100:103],v[32:35]
ds_read_b128 v[96:99],v11 offset:8192
s_waitcnt lgkmcnt(6)
v_mfma_f32_16x16x32_bf16 v[24:27],v[72:75],v[104:107],v[24:27]
ds_read_b128 v[64:67],v11 offset:2048
v_mfma_f32_16x16x32_bf16 v[28:31],v[76:79],v[104:107],v[28:31]
ds_read_b128 v[68:71],v11 offset:3072
v_mfma_f32_16x16x32_bf16 v[32:35],v[104:107],v[104:107],v[32:35]
ds_read_b128 v[100:103],v11 offset:9216
s_waitcnt lgkmcnt(7)
v_mfma_f32_16x16x32_bf16 v[24:27],v[80:83],v[108:111],v[24:27]
ds_read_b128 v[72:75],v11 offset:4096
v_mfma_f32_16x16x32_bf16 v[28:31],v[84:87],v[108:111],v[28:31]
ds_read_b128 v[76:79],v11 offset:5120
v_mfma_f32_16x16x32_bf16 v[32:35],v[108:111],v[108:111],v[32:35]
ds_read_b128 v[104:107],v11 offset:10240
v_smfmac_f32_16x16x64_bf16 v[116:119],v[48:51],v[232:239],v2
ds_read_b128 v[80:83],v11 offset:6144
v_smfmac_f32_16x16x64_bf16 v[112:115],v[52:55],v[240:247],v2
ds_read_b128 v[84:87],v11 offset:7168
v_smfmac_f32_16x16x64_bf16 v[116:119],v[52:55],v[248:255],v2
ds_read_b128 v[108:111],v11 offset:11264
v_max3_f32 v126,v24,v25,v26
v_max3_f32 v127,v27,v28,v29
v_max3_f32 v126,v30,v31,v126
v_max3_f32 v127,v34,v35,v127
v_max_f32 v126,v126,v127
v_max_f32 v127,v126,v127
v_pk_mul_f32 v[34:35],v[34:35],v[0:1] op_sel:[0,1]
v_pk_mul_f32 v[24:25],v[24:25],v[0:1] op_sel:[0,1]
v_permlane16_swap_b32 v126,v127
v_max_f32 v126,v126,v127
v_max_f32 v127,v126,v127
v_pk_add_f32 v[112:113],v[112:113],v[114:115]
v_pk_add_f32 v[116:117],v[116:117],v[118:119]
v_permlane32_swap_b32 v126,v127
v_max_f32 v126,v126,v127
v_mul_f32 v126,v1,v126
v_pk_add_f32 v[34:35],v[34:35],v[126:127] op_sel_hi:[1,0] neg_lo:[0,1] neg_hi:[0,1]
v_pk_add_f32 v[24:25],v[24:25],v[126:127] op_sel_hi:[1,0] neg_lo:[0,1] neg_hi:[0,1]
v_pk_fma_f32 v[26:27],v[26:27],v[0:1],v[126:127] op_sel:[0,1,0] op_sel_hi:[1,1,0] neg_lo:[0,0,1] neg_hi:[0,0,1]
v_pk_fma_f32 v[28:29],v[28:29],v[0:1],v[126:127] op_sel:[0,1,0] op_sel_hi:[1,1,0] neg_lo:[0,0,1] neg_hi:[0,0,1]
v_pk_fma_f32 v[30:31],v[30:31],v[0:1],v[126:127] op_sel:[0,1,0] op_sel_hi:[1,1,0] neg_lo:[0,0,1] neg_hi:[0,0,1]
v_exp_f32 v34,v34
v_exp_f32 v35,v35
v_cvt_pk_bf16_f32 v126,v112,v113
v_cvt_pk_bf16_f32 v124,v34,v35
v_cvt_pk_bf16_f32 v127,v116,v117
v_cvt_pk_bf16_f32 v36,v116,v117
v_mfma_f32_16x16x16_bf16 v[32:35],v[14:15],v[124:125],0
ds_read_b128 v[44:47],v11 offset:13312
v_exp_f32 v24,v24
v_mfma_f32_16x16x16_bf16 v[112:115],v[126:127],v[124:125],0
ds_read_b128 v[48:51],v11 offset:14336
v_exp_f32 v25,v25
v_mfma_f32_16x16x16_bf16 v[116:119],v[36:37],v[124:125],0
ds_read_b128 v[52:55],v11 offset:15360
v_exp_f32 v26,v26
v_exp_f32 v27,v27
v_cvt_pk_bf16_f32 v120,v24,v25
v_exp_f32 v28,v28
v_exp_f32 v29,v29
v_cvt_pk_bf16_f32 v121,v26,v27
v_exp_f32 v30,v30
v_exp_f32 v31,v31
v_cvt_pk_bf16_f32 v122,v28,v29
v_cvt_pk_bf16_f32 v123,v30,v31
s_add_u32 s75,s75,8192
s_add_u32 s51,s51,1
v_mfma_f32_16x16x32_bf16 v[32:35],v[14:17],v[120:123],v[32:35]
v_mfma_f32_16x16x32_bf16 v[112:115],v[88:91],v[120:123],v[112:115]
ds_read_b128 v[88:91],v11 offset:16384
v_mfma_f32_16x16x32_bf16 v[116:119],v[92:95],v[120:123],v[116:119]
ds_read_b128 v[92:95],v11 offset:17408
v_rcp_f32 v32,v32
v_mov_b64 v[24:25],-1
v_mov_b64 v[26:27],-1
s_add_u32 s64,s75,11534336
s_add_u32 s70,s64,4096
v_pk_mul_f32 v[112:113],v[112:113],v[32:33] op_sel_hi:[1,0]
v_pk_mul_f32 v[114:115],v[114:115],v[32:33] op_sel_hi:[1,0]
v_pk_mul_f32 v[116:117],v[116:117],v[32:33] op_sel_hi:[1,0]
v_pk_mul_f32 v[118:119],v[118:119],v[32:33] op_sel_hi:[1,0]
v_cvt_pk_bf16_f32 v120,v112,v116
v_cvt_pk_bf16_f32 v121,v113,v117
v_cvt_pk_bf16_f32 v122,v114,v118
v_cvt_pk_bf16_f32 v123,v115,v119
ds_write_b128 v7,v[120:123]
buffer_store_dwordx4 v[24:27],v0,s[8:11],s69 offen sc1
buffer_store_dwordx4 v[24:27],v0,s[8:11],s69 offen offset:1024 sc1
v_mov_b64 v[112:113],0
v_mov_b64 v[114:115],0
v_mov_b64 v[116:117],0
v_mov_b64 v[118:119],0
s_waitcnt lgkmcnt(0)
s_barrier
ds_read_b128 v[24:27],v8 offset:0
ds_read_b128 v[28:31],v8 offset:512
ds_read_b128 v[32:35],v8 offset:1024
ds_read_b128 v[36:39],v8 offset:1536
v_mov_b64 v[120:121],0
v_mov_b64 v[122:123],0
s_add_u32 s57,s65,65536
s_add_u32 s58,s65,131072
s_add_u32 s59,s65,196608
s_add_u32 s56,s18,s75
s_waitcnt lgkmcnt(3)
v_smfmac_f32_16x16x64_bf16 v[112:115],v[24:27],v[56:63],v3
ds_read_b128 v[56:59],v11 offset:18432
s_waitcnt lgkmcnt(3)
v_smfmac_f32_16x16x64_bf16 v[112:115],v[28:31],v[64:71],v3
ds_read_b128 v[60:63],v11 offset:19456
s_waitcnt lgkmcnt(3)
v_smfmac_f32_16x16x64_bf16 v[112:115],v[32:35],v[72:79],v3
ds_read_b128 v[64:67],v11 offset:20480
s_waitcnt lgkmcnt(3)
v_smfmac_f32_16x16x64_bf16 v[112:115],v[36:39],v[80:87],v3
ds_read_b128 v[68:71],v11 offset:21504
v_smfmac_f32_16x16x64_bf16 v[116:119],v[24:27],v[96:103],v3
ds_read_b128 v[72:75],v11 offset:22528
v_smfmac_f32_16x16x64_bf16 v[116:119],v[28:31],v[104:111],v3
ds_read_b128 v[76:79],v11 offset:23552
v_cvt_pk_bf16_f32 v112,v112,v113
v_smfmac_f32_16x16x64_bf16 v[116:119],v[32:35],v[40:47],v3
ds_read_b128 v[80:83],v11 offset:24576
v_cvt_pk_bf16_f32 v113,v114,v115
buffer_store_dwordx2 v[112:113],v9,s[8:11],s65 offen sc1
v_smfmac_f32_16x16x64_bf16 v[116:119],v[36:39],v[48:55],v3
ds_read_b128 v[84:87],v11 offset:25600
v_mov_b64 v[112:113],0
v_smfmac_f32_16x16x64_bf16 v[120:123],v[24:27],v[88:95],v3
ds_read_b128 v[96:99],v11 offset:26624
ds_read_b128 v[100:103],v11 offset:27648
v_mov_b64 v[114:115],0
s_waitcnt lgkmcnt(8)
v_smfmac_f32_16x16x64_bf16 v[120:123],v[28:31],v[56:63],v3
ds_read_b128 v[104:107],v11 offset:28672
v_cvt_pk_bf16_f32 v116,v116,v117
s_waitcnt lgkmcnt(7)
v_smfmac_f32_16x16x64_bf16 v[120:123],v[32:35],v[64:71],v3
ds_read_b128 v[108:111],v11 offset:29696
ds_read_b128 v[40:43],v11 offset:30720
v_cvt_pk_bf16_f32 v117,v118,v119
buffer_store_dwordx2 v[116:117],v9,s[8:11],s57 offen sc1
s_waitcnt lgkmcnt(7)
v_smfmac_f32_16x16x64_bf16 v[120:123],v[36:39],v[72:79],v3
ds_read_b128 v[44:47],v11 offset:31744
v_add_u32 v52,s50,v5
s_waitcnt lgkmcnt(6)
v_smfmac_f32_16x16x64_bf16 v[112:115],v[24:27],v[80:87],v3
v_add_u32 v54,s50,v6
s_waitcnt lgkmcnt(4)
v_smfmac_f32_16x16x64_bf16 v[112:115],v[28:31],v[96:103],v3
ds_read_b64_tr_b16 v[52:53],v52
v_cvt_pk_bf16_f32 v120,v120,v121
s_waitcnt lgkmcnt(3)
v_smfmac_f32_16x16x64_bf16 v[112:115],v[32:35],v[104:111],v3
ds_read_b64_tr_b16 v[54:55],v54
v_cvt_pk_bf16_f32 v121,v122,v123
buffer_store_dwordx2 v[120:121],v9,s[8:11],s58 offen sc1
s_waitcnt lgkmcnt(2)
v_smfmac_f32_16x16x64_bf16 v[112:115],v[36:39],v[40:47],v3
v_mov_b64 v[116:117],0
v_mov_b64 v[118:119],0
s_xor_b32 s65,s65,262144
v_mov_b32_dpp v124,v126 quad_perm:[2,3,2,3] row_mask:0xf bank_mask:0xf
v_mov_b32_dpp v125,v127 quad_perm:[2,3,2,3] row_mask:0xf bank_mask:0xf
s_mov_b32 vcc_lo,0xcccccccc
s_mov_b32 vcc_hi,0xcccccccc
s_nop 0
v_cvt_pk_bf16_f32 v112,v112,v113
v_cvt_pk_bf16_f32 v113,v114,v115
buffer_store_dwordx2 v[112:113],v9,s[8:11],s59 offen sc1
s_waitcnt lgkmcnt(0)
s_buffer_load_dword s19,s[8:11],s56
v_cndmask_b32 v124,v124,v52,vcc
v_cndmask_b32 v125,v125,v53,vcc
s_cmp_lt_u32 s46,2
s_waitcnt vmcnt(3)
s_cbranch_scc1 L_crg_260
s_cmp_eq_u32 s46,2
s_waitcnt vmcnt(1)
s_cbranch_scc1 L_crg_260
s_waitcnt vmcnt(0)
L_crg_260:
buffer_load_dwordx4 v[32:35],v0,s[8:11],s66 offen offset:0 sc1
buffer_load_dwordx4 v[36:39],v0,s[8:11],s66 offen offset:1024 sc1
v_cndmask_b32 v126,v126,v54,vcc
v_cndmask_b32 v127,v127,v55,vcc
v_mov_b64 v[96:97],0
v_mov_b64 v[98:99],0
v_mov_b64 v[100:101],0
v_mov_b64 v[102:103],0
v_mov_b64 v[104:105],0
v_mov_b64 v[106:107],0
v_mov_b64 v[108:109],0
v_mov_b64 v[110:111],0
v_mov_b64 v[112:113],0
v_mov_b64 v[114:115],0
v_add_u32 v55,131072,v0
v_add_u32 v123,s73,v55
v_xor_b32 v120,1024,v12
v_xor_b32 v121,2048,v12
v_xor_b32 v122,3072,v12
buffer_load_dwordx4 v[44:47],v0,s[8:11],s66 offen offset:0 sc1
buffer_load_dwordx4 v[48:51],v0,s[8:11],s66 offen offset:1024 sc1
s_cmp_ge_u32 s51,63
s_cselect_b32 s76,0,1
s_cmp_eq_u32 s46,0
s_cselect_b32 s76,s76,0
s_waitcnt vmcnt(3)
v_mfma_f32_16x16x32_bf16 v[28:31],v[18:21],v[32:35],0
s_waitcnt vmcnt(2)
v_mfma_f32_16x16x32_bf16 v[28:31],v[18:21],v[36:39],v[28:31]
s_nop 7
v_cmp_u_f32 vcc,v28,v28
v_add_f32_dpp v52,v28,v28 row_ror:8 row_mask:0xf bank_mask:0x3
v_add_f32_dpp v53,v29,v29 row_ror:8 row_mask:0xf bank_mask:0x3
v_add_f32_dpp v52,v30,v30 row_ror:8 row_mask:0xf bank_mask:0xc
v_add_f32_dpp v53,v31,v31 row_ror:8 row_mask:0xf bank_mask:0xc
s_cbranch_vccnz L_crp_255
L_cok_261:
v_add_f32_dpp v52,v52,v52 row_shl:4 row_mask:0xf bank_mask:0x5
v_add_f32_dpp v53,v53,v53 row_shl:4 row_mask:0xf bank_mask:0x5
v_cvt_pk_bf16_f32 v54,v52,v53
buffer_store_dword v54,v10,s[8:11],s64 offen sc1
s_mov_b32 s69,s66
s_xor_b32 s66,s66,262144
s_barrier
ds_read_b128 v[56:59],v55 offset:0
ds_read_b128 v[60:63],v55 offset:4096
ds_read_b128 v[64:67],v55 offset:1024
buffer_load_dwordx4 v[24:27],v13,s[8:11],s64 offen sc1
ds_read_b128 v[68:71],v55 offset:5120
ds_read_b128 v[72:75],v55 offset:2048
ds_read_b128 v[76:79],v55 offset:6144
ds_read_b128 v[80:83],v55 offset:3072
buffer_load_dwordx4 v[24:27],v13,s[8:11],s64 offen sc1
ds_read_b128 v[84:87],v55 offset:7168
ds_read_b128 v[88:91],v123 offset:8192
ds_read_b128 v[92:95],v123 offset:9216
s_branch L_chain_250
L_cpb_257:
buffer_load_dwordx4 v[40:43],v13,s[8:11],s70 offen sc1
s_sub_u32 s49,s49,1
s_cbranch_scc1 L_abort2
s_waitcnt vmcnt(0)
v_max3_u32 v123,v40,v41,v42
v_max_u32 v123,v43,v123
v_cmp_le_u32 vcc,s72,v123
s_cbranch_vccnz L_cpb_257
ds_write_b128 v12,v[40:43] offset:4096
s_branch L_cback_259
L_crp_255:
buffer_load_dwordx4 v[32:35],v0,s[8:11],s66 offen offset:0 sc1
buffer_load_dwordx4 v[36:39],v0,s[8:11],s66 offen offset:1024 sc1
s_sub_u32 s49,s49,1
s_cbranch_scc1 L_abort2
s_waitcnt vmcnt(3)
v_mfma_f32_16x16x32_bf16 v[28:31],v[18:21],v[44:47],0
s_waitcnt vmcnt(2)
v_mfma_f32_16x16x32_bf16 v[28:31],v[18:21],v[48:51],v[28:31]
s_nop 7
v_cmp_u_f32 vcc,v28,v28
v_add_f32_dpp v52,v28,v28 row_ror:8 row_mask:0xf bank_mask:0x3
v_add_f32_dpp v53,v29,v29 row_ror:8 row_mask:0xf bank_mask:0x3
v_add_f32_dpp v52,v30,v30 row_ror:8 row_mask:0xf bank_mask:0xc
v_add_f32_dpp v53,v31,v31 row_ror:8 row_mask:0xf bank_mask:0xc
s_cbranch_vccz L_cok_261
buffer_load_dwordx4 v[44:47],v0,s[8:11],s66 offen offset:0 sc1
buffer_load_dwordx4 v[48:51],v0,s[8:11],s66 offen offset:1024 sc1
s_sub_u32 s49,s49,1
s_cbranch_scc1 L_abort2
s_waitcnt vmcnt(3)
v_mfma_f32_16x16x32_bf16 v[28:31],v[18:21],v[32:35],0
s_waitcnt vmcnt(2)
v_mfma_f32_16x16x32_bf16 v[28:31],v[18:21],v[36:39],v[28:31]
s_nop 7
v_cmp_u_f32 vcc,v28,v28
v_add_f32_dpp v52,v28,v28 row_ror:8 row_mask:0xf bank_mask:0x3
v_add_f32_dpp v53,v29,v29 row_ror:8 row_mask:0xf bank_mask:0x3
v_add_f32_dpp v52,v30,v30 row_ror:8 row_mask:0xf bank_mask:0xc
v_add_f32_dpp v53,v31,v31 row_ror:8 row_mask:0xf bank_mask:0xc
s_cbranch_vccz L_cok_261
s_branch L_crp_255
L_ckw_243:
s_add_u32 s59,s18,s75
L_ww_262:
s_sleep 1
buffer_load_dword v23,off,s[8:11],s59 sc1
s_sub_u32 s49,s49,1
s_cbranch_scc1 L_abort2
s_waitcnt vmcnt(0)
v_readfirstlane_b32 s76,v23
s_cmp_eq_u32 s76,0
s_cbranch_scc1 L_ww_262
L_wwd_263:
s_branch L_ckb_244
L_cend_253:
v_smfmac_f32_16x16x64_bf16 v[116:119],v[36:39],v[184:191],v2
v_smfmac_f32_16x16x64_bf16 v[112:115],v[40:43],v[192:199],v2
v_smfmac_f32_16x16x64_bf16 v[116:119],v[40:43],v[200:207],v2
v_smfmac_f32_16x16x64_bf16 v[112:115],v[44:47],v[208:215],v2
v_smfmac_f32_16x16x64_bf16 v[116:119],v[44:47],v[216:223],v2
v_smfmac_f32_16x16x64_bf16 v[112:115],v[48:51],v[224:231],v2
v_smfmac_f32_16x16x64_bf16 v[116:119],v[48:51],v[232:239],v2
v_smfmac_f32_16x16x64_bf16 v[112:115],v[52:55],v[240:247],v2
v_smfmac_f32_16x16x64_bf16 v[116:119],v[52:55],v[248:255],v2
s_waitcnt lgkmcnt(0)
s_nop 2
v_pk_add_f32 v[112:113],v[112:113],v[114:115]
s_nop 2
v_pk_add_f32 v[116:117],v[116:117],v[118:119]
v_cvt_pk_bf16_f32 v126,v112,v113
v_cvt_pk_bf16_f32 v127,v116,v117
v_add_u32 v52,s50,v5
v_add_u32 v54,s50,v6
ds_read_b64_tr_b16 v[52:53],v52
ds_read_b64_tr_b16 v[54:55],v54
v_mov_b32_dpp v124,v126 quad_perm:[2,3,2,3] row_mask:0xf bank_mask:0xf
v_mov_b32_dpp v125,v127 quad_perm:[2,3,2,3] row_mask:0xf bank_mask:0xf
s_mov_b32 vcc_lo,0xcccccccc
s_mov_b32 vcc_hi,0xcccccccc
s_waitcnt lgkmcnt(0)
v_cndmask_b32 v124,v124,v52,vcc
v_cndmask_b32 v125,v125,v53,vcc
v_cndmask_b32 v126,v126,v54,vcc
v_cndmask_b32 v127,v127,v55,vcc
buffer_store_dwordx4 v[124:127],v0,s[8:11],s54 offen sc1
s_mov_b32 s51,64
s_waitcnt vmcnt(0)
s_barrier
s_nop 11
v_lshrrev_b32 v1,4,v0
s_mov_b32 s53,0
s_branch L_rb_7
L_rc1_237:
v_and_b32 v120,15,v1
v_lshrrev_b32 v121,4,v1
v_and_b32 v122,2,v1
v_cmp_eq_u32 vcc,0,v122
v_mov_b32 v2,0xeeee
v_mov_b32 v123,0x4444
v_cndmask_b32 v2,v2,v123,vcc
v_and_b32 v122,1,v1
v_cmp_eq_u32 vcc,0,v122
v_mov_b32 v3,0xdddd
v_mov_b32 v123,0x8888
v_cndmask_b32 v3,v3,v123,vcc
v_lshrrev_b32 v122,1,v120
v_bfe_u32 v123,v120,2,1
v_xor_b32 v123,v123,v122
v_lshlrev_b32 v4,7,v123
v_and_b32 v123,1,v120
v_lshl_add_u32 v4,v123,6,v4
v_xor_b32 v123,v121,v122
v_and_b32 v123,3,v123
v_lshl_add_u32 v4,v123,4,v4
s_lshl_b32 s56,s46,10
s_add_u32 s56,s56,147456
v_add_u32 v4,s56,v4
v_lshlrev_b32 v122,1,v121
v_add_u32 v122,0,v122
v_and_b32 v123,1,v121
v_xor_b32 v123,v123,v122
v_lshlrev_b32 v5,7,v123
v_bfe_u32 v123,v120,3,1
v_lshl_add_u32 v5,v123,6,v5
v_xor_b32 v123,v120,v122
v_and_b32 v123,3,v123
v_lshl_add_u32 v5,v123,4,v5
v_bfe_u32 v123,v120,2,1
v_lshl_add_u32 v5,v123,3,v5
v_add_u32 v5,147456,v5
v_lshlrev_b32 v122,1,v121
v_add_u32 v122,1,v122
v_and_b32 v123,1,v121
v_xor_b32 v123,v123,v122
v_lshlrev_b32 v6,7,v123
v_bfe_u32 v123,v120,3,1
v_lshl_add_u32 v6,v123,6,v6
v_xor_b32 v123,v120,v122
v_and_b32 v123,3,v123
v_lshl_add_u32 v6,v123,4,v6
v_bfe_u32 v123,v120,2,1
v_lshl_add_u32 v6,v123,3,v6
v_add_u32 v6,147456,v6
v_lshlrev_b32 v7,7,v121
v_lshrrev_b32 v122,1,v120
v_lshl_add_u32 v8,v122,4,v7
v_add_u32 v8,151552,v8
v_lshrrev_b32 v122,2,v120
v_lshl_add_u32 v7,v122,5,v7
v_and_b32 v122,1,v120
v_lshl_add_u32 v7,v122,4,v7
v_and_b32 v122,2,v120
v_cmp_eq_u32 vcc,0,v122
s_lshl_b32 s56,s46,9
v_mov_b32 v122,2048
v_mov_b32 v123,s56
v_cndmask_b32 v122,v122,v123,vcc
v_add_u32 v7,v122,v7
v_add_u32 v7,151552,v7
v_lshrrev_b32 v122,3,v1
v_lshlrev_b32 v9,11,v122
v_and_b32 v122,7,v1
v_lshl_add_u32 v9,v122,3,v9
s_lshl_b32 s56,s46,14
s_lshl_b32 s57,s47,6
s_add_u32 s56,s56,s57
v_add_u32 v9,s56,v9
s_lshl_b32 s71,s46,5
s_add_u32 s71,s71,s47
s_bfe_u32 s56,s71,0x10003
s_lshl_b32 s56,s56,11
s_and_b32 s57,s71,1
s_lshl_b32 s57,s57,10
s_add_u32 s56,s56,s57
s_bfe_u32 s57,s71,0x10002
s_lshl_b32 s57,s57,9
s_add_u32 s56,s56,s57
s_bfe_u32 s57,s71,0x10001
s_lshl_b32 s57,s57,6
s_add_u32 s56,s56,s57
s_bfe_u32 s57,s71,0x10004
s_lshl_b32 s57,s57,8
s_add_u32 s56,s56,s57
s_bfe_u32 s57,s71,0x10005
s_lshl_b32 s57,s57,7
s_add_u32 s56,s56,s57
s_bfe_u32 s57,s71,0x10006
s_lshl_b32 s57,s57,12
s_add_u32 s56,s56,s57
v_and_b32 v122,3,v120
v_lshlrev_b32 v10,2,v122
v_bfe_u32 v122,v120,3,1
v_lshl_add_u32 v10,v122,4,v10
v_and_b32 v122,1,v121
v_lshl_add_u32 v10,v122,5,v10
v_add_u32 v10,s56,v10
v_and_b32 v123,36,v1
v_mov_b32 v122,0x80000000
v_cmp_eq_u32 vcc,0,v123
s_nop 1
v_cndmask_b32 v10,v122,v10,vcc
s_lshl_b32 s71,s71,11
s_lshl_b32 s73,s46,11
s_mov_b32 s72,0xffc00000
s_mov_b32 s74,0
v_and_b32 v11,1,v121
v_xor_b32 v11,v11,v120
v_and_b32 v11,3,v11
v_lshrrev_b32 v122,2,v120
v_lshl_add_u32 v11,v11,2,v122
v_lshl_add_u32 v11,v121,4,v11
v_lshlrev_b32 v11,4,v11
s_lshl_b32 s56,s46,15
v_add_u32 v11,s56,v11
v_lshrrev_b32 v13,3,v1
v_lshlrev_b32 v13,9,v13
v_and_b32 v122,7,v1
v_lshl_add_u32 v13,v122,4,v13
v_and_b32 v122,15,v1
v_and_b32 v123,1,v1
v_lshlrev_b32 v123,4,v123
v_mov_b32 v124,0x3f80
v_lshlrev_b32 v124,v123,v124
v_lshrrev_b32 v122,1,v122
v_cmp_eq_u32 vcc,0,v122
s_nop 1
v_cndmask_b32 v18,0,v124,vcc
v_cmp_eq_u32 vcc,1,v122
s_nop 1
v_cndmask_b32 v19,0,v124,vcc
v_cmp_eq_u32 vcc,2,v122
s_nop 1
v_cndmask_b32 v20,0,v124,vcc
v_cmp_eq_u32 vcc,3,v122
s_nop 1
v_cndmask_b32 v21,0,v124,vcc
s_and_b32 s56,s46,1
s_lshl_b32 s56,s56,8
s_and_b32 s57,s46,2
s_lshl_b32 s57,s57,6
s_add_u32 s56,s56,s57
v_add_u32 v13,s56,v13
s_add_u32 s56,s50,155648
v_add_u32 v12,s56,v0
v_mov_b64 v[14:15],s[28:29]
v_mov_b64 v[16:17],s[28:29]
v_add_u32 v22,12599296,v10
s_lshl_b32 s18,s47,2
s_add_u32 s18,s18,10494080
v_mov_b32 v1,s80
s_mov_b32 s65,15728640
s_add_u32 s66,s71,15728640
s_add_u32 s69,s71,15990784
s_mov_b32 s30,0x40000000
s_mov_b32 s51,0
L_cst_267:
s_cmp_lg_u32 s46,0
s_cbranch_scc1 L_csw_272
s_lshl_b32 s59,s51,13
s_lshl2_add_u32 s59,s47,s59
s_add_u32 s59,s59,10485888
L_ww_273:
s_sleep 1
buffer_load_dword v122,off,s[8:11],s59 sc1
s_sub_u32 s49,s49,1
s_cbranch_scc1 L_abort2
s_waitcnt vmcnt(0)
v_readfirstlane_b32 s61,v122
s_cmp_eq_u32 s61,0
s_cbranch_scc1 L_ww_273
L_wwd_274:
L_csw_272:
s_waitcnt lgkmcnt(0)
s_barrier
s_lshl_b32 s56,s51,5
s_add_u32 s56,s56,s47
s_mul_i32 s56,s56,24576
s_add_u32 s56,s56,150994944
s_add_u32 s67,s56,s73
s_add_u32 m0,s73,131072
s_add_u32 s57,s67,8192
buffer_load_dwordx4 v0,s[8:11],s67 offen sc1 lds
buffer_load_dwordx4 v0,s[8:11],s67 offen offset:1024 sc1 lds
s_add_u32 m0,s73,139264
s_add_u32 s67,s67,786432
buffer_load_dwordx4 v0,s[8:11],s57 offen sc1 lds
buffer_load_dwordx4 v0,s[8:11],s57 offen offset:1024 sc1 lds
s_lshl_b32 s75,s51,13
s_add_u32 s56,s75,12591104
buffer_load_dword v23,v10,s[8:11],s56 offen sc1
s_add_u32 s64,s75,12582912
s_add_u32 s70,s64,4096
s_lshl_b32 s68,s51,5
s_add_u32 s68,s68,s47
s_lshl_b32 s68,s68,12
s_lshl_b32 s56,s46,10
s_add_u32 s68,s68,s56
s_add_u32 s68,s68,58720256
s_mov_b32 s54,0x80000000
s_mov_b32 s77,0
s_add_u32 s56,s18,s75
s_buffer_load_dword s19,s[8:11],s56
s_cmp_eq_u32 s51,63
s_cselect_b32 s76,1,s46
s_cmp_eq_u32 s76,0
s_cselect_b32 s76,1,0
v_mov_b64 v[96:97],0
v_mov_b64 v[98:99],0
v_mov_b64 v[100:101],0
v_mov_b64 v[102:103],0
v_mov_b64 v[104:105],0
v_mov_b64 v[106:107],0
v_mov_b64 v[108:109],0
v_mov_b64 v[110:111],0
v_mov_b64 v[112:113],0
v_mov_b64 v[114:115],0
v_mov_b64 v[116:117],0
v_mov_b64 v[118:119],0
s_waitcnt vmcnt(0) lgkmcnt(0)
s_barrier
v_add_u32 v55,131072,v0
ds_read_b128 v[56:59],v55 offset:0
ds_read_b128 v[60:63],v55 offset:4096
ds_read_b128 v[64:67],v55 offset:1024
ds_read_b128 v[68:71],v55 offset:5120
ds_read_b128 v[72:75],v55 offset:2048
ds_read_b128 v[76:79],v55 offset:6144
ds_read_b128 v[80:83],v55 offset:3072
ds_read_b128 v[84:87],v55 offset:7168
v_add_u32 v123,s73,v55
ds_read_b128 v[88:91],v123 offset:8192
ds_read_b128 v[92:95],v123 offset:9216
v_xor_b32 v120,1024,v12
v_xor_b32 v121,2048,v12
v_xor_b32 v122,3072,v12
buffer_load_dwordx4 v[24:27],v13,s[8:11],s64 offen sc1
buffer_load_dwordx4 v[24:27],v13,s[8:11],s64 offen sc1
.p2align 6
L_chain_275:
L_cpa_276:
buffer_load_dwordx4 v[24:27],v13,s[8:11],s64 offen sc1
s_sub_u32 s49,s49,1
s_cbranch_scc1 L_abort2
s_waitcnt vmcnt(2)
v_max3_u32 v123,v24,v25,v26
v_max_u32 v123,v27,v123
v_cmp_le_u32 vcc,s72,v123
ds_write_b128 v12,v[24:27] offset:0
s_cbranch_vccnz L_cpa_276
L_cgo_279:
v_smfmac_f32_16x16x64_bf16 v[96:99],v[24:27],a[0:7],v2
buffer_load_dwordx4 v[40:43],v13,s[8:11],s70 offen sc1
s_waitcnt lgkmcnt(0)
s_barrier
ds_read_b128 v[28:31],v120 offset:0
v_smfmac_f32_16x16x64_bf16 v[100:103],v[24:27],a[128:135],v2
ds_read_b128 v[32:35],v121 offset:0
v_smfmac_f32_16x16x64_bf16 v[104:107],v[24:27],a[8:15],v2
ds_read_b128 v[36:39],v122 offset:0
v_smfmac_f32_16x16x64_bf16 v[108:111],v[24:27],a[136:143],v2
v_smfmac_f32_16x16x64_bf16 v[112:115],v[24:27],v[128:135],v2
v_smfmac_f32_16x16x64_bf16 v[116:119],v[24:27],v[136:143],v2
s_waitcnt lgkmcnt(2)
v_smfmac_f32_16x16x64_bf16 v[96:99],v[28:31],a[16:23],v2
s_add_u32 m0,s73,131072
v_smfmac_f32_16x16x64_bf16 v[100:103],v[28:31],a[144:151],v2
s_add_u32 s57,s67,8192
v_smfmac_f32_16x16x64_bf16 v[104:107],v[28:31],a[24:31],v2
s_cmp_lt_u32 s19,s76
s_cbranch_scc1 L_ckw_268
L_ckb_269:
v_smfmac_f32_16x16x64_bf16 v[108:111],v[28:31],a[152:159],v2
s_waitcnt vmcnt(0) lgkmcnt(1)
v_smfmac_f32_16x16x64_bf16 v[96:99],v[32:35],a[32:39],v2
ds_write_b128 v12,v[40:43] offset:4096
v_max3_u32 v123,v40,v41,v42
v_smfmac_f32_16x16x64_bf16 v[100:103],v[32:35],a[160:167],v2
v_max_u32 v123,v43,v123
v_smfmac_f32_16x16x64_bf16 v[104:107],v[32:35],a[40:47],v2
v_cmp_le_u32 vcc,s72,v123
v_smfmac_f32_16x16x64_bf16 v[108:111],v[32:35],a[168:175],v2
v_smfmac_f32_16x16x64_bf16 v[112:115],v[28:31],v[144:151],v2
s_cbranch_vccnz L_cpb_282
L_cback_284:
s_waitcnt lgkmcnt(0)
s_barrier
v_smfmac_f32_16x16x64_bf16 v[96:99],v[36:39],a[48:55],v2
buffer_store_dword v54,v10,s[8:11],s30 offen sc1
v_smfmac_f32_16x16x64_bf16 v[100:103],v[36:39],a[176:183],v2
ds_read_b128 v[44:47],v120 offset:4096
v_smfmac_f32_16x16x64_bf16 v[104:107],v[36:39],a[56:63],v2
buffer_load_dword v23,v22,s[8:11],s75 offen sc1
v_smfmac_f32_16x16x64_bf16 v[108:111],v[36:39],a[184:191],v2
ds_read_b128 v[48:51],v121 offset:4096
v_smfmac_f32_16x16x64_bf16 v[96:99],v[40:43],a[64:71],v2
buffer_load_dwordx4 v0,s[8:11],s67 offen sc1 lds
v_smfmac_f32_16x16x64_bf16 v[100:103],v[40:43],a[192:199],v2
ds_read_b128 v[52:55],v122 offset:4096
v_smfmac_f32_16x16x64_bf16 v[104:107],v[40:43],a[72:79],v2
buffer_store_dwordx4 v[124:127],v0,s[8:11],s54 offen sc1
v_smfmac_f32_16x16x64_bf16 v[108:111],v[40:43],a[200:207],v2
s_waitcnt lgkmcnt(2)
v_smfmac_f32_16x16x64_bf16 v[96:99],v[44:47],a[80:87],v2
buffer_load_dwordx4 v0,s[8:11],s67 offen offset:1024 sc1 lds
s_add_u32 m0,s73,139264
v_smfmac_f32_16x16x64_bf16 v[100:103],v[44:47],a[208:215],v2
s_waitcnt lgkmcnt(1)
v_smfmac_f32_16x16x64_bf16 v[96:99],v[48:51],a[96:103],v2
buffer_load_dwordx4 v0,s[8:11],s57 offen sc1 lds
s_add_u32 s67,s67,786432
v_smfmac_f32_16x16x64_bf16 v[100:103],v[48:51],a[224:231],v2
s_waitcnt lgkmcnt(0)
v_smfmac_f32_16x16x64_bf16 v[96:99],v[52:55],a[112:119],v2
buffer_load_dwordx4 v0,s[8:11],s57 offen offset:1024 sc1 lds
v_smfmac_f32_16x16x64_bf16 v[100:103],v[52:55],a[240:247],v2
v_smfmac_f32_16x16x64_bf16 v[104:107],v[44:47],a[88:95],v2
v_smfmac_f32_16x16x64_bf16 v[108:111],v[44:47],a[216:223],v2
v_smfmac_f32_16x16x64_bf16 v[104:107],v[48:51],a[104:111],v2
v_add_f32 v96,v96,v98
v_smfmac_f32_16x16x64_bf16 v[108:111],v[48:51],a[232:239],v2
v_add_f32 v97,v97,v99
v_smfmac_f32_16x16x64_bf16 v[104:107],v[52:55],a[120:127],v2
v_cvt_pk_bf16_f32 v120,v96,v97
v_smfmac_f32_16x16x64_bf16 v[108:111],v[52:55],a[248:255],v2
v_add_f32 v100,v100,v102
v_smfmac_f32_16x16x64_bf16 v[116:119],v[28:31],v[152:159],v2
v_add_f32 v101,v101,v103
v_smfmac_f32_16x16x64_bf16 v[112:115],v[32:35],v[160:167],v2
v_cvt_pk_bf16_f32 v121,v100,v101
v_add_f32 v104,v104,v106
v_add_f32 v105,v105,v107
v_cvt_pk_bf16_f32 v122,v104,v105
v_add_f32 v108,v108,v110
v_add_f32 v109,v109,v111
v_cvt_pk_bf16_f32 v123,v108,v109
ds_write_b128 v4,v[120:123]
v_smfmac_f32_16x16x64_bf16 v[116:119],v[32:35],v[168:175],v2
s_mov_b32 s54,s68
s_add_u32 s68,s68,131072
v_mov_b32 v125,0
v_smfmac_f32_16x16x64_bf16 v[112:115],v[36:39],v[176:183],v2
s_cmp_eq_u32 s51,63
s_cbranch_scc1 L_cend_278
v_smfmac_f32_16x16x64_bf16 v[116:119],v[36:39],v[184:191],v2
s_waitcnt lgkmcnt(0)
s_barrier
ds_read_b64_tr_b16 v[96:97],v5 offset:0
v_smfmac_f32_16x16x64_bf16 v[112:115],v[40:43],v[192:199],v2
ds_read_b64_tr_b16 v[98:99],v6 offset:0
v_smfmac_f32_16x16x64_bf16 v[116:119],v[40:43],v[200:207],v2
ds_read_b64_tr_b16 v[100:101],v5 offset:1024
v_smfmac_f32_16x16x64_bf16 v[112:115],v[44:47],v[208:215],v2
ds_read_b64_tr_b16 v[102:103],v6 offset:1024
v_smfmac_f32_16x16x64_bf16 v[116:119],v[44:47],v[216:223],v2
ds_read_b64_tr_b16 v[104:105],v5 offset:2048
v_smfmac_f32_16x16x64_bf16 v[112:115],v[48:51],v[224:231],v2
ds_read_b64_tr_b16 v[106:107],v6 offset:2048
s_waitcnt lgkmcnt(4)
v_mfma_f32_16x16x32_bf16 v[24:27],v[56:59],v[96:99],0
ds_read_b64_tr_b16 v[108:109],v5 offset:3072
v_mfma_f32_16x16x32_bf16 v[28:31],v[60:63],v[96:99],0
ds_read_b64_tr_b16 v[110:111],v6 offset:3072
v_mfma_f32_16x16x32_bf16 v[32:35],v[96:99],v[96:99],0
ds_read_b128 v[40:43],v11 offset:12288
s_waitcnt lgkmcnt(5)
v_mfma_f32_16x16x32_bf16 v[24:27],v[64:67],v[100:103],v[24:27]
ds_read_b128 v[56:59],v11 offset:0
v_mfma_f32_16x16x32_bf16 v[28:31],v[68:71],v[100:103],v[28:31]
ds_read_b128 v[60:63],v11 offset:1024
v_mfma_f32_16x16x32_bf16 v[32:35],v[100:103],v[100:103],v[32:35]
ds_read_b128 v[96:99],v11 offset:8192
s_waitcnt lgkmcnt(6)
v_mfma_f32_16x16x32_bf16 v[24:27],v[72:75],v[104:107],v[24:27]
ds_read_b128 v[64:67],v11 offset:2048
v_mfma_f32_16x16x32_bf16 v[28:31],v[76:79],v[104:107],v[28:31]
ds_read_b128 v[68:71],v11 offset:3072
v_mfma_f32_16x16x32_bf16 v[32:35],v[104:107],v[104:107],v[32:35]
ds_read_b128 v[100:103],v11 offset:9216
s_waitcnt lgkmcnt(7)
v_mfma_f32_16x16x32_bf16 v[24:27],v[80:83],v[108:111],v[24:27]
ds_read_b128 v[72:75],v11 offset:4096
v_mfma_f32_16x16x32_bf16 v[28:31],v[84:87],v[108:111],v[28:31]
ds_read_b128 v[76:79],v11 offset:5120
v_mfma_f32_16x16x32_bf16 v[32:35],v[108:111],v[108:111],v[32:35]
ds_read_b128 v[104:107],v11 offset:10240
v_smfmac_f32_16x16x64_bf16 v[116:119],v[48:51],v[232:239],v2
ds_read_b128 v[80:83],v11 offset:6144
v_smfmac_f32_16x16x64_bf16 v[112:115],v[52:55],v[240:247],v2
ds_read_b128 v[84:87],v11 offset:7168
v_smfmac_f32_16x16x64_bf16 v[116:119],v[52:55],v[248:255],v2
ds_read_b128 v[108:111],v11 offset:11264
v_max3_f32 v126,v24,v25,v26
v_max3_f32 v127,v27,v28,v29
v_max3_f32 v126,v30,v31,v126
v_max3_f32 v127,v34,v35,v127
v_max_f32 v126,v126,v127
v_max_f32 v127,v126,v127
v_pk_mul_f32 v[34:35],v[34:35],v[0:1] op_sel:[0,1]
v_pk_mul_f32 v[24:25],v[24:25],v[0:1] op_sel:[0,1]
v_permlane16_swap_b32 v126,v127
v_max_f32 v126,v126,v127
v_max_f32 v127,v126,v127
v_pk_add_f32 v[112:113],v[112:113],v[114:115]
v_pk_add_f32 v[116:117],v[116:117],v[118:119]
v_permlane32_swap_b32 v126,v127
v_max_f32 v126,v126,v127
v_mul_f32 v126,v1,v126
v_pk_add_f32 v[34:35],v[34:35],v[126:127] op_sel_hi:[1,0] neg_lo:[0,1] neg_hi:[0,1]
v_pk_add_f32 v[24:25],v[24:25],v[126:127] op_sel_hi:[1,0] neg_lo:[0,1] neg_hi:[0,1]
v_pk_fma_f32 v[26:27],v[26:27],v[0:1],v[126:127] op_sel:[0,1,0] op_sel_hi:[1,1,0] neg_lo:[0,0,1] neg_hi:[0,0,1]
v_pk_fma_f32 v[28:29],v[28:29],v[0:1],v[126:127] op_sel:[0,1,0] op_sel_hi:[1,1,0] neg_lo:[0,0,1] neg_hi:[0,0,1]
v_pk_fma_f32 v[30:31],v[30:31],v[0:1],v[126:127] op_sel:[0,1,0] op_sel_hi:[1,1,0] neg_lo:[0,0,1] neg_hi:[0,0,1]
v_exp_f32 v34,v34
v_exp_f32 v35,v35
v_cvt_pk_bf16_f32 v126,v112,v113
v_cvt_pk_bf16_f32 v124,v34,v35
v_cvt_pk_bf16_f32 v127,v116,v117
v_cvt_pk_bf16_f32 v36,v116,v117
v_mfma_f32_16x16x16_bf16 v[32:35],v[14:15],v[124:125],0
ds_read_b128 v[44:47],v11 offset:13312
v_exp_f32 v24,v24
v_mfma_f32_16x16x16_bf16 v[112:115],v[126:127],v[124:125],0
ds_read_b128 v[48:51],v11 offset:14336
v_exp_f32 v25,v25
v_mfma_f32_16x16x16_bf16 v[116:119],v[36:37],v[124:125],0
ds_read_b128 v[52:55],v11 offset:15360
v_exp_f32 v26,v26
v_exp_f32 v27,v27
v_cvt_pk_bf16_f32 v120,v24,v25
v_exp_f32 v28,v28
v_exp_f32 v29,v29
v_cvt_pk_bf16_f32 v121,v26,v27
v_exp_f32 v30,v30
v_exp_f32 v31,v31
v_cvt_pk_bf16_f32 v122,v28,v29
v_cvt_pk_bf16_f32 v123,v30,v31
s_add_u32 s75,s75,8192
s_add_u32 s51,s51,1
v_mfma_f32_16x16x32_bf16 v[32:35],v[14:17],v[120:123],v[32:35]
v_mfma_f32_16x16x32_bf16 v[112:115],v[88:91],v[120:123],v[112:115]
ds_read_b128 v[88:91],v11 offset:16384
v_mfma_f32_16x16x32_bf16 v[116:119],v[92:95],v[120:123],v[116:119]
ds_read_b128 v[92:95],v11 offset:17408
v_rcp_f32 v32,v32
v_mov_b64 v[24:25],-1
v_mov_b64 v[26:27],-1
s_add_u32 s64,s75,12582912
s_add_u32 s70,s64,4096
v_pk_mul_f32 v[112:113],v[112:113],v[32:33] op_sel_hi:[1,0]
v_pk_mul_f32 v[114:115],v[114:115],v[32:33] op_sel_hi:[1,0]
v_pk_mul_f32 v[116:117],v[116:117],v[32:33] op_sel_hi:[1,0]
v_pk_mul_f32 v[118:119],v[118:119],v[32:33] op_sel_hi:[1,0]
v_cvt_pk_bf16_f32 v120,v112,v116
v_cvt_pk_bf16_f32 v121,v113,v117
v_cvt_pk_bf16_f32 v122,v114,v118
v_cvt_pk_bf16_f32 v123,v115,v119
ds_write_b128 v7,v[120:123]
buffer_store_dwordx4 v[24:27],v0,s[8:11],s69 offen sc1
buffer_store_dwordx4 v[24:27],v0,s[8:11],s69 offen offset:1024 sc1
v_mov_b64 v[112:113],0
v_mov_b64 v[114:115],0
v_mov_b64 v[116:117],0
v_mov_b64 v[118:119],0
s_waitcnt lgkmcnt(0)
s_barrier
ds_read_b128 v[24:27],v8 offset:0
ds_read_b128 v[28:31],v8 offset:512
ds_read_b128 v[32:35],v8 offset:1024
ds_read_b128 v[36:39],v8 offset:1536
v_mov_b64 v[120:121],0
v_mov_b64 v[122:123],0
s_add_u32 s57,s65,65536
s_add_u32 s58,s65,131072
s_add_u32 s59,s65,196608
s_add_u32 s56,s18,s75
s_add_u32 s30,s75,17825792
s_waitcnt lgkmcnt(3)
v_smfmac_f32_16x16x64_bf16 v[112:115],v[24:27],v[56:63],v3
ds_read_b128 v[56:59],v11 offset:18432
s_waitcnt lgkmcnt(3)
v_smfmac_f32_16x16x64_bf16 v[112:115],v[28:31],v[64:71],v3
ds_read_b128 v[60:63],v11 offset:19456
s_waitcnt lgkmcnt(3)
v_smfmac_f32_16x16x64_bf16 v[112:115],v[32:35],v[72:79],v3
ds_read_b128 v[64:67],v11 offset:20480
s_waitcnt lgkmcnt(3)
v_smfmac_f32_16x16x64_bf16 v[112:115],v[36:39],v[80:87],v3
ds_read_b128 v[68:71],v11 offset:21504
v_smfmac_f32_16x16x64_bf16 v[116:119],v[24:27],v[96:103],v3
ds_read_b128 v[72:75],v11 offset:22528
v_smfmac_f32_16x16x64_bf16 v[116:119],v[28:31],v[104:111],v3
ds_read_b128 v[76:79],v11 offset:23552
v_cvt_pk_bf16_f32 v112,v112,v113
v_smfmac_f32_16x16x64_bf16 v[116:119],v[32:35],v[40:47],v3
ds_read_b128 v[80:83],v11 offset:24576
v_cvt_pk_bf16_f32 v113,v114,v115
buffer_store_dwordx2 v[112:113],v9,s[8:11],s65 offen sc1
v_smfmac_f32_16x16x64_bf16 v[116:119],v[36:39],v[48:55],v3
ds_read_b128 v[84:87],v11 offset:25600
v_mov_b64 v[112:113],0
v_smfmac_f32_16x16x64_bf16 v[120:123],v[24:27],v[88:95],v3
ds_read_b128 v[96:99],v11 offset:26624
ds_read_b128 v[100:103],v11 offset:27648
v_mov_b64 v[114:115],0
s_waitcnt lgkmcnt(8)
v_smfmac_f32_16x16x64_bf16 v[120:123],v[28:31],v[56:63],v3
ds_read_b128 v[104:107],v11 offset:28672
v_cvt_pk_bf16_f32 v116,v116,v117
s_waitcnt lgkmcnt(7)
v_smfmac_f32_16x16x64_bf16 v[120:123],v[32:35],v[64:71],v3
ds_read_b128 v[108:111],v11 offset:29696
ds_read_b128 v[40:43],v11 offset:30720
v_cvt_pk_bf16_f32 v117,v118,v119
buffer_store_dwordx2 v[116:117],v9,s[8:11],s57 offen sc1
s_waitcnt lgkmcnt(7)
v_smfmac_f32_16x16x64_bf16 v[120:123],v[36:39],v[72:79],v3
ds_read_b128 v[44:47],v11 offset:31744
v_add_u32 v52,s50,v5
s_waitcnt lgkmcnt(6)
v_smfmac_f32_16x16x64_bf16 v[112:115],v[24:27],v[80:87],v3
v_add_u32 v54,s50,v6
s_waitcnt lgkmcnt(4)
v_smfmac_f32_16x16x64_bf16 v[112:115],v[28:31],v[96:103],v3
ds_read_b64_tr_b16 v[52:53],v52
v_cvt_pk_bf16_f32 v120,v120,v121
s_waitcnt lgkmcnt(3)
v_smfmac_f32_16x16x64_bf16 v[112:115],v[32:35],v[104:111],v3
ds_read_b64_tr_b16 v[54:55],v54
v_cvt_pk_bf16_f32 v121,v122,v123
buffer_store_dwordx2 v[120:121],v9,s[8:11],s58 offen sc1
s_waitcnt lgkmcnt(2)
v_smfmac_f32_16x16x64_bf16 v[112:115],v[36:39],v[40:47],v3
v_mov_b64 v[116:117],0
v_mov_b64 v[118:119],0
s_xor_b32 s65,s65,262144
v_mov_b32_dpp v124,v126 quad_perm:[2,3,2,3] row_mask:0xf bank_mask:0xf
v_mov_b32_dpp v125,v127 quad_perm:[2,3,2,3] row_mask:0xf bank_mask:0xf
s_mov_b32 vcc_lo,0xcccccccc
s_mov_b32 vcc_hi,0xcccccccc
s_nop 0
v_cvt_pk_bf16_f32 v112,v112,v113
v_cvt_pk_bf16_f32 v113,v114,v115
buffer_store_dwordx2 v[112:113],v9,s[8:11],s59 offen sc1
s_waitcnt lgkmcnt(0)
s_buffer_load_dword s19,s[8:11],s56
v_cndmask_b32 v124,v124,v52,vcc
v_cndmask_b32 v125,v125,v53,vcc
s_cmp_lt_u32 s46,2
s_waitcnt vmcnt(3)
s_cbranch_scc1 L_crg_285
s_cmp_eq_u32 s46,2
s_waitcnt vmcnt(1)
s_cbranch_scc1 L_crg_285
s_waitcnt vmcnt(0)
L_crg_285:
buffer_load_dwordx4 v[32:35],v0,s[8:11],s66 offen offset:0 sc1
buffer_load_dwordx4 v[36:39],v0,s[8:11],s66 offen offset:1024 sc1
v_cndmask_b32 v126,v126,v54,vcc
v_cndmask_b32 v127,v127,v55,vcc
v_mov_b64 v[96:97],0
v_mov_b64 v[98:99],0
v_mov_b64 v[100:101],0
v_mov_b64 v[102:103],0
v_mov_b64 v[104:105],0
v_mov_b64 v[106:107],0
v_mov_b64 v[108:109],0
v_mov_b64 v[110:111],0
v_mov_b64 v[112:113],0
v_mov_b64 v[114:115],0
v_add_u32 v55,131072,v0
v_add_u32 v123,s73,v55
v_xor_b32 v120,1024,v12
v_xor_b32 v121,2048,v12
v_xor_b32 v122,3072,v12
buffer_load_dwordx4 v[44:47],v0,s[8:11],s66 offen offset:0 sc1
buffer_load_dwordx4 v[48:51],v0,s[8:11],s66 offen offset:1024 sc1
s_cmp_ge_u32 s51,63
s_cselect_b32 s76,0,1
s_cmp_eq_u32 s46,0
s_cselect_b32 s76,s76,0
s_waitcnt vmcnt(3)
v_mfma_f32_16x16x32_bf16 v[28:31],v[18:21],v[32:35],0
s_waitcnt vmcnt(2)
v_mfma_f32_16x16x32_bf16 v[28:31],v[18:21],v[36:39],v[28:31]
s_nop 7
v_cmp_u_f32 vcc,v28,v28
v_add_f32_dpp v52,v28,v28 row_ror:8 row_mask:0xf bank_mask:0x3
v_add_f32_dpp v53,v29,v29 row_ror:8 row_mask:0xf bank_mask:0x3
v_add_f32_dpp v52,v30,v30 row_ror:8 row_mask:0xf bank_mask:0xc
v_add_f32_dpp v53,v31,v31 row_ror:8 row_mask:0xf bank_mask:0xc
s_cbranch_vccnz L_crp_280
L_cok_286:
v_add_f32_dpp v52,v52,v52 row_shl:4 row_mask:0xf bank_mask:0x5
v_add_f32_dpp v53,v53,v53 row_shl:4 row_mask:0xf bank_mask:0x5
v_cvt_pk_bf16_f32 v54,v52,v53
buffer_store_dword v54,v10,s[8:11],s64 offen sc1
s_mov_b32 s69,s66
s_xor_b32 s66,s66,262144
s_barrier
ds_read_b128 v[56:59],v55 offset:0
ds_read_b128 v[60:63],v55 offset:4096
ds_read_b128 v[64:67],v55 offset:1024
buffer_load_dwordx4 v[24:27],v13,s[8:11],s64 offen sc1
ds_read_b128 v[68:71],v55 offset:5120
ds_read_b128 v[72:75],v55 offset:2048
ds_read_b128 v[76:79],v55 offset:6144
ds_read_b128 v[80:83],v55 offset:3072
buffer_load_dwordx4 v[24:27],v13,s[8:11],s64 offen sc1
ds_read_b128 v[84:87],v55 offset:7168
ds_read_b128 v[88:91],v123 offset:8192
ds_read_b128 v[92:95],v123 offset:9216
s_branch L_chain_275
L_cpb_282:
buffer_load_dwordx4 v[40:43],v13,s[8:11],s70 offen sc1
s_sub_u32 s49,s49,1
s_cbranch_scc1 L_abort2
s_waitcnt vmcnt(0)
v_max3_u32 v123,v40,v41,v42
v_max_u32 v123,v43,v123
v_cmp_le_u32 vcc,s72,v123
s_cbranch_vccnz L_cpb_282
ds_write_b128 v12,v[40:43] offset:4096
s_branch L_cback_284
L_crp_280:
buffer_load_dwordx4 v[32:35],v0,s[8:11],s66 offen offset:0 sc1
buffer_load_dwordx4 v[36:39],v0,s[8:11],s66 offen offset:1024 sc1
s_sub_u32 s49,s49,1
s_cbranch_scc1 L_abort2
s_waitcnt vmcnt(3)
v_mfma_f32_16x16x32_bf16 v[28:31],v[18:21],v[44:47],0
s_waitcnt vmcnt(2)
v_mfma_f32_16x16x32_bf16 v[28:31],v[18:21],v[48:51],v[28:31]
s_nop 7
v_cmp_u_f32 vcc,v28,v28
v_add_f32_dpp v52,v28,v28 row_ror:8 row_mask:0xf bank_mask:0x3
v_add_f32_dpp v53,v29,v29 row_ror:8 row_mask:0xf bank_mask:0x3
v_add_f32_dpp v52,v30,v30 row_ror:8 row_mask:0xf bank_mask:0xc
v_add_f32_dpp v53,v31,v31 row_ror:8 row_mask:0xf bank_mask:0xc
s_cbranch_vccz L_cok_286
buffer_load_dwordx4 v[44:47],v0,s[8:11],s66 offen offset:0 sc1
buffer_load_dwordx4 v[48:51],v0,s[8:11],s66 offen offset:1024 sc1
s_sub_u32 s49,s49,1
s_cbranch_scc1 L_abort2
s_waitcnt vmcnt(3)
v_mfma_f32_16x16x32_bf16 v[28:31],v[18:21],v[32:35],0
s_waitcnt vmcnt(2)
v_mfma_f32_16x16x32_bf16 v[28:31],v[18:21],v[36:39],v[28:31]
s_nop 7
v_cmp_u_f32 vcc,v28,v28
v_add_f32_dpp v52,v28,v28 row_ror:8 row_mask:0xf bank_mask:0x3
v_add_f32_dpp v53,v29,v29 row_ror:8 row_mask:0xf bank_mask:0x3
v_add_f32_dpp v52,v30,v30 row_ror:8 row_mask:0xf bank_mask:0xc
v_add_f32_dpp v53,v31,v31 row_ror:8 row_mask:0xf bank_mask:0xc
s_cbranch_vccz L_cok_286
s_branch L_crp_280
L_ckw_268:
s_add_u32 s59,s18,s75
L_ww_287:
s_sleep 1
buffer_load_dword v23,off,s[8:11],s59 sc1
s_sub_u32 s49,s49,1
s_cbranch_scc1 L_abort2
s_waitcnt vmcnt(0)
v_readfirstlane_b32 s76,v23
s_cmp_eq_u32 s76,0
s_cbranch_scc1 L_ww_287
L_wwd_288:
s_branch L_ckb_269
L_cend_278:
v_smfmac_f32_16x16x64_bf16 v[116:119],v[36:39],v[184:191],v2
v_smfmac_f32_16x16x64_bf16 v[112:115],v[40:43],v[192:199],v2
v_smfmac_f32_16x16x64_bf16 v[116:119],v[40:43],v[200:207],v2
v_smfmac_f32_16x16x64_bf16 v[112:115],v[44:47],v[208:215],v2
v_smfmac_f32_16x16x64_bf16 v[116:119],v[44:47],v[216:223],v2
v_smfmac_f32_16x16x64_bf16 v[112:115],v[48:51],v[224:231],v2
v_smfmac_f32_16x16x64_bf16 v[116:119],v[48:51],v[232:239],v2
v_smfmac_f32_16x16x64_bf16 v[112:115],v[52:55],v[240:247],v2
v_smfmac_f32_16x16x64_bf16 v[116:119],v[52:55],v[248:255],v2
s_waitcnt lgkmcnt(0)
s_nop 2
v_pk_add_f32 v[112:113],v[112:113],v[114:115]
s_nop 2
v_pk_add_f32 v[116:117],v[116:117],v[118:119]
v_cvt_pk_bf16_f32 v126,v112,v113
v_cvt_pk_bf16_f32 v127,v116,v117
v_add_u32 v52,s50,v5
v_add_u32 v54,s50,v6
ds_read_b64_tr_b16 v[52:53],v52
ds_read_b64_tr_b16 v[54:55],v54
v_mov_b32_dpp v124,v126 quad_perm:[2,3,2,3] row_mask:0xf bank_mask:0xf
v_mov_b32_dpp v125,v127 quad_perm:[2,3,2,3] row_mask:0xf bank_mask:0xf
s_mov_b32 vcc_lo,0xcccccccc
s_mov_b32 vcc_hi,0xcccccccc
s_waitcnt lgkmcnt(0)
v_cndmask_b32 v124,v124,v52,vcc
v_cndmask_b32 v125,v125,v53,vcc
v_cndmask_b32 v126,v126,v54,vcc
v_cndmask_b32 v127,v127,v55,vcc
buffer_store_dwordx4 v[124:127],v0,s[8:11],s54 offen sc1
s_mov_b32 s51,64
s_waitcnt vmcnt(0)
s_barrier
s_nop 11
v_lshrrev_b32 v1,4,v0
s_endpgm
L_rc2_238:
v_and_b32 v120,15,v1
v_lshrrev_b32 v121,4,v1
v_and_b32 v122,2,v1
v_cmp_eq_u32 vcc,0,v122
v_mov_b32 v2,0xeeee
v_mov_b32 v123,0x4444
v_cndmask_b32 v2,v2,v123,vcc
v_and_b32 v122,1,v1
v_cmp_eq_u32 vcc,0,v122
v_mov_b32 v3,0xdddd
v_mov_b32 v123,0x8888
v_cndmask_b32 v3,v3,v123,vcc
v_lshrrev_b32 v122,1,v120
v_bfe_u32 v123,v120,2,1
v_xor_b32 v123,v123,v122
v_lshlrev_b32 v4,7,v123
v_and_b32 v123,1,v120
v_lshl_add_u32 v4,v123,6,v4
v_xor_b32 v123,v121,v122
v_and_b32 v123,3,v123
v_lshl_add_u32 v4,v123,4,v4
s_lshl_b32 s56,s46,10
s_add_u32 s56,s56,147456
v_add_u32 v4,s56,v4
v_lshlrev_b32 v122,1,v121
v_add_u32 v122,0,v122
v_and_b32 v123,1,v121
v_xor_b32 v123,v123,v122
v_lshlrev_b32 v5,7,v123
v_bfe_u32 v123,v120,3,1
v_lshl_add_u32 v5,v123,6,v5
v_xor_b32 v123,v120,v122
v_and_b32 v123,3,v123
v_lshl_add_u32 v5,v123,4,v5
v_bfe_u32 v123,v120,2,1
v_lshl_add_u32 v5,v123,3,v5
v_add_u32 v5,147456,v5
v_lshlrev_b32 v122,1,v121
v_add_u32 v122,1,v122
v_and_b32 v123,1,v121
v_xor_b32 v123,v123,v122
v_lshlrev_b32 v6,7,v123
v_bfe_u32 v123,v120,3,1
v_lshl_add_u32 v6,v123,6,v6
v_xor_b32 v123,v120,v122
v_and_b32 v123,3,v123
v_lshl_add_u32 v6,v123,4,v6
v_bfe_u32 v123,v120,2,1
v_lshl_add_u32 v6,v123,3,v6
v_add_u32 v6,147456,v6
v_lshlrev_b32 v7,7,v121
v_lshrrev_b32 v122,1,v120
v_lshl_add_u32 v8,v122,4,v7
v_add_u32 v8,151552,v8
v_lshrrev_b32 v122,2,v120
v_lshl_add_u32 v7,v122,5,v7
v_and_b32 v122,1,v120
v_lshl_add_u32 v7,v122,4,v7
v_and_b32 v122,2,v120
v_cmp_eq_u32 vcc,0,v122
s_lshl_b32 s56,s46,9
v_mov_b32 v122,2048
v_mov_b32 v123,s56
v_cndmask_b32 v122,v122,v123,vcc
v_add_u32 v7,v122,v7
v_add_u32 v7,151552,v7
v_lshrrev_b32 v122,3,v1
v_lshlrev_b32 v9,11,v122
v_and_b32 v122,7,v1
v_lshl_add_u32 v9,v122,3,v9
s_lshl_b32 s56,s46,14
s_lshl_b32 s57,s47,6
s_add_u32 s56,s56,s57
v_add_u32 v9,s56,v9
s_lshl_b32 s71,s46,5
s_add_u32 s71,s71,s47
s_bfe_u32 s56,s71,0x10003
s_lshl_b32 s56,s56,11
s_and_b32 s57,s71,1
s_lshl_b32 s57,s57,10
s_add_u32 s56,s56,s57
s_bfe_u32 s57,s71,0x10002
s_lshl_b32 s57,s57,9
s_add_u32 s56,s56,s57
s_bfe_u32 s57,s71,0x10001
s_lshl_b32 s57,s57,6
s_add_u32 s56,s56,s57
s_bfe_u32 s57,s71,0x10004
s_lshl_b32 s57,s57,8
s_add_u32 s56,s56,s57
s_bfe_u32 s57,s71,0x10005
s_lshl_b32 s57,s57,7
s_add_u32 s56,s56,s57
s_bfe_u32 s57,s71,0x10006
s_lshl_b32 s57,s57,12
s_add_u32 s56,s56,s57
v_and_b32 v122,3,v120
v_lshlrev_b32 v10,2,v122
v_bfe_u32 v122,v120,3,1
v_lshl_add_u32 v10,v122,4,v10
v_and_b32 v122,1,v121
v_lshl_add_u32 v10,v122,5,v10
v_add_u32 v10,s56,v10
v_and_b32 v123,36,v1
v_mov_b32 v122,0x80000000
v_cmp_eq_u32 vcc,0,v123
s_nop 1
v_cndmask_b32 v10,v122,v10,vcc
s_lshl_b32 s71,s71,11
s_lshl_b32 s73,s46,11
s_mov_b32 s72,0xffc00000
s_mov_b32 s74,0
v_and_b32 v11,1,v121
v_xor_b32 v11,v11,v120
v_and_b32 v11,3,v11
v_lshrrev_b32 v122,2,v120
v_lshl_add_u32 v11,v11,2,v122
v_lshl_add_u32 v11,v121,4,v11
v_lshlrev_b32 v11,4,v11
s_lshl_b32 s56,s46,15
v_add_u32 v11,s56,v11
v_lshrrev_b32 v13,3,v1
v_lshlrev_b32 v13,9,v13
v_and_b32 v122,7,v1
v_lshl_add_u32 v13,v122,4,v13
v_and_b32 v122,15,v1
v_and_b32 v123,1,v1
v_lshlrev_b32 v123,4,v123
v_mov_b32 v124,0x3f80
v_lshlrev_b32 v124,v123,v124
v_lshrrev_b32 v122,1,v122
v_cmp_eq_u32 vcc,0,v122
s_nop 1
v_cndmask_b32 v18,0,v124,vcc
v_cmp_eq_u32 vcc,1,v122
s_nop 1
v_cndmask_b32 v19,0,v124,vcc
v_cmp_eq_u32 vcc,2,v122
s_nop 1
v_cndmask_b32 v20,0,v124,vcc
v_cmp_eq_u32 vcc,3,v122
s_nop 1
v_cndmask_b32 v21,0,v124,vcc
s_and_b32 s56,s46,1
s_lshl_b32 s56,s56,8
s_and_b32 s57,s46,2
s_lshl_b32 s57,s57,6
s_add_u32 s56,s56,s57
v_add_u32 v13,s56,v13
s_add_u32 s56,s50,155648
v_add_u32 v12,s56,v0
v_mov_b64 v[14:15],s[28:29]
v_mov_b64 v[16:17],s[28:29]
v_add_u32 v22,13647872,v10
s_lshl_b32 s18,s47,2
s_add_u32 s18,s18,10494080
v_mov_b32 v1,s80
s_mov_b32 s65,16777216
s_add_u32 s66,s71,16777216
s_add_u32 s69,s71,17039360
s_mov_b32 s30,0x40000000
s_mov_b32 s51,0
v_lshrrev_b32 v120,2,v0
v_add_u32 v120,10510464,v120
v_or_b32 v120,s52,v120
s_mov_b64 vcc,-1
s_mov_b32 vcc_lo,0
v_cndmask_b32 v22,v22,v120,vcc
s_or_b32 s56,s52,10495616
v_writelane_b32 v22,s56,4
s_or_b32 s56,s47,s46
s_mov_b32 s56,10486784
s_cmov_b32 s56,0x80000000
v_writelane_b32 v22,s56,5
s_mov_b32 s30,0
s_mov_b32 s31,0
L_cst_292:
s_cmp_lg_u32 s46,0
s_cbranch_scc1 L_csw_297
s_andn2_b32 s61,0x7ff,s30
s_lshr_b32 s61,s61,5
s_add_u32 s61,s61,2
s_add_u32 s60,s31,1
s_min_u32 s60,s60,63
s_cmp_gt_u32 s60,s61
s_cselect_b32 s60,s31,s60
s_sub_u32 s61,s60,s31
s_lshl_b32 s61,s61,13
s_lshl_b32 s59,s31,13
s_add_u32 s59,s59,10486016
v_lshrrev_b32 v121,2,v0
v_and_b32 v121,127,v121
v_lshrrev_b32 v120,9,v0
v_mul_u32_u24 v120,s61,v120
v_add_u32 v121,v120,v121
L_ckk_298:
s_sleep 1
buffer_load_dword v120,v121,s[8:11],s59 offen sc1
s_sub_u32 s49,s49,1
s_cbranch_scc1 L_abort2
s_waitcnt vmcnt(0)
v_cmp_eq_u32 vcc,0,v120
s_cbranch_vccnz L_ckk_298
v_max_u32_dpp v120,v120,v120 row_ror:8 row_mask:0xf bank_mask:0xf
s_nop 1
v_max_u32_dpp v120,v120,v120 row_ror:4 row_mask:0xf bank_mask:0xf
s_nop 1
v_max_u32_dpp v120,v120,v120 row_ror:2 row_mask:0xf bank_mask:0xf
s_nop 1
v_max_u32_dpp v120,v120,v120 row_ror:1 row_mask:0xf bank_mask:0xf
v_mov_b32 v121,v120
s_nop 1
v_permlane16_swap_b32 v120,v121
v_max_u32 v120,v120,v121
v_mov_b32 v121,v120
s_nop 1
v_permlane32_swap_b32 v120,v121
v_max_u32 v120,v120,v121
s_nop 0
v_readfirstlane_b32 s61,v120
s_max_u32 s30,s30,s61
s_add_u32 s31,s60,1
s_andn2_b32 s51,0x7ff,s30
s_lshr_b32 s51,s51,5
s_add_u32 s61,s51,2
s_min_u32 s61,s61,63
s_cmp_le_u32 s31,s61
s_cbranch_scc1 L_cst_292
v_mov_b32 v120,0
v_mov_b32 v121,s30
ds_write_b32 v8,v120 offset:2560
ds_write_b32 v8,v121 offset:3072
s_lshl_b32 s59,s51,13
s_lshl2_add_u32 s59,s47,s59
s_add_u32 s59,s59,10485888
L_ww_299:
s_sleep 1
buffer_load_dword v122,off,s[8:11],s59 sc1
s_sub_u32 s49,s49,1
s_cbranch_scc1 L_abort2
s_waitcnt vmcnt(0)
v_readfirstlane_b32 s61,v122
s_cmp_eq_u32 s61,0
s_cbranch_scc1 L_ww_299
L_wwd_300:
L_csw_297:
s_waitcnt lgkmcnt(0)
s_barrier
ds_read_b32 v120,v8 offset:3072
s_waitcnt lgkmcnt(0)
v_readfirstlane_b32 s30,v120
s_andn2_b32 s51,0x7ff,s30
s_lshr_b32 s51,s51,5
s_lshl_b32 s56,s51,5
s_add_u32 s56,s56,s47
s_mul_i32 s56,s56,24576
s_add_u32 s56,s56,150994944
s_add_u32 s67,s56,s73
s_add_u32 m0,s73,131072
s_add_u32 s57,s67,8192
buffer_load_dwordx4 v0,s[8:11],s67 offen sc1 lds
buffer_load_dwordx4 v0,s[8:11],s67 offen offset:1024 sc1 lds
s_add_u32 m0,s73,139264
s_add_u32 s67,s67,786432
buffer_load_dwordx4 v0,s[8:11],s57 offen sc1 lds
buffer_load_dwordx4 v0,s[8:11],s57 offen offset:1024 sc1 lds
s_lshl_b32 s75,s51,13
s_add_u32 s56,s75,13639680
buffer_load_dword v23,v10,s[8:11],s56 offen sc1
s_add_u32 s64,s75,17825792
s_add_u32 s70,s64,4096
s_lshl_b32 s68,s51,5
s_add_u32 s68,s68,s47
s_lshl_b32 s68,s68,12
s_lshl_b32 s56,s46,10
s_add_u32 s68,s68,s56
s_add_u32 s68,s68,75497472
s_mov_b32 s54,0x80000000
s_mov_b32 s77,0
s_add_u32 s56,s18,s75
s_buffer_load_dword s19,s[8:11],s56
s_cmp_eq_u32 s51,63
s_cselect_b32 s76,1,s46
s_cmp_eq_u32 s76,0
s_cselect_b32 s76,1,0
v_mov_b64 v[96:97],0
v_mov_b64 v[98:99],0
v_mov_b64 v[100:101],0
v_mov_b64 v[102:103],0
v_mov_b64 v[104:105],0
v_mov_b64 v[106:107],0
v_mov_b64 v[108:109],0
v_mov_b64 v[110:111],0
v_mov_b64 v[112:113],0
v_mov_b64 v[114:115],0
v_mov_b64 v[116:117],0
v_mov_b64 v[118:119],0
v_lshrrev_b32 v56,8,v0
v_lshlrev_b32 v56,5,v56
v_bfe_u32 v57,v0,5,1
v_lshl_add_u32 v56,v57,2,v56
s_lshl_b32 s56,s46,7
s_add_u32 s56,s56,155648
v_add_u32 v56,s56,v56
v_xor_b32 v57,128,v56
v_xor_b32 v58,256,v56
v_xor_b32 v59,384,v56
s_andn2_b32 s56,31,s30
s_lshr_b32 s57,s56,4
s_lshl_b32 s58,s57,12
s_and_b32 s59,s56,15
s_lshl4_add_u32 s58,s59,s58
s_add_u32 s58,s58,s50
s_add_u32 s58,s58,131072
v_bfe_u32 v60,v0,6,2
v_lshlrev_b32 v60,8,v60
v_bfe_u32 v61,v0,4,2
v_lshl_add_u32 v60,v61,2,v60
v_add_u32 v60,s58,v60
s_lshr_b32 s58,s59,2
s_lshl_b32 s58,s58,8
s_lshl3_add_u32 s58,s57,s58
s_and_b32 s59,s56,3
s_lshl1_add_u32 s58,s59,s58
s_add_u32 s58,s58,s73
s_add_u32 s58,s58,139264
v_and_b32 v61,255,v0
v_add_u32 v61,s58,v61
s_cmp_lg_u32 s46,0
s_cbranch_scc1 L_chd_302
s_lshl_b32 s59,s51,10
s_add_u32 s59,s59,11337728
L_chp_301:
buffer_load_dwordx4 v[120:123],v0,s[8:11],s59 offen sc1
s_sub_u32 s49,s49,1
s_cbranch_scc1 L_abort2
s_waitcnt vmcnt(0)
v_max3_u32 v124,v120,v121,v122
v_max_u32 v124,v123,v124
v_cmp_eq_u32 vcc,-1,v124
s_cbranch_vccnz L_chp_301
ds_write_b128 v12,v[120:123]
L_chd_302:
s_waitcnt vmcnt(0) lgkmcnt(0)
s_barrier
ds_read2_b32 v[24:25],v56 offset0:0 offset1:2
ds_read2_b32 v[26:27],v56 offset0:4 offset1:6
ds_read2_b32 v[28:29],v57 offset0:0 offset1:2
ds_read2_b32 v[30:31],v57 offset0:4 offset1:6
ds_read2_b32 v[32:33],v58 offset0:0 offset1:2
ds_read2_b32 v[34:35],v58 offset0:4 offset1:6
ds_read2_b32 v[36:37],v59 offset0:0 offset1:2
ds_read2_b32 v[38:39],v59 offset0:4 offset1:6
s_waitcnt lgkmcnt(4)
ds_read2_b32 v[40:41],v56 offset0:128 offset1:130
ds_read2_b32 v[42:43],v56 offset0:132 offset1:134
ds_read2_b32 v[44:45],v57 offset0:128 offset1:130
ds_read2_b32 v[46:47],v57 offset0:132 offset1:134
ds_read2_b32 v[48:49],v58 offset0:128 offset1:130
ds_read2_b32 v[50:51],v58 offset0:132 offset1:134
ds_read2_b32 v[52:53],v59 offset0:128 offset1:130
ds_read2_b32 v[54:55],v59 offset0:132 offset1:134
s_waitcnt lgkmcnt(12)
v_smfmac_f32_16x16x64_bf16 v[100:103],v[24:27],a[128:135],v2
v_smfmac_f32_16x16x64_bf16 v[112:115],v[24:27],v[128:135],v2
v_smfmac_f32_16x16x64_bf16 v[108:111],v[24:27],a[136:143],v2
v_smfmac_f32_16x16x64_bf16 v[116:119],v[24:27],v[136:143],v2
s_waitcnt lgkmcnt(12)
v_smfmac_f32_16x16x64_bf16 v[100:103],v[28:31],a[144:151],v2
v_smfmac_f32_16x16x64_bf16 v[112:115],v[28:31],v[144:151],v2
v_smfmac_f32_16x16x64_bf16 v[108:111],v[28:31],a[152:159],v2
v_smfmac_f32_16x16x64_bf16 v[116:119],v[28:31],v[152:159],v2
s_waitcnt lgkmcnt(10)
v_smfmac_f32_16x16x64_bf16 v[100:103],v[32:35],a[160:167],v2
v_smfmac_f32_16x16x64_bf16 v[112:115],v[32:35],v[160:167],v2
v_smfmac_f32_16x16x64_bf16 v[108:111],v[32:35],a[168:175],v2
v_smfmac_f32_16x16x64_bf16 v[116:119],v[32:35],v[168:175],v2
s_waitcnt lgkmcnt(8)
v_smfmac_f32_16x16x64_bf16 v[100:103],v[36:39],a[176:183],v2
v_smfmac_f32_16x16x64_bf16 v[112:115],v[36:39],v[176:183],v2
v_smfmac_f32_16x16x64_bf16 v[108:111],v[36:39],a[184:191],v2
v_smfmac_f32_16x16x64_bf16 v[116:119],v[36:39],v[184:191],v2
s_waitcnt lgkmcnt(6)
v_smfmac_f32_16x16x64_bf16 v[100:103],v[40:43],a[192:199],v2
v_smfmac_f32_16x16x64_bf16 v[112:115],v[40:43],v[192:199],v2
v_smfmac_f32_16x16x64_bf16 v[108:111],v[40:43],a[200:207],v2
v_smfmac_f32_16x16x64_bf16 v[116:119],v[40:43],v[200:207],v2
s_waitcnt lgkmcnt(4)
v_smfmac_f32_16x16x64_bf16 v[100:103],v[44:47],a[208:215],v2
v_smfmac_f32_16x16x64_bf16 v[112:115],v[44:47],v[208:215],v2
v_smfmac_f32_16x16x64_bf16 v[108:111],v[44:47],a[216:223],v2
v_smfmac_f32_16x16x64_bf16 v[116:119],v[44:47],v[216:223],v2
s_waitcnt lgkmcnt(2)
v_smfmac_f32_16x16x64_bf16 v[100:103],v[48:51],a[224:231],v2
v_smfmac_f32_16x16x64_bf16 v[112:115],v[48:51],v[224:231],v2
v_smfmac_f32_16x16x64_bf16 v[108:111],v[48:51],a[232:239],v2
v_smfmac_f32_16x16x64_bf16 v[116:119],v[48:51],v[232:239],v2
s_waitcnt lgkmcnt(0)
v_smfmac_f32_16x16x64_bf16 v[100:103],v[52:55],a[240:247],v2
v_smfmac_f32_16x16x64_bf16 v[112:115],v[52:55],v[240:247],v2
v_smfmac_f32_16x16x64_bf16 v[108:111],v[52:55],a[248:255],v2
v_smfmac_f32_16x16x64_bf16 v[116:119],v[52:55],v[248:255],v2
v_add_f32 v100,v100,v102
v_add_f32 v112,v112,v114
s_nop 1
v_add_f32 v108,v108,v110
s_nop 2
v_add_f32 v116,v116,v118
v_cvt_pk_bf16_f32 v120,v100,v108
v_cvt_pk_bf16_f32 v121,v112,v116
ds_write_b32 v60,v120
ds_write_b16 v61,v121
ds_write_b16_d16_hi v61,v121 offset:1024
v_mov_b64 v[96:97],0
v_mov_b64 v[98:99],0
v_mov_b64 v[100:101],0
v_mov_b64 v[102:103],0
v_mov_b64 v[104:105],0
v_mov_b64 v[106:107],0
v_mov_b64 v[108:109],0
v_mov_b64 v[110:111],0
v_mov_b64 v[112:113],0
v_mov_b64 v[114:115],0
v_mov_b64 v[116:117],0
v_mov_b64 v[118:119],0
s_waitcnt vmcnt(0) lgkmcnt(0)
s_barrier
v_add_u32 v55,131072,v0
ds_read_b128 v[56:59],v55 offset:0
ds_read_b128 v[60:63],v55 offset:4096
ds_read_b128 v[64:67],v55 offset:1024
ds_read_b128 v[68:71],v55 offset:5120
ds_read_b128 v[72:75],v55 offset:2048
ds_read_b128 v[76:79],v55 offset:6144
ds_read_b128 v[80:83],v55 offset:3072
ds_read_b128 v[84:87],v55 offset:7168
v_add_u32 v123,s73,v55
ds_read_b128 v[88:91],v123 offset:8192
ds_read_b128 v[92:95],v123 offset:9216
v_xor_b32 v120,1024,v12
v_xor_b32 v121,2048,v12
v_xor_b32 v122,3072,v12
buffer_load_dwordx4 v[24:27],v13,s[8:11],s64 offen sc1
buffer_load_dwordx4 v[24:27],v13,s[8:11],s64 offen sc1
.p2align 6
L_chain_303:
L_cpa_304:
buffer_load_dwordx4 v[24:27],v13,s[8:11],s64 offen sc1
s_sub_u32 s49,s49,1
s_cbranch_scc1 L_abort2
s_waitcnt vmcnt(2)
v_max3_u32 v123,v24,v25,v26
v_max_u32 v123,v27,v123
v_cmp_le_u32 vcc,s72,v123
ds_write_b128 v12,v[24:27] offset:0
s_cbranch_vccnz L_cpa_304
L_cgo_307:
v_smfmac_f32_16x16x64_bf16 v[96:99],v[24:27],a[0:7],v2
buffer_load_dwordx4 v[40:43],v13,s[8:11],s70 offen sc1
s_waitcnt lgkmcnt(0)
s_barrier
ds_read_b128 v[28:31],v120 offset:0
v_smfmac_f32_16x16x64_bf16 v[100:103],v[24:27],a[128:135],v2
ds_read_b128 v[32:35],v121 offset:0
v_smfmac_f32_16x16x64_bf16 v[104:107],v[24:27],a[8:15],v2
ds_read_b128 v[36:39],v122 offset:0
v_smfmac_f32_16x16x64_bf16 v[108:111],v[24:27],a[136:143],v2
v_smfmac_f32_16x16x64_bf16 v[112:115],v[24:27],v[128:135],v2
v_smfmac_f32_16x16x64_bf16 v[116:119],v[24:27],v[136:143],v2
s_waitcnt lgkmcnt(2)
v_smfmac_f32_16x16x64_bf16 v[96:99],v[28:31],a[16:23],v2
s_add_u32 m0,s73,131072
v_smfmac_f32_16x16x64_bf16 v[100:103],v[28:31],a[144:151],v2
s_add_u32 s57,s67,8192
v_smfmac_f32_16x16x64_bf16 v[104:107],v[28:31],a[24:31],v2
s_cmp_lt_u32 s19,s76
s_cbranch_scc1 L_ckw_293
L_ckb_294:
v_smfmac_f32_16x16x64_bf16 v[108:111],v[28:31],a[152:159],v2
s_waitcnt vmcnt(0) lgkmcnt(1)
v_smfmac_f32_16x16x64_bf16 v[96:99],v[32:35],a[32:39],v2
ds_write_b128 v12,v[40:43] offset:4096
v_max3_u32 v123,v40,v41,v42
v_smfmac_f32_16x16x64_bf16 v[100:103],v[32:35],a[160:167],v2
v_max_u32 v123,v43,v123
v_smfmac_f32_16x16x64_bf16 v[104:107],v[32:35],a[40:47],v2
v_cmp_le_u32 vcc,s72,v123
v_smfmac_f32_16x16x64_bf16 v[108:111],v[32:35],a[168:175],v2
v_smfmac_f32_16x16x64_bf16 v[112:115],v[28:31],v[144:151],v2
s_cbranch_vccnz L_cpb_310
L_cback_312:
s_waitcnt lgkmcnt(0)
s_barrier
v_smfmac_f32_16x16x64_bf16 v[96:99],v[36:39],a[48:55],v2
buffer_load_dword v23,v22,s[8:11],s75 offen sc1
v_smfmac_f32_16x16x64_bf16 v[100:103],v[36:39],a[176:183],v2
ds_read_b128 v[44:47],v120 offset:4096
v_smfmac_f32_16x16x64_bf16 v[104:107],v[36:39],a[56:63],v2
buffer_load_dwordx4 v0,s[8:11],s67 offen sc1 lds
v_smfmac_f32_16x16x64_bf16 v[108:111],v[36:39],a[184:191],v2
ds_read_b128 v[48:51],v121 offset:4096
v_smfmac_f32_16x16x64_bf16 v[96:99],v[40:43],a[64:71],v2
buffer_store_dwordx4 v[124:127],v0,s[8:11],s54 offen sc1
v_smfmac_f32_16x16x64_bf16 v[100:103],v[40:43],a[192:199],v2
ds_read_b128 v[52:55],v122 offset:4096
v_smfmac_f32_16x16x64_bf16 v[104:107],v[40:43],a[72:79],v2
buffer_load_dwordx4 v0,s[8:11],s67 offen offset:1024 sc1 lds
s_add_u32 m0,s73,139264
v_smfmac_f32_16x16x64_bf16 v[108:111],v[40:43],a[200:207],v2
ds_read_b32 v123,v8 offset:2560
s_waitcnt lgkmcnt(3)
v_smfmac_f32_16x16x64_bf16 v[96:99],v[44:47],a[80:87],v2
buffer_load_dwordx4 v0,s[8:11],s57 offen sc1 lds
s_add_u32 s67,s67,786432
v_smfmac_f32_16x16x64_bf16 v[100:103],v[44:47],a[208:215],v2
s_waitcnt lgkmcnt(2)
v_smfmac_f32_16x16x64_bf16 v[96:99],v[48:51],a[96:103],v2
buffer_load_dwordx4 v0,s[8:11],s57 offen offset:1024 sc1 lds
v_smfmac_f32_16x16x64_bf16 v[100:103],v[48:51],a[224:231],v2
s_waitcnt lgkmcnt(0)
v_smfmac_f32_16x16x64_bf16 v[96:99],v[52:55],a[112:119],v2
v_smfmac_f32_16x16x64_bf16 v[100:103],v[52:55],a[240:247],v2
v_readfirstlane_b32 s58,v123
v_smfmac_f32_16x16x64_bf16 v[104:107],v[44:47],a[88:95],v2
v_smfmac_f32_16x16x64_bf16 v[108:111],v[44:47],a[216:223],v2
s_cmp_lg_u32 s58,0
s_cbranch_scc1 L_cjump_296
v_smfmac_f32_16x16x64_bf16 v[104:107],v[48:51],a[104:111],v2
v_add_f32 v96,v96,v98
v_smfmac_f32_16x16x64_bf16 v[108:111],v[48:51],a[232:239],v2
v_add_f32 v97,v97,v99
v_smfmac_f32_16x16x64_bf16 v[104:107],v[52:55],a[120:127],v2
v_cvt_pk_bf16_f32 v120,v96,v97
v_smfmac_f32_16x16x64_bf16 v[108:111],v[52:55],a[248:255],v2
v_add_f32 v100,v100,v102
v_smfmac_f32_16x16x64_bf16 v[116:119],v[28:31],v[152:159],v2
v_add_f32 v101,v101,v103
v_smfmac_f32_16x16x64_bf16 v[112:115],v[32:35],v[160:167],v2
v_cvt_pk_bf16_f32 v121,v100,v101
v_add_f32 v104,v104,v106
v_add_f32 v105,v105,v107
v_cvt_pk_bf16_f32 v122,v104,v105
v_add_f32 v108,v108,v110
v_add_f32 v109,v109,v111
v_cvt_pk_bf16_f32 v123,v108,v109
ds_write_b128 v4,v[120:123]
v_smfmac_f32_16x16x64_bf16 v[116:119],v[32:35],v[168:175],v2
s_mov_b32 s54,s68
s_add_u32 s68,s68,131072
v_mov_b32 v125,0
v_smfmac_f32_16x16x64_bf16 v[112:115],v[36:39],v[176:183],v2
s_cmp_eq_u32 s51,63
s_cbranch_scc1 L_cend_306
v_smfmac_f32_16x16x64_bf16 v[116:119],v[36:39],v[184:191],v2
s_waitcnt lgkmcnt(0)
s_barrier
ds_read_b64_tr_b16 v[96:97],v5 offset:0
v_smfmac_f32_16x16x64_bf16 v[112:115],v[40:43],v[192:199],v2
ds_read_b64_tr_b16 v[98:99],v6 offset:0
v_smfmac_f32_16x16x64_bf16 v[116:119],v[40:43],v[200:207],v2
ds_read_b64_tr_b16 v[100:101],v5 offset:1024
v_smfmac_f32_16x16x64_bf16 v[112:115],v[44:47],v[208:215],v2
ds_read_b64_tr_b16 v[102:103],v6 offset:1024
v_smfmac_f32_16x16x64_bf16 v[116:119],v[44:47],v[216:223],v2
ds_read_b64_tr_b16 v[104:105],v5 offset:2048
v_smfmac_f32_16x16x64_bf16 v[112:115],v[48:51],v[224:231],v2
ds_read_b64_tr_b16 v[106:107],v6 offset:2048
s_waitcnt lgkmcnt(4)
v_mfma_f32_16x16x32_bf16 v[24:27],v[56:59],v[96:99],0
ds_read_b64_tr_b16 v[108:109],v5 offset:3072
v_mfma_f32_16x16x32_bf16 v[28:31],v[60:63],v[96:99],0
ds_read_b64_tr_b16 v[110:111],v6 offset:3072
v_mfma_f32_16x16x32_bf16 v[32:35],v[96:99],v[96:99],0
ds_read_b128 v[40:43],v11 offset:12288
s_waitcnt lgkmcnt(5)
v_mfma_f32_16x16x32_bf16 v[24:27],v[64:67],v[100:103],v[24:27]
ds_read_b128 v[56:59],v11 offset:0
v_mfma_f32_16x16x32_bf16 v[28:31],v[68:71],v[100:103],v[28:31]
ds_read_b128 v[60:63],v11 offset:1024
v_mfma_f32_16x16x32_bf16 v[32:35],v[100:103],v[100:103],v[32:35]
ds_read_b128 v[96:99],v11 offset:8192
s_waitcnt lgkmcnt(6)
v_mfma_f32_16x16x32_bf16 v[24:27],v[72:75],v[104:107],v[24:27]
ds_read_b128 v[64:67],v11 offset:2048
v_mfma_f32_16x16x32_bf16 v[28:31],v[76:79],v[104:107],v[28:31]
ds_read_b128 v[68:71],v11 offset:3072
v_mfma_f32_16x16x32_bf16 v[32:35],v[104:107],v[104:107],v[32:35]
ds_read_b128 v[100:103],v11 offset:9216
s_waitcnt lgkmcnt(7)
v_mfma_f32_16x16x32_bf16 v[24:27],v[80:83],v[108:111],v[24:27]
ds_read_b128 v[72:75],v11 offset:4096
v_mfma_f32_16x16x32_bf16 v[28:31],v[84:87],v[108:111],v[28:31]
ds_read_b128 v[76:79],v11 offset:5120
v_mfma_f32_16x16x32_bf16 v[32:35],v[108:111],v[108:111],v[32:35]
ds_read_b128 v[104:107],v11 offset:10240
v_smfmac_f32_16x16x64_bf16 v[116:119],v[48:51],v[232:239],v2
ds_read_b128 v[80:83],v11 offset:6144
v_smfmac_f32_16x16x64_bf16 v[112:115],v[52:55],v[240:247],v2
ds_read_b128 v[84:87],v11 offset:7168
v_smfmac_f32_16x16x64_bf16 v[116:119],v[52:55],v[248:255],v2
ds_read_b128 v[108:111],v11 offset:11264
v_max3_f32 v126,v24,v25,v26
v_max3_f32 v127,v27,v28,v29
v_max3_f32 v126,v30,v31,v126
v_max3_f32 v127,v34,v35,v127
v_max_f32 v126,v126,v127
v_max_f32 v127,v126,v127
v_pk_mul_f32 v[34:35],v[34:35],v[0:1] op_sel:[0,1]
v_pk_mul_f32 v[24:25],v[24:25],v[0:1] op_sel:[0,1]
v_permlane16_swap_b32 v126,v127
v_max_f32 v126,v126,v127
v_max_f32 v127,v126,v127
v_pk_add_f32 v[112:113],v[112:113],v[114:115]
v_pk_add_f32 v[116:117],v[116:117],v[118:119]
v_permlane32_swap_b32 v126,v127
v_max_f32 v126,v126,v127
v_mul_f32 v126,v1,v126
v_pk_add_f32 v[34:35],v[34:35],v[126:127] op_sel_hi:[1,0] neg_lo:[0,1] neg_hi:[0,1]
v_pk_add_f32 v[24:25],v[24:25],v[126:127] op_sel_hi:[1,0] neg_lo:[0,1] neg_hi:[0,1]
v_pk_fma_f32 v[26:27],v[26:27],v[0:1],v[126:127] op_sel:[0,1,0] op_sel_hi:[1,1,0] neg_lo:[0,0,1] neg_hi:[0,0,1]
v_pk_fma_f32 v[28:29],v[28:29],v[0:1],v[126:127] op_sel:[0,1,0] op_sel_hi:[1,1,0] neg_lo:[0,0,1] neg_hi:[0,0,1]
v_pk_fma_f32 v[30:31],v[30:31],v[0:1],v[126:127] op_sel:[0,1,0] op_sel_hi:[1,1,0] neg_lo:[0,0,1] neg_hi:[0,0,1]
v_exp_f32 v34,v34
v_exp_f32 v35,v35
v_cvt_pk_bf16_f32 v126,v112,v113
v_cvt_pk_bf16_f32 v124,v34,v35
v_cvt_pk_bf16_f32 v127,v116,v117
v_cvt_pk_bf16_f32 v36,v116,v117
v_mfma_f32_16x16x16_bf16 v[32:35],v[14:15],v[124:125],0
ds_read_b128 v[44:47],v11 offset:13312
v_exp_f32 v24,v24
v_mfma_f32_16x16x16_bf16 v[112:115],v[126:127],v[124:125],0
ds_read_b128 v[48:51],v11 offset:14336
v_exp_f32 v25,v25
v_mfma_f32_16x16x16_bf16 v[116:119],v[36:37],v[124:125],0
ds_read_b128 v[52:55],v11 offset:15360
v_exp_f32 v26,v26
v_exp_f32 v27,v27
v_cvt_pk_bf16_f32 v120,v24,v25
v_exp_f32 v28,v28
v_exp_f32 v29,v29
v_cvt_pk_bf16_f32 v121,v26,v27
v_exp_f32 v30,v30
v_exp_f32 v31,v31
v_cvt_pk_bf16_f32 v122,v28,v29
v_cvt_pk_bf16_f32 v123,v30,v31
s_add_u32 s75,s75,8192
s_add_u32 s51,s51,1
v_mfma_f32_16x16x32_bf16 v[32:35],v[14:17],v[120:123],v[32:35]
v_mfma_f32_16x16x32_bf16 v[112:115],v[88:91],v[120:123],v[112:115]
ds_read_b128 v[88:91],v11 offset:16384
v_mfma_f32_16x16x32_bf16 v[116:119],v[92:95],v[120:123],v[116:119]
ds_read_b128 v[92:95],v11 offset:17408
v_rcp_f32 v32,v32
v_mov_b64 v[24:25],-1
v_mov_b64 v[26:27],-1
s_add_u32 s64,s75,13631488
s_add_u32 s70,s64,4096
v_pk_mul_f32 v[112:113],v[112:113],v[32:33] op_sel_hi:[1,0]
v_pk_mul_f32 v[114:115],v[114:115],v[32:33] op_sel_hi:[1,0]
v_pk_mul_f32 v[116:117],v[116:117],v[32:33] op_sel_hi:[1,0]
v_pk_mul_f32 v[118:119],v[118:119],v[32:33] op_sel_hi:[1,0]
v_cvt_pk_bf16_f32 v120,v112,v116
v_cvt_pk_bf16_f32 v121,v113,v117
v_cvt_pk_bf16_f32 v122,v114,v118
v_cvt_pk_bf16_f32 v123,v115,v119
ds_write_b128 v7,v[120:123]
buffer_store_dwordx4 v[24:27],v0,s[8:11],s69 offen sc1
buffer_store_dwordx4 v[24:27],v0,s[8:11],s69 offen offset:1024 sc1
v_mov_b64 v[112:113],0
v_mov_b64 v[114:115],0
v_mov_b64 v[116:117],0
v_mov_b64 v[118:119],0
s_waitcnt lgkmcnt(0)
s_barrier
ds_read_b128 v[24:27],v8 offset:0
ds_read_b128 v[28:31],v8 offset:512
ds_read_b128 v[32:35],v8 offset:1024
ds_read_b128 v[36:39],v8 offset:1536
v_mov_b64 v[120:121],0
v_mov_b64 v[122:123],0
s_add_u32 s57,s65,65536
s_add_u32 s58,s65,131072
s_add_u32 s59,s65,196608
s_add_u32 s56,s18,s75
s_waitcnt lgkmcnt(3)
v_smfmac_f32_16x16x64_bf16 v[112:115],v[24:27],v[56:63],v3
ds_read_b128 v[56:59],v11 offset:18432
s_waitcnt lgkmcnt(3)
v_smfmac_f32_16x16x64_bf16 v[112:115],v[28:31],v[64:71],v3
ds_read_b128 v[60:63],v11 offset:19456
s_waitcnt lgkmcnt(3)
v_smfmac_f32_16x16x64_bf16 v[112:115],v[32:35],v[72:79],v3
ds_read_b128 v[64:67],v11 offset:20480
s_waitcnt lgkmcnt(3)
v_smfmac_f32_16x16x64_bf16 v[112:115],v[36:39],v[80:87],v3
ds_read_b128 v[68:71],v11 offset:21504
v_smfmac_f32_16x16x64_bf16 v[116:119],v[24:27],v[96:103],v3
ds_read_b128 v[72:75],v11 offset:22528
v_smfmac_f32_16x16x64_bf16 v[116:119],v[28:31],v[104:111],v3
ds_read_b128 v[76:79],v11 offset:23552
v_cvt_pk_bf16_f32 v112,v112,v113
v_smfmac_f32_16x16x64_bf16 v[116:119],v[32:35],v[40:47],v3
ds_read_b128 v[80:83],v11 offset:24576
v_cvt_pk_bf16_f32 v113,v114,v115
buffer_store_dwordx2 v[112:113],v9,s[8:11],s65 offen sc1
v_smfmac_f32_16x16x64_bf16 v[116:119],v[36:39],v[48:55],v3
ds_read_b128 v[84:87],v11 offset:25600
v_mov_b64 v[112:113],0
v_smfmac_f32_16x16x64_bf16 v[120:123],v[24:27],v[88:95],v3
ds_read_b128 v[96:99],v11 offset:26624
ds_read_b128 v[100:103],v11 offset:27648
v_mov_b64 v[114:115],0
s_waitcnt lgkmcnt(8)
v_smfmac_f32_16x16x64_bf16 v[120:123],v[28:31],v[56:63],v3
ds_read_b128 v[104:107],v11 offset:28672
v_cvt_pk_bf16_f32 v116,v116,v117
s_waitcnt lgkmcnt(7)
v_smfmac_f32_16x16x64_bf16 v[120:123],v[32:35],v[64:71],v3
ds_read_b128 v[108:111],v11 offset:29696
ds_read_b128 v[40:43],v11 offset:30720
v_cvt_pk_bf16_f32 v117,v118,v119
buffer_store_dwordx2 v[116:117],v9,s[8:11],s57 offen sc1
s_waitcnt lgkmcnt(7)
v_smfmac_f32_16x16x64_bf16 v[120:123],v[36:39],v[72:79],v3
ds_read_b128 v[44:47],v11 offset:31744
v_add_u32 v52,s50,v5
s_waitcnt lgkmcnt(6)
v_smfmac_f32_16x16x64_bf16 v[112:115],v[24:27],v[80:87],v3
v_add_u32 v54,s50,v6
s_waitcnt lgkmcnt(4)
v_smfmac_f32_16x16x64_bf16 v[112:115],v[28:31],v[96:103],v3
ds_read_b64_tr_b16 v[52:53],v52
v_cvt_pk_bf16_f32 v120,v120,v121
s_waitcnt lgkmcnt(3)
v_smfmac_f32_16x16x64_bf16 v[112:115],v[32:35],v[104:111],v3
ds_read_b64_tr_b16 v[54:55],v54
v_cvt_pk_bf16_f32 v121,v122,v123
buffer_store_dwordx2 v[120:121],v9,s[8:11],s58 offen sc1
s_waitcnt lgkmcnt(2)
v_smfmac_f32_16x16x64_bf16 v[112:115],v[36:39],v[40:47],v3
v_mov_b64 v[116:117],0
v_mov_b64 v[118:119],0
s_xor_b32 s65,s65,262144
v_mov_b32_dpp v124,v126 quad_perm:[2,3,2,3] row_mask:0xf bank_mask:0xf
v_mov_b32_dpp v125,v127 quad_perm:[2,3,2,3] row_mask:0xf bank_mask:0xf
s_mov_b32 vcc_lo,0xcccccccc
s_mov_b32 vcc_hi,0xcccccccc
s_nop 0
v_cvt_pk_bf16_f32 v112,v112,v113
v_cvt_pk_bf16_f32 v113,v114,v115
buffer_store_dwordx2 v[112:113],v9,s[8:11],s59 offen sc1
s_waitcnt lgkmcnt(0)
s_buffer_load_dword s19,s[8:11],s56
v_cndmask_b32 v124,v124,v52,vcc
v_cndmask_b32 v125,v125,v53,vcc
s_cmp_lt_u32 s46,2
s_waitcnt vmcnt(3)
s_cbranch_scc1 L_crg_313
s_cmp_eq_u32 s46,2
s_waitcnt vmcnt(1)
s_cbranch_scc1 L_crg_313
s_waitcnt vmcnt(0)
L_crg_313:
buffer_load_dwordx4 v[32:35],v0,s[8:11],s66 offen offset:0 sc1
buffer_load_dwordx4 v[36:39],v0,s[8:11],s66 offen offset:1024 sc1
v_cndmask_b32 v126,v126,v54,vcc
v_cndmask_b32 v127,v127,v55,vcc
v_mov_b64 v[96:97],0
v_mov_b64 v[98:99],0
v_mov_b64 v[100:101],0
v_mov_b64 v[102:103],0
v_mov_b64 v[104:105],0
v_mov_b64 v[106:107],0
v_mov_b64 v[108:109],0
v_mov_b64 v[110:111],0
v_mov_b64 v[112:113],0
v_mov_b64 v[114:115],0
v_add_u32 v55,131072,v0
v_add_u32 v123,s73,v55
v_xor_b32 v120,1024,v12
v_xor_b32 v121,2048,v12
v_xor_b32 v122,3072,v12
buffer_load_dwordx4 v[44:47],v0,s[8:11],s66 offen offset:0 sc1
buffer_load_dwordx4 v[48:51],v0,s[8:11],s66 offen offset:1024 sc1
s_cmp_ge_u32 s51,63
s_cselect_b32 s76,0,1
v_readlane_b32 s56,v23,5
v_readlane_b32 s20,v23,4
v_add_u32 v23,-1,v23
v_cmp_le_u32 vcc,s30,v23
s_cmp_gt_u32 s51,61
s_cselect_b32 s77,0,vcc_hi
s_cmp_gt_u32 s20,s30
s_cselect_b32 s77,1,s77
s_cmp_lg_u32 s77,0
s_cselect_b32 s76,2,s76
s_cmp_gt_u32 s56,s30
s_cbranch_scc1 L_cld_289
L_clb_290:
s_cmp_eq_u32 s46,0
s_cselect_b32 s76,s76,0
s_waitcnt vmcnt(3)
v_mfma_f32_16x16x32_bf16 v[28:31],v[18:21],v[32:35],0
s_waitcnt vmcnt(2)
v_mfma_f32_16x16x32_bf16 v[28:31],v[18:21],v[36:39],v[28:31]
s_nop 7
v_cmp_u_f32 vcc,v28,v28
v_add_f32_dpp v52,v28,v28 row_ror:8 row_mask:0xf bank_mask:0x3
v_add_f32_dpp v53,v29,v29 row_ror:8 row_mask:0xf bank_mask:0x3
v_add_f32_dpp v52,v30,v30 row_ror:8 row_mask:0xf bank_mask:0xc
v_add_f32_dpp v53,v31,v31 row_ror:8 row_mask:0xf bank_mask:0xc
s_cbranch_vccnz L_crp_308
L_cok_314:
v_add_f32_dpp v52,v52,v52 row_shl:4 row_mask:0xf bank_mask:0x5
v_add_f32_dpp v53,v53,v53 row_shl:4 row_mask:0xf bank_mask:0x5
v_cvt_pk_bf16_f32 v54,v52,v53
buffer_store_dword v54,v10,s[8:11],s64 offen sc1
s_mov_b32 s69,s66
s_xor_b32 s66,s66,262144
s_barrier
ds_read_b128 v[56:59],v55 offset:0
ds_read_b128 v[60:63],v55 offset:4096
ds_read_b128 v[64:67],v55 offset:1024
buffer_load_dwordx4 v[24:27],v13,s[8:11],s64 offen sc1
ds_read_b128 v[68:71],v55 offset:5120
ds_read_b128 v[72:75],v55 offset:2048
ds_read_b128 v[76:79],v55 offset:6144
ds_read_b128 v[80:83],v55 offset:3072
buffer_load_dwordx4 v[24:27],v13,s[8:11],s64 offen sc1
ds_read_b128 v[84:87],v55 offset:7168
ds_read_b128 v[88:91],v123 offset:8192
ds_read_b128 v[92:95],v123 offset:9216
s_branch L_chain_303
L_cpb_310:
buffer_load_dwordx4 v[40:43],v13,s[8:11],s70 offen sc1
s_sub_u32 s49,s49,1
s_cbranch_scc1 L_abort2
s_waitcnt vmcnt(0)
v_max3_u32 v123,v40,v41,v42
v_max_u32 v123,v43,v123
v_cmp_le_u32 vcc,s72,v123
s_cbranch_vccnz L_cpb_310
ds_write_b128 v12,v[40:43] offset:4096
s_branch L_cback_312
L_crp_308:
buffer_load_dwordx4 v[32:35],v0,s[8:11],s66 offen offset:0 sc1
buffer_load_dwordx4 v[36:39],v0,s[8:11],s66 offen offset:1024 sc1
s_sub_u32 s49,s49,1
s_cbranch_scc1 L_abort2
s_waitcnt vmcnt(3)
v_mfma_f32_16x16x32_bf16 v[28:31],v[18:21],v[44:47],0
s_waitcnt vmcnt(2)
v_mfma_f32_16x16x32_bf16 v[28:31],v[18:21],v[48:51],v[28:31]
s_nop 7
v_cmp_u_f32 vcc,v28,v28
v_add_f32_dpp v52,v28,v28 row_ror:8 row_mask:0xf bank_mask:0x3
v_add_f32_dpp v53,v29,v29 row_ror:8 row_mask:0xf bank_mask:0x3
v_add_f32_dpp v52,v30,v30 row_ror:8 row_mask:0xf bank_mask:0xc
v_add_f32_dpp v53,v31,v31 row_ror:8 row_mask:0xf bank_mask:0xc
s_cbranch_vccz L_cok_314
buffer_load_dwordx4 v[44:47],v0,s[8:11],s66 offen offset:0 sc1
buffer_load_dwordx4 v[48:51],v0,s[8:11],s66 offen offset:1024 sc1
s_sub_u32 s49,s49,1
s_cbranch_scc1 L_abort2
s_waitcnt vmcnt(3)
v_mfma_f32_16x16x32_bf16 v[28:31],v[18:21],v[32:35],0
s_waitcnt vmcnt(2)
v_mfma_f32_16x16x32_bf16 v[28:31],v[18:21],v[36:39],v[28:31]
s_nop 7
v_cmp_u_f32 vcc,v28,v28
v_add_f32_dpp v52,v28,v28 row_ror:8 row_mask:0xf bank_mask:0x3
v_add_f32_dpp v53,v29,v29 row_ror:8 row_mask:0xf bank_mask:0x3
v_add_f32_dpp v52,v30,v30 row_ror:8 row_mask:0xf bank_mask:0xc
v_add_f32_dpp v53,v31,v31 row_ror:8 row_mask:0xf bank_mask:0xc
s_cbranch_vccz L_cok_314
s_branch L_crp_308
L_ckw_293:
s_cmp_eq_u32 s77,0
s_cbranch_scc1 L_cjw_295
s_cmp_gt_u32 s20,s30
s_cbranch_scc1 L_cjs_291
s_add_u32 s31,s51,2
s_lshl_b32 s59,s31,13
s_add_u32 s59,s59,10486016
v_lshrrev_b32 v45,2,v0
v_and_b32 v45,127,v45
L_ckk_315:
s_sleep 1
buffer_load_dword v44,v45,s[8:11],s59 offen sc1
s_sub_u32 s49,s49,1
s_cbranch_scc1 L_abort2
s_waitcnt vmcnt(0)
v_cmp_eq_u32 vcc,0,v44
s_cbranch_vccnz L_ckk_315
v_cmp_lt_u32 vcc,s30,v44
s_cbranch_vccz L_cjw_295
v_max_u32_dpp v44,v44,v44 row_ror:8 row_mask:0xf bank_mask:0xf
s_nop 1
v_max_u32_dpp v44,v44,v44 row_ror:4 row_mask:0xf bank_mask:0xf
s_nop 1
v_max_u32_dpp v44,v44,v44 row_ror:2 row_mask:0xf bank_mask:0xf
s_nop 1
v_max_u32_dpp v44,v44,v44 row_ror:1 row_mask:0xf bank_mask:0xf
v_mov_b32 v45,v44
s_nop 1
v_permlane16_swap_b32 v44,v45
v_max_u32 v44,v44,v45
v_mov_b32 v45,v44
s_nop 1
v_permlane32_swap_b32 v44,v45
v_max_u32 v44,v44,v45
s_nop 0
v_readfirstlane_b32 s20,v44
L_cjs_291:
s_mov_b32 s30,s20
s_andn2_b32 s31,0x7ff,s20
s_lshr_b32 s31,s31,5
s_add_u32 s31,s31,1
s_min_u32 s31,s31,63
ds_write_b32 v8,v2 offset:2560
s_waitcnt lgkmcnt(0)
s_branch L_ckb_294
L_cld_289:
v_mov_b32 v23,s56
s_add_u32 s56,s75,10495616
buffer_store_dword v23,off,s[8:11],s56 sc1
s_waitcnt vmcnt(0)
s_branch L_clb_290
L_cjw_295:
s_cmp_lg_u32 s19,0
s_cbranch_scc1 L_ckb_294
s_add_u32 s59,s18,s75
L_ww_316:
s_sleep 1
buffer_load_dword v23,off,s[8:11],s59 sc1
s_sub_u32 s49,s49,1
s_cbranch_scc1 L_abort2
s_waitcnt vmcnt(0)
v_readfirstlane_b32 s76,v23
s_cmp_eq_u32 s76,0
s_cbranch_scc1 L_ww_316
L_wwd_317:
s_branch L_ckb_294
L_cjump_296:
s_waitcnt vmcnt(0) lgkmcnt(0)
s_barrier
s_branch L_cst_292
L_cend_306:
v_smfmac_f32_16x16x64_bf16 v[116:119],v[36:39],v[184:191],v2
v_smfmac_f32_16x16x64_bf16 v[112:115],v[40:43],v[192:199],v2
v_smfmac_f32_16x16x64_bf16 v[116:119],v[40:43],v[200:207],v2
v_smfmac_f32_16x16x64_bf16 v[112:115],v[44:47],v[208:215],v2
v_smfmac_f32_16x16x64_bf16 v[116:119],v[44:47],v[216:223],v2
v_smfmac_f32_16x16x64_bf16 v[112:115],v[48:51],v[224:231],v2
v_smfmac_f32_16x16x64_bf16 v[116:119],v[48:51],v[232:239],v2
v_smfmac_f32_16x16x64_bf16 v[112:115],v[52:55],v[240:247],v2
v_smfmac_f32_16x16x64_bf16 v[116:119],v[52:55],v[248:255],v2
s_waitcnt lgkmcnt(0)
s_nop 2
v_pk_add_f32 v[112:113],v[112:113],v[114:115]
s_nop 2
v_pk_add_f32 v[116:117],v[116:117],v[118:119]
v_cvt_pk_bf16_f32 v126,v112,v113
v_cvt_pk_bf16_f32 v127,v116,v117
v_add_u32 v52,s50,v5
v_add_u32 v54,s50,v6
ds_read_b64_tr_b16 v[52:53],v52
ds_read_b64_tr_b16 v[54:55],v54
v_mov_b32_dpp v124,v126 quad_perm:[2,3,2,3] row_mask:0xf bank_mask:0xf
v_mov_b32_dpp v125,v127 quad_perm:[2,3,2,3] row_mask:0xf bank_mask:0xf
s_mov_b32 vcc_lo,0xcccccccc
s_mov_b32 vcc_hi,0xcccccccc
s_waitcnt lgkmcnt(0)
v_cndmask_b32 v124,v124,v52,vcc
v_cndmask_b32 v125,v125,v53,vcc
v_cndmask_b32 v126,v126,v54,vcc
v_cndmask_b32 v127,v127,v55,vcc
buffer_store_dwordx4 v[124:127],v0,s[8:11],s54 offen sc1
s_mov_b32 s51,64
s_waitcnt vmcnt(0)
s_barrier
s_nop 11
v_lshrrev_b32 v1,4,v0
s_endpgm
L_wa:
s_nop 11
v_and_b32 v238,15,v1
v_and_b32 v239,1,v1
v_lshlrev_b32 v239,4,v239
v_mov_b32 v240,0x3f80
v_lshlrev_b32 v240,v239,v240
v_lshrrev_b32 v238,1,v238
v_cmp_eq_u32 vcc,0,v238
s_nop 1
v_cndmask_b32 v156,0,v240,vcc
v_cmp_eq_u32 vcc,1,v238
s_nop 1
v_cndmask_b32 v157,0,v240,vcc
v_cmp_eq_u32 vcc,2,v238
s_nop 1
v_cndmask_b32 v158,0,v240,vcc
v_cmp_eq_u32 vcc,3,v238
s_nop 1
v_cndmask_b32 v159,0,v240,vcc
s_mov_b32 s4,s32
s_mov_b32 s5,s33
s_mov_b32 s6,1024
s_mov_b32 s7,0x20000
buffer_load_dwordx4 v[224:227],v0,s[4:7],0 offen
v_and_b32 v238,15,v1
v_lshrrev_b32 v239,4,v1
v_lshlrev_b32 v240,2,v239
v_mov_b32 v241,0xf149f2ca
s_and_b32 s56,s46,1
s_lshl_b32 s56,s56,4
v_add_u32 v242,s56,v238
v_add_u32 v243,0,v240
v_cmp_gt_u32 vcc,v243,v242
s_nop 1
v_cndmask_b32 v8,0,v241,vcc
v_add_u32 v243,1,v240
v_cmp_gt_u32 vcc,v243,v242
s_nop 1
v_cndmask_b32 v9,0,v241,vcc
v_add_u32 v243,2,v240
v_cmp_gt_u32 vcc,v243,v242
s_nop 1
v_cndmask_b32 v10,0,v241,vcc
v_add_u32 v243,3,v240
v_cmp_gt_u32 vcc,v243,v242
s_nop 1
v_cndmask_b32 v11,0,v241,vcc
v_add_u32 v243,16,v240
v_cmp_gt_u32 vcc,v243,v242
s_nop 1
v_cndmask_b32 v12,0,v241,vcc
v_add_u32 v243,17,v240
v_cmp_gt_u32 vcc,v243,v242
s_nop 1
v_cndmask_b32 v13,0,v241,vcc
v_add_u32 v243,18,v240
v_cmp_gt_u32 vcc,v243,v242
s_nop 1
v_cndmask_b32 v14,0,v241,vcc
v_add_u32 v243,19,v240
v_cmp_gt_u32 vcc,v243,v242
s_nop 1
v_cndmask_b32 v15,0,v241,vcc
v_mov_b32 v152,s80
v_mov_b32 v145,0
v_mov_b32 v146,0
s_lshl_b32 s56,s46,12
s_add_u32 s56,s56,131072
v_add_u32 v3,s56,v0
v_add_u32 v4,131072,v0
s_lshl_b32 s56,s46,8
v_lshlrev_b32 v7,4,v238
v_add_u32 v7,s56,v7
v_lshl_add_u32 v5,v239,16,v7
v_lshlrev_b32 v6,1,v7
v_lshl_add_u32 v7,v239,10,v7
v_and_b32 v243,1,v239
v_lshl_add_u32 v6,v243,4,v6
v_lshrrev_b32 v243,1,v239
v_lshl_add_u32 v6,v243,12,v6
v_add_u32 v6,147456,v6
v_lshlrev_b32 v16,2,v1
v_lshlrev_b32 v21,3,v238
s_and_b32 s68,s47,15
s_lshl_b32 s56,s68,10
v_add_u32 v5,s56,v5
s_lshl_b32 s56,s68,15
v_add_u32 v7,s56,v7
s_lshl_b32 s69,s54,20
s_add_u32 s69,s69,20971520
s_lshl_b32 s87,s54,13
s_add_u32 s87,s87,10486272
s_lshl4_add_u32 s74,s68,s87
s_lshl2_add_u32 s74,s46,s74
s_lshl_b32 s68,s68,1
s_lshr_b32 s56,s46,1
s_add_u32 s68,s68,s56
s_mov_b32 s66,0
s_mov_b32 s67,0
s_mov_b32 s73,0x80000000
s_mov_b32 s75,0
s_mov_b32 s37,0
s_mov_b32 s42,4294966272
s_mov_b32 s43,4294967295
s_mov_b64 s[38:39],0
s_sub_u32 s36,s54,12
s_and_b32 s36,s36,3
s_mov_b32 s12,s40
s_mov_b32 s13,s41
s_mov_b32 s14,2097152
s_mov_b32 s15,0x20000
s_and_b32 s29,s46,1
s_mul_i32 s28,s29,12288
s_lshl_b32 s29,s29,11
s_and_b32 s56,s50,2048
s_lshl_b32 s56,s56,4
s_add_u32 s56,s56,65536
s_add_u32 s40,s56,s28
s_add_u32 s41,s56,s29
v_add_u32 v21,10487168,v21
v_mov_b32 v244,v21
s_and_b32 s56,s50,2048
s_add_u32 s56,s56,147456
v_lshlrev_b32 v23,5,v1
v_add_u32 v23,s56,v23
v_and_b32 v253,32,v0
v_lshrrev_b32 v245,2,v253
v_add_u32 v253,v253,v245
v_sub_u32 v253,v0,v253
v_add_u32 v253,8,v253
v_mov_b32 v254,0x80000000
s_mov_b32 s56,1408
v_writelane_b32 v254,s56,0
s_mov_b32 s56,256
v_writelane_b32 v254,s56,1
s_mov_b32 s56,1280
v_writelane_b32 v254,s56,2
v_mov_b32 v245,155648
s_lshl_b32 s56,s46,2
v_add_u32 v247,s56,v245
s_waitcnt vmcnt(0)
v_lshlrev_b32 v228,16,v224
v_and_b32 v229,0xffff0000,v224
v_lshlrev_b32 v230,16,v225
v_and_b32 v231,0xffff0000,v225
v_lshlrev_b32 v232,16,v226
v_and_b32 v233,0xffff0000,v226
v_lshlrev_b32 v234,16,v227
v_and_b32 v235,0xffff0000,v227
v_mul_f32 v255,v228,v228
v_fma_f32 v255,v229,v229,v255
v_fma_f32 v255,v230,v230,v255
v_fma_f32 v255,v231,v231,v255
v_fma_f32 v255,v232,v232,v255
v_fma_f32 v255,v233,v233,v255
v_fma_f32 v255,v234,v234,v255
v_fma_f32 v255,v235,v235,v255
s_nop 1
v_add_f32_dpp v255,v255,v255 row_ror:8 row_mask:0xf bank_mask:0xf
s_nop 1
v_add_f32_dpp v255,v255,v255 row_ror:4 row_mask:0xf bank_mask:0xf
s_nop 1
v_add_f32_dpp v255,v255,v255 row_ror:2 row_mask:0xf bank_mask:0xf
s_nop 1
v_add_f32_dpp v255,v255,v255 row_ror:1 row_mask:0xf bank_mask:0xf
v_mov_b32 v238,v255
s_nop 1
v_permlane16_swap_b32 v255,v238
v_add_f32 v255,v255,v238
v_mov_b32 v238,v255
s_nop 1
v_permlane32_swap_b32 v255,v238
v_add_f32 v255,v255,v238
v_sqrt_f32 v255,v255
v_sub_u32 v238,67,v1
v_cvt_f32_u32 v238,v238
v_log_f32 v238,v238
v_mov_b32 v239,0x3ff9999a
v_fmac_f32 v239,0x3e632166,v238
v_mul_f32 v255,v255,v239
v_or_b32 v255,0x80000000,v255
s_cmp_lt_u32 s54,2
s_cbranch_scc1 L_aa_318
s_sub_u32 s77,s54,2
s_mov_b32 s30,0
s_mov_b32 s86,1536
s_lshl_b32 s56,s77,5
s_add_u32 s56,s56,s68
s_mul_i32 s70,s56,24576
s_lshl_b32 s71,s56,12
s_lshl_b32 s59,s77,13
s_lshl2_add_u32 s59,s68,s59
s_add_u32 s59,s59,10485760
s_buffer_load_dword s32,s[8:11],s59
s_mov_b32 s33,1
s_add_u32 s70,s70,100663296
s_add_u32 s71,s71,41943040
v_mov_b32 v19,s59
s_branch L_aa_326
L_aa_332:
s_bitcmp1_b32 s46,0
s_cbranch_scc1 L_av_333
ds_read_b128 v[24:27],v4 offset:0
ds_read_b128 v[28:31],v4 offset:1024
s_min_u32 s56,s32,s33
s_cmp_lt_u32 s77,64
s_cselect_b32 s56,s56,0
s_cmp_eq_u32 s56,0
s_cselect_b32 s72,0x80000000,0
v_mov_b32 v248,s72
s_or_b32 s64,s70,s72
s_or_b32 s65,s71,s72
s_cmp_lt_u32 s30,s31
s_cselect_b32 s65,0x80000000,s65
s_add_u32 s64,s64,s28
s_add_u32 s65,s65,s29
s_xor_b32 s58,s67,s40
s_xor_b32 s57,s67,s41
s_add_u32 m0,s58,0
s_waitcnt lgkmcnt(1)
v_mfma_f32_16x16x32_bf16 v[160:163],v[24:27],a[0:3],0
buffer_load_dwordx4 v0,s[8:11],s64 offen offset:0 sc1 lds
v_mfma_f32_16x16x32_bf16 v[164:167],v[24:27],a[4:7],0
ds_read_b128 v[32:35],v4 offset:2048
v_lshlrev_b32 v88,16,v224
v_mfma_f32_16x16x32_bf16 v[168:171],v[24:27],a[8:11],0
ds_read_b128 v[36:39],v4 offset:3072
v_and_b32 v89,0xffff0000,v224
v_mfma_f32_16x16x32_bf16 v[172:175],v[24:27],a[12:15],0
ds_read_b128 v[40:43],v4 offset:8192
v_lshlrev_b32 v90,16,v225
v_mfma_f32_16x16x32_bf16 v[176:179],v[24:27],a[16:19],0
ds_read_b128 v[44:47],v4 offset:9216
v_and_b32 v91,0xffff0000,v225
v_mfma_f32_16x16x32_bf16 v[180:183],v[24:27],a[20:23],0
buffer_load_dwordx4 v0,s[8:11],s64 offen offset:1024 sc1 lds
v_mfma_f32_16x16x32_bf16 v[184:187],v[24:27],a[24:27],0
ds_read_b128 v[48:51],v4 offset:10240
s_waitcnt vmcnt(9)
v_mfma_f32_16x16x32_bf16 v[188:191],v[24:27],a[28:31],0
ds_read_b128 v[52:55],v4 offset:11264
v_mfma_f32_16x16x32_bf16 v[128:131],v[156:159],v[192:195],0
ds_write_b32 v247,v248
v_lshlrev_b32 v92,16,v226
s_waitcnt lgkmcnt(7)
v_mfma_f32_16x16x32_bf16 v[160:163],v[28:31],a[32:35],v[160:163]
ds_read_b128 v[56:59],v4 offset:4096
s_waitcnt vmcnt(8)
v_mfma_f32_16x16x32_bf16 v[164:167],v[28:31],a[36:39],v[164:167]
ds_read_b128 v[60:63],v4 offset:5120
v_mfma_f32_16x16x32_bf16 v[128:131],v[156:159],v[196:199],v[128:131]
ds_read_b128 v[64:67],v4 offset:6144
v_and_b32 v93,0xffff0000,v226
v_mfma_f32_16x16x32_bf16 v[168:171],v[28:31],a[40:43],v[168:171]
buffer_load_dwordx4 v0,s[8:11],s64 offen offset:2048 sc1 lds
v_mfma_f32_16x16x32_bf16 v[172:175],v[28:31],a[44:47],v[172:175]
ds_read_b128 v[68:71],v4 offset:7168
s_waitcnt vmcnt(8)
v_mfma_f32_16x16x32_bf16 v[176:179],v[28:31],a[48:51],v[176:179]
ds_read_b128 v[72:75],v4 offset:12288
v_mfma_f32_16x16x32_bf16 v[128:131],v[156:159],v[200:203],v[128:131]
ds_read_b128 v[76:79],v4 offset:13312
v_lshlrev_b32 v94,16,v227
v_mfma_f32_16x16x32_bf16 v[180:183],v[28:31],a[52:55],v[180:183]
ds_read_b128 v[80:83],v4 offset:14336
s_waitcnt vmcnt(7)
v_mfma_f32_16x16x32_bf16 v[184:187],v[28:31],a[56:59],v[184:187]
ds_read_b128 v[84:87],v4 offset:15360
v_mfma_f32_16x16x32_bf16 v[128:131],v[156:159],v[204:207],v[128:131]
v_and_b32 v95,0xffff0000,v227
v_readfirstlane_b32 s22,v246
v_mfma_f32_16x16x32_bf16 v[188:191],v[28:31],a[60:63],v[188:191]
buffer_load_dwordx4 v0,s[8:11],s64 offen offset:3072 sc1 lds
s_waitcnt lgkmcnt(14)
v_mfma_f32_16x16x32_bf16 v[160:163],v[32:35],a[64:67],v[160:163]
s_waitcnt vmcnt(7)
v_mfma_f32_16x16x32_bf16 v[132:135],v[156:159],v[208:211],0
s_cmp_eq_u32 s22,0
s_cbranch_scc1 L_ag_334
L_agb_335:
v_mfma_f32_16x16x32_bf16 v[164:167],v[32:35],a[68:71],v[164:167]
s_waitcnt vmcnt(6)
v_mfma_f32_16x16x32_bf16 v[132:135],v[156:159],v[212:215],v[132:135]
s_lshl_b32 s18,s26,5
s_add_u32 s18,s18,s68
s_lshl_b32 s19,s18,10
v_mfma_f32_16x16x32_bf16 v[168:171],v[32:35],a[72:75],v[168:171]
s_waitcnt vmcnt(5)
v_mfma_f32_16x16x32_bf16 v[132:135],v[156:159],v[216:219],v[132:135]
s_add_u32 s20,s19,6291456
s_lshl_b32 s23,s51,5
s_add_u32 s23,s23,s68
v_mfma_f32_16x16x32_bf16 v[172:175],v[32:35],a[76:79],v[172:175]
ds_write_b128 v6,v[128:131]
v_mfma_f32_16x16x32_bf16 v[176:179],v[32:35],a[80:83],v[176:179]
s_waitcnt vmcnt(4)
v_mfma_f32_16x16x32_bf16 v[132:135],v[156:159],v[220:223],v[132:135]
s_add_u32 m0,s58,4096
s_add_u32 s64,s64,4096
s_lshl_b32 s24,s23,10
v_mfma_f32_16x16x32_bf16 v[180:183],v[32:35],a[84:87],v[180:183]
buffer_load_dwordx4 v0,s[8:11],s64 offen offset:0 sc1 lds
v_mfma_f32_16x16x32_bf16 v[184:187],v[32:35],a[88:91],v[184:187]
s_lshl_b32 s25,s51,10
s_add_u32 s25,s25,2883584
s_cmp_eq_u32 s23,s55
s_cselect_b32 s25,s25,s24
v_mfma_f32_16x16x32_bf16 v[188:191],v[32:35],a[92:95],v[188:191]
ds_write_b128 v6,v[132:135] offset:2048
s_waitcnt lgkmcnt(15)
v_mfma_f32_16x16x32_bf16 v[160:163],v[36:39],a[96:99],v[160:163]
s_add_u32 s25,s25,8388608
s_mov_b32 s6,268435456
s_cmp_eq_u32 s31,0
s_cselect_b32 s25,s24,s25
s_cselect_b64 s[4:5],s[16:17],s[44:45]
s_cmov_b32 s6,2097152
v_mfma_f32_16x16x32_bf16 v[164:167],v[36:39],a[100:103],v[164:167]
buffer_load_dwordx4 v[224:227],v0,s[4:7],s25 offen sc1
v_mfma_f32_16x16x32_bf16 v[168:171],v[36:39],a[104:107],v[168:171]
buffer_load_dwordx4 v0,s[8:11],s64 offen offset:1024 sc1 lds
v_mfma_f32_16x16x32_bf16 v[172:175],v[36:39],a[108:111],v[172:175]
s_lshr_b32 s24,s55,5
s_cmp_lt_u32 s51,s24
s_cselect_b32 s24,1,2
v_mfma_f32_16x16x32_bf16 v[176:179],v[36:39],a[112:115],v[176:179]
s_waitcnt lgkmcnt(0)
s_barrier
v_mov_b32 v252,s24
v_mfma_f32_16x16x32_bf16 v[180:183],v[36:39],a[116:119],v[180:183]
ds_read_b128 v[96:99],v23
s_lshl2_add_u32 s25,s51,11018240
v_mfma_f32_16x16x32_bf16 v[184:187],v[36:39],a[120:123],v[184:187]
ds_read_b128 v[100:103],v23 offset:16
s_lshl_b32 s24,s68,16
v_mfma_f32_16x16x32_bf16 v[188:191],v[36:39],a[124:127],v[188:191]
buffer_load_dwordx4 v0,s[8:11],s64 offen offset:2048 sc1 lds
s_add_u32 s24,s24,s31
v_mfma_f32_16x16x32_bf16 v[160:163],v[40:43],a[128:131],v[160:163]
ds_read_b128 v[248:251],v245
s_add_u32 s24,s24,s86
s_cmp_eq_u32 s24,1537
s_cselect_b32 s25,s25,0x80000000
v_mfma_f32_16x16x32_bf16 v[164:167],v[40:43],a[132:135],v[164:167]
buffer_store_dword v252,off,s[8:11],s25 sc1
s_bitcmp1_b64 s[38:39],s51
s_cselect_b32 s24,128,0
v_mfma_f32_16x16x32_bf16 v[168:171],v[40:43],a[136:139],v[168:171]
buffer_store_dword v20,off,s[8:11],s73 sc1
s_lshl_b32 s23,s51,13
v_mfma_f32_16x16x32_bf16 v[172:175],v[40:43],a[140:143],v[172:175]
s_lshl2_add_u32 s23,s68,s23
s_add_u32 s23,s23,10487168
s_add_u32 s23,s23,s24
s_mov_b32 s73,0x80000000
v_mfma_f32_16x16x32_bf16 v[176:179],v[40:43],a[144:147],v[176:179]
buffer_load_dwordx4 v0,s[8:11],s64 offen offset:3072 sc1 lds
v_mfma_f32_16x16x32_bf16 v[180:183],v[40:43],a[148:151],v[180:183]
buffer_load_dword v246,off,s[8:11],s23 sc1
v_lshrrev_b32 v244,4,v1
v_mfma_f32_16x16x32_bf16 v[184:187],v[40:43],a[152:155],v[184:187]
s_waitcnt lgkmcnt(0)
v_or3_b32 v248,v248,v249,v250
v_or_b32 v248,v248,v251
s_sub_u32 s23,s77,7
v_mfma_f32_16x16x32_bf16 v[188:191],v[40:43],a[156:159],v[188:191]
v_readfirstlane_b32 s72,v248
v_add_u32 v244,s23,v244
v_max_i32 v244,0,v244
v_mfma_f32_16x16x32_bf16 v[160:163],v[44:47],a[160:163],v[160:163]
s_waitcnt lgkmcnt(1)
v_lshl_add_u32 v244,v244,13,v21
v_cvt_pk_bf16_f32 v104,v96,v97
v_cvt_pk_bf16_f32 v105,v98,v99
v_mfma_f32_16x16x32_bf16 v[164:167],v[44:47],a[164:167],v[164:167]
buffer_load_dwordx2 v[242:243],v244,s[8:11],0 offen sc1
s_add_u32 m0,s58,8192
v_mfma_f32_16x16x32_bf16 v[168:171],v[44:47],a[168:171],v[168:171]
s_add_u32 s64,s64,4096
v_cvt_pk_bf16_f32 v106,v100,v101
v_cvt_pk_bf16_f32 v107,v102,v103
v_lshlrev_b32 v96,16,v104
v_mfma_f32_16x16x32_bf16 v[172:175],v[44:47],a[172:175],v[172:175]
buffer_load_dwordx4 v0,s[8:11],s64 offen offset:0 sc1 lds
v_and_b32 v97,0xffff0000,v104
v_mfma_f32_16x16x32_bf16 v[176:179],v[44:47],a[176:179],v[176:179]
v_lshlrev_b32 v98,16,v105
v_and_b32 v99,0xffff0000,v105
v_lshlrev_b32 v100,16,v106
v_mfma_f32_16x16x32_bf16 v[180:183],v[44:47],a[180:183],v[180:183]
v_and_b32 v101,0xffff0000,v106
v_lshlrev_b32 v102,16,v107
v_and_b32 v103,0xffff0000,v107
v_mfma_f32_16x16x32_bf16 v[184:187],v[44:47],a[184:187],v[184:187]
v_add_f32 v88,v88,v96
v_add_f32 v89,v89,v97
v_add_f32 v90,v90,v98
v_mfma_f32_16x16x32_bf16 v[188:191],v[44:47],a[188:191],v[188:191]
v_add_f32 v91,v91,v99
v_add_f32 v92,v92,v100
v_add_f32 v93,v93,v101
v_mfma_f32_16x16x32_bf16 v[160:163],v[48:51],a[192:195],v[160:163]
buffer_load_dwordx4 v0,s[8:11],s64 offen offset:1024 sc1 lds
v_add_f32 v94,v94,v102
v_mfma_f32_16x16x32_bf16 v[164:167],v[48:51],a[196:199],v[164:167]
v_add_f32 v95,v95,v103
v_cvt_pk_bf16_f32 v104,v88,v89
v_cvt_pk_bf16_f32 v105,v90,v91
v_mfma_f32_16x16x32_bf16 v[168:171],v[48:51],a[200:203],v[168:171]
v_cvt_pk_bf16_f32 v106,v92,v93
v_cvt_pk_bf16_f32 v107,v94,v95
v_mfma_f32_16x16x32_bf16 v[172:175],v[48:51],a[204:207],v[172:175]
buffer_store_dwordx4 v[104:107],v0,s[8:11],s20 offen sc1
v_lshlrev_b32 v88,16,v104
v_mfma_f32_16x16x32_bf16 v[176:179],v[48:51],a[208:211],v[176:179]
v_and_b32 v89,0xffff0000,v104
v_lshlrev_b32 v90,16,v105
v_and_b32 v91,0xffff0000,v105
v_mfma_f32_16x16x32_bf16 v[180:183],v[48:51],a[212:215],v[180:183]
buffer_load_dwordx4 v0,s[8:11],s64 offen offset:2048 sc1 lds
v_lshlrev_b32 v92,16,v106
v_mfma_f32_16x16x32_bf16 v[184:187],v[48:51],a[216:219],v[184:187]
v_and_b32 v93,0xffff0000,v106
v_lshlrev_b32 v94,16,v107
v_and_b32 v95,0xffff0000,v107
v_mfma_f32_16x16x32_bf16 v[188:191],v[48:51],a[220:223],v[188:191]
v_readfirstlane_b32 s78,v88
v_mfma_f32_16x16x32_bf16 v[160:163],v[52:55],a[224:227],v[160:163]
s_nop 0
v_add_f32 v120,v88,-s78
v_add_f32 v121,v89,-s78
v_add_f32 v122,v90,-s78
v_mfma_f32_16x16x32_bf16 v[164:167],v[52:55],a[228:231],v[164:167]
v_add_f32 v123,v91,-s78
v_add_f32 v124,v92,-s78
v_add_f32 v125,v93,-s78
v_mfma_f32_16x16x32_bf16 v[168:171],v[52:55],a[232:235],v[168:171]
buffer_load_dwordx4 v0,s[8:11],s64 offen offset:3072 sc1 lds
v_add_f32 v126,v94,-s78
v_mfma_f32_16x16x32_bf16 v[172:175],v[52:55],a[236:239],v[172:175]
v_add_f32 v127,v95,-s78
v_add_f32 v128,v120,v122
v_add_f32 v129,v121,v123
v_mfma_f32_16x16x32_bf16 v[176:179],v[52:55],a[240:243],v[176:179]
v_mul_f32 v130,v120,v120
v_mul_f32 v131,v121,v121
v_add_f32 v132,v124,v126
v_mfma_f32_16x16x32_bf16 v[180:183],v[52:55],a[244:247],v[180:183]
v_add_f32 v133,v125,v127
v_fma_f32 v130,v122,v122,v130
v_fma_f32 v131,v123,v123,v131
v_mfma_f32_16x16x32_bf16 v[184:187],v[52:55],a[248:251],v[184:187]
v_add_f32 v128,v128,v132
v_add_f32 v129,v129,v133
v_fma_f32 v130,v124,v124,v130
v_mfma_f32_16x16x32_bf16 v[188:191],v[52:55],a[252:255],v[188:191]
s_add_u32 m0,s57,24576
v_fma_f32 v131,v125,v125,v131
v_add_f32 v128,v128,v129
v_fma_f32 v130,v126,v126,v130
v_mfma_f32_16x16x32_bf16 v[192:195],v[56:59],a[0:3],0
buffer_load_dwordx4 v0,s[8:11],s65 offen offset:0 sc1 lds
v_fma_f32 v131,v127,v127,v131
v_mfma_f32_16x16x32_bf16 v[196:199],v[56:59],a[4:7],0
v_add_f32 v130,v130,v131
v_mfma_f32_16x16x32_bf16 v[200:203],v[56:59],a[8:11],0
s_nop 0
v_permlane32_swap_b32 v128,v130
v_add_f32 v128,v128,v130
v_cvt_pk_bf16_f32 v24,v160,v164
v_mfma_f32_16x16x32_bf16 v[204:207],v[56:59],a[12:15],0
v_add_f32_dpp v128,v128,v128 row_ror:8 row_mask:0xf bank_mask:0xf
v_cvt_pk_bf16_f32 v25,v168,v172
v_cvt_pk_bf16_f32 v26,v176,v180
v_mfma_f32_16x16x32_bf16 v[208:211],v[56:59],a[16:19],0
v_add_f32_dpp v128,v128,v128 row_ror:4 row_mask:0xf bank_mask:0xf
v_cvt_pk_bf16_f32 v27,v184,v188
v_cvt_pk_bf16_f32 v28,v161,v165
v_mfma_f32_16x16x32_bf16 v[212:215],v[56:59],a[20:23],0
buffer_load_dwordx4 v0,s[8:11],s65 offen offset:1024 sc1 lds
v_add_f32_dpp v128,v128,v128 row_ror:2 row_mask:0xf bank_mask:0xf
v_mfma_f32_16x16x32_bf16 v[216:219],v[56:59],a[24:27],0
s_nop 0
v_add_f32_dpp v128,v128,v128 row_ror:1 row_mask:0xf bank_mask:0xf
v_mov_b32 v130,v128
v_cvt_pk_bf16_f32 v29,v169,v173
v_mfma_f32_16x16x32_bf16 v[220:223],v[56:59],a[28:31],0
v_permlane16_swap_b32 v128,v130
v_add_f32 v128,v128,v130
v_mul_f32 v128,0x3b000000,v128
v_mfma_f32_16x16x32_bf16 v[192:195],v[60:63],a[32:35],v[192:195]
v_mov_b32 v130,v128
v_cvt_pk_bf16_f32 v30,v177,v181
v_cvt_pk_bf16_f32 v31,v185,v189
v_mfma_f32_16x16x32_bf16 v[196:199],v[60:63],a[36:39],v[196:199]
v_permlane32_swap_b32 v128,v130
v_fma_f32 v130,-v128,v128,v130
v_add_f32 v128,s78,v128
v_mfma_f32_16x16x32_bf16 v[200:203],v[60:63],a[40:43],v[200:203]
v_max_f32 v130,0,v130
v_cvt_pk_bf16_f32 v130,v128,v130
v_lshlrev_b32 v128,16,v130
v_mfma_f32_16x16x32_bf16 v[204:207],v[60:63],a[44:47],v[204:207]
v_and_b32 v130,0xffff0000,v130
v_add_f32 v130,0x3727c5ac,v130
v_cvt_pk_bf16_f32 v130,v130,v130
v_mfma_f32_16x16x32_bf16 v[208:211],v[60:63],a[48:51],v[208:211]
v_and_b32 v130,0xffff0000,v130
v_sqrt_f32 v130,v130
v_add_f32 v120,v88,-v128
v_mfma_f32_16x16x32_bf16 v[212:215],v[60:63],a[52:55],v[212:215]
v_add_f32 v121,v89,-v128
v_add_f32 v122,v90,-v128
v_add_f32 v123,v91,-v128
v_mfma_f32_16x16x32_bf16 v[216:219],v[60:63],a[56:59],v[216:219]
v_add_f32 v124,v92,-v128
v_add_f32 v125,v93,-v128
v_add_f32 v126,v94,-v128
v_mfma_f32_16x16x32_bf16 v[220:223],v[60:63],a[60:63],v[220:223]
v_add_f32 v127,v95,-v128
v_cvt_pk_bf16_f32 v130,v130,v130
v_and_b32 v130,0xffff0000,v130
v_mfma_f32_16x16x32_bf16 v[192:195],v[64:67],a[64:67],v[192:195]
v_rcp_f32 v130,v130
v_cvt_pk_bf16_f32 v108,v120,v121
v_cvt_pk_bf16_f32 v109,v122,v123
v_mfma_f32_16x16x32_bf16 v[196:199],v[64:67],a[68:71],v[196:199]
v_cvt_pk_bf16_f32 v110,v124,v125
v_cvt_pk_bf16_f32 v111,v126,v127
v_lshlrev_b32 v120,16,v108
v_mfma_f32_16x16x32_bf16 v[200:203],v[64:67],a[72:75],v[200:203]
v_and_b32 v121,0xffff0000,v108
v_lshlrev_b32 v122,16,v109
v_and_b32 v123,0xffff0000,v109
v_mfma_f32_16x16x32_bf16 v[204:207],v[64:67],a[76:79],v[204:207]
v_lshlrev_b32 v124,16,v110
v_and_b32 v125,0xffff0000,v110
v_lshlrev_b32 v126,16,v111
v_mfma_f32_16x16x32_bf16 v[208:211],v[64:67],a[80:83],v[208:211]
v_cvt_pk_bf16_f32 v32,v162,v166
v_cvt_pk_bf16_f32 v33,v170,v174
v_cvt_pk_bf16_f32 v34,v178,v182
v_mfma_f32_16x16x32_bf16 v[212:215],v[64:67],a[84:87],v[212:215]
v_cvt_pk_bf16_f32 v35,v186,v190
v_cvt_pk_bf16_f32 v36,v163,v167
v_cvt_pk_bf16_f32 v37,v171,v175
v_mfma_f32_16x16x32_bf16 v[216:219],v[64:67],a[88:91],v[216:219]
v_cvt_pk_bf16_f32 v38,v179,v183
v_cvt_pk_bf16_f32 v39,v187,v191
v_and_b32 v127,0xffff0000,v111
v_mfma_f32_16x16x32_bf16 v[220:223],v[64:67],a[92:95],v[220:223]
v_mul_f32 v120,v120,v130
v_mul_f32 v121,v121,v130
v_mul_f32 v122,v122,v130
v_mfma_f32_16x16x32_bf16 v[192:195],v[68:71],a[96:99],v[192:195]
v_mul_f32 v123,v123,v130
v_mul_f32 v124,v124,v130
v_mul_f32 v125,v125,v130
v_mfma_f32_16x16x32_bf16 v[196:199],v[68:71],a[100:103],v[196:199]
v_mul_f32 v126,v126,v130
v_mul_f32 v127,v127,v130
v_cvt_pk_bf16_f32 v108,v120,v121
v_mfma_f32_16x16x32_bf16 v[200:203],v[68:71],a[104:107],v[200:203]
v_cvt_pk_bf16_f32 v109,v122,v123
v_cvt_pk_bf16_f32 v110,v124,v125
v_cvt_pk_bf16_f32 v111,v126,v127
v_mfma_f32_16x16x32_bf16 v[204:207],v[68:71],a[108:111],v[204:207]
v_lshlrev_b32 v112,16,v108
v_and_b32 v113,0xffff0000,v108
v_lshlrev_b32 v114,16,v109
v_mfma_f32_16x16x32_bf16 v[208:211],v[68:71],a[112:115],v[208:211]
s_add_u32 s62,s69,0
v_and_b32 v115,0xffff0000,v109
v_lshlrev_b32 v116,16,v110
v_and_b32 v117,0xffff0000,v110
v_mfma_f32_16x16x32_bf16 v[212:215],v[68:71],a[116:119],v[212:215]
buffer_store_dwordx4 v[24:27],v5,s[8:11],s62 offen sc1
v_lshlrev_b32 v118,16,v111
v_mfma_f32_16x16x32_bf16 v[216:219],v[68:71],a[120:123],v[216:219]
v_and_b32 v119,0xffff0000,v111
v_add_f32 v88,v88,v112
v_add_f32 v89,v89,v113
v_mfma_f32_16x16x32_bf16 v[220:223],v[68:71],a[124:127],v[220:223]
v_add_f32 v90,v90,v114
v_add_f32 v91,v91,v115
v_add_f32 v92,v92,v116
v_mfma_f32_16x16x32_bf16 v[192:195],v[72:75],a[128:131],v[192:195]
s_add_u32 s62,s69,16384
v_add_f32 v93,v93,v117
v_add_f32 v94,v94,v118
v_add_f32 v95,v95,v119
v_mfma_f32_16x16x32_bf16 v[196:199],v[72:75],a[132:135],v[196:199]
buffer_store_dwordx4 v[28:31],v5,s[8:11],s62 offen sc1
v_cvt_pk_bf16_f32 v96,v88,v89
v_mfma_f32_16x16x32_bf16 v[200:203],v[72:75],a[136:139],v[200:203]
v_cvt_pk_bf16_f32 v97,v90,v91
v_cvt_pk_bf16_f32 v98,v92,v93
v_cvt_pk_bf16_f32 v99,v94,v95
v_mfma_f32_16x16x32_bf16 v[204:207],v[72:75],a[140:143],v[204:207]
buffer_store_dwordx4 v[96:99],v0,s[12:15],s19 offen sc1
v_mul_f32 v236,v112,v228
v_mfma_f32_16x16x32_bf16 v[208:211],v[72:75],a[144:147],v[208:211]
s_add_u32 s62,s69,32768
v_mul_f32 v237,v113,v229
v_fma_f32 v236,v114,v230,v236
v_fma_f32 v237,v115,v231,v237
v_mfma_f32_16x16x32_bf16 v[212:215],v[72:75],a[148:151],v[212:215]
buffer_store_dwordx4 v[32:35],v5,s[8:11],s62 offen sc1
v_fma_f32 v236,v116,v232,v236
v_mfma_f32_16x16x32_bf16 v[216:219],v[72:75],a[152:155],v[216:219]
v_fma_f32 v237,v117,v233,v237
v_fma_f32 v236,v118,v234,v236
v_fma_f32 v237,v119,v235,v237
v_mfma_f32_16x16x32_bf16 v[220:223],v[72:75],a[156:159],v[220:223]
v_add_f32 v236,v236,v237
v_mfma_f32_16x16x32_bf16 v[192:195],v[76:79],a[160:163],v[192:195]
s_add_u32 s62,s69,49152
v_add_f32_dpp v236,v236,v236 row_ror:8 row_mask:0xf bank_mask:0xf
v_mfma_f32_16x16x32_bf16 v[196:199],v[76:79],a[164:167],v[196:199]
buffer_store_dwordx4 v[36:39],v5,s[8:11],s62 offen sc1
v_add_f32_dpp v236,v236,v236 row_ror:4 row_mask:0xf bank_mask:0xf
v_mfma_f32_16x16x32_bf16 v[200:203],v[76:79],a[168:171],v[200:203]
s_nop 0
v_add_f32_dpp v236,v236,v236 row_ror:2 row_mask:0xf bank_mask:0xf
v_mfma_f32_16x16x32_bf16 v[204:207],v[76:79],a[172:175],v[204:207]
s_nop 0
v_add_f32_dpp v236,v236,v236 row_ror:1 row_mask:0xf bank_mask:0xf
v_mov_b32 v237,v236
v_mfma_f32_16x16x32_bf16 v[208:211],v[76:79],a[176:179],v[208:211]
s_nop 0
v_permlane16_swap_b32 v236,v237
v_add_f32 v236,v236,v237
v_mov_b32 v237,v236
v_mfma_f32_16x16x32_bf16 v[212:215],v[76:79],a[180:183],v[212:215]
s_nop 0
v_permlane32_swap_b32 v236,v237
v_add_f32 v236,v236,v237
v_cvt_pk_bf16_f32 v236,v236,v236
v_mfma_f32_16x16x32_bf16 v[216:219],v[76:79],a[184:187],v[216:219]
v_and_b32 v236,0xffff0000,v236
v_ashrrev_i32 v237,31,v236
v_or_b32 v237,0x80000000,v237
v_mfma_f32_16x16x32_bf16 v[220:223],v[76:79],a[188:191],v[220:223]
v_xor_b32 v236,v236,v237
v_and_b32 v236,0xffff0000,v236
s_sub_u32 s20,4095,s18
v_mfma_f32_16x16x32_bf16 v[192:195],v[80:83],a[192:195],v[192:195]
v_or_b32 v20,s20,v236
s_lshl_b32 s73,s26,13
s_lshl2_add_u32 s73,s68,s73
v_mfma_f32_16x16x32_bf16 v[196:199],v[80:83],a[196:199],v[196:199]
s_add_u32 s73,s73,10485760
s_add_u32 s73,s73,s86
v_mfma_f32_16x16x32_bf16 v[192:195],v[84:87],a[224:227],v[192:195]
v_mfma_f32_16x16x32_bf16 v[196:199],v[84:87],a[228:231],v[196:199]
v_mfma_f32_16x16x32_bf16 v[200:203],v[80:83],a[200:203],v[200:203]
v_mfma_f32_16x16x32_bf16 v[204:207],v[80:83],a[204:207],v[204:207]
v_mfma_f32_16x16x32_bf16 v[200:203],v[84:87],a[232:235],v[200:203]
v_mfma_f32_16x16x32_bf16 v[204:207],v[84:87],a[236:239],v[204:207]
v_cvt_pk_bf16_f32 v40,v192,v196
v_cvt_pk_bf16_f32 v44,v193,v197
v_cvt_pk_bf16_f32 v48,v194,v198
v_mfma_f32_16x16x32_bf16 v[208:211],v[80:83],a[208:211],v[208:211]
v_cvt_pk_bf16_f32 v52,v195,v199
v_mfma_f32_16x16x32_bf16 v[212:215],v[80:83],a[212:215],v[212:215]
v_cvt_pk_bf16_f32 v41,v200,v204
v_cvt_pk_bf16_f32 v45,v201,v205
v_cvt_pk_bf16_f32 v49,v202,v206
v_mfma_f32_16x16x32_bf16 v[208:211],v[84:87],a[240:243],v[208:211]
v_cvt_pk_bf16_f32 v53,v203,v207
v_mfma_f32_16x16x32_bf16 v[212:215],v[84:87],a[244:247],v[212:215]
v_mfma_f32_16x16x32_bf16 v[216:219],v[80:83],a[216:219],v[216:219]
v_mfma_f32_16x16x32_bf16 v[220:223],v[80:83],a[220:223],v[220:223]
v_mfma_f32_16x16x32_bf16 v[216:219],v[84:87],a[248:251],v[216:219]
v_mfma_f32_16x16x32_bf16 v[220:223],v[84:87],a[252:255],v[220:223]
v_cvt_pk_bf16_f32 v42,v208,v212
v_cvt_pk_bf16_f32 v46,v209,v213
v_cvt_pk_bf16_f32 v50,v210,v214
v_cvt_pk_bf16_f32 v54,v211,v215
s_nop 3
v_cvt_pk_bf16_f32 v43,v216,v220
s_add_u32 s62,s69,262144
buffer_store_dwordx4 v[40:43],v5,s[8:11],s62 offen sc1
v_cvt_pk_bf16_f32 v47,v217,v221
s_add_u32 s62,s69,278528
buffer_store_dwordx4 v[44:47],v5,s[8:11],s62 offen sc1
v_cvt_pk_bf16_f32 v51,v218,v222
s_add_u32 s62,s69,294912
buffer_store_dwordx4 v[48:51],v5,s[8:11],s62 offen sc1
v_cvt_pk_bf16_f32 v55,v219,v223
s_add_u32 s62,s69,311296
buffer_store_dwordx4 v[52:55],v5,s[8:11],s62 offen sc1
s_cmp_lg_u32 s72,0
s_cbranch_scc1 L_aa_321
s_waitcnt vmcnt(9)
s_branch L_aa_331
L_av_333:
ds_read_b128 v[24:27],v4 offset:0
ds_read_b128 v[28:31],v4 offset:1024
s_min_u32 s56,s32,s33
s_cmp_lt_u32 s77,64
s_cselect_b32 s56,s56,0
s_cmp_eq_u32 s56,0
s_cselect_b32 s72,0x80000000,0
v_mov_b32 v248,s72
s_or_b32 s64,s70,s72
s_or_b32 s65,s71,s72
s_cmp_lt_u32 s30,s31
s_cselect_b32 s65,0x80000000,s65
s_add_u32 s64,s64,s28
s_add_u32 s65,s65,s29
s_xor_b32 s58,s67,s40
s_xor_b32 s57,s67,s41
s_add_u32 m0,s58,0
s_waitcnt lgkmcnt(1)
v_mfma_f32_16x16x32_bf16 v[160:163],v[24:27],a[0:3],0
buffer_load_dwordx4 v0,s[8:11],s64 offen offset:0 sc1 lds
v_mfma_f32_16x16x32_bf16 v[164:167],v[24:27],a[4:7],0
ds_read_b128 v[32:35],v4 offset:2048
s_lshl_b32 s23,s51,5
v_mfma_f32_16x16x32_bf16 v[168:171],v[24:27],a[8:11],0
ds_read_b128 v[36:39],v4 offset:3072
s_add_u32 s23,s23,s68
v_mfma_f32_16x16x32_bf16 v[172:175],v[24:27],a[12:15],0
ds_read_b128 v[40:43],v4 offset:8192
s_lshl_b32 s24,s23,10
v_mfma_f32_16x16x32_bf16 v[176:179],v[24:27],a[16:19],0
ds_read_b128 v[44:47],v4 offset:9216
s_lshl_b32 s25,s51,10
v_mfma_f32_16x16x32_bf16 v[180:183],v[24:27],a[20:23],0
buffer_load_dwordx4 v0,s[8:11],s64 offen offset:1024 sc1 lds
v_mfma_f32_16x16x32_bf16 v[184:187],v[24:27],a[24:27],0
ds_read_b128 v[48:51],v4 offset:10240
s_waitcnt vmcnt(9)
v_mfma_f32_16x16x32_bf16 v[188:191],v[24:27],a[28:31],0
ds_read_b128 v[52:55],v4 offset:11264
v_mfma_f32_16x16x32_bf16 v[128:131],v[156:159],v[192:195],0
ds_write_b32 v247,v248
s_add_u32 s25,s25,2883584
s_waitcnt lgkmcnt(7)
v_mfma_f32_16x16x32_bf16 v[160:163],v[28:31],a[32:35],v[160:163]
ds_read_b128 v[56:59],v4 offset:4096
s_waitcnt vmcnt(8)
v_mfma_f32_16x16x32_bf16 v[164:167],v[28:31],a[36:39],v[164:167]
ds_read_b128 v[60:63],v4 offset:5120
v_mfma_f32_16x16x32_bf16 v[128:131],v[156:159],v[196:199],v[128:131]
ds_read_b128 v[64:67],v4 offset:6144
s_cmp_eq_u32 s23,s55
s_cselect_b32 s25,s25,s24
v_mfma_f32_16x16x32_bf16 v[168:171],v[28:31],a[40:43],v[168:171]
buffer_load_dwordx4 v0,s[8:11],s64 offen offset:2048 sc1 lds
v_mfma_f32_16x16x32_bf16 v[172:175],v[28:31],a[44:47],v[172:175]
ds_read_b128 v[68:71],v4 offset:7168
s_waitcnt vmcnt(8)
v_mfma_f32_16x16x32_bf16 v[176:179],v[28:31],a[48:51],v[176:179]
ds_read_b128 v[72:75],v4 offset:12288
v_mfma_f32_16x16x32_bf16 v[128:131],v[156:159],v[200:203],v[128:131]
ds_read_b128 v[76:79],v4 offset:13312
s_add_u32 s25,s25,8388608
v_mfma_f32_16x16x32_bf16 v[180:183],v[28:31],a[52:55],v[180:183]
ds_read_b128 v[80:83],v4 offset:14336
s_waitcnt vmcnt(7)
v_mfma_f32_16x16x32_bf16 v[184:187],v[28:31],a[56:59],v[184:187]
ds_read_b128 v[84:87],v4 offset:15360
v_mfma_f32_16x16x32_bf16 v[128:131],v[156:159],v[204:207],v[128:131]
s_mov_b32 s6,268435456
s_cmp_eq_u32 s31,0
s_cselect_b32 s25,s24,s25
s_cselect_b64 s[4:5],s[16:17],s[44:45]
s_cmov_b32 s6,2097152
v_mfma_f32_16x16x32_bf16 v[188:191],v[28:31],a[60:63],v[188:191]
buffer_load_dwordx4 v0,s[8:11],s64 offen offset:3072 sc1 lds
s_waitcnt lgkmcnt(14)
v_mfma_f32_16x16x32_bf16 v[160:163],v[32:35],a[64:67],v[160:163]
buffer_load_dwordx4 v[224:227],v0,s[4:7],s25 offen sc1
v_mfma_f32_16x16x32_bf16 v[164:167],v[32:35],a[68:71],v[164:167]
s_waitcnt vmcnt(8)
v_mfma_f32_16x16x32_bf16 v[132:135],v[156:159],v[208:211],0
s_lshr_b32 s24,s55,5
s_cmp_lt_u32 s51,s24
s_cselect_b32 s24,1,2
v_mfma_f32_16x16x32_bf16 v[168:171],v[32:35],a[72:75],v[168:171]
s_waitcnt vmcnt(7)
v_mfma_f32_16x16x32_bf16 v[132:135],v[156:159],v[212:215],v[132:135]
v_mov_b32 v252,s24
s_lshl2_add_u32 s25,s51,11018240
v_mfma_f32_16x16x32_bf16 v[172:175],v[32:35],a[76:79],v[172:175]
s_waitcnt vmcnt(6)
v_mfma_f32_16x16x32_bf16 v[132:135],v[156:159],v[216:219],v[132:135]
s_lshl_b32 s24,s68,16
s_add_u32 s24,s24,s31
s_add_u32 s24,s24,s86
v_mfma_f32_16x16x32_bf16 v[176:179],v[32:35],a[80:83],v[176:179]
ds_write_b128 v6,v[128:131]
v_mfma_f32_16x16x32_bf16 v[180:183],v[32:35],a[84:87],v[180:183]
s_waitcnt vmcnt(5)
v_mfma_f32_16x16x32_bf16 v[132:135],v[156:159],v[220:223],v[132:135]
s_add_u32 m0,s58,4096
s_add_u32 s64,s64,4096
s_cmp_eq_u32 s24,1537
s_cselect_b32 s25,s25,0x80000000
v_mfma_f32_16x16x32_bf16 v[184:187],v[32:35],a[88:91],v[184:187]
buffer_load_dwordx4 v0,s[8:11],s64 offen offset:0 sc1 lds
v_mfma_f32_16x16x32_bf16 v[188:191],v[32:35],a[92:95],v[188:191]
buffer_store_dword v252,off,s[8:11],s25 sc1
s_waitcnt lgkmcnt(14)
v_mfma_f32_16x16x32_bf16 v[160:163],v[36:39],a[96:99],v[160:163]
ds_write_b128 v6,v[132:135] offset:2048
v_mfma_f32_16x16x32_bf16 v[164:167],v[36:39],a[100:103],v[164:167]
s_bitcmp1_b64 s[38:39],s51
s_cselect_b32 s24,128,0
s_lshl_b32 s23,s51,13
v_mfma_f32_16x16x32_bf16 v[168:171],v[36:39],a[104:107],v[168:171]
s_lshl2_add_u32 s23,s68,s23
s_add_u32 s23,s23,10487168
s_add_u32 s23,s23,s24
v_mfma_f32_16x16x32_bf16 v[172:175],v[36:39],a[108:111],v[172:175]
buffer_load_dwordx4 v0,s[8:11],s64 offen offset:1024 sc1 lds
v_mfma_f32_16x16x32_bf16 v[176:179],v[36:39],a[112:115],v[176:179]
buffer_load_dword v246,off,s[8:11],s23 sc1
v_mfma_f32_16x16x32_bf16 v[180:183],v[36:39],a[116:119],v[180:183]
s_waitcnt lgkmcnt(0)
s_barrier
v_lshrrev_b32 v244,4,v1
v_mfma_f32_16x16x32_bf16 v[184:187],v[36:39],a[120:123],v[184:187]
ds_read_b128 v[248:251],v245
s_sub_u32 s23,s77,7
v_mfma_f32_16x16x32_bf16 v[188:191],v[36:39],a[124:127],v[188:191]
buffer_store_dword v20,off,s[8:11],s73 sc1
v_mfma_f32_16x16x32_bf16 v[160:163],v[40:43],a[128:131],v[160:163]
buffer_load_dwordx4 v0,s[8:11],s64 offen offset:2048 sc1 lds
v_mfma_f32_16x16x32_bf16 v[164:167],v[40:43],a[132:135],v[164:167]
s_mov_b32 s73,0x80000000
v_add_u32 v244,s23,v244
v_max_i32 v244,0,v244
v_mfma_f32_16x16x32_bf16 v[168:171],v[40:43],a[136:139],v[168:171]
v_lshl_add_u32 v244,v244,13,v21
v_mfma_f32_16x16x32_bf16 v[172:175],v[40:43],a[140:143],v[172:175]
buffer_load_dwordx2 v[242:243],v244,s[8:11],0 offen sc1
v_mfma_f32_16x16x32_bf16 v[176:179],v[40:43],a[144:147],v[176:179]
s_waitcnt lgkmcnt(0)
v_or3_b32 v248,v248,v249,v250
v_or_b32 v248,v248,v251
v_mfma_f32_16x16x32_bf16 v[180:183],v[40:43],a[148:151],v[180:183]
buffer_load_dwordx4 v0,s[8:11],s64 offen offset:3072 sc1 lds
v_mfma_f32_16x16x32_bf16 v[184:187],v[40:43],a[152:155],v[184:187]
v_mfma_f32_16x16x32_bf16 v[188:191],v[40:43],a[156:159],v[188:191]
v_readfirstlane_b32 s72,v248
v_mfma_f32_16x16x32_bf16 v[160:163],v[44:47],a[160:163],v[160:163]
v_mfma_f32_16x16x32_bf16 v[164:167],v[44:47],a[164:167],v[164:167]
v_mfma_f32_16x16x32_bf16 v[168:171],v[44:47],a[168:171],v[168:171]
s_add_u32 m0,s58,8192
s_add_u32 s64,s64,4096
v_mfma_f32_16x16x32_bf16 v[172:175],v[44:47],a[172:175],v[172:175]
buffer_load_dwordx4 v0,s[8:11],s64 offen offset:0 sc1 lds
v_mfma_f32_16x16x32_bf16 v[176:179],v[44:47],a[176:179],v[176:179]
v_mfma_f32_16x16x32_bf16 v[180:183],v[44:47],a[180:183],v[180:183]
v_mfma_f32_16x16x32_bf16 v[184:187],v[44:47],a[184:187],v[184:187]
v_mfma_f32_16x16x32_bf16 v[188:191],v[44:47],a[188:191],v[188:191]
v_mfma_f32_16x16x32_bf16 v[160:163],v[48:51],a[192:195],v[160:163]
buffer_load_dwordx4 v0,s[8:11],s64 offen offset:1024 sc1 lds
v_mfma_f32_16x16x32_bf16 v[164:167],v[48:51],a[196:199],v[164:167]
v_mfma_f32_16x16x32_bf16 v[168:171],v[48:51],a[200:203],v[168:171]
v_mfma_f32_16x16x32_bf16 v[172:175],v[48:51],a[204:207],v[172:175]
v_mfma_f32_16x16x32_bf16 v[176:179],v[48:51],a[208:211],v[176:179]
v_mfma_f32_16x16x32_bf16 v[180:183],v[48:51],a[212:215],v[180:183]
buffer_load_dwordx4 v0,s[8:11],s64 offen offset:2048 sc1 lds
v_mfma_f32_16x16x32_bf16 v[184:187],v[48:51],a[216:219],v[184:187]
v_mfma_f32_16x16x32_bf16 v[188:191],v[48:51],a[220:223],v[188:191]
v_mfma_f32_16x16x32_bf16 v[160:163],v[52:55],a[224:227],v[160:163]
v_mfma_f32_16x16x32_bf16 v[164:167],v[52:55],a[228:231],v[164:167]
v_mfma_f32_16x16x32_bf16 v[168:171],v[52:55],a[232:235],v[168:171]
buffer_load_dwordx4 v0,s[8:11],s64 offen offset:3072 sc1 lds
v_mfma_f32_16x16x32_bf16 v[172:175],v[52:55],a[236:239],v[172:175]
v_mfma_f32_16x16x32_bf16 v[176:179],v[52:55],a[240:243],v[176:179]
v_mfma_f32_16x16x32_bf16 v[180:183],v[52:55],a[244:247],v[180:183]
v_mfma_f32_16x16x32_bf16 v[184:187],v[52:55],a[248:251],v[184:187]
v_mfma_f32_16x16x32_bf16 v[188:191],v[52:55],a[252:255],v[188:191]
s_add_u32 m0,s57,24576
v_mfma_f32_16x16x32_bf16 v[192:195],v[56:59],a[0:3],0
buffer_load_dwordx4 v0,s[8:11],s65 offen offset:0 sc1 lds
v_mfma_f32_16x16x32_bf16 v[196:199],v[56:59],a[4:7],0
v_mfma_f32_16x16x32_bf16 v[200:203],v[56:59],a[8:11],0
v_cvt_pk_bf16_f32 v24,v160,v164
v_cvt_pk_bf16_f32 v25,v168,v172
v_mfma_f32_16x16x32_bf16 v[204:207],v[56:59],a[12:15],0
v_cvt_pk_bf16_f32 v26,v176,v180
v_cvt_pk_bf16_f32 v27,v184,v188
v_mfma_f32_16x16x32_bf16 v[208:211],v[56:59],a[16:19],0
v_cvt_pk_bf16_f32 v28,v161,v165
v_cvt_pk_bf16_f32 v29,v169,v173
v_mfma_f32_16x16x32_bf16 v[212:215],v[56:59],a[20:23],0
buffer_load_dwordx4 v0,s[8:11],s65 offen offset:1024 sc1 lds
v_mfma_f32_16x16x32_bf16 v[216:219],v[56:59],a[24:27],0
v_cvt_pk_bf16_f32 v30,v177,v181
v_cvt_pk_bf16_f32 v31,v185,v189
v_mfma_f32_16x16x32_bf16 v[220:223],v[56:59],a[28:31],0
v_cvt_pk_bf16_f32 v32,v162,v166
v_cvt_pk_bf16_f32 v33,v170,v174
v_mfma_f32_16x16x32_bf16 v[192:195],v[60:63],a[32:35],v[192:195]
v_cvt_pk_bf16_f32 v34,v178,v182
v_cvt_pk_bf16_f32 v35,v186,v190
v_mfma_f32_16x16x32_bf16 v[196:199],v[60:63],a[36:39],v[196:199]
v_cvt_pk_bf16_f32 v36,v163,v167
v_cvt_pk_bf16_f32 v37,v171,v175
v_mfma_f32_16x16x32_bf16 v[200:203],v[60:63],a[40:43],v[200:203]
v_cvt_pk_bf16_f32 v38,v179,v183
v_cvt_pk_bf16_f32 v39,v187,v191
v_mfma_f32_16x16x32_bf16 v[204:207],v[60:63],a[44:47],v[204:207]
v_mfma_f32_16x16x32_bf16 v[208:211],v[60:63],a[48:51],v[208:211]
v_mfma_f32_16x16x32_bf16 v[212:215],v[60:63],a[52:55],v[212:215]
v_mfma_f32_16x16x32_bf16 v[216:219],v[60:63],a[56:59],v[216:219]
v_mfma_f32_16x16x32_bf16 v[220:223],v[60:63],a[60:63],v[220:223]
v_mfma_f32_16x16x32_bf16 v[192:195],v[64:67],a[64:67],v[192:195]
v_mfma_f32_16x16x32_bf16 v[196:199],v[64:67],a[68:71],v[196:199]
v_mfma_f32_16x16x32_bf16 v[200:203],v[64:67],a[72:75],v[200:203]
v_mfma_f32_16x16x32_bf16 v[204:207],v[64:67],a[76:79],v[204:207]
v_mfma_f32_16x16x32_bf16 v[208:211],v[64:67],a[80:83],v[208:211]
v_mfma_f32_16x16x32_bf16 v[212:215],v[64:67],a[84:87],v[212:215]
v_mfma_f32_16x16x32_bf16 v[216:219],v[64:67],a[88:91],v[216:219]
v_mfma_f32_16x16x32_bf16 v[220:223],v[64:67],a[92:95],v[220:223]
v_mfma_f32_16x16x32_bf16 v[192:195],v[68:71],a[96:99],v[192:195]
v_mfma_f32_16x16x32_bf16 v[196:199],v[68:71],a[100:103],v[196:199]
v_mfma_f32_16x16x32_bf16 v[200:203],v[68:71],a[104:107],v[200:203]
v_mfma_f32_16x16x32_bf16 v[204:207],v[68:71],a[108:111],v[204:207]
v_mfma_f32_16x16x32_bf16 v[208:211],v[68:71],a[112:115],v[208:211]
s_add_u32 s62,s69,0
v_mfma_f32_16x16x32_bf16 v[212:215],v[68:71],a[116:119],v[212:215]
buffer_store_dwordx4 v[24:27],v5,s[8:11],s62 offen sc1
v_mfma_f32_16x16x32_bf16 v[216:219],v[68:71],a[120:123],v[216:219]
v_mfma_f32_16x16x32_bf16 v[220:223],v[68:71],a[124:127],v[220:223]
v_mfma_f32_16x16x32_bf16 v[192:195],v[72:75],a[128:131],v[192:195]
v_mfma_f32_16x16x32_bf16 v[196:199],v[72:75],a[132:135],v[196:199]
s_add_u32 s62,s69,16384
v_mfma_f32_16x16x32_bf16 v[200:203],v[72:75],a[136:139],v[200:203]
buffer_store_dwordx4 v[28:31],v5,s[8:11],s62 offen sc1
v_mfma_f32_16x16x32_bf16 v[204:207],v[72:75],a[140:143],v[204:207]
v_mfma_f32_16x16x32_bf16 v[208:211],v[72:75],a[144:147],v[208:211]
v_mfma_f32_16x16x32_bf16 v[212:215],v[72:75],a[148:151],v[212:215]
v_mfma_f32_16x16x32_bf16 v[216:219],v[72:75],a[152:155],v[216:219]
s_add_u32 s62,s69,32768
v_mfma_f32_16x16x32_bf16 v[220:223],v[72:75],a[156:159],v[220:223]
buffer_store_dwordx4 v[32:35],v5,s[8:11],s62 offen sc1
v_mfma_f32_16x16x32_bf16 v[192:195],v[76:79],a[160:163],v[192:195]
v_mfma_f32_16x16x32_bf16 v[196:199],v[76:79],a[164:167],v[196:199]
v_mfma_f32_16x16x32_bf16 v[200:203],v[76:79],a[168:171],v[200:203]
v_mfma_f32_16x16x32_bf16 v[204:207],v[76:79],a[172:175],v[204:207]
s_add_u32 s62,s69,49152
v_mfma_f32_16x16x32_bf16 v[208:211],v[76:79],a[176:179],v[208:211]
buffer_store_dwordx4 v[36:39],v5,s[8:11],s62 offen sc1
v_mfma_f32_16x16x32_bf16 v[212:215],v[76:79],a[180:183],v[212:215]
v_mfma_f32_16x16x32_bf16 v[216:219],v[76:79],a[184:187],v[216:219]
v_mfma_f32_16x16x32_bf16 v[220:223],v[76:79],a[188:191],v[220:223]
v_mfma_f32_16x16x32_bf16 v[192:195],v[80:83],a[192:195],v[192:195]
v_mfma_f32_16x16x32_bf16 v[196:199],v[80:83],a[196:199],v[196:199]
v_mfma_f32_16x16x32_bf16 v[192:195],v[84:87],a[224:227],v[192:195]
v_mfma_f32_16x16x32_bf16 v[196:199],v[84:87],a[228:231],v[196:199]
v_mfma_f32_16x16x32_bf16 v[200:203],v[80:83],a[200:203],v[200:203]
v_mfma_f32_16x16x32_bf16 v[204:207],v[80:83],a[204:207],v[204:207]
v_mfma_f32_16x16x32_bf16 v[200:203],v[84:87],a[232:235],v[200:203]
v_mfma_f32_16x16x32_bf16 v[204:207],v[84:87],a[236:239],v[204:207]
v_cvt_pk_bf16_f32 v40,v192,v196
v_cvt_pk_bf16_f32 v44,v193,v197
v_cvt_pk_bf16_f32 v48,v194,v198
v_mfma_f32_16x16x32_bf16 v[208:211],v[80:83],a[208:211],v[208:211]
v_cvt_pk_bf16_f32 v52,v195,v199
v_mfma_f32_16x16x32_bf16 v[212:215],v[80:83],a[212:215],v[212:215]
v_cvt_pk_bf16_f32 v41,v200,v204
v_cvt_pk_bf16_f32 v45,v201,v205
v_cvt_pk_bf16_f32 v49,v202,v206
v_mfma_f32_16x16x32_bf16 v[208:211],v[84:87],a[240:243],v[208:211]
v_cvt_pk_bf16_f32 v53,v203,v207
v_mfma_f32_16x16x32_bf16 v[212:215],v[84:87],a[244:247],v[212:215]
v_mfma_f32_16x16x32_bf16 v[216:219],v[80:83],a[216:219],v[216:219]
v_mfma_f32_16x16x32_bf16 v[220:223],v[80:83],a[220:223],v[220:223]
v_mfma_f32_16x16x32_bf16 v[216:219],v[84:87],a[248:251],v[216:219]
v_mfma_f32_16x16x32_bf16 v[220:223],v[84:87],a[252:255],v[220:223]
v_cvt_pk_bf16_f32 v42,v208,v212
v_cvt_pk_bf16_f32 v46,v209,v213
v_cvt_pk_bf16_f32 v50,v210,v214
v_cvt_pk_bf16_f32 v54,v211,v215
s_nop 3
v_cvt_pk_bf16_f32 v43,v216,v220
s_add_u32 s62,s69,262144
buffer_store_dwordx4 v[40:43],v5,s[8:11],s62 offen sc1
v_cvt_pk_bf16_f32 v47,v217,v221
s_add_u32 s62,s69,278528
buffer_store_dwordx4 v[44:47],v5,s[8:11],s62 offen sc1
v_cvt_pk_bf16_f32 v51,v218,v222
s_add_u32 s62,s69,294912
buffer_store_dwordx4 v[48:51],v5,s[8:11],s62 offen sc1
v_cvt_pk_bf16_f32 v55,v219,v223
s_add_u32 s62,s69,311296
buffer_store_dwordx4 v[52:55],v5,s[8:11],s62 offen sc1
s_cmp_lg_u32 s72,0
s_cbranch_scc1 L_aa_321
s_waitcnt vmcnt(8)
s_branch L_aa_331
L_aa_319:
ds_read_b128 v[24:27],v4 offset:0
ds_read_b128 v[28:31],v4 offset:1024
s_min_u32 s56,s32,s33
s_cmp_lt_u32 s77,64
s_cselect_b32 s56,s56,0
s_cmp_eq_u32 s56,0
s_cselect_b32 s72,0x80000000,0
v_mov_b32 v248,s72
s_or_b32 s64,s70,s72
s_or_b32 s65,s71,s72
s_cmp_lt_u32 s30,s31
s_cselect_b32 s65,0x80000000,s65
s_add_u32 s64,s64,s28
s_add_u32 s65,s65,s29
s_xor_b32 s58,s67,s40
s_xor_b32 s57,s67,s41
s_add_u32 m0,s58,0
s_waitcnt lgkmcnt(1)
v_mfma_f32_16x16x32_bf16 v[160:163],v[24:27],a[0:3],0
buffer_load_dwordx4 v0,s[8:11],s64 offen offset:0 sc1 lds
v_mfma_f32_16x16x32_bf16 v[164:167],v[24:27],a[4:7],0
ds_read_b128 v[32:35],v4 offset:2048
s_lshl_b32 s23,s51,5
v_mfma_f32_16x16x32_bf16 v[168:171],v[24:27],a[8:11],0
ds_read_b128 v[36:39],v4 offset:3072
s_add_u32 s23,s23,s68
v_mfma_f32_16x16x32_bf16 v[172:175],v[24:27],a[12:15],0
ds_read_b128 v[40:43],v4 offset:8192
s_lshl_b32 s24,s23,10
v_mfma_f32_16x16x32_bf16 v[176:179],v[24:27],a[16:19],0
ds_read_b128 v[44:47],v4 offset:9216
s_lshl_b32 s25,s51,10
v_mfma_f32_16x16x32_bf16 v[180:183],v[24:27],a[20:23],0
buffer_load_dwordx4 v0,s[8:11],s64 offen offset:1024 sc1 lds
v_mfma_f32_16x16x32_bf16 v[184:187],v[24:27],a[24:27],0
ds_read_b128 v[48:51],v4 offset:10240
s_add_u32 s25,s25,2883584
v_mfma_f32_16x16x32_bf16 v[188:191],v[24:27],a[28:31],0
ds_read_b128 v[52:55],v4 offset:11264
s_cmp_eq_u32 s23,s55
s_cselect_b32 s25,s25,s24
s_waitcnt lgkmcnt(6)
v_mfma_f32_16x16x32_bf16 v[160:163],v[28:31],a[32:35],v[160:163]
ds_write_b32 v247,v248
s_add_u32 s25,s25,8388608
v_mfma_f32_16x16x32_bf16 v[164:167],v[28:31],a[36:39],v[164:167]
ds_read_b128 v[56:59],v4 offset:4096
s_mov_b32 s6,268435456
v_mfma_f32_16x16x32_bf16 v[168:171],v[28:31],a[40:43],v[168:171]
buffer_load_dwordx4 v0,s[8:11],s64 offen offset:2048 sc1 lds
v_mfma_f32_16x16x32_bf16 v[172:175],v[28:31],a[44:47],v[172:175]
ds_read_b128 v[60:63],v4 offset:5120
s_cmp_eq_u32 s31,0
s_cselect_b32 s25,s24,s25
s_cselect_b64 s[4:5],s[16:17],s[44:45]
s_cmov_b32 s6,2097152
v_mfma_f32_16x16x32_bf16 v[176:179],v[28:31],a[48:51],v[176:179]
ds_read_b128 v[64:67],v4 offset:6144
v_mfma_f32_16x16x32_bf16 v[180:183],v[28:31],a[52:55],v[180:183]
ds_read_b128 v[68:71],v4 offset:7168
v_mfma_f32_16x16x32_bf16 v[184:187],v[28:31],a[56:59],v[184:187]
ds_read_b128 v[72:75],v4 offset:12288
v_mfma_f32_16x16x32_bf16 v[188:191],v[28:31],a[60:63],v[188:191]
buffer_load_dwordx4 v0,s[8:11],s64 offen offset:3072 sc1 lds
s_waitcnt lgkmcnt(11)
v_mfma_f32_16x16x32_bf16 v[160:163],v[32:35],a[64:67],v[160:163]
ds_read_b128 v[76:79],v4 offset:13312
v_mfma_f32_16x16x32_bf16 v[164:167],v[32:35],a[68:71],v[164:167]
ds_read_b128 v[80:83],v4 offset:14336
v_mfma_f32_16x16x32_bf16 v[168:171],v[32:35],a[72:75],v[168:171]
ds_read_b128 v[84:87],v4 offset:15360
v_mfma_f32_16x16x32_bf16 v[172:175],v[32:35],a[76:79],v[172:175]
buffer_load_dwordx4 v[224:227],v0,s[4:7],s25 offen sc1
v_mfma_f32_16x16x32_bf16 v[176:179],v[32:35],a[80:83],v[176:179]
s_add_u32 m0,s58,4096
s_add_u32 s64,s64,4096
s_lshr_b32 s24,s55,5
v_mfma_f32_16x16x32_bf16 v[180:183],v[32:35],a[84:87],v[180:183]
buffer_load_dwordx4 v0,s[8:11],s64 offen offset:0 sc1 lds
v_mfma_f32_16x16x32_bf16 v[184:187],v[32:35],a[88:91],v[184:187]
s_cmp_lt_u32 s51,s24
s_cselect_b32 s24,1,2
v_mov_b32 v252,s24
v_mfma_f32_16x16x32_bf16 v[188:191],v[32:35],a[92:95],v[188:191]
s_waitcnt lgkmcnt(0)
s_barrier
s_lshl2_add_u32 s25,s51,11018240
v_mfma_f32_16x16x32_bf16 v[160:163],v[36:39],a[96:99],v[160:163]
ds_read_b128 v[248:251],v245
s_lshl_b32 s24,s68,16
v_mfma_f32_16x16x32_bf16 v[164:167],v[36:39],a[100:103],v[164:167]
s_add_u32 s24,s24,s31
s_add_u32 s24,s24,s86
s_cmp_eq_u32 s24,1537
s_cselect_b32 s25,s25,0x80000000
v_mfma_f32_16x16x32_bf16 v[168:171],v[36:39],a[104:107],v[168:171]
buffer_load_dwordx4 v0,s[8:11],s64 offen offset:1024 sc1 lds
v_mfma_f32_16x16x32_bf16 v[172:175],v[36:39],a[108:111],v[172:175]
buffer_store_dword v252,off,s[8:11],s25 sc1
v_mfma_f32_16x16x32_bf16 v[176:179],v[36:39],a[112:115],v[176:179]
s_bitcmp1_b64 s[38:39],s51
s_cselect_b32 s24,128,0
s_lshl_b32 s23,s51,13
v_mfma_f32_16x16x32_bf16 v[180:183],v[36:39],a[116:119],v[180:183]
s_lshl2_add_u32 s23,s68,s23
s_add_u32 s23,s23,10487168
s_add_u32 s23,s23,s24
v_mfma_f32_16x16x32_bf16 v[184:187],v[36:39],a[120:123],v[184:187]
buffer_load_dword v246,off,s[8:11],s23 sc1
v_mfma_f32_16x16x32_bf16 v[188:191],v[36:39],a[124:127],v[188:191]
buffer_load_dwordx4 v0,s[8:11],s64 offen offset:2048 sc1 lds
v_mfma_f32_16x16x32_bf16 v[160:163],v[40:43],a[128:131],v[160:163]
s_waitcnt lgkmcnt(0)
v_or3_b32 v248,v248,v249,v250
v_or_b32 v248,v248,v251
v_mfma_f32_16x16x32_bf16 v[164:167],v[40:43],a[132:135],v[164:167]
v_lshrrev_b32 v244,4,v1
s_sub_u32 s23,s77,7
v_mfma_f32_16x16x32_bf16 v[168:171],v[40:43],a[136:139],v[168:171]
v_readfirstlane_b32 s72,v248
v_add_u32 v244,s23,v244
v_mfma_f32_16x16x32_bf16 v[172:175],v[40:43],a[140:143],v[172:175]
v_max_i32 v244,0,v244
v_lshl_add_u32 v244,v244,13,v21
v_mfma_f32_16x16x32_bf16 v[176:179],v[40:43],a[144:147],v[176:179]
buffer_load_dwordx4 v0,s[8:11],s64 offen offset:3072 sc1 lds
v_mfma_f32_16x16x32_bf16 v[180:183],v[40:43],a[148:151],v[180:183]
buffer_load_dwordx2 v[242:243],v244,s[8:11],0 offen sc1
v_mfma_f32_16x16x32_bf16 v[184:187],v[40:43],a[152:155],v[184:187]
s_waitcnt vmcnt(12)
v_mfma_f32_16x16x32_bf16 v[188:191],v[40:43],a[156:159],v[188:191]
buffer_store_dword v20,off,s[8:11],s73 sc1
v_mfma_f32_16x16x32_bf16 v[160:163],v[44:47],a[160:163],v[160:163]
s_mov_b32 s73,0x80000000
v_mfma_f32_16x16x32_bf16 v[164:167],v[44:47],a[164:167],v[164:167]
s_add_u32 m0,s58,8192
s_add_u32 s64,s64,4096
v_mfma_f32_16x16x32_bf16 v[168:171],v[44:47],a[168:171],v[168:171]
buffer_load_dwordx4 v0,s[8:11],s64 offen offset:0 sc1 lds
v_mfma_f32_16x16x32_bf16 v[172:175],v[44:47],a[172:175],v[172:175]
v_mfma_f32_16x16x32_bf16 v[176:179],v[44:47],a[176:179],v[176:179]
v_mfma_f32_16x16x32_bf16 v[180:183],v[44:47],a[180:183],v[180:183]
v_mfma_f32_16x16x32_bf16 v[184:187],v[44:47],a[184:187],v[184:187]
v_mfma_f32_16x16x32_bf16 v[188:191],v[44:47],a[188:191],v[188:191]
buffer_load_dwordx4 v0,s[8:11],s64 offen offset:1024 sc1 lds
v_mfma_f32_16x16x32_bf16 v[160:163],v[48:51],a[192:195],v[160:163]
v_mfma_f32_16x16x32_bf16 v[164:167],v[48:51],a[196:199],v[164:167]
v_mfma_f32_16x16x32_bf16 v[168:171],v[48:51],a[200:203],v[168:171]
v_mfma_f32_16x16x32_bf16 v[172:175],v[48:51],a[204:207],v[172:175]
v_mfma_f32_16x16x32_bf16 v[176:179],v[48:51],a[208:211],v[176:179]
buffer_load_dwordx4 v0,s[8:11],s64 offen offset:2048 sc1 lds
v_mfma_f32_16x16x32_bf16 v[180:183],v[48:51],a[212:215],v[180:183]
v_mfma_f32_16x16x32_bf16 v[184:187],v[48:51],a[216:219],v[184:187]
v_mfma_f32_16x16x32_bf16 v[188:191],v[48:51],a[220:223],v[188:191]
v_mfma_f32_16x16x32_bf16 v[160:163],v[52:55],a[224:227],v[160:163]
v_mfma_f32_16x16x32_bf16 v[164:167],v[52:55],a[228:231],v[164:167]
buffer_load_dwordx4 v0,s[8:11],s64 offen offset:3072 sc1 lds
v_mfma_f32_16x16x32_bf16 v[168:171],v[52:55],a[232:235],v[168:171]
v_mfma_f32_16x16x32_bf16 v[172:175],v[52:55],a[236:239],v[172:175]
v_mfma_f32_16x16x32_bf16 v[176:179],v[52:55],a[240:243],v[176:179]
v_mfma_f32_16x16x32_bf16 v[180:183],v[52:55],a[244:247],v[180:183]
v_mfma_f32_16x16x32_bf16 v[184:187],v[52:55],a[248:251],v[184:187]
s_add_u32 m0,s57,24576
v_mfma_f32_16x16x32_bf16 v[188:191],v[52:55],a[252:255],v[188:191]
buffer_load_dwordx4 v0,s[8:11],s65 offen offset:0 sc1 lds
v_mfma_f32_16x16x32_bf16 v[192:195],v[56:59],a[0:3],0
v_mfma_f32_16x16x32_bf16 v[196:199],v[56:59],a[4:7],0
v_mfma_f32_16x16x32_bf16 v[200:203],v[56:59],a[8:11],0
v_cvt_pk_bf16_f32 v24,v160,v164
v_cvt_pk_bf16_f32 v25,v168,v172
v_mfma_f32_16x16x32_bf16 v[204:207],v[56:59],a[12:15],0
v_cvt_pk_bf16_f32 v26,v176,v180
v_cvt_pk_bf16_f32 v27,v184,v188
v_mfma_f32_16x16x32_bf16 v[208:211],v[56:59],a[16:19],0
buffer_load_dwordx4 v0,s[8:11],s65 offen offset:1024 sc1 lds
v_mfma_f32_16x16x32_bf16 v[212:215],v[56:59],a[20:23],0
v_cvt_pk_bf16_f32 v28,v161,v165
v_cvt_pk_bf16_f32 v29,v169,v173
v_mfma_f32_16x16x32_bf16 v[216:219],v[56:59],a[24:27],0
v_cvt_pk_bf16_f32 v30,v177,v181
v_cvt_pk_bf16_f32 v31,v185,v189
v_mfma_f32_16x16x32_bf16 v[220:223],v[56:59],a[28:31],0
v_cvt_pk_bf16_f32 v32,v162,v166
v_cvt_pk_bf16_f32 v33,v170,v174
v_mfma_f32_16x16x32_bf16 v[192:195],v[60:63],a[32:35],v[192:195]
v_cvt_pk_bf16_f32 v34,v178,v182
v_cvt_pk_bf16_f32 v35,v186,v190
v_mfma_f32_16x16x32_bf16 v[196:199],v[60:63],a[36:39],v[196:199]
v_cvt_pk_bf16_f32 v36,v163,v167
v_cvt_pk_bf16_f32 v37,v171,v175
v_mfma_f32_16x16x32_bf16 v[200:203],v[60:63],a[40:43],v[200:203]
v_cvt_pk_bf16_f32 v38,v179,v183
v_cvt_pk_bf16_f32 v39,v187,v191
v_mfma_f32_16x16x32_bf16 v[204:207],v[60:63],a[44:47],v[204:207]
v_mfma_f32_16x16x32_bf16 v[208:211],v[60:63],a[48:51],v[208:211]
v_mfma_f32_16x16x32_bf16 v[212:215],v[60:63],a[52:55],v[212:215]
v_mfma_f32_16x16x32_bf16 v[216:219],v[60:63],a[56:59],v[216:219]
v_mfma_f32_16x16x32_bf16 v[220:223],v[60:63],a[60:63],v[220:223]
v_mfma_f32_16x16x32_bf16 v[192:195],v[64:67],a[64:67],v[192:195]
v_mfma_f32_16x16x32_bf16 v[196:199],v[64:67],a[68:71],v[196:199]
v_mfma_f32_16x16x32_bf16 v[200:203],v[64:67],a[72:75],v[200:203]
v_mfma_f32_16x16x32_bf16 v[204:207],v[64:67],a[76:79],v[204:207]
v_mfma_f32_16x16x32_bf16 v[208:211],v[64:67],a[80:83],v[208:211]
v_mfma_f32_16x16x32_bf16 v[212:215],v[64:67],a[84:87],v[212:215]
v_mfma_f32_16x16x32_bf16 v[216:219],v[64:67],a[88:91],v[216:219]
v_mfma_f32_16x16x32_bf16 v[220:223],v[64:67],a[92:95],v[220:223]
v_mfma_f32_16x16x32_bf16 v[192:195],v[68:71],a[96:99],v[192:195]
v_mfma_f32_16x16x32_bf16 v[196:199],v[68:71],a[100:103],v[196:199]
v_mfma_f32_16x16x32_bf16 v[200:203],v[68:71],a[104:107],v[200:203]
v_mfma_f32_16x16x32_bf16 v[204:207],v[68:71],a[108:111],v[204:207]
v_mfma_f32_16x16x32_bf16 v[208:211],v[68:71],a[112:115],v[208:211]
s_add_u32 s62,s69,0
v_mfma_f32_16x16x32_bf16 v[212:215],v[68:71],a[116:119],v[212:215]
buffer_store_dwordx4 v[24:27],v5,s[8:11],s62 offen sc1
v_mfma_f32_16x16x32_bf16 v[216:219],v[68:71],a[120:123],v[216:219]
v_mfma_f32_16x16x32_bf16 v[220:223],v[68:71],a[124:127],v[220:223]
v_mfma_f32_16x16x32_bf16 v[192:195],v[72:75],a[128:131],v[192:195]
v_mfma_f32_16x16x32_bf16 v[196:199],v[72:75],a[132:135],v[196:199]
s_add_u32 s62,s69,16384
v_mfma_f32_16x16x32_bf16 v[200:203],v[72:75],a[136:139],v[200:203]
buffer_store_dwordx4 v[28:31],v5,s[8:11],s62 offen sc1
v_mfma_f32_16x16x32_bf16 v[204:207],v[72:75],a[140:143],v[204:207]
v_mfma_f32_16x16x32_bf16 v[208:211],v[72:75],a[144:147],v[208:211]
v_mfma_f32_16x16x32_bf16 v[212:215],v[72:75],a[148:151],v[212:215]
v_mfma_f32_16x16x32_bf16 v[216:219],v[72:75],a[152:155],v[216:219]
s_add_u32 s62,s69,32768
v_mfma_f32_16x16x32_bf16 v[220:223],v[72:75],a[156:159],v[220:223]
buffer_store_dwordx4 v[32:35],v5,s[8:11],s62 offen sc1
v_mfma_f32_16x16x32_bf16 v[192:195],v[76:79],a[160:163],v[192:195]
v_mfma_f32_16x16x32_bf16 v[196:199],v[76:79],a[164:167],v[196:199]
v_mfma_f32_16x16x32_bf16 v[200:203],v[76:79],a[168:171],v[200:203]
v_mfma_f32_16x16x32_bf16 v[204:207],v[76:79],a[172:175],v[204:207]
s_add_u32 s62,s69,49152
v_mfma_f32_16x16x32_bf16 v[208:211],v[76:79],a[176:179],v[208:211]
buffer_store_dwordx4 v[36:39],v5,s[8:11],s62 offen sc1
v_mfma_f32_16x16x32_bf16 v[212:215],v[76:79],a[180:183],v[212:215]
v_mfma_f32_16x16x32_bf16 v[216:219],v[76:79],a[184:187],v[216:219]
v_mfma_f32_16x16x32_bf16 v[220:223],v[76:79],a[188:191],v[220:223]
v_mfma_f32_16x16x32_bf16 v[192:195],v[80:83],a[192:195],v[192:195]
v_mfma_f32_16x16x32_bf16 v[196:199],v[80:83],a[196:199],v[196:199]
v_mfma_f32_16x16x32_bf16 v[192:195],v[84:87],a[224:227],v[192:195]
v_mfma_f32_16x16x32_bf16 v[196:199],v[84:87],a[228:231],v[196:199]
v_mfma_f32_16x16x32_bf16 v[200:203],v[80:83],a[200:203],v[200:203]
v_mfma_f32_16x16x32_bf16 v[204:207],v[80:83],a[204:207],v[204:207]
v_mfma_f32_16x16x32_bf16 v[200:203],v[84:87],a[232:235],v[200:203]
v_mfma_f32_16x16x32_bf16 v[204:207],v[84:87],a[236:239],v[204:207]
v_cvt_pk_bf16_f32 v40,v192,v196
v_cvt_pk_bf16_f32 v44,v193,v197
v_cvt_pk_bf16_f32 v48,v194,v198
v_mfma_f32_16x16x32_bf16 v[208:211],v[80:83],a[208:211],v[208:211]
v_cvt_pk_bf16_f32 v52,v195,v199
v_mfma_f32_16x16x32_bf16 v[212:215],v[80:83],a[212:215],v[212:215]
v_cvt_pk_bf16_f32 v41,v200,v204
v_cvt_pk_bf16_f32 v45,v201,v205
v_cvt_pk_bf16_f32 v49,v202,v206
v_mfma_f32_16x16x32_bf16 v[208:211],v[84:87],a[240:243],v[208:211]
v_cvt_pk_bf16_f32 v53,v203,v207
v_mfma_f32_16x16x32_bf16 v[212:215],v[84:87],a[244:247],v[212:215]
v_mfma_f32_16x16x32_bf16 v[216:219],v[80:83],a[216:219],v[216:219]
v_mfma_f32_16x16x32_bf16 v[220:223],v[80:83],a[220:223],v[220:223]
v_mfma_f32_16x16x32_bf16 v[216:219],v[84:87],a[248:251],v[216:219]
v_mfma_f32_16x16x32_bf16 v[220:223],v[84:87],a[252:255],v[220:223]
v_cvt_pk_bf16_f32 v42,v208,v212
v_cvt_pk_bf16_f32 v46,v209,v213
v_cvt_pk_bf16_f32 v50,v210,v214
v_cvt_pk_bf16_f32 v54,v211,v215
s_nop 3
v_cvt_pk_bf16_f32 v43,v216,v220
s_add_u32 s62,s69,262144
buffer_store_dwordx4 v[40:43],v5,s[8:11],s62 offen sc1
v_cvt_pk_bf16_f32 v47,v217,v221
s_add_u32 s62,s69,278528
buffer_store_dwordx4 v[44:47],v5,s[8:11],s62 offen sc1
v_cvt_pk_bf16_f32 v51,v218,v222
s_add_u32 s62,s69,294912
buffer_store_dwordx4 v[48:51],v5,s[8:11],s62 offen sc1
v_cvt_pk_bf16_f32 v55,v219,v223
s_add_u32 s62,s69,311296
buffer_store_dwordx4 v[52:55],v5,s[8:11],s62 offen sc1
s_cmp_lg_u32 s72,0
s_cbranch_scc1 L_aa_321
s_waitcnt vmcnt(8)
L_aa_331:
s_barrier
s_cmp_lt_u32 s30,s31
s_cbranch_scc1 L_ao_338
s_xor_b32 s67,s67,65536
s_and_b32 s56,s50,2048
s_lshl_b32 s56,s56,4
s_add_u32 s56,s56,s67
v_add_u32 v2,s56,v0
s_and_b32 s56,s50,1024
s_lshl_b32 s56,s56,2
v_add_u32 v238,s56,v2
s_mov_b32 s76,s71
s_mov_b32 s53,s77
ds_read_b128 v[24:27],v238 offset:16384
ds_read_b128 v[40:43],v2 offset:0
ds_read_b128 v[56:59],v2 offset:4096
ds_read_b128 v[28:31],v238 offset:17408
ds_read_b128 v[44:47],v2 offset:1024
ds_read_b128 v[60:63],v2 offset:5120
ds_read_b128 v[32:35],v238 offset:18432
ds_read_b128 v[48:51],v2 offset:2048
ds_read_b128 v[64:67],v2 offset:6144
ds_read_b128 v[36:39],v238 offset:19456
ds_read_b128 v[52:55],v2 offset:3072
ds_read_b128 v[68:71],v2 offset:7168
s_waitcnt lgkmcnt(9)
v_mfma_f32_16x16x32_bf16 v[128:131],v[40:43],v[24:27],v[8:11]
ds_read_b128 v[72:75],v2 offset:24576
v_mfma_f32_16x16x32_bf16 v[132:135],v[56:59],v[24:27],v[12:15]
ds_read_b128 v[76:79],v2 offset:25600
s_waitcnt lgkmcnt(8)
v_mfma_f32_16x16x32_bf16 v[128:131],v[44:47],v[28:31],v[128:131]
ds_read_b128 v[80:83],v2 offset:26624
v_mfma_f32_16x16x32_bf16 v[132:135],v[60:63],v[28:31],v[132:135]
ds_read_b128 v[84:87],v2 offset:27648
s_waitcnt lgkmcnt(7)
v_mfma_f32_16x16x32_bf16 v[128:131],v[48:51],v[32:35],v[128:131]
ds_read_b128 v[88:91],v2 offset:8192
v_mfma_f32_16x16x32_bf16 v[132:135],v[64:67],v[32:35],v[132:135]
ds_read_b128 v[92:95],v2 offset:9216
s_waitcnt lgkmcnt(6)
v_mfma_f32_16x16x32_bf16 v[128:131],v[52:55],v[36:39],v[128:131]
ds_read_b128 v[96:99],v2 offset:10240
v_mfma_f32_16x16x32_bf16 v[132:135],v[68:71],v[36:39],v[132:135]
ds_read_b128 v[100:103],v2 offset:11264
s_waitcnt lgkmcnt(4)
s_mov_b32 vcc_lo,0x33333333
s_mov_b32 vcc_hi,0x33333333
v_mfma_f32_16x16x32_bf16 v[136:139],v[72:75],v[24:27],0
ds_read_b128 v[104:107],v2 offset:12288
v_max3_u32 v238,v72,v73,v74
v_max3_u32 v238,v74,v75,v238
v_cndmask_b32_dpp v120,v72,v74,vcc quad_perm:[0,1,0,1] row_mask:0xf bank_mask:0xf
v_cndmask_b32_dpp v121,v73,v75,vcc quad_perm:[0,1,0,1] row_mask:0xf bank_mask:0xf
v_mfma_f32_16x16x32_bf16 v[136:139],v[76:79],v[28:31],v[136:139]
ds_read_b128 v[108:111],v2 offset:13312
v_max3_u32 v238,v76,v77,v238
v_max3_u32 v238,v78,v79,v238
v_cndmask_b32_dpp v122,v76,v78,vcc quad_perm:[0,1,0,1] row_mask:0xf bank_mask:0xf
v_cndmask_b32_dpp v123,v77,v79,vcc quad_perm:[0,1,0,1] row_mask:0xf bank_mask:0xf
v_mfma_f32_16x16x32_bf16 v[136:139],v[80:83],v[32:35],v[136:139]
ds_read_b128 v[112:115],v2 offset:14336
v_max3_u32 v238,v80,v81,v238
v_max3_u32 v238,v82,v83,v238
v_cndmask_b32_dpp v124,v80,v82,vcc quad_perm:[0,1,0,1] row_mask:0xf bank_mask:0xf
v_cndmask_b32_dpp v125,v81,v83,vcc quad_perm:[0,1,0,1] row_mask:0xf bank_mask:0xf
v_mfma_f32_16x16x32_bf16 v[136:139],v[84:87],v[36:39],v[136:139]
ds_read_b128 v[116:119],v2 offset:15360
v_max3_u32 v238,v84,v85,v238
v_max3_u32 v238,v86,v87,v238
v_cndmask_b32_dpp v126,v84,v86,vcc quad_perm:[0,1,0,1] row_mask:0xf bank_mask:0xf
v_cndmask_b32_dpp v127,v85,v87,vcc quad_perm:[0,1,0,1] row_mask:0xf bank_mask:0xf
v_cmp_eq_u32 vcc,-1,v238
s_cmp_eq_u32 s30,0
s_cbranch_scc1 L_aa_320
s_cmp_lg_u64 vcc,0
s_cselect_b32 s27,1,0
s_andn2_b32 s57,s27,s31
s_add_u32 s66,s66,4
s_bfe_u32 s56,s66,0x10002
s_bitset0_b32 s37,s56
s_lshl_b32 s56,s57,s56
s_or_b32 s37,s37,s56
s_or_b32 s56,s37,s66
v_mov_b32 v22,s56
s_xor_b32 s69,s69,524288
s_waitcnt vmcnt(0) lgkmcnt(0)
buffer_store_dword v22,off,s[8:11],s74 sc1
s_cmp_lg_u32 s86,1536
s_cbranch_scc1 L_ae_341
s_mov_b32 s77,s35
s_mov_b32 s30,0
s_lshl_b32 s56,s77,5
s_add_u32 s56,s56,s68
s_mul_i32 s70,s56,24576
s_lshl_b32 s71,s56,12
s_lshl_b32 s59,s77,13
s_lshl2_add_u32 s59,s68,s59
s_add_u32 s59,s59,10485760
s_buffer_load_dword s32,s[8:11],s59
s_mov_b32 s33,1
s_add_u32 s70,s70,100663296
s_add_u32 s71,s71,41943040
v_mov_b32 v19,s59
s_branch L_af_342
L_ae_341:
s_ff1_i32_b64 s77,s[84:85]
s_bitset0_b64 s[84:85],s77
s_min_u32 s77,s77,64
s_lshr_b32 s61,s55,5
s_lshl_b32 s56,s77,5
s_add_u32 s56,s56,s68
s_mul_i32 s70,s56,24576
s_lshl_b32 s71,s56,12
s_lshl_b32 s59,s77,13
s_lshl2_add_u32 s59,s68,s59
s_add_u32 s59,s59,10486144
s_cmp_lt_u32 s77,s61
s_cselect_b32 s57,0,16777216
s_mov_b32 s60,s59
s_buffer_load_dword s33,s[8:11],s60
s_add_u32 s71,s71,s57
s_add_u32 s71,s71,58720256
s_cmp_eq_u32 s77,s61
s_cselect_b32 s57,50331648,0
s_cselect_b32 s58,1536,0
s_add_u32 s59,s59,s58
s_buffer_load_dword s32,s[8:11],s59
s_add_u32 s70,s70,s57
s_add_u32 s70,s70,150994944
v_mov_b32 v19,s59
v_writelane_b32 v19,s60,1
L_af_342:
s_cmp_ge_u32 s53,60
s_cbranch_scc1 L_a4_343
L_a4_344:
s_and_b32 s27,s27,s31
s_cbranch_scc1 L_ac_346
L_acb_347:
v_max3_f32 v238,v128,v129,v130
v_max3_f32 v239,v131,v132,v133
v_max3_f32 v238,v134,v135,v238
v_max3_f32 v239,v138,v139,v239
v_max_f32 v238,v238,v239
v_max_f32 v239,v238,v239
v_pk_mul_f32 v[128:129],v[128:129],v[152:153] op_sel_hi:[1,0]
v_pk_mul_f32 v[130:131],v[130:131],v[152:153] op_sel_hi:[1,0]
v_permlane16_swap_b32 v238,v239
v_max_f32 v238,v238,v239
v_max_f32 v239,v238,v239
v_pk_mul_f32 v[132:133],v[132:133],v[152:153] op_sel_hi:[1,0]
v_pk_mul_f32 v[134:135],v[134:135],v[152:153] op_sel_hi:[1,0]
v_permlane32_swap_b32 v238,v239
v_max_f32 v238,v238,v239
v_mul_f32 v238,v152,v238
v_pk_mul_f32 v[138:139],v[138:139],v[152:153] op_sel_hi:[1,0]
buffer_load_dword v17,v16,s[8:11],s87 offen sc1
v_pk_add_f32 v[128:129],v[128:129],v[238:239] op_sel_hi:[1,0] neg_lo:[0,1] neg_hi:[0,1]
v_pk_add_f32 v[130:131],v[130:131],v[238:239] op_sel_hi:[1,0] neg_lo:[0,1] neg_hi:[0,1]
v_pk_add_f32 v[132:133],v[132:133],v[238:239] op_sel_hi:[1,0] neg_lo:[0,1] neg_hi:[0,1]
v_pk_add_f32 v[134:135],v[134:135],v[238:239] op_sel_hi:[1,0] neg_lo:[0,1] neg_hi:[0,1]
v_pk_add_f32 v[138:139],v[138:139],v[238:239] op_sel_hi:[1,0] neg_lo:[0,1] neg_hi:[0,1]
v_exp_f32 v128,v128
v_exp_f32 v129,v129
v_exp_f32 v130,v130
v_exp_f32 v131,v131
v_exp_f32 v132,v132
v_exp_f32 v133,v133
v_exp_f32 v134,v134
v_exp_f32 v135,v135
v_exp_f32 v138,v138
v_exp_f32 v139,v139
v_pk_add_f32 v[148:149],v[128:129],v[130:131]
v_pk_add_f32 v[150:151],v[132:133],v[134:135]
v_pk_add_f32 v[148:149],v[148:149],v[138:139]
v_pk_add_f32 v[148:149],v[148:149],v[150:151]
v_add_f32 v150,v148,v149
v_add_f32 v151,v148,v149
s_nop 1
v_permlane16_swap_b32 v150,v151
v_add_f32 v148,v150,v151
v_add_f32 v149,v150,v151
s_nop 1
v_permlane32_swap_b32 v148,v149
v_add_f32 v148,v148,v149
v_rcp_f32 v148,v148
s_waitcnt vmcnt(0)
v_cmp_gt_u32 vcc,s66,v17
v_pk_mul_f32 v[138:139],v[138:139],v[148:149] op_sel_hi:[1,0]
v_pk_mul_f32 v[128:129],v[128:129],v[148:149] op_sel_hi:[1,0]
v_pk_mul_f32 v[130:131],v[130:131],v[148:149] op_sel_hi:[1,0]
v_pk_mul_f32 v[132:133],v[132:133],v[148:149] op_sel_hi:[1,0]
v_pk_mul_f32 v[134:135],v[134:135],v[148:149] op_sel_hi:[1,0]
s_cbranch_vccnz L_ap_349
L_apb_350:
s_xor_b32 s34,s69,524288
buffer_load_dwordx4 v[192:195],v7,s[8:11],s34 offen sc1
s_bfe_u32 s56,s66,0x10002
v_lshrrev_b32 v238,s56,v17
v_and_b32 v238,1,v238
v_cmp_ne_u32 vcc,0,v238
v_cvt_pk_bf16_f32 v144,v138,v139
v_cvt_pk_bf16_f32 v147,v138,v139
v_cvt_pk_bf16_f32 v140,v128,v129
v_cvt_pk_bf16_f32 v141,v130,v131
v_cvt_pk_bf16_f32 v142,v132,v133
v_cvt_pk_bf16_f32 v143,v134,v135
s_cbranch_vccnz L_ak_340
s_add_u32 s36,s36,4
v_mfma_f32_16x16x16_bf16 v[24:27],v[120:121],v[144:145],0
s_add_u32 s34,s34,4096
v_mfma_f32_16x16x16_bf16 v[28:31],v[120:121],v[146:147],0
buffer_load_dwordx4 v[196:199],v7,s[8:11],s34 offen sc1
v_mfma_f32_16x16x16_bf16 v[32:35],v[122:123],v[144:145],0
s_add_u32 s34,s34,4096
v_mfma_f32_16x16x16_bf16 v[36:39],v[122:123],v[146:147],0
buffer_load_dwordx4 v[200:203],v7,s[8:11],s34 offen sc1
v_mfma_f32_16x16x16_bf16 v[40:43],v[124:125],v[144:145],0
s_add_u32 s34,s34,4096
v_mfma_f32_16x16x16_bf16 v[44:47],v[124:125],v[146:147],0
buffer_load_dwordx4 v[204:207],v7,s[8:11],s34 offen sc1
v_mfma_f32_16x16x16_bf16 v[48:51],v[126:127],v[144:145],0
s_add_u32 s34,s34,4096
v_mfma_f32_16x16x16_bf16 v[52:55],v[126:127],v[146:147],0
buffer_load_dwordx4 v[208:211],v7,s[8:11],s34 offen sc1
v_mfma_f32_16x16x32_bf16 v[24:27],v[88:91],v[140:143],v[24:27]
s_add_u32 s34,s34,4096
v_mfma_f32_16x16x32_bf16 v[28:31],v[92:95],v[140:143],v[28:31]
buffer_load_dwordx4 v[212:215],v7,s[8:11],s34 offen sc1
v_mfma_f32_16x16x32_bf16 v[32:35],v[96:99],v[140:143],v[32:35]
s_add_u32 s34,s34,4096
v_mfma_f32_16x16x32_bf16 v[36:39],v[100:103],v[140:143],v[36:39]
buffer_load_dwordx4 v[216:219],v7,s[8:11],s34 offen sc1
v_cvt_pk_bf16_f32 v72,v24,v28
v_cvt_pk_bf16_f32 v73,v25,v29
v_mfma_f32_16x16x32_bf16 v[40:43],v[104:107],v[140:143],v[40:43]
s_add_u32 s34,s34,4096
v_cvt_pk_bf16_f32 v74,v26,v30
v_cvt_pk_bf16_f32 v75,v27,v31
v_mfma_f32_16x16x32_bf16 v[44:47],v[108:111],v[140:143],v[44:47]
ds_write_b128 v3,v[72:75] offset:0
v_cvt_pk_bf16_f32 v76,v32,v36
v_cvt_pk_bf16_f32 v77,v33,v37
v_mfma_f32_16x16x32_bf16 v[48:51],v[112:115],v[140:143],v[48:51]
buffer_load_dwordx4 v[220:223],v7,s[8:11],s34 offen sc1
v_cvt_pk_bf16_f32 v78,v34,v38
v_cvt_pk_bf16_f32 v79,v35,v39
v_mfma_f32_16x16x32_bf16 v[52:55],v[116:119],v[140:143],v[52:55]
ds_write_b128 v3,v[76:79] offset:1024
v_cvt_pk_bf16_f32 v80,v40,v44
v_cvt_pk_bf16_f32 v81,v41,v45
v_cvt_pk_bf16_f32 v82,v42,v46
v_cvt_pk_bf16_f32 v83,v43,v47
ds_write_b128 v3,v[80:83] offset:2048
s_nop 1
v_cvt_pk_bf16_f32 v84,v48,v52
v_cvt_pk_bf16_f32 v85,v49,v53
v_cvt_pk_bf16_f32 v86,v50,v54
v_cvt_pk_bf16_f32 v87,v51,v55
ds_write_b128 v3,v[84:87] offset:3072
s_cmp_eq_u32 s31,0
s_cbranch_scc1 L_ah_348
s_waitcnt lgkmcnt(0)
s_barrier
s_mov_b32 s26,s51
s_mov_b32 s51,s53
s_branch L_aa_332
L_ah_348:
s_cmp_ge_u32 s35,64
s_cbranch_scc1 L_a1_351
L_a2_352:
s_waitcnt vmcnt(7)
v_mfma_f32_16x16x32_bf16 v[160:163],v[156:159],v[192:195],0
s_waitcnt vmcnt(6)
v_mfma_f32_16x16x32_bf16 v[160:163],v[156:159],v[196:199],v[160:163]
s_waitcnt vmcnt(5)
v_mfma_f32_16x16x32_bf16 v[160:163],v[156:159],v[200:203],v[160:163]
s_waitcnt vmcnt(4)
v_mfma_f32_16x16x32_bf16 v[160:163],v[156:159],v[204:207],v[160:163]
s_waitcnt vmcnt(3)
v_mfma_f32_16x16x32_bf16 v[164:167],v[156:159],v[208:211],0
s_waitcnt vmcnt(2)
v_mfma_f32_16x16x32_bf16 v[164:167],v[156:159],v[212:215],v[164:167]
s_waitcnt vmcnt(1)
v_mfma_f32_16x16x32_bf16 v[164:167],v[156:159],v[216:219],v[164:167]
ds_write_b128 v6,v[160:163]
s_waitcnt vmcnt(0)
v_mfma_f32_16x16x32_bf16 v[164:167],v[156:159],v[220:223],v[164:167]
s_nop 7
ds_write_b128 v6,v[164:167] offset:2048
s_waitcnt lgkmcnt(0)
s_barrier
buffer_store_dword v20,off,s[8:11],s73 sc1
s_mov_b32 s73,0x80000000
s_mov_b32 s27,1
s_branch L_aa_323
L_ao_338:
s_xor_b32 s67,s67,65536
s_and_b32 s56,s50,2048
s_lshl_b32 s56,s56,4
s_add_u32 s56,s56,s67
v_add_u32 v2,s56,v0
s_and_b32 s56,s50,1024
s_lshl_b32 s56,s56,2
v_add_u32 v238,s56,v2
s_mov_b32 s76,s71
s_mov_b32 s53,s77
ds_read_b128 v[24:27],v238 offset:16384
ds_read_b128 v[40:43],v2 offset:0
ds_read_b128 v[56:59],v2 offset:4096
ds_read_b128 v[28:31],v238 offset:17408
ds_read_b128 v[44:47],v2 offset:1024
ds_read_b128 v[60:63],v2 offset:5120
ds_read_b128 v[32:35],v238 offset:18432
ds_read_b128 v[48:51],v2 offset:2048
ds_read_b128 v[64:67],v2 offset:6144
ds_read_b128 v[36:39],v238 offset:19456
ds_read_b128 v[52:55],v2 offset:3072
ds_read_b128 v[68:71],v2 offset:7168
buffer_load_dwordx4 v[72:75],v0,s[8:11],s76 offen offset:0 sc1
buffer_load_dwordx4 v[76:79],v0,s[8:11],s76 offen offset:1024 sc1
buffer_load_dwordx4 v[80:83],v0,s[8:11],s76 offen offset:2048 sc1
buffer_load_dwordx4 v[84:87],v0,s[8:11],s76 offen offset:3072 sc1
s_waitcnt lgkmcnt(9)
v_mfma_f32_16x16x32_bf16 v[128:131],v[40:43],v[24:27],v[8:11]
ds_read_b128 v[88:91],v2 offset:8192
v_mfma_f32_16x16x32_bf16 v[132:135],v[56:59],v[24:27],v[12:15]
ds_read_b128 v[92:95],v2 offset:9216
s_waitcnt lgkmcnt(8)
v_mfma_f32_16x16x32_bf16 v[128:131],v[44:47],v[28:31],v[128:131]
ds_read_b128 v[96:99],v2 offset:10240
v_mfma_f32_16x16x32_bf16 v[132:135],v[60:63],v[28:31],v[132:135]
ds_read_b128 v[100:103],v2 offset:11264
s_waitcnt lgkmcnt(7)
v_mfma_f32_16x16x32_bf16 v[128:131],v[48:51],v[32:35],v[128:131]
ds_read_b128 v[104:107],v2 offset:12288
v_mfma_f32_16x16x32_bf16 v[132:135],v[64:67],v[32:35],v[132:135]
ds_read_b128 v[108:111],v2 offset:13312
s_waitcnt lgkmcnt(6)
v_mfma_f32_16x16x32_bf16 v[128:131],v[52:55],v[36:39],v[128:131]
ds_read_b128 v[112:115],v2 offset:14336
v_mfma_f32_16x16x32_bf16 v[132:135],v[68:71],v[36:39],v[132:135]
ds_read_b128 v[116:119],v2 offset:15360
s_add_u32 s66,s66,4
s_bfe_u32 s56,s66,0x10002
s_bitset0_b32 s37,s56
s_lshl_b32 s56,0,s56
s_or_b32 s37,s37,s56
s_or_b32 s56,s37,s66
v_mov_b32 v22,s56
s_xor_b32 s69,s69,524288
s_waitcnt vmcnt(4) lgkmcnt(0)
buffer_store_dword v22,off,s[8:11],s74 sc1
s_mov_b32 s26,s51
s_mov_b32 s27,3
s_branch L_aa_327
L_aa_320:
s_add_u32 s66,s66,4
s_bfe_u32 s56,s66,0x10002
s_bitset0_b32 s37,s56
s_lshl_b32 s56,0,s56
s_or_b32 s37,s37,s56
s_or_b32 s56,s37,s66
v_mov_b32 v22,s56
s_xor_b32 s69,s69,524288
s_waitcnt vmcnt(0) lgkmcnt(0)
buffer_store_dword v22,off,s[8:11],s74 sc1
L_aq_353:
buffer_load_dword v17,v16,s[8:11],s87 offen sc1
s_sub_u32 s49,s49,1
s_cbranch_scc1 L_abort2
s_waitcnt vmcnt(0)
v_cmp_gt_u32 vcc,s66,v17
s_cbranch_vccnz L_aq_353
s_xor_b32 s34,s69,524288
buffer_load_dwordx4 v[160:163],v7,s[8:11],s34 offen sc1
s_add_u32 s34,s34,4096
buffer_load_dwordx4 v[164:167],v7,s[8:11],s34 offen sc1
s_add_u32 s34,s34,4096
buffer_load_dwordx4 v[168:171],v7,s[8:11],s34 offen sc1
s_add_u32 s34,s34,4096
buffer_load_dwordx4 v[172:175],v7,s[8:11],s34 offen sc1
s_add_u32 s34,s34,4096
buffer_load_dwordx4 v[176:179],v7,s[8:11],s34 offen sc1
s_add_u32 s34,s34,4096
buffer_load_dwordx4 v[180:183],v7,s[8:11],s34 offen sc1
s_add_u32 s34,s34,4096
buffer_load_dwordx4 v[184:187],v7,s[8:11],s34 offen sc1
s_add_u32 s34,s34,4096
buffer_load_dwordx4 v[188:191],v7,s[8:11],s34 offen sc1
buffer_load_dwordx4 v[72:75],v0,s[8:11],s76 offen offset:0 sc1
buffer_load_dwordx4 v[76:79],v0,s[8:11],s76 offen offset:1024 sc1
buffer_load_dwordx4 v[80:83],v0,s[8:11],s76 offen offset:2048 sc1
buffer_load_dwordx4 v[84:87],v0,s[8:11],s76 offen offset:3072 sc1
s_waitcnt vmcnt(11)
v_mfma_f32_16x16x32_bf16 v[192:195],v[156:159],v[160:163],0
s_waitcnt vmcnt(10)
v_mfma_f32_16x16x32_bf16 v[192:195],v[156:159],v[164:167],v[192:195]
s_waitcnt vmcnt(9)
v_mfma_f32_16x16x32_bf16 v[192:195],v[156:159],v[168:171],v[192:195]
s_waitcnt vmcnt(8)
v_mfma_f32_16x16x32_bf16 v[192:195],v[156:159],v[172:175],v[192:195]
s_waitcnt vmcnt(7)
v_mfma_f32_16x16x32_bf16 v[196:199],v[156:159],v[176:179],0
s_waitcnt vmcnt(6)
v_mfma_f32_16x16x32_bf16 v[196:199],v[156:159],v[180:183],v[196:199]
s_waitcnt vmcnt(5)
v_mfma_f32_16x16x32_bf16 v[196:199],v[156:159],v[184:187],v[196:199]
ds_write_b128 v6,v[192:195]
s_waitcnt vmcnt(4)
v_mfma_f32_16x16x32_bf16 v[196:199],v[156:159],v[188:191],v[196:199]
s_nop 7
ds_write_b128 v6,v[196:199] offset:2048
s_waitcnt lgkmcnt(0)
s_barrier
buffer_store_dword v20,off,s[8:11],s73 sc1
s_mov_b32 s73,0x80000000
s_mov_b32 s27,0
s_branch L_aa_323
L_aa_321:
s_add_u32 s56,s30,s86
s_cmp_lg_u32 s56,1537
s_cbranch_scc1 L_al_339
s_add_u32 s66,s66,4
s_bfe_u32 s56,s66,0x10002
s_bitset0_b32 s37,s56
s_lshl_b32 s56,1,s56
s_or_b32 s37,s37,s56
s_or_b32 s56,s37,s66
v_mov_b32 v22,s56
s_xor_b32 s69,s69,524288
s_waitcnt vmcnt(0) lgkmcnt(0)
buffer_store_dword v22,off,s[8:11],s74 sc1
s_cmp_lg_u32 s86,1536
s_cbranch_scc1 L_ae_354
s_mov_b32 s77,s35
s_mov_b32 s30,0
s_lshl_b32 s56,s77,5
s_add_u32 s56,s56,s68
s_mul_i32 s70,s56,24576
s_lshl_b32 s71,s56,12
s_lshl_b32 s59,s77,13
s_lshl2_add_u32 s59,s68,s59
s_add_u32 s59,s59,10485760
s_buffer_load_dword s32,s[8:11],s59
s_mov_b32 s33,1
s_add_u32 s70,s70,100663296
s_add_u32 s71,s71,41943040
v_mov_b32 v19,s59
s_branch L_af_355
L_ae_354:
s_ff1_i32_b64 s77,s[84:85]
s_bitset0_b64 s[84:85],s77
s_min_u32 s77,s77,64
s_lshr_b32 s61,s55,5
s_lshl_b32 s56,s77,5
s_add_u32 s56,s56,s68
s_mul_i32 s70,s56,24576
s_lshl_b32 s71,s56,12
s_lshl_b32 s59,s77,13
s_lshl2_add_u32 s59,s68,s59
s_add_u32 s59,s59,10486144
s_cmp_lt_u32 s77,s61
s_cselect_b32 s57,0,16777216
s_mov_b32 s60,s59
s_buffer_load_dword s33,s[8:11],s60
s_add_u32 s71,s71,s57
s_add_u32 s71,s71,58720256
s_cmp_eq_u32 s77,s61
s_cselect_b32 s57,50331648,0
s_cselect_b32 s58,1536,0
s_add_u32 s59,s59,s58
s_buffer_load_dword s32,s[8:11],s59
s_add_u32 s70,s70,s57
s_add_u32 s70,s70,150994944
v_mov_b32 v19,s59
v_writelane_b32 v19,s60,1
L_af_355:
s_branch L_ak_340
L_al_339:
s_add_u32 s66,s66,4
s_bfe_u32 s56,s66,0x10002
s_bitset0_b32 s37,s56
s_lshl_b32 s56,0,s56
s_or_b32 s37,s37,s56
s_or_b32 s56,s37,s66
v_mov_b32 v22,s56
s_xor_b32 s69,s69,524288
s_waitcnt vmcnt(0) lgkmcnt(0)
buffer_store_dword v22,off,s[8:11],s74 sc1
buffer_store_dword v20,off,s[8:11],s73 sc1
s_mov_b32 s73,0x80000000
L_ak_340:
L_aq_356:
buffer_load_dword v17,v16,s[8:11],s87 offen sc1
s_sub_u32 s49,s49,1
s_cbranch_scc1 L_abort2
s_waitcnt vmcnt(0)
v_cmp_gt_u32 vcc,s66,v17
s_cbranch_vccnz L_aq_356
s_xor_b32 s34,s69,524288
buffer_load_dwordx4 v[160:163],v7,s[8:11],s34 offen sc1
s_add_u32 s34,s34,4096
buffer_load_dwordx4 v[164:167],v7,s[8:11],s34 offen sc1
s_add_u32 s34,s34,4096
buffer_load_dwordx4 v[168:171],v7,s[8:11],s34 offen sc1
s_add_u32 s34,s34,4096
buffer_load_dwordx4 v[172:175],v7,s[8:11],s34 offen sc1
s_add_u32 s34,s34,4096
buffer_load_dwordx4 v[176:179],v7,s[8:11],s34 offen sc1
s_add_u32 s34,s34,4096
buffer_load_dwordx4 v[180:183],v7,s[8:11],s34 offen sc1
s_add_u32 s34,s34,4096
buffer_load_dwordx4 v[184:187],v7,s[8:11],s34 offen sc1
s_add_u32 s34,s34,4096
buffer_load_dwordx4 v[188:191],v7,s[8:11],s34 offen sc1
s_waitcnt vmcnt(7)
v_mfma_f32_16x16x32_bf16 v[192:195],v[156:159],v[160:163],0
s_waitcnt vmcnt(6)
v_mfma_f32_16x16x32_bf16 v[192:195],v[156:159],v[164:167],v[192:195]
s_waitcnt vmcnt(5)
v_mfma_f32_16x16x32_bf16 v[192:195],v[156:159],v[168:171],v[192:195]
s_waitcnt vmcnt(4)
v_mfma_f32_16x16x32_bf16 v[192:195],v[156:159],v[172:175],v[192:195]
s_waitcnt vmcnt(3)
v_mfma_f32_16x16x32_bf16 v[196:199],v[156:159],v[176:179],0
s_waitcnt vmcnt(2)
v_mfma_f32_16x16x32_bf16 v[196:199],v[156:159],v[180:183],v[196:199]
s_waitcnt vmcnt(1)
v_mfma_f32_16x16x32_bf16 v[196:199],v[156:159],v[184:187],v[196:199]
ds_write_b128 v6,v[192:195]
s_waitcnt vmcnt(0)
v_mfma_f32_16x16x32_bf16 v[196:199],v[156:159],v[188:191],v[196:199]
s_nop 7
ds_write_b128 v6,v[196:199] offset:2048
s_waitcnt lgkmcnt(0)
s_barrier
buffer_store_dword v20,off,s[8:11],s73 sc1
s_mov_b32 s73,0x80000000
s_mov_b32 s27,2
L_aa_323:
s_cmp_lg_u32 s31,0
s_cbranch_scc1 L_ar_359
s_bitcmp1_b32 s46,0
s_cbranch_scc1 L_ar_358
L_ar_357:
ds_read_b128 v[160:163],v23
ds_read_b128 v[164:167],v23 offset:16
v_lshlrev_b32 v200,16,v224
v_and_b32 v201,0xffff0000,v224
v_lshlrev_b32 v202,16,v225
v_and_b32 v203,0xffff0000,v225
v_lshlrev_b32 v204,16,v226
v_and_b32 v205,0xffff0000,v226
v_lshlrev_b32 v206,16,v227
v_and_b32 v207,0xffff0000,v227
s_lshl_b32 s18,s51,5
s_add_u32 s18,s18,s68
s_lshl_b32 s19,s18,10
s_add_u32 s20,s19,8388608
s_waitcnt lgkmcnt(0)
v_cvt_pk_bf16_f32 v168,v160,v161
v_cvt_pk_bf16_f32 v169,v162,v163
v_cvt_pk_bf16_f32 v170,v164,v165
v_cvt_pk_bf16_f32 v171,v166,v167
v_lshlrev_b32 v160,16,v168
v_and_b32 v161,0xffff0000,v168
v_lshlrev_b32 v162,16,v169
v_and_b32 v163,0xffff0000,v169
v_lshlrev_b32 v164,16,v170
v_and_b32 v165,0xffff0000,v170
v_lshlrev_b32 v166,16,v171
v_and_b32 v167,0xffff0000,v171
v_pk_add_f32 v[200:201],v[200:201],v[160:161]
v_pk_add_f32 v[202:203],v[202:203],v[162:163]
v_pk_add_f32 v[204:205],v[204:205],v[164:165]
v_pk_add_f32 v[206:207],v[206:207],v[166:167]
v_cvt_pk_bf16_f32 v168,v200,v201
v_cvt_pk_bf16_f32 v169,v202,v203
v_cvt_pk_bf16_f32 v170,v204,v205
v_cvt_pk_bf16_f32 v171,v206,v207
v_lshlrev_b32 v200,16,v168
v_and_b32 v201,0xffff0000,v168
v_lshlrev_b32 v202,16,v169
v_and_b32 v203,0xffff0000,v169
v_lshlrev_b32 v204,16,v170
v_and_b32 v205,0xffff0000,v170
v_lshlrev_b32 v206,16,v171
v_and_b32 v207,0xffff0000,v171
v_readfirstlane_b32 s78,v200
s_nop 1
v_pk_add_f32 v[184:185],v[200:201],s[78:79] op_sel_hi:[1,0] neg_lo:[0,1] neg_hi:[0,1]
v_pk_add_f32 v[186:187],v[202:203],s[78:79] op_sel_hi:[1,0] neg_lo:[0,1] neg_hi:[0,1]
v_pk_add_f32 v[188:189],v[204:205],s[78:79] op_sel_hi:[1,0] neg_lo:[0,1] neg_hi:[0,1]
v_pk_add_f32 v[190:191],v[206:207],s[78:79] op_sel_hi:[1,0] neg_lo:[0,1] neg_hi:[0,1]
v_pk_add_f32 v[192:193],v[184:185],v[186:187]
v_pk_mul_f32 v[194:195],v[184:185],v[184:185]
v_pk_add_f32 v[196:197],v[188:189],v[190:191]
v_pk_fma_f32 v[194:195],v[186:187],v[186:187],v[194:195]
v_pk_add_f32 v[192:193],v[192:193],v[196:197]
v_pk_fma_f32 v[194:195],v[188:189],v[188:189],v[194:195]
v_add_f32 v192,v192,v193
v_pk_fma_f32 v[194:195],v[190:191],v[190:191],v[194:195]
v_add_f32 v194,v194,v195
s_nop 1
v_permlane32_swap_b32 v192,v194
v_add_f32 v192,v192,v194
s_nop 1
v_add_f32_dpp v192,v192,v192 row_ror:8 row_mask:0xf bank_mask:0xf
s_nop 1
v_add_f32_dpp v192,v192,v192 row_ror:4 row_mask:0xf bank_mask:0xf
s_nop 1
v_add_f32_dpp v192,v192,v192 row_ror:2 row_mask:0xf bank_mask:0xf
s_nop 1
v_add_f32_dpp v192,v192,v192 row_ror:1 row_mask:0xf bank_mask:0xf
v_mov_b32 v194,v192
s_nop 1
v_permlane16_swap_b32 v192,v194
v_add_f32 v192,v192,v194
v_mul_f32 v192,0x3b000000,v192
v_mov_b32 v194,v192
s_nop 1
v_permlane32_swap_b32 v192,v194
v_fma_f32 v194,-v192,v192,v194
v_add_f32 v192,s78,v192
v_max_f32 v194,0,v194
v_cvt_pk_bf16_f32 v194,v192,v194
v_lshlrev_b32 v192,16,v194
v_and_b32 v194,0xffff0000,v194
v_add_f32 v194,0x3727c5ac,v194
v_cvt_pk_bf16_f32 v194,v194,v194
v_and_b32 v194,0xffff0000,v194
v_sqrt_f32 v194,v194
v_pk_add_f32 v[184:185],v[200:201],v[192:193] op_sel_hi:[1,0] neg_lo:[0,1] neg_hi:[0,1]
v_pk_add_f32 v[186:187],v[202:203],v[192:193] op_sel_hi:[1,0] neg_lo:[0,1] neg_hi:[0,1]
v_pk_add_f32 v[188:189],v[204:205],v[192:193] op_sel_hi:[1,0] neg_lo:[0,1] neg_hi:[0,1]
v_pk_add_f32 v[190:191],v[206:207],v[192:193] op_sel_hi:[1,0] neg_lo:[0,1] neg_hi:[0,1]
v_cvt_pk_bf16_f32 v194,v194,v194
v_and_b32 v194,0xffff0000,v194
v_rcp_f32 v194,v194
v_cvt_pk_bf16_f32 v172,v184,v185
v_cvt_pk_bf16_f32 v173,v186,v187
v_cvt_pk_bf16_f32 v174,v188,v189
v_cvt_pk_bf16_f32 v175,v190,v191
v_lshlrev_b32 v184,16,v172
v_and_b32 v185,0xffff0000,v172
v_lshlrev_b32 v186,16,v173
v_and_b32 v187,0xffff0000,v173
v_lshlrev_b32 v188,16,v174
v_and_b32 v189,0xffff0000,v174
v_lshlrev_b32 v190,16,v175
v_and_b32 v191,0xffff0000,v175
v_pk_mul_f32 v[184:185],v[184:185],v[194:195] op_sel_hi:[1,0]
v_pk_mul_f32 v[186:187],v[186:187],v[194:195] op_sel_hi:[1,0]
v_pk_mul_f32 v[188:189],v[188:189],v[194:195] op_sel_hi:[1,0]
v_pk_mul_f32 v[190:191],v[190:191],v[194:195] op_sel_hi:[1,0]
v_cvt_pk_bf16_f32 v172,v184,v185
v_cvt_pk_bf16_f32 v173,v186,v187
v_cvt_pk_bf16_f32 v174,v188,v189
v_cvt_pk_bf16_f32 v175,v190,v191
v_lshlrev_b32 v176,16,v172
v_and_b32 v177,0xffff0000,v172
v_lshlrev_b32 v178,16,v173
v_and_b32 v179,0xffff0000,v173
v_lshlrev_b32 v180,16,v174
v_and_b32 v181,0xffff0000,v174
v_lshlrev_b32 v182,16,v175
v_and_b32 v183,0xffff0000,v175
v_pk_add_f32 v[200:201],v[200:201],v[176:177]
v_pk_add_f32 v[202:203],v[202:203],v[178:179]
v_pk_add_f32 v[204:205],v[204:205],v[180:181]
v_pk_add_f32 v[206:207],v[206:207],v[182:183]
v_cvt_pk_bf16_f32 v160,v200,v201
v_cvt_pk_bf16_f32 v161,v202,v203
v_cvt_pk_bf16_f32 v162,v204,v205
v_cvt_pk_bf16_f32 v163,v206,v207
buffer_store_dwordx4 v[160:163],v0,s[8:11],s20 offen sc1
v_lshlrev_b32 v200,16,v160
v_and_b32 v201,0xffff0000,v160
v_lshlrev_b32 v202,16,v161
v_and_b32 v203,0xffff0000,v161
v_lshlrev_b32 v204,16,v162
v_and_b32 v205,0xffff0000,v162
v_lshlrev_b32 v206,16,v163
v_and_b32 v207,0xffff0000,v163
v_readfirstlane_b32 s78,v200
s_nop 1
v_pk_add_f32 v[184:185],v[200:201],s[78:79] op_sel_hi:[1,0] neg_lo:[0,1] neg_hi:[0,1]
v_pk_add_f32 v[186:187],v[202:203],s[78:79] op_sel_hi:[1,0] neg_lo:[0,1] neg_hi:[0,1]
v_pk_add_f32 v[188:189],v[204:205],s[78:79] op_sel_hi:[1,0] neg_lo:[0,1] neg_hi:[0,1]
v_pk_add_f32 v[190:191],v[206:207],s[78:79] op_sel_hi:[1,0] neg_lo:[0,1] neg_hi:[0,1]
v_pk_add_f32 v[192:193],v[184:185],v[186:187]
v_pk_mul_f32 v[194:195],v[184:185],v[184:185]
v_pk_add_f32 v[196:197],v[188:189],v[190:191]
v_pk_fma_f32 v[194:195],v[186:187],v[186:187],v[194:195]
v_pk_add_f32 v[192:193],v[192:193],v[196:197]
v_pk_fma_f32 v[194:195],v[188:189],v[188:189],v[194:195]
v_add_f32 v192,v192,v193
v_pk_fma_f32 v[194:195],v[190:191],v[190:191],v[194:195]
v_add_f32 v194,v194,v195
s_nop 1
v_permlane32_swap_b32 v192,v194
v_add_f32 v192,v192,v194
s_nop 1
v_add_f32_dpp v192,v192,v192 row_ror:8 row_mask:0xf bank_mask:0xf
s_nop 1
v_add_f32_dpp v192,v192,v192 row_ror:4 row_mask:0xf bank_mask:0xf
s_nop 1
v_add_f32_dpp v192,v192,v192 row_ror:2 row_mask:0xf bank_mask:0xf
s_nop 1
v_add_f32_dpp v192,v192,v192 row_ror:1 row_mask:0xf bank_mask:0xf
v_mov_b32 v194,v192
s_nop 1
v_permlane16_swap_b32 v192,v194
v_add_f32 v192,v192,v194
v_mul_f32 v192,0x3b000000,v192
v_mov_b32 v194,v192
s_nop 1
v_permlane32_swap_b32 v192,v194
v_fma_f32 v194,-v192,v192,v194
v_add_f32 v192,s78,v192
v_max_f32 v194,0,v194
v_cvt_pk_bf16_f32 v194,v192,v194
v_lshlrev_b32 v192,16,v194
v_and_b32 v194,0xffff0000,v194
v_add_f32 v194,0x3727c5ac,v194
v_cvt_pk_bf16_f32 v194,v194,v194
v_and_b32 v194,0xffff0000,v194
v_sqrt_f32 v194,v194
v_pk_add_f32 v[184:185],v[200:201],v[192:193] op_sel_hi:[1,0] neg_lo:[0,1] neg_hi:[0,1]
v_pk_add_f32 v[186:187],v[202:203],v[192:193] op_sel_hi:[1,0] neg_lo:[0,1] neg_hi:[0,1]
v_pk_add_f32 v[188:189],v[204:205],v[192:193] op_sel_hi:[1,0] neg_lo:[0,1] neg_hi:[0,1]
v_pk_add_f32 v[190:191],v[206:207],v[192:193] op_sel_hi:[1,0] neg_lo:[0,1] neg_hi:[0,1]
v_cvt_pk_bf16_f32 v194,v194,v194
v_and_b32 v194,0xffff0000,v194
v_rcp_f32 v194,v194
v_cvt_pk_bf16_f32 v164,v184,v185
v_cvt_pk_bf16_f32 v165,v186,v187
v_cvt_pk_bf16_f32 v166,v188,v189
v_cvt_pk_bf16_f32 v167,v190,v191
v_lshlrev_b32 v184,16,v164
v_and_b32 v185,0xffff0000,v164
v_lshlrev_b32 v186,16,v165
v_and_b32 v187,0xffff0000,v165
v_lshlrev_b32 v188,16,v166
v_and_b32 v189,0xffff0000,v166
v_lshlrev_b32 v190,16,v167
v_and_b32 v191,0xffff0000,v167
v_pk_mul_f32 v[184:185],v[184:185],v[194:195] op_sel_hi:[1,0]
v_pk_mul_f32 v[186:187],v[186:187],v[194:195] op_sel_hi:[1,0]
v_pk_mul_f32 v[188:189],v[188:189],v[194:195] op_sel_hi:[1,0]
v_pk_mul_f32 v[190:191],v[190:191],v[194:195] op_sel_hi:[1,0]
v_cvt_pk_bf16_f32 v164,v184,v185
v_cvt_pk_bf16_f32 v165,v186,v187
v_cvt_pk_bf16_f32 v166,v188,v189
v_cvt_pk_bf16_f32 v167,v190,v191
s_add_u32 s20,s19,2097152
buffer_store_dwordx4 v[164:167],v0,s[8:11],s20 offen sc1
v_mov_b32 v20,1
s_lshl_b32 s73,s51,13
s_lshl2_add_u32 s73,s68,s73
s_add_u32 s73,s73,10487552
s_branch L_aa_324
L_ar_358:
ds_read_b128 v[160:163],v23
ds_read_b128 v[164:167],v23 offset:16
v_lshlrev_b32 v200,16,v224
v_and_b32 v201,0xffff0000,v224
v_lshlrev_b32 v202,16,v225
v_and_b32 v203,0xffff0000,v225
v_lshlrev_b32 v204,16,v226
v_and_b32 v205,0xffff0000,v226
v_lshlrev_b32 v206,16,v227
v_and_b32 v207,0xffff0000,v227
s_lshl_b32 s18,s51,5
s_add_u32 s18,s18,s68
s_lshl_b32 s19,s18,10
s_add_u32 s20,s19,4194304
s_waitcnt lgkmcnt(0)
v_cvt_pk_bf16_f32 v168,v160,v161
v_cvt_pk_bf16_f32 v169,v162,v163
v_cvt_pk_bf16_f32 v170,v164,v165
v_cvt_pk_bf16_f32 v171,v166,v167
v_lshlrev_b32 v160,16,v168
v_and_b32 v161,0xffff0000,v168
v_lshlrev_b32 v162,16,v169
v_and_b32 v163,0xffff0000,v169
v_lshlrev_b32 v164,16,v170
v_and_b32 v165,0xffff0000,v170
v_lshlrev_b32 v166,16,v171
v_and_b32 v167,0xffff0000,v171
v_pk_add_f32 v[200:201],v[200:201],v[160:161]
v_pk_add_f32 v[202:203],v[202:203],v[162:163]
v_pk_add_f32 v[204:205],v[204:205],v[164:165]
v_pk_add_f32 v[206:207],v[206:207],v[166:167]
v_cvt_pk_bf16_f32 v168,v200,v201
v_cvt_pk_bf16_f32 v169,v202,v203
v_cvt_pk_bf16_f32 v170,v204,v205
v_cvt_pk_bf16_f32 v171,v206,v207
buffer_store_dwordx4 v[168:171],v0,s[8:11],s20 offen sc1
v_lshlrev_b32 v200,16,v168
v_and_b32 v201,0xffff0000,v168
v_lshlrev_b32 v202,16,v169
v_and_b32 v203,0xffff0000,v169
v_lshlrev_b32 v204,16,v170
v_and_b32 v205,0xffff0000,v170
v_lshlrev_b32 v206,16,v171
v_and_b32 v207,0xffff0000,v171
v_readfirstlane_b32 s78,v200
s_nop 1
v_pk_add_f32 v[184:185],v[200:201],s[78:79] op_sel_hi:[1,0] neg_lo:[0,1] neg_hi:[0,1]
v_pk_add_f32 v[186:187],v[202:203],s[78:79] op_sel_hi:[1,0] neg_lo:[0,1] neg_hi:[0,1]
v_pk_add_f32 v[188:189],v[204:205],s[78:79] op_sel_hi:[1,0] neg_lo:[0,1] neg_hi:[0,1]
v_pk_add_f32 v[190:191],v[206:207],s[78:79] op_sel_hi:[1,0] neg_lo:[0,1] neg_hi:[0,1]
v_pk_add_f32 v[192:193],v[184:185],v[186:187]
v_pk_mul_f32 v[194:195],v[184:185],v[184:185]
v_pk_add_f32 v[196:197],v[188:189],v[190:191]
v_pk_fma_f32 v[194:195],v[186:187],v[186:187],v[194:195]
v_pk_add_f32 v[192:193],v[192:193],v[196:197]
v_pk_fma_f32 v[194:195],v[188:189],v[188:189],v[194:195]
v_add_f32 v192,v192,v193
v_pk_fma_f32 v[194:195],v[190:191],v[190:191],v[194:195]
v_add_f32 v194,v194,v195
s_nop 1
v_permlane32_swap_b32 v192,v194
v_add_f32 v192,v192,v194
s_nop 1
v_add_f32_dpp v192,v192,v192 row_ror:8 row_mask:0xf bank_mask:0xf
s_nop 1
v_add_f32_dpp v192,v192,v192 row_ror:4 row_mask:0xf bank_mask:0xf
s_nop 1
v_add_f32_dpp v192,v192,v192 row_ror:2 row_mask:0xf bank_mask:0xf
s_nop 1
v_add_f32_dpp v192,v192,v192 row_ror:1 row_mask:0xf bank_mask:0xf
v_mov_b32 v194,v192
s_nop 1
v_permlane16_swap_b32 v192,v194
v_add_f32 v192,v192,v194
v_mul_f32 v192,0x3b000000,v192
v_mov_b32 v194,v192
s_nop 1
v_permlane32_swap_b32 v192,v194
v_fma_f32 v194,-v192,v192,v194
v_add_f32 v192,s78,v192
v_max_f32 v194,0,v194
v_cvt_pk_bf16_f32 v194,v192,v194
v_lshlrev_b32 v192,16,v194
v_and_b32 v194,0xffff0000,v194
v_add_f32 v194,0x3727c5ac,v194
v_cvt_pk_bf16_f32 v194,v194,v194
v_and_b32 v194,0xffff0000,v194
v_sqrt_f32 v194,v194
v_pk_add_f32 v[184:185],v[200:201],v[192:193] op_sel_hi:[1,0] neg_lo:[0,1] neg_hi:[0,1]
v_pk_add_f32 v[186:187],v[202:203],v[192:193] op_sel_hi:[1,0] neg_lo:[0,1] neg_hi:[0,1]
v_pk_add_f32 v[188:189],v[204:205],v[192:193] op_sel_hi:[1,0] neg_lo:[0,1] neg_hi:[0,1]
v_pk_add_f32 v[190:191],v[206:207],v[192:193] op_sel_hi:[1,0] neg_lo:[0,1] neg_hi:[0,1]
v_cvt_pk_bf16_f32 v194,v194,v194
v_and_b32 v194,0xffff0000,v194
v_rcp_f32 v194,v194
v_cvt_pk_bf16_f32 v172,v184,v185
v_cvt_pk_bf16_f32 v173,v186,v187
v_cvt_pk_bf16_f32 v174,v188,v189
v_cvt_pk_bf16_f32 v175,v190,v191
v_lshlrev_b32 v184,16,v172
v_and_b32 v185,0xffff0000,v172
v_lshlrev_b32 v186,16,v173
v_and_b32 v187,0xffff0000,v173
v_lshlrev_b32 v188,16,v174
v_and_b32 v189,0xffff0000,v174
v_lshlrev_b32 v190,16,v175
v_and_b32 v191,0xffff0000,v175
v_pk_mul_f32 v[184:185],v[184:185],v[194:195] op_sel_hi:[1,0]
v_pk_mul_f32 v[186:187],v[186:187],v[194:195] op_sel_hi:[1,0]
v_pk_mul_f32 v[188:189],v[188:189],v[194:195] op_sel_hi:[1,0]
v_pk_mul_f32 v[190:191],v[190:191],v[194:195] op_sel_hi:[1,0]
v_cvt_pk_bf16_f32 v172,v184,v185
v_cvt_pk_bf16_f32 v173,v186,v187
v_cvt_pk_bf16_f32 v174,v188,v189
v_cvt_pk_bf16_f32 v175,v190,v191
v_lshlrev_b32 v176,16,v172
v_and_b32 v177,0xffff0000,v172
v_lshlrev_b32 v178,16,v173
v_and_b32 v179,0xffff0000,v173
v_lshlrev_b32 v180,16,v174
v_and_b32 v181,0xffff0000,v174
v_lshlrev_b32 v182,16,v175
v_and_b32 v183,0xffff0000,v175
v_pk_mul_f32 v[236:237],v[176:177],v[228:229]
v_pk_fma_f32 v[236:237],v[178:179],v[230:231],v[236:237]
v_pk_fma_f32 v[236:237],v[180:181],v[232:233],v[236:237]
v_pk_fma_f32 v[236:237],v[182:183],v[234:235],v[236:237]
v_add_f32 v236,v236,v237
s_nop 1
v_add_f32_dpp v236,v236,v236 row_ror:8 row_mask:0xf bank_mask:0xf
s_nop 1
v_add_f32_dpp v236,v236,v236 row_ror:4 row_mask:0xf bank_mask:0xf
s_nop 1
v_add_f32_dpp v236,v236,v236 row_ror:2 row_mask:0xf bank_mask:0xf
s_nop 1
v_add_f32_dpp v236,v236,v236 row_ror:1 row_mask:0xf bank_mask:0xf
v_mov_b32 v237,v236
s_nop 1
v_permlane16_swap_b32 v236,v237
v_add_f32 v236,v236,v237
v_mov_b32 v237,v236
s_nop 1
v_permlane32_swap_b32 v236,v237
v_add_f32 v236,v236,v237
v_cvt_pk_bf16_f32 v236,v236,v236
v_and_b32 v236,0xffff0000,v236
v_ashrrev_i32 v237,31,v236
v_or_b32 v237,0x80000000,v237
v_xor_b32 v236,v236,v237
v_and_b32 v236,0xffff0000,v236
s_sub_u32 s20,4095,s18
v_or_b32 v20,s20,v236
s_lshl_b32 s20,s51,13
s_lshl2_add_u32 s20,s68,s20
s_add_u32 s20,s20,10485760
buffer_store_dword v20,v254,s[8:11],s20 offen sc1
s_branch L_aa_324
L_ar_359:
s_bitcmp1_b32 s46,0
s_cbranch_scc1 L_aa_324
ds_read_b128 v[160:163],v23
ds_read_b128 v[164:167],v23 offset:16
v_lshlrev_b32 v200,16,v224
v_and_b32 v201,0xffff0000,v224
v_lshlrev_b32 v202,16,v225
v_and_b32 v203,0xffff0000,v225
v_lshlrev_b32 v204,16,v226
v_and_b32 v205,0xffff0000,v226
v_lshlrev_b32 v206,16,v227
v_and_b32 v207,0xffff0000,v227
v_readfirstlane_b32 s22,v246
s_cmp_eq_u32 s22,0
s_cbranch_scc1 L_ag_360
L_agb_361:
s_lshl_b32 s18,s51,5
s_add_u32 s18,s18,s68
s_lshl_b32 s19,s18,10
s_add_u32 s20,s19,6291456
s_waitcnt lgkmcnt(0)
v_cvt_pk_bf16_f32 v168,v160,v161
v_cvt_pk_bf16_f32 v169,v162,v163
v_cvt_pk_bf16_f32 v170,v164,v165
v_cvt_pk_bf16_f32 v171,v166,v167
v_lshlrev_b32 v160,16,v168
v_and_b32 v161,0xffff0000,v168
v_lshlrev_b32 v162,16,v169
v_and_b32 v163,0xffff0000,v169
v_lshlrev_b32 v164,16,v170
v_and_b32 v165,0xffff0000,v170
v_lshlrev_b32 v166,16,v171
v_and_b32 v167,0xffff0000,v171
v_pk_add_f32 v[200:201],v[200:201],v[160:161]
v_pk_add_f32 v[202:203],v[202:203],v[162:163]
v_pk_add_f32 v[204:205],v[204:205],v[164:165]
v_pk_add_f32 v[206:207],v[206:207],v[166:167]
v_cvt_pk_bf16_f32 v168,v200,v201
v_cvt_pk_bf16_f32 v169,v202,v203
v_cvt_pk_bf16_f32 v170,v204,v205
v_cvt_pk_bf16_f32 v171,v206,v207
buffer_store_dwordx4 v[168:171],v0,s[8:11],s20 offen sc1
v_lshlrev_b32 v200,16,v168
v_and_b32 v201,0xffff0000,v168
v_lshlrev_b32 v202,16,v169
v_and_b32 v203,0xffff0000,v169
v_lshlrev_b32 v204,16,v170
v_and_b32 v205,0xffff0000,v170
v_lshlrev_b32 v206,16,v171
v_and_b32 v207,0xffff0000,v171
v_readfirstlane_b32 s78,v200
s_nop 1
v_pk_add_f32 v[184:185],v[200:201],s[78:79] op_sel_hi:[1,0] neg_lo:[0,1] neg_hi:[0,1]
v_pk_add_f32 v[186:187],v[202:203],s[78:79] op_sel_hi:[1,0] neg_lo:[0,1] neg_hi:[0,1]
v_pk_add_f32 v[188:189],v[204:205],s[78:79] op_sel_hi:[1,0] neg_lo:[0,1] neg_hi:[0,1]
v_pk_add_f32 v[190:191],v[206:207],s[78:79] op_sel_hi:[1,0] neg_lo:[0,1] neg_hi:[0,1]
v_pk_add_f32 v[192:193],v[184:185],v[186:187]
v_pk_mul_f32 v[194:195],v[184:185],v[184:185]
v_pk_add_f32 v[196:197],v[188:189],v[190:191]
v_pk_fma_f32 v[194:195],v[186:187],v[186:187],v[194:195]
v_pk_add_f32 v[192:193],v[192:193],v[196:197]
v_pk_fma_f32 v[194:195],v[188:189],v[188:189],v[194:195]
v_add_f32 v192,v192,v193
v_pk_fma_f32 v[194:195],v[190:191],v[190:191],v[194:195]
v_add_f32 v194,v194,v195
s_nop 1
v_permlane32_swap_b32 v192,v194
v_add_f32 v192,v192,v194
s_nop 1
v_add_f32_dpp v192,v192,v192 row_ror:8 row_mask:0xf bank_mask:0xf
s_nop 1
v_add_f32_dpp v192,v192,v192 row_ror:4 row_mask:0xf bank_mask:0xf
s_nop 1
v_add_f32_dpp v192,v192,v192 row_ror:2 row_mask:0xf bank_mask:0xf
s_nop 1
v_add_f32_dpp v192,v192,v192 row_ror:1 row_mask:0xf bank_mask:0xf
v_mov_b32 v194,v192
s_nop 1
v_permlane16_swap_b32 v192,v194
v_add_f32 v192,v192,v194
v_mul_f32 v192,0x3b000000,v192
v_mov_b32 v194,v192
s_nop 1
v_permlane32_swap_b32 v192,v194
v_fma_f32 v194,-v192,v192,v194
v_add_f32 v192,s78,v192
v_max_f32 v194,0,v194
v_cvt_pk_bf16_f32 v194,v192,v194
v_lshlrev_b32 v192,16,v194
v_and_b32 v194,0xffff0000,v194
v_add_f32 v194,0x3727c5ac,v194
v_cvt_pk_bf16_f32 v194,v194,v194
v_and_b32 v194,0xffff0000,v194
v_sqrt_f32 v194,v194
v_pk_add_f32 v[184:185],v[200:201],v[192:193] op_sel_hi:[1,0] neg_lo:[0,1] neg_hi:[0,1]
v_pk_add_f32 v[186:187],v[202:203],v[192:193] op_sel_hi:[1,0] neg_lo:[0,1] neg_hi:[0,1]
v_pk_add_f32 v[188:189],v[204:205],v[192:193] op_sel_hi:[1,0] neg_lo:[0,1] neg_hi:[0,1]
v_pk_add_f32 v[190:191],v[206:207],v[192:193] op_sel_hi:[1,0] neg_lo:[0,1] neg_hi:[0,1]
v_cvt_pk_bf16_f32 v194,v194,v194
v_and_b32 v194,0xffff0000,v194
v_rcp_f32 v194,v194
v_cvt_pk_bf16_f32 v172,v184,v185
v_cvt_pk_bf16_f32 v173,v186,v187
v_cvt_pk_bf16_f32 v174,v188,v189
v_cvt_pk_bf16_f32 v175,v190,v191
v_lshlrev_b32 v184,16,v172
v_and_b32 v185,0xffff0000,v172
v_lshlrev_b32 v186,16,v173
v_and_b32 v187,0xffff0000,v173
v_lshlrev_b32 v188,16,v174
v_and_b32 v189,0xffff0000,v174
v_lshlrev_b32 v190,16,v175
v_and_b32 v191,0xffff0000,v175
v_pk_mul_f32 v[184:185],v[184:185],v[194:195] op_sel_hi:[1,0]
v_pk_mul_f32 v[186:187],v[186:187],v[194:195] op_sel_hi:[1,0]
v_pk_mul_f32 v[188:189],v[188:189],v[194:195] op_sel_hi:[1,0]
v_pk_mul_f32 v[190:191],v[190:191],v[194:195] op_sel_hi:[1,0]
v_cvt_pk_bf16_f32 v172,v184,v185
v_cvt_pk_bf16_f32 v173,v186,v187
v_cvt_pk_bf16_f32 v174,v188,v189
v_cvt_pk_bf16_f32 v175,v190,v191
v_lshlrev_b32 v176,16,v172
v_and_b32 v177,0xffff0000,v172
v_lshlrev_b32 v178,16,v173
v_and_b32 v179,0xffff0000,v173
v_lshlrev_b32 v180,16,v174
v_and_b32 v181,0xffff0000,v174
v_lshlrev_b32 v182,16,v175
v_and_b32 v183,0xffff0000,v175
v_pk_add_f32 v[200:201],v[200:201],v[176:177]
v_pk_add_f32 v[202:203],v[202:203],v[178:179]
v_pk_add_f32 v[204:205],v[204:205],v[180:181]
v_pk_add_f32 v[206:207],v[206:207],v[182:183]
v_cvt_pk_bf16_f32 v160,v200,v201
v_cvt_pk_bf16_f32 v161,v202,v203
v_cvt_pk_bf16_f32 v162,v204,v205
v_cvt_pk_bf16_f32 v163,v206,v207
buffer_store_dwordx4 v[160:163],v0,s[12:15],s19 offen sc1
v_pk_mul_f32 v[236:237],v[176:177],v[228:229]
v_pk_fma_f32 v[236:237],v[178:179],v[230:231],v[236:237]
v_pk_fma_f32 v[236:237],v[180:181],v[232:233],v[236:237]
v_pk_fma_f32 v[236:237],v[182:183],v[234:235],v[236:237]
v_add_f32 v236,v236,v237
s_nop 1
v_add_f32_dpp v236,v236,v236 row_ror:8 row_mask:0xf bank_mask:0xf
s_nop 1
v_add_f32_dpp v236,v236,v236 row_ror:4 row_mask:0xf bank_mask:0xf
s_nop 1
v_add_f32_dpp v236,v236,v236 row_ror:2 row_mask:0xf bank_mask:0xf
s_nop 1
v_add_f32_dpp v236,v236,v236 row_ror:1 row_mask:0xf bank_mask:0xf
v_mov_b32 v237,v236
s_nop 1
v_permlane16_swap_b32 v236,v237
v_add_f32 v236,v236,v237
v_mov_b32 v237,v236
s_nop 1
v_permlane32_swap_b32 v236,v237
v_add_f32 v236,v236,v237
v_cvt_pk_bf16_f32 v236,v236,v236
v_and_b32 v236,0xffff0000,v236
v_ashrrev_i32 v237,31,v236
v_or_b32 v237,0x80000000,v237
v_xor_b32 v236,v236,v237
v_and_b32 v236,0xffff0000,v236
s_sub_u32 s20,4095,s18
v_or_b32 v20,s20,v236
s_lshl_b32 s73,s51,13
s_lshl2_add_u32 s73,s68,s73
s_add_u32 s73,s73,10485760
s_add_u32 s73,s73,s86
L_aa_324:
s_cmp_eq_u32 s27,1
s_cbranch_scc1 L_ad_362
s_cmp_eq_u32 s27,0
s_cbranch_scc1 L_aa_325
s_cmp_eq_u32 s27,4
s_cbranch_scc1 L_a4_345
s_cmp_ge_u32 s77,64
s_cbranch_scc1 L_aa_328
L_aa_326:
s_waitcnt vmcnt(0)
buffer_store_dword v20,off,s[8:11],s73 sc1
s_mov_b32 s73,0x80000000
v_mov_b32 v18,0
s_mov_b32 s27,0
L_aw_363:
v_cmp_eq_u32 vcc,0,v18
s_cbranch_vccz L_awd_364
buffer_load_dword v18,v19,s[8:11],0 offen sc1
s_sub_u32 s49,s49,1
s_cbranch_scc1 L_abort2
s_waitcnt vmcnt(0)
s_branch L_aw_363
L_awd_364:
L_a3_365:
s_mov_b32 s64,s70
s_mov_b32 s65,s71
s_add_u32 s64,s64,s28
s_add_u32 s65,s65,s29
s_xor_b32 s58,s67,s40
s_xor_b32 s57,s67,s41
s_add_u32 m0,s58,0
s_nop 0
buffer_load_dwordx4 v0,s[8:11],s64 offen offset:0 sc1 lds
buffer_load_dwordx4 v0,s[8:11],s64 offen offset:1024 sc1 lds
buffer_load_dwordx4 v0,s[8:11],s64 offen offset:2048 sc1 lds
buffer_load_dwordx4 v0,s[8:11],s64 offen offset:3072 sc1 lds
s_add_u32 m0,s58,4096
s_add_u32 s64,s64,4096
buffer_load_dwordx4 v0,s[8:11],s64 offen offset:0 sc1 lds
buffer_load_dwordx4 v0,s[8:11],s64 offen offset:1024 sc1 lds
buffer_load_dwordx4 v0,s[8:11],s64 offen offset:2048 sc1 lds
buffer_load_dwordx4 v0,s[8:11],s64 offen offset:3072 sc1 lds
s_add_u32 m0,s58,8192
s_add_u32 s64,s64,4096
buffer_load_dwordx4 v0,s[8:11],s64 offen offset:0 sc1 lds
buffer_load_dwordx4 v0,s[8:11],s64 offen offset:1024 sc1 lds
buffer_load_dwordx4 v0,s[8:11],s64 offen offset:2048 sc1 lds
buffer_load_dwordx4 v0,s[8:11],s64 offen offset:3072 sc1 lds
s_add_u32 m0,s57,24576
s_nop 0
buffer_load_dwordx4 v0,s[8:11],s65 offen offset:0 sc1 lds
buffer_load_dwordx4 v0,s[8:11],s65 offen offset:1024 sc1 lds
v_lshrrev_b32 v244,4,v1
s_sub_u32 s56,s77,7
v_add_u32 v244,s56,v244
v_max_i32 v244,0,v244
v_lshl_add_u32 v244,v244,13,v21
buffer_load_dwordx2 v[242:243],v244,s[8:11],0 offen sc1
s_waitcnt vmcnt(0) lgkmcnt(0)
s_barrier
s_xor_b32 s67,s67,65536
s_and_b32 s56,s50,2048
s_lshl_b32 s56,s56,4
s_add_u32 s56,s56,s67
v_add_u32 v2,s56,v0
s_and_b32 s56,s50,1024
s_lshl_b32 s56,s56,2
v_add_u32 v238,s56,v2
s_mov_b32 s76,s71
s_mov_b32 s53,s77
ds_read_b128 v[24:27],v238 offset:16384
ds_read_b128 v[40:43],v2 offset:0
ds_read_b128 v[56:59],v2 offset:4096
ds_read_b128 v[28:31],v238 offset:17408
ds_read_b128 v[44:47],v2 offset:1024
ds_read_b128 v[60:63],v2 offset:5120
ds_read_b128 v[32:35],v238 offset:18432
ds_read_b128 v[48:51],v2 offset:2048
ds_read_b128 v[64:67],v2 offset:6144
ds_read_b128 v[36:39],v238 offset:19456
ds_read_b128 v[52:55],v2 offset:3072
ds_read_b128 v[68:71],v2 offset:7168
s_waitcnt lgkmcnt(9)
v_mfma_f32_16x16x32_bf16 v[128:131],v[40:43],v[24:27],v[8:11]
ds_read_b128 v[72:75],v2 offset:24576
v_mfma_f32_16x16x32_bf16 v[132:135],v[56:59],v[24:27],v[12:15]
ds_read_b128 v[76:79],v2 offset:25600
s_waitcnt lgkmcnt(8)
v_mfma_f32_16x16x32_bf16 v[128:131],v[44:47],v[28:31],v[128:131]
ds_read_b128 v[80:83],v2 offset:26624
v_mfma_f32_16x16x32_bf16 v[132:135],v[60:63],v[28:31],v[132:135]
ds_read_b128 v[84:87],v2 offset:27648
s_waitcnt lgkmcnt(7)
v_mfma_f32_16x16x32_bf16 v[128:131],v[48:51],v[32:35],v[128:131]
ds_read_b128 v[88:91],v2 offset:8192
v_mfma_f32_16x16x32_bf16 v[132:135],v[64:67],v[32:35],v[132:135]
ds_read_b128 v[92:95],v2 offset:9216
s_waitcnt lgkmcnt(6)
v_mfma_f32_16x16x32_bf16 v[128:131],v[52:55],v[36:39],v[128:131]
ds_read_b128 v[96:99],v2 offset:10240
v_mfma_f32_16x16x32_bf16 v[132:135],v[68:71],v[36:39],v[132:135]
ds_read_b128 v[100:103],v2 offset:11264
s_waitcnt lgkmcnt(4)
s_mov_b32 vcc_lo,0x33333333
s_mov_b32 vcc_hi,0x33333333
v_mfma_f32_16x16x32_bf16 v[136:139],v[72:75],v[24:27],0
ds_read_b128 v[104:107],v2 offset:12288
v_max3_u32 v238,v72,v73,v74
v_max3_u32 v238,v74,v75,v238
v_cndmask_b32_dpp v120,v72,v74,vcc quad_perm:[0,1,0,1] row_mask:0xf bank_mask:0xf
v_cndmask_b32_dpp v121,v73,v75,vcc quad_perm:[0,1,0,1] row_mask:0xf bank_mask:0xf
v_mfma_f32_16x16x32_bf16 v[136:139],v[76:79],v[28:31],v[136:139]
ds_read_b128 v[108:111],v2 offset:13312
v_max3_u32 v238,v76,v77,v238
v_max3_u32 v238,v78,v79,v238
v_cndmask_b32_dpp v122,v76,v78,vcc quad_perm:[0,1,0,1] row_mask:0xf bank_mask:0xf
v_cndmask_b32_dpp v123,v77,v79,vcc quad_perm:[0,1,0,1] row_mask:0xf bank_mask:0xf
v_mfma_f32_16x16x32_bf16 v[136:139],v[80:83],v[32:35],v[136:139]
ds_read_b128 v[112:115],v2 offset:14336
v_max3_u32 v238,v80,v81,v238
v_max3_u32 v238,v82,v83,v238
v_cndmask_b32_dpp v124,v80,v82,vcc quad_perm:[0,1,0,1] row_mask:0xf bank_mask:0xf
v_cndmask_b32_dpp v125,v81,v83,vcc quad_perm:[0,1,0,1] row_mask:0xf bank_mask:0xf
v_mfma_f32_16x16x32_bf16 v[136:139],v[84:87],v[36:39],v[136:139]
ds_read_b128 v[116:119],v2 offset:15360
v_max3_u32 v238,v84,v85,v238
v_max3_u32 v238,v86,v87,v238
v_cndmask_b32_dpp v126,v84,v86,vcc quad_perm:[0,1,0,1] row_mask:0xf bank_mask:0xf
v_cndmask_b32_dpp v127,v85,v87,vcc quad_perm:[0,1,0,1] row_mask:0xf bank_mask:0xf
v_cmp_eq_u32 vcc,-1,v238
s_waitcnt lgkmcnt(0)
s_cmp_eq_u32 s30,0
s_cbranch_scc1 L_aa_327
s_cmp_lg_u32 s86,1536
s_cbranch_scc1 L_ae_366
s_mov_b32 s77,s35
s_mov_b32 s30,0
s_lshl_b32 s56,s77,5
s_add_u32 s56,s56,s68
s_mul_i32 s70,s56,24576
s_lshl_b32 s71,s56,12
s_lshl_b32 s59,s77,13
s_lshl2_add_u32 s59,s68,s59
s_add_u32 s59,s59,10485760
s_buffer_load_dword s32,s[8:11],s59
s_mov_b32 s33,1
s_add_u32 s70,s70,100663296
s_add_u32 s71,s71,41943040
v_mov_b32 v19,s59
s_branch L_af_367
L_ae_366:
s_ff1_i32_b64 s77,s[84:85]
s_bitset0_b64 s[84:85],s77
s_min_u32 s77,s77,64
s_lshr_b32 s61,s55,5
s_lshl_b32 s56,s77,5
s_add_u32 s56,s56,s68
s_mul_i32 s70,s56,24576
s_lshl_b32 s71,s56,12
s_lshl_b32 s59,s77,13
s_lshl2_add_u32 s59,s68,s59
s_add_u32 s59,s59,10486144
s_cmp_lt_u32 s77,s61
s_cselect_b32 s57,0,16777216
s_mov_b32 s60,s59
s_buffer_load_dword s33,s[8:11],s60
s_add_u32 s71,s71,s57
s_add_u32 s71,s71,58720256
s_cmp_eq_u32 s77,s61
s_cselect_b32 s57,50331648,0
s_cselect_b32 s58,1536,0
s_add_u32 s59,s59,s58
s_buffer_load_dword s32,s[8:11],s59
s_add_u32 s70,s70,s57
s_add_u32 s70,s70,150994944
v_mov_b32 v19,s59
v_writelane_b32 v19,s60,1
L_af_367:
L_a4_345:
s_waitcnt vmcnt(0)
buffer_store_dword v20,off,s[8:11],s73 sc1
s_mov_b32 s73,0x80000000
v_max3_u32 v238,v72,v73,v74
v_max3_u32 v238,v74,v75,v238
v_max3_u32 v238,v76,v77,v238
v_max3_u32 v238,v78,v79,v238
v_max3_u32 v238,v80,v81,v238
v_max3_u32 v238,v82,v83,v238
v_max3_u32 v238,v84,v85,v238
v_max3_u32 v238,v86,v87,v238
v_cmp_eq_u32 vcc,-1,v238
s_cbranch_vccnz L_ac_368
L_acb_369:
v_max3_f32 v238,v128,v129,v130
v_max3_f32 v239,v131,v132,v133
v_max3_f32 v238,v134,v135,v238
v_max3_f32 v239,v138,v139,v239
v_max_f32 v238,v238,v239
v_max_f32 v239,v238,v239
v_pk_mul_f32 v[128:129],v[128:129],v[152:153] op_sel_hi:[1,0]
v_pk_mul_f32 v[130:131],v[130:131],v[152:153] op_sel_hi:[1,0]
v_permlane16_swap_b32 v238,v239
v_max_f32 v238,v238,v239
v_max_f32 v239,v238,v239
v_pk_mul_f32 v[132:133],v[132:133],v[152:153] op_sel_hi:[1,0]
v_pk_mul_f32 v[134:135],v[134:135],v[152:153] op_sel_hi:[1,0]
v_permlane32_swap_b32 v238,v239
v_max_f32 v238,v238,v239
v_mul_f32 v238,v152,v238
v_pk_mul_f32 v[138:139],v[138:139],v[152:153] op_sel_hi:[1,0]
v_pk_add_f32 v[128:129],v[128:129],v[238:239] op_sel_hi:[1,0] neg_lo:[0,1] neg_hi:[0,1]
v_pk_add_f32 v[130:131],v[130:131],v[238:239] op_sel_hi:[1,0] neg_lo:[0,1] neg_hi:[0,1]
v_pk_add_f32 v[132:133],v[132:133],v[238:239] op_sel_hi:[1,0] neg_lo:[0,1] neg_hi:[0,1]
v_pk_add_f32 v[134:135],v[134:135],v[238:239] op_sel_hi:[1,0] neg_lo:[0,1] neg_hi:[0,1]
v_pk_add_f32 v[138:139],v[138:139],v[238:239] op_sel_hi:[1,0] neg_lo:[0,1] neg_hi:[0,1]
v_exp_f32 v128,v128
v_exp_f32 v129,v129
v_exp_f32 v130,v130
v_exp_f32 v131,v131
v_exp_f32 v132,v132
v_exp_f32 v133,v133
v_exp_f32 v134,v134
v_exp_f32 v135,v135
v_exp_f32 v138,v138
v_exp_f32 v139,v139
v_pk_add_f32 v[148:149],v[128:129],v[130:131]
v_pk_add_f32 v[150:151],v[132:133],v[134:135]
v_pk_add_f32 v[148:149],v[148:149],v[138:139]
v_pk_add_f32 v[148:149],v[148:149],v[150:151]
v_add_f32 v150,v148,v149
v_add_f32 v151,v148,v149
s_nop 1
v_permlane16_swap_b32 v150,v151
v_add_f32 v148,v150,v151
v_add_f32 v149,v150,v151
s_nop 1
v_permlane32_swap_b32 v148,v149
v_add_f32 v148,v148,v149
v_rcp_f32 v148,v148
s_nop 0
v_pk_mul_f32 v[138:139],v[138:139],v[148:149] op_sel_hi:[1,0]
v_pk_mul_f32 v[128:129],v[128:129],v[148:149] op_sel_hi:[1,0]
v_pk_mul_f32 v[130:131],v[130:131],v[148:149] op_sel_hi:[1,0]
v_pk_mul_f32 v[132:133],v[132:133],v[148:149] op_sel_hi:[1,0]
v_pk_mul_f32 v[134:135],v[134:135],v[148:149] op_sel_hi:[1,0]
v_cvt_pk_bf16_f32 v144,v138,v139
v_cvt_pk_bf16_f32 v147,v138,v139
s_nop 0
v_mfma_f32_16x16x16_bf16 v[24:27],v[120:121],v[144:145],0
v_cvt_pk_bf16_f32 v140,v128,v129
v_mfma_f32_16x16x16_bf16 v[28:31],v[120:121],v[146:147],0
v_cvt_pk_bf16_f32 v141,v130,v131
v_mfma_f32_16x16x16_bf16 v[32:35],v[122:123],v[144:145],0
v_cvt_pk_bf16_f32 v142,v132,v133
v_mfma_f32_16x16x16_bf16 v[36:39],v[122:123],v[146:147],0
v_cvt_pk_bf16_f32 v143,v134,v135
v_mfma_f32_16x16x16_bf16 v[40:43],v[124:125],v[144:145],0
v_mfma_f32_16x16x16_bf16 v[44:47],v[124:125],v[146:147],0
v_mfma_f32_16x16x16_bf16 v[48:51],v[126:127],v[144:145],0
v_mfma_f32_16x16x16_bf16 v[52:55],v[126:127],v[146:147],0
v_mfma_f32_16x16x32_bf16 v[24:27],v[88:91],v[140:143],v[24:27]
v_mfma_f32_16x16x32_bf16 v[28:31],v[92:95],v[140:143],v[28:31]
v_mfma_f32_16x16x32_bf16 v[32:35],v[96:99],v[140:143],v[32:35]
v_mfma_f32_16x16x32_bf16 v[36:39],v[100:103],v[140:143],v[36:39]
v_cvt_pk_bf16_f32 v72,v24,v28
v_cvt_pk_bf16_f32 v73,v25,v29
v_mfma_f32_16x16x32_bf16 v[40:43],v[104:107],v[140:143],v[40:43]
v_cvt_pk_bf16_f32 v74,v26,v30
v_cvt_pk_bf16_f32 v75,v27,v31
v_mfma_f32_16x16x32_bf16 v[44:47],v[108:111],v[140:143],v[44:47]
ds_write_b128 v3,v[72:75] offset:0
v_cvt_pk_bf16_f32 v76,v32,v36
v_cvt_pk_bf16_f32 v77,v33,v37
v_mfma_f32_16x16x32_bf16 v[48:51],v[112:115],v[140:143],v[48:51]
v_cvt_pk_bf16_f32 v78,v34,v38
v_cvt_pk_bf16_f32 v79,v35,v39
v_mfma_f32_16x16x32_bf16 v[52:55],v[116:119],v[140:143],v[52:55]
ds_write_b128 v3,v[76:79] offset:1024
v_cvt_pk_bf16_f32 v80,v40,v44
v_cvt_pk_bf16_f32 v81,v41,v45
v_cvt_pk_bf16_f32 v82,v42,v46
v_cvt_pk_bf16_f32 v83,v43,v47
ds_write_b128 v3,v[80:83] offset:2048
s_nop 1
v_cvt_pk_bf16_f32 v84,v48,v52
v_cvt_pk_bf16_f32 v85,v49,v53
v_cvt_pk_bf16_f32 v86,v50,v54
v_cvt_pk_bf16_f32 v87,v51,v55
ds_write_b128 v3,v[84:87] offset:3072
s_waitcnt lgkmcnt(0)
s_barrier
L_ad_362:
s_mov_b32 s51,s53
s_mov_b32 s31,1
s_branch L_aa_319
L_aa_325:
s_waitcnt vmcnt(0)
buffer_store_dword v20,off,s[8:11],s73 sc1
s_mov_b32 s73,0x80000000
L_aa_327:
s_mov_b32 s51,s53
s_mov_b32 s31,0
s_add_u32 s35,s53,4
s_cmp_lt_u32 s53,4
s_cbranch_scc1 L_ab_370
s_cmp_ge_u32 s53,63
s_cbranch_scc1 L_am_372
L_aw_373:
v_min_u32 v239,v242,v243
v_cmp_eq_u32 vcc,0,v239
s_cbranch_vccz L_awd_374
s_sleep 4
buffer_load_dwordx2 v[242:243],v244,s[8:11],0 offen sc1
s_sub_u32 s49,s49,1
s_cbranch_scc1 L_abort2
s_waitcnt vmcnt(0)
s_branch L_aw_373
L_awd_374:
v_max_u32 v242,v242,v243
s_nop 1
v_max_u32_dpp v242,v242,v242 row_ror:8 row_mask:0xf bank_mask:0xf
s_nop 1
v_max_u32_dpp v242,v242,v242 row_ror:4 row_mask:0xf bank_mask:0xf
s_nop 1
v_max_u32_dpp v242,v242,v242 row_ror:2 row_mask:0xf bank_mask:0xf
s_nop 1
v_max_u32_dpp v242,v242,v242 row_ror:1 row_mask:0xf bank_mask:0xf
v_mov_b32 v243,v242
s_nop 1
v_permlane16_swap_b32 v242,v243
v_max_u32 v242,v242,v243
v_mov_b32 v243,v242
s_nop 1
v_permlane32_swap_b32 v242,v243
v_max_u32 v242,v242,v243
s_nop 0
v_readfirstlane_b32 s56,v242
v_readlane_b32 s57,v255,s53
s_max_u32 s75,s75,s56
s_bitcmp0_b64 s[42:43],s53
s_cbranch_scc1 L_ab_370
s_mov_b32 s77,s36
s_and_b32 s55,s75,0x7ff
s_sub_u32 s55,2047,s55
s_cmp_lt_u32 s75,s57
s_cselect_b32 s55,4095,s55
s_lshr_b32 s61,s55,5
s_mov_b32 s30,1
s_lshl_b32 s56,s77,5
s_add_u32 s56,s56,s68
s_mul_i32 s70,s56,24576
s_lshl_b32 s71,s56,12
s_lshl_b32 s59,s77,13
s_lshl2_add_u32 s59,s68,s59
s_add_u32 s59,s59,10486144
s_cmp_lt_u32 s77,s61
s_cselect_b32 s57,0,16777216
s_mov_b32 s60,s59
s_add_u32 s71,s71,s57
s_add_u32 s71,s71,58720256
s_cmp_eq_u32 s77,s61
s_cselect_b32 s57,50331648,0
s_cselect_b32 s58,1536,0
s_add_u32 s59,s59,s58
s_add_u32 s70,s70,s57
s_add_u32 s70,s70,150994944
v_mov_b32 v19,s59
v_writelane_b32 v19,s60,1
s_branch L_aj_371
L_ab_370:
s_mov_b32 s77,s35
s_mov_b32 s30,0
s_lshl_b32 s56,s77,5
s_add_u32 s56,s56,s68
s_mul_i32 s70,s56,24576
s_lshl_b32 s71,s56,12
s_lshl_b32 s59,s77,13
s_lshl2_add_u32 s59,s68,s59
s_add_u32 s59,s59,10485760
s_mov_b32 s33,1
s_add_u32 s70,s70,100663296
s_add_u32 s71,s71,41943040
v_mov_b32 v19,s59
L_aj_371:
buffer_load_dword v18,v19,s[8:11],0 offen sc1
s_waitcnt vmcnt(2)
s_mov_b32 vcc_lo,0x33333333
s_mov_b32 vcc_hi,0x33333333
v_mfma_f32_16x16x32_bf16 v[136:139],v[72:75],v[24:27],0
v_max3_u32 v238,v72,v73,v74
v_max3_u32 v238,v74,v75,v238
v_cndmask_b32_dpp v120,v72,v74,vcc quad_perm:[0,1,0,1] row_mask:0xf bank_mask:0xf
v_cndmask_b32_dpp v121,v73,v75,vcc quad_perm:[0,1,0,1] row_mask:0xf bank_mask:0xf
v_mfma_f32_16x16x32_bf16 v[136:139],v[76:79],v[28:31],v[136:139]
v_max3_u32 v238,v76,v77,v238
v_max3_u32 v238,v78,v79,v238
v_cndmask_b32_dpp v122,v76,v78,vcc quad_perm:[0,1,0,1] row_mask:0xf bank_mask:0xf
v_cndmask_b32_dpp v123,v77,v79,vcc quad_perm:[0,1,0,1] row_mask:0xf bank_mask:0xf
v_mfma_f32_16x16x32_bf16 v[136:139],v[80:83],v[32:35],v[136:139]
v_max3_u32 v238,v80,v81,v238
v_max3_u32 v238,v82,v83,v238
v_cndmask_b32_dpp v124,v80,v82,vcc quad_perm:[0,1,0,1] row_mask:0xf bank_mask:0xf
v_cndmask_b32_dpp v125,v81,v83,vcc quad_perm:[0,1,0,1] row_mask:0xf bank_mask:0xf
v_mfma_f32_16x16x32_bf16 v[136:139],v[84:87],v[36:39],v[136:139]
v_max3_u32 v238,v84,v85,v238
v_max3_u32 v238,v86,v87,v238
v_cndmask_b32_dpp v126,v84,v86,vcc quad_perm:[0,1,0,1] row_mask:0xf bank_mask:0xf
v_cndmask_b32_dpp v127,v85,v87,vcc quad_perm:[0,1,0,1] row_mask:0xf bank_mask:0xf
v_cmp_eq_u32 vcc,-1,v238
s_cbranch_vccz L_aa_330
L_aa_329:
buffer_load_dwordx4 v[72:75],v0,s[8:11],s76 offen offset:0 sc1
buffer_load_dwordx4 v[76:79],v0,s[8:11],s76 offen offset:1024 sc1
buffer_load_dwordx4 v[80:83],v0,s[8:11],s76 offen offset:2048 sc1
buffer_load_dwordx4 v[84:87],v0,s[8:11],s76 offen offset:3072 sc1
buffer_load_dword v18,v19,s[8:11],0 offen sc1
s_sub_u32 s49,s49,1
s_cbranch_scc1 L_abort2
s_mov_b32 vcc_lo,0x33333333
s_mov_b32 vcc_hi,0x33333333
s_waitcnt vmcnt(4)
v_mfma_f32_16x16x32_bf16 v[136:139],v[72:75],v[24:27],0
v_max3_u32 v238,v72,v73,v74
v_max3_u32 v238,v74,v75,v238
v_cndmask_b32_dpp v120,v72,v74,vcc quad_perm:[0,1,0,1] row_mask:0xf bank_mask:0xf
v_cndmask_b32_dpp v121,v73,v75,vcc quad_perm:[0,1,0,1] row_mask:0xf bank_mask:0xf
s_waitcnt vmcnt(3)
v_mfma_f32_16x16x32_bf16 v[136:139],v[76:79],v[28:31],v[136:139]
v_max3_u32 v238,v76,v77,v238
v_max3_u32 v238,v78,v79,v238
v_cndmask_b32_dpp v122,v76,v78,vcc quad_perm:[0,1,0,1] row_mask:0xf bank_mask:0xf
v_cndmask_b32_dpp v123,v77,v79,vcc quad_perm:[0,1,0,1] row_mask:0xf bank_mask:0xf
s_waitcnt vmcnt(2)
v_mfma_f32_16x16x32_bf16 v[136:139],v[80:83],v[32:35],v[136:139]
v_max3_u32 v238,v80,v81,v238
v_max3_u32 v238,v82,v83,v238
v_cndmask_b32_dpp v124,v80,v82,vcc quad_perm:[0,1,0,1] row_mask:0xf bank_mask:0xf
v_cndmask_b32_dpp v125,v81,v83,vcc quad_perm:[0,1,0,1] row_mask:0xf bank_mask:0xf
s_waitcnt vmcnt(1)
v_mfma_f32_16x16x32_bf16 v[136:139],v[84:87],v[36:39],v[136:139]
v_max3_u32 v238,v84,v85,v238
v_max3_u32 v238,v86,v87,v238
v_cndmask_b32_dpp v126,v84,v86,vcc quad_perm:[0,1,0,1] row_mask:0xf bank_mask:0xf
v_cndmask_b32_dpp v127,v85,v87,vcc quad_perm:[0,1,0,1] row_mask:0xf bank_mask:0xf
v_cmp_eq_u32 vcc,-1,v238
s_cbranch_vccnz L_aa_329
L_aa_330:
s_cmp_lg_u32 s27,3
s_cbranch_scc1 L_ai_375
v_max3_f32 v238,v128,v129,v130
v_max3_f32 v239,v131,v132,v133
v_max3_f32 v238,v134,v135,v238
v_max3_f32 v239,v138,v139,v239
v_max_f32 v238,v238,v239
v_max_f32 v239,v238,v239
v_pk_mul_f32 v[128:129],v[128:129],v[152:153] op_sel_hi:[1,0]
v_pk_mul_f32 v[130:131],v[130:131],v[152:153] op_sel_hi:[1,0]
v_permlane16_swap_b32 v238,v239
v_max_f32 v238,v238,v239
v_max_f32 v239,v238,v239
v_pk_mul_f32 v[132:133],v[132:133],v[152:153] op_sel_hi:[1,0]
v_pk_mul_f32 v[134:135],v[134:135],v[152:153] op_sel_hi:[1,0]
v_permlane32_swap_b32 v238,v239
v_max_f32 v238,v238,v239
v_mul_f32 v238,v152,v238
v_pk_mul_f32 v[138:139],v[138:139],v[152:153] op_sel_hi:[1,0]
buffer_load_dword v17,v16,s[8:11],s87 offen sc1
v_pk_add_f32 v[128:129],v[128:129],v[238:239] op_sel_hi:[1,0] neg_lo:[0,1] neg_hi:[0,1]
v_pk_add_f32 v[130:131],v[130:131],v[238:239] op_sel_hi:[1,0] neg_lo:[0,1] neg_hi:[0,1]
v_pk_add_f32 v[132:133],v[132:133],v[238:239] op_sel_hi:[1,0] neg_lo:[0,1] neg_hi:[0,1]
v_pk_add_f32 v[134:135],v[134:135],v[238:239] op_sel_hi:[1,0] neg_lo:[0,1] neg_hi:[0,1]
v_pk_add_f32 v[138:139],v[138:139],v[238:239] op_sel_hi:[1,0] neg_lo:[0,1] neg_hi:[0,1]
v_exp_f32 v128,v128
v_exp_f32 v129,v129
v_exp_f32 v130,v130
v_exp_f32 v131,v131
v_exp_f32 v132,v132
v_exp_f32 v133,v133
v_exp_f32 v134,v134
v_exp_f32 v135,v135
v_exp_f32 v138,v138
v_exp_f32 v139,v139
v_pk_add_f32 v[148:149],v[128:129],v[130:131]
v_pk_add_f32 v[150:151],v[132:133],v[134:135]
v_pk_add_f32 v[148:149],v[148:149],v[138:139]
v_pk_add_f32 v[148:149],v[148:149],v[150:151]
v_add_f32 v150,v148,v149
v_add_f32 v151,v148,v149
s_nop 1
v_permlane16_swap_b32 v150,v151
v_add_f32 v148,v150,v151
v_add_f32 v149,v150,v151
s_nop 1
v_permlane32_swap_b32 v148,v149
v_add_f32 v148,v148,v149
v_rcp_f32 v148,v148
s_waitcnt vmcnt(0)
v_cmp_gt_u32 vcc,s66,v17
v_pk_mul_f32 v[138:139],v[138:139],v[148:149] op_sel_hi:[1,0]
v_pk_mul_f32 v[128:129],v[128:129],v[148:149] op_sel_hi:[1,0]
v_pk_mul_f32 v[130:131],v[130:131],v[148:149] op_sel_hi:[1,0]
v_pk_mul_f32 v[132:133],v[132:133],v[148:149] op_sel_hi:[1,0]
v_pk_mul_f32 v[134:135],v[134:135],v[148:149] op_sel_hi:[1,0]
s_cbranch_vccnz L_ap_376
L_apb_377:
s_xor_b32 s34,s69,524288
buffer_load_dwordx4 v[192:195],v7,s[8:11],s34 offen sc1
v_cvt_pk_bf16_f32 v144,v138,v139
v_cvt_pk_bf16_f32 v147,v138,v139
s_nop 0
v_mfma_f32_16x16x16_bf16 v[24:27],v[120:121],v[144:145],0
s_add_u32 s34,s34,4096
v_cvt_pk_bf16_f32 v140,v128,v129
v_mfma_f32_16x16x16_bf16 v[28:31],v[120:121],v[146:147],0
buffer_load_dwordx4 v[196:199],v7,s[8:11],s34 offen sc1
v_cvt_pk_bf16_f32 v141,v130,v131
v_mfma_f32_16x16x16_bf16 v[32:35],v[122:123],v[144:145],0
s_add_u32 s34,s34,4096
v_cvt_pk_bf16_f32 v142,v132,v133
v_mfma_f32_16x16x16_bf16 v[36:39],v[122:123],v[146:147],0
buffer_load_dwordx4 v[200:203],v7,s[8:11],s34 offen sc1
v_cvt_pk_bf16_f32 v143,v134,v135
v_mfma_f32_16x16x16_bf16 v[40:43],v[124:125],v[144:145],0
s_add_u32 s34,s34,4096
v_mfma_f32_16x16x16_bf16 v[44:47],v[124:125],v[146:147],0
buffer_load_dwordx4 v[204:207],v7,s[8:11],s34 offen sc1
v_mfma_f32_16x16x16_bf16 v[48:51],v[126:127],v[144:145],0
s_add_u32 s34,s34,4096
v_mfma_f32_16x16x16_bf16 v[52:55],v[126:127],v[146:147],0
buffer_load_dwordx4 v[208:211],v7,s[8:11],s34 offen sc1
v_mfma_f32_16x16x32_bf16 v[24:27],v[88:91],v[140:143],v[24:27]
s_add_u32 s34,s34,4096
v_mfma_f32_16x16x32_bf16 v[28:31],v[92:95],v[140:143],v[28:31]
buffer_load_dwordx4 v[212:215],v7,s[8:11],s34 offen sc1
v_mfma_f32_16x16x32_bf16 v[32:35],v[96:99],v[140:143],v[32:35]
s_add_u32 s34,s34,4096
v_mfma_f32_16x16x32_bf16 v[36:39],v[100:103],v[140:143],v[36:39]
buffer_load_dwordx4 v[216:219],v7,s[8:11],s34 offen sc1
v_cvt_pk_bf16_f32 v72,v24,v28
v_cvt_pk_bf16_f32 v73,v25,v29
v_mfma_f32_16x16x32_bf16 v[40:43],v[104:107],v[140:143],v[40:43]
s_add_u32 s34,s34,4096
v_cvt_pk_bf16_f32 v74,v26,v30
v_cvt_pk_bf16_f32 v75,v27,v31
v_mfma_f32_16x16x32_bf16 v[44:47],v[108:111],v[140:143],v[44:47]
ds_write_b128 v3,v[72:75] offset:0
v_cvt_pk_bf16_f32 v76,v32,v36
v_cvt_pk_bf16_f32 v77,v33,v37
v_mfma_f32_16x16x32_bf16 v[48:51],v[112:115],v[140:143],v[48:51]
buffer_load_dwordx4 v[220:223],v7,s[8:11],s34 offen sc1
v_cvt_pk_bf16_f32 v78,v34,v38
v_cvt_pk_bf16_f32 v79,v35,v39
v_mfma_f32_16x16x32_bf16 v[52:55],v[116:119],v[140:143],v[52:55]
ds_write_b128 v3,v[76:79] offset:1024
v_cvt_pk_bf16_f32 v80,v40,v44
v_cvt_pk_bf16_f32 v81,v41,v45
v_cvt_pk_bf16_f32 v82,v42,v46
v_cvt_pk_bf16_f32 v83,v43,v47
ds_write_b128 v3,v[80:83] offset:2048
s_nop 1
v_cvt_pk_bf16_f32 v84,v48,v52
v_cvt_pk_bf16_f32 v85,v49,v53
v_cvt_pk_bf16_f32 v86,v50,v54
v_cvt_pk_bf16_f32 v87,v51,v55
ds_write_b128 v3,v[84:87] offset:3072
v_readlane_b32 s32,v18,0
v_readlane_b32 s33,v18,1
s_waitcnt lgkmcnt(0)
s_barrier
s_branch L_aa_332
L_ai_375:
v_max3_f32 v238,v128,v129,v130
v_max3_f32 v239,v131,v132,v133
v_max3_f32 v238,v134,v135,v238
v_max3_f32 v239,v138,v139,v239
v_max_f32 v238,v238,v239
v_max_f32 v239,v238,v239
v_pk_mul_f32 v[128:129],v[128:129],v[152:153] op_sel_hi:[1,0]
v_pk_mul_f32 v[130:131],v[130:131],v[152:153] op_sel_hi:[1,0]
v_permlane16_swap_b32 v238,v239
v_max_f32 v238,v238,v239
v_max_f32 v239,v238,v239
v_pk_mul_f32 v[132:133],v[132:133],v[152:153] op_sel_hi:[1,0]
v_pk_mul_f32 v[134:135],v[134:135],v[152:153] op_sel_hi:[1,0]
v_permlane32_swap_b32 v238,v239
v_max_f32 v238,v238,v239
v_mul_f32 v238,v152,v238
v_pk_mul_f32 v[138:139],v[138:139],v[152:153] op_sel_hi:[1,0]
v_pk_add_f32 v[128:129],v[128:129],v[238:239] op_sel_hi:[1,0] neg_lo:[0,1] neg_hi:[0,1]
v_pk_add_f32 v[130:131],v[130:131],v[238:239] op_sel_hi:[1,0] neg_lo:[0,1] neg_hi:[0,1]
v_pk_add_f32 v[132:133],v[132:133],v[238:239] op_sel_hi:[1,0] neg_lo:[0,1] neg_hi:[0,1]
v_pk_add_f32 v[134:135],v[134:135],v[238:239] op_sel_hi:[1,0] neg_lo:[0,1] neg_hi:[0,1]
v_pk_add_f32 v[138:139],v[138:139],v[238:239] op_sel_hi:[1,0] neg_lo:[0,1] neg_hi:[0,1]
v_exp_f32 v128,v128
v_exp_f32 v129,v129
v_exp_f32 v130,v130
v_exp_f32 v131,v131
v_exp_f32 v132,v132
v_exp_f32 v133,v133
v_exp_f32 v134,v134
v_exp_f32 v135,v135
v_exp_f32 v138,v138
v_exp_f32 v139,v139
v_pk_add_f32 v[148:149],v[128:129],v[130:131]
v_pk_add_f32 v[150:151],v[132:133],v[134:135]
v_pk_add_f32 v[148:149],v[148:149],v[138:139]
v_pk_add_f32 v[148:149],v[148:149],v[150:151]
v_add_f32 v150,v148,v149
v_add_f32 v151,v148,v149
s_nop 1
v_permlane16_swap_b32 v150,v151
v_add_f32 v148,v150,v151
v_add_f32 v149,v150,v151
s_nop 1
v_permlane32_swap_b32 v148,v149
v_add_f32 v148,v148,v149
v_rcp_f32 v148,v148
s_nop 0
v_pk_mul_f32 v[138:139],v[138:139],v[148:149] op_sel_hi:[1,0]
v_pk_mul_f32 v[128:129],v[128:129],v[148:149] op_sel_hi:[1,0]
v_pk_mul_f32 v[130:131],v[130:131],v[148:149] op_sel_hi:[1,0]
v_pk_mul_f32 v[132:133],v[132:133],v[148:149] op_sel_hi:[1,0]
v_pk_mul_f32 v[134:135],v[134:135],v[148:149] op_sel_hi:[1,0]
v_cvt_pk_bf16_f32 v144,v138,v139
v_cvt_pk_bf16_f32 v147,v138,v139
s_nop 0
v_mfma_f32_16x16x16_bf16 v[24:27],v[120:121],v[144:145],0
v_cvt_pk_bf16_f32 v140,v128,v129
v_mfma_f32_16x16x16_bf16 v[28:31],v[120:121],v[146:147],0
v_cvt_pk_bf16_f32 v141,v130,v131
v_mfma_f32_16x16x16_bf16 v[32:35],v[122:123],v[144:145],0
v_cvt_pk_bf16_f32 v142,v132,v133
v_mfma_f32_16x16x16_bf16 v[36:39],v[122:123],v[146:147],0
v_cvt_pk_bf16_f32 v143,v134,v135
v_mfma_f32_16x16x16_bf16 v[40:43],v[124:125],v[144:145],0
v_mfma_f32_16x16x16_bf16 v[44:47],v[124:125],v[146:147],0
v_mfma_f32_16x16x16_bf16 v[48:51],v[126:127],v[144:145],0
v_mfma_f32_16x16x16_bf16 v[52:55],v[126:127],v[146:147],0
v_mfma_f32_16x16x32_bf16 v[24:27],v[88:91],v[140:143],v[24:27]
v_mfma_f32_16x16x32_bf16 v[28:31],v[92:95],v[140:143],v[28:31]
v_mfma_f32_16x16x32_bf16 v[32:35],v[96:99],v[140:143],v[32:35]
v_mfma_f32_16x16x32_bf16 v[36:39],v[100:103],v[140:143],v[36:39]
v_cvt_pk_bf16_f32 v72,v24,v28
v_cvt_pk_bf16_f32 v73,v25,v29
v_mfma_f32_16x16x32_bf16 v[40:43],v[104:107],v[140:143],v[40:43]
v_cvt_pk_bf16_f32 v74,v26,v30
v_cvt_pk_bf16_f32 v75,v27,v31
v_mfma_f32_16x16x32_bf16 v[44:47],v[108:111],v[140:143],v[44:47]
ds_write_b128 v3,v[72:75] offset:0
v_cvt_pk_bf16_f32 v76,v32,v36
v_cvt_pk_bf16_f32 v77,v33,v37
v_mfma_f32_16x16x32_bf16 v[48:51],v[112:115],v[140:143],v[48:51]
v_cvt_pk_bf16_f32 v78,v34,v38
v_cvt_pk_bf16_f32 v79,v35,v39
v_mfma_f32_16x16x32_bf16 v[52:55],v[116:119],v[140:143],v[52:55]
ds_write_b128 v3,v[76:79] offset:1024
v_cvt_pk_bf16_f32 v80,v40,v44
v_cvt_pk_bf16_f32 v81,v41,v45
v_cvt_pk_bf16_f32 v82,v42,v46
v_cvt_pk_bf16_f32 v83,v43,v47
ds_write_b128 v3,v[80:83] offset:2048
s_nop 1
v_cvt_pk_bf16_f32 v84,v48,v52
v_cvt_pk_bf16_f32 v85,v49,v53
v_cvt_pk_bf16_f32 v86,v50,v54
v_cvt_pk_bf16_f32 v87,v51,v55
ds_write_b128 v3,v[84:87] offset:3072
s_waitcnt vmcnt(0)
v_readlane_b32 s32,v18,0
v_readlane_b32 s33,v18,1
s_waitcnt lgkmcnt(0)
s_barrier
s_branch L_aa_319
L_aa_328:
s_cmp_lg_u32 s86,1536
s_cbranch_scc1 L_az_378
s_cmp_ge_u32 s35,67
s_cbranch_scc1 L_aa_318
v_subrev_u32 v248,s36,v1
v_and_b32 v248,0x80000003,v248
v_cmp_eq_u32 vcc,0,v248
v_lshlrev_b32 v248,2,v1
v_mov_b32 v249,0x40000000
v_cndmask_b32 v248,v249,v248,vcc
v_mov_b32 v249,3
s_or_b32 s59,s68,s46
s_mov_b32 s59,11018240
s_cmov_b32 s59,0x80000000
buffer_store_dword v249,v248,s[8:11],s59 offen sc1
L_aa_318:
s_waitcnt vmcnt(0)
buffer_store_dword v20,off,s[8:11],s73 sc1
s_mov_b32 s73,0x80000000
v_lshlrev_b32 v238,2,v1
v_add_u32 v248,155712,v238
s_cmp_lg_u32 s46,0
s_cbranch_scc1 L_an_379
s_lshl_b32 s59,s54,13
s_add_u32 s59,s59,11026432
L_fp_380:
s_sleep 1
buffer_load_dword v239,v238,s[8:11],s59 offen sc1
s_sub_u32 s49,s49,1
s_cbranch_scc1 L_abort2
s_waitcnt vmcnt(0)
v_cmp_eq_u32 vcc,0,v239
s_cbranch_vccnz L_fp_380
ds_write_b32 v248,v239
s_waitcnt lgkmcnt(0)
L_an_379:
s_barrier
ds_read_b32 v239,v248
s_mov_b32 s86,768
s_mov_b32 s30,1
s_waitcnt lgkmcnt(0)
v_readfirstlane_b32 s55,v239
v_and_b32 v239,255,v239
s_lshr_b32 s55,s55,8
s_lshr_b32 s61,s55,5
v_cmp_ne_u32 s[38:39],3,v239
v_cmp_le_u32 vcc,s61,v1
s_nop 1
v_cndmask_b32 v238,1,2,vcc
v_cmp_ne_u32 s[84:85],v238,v239
s_bcnt1_i32_b64 s56,s[84:85]
s_nop 0
v_mbcnt_lo_u32_b32 v238,s84,0
v_mbcnt_hi_u32_b32 v238,s85,v238
s_mul_i32 s56,s56,15
s_add_u32 s56,s56,130
s_lshr_b32 s56,s56,7
s_lshl_b32 s56,s56,1
v_cmp_gt_u32 vcc,s56,v238
v_and_b32 v239,1,v238
v_and_b32 v238,3,v238
v_add_u32 v238,2,v238
v_cndmask_b32 v238,v238,v239,vcc
v_cmp_eq_u32 vcc,s54,v238
s_and_b64 s[84:85],s[84:85],vcc
s_ff1_i32_b64 s77,s[84:85]
s_bitset0_b64 s[84:85],s77
s_min_u32 s77,s77,64
s_lshl_b32 s56,s77,5
s_add_u32 s56,s56,s68
s_mul_i32 s70,s56,24576
s_lshl_b32 s71,s56,12
s_lshl_b32 s59,s77,13
s_lshl2_add_u32 s59,s68,s59
s_add_u32 s59,s59,10486144
s_cmp_lt_u32 s77,s61
s_cselect_b32 s57,0,16777216
s_mov_b32 s60,s59
s_buffer_load_dword s33,s[8:11],s60
s_add_u32 s71,s71,s57
s_add_u32 s71,s71,58720256
s_cmp_eq_u32 s77,s61
s_cselect_b32 s57,50331648,0
s_cselect_b32 s58,1536,0
s_add_u32 s59,s59,s58
s_buffer_load_dword s32,s[8:11],s59
s_add_u32 s70,s70,s57
s_add_u32 s70,s70,150994944
v_mov_b32 v19,s59
v_writelane_b32 v19,s60,1
s_cmp_ge_u32 s77,64
s_cbranch_scc1 L_az_378
s_cmp_eq_u32 s77,s61
s_cbranch_scc1 L_aa_326
s_mov_b32 s27,0
s_bitcmp1_b64 s[38:39],s77
s_cbranch_scc1 L_a3_365
s_branch L_aa_326
L_az_378:
s_waitcnt vmcnt(0)
buffer_store_dword v20,off,s[8:11],s73 sc1
s_mov_b32 s73,0x80000000
s_endpgm
L_ag_334:
s_lshl_b32 s21,s26,13
s_lshl2_add_u32 s21,s68,s21
s_add_u32 s21,s21,10487296
L_ww_381:
buffer_load_dword v246,off,s[8:11],s21 sc1
s_sub_u32 s49,s49,1
s_cbranch_scc1 L_abort2
s_waitcnt vmcnt(0)
v_readfirstlane_b32 s22,v246
s_cmp_eq_u32 s22,0
s_cbranch_scc1 L_ww_381
L_wwd_382:
s_branch L_agb_335
L_a4_343:
v_mov_b32 v248,s27
ds_write_b32 v247,v248 offset:16
s_waitcnt lgkmcnt(0)
s_barrier
ds_read_b128 v[248:251],v245 offset:16
s_waitcnt lgkmcnt(0)
v_or3_b32 v248,v248,v249,v250
v_or_b32 v248,v248,v251
v_cmp_ne_u32 vcc,0,v248
s_cbranch_vccz L_a4_344
L_aq_383:
buffer_load_dword v17,v16,s[8:11],s87 offen sc1
s_sub_u32 s49,s49,1
s_cbranch_scc1 L_abort2
s_waitcnt vmcnt(0)
v_cmp_gt_u32 vcc,s66,v17
s_cbranch_vccnz L_aq_383
s_xor_b32 s34,s69,524288
buffer_load_dwordx4 v[160:163],v7,s[8:11],s34 offen sc1
s_add_u32 s34,s34,4096
buffer_load_dwordx4 v[164:167],v7,s[8:11],s34 offen sc1
s_add_u32 s34,s34,4096
buffer_load_dwordx4 v[168:171],v7,s[8:11],s34 offen sc1
s_add_u32 s34,s34,4096
buffer_load_dwordx4 v[172:175],v7,s[8:11],s34 offen sc1
s_add_u32 s34,s34,4096
buffer_load_dwordx4 v[176:179],v7,s[8:11],s34 offen sc1
s_add_u32 s34,s34,4096
buffer_load_dwordx4 v[180:183],v7,s[8:11],s34 offen sc1
s_add_u32 s34,s34,4096
buffer_load_dwordx4 v[184:187],v7,s[8:11],s34 offen sc1
s_add_u32 s34,s34,4096
buffer_load_dwordx4 v[188:191],v7,s[8:11],s34 offen sc1
s_waitcnt vmcnt(7)
v_mfma_f32_16x16x32_bf16 v[192:195],v[156:159],v[160:163],0
s_waitcnt vmcnt(6)
v_mfma_f32_16x16x32_bf16 v[192:195],v[156:159],v[164:167],v[192:195]
s_waitcnt vmcnt(5)
v_mfma_f32_16x16x32_bf16 v[192:195],v[156:159],v[168:171],v[192:195]
s_waitcnt vmcnt(4)
v_mfma_f32_16x16x32_bf16 v[192:195],v[156:159],v[172:175],v[192:195]
s_waitcnt vmcnt(3)
v_mfma_f32_16x16x32_bf16 v[196:199],v[156:159],v[176:179],0
s_waitcnt vmcnt(2)
v_mfma_f32_16x16x32_bf16 v[196:199],v[156:159],v[180:183],v[196:199]
s_waitcnt vmcnt(1)
v_mfma_f32_16x16x32_bf16 v[196:199],v[156:159],v[184:187],v[196:199]
ds_write_b128 v6,v[192:195]
s_waitcnt vmcnt(0)
v_mfma_f32_16x16x32_bf16 v[196:199],v[156:159],v[188:191],v[196:199]
s_nop 7
ds_write_b128 v6,v[196:199] offset:2048
s_waitcnt lgkmcnt(0)
s_barrier
buffer_store_dword v20,off,s[8:11],s73 sc1
s_mov_b32 s73,0x80000000
s_mov_b32 s27,4
s_branch L_aa_323
L_ac_346:
buffer_store_dword v20,off,s[8:11],s73 sc1
s_mov_b32 s73,0x80000000
buffer_load_dwordx4 v[72:75],v0,s[8:11],s76 offen offset:0 sc1
buffer_load_dwordx4 v[76:79],v0,s[8:11],s76 offen offset:1024 sc1
buffer_load_dwordx4 v[80:83],v0,s[8:11],s76 offen offset:2048 sc1
buffer_load_dwordx4 v[84:87],v0,s[8:11],s76 offen offset:3072 sc1
s_sub_u32 s49,s49,1
s_cbranch_scc1 L_abort2
s_mov_b32 vcc_lo,0x33333333
s_mov_b32 vcc_hi,0x33333333
s_waitcnt vmcnt(3)
v_mfma_f32_16x16x32_bf16 v[136:139],v[72:75],v[24:27],0
v_max3_u32 v238,v72,v73,v74
v_max3_u32 v238,v74,v75,v238
v_cndmask_b32_dpp v120,v72,v74,vcc quad_perm:[0,1,0,1] row_mask:0xf bank_mask:0xf
v_cndmask_b32_dpp v121,v73,v75,vcc quad_perm:[0,1,0,1] row_mask:0xf bank_mask:0xf
s_waitcnt vmcnt(2)
v_mfma_f32_16x16x32_bf16 v[136:139],v[76:79],v[28:31],v[136:139]
v_max3_u32 v238,v76,v77,v238
v_max3_u32 v238,v78,v79,v238
v_cndmask_b32_dpp v122,v76,v78,vcc quad_perm:[0,1,0,1] row_mask:0xf bank_mask:0xf
v_cndmask_b32_dpp v123,v77,v79,vcc quad_perm:[0,1,0,1] row_mask:0xf bank_mask:0xf
s_waitcnt vmcnt(1)
v_mfma_f32_16x16x32_bf16 v[136:139],v[80:83],v[32:35],v[136:139]
v_max3_u32 v238,v80,v81,v238
v_max3_u32 v238,v82,v83,v238
v_cndmask_b32_dpp v124,v80,v82,vcc quad_perm:[0,1,0,1] row_mask:0xf bank_mask:0xf
v_cndmask_b32_dpp v125,v81,v83,vcc quad_perm:[0,1,0,1] row_mask:0xf bank_mask:0xf
s_waitcnt vmcnt(0)
v_mfma_f32_16x16x32_bf16 v[136:139],v[84:87],v[36:39],v[136:139]
v_max3_u32 v238,v84,v85,v238
v_max3_u32 v238,v86,v87,v238
v_cndmask_b32_dpp v126,v84,v86,vcc quad_perm:[0,1,0,1] row_mask:0xf bank_mask:0xf
v_cndmask_b32_dpp v127,v85,v87,vcc quad_perm:[0,1,0,1] row_mask:0xf bank_mask:0xf
v_cmp_eq_u32 vcc,-1,v238
s_cbranch_vccnz L_ac_346
s_branch L_acb_347
L_ap_349:
L_aw_384:
v_cmp_gt_u32 vcc,s66,v17
s_cbranch_vccz L_awd_385
buffer_load_dword v17,v16,s[8:11],s87 offen sc1
s_sub_u32 s49,s49,1
s_cbranch_scc1 L_abort2
s_waitcnt vmcnt(0)
s_branch L_aw_384
L_awd_385:
s_branch L_apb_350
L_a1_351:
v_subrev_u32 v248,s36,v1
v_and_b32 v248,0x80000003,v248
v_cmp_eq_u32 vcc,0,v248
v_lshlrev_b32 v248,2,v1
v_mov_b32 v249,0x40000000
v_cndmask_b32 v248,v249,v248,vcc
v_mov_b32 v249,3
s_or_b32 s59,s68,s46
s_mov_b32 s59,11018240
s_cmov_b32 s59,0x80000000
buffer_store_dword v249,v248,s[8:11],s59 offen sc1
s_branch L_a2_352
L_ag_360:
s_lshl_b32 s21,s51,13
s_lshl2_add_u32 s21,s68,s21
s_add_u32 s21,s21,10487296
L_ww_386:
buffer_load_dword v246,off,s[8:11],s21 sc1
s_sub_u32 s49,s49,1
s_cbranch_scc1 L_abort2
s_waitcnt vmcnt(0)
v_readfirstlane_b32 s22,v246
s_cmp_eq_u32 s22,0
s_cbranch_scc1 L_ww_386
L_wwd_387:
s_branch L_agb_361
L_ac_368:
buffer_store_dword v20,off,s[8:11],s73 sc1
s_mov_b32 s73,0x80000000
buffer_load_dwordx4 v[72:75],v0,s[8:11],s76 offen offset:0 sc1
buffer_load_dwordx4 v[76:79],v0,s[8:11],s76 offen offset:1024 sc1
buffer_load_dwordx4 v[80:83],v0,s[8:11],s76 offen offset:2048 sc1
buffer_load_dwordx4 v[84:87],v0,s[8:11],s76 offen offset:3072 sc1
s_sub_u32 s49,s49,1
s_cbranch_scc1 L_abort2
s_mov_b32 vcc_lo,0x33333333
s_mov_b32 vcc_hi,0x33333333
s_waitcnt vmcnt(3)
v_mfma_f32_16x16x32_bf16 v[136:139],v[72:75],v[24:27],0
v_max3_u32 v238,v72,v73,v74
v_max3_u32 v238,v74,v75,v238
v_cndmask_b32_dpp v120,v72,v74,vcc quad_perm:[0,1,0,1] row_mask:0xf bank_mask:0xf
v_cndmask_b32_dpp v121,v73,v75,vcc quad_perm:[0,1,0,1] row_mask:0xf bank_mask:0xf
s_waitcnt vmcnt(2)
v_mfma_f32_16x16x32_bf16 v[136:139],v[76:79],v[28:31],v[136:139]
v_max3_u32 v238,v76,v77,v238
v_max3_u32 v238,v78,v79,v238
v_cndmask_b32_dpp v122,v76,v78,vcc quad_perm:[0,1,0,1] row_mask:0xf bank_mask:0xf
v_cndmask_b32_dpp v123,v77,v79,vcc quad_perm:[0,1,0,1] row_mask:0xf bank_mask:0xf
s_waitcnt vmcnt(1)
v_mfma_f32_16x16x32_bf16 v[136:139],v[80:83],v[32:35],v[136:139]
v_max3_u32 v238,v80,v81,v238
v_max3_u32 v238,v82,v83,v238
v_cndmask_b32_dpp v124,v80,v82,vcc quad_perm:[0,1,0,1] row_mask:0xf bank_mask:0xf
v_cndmask_b32_dpp v125,v81,v83,vcc quad_perm:[0,1,0,1] row_mask:0xf bank_mask:0xf
s_waitcnt vmcnt(0)
v_mfma_f32_16x16x32_bf16 v[136:139],v[84:87],v[36:39],v[136:139]
v_max3_u32 v238,v84,v85,v238
v_max3_u32 v238,v86,v87,v238
v_cndmask_b32_dpp v126,v84,v86,vcc quad_perm:[0,1,0,1] row_mask:0xf bank_mask:0xf
v_cndmask_b32_dpp v127,v85,v87,vcc quad_perm:[0,1,0,1] row_mask:0xf bank_mask:0xf
v_cmp_eq_u32 vcc,-1,v238
s_cbranch_vccnz L_ac_368
s_branch L_acb_369
L_am_372:
v_subrev_u32 v248,s36,v1
v_and_b32 v248,0x80000003,v248
v_cmp_eq_u32 vcc,0,v248
v_lshlrev_b32 v248,2,v1
v_mov_b32 v249,0x40000000
v_cndmask_b32 v248,v249,v248,vcc
v_mov_b32 v249,3
s_or_b32 s59,s68,s46
s_mov_b32 s59,11018240
s_cmov_b32 s59,0x80000000
buffer_store_dword v249,v248,s[8:11],s59 offen sc1
s_branch L_ab_370
L_ap_376:
L_aw_388:
v_cmp_gt_u32 vcc,s66,v17
s_cbranch_vccz L_awd_389
buffer_load_dword v17,v16,s[8:11],s87 offen sc1
s_sub_u32 s49,s49,1
s_cbranch_scc1 L_abort2
s_waitcnt vmcnt(0)
s_branch L_aw_388
L_awd_389:
s_branch L_apb_377
s_endpgm
L_wm:
s_nop 11
v_and_b32 v120,15,v1
v_lshrrev_b32 v121,4,v1
v_mov_b32 v17,1
s_lshl_b32 s56,s46,15
v_add_u32 v18,s56,v0
s_lshl_b32 s56,s46,2
v_add_u32 v125,s56,v121
v_xor_b32 v126,v125,v120
v_lshlrev_b32 v126,4,v126
v_lshl_add_u32 v20,v125,10,v126
v_add_u32 v125,0,v121
v_xor_b32 v125,v125,v120
v_lshlrev_b32 v125,4,v125
v_lshl_add_u32 v125,v120,8,v125
v_add_u32 v4,131072,v125
v_add_u32 v125,4,v121
v_xor_b32 v125,v125,v120
v_lshlrev_b32 v125,4,v125
v_lshl_add_u32 v125,v120,8,v125
v_add_u32 v5,131072,v125
v_add_u32 v125,8,v121
v_xor_b32 v125,v125,v120
v_lshlrev_b32 v125,4,v125
v_lshl_add_u32 v125,v120,8,v125
v_add_u32 v6,131072,v125
v_add_u32 v125,12,v121
v_xor_b32 v125,v125,v120
v_lshlrev_b32 v125,4,v125
v_lshl_add_u32 v125,v120,8,v125
v_add_u32 v7,131072,v125
v_lshlrev_b32 v21,5,v120
v_and_b32 v125,1,v121
v_lshl_add_u32 v21,v125,4,v21
s_lshl_b32 s56,s46,9
v_lshrrev_b32 v125,1,v121
v_lshl_add_u32 v21,v125,11,v21
s_add_u32 s56,s56,155648
v_add_u32 v21,s56,v21
v_lshlrev_b32 v22,4,v120
v_lshl_add_u32 v22,v121,10,v22
s_lshl_b32 s56,s46,8
v_add_u32 v22,s56,v22
s_mov_b32 s54,0
s_mov_b32 s31,0
s_mov_b32 s53,6
s_mov_b32 s72,0x80000000
s_mov_b32 s73,0
s_mov_b32 s77,-1
s_mov_b32 s86,0
s_mov_b32 s19,0
s_mov_b32 s74,2948595712
s_mov_b32 s75,2863311530
v_and_b32 v23,15,v1
v_lshlrev_b32 v23,3,v23
v_lshrrev_b32 v16,4,v1
v_lshl_add_u32 v23,v16,13,v23
v_mov_b32 v19,159744
v_lshl_add_u32 v16,v16,2,v19
v_and_b32 v9,15,v1
v_lshrrev_b32 v10,4,v1
v_and_b32 v124,1,v1
v_lshlrev_b32 v124,4,v124
v_mov_b32 v125,0xffff
v_lshlrev_b32 v125,v124,v125
v_lshrrev_b32 v124,2,v9
v_cmp_eq_u32 vcc,0,v124
s_nop 1
v_cndmask_b32 v12,0,v125,vcc
v_cmp_eq_u32 vcc,1,v124
s_nop 1
v_cndmask_b32 v13,0,v125,vcc
v_and_b32 v124,2,v1
v_cmp_eq_u32 vcc,0,v124
v_mov_b32 v14,0xeeee
v_mov_b32 v124,0x4444
v_cndmask_b32 v14,v14,v124,vcc
v_lshlrev_b32 v11,14,v10
v_lshl_add_u32 v11,v9,4,v11
s_lshl_b32 s65,s51,15
s_add_u32 s65,s65,92274688
s_lshl_b32 s62,s47,10
s_add_u32 s62,s62,s65
s_lshl_b32 s63,s47,16
s_lshl_b32 s60,s46,8
s_add_u32 s63,s63,s60
s_mov_b32 s4,s38
s_mov_b32 s5,s39
s_mov_b32 s6,1835008
s_mov_b32 s7,0x20000
buffer_load_dwordx4 v[24:27],v11,s[4:7],s63 offen offset:0
buffer_load_dwordx4 v[28:31],v11,s[4:7],s63 offen offset:1024
buffer_load_dwordx4 v[32:35],v11,s[4:7],s63 offen offset:2048
buffer_load_dwordx4 v[36:39],v11,s[4:7],s63 offen offset:3072
s_add_u32 s63,s63,4096
buffer_load_dwordx4 v[40:43],v11,s[4:7],s63 offen offset:0
buffer_load_dwordx4 v[44:47],v11,s[4:7],s63 offen offset:1024
buffer_load_dwordx4 v[48:51],v11,s[4:7],s63 offen offset:2048
buffer_load_dwordx4 v[52:55],v11,s[4:7],s63 offen offset:3072
s_add_u32 s63,s63,4096
buffer_load_dwordx4 v[56:59],v11,s[4:7],s63 offen offset:0
buffer_load_dwordx4 v[60:63],v11,s[4:7],s63 offen offset:1024
buffer_load_dwordx4 v[64:67],v11,s[4:7],s63 offen offset:2048
buffer_load_dwordx4 v[68:71],v11,s[4:7],s63 offen offset:3072
s_add_u32 s63,s63,4096
buffer_load_dwordx4 v[72:75],v11,s[4:7],s63 offen offset:0
buffer_load_dwordx4 v[76:79],v11,s[4:7],s63 offen offset:1024
buffer_load_dwordx4 v[80:83],v11,s[4:7],s63 offen offset:2048
buffer_load_dwordx4 v[84:87],v11,s[4:7],s63 offen offset:3072
s_mov_b32 s4,s32
s_mov_b32 s5,s33
s_mov_b32 s6,1024
s_mov_b32 s7,0x20000
buffer_load_dwordx4 v[88:91],v0,s[4:7],0 offen
s_waitcnt vmcnt(0)
v_lshlrev_b32 v96,16,v88
v_and_b32 v97,0xffff0000,v88
v_lshlrev_b32 v98,16,v89
v_and_b32 v99,0xffff0000,v89
v_lshlrev_b32 v100,16,v90
v_and_b32 v101,0xffff0000,v90
v_lshlrev_b32 v102,16,v91
v_and_b32 v103,0xffff0000,v91
v_mul_f32 v88,v96,v96
v_fma_f32 v88,v97,v97,v88
v_fma_f32 v88,v98,v98,v88
v_fma_f32 v88,v99,v99,v88
v_fma_f32 v88,v100,v100,v88
v_fma_f32 v88,v101,v101,v88
v_fma_f32 v88,v102,v102,v88
v_fma_f32 v88,v103,v103,v88
s_nop 1
v_add_f32_dpp v88,v88,v88 row_ror:8 row_mask:0xf bank_mask:0xf
s_nop 1
v_add_f32_dpp v88,v88,v88 row_ror:4 row_mask:0xf bank_mask:0xf
s_nop 1
v_add_f32_dpp v88,v88,v88 row_ror:2 row_mask:0xf bank_mask:0xf
s_nop 1
v_add_f32_dpp v88,v88,v88 row_ror:1 row_mask:0xf bank_mask:0xf
v_mov_b32 v89,v88
s_nop 1
v_permlane16_swap_b32 v88,v89
v_add_f32 v88,v88,v89
v_mov_b32 v89,v88
s_nop 1
v_permlane32_swap_b32 v88,v89
v_add_f32 v88,v88,v89
v_sqrt_f32 v88,v88
s_nop 0
v_mul_f32 v88,0x40333333,v88
s_nop 0
v_readfirstlane_b32 s25,v88
s_bitset1_b32 s25,31
s_ff1_i32_b64 s30,s[74:75]
s_bitset0_b64 s[74:75],s30
s_min_u32 s30,s30,127
s_lshl_b32 s70,s30,15
s_add_u32 s70,s70,0
s_add_u32 s71,s70,16384
L_mo_394:
s_cmp_lg_u32 s19,0
s_cbranch_scc1 L_mo_395
s_add_u32 m0,s50,131072
s_nop 0
buffer_load_dwordx4 v20,s[8:11],s70 offen offset:0 sc1 lds
s_add_u32 m0,s50,135168
s_nop 0
buffer_load_dwordx4 v20,s[8:11],s71 offen offset:0 sc1 lds
s_add_u32 m0,s50,139008
s_nop 0
buffer_load_dwordx4 v20,s[8:11],s70 offen offset:256 sc1 lds
s_add_u32 m0,s50,143104
s_nop 0
buffer_load_dwordx4 v20,s[8:11],s71 offen offset:256 sc1 lds
s_add_u32 m0,s50,146944
s_nop 0
buffer_load_dwordx4 v20,s[8:11],s70 offen offset:512 sc1 lds
s_add_u32 m0,s50,151040
s_nop 0
buffer_load_dwordx4 v20,s[8:11],s71 offen offset:512 sc1 lds
s_mov_b32 s19,1
s_waitcnt vmcnt(0)
L_mo_395:
s_mov_b32 s51,s30
s_mov_b64 s[68:69],s[70:71]
s_ff1_i32_b64 s30,s[74:75]
s_bitset0_b64 s[74:75],s30
s_min_u32 s30,s30,127
s_lshl_b32 s70,s30,15
s_add_u32 s70,s70,0
s_add_u32 s71,s70,16384
s_lshl_b32 s76,s31,13
s_add_u32 s76,s76,10487040
s_lshl_b32 s58,s51,5
s_add_u32 s58,s58,s47
s_mul_i32 s58,s58,24576
s_add_u32 s58,s58,100663296
s_add_u32 s61,s58,s50
s_add_u32 s62,s61,4096
s_add_u32 s63,s61,16384
s_add_u32 s64,s61,20480
s_add_u32 s65,s61,s50
s_add_u32 s65,s65,8192
s_waitcnt vmcnt(12)
s_barrier
ds_read_b128 v[72:75],v4 offset:0
ds_read_b128 v[76:79],v4 offset:4096
ds_read_b128 v[80:83],v5 offset:0
ds_read_b128 v[84:87],v5 offset:4096
s_add_u32 m0,s50,154880
s_nop 0
buffer_load_dwordx4 v20,s[8:11],s68 offen offset:768 sc1 lds
s_add_u32 m0,s50,158976
s_nop 0
buffer_load_dwordx4 v20,s[8:11],s69 offen offset:768 sc1 lds
s_waitcnt lgkmcnt(2)
v_mfma_f32_16x16x32_bf16 v[40:43],a[128:131],v[72:75],0
ds_read_b128 v[108:111],v6 offset:0
v_mfma_f32_16x16x32_bf16 v[56:59],v[72:75],v[128:131],0
v_mfma_f32_16x16x32_bf16 v[24:27],a[0:3],v[72:75],0
ds_read_b128 v[112:115],v6 offset:4096
v_mfma_f32_16x16x32_bf16 v[44:47],a[128:131],v[76:79],0
v_mfma_f32_16x16x32_bf16 v[60:63],v[76:79],v[128:131],0
v_mfma_f32_16x16x32_bf16 v[28:31],a[0:3],v[76:79],0
v_mfma_f32_16x16x32_bf16 v[48:51],a[136:139],v[72:75],0
v_mfma_f32_16x16x32_bf16 v[64:67],v[72:75],v[136:139],0
v_mfma_f32_16x16x32_bf16 v[32:35],a[8:11],v[72:75],0
v_mfma_f32_16x16x32_bf16 v[52:55],a[136:139],v[76:79],0
v_mfma_f32_16x16x32_bf16 v[68:71],v[76:79],v[136:139],0
v_mfma_f32_16x16x32_bf16 v[36:39],a[8:11],v[76:79],0
s_waitcnt lgkmcnt(2)
v_mfma_f32_16x16x32_bf16 v[40:43],a[132:135],v[80:83],v[40:43]
ds_read_b128 v[72:75],v7 offset:0
v_mfma_f32_16x16x32_bf16 v[56:59],v[80:83],v[132:135],v[56:59]
v_mfma_f32_16x16x32_bf16 v[24:27],a[4:7],v[80:83],v[24:27]
ds_read_b128 v[76:79],v7 offset:4096
v_mfma_f32_16x16x32_bf16 v[44:47],a[132:135],v[84:87],v[44:47]
v_mfma_f32_16x16x32_bf16 v[60:63],v[84:87],v[132:135],v[60:63]
v_mfma_f32_16x16x32_bf16 v[28:31],a[4:7],v[84:87],v[28:31]
v_mfma_f32_16x16x32_bf16 v[48:51],a[140:143],v[80:83],v[48:51]
v_mfma_f32_16x16x32_bf16 v[64:67],v[80:83],v[140:143],v[64:67]
v_mfma_f32_16x16x32_bf16 v[32:35],a[12:15],v[80:83],v[32:35]
v_mfma_f32_16x16x32_bf16 v[52:55],a[140:143],v[84:87],v[52:55]
v_mfma_f32_16x16x32_bf16 v[68:71],v[84:87],v[140:143],v[68:71]
v_mfma_f32_16x16x32_bf16 v[36:39],a[12:15],v[84:87],v[36:39]
s_waitcnt vmcnt(12)
s_barrier
s_waitcnt lgkmcnt(2)
v_mfma_f32_16x16x32_bf16 v[40:43],a[144:147],v[108:111],v[40:43]
ds_read_b128 v[80:83],v4 offset:8192
v_mfma_f32_16x16x32_bf16 v[56:59],v[108:111],v[144:147],v[56:59]
v_mfma_f32_16x16x32_bf16 v[24:27],a[16:19],v[108:111],v[24:27]
ds_read_b128 v[84:87],v4 offset:12288
v_mfma_f32_16x16x32_bf16 v[44:47],a[144:147],v[112:115],v[44:47]
v_mfma_f32_16x16x32_bf16 v[60:63],v[112:115],v[144:147],v[60:63]
v_mfma_f32_16x16x32_bf16 v[28:31],a[16:19],v[112:115],v[28:31]
v_mfma_f32_16x16x32_bf16 v[48:51],a[152:155],v[108:111],v[48:51]
v_mfma_f32_16x16x32_bf16 v[64:67],v[108:111],v[152:155],v[64:67]
v_mfma_f32_16x16x32_bf16 v[32:35],a[24:27],v[108:111],v[32:35]
v_mfma_f32_16x16x32_bf16 v[52:55],a[152:155],v[112:115],v[52:55]
v_mfma_f32_16x16x32_bf16 v[68:71],v[112:115],v[152:155],v[68:71]
v_mfma_f32_16x16x32_bf16 v[36:39],a[24:27],v[112:115],v[36:39]
s_waitcnt lgkmcnt(2)
v_mfma_f32_16x16x32_bf16 v[40:43],a[148:151],v[72:75],v[40:43]
ds_read_b128 v[108:111],v5 offset:8192
v_mfma_f32_16x16x32_bf16 v[56:59],v[72:75],v[148:151],v[56:59]
v_mfma_f32_16x16x32_bf16 v[24:27],a[20:23],v[72:75],v[24:27]
ds_read_b128 v[112:115],v5 offset:12288
v_mfma_f32_16x16x32_bf16 v[44:47],a[148:151],v[76:79],v[44:47]
v_mfma_f32_16x16x32_bf16 v[60:63],v[76:79],v[148:151],v[60:63]
v_mfma_f32_16x16x32_bf16 v[28:31],a[20:23],v[76:79],v[28:31]
v_mfma_f32_16x16x32_bf16 v[48:51],a[156:159],v[72:75],v[48:51]
v_mfma_f32_16x16x32_bf16 v[64:67],v[72:75],v[156:159],v[64:67]
v_mfma_f32_16x16x32_bf16 v[32:35],a[28:31],v[72:75],v[32:35]
v_mfma_f32_16x16x32_bf16 v[52:55],a[156:159],v[76:79],v[52:55]
v_mfma_f32_16x16x32_bf16 v[68:71],v[76:79],v[156:159],v[68:71]
v_mfma_f32_16x16x32_bf16 v[36:39],a[28:31],v[76:79],v[36:39]
s_waitcnt lgkmcnt(2)
v_mfma_f32_16x16x32_bf16 v[40:43],a[160:163],v[80:83],v[40:43]
ds_read_b128 v[72:75],v6 offset:8192
v_mfma_f32_16x16x32_bf16 v[56:59],v[80:83],v[160:163],v[56:59]
v_mfma_f32_16x16x32_bf16 v[24:27],a[32:35],v[80:83],v[24:27]
ds_read_b128 v[76:79],v6 offset:12288
v_mfma_f32_16x16x32_bf16 v[44:47],a[160:163],v[84:87],v[44:47]
v_mfma_f32_16x16x32_bf16 v[60:63],v[84:87],v[160:163],v[60:63]
v_mfma_f32_16x16x32_bf16 v[28:31],a[32:35],v[84:87],v[28:31]
v_mfma_f32_16x16x32_bf16 v[48:51],a[168:171],v[80:83],v[48:51]
v_mfma_f32_16x16x32_bf16 v[64:67],v[80:83],v[168:171],v[64:67]
v_mfma_f32_16x16x32_bf16 v[32:35],a[40:43],v[80:83],v[32:35]
v_mfma_f32_16x16x32_bf16 v[52:55],a[168:171],v[84:87],v[52:55]
v_mfma_f32_16x16x32_bf16 v[68:71],v[84:87],v[168:171],v[68:71]
v_mfma_f32_16x16x32_bf16 v[36:39],a[40:43],v[84:87],v[36:39]
s_waitcnt lgkmcnt(2)
v_mfma_f32_16x16x32_bf16 v[40:43],a[164:167],v[108:111],v[40:43]
ds_read_b128 v[80:83],v7 offset:8192
v_mfma_f32_16x16x32_bf16 v[56:59],v[108:111],v[164:167],v[56:59]
v_mfma_f32_16x16x32_bf16 v[24:27],a[36:39],v[108:111],v[24:27]
ds_read_b128 v[84:87],v7 offset:12288
v_mfma_f32_16x16x32_bf16 v[44:47],a[164:167],v[112:115],v[44:47]
v_mfma_f32_16x16x32_bf16 v[60:63],v[112:115],v[164:167],v[60:63]
v_mfma_f32_16x16x32_bf16 v[28:31],a[36:39],v[112:115],v[28:31]
v_mfma_f32_16x16x32_bf16 v[48:51],a[172:175],v[108:111],v[48:51]
v_mfma_f32_16x16x32_bf16 v[64:67],v[108:111],v[172:175],v[64:67]
v_mfma_f32_16x16x32_bf16 v[32:35],a[44:47],v[108:111],v[32:35]
v_mfma_f32_16x16x32_bf16 v[52:55],a[172:175],v[112:115],v[52:55]
v_mfma_f32_16x16x32_bf16 v[68:71],v[112:115],v[172:175],v[68:71]
v_mfma_f32_16x16x32_bf16 v[36:39],a[44:47],v[112:115],v[36:39]
s_waitcnt vmcnt(10)
s_barrier
s_waitcnt lgkmcnt(2)
v_mfma_f32_16x16x32_bf16 v[40:43],a[176:179],v[72:75],v[40:43]
ds_read_b128 v[108:111],v4 offset:16384
v_mfma_f32_16x16x32_bf16 v[56:59],v[72:75],v[176:179],v[56:59]
v_mfma_f32_16x16x32_bf16 v[24:27],a[48:51],v[72:75],v[24:27]
ds_read_b128 v[112:115],v4 offset:20480
v_mfma_f32_16x16x32_bf16 v[44:47],a[176:179],v[76:79],v[44:47]
v_mfma_f32_16x16x32_bf16 v[60:63],v[76:79],v[176:179],v[60:63]
v_mfma_f32_16x16x32_bf16 v[28:31],a[48:51],v[76:79],v[28:31]
v_mfma_f32_16x16x32_bf16 v[48:51],a[184:187],v[72:75],v[48:51]
v_mfma_f32_16x16x32_bf16 v[64:67],v[72:75],v[184:187],v[64:67]
v_mfma_f32_16x16x32_bf16 v[32:35],a[56:59],v[72:75],v[32:35]
v_mfma_f32_16x16x32_bf16 v[52:55],a[184:187],v[76:79],v[52:55]
v_mfma_f32_16x16x32_bf16 v[68:71],v[76:79],v[184:187],v[68:71]
v_mfma_f32_16x16x32_bf16 v[36:39],a[56:59],v[76:79],v[36:39]
s_waitcnt vmcnt(2)
s_barrier
s_or_b32 s72,s72,s52
buffer_store_dword v17,off,s[8:11],s72 sc1
s_waitcnt lgkmcnt(2)
v_mfma_f32_16x16x32_bf16 v[40:43],a[180:183],v[80:83],v[40:43]
ds_read_b128 v[72:75],v5 offset:16384
v_mfma_f32_16x16x32_bf16 v[56:59],v[80:83],v[180:183],v[56:59]
v_mfma_f32_16x16x32_bf16 v[24:27],a[52:55],v[80:83],v[24:27]
ds_read_b128 v[76:79],v5 offset:20480
v_mfma_f32_16x16x32_bf16 v[44:47],a[180:183],v[84:87],v[44:47]
v_mfma_f32_16x16x32_bf16 v[60:63],v[84:87],v[180:183],v[60:63]
v_mfma_f32_16x16x32_bf16 v[28:31],a[52:55],v[84:87],v[28:31]
v_mfma_f32_16x16x32_bf16 v[48:51],a[188:191],v[80:83],v[48:51]
v_mfma_f32_16x16x32_bf16 v[64:67],v[80:83],v[188:191],v[64:67]
v_mfma_f32_16x16x32_bf16 v[32:35],a[60:63],v[80:83],v[32:35]
v_mfma_f32_16x16x32_bf16 v[52:55],a[188:191],v[84:87],v[52:55]
v_mfma_f32_16x16x32_bf16 v[68:71],v[84:87],v[188:191],v[68:71]
v_mfma_f32_16x16x32_bf16 v[36:39],a[60:63],v[84:87],v[36:39]
s_waitcnt lgkmcnt(2)
v_mfma_f32_16x16x32_bf16 v[40:43],a[192:195],v[108:111],v[40:43]
ds_read_b128 v[80:83],v6 offset:16384
v_mfma_f32_16x16x32_bf16 v[56:59],v[108:111],v[192:195],v[56:59]
v_mfma_f32_16x16x32_bf16 v[24:27],a[64:67],v[108:111],v[24:27]
ds_read_b128 v[84:87],v6 offset:20480
v_mfma_f32_16x16x32_bf16 v[44:47],a[192:195],v[112:115],v[44:47]
v_mfma_f32_16x16x32_bf16 v[60:63],v[112:115],v[192:195],v[60:63]
v_mfma_f32_16x16x32_bf16 v[28:31],a[64:67],v[112:115],v[28:31]
v_mfma_f32_16x16x32_bf16 v[48:51],a[200:203],v[108:111],v[48:51]
v_mfma_f32_16x16x32_bf16 v[64:67],v[108:111],v[200:203],v[64:67]
v_mfma_f32_16x16x32_bf16 v[32:35],a[72:75],v[108:111],v[32:35]
v_mfma_f32_16x16x32_bf16 v[52:55],a[200:203],v[112:115],v[52:55]
v_mfma_f32_16x16x32_bf16 v[68:71],v[112:115],v[200:203],v[68:71]
v_mfma_f32_16x16x32_bf16 v[36:39],a[72:75],v[112:115],v[36:39]
s_waitcnt lgkmcnt(2)
v_mfma_f32_16x16x32_bf16 v[40:43],a[196:199],v[72:75],v[40:43]
ds_read_b128 v[108:111],v7 offset:16384
v_mfma_f32_16x16x32_bf16 v[56:59],v[72:75],v[196:199],v[56:59]
v_mfma_f32_16x16x32_bf16 v[24:27],a[68:71],v[72:75],v[24:27]
ds_read_b128 v[112:115],v7 offset:20480
v_mfma_f32_16x16x32_bf16 v[44:47],a[196:199],v[76:79],v[44:47]
v_mfma_f32_16x16x32_bf16 v[60:63],v[76:79],v[196:199],v[60:63]
v_mfma_f32_16x16x32_bf16 v[28:31],a[68:71],v[76:79],v[28:31]
v_mfma_f32_16x16x32_bf16 v[48:51],a[204:207],v[72:75],v[48:51]
v_mfma_f32_16x16x32_bf16 v[64:67],v[72:75],v[204:207],v[64:67]
v_mfma_f32_16x16x32_bf16 v[32:35],a[76:79],v[72:75],v[32:35]
v_mfma_f32_16x16x32_bf16 v[52:55],a[204:207],v[76:79],v[52:55]
v_mfma_f32_16x16x32_bf16 v[68:71],v[76:79],v[204:207],v[68:71]
v_mfma_f32_16x16x32_bf16 v[36:39],a[76:79],v[76:79],v[36:39]
s_waitcnt vmcnt(1)
s_barrier
s_waitcnt lgkmcnt(2)
v_mfma_f32_16x16x32_bf16 v[40:43],a[208:211],v[80:83],v[40:43]
ds_read_b128 v[72:75],v4 offset:24576
v_mfma_f32_16x16x32_bf16 v[56:59],v[80:83],v[208:211],v[56:59]
v_mfma_f32_16x16x32_bf16 v[24:27],a[80:83],v[80:83],v[24:27]
ds_read_b128 v[76:79],v4 offset:28672
v_mfma_f32_16x16x32_bf16 v[44:47],a[208:211],v[84:87],v[44:47]
v_mfma_f32_16x16x32_bf16 v[60:63],v[84:87],v[208:211],v[60:63]
v_mfma_f32_16x16x32_bf16 v[28:31],a[80:83],v[84:87],v[28:31]
v_mfma_f32_16x16x32_bf16 v[48:51],a[216:219],v[80:83],v[48:51]
v_mfma_f32_16x16x32_bf16 v[64:67],v[80:83],v[216:219],v[64:67]
v_mfma_f32_16x16x32_bf16 v[32:35],a[88:91],v[80:83],v[32:35]
v_mfma_f32_16x16x32_bf16 v[52:55],a[216:219],v[84:87],v[52:55]
v_mfma_f32_16x16x32_bf16 v[68:71],v[84:87],v[216:219],v[68:71]
v_mfma_f32_16x16x32_bf16 v[36:39],a[88:91],v[84:87],v[36:39]
s_waitcnt lgkmcnt(2)
v_mfma_f32_16x16x32_bf16 v[40:43],a[212:215],v[108:111],v[40:43]
ds_read_b128 v[80:83],v5 offset:24576
v_mfma_f32_16x16x32_bf16 v[56:59],v[108:111],v[212:215],v[56:59]
v_mfma_f32_16x16x32_bf16 v[24:27],a[84:87],v[108:111],v[24:27]
ds_read_b128 v[84:87],v5 offset:28672
v_mfma_f32_16x16x32_bf16 v[44:47],a[212:215],v[112:115],v[44:47]
v_mfma_f32_16x16x32_bf16 v[60:63],v[112:115],v[212:215],v[60:63]
v_mfma_f32_16x16x32_bf16 v[28:31],a[84:87],v[112:115],v[28:31]
v_mfma_f32_16x16x32_bf16 v[48:51],a[220:223],v[108:111],v[48:51]
v_mfma_f32_16x16x32_bf16 v[64:67],v[108:111],v[220:223],v[64:67]
v_mfma_f32_16x16x32_bf16 v[32:35],a[92:95],v[108:111],v[32:35]
v_mfma_f32_16x16x32_bf16 v[52:55],a[220:223],v[112:115],v[52:55]
v_mfma_f32_16x16x32_bf16 v[68:71],v[112:115],v[220:223],v[68:71]
v_mfma_f32_16x16x32_bf16 v[36:39],a[92:95],v[112:115],v[36:39]
s_barrier
s_waitcnt lgkmcnt(2)
v_mfma_f32_16x16x32_bf16 v[40:43],a[224:227],v[72:75],v[40:43]
ds_read_b128 v[108:111],v6 offset:24576
v_mfma_f32_16x16x32_bf16 v[56:59],v[72:75],v[224:227],v[56:59]
s_add_u32 m0,s50,131072
v_mfma_f32_16x16x32_bf16 v[24:27],a[96:99],v[72:75],v[24:27]
ds_read_b128 v[112:115],v6 offset:28672
v_mfma_f32_16x16x32_bf16 v[44:47],a[224:227],v[76:79],v[44:47]
buffer_load_dwordx4 v20,s[8:11],s70 offen offset:0 sc1 lds
v_mfma_f32_16x16x32_bf16 v[60:63],v[76:79],v[224:227],v[60:63]
s_add_u32 m0,s50,135168
v_mfma_f32_16x16x32_bf16 v[28:31],a[96:99],v[76:79],v[28:31]
buffer_load_dwordx4 v20,s[8:11],s71 offen offset:0 sc1 lds
v_mfma_f32_16x16x32_bf16 v[48:51],a[232:235],v[72:75],v[48:51]
s_add_u32 m0,s50,139008
v_mfma_f32_16x16x32_bf16 v[64:67],v[72:75],v[232:235],v[64:67]
buffer_load_dwordx4 v20,s[8:11],s70 offen offset:256 sc1 lds
v_mfma_f32_16x16x32_bf16 v[32:35],a[104:107],v[72:75],v[32:35]
s_add_u32 m0,s50,143104
v_mfma_f32_16x16x32_bf16 v[52:55],a[232:235],v[76:79],v[52:55]
buffer_load_dwordx4 v20,s[8:11],s71 offen offset:256 sc1 lds
v_mfma_f32_16x16x32_bf16 v[68:71],v[76:79],v[232:235],v[68:71]
s_add_u32 m0,s50,146944
v_mfma_f32_16x16x32_bf16 v[36:39],a[104:107],v[76:79],v[36:39]
buffer_load_dwordx4 v20,s[8:11],s70 offen offset:512 sc1 lds
s_waitcnt lgkmcnt(2)
v_mfma_f32_16x16x32_bf16 v[40:43],a[228:231],v[80:83],v[40:43]
ds_read_b128 v[72:75],v7 offset:24576
v_mfma_f32_16x16x32_bf16 v[56:59],v[80:83],v[228:231],v[56:59]
s_add_u32 m0,s50,151040
v_mfma_f32_16x16x32_bf16 v[24:27],a[100:103],v[80:83],v[24:27]
ds_read_b128 v[76:79],v7 offset:28672
v_mfma_f32_16x16x32_bf16 v[44:47],a[228:231],v[84:87],v[44:47]
buffer_load_dwordx4 v20,s[8:11],s71 offen offset:512 sc1 lds
v_mfma_f32_16x16x32_bf16 v[60:63],v[84:87],v[228:231],v[60:63]
buffer_load_dwordx2 v[124:125],v23,s[8:11],s76 offen sc1
v_mfma_f32_16x16x32_bf16 v[28:31],a[100:103],v[84:87],v[28:31]
v_mfma_f32_16x16x32_bf16 v[48:51],a[236:239],v[80:83],v[48:51]
v_mfma_f32_16x16x32_bf16 v[64:67],v[80:83],v[236:239],v[64:67]
v_mfma_f32_16x16x32_bf16 v[32:35],a[108:111],v[80:83],v[32:35]
v_mfma_f32_16x16x32_bf16 v[52:55],a[236:239],v[84:87],v[52:55]
v_mfma_f32_16x16x32_bf16 v[68:71],v[84:87],v[236:239],v[68:71]
v_mfma_f32_16x16x32_bf16 v[36:39],a[108:111],v[84:87],v[36:39]
s_waitcnt lgkmcnt(2)
v_mfma_f32_16x16x32_bf16 v[40:43],a[240:243],v[108:111],v[40:43]
v_mfma_f32_16x16x32_bf16 v[56:59],v[108:111],v[240:243],v[56:59]
v_mfma_f32_16x16x32_bf16 v[24:27],a[112:115],v[108:111],v[24:27]
v_mfma_f32_16x16x32_bf16 v[44:47],a[240:243],v[112:115],v[44:47]
v_mfma_f32_16x16x32_bf16 v[60:63],v[112:115],v[240:243],v[60:63]
v_mfma_f32_16x16x32_bf16 v[28:31],a[112:115],v[112:115],v[28:31]
v_mfma_f32_16x16x32_bf16 v[48:51],a[248:251],v[108:111],v[48:51]
v_mfma_f32_16x16x32_bf16 v[64:67],v[108:111],v[248:251],v[64:67]
v_mfma_f32_16x16x32_bf16 v[32:35],a[120:123],v[108:111],v[32:35]
v_mfma_f32_16x16x32_bf16 v[52:55],a[248:251],v[112:115],v[52:55]
v_mfma_f32_16x16x32_bf16 v[68:71],v[112:115],v[248:251],v[68:71]
v_mfma_f32_16x16x32_bf16 v[36:39],a[120:123],v[112:115],v[36:39]
s_waitcnt lgkmcnt(0)
v_mfma_f32_16x16x32_bf16 v[40:43],a[244:247],v[72:75],v[40:43]
v_mfma_f32_16x16x32_bf16 v[56:59],v[72:75],v[244:247],v[56:59]
v_mfma_f32_16x16x32_bf16 v[24:27],a[116:119],v[72:75],v[24:27]
v_mfma_f32_16x16x32_bf16 v[44:47],a[244:247],v[76:79],v[44:47]
v_mfma_f32_16x16x32_bf16 v[60:63],v[76:79],v[244:247],v[60:63]
v_mfma_f32_16x16x32_bf16 v[28:31],a[116:119],v[76:79],v[28:31]
v_mfma_f32_16x16x32_bf16 v[48:51],a[252:255],v[72:75],v[48:51]
v_mfma_f32_16x16x32_bf16 v[64:67],v[72:75],v[252:255],v[64:67]
v_mfma_f32_16x16x32_bf16 v[32:35],a[124:127],v[72:75],v[32:35]
v_mfma_f32_16x16x32_bf16 v[52:55],a[252:255],v[76:79],v[52:55]
v_mfma_f32_16x16x32_bf16 v[68:71],v[76:79],v[252:255],v[68:71]
v_mfma_f32_16x16x32_bf16 v[36:39],a[124:127],v[76:79],v[36:39]
s_lshl_b32 s56,s51,5
s_add_u32 s56,s56,s47
s_lshl_b32 s56,s56,12
s_add_u32 s56,s56,s50
s_add_u32 s56,s56,41943040
v_mov_b64 v[120:121],-1
v_mov_b64 v[122:123],-1
buffer_store_dwordx4 v[120:123],v0,s[8:11],s56 offen sc1
v_cvt_pk_bf16_f32 v72,v40,v48
v_cvt_pk_bf16_f32 v73,v41,v49
v_cvt_pk_bf16_f32 v74,v42,v50
v_cvt_pk_bf16_f32 v75,v43,v51
buffer_store_dwordx4 v[72:75],v0,s[8:11],s61 offen sc1
v_cvt_pk_bf16_f32 v76,v44,v52
v_cvt_pk_bf16_f32 v77,v45,v53
v_cvt_pk_bf16_f32 v78,v46,v54
v_cvt_pk_bf16_f32 v79,v47,v55
buffer_store_dwordx4 v[76:79],v0,s[8:11],s62 offen sc1
v_cvt_pk_bf16_f32 v80,v56,v57
v_cvt_pk_bf16_f32 v81,v58,v59
v_cvt_pk_bf16_f32 v82,v60,v61
v_cvt_pk_bf16_f32 v83,v62,v63
buffer_store_dwordx4 v[80:83],v0,s[8:11],s65 offen offset:0 sc1
v_cvt_pk_bf16_f32 v84,v64,v65
v_cvt_pk_bf16_f32 v85,v66,v67
v_cvt_pk_bf16_f32 v86,v68,v69
v_cvt_pk_bf16_f32 v87,v70,v71
buffer_store_dwordx4 v[84:87],v0,s[8:11],s65 offen offset:1024 sc1
v_cvt_pk_bf16_f32 v108,v24,v32
v_cvt_pk_bf16_f32 v109,v25,v33
v_cvt_pk_bf16_f32 v110,v26,v34
v_cvt_pk_bf16_f32 v111,v27,v35
buffer_store_dwordx4 v[108:111],v0,s[8:11],s63 offen sc1
v_cvt_pk_bf16_f32 v112,v28,v36
v_cvt_pk_bf16_f32 v113,v29,v37
v_cvt_pk_bf16_f32 v114,v30,v38
v_cvt_pk_bf16_f32 v115,v31,v39
buffer_store_dwordx4 v[112:115],v0,s[8:11],s64 offen sc1
s_lshl_b32 s72,s51,13
s_lshl2_add_u32 s72,s47,s72
s_add_u32 s72,s72,10485760
s_sub_u32 s53,s53,1
s_cmp_gt_i32 s53,3
s_cbranch_scc1 L_mo_395
s_cmp_gt_i32 s53,0
s_cselect_b32 s87,1,3
s_mov_b32 s18,0
s_waitcnt vmcnt(7)
s_branch L_mo_400
L_mo_393:
s_mov_b32 s55,s22
s_mov_b32 s22,s23
s_mov_b32 s23,s24
s_mov_b32 s24,-1
v_mov_b32 v3,0
s_cmp_lg_u32 s55,-1
s_cbranch_scc1 L_mp_390
s_sub_u32 s56,s30,s31
s_cmp_gt_i32 s77,0
s_cselect_b32 s57,6,20
s_cmp_lg_u32 s86,0
s_cselect_b32 s57,9,s57
s_cmp_lt_i32 s56,s57
s_cbranch_scc1 L_mo_394
s_cmp_lt_i32 s56,30
s_cselect_b32 s87,s18,0
s_cmp_ge_u32 s31,8
s_cselect_b32 s56,1,s18
s_and_b32 s56,s56,s86
s_cselect_b32 s87,2,s87
s_mul_i32 s56,s87,s18
s_cmp_lg_u32 s56,0
s_cbranch_scc1 L_mo_398
s_mov_b32 s18,0
s_lshr_b32 s56,s72,31
s_or_b32 s56,s56,s87
s_cbranch_scc1 L_mo_404
s_waitcnt vmcnt(0)
s_barrier
s_or_b32 s72,s72,s52
buffer_store_dword v17,off,s[8:11],s72 sc1
s_mov_b32 s72,0x80000000
L_mo_404:
s_cmp_lg_u32 s46,0
s_cbranch_scc1 L_mo_402
s_lshl_b32 s76,s31,13
s_add_u32 s76,s76,10487040
s_lshl_b32 s57,s47,8
s_add_u32 s57,s57,s31
s_cmp_eq_u32 s57,63
s_mov_b32 s57,0x80000000
s_cmov_b32 s57,11018240
v_lshlrev_b32 v2,2,v1
L_mo_401:
buffer_load_dwordx2 v[124:125],v23,s[8:11],s76 offen sc1
buffer_load_dword v3,v2,s[8:11],s57 offen sc1
s_sub_u32 s49,s49,1
s_cbranch_scc1 L_abort2
s_waitcnt vmcnt(0)
L_mo_400:
v_min_u32 v123,v124,v125
v_max_u32 v125,v124,v125
v_cmp_eq_u32 vcc,0,v123
s_nop 1
v_cndmask_b32 v125,v125,-1,vcc
s_and_b32 s56,vcc_lo,0xffff
s_cbranch_scc0 L_mo_405
s_cmp_lg_u32 s87,0
s_cbranch_scc1 L_mo_405
s_mov_b32 s18,1
s_sleep 2
s_branch L_mo_401
L_mo_405:
v_max_u32_dpp v125,v125,v125 row_ror:8 row_mask:0xf bank_mask:0xf
s_nop 1
v_max_u32_dpp v125,v125,v125 row_ror:4 row_mask:0xf bank_mask:0xf
s_nop 1
v_max_u32_dpp v125,v125,v125 row_ror:2 row_mask:0xf bank_mask:0xf
s_nop 1
v_max_u32_dpp v125,v125,v125 row_ror:1 row_mask:0xf bank_mask:0xf
L_mo_402:
s_sub_u32 s49,s49,1
s_cbranch_scc1 L_abort2
v_mov_b32 v124,s18
s_barrier
s_cmp_lg_u32 s46,0
s_cbranch_scc1 L_mo_403
ds_write_b32 v16,v125
ds_write_b32 v19,v124 offset:16
s_waitcnt lgkmcnt(0)
L_mo_403:
s_barrier
ds_read_b128 v[120:123],v19
ds_read_b32 v124,v19 offset:16
s_waitcnt lgkmcnt(0)
v_readfirstlane_b32 s55,v120
v_readfirstlane_b32 s22,v121
v_readfirstlane_b32 s23,v122
v_readfirstlane_b32 s24,v123
v_readfirstlane_b32 s18,v124
s_cmp_lg_u32 s55,-1
s_cbranch_scc1 L_mp_390
L_mo_398:
s_mov_b32 s22,-1
s_cmp_eq_u32 s87,1
s_cbranch_scc1 L_mo_394
s_cmp_eq_u32 s87,2
s_cbranch_scc1 L_mo_399
s_branch L_mo_393
L_mp_390:
s_mov_b32 s53,0
s_sub_u32 s73,s73,1
s_max_i32 s73,s73,0
s_sub_u32 s77,s77,1
s_min_u32 s61,s73,2
s_cmp_lt_u32 s31,5
s_cselect_b32 s60,s25,0
s_cmp_lt_u32 s55,s60
s_cselect_b32 s61,2,s61
s_cmp_le_u32 s55,s54
s_cbranch_scc1 L_mr_391
s_mov_b32 s77,s61
s_mov_b32 s54,s55
s_mov_b32 s86,0
s_or_b32 s61,s47,s46
s_cbranch_scc1 L_mr_391
v_mov_b32 v120,s54
v_lshlrev_b32 v121,13,v1
s_mov_b32 s61,10486784
buffer_store_dword v120,v121,s[8:11],s61 offen sc1
L_mr_391:
s_cmp_lg_u32 s31,63
s_cbranch_scc1 L_mo_396
s_min_i32 s77,s77,0
s_or_b32 s61,s47,s46
s_cbranch_scc1 L_mo_396
s_mov_b32 s59,11018240
v_lshlrev_b32 v120,2,v1
v_mov_b32 v121,v3
v_cmp_eq_u32 vcc,0,v3
s_cbranch_vccz L_mg_392
L_fp_407:
s_sleep 0
buffer_load_dword v121,v120,s[8:11],s59 offen sc1
s_sub_u32 s49,s49,1
s_cbranch_scc1 L_abort2
s_waitcnt vmcnt(0)
v_cmp_eq_u32 vcc,0,v121
s_cbranch_vccnz L_fp_407
L_mg_392:
s_andn2_b32 s62,0x7ff,s54
v_lshl_or_b32 v121,s62,8,v121
s_add_u32 s59,s59,8192
buffer_store_dword v121,v120,s[8:11],s59 offen sc1
s_add_u32 s59,s59,8192
buffer_store_dword v121,v120,s[8:11],s59 offen sc1
s_add_u32 s59,s59,8192
buffer_store_dword v121,v120,s[8:11],s59 offen sc1
s_add_u32 s59,s59,8192
buffer_store_dword v121,v120,s[8:11],s59 offen sc1
s_add_u32 s59,s59,8192
buffer_store_dword v121,v120,s[8:11],s59 offen sc1
s_add_u32 s59,s59,8192
buffer_store_dword v121,v120,s[8:11],s59 offen sc1
L_mo_396:
s_add_u32 s31,s31,1
s_cmp_gt_i32 s77,0
s_cmov_b32 s18,0
s_cbranch_scc1 L_mo_393
s_cmp_lg_u32 s77,0
s_cbranch_scc1 L_mo_397
s_andn2_b32 s51,0x7ff,s54
s_lshr_b32 s51,s51,5
s_add_u32 s73,s73,2
s_mov_b32 s86,1
s_mov_b32 s19,0
s_mov_b32 s18,0
s_waitcnt vmcnt(8)
s_barrier
s_andn2_b32 s64,0x7ff,s54
s_lshl_b32 s56,s64,10
s_add_u32 s58,s56,4194304
buffer_load_dwordx4 v[88:91],v0,s[8:11],s58 offen sc1
v_and_b32 v9,15,v1
v_lshrrev_b32 v10,4,v1
v_and_b32 v124,1,v1
v_lshlrev_b32 v124,4,v124
v_mov_b32 v125,0xffff
v_lshlrev_b32 v125,v124,v125
v_lshrrev_b32 v124,2,v9
v_cmp_eq_u32 vcc,0,v124
s_nop 1
v_cndmask_b32 v12,0,v125,vcc
v_cmp_eq_u32 vcc,1,v124
s_nop 1
v_cndmask_b32 v13,0,v125,vcc
v_and_b32 v124,2,v1
v_cmp_eq_u32 vcc,0,v124
v_mov_b32 v14,0xeeee
v_mov_b32 v124,0x4444
v_cndmask_b32 v14,v14,v124,vcc
v_lshlrev_b32 v11,14,v10
v_lshl_add_u32 v11,v9,4,v11
s_lshl_b32 s65,s51,15
s_add_u32 s65,s65,92274688
s_lshl_b32 s62,s47,10
s_add_u32 s62,s62,s65
s_lshl_b32 s63,s47,16
s_lshl_b32 s60,s46,8
s_add_u32 s63,s63,s60
s_mov_b32 s4,s38
s_mov_b32 s5,s39
s_mov_b32 s6,1835008
s_mov_b32 s7,0x20000
s_lshl_b32 s57,s46,11
s_add_u32 s57,s57,139264
v_add_u32 v8,s57,v0
v_and_b32 v2,1,v10
v_lshrrev_b32 v3,1,v10
v_lshlrev_b32 v2,7,v2
v_lshl_add_u32 v2,v3,10,v2
s_lshl_b32 s59,s46,8
s_add_u32 s59,s57,s59
v_add_u32 v2,s59,v2
s_mov_b32 s60,0x01000100
s_mov_b32 s61,0x03020302
s_waitcnt vmcnt(0)
L_mx_408:
v_max3_u32 v124,v88,v89,v90
v_max_u32 v124,v91,v124
v_cmp_eq_u32 vcc,-1,v124
s_cbranch_vccz L_mxd_409
buffer_load_dwordx4 v[88:91],v0,s[8:11],s58 offen sc1
s_sub_u32 s49,s49,1
s_cbranch_scc1 L_abort2
s_waitcnt vmcnt(0)
s_branch L_mx_408
L_mxd_409:
buffer_load_dwordx4 v[24:27],v11,s[4:7],s63 offen offset:0
buffer_load_dwordx4 v[28:31],v11,s[4:7],s63 offen offset:1024
buffer_load_dwordx4 v[32:35],v11,s[4:7],s63 offen offset:2048
buffer_load_dwordx4 v[36:39],v11,s[4:7],s63 offen offset:3072
v_lshlrev_b32 v96,16,v88
v_and_b32 v97,0xffff0000,v88
v_lshlrev_b32 v98,16,v89
v_and_b32 v99,0xffff0000,v89
v_lshlrev_b32 v100,16,v90
v_and_b32 v101,0xffff0000,v90
v_lshlrev_b32 v102,16,v91
v_and_b32 v103,0xffff0000,v91
v_readfirstlane_b32 s78,v96
s_nop 1
v_pk_add_f32 v[108:109],v[96:97],s[78:79] op_sel_hi:[1,0] neg_lo:[0,1] neg_hi:[0,1]
v_pk_add_f32 v[110:111],v[98:99],s[78:79] op_sel_hi:[1,0] neg_lo:[0,1] neg_hi:[0,1]
v_pk_add_f32 v[112:113],v[100:101],s[78:79] op_sel_hi:[1,0] neg_lo:[0,1] neg_hi:[0,1]
v_pk_add_f32 v[114:115],v[102:103],s[78:79] op_sel_hi:[1,0] neg_lo:[0,1] neg_hi:[0,1]
v_pk_add_f32 v[116:117],v[108:109],v[110:111]
v_pk_mul_f32 v[118:119],v[108:109],v[108:109]
v_pk_add_f32 v[120:121],v[112:113],v[114:115]
v_pk_fma_f32 v[118:119],v[110:111],v[110:111],v[118:119]
v_pk_add_f32 v[116:117],v[116:117],v[120:121]
v_pk_fma_f32 v[118:119],v[112:113],v[112:113],v[118:119]
v_add_f32 v116,v116,v117
v_pk_fma_f32 v[118:119],v[114:115],v[114:115],v[118:119]
v_add_f32 v118,v118,v119
s_nop 1
v_permlane32_swap_b32 v116,v118
v_add_f32 v116,v116,v118
s_nop 1
v_add_f32_dpp v116,v116,v116 row_ror:8 row_mask:0xf bank_mask:0xf
s_nop 1
v_add_f32_dpp v116,v116,v116 row_ror:4 row_mask:0xf bank_mask:0xf
s_nop 1
v_add_f32_dpp v116,v116,v116 row_ror:2 row_mask:0xf bank_mask:0xf
s_nop 1
v_add_f32_dpp v116,v116,v116 row_ror:1 row_mask:0xf bank_mask:0xf
v_mov_b32 v118,v116
s_nop 1
v_permlane16_swap_b32 v116,v118
v_add_f32 v116,v116,v118
v_mul_f32 v116,0x3b000000,v116
v_mov_b32 v118,v116
s_nop 1
v_permlane32_swap_b32 v116,v118
v_fma_f32 v118,-v116,v116,v118
v_add_f32 v116,s78,v116
v_max_f32 v118,0,v118
v_cvt_pk_bf16_f32 v118,v116,v118
v_lshlrev_b32 v116,16,v118
v_and_b32 v118,0xffff0000,v118
v_add_f32 v118,0x3727c5ac,v118
v_cvt_pk_bf16_f32 v118,v118,v118
v_and_b32 v118,0xffff0000,v118
v_sqrt_f32 v118,v118
v_pk_add_f32 v[108:109],v[96:97],v[116:117] op_sel_hi:[1,0] neg_lo:[0,1] neg_hi:[0,1]
v_pk_add_f32 v[110:111],v[98:99],v[116:117] op_sel_hi:[1,0] neg_lo:[0,1] neg_hi:[0,1]
v_pk_add_f32 v[112:113],v[100:101],v[116:117] op_sel_hi:[1,0] neg_lo:[0,1] neg_hi:[0,1]
v_pk_add_f32 v[114:115],v[102:103],v[116:117] op_sel_hi:[1,0] neg_lo:[0,1] neg_hi:[0,1]
v_cvt_pk_bf16_f32 v118,v118,v118
v_and_b32 v118,0xffff0000,v118
v_rcp_f32 v118,v118
v_cvt_pk_bf16_f32 v104,v108,v109
v_cvt_pk_bf16_f32 v105,v110,v111
v_cvt_pk_bf16_f32 v106,v112,v113
v_cvt_pk_bf16_f32 v107,v114,v115
v_lshlrev_b32 v108,16,v104
v_and_b32 v109,0xffff0000,v104
v_lshlrev_b32 v110,16,v105
v_and_b32 v111,0xffff0000,v105
v_lshlrev_b32 v112,16,v106
v_and_b32 v113,0xffff0000,v106
v_lshlrev_b32 v114,16,v107
v_and_b32 v115,0xffff0000,v107
v_pk_mul_f32 v[108:109],v[108:109],v[118:119] op_sel_hi:[1,0]
v_pk_mul_f32 v[110:111],v[110:111],v[118:119] op_sel_hi:[1,0]
v_pk_mul_f32 v[112:113],v[112:113],v[118:119] op_sel_hi:[1,0]
v_pk_mul_f32 v[114:115],v[114:115],v[118:119] op_sel_hi:[1,0]
v_cvt_pk_bf16_f32 v104,v108,v109
v_cvt_pk_bf16_f32 v105,v110,v111
v_cvt_pk_bf16_f32 v106,v112,v113
v_cvt_pk_bf16_f32 v107,v114,v115
v_perm_b32 v88,v104,v104,s60
v_perm_b32 v89,v105,v105,s60
v_perm_b32 v90,v106,v106,s60
v_perm_b32 v91,v107,v107,s60
ds_write_b128 v8,v[88:91]
v_perm_b32 v92,v104,v104,s61
v_perm_b32 v93,v105,v105,s61
v_perm_b32 v94,v106,v106,s61
v_perm_b32 v95,v107,v107,s61
ds_write_b128 v8,v[92:95] offset:1024
s_mov_b32 s58,s57
ds_read_b128 v[88:91],v2 offset:0
ds_read_b128 v[92:95],v2 offset:64
ds_read_b128 v[108:111],v18 offset:0
ds_read_b128 v[112:115],v18 offset:1024
ds_read_b128 v[64:67],v18 offset:2048
ds_read_b128 v[68:71],v18 offset:3072
ds_read_b128 v[72:75],v18 offset:4096
ds_read_b128 v[76:79],v18 offset:5120
ds_read_b128 v[80:83],v18 offset:6144
ds_read_b128 v[84:87],v18 offset:7168
v_mov_b64 v[116:117],0
v_mov_b64 v[118:119],0
s_waitcnt lgkmcnt(8)
v_and_b32 v120,v12,v88
v_and_b32 v121,v13,v88
v_and_b32 v122,v12,v92
v_and_b32 v123,v13,v92
s_waitcnt lgkmcnt(6)
s_nop 0
v_smfmac_f32_16x16x64_bf16 v[116:119],v[120:123],v[108:115],v14
ds_read_b128 v[108:111],v18 offset:8192
ds_read_b128 v[112:115],v18 offset:9216
s_add_u32 s63,s63,4096
buffer_load_dwordx4 v[40:43],v11,s[4:7],s63 offen offset:0
v_and_b32 v124,v12,v89
v_and_b32 v125,v13,v89
v_and_b32 v126,v12,v93
v_and_b32 v127,v13,v93
s_waitcnt lgkmcnt(6)
s_nop 0
v_smfmac_f32_16x16x64_bf16 v[116:119],v[124:127],v[64:71],v14
ds_read_b128 v[64:67],v18 offset:10240
ds_read_b128 v[68:71],v18 offset:11264
buffer_load_dwordx4 v[44:47],v11,s[4:7],s63 offen offset:1024
v_and_b32 v120,v12,v90
v_and_b32 v121,v13,v90
v_and_b32 v122,v12,v94
v_and_b32 v123,v13,v94
s_waitcnt lgkmcnt(6)
s_nop 0
v_smfmac_f32_16x16x64_bf16 v[116:119],v[120:123],v[72:79],v14
ds_read_b128 v[72:75],v18 offset:12288
ds_read_b128 v[76:79],v18 offset:13312
buffer_load_dwordx4 v[48:51],v11,s[4:7],s63 offen offset:2048
v_and_b32 v124,v12,v91
v_and_b32 v125,v13,v91
v_and_b32 v126,v12,v95
v_and_b32 v127,v13,v95
ds_read_b128 v[88:91],v2 offset:16
ds_read_b128 v[92:95],v2 offset:80
s_waitcnt lgkmcnt(8)
v_smfmac_f32_16x16x64_bf16 v[116:119],v[124:127],v[80:87],v14
ds_read_b128 v[80:83],v18 offset:14336
ds_read_b128 v[84:87],v18 offset:15360
buffer_load_dwordx4 v[52:55],v11,s[4:7],s63 offen offset:3072
s_waitcnt lgkmcnt(2)
v_and_b32 v120,v12,v88
v_and_b32 v121,v13,v88
v_and_b32 v122,v12,v92
v_and_b32 v123,v13,v92
s_waitcnt lgkmcnt(8)
s_nop 0
v_smfmac_f32_16x16x64_bf16 v[116:119],v[120:123],v[108:115],v14
ds_read_b128 v[108:111],v18 offset:16384
ds_read_b128 v[112:115],v18 offset:17408
s_add_u32 s63,s63,4096
buffer_load_dwordx4 v[56:59],v11,s[4:7],s63 offen offset:0
v_and_b32 v124,v12,v89
v_and_b32 v125,v13,v89
v_and_b32 v126,v12,v93
v_and_b32 v127,v13,v93
s_waitcnt lgkmcnt(8)
s_nop 0
v_smfmac_f32_16x16x64_bf16 v[116:119],v[124:127],v[64:71],v14
ds_read_b128 v[64:67],v18 offset:18432
ds_read_b128 v[68:71],v18 offset:19456
buffer_load_dwordx4 v[60:63],v11,s[4:7],s63 offen offset:1024
v_and_b32 v120,v12,v90
v_and_b32 v121,v13,v90
v_and_b32 v122,v12,v94
v_and_b32 v123,v13,v94
s_waitcnt lgkmcnt(8)
s_nop 0
v_smfmac_f32_16x16x64_bf16 v[116:119],v[120:123],v[72:79],v14
ds_read_b128 v[72:75],v18 offset:20480
ds_read_b128 v[76:79],v18 offset:21504
v_and_b32 v124,v12,v91
v_and_b32 v125,v13,v91
v_and_b32 v126,v12,v95
v_and_b32 v127,v13,v95
ds_read_b128 v[88:91],v2 offset:32
ds_read_b128 v[92:95],v2 offset:96
s_waitcnt lgkmcnt(8)
v_smfmac_f32_16x16x64_bf16 v[116:119],v[124:127],v[80:87],v14
ds_read_b128 v[80:83],v18 offset:22528
ds_read_b128 v[84:87],v18 offset:23552
s_waitcnt lgkmcnt(2)
v_and_b32 v120,v12,v88
v_and_b32 v121,v13,v88
v_and_b32 v122,v12,v92
v_and_b32 v123,v13,v92
s_waitcnt lgkmcnt(8)
s_nop 0
v_smfmac_f32_16x16x64_bf16 v[116:119],v[120:123],v[108:115],v14
ds_read_b128 v[108:111],v18 offset:24576
ds_read_b128 v[112:115],v18 offset:25600
v_and_b32 v124,v12,v89
v_and_b32 v125,v13,v89
v_and_b32 v126,v12,v93
v_and_b32 v127,v13,v93
s_waitcnt lgkmcnt(8)
s_nop 0
v_smfmac_f32_16x16x64_bf16 v[116:119],v[124:127],v[64:71],v14
ds_read_b128 v[64:67],v18 offset:26624
ds_read_b128 v[68:71],v18 offset:27648
v_and_b32 v120,v12,v90
v_and_b32 v121,v13,v90
v_and_b32 v122,v12,v94
v_and_b32 v123,v13,v94
s_waitcnt lgkmcnt(8)
s_nop 0
v_smfmac_f32_16x16x64_bf16 v[116:119],v[120:123],v[72:79],v14
ds_read_b128 v[72:75],v18 offset:28672
ds_read_b128 v[76:79],v18 offset:29696
v_and_b32 v124,v12,v91
v_and_b32 v125,v13,v91
v_and_b32 v126,v12,v95
v_and_b32 v127,v13,v95
ds_read_b128 v[88:91],v2 offset:48
ds_read_b128 v[92:95],v2 offset:112
s_waitcnt lgkmcnt(8)
v_smfmac_f32_16x16x64_bf16 v[116:119],v[124:127],v[80:87],v14
ds_read_b128 v[80:83],v18 offset:30720
ds_read_b128 v[84:87],v18 offset:31744
s_waitcnt lgkmcnt(2)
v_and_b32 v120,v12,v88
v_and_b32 v121,v13,v88
v_and_b32 v122,v12,v92
v_and_b32 v123,v13,v92
s_waitcnt lgkmcnt(8)
s_nop 0
v_smfmac_f32_16x16x64_bf16 v[116:119],v[120:123],v[108:115],v14
v_and_b32 v124,v12,v89
v_and_b32 v125,v13,v89
v_and_b32 v126,v12,v93
v_and_b32 v127,v13,v93
s_waitcnt lgkmcnt(6)
s_nop 0
v_smfmac_f32_16x16x64_bf16 v[116:119],v[124:127],v[64:71],v14
buffer_load_dwordx4 v[64:67],v11,s[4:7],s63 offen offset:2048
buffer_load_dwordx4 v[68:71],v11,s[4:7],s63 offen offset:3072
v_and_b32 v120,v12,v90
v_and_b32 v121,v13,v90
v_and_b32 v122,v12,v94
v_and_b32 v123,v13,v94
s_waitcnt lgkmcnt(4)
s_nop 0
v_smfmac_f32_16x16x64_bf16 v[116:119],v[120:123],v[72:79],v14
s_add_u32 s63,s63,4096
buffer_load_dwordx4 v[72:75],v11,s[4:7],s63 offen offset:0
buffer_load_dwordx4 v[76:79],v11,s[4:7],s63 offen offset:1024
v_and_b32 v124,v12,v91
v_and_b32 v125,v13,v91
v_and_b32 v126,v12,v95
v_and_b32 v127,v13,v95
s_waitcnt lgkmcnt(0)
s_nop 0
v_smfmac_f32_16x16x64_bf16 v[116:119],v[124:127],v[80:87],v14
buffer_load_dwordx4 v[80:83],v11,s[4:7],s63 offen offset:2048
buffer_load_dwordx4 v[84:87],v11,s[4:7],s63 offen offset:3072
v_lshlrev_b32 v8,5,v9
v_and_b32 v124,1,v10
v_lshl_add_u32 v8,v124,4,v8
v_lshrrev_b32 v124,1,v10
v_lshl_add_u32 v8,v124,11,v8
s_lshl_b32 s60,s46,9
s_add_u32 s60,s60,147456
v_add_u32 v8,s60,v8
ds_write_b128 v8,v[116:119]
v_lshlrev_b32 v8,2,v1
v_add_u32 v8,147456,v8
v_and_b32 v2,1,v1
v_lshrrev_b32 v3,1,v1
v_lshlrev_b32 v3,2,v3
v_lshl_add_u32 v2,v2,7,v3
v_add_u32 v2,s58,v2
v_lshlrev_b32 v3,6,v10
v_add_u32 v3,s58,v3
s_waitcnt lgkmcnt(0)
s_barrier
ds_read2st64_b32 v[88:89],v8 offset0:0 offset1:1
ds_read2st64_b32 v[90:91],v8 offset0:2 offset1:3
ds_read2st64_b32 v[92:93],v8 offset0:4 offset1:5
ds_read2st64_b32 v[94:95],v8 offset0:6 offset1:7
s_waitcnt lgkmcnt(0)
v_pk_add_f32 v[88:89],v[88:89],v[90:91]
v_pk_add_f32 v[92:93],v[92:93],v[94:95]
v_pk_add_f32 v[88:89],v[88:89],v[92:93]
v_cvt_pk_bf16_f32 v88,v88,v88
v_and_b32 v88,0xffff0000,v88
v_cvt_pk_bf16_f32 v89,v89,v89
v_and_b32 v89,0xffff0000,v89
v_mul_f32 v90,0xbfb8aa3b,v88
v_exp_f32 v90,v90
s_nop 0
v_add_f32 v90,1.0,v90
v_rcp_f32 v90,v90
s_nop 0
v_mul_f32 v88,v88,v90
v_cvt_pk_bf16_f32 v88,v88,v88
v_and_b32 v88,0xffff0000,v88
v_mul_f32 v88,v88,v89
v_cvt_pk_bf16_f32 v88,v88,v88
ds_write_b32 v2,v88
ds_read_b128 v[88:91],v3
ds_read_b128 v[108:111],v3 offset:32
ds_read_b128 v[92:95],v3 offset:16
ds_read_b128 v[112:115],v3 offset:48
v_mov_b64 v[116:117],0
v_mov_b64 v[118:119],0
s_waitcnt vmcnt(0) lgkmcnt(0)
v_and_b32 v120,v12,v88
v_and_b32 v121,v13,v88
v_and_b32 v122,v12,v108
v_and_b32 v123,v13,v108
v_and_b32 v124,v12,v89
v_and_b32 v125,v13,v89
v_smfmac_f32_16x16x64_bf16 v[116:119],v[120:123],v[24:31],v14
v_and_b32 v126,v12,v109
v_and_b32 v127,v13,v109
v_and_b32 v120,v12,v90
v_and_b32 v121,v13,v90
v_smfmac_f32_16x16x64_bf16 v[116:119],v[124:127],v[32:39],v14
v_and_b32 v122,v12,v110
v_and_b32 v123,v13,v110
v_and_b32 v124,v12,v91
v_and_b32 v125,v13,v91
v_smfmac_f32_16x16x64_bf16 v[116:119],v[120:123],v[40:47],v14
v_and_b32 v126,v12,v111
v_and_b32 v127,v13,v111
v_and_b32 v120,v12,v92
v_and_b32 v121,v13,v92
v_smfmac_f32_16x16x64_bf16 v[116:119],v[124:127],v[48:55],v14
v_and_b32 v122,v12,v112
v_and_b32 v123,v13,v112
v_and_b32 v124,v12,v93
v_and_b32 v125,v13,v93
v_smfmac_f32_16x16x64_bf16 v[116:119],v[120:123],v[56:63],v14
v_and_b32 v126,v12,v113
v_and_b32 v127,v13,v113
v_and_b32 v120,v12,v94
v_and_b32 v121,v13,v94
v_smfmac_f32_16x16x64_bf16 v[116:119],v[124:127],v[64:71],v14
v_and_b32 v122,v12,v114
v_and_b32 v123,v13,v114
v_and_b32 v124,v12,v95
v_and_b32 v125,v13,v95
v_smfmac_f32_16x16x64_bf16 v[116:119],v[120:123],v[72:79],v14
v_and_b32 v126,v12,v115
v_and_b32 v127,v13,v115
s_nop 1
v_smfmac_f32_16x16x64_bf16 v[116:119],v[124:127],v[80:87],v14
v_lshlrev_b32 v8,4,v9
v_and_b32 v124,1,v10
v_lshl_add_u32 v8,v124,3,v8
v_and_b32 v124,2,v10
v_lshl_add_u32 v8,v124,30,v8
s_lshl_b32 s60,s46,8
s_add_u32 s59,s62,s60
s_nop 0
v_cvt_pk_bf16_f32 v88,v116,v117
v_cvt_pk_bf16_f32 v89,v118,v119
buffer_store_dwordx2 v[88:89],v8,s[8:11],s59 offen sc1
s_lshl_b32 s59,s51,13
s_lshl2_add_u32 s59,s47,s59
s_add_u32 s59,s59,10486912
s_waitcnt vmcnt(0)
s_barrier
s_or_b32 s59,s59,s52
buffer_store_dword v17,off,s[8:11],s59 sc1
s_lshl_b32 s59,s51,13
s_add_u32 s59,s59,10486912
v_and_b32 v124,31,v1
v_lshlrev_b32 v124,2,v124
L_fw_411:
buffer_load_dword v125,v124,s[8:11],s59 offen sc1
s_sub_u32 s49,s49,1
s_cbranch_scc1 L_abort2
s_waitcnt vmcnt(0)
v_cmp_eq_u32 vcc,0,v125
s_cbranch_vccnz L_fw_411
s_add_u32 s63,s65,0
buffer_load_dwordx4 v[24:27],v22,s[8:11],s63 offen sc1
s_add_u32 s63,s65,4096
buffer_load_dwordx4 v[28:31],v22,s[8:11],s63 offen sc1
s_add_u32 s63,s65,8192
buffer_load_dwordx4 v[32:35],v22,s[8:11],s63 offen sc1
s_add_u32 s63,s65,12288
buffer_load_dwordx4 v[36:39],v22,s[8:11],s63 offen sc1
s_add_u32 s63,s65,16384
buffer_load_dwordx4 v[40:43],v22,s[8:11],s63 offen sc1
s_add_u32 s63,s65,20480
buffer_load_dwordx4 v[44:47],v22,s[8:11],s63 offen sc1
s_add_u32 s63,s65,24576
buffer_load_dwordx4 v[48:51],v22,s[8:11],s63 offen sc1
s_add_u32 s63,s65,28672
buffer_load_dwordx4 v[52:55],v22,s[8:11],s63 offen sc1
v_and_b32 v64,15,v1
v_and_b32 v65,1,v1
v_lshlrev_b32 v65,4,v65
v_mov_b32 v66,0x3f80
v_lshlrev_b32 v66,v65,v66
v_lshrrev_b32 v64,1,v64
v_cmp_eq_u32 vcc,0,v64
s_nop 1
v_cndmask_b32 v56,0,v66,vcc
v_cmp_eq_u32 vcc,1,v64
s_nop 1
v_cndmask_b32 v57,0,v66,vcc
v_cmp_eq_u32 vcc,2,v64
s_nop 1
v_cndmask_b32 v58,0,v66,vcc
v_cmp_eq_u32 vcc,3,v64
s_nop 1
v_cndmask_b32 v59,0,v66,vcc
s_waitcnt vmcnt(7)
s_nop 0
v_mfma_f32_16x16x32_bf16 v[60:63],v[56:59],v[24:27],0
s_waitcnt vmcnt(6)
v_mfma_f32_16x16x32_bf16 v[60:63],v[56:59],v[28:31],v[60:63]
s_waitcnt vmcnt(5)
v_mfma_f32_16x16x32_bf16 v[60:63],v[56:59],v[32:35],v[60:63]
s_waitcnt vmcnt(4)
v_mfma_f32_16x16x32_bf16 v[60:63],v[56:59],v[36:39],v[60:63]
s_waitcnt vmcnt(3)
v_mfma_f32_16x16x32_bf16 v[60:63],v[56:59],v[40:43],v[60:63]
s_waitcnt vmcnt(2)
v_mfma_f32_16x16x32_bf16 v[60:63],v[56:59],v[44:47],v[60:63]
s_waitcnt vmcnt(1)
v_mfma_f32_16x16x32_bf16 v[60:63],v[56:59],v[48:51],v[60:63]
s_waitcnt vmcnt(0)
v_mfma_f32_16x16x32_bf16 v[60:63],v[56:59],v[52:55],v[60:63]
s_nop 7
ds_write_b128 v21,v[60:63]
s_waitcnt lgkmcnt(0)
s_barrier
s_cmp_lg_u32 s46,0
s_cbranch_scc1 L_moed_410
v_lshlrev_b32 v56,5,v1
v_add_u32 v56,155648,v56
ds_read_b128 v[24:27],v56
ds_read_b128 v[28:31],v56 offset:16
s_and_b32 s59,s54,0xffff0000
s_xor_b32 s60,s59,0x80000000
s_xor_b32 s61,s59,0xffff0000
s_cmp_lt_i32 s59,0
s_cselect_b32 s59,s60,s61
v_mov_b32 v56,s59
v_mul_f32 v56,0xbfb8aa3b,v56
v_exp_f32 v56,v56
s_nop 0
v_add_f32 v56,1.0,v56
v_rcp_f32 v56,v56
s_nop 0
v_cvt_pk_bf16_f32 v56,v56,v56
v_and_b32 v56,0xffff0000,v56
v_lshlrev_b32 v48,16,v104
v_and_b32 v49,0xffff0000,v104
v_lshlrev_b32 v50,16,v105
v_and_b32 v51,0xffff0000,v105
v_lshlrev_b32 v52,16,v106
v_and_b32 v53,0xffff0000,v106
v_lshlrev_b32 v54,16,v107
v_and_b32 v55,0xffff0000,v107
s_waitcnt lgkmcnt(0)
v_cvt_pk_bf16_f32 v40,v24,v25
v_cvt_pk_bf16_f32 v41,v26,v27
v_cvt_pk_bf16_f32 v42,v28,v29
v_cvt_pk_bf16_f32 v43,v30,v31
v_lshlrev_b32 v24,16,v40
v_and_b32 v25,0xffff0000,v40
v_lshlrev_b32 v26,16,v41
v_and_b32 v27,0xffff0000,v41
v_lshlrev_b32 v28,16,v42
v_and_b32 v29,0xffff0000,v42
v_lshlrev_b32 v30,16,v43
v_and_b32 v31,0xffff0000,v43
v_pk_mul_f32 v[24:25],v[24:25],v[56:57] op_sel_hi:[1,0]
v_pk_mul_f32 v[26:27],v[26:27],v[56:57] op_sel_hi:[1,0]
v_pk_mul_f32 v[28:29],v[28:29],v[56:57] op_sel_hi:[1,0]
v_pk_mul_f32 v[30:31],v[30:31],v[56:57] op_sel_hi:[1,0]
v_cvt_pk_bf16_f32 v40,v24,v25
v_cvt_pk_bf16_f32 v41,v26,v27
v_cvt_pk_bf16_f32 v42,v28,v29
v_cvt_pk_bf16_f32 v43,v30,v31
v_lshlrev_b32 v24,16,v40
v_and_b32 v25,0xffff0000,v40
v_lshlrev_b32 v26,16,v41
v_and_b32 v27,0xffff0000,v41
v_lshlrev_b32 v28,16,v42
v_and_b32 v29,0xffff0000,v42
v_lshlrev_b32 v30,16,v43
v_and_b32 v31,0xffff0000,v43
v_pk_add_f32 v[24:25],v[24:25],v[48:49]
v_pk_add_f32 v[26:27],v[26:27],v[50:51]
v_pk_add_f32 v[28:29],v[28:29],v[52:53]
v_pk_add_f32 v[30:31],v[30:31],v[54:55]
v_cvt_pk_bf16_f32 v40,v24,v25
v_cvt_pk_bf16_f32 v41,v26,v27
v_cvt_pk_bf16_f32 v42,v28,v29
v_cvt_pk_bf16_f32 v43,v30,v31
v_lshlrev_b32 v24,16,v40
v_and_b32 v25,0xffff0000,v40
v_lshlrev_b32 v26,16,v41
v_and_b32 v27,0xffff0000,v41
v_lshlrev_b32 v28,16,v42
v_and_b32 v29,0xffff0000,v42
v_lshlrev_b32 v30,16,v43
v_and_b32 v31,0xffff0000,v43
v_pk_add_f32 v[96:97],v[96:97],v[24:25]
v_pk_add_f32 v[98:99],v[98:99],v[26:27]
v_pk_add_f32 v[100:101],v[100:101],v[28:29]
v_pk_add_f32 v[102:103],v[102:103],v[30:31]
v_cvt_pk_bf16_f32 v80,v96,v97
v_cvt_pk_bf16_f32 v81,v98,v99
v_cvt_pk_bf16_f32 v82,v100,v101
v_cvt_pk_bf16_f32 v83,v102,v103
v_lshlrev_b32 v96,16,v80
v_and_b32 v97,0xffff0000,v80
v_lshlrev_b32 v98,16,v81
v_and_b32 v99,0xffff0000,v81
v_lshlrev_b32 v100,16,v82
v_and_b32 v101,0xffff0000,v82
v_lshlrev_b32 v102,16,v83
v_and_b32 v103,0xffff0000,v83
v_readfirstlane_b32 s78,v96
s_nop 1
v_pk_add_f32 v[58:59],v[96:97],s[78:79] op_sel_hi:[1,0] neg_lo:[0,1] neg_hi:[0,1]
v_pk_add_f32 v[60:61],v[98:99],s[78:79] op_sel_hi:[1,0] neg_lo:[0,1] neg_hi:[0,1]
v_pk_add_f32 v[62:63],v[100:101],s[78:79] op_sel_hi:[1,0] neg_lo:[0,1] neg_hi:[0,1]
v_pk_add_f32 v[64:65],v[102:103],s[78:79] op_sel_hi:[1,0] neg_lo:[0,1] neg_hi:[0,1]
v_pk_add_f32 v[66:67],v[58:59],v[60:61]
v_pk_mul_f32 v[68:69],v[58:59],v[58:59]
v_pk_add_f32 v[70:71],v[62:63],v[64:65]
v_pk_fma_f32 v[68:69],v[60:61],v[60:61],v[68:69]
v_pk_add_f32 v[66:67],v[66:67],v[70:71]
v_pk_fma_f32 v[68:69],v[62:63],v[62:63],v[68:69]
v_add_f32 v66,v66,v67
v_pk_fma_f32 v[68:69],v[64:65],v[64:65],v[68:69]
v_add_f32 v68,v68,v69
s_nop 1
v_permlane32_swap_b32 v66,v68
v_add_f32 v66,v66,v68
s_nop 1
v_add_f32_dpp v66,v66,v66 row_ror:8 row_mask:0xf bank_mask:0xf
s_nop 1
v_add_f32_dpp v66,v66,v66 row_ror:4 row_mask:0xf bank_mask:0xf
s_nop 1
v_add_f32_dpp v66,v66,v66 row_ror:2 row_mask:0xf bank_mask:0xf
s_nop 1
v_add_f32_dpp v66,v66,v66 row_ror:1 row_mask:0xf bank_mask:0xf
v_mov_b32 v68,v66
s_nop 1
v_permlane16_swap_b32 v66,v68
v_add_f32 v66,v66,v68
v_mul_f32 v66,0x3b000000,v66
v_mov_b32 v68,v66
s_nop 1
v_permlane32_swap_b32 v66,v68
v_fma_f32 v68,-v66,v66,v68
v_add_f32 v66,s78,v66
v_max_f32 v68,0,v68
v_cvt_pk_bf16_f32 v68,v66,v68
v_lshlrev_b32 v66,16,v68
v_and_b32 v68,0xffff0000,v68
v_add_f32 v68,0x3727c5ac,v68
v_cvt_pk_bf16_f32 v68,v68,v68
v_and_b32 v68,0xffff0000,v68
v_sqrt_f32 v68,v68
v_pk_add_f32 v[58:59],v[96:97],v[66:67] op_sel_hi:[1,0] neg_lo:[0,1] neg_hi:[0,1]
v_pk_add_f32 v[60:61],v[98:99],v[66:67] op_sel_hi:[1,0] neg_lo:[0,1] neg_hi:[0,1]
v_pk_add_f32 v[62:63],v[100:101],v[66:67] op_sel_hi:[1,0] neg_lo:[0,1] neg_hi:[0,1]
v_pk_add_f32 v[64:65],v[102:103],v[66:67] op_sel_hi:[1,0] neg_lo:[0,1] neg_hi:[0,1]
v_cvt_pk_bf16_f32 v68,v68,v68
v_and_b32 v68,0xffff0000,v68
v_rcp_f32 v68,v68
v_cvt_pk_bf16_f32 v84,v58,v59
v_cvt_pk_bf16_f32 v85,v60,v61
v_cvt_pk_bf16_f32 v86,v62,v63
v_cvt_pk_bf16_f32 v87,v64,v65
v_lshlrev_b32 v58,16,v84
v_and_b32 v59,0xffff0000,v84
v_lshlrev_b32 v60,16,v85
v_and_b32 v61,0xffff0000,v85
v_lshlrev_b32 v62,16,v86
v_and_b32 v63,0xffff0000,v86
v_lshlrev_b32 v64,16,v87
v_and_b32 v65,0xffff0000,v87
v_pk_mul_f32 v[58:59],v[58:59],v[68:69] op_sel_hi:[1,0]
v_pk_mul_f32 v[60:61],v[60:61],v[68:69] op_sel_hi:[1,0]
v_pk_mul_f32 v[62:63],v[62:63],v[68:69] op_sel_hi:[1,0]
v_pk_mul_f32 v[64:65],v[64:65],v[68:69] op_sel_hi:[1,0]
v_cvt_pk_bf16_f32 v84,v58,v59
v_cvt_pk_bf16_f32 v85,v60,v61
v_cvt_pk_bf16_f32 v86,v62,v63
v_cvt_pk_bf16_f32 v87,v64,v65
s_lshl_b32 s58,s51,10
s_add_u32 s58,s58,11272192
s_add_u32 s59,s58,65536
s_cmp_eq_u32 s47,0
s_cselect_b32 s59,s59,0x80000000
s_add_u32 s57,s56,98566144
buffer_store_dwordx4 v[84:87],v0,s[8:11],s59 offen sc1
buffer_store_dwordx4 v[80:83],v0,s[8:11],s58 offen sc1
buffer_store_dwordx4 v[84:87],v0,s[8:11],s57 offen sc1
L_moed_410:
s_barrier
L_mo_397:
s_mov_b32 s77,-1
s_cmp_lt_u32 s31,64
s_cbranch_scc1 L_mo_393
s_cmp_eq_u32 s86,0
s_cbranch_scc1 L_mo_406
L_mo_399:
s_andn2_b32 s51,0x7ff,s54
s_lshr_b32 s51,s51,5
s_andn2_b32 s56,31,s54
v_lshrrev_b32 v2,10,v20
v_add_u32 v3,16,v2
v_add_u32 v8,96468992,v20
v_cmp_eq_u32 vcc,s56,v2
s_nop 1
v_cndmask_b32 v2,v20,v8,vcc
v_cmp_eq_u32 vcc,s56,v3
s_nop 1
v_cndmask_b32 v3,v20,v8,vcc
s_waitcnt vmcnt(0)
s_lshl_b32 s59,s51,13
s_add_u32 s59,s59,10487552
s_cmp_lg_u32 s46,0
s_cbranch_scc1 L_fd_415
v_and_b32 v124,31,v1
v_lshlrev_b32 v124,2,v124
s_branch L_ff_416
L_fw_414:
s_sleep 2
L_ff_416:
buffer_load_dword v125,v124,s[8:11],s59 offen sc1
s_sub_u32 s49,s49,1
s_cbranch_scc1 L_abort2
s_waitcnt vmcnt(0)
v_cmp_eq_u32 vcc,0,v125
s_cbranch_vccnz L_fw_414
L_fd_415:
s_barrier
s_or_b32 s72,s72,s52
buffer_store_dword v17,off,s[8:11],s72 sc1
s_lshl_b32 s66,s51,15
s_add_u32 s66,s66,2097152
s_add_u32 s67,s66,16384
s_add_u32 m0,s50,131072
s_nop 0
buffer_load_dwordx4 v2,s[8:11],s66 offen offset:0 sc1 lds
s_add_u32 m0,s50,135168
s_nop 0
buffer_load_dwordx4 v3,s[8:11],s67 offen offset:0 sc1 lds
s_add_u32 m0,s50,139008
s_nop 0
buffer_load_dwordx4 v2,s[8:11],s66 offen offset:256 sc1 lds
s_add_u32 m0,s50,143104
s_nop 0
buffer_load_dwordx4 v3,s[8:11],s67 offen offset:256 sc1 lds
s_add_u32 m0,s50,146944
s_nop 0
buffer_load_dwordx4 v2,s[8:11],s66 offen offset:512 sc1 lds
s_add_u32 m0,s50,151040
s_nop 0
buffer_load_dwordx4 v3,s[8:11],s67 offen offset:512 sc1 lds
s_waitcnt vmcnt(4)
s_barrier
ds_read_b128 v[104:107],v4 offset:0
ds_read_b128 v[108:111],v4 offset:4096
ds_read_b128 v[112:115],v5 offset:0
ds_read_b128 v[116:119],v5 offset:4096
s_add_u32 m0,s50,154880
s_nop 0
buffer_load_dwordx4 v2,s[8:11],s66 offen offset:768 sc1 lds
s_add_u32 m0,s50,158976
s_nop 0
buffer_load_dwordx4 v3,s[8:11],s67 offen offset:768 sc1 lds
s_waitcnt lgkmcnt(2)
v_mfma_f32_16x16x32_bf16 v[24:27],a[128:131],v[104:107],0
ds_read_b128 v[120:123],v6 offset:0
v_mfma_f32_16x16x32_bf16 v[40:43],v[104:107],v[128:131],0
s_lshl_b32 s58,s51,5
v_mfma_f32_16x16x32_bf16 v[28:31],a[128:131],v[108:111],0
ds_read_b128 v[124:127],v6 offset:4096
v_mfma_f32_16x16x32_bf16 v[44:47],v[108:111],v[128:131],0
s_add_u32 s58,s58,s47
v_mfma_f32_16x16x32_bf16 v[32:35],a[136:139],v[104:107],0
s_mul_i32 s58,s58,24576
v_mfma_f32_16x16x32_bf16 v[48:51],v[104:107],v[136:139],0
s_add_u32 s58,s58,201326592
v_mfma_f32_16x16x32_bf16 v[36:39],a[136:139],v[108:111],0
s_add_u32 s61,s58,s50
v_mfma_f32_16x16x32_bf16 v[52:55],v[108:111],v[136:139],0
s_add_u32 s62,s61,4096
s_waitcnt lgkmcnt(2)
v_mfma_f32_16x16x32_bf16 v[24:27],a[132:135],v[112:115],v[24:27]
ds_read_b128 v[104:107],v7 offset:0
v_mfma_f32_16x16x32_bf16 v[40:43],v[112:115],v[132:135],v[40:43]
s_add_u32 s63,s61,16384
v_mfma_f32_16x16x32_bf16 v[28:31],a[132:135],v[116:119],v[28:31]
ds_read_b128 v[108:111],v7 offset:4096
v_mfma_f32_16x16x32_bf16 v[44:47],v[116:119],v[132:135],v[44:47]
s_add_u32 s64,s61,20480
v_mfma_f32_16x16x32_bf16 v[32:35],a[140:143],v[112:115],v[32:35]
s_add_u32 s65,s61,s50
v_mfma_f32_16x16x32_bf16 v[48:51],v[112:115],v[140:143],v[48:51]
s_add_u32 s65,s65,8192
v_mfma_f32_16x16x32_bf16 v[36:39],a[140:143],v[116:119],v[36:39]
v_mfma_f32_16x16x32_bf16 v[52:55],v[116:119],v[140:143],v[52:55]
s_waitcnt vmcnt(4)
s_barrier
s_waitcnt lgkmcnt(2)
v_mfma_f32_16x16x32_bf16 v[24:27],a[144:147],v[120:123],v[24:27]
ds_read_b128 v[112:115],v4 offset:8192
v_mfma_f32_16x16x32_bf16 v[40:43],v[120:123],v[144:147],v[40:43]
v_mfma_f32_16x16x32_bf16 v[28:31],a[144:147],v[124:127],v[28:31]
ds_read_b128 v[116:119],v4 offset:12288
v_mfma_f32_16x16x32_bf16 v[44:47],v[124:127],v[144:147],v[44:47]
v_mfma_f32_16x16x32_bf16 v[32:35],a[152:155],v[120:123],v[32:35]
v_mfma_f32_16x16x32_bf16 v[48:51],v[120:123],v[152:155],v[48:51]
v_mfma_f32_16x16x32_bf16 v[36:39],a[152:155],v[124:127],v[36:39]
v_mfma_f32_16x16x32_bf16 v[52:55],v[124:127],v[152:155],v[52:55]
s_waitcnt lgkmcnt(2)
v_mfma_f32_16x16x32_bf16 v[24:27],a[148:151],v[104:107],v[24:27]
ds_read_b128 v[120:123],v5 offset:8192
v_mfma_f32_16x16x32_bf16 v[40:43],v[104:107],v[148:151],v[40:43]
v_mfma_f32_16x16x32_bf16 v[28:31],a[148:151],v[108:111],v[28:31]
ds_read_b128 v[124:127],v5 offset:12288
v_mfma_f32_16x16x32_bf16 v[44:47],v[108:111],v[148:151],v[44:47]
v_mfma_f32_16x16x32_bf16 v[32:35],a[156:159],v[104:107],v[32:35]
v_mfma_f32_16x16x32_bf16 v[48:51],v[104:107],v[156:159],v[48:51]
v_mfma_f32_16x16x32_bf16 v[36:39],a[156:159],v[108:111],v[36:39]
v_mfma_f32_16x16x32_bf16 v[52:55],v[108:111],v[156:159],v[52:55]
s_waitcnt lgkmcnt(2)
v_mfma_f32_16x16x32_bf16 v[24:27],a[160:163],v[112:115],v[24:27]
ds_read_b128 v[104:107],v6 offset:8192
v_mfma_f32_16x16x32_bf16 v[40:43],v[112:115],v[160:163],v[40:43]
v_mfma_f32_16x16x32_bf16 v[28:31],a[160:163],v[116:119],v[28:31]
ds_read_b128 v[108:111],v6 offset:12288
v_mfma_f32_16x16x32_bf16 v[44:47],v[116:119],v[160:163],v[44:47]
v_mfma_f32_16x16x32_bf16 v[32:35],a[168:171],v[112:115],v[32:35]
v_mfma_f32_16x16x32_bf16 v[48:51],v[112:115],v[168:171],v[48:51]
v_mfma_f32_16x16x32_bf16 v[36:39],a[168:171],v[116:119],v[36:39]
v_mfma_f32_16x16x32_bf16 v[52:55],v[116:119],v[168:171],v[52:55]
s_waitcnt lgkmcnt(2)
v_mfma_f32_16x16x32_bf16 v[24:27],a[164:167],v[120:123],v[24:27]
ds_read_b128 v[112:115],v7 offset:8192
v_mfma_f32_16x16x32_bf16 v[40:43],v[120:123],v[164:167],v[40:43]
v_mfma_f32_16x16x32_bf16 v[28:31],a[164:167],v[124:127],v[28:31]
ds_read_b128 v[116:119],v7 offset:12288
v_mfma_f32_16x16x32_bf16 v[44:47],v[124:127],v[164:167],v[44:47]
v_mfma_f32_16x16x32_bf16 v[32:35],a[172:175],v[120:123],v[32:35]
v_mfma_f32_16x16x32_bf16 v[48:51],v[120:123],v[172:175],v[48:51]
v_mfma_f32_16x16x32_bf16 v[36:39],a[172:175],v[124:127],v[36:39]
v_mfma_f32_16x16x32_bf16 v[52:55],v[124:127],v[172:175],v[52:55]
s_waitcnt vmcnt(2)
s_barrier
s_waitcnt lgkmcnt(2)
v_mfma_f32_16x16x32_bf16 v[24:27],a[176:179],v[104:107],v[24:27]
ds_read_b128 v[120:123],v4 offset:16384
v_mfma_f32_16x16x32_bf16 v[40:43],v[104:107],v[176:179],v[40:43]
v_mfma_f32_16x16x32_bf16 v[28:31],a[176:179],v[108:111],v[28:31]
ds_read_b128 v[124:127],v4 offset:20480
v_mfma_f32_16x16x32_bf16 v[44:47],v[108:111],v[176:179],v[44:47]
v_mfma_f32_16x16x32_bf16 v[32:35],a[184:187],v[104:107],v[32:35]
v_mfma_f32_16x16x32_bf16 v[48:51],v[104:107],v[184:187],v[48:51]
v_mfma_f32_16x16x32_bf16 v[36:39],a[184:187],v[108:111],v[36:39]
v_mfma_f32_16x16x32_bf16 v[52:55],v[108:111],v[184:187],v[52:55]
s_waitcnt lgkmcnt(2)
v_mfma_f32_16x16x32_bf16 v[24:27],a[180:183],v[112:115],v[24:27]
ds_read_b128 v[104:107],v5 offset:16384
v_mfma_f32_16x16x32_bf16 v[40:43],v[112:115],v[180:183],v[40:43]
v_mfma_f32_16x16x32_bf16 v[28:31],a[180:183],v[116:119],v[28:31]
ds_read_b128 v[108:111],v5 offset:20480
v_mfma_f32_16x16x32_bf16 v[44:47],v[116:119],v[180:183],v[44:47]
v_mfma_f32_16x16x32_bf16 v[32:35],a[188:191],v[112:115],v[32:35]
v_mfma_f32_16x16x32_bf16 v[48:51],v[112:115],v[188:191],v[48:51]
v_mfma_f32_16x16x32_bf16 v[36:39],a[188:191],v[116:119],v[36:39]
v_mfma_f32_16x16x32_bf16 v[52:55],v[116:119],v[188:191],v[52:55]
s_waitcnt lgkmcnt(2)
v_mfma_f32_16x16x32_bf16 v[24:27],a[192:195],v[120:123],v[24:27]
ds_read_b128 v[112:115],v6 offset:16384
v_mfma_f32_16x16x32_bf16 v[40:43],v[120:123],v[192:195],v[40:43]
v_mfma_f32_16x16x32_bf16 v[28:31],a[192:195],v[124:127],v[28:31]
ds_read_b128 v[116:119],v6 offset:20480
v_mfma_f32_16x16x32_bf16 v[44:47],v[124:127],v[192:195],v[44:47]
v_mfma_f32_16x16x32_bf16 v[32:35],a[200:203],v[120:123],v[32:35]
v_mfma_f32_16x16x32_bf16 v[48:51],v[120:123],v[200:203],v[48:51]
v_mfma_f32_16x16x32_bf16 v[36:39],a[200:203],v[124:127],v[36:39]
v_mfma_f32_16x16x32_bf16 v[52:55],v[124:127],v[200:203],v[52:55]
s_waitcnt lgkmcnt(2)
v_mfma_f32_16x16x32_bf16 v[24:27],a[196:199],v[104:107],v[24:27]
ds_read_b128 v[120:123],v7 offset:16384
v_mfma_f32_16x16x32_bf16 v[40:43],v[104:107],v[196:199],v[40:43]
v_mfma_f32_16x16x32_bf16 v[28:31],a[196:199],v[108:111],v[28:31]
ds_read_b128 v[124:127],v7 offset:20480
v_mfma_f32_16x16x32_bf16 v[44:47],v[108:111],v[196:199],v[44:47]
v_mfma_f32_16x16x32_bf16 v[32:35],a[204:207],v[104:107],v[32:35]
v_mfma_f32_16x16x32_bf16 v[48:51],v[104:107],v[204:207],v[48:51]
v_mfma_f32_16x16x32_bf16 v[36:39],a[204:207],v[108:111],v[36:39]
v_mfma_f32_16x16x32_bf16 v[52:55],v[108:111],v[204:207],v[52:55]
s_waitcnt vmcnt(0)
s_barrier
s_waitcnt lgkmcnt(2)
v_mfma_f32_16x16x32_bf16 v[24:27],a[208:211],v[112:115],v[24:27]
ds_read_b128 v[104:107],v4 offset:24576
v_mfma_f32_16x16x32_bf16 v[40:43],v[112:115],v[208:211],v[40:43]
v_mfma_f32_16x16x32_bf16 v[28:31],a[208:211],v[116:119],v[28:31]
ds_read_b128 v[108:111],v4 offset:28672
v_mfma_f32_16x16x32_bf16 v[44:47],v[116:119],v[208:211],v[44:47]
v_mfma_f32_16x16x32_bf16 v[32:35],a[216:219],v[112:115],v[32:35]
v_mfma_f32_16x16x32_bf16 v[48:51],v[112:115],v[216:219],v[48:51]
v_mfma_f32_16x16x32_bf16 v[36:39],a[216:219],v[116:119],v[36:39]
v_mfma_f32_16x16x32_bf16 v[52:55],v[116:119],v[216:219],v[52:55]
s_waitcnt lgkmcnt(2)
v_mfma_f32_16x16x32_bf16 v[24:27],a[212:215],v[120:123],v[24:27]
ds_read_b128 v[112:115],v5 offset:24576
v_mfma_f32_16x16x32_bf16 v[40:43],v[120:123],v[212:215],v[40:43]
v_mfma_f32_16x16x32_bf16 v[28:31],a[212:215],v[124:127],v[28:31]
ds_read_b128 v[116:119],v5 offset:28672
v_mfma_f32_16x16x32_bf16 v[44:47],v[124:127],v[212:215],v[44:47]
v_mfma_f32_16x16x32_bf16 v[32:35],a[220:223],v[120:123],v[32:35]
v_mfma_f32_16x16x32_bf16 v[48:51],v[120:123],v[220:223],v[48:51]
v_mfma_f32_16x16x32_bf16 v[36:39],a[220:223],v[124:127],v[36:39]
v_mfma_f32_16x16x32_bf16 v[52:55],v[124:127],v[220:223],v[52:55]
s_waitcnt lgkmcnt(2)
v_mfma_f32_16x16x32_bf16 v[24:27],a[224:227],v[104:107],v[24:27]
ds_read_b128 v[120:123],v6 offset:24576
v_mfma_f32_16x16x32_bf16 v[40:43],v[104:107],v[224:227],v[40:43]
v_mfma_f32_16x16x32_bf16 v[28:31],a[224:227],v[108:111],v[28:31]
ds_read_b128 v[124:127],v6 offset:28672
v_mfma_f32_16x16x32_bf16 v[44:47],v[108:111],v[224:227],v[44:47]
v_mfma_f32_16x16x32_bf16 v[32:35],a[232:235],v[104:107],v[32:35]
v_mfma_f32_16x16x32_bf16 v[48:51],v[104:107],v[232:235],v[48:51]
v_mfma_f32_16x16x32_bf16 v[36:39],a[232:235],v[108:111],v[36:39]
v_mfma_f32_16x16x32_bf16 v[52:55],v[108:111],v[232:235],v[52:55]
s_waitcnt lgkmcnt(2)
v_mfma_f32_16x16x32_bf16 v[24:27],a[228:231],v[112:115],v[24:27]
ds_read_b128 v[104:107],v7 offset:24576
v_mfma_f32_16x16x32_bf16 v[40:43],v[112:115],v[228:231],v[40:43]
v_mfma_f32_16x16x32_bf16 v[28:31],a[228:231],v[116:119],v[28:31]
ds_read_b128 v[108:111],v7 offset:28672
v_mfma_f32_16x16x32_bf16 v[44:47],v[116:119],v[228:231],v[44:47]
v_mfma_f32_16x16x32_bf16 v[32:35],a[236:239],v[112:115],v[32:35]
v_mfma_f32_16x16x32_bf16 v[48:51],v[112:115],v[236:239],v[48:51]
v_mfma_f32_16x16x32_bf16 v[36:39],a[236:239],v[116:119],v[36:39]
v_mfma_f32_16x16x32_bf16 v[52:55],v[116:119],v[236:239],v[52:55]
s_waitcnt lgkmcnt(2)
v_mfma_f32_16x16x32_bf16 v[24:27],a[240:243],v[120:123],v[24:27]
ds_read_b128 v[112:115],v4 offset:0
v_mfma_f32_16x16x32_bf16 v[40:43],v[120:123],v[240:243],v[40:43]
v_mfma_f32_16x16x32_bf16 v[28:31],a[240:243],v[124:127],v[28:31]
ds_read_b128 v[116:119],v4 offset:4096
v_mfma_f32_16x16x32_bf16 v[44:47],v[124:127],v[240:243],v[44:47]
v_mfma_f32_16x16x32_bf16 v[32:35],a[248:251],v[120:123],v[32:35]
v_mfma_f32_16x16x32_bf16 v[48:51],v[120:123],v[248:251],v[48:51]
v_mfma_f32_16x16x32_bf16 v[36:39],a[248:251],v[124:127],v[36:39]
v_mfma_f32_16x16x32_bf16 v[52:55],v[124:127],v[248:251],v[52:55]
s_waitcnt lgkmcnt(2)
v_mfma_f32_16x16x32_bf16 v[24:27],a[244:247],v[104:107],v[24:27]
ds_read_b128 v[120:123],v5 offset:0
v_mfma_f32_16x16x32_bf16 v[40:43],v[104:107],v[244:247],v[40:43]
v_mfma_f32_16x16x32_bf16 v[28:31],a[244:247],v[108:111],v[28:31]
ds_read_b128 v[124:127],v5 offset:4096
v_mfma_f32_16x16x32_bf16 v[44:47],v[108:111],v[244:247],v[44:47]
v_mfma_f32_16x16x32_bf16 v[32:35],a[252:255],v[104:107],v[32:35]
v_mfma_f32_16x16x32_bf16 v[48:51],v[104:107],v[252:255],v[48:51]
v_mfma_f32_16x16x32_bf16 v[36:39],a[252:255],v[108:111],v[36:39]
v_mfma_f32_16x16x32_bf16 v[52:55],v[108:111],v[252:255],v[52:55]
s_waitcnt lgkmcnt(2)
v_mfma_f32_16x16x32_bf16 v[88:91],a[0:3],v[112:115],0
ds_read_b128 v[104:107],v6 offset:0
v_mfma_f32_16x16x32_bf16 v[92:95],a[0:3],v[116:119],0
v_mfma_f32_16x16x32_bf16 v[96:99],a[8:11],v[112:115],0
ds_read_b128 v[108:111],v6 offset:4096
v_cvt_pk_bf16_f32 v56,v24,v32
v_cvt_pk_bf16_f32 v57,v25,v33
v_mfma_f32_16x16x32_bf16 v[100:103],a[8:11],v[116:119],0
v_cvt_pk_bf16_f32 v58,v26,v34
v_cvt_pk_bf16_f32 v59,v27,v35
s_waitcnt lgkmcnt(2)
v_mfma_f32_16x16x32_bf16 v[88:91],a[4:7],v[120:123],v[88:91]
ds_read_b128 v[112:115],v7 offset:0
v_mfma_f32_16x16x32_bf16 v[92:95],a[4:7],v[124:127],v[92:95]
buffer_store_dwordx4 v[56:59],v0,s[8:11],s61 offen sc1
v_cvt_pk_bf16_f32 v60,v28,v36
v_cvt_pk_bf16_f32 v61,v29,v37
v_mfma_f32_16x16x32_bf16 v[96:99],a[12:15],v[120:123],v[96:99]
ds_read_b128 v[116:119],v7 offset:4096
v_cvt_pk_bf16_f32 v62,v30,v38
v_cvt_pk_bf16_f32 v63,v31,v39
v_mfma_f32_16x16x32_bf16 v[100:103],a[12:15],v[124:127],v[100:103]
buffer_store_dwordx4 v[60:63],v0,s[8:11],s62 offen sc1
v_cvt_pk_bf16_f32 v64,v40,v41
v_cvt_pk_bf16_f32 v65,v42,v43
s_waitcnt lgkmcnt(2)
v_mfma_f32_16x16x32_bf16 v[88:91],a[16:19],v[104:107],v[88:91]
ds_read_b128 v[120:123],v4 offset:8192
v_cvt_pk_bf16_f32 v66,v44,v45
v_cvt_pk_bf16_f32 v67,v46,v47
v_mfma_f32_16x16x32_bf16 v[92:95],a[16:19],v[108:111],v[92:95]
buffer_store_dwordx4 v[64:67],v0,s[8:11],s65 offen offset:0 sc1
v_cvt_pk_bf16_f32 v68,v48,v49
v_cvt_pk_bf16_f32 v69,v50,v51
v_mfma_f32_16x16x32_bf16 v[96:99],a[24:27],v[104:107],v[96:99]
ds_read_b128 v[124:127],v4 offset:12288
v_cvt_pk_bf16_f32 v70,v52,v53
v_cvt_pk_bf16_f32 v71,v54,v55
v_mfma_f32_16x16x32_bf16 v[100:103],a[24:27],v[108:111],v[100:103]
buffer_store_dwordx4 v[68:71],v0,s[8:11],s65 offen offset:1024 sc1
s_waitcnt lgkmcnt(2)
v_mfma_f32_16x16x32_bf16 v[88:91],a[20:23],v[112:115],v[88:91]
ds_read_b128 v[104:107],v5 offset:8192
v_mfma_f32_16x16x32_bf16 v[92:95],a[20:23],v[116:119],v[92:95]
v_mfma_f32_16x16x32_bf16 v[96:99],a[28:31],v[112:115],v[96:99]
ds_read_b128 v[108:111],v5 offset:12288
v_mfma_f32_16x16x32_bf16 v[100:103],a[28:31],v[116:119],v[100:103]
s_waitcnt lgkmcnt(2)
v_mfma_f32_16x16x32_bf16 v[88:91],a[32:35],v[120:123],v[88:91]
ds_read_b128 v[112:115],v6 offset:8192
v_mfma_f32_16x16x32_bf16 v[92:95],a[32:35],v[124:127],v[92:95]
v_mfma_f32_16x16x32_bf16 v[96:99],a[40:43],v[120:123],v[96:99]
ds_read_b128 v[116:119],v6 offset:12288
v_mfma_f32_16x16x32_bf16 v[100:103],a[40:43],v[124:127],v[100:103]
s_waitcnt lgkmcnt(2)
v_mfma_f32_16x16x32_bf16 v[88:91],a[36:39],v[104:107],v[88:91]
ds_read_b128 v[120:123],v7 offset:8192
v_mfma_f32_16x16x32_bf16 v[92:95],a[36:39],v[108:111],v[92:95]
v_mfma_f32_16x16x32_bf16 v[96:99],a[44:47],v[104:107],v[96:99]
ds_read_b128 v[124:127],v7 offset:12288
v_mfma_f32_16x16x32_bf16 v[100:103],a[44:47],v[108:111],v[100:103]
s_waitcnt lgkmcnt(2)
v_mfma_f32_16x16x32_bf16 v[88:91],a[48:51],v[112:115],v[88:91]
ds_read_b128 v[104:107],v4 offset:16384
v_mfma_f32_16x16x32_bf16 v[92:95],a[48:51],v[116:119],v[92:95]
v_mfma_f32_16x16x32_bf16 v[96:99],a[56:59],v[112:115],v[96:99]
ds_read_b128 v[108:111],v4 offset:20480
v_mfma_f32_16x16x32_bf16 v[100:103],a[56:59],v[116:119],v[100:103]
s_waitcnt lgkmcnt(2)
v_mfma_f32_16x16x32_bf16 v[88:91],a[52:55],v[120:123],v[88:91]
ds_read_b128 v[112:115],v5 offset:16384
v_mfma_f32_16x16x32_bf16 v[92:95],a[52:55],v[124:127],v[92:95]
v_mfma_f32_16x16x32_bf16 v[96:99],a[60:63],v[120:123],v[96:99]
ds_read_b128 v[116:119],v5 offset:20480
v_mfma_f32_16x16x32_bf16 v[100:103],a[60:63],v[124:127],v[100:103]
s_waitcnt lgkmcnt(2)
v_mfma_f32_16x16x32_bf16 v[88:91],a[64:67],v[104:107],v[88:91]
ds_read_b128 v[120:123],v6 offset:16384
v_mfma_f32_16x16x32_bf16 v[92:95],a[64:67],v[108:111],v[92:95]
v_mfma_f32_16x16x32_bf16 v[96:99],a[72:75],v[104:107],v[96:99]
ds_read_b128 v[124:127],v6 offset:20480
v_mfma_f32_16x16x32_bf16 v[100:103],a[72:75],v[108:111],v[100:103]
s_waitcnt lgkmcnt(2)
v_mfma_f32_16x16x32_bf16 v[88:91],a[68:71],v[112:115],v[88:91]
ds_read_b128 v[104:107],v7 offset:16384
v_mfma_f32_16x16x32_bf16 v[92:95],a[68:71],v[116:119],v[92:95]
v_mfma_f32_16x16x32_bf16 v[96:99],a[76:79],v[112:115],v[96:99]
ds_read_b128 v[108:111],v7 offset:20480
v_mfma_f32_16x16x32_bf16 v[100:103],a[76:79],v[116:119],v[100:103]
s_waitcnt lgkmcnt(2)
v_mfma_f32_16x16x32_bf16 v[88:91],a[80:83],v[120:123],v[88:91]
ds_read_b128 v[112:115],v4 offset:24576
v_mfma_f32_16x16x32_bf16 v[92:95],a[80:83],v[124:127],v[92:95]
v_mfma_f32_16x16x32_bf16 v[96:99],a[88:91],v[120:123],v[96:99]
ds_read_b128 v[116:119],v4 offset:28672
v_mfma_f32_16x16x32_bf16 v[100:103],a[88:91],v[124:127],v[100:103]
s_waitcnt lgkmcnt(2)
v_mfma_f32_16x16x32_bf16 v[88:91],a[84:87],v[104:107],v[88:91]
ds_read_b128 v[120:123],v5 offset:24576
v_mfma_f32_16x16x32_bf16 v[92:95],a[84:87],v[108:111],v[92:95]
v_mfma_f32_16x16x32_bf16 v[96:99],a[92:95],v[104:107],v[96:99]
ds_read_b128 v[124:127],v5 offset:28672
v_mfma_f32_16x16x32_bf16 v[100:103],a[92:95],v[108:111],v[100:103]
s_waitcnt lgkmcnt(2)
v_mfma_f32_16x16x32_bf16 v[88:91],a[96:99],v[112:115],v[88:91]
ds_read_b128 v[104:107],v6 offset:24576
v_mfma_f32_16x16x32_bf16 v[92:95],a[96:99],v[116:119],v[92:95]
v_mfma_f32_16x16x32_bf16 v[96:99],a[104:107],v[112:115],v[96:99]
ds_read_b128 v[108:111],v6 offset:28672
v_mfma_f32_16x16x32_bf16 v[100:103],a[104:107],v[116:119],v[100:103]
s_waitcnt lgkmcnt(2)
v_mfma_f32_16x16x32_bf16 v[88:91],a[100:103],v[120:123],v[88:91]
ds_read_b128 v[112:115],v7 offset:24576
v_mfma_f32_16x16x32_bf16 v[92:95],a[100:103],v[124:127],v[92:95]
v_mfma_f32_16x16x32_bf16 v[96:99],a[108:111],v[120:123],v[96:99]
ds_read_b128 v[116:119],v7 offset:28672
v_mfma_f32_16x16x32_bf16 v[100:103],a[108:111],v[124:127],v[100:103]
s_waitcnt lgkmcnt(2)
v_mfma_f32_16x16x32_bf16 v[88:91],a[112:115],v[104:107],v[88:91]
v_mfma_f32_16x16x32_bf16 v[92:95],a[112:115],v[108:111],v[92:95]
v_mfma_f32_16x16x32_bf16 v[96:99],a[120:123],v[104:107],v[96:99]
v_mfma_f32_16x16x32_bf16 v[100:103],a[120:123],v[108:111],v[100:103]
s_waitcnt lgkmcnt(0)
v_mfma_f32_16x16x32_bf16 v[88:91],a[116:119],v[112:115],v[88:91]
v_mfma_f32_16x16x32_bf16 v[92:95],a[116:119],v[116:119],v[92:95]
v_mfma_f32_16x16x32_bf16 v[96:99],a[124:127],v[112:115],v[96:99]
v_mfma_f32_16x16x32_bf16 v[100:103],a[124:127],v[116:119],v[100:103]
s_nop 3
v_cvt_pk_bf16_f32 v104,v88,v96
v_cvt_pk_bf16_f32 v105,v89,v97
v_cvt_pk_bf16_f32 v106,v90,v98
v_cvt_pk_bf16_f32 v107,v91,v99
v_cvt_pk_bf16_f32 v108,v92,v100
v_cvt_pk_bf16_f32 v109,v93,v101
v_cvt_pk_bf16_f32 v110,v94,v102
v_cvt_pk_bf16_f32 v111,v95,v103
buffer_store_dwordx4 v[104:107],v0,s[8:11],s63 offen sc1
buffer_store_dwordx4 v[108:111],v0,s[8:11],s64 offen sc1
s_waitcnt vmcnt(6)
s_barrier
s_add_u32 m0,s50,131072
s_nop 0
buffer_load_dwordx4 v20,s[8:11],s70 offen offset:0 sc1 lds
s_add_u32 m0,s50,135168
s_nop 0
buffer_load_dwordx4 v20,s[8:11],s71 offen offset:0 sc1 lds
s_add_u32 m0,s50,139008
s_nop 0
buffer_load_dwordx4 v20,s[8:11],s70 offen offset:256 sc1 lds
s_add_u32 m0,s50,143104
s_nop 0
buffer_load_dwordx4 v20,s[8:11],s71 offen offset:256 sc1 lds
s_add_u32 m0,s50,146944
s_nop 0
buffer_load_dwordx4 v20,s[8:11],s70 offen offset:512 sc1 lds
s_add_u32 m0,s50,151040
s_nop 0
buffer_load_dwordx4 v20,s[8:11],s71 offen offset:512 sc1 lds
s_lshl_b32 s59,s51,13
s_lshl2_add_u32 s59,s47,s59
s_add_u32 s59,s59,10487680
s_waitcnt vmcnt(0)
s_barrier
s_or_b32 s59,s59,s52
buffer_store_dword v17,off,s[8:11],s59 sc1
s_mov_b32 s72,0x80000000
s_mov_b32 s86,0
s_mov_b32 s19,1
s_mov_b32 s18,0
s_cmp_lt_u32 s31,64
s_cbranch_scc1 L_mo_393
L_mo_406:
s_mov_b32 s51,64
s_cmp_eq_u32 s47,31
s_cbranch_scc1 L_mf_417
v_and_b32 v9,15,v1
v_lshrrev_b32 v10,4,v1
v_and_b32 v124,1,v1
v_lshlrev_b32 v124,4,v124
v_mov_b32 v125,0xffff
v_lshlrev_b32 v125,v124,v125
v_lshrrev_b32 v124,2,v9
v_cmp_eq_u32 vcc,0,v124
s_nop 1
v_cndmask_b32 v12,0,v125,vcc
v_cmp_eq_u32 vcc,1,v124
s_nop 1
v_cndmask_b32 v13,0,v125,vcc
v_and_b32 v124,2,v1
v_cmp_eq_u32 vcc,0,v124
v_mov_b32 v14,0xeeee
v_mov_b32 v124,0x4444
v_cndmask_b32 v14,v14,v124,vcc
v_lshlrev_b32 v11,14,v10
v_lshl_add_u32 v11,v9,4,v11
s_lshl_b32 s65,s51,15
s_add_u32 s65,s65,92274688
s_lshl_b32 s62,s47,10
s_add_u32 s62,s62,s65
s_lshl_b32 s63,s47,16
s_lshl_b32 s60,s46,8
s_add_u32 s63,s63,s60
s_mov_b32 s4,s38
s_mov_b32 s5,s39
s_mov_b32 s6,1835008
s_mov_b32 s7,0x20000
buffer_load_dwordx4 v[24:27],v11,s[4:7],s63 offen offset:0
buffer_load_dwordx4 v[28:31],v11,s[4:7],s63 offen offset:1024
buffer_load_dwordx4 v[32:35],v11,s[4:7],s63 offen offset:2048
buffer_load_dwordx4 v[36:39],v11,s[4:7],s63 offen offset:3072
s_add_u32 s63,s63,4096
buffer_load_dwordx4 v[40:43],v11,s[4:7],s63 offen offset:0
buffer_load_dwordx4 v[44:47],v11,s[4:7],s63 offen offset:1024
buffer_load_dwordx4 v[48:51],v11,s[4:7],s63 offen offset:2048
buffer_load_dwordx4 v[52:55],v11,s[4:7],s63 offen offset:3072
s_add_u32 s63,s63,4096
buffer_load_dwordx4 v[56:59],v11,s[4:7],s63 offen offset:0
buffer_load_dwordx4 v[60:63],v11,s[4:7],s63 offen offset:1024
buffer_load_dwordx4 v[64:67],v11,s[4:7],s63 offen offset:2048
buffer_load_dwordx4 v[68:71],v11,s[4:7],s63 offen offset:3072
s_add_u32 s63,s63,4096
buffer_load_dwordx4 v[72:75],v11,s[4:7],s63 offen offset:0
buffer_load_dwordx4 v[76:79],v11,s[4:7],s63 offen offset:1024
buffer_load_dwordx4 v[80:83],v11,s[4:7],s63 offen offset:2048
buffer_load_dwordx4 v[84:87],v11,s[4:7],s63 offen offset:3072
ds_read_b128 a[0:3],v18 offset:0
ds_read_b128 a[4:7],v18 offset:1024
ds_read_b128 a[8:11],v18 offset:2048
ds_read_b128 a[12:15],v18 offset:3072
ds_read_b128 a[16:19],v18 offset:4096
ds_read_b128 a[20:23],v18 offset:5120
ds_read_b128 a[24:27],v18 offset:6144
ds_read_b128 a[28:31],v18 offset:7168
ds_read_b128 a[32:35],v18 offset:8192
ds_read_b128 a[36:39],v18 offset:9216
ds_read_b128 a[40:43],v18 offset:10240
ds_read_b128 a[44:47],v18 offset:11264
ds_read_b128 a[48:51],v18 offset:12288
ds_read_b128 a[52:55],v18 offset:13312
ds_read_b128 a[56:59],v18 offset:14336
ds_read_b128 a[60:63],v18 offset:15360
ds_read_b128 a[64:67],v18 offset:16384
ds_read_b128 a[68:71],v18 offset:17408
ds_read_b128 a[72:75],v18 offset:18432
ds_read_b128 a[76:79],v18 offset:19456
ds_read_b128 a[80:83],v18 offset:20480
ds_read_b128 a[84:87],v18 offset:21504
ds_read_b128 a[88:91],v18 offset:22528
ds_read_b128 a[92:95],v18 offset:23552
ds_read_b128 a[96:99],v18 offset:24576
ds_read_b128 a[100:103],v18 offset:25600
ds_read_b128 a[104:107],v18 offset:26624
ds_read_b128 a[108:111],v18 offset:27648
ds_read_b128 a[112:115],v18 offset:28672
ds_read_b128 a[116:119],v18 offset:29696
ds_read_b128 a[120:123],v18 offset:30720
ds_read_b128 a[124:127],v18 offset:31744
L_mf_418:
s_lshl_b32 s59,s51,13
s_lshl_b32 s61,s46,7
s_add_u32 s59,s59,s61
s_add_u32 s59,s59,10486272
L_ww_423:
s_sleep 1
buffer_load_dword v2,off,s[8:11],s59 sc1
s_sub_u32 s49,s49,1
s_cbranch_scc1 L_abort2
s_waitcnt vmcnt(0)
v_readfirstlane_b32 s55,v2
s_cmp_eq_u32 s55,0
s_cbranch_scc1 L_ww_423
L_wwd_424:
s_cmp_eq_u32 s55,1
s_cbranch_scc1 L_mf_419
s_barrier
s_andn2_b32 s64,0x7ff,s55
s_lshl_b32 s56,s64,10
s_add_u32 s58,s56,6291456
buffer_load_dwordx4 v[88:91],v0,s[8:11],s58 offen sc1
s_lshl_b32 s57,s46,11
s_add_u32 s57,s57,139264
v_add_u32 v8,s57,v0
v_and_b32 v2,1,v10
v_lshrrev_b32 v3,1,v10
v_lshlrev_b32 v2,7,v2
v_lshl_add_u32 v2,v3,10,v2
s_lshl_b32 s59,s46,8
s_add_u32 s59,s57,s59
v_add_u32 v2,s59,v2
s_mov_b32 s60,0x01000100
s_mov_b32 s61,0x03020302
s_waitcnt vmcnt(0)
v_lshlrev_b32 v96,16,v88
v_and_b32 v97,0xffff0000,v88
v_lshlrev_b32 v98,16,v89
v_and_b32 v99,0xffff0000,v89
v_lshlrev_b32 v100,16,v90
v_and_b32 v101,0xffff0000,v90
v_lshlrev_b32 v102,16,v91
v_and_b32 v103,0xffff0000,v91
v_readfirstlane_b32 s78,v96
s_nop 1
v_pk_add_f32 v[108:109],v[96:97],s[78:79] op_sel_hi:[1,0] neg_lo:[0,1] neg_hi:[0,1]
v_pk_add_f32 v[110:111],v[98:99],s[78:79] op_sel_hi:[1,0] neg_lo:[0,1] neg_hi:[0,1]
v_pk_add_f32 v[112:113],v[100:101],s[78:79] op_sel_hi:[1,0] neg_lo:[0,1] neg_hi:[0,1]
v_pk_add_f32 v[114:115],v[102:103],s[78:79] op_sel_hi:[1,0] neg_lo:[0,1] neg_hi:[0,1]
v_pk_add_f32 v[116:117],v[108:109],v[110:111]
v_pk_mul_f32 v[118:119],v[108:109],v[108:109]
v_pk_add_f32 v[120:121],v[112:113],v[114:115]
v_pk_fma_f32 v[118:119],v[110:111],v[110:111],v[118:119]
v_pk_add_f32 v[116:117],v[116:117],v[120:121]
v_pk_fma_f32 v[118:119],v[112:113],v[112:113],v[118:119]
v_add_f32 v116,v116,v117
v_pk_fma_f32 v[118:119],v[114:115],v[114:115],v[118:119]
v_add_f32 v118,v118,v119
s_nop 1
v_permlane32_swap_b32 v116,v118
v_add_f32 v116,v116,v118
s_nop 1
v_add_f32_dpp v116,v116,v116 row_ror:8 row_mask:0xf bank_mask:0xf
s_nop 1
v_add_f32_dpp v116,v116,v116 row_ror:4 row_mask:0xf bank_mask:0xf
s_nop 1
v_add_f32_dpp v116,v116,v116 row_ror:2 row_mask:0xf bank_mask:0xf
s_nop 1
v_add_f32_dpp v116,v116,v116 row_ror:1 row_mask:0xf bank_mask:0xf
v_mov_b32 v118,v116
s_nop 1
v_permlane16_swap_b32 v116,v118
v_add_f32 v116,v116,v118
v_mul_f32 v116,0x3b000000,v116
v_mov_b32 v118,v116
s_nop 1
v_permlane32_swap_b32 v116,v118
v_fma_f32 v118,-v116,v116,v118
v_add_f32 v116,s78,v116
v_max_f32 v118,0,v118
v_cvt_pk_bf16_f32 v118,v116,v118
v_lshlrev_b32 v116,16,v118
v_and_b32 v118,0xffff0000,v118
v_add_f32 v118,0x3727c5ac,v118
v_cvt_pk_bf16_f32 v118,v118,v118
v_and_b32 v118,0xffff0000,v118
v_sqrt_f32 v118,v118
v_pk_add_f32 v[108:109],v[96:97],v[116:117] op_sel_hi:[1,0] neg_lo:[0,1] neg_hi:[0,1]
v_pk_add_f32 v[110:111],v[98:99],v[116:117] op_sel_hi:[1,0] neg_lo:[0,1] neg_hi:[0,1]
v_pk_add_f32 v[112:113],v[100:101],v[116:117] op_sel_hi:[1,0] neg_lo:[0,1] neg_hi:[0,1]
v_pk_add_f32 v[114:115],v[102:103],v[116:117] op_sel_hi:[1,0] neg_lo:[0,1] neg_hi:[0,1]
v_cvt_pk_bf16_f32 v118,v118,v118
v_and_b32 v118,0xffff0000,v118
v_rcp_f32 v118,v118
v_cvt_pk_bf16_f32 v104,v108,v109
v_cvt_pk_bf16_f32 v105,v110,v111
v_cvt_pk_bf16_f32 v106,v112,v113
v_cvt_pk_bf16_f32 v107,v114,v115
v_lshlrev_b32 v108,16,v104
v_and_b32 v109,0xffff0000,v104
v_lshlrev_b32 v110,16,v105
v_and_b32 v111,0xffff0000,v105
v_lshlrev_b32 v112,16,v106
v_and_b32 v113,0xffff0000,v106
v_lshlrev_b32 v114,16,v107
v_and_b32 v115,0xffff0000,v107
v_pk_mul_f32 v[108:109],v[108:109],v[118:119] op_sel_hi:[1,0]
v_pk_mul_f32 v[110:111],v[110:111],v[118:119] op_sel_hi:[1,0]
v_pk_mul_f32 v[112:113],v[112:113],v[118:119] op_sel_hi:[1,0]
v_pk_mul_f32 v[114:115],v[114:115],v[118:119] op_sel_hi:[1,0]
v_cvt_pk_bf16_f32 v104,v108,v109
v_cvt_pk_bf16_f32 v105,v110,v111
v_cvt_pk_bf16_f32 v106,v112,v113
v_cvt_pk_bf16_f32 v107,v114,v115
v_perm_b32 v88,v104,v104,s60
v_perm_b32 v89,v105,v105,s60
v_perm_b32 v90,v106,v106,s60
v_perm_b32 v91,v107,v107,s60
ds_write_b128 v8,v[88:91]
v_perm_b32 v92,v104,v104,s61
v_perm_b32 v93,v105,v105,s61
v_perm_b32 v94,v106,v106,s61
v_perm_b32 v95,v107,v107,s61
ds_write_b128 v8,v[92:95] offset:1024
s_mov_b32 s58,s57
ds_read_b128 v[128:131],v2 offset:0
ds_read_b128 v[144:147],v2 offset:64
ds_read_b128 v[132:135],v2 offset:16
ds_read_b128 v[148:151],v2 offset:80
ds_read_b128 v[136:139],v2 offset:32
ds_read_b128 v[152:155],v2 offset:96
ds_read_b128 v[140:143],v2 offset:48
ds_read_b128 v[156:159],v2 offset:112
v_mov_b64 v[116:117],0
v_mov_b64 v[118:119],0
s_waitcnt lgkmcnt(6)
v_and_b32 v120,v12,v128
v_and_b32 v121,v13,v128
v_and_b32 v122,v12,v144
v_and_b32 v123,v13,v144
v_and_b32 v124,v12,v129
v_and_b32 v125,v13,v129
v_smfmac_f32_16x16x64_bf16 v[116:119],v[120:123],a[0:7],v14
v_and_b32 v126,v12,v145
v_and_b32 v127,v13,v145
v_and_b32 v120,v12,v130
v_and_b32 v121,v13,v130
v_smfmac_f32_16x16x64_bf16 v[116:119],v[124:127],a[8:15],v14
v_and_b32 v122,v12,v146
v_and_b32 v123,v13,v146
v_and_b32 v124,v12,v131
v_and_b32 v125,v13,v131
v_smfmac_f32_16x16x64_bf16 v[116:119],v[120:123],a[16:23],v14
v_and_b32 v126,v12,v147
v_and_b32 v127,v13,v147
s_waitcnt lgkmcnt(4)
v_and_b32 v120,v12,v132
v_and_b32 v121,v13,v132
v_smfmac_f32_16x16x64_bf16 v[116:119],v[124:127],a[24:31],v14
v_and_b32 v122,v12,v148
v_and_b32 v123,v13,v148
v_and_b32 v124,v12,v133
v_and_b32 v125,v13,v133
v_smfmac_f32_16x16x64_bf16 v[116:119],v[120:123],a[32:39],v14
v_and_b32 v126,v12,v149
v_and_b32 v127,v13,v149
v_and_b32 v120,v12,v134
v_and_b32 v121,v13,v134
v_smfmac_f32_16x16x64_bf16 v[116:119],v[124:127],a[40:47],v14
v_and_b32 v122,v12,v150
v_and_b32 v123,v13,v150
v_and_b32 v124,v12,v135
v_and_b32 v125,v13,v135
v_smfmac_f32_16x16x64_bf16 v[116:119],v[120:123],a[48:55],v14
v_and_b32 v126,v12,v151
v_and_b32 v127,v13,v151
s_waitcnt lgkmcnt(2)
v_and_b32 v120,v12,v136
v_and_b32 v121,v13,v136
v_smfmac_f32_16x16x64_bf16 v[116:119],v[124:127],a[56:63],v14
v_and_b32 v122,v12,v152
v_and_b32 v123,v13,v152
v_and_b32 v124,v12,v137
v_and_b32 v125,v13,v137
v_smfmac_f32_16x16x64_bf16 v[116:119],v[120:123],a[64:71],v14
v_and_b32 v126,v12,v153
v_and_b32 v127,v13,v153
v_and_b32 v120,v12,v138
v_and_b32 v121,v13,v138
v_smfmac_f32_16x16x64_bf16 v[116:119],v[124:127],a[72:79],v14
v_and_b32 v122,v12,v154
v_and_b32 v123,v13,v154
v_and_b32 v124,v12,v139
v_and_b32 v125,v13,v139
v_smfmac_f32_16x16x64_bf16 v[116:119],v[120:123],a[80:87],v14
v_and_b32 v126,v12,v155
v_and_b32 v127,v13,v155
s_waitcnt lgkmcnt(0)
v_and_b32 v120,v12,v140
v_and_b32 v121,v13,v140
v_smfmac_f32_16x16x64_bf16 v[116:119],v[124:127],a[88:95],v14
v_and_b32 v122,v12,v156
v_and_b32 v123,v13,v156
v_and_b32 v124,v12,v141
v_and_b32 v125,v13,v141
v_smfmac_f32_16x16x64_bf16 v[116:119],v[120:123],a[96:103],v14
v_and_b32 v126,v12,v157
v_and_b32 v127,v13,v157
v_and_b32 v120,v12,v142
v_and_b32 v121,v13,v142
v_smfmac_f32_16x16x64_bf16 v[116:119],v[124:127],a[104:111],v14
v_and_b32 v122,v12,v158
v_and_b32 v123,v13,v158
v_and_b32 v124,v12,v143
v_and_b32 v125,v13,v143
v_smfmac_f32_16x16x64_bf16 v[116:119],v[120:123],a[112:119],v14
v_and_b32 v126,v12,v159
v_and_b32 v127,v13,v159
s_nop 1
v_smfmac_f32_16x16x64_bf16 v[116:119],v[124:127],a[120:127],v14
v_lshlrev_b32 v8,5,v9
v_and_b32 v124,1,v10
v_lshl_add_u32 v8,v124,4,v8
v_lshrrev_b32 v124,1,v10
v_lshl_add_u32 v8,v124,11,v8
s_lshl_b32 s60,s46,9
s_add_u32 s60,s60,147456
v_add_u32 v8,s60,v8
ds_write_b128 v8,v[116:119]
v_lshlrev_b32 v8,2,v1
v_add_u32 v8,147456,v8
v_and_b32 v2,1,v1
v_lshrrev_b32 v3,1,v1
v_lshlrev_b32 v3,2,v3
v_lshl_add_u32 v2,v2,7,v3
v_add_u32 v2,s58,v2
v_lshlrev_b32 v3,6,v10
v_add_u32 v3,s58,v3
s_waitcnt lgkmcnt(0)
s_barrier
ds_read2st64_b32 v[88:89],v8 offset0:0 offset1:1
ds_read2st64_b32 v[90:91],v8 offset0:2 offset1:3
ds_read2st64_b32 v[92:93],v8 offset0:4 offset1:5
ds_read2st64_b32 v[94:95],v8 offset0:6 offset1:7
s_waitcnt lgkmcnt(0)
v_pk_add_f32 v[88:89],v[88:89],v[90:91]
v_pk_add_f32 v[92:93],v[92:93],v[94:95]
v_pk_add_f32 v[88:89],v[88:89],v[92:93]
v_cvt_pk_bf16_f32 v88,v88,v88
v_and_b32 v88,0xffff0000,v88
v_cvt_pk_bf16_f32 v89,v89,v89
v_and_b32 v89,0xffff0000,v89
v_mul_f32 v90,0xbfb8aa3b,v88
v_exp_f32 v90,v90
s_nop 0
v_add_f32 v90,1.0,v90
v_rcp_f32 v90,v90
s_nop 0
v_mul_f32 v88,v88,v90
v_cvt_pk_bf16_f32 v88,v88,v88
v_and_b32 v88,0xffff0000,v88
v_mul_f32 v88,v88,v89
v_cvt_pk_bf16_f32 v88,v88,v88
ds_write_b32 v2,v88
ds_read_b128 v[88:91],v3
ds_read_b128 v[108:111],v3 offset:32
ds_read_b128 v[92:95],v3 offset:16
ds_read_b128 v[112:115],v3 offset:48
v_mov_b64 v[116:117],0
v_mov_b64 v[118:119],0
s_waitcnt vmcnt(0) lgkmcnt(0)
v_and_b32 v120,v12,v88
v_and_b32 v121,v13,v88
v_and_b32 v122,v12,v108
v_and_b32 v123,v13,v108
v_and_b32 v124,v12,v89
v_and_b32 v125,v13,v89
v_smfmac_f32_16x16x64_bf16 v[116:119],v[120:123],v[24:31],v14
v_and_b32 v126,v12,v109
v_and_b32 v127,v13,v109
v_and_b32 v120,v12,v90
v_and_b32 v121,v13,v90
v_smfmac_f32_16x16x64_bf16 v[116:119],v[124:127],v[32:39],v14
v_and_b32 v122,v12,v110
v_and_b32 v123,v13,v110
v_and_b32 v124,v12,v91
v_and_b32 v125,v13,v91
v_smfmac_f32_16x16x64_bf16 v[116:119],v[120:123],v[40:47],v14
v_and_b32 v126,v12,v111
v_and_b32 v127,v13,v111
v_and_b32 v120,v12,v92
v_and_b32 v121,v13,v92
v_smfmac_f32_16x16x64_bf16 v[116:119],v[124:127],v[48:55],v14
v_and_b32 v122,v12,v112
v_and_b32 v123,v13,v112
v_and_b32 v124,v12,v93
v_and_b32 v125,v13,v93
v_smfmac_f32_16x16x64_bf16 v[116:119],v[120:123],v[56:63],v14
v_and_b32 v126,v12,v113
v_and_b32 v127,v13,v113
v_and_b32 v120,v12,v94
v_and_b32 v121,v13,v94
v_smfmac_f32_16x16x64_bf16 v[116:119],v[124:127],v[64:71],v14
v_and_b32 v122,v12,v114
v_and_b32 v123,v13,v114
v_and_b32 v124,v12,v95
v_and_b32 v125,v13,v95
v_smfmac_f32_16x16x64_bf16 v[116:119],v[120:123],v[72:79],v14
v_and_b32 v126,v12,v115
v_and_b32 v127,v13,v115
s_nop 1
v_smfmac_f32_16x16x64_bf16 v[116:119],v[124:127],v[80:87],v14
v_lshlrev_b32 v8,4,v9
v_and_b32 v124,1,v10
v_lshl_add_u32 v8,v124,3,v8
v_and_b32 v124,2,v10
v_lshl_add_u32 v8,v124,30,v8
s_lshl_b32 s60,s46,8
s_add_u32 s59,s62,s60
s_nop 0
v_cvt_pk_bf16_f32 v88,v116,v117
v_cvt_pk_bf16_f32 v89,v118,v119
buffer_store_dwordx2 v[88:89],v8,s[8:11],s59 offen sc1
s_lshl_b32 s59,s51,13
s_lshl2_add_u32 s59,s47,s59
s_add_u32 s59,s59,10486912
s_waitcnt vmcnt(0)
s_barrier
s_or_b32 s59,s59,s52
buffer_store_dword v17,off,s[8:11],s59 sc1
s_cmp_lg_u32 s47,0
s_cbranch_scc1 L_moed_425
s_lshl_b32 s59,s51,13
s_add_u32 s59,s59,10486912
v_and_b32 v124,31,v1
v_lshlrev_b32 v124,2,v124
L_fw_426:
buffer_load_dword v125,v124,s[8:11],s59 offen sc1
s_sub_u32 s49,s49,1
s_cbranch_scc1 L_abort2
s_waitcnt vmcnt(0)
v_cmp_eq_u32 vcc,0,v125
s_cbranch_vccnz L_fw_426
s_add_u32 s63,s65,0
buffer_load_dwordx4 v[168:171],v22,s[8:11],s63 offen sc1
s_add_u32 s63,s65,4096
buffer_load_dwordx4 v[172:175],v22,s[8:11],s63 offen sc1
s_add_u32 s63,s65,8192
buffer_load_dwordx4 v[176:179],v22,s[8:11],s63 offen sc1
s_add_u32 s63,s65,12288
buffer_load_dwordx4 v[180:183],v22,s[8:11],s63 offen sc1
s_add_u32 s63,s65,16384
buffer_load_dwordx4 v[184:187],v22,s[8:11],s63 offen sc1
s_add_u32 s63,s65,20480
buffer_load_dwordx4 v[188:191],v22,s[8:11],s63 offen sc1
s_add_u32 s63,s65,24576
buffer_load_dwordx4 v[192:195],v22,s[8:11],s63 offen sc1
s_add_u32 s63,s65,28672
buffer_load_dwordx4 v[196:199],v22,s[8:11],s63 offen sc1
v_and_b32 v208,15,v1
v_and_b32 v209,1,v1
v_lshlrev_b32 v209,4,v209
v_mov_b32 v210,0x3f80
v_lshlrev_b32 v210,v209,v210
v_lshrrev_b32 v208,1,v208
v_cmp_eq_u32 vcc,0,v208
s_nop 1
v_cndmask_b32 v200,0,v210,vcc
v_cmp_eq_u32 vcc,1,v208
s_nop 1
v_cndmask_b32 v201,0,v210,vcc
v_cmp_eq_u32 vcc,2,v208
s_nop 1
v_cndmask_b32 v202,0,v210,vcc
v_cmp_eq_u32 vcc,3,v208
s_nop 1
v_cndmask_b32 v203,0,v210,vcc
s_waitcnt vmcnt(7)
s_nop 0
v_mfma_f32_16x16x32_bf16 v[204:207],v[200:203],v[168:171],0
s_waitcnt vmcnt(6)
v_mfma_f32_16x16x32_bf16 v[204:207],v[200:203],v[172:175],v[204:207]
s_waitcnt vmcnt(5)
v_mfma_f32_16x16x32_bf16 v[204:207],v[200:203],v[176:179],v[204:207]
s_waitcnt vmcnt(4)
v_mfma_f32_16x16x32_bf16 v[204:207],v[200:203],v[180:183],v[204:207]
s_waitcnt vmcnt(3)
v_mfma_f32_16x16x32_bf16 v[204:207],v[200:203],v[184:187],v[204:207]
s_waitcnt vmcnt(2)
v_mfma_f32_16x16x32_bf16 v[204:207],v[200:203],v[188:191],v[204:207]
s_waitcnt vmcnt(1)
v_mfma_f32_16x16x32_bf16 v[204:207],v[200:203],v[192:195],v[204:207]
s_waitcnt vmcnt(0)
v_mfma_f32_16x16x32_bf16 v[204:207],v[200:203],v[196:199],v[204:207]
s_nop 7
ds_write_b128 v21,v[204:207]
s_waitcnt lgkmcnt(0)
s_barrier
s_cmp_lg_u32 s46,0
s_cbranch_scc1 L_moed_425
v_lshlrev_b32 v200,5,v1
v_add_u32 v200,155648,v200
ds_read_b128 v[168:171],v200
ds_read_b128 v[172:175],v200 offset:16
s_and_b32 s59,s55,0xffff0000
s_xor_b32 s60,s59,0x80000000
s_xor_b32 s61,s59,0xffff0000
s_cmp_lt_i32 s59,0
s_cselect_b32 s59,s60,s61
v_mov_b32 v200,s59
v_mul_f32 v200,0xbfb8aa3b,v200
v_exp_f32 v200,v200
s_nop 0
v_add_f32 v200,1.0,v200
v_rcp_f32 v200,v200
s_nop 0
v_cvt_pk_bf16_f32 v200,v200,v200
v_and_b32 v200,0xffff0000,v200
v_lshlrev_b32 v192,16,v104
v_and_b32 v193,0xffff0000,v104
v_lshlrev_b32 v194,16,v105
v_and_b32 v195,0xffff0000,v105
v_lshlrev_b32 v196,16,v106
v_and_b32 v197,0xffff0000,v106
v_lshlrev_b32 v198,16,v107
v_and_b32 v199,0xffff0000,v107
s_waitcnt lgkmcnt(0)
v_cvt_pk_bf16_f32 v184,v168,v169
v_cvt_pk_bf16_f32 v185,v170,v171
v_cvt_pk_bf16_f32 v186,v172,v173
v_cvt_pk_bf16_f32 v187,v174,v175
v_lshlrev_b32 v168,16,v184
v_and_b32 v169,0xffff0000,v184
v_lshlrev_b32 v170,16,v185
v_and_b32 v171,0xffff0000,v185
v_lshlrev_b32 v172,16,v186
v_and_b32 v173,0xffff0000,v186
v_lshlrev_b32 v174,16,v187
v_and_b32 v175,0xffff0000,v187
v_pk_mul_f32 v[168:169],v[168:169],v[200:201] op_sel_hi:[1,0]
v_pk_mul_f32 v[170:171],v[170:171],v[200:201] op_sel_hi:[1,0]
v_pk_mul_f32 v[172:173],v[172:173],v[200:201] op_sel_hi:[1,0]
v_pk_mul_f32 v[174:175],v[174:175],v[200:201] op_sel_hi:[1,0]
v_cvt_pk_bf16_f32 v184,v168,v169
v_cvt_pk_bf16_f32 v185,v170,v171
v_cvt_pk_bf16_f32 v186,v172,v173
v_cvt_pk_bf16_f32 v187,v174,v175
v_lshlrev_b32 v168,16,v184
v_and_b32 v169,0xffff0000,v184
v_lshlrev_b32 v170,16,v185
v_and_b32 v171,0xffff0000,v185
v_lshlrev_b32 v172,16,v186
v_and_b32 v173,0xffff0000,v186
v_lshlrev_b32 v174,16,v187
v_and_b32 v175,0xffff0000,v187
v_pk_add_f32 v[168:169],v[168:169],v[192:193]
v_pk_add_f32 v[170:171],v[170:171],v[194:195]
v_pk_add_f32 v[172:173],v[172:173],v[196:197]
v_pk_add_f32 v[174:175],v[174:175],v[198:199]
v_cvt_pk_bf16_f32 v184,v168,v169
v_cvt_pk_bf16_f32 v185,v170,v171
v_cvt_pk_bf16_f32 v186,v172,v173
v_cvt_pk_bf16_f32 v187,v174,v175
v_lshlrev_b32 v168,16,v184
v_and_b32 v169,0xffff0000,v184
v_lshlrev_b32 v170,16,v185
v_and_b32 v171,0xffff0000,v185
v_lshlrev_b32 v172,16,v186
v_and_b32 v173,0xffff0000,v186
v_lshlrev_b32 v174,16,v187
v_and_b32 v175,0xffff0000,v187
v_pk_add_f32 v[96:97],v[96:97],v[168:169]
v_pk_add_f32 v[98:99],v[98:99],v[170:171]
v_pk_add_f32 v[100:101],v[100:101],v[172:173]
v_pk_add_f32 v[102:103],v[102:103],v[174:175]
v_cvt_pk_bf16_f32 v160,v96,v97
v_cvt_pk_bf16_f32 v161,v98,v99
v_cvt_pk_bf16_f32 v162,v100,v101
v_cvt_pk_bf16_f32 v163,v102,v103
L_moed_425:
s_add_u32 s51,s51,1
s_add_u32 s62,s62,32768
s_add_u32 s65,s65,32768
s_branch L_mf_418
L_mf_419:
s_mov_b32 s4,s40
s_mov_b32 s5,s41
s_mov_b32 s6,2097152
s_mov_b32 s7,0x20000
s_or_b32 s61,s47,s46
s_cselect_b32 s56,0x80000000,s56
buffer_store_dwordx4 v[160:163],v0,s[4:7],s56 offen sc1
s_waitcnt vmcnt(0)
s_endpgm
L_mf_417:
s_cmp_lg_u32 s46,0
s_cbranch_scc1 L_mf_422
v_mov_b64 v[24:25],0
v_mov_b64 v[26:27],0
s_mov_b32 s56,94403584
buffer_store_dwordx4 v[24:27],v0,s[8:11],s56 offen sc1
s_mov_b32 s56,94436352
buffer_store_dwordx4 v[24:27],v0,s[8:11],s56 offen sc1
s_mov_b32 s56,94469120
buffer_store_dwordx4 v[24:27],v0,s[8:11],s56 offen sc1
s_mov_b32 s56,94501888
buffer_store_dwordx4 v[24:27],v0,s[8:11],s56 offen sc1
s_mov_b32 s56,94534656
buffer_store_dwordx4 v[24:27],v0,s[8:11],s56 offen sc1
s_mov_b32 s56,94567424
buffer_store_dwordx4 v[24:27],v0,s[8:11],s56 offen sc1
s_andn2_b32 s61,0x7ff,s54
s_lshr_b32 s61,s61,5
s_mov_b32 s59,11018240
v_lshlrev_b32 v2,2,v1
L_fp_429:
s_sleep 2
buffer_load_dword v3,v2,s[8:11],s59 offen sc1
s_sub_u32 s49,s49,1
s_cbranch_scc1 L_abort2
s_waitcnt vmcnt(0)
v_cmp_eq_u32 vcc,0,v3
s_cbranch_vccnz L_fp_429
v_cmp_le_u32 vcc,s61,v1
s_nop 1
v_cndmask_b32 v2,1,2,vcc
v_cmp_ne_u32 s[84:85],v2,v3
s_mov_b32 s56,11011324
buffer_store_dword v17,off,s[8:11],s56 sc1
s_mov_b32 s56,11019516
buffer_store_dword v17,off,s[8:11],s56 sc1
s_mov_b32 s56,11027708
buffer_store_dword v17,off,s[8:11],s56 sc1
s_mov_b32 s56,11035900
buffer_store_dword v17,off,s[8:11],s56 sc1
s_mov_b32 s56,11044092
buffer_store_dword v17,off,s[8:11],s56 sc1
s_mov_b32 s56,11052284
buffer_store_dword v17,off,s[8:11],s56 sc1
v_lshrrev_b32 v2,3,v1
v_and_b32 v3,0x70,v0
v_lshl_add_u32 v3,v2,13,v3
s_lshr_b64 s[20:21],s[84:85],0
v_lshrrev_b32 v60,v2,s20
v_and_b32 v60,1,v60
v_mul_u32_u24 v60,768,v60
v_sub_u32 v60,v3,v60
v_add_u32 v60,10487296,v60
s_lshr_b64 s[20:21],s[84:85],8
v_lshrrev_b32 v61,v2,s20
v_and_b32 v61,1,v61
v_mul_u32_u24 v61,768,v61
v_sub_u32 v61,v3,v61
v_add_u32 v61,10552832,v61
s_lshr_b64 s[20:21],s[84:85],16
v_lshrrev_b32 v62,v2,s20
v_and_b32 v62,1,v62
v_mul_u32_u24 v62,768,v62
v_sub_u32 v62,v3,v62
v_add_u32 v62,10618368,v62
s_lshr_b64 s[20:21],s[84:85],24
v_lshrrev_b32 v63,v2,s20
v_and_b32 v63,1,v63
v_mul_u32_u24 v63,768,v63
v_sub_u32 v63,v3,v63
v_add_u32 v63,10683904,v63
s_lshr_b64 s[20:21],s[84:85],32
v_lshrrev_b32 v64,v2,s20
v_and_b32 v64,1,v64
v_mul_u32_u24 v64,768,v64
v_sub_u32 v64,v3,v64
v_add_u32 v64,10749440,v64
s_lshr_b64 s[20:21],s[84:85],40
v_lshrrev_b32 v65,v2,s20
v_and_b32 v65,1,v65
v_mul_u32_u24 v65,768,v65
v_sub_u32 v65,v3,v65
v_add_u32 v65,10814976,v65
s_lshr_b64 s[20:21],s[84:85],48
v_lshrrev_b32 v66,v2,s20
v_and_b32 v66,1,v66
v_mul_u32_u24 v66,768,v66
v_sub_u32 v66,v3,v66
v_add_u32 v66,10880512,v66
s_lshr_b64 s[20:21],s[84:85],56
v_lshrrev_b32 v67,v2,s20
v_and_b32 v67,1,v67
v_mul_u32_u24 v67,768,v67
v_sub_u32 v67,v3,v67
v_add_u32 v67,10946048,v67
v_and_b32 v68,3,v1
v_lshlrev_b32 v68,7,v68
v_add_u32 v68,10486272,v68
v_and_b32 v69,31,v1
v_lshlrev_b32 v69,2,v69
v_add_u32 v69,10478720,v69
s_mov_b32 s66,0
s_mov_b32 s67,524288
v_mov_b32 v57,0
s_mov_b32 s58,1
L_mf_420:
s_sub_u32 s49,s49,1
s_cbranch_scc1 L_abort2
s_mov_b32 s57,0
s_cmp_lg_u32 s58,0
s_cbranch_scc1 L_ms_430
buffer_load_dwordx4 v[52:55],v67,s[8:11],0 offen sc1
buffer_load_dword v70,v69,s[8:11],s67 offen sc1
s_branch L_mj_431
L_ms_430:
buffer_load_dwordx4 v[24:27],v60,s[8:11],0 offen sc1
buffer_load_dwordx4 v[28:31],v61,s[8:11],0 offen sc1
buffer_load_dwordx4 v[32:35],v62,s[8:11],0 offen sc1
buffer_load_dwordx4 v[36:39],v63,s[8:11],0 offen sc1
buffer_load_dwordx4 v[40:43],v64,s[8:11],0 offen sc1
buffer_load_dwordx4 v[44:47],v65,s[8:11],0 offen sc1
buffer_load_dwordx4 v[48:51],v66,s[8:11],0 offen sc1
buffer_load_dwordx4 v[52:55],v67,s[8:11],0 offen sc1
buffer_load_dword v70,v69,s[8:11],s67 offen sc1
s_waitcnt vmcnt(8)
v_min3_u32 v56,v24,v25,v26
v_max3_u32 v57,v24,v25,v57
v_min_u32 v56,v27,v56
v_max3_u32 v57,v26,v27,v57
v_cmp_eq_u32 vcc,0,v56
s_bcnt1_i32_b64 s56,vcc
s_add_u32 s57,s57,s56
s_waitcnt vmcnt(7)
v_min3_u32 v56,v28,v29,v30
v_max3_u32 v57,v28,v29,v57
v_min_u32 v56,v31,v56
v_max3_u32 v57,v30,v31,v57
v_cmp_eq_u32 vcc,0,v56
s_bcnt1_i32_b64 s56,vcc
s_add_u32 s57,s57,s56
s_waitcnt vmcnt(6)
v_min3_u32 v56,v32,v33,v34
v_max3_u32 v57,v32,v33,v57
v_min_u32 v56,v35,v56
v_max3_u32 v57,v34,v35,v57
v_cmp_eq_u32 vcc,0,v56
s_bcnt1_i32_b64 s56,vcc
s_add_u32 s57,s57,s56
s_waitcnt vmcnt(5)
v_min3_u32 v56,v36,v37,v38
v_max3_u32 v57,v36,v37,v57
v_min_u32 v56,v39,v56
v_max3_u32 v57,v38,v39,v57
v_cmp_eq_u32 vcc,0,v56
s_bcnt1_i32_b64 s56,vcc
s_add_u32 s57,s57,s56
s_waitcnt vmcnt(4)
v_min3_u32 v56,v40,v41,v42
v_max3_u32 v57,v40,v41,v57
v_min_u32 v56,v43,v56
v_max3_u32 v57,v42,v43,v57
v_cmp_eq_u32 vcc,0,v56
s_bcnt1_i32_b64 s56,vcc
s_add_u32 s57,s57,s56
s_waitcnt vmcnt(3)
v_min3_u32 v56,v44,v45,v46
v_max3_u32 v57,v44,v45,v57
v_min_u32 v56,v47,v56
v_max3_u32 v57,v46,v47,v57
v_cmp_eq_u32 vcc,0,v56
s_bcnt1_i32_b64 s56,vcc
s_add_u32 s57,s57,s56
s_waitcnt vmcnt(2)
v_min3_u32 v56,v48,v49,v50
v_max3_u32 v57,v48,v49,v57
v_min_u32 v56,v51,v56
v_max3_u32 v57,v50,v51,v57
v_cmp_eq_u32 vcc,0,v56
s_bcnt1_i32_b64 s56,vcc
s_add_u32 s57,s57,s56
s_mov_b32 s58,s57
L_mj_431:
s_waitcnt vmcnt(1)
v_min3_u32 v56,v52,v53,v54
v_max3_u32 v57,v52,v53,v57
v_min_u32 v56,v55,v56
v_max3_u32 v57,v54,v55,v57
v_cmp_eq_u32 vcc,0,v56
s_bcnt1_i32_b64 s56,vcc
s_add_u32 s57,s57,s56
v_max_u32_dpp v57,v57,v57 row_ror:8 row_mask:0xf bank_mask:0xf
s_nop 1
v_max_u32_dpp v57,v57,v57 row_ror:4 row_mask:0xf bank_mask:0xf
s_nop 1
v_max_u32_dpp v57,v57,v57 row_ror:2 row_mask:0xf bank_mask:0xf
s_nop 1
v_max_u32_dpp v57,v57,v57 row_ror:1 row_mask:0xf bank_mask:0xf
v_mov_b32 v58,v57
s_nop 1
v_permlane16_swap_b32 v57,v58
v_max_u32 v57,v57,v58
v_mov_b32 v58,v57
s_nop 1
v_permlane32_swap_b32 v57,v58
v_max_u32 v57,v57,v58
s_nop 0
v_readfirstlane_b32 s55,v57
s_cmp_lg_u32 s55,s66
s_cbranch_scc1 L_mf_421
s_cmp_lg_u32 s57,0
s_cbranch_scc1 L_mf_420
v_mov_b32 v57,1
buffer_store_dword v57,v68,s[8:11],s67 offen sc1
L_mf_422:
s_waitcnt vmcnt(0)
s_endpgm
L_mf_421:
s_waitcnt vmcnt(0)
v_cmp_eq_u32 vcc,0,v70
s_cmp_eq_u32 s66,0
s_cselect_b32 s56,0,vcc_lo
s_cmp_gt_u32 s57,112
s_cselect_b32 s56,1,s56
s_cmp_ge_u32 s67,565248
s_cselect_b32 s56,1,s56
s_cmp_eq_u32 s57,0
s_cselect_b32 s56,0,s56
s_cmp_lg_u32 s56,0
s_cbranch_scc1 L_mf_420
buffer_store_dword v57,v68,s[8:11],s67 offen sc1
s_mov_b32 s66,s55
s_add_u32 s67,s67,8192
s_branch L_mf_420
s_endpgm
.section .rodata,"a"
.p2align 6
.amdhsa_kernel interleave_layers__memory_aug_recurrent_mem_tr__moe_arch_mod__prompt_kernel
  .amdhsa_next_free_vgpr 512
  .amdhsa_next_free_sgpr 102
  .amdhsa_accum_offset 256
  .amdhsa_group_segment_fixed_size 0
  .amdhsa_kernarg_size 120
  .amdhsa_user_sgpr_count 2
  .amdhsa_user_sgpr_kernarg_segment_ptr 1
  .amdhsa_system_sgpr_workgroup_id_x 1
  .amdhsa_float_denorm_mode_32 3
.end_amdhsa_kernel
```

```asm
; @launch grid=(256,1,1) block=(256,1,1) lds=163840
.amdgcn_target "amdgcn-amd-amdhsa--gfx950"
.text
.globl interleave_layers__memory_aug_recurrent_mem_tr__moe_arch_mod__prompt_kernel
.p2align 8
.type interleave_layers__memory_aug_recurrent_mem_tr__moe_arch_mod__prompt_kernel,@function
interleave_layers__memory_aug_recurrent_mem_tr__moe_arch_mod__prompt_kernel:
s_cmp_ge_u32 s2,256
s_cbranch_scc1 L_abort
s_load_dwordx16 s[16:31],s[0:1],0
s_load_dwordx8 s[32:39],s[0:1],64
s_load_dwordx4 s[40:43],s[0:1],96
s_load_dwordx2 s[44:45],s[0:1],112
v_lshrrev_b32 v2,6,v0
v_and_b32 v1,63,v0
v_readfirstlane_b32 s46,v2
v_lshlrev_b32 v0,4,v1
s_getreg_b32 s48,hwreg(HW_REG_XCC_ID)
s_and_b32 s48,s48,7
s_lshl_b32 s48,s48,2
s_lshr_b32 s48,1399931488,s48
s_and_b32 s48,s48,7
s_mov_b32 s49,100000
s_mov_b32 s80,0x3e0293ee
s_waitcnt lgkmcnt(0)
s_mov_b32 s8,s44
s_mov_b32 s9,s45
s_mov_b32 s10,268435456
s_mov_b32 s11,0x20000
s_mov_b32 s12,s42
s_mov_b32 s13,s43
s_mov_b32 s14,256
s_mov_b32 s15,0x20000
s_lshl_b32 s56,s48,2
s_lshr_b32 s56,2822958528,s56
s_and_b32 s56,s56,15
s_lshl_b32 s56,s56,4
v_mov_b32 v14,s56
v_mov_b32 v15,1
s_cmp_lg_u32 s46,0
s_cbranch_scc1 L_tk_1
s_cmp_ge_u32 s56,192
s_cbranch_scc1 L_tk_1
s_mov_b64 exec,1
buffer_atomic_add v15,v14,s[12:15],0 offen sc0
s_mov_b64 exec,-1
L_tk_1:
s_mov_b32 s4,s18
s_mov_b32 s5,s19
s_mov_b32 s6,8192
s_mov_b32 s7,0x20000
s_cmp_ge_u32 s2,2
s_cbranch_scc1 L_m0_2
s_lshl_b32 s56,s2,2
s_add_u32 s56,s56,s46
v_bfe_u32 v2,v1,2,2
v_and_b32 v3,1,v1
v_lshl_add_u32 v2,v2,1,v3
v_lshlrev_b32 v2,10,v2
v_lshrrev_b32 v3,4,v1
v_lshl_add_u32 v2,v3,5,v2
v_and_b32 v3,2,v1
v_lshl_add_u32 v2,v3,1,v2
s_lshl_b32 s57,s56,7
buffer_load_dword v64,v2,s[4:7],s57 offen offset:0
buffer_load_dword v65,v2,s[4:7],s57 offen offset:8
buffer_load_dword v66,v2,s[4:7],s57 offen offset:16
buffer_load_dword v67,v2,s[4:7],s57 offen offset:24
L_m0_2:
s_mov_b32 s4,s16
s_mov_b32 s5,s17
s_mov_b32 s6,2097152
s_mov_b32 s7,0x20000
s_lshl_b32 s56,s2,3
s_lshl_b32 s65,s46,1
s_add_u32 s56,s56,s65
s_lshl_b32 s65,s56,10
buffer_load_dwordx4 v[24:27],v0,s[4:7],s65 offen
buffer_load_dwordx4 v[28:31],v0,s[4:7],s65 offen offset:1024
s_lshl_b32 s56,s2,12
s_lshl_b32 s57,s46,10
s_add_u32 s56,s56,s57
v_add_u32 v2,s56,v0
v_mov_b32 v4,-1
v_mov_b32 v5,-1
v_mov_b32 v6,-1
v_mov_b32 v7,-1
v_mov_b32 v8,0
v_mov_b32 v9,0
v_mov_b32 v10,0
v_mov_b32 v11,0
v_cmp_gt_u32 vcc,524288,v2
v_mov_b32 v3,14155776
v_mov_b32 v12,11542528
v_cndmask_b32 v3,v3,v12,vcc
v_add_u32 v3,v3,v2
s_mov_b32 s56,0
buffer_store_dwordx4 v[4:7],v3,s[8:11],s56 offen sc1
s_mov_b32 s56,1048576
buffer_store_dwordx4 v[4:7],v3,s[8:11],s56 offen sc1
s_mov_b32 s56,2097152
buffer_store_dwordx4 v[4:7],v3,s[8:11],s56 offen sc1
s_mov_b32 s56,4194304
buffer_store_dwordx4 v[4:7],v2,s[8:11],s56 offen sc1
s_mov_b32 s56,5242880
buffer_store_dwordx4 v[4:7],v2,s[8:11],s56 offen sc1
v_add_u32 v3,17309696,v2
v_mov_b32 v12,0x80000000
v_cndmask_b32 v3,v3,v12,vcc
buffer_store_dwordx4 v[4:7],v3,s[8:11],0 offen sc1
v_cmp_gt_u32 vcc,147456,v2
v_lshrrev_b32 v3,11,v2
v_lshlrev_b32 v3,13,v3
v_and_b32 v13,0x7ff,v2
v_add_u32 v3,v3,v13
v_add_u32 v3,10485760,v3
v_cndmask_b32 v3,v12,v3,vcc
buffer_store_dwordx4 v[8:11],v3,s[8:11],0 offen sc1
v_add_u32 v3,11075584,v2
v_lshrrev_b32 v13,16,v2
v_cmp_eq_u32 vcc,4,v13
s_nop 1
v_cndmask_b32 v3,v12,v3,vcc
buffer_store_dwordx4 v[4:7],v3,s[8:11],0 offen sc1
s_cmp_lg_u32 s46,0
s_cbranch_scc1 L_tk_3
s_mov_b64 exec,1
s_sub_u32 s56,s48,1
s_cmp_gt_u32 s56,2
s_cbranch_scc1 L_tk_3x
s_waitcnt vmcnt(8)
buffer_atomic_add v15,v14,s[12:15],0 offen sc0
s_waitcnt vmcnt(0)
L_tk_3x:
v_mov_b32 v14,159744
s_waitcnt vmcnt(10)
ds_write_b32 v14,v15
s_mov_b64 exec,-1
s_waitcnt lgkmcnt(0)
L_tk_3:
s_barrier
v_mov_b32 v14,159744
ds_read_b32 v2,v14
s_waitcnt lgkmcnt(0)
v_readfirstlane_b32 s47,v2
s_mov_b32 s3,0
s_cmp_ge_u32 s47,32
s_cselect_b32 s53,0x10001,1
s_and_b32 s47,s47,31
s_lshl_b32 s50,s46,10
s_cmp_eq_u32 s46,0
s_cselect_b32 s52,0,0x80000000
s_mov_b32 s28,0x3f803f80
s_mov_b32 s29,0x3f803f80
s_mov_b32 s51,0
s_bfe_u32 s56,s48,0x10001
s_and_b32 s57,s48,1
s_add_u32 s58,s56,6
s_sub_u32 s59,5,s57
s_cmp_ge_u32 s47,16
s_cselect_b32 s58,s58,s59
s_cselect_b32 s57,s57,s56
s_and_b32 s59,s47,15
s_lshl4_add_u32 s57,s57,s59
s_cmp_ge_u32 s48,4
s_cselect_b32 s48,s58,s48
s_cselect_b32 s47,s57,s47
L_roles:
s_lshl_b32 s56,1,s48
s_and_b32 s56,s56,6
s_cbranch_scc0 L_x_10
s_cmp_eq_u32 s53,0
s_cbranch_scc1 L_m0_11
s_waitcnt vmcnt(8)
v_lshlrev_b32 v32,16,v24
v_and_b32 v33,0xffff0000,v24
v_lshlrev_b32 v34,16,v25
v_and_b32 v35,0xffff0000,v25
v_lshlrev_b32 v36,16,v26
v_and_b32 v37,0xffff0000,v26
v_lshlrev_b32 v38,16,v27
v_and_b32 v39,0xffff0000,v27
v_readfirstlane_b32 s78,v32
s_nop 1
v_pk_add_f32 v[48:49],v[32:33],s[78:79] op_sel_hi:[1,0] neg_lo:[0,1] neg_hi:[0,1]
v_pk_add_f32 v[50:51],v[34:35],s[78:79] op_sel_hi:[1,0] neg_lo:[0,1] neg_hi:[0,1]
v_pk_add_f32 v[52:53],v[36:37],s[78:79] op_sel_hi:[1,0] neg_lo:[0,1] neg_hi:[0,1]
v_pk_add_f32 v[54:55],v[38:39],s[78:79] op_sel_hi:[1,0] neg_lo:[0,1] neg_hi:[0,1]
v_pk_add_f32 v[56:57],v[48:49],v[50:51]
v_pk_mul_f32 v[58:59],v[48:49],v[48:49]
v_pk_add_f32 v[60:61],v[52:53],v[54:55]
v_pk_fma_f32 v[58:59],v[50:51],v[50:51],v[58:59]
v_pk_add_f32 v[56:57],v[56:57],v[60:61]
v_pk_fma_f32 v[58:59],v[52:53],v[52:53],v[58:59]
v_add_f32 v56,v56,v57
v_pk_fma_f32 v[58:59],v[54:55],v[54:55],v[58:59]
v_add_f32 v58,v58,v59
s_nop 1
v_permlane32_swap_b32 v56,v58
v_add_f32 v56,v56,v58
s_nop 1
v_add_f32_dpp v56,v56,v56 row_ror:8 row_mask:0xf bank_mask:0xf
s_nop 1
v_add_f32_dpp v56,v56,v56 row_ror:4 row_mask:0xf bank_mask:0xf
s_nop 1
v_add_f32_dpp v56,v56,v56 row_ror:2 row_mask:0xf bank_mask:0xf
s_nop 1
v_add_f32_dpp v56,v56,v56 row_ror:1 row_mask:0xf bank_mask:0xf
v_mov_b32 v58,v56
s_nop 1
v_permlane16_swap_b32 v56,v58
v_add_f32 v56,v56,v58
v_mul_f32 v56,0x3b000000,v56
v_mov_b32 v58,v56
s_nop 1
v_permlane32_swap_b32 v56,v58
v_fma_f32 v58,-v56,v56,v58
v_add_f32 v56,s78,v56
v_max_f32 v58,0,v58
v_cvt_pk_bf16_f32 v58,v56,v58
v_lshlrev_b32 v56,16,v58
v_and_b32 v58,0xffff0000,v58
v_add_f32 v58,0x3727c5ac,v58
v_cvt_pk_bf16_f32 v58,v58,v58
v_and_b32 v58,0xffff0000,v58
v_sqrt_f32 v58,v58
v_pk_add_f32 v[48:49],v[32:33],v[56:57] op_sel_hi:[1,0] neg_lo:[0,1] neg_hi:[0,1]
v_pk_add_f32 v[50:51],v[34:35],v[56:57] op_sel_hi:[1,0] neg_lo:[0,1] neg_hi:[0,1]
v_pk_add_f32 v[52:53],v[36:37],v[56:57] op_sel_hi:[1,0] neg_lo:[0,1] neg_hi:[0,1]
v_pk_add_f32 v[54:55],v[38:39],v[56:57] op_sel_hi:[1,0] neg_lo:[0,1] neg_hi:[0,1]
v_cvt_pk_bf16_f32 v58,v58,v58
v_and_b32 v58,0xffff0000,v58
v_rcp_f32 v58,v58
v_cvt_pk_bf16_f32 v40,v48,v49
v_cvt_pk_bf16_f32 v41,v50,v51
v_cvt_pk_bf16_f32 v42,v52,v53
v_cvt_pk_bf16_f32 v43,v54,v55
v_lshlrev_b32 v48,16,v40
v_and_b32 v49,0xffff0000,v40
v_lshlrev_b32 v50,16,v41
v_and_b32 v51,0xffff0000,v41
v_lshlrev_b32 v52,16,v42
v_and_b32 v53,0xffff0000,v42
v_lshlrev_b32 v54,16,v43
v_and_b32 v55,0xffff0000,v43
v_pk_mul_f32 v[48:49],v[48:49],v[58:59] op_sel_hi:[1,0]
v_pk_mul_f32 v[50:51],v[50:51],v[58:59] op_sel_hi:[1,0]
v_pk_mul_f32 v[52:53],v[52:53],v[58:59] op_sel_hi:[1,0]
v_pk_mul_f32 v[54:55],v[54:55],v[58:59] op_sel_hi:[1,0]
v_cvt_pk_bf16_f32 v40,v48,v49
v_cvt_pk_bf16_f32 v41,v50,v51
v_cvt_pk_bf16_f32 v42,v52,v53
v_cvt_pk_bf16_f32 v43,v54,v55
buffer_store_dwordx4 v[40:43],v0,s[8:11],s65 offen offset:0 sc1
v_lshlrev_b32 v32,16,v28
v_and_b32 v33,0xffff0000,v28
v_lshlrev_b32 v34,16,v29
v_and_b32 v35,0xffff0000,v29
v_lshlrev_b32 v36,16,v30
v_and_b32 v37,0xffff0000,v30
v_lshlrev_b32 v38,16,v31
v_and_b32 v39,0xffff0000,v31
v_readfirstlane_b32 s78,v32
s_nop 1
v_pk_add_f32 v[48:49],v[32:33],s[78:79] op_sel_hi:[1,0] neg_lo:[0,1] neg_hi:[0,1]
v_pk_add_f32 v[50:51],v[34:35],s[78:79] op_sel_hi:[1,0] neg_lo:[0,1] neg_hi:[0,1]
v_pk_add_f32 v[52:53],v[36:37],s[78:79] op_sel_hi:[1,0] neg_lo:[0,1] neg_hi:[0,1]
v_pk_add_f32 v[54:55],v[38:39],s[78:79] op_sel_hi:[1,0] neg_lo:[0,1] neg_hi:[0,1]
v_pk_add_f32 v[56:57],v[48:49],v[50:51]
v_pk_mul_f32 v[58:59],v[48:49],v[48:49]
v_pk_add_f32 v[60:61],v[52:53],v[54:55]
v_pk_fma_f32 v[58:59],v[50:51],v[50:51],v[58:59]
v_pk_add_f32 v[56:57],v[56:57],v[60:61]
v_pk_fma_f32 v[58:59],v[52:53],v[52:53],v[58:59]
v_add_f32 v56,v56,v57
v_pk_fma_f32 v[58:59],v[54:55],v[54:55],v[58:59]
v_add_f32 v58,v58,v59
s_nop 1
v_permlane32_swap_b32 v56,v58
v_add_f32 v56,v56,v58
s_nop 1
v_add_f32_dpp v56,v56,v56 row_ror:8 row_mask:0xf bank_mask:0xf
s_nop 1
v_add_f32_dpp v56,v56,v56 row_ror:4 row_mask:0xf bank_mask:0xf
s_nop 1
v_add_f32_dpp v56,v56,v56 row_ror:2 row_mask:0xf bank_mask:0xf
s_nop 1
v_add_f32_dpp v56,v56,v56 row_ror:1 row_mask:0xf bank_mask:0xf
v_mov_b32 v58,v56
s_nop 1
v_permlane16_swap_b32 v56,v58
v_add_f32 v56,v56,v58
v_mul_f32 v56,0x3b000000,v56
v_mov_b32 v58,v56
s_nop 1
v_permlane32_swap_b32 v56,v58
v_fma_f32 v58,-v56,v56,v58
v_add_f32 v56,s78,v56
v_max_f32 v58,0,v58
v_cvt_pk_bf16_f32 v58,v56,v58
v_lshlrev_b32 v56,16,v58
v_and_b32 v58,0xffff0000,v58
v_add_f32 v58,0x3727c5ac,v58
v_cvt_pk_bf16_f32 v58,v58,v58
v_and_b32 v58,0xffff0000,v58
v_sqrt_f32 v58,v58
v_pk_add_f32 v[48:49],v[32:33],v[56:57] op_sel_hi:[1,0] neg_lo:[0,1] neg_hi:[0,1]
v_pk_add_f32 v[50:51],v[34:35],v[56:57] op_sel_hi:[1,0] neg_lo:[0,1] neg_hi:[0,1]
v_pk_add_f32 v[52:53],v[36:37],v[56:57] op_sel_hi:[1,0] neg_lo:[0,1] neg_hi:[0,1]
v_pk_add_f32 v[54:55],v[38:39],v[56:57] op_sel_hi:[1,0] neg_lo:[0,1] neg_hi:[0,1]
v_cvt_pk_bf16_f32 v58,v58,v58
v_and_b32 v58,0xffff0000,v58
v_rcp_f32 v58,v58
v_cvt_pk_bf16_f32 v44,v48,v49
v_cvt_pk_bf16_f32 v45,v50,v51
v_cvt_pk_bf16_f32 v46,v52,v53
v_cvt_pk_bf16_f32 v47,v54,v55
v_lshlrev_b32 v48,16,v44
v_and_b32 v49,0xffff0000,v44
v_lshlrev_b32 v50,16,v45
v_and_b32 v51,0xffff0000,v45
v_lshlrev_b32 v52,16,v46
v_and_b32 v53,0xffff0000,v46
v_lshlrev_b32 v54,16,v47
v_and_b32 v55,0xffff0000,v47
v_pk_mul_f32 v[48:49],v[48:49],v[58:59] op_sel_hi:[1,0]
v_pk_mul_f32 v[50:51],v[50:51],v[58:59] op_sel_hi:[1,0]
v_pk_mul_f32 v[52:53],v[52:53],v[58:59] op_sel_hi:[1,0]
v_pk_mul_f32 v[54:55],v[54:55],v[58:59] op_sel_hi:[1,0]
v_cvt_pk_bf16_f32 v44,v48,v49
v_cvt_pk_bf16_f32 v45,v50,v51
v_cvt_pk_bf16_f32 v46,v52,v53
v_cvt_pk_bf16_f32 v47,v54,v55
buffer_store_dwordx4 v[44:47],v0,s[8:11],s65 offen offset:1024 sc1
s_cmp_ge_u32 s2,2
s_cbranch_scc1 L_m0_11
v_lshrrev_b32 v12,3,v1
v_lshlrev_b32 v12,9,v12
v_and_b32 v13,7,v1
v_lshl_add_u32 v12,v13,4,v12
s_lshl_b32 s66,s2,2
s_add_u32 s66,s66,s46
s_and_b32 s67,s66,1
s_lshl_b32 s67,s67,8
s_and_b32 s68,s66,2
s_lshl_b32 s68,s68,6
s_add_u32 s67,s67,s68
s_and_b32 s68,s66,4
s_lshl_b32 s68,s68,10
s_add_u32 s67,s67,s68
s_add_u32 s68,s67,11534336
buffer_store_dwordx4 v[64:67],v12,s[8:11],s68 offen sc1
s_add_u32 s68,s67,12582912
buffer_store_dwordx4 v[64:67],v12,s[8:11],s68 offen sc1
s_add_u32 s68,s67,17825792
buffer_store_dwordx4 v[64:67],v12,s[8:11],s68 offen sc1
L_m0_11:
s_waitcnt vmcnt(0)
s_barrier
s_cmp_lg_u32 s46,0
s_cbranch_scc1 L_ar_12
v_mov_b32 v8,240
v_mov_b32 v9,s53
s_mov_b64 exec,1
buffer_atomic_add v9,v8,s[12:15],0 offen
s_mov_b64 exec,-1
L_ar_12:
s_mov_b32 s53,0
v_mov_b32 v123,159744
s_cmp_lg_u32 s46,0
s_cbranch_scc1 L_gbd_14
v_mov_b32 v124,240
L_gb_13:
buffer_load_dword v125,v124,s[12:15],0 offen sc1
s_waitcnt vmcnt(0)
v_readfirstlane_b32 s56,v125
ds_write_b32 v123,v125
s_bitcmp1_b32 s56,8
s_cbranch_scc1 L_gbd_14
s_sleep 4
s_sub_u32 s49,s49,1
s_cmp_gt_i32 s49,0
s_cbranch_scc1 L_gb_13
s_branch L_abort
L_gbd_14:
s_waitcnt lgkmcnt(0)
s_barrier
ds_read_b32 v125,v123
s_waitcnt lgkmcnt(0)
v_readfirstlane_b32 s56,v125
s_barrier
s_lshr_b32 s56,s56,16
s_andn2_b32 s56,s56,s3
s_cbranch_scc1 L_spread
s_cmp_lg_u32 s48,2
s_cbranch_scc1 L_y_15
s_sleep 30
L_y_15:
L_x_10:
s_cmp_ge_u32 s48,6
s_cbranch_scc1 L_ra_6
v_lshrrev_b32 v2,2,v1
v_lshrrev_b32 v3,5,v1
v_xor_b32 v2,v2,v3
v_lshlrev_b32 v2,13,v2
v_and_b32 v3,3,v1
v_lshl_add_u32 v2,v3,4,v2
v_and_b32 v3,15,v1
v_lshlrev_b32 v3,2,v3
v_lshrrev_b32 v4,4,v1
v_lshl_add_u32 v3,v4,9,v3
v_and_b32 v4,1,v4
v_lshl_add_u32 v3,v4,6,v3
s_lshl_b32 s59,s46,15
s_cmp_lt_u32 s48,3
s_cselect_b32 s63,s46,0
s_lshl_b32 s56,s63,12
s_add_u32 s56,s59,s56
v_add_u32 v3,s56,v3
v_xor_b32 v4,64,v3
s_lshl_b32 s58,s47,8
s_lshl_b32 s56,s46,6
s_add_u32 s58,s58,s56
s_mov_b32 s61,0x05040100
s_mov_b32 s62,0x07060302
s_mov_b32 s4,s22
s_mov_b32 s5,s23
s_mov_b32 s6,4194304
s_mov_b32 s7,0x20000
s_xor_b32 m0,s59,0
s_xor_b32 s60,s58,0
buffer_load_dwordx4 v2,s[4:7],s60 offen lds
s_add_u32 m0,m0,1024
s_add_u32 s60,s60,131072
buffer_load_dwordx4 v2,s[4:7],s60 offen lds
s_xor_b32 m0,s59,2048
s_xor_b32 s60,s58,262144
buffer_load_dwordx4 v2,s[4:7],s60 offen lds
s_add_u32 m0,m0,1024
s_add_u32 s60,s60,131072
buffer_load_dwordx4 v2,s[4:7],s60 offen lds
s_xor_b32 m0,s59,4096
s_xor_b32 s60,s58,524288
buffer_load_dwordx4 v2,s[4:7],s60 offen lds
s_add_u32 m0,m0,1024
s_add_u32 s60,s60,131072
buffer_load_dwordx4 v2,s[4:7],s60 offen lds
s_xor_b32 m0,s59,6144
s_xor_b32 s60,s58,786432
buffer_load_dwordx4 v2,s[4:7],s60 offen lds
s_add_u32 m0,m0,1024
s_add_u32 s60,s60,131072
buffer_load_dwordx4 v2,s[4:7],s60 offen lds
s_xor_b32 m0,s59,8192
s_xor_b32 s60,s58,1048576
buffer_load_dwordx4 v2,s[4:7],s60 offen lds
s_add_u32 m0,m0,1024
s_add_u32 s60,s60,131072
buffer_load_dwordx4 v2,s[4:7],s60 offen lds
s_xor_b32 m0,s59,10240
s_xor_b32 s60,s58,1310720
buffer_load_dwordx4 v2,s[4:7],s60 offen lds
s_add_u32 m0,m0,1024
s_add_u32 s60,s60,131072
buffer_load_dwordx4 v2,s[4:7],s60 offen lds
s_xor_b32 m0,s59,12288
s_xor_b32 s60,s58,1572864
buffer_load_dwordx4 v2,s[4:7],s60 offen lds
s_add_u32 m0,m0,1024
s_add_u32 s60,s60,131072
buffer_load_dwordx4 v2,s[4:7],s60 offen lds
s_xor_b32 m0,s59,14336
s_xor_b32 s60,s58,1835008
buffer_load_dwordx4 v2,s[4:7],s60 offen lds
s_add_u32 m0,m0,1024
s_add_u32 s60,s60,131072
buffer_load_dwordx4 v2,s[4:7],s60 offen lds
s_xor_b32 m0,s59,16384
s_xor_b32 s60,s58,2097152
buffer_load_dwordx4 v2,s[4:7],s60 offen lds
s_add_u32 m0,m0,1024
s_add_u32 s60,s60,131072
buffer_load_dwordx4 v2,s[4:7],s60 offen lds
s_xor_b32 m0,s59,18432
s_xor_b32 s60,s58,2359296
buffer_load_dwordx4 v2,s[4:7],s60 offen lds
s_add_u32 m0,m0,1024
s_add_u32 s60,s60,131072
buffer_load_dwordx4 v2,s[4:7],s60 offen lds
s_xor_b32 m0,s59,20480
s_xor_b32 s60,s58,2621440
buffer_load_dwordx4 v2,s[4:7],s60 offen lds
s_add_u32 m0,m0,1024
s_add_u32 s60,s60,131072
buffer_load_dwordx4 v2,s[4:7],s60 offen lds
s_xor_b32 m0,s59,22528
s_xor_b32 s60,s58,2883584
buffer_load_dwordx4 v2,s[4:7],s60 offen lds
s_add_u32 m0,m0,1024
s_add_u32 s60,s60,131072
buffer_load_dwordx4 v2,s[4:7],s60 offen lds
s_xor_b32 m0,s59,24576
s_xor_b32 s60,s58,3145728
buffer_load_dwordx4 v2,s[4:7],s60 offen lds
s_add_u32 m0,m0,1024
s_add_u32 s60,s60,131072
buffer_load_dwordx4 v2,s[4:7],s60 offen lds
s_xor_b32 m0,s59,26624
s_xor_b32 s60,s58,3407872
buffer_load_dwordx4 v2,s[4:7],s60 offen lds
s_add_u32 m0,m0,1024
s_add_u32 s60,s60,131072
buffer_load_dwordx4 v2,s[4:7],s60 offen lds
s_xor_b32 m0,s59,28672
s_xor_b32 s60,s58,3670016
buffer_load_dwordx4 v2,s[4:7],s60 offen lds
s_add_u32 m0,m0,1024
s_add_u32 s60,s60,131072
buffer_load_dwordx4 v2,s[4:7],s60 offen lds
s_xor_b32 m0,s59,30720
s_xor_b32 s60,s58,3932160
buffer_load_dwordx4 v2,s[4:7],s60 offen lds
s_add_u32 m0,m0,1024
s_add_u32 s60,s60,131072
buffer_load_dwordx4 v2,s[4:7],s60 offen lds
s_cmp_eq_u32 s53,0
s_cbranch_scc1 L_m0_16
s_waitcnt vmcnt(40)
v_lshlrev_b32 v32,16,v24
v_and_b32 v33,0xffff0000,v24
v_lshlrev_b32 v34,16,v25
v_and_b32 v35,0xffff0000,v25
v_lshlrev_b32 v36,16,v26
v_and_b32 v37,0xffff0000,v26
v_lshlrev_b32 v38,16,v27
v_and_b32 v39,0xffff0000,v27
v_readfirstlane_b32 s78,v32
s_nop 1
v_pk_add_f32 v[48:49],v[32:33],s[78:79] op_sel_hi:[1,0] neg_lo:[0,1] neg_hi:[0,1]
v_pk_add_f32 v[50:51],v[34:35],s[78:79] op_sel_hi:[1,0] neg_lo:[0,1] neg_hi:[0,1]
v_pk_add_f32 v[52:53],v[36:37],s[78:79] op_sel_hi:[1,0] neg_lo:[0,1] neg_hi:[0,1]
v_pk_add_f32 v[54:55],v[38:39],s[78:79] op_sel_hi:[1,0] neg_lo:[0,1] neg_hi:[0,1]
v_pk_add_f32 v[56:57],v[48:49],v[50:51]
v_pk_mul_f32 v[58:59],v[48:49],v[48:49]
v_pk_add_f32 v[60:61],v[52:53],v[54:55]
v_pk_fma_f32 v[58:59],v[50:51],v[50:51],v[58:59]
v_pk_add_f32 v[56:57],v[56:57],v[60:61]
v_pk_fma_f32 v[58:59],v[52:53],v[52:53],v[58:59]
v_add_f32 v56,v56,v57
v_pk_fma_f32 v[58:59],v[54:55],v[54:55],v[58:59]
v_add_f32 v58,v58,v59
s_nop 1
v_permlane32_swap_b32 v56,v58
v_add_f32 v56,v56,v58
s_nop 1
v_add_f32_dpp v56,v56,v56 row_ror:8 row_mask:0xf bank_mask:0xf
s_nop 1
v_add_f32_dpp v56,v56,v56 row_ror:4 row_mask:0xf bank_mask:0xf
s_nop 1
v_add_f32_dpp v56,v56,v56 row_ror:2 row_mask:0xf bank_mask:0xf
s_nop 1
v_add_f32_dpp v56,v56,v56 row_ror:1 row_mask:0xf bank_mask:0xf
v_mov_b32 v58,v56
s_nop 1
v_permlane16_swap_b32 v56,v58
v_add_f32 v56,v56,v58
v_mul_f32 v56,0x3b000000,v56
v_mov_b32 v58,v56
s_nop 1
v_permlane32_swap_b32 v56,v58
v_fma_f32 v58,-v56,v56,v58
v_add_f32 v56,s78,v56
v_max_f32 v58,0,v58
v_cvt_pk_bf16_f32 v58,v56,v58
v_lshlrev_b32 v56,16,v58
v_and_b32 v58,0xffff0000,v58
v_add_f32 v58,0x3727c5ac,v58
v_cvt_pk_bf16_f32 v58,v58,v58
v_and_b32 v58,0xffff0000,v58
v_sqrt_f32 v58,v58
v_pk_add_f32 v[48:49],v[32:33],v[56:57] op_sel_hi:[1,0] neg_lo:[0,1] neg_hi:[0,1]
v_pk_add_f32 v[50:51],v[34:35],v[56:57] op_sel_hi:[1,0] neg_lo:[0,1] neg_hi:[0,1]
v_pk_add_f32 v[52:53],v[36:37],v[56:57] op_sel_hi:[1,0] neg_lo:[0,1] neg_hi:[0,1]
v_pk_add_f32 v[54:55],v[38:39],v[56:57] op_sel_hi:[1,0] neg_lo:[0,1] neg_hi:[0,1]
v_cvt_pk_bf16_f32 v58,v58,v58
v_and_b32 v58,0xffff0000,v58
v_rcp_f32 v58,v58
v_cvt_pk_bf16_f32 v40,v48,v49
v_cvt_pk_bf16_f32 v41,v50,v51
v_cvt_pk_bf16_f32 v42,v52,v53
v_cvt_pk_bf16_f32 v43,v54,v55
v_lshlrev_b32 v48,16,v40
v_and_b32 v49,0xffff0000,v40
v_lshlrev_b32 v50,16,v41
v_and_b32 v51,0xffff0000,v41
v_lshlrev_b32 v52,16,v42
v_and_b32 v53,0xffff0000,v42
v_lshlrev_b32 v54,16,v43
v_and_b32 v55,0xffff0000,v43
v_pk_mul_f32 v[48:49],v[48:49],v[58:59] op_sel_hi:[1,0]
v_pk_mul_f32 v[50:51],v[50:51],v[58:59] op_sel_hi:[1,0]
v_pk_mul_f32 v[52:53],v[52:53],v[58:59] op_sel_hi:[1,0]
v_pk_mul_f32 v[54:55],v[54:55],v[58:59] op_sel_hi:[1,0]
v_cvt_pk_bf16_f32 v40,v48,v49
v_cvt_pk_bf16_f32 v41,v50,v51
v_cvt_pk_bf16_f32 v42,v52,v53
v_cvt_pk_bf16_f32 v43,v54,v55
buffer_store_dwordx4 v[40:43],v0,s[8:11],s65 offen offset:0 sc1
v_lshlrev_b32 v32,16,v28
v_and_b32 v33,0xffff0000,v28
v_lshlrev_b32 v34,16,v29
v_and_b32 v35,0xffff0000,v29
v_lshlrev_b32 v36,16,v30
v_and_b32 v37,0xffff0000,v30
v_lshlrev_b32 v38,16,v31
v_and_b32 v39,0xffff0000,v31
v_readfirstlane_b32 s78,v32
s_nop 1
v_pk_add_f32 v[48:49],v[32:33],s[78:79] op_sel_hi:[1,0] neg_lo:[0,1] neg_hi:[0,1]
v_pk_add_f32 v[50:51],v[34:35],s[78:79] op_sel_hi:[1,0] neg_lo:[0,1] neg_hi:[0,1]
v_pk_add_f32 v[52:53],v[36:37],s[78:79] op_sel_hi:[1,0] neg_lo:[0,1] neg_hi:[0,1]
v_pk_add_f32 v[54:55],v[38:39],s[78:79] op_sel_hi:[1,0] neg_lo:[0,1] neg_hi:[0,1]
v_pk_add_f32 v[56:57],v[48:49],v[50:51]
v_pk_mul_f32 v[58:59],v[48:49],v[48:49]
v_pk_add_f32 v[60:61],v[52:53],v[54:55]
v_pk_fma_f32 v[58:59],v[50:51],v[50:51],v[58:59]
v_pk_add_f32 v[56:57],v[56:57],v[60:61]
v_pk_fma_f32 v[58:59],v[52:53],v[52:53],v[58:59]
v_add_f32 v56,v56,v57
v_pk_fma_f32 v[58:59],v[54:55],v[54:55],v[58:59]
v_add_f32 v58,v58,v59
s_nop 1
v_permlane32_swap_b32 v56,v58
v_add_f32 v56,v56,v58
s_nop 1
v_add_f32_dpp v56,v56,v56 row_ror:8 row_mask:0xf bank_mask:0xf
s_nop 1
v_add_f32_dpp v56,v56,v56 row_ror:4 row_mask:0xf bank_mask:0xf
s_nop 1
v_add_f32_dpp v56,v56,v56 row_ror:2 row_mask:0xf bank_mask:0xf
s_nop 1
v_add_f32_dpp v56,v56,v56 row_ror:1 row_mask:0xf bank_mask:0xf
v_mov_b32 v58,v56
s_nop 1
v_permlane16_swap_b32 v56,v58
v_add_f32 v56,v56,v58
v_mul_f32 v56,0x3b000000,v56
v_mov_b32 v58,v56
s_nop 1
v_permlane32_swap_b32 v56,v58
v_fma_f32 v58,-v56,v56,v58
v_add_f32 v56,s78,v56
v_max_f32 v58,0,v58
v_cvt_pk_bf16_f32 v58,v56,v58
v_lshlrev_b32 v56,16,v58
v_and_b32 v58,0xffff0000,v58
v_add_f32 v58,0x3727c5ac,v58
v_cvt_pk_bf16_f32 v58,v58,v58
v_and_b32 v58,0xffff0000,v58
v_sqrt_f32 v58,v58
v_pk_add_f32 v[48:49],v[32:33],v[56:57] op_sel_hi:[1,0] neg_lo:[0,1] neg_hi:[0,1]
v_pk_add_f32 v[50:51],v[34:35],v[56:57] op_sel_hi:[1,0] neg_lo:[0,1] neg_hi:[0,1]
v_pk_add_f32 v[52:53],v[36:37],v[56:57] op_sel_hi:[1,0] neg_lo:[0,1] neg_hi:[0,1]
v_pk_add_f32 v[54:55],v[38:39],v[56:57] op_sel_hi:[1,0] neg_lo:[0,1] neg_hi:[0,1]
v_cvt_pk_bf16_f32 v58,v58,v58
v_and_b32 v58,0xffff0000,v58
v_rcp_f32 v58,v58
v_cvt_pk_bf16_f32 v44,v48,v49
v_cvt_pk_bf16_f32 v45,v50,v51
v_cvt_pk_bf16_f32 v46,v52,v53
v_cvt_pk_bf16_f32 v47,v54,v55
v_lshlrev_b32 v48,16,v44
v_and_b32 v49,0xffff0000,v44
v_lshlrev_b32 v50,16,v45
v_and_b32 v51,0xffff0000,v45
v_lshlrev_b32 v52,16,v46
v_and_b32 v53,0xffff0000,v46
v_lshlrev_b32 v54,16,v47
v_and_b32 v55,0xffff0000,v47
v_pk_mul_f32 v[48:49],v[48:49],v[58:59] op_sel_hi:[1,0]
v_pk_mul_f32 v[50:51],v[50:51],v[58:59] op_sel_hi:[1,0]
v_pk_mul_f32 v[52:53],v[52:53],v[58:59] op_sel_hi:[1,0]
v_pk_mul_f32 v[54:55],v[54:55],v[58:59] op_sel_hi:[1,0]
v_cvt_pk_bf16_f32 v44,v48,v49
v_cvt_pk_bf16_f32 v45,v50,v51
v_cvt_pk_bf16_f32 v46,v52,v53
v_cvt_pk_bf16_f32 v47,v54,v55
buffer_store_dwordx4 v[44:47],v0,s[8:11],s65 offen offset:1024 sc1
s_cmp_ge_u32 s2,2
s_cbranch_scc1 L_m0_16
v_lshrrev_b32 v12,3,v1
v_lshlrev_b32 v12,9,v12
v_and_b32 v13,7,v1
v_lshl_add_u32 v12,v13,4,v12
s_lshl_b32 s66,s2,2
s_add_u32 s66,s66,s46
s_and_b32 s67,s66,1
s_lshl_b32 s67,s67,8
s_and_b32 s68,s66,2
s_lshl_b32 s68,s68,6
s_add_u32 s67,s67,s68
s_and_b32 s68,s66,4
s_lshl_b32 s68,s68,10
s_add_u32 s67,s67,s68
s_add_u32 s68,s67,11534336
buffer_store_dwordx4 v[64:67],v12,s[8:11],s68 offen sc1
s_add_u32 s68,s67,12582912
buffer_store_dwordx4 v[64:67],v12,s[8:11],s68 offen sc1
s_add_u32 s68,s67,17825792
buffer_store_dwordx4 v[64:67],v12,s[8:11],s68 offen sc1
L_m0_16:
s_waitcnt vmcnt(16)
v_xor_b32 v5,0,v3
v_xor_b32 v6,0,v4
ds_read2_b32 v[96:97],v5 offset1:32
ds_read2_b32 v[100:101],v6 offset1:32
ds_read2_b32 v[98:99],v5 offset0:64 offset1:96
ds_read2_b32 v[102:103],v6 offset0:64 offset1:96
v_xor_b32 v5,2048,v3
v_xor_b32 v6,2048,v4
ds_read2_b32 v[104:105],v5 offset1:32
ds_read2_b32 v[108:109],v6 offset1:32
ds_read2_b32 v[106:107],v5 offset0:64 offset1:96
ds_read2_b32 v[110:111],v6 offset0:64 offset1:96
s_waitcnt lgkmcnt(4)
v_perm_b32 v112,v100,v96,s61
v_perm_b32 v113,v101,v97,s61
v_perm_b32 v114,v102,v98,s61
v_perm_b32 v115,v103,v99,s61
v_perm_b32 v116,v100,v96,s62
v_perm_b32 v117,v101,v97,s62
v_perm_b32 v118,v102,v98,s62
v_perm_b32 v119,v103,v99,s62
v_accvgpr_write_b32 a128,v112
v_accvgpr_write_b32 a129,v113
v_accvgpr_write_b32 a130,v114
v_accvgpr_write_b32 a131,v115
v_accvgpr_write_b32 a136,v116
v_accvgpr_write_b32 a137,v117
v_accvgpr_write_b32 a138,v118
v_accvgpr_write_b32 a139,v119
v_xor_b32 v5,4096,v3
v_xor_b32 v6,4096,v4
ds_read2_b32 v[96:97],v5 offset1:32
ds_read2_b32 v[100:101],v6 offset1:32
ds_read2_b32 v[98:99],v5 offset0:64 offset1:96
ds_read2_b32 v[102:103],v6 offset0:64 offset1:96
s_waitcnt lgkmcnt(4)
v_perm_b32 v112,v108,v104,s61
v_perm_b32 v113,v109,v105,s61
v_perm_b32 v114,v110,v106,s61
v_perm_b32 v115,v111,v107,s61
v_perm_b32 v116,v108,v104,s62
v_perm_b32 v117,v109,v105,s62
v_perm_b32 v118,v110,v106,s62
v_perm_b32 v119,v111,v107,s62
v_accvgpr_write_b32 a132,v112
v_accvgpr_write_b32 a133,v113
v_accvgpr_write_b32 a134,v114
v_accvgpr_write_b32 a135,v115
v_accvgpr_write_b32 a140,v116
v_accvgpr_write_b32 a141,v117
v_accvgpr_write_b32 a142,v118
v_accvgpr_write_b32 a143,v119
v_xor_b32 v5,6144,v3
v_xor_b32 v6,6144,v4
ds_read2_b32 v[104:105],v5 offset1:32
ds_read2_b32 v[108:109],v6 offset1:32
ds_read2_b32 v[106:107],v5 offset0:64 offset1:96
ds_read2_b32 v[110:111],v6 offset0:64 offset1:96
s_waitcnt lgkmcnt(4)
v_perm_b32 v112,v100,v96,s61
v_perm_b32 v113,v101,v97,s61
v_perm_b32 v114,v102,v98,s61
v_perm_b32 v115,v103,v99,s61
v_perm_b32 v116,v100,v96,s62
v_perm_b32 v117,v101,v97,s62
v_perm_b32 v118,v102,v98,s62
v_perm_b32 v119,v103,v99,s62
v_accvgpr_write_b32 a144,v112
v_accvgpr_write_b32 a145,v113
v_accvgpr_write_b32 a146,v114
v_accvgpr_write_b32 a147,v115
v_accvgpr_write_b32 a152,v116
v_accvgpr_write_b32 a153,v117
v_accvgpr_write_b32 a154,v118
v_accvgpr_write_b32 a155,v119
v_xor_b32 v5,8192,v3
v_xor_b32 v6,8192,v4
ds_read2_b32 v[96:97],v5 offset1:32
ds_read2_b32 v[100:101],v6 offset1:32
ds_read2_b32 v[98:99],v5 offset0:64 offset1:96
ds_read2_b32 v[102:103],v6 offset0:64 offset1:96
s_waitcnt lgkmcnt(4)
v_perm_b32 v112,v108,v104,s61
v_perm_b32 v113,v109,v105,s61
v_perm_b32 v114,v110,v106,s61
v_perm_b32 v115,v111,v107,s61
v_perm_b32 v116,v108,v104,s62
v_perm_b32 v117,v109,v105,s62
v_perm_b32 v118,v110,v106,s62
v_perm_b32 v119,v111,v107,s62
v_accvgpr_write_b32 a148,v112
v_accvgpr_write_b32 a149,v113
v_accvgpr_write_b32 a150,v114
v_accvgpr_write_b32 a151,v115
v_accvgpr_write_b32 a156,v116
v_accvgpr_write_b32 a157,v117
v_accvgpr_write_b32 a158,v118
v_accvgpr_write_b32 a159,v119
v_xor_b32 v5,10240,v3
v_xor_b32 v6,10240,v4
ds_read2_b32 v[104:105],v5 offset1:32
ds_read2_b32 v[108:109],v6 offset1:32
ds_read2_b32 v[106:107],v5 offset0:64 offset1:96
ds_read2_b32 v[110:111],v6 offset0:64 offset1:96
s_waitcnt lgkmcnt(4)
v_perm_b32 v112,v100,v96,s61
v_perm_b32 v113,v101,v97,s61
v_perm_b32 v114,v102,v98,s61
v_perm_b32 v115,v103,v99,s61
v_perm_b32 v116,v100,v96,s62
v_perm_b32 v117,v101,v97,s62
v_perm_b32 v118,v102,v98,s62
v_perm_b32 v119,v103,v99,s62
v_accvgpr_write_b32 a160,v112
v_accvgpr_write_b32 a161,v113
v_accvgpr_write_b32 a162,v114
v_accvgpr_write_b32 a163,v115
v_accvgpr_write_b32 a168,v116
v_accvgpr_write_b32 a169,v117
v_accvgpr_write_b32 a170,v118
v_accvgpr_write_b32 a171,v119
v_xor_b32 v5,12288,v3
v_xor_b32 v6,12288,v4
ds_read2_b32 v[96:97],v5 offset1:32
ds_read2_b32 v[100:101],v6 offset1:32
ds_read2_b32 v[98:99],v5 offset0:64 offset1:96
ds_read2_b32 v[102:103],v6 offset0:64 offset1:96
s_waitcnt lgkmcnt(4)
v_perm_b32 v112,v108,v104,s61
v_perm_b32 v113,v109,v105,s61
v_perm_b32 v114,v110,v106,s61
v_perm_b32 v115,v111,v107,s61
v_perm_b32 v116,v108,v104,s62
v_perm_b32 v117,v109,v105,s62
v_perm_b32 v118,v110,v106,s62
v_perm_b32 v119,v111,v107,s62
v_accvgpr_write_b32 a164,v112
v_accvgpr_write_b32 a165,v113
v_accvgpr_write_b32 a166,v114
v_accvgpr_write_b32 a167,v115
v_accvgpr_write_b32 a172,v116
v_accvgpr_write_b32 a173,v117
v_accvgpr_write_b32 a174,v118
v_accvgpr_write_b32 a175,v119
v_xor_b32 v5,14336,v3
v_xor_b32 v6,14336,v4
ds_read2_b32 v[104:105],v5 offset1:32
ds_read2_b32 v[108:109],v6 offset1:32
ds_read2_b32 v[106:107],v5 offset0:64 offset1:96
ds_read2_b32 v[110:111],v6 offset0:64 offset1:96
s_waitcnt lgkmcnt(4)
v_perm_b32 v112,v100,v96,s61
v_perm_b32 v113,v101,v97,s61
v_perm_b32 v114,v102,v98,s61
v_perm_b32 v115,v103,v99,s61
v_perm_b32 v116,v100,v96,s62
v_perm_b32 v117,v101,v97,s62
v_perm_b32 v118,v102,v98,s62
v_perm_b32 v119,v103,v99,s62
v_accvgpr_write_b32 a176,v112
v_accvgpr_write_b32 a177,v113
v_accvgpr_write_b32 a178,v114
v_accvgpr_write_b32 a179,v115
v_accvgpr_write_b32 a184,v116
v_accvgpr_write_b32 a185,v117
v_accvgpr_write_b32 a186,v118
v_accvgpr_write_b32 a187,v119
s_waitcnt lgkmcnt(0)
s_mov_b32 s4,s24
s_mov_b32 s5,s25
s_mov_b32 s6,4194304
s_mov_b32 s7,0x20000
s_xor_b32 m0,s59,0
s_xor_b32 s60,s58,0
buffer_load_dwordx4 v2,s[4:7],s60 offen lds
s_add_u32 m0,m0,1024
s_add_u32 s60,s60,131072
buffer_load_dwordx4 v2,s[4:7],s60 offen lds
s_xor_b32 m0,s59,2048
s_xor_b32 s60,s58,262144
buffer_load_dwordx4 v2,s[4:7],s60 offen lds
s_add_u32 m0,m0,1024
s_add_u32 s60,s60,131072
buffer_load_dwordx4 v2,s[4:7],s60 offen lds
s_xor_b32 m0,s59,4096
s_xor_b32 s60,s58,524288
buffer_load_dwordx4 v2,s[4:7],s60 offen lds
s_add_u32 m0,m0,1024
s_add_u32 s60,s60,131072
buffer_load_dwordx4 v2,s[4:7],s60 offen lds
s_xor_b32 m0,s59,6144
s_xor_b32 s60,s58,786432
buffer_load_dwordx4 v2,s[4:7],s60 offen lds
s_add_u32 m0,m0,1024
s_add_u32 s60,s60,131072
buffer_load_dwordx4 v2,s[4:7],s60 offen lds
s_xor_b32 m0,s59,8192
s_xor_b32 s60,s58,1048576
buffer_load_dwordx4 v2,s[4:7],s60 offen lds
s_add_u32 m0,m0,1024
s_add_u32 s60,s60,131072
buffer_load_dwordx4 v2,s[4:7],s60 offen lds
s_xor_b32 m0,s59,10240
s_xor_b32 s60,s58,1310720
buffer_load_dwordx4 v2,s[4:7],s60 offen lds
s_add_u32 m0,m0,1024
s_add_u32 s60,s60,131072
buffer_load_dwordx4 v2,s[4:7],s60 offen lds
s_xor_b32 m0,s59,12288
s_xor_b32 s60,s58,1572864
buffer_load_dwordx4 v2,s[4:7],s60 offen lds
s_add_u32 m0,m0,1024
s_add_u32 s60,s60,131072
buffer_load_dwordx4 v2,s[4:7],s60 offen lds
s_xor_b32 m0,s59,14336
s_xor_b32 s60,s58,1835008
buffer_load_dwordx4 v2,s[4:7],s60 offen lds
s_add_u32 m0,m0,1024
s_add_u32 s60,s60,131072
buffer_load_dwordx4 v2,s[4:7],s60 offen lds
v_perm_b32 v112,v108,v104,s61
v_perm_b32 v113,v109,v105,s61
v_perm_b32 v114,v110,v106,s61
v_perm_b32 v115,v111,v107,s61
v_perm_b32 v116,v108,v104,s62
v_perm_b32 v117,v109,v105,s62
v_perm_b32 v118,v110,v106,s62
v_perm_b32 v119,v111,v107,s62
v_accvgpr_write_b32 a180,v112
v_accvgpr_write_b32 a181,v113
v_accvgpr_write_b32 a182,v114
v_accvgpr_write_b32 a183,v115
v_accvgpr_write_b32 a188,v116
v_accvgpr_write_b32 a189,v117
v_accvgpr_write_b32 a190,v118
v_accvgpr_write_b32 a191,v119
s_waitcnt vmcnt(16)
s_barrier
s_cmp_lg_u32 s46,0
s_cbranch_scc1 L_ar_17
v_mov_b32 v8,240
v_mov_b32 v9,s53
s_mov_b64 exec,1
buffer_atomic_add v9,v8,s[12:15],0 offen
s_mov_b64 exec,-1
L_ar_17:
s_mov_b32 s53,0
v_xor_b32 v5,16384,v3
v_xor_b32 v6,16384,v4
ds_read2_b32 v[96:97],v5 offset1:32
ds_read2_b32 v[100:101],v6 offset1:32
ds_read2_b32 v[98:99],v5 offset0:64 offset1:96
ds_read2_b32 v[102:103],v6 offset0:64 offset1:96
v_xor_b32 v5,18432,v3
v_xor_b32 v6,18432,v4
ds_read2_b32 v[104:105],v5 offset1:32
ds_read2_b32 v[108:109],v6 offset1:32
ds_read2_b32 v[106:107],v5 offset0:64 offset1:96
ds_read2_b32 v[110:111],v6 offset0:64 offset1:96
s_waitcnt lgkmcnt(4)
v_perm_b32 v112,v100,v96,s61
v_perm_b32 v113,v101,v97,s61
v_perm_b32 v114,v102,v98,s61
v_perm_b32 v115,v103,v99,s61
v_perm_b32 v116,v100,v96,s62
v_perm_b32 v117,v101,v97,s62
v_perm_b32 v118,v102,v98,s62
v_perm_b32 v119,v103,v99,s62
v_accvgpr_write_b32 a192,v112
v_accvgpr_write_b32 a193,v113
v_accvgpr_write_b32 a194,v114
v_accvgpr_write_b32 a195,v115
v_accvgpr_write_b32 a200,v116
v_accvgpr_write_b32 a201,v117
v_accvgpr_write_b32 a202,v118
v_accvgpr_write_b32 a203,v119
v_xor_b32 v5,20480,v3
v_xor_b32 v6,20480,v4
ds_read2_b32 v[96:97],v5 offset1:32
ds_read2_b32 v[100:101],v6 offset1:32
ds_read2_b32 v[98:99],v5 offset0:64 offset1:96
ds_read2_b32 v[102:103],v6 offset0:64 offset1:96
s_waitcnt lgkmcnt(4)
v_perm_b32 v112,v108,v104,s61
v_perm_b32 v113,v109,v105,s61
v_perm_b32 v114,v110,v106,s61
v_perm_b32 v115,v111,v107,s61
v_perm_b32 v116,v108,v104,s62
v_perm_b32 v117,v109,v105,s62
v_perm_b32 v118,v110,v106,s62
v_perm_b32 v119,v111,v107,s62
v_accvgpr_write_b32 a196,v112
v_accvgpr_write_b32 a197,v113
v_accvgpr_write_b32 a198,v114
v_accvgpr_write_b32 a199,v115
v_accvgpr_write_b32 a204,v116
v_accvgpr_write_b32 a205,v117
v_accvgpr_write_b32 a206,v118
v_accvgpr_write_b32 a207,v119
v_xor_b32 v5,22528,v3
v_xor_b32 v6,22528,v4
ds_read2_b32 v[104:105],v5 offset1:32
ds_read2_b32 v[108:109],v6 offset1:32
ds_read2_b32 v[106:107],v5 offset0:64 offset1:96
ds_read2_b32 v[110:111],v6 offset0:64 offset1:96
s_waitcnt lgkmcnt(4)
v_perm_b32 v112,v100,v96,s61
v_perm_b32 v113,v101,v97,s61
v_perm_b32 v114,v102,v98,s61
v_perm_b32 v115,v103,v99,s61
v_perm_b32 v116,v100,v96,s62
v_perm_b32 v117,v101,v97,s62
v_perm_b32 v118,v102,v98,s62
v_perm_b32 v119,v103,v99,s62
v_accvgpr_write_b32 a208,v112
v_accvgpr_write_b32 a209,v113
v_accvgpr_write_b32 a210,v114
v_accvgpr_write_b32 a211,v115
v_accvgpr_write_b32 a216,v116
v_accvgpr_write_b32 a217,v117
v_accvgpr_write_b32 a218,v118
v_accvgpr_write_b32 a219,v119
v_xor_b32 v5,24576,v3
v_xor_b32 v6,24576,v4
ds_read2_b32 v[96:97],v5 offset1:32
ds_read2_b32 v[100:101],v6 offset1:32
ds_read2_b32 v[98:99],v5 offset0:64 offset1:96
ds_read2_b32 v[102:103],v6 offset0:64 offset1:96
s_waitcnt lgkmcnt(4)
v_perm_b32 v112,v108,v104,s61
v_perm_b32 v113,v109,v105,s61
v_perm_b32 v114,v110,v106,s61
v_perm_b32 v115,v111,v107,s61
v_perm_b32 v116,v108,v104,s62
v_perm_b32 v117,v109,v105,s62
v_perm_b32 v118,v110,v106,s62
v_perm_b32 v119,v111,v107,s62
v_accvgpr_write_b32 a212,v112
v_accvgpr_write_b32 a213,v113
v_accvgpr_write_b32 a214,v114
v_accvgpr_write_b32 a215,v115
v_accvgpr_write_b32 a220,v116
v_accvgpr_write_b32 a221,v117
v_accvgpr_write_b32 a222,v118
v_accvgpr_write_b32 a223,v119
v_xor_b32 v5,26624,v3
v_xor_b32 v6,26624,v4
ds_read2_b32 v[104:105],v5 offset1:32
ds_read2_b32 v[108:109],v6 offset1:32
ds_read2_b32 v[106:107],v5 offset0:64 offset1:96
ds_read2_b32 v[110:111],v6 offset0:64 offset1:96
s_waitcnt lgkmcnt(4)
v_perm_b32 v112,v100,v96,s61
v_perm_b32 v113,v101,v97,s61
v_perm_b32 v114,v102,v98,s61
v_perm_b32 v115,v103,v99,s61
v_perm_b32 v116,v100,v96,s62
v_perm_b32 v117,v101,v97,s62
v_perm_b32 v118,v102,v98,s62
v_perm_b32 v119,v103,v99,s62
v_accvgpr_write_b32 a224,v112
v_accvgpr_write_b32 a225,v113
v_accvgpr_write_b32 a226,v114
v_accvgpr_write_b32 a227,v115
v_accvgpr_write_b32 a232,v116
v_accvgpr_write_b32 a233,v117
v_accvgpr_write_b32 a234,v118
v_accvgpr_write_b32 a235,v119
v_xor_b32 v5,28672,v3
v_xor_b32 v6,28672,v4
ds_read2_b32 v[96:97],v5 offset1:32
ds_read2_b32 v[100:101],v6 offset1:32
ds_read2_b32 v[98:99],v5 offset0:64 offset1:96
ds_read2_b32 v[102:103],v6 offset0:64 offset1:96
s_waitcnt lgkmcnt(4)
v_perm_b32 v112,v108,v104,s61
v_perm_b32 v113,v109,v105,s61
v_perm_b32 v114,v110,v106,s61
v_perm_b32 v115,v111,v107,s61
v_perm_b32 v116,v108,v104,s62
v_perm_b32 v117,v109,v105,s62
v_perm_b32 v118,v110,v106,s62
v_perm_b32 v119,v111,v107,s62
v_accvgpr_write_b32 a228,v112
v_accvgpr_write_b32 a229,v113
v_accvgpr_write_b32 a230,v114
v_accvgpr_write_b32 a231,v115
v_accvgpr_write_b32 a236,v116
v_accvgpr_write_b32 a237,v117
v_accvgpr_write_b32 a238,v118
v_accvgpr_write_b32 a239,v119
v_xor_b32 v5,30720,v3
v_xor_b32 v6,30720,v4
ds_read2_b32 v[104:105],v5 offset1:32
ds_read2_b32 v[108:109],v6 offset1:32
ds_read2_b32 v[106:107],v5 offset0:64 offset1:96
ds_read2_b32 v[110:111],v6 offset0:64 offset1:96
s_waitcnt lgkmcnt(4)
v_perm_b32 v112,v100,v96,s61
v_perm_b32 v113,v101,v97,s61
v_perm_b32 v114,v102,v98,s61
v_perm_b32 v115,v103,v99,s61
v_perm_b32 v116,v100,v96,s62
v_perm_b32 v117,v101,v97,s62
v_perm_b32 v118,v102,v98,s62
v_perm_b32 v119,v103,v99,s62
v_accvgpr_write_b32 a240,v112
v_accvgpr_write_b32 a241,v113
v_accvgpr_write_b32 a242,v114
v_accvgpr_write_b32 a243,v115
v_accvgpr_write_b32 a248,v116
v_accvgpr_write_b32 a249,v117
v_accvgpr_write_b32 a250,v118
v_accvgpr_write_b32 a251,v119
s_waitcnt lgkmcnt(0)
s_xor_b32 m0,s59,16384
s_xor_b32 s60,s58,2097152
buffer_load_dwordx4 v2,s[4:7],s60 offen lds
s_add_u32 m0,m0,1024
s_add_u32 s60,s60,131072
buffer_load_dwordx4 v2,s[4:7],s60 offen lds
s_xor_b32 m0,s59,18432
s_xor_b32 s60,s58,2359296
buffer_load_dwordx4 v2,s[4:7],s60 offen lds
s_add_u32 m0,m0,1024
s_add_u32 s60,s60,131072
buffer_load_dwordx4 v2,s[4:7],s60 offen lds
s_xor_b32 m0,s59,20480
s_xor_b32 s60,s58,2621440
buffer_load_dwordx4 v2,s[4:7],s60 offen lds
s_add_u32 m0,m0,1024
s_add_u32 s60,s60,131072
buffer_load_dwordx4 v2,s[4:7],s60 offen lds
s_xor_b32 m0,s59,22528
s_xor_b32 s60,s58,2883584
buffer_load_dwordx4 v2,s[4:7],s60 offen lds
s_add_u32 m0,m0,1024
s_add_u32 s60,s60,131072
buffer_load_dwordx4 v2,s[4:7],s60 offen lds
s_xor_b32 m0,s59,24576
s_xor_b32 s60,s58,3145728
buffer_load_dwordx4 v2,s[4:7],s60 offen lds
s_add_u32 m0,m0,1024
s_add_u32 s60,s60,131072
buffer_load_dwordx4 v2,s[4:7],s60 offen lds
s_xor_b32 m0,s59,26624
s_xor_b32 s60,s58,3407872
buffer_load_dwordx4 v2,s[4:7],s60 offen lds
s_add_u32 m0,m0,1024
s_add_u32 s60,s60,131072
buffer_load_dwordx4 v2,s[4:7],s60 offen lds
s_xor_b32 m0,s59,28672
s_xor_b32 s60,s58,3670016
buffer_load_dwordx4 v2,s[4:7],s60 offen lds
s_add_u32 m0,m0,1024
s_add_u32 s60,s60,131072
buffer_load_dwordx4 v2,s[4:7],s60 offen lds
s_xor_b32 m0,s59,30720
s_xor_b32 s60,s58,3932160
buffer_load_dwordx4 v2,s[4:7],s60 offen lds
s_add_u32 m0,m0,1024
s_add_u32 s60,s60,131072
buffer_load_dwordx4 v2,s[4:7],s60 offen lds
v_perm_b32 v112,v108,v104,s61
v_perm_b32 v113,v109,v105,s61
v_perm_b32 v114,v110,v106,s61
v_perm_b32 v115,v111,v107,s61
v_perm_b32 v116,v108,v104,s62
v_perm_b32 v117,v109,v105,s62
v_perm_b32 v118,v110,v106,s62
v_perm_b32 v119,v111,v107,s62
v_accvgpr_write_b32 a244,v112
v_accvgpr_write_b32 a245,v113
v_accvgpr_write_b32 a246,v114
v_accvgpr_write_b32 a247,v115
v_accvgpr_write_b32 a252,v116
v_accvgpr_write_b32 a253,v117
v_accvgpr_write_b32 a254,v118
v_accvgpr_write_b32 a255,v119
s_waitcnt vmcnt(16)
v_xor_b32 v5,0,v3
v_xor_b32 v6,0,v4
ds_read2_b32 v[96:97],v5 offset1:32
ds_read2_b32 v[100:101],v6 offset1:32
ds_read2_b32 v[98:99],v5 offset0:64 offset1:96
ds_read2_b32 v[102:103],v6 offset0:64 offset1:96
v_xor_b32 v5,2048,v3
v_xor_b32 v6,2048,v4
ds_read2_b32 v[104:105],v5 offset1:32
ds_read2_b32 v[108:109],v6 offset1:32
ds_read2_b32 v[106:107],v5 offset0:64 offset1:96
ds_read2_b32 v[110:111],v6 offset0:64 offset1:96
s_waitcnt lgkmcnt(4)
v_perm_b32 v128,v100,v96,s61
v_perm_b32 v129,v101,v97,s61
v_perm_b32 v130,v102,v98,s61
v_perm_b32 v131,v103,v99,s61
v_perm_b32 v136,v100,v96,s62
v_perm_b32 v137,v101,v97,s62
v_perm_b32 v138,v102,v98,s62
v_perm_b32 v139,v103,v99,s62
v_xor_b32 v5,4096,v3
v_xor_b32 v6,4096,v4
ds_read2_b32 v[96:97],v5 offset1:32
ds_read2_b32 v[100:101],v6 offset1:32
ds_read2_b32 v[98:99],v5 offset0:64 offset1:96
ds_read2_b32 v[102:103],v6 offset0:64 offset1:96
s_waitcnt lgkmcnt(4)
v_perm_b32 v132,v108,v104,s61
v_perm_b32 v133,v109,v105,s61
v_perm_b32 v134,v110,v106,s61
v_perm_b32 v135,v111,v107,s61
v_perm_b32 v140,v108,v104,s62
v_perm_b32 v141,v109,v105,s62
v_perm_b32 v142,v110,v106,s62
v_perm_b32 v143,v111,v107,s62
v_xor_b32 v5,6144,v3
v_xor_b32 v6,6144,v4
ds_read2_b32 v[104:105],v5 offset1:32
ds_read2_b32 v[108:109],v6 offset1:32
ds_read2_b32 v[106:107],v5 offset0:64 offset1:96
ds_read2_b32 v[110:111],v6 offset0:64 offset1:96
s_waitcnt lgkmcnt(4)
v_perm_b32 v144,v100,v96,s61
v_perm_b32 v145,v101,v97,s61
v_perm_b32 v146,v102,v98,s61
v_perm_b32 v147,v103,v99,s61
v_perm_b32 v152,v100,v96,s62
v_perm_b32 v153,v101,v97,s62
v_perm_b32 v154,v102,v98,s62
v_perm_b32 v155,v103,v99,s62
v_xor_b32 v5,8192,v3
v_xor_b32 v6,8192,v4
ds_read2_b32 v[96:97],v5 offset1:32
ds_read2_b32 v[100:101],v6 offset1:32
ds_read2_b32 v[98:99],v5 offset0:64 offset1:96
ds_read2_b32 v[102:103],v6 offset0:64 offset1:96
s_waitcnt lgkmcnt(4)
v_perm_b32 v148,v108,v104,s61
v_perm_b32 v149,v109,v105,s61
v_perm_b32 v150,v110,v106,s61
v_perm_b32 v151,v111,v107,s61
v_perm_b32 v156,v108,v104,s62
v_perm_b32 v157,v109,v105,s62
v_perm_b32 v158,v110,v106,s62
v_perm_b32 v159,v111,v107,s62
v_xor_b32 v5,10240,v3
v_xor_b32 v6,10240,v4
ds_read2_b32 v[104:105],v5 offset1:32
ds_read2_b32 v[108:109],v6 offset1:32
ds_read2_b32 v[106:107],v5 offset0:64 offset1:96
ds_read2_b32 v[110:111],v6 offset0:64 offset1:96
s_waitcnt lgkmcnt(4)
v_perm_b32 v160,v100,v96,s61
v_perm_b32 v161,v101,v97,s61
v_perm_b32 v162,v102,v98,s61
v_perm_b32 v163,v103,v99,s61
v_perm_b32 v168,v100,v96,s62
v_perm_b32 v169,v101,v97,s62
v_perm_b32 v170,v102,v98,s62
v_perm_b32 v171,v103,v99,s62
v_xor_b32 v5,12288,v3
v_xor_b32 v6,12288,v4
ds_read2_b32 v[96:97],v5 offset1:32
ds_read2_b32 v[100:101],v6 offset1:32
ds_read2_b32 v[98:99],v5 offset0:64 offset1:96
ds_read2_b32 v[102:103],v6 offset0:64 offset1:96
s_waitcnt lgkmcnt(4)
v_perm_b32 v164,v108,v104,s61
v_perm_b32 v165,v109,v105,s61
v_perm_b32 v166,v110,v106,s61
v_perm_b32 v167,v111,v107,s61
v_perm_b32 v172,v108,v104,s62
v_perm_b32 v173,v109,v105,s62
v_perm_b32 v174,v110,v106,s62
v_perm_b32 v175,v111,v107,s62
v_xor_b32 v5,14336,v3
v_xor_b32 v6,14336,v4
ds_read2_b32 v[104:105],v5 offset1:32
ds_read2_b32 v[108:109],v6 offset1:32
ds_read2_b32 v[106:107],v5 offset0:64 offset1:96
ds_read2_b32 v[110:111],v6 offset0:64 offset1:96
s_waitcnt lgkmcnt(4)
v_perm_b32 v176,v100,v96,s61
v_perm_b32 v177,v101,v97,s61
v_perm_b32 v178,v102,v98,s61
v_perm_b32 v179,v103,v99,s61
v_perm_b32 v184,v100,v96,s62
v_perm_b32 v185,v101,v97,s62
v_perm_b32 v186,v102,v98,s62
v_perm_b32 v187,v103,v99,s62
s_waitcnt lgkmcnt(0)
s_mov_b32 s4,s20
s_mov_b32 s5,s21
s_mov_b32 s6,4194304
s_mov_b32 s7,0x20000
s_xor_b32 m0,s59,0
s_xor_b32 s60,s58,0
buffer_load_dwordx4 v2,s[4:7],s60 offen lds
s_add_u32 m0,m0,1024
s_add_u32 s60,s60,131072
buffer_load_dwordx4 v2,s[4:7],s60 offen lds
s_xor_b32 m0,s59,2048
s_xor_b32 s60,s58,262144
buffer_load_dwordx4 v2,s[4:7],s60 offen lds
s_add_u32 m0,m0,1024
s_add_u32 s60,s60,131072
buffer_load_dwordx4 v2,s[4:7],s60 offen lds
s_xor_b32 m0,s59,4096
s_xor_b32 s60,s58,524288
buffer_load_dwordx4 v2,s[4:7],s60 offen lds
s_add_u32 m0,m0,1024
s_add_u32 s60,s60,131072
buffer_load_dwordx4 v2,s[4:7],s60 offen lds
s_xor_b32 m0,s59,6144
s_xor_b32 s60,s58,786432
buffer_load_dwordx4 v2,s[4:7],s60 offen lds
s_add_u32 m0,m0,1024
s_add_u32 s60,s60,131072
buffer_load_dwordx4 v2,s[4:7],s60 offen lds
s_xor_b32 m0,s59,8192
s_xor_b32 s60,s58,1048576
buffer_load_dwordx4 v2,s[4:7],s60 offen lds
s_add_u32 m0,m0,1024
s_add_u32 s60,s60,131072
buffer_load_dwordx4 v2,s[4:7],s60 offen lds
s_xor_b32 m0,s59,10240
s_xor_b32 s60,s58,1310720
buffer_load_dwordx4 v2,s[4:7],s60 offen lds
s_add_u32 m0,m0,1024
s_add_u32 s60,s60,131072
buffer_load_dwordx4 v2,s[4:7],s60 offen lds
s_xor_b32 m0,s59,12288
s_xor_b32 s60,s58,1572864
buffer_load_dwordx4 v2,s[4:7],s60 offen lds
s_add_u32 m0,m0,1024
s_add_u32 s60,s60,131072
buffer_load_dwordx4 v2,s[4:7],s60 offen lds
s_xor_b32 m0,s59,14336
s_xor_b32 s60,s58,1835008
buffer_load_dwordx4 v2,s[4:7],s60 offen lds
s_add_u32 m0,m0,1024
s_add_u32 s60,s60,131072
buffer_load_dwordx4 v2,s[4:7],s60 offen lds
v_perm_b32 v180,v108,v104,s61
v_perm_b32 v181,v109,v105,s61
v_perm_b32 v182,v110,v106,s61
v_perm_b32 v183,v111,v107,s61
v_perm_b32 v188,v108,v104,s62
v_perm_b32 v189,v109,v105,s62
v_perm_b32 v190,v110,v106,s62
v_perm_b32 v191,v111,v107,s62
s_waitcnt vmcnt(16)
v_xor_b32 v5,16384,v3
v_xor_b32 v6,16384,v4
ds_read2_b32 v[96:97],v5 offset1:32
ds_read2_b32 v[100:101],v6 offset1:32
ds_read2_b32 v[98:99],v5 offset0:64 offset1:96
ds_read2_b32 v[102:103],v6 offset0:64 offset1:96
v_xor_b32 v5,18432,v3
v_xor_b32 v6,18432,v4
ds_read2_b32 v[104:105],v5 offset1:32
ds_read2_b32 v[108:109],v6 offset1:32
ds_read2_b32 v[106:107],v5 offset0:64 offset1:96
ds_read2_b32 v[110:111],v6 offset0:64 offset1:96
s_waitcnt lgkmcnt(4)
v_perm_b32 v192,v100,v96,s61
v_perm_b32 v193,v101,v97,s61
v_perm_b32 v194,v102,v98,s61
v_perm_b32 v195,v103,v99,s61
v_perm_b32 v200,v100,v96,s62
v_perm_b32 v201,v101,v97,s62
v_perm_b32 v202,v102,v98,s62
v_perm_b32 v203,v103,v99,s62
v_xor_b32 v5,20480,v3
v_xor_b32 v6,20480,v4
ds_read2_b32 v[96:97],v5 offset1:32
ds_read2_b32 v[100:101],v6 offset1:32
ds_read2_b32 v[98:99],v5 offset0:64 offset1:96
ds_read2_b32 v[102:103],v6 offset0:64 offset1:96
s_waitcnt lgkmcnt(4)
v_perm_b32 v196,v108,v104,s61
v_perm_b32 v197,v109,v105,s61
v_perm_b32 v198,v110,v106,s61
v_perm_b32 v199,v111,v107,s61
v_perm_b32 v204,v108,v104,s62
v_perm_b32 v205,v109,v105,s62
v_perm_b32 v206,v110,v106,s62
v_perm_b32 v207,v111,v107,s62
v_xor_b32 v5,22528,v3
v_xor_b32 v6,22528,v4
ds_read2_b32 v[104:105],v5 offset1:32
ds_read2_b32 v[108:109],v6 offset1:32
ds_read2_b32 v[106:107],v5 offset0:64 offset1:96
ds_read2_b32 v[110:111],v6 offset0:64 offset1:96
s_waitcnt lgkmcnt(4)
v_perm_b32 v208,v100,v96,s61
v_perm_b32 v209,v101,v97,s61
v_perm_b32 v210,v102,v98,s61
v_perm_b32 v211,v103,v99,s61
v_perm_b32 v216,v100,v96,s62
v_perm_b32 v217,v101,v97,s62
v_perm_b32 v218,v102,v98,s62
v_perm_b32 v219,v103,v99,s62
v_xor_b32 v5,24576,v3
v_xor_b32 v6,24576,v4
ds_read2_b32 v[96:97],v5 offset1:32
ds_read2_b32 v[100:101],v6 offset1:32
ds_read2_b32 v[98:99],v5 offset0:64 offset1:96
ds_read2_b32 v[102:103],v6 offset0:64 offset1:96
s_waitcnt lgkmcnt(4)
v_perm_b32 v212,v108,v104,s61
v_perm_b32 v213,v109,v105,s61
v_perm_b32 v214,v110,v106,s61
v_perm_b32 v215,v111,v107,s61
v_perm_b32 v220,v108,v104,s62
v_perm_b32 v221,v109,v105,s62
v_perm_b32 v222,v110,v106,s62
v_perm_b32 v223,v111,v107,s62
v_xor_b32 v5,26624,v3
v_xor_b32 v6,26624,v4
ds_read2_b32 v[104:105],v5 offset1:32
ds_read2_b32 v[108:109],v6 offset1:32
ds_read2_b32 v[106:107],v5 offset0:64 offset1:96
ds_read2_b32 v[110:111],v6 offset0:64 offset1:96
s_waitcnt lgkmcnt(4)
v_perm_b32 v224,v100,v96,s61
v_perm_b32 v225,v101,v97,s61
v_perm_b32 v226,v102,v98,s61
v_perm_b32 v227,v103,v99,s61
v_perm_b32 v232,v100,v96,s62
v_perm_b32 v233,v101,v97,s62
v_perm_b32 v234,v102,v98,s62
v_perm_b32 v235,v103,v99,s62
v_xor_b32 v5,28672,v3
v_xor_b32 v6,28672,v4
ds_read2_b32 v[96:97],v5 offset1:32
ds_read2_b32 v[100:101],v6 offset1:32
ds_read2_b32 v[98:99],v5 offset0:64 offset1:96
ds_read2_b32 v[102:103],v6 offset0:64 offset1:96
s_waitcnt lgkmcnt(4)
v_perm_b32 v228,v108,v104,s61
v_perm_b32 v229,v109,v105,s61
v_perm_b32 v230,v110,v106,s61
v_perm_b32 v231,v111,v107,s61
v_perm_b32 v236,v108,v104,s62
v_perm_b32 v237,v109,v105,s62
v_perm_b32 v238,v110,v106,s62
v_perm_b32 v239,v111,v107,s62
v_xor_b32 v5,30720,v3
v_xor_b32 v6,30720,v4
ds_read2_b32 v[104:105],v5 offset1:32
ds_read2_b32 v[108:109],v6 offset1:32
ds_read2_b32 v[106:107],v5 offset0:64 offset1:96
ds_read2_b32 v[110:111],v6 offset0:64 offset1:96
s_waitcnt lgkmcnt(4)
v_perm_b32 v240,v100,v96,s61
v_perm_b32 v241,v101,v97,s61
v_perm_b32 v242,v102,v98,s61
v_perm_b32 v243,v103,v99,s61
v_perm_b32 v248,v100,v96,s62
v_perm_b32 v249,v101,v97,s62
v_perm_b32 v250,v102,v98,s62
v_perm_b32 v251,v103,v99,s62
s_waitcnt lgkmcnt(0)
s_xor_b32 m0,s59,16384
s_xor_b32 s60,s58,2097152
buffer_load_dwordx4 v2,s[4:7],s60 offen lds
s_add_u32 m0,m0,1024
s_add_u32 s60,s60,131072
buffer_load_dwordx4 v2,s[4:7],s60 offen lds
s_xor_b32 m0,s59,18432
s_xor_b32 s60,s58,2359296
buffer_load_dwordx4 v2,s[4:7],s60 offen lds
s_add_u32 m0,m0,1024
s_add_u32 s60,s60,131072
buffer_load_dwordx4 v2,s[4:7],s60 offen lds
s_xor_b32 m0,s59,20480
s_xor_b32 s60,s58,2621440
buffer_load_dwordx4 v2,s[4:7],s60 offen lds
s_add_u32 m0,m0,1024
s_add_u32 s60,s60,131072
buffer_load_dwordx4 v2,s[4:7],s60 offen lds
s_xor_b32 m0,s59,22528
s_xor_b32 s60,s58,2883584
buffer_load_dwordx4 v2,s[4:7],s60 offen lds
s_add_u32 m0,m0,1024
s_add_u32 s60,s60,131072
buffer_load_dwordx4 v2,s[4:7],s60 offen lds
s_xor_b32 m0,s59,24576
s_xor_b32 s60,s58,3145728
buffer_load_dwordx4 v2,s[4:7],s60 offen lds
s_add_u32 m0,m0,1024
s_add_u32 s60,s60,131072
buffer_load_dwordx4 v2,s[4:7],s60 offen lds
s_xor_b32 m0,s59,26624
s_xor_b32 s60,s58,3407872
buffer_load_dwordx4 v2,s[4:7],s60 offen lds
s_add_u32 m0,m0,1024
s_add_u32 s60,s60,131072
buffer_load_dwordx4 v2,s[4:7],s60 offen lds
s_xor_b32 m0,s59,28672
s_xor_b32 s60,s58,3670016
buffer_load_dwordx4 v2,s[4:7],s60 offen lds
s_add_u32 m0,m0,1024
s_add_u32 s60,s60,131072
buffer_load_dwordx4 v2,s[4:7],s60 offen lds
s_xor_b32 m0,s59,30720
s_xor_b32 s60,s58,3932160
buffer_load_dwordx4 v2,s[4:7],s60 offen lds
s_add_u32 m0,m0,1024
s_add_u32 s60,s60,131072
buffer_load_dwordx4 v2,s[4:7],s60 offen lds
v_perm_b32 v244,v108,v104,s61
v_perm_b32 v245,v109,v105,s61
v_perm_b32 v246,v110,v106,s61
v_perm_b32 v247,v111,v107,s61
v_perm_b32 v252,v108,v104,s62
v_perm_b32 v253,v109,v105,s62
v_perm_b32 v254,v110,v106,s62
v_perm_b32 v255,v111,v107,s62
s_waitcnt vmcnt(16)
v_xor_b32 v5,0,v3
v_xor_b32 v6,0,v4
ds_read2_b32 v[96:97],v5 offset1:32
ds_read2_b32 v[100:101],v6 offset1:32
ds_read2_b32 v[98:99],v5 offset0:64 offset1:96
ds_read2_b32 v[102:103],v6 offset0:64 offset1:96
v_xor_b32 v5,2048,v3
v_xor_b32 v6,2048,v4
ds_read2_b32 v[104:105],v5 offset1:32
ds_read2_b32 v[108:109],v6 offset1:32
ds_read2_b32 v[106:107],v5 offset0:64 offset1:96
ds_read2_b32 v[110:111],v6 offset0:64 offset1:96
s_waitcnt lgkmcnt(4)
v_perm_b32 v112,v100,v96,s61
v_perm_b32 v113,v101,v97,s61
v_perm_b32 v114,v102,v98,s61
v_perm_b32 v115,v103,v99,s61
v_perm_b32 v116,v100,v96,s62
v_perm_b32 v117,v101,v97,s62
v_perm_b32 v118,v102,v98,s62
v_perm_b32 v119,v103,v99,s62
v_accvgpr_write_b32 a0,v112
v_accvgpr_write_b32 a1,v113
v_accvgpr_write_b32 a2,v114
v_accvgpr_write_b32 a3,v115
v_accvgpr_write_b32 a8,v116
v_accvgpr_write_b32 a9,v117
v_accvgpr_write_b32 a10,v118
v_accvgpr_write_b32 a11,v119
v_xor_b32 v5,4096,v3
v_xor_b32 v6,4096,v4
ds_read2_b32 v[96:97],v5 offset1:32
ds_read2_b32 v[100:101],v6 offset1:32
ds_read2_b32 v[98:99],v5 offset0:64 offset1:96
ds_read2_b32 v[102:103],v6 offset0:64 offset1:96
s_waitcnt lgkmcnt(4)
v_perm_b32 v112,v108,v104,s61
v_perm_b32 v113,v109,v105,s61
v_perm_b32 v114,v110,v106,s61
v_perm_b32 v115,v111,v107,s61
v_perm_b32 v116,v108,v104,s62
v_perm_b32 v117,v109,v105,s62
v_perm_b32 v118,v110,v106,s62
v_perm_b32 v119,v111,v107,s62
v_accvgpr_write_b32 a4,v112
v_accvgpr_write_b32 a5,v113
v_accvgpr_write_b32 a6,v114
v_accvgpr_write_b32 a7,v115
v_accvgpr_write_b32 a12,v116
v_accvgpr_write_b32 a13,v117
v_accvgpr_write_b32 a14,v118
v_accvgpr_write_b32 a15,v119
v_xor_b32 v5,6144,v3
v_xor_b32 v6,6144,v4
ds_read2_b32 v[104:105],v5 offset1:32
ds_read2_b32 v[108:109],v6 offset1:32
ds_read2_b32 v[106:107],v5 offset0:64 offset1:96
ds_read2_b32 v[110:111],v6 offset0:64 offset1:96
s_waitcnt lgkmcnt(4)
v_perm_b32 v112,v100,v96,s61
v_perm_b32 v113,v101,v97,s61
v_perm_b32 v114,v102,v98,s61
v_perm_b32 v115,v103,v99,s61
v_perm_b32 v116,v100,v96,s62
v_perm_b32 v117,v101,v97,s62
v_perm_b32 v118,v102,v98,s62
v_perm_b32 v119,v103,v99,s62
v_accvgpr_write_b32 a16,v112
v_accvgpr_write_b32 a17,v113
v_accvgpr_write_b32 a18,v114
v_accvgpr_write_b32 a19,v115
v_accvgpr_write_b32 a24,v116
v_accvgpr_write_b32 a25,v117
v_accvgpr_write_b32 a26,v118
v_accvgpr_write_b32 a27,v119
v_xor_b32 v5,8192,v3
v_xor_b32 v6,8192,v4
ds_read2_b32 v[96:97],v5 offset1:32
ds_read2_b32 v[100:101],v6 offset1:32
ds_read2_b32 v[98:99],v5 offset0:64 offset1:96
ds_read2_b32 v[102:103],v6 offset0:64 offset1:96
s_waitcnt lgkmcnt(4)
v_perm_b32 v112,v108,v104,s61
v_perm_b32 v113,v109,v105,s61
v_perm_b32 v114,v110,v106,s61
v_perm_b32 v115,v111,v107,s61
v_perm_b32 v116,v108,v104,s62
v_perm_b32 v117,v109,v105,s62
v_perm_b32 v118,v110,v106,s62
v_perm_b32 v119,v111,v107,s62
v_accvgpr_write_b32 a20,v112
v_accvgpr_write_b32 a21,v113
v_accvgpr_write_b32 a22,v114
v_accvgpr_write_b32 a23,v115
v_accvgpr_write_b32 a28,v116
v_accvgpr_write_b32 a29,v117
v_accvgpr_write_b32 a30,v118
v_accvgpr_write_b32 a31,v119
v_xor_b32 v5,10240,v3
v_xor_b32 v6,10240,v4
ds_read2_b32 v[104:105],v5 offset1:32
ds_read2_b32 v[108:109],v6 offset1:32
ds_read2_b32 v[106:107],v5 offset0:64 offset1:96
ds_read2_b32 v[110:111],v6 offset0:64 offset1:96
s_waitcnt lgkmcnt(4)
v_perm_b32 v112,v100,v96,s61
v_perm_b32 v113,v101,v97,s61
v_perm_b32 v114,v102,v98,s61
v_perm_b32 v115,v103,v99,s61
v_perm_b32 v116,v100,v96,s62
v_perm_b32 v117,v101,v97,s62
v_perm_b32 v118,v102,v98,s62
v_perm_b32 v119,v103,v99,s62
v_accvgpr_write_b32 a32,v112
v_accvgpr_write_b32 a33,v113
v_accvgpr_write_b32 a34,v114
v_accvgpr_write_b32 a35,v115
v_accvgpr_write_b32 a40,v116
v_accvgpr_write_b32 a41,v117
v_accvgpr_write_b32 a42,v118
v_accvgpr_write_b32 a43,v119
v_xor_b32 v5,12288,v3
v_xor_b32 v6,12288,v4
ds_read2_b32 v[96:97],v5 offset1:32
ds_read2_b32 v[100:101],v6 offset1:32
ds_read2_b32 v[98:99],v5 offset0:64 offset1:96
ds_read2_b32 v[102:103],v6 offset0:64 offset1:96
s_waitcnt lgkmcnt(4)
v_perm_b32 v112,v108,v104,s61
v_perm_b32 v113,v109,v105,s61
v_perm_b32 v114,v110,v106,s61
v_perm_b32 v115,v111,v107,s61
v_perm_b32 v116,v108,v104,s62
v_perm_b32 v117,v109,v105,s62
v_perm_b32 v118,v110,v106,s62
v_perm_b32 v119,v111,v107,s62
v_accvgpr_write_b32 a36,v112
v_accvgpr_write_b32 a37,v113
v_accvgpr_write_b32 a38,v114
v_accvgpr_write_b32 a39,v115
v_accvgpr_write_b32 a44,v116
v_accvgpr_write_b32 a45,v117
v_accvgpr_write_b32 a46,v118
v_accvgpr_write_b32 a47,v119
v_xor_b32 v5,14336,v3
v_xor_b32 v6,14336,v4
ds_read2_b32 v[104:105],v5 offset1:32
ds_read2_b32 v[108:109],v6 offset1:32
ds_read2_b32 v[106:107],v5 offset0:64 offset1:96
ds_read2_b32 v[110:111],v6 offset0:64 offset1:96
s_waitcnt lgkmcnt(4)
v_perm_b32 v112,v100,v96,s61
v_perm_b32 v113,v101,v97,s61
v_perm_b32 v114,v102,v98,s61
v_perm_b32 v115,v103,v99,s61
v_perm_b32 v116,v100,v96,s62
v_perm_b32 v117,v101,v97,s62
v_perm_b32 v118,v102,v98,s62
v_perm_b32 v119,v103,v99,s62
v_accvgpr_write_b32 a48,v112
v_accvgpr_write_b32 a49,v113
v_accvgpr_write_b32 a50,v114
v_accvgpr_write_b32 a51,v115
v_accvgpr_write_b32 a56,v116
v_accvgpr_write_b32 a57,v117
v_accvgpr_write_b32 a58,v118
v_accvgpr_write_b32 a59,v119
s_waitcnt lgkmcnt(0)
v_perm_b32 v112,v108,v104,s61
v_perm_b32 v113,v109,v105,s61
v_perm_b32 v114,v110,v106,s61
v_perm_b32 v115,v111,v107,s61
v_perm_b32 v116,v108,v104,s62
v_perm_b32 v117,v109,v105,s62
v_perm_b32 v118,v110,v106,s62
v_perm_b32 v119,v111,v107,s62
v_accvgpr_write_b32 a52,v112
v_accvgpr_write_b32 a53,v113
v_accvgpr_write_b32 a54,v114
v_accvgpr_write_b32 a55,v115
v_accvgpr_write_b32 a60,v116
v_accvgpr_write_b32 a61,v117
v_accvgpr_write_b32 a62,v118
v_accvgpr_write_b32 a63,v119
s_mov_b32 s4,s26
s_mov_b32 s5,s27
s_mov_b32 s6,4194304
s_mov_b32 s7,0x20000
v_and_b32 v92,3,v1
v_lshlrev_b32 v93,4,v92
v_bfe_u32 v94,v1,2,2
v_lshl_add_u32 v92,v94,12,v93
v_lshl_add_u32 v93,v94,8,v93
v_and_b32 v94,1,v94
v_lshl_add_u32 v93,v94,6,v93
v_lshrrev_b32 v94,4,v1
v_lshl_add_u32 v92,v94,8,v92
v_lshl_add_u32 v93,v94,13,v93
s_lshl_b32 s56,s46,15
v_add_u32 v93,s56,v93
v_xor_b32 v94,64,v93
s_lshl_b32 s56,s47,17
s_lshl_b32 s57,s46,6
s_add_u32 s56,s56,s57
v_add_u32 v92,s56,v92
s_cmp_ge_u32 s48,3
s_cbranch_scc1 L_lw_18
s_mov_b32 s56,0
buffer_load_dwordx4 v[24:27],v92,s[4:7],s56 offen offset:0
buffer_load_dwordx4 v[28:31],v92,s[4:7],s56 offen offset:1024
buffer_load_dwordx4 v[32:35],v92,s[4:7],s56 offen offset:2048
buffer_load_dwordx4 v[36:39],v92,s[4:7],s56 offen offset:3072
s_mov_b32 s56,16384
buffer_load_dwordx4 v[40:43],v92,s[4:7],s56 offen offset:0
buffer_load_dwordx4 v[44:47],v92,s[4:7],s56 offen offset:1024
buffer_load_dwordx4 v[48:51],v92,s[4:7],s56 offen offset:2048
buffer_load_dwordx4 v[52:55],v92,s[4:7],s56 offen offset:3072
s_mov_b32 s56,32768
buffer_load_dwordx4 v[56:59],v92,s[4:7],s56 offen offset:0
buffer_load_dwordx4 v[60:63],v92,s[4:7],s56 offen offset:1024
buffer_load_dwordx4 v[64:67],v92,s[4:7],s56 offen offset:2048
buffer_load_dwordx4 v[68:71],v92,s[4:7],s56 offen offset:3072
s_mov_b32 s56,49152
buffer_load_dwordx4 v[72:75],v92,s[4:7],s56 offen offset:0
buffer_load_dwordx4 v[76:79],v92,s[4:7],s56 offen offset:1024
buffer_load_dwordx4 v[80:83],v92,s[4:7],s56 offen offset:2048
buffer_load_dwordx4 v[84:87],v92,s[4:7],s56 offen offset:3072
s_waitcnt vmcnt(16)
s_branch L_lj_19
L_lw_18:
s_waitcnt vmcnt(0)
L_lj_19:
v_xor_b32 v5,16384,v3
v_xor_b32 v6,16384,v4
ds_read2_b32 v[96:97],v5 offset1:32
ds_read2_b32 v[100:101],v6 offset1:32
ds_read2_b32 v[98:99],v5 offset0:64 offset1:96
ds_read2_b32 v[102:103],v6 offset0:64 offset1:96
v_xor_b32 v5,18432,v3
v_xor_b32 v6,18432,v4
ds_read2_b32 v[104:105],v5 offset1:32
ds_read2_b32 v[108:109],v6 offset1:32
ds_read2_b32 v[106:107],v5 offset0:64 offset1:96
ds_read2_b32 v[110:111],v6 offset0:64 offset1:96
s_waitcnt lgkmcnt(4)
v_perm_b32 v112,v100,v96,s61
v_perm_b32 v113,v101,v97,s61
v_perm_b32 v114,v102,v98,s61
v_perm_b32 v115,v103,v99,s61
v_perm_b32 v116,v100,v96,s62
v_perm_b32 v117,v101,v97,s62
v_perm_b32 v118,v102,v98,s62
v_perm_b32 v119,v103,v99,s62
v_accvgpr_write_b32 a64,v112
v_accvgpr_write_b32 a65,v113
v_accvgpr_write_b32 a66,v114
v_accvgpr_write_b32 a67,v115
v_accvgpr_write_b32 a72,v116
v_accvgpr_write_b32 a73,v117
v_accvgpr_write_b32 a74,v118
v_accvgpr_write_b32 a75,v119
v_xor_b32 v5,20480,v3
v_xor_b32 v6,20480,v4
ds_read2_b32 v[96:97],v5 offset1:32
ds_read2_b32 v[100:101],v6 offset1:32
ds_read2_b32 v[98:99],v5 offset0:64 offset1:96
ds_read2_b32 v[102:103],v6 offset0:64 offset1:96
s_waitcnt lgkmcnt(4)
v_perm_b32 v112,v108,v104,s61
v_perm_b32 v113,v109,v105,s61
v_perm_b32 v114,v110,v106,s61
v_perm_b32 v115,v111,v107,s61
v_perm_b32 v116,v108,v104,s62
v_perm_b32 v117,v109,v105,s62
v_perm_b32 v118,v110,v106,s62
v_perm_b32 v119,v111,v107,s62
v_accvgpr_write_b32 a68,v112
v_accvgpr_write_b32 a69,v113
v_accvgpr_write_b32 a70,v114
v_accvgpr_write_b32 a71,v115
v_accvgpr_write_b32 a76,v116
v_accvgpr_write_b32 a77,v117
v_accvgpr_write_b32 a78,v118
v_accvgpr_write_b32 a79,v119
v_xor_b32 v5,22528,v3
v_xor_b32 v6,22528,v4
ds_read2_b32 v[104:105],v5 offset1:32
ds_read2_b32 v[108:109],v6 offset1:32
ds_read2_b32 v[106:107],v5 offset0:64 offset1:96
ds_read2_b32 v[110:111],v6 offset0:64 offset1:96
s_waitcnt lgkmcnt(4)
v_perm_b32 v112,v100,v96,s61
v_perm_b32 v113,v101,v97,s61
v_perm_b32 v114,v102,v98,s61
v_perm_b32 v115,v103,v99,s61
v_perm_b32 v116,v100,v96,s62
v_perm_b32 v117,v101,v97,s62
v_perm_b32 v118,v102,v98,s62
v_perm_b32 v119,v103,v99,s62
v_accvgpr_write_b32 a80,v112
v_accvgpr_write_b32 a81,v113
v_accvgpr_write_b32 a82,v114
v_accvgpr_write_b32 a83,v115
v_accvgpr_write_b32 a88,v116
v_accvgpr_write_b32 a89,v117
v_accvgpr_write_b32 a90,v118
v_accvgpr_write_b32 a91,v119
v_xor_b32 v5,24576,v3
v_xor_b32 v6,24576,v4
ds_read2_b32 v[96:97],v5 offset1:32
ds_read2_b32 v[100:101],v6 offset1:32
ds_read2_b32 v[98:99],v5 offset0:64 offset1:96
ds_read2_b32 v[102:103],v6 offset0:64 offset1:96
s_waitcnt lgkmcnt(4)
v_perm_b32 v112,v108,v104,s61
v_perm_b32 v113,v109,v105,s61
v_perm_b32 v114,v110,v106,s61
v_perm_b32 v115,v111,v107,s61
v_perm_b32 v116,v108,v104,s62
v_perm_b32 v117,v109,v105,s62
v_perm_b32 v118,v110,v106,s62
v_perm_b32 v119,v111,v107,s62
v_accvgpr_write_b32 a84,v112
v_accvgpr_write_b32 a85,v113
v_accvgpr_write_b32 a86,v114
v_accvgpr_write_b32 a87,v115
v_accvgpr_write_b32 a92,v116
v_accvgpr_write_b32 a93,v117
v_accvgpr_write_b32 a94,v118
v_accvgpr_write_b32 a95,v119
v_xor_b32 v5,26624,v3
v_xor_b32 v6,26624,v4
ds_read2_b32 v[104:105],v5 offset1:32
ds_read2_b32 v[108:109],v6 offset1:32
ds_read2_b32 v[106:107],v5 offset0:64 offset1:96
ds_read2_b32 v[110:111],v6 offset0:64 offset1:96
s_waitcnt lgkmcnt(4)
v_perm_b32 v112,v100,v96,s61
v_perm_b32 v113,v101,v97,s61
v_perm_b32 v114,v102,v98,s61
v_perm_b32 v115,v103,v99,s61
v_perm_b32 v116,v100,v96,s62
v_perm_b32 v117,v101,v97,s62
v_perm_b32 v118,v102,v98,s62
v_perm_b32 v119,v103,v99,s62
v_accvgpr_write_b32 a96,v112
v_accvgpr_write_b32 a97,v113
v_accvgpr_write_b32 a98,v114
v_accvgpr_write_b32 a99,v115
v_accvgpr_write_b32 a104,v116
v_accvgpr_write_b32 a105,v117
v_accvgpr_write_b32 a106,v118
v_accvgpr_write_b32 a107,v119
v_xor_b32 v5,28672,v3
v_xor_b32 v6,28672,v4
ds_read2_b32 v[96:97],v5 offset1:32
ds_read2_b32 v[100:101],v6 offset1:32
ds_read2_b32 v[98:99],v5 offset0:64 offset1:96
ds_read2_b32 v[102:103],v6 offset0:64 offset1:96
s_waitcnt lgkmcnt(4)
v_perm_b32 v112,v108,v104,s61
v_perm_b32 v113,v109,v105,s61
v_perm_b32 v114,v110,v106,s61
v_perm_b32 v115,v111,v107,s61
v_perm_b32 v116,v108,v104,s62
v_perm_b32 v117,v109,v105,s62
v_perm_b32 v118,v110,v106,s62
v_perm_b32 v119,v111,v107,s62
v_accvgpr_write_b32 a100,v112
v_accvgpr_write_b32 a101,v113
v_accvgpr_write_b32 a102,v114
v_accvgpr_write_b32 a103,v115
v_accvgpr_write_b32 a108,v116
v_accvgpr_write_b32 a109,v117
v_accvgpr_write_b32 a110,v118
v_accvgpr_write_b32 a111,v119
v_xor_b32 v5,30720,v3
v_xor_b32 v6,30720,v4
ds_read2_b32 v[104:105],v5 offset1:32
ds_read2_b32 v[108:109],v6 offset1:32
ds_read2_b32 v[106:107],v5 offset0:64 offset1:96
ds_read2_b32 v[110:111],v6 offset0:64 offset1:96
s_waitcnt lgkmcnt(4)
v_perm_b32 v112,v100,v96,s61
v_perm_b32 v113,v101,v97,s61
v_perm_b32 v114,v102,v98,s61
v_perm_b32 v115,v103,v99,s61
v_perm_b32 v116,v100,v96,s62
v_perm_b32 v117,v101,v97,s62
v_perm_b32 v118,v102,v98,s62
v_perm_b32 v119,v103,v99,s62
v_accvgpr_write_b32 a112,v112
v_accvgpr_write_b32 a113,v113
v_accvgpr_write_b32 a114,v114
v_accvgpr_write_b32 a115,v115
v_accvgpr_write_b32 a120,v116
v_accvgpr_write_b32 a121,v117
v_accvgpr_write_b32 a122,v118
v_accvgpr_write_b32 a123,v119
s_waitcnt lgkmcnt(0)
v_perm_b32 v112,v108,v104,s61
v_perm_b32 v113,v109,v105,s61
v_perm_b32 v114,v110,v106,s61
v_perm_b32 v115,v111,v107,s61
v_perm_b32 v116,v108,v104,s62
v_perm_b32 v117,v109,v105,s62
v_perm_b32 v118,v110,v106,s62
v_perm_b32 v119,v111,v107,s62
v_accvgpr_write_b32 a116,v112
v_accvgpr_write_b32 a117,v113
v_accvgpr_write_b32 a118,v114
v_accvgpr_write_b32 a119,v115
v_accvgpr_write_b32 a124,v116
v_accvgpr_write_b32 a125,v117
v_accvgpr_write_b32 a126,v118
v_accvgpr_write_b32 a127,v119
s_cmp_lt_u32 s48,3
s_cbranch_scc1 L_rch_4
s_cmp_eq_u32 s48,3
s_cbranch_scc1 L_rm_5
v_mov_b32 v123,159744
s_cmp_lg_u32 s46,0
s_cbranch_scc1 L_gbd_21
v_mov_b32 v124,240
L_gb_20:
buffer_load_dword v125,v124,s[12:15],0 offen sc1
s_waitcnt vmcnt(0)
v_readfirstlane_b32 s56,v125
ds_write_b32 v123,v125
s_bitcmp1_b32 s56,8
s_cbranch_scc1 L_gbd_21
s_sleep 4
s_sub_u32 s49,s49,1
s_cmp_gt_i32 s49,0
s_cbranch_scc1 L_gb_20
s_branch L_abort
L_gbd_21:
s_waitcnt lgkmcnt(0)
s_barrier
ds_read_b32 v125,v123
s_waitcnt lgkmcnt(0)
v_readfirstlane_b32 s56,v125
s_barrier
s_lshr_b32 s56,s56,16
s_andn2_b32 s56,s56,s3
s_cbranch_scc1 L_spread
v_and_b32 v120,15,v1
v_lshrrev_b32 v121,4,v1
v_mov_b32 v17,1
s_lshl_b32 s56,s46,15
v_add_u32 v18,s56,v0
s_lshl_b32 s56,s46,2
v_add_u32 v125,s56,v121
v_xor_b32 v126,v125,v120
v_lshlrev_b32 v126,4,v126
v_lshl_add_u32 v20,v125,10,v126
v_add_u32 v125,0,v121
v_xor_b32 v125,v125,v120
v_lshlrev_b32 v125,4,v125
v_lshl_add_u32 v125,v120,8,v125
v_add_u32 v4,65536,v125
v_add_u32 v125,4,v121
v_xor_b32 v125,v125,v120
v_lshlrev_b32 v125,4,v125
v_lshl_add_u32 v125,v120,8,v125
v_add_u32 v5,65536,v125
v_add_u32 v125,8,v121
v_xor_b32 v125,v125,v120
v_lshlrev_b32 v125,4,v125
v_lshl_add_u32 v125,v120,8,v125
v_add_u32 v6,65536,v125
v_add_u32 v125,12,v121
v_xor_b32 v125,v125,v120
v_lshlrev_b32 v125,4,v125
v_lshl_add_u32 v125,v120,8,v125
v_add_u32 v7,65536,v125
v_lshlrev_b32 v21,5,v120
v_and_b32 v125,1,v121
v_lshl_add_u32 v21,v125,4,v21
s_lshl_b32 s56,s46,9
v_lshrrev_b32 v125,1,v121
v_lshl_add_u32 v21,v125,11,v21
s_add_u32 s56,s56,155648
v_add_u32 v21,s56,v21
v_lshlrev_b32 v22,4,v120
v_lshl_add_u32 v22,v121,10,v22
s_lshl_b32 s56,s46,8
v_add_u32 v22,s56,v22
s_sub_u32 s54,s48,4
s_cmp_eq_u32 s54,0
s_mov_b32 s72,1073752746
s_mov_b32 s73,1145324612
s_cmov_b32 s72,268440917
s_cmov_b32 s73,286331153
s_mov_b32 s70,0x80000000
s_mov_b32 s53,7
s_mov_b32 s74,s50
s_xor_b32 s75,s74,32768
v_and_b32 v23,31,v1
v_lshlrev_b32 v23,2,v23
v_mov_b32 v19,s50
v_mov_b32 v16,0
s_ff1_i32_b64 s55,s[72:73]
s_bitset0_b64 s[72:73],s55
s_min_u32 s55,s55,127
s_lshl_b32 s68,s55,15
s_add_u32 s68,s68,0
s_add_u32 s69,s68,16384
s_add_u32 m0,s75,65536
s_nop 0
buffer_load_dwordx4 v20,s[8:11],s68 offen offset:0 sc1 lds
s_add_u32 m0,s75,69632
s_nop 0
buffer_load_dwordx4 v20,s[8:11],s69 offen offset:0 sc1 lds
s_add_u32 m0,s75,73472
s_nop 0
buffer_load_dwordx4 v20,s[8:11],s68 offen offset:256 sc1 lds
s_add_u32 m0,s75,77568
s_nop 0
buffer_load_dwordx4 v20,s[8:11],s69 offen offset:256 sc1 lds
s_add_u32 m0,s75,81408
s_nop 0
buffer_load_dwordx4 v20,s[8:11],s68 offen offset:512 sc1 lds
s_add_u32 m0,s75,85504
s_nop 0
buffer_load_dwordx4 v20,s[8:11],s69 offen offset:512 sc1 lds
s_add_u32 m0,s75,89344
s_nop 0
buffer_load_dwordx4 v20,s[8:11],s68 offen offset:768 sc1 lds
s_add_u32 m0,s75,93440
s_nop 0
buffer_load_dwordx4 v20,s[8:11],s69 offen offset:768 sc1 lds
s_waitcnt vmcnt(0)
s_barrier
L_p_22:
s_mov_b32 s75,s74
s_xor_b32 s74,s74,32768
v_xor_b32 v4,32768,v4
v_xor_b32 v5,32768,v5
v_xor_b32 v6,32768,v6
v_xor_b32 v7,32768,v7
ds_read_b128 v[104:107],v4 offset:0
ds_read_b128 v[108:111],v4 offset:4096
ds_read_b128 v[112:115],v5 offset:0
ds_read_b128 v[116:119],v5 offset:4096
s_waitcnt lgkmcnt(2)
v_mfma_f32_16x16x32_bf16 v[24:27],a[128:131],v[104:107],0
ds_read_b128 v[120:123],v6 offset:0
v_mfma_f32_16x16x32_bf16 v[40:43],v[104:107],v[128:131],0
s_mov_b32 s51,s55
v_mfma_f32_16x16x32_bf16 v[28:31],a[128:131],v[108:111],0
ds_read_b128 v[124:127],v6 offset:4096
v_mfma_f32_16x16x32_bf16 v[44:47],v[108:111],v[128:131],0
s_mov_b32 s77,0
v_mfma_f32_16x16x32_bf16 v[32:35],a[136:139],v[104:107],0
s_sub_u32 s53,s53,1
v_mfma_f32_16x16x32_bf16 v[48:51],v[104:107],v[136:139],0
s_ff1_i32_b64 s55,s[72:73]
v_mfma_f32_16x16x32_bf16 v[36:39],a[136:139],v[108:111],0
s_bitset0_b64 s[72:73],s55
v_mfma_f32_16x16x32_bf16 v[52:55],v[108:111],v[136:139],0
s_min_u32 s55,s55,127
s_waitcnt lgkmcnt(2)
v_mfma_f32_16x16x32_bf16 v[24:27],a[132:135],v[112:115],v[24:27]
ds_read_b128 v[104:107],v7 offset:0
v_mfma_f32_16x16x32_bf16 v[40:43],v[112:115],v[132:135],v[40:43]
s_lshl_b32 s58,s51,5
v_mfma_f32_16x16x32_bf16 v[28:31],a[132:135],v[116:119],v[28:31]
ds_read_b128 v[108:111],v7 offset:4096
v_mfma_f32_16x16x32_bf16 v[44:47],v[116:119],v[132:135],v[44:47]
s_add_u32 s58,s58,s47
v_mfma_f32_16x16x32_bf16 v[32:35],a[140:143],v[112:115],v[32:35]
s_mul_i32 s58,s58,24576
v_mfma_f32_16x16x32_bf16 v[48:51],v[112:115],v[140:143],v[48:51]
s_add_u32 s58,s58,100663296
v_mfma_f32_16x16x32_bf16 v[36:39],a[140:143],v[116:119],v[36:39]
s_add_u32 s61,s58,s50
v_mfma_f32_16x16x32_bf16 v[52:55],v[116:119],v[140:143],v[52:55]
s_add_u32 s62,s61,4096
s_waitcnt lgkmcnt(2)
v_mfma_f32_16x16x32_bf16 v[24:27],a[144:147],v[120:123],v[24:27]
ds_read_b128 v[112:115],v4 offset:8192
v_mfma_f32_16x16x32_bf16 v[40:43],v[120:123],v[144:147],v[40:43]
s_add_u32 s63,s61,16384
v_mfma_f32_16x16x32_bf16 v[28:31],a[144:147],v[124:127],v[28:31]
ds_read_b128 v[116:119],v4 offset:12288
v_mfma_f32_16x16x32_bf16 v[44:47],v[124:127],v[144:147],v[44:47]
s_add_u32 s64,s61,20480
v_mfma_f32_16x16x32_bf16 v[32:35],a[152:155],v[120:123],v[32:35]
s_add_u32 s65,s61,s50
v_mfma_f32_16x16x32_bf16 v[48:51],v[120:123],v[152:155],v[48:51]
s_add_u32 s65,s65,8192
v_mfma_f32_16x16x32_bf16 v[36:39],a[152:155],v[124:127],v[36:39]
v_mfma_f32_16x16x32_bf16 v[52:55],v[124:127],v[152:155],v[52:55]
s_waitcnt lgkmcnt(2)
v_mfma_f32_16x16x32_bf16 v[24:27],a[148:151],v[104:107],v[24:27]
ds_read_b128 v[120:123],v5 offset:8192
v_mfma_f32_16x16x32_bf16 v[40:43],v[104:107],v[148:151],v[40:43]
v_mfma_f32_16x16x32_bf16 v[28:31],a[148:151],v[108:111],v[28:31]
ds_read_b128 v[124:127],v5 offset:12288
v_mfma_f32_16x16x32_bf16 v[44:47],v[108:111],v[148:151],v[44:47]
v_mfma_f32_16x16x32_bf16 v[32:35],a[156:159],v[104:107],v[32:35]
v_mfma_f32_16x16x32_bf16 v[48:51],v[104:107],v[156:159],v[48:51]
v_mfma_f32_16x16x32_bf16 v[36:39],a[156:159],v[108:111],v[36:39]
v_mfma_f32_16x16x32_bf16 v[52:55],v[108:111],v[156:159],v[52:55]
s_waitcnt lgkmcnt(2)
v_mfma_f32_16x16x32_bf16 v[24:27],a[160:163],v[112:115],v[24:27]
ds_read_b128 v[104:107],v6 offset:8192
v_mfma_f32_16x16x32_bf16 v[40:43],v[112:115],v[160:163],v[40:43]
s_lshl_b32 s56,s54,13
v_mfma_f32_16x16x32_bf16 v[28:31],a[160:163],v[116:119],v[28:31]
ds_read_b128 v[108:111],v6 offset:12288
v_mfma_f32_16x16x32_bf16 v[44:47],v[116:119],v[160:163],v[44:47]
s_add_u32 s56,s56,10487552
v_mfma_f32_16x16x32_bf16 v[32:35],a[168:171],v[112:115],v[32:35]
s_or_b32 s56,s56,s52
v_mfma_f32_16x16x32_bf16 v[48:51],v[112:115],v[168:171],v[48:51]
buffer_load_dword v76,v23,s[8:11],s56 offen sc1
v_mfma_f32_16x16x32_bf16 v[36:39],a[168:171],v[116:119],v[36:39]
v_mfma_f32_16x16x32_bf16 v[52:55],v[116:119],v[168:171],v[52:55]
s_waitcnt lgkmcnt(2)
v_mfma_f32_16x16x32_bf16 v[24:27],a[164:167],v[120:123],v[24:27]
ds_read_b128 v[112:115],v7 offset:8192
v_mfma_f32_16x16x32_bf16 v[40:43],v[120:123],v[164:167],v[40:43]
v_mfma_f32_16x16x32_bf16 v[28:31],a[164:167],v[124:127],v[28:31]
ds_read_b128 v[116:119],v7 offset:12288
v_mfma_f32_16x16x32_bf16 v[44:47],v[124:127],v[164:167],v[44:47]
v_mfma_f32_16x16x32_bf16 v[32:35],a[172:175],v[120:123],v[32:35]
v_mfma_f32_16x16x32_bf16 v[48:51],v[120:123],v[172:175],v[48:51]
v_mfma_f32_16x16x32_bf16 v[36:39],a[172:175],v[124:127],v[36:39]
v_mfma_f32_16x16x32_bf16 v[52:55],v[124:127],v[172:175],v[52:55]
s_waitcnt lgkmcnt(2)
v_mfma_f32_16x16x32_bf16 v[24:27],a[176:179],v[104:107],v[24:27]
ds_read_b128 v[120:123],v4 offset:16384
v_mfma_f32_16x16x32_bf16 v[40:43],v[104:107],v[176:179],v[40:43]
v_mfma_f32_16x16x32_bf16 v[28:31],a[176:179],v[108:111],v[28:31]
ds_read_b128 v[124:127],v4 offset:20480
v_mfma_f32_16x16x32_bf16 v[44:47],v[108:111],v[176:179],v[44:47]
v_mfma_f32_16x16x32_bf16 v[32:35],a[184:187],v[104:107],v[32:35]
v_mfma_f32_16x16x32_bf16 v[48:51],v[104:107],v[184:187],v[48:51]
v_mfma_f32_16x16x32_bf16 v[36:39],a[184:187],v[108:111],v[36:39]
v_mfma_f32_16x16x32_bf16 v[52:55],v[108:111],v[184:187],v[52:55]
s_waitcnt lgkmcnt(2)
v_mfma_f32_16x16x32_bf16 v[24:27],a[180:183],v[112:115],v[24:27]
ds_read_b128 v[104:107],v5 offset:16384
v_mfma_f32_16x16x32_bf16 v[40:43],v[112:115],v[180:183],v[40:43]
v_mfma_f32_16x16x32_bf16 v[28:31],a[180:183],v[116:119],v[28:31]
ds_read_b128 v[108:111],v5 offset:20480
v_mfma_f32_16x16x32_bf16 v[44:47],v[116:119],v[180:183],v[44:47]
v_mfma_f32_16x16x32_bf16 v[32:35],a[188:191],v[112:115],v[32:35]
v_mfma_f32_16x16x32_bf16 v[48:51],v[112:115],v[188:191],v[48:51]
v_mfma_f32_16x16x32_bf16 v[36:39],a[188:191],v[116:119],v[36:39]
v_mfma_f32_16x16x32_bf16 v[52:55],v[116:119],v[188:191],v[52:55]
s_waitcnt lgkmcnt(2)
v_mfma_f32_16x16x32_bf16 v[24:27],a[192:195],v[120:123],v[24:27]
ds_read_b128 v[112:115],v6 offset:16384
v_mfma_f32_16x16x32_bf16 v[40:43],v[120:123],v[192:195],v[40:43]
v_mfma_f32_16x16x32_bf16 v[28:31],a[192:195],v[124:127],v[28:31]
ds_read_b128 v[116:119],v6 offset:20480
v_mfma_f32_16x16x32_bf16 v[44:47],v[124:127],v[192:195],v[44:47]
v_mfma_f32_16x16x32_bf16 v[32:35],a[200:203],v[120:123],v[32:35]
v_mfma_f32_16x16x32_bf16 v[48:51],v[120:123],v[200:203],v[48:51]
v_mfma_f32_16x16x32_bf16 v[36:39],a[200:203],v[124:127],v[36:39]
v_mfma_f32_16x16x32_bf16 v[52:55],v[124:127],v[200:203],v[52:55]
s_waitcnt lgkmcnt(2)
v_mfma_f32_16x16x32_bf16 v[24:27],a[196:199],v[104:107],v[24:27]
ds_read_b128 v[120:123],v7 offset:16384
v_mfma_f32_16x16x32_bf16 v[40:43],v[104:107],v[196:199],v[40:43]
s_waitcnt vmcnt(0)
v_mfma_f32_16x16x32_bf16 v[28:31],a[196:199],v[108:111],v[28:31]
ds_read_b128 v[124:127],v7 offset:20480
v_mfma_f32_16x16x32_bf16 v[44:47],v[108:111],v[196:199],v[44:47]
v_cmp_eq_u32 vcc,0,v76
v_mfma_f32_16x16x32_bf16 v[32:35],a[204:207],v[104:107],v[32:35]
s_nop 0
v_mov_b32 v76,vcc_lo
v_mfma_f32_16x16x32_bf16 v[48:51],v[104:107],v[204:207],v[48:51]
ds_write_b32 v19,v76
v_mfma_f32_16x16x32_bf16 v[36:39],a[204:207],v[108:111],v[36:39]
v_mfma_f32_16x16x32_bf16 v[52:55],v[108:111],v[204:207],v[52:55]
s_waitcnt vmcnt(0) lgkmcnt(0)
s_barrier
s_or_b32 s70,s70,s52
buffer_store_dword v17,off,s[8:11],s70 sc1
ds_read_b32 v76,v16
v_mfma_f32_16x16x32_bf16 v[24:27],a[208:211],v[112:115],v[24:27]
ds_read_b128 v[104:107],v4 offset:24576
v_mfma_f32_16x16x32_bf16 v[40:43],v[112:115],v[208:211],v[40:43]
s_lshl_b32 s56,s51,5
s_add_u32 s56,s56,s47
s_lshl_b32 s56,s56,12
v_mfma_f32_16x16x32_bf16 v[28:31],a[208:211],v[116:119],v[28:31]
ds_read_b128 v[108:111],v4 offset:28672
v_mfma_f32_16x16x32_bf16 v[44:47],v[116:119],v[208:211],v[44:47]
s_add_u32 s56,s56,s50
s_add_u32 s56,s56,41943040
v_mfma_f32_16x16x32_bf16 v[32:35],a[216:219],v[112:115],v[32:35]
v_mov_b64 v[72:73],-1
v_mov_b64 v[74:75],-1
v_mfma_f32_16x16x32_bf16 v[48:51],v[112:115],v[216:219],v[48:51]
buffer_store_dwordx4 v[72:75],v0,s[8:11],s56 offen sc1
v_mfma_f32_16x16x32_bf16 v[36:39],a[216:219],v[116:119],v[36:39]
v_mfma_f32_16x16x32_bf16 v[52:55],v[116:119],v[216:219],v[52:55]
s_waitcnt lgkmcnt(2)
v_mfma_f32_16x16x32_bf16 v[24:27],a[212:215],v[120:123],v[24:27]
ds_read_b128 v[112:115],v5 offset:24576
v_mfma_f32_16x16x32_bf16 v[40:43],v[120:123],v[212:215],v[40:43]
v_readfirstlane_b32 s57,v76
v_mfma_f32_16x16x32_bf16 v[28:31],a[212:215],v[124:127],v[28:31]
ds_read_b128 v[116:119],v5 offset:28672
v_mfma_f32_16x16x32_bf16 v[44:47],v[124:127],v[212:215],v[44:47]
s_sub_u32 s59,s55,s54
s_cmp_lt_i32 s59,44
s_cselect_b32 s76,2,0
v_mfma_f32_16x16x32_bf16 v[32:35],a[220:223],v[120:123],v[32:35]
s_cmp_gt_i32 s53,0
s_cselect_b32 s76,s76,0
v_mfma_f32_16x16x32_bf16 v[48:51],v[120:123],v[220:223],v[48:51]
s_cmp_eq_u32 s57,0
s_cselect_b32 s76,1,s76
v_mfma_f32_16x16x32_bf16 v[36:39],a[220:223],v[124:127],v[36:39]
s_cmp_lt_i32 s59,12
s_cselect_b32 s76,2,s76
s_add_u32 s57,s54,64
v_mfma_f32_16x16x32_bf16 v[52:55],v[124:127],v[220:223],v[52:55]
s_cmp_eq_u32 s76,1
s_cselect_b32 s68,s57,s55
s_lshl_b32 s68,s68,15
s_waitcnt lgkmcnt(2)
v_mfma_f32_16x16x32_bf16 v[24:27],a[224:227],v[104:107],v[24:27]
ds_read_b128 v[120:123],v6 offset:24576
v_mfma_f32_16x16x32_bf16 v[40:43],v[104:107],v[224:227],v[40:43]
s_cmp_eq_u32 s76,0
s_cselect_b32 s68,0x80000000,s68
s_add_u32 s69,s68,16384
v_mfma_f32_16x16x32_bf16 v[28:31],a[224:227],v[108:111],v[28:31]
ds_read_b128 v[124:127],v6 offset:28672
v_mfma_f32_16x16x32_bf16 v[44:47],v[108:111],v[224:227],v[44:47]
s_add_u32 m0,s75,65536
v_mfma_f32_16x16x32_bf16 v[32:35],a[232:235],v[104:107],v[32:35]
buffer_load_dwordx4 v20,s[8:11],s68 offen offset:0 sc1 lds
v_mfma_f32_16x16x32_bf16 v[48:51],v[104:107],v[232:235],v[48:51]
s_add_u32 m0,s75,69632
v_mfma_f32_16x16x32_bf16 v[36:39],a[232:235],v[108:111],v[36:39]
buffer_load_dwordx4 v20,s[8:11],s69 offen offset:0 sc1 lds
v_mfma_f32_16x16x32_bf16 v[52:55],v[108:111],v[232:235],v[52:55]
s_add_u32 m0,s75,73472
s_waitcnt lgkmcnt(2)
v_mfma_f32_16x16x32_bf16 v[24:27],a[228:231],v[112:115],v[24:27]
ds_read_b128 v[104:107],v7 offset:24576
v_mfma_f32_16x16x32_bf16 v[40:43],v[112:115],v[228:231],v[40:43]
buffer_load_dwordx4 v20,s[8:11],s68 offen offset:256 sc1 lds
v_mfma_f32_16x16x32_bf16 v[28:31],a[228:231],v[116:119],v[28:31]
ds_read_b128 v[108:111],v7 offset:28672
v_mfma_f32_16x16x32_bf16 v[44:47],v[116:119],v[228:231],v[44:47]
s_add_u32 m0,s75,77568
v_mfma_f32_16x16x32_bf16 v[32:35],a[236:239],v[112:115],v[32:35]
buffer_load_dwordx4 v20,s[8:11],s69 offen offset:256 sc1 lds
v_mfma_f32_16x16x32_bf16 v[48:51],v[112:115],v[236:239],v[48:51]
s_add_u32 m0,s75,81408
v_mfma_f32_16x16x32_bf16 v[36:39],a[236:239],v[116:119],v[36:39]
buffer_load_dwordx4 v20,s[8:11],s68 offen offset:512 sc1 lds
v_mfma_f32_16x16x32_bf16 v[52:55],v[116:119],v[236:239],v[52:55]
s_add_u32 m0,s75,85504
s_waitcnt lgkmcnt(2)
v_mfma_f32_16x16x32_bf16 v[24:27],a[240:243],v[120:123],v[24:27]
ds_read_b128 v[112:115],v4 offset:0
v_mfma_f32_16x16x32_bf16 v[40:43],v[120:123],v[240:243],v[40:43]
buffer_load_dwordx4 v20,s[8:11],s69 offen offset:512 sc1 lds
v_mfma_f32_16x16x32_bf16 v[28:31],a[240:243],v[124:127],v[28:31]
ds_read_b128 v[116:119],v4 offset:4096
v_mfma_f32_16x16x32_bf16 v[44:47],v[124:127],v[240:243],v[44:47]
s_add_u32 m0,s75,89344
v_mfma_f32_16x16x32_bf16 v[32:35],a[248:251],v[120:123],v[32:35]
buffer_load_dwordx4 v20,s[8:11],s68 offen offset:768 sc1 lds
v_mfma_f32_16x16x32_bf16 v[48:51],v[120:123],v[248:251],v[48:51]
s_add_u32 m0,s75,93440
v_mfma_f32_16x16x32_bf16 v[36:39],a[248:251],v[124:127],v[36:39]
buffer_load_dwordx4 v20,s[8:11],s69 offen offset:768 sc1 lds
v_mfma_f32_16x16x32_bf16 v[52:55],v[124:127],v[248:251],v[52:55]
s_waitcnt lgkmcnt(2)
v_mfma_f32_16x16x32_bf16 v[24:27],a[244:247],v[104:107],v[24:27]
ds_read_b128 v[120:123],v5 offset:0
v_mfma_f32_16x16x32_bf16 v[40:43],v[104:107],v[244:247],v[40:43]
v_mfma_f32_16x16x32_bf16 v[28:31],a[244:247],v[108:111],v[28:31]
ds_read_b128 v[124:127],v5 offset:4096
v_mfma_f32_16x16x32_bf16 v[44:47],v[108:111],v[244:247],v[44:47]
v_mfma_f32_16x16x32_bf16 v[32:35],a[252:255],v[104:107],v[32:35]
v_mfma_f32_16x16x32_bf16 v[48:51],v[104:107],v[252:255],v[48:51]
v_mfma_f32_16x16x32_bf16 v[36:39],a[252:255],v[108:111],v[36:39]
v_mfma_f32_16x16x32_bf16 v[52:55],v[108:111],v[252:255],v[52:55]
s_waitcnt lgkmcnt(2)
v_mfma_f32_16x16x32_bf16 v[88:91],a[0:3],v[112:115],0
ds_read_b128 v[104:107],v6 offset:0
v_mfma_f32_16x16x32_bf16 v[92:95],a[0:3],v[116:119],0
v_mfma_f32_16x16x32_bf16 v[96:99],a[8:11],v[112:115],0
ds_read_b128 v[108:111],v6 offset:4096
v_cvt_pk_bf16_f32 v56,v24,v32
v_cvt_pk_bf16_f32 v57,v25,v33
v_mfma_f32_16x16x32_bf16 v[100:103],a[8:11],v[116:119],0
v_cvt_pk_bf16_f32 v58,v26,v34
v_cvt_pk_bf16_f32 v59,v27,v35
s_waitcnt lgkmcnt(2)
v_mfma_f32_16x16x32_bf16 v[88:91],a[4:7],v[120:123],v[88:91]
ds_read_b128 v[112:115],v7 offset:0
v_mfma_f32_16x16x32_bf16 v[92:95],a[4:7],v[124:127],v[92:95]
buffer_store_dwordx4 v[56:59],v0,s[8:11],s61 offen sc1
v_cvt_pk_bf16_f32 v60,v28,v36
v_cvt_pk_bf16_f32 v61,v29,v37
v_mfma_f32_16x16x32_bf16 v[96:99],a[12:15],v[120:123],v[96:99]
ds_read_b128 v[116:119],v7 offset:4096
v_cvt_pk_bf16_f32 v62,v30,v38
v_cvt_pk_bf16_f32 v63,v31,v39
v_mfma_f32_16x16x32_bf16 v[100:103],a[12:15],v[124:127],v[100:103]
buffer_store_dwordx4 v[60:63],v0,s[8:11],s62 offen sc1
v_cvt_pk_bf16_f32 v64,v40,v41
v_cvt_pk_bf16_f32 v65,v42,v43
s_waitcnt lgkmcnt(2)
v_mfma_f32_16x16x32_bf16 v[88:91],a[16:19],v[104:107],v[88:91]
ds_read_b128 v[120:123],v4 offset:8192
v_cvt_pk_bf16_f32 v66,v44,v45
v_cvt_pk_bf16_f32 v67,v46,v47
v_mfma_f32_16x16x32_bf16 v[92:95],a[16:19],v[108:111],v[92:95]
buffer_store_dwordx4 v[64:67],v0,s[8:11],s65 offen offset:0 sc1
v_cvt_pk_bf16_f32 v68,v48,v49
v_cvt_pk_bf16_f32 v69,v50,v51
v_mfma_f32_16x16x32_bf16 v[96:99],a[24:27],v[104:107],v[96:99]
ds_read_b128 v[124:127],v4 offset:12288
v_cvt_pk_bf16_f32 v70,v52,v53
v_cvt_pk_bf16_f32 v71,v54,v55
v_mfma_f32_16x16x32_bf16 v[100:103],a[24:27],v[108:111],v[100:103]
buffer_store_dwordx4 v[68:71],v0,s[8:11],s65 offen offset:1024 sc1
s_waitcnt lgkmcnt(2)
v_mfma_f32_16x16x32_bf16 v[88:91],a[20:23],v[112:115],v[88:91]
ds_read_b128 v[104:107],v5 offset:8192
v_mfma_f32_16x16x32_bf16 v[92:95],a[20:23],v[116:119],v[92:95]
v_mfma_f32_16x16x32_bf16 v[96:99],a[28:31],v[112:115],v[96:99]
ds_read_b128 v[108:111],v5 offset:12288
v_mfma_f32_16x16x32_bf16 v[100:103],a[28:31],v[116:119],v[100:103]
s_waitcnt lgkmcnt(2)
v_mfma_f32_16x16x32_bf16 v[88:91],a[32:35],v[120:123],v[88:91]
ds_read_b128 v[112:115],v6 offset:8192
v_mfma_f32_16x16x32_bf16 v[92:95],a[32:35],v[124:127],v[92:95]
v_mfma_f32_16x16x32_bf16 v[96:99],a[40:43],v[120:123],v[96:99]
ds_read_b128 v[116:119],v6 offset:12288
v_mfma_f32_16x16x32_bf16 v[100:103],a[40:43],v[124:127],v[100:103]
s_waitcnt lgkmcnt(2)
v_mfma_f32_16x16x32_bf16 v[88:91],a[36:39],v[104:107],v[88:91]
ds_read_b128 v[120:123],v7 offset:8192
v_mfma_f32_16x16x32_bf16 v[92:95],a[36:39],v[108:111],v[92:95]
v_mfma_f32_16x16x32_bf16 v[96:99],a[44:47],v[104:107],v[96:99]
ds_read_b128 v[124:127],v7 offset:12288
v_mfma_f32_16x16x32_bf16 v[100:103],a[44:47],v[108:111],v[100:103]
s_waitcnt lgkmcnt(2)
v_mfma_f32_16x16x32_bf16 v[88:91],a[48:51],v[112:115],v[88:91]
ds_read_b128 v[104:107],v4 offset:16384
v_mfma_f32_16x16x32_bf16 v[92:95],a[48:51],v[116:119],v[92:95]
s_lshl_b32 s56,s54,13
v_mfma_f32_16x16x32_bf16 v[96:99],a[56:59],v[112:115],v[96:99]
ds_read_b128 v[108:111],v4 offset:20480
v_mfma_f32_16x16x32_bf16 v[100:103],a[56:59],v[116:119],v[100:103]
s_add_u32 s56,s56,10487552
s_waitcnt lgkmcnt(2)
v_mfma_f32_16x16x32_bf16 v[88:91],a[52:55],v[120:123],v[88:91]
ds_read_b128 v[112:115],v5 offset:16384
v_mfma_f32_16x16x32_bf16 v[92:95],a[52:55],v[124:127],v[92:95]
s_or_b32 s56,s56,s52
v_mfma_f32_16x16x32_bf16 v[96:99],a[60:63],v[120:123],v[96:99]
ds_read_b128 v[116:119],v5 offset:20480
v_mfma_f32_16x16x32_bf16 v[100:103],a[60:63],v[124:127],v[100:103]
buffer_load_dword v76,v23,s[8:11],s56 offen sc1
s_waitcnt lgkmcnt(2)
v_mfma_f32_16x16x32_bf16 v[88:91],a[64:67],v[104:107],v[88:91]
ds_read_b128 v[120:123],v6 offset:16384
v_mfma_f32_16x16x32_bf16 v[92:95],a[64:67],v[108:111],v[92:95]
v_mfma_f32_16x16x32_bf16 v[96:99],a[72:75],v[104:107],v[96:99]
ds_read_b128 v[124:127],v6 offset:20480
v_mfma_f32_16x16x32_bf16 v[100:103],a[72:75],v[108:111],v[100:103]
s_waitcnt lgkmcnt(2)
v_mfma_f32_16x16x32_bf16 v[88:91],a[68:71],v[112:115],v[88:91]
ds_read_b128 v[104:107],v7 offset:16384
v_mfma_f32_16x16x32_bf16 v[92:95],a[68:71],v[116:119],v[92:95]
v_mfma_f32_16x16x32_bf16 v[96:99],a[76:79],v[112:115],v[96:99]
ds_read_b128 v[108:111],v7 offset:20480
v_mfma_f32_16x16x32_bf16 v[100:103],a[76:79],v[116:119],v[100:103]
s_waitcnt lgkmcnt(2)
v_mfma_f32_16x16x32_bf16 v[88:91],a[80:83],v[120:123],v[88:91]
ds_read_b128 v[112:115],v4 offset:24576
v_mfma_f32_16x16x32_bf16 v[92:95],a[80:83],v[124:127],v[92:95]
v_mfma_f32_16x16x32_bf16 v[96:99],a[88:91],v[120:123],v[96:99]
ds_read_b128 v[116:119],v4 offset:28672
v_mfma_f32_16x16x32_bf16 v[100:103],a[88:91],v[124:127],v[100:103]
s_waitcnt lgkmcnt(2)
v_mfma_f32_16x16x32_bf16 v[88:91],a[84:87],v[104:107],v[88:91]
ds_read_b128 v[120:123],v5 offset:24576
v_mfma_f32_16x16x32_bf16 v[92:95],a[84:87],v[108:111],v[92:95]
v_mfma_f32_16x16x32_bf16 v[96:99],a[92:95],v[104:107],v[96:99]
ds_read_b128 v[124:127],v5 offset:28672
v_mfma_f32_16x16x32_bf16 v[100:103],a[92:95],v[108:111],v[100:103]
s_waitcnt lgkmcnt(2)
v_mfma_f32_16x16x32_bf16 v[88:91],a[96:99],v[112:115],v[88:91]
ds_read_b128 v[104:107],v6 offset:24576
v_mfma_f32_16x16x32_bf16 v[92:95],a[96:99],v[116:119],v[92:95]
v_mfma_f32_16x16x32_bf16 v[96:99],a[104:107],v[112:115],v[96:99]
ds_read_b128 v[108:111],v6 offset:28672
v_mfma_f32_16x16x32_bf16 v[100:103],a[104:107],v[116:119],v[100:103]
s_waitcnt lgkmcnt(2)
v_mfma_f32_16x16x32_bf16 v[88:91],a[100:103],v[120:123],v[88:91]
ds_read_b128 v[112:115],v7 offset:24576
v_mfma_f32_16x16x32_bf16 v[92:95],a[100:103],v[124:127],v[92:95]
v_mfma_f32_16x16x32_bf16 v[96:99],a[108:111],v[120:123],v[96:99]
ds_read_b128 v[116:119],v7 offset:28672
v_mfma_f32_16x16x32_bf16 v[100:103],a[108:111],v[124:127],v[100:103]
s_waitcnt lgkmcnt(2)
v_mfma_f32_16x16x32_bf16 v[88:91],a[112:115],v[104:107],v[88:91]
v_mfma_f32_16x16x32_bf16 v[92:95],a[112:115],v[108:111],v[92:95]
v_mfma_f32_16x16x32_bf16 v[96:99],a[120:123],v[104:107],v[96:99]
v_mfma_f32_16x16x32_bf16 v[100:103],a[120:123],v[108:111],v[100:103]
s_waitcnt lgkmcnt(0)
v_mfma_f32_16x16x32_bf16 v[88:91],a[116:119],v[112:115],v[88:91]
v_mfma_f32_16x16x32_bf16 v[92:95],a[116:119],v[116:119],v[92:95]
v_mfma_f32_16x16x32_bf16 v[96:99],a[124:127],v[112:115],v[96:99]
v_mfma_f32_16x16x32_bf16 v[100:103],a[124:127],v[116:119],v[100:103]
s_nop 3
v_cvt_pk_bf16_f32 v104,v88,v96
v_cvt_pk_bf16_f32 v105,v89,v97
v_cvt_pk_bf16_f32 v106,v90,v98
v_cvt_pk_bf16_f32 v107,v91,v99
v_cvt_pk_bf16_f32 v108,v92,v100
v_cvt_pk_bf16_f32 v109,v93,v101
v_cvt_pk_bf16_f32 v110,v94,v102
v_cvt_pk_bf16_f32 v111,v95,v103
buffer_store_dwordx4 v[104:107],v0,s[8:11],s63 offen sc1
buffer_store_dwordx4 v[108:111],v0,s[8:11],s64 offen sc1
s_waitcnt vmcnt(7)
s_barrier
s_lshl_b32 s70,s51,13
s_lshl2_add_u32 s70,s47,s70
s_add_u32 s70,s70,10485760
s_cmp_ge_u32 s51,2
s_cbranch_scc1 L_p_24
s_waitcnt vmcnt(0)
s_barrier
s_or_b32 s70,s70,s52
buffer_store_dword v17,off,s[8:11],s70 sc1
L_p_24:
s_cmp_eq_u32 s76,2
s_cbranch_scc1 L_p_22
s_mov_b32 s53,0
s_mov_b32 s51,s54
s_add_u32 s54,s54,2
s_cmp_eq_u32 s76,1
s_cbranch_scc1 L_p_23
s_cmp_lg_u32 s77,0
s_waitcnt vmcnt(3)
s_cbranch_scc1 L_p_26
s_waitcnt vmcnt(2)
L_p_26:
v_cmp_eq_u32 vcc,0,v76
s_nop 1
v_mov_b32 v76,vcc_lo
ds_write_b32 v19,v76
s_lshl_b32 s66,s51,15
s_add_u32 s66,s66,2097152
s_add_u32 s67,s66,16384
s_waitcnt lgkmcnt(0)
s_barrier
ds_read_b32 v76,v16
s_waitcnt lgkmcnt(0)
v_cmp_eq_u32 vcc,0,v76
s_cbranch_vccnz L_p_27
s_waitcnt vmcnt(0)
s_barrier
s_or_b32 s70,s70,s52
buffer_store_dword v17,off,s[8:11],s70 sc1
s_mov_b32 s70,0x80000000
s_mov_b32 s53,1
s_cmp_ge_u32 s51,64
s_cbranch_scc1 L_p_25
s_lshl_b32 s59,s51,13
s_add_u32 s59,s59,10487552
s_cmp_lg_u32 s46,0
s_cbranch_scc1 L_fd_29
v_and_b32 v124,31,v1
v_lshlrev_b32 v124,2,v124
L_fw_28:
buffer_load_dword v125,v124,s[8:11],s59 offen sc1
s_sub_u32 s49,s49,1
s_cbranch_scc1 L_abort
s_waitcnt vmcnt(0)
v_cmp_eq_u32 vcc,0,v125
s_cbranch_vccnz L_fw_28
L_fd_29:
s_barrier
L_p_27:
s_add_u32 m0,s74,65536
s_nop 0
buffer_load_dwordx4 v20,s[8:11],s66 offen offset:0 sc1 lds
s_add_u32 m0,s74,69632
s_nop 0
buffer_load_dwordx4 v20,s[8:11],s67 offen offset:0 sc1 lds
s_add_u32 m0,s74,73472
s_nop 0
buffer_load_dwordx4 v20,s[8:11],s66 offen offset:256 sc1 lds
s_add_u32 m0,s74,77568
s_nop 0
buffer_load_dwordx4 v20,s[8:11],s67 offen offset:256 sc1 lds
s_add_u32 m0,s74,81408
s_nop 0
buffer_load_dwordx4 v20,s[8:11],s66 offen offset:512 sc1 lds
s_add_u32 m0,s74,85504
s_nop 0
buffer_load_dwordx4 v20,s[8:11],s67 offen offset:512 sc1 lds
s_add_u32 m0,s74,89344
s_nop 0
buffer_load_dwordx4 v20,s[8:11],s66 offen offset:768 sc1 lds
s_add_u32 m0,s74,93440
s_nop 0
buffer_load_dwordx4 v20,s[8:11],s67 offen offset:768 sc1 lds
s_lshl_b32 s56,s54,13
s_add_u32 s56,s56,10487552
s_or_b32 s56,s56,s52
buffer_load_dword v76,v23,s[8:11],s56 offen sc1
s_waitcnt vmcnt(7)
s_barrier
ds_read_b128 v[104:107],v4 offset:0
ds_read_b128 v[108:111],v4 offset:4096
ds_read_b128 v[112:115],v5 offset:0
ds_read_b128 v[116:119],v5 offset:4096
s_waitcnt lgkmcnt(2)
v_mfma_f32_16x16x32_bf16 v[24:27],a[128:131],v[104:107],0
ds_read_b128 v[120:123],v6 offset:0
v_mfma_f32_16x16x32_bf16 v[40:43],v[104:107],v[128:131],0
s_lshl_b32 s58,s51,5
v_mfma_f32_16x16x32_bf16 v[28:31],a[128:131],v[108:111],0
ds_read_b128 v[124:127],v6 offset:4096
v_mfma_f32_16x16x32_bf16 v[44:47],v[108:111],v[128:131],0
s_add_u32 s58,s58,s47
v_mfma_f32_16x16x32_bf16 v[32:35],a[136:139],v[104:107],0
s_mul_i32 s58,s58,24576
v_mfma_f32_16x16x32_bf16 v[48:51],v[104:107],v[136:139],0
s_add_u32 s58,s58,150994944
v_mfma_f32_16x16x32_bf16 v[36:39],a[136:139],v[108:111],0
s_add_u32 s61,s58,s50
v_mfma_f32_16x16x32_bf16 v[52:55],v[108:111],v[136:139],0
s_add_u32 s62,s61,4096
s_waitcnt lgkmcnt(2)
v_mfma_f32_16x16x32_bf16 v[24:27],a[132:135],v[112:115],v[24:27]
ds_read_b128 v[104:107],v7 offset:0
v_mfma_f32_16x16x32_bf16 v[40:43],v[112:115],v[132:135],v[40:43]
s_add_u32 s63,s61,16384
v_mfma_f32_16x16x32_bf16 v[28:31],a[132:135],v[116:119],v[28:31]
ds_read_b128 v[108:111],v7 offset:4096
v_mfma_f32_16x16x32_bf16 v[44:47],v[116:119],v[132:135],v[44:47]
s_add_u32 s64,s61,20480
v_mfma_f32_16x16x32_bf16 v[32:35],a[140:143],v[112:115],v[32:35]
s_add_u32 s65,s61,s50
v_mfma_f32_16x16x32_bf16 v[48:51],v[112:115],v[140:143],v[48:51]
s_add_u32 s65,s65,8192
v_mfma_f32_16x16x32_bf16 v[36:39],a[140:143],v[116:119],v[36:39]
v_mfma_f32_16x16x32_bf16 v[52:55],v[116:119],v[140:143],v[52:55]
s_waitcnt vmcnt(5)
s_barrier
s_waitcnt lgkmcnt(2)
v_mfma_f32_16x16x32_bf16 v[24:27],a[144:147],v[120:123],v[24:27]
ds_read_b128 v[112:115],v4 offset:8192
v_mfma_f32_16x16x32_bf16 v[40:43],v[120:123],v[144:147],v[40:43]
v_mfma_f32_16x16x32_bf16 v[28:31],a[144:147],v[124:127],v[28:31]
ds_read_b128 v[116:119],v4 offset:12288
v_mfma_f32_16x16x32_bf16 v[44:47],v[124:127],v[144:147],v[44:47]
v_mfma_f32_16x16x32_bf16 v[32:35],a[152:155],v[120:123],v[32:35]
v_mfma_f32_16x16x32_bf16 v[48:51],v[120:123],v[152:155],v[48:51]
v_mfma_f32_16x16x32_bf16 v[36:39],a[152:155],v[124:127],v[36:39]
v_mfma_f32_16x16x32_bf16 v[52:55],v[124:127],v[152:155],v[52:55]
s_waitcnt lgkmcnt(2)
v_mfma_f32_16x16x32_bf16 v[24:27],a[148:151],v[104:107],v[24:27]
ds_read_b128 v[120:123],v5 offset:8192
v_mfma_f32_16x16x32_bf16 v[40:43],v[104:107],v[148:151],v[40:43]
v_mfma_f32_16x16x32_bf16 v[28:31],a[148:151],v[108:111],v[28:31]
ds_read_b128 v[124:127],v5 offset:12288
v_mfma_f32_16x16x32_bf16 v[44:47],v[108:111],v[148:151],v[44:47]
v_mfma_f32_16x16x32_bf16 v[32:35],a[156:159],v[104:107],v[32:35]
v_mfma_f32_16x16x32_bf16 v[48:51],v[104:107],v[156:159],v[48:51]
v_mfma_f32_16x16x32_bf16 v[36:39],a[156:159],v[108:111],v[36:39]
v_mfma_f32_16x16x32_bf16 v[52:55],v[108:111],v[156:159],v[52:55]
s_waitcnt lgkmcnt(2)
v_mfma_f32_16x16x32_bf16 v[24:27],a[160:163],v[112:115],v[24:27]
ds_read_b128 v[104:107],v6 offset:8192
v_mfma_f32_16x16x32_bf16 v[40:43],v[112:115],v[160:163],v[40:43]
v_mfma_f32_16x16x32_bf16 v[28:31],a[160:163],v[116:119],v[28:31]
ds_read_b128 v[108:111],v6 offset:12288
v_mfma_f32_16x16x32_bf16 v[44:47],v[116:119],v[160:163],v[44:47]
v_mfma_f32_16x16x32_bf16 v[32:35],a[168:171],v[112:115],v[32:35]
v_mfma_f32_16x16x32_bf16 v[48:51],v[112:115],v[168:171],v[48:51]
v_mfma_f32_16x16x32_bf16 v[36:39],a[168:171],v[116:119],v[36:39]
v_mfma_f32_16x16x32_bf16 v[52:55],v[116:119],v[168:171],v[52:55]
s_waitcnt lgkmcnt(2)
v_mfma_f32_16x16x32_bf16 v[24:27],a[164:167],v[120:123],v[24:27]
ds_read_b128 v[112:115],v7 offset:8192
v_mfma_f32_16x16x32_bf16 v[40:43],v[120:123],v[164:167],v[40:43]
v_mfma_f32_16x16x32_bf16 v[28:31],a[164:167],v[124:127],v[28:31]
ds_read_b128 v[116:119],v7 offset:12288
v_mfma_f32_16x16x32_bf16 v[44:47],v[124:127],v[164:167],v[44:47]
v_mfma_f32_16x16x32_bf16 v[32:35],a[172:175],v[120:123],v[32:35]
v_mfma_f32_16x16x32_bf16 v[48:51],v[120:123],v[172:175],v[48:51]
v_mfma_f32_16x16x32_bf16 v[36:39],a[172:175],v[124:127],v[36:39]
v_mfma_f32_16x16x32_bf16 v[52:55],v[124:127],v[172:175],v[52:55]
s_waitcnt vmcnt(3)
s_barrier
s_waitcnt lgkmcnt(2)
v_mfma_f32_16x16x32_bf16 v[24:27],a[176:179],v[104:107],v[24:27]
ds_read_b128 v[120:123],v4 offset:16384
v_mfma_f32_16x16x32_bf16 v[40:43],v[104:107],v[176:179],v[40:43]
v_mfma_f32_16x16x32_bf16 v[28:31],a[176:179],v[108:111],v[28:31]
ds_read_b128 v[124:127],v4 offset:20480
v_mfma_f32_16x16x32_bf16 v[44:47],v[108:111],v[176:179],v[44:47]
v_mfma_f32_16x16x32_bf16 v[32:35],a[184:187],v[104:107],v[32:35]
v_mfma_f32_16x16x32_bf16 v[48:51],v[104:107],v[184:187],v[48:51]
v_mfma_f32_16x16x32_bf16 v[36:39],a[184:187],v[108:111],v[36:39]
v_mfma_f32_16x16x32_bf16 v[52:55],v[108:111],v[184:187],v[52:55]
s_waitcnt lgkmcnt(2)
v_mfma_f32_16x16x32_bf16 v[24:27],a[180:183],v[112:115],v[24:27]
ds_read_b128 v[104:107],v5 offset:16384
v_mfma_f32_16x16x32_bf16 v[40:43],v[112:115],v[180:183],v[40:43]
v_mfma_f32_16x16x32_bf16 v[28:31],a[180:183],v[116:119],v[28:31]
ds_read_b128 v[108:111],v5 offset:20480
v_mfma_f32_16x16x32_bf16 v[44:47],v[116:119],v[180:183],v[44:47]
v_mfma_f32_16x16x32_bf16 v[32:35],a[188:191],v[112:115],v[32:35]
v_mfma_f32_16x16x32_bf16 v[48:51],v[112:115],v[188:191],v[48:51]
v_mfma_f32_16x16x32_bf16 v[36:39],a[188:191],v[116:119],v[36:39]
v_mfma_f32_16x16x32_bf16 v[52:55],v[116:119],v[188:191],v[52:55]
s_waitcnt lgkmcnt(2)
v_mfma_f32_16x16x32_bf16 v[24:27],a[192:195],v[120:123],v[24:27]
ds_read_b128 v[112:115],v6 offset:16384
v_mfma_f32_16x16x32_bf16 v[40:43],v[120:123],v[192:195],v[40:43]
v_mfma_f32_16x16x32_bf16 v[28:31],a[192:195],v[124:127],v[28:31]
ds_read_b128 v[116:119],v6 offset:20480
v_mfma_f32_16x16x32_bf16 v[44:47],v[124:127],v[192:195],v[44:47]
v_mfma_f32_16x16x32_bf16 v[32:35],a[200:203],v[120:123],v[32:35]
v_mfma_f32_16x16x32_bf16 v[48:51],v[120:123],v[200:203],v[48:51]
v_mfma_f32_16x16x32_bf16 v[36:39],a[200:203],v[124:127],v[36:39]
v_mfma_f32_16x16x32_bf16 v[52:55],v[124:127],v[200:203],v[52:55]
s_waitcnt lgkmcnt(2)
v_mfma_f32_16x16x32_bf16 v[24:27],a[196:199],v[104:107],v[24:27]
ds_read_b128 v[120:123],v7 offset:16384
v_mfma_f32_16x16x32_bf16 v[40:43],v[104:107],v[196:199],v[40:43]
s_waitcnt vmcnt(0)
v_mfma_f32_16x16x32_bf16 v[28:31],a[196:199],v[108:111],v[28:31]
ds_read_b128 v[124:127],v7 offset:20480
v_mfma_f32_16x16x32_bf16 v[44:47],v[108:111],v[196:199],v[44:47]
v_cmp_eq_u32 vcc,0,v76
v_mfma_f32_16x16x32_bf16 v[32:35],a[204:207],v[104:107],v[32:35]
s_nop 0
v_mov_b32 v76,vcc_lo
v_mfma_f32_16x16x32_bf16 v[48:51],v[104:107],v[204:207],v[48:51]
ds_write_b32 v19,v76
v_mfma_f32_16x16x32_bf16 v[36:39],a[204:207],v[108:111],v[36:39]
v_mfma_f32_16x16x32_bf16 v[52:55],v[108:111],v[204:207],v[52:55]
s_waitcnt vmcnt(0) lgkmcnt(0)
s_barrier
s_or_b32 s70,s70,s52
buffer_store_dword v17,off,s[8:11],s70 sc1
ds_read_b32 v76,v16
v_mfma_f32_16x16x32_bf16 v[24:27],a[208:211],v[112:115],v[24:27]
ds_read_b128 v[104:107],v4 offset:24576
v_mfma_f32_16x16x32_bf16 v[40:43],v[112:115],v[208:211],v[40:43]
s_lshl_b32 s56,s51,5
s_add_u32 s56,s56,s47
s_lshl_b32 s56,s56,12
v_mfma_f32_16x16x32_bf16 v[28:31],a[208:211],v[116:119],v[28:31]
ds_read_b128 v[108:111],v4 offset:28672
v_mfma_f32_16x16x32_bf16 v[44:47],v[116:119],v[208:211],v[44:47]
s_add_u32 s56,s56,s50
s_add_u32 s56,s56,58720256
v_mfma_f32_16x16x32_bf16 v[32:35],a[216:219],v[112:115],v[32:35]
v_mov_b64 v[72:73],-1
v_mov_b64 v[74:75],-1
v_mfma_f32_16x16x32_bf16 v[48:51],v[112:115],v[216:219],v[48:51]
buffer_store_dwordx4 v[72:75],v0,s[8:11],s56 offen sc1
v_mfma_f32_16x16x32_bf16 v[36:39],a[216:219],v[116:119],v[36:39]
s_add_u32 s56,s56,16777216
v_mfma_f32_16x16x32_bf16 v[52:55],v[116:119],v[216:219],v[52:55]
buffer_store_dwordx4 v[72:75],v0,s[8:11],s56 offen sc1
s_waitcnt lgkmcnt(2)
v_mfma_f32_16x16x32_bf16 v[24:27],a[212:215],v[120:123],v[24:27]
ds_read_b128 v[112:115],v5 offset:24576
v_mfma_f32_16x16x32_bf16 v[40:43],v[120:123],v[212:215],v[40:43]
v_readfirstlane_b32 s57,v76
v_mfma_f32_16x16x32_bf16 v[28:31],a[212:215],v[124:127],v[28:31]
ds_read_b128 v[116:119],v5 offset:28672
v_mfma_f32_16x16x32_bf16 v[44:47],v[124:127],v[212:215],v[44:47]
s_sub_u32 s59,s55,s54
s_cmp_lt_i32 s59,44
s_cselect_b32 s76,2,0
v_mfma_f32_16x16x32_bf16 v[32:35],a[220:223],v[120:123],v[32:35]
s_cmp_gt_i32 s53,0
s_cselect_b32 s76,s76,0
v_mfma_f32_16x16x32_bf16 v[48:51],v[120:123],v[220:223],v[48:51]
s_cmp_eq_u32 s57,0
s_cselect_b32 s76,1,s76
v_mfma_f32_16x16x32_bf16 v[36:39],a[220:223],v[124:127],v[36:39]
s_cmp_lt_i32 s59,12
s_cselect_b32 s76,2,s76
s_add_u32 s57,s54,64
v_mfma_f32_16x16x32_bf16 v[52:55],v[124:127],v[220:223],v[52:55]
s_cmp_eq_u32 s76,1
s_cselect_b32 s68,s57,s55
s_lshl_b32 s68,s68,15
s_waitcnt lgkmcnt(2)
v_mfma_f32_16x16x32_bf16 v[24:27],a[224:227],v[104:107],v[24:27]
ds_read_b128 v[120:123],v6 offset:24576
v_mfma_f32_16x16x32_bf16 v[40:43],v[104:107],v[224:227],v[40:43]
s_cmp_eq_u32 s76,0
s_cselect_b32 s68,0x80000000,s68
s_add_u32 s69,s68,16384
v_mfma_f32_16x16x32_bf16 v[28:31],a[224:227],v[108:111],v[28:31]
ds_read_b128 v[124:127],v6 offset:28672
v_mfma_f32_16x16x32_bf16 v[44:47],v[108:111],v[224:227],v[44:47]
s_add_u32 m0,s75,65536
v_mfma_f32_16x16x32_bf16 v[32:35],a[232:235],v[104:107],v[32:35]
buffer_load_dwordx4 v20,s[8:11],s68 offen offset:0 sc1 lds
v_mfma_f32_16x16x32_bf16 v[48:51],v[104:107],v[232:235],v[48:51]
s_add_u32 m0,s75,69632
v_mfma_f32_16x16x32_bf16 v[36:39],a[232:235],v[108:111],v[36:39]
buffer_load_dwordx4 v20,s[8:11],s69 offen offset:0 sc1 lds
v_mfma_f32_16x16x32_bf16 v[52:55],v[108:111],v[232:235],v[52:55]
s_add_u32 m0,s75,73472
s_waitcnt lgkmcnt(2)
v_mfma_f32_16x16x32_bf16 v[24:27],a[228:231],v[112:115],v[24:27]
ds_read_b128 v[104:107],v7 offset:24576
v_mfma_f32_16x16x32_bf16 v[40:43],v[112:115],v[228:231],v[40:43]
buffer_load_dwordx4 v20,s[8:11],s68 offen offset:256 sc1 lds
v_mfma_f32_16x16x32_bf16 v[28:31],a[228:231],v[116:119],v[28:31]
ds_read_b128 v[108:111],v7 offset:28672
v_mfma_f32_16x16x32_bf16 v[44:47],v[116:119],v[228:231],v[44:47]
s_add_u32 m0,s75,77568
v_mfma_f32_16x16x32_bf16 v[32:35],a[236:239],v[112:115],v[32:35]
buffer_load_dwordx4 v20,s[8:11],s69 offen offset:256 sc1 lds
v_mfma_f32_16x16x32_bf16 v[48:51],v[112:115],v[236:239],v[48:51]
s_add_u32 m0,s75,81408
v_mfma_f32_16x16x32_bf16 v[36:39],a[236:239],v[116:119],v[36:39]
buffer_load_dwordx4 v20,s[8:11],s68 offen offset:512 sc1 lds
v_mfma_f32_16x16x32_bf16 v[52:55],v[116:119],v[236:239],v[52:55]
s_add_u32 m0,s75,85504
s_waitcnt lgkmcnt(2)
v_mfma_f32_16x16x32_bf16 v[24:27],a[240:243],v[120:123],v[24:27]
ds_read_b128 v[112:115],v4 offset:0
v_mfma_f32_16x16x32_bf16 v[40:43],v[120:123],v[240:243],v[40:43]
buffer_load_dwordx4 v20,s[8:11],s69 offen offset:512 sc1 lds
v_mfma_f32_16x16x32_bf16 v[28:31],a[240:243],v[124:127],v[28:31]
ds_read_b128 v[116:119],v4 offset:4096
v_mfma_f32_16x16x32_bf16 v[44:47],v[124:127],v[240:243],v[44:47]
s_add_u32 m0,s75,89344
v_mfma_f32_16x16x32_bf16 v[32:35],a[248:251],v[120:123],v[32:35]
buffer_load_dwordx4 v20,s[8:11],s68 offen offset:768 sc1 lds
v_mfma_f32_16x16x32_bf16 v[48:51],v[120:123],v[248:251],v[48:51]
s_add_u32 m0,s75,93440
v_mfma_f32_16x16x32_bf16 v[36:39],a[248:251],v[124:127],v[36:39]
buffer_load_dwordx4 v20,s[8:11],s69 offen offset:768 sc1 lds
v_mfma_f32_16x16x32_bf16 v[52:55],v[124:127],v[248:251],v[52:55]
s_waitcnt lgkmcnt(2)
v_mfma_f32_16x16x32_bf16 v[24:27],a[244:247],v[104:107],v[24:27]
ds_read_b128 v[120:123],v5 offset:0
v_mfma_f32_16x16x32_bf16 v[40:43],v[104:107],v[244:247],v[40:43]
v_mfma_f32_16x16x32_bf16 v[28:31],a[244:247],v[108:111],v[28:31]
ds_read_b128 v[124:127],v5 offset:4096
v_mfma_f32_16x16x32_bf16 v[44:47],v[108:111],v[244:247],v[44:47]
v_mfma_f32_16x16x32_bf16 v[32:35],a[252:255],v[104:107],v[32:35]
v_mfma_f32_16x16x32_bf16 v[48:51],v[104:107],v[252:255],v[48:51]
v_mfma_f32_16x16x32_bf16 v[36:39],a[252:255],v[108:111],v[36:39]
v_mfma_f32_16x16x32_bf16 v[52:55],v[108:111],v[252:255],v[52:55]
s_waitcnt lgkmcnt(2)
v_mfma_f32_16x16x32_bf16 v[88:91],a[0:3],v[112:115],0
ds_read_b128 v[104:107],v6 offset:0
v_mfma_f32_16x16x32_bf16 v[92:95],a[0:3],v[116:119],0
v_mfma_f32_16x16x32_bf16 v[96:99],a[8:11],v[112:115],0
ds_read_b128 v[108:111],v6 offset:4096
v_cvt_pk_bf16_f32 v56,v24,v32
v_cvt_pk_bf16_f32 v57,v25,v33
v_mfma_f32_16x16x32_bf16 v[100:103],a[8:11],v[116:119],0
v_cvt_pk_bf16_f32 v58,v26,v34
v_cvt_pk_bf16_f32 v59,v27,v35
s_waitcnt lgkmcnt(2)
v_mfma_f32_16x16x32_bf16 v[88:91],a[4:7],v[120:123],v[88:91]
ds_read_b128 v[112:115],v7 offset:0
v_mfma_f32_16x16x32_bf16 v[92:95],a[4:7],v[124:127],v[92:95]
buffer_store_dwordx4 v[56:59],v0,s[8:11],s61 offen sc1
v_cvt_pk_bf16_f32 v60,v28,v36
v_cvt_pk_bf16_f32 v61,v29,v37
v_mfma_f32_16x16x32_bf16 v[96:99],a[12:15],v[120:123],v[96:99]
ds_read_b128 v[116:119],v7 offset:4096
v_cvt_pk_bf16_f32 v62,v30,v38
v_cvt_pk_bf16_f32 v63,v31,v39
v_mfma_f32_16x16x32_bf16 v[100:103],a[12:15],v[124:127],v[100:103]
buffer_store_dwordx4 v[60:63],v0,s[8:11],s62 offen sc1
v_cvt_pk_bf16_f32 v64,v40,v41
v_cvt_pk_bf16_f32 v65,v42,v43
s_waitcnt lgkmcnt(2)
v_mfma_f32_16x16x32_bf16 v[88:91],a[16:19],v[104:107],v[88:91]
ds_read_b128 v[120:123],v4 offset:8192
v_cvt_pk_bf16_f32 v66,v44,v45
v_cvt_pk_bf16_f32 v67,v46,v47
v_mfma_f32_16x16x32_bf16 v[92:95],a[16:19],v[108:111],v[92:95]
buffer_store_dwordx4 v[64:67],v0,s[8:11],s65 offen offset:0 sc1
v_cvt_pk_bf16_f32 v68,v48,v49
v_cvt_pk_bf16_f32 v69,v50,v51
v_mfma_f32_16x16x32_bf16 v[96:99],a[24:27],v[104:107],v[96:99]
ds_read_b128 v[124:127],v4 offset:12288
v_cvt_pk_bf16_f32 v70,v52,v53
v_cvt_pk_bf16_f32 v71,v54,v55
v_mfma_f32_16x16x32_bf16 v[100:103],a[24:27],v[108:111],v[100:103]
buffer_store_dwordx4 v[68:71],v0,s[8:11],s65 offen offset:1024 sc1
s_waitcnt lgkmcnt(2)
v_mfma_f32_16x16x32_bf16 v[88:91],a[20:23],v[112:115],v[88:91]
ds_read_b128 v[104:107],v5 offset:8192
v_mfma_f32_16x16x32_bf16 v[92:95],a[20:23],v[116:119],v[92:95]
v_mfma_f32_16x16x32_bf16 v[96:99],a[28:31],v[112:115],v[96:99]
ds_read_b128 v[108:111],v5 offset:12288
v_mfma_f32_16x16x32_bf16 v[100:103],a[28:31],v[116:119],v[100:103]
s_waitcnt lgkmcnt(2)
v_mfma_f32_16x16x32_bf16 v[88:91],a[32:35],v[120:123],v[88:91]
ds_read_b128 v[112:115],v6 offset:8192
v_mfma_f32_16x16x32_bf16 v[92:95],a[32:35],v[124:127],v[92:95]
v_mfma_f32_16x16x32_bf16 v[96:99],a[40:43],v[120:123],v[96:99]
ds_read_b128 v[116:119],v6 offset:12288
v_mfma_f32_16x16x32_bf16 v[100:103],a[40:43],v[124:127],v[100:103]
s_waitcnt lgkmcnt(2)
v_mfma_f32_16x16x32_bf16 v[88:91],a[36:39],v[104:107],v[88:91]
ds_read_b128 v[120:123],v7 offset:8192
v_mfma_f32_16x16x32_bf16 v[92:95],a[36:39],v[108:111],v[92:95]
v_mfma_f32_16x16x32_bf16 v[96:99],a[44:47],v[104:107],v[96:99]
ds_read_b128 v[124:127],v7 offset:12288
v_mfma_f32_16x16x32_bf16 v[100:103],a[44:47],v[108:111],v[100:103]
s_waitcnt lgkmcnt(2)
v_mfma_f32_16x16x32_bf16 v[88:91],a[48:51],v[112:115],v[88:91]
ds_read_b128 v[104:107],v4 offset:16384
v_mfma_f32_16x16x32_bf16 v[92:95],a[48:51],v[116:119],v[92:95]
s_lshl_b32 s56,s54,13
v_mfma_f32_16x16x32_bf16 v[96:99],a[56:59],v[112:115],v[96:99]
ds_read_b128 v[108:111],v4 offset:20480
v_mfma_f32_16x16x32_bf16 v[100:103],a[56:59],v[116:119],v[100:103]
s_add_u32 s56,s56,10487552
s_waitcnt lgkmcnt(2)
v_mfma_f32_16x16x32_bf16 v[88:91],a[52:55],v[120:123],v[88:91]
ds_read_b128 v[112:115],v5 offset:16384
v_mfma_f32_16x16x32_bf16 v[92:95],a[52:55],v[124:127],v[92:95]
s_or_b32 s56,s56,s52
v_mfma_f32_16x16x32_bf16 v[96:99],a[60:63],v[120:123],v[96:99]
ds_read_b128 v[116:119],v5 offset:20480
v_mfma_f32_16x16x32_bf16 v[100:103],a[60:63],v[124:127],v[100:103]
buffer_load_dword v76,v23,s[8:11],s56 offen sc1
s_waitcnt lgkmcnt(2)
v_mfma_f32_16x16x32_bf16 v[88:91],a[64:67],v[104:107],v[88:91]
ds_read_b128 v[120:123],v6 offset:16384
v_mfma_f32_16x16x32_bf16 v[92:95],a[64:67],v[108:111],v[92:95]
v_mfma_f32_16x16x32_bf16 v[96:99],a[72:75],v[104:107],v[96:99]
ds_read_b128 v[124:127],v6 offset:20480
v_mfma_f32_16x16x32_bf16 v[100:103],a[72:75],v[108:111],v[100:103]
s_waitcnt lgkmcnt(2)
v_mfma_f32_16x16x32_bf16 v[88:91],a[68:71],v[112:115],v[88:91]
ds_read_b128 v[104:107],v7 offset:16384
v_mfma_f32_16x16x32_bf16 v[92:95],a[68:71],v[116:119],v[92:95]
v_mfma_f32_16x16x32_bf16 v[96:99],a[76:79],v[112:115],v[96:99]
ds_read_b128 v[108:111],v7 offset:20480
v_mfma_f32_16x16x32_bf16 v[100:103],a[76:79],v[116:119],v[100:103]
s_waitcnt lgkmcnt(2)
v_mfma_f32_16x16x32_bf16 v[88:91],a[80:83],v[120:123],v[88:91]
ds_read_b128 v[112:115],v4 offset:24576
v_mfma_f32_16x16x32_bf16 v[92:95],a[80:83],v[124:127],v[92:95]
v_mfma_f32_16x16x32_bf16 v[96:99],a[88:91],v[120:123],v[96:99]
ds_read_b128 v[116:119],v4 offset:28672
v_mfma_f32_16x16x32_bf16 v[100:103],a[88:91],v[124:127],v[100:103]
s_waitcnt lgkmcnt(2)
v_mfma_f32_16x16x32_bf16 v[88:91],a[84:87],v[104:107],v[88:91]
ds_read_b128 v[120:123],v5 offset:24576
v_mfma_f32_16x16x32_bf16 v[92:95],a[84:87],v[108:111],v[92:95]
v_mfma_f32_16x16x32_bf16 v[96:99],a[92:95],v[104:107],v[96:99]
ds_read_b128 v[124:127],v5 offset:28672
v_mfma_f32_16x16x32_bf16 v[100:103],a[92:95],v[108:111],v[100:103]
s_waitcnt lgkmcnt(2)
v_mfma_f32_16x16x32_bf16 v[88:91],a[96:99],v[112:115],v[88:91]
ds_read_b128 v[104:107],v6 offset:24576
v_mfma_f32_16x16x32_bf16 v[92:95],a[96:99],v[116:119],v[92:95]
v_mfma_f32_16x16x32_bf16 v[96:99],a[104:107],v[112:115],v[96:99]
ds_read_b128 v[108:111],v6 offset:28672
v_mfma_f32_16x16x32_bf16 v[100:103],a[104:107],v[116:119],v[100:103]
s_waitcnt lgkmcnt(2)
v_mfma_f32_16x16x32_bf16 v[88:91],a[100:103],v[120:123],v[88:91]
ds_read_b128 v[112:115],v7 offset:24576
v_mfma_f32_16x16x32_bf16 v[92:95],a[100:103],v[124:127],v[92:95]
v_mfma_f32_16x16x32_bf16 v[96:99],a[108:111],v[120:123],v[96:99]
ds_read_b128 v[116:119],v7 offset:28672
v_mfma_f32_16x16x32_bf16 v[100:103],a[108:111],v[124:127],v[100:103]
s_waitcnt lgkmcnt(2)
v_mfma_f32_16x16x32_bf16 v[88:91],a[112:115],v[104:107],v[88:91]
v_mfma_f32_16x16x32_bf16 v[92:95],a[112:115],v[108:111],v[92:95]
v_mfma_f32_16x16x32_bf16 v[96:99],a[120:123],v[104:107],v[96:99]
v_mfma_f32_16x16x32_bf16 v[100:103],a[120:123],v[108:111],v[100:103]
s_waitcnt lgkmcnt(0)
v_mfma_f32_16x16x32_bf16 v[88:91],a[116:119],v[112:115],v[88:91]
v_mfma_f32_16x16x32_bf16 v[92:95],a[116:119],v[116:119],v[92:95]
v_mfma_f32_16x16x32_bf16 v[96:99],a[124:127],v[112:115],v[96:99]
v_mfma_f32_16x16x32_bf16 v[100:103],a[124:127],v[116:119],v[100:103]
s_nop 3
v_cvt_pk_bf16_f32 v104,v88,v96
v_cvt_pk_bf16_f32 v105,v89,v97
v_cvt_pk_bf16_f32 v106,v90,v98
v_cvt_pk_bf16_f32 v107,v91,v99
v_cvt_pk_bf16_f32 v108,v92,v100
v_cvt_pk_bf16_f32 v109,v93,v101
v_cvt_pk_bf16_f32 v110,v94,v102
v_cvt_pk_bf16_f32 v111,v95,v103
buffer_store_dwordx4 v[104:107],v0,s[8:11],s63 offen sc1
buffer_store_dwordx4 v[108:111],v0,s[8:11],s64 offen sc1
s_lshl_b32 s59,s51,13
s_lshl2_add_u32 s59,s47,s59
s_add_u32 s59,s59,10485888
s_waitcnt vmcnt(3)
s_barrier
s_or_b32 s59,s59,s52
buffer_store_dword v17,off,s[8:11],s59 sc1
s_mov_b32 s77,1
s_lshl_b32 s70,s51,13
s_lshl2_add_u32 s70,s47,s70
s_add_u32 s70,s70,10486144
s_branch L_p_24
L_p_23:
s_mov_b32 s75,s74
s_xor_b32 s74,s74,32768
v_xor_b32 v4,32768,v4
v_xor_b32 v5,32768,v5
v_xor_b32 v6,32768,v6
v_xor_b32 v7,32768,v7
ds_read_b128 v[104:107],v4 offset:0
ds_read_b128 v[108:111],v4 offset:4096
ds_read_b128 v[112:115],v5 offset:0
ds_read_b128 v[116:119],v5 offset:4096
s_waitcnt lgkmcnt(2)
v_mfma_f32_16x16x32_bf16 v[24:27],a[128:131],v[104:107],0
ds_read_b128 v[120:123],v6 offset:0
v_mfma_f32_16x16x32_bf16 v[40:43],v[104:107],v[128:131],0
s_lshl_b32 s58,s51,5
v_mfma_f32_16x16x32_bf16 v[28:31],a[128:131],v[108:111],0
ds_read_b128 v[124:127],v6 offset:4096
v_mfma_f32_16x16x32_bf16 v[44:47],v[108:111],v[128:131],0
s_add_u32 s58,s58,s47
v_mfma_f32_16x16x32_bf16 v[32:35],a[136:139],v[104:107],0
s_mul_i32 s58,s58,24576
v_mfma_f32_16x16x32_bf16 v[48:51],v[104:107],v[136:139],0
s_add_u32 s58,s58,150994944
v_mfma_f32_16x16x32_bf16 v[36:39],a[136:139],v[108:111],0
s_add_u32 s61,s58,s50
v_mfma_f32_16x16x32_bf16 v[52:55],v[108:111],v[136:139],0
s_add_u32 s62,s61,4096
s_waitcnt lgkmcnt(2)
v_mfma_f32_16x16x32_bf16 v[24:27],a[132:135],v[112:115],v[24:27]
ds_read_b128 v[104:107],v7 offset:0
v_mfma_f32_16x16x32_bf16 v[40:43],v[112:115],v[132:135],v[40:43]
s_add_u32 s63,s61,16384
v_mfma_f32_16x16x32_bf16 v[28:31],a[132:135],v[116:119],v[28:31]
ds_read_b128 v[108:111],v7 offset:4096
v_mfma_f32_16x16x32_bf16 v[44:47],v[116:119],v[132:135],v[44:47]
s_add_u32 s64,s61,20480
v_mfma_f32_16x16x32_bf16 v[32:35],a[140:143],v[112:115],v[32:35]
s_add_u32 s65,s61,s50
v_mfma_f32_16x16x32_bf16 v[48:51],v[112:115],v[140:143],v[48:51]
s_add_u32 s65,s65,8192
v_mfma_f32_16x16x32_bf16 v[36:39],a[140:143],v[116:119],v[36:39]
v_mfma_f32_16x16x32_bf16 v[52:55],v[116:119],v[140:143],v[52:55]
s_waitcnt lgkmcnt(2)
v_mfma_f32_16x16x32_bf16 v[24:27],a[144:147],v[120:123],v[24:27]
ds_read_b128 v[112:115],v4 offset:8192
v_mfma_f32_16x16x32_bf16 v[40:43],v[120:123],v[144:147],v[40:43]
v_mfma_f32_16x16x32_bf16 v[28:31],a[144:147],v[124:127],v[28:31]
ds_read_b128 v[116:119],v4 offset:12288
v_mfma_f32_16x16x32_bf16 v[44:47],v[124:127],v[144:147],v[44:47]
v_mfma_f32_16x16x32_bf16 v[32:35],a[152:155],v[120:123],v[32:35]
v_mfma_f32_16x16x32_bf16 v[48:51],v[120:123],v[152:155],v[48:51]
v_mfma_f32_16x16x32_bf16 v[36:39],a[152:155],v[124:127],v[36:39]
v_mfma_f32_16x16x32_bf16 v[52:55],v[124:127],v[152:155],v[52:55]
s_waitcnt lgkmcnt(2)
v_mfma_f32_16x16x32_bf16 v[24:27],a[148:151],v[104:107],v[24:27]
ds_read_b128 v[120:123],v5 offset:8192
v_mfma_f32_16x16x32_bf16 v[40:43],v[104:107],v[148:151],v[40:43]
v_mfma_f32_16x16x32_bf16 v[28:31],a[148:151],v[108:111],v[28:31]
ds_read_b128 v[124:127],v5 offset:12288
v_mfma_f32_16x16x32_bf16 v[44:47],v[108:111],v[148:151],v[44:47]
v_mfma_f32_16x16x32_bf16 v[32:35],a[156:159],v[104:107],v[32:35]
v_mfma_f32_16x16x32_bf16 v[48:51],v[104:107],v[156:159],v[48:51]
v_mfma_f32_16x16x32_bf16 v[36:39],a[156:159],v[108:111],v[36:39]
v_mfma_f32_16x16x32_bf16 v[52:55],v[108:111],v[156:159],v[52:55]
s_waitcnt lgkmcnt(2)
v_mfma_f32_16x16x32_bf16 v[24:27],a[160:163],v[112:115],v[24:27]
ds_read_b128 v[104:107],v6 offset:8192
v_mfma_f32_16x16x32_bf16 v[40:43],v[112:115],v[160:163],v[40:43]
s_lshl_b32 s56,s54,13
v_mfma_f32_16x16x32_bf16 v[28:31],a[160:163],v[116:119],v[28:31]
ds_read_b128 v[108:111],v6 offset:12288
v_mfma_f32_16x16x32_bf16 v[44:47],v[116:119],v[160:163],v[44:47]
s_add_u32 s56,s56,10487552
v_mfma_f32_16x16x32_bf16 v[32:35],a[168:171],v[112:115],v[32:35]
s_or_b32 s56,s56,s52
v_mfma_f32_16x16x32_bf16 v[48:51],v[112:115],v[168:171],v[48:51]
buffer_load_dword v76,v23,s[8:11],s56 offen sc1
v_mfma_f32_16x16x32_bf16 v[36:39],a[168:171],v[116:119],v[36:39]
v_mfma_f32_16x16x32_bf16 v[52:55],v[116:119],v[168:171],v[52:55]
s_waitcnt lgkmcnt(2)
v_mfma_f32_16x16x32_bf16 v[24:27],a[164:167],v[120:123],v[24:27]
ds_read_b128 v[112:115],v7 offset:8192
v_mfma_f32_16x16x32_bf16 v[40:43],v[120:123],v[164:167],v[40:43]
v_mfma_f32_16x16x32_bf16 v[28:31],a[164:167],v[124:127],v[28:31]
ds_read_b128 v[116:119],v7 offset:12288
v_mfma_f32_16x16x32_bf16 v[44:47],v[124:127],v[164:167],v[44:47]
v_mfma_f32_16x16x32_bf16 v[32:35],a[172:175],v[120:123],v[32:35]
v_mfma_f32_16x16x32_bf16 v[48:51],v[120:123],v[172:175],v[48:51]
v_mfma_f32_16x16x32_bf16 v[36:39],a[172:175],v[124:127],v[36:39]
v_mfma_f32_16x16x32_bf16 v[52:55],v[124:127],v[172:175],v[52:55]
s_waitcnt lgkmcnt(2)
v_mfma_f32_16x16x32_bf16 v[24:27],a[176:179],v[104:107],v[24:27]
ds_read_b128 v[120:123],v4 offset:16384
v_mfma_f32_16x16x32_bf16 v[40:43],v[104:107],v[176:179],v[40:43]
v_mfma_f32_16x16x32_bf16 v[28:31],a[176:179],v[108:111],v[28:31]
ds_read_b128 v[124:127],v4 offset:20480
v_mfma_f32_16x16x32_bf16 v[44:47],v[108:111],v[176:179],v[44:47]
v_mfma_f32_16x16x32_bf16 v[32:35],a[184:187],v[104:107],v[32:35]
v_mfma_f32_16x16x32_bf16 v[48:51],v[104:107],v[184:187],v[48:51]
v_mfma_f32_16x16x32_bf16 v[36:39],a[184:187],v[108:111],v[36:39]
v_mfma_f32_16x16x32_bf16 v[52:55],v[108:111],v[184:187],v[52:55]
s_waitcnt lgkmcnt(2)
v_mfma_f32_16x16x32_bf16 v[24:27],a[180:183],v[112:115],v[24:27]
ds_read_b128 v[104:107],v5 offset:16384
v_mfma_f32_16x16x32_bf16 v[40:43],v[112:115],v[180:183],v[40:43]
v_mfma_f32_16x16x32_bf16 v[28:31],a[180:183],v[116:119],v[28:31]
ds_read_b128 v[108:111],v5 offset:20480
v_mfma_f32_16x16x32_bf16 v[44:47],v[116:119],v[180:183],v[44:47]
v_mfma_f32_16x16x32_bf16 v[32:35],a[188:191],v[112:115],v[32:35]
v_mfma_f32_16x16x32_bf16 v[48:51],v[112:115],v[188:191],v[48:51]
v_mfma_f32_16x16x32_bf16 v[36:39],a[188:191],v[116:119],v[36:39]
v_mfma_f32_16x16x32_bf16 v[52:55],v[116:119],v[188:191],v[52:55]
s_waitcnt lgkmcnt(2)
v_mfma_f32_16x16x32_bf16 v[24:27],a[192:195],v[120:123],v[24:27]
ds_read_b128 v[112:115],v6 offset:16384
v_mfma_f32_16x16x32_bf16 v[40:43],v[120:123],v[192:195],v[40:43]
v_mfma_f32_16x16x32_bf16 v[28:31],a[192:195],v[124:127],v[28:31]
ds_read_b128 v[116:119],v6 offset:20480
v_mfma_f32_16x16x32_bf16 v[44:47],v[124:127],v[192:195],v[44:47]
v_mfma_f32_16x16x32_bf16 v[32:35],a[200:203],v[120:123],v[32:35]
v_mfma_f32_16x16x32_bf16 v[48:51],v[120:123],v[200:203],v[48:51]
v_mfma_f32_16x16x32_bf16 v[36:39],a[200:203],v[124:127],v[36:39]
v_mfma_f32_16x16x32_bf16 v[52:55],v[124:127],v[200:203],v[52:55]
s_waitcnt lgkmcnt(2)
v_mfma_f32_16x16x32_bf16 v[24:27],a[196:199],v[104:107],v[24:27]
ds_read_b128 v[120:123],v7 offset:16384
v_mfma_f32_16x16x32_bf16 v[40:43],v[104:107],v[196:199],v[40:43]
s_waitcnt vmcnt(0)
v_mfma_f32_16x16x32_bf16 v[28:31],a[196:199],v[108:111],v[28:31]
ds_read_b128 v[124:127],v7 offset:20480
v_mfma_f32_16x16x32_bf16 v[44:47],v[108:111],v[196:199],v[44:47]
v_cmp_eq_u32 vcc,0,v76
v_mfma_f32_16x16x32_bf16 v[32:35],a[204:207],v[104:107],v[32:35]
s_nop 0
v_mov_b32 v76,vcc_lo
v_mfma_f32_16x16x32_bf16 v[48:51],v[104:107],v[204:207],v[48:51]
ds_write_b32 v19,v76
v_mfma_f32_16x16x32_bf16 v[36:39],a[204:207],v[108:111],v[36:39]
v_mfma_f32_16x16x32_bf16 v[52:55],v[108:111],v[204:207],v[52:55]
s_waitcnt vmcnt(0) lgkmcnt(0)
s_barrier
s_or_b32 s70,s70,s52
buffer_store_dword v17,off,s[8:11],s70 sc1
ds_read_b32 v76,v16
v_mfma_f32_16x16x32_bf16 v[24:27],a[208:211],v[112:115],v[24:27]
ds_read_b128 v[104:107],v4 offset:24576
v_mfma_f32_16x16x32_bf16 v[40:43],v[112:115],v[208:211],v[40:43]
s_lshl_b32 s56,s51,5
s_add_u32 s56,s56,s47
s_lshl_b32 s56,s56,12
v_mfma_f32_16x16x32_bf16 v[28:31],a[208:211],v[116:119],v[28:31]
ds_read_b128 v[108:111],v4 offset:28672
v_mfma_f32_16x16x32_bf16 v[44:47],v[116:119],v[208:211],v[44:47]
s_add_u32 s56,s56,s50
s_add_u32 s56,s56,58720256
v_mfma_f32_16x16x32_bf16 v[32:35],a[216:219],v[112:115],v[32:35]
v_mov_b64 v[72:73],-1
v_mov_b64 v[74:75],-1
v_mfma_f32_16x16x32_bf16 v[48:51],v[112:115],v[216:219],v[48:51]
buffer_store_dwordx4 v[72:75],v0,s[8:11],s56 offen sc1
v_mfma_f32_16x16x32_bf16 v[36:39],a[216:219],v[116:119],v[36:39]
s_add_u32 s56,s56,16777216
v_mfma_f32_16x16x32_bf16 v[52:55],v[116:119],v[216:219],v[52:55]
buffer_store_dwordx4 v[72:75],v0,s[8:11],s56 offen sc1
s_waitcnt lgkmcnt(2)
v_mfma_f32_16x16x32_bf16 v[24:27],a[212:215],v[120:123],v[24:27]
ds_read_b128 v[112:115],v5 offset:24576
v_mfma_f32_16x16x32_bf16 v[40:43],v[120:123],v[212:215],v[40:43]
v_readfirstlane_b32 s57,v76
v_mfma_f32_16x16x32_bf16 v[28:31],a[212:215],v[124:127],v[28:31]
ds_read_b128 v[116:119],v5 offset:28672
v_mfma_f32_16x16x32_bf16 v[44:47],v[124:127],v[212:215],v[44:47]
s_sub_u32 s59,s55,s54
s_cmp_lt_i32 s59,44
s_cselect_b32 s76,2,0
v_mfma_f32_16x16x32_bf16 v[32:35],a[220:223],v[120:123],v[32:35]
s_cmp_gt_i32 s53,0
s_cselect_b32 s76,s76,0
v_mfma_f32_16x16x32_bf16 v[48:51],v[120:123],v[220:223],v[48:51]
s_cmp_eq_u32 s57,0
s_cselect_b32 s76,1,s76
v_mfma_f32_16x16x32_bf16 v[36:39],a[220:223],v[124:127],v[36:39]
s_cmp_lt_i32 s59,12
s_cselect_b32 s76,2,s76
s_add_u32 s57,s54,64
v_mfma_f32_16x16x32_bf16 v[52:55],v[124:127],v[220:223],v[52:55]
s_cmp_eq_u32 s76,1
s_cselect_b32 s68,s57,s55
s_lshl_b32 s68,s68,15
s_waitcnt lgkmcnt(2)
v_mfma_f32_16x16x32_bf16 v[24:27],a[224:227],v[104:107],v[24:27]
ds_read_b128 v[120:123],v6 offset:24576
v_mfma_f32_16x16x32_bf16 v[40:43],v[104:107],v[224:227],v[40:43]
s_cmp_eq_u32 s76,0
s_cselect_b32 s68,0x80000000,s68
s_add_u32 s69,s68,16384
v_mfma_f32_16x16x32_bf16 v[28:31],a[224:227],v[108:111],v[28:31]
ds_read_b128 v[124:127],v6 offset:28672
v_mfma_f32_16x16x32_bf16 v[44:47],v[108:111],v[224:227],v[44:47]
s_add_u32 m0,s75,65536
v_mfma_f32_16x16x32_bf16 v[32:35],a[232:235],v[104:107],v[32:35]
buffer_load_dwordx4 v20,s[8:11],s68 offen offset:0 sc1 lds
v_mfma_f32_16x16x32_bf16 v[48:51],v[104:107],v[232:235],v[48:51]
s_add_u32 m0,s75,69632
v_mfma_f32_16x16x32_bf16 v[36:39],a[232:235],v[108:111],v[36:39]
buffer_load_dwordx4 v20,s[8:11],s69 offen offset:0 sc1 lds
v_mfma_f32_16x16x32_bf16 v[52:55],v[108:111],v[232:235],v[52:55]
s_add_u32 m0,s75,73472
s_waitcnt lgkmcnt(2)
v_mfma_f32_16x16x32_bf16 v[24:27],a[228:231],v[112:115],v[24:27]
ds_read_b128 v[104:107],v7 offset:24576
v_mfma_f32_16x16x32_bf16 v[40:43],v[112:115],v[228:231],v[40:43]
buffer_load_dwordx4 v20,s[8:11],s68 offen offset:256 sc1 lds
v_mfma_f32_16x16x32_bf16 v[28:31],a[228:231],v[116:119],v[28:31]
ds_read_b128 v[108:111],v7 offset:28672
v_mfma_f32_16x16x32_bf16 v[44:47],v[116:119],v[228:231],v[44:47]
s_add_u32 m0,s75,77568
v_mfma_f32_16x16x32_bf16 v[32:35],a[236:239],v[112:115],v[32:35]
buffer_load_dwordx4 v20,s[8:11],s69 offen offset:256 sc1 lds
v_mfma_f32_16x16x32_bf16 v[48:51],v[112:115],v[236:239],v[48:51]
s_add_u32 m0,s75,81408
v_mfma_f32_16x16x32_bf16 v[36:39],a[236:239],v[116:119],v[36:39]
buffer_load_dwordx4 v20,s[8:11],s68 offen offset:512 sc1 lds
v_mfma_f32_16x16x32_bf16 v[52:55],v[116:119],v[236:239],v[52:55]
s_add_u32 m0,s75,85504
s_waitcnt lgkmcnt(2)
v_mfma_f32_16x16x32_bf16 v[24:27],a[240:243],v[120:123],v[24:27]
ds_read_b128 v[112:115],v4 offset:0
v_mfma_f32_16x16x32_bf16 v[40:43],v[120:123],v[240:243],v[40:43]
buffer_load_dwordx4 v20,s[8:11],s69 offen offset:512 sc1 lds
v_mfma_f32_16x16x32_bf16 v[28:31],a[240:243],v[124:127],v[28:31]
ds_read_b128 v[116:119],v4 offset:4096
v_mfma_f32_16x16x32_bf16 v[44:47],v[124:127],v[240:243],v[44:47]
s_add_u32 m0,s75,89344
v_mfma_f32_16x16x32_bf16 v[32:35],a[248:251],v[120:123],v[32:35]
buffer_load_dwordx4 v20,s[8:11],s68 offen offset:768 sc1 lds
v_mfma_f32_16x16x32_bf16 v[48:51],v[120:123],v[248:251],v[48:51]
s_add_u32 m0,s75,93440
v_mfma_f32_16x16x32_bf16 v[36:39],a[248:251],v[124:127],v[36:39]
buffer_load_dwordx4 v20,s[8:11],s69 offen offset:768 sc1 lds
v_mfma_f32_16x16x32_bf16 v[52:55],v[124:127],v[248:251],v[52:55]
s_waitcnt lgkmcnt(2)
v_mfma_f32_16x16x32_bf16 v[24:27],a[244:247],v[104:107],v[24:27]
ds_read_b128 v[120:123],v5 offset:0
v_mfma_f32_16x16x32_bf16 v[40:43],v[104:107],v[244:247],v[40:43]
v_mfma_f32_16x16x32_bf16 v[28:31],a[244:247],v[108:111],v[28:31]
ds_read_b128 v[124:127],v5 offset:4096
v_mfma_f32_16x16x32_bf16 v[44:47],v[108:111],v[244:247],v[44:47]
v_mfma_f32_16x16x32_bf16 v[32:35],a[252:255],v[104:107],v[32:35]
v_mfma_f32_16x16x32_bf16 v[48:51],v[104:107],v[252:255],v[48:51]
v_mfma_f32_16x16x32_bf16 v[36:39],a[252:255],v[108:111],v[36:39]
v_mfma_f32_16x16x32_bf16 v[52:55],v[108:111],v[252:255],v[52:55]
s_waitcnt lgkmcnt(2)
v_mfma_f32_16x16x32_bf16 v[88:91],a[0:3],v[112:115],0
ds_read_b128 v[104:107],v6 offset:0
v_mfma_f32_16x16x32_bf16 v[92:95],a[0:3],v[116:119],0
v_mfma_f32_16x16x32_bf16 v[96:99],a[8:11],v[112:115],0
ds_read_b128 v[108:111],v6 offset:4096
v_cvt_pk_bf16_f32 v56,v24,v32
v_cvt_pk_bf16_f32 v57,v25,v33
v_mfma_f32_16x16x32_bf16 v[100:103],a[8:11],v[116:119],0
v_cvt_pk_bf16_f32 v58,v26,v34
v_cvt_pk_bf16_f32 v59,v27,v35
s_waitcnt lgkmcnt(2)
v_mfma_f32_16x16x32_bf16 v[88:91],a[4:7],v[120:123],v[88:91]
ds_read_b128 v[112:115],v7 offset:0
v_mfma_f32_16x16x32_bf16 v[92:95],a[4:7],v[124:127],v[92:95]
buffer_store_dwordx4 v[56:59],v0,s[8:11],s61 offen sc1
v_cvt_pk_bf16_f32 v60,v28,v36
v_cvt_pk_bf16_f32 v61,v29,v37
v_mfma_f32_16x16x32_bf16 v[96:99],a[12:15],v[120:123],v[96:99]
ds_read_b128 v[116:119],v7 offset:4096
v_cvt_pk_bf16_f32 v62,v30,v38
v_cvt_pk_bf16_f32 v63,v31,v39
v_mfma_f32_16x16x32_bf16 v[100:103],a[12:15],v[124:127],v[100:103]
buffer_store_dwordx4 v[60:63],v0,s[8:11],s62 offen sc1
v_cvt_pk_bf16_f32 v64,v40,v41
v_cvt_pk_bf16_f32 v65,v42,v43
s_waitcnt lgkmcnt(2)
v_mfma_f32_16x16x32_bf16 v[88:91],a[16:19],v[104:107],v[88:91]
ds_read_b128 v[120:123],v4 offset:8192
v_cvt_pk_bf16_f32 v66,v44,v45
v_cvt_pk_bf16_f32 v67,v46,v47
v_mfma_f32_16x16x32_bf16 v[92:95],a[16:19],v[108:111],v[92:95]
buffer_store_dwordx4 v[64:67],v0,s[8:11],s65 offen offset:0 sc1
v_cvt_pk_bf16_f32 v68,v48,v49
v_cvt_pk_bf16_f32 v69,v50,v51
v_mfma_f32_16x16x32_bf16 v[96:99],a[24:27],v[104:107],v[96:99]
ds_read_b128 v[124:127],v4 offset:12288
v_cvt_pk_bf16_f32 v70,v52,v53
v_cvt_pk_bf16_f32 v71,v54,v55
v_mfma_f32_16x16x32_bf16 v[100:103],a[24:27],v[108:111],v[100:103]
buffer_store_dwordx4 v[68:71],v0,s[8:11],s65 offen offset:1024 sc1
s_waitcnt lgkmcnt(2)
v_mfma_f32_16x16x32_bf16 v[88:91],a[20:23],v[112:115],v[88:91]
ds_read_b128 v[104:107],v5 offset:8192
v_mfma_f32_16x16x32_bf16 v[92:95],a[20:23],v[116:119],v[92:95]
v_mfma_f32_16x16x32_bf16 v[96:99],a[28:31],v[112:115],v[96:99]
ds_read_b128 v[108:111],v5 offset:12288
v_mfma_f32_16x16x32_bf16 v[100:103],a[28:31],v[116:119],v[100:103]
s_waitcnt lgkmcnt(2)
v_mfma_f32_16x16x32_bf16 v[88:91],a[32:35],v[120:123],v[88:91]
ds_read_b128 v[112:115],v6 offset:8192
v_mfma_f32_16x16x32_bf16 v[92:95],a[32:35],v[124:127],v[92:95]
v_mfma_f32_16x16x32_bf16 v[96:99],a[40:43],v[120:123],v[96:99]
ds_read_b128 v[116:119],v6 offset:12288
v_mfma_f32_16x16x32_bf16 v[100:103],a[40:43],v[124:127],v[100:103]
s_waitcnt lgkmcnt(2)
v_mfma_f32_16x16x32_bf16 v[88:91],a[36:39],v[104:107],v[88:91]
ds_read_b128 v[120:123],v7 offset:8192
v_mfma_f32_16x16x32_bf16 v[92:95],a[36:39],v[108:111],v[92:95]
v_mfma_f32_16x16x32_bf16 v[96:99],a[44:47],v[104:107],v[96:99]
ds_read_b128 v[124:127],v7 offset:12288
v_mfma_f32_16x16x32_bf16 v[100:103],a[44:47],v[108:111],v[100:103]
s_waitcnt lgkmcnt(2)
v_mfma_f32_16x16x32_bf16 v[88:91],a[48:51],v[112:115],v[88:91]
ds_read_b128 v[104:107],v4 offset:16384
v_mfma_f32_16x16x32_bf16 v[92:95],a[48:51],v[116:119],v[92:95]
s_lshl_b32 s56,s54,13
v_mfma_f32_16x16x32_bf16 v[96:99],a[56:59],v[112:115],v[96:99]
ds_read_b128 v[108:111],v4 offset:20480
v_mfma_f32_16x16x32_bf16 v[100:103],a[56:59],v[116:119],v[100:103]
s_add_u32 s56,s56,10487552
s_waitcnt lgkmcnt(2)
v_mfma_f32_16x16x32_bf16 v[88:91],a[52:55],v[120:123],v[88:91]
ds_read_b128 v[112:115],v5 offset:16384
v_mfma_f32_16x16x32_bf16 v[92:95],a[52:55],v[124:127],v[92:95]
s_or_b32 s56,s56,s52
v_mfma_f32_16x16x32_bf16 v[96:99],a[60:63],v[120:123],v[96:99]
ds_read_b128 v[116:119],v5 offset:20480
v_mfma_f32_16x16x32_bf16 v[100:103],a[60:63],v[124:127],v[100:103]
buffer_load_dword v76,v23,s[8:11],s56 offen sc1
s_waitcnt lgkmcnt(2)
v_mfma_f32_16x16x32_bf16 v[88:91],a[64:67],v[104:107],v[88:91]
ds_read_b128 v[120:123],v6 offset:16384
v_mfma_f32_16x16x32_bf16 v[92:95],a[64:67],v[108:111],v[92:95]
v_mfma_f32_16x16x32_bf16 v[96:99],a[72:75],v[104:107],v[96:99]
ds_read_b128 v[124:127],v6 offset:20480
v_mfma_f32_16x16x32_bf16 v[100:103],a[72:75],v[108:111],v[100:103]
s_waitcnt lgkmcnt(2)
v_mfma_f32_16x16x32_bf16 v[88:91],a[68:71],v[112:115],v[88:91]
ds_read_b128 v[104:107],v7 offset:16384
v_mfma_f32_16x16x32_bf16 v[92:95],a[68:71],v[116:119],v[92:95]
v_mfma_f32_16x16x32_bf16 v[96:99],a[76:79],v[112:115],v[96:99]
ds_read_b128 v[108:111],v7 offset:20480
v_mfma_f32_16x16x32_bf16 v[100:103],a[76:79],v[116:119],v[100:103]
s_waitcnt lgkmcnt(2)
v_mfma_f32_16x16x32_bf16 v[88:91],a[80:83],v[120:123],v[88:91]
ds_read_b128 v[112:115],v4 offset:24576
v_mfma_f32_16x16x32_bf16 v[92:95],a[80:83],v[124:127],v[92:95]
v_mfma_f32_16x16x32_bf16 v[96:99],a[88:91],v[120:123],v[96:99]
ds_read_b128 v[116:119],v4 offset:28672
v_mfma_f32_16x16x32_bf16 v[100:103],a[88:91],v[124:127],v[100:103]
s_waitcnt lgkmcnt(2)
v_mfma_f32_16x16x32_bf16 v[88:91],a[84:87],v[104:107],v[88:91]
ds_read_b128 v[120:123],v5 offset:24576
v_mfma_f32_16x16x32_bf16 v[92:95],a[84:87],v[108:111],v[92:95]
v_mfma_f32_16x16x32_bf16 v[96:99],a[92:95],v[104:107],v[96:99]
ds_read_b128 v[124:127],v5 offset:28672
v_mfma_f32_16x16x32_bf16 v[100:103],a[92:95],v[108:111],v[100:103]
s_waitcnt lgkmcnt(2)
v_mfma_f32_16x16x32_bf16 v[88:91],a[96:99],v[112:115],v[88:91]
ds_read_b128 v[104:107],v6 offset:24576
v_mfma_f32_16x16x32_bf16 v[92:95],a[96:99],v[116:119],v[92:95]
v_mfma_f32_16x16x32_bf16 v[96:99],a[104:107],v[112:115],v[96:99]
ds_read_b128 v[108:111],v6 offset:28672
v_mfma_f32_16x16x32_bf16 v[100:103],a[104:107],v[116:119],v[100:103]
s_waitcnt lgkmcnt(2)
v_mfma_f32_16x16x32_bf16 v[88:91],a[100:103],v[120:123],v[88:91]
ds_read_b128 v[112:115],v7 offset:24576
v_mfma_f32_16x16x32_bf16 v[92:95],a[100:103],v[124:127],v[92:95]
v_mfma_f32_16x16x32_bf16 v[96:99],a[108:111],v[120:123],v[96:99]
ds_read_b128 v[116:119],v7 offset:28672
v_mfma_f32_16x16x32_bf16 v[100:103],a[108:111],v[124:127],v[100:103]
s_waitcnt lgkmcnt(2)
v_mfma_f32_16x16x32_bf16 v[88:91],a[112:115],v[104:107],v[88:91]
v_mfma_f32_16x16x32_bf16 v[92:95],a[112:115],v[108:111],v[92:95]
v_mfma_f32_16x16x32_bf16 v[96:99],a[120:123],v[104:107],v[96:99]
v_mfma_f32_16x16x32_bf16 v[100:103],a[120:123],v[108:111],v[100:103]
s_waitcnt lgkmcnt(0)
v_mfma_f32_16x16x32_bf16 v[88:91],a[116:119],v[112:115],v[88:91]
v_mfma_f32_16x16x32_bf16 v[92:95],a[116:119],v[116:119],v[92:95]
v_mfma_f32_16x16x32_bf16 v[96:99],a[124:127],v[112:115],v[96:99]
v_mfma_f32_16x16x32_bf16 v[100:103],a[124:127],v[116:119],v[100:103]
s_nop 3
v_cvt_pk_bf16_f32 v104,v88,v96
v_cvt_pk_bf16_f32 v105,v89,v97
v_cvt_pk_bf16_f32 v106,v90,v98
v_cvt_pk_bf16_f32 v107,v91,v99
v_cvt_pk_bf16_f32 v108,v92,v100
v_cvt_pk_bf16_f32 v109,v93,v101
v_cvt_pk_bf16_f32 v110,v94,v102
v_cvt_pk_bf16_f32 v111,v95,v103
buffer_store_dwordx4 v[104:107],v0,s[8:11],s63 offen sc1
buffer_store_dwordx4 v[108:111],v0,s[8:11],s64 offen sc1
s_lshl_b32 s59,s51,13
s_lshl2_add_u32 s59,s47,s59
s_add_u32 s59,s59,10485888
s_waitcnt vmcnt(3)
s_barrier
s_or_b32 s59,s59,s52
buffer_store_dword v17,off,s[8:11],s59 sc1
s_mov_b32 s77,1
s_lshl_b32 s70,s51,13
s_lshl2_add_u32 s70,s47,s70
s_add_u32 s70,s70,10486144
s_branch L_p_24
L_p_25:
s_endpgm
L_rm_5:
v_and_b32 v33,15,v1
v_lshrrev_b32 v34,4,v1
s_min_u32 s60,s47,27
s_lshl_b32 s60,s60,7
s_mul_i32 s59,s46,458752
s_add_u32 s60,s60,s59
v_mul_u32_u24 v36,114688,v34
v_and_b32 v35,7,v33
v_lshl_add_u32 v36,v35,4,v36
v_add_u32 v36,s60,v36
v_cmp_gt_u32 vcc,8,v33
v_mov_b32 v38,s36
v_mov_b32 v39,s37
v_mov_b32 v40,s34
v_mov_b32 v41,s35
v_cndmask_b32 v38,v38,v40,vcc
v_cndmask_b32 v39,v39,v41,vcc
v_add_co_u32 v38,vcc,v38,v36
s_nop 1
v_addc_co_u32 v39,vcc,0,v39,vcc
s_lshl_b32 s56,s46,15
v_add_u32 v37,s56,v0
global_load_dwordx4 v[44:47],v[38:39],off
v_add_co_u32 v38,vcc,3584,v38
s_nop 1
v_addc_co_u32 v39,vcc,0,v39,vcc
global_load_dwordx4 v[48:51],v[38:39],off
v_add_co_u32 v38,vcc,3584,v38
s_nop 1
v_addc_co_u32 v39,vcc,0,v39,vcc
global_load_dwordx4 v[52:55],v[38:39],off
v_add_co_u32 v38,vcc,3584,v38
s_nop 1
v_addc_co_u32 v39,vcc,0,v39,vcc
global_load_dwordx4 v[56:59],v[38:39],off
v_add_co_u32 v38,vcc,3584,v38
s_nop 1
v_addc_co_u32 v39,vcc,0,v39,vcc
global_load_dwordx4 v[60:63],v[38:39],off
v_add_co_u32 v38,vcc,3584,v38
s_nop 1
v_addc_co_u32 v39,vcc,0,v39,vcc
global_load_dwordx4 v[64:67],v[38:39],off
v_add_co_u32 v38,vcc,3584,v38
s_nop 1
v_addc_co_u32 v39,vcc,0,v39,vcc
global_load_dwordx4 v[68:71],v[38:39],off
v_add_co_u32 v38,vcc,3584,v38
s_nop 1
v_addc_co_u32 v39,vcc,0,v39,vcc
global_load_dwordx4 v[72:75],v[38:39],off
v_add_co_u32 v38,vcc,3584,v38
s_nop 1
v_addc_co_u32 v39,vcc,0,v39,vcc
global_load_dwordx4 v[76:79],v[38:39],off
v_add_co_u32 v38,vcc,3584,v38
s_nop 1
v_addc_co_u32 v39,vcc,0,v39,vcc
global_load_dwordx4 v[80:83],v[38:39],off
v_add_co_u32 v38,vcc,3584,v38
s_nop 1
v_addc_co_u32 v39,vcc,0,v39,vcc
global_load_dwordx4 v[84:87],v[38:39],off
v_add_co_u32 v38,vcc,3584,v38
s_nop 1
v_addc_co_u32 v39,vcc,0,v39,vcc
global_load_dwordx4 v[88:91],v[38:39],off
v_add_co_u32 v38,vcc,3584,v38
s_nop 1
v_addc_co_u32 v39,vcc,0,v39,vcc
global_load_dwordx4 v[92:95],v[38:39],off
v_add_co_u32 v38,vcc,3584,v38
s_nop 1
v_addc_co_u32 v39,vcc,0,v39,vcc
global_load_dwordx4 v[96:99],v[38:39],off
v_add_co_u32 v38,vcc,3584,v38
s_nop 1
v_addc_co_u32 v39,vcc,0,v39,vcc
global_load_dwordx4 v[100:103],v[38:39],off
v_add_co_u32 v38,vcc,3584,v38
s_nop 1
v_addc_co_u32 v39,vcc,0,v39,vcc
global_load_dwordx4 v[104:107],v[38:39],off
v_add_co_u32 v38,vcc,3584,v38
s_nop 1
v_addc_co_u32 v39,vcc,0,v39,vcc
s_waitcnt vmcnt(15)
ds_write_b128 v37,v[44:47] offset:0
s_waitcnt vmcnt(14)
ds_write_b128 v37,v[48:51] offset:1024
s_waitcnt vmcnt(13)
ds_write_b128 v37,v[52:55] offset:2048
s_waitcnt vmcnt(12)
ds_write_b128 v37,v[56:59] offset:3072
s_waitcnt vmcnt(11)
ds_write_b128 v37,v[60:63] offset:4096
s_waitcnt vmcnt(10)
ds_write_b128 v37,v[64:67] offset:5120
s_waitcnt vmcnt(9)
ds_write_b128 v37,v[68:71] offset:6144
s_waitcnt vmcnt(8)
ds_write_b128 v37,v[72:75] offset:7168
s_waitcnt lgkmcnt(0)
s_waitcnt vmcnt(7)
ds_write_b128 v37,v[76:79] offset:8192
s_waitcnt vmcnt(6)
ds_write_b128 v37,v[80:83] offset:9216
s_waitcnt vmcnt(5)
ds_write_b128 v37,v[84:87] offset:10240
s_waitcnt vmcnt(4)
ds_write_b128 v37,v[88:91] offset:11264
s_waitcnt vmcnt(3)
ds_write_b128 v37,v[92:95] offset:12288
s_waitcnt vmcnt(2)
ds_write_b128 v37,v[96:99] offset:13312
s_waitcnt vmcnt(1)
ds_write_b128 v37,v[100:103] offset:14336
s_waitcnt vmcnt(0)
ds_write_b128 v37,v[104:107] offset:15360
s_waitcnt lgkmcnt(0)
global_load_dwordx4 v[44:47],v[38:39],off
v_add_co_u32 v38,vcc,3584,v38
s_nop 1
v_addc_co_u32 v39,vcc,0,v39,vcc
global_load_dwordx4 v[48:51],v[38:39],off
v_add_co_u32 v38,vcc,3584,v38
s_nop 1
v_addc_co_u32 v39,vcc,0,v39,vcc
global_load_dwordx4 v[52:55],v[38:39],off
v_add_co_u32 v38,vcc,3584,v38
s_nop 1
v_addc_co_u32 v39,vcc,0,v39,vcc
global_load_dwordx4 v[56:59],v[38:39],off
v_add_co_u32 v38,vcc,3584,v38
s_nop 1
v_addc_co_u32 v39,vcc,0,v39,vcc
global_load_dwordx4 v[60:63],v[38:39],off
v_add_co_u32 v38,vcc,3584,v38
s_nop 1
v_addc_co_u32 v39,vcc,0,v39,vcc
global_load_dwordx4 v[64:67],v[38:39],off
v_add_co_u32 v38,vcc,3584,v38
s_nop 1
v_addc_co_u32 v39,vcc,0,v39,vcc
global_load_dwordx4 v[68:71],v[38:39],off
v_add_co_u32 v38,vcc,3584,v38
s_nop 1
v_addc_co_u32 v39,vcc,0,v39,vcc
global_load_dwordx4 v[72:75],v[38:39],off
v_add_co_u32 v38,vcc,3584,v38
s_nop 1
v_addc_co_u32 v39,vcc,0,v39,vcc
global_load_dwordx4 v[76:79],v[38:39],off
v_add_co_u32 v38,vcc,3584,v38
s_nop 1
v_addc_co_u32 v39,vcc,0,v39,vcc
global_load_dwordx4 v[80:83],v[38:39],off
v_add_co_u32 v38,vcc,3584,v38
s_nop 1
v_addc_co_u32 v39,vcc,0,v39,vcc
global_load_dwordx4 v[84:87],v[38:39],off
v_add_co_u32 v38,vcc,3584,v38
s_nop 1
v_addc_co_u32 v39,vcc,0,v39,vcc
global_load_dwordx4 v[88:91],v[38:39],off
v_add_co_u32 v38,vcc,3584,v38
s_nop 1
v_addc_co_u32 v39,vcc,0,v39,vcc
global_load_dwordx4 v[92:95],v[38:39],off
v_add_co_u32 v38,vcc,3584,v38
s_nop 1
v_addc_co_u32 v39,vcc,0,v39,vcc
global_load_dwordx4 v[96:99],v[38:39],off
v_add_co_u32 v38,vcc,3584,v38
s_nop 1
v_addc_co_u32 v39,vcc,0,v39,vcc
global_load_dwordx4 v[100:103],v[38:39],off
v_add_co_u32 v38,vcc,3584,v38
s_nop 1
v_addc_co_u32 v39,vcc,0,v39,vcc
global_load_dwordx4 v[104:107],v[38:39],off
v_add_co_u32 v38,vcc,3584,v38
s_nop 1
v_addc_co_u32 v39,vcc,0,v39,vcc
s_waitcnt vmcnt(15)
ds_write_b128 v37,v[44:47] offset:16384
s_waitcnt vmcnt(14)
ds_write_b128 v37,v[48:51] offset:17408
s_waitcnt vmcnt(13)
ds_write_b128 v37,v[52:55] offset:18432
s_waitcnt vmcnt(12)
ds_write_b128 v37,v[56:59] offset:19456
s_waitcnt vmcnt(11)
ds_write_b128 v37,v[60:63] offset:20480
s_waitcnt vmcnt(10)
ds_write_b128 v37,v[64:67] offset:21504
s_waitcnt vmcnt(9)
ds_write_b128 v37,v[68:71] offset:22528
s_waitcnt vmcnt(8)
ds_write_b128 v37,v[72:75] offset:23552
s_waitcnt lgkmcnt(0)
s_waitcnt vmcnt(7)
ds_write_b128 v37,v[76:79] offset:24576
s_waitcnt vmcnt(6)
ds_write_b128 v37,v[80:83] offset:25600
s_waitcnt vmcnt(5)
ds_write_b128 v37,v[84:87] offset:26624
s_waitcnt vmcnt(4)
ds_write_b128 v37,v[88:91] offset:27648
s_waitcnt vmcnt(3)
ds_write_b128 v37,v[92:95] offset:28672
s_waitcnt vmcnt(2)
ds_write_b128 v37,v[96:99] offset:29696
s_waitcnt vmcnt(1)
ds_write_b128 v37,v[100:103] offset:30720
s_waitcnt vmcnt(0)
ds_write_b128 v37,v[104:107] offset:31744
s_waitcnt lgkmcnt(0)
v_mov_b32 v123,159744
s_cmp_lg_u32 s46,0
s_cbranch_scc1 L_gbd_32
v_mov_b32 v124,240
L_gb_31:
buffer_load_dword v125,v124,s[12:15],0 offen sc1
s_waitcnt vmcnt(0)
v_readfirstlane_b32 s56,v125
ds_write_b32 v123,v125
s_bitcmp1_b32 s56,8
s_cbranch_scc1 L_gbd_32
s_sleep 4
s_sub_u32 s49,s49,1
s_cmp_gt_i32 s49,0
s_cbranch_scc1 L_gb_31
s_branch L_abort
L_gbd_32:
s_waitcnt lgkmcnt(0)
s_barrier
ds_read_b32 v125,v123
s_waitcnt lgkmcnt(0)
v_readfirstlane_b32 s56,v125
s_barrier
s_lshr_b32 s56,s56,16
s_andn2_b32 s56,s56,s3
s_cbranch_scc1 L_spread
s_cmp_lg_u32 s3,0
s_cbranch_scc1 L_wm
v_and_b32 v120,15,v1
v_lshrrev_b32 v121,4,v1
v_mov_b32 v17,1
s_lshl_b32 s56,s46,15
v_add_u32 v18,s56,v0
s_lshl_b32 s56,s46,2
v_add_u32 v125,s56,v121
v_xor_b32 v126,v125,v120
v_lshlrev_b32 v126,4,v126
v_lshl_add_u32 v20,v125,10,v126
v_add_u32 v125,0,v121
v_xor_b32 v125,v125,v120
v_lshlrev_b32 v125,4,v125
v_lshl_add_u32 v125,v120,8,v125
v_add_u32 v4,131072,v125
v_add_u32 v125,4,v121
v_xor_b32 v125,v125,v120
v_lshlrev_b32 v125,4,v125
v_lshl_add_u32 v125,v120,8,v125
v_add_u32 v5,131072,v125
v_add_u32 v125,8,v121
v_xor_b32 v125,v125,v120
v_lshlrev_b32 v125,4,v125
v_lshl_add_u32 v125,v120,8,v125
v_add_u32 v6,131072,v125
v_add_u32 v125,12,v121
v_xor_b32 v125,v125,v120
v_lshlrev_b32 v125,4,v125
v_lshl_add_u32 v125,v120,8,v125
v_add_u32 v7,131072,v125
v_lshlrev_b32 v21,5,v120
v_and_b32 v125,1,v121
v_lshl_add_u32 v21,v125,4,v21
s_lshl_b32 s56,s46,9
v_lshrrev_b32 v125,1,v121
v_lshl_add_u32 v21,v125,11,v21
s_add_u32 s56,s56,155648
v_add_u32 v21,s56,v21
v_lshlrev_b32 v22,4,v120
v_lshl_add_u32 v22,v121,10,v22
s_lshl_b32 s56,s46,8
v_add_u32 v22,s56,v22
s_mov_b32 s54,0
s_mov_b32 s31,0
s_mov_b32 s53,6
s_mov_b32 s72,0x80000000
s_mov_b32 s73,0
s_mov_b32 s77,-1
s_mov_b32 s86,0
s_mov_b32 s19,0
s_mov_b32 s74,2948595712
s_mov_b32 s75,2863311530
v_and_b32 v23,15,v1
v_lshlrev_b32 v23,3,v23
v_lshrrev_b32 v16,4,v1
v_lshl_add_u32 v23,v16,13,v23
v_mov_b32 v19,159744
v_lshl_add_u32 v16,v16,2,v19
v_and_b32 v9,15,v1
v_lshrrev_b32 v10,4,v1
v_and_b32 v124,1,v1
v_lshlrev_b32 v124,4,v124
v_mov_b32 v125,0xffff
v_lshlrev_b32 v125,v124,v125
v_lshrrev_b32 v124,2,v9
v_cmp_eq_u32 vcc,0,v124
s_nop 1
v_cndmask_b32 v12,0,v125,vcc
v_cmp_eq_u32 vcc,1,v124
s_nop 1
v_cndmask_b32 v13,0,v125,vcc
v_and_b32 v124,2,v1
v_cmp_eq_u32 vcc,0,v124
v_mov_b32 v14,0xeeee
v_mov_b32 v124,0x4444
v_cndmask_b32 v14,v14,v124,vcc
v_lshlrev_b32 v11,14,v10
v_lshl_add_u32 v11,v9,4,v11
s_lshl_b32 s65,s51,15
s_add_u32 s65,s65,92274688
s_lshl_b32 s62,s47,10
s_add_u32 s62,s62,s65
s_lshl_b32 s63,s47,16
s_lshl_b32 s60,s46,8
s_add_u32 s63,s63,s60
s_mov_b32 s4,s38
s_mov_b32 s5,s39
s_mov_b32 s6,1835008
s_mov_b32 s7,0x20000
buffer_load_dwordx4 v[24:27],v11,s[4:7],s63 offen offset:0
buffer_load_dwordx4 v[28:31],v11,s[4:7],s63 offen offset:1024
buffer_load_dwordx4 v[32:35],v11,s[4:7],s63 offen offset:2048
buffer_load_dwordx4 v[36:39],v11,s[4:7],s63 offen offset:3072
s_add_u32 s63,s63,4096
buffer_load_dwordx4 v[40:43],v11,s[4:7],s63 offen offset:0
buffer_load_dwordx4 v[44:47],v11,s[4:7],s63 offen offset:1024
buffer_load_dwordx4 v[48:51],v11,s[4:7],s63 offen offset:2048
buffer_load_dwordx4 v[52:55],v11,s[4:7],s63 offen offset:3072
s_add_u32 s63,s63,4096
buffer_load_dwordx4 v[56:59],v11,s[4:7],s63 offen offset:0
buffer_load_dwordx4 v[60:63],v11,s[4:7],s63 offen offset:1024
buffer_load_dwordx4 v[64:67],v11,s[4:7],s63 offen offset:2048
buffer_load_dwordx4 v[68:71],v11,s[4:7],s63 offen offset:3072
s_add_u32 s63,s63,4096
buffer_load_dwordx4 v[72:75],v11,s[4:7],s63 offen offset:0
buffer_load_dwordx4 v[76:79],v11,s[4:7],s63 offen offset:1024
buffer_load_dwordx4 v[80:83],v11,s[4:7],s63 offen offset:2048
buffer_load_dwordx4 v[84:87],v11,s[4:7],s63 offen offset:3072
s_mov_b32 s4,s32
s_mov_b32 s5,s33
s_mov_b32 s6,1024
s_mov_b32 s7,0x20000
buffer_load_dwordx4 v[88:91],v0,s[4:7],0 offen
s_waitcnt vmcnt(0)
v_lshlrev_b32 v96,16,v88
v_and_b32 v97,0xffff0000,v88
v_lshlrev_b32 v98,16,v89
v_and_b32 v99,0xffff0000,v89
v_lshlrev_b32 v100,16,v90
v_and_b32 v101,0xffff0000,v90
v_lshlrev_b32 v102,16,v91
v_and_b32 v103,0xffff0000,v91
v_mul_f32 v88,v96,v96
v_fma_f32 v88,v97,v97,v88
v_fma_f32 v88,v98,v98,v88
v_fma_f32 v88,v99,v99,v88
v_fma_f32 v88,v100,v100,v88
v_fma_f32 v88,v101,v101,v88
v_fma_f32 v88,v102,v102,v88
v_fma_f32 v88,v103,v103,v88
s_nop 1
v_add_f32_dpp v88,v88,v88 row_ror:8 row_mask:0xf bank_mask:0xf
s_nop 1
v_add_f32_dpp v88,v88,v88 row_ror:4 row_mask:0xf bank_mask:0xf
s_nop 1
v_add_f32_dpp v88,v88,v88 row_ror:2 row_mask:0xf bank_mask:0xf
s_nop 1
v_add_f32_dpp v88,v88,v88 row_ror:1 row_mask:0xf bank_mask:0xf
v_mov_b32 v89,v88
s_nop 1
v_permlane16_swap_b32 v88,v89
v_add_f32 v88,v88,v89
v_mov_b32 v89,v88
s_nop 1
v_permlane32_swap_b32 v88,v89
v_add_f32 v88,v88,v89
v_sqrt_f32 v88,v88
s_nop 0
v_mul_f32 v88,0x40333333,v88
s_nop 0
v_readfirstlane_b32 s25,v88
s_bitset1_b32 s25,31
s_ff1_i32_b64 s30,s[74:75]
s_bitset0_b64 s[74:75],s30
s_min_u32 s30,s30,127
s_lshl_b32 s70,s30,15
s_add_u32 s70,s70,0
s_add_u32 s71,s70,16384
L_mo_37:
s_cmp_lg_u32 s19,0
s_cbranch_scc1 L_mo_38
s_add_u32 m0,s50,131072
s_nop 0
buffer_load_dwordx4 v20,s[8:11],s70 offen offset:0 sc1 lds
s_add_u32 m0,s50,135168
s_nop 0
buffer_load_dwordx4 v20,s[8:11],s71 offen offset:0 sc1 lds
s_add_u32 m0,s50,139008
s_nop 0
buffer_load_dwordx4 v20,s[8:11],s70 offen offset:256 sc1 lds
s_add_u32 m0,s50,143104
s_nop 0
buffer_load_dwordx4 v20,s[8:11],s71 offen offset:256 sc1 lds
s_add_u32 m0,s50,146944
s_nop 0
buffer_load_dwordx4 v20,s[8:11],s70 offen offset:512 sc1 lds
s_add_u32 m0,s50,151040
s_nop 0
buffer_load_dwordx4 v20,s[8:11],s71 offen offset:512 sc1 lds
s_mov_b32 s19,1
s_waitcnt vmcnt(0)
L_mo_38:
s_mov_b32 s51,s30
s_mov_b64 s[68:69],s[70:71]
s_ff1_i32_b64 s30,s[74:75]
s_bitset0_b64 s[74:75],s30
s_min_u32 s30,s30,127
s_lshl_b32 s70,s30,15
s_add_u32 s70,s70,0
s_add_u32 s71,s70,16384
s_lshl_b32 s76,s31,13
s_add_u32 s76,s76,10487040
s_lshl_b32 s58,s51,5
s_add_u32 s58,s58,s47
s_mul_i32 s58,s58,24576
s_add_u32 s58,s58,100663296
s_add_u32 s61,s58,s50
s_add_u32 s62,s61,4096
s_add_u32 s63,s61,16384
s_add_u32 s64,s61,20480
s_add_u32 s65,s61,s50
s_add_u32 s65,s65,8192
s_waitcnt vmcnt(12)
s_barrier
ds_read_b128 v[72:75],v4 offset:0
ds_read_b128 v[76:79],v4 offset:4096
ds_read_b128 v[80:83],v5 offset:0
ds_read_b128 v[84:87],v5 offset:4096
s_add_u32 m0,s50,154880
s_nop 0
buffer_load_dwordx4 v20,s[8:11],s68 offen offset:768 sc1 lds
s_add_u32 m0,s50,158976
s_nop 0
buffer_load_dwordx4 v20,s[8:11],s69 offen offset:768 sc1 lds
s_waitcnt lgkmcnt(2)
v_mfma_f32_16x16x32_bf16 v[40:43],a[128:131],v[72:75],0
ds_read_b128 v[108:111],v6 offset:0
v_mfma_f32_16x16x32_bf16 v[56:59],v[72:75],v[128:131],0
v_mfma_f32_16x16x32_bf16 v[24:27],a[0:3],v[72:75],0
ds_read_b128 v[112:115],v6 offset:4096
v_mfma_f32_16x16x32_bf16 v[44:47],a[128:131],v[76:79],0
v_mfma_f32_16x16x32_bf16 v[60:63],v[76:79],v[128:131],0
v_mfma_f32_16x16x32_bf16 v[28:31],a[0:3],v[76:79],0
v_mfma_f32_16x16x32_bf16 v[48:51],a[136:139],v[72:75],0
v_mfma_f32_16x16x32_bf16 v[64:67],v[72:75],v[136:139],0
v_mfma_f32_16x16x32_bf16 v[32:35],a[8:11],v[72:75],0
v_mfma_f32_16x16x32_bf16 v[52:55],a[136:139],v[76:79],0
v_mfma_f32_16x16x32_bf16 v[68:71],v[76:79],v[136:139],0
v_mfma_f32_16x16x32_bf16 v[36:39],a[8:11],v[76:79],0
s_waitcnt lgkmcnt(2)
v_mfma_f32_16x16x32_bf16 v[40:43],a[132:135],v[80:83],v[40:43]
ds_read_b128 v[72:75],v7 offset:0
v_mfma_f32_16x16x32_bf16 v[56:59],v[80:83],v[132:135],v[56:59]
v_mfma_f32_16x16x32_bf16 v[24:27],a[4:7],v[80:83],v[24:27]
ds_read_b128 v[76:79],v7 offset:4096
v_mfma_f32_16x16x32_bf16 v[44:47],a[132:135],v[84:87],v[44:47]
v_mfma_f32_16x16x32_bf16 v[60:63],v[84:87],v[132:135],v[60:63]
v_mfma_f32_16x16x32_bf16 v[28:31],a[4:7],v[84:87],v[28:31]
v_mfma_f32_16x16x32_bf16 v[48:51],a[140:143],v[80:83],v[48:51]
v_mfma_f32_16x16x32_bf16 v[64:67],v[80:83],v[140:143],v[64:67]
v_mfma_f32_16x16x32_bf16 v[32:35],a[12:15],v[80:83],v[32:35]
v_mfma_f32_16x16x32_bf16 v[52:55],a[140:143],v[84:87],v[52:55]
v_mfma_f32_16x16x32_bf16 v[68:71],v[84:87],v[140:143],v[68:71]
v_mfma_f32_16x16x32_bf16 v[36:39],a[12:15],v[84:87],v[36:39]
s_waitcnt vmcnt(12)
s_barrier
s_waitcnt lgkmcnt(2)
v_mfma_f32_16x16x32_bf16 v[40:43],a[144:147],v[108:111],v[40:43]
ds_read_b128 v[80:83],v4 offset:8192
v_mfma_f32_16x16x32_bf16 v[56:59],v[108:111],v[144:147],v[56:59]
v_mfma_f32_16x16x32_bf16 v[24:27],a[16:19],v[108:111],v[24:27]
ds_read_b128 v[84:87],v4 offset:12288
v_mfma_f32_16x16x32_bf16 v[44:47],a[144:147],v[112:115],v[44:47]
v_mfma_f32_16x16x32_bf16 v[60:63],v[112:115],v[144:147],v[60:63]
v_mfma_f32_16x16x32_bf16 v[28:31],a[16:19],v[112:115],v[28:31]
v_mfma_f32_16x16x32_bf16 v[48:51],a[152:155],v[108:111],v[48:51]
v_mfma_f32_16x16x32_bf16 v[64:67],v[108:111],v[152:155],v[64:67]
v_mfma_f32_16x16x32_bf16 v[32:35],a[24:27],v[108:111],v[32:35]
v_mfma_f32_16x16x32_bf16 v[52:55],a[152:155],v[112:115],v[52:55]
v_mfma_f32_16x16x32_bf16 v[68:71],v[112:115],v[152:155],v[68:71]
v_mfma_f32_16x16x32_bf16 v[36:39],a[24:27],v[112:115],v[36:39]
s_waitcnt lgkmcnt(2)
v_mfma_f32_16x16x32_bf16 v[40:43],a[148:151],v[72:75],v[40:43]
ds_read_b128 v[108:111],v5 offset:8192
v_mfma_f32_16x16x32_bf16 v[56:59],v[72:75],v[148:151],v[56:59]
v_mfma_f32_16x16x32_bf16 v[24:27],a[20:23],v[72:75],v[24:27]
ds_read_b128 v[112:115],v5 offset:12288
v_mfma_f32_16x16x32_bf16 v[44:47],a[148:151],v[76:79],v[44:47]
v_mfma_f32_16x16x32_bf16 v[60:63],v[76:79],v[148:151],v[60:63]
v_mfma_f32_16x16x32_bf16 v[28:31],a[20:23],v[76:79],v[28:31]
v_mfma_f32_16x16x32_bf16 v[48:51],a[156:159],v[72:75],v[48:51]
v_mfma_f32_16x16x32_bf16 v[64:67],v[72:75],v[156:159],v[64:67]
v_mfma_f32_16x16x32_bf16 v[32:35],a[28:31],v[72:75],v[32:35]
v_mfma_f32_16x16x32_bf16 v[52:55],a[156:159],v[76:79],v[52:55]
v_mfma_f32_16x16x32_bf16 v[68:71],v[76:79],v[156:159],v[68:71]
v_mfma_f32_16x16x32_bf16 v[36:39],a[28:31],v[76:79],v[36:39]
s_waitcnt lgkmcnt(2)
v_mfma_f32_16x16x32_bf16 v[40:43],a[160:163],v[80:83],v[40:43]
ds_read_b128 v[72:75],v6 offset:8192
v_mfma_f32_16x16x32_bf16 v[56:59],v[80:83],v[160:163],v[56:59]
v_mfma_f32_16x16x32_bf16 v[24:27],a[32:35],v[80:83],v[24:27]
ds_read_b128 v[76:79],v6 offset:12288
v_mfma_f32_16x16x32_bf16 v[44:47],a[160:163],v[84:87],v[44:47]
v_mfma_f32_16x16x32_bf16 v[60:63],v[84:87],v[160:163],v[60:63]
v_mfma_f32_16x16x32_bf16 v[28:31],a[32:35],v[84:87],v[28:31]
v_mfma_f32_16x16x32_bf16 v[48:51],a[168:171],v[80:83],v[48:51]
v_mfma_f32_16x16x32_bf16 v[64:67],v[80:83],v[168:171],v[64:67]
v_mfma_f32_16x16x32_bf16 v[32:35],a[40:43],v[80:83],v[32:35]
v_mfma_f32_16x16x32_bf16 v[52:55],a[168:171],v[84:87],v[52:55]
v_mfma_f32_16x16x32_bf16 v[68:71],v[84:87],v[168:171],v[68:71]
v_mfma_f32_16x16x32_bf16 v[36:39],a[40:43],v[84:87],v[36:39]
s_waitcnt lgkmcnt(2)
v_mfma_f32_16x16x32_bf16 v[40:43],a[164:167],v[108:111],v[40:43]
ds_read_b128 v[80:83],v7 offset:8192
v_mfma_f32_16x16x32_bf16 v[56:59],v[108:111],v[164:167],v[56:59]
v_mfma_f32_16x16x32_bf16 v[24:27],a[36:39],v[108:111],v[24:27]
ds_read_b128 v[84:87],v7 offset:12288
v_mfma_f32_16x16x32_bf16 v[44:47],a[164:167],v[112:115],v[44:47]
v_mfma_f32_16x16x32_bf16 v[60:63],v[112:115],v[164:167],v[60:63]
v_mfma_f32_16x16x32_bf16 v[28:31],a[36:39],v[112:115],v[28:31]
v_mfma_f32_16x16x32_bf16 v[48:51],a[172:175],v[108:111],v[48:51]
v_mfma_f32_16x16x32_bf16 v[64:67],v[108:111],v[172:175],v[64:67]
v_mfma_f32_16x16x32_bf16 v[32:35],a[44:47],v[108:111],v[32:35]
v_mfma_f32_16x16x32_bf16 v[52:55],a[172:175],v[112:115],v[52:55]
v_mfma_f32_16x16x32_bf16 v[68:71],v[112:115],v[172:175],v[68:71]
v_mfma_f32_16x16x32_bf16 v[36:39],a[44:47],v[112:115],v[36:39]
s_waitcnt vmcnt(10)
s_barrier
s_waitcnt lgkmcnt(2)
v_mfma_f32_16x16x32_bf16 v[40:43],a[176:179],v[72:75],v[40:43]
ds_read_b128 v[108:111],v4 offset:16384
v_mfma_f32_16x16x32_bf16 v[56:59],v[72:75],v[176:179],v[56:59]
v_mfma_f32_16x16x32_bf16 v[24:27],a[48:51],v[72:75],v[24:27]
ds_read_b128 v[112:115],v4 offset:20480
v_mfma_f32_16x16x32_bf16 v[44:47],a[176:179],v[76:79],v[44:47]
v_mfma_f32_16x16x32_bf16 v[60:63],v[76:79],v[176:179],v[60:63]
v_mfma_f32_16x16x32_bf16 v[28:31],a[48:51],v[76:79],v[28:31]
v_mfma_f32_16x16x32_bf16 v[48:51],a[184:187],v[72:75],v[48:51]
v_mfma_f32_16x16x32_bf16 v[64:67],v[72:75],v[184:187],v[64:67]
v_mfma_f32_16x16x32_bf16 v[32:35],a[56:59],v[72:75],v[32:35]
v_mfma_f32_16x16x32_bf16 v[52:55],a[184:187],v[76:79],v[52:55]
v_mfma_f32_16x16x32_bf16 v[68:71],v[76:79],v[184:187],v[68:71]
v_mfma_f32_16x16x32_bf16 v[36:39],a[56:59],v[76:79],v[36:39]
s_waitcnt vmcnt(2)
s_barrier
s_or_b32 s72,s72,s52
buffer_store_dword v17,off,s[8:11],s72 sc1
s_waitcnt lgkmcnt(2)
v_mfma_f32_16x16x32_bf16 v[40:43],a[180:183],v[80:83],v[40:43]
ds_read_b128 v[72:75],v5 offset:16384
v_mfma_f32_16x16x32_bf16 v[56:59],v[80:83],v[180:183],v[56:59]
v_mfma_f32_16x16x32_bf16 v[24:27],a[52:55],v[80:83],v[24:27]
ds_read_b128 v[76:79],v5 offset:20480
v_mfma_f32_16x16x32_bf16 v[44:47],a[180:183],v[84:87],v[44:47]
v_mfma_f32_16x16x32_bf16 v[60:63],v[84:87],v[180:183],v[60:63]
v_mfma_f32_16x16x32_bf16 v[28:31],a[52:55],v[84:87],v[28:31]
v_mfma_f32_16x16x32_bf16 v[48:51],a[188:191],v[80:83],v[48:51]
v_mfma_f32_16x16x32_bf16 v[64:67],v[80:83],v[188:191],v[64:67]
v_mfma_f32_16x16x32_bf16 v[32:35],a[60:63],v[80:83],v[32:35]
v_mfma_f32_16x16x32_bf16 v[52:55],a[188:191],v[84:87],v[52:55]
v_mfma_f32_16x16x32_bf16 v[68:71],v[84:87],v[188:191],v[68:71]
v_mfma_f32_16x16x32_bf16 v[36:39],a[60:63],v[84:87],v[36:39]
s_waitcnt lgkmcnt(2)
v_mfma_f32_16x16x32_bf16 v[40:43],a[192:195],v[108:111],v[40:43]
ds_read_b128 v[80:83],v6 offset:16384
v_mfma_f32_16x16x32_bf16 v[56:59],v[108:111],v[192:195],v[56:59]
v_mfma_f32_16x16x32_bf16 v[24:27],a[64:67],v[108:111],v[24:27]
ds_read_b128 v[84:87],v6 offset:20480
v_mfma_f32_16x16x32_bf16 v[44:47],a[192:195],v[112:115],v[44:47]
v_mfma_f32_16x16x32_bf16 v[60:63],v[112:115],v[192:195],v[60:63]
v_mfma_f32_16x16x32_bf16 v[28:31],a[64:67],v[112:115],v[28:31]
v_mfma_f32_16x16x32_bf16 v[48:51],a[200:203],v[108:111],v[48:51]
v_mfma_f32_16x16x32_bf16 v[64:67],v[108:111],v[200:203],v[64:67]
v_mfma_f32_16x16x32_bf16 v[32:35],a[72:75],v[108:111],v[32:35]
v_mfma_f32_16x16x32_bf16 v[52:55],a[200:203],v[112:115],v[52:55]
v_mfma_f32_16x16x32_bf16 v[68:71],v[112:115],v[200:203],v[68:71]
v_mfma_f32_16x16x32_bf16 v[36:39],a[72:75],v[112:115],v[36:39]
s_waitcnt lgkmcnt(2)
v_mfma_f32_16x16x32_bf16 v[40:43],a[196:199],v[72:75],v[40:43]
ds_read_b128 v[108:111],v7 offset:16384
v_mfma_f32_16x16x32_bf16 v[56:59],v[72:75],v[196:199],v[56:59]
v_mfma_f32_16x16x32_bf16 v[24:27],a[68:71],v[72:75],v[24:27]
ds_read_b128 v[112:115],v7 offset:20480
v_mfma_f32_16x16x32_bf16 v[44:47],a[196:199],v[76:79],v[44:47]
v_mfma_f32_16x16x32_bf16 v[60:63],v[76:79],v[196:199],v[60:63]
v_mfma_f32_16x16x32_bf16 v[28:31],a[68:71],v[76:79],v[28:31]
v_mfma_f32_16x16x32_bf16 v[48:51],a[204:207],v[72:75],v[48:51]
v_mfma_f32_16x16x32_bf16 v[64:67],v[72:75],v[204:207],v[64:67]
v_mfma_f32_16x16x32_bf16 v[32:35],a[76:79],v[72:75],v[32:35]
v_mfma_f32_16x16x32_bf16 v[52:55],a[204:207],v[76:79],v[52:55]
v_mfma_f32_16x16x32_bf16 v[68:71],v[76:79],v[204:207],v[68:71]
v_mfma_f32_16x16x32_bf16 v[36:39],a[76:79],v[76:79],v[36:39]
s_waitcnt vmcnt(1)
s_barrier
s_waitcnt lgkmcnt(2)
v_mfma_f32_16x16x32_bf16 v[40:43],a[208:211],v[80:83],v[40:43]
ds_read_b128 v[72:75],v4 offset:24576
v_mfma_f32_16x16x32_bf16 v[56:59],v[80:83],v[208:211],v[56:59]
v_mfma_f32_16x16x32_bf16 v[24:27],a[80:83],v[80:83],v[24:27]
ds_read_b128 v[76:79],v4 offset:28672
v_mfma_f32_16x16x32_bf16 v[44:47],a[208:211],v[84:87],v[44:47]
v_mfma_f32_16x16x32_bf16 v[60:63],v[84:87],v[208:211],v[60:63]
v_mfma_f32_16x16x32_bf16 v[28:31],a[80:83],v[84:87],v[28:31]
v_mfma_f32_16x16x32_bf16 v[48:51],a[216:219],v[80:83],v[48:51]
v_mfma_f32_16x16x32_bf16 v[64:67],v[80:83],v[216:219],v[64:67]
v_mfma_f32_16x16x32_bf16 v[32:35],a[88:91],v[80:83],v[32:35]
v_mfma_f32_16x16x32_bf16 v[52:55],a[216:219],v[84:87],v[52:55]
v_mfma_f32_16x16x32_bf16 v[68:71],v[84:87],v[216:219],v[68:71]
v_mfma_f32_16x16x32_bf16 v[36:39],a[88:91],v[84:87],v[36:39]
s_waitcnt lgkmcnt(2)
v_mfma_f32_16x16x32_bf16 v[40:43],a[212:215],v[108:111],v[40:43]
ds_read_b128 v[80:83],v5 offset:24576
v_mfma_f32_16x16x32_bf16 v[56:59],v[108:111],v[212:215],v[56:59]
v_mfma_f32_16x16x32_bf16 v[24:27],a[84:87],v[108:111],v[24:27]
ds_read_b128 v[84:87],v5 offset:28672
v_mfma_f32_16x16x32_bf16 v[44:47],a[212:215],v[112:115],v[44:47]
v_mfma_f32_16x16x32_bf16 v[60:63],v[112:115],v[212:215],v[60:63]
v_mfma_f32_16x16x32_bf16 v[28:31],a[84:87],v[112:115],v[28:31]
v_mfma_f32_16x16x32_bf16 v[48:51],a[220:223],v[108:111],v[48:51]
v_mfma_f32_16x16x32_bf16 v[64:67],v[108:111],v[220:223],v[64:67]
v_mfma_f32_16x16x32_bf16 v[32:35],a[92:95],v[108:111],v[32:35]
v_mfma_f32_16x16x32_bf16 v[52:55],a[220:223],v[112:115],v[52:55]
v_mfma_f32_16x16x32_bf16 v[68:71],v[112:115],v[220:223],v[68:71]
v_mfma_f32_16x16x32_bf16 v[36:39],a[92:95],v[112:115],v[36:39]
s_barrier
s_waitcnt lgkmcnt(2)
v_mfma_f32_16x16x32_bf16 v[40:43],a[224:227],v[72:75],v[40:43]
ds_read_b128 v[108:111],v6 offset:24576
v_mfma_f32_16x16x32_bf16 v[56:59],v[72:75],v[224:227],v[56:59]
s_add_u32 m0,s50,131072
v_mfma_f32_16x16x32_bf16 v[24:27],a[96:99],v[72:75],v[24:27]
ds_read_b128 v[112:115],v6 offset:28672
v_mfma_f32_16x16x32_bf16 v[44:47],a[224:227],v[76:79],v[44:47]
buffer_load_dwordx4 v20,s[8:11],s70 offen offset:0 sc1 lds
v_mfma_f32_16x16x32_bf16 v[60:63],v[76:79],v[224:227],v[60:63]
s_add_u32 m0,s50,135168
v_mfma_f32_16x16x32_bf16 v[28:31],a[96:99],v[76:79],v[28:31]
buffer_load_dwordx4 v20,s[8:11],s71 offen offset:0 sc1 lds
v_mfma_f32_16x16x32_bf16 v[48:51],a[232:235],v[72:75],v[48:51]
s_add_u32 m0,s50,139008
v_mfma_f32_16x16x32_bf16 v[64:67],v[72:75],v[232:235],v[64:67]
buffer_load_dwordx4 v20,s[8:11],s70 offen offset:256 sc1 lds
v_mfma_f32_16x16x32_bf16 v[32:35],a[104:107],v[72:75],v[32:35]
s_add_u32 m0,s50,143104
v_mfma_f32_16x16x32_bf16 v[52:55],a[232:235],v[76:79],v[52:55]
buffer_load_dwordx4 v20,s[8:11],s71 offen offset:256 sc1 lds
v_mfma_f32_16x16x32_bf16 v[68:71],v[76:79],v[232:235],v[68:71]
s_add_u32 m0,s50,146944
v_mfma_f32_16x16x32_bf16 v[36:39],a[104:107],v[76:79],v[36:39]
buffer_load_dwordx4 v20,s[8:11],s70 offen offset:512 sc1 lds
s_waitcnt lgkmcnt(2)
v_mfma_f32_16x16x32_bf16 v[40:43],a[228:231],v[80:83],v[40:43]
ds_read_b128 v[72:75],v7 offset:24576
v_mfma_f32_16x16x32_bf16 v[56:59],v[80:83],v[228:231],v[56:59]
s_add_u32 m0,s50,151040
v_mfma_f32_16x16x32_bf16 v[24:27],a[100:103],v[80:83],v[24:27]
ds_read_b128 v[76:79],v7 offset:28672
v_mfma_f32_16x16x32_bf16 v[44:47],a[228:231],v[84:87],v[44:47]
buffer_load_dwordx4 v20,s[8:11],s71 offen offset:512 sc1 lds
v_mfma_f32_16x16x32_bf16 v[60:63],v[84:87],v[228:231],v[60:63]
buffer_load_dwordx2 v[124:125],v23,s[8:11],s76 offen sc1
v_mfma_f32_16x16x32_bf16 v[28:31],a[100:103],v[84:87],v[28:31]
v_mfma_f32_16x16x32_bf16 v[48:51],a[236:239],v[80:83],v[48:51]
v_mfma_f32_16x16x32_bf16 v[64:67],v[80:83],v[236:239],v[64:67]
v_mfma_f32_16x16x32_bf16 v[32:35],a[108:111],v[80:83],v[32:35]
v_mfma_f32_16x16x32_bf16 v[52:55],a[236:239],v[84:87],v[52:55]
v_mfma_f32_16x16x32_bf16 v[68:71],v[84:87],v[236:239],v[68:71]
v_mfma_f32_16x16x32_bf16 v[36:39],a[108:111],v[84:87],v[36:39]
s_waitcnt lgkmcnt(2)
v_mfma_f32_16x16x32_bf16 v[40:43],a[240:243],v[108:111],v[40:43]
v_mfma_f32_16x16x32_bf16 v[56:59],v[108:111],v[240:243],v[56:59]
v_mfma_f32_16x16x32_bf16 v[24:27],a[112:115],v[108:111],v[24:27]
v_mfma_f32_16x16x32_bf16 v[44:47],a[240:243],v[112:115],v[44:47]
v_mfma_f32_16x16x32_bf16 v[60:63],v[112:115],v[240:243],v[60:63]
v_mfma_f32_16x16x32_bf16 v[28:31],a[112:115],v[112:115],v[28:31]
v_mfma_f32_16x16x32_bf16 v[48:51],a[248:251],v[108:111],v[48:51]
v_mfma_f32_16x16x32_bf16 v[64:67],v[108:111],v[248:251],v[64:67]
v_mfma_f32_16x16x32_bf16 v[32:35],a[120:123],v[108:111],v[32:35]
v_mfma_f32_16x16x32_bf16 v[52:55],a[248:251],v[112:115],v[52:55]
v_mfma_f32_16x16x32_bf16 v[68:71],v[112:115],v[248:251],v[68:71]
v_mfma_f32_16x16x32_bf16 v[36:39],a[120:123],v[112:115],v[36:39]
s_waitcnt lgkmcnt(0)
v_mfma_f32_16x16x32_bf16 v[40:43],a[244:247],v[72:75],v[40:43]
v_mfma_f32_16x16x32_bf16 v[56:59],v[72:75],v[244:247],v[56:59]
v_mfma_f32_16x16x32_bf16 v[24:27],a[116:119],v[72:75],v[24:27]
v_mfma_f32_16x16x32_bf16 v[44:47],a[244:247],v[76:79],v[44:47]
v_mfma_f32_16x16x32_bf16 v[60:63],v[76:79],v[244:247],v[60:63]
v_mfma_f32_16x16x32_bf16 v[28:31],a[116:119],v[76:79],v[28:31]
v_mfma_f32_16x16x32_bf16 v[48:51],a[252:255],v[72:75],v[48:51]
v_mfma_f32_16x16x32_bf16 v[64:67],v[72:75],v[252:255],v[64:67]
v_mfma_f32_16x16x32_bf16 v[32:35],a[124:127],v[72:75],v[32:35]
v_mfma_f32_16x16x32_bf16 v[52:55],a[252:255],v[76:79],v[52:55]
v_mfma_f32_16x16x32_bf16 v[68:71],v[76:79],v[252:255],v[68:71]
v_mfma_f32_16x16x32_bf16 v[36:39],a[124:127],v[76:79],v[36:39]
s_lshl_b32 s56,s51,5
s_add_u32 s56,s56,s47
s_lshl_b32 s56,s56,12
s_add_u32 s56,s56,s50
s_add_u32 s56,s56,41943040
v_mov_b64 v[120:121],-1
v_mov_b64 v[122:123],-1
buffer_store_dwordx4 v[120:123],v0,s[8:11],s56 offen sc1
v_cvt_pk_bf16_f32 v72,v40,v48
v_cvt_pk_bf16_f32 v73,v41,v49
v_cvt_pk_bf16_f32 v74,v42,v50
v_cvt_pk_bf16_f32 v75,v43,v51
buffer_store_dwordx4 v[72:75],v0,s[8:11],s61 offen sc1
v_cvt_pk_bf16_f32 v76,v44,v52
v_cvt_pk_bf16_f32 v77,v45,v53
v_cvt_pk_bf16_f32 v78,v46,v54
v_cvt_pk_bf16_f32 v79,v47,v55
buffer_store_dwordx4 v[76:79],v0,s[8:11],s62 offen sc1
v_cvt_pk_bf16_f32 v80,v56,v57
v_cvt_pk_bf16_f32 v81,v58,v59
v_cvt_pk_bf16_f32 v82,v60,v61
v_cvt_pk_bf16_f32 v83,v62,v63
buffer_store_dwordx4 v[80:83],v0,s[8:11],s65 offen offset:0 sc1
v_cvt_pk_bf16_f32 v84,v64,v65
v_cvt_pk_bf16_f32 v85,v66,v67
v_cvt_pk_bf16_f32 v86,v68,v69
v_cvt_pk_bf16_f32 v87,v70,v71
buffer_store_dwordx4 v[84:87],v0,s[8:11],s65 offen offset:1024 sc1
v_cvt_pk_bf16_f32 v108,v24,v32
v_cvt_pk_bf16_f32 v109,v25,v33
v_cvt_pk_bf16_f32 v110,v26,v34
v_cvt_pk_bf16_f32 v111,v27,v35
buffer_store_dwordx4 v[108:111],v0,s[8:11],s63 offen sc1
v_cvt_pk_bf16_f32 v112,v28,v36
v_cvt_pk_bf16_f32 v113,v29,v37
v_cvt_pk_bf16_f32 v114,v30,v38
v_cvt_pk_bf16_f32 v115,v31,v39
buffer_store_dwordx4 v[112:115],v0,s[8:11],s64 offen sc1
s_lshl_b32 s72,s51,13
s_lshl2_add_u32 s72,s47,s72
s_add_u32 s72,s72,10485760
s_sub_u32 s53,s53,1
s_cmp_gt_i32 s53,3
s_cbranch_scc1 L_mo_38
s_cmp_gt_i32 s53,0
s_cselect_b32 s87,1,3
s_mov_b32 s18,0
s_waitcnt vmcnt(7)
s_branch L_mo_43
L_mo_36:
s_mov_b32 s55,s22
s_mov_b32 s22,s23
s_mov_b32 s23,s24
s_mov_b32 s24,-1
v_mov_b32 v3,0
s_cmp_lg_u32 s55,-1
s_cbranch_scc1 L_mp_33
s_sub_u32 s56,s30,s31
s_cmp_gt_i32 s77,0
s_cselect_b32 s57,6,20
s_cmp_lg_u32 s86,0
s_cselect_b32 s57,9,s57
s_cmp_lt_i32 s56,s57
s_cbranch_scc1 L_mo_37
s_cmp_lt_i32 s56,30
s_cselect_b32 s87,s18,0
s_cmp_ge_u32 s31,8
s_cselect_b32 s56,1,s18
s_and_b32 s56,s56,s86
s_cselect_b32 s87,2,s87
s_mul_i32 s56,s87,s18
s_cmp_lg_u32 s56,0
s_cbranch_scc1 L_mo_41
s_mov_b32 s18,0
s_lshr_b32 s56,s72,31
s_or_b32 s56,s56,s87
s_cbranch_scc1 L_mo_47
s_waitcnt vmcnt(0)
s_barrier
s_or_b32 s72,s72,s52
buffer_store_dword v17,off,s[8:11],s72 sc1
s_mov_b32 s72,0x80000000
L_mo_47:
s_cmp_lg_u32 s46,0
s_cbranch_scc1 L_mo_45
s_lshl_b32 s76,s31,13
s_add_u32 s76,s76,10487040
s_lshl_b32 s57,s47,8
s_add_u32 s57,s57,s31
s_cmp_eq_u32 s57,63
s_mov_b32 s57,0x80000000
s_cmov_b32 s57,11018240
v_lshlrev_b32 v2,2,v1
L_mo_44:
buffer_load_dwordx2 v[124:125],v23,s[8:11],s76 offen sc1
buffer_load_dword v3,v2,s[8:11],s57 offen sc1
s_sub_u32 s49,s49,1
s_cbranch_scc1 L_abort
s_waitcnt vmcnt(0)
L_mo_43:
v_min_u32 v123,v124,v125
v_max_u32 v125,v124,v125
v_cmp_eq_u32 vcc,0,v123
s_nop 1
v_cndmask_b32 v125,v125,-1,vcc
s_and_b32 s56,vcc_lo,0xffff
s_cbranch_scc0 L_mo_48
s_cmp_lg_u32 s87,0
s_cbranch_scc1 L_mo_48
s_mov_b32 s18,1
s_sleep 2
s_branch L_mo_44
L_mo_48:
v_max_u32_dpp v125,v125,v125 row_ror:8 row_mask:0xf bank_mask:0xf
s_nop 1
v_max_u32_dpp v125,v125,v125 row_ror:4 row_mask:0xf bank_mask:0xf
s_nop 1
v_max_u32_dpp v125,v125,v125 row_ror:2 row_mask:0xf bank_mask:0xf
s_nop 1
v_max_u32_dpp v125,v125,v125 row_ror:1 row_mask:0xf bank_mask:0xf
L_mo_45:
s_sub_u32 s49,s49,1
s_cbranch_scc1 L_abort
v_mov_b32 v124,s18
s_barrier
s_cmp_lg_u32 s46,0
s_cbranch_scc1 L_mo_46
ds_write_b32 v16,v125
ds_write_b32 v19,v124 offset:16
s_waitcnt lgkmcnt(0)
L_mo_46:
s_barrier
ds_read_b128 v[120:123],v19
ds_read_b32 v124,v19 offset:16
s_waitcnt lgkmcnt(0)
v_readfirstlane_b32 s55,v120
v_readfirstlane_b32 s22,v121
v_readfirstlane_b32 s23,v122
v_readfirstlane_b32 s24,v123
v_readfirstlane_b32 s18,v124
s_cmp_lg_u32 s55,-1
s_cbranch_scc1 L_mp_33
L_mo_41:
s_mov_b32 s22,-1
s_cmp_eq_u32 s87,1
s_cbranch_scc1 L_mo_37
s_cmp_eq_u32 s87,2
s_cbranch_scc1 L_mo_42
s_branch L_mo_36
L_mp_33:
s_mov_b32 s53,0
s_sub_u32 s73,s73,1
s_max_i32 s73,s73,0
s_sub_u32 s77,s77,1
s_min_u32 s61,s73,2
s_cmp_lt_u32 s31,5
s_cselect_b32 s60,s25,0
s_cmp_lt_u32 s55,s60
s_cselect_b32 s61,2,s61
s_cmp_le_u32 s55,s54
s_cbranch_scc1 L_mr_34
s_mov_b32 s77,s61
s_mov_b32 s54,s55
s_mov_b32 s86,0
s_or_b32 s61,s47,s46
s_cbranch_scc1 L_mr_34
v_mov_b32 v120,s54
v_lshlrev_b32 v121,13,v1
s_mov_b32 s61,10486784
buffer_store_dword v120,v121,s[8:11],s61 offen sc1
L_mr_34:
s_cmp_lg_u32 s31,63
s_cbranch_scc1 L_mo_39
s_min_i32 s77,s77,0
s_or_b32 s61,s47,s46
s_cbranch_scc1 L_mo_39
s_mov_b32 s59,11018240
v_lshlrev_b32 v120,2,v1
v_mov_b32 v121,v3
v_cmp_eq_u32 vcc,0,v3
s_cbranch_vccz L_mg_35
L_fp_50:
s_sleep 0
buffer_load_dword v121,v120,s[8:11],s59 offen sc1
s_sub_u32 s49,s49,1
s_cbranch_scc1 L_abort
s_waitcnt vmcnt(0)
v_cmp_eq_u32 vcc,0,v121
s_cbranch_vccnz L_fp_50
L_mg_35:
s_andn2_b32 s62,0x7ff,s54
v_lshl_or_b32 v121,s62,8,v121
s_add_u32 s59,s59,8192
buffer_store_dword v121,v120,s[8:11],s59 offen sc1
s_add_u32 s59,s59,8192
buffer_store_dword v121,v120,s[8:11],s59 offen sc1
s_add_u32 s59,s59,8192
buffer_store_dword v121,v120,s[8:11],s59 offen sc1
s_add_u32 s59,s59,8192
buffer_store_dword v121,v120,s[8:11],s59 offen sc1
s_add_u32 s59,s59,8192
buffer_store_dword v121,v120,s[8:11],s59 offen sc1
s_add_u32 s59,s59,8192
buffer_store_dword v121,v120,s[8:11],s59 offen sc1
L_mo_39:
s_add_u32 s31,s31,1
s_cmp_gt_i32 s77,0
s_cmov_b32 s18,0
s_cbranch_scc1 L_mo_36
s_cmp_lg_u32 s77,0
s_cbranch_scc1 L_mo_40
s_andn2_b32 s51,0x7ff,s54
s_lshr_b32 s51,s51,5
s_add_u32 s73,s73,2
s_mov_b32 s86,1
s_mov_b32 s19,0
s_mov_b32 s18,0
s_waitcnt vmcnt(8)
s_barrier
s_andn2_b32 s64,0x7ff,s54
s_lshl_b32 s56,s64,10
s_add_u32 s58,s56,4194304
buffer_load_dwordx4 v[88:91],v0,s[8:11],s58 offen sc1
v_and_b32 v9,15,v1
v_lshrrev_b32 v10,4,v1
v_and_b32 v124,1,v1
v_lshlrev_b32 v124,4,v124
v_mov_b32 v125,0xffff
v_lshlrev_b32 v125,v124,v125
v_lshrrev_b32 v124,2,v9
v_cmp_eq_u32 vcc,0,v124
s_nop 1
v_cndmask_b32 v12,0,v125,vcc
v_cmp_eq_u32 vcc,1,v124
s_nop 1
v_cndmask_b32 v13,0,v125,vcc
v_and_b32 v124,2,v1
v_cmp_eq_u32 vcc,0,v124
v_mov_b32 v14,0xeeee
v_mov_b32 v124,0x4444
v_cndmask_b32 v14,v14,v124,vcc
v_lshlrev_b32 v11,14,v10
v_lshl_add_u32 v11,v9,4,v11
s_lshl_b32 s65,s51,15
s_add_u32 s65,s65,92274688
s_lshl_b32 s62,s47,10
s_add_u32 s62,s62,s65
s_lshl_b32 s63,s47,16
s_lshl_b32 s60,s46,8
s_add_u32 s63,s63,s60
s_mov_b32 s4,s38
s_mov_b32 s5,s39
s_mov_b32 s6,1835008
s_mov_b32 s7,0x20000
s_lshl_b32 s57,s46,11
s_add_u32 s57,s57,139264
v_add_u32 v8,s57,v0
v_and_b32 v2,1,v10
v_lshrrev_b32 v3,1,v10
v_lshlrev_b32 v2,7,v2
v_lshl_add_u32 v2,v3,10,v2
s_lshl_b32 s59,s46,8
s_add_u32 s59,s57,s59
v_add_u32 v2,s59,v2
s_mov_b32 s60,0x01000100
s_mov_b32 s61,0x03020302
s_waitcnt vmcnt(0)
L_mx_51:
v_max3_u32 v124,v88,v89,v90
v_max_u32 v124,v91,v124
v_cmp_eq_u32 vcc,-1,v124
s_cbranch_vccz L_mxd_52
buffer_load_dwordx4 v[88:91],v0,s[8:11],s58 offen sc1
s_sub_u32 s49,s49,1
s_cbranch_scc1 L_abort
s_waitcnt vmcnt(0)
s_branch L_mx_51
L_mxd_52:
buffer_load_dwordx4 v[24:27],v11,s[4:7],s63 offen offset:0
buffer_load_dwordx4 v[28:31],v11,s[4:7],s63 offen offset:1024
buffer_load_dwordx4 v[32:35],v11,s[4:7],s63 offen offset:2048
buffer_load_dwordx4 v[36:39],v11,s[4:7],s63 offen offset:3072
v_lshlrev_b32 v96,16,v88
v_and_b32 v97,0xffff0000,v88
v_lshlrev_b32 v98,16,v89
v_and_b32 v99,0xffff0000,v89
v_lshlrev_b32 v100,16,v90
v_and_b32 v101,0xffff0000,v90
v_lshlrev_b32 v102,16,v91
v_and_b32 v103,0xffff0000,v91
v_readfirstlane_b32 s78,v96
s_nop 1
v_pk_add_f32 v[108:109],v[96:97],s[78:79] op_sel_hi:[1,0] neg_lo:[0,1] neg_hi:[0,1]
v_pk_add_f32 v[110:111],v[98:99],s[78:79] op_sel_hi:[1,0] neg_lo:[0,1] neg_hi:[0,1]
v_pk_add_f32 v[112:113],v[100:101],s[78:79] op_sel_hi:[1,0] neg_lo:[0,1] neg_hi:[0,1]
v_pk_add_f32 v[114:115],v[102:103],s[78:79] op_sel_hi:[1,0] neg_lo:[0,1] neg_hi:[0,1]
v_pk_add_f32 v[116:117],v[108:109],v[110:111]
v_pk_mul_f32 v[118:119],v[108:109],v[108:109]
v_pk_add_f32 v[120:121],v[112:113],v[114:115]
v_pk_fma_f32 v[118:119],v[110:111],v[110:111],v[118:119]
v_pk_add_f32 v[116:117],v[116:117],v[120:121]
v_pk_fma_f32 v[118:119],v[112:113],v[112:113],v[118:119]
v_add_f32 v116,v116,v117
v_pk_fma_f32 v[118:119],v[114:115],v[114:115],v[118:119]
v_add_f32 v118,v118,v119
s_nop 1
v_permlane32_swap_b32 v116,v118
v_add_f32 v116,v116,v118
s_nop 1
v_add_f32_dpp v116,v116,v116 row_ror:8 row_mask:0xf bank_mask:0xf
s_nop 1
v_add_f32_dpp v116,v116,v116 row_ror:4 row_mask:0xf bank_mask:0xf
s_nop 1
v_add_f32_dpp v116,v116,v116 row_ror:2 row_mask:0xf bank_mask:0xf
s_nop 1
v_add_f32_dpp v116,v116,v116 row_ror:1 row_mask:0xf bank_mask:0xf
v_mov_b32 v118,v116
s_nop 1
v_permlane16_swap_b32 v116,v118
v_add_f32 v116,v116,v118
v_mul_f32 v116,0x3b000000,v116
v_mov_b32 v118,v116
s_nop 1
v_permlane32_swap_b32 v116,v118
v_fma_f32 v118,-v116,v116,v118
v_add_f32 v116,s78,v116
v_max_f32 v118,0,v118
v_cvt_pk_bf16_f32 v118,v116,v118
v_lshlrev_b32 v116,16,v118
v_and_b32 v118,0xffff0000,v118
v_add_f32 v118,0x3727c5ac,v118
v_cvt_pk_bf16_f32 v118,v118,v118
v_and_b32 v118,0xffff0000,v118
v_sqrt_f32 v118,v118
v_pk_add_f32 v[108:109],v[96:97],v[116:117] op_sel_hi:[1,0] neg_lo:[0,1] neg_hi:[0,1]
v_pk_add_f32 v[110:111],v[98:99],v[116:117] op_sel_hi:[1,0] neg_lo:[0,1] neg_hi:[0,1]
v_pk_add_f32 v[112:113],v[100:101],v[116:117] op_sel_hi:[1,0] neg_lo:[0,1] neg_hi:[0,1]
v_pk_add_f32 v[114:115],v[102:103],v[116:117] op_sel_hi:[1,0] neg_lo:[0,1] neg_hi:[0,1]
v_cvt_pk_bf16_f32 v118,v118,v118
v_and_b32 v118,0xffff0000,v118
v_rcp_f32 v118,v118
v_cvt_pk_bf16_f32 v104,v108,v109
v_cvt_pk_bf16_f32 v105,v110,v111
v_cvt_pk_bf16_f32 v106,v112,v113
v_cvt_pk_bf16_f32 v107,v114,v115
v_lshlrev_b32 v108,16,v104
v_and_b32 v109,0xffff0000,v104
v_lshlrev_b32 v110,16,v105
v_and_b32 v111,0xffff0000,v105
v_lshlrev_b32 v112,16,v106
v_and_b32 v113,0xffff0000,v106
v_lshlrev_b32 v114,16,v107
v_and_b32 v115,0xffff0000,v107
v_pk_mul_f32 v[108:109],v[108:109],v[118:119] op_sel_hi:[1,0]
v_pk_mul_f32 v[110:111],v[110:111],v[118:119] op_sel_hi:[1,0]
v_pk_mul_f32 v[112:113],v[112:113],v[118:119] op_sel_hi:[1,0]
v_pk_mul_f32 v[114:115],v[114:115],v[118:119] op_sel_hi:[1,0]
v_cvt_pk_bf16_f32 v104,v108,v109
v_cvt_pk_bf16_f32 v105,v110,v111
v_cvt_pk_bf16_f32 v106,v112,v113
v_cvt_pk_bf16_f32 v107,v114,v115
v_perm_b32 v88,v104,v104,s60
v_perm_b32 v89,v105,v105,s60
v_perm_b32 v90,v106,v106,s60
v_perm_b32 v91,v107,v107,s60
ds_write_b128 v8,v[88:91]
v_perm_b32 v92,v104,v104,s61
v_perm_b32 v93,v105,v105,s61
v_perm_b32 v94,v106,v106,s61
v_perm_b32 v95,v107,v107,s61
ds_write_b128 v8,v[92:95] offset:1024
s_mov_b32 s58,s57
ds_read_b128 v[88:91],v2 offset:0
ds_read_b128 v[92:95],v2 offset:64
ds_read_b128 v[108:111],v18 offset:0
ds_read_b128 v[112:115],v18 offset:1024
ds_read_b128 v[64:67],v18 offset:2048
ds_read_b128 v[68:71],v18 offset:3072
ds_read_b128 v[72:75],v18 offset:4096
ds_read_b128 v[76:79],v18 offset:5120
ds_read_b128 v[80:83],v18 offset:6144
ds_read_b128 v[84:87],v18 offset:7168
v_mov_b64 v[116:117],0
v_mov_b64 v[118:119],0
s_waitcnt lgkmcnt(8)
v_and_b32 v120,v12,v88
v_and_b32 v121,v13,v88
v_and_b32 v122,v12,v92
v_and_b32 v123,v13,v92
s_waitcnt lgkmcnt(6)
s_nop 0
v_smfmac_f32_16x16x64_bf16 v[116:119],v[120:123],v[108:115],v14
ds_read_b128 v[108:111],v18 offset:8192
ds_read_b128 v[112:115],v18 offset:9216
s_add_u32 s63,s63,4096
buffer_load_dwordx4 v[40:43],v11,s[4:7],s63 offen offset:0
v_and_b32 v124,v12,v89
v_and_b32 v125,v13,v89
v_and_b32 v126,v12,v93
v_and_b32 v127,v13,v93
s_waitcnt lgkmcnt(6)
s_nop 0
v_smfmac_f32_16x16x64_bf16 v[116:119],v[124:127],v[64:71],v14
ds_read_b128 v[64:67],v18 offset:10240
ds_read_b128 v[68:71],v18 offset:11264
buffer_load_dwordx4 v[44:47],v11,s[4:7],s63 offen offset:1024
v_and_b32 v120,v12,v90
v_and_b32 v121,v13,v90
v_and_b32 v122,v12,v94
v_and_b32 v123,v13,v94
s_waitcnt lgkmcnt(6)
s_nop 0
v_smfmac_f32_16x16x64_bf16 v[116:119],v[120:123],v[72:79],v14
ds_read_b128 v[72:75],v18 offset:12288
ds_read_b128 v[76:79],v18 offset:13312
buffer_load_dwordx4 v[48:51],v11,s[4:7],s63 offen offset:2048
v_and_b32 v124,v12,v91
v_and_b32 v125,v13,v91
v_and_b32 v126,v12,v95
v_and_b32 v127,v13,v95
ds_read_b128 v[88:91],v2 offset:16
ds_read_b128 v[92:95],v2 offset:80
s_waitcnt lgkmcnt(8)
v_smfmac_f32_16x16x64_bf16 v[116:119],v[124:127],v[80:87],v14
ds_read_b128 v[80:83],v18 offset:14336
ds_read_b128 v[84:87],v18 offset:15360
buffer_load_dwordx4 v[52:55],v11,s[4:7],s63 offen offset:3072
s_waitcnt lgkmcnt(2)
v_and_b32 v120,v12,v88
v_and_b32 v121,v13,v88
v_and_b32 v122,v12,v92
v_and_b32 v123,v13,v92
s_waitcnt lgkmcnt(8)
s_nop 0
v_smfmac_f32_16x16x64_bf16 v[116:119],v[120:123],v[108:115],v14
ds_read_b128 v[108:111],v18 offset:16384
ds_read_b128 v[112:115],v18 offset:17408
s_add_u32 s63,s63,4096
buffer_load_dwordx4 v[56:59],v11,s[4:7],s63 offen offset:0
v_and_b32 v124,v12,v89
v_and_b32 v125,v13,v89
v_and_b32 v126,v12,v93
v_and_b32 v127,v13,v93
s_waitcnt lgkmcnt(8)
s_nop 0
v_smfmac_f32_16x16x64_bf16 v[116:119],v[124:127],v[64:71],v14
ds_read_b128 v[64:67],v18 offset:18432
ds_read_b128 v[68:71],v18 offset:19456
buffer_load_dwordx4 v[60:63],v11,s[4:7],s63 offen offset:1024
v_and_b32 v120,v12,v90
v_and_b32 v121,v13,v90
v_and_b32 v122,v12,v94
v_and_b32 v123,v13,v94
s_waitcnt lgkmcnt(8)
s_nop 0
v_smfmac_f32_16x16x64_bf16 v[116:119],v[120:123],v[72:79],v14
ds_read_b128 v[72:75],v18 offset:20480
ds_read_b128 v[76:79],v18 offset:21504
buffer_load_dword v15,v0,s[8:11],s62 offen
v_and_b32 v124,v12,v91
v_and_b32 v125,v13,v91
v_and_b32 v126,v12,v95
v_and_b32 v127,v13,v95
ds_read_b128 v[88:91],v2 offset:32
ds_read_b128 v[92:95],v2 offset:96
s_waitcnt lgkmcnt(8)
v_smfmac_f32_16x16x64_bf16 v[116:119],v[124:127],v[80:87],v14
ds_read_b128 v[80:83],v18 offset:22528
ds_read_b128 v[84:87],v18 offset:23552
s_waitcnt lgkmcnt(2)
v_and_b32 v120,v12,v88
v_and_b32 v121,v13,v88
v_and_b32 v122,v12,v92
v_and_b32 v123,v13,v92
s_waitcnt lgkmcnt(8)
s_nop 0
v_smfmac_f32_16x16x64_bf16 v[116:119],v[120:123],v[108:115],v14
ds_read_b128 v[108:111],v18 offset:24576
ds_read_b128 v[112:115],v18 offset:25600
v_and_b32 v124,v12,v89
v_and_b32 v125,v13,v89
v_and_b32 v126,v12,v93
v_and_b32 v127,v13,v93
s_waitcnt lgkmcnt(8)
s_nop 0
v_smfmac_f32_16x16x64_bf16 v[116:119],v[124:127],v[64:71],v14
ds_read_b128 v[64:67],v18 offset:26624
ds_read_b128 v[68:71],v18 offset:27648
v_and_b32 v120,v12,v90
v_and_b32 v121,v13,v90
v_and_b32 v122,v12,v94
v_and_b32 v123,v13,v94
s_waitcnt lgkmcnt(8)
s_nop 0
v_smfmac_f32_16x16x64_bf16 v[116:119],v[120:123],v[72:79],v14
ds_read_b128 v[72:75],v18 offset:28672
ds_read_b128 v[76:79],v18 offset:29696
v_and_b32 v124,v12,v91
v_and_b32 v125,v13,v91
v_and_b32 v126,v12,v95
v_and_b32 v127,v13,v95
ds_read_b128 v[88:91],v2 offset:48
ds_read_b128 v[92:95],v2 offset:112
s_waitcnt lgkmcnt(8)
v_smfmac_f32_16x16x64_bf16 v[116:119],v[124:127],v[80:87],v14
ds_read_b128 v[80:83],v18 offset:30720
ds_read_b128 v[84:87],v18 offset:31744
s_waitcnt lgkmcnt(2)
v_and_b32 v120,v12,v88
v_and_b32 v121,v13,v88
v_and_b32 v122,v12,v92
v_and_b32 v123,v13,v92
s_waitcnt lgkmcnt(8)
s_nop 0
v_smfmac_f32_16x16x64_bf16 v[116:119],v[120:123],v[108:115],v14
v_and_b32 v124,v12,v89
v_and_b32 v125,v13,v89
v_and_b32 v126,v12,v93
v_and_b32 v127,v13,v93
s_waitcnt lgkmcnt(6)
s_nop 0
v_smfmac_f32_16x16x64_bf16 v[116:119],v[124:127],v[64:71],v14
buffer_load_dwordx4 v[64:67],v11,s[4:7],s63 offen offset:2048
buffer_load_dwordx4 v[68:71],v11,s[4:7],s63 offen offset:3072
v_and_b32 v120,v12,v90
v_and_b32 v121,v13,v90
v_and_b32 v122,v12,v94
v_and_b32 v123,v13,v94
s_waitcnt lgkmcnt(4)
s_nop 0
v_smfmac_f32_16x16x64_bf16 v[116:119],v[120:123],v[72:79],v14
s_add_u32 s63,s63,4096
buffer_load_dwordx4 v[72:75],v11,s[4:7],s63 offen offset:0
buffer_load_dwordx4 v[76:79],v11,s[4:7],s63 offen offset:1024
v_and_b32 v124,v12,v91
v_and_b32 v125,v13,v91
v_and_b32 v126,v12,v95
v_and_b32 v127,v13,v95
s_waitcnt lgkmcnt(0)
s_nop 0
v_smfmac_f32_16x16x64_bf16 v[116:119],v[124:127],v[80:87],v14
buffer_load_dwordx4 v[80:83],v11,s[4:7],s63 offen offset:2048
buffer_load_dwordx4 v[84:87],v11,s[4:7],s63 offen offset:3072
v_lshlrev_b32 v8,5,v9
v_and_b32 v124,1,v10
v_lshl_add_u32 v8,v124,4,v8
v_lshrrev_b32 v124,1,v10
v_lshl_add_u32 v8,v124,11,v8
s_lshl_b32 s60,s46,9
s_add_u32 s60,s60,147456
v_add_u32 v8,s60,v8
ds_write_b128 v8,v[116:119]
v_lshlrev_b32 v8,2,v1
v_add_u32 v8,147456,v8
v_and_b32 v2,1,v1
v_lshrrev_b32 v3,1,v1
v_lshlrev_b32 v3,2,v3
v_lshl_add_u32 v2,v2,7,v3
v_add_u32 v2,s58,v2
v_lshlrev_b32 v3,6,v10
v_add_u32 v3,s58,v3
s_waitcnt lgkmcnt(0)
s_barrier
ds_read2st64_b32 v[88:89],v8 offset0:0 offset1:1
ds_read2st64_b32 v[90:91],v8 offset0:2 offset1:3
ds_read2st64_b32 v[92:93],v8 offset0:4 offset1:5
ds_read2st64_b32 v[94:95],v8 offset0:6 offset1:7
s_waitcnt lgkmcnt(0)
v_pk_add_f32 v[88:89],v[88:89],v[90:91]
v_pk_add_f32 v[92:93],v[92:93],v[94:95]
v_pk_add_f32 v[88:89],v[88:89],v[92:93]
v_cvt_pk_bf16_f32 v88,v88,v88
v_and_b32 v88,0xffff0000,v88
v_cvt_pk_bf16_f32 v89,v89,v89
v_and_b32 v89,0xffff0000,v89
v_mul_f32 v90,0xbfb8aa3b,v88
v_exp_f32 v90,v90
s_nop 0
v_add_f32 v90,1.0,v90
v_rcp_f32 v90,v90
s_nop 0
v_mul_f32 v88,v88,v90
v_cvt_pk_bf16_f32 v88,v88,v88
v_and_b32 v88,0xffff0000,v88
v_mul_f32 v88,v88,v89
v_cvt_pk_bf16_f32 v88,v88,v88
ds_write_b32 v2,v88
ds_read_b128 v[88:91],v3
ds_read_b128 v[108:111],v3 offset:32
ds_read_b128 v[92:95],v3 offset:16
ds_read_b128 v[112:115],v3 offset:48
v_mov_b64 v[116:117],0
v_mov_b64 v[118:119],0
s_waitcnt vmcnt(0) lgkmcnt(0)
v_and_b32 v120,v12,v88
v_and_b32 v121,v13,v88
v_and_b32 v122,v12,v108
v_and_b32 v123,v13,v108
v_and_b32 v124,v12,v89
v_and_b32 v125,v13,v89
v_smfmac_f32_16x16x64_bf16 v[116:119],v[120:123],v[24:31],v14
v_and_b32 v126,v12,v109
v_and_b32 v127,v13,v109
v_and_b32 v120,v12,v90
v_and_b32 v121,v13,v90
v_smfmac_f32_16x16x64_bf16 v[116:119],v[124:127],v[32:39],v14
v_and_b32 v122,v12,v110
v_and_b32 v123,v13,v110
v_and_b32 v124,v12,v91
v_and_b32 v125,v13,v91
v_smfmac_f32_16x16x64_bf16 v[116:119],v[120:123],v[40:47],v14
v_and_b32 v126,v12,v111
v_and_b32 v127,v13,v111
v_and_b32 v120,v12,v92
v_and_b32 v121,v13,v92
v_smfmac_f32_16x16x64_bf16 v[116:119],v[124:127],v[48:55],v14
v_and_b32 v122,v12,v112
v_and_b32 v123,v13,v112
v_and_b32 v124,v12,v93
v_and_b32 v125,v13,v93
v_smfmac_f32_16x16x64_bf16 v[116:119],v[120:123],v[56:63],v14
v_and_b32 v126,v12,v113
v_and_b32 v127,v13,v113
v_and_b32 v120,v12,v94
v_and_b32 v121,v13,v94
v_smfmac_f32_16x16x64_bf16 v[116:119],v[124:127],v[64:71],v14
v_and_b32 v122,v12,v114
v_and_b32 v123,v13,v114
v_and_b32 v124,v12,v95
v_and_b32 v125,v13,v95
v_smfmac_f32_16x16x64_bf16 v[116:119],v[120:123],v[72:79],v14
v_and_b32 v126,v12,v115
v_and_b32 v127,v13,v115
s_nop 1
v_smfmac_f32_16x16x64_bf16 v[116:119],v[124:127],v[80:87],v14
v_lshlrev_b32 v8,4,v9
v_and_b32 v124,1,v10
v_lshl_add_u32 v8,v124,3,v8
v_and_b32 v124,2,v10
v_lshl_add_u32 v8,v124,30,v8
s_lshl_b32 s60,s46,8
s_add_u32 s59,s62,s60
s_nop 0
v_cvt_pk_bf16_f32 v88,v116,v117
v_cvt_pk_bf16_f32 v89,v118,v119
buffer_store_dwordx2 v[88:89],v8,s[8:11],s59 offen
s_lshl_b32 s59,s51,13
s_lshl2_add_u32 s59,s47,s59
s_add_u32 s59,s59,10486912
s_waitcnt vmcnt(0)
s_barrier
s_or_b32 s59,s59,s52
buffer_store_dword v17,off,s[8:11],s59
s_lshl_b32 s59,s51,13
s_add_u32 s59,s59,10486912
v_and_b32 v124,31,v1
v_lshlrev_b32 v124,2,v124
L_fw_54:
buffer_load_dword v125,v124,s[8:11],s59 offen sc1
s_sub_u32 s49,s49,1
s_cbranch_scc1 L_abort
s_waitcnt vmcnt(0)
v_cmp_eq_u32 vcc,0,v125
s_cbranch_vccnz L_fw_54
s_add_u32 s63,s65,0
buffer_load_dwordx4 v[24:27],v22,s[8:11],s63 offen sc1
s_add_u32 s63,s65,4096
buffer_load_dwordx4 v[28:31],v22,s[8:11],s63 offen sc1
s_add_u32 s63,s65,8192
buffer_load_dwordx4 v[32:35],v22,s[8:11],s63 offen sc1
s_add_u32 s63,s65,12288
buffer_load_dwordx4 v[36:39],v22,s[8:11],s63 offen sc1
s_add_u32 s63,s65,16384
buffer_load_dwordx4 v[40:43],v22,s[8:11],s63 offen sc1
s_add_u32 s63,s65,20480
buffer_load_dwordx4 v[44:47],v22,s[8:11],s63 offen sc1
s_add_u32 s63,s65,24576
buffer_load_dwordx4 v[48:51],v22,s[8:11],s63 offen sc1
s_add_u32 s63,s65,28672
buffer_load_dwordx4 v[52:55],v22,s[8:11],s63 offen sc1
v_and_b32 v64,15,v1
v_and_b32 v65,1,v1
v_lshlrev_b32 v65,4,v65
v_mov_b32 v66,0x3f80
v_lshlrev_b32 v66,v65,v66
v_lshrrev_b32 v64,1,v64
v_cmp_eq_u32 vcc,0,v64
s_nop 1
v_cndmask_b32 v56,0,v66,vcc
v_cmp_eq_u32 vcc,1,v64
s_nop 1
v_cndmask_b32 v57,0,v66,vcc
v_cmp_eq_u32 vcc,2,v64
s_nop 1
v_cndmask_b32 v58,0,v66,vcc
v_cmp_eq_u32 vcc,3,v64
s_nop 1
v_cndmask_b32 v59,0,v66,vcc
s_waitcnt vmcnt(7)
s_nop 0
v_mfma_f32_16x16x32_bf16 v[60:63],v[56:59],v[24:27],0
s_waitcnt vmcnt(6)
v_mfma_f32_16x16x32_bf16 v[60:63],v[56:59],v[28:31],v[60:63]
s_waitcnt vmcnt(5)
v_mfma_f32_16x16x32_bf16 v[60:63],v[56:59],v[32:35],v[60:63]
s_waitcnt vmcnt(4)
v_mfma_f32_16x16x32_bf16 v[60:63],v[56:59],v[36:39],v[60:63]
s_waitcnt vmcnt(3)
v_mfma_f32_16x16x32_bf16 v[60:63],v[56:59],v[40:43],v[60:63]
s_waitcnt vmcnt(2)
v_mfma_f32_16x16x32_bf16 v[60:63],v[56:59],v[44:47],v[60:63]
s_waitcnt vmcnt(1)
v_mfma_f32_16x16x32_bf16 v[60:63],v[56:59],v[48:51],v[60:63]
s_waitcnt vmcnt(0)
v_mfma_f32_16x16x32_bf16 v[60:63],v[56:59],v[52:55],v[60:63]
s_nop 7
ds_write_b128 v21,v[60:63]
s_waitcnt lgkmcnt(0)
s_barrier
s_cmp_lg_u32 s46,0
s_cbranch_scc1 L_moed_53
v_lshlrev_b32 v56,5,v1
v_add_u32 v56,155648,v56
ds_read_b128 v[24:27],v56
ds_read_b128 v[28:31],v56 offset:16
s_and_b32 s59,s54,0xffff0000
s_xor_b32 s60,s59,0x80000000
s_xor_b32 s61,s59,0xffff0000
s_cmp_lt_i32 s59,0
s_cselect_b32 s59,s60,s61
v_mov_b32 v56,s59
v_mul_f32 v56,0xbfb8aa3b,v56
v_exp_f32 v56,v56
s_nop 0
v_add_f32 v56,1.0,v56
v_rcp_f32 v56,v56
s_nop 0
v_cvt_pk_bf16_f32 v56,v56,v56
v_and_b32 v56,0xffff0000,v56
v_lshlrev_b32 v48,16,v104
v_and_b32 v49,0xffff0000,v104
v_lshlrev_b32 v50,16,v105
v_and_b32 v51,0xffff0000,v105
v_lshlrev_b32 v52,16,v106
v_and_b32 v53,0xffff0000,v106
v_lshlrev_b32 v54,16,v107
v_and_b32 v55,0xffff0000,v107
s_waitcnt lgkmcnt(0)
v_cvt_pk_bf16_f32 v40,v24,v25
v_cvt_pk_bf16_f32 v41,v26,v27
v_cvt_pk_bf16_f32 v42,v28,v29
v_cvt_pk_bf16_f32 v43,v30,v31
v_lshlrev_b32 v24,16,v40
v_and_b32 v25,0xffff0000,v40
v_lshlrev_b32 v26,16,v41
v_and_b32 v27,0xffff0000,v41
v_lshlrev_b32 v28,16,v42
v_and_b32 v29,0xffff0000,v42
v_lshlrev_b32 v30,16,v43
v_and_b32 v31,0xffff0000,v43
v_pk_mul_f32 v[24:25],v[24:25],v[56:57] op_sel_hi:[1,0]
v_pk_mul_f32 v[26:27],v[26:27],v[56:57] op_sel_hi:[1,0]
v_pk_mul_f32 v[28:29],v[28:29],v[56:57] op_sel_hi:[1,0]
v_pk_mul_f32 v[30:31],v[30:31],v[56:57] op_sel_hi:[1,0]
v_cvt_pk_bf16_f32 v40,v24,v25
v_cvt_pk_bf16_f32 v41,v26,v27
v_cvt_pk_bf16_f32 v42,v28,v29
v_cvt_pk_bf16_f32 v43,v30,v31
v_lshlrev_b32 v24,16,v40
v_and_b32 v25,0xffff0000,v40
v_lshlrev_b32 v26,16,v41
v_and_b32 v27,0xffff0000,v41
v_lshlrev_b32 v28,16,v42
v_and_b32 v29,0xffff0000,v42
v_lshlrev_b32 v30,16,v43
v_and_b32 v31,0xffff0000,v43
v_pk_add_f32 v[24:25],v[24:25],v[48:49]
v_pk_add_f32 v[26:27],v[26:27],v[50:51]
v_pk_add_f32 v[28:29],v[28:29],v[52:53]
v_pk_add_f32 v[30:31],v[30:31],v[54:55]
v_cvt_pk_bf16_f32 v40,v24,v25
v_cvt_pk_bf16_f32 v41,v26,v27
v_cvt_pk_bf16_f32 v42,v28,v29
v_cvt_pk_bf16_f32 v43,v30,v31
v_lshlrev_b32 v24,16,v40
v_and_b32 v25,0xffff0000,v40
v_lshlrev_b32 v26,16,v41
v_and_b32 v27,0xffff0000,v41
v_lshlrev_b32 v28,16,v42
v_and_b32 v29,0xffff0000,v42
v_lshlrev_b32 v30,16,v43
v_and_b32 v31,0xffff0000,v43
v_pk_add_f32 v[96:97],v[96:97],v[24:25]
v_pk_add_f32 v[98:99],v[98:99],v[26:27]
v_pk_add_f32 v[100:101],v[100:101],v[28:29]
v_pk_add_f32 v[102:103],v[102:103],v[30:31]
v_cvt_pk_bf16_f32 v80,v96,v97
v_cvt_pk_bf16_f32 v81,v98,v99
v_cvt_pk_bf16_f32 v82,v100,v101
v_cvt_pk_bf16_f32 v83,v102,v103
v_lshlrev_b32 v96,16,v80
v_and_b32 v97,0xffff0000,v80
v_lshlrev_b32 v98,16,v81
v_and_b32 v99,0xffff0000,v81
v_lshlrev_b32 v100,16,v82
v_and_b32 v101,0xffff0000,v82
v_lshlrev_b32 v102,16,v83
v_and_b32 v103,0xffff0000,v83
v_readfirstlane_b32 s78,v96
s_nop 1
v_pk_add_f32 v[58:59],v[96:97],s[78:79] op_sel_hi:[1,0] neg_lo:[0,1] neg_hi:[0,1]
v_pk_add_f32 v[60:61],v[98:99],s[78:79] op_sel_hi:[1,0] neg_lo:[0,1] neg_hi:[0,1]
v_pk_add_f32 v[62:63],v[100:101],s[78:79] op_sel_hi:[1,0] neg_lo:[0,1] neg_hi:[0,1]
v_pk_add_f32 v[64:65],v[102:103],s[78:79] op_sel_hi:[1,0] neg_lo:[0,1] neg_hi:[0,1]
v_pk_add_f32 v[66:67],v[58:59],v[60:61]
v_pk_mul_f32 v[68:69],v[58:59],v[58:59]
v_pk_add_f32 v[70:71],v[62:63],v[64:65]
v_pk_fma_f32 v[68:69],v[60:61],v[60:61],v[68:69]
v_pk_add_f32 v[66:67],v[66:67],v[70:71]
v_pk_fma_f32 v[68:69],v[62:63],v[62:63],v[68:69]
v_add_f32 v66,v66,v67
v_pk_fma_f32 v[68:69],v[64:65],v[64:65],v[68:69]
v_add_f32 v68,v68,v69
s_nop 1
v_permlane32_swap_b32 v66,v68
v_add_f32 v66,v66,v68
s_nop 1
v_add_f32_dpp v66,v66,v66 row_ror:8 row_mask:0xf bank_mask:0xf
s_nop 1
v_add_f32_dpp v66,v66,v66 row_ror:4 row_mask:0xf bank_mask:0xf
s_nop 1
v_add_f32_dpp v66,v66,v66 row_ror:2 row_mask:0xf bank_mask:0xf
s_nop 1
v_add_f32_dpp v66,v66,v66 row_ror:1 row_mask:0xf bank_mask:0xf
v_mov_b32 v68,v66
s_nop 1
v_permlane16_swap_b32 v66,v68
v_add_f32 v66,v66,v68
v_mul_f32 v66,0x3b000000,v66
v_mov_b32 v68,v66
s_nop 1
v_permlane32_swap_b32 v66,v68
v_fma_f32 v68,-v66,v66,v68
v_add_f32 v66,s78,v66
v_max_f32 v68,0,v68
v_cvt_pk_bf16_f32 v68,v66,v68
v_lshlrev_b32 v66,16,v68
v_and_b32 v68,0xffff0000,v68
v_add_f32 v68,0x3727c5ac,v68
v_cvt_pk_bf16_f32 v68,v68,v68
v_and_b32 v68,0xffff0000,v68
v_sqrt_f32 v68,v68
v_pk_add_f32 v[58:59],v[96:97],v[66:67] op_sel_hi:[1,0] neg_lo:[0,1] neg_hi:[0,1]
v_pk_add_f32 v[60:61],v[98:99],v[66:67] op_sel_hi:[1,0] neg_lo:[0,1] neg_hi:[0,1]
v_pk_add_f32 v[62:63],v[100:101],v[66:67] op_sel_hi:[1,0] neg_lo:[0,1] neg_hi:[0,1]
v_pk_add_f32 v[64:65],v[102:103],v[66:67] op_sel_hi:[1,0] neg_lo:[0,1] neg_hi:[0,1]
v_cvt_pk_bf16_f32 v68,v68,v68
v_and_b32 v68,0xffff0000,v68
v_rcp_f32 v68,v68
v_cvt_pk_bf16_f32 v84,v58,v59
v_cvt_pk_bf16_f32 v85,v60,v61
v_cvt_pk_bf16_f32 v86,v62,v63
v_cvt_pk_bf16_f32 v87,v64,v65
v_lshlrev_b32 v58,16,v84
v_and_b32 v59,0xffff0000,v84
v_lshlrev_b32 v60,16,v85
v_and_b32 v61,0xffff0000,v85
v_lshlrev_b32 v62,16,v86
v_and_b32 v63,0xffff0000,v86
v_lshlrev_b32 v64,16,v87
v_and_b32 v65,0xffff0000,v87
v_pk_mul_f32 v[58:59],v[58:59],v[68:69] op_sel_hi:[1,0]
v_pk_mul_f32 v[60:61],v[60:61],v[68:69] op_sel_hi:[1,0]
v_pk_mul_f32 v[62:63],v[62:63],v[68:69] op_sel_hi:[1,0]
v_pk_mul_f32 v[64:65],v[64:65],v[68:69] op_sel_hi:[1,0]
v_cvt_pk_bf16_f32 v84,v58,v59
v_cvt_pk_bf16_f32 v85,v60,v61
v_cvt_pk_bf16_f32 v86,v62,v63
v_cvt_pk_bf16_f32 v87,v64,v65
s_lshl_b32 s58,s51,10
s_add_u32 s58,s58,11272192
s_add_u32 s59,s58,65536
s_cmp_eq_u32 s47,0
s_cselect_b32 s59,s59,0x80000000
s_add_u32 s57,s56,98566144
buffer_store_dwordx4 v[84:87],v0,s[8:11],s59 offen sc1
buffer_store_dwordx4 v[80:83],v0,s[8:11],s58 offen sc1
buffer_store_dwordx4 v[84:87],v0,s[8:11],s57 offen sc1
L_moed_53:
s_barrier
L_mo_40:
s_mov_b32 s77,-1
s_cmp_lt_u32 s31,64
s_cbranch_scc1 L_mo_36
s_cmp_eq_u32 s86,0
s_cbranch_scc1 L_mo_49
L_mo_42:
s_andn2_b32 s51,0x7ff,s54
s_lshr_b32 s51,s51,5
s_andn2_b32 s56,31,s54
v_lshrrev_b32 v2,10,v20
v_add_u32 v3,16,v2
v_add_u32 v8,96468992,v20
v_cmp_eq_u32 vcc,s56,v2
s_nop 1
v_cndmask_b32 v2,v20,v8,vcc
v_cmp_eq_u32 vcc,s56,v3
s_nop 1
v_cndmask_b32 v3,v20,v8,vcc
s_waitcnt vmcnt(0)
s_lshl_b32 s59,s51,13
s_add_u32 s59,s59,10487552
s_cmp_lg_u32 s46,0
s_cbranch_scc1 L_fd_58
v_and_b32 v124,31,v1
v_lshlrev_b32 v124,2,v124
s_branch L_ff_59
L_fw_57:
s_sleep 2
L_ff_59:
buffer_load_dword v125,v124,s[8:11],s59 offen sc1
s_sub_u32 s49,s49,1
s_cbranch_scc1 L_abort
s_waitcnt vmcnt(0)
v_cmp_eq_u32 vcc,0,v125
s_cbranch_vccnz L_fw_57
L_fd_58:
s_barrier
s_or_b32 s72,s72,s52
buffer_store_dword v17,off,s[8:11],s72 sc1
s_lshl_b32 s66,s51,15
s_add_u32 s66,s66,2097152
s_add_u32 s67,s66,16384
s_add_u32 m0,s50,131072
s_nop 0
buffer_load_dwordx4 v2,s[8:11],s66 offen offset:0 sc1 lds
s_add_u32 m0,s50,135168
s_nop 0
buffer_load_dwordx4 v3,s[8:11],s67 offen offset:0 sc1 lds
s_add_u32 m0,s50,139008
s_nop 0
buffer_load_dwordx4 v2,s[8:11],s66 offen offset:256 sc1 lds
s_add_u32 m0,s50,143104
s_nop 0
buffer_load_dwordx4 v3,s[8:11],s67 offen offset:256 sc1 lds
s_add_u32 m0,s50,146944
s_nop 0
buffer_load_dwordx4 v2,s[8:11],s66 offen offset:512 sc1 lds
s_add_u32 m0,s50,151040
s_nop 0
buffer_load_dwordx4 v3,s[8:11],s67 offen offset:512 sc1 lds
s_waitcnt vmcnt(4)
s_barrier
ds_read_b128 v[104:107],v4 offset:0
ds_read_b128 v[108:111],v4 offset:4096
ds_read_b128 v[112:115],v5 offset:0
ds_read_b128 v[116:119],v5 offset:4096
s_add_u32 m0,s50,154880
s_nop 0
buffer_load_dwordx4 v2,s[8:11],s66 offen offset:768 sc1 lds
s_add_u32 m0,s50,158976
s_nop 0
buffer_load_dwordx4 v3,s[8:11],s67 offen offset:768 sc1 lds
s_waitcnt lgkmcnt(2)
v_mfma_f32_16x16x32_bf16 v[24:27],a[128:131],v[104:107],0
ds_read_b128 v[120:123],v6 offset:0
v_mfma_f32_16x16x32_bf16 v[40:43],v[104:107],v[128:131],0
s_lshl_b32 s58,s51,5
v_mfma_f32_16x16x32_bf16 v[28:31],a[128:131],v[108:111],0
ds_read_b128 v[124:127],v6 offset:4096
v_mfma_f32_16x16x32_bf16 v[44:47],v[108:111],v[128:131],0
s_add_u32 s58,s58,s47
v_mfma_f32_16x16x32_bf16 v[32:35],a[136:139],v[104:107],0
s_mul_i32 s58,s58,24576
v_mfma_f32_16x16x32_bf16 v[48:51],v[104:107],v[136:139],0
s_add_u32 s58,s58,201326592
v_mfma_f32_16x16x32_bf16 v[36:39],a[136:139],v[108:111],0
s_add_u32 s61,s58,s50
v_mfma_f32_16x16x32_bf16 v[52:55],v[108:111],v[136:139],0
s_add_u32 s62,s61,4096
s_waitcnt lgkmcnt(2)
v_mfma_f32_16x16x32_bf16 v[24:27],a[132:135],v[112:115],v[24:27]
ds_read_b128 v[104:107],v7 offset:0
v_mfma_f32_16x16x32_bf16 v[40:43],v[112:115],v[132:135],v[40:43]
s_add_u32 s63,s61,16384
v_mfma_f32_16x16x32_bf16 v[28:31],a[132:135],v[116:119],v[28:31]
ds_read_b128 v[108:111],v7 offset:4096
v_mfma_f32_16x16x32_bf16 v[44:47],v[116:119],v[132:135],v[44:47]
s_add_u32 s64,s61,20480
v_mfma_f32_16x16x32_bf16 v[32:35],a[140:143],v[112:115],v[32:35]
s_add_u32 s65,s61,s50
v_mfma_f32_16x16x32_bf16 v[48:51],v[112:115],v[140:143],v[48:51]
s_add_u32 s65,s65,8192
v_mfma_f32_16x16x32_bf16 v[36:39],a[140:143],v[116:119],v[36:39]
v_mfma_f32_16x16x32_bf16 v[52:55],v[116:119],v[140:143],v[52:55]
s_waitcnt vmcnt(4)
s_barrier
s_waitcnt lgkmcnt(2)
v_mfma_f32_16x16x32_bf16 v[24:27],a[144:147],v[120:123],v[24:27]
ds_read_b128 v[112:115],v4 offset:8192
v_mfma_f32_16x16x32_bf16 v[40:43],v[120:123],v[144:147],v[40:43]
v_mfma_f32_16x16x32_bf16 v[28:31],a[144:147],v[124:127],v[28:31]
ds_read_b128 v[116:119],v4 offset:12288
v_mfma_f32_16x16x32_bf16 v[44:47],v[124:127],v[144:147],v[44:47]
v_mfma_f32_16x16x32_bf16 v[32:35],a[152:155],v[120:123],v[32:35]
v_mfma_f32_16x16x32_bf16 v[48:51],v[120:123],v[152:155],v[48:51]
v_mfma_f32_16x16x32_bf16 v[36:39],a[152:155],v[124:127],v[36:39]
v_mfma_f32_16x16x32_bf16 v[52:55],v[124:127],v[152:155],v[52:55]
s_waitcnt lgkmcnt(2)
v_mfma_f32_16x16x32_bf16 v[24:27],a[148:151],v[104:107],v[24:27]
ds_read_b128 v[120:123],v5 offset:8192
v_mfma_f32_16x16x32_bf16 v[40:43],v[104:107],v[148:151],v[40:43]
v_mfma_f32_16x16x32_bf16 v[28:31],a[148:151],v[108:111],v[28:31]
ds_read_b128 v[124:127],v5 offset:12288
v_mfma_f32_16x16x32_bf16 v[44:47],v[108:111],v[148:151],v[44:47]
v_mfma_f32_16x16x32_bf16 v[32:35],a[156:159],v[104:107],v[32:35]
v_mfma_f32_16x16x32_bf16 v[48:51],v[104:107],v[156:159],v[48:51]
v_mfma_f32_16x16x32_bf16 v[36:39],a[156:159],v[108:111],v[36:39]
v_mfma_f32_16x16x32_bf16 v[52:55],v[108:111],v[156:159],v[52:55]
s_waitcnt lgkmcnt(2)
v_mfma_f32_16x16x32_bf16 v[24:27],a[160:163],v[112:115],v[24:27]
ds_read_b128 v[104:107],v6 offset:8192
v_mfma_f32_16x16x32_bf16 v[40:43],v[112:115],v[160:163],v[40:43]
v_mfma_f32_16x16x32_bf16 v[28:31],a[160:163],v[116:119],v[28:31]
ds_read_b128 v[108:111],v6 offset:12288
v_mfma_f32_16x16x32_bf16 v[44:47],v[116:119],v[160:163],v[44:47]
v_mfma_f32_16x16x32_bf16 v[32:35],a[168:171],v[112:115],v[32:35]
v_mfma_f32_16x16x32_bf16 v[48:51],v[112:115],v[168:171],v[48:51]
v_mfma_f32_16x16x32_bf16 v[36:39],a[168:171],v[116:119],v[36:39]
v_mfma_f32_16x16x32_bf16 v[52:55],v[116:119],v[168:171],v[52:55]
s_waitcnt lgkmcnt(2)
v_mfma_f32_16x16x32_bf16 v[24:27],a[164:167],v[120:123],v[24:27]
ds_read_b128 v[112:115],v7 offset:8192
v_mfma_f32_16x16x32_bf16 v[40:43],v[120:123],v[164:167],v[40:43]
v_mfma_f32_16x16x32_bf16 v[28:31],a[164:167],v[124:127],v[28:31]
ds_read_b128 v[116:119],v7 offset:12288
v_mfma_f32_16x16x32_bf16 v[44:47],v[124:127],v[164:167],v[44:47]
v_mfma_f32_16x16x32_bf16 v[32:35],a[172:175],v[120:123],v[32:35]
v_mfma_f32_16x16x32_bf16 v[48:51],v[120:123],v[172:175],v[48:51]
v_mfma_f32_16x16x32_bf16 v[36:39],a[172:175],v[124:127],v[36:39]
v_mfma_f32_16x16x32_bf16 v[52:55],v[124:127],v[172:175],v[52:55]
s_waitcnt vmcnt(2)
s_barrier
s_waitcnt lgkmcnt(2)
v_mfma_f32_16x16x32_bf16 v[24:27],a[176:179],v[104:107],v[24:27]
ds_read_b128 v[120:123],v4 offset:16384
v_mfma_f32_16x16x32_bf16 v[40:43],v[104:107],v[176:179],v[40:43]
v_mfma_f32_16x16x32_bf16 v[28:31],a[176:179],v[108:111],v[28:31]
ds_read_b128 v[124:127],v4 offset:20480
v_mfma_f32_16x16x32_bf16 v[44:47],v[108:111],v[176:179],v[44:47]
v_mfma_f32_16x16x32_bf16 v[32:35],a[184:187],v[104:107],v[32:35]
v_mfma_f32_16x16x32_bf16 v[48:51],v[104:107],v[184:187],v[48:51]
v_mfma_f32_16x16x32_bf16 v[36:39],a[184:187],v[108:111],v[36:39]
v_mfma_f32_16x16x32_bf16 v[52:55],v[108:111],v[184:187],v[52:55]
s_waitcnt lgkmcnt(2)
v_mfma_f32_16x16x32_bf16 v[24:27],a[180:183],v[112:115],v[24:27]
ds_read_b128 v[104:107],v5 offset:16384
v_mfma_f32_16x16x32_bf16 v[40:43],v[112:115],v[180:183],v[40:43]
v_mfma_f32_16x16x32_bf16 v[28:31],a[180:183],v[116:119],v[28:31]
ds_read_b128 v[108:111],v5 offset:20480
v_mfma_f32_16x16x32_bf16 v[44:47],v[116:119],v[180:183],v[44:47]
v_mfma_f32_16x16x32_bf16 v[32:35],a[188:191],v[112:115],v[32:35]
v_mfma_f32_16x16x32_bf16 v[48:51],v[112:115],v[188:191],v[48:51]
v_mfma_f32_16x16x32_bf16 v[36:39],a[188:191],v[116:119],v[36:39]
v_mfma_f32_16x16x32_bf16 v[52:55],v[116:119],v[188:191],v[52:55]
s_waitcnt lgkmcnt(2)
v_mfma_f32_16x16x32_bf16 v[24:27],a[192:195],v[120:123],v[24:27]
ds_read_b128 v[112:115],v6 offset:16384
v_mfma_f32_16x16x32_bf16 v[40:43],v[120:123],v[192:195],v[40:43]
v_mfma_f32_16x16x32_bf16 v[28:31],a[192:195],v[124:127],v[28:31]
ds_read_b128 v[116:119],v6 offset:20480
v_mfma_f32_16x16x32_bf16 v[44:47],v[124:127],v[192:195],v[44:47]
v_mfma_f32_16x16x32_bf16 v[32:35],a[200:203],v[120:123],v[32:35]
v_mfma_f32_16x16x32_bf16 v[48:51],v[120:123],v[200:203],v[48:51]
v_mfma_f32_16x16x32_bf16 v[36:39],a[200:203],v[124:127],v[36:39]
v_mfma_f32_16x16x32_bf16 v[52:55],v[124:127],v[200:203],v[52:55]
s_waitcnt lgkmcnt(2)
v_mfma_f32_16x16x32_bf16 v[24:27],a[196:199],v[104:107],v[24:27]
ds_read_b128 v[120:123],v7 offset:16384
v_mfma_f32_16x16x32_bf16 v[40:43],v[104:107],v[196:199],v[40:43]
v_mfma_f32_16x16x32_bf16 v[28:31],a[196:199],v[108:111],v[28:31]
ds_read_b128 v[124:127],v7 offset:20480
v_mfma_f32_16x16x32_bf16 v[44:47],v[108:111],v[196:199],v[44:47]
v_mfma_f32_16x16x32_bf16 v[32:35],a[204:207],v[104:107],v[32:35]
v_mfma_f32_16x16x32_bf16 v[48:51],v[104:107],v[204:207],v[48:51]
v_mfma_f32_16x16x32_bf16 v[36:39],a[204:207],v[108:111],v[36:39]
v_mfma_f32_16x16x32_bf16 v[52:55],v[108:111],v[204:207],v[52:55]
s_waitcnt vmcnt(0)
s_barrier
s_waitcnt lgkmcnt(2)
v_mfma_f32_16x16x32_bf16 v[24:27],a[208:211],v[112:115],v[24:27]
ds_read_b128 v[104:107],v4 offset:24576
v_mfma_f32_16x16x32_bf16 v[40:43],v[112:115],v[208:211],v[40:43]
v_mfma_f32_16x16x32_bf16 v[28:31],a[208:211],v[116:119],v[28:31]
ds_read_b128 v[108:111],v4 offset:28672
v_mfma_f32_16x16x32_bf16 v[44:47],v[116:119],v[208:211],v[44:47]
v_mfma_f32_16x16x32_bf16 v[32:35],a[216:219],v[112:115],v[32:35]
v_mfma_f32_16x16x32_bf16 v[48:51],v[112:115],v[216:219],v[48:51]
v_mfma_f32_16x16x32_bf16 v[36:39],a[216:219],v[116:119],v[36:39]
v_mfma_f32_16x16x32_bf16 v[52:55],v[116:119],v[216:219],v[52:55]
s_waitcnt lgkmcnt(2)
v_mfma_f32_16x16x32_bf16 v[24:27],a[212:215],v[120:123],v[24:27]
ds_read_b128 v[112:115],v5 offset:24576
v_mfma_f32_16x16x32_bf16 v[40:43],v[120:123],v[212:215],v[40:43]
v_mfma_f32_16x16x32_bf16 v[28:31],a[212:215],v[124:127],v[28:31]
ds_read_b128 v[116:119],v5 offset:28672
v_mfma_f32_16x16x32_bf16 v[44:47],v[124:127],v[212:215],v[44:47]
v_mfma_f32_16x16x32_bf16 v[32:35],a[220:223],v[120:123],v[32:35]
v_mfma_f32_16x16x32_bf16 v[48:51],v[120:123],v[220:223],v[48:51]
v_mfma_f32_16x16x32_bf16 v[36:39],a[220:223],v[124:127],v[36:39]
v_mfma_f32_16x16x32_bf16 v[52:55],v[124:127],v[220:223],v[52:55]
s_waitcnt lgkmcnt(2)
v_mfma_f32_16x16x32_bf16 v[24:27],a[224:227],v[104:107],v[24:27]
ds_read_b128 v[120:123],v6 offset:24576
v_mfma_f32_16x16x32_bf16 v[40:43],v[104:107],v[224:227],v[40:43]
v_mfma_f32_16x16x32_bf16 v[28:31],a[224:227],v[108:111],v[28:31]
ds_read_b128 v[124:127],v6 offset:28672
v_mfma_f32_16x16x32_bf16 v[44:47],v[108:111],v[224:227],v[44:47]
v_mfma_f32_16x16x32_bf16 v[32:35],a[232:235],v[104:107],v[32:35]
v_mfma_f32_16x16x32_bf16 v[48:51],v[104:107],v[232:235],v[48:51]
v_mfma_f32_16x16x32_bf16 v[36:39],a[232:235],v[108:111],v[36:39]
v_mfma_f32_16x16x32_bf16 v[52:55],v[108:111],v[232:235],v[52:55]
s_waitcnt lgkmcnt(2)
v_mfma_f32_16x16x32_bf16 v[24:27],a[228:231],v[112:115],v[24:27]
ds_read_b128 v[104:107],v7 offset:24576
v_mfma_f32_16x16x32_bf16 v[40:43],v[112:115],v[228:231],v[40:43]
v_mfma_f32_16x16x32_bf16 v[28:31],a[228:231],v[116:119],v[28:31]
ds_read_b128 v[108:111],v7 offset:28672
v_mfma_f32_16x16x32_bf16 v[44:47],v[116:119],v[228:231],v[44:47]
v_mfma_f32_16x16x32_bf16 v[32:35],a[236:239],v[112:115],v[32:35]
v_mfma_f32_16x16x32_bf16 v[48:51],v[112:115],v[236:239],v[48:51]
v_mfma_f32_16x16x32_bf16 v[36:39],a[236:239],v[116:119],v[36:39]
v_mfma_f32_16x16x32_bf16 v[52:55],v[116:119],v[236:239],v[52:55]
s_waitcnt lgkmcnt(2)
v_mfma_f32_16x16x32_bf16 v[24:27],a[240:243],v[120:123],v[24:27]
ds_read_b128 v[112:115],v4 offset:0
v_mfma_f32_16x16x32_bf16 v[40:43],v[120:123],v[240:243],v[40:43]
v_mfma_f32_16x16x32_bf16 v[28:31],a[240:243],v[124:127],v[28:31]
ds_read_b128 v[116:119],v4 offset:4096
v_mfma_f32_16x16x32_bf16 v[44:47],v[124:127],v[240:243],v[44:47]
v_mfma_f32_16x16x32_bf16 v[32:35],a[248:251],v[120:123],v[32:35]
v_mfma_f32_16x16x32_bf16 v[48:51],v[120:123],v[248:251],v[48:51]
v_mfma_f32_16x16x32_bf16 v[36:39],a[248:251],v[124:127],v[36:39]
v_mfma_f32_16x16x32_bf16 v[52:55],v[124:127],v[248:251],v[52:55]
s_waitcnt lgkmcnt(2)
v_mfma_f32_16x16x32_bf16 v[24:27],a[244:247],v[104:107],v[24:27]
ds_read_b128 v[120:123],v5 offset:0
v_mfma_f32_16x16x32_bf16 v[40:43],v[104:107],v[244:247],v[40:43]
v_mfma_f32_16x16x32_bf16 v[28:31],a[244:247],v[108:111],v[28:31]
ds_read_b128 v[124:127],v5 offset:4096
v_mfma_f32_16x16x32_bf16 v[44:47],v[108:111],v[244:247],v[44:47]
v_mfma_f32_16x16x32_bf16 v[32:35],a[252:255],v[104:107],v[32:35]
v_mfma_f32_16x16x32_bf16 v[48:51],v[104:107],v[252:255],v[48:51]
v_mfma_f32_16x16x32_bf16 v[36:39],a[252:255],v[108:111],v[36:39]
v_mfma_f32_16x16x32_bf16 v[52:55],v[108:111],v[252:255],v[52:55]
s_waitcnt lgkmcnt(2)
v_mfma_f32_16x16x32_bf16 v[88:91],a[0:3],v[112:115],0
ds_read_b128 v[104:107],v6 offset:0
v_mfma_f32_16x16x32_bf16 v[92:95],a[0:3],v[116:119],0
v_mfma_f32_16x16x32_bf16 v[96:99],a[8:11],v[112:115],0
ds_read_b128 v[108:111],v6 offset:4096
v_cvt_pk_bf16_f32 v56,v24,v32
v_cvt_pk_bf16_f32 v57,v25,v33
v_mfma_f32_16x16x32_bf16 v[100:103],a[8:11],v[116:119],0
v_cvt_pk_bf16_f32 v58,v26,v34
v_cvt_pk_bf16_f32 v59,v27,v35
s_waitcnt lgkmcnt(2)
v_mfma_f32_16x16x32_bf16 v[88:91],a[4:7],v[120:123],v[88:91]
ds_read_b128 v[112:115],v7 offset:0
v_mfma_f32_16x16x32_bf16 v[92:95],a[4:7],v[124:127],v[92:95]
buffer_store_dwordx4 v[56:59],v0,s[8:11],s61 offen sc1
v_cvt_pk_bf16_f32 v60,v28,v36
v_cvt_pk_bf16_f32 v61,v29,v37
v_mfma_f32_16x16x32_bf16 v[96:99],a[12:15],v[120:123],v[96:99]
ds_read_b128 v[116:119],v7 offset:4096
v_cvt_pk_bf16_f32 v62,v30,v38
v_cvt_pk_bf16_f32 v63,v31,v39
v_mfma_f32_16x16x32_bf16 v[100:103],a[12:15],v[124:127],v[100:103]
buffer_store_dwordx4 v[60:63],v0,s[8:11],s62 offen sc1
v_cvt_pk_bf16_f32 v64,v40,v41
v_cvt_pk_bf16_f32 v65,v42,v43
s_waitcnt lgkmcnt(2)
v_mfma_f32_16x16x32_bf16 v[88:91],a[16:19],v[104:107],v[88:91]
ds_read_b128 v[120:123],v4 offset:8192
v_cvt_pk_bf16_f32 v66,v44,v45
v_cvt_pk_bf16_f32 v67,v46,v47
v_mfma_f32_16x16x32_bf16 v[92:95],a[16:19],v[108:111],v[92:95]
buffer_store_dwordx4 v[64:67],v0,s[8:11],s65 offen offset:0 sc1
v_cvt_pk_bf16_f32 v68,v48,v49
v_cvt_pk_bf16_f32 v69,v50,v51
v_mfma_f32_16x16x32_bf16 v[96:99],a[24:27],v[104:107],v[96:99]
ds_read_b128 v[124:127],v4 offset:12288
v_cvt_pk_bf16_f32 v70,v52,v53
v_cvt_pk_bf16_f32 v71,v54,v55
v_mfma_f32_16x16x32_bf16 v[100:103],a[24:27],v[108:111],v[100:103]
buffer_store_dwordx4 v[68:71],v0,s[8:11],s65 offen offset:1024 sc1
s_waitcnt lgkmcnt(2)
v_mfma_f32_16x16x32_bf16 v[88:91],a[20:23],v[112:115],v[88:91]
ds_read_b128 v[104:107],v5 offset:8192
v_mfma_f32_16x16x32_bf16 v[92:95],a[20:23],v[116:119],v[92:95]
v_mfma_f32_16x16x32_bf16 v[96:99],a[28:31],v[112:115],v[96:99]
ds_read_b128 v[108:111],v5 offset:12288
v_mfma_f32_16x16x32_bf16 v[100:103],a[28:31],v[116:119],v[100:103]
s_waitcnt lgkmcnt(2)
v_mfma_f32_16x16x32_bf16 v[88:91],a[32:35],v[120:123],v[88:91]
ds_read_b128 v[112:115],v6 offset:8192
v_mfma_f32_16x16x32_bf16 v[92:95],a[32:35],v[124:127],v[92:95]
v_mfma_f32_16x16x32_bf16 v[96:99],a[40:43],v[120:123],v[96:99]
ds_read_b128 v[116:119],v6 offset:12288
v_mfma_f32_16x16x32_bf16 v[100:103],a[40:43],v[124:127],v[100:103]
s_waitcnt lgkmcnt(2)
v_mfma_f32_16x16x32_bf16 v[88:91],a[36:39],v[104:107],v[88:91]
ds_read_b128 v[120:123],v7 offset:8192
v_mfma_f32_16x16x32_bf16 v[92:95],a[36:39],v[108:111],v[92:95]
v_mfma_f32_16x16x32_bf16 v[96:99],a[44:47],v[104:107],v[96:99]
ds_read_b128 v[124:127],v7 offset:12288
v_mfma_f32_16x16x32_bf16 v[100:103],a[44:47],v[108:111],v[100:103]
s_waitcnt lgkmcnt(2)
v_mfma_f32_16x16x32_bf16 v[88:91],a[48:51],v[112:115],v[88:91]
ds_read_b128 v[104:107],v4 offset:16384
v_mfma_f32_16x16x32_bf16 v[92:95],a[48:51],v[116:119],v[92:95]
v_mfma_f32_16x16x32_bf16 v[96:99],a[56:59],v[112:115],v[96:99]
ds_read_b128 v[108:111],v4 offset:20480
v_mfma_f32_16x16x32_bf16 v[100:103],a[56:59],v[116:119],v[100:103]
s_waitcnt lgkmcnt(2)
v_mfma_f32_16x16x32_bf16 v[88:91],a[52:55],v[120:123],v[88:91]
ds_read_b128 v[112:115],v5 offset:16384
v_mfma_f32_16x16x32_bf16 v[92:95],a[52:55],v[124:127],v[92:95]
v_mfma_f32_16x16x32_bf16 v[96:99],a[60:63],v[120:123],v[96:99]
ds_read_b128 v[116:119],v5 offset:20480
v_mfma_f32_16x16x32_bf16 v[100:103],a[60:63],v[124:127],v[100:103]
s_waitcnt lgkmcnt(2)
v_mfma_f32_16x16x32_bf16 v[88:91],a[64:67],v[104:107],v[88:91]
ds_read_b128 v[120:123],v6 offset:16384
v_mfma_f32_16x16x32_bf16 v[92:95],a[64:67],v[108:111],v[92:95]
v_mfma_f32_16x16x32_bf16 v[96:99],a[72:75],v[104:107],v[96:99]
ds_read_b128 v[124:127],v6 offset:20480
v_mfma_f32_16x16x32_bf16 v[100:103],a[72:75],v[108:111],v[100:103]
s_waitcnt lgkmcnt(2)
v_mfma_f32_16x16x32_bf16 v[88:91],a[68:71],v[112:115],v[88:91]
ds_read_b128 v[104:107],v7 offset:16384
v_mfma_f32_16x16x32_bf16 v[92:95],a[68:71],v[116:119],v[92:95]
v_mfma_f32_16x16x32_bf16 v[96:99],a[76:79],v[112:115],v[96:99]
ds_read_b128 v[108:111],v7 offset:20480
v_mfma_f32_16x16x32_bf16 v[100:103],a[76:79],v[116:119],v[100:103]
s_waitcnt lgkmcnt(2)
v_mfma_f32_16x16x32_bf16 v[88:91],a[80:83],v[120:123],v[88:91]
ds_read_b128 v[112:115],v4 offset:24576
v_mfma_f32_16x16x32_bf16 v[92:95],a[80:83],v[124:127],v[92:95]
v_mfma_f32_16x16x32_bf16 v[96:99],a[88:91],v[120:123],v[96:99]
ds_read_b128 v[116:119],v4 offset:28672
v_mfma_f32_16x16x32_bf16 v[100:103],a[88:91],v[124:127],v[100:103]
s_waitcnt lgkmcnt(2)
v_mfma_f32_16x16x32_bf16 v[88:91],a[84:87],v[104:107],v[88:91]
ds_read_b128 v[120:123],v5 offset:24576
v_mfma_f32_16x16x32_bf16 v[92:95],a[84:87],v[108:111],v[92:95]
v_mfma_f32_16x16x32_bf16 v[96:99],a[92:95],v[104:107],v[96:99]
ds_read_b128 v[124:127],v5 offset:28672
v_mfma_f32_16x16x32_bf16 v[100:103],a[92:95],v[108:111],v[100:103]
s_waitcnt lgkmcnt(2)
v_mfma_f32_16x16x32_bf16 v[88:91],a[96:99],v[112:115],v[88:91]
ds_read_b128 v[104:107],v6 offset:24576
v_mfma_f32_16x16x32_bf16 v[92:95],a[96:99],v[116:119],v[92:95]
v_mfma_f32_16x16x32_bf16 v[96:99],a[104:107],v[112:115],v[96:99]
ds_read_b128 v[108:111],v6 offset:28672
v_mfma_f32_16x16x32_bf16 v[100:103],a[104:107],v[116:119],v[100:103]
s_waitcnt lgkmcnt(2)
v_mfma_f32_16x16x32_bf16 v[88:91],a[100:103],v[120:123],v[88:91]
ds_read_b128 v[112:115],v7 offset:24576
v_mfma_f32_16x16x32_bf16 v[92:95],a[100:103],v[124:127],v[92:95]
v_mfma_f32_16x16x32_bf16 v[96:99],a[108:111],v[120:123],v[96:99]
ds_read_b128 v[116:119],v7 offset:28672
v_mfma_f32_16x16x32_bf16 v[100:103],a[108:111],v[124:127],v[100:103]
s_waitcnt lgkmcnt(2)
v_mfma_f32_16x16x32_bf16 v[88:91],a[112:115],v[104:107],v[88:91]
v_mfma_f32_16x16x32_bf16 v[92:95],a[112:115],v[108:111],v[92:95]
v_mfma_f32_16x16x32_bf16 v[96:99],a[120:123],v[104:107],v[96:99]
v_mfma_f32_16x16x32_bf16 v[100:103],a[120:123],v[108:111],v[100:103]
s_waitcnt lgkmcnt(0)
v_mfma_f32_16x16x32_bf16 v[88:91],a[116:119],v[112:115],v[88:91]
v_mfma_f32_16x16x32_bf16 v[92:95],a[116:119],v[116:119],v[92:95]
v_mfma_f32_16x16x32_bf16 v[96:99],a[124:127],v[112:115],v[96:99]
v_mfma_f32_16x16x32_bf16 v[100:103],a[124:127],v[116:119],v[100:103]
s_nop 3
v_cvt_pk_bf16_f32 v104,v88,v96
v_cvt_pk_bf16_f32 v105,v89,v97
v_cvt_pk_bf16_f32 v106,v90,v98
v_cvt_pk_bf16_f32 v107,v91,v99
v_cvt_pk_bf16_f32 v108,v92,v100
v_cvt_pk_bf16_f32 v109,v93,v101
v_cvt_pk_bf16_f32 v110,v94,v102
v_cvt_pk_bf16_f32 v111,v95,v103
buffer_store_dwordx4 v[104:107],v0,s[8:11],s63 offen sc1
buffer_store_dwordx4 v[108:111],v0,s[8:11],s64 offen sc1
s_waitcnt vmcnt(6)
s_barrier
s_add_u32 m0,s50,131072
s_nop 0
buffer_load_dwordx4 v20,s[8:11],s70 offen offset:0 sc1 lds
s_add_u32 m0,s50,135168
s_nop 0
buffer_load_dwordx4 v20,s[8:11],s71 offen offset:0 sc1 lds
s_add_u32 m0,s50,139008
s_nop 0
buffer_load_dwordx4 v20,s[8:11],s70 offen offset:256 sc1 lds
s_add_u32 m0,s50,143104
s_nop 0
buffer_load_dwordx4 v20,s[8:11],s71 offen offset:256 sc1 lds
s_add_u32 m0,s50,146944
s_nop 0
buffer_load_dwordx4 v20,s[8:11],s70 offen offset:512 sc1 lds
s_add_u32 m0,s50,151040
s_nop 0
buffer_load_dwordx4 v20,s[8:11],s71 offen offset:512 sc1 lds
s_lshl_b32 s59,s51,13
s_lshl2_add_u32 s59,s47,s59
s_add_u32 s59,s59,10487680
s_waitcnt vmcnt(0)
s_barrier
s_or_b32 s59,s59,s52
buffer_store_dword v17,off,s[8:11],s59 sc1
s_mov_b32 s72,0x80000000
s_mov_b32 s86,0
s_mov_b32 s19,1
s_mov_b32 s18,0
s_cmp_lt_u32 s31,64
s_cbranch_scc1 L_mo_36
L_mo_49:
s_mov_b32 s51,64
s_cmp_eq_u32 s47,31
s_cbranch_scc1 L_mf_60
v_and_b32 v9,15,v1
v_lshrrev_b32 v10,4,v1
v_and_b32 v124,1,v1
v_lshlrev_b32 v124,4,v124
v_mov_b32 v125,0xffff
v_lshlrev_b32 v125,v124,v125
v_lshrrev_b32 v124,2,v9
v_cmp_eq_u32 vcc,0,v124
s_nop 1
v_cndmask_b32 v12,0,v125,vcc
v_cmp_eq_u32 vcc,1,v124
s_nop 1
v_cndmask_b32 v13,0,v125,vcc
v_and_b32 v124,2,v1
v_cmp_eq_u32 vcc,0,v124
v_mov_b32 v14,0xeeee
v_mov_b32 v124,0x4444
v_cndmask_b32 v14,v14,v124,vcc
v_lshlrev_b32 v11,14,v10
v_lshl_add_u32 v11,v9,4,v11
s_lshl_b32 s65,s51,15
s_add_u32 s65,s65,92274688
s_lshl_b32 s62,s47,10
s_add_u32 s62,s62,s65
s_lshl_b32 s63,s47,16
s_lshl_b32 s60,s46,8
s_add_u32 s63,s63,s60
s_mov_b32 s4,s38
s_mov_b32 s5,s39
s_mov_b32 s6,1835008
s_mov_b32 s7,0x20000
buffer_load_dwordx4 v[24:27],v11,s[4:7],s63 offen offset:0
buffer_load_dwordx4 v[28:31],v11,s[4:7],s63 offen offset:1024
buffer_load_dwordx4 v[32:35],v11,s[4:7],s63 offen offset:2048
buffer_load_dwordx4 v[36:39],v11,s[4:7],s63 offen offset:3072
s_add_u32 s63,s63,4096
buffer_load_dwordx4 v[40:43],v11,s[4:7],s63 offen offset:0
buffer_load_dwordx4 v[44:47],v11,s[4:7],s63 offen offset:1024
buffer_load_dwordx4 v[48:51],v11,s[4:7],s63 offen offset:2048
buffer_load_dwordx4 v[52:55],v11,s[4:7],s63 offen offset:3072
s_add_u32 s63,s63,4096
buffer_load_dwordx4 v[56:59],v11,s[4:7],s63 offen offset:0
buffer_load_dwordx4 v[60:63],v11,s[4:7],s63 offen offset:1024
buffer_load_dwordx4 v[64:67],v11,s[4:7],s63 offen offset:2048
buffer_load_dwordx4 v[68:71],v11,s[4:7],s63 offen offset:3072
s_add_u32 s63,s63,4096
buffer_load_dwordx4 v[72:75],v11,s[4:7],s63 offen offset:0
buffer_load_dwordx4 v[76:79],v11,s[4:7],s63 offen offset:1024
buffer_load_dwordx4 v[80:83],v11,s[4:7],s63 offen offset:2048
buffer_load_dwordx4 v[84:87],v11,s[4:7],s63 offen offset:3072
buffer_load_dword v15,v0,s[8:11],s62 offen
ds_read_b128 a[0:3],v18 offset:0
ds_read_b128 a[4:7],v18 offset:1024
ds_read_b128 a[8:11],v18 offset:2048
ds_read_b128 a[12:15],v18 offset:3072
ds_read_b128 a[16:19],v18 offset:4096
ds_read_b128 a[20:23],v18 offset:5120
ds_read_b128 a[24:27],v18 offset:6144
ds_read_b128 a[28:31],v18 offset:7168
ds_read_b128 a[32:35],v18 offset:8192
ds_read_b128 a[36:39],v18 offset:9216
ds_read_b128 a[40:43],v18 offset:10240
ds_read_b128 a[44:47],v18 offset:11264
ds_read_b128 a[48:51],v18 offset:12288
ds_read_b128 a[52:55],v18 offset:13312
ds_read_b128 a[56:59],v18 offset:14336
ds_read_b128 a[60:63],v18 offset:15360
ds_read_b128 a[64:67],v18 offset:16384
ds_read_b128 a[68:71],v18 offset:17408
ds_read_b128 a[72:75],v18 offset:18432
ds_read_b128 a[76:79],v18 offset:19456
ds_read_b128 a[80:83],v18 offset:20480
ds_read_b128 a[84:87],v18 offset:21504
ds_read_b128 a[88:91],v18 offset:22528
ds_read_b128 a[92:95],v18 offset:23552
ds_read_b128 a[96:99],v18 offset:24576
ds_read_b128 a[100:103],v18 offset:25600
ds_read_b128 a[104:107],v18 offset:26624
ds_read_b128 a[108:111],v18 offset:27648
ds_read_b128 a[112:115],v18 offset:28672
ds_read_b128 a[116:119],v18 offset:29696
ds_read_b128 a[120:123],v18 offset:30720
ds_read_b128 a[124:127],v18 offset:31744
s_add_u32 s59,s62,32768
buffer_load_dword v15,v0,s[8:11],s59 offen
s_add_u32 s59,s62,65536
buffer_load_dword v15,v0,s[8:11],s59 offen
s_add_u32 s59,s62,98304
buffer_load_dword v15,v0,s[8:11],s59 offen
s_add_u32 s59,s62,131072
buffer_load_dword v15,v0,s[8:11],s59 offen
s_add_u32 s59,s62,163840
buffer_load_dword v15,v0,s[8:11],s59 offen
L_mf_61:
s_lshl_b32 s59,s51,13
s_lshl_b32 s61,s46,7
s_add_u32 s59,s59,s61
s_add_u32 s59,s59,10486272
L_ww_66:
s_sleep 1
buffer_load_dword v2,off,s[8:11],s59 sc1
s_sub_u32 s49,s49,1
s_cbranch_scc1 L_abort
s_waitcnt vmcnt(0)
v_readfirstlane_b32 s55,v2
s_cmp_eq_u32 s55,0
s_cbranch_scc1 L_ww_66
L_wwd_67:
s_cmp_eq_u32 s55,1
s_cbranch_scc1 L_mf_62
s_barrier
s_andn2_b32 s64,0x7ff,s55
s_lshl_b32 s56,s64,10
s_add_u32 s58,s56,6291456
buffer_load_dwordx4 v[88:91],v0,s[8:11],s58 offen sc1
s_lshl_b32 s57,s46,11
s_add_u32 s57,s57,139264
v_add_u32 v8,s57,v0
v_and_b32 v2,1,v10
v_lshrrev_b32 v3,1,v10
v_lshlrev_b32 v2,7,v2
v_lshl_add_u32 v2,v3,10,v2
s_lshl_b32 s59,s46,8
s_add_u32 s59,s57,s59
v_add_u32 v2,s59,v2
s_mov_b32 s60,0x01000100
s_mov_b32 s61,0x03020302
s_waitcnt vmcnt(0)
v_lshlrev_b32 v96,16,v88
v_and_b32 v97,0xffff0000,v88
v_lshlrev_b32 v98,16,v89
v_and_b32 v99,0xffff0000,v89
v_lshlrev_b32 v100,16,v90
v_and_b32 v101,0xffff0000,v90
v_lshlrev_b32 v102,16,v91
v_and_b32 v103,0xffff0000,v91
v_readfirstlane_b32 s78,v96
s_nop 1
v_pk_add_f32 v[108:109],v[96:97],s[78:79] op_sel_hi:[1,0] neg_lo:[0,1] neg_hi:[0,1]
v_pk_add_f32 v[110:111],v[98:99],s[78:79] op_sel_hi:[1,0] neg_lo:[0,1] neg_hi:[0,1]
v_pk_add_f32 v[112:113],v[100:101],s[78:79] op_sel_hi:[1,0] neg_lo:[0,1] neg_hi:[0,1]
v_pk_add_f32 v[114:115],v[102:103],s[78:79] op_sel_hi:[1,0] neg_lo:[0,1] neg_hi:[0,1]
v_pk_add_f32 v[116:117],v[108:109],v[110:111]
v_pk_mul_f32 v[118:119],v[108:109],v[108:109]
v_pk_add_f32 v[120:121],v[112:113],v[114:115]
v_pk_fma_f32 v[118:119],v[110:111],v[110:111],v[118:119]
v_pk_add_f32 v[116:117],v[116:117],v[120:121]
v_pk_fma_f32 v[118:119],v[112:113],v[112:113],v[118:119]
v_add_f32 v116,v116,v117
v_pk_fma_f32 v[118:119],v[114:115],v[114:115],v[118:119]
v_add_f32 v118,v118,v119
s_nop 1
v_permlane32_swap_b32 v116,v118
v_add_f32 v116,v116,v118
s_nop 1
v_add_f32_dpp v116,v116,v116 row_ror:8 row_mask:0xf bank_mask:0xf
s_nop 1
v_add_f32_dpp v116,v116,v116 row_ror:4 row_mask:0xf bank_mask:0xf
s_nop 1
v_add_f32_dpp v116,v116,v116 row_ror:2 row_mask:0xf bank_mask:0xf
s_nop 1
v_add_f32_dpp v116,v116,v116 row_ror:1 row_mask:0xf bank_mask:0xf
v_mov_b32 v118,v116
s_nop 1
v_permlane16_swap_b32 v116,v118
v_add_f32 v116,v116,v118
v_mul_f32 v116,0x3b000000,v116
v_mov_b32 v118,v116
s_nop 1
v_permlane32_swap_b32 v116,v118
v_fma_f32 v118,-v116,v116,v118
v_add_f32 v116,s78,v116
v_max_f32 v118,0,v118
v_cvt_pk_bf16_f32 v118,v116,v118
v_lshlrev_b32 v116,16,v118
v_and_b32 v118,0xffff0000,v118
v_add_f32 v118,0x3727c5ac,v118
v_cvt_pk_bf16_f32 v118,v118,v118
v_and_b32 v118,0xffff0000,v118
v_sqrt_f32 v118,v118
v_pk_add_f32 v[108:109],v[96:97],v[116:117] op_sel_hi:[1,0] neg_lo:[0,1] neg_hi:[0,1]
v_pk_add_f32 v[110:111],v[98:99],v[116:117] op_sel_hi:[1,0] neg_lo:[0,1] neg_hi:[0,1]
v_pk_add_f32 v[112:113],v[100:101],v[116:117] op_sel_hi:[1,0] neg_lo:[0,1] neg_hi:[0,1]
v_pk_add_f32 v[114:115],v[102:103],v[116:117] op_sel_hi:[1,0] neg_lo:[0,1] neg_hi:[0,1]
v_cvt_pk_bf16_f32 v118,v118,v118
v_and_b32 v118,0xffff0000,v118
v_rcp_f32 v118,v118
v_cvt_pk_bf16_f32 v104,v108,v109
v_cvt_pk_bf16_f32 v105,v110,v111
v_cvt_pk_bf16_f32 v106,v112,v113
v_cvt_pk_bf16_f32 v107,v114,v115
v_lshlrev_b32 v108,16,v104
v_and_b32 v109,0xffff0000,v104
v_lshlrev_b32 v110,16,v105
v_and_b32 v111,0xffff0000,v105
v_lshlrev_b32 v112,16,v106
v_and_b32 v113,0xffff0000,v106
v_lshlrev_b32 v114,16,v107
v_and_b32 v115,0xffff0000,v107
v_pk_mul_f32 v[108:109],v[108:109],v[118:119] op_sel_hi:[1,0]
v_pk_mul_f32 v[110:111],v[110:111],v[118:119] op_sel_hi:[1,0]
v_pk_mul_f32 v[112:113],v[112:113],v[118:119] op_sel_hi:[1,0]
v_pk_mul_f32 v[114:115],v[114:115],v[118:119] op_sel_hi:[1,0]
v_cvt_pk_bf16_f32 v104,v108,v109
v_cvt_pk_bf16_f32 v105,v110,v111
v_cvt_pk_bf16_f32 v106,v112,v113
v_cvt_pk_bf16_f32 v107,v114,v115
v_perm_b32 v88,v104,v104,s60
v_perm_b32 v89,v105,v105,s60
v_perm_b32 v90,v106,v106,s60
v_perm_b32 v91,v107,v107,s60
ds_write_b128 v8,v[88:91]
v_perm_b32 v92,v104,v104,s61
v_perm_b32 v93,v105,v105,s61
v_perm_b32 v94,v106,v106,s61
v_perm_b32 v95,v107,v107,s61
ds_write_b128 v8,v[92:95] offset:1024
s_mov_b32 s58,s57
ds_read_b128 v[128:131],v2 offset:0
ds_read_b128 v[144:147],v2 offset:64
ds_read_b128 v[132:135],v2 offset:16
ds_read_b128 v[148:151],v2 offset:80
ds_read_b128 v[136:139],v2 offset:32
ds_read_b128 v[152:155],v2 offset:96
ds_read_b128 v[140:143],v2 offset:48
ds_read_b128 v[156:159],v2 offset:112
v_mov_b64 v[116:117],0
v_mov_b64 v[118:119],0
s_waitcnt lgkmcnt(6)
v_and_b32 v120,v12,v128
v_and_b32 v121,v13,v128
v_and_b32 v122,v12,v144
v_and_b32 v123,v13,v144
v_and_b32 v124,v12,v129
v_and_b32 v125,v13,v129
v_smfmac_f32_16x16x64_bf16 v[116:119],v[120:123],a[0:7],v14
v_and_b32 v126,v12,v145
v_and_b32 v127,v13,v145
v_and_b32 v120,v12,v130
v_and_b32 v121,v13,v130
v_smfmac_f32_16x16x64_bf16 v[116:119],v[124:127],a[8:15],v14
v_and_b32 v122,v12,v146
v_and_b32 v123,v13,v146
v_and_b32 v124,v12,v131
v_and_b32 v125,v13,v131
v_smfmac_f32_16x16x64_bf16 v[116:119],v[120:123],a[16:23],v14
v_and_b32 v126,v12,v147
v_and_b32 v127,v13,v147
s_waitcnt lgkmcnt(4)
v_and_b32 v120,v12,v132
v_and_b32 v121,v13,v132
v_smfmac_f32_16x16x64_bf16 v[116:119],v[124:127],a[24:31],v14
v_and_b32 v122,v12,v148
v_and_b32 v123,v13,v148
v_and_b32 v124,v12,v133
v_and_b32 v125,v13,v133
v_smfmac_f32_16x16x64_bf16 v[116:119],v[120:123],a[32:39],v14
v_and_b32 v126,v12,v149
v_and_b32 v127,v13,v149
v_and_b32 v120,v12,v134
v_and_b32 v121,v13,v134
v_smfmac_f32_16x16x64_bf16 v[116:119],v[124:127],a[40:47],v14
v_and_b32 v122,v12,v150
v_and_b32 v123,v13,v150
v_and_b32 v124,v12,v135
v_and_b32 v125,v13,v135
v_smfmac_f32_16x16x64_bf16 v[116:119],v[120:123],a[48:55],v14
v_and_b32 v126,v12,v151
v_and_b32 v127,v13,v151
s_waitcnt lgkmcnt(2)
v_and_b32 v120,v12,v136
v_and_b32 v121,v13,v136
v_smfmac_f32_16x16x64_bf16 v[116:119],v[124:127],a[56:63],v14
v_and_b32 v122,v12,v152
v_and_b32 v123,v13,v152
v_and_b32 v124,v12,v137
v_and_b32 v125,v13,v137
v_smfmac_f32_16x16x64_bf16 v[116:119],v[120:123],a[64:71],v14
v_and_b32 v126,v12,v153
v_and_b32 v127,v13,v153
v_and_b32 v120,v12,v138
v_and_b32 v121,v13,v138
v_smfmac_f32_16x16x64_bf16 v[116:119],v[124:127],a[72:79],v14
v_and_b32 v122,v12,v154
v_and_b32 v123,v13,v154
v_and_b32 v124,v12,v139
v_and_b32 v125,v13,v139
v_smfmac_f32_16x16x64_bf16 v[116:119],v[120:123],a[80:87],v14
v_and_b32 v126,v12,v155
v_and_b32 v127,v13,v155
s_waitcnt lgkmcnt(0)
v_and_b32 v120,v12,v140
v_and_b32 v121,v13,v140
v_smfmac_f32_16x16x64_bf16 v[116:119],v[124:127],a[88:95],v14
v_and_b32 v122,v12,v156
v_and_b32 v123,v13,v156
v_and_b32 v124,v12,v141
v_and_b32 v125,v13,v141
v_smfmac_f32_16x16x64_bf16 v[116:119],v[120:123],a[96:103],v14
v_and_b32 v126,v12,v157
v_and_b32 v127,v13,v157
v_and_b32 v120,v12,v142
v_and_b32 v121,v13,v142
v_smfmac_f32_16x16x64_bf16 v[116:119],v[124:127],a[104:111],v14
v_and_b32 v122,v12,v158
v_and_b32 v123,v13,v158
v_and_b32 v124,v12,v143
v_and_b32 v125,v13,v143
v_smfmac_f32_16x16x64_bf16 v[116:119],v[120:123],a[112:119],v14
v_and_b32 v126,v12,v159
v_and_b32 v127,v13,v159
s_nop 1
v_smfmac_f32_16x16x64_bf16 v[116:119],v[124:127],a[120:127],v14
v_lshlrev_b32 v8,5,v9
v_and_b32 v124,1,v10
v_lshl_add_u32 v8,v124,4,v8
v_lshrrev_b32 v124,1,v10
v_lshl_add_u32 v8,v124,11,v8
s_lshl_b32 s60,s46,9
s_add_u32 s60,s60,147456
v_add_u32 v8,s60,v8
ds_write_b128 v8,v[116:119]
v_lshlrev_b32 v8,2,v1
v_add_u32 v8,147456,v8
v_and_b32 v2,1,v1
v_lshrrev_b32 v3,1,v1
v_lshlrev_b32 v3,2,v3
v_lshl_add_u32 v2,v2,7,v3
v_add_u32 v2,s58,v2
v_lshlrev_b32 v3,6,v10
v_add_u32 v3,s58,v3
s_waitcnt lgkmcnt(0)
s_barrier
ds_read2st64_b32 v[88:89],v8 offset0:0 offset1:1
ds_read2st64_b32 v[90:91],v8 offset0:2 offset1:3
ds_read2st64_b32 v[92:93],v8 offset0:4 offset1:5
ds_read2st64_b32 v[94:95],v8 offset0:6 offset1:7
s_waitcnt lgkmcnt(0)
v_pk_add_f32 v[88:89],v[88:89],v[90:91]
v_pk_add_f32 v[92:93],v[92:93],v[94:95]
v_pk_add_f32 v[88:89],v[88:89],v[92:93]
v_cvt_pk_bf16_f32 v88,v88,v88
v_and_b32 v88,0xffff0000,v88
v_cvt_pk_bf16_f32 v89,v89,v89
v_and_b32 v89,0xffff0000,v89
v_mul_f32 v90,0xbfb8aa3b,v88
v_exp_f32 v90,v90
s_nop 0
v_add_f32 v90,1.0,v90
v_rcp_f32 v90,v90
s_nop 0
v_mul_f32 v88,v88,v90
v_cvt_pk_bf16_f32 v88,v88,v88
v_and_b32 v88,0xffff0000,v88
v_mul_f32 v88,v88,v89
v_cvt_pk_bf16_f32 v88,v88,v88
ds_write_b32 v2,v88
ds_read_b128 v[88:91],v3
ds_read_b128 v[108:111],v3 offset:32
ds_read_b128 v[92:95],v3 offset:16
ds_read_b128 v[112:115],v3 offset:48
v_mov_b64 v[116:117],0
v_mov_b64 v[118:119],0
s_waitcnt vmcnt(0) lgkmcnt(0)
v_and_b32 v120,v12,v88
v_and_b32 v121,v13,v88
v_and_b32 v122,v12,v108
v_and_b32 v123,v13,v108
v_and_b32 v124,v12,v89
v_and_b32 v125,v13,v89
v_smfmac_f32_16x16x64_bf16 v[116:119],v[120:123],v[24:31],v14
v_and_b32 v126,v12,v109
v_and_b32 v127,v13,v109
v_and_b32 v120,v12,v90
v_and_b32 v121,v13,v90
v_smfmac_f32_16x16x64_bf16 v[116:119],v[124:127],v[32:39],v14
v_and_b32 v122,v12,v110
v_and_b32 v123,v13,v110
v_and_b32 v124,v12,v91
v_and_b32 v125,v13,v91
v_smfmac_f32_16x16x64_bf16 v[116:119],v[120:123],v[40:47],v14
v_and_b32 v126,v12,v111
v_and_b32 v127,v13,v111
v_and_b32 v120,v12,v92
v_and_b32 v121,v13,v92
v_smfmac_f32_16x16x64_bf16 v[116:119],v[124:127],v[48:55],v14
v_and_b32 v122,v12,v112
v_and_b32 v123,v13,v112
v_and_b32 v124,v12,v93
v_and_b32 v125,v13,v93
v_smfmac_f32_16x16x64_bf16 v[116:119],v[120:123],v[56:63],v14
v_and_b32 v126,v12,v113
v_and_b32 v127,v13,v113
v_and_b32 v120,v12,v94
v_and_b32 v121,v13,v94
v_smfmac_f32_16x16x64_bf16 v[116:119],v[124:127],v[64:71],v14
v_and_b32 v122,v12,v114
v_and_b32 v123,v13,v114
v_and_b32 v124,v12,v95
v_and_b32 v125,v13,v95
v_smfmac_f32_16x16x64_bf16 v[116:119],v[120:123],v[72:79],v14
v_and_b32 v126,v12,v115
v_and_b32 v127,v13,v115
s_nop 1
v_smfmac_f32_16x16x64_bf16 v[116:119],v[124:127],v[80:87],v14
v_lshlrev_b32 v8,4,v9
v_and_b32 v124,1,v10
v_lshl_add_u32 v8,v124,3,v8
v_and_b32 v124,2,v10
v_lshl_add_u32 v8,v124,30,v8
s_lshl_b32 s60,s46,8
s_add_u32 s59,s62,s60
s_nop 0
v_cvt_pk_bf16_f32 v88,v116,v117
v_cvt_pk_bf16_f32 v89,v118,v119
buffer_store_dwordx2 v[88:89],v8,s[8:11],s59 offen
s_lshl_b32 s59,s51,13
s_lshl2_add_u32 s59,s47,s59
s_add_u32 s59,s59,10486912
s_waitcnt vmcnt(0)
s_barrier
s_or_b32 s59,s59,s52
buffer_store_dword v17,off,s[8:11],s59
s_cmp_lg_u32 s47,0
s_cbranch_scc1 L_moed_68
s_lshl_b32 s59,s51,13
s_add_u32 s59,s59,10486912
v_and_b32 v124,31,v1
v_lshlrev_b32 v124,2,v124
L_fw_69:
buffer_load_dword v125,v124,s[8:11],s59 offen sc1
s_sub_u32 s49,s49,1
s_cbranch_scc1 L_abort
s_waitcnt vmcnt(0)
v_cmp_eq_u32 vcc,0,v125
s_cbranch_vccnz L_fw_69
s_add_u32 s63,s65,0
buffer_load_dwordx4 v[168:171],v22,s[8:11],s63 offen sc1
s_add_u32 s63,s65,4096
buffer_load_dwordx4 v[172:175],v22,s[8:11],s63 offen sc1
s_add_u32 s63,s65,8192
buffer_load_dwordx4 v[176:179],v22,s[8:11],s63 offen sc1
s_add_u32 s63,s65,12288
buffer_load_dwordx4 v[180:183],v22,s[8:11],s63 offen sc1
s_add_u32 s63,s65,16384
buffer_load_dwordx4 v[184:187],v22,s[8:11],s63 offen sc1
s_add_u32 s63,s65,20480
buffer_load_dwordx4 v[188:191],v22,s[8:11],s63 offen sc1
s_add_u32 s63,s65,24576
buffer_load_dwordx4 v[192:195],v22,s[8:11],s63 offen sc1
s_add_u32 s63,s65,28672
buffer_load_dwordx4 v[196:199],v22,s[8:11],s63 offen sc1
v_and_b32 v208,15,v1
v_and_b32 v209,1,v1
v_lshlrev_b32 v209,4,v209
v_mov_b32 v210,0x3f80
v_lshlrev_b32 v210,v209,v210
v_lshrrev_b32 v208,1,v208
v_cmp_eq_u32 vcc,0,v208
s_nop 1
v_cndmask_b32 v200,0,v210,vcc
v_cmp_eq_u32 vcc,1,v208
s_nop 1
v_cndmask_b32 v201,0,v210,vcc
v_cmp_eq_u32 vcc,2,v208
s_nop 1
v_cndmask_b32 v202,0,v210,vcc
v_cmp_eq_u32 vcc,3,v208
s_nop 1
v_cndmask_b32 v203,0,v210,vcc
s_waitcnt vmcnt(7)
s_nop 0
v_mfma_f32_16x16x32_bf16 v[204:207],v[200:203],v[168:171],0
s_waitcnt vmcnt(6)
v_mfma_f32_16x16x32_bf16 v[204:207],v[200:203],v[172:175],v[204:207]
s_waitcnt vmcnt(5)
v_mfma_f32_16x16x32_bf16 v[204:207],v[200:203],v[176:179],v[204:207]
s_waitcnt vmcnt(4)
v_mfma_f32_16x16x32_bf16 v[204:207],v[200:203],v[180:183],v[204:207]
s_waitcnt vmcnt(3)
v_mfma_f32_16x16x32_bf16 v[204:207],v[200:203],v[184:187],v[204:207]
s_waitcnt vmcnt(2)
v_mfma_f32_16x16x32_bf16 v[204:207],v[200:203],v[188:191],v[204:207]
s_waitcnt vmcnt(1)
v_mfma_f32_16x16x32_bf16 v[204:207],v[200:203],v[192:195],v[204:207]
s_waitcnt vmcnt(0)
v_mfma_f32_16x16x32_bf16 v[204:207],v[200:203],v[196:199],v[204:207]
s_nop 7
ds_write_b128 v21,v[204:207]
s_waitcnt lgkmcnt(0)
s_barrier
s_cmp_lg_u32 s46,0
s_cbranch_scc1 L_moed_68
v_lshlrev_b32 v200,5,v1
v_add_u32 v200,155648,v200
ds_read_b128 v[168:171],v200
ds_read_b128 v[172:175],v200 offset:16
s_and_b32 s59,s55,0xffff0000
s_xor_b32 s60,s59,0x80000000
s_xor_b32 s61,s59,0xffff0000
s_cmp_lt_i32 s59,0
s_cselect_b32 s59,s60,s61
v_mov_b32 v200,s59
v_mul_f32 v200,0xbfb8aa3b,v200
v_exp_f32 v200,v200
s_nop 0
v_add_f32 v200,1.0,v200
v_rcp_f32 v200,v200
s_nop 0
v_cvt_pk_bf16_f32 v200,v200,v200
v_and_b32 v200,0xffff0000,v200
v_lshlrev_b32 v192,16,v104
v_and_b32 v193,0xffff0000,v104
v_lshlrev_b32 v194,16,v105
v_and_b32 v195,0xffff0000,v105
v_lshlrev_b32 v196,16,v106
v_and_b32 v197,0xffff0000,v106
v_lshlrev_b32 v198,16,v107
v_and_b32 v199,0xffff0000,v107
s_waitcnt lgkmcnt(0)
v_cvt_pk_bf16_f32 v184,v168,v169
v_cvt_pk_bf16_f32 v185,v170,v171
v_cvt_pk_bf16_f32 v186,v172,v173
v_cvt_pk_bf16_f32 v187,v174,v175
v_lshlrev_b32 v168,16,v184
v_and_b32 v169,0xffff0000,v184
v_lshlrev_b32 v170,16,v185
v_and_b32 v171,0xffff0000,v185
v_lshlrev_b32 v172,16,v186
v_and_b32 v173,0xffff0000,v186
v_lshlrev_b32 v174,16,v187
v_and_b32 v175,0xffff0000,v187
v_pk_mul_f32 v[168:169],v[168:169],v[200:201] op_sel_hi:[1,0]
v_pk_mul_f32 v[170:171],v[170:171],v[200:201] op_sel_hi:[1,0]
v_pk_mul_f32 v[172:173],v[172:173],v[200:201] op_sel_hi:[1,0]
v_pk_mul_f32 v[174:175],v[174:175],v[200:201] op_sel_hi:[1,0]
v_cvt_pk_bf16_f32 v184,v168,v169
v_cvt_pk_bf16_f32 v185,v170,v171
v_cvt_pk_bf16_f32 v186,v172,v173
v_cvt_pk_bf16_f32 v187,v174,v175
v_lshlrev_b32 v168,16,v184
v_and_b32 v169,0xffff0000,v184
v_lshlrev_b32 v170,16,v185
v_and_b32 v171,0xffff0000,v185
v_lshlrev_b32 v172,16,v186
v_and_b32 v173,0xffff0000,v186
v_lshlrev_b32 v174,16,v187
v_and_b32 v175,0xffff0000,v187
v_pk_add_f32 v[168:169],v[168:169],v[192:193]
v_pk_add_f32 v[170:171],v[170:171],v[194:195]
v_pk_add_f32 v[172:173],v[172:173],v[196:197]
v_pk_add_f32 v[174:175],v[174:175],v[198:199]
v_cvt_pk_bf16_f32 v184,v168,v169
v_cvt_pk_bf16_f32 v185,v170,v171
v_cvt_pk_bf16_f32 v186,v172,v173
v_cvt_pk_bf16_f32 v187,v174,v175
v_lshlrev_b32 v168,16,v184
v_and_b32 v169,0xffff0000,v184
v_lshlrev_b32 v170,16,v185
v_and_b32 v171,0xffff0000,v185
v_lshlrev_b32 v172,16,v186
v_and_b32 v173,0xffff0000,v186
v_lshlrev_b32 v174,16,v187
v_and_b32 v175,0xffff0000,v187
v_pk_add_f32 v[96:97],v[96:97],v[168:169]
v_pk_add_f32 v[98:99],v[98:99],v[170:171]
v_pk_add_f32 v[100:101],v[100:101],v[172:173]
v_pk_add_f32 v[102:103],v[102:103],v[174:175]
v_cvt_pk_bf16_f32 v160,v96,v97
v_cvt_pk_bf16_f32 v161,v98,v99
v_cvt_pk_bf16_f32 v162,v100,v101
v_cvt_pk_bf16_f32 v163,v102,v103
L_moed_68:
s_add_u32 s51,s51,1
s_add_u32 s62,s62,32768
s_add_u32 s65,s65,32768
s_branch L_mf_61
L_mf_62:
s_mov_b32 s4,s40
s_mov_b32 s5,s41
s_mov_b32 s6,2097152
s_mov_b32 s7,0x20000
s_or_b32 s61,s47,s46
s_cselect_b32 s56,0x80000000,s56
buffer_store_dwordx4 v[160:163],v0,s[4:7],s56 offen sc1
s_waitcnt vmcnt(0)
s_endpgm
L_mf_60:
s_cmp_lg_u32 s46,0
s_cbranch_scc1 L_mf_65
v_mov_b64 v[24:25],0
v_mov_b64 v[26:27],0
s_mov_b32 s56,94403584
buffer_store_dwordx4 v[24:27],v0,s[8:11],s56 offen
s_mov_b32 s56,94436352
buffer_store_dwordx4 v[24:27],v0,s[8:11],s56 offen
s_mov_b32 s56,94469120
buffer_store_dwordx4 v[24:27],v0,s[8:11],s56 offen
s_mov_b32 s56,94501888
buffer_store_dwordx4 v[24:27],v0,s[8:11],s56 offen
s_mov_b32 s56,94534656
buffer_store_dwordx4 v[24:27],v0,s[8:11],s56 offen
s_mov_b32 s56,94567424
buffer_store_dwordx4 v[24:27],v0,s[8:11],s56 offen
s_andn2_b32 s61,0x7ff,s54
s_lshr_b32 s61,s61,5
s_mov_b32 s59,11018240
v_lshlrev_b32 v2,2,v1
L_fp_72:
s_sleep 2
buffer_load_dword v3,v2,s[8:11],s59 offen sc1
s_sub_u32 s49,s49,1
s_cbranch_scc1 L_abort
s_waitcnt vmcnt(0)
v_cmp_eq_u32 vcc,0,v3
s_cbranch_vccnz L_fp_72
v_cmp_le_u32 vcc,s61,v1
s_nop 1
v_cndmask_b32 v2,1,2,vcc
v_cmp_ne_u32 s[84:85],v2,v3
s_mov_b32 s56,11011324
buffer_store_dword v17,off,s[8:11],s56
s_mov_b32 s56,11019516
buffer_store_dword v17,off,s[8:11],s56
s_mov_b32 s56,11027708
buffer_store_dword v17,off,s[8:11],s56
s_mov_b32 s56,11035900
buffer_store_dword v17,off,s[8:11],s56
s_mov_b32 s56,11044092
buffer_store_dword v17,off,s[8:11],s56
s_mov_b32 s56,11052284
buffer_store_dword v17,off,s[8:11],s56
v_lshrrev_b32 v2,3,v1
v_and_b32 v3,0x70,v0
v_lshl_add_u32 v3,v2,13,v3
s_lshr_b64 s[20:21],s[84:85],0
v_lshrrev_b32 v60,v2,s20
v_and_b32 v60,1,v60
v_mul_u32_u24 v60,768,v60
v_sub_u32 v60,v3,v60
v_add_u32 v60,10487296,v60
s_lshr_b64 s[20:21],s[84:85],8
v_lshrrev_b32 v61,v2,s20
v_and_b32 v61,1,v61
v_mul_u32_u24 v61,768,v61
v_sub_u32 v61,v3,v61
v_add_u32 v61,10552832,v61
s_lshr_b64 s[20:21],s[84:85],16
v_lshrrev_b32 v62,v2,s20
v_and_b32 v62,1,v62
v_mul_u32_u24 v62,768,v62
v_sub_u32 v62,v3,v62
v_add_u32 v62,10618368,v62
s_lshr_b64 s[20:21],s[84:85],24
v_lshrrev_b32 v63,v2,s20
v_and_b32 v63,1,v63
v_mul_u32_u24 v63,768,v63
v_sub_u32 v63,v3,v63
v_add_u32 v63,10683904,v63
s_lshr_b64 s[20:21],s[84:85],32
v_lshrrev_b32 v64,v2,s20
v_and_b32 v64,1,v64
v_mul_u32_u24 v64,768,v64
v_sub_u32 v64,v3,v64
v_add_u32 v64,10749440,v64
s_lshr_b64 s[20:21],s[84:85],40
v_lshrrev_b32 v65,v2,s20
v_and_b32 v65,1,v65
v_mul_u32_u24 v65,768,v65
v_sub_u32 v65,v3,v65
v_add_u32 v65,10814976,v65
s_lshr_b64 s[20:21],s[84:85],48
v_lshrrev_b32 v66,v2,s20
v_and_b32 v66,1,v66
v_mul_u32_u24 v66,768,v66
v_sub_u32 v66,v3,v66
v_add_u32 v66,10880512,v66
s_lshr_b64 s[20:21],s[84:85],56
v_lshrrev_b32 v67,v2,s20
v_and_b32 v67,1,v67
v_mul_u32_u24 v67,768,v67
v_sub_u32 v67,v3,v67
v_add_u32 v67,10946048,v67
v_and_b32 v68,3,v1
v_lshlrev_b32 v68,7,v68
v_add_u32 v68,10486272,v68
v_and_b32 v69,31,v1
v_lshlrev_b32 v69,2,v69
v_add_u32 v69,10478720,v69
s_mov_b32 s66,0
s_mov_b32 s67,524288
v_mov_b32 v57,0
s_mov_b32 s58,1
L_mf_63:
s_sub_u32 s49,s49,1
s_cbranch_scc1 L_abort
s_mov_b32 s57,0
s_cmp_lg_u32 s58,0
s_cbranch_scc1 L_ms_73
buffer_load_dwordx4 v[52:55],v67,s[8:11],0 offen sc1
buffer_load_dword v70,v69,s[8:11],s67 offen sc1
s_branch L_mj_74
L_ms_73:
buffer_load_dwordx4 v[24:27],v60,s[8:11],0 offen sc1
buffer_load_dwordx4 v[28:31],v61,s[8:11],0 offen sc1
buffer_load_dwordx4 v[32:35],v62,s[8:11],0 offen sc1
buffer_load_dwordx4 v[36:39],v63,s[8:11],0 offen sc1
buffer_load_dwordx4 v[40:43],v64,s[8:11],0 offen sc1
buffer_load_dwordx4 v[44:47],v65,s[8:11],0 offen sc1
buffer_load_dwordx4 v[48:51],v66,s[8:11],0 offen sc1
buffer_load_dwordx4 v[52:55],v67,s[8:11],0 offen sc1
buffer_load_dword v70,v69,s[8:11],s67 offen sc1
s_waitcnt vmcnt(8)
v_min3_u32 v56,v24,v25,v26
v_max3_u32 v57,v24,v25,v57
v_min_u32 v56,v27,v56
v_max3_u32 v57,v26,v27,v57
v_cmp_eq_u32 vcc,0,v56
s_bcnt1_i32_b64 s56,vcc
s_add_u32 s57,s57,s56
s_waitcnt vmcnt(7)
v_min3_u32 v56,v28,v29,v30
v_max3_u32 v57,v28,v29,v57
v_min_u32 v56,v31,v56
v_max3_u32 v57,v30,v31,v57
v_cmp_eq_u32 vcc,0,v56
s_bcnt1_i32_b64 s56,vcc
s_add_u32 s57,s57,s56
s_waitcnt vmcnt(6)
v_min3_u32 v56,v32,v33,v34
v_max3_u32 v57,v32,v33,v57
v_min_u32 v56,v35,v56
v_max3_u32 v57,v34,v35,v57
v_cmp_eq_u32 vcc,0,v56
s_bcnt1_i32_b64 s56,vcc
s_add_u32 s57,s57,s56
s_waitcnt vmcnt(5)
v_min3_u32 v56,v36,v37,v38
v_max3_u32 v57,v36,v37,v57
v_min_u32 v56,v39,v56
v_max3_u32 v57,v38,v39,v57
v_cmp_eq_u32 vcc,0,v56
s_bcnt1_i32_b64 s56,vcc
s_add_u32 s57,s57,s56
s_waitcnt vmcnt(4)
v_min3_u32 v56,v40,v41,v42
v_max3_u32 v57,v40,v41,v57
v_min_u32 v56,v43,v56
v_max3_u32 v57,v42,v43,v57
v_cmp_eq_u32 vcc,0,v56
s_bcnt1_i32_b64 s56,vcc
s_add_u32 s57,s57,s56
s_waitcnt vmcnt(3)
v_min3_u32 v56,v44,v45,v46
v_max3_u32 v57,v44,v45,v57
v_min_u32 v56,v47,v56
v_max3_u32 v57,v46,v47,v57
v_cmp_eq_u32 vcc,0,v56
s_bcnt1_i32_b64 s56,vcc
s_add_u32 s57,s57,s56
s_waitcnt vmcnt(2)
v_min3_u32 v56,v48,v49,v50
v_max3_u32 v57,v48,v49,v57
v_min_u32 v56,v51,v56
v_max3_u32 v57,v50,v51,v57
v_cmp_eq_u32 vcc,0,v56
s_bcnt1_i32_b64 s56,vcc
s_add_u32 s57,s57,s56
s_mov_b32 s58,s57
L_mj_74:
s_waitcnt vmcnt(1)
v_min3_u32 v56,v52,v53,v54
v_max3_u32 v57,v52,v53,v57
v_min_u32 v56,v55,v56
v_max3_u32 v57,v54,v55,v57
v_cmp_eq_u32 vcc,0,v56
s_bcnt1_i32_b64 s56,vcc
s_add_u32 s57,s57,s56
v_max_u32_dpp v57,v57,v57 row_ror:8 row_mask:0xf bank_mask:0xf
s_nop 1
v_max_u32_dpp v57,v57,v57 row_ror:4 row_mask:0xf bank_mask:0xf
s_nop 1
v_max_u32_dpp v57,v57,v57 row_ror:2 row_mask:0xf bank_mask:0xf
s_nop 1
v_max_u32_dpp v57,v57,v57 row_ror:1 row_mask:0xf bank_mask:0xf
v_mov_b32 v58,v57
s_nop 1
v_permlane16_swap_b32 v57,v58
v_max_u32 v57,v57,v58
v_mov_b32 v58,v57
s_nop 1
v_permlane32_swap_b32 v57,v58
v_max_u32 v57,v57,v58
s_nop 0
v_readfirstlane_b32 s55,v57
s_cmp_lg_u32 s55,s66
s_cbranch_scc1 L_mf_64
s_cmp_lg_u32 s57,0
s_cbranch_scc1 L_mf_63
v_mov_b32 v57,1
buffer_store_dword v57,v68,s[8:11],s67 offen
L_mf_65:
s_waitcnt vmcnt(0)
s_endpgm
L_mf_64:
s_waitcnt vmcnt(0)
v_cmp_eq_u32 vcc,0,v70
s_cmp_eq_u32 s66,0
s_cselect_b32 s56,0,vcc_lo
s_cmp_gt_u32 s57,112
s_cselect_b32 s56,1,s56
s_cmp_ge_u32 s67,565248
s_cselect_b32 s56,1,s56
s_cmp_eq_u32 s57,0
s_cselect_b32 s56,0,s56
s_cmp_lg_u32 s56,0
s_cbranch_scc1 L_mf_63
buffer_store_dword v57,v68,s[8:11],s67 offen
s_mov_b32 s66,s55
s_add_u32 s67,s67,8192
s_branch L_mf_63
s_endpgm
L_abort:
s_endpgm
L_spread:
s_mov_b32 s3,-1
s_lshr_b32 s48,s2,5
s_and_b32 s47,s2,31
s_branch L_roles
L_ra_6:
s_and_b32 s56,s48,1
s_lshl_b32 s56,s56,12
s_add_u32 s56,s56,s50
s_and_b32 s57,s47,15
s_lshl_b32 s57,s57,13
s_add_u32 s56,s56,s57
s_mov_b32 s4,s22
s_mov_b32 s5,s23
s_mov_b32 s6,4194304
s_mov_b32 s7,0x20000
s_add_u32 s57,s56,0
buffer_load_dwordx4 v[72:75],v0,s[4:7],s57 offen
s_add_u32 s57,s56,131072
buffer_load_dwordx4 v[72:75],v0,s[4:7],s57 offen
s_add_u32 s57,s56,262144
buffer_load_dwordx4 v[72:75],v0,s[4:7],s57 offen
s_add_u32 s57,s56,393216
buffer_load_dwordx4 v[72:75],v0,s[4:7],s57 offen
s_add_u32 s57,s56,524288
buffer_load_dwordx4 v[72:75],v0,s[4:7],s57 offen
s_add_u32 s57,s56,655360
buffer_load_dwordx4 v[72:75],v0,s[4:7],s57 offen
s_add_u32 s57,s56,786432
buffer_load_dwordx4 v[72:75],v0,s[4:7],s57 offen
s_add_u32 s57,s56,917504
buffer_load_dwordx4 v[72:75],v0,s[4:7],s57 offen
s_cmp_eq_u32 s53,0
s_cbranch_scc1 L_m0_75
s_waitcnt vmcnt(16)
v_lshlrev_b32 v32,16,v24
v_and_b32 v33,0xffff0000,v24
v_lshlrev_b32 v34,16,v25
v_and_b32 v35,0xffff0000,v25
v_lshlrev_b32 v36,16,v26
v_and_b32 v37,0xffff0000,v26
v_lshlrev_b32 v38,16,v27
v_and_b32 v39,0xffff0000,v27
v_readfirstlane_b32 s78,v32
s_nop 1
v_pk_add_f32 v[48:49],v[32:33],s[78:79] op_sel_hi:[1,0] neg_lo:[0,1] neg_hi:[0,1]
v_pk_add_f32 v[50:51],v[34:35],s[78:79] op_sel_hi:[1,0] neg_lo:[0,1] neg_hi:[0,1]
v_pk_add_f32 v[52:53],v[36:37],s[78:79] op_sel_hi:[1,0] neg_lo:[0,1] neg_hi:[0,1]
v_pk_add_f32 v[54:55],v[38:39],s[78:79] op_sel_hi:[1,0] neg_lo:[0,1] neg_hi:[0,1]
v_pk_add_f32 v[56:57],v[48:49],v[50:51]
v_pk_mul_f32 v[58:59],v[48:49],v[48:49]
v_pk_add_f32 v[60:61],v[52:53],v[54:55]
v_pk_fma_f32 v[58:59],v[50:51],v[50:51],v[58:59]
v_pk_add_f32 v[56:57],v[56:57],v[60:61]
v_pk_fma_f32 v[58:59],v[52:53],v[52:53],v[58:59]
v_add_f32 v56,v56,v57
v_pk_fma_f32 v[58:59],v[54:55],v[54:55],v[58:59]
v_add_f32 v58,v58,v59
s_nop 1
v_permlane32_swap_b32 v56,v58
v_add_f32 v56,v56,v58
s_nop 1
v_add_f32_dpp v56,v56,v56 row_ror:8 row_mask:0xf bank_mask:0xf
s_nop 1
v_add_f32_dpp v56,v56,v56 row_ror:4 row_mask:0xf bank_mask:0xf
s_nop 1
v_add_f32_dpp v56,v56,v56 row_ror:2 row_mask:0xf bank_mask:0xf
s_nop 1
v_add_f32_dpp v56,v56,v56 row_ror:1 row_mask:0xf bank_mask:0xf
v_mov_b32 v58,v56
s_nop 1
v_permlane16_swap_b32 v56,v58
v_add_f32 v56,v56,v58
v_mul_f32 v56,0x3b000000,v56
v_mov_b32 v58,v56
s_nop 1
v_permlane32_swap_b32 v56,v58
v_fma_f32 v58,-v56,v56,v58
v_add_f32 v56,s78,v56
v_max_f32 v58,0,v58
v_cvt_pk_bf16_f32 v58,v56,v58
v_lshlrev_b32 v56,16,v58
v_and_b32 v58,0xffff0000,v58
v_add_f32 v58,0x3727c5ac,v58
v_cvt_pk_bf16_f32 v58,v58,v58
v_and_b32 v58,0xffff0000,v58
v_sqrt_f32 v58,v58
v_pk_add_f32 v[48:49],v[32:33],v[56:57] op_sel_hi:[1,0] neg_lo:[0,1] neg_hi:[0,1]
v_pk_add_f32 v[50:51],v[34:35],v[56:57] op_sel_hi:[1,0] neg_lo:[0,1] neg_hi:[0,1]
v_pk_add_f32 v[52:53],v[36:37],v[56:57] op_sel_hi:[1,0] neg_lo:[0,1] neg_hi:[0,1]
v_pk_add_f32 v[54:55],v[38:39],v[56:57] op_sel_hi:[1,0] neg_lo:[0,1] neg_hi:[0,1]
v_cvt_pk_bf16_f32 v58,v58,v58
v_and_b32 v58,0xffff0000,v58
v_rcp_f32 v58,v58
v_cvt_pk_bf16_f32 v40,v48,v49
v_cvt_pk_bf16_f32 v41,v50,v51
v_cvt_pk_bf16_f32 v42,v52,v53
v_cvt_pk_bf16_f32 v43,v54,v55
v_lshlrev_b32 v48,16,v40
v_and_b32 v49,0xffff0000,v40
v_lshlrev_b32 v50,16,v41
v_and_b32 v51,0xffff0000,v41
v_lshlrev_b32 v52,16,v42
v_and_b32 v53,0xffff0000,v42
v_lshlrev_b32 v54,16,v43
v_and_b32 v55,0xffff0000,v43
v_pk_mul_f32 v[48:49],v[48:49],v[58:59] op_sel_hi:[1,0]
v_pk_mul_f32 v[50:51],v[50:51],v[58:59] op_sel_hi:[1,0]
v_pk_mul_f32 v[52:53],v[52:53],v[58:59] op_sel_hi:[1,0]
v_pk_mul_f32 v[54:55],v[54:55],v[58:59] op_sel_hi:[1,0]
v_cvt_pk_bf16_f32 v40,v48,v49
v_cvt_pk_bf16_f32 v41,v50,v51
v_cvt_pk_bf16_f32 v42,v52,v53
v_cvt_pk_bf16_f32 v43,v54,v55
buffer_store_dwordx4 v[40:43],v0,s[8:11],s65 offen offset:0 sc1
v_lshlrev_b32 v32,16,v28
v_and_b32 v33,0xffff0000,v28
v_lshlrev_b32 v34,16,v29
v_and_b32 v35,0xffff0000,v29
v_lshlrev_b32 v36,16,v30
v_and_b32 v37,0xffff0000,v30
v_lshlrev_b32 v38,16,v31
v_and_b32 v39,0xffff0000,v31
v_readfirstlane_b32 s78,v32
s_nop 1
v_pk_add_f32 v[48:49],v[32:33],s[78:79] op_sel_hi:[1,0] neg_lo:[0,1] neg_hi:[0,1]
v_pk_add_f32 v[50:51],v[34:35],s[78:79] op_sel_hi:[1,0] neg_lo:[0,1] neg_hi:[0,1]
v_pk_add_f32 v[52:53],v[36:37],s[78:79] op_sel_hi:[1,0] neg_lo:[0,1] neg_hi:[0,1]
v_pk_add_f32 v[54:55],v[38:39],s[78:79] op_sel_hi:[1,0] neg_lo:[0,1] neg_hi:[0,1]
v_pk_add_f32 v[56:57],v[48:49],v[50:51]
v_pk_mul_f32 v[58:59],v[48:49],v[48:49]
v_pk_add_f32 v[60:61],v[52:53],v[54:55]
v_pk_fma_f32 v[58:59],v[50:51],v[50:51],v[58:59]
v_pk_add_f32 v[56:57],v[56:57],v[60:61]
v_pk_fma_f32 v[58:59],v[52:53],v[52:53],v[58:59]
v_add_f32 v56,v56,v57
v_pk_fma_f32 v[58:59],v[54:55],v[54:55],v[58:59]
v_add_f32 v58,v58,v59
s_nop 1
v_permlane32_swap_b32 v56,v58
v_add_f32 v56,v56,v58
s_nop 1
v_add_f32_dpp v56,v56,v56 row_ror:8 row_mask:0xf bank_mask:0xf
s_nop 1
v_add_f32_dpp v56,v56,v56 row_ror:4 row_mask:0xf bank_mask:0xf
s_nop 1
v_add_f32_dpp v56,v56,v56 row_ror:2 row_mask:0xf bank_mask:0xf
s_nop 1
v_add_f32_dpp v56,v56,v56 row_ror:1 row_mask:0xf bank_mask:0xf
v_mov_b32 v58,v56
s_nop 1
v_permlane16_swap_b32 v56,v58
v_add_f32 v56,v56,v58
v_mul_f32 v56,0x3b000000,v56
v_mov_b32 v58,v56
s_nop 1
v_permlane32_swap_b32 v56,v58
v_fma_f32 v58,-v56,v56,v58
v_add_f32 v56,s78,v56
v_max_f32 v58,0,v58
v_cvt_pk_bf16_f32 v58,v56,v58
v_lshlrev_b32 v56,16,v58
v_and_b32 v58,0xffff0000,v58
v_add_f32 v58,0x3727c5ac,v58
v_cvt_pk_bf16_f32 v58,v58,v58
v_and_b32 v58,0xffff0000,v58
v_sqrt_f32 v58,v58
v_pk_add_f32 v[48:49],v[32:33],v[56:57] op_sel_hi:[1,0] neg_lo:[0,1] neg_hi:[0,1]
v_pk_add_f32 v[50:51],v[34:35],v[56:57] op_sel_hi:[1,0] neg_lo:[0,1] neg_hi:[0,1]
v_pk_add_f32 v[52:53],v[36:37],v[56:57] op_sel_hi:[1,0] neg_lo:[0,1] neg_hi:[0,1]
v_pk_add_f32 v[54:55],v[38:39],v[56:57] op_sel_hi:[1,0] neg_lo:[0,1] neg_hi:[0,1]
v_cvt_pk_bf16_f32 v58,v58,v58
v_and_b32 v58,0xffff0000,v58
v_rcp_f32 v58,v58
v_cvt_pk_bf16_f32 v44,v48,v49
v_cvt_pk_bf16_f32 v45,v50,v51
v_cvt_pk_bf16_f32 v46,v52,v53
v_cvt_pk_bf16_f32 v47,v54,v55
v_lshlrev_b32 v48,16,v44
v_and_b32 v49,0xffff0000,v44
v_lshlrev_b32 v50,16,v45
v_and_b32 v51,0xffff0000,v45
v_lshlrev_b32 v52,16,v46
v_and_b32 v53,0xffff0000,v46
v_lshlrev_b32 v54,16,v47
v_and_b32 v55,0xffff0000,v47
v_pk_mul_f32 v[48:49],v[48:49],v[58:59] op_sel_hi:[1,0]
v_pk_mul_f32 v[50:51],v[50:51],v[58:59] op_sel_hi:[1,0]
v_pk_mul_f32 v[52:53],v[52:53],v[58:59] op_sel_hi:[1,0]
v_pk_mul_f32 v[54:55],v[54:55],v[58:59] op_sel_hi:[1,0]
v_cvt_pk_bf16_f32 v44,v48,v49
v_cvt_pk_bf16_f32 v45,v50,v51
v_cvt_pk_bf16_f32 v46,v52,v53
v_cvt_pk_bf16_f32 v47,v54,v55
buffer_store_dwordx4 v[44:47],v0,s[8:11],s65 offen offset:1024 sc1
s_cmp_ge_u32 s2,2
s_cbranch_scc1 L_m0_75
v_lshrrev_b32 v12,3,v1
v_lshlrev_b32 v12,9,v12
v_and_b32 v13,7,v1
v_lshl_add_u32 v12,v13,4,v12
s_lshl_b32 s66,s2,2
s_add_u32 s66,s66,s46
s_and_b32 s67,s66,1
s_lshl_b32 s67,s67,8
s_and_b32 s68,s66,2
s_lshl_b32 s68,s68,6
s_add_u32 s67,s67,s68
s_and_b32 s68,s66,4
s_lshl_b32 s68,s68,10
s_add_u32 s67,s67,s68
s_add_u32 s68,s67,11534336
buffer_store_dwordx4 v[64:67],v12,s[8:11],s68 offen sc1
s_add_u32 s68,s67,12582912
buffer_store_dwordx4 v[64:67],v12,s[8:11],s68 offen sc1
s_add_u32 s68,s67,17825792
buffer_store_dwordx4 v[64:67],v12,s[8:11],s68 offen sc1
L_m0_75:
s_waitcnt vmcnt(7)
s_add_u32 s57,s56,1048576
buffer_load_dwordx4 v[72:75],v0,s[4:7],s57 offen
s_waitcnt vmcnt(7)
s_add_u32 s57,s56,1179648
buffer_load_dwordx4 v[72:75],v0,s[4:7],s57 offen
s_waitcnt vmcnt(7)
s_add_u32 s57,s56,1310720
buffer_load_dwordx4 v[72:75],v0,s[4:7],s57 offen
s_waitcnt vmcnt(7)
s_add_u32 s57,s56,1441792
buffer_load_dwordx4 v[72:75],v0,s[4:7],s57 offen
s_waitcnt vmcnt(7)
s_add_u32 s57,s56,1572864
buffer_load_dwordx4 v[72:75],v0,s[4:7],s57 offen
s_waitcnt vmcnt(7)
s_add_u32 s57,s56,1703936
buffer_load_dwordx4 v[72:75],v0,s[4:7],s57 offen
s_waitcnt vmcnt(7)
s_add_u32 s57,s56,1835008
buffer_load_dwordx4 v[72:75],v0,s[4:7],s57 offen
s_waitcnt vmcnt(7)
s_add_u32 s57,s56,1966080
buffer_load_dwordx4 v[72:75],v0,s[4:7],s57 offen
s_waitcnt vmcnt(7)
s_add_u32 s57,s56,2097152
buffer_load_dwordx4 v[72:75],v0,s[4:7],s57 offen
s_barrier
s_cmp_lg_u32 s46,0
s_cbranch_scc1 L_ar_76
v_mov_b32 v8,240
v_mov_b32 v9,s53
s_mov_b64 exec,1
buffer_atomic_add v9,v8,s[12:15],0 offen
s_mov_b64 exec,-1
L_ar_76:
s_mov_b32 s53,0
s_waitcnt vmcnt(7)
s_add_u32 s57,s56,2228224
buffer_load_dwordx4 v[72:75],v0,s[4:7],s57 offen
s_waitcnt vmcnt(7)
s_add_u32 s57,s56,2359296
buffer_load_dwordx4 v[72:75],v0,s[4:7],s57 offen
s_waitcnt vmcnt(7)
s_add_u32 s57,s56,2490368
buffer_load_dwordx4 v[72:75],v0,s[4:7],s57 offen
s_waitcnt vmcnt(7)
s_add_u32 s57,s56,2621440
buffer_load_dwordx4 v[72:75],v0,s[4:7],s57 offen
s_waitcnt vmcnt(7)
s_add_u32 s57,s56,2752512
buffer_load_dwordx4 v[72:75],v0,s[4:7],s57 offen
s_waitcnt vmcnt(7)
s_add_u32 s57,s56,2883584
buffer_load_dwordx4 v[72:75],v0,s[4:7],s57 offen
s_waitcnt vmcnt(7)
s_add_u32 s57,s56,3014656
buffer_load_dwordx4 v[72:75],v0,s[4:7],s57 offen
s_waitcnt vmcnt(7)
s_add_u32 s57,s56,3145728
buffer_load_dwordx4 v[72:75],v0,s[4:7],s57 offen
s_waitcnt vmcnt(7)
s_add_u32 s57,s56,3276800
buffer_load_dwordx4 v[72:75],v0,s[4:7],s57 offen
s_waitcnt vmcnt(7)
s_add_u32 s57,s56,3407872
buffer_load_dwordx4 v[72:75],v0,s[4:7],s57 offen
s_waitcnt vmcnt(7)
s_add_u32 s57,s56,3538944
buffer_load_dwordx4 v[72:75],v0,s[4:7],s57 offen
s_waitcnt vmcnt(7)
s_add_u32 s57,s56,3670016
buffer_load_dwordx4 v[72:75],v0,s[4:7],s57 offen
s_waitcnt vmcnt(7)
s_add_u32 s57,s56,3801088
buffer_load_dwordx4 v[72:75],v0,s[4:7],s57 offen
s_waitcnt vmcnt(7)
s_add_u32 s57,s56,3932160
buffer_load_dwordx4 v[72:75],v0,s[4:7],s57 offen
s_waitcnt vmcnt(7)
s_add_u32 s57,s56,4063232
buffer_load_dwordx4 v[72:75],v0,s[4:7],s57 offen
s_mov_b32 s4,s24
s_mov_b32 s5,s25
s_mov_b32 s6,4194304
s_mov_b32 s7,0x20000
s_waitcnt vmcnt(7)
s_add_u32 s57,s56,0
buffer_load_dwordx4 v[72:75],v0,s[4:7],s57 offen
s_waitcnt vmcnt(7)
s_add_u32 s57,s56,131072
buffer_load_dwordx4 v[72:75],v0,s[4:7],s57 offen
s_waitcnt vmcnt(7)
s_add_u32 s57,s56,262144
buffer_load_dwordx4 v[72:75],v0,s[4:7],s57 offen
s_waitcnt vmcnt(7)
s_add_u32 s57,s56,393216
buffer_load_dwordx4 v[72:75],v0,s[4:7],s57 offen
s_waitcnt vmcnt(7)
s_add_u32 s57,s56,524288
buffer_load_dwordx4 v[72:75],v0,s[4:7],s57 offen
s_waitcnt vmcnt(7)
s_add_u32 s57,s56,655360
buffer_load_dwordx4 v[72:75],v0,s[4:7],s57 offen
s_waitcnt vmcnt(7)
s_add_u32 s57,s56,786432
buffer_load_dwordx4 v[72:75],v0,s[4:7],s57 offen
s_waitcnt vmcnt(7)
s_add_u32 s57,s56,917504
buffer_load_dwordx4 v[72:75],v0,s[4:7],s57 offen
s_waitcnt vmcnt(7)
s_add_u32 s57,s56,1048576
buffer_load_dwordx4 v[72:75],v0,s[4:7],s57 offen
s_waitcnt vmcnt(7)
s_add_u32 s57,s56,1179648
buffer_load_dwordx4 v[72:75],v0,s[4:7],s57 offen
s_waitcnt vmcnt(7)
s_add_u32 s57,s56,1310720
buffer_load_dwordx4 v[72:75],v0,s[4:7],s57 offen
s_waitcnt vmcnt(7)
s_add_u32 s57,s56,1441792
buffer_load_dwordx4 v[72:75],v0,s[4:7],s57 offen
s_waitcnt vmcnt(7)
s_add_u32 s57,s56,1572864
buffer_load_dwordx4 v[72:75],v0,s[4:7],s57 offen
s_waitcnt vmcnt(7)
s_add_u32 s57,s56,1703936
buffer_load_dwordx4 v[72:75],v0,s[4:7],s57 offen
s_waitcnt vmcnt(7)
s_add_u32 s57,s56,1835008
buffer_load_dwordx4 v[72:75],v0,s[4:7],s57 offen
s_waitcnt vmcnt(7)
s_add_u32 s57,s56,1966080
buffer_load_dwordx4 v[72:75],v0,s[4:7],s57 offen
s_waitcnt vmcnt(7)
s_add_u32 s57,s56,2097152
buffer_load_dwordx4 v[72:75],v0,s[4:7],s57 offen
s_waitcnt vmcnt(7)
s_add_u32 s57,s56,2228224
buffer_load_dwordx4 v[72:75],v0,s[4:7],s57 offen
s_waitcnt vmcnt(7)
s_add_u32 s57,s56,2359296
buffer_load_dwordx4 v[72:75],v0,s[4:7],s57 offen
s_waitcnt vmcnt(7)
s_add_u32 s57,s56,2490368
buffer_load_dwordx4 v[72:75],v0,s[4:7],s57 offen
s_waitcnt vmcnt(7)
s_add_u32 s57,s56,2621440
buffer_load_dwordx4 v[72:75],v0,s[4:7],s57 offen
s_waitcnt vmcnt(7)
s_add_u32 s57,s56,2752512
buffer_load_dwordx4 v[72:75],v0,s[4:7],s57 offen
s_waitcnt vmcnt(7)
s_add_u32 s57,s56,2883584
buffer_load_dwordx4 v[72:75],v0,s[4:7],s57 offen
s_waitcnt vmcnt(7)
s_add_u32 s57,s56,3014656
buffer_load_dwordx4 v[72:75],v0,s[4:7],s57 offen
s_waitcnt vmcnt(7)
s_add_u32 s57,s56,3145728
buffer_load_dwordx4 v[72:75],v0,s[4:7],s57 offen
s_waitcnt vmcnt(7)
s_add_u32 s57,s56,3276800
buffer_load_dwordx4 v[72:75],v0,s[4:7],s57 offen
s_waitcnt vmcnt(7)
s_add_u32 s57,s56,3407872
buffer_load_dwordx4 v[72:75],v0,s[4:7],s57 offen
s_waitcnt vmcnt(7)
s_add_u32 s57,s56,3538944
buffer_load_dwordx4 v[72:75],v0,s[4:7],s57 offen
s_waitcnt vmcnt(7)
s_add_u32 s57,s56,3670016
buffer_load_dwordx4 v[72:75],v0,s[4:7],s57 offen
s_waitcnt vmcnt(7)
s_add_u32 s57,s56,3801088
buffer_load_dwordx4 v[72:75],v0,s[4:7],s57 offen
s_waitcnt vmcnt(7)
s_add_u32 s57,s56,3932160
buffer_load_dwordx4 v[72:75],v0,s[4:7],s57 offen
s_waitcnt vmcnt(7)
s_add_u32 s57,s56,4063232
buffer_load_dwordx4 v[72:75],v0,s[4:7],s57 offen
s_mov_b32 s4,s20
s_mov_b32 s5,s21
s_mov_b32 s6,4194304
s_mov_b32 s7,0x20000
s_waitcnt vmcnt(7)
s_add_u32 s57,s56,0
buffer_load_dwordx4 v[72:75],v0,s[4:7],s57 offen
s_waitcnt vmcnt(7)
s_add_u32 s57,s56,131072
buffer_load_dwordx4 v[72:75],v0,s[4:7],s57 offen
s_waitcnt vmcnt(7)
s_add_u32 s57,s56,262144
buffer_load_dwordx4 v[72:75],v0,s[4:7],s57 offen
s_waitcnt vmcnt(7)
s_add_u32 s57,s56,393216
buffer_load_dwordx4 v[72:75],v0,s[4:7],s57 offen
s_waitcnt vmcnt(7)
s_add_u32 s57,s56,524288
buffer_load_dwordx4 v[72:75],v0,s[4:7],s57 offen
s_waitcnt vmcnt(7)
s_add_u32 s57,s56,655360
buffer_load_dwordx4 v[72:75],v0,s[4:7],s57 offen
s_waitcnt vmcnt(7)
s_add_u32 s57,s56,786432
buffer_load_dwordx4 v[72:75],v0,s[4:7],s57 offen
s_waitcnt vmcnt(7)
s_add_u32 s57,s56,917504
buffer_load_dwordx4 v[72:75],v0,s[4:7],s57 offen
s_waitcnt vmcnt(7)
s_add_u32 s57,s56,1048576
buffer_load_dwordx4 v[72:75],v0,s[4:7],s57 offen
s_waitcnt vmcnt(7)
s_add_u32 s57,s56,1179648
buffer_load_dwordx4 v[72:75],v0,s[4:7],s57 offen
s_waitcnt vmcnt(7)
s_add_u32 s57,s56,1310720
buffer_load_dwordx4 v[72:75],v0,s[4:7],s57 offen
s_waitcnt vmcnt(7)
s_add_u32 s57,s56,1441792
buffer_load_dwordx4 v[72:75],v0,s[4:7],s57 offen
s_waitcnt vmcnt(7)
s_add_u32 s57,s56,1572864
buffer_load_dwordx4 v[72:75],v0,s[4:7],s57 offen
s_waitcnt vmcnt(7)
s_add_u32 s57,s56,1703936
buffer_load_dwordx4 v[72:75],v0,s[4:7],s57 offen
s_waitcnt vmcnt(7)
s_add_u32 s57,s56,1835008
buffer_load_dwordx4 v[72:75],v0,s[4:7],s57 offen
s_waitcnt vmcnt(7)
s_add_u32 s57,s56,1966080
buffer_load_dwordx4 v[72:75],v0,s[4:7],s57 offen
s_waitcnt vmcnt(7)
s_add_u32 s57,s56,2097152
buffer_load_dwordx4 v[72:75],v0,s[4:7],s57 offen
s_waitcnt vmcnt(7)
s_add_u32 s57,s56,2228224
buffer_load_dwordx4 v[72:75],v0,s[4:7],s57 offen
s_waitcnt vmcnt(7)
s_add_u32 s57,s56,2359296
buffer_load_dwordx4 v[72:75],v0,s[4:7],s57 offen
s_waitcnt vmcnt(7)
s_add_u32 s57,s56,2490368
buffer_load_dwordx4 v[72:75],v0,s[4:7],s57 offen
s_waitcnt vmcnt(7)
s_add_u32 s57,s56,2621440
buffer_load_dwordx4 v[72:75],v0,s[4:7],s57 offen
s_waitcnt vmcnt(7)
s_add_u32 s57,s56,2752512
buffer_load_dwordx4 v[72:75],v0,s[4:7],s57 offen
s_waitcnt vmcnt(7)
s_add_u32 s57,s56,2883584
buffer_load_dwordx4 v[72:75],v0,s[4:7],s57 offen
s_waitcnt vmcnt(7)
s_add_u32 s57,s56,3014656
buffer_load_dwordx4 v[72:75],v0,s[4:7],s57 offen
s_waitcnt vmcnt(7)
s_add_u32 s57,s56,3145728
buffer_load_dwordx4 v[72:75],v0,s[4:7],s57 offen
s_waitcnt vmcnt(7)
s_add_u32 s57,s56,3276800
buffer_load_dwordx4 v[72:75],v0,s[4:7],s57 offen
s_waitcnt vmcnt(7)
s_add_u32 s57,s56,3407872
buffer_load_dwordx4 v[72:75],v0,s[4:7],s57 offen
s_waitcnt vmcnt(7)
s_add_u32 s57,s56,3538944
buffer_load_dwordx4 v[72:75],v0,s[4:7],s57 offen
s_waitcnt vmcnt(7)
s_add_u32 s57,s56,3670016
buffer_load_dwordx4 v[72:75],v0,s[4:7],s57 offen
s_waitcnt vmcnt(7)
s_add_u32 s57,s56,3801088
buffer_load_dwordx4 v[72:75],v0,s[4:7],s57 offen
s_waitcnt vmcnt(7)
s_add_u32 s57,s56,3932160
buffer_load_dwordx4 v[72:75],v0,s[4:7],s57 offen
s_waitcnt vmcnt(7)
s_add_u32 s57,s56,4063232
buffer_load_dwordx4 v[72:75],v0,s[4:7],s57 offen
L_rb_7:
s_mov_b32 s4,s26
s_mov_b32 s5,s27
s_mov_b32 s6,4194304
s_mov_b32 s7,0x20000
v_and_b32 v2,15,v1
v_lshlrev_b32 v2,4,v2
v_lshrrev_b32 v3,4,v1
v_lshl_add_u32 v2,v3,13,v2
s_and_b32 s56,s47,15
s_lshl_b32 s56,s56,18
s_lshl_b32 s57,s46,8
s_add_u32 s56,s56,s57
s_mov_b32 s61,0x05040100
s_mov_b32 s62,0x07060302
s_add_u32 s57,s56,0
buffer_load_dwordx4 v[24:27],v2,s[4:7],s57 offen offset:0
buffer_load_dwordx4 v[28:31],v2,s[4:7],s57 offen offset:1024
buffer_load_dwordx4 v[32:35],v2,s[4:7],s57 offen offset:2048
buffer_load_dwordx4 v[36:39],v2,s[4:7],s57 offen offset:3072
s_add_u32 s57,s56,4096
buffer_load_dwordx4 v[40:43],v2,s[4:7],s57 offen offset:0
buffer_load_dwordx4 v[44:47],v2,s[4:7],s57 offen offset:1024
buffer_load_dwordx4 v[48:51],v2,s[4:7],s57 offen offset:2048
buffer_load_dwordx4 v[52:55],v2,s[4:7],s57 offen offset:3072
s_add_u32 s57,s56,32768
buffer_load_dwordx4 v[56:59],v2,s[4:7],s57 offen offset:0
buffer_load_dwordx4 v[60:63],v2,s[4:7],s57 offen offset:1024
buffer_load_dwordx4 v[64:67],v2,s[4:7],s57 offen offset:2048
buffer_load_dwordx4 v[68:71],v2,s[4:7],s57 offen offset:3072
s_add_u32 s57,s56,36864
buffer_load_dwordx4 v[72:75],v2,s[4:7],s57 offen offset:0
buffer_load_dwordx4 v[76:79],v2,s[4:7],s57 offen offset:1024
buffer_load_dwordx4 v[80:83],v2,s[4:7],s57 offen offset:2048
buffer_load_dwordx4 v[84:87],v2,s[4:7],s57 offen offset:3072
s_add_u32 s57,s56,65536
buffer_load_dwordx4 v[88:91],v2,s[4:7],s57 offen offset:0
buffer_load_dwordx4 v[92:95],v2,s[4:7],s57 offen offset:1024
buffer_load_dwordx4 v[96:99],v2,s[4:7],s57 offen offset:2048
buffer_load_dwordx4 v[100:103],v2,s[4:7],s57 offen offset:3072
s_add_u32 s57,s56,69632
buffer_load_dwordx4 v[104:107],v2,s[4:7],s57 offen offset:0
buffer_load_dwordx4 v[108:111],v2,s[4:7],s57 offen offset:1024
buffer_load_dwordx4 v[112:115],v2,s[4:7],s57 offen offset:2048
buffer_load_dwordx4 v[116:119],v2,s[4:7],s57 offen offset:3072
s_add_u32 s57,s56,98304
buffer_load_dwordx4 v[120:123],v2,s[4:7],s57 offen offset:0
buffer_load_dwordx4 v[124:127],v2,s[4:7],s57 offen offset:1024
buffer_load_dwordx4 v[128:131],v2,s[4:7],s57 offen offset:2048
buffer_load_dwordx4 v[132:135],v2,s[4:7],s57 offen offset:3072
s_add_u32 s57,s56,102400
buffer_load_dwordx4 v[136:139],v2,s[4:7],s57 offen offset:0
buffer_load_dwordx4 v[140:143],v2,s[4:7],s57 offen offset:1024
buffer_load_dwordx4 v[144:147],v2,s[4:7],s57 offen offset:2048
buffer_load_dwordx4 v[148:151],v2,s[4:7],s57 offen offset:3072
s_add_u32 s57,s56,131072
buffer_load_dwordx4 v[152:155],v2,s[4:7],s57 offen offset:0
buffer_load_dwordx4 v[156:159],v2,s[4:7],s57 offen offset:1024
buffer_load_dwordx4 v[160:163],v2,s[4:7],s57 offen offset:2048
buffer_load_dwordx4 v[164:167],v2,s[4:7],s57 offen offset:3072
s_add_u32 s57,s56,135168
buffer_load_dwordx4 v[168:171],v2,s[4:7],s57 offen offset:0
buffer_load_dwordx4 v[172:175],v2,s[4:7],s57 offen offset:1024
buffer_load_dwordx4 v[176:179],v2,s[4:7],s57 offen offset:2048
buffer_load_dwordx4 v[180:183],v2,s[4:7],s57 offen offset:3072
s_add_u32 s57,s56,163840
buffer_load_dwordx4 v[184:187],v2,s[4:7],s57 offen offset:0
buffer_load_dwordx4 v[188:191],v2,s[4:7],s57 offen offset:1024
buffer_load_dwordx4 v[192:195],v2,s[4:7],s57 offen offset:2048
buffer_load_dwordx4 v[196:199],v2,s[4:7],s57 offen offset:3072
s_add_u32 s57,s56,167936
buffer_load_dwordx4 v[200:203],v2,s[4:7],s57 offen offset:0
buffer_load_dwordx4 v[204:207],v2,s[4:7],s57 offen offset:1024
buffer_load_dwordx4 v[208:211],v2,s[4:7],s57 offen offset:2048
buffer_load_dwordx4 v[212:215],v2,s[4:7],s57 offen offset:3072
s_waitcnt vmcnt(40)
v_perm_b32 v216,v28,v24,s61
v_perm_b32 v217,v36,v32,s61
v_perm_b32 v218,v44,v40,s61
v_perm_b32 v219,v52,v48,s61
v_accvgpr_write_b32 a0,v216
v_accvgpr_write_b32 a1,v217
v_accvgpr_write_b32 a2,v218
v_accvgpr_write_b32 a3,v219
v_perm_b32 v216,v28,v24,s62
v_perm_b32 v217,v36,v32,s62
v_perm_b32 v218,v44,v40,s62
v_perm_b32 v219,v52,v48,s62
v_accvgpr_write_b32 a4,v216
v_accvgpr_write_b32 a5,v217
v_accvgpr_write_b32 a6,v218
v_accvgpr_write_b32 a7,v219
v_perm_b32 v216,v29,v25,s61
v_perm_b32 v217,v37,v33,s61
v_perm_b32 v218,v45,v41,s61
v_perm_b32 v219,v53,v49,s61
v_accvgpr_write_b32 a8,v216
v_accvgpr_write_b32 a9,v217
v_accvgpr_write_b32 a10,v218
v_accvgpr_write_b32 a11,v219
v_perm_b32 v216,v29,v25,s62
v_perm_b32 v217,v37,v33,s62
v_perm_b32 v218,v45,v41,s62
v_perm_b32 v219,v53,v49,s62
v_accvgpr_write_b32 a12,v216
v_accvgpr_write_b32 a13,v217
v_accvgpr_write_b32 a14,v218
v_accvgpr_write_b32 a15,v219
v_perm_b32 v216,v30,v26,s61
v_perm_b32 v217,v38,v34,s61
v_perm_b32 v218,v46,v42,s61
v_perm_b32 v219,v54,v50,s61
v_accvgpr_write_b32 a16,v216
v_accvgpr_write_b32 a17,v217
v_accvgpr_write_b32 a18,v218
v_accvgpr_write_b32 a19,v219
v_perm_b32 v216,v30,v26,s62
v_perm_b32 v217,v38,v34,s62
v_perm_b32 v218,v46,v42,s62
v_perm_b32 v219,v54,v50,s62
v_accvgpr_write_b32 a20,v216
v_accvgpr_write_b32 a21,v217
v_accvgpr_write_b32 a22,v218
v_accvgpr_write_b32 a23,v219
v_perm_b32 v216,v31,v27,s61
v_perm_b32 v217,v39,v35,s61
v_perm_b32 v218,v47,v43,s61
v_perm_b32 v219,v55,v51,s61
v_accvgpr_write_b32 a24,v216
v_accvgpr_write_b32 a25,v217
v_accvgpr_write_b32 a26,v218
v_accvgpr_write_b32 a27,v219
v_perm_b32 v216,v31,v27,s62
v_perm_b32 v217,v39,v35,s62
v_perm_b32 v218,v47,v43,s62
v_perm_b32 v219,v55,v51,s62
v_accvgpr_write_b32 a28,v216
v_accvgpr_write_b32 a29,v217
v_accvgpr_write_b32 a30,v218
v_accvgpr_write_b32 a31,v219
s_add_u32 s57,s56,196608
buffer_load_dwordx4 v[24:27],v2,s[4:7],s57 offen offset:0
buffer_load_dwordx4 v[28:31],v2,s[4:7],s57 offen offset:1024
buffer_load_dwordx4 v[32:35],v2,s[4:7],s57 offen offset:2048
buffer_load_dwordx4 v[36:39],v2,s[4:7],s57 offen offset:3072
s_add_u32 s57,s56,200704
buffer_load_dwordx4 v[40:43],v2,s[4:7],s57 offen offset:0
buffer_load_dwordx4 v[44:47],v2,s[4:7],s57 offen offset:1024
buffer_load_dwordx4 v[48:51],v2,s[4:7],s57 offen offset:2048
buffer_load_dwordx4 v[52:55],v2,s[4:7],s57 offen offset:3072
s_barrier
s_cmp_lg_u32 s46,0
s_cbranch_scc1 L_ar_77
v_mov_b32 v8,240
v_mov_b32 v9,s53
s_mov_b64 exec,1
buffer_atomic_add v9,v8,s[12:15],0 offen
s_mov_b64 exec,-1
L_ar_77:
s_mov_b32 s53,0
s_waitcnt vmcnt(40)
v_perm_b32 v216,v60,v56,s61
v_perm_b32 v217,v68,v64,s61
v_perm_b32 v218,v76,v72,s61
v_perm_b32 v219,v84,v80,s61
v_accvgpr_write_b32 a32,v216
v_accvgpr_write_b32 a33,v217
v_accvgpr_write_b32 a34,v218
v_accvgpr_write_b32 a35,v219
v_perm_b32 v216,v60,v56,s62
v_perm_b32 v217,v68,v64,s62
v_perm_b32 v218,v76,v72,s62
v_perm_b32 v219,v84,v80,s62
v_accvgpr_write_b32 a36,v216
v_accvgpr_write_b32 a37,v217
v_accvgpr_write_b32 a38,v218
v_accvgpr_write_b32 a39,v219
v_perm_b32 v216,v61,v57,s61
v_perm_b32 v217,v69,v65,s61
v_perm_b32 v218,v77,v73,s61
v_perm_b32 v219,v85,v81,s61
v_accvgpr_write_b32 a40,v216
v_accvgpr_write_b32 a41,v217
v_accvgpr_write_b32 a42,v218
v_accvgpr_write_b32 a43,v219
v_perm_b32 v216,v61,v57,s62
v_perm_b32 v217,v69,v65,s62
v_perm_b32 v218,v77,v73,s62
v_perm_b32 v219,v85,v81,s62
v_accvgpr_write_b32 a44,v216
v_accvgpr_write_b32 a45,v217
v_accvgpr_write_b32 a46,v218
v_accvgpr_write_b32 a47,v219
v_perm_b32 v216,v62,v58,s61
v_perm_b32 v217,v70,v66,s61
v_perm_b32 v218,v78,v74,s61
v_perm_b32 v219,v86,v82,s61
v_accvgpr_write_b32 a48,v216
v_accvgpr_write_b32 a49,v217
v_accvgpr_write_b32 a50,v218
v_accvgpr_write_b32 a51,v219
v_perm_b32 v216,v62,v58,s62
v_perm_b32 v217,v70,v66,s62
v_perm_b32 v218,v78,v74,s62
v_perm_b32 v219,v86,v82,s62
v_accvgpr_write_b32 a52,v216
v_accvgpr_write_b32 a53,v217
v_accvgpr_write_b32 a54,v218
v_accvgpr_write_b32 a55,v219
v_perm_b32 v216,v63,v59,s61
v_perm_b32 v217,v71,v67,s61
v_perm_b32 v218,v79,v75,s61
v_perm_b32 v219,v87,v83,s61
v_accvgpr_write_b32 a56,v216
v_accvgpr_write_b32 a57,v217
v_accvgpr_write_b32 a58,v218
v_accvgpr_write_b32 a59,v219
v_perm_b32 v216,v63,v59,s62
v_perm_b32 v217,v71,v67,s62
v_perm_b32 v218,v79,v75,s62
v_perm_b32 v219,v87,v83,s62
v_accvgpr_write_b32 a60,v216
v_accvgpr_write_b32 a61,v217
v_accvgpr_write_b32 a62,v218
v_accvgpr_write_b32 a63,v219
s_add_u32 s57,s56,229376
buffer_load_dwordx4 v[56:59],v2,s[4:7],s57 offen offset:0
buffer_load_dwordx4 v[60:63],v2,s[4:7],s57 offen offset:1024
buffer_load_dwordx4 v[64:67],v2,s[4:7],s57 offen offset:2048
buffer_load_dwordx4 v[68:71],v2,s[4:7],s57 offen offset:3072
s_add_u32 s57,s56,233472
buffer_load_dwordx4 v[72:75],v2,s[4:7],s57 offen offset:0
buffer_load_dwordx4 v[76:79],v2,s[4:7],s57 offen offset:1024
buffer_load_dwordx4 v[80:83],v2,s[4:7],s57 offen offset:2048
buffer_load_dwordx4 v[84:87],v2,s[4:7],s57 offen offset:3072
s_waitcnt vmcnt(40)
v_perm_b32 v216,v92,v88,s61
v_perm_b32 v217,v100,v96,s61
v_perm_b32 v218,v108,v104,s61
v_perm_b32 v219,v116,v112,s61
v_accvgpr_write_b32 a64,v216
v_accvgpr_write_b32 a65,v217
v_accvgpr_write_b32 a66,v218
v_accvgpr_write_b32 a67,v219
v_perm_b32 v216,v92,v88,s62
v_perm_b32 v217,v100,v96,s62
v_perm_b32 v218,v108,v104,s62
v_perm_b32 v219,v116,v112,s62
v_accvgpr_write_b32 a68,v216
v_accvgpr_write_b32 a69,v217
v_accvgpr_write_b32 a70,v218
v_accvgpr_write_b32 a71,v219
v_perm_b32 v216,v93,v89,s61
v_perm_b32 v217,v101,v97,s61
v_perm_b32 v218,v109,v105,s61
v_perm_b32 v219,v117,v113,s61
v_accvgpr_write_b32 a72,v216
v_accvgpr_write_b32 a73,v217
v_accvgpr_write_b32 a74,v218
v_accvgpr_write_b32 a75,v219
v_perm_b32 v216,v93,v89,s62
v_perm_b32 v217,v101,v97,s62
v_perm_b32 v218,v109,v105,s62
v_perm_b32 v219,v117,v113,s62
v_accvgpr_write_b32 a76,v216
v_accvgpr_write_b32 a77,v217
v_accvgpr_write_b32 a78,v218
v_accvgpr_write_b32 a79,v219
v_perm_b32 v216,v94,v90,s61
v_perm_b32 v217,v102,v98,s61
v_perm_b32 v218,v110,v106,s61
v_perm_b32 v219,v118,v114,s61
v_accvgpr_write_b32 a80,v216
v_accvgpr_write_b32 a81,v217
v_accvgpr_write_b32 a82,v218
v_accvgpr_write_b32 a83,v219
v_perm_b32 v216,v94,v90,s62
v_perm_b32 v217,v102,v98,s62
v_perm_b32 v218,v110,v106,s62
v_perm_b32 v219,v118,v114,s62
v_accvgpr_write_b32 a84,v216
v_accvgpr_write_b32 a85,v217
v_accvgpr_write_b32 a86,v218
v_accvgpr_write_b32 a87,v219
v_perm_b32 v216,v95,v91,s61
v_perm_b32 v217,v103,v99,s61
v_perm_b32 v218,v111,v107,s61
v_perm_b32 v219,v119,v115,s61
v_accvgpr_write_b32 a88,v216
v_accvgpr_write_b32 a89,v217
v_accvgpr_write_b32 a90,v218
v_accvgpr_write_b32 a91,v219
v_perm_b32 v216,v95,v91,s62
v_perm_b32 v217,v103,v99,s62
v_perm_b32 v218,v111,v107,s62
v_perm_b32 v219,v119,v115,s62
v_accvgpr_write_b32 a92,v216
v_accvgpr_write_b32 a93,v217
v_accvgpr_write_b32 a94,v218
v_accvgpr_write_b32 a95,v219
s_waitcnt vmcnt(32)
v_perm_b32 v216,v124,v120,s61
v_perm_b32 v217,v132,v128,s61
v_perm_b32 v218,v140,v136,s61
v_perm_b32 v219,v148,v144,s61
v_accvgpr_write_b32 a96,v216
v_accvgpr_write_b32 a97,v217
v_accvgpr_write_b32 a98,v218
v_accvgpr_write_b32 a99,v219
v_perm_b32 v216,v124,v120,s62
v_perm_b32 v217,v132,v128,s62
v_perm_b32 v218,v140,v136,s62
v_perm_b32 v219,v148,v144,s62
v_accvgpr_write_b32 a100,v216
v_accvgpr_write_b32 a101,v217
v_accvgpr_write_b32 a102,v218
v_accvgpr_write_b32 a103,v219
v_perm_b32 v216,v125,v121,s61
v_perm_b32 v217,v133,v129,s61
v_perm_b32 v218,v141,v137,s61
v_perm_b32 v219,v149,v145,s61
v_accvgpr_write_b32 a104,v216
v_accvgpr_write_b32 a105,v217
v_accvgpr_write_b32 a106,v218
v_accvgpr_write_b32 a107,v219
v_perm_b32 v216,v125,v121,s62
v_perm_b32 v217,v133,v129,s62
v_perm_b32 v218,v141,v137,s62
v_perm_b32 v219,v149,v145,s62
v_accvgpr_write_b32 a108,v216
v_accvgpr_write_b32 a109,v217
v_accvgpr_write_b32 a110,v218
v_accvgpr_write_b32 a111,v219
v_perm_b32 v216,v126,v122,s61
v_perm_b32 v217,v134,v130,s61
v_perm_b32 v218,v142,v138,s61
v_perm_b32 v219,v150,v146,s61
v_accvgpr_write_b32 a112,v216
v_accvgpr_write_b32 a113,v217
v_accvgpr_write_b32 a114,v218
v_accvgpr_write_b32 a115,v219
v_perm_b32 v216,v126,v122,s62
v_perm_b32 v217,v134,v130,s62
v_perm_b32 v218,v142,v138,s62
v_perm_b32 v219,v150,v146,s62
v_accvgpr_write_b32 a116,v216
v_accvgpr_write_b32 a117,v217
v_accvgpr_write_b32 a118,v218
v_accvgpr_write_b32 a119,v219
v_perm_b32 v216,v127,v123,s61
v_perm_b32 v217,v135,v131,s61
v_perm_b32 v218,v143,v139,s61
v_perm_b32 v219,v151,v147,s61
v_accvgpr_write_b32 a120,v216
v_accvgpr_write_b32 a121,v217
v_accvgpr_write_b32 a122,v218
v_accvgpr_write_b32 a123,v219
v_perm_b32 v216,v127,v123,s62
v_perm_b32 v217,v135,v131,s62
v_perm_b32 v218,v143,v139,s62
v_perm_b32 v219,v151,v147,s62
v_accvgpr_write_b32 a124,v216
v_accvgpr_write_b32 a125,v217
v_accvgpr_write_b32 a126,v218
v_accvgpr_write_b32 a127,v219
s_waitcnt vmcnt(24)
v_perm_b32 v216,v156,v152,s61
v_perm_b32 v217,v164,v160,s61
v_perm_b32 v218,v172,v168,s61
v_perm_b32 v219,v180,v176,s61
v_accvgpr_write_b32 a128,v216
v_accvgpr_write_b32 a129,v217
v_accvgpr_write_b32 a130,v218
v_accvgpr_write_b32 a131,v219
v_perm_b32 v216,v156,v152,s62
v_perm_b32 v217,v164,v160,s62
v_perm_b32 v218,v172,v168,s62
v_perm_b32 v219,v180,v176,s62
v_accvgpr_write_b32 a132,v216
v_accvgpr_write_b32 a133,v217
v_accvgpr_write_b32 a134,v218
v_accvgpr_write_b32 a135,v219
v_perm_b32 v216,v157,v153,s61
v_perm_b32 v217,v165,v161,s61
v_perm_b32 v218,v173,v169,s61
v_perm_b32 v219,v181,v177,s61
v_accvgpr_write_b32 a136,v216
v_accvgpr_write_b32 a137,v217
v_accvgpr_write_b32 a138,v218
v_accvgpr_write_b32 a139,v219
v_perm_b32 v216,v157,v153,s62
v_perm_b32 v217,v165,v161,s62
v_perm_b32 v218,v173,v169,s62
v_perm_b32 v219,v181,v177,s62
v_accvgpr_write_b32 a140,v216
v_accvgpr_write_b32 a141,v217
v_accvgpr_write_b32 a142,v218
v_accvgpr_write_b32 a143,v219
v_perm_b32 v216,v158,v154,s61
v_perm_b32 v217,v166,v162,s61
v_perm_b32 v218,v174,v170,s61
v_perm_b32 v219,v182,v178,s61
v_accvgpr_write_b32 a144,v216
v_accvgpr_write_b32 a145,v217
v_accvgpr_write_b32 a146,v218
v_accvgpr_write_b32 a147,v219
v_perm_b32 v216,v158,v154,s62
v_perm_b32 v217,v166,v162,s62
v_perm_b32 v218,v174,v170,s62
v_perm_b32 v219,v182,v178,s62
v_accvgpr_write_b32 a148,v216
v_accvgpr_write_b32 a149,v217
v_accvgpr_write_b32 a150,v218
v_accvgpr_write_b32 a151,v219
v_perm_b32 v216,v159,v155,s61
v_perm_b32 v217,v167,v163,s61
v_perm_b32 v218,v175,v171,s61
v_perm_b32 v219,v183,v179,s61
v_accvgpr_write_b32 a152,v216
v_accvgpr_write_b32 a153,v217
v_accvgpr_write_b32 a154,v218
v_accvgpr_write_b32 a155,v219
v_perm_b32 v216,v159,v155,s62
v_perm_b32 v217,v167,v163,s62
v_perm_b32 v218,v175,v171,s62
v_perm_b32 v219,v183,v179,s62
v_accvgpr_write_b32 a156,v216
v_accvgpr_write_b32 a157,v217
v_accvgpr_write_b32 a158,v218
v_accvgpr_write_b32 a159,v219
s_waitcnt vmcnt(16)
v_perm_b32 v216,v188,v184,s61
v_perm_b32 v217,v196,v192,s61
v_perm_b32 v218,v204,v200,s61
v_perm_b32 v219,v212,v208,s61
v_accvgpr_write_b32 a160,v216
v_accvgpr_write_b32 a161,v217
v_accvgpr_write_b32 a162,v218
v_accvgpr_write_b32 a163,v219
v_perm_b32 v216,v188,v184,s62
v_perm_b32 v217,v196,v192,s62
v_perm_b32 v218,v204,v200,s62
v_perm_b32 v219,v212,v208,s62
v_accvgpr_write_b32 a164,v216
v_accvgpr_write_b32 a165,v217
v_accvgpr_write_b32 a166,v218
v_accvgpr_write_b32 a167,v219
v_perm_b32 v216,v189,v185,s61
v_perm_b32 v217,v197,v193,s61
v_perm_b32 v218,v205,v201,s61
v_perm_b32 v219,v213,v209,s61
v_accvgpr_write_b32 a168,v216
v_accvgpr_write_b32 a169,v217
v_accvgpr_write_b32 a170,v218
v_accvgpr_write_b32 a171,v219
v_perm_b32 v216,v189,v185,s62
v_perm_b32 v217,v197,v193,s62
v_perm_b32 v218,v205,v201,s62
v_perm_b32 v219,v213,v209,s62
v_accvgpr_write_b32 a172,v216
v_accvgpr_write_b32 a173,v217
v_accvgpr_write_b32 a174,v218
v_accvgpr_write_b32 a175,v219
v_perm_b32 v216,v190,v186,s61
v_perm_b32 v217,v198,v194,s61
v_perm_b32 v218,v206,v202,s61
v_perm_b32 v219,v214,v210,s61
v_accvgpr_write_b32 a176,v216
v_accvgpr_write_b32 a177,v217
v_accvgpr_write_b32 a178,v218
v_accvgpr_write_b32 a179,v219
v_perm_b32 v216,v190,v186,s62
v_perm_b32 v217,v198,v194,s62
v_perm_b32 v218,v206,v202,s62
v_perm_b32 v219,v214,v210,s62
v_accvgpr_write_b32 a180,v216
v_accvgpr_write_b32 a181,v217
v_accvgpr_write_b32 a182,v218
v_accvgpr_write_b32 a183,v219
v_perm_b32 v216,v191,v187,s61
v_perm_b32 v217,v199,v195,s61
v_perm_b32 v218,v207,v203,s61
v_perm_b32 v219,v215,v211,s61
v_accvgpr_write_b32 a184,v216
v_accvgpr_write_b32 a185,v217
v_accvgpr_write_b32 a186,v218
v_accvgpr_write_b32 a187,v219
v_perm_b32 v216,v191,v187,s62
v_perm_b32 v217,v199,v195,s62
v_perm_b32 v218,v207,v203,s62
v_perm_b32 v219,v215,v211,s62
v_accvgpr_write_b32 a188,v216
v_accvgpr_write_b32 a189,v217
v_accvgpr_write_b32 a190,v218
v_accvgpr_write_b32 a191,v219
s_waitcnt vmcnt(8)
v_perm_b32 v216,v28,v24,s61
v_perm_b32 v217,v36,v32,s61
v_perm_b32 v218,v44,v40,s61
v_perm_b32 v219,v52,v48,s61
v_accvgpr_write_b32 a192,v216
v_accvgpr_write_b32 a193,v217
v_accvgpr_write_b32 a194,v218
v_accvgpr_write_b32 a195,v219
v_perm_b32 v216,v28,v24,s62
v_perm_b32 v217,v36,v32,s62
v_perm_b32 v218,v44,v40,s62
v_perm_b32 v219,v52,v48,s62
v_accvgpr_write_b32 a196,v216
v_accvgpr_write_b32 a197,v217
v_accvgpr_write_b32 a198,v218
v_accvgpr_write_b32 a199,v219
v_perm_b32 v216,v29,v25,s61
v_perm_b32 v217,v37,v33,s61
v_perm_b32 v218,v45,v41,s61
v_perm_b32 v219,v53,v49,s61
v_accvgpr_write_b32 a200,v216
v_accvgpr_write_b32 a201,v217
v_accvgpr_write_b32 a202,v218
v_accvgpr_write_b32 a203,v219
v_perm_b32 v216,v29,v25,s62
v_perm_b32 v217,v37,v33,s62
v_perm_b32 v218,v45,v41,s62
v_perm_b32 v219,v53,v49,s62
v_accvgpr_write_b32 a204,v216
v_accvgpr_write_b32 a205,v217
v_accvgpr_write_b32 a206,v218
v_accvgpr_write_b32 a207,v219
v_perm_b32 v216,v30,v26,s61
v_perm_b32 v217,v38,v34,s61
v_perm_b32 v218,v46,v42,s61
v_perm_b32 v219,v54,v50,s61
v_accvgpr_write_b32 a208,v216
v_accvgpr_write_b32 a209,v217
v_accvgpr_write_b32 a210,v218
v_accvgpr_write_b32 a211,v219
v_perm_b32 v216,v30,v26,s62
v_perm_b32 v217,v38,v34,s62
v_perm_b32 v218,v46,v42,s62
v_perm_b32 v219,v54,v50,s62
v_accvgpr_write_b32 a212,v216
v_accvgpr_write_b32 a213,v217
v_accvgpr_write_b32 a214,v218
v_accvgpr_write_b32 a215,v219
v_perm_b32 v216,v31,v27,s61
v_perm_b32 v217,v39,v35,s61
v_perm_b32 v218,v47,v43,s61
v_perm_b32 v219,v55,v51,s61
v_accvgpr_write_b32 a216,v216
v_accvgpr_write_b32 a217,v217
v_accvgpr_write_b32 a218,v218
v_accvgpr_write_b32 a219,v219
v_perm_b32 v216,v31,v27,s62
v_perm_b32 v217,v39,v35,s62
v_perm_b32 v218,v47,v43,s62
v_perm_b32 v219,v55,v51,s62
v_accvgpr_write_b32 a220,v216
v_accvgpr_write_b32 a221,v217
v_accvgpr_write_b32 a222,v218
v_accvgpr_write_b32 a223,v219
s_waitcnt vmcnt(0)
v_perm_b32 v216,v60,v56,s61
v_perm_b32 v217,v68,v64,s61
v_perm_b32 v218,v76,v72,s61
v_perm_b32 v219,v84,v80,s61
v_accvgpr_write_b32 a224,v216
v_accvgpr_write_b32 a225,v217
v_accvgpr_write_b32 a226,v218
v_accvgpr_write_b32 a227,v219
v_perm_b32 v216,v60,v56,s62
v_perm_b32 v217,v68,v64,s62
v_perm_b32 v218,v76,v72,s62
v_perm_b32 v219,v84,v80,s62
v_accvgpr_write_b32 a228,v216
v_accvgpr_write_b32 a229,v217
v_accvgpr_write_b32 a230,v218
v_accvgpr_write_b32 a231,v219
v_perm_b32 v216,v61,v57,s61
v_perm_b32 v217,v69,v65,s61
v_perm_b32 v218,v77,v73,s61
v_perm_b32 v219,v85,v81,s61
v_accvgpr_write_b32 a232,v216
v_accvgpr_write_b32 a233,v217
v_accvgpr_write_b32 a234,v218
v_accvgpr_write_b32 a235,v219
v_perm_b32 v216,v61,v57,s62
v_perm_b32 v217,v69,v65,s62
v_perm_b32 v218,v77,v73,s62
v_perm_b32 v219,v85,v81,s62
v_accvgpr_write_b32 a236,v216
v_accvgpr_write_b32 a237,v217
v_accvgpr_write_b32 a238,v218
v_accvgpr_write_b32 a239,v219
v_perm_b32 v216,v62,v58,s61
v_perm_b32 v217,v70,v66,s61
v_perm_b32 v218,v78,v74,s61
v_perm_b32 v219,v86,v82,s61
v_accvgpr_write_b32 a240,v216
v_accvgpr_write_b32 a241,v217
v_accvgpr_write_b32 a242,v218
v_accvgpr_write_b32 a243,v219
v_perm_b32 v216,v62,v58,s62
v_perm_b32 v217,v70,v66,s62
v_perm_b32 v218,v78,v74,s62
v_perm_b32 v219,v86,v82,s62
v_accvgpr_write_b32 a244,v216
v_accvgpr_write_b32 a245,v217
v_accvgpr_write_b32 a246,v218
v_accvgpr_write_b32 a247,v219
v_perm_b32 v216,v63,v59,s61
v_perm_b32 v217,v71,v67,s61
v_perm_b32 v218,v79,v75,s61
v_perm_b32 v219,v87,v83,s61
v_accvgpr_write_b32 a248,v216
v_accvgpr_write_b32 a249,v217
v_accvgpr_write_b32 a250,v218
v_accvgpr_write_b32 a251,v219
v_perm_b32 v216,v63,v59,s62
v_perm_b32 v217,v71,v67,s62
v_perm_b32 v218,v79,v75,s62
v_perm_b32 v219,v87,v83,s62
v_accvgpr_write_b32 a252,v216
v_accvgpr_write_b32 a253,v217
v_accvgpr_write_b32 a254,v218
v_accvgpr_write_b32 a255,v219
v_mov_b32 v123,159744
s_cmp_lg_u32 s46,0
s_cbranch_scc1 L_gbd_79
v_mov_b32 v124,240
L_gb_78:
buffer_load_dword v125,v124,s[12:15],0 offen sc1
s_waitcnt vmcnt(0)
v_readfirstlane_b32 s56,v125
ds_write_b32 v123,v125
s_bitcmp1_b32 s56,8
s_cbranch_scc1 L_gbd_79
s_sleep 4
s_sub_u32 s49,s49,1
s_cmp_gt_i32 s49,0
s_cbranch_scc1 L_gb_78
s_branch L_abort
L_gbd_79:
s_waitcnt lgkmcnt(0)
s_barrier
ds_read_b32 v125,v123
s_waitcnt lgkmcnt(0)
v_readfirstlane_b32 s56,v125
s_barrier
s_lshr_b32 s56,s56,16
s_andn2_b32 s56,s56,s3
s_cbranch_scc1 L_spread
s_max_u32 s54,s48,5
s_sub_u32 s54,s54,5
s_lshl_b32 s54,s54,1
s_lshr_b32 s56,s47,4
s_add_u32 s54,s54,s56
s_cmp_lg_u32 s3,0
s_cbranch_scc1 L_wa
v_and_b32 v238,15,v1
v_and_b32 v239,1,v1
v_lshlrev_b32 v239,4,v239
v_mov_b32 v240,0x3f80
v_lshlrev_b32 v240,v239,v240
v_lshrrev_b32 v238,1,v238
v_cmp_eq_u32 vcc,0,v238
s_nop 1
v_cndmask_b32 v156,0,v240,vcc
v_cmp_eq_u32 vcc,1,v238
s_nop 1
v_cndmask_b32 v157,0,v240,vcc
v_cmp_eq_u32 vcc,2,v238
s_nop 1
v_cndmask_b32 v158,0,v240,vcc
v_cmp_eq_u32 vcc,3,v238
s_nop 1
v_cndmask_b32 v159,0,v240,vcc
s_mov_b32 s4,s32
s_mov_b32 s5,s33
s_mov_b32 s6,1024
s_mov_b32 s7,0x20000
buffer_load_dwordx4 v[224:227],v0,s[4:7],0 offen
v_and_b32 v238,15,v1
v_lshrrev_b32 v239,4,v1
v_lshlrev_b32 v240,2,v239
v_mov_b32 v241,0xf149f2ca
s_and_b32 s56,s46,1
s_lshl_b32 s56,s56,4
v_add_u32 v242,s56,v238
v_add_u32 v243,0,v240
v_cmp_gt_u32 vcc,v243,v242
s_nop 1
v_cndmask_b32 v8,0,v241,vcc
v_add_u32 v243,1,v240
v_cmp_gt_u32 vcc,v243,v242
s_nop 1
v_cndmask_b32 v9,0,v241,vcc
v_add_u32 v243,2,v240
v_cmp_gt_u32 vcc,v243,v242
s_nop 1
v_cndmask_b32 v10,0,v241,vcc
v_add_u32 v243,3,v240
v_cmp_gt_u32 vcc,v243,v242
s_nop 1
v_cndmask_b32 v11,0,v241,vcc
v_add_u32 v243,16,v240
v_cmp_gt_u32 vcc,v243,v242
s_nop 1
v_cndmask_b32 v12,0,v241,vcc
v_add_u32 v243,17,v240
v_cmp_gt_u32 vcc,v243,v242
s_nop 1
v_cndmask_b32 v13,0,v241,vcc
v_add_u32 v243,18,v240
v_cmp_gt_u32 vcc,v243,v242
s_nop 1
v_cndmask_b32 v14,0,v241,vcc
v_add_u32 v243,19,v240
v_cmp_gt_u32 vcc,v243,v242
s_nop 1
v_cndmask_b32 v15,0,v241,vcc
v_mov_b32 v152,s80
v_mov_b32 v145,0
v_mov_b32 v146,0
s_lshl_b32 s56,s46,12
s_add_u32 s56,s56,131072
v_add_u32 v3,s56,v0
v_add_u32 v4,131072,v0
s_lshl_b32 s56,s46,8
v_lshlrev_b32 v7,4,v238
v_add_u32 v7,s56,v7
v_lshl_add_u32 v5,v239,16,v7
v_lshlrev_b32 v6,1,v7
v_lshl_add_u32 v7,v239,10,v7
v_and_b32 v243,1,v239
v_lshl_add_u32 v6,v243,4,v6
v_lshrrev_b32 v243,1,v239
v_lshl_add_u32 v6,v243,12,v6
v_add_u32 v6,147456,v6
v_lshlrev_b32 v16,2,v1
v_lshlrev_b32 v21,3,v238
s_and_b32 s68,s47,15
s_lshl_b32 s56,s68,10
v_add_u32 v5,s56,v5
s_lshl_b32 s56,s68,15
v_add_u32 v7,s56,v7
s_lshl_b32 s69,s54,20
s_add_u32 s69,s69,20971520
s_lshl_b32 s87,s54,13
s_add_u32 s87,s87,10486272
s_lshl4_add_u32 s74,s68,s87
s_lshl2_add_u32 s74,s46,s74
s_lshl_b32 s68,s68,1
s_lshr_b32 s56,s46,1
s_add_u32 s68,s68,s56
s_mov_b32 s66,0
s_mov_b32 s67,0
s_mov_b32 s73,0x80000000
s_mov_b32 s75,0
s_mov_b32 s37,0
s_mov_b32 s42,4294966272
s_mov_b32 s43,4294967295
s_mov_b64 s[38:39],0
s_sub_u32 s36,s54,12
s_and_b32 s36,s36,3
s_mov_b32 s12,s40
s_mov_b32 s13,s41
s_mov_b32 s14,2097152
s_mov_b32 s15,0x20000
s_and_b32 s29,s46,1
s_mul_i32 s28,s29,12288
s_lshl_b32 s29,s29,11
s_and_b32 s56,s50,2048
s_lshl_b32 s56,s56,4
s_add_u32 s56,s56,65536
s_add_u32 s40,s56,s28
s_add_u32 s41,s56,s29
v_add_u32 v21,10487168,v21
v_mov_b32 v244,v21
s_and_b32 s56,s50,2048
s_add_u32 s56,s56,147456
v_lshlrev_b32 v23,5,v1
v_add_u32 v23,s56,v23
v_and_b32 v253,32,v0
v_lshrrev_b32 v245,2,v253
v_add_u32 v253,v253,v245
v_sub_u32 v253,v0,v253
v_add_u32 v253,8,v253
v_mov_b32 v254,0x80000000
s_mov_b32 s56,1408
v_writelane_b32 v254,s56,0
s_mov_b32 s56,256
v_writelane_b32 v254,s56,1
s_mov_b32 s56,1280
v_writelane_b32 v254,s56,2
v_mov_b32 v245,155648
s_lshl_b32 s56,s46,2
v_add_u32 v247,s56,v245
s_waitcnt vmcnt(0)
v_lshlrev_b32 v228,16,v224
v_and_b32 v229,0xffff0000,v224
v_lshlrev_b32 v230,16,v225
v_and_b32 v231,0xffff0000,v225
v_lshlrev_b32 v232,16,v226
v_and_b32 v233,0xffff0000,v226
v_lshlrev_b32 v234,16,v227
v_and_b32 v235,0xffff0000,v227
v_mul_f32 v255,v228,v228
v_fma_f32 v255,v229,v229,v255
v_fma_f32 v255,v230,v230,v255
v_fma_f32 v255,v231,v231,v255
v_fma_f32 v255,v232,v232,v255
v_fma_f32 v255,v233,v233,v255
v_fma_f32 v255,v234,v234,v255
v_fma_f32 v255,v235,v235,v255
s_nop 1
v_add_f32_dpp v255,v255,v255 row_ror:8 row_mask:0xf bank_mask:0xf
s_nop 1
v_add_f32_dpp v255,v255,v255 row_ror:4 row_mask:0xf bank_mask:0xf
s_nop 1
v_add_f32_dpp v255,v255,v255 row_ror:2 row_mask:0xf bank_mask:0xf
s_nop 1
v_add_f32_dpp v255,v255,v255 row_ror:1 row_mask:0xf bank_mask:0xf
v_mov_b32 v238,v255
s_nop 1
v_permlane16_swap_b32 v255,v238
v_add_f32 v255,v255,v238
v_mov_b32 v238,v255
s_nop 1
v_permlane32_swap_b32 v255,v238
v_add_f32 v255,v255,v238
v_sqrt_f32 v255,v255
v_sub_u32 v238,67,v1
v_cvt_f32_u32 v238,v238
v_log_f32 v238,v238
v_mov_b32 v239,0x3ff9999a
v_fmac_f32 v239,0x3e632166,v238
v_mul_f32 v255,v255,v239
v_or_b32 v255,0x80000000,v255
s_xor_b32 s34,s69,524288
buffer_load_dwordx4 v[160:163],v7,s[8:11],s34 offen
s_add_u32 s34,s34,4096
buffer_load_dwordx4 v[164:167],v7,s[8:11],s34 offen
s_add_u32 s34,s34,4096
buffer_load_dwordx4 v[168:171],v7,s[8:11],s34 offen
s_add_u32 s34,s34,4096
buffer_load_dwordx4 v[172:175],v7,s[8:11],s34 offen
s_add_u32 s34,s34,4096
buffer_load_dwordx4 v[176:179],v7,s[8:11],s34 offen
s_add_u32 s34,s34,4096
buffer_load_dwordx4 v[180:183],v7,s[8:11],s34 offen
s_add_u32 s34,s34,4096
buffer_load_dwordx4 v[184:187],v7,s[8:11],s34 offen
s_add_u32 s34,s34,4096
buffer_load_dwordx4 v[188:191],v7,s[8:11],s34 offen
s_xor_b32 s69,s69,524288
s_xor_b32 s34,s69,524288
buffer_load_dwordx4 v[160:163],v7,s[8:11],s34 offen
s_add_u32 s34,s34,4096
buffer_load_dwordx4 v[164:167],v7,s[8:11],s34 offen
s_add_u32 s34,s34,4096
buffer_load_dwordx4 v[168:171],v7,s[8:11],s34 offen
s_add_u32 s34,s34,4096
buffer_load_dwordx4 v[172:175],v7,s[8:11],s34 offen
s_add_u32 s34,s34,4096
buffer_load_dwordx4 v[176:179],v7,s[8:11],s34 offen
s_add_u32 s34,s34,4096
buffer_load_dwordx4 v[180:183],v7,s[8:11],s34 offen
s_add_u32 s34,s34,4096
buffer_load_dwordx4 v[184:187],v7,s[8:11],s34 offen
s_add_u32 s34,s34,4096
buffer_load_dwordx4 v[188:191],v7,s[8:11],s34 offen
s_xor_b32 s69,s69,524288
s_cmp_lt_u32 s54,2
s_cbranch_scc1 L_aa_80
s_sub_u32 s77,s54,2
s_mov_b32 s30,0
s_mov_b32 s86,1536
s_lshl_b32 s56,s77,5
s_add_u32 s56,s56,s68
s_mul_i32 s70,s56,24576
s_lshl_b32 s71,s56,12
s_lshl_b32 s59,s77,13
s_lshl2_add_u32 s59,s68,s59
s_add_u32 s59,s59,10485760
s_buffer_load_dword s32,s[8:11],s59
s_mov_b32 s33,1
s_add_u32 s70,s70,100663296
s_add_u32 s71,s71,41943040
v_mov_b32 v19,s59
s_branch L_aa_88
L_aa_94:
s_bitcmp1_b32 s46,0
s_cbranch_scc1 L_av_95
ds_read_b128 v[24:27],v4 offset:0
ds_read_b128 v[28:31],v4 offset:1024
s_min_u32 s56,s32,s33
s_cmp_lt_u32 s77,64
s_cselect_b32 s56,s56,0
s_cmp_eq_u32 s56,0
s_cselect_b32 s72,0x80000000,0
v_mov_b32 v248,s72
s_or_b32 s64,s70,s72
s_or_b32 s65,s71,s72
s_cmp_lt_u32 s30,s31
s_cselect_b32 s65,0x80000000,s65
s_add_u32 s64,s64,s28
s_add_u32 s65,s65,s29
s_xor_b32 s58,s67,s40
s_xor_b32 s57,s67,s41
s_add_u32 m0,s58,0
s_waitcnt lgkmcnt(1)
v_mfma_f32_16x16x32_bf16 v[160:163],v[24:27],a[0:3],0
buffer_load_dwordx4 v0,s[8:11],s64 offen offset:0 sc1 lds
v_mfma_f32_16x16x32_bf16 v[164:167],v[24:27],a[4:7],0
ds_read_b128 v[32:35],v4 offset:2048
v_lshlrev_b32 v88,16,v224
v_mfma_f32_16x16x32_bf16 v[168:171],v[24:27],a[8:11],0
ds_read_b128 v[36:39],v4 offset:3072
v_and_b32 v89,0xffff0000,v224
v_mfma_f32_16x16x32_bf16 v[172:175],v[24:27],a[12:15],0
ds_read_b128 v[40:43],v4 offset:8192
v_lshlrev_b32 v90,16,v225
v_mfma_f32_16x16x32_bf16 v[176:179],v[24:27],a[16:19],0
ds_read_b128 v[44:47],v4 offset:9216
v_and_b32 v91,0xffff0000,v225
v_mfma_f32_16x16x32_bf16 v[180:183],v[24:27],a[20:23],0
buffer_load_dwordx4 v0,s[8:11],s64 offen offset:1024 sc1 lds
v_mfma_f32_16x16x32_bf16 v[184:187],v[24:27],a[24:27],0
ds_read_b128 v[48:51],v4 offset:10240
s_waitcnt vmcnt(9)
v_mfma_f32_16x16x32_bf16 v[188:191],v[24:27],a[28:31],0
ds_read_b128 v[52:55],v4 offset:11264
v_mfma_f32_16x16x32_bf16 v[128:131],v[156:159],v[192:195],0
ds_write_b32 v247,v248
v_lshlrev_b32 v92,16,v226
s_waitcnt lgkmcnt(7)
v_mfma_f32_16x16x32_bf16 v[160:163],v[28:31],a[32:35],v[160:163]
ds_read_b128 v[56:59],v4 offset:4096
s_waitcnt vmcnt(8)
v_mfma_f32_16x16x32_bf16 v[164:167],v[28:31],a[36:39],v[164:167]
ds_read_b128 v[60:63],v4 offset:5120
v_mfma_f32_16x16x32_bf16 v[128:131],v[156:159],v[196:199],v[128:131]
ds_read_b128 v[64:67],v4 offset:6144
v_and_b32 v93,0xffff0000,v226
v_mfma_f32_16x16x32_bf16 v[168:171],v[28:31],a[40:43],v[168:171]
buffer_load_dwordx4 v0,s[8:11],s64 offen offset:2048 sc1 lds
v_mfma_f32_16x16x32_bf16 v[172:175],v[28:31],a[44:47],v[172:175]
ds_read_b128 v[68:71],v4 offset:7168
s_waitcnt vmcnt(8)
v_mfma_f32_16x16x32_bf16 v[176:179],v[28:31],a[48:51],v[176:179]
ds_read_b128 v[72:75],v4 offset:12288
v_mfma_f32_16x16x32_bf16 v[128:131],v[156:159],v[200:203],v[128:131]
ds_read_b128 v[76:79],v4 offset:13312
v_lshlrev_b32 v94,16,v227
v_mfma_f32_16x16x32_bf16 v[180:183],v[28:31],a[52:55],v[180:183]
ds_read_b128 v[80:83],v4 offset:14336
s_waitcnt vmcnt(7)
v_mfma_f32_16x16x32_bf16 v[184:187],v[28:31],a[56:59],v[184:187]
ds_read_b128 v[84:87],v4 offset:15360
v_mfma_f32_16x16x32_bf16 v[128:131],v[156:159],v[204:207],v[128:131]
v_and_b32 v95,0xffff0000,v227
v_readfirstlane_b32 s22,v246
v_mfma_f32_16x16x32_bf16 v[188:191],v[28:31],a[60:63],v[188:191]
buffer_load_dwordx4 v0,s[8:11],s64 offen offset:3072 sc1 lds
s_waitcnt lgkmcnt(14)
v_mfma_f32_16x16x32_bf16 v[160:163],v[32:35],a[64:67],v[160:163]
s_waitcnt vmcnt(7)
v_mfma_f32_16x16x32_bf16 v[132:135],v[156:159],v[208:211],0
s_cmp_eq_u32 s22,0
s_cbranch_scc1 L_ag_96
L_agb_97:
v_mfma_f32_16x16x32_bf16 v[164:167],v[32:35],a[68:71],v[164:167]
s_waitcnt vmcnt(6)
v_mfma_f32_16x16x32_bf16 v[132:135],v[156:159],v[212:215],v[132:135]
s_lshl_b32 s18,s26,5
s_add_u32 s18,s18,s68
s_lshl_b32 s19,s18,10
v_mfma_f32_16x16x32_bf16 v[168:171],v[32:35],a[72:75],v[168:171]
s_waitcnt vmcnt(5)
v_mfma_f32_16x16x32_bf16 v[132:135],v[156:159],v[216:219],v[132:135]
s_add_u32 s20,s19,6291456
s_lshl_b32 s23,s51,5
s_add_u32 s23,s23,s68
v_mfma_f32_16x16x32_bf16 v[172:175],v[32:35],a[76:79],v[172:175]
ds_write_b128 v6,v[128:131]
v_mfma_f32_16x16x32_bf16 v[176:179],v[32:35],a[80:83],v[176:179]
s_waitcnt vmcnt(4)
v_mfma_f32_16x16x32_bf16 v[132:135],v[156:159],v[220:223],v[132:135]
s_add_u32 m0,s58,4096
s_add_u32 s64,s64,4096
s_lshl_b32 s24,s23,10
v_mfma_f32_16x16x32_bf16 v[180:183],v[32:35],a[84:87],v[180:183]
buffer_load_dwordx4 v0,s[8:11],s64 offen offset:0 sc1 lds
v_mfma_f32_16x16x32_bf16 v[184:187],v[32:35],a[88:91],v[184:187]
s_lshl_b32 s25,s51,10
s_add_u32 s25,s25,2883584
s_cmp_eq_u32 s23,s55
s_cselect_b32 s25,s25,s24
v_mfma_f32_16x16x32_bf16 v[188:191],v[32:35],a[92:95],v[188:191]
ds_write_b128 v6,v[132:135] offset:2048
s_waitcnt lgkmcnt(15)
v_mfma_f32_16x16x32_bf16 v[160:163],v[36:39],a[96:99],v[160:163]
s_add_u32 s25,s25,8388608
s_mov_b32 s6,268435456
s_cmp_eq_u32 s31,0
s_cselect_b32 s25,s24,s25
s_cselect_b64 s[4:5],s[16:17],s[44:45]
s_cmov_b32 s6,2097152
v_mfma_f32_16x16x32_bf16 v[164:167],v[36:39],a[100:103],v[164:167]
buffer_load_dwordx4 v[224:227],v0,s[4:7],s25 offen sc1
v_mfma_f32_16x16x32_bf16 v[168:171],v[36:39],a[104:107],v[168:171]
buffer_load_dwordx4 v0,s[8:11],s64 offen offset:1024 sc1 lds
v_mfma_f32_16x16x32_bf16 v[172:175],v[36:39],a[108:111],v[172:175]
s_lshr_b32 s24,s55,5
s_cmp_lt_u32 s51,s24
s_cselect_b32 s24,1,2
v_mfma_f32_16x16x32_bf16 v[176:179],v[36:39],a[112:115],v[176:179]
s_waitcnt lgkmcnt(0)
s_barrier
v_mov_b32 v252,s24
v_mfma_f32_16x16x32_bf16 v[180:183],v[36:39],a[116:119],v[180:183]
ds_read_b128 v[96:99],v23
s_lshl2_add_u32 s25,s51,11018240
v_mfma_f32_16x16x32_bf16 v[184:187],v[36:39],a[120:123],v[184:187]
ds_read_b128 v[100:103],v23 offset:16
s_lshl_b32 s24,s68,16
v_mfma_f32_16x16x32_bf16 v[188:191],v[36:39],a[124:127],v[188:191]
buffer_load_dwordx4 v0,s[8:11],s64 offen offset:2048 sc1 lds
s_add_u32 s24,s24,s31
v_mfma_f32_16x16x32_bf16 v[160:163],v[40:43],a[128:131],v[160:163]
ds_read_b128 v[248:251],v245
s_add_u32 s24,s24,s86
s_cmp_eq_u32 s24,1537
s_cselect_b32 s25,s25,0x80000000
v_mfma_f32_16x16x32_bf16 v[164:167],v[40:43],a[132:135],v[164:167]
buffer_store_dword v252,off,s[8:11],s25 sc1
s_bitcmp1_b64 s[38:39],s51
s_cselect_b32 s24,128,0
v_mfma_f32_16x16x32_bf16 v[168:171],v[40:43],a[136:139],v[168:171]
buffer_store_dword v20,off,s[8:11],s73 sc1
s_lshl_b32 s23,s51,13
v_mfma_f32_16x16x32_bf16 v[172:175],v[40:43],a[140:143],v[172:175]
s_lshl2_add_u32 s23,s68,s23
s_add_u32 s23,s23,10487168
s_add_u32 s23,s23,s24
s_mov_b32 s73,0x80000000
v_mfma_f32_16x16x32_bf16 v[176:179],v[40:43],a[144:147],v[176:179]
buffer_load_dwordx4 v0,s[8:11],s64 offen offset:3072 sc1 lds
v_mfma_f32_16x16x32_bf16 v[180:183],v[40:43],a[148:151],v[180:183]
buffer_load_dword v246,off,s[8:11],s23 sc1
v_lshrrev_b32 v244,4,v1
v_mfma_f32_16x16x32_bf16 v[184:187],v[40:43],a[152:155],v[184:187]
s_waitcnt lgkmcnt(0)
v_or3_b32 v248,v248,v249,v250
v_or_b32 v248,v248,v251
s_sub_u32 s23,s77,7
v_mfma_f32_16x16x32_bf16 v[188:191],v[40:43],a[156:159],v[188:191]
v_readfirstlane_b32 s72,v248
v_add_u32 v244,s23,v244
v_max_i32 v244,0,v244
v_mfma_f32_16x16x32_bf16 v[160:163],v[44:47],a[160:163],v[160:163]
s_waitcnt lgkmcnt(1)
v_lshl_add_u32 v244,v244,13,v21
v_cvt_pk_bf16_f32 v104,v96,v97
v_cvt_pk_bf16_f32 v105,v98,v99
v_mfma_f32_16x16x32_bf16 v[164:167],v[44:47],a[164:167],v[164:167]
buffer_load_dwordx2 v[242:243],v244,s[8:11],0 offen sc1
s_add_u32 m0,s58,8192
v_mfma_f32_16x16x32_bf16 v[168:171],v[44:47],a[168:171],v[168:171]
s_add_u32 s64,s64,4096
v_cvt_pk_bf16_f32 v106,v100,v101
v_cvt_pk_bf16_f32 v107,v102,v103
v_lshlrev_b32 v96,16,v104
v_mfma_f32_16x16x32_bf16 v[172:175],v[44:47],a[172:175],v[172:175]
buffer_load_dwordx4 v0,s[8:11],s64 offen offset:0 sc1 lds
v_and_b32 v97,0xffff0000,v104
v_mfma_f32_16x16x32_bf16 v[176:179],v[44:47],a[176:179],v[176:179]
v_lshlrev_b32 v98,16,v105
v_and_b32 v99,0xffff0000,v105
v_lshlrev_b32 v100,16,v106
v_mfma_f32_16x16x32_bf16 v[180:183],v[44:47],a[180:183],v[180:183]
v_and_b32 v101,0xffff0000,v106
v_lshlrev_b32 v102,16,v107
v_and_b32 v103,0xffff0000,v107
v_mfma_f32_16x16x32_bf16 v[184:187],v[44:47],a[184:187],v[184:187]
v_add_f32 v88,v88,v96
v_add_f32 v89,v89,v97
v_add_f32 v90,v90,v98
v_mfma_f32_16x16x32_bf16 v[188:191],v[44:47],a[188:191],v[188:191]
v_add_f32 v91,v91,v99
v_add_f32 v92,v92,v100
v_add_f32 v93,v93,v101
v_mfma_f32_16x16x32_bf16 v[160:163],v[48:51],a[192:195],v[160:163]
buffer_load_dwordx4 v0,s[8:11],s64 offen offset:1024 sc1 lds
v_add_f32 v94,v94,v102
v_mfma_f32_16x16x32_bf16 v[164:167],v[48:51],a[196:199],v[164:167]
v_add_f32 v95,v95,v103
v_cvt_pk_bf16_f32 v104,v88,v89
v_cvt_pk_bf16_f32 v105,v90,v91
v_mfma_f32_16x16x32_bf16 v[168:171],v[48:51],a[200:203],v[168:171]
v_cvt_pk_bf16_f32 v106,v92,v93
v_cvt_pk_bf16_f32 v107,v94,v95
v_mfma_f32_16x16x32_bf16 v[172:175],v[48:51],a[204:207],v[172:175]
buffer_store_dwordx4 v[104:107],v0,s[8:11],s20 offen sc1
v_lshlrev_b32 v88,16,v104
v_mfma_f32_16x16x32_bf16 v[176:179],v[48:51],a[208:211],v[176:179]
v_and_b32 v89,0xffff0000,v104
v_lshlrev_b32 v90,16,v105
v_and_b32 v91,0xffff0000,v105
v_mfma_f32_16x16x32_bf16 v[180:183],v[48:51],a[212:215],v[180:183]
buffer_load_dwordx4 v0,s[8:11],s64 offen offset:2048 sc1 lds
v_lshlrev_b32 v92,16,v106
v_mfma_f32_16x16x32_bf16 v[184:187],v[48:51],a[216:219],v[184:187]
v_and_b32 v93,0xffff0000,v106
v_lshlrev_b32 v94,16,v107
v_and_b32 v95,0xffff0000,v107
v_mfma_f32_16x16x32_bf16 v[188:191],v[48:51],a[220:223],v[188:191]
v_readfirstlane_b32 s78,v88
v_mfma_f32_16x16x32_bf16 v[160:163],v[52:55],a[224:227],v[160:163]
s_nop 0
v_add_f32 v120,v88,-s78
v_add_f32 v121,v89,-s78
v_add_f32 v122,v90,-s78
v_mfma_f32_16x16x32_bf16 v[164:167],v[52:55],a[228:231],v[164:167]
v_add_f32 v123,v91,-s78
v_add_f32 v124,v92,-s78
v_add_f32 v125,v93,-s78
v_mfma_f32_16x16x32_bf16 v[168:171],v[52:55],a[232:235],v[168:171]
buffer_load_dwordx4 v0,s[8:11],s64 offen offset:3072 sc1 lds
v_add_f32 v126,v94,-s78
v_mfma_f32_16x16x32_bf16 v[172:175],v[52:55],a[236:239],v[172:175]
v_add_f32 v127,v95,-s78
v_add_f32 v128,v120,v122
v_add_f32 v129,v121,v123
v_mfma_f32_16x16x32_bf16 v[176:179],v[52:55],a[240:243],v[176:179]
v_mul_f32 v130,v120,v120
v_mul_f32 v131,v121,v121
v_add_f32 v132,v124,v126
v_mfma_f32_16x16x32_bf16 v[180:183],v[52:55],a[244:247],v[180:183]
v_add_f32 v133,v125,v127
v_fma_f32 v130,v122,v122,v130
v_fma_f32 v131,v123,v123,v131
v_mfma_f32_16x16x32_bf16 v[184:187],v[52:55],a[248:251],v[184:187]
v_add_f32 v128,v128,v132
v_add_f32 v129,v129,v133
v_fma_f32 v130,v124,v124,v130
v_mfma_f32_16x16x32_bf16 v[188:191],v[52:55],a[252:255],v[188:191]
s_add_u32 m0,s57,24576
v_fma_f32 v131,v125,v125,v131
v_add_f32 v128,v128,v129
v_fma_f32 v130,v126,v126,v130
v_mfma_f32_16x16x32_bf16 v[192:195],v[56:59],a[0:3],0
buffer_load_dwordx4 v0,s[8:11],s65 offen offset:0 sc1 lds
v_fma_f32 v131,v127,v127,v131
v_mfma_f32_16x16x32_bf16 v[196:199],v[56:59],a[4:7],0
v_add_f32 v130,v130,v131
v_mfma_f32_16x16x32_bf16 v[200:203],v[56:59],a[8:11],0
s_nop 0
v_permlane32_swap_b32 v128,v130
v_add_f32 v128,v128,v130
v_cvt_pk_bf16_f32 v24,v160,v164
v_mfma_f32_16x16x32_bf16 v[204:207],v[56:59],a[12:15],0
v_add_f32_dpp v128,v128,v128 row_ror:8 row_mask:0xf bank_mask:0xf
v_cvt_pk_bf16_f32 v25,v168,v172
v_cvt_pk_bf16_f32 v26,v176,v180
v_mfma_f32_16x16x32_bf16 v[208:211],v[56:59],a[16:19],0
v_add_f32_dpp v128,v128,v128 row_ror:4 row_mask:0xf bank_mask:0xf
v_cvt_pk_bf16_f32 v27,v184,v188
v_cvt_pk_bf16_f32 v28,v161,v165
v_mfma_f32_16x16x32_bf16 v[212:215],v[56:59],a[20:23],0
buffer_load_dwordx4 v0,s[8:11],s65 offen offset:1024 sc1 lds
v_add_f32_dpp v128,v128,v128 row_ror:2 row_mask:0xf bank_mask:0xf
v_mfma_f32_16x16x32_bf16 v[216:219],v[56:59],a[24:27],0
s_nop 0
v_add_f32_dpp v128,v128,v128 row_ror:1 row_mask:0xf bank_mask:0xf
v_mov_b32 v130,v128
v_cvt_pk_bf16_f32 v29,v169,v173
v_mfma_f32_16x16x32_bf16 v[220:223],v[56:59],a[28:31],0
v_permlane16_swap_b32 v128,v130
v_add_f32 v128,v128,v130
v_mul_f32 v128,0x3b000000,v128
v_mfma_f32_16x16x32_bf16 v[192:195],v[60:63],a[32:35],v[192:195]
v_mov_b32 v130,v128
v_cvt_pk_bf16_f32 v30,v177,v181
v_cvt_pk_bf16_f32 v31,v185,v189
v_mfma_f32_16x16x32_bf16 v[196:199],v[60:63],a[36:39],v[196:199]
v_permlane32_swap_b32 v128,v130
v_fma_f32 v130,-v128,v128,v130
v_add_f32 v128,s78,v128
v_mfma_f32_16x16x32_bf16 v[200:203],v[60:63],a[40:43],v[200:203]
v_max_f32 v130,0,v130
v_cvt_pk_bf16_f32 v130,v128,v130
v_lshlrev_b32 v128,16,v130
v_mfma_f32_16x16x32_bf16 v[204:207],v[60:63],a[44:47],v[204:207]
v_and_b32 v130,0xffff0000,v130
v_add_f32 v130,0x3727c5ac,v130
v_cvt_pk_bf16_f32 v130,v130,v130
v_mfma_f32_16x16x32_bf16 v[208:211],v[60:63],a[48:51],v[208:211]
v_and_b32 v130,0xffff0000,v130
v_sqrt_f32 v130,v130
v_add_f32 v120,v88,-v128
v_mfma_f32_16x16x32_bf16 v[212:215],v[60:63],a[52:55],v[212:215]
v_add_f32 v121,v89,-v128
v_add_f32 v122,v90,-v128
v_add_f32 v123,v91,-v128
v_mfma_f32_16x16x32_bf16 v[216:219],v[60:63],a[56:59],v[216:219]
v_add_f32 v124,v92,-v128
v_add_f32 v125,v93,-v128
v_add_f32 v126,v94,-v128
v_mfma_f32_16x16x32_bf16 v[220:223],v[60:63],a[60:63],v[220:223]
v_add_f32 v127,v95,-v128
v_cvt_pk_bf16_f32 v130,v130,v130
v_and_b32 v130,0xffff0000,v130
v_mfma_f32_16x16x32_bf16 v[192:195],v[64:67],a[64:67],v[192:195]
v_rcp_f32 v130,v130
v_cvt_pk_bf16_f32 v108,v120,v121
v_cvt_pk_bf16_f32 v109,v122,v123
v_mfma_f32_16x16x32_bf16 v[196:199],v[64:67],a[68:71],v[196:199]
v_cvt_pk_bf16_f32 v110,v124,v125
v_cvt_pk_bf16_f32 v111,v126,v127
v_lshlrev_b32 v120,16,v108
v_mfma_f32_16x16x32_bf16 v[200:203],v[64:67],a[72:75],v[200:203]
v_and_b32 v121,0xffff0000,v108
v_lshlrev_b32 v122,16,v109
v_and_b32 v123,0xffff0000,v109
v_mfma_f32_16x16x32_bf16 v[204:207],v[64:67],a[76:79],v[204:207]
v_lshlrev_b32 v124,16,v110
v_and_b32 v125,0xffff0000,v110
v_lshlrev_b32 v126,16,v111
v_mfma_f32_16x16x32_bf16 v[208:211],v[64:67],a[80:83],v[208:211]
v_cvt_pk_bf16_f32 v32,v162,v166
v_cvt_pk_bf16_f32 v33,v170,v174
v_cvt_pk_bf16_f32 v34,v178,v182
v_mfma_f32_16x16x32_bf16 v[212:215],v[64:67],a[84:87],v[212:215]
v_cvt_pk_bf16_f32 v35,v186,v190
v_cvt_pk_bf16_f32 v36,v163,v167
v_cvt_pk_bf16_f32 v37,v171,v175
v_mfma_f32_16x16x32_bf16 v[216:219],v[64:67],a[88:91],v[216:219]
v_cvt_pk_bf16_f32 v38,v179,v183
v_cvt_pk_bf16_f32 v39,v187,v191
v_and_b32 v127,0xffff0000,v111
v_mfma_f32_16x16x32_bf16 v[220:223],v[64:67],a[92:95],v[220:223]
v_mul_f32 v120,v120,v130
v_mul_f32 v121,v121,v130
v_mul_f32 v122,v122,v130
v_mfma_f32_16x16x32_bf16 v[192:195],v[68:71],a[96:99],v[192:195]
v_mul_f32 v123,v123,v130
v_mul_f32 v124,v124,v130
v_mul_f32 v125,v125,v130
v_mfma_f32_16x16x32_bf16 v[196:199],v[68:71],a[100:103],v[196:199]
v_mul_f32 v126,v126,v130
v_mul_f32 v127,v127,v130
v_cvt_pk_bf16_f32 v108,v120,v121
v_mfma_f32_16x16x32_bf16 v[200:203],v[68:71],a[104:107],v[200:203]
v_cvt_pk_bf16_f32 v109,v122,v123
v_cvt_pk_bf16_f32 v110,v124,v125
v_cvt_pk_bf16_f32 v111,v126,v127
v_mfma_f32_16x16x32_bf16 v[204:207],v[68:71],a[108:111],v[204:207]
v_lshlrev_b32 v112,16,v108
v_and_b32 v113,0xffff0000,v108
v_lshlrev_b32 v114,16,v109
v_mfma_f32_16x16x32_bf16 v[208:211],v[68:71],a[112:115],v[208:211]
s_add_u32 s62,s69,0
v_and_b32 v115,0xffff0000,v109
v_lshlrev_b32 v116,16,v110
v_and_b32 v117,0xffff0000,v110
v_mfma_f32_16x16x32_bf16 v[212:215],v[68:71],a[116:119],v[212:215]
buffer_store_dwordx4 v[24:27],v5,s[8:11],s62 offen
v_lshlrev_b32 v118,16,v111
v_mfma_f32_16x16x32_bf16 v[216:219],v[68:71],a[120:123],v[216:219]
v_and_b32 v119,0xffff0000,v111
v_add_f32 v88,v88,v112
v_add_f32 v89,v89,v113
v_mfma_f32_16x16x32_bf16 v[220:223],v[68:71],a[124:127],v[220:223]
v_add_f32 v90,v90,v114
v_add_f32 v91,v91,v115
v_add_f32 v92,v92,v116
v_mfma_f32_16x16x32_bf16 v[192:195],v[72:75],a[128:131],v[192:195]
v_add_f32 v93,v93,v117
v_add_f32 v94,v94,v118
v_add_f32 v95,v95,v119
v_mfma_f32_16x16x32_bf16 v[196:199],v[72:75],a[132:135],v[196:199]
s_add_u32 s62,s69,16384
v_cvt_pk_bf16_f32 v96,v88,v89
v_cvt_pk_bf16_f32 v97,v90,v91
v_cvt_pk_bf16_f32 v98,v92,v93
v_mfma_f32_16x16x32_bf16 v[200:203],v[72:75],a[136:139],v[200:203]
buffer_store_dwordx4 v[28:31],v5,s[8:11],s62 offen
v_cvt_pk_bf16_f32 v99,v94,v95
v_mfma_f32_16x16x32_bf16 v[204:207],v[72:75],a[140:143],v[204:207]
buffer_store_dwordx4 v[96:99],v0,s[12:15],s19 offen sc1
v_mul_f32 v236,v112,v228
v_mfma_f32_16x16x32_bf16 v[208:211],v[72:75],a[144:147],v[208:211]
v_mul_f32 v237,v113,v229
v_fma_f32 v236,v114,v230,v236
v_fma_f32 v237,v115,v231,v237
v_mfma_f32_16x16x32_bf16 v[212:215],v[72:75],a[148:151],v[212:215]
v_fma_f32 v236,v116,v232,v236
v_fma_f32 v237,v117,v233,v237
v_fma_f32 v236,v118,v234,v236
v_mfma_f32_16x16x32_bf16 v[216:219],v[72:75],a[152:155],v[216:219]
s_add_u32 s62,s69,32768
v_fma_f32 v237,v119,v235,v237
v_add_f32 v236,v236,v237
v_mfma_f32_16x16x32_bf16 v[220:223],v[72:75],a[156:159],v[220:223]
buffer_store_dwordx4 v[32:35],v5,s[8:11],s62 offen
v_add_f32_dpp v236,v236,v236 row_ror:8 row_mask:0xf bank_mask:0xf
v_mfma_f32_16x16x32_bf16 v[192:195],v[76:79],a[160:163],v[192:195]
s_nop 0
v_add_f32_dpp v236,v236,v236 row_ror:4 row_mask:0xf bank_mask:0xf
v_mfma_f32_16x16x32_bf16 v[196:199],v[76:79],a[164:167],v[196:199]
s_nop 0
v_add_f32_dpp v236,v236,v236 row_ror:2 row_mask:0xf bank_mask:0xf
v_mfma_f32_16x16x32_bf16 v[200:203],v[76:79],a[168:171],v[200:203]
s_nop 0
v_add_f32_dpp v236,v236,v236 row_ror:1 row_mask:0xf bank_mask:0xf
v_mov_b32 v237,v236
v_mfma_f32_16x16x32_bf16 v[204:207],v[76:79],a[172:175],v[204:207]
s_add_u32 s62,s69,49152
v_permlane16_swap_b32 v236,v237
v_add_f32 v236,v236,v237
v_mov_b32 v237,v236
v_mfma_f32_16x16x32_bf16 v[208:211],v[76:79],a[176:179],v[208:211]
buffer_store_dwordx4 v[36:39],v5,s[8:11],s62 offen
v_permlane32_swap_b32 v236,v237
v_mfma_f32_16x16x32_bf16 v[212:215],v[76:79],a[180:183],v[212:215]
v_add_f32 v236,v236,v237
v_cvt_pk_bf16_f32 v236,v236,v236
v_and_b32 v236,0xffff0000,v236
v_mfma_f32_16x16x32_bf16 v[216:219],v[76:79],a[184:187],v[216:219]
v_ashrrev_i32 v237,31,v236
v_or_b32 v237,0x80000000,v237
v_xor_b32 v236,v236,v237
v_mfma_f32_16x16x32_bf16 v[220:223],v[76:79],a[188:191],v[220:223]
v_and_b32 v236,0xffff0000,v236
s_sub_u32 s20,4095,s18
v_or_b32 v20,s20,v236
v_mfma_f32_16x16x32_bf16 v[192:195],v[80:83],a[192:195],v[192:195]
s_lshl_b32 s73,s26,13
s_lshl2_add_u32 s73,s68,s73
s_add_u32 s73,s73,10485760
s_add_u32 s73,s73,s86
v_mfma_f32_16x16x32_bf16 v[196:199],v[80:83],a[196:199],v[196:199]
v_mfma_f32_16x16x32_bf16 v[192:195],v[84:87],a[224:227],v[192:195]
v_mfma_f32_16x16x32_bf16 v[196:199],v[84:87],a[228:231],v[196:199]
v_mfma_f32_16x16x32_bf16 v[200:203],v[80:83],a[200:203],v[200:203]
v_mfma_f32_16x16x32_bf16 v[204:207],v[80:83],a[204:207],v[204:207]
v_mfma_f32_16x16x32_bf16 v[200:203],v[84:87],a[232:235],v[200:203]
v_mfma_f32_16x16x32_bf16 v[204:207],v[84:87],a[236:239],v[204:207]
v_cvt_pk_bf16_f32 v40,v192,v196
v_cvt_pk_bf16_f32 v44,v193,v197
v_cvt_pk_bf16_f32 v48,v194,v198
v_mfma_f32_16x16x32_bf16 v[208:211],v[80:83],a[208:211],v[208:211]
v_cvt_pk_bf16_f32 v52,v195,v199
v_mfma_f32_16x16x32_bf16 v[212:215],v[80:83],a[212:215],v[212:215]
v_cvt_pk_bf16_f32 v41,v200,v204
v_cvt_pk_bf16_f32 v45,v201,v205
v_cvt_pk_bf16_f32 v49,v202,v206
v_mfma_f32_16x16x32_bf16 v[208:211],v[84:87],a[240:243],v[208:211]
v_cvt_pk_bf16_f32 v53,v203,v207
v_mfma_f32_16x16x32_bf16 v[212:215],v[84:87],a[244:247],v[212:215]
v_mfma_f32_16x16x32_bf16 v[216:219],v[80:83],a[216:219],v[216:219]
v_mfma_f32_16x16x32_bf16 v[220:223],v[80:83],a[220:223],v[220:223]
v_mfma_f32_16x16x32_bf16 v[216:219],v[84:87],a[248:251],v[216:219]
v_mfma_f32_16x16x32_bf16 v[220:223],v[84:87],a[252:255],v[220:223]
v_cvt_pk_bf16_f32 v42,v208,v212
v_cvt_pk_bf16_f32 v46,v209,v213
v_cvt_pk_bf16_f32 v50,v210,v214
v_cvt_pk_bf16_f32 v54,v211,v215
s_nop 3
v_cvt_pk_bf16_f32 v43,v216,v220
s_add_u32 s62,s69,262144
buffer_store_dwordx4 v[40:43],v5,s[8:11],s62 offen
v_cvt_pk_bf16_f32 v47,v217,v221
s_add_u32 s62,s69,278528
buffer_store_dwordx4 v[44:47],v5,s[8:11],s62 offen
v_cvt_pk_bf16_f32 v51,v218,v222
s_add_u32 s62,s69,294912
buffer_store_dwordx4 v[48:51],v5,s[8:11],s62 offen
v_cvt_pk_bf16_f32 v55,v219,v223
s_add_u32 s62,s69,311296
buffer_store_dwordx4 v[52:55],v5,s[8:11],s62 offen
s_cmp_lg_u32 s72,0
s_cbranch_scc1 L_aa_83
s_waitcnt vmcnt(9)
s_branch L_aa_93
L_av_95:
ds_read_b128 v[24:27],v4 offset:0
ds_read_b128 v[28:31],v4 offset:1024
s_min_u32 s56,s32,s33
s_cmp_lt_u32 s77,64
s_cselect_b32 s56,s56,0
s_cmp_eq_u32 s56,0
s_cselect_b32 s72,0x80000000,0
v_mov_b32 v248,s72
s_or_b32 s64,s70,s72
s_or_b32 s65,s71,s72
s_cmp_lt_u32 s30,s31
s_cselect_b32 s65,0x80000000,s65
s_add_u32 s64,s64,s28
s_add_u32 s65,s65,s29
s_xor_b32 s58,s67,s40
s_xor_b32 s57,s67,s41
s_add_u32 m0,s58,0
s_waitcnt lgkmcnt(1)
v_mfma_f32_16x16x32_bf16 v[160:163],v[24:27],a[0:3],0
buffer_load_dwordx4 v0,s[8:11],s64 offen offset:0 sc1 lds
v_mfma_f32_16x16x32_bf16 v[164:167],v[24:27],a[4:7],0
ds_read_b128 v[32:35],v4 offset:2048
s_lshl_b32 s23,s51,5
v_mfma_f32_16x16x32_bf16 v[168:171],v[24:27],a[8:11],0
ds_read_b128 v[36:39],v4 offset:3072
s_add_u32 s23,s23,s68
v_mfma_f32_16x16x32_bf16 v[172:175],v[24:27],a[12:15],0
ds_read_b128 v[40:43],v4 offset:8192
s_lshl_b32 s24,s23,10
v_mfma_f32_16x16x32_bf16 v[176:179],v[24:27],a[16:19],0
ds_read_b128 v[44:47],v4 offset:9216
s_lshl_b32 s25,s51,10
v_mfma_f32_16x16x32_bf16 v[180:183],v[24:27],a[20:23],0
buffer_load_dwordx4 v0,s[8:11],s64 offen offset:1024 sc1 lds
v_mfma_f32_16x16x32_bf16 v[184:187],v[24:27],a[24:27],0
ds_read_b128 v[48:51],v4 offset:10240
s_waitcnt vmcnt(9)
v_mfma_f32_16x16x32_bf16 v[188:191],v[24:27],a[28:31],0
ds_read_b128 v[52:55],v4 offset:11264
v_mfma_f32_16x16x32_bf16 v[128:131],v[156:159],v[192:195],0
ds_write_b32 v247,v248
s_add_u32 s25,s25,2883584
s_waitcnt lgkmcnt(7)
v_mfma_f32_16x16x32_bf16 v[160:163],v[28:31],a[32:35],v[160:163]
ds_read_b128 v[56:59],v4 offset:4096
s_waitcnt vmcnt(8)
v_mfma_f32_16x16x32_bf16 v[164:167],v[28:31],a[36:39],v[164:167]
ds_read_b128 v[60:63],v4 offset:5120
v_mfma_f32_16x16x32_bf16 v[128:131],v[156:159],v[196:199],v[128:131]
ds_read_b128 v[64:67],v4 offset:6144
s_cmp_eq_u32 s23,s55
s_cselect_b32 s25,s25,s24
v_mfma_f32_16x16x32_bf16 v[168:171],v[28:31],a[40:43],v[168:171]
buffer_load_dwordx4 v0,s[8:11],s64 offen offset:2048 sc1 lds
v_mfma_f32_16x16x32_bf16 v[172:175],v[28:31],a[44:47],v[172:175]
ds_read_b128 v[68:71],v4 offset:7168
s_waitcnt vmcnt(8)
v_mfma_f32_16x16x32_bf16 v[176:179],v[28:31],a[48:51],v[176:179]
ds_read_b128 v[72:75],v4 offset:12288
v_mfma_f32_16x16x32_bf16 v[128:131],v[156:159],v[200:203],v[128:131]
ds_read_b128 v[76:79],v4 offset:13312
s_add_u32 s25,s25,8388608
v_mfma_f32_16x16x32_bf16 v[180:183],v[28:31],a[52:55],v[180:183]
ds_read_b128 v[80:83],v4 offset:14336
s_waitcnt vmcnt(7)
v_mfma_f32_16x16x32_bf16 v[184:187],v[28:31],a[56:59],v[184:187]
ds_read_b128 v[84:87],v4 offset:15360
v_mfma_f32_16x16x32_bf16 v[128:131],v[156:159],v[204:207],v[128:131]
s_mov_b32 s6,268435456
s_cmp_eq_u32 s31,0
s_cselect_b32 s25,s24,s25
s_cselect_b64 s[4:5],s[16:17],s[44:45]
s_cmov_b32 s6,2097152
v_mfma_f32_16x16x32_bf16 v[188:191],v[28:31],a[60:63],v[188:191]
buffer_load_dwordx4 v0,s[8:11],s64 offen offset:3072 sc1 lds
s_waitcnt lgkmcnt(14)
v_mfma_f32_16x16x32_bf16 v[160:163],v[32:35],a[64:67],v[160:163]
buffer_load_dwordx4 v[224:227],v0,s[4:7],s25 offen sc1
v_mfma_f32_16x16x32_bf16 v[164:167],v[32:35],a[68:71],v[164:167]
s_waitcnt vmcnt(8)
v_mfma_f32_16x16x32_bf16 v[132:135],v[156:159],v[208:211],0
s_lshr_b32 s24,s55,5
s_cmp_lt_u32 s51,s24
s_cselect_b32 s24,1,2
v_mfma_f32_16x16x32_bf16 v[168:171],v[32:35],a[72:75],v[168:171]
s_waitcnt vmcnt(7)
v_mfma_f32_16x16x32_bf16 v[132:135],v[156:159],v[212:215],v[132:135]
v_mov_b32 v252,s24
s_lshl2_add_u32 s25,s51,11018240
v_mfma_f32_16x16x32_bf16 v[172:175],v[32:35],a[76:79],v[172:175]
s_waitcnt vmcnt(6)
v_mfma_f32_16x16x32_bf16 v[132:135],v[156:159],v[216:219],v[132:135]
s_lshl_b32 s24,s68,16
s_add_u32 s24,s24,s31
s_add_u32 s24,s24,s86
v_mfma_f32_16x16x32_bf16 v[176:179],v[32:35],a[80:83],v[176:179]
ds_write_b128 v6,v[128:131]
v_mfma_f32_16x16x32_bf16 v[180:183],v[32:35],a[84:87],v[180:183]
s_waitcnt vmcnt(5)
v_mfma_f32_16x16x32_bf16 v[132:135],v[156:159],v[220:223],v[132:135]
s_add_u32 m0,s58,4096
s_add_u32 s64,s64,4096
s_cmp_eq_u32 s24,1537
s_cselect_b32 s25,s25,0x80000000
v_mfma_f32_16x16x32_bf16 v[184:187],v[32:35],a[88:91],v[184:187]
buffer_load_dwordx4 v0,s[8:11],s64 offen offset:0 sc1 lds
v_mfma_f32_16x16x32_bf16 v[188:191],v[32:35],a[92:95],v[188:191]
buffer_store_dword v252,off,s[8:11],s25 sc1
s_waitcnt lgkmcnt(14)
v_mfma_f32_16x16x32_bf16 v[160:163],v[36:39],a[96:99],v[160:163]
ds_write_b128 v6,v[132:135] offset:2048
v_mfma_f32_16x16x32_bf16 v[164:167],v[36:39],a[100:103],v[164:167]
s_bitcmp1_b64 s[38:39],s51
s_cselect_b32 s24,128,0
s_lshl_b32 s23,s51,13
v_mfma_f32_16x16x32_bf16 v[168:171],v[36:39],a[104:107],v[168:171]
s_lshl2_add_u32 s23,s68,s23
s_add_u32 s23,s23,10487168
s_add_u32 s23,s23,s24
v_mfma_f32_16x16x32_bf16 v[172:175],v[36:39],a[108:111],v[172:175]
buffer_load_dwordx4 v0,s[8:11],s64 offen offset:1024 sc1 lds
v_mfma_f32_16x16x32_bf16 v[176:179],v[36:39],a[112:115],v[176:179]
buffer_load_dword v246,off,s[8:11],s23 sc1
v_mfma_f32_16x16x32_bf16 v[180:183],v[36:39],a[116:119],v[180:183]
s_waitcnt lgkmcnt(0)
s_barrier
v_lshrrev_b32 v244,4,v1
v_mfma_f32_16x16x32_bf16 v[184:187],v[36:39],a[120:123],v[184:187]
ds_read_b128 v[248:251],v245
s_sub_u32 s23,s77,7
v_mfma_f32_16x16x32_bf16 v[188:191],v[36:39],a[124:127],v[188:191]
buffer_store_dword v20,off,s[8:11],s73 sc1
v_mfma_f32_16x16x32_bf16 v[160:163],v[40:43],a[128:131],v[160:163]
buffer_load_dwordx4 v0,s[8:11],s64 offen offset:2048 sc1 lds
v_mfma_f32_16x16x32_bf16 v[164:167],v[40:43],a[132:135],v[164:167]
s_mov_b32 s73,0x80000000
v_add_u32 v244,s23,v244
v_max_i32 v244,0,v244
v_mfma_f32_16x16x32_bf16 v[168:171],v[40:43],a[136:139],v[168:171]
v_lshl_add_u32 v244,v244,13,v21
v_mfma_f32_16x16x32_bf16 v[172:175],v[40:43],a[140:143],v[172:175]
buffer_load_dwordx2 v[242:243],v244,s[8:11],0 offen sc1
v_mfma_f32_16x16x32_bf16 v[176:179],v[40:43],a[144:147],v[176:179]
s_waitcnt lgkmcnt(0)
v_or3_b32 v248,v248,v249,v250
v_or_b32 v248,v248,v251
v_mfma_f32_16x16x32_bf16 v[180:183],v[40:43],a[148:151],v[180:183]
buffer_load_dwordx4 v0,s[8:11],s64 offen offset:3072 sc1 lds
v_mfma_f32_16x16x32_bf16 v[184:187],v[40:43],a[152:155],v[184:187]
v_mfma_f32_16x16x32_bf16 v[188:191],v[40:43],a[156:159],v[188:191]
v_readfirstlane_b32 s72,v248
v_mfma_f32_16x16x32_bf16 v[160:163],v[44:47],a[160:163],v[160:163]
v_mfma_f32_16x16x32_bf16 v[164:167],v[44:47],a[164:167],v[164:167]
v_mfma_f32_16x16x32_bf16 v[168:171],v[44:47],a[168:171],v[168:171]
s_add_u32 m0,s58,8192
s_add_u32 s64,s64,4096
v_mfma_f32_16x16x32_bf16 v[172:175],v[44:47],a[172:175],v[172:175]
buffer_load_dwordx4 v0,s[8:11],s64 offen offset:0 sc1 lds
v_mfma_f32_16x16x32_bf16 v[176:179],v[44:47],a[176:179],v[176:179]
v_mfma_f32_16x16x32_bf16 v[180:183],v[44:47],a[180:183],v[180:183]
v_mfma_f32_16x16x32_bf16 v[184:187],v[44:47],a[184:187],v[184:187]
v_mfma_f32_16x16x32_bf16 v[188:191],v[44:47],a[188:191],v[188:191]
v_mfma_f32_16x16x32_bf16 v[160:163],v[48:51],a[192:195],v[160:163]
buffer_load_dwordx4 v0,s[8:11],s64 offen offset:1024 sc1 lds
v_mfma_f32_16x16x32_bf16 v[164:167],v[48:51],a[196:199],v[164:167]
v_mfma_f32_16x16x32_bf16 v[168:171],v[48:51],a[200:203],v[168:171]
v_mfma_f32_16x16x32_bf16 v[172:175],v[48:51],a[204:207],v[172:175]
v_mfma_f32_16x16x32_bf16 v[176:179],v[48:51],a[208:211],v[176:179]
v_mfma_f32_16x16x32_bf16 v[180:183],v[48:51],a[212:215],v[180:183]
buffer_load_dwordx4 v0,s[8:11],s64 offen offset:2048 sc1 lds
v_mfma_f32_16x16x32_bf16 v[184:187],v[48:51],a[216:219],v[184:187]
v_mfma_f32_16x16x32_bf16 v[188:191],v[48:51],a[220:223],v[188:191]
v_mfma_f32_16x16x32_bf16 v[160:163],v[52:55],a[224:227],v[160:163]
v_mfma_f32_16x16x32_bf16 v[164:167],v[52:55],a[228:231],v[164:167]
v_mfma_f32_16x16x32_bf16 v[168:171],v[52:55],a[232:235],v[168:171]
buffer_load_dwordx4 v0,s[8:11],s64 offen offset:3072 sc1 lds
v_mfma_f32_16x16x32_bf16 v[172:175],v[52:55],a[236:239],v[172:175]
v_mfma_f32_16x16x32_bf16 v[176:179],v[52:55],a[240:243],v[176:179]
v_mfma_f32_16x16x32_bf16 v[180:183],v[52:55],a[244:247],v[180:183]
v_mfma_f32_16x16x32_bf16 v[184:187],v[52:55],a[248:251],v[184:187]
v_mfma_f32_16x16x32_bf16 v[188:191],v[52:55],a[252:255],v[188:191]
s_add_u32 m0,s57,24576
v_mfma_f32_16x16x32_bf16 v[192:195],v[56:59],a[0:3],0
buffer_load_dwordx4 v0,s[8:11],s65 offen offset:0 sc1 lds
v_mfma_f32_16x16x32_bf16 v[196:199],v[56:59],a[4:7],0
v_mfma_f32_16x16x32_bf16 v[200:203],v[56:59],a[8:11],0
v_cvt_pk_bf16_f32 v24,v160,v164
v_cvt_pk_bf16_f32 v25,v168,v172
v_mfma_f32_16x16x32_bf16 v[204:207],v[56:59],a[12:15],0
v_cvt_pk_bf16_f32 v26,v176,v180
v_cvt_pk_bf16_f32 v27,v184,v188
v_mfma_f32_16x16x32_bf16 v[208:211],v[56:59],a[16:19],0
v_cvt_pk_bf16_f32 v28,v161,v165
v_cvt_pk_bf16_f32 v29,v169,v173
v_mfma_f32_16x16x32_bf16 v[212:215],v[56:59],a[20:23],0
buffer_load_dwordx4 v0,s[8:11],s65 offen offset:1024 sc1 lds
v_mfma_f32_16x16x32_bf16 v[216:219],v[56:59],a[24:27],0
v_cvt_pk_bf16_f32 v30,v177,v181
v_cvt_pk_bf16_f32 v31,v185,v189
v_mfma_f32_16x16x32_bf16 v[220:223],v[56:59],a[28:31],0
v_cvt_pk_bf16_f32 v32,v162,v166
v_cvt_pk_bf16_f32 v33,v170,v174
v_mfma_f32_16x16x32_bf16 v[192:195],v[60:63],a[32:35],v[192:195]
v_cvt_pk_bf16_f32 v34,v178,v182
v_cvt_pk_bf16_f32 v35,v186,v190
v_mfma_f32_16x16x32_bf16 v[196:199],v[60:63],a[36:39],v[196:199]
v_cvt_pk_bf16_f32 v36,v163,v167
v_cvt_pk_bf16_f32 v37,v171,v175
v_mfma_f32_16x16x32_bf16 v[200:203],v[60:63],a[40:43],v[200:203]
v_cvt_pk_bf16_f32 v38,v179,v183
v_cvt_pk_bf16_f32 v39,v187,v191
v_mfma_f32_16x16x32_bf16 v[204:207],v[60:63],a[44:47],v[204:207]
v_mfma_f32_16x16x32_bf16 v[208:211],v[60:63],a[48:51],v[208:211]
v_mfma_f32_16x16x32_bf16 v[212:215],v[60:63],a[52:55],v[212:215]
v_mfma_f32_16x16x32_bf16 v[216:219],v[60:63],a[56:59],v[216:219]
v_mfma_f32_16x16x32_bf16 v[220:223],v[60:63],a[60:63],v[220:223]
v_mfma_f32_16x16x32_bf16 v[192:195],v[64:67],a[64:67],v[192:195]
v_mfma_f32_16x16x32_bf16 v[196:199],v[64:67],a[68:71],v[196:199]
v_mfma_f32_16x16x32_bf16 v[200:203],v[64:67],a[72:75],v[200:203]
v_mfma_f32_16x16x32_bf16 v[204:207],v[64:67],a[76:79],v[204:207]
v_mfma_f32_16x16x32_bf16 v[208:211],v[64:67],a[80:83],v[208:211]
v_mfma_f32_16x16x32_bf16 v[212:215],v[64:67],a[84:87],v[212:215]
v_mfma_f32_16x16x32_bf16 v[216:219],v[64:67],a[88:91],v[216:219]
v_mfma_f32_16x16x32_bf16 v[220:223],v[64:67],a[92:95],v[220:223]
v_mfma_f32_16x16x32_bf16 v[192:195],v[68:71],a[96:99],v[192:195]
v_mfma_f32_16x16x32_bf16 v[196:199],v[68:71],a[100:103],v[196:199]
v_mfma_f32_16x16x32_bf16 v[200:203],v[68:71],a[104:107],v[200:203]
v_mfma_f32_16x16x32_bf16 v[204:207],v[68:71],a[108:111],v[204:207]
v_mfma_f32_16x16x32_bf16 v[208:211],v[68:71],a[112:115],v[208:211]
s_add_u32 s62,s69,0
v_mfma_f32_16x16x32_bf16 v[212:215],v[68:71],a[116:119],v[212:215]
buffer_store_dwordx4 v[24:27],v5,s[8:11],s62 offen
v_mfma_f32_16x16x32_bf16 v[216:219],v[68:71],a[120:123],v[216:219]
v_mfma_f32_16x16x32_bf16 v[220:223],v[68:71],a[124:127],v[220:223]
v_mfma_f32_16x16x32_bf16 v[192:195],v[72:75],a[128:131],v[192:195]
v_mfma_f32_16x16x32_bf16 v[196:199],v[72:75],a[132:135],v[196:199]
v_mfma_f32_16x16x32_bf16 v[200:203],v[72:75],a[136:139],v[200:203]
s_add_u32 s62,s69,16384
v_mfma_f32_16x16x32_bf16 v[204:207],v[72:75],a[140:143],v[204:207]
buffer_store_dwordx4 v[28:31],v5,s[8:11],s62 offen
v_mfma_f32_16x16x32_bf16 v[208:211],v[72:75],a[144:147],v[208:211]
v_mfma_f32_16x16x32_bf16 v[212:215],v[72:75],a[148:151],v[212:215]
v_mfma_f32_16x16x32_bf16 v[216:219],v[72:75],a[152:155],v[216:219]
v_mfma_f32_16x16x32_bf16 v[220:223],v[72:75],a[156:159],v[220:223]
v_mfma_f32_16x16x32_bf16 v[192:195],v[76:79],a[160:163],v[192:195]
s_add_u32 s62,s69,32768
v_mfma_f32_16x16x32_bf16 v[196:199],v[76:79],a[164:167],v[196:199]
buffer_store_dwordx4 v[32:35],v5,s[8:11],s62 offen
v_mfma_f32_16x16x32_bf16 v[200:203],v[76:79],a[168:171],v[200:203]
v_mfma_f32_16x16x32_bf16 v[204:207],v[76:79],a[172:175],v[204:207]
v_mfma_f32_16x16x32_bf16 v[208:211],v[76:79],a[176:179],v[208:211]
v_mfma_f32_16x16x32_bf16 v[212:215],v[76:79],a[180:183],v[212:215]
v_mfma_f32_16x16x32_bf16 v[216:219],v[76:79],a[184:187],v[216:219]
s_add_u32 s62,s69,49152
v_mfma_f32_16x16x32_bf16 v[220:223],v[76:79],a[188:191],v[220:223]
buffer_store_dwordx4 v[36:39],v5,s[8:11],s62 offen
v_mfma_f32_16x16x32_bf16 v[192:195],v[80:83],a[192:195],v[192:195]
v_mfma_f32_16x16x32_bf16 v[196:199],v[80:83],a[196:199],v[196:199]
v_mfma_f32_16x16x32_bf16 v[192:195],v[84:87],a[224:227],v[192:195]
v_mfma_f32_16x16x32_bf16 v[196:199],v[84:87],a[228:231],v[196:199]
v_mfma_f32_16x16x32_bf16 v[200:203],v[80:83],a[200:203],v[200:203]
v_mfma_f32_16x16x32_bf16 v[204:207],v[80:83],a[204:207],v[204:207]
v_mfma_f32_16x16x32_bf16 v[200:203],v[84:87],a[232:235],v[200:203]
v_mfma_f32_16x16x32_bf16 v[204:207],v[84:87],a[236:239],v[204:207]
v_cvt_pk_bf16_f32 v40,v192,v196
v_cvt_pk_bf16_f32 v44,v193,v197
v_cvt_pk_bf16_f32 v48,v194,v198
v_mfma_f32_16x16x32_bf16 v[208:211],v[80:83],a[208:211],v[208:211]
v_cvt_pk_bf16_f32 v52,v195,v199
v_mfma_f32_16x16x32_bf16 v[212:215],v[80:83],a[212:215],v[212:215]
v_cvt_pk_bf16_f32 v41,v200,v204
v_cvt_pk_bf16_f32 v45,v201,v205
v_cvt_pk_bf16_f32 v49,v202,v206
v_mfma_f32_16x16x32_bf16 v[208:211],v[84:87],a[240:243],v[208:211]
v_cvt_pk_bf16_f32 v53,v203,v207
v_mfma_f32_16x16x32_bf16 v[212:215],v[84:87],a[244:247],v[212:215]
v_mfma_f32_16x16x32_bf16 v[216:219],v[80:83],a[216:219],v[216:219]
v_mfma_f32_16x16x32_bf16 v[220:223],v[80:83],a[220:223],v[220:223]
v_mfma_f32_16x16x32_bf16 v[216:219],v[84:87],a[248:251],v[216:219]
v_mfma_f32_16x16x32_bf16 v[220:223],v[84:87],a[252:255],v[220:223]
v_cvt_pk_bf16_f32 v42,v208,v212
v_cvt_pk_bf16_f32 v46,v209,v213
v_cvt_pk_bf16_f32 v50,v210,v214
v_cvt_pk_bf16_f32 v54,v211,v215
s_nop 3
v_cvt_pk_bf16_f32 v43,v216,v220
s_add_u32 s62,s69,262144
buffer_store_dwordx4 v[40:43],v5,s[8:11],s62 offen
v_cvt_pk_bf16_f32 v47,v217,v221
s_add_u32 s62,s69,278528
buffer_store_dwordx4 v[44:47],v5,s[8:11],s62 offen
v_cvt_pk_bf16_f32 v51,v218,v222
s_add_u32 s62,s69,294912
buffer_store_dwordx4 v[48:51],v5,s[8:11],s62 offen
v_cvt_pk_bf16_f32 v55,v219,v223
s_add_u32 s62,s69,311296
buffer_store_dwordx4 v[52:55],v5,s[8:11],s62 offen
s_cmp_lg_u32 s72,0
s_cbranch_scc1 L_aa_83
s_waitcnt vmcnt(8)
s_branch L_aa_93
L_aa_81:
ds_read_b128 v[24:27],v4 offset:0
ds_read_b128 v[28:31],v4 offset:1024
s_min_u32 s56,s32,s33
s_cmp_lt_u32 s77,64
s_cselect_b32 s56,s56,0
s_cmp_eq_u32 s56,0
s_cselect_b32 s72,0x80000000,0
v_mov_b32 v248,s72
s_or_b32 s64,s70,s72
s_or_b32 s65,s71,s72
s_cmp_lt_u32 s30,s31
s_cselect_b32 s65,0x80000000,s65
s_add_u32 s64,s64,s28
s_add_u32 s65,s65,s29
s_xor_b32 s58,s67,s40
s_xor_b32 s57,s67,s41
s_add_u32 m0,s58,0
s_waitcnt lgkmcnt(1)
v_mfma_f32_16x16x32_bf16 v[160:163],v[24:27],a[0:3],0
buffer_load_dwordx4 v0,s[8:11],s64 offen offset:0 sc1 lds
v_mfma_f32_16x16x32_bf16 v[164:167],v[24:27],a[4:7],0
ds_read_b128 v[32:35],v4 offset:2048
s_lshl_b32 s23,s51,5
v_mfma_f32_16x16x32_bf16 v[168:171],v[24:27],a[8:11],0
ds_read_b128 v[36:39],v4 offset:3072
s_add_u32 s23,s23,s68
v_mfma_f32_16x16x32_bf16 v[172:175],v[24:27],a[12:15],0
ds_read_b128 v[40:43],v4 offset:8192
s_lshl_b32 s24,s23,10
v_mfma_f32_16x16x32_bf16 v[176:179],v[24:27],a[16:19],0
ds_read_b128 v[44:47],v4 offset:9216
s_lshl_b32 s25,s51,10
v_mfma_f32_16x16x32_bf16 v[180:183],v[24:27],a[20:23],0
buffer_load_dwordx4 v0,s[8:11],s64 offen offset:1024 sc1 lds
v_mfma_f32_16x16x32_bf16 v[184:187],v[24:27],a[24:27],0
ds_read_b128 v[48:51],v4 offset:10240
s_add_u32 s25,s25,2883584
v_mfma_f32_16x16x32_bf16 v[188:191],v[24:27],a[28:31],0
ds_read_b128 v[52:55],v4 offset:11264
s_cmp_eq_u32 s23,s55
s_cselect_b32 s25,s25,s24
s_waitcnt lgkmcnt(6)
v_mfma_f32_16x16x32_bf16 v[160:163],v[28:31],a[32:35],v[160:163]
ds_write_b32 v247,v248
s_add_u32 s25,s25,8388608
v_mfma_f32_16x16x32_bf16 v[164:167],v[28:31],a[36:39],v[164:167]
ds_read_b128 v[56:59],v4 offset:4096
s_mov_b32 s6,268435456
v_mfma_f32_16x16x32_bf16 v[168:171],v[28:31],a[40:43],v[168:171]
buffer_load_dwordx4 v0,s[8:11],s64 offen offset:2048 sc1 lds
v_mfma_f32_16x16x32_bf16 v[172:175],v[28:31],a[44:47],v[172:175]
ds_read_b128 v[60:63],v4 offset:5120
s_cmp_eq_u32 s31,0
s_cselect_b32 s25,s24,s25
s_cselect_b64 s[4:5],s[16:17],s[44:45]
s_cmov_b32 s6,2097152
v_mfma_f32_16x16x32_bf16 v[176:179],v[28:31],a[48:51],v[176:179]
ds_read_b128 v[64:67],v4 offset:6144
v_mfma_f32_16x16x32_bf16 v[180:183],v[28:31],a[52:55],v[180:183]
ds_read_b128 v[68:71],v4 offset:7168
v_mfma_f32_16x16x32_bf16 v[184:187],v[28:31],a[56:59],v[184:187]
ds_read_b128 v[72:75],v4 offset:12288
v_mfma_f32_16x16x32_bf16 v[188:191],v[28:31],a[60:63],v[188:191]
buffer_load_dwordx4 v0,s[8:11],s64 offen offset:3072 sc1 lds
s_waitcnt lgkmcnt(11)
v_mfma_f32_16x16x32_bf16 v[160:163],v[32:35],a[64:67],v[160:163]
ds_read_b128 v[76:79],v4 offset:13312
v_mfma_f32_16x16x32_bf16 v[164:167],v[32:35],a[68:71],v[164:167]
ds_read_b128 v[80:83],v4 offset:14336
v_mfma_f32_16x16x32_bf16 v[168:171],v[32:35],a[72:75],v[168:171]
ds_read_b128 v[84:87],v4 offset:15360
v_mfma_f32_16x16x32_bf16 v[172:175],v[32:35],a[76:79],v[172:175]
buffer_load_dwordx4 v[224:227],v0,s[4:7],s25 offen sc1
v_mfma_f32_16x16x32_bf16 v[176:179],v[32:35],a[80:83],v[176:179]
s_add_u32 m0,s58,4096
s_add_u32 s64,s64,4096
s_lshr_b32 s24,s55,5
v_mfma_f32_16x16x32_bf16 v[180:183],v[32:35],a[84:87],v[180:183]
buffer_load_dwordx4 v0,s[8:11],s64 offen offset:0 sc1 lds
v_mfma_f32_16x16x32_bf16 v[184:187],v[32:35],a[88:91],v[184:187]
s_cmp_lt_u32 s51,s24
s_cselect_b32 s24,1,2
v_mov_b32 v252,s24
v_mfma_f32_16x16x32_bf16 v[188:191],v[32:35],a[92:95],v[188:191]
s_waitcnt lgkmcnt(0)
s_barrier
s_lshl2_add_u32 s25,s51,11018240
v_mfma_f32_16x16x32_bf16 v[160:163],v[36:39],a[96:99],v[160:163]
ds_read_b128 v[248:251],v245
s_lshl_b32 s24,s68,16
v_mfma_f32_16x16x32_bf16 v[164:167],v[36:39],a[100:103],v[164:167]
s_add_u32 s24,s24,s31
s_add_u32 s24,s24,s86
s_cmp_eq_u32 s24,1537
s_cselect_b32 s25,s25,0x80000000
v_mfma_f32_16x16x32_bf16 v[168:171],v[36:39],a[104:107],v[168:171]
buffer_load_dwordx4 v0,s[8:11],s64 offen offset:1024 sc1 lds
v_mfma_f32_16x16x32_bf16 v[172:175],v[36:39],a[108:111],v[172:175]
buffer_store_dword v252,off,s[8:11],s25 sc1
v_mfma_f32_16x16x32_bf16 v[176:179],v[36:39],a[112:115],v[176:179]
s_bitcmp1_b64 s[38:39],s51
s_cselect_b32 s24,128,0
s_lshl_b32 s23,s51,13
v_mfma_f32_16x16x32_bf16 v[180:183],v[36:39],a[116:119],v[180:183]
s_lshl2_add_u32 s23,s68,s23
s_add_u32 s23,s23,10487168
s_add_u32 s23,s23,s24
v_mfma_f32_16x16x32_bf16 v[184:187],v[36:39],a[120:123],v[184:187]
buffer_load_dword v246,off,s[8:11],s23 sc1
v_mfma_f32_16x16x32_bf16 v[188:191],v[36:39],a[124:127],v[188:191]
buffer_load_dwordx4 v0,s[8:11],s64 offen offset:2048 sc1 lds
v_mfma_f32_16x16x32_bf16 v[160:163],v[40:43],a[128:131],v[160:163]
s_waitcnt lgkmcnt(0)
v_or3_b32 v248,v248,v249,v250
v_or_b32 v248,v248,v251
v_mfma_f32_16x16x32_bf16 v[164:167],v[40:43],a[132:135],v[164:167]
v_lshrrev_b32 v244,4,v1
s_sub_u32 s23,s77,7
v_mfma_f32_16x16x32_bf16 v[168:171],v[40:43],a[136:139],v[168:171]
v_readfirstlane_b32 s72,v248
v_add_u32 v244,s23,v244
v_mfma_f32_16x16x32_bf16 v[172:175],v[40:43],a[140:143],v[172:175]
v_max_i32 v244,0,v244
v_lshl_add_u32 v244,v244,13,v21
v_mfma_f32_16x16x32_bf16 v[176:179],v[40:43],a[144:147],v[176:179]
buffer_load_dwordx4 v0,s[8:11],s64 offen offset:3072 sc1 lds
v_mfma_f32_16x16x32_bf16 v[180:183],v[40:43],a[148:151],v[180:183]
buffer_load_dwordx2 v[242:243],v244,s[8:11],0 offen sc1
v_mfma_f32_16x16x32_bf16 v[184:187],v[40:43],a[152:155],v[184:187]
s_waitcnt vmcnt(12)
v_mfma_f32_16x16x32_bf16 v[188:191],v[40:43],a[156:159],v[188:191]
buffer_store_dword v20,off,s[8:11],s73 sc1
v_mfma_f32_16x16x32_bf16 v[160:163],v[44:47],a[160:163],v[160:163]
s_mov_b32 s73,0x80000000
v_mfma_f32_16x16x32_bf16 v[164:167],v[44:47],a[164:167],v[164:167]
s_add_u32 m0,s58,8192
s_add_u32 s64,s64,4096
v_mfma_f32_16x16x32_bf16 v[168:171],v[44:47],a[168:171],v[168:171]
buffer_load_dwordx4 v0,s[8:11],s64 offen offset:0 sc1 lds
v_mfma_f32_16x16x32_bf16 v[172:175],v[44:47],a[172:175],v[172:175]
v_mfma_f32_16x16x32_bf16 v[176:179],v[44:47],a[176:179],v[176:179]
v_mfma_f32_16x16x32_bf16 v[180:183],v[44:47],a[180:183],v[180:183]
v_mfma_f32_16x16x32_bf16 v[184:187],v[44:47],a[184:187],v[184:187]
v_mfma_f32_16x16x32_bf16 v[188:191],v[44:47],a[188:191],v[188:191]
buffer_load_dwordx4 v0,s[8:11],s64 offen offset:1024 sc1 lds
v_mfma_f32_16x16x32_bf16 v[160:163],v[48:51],a[192:195],v[160:163]
v_mfma_f32_16x16x32_bf16 v[164:167],v[48:51],a[196:199],v[164:167]
v_mfma_f32_16x16x32_bf16 v[168:171],v[48:51],a[200:203],v[168:171]
v_mfma_f32_16x16x32_bf16 v[172:175],v[48:51],a[204:207],v[172:175]
v_mfma_f32_16x16x32_bf16 v[176:179],v[48:51],a[208:211],v[176:179]
buffer_load_dwordx4 v0,s[8:11],s64 offen offset:2048 sc1 lds
v_mfma_f32_16x16x32_bf16 v[180:183],v[48:51],a[212:215],v[180:183]
v_mfma_f32_16x16x32_bf16 v[184:187],v[48:51],a[216:219],v[184:187]
v_mfma_f32_16x16x32_bf16 v[188:191],v[48:51],a[220:223],v[188:191]
v_mfma_f32_16x16x32_bf16 v[160:163],v[52:55],a[224:227],v[160:163]
v_mfma_f32_16x16x32_bf16 v[164:167],v[52:55],a[228:231],v[164:167]
buffer_load_dwordx4 v0,s[8:11],s64 offen offset:3072 sc1 lds
v_mfma_f32_16x16x32_bf16 v[168:171],v[52:55],a[232:235],v[168:171]
v_mfma_f32_16x16x32_bf16 v[172:175],v[52:55],a[236:239],v[172:175]
v_mfma_f32_16x16x32_bf16 v[176:179],v[52:55],a[240:243],v[176:179]
v_mfma_f32_16x16x32_bf16 v[180:183],v[52:55],a[244:247],v[180:183]
v_mfma_f32_16x16x32_bf16 v[184:187],v[52:55],a[248:251],v[184:187]
s_add_u32 m0,s57,24576
v_mfma_f32_16x16x32_bf16 v[188:191],v[52:55],a[252:255],v[188:191]
buffer_load_dwordx4 v0,s[8:11],s65 offen offset:0 sc1 lds
v_mfma_f32_16x16x32_bf16 v[192:195],v[56:59],a[0:3],0
v_mfma_f32_16x16x32_bf16 v[196:199],v[56:59],a[4:7],0
v_mfma_f32_16x16x32_bf16 v[200:203],v[56:59],a[8:11],0
v_cvt_pk_bf16_f32 v24,v160,v164
v_cvt_pk_bf16_f32 v25,v168,v172
v_mfma_f32_16x16x32_bf16 v[204:207],v[56:59],a[12:15],0
v_cvt_pk_bf16_f32 v26,v176,v180
v_cvt_pk_bf16_f32 v27,v184,v188
v_mfma_f32_16x16x32_bf16 v[208:211],v[56:59],a[16:19],0
buffer_load_dwordx4 v0,s[8:11],s65 offen offset:1024 sc1 lds
v_mfma_f32_16x16x32_bf16 v[212:215],v[56:59],a[20:23],0
v_cvt_pk_bf16_f32 v28,v161,v165
v_cvt_pk_bf16_f32 v29,v169,v173
v_mfma_f32_16x16x32_bf16 v[216:219],v[56:59],a[24:27],0
v_cvt_pk_bf16_f32 v30,v177,v181
v_cvt_pk_bf16_f32 v31,v185,v189
v_mfma_f32_16x16x32_bf16 v[220:223],v[56:59],a[28:31],0
v_cvt_pk_bf16_f32 v32,v162,v166
v_cvt_pk_bf16_f32 v33,v170,v174
v_mfma_f32_16x16x32_bf16 v[192:195],v[60:63],a[32:35],v[192:195]
v_cvt_pk_bf16_f32 v34,v178,v182
v_cvt_pk_bf16_f32 v35,v186,v190
v_mfma_f32_16x16x32_bf16 v[196:199],v[60:63],a[36:39],v[196:199]
v_cvt_pk_bf16_f32 v36,v163,v167
v_cvt_pk_bf16_f32 v37,v171,v175
v_mfma_f32_16x16x32_bf16 v[200:203],v[60:63],a[40:43],v[200:203]
v_cvt_pk_bf16_f32 v38,v179,v183
v_cvt_pk_bf16_f32 v39,v187,v191
v_mfma_f32_16x16x32_bf16 v[204:207],v[60:63],a[44:47],v[204:207]
v_mfma_f32_16x16x32_bf16 v[208:211],v[60:63],a[48:51],v[208:211]
v_mfma_f32_16x16x32_bf16 v[212:215],v[60:63],a[52:55],v[212:215]
v_mfma_f32_16x16x32_bf16 v[216:219],v[60:63],a[56:59],v[216:219]
v_mfma_f32_16x16x32_bf16 v[220:223],v[60:63],a[60:63],v[220:223]
v_mfma_f32_16x16x32_bf16 v[192:195],v[64:67],a[64:67],v[192:195]
v_mfma_f32_16x16x32_bf16 v[196:199],v[64:67],a[68:71],v[196:199]
v_mfma_f32_16x16x32_bf16 v[200:203],v[64:67],a[72:75],v[200:203]
v_mfma_f32_16x16x32_bf16 v[204:207],v[64:67],a[76:79],v[204:207]
v_mfma_f32_16x16x32_bf16 v[208:211],v[64:67],a[80:83],v[208:211]
v_mfma_f32_16x16x32_bf16 v[212:215],v[64:67],a[84:87],v[212:215]
v_mfma_f32_16x16x32_bf16 v[216:219],v[64:67],a[88:91],v[216:219]
v_mfma_f32_16x16x32_bf16 v[220:223],v[64:67],a[92:95],v[220:223]
v_mfma_f32_16x16x32_bf16 v[192:195],v[68:71],a[96:99],v[192:195]
v_mfma_f32_16x16x32_bf16 v[196:199],v[68:71],a[100:103],v[196:199]
v_mfma_f32_16x16x32_bf16 v[200:203],v[68:71],a[104:107],v[200:203]
v_mfma_f32_16x16x32_bf16 v[204:207],v[68:71],a[108:111],v[204:207]
v_mfma_f32_16x16x32_bf16 v[208:211],v[68:71],a[112:115],v[208:211]
s_add_u32 s62,s69,0
v_mfma_f32_16x16x32_bf16 v[212:215],v[68:71],a[116:119],v[212:215]
buffer_store_dwordx4 v[24:27],v5,s[8:11],s62 offen
v_mfma_f32_16x16x32_bf16 v[216:219],v[68:71],a[120:123],v[216:219]
v_mfma_f32_16x16x32_bf16 v[220:223],v[68:71],a[124:127],v[220:223]
v_mfma_f32_16x16x32_bf16 v[192:195],v[72:75],a[128:131],v[192:195]
v_mfma_f32_16x16x32_bf16 v[196:199],v[72:75],a[132:135],v[196:199]
v_mfma_f32_16x16x32_bf16 v[200:203],v[72:75],a[136:139],v[200:203]
s_add_u32 s62,s69,16384
v_mfma_f32_16x16x32_bf16 v[204:207],v[72:75],a[140:143],v[204:207]
buffer_store_dwordx4 v[28:31],v5,s[8:11],s62 offen
v_mfma_f32_16x16x32_bf16 v[208:211],v[72:75],a[144:147],v[208:211]
v_mfma_f32_16x16x32_bf16 v[212:215],v[72:75],a[148:151],v[212:215]
v_mfma_f32_16x16x32_bf16 v[216:219],v[72:75],a[152:155],v[216:219]
v_mfma_f32_16x16x32_bf16 v[220:223],v[72:75],a[156:159],v[220:223]
v_mfma_f32_16x16x32_bf16 v[192:195],v[76:79],a[160:163],v[192:195]
s_add_u32 s62,s69,32768
v_mfma_f32_16x16x32_bf16 v[196:199],v[76:79],a[164:167],v[196:199]
buffer_store_dwordx4 v[32:35],v5,s[8:11],s62 offen
v_mfma_f32_16x16x32_bf16 v[200:203],v[76:79],a[168:171],v[200:203]
v_mfma_f32_16x16x32_bf16 v[204:207],v[76:79],a[172:175],v[204:207]
v_mfma_f32_16x16x32_bf16 v[208:211],v[76:79],a[176:179],v[208:211]
v_mfma_f32_16x16x32_bf16 v[212:215],v[76:79],a[180:183],v[212:215]
v_mfma_f32_16x16x32_bf16 v[216:219],v[76:79],a[184:187],v[216:219]
s_add_u32 s62,s69,49152
v_mfma_f32_16x16x32_bf16 v[220:223],v[76:79],a[188:191],v[220:223]
buffer_store_dwordx4 v[36:39],v5,s[8:11],s62 offen
v_mfma_f32_16x16x32_bf16 v[192:195],v[80:83],a[192:195],v[192:195]
v_mfma_f32_16x16x32_bf16 v[196:199],v[80:83],a[196:199],v[196:199]
v_mfma_f32_16x16x32_bf16 v[192:195],v[84:87],a[224:227],v[192:195]
v_mfma_f32_16x16x32_bf16 v[196:199],v[84:87],a[228:231],v[196:199]
v_mfma_f32_16x16x32_bf16 v[200:203],v[80:83],a[200:203],v[200:203]
v_mfma_f32_16x16x32_bf16 v[204:207],v[80:83],a[204:207],v[204:207]
v_mfma_f32_16x16x32_bf16 v[200:203],v[84:87],a[232:235],v[200:203]
v_mfma_f32_16x16x32_bf16 v[204:207],v[84:87],a[236:239],v[204:207]
v_cvt_pk_bf16_f32 v40,v192,v196
v_cvt_pk_bf16_f32 v44,v193,v197
v_cvt_pk_bf16_f32 v48,v194,v198
v_mfma_f32_16x16x32_bf16 v[208:211],v[80:83],a[208:211],v[208:211]
v_cvt_pk_bf16_f32 v52,v195,v199
v_mfma_f32_16x16x32_bf16 v[212:215],v[80:83],a[212:215],v[212:215]
v_cvt_pk_bf16_f32 v41,v200,v204
v_cvt_pk_bf16_f32 v45,v201,v205
v_cvt_pk_bf16_f32 v49,v202,v206
v_mfma_f32_16x16x32_bf16 v[208:211],v[84:87],a[240:243],v[208:211]
v_cvt_pk_bf16_f32 v53,v203,v207
v_mfma_f32_16x16x32_bf16 v[212:215],v[84:87],a[244:247],v[212:215]
v_mfma_f32_16x16x32_bf16 v[216:219],v[80:83],a[216:219],v[216:219]
v_mfma_f32_16x16x32_bf16 v[220:223],v[80:83],a[220:223],v[220:223]
v_mfma_f32_16x16x32_bf16 v[216:219],v[84:87],a[248:251],v[216:219]
v_mfma_f32_16x16x32_bf16 v[220:223],v[84:87],a[252:255],v[220:223]
v_cvt_pk_bf16_f32 v42,v208,v212
v_cvt_pk_bf16_f32 v46,v209,v213
v_cvt_pk_bf16_f32 v50,v210,v214
v_cvt_pk_bf16_f32 v54,v211,v215
s_nop 3
v_cvt_pk_bf16_f32 v43,v216,v220
s_add_u32 s62,s69,262144
buffer_store_dwordx4 v[40:43],v5,s[8:11],s62 offen
v_cvt_pk_bf16_f32 v47,v217,v221
s_add_u32 s62,s69,278528
buffer_store_dwordx4 v[44:47],v5,s[8:11],s62 offen
v_cvt_pk_bf16_f32 v51,v218,v222
s_add_u32 s62,s69,294912
buffer_store_dwordx4 v[48:51],v5,s[8:11],s62 offen
v_cvt_pk_bf16_f32 v55,v219,v223
s_add_u32 s62,s69,311296
buffer_store_dwordx4 v[52:55],v5,s[8:11],s62 offen
s_cmp_lg_u32 s72,0
s_cbranch_scc1 L_aa_83
s_waitcnt vmcnt(8)
L_aa_93:
s_barrier
s_cmp_lt_u32 s30,s31
s_cbranch_scc1 L_ao_100
s_xor_b32 s67,s67,65536
s_and_b32 s56,s50,2048
s_lshl_b32 s56,s56,4
s_add_u32 s56,s56,s67
v_add_u32 v2,s56,v0
s_and_b32 s56,s50,1024
s_lshl_b32 s56,s56,2
v_add_u32 v238,s56,v2
s_mov_b32 s76,s71
s_mov_b32 s53,s77
ds_read_b128 v[24:27],v238 offset:16384
ds_read_b128 v[40:43],v2 offset:0
ds_read_b128 v[56:59],v2 offset:4096
ds_read_b128 v[28:31],v238 offset:17408
ds_read_b128 v[44:47],v2 offset:1024
ds_read_b128 v[60:63],v2 offset:5120
ds_read_b128 v[32:35],v238 offset:18432
ds_read_b128 v[48:51],v2 offset:2048
ds_read_b128 v[64:67],v2 offset:6144
ds_read_b128 v[36:39],v238 offset:19456
ds_read_b128 v[52:55],v2 offset:3072
ds_read_b128 v[68:71],v2 offset:7168
s_waitcnt lgkmcnt(9)
v_mfma_f32_16x16x32_bf16 v[128:131],v[40:43],v[24:27],v[8:11]
ds_read_b128 v[72:75],v2 offset:24576
v_mfma_f32_16x16x32_bf16 v[132:135],v[56:59],v[24:27],v[12:15]
ds_read_b128 v[76:79],v2 offset:25600
s_waitcnt lgkmcnt(8)
v_mfma_f32_16x16x32_bf16 v[128:131],v[44:47],v[28:31],v[128:131]
ds_read_b128 v[80:83],v2 offset:26624
v_mfma_f32_16x16x32_bf16 v[132:135],v[60:63],v[28:31],v[132:135]
ds_read_b128 v[84:87],v2 offset:27648
s_waitcnt lgkmcnt(7)
v_mfma_f32_16x16x32_bf16 v[128:131],v[48:51],v[32:35],v[128:131]
ds_read_b128 v[88:91],v2 offset:8192
v_mfma_f32_16x16x32_bf16 v[132:135],v[64:67],v[32:35],v[132:135]
ds_read_b128 v[92:95],v2 offset:9216
s_waitcnt lgkmcnt(6)
v_mfma_f32_16x16x32_bf16 v[128:131],v[52:55],v[36:39],v[128:131]
ds_read_b128 v[96:99],v2 offset:10240
v_mfma_f32_16x16x32_bf16 v[132:135],v[68:71],v[36:39],v[132:135]
ds_read_b128 v[100:103],v2 offset:11264
s_waitcnt lgkmcnt(4)
s_mov_b32 vcc_lo,0x33333333
s_mov_b32 vcc_hi,0x33333333
v_mfma_f32_16x16x32_bf16 v[136:139],v[72:75],v[24:27],0
ds_read_b128 v[104:107],v2 offset:12288
v_max3_u32 v238,v72,v73,v74
v_max3_u32 v238,v74,v75,v238
v_cndmask_b32_dpp v120,v72,v74,vcc quad_perm:[0,1,0,1] row_mask:0xf bank_mask:0xf
v_cndmask_b32_dpp v121,v73,v75,vcc quad_perm:[0,1,0,1] row_mask:0xf bank_mask:0xf
v_mfma_f32_16x16x32_bf16 v[136:139],v[76:79],v[28:31],v[136:139]
ds_read_b128 v[108:111],v2 offset:13312
v_max3_u32 v238,v76,v77,v238
v_max3_u32 v238,v78,v79,v238
v_cndmask_b32_dpp v122,v76,v78,vcc quad_perm:[0,1,0,1] row_mask:0xf bank_mask:0xf
v_cndmask_b32_dpp v123,v77,v79,vcc quad_perm:[0,1,0,1] row_mask:0xf bank_mask:0xf
v_mfma_f32_16x16x32_bf16 v[136:139],v[80:83],v[32:35],v[136:139]
ds_read_b128 v[112:115],v2 offset:14336
v_max3_u32 v238,v80,v81,v238
v_max3_u32 v238,v82,v83,v238
v_cndmask_b32_dpp v124,v80,v82,vcc quad_perm:[0,1,0,1] row_mask:0xf bank_mask:0xf
v_cndmask_b32_dpp v125,v81,v83,vcc quad_perm:[0,1,0,1] row_mask:0xf bank_mask:0xf
v_mfma_f32_16x16x32_bf16 v[136:139],v[84:87],v[36:39],v[136:139]
ds_read_b128 v[116:119],v2 offset:15360
v_max3_u32 v238,v84,v85,v238
v_max3_u32 v238,v86,v87,v238
v_cndmask_b32_dpp v126,v84,v86,vcc quad_perm:[0,1,0,1] row_mask:0xf bank_mask:0xf
v_cndmask_b32_dpp v127,v85,v87,vcc quad_perm:[0,1,0,1] row_mask:0xf bank_mask:0xf
v_cmp_eq_u32 vcc,-1,v238
s_cmp_eq_u32 s30,0
s_cbranch_scc1 L_aa_82
s_cmp_lg_u64 vcc,0
s_cselect_b32 s27,1,0
s_andn2_b32 s57,s27,s31
s_add_u32 s66,s66,4
s_bfe_u32 s56,s66,0x10002
s_bitset0_b32 s37,s56
s_lshl_b32 s56,s57,s56
s_or_b32 s37,s37,s56
s_or_b32 s56,s37,s66
v_mov_b32 v22,s56
s_xor_b32 s69,s69,524288
s_waitcnt vmcnt(0) lgkmcnt(0)
buffer_store_dword v22,off,s[8:11],s74
s_cmp_lg_u32 s86,1536
s_cbranch_scc1 L_ae_103
s_mov_b32 s77,s35
s_mov_b32 s30,0
s_lshl_b32 s56,s77,5
s_add_u32 s56,s56,s68
s_mul_i32 s70,s56,24576
s_lshl_b32 s71,s56,12
s_lshl_b32 s59,s77,13
s_lshl2_add_u32 s59,s68,s59
s_add_u32 s59,s59,10485760
s_buffer_load_dword s32,s[8:11],s59
s_mov_b32 s33,1
s_add_u32 s70,s70,100663296
s_add_u32 s71,s71,41943040
v_mov_b32 v19,s59
s_branch L_af_104
L_ae_103:
s_ff1_i32_b64 s77,s[84:85]
s_bitset0_b64 s[84:85],s77
s_min_u32 s77,s77,64
s_lshr_b32 s61,s55,5
s_lshl_b32 s56,s77,5
s_add_u32 s56,s56,s68
s_mul_i32 s70,s56,24576
s_lshl_b32 s71,s56,12
s_lshl_b32 s59,s77,13
s_lshl2_add_u32 s59,s68,s59
s_add_u32 s59,s59,10486144
s_cmp_lt_u32 s77,s61
s_cselect_b32 s57,0,16777216
s_mov_b32 s60,s59
s_buffer_load_dword s33,s[8:11],s60
s_add_u32 s71,s71,s57
s_add_u32 s71,s71,58720256
s_cmp_eq_u32 s77,s61
s_cselect_b32 s57,50331648,0
s_cselect_b32 s58,1536,0
s_add_u32 s59,s59,s58
s_buffer_load_dword s32,s[8:11],s59
s_add_u32 s70,s70,s57
s_add_u32 s70,s70,150994944
v_mov_b32 v19,s59
v_writelane_b32 v19,s60,1
L_af_104:
s_cmp_ge_u32 s53,60
s_cbranch_scc1 L_a4_105
L_a4_106:
s_and_b32 s27,s27,s31
s_cbranch_scc1 L_ac_108
L_acb_109:
v_max3_f32 v238,v128,v129,v130
v_max3_f32 v239,v131,v132,v133
v_max3_f32 v238,v134,v135,v238
v_max3_f32 v239,v138,v139,v239
v_max_f32 v238,v238,v239
v_max_f32 v239,v238,v239
v_pk_mul_f32 v[128:129],v[128:129],v[152:153] op_sel_hi:[1,0]
v_pk_mul_f32 v[130:131],v[130:131],v[152:153] op_sel_hi:[1,0]
v_permlane16_swap_b32 v238,v239
v_max_f32 v238,v238,v239
v_max_f32 v239,v238,v239
v_pk_mul_f32 v[132:133],v[132:133],v[152:153] op_sel_hi:[1,0]
v_pk_mul_f32 v[134:135],v[134:135],v[152:153] op_sel_hi:[1,0]
v_permlane32_swap_b32 v238,v239
v_max_f32 v238,v238,v239
v_mul_f32 v238,v152,v238
v_pk_mul_f32 v[138:139],v[138:139],v[152:153] op_sel_hi:[1,0]
buffer_load_dword v17,v16,s[8:11],s87 offen sc1
v_pk_add_f32 v[128:129],v[128:129],v[238:239] op_sel_hi:[1,0] neg_lo:[0,1] neg_hi:[0,1]
v_pk_add_f32 v[130:131],v[130:131],v[238:239] op_sel_hi:[1,0] neg_lo:[0,1] neg_hi:[0,1]
v_pk_add_f32 v[132:133],v[132:133],v[238:239] op_sel_hi:[1,0] neg_lo:[0,1] neg_hi:[0,1]
v_pk_add_f32 v[134:135],v[134:135],v[238:239] op_sel_hi:[1,0] neg_lo:[0,1] neg_hi:[0,1]
v_pk_add_f32 v[138:139],v[138:139],v[238:239] op_sel_hi:[1,0] neg_lo:[0,1] neg_hi:[0,1]
v_exp_f32 v128,v128
v_exp_f32 v129,v129
v_exp_f32 v130,v130
v_exp_f32 v131,v131
v_exp_f32 v132,v132
v_exp_f32 v133,v133
v_exp_f32 v134,v134
v_exp_f32 v135,v135
v_exp_f32 v138,v138
v_exp_f32 v139,v139
v_pk_add_f32 v[148:149],v[128:129],v[130:131]
v_pk_add_f32 v[150:151],v[132:133],v[134:135]
v_pk_add_f32 v[148:149],v[148:149],v[138:139]
v_pk_add_f32 v[148:149],v[148:149],v[150:151]
v_add_f32 v150,v148,v149
v_add_f32 v151,v148,v149
s_nop 1
v_permlane16_swap_b32 v150,v151
v_add_f32 v148,v150,v151
v_add_f32 v149,v150,v151
s_nop 1
v_permlane32_swap_b32 v148,v149
v_add_f32 v148,v148,v149
v_rcp_f32 v148,v148
s_waitcnt vmcnt(0)
v_cmp_gt_u32 vcc,s66,v17
v_pk_mul_f32 v[138:139],v[138:139],v[148:149] op_sel_hi:[1,0]
v_pk_mul_f32 v[128:129],v[128:129],v[148:149] op_sel_hi:[1,0]
v_pk_mul_f32 v[130:131],v[130:131],v[148:149] op_sel_hi:[1,0]
v_pk_mul_f32 v[132:133],v[132:133],v[148:149] op_sel_hi:[1,0]
v_pk_mul_f32 v[134:135],v[134:135],v[148:149] op_sel_hi:[1,0]
s_cbranch_vccnz L_ap_111
L_apb_112:
s_xor_b32 s34,s69,524288
buffer_load_dwordx4 v[192:195],v7,s[8:11],s34 offen sc1
s_bfe_u32 s56,s66,0x10002
v_lshrrev_b32 v238,s56,v17
v_and_b32 v238,1,v238
v_cmp_ne_u32 vcc,0,v238
v_cvt_pk_bf16_f32 v144,v138,v139
v_cvt_pk_bf16_f32 v147,v138,v139
v_cvt_pk_bf16_f32 v140,v128,v129
v_cvt_pk_bf16_f32 v141,v130,v131
v_cvt_pk_bf16_f32 v142,v132,v133
v_cvt_pk_bf16_f32 v143,v134,v135
s_cbranch_vccnz L_ak_102
s_add_u32 s36,s36,4
v_mfma_f32_16x16x16_bf16 v[24:27],v[120:121],v[144:145],0
s_add_u32 s34,s34,4096
v_mfma_f32_16x16x16_bf16 v[28:31],v[120:121],v[146:147],0
buffer_load_dwordx4 v[196:199],v7,s[8:11],s34 offen sc1
v_mfma_f32_16x16x16_bf16 v[32:35],v[122:123],v[144:145],0
s_add_u32 s34,s34,4096
v_mfma_f32_16x16x16_bf16 v[36:39],v[122:123],v[146:147],0
buffer_load_dwordx4 v[200:203],v7,s[8:11],s34 offen sc1
v_mfma_f32_16x16x16_bf16 v[40:43],v[124:125],v[144:145],0
s_add_u32 s34,s34,4096
v_mfma_f32_16x16x16_bf16 v[44:47],v[124:125],v[146:147],0
buffer_load_dwordx4 v[204:207],v7,s[8:11],s34 offen sc1
v_mfma_f32_16x16x16_bf16 v[48:51],v[126:127],v[144:145],0
s_add_u32 s34,s34,4096
v_mfma_f32_16x16x16_bf16 v[52:55],v[126:127],v[146:147],0
buffer_load_dwordx4 v[208:211],v7,s[8:11],s34 offen sc1
v_mfma_f32_16x16x32_bf16 v[24:27],v[88:91],v[140:143],v[24:27]
s_add_u32 s34,s34,4096
v_mfma_f32_16x16x32_bf16 v[28:31],v[92:95],v[140:143],v[28:31]
buffer_load_dwordx4 v[212:215],v7,s[8:11],s34 offen sc1
v_mfma_f32_16x16x32_bf16 v[32:35],v[96:99],v[140:143],v[32:35]
s_add_u32 s34,s34,4096
v_mfma_f32_16x16x32_bf16 v[36:39],v[100:103],v[140:143],v[36:39]
buffer_load_dwordx4 v[216:219],v7,s[8:11],s34 offen sc1
v_cvt_pk_bf16_f32 v72,v24,v28
v_cvt_pk_bf16_f32 v73,v25,v29
v_mfma_f32_16x16x32_bf16 v[40:43],v[104:107],v[140:143],v[40:43]
s_add_u32 s34,s34,4096
v_cvt_pk_bf16_f32 v74,v26,v30
v_cvt_pk_bf16_f32 v75,v27,v31
v_mfma_f32_16x16x32_bf16 v[44:47],v[108:111],v[140:143],v[44:47]
ds_write_b128 v3,v[72:75] offset:0
v_cvt_pk_bf16_f32 v76,v32,v36
v_cvt_pk_bf16_f32 v77,v33,v37
v_mfma_f32_16x16x32_bf16 v[48:51],v[112:115],v[140:143],v[48:51]
buffer_load_dwordx4 v[220:223],v7,s[8:11],s34 offen sc1
v_cvt_pk_bf16_f32 v78,v34,v38
v_cvt_pk_bf16_f32 v79,v35,v39
v_mfma_f32_16x16x32_bf16 v[52:55],v[116:119],v[140:143],v[52:55]
ds_write_b128 v3,v[76:79] offset:1024
v_cvt_pk_bf16_f32 v80,v40,v44
v_cvt_pk_bf16_f32 v81,v41,v45
v_cvt_pk_bf16_f32 v82,v42,v46
v_cvt_pk_bf16_f32 v83,v43,v47
ds_write_b128 v3,v[80:83] offset:2048
s_nop 1
v_cvt_pk_bf16_f32 v84,v48,v52
v_cvt_pk_bf16_f32 v85,v49,v53
v_cvt_pk_bf16_f32 v86,v50,v54
v_cvt_pk_bf16_f32 v87,v51,v55
ds_write_b128 v3,v[84:87] offset:3072
s_cmp_eq_u32 s31,0
s_cbranch_scc1 L_ah_110
s_waitcnt lgkmcnt(0)
s_barrier
s_mov_b32 s26,s51
s_mov_b32 s51,s53
s_branch L_aa_94
L_ah_110:
s_cmp_ge_u32 s35,64
s_cbranch_scc1 L_a1_113
L_a2_114:
s_waitcnt vmcnt(7)
v_mfma_f32_16x16x32_bf16 v[160:163],v[156:159],v[192:195],0
s_waitcnt vmcnt(6)
v_mfma_f32_16x16x32_bf16 v[160:163],v[156:159],v[196:199],v[160:163]
s_waitcnt vmcnt(5)
v_mfma_f32_16x16x32_bf16 v[160:163],v[156:159],v[200:203],v[160:163]
s_waitcnt vmcnt(4)
v_mfma_f32_16x16x32_bf16 v[160:163],v[156:159],v[204:207],v[160:163]
s_waitcnt vmcnt(3)
v_mfma_f32_16x16x32_bf16 v[164:167],v[156:159],v[208:211],0
s_waitcnt vmcnt(2)
v_mfma_f32_16x16x32_bf16 v[164:167],v[156:159],v[212:215],v[164:167]
s_waitcnt vmcnt(1)
v_mfma_f32_16x16x32_bf16 v[164:167],v[156:159],v[216:219],v[164:167]
ds_write_b128 v6,v[160:163]
s_waitcnt vmcnt(0)
v_mfma_f32_16x16x32_bf16 v[164:167],v[156:159],v[220:223],v[164:167]
s_nop 7
ds_write_b128 v6,v[164:167] offset:2048
s_waitcnt lgkmcnt(0)
s_barrier
buffer_store_dword v20,off,s[8:11],s73 sc1
s_mov_b32 s73,0x80000000
s_mov_b32 s27,1
s_branch L_aa_85
L_ao_100:
s_xor_b32 s67,s67,65536
s_and_b32 s56,s50,2048
s_lshl_b32 s56,s56,4
s_add_u32 s56,s56,s67
v_add_u32 v2,s56,v0
s_and_b32 s56,s50,1024
s_lshl_b32 s56,s56,2
v_add_u32 v238,s56,v2
s_mov_b32 s76,s71
s_mov_b32 s53,s77
ds_read_b128 v[24:27],v238 offset:16384
ds_read_b128 v[40:43],v2 offset:0
ds_read_b128 v[56:59],v2 offset:4096
ds_read_b128 v[28:31],v238 offset:17408
ds_read_b128 v[44:47],v2 offset:1024
ds_read_b128 v[60:63],v2 offset:5120
ds_read_b128 v[32:35],v238 offset:18432
ds_read_b128 v[48:51],v2 offset:2048
ds_read_b128 v[64:67],v2 offset:6144
ds_read_b128 v[36:39],v238 offset:19456
ds_read_b128 v[52:55],v2 offset:3072
ds_read_b128 v[68:71],v2 offset:7168
buffer_load_dwordx4 v[72:75],v0,s[8:11],s76 offen offset:0 sc1
buffer_load_dwordx4 v[76:79],v0,s[8:11],s76 offen offset:1024 sc1
buffer_load_dwordx4 v[80:83],v0,s[8:11],s76 offen offset:2048 sc1
buffer_load_dwordx4 v[84:87],v0,s[8:11],s76 offen offset:3072 sc1
s_waitcnt lgkmcnt(9)
v_mfma_f32_16x16x32_bf16 v[128:131],v[40:43],v[24:27],v[8:11]
ds_read_b128 v[88:91],v2 offset:8192
v_mfma_f32_16x16x32_bf16 v[132:135],v[56:59],v[24:27],v[12:15]
ds_read_b128 v[92:95],v2 offset:9216
s_waitcnt lgkmcnt(8)
v_mfma_f32_16x16x32_bf16 v[128:131],v[44:47],v[28:31],v[128:131]
ds_read_b128 v[96:99],v2 offset:10240
v_mfma_f32_16x16x32_bf16 v[132:135],v[60:63],v[28:31],v[132:135]
ds_read_b128 v[100:103],v2 offset:11264
s_waitcnt lgkmcnt(7)
v_mfma_f32_16x16x32_bf16 v[128:131],v[48:51],v[32:35],v[128:131]
ds_read_b128 v[104:107],v2 offset:12288
v_mfma_f32_16x16x32_bf16 v[132:135],v[64:67],v[32:35],v[132:135]
ds_read_b128 v[108:111],v2 offset:13312
s_waitcnt lgkmcnt(6)
v_mfma_f32_16x16x32_bf16 v[128:131],v[52:55],v[36:39],v[128:131]
ds_read_b128 v[112:115],v2 offset:14336
v_mfma_f32_16x16x32_bf16 v[132:135],v[68:71],v[36:39],v[132:135]
ds_read_b128 v[116:119],v2 offset:15360
s_add_u32 s66,s66,4
s_bfe_u32 s56,s66,0x10002
s_bitset0_b32 s37,s56
s_lshl_b32 s56,0,s56
s_or_b32 s37,s37,s56
s_or_b32 s56,s37,s66
v_mov_b32 v22,s56
s_xor_b32 s69,s69,524288
s_waitcnt vmcnt(4) lgkmcnt(0)
buffer_store_dword v22,off,s[8:11],s74
s_mov_b32 s26,s51
s_mov_b32 s27,3
s_branch L_aa_89
L_aa_82:
s_add_u32 s66,s66,4
s_bfe_u32 s56,s66,0x10002
s_bitset0_b32 s37,s56
s_lshl_b32 s56,0,s56
s_or_b32 s37,s37,s56
s_or_b32 s56,s37,s66
v_mov_b32 v22,s56
s_xor_b32 s69,s69,524288
s_waitcnt vmcnt(0) lgkmcnt(0)
buffer_store_dword v22,off,s[8:11],s74
L_aq_115:
buffer_load_dword v17,v16,s[8:11],s87 offen sc1
s_sub_u32 s49,s49,1
s_cbranch_scc1 L_abort
s_waitcnt vmcnt(0)
v_cmp_gt_u32 vcc,s66,v17
s_cbranch_vccnz L_aq_115
s_xor_b32 s34,s69,524288
buffer_load_dwordx4 v[160:163],v7,s[8:11],s34 offen sc1
s_add_u32 s34,s34,4096
buffer_load_dwordx4 v[164:167],v7,s[8:11],s34 offen sc1
s_add_u32 s34,s34,4096
buffer_load_dwordx4 v[168:171],v7,s[8:11],s34 offen sc1
s_add_u32 s34,s34,4096
buffer_load_dwordx4 v[172:175],v7,s[8:11],s34 offen sc1
s_add_u32 s34,s34,4096
buffer_load_dwordx4 v[176:179],v7,s[8:11],s34 offen sc1
s_add_u32 s34,s34,4096
buffer_load_dwordx4 v[180:183],v7,s[8:11],s34 offen sc1
s_add_u32 s34,s34,4096
buffer_load_dwordx4 v[184:187],v7,s[8:11],s34 offen sc1
s_add_u32 s34,s34,4096
buffer_load_dwordx4 v[188:191],v7,s[8:11],s34 offen sc1
buffer_load_dwordx4 v[72:75],v0,s[8:11],s76 offen offset:0 sc1
buffer_load_dwordx4 v[76:79],v0,s[8:11],s76 offen offset:1024 sc1
buffer_load_dwordx4 v[80:83],v0,s[8:11],s76 offen offset:2048 sc1
buffer_load_dwordx4 v[84:87],v0,s[8:11],s76 offen offset:3072 sc1
s_waitcnt vmcnt(11)
v_mfma_f32_16x16x32_bf16 v[192:195],v[156:159],v[160:163],0
s_waitcnt vmcnt(10)
v_mfma_f32_16x16x32_bf16 v[192:195],v[156:159],v[164:167],v[192:195]
s_waitcnt vmcnt(9)
v_mfma_f32_16x16x32_bf16 v[192:195],v[156:159],v[168:171],v[192:195]
s_waitcnt vmcnt(8)
v_mfma_f32_16x16x32_bf16 v[192:195],v[156:159],v[172:175],v[192:195]
s_waitcnt vmcnt(7)
v_mfma_f32_16x16x32_bf16 v[196:199],v[156:159],v[176:179],0
s_waitcnt vmcnt(6)
v_mfma_f32_16x16x32_bf16 v[196:199],v[156:159],v[180:183],v[196:199]
s_waitcnt vmcnt(5)
v_mfma_f32_16x16x32_bf16 v[196:199],v[156:159],v[184:187],v[196:199]
ds_write_b128 v6,v[192:195]
s_waitcnt vmcnt(4)
v_mfma_f32_16x16x32_bf16 v[196:199],v[156:159],v[188:191],v[196:199]
s_nop 7
ds_write_b128 v6,v[196:199] offset:2048
s_waitcnt lgkmcnt(0)
s_barrier
buffer_store_dword v20,off,s[8:11],s73 sc1
s_mov_b32 s73,0x80000000
s_mov_b32 s27,0
s_branch L_aa_85
L_aa_83:
s_add_u32 s56,s30,s86
s_cmp_lg_u32 s56,1537
s_cbranch_scc1 L_al_101
s_add_u32 s66,s66,4
s_bfe_u32 s56,s66,0x10002
s_bitset0_b32 s37,s56
s_lshl_b32 s56,1,s56
s_or_b32 s37,s37,s56
s_or_b32 s56,s37,s66
v_mov_b32 v22,s56
s_xor_b32 s69,s69,524288
s_waitcnt vmcnt(0) lgkmcnt(0)
buffer_store_dword v22,off,s[8:11],s74
s_cmp_lg_u32 s86,1536
s_cbranch_scc1 L_ae_116
s_mov_b32 s77,s35
s_mov_b32 s30,0
s_lshl_b32 s56,s77,5
s_add_u32 s56,s56,s68
s_mul_i32 s70,s56,24576
s_lshl_b32 s71,s56,12
s_lshl_b32 s59,s77,13
s_lshl2_add_u32 s59,s68,s59
s_add_u32 s59,s59,10485760
s_buffer_load_dword s32,s[8:11],s59
s_mov_b32 s33,1
s_add_u32 s70,s70,100663296
s_add_u32 s71,s71,41943040
v_mov_b32 v19,s59
s_branch L_af_117
L_ae_116:
s_ff1_i32_b64 s77,s[84:85]
s_bitset0_b64 s[84:85],s77
s_min_u32 s77,s77,64
s_lshr_b32 s61,s55,5
s_lshl_b32 s56,s77,5
s_add_u32 s56,s56,s68
s_mul_i32 s70,s56,24576
s_lshl_b32 s71,s56,12
s_lshl_b32 s59,s77,13
s_lshl2_add_u32 s59,s68,s59
s_add_u32 s59,s59,10486144
s_cmp_lt_u32 s77,s61
s_cselect_b32 s57,0,16777216
s_mov_b32 s60,s59
s_buffer_load_dword s33,s[8:11],s60
s_add_u32 s71,s71,s57
s_add_u32 s71,s71,58720256
s_cmp_eq_u32 s77,s61
s_cselect_b32 s57,50331648,0
s_cselect_b32 s58,1536,0
s_add_u32 s59,s59,s58
s_buffer_load_dword s32,s[8:11],s59
s_add_u32 s70,s70,s57
s_add_u32 s70,s70,150994944
v_mov_b32 v19,s59
v_writelane_b32 v19,s60,1
L_af_117:
s_branch L_ak_102
L_al_101:
s_add_u32 s66,s66,4
s_bfe_u32 s56,s66,0x10002
s_bitset0_b32 s37,s56
s_lshl_b32 s56,0,s56
s_or_b32 s37,s37,s56
s_or_b32 s56,s37,s66
v_mov_b32 v22,s56
s_xor_b32 s69,s69,524288
s_waitcnt vmcnt(0) lgkmcnt(0)
buffer_store_dword v22,off,s[8:11],s74
buffer_store_dword v20,off,s[8:11],s73 sc1
s_mov_b32 s73,0x80000000
L_ak_102:
L_aq_118:
buffer_load_dword v17,v16,s[8:11],s87 offen sc1
s_sub_u32 s49,s49,1
s_cbranch_scc1 L_abort
s_waitcnt vmcnt(0)
v_cmp_gt_u32 vcc,s66,v17
s_cbranch_vccnz L_aq_118
s_xor_b32 s34,s69,524288
buffer_load_dwordx4 v[160:163],v7,s[8:11],s34 offen sc1
s_add_u32 s34,s34,4096
buffer_load_dwordx4 v[164:167],v7,s[8:11],s34 offen sc1
s_add_u32 s34,s34,4096
buffer_load_dwordx4 v[168:171],v7,s[8:11],s34 offen sc1
s_add_u32 s34,s34,4096
buffer_load_dwordx4 v[172:175],v7,s[8:11],s34 offen sc1
s_add_u32 s34,s34,4096
buffer_load_dwordx4 v[176:179],v7,s[8:11],s34 offen sc1
s_add_u32 s34,s34,4096
buffer_load_dwordx4 v[180:183],v7,s[8:11],s34 offen sc1
s_add_u32 s34,s34,4096
buffer_load_dwordx4 v[184:187],v7,s[8:11],s34 offen sc1
s_add_u32 s34,s34,4096
buffer_load_dwordx4 v[188:191],v7,s[8:11],s34 offen sc1
s_waitcnt vmcnt(7)
v_mfma_f32_16x16x32_bf16 v[192:195],v[156:159],v[160:163],0
s_waitcnt vmcnt(6)
v_mfma_f32_16x16x32_bf16 v[192:195],v[156:159],v[164:167],v[192:195]
s_waitcnt vmcnt(5)
v_mfma_f32_16x16x32_bf16 v[192:195],v[156:159],v[168:171],v[192:195]
s_waitcnt vmcnt(4)
v_mfma_f32_16x16x32_bf16 v[192:195],v[156:159],v[172:175],v[192:195]
s_waitcnt vmcnt(3)
v_mfma_f32_16x16x32_bf16 v[196:199],v[156:159],v[176:179],0
s_waitcnt vmcnt(2)
v_mfma_f32_16x16x32_bf16 v[196:199],v[156:159],v[180:183],v[196:199]
s_waitcnt vmcnt(1)
v_mfma_f32_16x16x32_bf16 v[196:199],v[156:159],v[184:187],v[196:199]
ds_write_b128 v6,v[192:195]
s_waitcnt vmcnt(0)
v_mfma_f32_16x16x32_bf16 v[196:199],v[156:159],v[188:191],v[196:199]
s_nop 7
ds_write_b128 v6,v[196:199] offset:2048
s_waitcnt lgkmcnt(0)
s_barrier
buffer_store_dword v20,off,s[8:11],s73 sc1
s_mov_b32 s73,0x80000000
s_mov_b32 s27,2
L_aa_85:
s_cmp_lg_u32 s31,0
s_cbranch_scc1 L_ar_121
s_bitcmp1_b32 s46,0
s_cbranch_scc1 L_ar_120
L_ar_119:
ds_read_b128 v[160:163],v23
ds_read_b128 v[164:167],v23 offset:16
v_lshlrev_b32 v200,16,v224
v_and_b32 v201,0xffff0000,v224
v_lshlrev_b32 v202,16,v225
v_and_b32 v203,0xffff0000,v225
v_lshlrev_b32 v204,16,v226
v_and_b32 v205,0xffff0000,v226
v_lshlrev_b32 v206,16,v227
v_and_b32 v207,0xffff0000,v227
s_lshl_b32 s18,s51,5
s_add_u32 s18,s18,s68
s_lshl_b32 s19,s18,10
s_add_u32 s20,s19,8388608
s_waitcnt lgkmcnt(0)
v_cvt_pk_bf16_f32 v168,v160,v161
v_cvt_pk_bf16_f32 v169,v162,v163
v_cvt_pk_bf16_f32 v170,v164,v165
v_cvt_pk_bf16_f32 v171,v166,v167
v_lshlrev_b32 v160,16,v168
v_and_b32 v161,0xffff0000,v168
v_lshlrev_b32 v162,16,v169
v_and_b32 v163,0xffff0000,v169
v_lshlrev_b32 v164,16,v170
v_and_b32 v165,0xffff0000,v170
v_lshlrev_b32 v166,16,v171
v_and_b32 v167,0xffff0000,v171
v_pk_add_f32 v[200:201],v[200:201],v[160:161]
v_pk_add_f32 v[202:203],v[202:203],v[162:163]
v_pk_add_f32 v[204:205],v[204:205],v[164:165]
v_pk_add_f32 v[206:207],v[206:207],v[166:167]
v_cvt_pk_bf16_f32 v168,v200,v201
v_cvt_pk_bf16_f32 v169,v202,v203
v_cvt_pk_bf16_f32 v170,v204,v205
v_cvt_pk_bf16_f32 v171,v206,v207
v_lshlrev_b32 v200,16,v168
v_and_b32 v201,0xffff0000,v168
v_lshlrev_b32 v202,16,v169
v_and_b32 v203,0xffff0000,v169
v_lshlrev_b32 v204,16,v170
v_and_b32 v205,0xffff0000,v170
v_lshlrev_b32 v206,16,v171
v_and_b32 v207,0xffff0000,v171
v_readfirstlane_b32 s78,v200
s_nop 1
v_pk_add_f32 v[184:185],v[200:201],s[78:79] op_sel_hi:[1,0] neg_lo:[0,1] neg_hi:[0,1]
v_pk_add_f32 v[186:187],v[202:203],s[78:79] op_sel_hi:[1,0] neg_lo:[0,1] neg_hi:[0,1]
v_pk_add_f32 v[188:189],v[204:205],s[78:79] op_sel_hi:[1,0] neg_lo:[0,1] neg_hi:[0,1]
v_pk_add_f32 v[190:191],v[206:207],s[78:79] op_sel_hi:[1,0] neg_lo:[0,1] neg_hi:[0,1]
v_pk_add_f32 v[192:193],v[184:185],v[186:187]
v_pk_mul_f32 v[194:195],v[184:185],v[184:185]
v_pk_add_f32 v[196:197],v[188:189],v[190:191]
v_pk_fma_f32 v[194:195],v[186:187],v[186:187],v[194:195]
v_pk_add_f32 v[192:193],v[192:193],v[196:197]
v_pk_fma_f32 v[194:195],v[188:189],v[188:189],v[194:195]
v_add_f32 v192,v192,v193
v_pk_fma_f32 v[194:195],v[190:191],v[190:191],v[194:195]
v_add_f32 v194,v194,v195
s_nop 1
v_permlane32_swap_b32 v192,v194
v_add_f32 v192,v192,v194
s_nop 1
v_add_f32_dpp v192,v192,v192 row_ror:8 row_mask:0xf bank_mask:0xf
s_nop 1
v_add_f32_dpp v192,v192,v192 row_ror:4 row_mask:0xf bank_mask:0xf
s_nop 1
v_add_f32_dpp v192,v192,v192 row_ror:2 row_mask:0xf bank_mask:0xf
s_nop 1
v_add_f32_dpp v192,v192,v192 row_ror:1 row_mask:0xf bank_mask:0xf
v_mov_b32 v194,v192
s_nop 1
v_permlane16_swap_b32 v192,v194
v_add_f32 v192,v192,v194
v_mul_f32 v192,0x3b000000,v192
v_mov_b32 v194,v192
s_nop 1
v_permlane32_swap_b32 v192,v194
v_fma_f32 v194,-v192,v192,v194
v_add_f32 v192,s78,v192
v_max_f32 v194,0,v194
v_cvt_pk_bf16_f32 v194,v192,v194
v_lshlrev_b32 v192,16,v194
v_and_b32 v194,0xffff0000,v194
v_add_f32 v194,0x3727c5ac,v194
v_cvt_pk_bf16_f32 v194,v194,v194
v_and_b32 v194,0xffff0000,v194
v_sqrt_f32 v194,v194
v_pk_add_f32 v[184:185],v[200:201],v[192:193] op_sel_hi:[1,0] neg_lo:[0,1] neg_hi:[0,1]
v_pk_add_f32 v[186:187],v[202:203],v[192:193] op_sel_hi:[1,0] neg_lo:[0,1] neg_hi:[0,1]
v_pk_add_f32 v[188:189],v[204:205],v[192:193] op_sel_hi:[1,0] neg_lo:[0,1] neg_hi:[0,1]
v_pk_add_f32 v[190:191],v[206:207],v[192:193] op_sel_hi:[1,0] neg_lo:[0,1] neg_hi:[0,1]
v_cvt_pk_bf16_f32 v194,v194,v194
v_and_b32 v194,0xffff0000,v194
v_rcp_f32 v194,v194
v_cvt_pk_bf16_f32 v172,v184,v185
v_cvt_pk_bf16_f32 v173,v186,v187
v_cvt_pk_bf16_f32 v174,v188,v189
v_cvt_pk_bf16_f32 v175,v190,v191
v_lshlrev_b32 v184,16,v172
v_and_b32 v185,0xffff0000,v172
v_lshlrev_b32 v186,16,v173
v_and_b32 v187,0xffff0000,v173
v_lshlrev_b32 v188,16,v174
v_and_b32 v189,0xffff0000,v174
v_lshlrev_b32 v190,16,v175
v_and_b32 v191,0xffff0000,v175
v_pk_mul_f32 v[184:185],v[184:185],v[194:195] op_sel_hi:[1,0]
v_pk_mul_f32 v[186:187],v[186:187],v[194:195] op_sel_hi:[1,0]
v_pk_mul_f32 v[188:189],v[188:189],v[194:195] op_sel_hi:[1,0]
v_pk_mul_f32 v[190:191],v[190:191],v[194:195] op_sel_hi:[1,0]
v_cvt_pk_bf16_f32 v172,v184,v185
v_cvt_pk_bf16_f32 v173,v186,v187
v_cvt_pk_bf16_f32 v174,v188,v189
v_cvt_pk_bf16_f32 v175,v190,v191
v_lshlrev_b32 v176,16,v172
v_and_b32 v177,0xffff0000,v172
v_lshlrev_b32 v178,16,v173
v_and_b32 v179,0xffff0000,v173
v_lshlrev_b32 v180,16,v174
v_and_b32 v181,0xffff0000,v174
v_lshlrev_b32 v182,16,v175
v_and_b32 v183,0xffff0000,v175
v_pk_add_f32 v[200:201],v[200:201],v[176:177]
v_pk_add_f32 v[202:203],v[202:203],v[178:179]
v_pk_add_f32 v[204:205],v[204:205],v[180:181]
v_pk_add_f32 v[206:207],v[206:207],v[182:183]
v_cvt_pk_bf16_f32 v160,v200,v201
v_cvt_pk_bf16_f32 v161,v202,v203
v_cvt_pk_bf16_f32 v162,v204,v205
v_cvt_pk_bf16_f32 v163,v206,v207
buffer_store_dwordx4 v[160:163],v0,s[8:11],s20 offen sc1
v_lshlrev_b32 v200,16,v160
v_and_b32 v201,0xffff0000,v160
v_lshlrev_b32 v202,16,v161
v_and_b32 v203,0xffff0000,v161
v_lshlrev_b32 v204,16,v162
v_and_b32 v205,0xffff0000,v162
v_lshlrev_b32 v206,16,v163
v_and_b32 v207,0xffff0000,v163
v_readfirstlane_b32 s78,v200
s_nop 1
v_pk_add_f32 v[184:185],v[200:201],s[78:79] op_sel_hi:[1,0] neg_lo:[0,1] neg_hi:[0,1]
v_pk_add_f32 v[186:187],v[202:203],s[78:79] op_sel_hi:[1,0] neg_lo:[0,1] neg_hi:[0,1]
v_pk_add_f32 v[188:189],v[204:205],s[78:79] op_sel_hi:[1,0] neg_lo:[0,1] neg_hi:[0,1]
v_pk_add_f32 v[190:191],v[206:207],s[78:79] op_sel_hi:[1,0] neg_lo:[0,1] neg_hi:[0,1]
v_pk_add_f32 v[192:193],v[184:185],v[186:187]
v_pk_mul_f32 v[194:195],v[184:185],v[184:185]
v_pk_add_f32 v[196:197],v[188:189],v[190:191]
v_pk_fma_f32 v[194:195],v[186:187],v[186:187],v[194:195]
v_pk_add_f32 v[192:193],v[192:193],v[196:197]
v_pk_fma_f32 v[194:195],v[188:189],v[188:189],v[194:195]
v_add_f32 v192,v192,v193
v_pk_fma_f32 v[194:195],v[190:191],v[190:191],v[194:195]
v_add_f32 v194,v194,v195
s_nop 1
v_permlane32_swap_b32 v192,v194
v_add_f32 v192,v192,v194
s_nop 1
v_add_f32_dpp v192,v192,v192 row_ror:8 row_mask:0xf bank_mask:0xf
s_nop 1
v_add_f32_dpp v192,v192,v192 row_ror:4 row_mask:0xf bank_mask:0xf
s_nop 1
v_add_f32_dpp v192,v192,v192 row_ror:2 row_mask:0xf bank_mask:0xf
s_nop 1
v_add_f32_dpp v192,v192,v192 row_ror:1 row_mask:0xf bank_mask:0xf
v_mov_b32 v194,v192
s_nop 1
v_permlane16_swap_b32 v192,v194
v_add_f32 v192,v192,v194
v_mul_f32 v192,0x3b000000,v192
v_mov_b32 v194,v192
s_nop 1
v_permlane32_swap_b32 v192,v194
v_fma_f32 v194,-v192,v192,v194
v_add_f32 v192,s78,v192
v_max_f32 v194,0,v194
v_cvt_pk_bf16_f32 v194,v192,v194
v_lshlrev_b32 v192,16,v194
v_and_b32 v194,0xffff0000,v194
v_add_f32 v194,0x3727c5ac,v194
v_cvt_pk_bf16_f32 v194,v194,v194
v_and_b32 v194,0xffff0000,v194
v_sqrt_f32 v194,v194
v_pk_add_f32 v[184:185],v[200:201],v[192:193] op_sel_hi:[1,0] neg_lo:[0,1] neg_hi:[0,1]
v_pk_add_f32 v[186:187],v[202:203],v[192:193] op_sel_hi:[1,0] neg_lo:[0,1] neg_hi:[0,1]
v_pk_add_f32 v[188:189],v[204:205],v[192:193] op_sel_hi:[1,0] neg_lo:[0,1] neg_hi:[0,1]
v_pk_add_f32 v[190:191],v[206:207],v[192:193] op_sel_hi:[1,0] neg_lo:[0,1] neg_hi:[0,1]
v_cvt_pk_bf16_f32 v194,v194,v194
v_and_b32 v194,0xffff0000,v194
v_rcp_f32 v194,v194
v_cvt_pk_bf16_f32 v164,v184,v185
v_cvt_pk_bf16_f32 v165,v186,v187
v_cvt_pk_bf16_f32 v166,v188,v189
v_cvt_pk_bf16_f32 v167,v190,v191
v_lshlrev_b32 v184,16,v164
v_and_b32 v185,0xffff0000,v164
v_lshlrev_b32 v186,16,v165
v_and_b32 v187,0xffff0000,v165
v_lshlrev_b32 v188,16,v166
v_and_b32 v189,0xffff0000,v166
v_lshlrev_b32 v190,16,v167
v_and_b32 v191,0xffff0000,v167
v_pk_mul_f32 v[184:185],v[184:185],v[194:195] op_sel_hi:[1,0]
v_pk_mul_f32 v[186:187],v[186:187],v[194:195] op_sel_hi:[1,0]
v_pk_mul_f32 v[188:189],v[188:189],v[194:195] op_sel_hi:[1,0]
v_pk_mul_f32 v[190:191],v[190:191],v[194:195] op_sel_hi:[1,0]
v_cvt_pk_bf16_f32 v164,v184,v185
v_cvt_pk_bf16_f32 v165,v186,v187
v_cvt_pk_bf16_f32 v166,v188,v189
v_cvt_pk_bf16_f32 v167,v190,v191
s_add_u32 s20,s19,2097152
buffer_store_dwordx4 v[164:167],v0,s[8:11],s20 offen sc1
v_mov_b32 v20,1
s_lshl_b32 s73,s51,13
s_lshl2_add_u32 s73,s68,s73
s_add_u32 s73,s73,10487552
s_branch L_aa_86
L_ar_120:
ds_read_b128 v[160:163],v23
ds_read_b128 v[164:167],v23 offset:16
v_lshlrev_b32 v200,16,v224
v_and_b32 v201,0xffff0000,v224
v_lshlrev_b32 v202,16,v225
v_and_b32 v203,0xffff0000,v225
v_lshlrev_b32 v204,16,v226
v_and_b32 v205,0xffff0000,v226
v_lshlrev_b32 v206,16,v227
v_and_b32 v207,0xffff0000,v227
s_lshl_b32 s18,s51,5
s_add_u32 s18,s18,s68
s_lshl_b32 s19,s18,10
s_add_u32 s20,s19,4194304
s_waitcnt lgkmcnt(0)
v_cvt_pk_bf16_f32 v168,v160,v161
v_cvt_pk_bf16_f32 v169,v162,v163
v_cvt_pk_bf16_f32 v170,v164,v165
v_cvt_pk_bf16_f32 v171,v166,v167
v_lshlrev_b32 v160,16,v168
v_and_b32 v161,0xffff0000,v168
v_lshlrev_b32 v162,16,v169
v_and_b32 v163,0xffff0000,v169
v_lshlrev_b32 v164,16,v170
v_and_b32 v165,0xffff0000,v170
v_lshlrev_b32 v166,16,v171
v_and_b32 v167,0xffff0000,v171
v_pk_add_f32 v[200:201],v[200:201],v[160:161]
v_pk_add_f32 v[202:203],v[202:203],v[162:163]
v_pk_add_f32 v[204:205],v[204:205],v[164:165]
v_pk_add_f32 v[206:207],v[206:207],v[166:167]
v_cvt_pk_bf16_f32 v168,v200,v201
v_cvt_pk_bf16_f32 v169,v202,v203
v_cvt_pk_bf16_f32 v170,v204,v205
v_cvt_pk_bf16_f32 v171,v206,v207
buffer_store_dwordx4 v[168:171],v0,s[8:11],s20 offen sc1
v_lshlrev_b32 v200,16,v168
v_and_b32 v201,0xffff0000,v168
v_lshlrev_b32 v202,16,v169
v_and_b32 v203,0xffff0000,v169
v_lshlrev_b32 v204,16,v170
v_and_b32 v205,0xffff0000,v170
v_lshlrev_b32 v206,16,v171
v_and_b32 v207,0xffff0000,v171
v_readfirstlane_b32 s78,v200
s_nop 1
v_pk_add_f32 v[184:185],v[200:201],s[78:79] op_sel_hi:[1,0] neg_lo:[0,1] neg_hi:[0,1]
v_pk_add_f32 v[186:187],v[202:203],s[78:79] op_sel_hi:[1,0] neg_lo:[0,1] neg_hi:[0,1]
v_pk_add_f32 v[188:189],v[204:205],s[78:79] op_sel_hi:[1,0] neg_lo:[0,1] neg_hi:[0,1]
v_pk_add_f32 v[190:191],v[206:207],s[78:79] op_sel_hi:[1,0] neg_lo:[0,1] neg_hi:[0,1]
v_pk_add_f32 v[192:193],v[184:185],v[186:187]
v_pk_mul_f32 v[194:195],v[184:185],v[184:185]
v_pk_add_f32 v[196:197],v[188:189],v[190:191]
v_pk_fma_f32 v[194:195],v[186:187],v[186:187],v[194:195]
v_pk_add_f32 v[192:193],v[192:193],v[196:197]
v_pk_fma_f32 v[194:195],v[188:189],v[188:189],v[194:195]
v_add_f32 v192,v192,v193
v_pk_fma_f32 v[194:195],v[190:191],v[190:191],v[194:195]
v_add_f32 v194,v194,v195
s_nop 1
v_permlane32_swap_b32 v192,v194
v_add_f32 v192,v192,v194
s_nop 1
v_add_f32_dpp v192,v192,v192 row_ror:8 row_mask:0xf bank_mask:0xf
s_nop 1
v_add_f32_dpp v192,v192,v192 row_ror:4 row_mask:0xf bank_mask:0xf
s_nop 1
v_add_f32_dpp v192,v192,v192 row_ror:2 row_mask:0xf bank_mask:0xf
s_nop 1
v_add_f32_dpp v192,v192,v192 row_ror:1 row_mask:0xf bank_mask:0xf
v_mov_b32 v194,v192
s_nop 1
v_permlane16_swap_b32 v192,v194
v_add_f32 v192,v192,v194
v_mul_f32 v192,0x3b000000,v192
v_mov_b32 v194,v192
s_nop 1
v_permlane32_swap_b32 v192,v194
v_fma_f32 v194,-v192,v192,v194
v_add_f32 v192,s78,v192
v_max_f32 v194,0,v194
v_cvt_pk_bf16_f32 v194,v192,v194
v_lshlrev_b32 v192,16,v194
v_and_b32 v194,0xffff0000,v194
v_add_f32 v194,0x3727c5ac,v194
v_cvt_pk_bf16_f32 v194,v194,v194
v_and_b32 v194,0xffff0000,v194
v_sqrt_f32 v194,v194
v_pk_add_f32 v[184:185],v[200:201],v[192:193] op_sel_hi:[1,0] neg_lo:[0,1] neg_hi:[0,1]
v_pk_add_f32 v[186:187],v[202:203],v[192:193] op_sel_hi:[1,0] neg_lo:[0,1] neg_hi:[0,1]
v_pk_add_f32 v[188:189],v[204:205],v[192:193] op_sel_hi:[1,0] neg_lo:[0,1] neg_hi:[0,1]
v_pk_add_f32 v[190:191],v[206:207],v[192:193] op_sel_hi:[1,0] neg_lo:[0,1] neg_hi:[0,1]
v_cvt_pk_bf16_f32 v194,v194,v194
v_and_b32 v194,0xffff0000,v194
v_rcp_f32 v194,v194
v_cvt_pk_bf16_f32 v172,v184,v185
v_cvt_pk_bf16_f32 v173,v186,v187
v_cvt_pk_bf16_f32 v174,v188,v189
v_cvt_pk_bf16_f32 v175,v190,v191
v_lshlrev_b32 v184,16,v172
v_and_b32 v185,0xffff0000,v172
v_lshlrev_b32 v186,16,v173
v_and_b32 v187,0xffff0000,v173
v_lshlrev_b32 v188,16,v174
v_and_b32 v189,0xffff0000,v174
v_lshlrev_b32 v190,16,v175
v_and_b32 v191,0xffff0000,v175
v_pk_mul_f32 v[184:185],v[184:185],v[194:195] op_sel_hi:[1,0]
v_pk_mul_f32 v[186:187],v[186:187],v[194:195] op_sel_hi:[1,0]
v_pk_mul_f32 v[188:189],v[188:189],v[194:195] op_sel_hi:[1,0]
v_pk_mul_f32 v[190:191],v[190:191],v[194:195] op_sel_hi:[1,0]
v_cvt_pk_bf16_f32 v172,v184,v185
v_cvt_pk_bf16_f32 v173,v186,v187
v_cvt_pk_bf16_f32 v174,v188,v189
v_cvt_pk_bf16_f32 v175,v190,v191
v_lshlrev_b32 v176,16,v172
v_and_b32 v177,0xffff0000,v172
v_lshlrev_b32 v178,16,v173
v_and_b32 v179,0xffff0000,v173
v_lshlrev_b32 v180,16,v174
v_and_b32 v181,0xffff0000,v174
v_lshlrev_b32 v182,16,v175
v_and_b32 v183,0xffff0000,v175
v_pk_mul_f32 v[236:237],v[176:177],v[228:229]
v_pk_fma_f32 v[236:237],v[178:179],v[230:231],v[236:237]
v_pk_fma_f32 v[236:237],v[180:181],v[232:233],v[236:237]
v_pk_fma_f32 v[236:237],v[182:183],v[234:235],v[236:237]
v_add_f32 v236,v236,v237
s_nop 1
v_add_f32_dpp v236,v236,v236 row_ror:8 row_mask:0xf bank_mask:0xf
s_nop 1
v_add_f32_dpp v236,v236,v236 row_ror:4 row_mask:0xf bank_mask:0xf
s_nop 1
v_add_f32_dpp v236,v236,v236 row_ror:2 row_mask:0xf bank_mask:0xf
s_nop 1
v_add_f32_dpp v236,v236,v236 row_ror:1 row_mask:0xf bank_mask:0xf
v_mov_b32 v237,v236
s_nop 1
v_permlane16_swap_b32 v236,v237
v_add_f32 v236,v236,v237
v_mov_b32 v237,v236
s_nop 1
v_permlane32_swap_b32 v236,v237
v_add_f32 v236,v236,v237
v_cvt_pk_bf16_f32 v236,v236,v236
v_and_b32 v236,0xffff0000,v236
v_ashrrev_i32 v237,31,v236
v_or_b32 v237,0x80000000,v237
v_xor_b32 v236,v236,v237
v_and_b32 v236,0xffff0000,v236
s_sub_u32 s20,4095,s18
v_or_b32 v20,s20,v236
s_lshl_b32 s20,s51,13
s_lshl2_add_u32 s20,s68,s20
s_add_u32 s20,s20,10485760
buffer_store_dword v20,v254,s[8:11],s20 offen sc1
s_branch L_aa_86
L_ar_121:
s_bitcmp1_b32 s46,0
s_cbranch_scc1 L_aa_86
ds_read_b128 v[160:163],v23
ds_read_b128 v[164:167],v23 offset:16
v_lshlrev_b32 v200,16,v224
v_and_b32 v201,0xffff0000,v224
v_lshlrev_b32 v202,16,v225
v_and_b32 v203,0xffff0000,v225
v_lshlrev_b32 v204,16,v226
v_and_b32 v205,0xffff0000,v226
v_lshlrev_b32 v206,16,v227
v_and_b32 v207,0xffff0000,v227
v_readfirstlane_b32 s22,v246
s_cmp_eq_u32 s22,0
s_cbranch_scc1 L_ag_122
L_agb_123:
s_lshl_b32 s18,s51,5
s_add_u32 s18,s18,s68
s_lshl_b32 s19,s18,10
s_add_u32 s20,s19,6291456
s_waitcnt lgkmcnt(0)
v_cvt_pk_bf16_f32 v168,v160,v161
v_cvt_pk_bf16_f32 v169,v162,v163
v_cvt_pk_bf16_f32 v170,v164,v165
v_cvt_pk_bf16_f32 v171,v166,v167
v_lshlrev_b32 v160,16,v168
v_and_b32 v161,0xffff0000,v168
v_lshlrev_b32 v162,16,v169
v_and_b32 v163,0xffff0000,v169
v_lshlrev_b32 v164,16,v170
v_and_b32 v165,0xffff0000,v170
v_lshlrev_b32 v166,16,v171
v_and_b32 v167,0xffff0000,v171
v_pk_add_f32 v[200:201],v[200:201],v[160:161]
v_pk_add_f32 v[202:203],v[202:203],v[162:163]
v_pk_add_f32 v[204:205],v[204:205],v[164:165]
v_pk_add_f32 v[206:207],v[206:207],v[166:167]
v_cvt_pk_bf16_f32 v168,v200,v201
v_cvt_pk_bf16_f32 v169,v202,v203
v_cvt_pk_bf16_f32 v170,v204,v205
v_cvt_pk_bf16_f32 v171,v206,v207
buffer_store_dwordx4 v[168:171],v0,s[8:11],s20 offen sc1
v_lshlrev_b32 v200,16,v168
v_and_b32 v201,0xffff0000,v168
v_lshlrev_b32 v202,16,v169
v_and_b32 v203,0xffff0000,v169
v_lshlrev_b32 v204,16,v170
v_and_b32 v205,0xffff0000,v170
v_lshlrev_b32 v206,16,v171
v_and_b32 v207,0xffff0000,v171
v_readfirstlane_b32 s78,v200
s_nop 1
v_pk_add_f32 v[184:185],v[200:201],s[78:79] op_sel_hi:[1,0] neg_lo:[0,1] neg_hi:[0,1]
v_pk_add_f32 v[186:187],v[202:203],s[78:79] op_sel_hi:[1,0] neg_lo:[0,1] neg_hi:[0,1]
v_pk_add_f32 v[188:189],v[204:205],s[78:79] op_sel_hi:[1,0] neg_lo:[0,1] neg_hi:[0,1]
v_pk_add_f32 v[190:191],v[206:207],s[78:79] op_sel_hi:[1,0] neg_lo:[0,1] neg_hi:[0,1]
v_pk_add_f32 v[192:193],v[184:185],v[186:187]
v_pk_mul_f32 v[194:195],v[184:185],v[184:185]
v_pk_add_f32 v[196:197],v[188:189],v[190:191]
v_pk_fma_f32 v[194:195],v[186:187],v[186:187],v[194:195]
v_pk_add_f32 v[192:193],v[192:193],v[196:197]
v_pk_fma_f32 v[194:195],v[188:189],v[188:189],v[194:195]
v_add_f32 v192,v192,v193
v_pk_fma_f32 v[194:195],v[190:191],v[190:191],v[194:195]
v_add_f32 v194,v194,v195
s_nop 1
v_permlane32_swap_b32 v192,v194
v_add_f32 v192,v192,v194
s_nop 1
v_add_f32_dpp v192,v192,v192 row_ror:8 row_mask:0xf bank_mask:0xf
s_nop 1
v_add_f32_dpp v192,v192,v192 row_ror:4 row_mask:0xf bank_mask:0xf
s_nop 1
v_add_f32_dpp v192,v192,v192 row_ror:2 row_mask:0xf bank_mask:0xf
s_nop 1
v_add_f32_dpp v192,v192,v192 row_ror:1 row_mask:0xf bank_mask:0xf
v_mov_b32 v194,v192
s_nop 1
v_permlane16_swap_b32 v192,v194
v_add_f32 v192,v192,v194
v_mul_f32 v192,0x3b000000,v192
v_mov_b32 v194,v192
s_nop 1
v_permlane32_swap_b32 v192,v194
v_fma_f32 v194,-v192,v192,v194
v_add_f32 v192,s78,v192
v_max_f32 v194,0,v194
v_cvt_pk_bf16_f32 v194,v192,v194
v_lshlrev_b32 v192,16,v194
v_and_b32 v194,0xffff0000,v194
v_add_f32 v194,0x3727c5ac,v194
v_cvt_pk_bf16_f32 v194,v194,v194
v_and_b32 v194,0xffff0000,v194
v_sqrt_f32 v194,v194
v_pk_add_f32 v[184:185],v[200:201],v[192:193] op_sel_hi:[1,0] neg_lo:[0,1] neg_hi:[0,1]
v_pk_add_f32 v[186:187],v[202:203],v[192:193] op_sel_hi:[1,0] neg_lo:[0,1] neg_hi:[0,1]
v_pk_add_f32 v[188:189],v[204:205],v[192:193] op_sel_hi:[1,0] neg_lo:[0,1] neg_hi:[0,1]
v_pk_add_f32 v[190:191],v[206:207],v[192:193] op_sel_hi:[1,0] neg_lo:[0,1] neg_hi:[0,1]
v_cvt_pk_bf16_f32 v194,v194,v194
v_and_b32 v194,0xffff0000,v194
v_rcp_f32 v194,v194
v_cvt_pk_bf16_f32 v172,v184,v185
v_cvt_pk_bf16_f32 v173,v186,v187
v_cvt_pk_bf16_f32 v174,v188,v189
v_cvt_pk_bf16_f32 v175,v190,v191
v_lshlrev_b32 v184,16,v172
v_and_b32 v185,0xffff0000,v172
v_lshlrev_b32 v186,16,v173
v_and_b32 v187,0xffff0000,v173
v_lshlrev_b32 v188,16,v174
v_and_b32 v189,0xffff0000,v174
v_lshlrev_b32 v190,16,v175
v_and_b32 v191,0xffff0000,v175
v_pk_mul_f32 v[184:185],v[184:185],v[194:195] op_sel_hi:[1,0]
v_pk_mul_f32 v[186:187],v[186:187],v[194:195] op_sel_hi:[1,0]
v_pk_mul_f32 v[188:189],v[188:189],v[194:195] op_sel_hi:[1,0]
v_pk_mul_f32 v[190:191],v[190:191],v[194:195] op_sel_hi:[1,0]
v_cvt_pk_bf16_f32 v172,v184,v185
v_cvt_pk_bf16_f32 v173,v186,v187
v_cvt_pk_bf16_f32 v174,v188,v189
v_cvt_pk_bf16_f32 v175,v190,v191
v_lshlrev_b32 v176,16,v172
v_and_b32 v177,0xffff0000,v172
v_lshlrev_b32 v178,16,v173
v_and_b32 v179,0xffff0000,v173
v_lshlrev_b32 v180,16,v174
v_and_b32 v181,0xffff0000,v174
v_lshlrev_b32 v182,16,v175
v_and_b32 v183,0xffff0000,v175
v_pk_add_f32 v[200:201],v[200:201],v[176:177]
v_pk_add_f32 v[202:203],v[202:203],v[178:179]
v_pk_add_f32 v[204:205],v[204:205],v[180:181]
v_pk_add_f32 v[206:207],v[206:207],v[182:183]
v_cvt_pk_bf16_f32 v160,v200,v201
v_cvt_pk_bf16_f32 v161,v202,v203
v_cvt_pk_bf16_f32 v162,v204,v205
v_cvt_pk_bf16_f32 v163,v206,v207
buffer_store_dwordx4 v[160:163],v0,s[12:15],s19 offen sc1
v_pk_mul_f32 v[236:237],v[176:177],v[228:229]
v_pk_fma_f32 v[236:237],v[178:179],v[230:231],v[236:237]
v_pk_fma_f32 v[236:237],v[180:181],v[232:233],v[236:237]
v_pk_fma_f32 v[236:237],v[182:183],v[234:235],v[236:237]
v_add_f32 v236,v236,v237
s_nop 1
v_add_f32_dpp v236,v236,v236 row_ror:8 row_mask:0xf bank_mask:0xf
s_nop 1
v_add_f32_dpp v236,v236,v236 row_ror:4 row_mask:0xf bank_mask:0xf
s_nop 1
v_add_f32_dpp v236,v236,v236 row_ror:2 row_mask:0xf bank_mask:0xf
s_nop 1
v_add_f32_dpp v236,v236,v236 row_ror:1 row_mask:0xf bank_mask:0xf
v_mov_b32 v237,v236
s_nop 1
v_permlane16_swap_b32 v236,v237
v_add_f32 v236,v236,v237
v_mov_b32 v237,v236
s_nop 1
v_permlane32_swap_b32 v236,v237
v_add_f32 v236,v236,v237
v_cvt_pk_bf16_f32 v236,v236,v236
v_and_b32 v236,0xffff0000,v236
v_ashrrev_i32 v237,31,v236
v_or_b32 v237,0x80000000,v237
v_xor_b32 v236,v236,v237
v_and_b32 v236,0xffff0000,v236
s_sub_u32 s20,4095,s18
v_or_b32 v20,s20,v236
s_lshl_b32 s73,s51,13
s_lshl2_add_u32 s73,s68,s73
s_add_u32 s73,s73,10485760
s_add_u32 s73,s73,s86
L_aa_86:
s_cmp_eq_u32 s27,1
s_cbranch_scc1 L_ad_124
s_cmp_eq_u32 s27,0
s_cbranch_scc1 L_aa_87
s_cmp_eq_u32 s27,4
s_cbranch_scc1 L_a4_107
s_cmp_ge_u32 s77,64
s_cbranch_scc1 L_aa_90
L_aa_88:
s_waitcnt vmcnt(0)
buffer_store_dword v20,off,s[8:11],s73 sc1
s_mov_b32 s73,0x80000000
v_mov_b32 v18,0
s_mov_b32 s27,0
L_aw_125:
v_cmp_eq_u32 vcc,0,v18
s_cbranch_vccz L_awd_126
buffer_load_dword v18,v19,s[8:11],0 offen sc1
s_sub_u32 s49,s49,1
s_cbranch_scc1 L_abort
s_waitcnt vmcnt(0)
s_branch L_aw_125
L_awd_126:
L_a3_127:
s_mov_b32 s64,s70
s_mov_b32 s65,s71
s_add_u32 s64,s64,s28
s_add_u32 s65,s65,s29
s_xor_b32 s58,s67,s40
s_xor_b32 s57,s67,s41
s_add_u32 m0,s58,0
s_nop 0
buffer_load_dwordx4 v0,s[8:11],s64 offen offset:0 sc1 lds
buffer_load_dwordx4 v0,s[8:11],s64 offen offset:1024 sc1 lds
buffer_load_dwordx4 v0,s[8:11],s64 offen offset:2048 sc1 lds
buffer_load_dwordx4 v0,s[8:11],s64 offen offset:3072 sc1 lds
s_add_u32 m0,s58,4096
s_add_u32 s64,s64,4096
buffer_load_dwordx4 v0,s[8:11],s64 offen offset:0 sc1 lds
buffer_load_dwordx4 v0,s[8:11],s64 offen offset:1024 sc1 lds
buffer_load_dwordx4 v0,s[8:11],s64 offen offset:2048 sc1 lds
buffer_load_dwordx4 v0,s[8:11],s64 offen offset:3072 sc1 lds
s_add_u32 m0,s58,8192
s_add_u32 s64,s64,4096
buffer_load_dwordx4 v0,s[8:11],s64 offen offset:0 sc1 lds
buffer_load_dwordx4 v0,s[8:11],s64 offen offset:1024 sc1 lds
buffer_load_dwordx4 v0,s[8:11],s64 offen offset:2048 sc1 lds
buffer_load_dwordx4 v0,s[8:11],s64 offen offset:3072 sc1 lds
s_add_u32 m0,s57,24576
s_nop 0
buffer_load_dwordx4 v0,s[8:11],s65 offen offset:0 sc1 lds
buffer_load_dwordx4 v0,s[8:11],s65 offen offset:1024 sc1 lds
v_lshrrev_b32 v244,4,v1
s_sub_u32 s56,s77,7
v_add_u32 v244,s56,v244
v_max_i32 v244,0,v244
v_lshl_add_u32 v244,v244,13,v21
buffer_load_dwordx2 v[242:243],v244,s[8:11],0 offen sc1
s_waitcnt vmcnt(0) lgkmcnt(0)
s_barrier
s_xor_b32 s67,s67,65536
s_and_b32 s56,s50,2048
s_lshl_b32 s56,s56,4
s_add_u32 s56,s56,s67
v_add_u32 v2,s56,v0
s_and_b32 s56,s50,1024
s_lshl_b32 s56,s56,2
v_add_u32 v238,s56,v2
s_mov_b32 s76,s71
s_mov_b32 s53,s77
ds_read_b128 v[24:27],v238 offset:16384
ds_read_b128 v[40:43],v2 offset:0
ds_read_b128 v[56:59],v2 offset:4096
ds_read_b128 v[28:31],v238 offset:17408
ds_read_b128 v[44:47],v2 offset:1024
ds_read_b128 v[60:63],v2 offset:5120
ds_read_b128 v[32:35],v238 offset:18432
ds_read_b128 v[48:51],v2 offset:2048
ds_read_b128 v[64:67],v2 offset:6144
ds_read_b128 v[36:39],v238 offset:19456
ds_read_b128 v[52:55],v2 offset:3072
ds_read_b128 v[68:71],v2 offset:7168
s_waitcnt lgkmcnt(9)
v_mfma_f32_16x16x32_bf16 v[128:131],v[40:43],v[24:27],v[8:11]
ds_read_b128 v[72:75],v2 offset:24576
v_mfma_f32_16x16x32_bf16 v[132:135],v[56:59],v[24:27],v[12:15]
ds_read_b128 v[76:79],v2 offset:25600
s_waitcnt lgkmcnt(8)
v_mfma_f32_16x16x32_bf16 v[128:131],v[44:47],v[28:31],v[128:131]
ds_read_b128 v[80:83],v2 offset:26624
v_mfma_f32_16x16x32_bf16 v[132:135],v[60:63],v[28:31],v[132:135]
ds_read_b128 v[84:87],v2 offset:27648
s_waitcnt lgkmcnt(7)
v_mfma_f32_16x16x32_bf16 v[128:131],v[48:51],v[32:35],v[128:131]
ds_read_b128 v[88:91],v2 offset:8192
v_mfma_f32_16x16x32_bf16 v[132:135],v[64:67],v[32:35],v[132:135]
ds_read_b128 v[92:95],v2 offset:9216
s_waitcnt lgkmcnt(6)
v_mfma_f32_16x16x32_bf16 v[128:131],v[52:55],v[36:39],v[128:131]
ds_read_b128 v[96:99],v2 offset:10240
v_mfma_f32_16x16x32_bf16 v[132:135],v[68:71],v[36:39],v[132:135]
ds_read_b128 v[100:103],v2 offset:11264
s_waitcnt lgkmcnt(4)
s_mov_b32 vcc_lo,0x33333333
s_mov_b32 vcc_hi,0x33333333
v_mfma_f32_16x16x32_bf16 v[136:139],v[72:75],v[24:27],0
ds_read_b128 v[104:107],v2 offset:12288
v_max3_u32 v238,v72,v73,v74
v_max3_u32 v238,v74,v75,v238
v_cndmask_b32_dpp v120,v72,v74,vcc quad_perm:[0,1,0,1] row_mask:0xf bank_mask:0xf
v_cndmask_b32_dpp v121,v73,v75,vcc quad_perm:[0,1,0,1] row_mask:0xf bank_mask:0xf
v_mfma_f32_16x16x32_bf16 v[136:139],v[76:79],v[28:31],v[136:139]
ds_read_b128 v[108:111],v2 offset:13312
v_max3_u32 v238,v76,v77,v238
v_max3_u32 v238,v78,v79,v238
v_cndmask_b32_dpp v122,v76,v78,vcc quad_perm:[0,1,0,1] row_mask:0xf bank_mask:0xf
v_cndmask_b32_dpp v123,v77,v79,vcc quad_perm:[0,1,0,1] row_mask:0xf bank_mask:0xf
v_mfma_f32_16x16x32_bf16 v[136:139],v[80:83],v[32:35],v[136:139]
ds_read_b128 v[112:115],v2 offset:14336
v_max3_u32 v238,v80,v81,v238
v_max3_u32 v238,v82,v83,v238
v_cndmask_b32_dpp v124,v80,v82,vcc quad_perm:[0,1,0,1] row_mask:0xf bank_mask:0xf
v_cndmask_b32_dpp v125,v81,v83,vcc quad_perm:[0,1,0,1] row_mask:0xf bank_mask:0xf
v_mfma_f32_16x16x32_bf16 v[136:139],v[84:87],v[36:39],v[136:139]
ds_read_b128 v[116:119],v2 offset:15360
v_max3_u32 v238,v84,v85,v238
v_max3_u32 v238,v86,v87,v238
v_cndmask_b32_dpp v126,v84,v86,vcc quad_perm:[0,1,0,1] row_mask:0xf bank_mask:0xf
v_cndmask_b32_dpp v127,v85,v87,vcc quad_perm:[0,1,0,1] row_mask:0xf bank_mask:0xf
v_cmp_eq_u32 vcc,-1,v238
s_waitcnt lgkmcnt(0)
s_cmp_eq_u32 s30,0
s_cbranch_scc1 L_aa_89
s_cmp_lg_u32 s86,1536
s_cbranch_scc1 L_ae_128
s_mov_b32 s77,s35
s_mov_b32 s30,0
s_lshl_b32 s56,s77,5
s_add_u32 s56,s56,s68
s_mul_i32 s70,s56,24576
s_lshl_b32 s71,s56,12
s_lshl_b32 s59,s77,13
s_lshl2_add_u32 s59,s68,s59
s_add_u32 s59,s59,10485760
s_buffer_load_dword s32,s[8:11],s59
s_mov_b32 s33,1
s_add_u32 s70,s70,100663296
s_add_u32 s71,s71,41943040
v_mov_b32 v19,s59
s_branch L_af_129
L_ae_128:
s_ff1_i32_b64 s77,s[84:85]
s_bitset0_b64 s[84:85],s77
s_min_u32 s77,s77,64
s_lshr_b32 s61,s55,5
s_lshl_b32 s56,s77,5
s_add_u32 s56,s56,s68
s_mul_i32 s70,s56,24576
s_lshl_b32 s71,s56,12
s_lshl_b32 s59,s77,13
s_lshl2_add_u32 s59,s68,s59
s_add_u32 s59,s59,10486144
s_cmp_lt_u32 s77,s61
s_cselect_b32 s57,0,16777216
s_mov_b32 s60,s59
s_buffer_load_dword s33,s[8:11],s60
s_add_u32 s71,s71,s57
s_add_u32 s71,s71,58720256
s_cmp_eq_u32 s77,s61
s_cselect_b32 s57,50331648,0
s_cselect_b32 s58,1536,0
s_add_u32 s59,s59,s58
s_buffer_load_dword s32,s[8:11],s59
s_add_u32 s70,s70,s57
s_add_u32 s70,s70,150994944
v_mov_b32 v19,s59
v_writelane_b32 v19,s60,1
L_af_129:
L_a4_107:
s_waitcnt vmcnt(0)
buffer_store_dword v20,off,s[8:11],s73 sc1
s_mov_b32 s73,0x80000000
v_max3_u32 v238,v72,v73,v74
v_max3_u32 v238,v74,v75,v238
v_max3_u32 v238,v76,v77,v238
v_max3_u32 v238,v78,v79,v238
v_max3_u32 v238,v80,v81,v238
v_max3_u32 v238,v82,v83,v238
v_max3_u32 v238,v84,v85,v238
v_max3_u32 v238,v86,v87,v238
v_cmp_eq_u32 vcc,-1,v238
s_cbranch_vccnz L_ac_130
L_acb_131:
v_max3_f32 v238,v128,v129,v130
v_max3_f32 v239,v131,v132,v133
v_max3_f32 v238,v134,v135,v238
v_max3_f32 v239,v138,v139,v239
v_max_f32 v238,v238,v239
v_max_f32 v239,v238,v239
v_pk_mul_f32 v[128:129],v[128:129],v[152:153] op_sel_hi:[1,0]
v_pk_mul_f32 v[130:131],v[130:131],v[152:153] op_sel_hi:[1,0]
v_permlane16_swap_b32 v238,v239
v_max_f32 v238,v238,v239
v_max_f32 v239,v238,v239
v_pk_mul_f32 v[132:133],v[132:133],v[152:153] op_sel_hi:[1,0]
v_pk_mul_f32 v[134:135],v[134:135],v[152:153] op_sel_hi:[1,0]
v_permlane32_swap_b32 v238,v239
v_max_f32 v238,v238,v239
v_mul_f32 v238,v152,v238
v_pk_mul_f32 v[138:139],v[138:139],v[152:153] op_sel_hi:[1,0]
v_pk_add_f32 v[128:129],v[128:129],v[238:239] op_sel_hi:[1,0] neg_lo:[0,1] neg_hi:[0,1]
v_pk_add_f32 v[130:131],v[130:131],v[238:239] op_sel_hi:[1,0] neg_lo:[0,1] neg_hi:[0,1]
v_pk_add_f32 v[132:133],v[132:133],v[238:239] op_sel_hi:[1,0] neg_lo:[0,1] neg_hi:[0,1]
v_pk_add_f32 v[134:135],v[134:135],v[238:239] op_sel_hi:[1,0] neg_lo:[0,1] neg_hi:[0,1]
v_pk_add_f32 v[138:139],v[138:139],v[238:239] op_sel_hi:[1,0] neg_lo:[0,1] neg_hi:[0,1]
v_exp_f32 v128,v128
v_exp_f32 v129,v129
v_exp_f32 v130,v130
v_exp_f32 v131,v131
v_exp_f32 v132,v132
v_exp_f32 v133,v133
v_exp_f32 v134,v134
v_exp_f32 v135,v135
v_exp_f32 v138,v138
v_exp_f32 v139,v139
v_pk_add_f32 v[148:149],v[128:129],v[130:131]
v_pk_add_f32 v[150:151],v[132:133],v[134:135]
v_pk_add_f32 v[148:149],v[148:149],v[138:139]
v_pk_add_f32 v[148:149],v[148:149],v[150:151]
v_add_f32 v150,v148,v149
v_add_f32 v151,v148,v149
s_nop 1
v_permlane16_swap_b32 v150,v151
v_add_f32 v148,v150,v151
v_add_f32 v149,v150,v151
s_nop 1
v_permlane32_swap_b32 v148,v149
v_add_f32 v148,v148,v149
v_rcp_f32 v148,v148
s_nop 0
v_pk_mul_f32 v[138:139],v[138:139],v[148:149] op_sel_hi:[1,0]
v_pk_mul_f32 v[128:129],v[128:129],v[148:149] op_sel_hi:[1,0]
v_pk_mul_f32 v[130:131],v[130:131],v[148:149] op_sel_hi:[1,0]
v_pk_mul_f32 v[132:133],v[132:133],v[148:149] op_sel_hi:[1,0]
v_pk_mul_f32 v[134:135],v[134:135],v[148:149] op_sel_hi:[1,0]
v_cvt_pk_bf16_f32 v144,v138,v139
v_cvt_pk_bf16_f32 v147,v138,v139
s_nop 0
v_mfma_f32_16x16x16_bf16 v[24:27],v[120:121],v[144:145],0
v_cvt_pk_bf16_f32 v140,v128,v129
v_mfma_f32_16x16x16_bf16 v[28:31],v[120:121],v[146:147],0
v_cvt_pk_bf16_f32 v141,v130,v131
v_mfma_f32_16x16x16_bf16 v[32:35],v[122:123],v[144:145],0
v_cvt_pk_bf16_f32 v142,v132,v133
v_mfma_f32_16x16x16_bf16 v[36:39],v[122:123],v[146:147],0
v_cvt_pk_bf16_f32 v143,v134,v135
v_mfma_f32_16x16x16_bf16 v[40:43],v[124:125],v[144:145],0
v_mfma_f32_16x16x16_bf16 v[44:47],v[124:125],v[146:147],0
v_mfma_f32_16x16x16_bf16 v[48:51],v[126:127],v[144:145],0
v_mfma_f32_16x16x16_bf16 v[52:55],v[126:127],v[146:147],0
v_mfma_f32_16x16x32_bf16 v[24:27],v[88:91],v[140:143],v[24:27]
v_mfma_f32_16x16x32_bf16 v[28:31],v[92:95],v[140:143],v[28:31]
v_mfma_f32_16x16x32_bf16 v[32:35],v[96:99],v[140:143],v[32:35]
v_mfma_f32_16x16x32_bf16 v[36:39],v[100:103],v[140:143],v[36:39]
v_cvt_pk_bf16_f32 v72,v24,v28
v_cvt_pk_bf16_f32 v73,v25,v29
v_mfma_f32_16x16x32_bf16 v[40:43],v[104:107],v[140:143],v[40:43]
v_cvt_pk_bf16_f32 v74,v26,v30
v_cvt_pk_bf16_f32 v75,v27,v31
v_mfma_f32_16x16x32_bf16 v[44:47],v[108:111],v[140:143],v[44:47]
ds_write_b128 v3,v[72:75] offset:0
v_cvt_pk_bf16_f32 v76,v32,v36
v_cvt_pk_bf16_f32 v77,v33,v37
v_mfma_f32_16x16x32_bf16 v[48:51],v[112:115],v[140:143],v[48:51]
v_cvt_pk_bf16_f32 v78,v34,v38
v_cvt_pk_bf16_f32 v79,v35,v39
v_mfma_f32_16x16x32_bf16 v[52:55],v[116:119],v[140:143],v[52:55]
ds_write_b128 v3,v[76:79] offset:1024
v_cvt_pk_bf16_f32 v80,v40,v44
v_cvt_pk_bf16_f32 v81,v41,v45
v_cvt_pk_bf16_f32 v82,v42,v46
v_cvt_pk_bf16_f32 v83,v43,v47
ds_write_b128 v3,v[80:83] offset:2048
s_nop 1
v_cvt_pk_bf16_f32 v84,v48,v52
v_cvt_pk_bf16_f32 v85,v49,v53
v_cvt_pk_bf16_f32 v86,v50,v54
v_cvt_pk_bf16_f32 v87,v51,v55
ds_write_b128 v3,v[84:87] offset:3072
s_waitcnt lgkmcnt(0)
s_barrier
L_ad_124:
s_mov_b32 s51,s53
s_mov_b32 s31,1
s_branch L_aa_81
L_aa_87:
s_waitcnt vmcnt(0)
buffer_store_dword v20,off,s[8:11],s73 sc1
s_mov_b32 s73,0x80000000
L_aa_89:
s_mov_b32 s51,s53
s_mov_b32 s31,0
s_add_u32 s35,s53,4
s_cmp_lt_u32 s53,4
s_cbranch_scc1 L_ab_132
s_cmp_ge_u32 s53,63
s_cbranch_scc1 L_am_134
L_aw_135:
v_min_u32 v239,v242,v243
v_cmp_eq_u32 vcc,0,v239
s_cbranch_vccz L_awd_136
s_sleep 4
buffer_load_dwordx2 v[242:243],v244,s[8:11],0 offen sc1
s_sub_u32 s49,s49,1
s_cbranch_scc1 L_abort
s_waitcnt vmcnt(0)
s_branch L_aw_135
L_awd_136:
v_max_u32 v242,v242,v243
s_nop 1
v_max_u32_dpp v242,v242,v242 row_ror:8 row_mask:0xf bank_mask:0xf
s_nop 1
v_max_u32_dpp v242,v242,v242 row_ror:4 row_mask:0xf bank_mask:0xf
s_nop 1
v_max_u32_dpp v242,v242,v242 row_ror:2 row_mask:0xf bank_mask:0xf
s_nop 1
v_max_u32_dpp v242,v242,v242 row_ror:1 row_mask:0xf bank_mask:0xf
v_mov_b32 v243,v242
s_nop 1
v_permlane16_swap_b32 v242,v243
v_max_u32 v242,v242,v243
v_mov_b32 v243,v242
s_nop 1
v_permlane32_swap_b32 v242,v243
v_max_u32 v242,v242,v243
s_nop 0
v_readfirstlane_b32 s56,v242
v_readlane_b32 s57,v255,s53
s_max_u32 s75,s75,s56
s_bitcmp0_b64 s[42:43],s53
s_cbranch_scc1 L_ab_132
s_mov_b32 s77,s36
s_and_b32 s55,s75,0x7ff
s_sub_u32 s55,2047,s55
s_cmp_lt_u32 s75,s57
s_cselect_b32 s55,4095,s55
s_lshr_b32 s61,s55,5
s_mov_b32 s30,1
s_lshl_b32 s56,s77,5
s_add_u32 s56,s56,s68
s_mul_i32 s70,s56,24576
s_lshl_b32 s71,s56,12
s_lshl_b32 s59,s77,13
s_lshl2_add_u32 s59,s68,s59
s_add_u32 s59,s59,10486144
s_cmp_lt_u32 s77,s61
s_cselect_b32 s57,0,16777216
s_mov_b32 s60,s59
s_add_u32 s71,s71,s57
s_add_u32 s71,s71,58720256
s_cmp_eq_u32 s77,s61
s_cselect_b32 s57,50331648,0
s_cselect_b32 s58,1536,0
s_add_u32 s59,s59,s58
s_add_u32 s70,s70,s57
s_add_u32 s70,s70,150994944
v_mov_b32 v19,s59
v_writelane_b32 v19,s60,1
s_branch L_aj_133
L_ab_132:
s_mov_b32 s77,s35
s_mov_b32 s30,0
s_lshl_b32 s56,s77,5
s_add_u32 s56,s56,s68
s_mul_i32 s70,s56,24576
s_lshl_b32 s71,s56,12
s_lshl_b32 s59,s77,13
s_lshl2_add_u32 s59,s68,s59
s_add_u32 s59,s59,10485760
s_mov_b32 s33,1
s_add_u32 s70,s70,100663296
s_add_u32 s71,s71,41943040
v_mov_b32 v19,s59
L_aj_133:
buffer_load_dword v18,v19,s[8:11],0 offen sc1
s_waitcnt vmcnt(2)
s_mov_b32 vcc_lo,0x33333333
s_mov_b32 vcc_hi,0x33333333
v_mfma_f32_16x16x32_bf16 v[136:139],v[72:75],v[24:27],0
v_max3_u32 v238,v72,v73,v74
v_max3_u32 v238,v74,v75,v238
v_cndmask_b32_dpp v120,v72,v74,vcc quad_perm:[0,1,0,1] row_mask:0xf bank_mask:0xf
v_cndmask_b32_dpp v121,v73,v75,vcc quad_perm:[0,1,0,1] row_mask:0xf bank_mask:0xf
v_mfma_f32_16x16x32_bf16 v[136:139],v[76:79],v[28:31],v[136:139]
v_max3_u32 v238,v76,v77,v238
v_max3_u32 v238,v78,v79,v238
v_cndmask_b32_dpp v122,v76,v78,vcc quad_perm:[0,1,0,1] row_mask:0xf bank_mask:0xf
v_cndmask_b32_dpp v123,v77,v79,vcc quad_perm:[0,1,0,1] row_mask:0xf bank_mask:0xf
v_mfma_f32_16x16x32_bf16 v[136:139],v[80:83],v[32:35],v[136:139]
v_max3_u32 v238,v80,v81,v238
v_max3_u32 v238,v82,v83,v238
v_cndmask_b32_dpp v124,v80,v82,vcc quad_perm:[0,1,0,1] row_mask:0xf bank_mask:0xf
v_cndmask_b32_dpp v125,v81,v83,vcc quad_perm:[0,1,0,1] row_mask:0xf bank_mask:0xf
v_mfma_f32_16x16x32_bf16 v[136:139],v[84:87],v[36:39],v[136:139]
v_max3_u32 v238,v84,v85,v238
v_max3_u32 v238,v86,v87,v238
v_cndmask_b32_dpp v126,v84,v86,vcc quad_perm:[0,1,0,1] row_mask:0xf bank_mask:0xf
v_cndmask_b32_dpp v127,v85,v87,vcc quad_perm:[0,1,0,1] row_mask:0xf bank_mask:0xf
v_cmp_eq_u32 vcc,-1,v238
s_cbranch_vccz L_aa_92
L_aa_91:
buffer_load_dwordx4 v[72:75],v0,s[8:11],s76 offen offset:0 sc1
buffer_load_dwordx4 v[76:79],v0,s[8:11],s76 offen offset:1024 sc1
buffer_load_dwordx4 v[80:83],v0,s[8:11],s76 offen offset:2048 sc1
buffer_load_dwordx4 v[84:87],v0,s[8:11],s76 offen offset:3072 sc1
buffer_load_dword v18,v19,s[8:11],0 offen sc1
s_sub_u32 s49,s49,1
s_cbranch_scc1 L_abort
s_mov_b32 vcc_lo,0x33333333
s_mov_b32 vcc_hi,0x33333333
s_waitcnt vmcnt(4)
v_mfma_f32_16x16x32_bf16 v[136:139],v[72:75],v[24:27],0
v_max3_u32 v238,v72,v73,v74
v_max3_u32 v238,v74,v75,v238
v_cndmask_b32_dpp v120,v72,v74,vcc quad_perm:[0,1,0,1] row_mask:0xf bank_mask:0xf
v_cndmask_b32_dpp v121,v73,v75,vcc quad_perm:[0,1,0,1] row_mask:0xf bank_mask:0xf
s_waitcnt vmcnt(3)
v_mfma_f32_16x16x32_bf16 v[136:139],v[76:79],v[28:31],v[136:139]
v_max3_u32 v238,v76,v77,v238
v_max3_u32 v238,v78,v79,v238
v_cndmask_b32_dpp v122,v76,v78,vcc quad_perm:[0,1,0,1] row_mask:0xf bank_mask:0xf
v_cndmask_b32_dpp v123,v77,v79,vcc quad_perm:[0,1,0,1] row_mask:0xf bank_mask:0xf
s_waitcnt vmcnt(2)
v_mfma_f32_16x16x32_bf16 v[136:139],v[80:83],v[32:35],v[136:139]
v_max3_u32 v238,v80,v81,v238
v_max3_u32 v238,v82,v83,v238
v_cndmask_b32_dpp v124,v80,v82,vcc quad_perm:[0,1,0,1] row_mask:0xf bank_mask:0xf
v_cndmask_b32_dpp v125,v81,v83,vcc quad_perm:[0,1,0,1] row_mask:0xf bank_mask:0xf
s_waitcnt vmcnt(1)
v_mfma_f32_16x16x32_bf16 v[136:139],v[84:87],v[36:39],v[136:139]
v_max3_u32 v238,v84,v85,v238
v_max3_u32 v238,v86,v87,v238
v_cndmask_b32_dpp v126,v84,v86,vcc quad_perm:[0,1,0,1] row_mask:0xf bank_mask:0xf
v_cndmask_b32_dpp v127,v85,v87,vcc quad_perm:[0,1,0,1] row_mask:0xf bank_mask:0xf
v_cmp_eq_u32 vcc,-1,v238
s_cbranch_vccnz L_aa_91
L_aa_92:
s_cmp_lg_u32 s27,3
s_cbranch_scc1 L_ai_137
v_max3_f32 v238,v128,v129,v130
v_max3_f32 v239,v131,v132,v133
v_max3_f32 v238,v134,v135,v238
v_max3_f32 v239,v138,v139,v239
v_max_f32 v238,v238,v239
v_max_f32 v239,v238,v239
v_pk_mul_f32 v[128:129],v[128:129],v[152:153] op_sel_hi:[1,0]
v_pk_mul_f32 v[130:131],v[130:131],v[152:153] op_sel_hi:[1,0]
v_permlane16_swap_b32 v238,v239
v_max_f32 v238,v238,v239
v_max_f32 v239,v238,v239
v_pk_mul_f32 v[132:133],v[132:133],v[152:153] op_sel_hi:[1,0]
v_pk_mul_f32 v[134:135],v[134:135],v[152:153] op_sel_hi:[1,0]
v_permlane32_swap_b32 v238,v239
v_max_f32 v238,v238,v239
v_mul_f32 v238,v152,v238
v_pk_mul_f32 v[138:139],v[138:139],v[152:153] op_sel_hi:[1,0]
buffer_load_dword v17,v16,s[8:11],s87 offen sc1
v_pk_add_f32 v[128:129],v[128:129],v[238:239] op_sel_hi:[1,0] neg_lo:[0,1] neg_hi:[0,1]
v_pk_add_f32 v[130:131],v[130:131],v[238:239] op_sel_hi:[1,0] neg_lo:[0,1] neg_hi:[0,1]
v_pk_add_f32 v[132:133],v[132:133],v[238:239] op_sel_hi:[1,0] neg_lo:[0,1] neg_hi:[0,1]
v_pk_add_f32 v[134:135],v[134:135],v[238:239] op_sel_hi:[1,0] neg_lo:[0,1] neg_hi:[0,1]
v_pk_add_f32 v[138:139],v[138:139],v[238:239] op_sel_hi:[1,0] neg_lo:[0,1] neg_hi:[0,1]
v_exp_f32 v128,v128
v_exp_f32 v129,v129
v_exp_f32 v130,v130
v_exp_f32 v131,v131
v_exp_f32 v132,v132
v_exp_f32 v133,v133
v_exp_f32 v134,v134
v_exp_f32 v135,v135
v_exp_f32 v138,v138
v_exp_f32 v139,v139
v_pk_add_f32 v[148:149],v[128:129],v[130:131]
v_pk_add_f32 v[150:151],v[132:133],v[134:135]
v_pk_add_f32 v[148:149],v[148:149],v[138:139]
v_pk_add_f32 v[148:149],v[148:149],v[150:151]
v_add_f32 v150,v148,v149
v_add_f32 v151,v148,v149
s_nop 1
v_permlane16_swap_b32 v150,v151
v_add_f32 v148,v150,v151
v_add_f32 v149,v150,v151
s_nop 1
v_permlane32_swap_b32 v148,v149
v_add_f32 v148,v148,v149
v_rcp_f32 v148,v148
s_waitcnt vmcnt(0)
v_cmp_gt_u32 vcc,s66,v17
v_pk_mul_f32 v[138:139],v[138:139],v[148:149] op_sel_hi:[1,0]
v_pk_mul_f32 v[128:129],v[128:129],v[148:149] op_sel_hi:[1,0]
v_pk_mul_f32 v[130:131],v[130:131],v[148:149] op_sel_hi:[1,0]
v_pk_mul_f32 v[132:133],v[132:133],v[148:149] op_sel_hi:[1,0]
v_pk_mul_f32 v[134:135],v[134:135],v[148:149] op_sel_hi:[1,0]
s_cbranch_vccnz L_ap_138
L_apb_139:
s_xor_b32 s34,s69,524288
buffer_load_dwordx4 v[192:195],v7,s[8:11],s34 offen sc1
v_cvt_pk_bf16_f32 v144,v138,v139
v_cvt_pk_bf16_f32 v147,v138,v139
s_nop 0
v_mfma_f32_16x16x16_bf16 v[24:27],v[120:121],v[144:145],0
s_add_u32 s34,s34,4096
v_cvt_pk_bf16_f32 v140,v128,v129
v_mfma_f32_16x16x16_bf16 v[28:31],v[120:121],v[146:147],0
buffer_load_dwordx4 v[196:199],v7,s[8:11],s34 offen sc1
v_cvt_pk_bf16_f32 v141,v130,v131
v_mfma_f32_16x16x16_bf16 v[32:35],v[122:123],v[144:145],0
s_add_u32 s34,s34,4096
v_cvt_pk_bf16_f32 v142,v132,v133
v_mfma_f32_16x16x16_bf16 v[36:39],v[122:123],v[146:147],0
buffer_load_dwordx4 v[200:203],v7,s[8:11],s34 offen sc1
v_cvt_pk_bf16_f32 v143,v134,v135
v_mfma_f32_16x16x16_bf16 v[40:43],v[124:125],v[144:145],0
s_add_u32 s34,s34,4096
v_mfma_f32_16x16x16_bf16 v[44:47],v[124:125],v[146:147],0
buffer_load_dwordx4 v[204:207],v7,s[8:11],s34 offen sc1
v_mfma_f32_16x16x16_bf16 v[48:51],v[126:127],v[144:145],0
s_add_u32 s34,s34,4096
v_mfma_f32_16x16x16_bf16 v[52:55],v[126:127],v[146:147],0
buffer_load_dwordx4 v[208:211],v7,s[8:11],s34 offen sc1
v_mfma_f32_16x16x32_bf16 v[24:27],v[88:91],v[140:143],v[24:27]
s_add_u32 s34,s34,4096
v_mfma_f32_16x16x32_bf16 v[28:31],v[92:95],v[140:143],v[28:31]
buffer_load_dwordx4 v[212:215],v7,s[8:11],s34 offen sc1
v_mfma_f32_16x16x32_bf16 v[32:35],v[96:99],v[140:143],v[32:35]
s_add_u32 s34,s34,4096
v_mfma_f32_16x16x32_bf16 v[36:39],v[100:103],v[140:143],v[36:39]
buffer_load_dwordx4 v[216:219],v7,s[8:11],s34 offen sc1
v_cvt_pk_bf16_f32 v72,v24,v28
v_cvt_pk_bf16_f32 v73,v25,v29
v_mfma_f32_16x16x32_bf16 v[40:43],v[104:107],v[140:143],v[40:43]
s_add_u32 s34,s34,4096
v_cvt_pk_bf16_f32 v74,v26,v30
v_cvt_pk_bf16_f32 v75,v27,v31
v_mfma_f32_16x16x32_bf16 v[44:47],v[108:111],v[140:143],v[44:47]
ds_write_b128 v3,v[72:75] offset:0
v_cvt_pk_bf16_f32 v76,v32,v36
v_cvt_pk_bf16_f32 v77,v33,v37
v_mfma_f32_16x16x32_bf16 v[48:51],v[112:115],v[140:143],v[48:51]
buffer_load_dwordx4 v[220:223],v7,s[8:11],s34 offen sc1
v_cvt_pk_bf16_f32 v78,v34,v38
v_cvt_pk_bf16_f32 v79,v35,v39
v_mfma_f32_16x16x32_bf16 v[52:55],v[116:119],v[140:143],v[52:55]
ds_write_b128 v3,v[76:79] offset:1024
v_cvt_pk_bf16_f32 v80,v40,v44
v_cvt_pk_bf16_f32 v81,v41,v45
v_cvt_pk_bf16_f32 v82,v42,v46
v_cvt_pk_bf16_f32 v83,v43,v47
ds_write_b128 v3,v[80:83] offset:2048
s_nop 1
v_cvt_pk_bf16_f32 v84,v48,v52
v_cvt_pk_bf16_f32 v85,v49,v53
v_cvt_pk_bf16_f32 v86,v50,v54
v_cvt_pk_bf16_f32 v87,v51,v55
ds_write_b128 v3,v[84:87] offset:3072
v_readlane_b32 s32,v18,0
v_readlane_b32 s33,v18,1
s_waitcnt lgkmcnt(0)
s_barrier
s_branch L_aa_94
L_ai_137:
v_max3_f32 v238,v128,v129,v130
v_max3_f32 v239,v131,v132,v133
v_max3_f32 v238,v134,v135,v238
v_max3_f32 v239,v138,v139,v239
v_max_f32 v238,v238,v239
v_max_f32 v239,v238,v239
v_pk_mul_f32 v[128:129],v[128:129],v[152:153] op_sel_hi:[1,0]
v_pk_mul_f32 v[130:131],v[130:131],v[152:153] op_sel_hi:[1,0]
v_permlane16_swap_b32 v238,v239
v_max_f32 v238,v238,v239
v_max_f32 v239,v238,v239
v_pk_mul_f32 v[132:133],v[132:133],v[152:153] op_sel_hi:[1,0]
v_pk_mul_f32 v[134:135],v[134:135],v[152:153] op_sel_hi:[1,0]
v_permlane32_swap_b32 v238,v239
v_max_f32 v238,v238,v239
v_mul_f32 v238,v152,v238
v_pk_mul_f32 v[138:139],v[138:139],v[152:153] op_sel_hi:[1,0]
v_pk_add_f32 v[128:129],v[128:129],v[238:239] op_sel_hi:[1,0] neg_lo:[0,1] neg_hi:[0,1]
v_pk_add_f32 v[130:131],v[130:131],v[238:239] op_sel_hi:[1,0] neg_lo:[0,1] neg_hi:[0,1]
v_pk_add_f32 v[132:133],v[132:133],v[238:239] op_sel_hi:[1,0] neg_lo:[0,1] neg_hi:[0,1]
v_pk_add_f32 v[134:135],v[134:135],v[238:239] op_sel_hi:[1,0] neg_lo:[0,1] neg_hi:[0,1]
v_pk_add_f32 v[138:139],v[138:139],v[238:239] op_sel_hi:[1,0] neg_lo:[0,1] neg_hi:[0,1]
v_exp_f32 v128,v128
v_exp_f32 v129,v129
v_exp_f32 v130,v130
v_exp_f32 v131,v131
v_exp_f32 v132,v132
v_exp_f32 v133,v133
v_exp_f32 v134,v134
v_exp_f32 v135,v135
v_exp_f32 v138,v138
v_exp_f32 v139,v139
v_pk_add_f32 v[148:149],v[128:129],v[130:131]
v_pk_add_f32 v[150:151],v[132:133],v[134:135]
v_pk_add_f32 v[148:149],v[148:149],v[138:139]
v_pk_add_f32 v[148:149],v[148:149],v[150:151]
v_add_f32 v150,v148,v149
v_add_f32 v151,v148,v149
s_nop 1
v_permlane16_swap_b32 v150,v151
v_add_f32 v148,v150,v151
v_add_f32 v149,v150,v151
s_nop 1
v_permlane32_swap_b32 v148,v149
v_add_f32 v148,v148,v149
v_rcp_f32 v148,v148
s_nop 0
v_pk_mul_f32 v[138:139],v[138:139],v[148:149] op_sel_hi:[1,0]
v_pk_mul_f32 v[128:129],v[128:129],v[148:149] op_sel_hi:[1,0]
v_pk_mul_f32 v[130:131],v[130:131],v[148:149] op_sel_hi:[1,0]
v_pk_mul_f32 v[132:133],v[132:133],v[148:149] op_sel_hi:[1,0]
v_pk_mul_f32 v[134:135],v[134:135],v[148:149] op_sel_hi:[1,0]
v_cvt_pk_bf16_f32 v144,v138,v139
v_cvt_pk_bf16_f32 v147,v138,v139
s_nop 0
v_mfma_f32_16x16x16_bf16 v[24:27],v[120:121],v[144:145],0
v_cvt_pk_bf16_f32 v140,v128,v129
v_mfma_f32_16x16x16_bf16 v[28:31],v[120:121],v[146:147],0
v_cvt_pk_bf16_f32 v141,v130,v131
v_mfma_f32_16x16x16_bf16 v[32:35],v[122:123],v[144:145],0
v_cvt_pk_bf16_f32 v142,v132,v133
v_mfma_f32_16x16x16_bf16 v[36:39],v[122:123],v[146:147],0
v_cvt_pk_bf16_f32 v143,v134,v135
v_mfma_f32_16x16x16_bf16 v[40:43],v[124:125],v[144:145],0
v_mfma_f32_16x16x16_bf16 v[44:47],v[124:125],v[146:147],0
v_mfma_f32_16x16x16_bf16 v[48:51],v[126:127],v[144:145],0
v_mfma_f32_16x16x16_bf16 v[52:55],v[126:127],v[146:147],0
v_mfma_f32_16x16x32_bf16 v[24:27],v[88:91],v[140:143],v[24:27]
v_mfma_f32_16x16x32_bf16 v[28:31],v[92:95],v[140:143],v[28:31]
v_mfma_f32_16x16x32_bf16 v[32:35],v[96:99],v[140:143],v[32:35]
v_mfma_f32_16x16x32_bf16 v[36:39],v[100:103],v[140:143],v[36:39]
v_cvt_pk_bf16_f32 v72,v24,v28
v_cvt_pk_bf16_f32 v73,v25,v29
v_mfma_f32_16x16x32_bf16 v[40:43],v[104:107],v[140:143],v[40:43]
v_cvt_pk_bf16_f32 v74,v26,v30
v_cvt_pk_bf16_f32 v75,v27,v31
v_mfma_f32_16x16x32_bf16 v[44:47],v[108:111],v[140:143],v[44:47]
ds_write_b128 v3,v[72:75] offset:0
v_cvt_pk_bf16_f32 v76,v32,v36
v_cvt_pk_bf16_f32 v77,v33,v37
v_mfma_f32_16x16x32_bf16 v[48:51],v[112:115],v[140:143],v[48:51]
v_cvt_pk_bf16_f32 v78,v34,v38
v_cvt_pk_bf16_f32 v79,v35,v39
v_mfma_f32_16x16x32_bf16 v[52:55],v[116:119],v[140:143],v[52:55]
ds_write_b128 v3,v[76:79] offset:1024
v_cvt_pk_bf16_f32 v80,v40,v44
v_cvt_pk_bf16_f32 v81,v41,v45
v_cvt_pk_bf16_f32 v82,v42,v46
v_cvt_pk_bf16_f32 v83,v43,v47
ds_write_b128 v3,v[80:83] offset:2048
s_nop 1
v_cvt_pk_bf16_f32 v84,v48,v52
v_cvt_pk_bf16_f32 v85,v49,v53
v_cvt_pk_bf16_f32 v86,v50,v54
v_cvt_pk_bf16_f32 v87,v51,v55
ds_write_b128 v3,v[84:87] offset:3072
s_waitcnt vmcnt(0)
v_readlane_b32 s32,v18,0
v_readlane_b32 s33,v18,1
s_waitcnt lgkmcnt(0)
s_barrier
s_branch L_aa_81
L_aa_90:
s_cmp_lg_u32 s86,1536
s_cbranch_scc1 L_az_140
s_cmp_ge_u32 s35,67
s_cbranch_scc1 L_aa_80
v_subrev_u32 v248,s36,v1
v_and_b32 v248,0x80000003,v248
v_cmp_eq_u32 vcc,0,v248
v_lshlrev_b32 v248,2,v1
v_mov_b32 v249,0x40000000
v_cndmask_b32 v248,v249,v248,vcc
v_mov_b32 v249,3
s_or_b32 s59,s68,s46
s_mov_b32 s59,11018240
s_cmov_b32 s59,0x80000000
buffer_store_dword v249,v248,s[8:11],s59 offen sc1
L_aa_80:
s_waitcnt vmcnt(0)
buffer_store_dword v20,off,s[8:11],s73 sc1
s_mov_b32 s73,0x80000000
v_lshlrev_b32 v238,2,v1
v_add_u32 v248,155712,v238
s_cmp_lg_u32 s46,0
s_cbranch_scc1 L_an_141
s_lshl_b32 s59,s54,13
s_add_u32 s59,s59,11026432
L_fp_142:
s_sleep 1
buffer_load_dword v239,v238,s[8:11],s59 offen sc1
s_sub_u32 s49,s49,1
s_cbranch_scc1 L_abort
s_waitcnt vmcnt(0)
v_cmp_eq_u32 vcc,0,v239
s_cbranch_vccnz L_fp_142
ds_write_b32 v248,v239
s_waitcnt lgkmcnt(0)
L_an_141:
s_barrier
ds_read_b32 v239,v248
s_mov_b32 s86,768
s_mov_b32 s30,1
s_waitcnt lgkmcnt(0)
v_readfirstlane_b32 s55,v239
v_and_b32 v239,255,v239
s_lshr_b32 s55,s55,8
s_lshr_b32 s61,s55,5
v_cmp_ne_u32 s[38:39],3,v239
v_cmp_le_u32 vcc,s61,v1
s_nop 1
v_cndmask_b32 v238,1,2,vcc
v_cmp_ne_u32 s[84:85],v238,v239
s_bcnt1_i32_b64 s56,s[84:85]
s_nop 0
v_mbcnt_lo_u32_b32 v238,s84,0
v_mbcnt_hi_u32_b32 v238,s85,v238
s_mul_i32 s56,s56,12
s_add_u32 s56,s56,130
s_lshr_b32 s56,s56,7
s_lshl_b32 s56,s56,1
v_cmp_gt_u32 vcc,s56,v238
v_and_b32 v239,1,v238
v_and_b32 v238,3,v238
v_add_u32 v238,2,v238
v_cndmask_b32 v238,v238,v239,vcc
v_cmp_eq_u32 vcc,s54,v238
s_and_b64 s[84:85],s[84:85],vcc
s_ff1_i32_b64 s77,s[84:85]
s_bitset0_b64 s[84:85],s77
s_min_u32 s77,s77,64
s_lshl_b32 s56,s77,5
s_add_u32 s56,s56,s68
s_mul_i32 s70,s56,24576
s_lshl_b32 s71,s56,12
s_lshl_b32 s59,s77,13
s_lshl2_add_u32 s59,s68,s59
s_add_u32 s59,s59,10486144
s_cmp_lt_u32 s77,s61
s_cselect_b32 s57,0,16777216
s_mov_b32 s60,s59
s_buffer_load_dword s33,s[8:11],s60
s_add_u32 s71,s71,s57
s_add_u32 s71,s71,58720256
s_cmp_eq_u32 s77,s61
s_cselect_b32 s57,50331648,0
s_cselect_b32 s58,1536,0
s_add_u32 s59,s59,s58
s_buffer_load_dword s32,s[8:11],s59
s_add_u32 s70,s70,s57
s_add_u32 s70,s70,150994944
v_mov_b32 v19,s59
v_writelane_b32 v19,s60,1
s_cmp_ge_u32 s77,64
s_cbranch_scc1 L_az_140
s_cmp_eq_u32 s77,s61
s_cbranch_scc1 L_aa_88
s_mov_b32 s27,0
s_bitcmp1_b64 s[38:39],s77
s_cbranch_scc1 L_a3_127
s_branch L_aa_88
L_az_140:
s_waitcnt vmcnt(0)
buffer_store_dword v20,off,s[8:11],s73 sc1
s_mov_b32 s73,0x80000000
s_endpgm
L_ag_96:
s_lshl_b32 s21,s26,13
s_lshl2_add_u32 s21,s68,s21
s_add_u32 s21,s21,10487296
L_ww_143:
buffer_load_dword v246,off,s[8:11],s21 sc1
s_sub_u32 s49,s49,1
s_cbranch_scc1 L_abort
s_waitcnt vmcnt(0)
v_readfirstlane_b32 s22,v246
s_cmp_eq_u32 s22,0
s_cbranch_scc1 L_ww_143
L_wwd_144:
s_branch L_agb_97
L_a4_105:
v_mov_b32 v248,s27
ds_write_b32 v247,v248 offset:16
s_waitcnt lgkmcnt(0)
s_barrier
ds_read_b128 v[248:251],v245 offset:16
s_waitcnt lgkmcnt(0)
v_or3_b32 v248,v248,v249,v250
v_or_b32 v248,v248,v251
v_cmp_ne_u32 vcc,0,v248
s_cbranch_vccz L_a4_106
L_aq_145:
buffer_load_dword v17,v16,s[8:11],s87 offen sc1
s_sub_u32 s49,s49,1
s_cbranch_scc1 L_abort
s_waitcnt vmcnt(0)
v_cmp_gt_u32 vcc,s66,v17
s_cbranch_vccnz L_aq_145
s_xor_b32 s34,s69,524288
buffer_load_dwordx4 v[160:163],v7,s[8:11],s34 offen sc1
s_add_u32 s34,s34,4096
buffer_load_dwordx4 v[164:167],v7,s[8:11],s34 offen sc1
s_add_u32 s34,s34,4096
buffer_load_dwordx4 v[168:171],v7,s[8:11],s34 offen sc1
s_add_u32 s34,s34,4096
buffer_load_dwordx4 v[172:175],v7,s[8:11],s34 offen sc1
s_add_u32 s34,s34,4096
buffer_load_dwordx4 v[176:179],v7,s[8:11],s34 offen sc1
s_add_u32 s34,s34,4096
buffer_load_dwordx4 v[180:183],v7,s[8:11],s34 offen sc1
s_add_u32 s34,s34,4096
buffer_load_dwordx4 v[184:187],v7,s[8:11],s34 offen sc1
s_add_u32 s34,s34,4096
buffer_load_dwordx4 v[188:191],v7,s[8:11],s34 offen sc1
s_waitcnt vmcnt(7)
v_mfma_f32_16x16x32_bf16 v[192:195],v[156:159],v[160:163],0
s_waitcnt vmcnt(6)
v_mfma_f32_16x16x32_bf16 v[192:195],v[156:159],v[164:167],v[192:195]
s_waitcnt vmcnt(5)
v_mfma_f32_16x16x32_bf16 v[192:195],v[156:159],v[168:171],v[192:195]
s_waitcnt vmcnt(4)
v_mfma_f32_16x16x32_bf16 v[192:195],v[156:159],v[172:175],v[192:195]
s_waitcnt vmcnt(3)
v_mfma_f32_16x16x32_bf16 v[196:199],v[156:159],v[176:179],0
s_waitcnt vmcnt(2)
v_mfma_f32_16x16x32_bf16 v[196:199],v[156:159],v[180:183],v[196:199]
s_waitcnt vmcnt(1)
v_mfma_f32_16x16x32_bf16 v[196:199],v[156:159],v[184:187],v[196:199]
ds_write_b128 v6,v[192:195]
s_waitcnt vmcnt(0)
v_mfma_f32_16x16x32_bf16 v[196:199],v[156:159],v[188:191],v[196:199]
s_nop 7
ds_write_b128 v6,v[196:199] offset:2048
s_waitcnt lgkmcnt(0)
s_barrier
buffer_store_dword v20,off,s[8:11],s73 sc1
s_mov_b32 s73,0x80000000
s_mov_b32 s27,4
s_branch L_aa_85
L_ac_108:
buffer_store_dword v20,off,s[8:11],s73 sc1
s_mov_b32 s73,0x80000000
buffer_load_dwordx4 v[72:75],v0,s[8:11],s76 offen offset:0 sc1
buffer_load_dwordx4 v[76:79],v0,s[8:11],s76 offen offset:1024 sc1
buffer_load_dwordx4 v[80:83],v0,s[8:11],s76 offen offset:2048 sc1
buffer_load_dwordx4 v[84:87],v0,s[8:11],s76 offen offset:3072 sc1
s_sub_u32 s49,s49,1
s_cbranch_scc1 L_abort
s_mov_b32 vcc_lo,0x33333333
s_mov_b32 vcc_hi,0x33333333
s_waitcnt vmcnt(3)
v_mfma_f32_16x16x32_bf16 v[136:139],v[72:75],v[24:27],0
v_max3_u32 v238,v72,v73,v74
v_max3_u32 v238,v74,v75,v238
v_cndmask_b32_dpp v120,v72,v74,vcc quad_perm:[0,1,0,1] row_mask:0xf bank_mask:0xf
v_cndmask_b32_dpp v121,v73,v75,vcc quad_perm:[0,1,0,1] row_mask:0xf bank_mask:0xf
s_waitcnt vmcnt(2)
v_mfma_f32_16x16x32_bf16 v[136:139],v[76:79],v[28:31],v[136:139]
v_max3_u32 v238,v76,v77,v238
v_max3_u32 v238,v78,v79,v238
v_cndmask_b32_dpp v122,v76,v78,vcc quad_perm:[0,1,0,1] row_mask:0xf bank_mask:0xf
v_cndmask_b32_dpp v123,v77,v79,vcc quad_perm:[0,1,0,1] row_mask:0xf bank_mask:0xf
s_waitcnt vmcnt(1)
v_mfma_f32_16x16x32_bf16 v[136:139],v[80:83],v[32:35],v[136:139]
v_max3_u32 v238,v80,v81,v238
v_max3_u32 v238,v82,v83,v238
v_cndmask_b32_dpp v124,v80,v82,vcc quad_perm:[0,1,0,1] row_mask:0xf bank_mask:0xf
v_cndmask_b32_dpp v125,v81,v83,vcc quad_perm:[0,1,0,1] row_mask:0xf bank_mask:0xf
s_waitcnt vmcnt(0)
v_mfma_f32_16x16x32_bf16 v[136:139],v[84:87],v[36:39],v[136:139]
v_max3_u32 v238,v84,v85,v238
v_max3_u32 v238,v86,v87,v238
v_cndmask_b32_dpp v126,v84,v86,vcc quad_perm:[0,1,0,1] row_mask:0xf bank_mask:0xf
v_cndmask_b32_dpp v127,v85,v87,vcc quad_perm:[0,1,0,1] row_mask:0xf bank_mask:0xf
v_cmp_eq_u32 vcc,-1,v238
s_cbranch_vccnz L_ac_108
s_branch L_acb_109
L_ap_111:
L_aw_146:
v_cmp_gt_u32 vcc,s66,v17
s_cbranch_vccz L_awd_147
buffer_load_dword v17,v16,s[8:11],s87 offen sc1
s_sub_u32 s49,s49,1
s_cbranch_scc1 L_abort
s_waitcnt vmcnt(0)
s_branch L_aw_146
L_awd_147:
s_branch L_apb_112
L_a1_113:
v_subrev_u32 v248,s36,v1
v_and_b32 v248,0x80000003,v248
v_cmp_eq_u32 vcc,0,v248
v_lshlrev_b32 v248,2,v1
v_mov_b32 v249,0x40000000
v_cndmask_b32 v248,v249,v248,vcc
v_mov_b32 v249,3
s_or_b32 s59,s68,s46
s_mov_b32 s59,11018240
s_cmov_b32 s59,0x80000000
buffer_store_dword v249,v248,s[8:11],s59 offen sc1
s_branch L_a2_114
L_ag_122:
s_lshl_b32 s21,s51,13
s_lshl2_add_u32 s21,s68,s21
s_add_u32 s21,s21,10487296
L_ww_148:
buffer_load_dword v246,off,s[8:11],s21 sc1
s_sub_u32 s49,s49,1
s_cbranch_scc1 L_abort
s_waitcnt vmcnt(0)
v_readfirstlane_b32 s22,v246
s_cmp_eq_u32 s22,0
s_cbranch_scc1 L_ww_148
L_wwd_149:
s_branch L_agb_123
L_ac_130:
buffer_store_dword v20,off,s[8:11],s73 sc1
s_mov_b32 s73,0x80000000
buffer_load_dwordx4 v[72:75],v0,s[8:11],s76 offen offset:0 sc1
buffer_load_dwordx4 v[76:79],v0,s[8:11],s76 offen offset:1024 sc1
buffer_load_dwordx4 v[80:83],v0,s[8:11],s76 offen offset:2048 sc1
buffer_load_dwordx4 v[84:87],v0,s[8:11],s76 offen offset:3072 sc1
s_sub_u32 s49,s49,1
s_cbranch_scc1 L_abort
s_mov_b32 vcc_lo,0x33333333
s_mov_b32 vcc_hi,0x33333333
s_waitcnt vmcnt(3)
v_mfma_f32_16x16x32_bf16 v[136:139],v[72:75],v[24:27],0
v_max3_u32 v238,v72,v73,v74
v_max3_u32 v238,v74,v75,v238
v_cndmask_b32_dpp v120,v72,v74,vcc quad_perm:[0,1,0,1] row_mask:0xf bank_mask:0xf
v_cndmask_b32_dpp v121,v73,v75,vcc quad_perm:[0,1,0,1] row_mask:0xf bank_mask:0xf
s_waitcnt vmcnt(2)
v_mfma_f32_16x16x32_bf16 v[136:139],v[76:79],v[28:31],v[136:139]
v_max3_u32 v238,v76,v77,v238
v_max3_u32 v238,v78,v79,v238
v_cndmask_b32_dpp v122,v76,v78,vcc quad_perm:[0,1,0,1] row_mask:0xf bank_mask:0xf
v_cndmask_b32_dpp v123,v77,v79,vcc quad_perm:[0,1,0,1] row_mask:0xf bank_mask:0xf
s_waitcnt vmcnt(1)
v_mfma_f32_16x16x32_bf16 v[136:139],v[80:83],v[32:35],v[136:139]
v_max3_u32 v238,v80,v81,v238
v_max3_u32 v238,v82,v83,v238
v_cndmask_b32_dpp v124,v80,v82,vcc quad_perm:[0,1,0,1] row_mask:0xf bank_mask:0xf
v_cndmask_b32_dpp v125,v81,v83,vcc quad_perm:[0,1,0,1] row_mask:0xf bank_mask:0xf
s_waitcnt vmcnt(0)
v_mfma_f32_16x16x32_bf16 v[136:139],v[84:87],v[36:39],v[136:139]
v_max3_u32 v238,v84,v85,v238
v_max3_u32 v238,v86,v87,v238
v_cndmask_b32_dpp v126,v84,v86,vcc quad_perm:[0,1,0,1] row_mask:0xf bank_mask:0xf
v_cndmask_b32_dpp v127,v85,v87,vcc quad_perm:[0,1,0,1] row_mask:0xf bank_mask:0xf
v_cmp_eq_u32 vcc,-1,v238
s_cbranch_vccnz L_ac_130
s_branch L_acb_131
L_am_134:
v_subrev_u32 v248,s36,v1
v_and_b32 v248,0x80000003,v248
v_cmp_eq_u32 vcc,0,v248
v_lshlrev_b32 v248,2,v1
v_mov_b32 v249,0x40000000
v_cndmask_b32 v248,v249,v248,vcc
v_mov_b32 v249,3
s_or_b32 s59,s68,s46
s_mov_b32 s59,11018240
s_cmov_b32 s59,0x80000000
buffer_store_dword v249,v248,s[8:11],s59 offen sc1
s_branch L_ab_132
L_ap_138:
L_aw_150:
v_cmp_gt_u32 vcc,s66,v17
s_cbranch_vccz L_awd_151
buffer_load_dword v17,v16,s[8:11],s87 offen sc1
s_sub_u32 s49,s49,1
s_cbranch_scc1 L_abort
s_waitcnt vmcnt(0)
s_branch L_aw_150
L_awd_151:
s_branch L_apb_139
s_endpgm
L_rch_4:
s_waitcnt vmcnt(12)
v_swap_b32 v25,v28
v_swap_b32 v26,v32
v_swap_b32 v27,v36
v_swap_b32 v30,v33
v_swap_b32 v31,v37
v_swap_b32 v35,v38
ds_write_b128 v93,v[24:27] offset:0
ds_write_b128 v94,v[28:31] offset:0
ds_write_b128 v93,v[32:35] offset:128
ds_write_b128 v94,v[36:39] offset:128
s_waitcnt lgkmcnt(0)
s_mov_b32 s56,65536
buffer_load_dwordx4 v[24:27],v92,s[4:7],s56 offen offset:0
buffer_load_dwordx4 v[28:31],v92,s[4:7],s56 offen offset:1024
buffer_load_dwordx4 v[32:35],v92,s[4:7],s56 offen offset:2048
buffer_load_dwordx4 v[36:39],v92,s[4:7],s56 offen offset:3072
s_waitcnt vmcnt(12)
v_swap_b32 v41,v44
v_swap_b32 v42,v48
v_swap_b32 v43,v52
v_swap_b32 v46,v49
v_swap_b32 v47,v53
v_swap_b32 v51,v54
ds_write_b128 v93,v[40:43] offset:1024
ds_write_b128 v94,v[44:47] offset:1024
ds_write_b128 v93,v[48:51] offset:1152
ds_write_b128 v94,v[52:55] offset:1152
s_waitcnt lgkmcnt(0)
s_mov_b32 s56,81920
buffer_load_dwordx4 v[40:43],v92,s[4:7],s56 offen offset:0
buffer_load_dwordx4 v[44:47],v92,s[4:7],s56 offen offset:1024
buffer_load_dwordx4 v[48:51],v92,s[4:7],s56 offen offset:2048
buffer_load_dwordx4 v[52:55],v92,s[4:7],s56 offen offset:3072
s_waitcnt vmcnt(12)
v_swap_b32 v57,v60
v_swap_b32 v58,v64
v_swap_b32 v59,v68
v_swap_b32 v62,v65
v_swap_b32 v63,v69
v_swap_b32 v67,v70
ds_write_b128 v93,v[56:59] offset:2048
ds_write_b128 v94,v[60:63] offset:2048
ds_write_b128 v93,v[64:67] offset:2176
ds_write_b128 v94,v[68:71] offset:2176
s_waitcnt lgkmcnt(0)
s_mov_b32 s56,98304
buffer_load_dwordx4 v[56:59],v92,s[4:7],s56 offen offset:0
buffer_load_dwordx4 v[60:63],v92,s[4:7],s56 offen offset:1024
buffer_load_dwordx4 v[64:67],v92,s[4:7],s56 offen offset:2048
buffer_load_dwordx4 v[68:71],v92,s[4:7],s56 offen offset:3072
s_waitcnt vmcnt(12)
v_swap_b32 v73,v76
v_swap_b32 v74,v80
v_swap_b32 v75,v84
v_swap_b32 v78,v81
v_swap_b32 v79,v85
v_swap_b32 v83,v86
ds_write_b128 v93,v[72:75] offset:3072
ds_write_b128 v94,v[76:79] offset:3072
ds_write_b128 v93,v[80:83] offset:3200
ds_write_b128 v94,v[84:87] offset:3200
s_waitcnt lgkmcnt(0)
s_mov_b32 s56,114688
buffer_load_dwordx4 v[72:75],v92,s[4:7],s56 offen offset:0
buffer_load_dwordx4 v[76:79],v92,s[4:7],s56 offen offset:1024
buffer_load_dwordx4 v[80:83],v92,s[4:7],s56 offen offset:2048
buffer_load_dwordx4 v[84:87],v92,s[4:7],s56 offen offset:3072
s_cmp_eq_u32 s48,0
s_cbranch_scc1 L_rs_152
s_waitcnt vmcnt(12)
v_swap_b32 v25,v28
v_swap_b32 v26,v32
v_swap_b32 v27,v36
v_swap_b32 v30,v33
v_swap_b32 v31,v37
v_swap_b32 v35,v38
ds_write_b128 v93,v[24:27] offset:4096
ds_write_b128 v94,v[28:31] offset:4096
ds_write_b128 v93,v[32:35] offset:4224
ds_write_b128 v94,v[36:39] offset:4224
s_waitcnt vmcnt(8)
v_swap_b32 v41,v44
v_swap_b32 v42,v48
v_swap_b32 v43,v52
v_swap_b32 v46,v49
v_swap_b32 v47,v53
v_swap_b32 v51,v54
ds_write_b128 v93,v[40:43] offset:5120
ds_write_b128 v94,v[44:47] offset:5120
ds_write_b128 v93,v[48:51] offset:5248
ds_write_b128 v94,v[52:55] offset:5248
s_waitcnt vmcnt(4)
v_swap_b32 v57,v60
v_swap_b32 v58,v64
v_swap_b32 v59,v68
v_swap_b32 v62,v65
v_swap_b32 v63,v69
v_swap_b32 v67,v70
ds_write_b128 v93,v[56:59] offset:6144
ds_write_b128 v94,v[60:63] offset:6144
ds_write_b128 v93,v[64:67] offset:6272
ds_write_b128 v94,v[68:71] offset:6272
s_waitcnt vmcnt(0)
v_swap_b32 v73,v76
v_swap_b32 v74,v80
v_swap_b32 v75,v84
v_swap_b32 v78,v81
v_swap_b32 v79,v85
v_swap_b32 v83,v86
ds_write_b128 v93,v[72:75] offset:7168
ds_write_b128 v94,v[76:79] offset:7168
ds_write_b128 v93,v[80:83] offset:7296
ds_write_b128 v94,v[84:87] offset:7296
L_rs_152:
v_mov_b32 v123,159744
s_cmp_lg_u32 s46,0
s_cbranch_scc1 L_gbd_154
v_mov_b32 v124,240
s_buffer_load_dword s56,s[12:15],240
s_waitcnt lgkmcnt(0)
v_mov_b32 v125,s56
ds_write_b32 v123,v125
s_bitcmp1_b32 s56,8
s_cbranch_scc1 L_gbd_154
L_gb_153:
buffer_load_dword v125,v124,s[12:15],0 offen sc1
s_waitcnt vmcnt(0)
v_readfirstlane_b32 s56,v125
ds_write_b32 v123,v125
s_bitcmp1_b32 s56,8
s_cbranch_scc1 L_gbd_154
s_sleep 4
s_sub_u32 s49,s49,1
s_cmp_gt_i32 s49,0
s_cbranch_scc1 L_gb_153
s_branch L_abort
L_gbd_154:
s_waitcnt lgkmcnt(0)
s_barrier
ds_read_b32 v125,v123
s_waitcnt lgkmcnt(0)
v_readfirstlane_b32 s56,v125
s_barrier
s_lshr_b32 s56,s56,16
s_andn2_b32 s56,s56,s3
s_cbranch_scc1 L_spread
s_cmp_eq_u32 s48,0
s_cbranch_scc1 L_chd_155
v_and_b32 v120,15,v1
v_lshrrev_b32 v121,4,v1
v_mov_b32 v17,1
s_lshl_b32 s56,s46,2
v_add_u32 v125,s56,v121
v_xor_b32 v126,v125,v120
v_lshlrev_b32 v126,4,v126
v_lshl_add_u32 v20,v125,10,v126
s_lshl_b32 s56,s46,1
s_xor_b32 s56,s56,0
s_and_b32 s57,s56,3
s_lshl_b32 s57,s57,2
s_lshr_b32 s56,s56,2
s_lshl_b32 s56,s56,13
s_add_u32 s56,s56,131072
v_add_u32 v125,s57,v121
v_xor_b32 v125,v125,v120
v_lshlrev_b32 v125,4,v125
v_lshl_add_u32 v125,v120,8,v125
v_add_u32 v4,s56,v125
s_lshl_b32 s56,s46,1
s_xor_b32 s56,s56,1
s_and_b32 s57,s56,3
s_lshl_b32 s57,s57,2
s_lshr_b32 s56,s56,2
s_lshl_b32 s56,s56,13
s_add_u32 s56,s56,131072
v_add_u32 v125,s57,v121
v_xor_b32 v125,v125,v120
v_lshlrev_b32 v125,4,v125
v_lshl_add_u32 v125,v120,8,v125
v_add_u32 v5,s56,v125
s_lshl_b32 s56,s46,1
s_xor_b32 s56,s56,2
s_and_b32 s57,s56,3
s_lshl_b32 s57,s57,2
s_lshr_b32 s56,s56,2
s_lshl_b32 s56,s56,13
s_add_u32 s56,s56,131072
v_add_u32 v125,s57,v121
v_xor_b32 v125,v125,v120
v_lshlrev_b32 v125,4,v125
v_lshl_add_u32 v125,v120,8,v125
v_add_u32 v6,s56,v125
s_lshl_b32 s56,s46,1
s_xor_b32 s56,s56,3
s_and_b32 s57,s56,3
s_lshl_b32 s57,s57,2
s_lshr_b32 s56,s56,2
s_lshl_b32 s56,s56,13
s_add_u32 s56,s56,131072
v_add_u32 v125,s57,v121
v_xor_b32 v125,v125,v120
v_lshlrev_b32 v125,4,v125
v_lshl_add_u32 v125,v120,8,v125
v_add_u32 v7,s56,v125
s_lshl_b32 s56,s46,1
s_xor_b32 s56,s56,4
s_and_b32 s57,s56,3
s_lshl_b32 s57,s57,2
s_lshr_b32 s56,s56,2
s_lshl_b32 s56,s56,13
s_add_u32 s56,s56,131072
v_add_u32 v125,s57,v121
v_xor_b32 v125,v125,v120
v_lshlrev_b32 v125,4,v125
v_lshl_add_u32 v125,v120,8,v125
v_add_u32 v8,s56,v125
s_lshl_b32 s56,s46,1
s_xor_b32 s56,s56,5
s_and_b32 s57,s56,3
s_lshl_b32 s57,s57,2
s_lshr_b32 s56,s56,2
s_lshl_b32 s56,s56,13
s_add_u32 s56,s56,131072
v_add_u32 v125,s57,v121
v_xor_b32 v125,v125,v120
v_lshlrev_b32 v125,4,v125
v_lshl_add_u32 v125,v120,8,v125
v_add_u32 v9,s56,v125
s_lshl_b32 s56,s46,1
s_xor_b32 s56,s56,6
s_and_b32 s57,s56,3
s_lshl_b32 s57,s57,2
s_lshr_b32 s56,s56,2
s_lshl_b32 s56,s56,13
s_add_u32 s56,s56,131072
v_add_u32 v125,s57,v121
v_xor_b32 v125,v125,v120
v_lshlrev_b32 v125,4,v125
v_lshl_add_u32 v125,v120,8,v125
v_add_u32 v10,s56,v125
s_lshl_b32 s56,s46,1
s_xor_b32 s56,s56,7
s_and_b32 s57,s56,3
s_lshl_b32 s57,s57,2
s_lshr_b32 s56,s56,2
s_lshl_b32 s56,s56,13
s_add_u32 s56,s56,131072
v_add_u32 v125,s57,v121
v_xor_b32 v125,v125,v120
v_lshlrev_b32 v125,4,v125
v_lshl_add_u32 v125,v120,8,v125
v_add_u32 v11,s56,v125
s_cmp_eq_u32 s48,1
s_cselect_b32 s51,14,17
s_cselect_b32 s53,3,5
s_mov_b32 s72,0x80000000
s_lshl_b32 s70,s51,15
s_add_u32 s70,s70,0
s_add_u32 s71,s70,16384
s_add_u32 m0,s50,131072
s_nop 0
buffer_load_dwordx4 v20,s[8:11],s70 offen offset:0 sc1 lds
s_add_u32 m0,s50,135168
s_nop 0
buffer_load_dwordx4 v20,s[8:11],s71 offen offset:0 sc1 lds
s_add_u32 m0,s50,139008
s_nop 0
buffer_load_dwordx4 v20,s[8:11],s70 offen offset:256 sc1 lds
s_add_u32 m0,s50,143104
s_nop 0
buffer_load_dwordx4 v20,s[8:11],s71 offen offset:256 sc1 lds
s_waitcnt vmcnt(0)
L_chl_156:
s_mov_b64 s[68:69],s[70:71]
s_add_u32 s70,s70,32768
s_add_u32 s71,s71,32768
s_lshl_b32 s58,s51,5
s_add_u32 s58,s58,s47
s_mul_i32 s58,s58,24576
s_add_u32 s58,s58,100663296
s_add_u32 s61,s58,s50
s_add_u32 s62,s61,4096
s_add_u32 s63,s61,16384
s_add_u32 s64,s61,20480
s_add_u32 s65,s61,s50
s_add_u32 s65,s65,8192
s_waitcnt vmcnt(7)
s_barrier
ds_read_b128 v[72:75],v4 offset:0
ds_read_b128 v[76:79],v4 offset:4096
ds_read_b128 v[80:83],v5 offset:0
ds_read_b128 v[84:87],v5 offset:4096
s_add_u32 m0,s50,146944
s_nop 0
buffer_load_dwordx4 v20,s[8:11],s68 offen offset:512 sc1 lds
s_add_u32 m0,s50,151040
s_nop 0
buffer_load_dwordx4 v20,s[8:11],s69 offen offset:512 sc1 lds
s_add_u32 m0,s50,154880
s_nop 0
buffer_load_dwordx4 v20,s[8:11],s68 offen offset:768 sc1 lds
s_add_u32 m0,s50,158976
s_nop 0
buffer_load_dwordx4 v20,s[8:11],s69 offen offset:768 sc1 lds
s_waitcnt lgkmcnt(2)
v_mfma_f32_16x16x32_bf16 v[40:43],a[128:131],v[72:75],0
ds_read_b128 v[108:111],v6 offset:0
v_mfma_f32_16x16x32_bf16 v[56:59],v[72:75],v[128:131],0
v_mfma_f32_16x16x32_bf16 v[24:27],a[0:3],v[72:75],0
ds_read_b128 v[112:115],v6 offset:4096
v_mfma_f32_16x16x32_bf16 v[44:47],a[128:131],v[76:79],0
v_mfma_f32_16x16x32_bf16 v[60:63],v[76:79],v[128:131],0
v_mfma_f32_16x16x32_bf16 v[28:31],a[0:3],v[76:79],0
v_mfma_f32_16x16x32_bf16 v[48:51],a[136:139],v[72:75],0
v_mfma_f32_16x16x32_bf16 v[64:67],v[72:75],v[136:139],0
v_mfma_f32_16x16x32_bf16 v[32:35],a[8:11],v[72:75],0
v_mfma_f32_16x16x32_bf16 v[52:55],a[136:139],v[76:79],0
v_mfma_f32_16x16x32_bf16 v[68:71],v[76:79],v[136:139],0
v_mfma_f32_16x16x32_bf16 v[36:39],a[8:11],v[76:79],0
s_waitcnt lgkmcnt(2)
v_mfma_f32_16x16x32_bf16 v[40:43],a[132:135],v[80:83],v[40:43]
ds_read_b128 v[72:75],v7 offset:0
v_mfma_f32_16x16x32_bf16 v[56:59],v[80:83],v[132:135],v[56:59]
v_mfma_f32_16x16x32_bf16 v[24:27],a[4:7],v[80:83],v[24:27]
ds_read_b128 v[76:79],v7 offset:4096
v_mfma_f32_16x16x32_bf16 v[44:47],a[132:135],v[84:87],v[44:47]
v_mfma_f32_16x16x32_bf16 v[60:63],v[84:87],v[132:135],v[60:63]
v_mfma_f32_16x16x32_bf16 v[28:31],a[4:7],v[84:87],v[28:31]
v_mfma_f32_16x16x32_bf16 v[48:51],a[140:143],v[80:83],v[48:51]
v_mfma_f32_16x16x32_bf16 v[64:67],v[80:83],v[140:143],v[64:67]
v_mfma_f32_16x16x32_bf16 v[32:35],a[12:15],v[80:83],v[32:35]
v_mfma_f32_16x16x32_bf16 v[52:55],a[140:143],v[84:87],v[52:55]
v_mfma_f32_16x16x32_bf16 v[68:71],v[84:87],v[140:143],v[68:71]
v_mfma_f32_16x16x32_bf16 v[36:39],a[12:15],v[84:87],v[36:39]
s_waitcnt lgkmcnt(2)
v_mfma_f32_16x16x32_bf16 v[40:43],a[144:147],v[108:111],v[40:43]
ds_read_b128 v[80:83],v8 offset:0
v_mfma_f32_16x16x32_bf16 v[56:59],v[108:111],v[144:147],v[56:59]
v_mfma_f32_16x16x32_bf16 v[24:27],a[16:19],v[108:111],v[24:27]
ds_read_b128 v[84:87],v8 offset:4096
v_mfma_f32_16x16x32_bf16 v[44:47],a[144:147],v[112:115],v[44:47]
v_mfma_f32_16x16x32_bf16 v[60:63],v[112:115],v[144:147],v[60:63]
v_mfma_f32_16x16x32_bf16 v[28:31],a[16:19],v[112:115],v[28:31]
v_mfma_f32_16x16x32_bf16 v[48:51],a[152:155],v[108:111],v[48:51]
v_mfma_f32_16x16x32_bf16 v[64:67],v[108:111],v[152:155],v[64:67]
v_mfma_f32_16x16x32_bf16 v[32:35],a[24:27],v[108:111],v[32:35]
v_mfma_f32_16x16x32_bf16 v[52:55],a[152:155],v[112:115],v[52:55]
v_mfma_f32_16x16x32_bf16 v[68:71],v[112:115],v[152:155],v[68:71]
v_mfma_f32_16x16x32_bf16 v[36:39],a[24:27],v[112:115],v[36:39]
s_waitcnt lgkmcnt(2)
v_mfma_f32_16x16x32_bf16 v[40:43],a[148:151],v[72:75],v[40:43]
ds_read_b128 v[108:111],v9 offset:0
v_mfma_f32_16x16x32_bf16 v[56:59],v[72:75],v[148:151],v[56:59]
v_mfma_f32_16x16x32_bf16 v[24:27],a[20:23],v[72:75],v[24:27]
ds_read_b128 v[112:115],v9 offset:4096
v_mfma_f32_16x16x32_bf16 v[44:47],a[148:151],v[76:79],v[44:47]
v_mfma_f32_16x16x32_bf16 v[60:63],v[76:79],v[148:151],v[60:63]
v_mfma_f32_16x16x32_bf16 v[28:31],a[20:23],v[76:79],v[28:31]
v_mfma_f32_16x16x32_bf16 v[48:51],a[156:159],v[72:75],v[48:51]
v_mfma_f32_16x16x32_bf16 v[64:67],v[72:75],v[156:159],v[64:67]
v_mfma_f32_16x16x32_bf16 v[32:35],a[28:31],v[72:75],v[32:35]
v_mfma_f32_16x16x32_bf16 v[52:55],a[156:159],v[76:79],v[52:55]
v_mfma_f32_16x16x32_bf16 v[68:71],v[76:79],v[156:159],v[68:71]
v_mfma_f32_16x16x32_bf16 v[36:39],a[28:31],v[76:79],v[36:39]
s_waitcnt lgkmcnt(2)
v_mfma_f32_16x16x32_bf16 v[40:43],a[160:163],v[80:83],v[40:43]
ds_read_b128 v[72:75],v10 offset:0
v_mfma_f32_16x16x32_bf16 v[56:59],v[80:83],v[160:163],v[56:59]
v_mfma_f32_16x16x32_bf16 v[24:27],a[32:35],v[80:83],v[24:27]
ds_read_b128 v[76:79],v10 offset:4096
v_mfma_f32_16x16x32_bf16 v[44:47],a[160:163],v[84:87],v[44:47]
v_mfma_f32_16x16x32_bf16 v[60:63],v[84:87],v[160:163],v[60:63]
v_mfma_f32_16x16x32_bf16 v[28:31],a[32:35],v[84:87],v[28:31]
v_mfma_f32_16x16x32_bf16 v[48:51],a[168:171],v[80:83],v[48:51]
v_mfma_f32_16x16x32_bf16 v[64:67],v[80:83],v[168:171],v[64:67]
v_mfma_f32_16x16x32_bf16 v[32:35],a[40:43],v[80:83],v[32:35]
v_mfma_f32_16x16x32_bf16 v[52:55],a[168:171],v[84:87],v[52:55]
v_mfma_f32_16x16x32_bf16 v[68:71],v[84:87],v[168:171],v[68:71]
v_mfma_f32_16x16x32_bf16 v[36:39],a[40:43],v[84:87],v[36:39]
s_waitcnt lgkmcnt(2)
v_mfma_f32_16x16x32_bf16 v[40:43],a[164:167],v[108:111],v[40:43]
ds_read_b128 v[80:83],v11 offset:0
v_mfma_f32_16x16x32_bf16 v[56:59],v[108:111],v[164:167],v[56:59]
v_mfma_f32_16x16x32_bf16 v[24:27],a[36:39],v[108:111],v[24:27]
ds_read_b128 v[84:87],v11 offset:4096
v_mfma_f32_16x16x32_bf16 v[44:47],a[164:167],v[112:115],v[44:47]
v_mfma_f32_16x16x32_bf16 v[60:63],v[112:115],v[164:167],v[60:63]
v_mfma_f32_16x16x32_bf16 v[28:31],a[36:39],v[112:115],v[28:31]
v_mfma_f32_16x16x32_bf16 v[48:51],a[172:175],v[108:111],v[48:51]
v_mfma_f32_16x16x32_bf16 v[64:67],v[108:111],v[172:175],v[64:67]
v_mfma_f32_16x16x32_bf16 v[32:35],a[44:47],v[108:111],v[32:35]
v_mfma_f32_16x16x32_bf16 v[52:55],a[172:175],v[112:115],v[52:55]
v_mfma_f32_16x16x32_bf16 v[68:71],v[112:115],v[172:175],v[68:71]
v_mfma_f32_16x16x32_bf16 v[36:39],a[44:47],v[112:115],v[36:39]
s_waitcnt vmcnt(0)
s_barrier
s_or_b32 s72,s72,s52
buffer_store_dword v17,off,s[8:11],s72 sc1
s_waitcnt lgkmcnt(2)
v_mfma_f32_16x16x32_bf16 v[40:43],a[176:179],v[72:75],v[40:43]
ds_read_b128 v[108:111],v4 offset:16384
v_mfma_f32_16x16x32_bf16 v[56:59],v[72:75],v[176:179],v[56:59]
v_mfma_f32_16x16x32_bf16 v[24:27],a[48:51],v[72:75],v[24:27]
ds_read_b128 v[112:115],v4 offset:20480
v_mfma_f32_16x16x32_bf16 v[44:47],a[176:179],v[76:79],v[44:47]
v_mfma_f32_16x16x32_bf16 v[60:63],v[76:79],v[176:179],v[60:63]
v_mfma_f32_16x16x32_bf16 v[28:31],a[48:51],v[76:79],v[28:31]
v_mfma_f32_16x16x32_bf16 v[48:51],a[184:187],v[72:75],v[48:51]
v_mfma_f32_16x16x32_bf16 v[64:67],v[72:75],v[184:187],v[64:67]
v_mfma_f32_16x16x32_bf16 v[32:35],a[56:59],v[72:75],v[32:35]
v_mfma_f32_16x16x32_bf16 v[52:55],a[184:187],v[76:79],v[52:55]
v_mfma_f32_16x16x32_bf16 v[68:71],v[76:79],v[184:187],v[68:71]
v_mfma_f32_16x16x32_bf16 v[36:39],a[56:59],v[76:79],v[36:39]
s_waitcnt lgkmcnt(2)
v_mfma_f32_16x16x32_bf16 v[40:43],a[180:183],v[80:83],v[40:43]
ds_read_b128 v[72:75],v5 offset:16384
v_mfma_f32_16x16x32_bf16 v[56:59],v[80:83],v[180:183],v[56:59]
v_mfma_f32_16x16x32_bf16 v[24:27],a[52:55],v[80:83],v[24:27]
ds_read_b128 v[76:79],v5 offset:20480
v_mfma_f32_16x16x32_bf16 v[44:47],a[180:183],v[84:87],v[44:47]
v_mfma_f32_16x16x32_bf16 v[60:63],v[84:87],v[180:183],v[60:63]
v_mfma_f32_16x16x32_bf16 v[28:31],a[52:55],v[84:87],v[28:31]
v_mfma_f32_16x16x32_bf16 v[48:51],a[188:191],v[80:83],v[48:51]
v_mfma_f32_16x16x32_bf16 v[64:67],v[80:83],v[188:191],v[64:67]
v_mfma_f32_16x16x32_bf16 v[32:35],a[60:63],v[80:83],v[32:35]
v_mfma_f32_16x16x32_bf16 v[52:55],a[188:191],v[84:87],v[52:55]
v_mfma_f32_16x16x32_bf16 v[68:71],v[84:87],v[188:191],v[68:71]
v_mfma_f32_16x16x32_bf16 v[36:39],a[60:63],v[84:87],v[36:39]
s_waitcnt lgkmcnt(2)
v_mfma_f32_16x16x32_bf16 v[40:43],a[192:195],v[108:111],v[40:43]
ds_read_b128 v[80:83],v6 offset:16384
v_mfma_f32_16x16x32_bf16 v[56:59],v[108:111],v[192:195],v[56:59]
v_mfma_f32_16x16x32_bf16 v[24:27],a[64:67],v[108:111],v[24:27]
ds_read_b128 v[84:87],v6 offset:20480
v_mfma_f32_16x16x32_bf16 v[44:47],a[192:195],v[112:115],v[44:47]
v_mfma_f32_16x16x32_bf16 v[60:63],v[112:115],v[192:195],v[60:63]
v_mfma_f32_16x16x32_bf16 v[28:31],a[64:67],v[112:115],v[28:31]
v_mfma_f32_16x16x32_bf16 v[48:51],a[200:203],v[108:111],v[48:51]
v_mfma_f32_16x16x32_bf16 v[64:67],v[108:111],v[200:203],v[64:67]
v_mfma_f32_16x16x32_bf16 v[32:35],a[72:75],v[108:111],v[32:35]
v_mfma_f32_16x16x32_bf16 v[52:55],a[200:203],v[112:115],v[52:55]
v_mfma_f32_16x16x32_bf16 v[68:71],v[112:115],v[200:203],v[68:71]
v_mfma_f32_16x16x32_bf16 v[36:39],a[72:75],v[112:115],v[36:39]
s_waitcnt lgkmcnt(2)
v_mfma_f32_16x16x32_bf16 v[40:43],a[196:199],v[72:75],v[40:43]
ds_read_b128 v[108:111],v7 offset:16384
v_mfma_f32_16x16x32_bf16 v[56:59],v[72:75],v[196:199],v[56:59]
v_mfma_f32_16x16x32_bf16 v[24:27],a[68:71],v[72:75],v[24:27]
ds_read_b128 v[112:115],v7 offset:20480
v_mfma_f32_16x16x32_bf16 v[44:47],a[196:199],v[76:79],v[44:47]
v_mfma_f32_16x16x32_bf16 v[60:63],v[76:79],v[196:199],v[60:63]
v_mfma_f32_16x16x32_bf16 v[28:31],a[68:71],v[76:79],v[28:31]
v_mfma_f32_16x16x32_bf16 v[48:51],a[204:207],v[72:75],v[48:51]
v_mfma_f32_16x16x32_bf16 v[64:67],v[72:75],v[204:207],v[64:67]
v_mfma_f32_16x16x32_bf16 v[32:35],a[76:79],v[72:75],v[32:35]
v_mfma_f32_16x16x32_bf16 v[52:55],a[204:207],v[76:79],v[52:55]
v_mfma_f32_16x16x32_bf16 v[68:71],v[76:79],v[204:207],v[68:71]
v_mfma_f32_16x16x32_bf16 v[36:39],a[76:79],v[76:79],v[36:39]
s_waitcnt lgkmcnt(2)
v_mfma_f32_16x16x32_bf16 v[40:43],a[208:211],v[80:83],v[40:43]
ds_read_b128 v[72:75],v8 offset:16384
v_mfma_f32_16x16x32_bf16 v[56:59],v[80:83],v[208:211],v[56:59]
v_mfma_f32_16x16x32_bf16 v[24:27],a[80:83],v[80:83],v[24:27]
ds_read_b128 v[76:79],v8 offset:20480
v_mfma_f32_16x16x32_bf16 v[44:47],a[208:211],v[84:87],v[44:47]
v_mfma_f32_16x16x32_bf16 v[60:63],v[84:87],v[208:211],v[60:63]
v_mfma_f32_16x16x32_bf16 v[28:31],a[80:83],v[84:87],v[28:31]
v_mfma_f32_16x16x32_bf16 v[48:51],a[216:219],v[80:83],v[48:51]
v_mfma_f32_16x16x32_bf16 v[64:67],v[80:83],v[216:219],v[64:67]
v_mfma_f32_16x16x32_bf16 v[32:35],a[88:91],v[80:83],v[32:35]
v_mfma_f32_16x16x32_bf16 v[52:55],a[216:219],v[84:87],v[52:55]
v_mfma_f32_16x16x32_bf16 v[68:71],v[84:87],v[216:219],v[68:71]
v_mfma_f32_16x16x32_bf16 v[36:39],a[88:91],v[84:87],v[36:39]
s_waitcnt lgkmcnt(2)
v_mfma_f32_16x16x32_bf16 v[40:43],a[212:215],v[108:111],v[40:43]
ds_read_b128 v[80:83],v9 offset:16384
v_mfma_f32_16x16x32_bf16 v[56:59],v[108:111],v[212:215],v[56:59]
v_mfma_f32_16x16x32_bf16 v[24:27],a[84:87],v[108:111],v[24:27]
ds_read_b128 v[84:87],v9 offset:20480
v_mfma_f32_16x16x32_bf16 v[44:47],a[212:215],v[112:115],v[44:47]
v_mfma_f32_16x16x32_bf16 v[60:63],v[112:115],v[212:215],v[60:63]
v_mfma_f32_16x16x32_bf16 v[28:31],a[84:87],v[112:115],v[28:31]
v_mfma_f32_16x16x32_bf16 v[48:51],a[220:223],v[108:111],v[48:51]
v_mfma_f32_16x16x32_bf16 v[64:67],v[108:111],v[220:223],v[64:67]
v_mfma_f32_16x16x32_bf16 v[32:35],a[92:95],v[108:111],v[32:35]
v_mfma_f32_16x16x32_bf16 v[52:55],a[220:223],v[112:115],v[52:55]
v_mfma_f32_16x16x32_bf16 v[68:71],v[112:115],v[220:223],v[68:71]
v_mfma_f32_16x16x32_bf16 v[36:39],a[92:95],v[112:115],v[36:39]
s_barrier
s_waitcnt lgkmcnt(2)
v_mfma_f32_16x16x32_bf16 v[40:43],a[224:227],v[72:75],v[40:43]
ds_read_b128 v[108:111],v10 offset:16384
v_mfma_f32_16x16x32_bf16 v[56:59],v[72:75],v[224:227],v[56:59]
s_add_u32 m0,s50,131072
v_mfma_f32_16x16x32_bf16 v[24:27],a[96:99],v[72:75],v[24:27]
ds_read_b128 v[112:115],v10 offset:20480
v_mfma_f32_16x16x32_bf16 v[44:47],a[224:227],v[76:79],v[44:47]
buffer_load_dwordx4 v20,s[8:11],s70 offen offset:0 sc1 lds
v_mfma_f32_16x16x32_bf16 v[60:63],v[76:79],v[224:227],v[60:63]
s_add_u32 m0,s50,135168
v_mfma_f32_16x16x32_bf16 v[28:31],a[96:99],v[76:79],v[28:31]
buffer_load_dwordx4 v20,s[8:11],s71 offen offset:0 sc1 lds
v_mfma_f32_16x16x32_bf16 v[48:51],a[232:235],v[72:75],v[48:51]
s_add_u32 m0,s50,139008
v_mfma_f32_16x16x32_bf16 v[64:67],v[72:75],v[232:235],v[64:67]
buffer_load_dwordx4 v20,s[8:11],s70 offen offset:256 sc1 lds
v_mfma_f32_16x16x32_bf16 v[32:35],a[104:107],v[72:75],v[32:35]
s_add_u32 m0,s50,143104
v_mfma_f32_16x16x32_bf16 v[52:55],a[232:235],v[76:79],v[52:55]
buffer_load_dwordx4 v20,s[8:11],s71 offen offset:256 sc1 lds
v_mfma_f32_16x16x32_bf16 v[68:71],v[76:79],v[232:235],v[68:71]
v_mfma_f32_16x16x32_bf16 v[36:39],a[104:107],v[76:79],v[36:39]
s_waitcnt lgkmcnt(2)
v_mfma_f32_16x16x32_bf16 v[40:43],a[228:231],v[80:83],v[40:43]
ds_read_b128 v[72:75],v11 offset:16384
v_mfma_f32_16x16x32_bf16 v[56:59],v[80:83],v[228:231],v[56:59]
v_mfma_f32_16x16x32_bf16 v[24:27],a[100:103],v[80:83],v[24:27]
ds_read_b128 v[76:79],v11 offset:20480
v_mfma_f32_16x16x32_bf16 v[44:47],a[228:231],v[84:87],v[44:47]
v_mfma_f32_16x16x32_bf16 v[60:63],v[84:87],v[228:231],v[60:63]
v_mfma_f32_16x16x32_bf16 v[28:31],a[100:103],v[84:87],v[28:31]
v_mfma_f32_16x16x32_bf16 v[48:51],a[236:239],v[80:83],v[48:51]
v_mfma_f32_16x16x32_bf16 v[64:67],v[80:83],v[236:239],v[64:67]
v_mfma_f32_16x16x32_bf16 v[32:35],a[108:111],v[80:83],v[32:35]
v_mfma_f32_16x16x32_bf16 v[52:55],a[236:239],v[84:87],v[52:55]
v_mfma_f32_16x16x32_bf16 v[68:71],v[84:87],v[236:239],v[68:71]
v_mfma_f32_16x16x32_bf16 v[36:39],a[108:111],v[84:87],v[36:39]
s_waitcnt lgkmcnt(2)
v_mfma_f32_16x16x32_bf16 v[40:43],a[240:243],v[108:111],v[40:43]
v_mfma_f32_16x16x32_bf16 v[56:59],v[108:111],v[240:243],v[56:59]
v_mfma_f32_16x16x32_bf16 v[24:27],a[112:115],v[108:111],v[24:27]
v_mfma_f32_16x16x32_bf16 v[44:47],a[240:243],v[112:115],v[44:47]
v_mfma_f32_16x16x32_bf16 v[60:63],v[112:115],v[240:243],v[60:63]
v_mfma_f32_16x16x32_bf16 v[28:31],a[112:115],v[112:115],v[28:31]
v_mfma_f32_16x16x32_bf16 v[48:51],a[248:251],v[108:111],v[48:51]
v_mfma_f32_16x16x32_bf16 v[64:67],v[108:111],v[248:251],v[64:67]
v_mfma_f32_16x16x32_bf16 v[32:35],a[120:123],v[108:111],v[32:35]
v_mfma_f32_16x16x32_bf16 v[52:55],a[248:251],v[112:115],v[52:55]
v_mfma_f32_16x16x32_bf16 v[68:71],v[112:115],v[248:251],v[68:71]
v_mfma_f32_16x16x32_bf16 v[36:39],a[120:123],v[112:115],v[36:39]
s_waitcnt lgkmcnt(0)
v_mfma_f32_16x16x32_bf16 v[40:43],a[244:247],v[72:75],v[40:43]
v_mfma_f32_16x16x32_bf16 v[56:59],v[72:75],v[244:247],v[56:59]
v_mfma_f32_16x16x32_bf16 v[24:27],a[116:119],v[72:75],v[24:27]
v_mfma_f32_16x16x32_bf16 v[44:47],a[244:247],v[76:79],v[44:47]
v_mfma_f32_16x16x32_bf16 v[60:63],v[76:79],v[244:247],v[60:63]
v_mfma_f32_16x16x32_bf16 v[28:31],a[116:119],v[76:79],v[28:31]
v_mfma_f32_16x16x32_bf16 v[48:51],a[252:255],v[72:75],v[48:51]
v_mfma_f32_16x16x32_bf16 v[64:67],v[72:75],v[252:255],v[64:67]
v_mfma_f32_16x16x32_bf16 v[32:35],a[124:127],v[72:75],v[32:35]
v_mfma_f32_16x16x32_bf16 v[52:55],a[252:255],v[76:79],v[52:55]
v_mfma_f32_16x16x32_bf16 v[68:71],v[76:79],v[252:255],v[68:71]
v_mfma_f32_16x16x32_bf16 v[36:39],a[124:127],v[76:79],v[36:39]
s_lshl_b32 s56,s51,5
s_add_u32 s56,s56,s47
s_lshl_b32 s56,s56,12
s_add_u32 s56,s56,s50
s_add_u32 s56,s56,41943040
v_mov_b64 v[120:121],-1
v_mov_b64 v[122:123],-1
buffer_store_dwordx4 v[120:123],v0,s[8:11],s56 offen sc1
v_cvt_pk_bf16_f32 v72,v40,v48
v_cvt_pk_bf16_f32 v73,v41,v49
v_cvt_pk_bf16_f32 v74,v42,v50
v_cvt_pk_bf16_f32 v75,v43,v51
buffer_store_dwordx4 v[72:75],v0,s[8:11],s61 offen sc1
v_cvt_pk_bf16_f32 v76,v44,v52
v_cvt_pk_bf16_f32 v77,v45,v53
v_cvt_pk_bf16_f32 v78,v46,v54
v_cvt_pk_bf16_f32 v79,v47,v55
buffer_store_dwordx4 v[76:79],v0,s[8:11],s62 offen sc1
v_cvt_pk_bf16_f32 v80,v56,v57
v_cvt_pk_bf16_f32 v81,v58,v59
v_cvt_pk_bf16_f32 v82,v60,v61
v_cvt_pk_bf16_f32 v83,v62,v63
buffer_store_dwordx4 v[80:83],v0,s[8:11],s65 offen offset:0 sc1
v_cvt_pk_bf16_f32 v84,v64,v65
v_cvt_pk_bf16_f32 v85,v66,v67
v_cvt_pk_bf16_f32 v86,v68,v69
v_cvt_pk_bf16_f32 v87,v70,v71
buffer_store_dwordx4 v[84:87],v0,s[8:11],s65 offen offset:1024 sc1
v_cvt_pk_bf16_f32 v108,v24,v32
v_cvt_pk_bf16_f32 v109,v25,v33
v_cvt_pk_bf16_f32 v110,v26,v34
v_cvt_pk_bf16_f32 v111,v27,v35
buffer_store_dwordx4 v[108:111],v0,s[8:11],s63 offen sc1
v_cvt_pk_bf16_f32 v112,v28,v36
v_cvt_pk_bf16_f32 v113,v29,v37
v_cvt_pk_bf16_f32 v114,v30,v38
v_cvt_pk_bf16_f32 v115,v31,v39
buffer_store_dwordx4 v[112:115],v0,s[8:11],s64 offen sc1
s_lshl_b32 s72,s51,13
s_lshl2_add_u32 s72,s47,s72
s_add_u32 s72,s72,10485760
s_add_u32 s51,s51,1
s_sub_u32 s53,s53,1
s_cmp_gt_u32 s53,0
s_cbranch_scc1 L_chl_156
s_waitcnt vmcnt(0)
s_barrier
s_or_b32 s72,s72,s52
buffer_store_dword v17,off,s[8:11],s72 sc1
L_chd_155:
s_cmp_lg_u32 s3,0
s_cbranch_scc1 L_wc
s_cmp_eq_u32 s48,1
s_cbranch_scc1 L_rc1_157
s_cmp_eq_u32 s48,2
s_cbranch_scc1 L_rc2_158
v_and_b32 v120,15,v1
v_lshrrev_b32 v121,4,v1
v_and_b32 v122,2,v1
v_cmp_eq_u32 vcc,0,v122
v_mov_b32 v2,0xeeee
v_mov_b32 v123,0x4444
v_cndmask_b32 v2,v2,v123,vcc
v_and_b32 v122,1,v1
v_cmp_eq_u32 vcc,0,v122
v_mov_b32 v3,0xdddd
v_mov_b32 v123,0x8888
v_cndmask_b32 v3,v3,v123,vcc
v_lshrrev_b32 v122,1,v120
v_bfe_u32 v123,v120,2,1
v_xor_b32 v123,v123,v122
v_lshlrev_b32 v4,7,v123
v_and_b32 v123,1,v120
v_lshl_add_u32 v4,v123,6,v4
v_xor_b32 v123,v121,v122
v_and_b32 v123,3,v123
v_lshl_add_u32 v4,v123,4,v4
s_lshl_b32 s56,s46,10
s_add_u32 s56,s56,147456
v_add_u32 v4,s56,v4
v_lshlrev_b32 v122,1,v121
v_add_u32 v122,0,v122
v_and_b32 v123,1,v121
v_xor_b32 v123,v123,v122
v_lshlrev_b32 v5,7,v123
v_bfe_u32 v123,v120,3,1
v_lshl_add_u32 v5,v123,6,v5
v_xor_b32 v123,v120,v122
v_and_b32 v123,3,v123
v_lshl_add_u32 v5,v123,4,v5
v_bfe_u32 v123,v120,2,1
v_lshl_add_u32 v5,v123,3,v5
v_add_u32 v5,147456,v5
v_lshlrev_b32 v122,1,v121
v_add_u32 v122,1,v122
v_and_b32 v123,1,v121
v_xor_b32 v123,v123,v122
v_lshlrev_b32 v6,7,v123
v_bfe_u32 v123,v120,3,1
v_lshl_add_u32 v6,v123,6,v6
v_xor_b32 v123,v120,v122
v_and_b32 v123,3,v123
v_lshl_add_u32 v6,v123,4,v6
v_bfe_u32 v123,v120,2,1
v_lshl_add_u32 v6,v123,3,v6
v_add_u32 v6,147456,v6
v_lshlrev_b32 v7,7,v121
v_lshrrev_b32 v122,1,v120
v_lshl_add_u32 v8,v122,4,v7
v_add_u32 v8,151552,v8
v_lshrrev_b32 v122,2,v120
v_lshl_add_u32 v7,v122,5,v7
v_and_b32 v122,1,v120
v_lshl_add_u32 v7,v122,4,v7
v_and_b32 v122,2,v120
v_cmp_eq_u32 vcc,0,v122
s_lshl_b32 s56,s46,9
v_mov_b32 v122,2048
v_mov_b32 v123,s56
v_cndmask_b32 v122,v122,v123,vcc
v_add_u32 v7,v122,v7
v_add_u32 v7,151552,v7
v_lshrrev_b32 v122,3,v1
v_lshlrev_b32 v9,11,v122
v_and_b32 v122,7,v1
v_lshl_add_u32 v9,v122,3,v9
s_lshl_b32 s56,s46,14
s_lshl_b32 s57,s47,6
s_add_u32 s56,s56,s57
v_add_u32 v9,s56,v9
s_lshl_b32 s71,s46,5
s_add_u32 s71,s71,s47
s_bfe_u32 s56,s71,0x10003
s_lshl_b32 s56,s56,11
s_and_b32 s57,s71,1
s_lshl_b32 s57,s57,10
s_add_u32 s56,s56,s57
s_bfe_u32 s57,s71,0x10002
s_lshl_b32 s57,s57,9
s_add_u32 s56,s56,s57
s_bfe_u32 s57,s71,0x10001
s_lshl_b32 s57,s57,6
s_add_u32 s56,s56,s57
s_bfe_u32 s57,s71,0x10004
s_lshl_b32 s57,s57,8
s_add_u32 s56,s56,s57
s_bfe_u32 s57,s71,0x10005
s_lshl_b32 s57,s57,7
s_add_u32 s56,s56,s57
s_bfe_u32 s57,s71,0x10006
s_lshl_b32 s57,s57,12
s_add_u32 s56,s56,s57
v_and_b32 v122,3,v120
v_lshlrev_b32 v10,2,v122
v_bfe_u32 v122,v120,3,1
v_lshl_add_u32 v10,v122,4,v10
v_and_b32 v122,1,v121
v_lshl_add_u32 v10,v122,5,v10
v_add_u32 v10,s56,v10
v_and_b32 v123,36,v1
v_mov_b32 v122,0x80000000
v_cmp_eq_u32 vcc,0,v123
s_nop 1
v_cndmask_b32 v10,v122,v10,vcc
s_lshl_b32 s71,s71,11
s_lshl_b32 s73,s46,11
s_mov_b32 s72,0xffc00000
s_mov_b32 s74,0
v_and_b32 v11,1,v121
v_xor_b32 v11,v11,v120
v_and_b32 v11,3,v11
v_lshrrev_b32 v122,2,v120
v_lshl_add_u32 v11,v11,2,v122
v_lshl_add_u32 v11,v121,4,v11
v_lshlrev_b32 v11,4,v11
s_lshl_b32 s56,s46,15
v_add_u32 v11,s56,v11
v_lshrrev_b32 v13,3,v1
v_lshlrev_b32 v13,9,v13
v_and_b32 v122,7,v1
v_lshl_add_u32 v13,v122,4,v13
v_and_b32 v122,15,v1
v_and_b32 v123,1,v1
v_lshlrev_b32 v123,4,v123
v_mov_b32 v124,0x3f80
v_lshlrev_b32 v124,v123,v124
v_lshrrev_b32 v122,1,v122
v_cmp_eq_u32 vcc,0,v122
s_nop 1
v_cndmask_b32 v18,0,v124,vcc
v_cmp_eq_u32 vcc,1,v122
s_nop 1
v_cndmask_b32 v19,0,v124,vcc
v_cmp_eq_u32 vcc,2,v122
s_nop 1
v_cndmask_b32 v20,0,v124,vcc
v_cmp_eq_u32 vcc,3,v122
s_nop 1
v_cndmask_b32 v21,0,v124,vcc
s_and_b32 s56,s46,1
s_lshl_b32 s56,s56,8
s_and_b32 s57,s46,2
s_lshl_b32 s57,s57,6
s_add_u32 s56,s56,s57
v_add_u32 v13,s56,v13
s_add_u32 s56,s50,155648
v_add_u32 v12,s56,v0
v_mov_b64 v[14:15],s[28:29]
v_mov_b64 v[16:17],s[28:29]
v_add_u32 v22,11550720,v10
s_lshl_b32 s18,s47,2
s_add_u32 s18,s18,10493952
v_mov_b32 v1,s80
s_mov_b32 s65,14680064
s_add_u32 s66,s71,14680064
s_add_u32 s69,s71,14942208
s_mov_b32 s30,0x40000000
s_mov_b32 s51,0
buffer_load_dwordx4 v[88:91],v0,s[8:11],s66 offen offset:0
buffer_load_dwordx4 v[88:91],v0,s[8:11],s66 offen offset:1024
buffer_load_dwordx4 v[88:91],v0,s[8:11],s69 offen offset:0
buffer_load_dwordx4 v[88:91],v0,s[8:11],s69 offen offset:1024
L_cst_162:
s_cmp_lg_u32 s46,0
s_cbranch_scc1 L_csw_167
s_lshl_b32 s59,s51,13
s_lshl2_add_u32 s59,s47,s59
s_add_u32 s59,s59,10485760
s_buffer_load_dword s61,s[8:11],s59
s_waitcnt lgkmcnt(0)
s_cmp_lg_u32 s61,0
s_cbranch_scc1 L_wwd_169
L_ww_168:
s_sleep 1
buffer_load_dword v122,off,s[8:11],s59 sc1
s_sub_u32 s49,s49,1
s_cbranch_scc1 L_abort
s_waitcnt vmcnt(0)
v_readfirstlane_b32 s61,v122
s_cmp_eq_u32 s61,0
s_cbranch_scc1 L_ww_168
L_wwd_169:
L_csw_167:
s_waitcnt lgkmcnt(0)
s_barrier
s_lshl_b32 s56,s51,5
s_add_u32 s56,s56,s47
s_mul_i32 s56,s56,24576
s_add_u32 s56,s56,100663296
s_add_u32 s67,s56,s73
s_add_u32 m0,s73,131072
s_add_u32 s57,s67,8192
buffer_load_dwordx4 v0,s[8:11],s67 offen sc1 lds
buffer_load_dwordx4 v0,s[8:11],s67 offen offset:1024 sc1 lds
s_add_u32 m0,s73,139264
s_add_u32 s67,s67,786432
buffer_load_dwordx4 v0,s[8:11],s57 offen sc1 lds
buffer_load_dwordx4 v0,s[8:11],s57 offen offset:1024 sc1 lds
s_lshl_b32 s75,s51,13
s_add_u32 s56,s75,11542528
buffer_load_dword v23,v10,s[8:11],s56 offen sc1
s_add_u32 s64,s75,11534336
s_add_u32 s70,s64,4096
s_lshl_b32 s68,s51,5
s_add_u32 s68,s68,s47
s_lshl_b32 s68,s68,12
s_lshl_b32 s56,s46,10
s_add_u32 s68,s68,s56
s_add_u32 s68,s68,41943040
s_mov_b32 s54,0x80000000
s_mov_b32 s77,0
s_add_u32 s56,s18,s75
s_buffer_load_dword s19,s[8:11],s56
s_cmp_eq_u32 s51,63
s_cselect_b32 s76,1,s46
s_cmp_eq_u32 s76,0
s_cselect_b32 s76,1,0
v_mov_b64 v[96:97],0
v_mov_b64 v[98:99],0
v_mov_b64 v[100:101],0
v_mov_b64 v[102:103],0
v_mov_b64 v[104:105],0
v_mov_b64 v[106:107],0
v_mov_b64 v[108:109],0
v_mov_b64 v[110:111],0
v_mov_b64 v[112:113],0
v_mov_b64 v[114:115],0
v_mov_b64 v[116:117],0
v_mov_b64 v[118:119],0
buffer_load_dwordx4 v[88:91],v13,s[8:11],s64 offen
buffer_load_dwordx4 v[88:91],v13,s[8:11],s70 offen
s_waitcnt vmcnt(19)
v_swap_b32 v25,v28
v_swap_b32 v26,v32
v_swap_b32 v27,v36
v_swap_b32 v30,v33
v_swap_b32 v31,v37
v_swap_b32 v35,v38
ds_write_b128 v93,v[24:27] offset:4096
ds_write_b128 v94,v[28:31] offset:4096
ds_write_b128 v93,v[32:35] offset:4224
ds_write_b128 v94,v[36:39] offset:4224
s_waitcnt vmcnt(15)
v_swap_b32 v41,v44
v_swap_b32 v42,v48
v_swap_b32 v43,v52
v_swap_b32 v46,v49
v_swap_b32 v47,v53
v_swap_b32 v51,v54
ds_write_b128 v93,v[40:43] offset:5120
ds_write_b128 v94,v[44:47] offset:5120
ds_write_b128 v93,v[48:51] offset:5248
ds_write_b128 v94,v[52:55] offset:5248
s_waitcnt vmcnt(11)
v_swap_b32 v57,v60
v_swap_b32 v58,v64
v_swap_b32 v59,v68
v_swap_b32 v62,v65
v_swap_b32 v63,v69
v_swap_b32 v67,v70
ds_write_b128 v93,v[56:59] offset:6144
ds_write_b128 v94,v[60:63] offset:6144
ds_write_b128 v93,v[64:67] offset:6272
ds_write_b128 v94,v[68:71] offset:6272
s_waitcnt vmcnt(7)
v_swap_b32 v73,v76
v_swap_b32 v74,v80
v_swap_b32 v75,v84
v_swap_b32 v78,v81
v_swap_b32 v79,v85
v_swap_b32 v83,v86
ds_write_b128 v93,v[72:75] offset:7168
ds_write_b128 v94,v[76:79] offset:7168
ds_write_b128 v93,v[80:83] offset:7296
ds_write_b128 v94,v[84:87] offset:7296
s_waitcnt vmcnt(0) lgkmcnt(0)
s_barrier
v_add_u32 v55,131072,v0
ds_read_b128 v[56:59],v55 offset:0
ds_read_b128 v[60:63],v55 offset:4096
ds_read_b128 v[64:67],v55 offset:1024
ds_read_b128 v[68:71],v55 offset:5120
ds_read_b128 v[72:75],v55 offset:2048
ds_read_b128 v[76:79],v55 offset:6144
ds_read_b128 v[80:83],v55 offset:3072
ds_read_b128 v[84:87],v55 offset:7168
v_add_u32 v123,s73,v55
ds_read_b128 v[88:91],v123 offset:8192
ds_read_b128 v[92:95],v123 offset:9216
v_xor_b32 v120,1024,v12
v_xor_b32 v121,2048,v12
v_xor_b32 v122,3072,v12
buffer_load_dwordx4 v[24:27],v13,s[8:11],s64 offen sc1
buffer_load_dwordx4 v[24:27],v13,s[8:11],s64 offen sc1
.p2align 6
L_chain_170:
L_cpa_171:
buffer_load_dwordx4 v[24:27],v13,s[8:11],s64 offen sc1
s_sub_u32 s49,s49,1
s_cbranch_scc1 L_abort
s_waitcnt vmcnt(2)
v_max3_u32 v123,v24,v25,v26
v_max_u32 v123,v27,v123
v_cmp_le_u32 vcc,s72,v123
ds_write_b128 v12,v[24:27] offset:0
s_cbranch_vccnz L_cpa_171
L_cgo_174:
v_smfmac_f32_16x16x64_bf16 v[96:99],v[24:27],a[0:7],v2
buffer_load_dwordx4 v[40:43],v13,s[8:11],s70 offen sc1
s_waitcnt lgkmcnt(0)
s_barrier
ds_read_b128 v[28:31],v120 offset:0
v_smfmac_f32_16x16x64_bf16 v[100:103],v[24:27],a[128:135],v2
ds_read_b128 v[32:35],v121 offset:0
v_smfmac_f32_16x16x64_bf16 v[104:107],v[24:27],a[8:15],v2
ds_read_b128 v[36:39],v122 offset:0
v_smfmac_f32_16x16x64_bf16 v[108:111],v[24:27],a[136:143],v2
v_smfmac_f32_16x16x64_bf16 v[112:115],v[24:27],v[128:135],v2
v_smfmac_f32_16x16x64_bf16 v[116:119],v[24:27],v[136:143],v2
s_waitcnt lgkmcnt(2)
v_smfmac_f32_16x16x64_bf16 v[96:99],v[28:31],a[16:23],v2
s_add_u32 m0,s73,131072
v_smfmac_f32_16x16x64_bf16 v[100:103],v[28:31],a[144:151],v2
s_add_u32 s57,s67,8192
v_smfmac_f32_16x16x64_bf16 v[104:107],v[28:31],a[24:31],v2
s_cmp_lt_u32 s19,s76
s_cbranch_scc1 L_ckw_163
L_ckb_164:
v_smfmac_f32_16x16x64_bf16 v[108:111],v[28:31],a[152:159],v2
s_waitcnt vmcnt(0) lgkmcnt(1)
v_smfmac_f32_16x16x64_bf16 v[96:99],v[32:35],a[32:39],v2
ds_write_b128 v12,v[40:43] offset:4096
v_max3_u32 v123,v40,v41,v42
v_smfmac_f32_16x16x64_bf16 v[100:103],v[32:35],a[160:167],v2
v_max_u32 v123,v43,v123
v_smfmac_f32_16x16x64_bf16 v[104:107],v[32:35],a[40:47],v2
v_cmp_le_u32 vcc,s72,v123
v_smfmac_f32_16x16x64_bf16 v[108:111],v[32:35],a[168:175],v2
v_smfmac_f32_16x16x64_bf16 v[112:115],v[28:31],v[144:151],v2
s_cbranch_vccnz L_cpb_177
L_cback_179:
s_waitcnt lgkmcnt(0)
s_barrier
v_smfmac_f32_16x16x64_bf16 v[96:99],v[36:39],a[48:55],v2
buffer_load_dword v23,v22,s[8:11],s75 offen sc1
v_smfmac_f32_16x16x64_bf16 v[100:103],v[36:39],a[176:183],v2
ds_read_b128 v[44:47],v120 offset:4096
v_smfmac_f32_16x16x64_bf16 v[104:107],v[36:39],a[56:63],v2
buffer_load_dwordx4 v0,s[8:11],s67 offen sc1 lds
v_smfmac_f32_16x16x64_bf16 v[108:111],v[36:39],a[184:191],v2
ds_read_b128 v[48:51],v121 offset:4096
v_smfmac_f32_16x16x64_bf16 v[96:99],v[40:43],a[64:71],v2
buffer_store_dwordx4 v[124:127],v0,s[8:11],s54 offen sc1
v_smfmac_f32_16x16x64_bf16 v[100:103],v[40:43],a[192:199],v2
ds_read_b128 v[52:55],v122 offset:4096
v_smfmac_f32_16x16x64_bf16 v[104:107],v[40:43],a[72:79],v2
buffer_load_dwordx4 v0,s[8:11],s67 offen offset:1024 sc1 lds
s_add_u32 m0,s73,139264
v_smfmac_f32_16x16x64_bf16 v[108:111],v[40:43],a[200:207],v2
s_waitcnt lgkmcnt(2)
v_smfmac_f32_16x16x64_bf16 v[96:99],v[44:47],a[80:87],v2
buffer_load_dwordx4 v0,s[8:11],s57 offen sc1 lds
s_add_u32 s67,s67,786432
v_smfmac_f32_16x16x64_bf16 v[100:103],v[44:47],a[208:215],v2
s_waitcnt lgkmcnt(1)
v_smfmac_f32_16x16x64_bf16 v[96:99],v[48:51],a[96:103],v2
buffer_load_dwordx4 v0,s[8:11],s57 offen offset:1024 sc1 lds
v_smfmac_f32_16x16x64_bf16 v[100:103],v[48:51],a[224:231],v2
s_waitcnt lgkmcnt(0)
v_smfmac_f32_16x16x64_bf16 v[96:99],v[52:55],a[112:119],v2
v_smfmac_f32_16x16x64_bf16 v[100:103],v[52:55],a[240:247],v2
v_smfmac_f32_16x16x64_bf16 v[104:107],v[44:47],a[88:95],v2
v_smfmac_f32_16x16x64_bf16 v[108:111],v[44:47],a[216:223],v2
v_smfmac_f32_16x16x64_bf16 v[104:107],v[48:51],a[104:111],v2
v_add_f32 v96,v96,v98
v_smfmac_f32_16x16x64_bf16 v[108:111],v[48:51],a[232:239],v2
v_add_f32 v97,v97,v99
v_smfmac_f32_16x16x64_bf16 v[104:107],v[52:55],a[120:127],v2
v_cvt_pk_bf16_f32 v120,v96,v97
v_smfmac_f32_16x16x64_bf16 v[108:111],v[52:55],a[248:255],v2
v_add_f32 v100,v100,v102
v_smfmac_f32_16x16x64_bf16 v[116:119],v[28:31],v[152:159],v2
v_add_f32 v101,v101,v103
v_smfmac_f32_16x16x64_bf16 v[112:115],v[32:35],v[160:167],v2
v_cvt_pk_bf16_f32 v121,v100,v101
v_add_f32 v104,v104,v106
v_add_f32 v105,v105,v107
v_cvt_pk_bf16_f32 v122,v104,v105
v_add_f32 v108,v108,v110
v_add_f32 v109,v109,v111
v_cvt_pk_bf16_f32 v123,v108,v109
ds_write_b128 v4,v[120:123]
v_smfmac_f32_16x16x64_bf16 v[116:119],v[32:35],v[168:175],v2
s_mov_b32 s54,s68
s_add_u32 s68,s68,131072
v_mov_b32 v125,0
v_smfmac_f32_16x16x64_bf16 v[112:115],v[36:39],v[176:183],v2
s_cmp_eq_u32 s51,63
s_cbranch_scc1 L_cend_173
v_smfmac_f32_16x16x64_bf16 v[116:119],v[36:39],v[184:191],v2
s_waitcnt lgkmcnt(0)
s_barrier
ds_read_b64_tr_b16 v[96:97],v5 offset:0
v_smfmac_f32_16x16x64_bf16 v[112:115],v[40:43],v[192:199],v2
ds_read_b64_tr_b16 v[98:99],v6 offset:0
v_smfmac_f32_16x16x64_bf16 v[116:119],v[40:43],v[200:207],v2
ds_read_b64_tr_b16 v[100:101],v5 offset:1024
v_smfmac_f32_16x16x64_bf16 v[112:115],v[44:47],v[208:215],v2
ds_read_b64_tr_b16 v[102:103],v6 offset:1024
v_smfmac_f32_16x16x64_bf16 v[116:119],v[44:47],v[216:223],v2
ds_read_b64_tr_b16 v[104:105],v5 offset:2048
v_smfmac_f32_16x16x64_bf16 v[112:115],v[48:51],v[224:231],v2
ds_read_b64_tr_b16 v[106:107],v6 offset:2048
s_waitcnt lgkmcnt(4)
v_mfma_f32_16x16x32_bf16 v[24:27],v[56:59],v[96:99],0
ds_read_b64_tr_b16 v[108:109],v5 offset:3072
v_mfma_f32_16x16x32_bf16 v[28:31],v[60:63],v[96:99],0
ds_read_b64_tr_b16 v[110:111],v6 offset:3072
v_mfma_f32_16x16x32_bf16 v[32:35],v[96:99],v[96:99],0
ds_read_b128 v[40:43],v11 offset:12288
s_waitcnt lgkmcnt(5)
v_mfma_f32_16x16x32_bf16 v[24:27],v[64:67],v[100:103],v[24:27]
ds_read_b128 v[56:59],v11 offset:0
v_mfma_f32_16x16x32_bf16 v[28:31],v[68:71],v[100:103],v[28:31]
ds_read_b128 v[60:63],v11 offset:1024
v_mfma_f32_16x16x32_bf16 v[32:35],v[100:103],v[100:103],v[32:35]
ds_read_b128 v[96:99],v11 offset:8192
s_waitcnt lgkmcnt(6)
v_mfma_f32_16x16x32_bf16 v[24:27],v[72:75],v[104:107],v[24:27]
ds_read_b128 v[64:67],v11 offset:2048
v_mfma_f32_16x16x32_bf16 v[28:31],v[76:79],v[104:107],v[28:31]
ds_read_b128 v[68:71],v11 offset:3072
v_mfma_f32_16x16x32_bf16 v[32:35],v[104:107],v[104:107],v[32:35]
ds_read_b128 v[100:103],v11 offset:9216
s_waitcnt lgkmcnt(7)
v_mfma_f32_16x16x32_bf16 v[24:27],v[80:83],v[108:111],v[24:27]
ds_read_b128 v[72:75],v11 offset:4096
v_mfma_f32_16x16x32_bf16 v[28:31],v[84:87],v[108:111],v[28:31]
ds_read_b128 v[76:79],v11 offset:5120
v_mfma_f32_16x16x32_bf16 v[32:35],v[108:111],v[108:111],v[32:35]
ds_read_b128 v[104:107],v11 offset:10240
v_smfmac_f32_16x16x64_bf16 v[116:119],v[48:51],v[232:239],v2
ds_read_b128 v[80:83],v11 offset:6144
v_smfmac_f32_16x16x64_bf16 v[112:115],v[52:55],v[240:247],v2
ds_read_b128 v[84:87],v11 offset:7168
v_smfmac_f32_16x16x64_bf16 v[116:119],v[52:55],v[248:255],v2
ds_read_b128 v[108:111],v11 offset:11264
v_max3_f32 v126,v24,v25,v26
v_max3_f32 v127,v27,v28,v29
v_max3_f32 v126,v30,v31,v126
v_max3_f32 v127,v34,v35,v127
v_max_f32 v126,v126,v127
v_max_f32 v127,v126,v127
v_pk_mul_f32 v[34:35],v[34:35],v[0:1] op_sel:[0,1]
v_pk_mul_f32 v[24:25],v[24:25],v[0:1] op_sel:[0,1]
v_permlane16_swap_b32 v126,v127
v_max_f32 v126,v126,v127
v_max_f32 v127,v126,v127
v_pk_add_f32 v[112:113],v[112:113],v[114:115]
v_pk_add_f32 v[116:117],v[116:117],v[118:119]
v_permlane32_swap_b32 v126,v127
v_max_f32 v126,v126,v127
v_mul_f32 v126,v1,v126
v_pk_add_f32 v[34:35],v[34:35],v[126:127] op_sel_hi:[1,0] neg_lo:[0,1] neg_hi:[0,1]
v_pk_add_f32 v[24:25],v[24:25],v[126:127] op_sel_hi:[1,0] neg_lo:[0,1] neg_hi:[0,1]
v_pk_fma_f32 v[26:27],v[26:27],v[0:1],v[126:127] op_sel:[0,1,0] op_sel_hi:[1,1,0] neg_lo:[0,0,1] neg_hi:[0,0,1]
v_pk_fma_f32 v[28:29],v[28:29],v[0:1],v[126:127] op_sel:[0,1,0] op_sel_hi:[1,1,0] neg_lo:[0,0,1] neg_hi:[0,0,1]
v_pk_fma_f32 v[30:31],v[30:31],v[0:1],v[126:127] op_sel:[0,1,0] op_sel_hi:[1,1,0] neg_lo:[0,0,1] neg_hi:[0,0,1]
v_exp_f32 v34,v34
v_exp_f32 v35,v35
v_cvt_pk_bf16_f32 v126,v112,v113
v_cvt_pk_bf16_f32 v124,v34,v35
v_cvt_pk_bf16_f32 v127,v116,v117
v_cvt_pk_bf16_f32 v36,v116,v117
v_mfma_f32_16x16x16_bf16 v[32:35],v[14:15],v[124:125],0
ds_read_b128 v[44:47],v11 offset:13312
v_exp_f32 v24,v24
v_mfma_f32_16x16x16_bf16 v[112:115],v[126:127],v[124:125],0
ds_read_b128 v[48:51],v11 offset:14336
v_exp_f32 v25,v25
v_mfma_f32_16x16x16_bf16 v[116:119],v[36:37],v[124:125],0
ds_read_b128 v[52:55],v11 offset:15360
v_exp_f32 v26,v26
v_exp_f32 v27,v27
v_cvt_pk_bf16_f32 v120,v24,v25
v_exp_f32 v28,v28
v_exp_f32 v29,v29
v_cvt_pk_bf16_f32 v121,v26,v27
v_exp_f32 v30,v30
v_exp_f32 v31,v31
v_cvt_pk_bf16_f32 v122,v28,v29
v_cvt_pk_bf16_f32 v123,v30,v31
s_add_u32 s75,s75,8192
s_add_u32 s51,s51,1
v_mfma_f32_16x16x32_bf16 v[32:35],v[14:17],v[120:123],v[32:35]
v_mfma_f32_16x16x32_bf16 v[112:115],v[88:91],v[120:123],v[112:115]
ds_read_b128 v[88:91],v11 offset:16384
v_mfma_f32_16x16x32_bf16 v[116:119],v[92:95],v[120:123],v[116:119]
ds_read_b128 v[92:95],v11 offset:17408
v_rcp_f32 v32,v32
v_mov_b64 v[24:25],-1
v_mov_b64 v[26:27],-1
s_add_u32 s64,s75,11534336
s_add_u32 s70,s64,4096
v_pk_mul_f32 v[112:113],v[112:113],v[32:33] op_sel_hi:[1,0]
v_pk_mul_f32 v[114:115],v[114:115],v[32:33] op_sel_hi:[1,0]
v_pk_mul_f32 v[116:117],v[116:117],v[32:33] op_sel_hi:[1,0]
v_pk_mul_f32 v[118:119],v[118:119],v[32:33] op_sel_hi:[1,0]
v_cvt_pk_bf16_f32 v120,v112,v116
v_cvt_pk_bf16_f32 v121,v113,v117
v_cvt_pk_bf16_f32 v122,v114,v118
v_cvt_pk_bf16_f32 v123,v115,v119
ds_write_b128 v7,v[120:123]
buffer_store_dwordx4 v[24:27],v0,s[8:11],s69 offen
buffer_store_dwordx4 v[24:27],v0,s[8:11],s69 offen offset:1024
v_mov_b64 v[112:113],0
v_mov_b64 v[114:115],0
v_mov_b64 v[116:117],0
v_mov_b64 v[118:119],0
s_waitcnt lgkmcnt(0)
s_barrier
ds_read_b128 v[24:27],v8 offset:0
ds_read_b128 v[28:31],v8 offset:512
ds_read_b128 v[32:35],v8 offset:1024
ds_read_b128 v[36:39],v8 offset:1536
v_mov_b64 v[120:121],0
v_mov_b64 v[122:123],0
s_add_u32 s57,s65,65536
s_add_u32 s58,s65,131072
s_add_u32 s59,s65,196608
s_add_u32 s56,s18,s75
s_waitcnt lgkmcnt(3)
v_smfmac_f32_16x16x64_bf16 v[112:115],v[24:27],v[56:63],v3
ds_read_b128 v[56:59],v11 offset:18432
s_waitcnt lgkmcnt(3)
v_smfmac_f32_16x16x64_bf16 v[112:115],v[28:31],v[64:71],v3
ds_read_b128 v[60:63],v11 offset:19456
s_waitcnt lgkmcnt(3)
v_smfmac_f32_16x16x64_bf16 v[112:115],v[32:35],v[72:79],v3
ds_read_b128 v[64:67],v11 offset:20480
s_waitcnt lgkmcnt(3)
v_smfmac_f32_16x16x64_bf16 v[112:115],v[36:39],v[80:87],v3
ds_read_b128 v[68:71],v11 offset:21504
v_smfmac_f32_16x16x64_bf16 v[116:119],v[24:27],v[96:103],v3
ds_read_b128 v[72:75],v11 offset:22528
v_smfmac_f32_16x16x64_bf16 v[116:119],v[28:31],v[104:111],v3
ds_read_b128 v[76:79],v11 offset:23552
v_cvt_pk_bf16_f32 v112,v112,v113
v_smfmac_f32_16x16x64_bf16 v[116:119],v[32:35],v[40:47],v3
ds_read_b128 v[80:83],v11 offset:24576
v_cvt_pk_bf16_f32 v113,v114,v115
buffer_store_dwordx2 v[112:113],v9,s[8:11],s65 offen
v_smfmac_f32_16x16x64_bf16 v[116:119],v[36:39],v[48:55],v3
ds_read_b128 v[84:87],v11 offset:25600
v_mov_b64 v[112:113],0
v_smfmac_f32_16x16x64_bf16 v[120:123],v[24:27],v[88:95],v3
ds_read_b128 v[96:99],v11 offset:26624
ds_read_b128 v[100:103],v11 offset:27648
v_mov_b64 v[114:115],0
s_waitcnt lgkmcnt(8)
v_smfmac_f32_16x16x64_bf16 v[120:123],v[28:31],v[56:63],v3
ds_read_b128 v[104:107],v11 offset:28672
v_cvt_pk_bf16_f32 v116,v116,v117
s_waitcnt lgkmcnt(7)
v_smfmac_f32_16x16x64_bf16 v[120:123],v[32:35],v[64:71],v3
ds_read_b128 v[108:111],v11 offset:29696
ds_read_b128 v[40:43],v11 offset:30720
v_cvt_pk_bf16_f32 v117,v118,v119
buffer_store_dwordx2 v[116:117],v9,s[8:11],s57 offen
s_waitcnt lgkmcnt(7)
v_smfmac_f32_16x16x64_bf16 v[120:123],v[36:39],v[72:79],v3
ds_read_b128 v[44:47],v11 offset:31744
v_add_u32 v52,s50,v5
s_waitcnt lgkmcnt(6)
v_smfmac_f32_16x16x64_bf16 v[112:115],v[24:27],v[80:87],v3
v_add_u32 v54,s50,v6
s_waitcnt lgkmcnt(4)
v_smfmac_f32_16x16x64_bf16 v[112:115],v[28:31],v[96:103],v3
ds_read_b64_tr_b16 v[52:53],v52
v_cvt_pk_bf16_f32 v120,v120,v121
s_waitcnt lgkmcnt(3)
v_smfmac_f32_16x16x64_bf16 v[112:115],v[32:35],v[104:111],v3
ds_read_b64_tr_b16 v[54:55],v54
v_cvt_pk_bf16_f32 v121,v122,v123
buffer_store_dwordx2 v[120:121],v9,s[8:11],s58 offen
s_waitcnt lgkmcnt(2)
v_smfmac_f32_16x16x64_bf16 v[112:115],v[36:39],v[40:47],v3
v_mov_b64 v[116:117],0
v_mov_b64 v[118:119],0
s_xor_b32 s65,s65,262144
v_mov_b32_dpp v124,v126 quad_perm:[2,3,2,3] row_mask:0xf bank_mask:0xf
v_mov_b32_dpp v125,v127 quad_perm:[2,3,2,3] row_mask:0xf bank_mask:0xf
s_mov_b32 vcc_lo,0xcccccccc
s_mov_b32 vcc_hi,0xcccccccc
s_nop 0
v_cvt_pk_bf16_f32 v112,v112,v113
v_cvt_pk_bf16_f32 v113,v114,v115
buffer_store_dwordx2 v[112:113],v9,s[8:11],s59 offen
s_waitcnt lgkmcnt(0)
s_buffer_load_dword s19,s[8:11],s56
v_cndmask_b32 v124,v124,v52,vcc
v_cndmask_b32 v125,v125,v53,vcc
s_cmp_lt_u32 s46,2
s_waitcnt vmcnt(3)
s_cbranch_scc1 L_crg_180
s_cmp_eq_u32 s46,2
s_waitcnt vmcnt(1)
s_cbranch_scc1 L_crg_180
s_waitcnt vmcnt(0)
L_crg_180:
buffer_load_dwordx4 v[32:35],v0,s[8:11],s66 offen offset:0 sc1
buffer_load_dwordx4 v[36:39],v0,s[8:11],s66 offen offset:1024 sc1
v_cndmask_b32 v126,v126,v54,vcc
v_cndmask_b32 v127,v127,v55,vcc
v_mov_b64 v[96:97],0
v_mov_b64 v[98:99],0
v_mov_b64 v[100:101],0
v_mov_b64 v[102:103],0
v_mov_b64 v[104:105],0
v_mov_b64 v[106:107],0
v_mov_b64 v[108:109],0
v_mov_b64 v[110:111],0
v_mov_b64 v[112:113],0
v_mov_b64 v[114:115],0
v_add_u32 v55,131072,v0
v_add_u32 v123,s73,v55
v_xor_b32 v120,1024,v12
v_xor_b32 v121,2048,v12
v_xor_b32 v122,3072,v12
buffer_load_dwordx4 v[44:47],v0,s[8:11],s66 offen offset:0 sc1
buffer_load_dwordx4 v[48:51],v0,s[8:11],s66 offen offset:1024 sc1
s_cmp_ge_u32 s51,63
s_cselect_b32 s76,0,1
s_cmp_eq_u32 s46,0
s_cselect_b32 s76,s76,0
s_waitcnt vmcnt(3)
v_mfma_f32_16x16x32_bf16 v[28:31],v[18:21],v[32:35],0
s_waitcnt vmcnt(2)
v_mfma_f32_16x16x32_bf16 v[28:31],v[18:21],v[36:39],v[28:31]
s_nop 7
v_cmp_u_f32 vcc,v28,v28
v_add_f32_dpp v52,v28,v28 row_ror:8 row_mask:0xf bank_mask:0x3
v_add_f32_dpp v53,v29,v29 row_ror:8 row_mask:0xf bank_mask:0x3
v_add_f32_dpp v52,v30,v30 row_ror:8 row_mask:0xf bank_mask:0xc
v_add_f32_dpp v53,v31,v31 row_ror:8 row_mask:0xf bank_mask:0xc
s_cbranch_vccnz L_crp_175
L_cok_181:
v_add_f32_dpp v52,v52,v52 row_shl:4 row_mask:0xf bank_mask:0x5
v_add_f32_dpp v53,v53,v53 row_shl:4 row_mask:0xf bank_mask:0x5
v_cvt_pk_bf16_f32 v54,v52,v53
buffer_store_dword v54,v10,s[8:11],s64 offen
s_mov_b32 s69,s66
s_xor_b32 s66,s66,262144
s_barrier
ds_read_b128 v[56:59],v55 offset:0
ds_read_b128 v[60:63],v55 offset:4096
ds_read_b128 v[64:67],v55 offset:1024
buffer_load_dwordx4 v[24:27],v13,s[8:11],s64 offen sc1
ds_read_b128 v[68:71],v55 offset:5120
ds_read_b128 v[72:75],v55 offset:2048
ds_read_b128 v[76:79],v55 offset:6144
ds_read_b128 v[80:83],v55 offset:3072
buffer_load_dwordx4 v[24:27],v13,s[8:11],s64 offen sc1
ds_read_b128 v[84:87],v55 offset:7168
ds_read_b128 v[88:91],v123 offset:8192
ds_read_b128 v[92:95],v123 offset:9216
s_branch L_chain_170
L_cpb_177:
buffer_load_dwordx4 v[40:43],v13,s[8:11],s70 offen sc1
s_sub_u32 s49,s49,1
s_cbranch_scc1 L_abort
s_waitcnt vmcnt(0)
v_max3_u32 v123,v40,v41,v42
v_max_u32 v123,v43,v123
v_cmp_le_u32 vcc,s72,v123
s_cbranch_vccnz L_cpb_177
ds_write_b128 v12,v[40:43] offset:4096
s_branch L_cback_179
L_crp_175:
buffer_load_dwordx4 v[32:35],v0,s[8:11],s66 offen offset:0 sc1
buffer_load_dwordx4 v[36:39],v0,s[8:11],s66 offen offset:1024 sc1
s_sub_u32 s49,s49,1
s_cbranch_scc1 L_abort
s_waitcnt vmcnt(3)
v_mfma_f32_16x16x32_bf16 v[28:31],v[18:21],v[44:47],0
s_waitcnt vmcnt(2)
v_mfma_f32_16x16x32_bf16 v[28:31],v[18:21],v[48:51],v[28:31]
s_nop 7
v_cmp_u_f32 vcc,v28,v28
v_add_f32_dpp v52,v28,v28 row_ror:8 row_mask:0xf bank_mask:0x3
v_add_f32_dpp v53,v29,v29 row_ror:8 row_mask:0xf bank_mask:0x3
v_add_f32_dpp v52,v30,v30 row_ror:8 row_mask:0xf bank_mask:0xc
v_add_f32_dpp v53,v31,v31 row_ror:8 row_mask:0xf bank_mask:0xc
s_cbranch_vccz L_cok_181
buffer_load_dwordx4 v[44:47],v0,s[8:11],s66 offen offset:0 sc1
buffer_load_dwordx4 v[48:51],v0,s[8:11],s66 offen offset:1024 sc1
s_sub_u32 s49,s49,1
s_cbranch_scc1 L_abort
s_waitcnt vmcnt(3)
v_mfma_f32_16x16x32_bf16 v[28:31],v[18:21],v[32:35],0
s_waitcnt vmcnt(2)
v_mfma_f32_16x16x32_bf16 v[28:31],v[18:21],v[36:39],v[28:31]
s_nop 7
v_cmp_u_f32 vcc,v28,v28
v_add_f32_dpp v52,v28,v28 row_ror:8 row_mask:0xf bank_mask:0x3
v_add_f32_dpp v53,v29,v29 row_ror:8 row_mask:0xf bank_mask:0x3
v_add_f32_dpp v52,v30,v30 row_ror:8 row_mask:0xf bank_mask:0xc
v_add_f32_dpp v53,v31,v31 row_ror:8 row_mask:0xf bank_mask:0xc
s_cbranch_vccz L_cok_181
s_branch L_crp_175
L_ckw_163:
s_add_u32 s59,s18,s75
L_ww_182:
buffer_load_dword v23,off,s[8:11],s59 sc1
s_sub_u32 s49,s49,1
s_cbranch_scc1 L_abort
s_waitcnt vmcnt(0)
v_readfirstlane_b32 s76,v23
s_cmp_eq_u32 s76,0
s_cbranch_scc1 L_ww_182
L_wwd_183:
s_branch L_ckb_164
L_cend_173:
v_smfmac_f32_16x16x64_bf16 v[116:119],v[36:39],v[184:191],v2
v_smfmac_f32_16x16x64_bf16 v[112:115],v[40:43],v[192:199],v2
v_smfmac_f32_16x16x64_bf16 v[116:119],v[40:43],v[200:207],v2
v_smfmac_f32_16x16x64_bf16 v[112:115],v[44:47],v[208:215],v2
v_smfmac_f32_16x16x64_bf16 v[116:119],v[44:47],v[216:223],v2
v_smfmac_f32_16x16x64_bf16 v[112:115],v[48:51],v[224:231],v2
v_smfmac_f32_16x16x64_bf16 v[116:119],v[48:51],v[232:239],v2
v_smfmac_f32_16x16x64_bf16 v[112:115],v[52:55],v[240:247],v2
v_smfmac_f32_16x16x64_bf16 v[116:119],v[52:55],v[248:255],v2
s_waitcnt lgkmcnt(0)
s_nop 2
v_pk_add_f32 v[112:113],v[112:113],v[114:115]
s_nop 2
v_pk_add_f32 v[116:117],v[116:117],v[118:119]
v_cvt_pk_bf16_f32 v126,v112,v113
v_cvt_pk_bf16_f32 v127,v116,v117
v_add_u32 v52,s50,v5
v_add_u32 v54,s50,v6
ds_read_b64_tr_b16 v[52:53],v52
ds_read_b64_tr_b16 v[54:55],v54
v_mov_b32_dpp v124,v126 quad_perm:[2,3,2,3] row_mask:0xf bank_mask:0xf
v_mov_b32_dpp v125,v127 quad_perm:[2,3,2,3] row_mask:0xf bank_mask:0xf
s_mov_b32 vcc_lo,0xcccccccc
s_mov_b32 vcc_hi,0xcccccccc
s_waitcnt lgkmcnt(0)
v_cndmask_b32 v124,v124,v52,vcc
v_cndmask_b32 v125,v125,v53,vcc
v_cndmask_b32 v126,v126,v54,vcc
v_cndmask_b32 v127,v127,v55,vcc
buffer_store_dwordx4 v[124:127],v0,s[8:11],s54 offen sc1
s_mov_b32 s51,64
s_waitcnt vmcnt(0)
s_barrier
s_nop 11
v_lshrrev_b32 v1,4,v0
s_mov_b32 s53,0
s_branch L_rb_7
L_rc1_157:
v_and_b32 v120,15,v1
v_lshrrev_b32 v121,4,v1
v_and_b32 v122,2,v1
v_cmp_eq_u32 vcc,0,v122
v_mov_b32 v2,0xeeee
v_mov_b32 v123,0x4444
v_cndmask_b32 v2,v2,v123,vcc
v_and_b32 v122,1,v1
v_cmp_eq_u32 vcc,0,v122
v_mov_b32 v3,0xdddd
v_mov_b32 v123,0x8888
v_cndmask_b32 v3,v3,v123,vcc
v_lshrrev_b32 v122,1,v120
v_bfe_u32 v123,v120,2,1
v_xor_b32 v123,v123,v122
v_lshlrev_b32 v4,7,v123
v_and_b32 v123,1,v120
v_lshl_add_u32 v4,v123,6,v4
v_xor_b32 v123,v121,v122
v_and_b32 v123,3,v123
v_lshl_add_u32 v4,v123,4,v4
s_lshl_b32 s56,s46,10
s_add_u32 s56,s56,147456
v_add_u32 v4,s56,v4
v_lshlrev_b32 v122,1,v121
v_add_u32 v122,0,v122
v_and_b32 v123,1,v121
v_xor_b32 v123,v123,v122
v_lshlrev_b32 v5,7,v123
v_bfe_u32 v123,v120,3,1
v_lshl_add_u32 v5,v123,6,v5
v_xor_b32 v123,v120,v122
v_and_b32 v123,3,v123
v_lshl_add_u32 v5,v123,4,v5
v_bfe_u32 v123,v120,2,1
v_lshl_add_u32 v5,v123,3,v5
v_add_u32 v5,147456,v5
v_lshlrev_b32 v122,1,v121
v_add_u32 v122,1,v122
v_and_b32 v123,1,v121
v_xor_b32 v123,v123,v122
v_lshlrev_b32 v6,7,v123
v_bfe_u32 v123,v120,3,1
v_lshl_add_u32 v6,v123,6,v6
v_xor_b32 v123,v120,v122
v_and_b32 v123,3,v123
v_lshl_add_u32 v6,v123,4,v6
v_bfe_u32 v123,v120,2,1
v_lshl_add_u32 v6,v123,3,v6
v_add_u32 v6,147456,v6
v_lshlrev_b32 v7,7,v121
v_lshrrev_b32 v122,1,v120
v_lshl_add_u32 v8,v122,4,v7
v_add_u32 v8,151552,v8
v_lshrrev_b32 v122,2,v120
v_lshl_add_u32 v7,v122,5,v7
v_and_b32 v122,1,v120
v_lshl_add_u32 v7,v122,4,v7
v_and_b32 v122,2,v120
v_cmp_eq_u32 vcc,0,v122
s_lshl_b32 s56,s46,9
v_mov_b32 v122,2048
v_mov_b32 v123,s56
v_cndmask_b32 v122,v122,v123,vcc
v_add_u32 v7,v122,v7
v_add_u32 v7,151552,v7
v_lshrrev_b32 v122,3,v1
v_lshlrev_b32 v9,11,v122
v_and_b32 v122,7,v1
v_lshl_add_u32 v9,v122,3,v9
s_lshl_b32 s56,s46,14
s_lshl_b32 s57,s47,6
s_add_u32 s56,s56,s57
v_add_u32 v9,s56,v9
s_lshl_b32 s71,s46,5
s_add_u32 s71,s71,s47
s_bfe_u32 s56,s71,0x10003
s_lshl_b32 s56,s56,11
s_and_b32 s57,s71,1
s_lshl_b32 s57,s57,10
s_add_u32 s56,s56,s57
s_bfe_u32 s57,s71,0x10002
s_lshl_b32 s57,s57,9
s_add_u32 s56,s56,s57
s_bfe_u32 s57,s71,0x10001
s_lshl_b32 s57,s57,6
s_add_u32 s56,s56,s57
s_bfe_u32 s57,s71,0x10004
s_lshl_b32 s57,s57,8
s_add_u32 s56,s56,s57
s_bfe_u32 s57,s71,0x10005
s_lshl_b32 s57,s57,7
s_add_u32 s56,s56,s57
s_bfe_u32 s57,s71,0x10006
s_lshl_b32 s57,s57,12
s_add_u32 s56,s56,s57
v_and_b32 v122,3,v120
v_lshlrev_b32 v10,2,v122
v_bfe_u32 v122,v120,3,1
v_lshl_add_u32 v10,v122,4,v10
v_and_b32 v122,1,v121
v_lshl_add_u32 v10,v122,5,v10
v_add_u32 v10,s56,v10
v_and_b32 v123,36,v1
v_mov_b32 v122,0x80000000
v_cmp_eq_u32 vcc,0,v123
s_nop 1
v_cndmask_b32 v10,v122,v10,vcc
s_lshl_b32 s71,s71,11
s_lshl_b32 s73,s46,11
s_mov_b32 s72,0xffc00000
s_mov_b32 s74,0
v_and_b32 v11,1,v121
v_xor_b32 v11,v11,v120
v_and_b32 v11,3,v11
v_lshrrev_b32 v122,2,v120
v_lshl_add_u32 v11,v11,2,v122
v_lshl_add_u32 v11,v121,4,v11
v_lshlrev_b32 v11,4,v11
s_lshl_b32 s56,s46,15
v_add_u32 v11,s56,v11
v_lshrrev_b32 v13,3,v1
v_lshlrev_b32 v13,9,v13
v_and_b32 v122,7,v1
v_lshl_add_u32 v13,v122,4,v13
v_and_b32 v122,15,v1
v_and_b32 v123,1,v1
v_lshlrev_b32 v123,4,v123
v_mov_b32 v124,0x3f80
v_lshlrev_b32 v124,v123,v124
v_lshrrev_b32 v122,1,v122
v_cmp_eq_u32 vcc,0,v122
s_nop 1
v_cndmask_b32 v18,0,v124,vcc
v_cmp_eq_u32 vcc,1,v122
s_nop 1
v_cndmask_b32 v19,0,v124,vcc
v_cmp_eq_u32 vcc,2,v122
s_nop 1
v_cndmask_b32 v20,0,v124,vcc
v_cmp_eq_u32 vcc,3,v122
s_nop 1
v_cndmask_b32 v21,0,v124,vcc
s_and_b32 s56,s46,1
s_lshl_b32 s56,s56,8
s_and_b32 s57,s46,2
s_lshl_b32 s57,s57,6
s_add_u32 s56,s56,s57
v_add_u32 v13,s56,v13
s_add_u32 s56,s50,155648
v_add_u32 v12,s56,v0
v_mov_b64 v[14:15],s[28:29]
v_mov_b64 v[16:17],s[28:29]
v_add_u32 v22,12599296,v10
s_lshl_b32 s18,s47,2
s_add_u32 s18,s18,10494080
v_mov_b32 v1,s80
s_mov_b32 s65,15728640
s_add_u32 s66,s71,15728640
s_add_u32 s69,s71,15990784
s_mov_b32 s30,0x40000000
s_mov_b32 s51,0
buffer_load_dwordx4 v[88:91],v0,s[8:11],s66 offen offset:0
buffer_load_dwordx4 v[88:91],v0,s[8:11],s66 offen offset:1024
buffer_load_dwordx4 v[88:91],v0,s[8:11],s69 offen offset:0
buffer_load_dwordx4 v[88:91],v0,s[8:11],s69 offen offset:1024
s_waitcnt vmcnt(0)
L_cst_187:
s_cmp_lg_u32 s46,0
s_cbranch_scc1 L_csw_192
s_lshl_b32 s59,s51,13
s_lshl2_add_u32 s59,s47,s59
s_add_u32 s59,s59,10485888
L_ww_193:
s_sleep 1
buffer_load_dword v122,off,s[8:11],s59 sc1
s_sub_u32 s49,s49,1
s_cbranch_scc1 L_abort
s_waitcnt vmcnt(0)
v_readfirstlane_b32 s61,v122
s_cmp_eq_u32 s61,0
s_cbranch_scc1 L_ww_193
L_wwd_194:
L_csw_192:
s_waitcnt lgkmcnt(0)
s_barrier
s_lshl_b32 s56,s51,5
s_add_u32 s56,s56,s47
s_mul_i32 s56,s56,24576
s_add_u32 s56,s56,150994944
s_add_u32 s67,s56,s73
s_add_u32 m0,s73,131072
s_add_u32 s57,s67,8192
buffer_load_dwordx4 v0,s[8:11],s67 offen sc1 lds
buffer_load_dwordx4 v0,s[8:11],s67 offen offset:1024 sc1 lds
s_add_u32 m0,s73,139264
s_add_u32 s67,s67,786432
buffer_load_dwordx4 v0,s[8:11],s57 offen sc1 lds
buffer_load_dwordx4 v0,s[8:11],s57 offen offset:1024 sc1 lds
s_lshl_b32 s75,s51,13
s_add_u32 s56,s75,12591104
buffer_load_dword v23,v10,s[8:11],s56 offen sc1
s_add_u32 s64,s75,12582912
s_add_u32 s70,s64,4096
s_lshl_b32 s68,s51,5
s_add_u32 s68,s68,s47
s_lshl_b32 s68,s68,12
s_lshl_b32 s56,s46,10
s_add_u32 s68,s68,s56
s_add_u32 s68,s68,58720256
s_mov_b32 s54,0x80000000
s_mov_b32 s77,0
s_add_u32 s56,s18,s75
s_buffer_load_dword s19,s[8:11],s56
s_cmp_eq_u32 s51,63
s_cselect_b32 s76,1,s46
s_cmp_eq_u32 s76,0
s_cselect_b32 s76,1,0
v_mov_b64 v[96:97],0
v_mov_b64 v[98:99],0
v_mov_b64 v[100:101],0
v_mov_b64 v[102:103],0
v_mov_b64 v[104:105],0
v_mov_b64 v[106:107],0
v_mov_b64 v[108:109],0
v_mov_b64 v[110:111],0
v_mov_b64 v[112:113],0
v_mov_b64 v[114:115],0
v_mov_b64 v[116:117],0
v_mov_b64 v[118:119],0
s_waitcnt vmcnt(0) lgkmcnt(0)
s_barrier
v_add_u32 v55,131072,v0
ds_read_b128 v[56:59],v55 offset:0
ds_read_b128 v[60:63],v55 offset:4096
ds_read_b128 v[64:67],v55 offset:1024
ds_read_b128 v[68:71],v55 offset:5120
ds_read_b128 v[72:75],v55 offset:2048
ds_read_b128 v[76:79],v55 offset:6144
ds_read_b128 v[80:83],v55 offset:3072
ds_read_b128 v[84:87],v55 offset:7168
v_add_u32 v123,s73,v55
ds_read_b128 v[88:91],v123 offset:8192
ds_read_b128 v[92:95],v123 offset:9216
v_xor_b32 v120,1024,v12
v_xor_b32 v121,2048,v12
v_xor_b32 v122,3072,v12
buffer_load_dwordx4 v[24:27],v13,s[8:11],s64 offen sc1
buffer_load_dwordx4 v[24:27],v13,s[8:11],s64 offen sc1
.p2align 6
L_chain_195:
L_cpa_196:
buffer_load_dwordx4 v[24:27],v13,s[8:11],s64 offen sc1
s_sub_u32 s49,s49,1
s_cbranch_scc1 L_abort
s_waitcnt vmcnt(2)
v_max3_u32 v123,v24,v25,v26
v_max_u32 v123,v27,v123
v_cmp_le_u32 vcc,s72,v123
ds_write_b128 v12,v[24:27] offset:0
s_cbranch_vccnz L_cpa_196
L_cgo_199:
v_smfmac_f32_16x16x64_bf16 v[96:99],v[24:27],a[0:7],v2
buffer_load_dwordx4 v[40:43],v13,s[8:11],s70 offen sc1
s_waitcnt lgkmcnt(0)
s_barrier
ds_read_b128 v[28:31],v120 offset:0
v_smfmac_f32_16x16x64_bf16 v[100:103],v[24:27],a[128:135],v2
ds_read_b128 v[32:35],v121 offset:0
v_smfmac_f32_16x16x64_bf16 v[104:107],v[24:27],a[8:15],v2
ds_read_b128 v[36:39],v122 offset:0
v_smfmac_f32_16x16x64_bf16 v[108:111],v[24:27],a[136:143],v2
v_smfmac_f32_16x16x64_bf16 v[112:115],v[24:27],v[128:135],v2
v_smfmac_f32_16x16x64_bf16 v[116:119],v[24:27],v[136:143],v2
s_waitcnt lgkmcnt(2)
v_smfmac_f32_16x16x64_bf16 v[96:99],v[28:31],a[16:23],v2
s_add_u32 m0,s73,131072
v_smfmac_f32_16x16x64_bf16 v[100:103],v[28:31],a[144:151],v2
s_add_u32 s57,s67,8192
v_smfmac_f32_16x16x64_bf16 v[104:107],v[28:31],a[24:31],v2
s_cmp_lt_u32 s19,s76
s_cbranch_scc1 L_ckw_188
L_ckb_189:
v_smfmac_f32_16x16x64_bf16 v[108:111],v[28:31],a[152:159],v2
s_waitcnt vmcnt(0) lgkmcnt(1)
v_smfmac_f32_16x16x64_bf16 v[96:99],v[32:35],a[32:39],v2
ds_write_b128 v12,v[40:43] offset:4096
v_max3_u32 v123,v40,v41,v42
v_smfmac_f32_16x16x64_bf16 v[100:103],v[32:35],a[160:167],v2
v_max_u32 v123,v43,v123
v_smfmac_f32_16x16x64_bf16 v[104:107],v[32:35],a[40:47],v2
v_cmp_le_u32 vcc,s72,v123
v_smfmac_f32_16x16x64_bf16 v[108:111],v[32:35],a[168:175],v2
v_smfmac_f32_16x16x64_bf16 v[112:115],v[28:31],v[144:151],v2
s_cbranch_vccnz L_cpb_202
L_cback_204:
s_waitcnt lgkmcnt(0)
s_barrier
v_smfmac_f32_16x16x64_bf16 v[96:99],v[36:39],a[48:55],v2
buffer_store_dword v54,v10,s[8:11],s30 offen sc1
v_smfmac_f32_16x16x64_bf16 v[100:103],v[36:39],a[176:183],v2
ds_read_b128 v[44:47],v120 offset:4096
v_smfmac_f32_16x16x64_bf16 v[104:107],v[36:39],a[56:63],v2
buffer_load_dword v23,v22,s[8:11],s75 offen sc1
v_smfmac_f32_16x16x64_bf16 v[108:111],v[36:39],a[184:191],v2
ds_read_b128 v[48:51],v121 offset:4096
v_smfmac_f32_16x16x64_bf16 v[96:99],v[40:43],a[64:71],v2
buffer_load_dwordx4 v0,s[8:11],s67 offen sc1 lds
v_smfmac_f32_16x16x64_bf16 v[100:103],v[40:43],a[192:199],v2
ds_read_b128 v[52:55],v122 offset:4096
v_smfmac_f32_16x16x64_bf16 v[104:107],v[40:43],a[72:79],v2
buffer_store_dwordx4 v[124:127],v0,s[8:11],s54 offen sc1
v_smfmac_f32_16x16x64_bf16 v[108:111],v[40:43],a[200:207],v2
s_waitcnt lgkmcnt(2)
v_smfmac_f32_16x16x64_bf16 v[96:99],v[44:47],a[80:87],v2
buffer_load_dwordx4 v0,s[8:11],s67 offen offset:1024 sc1 lds
s_add_u32 m0,s73,139264
v_smfmac_f32_16x16x64_bf16 v[100:103],v[44:47],a[208:215],v2
s_waitcnt lgkmcnt(1)
v_smfmac_f32_16x16x64_bf16 v[96:99],v[48:51],a[96:103],v2
buffer_load_dwordx4 v0,s[8:11],s57 offen sc1 lds
s_add_u32 s67,s67,786432
v_smfmac_f32_16x16x64_bf16 v[100:103],v[48:51],a[224:231],v2
s_waitcnt lgkmcnt(0)
v_smfmac_f32_16x16x64_bf16 v[96:99],v[52:55],a[112:119],v2
buffer_load_dwordx4 v0,s[8:11],s57 offen offset:1024 sc1 lds
v_smfmac_f32_16x16x64_bf16 v[100:103],v[52:55],a[240:247],v2
v_smfmac_f32_16x16x64_bf16 v[104:107],v[44:47],a[88:95],v2
v_smfmac_f32_16x16x64_bf16 v[108:111],v[44:47],a[216:223],v2
v_smfmac_f32_16x16x64_bf16 v[104:107],v[48:51],a[104:111],v2
v_add_f32 v96,v96,v98
v_smfmac_f32_16x16x64_bf16 v[108:111],v[48:51],a[232:239],v2
v_add_f32 v97,v97,v99
v_smfmac_f32_16x16x64_bf16 v[104:107],v[52:55],a[120:127],v2
v_cvt_pk_bf16_f32 v120,v96,v97
v_smfmac_f32_16x16x64_bf16 v[108:111],v[52:55],a[248:255],v2
v_add_f32 v100,v100,v102
v_smfmac_f32_16x16x64_bf16 v[116:119],v[28:31],v[152:159],v2
v_add_f32 v101,v101,v103
v_smfmac_f32_16x16x64_bf16 v[112:115],v[32:35],v[160:167],v2
v_cvt_pk_bf16_f32 v121,v100,v101
v_add_f32 v104,v104,v106
v_add_f32 v105,v105,v107
v_cvt_pk_bf16_f32 v122,v104,v105
v_add_f32 v108,v108,v110
v_add_f32 v109,v109,v111
v_cvt_pk_bf16_f32 v123,v108,v109
ds_write_b128 v4,v[120:123]
v_smfmac_f32_16x16x64_bf16 v[116:119],v[32:35],v[168:175],v2
s_mov_b32 s54,s68
s_add_u32 s68,s68,131072
v_mov_b32 v125,0
v_smfmac_f32_16x16x64_bf16 v[112:115],v[36:39],v[176:183],v2
s_cmp_eq_u32 s51,63
s_cbranch_scc1 L_cend_198
v_smfmac_f32_16x16x64_bf16 v[116:119],v[36:39],v[184:191],v2
s_waitcnt lgkmcnt(0)
s_barrier
ds_read_b64_tr_b16 v[96:97],v5 offset:0
v_smfmac_f32_16x16x64_bf16 v[112:115],v[40:43],v[192:199],v2
ds_read_b64_tr_b16 v[98:99],v6 offset:0
v_smfmac_f32_16x16x64_bf16 v[116:119],v[40:43],v[200:207],v2
ds_read_b64_tr_b16 v[100:101],v5 offset:1024
v_smfmac_f32_16x16x64_bf16 v[112:115],v[44:47],v[208:215],v2
ds_read_b64_tr_b16 v[102:103],v6 offset:1024
v_smfmac_f32_16x16x64_bf16 v[116:119],v[44:47],v[216:223],v2
ds_read_b64_tr_b16 v[104:105],v5 offset:2048
v_smfmac_f32_16x16x64_bf16 v[112:115],v[48:51],v[224:231],v2
ds_read_b64_tr_b16 v[106:107],v6 offset:2048
s_waitcnt lgkmcnt(4)
v_mfma_f32_16x16x32_bf16 v[24:27],v[56:59],v[96:99],0
ds_read_b64_tr_b16 v[108:109],v5 offset:3072
v_mfma_f32_16x16x32_bf16 v[28:31],v[60:63],v[96:99],0
ds_read_b64_tr_b16 v[110:111],v6 offset:3072
v_mfma_f32_16x16x32_bf16 v[32:35],v[96:99],v[96:99],0
ds_read_b128 v[40:43],v11 offset:12288
s_waitcnt lgkmcnt(5)
v_mfma_f32_16x16x32_bf16 v[24:27],v[64:67],v[100:103],v[24:27]
ds_read_b128 v[56:59],v11 offset:0
v_mfma_f32_16x16x32_bf16 v[28:31],v[68:71],v[100:103],v[28:31]
ds_read_b128 v[60:63],v11 offset:1024
v_mfma_f32_16x16x32_bf16 v[32:35],v[100:103],v[100:103],v[32:35]
ds_read_b128 v[96:99],v11 offset:8192
s_waitcnt lgkmcnt(6)
v_mfma_f32_16x16x32_bf16 v[24:27],v[72:75],v[104:107],v[24:27]
ds_read_b128 v[64:67],v11 offset:2048
v_mfma_f32_16x16x32_bf16 v[28:31],v[76:79],v[104:107],v[28:31]
ds_read_b128 v[68:71],v11 offset:3072
v_mfma_f32_16x16x32_bf16 v[32:35],v[104:107],v[104:107],v[32:35]
ds_read_b128 v[100:103],v11 offset:9216
s_waitcnt lgkmcnt(7)
v_mfma_f32_16x16x32_bf16 v[24:27],v[80:83],v[108:111],v[24:27]
ds_read_b128 v[72:75],v11 offset:4096
v_mfma_f32_16x16x32_bf16 v[28:31],v[84:87],v[108:111],v[28:31]
ds_read_b128 v[76:79],v11 offset:5120
v_mfma_f32_16x16x32_bf16 v[32:35],v[108:111],v[108:111],v[32:35]
ds_read_b128 v[104:107],v11 offset:10240
v_smfmac_f32_16x16x64_bf16 v[116:119],v[48:51],v[232:239],v2
ds_read_b128 v[80:83],v11 offset:6144
v_smfmac_f32_16x16x64_bf16 v[112:115],v[52:55],v[240:247],v2
ds_read_b128 v[84:87],v11 offset:7168
v_smfmac_f32_16x16x64_bf16 v[116:119],v[52:55],v[248:255],v2
ds_read_b128 v[108:111],v11 offset:11264
v_max3_f32 v126,v24,v25,v26
v_max3_f32 v127,v27,v28,v29
v_max3_f32 v126,v30,v31,v126
v_max3_f32 v127,v34,v35,v127
v_max_f32 v126,v126,v127
v_max_f32 v127,v126,v127
v_pk_mul_f32 v[34:35],v[34:35],v[0:1] op_sel:[0,1]
v_pk_mul_f32 v[24:25],v[24:25],v[0:1] op_sel:[0,1]
v_permlane16_swap_b32 v126,v127
v_max_f32 v126,v126,v127
v_max_f32 v127,v126,v127
v_pk_add_f32 v[112:113],v[112:113],v[114:115]
v_pk_add_f32 v[116:117],v[116:117],v[118:119]
v_permlane32_swap_b32 v126,v127
v_max_f32 v126,v126,v127
v_mul_f32 v126,v1,v126
v_pk_add_f32 v[34:35],v[34:35],v[126:127] op_sel_hi:[1,0] neg_lo:[0,1] neg_hi:[0,1]
v_pk_add_f32 v[24:25],v[24:25],v[126:127] op_sel_hi:[1,0] neg_lo:[0,1] neg_hi:[0,1]
v_pk_fma_f32 v[26:27],v[26:27],v[0:1],v[126:127] op_sel:[0,1,0] op_sel_hi:[1,1,0] neg_lo:[0,0,1] neg_hi:[0,0,1]
v_pk_fma_f32 v[28:29],v[28:29],v[0:1],v[126:127] op_sel:[0,1,0] op_sel_hi:[1,1,0] neg_lo:[0,0,1] neg_hi:[0,0,1]
v_pk_fma_f32 v[30:31],v[30:31],v[0:1],v[126:127] op_sel:[0,1,0] op_sel_hi:[1,1,0] neg_lo:[0,0,1] neg_hi:[0,0,1]
v_exp_f32 v34,v34
v_exp_f32 v35,v35
v_cvt_pk_bf16_f32 v126,v112,v113
v_cvt_pk_bf16_f32 v124,v34,v35
v_cvt_pk_bf16_f32 v127,v116,v117
v_cvt_pk_bf16_f32 v36,v116,v117
v_mfma_f32_16x16x16_bf16 v[32:35],v[14:15],v[124:125],0
ds_read_b128 v[44:47],v11 offset:13312
v_exp_f32 v24,v24
v_mfma_f32_16x16x16_bf16 v[112:115],v[126:127],v[124:125],0
ds_read_b128 v[48:51],v11 offset:14336
v_exp_f32 v25,v25
v_mfma_f32_16x16x16_bf16 v[116:119],v[36:37],v[124:125],0
ds_read_b128 v[52:55],v11 offset:15360
v_exp_f32 v26,v26
v_exp_f32 v27,v27
v_cvt_pk_bf16_f32 v120,v24,v25
v_exp_f32 v28,v28
v_exp_f32 v29,v29
v_cvt_pk_bf16_f32 v121,v26,v27
v_exp_f32 v30,v30
v_exp_f32 v31,v31
v_cvt_pk_bf16_f32 v122,v28,v29
v_cvt_pk_bf16_f32 v123,v30,v31
s_add_u32 s75,s75,8192
s_add_u32 s51,s51,1
v_mfma_f32_16x16x32_bf16 v[32:35],v[14:17],v[120:123],v[32:35]
v_mfma_f32_16x16x32_bf16 v[112:115],v[88:91],v[120:123],v[112:115]
ds_read_b128 v[88:91],v11 offset:16384
v_mfma_f32_16x16x32_bf16 v[116:119],v[92:95],v[120:123],v[116:119]
ds_read_b128 v[92:95],v11 offset:17408
v_rcp_f32 v32,v32
v_mov_b64 v[24:25],-1
v_mov_b64 v[26:27],-1
s_add_u32 s64,s75,12582912
s_add_u32 s70,s64,4096
v_pk_mul_f32 v[112:113],v[112:113],v[32:33] op_sel_hi:[1,0]
v_pk_mul_f32 v[114:115],v[114:115],v[32:33] op_sel_hi:[1,0]
v_pk_mul_f32 v[116:117],v[116:117],v[32:33] op_sel_hi:[1,0]
v_pk_mul_f32 v[118:119],v[118:119],v[32:33] op_sel_hi:[1,0]
v_cvt_pk_bf16_f32 v120,v112,v116
v_cvt_pk_bf16_f32 v121,v113,v117
v_cvt_pk_bf16_f32 v122,v114,v118
v_cvt_pk_bf16_f32 v123,v115,v119
ds_write_b128 v7,v[120:123]
buffer_store_dwordx4 v[24:27],v0,s[8:11],s69 offen
buffer_store_dwordx4 v[24:27],v0,s[8:11],s69 offen offset:1024
v_mov_b64 v[112:113],0
v_mov_b64 v[114:115],0
v_mov_b64 v[116:117],0
v_mov_b64 v[118:119],0
s_waitcnt lgkmcnt(0)
s_barrier
ds_read_b128 v[24:27],v8 offset:0
ds_read_b128 v[28:31],v8 offset:512
ds_read_b128 v[32:35],v8 offset:1024
ds_read_b128 v[36:39],v8 offset:1536
v_mov_b64 v[120:121],0
v_mov_b64 v[122:123],0
s_add_u32 s57,s65,65536
s_add_u32 s58,s65,131072
s_add_u32 s59,s65,196608
s_add_u32 s56,s18,s75
s_add_u32 s30,s75,17825792
s_waitcnt lgkmcnt(3)
v_smfmac_f32_16x16x64_bf16 v[112:115],v[24:27],v[56:63],v3
ds_read_b128 v[56:59],v11 offset:18432
s_waitcnt lgkmcnt(3)
v_smfmac_f32_16x16x64_bf16 v[112:115],v[28:31],v[64:71],v3
ds_read_b128 v[60:63],v11 offset:19456
s_waitcnt lgkmcnt(3)
v_smfmac_f32_16x16x64_bf16 v[112:115],v[32:35],v[72:79],v3
ds_read_b128 v[64:67],v11 offset:20480
s_waitcnt lgkmcnt(3)
v_smfmac_f32_16x16x64_bf16 v[112:115],v[36:39],v[80:87],v3
ds_read_b128 v[68:71],v11 offset:21504
v_smfmac_f32_16x16x64_bf16 v[116:119],v[24:27],v[96:103],v3
ds_read_b128 v[72:75],v11 offset:22528
v_smfmac_f32_16x16x64_bf16 v[116:119],v[28:31],v[104:111],v3
ds_read_b128 v[76:79],v11 offset:23552
v_cvt_pk_bf16_f32 v112,v112,v113
v_smfmac_f32_16x16x64_bf16 v[116:119],v[32:35],v[40:47],v3
ds_read_b128 v[80:83],v11 offset:24576
v_cvt_pk_bf16_f32 v113,v114,v115
buffer_store_dwordx2 v[112:113],v9,s[8:11],s65 offen
v_smfmac_f32_16x16x64_bf16 v[116:119],v[36:39],v[48:55],v3
ds_read_b128 v[84:87],v11 offset:25600
v_mov_b64 v[112:113],0
v_smfmac_f32_16x16x64_bf16 v[120:123],v[24:27],v[88:95],v3
ds_read_b128 v[96:99],v11 offset:26624
ds_read_b128 v[100:103],v11 offset:27648
v_mov_b64 v[114:115],0
s_waitcnt lgkmcnt(8)
v_smfmac_f32_16x16x64_bf16 v[120:123],v[28:31],v[56:63],v3
ds_read_b128 v[104:107],v11 offset:28672
v_cvt_pk_bf16_f32 v116,v116,v117
s_waitcnt lgkmcnt(7)
v_smfmac_f32_16x16x64_bf16 v[120:123],v[32:35],v[64:71],v3
ds_read_b128 v[108:111],v11 offset:29696
ds_read_b128 v[40:43],v11 offset:30720
v_cvt_pk_bf16_f32 v117,v118,v119
buffer_store_dwordx2 v[116:117],v9,s[8:11],s57 offen
s_waitcnt lgkmcnt(7)
v_smfmac_f32_16x16x64_bf16 v[120:123],v[36:39],v[72:79],v3
ds_read_b128 v[44:47],v11 offset:31744
v_add_u32 v52,s50,v5
s_waitcnt lgkmcnt(6)
v_smfmac_f32_16x16x64_bf16 v[112:115],v[24:27],v[80:87],v3
v_add_u32 v54,s50,v6
s_waitcnt lgkmcnt(4)
v_smfmac_f32_16x16x64_bf16 v[112:115],v[28:31],v[96:103],v3
ds_read_b64_tr_b16 v[52:53],v52
v_cvt_pk_bf16_f32 v120,v120,v121
s_waitcnt lgkmcnt(3)
v_smfmac_f32_16x16x64_bf16 v[112:115],v[32:35],v[104:111],v3
ds_read_b64_tr_b16 v[54:55],v54
v_cvt_pk_bf16_f32 v121,v122,v123
buffer_store_dwordx2 v[120:121],v9,s[8:11],s58 offen
s_waitcnt lgkmcnt(2)
v_smfmac_f32_16x16x64_bf16 v[112:115],v[36:39],v[40:47],v3
v_mov_b64 v[116:117],0
v_mov_b64 v[118:119],0
s_xor_b32 s65,s65,262144
v_mov_b32_dpp v124,v126 quad_perm:[2,3,2,3] row_mask:0xf bank_mask:0xf
v_mov_b32_dpp v125,v127 quad_perm:[2,3,2,3] row_mask:0xf bank_mask:0xf
s_mov_b32 vcc_lo,0xcccccccc
s_mov_b32 vcc_hi,0xcccccccc
s_nop 0
v_cvt_pk_bf16_f32 v112,v112,v113
v_cvt_pk_bf16_f32 v113,v114,v115
buffer_store_dwordx2 v[112:113],v9,s[8:11],s59 offen
s_waitcnt lgkmcnt(0)
s_buffer_load_dword s19,s[8:11],s56
v_cndmask_b32 v124,v124,v52,vcc
v_cndmask_b32 v125,v125,v53,vcc
s_cmp_lt_u32 s46,2
s_waitcnt vmcnt(3)
s_cbranch_scc1 L_crg_205
s_cmp_eq_u32 s46,2
s_waitcnt vmcnt(1)
s_cbranch_scc1 L_crg_205
s_waitcnt vmcnt(0)
L_crg_205:
buffer_load_dwordx4 v[32:35],v0,s[8:11],s66 offen offset:0 sc1
buffer_load_dwordx4 v[36:39],v0,s[8:11],s66 offen offset:1024 sc1
v_cndmask_b32 v126,v126,v54,vcc
v_cndmask_b32 v127,v127,v55,vcc
v_mov_b64 v[96:97],0
v_mov_b64 v[98:99],0
v_mov_b64 v[100:101],0
v_mov_b64 v[102:103],0
v_mov_b64 v[104:105],0
v_mov_b64 v[106:107],0
v_mov_b64 v[108:109],0
v_mov_b64 v[110:111],0
v_mov_b64 v[112:113],0
v_mov_b64 v[114:115],0
v_add_u32 v55,131072,v0
v_add_u32 v123,s73,v55
v_xor_b32 v120,1024,v12
v_xor_b32 v121,2048,v12
v_xor_b32 v122,3072,v12
buffer_load_dwordx4 v[44:47],v0,s[8:11],s66 offen offset:0 sc1
buffer_load_dwordx4 v[48:51],v0,s[8:11],s66 offen offset:1024 sc1
s_cmp_ge_u32 s51,63
s_cselect_b32 s76,0,1
s_cmp_eq_u32 s46,0
s_cselect_b32 s76,s76,0
s_waitcnt vmcnt(3)
v_mfma_f32_16x16x32_bf16 v[28:31],v[18:21],v[32:35],0
s_waitcnt vmcnt(2)
v_mfma_f32_16x16x32_bf16 v[28:31],v[18:21],v[36:39],v[28:31]
s_nop 7
v_cmp_u_f32 vcc,v28,v28
v_add_f32_dpp v52,v28,v28 row_ror:8 row_mask:0xf bank_mask:0x3
v_add_f32_dpp v53,v29,v29 row_ror:8 row_mask:0xf bank_mask:0x3
v_add_f32_dpp v52,v30,v30 row_ror:8 row_mask:0xf bank_mask:0xc
v_add_f32_dpp v53,v31,v31 row_ror:8 row_mask:0xf bank_mask:0xc
s_cbranch_vccnz L_crp_200
L_cok_206:
v_add_f32_dpp v52,v52,v52 row_shl:4 row_mask:0xf bank_mask:0x5
v_add_f32_dpp v53,v53,v53 row_shl:4 row_mask:0xf bank_mask:0x5
v_cvt_pk_bf16_f32 v54,v52,v53
buffer_store_dword v54,v10,s[8:11],s64 offen
s_mov_b32 s69,s66
s_xor_b32 s66,s66,262144
s_barrier
ds_read_b128 v[56:59],v55 offset:0
ds_read_b128 v[60:63],v55 offset:4096
ds_read_b128 v[64:67],v55 offset:1024
buffer_load_dwordx4 v[24:27],v13,s[8:11],s64 offen sc1
ds_read_b128 v[68:71],v55 offset:5120
ds_read_b128 v[72:75],v55 offset:2048
ds_read_b128 v[76:79],v55 offset:6144
ds_read_b128 v[80:83],v55 offset:3072
buffer_load_dwordx4 v[24:27],v13,s[8:11],s64 offen sc1
ds_read_b128 v[84:87],v55 offset:7168
ds_read_b128 v[88:91],v123 offset:8192
ds_read_b128 v[92:95],v123 offset:9216
s_branch L_chain_195
L_cpb_202:
buffer_load_dwordx4 v[40:43],v13,s[8:11],s70 offen sc1
s_sub_u32 s49,s49,1
s_cbranch_scc1 L_abort
s_waitcnt vmcnt(0)
v_max3_u32 v123,v40,v41,v42
v_max_u32 v123,v43,v123
v_cmp_le_u32 vcc,s72,v123
s_cbranch_vccnz L_cpb_202
ds_write_b128 v12,v[40:43] offset:4096
s_branch L_cback_204
L_crp_200:
buffer_load_dwordx4 v[32:35],v0,s[8:11],s66 offen offset:0 sc1
buffer_load_dwordx4 v[36:39],v0,s[8:11],s66 offen offset:1024 sc1
s_sub_u32 s49,s49,1
s_cbranch_scc1 L_abort
s_waitcnt vmcnt(3)
v_mfma_f32_16x16x32_bf16 v[28:31],v[18:21],v[44:47],0
s_waitcnt vmcnt(2)
v_mfma_f32_16x16x32_bf16 v[28:31],v[18:21],v[48:51],v[28:31]
s_nop 7
v_cmp_u_f32 vcc,v28,v28
v_add_f32_dpp v52,v28,v28 row_ror:8 row_mask:0xf bank_mask:0x3
v_add_f32_dpp v53,v29,v29 row_ror:8 row_mask:0xf bank_mask:0x3
v_add_f32_dpp v52,v30,v30 row_ror:8 row_mask:0xf bank_mask:0xc
v_add_f32_dpp v53,v31,v31 row_ror:8 row_mask:0xf bank_mask:0xc
s_cbranch_vccz L_cok_206
buffer_load_dwordx4 v[44:47],v0,s[8:11],s66 offen offset:0 sc1
buffer_load_dwordx4 v[48:51],v0,s[8:11],s66 offen offset:1024 sc1
s_sub_u32 s49,s49,1
s_cbranch_scc1 L_abort
s_waitcnt vmcnt(3)
v_mfma_f32_16x16x32_bf16 v[28:31],v[18:21],v[32:35],0
s_waitcnt vmcnt(2)
v_mfma_f32_16x16x32_bf16 v[28:31],v[18:21],v[36:39],v[28:31]
s_nop 7
v_cmp_u_f32 vcc,v28,v28
v_add_f32_dpp v52,v28,v28 row_ror:8 row_mask:0xf bank_mask:0x3
v_add_f32_dpp v53,v29,v29 row_ror:8 row_mask:0xf bank_mask:0x3
v_add_f32_dpp v52,v30,v30 row_ror:8 row_mask:0xf bank_mask:0xc
v_add_f32_dpp v53,v31,v31 row_ror:8 row_mask:0xf bank_mask:0xc
s_cbranch_vccz L_cok_206
s_branch L_crp_200
L_ckw_188:
s_add_u32 s59,s18,s75
L_ww_207:
buffer_load_dword v23,off,s[8:11],s59 sc1
s_sub_u32 s49,s49,1
s_cbranch_scc1 L_abort
s_waitcnt vmcnt(0)
v_readfirstlane_b32 s76,v23
s_cmp_eq_u32 s76,0
s_cbranch_scc1 L_ww_207
L_wwd_208:
s_branch L_ckb_189
L_cend_198:
v_smfmac_f32_16x16x64_bf16 v[116:119],v[36:39],v[184:191],v2
v_smfmac_f32_16x16x64_bf16 v[112:115],v[40:43],v[192:199],v2
v_smfmac_f32_16x16x64_bf16 v[116:119],v[40:43],v[200:207],v2
v_smfmac_f32_16x16x64_bf16 v[112:115],v[44:47],v[208:215],v2
v_smfmac_f32_16x16x64_bf16 v[116:119],v[44:47],v[216:223],v2
v_smfmac_f32_16x16x64_bf16 v[112:115],v[48:51],v[224:231],v2
v_smfmac_f32_16x16x64_bf16 v[116:119],v[48:51],v[232:239],v2
v_smfmac_f32_16x16x64_bf16 v[112:115],v[52:55],v[240:247],v2
v_smfmac_f32_16x16x64_bf16 v[116:119],v[52:55],v[248:255],v2
s_waitcnt lgkmcnt(0)
s_nop 2
v_pk_add_f32 v[112:113],v[112:113],v[114:115]
s_nop 2
v_pk_add_f32 v[116:117],v[116:117],v[118:119]
v_cvt_pk_bf16_f32 v126,v112,v113
v_cvt_pk_bf16_f32 v127,v116,v117
v_add_u32 v52,s50,v5
v_add_u32 v54,s50,v6
ds_read_b64_tr_b16 v[52:53],v52
ds_read_b64_tr_b16 v[54:55],v54
v_mov_b32_dpp v124,v126 quad_perm:[2,3,2,3] row_mask:0xf bank_mask:0xf
v_mov_b32_dpp v125,v127 quad_perm:[2,3,2,3] row_mask:0xf bank_mask:0xf
s_mov_b32 vcc_lo,0xcccccccc
s_mov_b32 vcc_hi,0xcccccccc
s_waitcnt lgkmcnt(0)
v_cndmask_b32 v124,v124,v52,vcc
v_cndmask_b32 v125,v125,v53,vcc
v_cndmask_b32 v126,v126,v54,vcc
v_cndmask_b32 v127,v127,v55,vcc
buffer_store_dwordx4 v[124:127],v0,s[8:11],s54 offen sc1
s_mov_b32 s51,64
s_waitcnt vmcnt(0)
s_barrier
s_nop 11
v_lshrrev_b32 v1,4,v0
s_endpgm
L_rc2_158:
v_and_b32 v120,15,v1
v_lshrrev_b32 v121,4,v1
v_and_b32 v122,2,v1
v_cmp_eq_u32 vcc,0,v122
v_mov_b32 v2,0xeeee
v_mov_b32 v123,0x4444
v_cndmask_b32 v2,v2,v123,vcc
v_and_b32 v122,1,v1
v_cmp_eq_u32 vcc,0,v122
v_mov_b32 v3,0xdddd
v_mov_b32 v123,0x8888
v_cndmask_b32 v3,v3,v123,vcc
v_lshrrev_b32 v122,1,v120
v_bfe_u32 v123,v120,2,1
v_xor_b32 v123,v123,v122
v_lshlrev_b32 v4,7,v123
v_and_b32 v123,1,v120
v_lshl_add_u32 v4,v123,6,v4
v_xor_b32 v123,v121,v122
v_and_b32 v123,3,v123
v_lshl_add_u32 v4,v123,4,v4
s_lshl_b32 s56,s46,10
s_add_u32 s56,s56,147456
v_add_u32 v4,s56,v4
v_lshlrev_b32 v122,1,v121
v_add_u32 v122,0,v122
v_and_b32 v123,1,v121
v_xor_b32 v123,v123,v122
v_lshlrev_b32 v5,7,v123
v_bfe_u32 v123,v120,3,1
v_lshl_add_u32 v5,v123,6,v5
v_xor_b32 v123,v120,v122
v_and_b32 v123,3,v123
v_lshl_add_u32 v5,v123,4,v5
v_bfe_u32 v123,v120,2,1
v_lshl_add_u32 v5,v123,3,v5
v_add_u32 v5,147456,v5
v_lshlrev_b32 v122,1,v121
v_add_u32 v122,1,v122
v_and_b32 v123,1,v121
v_xor_b32 v123,v123,v122
v_lshlrev_b32 v6,7,v123
v_bfe_u32 v123,v120,3,1
v_lshl_add_u32 v6,v123,6,v6
v_xor_b32 v123,v120,v122
v_and_b32 v123,3,v123
v_lshl_add_u32 v6,v123,4,v6
v_bfe_u32 v123,v120,2,1
v_lshl_add_u32 v6,v123,3,v6
v_add_u32 v6,147456,v6
v_lshlrev_b32 v7,7,v121
v_lshrrev_b32 v122,1,v120
v_lshl_add_u32 v8,v122,4,v7
v_add_u32 v8,151552,v8
v_lshrrev_b32 v122,2,v120
v_lshl_add_u32 v7,v122,5,v7
v_and_b32 v122,1,v120
v_lshl_add_u32 v7,v122,4,v7
v_and_b32 v122,2,v120
v_cmp_eq_u32 vcc,0,v122
s_lshl_b32 s56,s46,9
v_mov_b32 v122,2048
v_mov_b32 v123,s56
v_cndmask_b32 v122,v122,v123,vcc
v_add_u32 v7,v122,v7
v_add_u32 v7,151552,v7
v_lshrrev_b32 v122,3,v1
v_lshlrev_b32 v9,11,v122
v_and_b32 v122,7,v1
v_lshl_add_u32 v9,v122,3,v9
s_lshl_b32 s56,s46,14
s_lshl_b32 s57,s47,6
s_add_u32 s56,s56,s57
v_add_u32 v9,s56,v9
s_lshl_b32 s71,s46,5
s_add_u32 s71,s71,s47
s_bfe_u32 s56,s71,0x10003
s_lshl_b32 s56,s56,11
s_and_b32 s57,s71,1
s_lshl_b32 s57,s57,10
s_add_u32 s56,s56,s57
s_bfe_u32 s57,s71,0x10002
s_lshl_b32 s57,s57,9
s_add_u32 s56,s56,s57
s_bfe_u32 s57,s71,0x10001
s_lshl_b32 s57,s57,6
s_add_u32 s56,s56,s57
s_bfe_u32 s57,s71,0x10004
s_lshl_b32 s57,s57,8
s_add_u32 s56,s56,s57
s_bfe_u32 s57,s71,0x10005
s_lshl_b32 s57,s57,7
s_add_u32 s56,s56,s57
s_bfe_u32 s57,s71,0x10006
s_lshl_b32 s57,s57,12
s_add_u32 s56,s56,s57
v_and_b32 v122,3,v120
v_lshlrev_b32 v10,2,v122
v_bfe_u32 v122,v120,3,1
v_lshl_add_u32 v10,v122,4,v10
v_and_b32 v122,1,v121
v_lshl_add_u32 v10,v122,5,v10
v_add_u32 v10,s56,v10
v_and_b32 v123,36,v1
v_mov_b32 v122,0x80000000
v_cmp_eq_u32 vcc,0,v123
s_nop 1
v_cndmask_b32 v10,v122,v10,vcc
s_lshl_b32 s71,s71,11
s_lshl_b32 s73,s46,11
s_mov_b32 s72,0xffc00000
s_mov_b32 s74,0
v_and_b32 v11,1,v121
v_xor_b32 v11,v11,v120
v_and_b32 v11,3,v11
v_lshrrev_b32 v122,2,v120
v_lshl_add_u32 v11,v11,2,v122
v_lshl_add_u32 v11,v121,4,v11
v_lshlrev_b32 v11,4,v11
s_lshl_b32 s56,s46,15
v_add_u32 v11,s56,v11
v_lshrrev_b32 v13,3,v1
v_lshlrev_b32 v13,9,v13
v_and_b32 v122,7,v1
v_lshl_add_u32 v13,v122,4,v13
v_and_b32 v122,15,v1
v_and_b32 v123,1,v1
v_lshlrev_b32 v123,4,v123
v_mov_b32 v124,0x3f80
v_lshlrev_b32 v124,v123,v124
v_lshrrev_b32 v122,1,v122
v_cmp_eq_u32 vcc,0,v122
s_nop 1
v_cndmask_b32 v18,0,v124,vcc
v_cmp_eq_u32 vcc,1,v122
s_nop 1
v_cndmask_b32 v19,0,v124,vcc
v_cmp_eq_u32 vcc,2,v122
s_nop 1
v_cndmask_b32 v20,0,v124,vcc
v_cmp_eq_u32 vcc,3,v122
s_nop 1
v_cndmask_b32 v21,0,v124,vcc
s_and_b32 s56,s46,1
s_lshl_b32 s56,s56,8
s_and_b32 s57,s46,2
s_lshl_b32 s57,s57,6
s_add_u32 s56,s56,s57
v_add_u32 v13,s56,v13
s_add_u32 s56,s50,155648
v_add_u32 v12,s56,v0
v_mov_b64 v[14:15],s[28:29]
v_mov_b64 v[16:17],s[28:29]
v_add_u32 v22,13647872,v10
s_lshl_b32 s18,s47,2
s_add_u32 s18,s18,10494080
v_mov_b32 v1,s80
s_mov_b32 s65,16777216
s_add_u32 s66,s71,16777216
s_add_u32 s69,s71,17039360
s_mov_b32 s30,0x40000000
s_mov_b32 s51,0
v_lshrrev_b32 v120,2,v0
v_add_u32 v120,10510464,v120
v_or_b32 v120,s52,v120
s_mov_b64 vcc,-1
s_mov_b32 vcc_lo,0
v_cndmask_b32 v22,v22,v120,vcc
s_or_b32 s56,s52,10495616
v_writelane_b32 v22,s56,4
s_or_b32 s56,s47,s46
s_mov_b32 s56,10486784
s_cmov_b32 s56,0x80000000
v_writelane_b32 v22,s56,5
s_mov_b32 s30,0
s_mov_b32 s31,0
buffer_load_dwordx4 v[88:91],v0,s[8:11],s66 offen offset:0
buffer_load_dwordx4 v[88:91],v0,s[8:11],s66 offen offset:1024
buffer_load_dwordx4 v[88:91],v0,s[8:11],s69 offen offset:0
buffer_load_dwordx4 v[88:91],v0,s[8:11],s69 offen offset:1024
s_waitcnt vmcnt(0)
L_cst_212:
s_cmp_lg_u32 s46,0
s_cbranch_scc1 L_csw_217
s_andn2_b32 s61,0x7ff,s30
s_lshr_b32 s61,s61,5
s_add_u32 s61,s61,2
s_add_u32 s60,s31,1
s_min_u32 s60,s60,63
s_cmp_gt_u32 s60,s61
s_cselect_b32 s60,s31,s60
s_sub_u32 s61,s60,s31
s_lshl_b32 s61,s61,13
s_lshl_b32 s59,s31,13
s_add_u32 s59,s59,10486016
v_lshrrev_b32 v121,2,v0
v_and_b32 v121,127,v121
v_lshrrev_b32 v120,9,v0
v_mul_u32_u24 v120,s61,v120
v_add_u32 v121,v120,v121
L_ckk_218:
s_sleep 1
buffer_load_dword v120,v121,s[8:11],s59 offen sc1
s_sub_u32 s49,s49,1
s_cbranch_scc1 L_abort
s_waitcnt vmcnt(0)
v_cmp_eq_u32 vcc,0,v120
s_cbranch_vccnz L_ckk_218
v_max_u32_dpp v120,v120,v120 row_ror:8 row_mask:0xf bank_mask:0xf
s_nop 1
v_max_u32_dpp v120,v120,v120 row_ror:4 row_mask:0xf bank_mask:0xf
s_nop 1
v_max_u32_dpp v120,v120,v120 row_ror:2 row_mask:0xf bank_mask:0xf
s_nop 1
v_max_u32_dpp v120,v120,v120 row_ror:1 row_mask:0xf bank_mask:0xf
v_mov_b32 v121,v120
s_nop 1
v_permlane16_swap_b32 v120,v121
v_max_u32 v120,v120,v121
v_mov_b32 v121,v120
s_nop 1
v_permlane32_swap_b32 v120,v121
v_max_u32 v120,v120,v121
s_nop 0
v_readfirstlane_b32 s61,v120
s_max_u32 s30,s30,s61
s_add_u32 s31,s60,1
s_andn2_b32 s51,0x7ff,s30
s_lshr_b32 s51,s51,5
s_add_u32 s61,s51,2
s_min_u32 s61,s61,63
s_cmp_le_u32 s31,s61
s_cbranch_scc1 L_cst_212
v_mov_b32 v120,0
v_mov_b32 v121,s30
ds_write_b32 v8,v120 offset:2560
ds_write_b32 v8,v121 offset:3072
s_lshl_b32 s59,s51,13
s_lshl2_add_u32 s59,s47,s59
s_add_u32 s59,s59,10485888
L_ww_219:
s_sleep 1
buffer_load_dword v122,off,s[8:11],s59 sc1
s_sub_u32 s49,s49,1
s_cbranch_scc1 L_abort
s_waitcnt vmcnt(0)
v_readfirstlane_b32 s61,v122
s_cmp_eq_u32 s61,0
s_cbranch_scc1 L_ww_219
L_wwd_220:
L_csw_217:
s_waitcnt lgkmcnt(0)
s_barrier
ds_read_b32 v120,v8 offset:3072
s_waitcnt lgkmcnt(0)
v_readfirstlane_b32 s30,v120
s_andn2_b32 s51,0x7ff,s30
s_lshr_b32 s51,s51,5
s_lshl_b32 s56,s51,5
s_add_u32 s56,s56,s47
s_mul_i32 s56,s56,24576
s_add_u32 s56,s56,150994944
s_add_u32 s67,s56,s73
s_add_u32 m0,s73,131072
s_add_u32 s57,s67,8192
buffer_load_dwordx4 v0,s[8:11],s67 offen sc1 lds
buffer_load_dwordx4 v0,s[8:11],s67 offen offset:1024 sc1 lds
s_add_u32 m0,s73,139264
s_add_u32 s67,s67,786432
buffer_load_dwordx4 v0,s[8:11],s57 offen sc1 lds
buffer_load_dwordx4 v0,s[8:11],s57 offen offset:1024 sc1 lds
s_lshl_b32 s75,s51,13
s_add_u32 s56,s75,13639680
buffer_load_dword v23,v10,s[8:11],s56 offen sc1
s_add_u32 s64,s75,17825792
s_add_u32 s70,s64,4096
s_lshl_b32 s68,s51,5
s_add_u32 s68,s68,s47
s_lshl_b32 s68,s68,12
s_lshl_b32 s56,s46,10
s_add_u32 s68,s68,s56
s_add_u32 s68,s68,75497472
s_mov_b32 s54,0x80000000
s_mov_b32 s77,0
s_add_u32 s56,s18,s75
s_buffer_load_dword s19,s[8:11],s56
s_cmp_eq_u32 s51,63
s_cselect_b32 s76,1,s46
s_cmp_eq_u32 s76,0
s_cselect_b32 s76,1,0
v_mov_b64 v[96:97],0
v_mov_b64 v[98:99],0
v_mov_b64 v[100:101],0
v_mov_b64 v[102:103],0
v_mov_b64 v[104:105],0
v_mov_b64 v[106:107],0
v_mov_b64 v[108:109],0
v_mov_b64 v[110:111],0
v_mov_b64 v[112:113],0
v_mov_b64 v[114:115],0
v_mov_b64 v[116:117],0
v_mov_b64 v[118:119],0
v_lshrrev_b32 v56,8,v0
v_lshlrev_b32 v56,5,v56
v_bfe_u32 v57,v0,5,1
v_lshl_add_u32 v56,v57,2,v56
s_lshl_b32 s56,s46,7
s_add_u32 s56,s56,155648
v_add_u32 v56,s56,v56
v_xor_b32 v57,128,v56
v_xor_b32 v58,256,v56
v_xor_b32 v59,384,v56
s_andn2_b32 s56,31,s30
s_lshr_b32 s57,s56,4
s_lshl_b32 s58,s57,12
s_and_b32 s59,s56,15
s_lshl4_add_u32 s58,s59,s58
s_add_u32 s58,s58,s50
s_add_u32 s58,s58,131072
v_bfe_u32 v60,v0,6,2
v_lshlrev_b32 v60,8,v60
v_bfe_u32 v61,v0,4,2
v_lshl_add_u32 v60,v61,2,v60
v_add_u32 v60,s58,v60
s_lshr_b32 s58,s59,2
s_lshl_b32 s58,s58,8
s_lshl3_add_u32 s58,s57,s58
s_and_b32 s59,s56,3
s_lshl1_add_u32 s58,s59,s58
s_add_u32 s58,s58,s73
s_add_u32 s58,s58,139264
v_and_b32 v61,255,v0
v_add_u32 v61,s58,v61
s_cmp_lg_u32 s46,0
s_cbranch_scc1 L_chd_222
s_lshl_b32 s59,s51,10
s_add_u32 s59,s59,11337728
L_chp_221:
buffer_load_dwordx4 v[120:123],v0,s[8:11],s59 offen sc1
s_sub_u32 s49,s49,1
s_cbranch_scc1 L_abort
s_waitcnt vmcnt(0)
v_max3_u32 v124,v120,v121,v122
v_max_u32 v124,v123,v124
v_cmp_eq_u32 vcc,-1,v124
s_cbranch_vccnz L_chp_221
ds_write_b128 v12,v[120:123]
L_chd_222:
s_waitcnt vmcnt(0) lgkmcnt(0)
s_barrier
ds_read2_b32 v[24:25],v56 offset0:0 offset1:2
ds_read2_b32 v[26:27],v56 offset0:4 offset1:6
ds_read2_b32 v[28:29],v57 offset0:0 offset1:2
ds_read2_b32 v[30:31],v57 offset0:4 offset1:6
ds_read2_b32 v[32:33],v58 offset0:0 offset1:2
ds_read2_b32 v[34:35],v58 offset0:4 offset1:6
ds_read2_b32 v[36:37],v59 offset0:0 offset1:2
ds_read2_b32 v[38:39],v59 offset0:4 offset1:6
s_waitcnt lgkmcnt(4)
ds_read2_b32 v[40:41],v56 offset0:128 offset1:130
ds_read2_b32 v[42:43],v56 offset0:132 offset1:134
ds_read2_b32 v[44:45],v57 offset0:128 offset1:130
ds_read2_b32 v[46:47],v57 offset0:132 offset1:134
ds_read2_b32 v[48:49],v58 offset0:128 offset1:130
ds_read2_b32 v[50:51],v58 offset0:132 offset1:134
ds_read2_b32 v[52:53],v59 offset0:128 offset1:130
ds_read2_b32 v[54:55],v59 offset0:132 offset1:134
s_waitcnt lgkmcnt(12)
v_smfmac_f32_16x16x64_bf16 v[100:103],v[24:27],a[128:135],v2
v_smfmac_f32_16x16x64_bf16 v[112:115],v[24:27],v[128:135],v2
v_smfmac_f32_16x16x64_bf16 v[108:111],v[24:27],a[136:143],v2
v_smfmac_f32_16x16x64_bf16 v[116:119],v[24:27],v[136:143],v2
s_waitcnt lgkmcnt(12)
v_smfmac_f32_16x16x64_bf16 v[100:103],v[28:31],a[144:151],v2
v_smfmac_f32_16x16x64_bf16 v[112:115],v[28:31],v[144:151],v2
v_smfmac_f32_16x16x64_bf16 v[108:111],v[28:31],a[152:159],v2
v_smfmac_f32_16x16x64_bf16 v[116:119],v[28:31],v[152:159],v2
s_waitcnt lgkmcnt(10)
v_smfmac_f32_16x16x64_bf16 v[100:103],v[32:35],a[160:167],v2
v_smfmac_f32_16x16x64_bf16 v[112:115],v[32:35],v[160:167],v2
v_smfmac_f32_16x16x64_bf16 v[108:111],v[32:35],a[168:175],v2
v_smfmac_f32_16x16x64_bf16 v[116:119],v[32:35],v[168:175],v2
s_waitcnt lgkmcnt(8)
v_smfmac_f32_16x16x64_bf16 v[100:103],v[36:39],a[176:183],v2
v_smfmac_f32_16x16x64_bf16 v[112:115],v[36:39],v[176:183],v2
v_smfmac_f32_16x16x64_bf16 v[108:111],v[36:39],a[184:191],v2
v_smfmac_f32_16x16x64_bf16 v[116:119],v[36:39],v[184:191],v2
s_waitcnt lgkmcnt(6)
v_smfmac_f32_16x16x64_bf16 v[100:103],v[40:43],a[192:199],v2
v_smfmac_f32_16x16x64_bf16 v[112:115],v[40:43],v[192:199],v2
v_smfmac_f32_16x16x64_bf16 v[108:111],v[40:43],a[200:207],v2
v_smfmac_f32_16x16x64_bf16 v[116:119],v[40:43],v[200:207],v2
s_waitcnt lgkmcnt(4)
v_smfmac_f32_16x16x64_bf16 v[100:103],v[44:47],a[208:215],v2
v_smfmac_f32_16x16x64_bf16 v[112:115],v[44:47],v[208:215],v2
v_smfmac_f32_16x16x64_bf16 v[108:111],v[44:47],a[216:223],v2
v_smfmac_f32_16x16x64_bf16 v[116:119],v[44:47],v[216:223],v2
s_waitcnt lgkmcnt(2)
v_smfmac_f32_16x16x64_bf16 v[100:103],v[48:51],a[224:231],v2
v_smfmac_f32_16x16x64_bf16 v[112:115],v[48:51],v[224:231],v2
v_smfmac_f32_16x16x64_bf16 v[108:111],v[48:51],a[232:239],v2
v_smfmac_f32_16x16x64_bf16 v[116:119],v[48:51],v[232:239],v2
s_waitcnt lgkmcnt(0)
v_smfmac_f32_16x16x64_bf16 v[100:103],v[52:55],a[240:247],v2
v_smfmac_f32_16x16x64_bf16 v[112:115],v[52:55],v[240:247],v2
v_smfmac_f32_16x16x64_bf16 v[108:111],v[52:55],a[248:255],v2
v_smfmac_f32_16x16x64_bf16 v[116:119],v[52:55],v[248:255],v2
v_add_f32 v100,v100,v102
v_add_f32 v112,v112,v114
s_nop 1
v_add_f32 v108,v108,v110
s_nop 2
v_add_f32 v116,v116,v118
v_cvt_pk_bf16_f32 v120,v100,v108
v_cvt_pk_bf16_f32 v121,v112,v116
ds_write_b32 v60,v120
ds_write_b16 v61,v121
ds_write_b16_d16_hi v61,v121 offset:1024
v_mov_b64 v[96:97],0
v_mov_b64 v[98:99],0
v_mov_b64 v[100:101],0
v_mov_b64 v[102:103],0
v_mov_b64 v[104:105],0
v_mov_b64 v[106:107],0
v_mov_b64 v[108:109],0
v_mov_b64 v[110:111],0
v_mov_b64 v[112:113],0
v_mov_b64 v[114:115],0
v_mov_b64 v[116:117],0
v_mov_b64 v[118:119],0
s_waitcnt vmcnt(0) lgkmcnt(0)
s_barrier
v_add_u32 v55,131072,v0
ds_read_b128 v[56:59],v55 offset:0
ds_read_b128 v[60:63],v55 offset:4096
ds_read_b128 v[64:67],v55 offset:1024
ds_read_b128 v[68:71],v55 offset:5120
ds_read_b128 v[72:75],v55 offset:2048
ds_read_b128 v[76:79],v55 offset:6144
ds_read_b128 v[80:83],v55 offset:3072
ds_read_b128 v[84:87],v55 offset:7168
v_add_u32 v123,s73,v55
ds_read_b128 v[88:91],v123 offset:8192
ds_read_b128 v[92:95],v123 offset:9216
v_xor_b32 v120,1024,v12
v_xor_b32 v121,2048,v12
v_xor_b32 v122,3072,v12
buffer_load_dwordx4 v[24:27],v13,s[8:11],s64 offen sc1
buffer_load_dwordx4 v[24:27],v13,s[8:11],s64 offen sc1
.p2align 6
L_chain_223:
L_cpa_224:
buffer_load_dwordx4 v[24:27],v13,s[8:11],s64 offen sc1
s_sub_u32 s49,s49,1
s_cbranch_scc1 L_abort
s_waitcnt vmcnt(2)
v_max3_u32 v123,v24,v25,v26
v_max_u32 v123,v27,v123
v_cmp_le_u32 vcc,s72,v123
ds_write_b128 v12,v[24:27] offset:0
s_cbranch_vccnz L_cpa_224
L_cgo_227:
v_smfmac_f32_16x16x64_bf16 v[96:99],v[24:27],a[0:7],v2
buffer_load_dwordx4 v[40:43],v13,s[8:11],s70 offen sc1
s_waitcnt lgkmcnt(0)
s_barrier
ds_read_b128 v[28:31],v120 offset:0
v_smfmac_f32_16x16x64_bf16 v[100:103],v[24:27],a[128:135],v2
ds_read_b128 v[32:35],v121 offset:0
v_smfmac_f32_16x16x64_bf16 v[104:107],v[24:27],a[8:15],v2
ds_read_b128 v[36:39],v122 offset:0
v_smfmac_f32_16x16x64_bf16 v[108:111],v[24:27],a[136:143],v2
v_smfmac_f32_16x16x64_bf16 v[112:115],v[24:27],v[128:135],v2
v_smfmac_f32_16x16x64_bf16 v[116:119],v[24:27],v[136:143],v2
s_waitcnt lgkmcnt(2)
v_smfmac_f32_16x16x64_bf16 v[96:99],v[28:31],a[16:23],v2
s_add_u32 m0,s73,131072
v_smfmac_f32_16x16x64_bf16 v[100:103],v[28:31],a[144:151],v2
s_add_u32 s57,s67,8192
v_smfmac_f32_16x16x64_bf16 v[104:107],v[28:31],a[24:31],v2
s_cmp_lt_u32 s19,s76
s_cbranch_scc1 L_ckw_213
L_ckb_214:
v_smfmac_f32_16x16x64_bf16 v[108:111],v[28:31],a[152:159],v2
s_waitcnt vmcnt(0) lgkmcnt(1)
v_smfmac_f32_16x16x64_bf16 v[96:99],v[32:35],a[32:39],v2
ds_write_b128 v12,v[40:43] offset:4096
v_max3_u32 v123,v40,v41,v42
v_smfmac_f32_16x16x64_bf16 v[100:103],v[32:35],a[160:167],v2
v_max_u32 v123,v43,v123
v_smfmac_f32_16x16x64_bf16 v[104:107],v[32:35],a[40:47],v2
v_cmp_le_u32 vcc,s72,v123
v_smfmac_f32_16x16x64_bf16 v[108:111],v[32:35],a[168:175],v2
v_smfmac_f32_16x16x64_bf16 v[112:115],v[28:31],v[144:151],v2
s_cbranch_vccnz L_cpb_230
L_cback_232:
s_waitcnt lgkmcnt(0)
s_barrier
v_smfmac_f32_16x16x64_bf16 v[96:99],v[36:39],a[48:55],v2
buffer_load_dword v23,v22,s[8:11],s75 offen sc1
v_smfmac_f32_16x16x64_bf16 v[100:103],v[36:39],a[176:183],v2
ds_read_b128 v[44:47],v120 offset:4096
v_smfmac_f32_16x16x64_bf16 v[104:107],v[36:39],a[56:63],v2
buffer_load_dwordx4 v0,s[8:11],s67 offen sc1 lds
v_smfmac_f32_16x16x64_bf16 v[108:111],v[36:39],a[184:191],v2
ds_read_b128 v[48:51],v121 offset:4096
v_smfmac_f32_16x16x64_bf16 v[96:99],v[40:43],a[64:71],v2
buffer_store_dwordx4 v[124:127],v0,s[8:11],s54 offen sc1
v_smfmac_f32_16x16x64_bf16 v[100:103],v[40:43],a[192:199],v2
ds_read_b128 v[52:55],v122 offset:4096
v_smfmac_f32_16x16x64_bf16 v[104:107],v[40:43],a[72:79],v2
buffer_load_dwordx4 v0,s[8:11],s67 offen offset:1024 sc1 lds
s_add_u32 m0,s73,139264
v_smfmac_f32_16x16x64_bf16 v[108:111],v[40:43],a[200:207],v2
ds_read_b32 v123,v8 offset:2560
s_waitcnt lgkmcnt(3)
v_smfmac_f32_16x16x64_bf16 v[96:99],v[44:47],a[80:87],v2
buffer_load_dwordx4 v0,s[8:11],s57 offen sc1 lds
s_add_u32 s67,s67,786432
v_smfmac_f32_16x16x64_bf16 v[100:103],v[44:47],a[208:215],v2
s_waitcnt lgkmcnt(2)
v_smfmac_f32_16x16x64_bf16 v[96:99],v[48:51],a[96:103],v2
buffer_load_dwordx4 v0,s[8:11],s57 offen offset:1024 sc1 lds
v_smfmac_f32_16x16x64_bf16 v[100:103],v[48:51],a[224:231],v2
s_waitcnt lgkmcnt(0)
v_smfmac_f32_16x16x64_bf16 v[96:99],v[52:55],a[112:119],v2
v_smfmac_f32_16x16x64_bf16 v[100:103],v[52:55],a[240:247],v2
v_readfirstlane_b32 s58,v123
v_smfmac_f32_16x16x64_bf16 v[104:107],v[44:47],a[88:95],v2
v_smfmac_f32_16x16x64_bf16 v[108:111],v[44:47],a[216:223],v2
s_cmp_lg_u32 s58,0
s_cbranch_scc1 L_cjump_216
v_smfmac_f32_16x16x64_bf16 v[104:107],v[48:51],a[104:111],v2
v_add_f32 v96,v96,v98
v_smfmac_f32_16x16x64_bf16 v[108:111],v[48:51],a[232:239],v2
v_add_f32 v97,v97,v99
v_smfmac_f32_16x16x64_bf16 v[104:107],v[52:55],a[120:127],v2
v_cvt_pk_bf16_f32 v120,v96,v97
v_smfmac_f32_16x16x64_bf16 v[108:111],v[52:55],a[248:255],v2
v_add_f32 v100,v100,v102
v_smfmac_f32_16x16x64_bf16 v[116:119],v[28:31],v[152:159],v2
v_add_f32 v101,v101,v103
v_smfmac_f32_16x16x64_bf16 v[112:115],v[32:35],v[160:167],v2
v_cvt_pk_bf16_f32 v121,v100,v101
v_add_f32 v104,v104,v106
v_add_f32 v105,v105,v107
v_cvt_pk_bf16_f32 v122,v104,v105
v_add_f32 v108,v108,v110
v_add_f32 v109,v109,v111
v_cvt_pk_bf16_f32 v123,v108,v109
ds_write_b128 v4,v[120:123]
v_smfmac_f32_16x16x64_bf16 v[116:119],v[32:35],v[168:175],v2
s_mov_b32 s54,s68
s_add_u32 s68,s68,131072
v_mov_b32 v125,0
v_smfmac_f32_16x16x64_bf16 v[112:115],v[36:39],v[176:183],v2
s_cmp_eq_u32 s51,63
s_cbranch_scc1 L_cend_226
v_smfmac_f32_16x16x64_bf16 v[116:119],v[36:39],v[184:191],v2
s_waitcnt lgkmcnt(0)
s_barrier
ds_read_b64_tr_b16 v[96:97],v5 offset:0
v_smfmac_f32_16x16x64_bf16 v[112:115],v[40:43],v[192:199],v2
ds_read_b64_tr_b16 v[98:99],v6 offset:0
v_smfmac_f32_16x16x64_bf16 v[116:119],v[40:43],v[200:207],v2
ds_read_b64_tr_b16 v[100:101],v5 offset:1024
v_smfmac_f32_16x16x64_bf16 v[112:115],v[44:47],v[208:215],v2
ds_read_b64_tr_b16 v[102:103],v6 offset:1024
v_smfmac_f32_16x16x64_bf16 v[116:119],v[44:47],v[216:223],v2
ds_read_b64_tr_b16 v[104:105],v5 offset:2048
v_smfmac_f32_16x16x64_bf16 v[112:115],v[48:51],v[224:231],v2
ds_read_b64_tr_b16 v[106:107],v6 offset:2048
s_waitcnt lgkmcnt(4)
v_mfma_f32_16x16x32_bf16 v[24:27],v[56:59],v[96:99],0
ds_read_b64_tr_b16 v[108:109],v5 offset:3072
v_mfma_f32_16x16x32_bf16 v[28:31],v[60:63],v[96:99],0
ds_read_b64_tr_b16 v[110:111],v6 offset:3072
v_mfma_f32_16x16x32_bf16 v[32:35],v[96:99],v[96:99],0
ds_read_b128 v[40:43],v11 offset:12288
s_waitcnt lgkmcnt(5)
v_mfma_f32_16x16x32_bf16 v[24:27],v[64:67],v[100:103],v[24:27]
ds_read_b128 v[56:59],v11 offset:0
v_mfma_f32_16x16x32_bf16 v[28:31],v[68:71],v[100:103],v[28:31]
ds_read_b128 v[60:63],v11 offset:1024
v_mfma_f32_16x16x32_bf16 v[32:35],v[100:103],v[100:103],v[32:35]
ds_read_b128 v[96:99],v11 offset:8192
s_waitcnt lgkmcnt(6)
v_mfma_f32_16x16x32_bf16 v[24:27],v[72:75],v[104:107],v[24:27]
ds_read_b128 v[64:67],v11 offset:2048
v_mfma_f32_16x16x32_bf16 v[28:31],v[76:79],v[104:107],v[28:31]
ds_read_b128 v[68:71],v11 offset:3072
v_mfma_f32_16x16x32_bf16 v[32:35],v[104:107],v[104:107],v[32:35]
ds_read_b128 v[100:103],v11 offset:9216
s_waitcnt lgkmcnt(7)
v_mfma_f32_16x16x32_bf16 v[24:27],v[80:83],v[108:111],v[24:27]
ds_read_b128 v[72:75],v11 offset:4096
v_mfma_f32_16x16x32_bf16 v[28:31],v[84:87],v[108:111],v[28:31]
ds_read_b128 v[76:79],v11 offset:5120
v_mfma_f32_16x16x32_bf16 v[32:35],v[108:111],v[108:111],v[32:35]
ds_read_b128 v[104:107],v11 offset:10240
v_smfmac_f32_16x16x64_bf16 v[116:119],v[48:51],v[232:239],v2
ds_read_b128 v[80:83],v11 offset:6144
v_smfmac_f32_16x16x64_bf16 v[112:115],v[52:55],v[240:247],v2
ds_read_b128 v[84:87],v11 offset:7168
v_smfmac_f32_16x16x64_bf16 v[116:119],v[52:55],v[248:255],v2
ds_read_b128 v[108:111],v11 offset:11264
v_max3_f32 v126,v24,v25,v26
v_max3_f32 v127,v27,v28,v29
v_max3_f32 v126,v30,v31,v126
v_max3_f32 v127,v34,v35,v127
v_max_f32 v126,v126,v127
v_max_f32 v127,v126,v127
v_pk_mul_f32 v[34:35],v[34:35],v[0:1] op_sel:[0,1]
v_pk_mul_f32 v[24:25],v[24:25],v[0:1] op_sel:[0,1]
v_permlane16_swap_b32 v126,v127
v_max_f32 v126,v126,v127
v_max_f32 v127,v126,v127
v_pk_add_f32 v[112:113],v[112:113],v[114:115]
v_pk_add_f32 v[116:117],v[116:117],v[118:119]
v_permlane32_swap_b32 v126,v127
v_max_f32 v126,v126,v127
v_mul_f32 v126,v1,v126
v_pk_add_f32 v[34:35],v[34:35],v[126:127] op_sel_hi:[1,0] neg_lo:[0,1] neg_hi:[0,1]
v_pk_add_f32 v[24:25],v[24:25],v[126:127] op_sel_hi:[1,0] neg_lo:[0,1] neg_hi:[0,1]
v_pk_fma_f32 v[26:27],v[26:27],v[0:1],v[126:127] op_sel:[0,1,0] op_sel_hi:[1,1,0] neg_lo:[0,0,1] neg_hi:[0,0,1]
v_pk_fma_f32 v[28:29],v[28:29],v[0:1],v[126:127] op_sel:[0,1,0] op_sel_hi:[1,1,0] neg_lo:[0,0,1] neg_hi:[0,0,1]
v_pk_fma_f32 v[30:31],v[30:31],v[0:1],v[126:127] op_sel:[0,1,0] op_sel_hi:[1,1,0] neg_lo:[0,0,1] neg_hi:[0,0,1]
v_exp_f32 v34,v34
v_exp_f32 v35,v35
v_cvt_pk_bf16_f32 v126,v112,v113
v_cvt_pk_bf16_f32 v124,v34,v35
v_cvt_pk_bf16_f32 v127,v116,v117
v_cvt_pk_bf16_f32 v36,v116,v117
v_mfma_f32_16x16x16_bf16 v[32:35],v[14:15],v[124:125],0
ds_read_b128 v[44:47],v11 offset:13312
v_exp_f32 v24,v24
v_mfma_f32_16x16x16_bf16 v[112:115],v[126:127],v[124:125],0
ds_read_b128 v[48:51],v11 offset:14336
v_exp_f32 v25,v25
v_mfma_f32_16x16x16_bf16 v[116:119],v[36:37],v[124:125],0
ds_read_b128 v[52:55],v11 offset:15360
v_exp_f32 v26,v26
v_exp_f32 v27,v27
v_cvt_pk_bf16_f32 v120,v24,v25
v_exp_f32 v28,v28
v_exp_f32 v29,v29
v_cvt_pk_bf16_f32 v121,v26,v27
v_exp_f32 v30,v30
v_exp_f32 v31,v31
v_cvt_pk_bf16_f32 v122,v28,v29
v_cvt_pk_bf16_f32 v123,v30,v31
s_add_u32 s75,s75,8192
s_add_u32 s51,s51,1
v_mfma_f32_16x16x32_bf16 v[32:35],v[14:17],v[120:123],v[32:35]
v_mfma_f32_16x16x32_bf16 v[112:115],v[88:91],v[120:123],v[112:115]
ds_read_b128 v[88:91],v11 offset:16384
v_mfma_f32_16x16x32_bf16 v[116:119],v[92:95],v[120:123],v[116:119]
ds_read_b128 v[92:95],v11 offset:17408
v_rcp_f32 v32,v32
v_mov_b64 v[24:25],-1
v_mov_b64 v[26:27],-1
s_add_u32 s64,s75,13631488
s_add_u32 s70,s64,4096
v_pk_mul_f32 v[112:113],v[112:113],v[32:33] op_sel_hi:[1,0]
v_pk_mul_f32 v[114:115],v[114:115],v[32:33] op_sel_hi:[1,0]
v_pk_mul_f32 v[116:117],v[116:117],v[32:33] op_sel_hi:[1,0]
v_pk_mul_f32 v[118:119],v[118:119],v[32:33] op_sel_hi:[1,0]
v_cvt_pk_bf16_f32 v120,v112,v116
v_cvt_pk_bf16_f32 v121,v113,v117
v_cvt_pk_bf16_f32 v122,v114,v118
v_cvt_pk_bf16_f32 v123,v115,v119
ds_write_b128 v7,v[120:123]
buffer_store_dwordx4 v[24:27],v0,s[8:11],s69 offen
buffer_store_dwordx4 v[24:27],v0,s[8:11],s69 offen offset:1024
v_mov_b64 v[112:113],0
v_mov_b64 v[114:115],0
v_mov_b64 v[116:117],0
v_mov_b64 v[118:119],0
s_waitcnt lgkmcnt(0)
s_barrier
ds_read_b128 v[24:27],v8 offset:0
ds_read_b128 v[28:31],v8 offset:512
ds_read_b128 v[32:35],v8 offset:1024
ds_read_b128 v[36:39],v8 offset:1536
v_mov_b64 v[120:121],0
v_mov_b64 v[122:123],0
s_add_u32 s57,s65,65536
s_add_u32 s58,s65,131072
s_add_u32 s59,s65,196608
s_add_u32 s56,s18,s75
s_waitcnt lgkmcnt(3)
v_smfmac_f32_16x16x64_bf16 v[112:115],v[24:27],v[56:63],v3
ds_read_b128 v[56:59],v11 offset:18432
s_waitcnt lgkmcnt(3)
v_smfmac_f32_16x16x64_bf16 v[112:115],v[28:31],v[64:71],v3
ds_read_b128 v[60:63],v11 offset:19456
s_waitcnt lgkmcnt(3)
v_smfmac_f32_16x16x64_bf16 v[112:115],v[32:35],v[72:79],v3
ds_read_b128 v[64:67],v11 offset:20480
s_waitcnt lgkmcnt(3)
v_smfmac_f32_16x16x64_bf16 v[112:115],v[36:39],v[80:87],v3
ds_read_b128 v[68:71],v11 offset:21504
v_smfmac_f32_16x16x64_bf16 v[116:119],v[24:27],v[96:103],v3
ds_read_b128 v[72:75],v11 offset:22528
v_smfmac_f32_16x16x64_bf16 v[116:119],v[28:31],v[104:111],v3
ds_read_b128 v[76:79],v11 offset:23552
v_cvt_pk_bf16_f32 v112,v112,v113
v_smfmac_f32_16x16x64_bf16 v[116:119],v[32:35],v[40:47],v3
ds_read_b128 v[80:83],v11 offset:24576
v_cvt_pk_bf16_f32 v113,v114,v115
buffer_store_dwordx2 v[112:113],v9,s[8:11],s65 offen
v_smfmac_f32_16x16x64_bf16 v[116:119],v[36:39],v[48:55],v3
ds_read_b128 v[84:87],v11 offset:25600
v_mov_b64 v[112:113],0
v_smfmac_f32_16x16x64_bf16 v[120:123],v[24:27],v[88:95],v3
ds_read_b128 v[96:99],v11 offset:26624
ds_read_b128 v[100:103],v11 offset:27648
v_mov_b64 v[114:115],0
s_waitcnt lgkmcnt(8)
v_smfmac_f32_16x16x64_bf16 v[120:123],v[28:31],v[56:63],v3
ds_read_b128 v[104:107],v11 offset:28672
v_cvt_pk_bf16_f32 v116,v116,v117
s_waitcnt lgkmcnt(7)
v_smfmac_f32_16x16x64_bf16 v[120:123],v[32:35],v[64:71],v3
ds_read_b128 v[108:111],v11 offset:29696
ds_read_b128 v[40:43],v11 offset:30720
v_cvt_pk_bf16_f32 v117,v118,v119
buffer_store_dwordx2 v[116:117],v9,s[8:11],s57 offen
s_waitcnt lgkmcnt(7)
v_smfmac_f32_16x16x64_bf16 v[120:123],v[36:39],v[72:79],v3
ds_read_b128 v[44:47],v11 offset:31744
v_add_u32 v52,s50,v5
s_waitcnt lgkmcnt(6)
v_smfmac_f32_16x16x64_bf16 v[112:115],v[24:27],v[80:87],v3
v_add_u32 v54,s50,v6
s_waitcnt lgkmcnt(4)
v_smfmac_f32_16x16x64_bf16 v[112:115],v[28:31],v[96:103],v3
ds_read_b64_tr_b16 v[52:53],v52
v_cvt_pk_bf16_f32 v120,v120,v121
s_waitcnt lgkmcnt(3)
v_smfmac_f32_16x16x64_bf16 v[112:115],v[32:35],v[104:111],v3
ds_read_b64_tr_b16 v[54:55],v54
v_cvt_pk_bf16_f32 v121,v122,v123
buffer_store_dwordx2 v[120:121],v9,s[8:11],s58 offen
s_waitcnt lgkmcnt(2)
v_smfmac_f32_16x16x64_bf16 v[112:115],v[36:39],v[40:47],v3
v_mov_b64 v[116:117],0
v_mov_b64 v[118:119],0
s_xor_b32 s65,s65,262144
v_mov_b32_dpp v124,v126 quad_perm:[2,3,2,3] row_mask:0xf bank_mask:0xf
v_mov_b32_dpp v125,v127 quad_perm:[2,3,2,3] row_mask:0xf bank_mask:0xf
s_mov_b32 vcc_lo,0xcccccccc
s_mov_b32 vcc_hi,0xcccccccc
s_nop 0
v_cvt_pk_bf16_f32 v112,v112,v113
v_cvt_pk_bf16_f32 v113,v114,v115
buffer_store_dwordx2 v[112:113],v9,s[8:11],s59 offen
s_waitcnt lgkmcnt(0)
s_buffer_load_dword s19,s[8:11],s56
v_cndmask_b32 v124,v124,v52,vcc
v_cndmask_b32 v125,v125,v53,vcc
s_cmp_lt_u32 s46,2
s_waitcnt vmcnt(3)
s_cbranch_scc1 L_crg_233
s_cmp_eq_u32 s46,2
s_waitcnt vmcnt(1)
s_cbranch_scc1 L_crg_233
s_waitcnt vmcnt(0)
L_crg_233:
buffer_load_dwordx4 v[32:35],v0,s[8:11],s66 offen offset:0 sc1
buffer_load_dwordx4 v[36:39],v0,s[8:11],s66 offen offset:1024 sc1
v_cndmask_b32 v126,v126,v54,vcc
v_cndmask_b32 v127,v127,v55,vcc
v_mov_b64 v[96:97],0
v_mov_b64 v[98:99],0
v_mov_b64 v[100:101],0
v_mov_b64 v[102:103],0
v_mov_b64 v[104:105],0
v_mov_b64 v[106:107],0
v_mov_b64 v[108:109],0
v_mov_b64 v[110:111],0
v_mov_b64 v[112:113],0
v_mov_b64 v[114:115],0
v_add_u32 v55,131072,v0
v_add_u32 v123,s73,v55
v_xor_b32 v120,1024,v12
v_xor_b32 v121,2048,v12
v_xor_b32 v122,3072,v12
buffer_load_dwordx4 v[44:47],v0,s[8:11],s66 offen offset:0 sc1
buffer_load_dwordx4 v[48:51],v0,s[8:11],s66 offen offset:1024 sc1
s_cmp_ge_u32 s51,63
s_cselect_b32 s76,0,1
v_readlane_b32 s56,v23,5
v_readlane_b32 s20,v23,4
v_add_u32 v23,-1,v23
v_cmp_le_u32 vcc,s30,v23
s_cmp_gt_u32 s51,61
s_cselect_b32 s77,0,vcc_hi
s_cmp_gt_u32 s20,s30
s_cselect_b32 s77,1,s77
s_cmp_lg_u32 s77,0
s_cselect_b32 s76,2,s76
s_cmp_gt_u32 s56,s30
s_cbranch_scc1 L_cld_209
L_clb_210:
s_cmp_eq_u32 s46,0
s_cselect_b32 s76,s76,0
s_waitcnt vmcnt(3)
v_mfma_f32_16x16x32_bf16 v[28:31],v[18:21],v[32:35],0
s_waitcnt vmcnt(2)
v_mfma_f32_16x16x32_bf16 v[28:31],v[18:21],v[36:39],v[28:31]
s_nop 7
v_cmp_u_f32 vcc,v28,v28
v_add_f32_dpp v52,v28,v28 row_ror:8 row_mask:0xf bank_mask:0x3
v_add_f32_dpp v53,v29,v29 row_ror:8 row_mask:0xf bank_mask:0x3
v_add_f32_dpp v52,v30,v30 row_ror:8 row_mask:0xf bank_mask:0xc
v_add_f32_dpp v53,v31,v31 row_ror:8 row_mask:0xf bank_mask:0xc
s_cbranch_vccnz L_crp_228
L_cok_234:
v_add_f32_dpp v52,v52,v52 row_shl:4 row_mask:0xf bank_mask:0x5
v_add_f32_dpp v53,v53,v53 row_shl:4 row_mask:0xf bank_mask:0x5
v_cvt_pk_bf16_f32 v54,v52,v53
buffer_store_dword v54,v10,s[8:11],s64 offen
s_mov_b32 s69,s66
s_xor_b32 s66,s66,262144
s_barrier
ds_read_b128 v[56:59],v55 offset:0
ds_read_b128 v[60:63],v55 offset:4096
ds_read_b128 v[64:67],v55 offset:1024
buffer_load_dwordx4 v[24:27],v13,s[8:11],s64 offen sc1
ds_read_b128 v[68:71],v55 offset:5120
ds_read_b128 v[72:75],v55 offset:2048
ds_read_b128 v[76:79],v55 offset:6144
ds_read_b128 v[80:83],v55 offset:3072
buffer_load_dwordx4 v[24:27],v13,s[8:11],s64 offen sc1
ds_read_b128 v[84:87],v55 offset:7168
ds_read_b128 v[88:91],v123 offset:8192
ds_read_b128 v[92:95],v123 offset:9216
s_branch L_chain_223
L_cpb_230:
buffer_load_dwordx4 v[40:43],v13,s[8:11],s70 offen sc1
s_sub_u32 s49,s49,1
s_cbranch_scc1 L_abort
s_waitcnt vmcnt(0)
v_max3_u32 v123,v40,v41,v42
v_max_u32 v123,v43,v123
v_cmp_le_u32 vcc,s72,v123
s_cbranch_vccnz L_cpb_230
ds_write_b128 v12,v[40:43] offset:4096
s_branch L_cback_232
L_crp_228:
buffer_load_dwordx4 v[32:35],v0,s[8:11],s66 offen offset:0 sc1
buffer_load_dwordx4 v[36:39],v0,s[8:11],s66 offen offset:1024 sc1
s_sub_u32 s49,s49,1
s_cbranch_scc1 L_abort
s_waitcnt vmcnt(3)
v_mfma_f32_16x16x32_bf16 v[28:31],v[18:21],v[44:47],0
s_waitcnt vmcnt(2)
v_mfma_f32_16x16x32_bf16 v[28:31],v[18:21],v[48:51],v[28:31]
s_nop 7
v_cmp_u_f32 vcc,v28,v28
v_add_f32_dpp v52,v28,v28 row_ror:8 row_mask:0xf bank_mask:0x3
v_add_f32_dpp v53,v29,v29 row_ror:8 row_mask:0xf bank_mask:0x3
v_add_f32_dpp v52,v30,v30 row_ror:8 row_mask:0xf bank_mask:0xc
v_add_f32_dpp v53,v31,v31 row_ror:8 row_mask:0xf bank_mask:0xc
s_cbranch_vccz L_cok_234
buffer_load_dwordx4 v[44:47],v0,s[8:11],s66 offen offset:0 sc1
buffer_load_dwordx4 v[48:51],v0,s[8:11],s66 offen offset:1024 sc1
s_sub_u32 s49,s49,1
s_cbranch_scc1 L_abort
s_waitcnt vmcnt(3)
v_mfma_f32_16x16x32_bf16 v[28:31],v[18:21],v[32:35],0
s_waitcnt vmcnt(2)
v_mfma_f32_16x16x32_bf16 v[28:31],v[18:21],v[36:39],v[28:31]
s_nop 7
v_cmp_u_f32 vcc,v28,v28
v_add_f32_dpp v52,v28,v28 row_ror:8 row_mask:0xf bank_mask:0x3
v_add_f32_dpp v53,v29,v29 row_ror:8 row_mask:0xf bank_mask:0x3
v_add_f32_dpp v52,v30,v30 row_ror:8 row_mask:0xf bank_mask:0xc
v_add_f32_dpp v53,v31,v31 row_ror:8 row_mask:0xf bank_mask:0xc
s_cbranch_vccz L_cok_234
s_branch L_crp_228
L_ckw_213:
s_cmp_eq_u32 s77,0
s_cbranch_scc1 L_cjw_215
s_cmp_gt_u32 s20,s30
s_cbranch_scc1 L_cjs_211
s_add_u32 s31,s51,2
s_lshl_b32 s59,s31,13
s_add_u32 s59,s59,10486016
v_lshrrev_b32 v45,2,v0
v_and_b32 v45,127,v45
L_ckk_235:
s_sleep 1
buffer_load_dword v44,v45,s[8:11],s59 offen sc1
s_sub_u32 s49,s49,1
s_cbranch_scc1 L_abort
s_waitcnt vmcnt(0)
v_cmp_eq_u32 vcc,0,v44
s_cbranch_vccnz L_ckk_235
v_cmp_lt_u32 vcc,s30,v44
s_cbranch_vccz L_cjw_215
v_max_u32_dpp v44,v44,v44 row_ror:8 row_mask:0xf bank_mask:0xf
s_nop 1
v_max_u32_dpp v44,v44,v44 row_ror:4 row_mask:0xf bank_mask:0xf
s_nop 1
v_max_u32_dpp v44,v44,v44 row_ror:2 row_mask:0xf bank_mask:0xf
s_nop 1
v_max_u32_dpp v44,v44,v44 row_ror:1 row_mask:0xf bank_mask:0xf
v_mov_b32 v45,v44
s_nop 1
v_permlane16_swap_b32 v44,v45
v_max_u32 v44,v44,v45
v_mov_b32 v45,v44
s_nop 1
v_permlane32_swap_b32 v44,v45
v_max_u32 v44,v44,v45
s_nop 0
v_readfirstlane_b32 s20,v44
L_cjs_211:
s_mov_b32 s30,s20
s_andn2_b32 s31,0x7ff,s20
s_lshr_b32 s31,s31,5
s_add_u32 s31,s31,1
s_min_u32 s31,s31,63
ds_write_b32 v8,v2 offset:2560
s_waitcnt lgkmcnt(0)
s_branch L_ckb_214
L_cld_209:
v_mov_b32 v23,s56
s_add_u32 s56,s75,10495616
buffer_store_dword v23,off,s[8:11],s56
s_waitcnt vmcnt(0)
s_branch L_clb_210
L_cjw_215:
s_cmp_lg_u32 s19,0
s_cbranch_scc1 L_ckb_214
s_add_u32 s59,s18,s75
L_ww_236:
buffer_load_dword v23,off,s[8:11],s59 sc1
s_sub_u32 s49,s49,1
s_cbranch_scc1 L_abort
s_waitcnt vmcnt(0)
v_readfirstlane_b32 s76,v23
s_cmp_eq_u32 s76,0
s_cbranch_scc1 L_ww_236
L_wwd_237:
s_branch L_ckb_214
L_cjump_216:
s_waitcnt vmcnt(0) lgkmcnt(0)
s_barrier
s_branch L_cst_212
L_cend_226:
v_smfmac_f32_16x16x64_bf16 v[116:119],v[36:39],v[184:191],v2
v_smfmac_f32_16x16x64_bf16 v[112:115],v[40:43],v[192:199],v2
v_smfmac_f32_16x16x64_bf16 v[116:119],v[40:43],v[200:207],v2
v_smfmac_f32_16x16x64_bf16 v[112:115],v[44:47],v[208:215],v2
v_smfmac_f32_16x16x64_bf16 v[116:119],v[44:47],v[216:223],v2
v_smfmac_f32_16x16x64_bf16 v[112:115],v[48:51],v[224:231],v2
v_smfmac_f32_16x16x64_bf16 v[116:119],v[48:51],v[232:239],v2
v_smfmac_f32_16x16x64_bf16 v[112:115],v[52:55],v[240:247],v2
v_smfmac_f32_16x16x64_bf16 v[116:119],v[52:55],v[248:255],v2
s_waitcnt lgkmcnt(0)
s_nop 2
v_pk_add_f32 v[112:113],v[112:113],v[114:115]
s_nop 2
v_pk_add_f32 v[116:117],v[116:117],v[118:119]
v_cvt_pk_bf16_f32 v126,v112,v113
v_cvt_pk_bf16_f32 v127,v116,v117
v_add_u32 v52,s50,v5
v_add_u32 v54,s50,v6
ds_read_b64_tr_b16 v[52:53],v52
ds_read_b64_tr_b16 v[54:55],v54
v_mov_b32_dpp v124,v126 quad_perm:[2,3,2,3] row_mask:0xf bank_mask:0xf
v_mov_b32_dpp v125,v127 quad_perm:[2,3,2,3] row_mask:0xf bank_mask:0xf
s_mov_b32 vcc_lo,0xcccccccc
s_mov_b32 vcc_hi,0xcccccccc
s_waitcnt lgkmcnt(0)
v_cndmask_b32 v124,v124,v52,vcc
v_cndmask_b32 v125,v125,v53,vcc
v_cndmask_b32 v126,v126,v54,vcc
v_cndmask_b32 v127,v127,v55,vcc
buffer_store_dwordx4 v[124:127],v0,s[8:11],s54 offen sc1
s_mov_b32 s51,64
s_waitcnt vmcnt(0)
s_barrier
s_nop 11
v_lshrrev_b32 v1,4,v0
s_endpgm
L_abort2:
s_endpgm
L_wc:
s_nop 11
s_cmp_eq_u32 s48,1
s_cbranch_scc1 L_rc1_238
s_cmp_eq_u32 s48,2
s_cbranch_scc1 L_rc2_239
v_and_b32 v120,15,v1
v_lshrrev_b32 v121,4,v1
v_and_b32 v122,2,v1
v_cmp_eq_u32 vcc,0,v122
v_mov_b32 v2,0xeeee
v_mov_b32 v123,0x4444
v_cndmask_b32 v2,v2,v123,vcc
v_and_b32 v122,1,v1
v_cmp_eq_u32 vcc,0,v122
v_mov_b32 v3,0xdddd
v_mov_b32 v123,0x8888
v_cndmask_b32 v3,v3,v123,vcc
v_lshrrev_b32 v122,1,v120
v_bfe_u32 v123,v120,2,1
v_xor_b32 v123,v123,v122
v_lshlrev_b32 v4,7,v123
v_and_b32 v123,1,v120
v_lshl_add_u32 v4,v123,6,v4
v_xor_b32 v123,v121,v122
v_and_b32 v123,3,v123
v_lshl_add_u32 v4,v123,4,v4
s_lshl_b32 s56,s46,10
s_add_u32 s56,s56,147456
v_add_u32 v4,s56,v4
v_lshlrev_b32 v122,1,v121
v_add_u32 v122,0,v122
v_and_b32 v123,1,v121
v_xor_b32 v123,v123,v122
v_lshlrev_b32 v5,7,v123
v_bfe_u32 v123,v120,3,1
v_lshl_add_u32 v5,v123,6,v5
v_xor_b32 v123,v120,v122
v_and_b32 v123,3,v123
v_lshl_add_u32 v5,v123,4,v5
v_bfe_u32 v123,v120,2,1
v_lshl_add_u32 v5,v123,3,v5
v_add_u32 v5,147456,v5
v_lshlrev_b32 v122,1,v121
v_add_u32 v122,1,v122
v_and_b32 v123,1,v121
v_xor_b32 v123,v123,v122
v_lshlrev_b32 v6,7,v123
v_bfe_u32 v123,v120,3,1
v_lshl_add_u32 v6,v123,6,v6
v_xor_b32 v123,v120,v122
v_and_b32 v123,3,v123
v_lshl_add_u32 v6,v123,4,v6
v_bfe_u32 v123,v120,2,1
v_lshl_add_u32 v6,v123,3,v6
v_add_u32 v6,147456,v6
v_lshlrev_b32 v7,7,v121
v_lshrrev_b32 v122,1,v120
v_lshl_add_u32 v8,v122,4,v7
v_add_u32 v8,151552,v8
v_lshrrev_b32 v122,2,v120
v_lshl_add_u32 v7,v122,5,v7
v_and_b32 v122,1,v120
v_lshl_add_u32 v7,v122,4,v7
v_and_b32 v122,2,v120
v_cmp_eq_u32 vcc,0,v122
s_lshl_b32 s56,s46,9
v_mov_b32 v122,2048
v_mov_b32 v123,s56
v_cndmask_b32 v122,v122,v123,vcc
v_add_u32 v7,v122,v7
v_add_u32 v7,151552,v7
v_lshrrev_b32 v122,3,v1
v_lshlrev_b32 v9,11,v122
v_and_b32 v122,7,v1
v_lshl_add_u32 v9,v122,3,v9
s_lshl_b32 s56,s46,14
s_lshl_b32 s57,s47,6
s_add_u32 s56,s56,s57
v_add_u32 v9,s56,v9
s_lshl_b32 s71,s46,5
s_add_u32 s71,s71,s47
s_bfe_u32 s56,s71,0x10003
s_lshl_b32 s56,s56,11
s_and_b32 s57,s71,1
s_lshl_b32 s57,s57,10
s_add_u32 s56,s56,s57
s_bfe_u32 s57,s71,0x10002
s_lshl_b32 s57,s57,9
s_add_u32 s56,s56,s57
s_bfe_u32 s57,s71,0x10001
s_lshl_b32 s57,s57,6
s_add_u32 s56,s56,s57
s_bfe_u32 s57,s71,0x10004
s_lshl_b32 s57,s57,8
s_add_u32 s56,s56,s57
s_bfe_u32 s57,s71,0x10005
s_lshl_b32 s57,s57,7
s_add_u32 s56,s56,s57
s_bfe_u32 s57,s71,0x10006
s_lshl_b32 s57,s57,12
s_add_u32 s56,s56,s57
v_and_b32 v122,3,v120
v_lshlrev_b32 v10,2,v122
v_bfe_u32 v122,v120,3,1
v_lshl_add_u32 v10,v122,4,v10
v_and_b32 v122,1,v121
v_lshl_add_u32 v10,v122,5,v10
v_add_u32 v10,s56,v10
v_and_b32 v123,36,v1
v_mov_b32 v122,0x80000000
v_cmp_eq_u32 vcc,0,v123
s_nop 1
v_cndmask_b32 v10,v122,v10,vcc
s_lshl_b32 s71,s71,11
s_lshl_b32 s73,s46,11
s_mov_b32 s72,0xffc00000
s_mov_b32 s74,0
v_and_b32 v11,1,v121
v_xor_b32 v11,v11,v120
v_and_b32 v11,3,v11
v_lshrrev_b32 v122,2,v120
v_lshl_add_u32 v11,v11,2,v122
v_lshl_add_u32 v11,v121,4,v11
v_lshlrev_b32 v11,4,v11
s_lshl_b32 s56,s46,15
v_add_u32 v11,s56,v11
v_lshrrev_b32 v13,3,v1
v_lshlrev_b32 v13,9,v13
v_and_b32 v122,7,v1
v_lshl_add_u32 v13,v122,4,v13
v_and_b32 v122,15,v1
v_and_b32 v123,1,v1
v_lshlrev_b32 v123,4,v123
v_mov_b32 v124,0x3f80
v_lshlrev_b32 v124,v123,v124
v_lshrrev_b32 v122,1,v122
v_cmp_eq_u32 vcc,0,v122
s_nop 1
v_cndmask_b32 v18,0,v124,vcc
v_cmp_eq_u32 vcc,1,v122
s_nop 1
v_cndmask_b32 v19,0,v124,vcc
v_cmp_eq_u32 vcc,2,v122
s_nop 1
v_cndmask_b32 v20,0,v124,vcc
v_cmp_eq_u32 vcc,3,v122
s_nop 1
v_cndmask_b32 v21,0,v124,vcc
s_and_b32 s56,s46,1
s_lshl_b32 s56,s56,8
s_and_b32 s57,s46,2
s_lshl_b32 s57,s57,6
s_add_u32 s56,s56,s57
v_add_u32 v13,s56,v13
s_add_u32 s56,s50,155648
v_add_u32 v12,s56,v0
v_mov_b64 v[14:15],s[28:29]
v_mov_b64 v[16:17],s[28:29]
v_add_u32 v22,11550720,v10
s_lshl_b32 s18,s47,2
s_add_u32 s18,s18,10493952
v_mov_b32 v1,s80
s_mov_b32 s65,14680064
s_add_u32 s66,s71,14680064
s_add_u32 s69,s71,14942208
s_mov_b32 s30,0x40000000
s_mov_b32 s51,0
L_cst_243:
s_cmp_lg_u32 s46,0
s_cbranch_scc1 L_csw_248
s_lshl_b32 s59,s51,13
s_lshl2_add_u32 s59,s47,s59
s_add_u32 s59,s59,10485760
s_buffer_load_dword s61,s[8:11],s59
s_waitcnt lgkmcnt(0)
s_cmp_lg_u32 s61,0
s_cbranch_scc1 L_wwd_250
L_ww_249:
s_sleep 1
buffer_load_dword v122,off,s[8:11],s59 sc1
s_sub_u32 s49,s49,1
s_cbranch_scc1 L_abort2
s_waitcnt vmcnt(0)
v_readfirstlane_b32 s61,v122
s_cmp_eq_u32 s61,0
s_cbranch_scc1 L_ww_249
L_wwd_250:
L_csw_248:
s_waitcnt lgkmcnt(0)
s_barrier
s_lshl_b32 s56,s51,5
s_add_u32 s56,s56,s47
s_mul_i32 s56,s56,24576
s_add_u32 s56,s56,100663296
s_add_u32 s67,s56,s73
s_add_u32 m0,s73,131072
s_add_u32 s57,s67,8192
buffer_load_dwordx4 v0,s[8:11],s67 offen sc1 lds
buffer_load_dwordx4 v0,s[8:11],s67 offen offset:1024 sc1 lds
s_add_u32 m0,s73,139264
s_add_u32 s67,s67,786432
buffer_load_dwordx4 v0,s[8:11],s57 offen sc1 lds
buffer_load_dwordx4 v0,s[8:11],s57 offen offset:1024 sc1 lds
s_lshl_b32 s75,s51,13
s_add_u32 s56,s75,11542528
buffer_load_dword v23,v10,s[8:11],s56 offen sc1
s_add_u32 s64,s75,11534336
s_add_u32 s70,s64,4096
s_lshl_b32 s68,s51,5
s_add_u32 s68,s68,s47
s_lshl_b32 s68,s68,12
s_lshl_b32 s56,s46,10
s_add_u32 s68,s68,s56
s_add_u32 s68,s68,41943040
s_mov_b32 s54,0x80000000
s_mov_b32 s77,0
s_add_u32 s56,s18,s75
s_buffer_load_dword s19,s[8:11],s56
s_cmp_eq_u32 s51,63
s_cselect_b32 s76,1,s46
s_cmp_eq_u32 s76,0
s_cselect_b32 s76,1,0
v_mov_b64 v[96:97],0
v_mov_b64 v[98:99],0
v_mov_b64 v[100:101],0
v_mov_b64 v[102:103],0
v_mov_b64 v[104:105],0
v_mov_b64 v[106:107],0
v_mov_b64 v[108:109],0
v_mov_b64 v[110:111],0
v_mov_b64 v[112:113],0
v_mov_b64 v[114:115],0
v_mov_b64 v[116:117],0
v_mov_b64 v[118:119],0
buffer_load_dwordx4 v[88:91],v13,s[8:11],s64 offen
buffer_load_dwordx4 v[88:91],v13,s[8:11],s70 offen
s_waitcnt vmcnt(19)
v_swap_b32 v25,v28
v_swap_b32 v26,v32
v_swap_b32 v27,v36
v_swap_b32 v30,v33
v_swap_b32 v31,v37
v_swap_b32 v35,v38
ds_write_b128 v93,v[24:27] offset:4096
ds_write_b128 v94,v[28:31] offset:4096
ds_write_b128 v93,v[32:35] offset:4224
ds_write_b128 v94,v[36:39] offset:4224
s_waitcnt vmcnt(15)
v_swap_b32 v41,v44
v_swap_b32 v42,v48
v_swap_b32 v43,v52
v_swap_b32 v46,v49
v_swap_b32 v47,v53
v_swap_b32 v51,v54
ds_write_b128 v93,v[40:43] offset:5120
ds_write_b128 v94,v[44:47] offset:5120
ds_write_b128 v93,v[48:51] offset:5248
ds_write_b128 v94,v[52:55] offset:5248
s_waitcnt vmcnt(11)
v_swap_b32 v57,v60
v_swap_b32 v58,v64
v_swap_b32 v59,v68
v_swap_b32 v62,v65
v_swap_b32 v63,v69
v_swap_b32 v67,v70
ds_write_b128 v93,v[56:59] offset:6144
ds_write_b128 v94,v[60:63] offset:6144
ds_write_b128 v93,v[64:67] offset:6272
ds_write_b128 v94,v[68:71] offset:6272
s_waitcnt vmcnt(7)
v_swap_b32 v73,v76
v_swap_b32 v74,v80
v_swap_b32 v75,v84
v_swap_b32 v78,v81
v_swap_b32 v79,v85
v_swap_b32 v83,v86
ds_write_b128 v93,v[72:75] offset:7168
ds_write_b128 v94,v[76:79] offset:7168
ds_write_b128 v93,v[80:83] offset:7296
ds_write_b128 v94,v[84:87] offset:7296
s_waitcnt vmcnt(0) lgkmcnt(0)
s_barrier
v_add_u32 v55,131072,v0
ds_read_b128 v[56:59],v55 offset:0
ds_read_b128 v[60:63],v55 offset:4096
ds_read_b128 v[64:67],v55 offset:1024
ds_read_b128 v[68:71],v55 offset:5120
ds_read_b128 v[72:75],v55 offset:2048
ds_read_b128 v[76:79],v55 offset:6144
ds_read_b128 v[80:83],v55 offset:3072
ds_read_b128 v[84:87],v55 offset:7168
v_add_u32 v123,s73,v55
ds_read_b128 v[88:91],v123 offset:8192
ds_read_b128 v[92:95],v123 offset:9216
v_xor_b32 v120,1024,v12
v_xor_b32 v121,2048,v12
v_xor_b32 v122,3072,v12
buffer_load_dwordx4 v[24:27],v13,s[8:11],s64 offen sc1
buffer_load_dwordx4 v[24:27],v13,s[8:11],s64 offen sc1
.p2align 6
L_chain_251:
L_cpa_252:
buffer_load_dwordx4 v[24:27],v13,s[8:11],s64 offen sc1
s_sub_u32 s49,s49,1
s_cbranch_scc1 L_abort2
s_waitcnt vmcnt(2)
v_max3_u32 v123,v24,v25,v26
v_max_u32 v123,v27,v123
v_cmp_le_u32 vcc,s72,v123
ds_write_b128 v12,v[24:27] offset:0
s_cbranch_vccnz L_cpa_252
L_cgo_255:
v_smfmac_f32_16x16x64_bf16 v[96:99],v[24:27],a[0:7],v2
buffer_load_dwordx4 v[40:43],v13,s[8:11],s70 offen sc1
s_waitcnt lgkmcnt(0)
s_barrier
ds_read_b128 v[28:31],v120 offset:0
v_smfmac_f32_16x16x64_bf16 v[100:103],v[24:27],a[128:135],v2
ds_read_b128 v[32:35],v121 offset:0
v_smfmac_f32_16x16x64_bf16 v[104:107],v[24:27],a[8:15],v2
ds_read_b128 v[36:39],v122 offset:0
v_smfmac_f32_16x16x64_bf16 v[108:111],v[24:27],a[136:143],v2
v_smfmac_f32_16x16x64_bf16 v[112:115],v[24:27],v[128:135],v2
v_smfmac_f32_16x16x64_bf16 v[116:119],v[24:27],v[136:143],v2
s_waitcnt lgkmcnt(2)
v_smfmac_f32_16x16x64_bf16 v[96:99],v[28:31],a[16:23],v2
s_add_u32 m0,s73,131072
v_smfmac_f32_16x16x64_bf16 v[100:103],v[28:31],a[144:151],v2
s_add_u32 s57,s67,8192
v_smfmac_f32_16x16x64_bf16 v[104:107],v[28:31],a[24:31],v2
s_cmp_lt_u32 s19,s76
s_cbranch_scc1 L_ckw_244
L_ckb_245:
v_smfmac_f32_16x16x64_bf16 v[108:111],v[28:31],a[152:159],v2
s_waitcnt vmcnt(0) lgkmcnt(1)
v_smfmac_f32_16x16x64_bf16 v[96:99],v[32:35],a[32:39],v2
ds_write_b128 v12,v[40:43] offset:4096
v_max3_u32 v123,v40,v41,v42
v_smfmac_f32_16x16x64_bf16 v[100:103],v[32:35],a[160:167],v2
v_max_u32 v123,v43,v123
v_smfmac_f32_16x16x64_bf16 v[104:107],v[32:35],a[40:47],v2
v_cmp_le_u32 vcc,s72,v123
v_smfmac_f32_16x16x64_bf16 v[108:111],v[32:35],a[168:175],v2
v_smfmac_f32_16x16x64_bf16 v[112:115],v[28:31],v[144:151],v2
s_cbranch_vccnz L_cpb_258
L_cback_260:
s_waitcnt lgkmcnt(0)
s_barrier
v_smfmac_f32_16x16x64_bf16 v[96:99],v[36:39],a[48:55],v2
buffer_load_dword v23,v22,s[8:11],s75 offen sc1
v_smfmac_f32_16x16x64_bf16 v[100:103],v[36:39],a[176:183],v2
ds_read_b128 v[44:47],v120 offset:4096
v_smfmac_f32_16x16x64_bf16 v[104:107],v[36:39],a[56:63],v2
buffer_load_dwordx4 v0,s[8:11],s67 offen sc1 lds
v_smfmac_f32_16x16x64_bf16 v[108:111],v[36:39],a[184:191],v2
ds_read_b128 v[48:51],v121 offset:4096
v_smfmac_f32_16x16x64_bf16 v[96:99],v[40:43],a[64:71],v2
buffer_store_dwordx4 v[124:127],v0,s[8:11],s54 offen sc1
v_smfmac_f32_16x16x64_bf16 v[100:103],v[40:43],a[192:199],v2
ds_read_b128 v[52:55],v122 offset:4096
v_smfmac_f32_16x16x64_bf16 v[104:107],v[40:43],a[72:79],v2
buffer_load_dwordx4 v0,s[8:11],s67 offen offset:1024 sc1 lds
s_add_u32 m0,s73,139264
v_smfmac_f32_16x16x64_bf16 v[108:111],v[40:43],a[200:207],v2
s_waitcnt lgkmcnt(2)
v_smfmac_f32_16x16x64_bf16 v[96:99],v[44:47],a[80:87],v2
buffer_load_dwordx4 v0,s[8:11],s57 offen sc1 lds
s_add_u32 s67,s67,786432
v_smfmac_f32_16x16x64_bf16 v[100:103],v[44:47],a[208:215],v2
s_waitcnt lgkmcnt(1)
v_smfmac_f32_16x16x64_bf16 v[96:99],v[48:51],a[96:103],v2
buffer_load_dwordx4 v0,s[8:11],s57 offen offset:1024 sc1 lds
v_smfmac_f32_16x16x64_bf16 v[100:103],v[48:51],a[224:231],v2
s_waitcnt lgkmcnt(0)
v_smfmac_f32_16x16x64_bf16 v[96:99],v[52:55],a[112:119],v2
v_smfmac_f32_16x16x64_bf16 v[100:103],v[52:55],a[240:247],v2
v_smfmac_f32_16x16x64_bf16 v[104:107],v[44:47],a[88:95],v2
v_smfmac_f32_16x16x64_bf16 v[108:111],v[44:47],a[216:223],v2
v_smfmac_f32_16x16x64_bf16 v[104:107],v[48:51],a[104:111],v2
v_add_f32 v96,v96,v98
v_smfmac_f32_16x16x64_bf16 v[108:111],v[48:51],a[232:239],v2
v_add_f32 v97,v97,v99
v_smfmac_f32_16x16x64_bf16 v[104:107],v[52:55],a[120:127],v2
v_cvt_pk_bf16_f32 v120,v96,v97
v_smfmac_f32_16x16x64_bf16 v[108:111],v[52:55],a[248:255],v2
v_add_f32 v100,v100,v102
v_smfmac_f32_16x16x64_bf16 v[116:119],v[28:31],v[152:159],v2
v_add_f32 v101,v101,v103
v_smfmac_f32_16x16x64_bf16 v[112:115],v[32:35],v[160:167],v2
v_cvt_pk_bf16_f32 v121,v100,v101
v_add_f32 v104,v104,v106
v_add_f32 v105,v105,v107
v_cvt_pk_bf16_f32 v122,v104,v105
v_add_f32 v108,v108,v110
v_add_f32 v109,v109,v111
v_cvt_pk_bf16_f32 v123,v108,v109
ds_write_b128 v4,v[120:123]
v_smfmac_f32_16x16x64_bf16 v[116:119],v[32:35],v[168:175],v2
s_mov_b32 s54,s68
s_add_u32 s68,s68,131072
v_mov_b32 v125,0
v_smfmac_f32_16x16x64_bf16 v[112:115],v[36:39],v[176:183],v2
s_cmp_eq_u32 s51,63
s_cbranch_scc1 L_cend_254
v_smfmac_f32_16x16x64_bf16 v[116:119],v[36:39],v[184:191],v2
s_waitcnt lgkmcnt(0)
s_barrier
ds_read_b64_tr_b16 v[96:97],v5 offset:0
v_smfmac_f32_16x16x64_bf16 v[112:115],v[40:43],v[192:199],v2
ds_read_b64_tr_b16 v[98:99],v6 offset:0
v_smfmac_f32_16x16x64_bf16 v[116:119],v[40:43],v[200:207],v2
ds_read_b64_tr_b16 v[100:101],v5 offset:1024
v_smfmac_f32_16x16x64_bf16 v[112:115],v[44:47],v[208:215],v2
ds_read_b64_tr_b16 v[102:103],v6 offset:1024
v_smfmac_f32_16x16x64_bf16 v[116:119],v[44:47],v[216:223],v2
ds_read_b64_tr_b16 v[104:105],v5 offset:2048
v_smfmac_f32_16x16x64_bf16 v[112:115],v[48:51],v[224:231],v2
ds_read_b64_tr_b16 v[106:107],v6 offset:2048
s_waitcnt lgkmcnt(4)
v_mfma_f32_16x16x32_bf16 v[24:27],v[56:59],v[96:99],0
ds_read_b64_tr_b16 v[108:109],v5 offset:3072
v_mfma_f32_16x16x32_bf16 v[28:31],v[60:63],v[96:99],0
ds_read_b64_tr_b16 v[110:111],v6 offset:3072
v_mfma_f32_16x16x32_bf16 v[32:35],v[96:99],v[96:99],0
ds_read_b128 v[40:43],v11 offset:12288
s_waitcnt lgkmcnt(5)
v_mfma_f32_16x16x32_bf16 v[24:27],v[64:67],v[100:103],v[24:27]
ds_read_b128 v[56:59],v11 offset:0
v_mfma_f32_16x16x32_bf16 v[28:31],v[68:71],v[100:103],v[28:31]
ds_read_b128 v[60:63],v11 offset:1024
v_mfma_f32_16x16x32_bf16 v[32:35],v[100:103],v[100:103],v[32:35]
ds_read_b128 v[96:99],v11 offset:8192
s_waitcnt lgkmcnt(6)
v_mfma_f32_16x16x32_bf16 v[24:27],v[72:75],v[104:107],v[24:27]
ds_read_b128 v[64:67],v11 offset:2048
v_mfma_f32_16x16x32_bf16 v[28:31],v[76:79],v[104:107],v[28:31]
ds_read_b128 v[68:71],v11 offset:3072
v_mfma_f32_16x16x32_bf16 v[32:35],v[104:107],v[104:107],v[32:35]
ds_read_b128 v[100:103],v11 offset:9216
s_waitcnt lgkmcnt(7)
v_mfma_f32_16x16x32_bf16 v[24:27],v[80:83],v[108:111],v[24:27]
ds_read_b128 v[72:75],v11 offset:4096
v_mfma_f32_16x16x32_bf16 v[28:31],v[84:87],v[108:111],v[28:31]
ds_read_b128 v[76:79],v11 offset:5120
v_mfma_f32_16x16x32_bf16 v[32:35],v[108:111],v[108:111],v[32:35]
ds_read_b128 v[104:107],v11 offset:10240
v_smfmac_f32_16x16x64_bf16 v[116:119],v[48:51],v[232:239],v2
ds_read_b128 v[80:83],v11 offset:6144
v_smfmac_f32_16x16x64_bf16 v[112:115],v[52:55],v[240:247],v2
ds_read_b128 v[84:87],v11 offset:7168
v_smfmac_f32_16x16x64_bf16 v[116:119],v[52:55],v[248:255],v2
ds_read_b128 v[108:111],v11 offset:11264
v_max3_f32 v126,v24,v25,v26
v_max3_f32 v127,v27,v28,v29
v_max3_f32 v126,v30,v31,v126
v_max3_f32 v127,v34,v35,v127
v_max_f32 v126,v126,v127
v_max_f32 v127,v126,v127
v_pk_mul_f32 v[34:35],v[34:35],v[0:1] op_sel:[0,1]
v_pk_mul_f32 v[24:25],v[24:25],v[0:1] op_sel:[0,1]
v_permlane16_swap_b32 v126,v127
v_max_f32 v126,v126,v127
v_max_f32 v127,v126,v127
v_pk_add_f32 v[112:113],v[112:113],v[114:115]
v_pk_add_f32 v[116:117],v[116:117],v[118:119]
v_permlane32_swap_b32 v126,v127
v_max_f32 v126,v126,v127
v_mul_f32 v126,v1,v126
v_pk_add_f32 v[34:35],v[34:35],v[126:127] op_sel_hi:[1,0] neg_lo:[0,1] neg_hi:[0,1]
v_pk_add_f32 v[24:25],v[24:25],v[126:127] op_sel_hi:[1,0] neg_lo:[0,1] neg_hi:[0,1]
v_pk_fma_f32 v[26:27],v[26:27],v[0:1],v[126:127] op_sel:[0,1,0] op_sel_hi:[1,1,0] neg_lo:[0,0,1] neg_hi:[0,0,1]
v_pk_fma_f32 v[28:29],v[28:29],v[0:1],v[126:127] op_sel:[0,1,0] op_sel_hi:[1,1,0] neg_lo:[0,0,1] neg_hi:[0,0,1]
v_pk_fma_f32 v[30:31],v[30:31],v[0:1],v[126:127] op_sel:[0,1,0] op_sel_hi:[1,1,0] neg_lo:[0,0,1] neg_hi:[0,0,1]
v_exp_f32 v34,v34
v_exp_f32 v35,v35
v_cvt_pk_bf16_f32 v126,v112,v113
v_cvt_pk_bf16_f32 v124,v34,v35
v_cvt_pk_bf16_f32 v127,v116,v117
v_cvt_pk_bf16_f32 v36,v116,v117
v_mfma_f32_16x16x16_bf16 v[32:35],v[14:15],v[124:125],0
ds_read_b128 v[44:47],v11 offset:13312
v_exp_f32 v24,v24
v_mfma_f32_16x16x16_bf16 v[112:115],v[126:127],v[124:125],0
ds_read_b128 v[48:51],v11 offset:14336
v_exp_f32 v25,v25
v_mfma_f32_16x16x16_bf16 v[116:119],v[36:37],v[124:125],0
ds_read_b128 v[52:55],v11 offset:15360
v_exp_f32 v26,v26
v_exp_f32 v27,v27
v_cvt_pk_bf16_f32 v120,v24,v25
v_exp_f32 v28,v28
v_exp_f32 v29,v29
v_cvt_pk_bf16_f32 v121,v26,v27
v_exp_f32 v30,v30
v_exp_f32 v31,v31
v_cvt_pk_bf16_f32 v122,v28,v29
v_cvt_pk_bf16_f32 v123,v30,v31
s_add_u32 s75,s75,8192
s_add_u32 s51,s51,1
v_mfma_f32_16x16x32_bf16 v[32:35],v[14:17],v[120:123],v[32:35]
v_mfma_f32_16x16x32_bf16 v[112:115],v[88:91],v[120:123],v[112:115]
ds_read_b128 v[88:91],v11 offset:16384
v_mfma_f32_16x16x32_bf16 v[116:119],v[92:95],v[120:123],v[116:119]
ds_read_b128 v[92:95],v11 offset:17408
v_rcp_f32 v32,v32
v_mov_b64 v[24:25],-1
v_mov_b64 v[26:27],-1
s_add_u32 s64,s75,11534336
s_add_u32 s70,s64,4096
v_pk_mul_f32 v[112:113],v[112:113],v[32:33] op_sel_hi:[1,0]
v_pk_mul_f32 v[114:115],v[114:115],v[32:33] op_sel_hi:[1,0]
v_pk_mul_f32 v[116:117],v[116:117],v[32:33] op_sel_hi:[1,0]
v_pk_mul_f32 v[118:119],v[118:119],v[32:33] op_sel_hi:[1,0]
v_cvt_pk_bf16_f32 v120,v112,v116
v_cvt_pk_bf16_f32 v121,v113,v117
v_cvt_pk_bf16_f32 v122,v114,v118
v_cvt_pk_bf16_f32 v123,v115,v119
ds_write_b128 v7,v[120:123]
buffer_store_dwordx4 v[24:27],v0,s[8:11],s69 offen sc1
buffer_store_dwordx4 v[24:27],v0,s[8:11],s69 offen offset:1024 sc1
v_mov_b64 v[112:113],0
v_mov_b64 v[114:115],0
v_mov_b64 v[116:117],0
v_mov_b64 v[118:119],0
s_waitcnt lgkmcnt(0)
s_barrier
ds_read_b128 v[24:27],v8 offset:0
ds_read_b128 v[28:31],v8 offset:512
ds_read_b128 v[32:35],v8 offset:1024
ds_read_b128 v[36:39],v8 offset:1536
v_mov_b64 v[120:121],0
v_mov_b64 v[122:123],0
s_add_u32 s57,s65,65536
s_add_u32 s58,s65,131072
s_add_u32 s59,s65,196608
s_add_u32 s56,s18,s75
s_waitcnt lgkmcnt(3)
v_smfmac_f32_16x16x64_bf16 v[112:115],v[24:27],v[56:63],v3
ds_read_b128 v[56:59],v11 offset:18432
s_waitcnt lgkmcnt(3)
v_smfmac_f32_16x16x64_bf16 v[112:115],v[28:31],v[64:71],v3
ds_read_b128 v[60:63],v11 offset:19456
s_waitcnt lgkmcnt(3)
v_smfmac_f32_16x16x64_bf16 v[112:115],v[32:35],v[72:79],v3
ds_read_b128 v[64:67],v11 offset:20480
s_waitcnt lgkmcnt(3)
v_smfmac_f32_16x16x64_bf16 v[112:115],v[36:39],v[80:87],v3
ds_read_b128 v[68:71],v11 offset:21504
v_smfmac_f32_16x16x64_bf16 v[116:119],v[24:27],v[96:103],v3
ds_read_b128 v[72:75],v11 offset:22528
v_smfmac_f32_16x16x64_bf16 v[116:119],v[28:31],v[104:111],v3
ds_read_b128 v[76:79],v11 offset:23552
v_cvt_pk_bf16_f32 v112,v112,v113
v_smfmac_f32_16x16x64_bf16 v[116:119],v[32:35],v[40:47],v3
ds_read_b128 v[80:83],v11 offset:24576
v_cvt_pk_bf16_f32 v113,v114,v115
buffer_store_dwordx2 v[112:113],v9,s[8:11],s65 offen sc1
v_smfmac_f32_16x16x64_bf16 v[116:119],v[36:39],v[48:55],v3
ds_read_b128 v[84:87],v11 offset:25600
v_mov_b64 v[112:113],0
v_smfmac_f32_16x16x64_bf16 v[120:123],v[24:27],v[88:95],v3
ds_read_b128 v[96:99],v11 offset:26624
ds_read_b128 v[100:103],v11 offset:27648
v_mov_b64 v[114:115],0
s_waitcnt lgkmcnt(8)
v_smfmac_f32_16x16x64_bf16 v[120:123],v[28:31],v[56:63],v3
ds_read_b128 v[104:107],v11 offset:28672
v_cvt_pk_bf16_f32 v116,v116,v117
s_waitcnt lgkmcnt(7)
v_smfmac_f32_16x16x64_bf16 v[120:123],v[32:35],v[64:71],v3
ds_read_b128 v[108:111],v11 offset:29696
ds_read_b128 v[40:43],v11 offset:30720
v_cvt_pk_bf16_f32 v117,v118,v119
buffer_store_dwordx2 v[116:117],v9,s[8:11],s57 offen sc1
s_waitcnt lgkmcnt(7)
v_smfmac_f32_16x16x64_bf16 v[120:123],v[36:39],v[72:79],v3
ds_read_b128 v[44:47],v11 offset:31744
v_add_u32 v52,s50,v5
s_waitcnt lgkmcnt(6)
v_smfmac_f32_16x16x64_bf16 v[112:115],v[24:27],v[80:87],v3
v_add_u32 v54,s50,v6
s_waitcnt lgkmcnt(4)
v_smfmac_f32_16x16x64_bf16 v[112:115],v[28:31],v[96:103],v3
ds_read_b64_tr_b16 v[52:53],v52
v_cvt_pk_bf16_f32 v120,v120,v121
s_waitcnt lgkmcnt(3)
v_smfmac_f32_16x16x64_bf16 v[112:115],v[32:35],v[104:111],v3
ds_read_b64_tr_b16 v[54:55],v54
v_cvt_pk_bf16_f32 v121,v122,v123
buffer_store_dwordx2 v[120:121],v9,s[8:11],s58 offen sc1
s_waitcnt lgkmcnt(2)
v_smfmac_f32_16x16x64_bf16 v[112:115],v[36:39],v[40:47],v3
v_mov_b64 v[116:117],0
v_mov_b64 v[118:119],0
s_xor_b32 s65,s65,262144
v_mov_b32_dpp v124,v126 quad_perm:[2,3,2,3] row_mask:0xf bank_mask:0xf
v_mov_b32_dpp v125,v127 quad_perm:[2,3,2,3] row_mask:0xf bank_mask:0xf
s_mov_b32 vcc_lo,0xcccccccc
s_mov_b32 vcc_hi,0xcccccccc
s_nop 0
v_cvt_pk_bf16_f32 v112,v112,v113
v_cvt_pk_bf16_f32 v113,v114,v115
buffer_store_dwordx2 v[112:113],v9,s[8:11],s59 offen sc1
s_waitcnt lgkmcnt(0)
s_buffer_load_dword s19,s[8:11],s56
v_cndmask_b32 v124,v124,v52,vcc
v_cndmask_b32 v125,v125,v53,vcc
s_cmp_lt_u32 s46,2
s_waitcnt vmcnt(3)
s_cbranch_scc1 L_crg_261
s_cmp_eq_u32 s46,2
s_waitcnt vmcnt(1)
s_cbranch_scc1 L_crg_261
s_waitcnt vmcnt(0)
L_crg_261:
buffer_load_dwordx4 v[32:35],v0,s[8:11],s66 offen offset:0 sc1
buffer_load_dwordx4 v[36:39],v0,s[8:11],s66 offen offset:1024 sc1
v_cndmask_b32 v126,v126,v54,vcc
v_cndmask_b32 v127,v127,v55,vcc
v_mov_b64 v[96:97],0
v_mov_b64 v[98:99],0
v_mov_b64 v[100:101],0
v_mov_b64 v[102:103],0
v_mov_b64 v[104:105],0
v_mov_b64 v[106:107],0
v_mov_b64 v[108:109],0
v_mov_b64 v[110:111],0
v_mov_b64 v[112:113],0
v_mov_b64 v[114:115],0
v_add_u32 v55,131072,v0
v_add_u32 v123,s73,v55
v_xor_b32 v120,1024,v12
v_xor_b32 v121,2048,v12
v_xor_b32 v122,3072,v12
buffer_load_dwordx4 v[44:47],v0,s[8:11],s66 offen offset:0 sc1
buffer_load_dwordx4 v[48:51],v0,s[8:11],s66 offen offset:1024 sc1
s_cmp_ge_u32 s51,63
s_cselect_b32 s76,0,1
s_cmp_eq_u32 s46,0
s_cselect_b32 s76,s76,0
s_waitcnt vmcnt(3)
v_mfma_f32_16x16x32_bf16 v[28:31],v[18:21],v[32:35],0
s_waitcnt vmcnt(2)
v_mfma_f32_16x16x32_bf16 v[28:31],v[18:21],v[36:39],v[28:31]
s_nop 7
v_cmp_u_f32 vcc,v28,v28
v_add_f32_dpp v52,v28,v28 row_ror:8 row_mask:0xf bank_mask:0x3
v_add_f32_dpp v53,v29,v29 row_ror:8 row_mask:0xf bank_mask:0x3
v_add_f32_dpp v52,v30,v30 row_ror:8 row_mask:0xf bank_mask:0xc
v_add_f32_dpp v53,v31,v31 row_ror:8 row_mask:0xf bank_mask:0xc
s_cbranch_vccnz L_crp_256
L_cok_262:
v_add_f32_dpp v52,v52,v52 row_shl:4 row_mask:0xf bank_mask:0x5
v_add_f32_dpp v53,v53,v53 row_shl:4 row_mask:0xf bank_mask:0x5
v_cvt_pk_bf16_f32 v54,v52,v53
buffer_store_dword v54,v10,s[8:11],s64 offen sc1
s_mov_b32 s69,s66
s_xor_b32 s66,s66,262144
s_barrier
ds_read_b128 v[56:59],v55 offset:0
ds_read_b128 v[60:63],v55 offset:4096
ds_read_b128 v[64:67],v55 offset:1024
buffer_load_dwordx4 v[24:27],v13,s[8:11],s64 offen sc1
ds_read_b128 v[68:71],v55 offset:5120
ds_read_b128 v[72:75],v55 offset:2048
ds_read_b128 v[76:79],v55 offset:6144
ds_read_b128 v[80:83],v55 offset:3072
buffer_load_dwordx4 v[24:27],v13,s[8:11],s64 offen sc1
ds_read_b128 v[84:87],v55 offset:7168
ds_read_b128 v[88:91],v123 offset:8192
ds_read_b128 v[92:95],v123 offset:9216
s_branch L_chain_251
L_cpb_258:
buffer_load_dwordx4 v[40:43],v13,s[8:11],s70 offen sc1
s_sub_u32 s49,s49,1
s_cbranch_scc1 L_abort2
s_waitcnt vmcnt(0)
v_max3_u32 v123,v40,v41,v42
v_max_u32 v123,v43,v123
v_cmp_le_u32 vcc,s72,v123
s_cbranch_vccnz L_cpb_258
ds_write_b128 v12,v[40:43] offset:4096
s_branch L_cback_260
L_crp_256:
buffer_load_dwordx4 v[32:35],v0,s[8:11],s66 offen offset:0 sc1
buffer_load_dwordx4 v[36:39],v0,s[8:11],s66 offen offset:1024 sc1
s_sub_u32 s49,s49,1
s_cbranch_scc1 L_abort2
s_waitcnt vmcnt(3)
v_mfma_f32_16x16x32_bf16 v[28:31],v[18:21],v[44:47],0
s_waitcnt vmcnt(2)
v_mfma_f32_16x16x32_bf16 v[28:31],v[18:21],v[48:51],v[28:31]
s_nop 7
v_cmp_u_f32 vcc,v28,v28
v_add_f32_dpp v52,v28,v28 row_ror:8 row_mask:0xf bank_mask:0x3
v_add_f32_dpp v53,v29,v29 row_ror:8 row_mask:0xf bank_mask:0x3
v_add_f32_dpp v52,v30,v30 row_ror:8 row_mask:0xf bank_mask:0xc
v_add_f32_dpp v53,v31,v31 row_ror:8 row_mask:0xf bank_mask:0xc
s_cbranch_vccz L_cok_262
buffer_load_dwordx4 v[44:47],v0,s[8:11],s66 offen offset:0 sc1
buffer_load_dwordx4 v[48:51],v0,s[8:11],s66 offen offset:1024 sc1
s_sub_u32 s49,s49,1
s_cbranch_scc1 L_abort2
s_waitcnt vmcnt(3)
v_mfma_f32_16x16x32_bf16 v[28:31],v[18:21],v[32:35],0
s_waitcnt vmcnt(2)
v_mfma_f32_16x16x32_bf16 v[28:31],v[18:21],v[36:39],v[28:31]
s_nop 7
v_cmp_u_f32 vcc,v28,v28
v_add_f32_dpp v52,v28,v28 row_ror:8 row_mask:0xf bank_mask:0x3
v_add_f32_dpp v53,v29,v29 row_ror:8 row_mask:0xf bank_mask:0x3
v_add_f32_dpp v52,v30,v30 row_ror:8 row_mask:0xf bank_mask:0xc
v_add_f32_dpp v53,v31,v31 row_ror:8 row_mask:0xf bank_mask:0xc
s_cbranch_vccz L_cok_262
s_branch L_crp_256
L_ckw_244:
s_add_u32 s59,s18,s75
L_ww_263:
buffer_load_dword v23,off,s[8:11],s59 sc1
s_sub_u32 s49,s49,1
s_cbranch_scc1 L_abort2
s_waitcnt vmcnt(0)
v_readfirstlane_b32 s76,v23
s_cmp_eq_u32 s76,0
s_cbranch_scc1 L_ww_263
L_wwd_264:
s_branch L_ckb_245
L_cend_254:
v_smfmac_f32_16x16x64_bf16 v[116:119],v[36:39],v[184:191],v2
v_smfmac_f32_16x16x64_bf16 v[112:115],v[40:43],v[192:199],v2
v_smfmac_f32_16x16x64_bf16 v[116:119],v[40:43],v[200:207],v2
v_smfmac_f32_16x16x64_bf16 v[112:115],v[44:47],v[208:215],v2
v_smfmac_f32_16x16x64_bf16 v[116:119],v[44:47],v[216:223],v2
v_smfmac_f32_16x16x64_bf16 v[112:115],v[48:51],v[224:231],v2
v_smfmac_f32_16x16x64_bf16 v[116:119],v[48:51],v[232:239],v2
v_smfmac_f32_16x16x64_bf16 v[112:115],v[52:55],v[240:247],v2
v_smfmac_f32_16x16x64_bf16 v[116:119],v[52:55],v[248:255],v2
s_waitcnt lgkmcnt(0)
s_nop 2
v_pk_add_f32 v[112:113],v[112:113],v[114:115]
s_nop 2
v_pk_add_f32 v[116:117],v[116:117],v[118:119]
v_cvt_pk_bf16_f32 v126,v112,v113
v_cvt_pk_bf16_f32 v127,v116,v117
v_add_u32 v52,s50,v5
v_add_u32 v54,s50,v6
ds_read_b64_tr_b16 v[52:53],v52
ds_read_b64_tr_b16 v[54:55],v54
v_mov_b32_dpp v124,v126 quad_perm:[2,3,2,3] row_mask:0xf bank_mask:0xf
v_mov_b32_dpp v125,v127 quad_perm:[2,3,2,3] row_mask:0xf bank_mask:0xf
s_mov_b32 vcc_lo,0xcccccccc
s_mov_b32 vcc_hi,0xcccccccc
s_waitcnt lgkmcnt(0)
v_cndmask_b32 v124,v124,v52,vcc
v_cndmask_b32 v125,v125,v53,vcc
v_cndmask_b32 v126,v126,v54,vcc
v_cndmask_b32 v127,v127,v55,vcc
buffer_store_dwordx4 v[124:127],v0,s[8:11],s54 offen sc1
s_mov_b32 s51,64
s_waitcnt vmcnt(0)
s_barrier
s_nop 11
v_lshrrev_b32 v1,4,v0
s_mov_b32 s53,0
s_branch L_rb_7
L_rc1_238:
v_and_b32 v120,15,v1
v_lshrrev_b32 v121,4,v1
v_and_b32 v122,2,v1
v_cmp_eq_u32 vcc,0,v122
v_mov_b32 v2,0xeeee
v_mov_b32 v123,0x4444
v_cndmask_b32 v2,v2,v123,vcc
v_and_b32 v122,1,v1
v_cmp_eq_u32 vcc,0,v122
v_mov_b32 v3,0xdddd
v_mov_b32 v123,0x8888
v_cndmask_b32 v3,v3,v123,vcc
v_lshrrev_b32 v122,1,v120
v_bfe_u32 v123,v120,2,1
v_xor_b32 v123,v123,v122
v_lshlrev_b32 v4,7,v123
v_and_b32 v123,1,v120
v_lshl_add_u32 v4,v123,6,v4
v_xor_b32 v123,v121,v122
v_and_b32 v123,3,v123
v_lshl_add_u32 v4,v123,4,v4
s_lshl_b32 s56,s46,10
s_add_u32 s56,s56,147456
v_add_u32 v4,s56,v4
v_lshlrev_b32 v122,1,v121
v_add_u32 v122,0,v122
v_and_b32 v123,1,v121
v_xor_b32 v123,v123,v122
v_lshlrev_b32 v5,7,v123
v_bfe_u32 v123,v120,3,1
v_lshl_add_u32 v5,v123,6,v5
v_xor_b32 v123,v120,v122
v_and_b32 v123,3,v123
v_lshl_add_u32 v5,v123,4,v5
v_bfe_u32 v123,v120,2,1
v_lshl_add_u32 v5,v123,3,v5
v_add_u32 v5,147456,v5
v_lshlrev_b32 v122,1,v121
v_add_u32 v122,1,v122
v_and_b32 v123,1,v121
v_xor_b32 v123,v123,v122
v_lshlrev_b32 v6,7,v123
v_bfe_u32 v123,v120,3,1
v_lshl_add_u32 v6,v123,6,v6
v_xor_b32 v123,v120,v122
v_and_b32 v123,3,v123
v_lshl_add_u32 v6,v123,4,v6
v_bfe_u32 v123,v120,2,1
v_lshl_add_u32 v6,v123,3,v6
v_add_u32 v6,147456,v6
v_lshlrev_b32 v7,7,v121
v_lshrrev_b32 v122,1,v120
v_lshl_add_u32 v8,v122,4,v7
v_add_u32 v8,151552,v8
v_lshrrev_b32 v122,2,v120
v_lshl_add_u32 v7,v122,5,v7
v_and_b32 v122,1,v120
v_lshl_add_u32 v7,v122,4,v7
v_and_b32 v122,2,v120
v_cmp_eq_u32 vcc,0,v122
s_lshl_b32 s56,s46,9
v_mov_b32 v122,2048
v_mov_b32 v123,s56
v_cndmask_b32 v122,v122,v123,vcc
v_add_u32 v7,v122,v7
v_add_u32 v7,151552,v7
v_lshrrev_b32 v122,3,v1
v_lshlrev_b32 v9,11,v122
v_and_b32 v122,7,v1
v_lshl_add_u32 v9,v122,3,v9
s_lshl_b32 s56,s46,14
s_lshl_b32 s57,s47,6
s_add_u32 s56,s56,s57
v_add_u32 v9,s56,v9
s_lshl_b32 s71,s46,5
s_add_u32 s71,s71,s47
s_bfe_u32 s56,s71,0x10003
s_lshl_b32 s56,s56,11
s_and_b32 s57,s71,1
s_lshl_b32 s57,s57,10
s_add_u32 s56,s56,s57
s_bfe_u32 s57,s71,0x10002
s_lshl_b32 s57,s57,9
s_add_u32 s56,s56,s57
s_bfe_u32 s57,s71,0x10001
s_lshl_b32 s57,s57,6
s_add_u32 s56,s56,s57
s_bfe_u32 s57,s71,0x10004
s_lshl_b32 s57,s57,8
s_add_u32 s56,s56,s57
s_bfe_u32 s57,s71,0x10005
s_lshl_b32 s57,s57,7
s_add_u32 s56,s56,s57
s_bfe_u32 s57,s71,0x10006
s_lshl_b32 s57,s57,12
s_add_u32 s56,s56,s57
v_and_b32 v122,3,v120
v_lshlrev_b32 v10,2,v122
v_bfe_u32 v122,v120,3,1
v_lshl_add_u32 v10,v122,4,v10
v_and_b32 v122,1,v121
v_lshl_add_u32 v10,v122,5,v10
v_add_u32 v10,s56,v10
v_and_b32 v123,36,v1
v_mov_b32 v122,0x80000000
v_cmp_eq_u32 vcc,0,v123
s_nop 1
v_cndmask_b32 v10,v122,v10,vcc
s_lshl_b32 s71,s71,11
s_lshl_b32 s73,s46,11
s_mov_b32 s72,0xffc00000
s_mov_b32 s74,0
v_and_b32 v11,1,v121
v_xor_b32 v11,v11,v120
v_and_b32 v11,3,v11
v_lshrrev_b32 v122,2,v120
v_lshl_add_u32 v11,v11,2,v122
v_lshl_add_u32 v11,v121,4,v11
v_lshlrev_b32 v11,4,v11
s_lshl_b32 s56,s46,15
v_add_u32 v11,s56,v11
v_lshrrev_b32 v13,3,v1
v_lshlrev_b32 v13,9,v13
v_and_b32 v122,7,v1
v_lshl_add_u32 v13,v122,4,v13
v_and_b32 v122,15,v1
v_and_b32 v123,1,v1
v_lshlrev_b32 v123,4,v123
v_mov_b32 v124,0x3f80
v_lshlrev_b32 v124,v123,v124
v_lshrrev_b32 v122,1,v122
v_cmp_eq_u32 vcc,0,v122
s_nop 1
v_cndmask_b32 v18,0,v124,vcc
v_cmp_eq_u32 vcc,1,v122
s_nop 1
v_cndmask_b32 v19,0,v124,vcc
v_cmp_eq_u32 vcc,2,v122
s_nop 1
v_cndmask_b32 v20,0,v124,vcc
v_cmp_eq_u32 vcc,3,v122
s_nop 1
v_cndmask_b32 v21,0,v124,vcc
s_and_b32 s56,s46,1
s_lshl_b32 s56,s56,8
s_and_b32 s57,s46,2
s_lshl_b32 s57,s57,6
s_add_u32 s56,s56,s57
v_add_u32 v13,s56,v13
s_add_u32 s56,s50,155648
v_add_u32 v12,s56,v0
v_mov_b64 v[14:15],s[28:29]
v_mov_b64 v[16:17],s[28:29]
v_add_u32 v22,12599296,v10
s_lshl_b32 s18,s47,2
s_add_u32 s18,s18,10494080
v_mov_b32 v1,s80
s_mov_b32 s65,15728640
s_add_u32 s66,s71,15728640
s_add_u32 s69,s71,15990784
s_mov_b32 s30,0x40000000
s_mov_b32 s51,0
L_cst_268:
s_cmp_lg_u32 s46,0
s_cbranch_scc1 L_csw_273
s_lshl_b32 s59,s51,13
s_lshl2_add_u32 s59,s47,s59
s_add_u32 s59,s59,10485888
L_ww_274:
s_sleep 1
buffer_load_dword v122,off,s[8:11],s59 sc1
s_sub_u32 s49,s49,1
s_cbranch_scc1 L_abort2
s_waitcnt vmcnt(0)
v_readfirstlane_b32 s61,v122
s_cmp_eq_u32 s61,0
s_cbranch_scc1 L_ww_274
L_wwd_275:
L_csw_273:
s_waitcnt lgkmcnt(0)
s_barrier
s_lshl_b32 s56,s51,5
s_add_u32 s56,s56,s47
s_mul_i32 s56,s56,24576
s_add_u32 s56,s56,150994944
s_add_u32 s67,s56,s73
s_add_u32 m0,s73,131072
s_add_u32 s57,s67,8192
buffer_load_dwordx4 v0,s[8:11],s67 offen sc1 lds
buffer_load_dwordx4 v0,s[8:11],s67 offen offset:1024 sc1 lds
s_add_u32 m0,s73,139264
s_add_u32 s67,s67,786432
buffer_load_dwordx4 v0,s[8:11],s57 offen sc1 lds
buffer_load_dwordx4 v0,s[8:11],s57 offen offset:1024 sc1 lds
s_lshl_b32 s75,s51,13
s_add_u32 s56,s75,12591104
buffer_load_dword v23,v10,s[8:11],s56 offen sc1
s_add_u32 s64,s75,12582912
s_add_u32 s70,s64,4096
s_lshl_b32 s68,s51,5
s_add_u32 s68,s68,s47
s_lshl_b32 s68,s68,12
s_lshl_b32 s56,s46,10
s_add_u32 s68,s68,s56
s_add_u32 s68,s68,58720256
s_mov_b32 s54,0x80000000
s_mov_b32 s77,0
s_add_u32 s56,s18,s75
s_buffer_load_dword s19,s[8:11],s56
s_cmp_eq_u32 s51,63
s_cselect_b32 s76,1,s46
s_cmp_eq_u32 s76,0
s_cselect_b32 s76,1,0
v_mov_b64 v[96:97],0
v_mov_b64 v[98:99],0
v_mov_b64 v[100:101],0
v_mov_b64 v[102:103],0
v_mov_b64 v[104:105],0
v_mov_b64 v[106:107],0
v_mov_b64 v[108:109],0
v_mov_b64 v[110:111],0
v_mov_b64 v[112:113],0
v_mov_b64 v[114:115],0
v_mov_b64 v[116:117],0
v_mov_b64 v[118:119],0
s_waitcnt vmcnt(0) lgkmcnt(0)
s_barrier
v_add_u32 v55,131072,v0
ds_read_b128 v[56:59],v55 offset:0
ds_read_b128 v[60:63],v55 offset:4096
ds_read_b128 v[64:67],v55 offset:1024
ds_read_b128 v[68:71],v55 offset:5120
ds_read_b128 v[72:75],v55 offset:2048
ds_read_b128 v[76:79],v55 offset:6144
ds_read_b128 v[80:83],v55 offset:3072
ds_read_b128 v[84:87],v55 offset:7168
v_add_u32 v123,s73,v55
ds_read_b128 v[88:91],v123 offset:8192
ds_read_b128 v[92:95],v123 offset:9216
v_xor_b32 v120,1024,v12
v_xor_b32 v121,2048,v12
v_xor_b32 v122,3072,v12
buffer_load_dwordx4 v[24:27],v13,s[8:11],s64 offen sc1
buffer_load_dwordx4 v[24:27],v13,s[8:11],s64 offen sc1
.p2align 6
L_chain_276:
L_cpa_277:
buffer_load_dwordx4 v[24:27],v13,s[8:11],s64 offen sc1
s_sub_u32 s49,s49,1
s_cbranch_scc1 L_abort2
s_waitcnt vmcnt(2)
v_max3_u32 v123,v24,v25,v26
v_max_u32 v123,v27,v123
v_cmp_le_u32 vcc,s72,v123
ds_write_b128 v12,v[24:27] offset:0
s_cbranch_vccnz L_cpa_277
L_cgo_280:
v_smfmac_f32_16x16x64_bf16 v[96:99],v[24:27],a[0:7],v2
buffer_load_dwordx4 v[40:43],v13,s[8:11],s70 offen sc1
s_waitcnt lgkmcnt(0)
s_barrier
ds_read_b128 v[28:31],v120 offset:0
v_smfmac_f32_16x16x64_bf16 v[100:103],v[24:27],a[128:135],v2
ds_read_b128 v[32:35],v121 offset:0
v_smfmac_f32_16x16x64_bf16 v[104:107],v[24:27],a[8:15],v2
ds_read_b128 v[36:39],v122 offset:0
v_smfmac_f32_16x16x64_bf16 v[108:111],v[24:27],a[136:143],v2
v_smfmac_f32_16x16x64_bf16 v[112:115],v[24:27],v[128:135],v2
v_smfmac_f32_16x16x64_bf16 v[116:119],v[24:27],v[136:143],v2
s_waitcnt lgkmcnt(2)
v_smfmac_f32_16x16x64_bf16 v[96:99],v[28:31],a[16:23],v2
s_add_u32 m0,s73,131072
v_smfmac_f32_16x16x64_bf16 v[100:103],v[28:31],a[144:151],v2
s_add_u32 s57,s67,8192
v_smfmac_f32_16x16x64_bf16 v[104:107],v[28:31],a[24:31],v2
s_cmp_lt_u32 s19,s76
s_cbranch_scc1 L_ckw_269
L_ckb_270:
v_smfmac_f32_16x16x64_bf16 v[108:111],v[28:31],a[152:159],v2
s_waitcnt vmcnt(0) lgkmcnt(1)
v_smfmac_f32_16x16x64_bf16 v[96:99],v[32:35],a[32:39],v2
ds_write_b128 v12,v[40:43] offset:4096
v_max3_u32 v123,v40,v41,v42
v_smfmac_f32_16x16x64_bf16 v[100:103],v[32:35],a[160:167],v2
v_max_u32 v123,v43,v123
v_smfmac_f32_16x16x64_bf16 v[104:107],v[32:35],a[40:47],v2
v_cmp_le_u32 vcc,s72,v123
v_smfmac_f32_16x16x64_bf16 v[108:111],v[32:35],a[168:175],v2
v_smfmac_f32_16x16x64_bf16 v[112:115],v[28:31],v[144:151],v2
s_cbranch_vccnz L_cpb_283
L_cback_285:
s_waitcnt lgkmcnt(0)
s_barrier
v_smfmac_f32_16x16x64_bf16 v[96:99],v[36:39],a[48:55],v2
buffer_store_dword v54,v10,s[8:11],s30 offen sc1
v_smfmac_f32_16x16x64_bf16 v[100:103],v[36:39],a[176:183],v2
ds_read_b128 v[44:47],v120 offset:4096
v_smfmac_f32_16x16x64_bf16 v[104:107],v[36:39],a[56:63],v2
buffer_load_dword v23,v22,s[8:11],s75 offen sc1
v_smfmac_f32_16x16x64_bf16 v[108:111],v[36:39],a[184:191],v2
ds_read_b128 v[48:51],v121 offset:4096
v_smfmac_f32_16x16x64_bf16 v[96:99],v[40:43],a[64:71],v2
buffer_load_dwordx4 v0,s[8:11],s67 offen sc1 lds
v_smfmac_f32_16x16x64_bf16 v[100:103],v[40:43],a[192:199],v2
ds_read_b128 v[52:55],v122 offset:4096
v_smfmac_f32_16x16x64_bf16 v[104:107],v[40:43],a[72:79],v2
buffer_store_dwordx4 v[124:127],v0,s[8:11],s54 offen sc1
v_smfmac_f32_16x16x64_bf16 v[108:111],v[40:43],a[200:207],v2
s_waitcnt lgkmcnt(2)
v_smfmac_f32_16x16x64_bf16 v[96:99],v[44:47],a[80:87],v2
buffer_load_dwordx4 v0,s[8:11],s67 offen offset:1024 sc1 lds
s_add_u32 m0,s73,139264
v_smfmac_f32_16x16x64_bf16 v[100:103],v[44:47],a[208:215],v2
s_waitcnt lgkmcnt(1)
v_smfmac_f32_16x16x64_bf16 v[96:99],v[48:51],a[96:103],v2
buffer_load_dwordx4 v0,s[8:11],s57 offen sc1 lds
s_add_u32 s67,s67,786432
v_smfmac_f32_16x16x64_bf16 v[100:103],v[48:51],a[224:231],v2
s_waitcnt lgkmcnt(0)
v_smfmac_f32_16x16x64_bf16 v[96:99],v[52:55],a[112:119],v2
buffer_load_dwordx4 v0,s[8:11],s57 offen offset:1024 sc1 lds
v_smfmac_f32_16x16x64_bf16 v[100:103],v[52:55],a[240:247],v2
v_smfmac_f32_16x16x64_bf16 v[104:107],v[44:47],a[88:95],v2
v_smfmac_f32_16x16x64_bf16 v[108:111],v[44:47],a[216:223],v2
v_smfmac_f32_16x16x64_bf16 v[104:107],v[48:51],a[104:111],v2
v_add_f32 v96,v96,v98
v_smfmac_f32_16x16x64_bf16 v[108:111],v[48:51],a[232:239],v2
v_add_f32 v97,v97,v99
v_smfmac_f32_16x16x64_bf16 v[104:107],v[52:55],a[120:127],v2
v_cvt_pk_bf16_f32 v120,v96,v97
v_smfmac_f32_16x16x64_bf16 v[108:111],v[52:55],a[248:255],v2
v_add_f32 v100,v100,v102
v_smfmac_f32_16x16x64_bf16 v[116:119],v[28:31],v[152:159],v2
v_add_f32 v101,v101,v103
v_smfmac_f32_16x16x64_bf16 v[112:115],v[32:35],v[160:167],v2
v_cvt_pk_bf16_f32 v121,v100,v101
v_add_f32 v104,v104,v106
v_add_f32 v105,v105,v107
v_cvt_pk_bf16_f32 v122,v104,v105
v_add_f32 v108,v108,v110
v_add_f32 v109,v109,v111
v_cvt_pk_bf16_f32 v123,v108,v109
ds_write_b128 v4,v[120:123]
v_smfmac_f32_16x16x64_bf16 v[116:119],v[32:35],v[168:175],v2
s_mov_b32 s54,s68
s_add_u32 s68,s68,131072
v_mov_b32 v125,0
v_smfmac_f32_16x16x64_bf16 v[112:115],v[36:39],v[176:183],v2
s_cmp_eq_u32 s51,63
s_cbranch_scc1 L_cend_279
v_smfmac_f32_16x16x64_bf16 v[116:119],v[36:39],v[184:191],v2
s_waitcnt lgkmcnt(0)
s_barrier
ds_read_b64_tr_b16 v[96:97],v5 offset:0
v_smfmac_f32_16x16x64_bf16 v[112:115],v[40:43],v[192:199],v2
ds_read_b64_tr_b16 v[98:99],v6 offset:0
v_smfmac_f32_16x16x64_bf16 v[116:119],v[40:43],v[200:207],v2
ds_read_b64_tr_b16 v[100:101],v5 offset:1024
v_smfmac_f32_16x16x64_bf16 v[112:115],v[44:47],v[208:215],v2
ds_read_b64_tr_b16 v[102:103],v6 offset:1024
v_smfmac_f32_16x16x64_bf16 v[116:119],v[44:47],v[216:223],v2
ds_read_b64_tr_b16 v[104:105],v5 offset:2048
v_smfmac_f32_16x16x64_bf16 v[112:115],v[48:51],v[224:231],v2
ds_read_b64_tr_b16 v[106:107],v6 offset:2048
s_waitcnt lgkmcnt(4)
v_mfma_f32_16x16x32_bf16 v[24:27],v[56:59],v[96:99],0
ds_read_b64_tr_b16 v[108:109],v5 offset:3072
v_mfma_f32_16x16x32_bf16 v[28:31],v[60:63],v[96:99],0
ds_read_b64_tr_b16 v[110:111],v6 offset:3072
v_mfma_f32_16x16x32_bf16 v[32:35],v[96:99],v[96:99],0
ds_read_b128 v[40:43],v11 offset:12288
s_waitcnt lgkmcnt(5)
v_mfma_f32_16x16x32_bf16 v[24:27],v[64:67],v[100:103],v[24:27]
ds_read_b128 v[56:59],v11 offset:0
v_mfma_f32_16x16x32_bf16 v[28:31],v[68:71],v[100:103],v[28:31]
ds_read_b128 v[60:63],v11 offset:1024
v_mfma_f32_16x16x32_bf16 v[32:35],v[100:103],v[100:103],v[32:35]
ds_read_b128 v[96:99],v11 offset:8192
s_waitcnt lgkmcnt(6)
v_mfma_f32_16x16x32_bf16 v[24:27],v[72:75],v[104:107],v[24:27]
ds_read_b128 v[64:67],v11 offset:2048
v_mfma_f32_16x16x32_bf16 v[28:31],v[76:79],v[104:107],v[28:31]
ds_read_b128 v[68:71],v11 offset:3072
v_mfma_f32_16x16x32_bf16 v[32:35],v[104:107],v[104:107],v[32:35]
ds_read_b128 v[100:103],v11 offset:9216
s_waitcnt lgkmcnt(7)
v_mfma_f32_16x16x32_bf16 v[24:27],v[80:83],v[108:111],v[24:27]
ds_read_b128 v[72:75],v11 offset:4096
v_mfma_f32_16x16x32_bf16 v[28:31],v[84:87],v[108:111],v[28:31]
ds_read_b128 v[76:79],v11 offset:5120
v_mfma_f32_16x16x32_bf16 v[32:35],v[108:111],v[108:111],v[32:35]
ds_read_b128 v[104:107],v11 offset:10240
v_smfmac_f32_16x16x64_bf16 v[116:119],v[48:51],v[232:239],v2
ds_read_b128 v[80:83],v11 offset:6144
v_smfmac_f32_16x16x64_bf16 v[112:115],v[52:55],v[240:247],v2
ds_read_b128 v[84:87],v11 offset:7168
v_smfmac_f32_16x16x64_bf16 v[116:119],v[52:55],v[248:255],v2
ds_read_b128 v[108:111],v11 offset:11264
v_max3_f32 v126,v24,v25,v26
v_max3_f32 v127,v27,v28,v29
v_max3_f32 v126,v30,v31,v126
v_max3_f32 v127,v34,v35,v127
v_max_f32 v126,v126,v127
v_max_f32 v127,v126,v127
v_pk_mul_f32 v[34:35],v[34:35],v[0:1] op_sel:[0,1]
v_pk_mul_f32 v[24:25],v[24:25],v[0:1] op_sel:[0,1]
v_permlane16_swap_b32 v126,v127
v_max_f32 v126,v126,v127
v_max_f32 v127,v126,v127
v_pk_add_f32 v[112:113],v[112:113],v[114:115]
v_pk_add_f32 v[116:117],v[116:117],v[118:119]
v_permlane32_swap_b32 v126,v127
v_max_f32 v126,v126,v127
v_mul_f32 v126,v1,v126
v_pk_add_f32 v[34:35],v[34:35],v[126:127] op_sel_hi:[1,0] neg_lo:[0,1] neg_hi:[0,1]
v_pk_add_f32 v[24:25],v[24:25],v[126:127] op_sel_hi:[1,0] neg_lo:[0,1] neg_hi:[0,1]
v_pk_fma_f32 v[26:27],v[26:27],v[0:1],v[126:127] op_sel:[0,1,0] op_sel_hi:[1,1,0] neg_lo:[0,0,1] neg_hi:[0,0,1]
v_pk_fma_f32 v[28:29],v[28:29],v[0:1],v[126:127] op_sel:[0,1,0] op_sel_hi:[1,1,0] neg_lo:[0,0,1] neg_hi:[0,0,1]
v_pk_fma_f32 v[30:31],v[30:31],v[0:1],v[126:127] op_sel:[0,1,0] op_sel_hi:[1,1,0] neg_lo:[0,0,1] neg_hi:[0,0,1]
v_exp_f32 v34,v34
v_exp_f32 v35,v35
v_cvt_pk_bf16_f32 v126,v112,v113
v_cvt_pk_bf16_f32 v124,v34,v35
v_cvt_pk_bf16_f32 v127,v116,v117
v_cvt_pk_bf16_f32 v36,v116,v117
v_mfma_f32_16x16x16_bf16 v[32:35],v[14:15],v[124:125],0
ds_read_b128 v[44:47],v11 offset:13312
v_exp_f32 v24,v24
v_mfma_f32_16x16x16_bf16 v[112:115],v[126:127],v[124:125],0
ds_read_b128 v[48:51],v11 offset:14336
v_exp_f32 v25,v25
v_mfma_f32_16x16x16_bf16 v[116:119],v[36:37],v[124:125],0
ds_read_b128 v[52:55],v11 offset:15360
v_exp_f32 v26,v26
v_exp_f32 v27,v27
v_cvt_pk_bf16_f32 v120,v24,v25
v_exp_f32 v28,v28
v_exp_f32 v29,v29
v_cvt_pk_bf16_f32 v121,v26,v27
v_exp_f32 v30,v30
v_exp_f32 v31,v31
v_cvt_pk_bf16_f32 v122,v28,v29
v_cvt_pk_bf16_f32 v123,v30,v31
s_add_u32 s75,s75,8192
s_add_u32 s51,s51,1
v_mfma_f32_16x16x32_bf16 v[32:35],v[14:17],v[120:123],v[32:35]
v_mfma_f32_16x16x32_bf16 v[112:115],v[88:91],v[120:123],v[112:115]
ds_read_b128 v[88:91],v11 offset:16384
v_mfma_f32_16x16x32_bf16 v[116:119],v[92:95],v[120:123],v[116:119]
ds_read_b128 v[92:95],v11 offset:17408
v_rcp_f32 v32,v32
v_mov_b64 v[24:25],-1
v_mov_b64 v[26:27],-1
s_add_u32 s64,s75,12582912
s_add_u32 s70,s64,4096
v_pk_mul_f32 v[112:113],v[112:113],v[32:33] op_sel_hi:[1,0]
v_pk_mul_f32 v[114:115],v[114:115],v[32:33] op_sel_hi:[1,0]
v_pk_mul_f32 v[116:117],v[116:117],v[32:33] op_sel_hi:[1,0]
v_pk_mul_f32 v[118:119],v[118:119],v[32:33] op_sel_hi:[1,0]
v_cvt_pk_bf16_f32 v120,v112,v116
v_cvt_pk_bf16_f32 v121,v113,v117
v_cvt_pk_bf16_f32 v122,v114,v118
v_cvt_pk_bf16_f32 v123,v115,v119
ds_write_b128 v7,v[120:123]
buffer_store_dwordx4 v[24:27],v0,s[8:11],s69 offen sc1
buffer_store_dwordx4 v[24:27],v0,s[8:11],s69 offen offset:1024 sc1
v_mov_b64 v[112:113],0
v_mov_b64 v[114:115],0
v_mov_b64 v[116:117],0
v_mov_b64 v[118:119],0
s_waitcnt lgkmcnt(0)
s_barrier
ds_read_b128 v[24:27],v8 offset:0
ds_read_b128 v[28:31],v8 offset:512
ds_read_b128 v[32:35],v8 offset:1024
ds_read_b128 v[36:39],v8 offset:1536
v_mov_b64 v[120:121],0
v_mov_b64 v[122:123],0
s_add_u32 s57,s65,65536
s_add_u32 s58,s65,131072
s_add_u32 s59,s65,196608
s_add_u32 s56,s18,s75
s_add_u32 s30,s75,17825792
s_waitcnt lgkmcnt(3)
v_smfmac_f32_16x16x64_bf16 v[112:115],v[24:27],v[56:63],v3
ds_read_b128 v[56:59],v11 offset:18432
s_waitcnt lgkmcnt(3)
v_smfmac_f32_16x16x64_bf16 v[112:115],v[28:31],v[64:71],v3
ds_read_b128 v[60:63],v11 offset:19456
s_waitcnt lgkmcnt(3)
v_smfmac_f32_16x16x64_bf16 v[112:115],v[32:35],v[72:79],v3
ds_read_b128 v[64:67],v11 offset:20480
s_waitcnt lgkmcnt(3)
v_smfmac_f32_16x16x64_bf16 v[112:115],v[36:39],v[80:87],v3
ds_read_b128 v[68:71],v11 offset:21504
v_smfmac_f32_16x16x64_bf16 v[116:119],v[24:27],v[96:103],v3
ds_read_b128 v[72:75],v11 offset:22528
v_smfmac_f32_16x16x64_bf16 v[116:119],v[28:31],v[104:111],v3
ds_read_b128 v[76:79],v11 offset:23552
v_cvt_pk_bf16_f32 v112,v112,v113
v_smfmac_f32_16x16x64_bf16 v[116:119],v[32:35],v[40:47],v3
ds_read_b128 v[80:83],v11 offset:24576
v_cvt_pk_bf16_f32 v113,v114,v115
buffer_store_dwordx2 v[112:113],v9,s[8:11],s65 offen sc1
v_smfmac_f32_16x16x64_bf16 v[116:119],v[36:39],v[48:55],v3
ds_read_b128 v[84:87],v11 offset:25600
v_mov_b64 v[112:113],0
v_smfmac_f32_16x16x64_bf16 v[120:123],v[24:27],v[88:95],v3
ds_read_b128 v[96:99],v11 offset:26624
ds_read_b128 v[100:103],v11 offset:27648
v_mov_b64 v[114:115],0
s_waitcnt lgkmcnt(8)
v_smfmac_f32_16x16x64_bf16 v[120:123],v[28:31],v[56:63],v3
ds_read_b128 v[104:107],v11 offset:28672
v_cvt_pk_bf16_f32 v116,v116,v117
s_waitcnt lgkmcnt(7)
v_smfmac_f32_16x16x64_bf16 v[120:123],v[32:35],v[64:71],v3
ds_read_b128 v[108:111],v11 offset:29696
ds_read_b128 v[40:43],v11 offset:30720
v_cvt_pk_bf16_f32 v117,v118,v119
buffer_store_dwordx2 v[116:117],v9,s[8:11],s57 offen sc1
s_waitcnt lgkmcnt(7)
v_smfmac_f32_16x16x64_bf16 v[120:123],v[36:39],v[72:79],v3
ds_read_b128 v[44:47],v11 offset:31744
v_add_u32 v52,s50,v5
s_waitcnt lgkmcnt(6)
v_smfmac_f32_16x16x64_bf16 v[112:115],v[24:27],v[80:87],v3
v_add_u32 v54,s50,v6
s_waitcnt lgkmcnt(4)
v_smfmac_f32_16x16x64_bf16 v[112:115],v[28:31],v[96:103],v3
ds_read_b64_tr_b16 v[52:53],v52
v_cvt_pk_bf16_f32 v120,v120,v121
s_waitcnt lgkmcnt(3)
v_smfmac_f32_16x16x64_bf16 v[112:115],v[32:35],v[104:111],v3
ds_read_b64_tr_b16 v[54:55],v54
v_cvt_pk_bf16_f32 v121,v122,v123
buffer_store_dwordx2 v[120:121],v9,s[8:11],s58 offen sc1
s_waitcnt lgkmcnt(2)
v_smfmac_f32_16x16x64_bf16 v[112:115],v[36:39],v[40:47],v3
v_mov_b64 v[116:117],0
v_mov_b64 v[118:119],0
s_xor_b32 s65,s65,262144
v_mov_b32_dpp v124,v126 quad_perm:[2,3,2,3] row_mask:0xf bank_mask:0xf
v_mov_b32_dpp v125,v127 quad_perm:[2,3,2,3] row_mask:0xf bank_mask:0xf
s_mov_b32 vcc_lo,0xcccccccc
s_mov_b32 vcc_hi,0xcccccccc
s_nop 0
v_cvt_pk_bf16_f32 v112,v112,v113
v_cvt_pk_bf16_f32 v113,v114,v115
buffer_store_dwordx2 v[112:113],v9,s[8:11],s59 offen sc1
s_waitcnt lgkmcnt(0)
s_buffer_load_dword s19,s[8:11],s56
v_cndmask_b32 v124,v124,v52,vcc
v_cndmask_b32 v125,v125,v53,vcc
s_cmp_lt_u32 s46,2
s_waitcnt vmcnt(3)
s_cbranch_scc1 L_crg_286
s_cmp_eq_u32 s46,2
s_waitcnt vmcnt(1)
s_cbranch_scc1 L_crg_286
s_waitcnt vmcnt(0)
L_crg_286:
buffer_load_dwordx4 v[32:35],v0,s[8:11],s66 offen offset:0 sc1
buffer_load_dwordx4 v[36:39],v0,s[8:11],s66 offen offset:1024 sc1
v_cndmask_b32 v126,v126,v54,vcc
v_cndmask_b32 v127,v127,v55,vcc
v_mov_b64 v[96:97],0
v_mov_b64 v[98:99],0
v_mov_b64 v[100:101],0
v_mov_b64 v[102:103],0
v_mov_b64 v[104:105],0
v_mov_b64 v[106:107],0
v_mov_b64 v[108:109],0
v_mov_b64 v[110:111],0
v_mov_b64 v[112:113],0
v_mov_b64 v[114:115],0
v_add_u32 v55,131072,v0
v_add_u32 v123,s73,v55
v_xor_b32 v120,1024,v12
v_xor_b32 v121,2048,v12
v_xor_b32 v122,3072,v12
buffer_load_dwordx4 v[44:47],v0,s[8:11],s66 offen offset:0 sc1
buffer_load_dwordx4 v[48:51],v0,s[8:11],s66 offen offset:1024 sc1
s_cmp_ge_u32 s51,63
s_cselect_b32 s76,0,1
s_cmp_eq_u32 s46,0
s_cselect_b32 s76,s76,0
s_waitcnt vmcnt(3)
v_mfma_f32_16x16x32_bf16 v[28:31],v[18:21],v[32:35],0
s_waitcnt vmcnt(2)
v_mfma_f32_16x16x32_bf16 v[28:31],v[18:21],v[36:39],v[28:31]
s_nop 7
v_cmp_u_f32 vcc,v28,v28
v_add_f32_dpp v52,v28,v28 row_ror:8 row_mask:0xf bank_mask:0x3
v_add_f32_dpp v53,v29,v29 row_ror:8 row_mask:0xf bank_mask:0x3
v_add_f32_dpp v52,v30,v30 row_ror:8 row_mask:0xf bank_mask:0xc
v_add_f32_dpp v53,v31,v31 row_ror:8 row_mask:0xf bank_mask:0xc
s_cbranch_vccnz L_crp_281
L_cok_287:
v_add_f32_dpp v52,v52,v52 row_shl:4 row_mask:0xf bank_mask:0x5
v_add_f32_dpp v53,v53,v53 row_shl:4 row_mask:0xf bank_mask:0x5
v_cvt_pk_bf16_f32 v54,v52,v53
buffer_store_dword v54,v10,s[8:11],s64 offen sc1
s_mov_b32 s69,s66
s_xor_b32 s66,s66,262144
s_barrier
ds_read_b128 v[56:59],v55 offset:0
ds_read_b128 v[60:63],v55 offset:4096
ds_read_b128 v[64:67],v55 offset:1024
buffer_load_dwordx4 v[24:27],v13,s[8:11],s64 offen sc1
ds_read_b128 v[68:71],v55 offset:5120
ds_read_b128 v[72:75],v55 offset:2048
ds_read_b128 v[76:79],v55 offset:6144
ds_read_b128 v[80:83],v55 offset:3072
buffer_load_dwordx4 v[24:27],v13,s[8:11],s64 offen sc1
ds_read_b128 v[84:87],v55 offset:7168
ds_read_b128 v[88:91],v123 offset:8192
ds_read_b128 v[92:95],v123 offset:9216
s_branch L_chain_276
L_cpb_283:
buffer_load_dwordx4 v[40:43],v13,s[8:11],s70 offen sc1
s_sub_u32 s49,s49,1
s_cbranch_scc1 L_abort2
s_waitcnt vmcnt(0)
v_max3_u32 v123,v40,v41,v42
v_max_u32 v123,v43,v123
v_cmp_le_u32 vcc,s72,v123
s_cbranch_vccnz L_cpb_283
ds_write_b128 v12,v[40:43] offset:4096
s_branch L_cback_285
L_crp_281:
buffer_load_dwordx4 v[32:35],v0,s[8:11],s66 offen offset:0 sc1
buffer_load_dwordx4 v[36:39],v0,s[8:11],s66 offen offset:1024 sc1
s_sub_u32 s49,s49,1
s_cbranch_scc1 L_abort2
s_waitcnt vmcnt(3)
v_mfma_f32_16x16x32_bf16 v[28:31],v[18:21],v[44:47],0
s_waitcnt vmcnt(2)
v_mfma_f32_16x16x32_bf16 v[28:31],v[18:21],v[48:51],v[28:31]
s_nop 7
v_cmp_u_f32 vcc,v28,v28
v_add_f32_dpp v52,v28,v28 row_ror:8 row_mask:0xf bank_mask:0x3
v_add_f32_dpp v53,v29,v29 row_ror:8 row_mask:0xf bank_mask:0x3
v_add_f32_dpp v52,v30,v30 row_ror:8 row_mask:0xf bank_mask:0xc
v_add_f32_dpp v53,v31,v31 row_ror:8 row_mask:0xf bank_mask:0xc
s_cbranch_vccz L_cok_287
buffer_load_dwordx4 v[44:47],v0,s[8:11],s66 offen offset:0 sc1
buffer_load_dwordx4 v[48:51],v0,s[8:11],s66 offen offset:1024 sc1
s_sub_u32 s49,s49,1
s_cbranch_scc1 L_abort2
s_waitcnt vmcnt(3)
v_mfma_f32_16x16x32_bf16 v[28:31],v[18:21],v[32:35],0
s_waitcnt vmcnt(2)
v_mfma_f32_16x16x32_bf16 v[28:31],v[18:21],v[36:39],v[28:31]
s_nop 7
v_cmp_u_f32 vcc,v28,v28
v_add_f32_dpp v52,v28,v28 row_ror:8 row_mask:0xf bank_mask:0x3
v_add_f32_dpp v53,v29,v29 row_ror:8 row_mask:0xf bank_mask:0x3
v_add_f32_dpp v52,v30,v30 row_ror:8 row_mask:0xf bank_mask:0xc
v_add_f32_dpp v53,v31,v31 row_ror:8 row_mask:0xf bank_mask:0xc
s_cbranch_vccz L_cok_287
s_branch L_crp_281
L_ckw_269:
s_add_u32 s59,s18,s75
L_ww_288:
buffer_load_dword v23,off,s[8:11],s59 sc1
s_sub_u32 s49,s49,1
s_cbranch_scc1 L_abort2
s_waitcnt vmcnt(0)
v_readfirstlane_b32 s76,v23
s_cmp_eq_u32 s76,0
s_cbranch_scc1 L_ww_288
L_wwd_289:
s_branch L_ckb_270
L_cend_279:
v_smfmac_f32_16x16x64_bf16 v[116:119],v[36:39],v[184:191],v2
v_smfmac_f32_16x16x64_bf16 v[112:115],v[40:43],v[192:199],v2
v_smfmac_f32_16x16x64_bf16 v[116:119],v[40:43],v[200:207],v2
v_smfmac_f32_16x16x64_bf16 v[112:115],v[44:47],v[208:215],v2
v_smfmac_f32_16x16x64_bf16 v[116:119],v[44:47],v[216:223],v2
v_smfmac_f32_16x16x64_bf16 v[112:115],v[48:51],v[224:231],v2
v_smfmac_f32_16x16x64_bf16 v[116:119],v[48:51],v[232:239],v2
v_smfmac_f32_16x16x64_bf16 v[112:115],v[52:55],v[240:247],v2
v_smfmac_f32_16x16x64_bf16 v[116:119],v[52:55],v[248:255],v2
s_waitcnt lgkmcnt(0)
s_nop 2
v_pk_add_f32 v[112:113],v[112:113],v[114:115]
s_nop 2
v_pk_add_f32 v[116:117],v[116:117],v[118:119]
v_cvt_pk_bf16_f32 v126,v112,v113
v_cvt_pk_bf16_f32 v127,v116,v117
v_add_u32 v52,s50,v5
v_add_u32 v54,s50,v6
ds_read_b64_tr_b16 v[52:53],v52
ds_read_b64_tr_b16 v[54:55],v54
v_mov_b32_dpp v124,v126 quad_perm:[2,3,2,3] row_mask:0xf bank_mask:0xf
v_mov_b32_dpp v125,v127 quad_perm:[2,3,2,3] row_mask:0xf bank_mask:0xf
s_mov_b32 vcc_lo,0xcccccccc
s_mov_b32 vcc_hi,0xcccccccc
s_waitcnt lgkmcnt(0)
v_cndmask_b32 v124,v124,v52,vcc
v_cndmask_b32 v125,v125,v53,vcc
v_cndmask_b32 v126,v126,v54,vcc
v_cndmask_b32 v127,v127,v55,vcc
buffer_store_dwordx4 v[124:127],v0,s[8:11],s54 offen sc1
s_mov_b32 s51,64
s_waitcnt vmcnt(0)
s_barrier
s_nop 11
v_lshrrev_b32 v1,4,v0
s_endpgm
L_rc2_239:
v_and_b32 v120,15,v1
v_lshrrev_b32 v121,4,v1
v_and_b32 v122,2,v1
v_cmp_eq_u32 vcc,0,v122
v_mov_b32 v2,0xeeee
v_mov_b32 v123,0x4444
v_cndmask_b32 v2,v2,v123,vcc
v_and_b32 v122,1,v1
v_cmp_eq_u32 vcc,0,v122
v_mov_b32 v3,0xdddd
v_mov_b32 v123,0x8888
v_cndmask_b32 v3,v3,v123,vcc
v_lshrrev_b32 v122,1,v120
v_bfe_u32 v123,v120,2,1
v_xor_b32 v123,v123,v122
v_lshlrev_b32 v4,7,v123
v_and_b32 v123,1,v120
v_lshl_add_u32 v4,v123,6,v4
v_xor_b32 v123,v121,v122
v_and_b32 v123,3,v123
v_lshl_add_u32 v4,v123,4,v4
s_lshl_b32 s56,s46,10
s_add_u32 s56,s56,147456
v_add_u32 v4,s56,v4
v_lshlrev_b32 v122,1,v121
v_add_u32 v122,0,v122
v_and_b32 v123,1,v121
v_xor_b32 v123,v123,v122
v_lshlrev_b32 v5,7,v123
v_bfe_u32 v123,v120,3,1
v_lshl_add_u32 v5,v123,6,v5
v_xor_b32 v123,v120,v122
v_and_b32 v123,3,v123
v_lshl_add_u32 v5,v123,4,v5
v_bfe_u32 v123,v120,2,1
v_lshl_add_u32 v5,v123,3,v5
v_add_u32 v5,147456,v5
v_lshlrev_b32 v122,1,v121
v_add_u32 v122,1,v122
v_and_b32 v123,1,v121
v_xor_b32 v123,v123,v122
v_lshlrev_b32 v6,7,v123
v_bfe_u32 v123,v120,3,1
v_lshl_add_u32 v6,v123,6,v6
v_xor_b32 v123,v120,v122
v_and_b32 v123,3,v123
v_lshl_add_u32 v6,v123,4,v6
v_bfe_u32 v123,v120,2,1
v_lshl_add_u32 v6,v123,3,v6
v_add_u32 v6,147456,v6
v_lshlrev_b32 v7,7,v121
v_lshrrev_b32 v122,1,v120
v_lshl_add_u32 v8,v122,4,v7
v_add_u32 v8,151552,v8
v_lshrrev_b32 v122,2,v120
v_lshl_add_u32 v7,v122,5,v7
v_and_b32 v122,1,v120
v_lshl_add_u32 v7,v122,4,v7
v_and_b32 v122,2,v120
v_cmp_eq_u32 vcc,0,v122
s_lshl_b32 s56,s46,9
v_mov_b32 v122,2048
v_mov_b32 v123,s56
v_cndmask_b32 v122,v122,v123,vcc
v_add_u32 v7,v122,v7
v_add_u32 v7,151552,v7
v_lshrrev_b32 v122,3,v1
v_lshlrev_b32 v9,11,v122
v_and_b32 v122,7,v1
v_lshl_add_u32 v9,v122,3,v9
s_lshl_b32 s56,s46,14
s_lshl_b32 s57,s47,6
s_add_u32 s56,s56,s57
v_add_u32 v9,s56,v9
s_lshl_b32 s71,s46,5
s_add_u32 s71,s71,s47
s_bfe_u32 s56,s71,0x10003
s_lshl_b32 s56,s56,11
s_and_b32 s57,s71,1
s_lshl_b32 s57,s57,10
s_add_u32 s56,s56,s57
s_bfe_u32 s57,s71,0x10002
s_lshl_b32 s57,s57,9
s_add_u32 s56,s56,s57
s_bfe_u32 s57,s71,0x10001
s_lshl_b32 s57,s57,6
s_add_u32 s56,s56,s57
s_bfe_u32 s57,s71,0x10004
s_lshl_b32 s57,s57,8
s_add_u32 s56,s56,s57
s_bfe_u32 s57,s71,0x10005
s_lshl_b32 s57,s57,7
s_add_u32 s56,s56,s57
s_bfe_u32 s57,s71,0x10006
s_lshl_b32 s57,s57,12
s_add_u32 s56,s56,s57
v_and_b32 v122,3,v120
v_lshlrev_b32 v10,2,v122
v_bfe_u32 v122,v120,3,1
v_lshl_add_u32 v10,v122,4,v10
v_and_b32 v122,1,v121
v_lshl_add_u32 v10,v122,5,v10
v_add_u32 v10,s56,v10
v_and_b32 v123,36,v1
v_mov_b32 v122,0x80000000
v_cmp_eq_u32 vcc,0,v123
s_nop 1
v_cndmask_b32 v10,v122,v10,vcc
s_lshl_b32 s71,s71,11
s_lshl_b32 s73,s46,11
s_mov_b32 s72,0xffc00000
s_mov_b32 s74,0
v_and_b32 v11,1,v121
v_xor_b32 v11,v11,v120
v_and_b32 v11,3,v11
v_lshrrev_b32 v122,2,v120
v_lshl_add_u32 v11,v11,2,v122
v_lshl_add_u32 v11,v121,4,v11
v_lshlrev_b32 v11,4,v11
s_lshl_b32 s56,s46,15
v_add_u32 v11,s56,v11
v_lshrrev_b32 v13,3,v1
v_lshlrev_b32 v13,9,v13
v_and_b32 v122,7,v1
v_lshl_add_u32 v13,v122,4,v13
v_and_b32 v122,15,v1
v_and_b32 v123,1,v1
v_lshlrev_b32 v123,4,v123
v_mov_b32 v124,0x3f80
v_lshlrev_b32 v124,v123,v124
v_lshrrev_b32 v122,1,v122
v_cmp_eq_u32 vcc,0,v122
s_nop 1
v_cndmask_b32 v18,0,v124,vcc
v_cmp_eq_u32 vcc,1,v122
s_nop 1
v_cndmask_b32 v19,0,v124,vcc
v_cmp_eq_u32 vcc,2,v122
s_nop 1
v_cndmask_b32 v20,0,v124,vcc
v_cmp_eq_u32 vcc,3,v122
s_nop 1
v_cndmask_b32 v21,0,v124,vcc
s_and_b32 s56,s46,1
s_lshl_b32 s56,s56,8
s_and_b32 s57,s46,2
s_lshl_b32 s57,s57,6
s_add_u32 s56,s56,s57
v_add_u32 v13,s56,v13
s_add_u32 s56,s50,155648
v_add_u32 v12,s56,v0
v_mov_b64 v[14:15],s[28:29]
v_mov_b64 v[16:17],s[28:29]
v_add_u32 v22,13647872,v10
s_lshl_b32 s18,s47,2
s_add_u32 s18,s18,10494080
v_mov_b32 v1,s80
s_mov_b32 s65,16777216
s_add_u32 s66,s71,16777216
s_add_u32 s69,s71,17039360
s_mov_b32 s30,0x40000000
s_mov_b32 s51,0
v_lshrrev_b32 v120,2,v0
v_add_u32 v120,10510464,v120
v_or_b32 v120,s52,v120
s_mov_b64 vcc,-1
s_mov_b32 vcc_lo,0
v_cndmask_b32 v22,v22,v120,vcc
s_or_b32 s56,s52,10495616
v_writelane_b32 v22,s56,4
s_or_b32 s56,s47,s46
s_mov_b32 s56,10486784
s_cmov_b32 s56,0x80000000
v_writelane_b32 v22,s56,5
s_mov_b32 s30,0
s_mov_b32 s31,0
L_cst_293:
s_cmp_lg_u32 s46,0
s_cbranch_scc1 L_csw_298
s_andn2_b32 s61,0x7ff,s30
s_lshr_b32 s61,s61,5
s_add_u32 s61,s61,2
s_add_u32 s60,s31,1
s_min_u32 s60,s60,63
s_cmp_gt_u32 s60,s61
s_cselect_b32 s60,s31,s60
s_sub_u32 s61,s60,s31
s_lshl_b32 s61,s61,13
s_lshl_b32 s59,s31,13
s_add_u32 s59,s59,10486016
v_lshrrev_b32 v121,2,v0
v_and_b32 v121,127,v121
v_lshrrev_b32 v120,9,v0
v_mul_u32_u24 v120,s61,v120
v_add_u32 v121,v120,v121
L_ckk_299:
s_sleep 1
buffer_load_dword v120,v121,s[8:11],s59 offen sc1
s_sub_u32 s49,s49,1
s_cbranch_scc1 L_abort2
s_waitcnt vmcnt(0)
v_cmp_eq_u32 vcc,0,v120
s_cbranch_vccnz L_ckk_299
v_max_u32_dpp v120,v120,v120 row_ror:8 row_mask:0xf bank_mask:0xf
s_nop 1
v_max_u32_dpp v120,v120,v120 row_ror:4 row_mask:0xf bank_mask:0xf
s_nop 1
v_max_u32_dpp v120,v120,v120 row_ror:2 row_mask:0xf bank_mask:0xf
s_nop 1
v_max_u32_dpp v120,v120,v120 row_ror:1 row_mask:0xf bank_mask:0xf
v_mov_b32 v121,v120
s_nop 1
v_permlane16_swap_b32 v120,v121
v_max_u32 v120,v120,v121
v_mov_b32 v121,v120
s_nop 1
v_permlane32_swap_b32 v120,v121
v_max_u32 v120,v120,v121
s_nop 0
v_readfirstlane_b32 s61,v120
s_max_u32 s30,s30,s61
s_add_u32 s31,s60,1
s_andn2_b32 s51,0x7ff,s30
s_lshr_b32 s51,s51,5
s_add_u32 s61,s51,2
s_min_u32 s61,s61,63
s_cmp_le_u32 s31,s61
s_cbranch_scc1 L_cst_293
v_mov_b32 v120,0
v_mov_b32 v121,s30
ds_write_b32 v8,v120 offset:2560
ds_write_b32 v8,v121 offset:3072
s_lshl_b32 s59,s51,13
s_lshl2_add_u32 s59,s47,s59
s_add_u32 s59,s59,10485888
L_ww_300:
s_sleep 1
buffer_load_dword v122,off,s[8:11],s59 sc1
s_sub_u32 s49,s49,1
s_cbranch_scc1 L_abort2
s_waitcnt vmcnt(0)
v_readfirstlane_b32 s61,v122
s_cmp_eq_u32 s61,0
s_cbranch_scc1 L_ww_300
L_wwd_301:
L_csw_298:
s_waitcnt lgkmcnt(0)
s_barrier
ds_read_b32 v120,v8 offset:3072
s_waitcnt lgkmcnt(0)
v_readfirstlane_b32 s30,v120
s_andn2_b32 s51,0x7ff,s30
s_lshr_b32 s51,s51,5
s_lshl_b32 s56,s51,5
s_add_u32 s56,s56,s47
s_mul_i32 s56,s56,24576
s_add_u32 s56,s56,150994944
s_add_u32 s67,s56,s73
s_add_u32 m0,s73,131072
s_add_u32 s57,s67,8192
buffer_load_dwordx4 v0,s[8:11],s67 offen sc1 lds
buffer_load_dwordx4 v0,s[8:11],s67 offen offset:1024 sc1 lds
s_add_u32 m0,s73,139264
s_add_u32 s67,s67,786432
buffer_load_dwordx4 v0,s[8:11],s57 offen sc1 lds
buffer_load_dwordx4 v0,s[8:11],s57 offen offset:1024 sc1 lds
s_lshl_b32 s75,s51,13
s_add_u32 s56,s75,13639680
buffer_load_dword v23,v10,s[8:11],s56 offen sc1
s_add_u32 s64,s75,17825792
s_add_u32 s70,s64,4096
s_lshl_b32 s68,s51,5
s_add_u32 s68,s68,s47
s_lshl_b32 s68,s68,12
s_lshl_b32 s56,s46,10
s_add_u32 s68,s68,s56
s_add_u32 s68,s68,75497472
s_mov_b32 s54,0x80000000
s_mov_b32 s77,0
s_add_u32 s56,s18,s75
s_buffer_load_dword s19,s[8:11],s56
s_cmp_eq_u32 s51,63
s_cselect_b32 s76,1,s46
s_cmp_eq_u32 s76,0
s_cselect_b32 s76,1,0
v_mov_b64 v[96:97],0
v_mov_b64 v[98:99],0
v_mov_b64 v[100:101],0
v_mov_b64 v[102:103],0
v_mov_b64 v[104:105],0
v_mov_b64 v[106:107],0
v_mov_b64 v[108:109],0
v_mov_b64 v[110:111],0
v_mov_b64 v[112:113],0
v_mov_b64 v[114:115],0
v_mov_b64 v[116:117],0
v_mov_b64 v[118:119],0
v_lshrrev_b32 v56,8,v0
v_lshlrev_b32 v56,5,v56
v_bfe_u32 v57,v0,5,1
v_lshl_add_u32 v56,v57,2,v56
s_lshl_b32 s56,s46,7
s_add_u32 s56,s56,155648
v_add_u32 v56,s56,v56
v_xor_b32 v57,128,v56
v_xor_b32 v58,256,v56
v_xor_b32 v59,384,v56
s_andn2_b32 s56,31,s30
s_lshr_b32 s57,s56,4
s_lshl_b32 s58,s57,12
s_and_b32 s59,s56,15
s_lshl4_add_u32 s58,s59,s58
s_add_u32 s58,s58,s50
s_add_u32 s58,s58,131072
v_bfe_u32 v60,v0,6,2
v_lshlrev_b32 v60,8,v60
v_bfe_u32 v61,v0,4,2
v_lshl_add_u32 v60,v61,2,v60
v_add_u32 v60,s58,v60
s_lshr_b32 s58,s59,2
s_lshl_b32 s58,s58,8
s_lshl3_add_u32 s58,s57,s58
s_and_b32 s59,s56,3
s_lshl1_add_u32 s58,s59,s58
s_add_u32 s58,s58,s73
s_add_u32 s58,s58,139264
v_and_b32 v61,255,v0
v_add_u32 v61,s58,v61
s_cmp_lg_u32 s46,0
s_cbranch_scc1 L_chd_303
s_lshl_b32 s59,s51,10
s_add_u32 s59,s59,11337728
L_chp_302:
buffer_load_dwordx4 v[120:123],v0,s[8:11],s59 offen sc1
s_sub_u32 s49,s49,1
s_cbranch_scc1 L_abort2
s_waitcnt vmcnt(0)
v_max3_u32 v124,v120,v121,v122
v_max_u32 v124,v123,v124
v_cmp_eq_u32 vcc,-1,v124
s_cbranch_vccnz L_chp_302
ds_write_b128 v12,v[120:123]
L_chd_303:
s_waitcnt vmcnt(0) lgkmcnt(0)
s_barrier
ds_read2_b32 v[24:25],v56 offset0:0 offset1:2
ds_read2_b32 v[26:27],v56 offset0:4 offset1:6
ds_read2_b32 v[28:29],v57 offset0:0 offset1:2
ds_read2_b32 v[30:31],v57 offset0:4 offset1:6
ds_read2_b32 v[32:33],v58 offset0:0 offset1:2
ds_read2_b32 v[34:35],v58 offset0:4 offset1:6
ds_read2_b32 v[36:37],v59 offset0:0 offset1:2
ds_read2_b32 v[38:39],v59 offset0:4 offset1:6
s_waitcnt lgkmcnt(4)
ds_read2_b32 v[40:41],v56 offset0:128 offset1:130
ds_read2_b32 v[42:43],v56 offset0:132 offset1:134
ds_read2_b32 v[44:45],v57 offset0:128 offset1:130
ds_read2_b32 v[46:47],v57 offset0:132 offset1:134
ds_read2_b32 v[48:49],v58 offset0:128 offset1:130
ds_read2_b32 v[50:51],v58 offset0:132 offset1:134
ds_read2_b32 v[52:53],v59 offset0:128 offset1:130
ds_read2_b32 v[54:55],v59 offset0:132 offset1:134
s_waitcnt lgkmcnt(12)
v_smfmac_f32_16x16x64_bf16 v[100:103],v[24:27],a[128:135],v2
v_smfmac_f32_16x16x64_bf16 v[112:115],v[24:27],v[128:135],v2
v_smfmac_f32_16x16x64_bf16 v[108:111],v[24:27],a[136:143],v2
v_smfmac_f32_16x16x64_bf16 v[116:119],v[24:27],v[136:143],v2
s_waitcnt lgkmcnt(12)
v_smfmac_f32_16x16x64_bf16 v[100:103],v[28:31],a[144:151],v2
v_smfmac_f32_16x16x64_bf16 v[112:115],v[28:31],v[144:151],v2
v_smfmac_f32_16x16x64_bf16 v[108:111],v[28:31],a[152:159],v2
v_smfmac_f32_16x16x64_bf16 v[116:119],v[28:31],v[152:159],v2
s_waitcnt lgkmcnt(10)
v_smfmac_f32_16x16x64_bf16 v[100:103],v[32:35],a[160:167],v2
v_smfmac_f32_16x16x64_bf16 v[112:115],v[32:35],v[160:167],v2
v_smfmac_f32_16x16x64_bf16 v[108:111],v[32:35],a[168:175],v2
v_smfmac_f32_16x16x64_bf16 v[116:119],v[32:35],v[168:175],v2
s_waitcnt lgkmcnt(8)
v_smfmac_f32_16x16x64_bf16 v[100:103],v[36:39],a[176:183],v2
v_smfmac_f32_16x16x64_bf16 v[112:115],v[36:39],v[176:183],v2
v_smfmac_f32_16x16x64_bf16 v[108:111],v[36:39],a[184:191],v2
v_smfmac_f32_16x16x64_bf16 v[116:119],v[36:39],v[184:191],v2
s_waitcnt lgkmcnt(6)
v_smfmac_f32_16x16x64_bf16 v[100:103],v[40:43],a[192:199],v2
v_smfmac_f32_16x16x64_bf16 v[112:115],v[40:43],v[192:199],v2
v_smfmac_f32_16x16x64_bf16 v[108:111],v[40:43],a[200:207],v2
v_smfmac_f32_16x16x64_bf16 v[116:119],v[40:43],v[200:207],v2
s_waitcnt lgkmcnt(4)
v_smfmac_f32_16x16x64_bf16 v[100:103],v[44:47],a[208:215],v2
v_smfmac_f32_16x16x64_bf16 v[112:115],v[44:47],v[208:215],v2
v_smfmac_f32_16x16x64_bf16 v[108:111],v[44:47],a[216:223],v2
v_smfmac_f32_16x16x64_bf16 v[116:119],v[44:47],v[216:223],v2
s_waitcnt lgkmcnt(2)
v_smfmac_f32_16x16x64_bf16 v[100:103],v[48:51],a[224:231],v2
v_smfmac_f32_16x16x64_bf16 v[112:115],v[48:51],v[224:231],v2
v_smfmac_f32_16x16x64_bf16 v[108:111],v[48:51],a[232:239],v2
v_smfmac_f32_16x16x64_bf16 v[116:119],v[48:51],v[232:239],v2
s_waitcnt lgkmcnt(0)
v_smfmac_f32_16x16x64_bf16 v[100:103],v[52:55],a[240:247],v2
v_smfmac_f32_16x16x64_bf16 v[112:115],v[52:55],v[240:247],v2
v_smfmac_f32_16x16x64_bf16 v[108:111],v[52:55],a[248:255],v2
v_smfmac_f32_16x16x64_bf16 v[116:119],v[52:55],v[248:255],v2
v_add_f32 v100,v100,v102
v_add_f32 v112,v112,v114
s_nop 1
v_add_f32 v108,v108,v110
s_nop 2
v_add_f32 v116,v116,v118
v_cvt_pk_bf16_f32 v120,v100,v108
v_cvt_pk_bf16_f32 v121,v112,v116
ds_write_b32 v60,v120
ds_write_b16 v61,v121
ds_write_b16_d16_hi v61,v121 offset:1024
v_mov_b64 v[96:97],0
v_mov_b64 v[98:99],0
v_mov_b64 v[100:101],0
v_mov_b64 v[102:103],0
v_mov_b64 v[104:105],0
v_mov_b64 v[106:107],0
v_mov_b64 v[108:109],0
v_mov_b64 v[110:111],0
v_mov_b64 v[112:113],0
v_mov_b64 v[114:115],0
v_mov_b64 v[116:117],0
v_mov_b64 v[118:119],0
s_waitcnt vmcnt(0) lgkmcnt(0)
s_barrier
v_add_u32 v55,131072,v0
ds_read_b128 v[56:59],v55 offset:0
ds_read_b128 v[60:63],v55 offset:4096
ds_read_b128 v[64:67],v55 offset:1024
ds_read_b128 v[68:71],v55 offset:5120
ds_read_b128 v[72:75],v55 offset:2048
ds_read_b128 v[76:79],v55 offset:6144
ds_read_b128 v[80:83],v55 offset:3072
ds_read_b128 v[84:87],v55 offset:7168
v_add_u32 v123,s73,v55
ds_read_b128 v[88:91],v123 offset:8192
ds_read_b128 v[92:95],v123 offset:9216
v_xor_b32 v120,1024,v12
v_xor_b32 v121,2048,v12
v_xor_b32 v122,3072,v12
buffer_load_dwordx4 v[24:27],v13,s[8:11],s64 offen sc1
buffer_load_dwordx4 v[24:27],v13,s[8:11],s64 offen sc1
.p2align 6
L_chain_304:
L_cpa_305:
buffer_load_dwordx4 v[24:27],v13,s[8:11],s64 offen sc1
s_sub_u32 s49,s49,1
s_cbranch_scc1 L_abort2
s_waitcnt vmcnt(2)
v_max3_u32 v123,v24,v25,v26
v_max_u32 v123,v27,v123
v_cmp_le_u32 vcc,s72,v123
ds_write_b128 v12,v[24:27] offset:0
s_cbranch_vccnz L_cpa_305
L_cgo_308:
v_smfmac_f32_16x16x64_bf16 v[96:99],v[24:27],a[0:7],v2
buffer_load_dwordx4 v[40:43],v13,s[8:11],s70 offen sc1
s_waitcnt lgkmcnt(0)
s_barrier
ds_read_b128 v[28:31],v120 offset:0
v_smfmac_f32_16x16x64_bf16 v[100:103],v[24:27],a[128:135],v2
ds_read_b128 v[32:35],v121 offset:0
v_smfmac_f32_16x16x64_bf16 v[104:107],v[24:27],a[8:15],v2
ds_read_b128 v[36:39],v122 offset:0
v_smfmac_f32_16x16x64_bf16 v[108:111],v[24:27],a[136:143],v2
v_smfmac_f32_16x16x64_bf16 v[112:115],v[24:27],v[128:135],v2
v_smfmac_f32_16x16x64_bf16 v[116:119],v[24:27],v[136:143],v2
s_waitcnt lgkmcnt(2)
v_smfmac_f32_16x16x64_bf16 v[96:99],v[28:31],a[16:23],v2
s_add_u32 m0,s73,131072
v_smfmac_f32_16x16x64_bf16 v[100:103],v[28:31],a[144:151],v2
s_add_u32 s57,s67,8192
v_smfmac_f32_16x16x64_bf16 v[104:107],v[28:31],a[24:31],v2
s_cmp_lt_u32 s19,s76
s_cbranch_scc1 L_ckw_294
L_ckb_295:
v_smfmac_f32_16x16x64_bf16 v[108:111],v[28:31],a[152:159],v2
s_waitcnt vmcnt(0) lgkmcnt(1)
v_smfmac_f32_16x16x64_bf16 v[96:99],v[32:35],a[32:39],v2
ds_write_b128 v12,v[40:43] offset:4096
v_max3_u32 v123,v40,v41,v42
v_smfmac_f32_16x16x64_bf16 v[100:103],v[32:35],a[160:167],v2
v_max_u32 v123,v43,v123
v_smfmac_f32_16x16x64_bf16 v[104:107],v[32:35],a[40:47],v2
v_cmp_le_u32 vcc,s72,v123
v_smfmac_f32_16x16x64_bf16 v[108:111],v[32:35],a[168:175],v2
v_smfmac_f32_16x16x64_bf16 v[112:115],v[28:31],v[144:151],v2
s_cbranch_vccnz L_cpb_311
L_cback_313:
s_waitcnt lgkmcnt(0)
s_barrier
v_smfmac_f32_16x16x64_bf16 v[96:99],v[36:39],a[48:55],v2
buffer_load_dword v23,v22,s[8:11],s75 offen sc1
v_smfmac_f32_16x16x64_bf16 v[100:103],v[36:39],a[176:183],v2
ds_read_b128 v[44:47],v120 offset:4096
v_smfmac_f32_16x16x64_bf16 v[104:107],v[36:39],a[56:63],v2
buffer_load_dwordx4 v0,s[8:11],s67 offen sc1 lds
v_smfmac_f32_16x16x64_bf16 v[108:111],v[36:39],a[184:191],v2
ds_read_b128 v[48:51],v121 offset:4096
v_smfmac_f32_16x16x64_bf16 v[96:99],v[40:43],a[64:71],v2
buffer_store_dwordx4 v[124:127],v0,s[8:11],s54 offen sc1
v_smfmac_f32_16x16x64_bf16 v[100:103],v[40:43],a[192:199],v2
ds_read_b128 v[52:55],v122 offset:4096
v_smfmac_f32_16x16x64_bf16 v[104:107],v[40:43],a[72:79],v2
buffer_load_dwordx4 v0,s[8:11],s67 offen offset:1024 sc1 lds
s_add_u32 m0,s73,139264
v_smfmac_f32_16x16x64_bf16 v[108:111],v[40:43],a[200:207],v2
ds_read_b32 v123,v8 offset:2560
s_waitcnt lgkmcnt(3)
v_smfmac_f32_16x16x64_bf16 v[96:99],v[44:47],a[80:87],v2
buffer_load_dwordx4 v0,s[8:11],s57 offen sc1 lds
s_add_u32 s67,s67,786432
v_smfmac_f32_16x16x64_bf16 v[100:103],v[44:47],a[208:215],v2
s_waitcnt lgkmcnt(2)
v_smfmac_f32_16x16x64_bf16 v[96:99],v[48:51],a[96:103],v2
buffer_load_dwordx4 v0,s[8:11],s57 offen offset:1024 sc1 lds
v_smfmac_f32_16x16x64_bf16 v[100:103],v[48:51],a[224:231],v2
s_waitcnt lgkmcnt(0)
v_smfmac_f32_16x16x64_bf16 v[96:99],v[52:55],a[112:119],v2
v_smfmac_f32_16x16x64_bf16 v[100:103],v[52:55],a[240:247],v2
v_readfirstlane_b32 s58,v123
v_smfmac_f32_16x16x64_bf16 v[104:107],v[44:47],a[88:95],v2
v_smfmac_f32_16x16x64_bf16 v[108:111],v[44:47],a[216:223],v2
s_cmp_lg_u32 s58,0
s_cbranch_scc1 L_cjump_297
v_smfmac_f32_16x16x64_bf16 v[104:107],v[48:51],a[104:111],v2
v_add_f32 v96,v96,v98
v_smfmac_f32_16x16x64_bf16 v[108:111],v[48:51],a[232:239],v2
v_add_f32 v97,v97,v99
v_smfmac_f32_16x16x64_bf16 v[104:107],v[52:55],a[120:127],v2
v_cvt_pk_bf16_f32 v120,v96,v97
v_smfmac_f32_16x16x64_bf16 v[108:111],v[52:55],a[248:255],v2
v_add_f32 v100,v100,v102
v_smfmac_f32_16x16x64_bf16 v[116:119],v[28:31],v[152:159],v2
v_add_f32 v101,v101,v103
v_smfmac_f32_16x16x64_bf16 v[112:115],v[32:35],v[160:167],v2
v_cvt_pk_bf16_f32 v121,v100,v101
v_add_f32 v104,v104,v106
v_add_f32 v105,v105,v107
v_cvt_pk_bf16_f32 v122,v104,v105
v_add_f32 v108,v108,v110
v_add_f32 v109,v109,v111
v_cvt_pk_bf16_f32 v123,v108,v109
ds_write_b128 v4,v[120:123]
v_smfmac_f32_16x16x64_bf16 v[116:119],v[32:35],v[168:175],v2
s_mov_b32 s54,s68
s_add_u32 s68,s68,131072
v_mov_b32 v125,0
v_smfmac_f32_16x16x64_bf16 v[112:115],v[36:39],v[176:183],v2
s_cmp_eq_u32 s51,63
s_cbranch_scc1 L_cend_307
v_smfmac_f32_16x16x64_bf16 v[116:119],v[36:39],v[184:191],v2
s_waitcnt lgkmcnt(0)
s_barrier
ds_read_b64_tr_b16 v[96:97],v5 offset:0
v_smfmac_f32_16x16x64_bf16 v[112:115],v[40:43],v[192:199],v2
ds_read_b64_tr_b16 v[98:99],v6 offset:0
v_smfmac_f32_16x16x64_bf16 v[116:119],v[40:43],v[200:207],v2
ds_read_b64_tr_b16 v[100:101],v5 offset:1024
v_smfmac_f32_16x16x64_bf16 v[112:115],v[44:47],v[208:215],v2
ds_read_b64_tr_b16 v[102:103],v6 offset:1024
v_smfmac_f32_16x16x64_bf16 v[116:119],v[44:47],v[216:223],v2
ds_read_b64_tr_b16 v[104:105],v5 offset:2048
v_smfmac_f32_16x16x64_bf16 v[112:115],v[48:51],v[224:231],v2
ds_read_b64_tr_b16 v[106:107],v6 offset:2048
s_waitcnt lgkmcnt(4)
v_mfma_f32_16x16x32_bf16 v[24:27],v[56:59],v[96:99],0
ds_read_b64_tr_b16 v[108:109],v5 offset:3072
v_mfma_f32_16x16x32_bf16 v[28:31],v[60:63],v[96:99],0
ds_read_b64_tr_b16 v[110:111],v6 offset:3072
v_mfma_f32_16x16x32_bf16 v[32:35],v[96:99],v[96:99],0
ds_read_b128 v[40:43],v11 offset:12288
s_waitcnt lgkmcnt(5)
v_mfma_f32_16x16x32_bf16 v[24:27],v[64:67],v[100:103],v[24:27]
ds_read_b128 v[56:59],v11 offset:0
v_mfma_f32_16x16x32_bf16 v[28:31],v[68:71],v[100:103],v[28:31]
ds_read_b128 v[60:63],v11 offset:1024
v_mfma_f32_16x16x32_bf16 v[32:35],v[100:103],v[100:103],v[32:35]
ds_read_b128 v[96:99],v11 offset:8192
s_waitcnt lgkmcnt(6)
v_mfma_f32_16x16x32_bf16 v[24:27],v[72:75],v[104:107],v[24:27]
ds_read_b128 v[64:67],v11 offset:2048
v_mfma_f32_16x16x32_bf16 v[28:31],v[76:79],v[104:107],v[28:31]
ds_read_b128 v[68:71],v11 offset:3072
v_mfma_f32_16x16x32_bf16 v[32:35],v[104:107],v[104:107],v[32:35]
ds_read_b128 v[100:103],v11 offset:9216
s_waitcnt lgkmcnt(7)
v_mfma_f32_16x16x32_bf16 v[24:27],v[80:83],v[108:111],v[24:27]
ds_read_b128 v[72:75],v11 offset:4096
v_mfma_f32_16x16x32_bf16 v[28:31],v[84:87],v[108:111],v[28:31]
ds_read_b128 v[76:79],v11 offset:5120
v_mfma_f32_16x16x32_bf16 v[32:35],v[108:111],v[108:111],v[32:35]
ds_read_b128 v[104:107],v11 offset:10240
v_smfmac_f32_16x16x64_bf16 v[116:119],v[48:51],v[232:239],v2
ds_read_b128 v[80:83],v11 offset:6144
v_smfmac_f32_16x16x64_bf16 v[112:115],v[52:55],v[240:247],v2
ds_read_b128 v[84:87],v11 offset:7168
v_smfmac_f32_16x16x64_bf16 v[116:119],v[52:55],v[248:255],v2
ds_read_b128 v[108:111],v11 offset:11264
v_max3_f32 v126,v24,v25,v26
v_max3_f32 v127,v27,v28,v29
v_max3_f32 v126,v30,v31,v126
v_max3_f32 v127,v34,v35,v127
v_max_f32 v126,v126,v127
v_max_f32 v127,v126,v127
v_pk_mul_f32 v[34:35],v[34:35],v[0:1] op_sel:[0,1]
v_pk_mul_f32 v[24:25],v[24:25],v[0:1] op_sel:[0,1]
v_permlane16_swap_b32 v126,v127
v_max_f32 v126,v126,v127
v_max_f32 v127,v126,v127
v_pk_add_f32 v[112:113],v[112:113],v[114:115]
v_pk_add_f32 v[116:117],v[116:117],v[118:119]
v_permlane32_swap_b32 v126,v127
v_max_f32 v126,v126,v127
v_mul_f32 v126,v1,v126
v_pk_add_f32 v[34:35],v[34:35],v[126:127] op_sel_hi:[1,0] neg_lo:[0,1] neg_hi:[0,1]
v_pk_add_f32 v[24:25],v[24:25],v[126:127] op_sel_hi:[1,0] neg_lo:[0,1] neg_hi:[0,1]
v_pk_fma_f32 v[26:27],v[26:27],v[0:1],v[126:127] op_sel:[0,1,0] op_sel_hi:[1,1,0] neg_lo:[0,0,1] neg_hi:[0,0,1]
v_pk_fma_f32 v[28:29],v[28:29],v[0:1],v[126:127] op_sel:[0,1,0] op_sel_hi:[1,1,0] neg_lo:[0,0,1] neg_hi:[0,0,1]
v_pk_fma_f32 v[30:31],v[30:31],v[0:1],v[126:127] op_sel:[0,1,0] op_sel_hi:[1,1,0] neg_lo:[0,0,1] neg_hi:[0,0,1]
v_exp_f32 v34,v34
v_exp_f32 v35,v35
v_cvt_pk_bf16_f32 v126,v112,v113
v_cvt_pk_bf16_f32 v124,v34,v35
v_cvt_pk_bf16_f32 v127,v116,v117
v_cvt_pk_bf16_f32 v36,v116,v117
v_mfma_f32_16x16x16_bf16 v[32:35],v[14:15],v[124:125],0
ds_read_b128 v[44:47],v11 offset:13312
v_exp_f32 v24,v24
v_mfma_f32_16x16x16_bf16 v[112:115],v[126:127],v[124:125],0
ds_read_b128 v[48:51],v11 offset:14336
v_exp_f32 v25,v25
v_mfma_f32_16x16x16_bf16 v[116:119],v[36:37],v[124:125],0
ds_read_b128 v[52:55],v11 offset:15360
v_exp_f32 v26,v26
v_exp_f32 v27,v27
v_cvt_pk_bf16_f32 v120,v24,v25
v_exp_f32 v28,v28
v_exp_f32 v29,v29
v_cvt_pk_bf16_f32 v121,v26,v27
v_exp_f32 v30,v30
v_exp_f32 v31,v31
v_cvt_pk_bf16_f32 v122,v28,v29
v_cvt_pk_bf16_f32 v123,v30,v31
s_add_u32 s75,s75,8192
s_add_u32 s51,s51,1
v_mfma_f32_16x16x32_bf16 v[32:35],v[14:17],v[120:123],v[32:35]
v_mfma_f32_16x16x32_bf16 v[112:115],v[88:91],v[120:123],v[112:115]
ds_read_b128 v[88:91],v11 offset:16384
v_mfma_f32_16x16x32_bf16 v[116:119],v[92:95],v[120:123],v[116:119]
ds_read_b128 v[92:95],v11 offset:17408
v_rcp_f32 v32,v32
v_mov_b64 v[24:25],-1
v_mov_b64 v[26:27],-1
s_add_u32 s64,s75,13631488
s_add_u32 s70,s64,4096
v_pk_mul_f32 v[112:113],v[112:113],v[32:33] op_sel_hi:[1,0]
v_pk_mul_f32 v[114:115],v[114:115],v[32:33] op_sel_hi:[1,0]
v_pk_mul_f32 v[116:117],v[116:117],v[32:33] op_sel_hi:[1,0]
v_pk_mul_f32 v[118:119],v[118:119],v[32:33] op_sel_hi:[1,0]
v_cvt_pk_bf16_f32 v120,v112,v116
v_cvt_pk_bf16_f32 v121,v113,v117
v_cvt_pk_bf16_f32 v122,v114,v118
v_cvt_pk_bf16_f32 v123,v115,v119
ds_write_b128 v7,v[120:123]
buffer_store_dwordx4 v[24:27],v0,s[8:11],s69 offen sc1
buffer_store_dwordx4 v[24:27],v0,s[8:11],s69 offen offset:1024 sc1
v_mov_b64 v[112:113],0
v_mov_b64 v[114:115],0
v_mov_b64 v[116:117],0
v_mov_b64 v[118:119],0
s_waitcnt lgkmcnt(0)
s_barrier
ds_read_b128 v[24:27],v8 offset:0
ds_read_b128 v[28:31],v8 offset:512
ds_read_b128 v[32:35],v8 offset:1024
ds_read_b128 v[36:39],v8 offset:1536
v_mov_b64 v[120:121],0
v_mov_b64 v[122:123],0
s_add_u32 s57,s65,65536
s_add_u32 s58,s65,131072
s_add_u32 s59,s65,196608
s_add_u32 s56,s18,s75
s_waitcnt lgkmcnt(3)
v_smfmac_f32_16x16x64_bf16 v[112:115],v[24:27],v[56:63],v3
ds_read_b128 v[56:59],v11 offset:18432
s_waitcnt lgkmcnt(3)
v_smfmac_f32_16x16x64_bf16 v[112:115],v[28:31],v[64:71],v3
ds_read_b128 v[60:63],v11 offset:19456
s_waitcnt lgkmcnt(3)
v_smfmac_f32_16x16x64_bf16 v[112:115],v[32:35],v[72:79],v3
ds_read_b128 v[64:67],v11 offset:20480
s_waitcnt lgkmcnt(3)
v_smfmac_f32_16x16x64_bf16 v[112:115],v[36:39],v[80:87],v3
ds_read_b128 v[68:71],v11 offset:21504
v_smfmac_f32_16x16x64_bf16 v[116:119],v[24:27],v[96:103],v3
ds_read_b128 v[72:75],v11 offset:22528
v_smfmac_f32_16x16x64_bf16 v[116:119],v[28:31],v[104:111],v3
ds_read_b128 v[76:79],v11 offset:23552
v_cvt_pk_bf16_f32 v112,v112,v113
v_smfmac_f32_16x16x64_bf16 v[116:119],v[32:35],v[40:47],v3
ds_read_b128 v[80:83],v11 offset:24576
v_cvt_pk_bf16_f32 v113,v114,v115
buffer_store_dwordx2 v[112:113],v9,s[8:11],s65 offen sc1
v_smfmac_f32_16x16x64_bf16 v[116:119],v[36:39],v[48:55],v3
ds_read_b128 v[84:87],v11 offset:25600
v_mov_b64 v[112:113],0
v_smfmac_f32_16x16x64_bf16 v[120:123],v[24:27],v[88:95],v3
ds_read_b128 v[96:99],v11 offset:26624
ds_read_b128 v[100:103],v11 offset:27648
v_mov_b64 v[114:115],0
s_waitcnt lgkmcnt(8)
v_smfmac_f32_16x16x64_bf16 v[120:123],v[28:31],v[56:63],v3
ds_read_b128 v[104:107],v11 offset:28672
v_cvt_pk_bf16_f32 v116,v116,v117
s_waitcnt lgkmcnt(7)
v_smfmac_f32_16x16x64_bf16 v[120:123],v[32:35],v[64:71],v3
ds_read_b128 v[108:111],v11 offset:29696
ds_read_b128 v[40:43],v11 offset:30720
v_cvt_pk_bf16_f32 v117,v118,v119
buffer_store_dwordx2 v[116:117],v9,s[8:11],s57 offen sc1
s_waitcnt lgkmcnt(7)
v_smfmac_f32_16x16x64_bf16 v[120:123],v[36:39],v[72:79],v3
ds_read_b128 v[44:47],v11 offset:31744
v_add_u32 v52,s50,v5
s_waitcnt lgkmcnt(6)
v_smfmac_f32_16x16x64_bf16 v[112:115],v[24:27],v[80:87],v3
v_add_u32 v54,s50,v6
s_waitcnt lgkmcnt(4)
v_smfmac_f32_16x16x64_bf16 v[112:115],v[28:31],v[96:103],v3
ds_read_b64_tr_b16 v[52:53],v52
v_cvt_pk_bf16_f32 v120,v120,v121
s_waitcnt lgkmcnt(3)
v_smfmac_f32_16x16x64_bf16 v[112:115],v[32:35],v[104:111],v3
ds_read_b64_tr_b16 v[54:55],v54
v_cvt_pk_bf16_f32 v121,v122,v123
buffer_store_dwordx2 v[120:121],v9,s[8:11],s58 offen sc1
s_waitcnt lgkmcnt(2)
v_smfmac_f32_16x16x64_bf16 v[112:115],v[36:39],v[40:47],v3
v_mov_b64 v[116:117],0
v_mov_b64 v[118:119],0
s_xor_b32 s65,s65,262144
v_mov_b32_dpp v124,v126 quad_perm:[2,3,2,3] row_mask:0xf bank_mask:0xf
v_mov_b32_dpp v125,v127 quad_perm:[2,3,2,3] row_mask:0xf bank_mask:0xf
s_mov_b32 vcc_lo,0xcccccccc
s_mov_b32 vcc_hi,0xcccccccc
s_nop 0
v_cvt_pk_bf16_f32 v112,v112,v113
v_cvt_pk_bf16_f32 v113,v114,v115
buffer_store_dwordx2 v[112:113],v9,s[8:11],s59 offen sc1
s_waitcnt lgkmcnt(0)
s_buffer_load_dword s19,s[8:11],s56
v_cndmask_b32 v124,v124,v52,vcc
v_cndmask_b32 v125,v125,v53,vcc
s_cmp_lt_u32 s46,2
s_waitcnt vmcnt(3)
s_cbranch_scc1 L_crg_314
s_cmp_eq_u32 s46,2
s_waitcnt vmcnt(1)
s_cbranch_scc1 L_crg_314
s_waitcnt vmcnt(0)
L_crg_314:
buffer_load_dwordx4 v[32:35],v0,s[8:11],s66 offen offset:0 sc1
buffer_load_dwordx4 v[36:39],v0,s[8:11],s66 offen offset:1024 sc1
v_cndmask_b32 v126,v126,v54,vcc
v_cndmask_b32 v127,v127,v55,vcc
v_mov_b64 v[96:97],0
v_mov_b64 v[98:99],0
v_mov_b64 v[100:101],0
v_mov_b64 v[102:103],0
v_mov_b64 v[104:105],0
v_mov_b64 v[106:107],0
v_mov_b64 v[108:109],0
v_mov_b64 v[110:111],0
v_mov_b64 v[112:113],0
v_mov_b64 v[114:115],0
v_add_u32 v55,131072,v0
v_add_u32 v123,s73,v55
v_xor_b32 v120,1024,v12
v_xor_b32 v121,2048,v12
v_xor_b32 v122,3072,v12
buffer_load_dwordx4 v[44:47],v0,s[8:11],s66 offen offset:0 sc1
buffer_load_dwordx4 v[48:51],v0,s[8:11],s66 offen offset:1024 sc1
s_cmp_ge_u32 s51,63
s_cselect_b32 s76,0,1
v_readlane_b32 s56,v23,5
v_readlane_b32 s20,v23,4
v_add_u32 v23,-1,v23
v_cmp_le_u32 vcc,s30,v23
s_cmp_gt_u32 s51,61
s_cselect_b32 s77,0,vcc_hi
s_cmp_gt_u32 s20,s30
s_cselect_b32 s77,1,s77
s_cmp_lg_u32 s77,0
s_cselect_b32 s76,2,s76
s_cmp_gt_u32 s56,s30
s_cbranch_scc1 L_cld_290
L_clb_291:
s_cmp_eq_u32 s46,0
s_cselect_b32 s76,s76,0
s_waitcnt vmcnt(3)
v_mfma_f32_16x16x32_bf16 v[28:31],v[18:21],v[32:35],0
s_waitcnt vmcnt(2)
v_mfma_f32_16x16x32_bf16 v[28:31],v[18:21],v[36:39],v[28:31]
s_nop 7
v_cmp_u_f32 vcc,v28,v28
v_add_f32_dpp v52,v28,v28 row_ror:8 row_mask:0xf bank_mask:0x3
v_add_f32_dpp v53,v29,v29 row_ror:8 row_mask:0xf bank_mask:0x3
v_add_f32_dpp v52,v30,v30 row_ror:8 row_mask:0xf bank_mask:0xc
v_add_f32_dpp v53,v31,v31 row_ror:8 row_mask:0xf bank_mask:0xc
s_cbranch_vccnz L_crp_309
L_cok_315:
v_add_f32_dpp v52,v52,v52 row_shl:4 row_mask:0xf bank_mask:0x5
v_add_f32_dpp v53,v53,v53 row_shl:4 row_mask:0xf bank_mask:0x5
v_cvt_pk_bf16_f32 v54,v52,v53
buffer_store_dword v54,v10,s[8:11],s64 offen sc1
s_mov_b32 s69,s66
s_xor_b32 s66,s66,262144
s_barrier
ds_read_b128 v[56:59],v55 offset:0
ds_read_b128 v[60:63],v55 offset:4096
ds_read_b128 v[64:67],v55 offset:1024
buffer_load_dwordx4 v[24:27],v13,s[8:11],s64 offen sc1
ds_read_b128 v[68:71],v55 offset:5120
ds_read_b128 v[72:75],v55 offset:2048
ds_read_b128 v[76:79],v55 offset:6144
ds_read_b128 v[80:83],v55 offset:3072
buffer_load_dwordx4 v[24:27],v13,s[8:11],s64 offen sc1
ds_read_b128 v[84:87],v55 offset:7168
ds_read_b128 v[88:91],v123 offset:8192
ds_read_b128 v[92:95],v123 offset:9216
s_branch L_chain_304
L_cpb_311:
buffer_load_dwordx4 v[40:43],v13,s[8:11],s70 offen sc1
s_sub_u32 s49,s49,1
s_cbranch_scc1 L_abort2
s_waitcnt vmcnt(0)
v_max3_u32 v123,v40,v41,v42
v_max_u32 v123,v43,v123
v_cmp_le_u32 vcc,s72,v123
s_cbranch_vccnz L_cpb_311
ds_write_b128 v12,v[40:43] offset:4096
s_branch L_cback_313
L_crp_309:
buffer_load_dwordx4 v[32:35],v0,s[8:11],s66 offen offset:0 sc1
buffer_load_dwordx4 v[36:39],v0,s[8:11],s66 offen offset:1024 sc1
s_sub_u32 s49,s49,1
s_cbranch_scc1 L_abort2
s_waitcnt vmcnt(3)
v_mfma_f32_16x16x32_bf16 v[28:31],v[18:21],v[44:47],0
s_waitcnt vmcnt(2)
v_mfma_f32_16x16x32_bf16 v[28:31],v[18:21],v[48:51],v[28:31]
s_nop 7
v_cmp_u_f32 vcc,v28,v28
v_add_f32_dpp v52,v28,v28 row_ror:8 row_mask:0xf bank_mask:0x3
v_add_f32_dpp v53,v29,v29 row_ror:8 row_mask:0xf bank_mask:0x3
v_add_f32_dpp v52,v30,v30 row_ror:8 row_mask:0xf bank_mask:0xc
v_add_f32_dpp v53,v31,v31 row_ror:8 row_mask:0xf bank_mask:0xc
s_cbranch_vccz L_cok_315
buffer_load_dwordx4 v[44:47],v0,s[8:11],s66 offen offset:0 sc1
buffer_load_dwordx4 v[48:51],v0,s[8:11],s66 offen offset:1024 sc1
s_sub_u32 s49,s49,1
s_cbranch_scc1 L_abort2
s_waitcnt vmcnt(3)
v_mfma_f32_16x16x32_bf16 v[28:31],v[18:21],v[32:35],0
s_waitcnt vmcnt(2)
v_mfma_f32_16x16x32_bf16 v[28:31],v[18:21],v[36:39],v[28:31]
s_nop 7
v_cmp_u_f32 vcc,v28,v28
v_add_f32_dpp v52,v28,v28 row_ror:8 row_mask:0xf bank_mask:0x3
v_add_f32_dpp v53,v29,v29 row_ror:8 row_mask:0xf bank_mask:0x3
v_add_f32_dpp v52,v30,v30 row_ror:8 row_mask:0xf bank_mask:0xc
v_add_f32_dpp v53,v31,v31 row_ror:8 row_mask:0xf bank_mask:0xc
s_cbranch_vccz L_cok_315
s_branch L_crp_309
L_ckw_294:
s_cmp_eq_u32 s77,0
s_cbranch_scc1 L_cjw_296
s_cmp_gt_u32 s20,s30
s_cbranch_scc1 L_cjs_292
s_add_u32 s31,s51,2
s_lshl_b32 s59,s31,13
s_add_u32 s59,s59,10486016
v_lshrrev_b32 v45,2,v0
v_and_b32 v45,127,v45
L_ckk_316:
s_sleep 1
buffer_load_dword v44,v45,s[8:11],s59 offen sc1
s_sub_u32 s49,s49,1
s_cbranch_scc1 L_abort2
s_waitcnt vmcnt(0)
v_cmp_eq_u32 vcc,0,v44
s_cbranch_vccnz L_ckk_316
v_cmp_lt_u32 vcc,s30,v44
s_cbranch_vccz L_cjw_296
v_max_u32_dpp v44,v44,v44 row_ror:8 row_mask:0xf bank_mask:0xf
s_nop 1
v_max_u32_dpp v44,v44,v44 row_ror:4 row_mask:0xf bank_mask:0xf
s_nop 1
v_max_u32_dpp v44,v44,v44 row_ror:2 row_mask:0xf bank_mask:0xf
s_nop 1
v_max_u32_dpp v44,v44,v44 row_ror:1 row_mask:0xf bank_mask:0xf
v_mov_b32 v45,v44
s_nop 1
v_permlane16_swap_b32 v44,v45
v_max_u32 v44,v44,v45
v_mov_b32 v45,v44
s_nop 1
v_permlane32_swap_b32 v44,v45
v_max_u32 v44,v44,v45
s_nop 0
v_readfirstlane_b32 s20,v44
L_cjs_292:
s_mov_b32 s30,s20
s_andn2_b32 s31,0x7ff,s20
s_lshr_b32 s31,s31,5
s_add_u32 s31,s31,1
s_min_u32 s31,s31,63
ds_write_b32 v8,v2 offset:2560
s_waitcnt lgkmcnt(0)
s_branch L_ckb_295
L_cld_290:
v_mov_b32 v23,s56
s_add_u32 s56,s75,10495616
buffer_store_dword v23,off,s[8:11],s56 sc1
s_waitcnt vmcnt(0)
s_branch L_clb_291
L_cjw_296:
s_cmp_lg_u32 s19,0
s_cbranch_scc1 L_ckb_295
s_add_u32 s59,s18,s75
L_ww_317:
buffer_load_dword v23,off,s[8:11],s59 sc1
s_sub_u32 s49,s49,1
s_cbranch_scc1 L_abort2
s_waitcnt vmcnt(0)
v_readfirstlane_b32 s76,v23
s_cmp_eq_u32 s76,0
s_cbranch_scc1 L_ww_317
L_wwd_318:
s_branch L_ckb_295
L_cjump_297:
s_waitcnt vmcnt(0) lgkmcnt(0)
s_barrier
s_branch L_cst_293
L_cend_307:
v_smfmac_f32_16x16x64_bf16 v[116:119],v[36:39],v[184:191],v2
v_smfmac_f32_16x16x64_bf16 v[112:115],v[40:43],v[192:199],v2
v_smfmac_f32_16x16x64_bf16 v[116:119],v[40:43],v[200:207],v2
v_smfmac_f32_16x16x64_bf16 v[112:115],v[44:47],v[208:215],v2
v_smfmac_f32_16x16x64_bf16 v[116:119],v[44:47],v[216:223],v2
v_smfmac_f32_16x16x64_bf16 v[112:115],v[48:51],v[224:231],v2
v_smfmac_f32_16x16x64_bf16 v[116:119],v[48:51],v[232:239],v2
v_smfmac_f32_16x16x64_bf16 v[112:115],v[52:55],v[240:247],v2
v_smfmac_f32_16x16x64_bf16 v[116:119],v[52:55],v[248:255],v2
s_waitcnt lgkmcnt(0)
s_nop 2
v_pk_add_f32 v[112:113],v[112:113],v[114:115]
s_nop 2
v_pk_add_f32 v[116:117],v[116:117],v[118:119]
v_cvt_pk_bf16_f32 v126,v112,v113
v_cvt_pk_bf16_f32 v127,v116,v117
v_add_u32 v52,s50,v5
v_add_u32 v54,s50,v6
ds_read_b64_tr_b16 v[52:53],v52
ds_read_b64_tr_b16 v[54:55],v54
v_mov_b32_dpp v124,v126 quad_perm:[2,3,2,3] row_mask:0xf bank_mask:0xf
v_mov_b32_dpp v125,v127 quad_perm:[2,3,2,3] row_mask:0xf bank_mask:0xf
s_mov_b32 vcc_lo,0xcccccccc
s_mov_b32 vcc_hi,0xcccccccc
s_waitcnt lgkmcnt(0)
v_cndmask_b32 v124,v124,v52,vcc
v_cndmask_b32 v125,v125,v53,vcc
v_cndmask_b32 v126,v126,v54,vcc
v_cndmask_b32 v127,v127,v55,vcc
buffer_store_dwordx4 v[124:127],v0,s[8:11],s54 offen sc1
s_mov_b32 s51,64
s_waitcnt vmcnt(0)
s_barrier
s_nop 11
v_lshrrev_b32 v1,4,v0
s_endpgm
L_wa:
s_nop 11
v_and_b32 v238,15,v1
v_and_b32 v239,1,v1
v_lshlrev_b32 v239,4,v239
v_mov_b32 v240,0x3f80
v_lshlrev_b32 v240,v239,v240
v_lshrrev_b32 v238,1,v238
v_cmp_eq_u32 vcc,0,v238
s_nop 1
v_cndmask_b32 v156,0,v240,vcc
v_cmp_eq_u32 vcc,1,v238
s_nop 1
v_cndmask_b32 v157,0,v240,vcc
v_cmp_eq_u32 vcc,2,v238
s_nop 1
v_cndmask_b32 v158,0,v240,vcc
v_cmp_eq_u32 vcc,3,v238
s_nop 1
v_cndmask_b32 v159,0,v240,vcc
s_mov_b32 s4,s32
s_mov_b32 s5,s33
s_mov_b32 s6,1024
s_mov_b32 s7,0x20000
buffer_load_dwordx4 v[224:227],v0,s[4:7],0 offen
v_and_b32 v238,15,v1
v_lshrrev_b32 v239,4,v1
v_lshlrev_b32 v240,2,v239
v_mov_b32 v241,0xf149f2ca
s_and_b32 s56,s46,1
s_lshl_b32 s56,s56,4
v_add_u32 v242,s56,v238
v_add_u32 v243,0,v240
v_cmp_gt_u32 vcc,v243,v242
s_nop 1
v_cndmask_b32 v8,0,v241,vcc
v_add_u32 v243,1,v240
v_cmp_gt_u32 vcc,v243,v242
s_nop 1
v_cndmask_b32 v9,0,v241,vcc
v_add_u32 v243,2,v240
v_cmp_gt_u32 vcc,v243,v242
s_nop 1
v_cndmask_b32 v10,0,v241,vcc
v_add_u32 v243,3,v240
v_cmp_gt_u32 vcc,v243,v242
s_nop 1
v_cndmask_b32 v11,0,v241,vcc
v_add_u32 v243,16,v240
v_cmp_gt_u32 vcc,v243,v242
s_nop 1
v_cndmask_b32 v12,0,v241,vcc
v_add_u32 v243,17,v240
v_cmp_gt_u32 vcc,v243,v242
s_nop 1
v_cndmask_b32 v13,0,v241,vcc
v_add_u32 v243,18,v240
v_cmp_gt_u32 vcc,v243,v242
s_nop 1
v_cndmask_b32 v14,0,v241,vcc
v_add_u32 v243,19,v240
v_cmp_gt_u32 vcc,v243,v242
s_nop 1
v_cndmask_b32 v15,0,v241,vcc
v_mov_b32 v152,s80
v_mov_b32 v145,0
v_mov_b32 v146,0
s_lshl_b32 s56,s46,12
s_add_u32 s56,s56,131072
v_add_u32 v3,s56,v0
v_add_u32 v4,131072,v0
s_lshl_b32 s56,s46,8
v_lshlrev_b32 v7,4,v238
v_add_u32 v7,s56,v7
v_lshl_add_u32 v5,v239,16,v7
v_lshlrev_b32 v6,1,v7
v_lshl_add_u32 v7,v239,10,v7
v_and_b32 v243,1,v239
v_lshl_add_u32 v6,v243,4,v6
v_lshrrev_b32 v243,1,v239
v_lshl_add_u32 v6,v243,12,v6
v_add_u32 v6,147456,v6
v_lshlrev_b32 v16,2,v1
v_lshlrev_b32 v21,3,v238
s_and_b32 s68,s47,15
s_lshl_b32 s56,s68,10
v_add_u32 v5,s56,v5
s_lshl_b32 s56,s68,15
v_add_u32 v7,s56,v7
s_lshl_b32 s69,s54,20
s_add_u32 s69,s69,20971520
s_lshl_b32 s87,s54,13
s_add_u32 s87,s87,10486272
s_lshl4_add_u32 s74,s68,s87
s_lshl2_add_u32 s74,s46,s74
s_lshl_b32 s68,s68,1
s_lshr_b32 s56,s46,1
s_add_u32 s68,s68,s56
s_mov_b32 s66,0
s_mov_b32 s67,0
s_mov_b32 s73,0x80000000
s_mov_b32 s75,0
s_mov_b32 s37,0
s_mov_b32 s42,4294966272
s_mov_b32 s43,4294967295
s_mov_b64 s[38:39],0
s_sub_u32 s36,s54,12
s_and_b32 s36,s36,3
s_mov_b32 s12,s40
s_mov_b32 s13,s41
s_mov_b32 s14,2097152
s_mov_b32 s15,0x20000
s_and_b32 s29,s46,1
s_mul_i32 s28,s29,12288
s_lshl_b32 s29,s29,11
s_and_b32 s56,s50,2048
s_lshl_b32 s56,s56,4
s_add_u32 s56,s56,65536
s_add_u32 s40,s56,s28
s_add_u32 s41,s56,s29
v_add_u32 v21,10487168,v21
v_mov_b32 v244,v21
s_and_b32 s56,s50,2048
s_add_u32 s56,s56,147456
v_lshlrev_b32 v23,5,v1
v_add_u32 v23,s56,v23
v_and_b32 v253,32,v0
v_lshrrev_b32 v245,2,v253
v_add_u32 v253,v253,v245
v_sub_u32 v253,v0,v253
v_add_u32 v253,8,v253
v_mov_b32 v254,0x80000000
s_mov_b32 s56,1408
v_writelane_b32 v254,s56,0
s_mov_b32 s56,256
v_writelane_b32 v254,s56,1
s_mov_b32 s56,1280
v_writelane_b32 v254,s56,2
v_mov_b32 v245,155648
s_lshl_b32 s56,s46,2
v_add_u32 v247,s56,v245
s_waitcnt vmcnt(0)
v_lshlrev_b32 v228,16,v224
v_and_b32 v229,0xffff0000,v224
v_lshlrev_b32 v230,16,v225
v_and_b32 v231,0xffff0000,v225
v_lshlrev_b32 v232,16,v226
v_and_b32 v233,0xffff0000,v226
v_lshlrev_b32 v234,16,v227
v_and_b32 v235,0xffff0000,v227
v_mul_f32 v255,v228,v228
v_fma_f32 v255,v229,v229,v255
v_fma_f32 v255,v230,v230,v255
v_fma_f32 v255,v231,v231,v255
v_fma_f32 v255,v232,v232,v255
v_fma_f32 v255,v233,v233,v255
v_fma_f32 v255,v234,v234,v255
v_fma_f32 v255,v235,v235,v255
s_nop 1
v_add_f32_dpp v255,v255,v255 row_ror:8 row_mask:0xf bank_mask:0xf
s_nop 1
v_add_f32_dpp v255,v255,v255 row_ror:4 row_mask:0xf bank_mask:0xf
s_nop 1
v_add_f32_dpp v255,v255,v255 row_ror:2 row_mask:0xf bank_mask:0xf
s_nop 1
v_add_f32_dpp v255,v255,v255 row_ror:1 row_mask:0xf bank_mask:0xf
v_mov_b32 v238,v255
s_nop 1
v_permlane16_swap_b32 v255,v238
v_add_f32 v255,v255,v238
v_mov_b32 v238,v255
s_nop 1
v_permlane32_swap_b32 v255,v238
v_add_f32 v255,v255,v238
v_sqrt_f32 v255,v255
v_sub_u32 v238,67,v1
v_cvt_f32_u32 v238,v238
v_log_f32 v238,v238
v_mov_b32 v239,0x3ff9999a
v_fmac_f32 v239,0x3e632166,v238
v_mul_f32 v255,v255,v239
v_or_b32 v255,0x80000000,v255
s_cmp_lt_u32 s54,2
s_cbranch_scc1 L_aa_319
s_sub_u32 s77,s54,2
s_mov_b32 s30,0
s_mov_b32 s86,1536
s_lshl_b32 s56,s77,5
s_add_u32 s56,s56,s68
s_mul_i32 s70,s56,24576
s_lshl_b32 s71,s56,12
s_lshl_b32 s59,s77,13
s_lshl2_add_u32 s59,s68,s59
s_add_u32 s59,s59,10485760
s_buffer_load_dword s32,s[8:11],s59
s_mov_b32 s33,1
s_add_u32 s70,s70,100663296
s_add_u32 s71,s71,41943040
v_mov_b32 v19,s59
s_branch L_aa_327
L_aa_333:
s_bitcmp1_b32 s46,0
s_cbranch_scc1 L_av_334
ds_read_b128 v[24:27],v4 offset:0
ds_read_b128 v[28:31],v4 offset:1024
s_min_u32 s56,s32,s33
s_cmp_lt_u32 s77,64
s_cselect_b32 s56,s56,0
s_cmp_eq_u32 s56,0
s_cselect_b32 s72,0x80000000,0
v_mov_b32 v248,s72
s_or_b32 s64,s70,s72
s_or_b32 s65,s71,s72
s_cmp_lt_u32 s30,s31
s_cselect_b32 s65,0x80000000,s65
s_add_u32 s64,s64,s28
s_add_u32 s65,s65,s29
s_xor_b32 s58,s67,s40
s_xor_b32 s57,s67,s41
s_add_u32 m0,s58,0
s_waitcnt lgkmcnt(1)
v_mfma_f32_16x16x32_bf16 v[160:163],v[24:27],a[0:3],0
buffer_load_dwordx4 v0,s[8:11],s64 offen offset:0 sc1 lds
v_mfma_f32_16x16x32_bf16 v[164:167],v[24:27],a[4:7],0
ds_read_b128 v[32:35],v4 offset:2048
v_lshlrev_b32 v88,16,v224
v_mfma_f32_16x16x32_bf16 v[168:171],v[24:27],a[8:11],0
ds_read_b128 v[36:39],v4 offset:3072
v_and_b32 v89,0xffff0000,v224
v_mfma_f32_16x16x32_bf16 v[172:175],v[24:27],a[12:15],0
ds_read_b128 v[40:43],v4 offset:8192
v_lshlrev_b32 v90,16,v225
v_mfma_f32_16x16x32_bf16 v[176:179],v[24:27],a[16:19],0
ds_read_b128 v[44:47],v4 offset:9216
v_and_b32 v91,0xffff0000,v225
v_mfma_f32_16x16x32_bf16 v[180:183],v[24:27],a[20:23],0
buffer_load_dwordx4 v0,s[8:11],s64 offen offset:1024 sc1 lds
v_mfma_f32_16x16x32_bf16 v[184:187],v[24:27],a[24:27],0
ds_read_b128 v[48:51],v4 offset:10240
s_waitcnt vmcnt(9)
v_mfma_f32_16x16x32_bf16 v[188:191],v[24:27],a[28:31],0
ds_read_b128 v[52:55],v4 offset:11264
v_mfma_f32_16x16x32_bf16 v[128:131],v[156:159],v[192:195],0
ds_write_b32 v247,v248
v_lshlrev_b32 v92,16,v226
s_waitcnt lgkmcnt(7)
v_mfma_f32_16x16x32_bf16 v[160:163],v[28:31],a[32:35],v[160:163]
ds_read_b128 v[56:59],v4 offset:4096
s_waitcnt vmcnt(8)
v_mfma_f32_16x16x32_bf16 v[164:167],v[28:31],a[36:39],v[164:167]
ds_read_b128 v[60:63],v4 offset:5120
v_mfma_f32_16x16x32_bf16 v[128:131],v[156:159],v[196:199],v[128:131]
ds_read_b128 v[64:67],v4 offset:6144
v_and_b32 v93,0xffff0000,v226
v_mfma_f32_16x16x32_bf16 v[168:171],v[28:31],a[40:43],v[168:171]
buffer_load_dwordx4 v0,s[8:11],s64 offen offset:2048 sc1 lds
v_mfma_f32_16x16x32_bf16 v[172:175],v[28:31],a[44:47],v[172:175]
ds_read_b128 v[68:71],v4 offset:7168
s_waitcnt vmcnt(8)
v_mfma_f32_16x16x32_bf16 v[176:179],v[28:31],a[48:51],v[176:179]
ds_read_b128 v[72:75],v4 offset:12288
v_mfma_f32_16x16x32_bf16 v[128:131],v[156:159],v[200:203],v[128:131]
ds_read_b128 v[76:79],v4 offset:13312
v_lshlrev_b32 v94,16,v227
v_mfma_f32_16x16x32_bf16 v[180:183],v[28:31],a[52:55],v[180:183]
ds_read_b128 v[80:83],v4 offset:14336
s_waitcnt vmcnt(7)
v_mfma_f32_16x16x32_bf16 v[184:187],v[28:31],a[56:59],v[184:187]
ds_read_b128 v[84:87],v4 offset:15360
v_mfma_f32_16x16x32_bf16 v[128:131],v[156:159],v[204:207],v[128:131]
v_and_b32 v95,0xffff0000,v227
v_readfirstlane_b32 s22,v246
v_mfma_f32_16x16x32_bf16 v[188:191],v[28:31],a[60:63],v[188:191]
buffer_load_dwordx4 v0,s[8:11],s64 offen offset:3072 sc1 lds
s_waitcnt lgkmcnt(14)
v_mfma_f32_16x16x32_bf16 v[160:163],v[32:35],a[64:67],v[160:163]
s_waitcnt vmcnt(7)
v_mfma_f32_16x16x32_bf16 v[132:135],v[156:159],v[208:211],0
s_cmp_eq_u32 s22,0
s_cbranch_scc1 L_ag_335
L_agb_336:
v_mfma_f32_16x16x32_bf16 v[164:167],v[32:35],a[68:71],v[164:167]
s_waitcnt vmcnt(6)
v_mfma_f32_16x16x32_bf16 v[132:135],v[156:159],v[212:215],v[132:135]
s_lshl_b32 s18,s26,5
s_add_u32 s18,s18,s68
s_lshl_b32 s19,s18,10
v_mfma_f32_16x16x32_bf16 v[168:171],v[32:35],a[72:75],v[168:171]
s_waitcnt vmcnt(5)
v_mfma_f32_16x16x32_bf16 v[132:135],v[156:159],v[216:219],v[132:135]
s_add_u32 s20,s19,6291456
s_lshl_b32 s23,s51,5
s_add_u32 s23,s23,s68
v_mfma_f32_16x16x32_bf16 v[172:175],v[32:35],a[76:79],v[172:175]
ds_write_b128 v6,v[128:131]
v_mfma_f32_16x16x32_bf16 v[176:179],v[32:35],a[80:83],v[176:179]
s_waitcnt vmcnt(4)
v_mfma_f32_16x16x32_bf16 v[132:135],v[156:159],v[220:223],v[132:135]
s_add_u32 m0,s58,4096
s_add_u32 s64,s64,4096
s_lshl_b32 s24,s23,10
v_mfma_f32_16x16x32_bf16 v[180:183],v[32:35],a[84:87],v[180:183]
buffer_load_dwordx4 v0,s[8:11],s64 offen offset:0 sc1 lds
v_mfma_f32_16x16x32_bf16 v[184:187],v[32:35],a[88:91],v[184:187]
s_lshl_b32 s25,s51,10
s_add_u32 s25,s25,2883584
s_cmp_eq_u32 s23,s55
s_cselect_b32 s25,s25,s24
v_mfma_f32_16x16x32_bf16 v[188:191],v[32:35],a[92:95],v[188:191]
ds_write_b128 v6,v[132:135] offset:2048
s_waitcnt lgkmcnt(15)
v_mfma_f32_16x16x32_bf16 v[160:163],v[36:39],a[96:99],v[160:163]
s_add_u32 s25,s25,8388608
s_mov_b32 s6,268435456
s_cmp_eq_u32 s31,0
s_cselect_b32 s25,s24,s25
s_cselect_b64 s[4:5],s[16:17],s[44:45]
s_cmov_b32 s6,2097152
v_mfma_f32_16x16x32_bf16 v[164:167],v[36:39],a[100:103],v[164:167]
buffer_load_dwordx4 v[224:227],v0,s[4:7],s25 offen sc1
v_mfma_f32_16x16x32_bf16 v[168:171],v[36:39],a[104:107],v[168:171]
buffer_load_dwordx4 v0,s[8:11],s64 offen offset:1024 sc1 lds
v_mfma_f32_16x16x32_bf16 v[172:175],v[36:39],a[108:111],v[172:175]
s_lshr_b32 s24,s55,5
s_cmp_lt_u32 s51,s24
s_cselect_b32 s24,1,2
v_mfma_f32_16x16x32_bf16 v[176:179],v[36:39],a[112:115],v[176:179]
s_waitcnt lgkmcnt(0)
s_barrier
v_mov_b32 v252,s24
v_mfma_f32_16x16x32_bf16 v[180:183],v[36:39],a[116:119],v[180:183]
ds_read_b128 v[96:99],v23
s_lshl2_add_u32 s25,s51,11018240
v_mfma_f32_16x16x32_bf16 v[184:187],v[36:39],a[120:123],v[184:187]
ds_read_b128 v[100:103],v23 offset:16
s_lshl_b32 s24,s68,16
v_mfma_f32_16x16x32_bf16 v[188:191],v[36:39],a[124:127],v[188:191]
buffer_load_dwordx4 v0,s[8:11],s64 offen offset:2048 sc1 lds
s_add_u32 s24,s24,s31
v_mfma_f32_16x16x32_bf16 v[160:163],v[40:43],a[128:131],v[160:163]
ds_read_b128 v[248:251],v245
s_add_u32 s24,s24,s86
s_cmp_eq_u32 s24,1537
s_cselect_b32 s25,s25,0x80000000
v_mfma_f32_16x16x32_bf16 v[164:167],v[40:43],a[132:135],v[164:167]
buffer_store_dword v252,off,s[8:11],s25 sc1
s_bitcmp1_b64 s[38:39],s51
s_cselect_b32 s24,128,0
v_mfma_f32_16x16x32_bf16 v[168:171],v[40:43],a[136:139],v[168:171]
buffer_store_dword v20,off,s[8:11],s73 sc1
s_lshl_b32 s23,s51,13
v_mfma_f32_16x16x32_bf16 v[172:175],v[40:43],a[140:143],v[172:175]
s_lshl2_add_u32 s23,s68,s23
s_add_u32 s23,s23,10487168
s_add_u32 s23,s23,s24
s_mov_b32 s73,0x80000000
v_mfma_f32_16x16x32_bf16 v[176:179],v[40:43],a[144:147],v[176:179]
buffer_load_dwordx4 v0,s[8:11],s64 offen offset:3072 sc1 lds
v_mfma_f32_16x16x32_bf16 v[180:183],v[40:43],a[148:151],v[180:183]
buffer_load_dword v246,off,s[8:11],s23 sc1
v_lshrrev_b32 v244,4,v1
v_mfma_f32_16x16x32_bf16 v[184:187],v[40:43],a[152:155],v[184:187]
s_waitcnt lgkmcnt(0)
v_or3_b32 v248,v248,v249,v250
v_or_b32 v248,v248,v251
s_sub_u32 s23,s77,7
v_mfma_f32_16x16x32_bf16 v[188:191],v[40:43],a[156:159],v[188:191]
v_readfirstlane_b32 s72,v248
v_add_u32 v244,s23,v244
v_max_i32 v244,0,v244
v_mfma_f32_16x16x32_bf16 v[160:163],v[44:47],a[160:163],v[160:163]
s_waitcnt lgkmcnt(1)
v_lshl_add_u32 v244,v244,13,v21
v_cvt_pk_bf16_f32 v104,v96,v97
v_cvt_pk_bf16_f32 v105,v98,v99
v_mfma_f32_16x16x32_bf16 v[164:167],v[44:47],a[164:167],v[164:167]
buffer_load_dwordx2 v[242:243],v244,s[8:11],0 offen sc1
s_add_u32 m0,s58,8192
v_mfma_f32_16x16x32_bf16 v[168:171],v[44:47],a[168:171],v[168:171]
s_add_u32 s64,s64,4096
v_cvt_pk_bf16_f32 v106,v100,v101
v_cvt_pk_bf16_f32 v107,v102,v103
v_lshlrev_b32 v96,16,v104
v_mfma_f32_16x16x32_bf16 v[172:175],v[44:47],a[172:175],v[172:175]
buffer_load_dwordx4 v0,s[8:11],s64 offen offset:0 sc1 lds
v_and_b32 v97,0xffff0000,v104
v_mfma_f32_16x16x32_bf16 v[176:179],v[44:47],a[176:179],v[176:179]
v_lshlrev_b32 v98,16,v105
v_and_b32 v99,0xffff0000,v105
v_lshlrev_b32 v100,16,v106
v_mfma_f32_16x16x32_bf16 v[180:183],v[44:47],a[180:183],v[180:183]
v_and_b32 v101,0xffff0000,v106
v_lshlrev_b32 v102,16,v107
v_and_b32 v103,0xffff0000,v107
v_mfma_f32_16x16x32_bf16 v[184:187],v[44:47],a[184:187],v[184:187]
v_add_f32 v88,v88,v96
v_add_f32 v89,v89,v97
v_add_f32 v90,v90,v98
v_mfma_f32_16x16x32_bf16 v[188:191],v[44:47],a[188:191],v[188:191]
v_add_f32 v91,v91,v99
v_add_f32 v92,v92,v100
v_add_f32 v93,v93,v101
v_mfma_f32_16x16x32_bf16 v[160:163],v[48:51],a[192:195],v[160:163]
buffer_load_dwordx4 v0,s[8:11],s64 offen offset:1024 sc1 lds
v_add_f32 v94,v94,v102
v_mfma_f32_16x16x32_bf16 v[164:167],v[48:51],a[196:199],v[164:167]
v_add_f32 v95,v95,v103
v_cvt_pk_bf16_f32 v104,v88,v89
v_cvt_pk_bf16_f32 v105,v90,v91
v_mfma_f32_16x16x32_bf16 v[168:171],v[48:51],a[200:203],v[168:171]
v_cvt_pk_bf16_f32 v106,v92,v93
v_cvt_pk_bf16_f32 v107,v94,v95
v_mfma_f32_16x16x32_bf16 v[172:175],v[48:51],a[204:207],v[172:175]
buffer_store_dwordx4 v[104:107],v0,s[8:11],s20 offen sc1
v_lshlrev_b32 v88,16,v104
v_mfma_f32_16x16x32_bf16 v[176:179],v[48:51],a[208:211],v[176:179]
v_and_b32 v89,0xffff0000,v104
v_lshlrev_b32 v90,16,v105
v_and_b32 v91,0xffff0000,v105
v_mfma_f32_16x16x32_bf16 v[180:183],v[48:51],a[212:215],v[180:183]
buffer_load_dwordx4 v0,s[8:11],s64 offen offset:2048 sc1 lds
v_lshlrev_b32 v92,16,v106
v_mfma_f32_16x16x32_bf16 v[184:187],v[48:51],a[216:219],v[184:187]
v_and_b32 v93,0xffff0000,v106
v_lshlrev_b32 v94,16,v107
v_and_b32 v95,0xffff0000,v107
v_mfma_f32_16x16x32_bf16 v[188:191],v[48:51],a[220:223],v[188:191]
v_readfirstlane_b32 s78,v88
v_mfma_f32_16x16x32_bf16 v[160:163],v[52:55],a[224:227],v[160:163]
s_nop 0
v_add_f32 v120,v88,-s78
v_add_f32 v121,v89,-s78
v_add_f32 v122,v90,-s78
v_mfma_f32_16x16x32_bf16 v[164:167],v[52:55],a[228:231],v[164:167]
v_add_f32 v123,v91,-s78
v_add_f32 v124,v92,-s78
v_add_f32 v125,v93,-s78
v_mfma_f32_16x16x32_bf16 v[168:171],v[52:55],a[232:235],v[168:171]
buffer_load_dwordx4 v0,s[8:11],s64 offen offset:3072 sc1 lds
v_add_f32 v126,v94,-s78
v_mfma_f32_16x16x32_bf16 v[172:175],v[52:55],a[236:239],v[172:175]
v_add_f32 v127,v95,-s78
v_add_f32 v128,v120,v122
v_add_f32 v129,v121,v123
v_mfma_f32_16x16x32_bf16 v[176:179],v[52:55],a[240:243],v[176:179]
v_mul_f32 v130,v120,v120
v_mul_f32 v131,v121,v121
v_add_f32 v132,v124,v126
v_mfma_f32_16x16x32_bf16 v[180:183],v[52:55],a[244:247],v[180:183]
v_add_f32 v133,v125,v127
v_fma_f32 v130,v122,v122,v130
v_fma_f32 v131,v123,v123,v131
v_mfma_f32_16x16x32_bf16 v[184:187],v[52:55],a[248:251],v[184:187]
v_add_f32 v128,v128,v132
v_add_f32 v129,v129,v133
v_fma_f32 v130,v124,v124,v130
v_mfma_f32_16x16x32_bf16 v[188:191],v[52:55],a[252:255],v[188:191]
s_add_u32 m0,s57,24576
v_fma_f32 v131,v125,v125,v131
v_add_f32 v128,v128,v129
v_fma_f32 v130,v126,v126,v130
v_mfma_f32_16x16x32_bf16 v[192:195],v[56:59],a[0:3],0
buffer_load_dwordx4 v0,s[8:11],s65 offen offset:0 sc1 lds
v_fma_f32 v131,v127,v127,v131
v_mfma_f32_16x16x32_bf16 v[196:199],v[56:59],a[4:7],0
v_add_f32 v130,v130,v131
v_mfma_f32_16x16x32_bf16 v[200:203],v[56:59],a[8:11],0
s_nop 0
v_permlane32_swap_b32 v128,v130
v_add_f32 v128,v128,v130
v_cvt_pk_bf16_f32 v24,v160,v164
v_mfma_f32_16x16x32_bf16 v[204:207],v[56:59],a[12:15],0
v_add_f32_dpp v128,v128,v128 row_ror:8 row_mask:0xf bank_mask:0xf
v_cvt_pk_bf16_f32 v25,v168,v172
v_cvt_pk_bf16_f32 v26,v176,v180
v_mfma_f32_16x16x32_bf16 v[208:211],v[56:59],a[16:19],0
v_add_f32_dpp v128,v128,v128 row_ror:4 row_mask:0xf bank_mask:0xf
v_cvt_pk_bf16_f32 v27,v184,v188
v_cvt_pk_bf16_f32 v28,v161,v165
v_mfma_f32_16x16x32_bf16 v[212:215],v[56:59],a[20:23],0
buffer_load_dwordx4 v0,s[8:11],s65 offen offset:1024 sc1 lds
v_add_f32_dpp v128,v128,v128 row_ror:2 row_mask:0xf bank_mask:0xf
v_mfma_f32_16x16x32_bf16 v[216:219],v[56:59],a[24:27],0
s_nop 0
v_add_f32_dpp v128,v128,v128 row_ror:1 row_mask:0xf bank_mask:0xf
v_mov_b32 v130,v128
v_cvt_pk_bf16_f32 v29,v169,v173
v_mfma_f32_16x16x32_bf16 v[220:223],v[56:59],a[28:31],0
v_permlane16_swap_b32 v128,v130
v_add_f32 v128,v128,v130
v_mul_f32 v128,0x3b000000,v128
v_mfma_f32_16x16x32_bf16 v[192:195],v[60:63],a[32:35],v[192:195]
v_mov_b32 v130,v128
v_cvt_pk_bf16_f32 v30,v177,v181
v_cvt_pk_bf16_f32 v31,v185,v189
v_mfma_f32_16x16x32_bf16 v[196:199],v[60:63],a[36:39],v[196:199]
v_permlane32_swap_b32 v128,v130
v_fma_f32 v130,-v128,v128,v130
v_add_f32 v128,s78,v128
v_mfma_f32_16x16x32_bf16 v[200:203],v[60:63],a[40:43],v[200:203]
v_max_f32 v130,0,v130
v_cvt_pk_bf16_f32 v130,v128,v130
v_lshlrev_b32 v128,16,v130
v_mfma_f32_16x16x32_bf16 v[204:207],v[60:63],a[44:47],v[204:207]
v_and_b32 v130,0xffff0000,v130
v_add_f32 v130,0x3727c5ac,v130
v_cvt_pk_bf16_f32 v130,v130,v130
v_mfma_f32_16x16x32_bf16 v[208:211],v[60:63],a[48:51],v[208:211]
v_and_b32 v130,0xffff0000,v130
v_sqrt_f32 v130,v130
v_add_f32 v120,v88,-v128
v_mfma_f32_16x16x32_bf16 v[212:215],v[60:63],a[52:55],v[212:215]
v_add_f32 v121,v89,-v128
v_add_f32 v122,v90,-v128
v_add_f32 v123,v91,-v128
v_mfma_f32_16x16x32_bf16 v[216:219],v[60:63],a[56:59],v[216:219]
v_add_f32 v124,v92,-v128
v_add_f32 v125,v93,-v128
v_add_f32 v126,v94,-v128
v_mfma_f32_16x16x32_bf16 v[220:223],v[60:63],a[60:63],v[220:223]
v_add_f32 v127,v95,-v128
v_cvt_pk_bf16_f32 v130,v130,v130
v_and_b32 v130,0xffff0000,v130
v_mfma_f32_16x16x32_bf16 v[192:195],v[64:67],a[64:67],v[192:195]
v_rcp_f32 v130,v130
v_cvt_pk_bf16_f32 v108,v120,v121
v_cvt_pk_bf16_f32 v109,v122,v123
v_mfma_f32_16x16x32_bf16 v[196:199],v[64:67],a[68:71],v[196:199]
v_cvt_pk_bf16_f32 v110,v124,v125
v_cvt_pk_bf16_f32 v111,v126,v127
v_lshlrev_b32 v120,16,v108
v_mfma_f32_16x16x32_bf16 v[200:203],v[64:67],a[72:75],v[200:203]
v_and_b32 v121,0xffff0000,v108
v_lshlrev_b32 v122,16,v109
v_and_b32 v123,0xffff0000,v109
v_mfma_f32_16x16x32_bf16 v[204:207],v[64:67],a[76:79],v[204:207]
v_lshlrev_b32 v124,16,v110
v_and_b32 v125,0xffff0000,v110
v_lshlrev_b32 v126,16,v111
v_mfma_f32_16x16x32_bf16 v[208:211],v[64:67],a[80:83],v[208:211]
v_cvt_pk_bf16_f32 v32,v162,v166
v_cvt_pk_bf16_f32 v33,v170,v174
v_cvt_pk_bf16_f32 v34,v178,v182
v_mfma_f32_16x16x32_bf16 v[212:215],v[64:67],a[84:87],v[212:215]
v_cvt_pk_bf16_f32 v35,v186,v190
v_cvt_pk_bf16_f32 v36,v163,v167
v_cvt_pk_bf16_f32 v37,v171,v175
v_mfma_f32_16x16x32_bf16 v[216:219],v[64:67],a[88:91],v[216:219]
v_cvt_pk_bf16_f32 v38,v179,v183
v_cvt_pk_bf16_f32 v39,v187,v191
v_and_b32 v127,0xffff0000,v111
v_mfma_f32_16x16x32_bf16 v[220:223],v[64:67],a[92:95],v[220:223]
v_mul_f32 v120,v120,v130
v_mul_f32 v121,v121,v130
v_mul_f32 v122,v122,v130
v_mfma_f32_16x16x32_bf16 v[192:195],v[68:71],a[96:99],v[192:195]
v_mul_f32 v123,v123,v130
v_mul_f32 v124,v124,v130
v_mul_f32 v125,v125,v130
v_mfma_f32_16x16x32_bf16 v[196:199],v[68:71],a[100:103],v[196:199]
v_mul_f32 v126,v126,v130
v_mul_f32 v127,v127,v130
v_cvt_pk_bf16_f32 v108,v120,v121
v_mfma_f32_16x16x32_bf16 v[200:203],v[68:71],a[104:107],v[200:203]
v_cvt_pk_bf16_f32 v109,v122,v123
v_cvt_pk_bf16_f32 v110,v124,v125
v_cvt_pk_bf16_f32 v111,v126,v127
v_mfma_f32_16x16x32_bf16 v[204:207],v[68:71],a[108:111],v[204:207]
v_lshlrev_b32 v112,16,v108
v_and_b32 v113,0xffff0000,v108
v_lshlrev_b32 v114,16,v109
v_mfma_f32_16x16x32_bf16 v[208:211],v[68:71],a[112:115],v[208:211]
s_add_u32 s62,s69,0
v_and_b32 v115,0xffff0000,v109
v_lshlrev_b32 v116,16,v110
v_and_b32 v117,0xffff0000,v110
v_mfma_f32_16x16x32_bf16 v[212:215],v[68:71],a[116:119],v[212:215]
buffer_store_dwordx4 v[24:27],v5,s[8:11],s62 offen sc1
v_lshlrev_b32 v118,16,v111
v_mfma_f32_16x16x32_bf16 v[216:219],v[68:71],a[120:123],v[216:219]
v_and_b32 v119,0xffff0000,v111
v_add_f32 v88,v88,v112
v_add_f32 v89,v89,v113
v_mfma_f32_16x16x32_bf16 v[220:223],v[68:71],a[124:127],v[220:223]
v_add_f32 v90,v90,v114
v_add_f32 v91,v91,v115
v_add_f32 v92,v92,v116
v_mfma_f32_16x16x32_bf16 v[192:195],v[72:75],a[128:131],v[192:195]
v_add_f32 v93,v93,v117
v_add_f32 v94,v94,v118
v_add_f32 v95,v95,v119
v_mfma_f32_16x16x32_bf16 v[196:199],v[72:75],a[132:135],v[196:199]
s_add_u32 s62,s69,16384
v_cvt_pk_bf16_f32 v96,v88,v89
v_cvt_pk_bf16_f32 v97,v90,v91
v_cvt_pk_bf16_f32 v98,v92,v93
v_mfma_f32_16x16x32_bf16 v[200:203],v[72:75],a[136:139],v[200:203]
buffer_store_dwordx4 v[28:31],v5,s[8:11],s62 offen sc1
v_cvt_pk_bf16_f32 v99,v94,v95
v_mfma_f32_16x16x32_bf16 v[204:207],v[72:75],a[140:143],v[204:207]
buffer_store_dwordx4 v[96:99],v0,s[12:15],s19 offen sc1
v_mul_f32 v236,v112,v228
v_mfma_f32_16x16x32_bf16 v[208:211],v[72:75],a[144:147],v[208:211]
v_mul_f32 v237,v113,v229
v_fma_f32 v236,v114,v230,v236
v_fma_f32 v237,v115,v231,v237
v_mfma_f32_16x16x32_bf16 v[212:215],v[72:75],a[148:151],v[212:215]
v_fma_f32 v236,v116,v232,v236
v_fma_f32 v237,v117,v233,v237
v_fma_f32 v236,v118,v234,v236
v_mfma_f32_16x16x32_bf16 v[216:219],v[72:75],a[152:155],v[216:219]
s_add_u32 s62,s69,32768
v_fma_f32 v237,v119,v235,v237
v_add_f32 v236,v236,v237
v_mfma_f32_16x16x32_bf16 v[220:223],v[72:75],a[156:159],v[220:223]
buffer_store_dwordx4 v[32:35],v5,s[8:11],s62 offen sc1
v_add_f32_dpp v236,v236,v236 row_ror:8 row_mask:0xf bank_mask:0xf
v_mfma_f32_16x16x32_bf16 v[192:195],v[76:79],a[160:163],v[192:195]
s_nop 0
v_add_f32_dpp v236,v236,v236 row_ror:4 row_mask:0xf bank_mask:0xf
v_mfma_f32_16x16x32_bf16 v[196:199],v[76:79],a[164:167],v[196:199]
s_nop 0
v_add_f32_dpp v236,v236,v236 row_ror:2 row_mask:0xf bank_mask:0xf
v_mfma_f32_16x16x32_bf16 v[200:203],v[76:79],a[168:171],v[200:203]
s_nop 0
v_add_f32_dpp v236,v236,v236 row_ror:1 row_mask:0xf bank_mask:0xf
v_mov_b32 v237,v236
v_mfma_f32_16x16x32_bf16 v[204:207],v[76:79],a[172:175],v[204:207]
s_add_u32 s62,s69,49152
v_permlane16_swap_b32 v236,v237
v_add_f32 v236,v236,v237
v_mov_b32 v237,v236
v_mfma_f32_16x16x32_bf16 v[208:211],v[76:79],a[176:179],v[208:211]
buffer_store_dwordx4 v[36:39],v5,s[8:11],s62 offen sc1
v_permlane32_swap_b32 v236,v237
v_mfma_f32_16x16x32_bf16 v[212:215],v[76:79],a[180:183],v[212:215]
v_add_f32 v236,v236,v237
v_cvt_pk_bf16_f32 v236,v236,v236
v_and_b32 v236,0xffff0000,v236
v_mfma_f32_16x16x32_bf16 v[216:219],v[76:79],a[184:187],v[216:219]
v_ashrrev_i32 v237,31,v236
v_or_b32 v237,0x80000000,v237
v_xor_b32 v236,v236,v237
v_mfma_f32_16x16x32_bf16 v[220:223],v[76:79],a[188:191],v[220:223]
v_and_b32 v236,0xffff0000,v236
s_sub_u32 s20,4095,s18
v_or_b32 v20,s20,v236
v_mfma_f32_16x16x32_bf16 v[192:195],v[80:83],a[192:195],v[192:195]
s_lshl_b32 s73,s26,13
s_lshl2_add_u32 s73,s68,s73
s_add_u32 s73,s73,10485760
s_add_u32 s73,s73,s86
v_mfma_f32_16x16x32_bf16 v[196:199],v[80:83],a[196:199],v[196:199]
v_mfma_f32_16x16x32_bf16 v[192:195],v[84:87],a[224:227],v[192:195]
v_mfma_f32_16x16x32_bf16 v[196:199],v[84:87],a[228:231],v[196:199]
v_mfma_f32_16x16x32_bf16 v[200:203],v[80:83],a[200:203],v[200:203]
v_mfma_f32_16x16x32_bf16 v[204:207],v[80:83],a[204:207],v[204:207]
v_mfma_f32_16x16x32_bf16 v[200:203],v[84:87],a[232:235],v[200:203]
v_mfma_f32_16x16x32_bf16 v[204:207],v[84:87],a[236:239],v[204:207]
v_cvt_pk_bf16_f32 v40,v192,v196
v_cvt_pk_bf16_f32 v44,v193,v197
v_cvt_pk_bf16_f32 v48,v194,v198
v_mfma_f32_16x16x32_bf16 v[208:211],v[80:83],a[208:211],v[208:211]
v_cvt_pk_bf16_f32 v52,v195,v199
v_mfma_f32_16x16x32_bf16 v[212:215],v[80:83],a[212:215],v[212:215]
v_cvt_pk_bf16_f32 v41,v200,v204
v_cvt_pk_bf16_f32 v45,v201,v205
v_cvt_pk_bf16_f32 v49,v202,v206
v_mfma_f32_16x16x32_bf16 v[208:211],v[84:87],a[240:243],v[208:211]
v_cvt_pk_bf16_f32 v53,v203,v207
v_mfma_f32_16x16x32_bf16 v[212:215],v[84:87],a[244:247],v[212:215]
v_mfma_f32_16x16x32_bf16 v[216:219],v[80:83],a[216:219],v[216:219]
v_mfma_f32_16x16x32_bf16 v[220:223],v[80:83],a[220:223],v[220:223]
v_mfma_f32_16x16x32_bf16 v[216:219],v[84:87],a[248:251],v[216:219]
v_mfma_f32_16x16x32_bf16 v[220:223],v[84:87],a[252:255],v[220:223]
v_cvt_pk_bf16_f32 v42,v208,v212
v_cvt_pk_bf16_f32 v46,v209,v213
v_cvt_pk_bf16_f32 v50,v210,v214
v_cvt_pk_bf16_f32 v54,v211,v215
s_nop 3
v_cvt_pk_bf16_f32 v43,v216,v220
s_add_u32 s62,s69,262144
buffer_store_dwordx4 v[40:43],v5,s[8:11],s62 offen sc1
v_cvt_pk_bf16_f32 v47,v217,v221
s_add_u32 s62,s69,278528
buffer_store_dwordx4 v[44:47],v5,s[8:11],s62 offen sc1
v_cvt_pk_bf16_f32 v51,v218,v222
s_add_u32 s62,s69,294912
buffer_store_dwordx4 v[48:51],v5,s[8:11],s62 offen sc1
v_cvt_pk_bf16_f32 v55,v219,v223
s_add_u32 s62,s69,311296
buffer_store_dwordx4 v[52:55],v5,s[8:11],s62 offen sc1
s_cmp_lg_u32 s72,0
s_cbranch_scc1 L_aa_322
s_waitcnt vmcnt(9)
s_branch L_aa_332
L_av_334:
ds_read_b128 v[24:27],v4 offset:0
ds_read_b128 v[28:31],v4 offset:1024
s_min_u32 s56,s32,s33
s_cmp_lt_u32 s77,64
s_cselect_b32 s56,s56,0
s_cmp_eq_u32 s56,0
s_cselect_b32 s72,0x80000000,0
v_mov_b32 v248,s72
s_or_b32 s64,s70,s72
s_or_b32 s65,s71,s72
s_cmp_lt_u32 s30,s31
s_cselect_b32 s65,0x80000000,s65
s_add_u32 s64,s64,s28
s_add_u32 s65,s65,s29
s_xor_b32 s58,s67,s40
s_xor_b32 s57,s67,s41
s_add_u32 m0,s58,0
s_waitcnt lgkmcnt(1)
v_mfma_f32_16x16x32_bf16 v[160:163],v[24:27],a[0:3],0
buffer_load_dwordx4 v0,s[8:11],s64 offen offset:0 sc1 lds
v_mfma_f32_16x16x32_bf16 v[164:167],v[24:27],a[4:7],0
ds_read_b128 v[32:35],v4 offset:2048
s_lshl_b32 s23,s51,5
v_mfma_f32_16x16x32_bf16 v[168:171],v[24:27],a[8:11],0
ds_read_b128 v[36:39],v4 offset:3072
s_add_u32 s23,s23,s68
v_mfma_f32_16x16x32_bf16 v[172:175],v[24:27],a[12:15],0
ds_read_b128 v[40:43],v4 offset:8192
s_lshl_b32 s24,s23,10
v_mfma_f32_16x16x32_bf16 v[176:179],v[24:27],a[16:19],0
ds_read_b128 v[44:47],v4 offset:9216
s_lshl_b32 s25,s51,10
v_mfma_f32_16x16x32_bf16 v[180:183],v[24:27],a[20:23],0
buffer_load_dwordx4 v0,s[8:11],s64 offen offset:1024 sc1 lds
v_mfma_f32_16x16x32_bf16 v[184:187],v[24:27],a[24:27],0
ds_read_b128 v[48:51],v4 offset:10240
s_waitcnt vmcnt(9)
v_mfma_f32_16x16x32_bf16 v[188:191],v[24:27],a[28:31],0
ds_read_b128 v[52:55],v4 offset:11264
v_mfma_f32_16x16x32_bf16 v[128:131],v[156:159],v[192:195],0
ds_write_b32 v247,v248
s_add_u32 s25,s25,2883584
s_waitcnt lgkmcnt(7)
v_mfma_f32_16x16x32_bf16 v[160:163],v[28:31],a[32:35],v[160:163]
ds_read_b128 v[56:59],v4 offset:4096
s_waitcnt vmcnt(8)
v_mfma_f32_16x16x32_bf16 v[164:167],v[28:31],a[36:39],v[164:167]
ds_read_b128 v[60:63],v4 offset:5120
v_mfma_f32_16x16x32_bf16 v[128:131],v[156:159],v[196:199],v[128:131]
ds_read_b128 v[64:67],v4 offset:6144
s_cmp_eq_u32 s23,s55
s_cselect_b32 s25,s25,s24
v_mfma_f32_16x16x32_bf16 v[168:171],v[28:31],a[40:43],v[168:171]
buffer_load_dwordx4 v0,s[8:11],s64 offen offset:2048 sc1 lds
v_mfma_f32_16x16x32_bf16 v[172:175],v[28:31],a[44:47],v[172:175]
ds_read_b128 v[68:71],v4 offset:7168
s_waitcnt vmcnt(8)
v_mfma_f32_16x16x32_bf16 v[176:179],v[28:31],a[48:51],v[176:179]
ds_read_b128 v[72:75],v4 offset:12288
v_mfma_f32_16x16x32_bf16 v[128:131],v[156:159],v[200:203],v[128:131]
ds_read_b128 v[76:79],v4 offset:13312
s_add_u32 s25,s25,8388608
v_mfma_f32_16x16x32_bf16 v[180:183],v[28:31],a[52:55],v[180:183]
ds_read_b128 v[80:83],v4 offset:14336
s_waitcnt vmcnt(7)
v_mfma_f32_16x16x32_bf16 v[184:187],v[28:31],a[56:59],v[184:187]
ds_read_b128 v[84:87],v4 offset:15360
v_mfma_f32_16x16x32_bf16 v[128:131],v[156:159],v[204:207],v[128:131]
s_mov_b32 s6,268435456
s_cmp_eq_u32 s31,0
s_cselect_b32 s25,s24,s25
s_cselect_b64 s[4:5],s[16:17],s[44:45]
s_cmov_b32 s6,2097152
v_mfma_f32_16x16x32_bf16 v[188:191],v[28:31],a[60:63],v[188:191]
buffer_load_dwordx4 v0,s[8:11],s64 offen offset:3072 sc1 lds
s_waitcnt lgkmcnt(14)
v_mfma_f32_16x16x32_bf16 v[160:163],v[32:35],a[64:67],v[160:163]
buffer_load_dwordx4 v[224:227],v0,s[4:7],s25 offen sc1
v_mfma_f32_16x16x32_bf16 v[164:167],v[32:35],a[68:71],v[164:167]
s_waitcnt vmcnt(8)
v_mfma_f32_16x16x32_bf16 v[132:135],v[156:159],v[208:211],0
s_lshr_b32 s24,s55,5
s_cmp_lt_u32 s51,s24
s_cselect_b32 s24,1,2
v_mfma_f32_16x16x32_bf16 v[168:171],v[32:35],a[72:75],v[168:171]
s_waitcnt vmcnt(7)
v_mfma_f32_16x16x32_bf16 v[132:135],v[156:159],v[212:215],v[132:135]
v_mov_b32 v252,s24
s_lshl2_add_u32 s25,s51,11018240
v_mfma_f32_16x16x32_bf16 v[172:175],v[32:35],a[76:79],v[172:175]
s_waitcnt vmcnt(6)
v_mfma_f32_16x16x32_bf16 v[132:135],v[156:159],v[216:219],v[132:135]
s_lshl_b32 s24,s68,16
s_add_u32 s24,s24,s31
s_add_u32 s24,s24,s86
v_mfma_f32_16x16x32_bf16 v[176:179],v[32:35],a[80:83],v[176:179]
ds_write_b128 v6,v[128:131]
v_mfma_f32_16x16x32_bf16 v[180:183],v[32:35],a[84:87],v[180:183]
s_waitcnt vmcnt(5)
v_mfma_f32_16x16x32_bf16 v[132:135],v[156:159],v[220:223],v[132:135]
s_add_u32 m0,s58,4096
s_add_u32 s64,s64,4096
s_cmp_eq_u32 s24,1537
s_cselect_b32 s25,s25,0x80000000
v_mfma_f32_16x16x32_bf16 v[184:187],v[32:35],a[88:91],v[184:187]
buffer_load_dwordx4 v0,s[8:11],s64 offen offset:0 sc1 lds
v_mfma_f32_16x16x32_bf16 v[188:191],v[32:35],a[92:95],v[188:191]
buffer_store_dword v252,off,s[8:11],s25 sc1
s_waitcnt lgkmcnt(14)
v_mfma_f32_16x16x32_bf16 v[160:163],v[36:39],a[96:99],v[160:163]
ds_write_b128 v6,v[132:135] offset:2048
v_mfma_f32_16x16x32_bf16 v[164:167],v[36:39],a[100:103],v[164:167]
s_bitcmp1_b64 s[38:39],s51
s_cselect_b32 s24,128,0
s_lshl_b32 s23,s51,13
v_mfma_f32_16x16x32_bf16 v[168:171],v[36:39],a[104:107],v[168:171]
s_lshl2_add_u32 s23,s68,s23
s_add_u32 s23,s23,10487168
s_add_u32 s23,s23,s24
v_mfma_f32_16x16x32_bf16 v[172:175],v[36:39],a[108:111],v[172:175]
buffer_load_dwordx4 v0,s[8:11],s64 offen offset:1024 sc1 lds
v_mfma_f32_16x16x32_bf16 v[176:179],v[36:39],a[112:115],v[176:179]
buffer_load_dword v246,off,s[8:11],s23 sc1
v_mfma_f32_16x16x32_bf16 v[180:183],v[36:39],a[116:119],v[180:183]
s_waitcnt lgkmcnt(0)
s_barrier
v_lshrrev_b32 v244,4,v1
v_mfma_f32_16x16x32_bf16 v[184:187],v[36:39],a[120:123],v[184:187]
ds_read_b128 v[248:251],v245
s_sub_u32 s23,s77,7
v_mfma_f32_16x16x32_bf16 v[188:191],v[36:39],a[124:127],v[188:191]
buffer_store_dword v20,off,s[8:11],s73 sc1
v_mfma_f32_16x16x32_bf16 v[160:163],v[40:43],a[128:131],v[160:163]
buffer_load_dwordx4 v0,s[8:11],s64 offen offset:2048 sc1 lds
v_mfma_f32_16x16x32_bf16 v[164:167],v[40:43],a[132:135],v[164:167]
s_mov_b32 s73,0x80000000
v_add_u32 v244,s23,v244
v_max_i32 v244,0,v244
v_mfma_f32_16x16x32_bf16 v[168:171],v[40:43],a[136:139],v[168:171]
v_lshl_add_u32 v244,v244,13,v21
v_mfma_f32_16x16x32_bf16 v[172:175],v[40:43],a[140:143],v[172:175]
buffer_load_dwordx2 v[242:243],v244,s[8:11],0 offen sc1
v_mfma_f32_16x16x32_bf16 v[176:179],v[40:43],a[144:147],v[176:179]
s_waitcnt lgkmcnt(0)
v_or3_b32 v248,v248,v249,v250
v_or_b32 v248,v248,v251
v_mfma_f32_16x16x32_bf16 v[180:183],v[40:43],a[148:151],v[180:183]
buffer_load_dwordx4 v0,s[8:11],s64 offen offset:3072 sc1 lds
v_mfma_f32_16x16x32_bf16 v[184:187],v[40:43],a[152:155],v[184:187]
v_mfma_f32_16x16x32_bf16 v[188:191],v[40:43],a[156:159],v[188:191]
v_readfirstlane_b32 s72,v248
v_mfma_f32_16x16x32_bf16 v[160:163],v[44:47],a[160:163],v[160:163]
v_mfma_f32_16x16x32_bf16 v[164:167],v[44:47],a[164:167],v[164:167]
v_mfma_f32_16x16x32_bf16 v[168:171],v[44:47],a[168:171],v[168:171]
s_add_u32 m0,s58,8192
s_add_u32 s64,s64,4096
v_mfma_f32_16x16x32_bf16 v[172:175],v[44:47],a[172:175],v[172:175]
buffer_load_dwordx4 v0,s[8:11],s64 offen offset:0 sc1 lds
v_mfma_f32_16x16x32_bf16 v[176:179],v[44:47],a[176:179],v[176:179]
v_mfma_f32_16x16x32_bf16 v[180:183],v[44:47],a[180:183],v[180:183]
v_mfma_f32_16x16x32_bf16 v[184:187],v[44:47],a[184:187],v[184:187]
v_mfma_f32_16x16x32_bf16 v[188:191],v[44:47],a[188:191],v[188:191]
v_mfma_f32_16x16x32_bf16 v[160:163],v[48:51],a[192:195],v[160:163]
buffer_load_dwordx4 v0,s[8:11],s64 offen offset:1024 sc1 lds
v_mfma_f32_16x16x32_bf16 v[164:167],v[48:51],a[196:199],v[164:167]
v_mfma_f32_16x16x32_bf16 v[168:171],v[48:51],a[200:203],v[168:171]
v_mfma_f32_16x16x32_bf16 v[172:175],v[48:51],a[204:207],v[172:175]
v_mfma_f32_16x16x32_bf16 v[176:179],v[48:51],a[208:211],v[176:179]
v_mfma_f32_16x16x32_bf16 v[180:183],v[48:51],a[212:215],v[180:183]
buffer_load_dwordx4 v0,s[8:11],s64 offen offset:2048 sc1 lds
v_mfma_f32_16x16x32_bf16 v[184:187],v[48:51],a[216:219],v[184:187]
v_mfma_f32_16x16x32_bf16 v[188:191],v[48:51],a[220:223],v[188:191]
v_mfma_f32_16x16x32_bf16 v[160:163],v[52:55],a[224:227],v[160:163]
v_mfma_f32_16x16x32_bf16 v[164:167],v[52:55],a[228:231],v[164:167]
v_mfma_f32_16x16x32_bf16 v[168:171],v[52:55],a[232:235],v[168:171]
buffer_load_dwordx4 v0,s[8:11],s64 offen offset:3072 sc1 lds
v_mfma_f32_16x16x32_bf16 v[172:175],v[52:55],a[236:239],v[172:175]
v_mfma_f32_16x16x32_bf16 v[176:179],v[52:55],a[240:243],v[176:179]
v_mfma_f32_16x16x32_bf16 v[180:183],v[52:55],a[244:247],v[180:183]
v_mfma_f32_16x16x32_bf16 v[184:187],v[52:55],a[248:251],v[184:187]
v_mfma_f32_16x16x32_bf16 v[188:191],v[52:55],a[252:255],v[188:191]
s_add_u32 m0,s57,24576
v_mfma_f32_16x16x32_bf16 v[192:195],v[56:59],a[0:3],0
buffer_load_dwordx4 v0,s[8:11],s65 offen offset:0 sc1 lds
v_mfma_f32_16x16x32_bf16 v[196:199],v[56:59],a[4:7],0
v_mfma_f32_16x16x32_bf16 v[200:203],v[56:59],a[8:11],0
v_cvt_pk_bf16_f32 v24,v160,v164
v_cvt_pk_bf16_f32 v25,v168,v172
v_mfma_f32_16x16x32_bf16 v[204:207],v[56:59],a[12:15],0
v_cvt_pk_bf16_f32 v26,v176,v180
v_cvt_pk_bf16_f32 v27,v184,v188
v_mfma_f32_16x16x32_bf16 v[208:211],v[56:59],a[16:19],0
v_cvt_pk_bf16_f32 v28,v161,v165
v_cvt_pk_bf16_f32 v29,v169,v173
v_mfma_f32_16x16x32_bf16 v[212:215],v[56:59],a[20:23],0
buffer_load_dwordx4 v0,s[8:11],s65 offen offset:1024 sc1 lds
v_mfma_f32_16x16x32_bf16 v[216:219],v[56:59],a[24:27],0
v_cvt_pk_bf16_f32 v30,v177,v181
v_cvt_pk_bf16_f32 v31,v185,v189
v_mfma_f32_16x16x32_bf16 v[220:223],v[56:59],a[28:31],0
v_cvt_pk_bf16_f32 v32,v162,v166
v_cvt_pk_bf16_f32 v33,v170,v174
v_mfma_f32_16x16x32_bf16 v[192:195],v[60:63],a[32:35],v[192:195]
v_cvt_pk_bf16_f32 v34,v178,v182
v_cvt_pk_bf16_f32 v35,v186,v190
v_mfma_f32_16x16x32_bf16 v[196:199],v[60:63],a[36:39],v[196:199]
v_cvt_pk_bf16_f32 v36,v163,v167
v_cvt_pk_bf16_f32 v37,v171,v175
v_mfma_f32_16x16x32_bf16 v[200:203],v[60:63],a[40:43],v[200:203]
v_cvt_pk_bf16_f32 v38,v179,v183
v_cvt_pk_bf16_f32 v39,v187,v191
v_mfma_f32_16x16x32_bf16 v[204:207],v[60:63],a[44:47],v[204:207]
v_mfma_f32_16x16x32_bf16 v[208:211],v[60:63],a[48:51],v[208:211]
v_mfma_f32_16x16x32_bf16 v[212:215],v[60:63],a[52:55],v[212:215]
v_mfma_f32_16x16x32_bf16 v[216:219],v[60:63],a[56:59],v[216:219]
v_mfma_f32_16x16x32_bf16 v[220:223],v[60:63],a[60:63],v[220:223]
v_mfma_f32_16x16x32_bf16 v[192:195],v[64:67],a[64:67],v[192:195]
v_mfma_f32_16x16x32_bf16 v[196:199],v[64:67],a[68:71],v[196:199]
v_mfma_f32_16x16x32_bf16 v[200:203],v[64:67],a[72:75],v[200:203]
v_mfma_f32_16x16x32_bf16 v[204:207],v[64:67],a[76:79],v[204:207]
v_mfma_f32_16x16x32_bf16 v[208:211],v[64:67],a[80:83],v[208:211]
v_mfma_f32_16x16x32_bf16 v[212:215],v[64:67],a[84:87],v[212:215]
v_mfma_f32_16x16x32_bf16 v[216:219],v[64:67],a[88:91],v[216:219]
v_mfma_f32_16x16x32_bf16 v[220:223],v[64:67],a[92:95],v[220:223]
v_mfma_f32_16x16x32_bf16 v[192:195],v[68:71],a[96:99],v[192:195]
v_mfma_f32_16x16x32_bf16 v[196:199],v[68:71],a[100:103],v[196:199]
v_mfma_f32_16x16x32_bf16 v[200:203],v[68:71],a[104:107],v[200:203]
v_mfma_f32_16x16x32_bf16 v[204:207],v[68:71],a[108:111],v[204:207]
v_mfma_f32_16x16x32_bf16 v[208:211],v[68:71],a[112:115],v[208:211]
s_add_u32 s62,s69,0
v_mfma_f32_16x16x32_bf16 v[212:215],v[68:71],a[116:119],v[212:215]
buffer_store_dwordx4 v[24:27],v5,s[8:11],s62 offen sc1
v_mfma_f32_16x16x32_bf16 v[216:219],v[68:71],a[120:123],v[216:219]
v_mfma_f32_16x16x32_bf16 v[220:223],v[68:71],a[124:127],v[220:223]
v_mfma_f32_16x16x32_bf16 v[192:195],v[72:75],a[128:131],v[192:195]
v_mfma_f32_16x16x32_bf16 v[196:199],v[72:75],a[132:135],v[196:199]
v_mfma_f32_16x16x32_bf16 v[200:203],v[72:75],a[136:139],v[200:203]
s_add_u32 s62,s69,16384
v_mfma_f32_16x16x32_bf16 v[204:207],v[72:75],a[140:143],v[204:207]
buffer_store_dwordx4 v[28:31],v5,s[8:11],s62 offen sc1
v_mfma_f32_16x16x32_bf16 v[208:211],v[72:75],a[144:147],v[208:211]
v_mfma_f32_16x16x32_bf16 v[212:215],v[72:75],a[148:151],v[212:215]
v_mfma_f32_16x16x32_bf16 v[216:219],v[72:75],a[152:155],v[216:219]
v_mfma_f32_16x16x32_bf16 v[220:223],v[72:75],a[156:159],v[220:223]
v_mfma_f32_16x16x32_bf16 v[192:195],v[76:79],a[160:163],v[192:195]
s_add_u32 s62,s69,32768
v_mfma_f32_16x16x32_bf16 v[196:199],v[76:79],a[164:167],v[196:199]
buffer_store_dwordx4 v[32:35],v5,s[8:11],s62 offen sc1
v_mfma_f32_16x16x32_bf16 v[200:203],v[76:79],a[168:171],v[200:203]
v_mfma_f32_16x16x32_bf16 v[204:207],v[76:79],a[172:175],v[204:207]
v_mfma_f32_16x16x32_bf16 v[208:211],v[76:79],a[176:179],v[208:211]
v_mfma_f32_16x16x32_bf16 v[212:215],v[76:79],a[180:183],v[212:215]
v_mfma_f32_16x16x32_bf16 v[216:219],v[76:79],a[184:187],v[216:219]
s_add_u32 s62,s69,49152
v_mfma_f32_16x16x32_bf16 v[220:223],v[76:79],a[188:191],v[220:223]
buffer_store_dwordx4 v[36:39],v5,s[8:11],s62 offen sc1
v_mfma_f32_16x16x32_bf16 v[192:195],v[80:83],a[192:195],v[192:195]
v_mfma_f32_16x16x32_bf16 v[196:199],v[80:83],a[196:199],v[196:199]
v_mfma_f32_16x16x32_bf16 v[192:195],v[84:87],a[224:227],v[192:195]
v_mfma_f32_16x16x32_bf16 v[196:199],v[84:87],a[228:231],v[196:199]
v_mfma_f32_16x16x32_bf16 v[200:203],v[80:83],a[200:203],v[200:203]
v_mfma_f32_16x16x32_bf16 v[204:207],v[80:83],a[204:207],v[204:207]
v_mfma_f32_16x16x32_bf16 v[200:203],v[84:87],a[232:235],v[200:203]
v_mfma_f32_16x16x32_bf16 v[204:207],v[84:87],a[236:239],v[204:207]
v_cvt_pk_bf16_f32 v40,v192,v196
v_cvt_pk_bf16_f32 v44,v193,v197
v_cvt_pk_bf16_f32 v48,v194,v198
v_mfma_f32_16x16x32_bf16 v[208:211],v[80:83],a[208:211],v[208:211]
v_cvt_pk_bf16_f32 v52,v195,v199
v_mfma_f32_16x16x32_bf16 v[212:215],v[80:83],a[212:215],v[212:215]
v_cvt_pk_bf16_f32 v41,v200,v204
v_cvt_pk_bf16_f32 v45,v201,v205
v_cvt_pk_bf16_f32 v49,v202,v206
v_mfma_f32_16x16x32_bf16 v[208:211],v[84:87],a[240:243],v[208:211]
v_cvt_pk_bf16_f32 v53,v203,v207
v_mfma_f32_16x16x32_bf16 v[212:215],v[84:87],a[244:247],v[212:215]
v_mfma_f32_16x16x32_bf16 v[216:219],v[80:83],a[216:219],v[216:219]
v_mfma_f32_16x16x32_bf16 v[220:223],v[80:83],a[220:223],v[220:223]
v_mfma_f32_16x16x32_bf16 v[216:219],v[84:87],a[248:251],v[216:219]
v_mfma_f32_16x16x32_bf16 v[220:223],v[84:87],a[252:255],v[220:223]
v_cvt_pk_bf16_f32 v42,v208,v212
v_cvt_pk_bf16_f32 v46,v209,v213
v_cvt_pk_bf16_f32 v50,v210,v214
v_cvt_pk_bf16_f32 v54,v211,v215
s_nop 3
v_cvt_pk_bf16_f32 v43,v216,v220
s_add_u32 s62,s69,262144
buffer_store_dwordx4 v[40:43],v5,s[8:11],s62 offen sc1
v_cvt_pk_bf16_f32 v47,v217,v221
s_add_u32 s62,s69,278528
buffer_store_dwordx4 v[44:47],v5,s[8:11],s62 offen sc1
v_cvt_pk_bf16_f32 v51,v218,v222
s_add_u32 s62,s69,294912
buffer_store_dwordx4 v[48:51],v5,s[8:11],s62 offen sc1
v_cvt_pk_bf16_f32 v55,v219,v223
s_add_u32 s62,s69,311296
buffer_store_dwordx4 v[52:55],v5,s[8:11],s62 offen sc1
s_cmp_lg_u32 s72,0
s_cbranch_scc1 L_aa_322
s_waitcnt vmcnt(8)
s_branch L_aa_332
L_aa_320:
ds_read_b128 v[24:27],v4 offset:0
ds_read_b128 v[28:31],v4 offset:1024
s_min_u32 s56,s32,s33
s_cmp_lt_u32 s77,64
s_cselect_b32 s56,s56,0
s_cmp_eq_u32 s56,0
s_cselect_b32 s72,0x80000000,0
v_mov_b32 v248,s72
s_or_b32 s64,s70,s72
s_or_b32 s65,s71,s72
s_cmp_lt_u32 s30,s31
s_cselect_b32 s65,0x80000000,s65
s_add_u32 s64,s64,s28
s_add_u32 s65,s65,s29
s_xor_b32 s58,s67,s40
s_xor_b32 s57,s67,s41
s_add_u32 m0,s58,0
s_waitcnt lgkmcnt(1)
v_mfma_f32_16x16x32_bf16 v[160:163],v[24:27],a[0:3],0
buffer_load_dwordx4 v0,s[8:11],s64 offen offset:0 sc1 lds
v_mfma_f32_16x16x32_bf16 v[164:167],v[24:27],a[4:7],0
ds_read_b128 v[32:35],v4 offset:2048
s_lshl_b32 s23,s51,5
v_mfma_f32_16x16x32_bf16 v[168:171],v[24:27],a[8:11],0
ds_read_b128 v[36:39],v4 offset:3072
s_add_u32 s23,s23,s68
v_mfma_f32_16x16x32_bf16 v[172:175],v[24:27],a[12:15],0
ds_read_b128 v[40:43],v4 offset:8192
s_lshl_b32 s24,s23,10
v_mfma_f32_16x16x32_bf16 v[176:179],v[24:27],a[16:19],0
ds_read_b128 v[44:47],v4 offset:9216
s_lshl_b32 s25,s51,10
v_mfma_f32_16x16x32_bf16 v[180:183],v[24:27],a[20:23],0
buffer_load_dwordx4 v0,s[8:11],s64 offen offset:1024 sc1 lds
v_mfma_f32_16x16x32_bf16 v[184:187],v[24:27],a[24:27],0
ds_read_b128 v[48:51],v4 offset:10240
s_add_u32 s25,s25,2883584
v_mfma_f32_16x16x32_bf16 v[188:191],v[24:27],a[28:31],0
ds_read_b128 v[52:55],v4 offset:11264
s_cmp_eq_u32 s23,s55
s_cselect_b32 s25,s25,s24
s_waitcnt lgkmcnt(6)
v_mfma_f32_16x16x32_bf16 v[160:163],v[28:31],a[32:35],v[160:163]
ds_write_b32 v247,v248
s_add_u32 s25,s25,8388608
v_mfma_f32_16x16x32_bf16 v[164:167],v[28:31],a[36:39],v[164:167]
ds_read_b128 v[56:59],v4 offset:4096
s_mov_b32 s6,268435456
v_mfma_f32_16x16x32_bf16 v[168:171],v[28:31],a[40:43],v[168:171]
buffer_load_dwordx4 v0,s[8:11],s64 offen offset:2048 sc1 lds
v_mfma_f32_16x16x32_bf16 v[172:175],v[28:31],a[44:47],v[172:175]
ds_read_b128 v[60:63],v4 offset:5120
s_cmp_eq_u32 s31,0
s_cselect_b32 s25,s24,s25
s_cselect_b64 s[4:5],s[16:17],s[44:45]
s_cmov_b32 s6,2097152
v_mfma_f32_16x16x32_bf16 v[176:179],v[28:31],a[48:51],v[176:179]
ds_read_b128 v[64:67],v4 offset:6144
v_mfma_f32_16x16x32_bf16 v[180:183],v[28:31],a[52:55],v[180:183]
ds_read_b128 v[68:71],v4 offset:7168
v_mfma_f32_16x16x32_bf16 v[184:187],v[28:31],a[56:59],v[184:187]
ds_read_b128 v[72:75],v4 offset:12288
v_mfma_f32_16x16x32_bf16 v[188:191],v[28:31],a[60:63],v[188:191]
buffer_load_dwordx4 v0,s[8:11],s64 offen offset:3072 sc1 lds
s_waitcnt lgkmcnt(11)
v_mfma_f32_16x16x32_bf16 v[160:163],v[32:35],a[64:67],v[160:163]
ds_read_b128 v[76:79],v4 offset:13312
v_mfma_f32_16x16x32_bf16 v[164:167],v[32:35],a[68:71],v[164:167]
ds_read_b128 v[80:83],v4 offset:14336
v_mfma_f32_16x16x32_bf16 v[168:171],v[32:35],a[72:75],v[168:171]
ds_read_b128 v[84:87],v4 offset:15360
v_mfma_f32_16x16x32_bf16 v[172:175],v[32:35],a[76:79],v[172:175]
buffer_load_dwordx4 v[224:227],v0,s[4:7],s25 offen sc1
v_mfma_f32_16x16x32_bf16 v[176:179],v[32:35],a[80:83],v[176:179]
s_add_u32 m0,s58,4096
s_add_u32 s64,s64,4096
s_lshr_b32 s24,s55,5
v_mfma_f32_16x16x32_bf16 v[180:183],v[32:35],a[84:87],v[180:183]
buffer_load_dwordx4 v0,s[8:11],s64 offen offset:0 sc1 lds
v_mfma_f32_16x16x32_bf16 v[184:187],v[32:35],a[88:91],v[184:187]
s_cmp_lt_u32 s51,s24
s_cselect_b32 s24,1,2
v_mov_b32 v252,s24
v_mfma_f32_16x16x32_bf16 v[188:191],v[32:35],a[92:95],v[188:191]
s_waitcnt lgkmcnt(0)
s_barrier
s_lshl2_add_u32 s25,s51,11018240
v_mfma_f32_16x16x32_bf16 v[160:163],v[36:39],a[96:99],v[160:163]
ds_read_b128 v[248:251],v245
s_lshl_b32 s24,s68,16
v_mfma_f32_16x16x32_bf16 v[164:167],v[36:39],a[100:103],v[164:167]
s_add_u32 s24,s24,s31
s_add_u32 s24,s24,s86
s_cmp_eq_u32 s24,1537
s_cselect_b32 s25,s25,0x80000000
v_mfma_f32_16x16x32_bf16 v[168:171],v[36:39],a[104:107],v[168:171]
buffer_load_dwordx4 v0,s[8:11],s64 offen offset:1024 sc1 lds
v_mfma_f32_16x16x32_bf16 v[172:175],v[36:39],a[108:111],v[172:175]
buffer_store_dword v252,off,s[8:11],s25 sc1
v_mfma_f32_16x16x32_bf16 v[176:179],v[36:39],a[112:115],v[176:179]
s_bitcmp1_b64 s[38:39],s51
s_cselect_b32 s24,128,0
s_lshl_b32 s23,s51,13
v_mfma_f32_16x16x32_bf16 v[180:183],v[36:39],a[116:119],v[180:183]
s_lshl2_add_u32 s23,s68,s23
s_add_u32 s23,s23,10487168
s_add_u32 s23,s23,s24
v_mfma_f32_16x16x32_bf16 v[184:187],v[36:39],a[120:123],v[184:187]
buffer_load_dword v246,off,s[8:11],s23 sc1
v_mfma_f32_16x16x32_bf16 v[188:191],v[36:39],a[124:127],v[188:191]
buffer_load_dwordx4 v0,s[8:11],s64 offen offset:2048 sc1 lds
v_mfma_f32_16x16x32_bf16 v[160:163],v[40:43],a[128:131],v[160:163]
s_waitcnt lgkmcnt(0)
v_or3_b32 v248,v248,v249,v250
v_or_b32 v248,v248,v251
v_mfma_f32_16x16x32_bf16 v[164:167],v[40:43],a[132:135],v[164:167]
v_lshrrev_b32 v244,4,v1
s_sub_u32 s23,s77,7
v_mfma_f32_16x16x32_bf16 v[168:171],v[40:43],a[136:139],v[168:171]
v_readfirstlane_b32 s72,v248
v_add_u32 v244,s23,v244
v_mfma_f32_16x16x32_bf16 v[172:175],v[40:43],a[140:143],v[172:175]
v_max_i32 v244,0,v244
v_lshl_add_u32 v244,v244,13,v21
v_mfma_f32_16x16x32_bf16 v[176:179],v[40:43],a[144:147],v[176:179]
buffer_load_dwordx4 v0,s[8:11],s64 offen offset:3072 sc1 lds
v_mfma_f32_16x16x32_bf16 v[180:183],v[40:43],a[148:151],v[180:183]
buffer_load_dwordx2 v[242:243],v244,s[8:11],0 offen sc1
v_mfma_f32_16x16x32_bf16 v[184:187],v[40:43],a[152:155],v[184:187]
s_waitcnt vmcnt(12)
v_mfma_f32_16x16x32_bf16 v[188:191],v[40:43],a[156:159],v[188:191]
buffer_store_dword v20,off,s[8:11],s73 sc1
v_mfma_f32_16x16x32_bf16 v[160:163],v[44:47],a[160:163],v[160:163]
s_mov_b32 s73,0x80000000
v_mfma_f32_16x16x32_bf16 v[164:167],v[44:47],a[164:167],v[164:167]
s_add_u32 m0,s58,8192
s_add_u32 s64,s64,4096
v_mfma_f32_16x16x32_bf16 v[168:171],v[44:47],a[168:171],v[168:171]
buffer_load_dwordx4 v0,s[8:11],s64 offen offset:0 sc1 lds
v_mfma_f32_16x16x32_bf16 v[172:175],v[44:47],a[172:175],v[172:175]
v_mfma_f32_16x16x32_bf16 v[176:179],v[44:47],a[176:179],v[176:179]
v_mfma_f32_16x16x32_bf16 v[180:183],v[44:47],a[180:183],v[180:183]
v_mfma_f32_16x16x32_bf16 v[184:187],v[44:47],a[184:187],v[184:187]
v_mfma_f32_16x16x32_bf16 v[188:191],v[44:47],a[188:191],v[188:191]
buffer_load_dwordx4 v0,s[8:11],s64 offen offset:1024 sc1 lds
v_mfma_f32_16x16x32_bf16 v[160:163],v[48:51],a[192:195],v[160:163]
v_mfma_f32_16x16x32_bf16 v[164:167],v[48:51],a[196:199],v[164:167]
v_mfma_f32_16x16x32_bf16 v[168:171],v[48:51],a[200:203],v[168:171]
v_mfma_f32_16x16x32_bf16 v[172:175],v[48:51],a[204:207],v[172:175]
v_mfma_f32_16x16x32_bf16 v[176:179],v[48:51],a[208:211],v[176:179]
buffer_load_dwordx4 v0,s[8:11],s64 offen offset:2048 sc1 lds
v_mfma_f32_16x16x32_bf16 v[180:183],v[48:51],a[212:215],v[180:183]
v_mfma_f32_16x16x32_bf16 v[184:187],v[48:51],a[216:219],v[184:187]
v_mfma_f32_16x16x32_bf16 v[188:191],v[48:51],a[220:223],v[188:191]
v_mfma_f32_16x16x32_bf16 v[160:163],v[52:55],a[224:227],v[160:163]
v_mfma_f32_16x16x32_bf16 v[164:167],v[52:55],a[228:231],v[164:167]
buffer_load_dwordx4 v0,s[8:11],s64 offen offset:3072 sc1 lds
v_mfma_f32_16x16x32_bf16 v[168:171],v[52:55],a[232:235],v[168:171]
v_mfma_f32_16x16x32_bf16 v[172:175],v[52:55],a[236:239],v[172:175]
v_mfma_f32_16x16x32_bf16 v[176:179],v[52:55],a[240:243],v[176:179]
v_mfma_f32_16x16x32_bf16 v[180:183],v[52:55],a[244:247],v[180:183]
v_mfma_f32_16x16x32_bf16 v[184:187],v[52:55],a[248:251],v[184:187]
s_add_u32 m0,s57,24576
v_mfma_f32_16x16x32_bf16 v[188:191],v[52:55],a[252:255],v[188:191]
buffer_load_dwordx4 v0,s[8:11],s65 offen offset:0 sc1 lds
v_mfma_f32_16x16x32_bf16 v[192:195],v[56:59],a[0:3],0
v_mfma_f32_16x16x32_bf16 v[196:199],v[56:59],a[4:7],0
v_mfma_f32_16x16x32_bf16 v[200:203],v[56:59],a[8:11],0
v_cvt_pk_bf16_f32 v24,v160,v164
v_cvt_pk_bf16_f32 v25,v168,v172
v_mfma_f32_16x16x32_bf16 v[204:207],v[56:59],a[12:15],0
v_cvt_pk_bf16_f32 v26,v176,v180
v_cvt_pk_bf16_f32 v27,v184,v188
v_mfma_f32_16x16x32_bf16 v[208:211],v[56:59],a[16:19],0
buffer_load_dwordx4 v0,s[8:11],s65 offen offset:1024 sc1 lds
v_mfma_f32_16x16x32_bf16 v[212:215],v[56:59],a[20:23],0
v_cvt_pk_bf16_f32 v28,v161,v165
v_cvt_pk_bf16_f32 v29,v169,v173
v_mfma_f32_16x16x32_bf16 v[216:219],v[56:59],a[24:27],0
v_cvt_pk_bf16_f32 v30,v177,v181
v_cvt_pk_bf16_f32 v31,v185,v189
v_mfma_f32_16x16x32_bf16 v[220:223],v[56:59],a[28:31],0
v_cvt_pk_bf16_f32 v32,v162,v166
v_cvt_pk_bf16_f32 v33,v170,v174
v_mfma_f32_16x16x32_bf16 v[192:195],v[60:63],a[32:35],v[192:195]
v_cvt_pk_bf16_f32 v34,v178,v182
v_cvt_pk_bf16_f32 v35,v186,v190
v_mfma_f32_16x16x32_bf16 v[196:199],v[60:63],a[36:39],v[196:199]
v_cvt_pk_bf16_f32 v36,v163,v167
v_cvt_pk_bf16_f32 v37,v171,v175
v_mfma_f32_16x16x32_bf16 v[200:203],v[60:63],a[40:43],v[200:203]
v_cvt_pk_bf16_f32 v38,v179,v183
v_cvt_pk_bf16_f32 v39,v187,v191
v_mfma_f32_16x16x32_bf16 v[204:207],v[60:63],a[44:47],v[204:207]
v_mfma_f32_16x16x32_bf16 v[208:211],v[60:63],a[48:51],v[208:211]
v_mfma_f32_16x16x32_bf16 v[212:215],v[60:63],a[52:55],v[212:215]
v_mfma_f32_16x16x32_bf16 v[216:219],v[60:63],a[56:59],v[216:219]
v_mfma_f32_16x16x32_bf16 v[220:223],v[60:63],a[60:63],v[220:223]
v_mfma_f32_16x16x32_bf16 v[192:195],v[64:67],a[64:67],v[192:195]
v_mfma_f32_16x16x32_bf16 v[196:199],v[64:67],a[68:71],v[196:199]
v_mfma_f32_16x16x32_bf16 v[200:203],v[64:67],a[72:75],v[200:203]
v_mfma_f32_16x16x32_bf16 v[204:207],v[64:67],a[76:79],v[204:207]
v_mfma_f32_16x16x32_bf16 v[208:211],v[64:67],a[80:83],v[208:211]
v_mfma_f32_16x16x32_bf16 v[212:215],v[64:67],a[84:87],v[212:215]
v_mfma_f32_16x16x32_bf16 v[216:219],v[64:67],a[88:91],v[216:219]
v_mfma_f32_16x16x32_bf16 v[220:223],v[64:67],a[92:95],v[220:223]
v_mfma_f32_16x16x32_bf16 v[192:195],v[68:71],a[96:99],v[192:195]
v_mfma_f32_16x16x32_bf16 v[196:199],v[68:71],a[100:103],v[196:199]
v_mfma_f32_16x16x32_bf16 v[200:203],v[68:71],a[104:107],v[200:203]
v_mfma_f32_16x16x32_bf16 v[204:207],v[68:71],a[108:111],v[204:207]
v_mfma_f32_16x16x32_bf16 v[208:211],v[68:71],a[112:115],v[208:211]
s_add_u32 s62,s69,0
v_mfma_f32_16x16x32_bf16 v[212:215],v[68:71],a[116:119],v[212:215]
buffer_store_dwordx4 v[24:27],v5,s[8:11],s62 offen sc1
v_mfma_f32_16x16x32_bf16 v[216:219],v[68:71],a[120:123],v[216:219]
v_mfma_f32_16x16x32_bf16 v[220:223],v[68:71],a[124:127],v[220:223]
v_mfma_f32_16x16x32_bf16 v[192:195],v[72:75],a[128:131],v[192:195]
v_mfma_f32_16x16x32_bf16 v[196:199],v[72:75],a[132:135],v[196:199]
v_mfma_f32_16x16x32_bf16 v[200:203],v[72:75],a[136:139],v[200:203]
s_add_u32 s62,s69,16384
v_mfma_f32_16x16x32_bf16 v[204:207],v[72:75],a[140:143],v[204:207]
buffer_store_dwordx4 v[28:31],v5,s[8:11],s62 offen sc1
v_mfma_f32_16x16x32_bf16 v[208:211],v[72:75],a[144:147],v[208:211]
v_mfma_f32_16x16x32_bf16 v[212:215],v[72:75],a[148:151],v[212:215]
v_mfma_f32_16x16x32_bf16 v[216:219],v[72:75],a[152:155],v[216:219]
v_mfma_f32_16x16x32_bf16 v[220:223],v[72:75],a[156:159],v[220:223]
v_mfma_f32_16x16x32_bf16 v[192:195],v[76:79],a[160:163],v[192:195]
s_add_u32 s62,s69,32768
v_mfma_f32_16x16x32_bf16 v[196:199],v[76:79],a[164:167],v[196:199]
buffer_store_dwordx4 v[32:35],v5,s[8:11],s62 offen sc1
v_mfma_f32_16x16x32_bf16 v[200:203],v[76:79],a[168:171],v[200:203]
v_mfma_f32_16x16x32_bf16 v[204:207],v[76:79],a[172:175],v[204:207]
v_mfma_f32_16x16x32_bf16 v[208:211],v[76:79],a[176:179],v[208:211]
v_mfma_f32_16x16x32_bf16 v[212:215],v[76:79],a[180:183],v[212:215]
v_mfma_f32_16x16x32_bf16 v[216:219],v[76:79],a[184:187],v[216:219]
s_add_u32 s62,s69,49152
v_mfma_f32_16x16x32_bf16 v[220:223],v[76:79],a[188:191],v[220:223]
buffer_store_dwordx4 v[36:39],v5,s[8:11],s62 offen sc1
v_mfma_f32_16x16x32_bf16 v[192:195],v[80:83],a[192:195],v[192:195]
v_mfma_f32_16x16x32_bf16 v[196:199],v[80:83],a[196:199],v[196:199]
v_mfma_f32_16x16x32_bf16 v[192:195],v[84:87],a[224:227],v[192:195]
v_mfma_f32_16x16x32_bf16 v[196:199],v[84:87],a[228:231],v[196:199]
v_mfma_f32_16x16x32_bf16 v[200:203],v[80:83],a[200:203],v[200:203]
v_mfma_f32_16x16x32_bf16 v[204:207],v[80:83],a[204:207],v[204:207]
v_mfma_f32_16x16x32_bf16 v[200:203],v[84:87],a[232:235],v[200:203]
v_mfma_f32_16x16x32_bf16 v[204:207],v[84:87],a[236:239],v[204:207]
v_cvt_pk_bf16_f32 v40,v192,v196
v_cvt_pk_bf16_f32 v44,v193,v197
v_cvt_pk_bf16_f32 v48,v194,v198
v_mfma_f32_16x16x32_bf16 v[208:211],v[80:83],a[208:211],v[208:211]
v_cvt_pk_bf16_f32 v52,v195,v199
v_mfma_f32_16x16x32_bf16 v[212:215],v[80:83],a[212:215],v[212:215]
v_cvt_pk_bf16_f32 v41,v200,v204
v_cvt_pk_bf16_f32 v45,v201,v205
v_cvt_pk_bf16_f32 v49,v202,v206
v_mfma_f32_16x16x32_bf16 v[208:211],v[84:87],a[240:243],v[208:211]
v_cvt_pk_bf16_f32 v53,v203,v207
v_mfma_f32_16x16x32_bf16 v[212:215],v[84:87],a[244:247],v[212:215]
v_mfma_f32_16x16x32_bf16 v[216:219],v[80:83],a[216:219],v[216:219]
v_mfma_f32_16x16x32_bf16 v[220:223],v[80:83],a[220:223],v[220:223]
v_mfma_f32_16x16x32_bf16 v[216:219],v[84:87],a[248:251],v[216:219]
v_mfma_f32_16x16x32_bf16 v[220:223],v[84:87],a[252:255],v[220:223]
v_cvt_pk_bf16_f32 v42,v208,v212
v_cvt_pk_bf16_f32 v46,v209,v213
v_cvt_pk_bf16_f32 v50,v210,v214
v_cvt_pk_bf16_f32 v54,v211,v215
s_nop 3
v_cvt_pk_bf16_f32 v43,v216,v220
s_add_u32 s62,s69,262144
buffer_store_dwordx4 v[40:43],v5,s[8:11],s62 offen sc1
v_cvt_pk_bf16_f32 v47,v217,v221
s_add_u32 s62,s69,278528
buffer_store_dwordx4 v[44:47],v5,s[8:11],s62 offen sc1
v_cvt_pk_bf16_f32 v51,v218,v222
s_add_u32 s62,s69,294912
buffer_store_dwordx4 v[48:51],v5,s[8:11],s62 offen sc1
v_cvt_pk_bf16_f32 v55,v219,v223
s_add_u32 s62,s69,311296
buffer_store_dwordx4 v[52:55],v5,s[8:11],s62 offen sc1
s_cmp_lg_u32 s72,0
s_cbranch_scc1 L_aa_322
s_waitcnt vmcnt(8)
L_aa_332:
s_barrier
s_cmp_lt_u32 s30,s31
s_cbranch_scc1 L_ao_339
s_xor_b32 s67,s67,65536
s_and_b32 s56,s50,2048
s_lshl_b32 s56,s56,4
s_add_u32 s56,s56,s67
v_add_u32 v2,s56,v0
s_and_b32 s56,s50,1024
s_lshl_b32 s56,s56,2
v_add_u32 v238,s56,v2
s_mov_b32 s76,s71
s_mov_b32 s53,s77
ds_read_b128 v[24:27],v238 offset:16384
ds_read_b128 v[40:43],v2 offset:0
ds_read_b128 v[56:59],v2 offset:4096
ds_read_b128 v[28:31],v238 offset:17408
ds_read_b128 v[44:47],v2 offset:1024
ds_read_b128 v[60:63],v2 offset:5120
ds_read_b128 v[32:35],v238 offset:18432
ds_read_b128 v[48:51],v2 offset:2048
ds_read_b128 v[64:67],v2 offset:6144
ds_read_b128 v[36:39],v238 offset:19456
ds_read_b128 v[52:55],v2 offset:3072
ds_read_b128 v[68:71],v2 offset:7168
s_waitcnt lgkmcnt(9)
v_mfma_f32_16x16x32_bf16 v[128:131],v[40:43],v[24:27],v[8:11]
ds_read_b128 v[72:75],v2 offset:24576
v_mfma_f32_16x16x32_bf16 v[132:135],v[56:59],v[24:27],v[12:15]
ds_read_b128 v[76:79],v2 offset:25600
s_waitcnt lgkmcnt(8)
v_mfma_f32_16x16x32_bf16 v[128:131],v[44:47],v[28:31],v[128:131]
ds_read_b128 v[80:83],v2 offset:26624
v_mfma_f32_16x16x32_bf16 v[132:135],v[60:63],v[28:31],v[132:135]
ds_read_b128 v[84:87],v2 offset:27648
s_waitcnt lgkmcnt(7)
v_mfma_f32_16x16x32_bf16 v[128:131],v[48:51],v[32:35],v[128:131]
ds_read_b128 v[88:91],v2 offset:8192
v_mfma_f32_16x16x32_bf16 v[132:135],v[64:67],v[32:35],v[132:135]
ds_read_b128 v[92:95],v2 offset:9216
s_waitcnt lgkmcnt(6)
v_mfma_f32_16x16x32_bf16 v[128:131],v[52:55],v[36:39],v[128:131]
ds_read_b128 v[96:99],v2 offset:10240
v_mfma_f32_16x16x32_bf16 v[132:135],v[68:71],v[36:39],v[132:135]
ds_read_b128 v[100:103],v2 offset:11264
s_waitcnt lgkmcnt(4)
s_mov_b32 vcc_lo,0x33333333
s_mov_b32 vcc_hi,0x33333333
v_mfma_f32_16x16x32_bf16 v[136:139],v[72:75],v[24:27],0
ds_read_b128 v[104:107],v2 offset:12288
v_max3_u32 v238,v72,v73,v74
v_max3_u32 v238,v74,v75,v238
v_cndmask_b32_dpp v120,v72,v74,vcc quad_perm:[0,1,0,1] row_mask:0xf bank_mask:0xf
v_cndmask_b32_dpp v121,v73,v75,vcc quad_perm:[0,1,0,1] row_mask:0xf bank_mask:0xf
v_mfma_f32_16x16x32_bf16 v[136:139],v[76:79],v[28:31],v[136:139]
ds_read_b128 v[108:111],v2 offset:13312
v_max3_u32 v238,v76,v77,v238
v_max3_u32 v238,v78,v79,v238
v_cndmask_b32_dpp v122,v76,v78,vcc quad_perm:[0,1,0,1] row_mask:0xf bank_mask:0xf
v_cndmask_b32_dpp v123,v77,v79,vcc quad_perm:[0,1,0,1] row_mask:0xf bank_mask:0xf
v_mfma_f32_16x16x32_bf16 v[136:139],v[80:83],v[32:35],v[136:139]
ds_read_b128 v[112:115],v2 offset:14336
v_max3_u32 v238,v80,v81,v238
v_max3_u32 v238,v82,v83,v238
v_cndmask_b32_dpp v124,v80,v82,vcc quad_perm:[0,1,0,1] row_mask:0xf bank_mask:0xf
v_cndmask_b32_dpp v125,v81,v83,vcc quad_perm:[0,1,0,1] row_mask:0xf bank_mask:0xf
v_mfma_f32_16x16x32_bf16 v[136:139],v[84:87],v[36:39],v[136:139]
ds_read_b128 v[116:119],v2 offset:15360
v_max3_u32 v238,v84,v85,v238
v_max3_u32 v238,v86,v87,v238
v_cndmask_b32_dpp v126,v84,v86,vcc quad_perm:[0,1,0,1] row_mask:0xf bank_mask:0xf
v_cndmask_b32_dpp v127,v85,v87,vcc quad_perm:[0,1,0,1] row_mask:0xf bank_mask:0xf
v_cmp_eq_u32 vcc,-1,v238
s_cmp_eq_u32 s30,0
s_cbranch_scc1 L_aa_321
s_cmp_lg_u64 vcc,0
s_cselect_b32 s27,1,0
s_andn2_b32 s57,s27,s31
s_add_u32 s66,s66,4
s_bfe_u32 s56,s66,0x10002
s_bitset0_b32 s37,s56
s_lshl_b32 s56,s57,s56
s_or_b32 s37,s37,s56
s_or_b32 s56,s37,s66
v_mov_b32 v22,s56
s_xor_b32 s69,s69,524288
s_waitcnt vmcnt(0) lgkmcnt(0)
buffer_store_dword v22,off,s[8:11],s74 sc1
s_cmp_lg_u32 s86,1536
s_cbranch_scc1 L_ae_342
s_mov_b32 s77,s35
s_mov_b32 s30,0
s_lshl_b32 s56,s77,5
s_add_u32 s56,s56,s68
s_mul_i32 s70,s56,24576
s_lshl_b32 s71,s56,12
s_lshl_b32 s59,s77,13
s_lshl2_add_u32 s59,s68,s59
s_add_u32 s59,s59,10485760
s_buffer_load_dword s32,s[8:11],s59
s_mov_b32 s33,1
s_add_u32 s70,s70,100663296
s_add_u32 s71,s71,41943040
v_mov_b32 v19,s59
s_branch L_af_343
L_ae_342:
s_ff1_i32_b64 s77,s[84:85]
s_bitset0_b64 s[84:85],s77
s_min_u32 s77,s77,64
s_lshr_b32 s61,s55,5
s_lshl_b32 s56,s77,5
s_add_u32 s56,s56,s68
s_mul_i32 s70,s56,24576
s_lshl_b32 s71,s56,12
s_lshl_b32 s59,s77,13
s_lshl2_add_u32 s59,s68,s59
s_add_u32 s59,s59,10486144
s_cmp_lt_u32 s77,s61
s_cselect_b32 s57,0,16777216
s_mov_b32 s60,s59
s_buffer_load_dword s33,s[8:11],s60
s_add_u32 s71,s71,s57
s_add_u32 s71,s71,58720256
s_cmp_eq_u32 s77,s61
s_cselect_b32 s57,50331648,0
s_cselect_b32 s58,1536,0
s_add_u32 s59,s59,s58
s_buffer_load_dword s32,s[8:11],s59
s_add_u32 s70,s70,s57
s_add_u32 s70,s70,150994944
v_mov_b32 v19,s59
v_writelane_b32 v19,s60,1
L_af_343:
s_cmp_ge_u32 s53,60
s_cbranch_scc1 L_a4_344
L_a4_345:
s_and_b32 s27,s27,s31
s_cbranch_scc1 L_ac_347
L_acb_348:
v_max3_f32 v238,v128,v129,v130
v_max3_f32 v239,v131,v132,v133
v_max3_f32 v238,v134,v135,v238
v_max3_f32 v239,v138,v139,v239
v_max_f32 v238,v238,v239
v_max_f32 v239,v238,v239
v_pk_mul_f32 v[128:129],v[128:129],v[152:153] op_sel_hi:[1,0]
v_pk_mul_f32 v[130:131],v[130:131],v[152:153] op_sel_hi:[1,0]
v_permlane16_swap_b32 v238,v239
v_max_f32 v238,v238,v239
v_max_f32 v239,v238,v239
v_pk_mul_f32 v[132:133],v[132:133],v[152:153] op_sel_hi:[1,0]
v_pk_mul_f32 v[134:135],v[134:135],v[152:153] op_sel_hi:[1,0]
v_permlane32_swap_b32 v238,v239
v_max_f32 v238,v238,v239
v_mul_f32 v238,v152,v238
v_pk_mul_f32 v[138:139],v[138:139],v[152:153] op_sel_hi:[1,0]
buffer_load_dword v17,v16,s[8:11],s87 offen sc1
v_pk_add_f32 v[128:129],v[128:129],v[238:239] op_sel_hi:[1,0] neg_lo:[0,1] neg_hi:[0,1]
v_pk_add_f32 v[130:131],v[130:131],v[238:239] op_sel_hi:[1,0] neg_lo:[0,1] neg_hi:[0,1]
v_pk_add_f32 v[132:133],v[132:133],v[238:239] op_sel_hi:[1,0] neg_lo:[0,1] neg_hi:[0,1]
v_pk_add_f32 v[134:135],v[134:135],v[238:239] op_sel_hi:[1,0] neg_lo:[0,1] neg_hi:[0,1]
v_pk_add_f32 v[138:139],v[138:139],v[238:239] op_sel_hi:[1,0] neg_lo:[0,1] neg_hi:[0,1]
v_exp_f32 v128,v128
v_exp_f32 v129,v129
v_exp_f32 v130,v130
v_exp_f32 v131,v131
v_exp_f32 v132,v132
v_exp_f32 v133,v133
v_exp_f32 v134,v134
v_exp_f32 v135,v135
v_exp_f32 v138,v138
v_exp_f32 v139,v139
v_pk_add_f32 v[148:149],v[128:129],v[130:131]
v_pk_add_f32 v[150:151],v[132:133],v[134:135]
v_pk_add_f32 v[148:149],v[148:149],v[138:139]
v_pk_add_f32 v[148:149],v[148:149],v[150:151]
v_add_f32 v150,v148,v149
v_add_f32 v151,v148,v149
s_nop 1
v_permlane16_swap_b32 v150,v151
v_add_f32 v148,v150,v151
v_add_f32 v149,v150,v151
s_nop 1
v_permlane32_swap_b32 v148,v149
v_add_f32 v148,v148,v149
v_rcp_f32 v148,v148
s_waitcnt vmcnt(0)
v_cmp_gt_u32 vcc,s66,v17
v_pk_mul_f32 v[138:139],v[138:139],v[148:149] op_sel_hi:[1,0]
v_pk_mul_f32 v[128:129],v[128:129],v[148:149] op_sel_hi:[1,0]
v_pk_mul_f32 v[130:131],v[130:131],v[148:149] op_sel_hi:[1,0]
v_pk_mul_f32 v[132:133],v[132:133],v[148:149] op_sel_hi:[1,0]
v_pk_mul_f32 v[134:135],v[134:135],v[148:149] op_sel_hi:[1,0]
s_cbranch_vccnz L_ap_350
L_apb_351:
s_xor_b32 s34,s69,524288
buffer_load_dwordx4 v[192:195],v7,s[8:11],s34 offen sc1
s_bfe_u32 s56,s66,0x10002
v_lshrrev_b32 v238,s56,v17
v_and_b32 v238,1,v238
v_cmp_ne_u32 vcc,0,v238
v_cvt_pk_bf16_f32 v144,v138,v139
v_cvt_pk_bf16_f32 v147,v138,v139
v_cvt_pk_bf16_f32 v140,v128,v129
v_cvt_pk_bf16_f32 v141,v130,v131
v_cvt_pk_bf16_f32 v142,v132,v133
v_cvt_pk_bf16_f32 v143,v134,v135
s_cbranch_vccnz L_ak_341
s_add_u32 s36,s36,4
v_mfma_f32_16x16x16_bf16 v[24:27],v[120:121],v[144:145],0
s_add_u32 s34,s34,4096
v_mfma_f32_16x16x16_bf16 v[28:31],v[120:121],v[146:147],0
buffer_load_dwordx4 v[196:199],v7,s[8:11],s34 offen sc1
v_mfma_f32_16x16x16_bf16 v[32:35],v[122:123],v[144:145],0
s_add_u32 s34,s34,4096
v_mfma_f32_16x16x16_bf16 v[36:39],v[122:123],v[146:147],0
buffer_load_dwordx4 v[200:203],v7,s[8:11],s34 offen sc1
v_mfma_f32_16x16x16_bf16 v[40:43],v[124:125],v[144:145],0
s_add_u32 s34,s34,4096
v_mfma_f32_16x16x16_bf16 v[44:47],v[124:125],v[146:147],0
buffer_load_dwordx4 v[204:207],v7,s[8:11],s34 offen sc1
v_mfma_f32_16x16x16_bf16 v[48:51],v[126:127],v[144:145],0
s_add_u32 s34,s34,4096
v_mfma_f32_16x16x16_bf16 v[52:55],v[126:127],v[146:147],0
buffer_load_dwordx4 v[208:211],v7,s[8:11],s34 offen sc1
v_mfma_f32_16x16x32_bf16 v[24:27],v[88:91],v[140:143],v[24:27]
s_add_u32 s34,s34,4096
v_mfma_f32_16x16x32_bf16 v[28:31],v[92:95],v[140:143],v[28:31]
buffer_load_dwordx4 v[212:215],v7,s[8:11],s34 offen sc1
v_mfma_f32_16x16x32_bf16 v[32:35],v[96:99],v[140:143],v[32:35]
s_add_u32 s34,s34,4096
v_mfma_f32_16x16x32_bf16 v[36:39],v[100:103],v[140:143],v[36:39]
buffer_load_dwordx4 v[216:219],v7,s[8:11],s34 offen sc1
v_cvt_pk_bf16_f32 v72,v24,v28
v_cvt_pk_bf16_f32 v73,v25,v29
v_mfma_f32_16x16x32_bf16 v[40:43],v[104:107],v[140:143],v[40:43]
s_add_u32 s34,s34,4096
v_cvt_pk_bf16_f32 v74,v26,v30
v_cvt_pk_bf16_f32 v75,v27,v31
v_mfma_f32_16x16x32_bf16 v[44:47],v[108:111],v[140:143],v[44:47]
ds_write_b128 v3,v[72:75] offset:0
v_cvt_pk_bf16_f32 v76,v32,v36
v_cvt_pk_bf16_f32 v77,v33,v37
v_mfma_f32_16x16x32_bf16 v[48:51],v[112:115],v[140:143],v[48:51]
buffer_load_dwordx4 v[220:223],v7,s[8:11],s34 offen sc1
v_cvt_pk_bf16_f32 v78,v34,v38
v_cvt_pk_bf16_f32 v79,v35,v39
v_mfma_f32_16x16x32_bf16 v[52:55],v[116:119],v[140:143],v[52:55]
ds_write_b128 v3,v[76:79] offset:1024
v_cvt_pk_bf16_f32 v80,v40,v44
v_cvt_pk_bf16_f32 v81,v41,v45
v_cvt_pk_bf16_f32 v82,v42,v46
v_cvt_pk_bf16_f32 v83,v43,v47
ds_write_b128 v3,v[80:83] offset:2048
s_nop 1
v_cvt_pk_bf16_f32 v84,v48,v52
v_cvt_pk_bf16_f32 v85,v49,v53
v_cvt_pk_bf16_f32 v86,v50,v54
v_cvt_pk_bf16_f32 v87,v51,v55
ds_write_b128 v3,v[84:87] offset:3072
s_cmp_eq_u32 s31,0
s_cbranch_scc1 L_ah_349
s_waitcnt lgkmcnt(0)
s_barrier
s_mov_b32 s26,s51
s_mov_b32 s51,s53
s_branch L_aa_333
L_ah_349:
s_cmp_ge_u32 s35,64
s_cbranch_scc1 L_a1_352
L_a2_353:
s_waitcnt vmcnt(7)
v_mfma_f32_16x16x32_bf16 v[160:163],v[156:159],v[192:195],0
s_waitcnt vmcnt(6)
v_mfma_f32_16x16x32_bf16 v[160:163],v[156:159],v[196:199],v[160:163]
s_waitcnt vmcnt(5)
v_mfma_f32_16x16x32_bf16 v[160:163],v[156:159],v[200:203],v[160:163]
s_waitcnt vmcnt(4)
v_mfma_f32_16x16x32_bf16 v[160:163],v[156:159],v[204:207],v[160:163]
s_waitcnt vmcnt(3)
v_mfma_f32_16x16x32_bf16 v[164:167],v[156:159],v[208:211],0
s_waitcnt vmcnt(2)
v_mfma_f32_16x16x32_bf16 v[164:167],v[156:159],v[212:215],v[164:167]
s_waitcnt vmcnt(1)
v_mfma_f32_16x16x32_bf16 v[164:167],v[156:159],v[216:219],v[164:167]
ds_write_b128 v6,v[160:163]
s_waitcnt vmcnt(0)
v_mfma_f32_16x16x32_bf16 v[164:167],v[156:159],v[220:223],v[164:167]
s_nop 7
ds_write_b128 v6,v[164:167] offset:2048
s_waitcnt lgkmcnt(0)
s_barrier
buffer_store_dword v20,off,s[8:11],s73 sc1
s_mov_b32 s73,0x80000000
s_mov_b32 s27,1
s_branch L_aa_324
L_ao_339:
s_xor_b32 s67,s67,65536
s_and_b32 s56,s50,2048
s_lshl_b32 s56,s56,4
s_add_u32 s56,s56,s67
v_add_u32 v2,s56,v0
s_and_b32 s56,s50,1024
s_lshl_b32 s56,s56,2
v_add_u32 v238,s56,v2
s_mov_b32 s76,s71
s_mov_b32 s53,s77
ds_read_b128 v[24:27],v238 offset:16384
ds_read_b128 v[40:43],v2 offset:0
ds_read_b128 v[56:59],v2 offset:4096
ds_read_b128 v[28:31],v238 offset:17408
ds_read_b128 v[44:47],v2 offset:1024
ds_read_b128 v[60:63],v2 offset:5120
ds_read_b128 v[32:35],v238 offset:18432
ds_read_b128 v[48:51],v2 offset:2048
ds_read_b128 v[64:67],v2 offset:6144
ds_read_b128 v[36:39],v238 offset:19456
ds_read_b128 v[52:55],v2 offset:3072
ds_read_b128 v[68:71],v2 offset:7168
buffer_load_dwordx4 v[72:75],v0,s[8:11],s76 offen offset:0 sc1
buffer_load_dwordx4 v[76:79],v0,s[8:11],s76 offen offset:1024 sc1
buffer_load_dwordx4 v[80:83],v0,s[8:11],s76 offen offset:2048 sc1
buffer_load_dwordx4 v[84:87],v0,s[8:11],s76 offen offset:3072 sc1
s_waitcnt lgkmcnt(9)
v_mfma_f32_16x16x32_bf16 v[128:131],v[40:43],v[24:27],v[8:11]
ds_read_b128 v[88:91],v2 offset:8192
v_mfma_f32_16x16x32_bf16 v[132:135],v[56:59],v[24:27],v[12:15]
ds_read_b128 v[92:95],v2 offset:9216
s_waitcnt lgkmcnt(8)
v_mfma_f32_16x16x32_bf16 v[128:131],v[44:47],v[28:31],v[128:131]
ds_read_b128 v[96:99],v2 offset:10240
v_mfma_f32_16x16x32_bf16 v[132:135],v[60:63],v[28:31],v[132:135]
ds_read_b128 v[100:103],v2 offset:11264
s_waitcnt lgkmcnt(7)
v_mfma_f32_16x16x32_bf16 v[128:131],v[48:51],v[32:35],v[128:131]
ds_read_b128 v[104:107],v2 offset:12288
v_mfma_f32_16x16x32_bf16 v[132:135],v[64:67],v[32:35],v[132:135]
ds_read_b128 v[108:111],v2 offset:13312
s_waitcnt lgkmcnt(6)
v_mfma_f32_16x16x32_bf16 v[128:131],v[52:55],v[36:39],v[128:131]
ds_read_b128 v[112:115],v2 offset:14336
v_mfma_f32_16x16x32_bf16 v[132:135],v[68:71],v[36:39],v[132:135]
ds_read_b128 v[116:119],v2 offset:15360
s_add_u32 s66,s66,4
s_bfe_u32 s56,s66,0x10002
s_bitset0_b32 s37,s56
s_lshl_b32 s56,0,s56
s_or_b32 s37,s37,s56
s_or_b32 s56,s37,s66
v_mov_b32 v22,s56
s_xor_b32 s69,s69,524288
s_waitcnt vmcnt(4) lgkmcnt(0)
buffer_store_dword v22,off,s[8:11],s74 sc1
s_mov_b32 s26,s51
s_mov_b32 s27,3
s_branch L_aa_328
L_aa_321:
s_add_u32 s66,s66,4
s_bfe_u32 s56,s66,0x10002
s_bitset0_b32 s37,s56
s_lshl_b32 s56,0,s56
s_or_b32 s37,s37,s56
s_or_b32 s56,s37,s66
v_mov_b32 v22,s56
s_xor_b32 s69,s69,524288
s_waitcnt vmcnt(0) lgkmcnt(0)
buffer_store_dword v22,off,s[8:11],s74 sc1
L_aq_354:
buffer_load_dword v17,v16,s[8:11],s87 offen sc1
s_sub_u32 s49,s49,1
s_cbranch_scc1 L_abort2
s_waitcnt vmcnt(0)
v_cmp_gt_u32 vcc,s66,v17
s_cbranch_vccnz L_aq_354
s_xor_b32 s34,s69,524288
buffer_load_dwordx4 v[160:163],v7,s[8:11],s34 offen sc1
s_add_u32 s34,s34,4096
buffer_load_dwordx4 v[164:167],v7,s[8:11],s34 offen sc1
s_add_u32 s34,s34,4096
buffer_load_dwordx4 v[168:171],v7,s[8:11],s34 offen sc1
s_add_u32 s34,s34,4096
buffer_load_dwordx4 v[172:175],v7,s[8:11],s34 offen sc1
s_add_u32 s34,s34,4096
buffer_load_dwordx4 v[176:179],v7,s[8:11],s34 offen sc1
s_add_u32 s34,s34,4096
buffer_load_dwordx4 v[180:183],v7,s[8:11],s34 offen sc1
s_add_u32 s34,s34,4096
buffer_load_dwordx4 v[184:187],v7,s[8:11],s34 offen sc1
s_add_u32 s34,s34,4096
buffer_load_dwordx4 v[188:191],v7,s[8:11],s34 offen sc1
buffer_load_dwordx4 v[72:75],v0,s[8:11],s76 offen offset:0 sc1
buffer_load_dwordx4 v[76:79],v0,s[8:11],s76 offen offset:1024 sc1
buffer_load_dwordx4 v[80:83],v0,s[8:11],s76 offen offset:2048 sc1
buffer_load_dwordx4 v[84:87],v0,s[8:11],s76 offen offset:3072 sc1
s_waitcnt vmcnt(11)
v_mfma_f32_16x16x32_bf16 v[192:195],v[156:159],v[160:163],0
s_waitcnt vmcnt(10)
v_mfma_f32_16x16x32_bf16 v[192:195],v[156:159],v[164:167],v[192:195]
s_waitcnt vmcnt(9)
v_mfma_f32_16x16x32_bf16 v[192:195],v[156:159],v[168:171],v[192:195]
s_waitcnt vmcnt(8)
v_mfma_f32_16x16x32_bf16 v[192:195],v[156:159],v[172:175],v[192:195]
s_waitcnt vmcnt(7)
v_mfma_f32_16x16x32_bf16 v[196:199],v[156:159],v[176:179],0
s_waitcnt vmcnt(6)
v_mfma_f32_16x16x32_bf16 v[196:199],v[156:159],v[180:183],v[196:199]
s_waitcnt vmcnt(5)
v_mfma_f32_16x16x32_bf16 v[196:199],v[156:159],v[184:187],v[196:199]
ds_write_b128 v6,v[192:195]
s_waitcnt vmcnt(4)
v_mfma_f32_16x16x32_bf16 v[196:199],v[156:159],v[188:191],v[196:199]
s_nop 7
ds_write_b128 v6,v[196:199] offset:2048
s_waitcnt lgkmcnt(0)
s_barrier
buffer_store_dword v20,off,s[8:11],s73 sc1
s_mov_b32 s73,0x80000000
s_mov_b32 s27,0
s_branch L_aa_324
L_aa_322:
s_add_u32 s56,s30,s86
s_cmp_lg_u32 s56,1537
s_cbranch_scc1 L_al_340
s_add_u32 s66,s66,4
s_bfe_u32 s56,s66,0x10002
s_bitset0_b32 s37,s56
s_lshl_b32 s56,1,s56
s_or_b32 s37,s37,s56
s_or_b32 s56,s37,s66
v_mov_b32 v22,s56
s_xor_b32 s69,s69,524288
s_waitcnt vmcnt(0) lgkmcnt(0)
buffer_store_dword v22,off,s[8:11],s74 sc1
s_cmp_lg_u32 s86,1536
s_cbranch_scc1 L_ae_355
s_mov_b32 s77,s35
s_mov_b32 s30,0
s_lshl_b32 s56,s77,5
s_add_u32 s56,s56,s68
s_mul_i32 s70,s56,24576
s_lshl_b32 s71,s56,12
s_lshl_b32 s59,s77,13
s_lshl2_add_u32 s59,s68,s59
s_add_u32 s59,s59,10485760
s_buffer_load_dword s32,s[8:11],s59
s_mov_b32 s33,1
s_add_u32 s70,s70,100663296
s_add_u32 s71,s71,41943040
v_mov_b32 v19,s59
s_branch L_af_356
L_ae_355:
s_ff1_i32_b64 s77,s[84:85]
s_bitset0_b64 s[84:85],s77
s_min_u32 s77,s77,64
s_lshr_b32 s61,s55,5
s_lshl_b32 s56,s77,5
s_add_u32 s56,s56,s68
s_mul_i32 s70,s56,24576
s_lshl_b32 s71,s56,12
s_lshl_b32 s59,s77,13
s_lshl2_add_u32 s59,s68,s59
s_add_u32 s59,s59,10486144
s_cmp_lt_u32 s77,s61
s_cselect_b32 s57,0,16777216
s_mov_b32 s60,s59
s_buffer_load_dword s33,s[8:11],s60
s_add_u32 s71,s71,s57
s_add_u32 s71,s71,58720256
s_cmp_eq_u32 s77,s61
s_cselect_b32 s57,50331648,0
s_cselect_b32 s58,1536,0
s_add_u32 s59,s59,s58
s_buffer_load_dword s32,s[8:11],s59
s_add_u32 s70,s70,s57
s_add_u32 s70,s70,150994944
v_mov_b32 v19,s59
v_writelane_b32 v19,s60,1
L_af_356:
s_branch L_ak_341
L_al_340:
s_add_u32 s66,s66,4
s_bfe_u32 s56,s66,0x10002
s_bitset0_b32 s37,s56
s_lshl_b32 s56,0,s56
s_or_b32 s37,s37,s56
s_or_b32 s56,s37,s66
v_mov_b32 v22,s56
s_xor_b32 s69,s69,524288
s_waitcnt vmcnt(0) lgkmcnt(0)
buffer_store_dword v22,off,s[8:11],s74 sc1
buffer_store_dword v20,off,s[8:11],s73 sc1
s_mov_b32 s73,0x80000000
L_ak_341:
L_aq_357:
buffer_load_dword v17,v16,s[8:11],s87 offen sc1
s_sub_u32 s49,s49,1
s_cbranch_scc1 L_abort2
s_waitcnt vmcnt(0)
v_cmp_gt_u32 vcc,s66,v17
s_cbranch_vccnz L_aq_357
s_xor_b32 s34,s69,524288
buffer_load_dwordx4 v[160:163],v7,s[8:11],s34 offen sc1
s_add_u32 s34,s34,4096
buffer_load_dwordx4 v[164:167],v7,s[8:11],s34 offen sc1
s_add_u32 s34,s34,4096
buffer_load_dwordx4 v[168:171],v7,s[8:11],s34 offen sc1
s_add_u32 s34,s34,4096
buffer_load_dwordx4 v[172:175],v7,s[8:11],s34 offen sc1
s_add_u32 s34,s34,4096
buffer_load_dwordx4 v[176:179],v7,s[8:11],s34 offen sc1
s_add_u32 s34,s34,4096
buffer_load_dwordx4 v[180:183],v7,s[8:11],s34 offen sc1
s_add_u32 s34,s34,4096
buffer_load_dwordx4 v[184:187],v7,s[8:11],s34 offen sc1
s_add_u32 s34,s34,4096
buffer_load_dwordx4 v[188:191],v7,s[8:11],s34 offen sc1
s_waitcnt vmcnt(7)
v_mfma_f32_16x16x32_bf16 v[192:195],v[156:159],v[160:163],0
s_waitcnt vmcnt(6)
v_mfma_f32_16x16x32_bf16 v[192:195],v[156:159],v[164:167],v[192:195]
s_waitcnt vmcnt(5)
v_mfma_f32_16x16x32_bf16 v[192:195],v[156:159],v[168:171],v[192:195]
s_waitcnt vmcnt(4)
v_mfma_f32_16x16x32_bf16 v[192:195],v[156:159],v[172:175],v[192:195]
s_waitcnt vmcnt(3)
v_mfma_f32_16x16x32_bf16 v[196:199],v[156:159],v[176:179],0
s_waitcnt vmcnt(2)
v_mfma_f32_16x16x32_bf16 v[196:199],v[156:159],v[180:183],v[196:199]
s_waitcnt vmcnt(1)
v_mfma_f32_16x16x32_bf16 v[196:199],v[156:159],v[184:187],v[196:199]
ds_write_b128 v6,v[192:195]
s_waitcnt vmcnt(0)
v_mfma_f32_16x16x32_bf16 v[196:199],v[156:159],v[188:191],v[196:199]
s_nop 7
ds_write_b128 v6,v[196:199] offset:2048
s_waitcnt lgkmcnt(0)
s_barrier
buffer_store_dword v20,off,s[8:11],s73 sc1
s_mov_b32 s73,0x80000000
s_mov_b32 s27,2
L_aa_324:
s_cmp_lg_u32 s31,0
s_cbranch_scc1 L_ar_360
s_bitcmp1_b32 s46,0
s_cbranch_scc1 L_ar_359
L_ar_358:
ds_read_b128 v[160:163],v23
ds_read_b128 v[164:167],v23 offset:16
v_lshlrev_b32 v200,16,v224
v_and_b32 v201,0xffff0000,v224
v_lshlrev_b32 v202,16,v225
v_and_b32 v203,0xffff0000,v225
v_lshlrev_b32 v204,16,v226
v_and_b32 v205,0xffff0000,v226
v_lshlrev_b32 v206,16,v227
v_and_b32 v207,0xffff0000,v227
s_lshl_b32 s18,s51,5
s_add_u32 s18,s18,s68
s_lshl_b32 s19,s18,10
s_add_u32 s20,s19,8388608
s_waitcnt lgkmcnt(0)
v_cvt_pk_bf16_f32 v168,v160,v161
v_cvt_pk_bf16_f32 v169,v162,v163
v_cvt_pk_bf16_f32 v170,v164,v165
v_cvt_pk_bf16_f32 v171,v166,v167
v_lshlrev_b32 v160,16,v168
v_and_b32 v161,0xffff0000,v168
v_lshlrev_b32 v162,16,v169
v_and_b32 v163,0xffff0000,v169
v_lshlrev_b32 v164,16,v170
v_and_b32 v165,0xffff0000,v170
v_lshlrev_b32 v166,16,v171
v_and_b32 v167,0xffff0000,v171
v_pk_add_f32 v[200:201],v[200:201],v[160:161]
v_pk_add_f32 v[202:203],v[202:203],v[162:163]
v_pk_add_f32 v[204:205],v[204:205],v[164:165]
v_pk_add_f32 v[206:207],v[206:207],v[166:167]
v_cvt_pk_bf16_f32 v168,v200,v201
v_cvt_pk_bf16_f32 v169,v202,v203
v_cvt_pk_bf16_f32 v170,v204,v205
v_cvt_pk_bf16_f32 v171,v206,v207
v_lshlrev_b32 v200,16,v168
v_and_b32 v201,0xffff0000,v168
v_lshlrev_b32 v202,16,v169
v_and_b32 v203,0xffff0000,v169
v_lshlrev_b32 v204,16,v170
v_and_b32 v205,0xffff0000,v170
v_lshlrev_b32 v206,16,v171
v_and_b32 v207,0xffff0000,v171
v_readfirstlane_b32 s78,v200
s_nop 1
v_pk_add_f32 v[184:185],v[200:201],s[78:79] op_sel_hi:[1,0] neg_lo:[0,1] neg_hi:[0,1]
v_pk_add_f32 v[186:187],v[202:203],s[78:79] op_sel_hi:[1,0] neg_lo:[0,1] neg_hi:[0,1]
v_pk_add_f32 v[188:189],v[204:205],s[78:79] op_sel_hi:[1,0] neg_lo:[0,1] neg_hi:[0,1]
v_pk_add_f32 v[190:191],v[206:207],s[78:79] op_sel_hi:[1,0] neg_lo:[0,1] neg_hi:[0,1]
v_pk_add_f32 v[192:193],v[184:185],v[186:187]
v_pk_mul_f32 v[194:195],v[184:185],v[184:185]
v_pk_add_f32 v[196:197],v[188:189],v[190:191]
v_pk_fma_f32 v[194:195],v[186:187],v[186:187],v[194:195]
v_pk_add_f32 v[192:193],v[192:193],v[196:197]
v_pk_fma_f32 v[194:195],v[188:189],v[188:189],v[194:195]
v_add_f32 v192,v192,v193
v_pk_fma_f32 v[194:195],v[190:191],v[190:191],v[194:195]
v_add_f32 v194,v194,v195
s_nop 1
v_permlane32_swap_b32 v192,v194
v_add_f32 v192,v192,v194
s_nop 1
v_add_f32_dpp v192,v192,v192 row_ror:8 row_mask:0xf bank_mask:0xf
s_nop 1
v_add_f32_dpp v192,v192,v192 row_ror:4 row_mask:0xf bank_mask:0xf
s_nop 1
v_add_f32_dpp v192,v192,v192 row_ror:2 row_mask:0xf bank_mask:0xf
s_nop 1
v_add_f32_dpp v192,v192,v192 row_ror:1 row_mask:0xf bank_mask:0xf
v_mov_b32 v194,v192
s_nop 1
v_permlane16_swap_b32 v192,v194
v_add_f32 v192,v192,v194
v_mul_f32 v192,0x3b000000,v192
v_mov_b32 v194,v192
s_nop 1
v_permlane32_swap_b32 v192,v194
v_fma_f32 v194,-v192,v192,v194
v_add_f32 v192,s78,v192
v_max_f32 v194,0,v194
v_cvt_pk_bf16_f32 v194,v192,v194
v_lshlrev_b32 v192,16,v194
v_and_b32 v194,0xffff0000,v194
v_add_f32 v194,0x3727c5ac,v194
v_cvt_pk_bf16_f32 v194,v194,v194
v_and_b32 v194,0xffff0000,v194
v_sqrt_f32 v194,v194
v_pk_add_f32 v[184:185],v[200:201],v[192:193] op_sel_hi:[1,0] neg_lo:[0,1] neg_hi:[0,1]
v_pk_add_f32 v[186:187],v[202:203],v[192:193] op_sel_hi:[1,0] neg_lo:[0,1] neg_hi:[0,1]
v_pk_add_f32 v[188:189],v[204:205],v[192:193] op_sel_hi:[1,0] neg_lo:[0,1] neg_hi:[0,1]
v_pk_add_f32 v[190:191],v[206:207],v[192:193] op_sel_hi:[1,0] neg_lo:[0,1] neg_hi:[0,1]
v_cvt_pk_bf16_f32 v194,v194,v194
v_and_b32 v194,0xffff0000,v194
v_rcp_f32 v194,v194
v_cvt_pk_bf16_f32 v172,v184,v185
v_cvt_pk_bf16_f32 v173,v186,v187
v_cvt_pk_bf16_f32 v174,v188,v189
v_cvt_pk_bf16_f32 v175,v190,v191
v_lshlrev_b32 v184,16,v172
v_and_b32 v185,0xffff0000,v172
v_lshlrev_b32 v186,16,v173
v_and_b32 v187,0xffff0000,v173
v_lshlrev_b32 v188,16,v174
v_and_b32 v189,0xffff0000,v174
v_lshlrev_b32 v190,16,v175
v_and_b32 v191,0xffff0000,v175
v_pk_mul_f32 v[184:185],v[184:185],v[194:195] op_sel_hi:[1,0]
v_pk_mul_f32 v[186:187],v[186:187],v[194:195] op_sel_hi:[1,0]
v_pk_mul_f32 v[188:189],v[188:189],v[194:195] op_sel_hi:[1,0]
v_pk_mul_f32 v[190:191],v[190:191],v[194:195] op_sel_hi:[1,0]
v_cvt_pk_bf16_f32 v172,v184,v185
v_cvt_pk_bf16_f32 v173,v186,v187
v_cvt_pk_bf16_f32 v174,v188,v189
v_cvt_pk_bf16_f32 v175,v190,v191
v_lshlrev_b32 v176,16,v172
v_and_b32 v177,0xffff0000,v172
v_lshlrev_b32 v178,16,v173
v_and_b32 v179,0xffff0000,v173
v_lshlrev_b32 v180,16,v174
v_and_b32 v181,0xffff0000,v174
v_lshlrev_b32 v182,16,v175
v_and_b32 v183,0xffff0000,v175
v_pk_add_f32 v[200:201],v[200:201],v[176:177]
v_pk_add_f32 v[202:203],v[202:203],v[178:179]
v_pk_add_f32 v[204:205],v[204:205],v[180:181]
v_pk_add_f32 v[206:207],v[206:207],v[182:183]
v_cvt_pk_bf16_f32 v160,v200,v201
v_cvt_pk_bf16_f32 v161,v202,v203
v_cvt_pk_bf16_f32 v162,v204,v205
v_cvt_pk_bf16_f32 v163,v206,v207
buffer_store_dwordx4 v[160:163],v0,s[8:11],s20 offen sc1
v_lshlrev_b32 v200,16,v160
v_and_b32 v201,0xffff0000,v160
v_lshlrev_b32 v202,16,v161
v_and_b32 v203,0xffff0000,v161
v_lshlrev_b32 v204,16,v162
v_and_b32 v205,0xffff0000,v162
v_lshlrev_b32 v206,16,v163
v_and_b32 v207,0xffff0000,v163
v_readfirstlane_b32 s78,v200
s_nop 1
v_pk_add_f32 v[184:185],v[200:201],s[78:79] op_sel_hi:[1,0] neg_lo:[0,1] neg_hi:[0,1]
v_pk_add_f32 v[186:187],v[202:203],s[78:79] op_sel_hi:[1,0] neg_lo:[0,1] neg_hi:[0,1]
v_pk_add_f32 v[188:189],v[204:205],s[78:79] op_sel_hi:[1,0] neg_lo:[0,1] neg_hi:[0,1]
v_pk_add_f32 v[190:191],v[206:207],s[78:79] op_sel_hi:[1,0] neg_lo:[0,1] neg_hi:[0,1]
v_pk_add_f32 v[192:193],v[184:185],v[186:187]
v_pk_mul_f32 v[194:195],v[184:185],v[184:185]
v_pk_add_f32 v[196:197],v[188:189],v[190:191]
v_pk_fma_f32 v[194:195],v[186:187],v[186:187],v[194:195]
v_pk_add_f32 v[192:193],v[192:193],v[196:197]
v_pk_fma_f32 v[194:195],v[188:189],v[188:189],v[194:195]
v_add_f32 v192,v192,v193
v_pk_fma_f32 v[194:195],v[190:191],v[190:191],v[194:195]
v_add_f32 v194,v194,v195
s_nop 1
v_permlane32_swap_b32 v192,v194
v_add_f32 v192,v192,v194
s_nop 1
v_add_f32_dpp v192,v192,v192 row_ror:8 row_mask:0xf bank_mask:0xf
s_nop 1
v_add_f32_dpp v192,v192,v192 row_ror:4 row_mask:0xf bank_mask:0xf
s_nop 1
v_add_f32_dpp v192,v192,v192 row_ror:2 row_mask:0xf bank_mask:0xf
s_nop 1
v_add_f32_dpp v192,v192,v192 row_ror:1 row_mask:0xf bank_mask:0xf
v_mov_b32 v194,v192
s_nop 1
v_permlane16_swap_b32 v192,v194
v_add_f32 v192,v192,v194
v_mul_f32 v192,0x3b000000,v192
v_mov_b32 v194,v192
s_nop 1
v_permlane32_swap_b32 v192,v194
v_fma_f32 v194,-v192,v192,v194
v_add_f32 v192,s78,v192
v_max_f32 v194,0,v194
v_cvt_pk_bf16_f32 v194,v192,v194
v_lshlrev_b32 v192,16,v194
v_and_b32 v194,0xffff0000,v194
v_add_f32 v194,0x3727c5ac,v194
v_cvt_pk_bf16_f32 v194,v194,v194
v_and_b32 v194,0xffff0000,v194
v_sqrt_f32 v194,v194
v_pk_add_f32 v[184:185],v[200:201],v[192:193] op_sel_hi:[1,0] neg_lo:[0,1] neg_hi:[0,1]
v_pk_add_f32 v[186:187],v[202:203],v[192:193] op_sel_hi:[1,0] neg_lo:[0,1] neg_hi:[0,1]
v_pk_add_f32 v[188:189],v[204:205],v[192:193] op_sel_hi:[1,0] neg_lo:[0,1] neg_hi:[0,1]
v_pk_add_f32 v[190:191],v[206:207],v[192:193] op_sel_hi:[1,0] neg_lo:[0,1] neg_hi:[0,1]
v_cvt_pk_bf16_f32 v194,v194,v194
v_and_b32 v194,0xffff0000,v194
v_rcp_f32 v194,v194
v_cvt_pk_bf16_f32 v164,v184,v185
v_cvt_pk_bf16_f32 v165,v186,v187
v_cvt_pk_bf16_f32 v166,v188,v189
v_cvt_pk_bf16_f32 v167,v190,v191
v_lshlrev_b32 v184,16,v164
v_and_b32 v185,0xffff0000,v164
v_lshlrev_b32 v186,16,v165
v_and_b32 v187,0xffff0000,v165
v_lshlrev_b32 v188,16,v166
v_and_b32 v189,0xffff0000,v166
v_lshlrev_b32 v190,16,v167
v_and_b32 v191,0xffff0000,v167
v_pk_mul_f32 v[184:185],v[184:185],v[194:195] op_sel_hi:[1,0]
v_pk_mul_f32 v[186:187],v[186:187],v[194:195] op_sel_hi:[1,0]
v_pk_mul_f32 v[188:189],v[188:189],v[194:195] op_sel_hi:[1,0]
v_pk_mul_f32 v[190:191],v[190:191],v[194:195] op_sel_hi:[1,0]
v_cvt_pk_bf16_f32 v164,v184,v185
v_cvt_pk_bf16_f32 v165,v186,v187
v_cvt_pk_bf16_f32 v166,v188,v189
v_cvt_pk_bf16_f32 v167,v190,v191
s_add_u32 s20,s19,2097152
buffer_store_dwordx4 v[164:167],v0,s[8:11],s20 offen sc1
v_mov_b32 v20,1
s_lshl_b32 s73,s51,13
s_lshl2_add_u32 s73,s68,s73
s_add_u32 s73,s73,10487552
s_branch L_aa_325
L_ar_359:
ds_read_b128 v[160:163],v23
ds_read_b128 v[164:167],v23 offset:16
v_lshlrev_b32 v200,16,v224
v_and_b32 v201,0xffff0000,v224
v_lshlrev_b32 v202,16,v225
v_and_b32 v203,0xffff0000,v225
v_lshlrev_b32 v204,16,v226
v_and_b32 v205,0xffff0000,v226
v_lshlrev_b32 v206,16,v227
v_and_b32 v207,0xffff0000,v227
s_lshl_b32 s18,s51,5
s_add_u32 s18,s18,s68
s_lshl_b32 s19,s18,10
s_add_u32 s20,s19,4194304
s_waitcnt lgkmcnt(0)
v_cvt_pk_bf16_f32 v168,v160,v161
v_cvt_pk_bf16_f32 v169,v162,v163
v_cvt_pk_bf16_f32 v170,v164,v165
v_cvt_pk_bf16_f32 v171,v166,v167
v_lshlrev_b32 v160,16,v168
v_and_b32 v161,0xffff0000,v168
v_lshlrev_b32 v162,16,v169
v_and_b32 v163,0xffff0000,v169
v_lshlrev_b32 v164,16,v170
v_and_b32 v165,0xffff0000,v170
v_lshlrev_b32 v166,16,v171
v_and_b32 v167,0xffff0000,v171
v_pk_add_f32 v[200:201],v[200:201],v[160:161]
v_pk_add_f32 v[202:203],v[202:203],v[162:163]
v_pk_add_f32 v[204:205],v[204:205],v[164:165]
v_pk_add_f32 v[206:207],v[206:207],v[166:167]
v_cvt_pk_bf16_f32 v168,v200,v201
v_cvt_pk_bf16_f32 v169,v202,v203
v_cvt_pk_bf16_f32 v170,v204,v205
v_cvt_pk_bf16_f32 v171,v206,v207
buffer_store_dwordx4 v[168:171],v0,s[8:11],s20 offen sc1
v_lshlrev_b32 v200,16,v168
v_and_b32 v201,0xffff0000,v168
v_lshlrev_b32 v202,16,v169
v_and_b32 v203,0xffff0000,v169
v_lshlrev_b32 v204,16,v170
v_and_b32 v205,0xffff0000,v170
v_lshlrev_b32 v206,16,v171
v_and_b32 v207,0xffff0000,v171
v_readfirstlane_b32 s78,v200
s_nop 1
v_pk_add_f32 v[184:185],v[200:201],s[78:79] op_sel_hi:[1,0] neg_lo:[0,1] neg_hi:[0,1]
v_pk_add_f32 v[186:187],v[202:203],s[78:79] op_sel_hi:[1,0] neg_lo:[0,1] neg_hi:[0,1]
v_pk_add_f32 v[188:189],v[204:205],s[78:79] op_sel_hi:[1,0] neg_lo:[0,1] neg_hi:[0,1]
v_pk_add_f32 v[190:191],v[206:207],s[78:79] op_sel_hi:[1,0] neg_lo:[0,1] neg_hi:[0,1]
v_pk_add_f32 v[192:193],v[184:185],v[186:187]
v_pk_mul_f32 v[194:195],v[184:185],v[184:185]
v_pk_add_f32 v[196:197],v[188:189],v[190:191]
v_pk_fma_f32 v[194:195],v[186:187],v[186:187],v[194:195]
v_pk_add_f32 v[192:193],v[192:193],v[196:197]
v_pk_fma_f32 v[194:195],v[188:189],v[188:189],v[194:195]
v_add_f32 v192,v192,v193
v_pk_fma_f32 v[194:195],v[190:191],v[190:191],v[194:195]
v_add_f32 v194,v194,v195
s_nop 1
v_permlane32_swap_b32 v192,v194
v_add_f32 v192,v192,v194
s_nop 1
v_add_f32_dpp v192,v192,v192 row_ror:8 row_mask:0xf bank_mask:0xf
s_nop 1
v_add_f32_dpp v192,v192,v192 row_ror:4 row_mask:0xf bank_mask:0xf
s_nop 1
v_add_f32_dpp v192,v192,v192 row_ror:2 row_mask:0xf bank_mask:0xf
s_nop 1
v_add_f32_dpp v192,v192,v192 row_ror:1 row_mask:0xf bank_mask:0xf
v_mov_b32 v194,v192
s_nop 1
v_permlane16_swap_b32 v192,v194
v_add_f32 v192,v192,v194
v_mul_f32 v192,0x3b000000,v192
v_mov_b32 v194,v192
s_nop 1
v_permlane32_swap_b32 v192,v194
v_fma_f32 v194,-v192,v192,v194
v_add_f32 v192,s78,v192
v_max_f32 v194,0,v194
v_cvt_pk_bf16_f32 v194,v192,v194
v_lshlrev_b32 v192,16,v194
v_and_b32 v194,0xffff0000,v194
v_add_f32 v194,0x3727c5ac,v194
v_cvt_pk_bf16_f32 v194,v194,v194
v_and_b32 v194,0xffff0000,v194
v_sqrt_f32 v194,v194
v_pk_add_f32 v[184:185],v[200:201],v[192:193] op_sel_hi:[1,0] neg_lo:[0,1] neg_hi:[0,1]
v_pk_add_f32 v[186:187],v[202:203],v[192:193] op_sel_hi:[1,0] neg_lo:[0,1] neg_hi:[0,1]
v_pk_add_f32 v[188:189],v[204:205],v[192:193] op_sel_hi:[1,0] neg_lo:[0,1] neg_hi:[0,1]
v_pk_add_f32 v[190:191],v[206:207],v[192:193] op_sel_hi:[1,0] neg_lo:[0,1] neg_hi:[0,1]
v_cvt_pk_bf16_f32 v194,v194,v194
v_and_b32 v194,0xffff0000,v194
v_rcp_f32 v194,v194
v_cvt_pk_bf16_f32 v172,v184,v185
v_cvt_pk_bf16_f32 v173,v186,v187
v_cvt_pk_bf16_f32 v174,v188,v189
v_cvt_pk_bf16_f32 v175,v190,v191
v_lshlrev_b32 v184,16,v172
v_and_b32 v185,0xffff0000,v172
v_lshlrev_b32 v186,16,v173
v_and_b32 v187,0xffff0000,v173
v_lshlrev_b32 v188,16,v174
v_and_b32 v189,0xffff0000,v174
v_lshlrev_b32 v190,16,v175
v_and_b32 v191,0xffff0000,v175
v_pk_mul_f32 v[184:185],v[184:185],v[194:195] op_sel_hi:[1,0]
v_pk_mul_f32 v[186:187],v[186:187],v[194:195] op_sel_hi:[1,0]
v_pk_mul_f32 v[188:189],v[188:189],v[194:195] op_sel_hi:[1,0]
v_pk_mul_f32 v[190:191],v[190:191],v[194:195] op_sel_hi:[1,0]
v_cvt_pk_bf16_f32 v172,v184,v185
v_cvt_pk_bf16_f32 v173,v186,v187
v_cvt_pk_bf16_f32 v174,v188,v189
v_cvt_pk_bf16_f32 v175,v190,v191
v_lshlrev_b32 v176,16,v172
v_and_b32 v177,0xffff0000,v172
v_lshlrev_b32 v178,16,v173
v_and_b32 v179,0xffff0000,v173
v_lshlrev_b32 v180,16,v174
v_and_b32 v181,0xffff0000,v174
v_lshlrev_b32 v182,16,v175
v_and_b32 v183,0xffff0000,v175
v_pk_mul_f32 v[236:237],v[176:177],v[228:229]
v_pk_fma_f32 v[236:237],v[178:179],v[230:231],v[236:237]
v_pk_fma_f32 v[236:237],v[180:181],v[232:233],v[236:237]
v_pk_fma_f32 v[236:237],v[182:183],v[234:235],v[236:237]
v_add_f32 v236,v236,v237
s_nop 1
v_add_f32_dpp v236,v236,v236 row_ror:8 row_mask:0xf bank_mask:0xf
s_nop 1
v_add_f32_dpp v236,v236,v236 row_ror:4 row_mask:0xf bank_mask:0xf
s_nop 1
v_add_f32_dpp v236,v236,v236 row_ror:2 row_mask:0xf bank_mask:0xf
s_nop 1
v_add_f32_dpp v236,v236,v236 row_ror:1 row_mask:0xf bank_mask:0xf
v_mov_b32 v237,v236
s_nop 1
v_permlane16_swap_b32 v236,v237
v_add_f32 v236,v236,v237
v_mov_b32 v237,v236
s_nop 1
v_permlane32_swap_b32 v236,v237
v_add_f32 v236,v236,v237
v_cvt_pk_bf16_f32 v236,v236,v236
v_and_b32 v236,0xffff0000,v236
v_ashrrev_i32 v237,31,v236
v_or_b32 v237,0x80000000,v237
v_xor_b32 v236,v236,v237
v_and_b32 v236,0xffff0000,v236
s_sub_u32 s20,4095,s18
v_or_b32 v20,s20,v236
s_lshl_b32 s20,s51,13
s_lshl2_add_u32 s20,s68,s20
s_add_u32 s20,s20,10485760
buffer_store_dword v20,v254,s[8:11],s20 offen sc1
s_branch L_aa_325
L_ar_360:
s_bitcmp1_b32 s46,0
s_cbranch_scc1 L_aa_325
ds_read_b128 v[160:163],v23
ds_read_b128 v[164:167],v23 offset:16
v_lshlrev_b32 v200,16,v224
v_and_b32 v201,0xffff0000,v224
v_lshlrev_b32 v202,16,v225
v_and_b32 v203,0xffff0000,v225
v_lshlrev_b32 v204,16,v226
v_and_b32 v205,0xffff0000,v226
v_lshlrev_b32 v206,16,v227
v_and_b32 v207,0xffff0000,v227
v_readfirstlane_b32 s22,v246
s_cmp_eq_u32 s22,0
s_cbranch_scc1 L_ag_361
L_agb_362:
s_lshl_b32 s18,s51,5
s_add_u32 s18,s18,s68
s_lshl_b32 s19,s18,10
s_add_u32 s20,s19,6291456
s_waitcnt lgkmcnt(0)
v_cvt_pk_bf16_f32 v168,v160,v161
v_cvt_pk_bf16_f32 v169,v162,v163
v_cvt_pk_bf16_f32 v170,v164,v165
v_cvt_pk_bf16_f32 v171,v166,v167
v_lshlrev_b32 v160,16,v168
v_and_b32 v161,0xffff0000,v168
v_lshlrev_b32 v162,16,v169
v_and_b32 v163,0xffff0000,v169
v_lshlrev_b32 v164,16,v170
v_and_b32 v165,0xffff0000,v170
v_lshlrev_b32 v166,16,v171
v_and_b32 v167,0xffff0000,v171
v_pk_add_f32 v[200:201],v[200:201],v[160:161]
v_pk_add_f32 v[202:203],v[202:203],v[162:163]
v_pk_add_f32 v[204:205],v[204:205],v[164:165]
v_pk_add_f32 v[206:207],v[206:207],v[166:167]
v_cvt_pk_bf16_f32 v168,v200,v201
v_cvt_pk_bf16_f32 v169,v202,v203
v_cvt_pk_bf16_f32 v170,v204,v205
v_cvt_pk_bf16_f32 v171,v206,v207
buffer_store_dwordx4 v[168:171],v0,s[8:11],s20 offen sc1
v_lshlrev_b32 v200,16,v168
v_and_b32 v201,0xffff0000,v168
v_lshlrev_b32 v202,16,v169
v_and_b32 v203,0xffff0000,v169
v_lshlrev_b32 v204,16,v170
v_and_b32 v205,0xffff0000,v170
v_lshlrev_b32 v206,16,v171
v_and_b32 v207,0xffff0000,v171
v_readfirstlane_b32 s78,v200
s_nop 1
v_pk_add_f32 v[184:185],v[200:201],s[78:79] op_sel_hi:[1,0] neg_lo:[0,1] neg_hi:[0,1]
v_pk_add_f32 v[186:187],v[202:203],s[78:79] op_sel_hi:[1,0] neg_lo:[0,1] neg_hi:[0,1]
v_pk_add_f32 v[188:189],v[204:205],s[78:79] op_sel_hi:[1,0] neg_lo:[0,1] neg_hi:[0,1]
v_pk_add_f32 v[190:191],v[206:207],s[78:79] op_sel_hi:[1,0] neg_lo:[0,1] neg_hi:[0,1]
v_pk_add_f32 v[192:193],v[184:185],v[186:187]
v_pk_mul_f32 v[194:195],v[184:185],v[184:185]
v_pk_add_f32 v[196:197],v[188:189],v[190:191]
v_pk_fma_f32 v[194:195],v[186:187],v[186:187],v[194:195]
v_pk_add_f32 v[192:193],v[192:193],v[196:197]
v_pk_fma_f32 v[194:195],v[188:189],v[188:189],v[194:195]
v_add_f32 v192,v192,v193
v_pk_fma_f32 v[194:195],v[190:191],v[190:191],v[194:195]
v_add_f32 v194,v194,v195
s_nop 1
v_permlane32_swap_b32 v192,v194
v_add_f32 v192,v192,v194
s_nop 1
v_add_f32_dpp v192,v192,v192 row_ror:8 row_mask:0xf bank_mask:0xf
s_nop 1
v_add_f32_dpp v192,v192,v192 row_ror:4 row_mask:0xf bank_mask:0xf
s_nop 1
v_add_f32_dpp v192,v192,v192 row_ror:2 row_mask:0xf bank_mask:0xf
s_nop 1
v_add_f32_dpp v192,v192,v192 row_ror:1 row_mask:0xf bank_mask:0xf
v_mov_b32 v194,v192
s_nop 1
v_permlane16_swap_b32 v192,v194
v_add_f32 v192,v192,v194
v_mul_f32 v192,0x3b000000,v192
v_mov_b32 v194,v192
s_nop 1
v_permlane32_swap_b32 v192,v194
v_fma_f32 v194,-v192,v192,v194
v_add_f32 v192,s78,v192
v_max_f32 v194,0,v194
v_cvt_pk_bf16_f32 v194,v192,v194
v_lshlrev_b32 v192,16,v194
v_and_b32 v194,0xffff0000,v194
v_add_f32 v194,0x3727c5ac,v194
v_cvt_pk_bf16_f32 v194,v194,v194
v_and_b32 v194,0xffff0000,v194
v_sqrt_f32 v194,v194
v_pk_add_f32 v[184:185],v[200:201],v[192:193] op_sel_hi:[1,0] neg_lo:[0,1] neg_hi:[0,1]
v_pk_add_f32 v[186:187],v[202:203],v[192:193] op_sel_hi:[1,0] neg_lo:[0,1] neg_hi:[0,1]
v_pk_add_f32 v[188:189],v[204:205],v[192:193] op_sel_hi:[1,0] neg_lo:[0,1] neg_hi:[0,1]
v_pk_add_f32 v[190:191],v[206:207],v[192:193] op_sel_hi:[1,0] neg_lo:[0,1] neg_hi:[0,1]
v_cvt_pk_bf16_f32 v194,v194,v194
v_and_b32 v194,0xffff0000,v194
v_rcp_f32 v194,v194
v_cvt_pk_bf16_f32 v172,v184,v185
v_cvt_pk_bf16_f32 v173,v186,v187
v_cvt_pk_bf16_f32 v174,v188,v189
v_cvt_pk_bf16_f32 v175,v190,v191
v_lshlrev_b32 v184,16,v172
v_and_b32 v185,0xffff0000,v172
v_lshlrev_b32 v186,16,v173
v_and_b32 v187,0xffff0000,v173
v_lshlrev_b32 v188,16,v174
v_and_b32 v189,0xffff0000,v174
v_lshlrev_b32 v190,16,v175
v_and_b32 v191,0xffff0000,v175
v_pk_mul_f32 v[184:185],v[184:185],v[194:195] op_sel_hi:[1,0]
v_pk_mul_f32 v[186:187],v[186:187],v[194:195] op_sel_hi:[1,0]
v_pk_mul_f32 v[188:189],v[188:189],v[194:195] op_sel_hi:[1,0]
v_pk_mul_f32 v[190:191],v[190:191],v[194:195] op_sel_hi:[1,0]
v_cvt_pk_bf16_f32 v172,v184,v185
v_cvt_pk_bf16_f32 v173,v186,v187
v_cvt_pk_bf16_f32 v174,v188,v189
v_cvt_pk_bf16_f32 v175,v190,v191
v_lshlrev_b32 v176,16,v172
v_and_b32 v177,0xffff0000,v172
v_lshlrev_b32 v178,16,v173
v_and_b32 v179,0xffff0000,v173
v_lshlrev_b32 v180,16,v174
v_and_b32 v181,0xffff0000,v174
v_lshlrev_b32 v182,16,v175
v_and_b32 v183,0xffff0000,v175
v_pk_add_f32 v[200:201],v[200:201],v[176:177]
v_pk_add_f32 v[202:203],v[202:203],v[178:179]
v_pk_add_f32 v[204:205],v[204:205],v[180:181]
v_pk_add_f32 v[206:207],v[206:207],v[182:183]
v_cvt_pk_bf16_f32 v160,v200,v201
v_cvt_pk_bf16_f32 v161,v202,v203
v_cvt_pk_bf16_f32 v162,v204,v205
v_cvt_pk_bf16_f32 v163,v206,v207
buffer_store_dwordx4 v[160:163],v0,s[12:15],s19 offen sc1
v_pk_mul_f32 v[236:237],v[176:177],v[228:229]
v_pk_fma_f32 v[236:237],v[178:179],v[230:231],v[236:237]
v_pk_fma_f32 v[236:237],v[180:181],v[232:233],v[236:237]
v_pk_fma_f32 v[236:237],v[182:183],v[234:235],v[236:237]
v_add_f32 v236,v236,v237
s_nop 1
v_add_f32_dpp v236,v236,v236 row_ror:8 row_mask:0xf bank_mask:0xf
s_nop 1
v_add_f32_dpp v236,v236,v236 row_ror:4 row_mask:0xf bank_mask:0xf
s_nop 1
v_add_f32_dpp v236,v236,v236 row_ror:2 row_mask:0xf bank_mask:0xf
s_nop 1
v_add_f32_dpp v236,v236,v236 row_ror:1 row_mask:0xf bank_mask:0xf
v_mov_b32 v237,v236
s_nop 1
v_permlane16_swap_b32 v236,v237
v_add_f32 v236,v236,v237
v_mov_b32 v237,v236
s_nop 1
v_permlane32_swap_b32 v236,v237
v_add_f32 v236,v236,v237
v_cvt_pk_bf16_f32 v236,v236,v236
v_and_b32 v236,0xffff0000,v236
v_ashrrev_i32 v237,31,v236
v_or_b32 v237,0x80000000,v237
v_xor_b32 v236,v236,v237
v_and_b32 v236,0xffff0000,v236
s_sub_u32 s20,4095,s18
v_or_b32 v20,s20,v236
s_lshl_b32 s73,s51,13
s_lshl2_add_u32 s73,s68,s73
s_add_u32 s73,s73,10485760
s_add_u32 s73,s73,s86
L_aa_325:
s_cmp_eq_u32 s27,1
s_cbranch_scc1 L_ad_363
s_cmp_eq_u32 s27,0
s_cbranch_scc1 L_aa_326
s_cmp_eq_u32 s27,4
s_cbranch_scc1 L_a4_346
s_cmp_ge_u32 s77,64
s_cbranch_scc1 L_aa_329
L_aa_327:
s_waitcnt vmcnt(0)
buffer_store_dword v20,off,s[8:11],s73 sc1
s_mov_b32 s73,0x80000000
v_mov_b32 v18,0
s_mov_b32 s27,0
L_aw_364:
v_cmp_eq_u32 vcc,0,v18
s_cbranch_vccz L_awd_365
buffer_load_dword v18,v19,s[8:11],0 offen sc1
s_sub_u32 s49,s49,1
s_cbranch_scc1 L_abort2
s_waitcnt vmcnt(0)
s_branch L_aw_364
L_awd_365:
L_a3_366:
s_mov_b32 s64,s70
s_mov_b32 s65,s71
s_add_u32 s64,s64,s28
s_add_u32 s65,s65,s29
s_xor_b32 s58,s67,s40
s_xor_b32 s57,s67,s41
s_add_u32 m0,s58,0
s_nop 0
buffer_load_dwordx4 v0,s[8:11],s64 offen offset:0 sc1 lds
buffer_load_dwordx4 v0,s[8:11],s64 offen offset:1024 sc1 lds
buffer_load_dwordx4 v0,s[8:11],s64 offen offset:2048 sc1 lds
buffer_load_dwordx4 v0,s[8:11],s64 offen offset:3072 sc1 lds
s_add_u32 m0,s58,4096
s_add_u32 s64,s64,4096
buffer_load_dwordx4 v0,s[8:11],s64 offen offset:0 sc1 lds
buffer_load_dwordx4 v0,s[8:11],s64 offen offset:1024 sc1 lds
buffer_load_dwordx4 v0,s[8:11],s64 offen offset:2048 sc1 lds
buffer_load_dwordx4 v0,s[8:11],s64 offen offset:3072 sc1 lds
s_add_u32 m0,s58,8192
s_add_u32 s64,s64,4096
buffer_load_dwordx4 v0,s[8:11],s64 offen offset:0 sc1 lds
buffer_load_dwordx4 v0,s[8:11],s64 offen offset:1024 sc1 lds
buffer_load_dwordx4 v0,s[8:11],s64 offen offset:2048 sc1 lds
buffer_load_dwordx4 v0,s[8:11],s64 offen offset:3072 sc1 lds
s_add_u32 m0,s57,24576
s_nop 0
buffer_load_dwordx4 v0,s[8:11],s65 offen offset:0 sc1 lds
buffer_load_dwordx4 v0,s[8:11],s65 offen offset:1024 sc1 lds
v_lshrrev_b32 v244,4,v1
s_sub_u32 s56,s77,7
v_add_u32 v244,s56,v244
v_max_i32 v244,0,v244
v_lshl_add_u32 v244,v244,13,v21
buffer_load_dwordx2 v[242:243],v244,s[8:11],0 offen sc1
s_waitcnt vmcnt(0) lgkmcnt(0)
s_barrier
s_xor_b32 s67,s67,65536
s_and_b32 s56,s50,2048
s_lshl_b32 s56,s56,4
s_add_u32 s56,s56,s67
v_add_u32 v2,s56,v0
s_and_b32 s56,s50,1024
s_lshl_b32 s56,s56,2
v_add_u32 v238,s56,v2
s_mov_b32 s76,s71
s_mov_b32 s53,s77
ds_read_b128 v[24:27],v238 offset:16384
ds_read_b128 v[40:43],v2 offset:0
ds_read_b128 v[56:59],v2 offset:4096
ds_read_b128 v[28:31],v238 offset:17408
ds_read_b128 v[44:47],v2 offset:1024
ds_read_b128 v[60:63],v2 offset:5120
ds_read_b128 v[32:35],v238 offset:18432
ds_read_b128 v[48:51],v2 offset:2048
ds_read_b128 v[64:67],v2 offset:6144
ds_read_b128 v[36:39],v238 offset:19456
ds_read_b128 v[52:55],v2 offset:3072
ds_read_b128 v[68:71],v2 offset:7168
s_waitcnt lgkmcnt(9)
v_mfma_f32_16x16x32_bf16 v[128:131],v[40:43],v[24:27],v[8:11]
ds_read_b128 v[72:75],v2 offset:24576
v_mfma_f32_16x16x32_bf16 v[132:135],v[56:59],v[24:27],v[12:15]
ds_read_b128 v[76:79],v2 offset:25600
s_waitcnt lgkmcnt(8)
v_mfma_f32_16x16x32_bf16 v[128:131],v[44:47],v[28:31],v[128:131]
ds_read_b128 v[80:83],v2 offset:26624
v_mfma_f32_16x16x32_bf16 v[132:135],v[60:63],v[28:31],v[132:135]
ds_read_b128 v[84:87],v2 offset:27648
s_waitcnt lgkmcnt(7)
v_mfma_f32_16x16x32_bf16 v[128:131],v[48:51],v[32:35],v[128:131]
ds_read_b128 v[88:91],v2 offset:8192
v_mfma_f32_16x16x32_bf16 v[132:135],v[64:67],v[32:35],v[132:135]
ds_read_b128 v[92:95],v2 offset:9216
s_waitcnt lgkmcnt(6)
v_mfma_f32_16x16x32_bf16 v[128:131],v[52:55],v[36:39],v[128:131]
ds_read_b128 v[96:99],v2 offset:10240
v_mfma_f32_16x16x32_bf16 v[132:135],v[68:71],v[36:39],v[132:135]
ds_read_b128 v[100:103],v2 offset:11264
s_waitcnt lgkmcnt(4)
s_mov_b32 vcc_lo,0x33333333
s_mov_b32 vcc_hi,0x33333333
v_mfma_f32_16x16x32_bf16 v[136:139],v[72:75],v[24:27],0
ds_read_b128 v[104:107],v2 offset:12288
v_max3_u32 v238,v72,v73,v74
v_max3_u32 v238,v74,v75,v238
v_cndmask_b32_dpp v120,v72,v74,vcc quad_perm:[0,1,0,1] row_mask:0xf bank_mask:0xf
v_cndmask_b32_dpp v121,v73,v75,vcc quad_perm:[0,1,0,1] row_mask:0xf bank_mask:0xf
v_mfma_f32_16x16x32_bf16 v[136:139],v[76:79],v[28:31],v[136:139]
ds_read_b128 v[108:111],v2 offset:13312
v_max3_u32 v238,v76,v77,v238
v_max3_u32 v238,v78,v79,v238
v_cndmask_b32_dpp v122,v76,v78,vcc quad_perm:[0,1,0,1] row_mask:0xf bank_mask:0xf
v_cndmask_b32_dpp v123,v77,v79,vcc quad_perm:[0,1,0,1] row_mask:0xf bank_mask:0xf
v_mfma_f32_16x16x32_bf16 v[136:139],v[80:83],v[32:35],v[136:139]
ds_read_b128 v[112:115],v2 offset:14336
v_max3_u32 v238,v80,v81,v238
v_max3_u32 v238,v82,v83,v238
v_cndmask_b32_dpp v124,v80,v82,vcc quad_perm:[0,1,0,1] row_mask:0xf bank_mask:0xf
v_cndmask_b32_dpp v125,v81,v83,vcc quad_perm:[0,1,0,1] row_mask:0xf bank_mask:0xf
v_mfma_f32_16x16x32_bf16 v[136:139],v[84:87],v[36:39],v[136:139]
ds_read_b128 v[116:119],v2 offset:15360
v_max3_u32 v238,v84,v85,v238
v_max3_u32 v238,v86,v87,v238
v_cndmask_b32_dpp v126,v84,v86,vcc quad_perm:[0,1,0,1] row_mask:0xf bank_mask:0xf
v_cndmask_b32_dpp v127,v85,v87,vcc quad_perm:[0,1,0,1] row_mask:0xf bank_mask:0xf
v_cmp_eq_u32 vcc,-1,v238
s_waitcnt lgkmcnt(0)
s_cmp_eq_u32 s30,0
s_cbranch_scc1 L_aa_328
s_cmp_lg_u32 s86,1536
s_cbranch_scc1 L_ae_367
s_mov_b32 s77,s35
s_mov_b32 s30,0
s_lshl_b32 s56,s77,5
s_add_u32 s56,s56,s68
s_mul_i32 s70,s56,24576
s_lshl_b32 s71,s56,12
s_lshl_b32 s59,s77,13
s_lshl2_add_u32 s59,s68,s59
s_add_u32 s59,s59,10485760
s_buffer_load_dword s32,s[8:11],s59
s_mov_b32 s33,1
s_add_u32 s70,s70,100663296
s_add_u32 s71,s71,41943040
v_mov_b32 v19,s59
s_branch L_af_368
L_ae_367:
s_ff1_i32_b64 s77,s[84:85]
s_bitset0_b64 s[84:85],s77
s_min_u32 s77,s77,64
s_lshr_b32 s61,s55,5
s_lshl_b32 s56,s77,5
s_add_u32 s56,s56,s68
s_mul_i32 s70,s56,24576
s_lshl_b32 s71,s56,12
s_lshl_b32 s59,s77,13
s_lshl2_add_u32 s59,s68,s59
s_add_u32 s59,s59,10486144
s_cmp_lt_u32 s77,s61
s_cselect_b32 s57,0,16777216
s_mov_b32 s60,s59
s_buffer_load_dword s33,s[8:11],s60
s_add_u32 s71,s71,s57
s_add_u32 s71,s71,58720256
s_cmp_eq_u32 s77,s61
s_cselect_b32 s57,50331648,0
s_cselect_b32 s58,1536,0
s_add_u32 s59,s59,s58
s_buffer_load_dword s32,s[8:11],s59
s_add_u32 s70,s70,s57
s_add_u32 s70,s70,150994944
v_mov_b32 v19,s59
v_writelane_b32 v19,s60,1
L_af_368:
L_a4_346:
s_waitcnt vmcnt(0)
buffer_store_dword v20,off,s[8:11],s73 sc1
s_mov_b32 s73,0x80000000
v_max3_u32 v238,v72,v73,v74
v_max3_u32 v238,v74,v75,v238
v_max3_u32 v238,v76,v77,v238
v_max3_u32 v238,v78,v79,v238
v_max3_u32 v238,v80,v81,v238
v_max3_u32 v238,v82,v83,v238
v_max3_u32 v238,v84,v85,v238
v_max3_u32 v238,v86,v87,v238
v_cmp_eq_u32 vcc,-1,v238
s_cbranch_vccnz L_ac_369
L_acb_370:
v_max3_f32 v238,v128,v129,v130
v_max3_f32 v239,v131,v132,v133
v_max3_f32 v238,v134,v135,v238
v_max3_f32 v239,v138,v139,v239
v_max_f32 v238,v238,v239
v_max_f32 v239,v238,v239
v_pk_mul_f32 v[128:129],v[128:129],v[152:153] op_sel_hi:[1,0]
v_pk_mul_f32 v[130:131],v[130:131],v[152:153] op_sel_hi:[1,0]
v_permlane16_swap_b32 v238,v239
v_max_f32 v238,v238,v239
v_max_f32 v239,v238,v239
v_pk_mul_f32 v[132:133],v[132:133],v[152:153] op_sel_hi:[1,0]
v_pk_mul_f32 v[134:135],v[134:135],v[152:153] op_sel_hi:[1,0]
v_permlane32_swap_b32 v238,v239
v_max_f32 v238,v238,v239
v_mul_f32 v238,v152,v238
v_pk_mul_f32 v[138:139],v[138:139],v[152:153] op_sel_hi:[1,0]
v_pk_add_f32 v[128:129],v[128:129],v[238:239] op_sel_hi:[1,0] neg_lo:[0,1] neg_hi:[0,1]
v_pk_add_f32 v[130:131],v[130:131],v[238:239] op_sel_hi:[1,0] neg_lo:[0,1] neg_hi:[0,1]
v_pk_add_f32 v[132:133],v[132:133],v[238:239] op_sel_hi:[1,0] neg_lo:[0,1] neg_hi:[0,1]
v_pk_add_f32 v[134:135],v[134:135],v[238:239] op_sel_hi:[1,0] neg_lo:[0,1] neg_hi:[0,1]
v_pk_add_f32 v[138:139],v[138:139],v[238:239] op_sel_hi:[1,0] neg_lo:[0,1] neg_hi:[0,1]
v_exp_f32 v128,v128
v_exp_f32 v129,v129
v_exp_f32 v130,v130
v_exp_f32 v131,v131
v_exp_f32 v132,v132
v_exp_f32 v133,v133
v_exp_f32 v134,v134
v_exp_f32 v135,v135
v_exp_f32 v138,v138
v_exp_f32 v139,v139
v_pk_add_f32 v[148:149],v[128:129],v[130:131]
v_pk_add_f32 v[150:151],v[132:133],v[134:135]
v_pk_add_f32 v[148:149],v[148:149],v[138:139]
v_pk_add_f32 v[148:149],v[148:149],v[150:151]
v_add_f32 v150,v148,v149
v_add_f32 v151,v148,v149
s_nop 1
v_permlane16_swap_b32 v150,v151
v_add_f32 v148,v150,v151
v_add_f32 v149,v150,v151
s_nop 1
v_permlane32_swap_b32 v148,v149
v_add_f32 v148,v148,v149
v_rcp_f32 v148,v148
s_nop 0
v_pk_mul_f32 v[138:139],v[138:139],v[148:149] op_sel_hi:[1,0]
v_pk_mul_f32 v[128:129],v[128:129],v[148:149] op_sel_hi:[1,0]
v_pk_mul_f32 v[130:131],v[130:131],v[148:149] op_sel_hi:[1,0]
v_pk_mul_f32 v[132:133],v[132:133],v[148:149] op_sel_hi:[1,0]
v_pk_mul_f32 v[134:135],v[134:135],v[148:149] op_sel_hi:[1,0]
v_cvt_pk_bf16_f32 v144,v138,v139
v_cvt_pk_bf16_f32 v147,v138,v139
s_nop 0
v_mfma_f32_16x16x16_bf16 v[24:27],v[120:121],v[144:145],0
v_cvt_pk_bf16_f32 v140,v128,v129
v_mfma_f32_16x16x16_bf16 v[28:31],v[120:121],v[146:147],0
v_cvt_pk_bf16_f32 v141,v130,v131
v_mfma_f32_16x16x16_bf16 v[32:35],v[122:123],v[144:145],0
v_cvt_pk_bf16_f32 v142,v132,v133
v_mfma_f32_16x16x16_bf16 v[36:39],v[122:123],v[146:147],0
v_cvt_pk_bf16_f32 v143,v134,v135
v_mfma_f32_16x16x16_bf16 v[40:43],v[124:125],v[144:145],0
v_mfma_f32_16x16x16_bf16 v[44:47],v[124:125],v[146:147],0
v_mfma_f32_16x16x16_bf16 v[48:51],v[126:127],v[144:145],0
v_mfma_f32_16x16x16_bf16 v[52:55],v[126:127],v[146:147],0
v_mfma_f32_16x16x32_bf16 v[24:27],v[88:91],v[140:143],v[24:27]
v_mfma_f32_16x16x32_bf16 v[28:31],v[92:95],v[140:143],v[28:31]
v_mfma_f32_16x16x32_bf16 v[32:35],v[96:99],v[140:143],v[32:35]
v_mfma_f32_16x16x32_bf16 v[36:39],v[100:103],v[140:143],v[36:39]
v_cvt_pk_bf16_f32 v72,v24,v28
v_cvt_pk_bf16_f32 v73,v25,v29
v_mfma_f32_16x16x32_bf16 v[40:43],v[104:107],v[140:143],v[40:43]
v_cvt_pk_bf16_f32 v74,v26,v30
v_cvt_pk_bf16_f32 v75,v27,v31
v_mfma_f32_16x16x32_bf16 v[44:47],v[108:111],v[140:143],v[44:47]
ds_write_b128 v3,v[72:75] offset:0
v_cvt_pk_bf16_f32 v76,v32,v36
v_cvt_pk_bf16_f32 v77,v33,v37
v_mfma_f32_16x16x32_bf16 v[48:51],v[112:115],v[140:143],v[48:51]
v_cvt_pk_bf16_f32 v78,v34,v38
v_cvt_pk_bf16_f32 v79,v35,v39
v_mfma_f32_16x16x32_bf16 v[52:55],v[116:119],v[140:143],v[52:55]
ds_write_b128 v3,v[76:79] offset:1024
v_cvt_pk_bf16_f32 v80,v40,v44
v_cvt_pk_bf16_f32 v81,v41,v45
v_cvt_pk_bf16_f32 v82,v42,v46
v_cvt_pk_bf16_f32 v83,v43,v47
ds_write_b128 v3,v[80:83] offset:2048
s_nop 1
v_cvt_pk_bf16_f32 v84,v48,v52
v_cvt_pk_bf16_f32 v85,v49,v53
v_cvt_pk_bf16_f32 v86,v50,v54
v_cvt_pk_bf16_f32 v87,v51,v55
ds_write_b128 v3,v[84:87] offset:3072
s_waitcnt lgkmcnt(0)
s_barrier
L_ad_363:
s_mov_b32 s51,s53
s_mov_b32 s31,1
s_branch L_aa_320
L_aa_326:
s_waitcnt vmcnt(0)
buffer_store_dword v20,off,s[8:11],s73 sc1
s_mov_b32 s73,0x80000000
L_aa_328:
s_mov_b32 s51,s53
s_mov_b32 s31,0
s_add_u32 s35,s53,4
s_cmp_lt_u32 s53,4
s_cbranch_scc1 L_ab_371
s_cmp_ge_u32 s53,63
s_cbranch_scc1 L_am_373
L_aw_374:
v_min_u32 v239,v242,v243
v_cmp_eq_u32 vcc,0,v239
s_cbranch_vccz L_awd_375
s_sleep 4
buffer_load_dwordx2 v[242:243],v244,s[8:11],0 offen sc1
s_sub_u32 s49,s49,1
s_cbranch_scc1 L_abort2
s_waitcnt vmcnt(0)
s_branch L_aw_374
L_awd_375:
v_max_u32 v242,v242,v243
s_nop 1
v_max_u32_dpp v242,v242,v242 row_ror:8 row_mask:0xf bank_mask:0xf
s_nop 1
v_max_u32_dpp v242,v242,v242 row_ror:4 row_mask:0xf bank_mask:0xf
s_nop 1
v_max_u32_dpp v242,v242,v242 row_ror:2 row_mask:0xf bank_mask:0xf
s_nop 1
v_max_u32_dpp v242,v242,v242 row_ror:1 row_mask:0xf bank_mask:0xf
v_mov_b32 v243,v242
s_nop 1
v_permlane16_swap_b32 v242,v243
v_max_u32 v242,v242,v243
v_mov_b32 v243,v242
s_nop 1
v_permlane32_swap_b32 v242,v243
v_max_u32 v242,v242,v243
s_nop 0
v_readfirstlane_b32 s56,v242
v_readlane_b32 s57,v255,s53
s_max_u32 s75,s75,s56
s_bitcmp0_b64 s[42:43],s53
s_cbranch_scc1 L_ab_371
s_mov_b32 s77,s36
s_and_b32 s55,s75,0x7ff
s_sub_u32 s55,2047,s55
s_cmp_lt_u32 s75,s57
s_cselect_b32 s55,4095,s55
s_lshr_b32 s61,s55,5
s_mov_b32 s30,1
s_lshl_b32 s56,s77,5
s_add_u32 s56,s56,s68
s_mul_i32 s70,s56,24576
s_lshl_b32 s71,s56,12
s_lshl_b32 s59,s77,13
s_lshl2_add_u32 s59,s68,s59
s_add_u32 s59,s59,10486144
s_cmp_lt_u32 s77,s61
s_cselect_b32 s57,0,16777216
s_mov_b32 s60,s59
s_add_u32 s71,s71,s57
s_add_u32 s71,s71,58720256
s_cmp_eq_u32 s77,s61
s_cselect_b32 s57,50331648,0
s_cselect_b32 s58,1536,0
s_add_u32 s59,s59,s58
s_add_u32 s70,s70,s57
s_add_u32 s70,s70,150994944
v_mov_b32 v19,s59
v_writelane_b32 v19,s60,1
s_branch L_aj_372
L_ab_371:
s_mov_b32 s77,s35
s_mov_b32 s30,0
s_lshl_b32 s56,s77,5
s_add_u32 s56,s56,s68
s_mul_i32 s70,s56,24576
s_lshl_b32 s71,s56,12
s_lshl_b32 s59,s77,13
s_lshl2_add_u32 s59,s68,s59
s_add_u32 s59,s59,10485760
s_mov_b32 s33,1
s_add_u32 s70,s70,100663296
s_add_u32 s71,s71,41943040
v_mov_b32 v19,s59
L_aj_372:
buffer_load_dword v18,v19,s[8:11],0 offen sc1
s_waitcnt vmcnt(2)
s_mov_b32 vcc_lo,0x33333333
s_mov_b32 vcc_hi,0x33333333
v_mfma_f32_16x16x32_bf16 v[136:139],v[72:75],v[24:27],0
v_max3_u32 v238,v72,v73,v74
v_max3_u32 v238,v74,v75,v238
v_cndmask_b32_dpp v120,v72,v74,vcc quad_perm:[0,1,0,1] row_mask:0xf bank_mask:0xf
v_cndmask_b32_dpp v121,v73,v75,vcc quad_perm:[0,1,0,1] row_mask:0xf bank_mask:0xf
v_mfma_f32_16x16x32_bf16 v[136:139],v[76:79],v[28:31],v[136:139]
v_max3_u32 v238,v76,v77,v238
v_max3_u32 v238,v78,v79,v238
v_cndmask_b32_dpp v122,v76,v78,vcc quad_perm:[0,1,0,1] row_mask:0xf bank_mask:0xf
v_cndmask_b32_dpp v123,v77,v79,vcc quad_perm:[0,1,0,1] row_mask:0xf bank_mask:0xf
v_mfma_f32_16x16x32_bf16 v[136:139],v[80:83],v[32:35],v[136:139]
v_max3_u32 v238,v80,v81,v238
v_max3_u32 v238,v82,v83,v238
v_cndmask_b32_dpp v124,v80,v82,vcc quad_perm:[0,1,0,1] row_mask:0xf bank_mask:0xf
v_cndmask_b32_dpp v125,v81,v83,vcc quad_perm:[0,1,0,1] row_mask:0xf bank_mask:0xf
v_mfma_f32_16x16x32_bf16 v[136:139],v[84:87],v[36:39],v[136:139]
v_max3_u32 v238,v84,v85,v238
v_max3_u32 v238,v86,v87,v238
v_cndmask_b32_dpp v126,v84,v86,vcc quad_perm:[0,1,0,1] row_mask:0xf bank_mask:0xf
v_cndmask_b32_dpp v127,v85,v87,vcc quad_perm:[0,1,0,1] row_mask:0xf bank_mask:0xf
v_cmp_eq_u32 vcc,-1,v238
s_cbranch_vccz L_aa_331
L_aa_330:
buffer_load_dwordx4 v[72:75],v0,s[8:11],s76 offen offset:0 sc1
buffer_load_dwordx4 v[76:79],v0,s[8:11],s76 offen offset:1024 sc1
buffer_load_dwordx4 v[80:83],v0,s[8:11],s76 offen offset:2048 sc1
buffer_load_dwordx4 v[84:87],v0,s[8:11],s76 offen offset:3072 sc1
buffer_load_dword v18,v19,s[8:11],0 offen sc1
s_sub_u32 s49,s49,1
s_cbranch_scc1 L_abort2
s_mov_b32 vcc_lo,0x33333333
s_mov_b32 vcc_hi,0x33333333
s_waitcnt vmcnt(4)
v_mfma_f32_16x16x32_bf16 v[136:139],v[72:75],v[24:27],0
v_max3_u32 v238,v72,v73,v74
v_max3_u32 v238,v74,v75,v238
v_cndmask_b32_dpp v120,v72,v74,vcc quad_perm:[0,1,0,1] row_mask:0xf bank_mask:0xf
v_cndmask_b32_dpp v121,v73,v75,vcc quad_perm:[0,1,0,1] row_mask:0xf bank_mask:0xf
s_waitcnt vmcnt(3)
v_mfma_f32_16x16x32_bf16 v[136:139],v[76:79],v[28:31],v[136:139]
v_max3_u32 v238,v76,v77,v238
v_max3_u32 v238,v78,v79,v238
v_cndmask_b32_dpp v122,v76,v78,vcc quad_perm:[0,1,0,1] row_mask:0xf bank_mask:0xf
v_cndmask_b32_dpp v123,v77,v79,vcc quad_perm:[0,1,0,1] row_mask:0xf bank_mask:0xf
s_waitcnt vmcnt(2)
v_mfma_f32_16x16x32_bf16 v[136:139],v[80:83],v[32:35],v[136:139]
v_max3_u32 v238,v80,v81,v238
v_max3_u32 v238,v82,v83,v238
v_cndmask_b32_dpp v124,v80,v82,vcc quad_perm:[0,1,0,1] row_mask:0xf bank_mask:0xf
v_cndmask_b32_dpp v125,v81,v83,vcc quad_perm:[0,1,0,1] row_mask:0xf bank_mask:0xf
s_waitcnt vmcnt(1)
v_mfma_f32_16x16x32_bf16 v[136:139],v[84:87],v[36:39],v[136:139]
v_max3_u32 v238,v84,v85,v238
v_max3_u32 v238,v86,v87,v238
v_cndmask_b32_dpp v126,v84,v86,vcc quad_perm:[0,1,0,1] row_mask:0xf bank_mask:0xf
v_cndmask_b32_dpp v127,v85,v87,vcc quad_perm:[0,1,0,1] row_mask:0xf bank_mask:0xf
v_cmp_eq_u32 vcc,-1,v238
s_cbranch_vccnz L_aa_330
L_aa_331:
s_cmp_lg_u32 s27,3
s_cbranch_scc1 L_ai_376
v_max3_f32 v238,v128,v129,v130
v_max3_f32 v239,v131,v132,v133
v_max3_f32 v238,v134,v135,v238
v_max3_f32 v239,v138,v139,v239
v_max_f32 v238,v238,v239
v_max_f32 v239,v238,v239
v_pk_mul_f32 v[128:129],v[128:129],v[152:153] op_sel_hi:[1,0]
v_pk_mul_f32 v[130:131],v[130:131],v[152:153] op_sel_hi:[1,0]
v_permlane16_swap_b32 v238,v239
v_max_f32 v238,v238,v239
v_max_f32 v239,v238,v239
v_pk_mul_f32 v[132:133],v[132:133],v[152:153] op_sel_hi:[1,0]
v_pk_mul_f32 v[134:135],v[134:135],v[152:153] op_sel_hi:[1,0]
v_permlane32_swap_b32 v238,v239
v_max_f32 v238,v238,v239
v_mul_f32 v238,v152,v238
v_pk_mul_f32 v[138:139],v[138:139],v[152:153] op_sel_hi:[1,0]
buffer_load_dword v17,v16,s[8:11],s87 offen sc1
v_pk_add_f32 v[128:129],v[128:129],v[238:239] op_sel_hi:[1,0] neg_lo:[0,1] neg_hi:[0,1]
v_pk_add_f32 v[130:131],v[130:131],v[238:239] op_sel_hi:[1,0] neg_lo:[0,1] neg_hi:[0,1]
v_pk_add_f32 v[132:133],v[132:133],v[238:239] op_sel_hi:[1,0] neg_lo:[0,1] neg_hi:[0,1]
v_pk_add_f32 v[134:135],v[134:135],v[238:239] op_sel_hi:[1,0] neg_lo:[0,1] neg_hi:[0,1]
v_pk_add_f32 v[138:139],v[138:139],v[238:239] op_sel_hi:[1,0] neg_lo:[0,1] neg_hi:[0,1]
v_exp_f32 v128,v128
v_exp_f32 v129,v129
v_exp_f32 v130,v130
v_exp_f32 v131,v131
v_exp_f32 v132,v132
v_exp_f32 v133,v133
v_exp_f32 v134,v134
v_exp_f32 v135,v135
v_exp_f32 v138,v138
v_exp_f32 v139,v139
v_pk_add_f32 v[148:149],v[128:129],v[130:131]
v_pk_add_f32 v[150:151],v[132:133],v[134:135]
v_pk_add_f32 v[148:149],v[148:149],v[138:139]
v_pk_add_f32 v[148:149],v[148:149],v[150:151]
v_add_f32 v150,v148,v149
v_add_f32 v151,v148,v149
s_nop 1
v_permlane16_swap_b32 v150,v151
v_add_f32 v148,v150,v151
v_add_f32 v149,v150,v151
s_nop 1
v_permlane32_swap_b32 v148,v149
v_add_f32 v148,v148,v149
v_rcp_f32 v148,v148
s_waitcnt vmcnt(0)
v_cmp_gt_u32 vcc,s66,v17
v_pk_mul_f32 v[138:139],v[138:139],v[148:149] op_sel_hi:[1,0]
v_pk_mul_f32 v[128:129],v[128:129],v[148:149] op_sel_hi:[1,0]
v_pk_mul_f32 v[130:131],v[130:131],v[148:149] op_sel_hi:[1,0]
v_pk_mul_f32 v[132:133],v[132:133],v[148:149] op_sel_hi:[1,0]
v_pk_mul_f32 v[134:135],v[134:135],v[148:149] op_sel_hi:[1,0]
s_cbranch_vccnz L_ap_377
L_apb_378:
s_xor_b32 s34,s69,524288
buffer_load_dwordx4 v[192:195],v7,s[8:11],s34 offen sc1
v_cvt_pk_bf16_f32 v144,v138,v139
v_cvt_pk_bf16_f32 v147,v138,v139
s_nop 0
v_mfma_f32_16x16x16_bf16 v[24:27],v[120:121],v[144:145],0
s_add_u32 s34,s34,4096
v_cvt_pk_bf16_f32 v140,v128,v129
v_mfma_f32_16x16x16_bf16 v[28:31],v[120:121],v[146:147],0
buffer_load_dwordx4 v[196:199],v7,s[8:11],s34 offen sc1
v_cvt_pk_bf16_f32 v141,v130,v131
v_mfma_f32_16x16x16_bf16 v[32:35],v[122:123],v[144:145],0
s_add_u32 s34,s34,4096
v_cvt_pk_bf16_f32 v142,v132,v133
v_mfma_f32_16x16x16_bf16 v[36:39],v[122:123],v[146:147],0
buffer_load_dwordx4 v[200:203],v7,s[8:11],s34 offen sc1
v_cvt_pk_bf16_f32 v143,v134,v135
v_mfma_f32_16x16x16_bf16 v[40:43],v[124:125],v[144:145],0
s_add_u32 s34,s34,4096
v_mfma_f32_16x16x16_bf16 v[44:47],v[124:125],v[146:147],0
buffer_load_dwordx4 v[204:207],v7,s[8:11],s34 offen sc1
v_mfma_f32_16x16x16_bf16 v[48:51],v[126:127],v[144:145],0
s_add_u32 s34,s34,4096
v_mfma_f32_16x16x16_bf16 v[52:55],v[126:127],v[146:147],0
buffer_load_dwordx4 v[208:211],v7,s[8:11],s34 offen sc1
v_mfma_f32_16x16x32_bf16 v[24:27],v[88:91],v[140:143],v[24:27]
s_add_u32 s34,s34,4096
v_mfma_f32_16x16x32_bf16 v[28:31],v[92:95],v[140:143],v[28:31]
buffer_load_dwordx4 v[212:215],v7,s[8:11],s34 offen sc1
v_mfma_f32_16x16x32_bf16 v[32:35],v[96:99],v[140:143],v[32:35]
s_add_u32 s34,s34,4096
v_mfma_f32_16x16x32_bf16 v[36:39],v[100:103],v[140:143],v[36:39]
buffer_load_dwordx4 v[216:219],v7,s[8:11],s34 offen sc1
v_cvt_pk_bf16_f32 v72,v24,v28
v_cvt_pk_bf16_f32 v73,v25,v29
v_mfma_f32_16x16x32_bf16 v[40:43],v[104:107],v[140:143],v[40:43]
s_add_u32 s34,s34,4096
v_cvt_pk_bf16_f32 v74,v26,v30
v_cvt_pk_bf16_f32 v75,v27,v31
v_mfma_f32_16x16x32_bf16 v[44:47],v[108:111],v[140:143],v[44:47]
ds_write_b128 v3,v[72:75] offset:0
v_cvt_pk_bf16_f32 v76,v32,v36
v_cvt_pk_bf16_f32 v77,v33,v37
v_mfma_f32_16x16x32_bf16 v[48:51],v[112:115],v[140:143],v[48:51]
buffer_load_dwordx4 v[220:223],v7,s[8:11],s34 offen sc1
v_cvt_pk_bf16_f32 v78,v34,v38
v_cvt_pk_bf16_f32 v79,v35,v39
v_mfma_f32_16x16x32_bf16 v[52:55],v[116:119],v[140:143],v[52:55]
ds_write_b128 v3,v[76:79] offset:1024
v_cvt_pk_bf16_f32 v80,v40,v44
v_cvt_pk_bf16_f32 v81,v41,v45
v_cvt_pk_bf16_f32 v82,v42,v46
v_cvt_pk_bf16_f32 v83,v43,v47
ds_write_b128 v3,v[80:83] offset:2048
s_nop 1
v_cvt_pk_bf16_f32 v84,v48,v52
v_cvt_pk_bf16_f32 v85,v49,v53
v_cvt_pk_bf16_f32 v86,v50,v54
v_cvt_pk_bf16_f32 v87,v51,v55
ds_write_b128 v3,v[84:87] offset:3072
v_readlane_b32 s32,v18,0
v_readlane_b32 s33,v18,1
s_waitcnt lgkmcnt(0)
s_barrier
s_branch L_aa_333
L_ai_376:
v_max3_f32 v238,v128,v129,v130
v_max3_f32 v239,v131,v132,v133
v_max3_f32 v238,v134,v135,v238
v_max3_f32 v239,v138,v139,v239
v_max_f32 v238,v238,v239
v_max_f32 v239,v238,v239
v_pk_mul_f32 v[128:129],v[128:129],v[152:153] op_sel_hi:[1,0]
v_pk_mul_f32 v[130:131],v[130:131],v[152:153] op_sel_hi:[1,0]
v_permlane16_swap_b32 v238,v239
v_max_f32 v238,v238,v239
v_max_f32 v239,v238,v239
v_pk_mul_f32 v[132:133],v[132:133],v[152:153] op_sel_hi:[1,0]
v_pk_mul_f32 v[134:135],v[134:135],v[152:153] op_sel_hi:[1,0]
v_permlane32_swap_b32 v238,v239
v_max_f32 v238,v238,v239
v_mul_f32 v238,v152,v238
v_pk_mul_f32 v[138:139],v[138:139],v[152:153] op_sel_hi:[1,0]
v_pk_add_f32 v[128:129],v[128:129],v[238:239] op_sel_hi:[1,0] neg_lo:[0,1] neg_hi:[0,1]
v_pk_add_f32 v[130:131],v[130:131],v[238:239] op_sel_hi:[1,0] neg_lo:[0,1] neg_hi:[0,1]
v_pk_add_f32 v[132:133],v[132:133],v[238:239] op_sel_hi:[1,0] neg_lo:[0,1] neg_hi:[0,1]
v_pk_add_f32 v[134:135],v[134:135],v[238:239] op_sel_hi:[1,0] neg_lo:[0,1] neg_hi:[0,1]
v_pk_add_f32 v[138:139],v[138:139],v[238:239] op_sel_hi:[1,0] neg_lo:[0,1] neg_hi:[0,1]
v_exp_f32 v128,v128
v_exp_f32 v129,v129
v_exp_f32 v130,v130
v_exp_f32 v131,v131
v_exp_f32 v132,v132
v_exp_f32 v133,v133
v_exp_f32 v134,v134
v_exp_f32 v135,v135
v_exp_f32 v138,v138
v_exp_f32 v139,v139
v_pk_add_f32 v[148:149],v[128:129],v[130:131]
v_pk_add_f32 v[150:151],v[132:133],v[134:135]
v_pk_add_f32 v[148:149],v[148:149],v[138:139]
v_pk_add_f32 v[148:149],v[148:149],v[150:151]
v_add_f32 v150,v148,v149
v_add_f32 v151,v148,v149
s_nop 1
v_permlane16_swap_b32 v150,v151
v_add_f32 v148,v150,v151
v_add_f32 v149,v150,v151
s_nop 1
v_permlane32_swap_b32 v148,v149
v_add_f32 v148,v148,v149
v_rcp_f32 v148,v148
s_nop 0
v_pk_mul_f32 v[138:139],v[138:139],v[148:149] op_sel_hi:[1,0]
v_pk_mul_f32 v[128:129],v[128:129],v[148:149] op_sel_hi:[1,0]
v_pk_mul_f32 v[130:131],v[130:131],v[148:149] op_sel_hi:[1,0]
v_pk_mul_f32 v[132:133],v[132:133],v[148:149] op_sel_hi:[1,0]
v_pk_mul_f32 v[134:135],v[134:135],v[148:149] op_sel_hi:[1,0]
v_cvt_pk_bf16_f32 v144,v138,v139
v_cvt_pk_bf16_f32 v147,v138,v139
s_nop 0
v_mfma_f32_16x16x16_bf16 v[24:27],v[120:121],v[144:145],0
v_cvt_pk_bf16_f32 v140,v128,v129
v_mfma_f32_16x16x16_bf16 v[28:31],v[120:121],v[146:147],0
v_cvt_pk_bf16_f32 v141,v130,v131
v_mfma_f32_16x16x16_bf16 v[32:35],v[122:123],v[144:145],0
v_cvt_pk_bf16_f32 v142,v132,v133
v_mfma_f32_16x16x16_bf16 v[36:39],v[122:123],v[146:147],0
v_cvt_pk_bf16_f32 v143,v134,v135
v_mfma_f32_16x16x16_bf16 v[40:43],v[124:125],v[144:145],0
v_mfma_f32_16x16x16_bf16 v[44:47],v[124:125],v[146:147],0
v_mfma_f32_16x16x16_bf16 v[48:51],v[126:127],v[144:145],0
v_mfma_f32_16x16x16_bf16 v[52:55],v[126:127],v[146:147],0
v_mfma_f32_16x16x32_bf16 v[24:27],v[88:91],v[140:143],v[24:27]
v_mfma_f32_16x16x32_bf16 v[28:31],v[92:95],v[140:143],v[28:31]
v_mfma_f32_16x16x32_bf16 v[32:35],v[96:99],v[140:143],v[32:35]
v_mfma_f32_16x16x32_bf16 v[36:39],v[100:103],v[140:143],v[36:39]
v_cvt_pk_bf16_f32 v72,v24,v28
v_cvt_pk_bf16_f32 v73,v25,v29
v_mfma_f32_16x16x32_bf16 v[40:43],v[104:107],v[140:143],v[40:43]
v_cvt_pk_bf16_f32 v74,v26,v30
v_cvt_pk_bf16_f32 v75,v27,v31
v_mfma_f32_16x16x32_bf16 v[44:47],v[108:111],v[140:143],v[44:47]
ds_write_b128 v3,v[72:75] offset:0
v_cvt_pk_bf16_f32 v76,v32,v36
v_cvt_pk_bf16_f32 v77,v33,v37
v_mfma_f32_16x16x32_bf16 v[48:51],v[112:115],v[140:143],v[48:51]
v_cvt_pk_bf16_f32 v78,v34,v38
v_cvt_pk_bf16_f32 v79,v35,v39
v_mfma_f32_16x16x32_bf16 v[52:55],v[116:119],v[140:143],v[52:55]
ds_write_b128 v3,v[76:79] offset:1024
v_cvt_pk_bf16_f32 v80,v40,v44
v_cvt_pk_bf16_f32 v81,v41,v45
v_cvt_pk_bf16_f32 v82,v42,v46
v_cvt_pk_bf16_f32 v83,v43,v47
ds_write_b128 v3,v[80:83] offset:2048
s_nop 1
v_cvt_pk_bf16_f32 v84,v48,v52
v_cvt_pk_bf16_f32 v85,v49,v53
v_cvt_pk_bf16_f32 v86,v50,v54
v_cvt_pk_bf16_f32 v87,v51,v55
ds_write_b128 v3,v[84:87] offset:3072
s_waitcnt vmcnt(0)
v_readlane_b32 s32,v18,0
v_readlane_b32 s33,v18,1
s_waitcnt lgkmcnt(0)
s_barrier
s_branch L_aa_320
L_aa_329:
s_cmp_lg_u32 s86,1536
s_cbranch_scc1 L_az_379
s_cmp_ge_u32 s35,67
s_cbranch_scc1 L_aa_319
v_subrev_u32 v248,s36,v1
v_and_b32 v248,0x80000003,v248
v_cmp_eq_u32 vcc,0,v248
v_lshlrev_b32 v248,2,v1
v_mov_b32 v249,0x40000000
v_cndmask_b32 v248,v249,v248,vcc
v_mov_b32 v249,3
s_or_b32 s59,s68,s46
s_mov_b32 s59,11018240
s_cmov_b32 s59,0x80000000
buffer_store_dword v249,v248,s[8:11],s59 offen sc1
L_aa_319:
s_waitcnt vmcnt(0)
buffer_store_dword v20,off,s[8:11],s73 sc1
s_mov_b32 s73,0x80000000
v_lshlrev_b32 v238,2,v1
v_add_u32 v248,155712,v238
s_cmp_lg_u32 s46,0
s_cbranch_scc1 L_an_380
s_lshl_b32 s59,s54,13
s_add_u32 s59,s59,11026432
L_fp_381:
s_sleep 1
buffer_load_dword v239,v238,s[8:11],s59 offen sc1
s_sub_u32 s49,s49,1
s_cbranch_scc1 L_abort2
s_waitcnt vmcnt(0)
v_cmp_eq_u32 vcc,0,v239
s_cbranch_vccnz L_fp_381
ds_write_b32 v248,v239
s_waitcnt lgkmcnt(0)
L_an_380:
s_barrier
ds_read_b32 v239,v248
s_mov_b32 s86,768
s_mov_b32 s30,1
s_waitcnt lgkmcnt(0)
v_readfirstlane_b32 s55,v239
v_and_b32 v239,255,v239
s_lshr_b32 s55,s55,8
s_lshr_b32 s61,s55,5
v_cmp_ne_u32 s[38:39],3,v239
v_cmp_le_u32 vcc,s61,v1
s_nop 1
v_cndmask_b32 v238,1,2,vcc
v_cmp_ne_u32 s[84:85],v238,v239
s_bcnt1_i32_b64 s56,s[84:85]
s_nop 0
v_mbcnt_lo_u32_b32 v238,s84,0
v_mbcnt_hi_u32_b32 v238,s85,v238
s_mul_i32 s56,s56,12
s_add_u32 s56,s56,130
s_lshr_b32 s56,s56,7
s_lshl_b32 s56,s56,1
v_cmp_gt_u32 vcc,s56,v238
v_and_b32 v239,1,v238
v_and_b32 v238,3,v238
v_add_u32 v238,2,v238
v_cndmask_b32 v238,v238,v239,vcc
v_cmp_eq_u32 vcc,s54,v238
s_and_b64 s[84:85],s[84:85],vcc
s_ff1_i32_b64 s77,s[84:85]
s_bitset0_b64 s[84:85],s77
s_min_u32 s77,s77,64
s_lshl_b32 s56,s77,5
s_add_u32 s56,s56,s68
s_mul_i32 s70,s56,24576
s_lshl_b32 s71,s56,12
s_lshl_b32 s59,s77,13
s_lshl2_add_u32 s59,s68,s59
s_add_u32 s59,s59,10486144
s_cmp_lt_u32 s77,s61
s_cselect_b32 s57,0,16777216
s_mov_b32 s60,s59
s_buffer_load_dword s33,s[8:11],s60
s_add_u32 s71,s71,s57
s_add_u32 s71,s71,58720256
s_cmp_eq_u32 s77,s61
s_cselect_b32 s57,50331648,0
s_cselect_b32 s58,1536,0
s_add_u32 s59,s59,s58
s_buffer_load_dword s32,s[8:11],s59
s_add_u32 s70,s70,s57
s_add_u32 s70,s70,150994944
v_mov_b32 v19,s59
v_writelane_b32 v19,s60,1
s_cmp_ge_u32 s77,64
s_cbranch_scc1 L_az_379
s_cmp_eq_u32 s77,s61
s_cbranch_scc1 L_aa_327
s_mov_b32 s27,0
s_bitcmp1_b64 s[38:39],s77
s_cbranch_scc1 L_a3_366
s_branch L_aa_327
L_az_379:
s_waitcnt vmcnt(0)
buffer_store_dword v20,off,s[8:11],s73 sc1
s_mov_b32 s73,0x80000000
s_endpgm
L_ag_335:
s_lshl_b32 s21,s26,13
s_lshl2_add_u32 s21,s68,s21
s_add_u32 s21,s21,10487296
L_ww_382:
buffer_load_dword v246,off,s[8:11],s21 sc1
s_sub_u32 s49,s49,1
s_cbranch_scc1 L_abort2
s_waitcnt vmcnt(0)
v_readfirstlane_b32 s22,v246
s_cmp_eq_u32 s22,0
s_cbranch_scc1 L_ww_382
L_wwd_383:
s_branch L_agb_336
L_a4_344:
v_mov_b32 v248,s27
ds_write_b32 v247,v248 offset:16
s_waitcnt lgkmcnt(0)
s_barrier
ds_read_b128 v[248:251],v245 offset:16
s_waitcnt lgkmcnt(0)
v_or3_b32 v248,v248,v249,v250
v_or_b32 v248,v248,v251
v_cmp_ne_u32 vcc,0,v248
s_cbranch_vccz L_a4_345
L_aq_384:
buffer_load_dword v17,v16,s[8:11],s87 offen sc1
s_sub_u32 s49,s49,1
s_cbranch_scc1 L_abort2
s_waitcnt vmcnt(0)
v_cmp_gt_u32 vcc,s66,v17
s_cbranch_vccnz L_aq_384
s_xor_b32 s34,s69,524288
buffer_load_dwordx4 v[160:163],v7,s[8:11],s34 offen sc1
s_add_u32 s34,s34,4096
buffer_load_dwordx4 v[164:167],v7,s[8:11],s34 offen sc1
s_add_u32 s34,s34,4096
buffer_load_dwordx4 v[168:171],v7,s[8:11],s34 offen sc1
s_add_u32 s34,s34,4096
buffer_load_dwordx4 v[172:175],v7,s[8:11],s34 offen sc1
s_add_u32 s34,s34,4096
buffer_load_dwordx4 v[176:179],v7,s[8:11],s34 offen sc1
s_add_u32 s34,s34,4096
buffer_load_dwordx4 v[180:183],v7,s[8:11],s34 offen sc1
s_add_u32 s34,s34,4096
buffer_load_dwordx4 v[184:187],v7,s[8:11],s34 offen sc1
s_add_u32 s34,s34,4096
buffer_load_dwordx4 v[188:191],v7,s[8:11],s34 offen sc1
s_waitcnt vmcnt(7)
v_mfma_f32_16x16x32_bf16 v[192:195],v[156:159],v[160:163],0
s_waitcnt vmcnt(6)
v_mfma_f32_16x16x32_bf16 v[192:195],v[156:159],v[164:167],v[192:195]
s_waitcnt vmcnt(5)
v_mfma_f32_16x16x32_bf16 v[192:195],v[156:159],v[168:171],v[192:195]
s_waitcnt vmcnt(4)
v_mfma_f32_16x16x32_bf16 v[192:195],v[156:159],v[172:175],v[192:195]
s_waitcnt vmcnt(3)
v_mfma_f32_16x16x32_bf16 v[196:199],v[156:159],v[176:179],0
s_waitcnt vmcnt(2)
v_mfma_f32_16x16x32_bf16 v[196:199],v[156:159],v[180:183],v[196:199]
s_waitcnt vmcnt(1)
v_mfma_f32_16x16x32_bf16 v[196:199],v[156:159],v[184:187],v[196:199]
ds_write_b128 v6,v[192:195]
s_waitcnt vmcnt(0)
v_mfma_f32_16x16x32_bf16 v[196:199],v[156:159],v[188:191],v[196:199]
s_nop 7
ds_write_b128 v6,v[196:199] offset:2048
s_waitcnt lgkmcnt(0)
s_barrier
buffer_store_dword v20,off,s[8:11],s73 sc1
s_mov_b32 s73,0x80000000
s_mov_b32 s27,4
s_branch L_aa_324
L_ac_347:
buffer_store_dword v20,off,s[8:11],s73 sc1
s_mov_b32 s73,0x80000000
buffer_load_dwordx4 v[72:75],v0,s[8:11],s76 offen offset:0 sc1
buffer_load_dwordx4 v[76:79],v0,s[8:11],s76 offen offset:1024 sc1
buffer_load_dwordx4 v[80:83],v0,s[8:11],s76 offen offset:2048 sc1
buffer_load_dwordx4 v[84:87],v0,s[8:11],s76 offen offset:3072 sc1
s_sub_u32 s49,s49,1
s_cbranch_scc1 L_abort2
s_mov_b32 vcc_lo,0x33333333
s_mov_b32 vcc_hi,0x33333333
s_waitcnt vmcnt(3)
v_mfma_f32_16x16x32_bf16 v[136:139],v[72:75],v[24:27],0
v_max3_u32 v238,v72,v73,v74
v_max3_u32 v238,v74,v75,v238
v_cndmask_b32_dpp v120,v72,v74,vcc quad_perm:[0,1,0,1] row_mask:0xf bank_mask:0xf
v_cndmask_b32_dpp v121,v73,v75,vcc quad_perm:[0,1,0,1] row_mask:0xf bank_mask:0xf
s_waitcnt vmcnt(2)
v_mfma_f32_16x16x32_bf16 v[136:139],v[76:79],v[28:31],v[136:139]
v_max3_u32 v238,v76,v77,v238
v_max3_u32 v238,v78,v79,v238
v_cndmask_b32_dpp v122,v76,v78,vcc quad_perm:[0,1,0,1] row_mask:0xf bank_mask:0xf
v_cndmask_b32_dpp v123,v77,v79,vcc quad_perm:[0,1,0,1] row_mask:0xf bank_mask:0xf
s_waitcnt vmcnt(1)
v_mfma_f32_16x16x32_bf16 v[136:139],v[80:83],v[32:35],v[136:139]
v_max3_u32 v238,v80,v81,v238
v_max3_u32 v238,v82,v83,v238
v_cndmask_b32_dpp v124,v80,v82,vcc quad_perm:[0,1,0,1] row_mask:0xf bank_mask:0xf
v_cndmask_b32_dpp v125,v81,v83,vcc quad_perm:[0,1,0,1] row_mask:0xf bank_mask:0xf
s_waitcnt vmcnt(0)
v_mfma_f32_16x16x32_bf16 v[136:139],v[84:87],v[36:39],v[136:139]
v_max3_u32 v238,v84,v85,v238
v_max3_u32 v238,v86,v87,v238
v_cndmask_b32_dpp v126,v84,v86,vcc quad_perm:[0,1,0,1] row_mask:0xf bank_mask:0xf
v_cndmask_b32_dpp v127,v85,v87,vcc quad_perm:[0,1,0,1] row_mask:0xf bank_mask:0xf
v_cmp_eq_u32 vcc,-1,v238
s_cbranch_vccnz L_ac_347
s_branch L_acb_348
L_ap_350:
L_aw_385:
v_cmp_gt_u32 vcc,s66,v17
s_cbranch_vccz L_awd_386
buffer_load_dword v17,v16,s[8:11],s87 offen sc1
s_sub_u32 s49,s49,1
s_cbranch_scc1 L_abort2
s_waitcnt vmcnt(0)
s_branch L_aw_385
L_awd_386:
s_branch L_apb_351
L_a1_352:
v_subrev_u32 v248,s36,v1
v_and_b32 v248,0x80000003,v248
v_cmp_eq_u32 vcc,0,v248
v_lshlrev_b32 v248,2,v1
v_mov_b32 v249,0x40000000
v_cndmask_b32 v248,v249,v248,vcc
v_mov_b32 v249,3
s_or_b32 s59,s68,s46
s_mov_b32 s59,11018240
s_cmov_b32 s59,0x80000000
buffer_store_dword v249,v248,s[8:11],s59 offen sc1
s_branch L_a2_353
L_ag_361:
s_lshl_b32 s21,s51,13
s_lshl2_add_u32 s21,s68,s21
s_add_u32 s21,s21,10487296
L_ww_387:
buffer_load_dword v246,off,s[8:11],s21 sc1
s_sub_u32 s49,s49,1
s_cbranch_scc1 L_abort2
s_waitcnt vmcnt(0)
v_readfirstlane_b32 s22,v246
s_cmp_eq_u32 s22,0
s_cbranch_scc1 L_ww_387
L_wwd_388:
s_branch L_agb_362
L_ac_369:
buffer_store_dword v20,off,s[8:11],s73 sc1
s_mov_b32 s73,0x80000000
buffer_load_dwordx4 v[72:75],v0,s[8:11],s76 offen offset:0 sc1
buffer_load_dwordx4 v[76:79],v0,s[8:11],s76 offen offset:1024 sc1
buffer_load_dwordx4 v[80:83],v0,s[8:11],s76 offen offset:2048 sc1
buffer_load_dwordx4 v[84:87],v0,s[8:11],s76 offen offset:3072 sc1
s_sub_u32 s49,s49,1
s_cbranch_scc1 L_abort2
s_mov_b32 vcc_lo,0x33333333
s_mov_b32 vcc_hi,0x33333333
s_waitcnt vmcnt(3)
v_mfma_f32_16x16x32_bf16 v[136:139],v[72:75],v[24:27],0
v_max3_u32 v238,v72,v73,v74
v_max3_u32 v238,v74,v75,v238
v_cndmask_b32_dpp v120,v72,v74,vcc quad_perm:[0,1,0,1] row_mask:0xf bank_mask:0xf
v_cndmask_b32_dpp v121,v73,v75,vcc quad_perm:[0,1,0,1] row_mask:0xf bank_mask:0xf
s_waitcnt vmcnt(2)
v_mfma_f32_16x16x32_bf16 v[136:139],v[76:79],v[28:31],v[136:139]
v_max3_u32 v238,v76,v77,v238
v_max3_u32 v238,v78,v79,v238
v_cndmask_b32_dpp v122,v76,v78,vcc quad_perm:[0,1,0,1] row_mask:0xf bank_mask:0xf
v_cndmask_b32_dpp v123,v77,v79,vcc quad_perm:[0,1,0,1] row_mask:0xf bank_mask:0xf
s_waitcnt vmcnt(1)
v_mfma_f32_16x16x32_bf16 v[136:139],v[80:83],v[32:35],v[136:139]
v_max3_u32 v238,v80,v81,v238
v_max3_u32 v238,v82,v83,v238
v_cndmask_b32_dpp v124,v80,v82,vcc quad_perm:[0,1,0,1] row_mask:0xf bank_mask:0xf
v_cndmask_b32_dpp v125,v81,v83,vcc quad_perm:[0,1,0,1] row_mask:0xf bank_mask:0xf
s_waitcnt vmcnt(0)
v_mfma_f32_16x16x32_bf16 v[136:139],v[84:87],v[36:39],v[136:139]
v_max3_u32 v238,v84,v85,v238
v_max3_u32 v238,v86,v87,v238
v_cndmask_b32_dpp v126,v84,v86,vcc quad_perm:[0,1,0,1] row_mask:0xf bank_mask:0xf
v_cndmask_b32_dpp v127,v85,v87,vcc quad_perm:[0,1,0,1] row_mask:0xf bank_mask:0xf
v_cmp_eq_u32 vcc,-1,v238
s_cbranch_vccnz L_ac_369
s_branch L_acb_370
L_am_373:
v_subrev_u32 v248,s36,v1
v_and_b32 v248,0x80000003,v248
v_cmp_eq_u32 vcc,0,v248
v_lshlrev_b32 v248,2,v1
v_mov_b32 v249,0x40000000
v_cndmask_b32 v248,v249,v248,vcc
v_mov_b32 v249,3
s_or_b32 s59,s68,s46
s_mov_b32 s59,11018240
s_cmov_b32 s59,0x80000000
buffer_store_dword v249,v248,s[8:11],s59 offen sc1
s_branch L_ab_371
L_ap_377:
L_aw_389:
v_cmp_gt_u32 vcc,s66,v17
s_cbranch_vccz L_awd_390
buffer_load_dword v17,v16,s[8:11],s87 offen sc1
s_sub_u32 s49,s49,1
s_cbranch_scc1 L_abort2
s_waitcnt vmcnt(0)
s_branch L_aw_389
L_awd_390:
s_branch L_apb_378
s_endpgm
L_wm:
s_nop 11
v_and_b32 v120,15,v1
v_lshrrev_b32 v121,4,v1
v_mov_b32 v17,1
s_lshl_b32 s56,s46,15
v_add_u32 v18,s56,v0
s_lshl_b32 s56,s46,2
v_add_u32 v125,s56,v121
v_xor_b32 v126,v125,v120
v_lshlrev_b32 v126,4,v126
v_lshl_add_u32 v20,v125,10,v126
v_add_u32 v125,0,v121
v_xor_b32 v125,v125,v120
v_lshlrev_b32 v125,4,v125
v_lshl_add_u32 v125,v120,8,v125
v_add_u32 v4,131072,v125
v_add_u32 v125,4,v121
v_xor_b32 v125,v125,v120
v_lshlrev_b32 v125,4,v125
v_lshl_add_u32 v125,v120,8,v125
v_add_u32 v5,131072,v125
v_add_u32 v125,8,v121
v_xor_b32 v125,v125,v120
v_lshlrev_b32 v125,4,v125
v_lshl_add_u32 v125,v120,8,v125
v_add_u32 v6,131072,v125
v_add_u32 v125,12,v121
v_xor_b32 v125,v125,v120
v_lshlrev_b32 v125,4,v125
v_lshl_add_u32 v125,v120,8,v125
v_add_u32 v7,131072,v125
v_lshlrev_b32 v21,5,v120
v_and_b32 v125,1,v121
v_lshl_add_u32 v21,v125,4,v21
s_lshl_b32 s56,s46,9
v_lshrrev_b32 v125,1,v121
v_lshl_add_u32 v21,v125,11,v21
s_add_u32 s56,s56,155648
v_add_u32 v21,s56,v21
v_lshlrev_b32 v22,4,v120
v_lshl_add_u32 v22,v121,10,v22
s_lshl_b32 s56,s46,8
v_add_u32 v22,s56,v22
s_mov_b32 s54,0
s_mov_b32 s31,0
s_mov_b32 s53,6
s_mov_b32 s72,0x80000000
s_mov_b32 s73,0
s_mov_b32 s77,-1
s_mov_b32 s86,0
s_mov_b32 s19,0
s_mov_b32 s74,2948595712
s_mov_b32 s75,2863311530
v_and_b32 v23,15,v1
v_lshlrev_b32 v23,3,v23
v_lshrrev_b32 v16,4,v1
v_lshl_add_u32 v23,v16,13,v23
v_mov_b32 v19,159744
v_lshl_add_u32 v16,v16,2,v19
v_and_b32 v9,15,v1
v_lshrrev_b32 v10,4,v1
v_and_b32 v124,1,v1
v_lshlrev_b32 v124,4,v124
v_mov_b32 v125,0xffff
v_lshlrev_b32 v125,v124,v125
v_lshrrev_b32 v124,2,v9
v_cmp_eq_u32 vcc,0,v124
s_nop 1
v_cndmask_b32 v12,0,v125,vcc
v_cmp_eq_u32 vcc,1,v124
s_nop 1
v_cndmask_b32 v13,0,v125,vcc
v_and_b32 v124,2,v1
v_cmp_eq_u32 vcc,0,v124
v_mov_b32 v14,0xeeee
v_mov_b32 v124,0x4444
v_cndmask_b32 v14,v14,v124,vcc
v_lshlrev_b32 v11,14,v10
v_lshl_add_u32 v11,v9,4,v11
s_lshl_b32 s65,s51,15
s_add_u32 s65,s65,92274688
s_lshl_b32 s62,s47,10
s_add_u32 s62,s62,s65
s_lshl_b32 s63,s47,16
s_lshl_b32 s60,s46,8
s_add_u32 s63,s63,s60
s_mov_b32 s4,s38
s_mov_b32 s5,s39
s_mov_b32 s6,1835008
s_mov_b32 s7,0x20000
buffer_load_dwordx4 v[24:27],v11,s[4:7],s63 offen offset:0
buffer_load_dwordx4 v[28:31],v11,s[4:7],s63 offen offset:1024
buffer_load_dwordx4 v[32:35],v11,s[4:7],s63 offen offset:2048
buffer_load_dwordx4 v[36:39],v11,s[4:7],s63 offen offset:3072
s_add_u32 s63,s63,4096
buffer_load_dwordx4 v[40:43],v11,s[4:7],s63 offen offset:0
buffer_load_dwordx4 v[44:47],v11,s[4:7],s63 offen offset:1024
buffer_load_dwordx4 v[48:51],v11,s[4:7],s63 offen offset:2048
buffer_load_dwordx4 v[52:55],v11,s[4:7],s63 offen offset:3072
s_add_u32 s63,s63,4096
buffer_load_dwordx4 v[56:59],v11,s[4:7],s63 offen offset:0
buffer_load_dwordx4 v[60:63],v11,s[4:7],s63 offen offset:1024
buffer_load_dwordx4 v[64:67],v11,s[4:7],s63 offen offset:2048
buffer_load_dwordx4 v[68:71],v11,s[4:7],s63 offen offset:3072
s_add_u32 s63,s63,4096
buffer_load_dwordx4 v[72:75],v11,s[4:7],s63 offen offset:0
buffer_load_dwordx4 v[76:79],v11,s[4:7],s63 offen offset:1024
buffer_load_dwordx4 v[80:83],v11,s[4:7],s63 offen offset:2048
buffer_load_dwordx4 v[84:87],v11,s[4:7],s63 offen offset:3072
s_mov_b32 s4,s32
s_mov_b32 s5,s33
s_mov_b32 s6,1024
s_mov_b32 s7,0x20000
buffer_load_dwordx4 v[88:91],v0,s[4:7],0 offen
s_waitcnt vmcnt(0)
v_lshlrev_b32 v96,16,v88
v_and_b32 v97,0xffff0000,v88
v_lshlrev_b32 v98,16,v89
v_and_b32 v99,0xffff0000,v89
v_lshlrev_b32 v100,16,v90
v_and_b32 v101,0xffff0000,v90
v_lshlrev_b32 v102,16,v91
v_and_b32 v103,0xffff0000,v91
v_mul_f32 v88,v96,v96
v_fma_f32 v88,v97,v97,v88
v_fma_f32 v88,v98,v98,v88
v_fma_f32 v88,v99,v99,v88
v_fma_f32 v88,v100,v100,v88
v_fma_f32 v88,v101,v101,v88
v_fma_f32 v88,v102,v102,v88
v_fma_f32 v88,v103,v103,v88
s_nop 1
v_add_f32_dpp v88,v88,v88 row_ror:8 row_mask:0xf bank_mask:0xf
s_nop 1
v_add_f32_dpp v88,v88,v88 row_ror:4 row_mask:0xf bank_mask:0xf
s_nop 1
v_add_f32_dpp v88,v88,v88 row_ror:2 row_mask:0xf bank_mask:0xf
s_nop 1
v_add_f32_dpp v88,v88,v88 row_ror:1 row_mask:0xf bank_mask:0xf
v_mov_b32 v89,v88
s_nop 1
v_permlane16_swap_b32 v88,v89
v_add_f32 v88,v88,v89
v_mov_b32 v89,v88
s_nop 1
v_permlane32_swap_b32 v88,v89
v_add_f32 v88,v88,v89
v_sqrt_f32 v88,v88
s_nop 0
v_mul_f32 v88,0x40333333,v88
s_nop 0
v_readfirstlane_b32 s25,v88
s_bitset1_b32 s25,31
s_ff1_i32_b64 s30,s[74:75]
s_bitset0_b64 s[74:75],s30
s_min_u32 s30,s30,127
s_lshl_b32 s70,s30,15
s_add_u32 s70,s70,0
s_add_u32 s71,s70,16384
L_mo_395:
s_cmp_lg_u32 s19,0
s_cbranch_scc1 L_mo_396
s_add_u32 m0,s50,131072
s_nop 0
buffer_load_dwordx4 v20,s[8:11],s70 offen offset:0 sc1 lds
s_add_u32 m0,s50,135168
s_nop 0
buffer_load_dwordx4 v20,s[8:11],s71 offen offset:0 sc1 lds
s_add_u32 m0,s50,139008
s_nop 0
buffer_load_dwordx4 v20,s[8:11],s70 offen offset:256 sc1 lds
s_add_u32 m0,s50,143104
s_nop 0
buffer_load_dwordx4 v20,s[8:11],s71 offen offset:256 sc1 lds
s_add_u32 m0,s50,146944
s_nop 0
buffer_load_dwordx4 v20,s[8:11],s70 offen offset:512 sc1 lds
s_add_u32 m0,s50,151040
s_nop 0
buffer_load_dwordx4 v20,s[8:11],s71 offen offset:512 sc1 lds
s_mov_b32 s19,1
s_waitcnt vmcnt(0)
L_mo_396:
s_mov_b32 s51,s30
s_mov_b64 s[68:69],s[70:71]
s_ff1_i32_b64 s30,s[74:75]
s_bitset0_b64 s[74:75],s30
s_min_u32 s30,s30,127
s_lshl_b32 s70,s30,15
s_add_u32 s70,s70,0
s_add_u32 s71,s70,16384
s_lshl_b32 s76,s31,13
s_add_u32 s76,s76,10487040
s_lshl_b32 s58,s51,5
s_add_u32 s58,s58,s47
s_mul_i32 s58,s58,24576
s_add_u32 s58,s58,100663296
s_add_u32 s61,s58,s50
s_add_u32 s62,s61,4096
s_add_u32 s63,s61,16384
s_add_u32 s64,s61,20480
s_add_u32 s65,s61,s50
s_add_u32 s65,s65,8192
s_waitcnt vmcnt(12)
s_barrier
ds_read_b128 v[72:75],v4 offset:0
ds_read_b128 v[76:79],v4 offset:4096
ds_read_b128 v[80:83],v5 offset:0
ds_read_b128 v[84:87],v5 offset:4096
s_add_u32 m0,s50,154880
s_nop 0
buffer_load_dwordx4 v20,s[8:11],s68 offen offset:768 sc1 lds
s_add_u32 m0,s50,158976
s_nop 0
buffer_load_dwordx4 v20,s[8:11],s69 offen offset:768 sc1 lds
s_waitcnt lgkmcnt(2)
v_mfma_f32_16x16x32_bf16 v[40:43],a[128:131],v[72:75],0
ds_read_b128 v[108:111],v6 offset:0
v_mfma_f32_16x16x32_bf16 v[56:59],v[72:75],v[128:131],0
v_mfma_f32_16x16x32_bf16 v[24:27],a[0:3],v[72:75],0
ds_read_b128 v[112:115],v6 offset:4096
v_mfma_f32_16x16x32_bf16 v[44:47],a[128:131],v[76:79],0
v_mfma_f32_16x16x32_bf16 v[60:63],v[76:79],v[128:131],0
v_mfma_f32_16x16x32_bf16 v[28:31],a[0:3],v[76:79],0
v_mfma_f32_16x16x32_bf16 v[48:51],a[136:139],v[72:75],0
v_mfma_f32_16x16x32_bf16 v[64:67],v[72:75],v[136:139],0
v_mfma_f32_16x16x32_bf16 v[32:35],a[8:11],v[72:75],0
v_mfma_f32_16x16x32_bf16 v[52:55],a[136:139],v[76:79],0
v_mfma_f32_16x16x32_bf16 v[68:71],v[76:79],v[136:139],0
v_mfma_f32_16x16x32_bf16 v[36:39],a[8:11],v[76:79],0
s_waitcnt lgkmcnt(2)
v_mfma_f32_16x16x32_bf16 v[40:43],a[132:135],v[80:83],v[40:43]
ds_read_b128 v[72:75],v7 offset:0
v_mfma_f32_16x16x32_bf16 v[56:59],v[80:83],v[132:135],v[56:59]
v_mfma_f32_16x16x32_bf16 v[24:27],a[4:7],v[80:83],v[24:27]
ds_read_b128 v[76:79],v7 offset:4096
v_mfma_f32_16x16x32_bf16 v[44:47],a[132:135],v[84:87],v[44:47]
v_mfma_f32_16x16x32_bf16 v[60:63],v[84:87],v[132:135],v[60:63]
v_mfma_f32_16x16x32_bf16 v[28:31],a[4:7],v[84:87],v[28:31]
v_mfma_f32_16x16x32_bf16 v[48:51],a[140:143],v[80:83],v[48:51]
v_mfma_f32_16x16x32_bf16 v[64:67],v[80:83],v[140:143],v[64:67]
v_mfma_f32_16x16x32_bf16 v[32:35],a[12:15],v[80:83],v[32:35]
v_mfma_f32_16x16x32_bf16 v[52:55],a[140:143],v[84:87],v[52:55]
v_mfma_f32_16x16x32_bf16 v[68:71],v[84:87],v[140:143],v[68:71]
v_mfma_f32_16x16x32_bf16 v[36:39],a[12:15],v[84:87],v[36:39]
s_waitcnt vmcnt(12)
s_barrier
s_waitcnt lgkmcnt(2)
v_mfma_f32_16x16x32_bf16 v[40:43],a[144:147],v[108:111],v[40:43]
ds_read_b128 v[80:83],v4 offset:8192
v_mfma_f32_16x16x32_bf16 v[56:59],v[108:111],v[144:147],v[56:59]
v_mfma_f32_16x16x32_bf16 v[24:27],a[16:19],v[108:111],v[24:27]
ds_read_b128 v[84:87],v4 offset:12288
v_mfma_f32_16x16x32_bf16 v[44:47],a[144:147],v[112:115],v[44:47]
v_mfma_f32_16x16x32_bf16 v[60:63],v[112:115],v[144:147],v[60:63]
v_mfma_f32_16x16x32_bf16 v[28:31],a[16:19],v[112:115],v[28:31]
v_mfma_f32_16x16x32_bf16 v[48:51],a[152:155],v[108:111],v[48:51]
v_mfma_f32_16x16x32_bf16 v[64:67],v[108:111],v[152:155],v[64:67]
v_mfma_f32_16x16x32_bf16 v[32:35],a[24:27],v[108:111],v[32:35]
v_mfma_f32_16x16x32_bf16 v[52:55],a[152:155],v[112:115],v[52:55]
v_mfma_f32_16x16x32_bf16 v[68:71],v[112:115],v[152:155],v[68:71]
v_mfma_f32_16x16x32_bf16 v[36:39],a[24:27],v[112:115],v[36:39]
s_waitcnt lgkmcnt(2)
v_mfma_f32_16x16x32_bf16 v[40:43],a[148:151],v[72:75],v[40:43]
ds_read_b128 v[108:111],v5 offset:8192
v_mfma_f32_16x16x32_bf16 v[56:59],v[72:75],v[148:151],v[56:59]
v_mfma_f32_16x16x32_bf16 v[24:27],a[20:23],v[72:75],v[24:27]
ds_read_b128 v[112:115],v5 offset:12288
v_mfma_f32_16x16x32_bf16 v[44:47],a[148:151],v[76:79],v[44:47]
v_mfma_f32_16x16x32_bf16 v[60:63],v[76:79],v[148:151],v[60:63]
v_mfma_f32_16x16x32_bf16 v[28:31],a[20:23],v[76:79],v[28:31]
v_mfma_f32_16x16x32_bf16 v[48:51],a[156:159],v[72:75],v[48:51]
v_mfma_f32_16x16x32_bf16 v[64:67],v[72:75],v[156:159],v[64:67]
v_mfma_f32_16x16x32_bf16 v[32:35],a[28:31],v[72:75],v[32:35]
v_mfma_f32_16x16x32_bf16 v[52:55],a[156:159],v[76:79],v[52:55]
v_mfma_f32_16x16x32_bf16 v[68:71],v[76:79],v[156:159],v[68:71]
v_mfma_f32_16x16x32_bf16 v[36:39],a[28:31],v[76:79],v[36:39]
s_waitcnt lgkmcnt(2)
v_mfma_f32_16x16x32_bf16 v[40:43],a[160:163],v[80:83],v[40:43]
ds_read_b128 v[72:75],v6 offset:8192
v_mfma_f32_16x16x32_bf16 v[56:59],v[80:83],v[160:163],v[56:59]
v_mfma_f32_16x16x32_bf16 v[24:27],a[32:35],v[80:83],v[24:27]
ds_read_b128 v[76:79],v6 offset:12288
v_mfma_f32_16x16x32_bf16 v[44:47],a[160:163],v[84:87],v[44:47]
v_mfma_f32_16x16x32_bf16 v[60:63],v[84:87],v[160:163],v[60:63]
v_mfma_f32_16x16x32_bf16 v[28:31],a[32:35],v[84:87],v[28:31]
v_mfma_f32_16x16x32_bf16 v[48:51],a[168:171],v[80:83],v[48:51]
v_mfma_f32_16x16x32_bf16 v[64:67],v[80:83],v[168:171],v[64:67]
v_mfma_f32_16x16x32_bf16 v[32:35],a[40:43],v[80:83],v[32:35]
v_mfma_f32_16x16x32_bf16 v[52:55],a[168:171],v[84:87],v[52:55]
v_mfma_f32_16x16x32_bf16 v[68:71],v[84:87],v[168:171],v[68:71]
v_mfma_f32_16x16x32_bf16 v[36:39],a[40:43],v[84:87],v[36:39]
s_waitcnt lgkmcnt(2)
v_mfma_f32_16x16x32_bf16 v[40:43],a[164:167],v[108:111],v[40:43]
ds_read_b128 v[80:83],v7 offset:8192
v_mfma_f32_16x16x32_bf16 v[56:59],v[108:111],v[164:167],v[56:59]
v_mfma_f32_16x16x32_bf16 v[24:27],a[36:39],v[108:111],v[24:27]
ds_read_b128 v[84:87],v7 offset:12288
v_mfma_f32_16x16x32_bf16 v[44:47],a[164:167],v[112:115],v[44:47]
v_mfma_f32_16x16x32_bf16 v[60:63],v[112:115],v[164:167],v[60:63]
v_mfma_f32_16x16x32_bf16 v[28:31],a[36:39],v[112:115],v[28:31]
v_mfma_f32_16x16x32_bf16 v[48:51],a[172:175],v[108:111],v[48:51]
v_mfma_f32_16x16x32_bf16 v[64:67],v[108:111],v[172:175],v[64:67]
v_mfma_f32_16x16x32_bf16 v[32:35],a[44:47],v[108:111],v[32:35]
v_mfma_f32_16x16x32_bf16 v[52:55],a[172:175],v[112:115],v[52:55]
v_mfma_f32_16x16x32_bf16 v[68:71],v[112:115],v[172:175],v[68:71]
v_mfma_f32_16x16x32_bf16 v[36:39],a[44:47],v[112:115],v[36:39]
s_waitcnt vmcnt(10)
s_barrier
s_waitcnt lgkmcnt(2)
v_mfma_f32_16x16x32_bf16 v[40:43],a[176:179],v[72:75],v[40:43]
ds_read_b128 v[108:111],v4 offset:16384
v_mfma_f32_16x16x32_bf16 v[56:59],v[72:75],v[176:179],v[56:59]
v_mfma_f32_16x16x32_bf16 v[24:27],a[48:51],v[72:75],v[24:27]
ds_read_b128 v[112:115],v4 offset:20480
v_mfma_f32_16x16x32_bf16 v[44:47],a[176:179],v[76:79],v[44:47]
v_mfma_f32_16x16x32_bf16 v[60:63],v[76:79],v[176:179],v[60:63]
v_mfma_f32_16x16x32_bf16 v[28:31],a[48:51],v[76:79],v[28:31]
v_mfma_f32_16x16x32_bf16 v[48:51],a[184:187],v[72:75],v[48:51]
v_mfma_f32_16x16x32_bf16 v[64:67],v[72:75],v[184:187],v[64:67]
v_mfma_f32_16x16x32_bf16 v[32:35],a[56:59],v[72:75],v[32:35]
v_mfma_f32_16x16x32_bf16 v[52:55],a[184:187],v[76:79],v[52:55]
v_mfma_f32_16x16x32_bf16 v[68:71],v[76:79],v[184:187],v[68:71]
v_mfma_f32_16x16x32_bf16 v[36:39],a[56:59],v[76:79],v[36:39]
s_waitcnt vmcnt(2)
s_barrier
s_or_b32 s72,s72,s52
buffer_store_dword v17,off,s[8:11],s72 sc1
s_waitcnt lgkmcnt(2)
v_mfma_f32_16x16x32_bf16 v[40:43],a[180:183],v[80:83],v[40:43]
ds_read_b128 v[72:75],v5 offset:16384
v_mfma_f32_16x16x32_bf16 v[56:59],v[80:83],v[180:183],v[56:59]
v_mfma_f32_16x16x32_bf16 v[24:27],a[52:55],v[80:83],v[24:27]
ds_read_b128 v[76:79],v5 offset:20480
v_mfma_f32_16x16x32_bf16 v[44:47],a[180:183],v[84:87],v[44:47]
v_mfma_f32_16x16x32_bf16 v[60:63],v[84:87],v[180:183],v[60:63]
v_mfma_f32_16x16x32_bf16 v[28:31],a[52:55],v[84:87],v[28:31]
v_mfma_f32_16x16x32_bf16 v[48:51],a[188:191],v[80:83],v[48:51]
v_mfma_f32_16x16x32_bf16 v[64:67],v[80:83],v[188:191],v[64:67]
v_mfma_f32_16x16x32_bf16 v[32:35],a[60:63],v[80:83],v[32:35]
v_mfma_f32_16x16x32_bf16 v[52:55],a[188:191],v[84:87],v[52:55]
v_mfma_f32_16x16x32_bf16 v[68:71],v[84:87],v[188:191],v[68:71]
v_mfma_f32_16x16x32_bf16 v[36:39],a[60:63],v[84:87],v[36:39]
s_waitcnt lgkmcnt(2)
v_mfma_f32_16x16x32_bf16 v[40:43],a[192:195],v[108:111],v[40:43]
ds_read_b128 v[80:83],v6 offset:16384
v_mfma_f32_16x16x32_bf16 v[56:59],v[108:111],v[192:195],v[56:59]
v_mfma_f32_16x16x32_bf16 v[24:27],a[64:67],v[108:111],v[24:27]
ds_read_b128 v[84:87],v6 offset:20480
v_mfma_f32_16x16x32_bf16 v[44:47],a[192:195],v[112:115],v[44:47]
v_mfma_f32_16x16x32_bf16 v[60:63],v[112:115],v[192:195],v[60:63]
v_mfma_f32_16x16x32_bf16 v[28:31],a[64:67],v[112:115],v[28:31]
v_mfma_f32_16x16x32_bf16 v[48:51],a[200:203],v[108:111],v[48:51]
v_mfma_f32_16x16x32_bf16 v[64:67],v[108:111],v[200:203],v[64:67]
v_mfma_f32_16x16x32_bf16 v[32:35],a[72:75],v[108:111],v[32:35]
v_mfma_f32_16x16x32_bf16 v[52:55],a[200:203],v[112:115],v[52:55]
v_mfma_f32_16x16x32_bf16 v[68:71],v[112:115],v[200:203],v[68:71]
v_mfma_f32_16x16x32_bf16 v[36:39],a[72:75],v[112:115],v[36:39]
s_waitcnt lgkmcnt(2)
v_mfma_f32_16x16x32_bf16 v[40:43],a[196:199],v[72:75],v[40:43]
ds_read_b128 v[108:111],v7 offset:16384
v_mfma_f32_16x16x32_bf16 v[56:59],v[72:75],v[196:199],v[56:59]
v_mfma_f32_16x16x32_bf16 v[24:27],a[68:71],v[72:75],v[24:27]
ds_read_b128 v[112:115],v7 offset:20480
v_mfma_f32_16x16x32_bf16 v[44:47],a[196:199],v[76:79],v[44:47]
v_mfma_f32_16x16x32_bf16 v[60:63],v[76:79],v[196:199],v[60:63]
v_mfma_f32_16x16x32_bf16 v[28:31],a[68:71],v[76:79],v[28:31]
v_mfma_f32_16x16x32_bf16 v[48:51],a[204:207],v[72:75],v[48:51]
v_mfma_f32_16x16x32_bf16 v[64:67],v[72:75],v[204:207],v[64:67]
v_mfma_f32_16x16x32_bf16 v[32:35],a[76:79],v[72:75],v[32:35]
v_mfma_f32_16x16x32_bf16 v[52:55],a[204:207],v[76:79],v[52:55]
v_mfma_f32_16x16x32_bf16 v[68:71],v[76:79],v[204:207],v[68:71]
v_mfma_f32_16x16x32_bf16 v[36:39],a[76:79],v[76:79],v[36:39]
s_waitcnt vmcnt(1)
s_barrier
s_waitcnt lgkmcnt(2)
v_mfma_f32_16x16x32_bf16 v[40:43],a[208:211],v[80:83],v[40:43]
ds_read_b128 v[72:75],v4 offset:24576
v_mfma_f32_16x16x32_bf16 v[56:59],v[80:83],v[208:211],v[56:59]
v_mfma_f32_16x16x32_bf16 v[24:27],a[80:83],v[80:83],v[24:27]
ds_read_b128 v[76:79],v4 offset:28672
v_mfma_f32_16x16x32_bf16 v[44:47],a[208:211],v[84:87],v[44:47]
v_mfma_f32_16x16x32_bf16 v[60:63],v[84:87],v[208:211],v[60:63]
v_mfma_f32_16x16x32_bf16 v[28:31],a[80:83],v[84:87],v[28:31]
v_mfma_f32_16x16x32_bf16 v[48:51],a[216:219],v[80:83],v[48:51]
v_mfma_f32_16x16x32_bf16 v[64:67],v[80:83],v[216:219],v[64:67]
v_mfma_f32_16x16x32_bf16 v[32:35],a[88:91],v[80:83],v[32:35]
v_mfma_f32_16x16x32_bf16 v[52:55],a[216:219],v[84:87],v[52:55]
v_mfma_f32_16x16x32_bf16 v[68:71],v[84:87],v[216:219],v[68:71]
v_mfma_f32_16x16x32_bf16 v[36:39],a[88:91],v[84:87],v[36:39]
s_waitcnt lgkmcnt(2)
v_mfma_f32_16x16x32_bf16 v[40:43],a[212:215],v[108:111],v[40:43]
ds_read_b128 v[80:83],v5 offset:24576
v_mfma_f32_16x16x32_bf16 v[56:59],v[108:111],v[212:215],v[56:59]
v_mfma_f32_16x16x32_bf16 v[24:27],a[84:87],v[108:111],v[24:27]
ds_read_b128 v[84:87],v5 offset:28672
v_mfma_f32_16x16x32_bf16 v[44:47],a[212:215],v[112:115],v[44:47]
v_mfma_f32_16x16x32_bf16 v[60:63],v[112:115],v[212:215],v[60:63]
v_mfma_f32_16x16x32_bf16 v[28:31],a[84:87],v[112:115],v[28:31]
v_mfma_f32_16x16x32_bf16 v[48:51],a[220:223],v[108:111],v[48:51]
v_mfma_f32_16x16x32_bf16 v[64:67],v[108:111],v[220:223],v[64:67]
v_mfma_f32_16x16x32_bf16 v[32:35],a[92:95],v[108:111],v[32:35]
v_mfma_f32_16x16x32_bf16 v[52:55],a[220:223],v[112:115],v[52:55]
v_mfma_f32_16x16x32_bf16 v[68:71],v[112:115],v[220:223],v[68:71]
v_mfma_f32_16x16x32_bf16 v[36:39],a[92:95],v[112:115],v[36:39]
s_barrier
s_waitcnt lgkmcnt(2)
v_mfma_f32_16x16x32_bf16 v[40:43],a[224:227],v[72:75],v[40:43]
ds_read_b128 v[108:111],v6 offset:24576
v_mfma_f32_16x16x32_bf16 v[56:59],v[72:75],v[224:227],v[56:59]
s_add_u32 m0,s50,131072
v_mfma_f32_16x16x32_bf16 v[24:27],a[96:99],v[72:75],v[24:27]
ds_read_b128 v[112:115],v6 offset:28672
v_mfma_f32_16x16x32_bf16 v[44:47],a[224:227],v[76:79],v[44:47]
buffer_load_dwordx4 v20,s[8:11],s70 offen offset:0 sc1 lds
v_mfma_f32_16x16x32_bf16 v[60:63],v[76:79],v[224:227],v[60:63]
s_add_u32 m0,s50,135168
v_mfma_f32_16x16x32_bf16 v[28:31],a[96:99],v[76:79],v[28:31]
buffer_load_dwordx4 v20,s[8:11],s71 offen offset:0 sc1 lds
v_mfma_f32_16x16x32_bf16 v[48:51],a[232:235],v[72:75],v[48:51]
s_add_u32 m0,s50,139008
v_mfma_f32_16x16x32_bf16 v[64:67],v[72:75],v[232:235],v[64:67]
buffer_load_dwordx4 v20,s[8:11],s70 offen offset:256 sc1 lds
v_mfma_f32_16x16x32_bf16 v[32:35],a[104:107],v[72:75],v[32:35]
s_add_u32 m0,s50,143104
v_mfma_f32_16x16x32_bf16 v[52:55],a[232:235],v[76:79],v[52:55]
buffer_load_dwordx4 v20,s[8:11],s71 offen offset:256 sc1 lds
v_mfma_f32_16x16x32_bf16 v[68:71],v[76:79],v[232:235],v[68:71]
s_add_u32 m0,s50,146944
v_mfma_f32_16x16x32_bf16 v[36:39],a[104:107],v[76:79],v[36:39]
buffer_load_dwordx4 v20,s[8:11],s70 offen offset:512 sc1 lds
s_waitcnt lgkmcnt(2)
v_mfma_f32_16x16x32_bf16 v[40:43],a[228:231],v[80:83],v[40:43]
ds_read_b128 v[72:75],v7 offset:24576
v_mfma_f32_16x16x32_bf16 v[56:59],v[80:83],v[228:231],v[56:59]
s_add_u32 m0,s50,151040
v_mfma_f32_16x16x32_bf16 v[24:27],a[100:103],v[80:83],v[24:27]
ds_read_b128 v[76:79],v7 offset:28672
v_mfma_f32_16x16x32_bf16 v[44:47],a[228:231],v[84:87],v[44:47]
buffer_load_dwordx4 v20,s[8:11],s71 offen offset:512 sc1 lds
v_mfma_f32_16x16x32_bf16 v[60:63],v[84:87],v[228:231],v[60:63]
buffer_load_dwordx2 v[124:125],v23,s[8:11],s76 offen sc1
v_mfma_f32_16x16x32_bf16 v[28:31],a[100:103],v[84:87],v[28:31]
v_mfma_f32_16x16x32_bf16 v[48:51],a[236:239],v[80:83],v[48:51]
v_mfma_f32_16x16x32_bf16 v[64:67],v[80:83],v[236:239],v[64:67]
v_mfma_f32_16x16x32_bf16 v[32:35],a[108:111],v[80:83],v[32:35]
v_mfma_f32_16x16x32_bf16 v[52:55],a[236:239],v[84:87],v[52:55]
v_mfma_f32_16x16x32_bf16 v[68:71],v[84:87],v[236:239],v[68:71]
v_mfma_f32_16x16x32_bf16 v[36:39],a[108:111],v[84:87],v[36:39]
s_waitcnt lgkmcnt(2)
v_mfma_f32_16x16x32_bf16 v[40:43],a[240:243],v[108:111],v[40:43]
v_mfma_f32_16x16x32_bf16 v[56:59],v[108:111],v[240:243],v[56:59]
v_mfma_f32_16x16x32_bf16 v[24:27],a[112:115],v[108:111],v[24:27]
v_mfma_f32_16x16x32_bf16 v[44:47],a[240:243],v[112:115],v[44:47]
v_mfma_f32_16x16x32_bf16 v[60:63],v[112:115],v[240:243],v[60:63]
v_mfma_f32_16x16x32_bf16 v[28:31],a[112:115],v[112:115],v[28:31]
v_mfma_f32_16x16x32_bf16 v[48:51],a[248:251],v[108:111],v[48:51]
v_mfma_f32_16x16x32_bf16 v[64:67],v[108:111],v[248:251],v[64:67]
v_mfma_f32_16x16x32_bf16 v[32:35],a[120:123],v[108:111],v[32:35]
v_mfma_f32_16x16x32_bf16 v[52:55],a[248:251],v[112:115],v[52:55]
v_mfma_f32_16x16x32_bf16 v[68:71],v[112:115],v[248:251],v[68:71]
v_mfma_f32_16x16x32_bf16 v[36:39],a[120:123],v[112:115],v[36:39]
s_waitcnt lgkmcnt(0)
v_mfma_f32_16x16x32_bf16 v[40:43],a[244:247],v[72:75],v[40:43]
v_mfma_f32_16x16x32_bf16 v[56:59],v[72:75],v[244:247],v[56:59]
v_mfma_f32_16x16x32_bf16 v[24:27],a[116:119],v[72:75],v[24:27]
v_mfma_f32_16x16x32_bf16 v[44:47],a[244:247],v[76:79],v[44:47]
v_mfma_f32_16x16x32_bf16 v[60:63],v[76:79],v[244:247],v[60:63]
v_mfma_f32_16x16x32_bf16 v[28:31],a[116:119],v[76:79],v[28:31]
v_mfma_f32_16x16x32_bf16 v[48:51],a[252:255],v[72:75],v[48:51]
v_mfma_f32_16x16x32_bf16 v[64:67],v[72:75],v[252:255],v[64:67]
v_mfma_f32_16x16x32_bf16 v[32:35],a[124:127],v[72:75],v[32:35]
v_mfma_f32_16x16x32_bf16 v[52:55],a[252:255],v[76:79],v[52:55]
v_mfma_f32_16x16x32_bf16 v[68:71],v[76:79],v[252:255],v[68:71]
v_mfma_f32_16x16x32_bf16 v[36:39],a[124:127],v[76:79],v[36:39]
s_lshl_b32 s56,s51,5
s_add_u32 s56,s56,s47
s_lshl_b32 s56,s56,12
s_add_u32 s56,s56,s50
s_add_u32 s56,s56,41943040
v_mov_b64 v[120:121],-1
v_mov_b64 v[122:123],-1
buffer_store_dwordx4 v[120:123],v0,s[8:11],s56 offen sc1
v_cvt_pk_bf16_f32 v72,v40,v48
v_cvt_pk_bf16_f32 v73,v41,v49
v_cvt_pk_bf16_f32 v74,v42,v50
v_cvt_pk_bf16_f32 v75,v43,v51
buffer_store_dwordx4 v[72:75],v0,s[8:11],s61 offen sc1
v_cvt_pk_bf16_f32 v76,v44,v52
v_cvt_pk_bf16_f32 v77,v45,v53
v_cvt_pk_bf16_f32 v78,v46,v54
v_cvt_pk_bf16_f32 v79,v47,v55
buffer_store_dwordx4 v[76:79],v0,s[8:11],s62 offen sc1
v_cvt_pk_bf16_f32 v80,v56,v57
v_cvt_pk_bf16_f32 v81,v58,v59
v_cvt_pk_bf16_f32 v82,v60,v61
v_cvt_pk_bf16_f32 v83,v62,v63
buffer_store_dwordx4 v[80:83],v0,s[8:11],s65 offen offset:0 sc1
v_cvt_pk_bf16_f32 v84,v64,v65
v_cvt_pk_bf16_f32 v85,v66,v67
v_cvt_pk_bf16_f32 v86,v68,v69
v_cvt_pk_bf16_f32 v87,v70,v71
buffer_store_dwordx4 v[84:87],v0,s[8:11],s65 offen offset:1024 sc1
v_cvt_pk_bf16_f32 v108,v24,v32
v_cvt_pk_bf16_f32 v109,v25,v33
v_cvt_pk_bf16_f32 v110,v26,v34
v_cvt_pk_bf16_f32 v111,v27,v35
buffer_store_dwordx4 v[108:111],v0,s[8:11],s63 offen sc1
v_cvt_pk_bf16_f32 v112,v28,v36
v_cvt_pk_bf16_f32 v113,v29,v37
v_cvt_pk_bf16_f32 v114,v30,v38
v_cvt_pk_bf16_f32 v115,v31,v39
buffer_store_dwordx4 v[112:115],v0,s[8:11],s64 offen sc1
s_lshl_b32 s72,s51,13
s_lshl2_add_u32 s72,s47,s72
s_add_u32 s72,s72,10485760
s_sub_u32 s53,s53,1
s_cmp_gt_i32 s53,3
s_cbranch_scc1 L_mo_396
s_cmp_gt_i32 s53,0
s_cselect_b32 s87,1,3
s_mov_b32 s18,0
s_waitcnt vmcnt(7)
s_branch L_mo_401
L_mo_394:
s_mov_b32 s55,s22
s_mov_b32 s22,s23
s_mov_b32 s23,s24
s_mov_b32 s24,-1
v_mov_b32 v3,0
s_cmp_lg_u32 s55,-1
s_cbranch_scc1 L_mp_391
s_sub_u32 s56,s30,s31
s_cmp_gt_i32 s77,0
s_cselect_b32 s57,6,20
s_cmp_lg_u32 s86,0
s_cselect_b32 s57,9,s57
s_cmp_lt_i32 s56,s57
s_cbranch_scc1 L_mo_395
s_cmp_lt_i32 s56,30
s_cselect_b32 s87,s18,0
s_cmp_ge_u32 s31,8
s_cselect_b32 s56,1,s18
s_and_b32 s56,s56,s86
s_cselect_b32 s87,2,s87
s_mul_i32 s56,s87,s18
s_cmp_lg_u32 s56,0
s_cbranch_scc1 L_mo_399
s_mov_b32 s18,0
s_lshr_b32 s56,s72,31
s_or_b32 s56,s56,s87
s_cbranch_scc1 L_mo_405
s_waitcnt vmcnt(0)
s_barrier
s_or_b32 s72,s72,s52
buffer_store_dword v17,off,s[8:11],s72 sc1
s_mov_b32 s72,0x80000000
L_mo_405:
s_cmp_lg_u32 s46,0
s_cbranch_scc1 L_mo_403
s_lshl_b32 s76,s31,13
s_add_u32 s76,s76,10487040
s_lshl_b32 s57,s47,8
s_add_u32 s57,s57,s31
s_cmp_eq_u32 s57,63
s_mov_b32 s57,0x80000000
s_cmov_b32 s57,11018240
v_lshlrev_b32 v2,2,v1
L_mo_402:
buffer_load_dwordx2 v[124:125],v23,s[8:11],s76 offen sc1
buffer_load_dword v3,v2,s[8:11],s57 offen sc1
s_sub_u32 s49,s49,1
s_cbranch_scc1 L_abort2
s_waitcnt vmcnt(0)
L_mo_401:
v_min_u32 v123,v124,v125
v_max_u32 v125,v124,v125
v_cmp_eq_u32 vcc,0,v123
s_nop 1
v_cndmask_b32 v125,v125,-1,vcc
s_and_b32 s56,vcc_lo,0xffff
s_cbranch_scc0 L_mo_406
s_cmp_lg_u32 s87,0
s_cbranch_scc1 L_mo_406
s_mov_b32 s18,1
s_sleep 2
s_branch L_mo_402
L_mo_406:
v_max_u32_dpp v125,v125,v125 row_ror:8 row_mask:0xf bank_mask:0xf
s_nop 1
v_max_u32_dpp v125,v125,v125 row_ror:4 row_mask:0xf bank_mask:0xf
s_nop 1
v_max_u32_dpp v125,v125,v125 row_ror:2 row_mask:0xf bank_mask:0xf
s_nop 1
v_max_u32_dpp v125,v125,v125 row_ror:1 row_mask:0xf bank_mask:0xf
L_mo_403:
s_sub_u32 s49,s49,1
s_cbranch_scc1 L_abort2
v_mov_b32 v124,s18
s_barrier
s_cmp_lg_u32 s46,0
s_cbranch_scc1 L_mo_404
ds_write_b32 v16,v125
ds_write_b32 v19,v124 offset:16
s_waitcnt lgkmcnt(0)
L_mo_404:
s_barrier
ds_read_b128 v[120:123],v19
ds_read_b32 v124,v19 offset:16
s_waitcnt lgkmcnt(0)
v_readfirstlane_b32 s55,v120
v_readfirstlane_b32 s22,v121
v_readfirstlane_b32 s23,v122
v_readfirstlane_b32 s24,v123
v_readfirstlane_b32 s18,v124
s_cmp_lg_u32 s55,-1
s_cbranch_scc1 L_mp_391
L_mo_399:
s_mov_b32 s22,-1
s_cmp_eq_u32 s87,1
s_cbranch_scc1 L_mo_395
s_cmp_eq_u32 s87,2
s_cbranch_scc1 L_mo_400
s_branch L_mo_394
L_mp_391:
s_mov_b32 s53,0
s_sub_u32 s73,s73,1
s_max_i32 s73,s73,0
s_sub_u32 s77,s77,1
s_min_u32 s61,s73,2
s_cmp_lt_u32 s31,5
s_cselect_b32 s60,s25,0
s_cmp_lt_u32 s55,s60
s_cselect_b32 s61,2,s61
s_cmp_le_u32 s55,s54
s_cbranch_scc1 L_mr_392
s_mov_b32 s77,s61
s_mov_b32 s54,s55
s_mov_b32 s86,0
s_or_b32 s61,s47,s46
s_cbranch_scc1 L_mr_392
v_mov_b32 v120,s54
v_lshlrev_b32 v121,13,v1
s_mov_b32 s61,10486784
buffer_store_dword v120,v121,s[8:11],s61 offen sc1
L_mr_392:
s_cmp_lg_u32 s31,63
s_cbranch_scc1 L_mo_397
s_min_i32 s77,s77,0
s_or_b32 s61,s47,s46
s_cbranch_scc1 L_mo_397
s_mov_b32 s59,11018240
v_lshlrev_b32 v120,2,v1
v_mov_b32 v121,v3
v_cmp_eq_u32 vcc,0,v3
s_cbranch_vccz L_mg_393
L_fp_408:
s_sleep 0
buffer_load_dword v121,v120,s[8:11],s59 offen sc1
s_sub_u32 s49,s49,1
s_cbranch_scc1 L_abort2
s_waitcnt vmcnt(0)
v_cmp_eq_u32 vcc,0,v121
s_cbranch_vccnz L_fp_408
L_mg_393:
s_andn2_b32 s62,0x7ff,s54
v_lshl_or_b32 v121,s62,8,v121
s_add_u32 s59,s59,8192
buffer_store_dword v121,v120,s[8:11],s59 offen sc1
s_add_u32 s59,s59,8192
buffer_store_dword v121,v120,s[8:11],s59 offen sc1
s_add_u32 s59,s59,8192
buffer_store_dword v121,v120,s[8:11],s59 offen sc1
s_add_u32 s59,s59,8192
buffer_store_dword v121,v120,s[8:11],s59 offen sc1
s_add_u32 s59,s59,8192
buffer_store_dword v121,v120,s[8:11],s59 offen sc1
s_add_u32 s59,s59,8192
buffer_store_dword v121,v120,s[8:11],s59 offen sc1
L_mo_397:
s_add_u32 s31,s31,1
s_cmp_gt_i32 s77,0
s_cmov_b32 s18,0
s_cbranch_scc1 L_mo_394
s_cmp_lg_u32 s77,0
s_cbranch_scc1 L_mo_398
s_andn2_b32 s51,0x7ff,s54
s_lshr_b32 s51,s51,5
s_add_u32 s73,s73,2
s_mov_b32 s86,1
s_mov_b32 s19,0
s_mov_b32 s18,0
s_waitcnt vmcnt(8)
s_barrier
s_andn2_b32 s64,0x7ff,s54
s_lshl_b32 s56,s64,10
s_add_u32 s58,s56,4194304
buffer_load_dwordx4 v[88:91],v0,s[8:11],s58 offen sc1
v_and_b32 v9,15,v1
v_lshrrev_b32 v10,4,v1
v_and_b32 v124,1,v1
v_lshlrev_b32 v124,4,v124
v_mov_b32 v125,0xffff
v_lshlrev_b32 v125,v124,v125
v_lshrrev_b32 v124,2,v9
v_cmp_eq_u32 vcc,0,v124
s_nop 1
v_cndmask_b32 v12,0,v125,vcc
v_cmp_eq_u32 vcc,1,v124
s_nop 1
v_cndmask_b32 v13,0,v125,vcc
v_and_b32 v124,2,v1
v_cmp_eq_u32 vcc,0,v124
v_mov_b32 v14,0xeeee
v_mov_b32 v124,0x4444
v_cndmask_b32 v14,v14,v124,vcc
v_lshlrev_b32 v11,14,v10
v_lshl_add_u32 v11,v9,4,v11
s_lshl_b32 s65,s51,15
s_add_u32 s65,s65,92274688
s_lshl_b32 s62,s47,10
s_add_u32 s62,s62,s65
s_lshl_b32 s63,s47,16
s_lshl_b32 s60,s46,8
s_add_u32 s63,s63,s60
s_mov_b32 s4,s38
s_mov_b32 s5,s39
s_mov_b32 s6,1835008
s_mov_b32 s7,0x20000
s_lshl_b32 s57,s46,11
s_add_u32 s57,s57,139264
v_add_u32 v8,s57,v0
v_and_b32 v2,1,v10
v_lshrrev_b32 v3,1,v10
v_lshlrev_b32 v2,7,v2
v_lshl_add_u32 v2,v3,10,v2
s_lshl_b32 s59,s46,8
s_add_u32 s59,s57,s59
v_add_u32 v2,s59,v2
s_mov_b32 s60,0x01000100
s_mov_b32 s61,0x03020302
s_waitcnt vmcnt(0)
L_mx_409:
v_max3_u32 v124,v88,v89,v90
v_max_u32 v124,v91,v124
v_cmp_eq_u32 vcc,-1,v124
s_cbranch_vccz L_mxd_410
buffer_load_dwordx4 v[88:91],v0,s[8:11],s58 offen sc1
s_sub_u32 s49,s49,1
s_cbranch_scc1 L_abort2
s_waitcnt vmcnt(0)
s_branch L_mx_409
L_mxd_410:
buffer_load_dwordx4 v[24:27],v11,s[4:7],s63 offen offset:0
buffer_load_dwordx4 v[28:31],v11,s[4:7],s63 offen offset:1024
buffer_load_dwordx4 v[32:35],v11,s[4:7],s63 offen offset:2048
buffer_load_dwordx4 v[36:39],v11,s[4:7],s63 offen offset:3072
v_lshlrev_b32 v96,16,v88
v_and_b32 v97,0xffff0000,v88
v_lshlrev_b32 v98,16,v89
v_and_b32 v99,0xffff0000,v89
v_lshlrev_b32 v100,16,v90
v_and_b32 v101,0xffff0000,v90
v_lshlrev_b32 v102,16,v91
v_and_b32 v103,0xffff0000,v91
v_readfirstlane_b32 s78,v96
s_nop 1
v_pk_add_f32 v[108:109],v[96:97],s[78:79] op_sel_hi:[1,0] neg_lo:[0,1] neg_hi:[0,1]
v_pk_add_f32 v[110:111],v[98:99],s[78:79] op_sel_hi:[1,0] neg_lo:[0,1] neg_hi:[0,1]
v_pk_add_f32 v[112:113],v[100:101],s[78:79] op_sel_hi:[1,0] neg_lo:[0,1] neg_hi:[0,1]
v_pk_add_f32 v[114:115],v[102:103],s[78:79] op_sel_hi:[1,0] neg_lo:[0,1] neg_hi:[0,1]
v_pk_add_f32 v[116:117],v[108:109],v[110:111]
v_pk_mul_f32 v[118:119],v[108:109],v[108:109]
v_pk_add_f32 v[120:121],v[112:113],v[114:115]
v_pk_fma_f32 v[118:119],v[110:111],v[110:111],v[118:119]
v_pk_add_f32 v[116:117],v[116:117],v[120:121]
v_pk_fma_f32 v[118:119],v[112:113],v[112:113],v[118:119]
v_add_f32 v116,v116,v117
v_pk_fma_f32 v[118:119],v[114:115],v[114:115],v[118:119]
v_add_f32 v118,v118,v119
s_nop 1
v_permlane32_swap_b32 v116,v118
v_add_f32 v116,v116,v118
s_nop 1
v_add_f32_dpp v116,v116,v116 row_ror:8 row_mask:0xf bank_mask:0xf
s_nop 1
v_add_f32_dpp v116,v116,v116 row_ror:4 row_mask:0xf bank_mask:0xf
s_nop 1
v_add_f32_dpp v116,v116,v116 row_ror:2 row_mask:0xf bank_mask:0xf
s_nop 1
v_add_f32_dpp v116,v116,v116 row_ror:1 row_mask:0xf bank_mask:0xf
v_mov_b32 v118,v116
s_nop 1
v_permlane16_swap_b32 v116,v118
v_add_f32 v116,v116,v118
v_mul_f32 v116,0x3b000000,v116
v_mov_b32 v118,v116
s_nop 1
v_permlane32_swap_b32 v116,v118
v_fma_f32 v118,-v116,v116,v118
v_add_f32 v116,s78,v116
v_max_f32 v118,0,v118
v_cvt_pk_bf16_f32 v118,v116,v118
v_lshlrev_b32 v116,16,v118
v_and_b32 v118,0xffff0000,v118
v_add_f32 v118,0x3727c5ac,v118
v_cvt_pk_bf16_f32 v118,v118,v118
v_and_b32 v118,0xffff0000,v118
v_sqrt_f32 v118,v118
v_pk_add_f32 v[108:109],v[96:97],v[116:117] op_sel_hi:[1,0] neg_lo:[0,1] neg_hi:[0,1]
v_pk_add_f32 v[110:111],v[98:99],v[116:117] op_sel_hi:[1,0] neg_lo:[0,1] neg_hi:[0,1]
v_pk_add_f32 v[112:113],v[100:101],v[116:117] op_sel_hi:[1,0] neg_lo:[0,1] neg_hi:[0,1]
v_pk_add_f32 v[114:115],v[102:103],v[116:117] op_sel_hi:[1,0] neg_lo:[0,1] neg_hi:[0,1]
v_cvt_pk_bf16_f32 v118,v118,v118
v_and_b32 v118,0xffff0000,v118
v_rcp_f32 v118,v118
v_cvt_pk_bf16_f32 v104,v108,v109
v_cvt_pk_bf16_f32 v105,v110,v111
v_cvt_pk_bf16_f32 v106,v112,v113
v_cvt_pk_bf16_f32 v107,v114,v115
v_lshlrev_b32 v108,16,v104
v_and_b32 v109,0xffff0000,v104
v_lshlrev_b32 v110,16,v105
v_and_b32 v111,0xffff0000,v105
v_lshlrev_b32 v112,16,v106
v_and_b32 v113,0xffff0000,v106
v_lshlrev_b32 v114,16,v107
v_and_b32 v115,0xffff0000,v107
v_pk_mul_f32 v[108:109],v[108:109],v[118:119] op_sel_hi:[1,0]
v_pk_mul_f32 v[110:111],v[110:111],v[118:119] op_sel_hi:[1,0]
v_pk_mul_f32 v[112:113],v[112:113],v[118:119] op_sel_hi:[1,0]
v_pk_mul_f32 v[114:115],v[114:115],v[118:119] op_sel_hi:[1,0]
v_cvt_pk_bf16_f32 v104,v108,v109
v_cvt_pk_bf16_f32 v105,v110,v111
v_cvt_pk_bf16_f32 v106,v112,v113
v_cvt_pk_bf16_f32 v107,v114,v115
v_perm_b32 v88,v104,v104,s60
v_perm_b32 v89,v105,v105,s60
v_perm_b32 v90,v106,v106,s60
v_perm_b32 v91,v107,v107,s60
ds_write_b128 v8,v[88:91]
v_perm_b32 v92,v104,v104,s61
v_perm_b32 v93,v105,v105,s61
v_perm_b32 v94,v106,v106,s61
v_perm_b32 v95,v107,v107,s61
ds_write_b128 v8,v[92:95] offset:1024
s_mov_b32 s58,s57
ds_read_b128 v[88:91],v2 offset:0
ds_read_b128 v[92:95],v2 offset:64
ds_read_b128 v[108:111],v18 offset:0
ds_read_b128 v[112:115],v18 offset:1024
ds_read_b128 v[64:67],v18 offset:2048
ds_read_b128 v[68:71],v18 offset:3072
ds_read_b128 v[72:75],v18 offset:4096
ds_read_b128 v[76:79],v18 offset:5120
ds_read_b128 v[80:83],v18 offset:6144
ds_read_b128 v[84:87],v18 offset:7168
v_mov_b64 v[116:117],0
v_mov_b64 v[118:119],0
s_waitcnt lgkmcnt(8)
v_and_b32 v120,v12,v88
v_and_b32 v121,v13,v88
v_and_b32 v122,v12,v92
v_and_b32 v123,v13,v92
s_waitcnt lgkmcnt(6)
s_nop 0
v_smfmac_f32_16x16x64_bf16 v[116:119],v[120:123],v[108:115],v14
ds_read_b128 v[108:111],v18 offset:8192
ds_read_b128 v[112:115],v18 offset:9216
s_add_u32 s63,s63,4096
buffer_load_dwordx4 v[40:43],v11,s[4:7],s63 offen offset:0
v_and_b32 v124,v12,v89
v_and_b32 v125,v13,v89
v_and_b32 v126,v12,v93
v_and_b32 v127,v13,v93
s_waitcnt lgkmcnt(6)
s_nop 0
v_smfmac_f32_16x16x64_bf16 v[116:119],v[124:127],v[64:71],v14
ds_read_b128 v[64:67],v18 offset:10240
ds_read_b128 v[68:71],v18 offset:11264
buffer_load_dwordx4 v[44:47],v11,s[4:7],s63 offen offset:1024
v_and_b32 v120,v12,v90
v_and_b32 v121,v13,v90
v_and_b32 v122,v12,v94
v_and_b32 v123,v13,v94
s_waitcnt lgkmcnt(6)
s_nop 0
v_smfmac_f32_16x16x64_bf16 v[116:119],v[120:123],v[72:79],v14
ds_read_b128 v[72:75],v18 offset:12288
ds_read_b128 v[76:79],v18 offset:13312
buffer_load_dwordx4 v[48:51],v11,s[4:7],s63 offen offset:2048
v_and_b32 v124,v12,v91
v_and_b32 v125,v13,v91
v_and_b32 v126,v12,v95
v_and_b32 v127,v13,v95
ds_read_b128 v[88:91],v2 offset:16
ds_read_b128 v[92:95],v2 offset:80
s_waitcnt lgkmcnt(8)
v_smfmac_f32_16x16x64_bf16 v[116:119],v[124:127],v[80:87],v14
ds_read_b128 v[80:83],v18 offset:14336
ds_read_b128 v[84:87],v18 offset:15360
buffer_load_dwordx4 v[52:55],v11,s[4:7],s63 offen offset:3072
s_waitcnt lgkmcnt(2)
v_and_b32 v120,v12,v88
v_and_b32 v121,v13,v88
v_and_b32 v122,v12,v92
v_and_b32 v123,v13,v92
s_waitcnt lgkmcnt(8)
s_nop 0
v_smfmac_f32_16x16x64_bf16 v[116:119],v[120:123],v[108:115],v14
ds_read_b128 v[108:111],v18 offset:16384
ds_read_b128 v[112:115],v18 offset:17408
s_add_u32 s63,s63,4096
buffer_load_dwordx4 v[56:59],v11,s[4:7],s63 offen offset:0
v_and_b32 v124,v12,v89
v_and_b32 v125,v13,v89
v_and_b32 v126,v12,v93
v_and_b32 v127,v13,v93
s_waitcnt lgkmcnt(8)
s_nop 0
v_smfmac_f32_16x16x64_bf16 v[116:119],v[124:127],v[64:71],v14
ds_read_b128 v[64:67],v18 offset:18432
ds_read_b128 v[68:71],v18 offset:19456
buffer_load_dwordx4 v[60:63],v11,s[4:7],s63 offen offset:1024
v_and_b32 v120,v12,v90
v_and_b32 v121,v13,v90
v_and_b32 v122,v12,v94
v_and_b32 v123,v13,v94
s_waitcnt lgkmcnt(8)
s_nop 0
v_smfmac_f32_16x16x64_bf16 v[116:119],v[120:123],v[72:79],v14
ds_read_b128 v[72:75],v18 offset:20480
ds_read_b128 v[76:79],v18 offset:21504
v_and_b32 v124,v12,v91
v_and_b32 v125,v13,v91
v_and_b32 v126,v12,v95
v_and_b32 v127,v13,v95
ds_read_b128 v[88:91],v2 offset:32
ds_read_b128 v[92:95],v2 offset:96
s_waitcnt lgkmcnt(8)
v_smfmac_f32_16x16x64_bf16 v[116:119],v[124:127],v[80:87],v14
ds_read_b128 v[80:83],v18 offset:22528
ds_read_b128 v[84:87],v18 offset:23552
s_waitcnt lgkmcnt(2)
v_and_b32 v120,v12,v88
v_and_b32 v121,v13,v88
v_and_b32 v122,v12,v92
v_and_b32 v123,v13,v92
s_waitcnt lgkmcnt(8)
s_nop 0
v_smfmac_f32_16x16x64_bf16 v[116:119],v[120:123],v[108:115],v14
ds_read_b128 v[108:111],v18 offset:24576
ds_read_b128 v[112:115],v18 offset:25600
v_and_b32 v124,v12,v89
v_and_b32 v125,v13,v89
v_and_b32 v126,v12,v93
v_and_b32 v127,v13,v93
s_waitcnt lgkmcnt(8)
s_nop 0
v_smfmac_f32_16x16x64_bf16 v[116:119],v[124:127],v[64:71],v14
ds_read_b128 v[64:67],v18 offset:26624
ds_read_b128 v[68:71],v18 offset:27648
v_and_b32 v120,v12,v90
v_and_b32 v121,v13,v90
v_and_b32 v122,v12,v94
v_and_b32 v123,v13,v94
s_waitcnt lgkmcnt(8)
s_nop 0
v_smfmac_f32_16x16x64_bf16 v[116:119],v[120:123],v[72:79],v14
ds_read_b128 v[72:75],v18 offset:28672
ds_read_b128 v[76:79],v18 offset:29696
v_and_b32 v124,v12,v91
v_and_b32 v125,v13,v91
v_and_b32 v126,v12,v95
v_and_b32 v127,v13,v95
ds_read_b128 v[88:91],v2 offset:48
ds_read_b128 v[92:95],v2 offset:112
s_waitcnt lgkmcnt(8)
v_smfmac_f32_16x16x64_bf16 v[116:119],v[124:127],v[80:87],v14
ds_read_b128 v[80:83],v18 offset:30720
ds_read_b128 v[84:87],v18 offset:31744
s_waitcnt lgkmcnt(2)
v_and_b32 v120,v12,v88
v_and_b32 v121,v13,v88
v_and_b32 v122,v12,v92
v_and_b32 v123,v13,v92
s_waitcnt lgkmcnt(8)
s_nop 0
v_smfmac_f32_16x16x64_bf16 v[116:119],v[120:123],v[108:115],v14
v_and_b32 v124,v12,v89
v_and_b32 v125,v13,v89
v_and_b32 v126,v12,v93
v_and_b32 v127,v13,v93
s_waitcnt lgkmcnt(6)
s_nop 0
v_smfmac_f32_16x16x64_bf16 v[116:119],v[124:127],v[64:71],v14
buffer_load_dwordx4 v[64:67],v11,s[4:7],s63 offen offset:2048
buffer_load_dwordx4 v[68:71],v11,s[4:7],s63 offen offset:3072
v_and_b32 v120,v12,v90
v_and_b32 v121,v13,v90
v_and_b32 v122,v12,v94
v_and_b32 v123,v13,v94
s_waitcnt lgkmcnt(4)
s_nop 0
v_smfmac_f32_16x16x64_bf16 v[116:119],v[120:123],v[72:79],v14
s_add_u32 s63,s63,4096
buffer_load_dwordx4 v[72:75],v11,s[4:7],s63 offen offset:0
buffer_load_dwordx4 v[76:79],v11,s[4:7],s63 offen offset:1024
v_and_b32 v124,v12,v91
v_and_b32 v125,v13,v91
v_and_b32 v126,v12,v95
v_and_b32 v127,v13,v95
s_waitcnt lgkmcnt(0)
s_nop 0
v_smfmac_f32_16x16x64_bf16 v[116:119],v[124:127],v[80:87],v14
buffer_load_dwordx4 v[80:83],v11,s[4:7],s63 offen offset:2048
buffer_load_dwordx4 v[84:87],v11,s[4:7],s63 offen offset:3072
v_lshlrev_b32 v8,5,v9
v_and_b32 v124,1,v10
v_lshl_add_u32 v8,v124,4,v8
v_lshrrev_b32 v124,1,v10
v_lshl_add_u32 v8,v124,11,v8
s_lshl_b32 s60,s46,9
s_add_u32 s60,s60,147456
v_add_u32 v8,s60,v8
ds_write_b128 v8,v[116:119]
v_lshlrev_b32 v8,2,v1
v_add_u32 v8,147456,v8
v_and_b32 v2,1,v1
v_lshrrev_b32 v3,1,v1
v_lshlrev_b32 v3,2,v3
v_lshl_add_u32 v2,v2,7,v3
v_add_u32 v2,s58,v2
v_lshlrev_b32 v3,6,v10
v_add_u32 v3,s58,v3
s_waitcnt lgkmcnt(0)
s_barrier
ds_read2st64_b32 v[88:89],v8 offset0:0 offset1:1
ds_read2st64_b32 v[90:91],v8 offset0:2 offset1:3
ds_read2st64_b32 v[92:93],v8 offset0:4 offset1:5
ds_read2st64_b32 v[94:95],v8 offset0:6 offset1:7
s_waitcnt lgkmcnt(0)
v_pk_add_f32 v[88:89],v[88:89],v[90:91]
v_pk_add_f32 v[92:93],v[92:93],v[94:95]
v_pk_add_f32 v[88:89],v[88:89],v[92:93]
v_cvt_pk_bf16_f32 v88,v88,v88
v_and_b32 v88,0xffff0000,v88
v_cvt_pk_bf16_f32 v89,v89,v89
v_and_b32 v89,0xffff0000,v89
v_mul_f32 v90,0xbfb8aa3b,v88
v_exp_f32 v90,v90
s_nop 0
v_add_f32 v90,1.0,v90
v_rcp_f32 v90,v90
s_nop 0
v_mul_f32 v88,v88,v90
v_cvt_pk_bf16_f32 v88,v88,v88
v_and_b32 v88,0xffff0000,v88
v_mul_f32 v88,v88,v89
v_cvt_pk_bf16_f32 v88,v88,v88
ds_write_b32 v2,v88
ds_read_b128 v[88:91],v3
ds_read_b128 v[108:111],v3 offset:32
ds_read_b128 v[92:95],v3 offset:16
ds_read_b128 v[112:115],v3 offset:48
v_mov_b64 v[116:117],0
v_mov_b64 v[118:119],0
s_waitcnt vmcnt(0) lgkmcnt(0)
v_and_b32 v120,v12,v88
v_and_b32 v121,v13,v88
v_and_b32 v122,v12,v108
v_and_b32 v123,v13,v108
v_and_b32 v124,v12,v89
v_and_b32 v125,v13,v89
v_smfmac_f32_16x16x64_bf16 v[116:119],v[120:123],v[24:31],v14
v_and_b32 v126,v12,v109
v_and_b32 v127,v13,v109
v_and_b32 v120,v12,v90
v_and_b32 v121,v13,v90
v_smfmac_f32_16x16x64_bf16 v[116:119],v[124:127],v[32:39],v14
v_and_b32 v122,v12,v110
v_and_b32 v123,v13,v110
v_and_b32 v124,v12,v91
v_and_b32 v125,v13,v91
v_smfmac_f32_16x16x64_bf16 v[116:119],v[120:123],v[40:47],v14
v_and_b32 v126,v12,v111
v_and_b32 v127,v13,v111
v_and_b32 v120,v12,v92
v_and_b32 v121,v13,v92
v_smfmac_f32_16x16x64_bf16 v[116:119],v[124:127],v[48:55],v14
v_and_b32 v122,v12,v112
v_and_b32 v123,v13,v112
v_and_b32 v124,v12,v93
v_and_b32 v125,v13,v93
v_smfmac_f32_16x16x64_bf16 v[116:119],v[120:123],v[56:63],v14
v_and_b32 v126,v12,v113
v_and_b32 v127,v13,v113
v_and_b32 v120,v12,v94
v_and_b32 v121,v13,v94
v_smfmac_f32_16x16x64_bf16 v[116:119],v[124:127],v[64:71],v14
v_and_b32 v122,v12,v114
v_and_b32 v123,v13,v114
v_and_b32 v124,v12,v95
v_and_b32 v125,v13,v95
v_smfmac_f32_16x16x64_bf16 v[116:119],v[120:123],v[72:79],v14
v_and_b32 v126,v12,v115
v_and_b32 v127,v13,v115
s_nop 1
v_smfmac_f32_16x16x64_bf16 v[116:119],v[124:127],v[80:87],v14
v_lshlrev_b32 v8,4,v9
v_and_b32 v124,1,v10
v_lshl_add_u32 v8,v124,3,v8
v_and_b32 v124,2,v10
v_lshl_add_u32 v8,v124,30,v8
s_lshl_b32 s60,s46,8
s_add_u32 s59,s62,s60
s_nop 0
v_cvt_pk_bf16_f32 v88,v116,v117
v_cvt_pk_bf16_f32 v89,v118,v119
buffer_store_dwordx2 v[88:89],v8,s[8:11],s59 offen sc1
s_lshl_b32 s59,s51,13
s_lshl2_add_u32 s59,s47,s59
s_add_u32 s59,s59,10486912
s_waitcnt vmcnt(0)
s_barrier
s_or_b32 s59,s59,s52
buffer_store_dword v17,off,s[8:11],s59 sc1
s_lshl_b32 s59,s51,13
s_add_u32 s59,s59,10486912
v_and_b32 v124,31,v1
v_lshlrev_b32 v124,2,v124
L_fw_412:
buffer_load_dword v125,v124,s[8:11],s59 offen sc1
s_sub_u32 s49,s49,1
s_cbranch_scc1 L_abort2
s_waitcnt vmcnt(0)
v_cmp_eq_u32 vcc,0,v125
s_cbranch_vccnz L_fw_412
s_add_u32 s63,s65,0
buffer_load_dwordx4 v[24:27],v22,s[8:11],s63 offen sc1
s_add_u32 s63,s65,4096
buffer_load_dwordx4 v[28:31],v22,s[8:11],s63 offen sc1
s_add_u32 s63,s65,8192
buffer_load_dwordx4 v[32:35],v22,s[8:11],s63 offen sc1
s_add_u32 s63,s65,12288
buffer_load_dwordx4 v[36:39],v22,s[8:11],s63 offen sc1
s_add_u32 s63,s65,16384
buffer_load_dwordx4 v[40:43],v22,s[8:11],s63 offen sc1
s_add_u32 s63,s65,20480
buffer_load_dwordx4 v[44:47],v22,s[8:11],s63 offen sc1
s_add_u32 s63,s65,24576
buffer_load_dwordx4 v[48:51],v22,s[8:11],s63 offen sc1
s_add_u32 s63,s65,28672
buffer_load_dwordx4 v[52:55],v22,s[8:11],s63 offen sc1
v_and_b32 v64,15,v1
v_and_b32 v65,1,v1
v_lshlrev_b32 v65,4,v65
v_mov_b32 v66,0x3f80
v_lshlrev_b32 v66,v65,v66
v_lshrrev_b32 v64,1,v64
v_cmp_eq_u32 vcc,0,v64
s_nop 1
v_cndmask_b32 v56,0,v66,vcc
v_cmp_eq_u32 vcc,1,v64
s_nop 1
v_cndmask_b32 v57,0,v66,vcc
v_cmp_eq_u32 vcc,2,v64
s_nop 1
v_cndmask_b32 v58,0,v66,vcc
v_cmp_eq_u32 vcc,3,v64
s_nop 1
v_cndmask_b32 v59,0,v66,vcc
s_waitcnt vmcnt(7)
s_nop 0
v_mfma_f32_16x16x32_bf16 v[60:63],v[56:59],v[24:27],0
s_waitcnt vmcnt(6)
v_mfma_f32_16x16x32_bf16 v[60:63],v[56:59],v[28:31],v[60:63]
s_waitcnt vmcnt(5)
v_mfma_f32_16x16x32_bf16 v[60:63],v[56:59],v[32:35],v[60:63]
s_waitcnt vmcnt(4)
v_mfma_f32_16x16x32_bf16 v[60:63],v[56:59],v[36:39],v[60:63]
s_waitcnt vmcnt(3)
v_mfma_f32_16x16x32_bf16 v[60:63],v[56:59],v[40:43],v[60:63]
s_waitcnt vmcnt(2)
v_mfma_f32_16x16x32_bf16 v[60:63],v[56:59],v[44:47],v[60:63]
s_waitcnt vmcnt(1)
v_mfma_f32_16x16x32_bf16 v[60:63],v[56:59],v[48:51],v[60:63]
s_waitcnt vmcnt(0)
v_mfma_f32_16x16x32_bf16 v[60:63],v[56:59],v[52:55],v[60:63]
s_nop 7
ds_write_b128 v21,v[60:63]
s_waitcnt lgkmcnt(0)
s_barrier
s_cmp_lg_u32 s46,0
s_cbranch_scc1 L_moed_411
v_lshlrev_b32 v56,5,v1
v_add_u32 v56,155648,v56
ds_read_b128 v[24:27],v56
ds_read_b128 v[28:31],v56 offset:16
s_and_b32 s59,s54,0xffff0000
s_xor_b32 s60,s59,0x80000000
s_xor_b32 s61,s59,0xffff0000
s_cmp_lt_i32 s59,0
s_cselect_b32 s59,s60,s61
v_mov_b32 v56,s59
v_mul_f32 v56,0xbfb8aa3b,v56
v_exp_f32 v56,v56
s_nop 0
v_add_f32 v56,1.0,v56
v_rcp_f32 v56,v56
s_nop 0
v_cvt_pk_bf16_f32 v56,v56,v56
v_and_b32 v56,0xffff0000,v56
v_lshlrev_b32 v48,16,v104
v_and_b32 v49,0xffff0000,v104
v_lshlrev_b32 v50,16,v105
v_and_b32 v51,0xffff0000,v105
v_lshlrev_b32 v52,16,v106
v_and_b32 v53,0xffff0000,v106
v_lshlrev_b32 v54,16,v107
v_and_b32 v55,0xffff0000,v107
s_waitcnt lgkmcnt(0)
v_cvt_pk_bf16_f32 v40,v24,v25
v_cvt_pk_bf16_f32 v41,v26,v27
v_cvt_pk_bf16_f32 v42,v28,v29
v_cvt_pk_bf16_f32 v43,v30,v31
v_lshlrev_b32 v24,16,v40
v_and_b32 v25,0xffff0000,v40
v_lshlrev_b32 v26,16,v41
v_and_b32 v27,0xffff0000,v41
v_lshlrev_b32 v28,16,v42
v_and_b32 v29,0xffff0000,v42
v_lshlrev_b32 v30,16,v43
v_and_b32 v31,0xffff0000,v43
v_pk_mul_f32 v[24:25],v[24:25],v[56:57] op_sel_hi:[1,0]
v_pk_mul_f32 v[26:27],v[26:27],v[56:57] op_sel_hi:[1,0]
v_pk_mul_f32 v[28:29],v[28:29],v[56:57] op_sel_hi:[1,0]
v_pk_mul_f32 v[30:31],v[30:31],v[56:57] op_sel_hi:[1,0]
v_cvt_pk_bf16_f32 v40,v24,v25
v_cvt_pk_bf16_f32 v41,v26,v27
v_cvt_pk_bf16_f32 v42,v28,v29
v_cvt_pk_bf16_f32 v43,v30,v31
v_lshlrev_b32 v24,16,v40
v_and_b32 v25,0xffff0000,v40
v_lshlrev_b32 v26,16,v41
v_and_b32 v27,0xffff0000,v41
v_lshlrev_b32 v28,16,v42
v_and_b32 v29,0xffff0000,v42
v_lshlrev_b32 v30,16,v43
v_and_b32 v31,0xffff0000,v43
v_pk_add_f32 v[24:25],v[24:25],v[48:49]
v_pk_add_f32 v[26:27],v[26:27],v[50:51]
v_pk_add_f32 v[28:29],v[28:29],v[52:53]
v_pk_add_f32 v[30:31],v[30:31],v[54:55]
v_cvt_pk_bf16_f32 v40,v24,v25
v_cvt_pk_bf16_f32 v41,v26,v27
v_cvt_pk_bf16_f32 v42,v28,v29
v_cvt_pk_bf16_f32 v43,v30,v31
v_lshlrev_b32 v24,16,v40
v_and_b32 v25,0xffff0000,v40
v_lshlrev_b32 v26,16,v41
v_and_b32 v27,0xffff0000,v41
v_lshlrev_b32 v28,16,v42
v_and_b32 v29,0xffff0000,v42
v_lshlrev_b32 v30,16,v43
v_and_b32 v31,0xffff0000,v43
v_pk_add_f32 v[96:97],v[96:97],v[24:25]
v_pk_add_f32 v[98:99],v[98:99],v[26:27]
v_pk_add_f32 v[100:101],v[100:101],v[28:29]
v_pk_add_f32 v[102:103],v[102:103],v[30:31]
v_cvt_pk_bf16_f32 v80,v96,v97
v_cvt_pk_bf16_f32 v81,v98,v99
v_cvt_pk_bf16_f32 v82,v100,v101
v_cvt_pk_bf16_f32 v83,v102,v103
v_lshlrev_b32 v96,16,v80
v_and_b32 v97,0xffff0000,v80
v_lshlrev_b32 v98,16,v81
v_and_b32 v99,0xffff0000,v81
v_lshlrev_b32 v100,16,v82
v_and_b32 v101,0xffff0000,v82
v_lshlrev_b32 v102,16,v83
v_and_b32 v103,0xffff0000,v83
v_readfirstlane_b32 s78,v96
s_nop 1
v_pk_add_f32 v[58:59],v[96:97],s[78:79] op_sel_hi:[1,0] neg_lo:[0,1] neg_hi:[0,1]
v_pk_add_f32 v[60:61],v[98:99],s[78:79] op_sel_hi:[1,0] neg_lo:[0,1] neg_hi:[0,1]
v_pk_add_f32 v[62:63],v[100:101],s[78:79] op_sel_hi:[1,0] neg_lo:[0,1] neg_hi:[0,1]
v_pk_add_f32 v[64:65],v[102:103],s[78:79] op_sel_hi:[1,0] neg_lo:[0,1] neg_hi:[0,1]
v_pk_add_f32 v[66:67],v[58:59],v[60:61]
v_pk_mul_f32 v[68:69],v[58:59],v[58:59]
v_pk_add_f32 v[70:71],v[62:63],v[64:65]
v_pk_fma_f32 v[68:69],v[60:61],v[60:61],v[68:69]
v_pk_add_f32 v[66:67],v[66:67],v[70:71]
v_pk_fma_f32 v[68:69],v[62:63],v[62:63],v[68:69]
v_add_f32 v66,v66,v67
v_pk_fma_f32 v[68:69],v[64:65],v[64:65],v[68:69]
v_add_f32 v68,v68,v69
s_nop 1
v_permlane32_swap_b32 v66,v68
v_add_f32 v66,v66,v68
s_nop 1
v_add_f32_dpp v66,v66,v66 row_ror:8 row_mask:0xf bank_mask:0xf
s_nop 1
v_add_f32_dpp v66,v66,v66 row_ror:4 row_mask:0xf bank_mask:0xf
s_nop 1
v_add_f32_dpp v66,v66,v66 row_ror:2 row_mask:0xf bank_mask:0xf
s_nop 1
v_add_f32_dpp v66,v66,v66 row_ror:1 row_mask:0xf bank_mask:0xf
v_mov_b32 v68,v66
s_nop 1
v_permlane16_swap_b32 v66,v68
v_add_f32 v66,v66,v68
v_mul_f32 v66,0x3b000000,v66
v_mov_b32 v68,v66
s_nop 1
v_permlane32_swap_b32 v66,v68
v_fma_f32 v68,-v66,v66,v68
v_add_f32 v66,s78,v66
v_max_f32 v68,0,v68
v_cvt_pk_bf16_f32 v68,v66,v68
v_lshlrev_b32 v66,16,v68
v_and_b32 v68,0xffff0000,v68
v_add_f32 v68,0x3727c5ac,v68
v_cvt_pk_bf16_f32 v68,v68,v68
v_and_b32 v68,0xffff0000,v68
v_sqrt_f32 v68,v68
v_pk_add_f32 v[58:59],v[96:97],v[66:67] op_sel_hi:[1,0] neg_lo:[0,1] neg_hi:[0,1]
v_pk_add_f32 v[60:61],v[98:99],v[66:67] op_sel_hi:[1,0] neg_lo:[0,1] neg_hi:[0,1]
v_pk_add_f32 v[62:63],v[100:101],v[66:67] op_sel_hi:[1,0] neg_lo:[0,1] neg_hi:[0,1]
v_pk_add_f32 v[64:65],v[102:103],v[66:67] op_sel_hi:[1,0] neg_lo:[0,1] neg_hi:[0,1]
v_cvt_pk_bf16_f32 v68,v68,v68
v_and_b32 v68,0xffff0000,v68
v_rcp_f32 v68,v68
v_cvt_pk_bf16_f32 v84,v58,v59
v_cvt_pk_bf16_f32 v85,v60,v61
v_cvt_pk_bf16_f32 v86,v62,v63
v_cvt_pk_bf16_f32 v87,v64,v65
v_lshlrev_b32 v58,16,v84
v_and_b32 v59,0xffff0000,v84
v_lshlrev_b32 v60,16,v85
v_and_b32 v61,0xffff0000,v85
v_lshlrev_b32 v62,16,v86
v_and_b32 v63,0xffff0000,v86
v_lshlrev_b32 v64,16,v87
v_and_b32 v65,0xffff0000,v87
v_pk_mul_f32 v[58:59],v[58:59],v[68:69] op_sel_hi:[1,0]
v_pk_mul_f32 v[60:61],v[60:61],v[68:69] op_sel_hi:[1,0]
v_pk_mul_f32 v[62:63],v[62:63],v[68:69] op_sel_hi:[1,0]
v_pk_mul_f32 v[64:65],v[64:65],v[68:69] op_sel_hi:[1,0]
v_cvt_pk_bf16_f32 v84,v58,v59
v_cvt_pk_bf16_f32 v85,v60,v61
v_cvt_pk_bf16_f32 v86,v62,v63
v_cvt_pk_bf16_f32 v87,v64,v65
s_lshl_b32 s58,s51,10
s_add_u32 s58,s58,11272192
s_add_u32 s59,s58,65536
s_cmp_eq_u32 s47,0
s_cselect_b32 s59,s59,0x80000000
s_add_u32 s57,s56,98566144
buffer_store_dwordx4 v[84:87],v0,s[8:11],s59 offen sc1
buffer_store_dwordx4 v[80:83],v0,s[8:11],s58 offen sc1
buffer_store_dwordx4 v[84:87],v0,s[8:11],s57 offen sc1
L_moed_411:
s_barrier
L_mo_398:
s_mov_b32 s77,-1
s_cmp_lt_u32 s31,64
s_cbranch_scc1 L_mo_394
s_cmp_eq_u32 s86,0
s_cbranch_scc1 L_mo_407
L_mo_400:
s_andn2_b32 s51,0x7ff,s54
s_lshr_b32 s51,s51,5
s_andn2_b32 s56,31,s54
v_lshrrev_b32 v2,10,v20
v_add_u32 v3,16,v2
v_add_u32 v8,96468992,v20
v_cmp_eq_u32 vcc,s56,v2
s_nop 1
v_cndmask_b32 v2,v20,v8,vcc
v_cmp_eq_u32 vcc,s56,v3
s_nop 1
v_cndmask_b32 v3,v20,v8,vcc
s_waitcnt vmcnt(0)
s_lshl_b32 s59,s51,13
s_add_u32 s59,s59,10487552
s_cmp_lg_u32 s46,0
s_cbranch_scc1 L_fd_416
v_and_b32 v124,31,v1
v_lshlrev_b32 v124,2,v124
s_branch L_ff_417
L_fw_415:
s_sleep 2
L_ff_417:
buffer_load_dword v125,v124,s[8:11],s59 offen sc1
s_sub_u32 s49,s49,1
s_cbranch_scc1 L_abort2
s_waitcnt vmcnt(0)
v_cmp_eq_u32 vcc,0,v125
s_cbranch_vccnz L_fw_415
L_fd_416:
s_barrier
s_or_b32 s72,s72,s52
buffer_store_dword v17,off,s[8:11],s72 sc1
s_lshl_b32 s66,s51,15
s_add_u32 s66,s66,2097152
s_add_u32 s67,s66,16384
s_add_u32 m0,s50,131072
s_nop 0
buffer_load_dwordx4 v2,s[8:11],s66 offen offset:0 sc1 lds
s_add_u32 m0,s50,135168
s_nop 0
buffer_load_dwordx4 v3,s[8:11],s67 offen offset:0 sc1 lds
s_add_u32 m0,s50,139008
s_nop 0
buffer_load_dwordx4 v2,s[8:11],s66 offen offset:256 sc1 lds
s_add_u32 m0,s50,143104
s_nop 0
buffer_load_dwordx4 v3,s[8:11],s67 offen offset:256 sc1 lds
s_add_u32 m0,s50,146944
s_nop 0
buffer_load_dwordx4 v2,s[8:11],s66 offen offset:512 sc1 lds
s_add_u32 m0,s50,151040
s_nop 0
buffer_load_dwordx4 v3,s[8:11],s67 offen offset:512 sc1 lds
s_waitcnt vmcnt(4)
s_barrier
ds_read_b128 v[104:107],v4 offset:0
ds_read_b128 v[108:111],v4 offset:4096
ds_read_b128 v[112:115],v5 offset:0
ds_read_b128 v[116:119],v5 offset:4096
s_add_u32 m0,s50,154880
s_nop 0
buffer_load_dwordx4 v2,s[8:11],s66 offen offset:768 sc1 lds
s_add_u32 m0,s50,158976
s_nop 0
buffer_load_dwordx4 v3,s[8:11],s67 offen offset:768 sc1 lds
s_waitcnt lgkmcnt(2)
v_mfma_f32_16x16x32_bf16 v[24:27],a[128:131],v[104:107],0
ds_read_b128 v[120:123],v6 offset:0
v_mfma_f32_16x16x32_bf16 v[40:43],v[104:107],v[128:131],0
s_lshl_b32 s58,s51,5
v_mfma_f32_16x16x32_bf16 v[28:31],a[128:131],v[108:111],0
ds_read_b128 v[124:127],v6 offset:4096
v_mfma_f32_16x16x32_bf16 v[44:47],v[108:111],v[128:131],0
s_add_u32 s58,s58,s47
v_mfma_f32_16x16x32_bf16 v[32:35],a[136:139],v[104:107],0
s_mul_i32 s58,s58,24576
v_mfma_f32_16x16x32_bf16 v[48:51],v[104:107],v[136:139],0
s_add_u32 s58,s58,201326592
v_mfma_f32_16x16x32_bf16 v[36:39],a[136:139],v[108:111],0
s_add_u32 s61,s58,s50
v_mfma_f32_16x16x32_bf16 v[52:55],v[108:111],v[136:139],0
s_add_u32 s62,s61,4096
s_waitcnt lgkmcnt(2)
v_mfma_f32_16x16x32_bf16 v[24:27],a[132:135],v[112:115],v[24:27]
ds_read_b128 v[104:107],v7 offset:0
v_mfma_f32_16x16x32_bf16 v[40:43],v[112:115],v[132:135],v[40:43]
s_add_u32 s63,s61,16384
v_mfma_f32_16x16x32_bf16 v[28:31],a[132:135],v[116:119],v[28:31]
ds_read_b128 v[108:111],v7 offset:4096
v_mfma_f32_16x16x32_bf16 v[44:47],v[116:119],v[132:135],v[44:47]
s_add_u32 s64,s61,20480
v_mfma_f32_16x16x32_bf16 v[32:35],a[140:143],v[112:115],v[32:35]
s_add_u32 s65,s61,s50
v_mfma_f32_16x16x32_bf16 v[48:51],v[112:115],v[140:143],v[48:51]
s_add_u32 s65,s65,8192
v_mfma_f32_16x16x32_bf16 v[36:39],a[140:143],v[116:119],v[36:39]
v_mfma_f32_16x16x32_bf16 v[52:55],v[116:119],v[140:143],v[52:55]
s_waitcnt vmcnt(4)
s_barrier
s_waitcnt lgkmcnt(2)
v_mfma_f32_16x16x32_bf16 v[24:27],a[144:147],v[120:123],v[24:27]
ds_read_b128 v[112:115],v4 offset:8192
v_mfma_f32_16x16x32_bf16 v[40:43],v[120:123],v[144:147],v[40:43]
v_mfma_f32_16x16x32_bf16 v[28:31],a[144:147],v[124:127],v[28:31]
ds_read_b128 v[116:119],v4 offset:12288
v_mfma_f32_16x16x32_bf16 v[44:47],v[124:127],v[144:147],v[44:47]
v_mfma_f32_16x16x32_bf16 v[32:35],a[152:155],v[120:123],v[32:35]
v_mfma_f32_16x16x32_bf16 v[48:51],v[120:123],v[152:155],v[48:51]
v_mfma_f32_16x16x32_bf16 v[36:39],a[152:155],v[124:127],v[36:39]
v_mfma_f32_16x16x32_bf16 v[52:55],v[124:127],v[152:155],v[52:55]
s_waitcnt lgkmcnt(2)
v_mfma_f32_16x16x32_bf16 v[24:27],a[148:151],v[104:107],v[24:27]
ds_read_b128 v[120:123],v5 offset:8192
v_mfma_f32_16x16x32_bf16 v[40:43],v[104:107],v[148:151],v[40:43]
v_mfma_f32_16x16x32_bf16 v[28:31],a[148:151],v[108:111],v[28:31]
ds_read_b128 v[124:127],v5 offset:12288
v_mfma_f32_16x16x32_bf16 v[44:47],v[108:111],v[148:151],v[44:47]
v_mfma_f32_16x16x32_bf16 v[32:35],a[156:159],v[104:107],v[32:35]
v_mfma_f32_16x16x32_bf16 v[48:51],v[104:107],v[156:159],v[48:51]
v_mfma_f32_16x16x32_bf16 v[36:39],a[156:159],v[108:111],v[36:39]
v_mfma_f32_16x16x32_bf16 v[52:55],v[108:111],v[156:159],v[52:55]
s_waitcnt lgkmcnt(2)
v_mfma_f32_16x16x32_bf16 v[24:27],a[160:163],v[112:115],v[24:27]
ds_read_b128 v[104:107],v6 offset:8192
v_mfma_f32_16x16x32_bf16 v[40:43],v[112:115],v[160:163],v[40:43]
v_mfma_f32_16x16x32_bf16 v[28:31],a[160:163],v[116:119],v[28:31]
ds_read_b128 v[108:111],v6 offset:12288
v_mfma_f32_16x16x32_bf16 v[44:47],v[116:119],v[160:163],v[44:47]
v_mfma_f32_16x16x32_bf16 v[32:35],a[168:171],v[112:115],v[32:35]
v_mfma_f32_16x16x32_bf16 v[48:51],v[112:115],v[168:171],v[48:51]
v_mfma_f32_16x16x32_bf16 v[36:39],a[168:171],v[116:119],v[36:39]
v_mfma_f32_16x16x32_bf16 v[52:55],v[116:119],v[168:171],v[52:55]
s_waitcnt lgkmcnt(2)
v_mfma_f32_16x16x32_bf16 v[24:27],a[164:167],v[120:123],v[24:27]
ds_read_b128 v[112:115],v7 offset:8192
v_mfma_f32_16x16x32_bf16 v[40:43],v[120:123],v[164:167],v[40:43]
v_mfma_f32_16x16x32_bf16 v[28:31],a[164:167],v[124:127],v[28:31]
ds_read_b128 v[116:119],v7 offset:12288
v_mfma_f32_16x16x32_bf16 v[44:47],v[124:127],v[164:167],v[44:47]
v_mfma_f32_16x16x32_bf16 v[32:35],a[172:175],v[120:123],v[32:35]
v_mfma_f32_16x16x32_bf16 v[48:51],v[120:123],v[172:175],v[48:51]
v_mfma_f32_16x16x32_bf16 v[36:39],a[172:175],v[124:127],v[36:39]
v_mfma_f32_16x16x32_bf16 v[52:55],v[124:127],v[172:175],v[52:55]
s_waitcnt vmcnt(2)
s_barrier
s_waitcnt lgkmcnt(2)
v_mfma_f32_16x16x32_bf16 v[24:27],a[176:179],v[104:107],v[24:27]
ds_read_b128 v[120:123],v4 offset:16384
v_mfma_f32_16x16x32_bf16 v[40:43],v[104:107],v[176:179],v[40:43]
v_mfma_f32_16x16x32_bf16 v[28:31],a[176:179],v[108:111],v[28:31]
ds_read_b128 v[124:127],v4 offset:20480
v_mfma_f32_16x16x32_bf16 v[44:47],v[108:111],v[176:179],v[44:47]
v_mfma_f32_16x16x32_bf16 v[32:35],a[184:187],v[104:107],v[32:35]
v_mfma_f32_16x16x32_bf16 v[48:51],v[104:107],v[184:187],v[48:51]
v_mfma_f32_16x16x32_bf16 v[36:39],a[184:187],v[108:111],v[36:39]
v_mfma_f32_16x16x32_bf16 v[52:55],v[108:111],v[184:187],v[52:55]
s_waitcnt lgkmcnt(2)
v_mfma_f32_16x16x32_bf16 v[24:27],a[180:183],v[112:115],v[24:27]
ds_read_b128 v[104:107],v5 offset:16384
v_mfma_f32_16x16x32_bf16 v[40:43],v[112:115],v[180:183],v[40:43]
v_mfma_f32_16x16x32_bf16 v[28:31],a[180:183],v[116:119],v[28:31]
ds_read_b128 v[108:111],v5 offset:20480
v_mfma_f32_16x16x32_bf16 v[44:47],v[116:119],v[180:183],v[44:47]
v_mfma_f32_16x16x32_bf16 v[32:35],a[188:191],v[112:115],v[32:35]
v_mfma_f32_16x16x32_bf16 v[48:51],v[112:115],v[188:191],v[48:51]
v_mfma_f32_16x16x32_bf16 v[36:39],a[188:191],v[116:119],v[36:39]
v_mfma_f32_16x16x32_bf16 v[52:55],v[116:119],v[188:191],v[52:55]
s_waitcnt lgkmcnt(2)
v_mfma_f32_16x16x32_bf16 v[24:27],a[192:195],v[120:123],v[24:27]
ds_read_b128 v[112:115],v6 offset:16384
v_mfma_f32_16x16x32_bf16 v[40:43],v[120:123],v[192:195],v[40:43]
v_mfma_f32_16x16x32_bf16 v[28:31],a[192:195],v[124:127],v[28:31]
ds_read_b128 v[116:119],v6 offset:20480
v_mfma_f32_16x16x32_bf16 v[44:47],v[124:127],v[192:195],v[44:47]
v_mfma_f32_16x16x32_bf16 v[32:35],a[200:203],v[120:123],v[32:35]
v_mfma_f32_16x16x32_bf16 v[48:51],v[120:123],v[200:203],v[48:51]
v_mfma_f32_16x16x32_bf16 v[36:39],a[200:203],v[124:127],v[36:39]
v_mfma_f32_16x16x32_bf16 v[52:55],v[124:127],v[200:203],v[52:55]
s_waitcnt lgkmcnt(2)
v_mfma_f32_16x16x32_bf16 v[24:27],a[196:199],v[104:107],v[24:27]
ds_read_b128 v[120:123],v7 offset:16384
v_mfma_f32_16x16x32_bf16 v[40:43],v[104:107],v[196:199],v[40:43]
v_mfma_f32_16x16x32_bf16 v[28:31],a[196:199],v[108:111],v[28:31]
ds_read_b128 v[124:127],v7 offset:20480
v_mfma_f32_16x16x32_bf16 v[44:47],v[108:111],v[196:199],v[44:47]
v_mfma_f32_16x16x32_bf16 v[32:35],a[204:207],v[104:107],v[32:35]
v_mfma_f32_16x16x32_bf16 v[48:51],v[104:107],v[204:207],v[48:51]
v_mfma_f32_16x16x32_bf16 v[36:39],a[204:207],v[108:111],v[36:39]
v_mfma_f32_16x16x32_bf16 v[52:55],v[108:111],v[204:207],v[52:55]
s_waitcnt vmcnt(0)
s_barrier
s_waitcnt lgkmcnt(2)
v_mfma_f32_16x16x32_bf16 v[24:27],a[208:211],v[112:115],v[24:27]
ds_read_b128 v[104:107],v4 offset:24576
v_mfma_f32_16x16x32_bf16 v[40:43],v[112:115],v[208:211],v[40:43]
v_mfma_f32_16x16x32_bf16 v[28:31],a[208:211],v[116:119],v[28:31]
ds_read_b128 v[108:111],v4 offset:28672
v_mfma_f32_16x16x32_bf16 v[44:47],v[116:119],v[208:211],v[44:47]
v_mfma_f32_16x16x32_bf16 v[32:35],a[216:219],v[112:115],v[32:35]
v_mfma_f32_16x16x32_bf16 v[48:51],v[112:115],v[216:219],v[48:51]
v_mfma_f32_16x16x32_bf16 v[36:39],a[216:219],v[116:119],v[36:39]
v_mfma_f32_16x16x32_bf16 v[52:55],v[116:119],v[216:219],v[52:55]
s_waitcnt lgkmcnt(2)
v_mfma_f32_16x16x32_bf16 v[24:27],a[212:215],v[120:123],v[24:27]
ds_read_b128 v[112:115],v5 offset:24576
v_mfma_f32_16x16x32_bf16 v[40:43],v[120:123],v[212:215],v[40:43]
v_mfma_f32_16x16x32_bf16 v[28:31],a[212:215],v[124:127],v[28:31]
ds_read_b128 v[116:119],v5 offset:28672
v_mfma_f32_16x16x32_bf16 v[44:47],v[124:127],v[212:215],v[44:47]
v_mfma_f32_16x16x32_bf16 v[32:35],a[220:223],v[120:123],v[32:35]
v_mfma_f32_16x16x32_bf16 v[48:51],v[120:123],v[220:223],v[48:51]
v_mfma_f32_16x16x32_bf16 v[36:39],a[220:223],v[124:127],v[36:39]
v_mfma_f32_16x16x32_bf16 v[52:55],v[124:127],v[220:223],v[52:55]
s_waitcnt lgkmcnt(2)
v_mfma_f32_16x16x32_bf16 v[24:27],a[224:227],v[104:107],v[24:27]
ds_read_b128 v[120:123],v6 offset:24576
v_mfma_f32_16x16x32_bf16 v[40:43],v[104:107],v[224:227],v[40:43]
v_mfma_f32_16x16x32_bf16 v[28:31],a[224:227],v[108:111],v[28:31]
ds_read_b128 v[124:127],v6 offset:28672
v_mfma_f32_16x16x32_bf16 v[44:47],v[108:111],v[224:227],v[44:47]
v_mfma_f32_16x16x32_bf16 v[32:35],a[232:235],v[104:107],v[32:35]
v_mfma_f32_16x16x32_bf16 v[48:51],v[104:107],v[232:235],v[48:51]
v_mfma_f32_16x16x32_bf16 v[36:39],a[232:235],v[108:111],v[36:39]
v_mfma_f32_16x16x32_bf16 v[52:55],v[108:111],v[232:235],v[52:55]
s_waitcnt lgkmcnt(2)
v_mfma_f32_16x16x32_bf16 v[24:27],a[228:231],v[112:115],v[24:27]
ds_read_b128 v[104:107],v7 offset:24576
v_mfma_f32_16x16x32_bf16 v[40:43],v[112:115],v[228:231],v[40:43]
v_mfma_f32_16x16x32_bf16 v[28:31],a[228:231],v[116:119],v[28:31]
ds_read_b128 v[108:111],v7 offset:28672
v_mfma_f32_16x16x32_bf16 v[44:47],v[116:119],v[228:231],v[44:47]
v_mfma_f32_16x16x32_bf16 v[32:35],a[236:239],v[112:115],v[32:35]
v_mfma_f32_16x16x32_bf16 v[48:51],v[112:115],v[236:239],v[48:51]
v_mfma_f32_16x16x32_bf16 v[36:39],a[236:239],v[116:119],v[36:39]
v_mfma_f32_16x16x32_bf16 v[52:55],v[116:119],v[236:239],v[52:55]
s_waitcnt lgkmcnt(2)
v_mfma_f32_16x16x32_bf16 v[24:27],a[240:243],v[120:123],v[24:27]
ds_read_b128 v[112:115],v4 offset:0
v_mfma_f32_16x16x32_bf16 v[40:43],v[120:123],v[240:243],v[40:43]
v_mfma_f32_16x16x32_bf16 v[28:31],a[240:243],v[124:127],v[28:31]
ds_read_b128 v[116:119],v4 offset:4096
v_mfma_f32_16x16x32_bf16 v[44:47],v[124:127],v[240:243],v[44:47]
v_mfma_f32_16x16x32_bf16 v[32:35],a[248:251],v[120:123],v[32:35]
v_mfma_f32_16x16x32_bf16 v[48:51],v[120:123],v[248:251],v[48:51]
v_mfma_f32_16x16x32_bf16 v[36:39],a[248:251],v[124:127],v[36:39]
v_mfma_f32_16x16x32_bf16 v[52:55],v[124:127],v[248:251],v[52:55]
s_waitcnt lgkmcnt(2)
v_mfma_f32_16x16x32_bf16 v[24:27],a[244:247],v[104:107],v[24:27]
ds_read_b128 v[120:123],v5 offset:0
v_mfma_f32_16x16x32_bf16 v[40:43],v[104:107],v[244:247],v[40:43]
v_mfma_f32_16x16x32_bf16 v[28:31],a[244:247],v[108:111],v[28:31]
ds_read_b128 v[124:127],v5 offset:4096
v_mfma_f32_16x16x32_bf16 v[44:47],v[108:111],v[244:247],v[44:47]
v_mfma_f32_16x16x32_bf16 v[32:35],a[252:255],v[104:107],v[32:35]
v_mfma_f32_16x16x32_bf16 v[48:51],v[104:107],v[252:255],v[48:51]
v_mfma_f32_16x16x32_bf16 v[36:39],a[252:255],v[108:111],v[36:39]
v_mfma_f32_16x16x32_bf16 v[52:55],v[108:111],v[252:255],v[52:55]
s_waitcnt lgkmcnt(2)
v_mfma_f32_16x16x32_bf16 v[88:91],a[0:3],v[112:115],0
ds_read_b128 v[104:107],v6 offset:0
v_mfma_f32_16x16x32_bf16 v[92:95],a[0:3],v[116:119],0
v_mfma_f32_16x16x32_bf16 v[96:99],a[8:11],v[112:115],0
ds_read_b128 v[108:111],v6 offset:4096
v_cvt_pk_bf16_f32 v56,v24,v32
v_cvt_pk_bf16_f32 v57,v25,v33
v_mfma_f32_16x16x32_bf16 v[100:103],a[8:11],v[116:119],0
v_cvt_pk_bf16_f32 v58,v26,v34
v_cvt_pk_bf16_f32 v59,v27,v35
s_waitcnt lgkmcnt(2)
v_mfma_f32_16x16x32_bf16 v[88:91],a[4:7],v[120:123],v[88:91]
ds_read_b128 v[112:115],v7 offset:0
v_mfma_f32_16x16x32_bf16 v[92:95],a[4:7],v[124:127],v[92:95]
buffer_store_dwordx4 v[56:59],v0,s[8:11],s61 offen sc1
v_cvt_pk_bf16_f32 v60,v28,v36
v_cvt_pk_bf16_f32 v61,v29,v37
v_mfma_f32_16x16x32_bf16 v[96:99],a[12:15],v[120:123],v[96:99]
ds_read_b128 v[116:119],v7 offset:4096
v_cvt_pk_bf16_f32 v62,v30,v38
v_cvt_pk_bf16_f32 v63,v31,v39
v_mfma_f32_16x16x32_bf16 v[100:103],a[12:15],v[124:127],v[100:103]
buffer_store_dwordx4 v[60:63],v0,s[8:11],s62 offen sc1
v_cvt_pk_bf16_f32 v64,v40,v41
v_cvt_pk_bf16_f32 v65,v42,v43
s_waitcnt lgkmcnt(2)
v_mfma_f32_16x16x32_bf16 v[88:91],a[16:19],v[104:107],v[88:91]
ds_read_b128 v[120:123],v4 offset:8192
v_cvt_pk_bf16_f32 v66,v44,v45
v_cvt_pk_bf16_f32 v67,v46,v47
v_mfma_f32_16x16x32_bf16 v[92:95],a[16:19],v[108:111],v[92:95]
buffer_store_dwordx4 v[64:67],v0,s[8:11],s65 offen offset:0 sc1
v_cvt_pk_bf16_f32 v68,v48,v49
v_cvt_pk_bf16_f32 v69,v50,v51
v_mfma_f32_16x16x32_bf16 v[96:99],a[24:27],v[104:107],v[96:99]
ds_read_b128 v[124:127],v4 offset:12288
v_cvt_pk_bf16_f32 v70,v52,v53
v_cvt_pk_bf16_f32 v71,v54,v55
v_mfma_f32_16x16x32_bf16 v[100:103],a[24:27],v[108:111],v[100:103]
buffer_store_dwordx4 v[68:71],v0,s[8:11],s65 offen offset:1024 sc1
s_waitcnt lgkmcnt(2)
v_mfma_f32_16x16x32_bf16 v[88:91],a[20:23],v[112:115],v[88:91]
ds_read_b128 v[104:107],v5 offset:8192
v_mfma_f32_16x16x32_bf16 v[92:95],a[20:23],v[116:119],v[92:95]
v_mfma_f32_16x16x32_bf16 v[96:99],a[28:31],v[112:115],v[96:99]
ds_read_b128 v[108:111],v5 offset:12288
v_mfma_f32_16x16x32_bf16 v[100:103],a[28:31],v[116:119],v[100:103]
s_waitcnt lgkmcnt(2)
v_mfma_f32_16x16x32_bf16 v[88:91],a[32:35],v[120:123],v[88:91]
ds_read_b128 v[112:115],v6 offset:8192
v_mfma_f32_16x16x32_bf16 v[92:95],a[32:35],v[124:127],v[92:95]
v_mfma_f32_16x16x32_bf16 v[96:99],a[40:43],v[120:123],v[96:99]
ds_read_b128 v[116:119],v6 offset:12288
v_mfma_f32_16x16x32_bf16 v[100:103],a[40:43],v[124:127],v[100:103]
s_waitcnt lgkmcnt(2)
v_mfma_f32_16x16x32_bf16 v[88:91],a[36:39],v[104:107],v[88:91]
ds_read_b128 v[120:123],v7 offset:8192
v_mfma_f32_16x16x32_bf16 v[92:95],a[36:39],v[108:111],v[92:95]
v_mfma_f32_16x16x32_bf16 v[96:99],a[44:47],v[104:107],v[96:99]
ds_read_b128 v[124:127],v7 offset:12288
v_mfma_f32_16x16x32_bf16 v[100:103],a[44:47],v[108:111],v[100:103]
s_waitcnt lgkmcnt(2)
v_mfma_f32_16x16x32_bf16 v[88:91],a[48:51],v[112:115],v[88:91]
ds_read_b128 v[104:107],v4 offset:16384
v_mfma_f32_16x16x32_bf16 v[92:95],a[48:51],v[116:119],v[92:95]
v_mfma_f32_16x16x32_bf16 v[96:99],a[56:59],v[112:115],v[96:99]
ds_read_b128 v[108:111],v4 offset:20480
v_mfma_f32_16x16x32_bf16 v[100:103],a[56:59],v[116:119],v[100:103]
s_waitcnt lgkmcnt(2)
v_mfma_f32_16x16x32_bf16 v[88:91],a[52:55],v[120:123],v[88:91]
ds_read_b128 v[112:115],v5 offset:16384
v_mfma_f32_16x16x32_bf16 v[92:95],a[52:55],v[124:127],v[92:95]
v_mfma_f32_16x16x32_bf16 v[96:99],a[60:63],v[120:123],v[96:99]
ds_read_b128 v[116:119],v5 offset:20480
v_mfma_f32_16x16x32_bf16 v[100:103],a[60:63],v[124:127],v[100:103]
s_waitcnt lgkmcnt(2)
v_mfma_f32_16x16x32_bf16 v[88:91],a[64:67],v[104:107],v[88:91]
ds_read_b128 v[120:123],v6 offset:16384
v_mfma_f32_16x16x32_bf16 v[92:95],a[64:67],v[108:111],v[92:95]
v_mfma_f32_16x16x32_bf16 v[96:99],a[72:75],v[104:107],v[96:99]
ds_read_b128 v[124:127],v6 offset:20480
v_mfma_f32_16x16x32_bf16 v[100:103],a[72:75],v[108:111],v[100:103]
s_waitcnt lgkmcnt(2)
v_mfma_f32_16x16x32_bf16 v[88:91],a[68:71],v[112:115],v[88:91]
ds_read_b128 v[104:107],v7 offset:16384
v_mfma_f32_16x16x32_bf16 v[92:95],a[68:71],v[116:119],v[92:95]
v_mfma_f32_16x16x32_bf16 v[96:99],a[76:79],v[112:115],v[96:99]
ds_read_b128 v[108:111],v7 offset:20480
v_mfma_f32_16x16x32_bf16 v[100:103],a[76:79],v[116:119],v[100:103]
s_waitcnt lgkmcnt(2)
v_mfma_f32_16x16x32_bf16 v[88:91],a[80:83],v[120:123],v[88:91]
ds_read_b128 v[112:115],v4 offset:24576
v_mfma_f32_16x16x32_bf16 v[92:95],a[80:83],v[124:127],v[92:95]
v_mfma_f32_16x16x32_bf16 v[96:99],a[88:91],v[120:123],v[96:99]
ds_read_b128 v[116:119],v4 offset:28672
v_mfma_f32_16x16x32_bf16 v[100:103],a[88:91],v[124:127],v[100:103]
s_waitcnt lgkmcnt(2)
v_mfma_f32_16x16x32_bf16 v[88:91],a[84:87],v[104:107],v[88:91]
ds_read_b128 v[120:123],v5 offset:24576
v_mfma_f32_16x16x32_bf16 v[92:95],a[84:87],v[108:111],v[92:95]
v_mfma_f32_16x16x32_bf16 v[96:99],a[92:95],v[104:107],v[96:99]
ds_read_b128 v[124:127],v5 offset:28672
v_mfma_f32_16x16x32_bf16 v[100:103],a[92:95],v[108:111],v[100:103]
s_waitcnt lgkmcnt(2)
v_mfma_f32_16x16x32_bf16 v[88:91],a[96:99],v[112:115],v[88:91]
ds_read_b128 v[104:107],v6 offset:24576
v_mfma_f32_16x16x32_bf16 v[92:95],a[96:99],v[116:119],v[92:95]
v_mfma_f32_16x16x32_bf16 v[96:99],a[104:107],v[112:115],v[96:99]
ds_read_b128 v[108:111],v6 offset:28672
v_mfma_f32_16x16x32_bf16 v[100:103],a[104:107],v[116:119],v[100:103]
s_waitcnt lgkmcnt(2)
v_mfma_f32_16x16x32_bf16 v[88:91],a[100:103],v[120:123],v[88:91]
ds_read_b128 v[112:115],v7 offset:24576
v_mfma_f32_16x16x32_bf16 v[92:95],a[100:103],v[124:127],v[92:95]
v_mfma_f32_16x16x32_bf16 v[96:99],a[108:111],v[120:123],v[96:99]
ds_read_b128 v[116:119],v7 offset:28672
v_mfma_f32_16x16x32_bf16 v[100:103],a[108:111],v[124:127],v[100:103]
s_waitcnt lgkmcnt(2)
v_mfma_f32_16x16x32_bf16 v[88:91],a[112:115],v[104:107],v[88:91]
v_mfma_f32_16x16x32_bf16 v[92:95],a[112:115],v[108:111],v[92:95]
v_mfma_f32_16x16x32_bf16 v[96:99],a[120:123],v[104:107],v[96:99]
v_mfma_f32_16x16x32_bf16 v[100:103],a[120:123],v[108:111],v[100:103]
s_waitcnt lgkmcnt(0)
v_mfma_f32_16x16x32_bf16 v[88:91],a[116:119],v[112:115],v[88:91]
v_mfma_f32_16x16x32_bf16 v[92:95],a[116:119],v[116:119],v[92:95]
v_mfma_f32_16x16x32_bf16 v[96:99],a[124:127],v[112:115],v[96:99]
v_mfma_f32_16x16x32_bf16 v[100:103],a[124:127],v[116:119],v[100:103]
s_nop 3
v_cvt_pk_bf16_f32 v104,v88,v96
v_cvt_pk_bf16_f32 v105,v89,v97
v_cvt_pk_bf16_f32 v106,v90,v98
v_cvt_pk_bf16_f32 v107,v91,v99
v_cvt_pk_bf16_f32 v108,v92,v100
v_cvt_pk_bf16_f32 v109,v93,v101
v_cvt_pk_bf16_f32 v110,v94,v102
v_cvt_pk_bf16_f32 v111,v95,v103
buffer_store_dwordx4 v[104:107],v0,s[8:11],s63 offen sc1
buffer_store_dwordx4 v[108:111],v0,s[8:11],s64 offen sc1
s_waitcnt vmcnt(6)
s_barrier
s_add_u32 m0,s50,131072
s_nop 0
buffer_load_dwordx4 v20,s[8:11],s70 offen offset:0 sc1 lds
s_add_u32 m0,s50,135168
s_nop 0
buffer_load_dwordx4 v20,s[8:11],s71 offen offset:0 sc1 lds
s_add_u32 m0,s50,139008
s_nop 0
buffer_load_dwordx4 v20,s[8:11],s70 offen offset:256 sc1 lds
s_add_u32 m0,s50,143104
s_nop 0
buffer_load_dwordx4 v20,s[8:11],s71 offen offset:256 sc1 lds
s_add_u32 m0,s50,146944
s_nop 0
buffer_load_dwordx4 v20,s[8:11],s70 offen offset:512 sc1 lds
s_add_u32 m0,s50,151040
s_nop 0
buffer_load_dwordx4 v20,s[8:11],s71 offen offset:512 sc1 lds
s_lshl_b32 s59,s51,13
s_lshl2_add_u32 s59,s47,s59
s_add_u32 s59,s59,10487680
s_waitcnt vmcnt(0)
s_barrier
s_or_b32 s59,s59,s52
buffer_store_dword v17,off,s[8:11],s59 sc1
s_mov_b32 s72,0x80000000
s_mov_b32 s86,0
s_mov_b32 s19,1
s_mov_b32 s18,0
s_cmp_lt_u32 s31,64
s_cbranch_scc1 L_mo_394
L_mo_407:
s_mov_b32 s51,64
s_cmp_eq_u32 s47,31
s_cbranch_scc1 L_mf_418
v_and_b32 v9,15,v1
v_lshrrev_b32 v10,4,v1
v_and_b32 v124,1,v1
v_lshlrev_b32 v124,4,v124
v_mov_b32 v125,0xffff
v_lshlrev_b32 v125,v124,v125
v_lshrrev_b32 v124,2,v9
v_cmp_eq_u32 vcc,0,v124
s_nop 1
v_cndmask_b32 v12,0,v125,vcc
v_cmp_eq_u32 vcc,1,v124
s_nop 1
v_cndmask_b32 v13,0,v125,vcc
v_and_b32 v124,2,v1
v_cmp_eq_u32 vcc,0,v124
v_mov_b32 v14,0xeeee
v_mov_b32 v124,0x4444
v_cndmask_b32 v14,v14,v124,vcc
v_lshlrev_b32 v11,14,v10
v_lshl_add_u32 v11,v9,4,v11
s_lshl_b32 s65,s51,15
s_add_u32 s65,s65,92274688
s_lshl_b32 s62,s47,10
s_add_u32 s62,s62,s65
s_lshl_b32 s63,s47,16
s_lshl_b32 s60,s46,8
s_add_u32 s63,s63,s60
s_mov_b32 s4,s38
s_mov_b32 s5,s39
s_mov_b32 s6,1835008
s_mov_b32 s7,0x20000
buffer_load_dwordx4 v[24:27],v11,s[4:7],s63 offen offset:0
buffer_load_dwordx4 v[28:31],v11,s[4:7],s63 offen offset:1024
buffer_load_dwordx4 v[32:35],v11,s[4:7],s63 offen offset:2048
buffer_load_dwordx4 v[36:39],v11,s[4:7],s63 offen offset:3072
s_add_u32 s63,s63,4096
buffer_load_dwordx4 v[40:43],v11,s[4:7],s63 offen offset:0
buffer_load_dwordx4 v[44:47],v11,s[4:7],s63 offen offset:1024
buffer_load_dwordx4 v[48:51],v11,s[4:7],s63 offen offset:2048
buffer_load_dwordx4 v[52:55],v11,s[4:7],s63 offen offset:3072
s_add_u32 s63,s63,4096
buffer_load_dwordx4 v[56:59],v11,s[4:7],s63 offen offset:0
buffer_load_dwordx4 v[60:63],v11,s[4:7],s63 offen offset:1024
buffer_load_dwordx4 v[64:67],v11,s[4:7],s63 offen offset:2048
buffer_load_dwordx4 v[68:71],v11,s[4:7],s63 offen offset:3072
s_add_u32 s63,s63,4096
buffer_load_dwordx4 v[72:75],v11,s[4:7],s63 offen offset:0
buffer_load_dwordx4 v[76:79],v11,s[4:7],s63 offen offset:1024
buffer_load_dwordx4 v[80:83],v11,s[4:7],s63 offen offset:2048
buffer_load_dwordx4 v[84:87],v11,s[4:7],s63 offen offset:3072
ds_read_b128 a[0:3],v18 offset:0
ds_read_b128 a[4:7],v18 offset:1024
ds_read_b128 a[8:11],v18 offset:2048
ds_read_b128 a[12:15],v18 offset:3072
ds_read_b128 a[16:19],v18 offset:4096
ds_read_b128 a[20:23],v18 offset:5120
ds_read_b128 a[24:27],v18 offset:6144
ds_read_b128 a[28:31],v18 offset:7168
ds_read_b128 a[32:35],v18 offset:8192
ds_read_b128 a[36:39],v18 offset:9216
ds_read_b128 a[40:43],v18 offset:10240
ds_read_b128 a[44:47],v18 offset:11264
ds_read_b128 a[48:51],v18 offset:12288
ds_read_b128 a[52:55],v18 offset:13312
ds_read_b128 a[56:59],v18 offset:14336
ds_read_b128 a[60:63],v18 offset:15360
ds_read_b128 a[64:67],v18 offset:16384
ds_read_b128 a[68:71],v18 offset:17408
ds_read_b128 a[72:75],v18 offset:18432
ds_read_b128 a[76:79],v18 offset:19456
ds_read_b128 a[80:83],v18 offset:20480
ds_read_b128 a[84:87],v18 offset:21504
ds_read_b128 a[88:91],v18 offset:22528
ds_read_b128 a[92:95],v18 offset:23552
ds_read_b128 a[96:99],v18 offset:24576
ds_read_b128 a[100:103],v18 offset:25600
ds_read_b128 a[104:107],v18 offset:26624
ds_read_b128 a[108:111],v18 offset:27648
ds_read_b128 a[112:115],v18 offset:28672
ds_read_b128 a[116:119],v18 offset:29696
ds_read_b128 a[120:123],v18 offset:30720
ds_read_b128 a[124:127],v18 offset:31744
L_mf_419:
s_lshl_b32 s59,s51,13
s_lshl_b32 s61,s46,7
s_add_u32 s59,s59,s61
s_add_u32 s59,s59,10486272
L_ww_424:
s_sleep 1
buffer_load_dword v2,off,s[8:11],s59 sc1
s_sub_u32 s49,s49,1
s_cbranch_scc1 L_abort2
s_waitcnt vmcnt(0)
v_readfirstlane_b32 s55,v2
s_cmp_eq_u32 s55,0
s_cbranch_scc1 L_ww_424
L_wwd_425:
s_cmp_eq_u32 s55,1
s_cbranch_scc1 L_mf_420
s_barrier
s_andn2_b32 s64,0x7ff,s55
s_lshl_b32 s56,s64,10
s_add_u32 s58,s56,6291456
buffer_load_dwordx4 v[88:91],v0,s[8:11],s58 offen sc1
s_lshl_b32 s57,s46,11
s_add_u32 s57,s57,139264
v_add_u32 v8,s57,v0
v_and_b32 v2,1,v10
v_lshrrev_b32 v3,1,v10
v_lshlrev_b32 v2,7,v2
v_lshl_add_u32 v2,v3,10,v2
s_lshl_b32 s59,s46,8
s_add_u32 s59,s57,s59
v_add_u32 v2,s59,v2
s_mov_b32 s60,0x01000100
s_mov_b32 s61,0x03020302
s_waitcnt vmcnt(0)
v_lshlrev_b32 v96,16,v88
v_and_b32 v97,0xffff0000,v88
v_lshlrev_b32 v98,16,v89
v_and_b32 v99,0xffff0000,v89
v_lshlrev_b32 v100,16,v90
v_and_b32 v101,0xffff0000,v90
v_lshlrev_b32 v102,16,v91
v_and_b32 v103,0xffff0000,v91
v_readfirstlane_b32 s78,v96
s_nop 1
v_pk_add_f32 v[108:109],v[96:97],s[78:79] op_sel_hi:[1,0] neg_lo:[0,1] neg_hi:[0,1]
v_pk_add_f32 v[110:111],v[98:99],s[78:79] op_sel_hi:[1,0] neg_lo:[0,1] neg_hi:[0,1]
v_pk_add_f32 v[112:113],v[100:101],s[78:79] op_sel_hi:[1,0] neg_lo:[0,1] neg_hi:[0,1]
v_pk_add_f32 v[114:115],v[102:103],s[78:79] op_sel_hi:[1,0] neg_lo:[0,1] neg_hi:[0,1]
v_pk_add_f32 v[116:117],v[108:109],v[110:111]
v_pk_mul_f32 v[118:119],v[108:109],v[108:109]
v_pk_add_f32 v[120:121],v[112:113],v[114:115]
v_pk_fma_f32 v[118:119],v[110:111],v[110:111],v[118:119]
v_pk_add_f32 v[116:117],v[116:117],v[120:121]
v_pk_fma_f32 v[118:119],v[112:113],v[112:113],v[118:119]
v_add_f32 v116,v116,v117
v_pk_fma_f32 v[118:119],v[114:115],v[114:115],v[118:119]
v_add_f32 v118,v118,v119
s_nop 1
v_permlane32_swap_b32 v116,v118
v_add_f32 v116,v116,v118
s_nop 1
v_add_f32_dpp v116,v116,v116 row_ror:8 row_mask:0xf bank_mask:0xf
s_nop 1
v_add_f32_dpp v116,v116,v116 row_ror:4 row_mask:0xf bank_mask:0xf
s_nop 1
v_add_f32_dpp v116,v116,v116 row_ror:2 row_mask:0xf bank_mask:0xf
s_nop 1
v_add_f32_dpp v116,v116,v116 row_ror:1 row_mask:0xf bank_mask:0xf
v_mov_b32 v118,v116
s_nop 1
v_permlane16_swap_b32 v116,v118
v_add_f32 v116,v116,v118
v_mul_f32 v116,0x3b000000,v116
v_mov_b32 v118,v116
s_nop 1
v_permlane32_swap_b32 v116,v118
v_fma_f32 v118,-v116,v116,v118
v_add_f32 v116,s78,v116
v_max_f32 v118,0,v118
v_cvt_pk_bf16_f32 v118,v116,v118
v_lshlrev_b32 v116,16,v118
v_and_b32 v118,0xffff0000,v118
v_add_f32 v118,0x3727c5ac,v118
v_cvt_pk_bf16_f32 v118,v118,v118
v_and_b32 v118,0xffff0000,v118
v_sqrt_f32 v118,v118
v_pk_add_f32 v[108:109],v[96:97],v[116:117] op_sel_hi:[1,0] neg_lo:[0,1] neg_hi:[0,1]
v_pk_add_f32 v[110:111],v[98:99],v[116:117] op_sel_hi:[1,0] neg_lo:[0,1] neg_hi:[0,1]
v_pk_add_f32 v[112:113],v[100:101],v[116:117] op_sel_hi:[1,0] neg_lo:[0,1] neg_hi:[0,1]
v_pk_add_f32 v[114:115],v[102:103],v[116:117] op_sel_hi:[1,0] neg_lo:[0,1] neg_hi:[0,1]
v_cvt_pk_bf16_f32 v118,v118,v118
v_and_b32 v118,0xffff0000,v118
v_rcp_f32 v118,v118
v_cvt_pk_bf16_f32 v104,v108,v109
v_cvt_pk_bf16_f32 v105,v110,v111
v_cvt_pk_bf16_f32 v106,v112,v113
v_cvt_pk_bf16_f32 v107,v114,v115
v_lshlrev_b32 v108,16,v104
v_and_b32 v109,0xffff0000,v104
v_lshlrev_b32 v110,16,v105
v_and_b32 v111,0xffff0000,v105
v_lshlrev_b32 v112,16,v106
v_and_b32 v113,0xffff0000,v106
v_lshlrev_b32 v114,16,v107
v_and_b32 v115,0xffff0000,v107
v_pk_mul_f32 v[108:109],v[108:109],v[118:119] op_sel_hi:[1,0]
v_pk_mul_f32 v[110:111],v[110:111],v[118:119] op_sel_hi:[1,0]
v_pk_mul_f32 v[112:113],v[112:113],v[118:119] op_sel_hi:[1,0]
v_pk_mul_f32 v[114:115],v[114:115],v[118:119] op_sel_hi:[1,0]
v_cvt_pk_bf16_f32 v104,v108,v109
v_cvt_pk_bf16_f32 v105,v110,v111
v_cvt_pk_bf16_f32 v106,v112,v113
v_cvt_pk_bf16_f32 v107,v114,v115
v_perm_b32 v88,v104,v104,s60
v_perm_b32 v89,v105,v105,s60
v_perm_b32 v90,v106,v106,s60
v_perm_b32 v91,v107,v107,s60
ds_write_b128 v8,v[88:91]
v_perm_b32 v92,v104,v104,s61
v_perm_b32 v93,v105,v105,s61
v_perm_b32 v94,v106,v106,s61
v_perm_b32 v95,v107,v107,s61
ds_write_b128 v8,v[92:95] offset:1024
s_mov_b32 s58,s57
ds_read_b128 v[128:131],v2 offset:0
ds_read_b128 v[144:147],v2 offset:64
ds_read_b128 v[132:135],v2 offset:16
ds_read_b128 v[148:151],v2 offset:80
ds_read_b128 v[136:139],v2 offset:32
ds_read_b128 v[152:155],v2 offset:96
ds_read_b128 v[140:143],v2 offset:48
ds_read_b128 v[156:159],v2 offset:112
v_mov_b64 v[116:117],0
v_mov_b64 v[118:119],0
s_waitcnt lgkmcnt(6)
v_and_b32 v120,v12,v128
v_and_b32 v121,v13,v128
v_and_b32 v122,v12,v144
v_and_b32 v123,v13,v144
v_and_b32 v124,v12,v129
v_and_b32 v125,v13,v129
v_smfmac_f32_16x16x64_bf16 v[116:119],v[120:123],a[0:7],v14
v_and_b32 v126,v12,v145
v_and_b32 v127,v13,v145
v_and_b32 v120,v12,v130
v_and_b32 v121,v13,v130
v_smfmac_f32_16x16x64_bf16 v[116:119],v[124:127],a[8:15],v14
v_and_b32 v122,v12,v146
v_and_b32 v123,v13,v146
v_and_b32 v124,v12,v131
v_and_b32 v125,v13,v131
v_smfmac_f32_16x16x64_bf16 v[116:119],v[120:123],a[16:23],v14
v_and_b32 v126,v12,v147
v_and_b32 v127,v13,v147
s_waitcnt lgkmcnt(4)
v_and_b32 v120,v12,v132
v_and_b32 v121,v13,v132
v_smfmac_f32_16x16x64_bf16 v[116:119],v[124:127],a[24:31],v14
v_and_b32 v122,v12,v148
v_and_b32 v123,v13,v148
v_and_b32 v124,v12,v133
v_and_b32 v125,v13,v133
v_smfmac_f32_16x16x64_bf16 v[116:119],v[120:123],a[32:39],v14
v_and_b32 v126,v12,v149
v_and_b32 v127,v13,v149
v_and_b32 v120,v12,v134
v_and_b32 v121,v13,v134
v_smfmac_f32_16x16x64_bf16 v[116:119],v[124:127],a[40:47],v14
v_and_b32 v122,v12,v150
v_and_b32 v123,v13,v150
v_and_b32 v124,v12,v135
v_and_b32 v125,v13,v135
v_smfmac_f32_16x16x64_bf16 v[116:119],v[120:123],a[48:55],v14
v_and_b32 v126,v12,v151
v_and_b32 v127,v13,v151
s_waitcnt lgkmcnt(2)
v_and_b32 v120,v12,v136
v_and_b32 v121,v13,v136
v_smfmac_f32_16x16x64_bf16 v[116:119],v[124:127],a[56:63],v14
v_and_b32 v122,v12,v152
v_and_b32 v123,v13,v152
v_and_b32 v124,v12,v137
v_and_b32 v125,v13,v137
v_smfmac_f32_16x16x64_bf16 v[116:119],v[120:123],a[64:71],v14
v_and_b32 v126,v12,v153
v_and_b32 v127,v13,v153
v_and_b32 v120,v12,v138
v_and_b32 v121,v13,v138
v_smfmac_f32_16x16x64_bf16 v[116:119],v[124:127],a[72:79],v14
v_and_b32 v122,v12,v154
v_and_b32 v123,v13,v154
v_and_b32 v124,v12,v139
v_and_b32 v125,v13,v139
v_smfmac_f32_16x16x64_bf16 v[116:119],v[120:123],a[80:87],v14
v_and_b32 v126,v12,v155
v_and_b32 v127,v13,v155
s_waitcnt lgkmcnt(0)
v_and_b32 v120,v12,v140
v_and_b32 v121,v13,v140
v_smfmac_f32_16x16x64_bf16 v[116:119],v[124:127],a[88:95],v14
v_and_b32 v122,v12,v156
v_and_b32 v123,v13,v156
v_and_b32 v124,v12,v141
v_and_b32 v125,v13,v141
v_smfmac_f32_16x16x64_bf16 v[116:119],v[120:123],a[96:103],v14
v_and_b32 v126,v12,v157
v_and_b32 v127,v13,v157
v_and_b32 v120,v12,v142
v_and_b32 v121,v13,v142
v_smfmac_f32_16x16x64_bf16 v[116:119],v[124:127],a[104:111],v14
v_and_b32 v122,v12,v158
v_and_b32 v123,v13,v158
v_and_b32 v124,v12,v143
v_and_b32 v125,v13,v143
v_smfmac_f32_16x16x64_bf16 v[116:119],v[120:123],a[112:119],v14
v_and_b32 v126,v12,v159
v_and_b32 v127,v13,v159
s_nop 1
v_smfmac_f32_16x16x64_bf16 v[116:119],v[124:127],a[120:127],v14
v_lshlrev_b32 v8,5,v9
v_and_b32 v124,1,v10
v_lshl_add_u32 v8,v124,4,v8
v_lshrrev_b32 v124,1,v10
v_lshl_add_u32 v8,v124,11,v8
s_lshl_b32 s60,s46,9
s_add_u32 s60,s60,147456
v_add_u32 v8,s60,v8
ds_write_b128 v8,v[116:119]
v_lshlrev_b32 v8,2,v1
v_add_u32 v8,147456,v8
v_and_b32 v2,1,v1
v_lshrrev_b32 v3,1,v1
v_lshlrev_b32 v3,2,v3
v_lshl_add_u32 v2,v2,7,v3
v_add_u32 v2,s58,v2
v_lshlrev_b32 v3,6,v10
v_add_u32 v3,s58,v3
s_waitcnt lgkmcnt(0)
s_barrier
ds_read2st64_b32 v[88:89],v8 offset0:0 offset1:1
ds_read2st64_b32 v[90:91],v8 offset0:2 offset1:3
ds_read2st64_b32 v[92:93],v8 offset0:4 offset1:5
ds_read2st64_b32 v[94:95],v8 offset0:6 offset1:7
s_waitcnt lgkmcnt(0)
v_pk_add_f32 v[88:89],v[88:89],v[90:91]
v_pk_add_f32 v[92:93],v[92:93],v[94:95]
v_pk_add_f32 v[88:89],v[88:89],v[92:93]
v_cvt_pk_bf16_f32 v88,v88,v88
v_and_b32 v88,0xffff0000,v88
v_cvt_pk_bf16_f32 v89,v89,v89
v_and_b32 v89,0xffff0000,v89
v_mul_f32 v90,0xbfb8aa3b,v88
v_exp_f32 v90,v90
s_nop 0
v_add_f32 v90,1.0,v90
v_rcp_f32 v90,v90
s_nop 0
v_mul_f32 v88,v88,v90
v_cvt_pk_bf16_f32 v88,v88,v88
v_and_b32 v88,0xffff0000,v88
v_mul_f32 v88,v88,v89
v_cvt_pk_bf16_f32 v88,v88,v88
ds_write_b32 v2,v88
ds_read_b128 v[88:91],v3
ds_read_b128 v[108:111],v3 offset:32
ds_read_b128 v[92:95],v3 offset:16
ds_read_b128 v[112:115],v3 offset:48
v_mov_b64 v[116:117],0
v_mov_b64 v[118:119],0
s_waitcnt vmcnt(0) lgkmcnt(0)
v_and_b32 v120,v12,v88
v_and_b32 v121,v13,v88
v_and_b32 v122,v12,v108
v_and_b32 v123,v13,v108
v_and_b32 v124,v12,v89
v_and_b32 v125,v13,v89
v_smfmac_f32_16x16x64_bf16 v[116:119],v[120:123],v[24:31],v14
v_and_b32 v126,v12,v109
v_and_b32 v127,v13,v109
v_and_b32 v120,v12,v90
v_and_b32 v121,v13,v90
v_smfmac_f32_16x16x64_bf16 v[116:119],v[124:127],v[32:39],v14
v_and_b32 v122,v12,v110
v_and_b32 v123,v13,v110
v_and_b32 v124,v12,v91
v_and_b32 v125,v13,v91
v_smfmac_f32_16x16x64_bf16 v[116:119],v[120:123],v[40:47],v14
v_and_b32 v126,v12,v111
v_and_b32 v127,v13,v111
v_and_b32 v120,v12,v92
v_and_b32 v121,v13,v92
v_smfmac_f32_16x16x64_bf16 v[116:119],v[124:127],v[48:55],v14
v_and_b32 v122,v12,v112
v_and_b32 v123,v13,v112
v_and_b32 v124,v12,v93
v_and_b32 v125,v13,v93
v_smfmac_f32_16x16x64_bf16 v[116:119],v[120:123],v[56:63],v14
v_and_b32 v126,v12,v113
v_and_b32 v127,v13,v113
v_and_b32 v120,v12,v94
v_and_b32 v121,v13,v94
v_smfmac_f32_16x16x64_bf16 v[116:119],v[124:127],v[64:71],v14
v_and_b32 v122,v12,v114
v_and_b32 v123,v13,v114
v_and_b32 v124,v12,v95
v_and_b32 v125,v13,v95
v_smfmac_f32_16x16x64_bf16 v[116:119],v[120:123],v[72:79],v14
v_and_b32 v126,v12,v115
v_and_b32 v127,v13,v115
s_nop 1
v_smfmac_f32_16x16x64_bf16 v[116:119],v[124:127],v[80:87],v14
v_lshlrev_b32 v8,4,v9
v_and_b32 v124,1,v10
v_lshl_add_u32 v8,v124,3,v8
v_and_b32 v124,2,v10
v_lshl_add_u32 v8,v124,30,v8
s_lshl_b32 s60,s46,8
s_add_u32 s59,s62,s60
s_nop 0
v_cvt_pk_bf16_f32 v88,v116,v117
v_cvt_pk_bf16_f32 v89,v118,v119
buffer_store_dwordx2 v[88:89],v8,s[8:11],s59 offen sc1
s_lshl_b32 s59,s51,13
s_lshl2_add_u32 s59,s47,s59
s_add_u32 s59,s59,10486912
s_waitcnt vmcnt(0)
s_barrier
s_or_b32 s59,s59,s52
buffer_store_dword v17,off,s[8:11],s59 sc1
s_cmp_lg_u32 s47,0
s_cbranch_scc1 L_moed_426
s_lshl_b32 s59,s51,13
s_add_u32 s59,s59,10486912
v_and_b32 v124,31,v1
v_lshlrev_b32 v124,2,v124
L_fw_427:
buffer_load_dword v125,v124,s[8:11],s59 offen sc1
s_sub_u32 s49,s49,1
s_cbranch_scc1 L_abort2
s_waitcnt vmcnt(0)
v_cmp_eq_u32 vcc,0,v125
s_cbranch_vccnz L_fw_427
s_add_u32 s63,s65,0
buffer_load_dwordx4 v[168:171],v22,s[8:11],s63 offen sc1
s_add_u32 s63,s65,4096
buffer_load_dwordx4 v[172:175],v22,s[8:11],s63 offen sc1
s_add_u32 s63,s65,8192
buffer_load_dwordx4 v[176:179],v22,s[8:11],s63 offen sc1
s_add_u32 s63,s65,12288
buffer_load_dwordx4 v[180:183],v22,s[8:11],s63 offen sc1
s_add_u32 s63,s65,16384
buffer_load_dwordx4 v[184:187],v22,s[8:11],s63 offen sc1
s_add_u32 s63,s65,20480
buffer_load_dwordx4 v[188:191],v22,s[8:11],s63 offen sc1
s_add_u32 s63,s65,24576
buffer_load_dwordx4 v[192:195],v22,s[8:11],s63 offen sc1
s_add_u32 s63,s65,28672
buffer_load_dwordx4 v[196:199],v22,s[8:11],s63 offen sc1
v_and_b32 v208,15,v1
v_and_b32 v209,1,v1
v_lshlrev_b32 v209,4,v209
v_mov_b32 v210,0x3f80
v_lshlrev_b32 v210,v209,v210
v_lshrrev_b32 v208,1,v208
v_cmp_eq_u32 vcc,0,v208
s_nop 1
v_cndmask_b32 v200,0,v210,vcc
v_cmp_eq_u32 vcc,1,v208
s_nop 1
v_cndmask_b32 v201,0,v210,vcc
v_cmp_eq_u32 vcc,2,v208
s_nop 1
v_cndmask_b32 v202,0,v210,vcc
v_cmp_eq_u32 vcc,3,v208
s_nop 1
v_cndmask_b32 v203,0,v210,vcc
s_waitcnt vmcnt(7)
s_nop 0
v_mfma_f32_16x16x32_bf16 v[204:207],v[200:203],v[168:171],0
s_waitcnt vmcnt(6)
v_mfma_f32_16x16x32_bf16 v[204:207],v[200:203],v[172:175],v[204:207]
s_waitcnt vmcnt(5)
v_mfma_f32_16x16x32_bf16 v[204:207],v[200:203],v[176:179],v[204:207]
s_waitcnt vmcnt(4)
v_mfma_f32_16x16x32_bf16 v[204:207],v[200:203],v[180:183],v[204:207]
s_waitcnt vmcnt(3)
v_mfma_f32_16x16x32_bf16 v[204:207],v[200:203],v[184:187],v[204:207]
s_waitcnt vmcnt(2)
v_mfma_f32_16x16x32_bf16 v[204:207],v[200:203],v[188:191],v[204:207]
s_waitcnt vmcnt(1)
v_mfma_f32_16x16x32_bf16 v[204:207],v[200:203],v[192:195],v[204:207]
s_waitcnt vmcnt(0)
v_mfma_f32_16x16x32_bf16 v[204:207],v[200:203],v[196:199],v[204:207]
s_nop 7
ds_write_b128 v21,v[204:207]
s_waitcnt lgkmcnt(0)
s_barrier
s_cmp_lg_u32 s46,0
s_cbranch_scc1 L_moed_426
v_lshlrev_b32 v200,5,v1
v_add_u32 v200,155648,v200
ds_read_b128 v[168:171],v200
ds_read_b128 v[172:175],v200 offset:16
s_and_b32 s59,s55,0xffff0000
s_xor_b32 s60,s59,0x80000000
s_xor_b32 s61,s59,0xffff0000
s_cmp_lt_i32 s59,0
s_cselect_b32 s59,s60,s61
v_mov_b32 v200,s59
v_mul_f32 v200,0xbfb8aa3b,v200
v_exp_f32 v200,v200
s_nop 0
v_add_f32 v200,1.0,v200
v_rcp_f32 v200,v200
s_nop 0
v_cvt_pk_bf16_f32 v200,v200,v200
v_and_b32 v200,0xffff0000,v200
v_lshlrev_b32 v192,16,v104
v_and_b32 v193,0xffff0000,v104
v_lshlrev_b32 v194,16,v105
v_and_b32 v195,0xffff0000,v105
v_lshlrev_b32 v196,16,v106
v_and_b32 v197,0xffff0000,v106
v_lshlrev_b32 v198,16,v107
v_and_b32 v199,0xffff0000,v107
s_waitcnt lgkmcnt(0)
v_cvt_pk_bf16_f32 v184,v168,v169
v_cvt_pk_bf16_f32 v185,v170,v171
v_cvt_pk_bf16_f32 v186,v172,v173
v_cvt_pk_bf16_f32 v187,v174,v175
v_lshlrev_b32 v168,16,v184
v_and_b32 v169,0xffff0000,v184
v_lshlrev_b32 v170,16,v185
v_and_b32 v171,0xffff0000,v185
v_lshlrev_b32 v172,16,v186
v_and_b32 v173,0xffff0000,v186
v_lshlrev_b32 v174,16,v187
v_and_b32 v175,0xffff0000,v187
v_pk_mul_f32 v[168:169],v[168:169],v[200:201] op_sel_hi:[1,0]
v_pk_mul_f32 v[170:171],v[170:171],v[200:201] op_sel_hi:[1,0]
v_pk_mul_f32 v[172:173],v[172:173],v[200:201] op_sel_hi:[1,0]
v_pk_mul_f32 v[174:175],v[174:175],v[200:201] op_sel_hi:[1,0]
v_cvt_pk_bf16_f32 v184,v168,v169
v_cvt_pk_bf16_f32 v185,v170,v171
v_cvt_pk_bf16_f32 v186,v172,v173
v_cvt_pk_bf16_f32 v187,v174,v175
v_lshlrev_b32 v168,16,v184
v_and_b32 v169,0xffff0000,v184
v_lshlrev_b32 v170,16,v185
v_and_b32 v171,0xffff0000,v185
v_lshlrev_b32 v172,16,v186
v_and_b32 v173,0xffff0000,v186
v_lshlrev_b32 v174,16,v187
v_and_b32 v175,0xffff0000,v187
v_pk_add_f32 v[168:169],v[168:169],v[192:193]
v_pk_add_f32 v[170:171],v[170:171],v[194:195]
v_pk_add_f32 v[172:173],v[172:173],v[196:197]
v_pk_add_f32 v[174:175],v[174:175],v[198:199]
v_cvt_pk_bf16_f32 v184,v168,v169
v_cvt_pk_bf16_f32 v185,v170,v171
v_cvt_pk_bf16_f32 v186,v172,v173
v_cvt_pk_bf16_f32 v187,v174,v175
v_lshlrev_b32 v168,16,v184
v_and_b32 v169,0xffff0000,v184
v_lshlrev_b32 v170,16,v185
v_and_b32 v171,0xffff0000,v185
v_lshlrev_b32 v172,16,v186
v_and_b32 v173,0xffff0000,v186
v_lshlrev_b32 v174,16,v187
v_and_b32 v175,0xffff0000,v187
v_pk_add_f32 v[96:97],v[96:97],v[168:169]
v_pk_add_f32 v[98:99],v[98:99],v[170:171]
v_pk_add_f32 v[100:101],v[100:101],v[172:173]
v_pk_add_f32 v[102:103],v[102:103],v[174:175]
v_cvt_pk_bf16_f32 v160,v96,v97
v_cvt_pk_bf16_f32 v161,v98,v99
v_cvt_pk_bf16_f32 v162,v100,v101
v_cvt_pk_bf16_f32 v163,v102,v103
L_moed_426:
s_add_u32 s51,s51,1
s_add_u32 s62,s62,32768
s_add_u32 s65,s65,32768
s_branch L_mf_419
L_mf_420:
s_mov_b32 s4,s40
s_mov_b32 s5,s41
s_mov_b32 s6,2097152
s_mov_b32 s7,0x20000
s_or_b32 s61,s47,s46
s_cselect_b32 s56,0x80000000,s56
buffer_store_dwordx4 v[160:163],v0,s[4:7],s56 offen sc1
s_waitcnt vmcnt(0)
s_endpgm
L_mf_418:
s_cmp_lg_u32 s46,0
s_cbranch_scc1 L_mf_423
v_mov_b64 v[24:25],0
v_mov_b64 v[26:27],0
s_mov_b32 s56,94403584
buffer_store_dwordx4 v[24:27],v0,s[8:11],s56 offen sc1
s_mov_b32 s56,94436352
buffer_store_dwordx4 v[24:27],v0,s[8:11],s56 offen sc1
s_mov_b32 s56,94469120
buffer_store_dwordx4 v[24:27],v0,s[8:11],s56 offen sc1
s_mov_b32 s56,94501888
buffer_store_dwordx4 v[24:27],v0,s[8:11],s56 offen sc1
s_mov_b32 s56,94534656
buffer_store_dwordx4 v[24:27],v0,s[8:11],s56 offen sc1
s_mov_b32 s56,94567424
buffer_store_dwordx4 v[24:27],v0,s[8:11],s56 offen sc1
s_andn2_b32 s61,0x7ff,s54
s_lshr_b32 s61,s61,5
s_mov_b32 s59,11018240
v_lshlrev_b32 v2,2,v1
L_fp_430:
s_sleep 2
buffer_load_dword v3,v2,s[8:11],s59 offen sc1
s_sub_u32 s49,s49,1
s_cbranch_scc1 L_abort2
s_waitcnt vmcnt(0)
v_cmp_eq_u32 vcc,0,v3
s_cbranch_vccnz L_fp_430
v_cmp_le_u32 vcc,s61,v1
s_nop 1
v_cndmask_b32 v2,1,2,vcc
v_cmp_ne_u32 s[84:85],v2,v3
s_mov_b32 s56,11011324
buffer_store_dword v17,off,s[8:11],s56 sc1
s_mov_b32 s56,11019516
buffer_store_dword v17,off,s[8:11],s56 sc1
s_mov_b32 s56,11027708
buffer_store_dword v17,off,s[8:11],s56 sc1
s_mov_b32 s56,11035900
buffer_store_dword v17,off,s[8:11],s56 sc1
s_mov_b32 s56,11044092
buffer_store_dword v17,off,s[8:11],s56 sc1
s_mov_b32 s56,11052284
buffer_store_dword v17,off,s[8:11],s56 sc1
v_lshrrev_b32 v2,3,v1
v_and_b32 v3,0x70,v0
v_lshl_add_u32 v3,v2,13,v3
s_lshr_b64 s[20:21],s[84:85],0
v_lshrrev_b32 v60,v2,s20
v_and_b32 v60,1,v60
v_mul_u32_u24 v60,768,v60
v_sub_u32 v60,v3,v60
v_add_u32 v60,10487296,v60
s_lshr_b64 s[20:21],s[84:85],8
v_lshrrev_b32 v61,v2,s20
v_and_b32 v61,1,v61
v_mul_u32_u24 v61,768,v61
v_sub_u32 v61,v3,v61
v_add_u32 v61,10552832,v61
s_lshr_b64 s[20:21],s[84:85],16
v_lshrrev_b32 v62,v2,s20
v_and_b32 v62,1,v62
v_mul_u32_u24 v62,768,v62
v_sub_u32 v62,v3,v62
v_add_u32 v62,10618368,v62
s_lshr_b64 s[20:21],s[84:85],24
v_lshrrev_b32 v63,v2,s20
v_and_b32 v63,1,v63
v_mul_u32_u24 v63,768,v63
v_sub_u32 v63,v3,v63
v_add_u32 v63,10683904,v63
s_lshr_b64 s[20:21],s[84:85],32
v_lshrrev_b32 v64,v2,s20
v_and_b32 v64,1,v64
v_mul_u32_u24 v64,768,v64
v_sub_u32 v64,v3,v64
v_add_u32 v64,10749440,v64
s_lshr_b64 s[20:21],s[84:85],40
v_lshrrev_b32 v65,v2,s20
v_and_b32 v65,1,v65
v_mul_u32_u24 v65,768,v65
v_sub_u32 v65,v3,v65
v_add_u32 v65,10814976,v65
s_lshr_b64 s[20:21],s[84:85],48
v_lshrrev_b32 v66,v2,s20
v_and_b32 v66,1,v66
v_mul_u32_u24 v66,768,v66
v_sub_u32 v66,v3,v66
v_add_u32 v66,10880512,v66
s_lshr_b64 s[20:21],s[84:85],56
v_lshrrev_b32 v67,v2,s20
v_and_b32 v67,1,v67
v_mul_u32_u24 v67,768,v67
v_sub_u32 v67,v3,v67
v_add_u32 v67,10946048,v67
v_and_b32 v68,3,v1
v_lshlrev_b32 v68,7,v68
v_add_u32 v68,10486272,v68
v_and_b32 v69,31,v1
v_lshlrev_b32 v69,2,v69
v_add_u32 v69,10478720,v69
s_mov_b32 s66,0
s_mov_b32 s67,524288
v_mov_b32 v57,0
s_mov_b32 s58,1
L_mf_421:
s_sub_u32 s49,s49,1
s_cbranch_scc1 L_abort2
s_mov_b32 s57,0
s_cmp_lg_u32 s58,0
s_cbranch_scc1 L_ms_431
buffer_load_dwordx4 v[52:55],v67,s[8:11],0 offen sc1
buffer_load_dword v70,v69,s[8:11],s67 offen sc1
s_branch L_mj_432
L_ms_431:
buffer_load_dwordx4 v[24:27],v60,s[8:11],0 offen sc1
buffer_load_dwordx4 v[28:31],v61,s[8:11],0 offen sc1
buffer_load_dwordx4 v[32:35],v62,s[8:11],0 offen sc1
buffer_load_dwordx4 v[36:39],v63,s[8:11],0 offen sc1
buffer_load_dwordx4 v[40:43],v64,s[8:11],0 offen sc1
buffer_load_dwordx4 v[44:47],v65,s[8:11],0 offen sc1
buffer_load_dwordx4 v[48:51],v66,s[8:11],0 offen sc1
buffer_load_dwordx4 v[52:55],v67,s[8:11],0 offen sc1
buffer_load_dword v70,v69,s[8:11],s67 offen sc1
s_waitcnt vmcnt(8)
v_min3_u32 v56,v24,v25,v26
v_max3_u32 v57,v24,v25,v57
v_min_u32 v56,v27,v56
v_max3_u32 v57,v26,v27,v57
v_cmp_eq_u32 vcc,0,v56
s_bcnt1_i32_b64 s56,vcc
s_add_u32 s57,s57,s56
s_waitcnt vmcnt(7)
v_min3_u32 v56,v28,v29,v30
v_max3_u32 v57,v28,v29,v57
v_min_u32 v56,v31,v56
v_max3_u32 v57,v30,v31,v57
v_cmp_eq_u32 vcc,0,v56
s_bcnt1_i32_b64 s56,vcc
s_add_u32 s57,s57,s56
s_waitcnt vmcnt(6)
v_min3_u32 v56,v32,v33,v34
v_max3_u32 v57,v32,v33,v57
v_min_u32 v56,v35,v56
v_max3_u32 v57,v34,v35,v57
v_cmp_eq_u32 vcc,0,v56
s_bcnt1_i32_b64 s56,vcc
s_add_u32 s57,s57,s56
s_waitcnt vmcnt(5)
v_min3_u32 v56,v36,v37,v38
v_max3_u32 v57,v36,v37,v57
v_min_u32 v56,v39,v56
v_max3_u32 v57,v38,v39,v57
v_cmp_eq_u32 vcc,0,v56
s_bcnt1_i32_b64 s56,vcc
s_add_u32 s57,s57,s56
s_waitcnt vmcnt(4)
v_min3_u32 v56,v40,v41,v42
v_max3_u32 v57,v40,v41,v57
v_min_u32 v56,v43,v56
v_max3_u32 v57,v42,v43,v57
v_cmp_eq_u32 vcc,0,v56
s_bcnt1_i32_b64 s56,vcc
s_add_u32 s57,s57,s56
s_waitcnt vmcnt(3)
v_min3_u32 v56,v44,v45,v46
v_max3_u32 v57,v44,v45,v57
v_min_u32 v56,v47,v56
v_max3_u32 v57,v46,v47,v57
v_cmp_eq_u32 vcc,0,v56
s_bcnt1_i32_b64 s56,vcc
s_add_u32 s57,s57,s56
s_waitcnt vmcnt(2)
v_min3_u32 v56,v48,v49,v50
v_max3_u32 v57,v48,v49,v57
v_min_u32 v56,v51,v56
v_max3_u32 v57,v50,v51,v57
v_cmp_eq_u32 vcc,0,v56
s_bcnt1_i32_b64 s56,vcc
s_add_u32 s57,s57,s56
s_mov_b32 s58,s57
L_mj_432:
s_waitcnt vmcnt(1)
v_min3_u32 v56,v52,v53,v54
v_max3_u32 v57,v52,v53,v57
v_min_u32 v56,v55,v56
v_max3_u32 v57,v54,v55,v57
v_cmp_eq_u32 vcc,0,v56
s_bcnt1_i32_b64 s56,vcc
s_add_u32 s57,s57,s56
v_max_u32_dpp v57,v57,v57 row_ror:8 row_mask:0xf bank_mask:0xf
s_nop 1
v_max_u32_dpp v57,v57,v57 row_ror:4 row_mask:0xf bank_mask:0xf
s_nop 1
v_max_u32_dpp v57,v57,v57 row_ror:2 row_mask:0xf bank_mask:0xf
s_nop 1
v_max_u32_dpp v57,v57,v57 row_ror:1 row_mask:0xf bank_mask:0xf
v_mov_b32 v58,v57
s_nop 1
v_permlane16_swap_b32 v57,v58
v_max_u32 v57,v57,v58
v_mov_b32 v58,v57
s_nop 1
v_permlane32_swap_b32 v57,v58
v_max_u32 v57,v57,v58
s_nop 0
v_readfirstlane_b32 s55,v57
s_cmp_lg_u32 s55,s66
s_cbranch_scc1 L_mf_422
s_cmp_lg_u32 s57,0
s_cbranch_scc1 L_mf_421
v_mov_b32 v57,1
buffer_store_dword v57,v68,s[8:11],s67 offen sc1
L_mf_423:
s_waitcnt vmcnt(0)
s_endpgm
L_mf_422:
s_waitcnt vmcnt(0)
v_cmp_eq_u32 vcc,0,v70
s_cmp_eq_u32 s66,0
s_cselect_b32 s56,0,vcc_lo
s_cmp_gt_u32 s57,112
s_cselect_b32 s56,1,s56
s_cmp_ge_u32 s67,565248
s_cselect_b32 s56,1,s56
s_cmp_eq_u32 s57,0
s_cselect_b32 s56,0,s56
s_cmp_lg_u32 s56,0
s_cbranch_scc1 L_mf_421
buffer_store_dword v57,v68,s[8:11],s67 offen sc1
s_mov_b32 s66,s55
s_add_u32 s67,s67,8192
s_branch L_mf_421
s_endpgm
.section .rodata,"a"
.p2align 6
.amdhsa_kernel interleave_layers__memory_aug_recurrent_mem_tr__moe_arch_mod__prompt_kernel
  .amdhsa_next_free_vgpr 512
  .amdhsa_next_free_sgpr 102
  .amdhsa_accum_offset 256
  .amdhsa_group_segment_fixed_size 0
  .amdhsa_kernarg_size 120
  .amdhsa_user_sgpr_count 2
  .amdhsa_user_sgpr_kernarg_segment_ptr 1
  .amdhsa_system_sgpr_workgroup_id_x 1
  .amdhsa_float_denorm_mode_32 3
.end_amdhsa_kernel
```
